```python
import torch

def _softmax(x, axis=-1):
    return torch.softmax(x, dim=axis)
def _gelu(x):
    return torch.nn.functional.gelu(x, approximate="tanh")
def _silu(x):
    return torch.nn.functional.silu(x)
def _sigmoid(x):
    return torch.sigmoid(x)
def _layernorm(x, axis=-1, eps=1e-5):
    m = x.mean(dim=axis, keepdim=True)
    v = x.var(dim=axis, keepdim=True, unbiased=False)
    return (x - m) / torch.sqrt(v + eps)
def _scatter_add(tgt, idx, src, axis=0):
    return tgt.clone().index_add_(axis, idx, src)
def _segment_sum(src, seg, n):
    out = torch.zeros((n,) + src.shape[1:], dtype=src.dtype)
    return out.index_add_(0, seg, src)
def _pad(x, pw):
    flat = tuple(v for pair in reversed(pw) for v in pair)
    return torch.nn.functional.pad(x, flat)

kernel_name = 'standalone__modern_conv_block_convnext_v2__vision'

def setup_inputs():

    _w = (lambda a: (lambda t: t.to(torch.bfloat16) if t.is_floating_point() else t)(torch.as_tensor(a)))
    H = W = 512
    C = 96
    K = 3
    return {
        "x": _w((lambda *s: torch.randn(*s, dtype=torch.bfloat16) * 0.05)(1, H, W, C)),
        "dw": _w((lambda *s: torch.randn(*s, dtype=torch.bfloat16) * 0.05)(K, K, C)),
        "w1": _w((lambda *s: torch.randn(*s, dtype=torch.bfloat16) * 0.05)(C, 4 * C)),
        "w2": _w((lambda *s: torch.randn(*s, dtype=torch.bfloat16) * 0.05)(4 * C, C)),
        "grn_gamma": _w((lambda *s: torch.randn(*s, dtype=torch.bfloat16) * 0.05)(4 * C)),
        "grn_beta": _w((lambda *s: torch.randn(*s, dtype=torch.bfloat16) * 0.05)(4 * C)),
    }

def reference(x, dw, w1, w2, grn_gamma, grn_beta):
    B, H, W, C = x.shape
    K = dw.shape[0]
    pad = K // 2
    xp = _pad(x, ((0,0),(pad,pad),(pad,pad),(0,0)))
    out = torch.zeros_like(x)
    for i in range(K):
        for j in range(K):
            out = out + xp[:, i:i+H, j:j+W, :] * dw[i, j][None, None, None, :]
    h = _layernorm(out, axis=-1)
    h = torch.einsum('bhwc,ce->bhwe', h, w1)
    h = _gelu(h)
    gx = torch.sqrt((h * h).sum(axis=(1, 2), keepdims=True) + 1e-6)
    nx = gx / (gx.mean(axis=-1, keepdims=True) + 1e-6)
    h = grn_gamma * (h * nx) + grn_beta + h
    h = torch.einsum('bhwe,ec->bhwc', h, w2)
    return x + h
```

```asm
; @launch grid=(256,1,1) block=(512,1,1) lds=163840
.amdgcn_target "amdgcn-amd-amdhsa--gfx950"
.text
.globl standalone__modern_conv_block_convnext_v2__vision_kernel
.p2align 8
.type standalone__modern_conv_block_convnext_v2__vision_kernel,@function
standalone__modern_conv_block_convnext_v2__vision_kernel:
s_branch Lmain
Lconv0:
ds_read_b64 v[224:225], v245
ds_read_b64 v[226:227], v246
ds_read_b128 v[192:195], v242
ds_read_b64 v[228:229], v245 offset:768
ds_read_b64 v[230:231], v246 offset:768
ds_read_b128 v[196:199], v242 offset:64
ds_read_b64 v[232:233], v245 offset:1536
ds_read_b64 v[234:235], v246 offset:1536
ds_read_b128 v[200:203], v242 offset:128
ds_read_b64 v[236:237], v245 offset:2304
ds_read_b64 v[238:239], v246 offset:2304
ds_read_b128 v[204:207], v243
ds_read_b64 v[216:217], v245 offset:3072
ds_read_b64 v[218:219], v246 offset:3072
ds_read_b128 v[208:211], v243 offset:64
ds_read_b64 v[220:221], v245 offset:3840
ds_read_b64 v[222:223], v246 offset:3840
ds_read_b128 v[212:215], v243 offset:128
s_waitcnt lgkmcnt(15)
v_mfma_f32_16x16x32_bf16 v[0:3], v[224:227], v[192:195], 0
s_waitcnt lgkmcnt(12)
v_mfma_f32_16x16x32_bf16 v[16:19], v[228:231], v[196:199], 0
ds_read_b64 v[224:225], v245 offset:4608
ds_read_b64 v[226:227], v246 offset:4608
ds_read_b128 v[192:195], v244
s_waitcnt lgkmcnt(12)
v_mfma_f32_16x16x32_bf16 v[32:35], v[232:235], v[200:203], 0
ds_read_b64 v[228:229], v245 offset:5376
ds_read_b64 v[230:231], v246 offset:5376
ds_read_b128 v[196:199], v244 offset:64
s_waitcnt lgkmcnt(12)
v_mfma_f32_16x16x32_bf16 v[0:3], v[236:239], v[204:207], v[0:3]
ds_read_b64 v[232:233], v245 offset:6144
ds_read_b64 v[234:235], v246 offset:6144
ds_read_b128 v[200:203], v244 offset:128
s_waitcnt lgkmcnt(12)
v_mfma_f32_16x16x32_bf16 v[16:19], v[216:219], v[208:211], v[16:19]
ds_read_b64 v[236:237], v245 offset:192
ds_read_b64 v[238:239], v246 offset:192
v_xor_b32 v242, 16, v242
ds_read_b128 v[204:207], v242
s_waitcnt lgkmcnt(12)
v_mfma_f32_16x16x32_bf16 v[32:35], v[220:223], v[212:215], v[32:35]
ds_read_b64 v[216:217], v245 offset:960
ds_read_b64 v[218:219], v246 offset:960
ds_read_b128 v[208:211], v242 offset:64
s_waitcnt lgkmcnt(12)
v_mfma_f32_16x16x32_bf16 v[0:3], v[224:227], v[192:195], v[0:3]
ds_read_b64 v[220:221], v245 offset:1728
ds_read_b64 v[222:223], v246 offset:1728
ds_read_b128 v[212:215], v242 offset:128
s_waitcnt lgkmcnt(12)
v_mfma_f32_16x16x32_bf16 v[16:19], v[228:231], v[196:199], v[16:19]
ds_read_b64 v[224:225], v245 offset:2496
ds_read_b64 v[226:227], v246 offset:2496
v_xor_b32 v243, 16, v243
ds_read_b128 v[192:195], v243
s_waitcnt lgkmcnt(12)
v_mfma_f32_16x16x32_bf16 v[32:35], v[232:235], v[200:203], v[32:35]
ds_read_b64 v[228:229], v245 offset:3264
ds_read_b64 v[230:231], v246 offset:3264
ds_read_b128 v[196:199], v243 offset:64
s_waitcnt lgkmcnt(12)
v_mfma_f32_16x16x32_bf16 v[4:7], v[236:239], v[204:207], 0
ds_read_b64 v[232:233], v245 offset:4032
ds_read_b64 v[234:235], v246 offset:4032
ds_read_b128 v[200:203], v243 offset:128
s_waitcnt lgkmcnt(12)
v_mfma_f32_16x16x32_bf16 v[20:23], v[216:219], v[208:211], 0
ds_read_b64 v[236:237], v245 offset:4800
ds_read_b64 v[238:239], v246 offset:4800
v_xor_b32 v244, 16, v244
ds_read_b128 v[204:207], v244
s_waitcnt lgkmcnt(12)
v_mfma_f32_16x16x32_bf16 v[36:39], v[220:223], v[212:215], 0
ds_read_b64 v[216:217], v245 offset:5568
ds_read_b64 v[218:219], v246 offset:5568
ds_read_b128 v[208:211], v244 offset:64
s_waitcnt lgkmcnt(12)
v_mfma_f32_16x16x32_bf16 v[4:7], v[224:227], v[192:195], v[4:7]
ds_read_b64 v[220:221], v245 offset:6336
ds_read_b64 v[222:223], v246 offset:6336
ds_read_b128 v[212:215], v244 offset:128
s_waitcnt lgkmcnt(12)
v_mfma_f32_16x16x32_bf16 v[20:23], v[228:231], v[196:199], v[20:23]
ds_read_b64 v[224:225], v245 offset:576
ds_read_b64 v[226:227], v246 offset:576
v_xor_b32 v242, 32, v242
ds_read_b128 v[192:195], v242
s_waitcnt lgkmcnt(12)
v_mfma_f32_16x16x32_bf16 v[36:39], v[232:235], v[200:203], v[36:39]
ds_read_b64 v[228:229], v245 offset:1344
ds_read_b64 v[230:231], v246 offset:1344
ds_read_b128 v[196:199], v242 offset:64
s_waitcnt lgkmcnt(12)
v_mfma_f32_16x16x32_bf16 v[4:7], v[236:239], v[204:207], v[4:7]
ds_read_b64 v[232:233], v245 offset:2112
ds_read_b64 v[234:235], v246 offset:2112
ds_read_b128 v[200:203], v242 offset:128
s_waitcnt lgkmcnt(12)
v_mfma_f32_16x16x32_bf16 v[20:23], v[216:219], v[208:211], v[20:23]
ds_read_b64 v[236:237], v245 offset:2880
ds_read_b64 v[238:239], v246 offset:2880
v_xor_b32 v243, 32, v243
ds_read_b128 v[204:207], v243
s_waitcnt lgkmcnt(12)
v_mfma_f32_16x16x32_bf16 v[36:39], v[220:223], v[212:215], v[36:39]
ds_read_b64 v[216:217], v245 offset:3648
ds_read_b64 v[218:219], v246 offset:3648
ds_read_b128 v[208:211], v243 offset:64
s_waitcnt lgkmcnt(12)
v_mfma_f32_16x16x32_bf16 v[12:15], v[224:227], v[192:195], 0
ds_read_b64 v[220:221], v245 offset:4416
ds_read_b64 v[222:223], v246 offset:4416
ds_read_b128 v[212:215], v243 offset:128
s_waitcnt lgkmcnt(12)
v_mfma_f32_16x16x32_bf16 v[28:31], v[228:231], v[196:199], 0
ds_read_b64 v[224:225], v245 offset:5184
ds_read_b64 v[226:227], v246 offset:5184
v_xor_b32 v244, 32, v244
ds_read_b128 v[192:195], v244
s_waitcnt lgkmcnt(12)
v_mfma_f32_16x16x32_bf16 v[44:47], v[232:235], v[200:203], 0
ds_read_b64 v[228:229], v245 offset:5952
ds_read_b64 v[230:231], v246 offset:5952
ds_read_b128 v[196:199], v244 offset:64
s_waitcnt lgkmcnt(12)
v_mfma_f32_16x16x32_bf16 v[12:15], v[236:239], v[204:207], v[12:15]
ds_read_b64 v[232:233], v245 offset:6720
ds_read_b64 v[234:235], v246 offset:6720
ds_read_b128 v[200:203], v244 offset:128
s_waitcnt lgkmcnt(12)
v_mfma_f32_16x16x32_bf16 v[28:31], v[216:219], v[208:211], v[28:31]
ds_read_b64 v[236:237], v245 offset:384
ds_read_b64 v[238:239], v246 offset:384
v_xor_b32 v242, 16, v242
ds_read_b128 v[204:207], v242
s_waitcnt lgkmcnt(12)
v_mfma_f32_16x16x32_bf16 v[44:47], v[220:223], v[212:215], v[44:47]
ds_read_b64 v[216:217], v245 offset:1152
ds_read_b64 v[218:219], v246 offset:1152
ds_read_b128 v[208:211], v242 offset:64
s_waitcnt lgkmcnt(12)
v_mfma_f32_16x16x32_bf16 v[12:15], v[224:227], v[192:195], v[12:15]
ds_read_b64 v[220:221], v245 offset:1920
ds_read_b64 v[222:223], v246 offset:1920
ds_read_b128 v[212:215], v242 offset:128
s_waitcnt lgkmcnt(12)
v_mfma_f32_16x16x32_bf16 v[28:31], v[228:231], v[196:199], v[28:31]
ds_read_b64 v[224:225], v245 offset:2688
ds_read_b64 v[226:227], v246 offset:2688
v_xor_b32 v243, 16, v243
ds_read_b128 v[192:195], v243
s_waitcnt lgkmcnt(12)
v_mfma_f32_16x16x32_bf16 v[44:47], v[232:235], v[200:203], v[44:47]
ds_read_b64 v[228:229], v245 offset:3456
ds_read_b64 v[230:231], v246 offset:3456
ds_read_b128 v[196:199], v243 offset:64
s_waitcnt lgkmcnt(12)
v_mfma_f32_16x16x32_bf16 v[8:11], v[236:239], v[204:207], 0
ds_read_b64 v[232:233], v245 offset:4224
ds_read_b64 v[234:235], v246 offset:4224
ds_read_b128 v[200:203], v243 offset:128
s_waitcnt lgkmcnt(12)
v_mfma_f32_16x16x32_bf16 v[24:27], v[216:219], v[208:211], 0
ds_read_b64 v[236:237], v245 offset:4992
ds_read_b64 v[238:239], v246 offset:4992
v_xor_b32 v244, 16, v244
ds_read_b128 v[204:207], v244
s_waitcnt lgkmcnt(12)
v_mfma_f32_16x16x32_bf16 v[40:43], v[220:223], v[212:215], 0
ds_read_b64 v[216:217], v245 offset:5760
ds_read_b64 v[218:219], v246 offset:5760
ds_read_b128 v[208:211], v244 offset:64
s_waitcnt lgkmcnt(12)
v_mfma_f32_16x16x32_bf16 v[8:11], v[224:227], v[192:195], v[8:11]
ds_read_b64 v[220:221], v245 offset:6528
ds_read_b64 v[222:223], v246 offset:6528
ds_read_b128 v[212:215], v244 offset:128
s_waitcnt lgkmcnt(12)
v_mfma_f32_16x16x32_bf16 v[24:27], v[228:231], v[196:199], v[24:27]
s_waitcnt lgkmcnt(9)
v_mfma_f32_16x16x32_bf16 v[40:43], v[232:235], v[200:203], v[40:43]
s_waitcnt lgkmcnt(6)
v_mfma_f32_16x16x32_bf16 v[8:11], v[236:239], v[204:207], v[8:11]
s_waitcnt lgkmcnt(3)
v_mfma_f32_16x16x32_bf16 v[24:27], v[216:219], v[208:211], v[24:27]
s_waitcnt lgkmcnt(0)
v_mfma_f32_16x16x32_bf16 v[40:43], v[220:223], v[212:215], v[40:43]
s_nop 11
s_setpc_b64 s[78:79]
Lln0:
v_pk_add_f32 v[168:169], v[0:1], v[2:3]
v_pk_mul_f32 v[170:171], v[0:1], v[0:1]
v_pk_fma_f32 v[170:171], v[2:3], v[2:3], v[170:171]
v_pk_add_f32 v[168:169], v[168:169], v[4:5]
v_pk_fma_f32 v[170:171], v[4:5], v[4:5], v[170:171]
v_pk_add_f32 v[168:169], v[168:169], v[6:7]
v_pk_fma_f32 v[170:171], v[6:7], v[6:7], v[170:171]
v_pk_add_f32 v[168:169], v[168:169], v[8:9]
v_pk_fma_f32 v[170:171], v[8:9], v[8:9], v[170:171]
v_pk_add_f32 v[168:169], v[168:169], v[10:11]
v_pk_fma_f32 v[170:171], v[10:11], v[10:11], v[170:171]
v_pk_add_f32 v[168:169], v[168:169], v[12:13]
v_pk_fma_f32 v[170:171], v[12:13], v[12:13], v[170:171]
v_pk_add_f32 v[168:169], v[168:169], v[14:15]
v_pk_fma_f32 v[170:171], v[14:15], v[14:15], v[170:171]
v_pk_add_f32 v[168:169], v[168:169], v[16:17]
v_pk_fma_f32 v[170:171], v[16:17], v[16:17], v[170:171]
v_pk_add_f32 v[168:169], v[168:169], v[18:19]
v_pk_fma_f32 v[170:171], v[18:19], v[18:19], v[170:171]
v_pk_add_f32 v[168:169], v[168:169], v[20:21]
v_pk_fma_f32 v[170:171], v[20:21], v[20:21], v[170:171]
v_pk_add_f32 v[168:169], v[168:169], v[22:23]
v_pk_fma_f32 v[170:171], v[22:23], v[22:23], v[170:171]
v_pk_add_f32 v[168:169], v[168:169], v[24:25]
v_pk_fma_f32 v[170:171], v[24:25], v[24:25], v[170:171]
v_pk_add_f32 v[168:169], v[168:169], v[26:27]
v_pk_fma_f32 v[170:171], v[26:27], v[26:27], v[170:171]
v_pk_add_f32 v[168:169], v[168:169], v[28:29]
v_pk_fma_f32 v[170:171], v[28:29], v[28:29], v[170:171]
v_pk_add_f32 v[168:169], v[168:169], v[30:31]
v_pk_fma_f32 v[170:171], v[30:31], v[30:31], v[170:171]
v_pk_add_f32 v[168:169], v[168:169], v[32:33]
v_pk_fma_f32 v[170:171], v[32:33], v[32:33], v[170:171]
v_pk_add_f32 v[168:169], v[168:169], v[34:35]
v_pk_fma_f32 v[170:171], v[34:35], v[34:35], v[170:171]
v_pk_add_f32 v[168:169], v[168:169], v[36:37]
v_pk_fma_f32 v[170:171], v[36:37], v[36:37], v[170:171]
v_pk_add_f32 v[168:169], v[168:169], v[38:39]
v_pk_fma_f32 v[170:171], v[38:39], v[38:39], v[170:171]
v_pk_add_f32 v[168:169], v[168:169], v[40:41]
v_pk_fma_f32 v[170:171], v[40:41], v[40:41], v[170:171]
v_pk_add_f32 v[168:169], v[168:169], v[42:43]
v_pk_fma_f32 v[170:171], v[42:43], v[42:43], v[170:171]
v_pk_add_f32 v[168:169], v[168:169], v[44:45]
v_pk_fma_f32 v[170:171], v[44:45], v[44:45], v[170:171]
v_pk_add_f32 v[168:169], v[168:169], v[46:47]
v_pk_fma_f32 v[170:171], v[46:47], v[46:47], v[170:171]
v_add_f32 v168, v168, v169
v_add_f32 v170, v170, v171
s_nop 1
v_permlane32_swap_b32 v168, v170
v_add_f32_e64 v168, v168, v170
v_mul_f32 v168, 1009429163, v168
v_mov_b32_e64 v170, v168
s_nop 1
v_permlane32_swap_b32 v168, v170
v_fma_f32 v170, -v168, v168, v170
v_max_f32_e64 v170, 0, v170
v_add_f32 v170, 925353388, v170
v_rsq_f32 v170, v170
s_nop 0
v_mul_f32 v172, 3203391086, v170
v_mul_f32_e64 v173, v168, v172
v_pk_fma_f32 v[0:1], v[0:1], v[172:173], v[172:173] op_sel:[0,0,1] op_sel_hi:[1,0,1] neg_lo:[0,0,1] neg_hi:[0,0,1]
v_pk_fma_f32 v[2:3], v[2:3], v[172:173], v[172:173] op_sel:[0,0,1] op_sel_hi:[1,0,1] neg_lo:[0,0,1] neg_hi:[0,0,1]
v_pk_fma_f32 v[4:5], v[4:5], v[172:173], v[172:173] op_sel:[0,0,1] op_sel_hi:[1,0,1] neg_lo:[0,0,1] neg_hi:[0,0,1]
v_pk_fma_f32 v[6:7], v[6:7], v[172:173], v[172:173] op_sel:[0,0,1] op_sel_hi:[1,0,1] neg_lo:[0,0,1] neg_hi:[0,0,1]
v_pk_fma_f32 v[8:9], v[8:9], v[172:173], v[172:173] op_sel:[0,0,1] op_sel_hi:[1,0,1] neg_lo:[0,0,1] neg_hi:[0,0,1]
v_pk_fma_f32 v[10:11], v[10:11], v[172:173], v[172:173] op_sel:[0,0,1] op_sel_hi:[1,0,1] neg_lo:[0,0,1] neg_hi:[0,0,1]
v_pk_fma_f32 v[12:13], v[12:13], v[172:173], v[172:173] op_sel:[0,0,1] op_sel_hi:[1,0,1] neg_lo:[0,0,1] neg_hi:[0,0,1]
v_pk_fma_f32 v[14:15], v[14:15], v[172:173], v[172:173] op_sel:[0,0,1] op_sel_hi:[1,0,1] neg_lo:[0,0,1] neg_hi:[0,0,1]
v_pk_fma_f32 v[16:17], v[16:17], v[172:173], v[172:173] op_sel:[0,0,1] op_sel_hi:[1,0,1] neg_lo:[0,0,1] neg_hi:[0,0,1]
v_pk_fma_f32 v[18:19], v[18:19], v[172:173], v[172:173] op_sel:[0,0,1] op_sel_hi:[1,0,1] neg_lo:[0,0,1] neg_hi:[0,0,1]
v_pk_fma_f32 v[20:21], v[20:21], v[172:173], v[172:173] op_sel:[0,0,1] op_sel_hi:[1,0,1] neg_lo:[0,0,1] neg_hi:[0,0,1]
v_pk_fma_f32 v[22:23], v[22:23], v[172:173], v[172:173] op_sel:[0,0,1] op_sel_hi:[1,0,1] neg_lo:[0,0,1] neg_hi:[0,0,1]
v_pk_fma_f32 v[24:25], v[24:25], v[172:173], v[172:173] op_sel:[0,0,1] op_sel_hi:[1,0,1] neg_lo:[0,0,1] neg_hi:[0,0,1]
v_pk_fma_f32 v[26:27], v[26:27], v[172:173], v[172:173] op_sel:[0,0,1] op_sel_hi:[1,0,1] neg_lo:[0,0,1] neg_hi:[0,0,1]
v_pk_fma_f32 v[28:29], v[28:29], v[172:173], v[172:173] op_sel:[0,0,1] op_sel_hi:[1,0,1] neg_lo:[0,0,1] neg_hi:[0,0,1]
v_pk_fma_f32 v[30:31], v[30:31], v[172:173], v[172:173] op_sel:[0,0,1] op_sel_hi:[1,0,1] neg_lo:[0,0,1] neg_hi:[0,0,1]
v_pk_fma_f32 v[32:33], v[32:33], v[172:173], v[172:173] op_sel:[0,0,1] op_sel_hi:[1,0,1] neg_lo:[0,0,1] neg_hi:[0,0,1]
v_pk_fma_f32 v[34:35], v[34:35], v[172:173], v[172:173] op_sel:[0,0,1] op_sel_hi:[1,0,1] neg_lo:[0,0,1] neg_hi:[0,0,1]
v_pk_fma_f32 v[36:37], v[36:37], v[172:173], v[172:173] op_sel:[0,0,1] op_sel_hi:[1,0,1] neg_lo:[0,0,1] neg_hi:[0,0,1]
v_pk_fma_f32 v[38:39], v[38:39], v[172:173], v[172:173] op_sel:[0,0,1] op_sel_hi:[1,0,1] neg_lo:[0,0,1] neg_hi:[0,0,1]
v_pk_fma_f32 v[40:41], v[40:41], v[172:173], v[172:173] op_sel:[0,0,1] op_sel_hi:[1,0,1] neg_lo:[0,0,1] neg_hi:[0,0,1]
v_pk_fma_f32 v[42:43], v[42:43], v[172:173], v[172:173] op_sel:[0,0,1] op_sel_hi:[1,0,1] neg_lo:[0,0,1] neg_hi:[0,0,1]
v_pk_fma_f32 v[44:45], v[44:45], v[172:173], v[172:173] op_sel:[0,0,1] op_sel_hi:[1,0,1] neg_lo:[0,0,1] neg_hi:[0,0,1]
v_pk_fma_f32 v[46:47], v[46:47], v[172:173], v[172:173] op_sel:[0,0,1] op_sel_hi:[1,0,1] neg_lo:[0,0,1] neg_hi:[0,0,1]
v_cvt_pk_bf16_f32 v48, v0, v1
v_cvt_pk_bf16_f32 v49, v2, v3
v_cvt_pk_bf16_f32 v50, v4, v5
v_cvt_pk_bf16_f32 v51, v6, v7
v_cvt_pk_bf16_f32 v52, v8, v9
v_cvt_pk_bf16_f32 v53, v10, v11
v_cvt_pk_bf16_f32 v54, v12, v13
v_cvt_pk_bf16_f32 v55, v14, v15
v_cvt_pk_bf16_f32 v56, v16, v17
v_cvt_pk_bf16_f32 v57, v18, v19
v_cvt_pk_bf16_f32 v58, v20, v21
v_cvt_pk_bf16_f32 v59, v22, v23
v_cvt_pk_bf16_f32 v60, v24, v25
v_cvt_pk_bf16_f32 v61, v26, v27
v_cvt_pk_bf16_f32 v62, v28, v29
v_cvt_pk_bf16_f32 v63, v30, v31
v_cvt_pk_bf16_f32 v64, v32, v33
v_cvt_pk_bf16_f32 v65, v34, v35
v_cvt_pk_bf16_f32 v66, v36, v37
v_cvt_pk_bf16_f32 v67, v38, v39
v_cvt_pk_bf16_f32 v68, v40, v41
v_cvt_pk_bf16_f32 v69, v42, v43
v_cvt_pk_bf16_f32 v70, v44, v45
v_cvt_pk_bf16_f32 v71, v46, v47
s_nop 1
s_setpc_b64 s[78:79]
Lw1a:
s_waitcnt vmcnt(0)
v_add_u32 v148, 65536, v146
v_add_u32 v149, 65536, v147
ds_read_b64_tr_b16 v[72:73], v146
ds_read_b64_tr_b16 v[74:75], v146 offset:512
ds_read_b64_tr_b16 v[76:77], v146 offset:4096
ds_read_b64_tr_b16 v[78:79], v146 offset:4608
ds_read_b64_tr_b16 v[80:81], v146 offset:8192
ds_read_b64_tr_b16 v[82:83], v146 offset:8704
ds_read_b64_tr_b16 v[84:85], v146 offset:12288
ds_read_b64_tr_b16 v[86:87], v146 offset:12800
ds_read_b64_tr_b16 v[88:89], v146 offset:16384
ds_read_b64_tr_b16 v[90:91], v146 offset:16896
ds_read_b64_tr_b16 v[92:93], v146 offset:20480
ds_read_b64_tr_b16 v[94:95], v146 offset:20992
s_waitcnt lgkmcnt(10)
ds_write_b128 v147, v[72:75]
s_waitcnt lgkmcnt(9)
ds_write_b128 v147, v[76:79] offset:4096
s_waitcnt lgkmcnt(8)
ds_write_b128 v147, v[80:83] offset:8192
s_waitcnt lgkmcnt(7)
ds_write_b128 v147, v[84:87] offset:12288
s_waitcnt lgkmcnt(6)
ds_write_b128 v147, v[88:91] offset:16384
s_waitcnt lgkmcnt(5)
ds_write_b128 v147, v[92:95] offset:20480
s_waitcnt lgkmcnt(0)
s_setpc_b64 s[78:79]
Lw1i:
s_and_b32 s43, s40, 3
s_add_u32 s43, s43, 24
s_mul_i32 s44, s43, 43
s_lshr_b32 s44, s44, 8
s_lshl_b32 s45, s43, 10
s_add_u32 m0, s45, 16384
s_mul_i32 s46, s44, 6
s_sub_u32 s43, s43, s46
s_lshl_b32 s43, s43, 1
s_sub_u32 s45, s43, 5
s_cmp_ge_u32 s43, 6
s_cselect_b32 s43, s45, s43
s_mul_i32 s43, s43, 12288
s_lshl_b32 s44, s44, 6
s_add_u32 s43, s43, s44
buffer_load_dwordx4 v145, s[12:15], s43 offen lds
s_and_b32 s43, s40, 3
s_add_u32 s43, s43, 28
s_mul_i32 s44, s43, 43
s_lshr_b32 s44, s44, 8
s_lshl_b32 s45, s43, 10
s_add_u32 m0, s45, 16384
s_mul_i32 s46, s44, 6
s_sub_u32 s43, s43, s46
s_lshl_b32 s43, s43, 1
s_sub_u32 s45, s43, 5
s_cmp_ge_u32 s43, 6
s_cselect_b32 s43, s45, s43
s_mul_i32 s43, s43, 12288
s_lshl_b32 s44, s44, 6
s_add_u32 s43, s43, s44
buffer_load_dwordx4 v145, s[12:15], s43 offen lds
s_and_b32 s43, s40, 3
s_add_u32 s43, s43, 32
s_mul_i32 s44, s43, 43
s_lshr_b32 s44, s44, 8
s_lshl_b32 s45, s43, 10
s_add_u32 m0, s45, 16384
s_mul_i32 s46, s44, 6
s_sub_u32 s43, s43, s46
s_lshl_b32 s43, s43, 1
s_sub_u32 s45, s43, 5
s_cmp_ge_u32 s43, 6
s_cselect_b32 s43, s45, s43
s_mul_i32 s43, s43, 12288
s_lshl_b32 s44, s44, 6
s_add_u32 s43, s43, s44
buffer_load_dwordx4 v145, s[12:15], s43 offen lds
s_and_b32 s43, s40, 3
s_add_u32 s43, s43, 36
s_mul_i32 s44, s43, 43
s_lshr_b32 s44, s44, 8
s_lshl_b32 s45, s43, 10
s_add_u32 m0, s45, 16384
s_mul_i32 s46, s44, 6
s_sub_u32 s43, s43, s46
s_lshl_b32 s43, s43, 1
s_sub_u32 s45, s43, 5
s_cmp_ge_u32 s43, 6
s_cselect_b32 s43, s45, s43
s_mul_i32 s43, s43, 12288
s_lshl_b32 s44, s44, 6
s_add_u32 s43, s43, s44
buffer_load_dwordx4 v145, s[12:15], s43 offen lds
s_and_b32 s43, s40, 3
s_add_u32 s43, s43, 40
s_mul_i32 s44, s43, 43
s_lshr_b32 s44, s44, 8
s_lshl_b32 s45, s43, 10
s_add_u32 m0, s45, 16384
s_mul_i32 s46, s44, 6
s_sub_u32 s43, s43, s46
s_lshl_b32 s43, s43, 1
s_sub_u32 s45, s43, 5
s_cmp_ge_u32 s43, 6
s_cselect_b32 s43, s45, s43
s_mul_i32 s43, s43, 12288
s_lshl_b32 s44, s44, 6
s_add_u32 s43, s43, s44
buffer_load_dwordx4 v145, s[12:15], s43 offen lds
s_and_b32 s43, s40, 3
s_add_u32 s43, s43, 44
s_mul_i32 s44, s43, 43
s_lshr_b32 s44, s44, 8
s_lshl_b32 s45, s43, 10
s_add_u32 m0, s45, 16384
s_mul_i32 s46, s44, 6
s_sub_u32 s43, s43, s46
s_lshl_b32 s43, s43, 1
s_sub_u32 s45, s43, 5
s_cmp_ge_u32 s43, 6
s_cselect_b32 s43, s45, s43
s_mul_i32 s43, s43, 12288
s_lshl_b32 s44, s44, 6
s_add_u32 s43, s43, s44
buffer_load_dwordx4 v145, s[12:15], s43 offen lds
s_and_b32 s43, s40, 3
s_add_u32 s43, s43, 48
s_mul_i32 s44, s43, 43
s_lshr_b32 s44, s44, 8
s_lshl_b32 s45, s43, 10
s_add_u32 m0, s45, 16384
s_mul_i32 s46, s44, 6
s_sub_u32 s43, s43, s46
s_lshl_b32 s43, s43, 1
s_sub_u32 s45, s43, 5
s_cmp_ge_u32 s43, 6
s_cselect_b32 s43, s45, s43
s_mul_i32 s43, s43, 12288
s_lshl_b32 s44, s44, 6
s_add_u32 s43, s43, s44
buffer_load_dwordx4 v145, s[12:15], s43 offen lds
s_and_b32 s43, s40, 3
s_add_u32 s43, s43, 52
s_mul_i32 s44, s43, 43
s_lshr_b32 s44, s44, 8
s_lshl_b32 s45, s43, 10
s_add_u32 m0, s45, 16384
s_mul_i32 s46, s44, 6
s_sub_u32 s43, s43, s46
s_lshl_b32 s43, s43, 1
s_sub_u32 s45, s43, 5
s_cmp_ge_u32 s43, 6
s_cselect_b32 s43, s45, s43
s_mul_i32 s43, s43, 12288
s_lshl_b32 s44, s44, 6
s_add_u32 s43, s43, s44
buffer_load_dwordx4 v145, s[12:15], s43 offen lds
s_and_b32 s43, s40, 3
s_add_u32 s43, s43, 56
s_mul_i32 s44, s43, 43
s_lshr_b32 s44, s44, 8
s_lshl_b32 s45, s43, 10
s_add_u32 m0, s45, 16384
s_mul_i32 s46, s44, 6
s_sub_u32 s43, s43, s46
s_lshl_b32 s43, s43, 1
s_sub_u32 s45, s43, 5
s_cmp_ge_u32 s43, 6
s_cselect_b32 s43, s45, s43
s_mul_i32 s43, s43, 12288
s_lshl_b32 s44, s44, 6
s_add_u32 s43, s43, s44
buffer_load_dwordx4 v145, s[12:15], s43 offen lds
s_and_b32 s43, s40, 3
s_add_u32 s43, s43, 60
s_mul_i32 s44, s43, 43
s_lshr_b32 s44, s44, 8
s_lshl_b32 s45, s43, 10
s_add_u32 m0, s45, 16384
s_mul_i32 s46, s44, 6
s_sub_u32 s43, s43, s46
s_lshl_b32 s43, s43, 1
s_sub_u32 s45, s43, 5
s_cmp_ge_u32 s43, 6
s_cselect_b32 s43, s45, s43
s_mul_i32 s43, s43, 12288
s_lshl_b32 s44, s44, 6
s_add_u32 s43, s43, s44
buffer_load_dwordx4 v145, s[12:15], s43 offen lds
s_and_b32 s43, s40, 3
s_add_u32 s43, s43, 64
s_mul_i32 s44, s43, 43
s_lshr_b32 s44, s44, 8
s_lshl_b32 s45, s43, 10
s_add_u32 m0, s45, 16384
s_mul_i32 s46, s44, 6
s_sub_u32 s43, s43, s46
s_lshl_b32 s43, s43, 1
s_sub_u32 s45, s43, 5
s_cmp_ge_u32 s43, 6
s_cselect_b32 s43, s45, s43
s_mul_i32 s43, s43, 12288
s_lshl_b32 s44, s44, 6
s_add_u32 s43, s43, s44
buffer_load_dwordx4 v145, s[12:15], s43 offen lds
s_and_b32 s43, s40, 3
s_add_u32 s43, s43, 68
s_mul_i32 s44, s43, 43
s_lshr_b32 s44, s44, 8
s_lshl_b32 s45, s43, 10
s_add_u32 m0, s45, 16384
s_mul_i32 s46, s44, 6
s_sub_u32 s43, s43, s46
s_lshl_b32 s43, s43, 1
s_sub_u32 s45, s43, 5
s_cmp_ge_u32 s43, 6
s_cselect_b32 s43, s45, s43
s_mul_i32 s43, s43, 12288
s_lshl_b32 s44, s44, 6
s_add_u32 s43, s43, s44
buffer_load_dwordx4 v145, s[12:15], s43 offen lds
s_setpc_b64 s[78:79]
Lw1b:
s_waitcnt vmcnt(0)
v_add_u32 v148, 65536, v146
v_add_u32 v149, 65536, v147
ds_read_b64_tr_b16 v[72:73], v146 offset:24576
ds_read_b64_tr_b16 v[74:75], v146 offset:25088
ds_read_b64_tr_b16 v[76:77], v146 offset:28672
ds_read_b64_tr_b16 v[78:79], v146 offset:29184
ds_read_b64_tr_b16 v[80:81], v146 offset:32768
ds_read_b64_tr_b16 v[82:83], v146 offset:33280
ds_read_b64_tr_b16 v[84:85], v146 offset:36864
ds_read_b64_tr_b16 v[86:87], v146 offset:37376
ds_read_b64_tr_b16 v[88:89], v146 offset:40960
ds_read_b64_tr_b16 v[90:91], v146 offset:41472
ds_read_b64_tr_b16 v[92:93], v146 offset:45056
ds_read_b64_tr_b16 v[94:95], v146 offset:45568
ds_read_b64_tr_b16 v[96:97], v146 offset:49152
ds_read_b64_tr_b16 v[98:99], v146 offset:49664
ds_read_b64_tr_b16 v[100:101], v146 offset:53248
ds_read_b64_tr_b16 v[102:103], v146 offset:53760
ds_read_b64_tr_b16 v[104:105], v146 offset:57344
ds_read_b64_tr_b16 v[106:107], v146 offset:57856
ds_read_b64_tr_b16 v[108:109], v146 offset:61440
ds_read_b64_tr_b16 v[110:111], v146 offset:61952
ds_read_b64_tr_b16 v[112:113], v148
ds_read_b64_tr_b16 v[114:115], v148 offset:512
ds_read_b64_tr_b16 v[116:117], v148 offset:4096
ds_read_b64_tr_b16 v[118:119], v148 offset:4608
s_waitcnt lgkmcnt(15)
ds_write_b128 v147, v[72:75] offset:24576
ds_write_b128 v147, v[76:79] offset:28672
ds_write_b128 v147, v[80:83] offset:32768
ds_write_b128 v147, v[84:87] offset:36864
s_waitcnt lgkmcnt(15)
ds_write_b128 v147, v[88:91] offset:40960
ds_write_b128 v147, v[92:95] offset:45056
s_waitcnt lgkmcnt(15)
ds_write_b128 v147, v[96:99] offset:49152
s_waitcnt lgkmcnt(15)
ds_write_b128 v147, v[100:103] offset:53248
s_waitcnt lgkmcnt(14)
ds_write_b128 v147, v[104:107] offset:57344
s_waitcnt lgkmcnt(13)
ds_write_b128 v147, v[108:111] offset:61440
s_waitcnt lgkmcnt(12)
ds_write_b128 v149, v[112:115]
s_waitcnt lgkmcnt(11)
ds_write_b128 v149, v[116:119] offset:4096
s_waitcnt lgkmcnt(0)
s_setpc_b64 s[78:79]
Lmain:
s_cmp_ge_u32 s2, 256
s_cbranch_scc1 Lend
s_load_dwordx16 s[80:95], s[0:1], 0
s_load_dwordx2 s[96:97], s[0:1], 64
v_mov_b32 v199, v0
v_and_b32 v251, 63, v0
v_lshrrev_b32 v120, 6, v0
s_nop 0
v_readfirstlane_b32 s40, v120
s_and_b32 s43, s2, 7
s_lshr_b32 s44, s2, 3
s_and_b32 s41, s43, 3
s_lshl_b32 s41, s41, 2
s_and_b32 s45, s44, 3
s_add_u32 s41, s41, s45
s_lshr_b32 s42, s43, 2
s_lshl_b32 s42, s42, 3
s_lshr_b32 s45, s44, 2
s_add_u32 s42, s42, s45
s_lshl_b32 s41, s41, 5
s_lshl_b32 s42, s42, 5
s_lshl_b32 s67, s40, 6
s_cmp_eq_u32 s40, 6
s_cselect_b32 s67, 352, s67
v_add_u32_e64 v125, s67, v251
v_mul_u32_u24 v121, 5462, v125
v_lshrrev_b32 v121, 16, v121
v_mul_u32_u24 v122, 12, v121
v_sub_u32 v122, v125, v122
v_bfe_u32 v123, v121, 2, 2
v_xor_b32 v122, v122, v123
v_add_u32 v123, s41, v121
v_subrev_u32 v123, 1, v123
v_mul_u32_u24 v124, 192, v123
v_lshl_add_u32 v124, v122, 4, v124
v_mov_b32 v240, 2147483648
s_movk_i32 s43, 512
v_cmp_gt_u32 vcc, s43, v123
s_nop 1
v_cndmask_b32 v124, v240, v124, vcc
v_cmp_gt_u32 vcc, 34, v121
s_nop 1
v_cndmask_b32 v240, v240, v124, vcc
v_mov_b32 v128, v199
v_add_u32 v129, 512, v199
v_min_u32 v129, 863, v129
v_lshlrev_b32_e64 v130, 1, v128
v_lshlrev_b32 v131, 1, v129
s_mov_b32 s66, s42
s_lshl_b32 s67, s67, 4
s_add_u32 s67, s67, 90112
s_waitcnt lgkmcnt(0)
s_mov_b32 s4, s80
s_and_b32 s5, s81, 65535
s_mov_b32 s6, 50331648
s_mov_b32 s7, 131072
s_mov_b32 s20, s82
s_and_b32 s21, s83, 65535
s_mov_b32 s22, 1728
s_mov_b32 s23, 131072
buffer_load_ushort v126, v130, s[20:23], 0 offen
buffer_load_ushort v127, v131, s[20:23], 0 offen
s_cmp_eq_u32 s40, 7
s_cbranch_scc1 Lskipx0
s_add_i32 s43, s66, -1
s_mul_i32 s44, s43, 98304
s_cmp_lt_u32 s43, 512
s_cselect_b32 s45, s44, 1073741824
s_add_u32 m0, s67, 0
s_nop 0
buffer_load_dwordx4 v240, s[4:7], s45 offen nt lds
s_add_i32 s43, s66, 0
s_mul_i32 s44, s43, 98304
s_cmp_lt_u32 s43, 512
s_cselect_b32 s45, s44, 1073741824
s_add_u32 m0, s67, 6656
s_nop 0
buffer_load_dwordx4 v240, s[4:7], s45 offen nt lds
s_add_i32 s43, s66, 1
s_mul_i32 s44, s43, 98304
s_cmp_lt_u32 s43, 512
s_cselect_b32 s45, s44, 1073741824
s_add_u32 m0, s67, 13312
s_nop 0
buffer_load_dwordx4 v240, s[4:7], s45 offen nt lds
s_add_i32 s43, s66, 2
s_mul_i32 s44, s43, 98304
s_cmp_lt_u32 s43, 512
s_cselect_b32 s45, s44, 1073741824
s_add_u32 m0, s67, 19968
s_nop 0
buffer_load_dwordx4 v240, s[4:7], s45 offen nt lds
s_add_i32 s43, s66, 3
s_mul_i32 s44, s43, 98304
s_cmp_lt_u32 s43, 512
s_cselect_b32 s45, s44, 1073741824
s_add_u32 m0, s67, 26624
s_nop 0
buffer_load_dwordx4 v240, s[4:7], s45 offen nt lds
s_add_i32 s43, s66, 4
s_mul_i32 s44, s43, 98304
s_cmp_lt_u32 s43, 512
s_cselect_b32 s45, s44, 1073741824
s_add_u32 m0, s67, 33280
s_nop 0
buffer_load_dwordx4 v240, s[4:7], s45 offen nt lds
Lskipx0:
s_mov_b32 s12, s84
s_and_b32 s13, s85, 65535
s_mov_b32 s14, 73728
s_mov_b32 s15, 131072
v_lshrrev_b32_e64 v145, 2, v251
v_mul_u32_u24 v145, 768, v145
v_and_b32_e64 v125, 3, v251
v_lshl_add_u32 v145, v125, 4, v145
s_mov_b32 s16, s86
s_and_b32 s17, s87, 65535
s_mov_b32 s18, 73728
s_mov_b32 s19, 131072
s_mov_b32 s24, s88
s_and_b32 s25, s89, 65535
s_mov_b32 s26, 768
s_mov_b32 s27, 131072
s_mov_b32 s28, s90
s_and_b32 s29, s91, 65535
s_mov_b32 s30, 768
s_mov_b32 s31, 131072
s_mov_b32 s8, s92
s_and_b32 s9, s93, 65535
s_mov_b32 s10, 50331648
s_mov_b32 s11, 131072
s_mov_b32 s36, s94
s_and_b32 s37, s95, 65535
s_mov_b32 s38, 256
s_mov_b32 s39, 131072
s_mov_b32 s32, s96
s_and_b32 s33, s97, 65535
s_mov_b32 s34, 83886080
s_mov_b32 s35, 131072
v_lshlrev_b32_e64 v24, 6, v199
s_mov_b32 s43, 1065362610
v_mov_b32 v25, 1084047360
v_add_u32 v0, 32772, v24
v_add_u32 v1, 32780, v24
v_add_u32 v2, 32788, v24
v_add_u32 v3, 32796, v24
v_add_u32 v4, 32804, v24
v_add_u32 v5, 32812, v24
v_add_u32 v6, 32820, v24
v_add_u32 v7, 32828, v24
v_cvt_f32_f16 v0, v0
v_cvt_f32_f16 v1, v1
v_cvt_f32_f16 v2, v2
v_cvt_f32_f16 v3, v3
v_cvt_f32_f16 v4, v4
v_cvt_f32_f16 v5, v5
v_cvt_f32_f16 v6, v6
v_cvt_f32_f16 v7, v7
v_mul_f32 v8, v0, v0
v_mul_f32 v9, v1, v1
v_mul_f32 v10, v2, v2
v_mul_f32 v11, v3, v3
v_mul_f32 v12, v4, v4
v_mul_f32 v13, v5, v5
v_mul_f32 v14, v6, v6
v_mul_f32 v15, v7, v7
v_fma_f32 v8, v8, s43, v25
v_fma_f32 v9, v9, s43, v25
v_fma_f32 v10, v10, s43, v25
v_fma_f32 v11, v11, s43, v25
v_fma_f32 v12, v12, s43, v25
v_fma_f32 v13, v13, s43, v25
v_fma_f32 v14, v14, s43, v25
v_fma_f32 v15, v15, s43, v25
v_mul_f32 v8, v0, v8
v_mul_f32 v9, v1, v9
v_mul_f32 v10, v2, v10
v_mul_f32 v11, v3, v11
v_mul_f32 v12, v4, v12
v_mul_f32 v13, v5, v13
v_mul_f32 v14, v6, v14
v_mul_f32 v15, v7, v15
v_exp_f32 v8, v8
v_exp_f32 v9, v9
v_exp_f32 v10, v10
v_exp_f32 v11, v11
v_exp_f32 v12, v12
v_exp_f32 v13, v13
v_exp_f32 v14, v14
v_exp_f32 v15, v15
v_add_f32 v16, 1.0, v8
v_add_f32 v17, 1.0, v9
v_add_f32 v18, 1.0, v10
v_add_f32 v19, 1.0, v11
v_add_f32 v20, 1.0, v12
v_add_f32 v21, 1.0, v13
v_add_f32 v22, 1.0, v14
v_add_f32 v23, 1.0, v15
v_rcp_f32 v16, v16
v_rcp_f32 v17, v17
v_rcp_f32 v18, v18
v_rcp_f32 v19, v19
v_rcp_f32 v20, v20
v_rcp_f32 v21, v21
v_rcp_f32 v22, v22
v_rcp_f32 v23, v23
v_mul_f32 v0, v0, v16
v_mul_f32 v1, v1, v17
v_mul_f32 v2, v2, v18
v_mul_f32 v3, v3, v19
v_mul_f32 v4, v4, v20
v_mul_f32 v5, v5, v21
v_mul_f32 v6, v6, v22
v_mul_f32 v7, v7, v23
v_mul_f32 v8, v8, v0
v_mul_f32 v9, v9, v1
v_mul_f32 v10, v10, v2
v_mul_f32 v11, v11, v3
v_mul_f32 v12, v12, v4
v_mul_f32 v13, v13, v5
v_mul_f32 v14, v14, v6
v_mul_f32 v15, v15, v7
v_cvt_pk_f16_f32 v28, v0, v1
v_cvt_pk_f16_f32 v32, -v8, -v9
v_cvt_pk_f16_f32 v29, v2, v3
v_cvt_pk_f16_f32 v33, -v10, -v11
v_cvt_pk_f16_f32 v30, v4, v5
v_cvt_pk_f16_f32 v34, -v12, -v13
v_cvt_pk_f16_f32 v31, v6, v7
v_cvt_pk_f16_f32 v35, -v14, -v15
v_lshlrev_b32_e64 v24, 4, v199
v_mov_b32 v25, 163840
s_movk_i32 s43, 496
v_cmp_gt_u32 vcc, s43, v199
s_nop 1
v_cndmask_b32 v24, v25, v24, vcc
ds_write_b128 v24, v[32:35]
ds_write_b128 v24, v[28:31] offset:8192
s_and_b32 s43, s40, 1
s_lshl_b32 s46, s43, 4
s_add_u32 s41, s41, s46
s_and_b32 s43, s40, 6
s_add_u32 s42, s42, s43
s_mul_i32 s45, s43, 6656
s_add_u32 s45, s45, 90112
v_and_b32 v131, 15, v251
v_lshrrev_b32_e64 v132, 4, v251
v_mul_u32_u24 v122, 6656, v132
v_add_u32 v122, s45, v122
v_add_u32 v121, s46, v131
v_mul_u32_u24 v123, 192, v121
v_bfe_u32 v124, v121, 2, 2
v_lshl_add_u32 v123, v124, 4, v123
v_add_u32 v242, v122, v123
v_add_u32 v121, 1, v121
v_mul_u32_u24 v123, 192, v121
v_bfe_u32 v124, v121, 2, 2
v_lshl_add_u32 v123, v124, 4, v123
v_add_u32 v243, v122, v123
v_add_u32 v121, 1, v121
v_mul_u32_u24 v123, 192, v121
v_bfe_u32 v124, v121, 2, 2
v_lshl_add_u32 v123, v124, 4, v123
v_add_u32_e64 v244, v122, v123
s_mul_i32 s72, s40, 9216
s_add_u32 s72, s72, 90112
v_mov_b32 v160, 0
v_mov_b32 v161, 0
v_mov_b32 v162, 0
v_mov_b32 v163, 0
v_mov_b32 v140, 16256
ds_write_b128 v140, v[160:163]
v_bfe_u32 v133, v131, 2, 1
v_sub_u32 v133, v132, v133
v_lshrrev_b32 v134, 3, v131
v_and_b32_e64 v135, 3, v131
v_lshl_add_u32 v135, v134, 2, v135
v_lshlrev_b32_e64 v136, 6, v133
v_lshl_add_u32 v136, v135, 3, v136
v_add_u32 v136, 156672, v136
v_mov_b32 v137, 163840
v_cmp_gt_u32 vcc, 3, v133
s_nop 1
v_cndmask_b32 v136, v137, v136, vcc
v_cmp_eq_u32 vcc, 0, v134
s_nop 1
v_cndmask_b32 v245, v137, v136, vcc
v_cndmask_b32 v246, v136, v137, vcc
v_lshlrev_b32 v241, 4, v251
v_and_b32_e64 v133, 35, v251
v_bfe_u32 v134, v251, 2, 2
v_lshl_add_u32 v133, v134, 3, v133
v_bfe_u32 v134, v251, 4, 1
v_lshl_add_u32 v133, v134, 2, v133
v_lshlrev_b32_e64 v248, 4, v133
v_add_u32 v249, 65536, v248
v_add_u32 v250, 131072, v248
s_lshl_b32 s73, s2, 3
s_add_u32 s73, s73, s40
s_lshl_b32 s80, s73, 10
s_add_u32 s80, s80, 4194304
s_mul_i32 s73, s73, 16
s_add_u32 s73, s73, 1048576
s_mul_i32 s46, s41, 192
s_add_u32 s43, s42, 0
s_mul_i32 s43, s43, 98304
s_add_u32 s68, s43, s46
s_add_u32 s43, s42, 8
s_mul_i32 s43, s43, 98304
s_add_u32 s69, s43, s46
s_add_u32 s43, s42, 16
s_mul_i32 s43, s43, 98304
s_add_u32 s70, s43, s46
s_add_u32 s43, s42, 24
s_mul_i32 s43, s43, 98304
s_add_u32 s71, s43, s46
s_mul_i32 s82, s40, 9216
s_mov_b32 s48, 1156203754
s_mov_b32 s49, 4294508536
s_mov_b32 s76, 400000
v_lshrrev_b32 v148, 5, v251
v_lshlrev_b32 v146, 8, v148
v_bfe_u32 v148, v251, 2, 2
v_lshl_add_u32 v146, v148, 6, v146
v_bfe_u32 v148, v251, 4, 1
v_lshl_add_u32 v146, v148, 5, v146
v_bfe_u32 v148, v251, 0, 1
v_lshl_add_u32 v146, v148, 4, v146
v_bfe_u32 v148, v251, 1, 1
v_lshl_add_u32 v146, v148, 3, v146
s_and_b32 s43, s40, 3
s_lshl_b32 s43, s43, 10
s_add_u32 s43, s43, 16384
v_add_u32 v146, s43, v146
v_add_u32 v147, s43, v248
v_mul_u32_u24 v140, 683, v128
v_lshrrev_b32_e64 v140, 16, v140
v_mul_u32_u24 v141, 96, v140
v_sub_u32 v141, v128, v141
v_mul_u32_u24 v142, 11, v140
v_lshrrev_b32 v142, 5, v142
v_mul_u32_u24 v143, 3, v142
v_sub_u32 v143, v140, v143
v_mul_u32_u24 v143, 12, v143
v_lshrrev_b32 v144, 3, v141
v_add_u32 v143, v143, v144
v_mul_u32_u24 v143, 192, v143
v_lshl_add_u32 v143, v142, 6, v143
v_and_b32_e64 v144, 7, v141
v_lshl_add_u32 v143, v144, 3, v143
v_add_u32 v150, 156672, v143
v_mul_u32_u24 v140, 683, v129
v_lshrrev_b32_e64 v140, 16, v140
v_mul_u32_u24 v141, 96, v140
v_sub_u32 v141, v129, v141
v_mul_u32_u24 v142, 11, v140
v_lshrrev_b32 v142, 5, v142
v_mul_u32_u24 v143, 3, v142
v_sub_u32 v143, v140, v143
v_mul_u32_u24 v143, 12, v143
v_lshrrev_b32 v144, 3, v141
v_add_u32 v143, v143, v144
v_mul_u32_u24 v143, 192, v143
v_lshl_add_u32 v143, v142, 6, v143
v_and_b32_e64 v144, 7, v141
v_lshl_add_u32 v143, v144, 3, v143
v_add_u32 v151, 156672, v143
s_waitcnt vmcnt(6)
s_cmp_lg_u32 s40, 7
s_cbranch_scc1 Lw7w
s_waitcnt vmcnt(0)
Lw7w:
v_and_b32 v130, 1, v128
v_lshlrev_b32 v130, 4, v130
v_lshlrev_b32 v126, v130, v126
v_and_b32 v130, 2, v128
v_cmp_eq_u32 vcc, 0, v130
s_nop 1
v_cndmask_b32 v160, 0, v126, vcc
v_sub_u32 v161, v126, v160
ds_write_b64 v150, v[160:161]
v_and_b32 v130, 1, v129
v_lshlrev_b32 v130, 4, v130
v_lshlrev_b32 v127, v130, v127
v_and_b32 v130, 2, v129
v_cmp_eq_u32 vcc, 0, v130
s_nop 1
v_cndmask_b32 v162, 0, v127, vcc
v_sub_u32 v163, v127, v162
ds_write_b64 v151, v[162:163]
s_cmp_lt_u32 s40, 4
s_cbranch_scc1 Lnow1a
s_and_b32 s43, s40, 3
s_add_u32 s43, s43, 0
s_mul_i32 s44, s43, 43
s_lshr_b32 s44, s44, 8
s_lshl_b32 s45, s43, 10
s_add_u32 m0, s45, 16384
s_mul_i32 s46, s44, 6
s_sub_u32 s43, s43, s46
s_lshl_b32 s43, s43, 1
s_sub_u32 s45, s43, 5
s_cmp_ge_u32 s43, 6
s_cselect_b32 s43, s45, s43
s_mul_i32 s43, s43, 12288
s_lshl_b32 s44, s44, 6
s_add_u32 s43, s43, s44
buffer_load_dwordx4 v145, s[12:15], s43 offen lds
s_and_b32 s43, s40, 3
s_add_u32 s43, s43, 4
s_mul_i32 s44, s43, 43
s_lshr_b32 s44, s44, 8
s_lshl_b32 s45, s43, 10
s_add_u32 m0, s45, 16384
s_mul_i32 s46, s44, 6
s_sub_u32 s43, s43, s46
s_lshl_b32 s43, s43, 1
s_sub_u32 s45, s43, 5
s_cmp_ge_u32 s43, 6
s_cselect_b32 s43, s45, s43
s_mul_i32 s43, s43, 12288
s_lshl_b32 s44, s44, 6
s_add_u32 s43, s43, s44
buffer_load_dwordx4 v145, s[12:15], s43 offen lds
s_and_b32 s43, s40, 3
s_add_u32 s43, s43, 8
s_mul_i32 s44, s43, 43
s_lshr_b32 s44, s44, 8
s_lshl_b32 s45, s43, 10
s_add_u32 m0, s45, 16384
s_mul_i32 s46, s44, 6
s_sub_u32 s43, s43, s46
s_lshl_b32 s43, s43, 1
s_sub_u32 s45, s43, 5
s_cmp_ge_u32 s43, 6
s_cselect_b32 s43, s45, s43
s_mul_i32 s43, s43, 12288
s_lshl_b32 s44, s44, 6
s_add_u32 s43, s43, s44
buffer_load_dwordx4 v145, s[12:15], s43 offen lds
s_and_b32 s43, s40, 3
s_add_u32 s43, s43, 12
s_mul_i32 s44, s43, 43
s_lshr_b32 s44, s44, 8
s_lshl_b32 s45, s43, 10
s_add_u32 m0, s45, 16384
s_mul_i32 s46, s44, 6
s_sub_u32 s43, s43, s46
s_lshl_b32 s43, s43, 1
s_sub_u32 s45, s43, 5
s_cmp_ge_u32 s43, 6
s_cselect_b32 s43, s45, s43
s_mul_i32 s43, s43, 12288
s_lshl_b32 s44, s44, 6
s_add_u32 s43, s43, s44
buffer_load_dwordx4 v145, s[12:15], s43 offen lds
s_and_b32 s43, s40, 3
s_add_u32 s43, s43, 16
s_mul_i32 s44, s43, 43
s_lshr_b32 s44, s44, 8
s_lshl_b32 s45, s43, 10
s_add_u32 m0, s45, 16384
s_mul_i32 s46, s44, 6
s_sub_u32 s43, s43, s46
s_lshl_b32 s43, s43, 1
s_sub_u32 s45, s43, 5
s_cmp_ge_u32 s43, 6
s_cselect_b32 s43, s45, s43
s_mul_i32 s43, s43, 12288
s_lshl_b32 s44, s44, 6
s_add_u32 s43, s43, s44
buffer_load_dwordx4 v145, s[12:15], s43 offen lds
s_and_b32 s43, s40, 3
s_add_u32 s43, s43, 20
s_mul_i32 s44, s43, 43
s_lshr_b32 s44, s44, 8
s_lshl_b32 s45, s43, 10
s_add_u32 m0, s45, 16384
s_mul_i32 s46, s44, 6
s_sub_u32 s43, s43, s46
s_lshl_b32 s43, s43, 1
s_sub_u32 s45, s43, 5
s_cmp_ge_u32 s43, 6
s_cselect_b32 s43, s45, s43
s_mul_i32 s43, s43, 12288
s_lshl_b32 s44, s44, 6
s_add_u32 s43, s43, s44
buffer_load_dwordx4 v145, s[12:15], s43 offen lds
Lnow1a:
s_cmp_eq_u32 s40, 7
s_cbranch_scc1 Lskipx1
s_add_i32 s43, s66, 5
s_mul_i32 s44, s43, 98304
s_cmp_lt_u32 s43, 512
s_cselect_b32 s45, s44, 1073741824
s_add_u32 m0, s67, 39936
s_nop 0
buffer_load_dwordx4 v240, s[4:7], s45 offen nt lds
s_add_i32 s43, s66, 6
s_mul_i32 s44, s43, 98304
s_cmp_lt_u32 s43, 512
s_cselect_b32 s45, s44, 1073741824
s_add_u32 m0, s67, 46592
s_nop 0
buffer_load_dwordx4 v240, s[4:7], s45 offen nt lds
s_add_i32 s43, s66, 7
s_mul_i32 s44, s43, 98304
s_cmp_lt_u32 s43, 512
s_cselect_b32 s45, s44, 1073741824
s_add_u32 m0, s67, 53248
s_nop 0
buffer_load_dwordx4 v240, s[4:7], s45 offen nt lds
s_add_i32 s43, s66, 8
s_mul_i32 s44, s43, 98304
s_cmp_lt_u32 s43, 512
s_cselect_b32 s45, s44, 1073741824
s_add_u32 m0, s67, 59904
s_nop 0
buffer_load_dwordx4 v240, s[4:7], s45 offen nt lds
Lskipx1:
s_waitcnt vmcnt(10) lgkmcnt(0)
s_cmp_ge_u32 s40, 4
s_cbranch_scc1 Lwa
s_waitcnt vmcnt(4)
Lwa:
s_barrier
s_setprio 2
s_cmp_lt_u32 s40, 4
s_cbranch_scc0 Lsu0
s_call_b64 s[78:79], Lconv0
s_call_b64 s[78:79], Lln0
s_waitcnt vmcnt(0)
Lsu0:
s_cmp_ge_u32 s40, 4
s_cbranch_scc0 Lsu1
s_call_b64 s[78:79], Lw1a
s_call_b64 s[78:79], Lw1i
Lsu1:
s_barrier
s_cmp_ge_u32 s40, 4
s_cbranch_scc0 Lsu2
s_setprio 3
s_call_b64 s[78:79], Lconv0
s_barrier
s_call_b64 s[78:79], Lw1b
s_barrier
s_call_b64 s[78:79], Lln0
Lsu2:
s_cmp_lg_u32 s40, 7
s_cbranch_scc1 Lnosent
v_mov_b32 v164, -1
v_mov_b32 v165, -1
v_mov_b32 v166, -1
v_mov_b32 v167, -1
v_lshlrev_b32_e64 v174, 12, v251
v_add_u32 v175, 262144, v174
v_cmp_gt_u32 vcc, 32, v251
v_mov_b32 v176, 2147483648
s_nop 0
v_cndmask_b32 v175, v176, v175, vcc
s_lshl_b32 s43, s2, 4
buffer_store_dwordx4 v[164:167], v174, s[32:35], s43 offen sc1
buffer_store_dwordx4 v[164:167], v175, s[32:35], s43 offen sc1
s_add_u32 s43, s43, 393216
s_cmp_lt_u32 s2, 96
s_cselect_b32 s43, s43, 1073741824
v_lshlrev_b32 v191, 11, v251
s_mov_b64 exec, 0xff
buffer_store_dwordx4 v[164:167], v191, s[32:35], s43 offen sc1
s_mov_b64 exec, -1
s_getpc_b64 s[74:75]
Lpc:
s_lshr_b32 s43, s2, 3
s_and_b32 s43, s43, 15
s_lshl_b32 s43, s43, 13
v_lshlrev_b32 v176, 7, v251
v_add_u32_e64 v176, s43, v176
v_min_u32 v176, Lend-Lpc, v176
global_load_dword v255, v176, s[74:75]
s_sub_u32 s43, s2, 96
s_cmp_lt_u32 s43, 96
s_cbranch_scc0 Lnobias
s_lshl_b32 s44, s43, 1
v_mul_u32_u24 v174, 192, v251
v_lshlrev_b32 v175, 1, v251
s_add_u32 s45, s44, 0
buffer_load_ushort v176, v174, s[16:19], s45 offen
buffer_load_ushort v182, v175, s[28:31], 0 offen offset:0
s_add_u32 s45, s44, 12288
buffer_load_ushort v177, v174, s[16:19], s45 offen
buffer_load_ushort v183, v175, s[28:31], 0 offen offset:128
s_add_u32 s45, s44, 24576
buffer_load_ushort v178, v174, s[16:19], s45 offen
buffer_load_ushort v184, v175, s[28:31], 0 offen offset:256
s_add_u32 s45, s44, 36864
buffer_load_ushort v179, v174, s[16:19], s45 offen
buffer_load_ushort v185, v175, s[28:31], 0 offen offset:384
s_add_u32 s45, s44, 49152
buffer_load_ushort v180, v174, s[16:19], s45 offen
buffer_load_ushort v186, v175, s[28:31], 0 offen offset:512
s_add_u32 s45, s44, 61440
buffer_load_ushort v181, v174, s[16:19], s45 offen
buffer_load_ushort v187, v175, s[28:31], 0 offen offset:640
Lnobias:
s_nop 1
Lnosent:
s_add_u32 s66, s66, 8
s_mul_i32 s66, s66, 98304
s_cmp_eq_u32 s40, 7
s_cselect_b32 s67, 163840, s67
ds_read_b128 v[224:227], v248 offset:16384
ds_read_b128 v[228:231], v248 offset:19456
ds_read_b128 v[232:235], v248 offset:17408
ds_read_b128 v[236:239], v248 offset:20480
ds_read_b128 v[216:219], v248 offset:18432
ds_read_b128 v[220:223], v248 offset:21504
s_setprio 2
s_waitcnt lgkmcnt(5)
v_mfma_f32_32x32x16_bf16 v[120:135], v[48:51], v[224:227], 0
s_waitcnt lgkmcnt(4)
ds_read_b128 v[224:227], v248 offset:22528
v_mfma_f32_32x32x16_bf16 v[120:135], v[52:55], v[228:231], v[120:135]
s_waitcnt lgkmcnt(4)
ds_read_b128 v[228:231], v248 offset:25600
v_mfma_f32_32x32x16_bf16 v[120:135], v[56:59], v[232:235], v[120:135]
s_waitcnt lgkmcnt(4)
ds_read_b128 v[232:235], v248 offset:23552
v_mfma_f32_32x32x16_bf16 v[120:135], v[60:63], v[236:239], v[120:135]
s_waitcnt lgkmcnt(4)
ds_read_b128 v[236:239], v248 offset:26624
v_mfma_f32_32x32x16_bf16 v[120:135], v[64:67], v[216:219], v[120:135]
s_waitcnt lgkmcnt(4)
ds_read_b128 v[216:219], v248 offset:24576
v_mfma_f32_32x32x16_bf16 v[120:135], v[68:71], v[220:223], v[120:135]
s_nop 11
v_cvt_pkrtz_f16_f32 v137, v120, v121
v_cvt_pkrtz_f16_f32 v139, v122, v123
v_cvt_pkrtz_f16_f32 v141, v124, v125
v_cvt_pkrtz_f16_f32 v143, v126, v127
v_cvt_pkrtz_f16_f32 v145, v128, v129
v_cvt_pk_f16_f32 v155, v130, v131
v_cvt_pk_f16_f32 v152, v132, v133
v_cvt_pk_f16_f32 v149, v134, v135
s_waitcnt lgkmcnt(1)
ds_read_b128 v[220:223], v248 offset:27648
v_mfma_f32_32x32x16_bf16 v[120:135], v[48:51], v[224:227], 0
v_pk_fma_f16 v154, v155, v155, s48
v_and_b32_e64 v137, s49, v137
v_pk_fma_f16 v151, v152, v152, s48
v_and_b32_e64 v139, s49, v139
v_pk_fma_f16 v148, v149, v149, s48
v_pk_mul_f16 v154, v155, v154
v_bfe_u32 v136, v137, 2, 14
v_pk_mul_f16 v151, v152, v151
v_pk_mul_f16 v148, v149, v148
v_bfe_u32 v138, v139, 2, 14
ds_read_b128 v[224:227], v248 offset:28672
ds_read_u16_d16 v136, v136
ds_read_u16_d16 v138, v138
v_mfma_f32_32x32x16_bf16 v[120:135], v[52:55], v[228:231], v[120:135]
v_exp_f16 v153, v154
v_lshrrev_b32 v137, 18, v137
v_exp_f16 v150, v151
v_lshrrev_b32 v139, 18, v139
v_exp_f16 v147, v148
v_and_b32 v141, s49, v141
v_and_b32_e64 v143, s49, v143
ds_read_b128 v[228:231], v248 offset:31744
ds_read_u16_d16_hi v137, v137
ds_read_u16_d16_hi v139, v139
v_mfma_f32_32x32x16_bf16 v[120:135], v[56:59], v[232:235], v[120:135]
v_exp_f16_sdwa v153, v154 dst_sel:WORD_1 dst_unused:UNUSED_PRESERVE src0_sel:WORD_1
v_bfe_u32 v140, v141, 2, 14
v_exp_f16_sdwa v150, v151 dst_sel:WORD_1 dst_unused:UNUSED_PRESERVE src0_sel:WORD_1
v_bfe_u32 v142, v143, 2, 14
v_exp_f16_sdwa v147, v148 dst_sel:WORD_1 dst_unused:UNUSED_PRESERVE src0_sel:WORD_1
v_lshrrev_b32_e64 v141, 18, v141
v_pk_add_f16 v153, v153, 1.0 op_sel_hi:[1,0]
ds_read_b128 v[232:235], v248 offset:29696
ds_read_u16_d16 v140, v140
ds_read_u16_d16 v142, v142
ds_read_u16_d16_hi v141, v141
v_mfma_f32_32x32x16_bf16 v[120:135], v[60:63], v[236:239], v[120:135]
v_lshrrev_b32_e64 v143, 18, v143
v_pk_add_f16 v150, v150, 1.0 op_sel_hi:[1,0]
v_pk_add_f16 v147, v147, 1.0 op_sel_hi:[1,0]
v_and_b32 v145, s49, v145
v_rcp_f16 v154, v153
v_bfe_u32 v144, v145, 2, 14
v_rcp_f16_e64 v151, v150
v_lshrrev_b32 v145, 18, v145
s_waitcnt lgkmcnt(7)
ds_read_b128 v[236:239], v248 offset:32768
ds_read_u16_d16_hi v143, v143
ds_read_u16_d16 v144, v144
ds_read_u16_d16_hi v145, v145
v_mfma_f32_32x32x16_bf16 v[120:135], v[64:67], v[216:219], v[120:135]
v_rcp_f16 v148, v147
v_rcp_f16_sdwa v154, v153 dst_sel:WORD_1 dst_unused:UNUSED_PRESERVE src0_sel:WORD_1
v_fma_mix_f32 v156, v136, v136, 0 op_sel:[0,0,0] op_sel_hi:[1,1,0]
s_waitcnt lgkmcnt(8)
v_fma_mix_f32 v156, v137, v137, v156 op_sel:[1,1,0] op_sel_hi:[1,1,0]
v_rcp_f16_sdwa v151, v150 dst_sel:WORD_1 dst_unused:UNUSED_PRESERVE src0_sel:WORD_1
v_fma_mix_f32 v156, v138, v138, v156 op_sel:[0,0,0] op_sel_hi:[1,1,0]
ds_read_b128 v[216:219], v248 offset:30720
v_mfma_f32_32x32x16_bf16 v[120:135], v[68:71], v[220:223], v[120:135]
v_rcp_f16_sdwa v148, v147 dst_sel:WORD_1 dst_unused:UNUSED_PRESERVE src0_sel:WORD_1
v_fma_mix_f32 v156, v139, v139, v156 op_sel:[1,1,0] op_sel_hi:[1,1,0]
v_pk_mul_f16 v155, v155, v154
s_waitcnt lgkmcnt(5)
v_fma_mix_f32 v156, v140, v140, v156 op_sel:[0,0,0] op_sel_hi:[1,1,0]
v_pk_mul_f16 v152, v152, v151
v_fma_mix_f32 v156, v141, v141, v156 op_sel:[1,1,0] op_sel_hi:[1,1,0]
v_pk_mul_f16 v149, v149, v148
v_fma_mix_f32 v156, v155, v155, v156 op_sel:[0,0,0] op_sel_hi:[1,1,0]
v_fma_mix_f32 v156, v142, v142, v156 op_sel:[0,0,0] op_sel_hi:[1,1,0]
v_fma_mix_f32 v156, v155, v155, v156 op_sel:[1,1,0] op_sel_hi:[1,1,0]
s_waitcnt lgkmcnt(3)
v_fma_mix_f32 v156, v143, v143, v156 op_sel:[1,1,0] op_sel_hi:[1,1,0]
v_fma_mix_f32 v156, v152, v152, v156 op_sel:[0,0,0] op_sel_hi:[1,1,0]
v_fma_mix_f32 v156, v152, v152, v156 op_sel:[1,1,0] op_sel_hi:[1,1,0]
s_waitcnt lgkmcnt(1)
v_fma_mix_f32 v156, v144, v144, v156 op_sel:[0,0,0] op_sel_hi:[1,1,0]
v_fma_mix_f32 v156, v149, v149, v156 op_sel:[0,0,0] op_sel_hi:[1,1,0]
v_fma_mix_f32 v156, v145, v145, v156 op_sel:[1,1,0] op_sel_hi:[1,1,0]
v_fma_mix_f32 v156, v149, v149, v156 op_sel:[1,1,0] op_sel_hi:[1,1,0]
s_cmp_lt_u32 s40, 4
s_cbranch_scc0 Lsu3
s_barrier
Lsu3:
v_add_u32 v247, -36864, v242
v_subrev_u32 v252, 66560, v247
v_min_u32_e64 v247, v247, v252
v_add_u32 v247, 90112, v247
v_sub_u32 v252, v247, v242
v_add_u32 v242, v252, v242
v_add_u32 v243, v252, v243
v_add_u32 v244, v252, v244
v_cvt_pkrtz_f16_f32 v137, v120, v121
v_cvt_pkrtz_f16_f32 v139, v122, v123
v_cvt_pkrtz_f16_f32 v141, v124, v125
v_cvt_pkrtz_f16_f32 v143, v126, v127
v_cvt_pkrtz_f16_f32 v145, v128, v129
v_cvt_pk_f16_f32 v155, v130, v131
v_cvt_pk_f16_f32 v152, v132, v133
v_cvt_pk_f16_f32 v149, v134, v135
s_add_u32 m0, s67, 0
s_add_u32 s66, s66, 98304
buffer_load_dwordx4 v240, s[4:7], s66 offen lds
ds_read_b128 v[220:223], v248 offset:33792
v_mfma_f32_32x32x16_bf16 v[120:135], v[48:51], v[224:227], 0
v_pk_fma_f16 v154, v155, v155, s48
v_and_b32 v137, s49, v137
v_pk_fma_f16 v151, v152, v152, s48
v_and_b32_e64 v139, s49, v139
v_pk_fma_f16 v148, v149, v149, s48
v_pk_mul_f16 v154, v155, v154
v_bfe_u32 v136, v137, 2, 14
v_pk_mul_f16 v151, v152, v151
v_pk_mul_f16 v148, v149, v148
v_bfe_u32 v138, v139, 2, 14
ds_read_b128 v[224:227], v248 offset:34816
ds_read_u16_d16 v136, v136
ds_read_u16_d16 v138, v138
v_mfma_f32_32x32x16_bf16 v[120:135], v[52:55], v[228:231], v[120:135]
v_exp_f16 v153, v154
v_lshrrev_b32 v137, 18, v137
v_exp_f16 v150, v151
v_lshrrev_b32 v139, 18, v139
v_exp_f16 v147, v148
v_and_b32 v141, s49, v141
v_and_b32_e64 v143, s49, v143
s_add_u32 m0, s67, 6656
s_add_u32 s66, s66, 98304
buffer_load_dwordx4 v240, s[4:7], s66 offen lds
ds_read_b128 v[228:231], v248 offset:37888
ds_read_u16_d16_hi v137, v137
ds_read_u16_d16_hi v139, v139
v_mfma_f32_32x32x16_bf16 v[120:135], v[56:59], v[232:235], v[120:135]
v_exp_f16_sdwa v153, v154 dst_sel:WORD_1 dst_unused:UNUSED_PRESERVE src0_sel:WORD_1
v_bfe_u32 v140, v141, 2, 14
v_exp_f16_sdwa v150, v151 dst_sel:WORD_1 dst_unused:UNUSED_PRESERVE src0_sel:WORD_1
v_bfe_u32 v142, v143, 2, 14
v_exp_f16_sdwa v147, v148 dst_sel:WORD_1 dst_unused:UNUSED_PRESERVE src0_sel:WORD_1
v_lshrrev_b32_e64 v141, 18, v141
v_pk_add_f16 v153, v153, 1.0 op_sel_hi:[1,0]
s_add_u32 m0, s67, 13312
s_add_u32 s66, s66, 98304
buffer_load_dwordx4 v240, s[4:7], s66 offen lds
ds_read_b128 v[232:235], v248 offset:35840
ds_read_u16_d16 v140, v140
ds_read_u16_d16 v142, v142
ds_read_u16_d16_hi v141, v141
v_mfma_f32_32x32x16_bf16 v[120:135], v[60:63], v[236:239], v[120:135]
v_lshrrev_b32_e64 v143, 18, v143
v_pk_add_f16 v150, v150, 1.0 op_sel_hi:[1,0]
v_pk_add_f16 v147, v147, 1.0 op_sel_hi:[1,0]
v_and_b32 v145, s49, v145
v_rcp_f16 v154, v153
v_bfe_u32 v144, v145, 2, 14
v_rcp_f16_e64 v151, v150
v_lshrrev_b32 v145, 18, v145
s_waitcnt lgkmcnt(4)
ds_read_b128 v[236:239], v248 offset:38912
ds_read_u16_d16_hi v143, v143
ds_read_u16_d16 v144, v144
ds_read_u16_d16_hi v145, v145
v_mfma_f32_32x32x16_bf16 v[120:135], v[64:67], v[216:219], v[120:135]
v_rcp_f16_e64 v148, v147
v_rcp_f16_sdwa v154, v153 dst_sel:WORD_1 dst_unused:UNUSED_PRESERVE src0_sel:WORD_1
v_fma_mix_f32 v157, v136, v136, 0 op_sel:[0,0,0] op_sel_hi:[1,1,0]
v_fma_mix_f32 v157, v137, v137, v157 op_sel:[1,1,0] op_sel_hi:[1,1,0]
v_rcp_f16_sdwa v151, v150 dst_sel:WORD_1 dst_unused:UNUSED_PRESERVE src0_sel:WORD_1
v_fma_mix_f32 v157, v138, v138, v157 op_sel:[0,0,0] op_sel_hi:[1,1,0]
s_setprio 1
s_add_u32 m0, s67, 19968
s_add_u32 s66, s66, 98304
buffer_load_dwordx4 v240, s[4:7], s66 offen lds
ds_read_b128 v[216:219], v248 offset:36864
v_mfma_f32_32x32x16_bf16 v[120:135], v[68:71], v[220:223], v[120:135]
v_rcp_f16_sdwa v148, v147 dst_sel:WORD_1 dst_unused:UNUSED_PRESERVE src0_sel:WORD_1
v_fma_mix_f32 v157, v139, v139, v157 op_sel:[1,1,0] op_sel_hi:[1,1,0]
v_pk_mul_f16 v155, v155, v154
s_waitcnt lgkmcnt(5)
v_fma_mix_f32 v157, v140, v140, v157 op_sel:[0,0,0] op_sel_hi:[1,1,0]
v_pk_mul_f16 v152, v152, v151
v_fma_mix_f32 v157, v141, v141, v157 op_sel:[1,1,0] op_sel_hi:[1,1,0]
v_pk_mul_f16 v149, v149, v148
v_fma_mix_f32 v157, v155, v155, v157 op_sel:[0,0,0] op_sel_hi:[1,1,0]
v_fma_mix_f32 v157, v142, v142, v157 op_sel:[0,0,0] op_sel_hi:[1,1,0]
v_fma_mix_f32 v157, v155, v155, v157 op_sel:[1,1,0] op_sel_hi:[1,1,0]
s_waitcnt lgkmcnt(1)
v_fma_mix_f32 v157, v143, v143, v157 op_sel:[1,1,0] op_sel_hi:[1,1,0]
v_fma_mix_f32 v157, v152, v152, v157 op_sel:[0,0,0] op_sel_hi:[1,1,0]
v_fma_mix_f32 v157, v152, v152, v157 op_sel:[1,1,0] op_sel_hi:[1,1,0]
v_fma_mix_f32 v157, v144, v144, v157 op_sel:[0,0,0] op_sel_hi:[1,1,0]
v_fma_mix_f32 v157, v149, v149, v157 op_sel:[0,0,0] op_sel_hi:[1,1,0]
v_fma_mix_f32 v157, v145, v145, v157 op_sel:[1,1,0] op_sel_hi:[1,1,0]
v_fma_mix_f32 v157, v149, v149, v157 op_sel:[1,1,0] op_sel_hi:[1,1,0]
s_cmp_lt_u32 s40, 4
s_cbranch_scc0 Lsu4
s_barrier
Lsu4:
v_cvt_pkrtz_f16_f32 v137, v120, v121
v_cvt_pkrtz_f16_f32 v139, v122, v123
v_cvt_pkrtz_f16_f32 v141, v124, v125
v_cvt_pkrtz_f16_f32 v143, v126, v127
v_cvt_pkrtz_f16_f32 v145, v128, v129
v_cvt_pk_f16_f32 v155, v130, v131
v_cvt_pk_f16_f32 v152, v132, v133
v_cvt_pk_f16_f32 v149, v134, v135
s_add_u32 m0, s67, 26624
s_add_u32 s66, s66, 98304
buffer_load_dwordx4 v240, s[4:7], s66 offen lds
ds_read_b128 v[220:223], v248 offset:39936
v_mfma_f32_32x32x16_bf16 v[120:135], v[48:51], v[224:227], 0
v_pk_fma_f16 v154, v155, v155, s48
v_and_b32_e64 v137, s49, v137
v_pk_fma_f16 v151, v152, v152, s48
v_and_b32_e64 v139, s49, v139
v_pk_fma_f16 v148, v149, v149, s48
v_pk_mul_f16 v154, v155, v154
v_bfe_u32 v136, v137, 2, 14
v_pk_mul_f16 v151, v152, v151
v_pk_mul_f16 v148, v149, v148
v_bfe_u32 v138, v139, 2, 14
ds_read_b128 v[224:227], v248 offset:40960
ds_read_u16_d16 v136, v136
ds_read_u16_d16 v138, v138
v_mfma_f32_32x32x16_bf16 v[120:135], v[52:55], v[228:231], v[120:135]
v_exp_f16 v153, v154
v_lshrrev_b32 v137, 18, v137
v_exp_f16 v150, v151
v_lshrrev_b32 v139, 18, v139
v_exp_f16 v147, v148
v_and_b32 v141, s49, v141
v_and_b32_e64 v143, s49, v143
s_add_u32 m0, s67, 33280
s_add_u32 s66, s66, 98304
buffer_load_dwordx4 v240, s[4:7], s66 offen lds
ds_read_b128 v[228:231], v248 offset:44032
ds_read_u16_d16_hi v137, v137
ds_read_u16_d16_hi v139, v139
v_mfma_f32_32x32x16_bf16 v[120:135], v[56:59], v[232:235], v[120:135]
v_exp_f16_sdwa v153, v154 dst_sel:WORD_1 dst_unused:UNUSED_PRESERVE src0_sel:WORD_1
v_bfe_u32 v140, v141, 2, 14
v_exp_f16_sdwa v150, v151 dst_sel:WORD_1 dst_unused:UNUSED_PRESERVE src0_sel:WORD_1
v_bfe_u32 v142, v143, 2, 14
v_exp_f16_sdwa v147, v148 dst_sel:WORD_1 dst_unused:UNUSED_PRESERVE src0_sel:WORD_1
v_lshrrev_b32_e64 v141, 18, v141
v_pk_add_f16 v153, v153, 1.0 op_sel_hi:[1,0]
s_add_u32 m0, s67, 39936
s_add_u32 s66, s66, 98304
buffer_load_dwordx4 v240, s[4:7], s66 offen lds
ds_read_b128 v[232:235], v248 offset:41984
ds_read_u16_d16 v140, v140
ds_read_u16_d16 v142, v142
ds_read_u16_d16_hi v141, v141
v_mfma_f32_32x32x16_bf16 v[120:135], v[60:63], v[236:239], v[120:135]
v_lshrrev_b32_e64 v143, 18, v143
v_pk_add_f16 v150, v150, 1.0 op_sel_hi:[1,0]
v_pk_add_f16 v147, v147, 1.0 op_sel_hi:[1,0]
v_and_b32 v145, s49, v145
v_rcp_f16 v154, v153
v_bfe_u32 v144, v145, 2, 14
v_rcp_f16_e64 v151, v150
v_lshrrev_b32 v145, 18, v145
s_waitcnt lgkmcnt(4)
ds_read_b128 v[236:239], v248 offset:45056
ds_read_u16_d16_hi v143, v143
ds_read_u16_d16 v144, v144
ds_read_u16_d16_hi v145, v145
v_mfma_f32_32x32x16_bf16 v[120:135], v[64:67], v[216:219], v[120:135]
v_rcp_f16 v148, v147
v_rcp_f16_sdwa v154, v153 dst_sel:WORD_1 dst_unused:UNUSED_PRESERVE src0_sel:WORD_1
v_fma_mix_f32 v158, v136, v136, 0 op_sel:[0,0,0] op_sel_hi:[1,1,0]
v_fma_mix_f32 v158, v137, v137, v158 op_sel:[1,1,0] op_sel_hi:[1,1,0]
v_rcp_f16_sdwa v151, v150 dst_sel:WORD_1 dst_unused:UNUSED_PRESERVE src0_sel:WORD_1
v_fma_mix_f32 v158, v138, v138, v158 op_sel:[0,0,0] op_sel_hi:[1,1,0]
s_add_u32 m0, s67, 46592
s_add_u32 s66, s66, 98304
buffer_load_dwordx4 v240, s[4:7], s66 offen lds
ds_read_b128 v[216:219], v248 offset:43008
v_mfma_f32_32x32x16_bf16 v[120:135], v[68:71], v[220:223], v[120:135]
v_rcp_f16_sdwa v148, v147 dst_sel:WORD_1 dst_unused:UNUSED_PRESERVE src0_sel:WORD_1
v_fma_mix_f32 v158, v139, v139, v158 op_sel:[1,1,0] op_sel_hi:[1,1,0]
v_pk_mul_f16 v155, v155, v154
s_waitcnt lgkmcnt(5)
v_fma_mix_f32 v158, v140, v140, v158 op_sel:[0,0,0] op_sel_hi:[1,1,0]
v_pk_mul_f16 v152, v152, v151
v_fma_mix_f32 v158, v141, v141, v158 op_sel:[1,1,0] op_sel_hi:[1,1,0]
v_pk_mul_f16 v149, v149, v148
v_fma_mix_f32 v158, v155, v155, v158 op_sel:[0,0,0] op_sel_hi:[1,1,0]
v_fma_mix_f32 v158, v142, v142, v158 op_sel:[0,0,0] op_sel_hi:[1,1,0]
v_fma_mix_f32 v158, v155, v155, v158 op_sel:[1,1,0] op_sel_hi:[1,1,0]
s_waitcnt lgkmcnt(2)
v_fma_mix_f32 v158, v143, v143, v158 op_sel:[1,1,0] op_sel_hi:[1,1,0]
v_fma_mix_f32 v158, v152, v152, v158 op_sel:[0,0,0] op_sel_hi:[1,1,0]
v_fma_mix_f32 v158, v152, v152, v158 op_sel:[1,1,0] op_sel_hi:[1,1,0]
v_fma_mix_f32 v158, v144, v144, v158 op_sel:[0,0,0] op_sel_hi:[1,1,0]
v_fma_mix_f32 v158, v149, v149, v158 op_sel:[0,0,0] op_sel_hi:[1,1,0]
s_waitcnt lgkmcnt(1)
v_fma_mix_f32 v158, v145, v145, v158 op_sel:[1,1,0] op_sel_hi:[1,1,0]
v_fma_mix_f32 v158, v149, v149, v158 op_sel:[1,1,0] op_sel_hi:[1,1,0]
v_cvt_pkrtz_f16_f32 v137, v120, v121
v_cvt_pkrtz_f16_f32 v139, v122, v123
v_cvt_pkrtz_f16_f32 v141, v124, v125
v_cvt_pkrtz_f16_f32 v143, v126, v127
v_cvt_pkrtz_f16_f32 v145, v128, v129
v_cvt_pk_f16_f32 v155, v130, v131
v_cvt_pk_f16_f32 v152, v132, v133
v_cvt_pk_f16_f32 v149, v134, v135
buffer_store_dwordx4 v[48:51], v241, s[32:35], s80 offen
ds_read_b128 v[220:223], v248 offset:46080
v_mfma_f32_32x32x16_bf16 v[120:135], v[48:51], v[224:227], 0
v_pk_fma_f16 v154, v155, v155, s48
v_and_b32_e64 v137, s49, v137
v_pk_fma_f16 v151, v152, v152, s48
v_and_b32_e64 v139, s49, v139
v_pk_fma_f16 v148, v149, v149, s48
v_pk_mul_f16 v154, v155, v154
v_bfe_u32 v136, v137, 2, 14
v_pk_mul_f16 v151, v152, v151
v_pk_mul_f16 v148, v149, v148
v_bfe_u32 v138, v139, 2, 14
ds_read_b128 v[224:227], v248 offset:47104
ds_read_u16_d16 v136, v136
ds_read_u16_d16 v138, v138
v_mfma_f32_32x32x16_bf16 v[120:135], v[52:55], v[228:231], v[120:135]
v_exp_f16 v153, v154
v_lshrrev_b32 v137, 18, v137
v_exp_f16 v150, v151
v_lshrrev_b32 v139, 18, v139
v_exp_f16 v147, v148
v_and_b32 v141, s49, v141
v_and_b32_e64 v143, s49, v143
ds_read_b128 v[228:231], v248 offset:50176
ds_read_u16_d16_hi v137, v137
ds_read_u16_d16_hi v139, v139
v_mfma_f32_32x32x16_bf16 v[120:135], v[56:59], v[232:235], v[120:135]
v_exp_f16_sdwa v153, v154 dst_sel:WORD_1 dst_unused:UNUSED_PRESERVE src0_sel:WORD_1
v_bfe_u32 v140, v141, 2, 14
v_exp_f16_sdwa v150, v151 dst_sel:WORD_1 dst_unused:UNUSED_PRESERVE src0_sel:WORD_1
v_bfe_u32 v142, v143, 2, 14
v_exp_f16_sdwa v147, v148 dst_sel:WORD_1 dst_unused:UNUSED_PRESERVE src0_sel:WORD_1
v_lshrrev_b32_e64 v141, 18, v141
v_pk_add_f16 v153, v153, 1.0 op_sel_hi:[1,0]
ds_read_b128 v[232:235], v248 offset:48128
ds_read_u16_d16 v140, v140
ds_read_u16_d16 v142, v142
ds_read_u16_d16_hi v141, v141
v_mfma_f32_32x32x16_bf16 v[120:135], v[60:63], v[236:239], v[120:135]
v_lshrrev_b32_e64 v143, 18, v143
v_pk_add_f16 v150, v150, 1.0 op_sel_hi:[1,0]
v_pk_add_f16 v147, v147, 1.0 op_sel_hi:[1,0]
v_and_b32 v145, s49, v145
v_rcp_f16 v154, v153
v_bfe_u32 v144, v145, 2, 14
v_rcp_f16_e64 v151, v150
v_lshrrev_b32 v145, 18, v145
s_waitcnt lgkmcnt(7)
ds_read_b128 v[236:239], v248 offset:51200
ds_read_u16_d16_hi v143, v143
ds_read_u16_d16 v144, v144
ds_read_u16_d16_hi v145, v145
v_mfma_f32_32x32x16_bf16 v[120:135], v[64:67], v[216:219], v[120:135]
v_rcp_f16 v148, v147
v_rcp_f16_sdwa v154, v153 dst_sel:WORD_1 dst_unused:UNUSED_PRESERVE src0_sel:WORD_1
s_setprio 0
v_fma_mix_f32 v159, v136, v136, 0 op_sel:[0,0,0] op_sel_hi:[1,1,0]
s_waitcnt lgkmcnt(8)
v_fma_mix_f32 v159, v137, v137, v159 op_sel:[1,1,0] op_sel_hi:[1,1,0]
v_rcp_f16_sdwa v151, v150 dst_sel:WORD_1 dst_unused:UNUSED_PRESERVE src0_sel:WORD_1
v_fma_mix_f32 v159, v138, v138, v159 op_sel:[0,0,0] op_sel_hi:[1,1,0]
ds_read_b128 v[216:219], v248 offset:49152
v_mfma_f32_32x32x16_bf16 v[120:135], v[68:71], v[220:223], v[120:135]
v_rcp_f16_sdwa v148, v147 dst_sel:WORD_1 dst_unused:UNUSED_PRESERVE src0_sel:WORD_1
v_fma_mix_f32 v159, v139, v139, v159 op_sel:[1,1,0] op_sel_hi:[1,1,0]
v_pk_mul_f16 v155, v155, v154
s_waitcnt lgkmcnt(5)
v_fma_mix_f32 v159, v140, v140, v159 op_sel:[0,0,0] op_sel_hi:[1,1,0]
v_pk_mul_f16 v152, v152, v151
v_fma_mix_f32 v159, v141, v141, v159 op_sel:[1,1,0] op_sel_hi:[1,1,0]
v_pk_mul_f16 v149, v149, v148
v_fma_mix_f32 v159, v155, v155, v159 op_sel:[0,0,0] op_sel_hi:[1,1,0]
v_fma_mix_f32 v159, v142, v142, v159 op_sel:[0,0,0] op_sel_hi:[1,1,0]
v_fma_mix_f32 v159, v155, v155, v159 op_sel:[1,1,0] op_sel_hi:[1,1,0]
s_waitcnt lgkmcnt(3)
v_fma_mix_f32 v159, v143, v143, v159 op_sel:[1,1,0] op_sel_hi:[1,1,0]
v_fma_mix_f32 v159, v152, v152, v159 op_sel:[0,0,0] op_sel_hi:[1,1,0]
v_fma_mix_f32 v159, v152, v152, v159 op_sel:[1,1,0] op_sel_hi:[1,1,0]
s_waitcnt lgkmcnt(1)
v_fma_mix_f32 v159, v144, v144, v159 op_sel:[0,0,0] op_sel_hi:[1,1,0]
v_fma_mix_f32 v159, v149, v149, v159 op_sel:[0,0,0] op_sel_hi:[1,1,0]
v_fma_mix_f32 v159, v145, v145, v159 op_sel:[1,1,0] op_sel_hi:[1,1,0]
v_fma_mix_f32 v159, v149, v149, v159 op_sel:[1,1,0] op_sel_hi:[1,1,0]
v_cvt_pkrtz_f16_f32 v137, v120, v121
v_cvt_pkrtz_f16_f32 v139, v122, v123
v_cvt_pkrtz_f16_f32 v141, v124, v125
v_cvt_pkrtz_f16_f32 v143, v126, v127
v_cvt_pkrtz_f16_f32 v145, v128, v129
v_cvt_pk_f16_f32 v155, v130, v131
v_cvt_pk_f16_f32 v152, v132, v133
v_cvt_pk_f16_f32 v149, v134, v135
s_add_u32 s46, s80, 2097152
buffer_store_dwordx4 v[52:55], v241, s[32:35], s46 offen
ds_read_b128 v[220:223], v248 offset:52224
v_mfma_f32_32x32x16_bf16 v[120:135], v[48:51], v[224:227], 0
v_pk_fma_f16 v154, v155, v155, s48
v_and_b32_e64 v137, s49, v137
v_pk_fma_f16 v151, v152, v152, s48
v_and_b32_e64 v139, s49, v139
v_pk_fma_f16 v148, v149, v149, s48
v_pk_mul_f16 v154, v155, v154
v_bfe_u32 v136, v137, 2, 14
v_pk_mul_f16 v151, v152, v151
v_pk_mul_f16 v148, v149, v148
v_bfe_u32 v138, v139, 2, 14
ds_read_b64 v[224:225], v245 offset:384
ds_read_b64 v[226:227], v246 offset:384
s_waitcnt vmcnt(2)
s_barrier
ds_read_b128 v[192:195], v242
ds_read_u16_d16 v136, v136
ds_read_u16_d16 v138, v138
v_mfma_f32_32x32x16_bf16 v[120:135], v[52:55], v[228:231], v[120:135]
v_exp_f16 v153, v154
v_lshrrev_b32 v137, 18, v137
v_exp_f16 v150, v151
v_lshrrev_b32 v139, 18, v139
v_exp_f16 v147, v148
v_and_b32 v141, s49, v141
v_and_b32_e64 v143, s49, v143
ds_read_b128 v[228:231], v248 offset:53248
ds_read_u16_d16_hi v137, v137
ds_read_u16_d16_hi v139, v139
v_mfma_f32_32x32x16_bf16 v[120:135], v[56:59], v[232:235], v[120:135]
v_exp_f16_sdwa v153, v154 dst_sel:WORD_1 dst_unused:UNUSED_PRESERVE src0_sel:WORD_1
v_bfe_u32 v140, v141, 2, 14
v_exp_f16_sdwa v150, v151 dst_sel:WORD_1 dst_unused:UNUSED_PRESERVE src0_sel:WORD_1
v_bfe_u32 v142, v143, 2, 14
v_exp_f16_sdwa v147, v148 dst_sel:WORD_1 dst_unused:UNUSED_PRESERVE src0_sel:WORD_1
v_lshrrev_b32 v141, 18, v141
v_pk_add_f16 v153, v153, 1.0 op_sel_hi:[1,0]
s_setprio 2
ds_read_b64 v[232:233], v245 offset:1152
ds_read_b64 v[234:235], v246 offset:1152
ds_read_b128 v[196:199], v242 offset:64
ds_read_u16_d16 v140, v140
ds_read_u16_d16 v142, v142
ds_read_u16_d16_hi v141, v141
v_mfma_f32_32x32x16_bf16 v[120:135], v[60:63], v[236:239], v[120:135]
v_lshrrev_b32_e64 v143, 18, v143
v_pk_add_f16 v150, v150, 1.0 op_sel_hi:[1,0]
v_pk_add_f16 v147, v147, 1.0 op_sel_hi:[1,0]
v_and_b32 v145, s49, v145
v_rcp_f16 v154, v153
v_bfe_u32 v144, v145, 2, 14
v_rcp_f16_e64 v151, v150
v_lshrrev_b32 v145, 18, v145
s_waitcnt lgkmcnt(6)
ds_read_b128 v[236:239], v248 offset:56320
ds_read_u16_d16_hi v143, v143
ds_read_u16_d16 v144, v144
ds_read_u16_d16_hi v145, v145
v_mfma_f32_32x32x16_bf16 v[120:135], v[64:67], v[216:219], v[120:135]
v_rcp_f16 v148, v147
v_rcp_f16_sdwa v154, v153 dst_sel:WORD_1 dst_unused:UNUSED_PRESERVE src0_sel:WORD_1
v_fma_mix_f32 v160, v136, v136, 0 op_sel:[0,0,0] op_sel_hi:[1,1,0]
v_fma_mix_f32 v160, v137, v137, v160 op_sel:[1,1,0] op_sel_hi:[1,1,0]
v_rcp_f16_sdwa v151, v150 dst_sel:WORD_1 dst_unused:UNUSED_PRESERVE src0_sel:WORD_1
v_fma_mix_f32 v160, v138, v138, v160 op_sel:[0,0,0] op_sel_hi:[1,1,0]
ds_read_b64 v[216:217], v245 offset:1920
ds_read_b64 v[218:219], v246 offset:1920
ds_read_b128 v[200:203], v242 offset:128
v_mfma_f32_32x32x16_bf16 v[120:135], v[68:71], v[220:223], v[120:135]
v_rcp_f16_sdwa v148, v147 dst_sel:WORD_1 dst_unused:UNUSED_PRESERVE src0_sel:WORD_1
v_fma_mix_f32 v160, v139, v139, v160 op_sel:[1,1,0] op_sel_hi:[1,1,0]
v_pk_mul_f16 v155, v155, v154
s_waitcnt lgkmcnt(7)
v_fma_mix_f32 v160, v140, v140, v160 op_sel:[0,0,0] op_sel_hi:[1,1,0]
v_pk_mul_f16 v152, v152, v151
v_fma_mix_f32 v160, v141, v141, v160 op_sel:[1,1,0] op_sel_hi:[1,1,0]
v_pk_mul_f16 v149, v149, v148
v_fma_mix_f32 v160, v155, v155, v160 op_sel:[0,0,0] op_sel_hi:[1,1,0]
v_fma_mix_f32 v160, v142, v142, v160 op_sel:[0,0,0] op_sel_hi:[1,1,0]
v_fma_mix_f32 v160, v155, v155, v160 op_sel:[1,1,0] op_sel_hi:[1,1,0]
s_waitcnt lgkmcnt(5)
v_fma_mix_f32 v160, v143, v143, v160 op_sel:[1,1,0] op_sel_hi:[1,1,0]
v_fma_mix_f32 v160, v152, v152, v160 op_sel:[0,0,0] op_sel_hi:[1,1,0]
v_fma_mix_f32 v160, v152, v152, v160 op_sel:[1,1,0] op_sel_hi:[1,1,0]
s_waitcnt lgkmcnt(3)
v_fma_mix_f32 v160, v144, v144, v160 op_sel:[0,0,0] op_sel_hi:[1,1,0]
v_fma_mix_f32 v160, v149, v149, v160 op_sel:[0,0,0] op_sel_hi:[1,1,0]
v_fma_mix_f32 v160, v145, v145, v160 op_sel:[1,1,0] op_sel_hi:[1,1,0]
v_fma_mix_f32 v160, v149, v149, v160 op_sel:[1,1,0] op_sel_hi:[1,1,0]
v_mfma_f32_16x16x32_bf16 v[8:11], v[224:227], v[192:195], 0
s_add_u32 s46, s80, 4194304
buffer_store_dwordx4 v[56:59], v241, s[32:35], s46 offen
ds_read_b128 v[220:223], v248 offset:54272
v_cvt_pkrtz_f16_f32 v137, v120, v121
v_cvt_pkrtz_f16_f32 v139, v122, v123
v_cvt_pkrtz_f16_f32 v141, v124, v125
v_cvt_pkrtz_f16_f32 v143, v126, v127
v_cvt_pk_f16_f32 v155, v128, v129
v_cvt_pk_f16_f32 v152, v130, v131
v_cvt_pk_f16_f32 v149, v132, v133
v_cvt_pk_f16_f32 v146, v134, v135
v_mfma_f32_32x32x16_bf16 v[120:135], v[48:51], v[228:231], 0
ds_read_b64 v[224:225], v245 offset:2688
ds_read_b64 v[226:227], v246 offset:2688
ds_read_b128 v[204:207], v243
v_pk_fma_f16 v154, v155, v155, s48
v_and_b32_e64 v137, s49, v137
v_pk_fma_f16 v151, v152, v152, s48
v_pk_fma_f16 v148, v149, v149, s48
v_mfma_f32_16x16x32_bf16 v[24:27], v[232:235], v[196:199], 0
ds_read_b128 v[228:231], v248 offset:57344
v_and_b32_e64 v139, s49, v139
v_pk_fma_f16 v145, v146, v146, s48
v_pk_mul_f16 v154, v155, v154
v_bfe_u32 v136, v137, 2, 14
v_mfma_f32_32x32x16_bf16 v[120:135], v[52:55], v[236:239], v[120:135]
ds_read_b64 v[232:233], v245 offset:3456
ds_read_b64 v[234:235], v246 offset:3456
ds_read_b128 v[208:211], v243 offset:64
ds_read_u16_d16 v136, v136
v_pk_mul_f16 v151, v152, v151
v_pk_mul_f16 v148, v149, v148
v_bfe_u32 v138, v139, 2, 14
v_pk_mul_f16 v145, v146, v145
v_exp_f16_e64 v153, v154
v_lshrrev_b32 v137, 18, v137
s_waitcnt lgkmcnt(8)
v_mfma_f32_16x16x32_bf16 v[40:43], v[216:219], v[200:203], 0
ds_read_b128 v[236:239], v248 offset:55296
ds_read_u16_d16 v138, v138
ds_read_u16_d16_hi v137, v137
v_exp_f16 v150, v151
v_lshrrev_b32 v139, 18, v139
v_exp_f16_e64 v147, v148
v_mfma_f32_32x32x16_bf16 v[120:135], v[56:59], v[220:223], v[120:135]
ds_read_b64 v[216:217], v245 offset:4224
ds_read_b64 v[218:219], v246 offset:4224
ds_read_b128 v[212:215], v243 offset:128
ds_read_u16_d16_hi v139, v139
v_and_b32 v141, s49, v141
v_exp_f16 v144, v145
v_and_b32 v143, s49, v143
v_exp_f16_sdwa v153, v154 dst_sel:WORD_1 dst_unused:UNUSED_PRESERVE src0_sel:WORD_1
v_bfe_u32 v140, v141, 2, 14
s_waitcnt lgkmcnt(7)
v_mfma_f32_16x16x32_bf16 v[8:11], v[224:227], v[204:207], v[8:11]
ds_read_b64 v[220:221], v245 offset:4992
ds_read_b64 v[222:223], v246 offset:4992
ds_read_b128 v[192:195], v244
ds_read_u16_d16 v140, v140
v_exp_f16_sdwa v150, v151 dst_sel:WORD_1 dst_unused:UNUSED_PRESERVE src0_sel:WORD_1
v_bfe_u32 v142, v143, 2, 14
v_exp_f16_sdwa v147, v148 dst_sel:WORD_1 dst_unused:UNUSED_PRESERVE src0_sel:WORD_1
v_mfma_f32_32x32x16_bf16 v[120:135], v[60:63], v[228:231], v[120:135]
ds_read_b128 v[224:227], v248 offset:58368
ds_read_u16_d16 v142, v142
v_lshrrev_b32_e64 v141, 18, v141
v_exp_f16_sdwa v144, v145 dst_sel:WORD_1 dst_unused:UNUSED_PRESERVE src0_sel:WORD_1
v_lshrrev_b32_e64 v143, 18, v143
v_pk_add_f16 v153, v153, 1.0 op_sel_hi:[1,0]
v_pk_add_f16 v150, v150, 1.0 op_sel_hi:[1,0]
v_pk_add_f16 v147, v147, 1.0 op_sel_hi:[1,0]
v_pk_add_f16 v144, v144, 1.0 op_sel_hi:[1,0]
v_mfma_f32_16x16x32_bf16 v[24:27], v[232:235], v[208:211], v[24:27]
ds_read_b64 v[228:229], v245 offset:5760
ds_read_b64 v[230:231], v246 offset:5760
ds_read_b128 v[196:199], v244 offset:64
ds_read_u16_d16_hi v141, v141
ds_read_u16_d16_hi v143, v143
v_rcp_f16_e64 v154, v153
v_rcp_f16 v151, v150
s_waitcnt lgkmcnt(10)
v_mfma_f32_32x32x16_bf16 v[120:135], v[64:67], v[236:239], v[120:135]
ds_read_b64 v[232:233], v245 offset:6528
ds_read_b64 v[234:235], v246 offset:6528
ds_read_b128 v[200:203], v244 offset:128
v_rcp_f16 v148, v147
v_rcp_f16 v145, v144
v_rcp_f16_sdwa v154, v153 dst_sel:WORD_1 dst_unused:UNUSED_PRESERVE src0_sel:WORD_1
v_rcp_f16_sdwa v151, v150 dst_sel:WORD_1 dst_unused:UNUSED_PRESERVE src0_sel:WORD_1
v_mfma_f32_16x16x32_bf16 v[40:43], v[216:219], v[212:215], v[40:43]
ds_read_b64 v[236:237], v245 offset:576
ds_read_b64 v[238:239], v246 offset:576
v_xor_b32 v242, 16, v242
ds_read_b128 v[204:207], v242
v_rcp_f16_sdwa v148, v147 dst_sel:WORD_1 dst_unused:UNUSED_PRESERVE src0_sel:WORD_1
v_fma_mix_f32 v161, v136, v136, 0 op_sel:[0,0,0] op_sel_hi:[1,1,0]
s_waitcnt lgkmcnt(11)
v_mfma_f32_16x16x32_bf16 v[8:11], v[220:223], v[192:195], v[8:11]
ds_read_b128 v[216:219], v248 offset:59392
v_rcp_f16_sdwa v145, v144 dst_sel:WORD_1 dst_unused:UNUSED_PRESERVE src0_sel:WORD_1
v_fma_mix_f32 v161, v137, v137, v161 op_sel:[1,1,0] op_sel_hi:[1,1,0]
v_pk_mul_f16 v155, v155, v154
v_fma_mix_f32 v161, v138, v138, v161 op_sel:[0,0,0] op_sel_hi:[1,1,0]
v_mfma_f32_32x32x16_bf16 v[120:135], v[68:71], v[224:227], v[120:135]
ds_read_b64 v[220:221], v245 offset:1344
ds_read_b64 v[222:223], v246 offset:1344
ds_read_b128 v[208:211], v242 offset:64
v_pk_mul_f16 v152, v152, v151
v_pk_mul_f16 v149, v149, v148
v_fma_mix_f32 v161, v139, v139, v161 op_sel:[1,1,0] op_sel_hi:[1,1,0]
v_pk_mul_f16 v146, v146, v145
v_fma_mix_f32 v161, v155, v155, v161 op_sel:[0,0,0] op_sel_hi:[1,1,0]
v_fma_mix_f32 v161, v140, v140, v161 op_sel:[0,0,0] op_sel_hi:[1,1,0]
v_fma_mix_f32 v161, v155, v155, v161 op_sel:[1,1,0] op_sel_hi:[1,1,0]
v_fma_mix_f32 v161, v152, v152, v161 op_sel:[0,0,0] op_sel_hi:[1,1,0]
s_waitcnt lgkmcnt(6)
v_mfma_f32_16x16x32_bf16 v[24:27], v[228:231], v[196:199], v[24:27]
ds_read_b128 v[224:227], v248 offset:62464
v_fma_mix_f32 v161, v141, v141, v161 op_sel:[1,1,0] op_sel_hi:[1,1,0]
v_fma_mix_f32 v161, v152, v152, v161 op_sel:[1,1,0] op_sel_hi:[1,1,0]
v_fma_mix_f32 v161, v149, v149, v161 op_sel:[0,0,0] op_sel_hi:[1,1,0]
v_fma_mix_f32 v161, v142, v142, v161 op_sel:[0,0,0] op_sel_hi:[1,1,0]
v_mfma_f32_16x16x32_bf16 v[40:43], v[232:235], v[200:203], v[40:43]
ds_read_b64 v[228:229], v245 offset:2112
ds_read_b64 v[230:231], v246 offset:2112
ds_read_b128 v[212:215], v242 offset:128
v_fma_mix_f32 v161, v149, v149, v161 op_sel:[1,1,0] op_sel_hi:[1,1,0]
v_fma_mix_f32 v161, v146, v146, v161 op_sel:[0,0,0] op_sel_hi:[1,1,0]
v_fma_mix_f32 v161, v143, v143, v161 op_sel:[1,1,0] op_sel_hi:[1,1,0]
v_fma_mix_f32 v161, v146, v146, v161 op_sel:[1,1,0] op_sel_hi:[1,1,0]
s_waitcnt lgkmcnt(5)
v_mfma_f32_16x16x32_bf16 v[12:15], v[236:239], v[204:207], 0
s_add_u32 s46, s80, 6291456
buffer_store_dwordx4 v[60:63], v241, s[32:35], s46 offen
ds_read_b128 v[232:235], v248 offset:60416
v_cvt_pkrtz_f16_f32 v137, v120, v121
v_cvt_pkrtz_f16_f32 v139, v122, v123
v_cvt_pkrtz_f16_f32 v141, v124, v125
v_cvt_pkrtz_f16_f32 v143, v126, v127
v_cvt_pk_f16_f32 v155, v128, v129
v_cvt_pk_f16_f32 v152, v130, v131
v_cvt_pk_f16_f32 v149, v132, v133
v_cvt_pk_f16_f32 v146, v134, v135
v_mfma_f32_32x32x16_bf16 v[120:135], v[48:51], v[216:219], 0
ds_read_b64 v[236:237], v245 offset:2880
ds_read_b64 v[238:239], v246 offset:2880
v_xor_b32 v243, 16, v243
ds_read_b128 v[192:195], v243
v_pk_fma_f16 v154, v155, v155, s48
v_and_b32 v137, s49, v137
v_pk_fma_f16 v151, v152, v152, s48
v_pk_fma_f16 v148, v149, v149, s48
s_waitcnt lgkmcnt(4)
v_mfma_f32_16x16x32_bf16 v[28:31], v[220:223], v[208:211], 0
ds_read_b128 v[216:219], v248 offset:63488
v_and_b32 v139, s49, v139
v_pk_fma_f16 v145, v146, v146, s48
v_pk_mul_f16 v154, v155, v154
v_bfe_u32 v136, v137, 2, 14
v_mfma_f32_32x32x16_bf16 v[120:135], v[52:55], v[224:227], v[120:135]
ds_read_b64 v[220:221], v245 offset:3648
ds_read_b64 v[222:223], v246 offset:3648
ds_read_b128 v[196:199], v243 offset:64
ds_read_u16_d16 v136, v136
v_pk_mul_f16 v151, v152, v151
v_pk_mul_f16 v148, v149, v148
v_bfe_u32 v138, v139, 2, 14
v_pk_mul_f16 v145, v146, v145
v_exp_f16 v153, v154
v_lshrrev_b32 v137, 18, v137
v_mfma_f32_16x16x32_bf16 v[44:47], v[228:231], v[212:215], 0
ds_read_b128 v[224:227], v248 offset:61440
ds_read_u16_d16 v138, v138
ds_read_u16_d16_hi v137, v137
v_exp_f16 v150, v151
v_lshrrev_b32 v139, 18, v139
v_exp_f16 v147, v148
s_waitcnt lgkmcnt(8)
v_mfma_f32_32x32x16_bf16 v[120:135], v[56:59], v[232:235], v[120:135]
ds_read_b64 v[228:229], v245 offset:4416
ds_read_b64 v[230:231], v246 offset:4416
ds_read_b128 v[200:203], v243 offset:128
ds_read_u16_d16_hi v139, v139
v_and_b32 v141, s49, v141
v_exp_f16 v144, v145
v_and_b32_e64 v143, s49, v143
v_exp_f16_sdwa v153, v154 dst_sel:WORD_1 dst_unused:UNUSED_PRESERVE src0_sel:WORD_1
v_bfe_u32 v140, v141, 2, 14
v_mfma_f32_16x16x32_bf16 v[12:15], v[236:239], v[192:195], v[12:15]
ds_read_b64 v[232:233], v245 offset:5184
ds_read_b64 v[234:235], v246 offset:5184
v_xor_b32 v244, 16, v244
ds_read_b128 v[204:207], v244
ds_read_u16_d16 v140, v140
v_exp_f16_sdwa v150, v151 dst_sel:WORD_1 dst_unused:UNUSED_PRESERVE src0_sel:WORD_1
v_bfe_u32 v142, v143, 2, 14
v_exp_f16_sdwa v147, v148 dst_sel:WORD_1 dst_unused:UNUSED_PRESERVE src0_sel:WORD_1
s_waitcnt lgkmcnt(9)
v_mfma_f32_32x32x16_bf16 v[120:135], v[60:63], v[216:219], v[120:135]
ds_read_b128 v[236:239], v248 offset:64512
ds_read_u16_d16 v142, v142
v_lshrrev_b32_e64 v141, 18, v141
v_exp_f16_sdwa v144, v145 dst_sel:WORD_1 dst_unused:UNUSED_PRESERVE src0_sel:WORD_1
v_lshrrev_b32_e64 v143, 18, v143
v_pk_add_f16 v153, v153, 1.0 op_sel_hi:[1,0]
v_pk_add_f16 v150, v150, 1.0 op_sel_hi:[1,0]
v_pk_add_f16 v147, v147, 1.0 op_sel_hi:[1,0]
v_pk_add_f16 v144, v144, 1.0 op_sel_hi:[1,0]
v_mfma_f32_16x16x32_bf16 v[28:31], v[220:223], v[196:199], v[28:31]
ds_read_b64 v[216:217], v245 offset:5952
ds_read_b64 v[218:219], v246 offset:5952
ds_read_b128 v[208:211], v244 offset:64
ds_read_u16_d16_hi v141, v141
ds_read_u16_d16_hi v143, v143
v_rcp_f16 v154, v153
v_rcp_f16 v151, v150
v_mfma_f32_32x32x16_bf16 v[120:135], v[64:67], v[224:227], v[120:135]
ds_read_b64 v[220:221], v245 offset:6720
ds_read_b64 v[222:223], v246 offset:6720
ds_read_b128 v[212:215], v244 offset:128
v_rcp_f16_e64 v148, v147
v_rcp_f16 v145, v144
v_rcp_f16_sdwa v154, v153 dst_sel:WORD_1 dst_unused:UNUSED_PRESERVE src0_sel:WORD_1
v_rcp_f16_sdwa v151, v150 dst_sel:WORD_1 dst_unused:UNUSED_PRESERVE src0_sel:WORD_1
s_waitcnt lgkmcnt(9)
v_mfma_f32_16x16x32_bf16 v[44:47], v[228:231], v[200:203], v[44:47]
ds_read_b64 v[224:225], v245 offset:192
ds_read_b64 v[226:227], v246 offset:192
v_xor_b32 v242, 32, v242
ds_read_b128 v[192:195], v242
v_rcp_f16_sdwa v148, v147 dst_sel:WORD_1 dst_unused:UNUSED_PRESERVE src0_sel:WORD_1
v_fma_mix_f32 v162, v136, v136, 0 op_sel:[0,0,0] op_sel_hi:[1,1,0]
s_setprio 1
v_mfma_f32_16x16x32_bf16 v[12:15], v[232:235], v[204:207], v[12:15]
ds_read_b128 v[228:231], v249
v_rcp_f16_sdwa v145, v144 dst_sel:WORD_1 dst_unused:UNUSED_PRESERVE src0_sel:WORD_1
v_fma_mix_f32 v162, v137, v137, v162 op_sel:[1,1,0] op_sel_hi:[1,1,0]
v_pk_mul_f16 v155, v155, v154
v_fma_mix_f32 v162, v138, v138, v162 op_sel:[0,0,0] op_sel_hi:[1,1,0]
v_mfma_f32_32x32x16_bf16 v[120:135], v[68:71], v[236:239], v[120:135]
ds_read_b64 v[232:233], v245 offset:960
ds_read_b64 v[234:235], v246 offset:960
ds_read_b128 v[196:199], v242 offset:64
v_pk_mul_f16 v152, v152, v151
v_pk_mul_f16 v149, v149, v148
v_fma_mix_f32 v162, v139, v139, v162 op_sel:[1,1,0] op_sel_hi:[1,1,0]
v_pk_mul_f16 v146, v146, v145
v_fma_mix_f32 v162, v155, v155, v162 op_sel:[0,0,0] op_sel_hi:[1,1,0]
v_fma_mix_f32 v162, v140, v140, v162 op_sel:[0,0,0] op_sel_hi:[1,1,0]
v_fma_mix_f32 v162, v155, v155, v162 op_sel:[1,1,0] op_sel_hi:[1,1,0]
v_fma_mix_f32 v162, v152, v152, v162 op_sel:[0,0,0] op_sel_hi:[1,1,0]
s_waitcnt lgkmcnt(6)
v_mfma_f32_16x16x32_bf16 v[28:31], v[216:219], v[208:211], v[28:31]
ds_read_b128 v[236:239], v249 offset:3072
v_fma_mix_f32 v162, v141, v141, v162 op_sel:[1,1,0] op_sel_hi:[1,1,0]
v_fma_mix_f32 v162, v152, v152, v162 op_sel:[1,1,0] op_sel_hi:[1,1,0]
v_fma_mix_f32 v162, v149, v149, v162 op_sel:[0,0,0] op_sel_hi:[1,1,0]
v_fma_mix_f32 v162, v142, v142, v162 op_sel:[0,0,0] op_sel_hi:[1,1,0]
v_mfma_f32_16x16x32_bf16 v[44:47], v[220:223], v[212:215], v[44:47]
ds_read_b64 v[216:217], v245 offset:1728
ds_read_b64 v[218:219], v246 offset:1728
ds_read_b128 v[200:203], v242 offset:128
v_fma_mix_f32 v162, v149, v149, v162 op_sel:[1,1,0] op_sel_hi:[1,1,0]
v_fma_mix_f32 v162, v146, v146, v162 op_sel:[0,0,0] op_sel_hi:[1,1,0]
v_fma_mix_f32 v162, v143, v143, v162 op_sel:[1,1,0] op_sel_hi:[1,1,0]
v_fma_mix_f32 v162, v146, v146, v162 op_sel:[1,1,0] op_sel_hi:[1,1,0]
s_waitcnt lgkmcnt(5)
v_mfma_f32_16x16x32_bf16 v[4:7], v[224:227], v[192:195], 0
s_add_u32 s46, s80, 8388608
buffer_store_dwordx4 v[64:67], v241, s[32:35], s46 offen
ds_read_b128 v[220:223], v249 offset:1024
v_cvt_pkrtz_f16_f32 v137, v120, v121
v_cvt_pkrtz_f16_f32 v139, v122, v123
v_cvt_pkrtz_f16_f32 v141, v124, v125
v_cvt_pkrtz_f16_f32 v143, v126, v127
v_cvt_pk_f16_f32 v155, v128, v129
v_cvt_pk_f16_f32 v152, v130, v131
v_cvt_pk_f16_f32 v149, v132, v133
v_cvt_pk_f16_f32 v146, v134, v135
v_mfma_f32_32x32x16_bf16 v[120:135], v[48:51], v[228:231], 0
ds_read_b64 v[224:225], v245 offset:2496
ds_read_b64 v[226:227], v246 offset:2496
v_xor_b32 v243, 32, v243
ds_read_b128 v[204:207], v243
v_pk_fma_f16 v154, v155, v155, s48
v_and_b32 v137, s49, v137
v_pk_fma_f16 v151, v152, v152, s48
v_pk_fma_f16 v148, v149, v149, s48
s_waitcnt lgkmcnt(4)
v_mfma_f32_16x16x32_bf16 v[20:23], v[232:235], v[196:199], 0
ds_read_b128 v[228:231], v249 offset:4096
v_and_b32 v139, s49, v139
v_pk_fma_f16 v145, v146, v146, s48
v_pk_mul_f16 v154, v155, v154
v_bfe_u32 v136, v137, 2, 14
v_mfma_f32_32x32x16_bf16 v[120:135], v[52:55], v[236:239], v[120:135]
ds_read_b64 v[232:233], v245 offset:3264
ds_read_b64 v[234:235], v246 offset:3264
ds_read_b128 v[208:211], v243 offset:64
ds_read_u16_d16 v136, v136
v_pk_mul_f16 v151, v152, v151
v_pk_mul_f16 v148, v149, v148
v_bfe_u32 v138, v139, 2, 14
v_pk_mul_f16 v145, v146, v145
v_exp_f16 v153, v154
v_lshrrev_b32 v137, 18, v137
v_mfma_f32_16x16x32_bf16 v[36:39], v[216:219], v[200:203], 0
ds_read_b128 v[236:239], v249 offset:2048
ds_read_u16_d16 v138, v138
ds_read_u16_d16_hi v137, v137
v_exp_f16 v150, v151
v_lshrrev_b32 v139, 18, v139
v_exp_f16 v147, v148
s_waitcnt lgkmcnt(8)
v_mfma_f32_32x32x16_bf16 v[120:135], v[56:59], v[220:223], v[120:135]
ds_read_b64 v[216:217], v245 offset:4032
ds_read_b64 v[218:219], v246 offset:4032
ds_read_b128 v[212:215], v243 offset:128
ds_read_u16_d16_hi v139, v139
v_and_b32 v141, s49, v141
v_exp_f16 v144, v145
v_and_b32_e64 v143, s49, v143
v_exp_f16_sdwa v153, v154 dst_sel:WORD_1 dst_unused:UNUSED_PRESERVE src0_sel:WORD_1
v_bfe_u32 v140, v141, 2, 14
v_mfma_f32_16x16x32_bf16 v[4:7], v[224:227], v[204:207], v[4:7]
ds_read_b64 v[220:221], v245 offset:4800
ds_read_b64 v[222:223], v246 offset:4800
v_xor_b32 v244, 32, v244
ds_read_b128 v[192:195], v244
ds_read_u16_d16 v140, v140
v_exp_f16_sdwa v150, v151 dst_sel:WORD_1 dst_unused:UNUSED_PRESERVE src0_sel:WORD_1
v_bfe_u32 v142, v143, 2, 14
v_exp_f16_sdwa v147, v148 dst_sel:WORD_1 dst_unused:UNUSED_PRESERVE src0_sel:WORD_1
s_waitcnt lgkmcnt(9)
v_mfma_f32_32x32x16_bf16 v[120:135], v[60:63], v[228:231], v[120:135]
ds_read_b128 v[224:227], v249 offset:5120
ds_read_u16_d16 v142, v142
v_lshrrev_b32_e64 v141, 18, v141
v_exp_f16_sdwa v144, v145 dst_sel:WORD_1 dst_unused:UNUSED_PRESERVE src0_sel:WORD_1
v_lshrrev_b32_e64 v143, 18, v143
v_pk_add_f16 v153, v153, 1.0 op_sel_hi:[1,0]
v_pk_add_f16 v150, v150, 1.0 op_sel_hi:[1,0]
v_pk_add_f16 v147, v147, 1.0 op_sel_hi:[1,0]
v_pk_add_f16 v144, v144, 1.0 op_sel_hi:[1,0]
v_mfma_f32_16x16x32_bf16 v[20:23], v[232:235], v[208:211], v[20:23]
ds_read_b64 v[228:229], v245 offset:5568
ds_read_b64 v[230:231], v246 offset:5568
ds_read_b128 v[196:199], v244 offset:64
ds_read_u16_d16_hi v141, v141
ds_read_u16_d16_hi v143, v143
v_rcp_f16 v154, v153
v_rcp_f16 v151, v150
v_mfma_f32_32x32x16_bf16 v[120:135], v[64:67], v[236:239], v[120:135]
ds_read_b64 v[232:233], v245 offset:6336
ds_read_b64 v[234:235], v246 offset:6336
ds_read_b128 v[200:203], v244 offset:128
v_rcp_f16 v148, v147
v_rcp_f16 v145, v144
v_rcp_f16_sdwa v154, v153 dst_sel:WORD_1 dst_unused:UNUSED_PRESERVE src0_sel:WORD_1
v_rcp_f16_sdwa v151, v150 dst_sel:WORD_1 dst_unused:UNUSED_PRESERVE src0_sel:WORD_1
s_waitcnt lgkmcnt(9)
v_mfma_f32_16x16x32_bf16 v[36:39], v[216:219], v[212:215], v[36:39]
ds_read_b64 v[236:237], v245
ds_read_b64 v[238:239], v246
v_xor_b32 v242, 16, v242
ds_read_b128 v[204:207], v242
v_rcp_f16_sdwa v148, v147 dst_sel:WORD_1 dst_unused:UNUSED_PRESERVE src0_sel:WORD_1
v_fma_mix_f32 v163, v136, v136, 0 op_sel:[0,0,0] op_sel_hi:[1,1,0]
v_mfma_f32_16x16x32_bf16 v[4:7], v[220:223], v[192:195], v[4:7]
ds_read_b128 v[216:219], v249 offset:6144
v_rcp_f16_sdwa v145, v144 dst_sel:WORD_1 dst_unused:UNUSED_PRESERVE src0_sel:WORD_1
v_fma_mix_f32 v163, v137, v137, v163 op_sel:[1,1,0] op_sel_hi:[1,1,0]
v_pk_mul_f16 v155, v155, v154
v_fma_mix_f32 v163, v138, v138, v163 op_sel:[0,0,0] op_sel_hi:[1,1,0]
v_mfma_f32_32x32x16_bf16 v[120:135], v[68:71], v[224:227], v[120:135]
ds_read_b64 v[220:221], v245 offset:768
ds_read_b64 v[222:223], v246 offset:768
ds_read_b128 v[208:211], v242 offset:64
v_pk_mul_f16 v152, v152, v151
v_pk_mul_f16 v149, v149, v148
v_fma_mix_f32 v163, v139, v139, v163 op_sel:[1,1,0] op_sel_hi:[1,1,0]
v_pk_mul_f16 v146, v146, v145
v_fma_mix_f32 v163, v155, v155, v163 op_sel:[0,0,0] op_sel_hi:[1,1,0]
v_fma_mix_f32 v163, v140, v140, v163 op_sel:[0,0,0] op_sel_hi:[1,1,0]
v_fma_mix_f32 v163, v155, v155, v163 op_sel:[1,1,0] op_sel_hi:[1,1,0]
v_fma_mix_f32 v163, v152, v152, v163 op_sel:[0,0,0] op_sel_hi:[1,1,0]
s_waitcnt lgkmcnt(7)
v_mfma_f32_16x16x32_bf16 v[20:23], v[228:231], v[196:199], v[20:23]
ds_read_b128 v[224:227], v249 offset:9216
v_fma_mix_f32 v163, v141, v141, v163 op_sel:[1,1,0] op_sel_hi:[1,1,0]
v_fma_mix_f32 v163, v152, v152, v163 op_sel:[1,1,0] op_sel_hi:[1,1,0]
v_fma_mix_f32 v163, v149, v149, v163 op_sel:[0,0,0] op_sel_hi:[1,1,0]
v_fma_mix_f32 v163, v142, v142, v163 op_sel:[0,0,0] op_sel_hi:[1,1,0]
v_mfma_f32_16x16x32_bf16 v[36:39], v[232:235], v[200:203], v[36:39]
ds_read_b64 v[228:229], v245 offset:1536
ds_read_b64 v[230:231], v246 offset:1536
ds_read_b128 v[212:215], v242 offset:128
v_fma_mix_f32 v163, v149, v149, v163 op_sel:[1,1,0] op_sel_hi:[1,1,0]
v_fma_mix_f32 v163, v146, v146, v163 op_sel:[0,0,0] op_sel_hi:[1,1,0]
v_fma_mix_f32 v163, v143, v143, v163 op_sel:[1,1,0] op_sel_hi:[1,1,0]
v_fma_mix_f32 v163, v146, v146, v163 op_sel:[1,1,0] op_sel_hi:[1,1,0]
s_waitcnt lgkmcnt(5)
v_mfma_f32_16x16x32_bf16 v[0:3], v[236:239], v[204:207], 0
s_add_u32 s46, s80, 10485760
buffer_store_dwordx4 v[68:71], v241, s[32:35], s46 offen
ds_read_b128 v[232:235], v249 offset:7168
v_cvt_pkrtz_f16_f32 v137, v120, v121
v_cvt_pkrtz_f16_f32 v139, v122, v123
v_cvt_pkrtz_f16_f32 v141, v124, v125
v_cvt_pkrtz_f16_f32 v143, v126, v127
v_cvt_pk_f16_f32 v155, v128, v129
v_cvt_pk_f16_f32 v152, v130, v131
v_cvt_pk_f16_f32 v149, v132, v133
v_cvt_pk_f16_f32 v146, v134, v135
v_mfma_f32_32x32x16_bf16 v[120:135], v[48:51], v[216:219], 0
ds_read_b64 v[236:237], v245 offset:2304
ds_read_b64 v[238:239], v246 offset:2304
v_xor_b32 v243, 16, v243
ds_read_b128 v[192:195], v243
v_pk_fma_f16 v154, v155, v155, s48
v_and_b32_e64 v137, s49, v137
s_waitcnt lgkmcnt(4)
v_mfma_f32_16x16x32_bf16 v[16:19], v[220:223], v[208:211], 0
ds_read_b128 v[216:219], v249 offset:10240
v_pk_fma_f16 v151, v152, v152, s48
v_pk_fma_f16 v148, v149, v149, s48
v_and_b32_e64 v139, s49, v139
v_pk_fma_f16 v145, v146, v146, s48
v_mfma_f32_32x32x16_bf16 v[120:135], v[52:55], v[224:227], v[120:135]
ds_read_b64 v[220:221], v245 offset:3072
ds_read_b64 v[222:223], v246 offset:3072
ds_read_b128 v[196:199], v243 offset:64
v_pk_mul_f16 v154, v155, v154
v_bfe_u32 v136, v137, 2, 14
v_pk_mul_f16 v151, v152, v151
v_pk_mul_f16 v148, v149, v148
v_bfe_u32 v138, v139, 2, 14
v_pk_mul_f16 v145, v146, v145
v_mfma_f32_16x16x32_bf16 v[32:35], v[228:231], v[212:215], 0
ds_read_b128 v[224:227], v249 offset:8192
ds_read_u16_d16 v136, v136
ds_read_u16_d16 v138, v138
v_exp_f16 v153, v154
v_lshrrev_b32 v137, 18, v137
v_exp_f16 v150, v151
s_waitcnt lgkmcnt(7)
v_mfma_f32_32x32x16_bf16 v[120:135], v[56:59], v[232:235], v[120:135]
ds_read_b64 v[228:229], v245 offset:3840
ds_read_b64 v[230:231], v246 offset:3840
ds_read_b128 v[200:203], v243 offset:128
ds_read_u16_d16_hi v137, v137
v_lshrrev_b32 v139, 18, v139
v_exp_f16 v147, v148
s_setprio 0
v_and_b32 v141, s49, v141
v_exp_f16 v144, v145
v_and_b32 v143, s49, v143
v_mfma_f32_16x16x32_bf16 v[0:3], v[236:239], v[192:195], v[0:3]
ds_read_b64 v[232:233], v245 offset:4608
ds_read_b64 v[234:235], v246 offset:4608
v_xor_b32 v244, 16, v244
ds_read_b128 v[204:207], v244
ds_read_u16_d16_hi v139, v139
v_exp_f16_sdwa v153, v154 dst_sel:WORD_1 dst_unused:UNUSED_PRESERVE src0_sel:WORD_1
v_bfe_u32 v140, v141, 2, 14
s_waitcnt lgkmcnt(9)
v_mfma_f32_32x32x16_bf16 v[120:135], v[60:63], v[216:219], v[120:135]
ds_read_b128 v[236:239], v249 offset:11264
ds_read_u16_d16 v140, v140
v_exp_f16_sdwa v150, v151 dst_sel:WORD_1 dst_unused:UNUSED_PRESERVE src0_sel:WORD_1
v_bfe_u32 v142, v143, 2, 14
v_exp_f16_sdwa v147, v148 dst_sel:WORD_1 dst_unused:UNUSED_PRESERVE src0_sel:WORD_1
v_lshrrev_b32_e64 v141, 18, v141
v_exp_f16_sdwa v144, v145 dst_sel:WORD_1 dst_unused:UNUSED_PRESERVE src0_sel:WORD_1
v_mfma_f32_16x16x32_bf16 v[16:19], v[220:223], v[196:199], v[16:19]
ds_read_b64 v[216:217], v245 offset:5376
ds_read_b64 v[218:219], v246 offset:5376
ds_read_b128 v[208:211], v244 offset:64
ds_read_u16_d16 v142, v142
ds_read_u16_d16_hi v141, v141
v_lshrrev_b32_e64 v143, 18, v143
v_pk_add_f16 v153, v153, 1.0 op_sel_hi:[1,0]
v_pk_add_f16 v150, v150, 1.0 op_sel_hi:[1,0]
v_pk_add_f16 v147, v147, 1.0 op_sel_hi:[1,0]
v_mfma_f32_32x32x16_bf16 v[120:135], v[64:67], v[224:227], v[120:135]
ds_read_b64 v[220:221], v245 offset:6144
ds_read_b64 v[222:223], v246 offset:6144
ds_read_b128 v[212:215], v244 offset:128
ds_read_u16_d16_hi v143, v143
v_pk_add_f16 v144, v144, 1.0 op_sel_hi:[1,0]
v_rcp_f16 v154, v153
v_rcp_f16 v151, v150
v_rcp_f16 v148, v147
s_waitcnt lgkmcnt(9)
v_mfma_f32_16x16x32_bf16 v[32:35], v[228:231], v[200:203], v[32:35]
ds_read_b128 v[224:227], v249 offset:12288
v_rcp_f16 v145, v144
v_mfma_f32_16x16x32_bf16 v[0:3], v[232:235], v[204:207], v[0:3]
ds_read_b128 v[228:231], v249 offset:15360
v_rcp_f16_sdwa v154, v153 dst_sel:WORD_1 dst_unused:UNUSED_PRESERVE src0_sel:WORD_1
v_rcp_f16_sdwa v151, v150 dst_sel:WORD_1 dst_unused:UNUSED_PRESERVE src0_sel:WORD_1
v_mfma_f32_32x32x16_bf16 v[120:135], v[68:71], v[236:239], v[120:135]
ds_read_b128 v[232:235], v249 offset:13312
v_rcp_f16_sdwa v148, v147 dst_sel:WORD_1 dst_unused:UNUSED_PRESERVE src0_sel:WORD_1
v_fma_mix_f32 v164, v136, v136, 0 op_sel:[0,0,0] op_sel_hi:[1,1,0]
v_rcp_f16_sdwa v145, v144 dst_sel:WORD_1 dst_unused:UNUSED_PRESERVE src0_sel:WORD_1
v_fma_mix_f32 v164, v137, v137, v164 op_sel:[1,1,0] op_sel_hi:[1,1,0]
v_pk_mul_f16 v155, v155, v154
v_fma_mix_f32 v164, v138, v138, v164 op_sel:[0,0,0] op_sel_hi:[1,1,0]
s_waitcnt lgkmcnt(7)
v_mfma_f32_16x16x32_bf16 v[16:19], v[216:219], v[208:211], v[16:19]
ds_read_b128 v[236:239], v249 offset:16384
v_pk_mul_f16 v152, v152, v151
v_pk_mul_f16 v149, v149, v148
v_fma_mix_f32 v164, v139, v139, v164 op_sel:[1,1,0] op_sel_hi:[1,1,0]
v_pk_mul_f16 v146, v146, v145
s_waitcnt lgkmcnt(4)
v_mfma_f32_16x16x32_bf16 v[32:35], v[220:223], v[212:215], v[32:35]
ds_read_b128 v[216:219], v249 offset:14336
v_fma_mix_f32 v164, v155, v155, v164 op_sel:[0,0,0] op_sel_hi:[1,1,0]
v_fma_mix_f32 v164, v140, v140, v164 op_sel:[0,0,0] op_sel_hi:[1,1,0]
v_fma_mix_f32 v164, v155, v155, v164 op_sel:[1,1,0] op_sel_hi:[1,1,0]
v_fma_mix_f32 v164, v152, v152, v164 op_sel:[0,0,0] op_sel_hi:[1,1,0]
v_fma_mix_f32 v164, v141, v141, v164 op_sel:[1,1,0] op_sel_hi:[1,1,0]
v_fma_mix_f32 v164, v152, v152, v164 op_sel:[1,1,0] op_sel_hi:[1,1,0]
v_fma_mix_f32 v164, v149, v149, v164 op_sel:[0,0,0] op_sel_hi:[1,1,0]
v_fma_mix_f32 v164, v142, v142, v164 op_sel:[0,0,0] op_sel_hi:[1,1,0]
v_fma_mix_f32 v164, v149, v149, v164 op_sel:[1,1,0] op_sel_hi:[1,1,0]
v_fma_mix_f32 v164, v146, v146, v164 op_sel:[0,0,0] op_sel_hi:[1,1,0]
v_fma_mix_f32 v164, v143, v143, v164 op_sel:[1,1,0] op_sel_hi:[1,1,0]
v_fma_mix_f32 v164, v146, v146, v164 op_sel:[1,1,0] op_sel_hi:[1,1,0]
s_setprio 3
v_pk_add_f32 v[168:169], v[0:1], v[2:3]
v_pk_mul_f32 v[170:171], v[0:1], v[0:1]
v_pk_fma_f32 v[170:171], v[2:3], v[2:3], v[170:171]
v_pk_add_f32 v[168:169], v[168:169], v[4:5]
v_pk_fma_f32 v[170:171], v[4:5], v[4:5], v[170:171]
v_pk_add_f32 v[168:169], v[168:169], v[6:7]
v_pk_fma_f32 v[170:171], v[6:7], v[6:7], v[170:171]
v_pk_add_f32 v[168:169], v[168:169], v[8:9]
v_pk_fma_f32 v[170:171], v[8:9], v[8:9], v[170:171]
v_pk_add_f32 v[168:169], v[168:169], v[10:11]
v_pk_fma_f32 v[170:171], v[10:11], v[10:11], v[170:171]
v_pk_add_f32 v[168:169], v[168:169], v[12:13]
v_pk_fma_f32 v[170:171], v[12:13], v[12:13], v[170:171]
v_pk_add_f32 v[168:169], v[168:169], v[14:15]
v_pk_fma_f32 v[170:171], v[14:15], v[14:15], v[170:171]
v_pk_add_f32 v[168:169], v[168:169], v[16:17]
v_pk_fma_f32 v[170:171], v[16:17], v[16:17], v[170:171]
v_pk_add_f32 v[168:169], v[168:169], v[18:19]
v_pk_fma_f32 v[170:171], v[18:19], v[18:19], v[170:171]
v_pk_add_f32 v[168:169], v[168:169], v[20:21]
v_pk_fma_f32 v[170:171], v[20:21], v[20:21], v[170:171]
v_pk_add_f32 v[168:169], v[168:169], v[22:23]
v_pk_fma_f32 v[170:171], v[22:23], v[22:23], v[170:171]
v_pk_add_f32 v[168:169], v[168:169], v[24:25]
v_pk_fma_f32 v[170:171], v[24:25], v[24:25], v[170:171]
v_pk_add_f32 v[168:169], v[168:169], v[26:27]
v_pk_fma_f32 v[170:171], v[26:27], v[26:27], v[170:171]
v_pk_add_f32 v[168:169], v[168:169], v[28:29]
v_pk_fma_f32 v[170:171], v[28:29], v[28:29], v[170:171]
v_pk_add_f32 v[168:169], v[168:169], v[30:31]
v_pk_fma_f32 v[170:171], v[30:31], v[30:31], v[170:171]
v_pk_add_f32 v[168:169], v[168:169], v[32:33]
v_pk_fma_f32 v[170:171], v[32:33], v[32:33], v[170:171]
v_pk_add_f32 v[168:169], v[168:169], v[34:35]
v_pk_fma_f32 v[170:171], v[34:35], v[34:35], v[170:171]
v_pk_add_f32 v[168:169], v[168:169], v[36:37]
v_pk_fma_f32 v[170:171], v[36:37], v[36:37], v[170:171]
v_pk_add_f32 v[168:169], v[168:169], v[38:39]
v_pk_fma_f32 v[170:171], v[38:39], v[38:39], v[170:171]
v_pk_add_f32 v[168:169], v[168:169], v[40:41]
v_pk_fma_f32 v[170:171], v[40:41], v[40:41], v[170:171]
v_pk_add_f32 v[168:169], v[168:169], v[42:43]
v_pk_fma_f32 v[170:171], v[42:43], v[42:43], v[170:171]
v_pk_add_f32 v[168:169], v[168:169], v[44:45]
v_pk_fma_f32 v[170:171], v[44:45], v[44:45], v[170:171]
v_pk_add_f32 v[168:169], v[168:169], v[46:47]
v_pk_fma_f32 v[170:171], v[46:47], v[46:47], v[170:171]
s_setprio 0
s_barrier
v_add_u32 v247, -36864, v242
v_subrev_u32 v252, 66560, v247
v_min_u32_e64 v247, v247, v252
v_add_u32 v247, 90112, v247
v_sub_u32 v252, v247, v242
v_add_u32 v242, v252, v242
v_add_u32_e64 v243, v252, v243
v_add_u32 v244, v252, v244
s_setprio 2
v_cvt_pkrtz_f16_f32 v137, v120, v121
v_cvt_pkrtz_f16_f32 v139, v122, v123
v_cvt_pkrtz_f16_f32 v141, v124, v125
v_cvt_pkrtz_f16_f32 v143, v126, v127
v_cvt_pkrtz_f16_f32 v145, v128, v129
v_cvt_pk_f16_f32 v155, v130, v131
v_cvt_pk_f16_f32 v152, v132, v133
v_cvt_pk_f16_f32 v149, v134, v135
s_waitcnt lgkmcnt(0)
s_add_u32 m0, s67, 53248
s_add_u32 s66, s66, 98304
buffer_load_dwordx4 v240, s[4:7], s66 offen lds
ds_read_b128 v[220:223], v249 offset:17408
v_mfma_f32_32x32x16_bf16 v[120:135], v[48:51], v[224:227], 0
v_pk_fma_f16 v154, v155, v155, s48
v_add_f32 v168, v168, v169
v_and_b32_e64 v137, s49, v137
v_pk_fma_f16 v151, v152, v152, s48
v_and_b32_e64 v139, s49, v139
v_pk_fma_f16 v148, v149, v149, s48
v_add_f32_e64 v170, v170, v171
v_pk_mul_f16 v154, v155, v154
v_bfe_u32 v136, v137, 2, 14
v_pk_mul_f16 v151, v152, v151
v_pk_mul_f16 v148, v149, v148
v_bfe_u32 v138, v139, 2, 14
ds_read_b128 v[224:227], v249 offset:18432
ds_read_u16_d16 v136, v136
ds_read_u16_d16 v138, v138
v_mfma_f32_32x32x16_bf16 v[120:135], v[52:55], v[228:231], v[120:135]
v_permlane32_swap_b32 v168, v170
v_exp_f16 v153, v154
v_lshrrev_b32 v137, 18, v137
v_exp_f16 v150, v151
v_add_f32 v168, v168, v170
v_lshrrev_b32 v139, 18, v139
v_exp_f16 v147, v148
v_and_b32 v141, s49, v141
v_and_b32_e64 v143, s49, v143
v_mul_f32 v168, 1009429163, v168
s_add_u32 m0, s67, 59904
s_add_u32 s66, s66, 98304
buffer_load_dwordx4 v240, s[4:7], s66 offen lds
ds_read_b128 v[228:231], v249 offset:21504
ds_read_u16_d16_hi v137, v137
ds_read_u16_d16_hi v139, v139
v_mfma_f32_32x32x16_bf16 v[120:135], v[56:59], v[232:235], v[120:135]
v_exp_f16_sdwa v153, v154 dst_sel:WORD_1 dst_unused:UNUSED_PRESERVE src0_sel:WORD_1
v_bfe_u32 v140, v141, 2, 14
v_exp_f16_sdwa v150, v151 dst_sel:WORD_1 dst_unused:UNUSED_PRESERVE src0_sel:WORD_1
v_mov_b32_e64 v170, v168
v_bfe_u32 v142, v143, 2, 14
v_exp_f16_sdwa v147, v148 dst_sel:WORD_1 dst_unused:UNUSED_PRESERVE src0_sel:WORD_1
v_lshrrev_b32 v141, 18, v141
v_permlane32_swap_b32 v168, v170
v_pk_add_f16 v153, v153, 1.0 op_sel_hi:[1,0]
ds_read_b128 v[232:235], v249 offset:19456
ds_read_u16_d16 v140, v140
ds_read_u16_d16 v142, v142
ds_read_u16_d16_hi v141, v141
v_mfma_f32_32x32x16_bf16 v[120:135], v[60:63], v[236:239], v[120:135]
v_lshrrev_b32_e64 v143, 18, v143
v_pk_add_f16 v150, v150, 1.0 op_sel_hi:[1,0]
v_pk_add_f16 v147, v147, 1.0 op_sel_hi:[1,0]
v_and_b32_e64 v145, s49, v145
v_fma_f32 v170, -v168, v168, v170
v_rcp_f16_e64 v154, v153
v_bfe_u32 v144, v145, 2, 14
v_rcp_f16 v151, v150
v_max_f32 v170, 0, v170
v_lshrrev_b32 v145, 18, v145
s_add_u32 m0, s67, 0
s_add_u32 s66, s66, 98304
buffer_load_dwordx4 v240, s[4:7], s66 offen lds
ds_read_b128 v[236:239], v249 offset:22528
ds_read_u16_d16_hi v143, v143
ds_read_u16_d16 v144, v144
ds_read_u16_d16_hi v145, v145
v_mfma_f32_32x32x16_bf16 v[120:135], v[64:67], v[216:219], v[120:135]
v_rcp_f16 v148, v147
v_rcp_f16_sdwa v154, v153 dst_sel:WORD_1 dst_unused:UNUSED_PRESERVE src0_sel:WORD_1
v_add_f32 v170, 925353388, v170
s_waitcnt lgkmcnt(6)
v_fma_mix_f32 v165, v136, v136, 0 op_sel:[0,0,0] op_sel_hi:[1,1,0]
v_fma_mix_f32 v165, v137, v137, v165 op_sel:[1,1,0] op_sel_hi:[1,1,0]
v_rcp_f16_sdwa v151, v150 dst_sel:WORD_1 dst_unused:UNUSED_PRESERVE src0_sel:WORD_1
v_rsq_f32_e64 v170, v170
v_fma_mix_f32 v165, v138, v138, v165 op_sel:[0,0,0] op_sel_hi:[1,1,0]
ds_read_b128 v[216:219], v249 offset:20480
v_mfma_f32_32x32x16_bf16 v[120:135], v[68:71], v[220:223], v[120:135]
v_rcp_f16_sdwa v148, v147 dst_sel:WORD_1 dst_unused:UNUSED_PRESERVE src0_sel:WORD_1
v_fma_mix_f32 v165, v139, v139, v165 op_sel:[1,1,0] op_sel_hi:[1,1,0]
v_pk_mul_f16 v155, v155, v154
v_fma_mix_f32 v165, v140, v140, v165 op_sel:[0,0,0] op_sel_hi:[1,1,0]
v_pk_mul_f16 v152, v152, v151
s_waitcnt lgkmcnt(5)
v_fma_mix_f32 v165, v141, v141, v165 op_sel:[1,1,0] op_sel_hi:[1,1,0]
v_pk_mul_f16 v149, v149, v148
v_fma_mix_f32 v165, v155, v155, v165 op_sel:[0,0,0] op_sel_hi:[1,1,0]
v_mul_f32 v172, 3203391086, v170
v_fma_mix_f32 v165, v142, v142, v165 op_sel:[0,0,0] op_sel_hi:[1,1,0]
v_fma_mix_f32 v165, v155, v155, v165 op_sel:[1,1,0] op_sel_hi:[1,1,0]
s_waitcnt lgkmcnt(1)
v_fma_mix_f32 v165, v143, v143, v165 op_sel:[1,1,0] op_sel_hi:[1,1,0]
v_fma_mix_f32 v165, v152, v152, v165 op_sel:[0,0,0] op_sel_hi:[1,1,0]
v_fma_mix_f32 v165, v152, v152, v165 op_sel:[1,1,0] op_sel_hi:[1,1,0]
v_mul_f32 v173, v168, v172
v_fma_mix_f32 v165, v144, v144, v165 op_sel:[0,0,0] op_sel_hi:[1,1,0]
v_fma_mix_f32 v165, v149, v149, v165 op_sel:[0,0,0] op_sel_hi:[1,1,0]
v_fma_mix_f32 v165, v145, v145, v165 op_sel:[1,1,0] op_sel_hi:[1,1,0]
v_fma_mix_f32 v165, v149, v149, v165 op_sel:[1,1,0] op_sel_hi:[1,1,0]
s_setprio 3
v_pk_fma_f32 v[0:1], v[0:1], v[172:173], v[172:173] op_sel:[0,0,1] op_sel_hi:[1,0,1] neg_lo:[0,0,1] neg_hi:[0,0,1]
v_pk_fma_f32 v[2:3], v[2:3], v[172:173], v[172:173] op_sel:[0,0,1] op_sel_hi:[1,0,1] neg_lo:[0,0,1] neg_hi:[0,0,1]
v_pk_fma_f32 v[4:5], v[4:5], v[172:173], v[172:173] op_sel:[0,0,1] op_sel_hi:[1,0,1] neg_lo:[0,0,1] neg_hi:[0,0,1]
v_pk_fma_f32 v[6:7], v[6:7], v[172:173], v[172:173] op_sel:[0,0,1] op_sel_hi:[1,0,1] neg_lo:[0,0,1] neg_hi:[0,0,1]
v_pk_fma_f32 v[8:9], v[8:9], v[172:173], v[172:173] op_sel:[0,0,1] op_sel_hi:[1,0,1] neg_lo:[0,0,1] neg_hi:[0,0,1]
v_pk_fma_f32 v[10:11], v[10:11], v[172:173], v[172:173] op_sel:[0,0,1] op_sel_hi:[1,0,1] neg_lo:[0,0,1] neg_hi:[0,0,1]
v_pk_fma_f32 v[12:13], v[12:13], v[172:173], v[172:173] op_sel:[0,0,1] op_sel_hi:[1,0,1] neg_lo:[0,0,1] neg_hi:[0,0,1]
v_pk_fma_f32 v[14:15], v[14:15], v[172:173], v[172:173] op_sel:[0,0,1] op_sel_hi:[1,0,1] neg_lo:[0,0,1] neg_hi:[0,0,1]
v_pk_fma_f32 v[16:17], v[16:17], v[172:173], v[172:173] op_sel:[0,0,1] op_sel_hi:[1,0,1] neg_lo:[0,0,1] neg_hi:[0,0,1]
v_pk_fma_f32 v[18:19], v[18:19], v[172:173], v[172:173] op_sel:[0,0,1] op_sel_hi:[1,0,1] neg_lo:[0,0,1] neg_hi:[0,0,1]
v_pk_fma_f32 v[20:21], v[20:21], v[172:173], v[172:173] op_sel:[0,0,1] op_sel_hi:[1,0,1] neg_lo:[0,0,1] neg_hi:[0,0,1]
v_pk_fma_f32 v[22:23], v[22:23], v[172:173], v[172:173] op_sel:[0,0,1] op_sel_hi:[1,0,1] neg_lo:[0,0,1] neg_hi:[0,0,1]
v_pk_fma_f32 v[24:25], v[24:25], v[172:173], v[172:173] op_sel:[0,0,1] op_sel_hi:[1,0,1] neg_lo:[0,0,1] neg_hi:[0,0,1]
v_pk_fma_f32 v[26:27], v[26:27], v[172:173], v[172:173] op_sel:[0,0,1] op_sel_hi:[1,0,1] neg_lo:[0,0,1] neg_hi:[0,0,1]
v_pk_fma_f32 v[28:29], v[28:29], v[172:173], v[172:173] op_sel:[0,0,1] op_sel_hi:[1,0,1] neg_lo:[0,0,1] neg_hi:[0,0,1]
v_pk_fma_f32 v[30:31], v[30:31], v[172:173], v[172:173] op_sel:[0,0,1] op_sel_hi:[1,0,1] neg_lo:[0,0,1] neg_hi:[0,0,1]
v_pk_fma_f32 v[32:33], v[32:33], v[172:173], v[172:173] op_sel:[0,0,1] op_sel_hi:[1,0,1] neg_lo:[0,0,1] neg_hi:[0,0,1]
v_pk_fma_f32 v[34:35], v[34:35], v[172:173], v[172:173] op_sel:[0,0,1] op_sel_hi:[1,0,1] neg_lo:[0,0,1] neg_hi:[0,0,1]
v_pk_fma_f32 v[36:37], v[36:37], v[172:173], v[172:173] op_sel:[0,0,1] op_sel_hi:[1,0,1] neg_lo:[0,0,1] neg_hi:[0,0,1]
v_pk_fma_f32 v[38:39], v[38:39], v[172:173], v[172:173] op_sel:[0,0,1] op_sel_hi:[1,0,1] neg_lo:[0,0,1] neg_hi:[0,0,1]
v_pk_fma_f32 v[40:41], v[40:41], v[172:173], v[172:173] op_sel:[0,0,1] op_sel_hi:[1,0,1] neg_lo:[0,0,1] neg_hi:[0,0,1]
v_pk_fma_f32 v[42:43], v[42:43], v[172:173], v[172:173] op_sel:[0,0,1] op_sel_hi:[1,0,1] neg_lo:[0,0,1] neg_hi:[0,0,1]
v_pk_fma_f32 v[44:45], v[44:45], v[172:173], v[172:173] op_sel:[0,0,1] op_sel_hi:[1,0,1] neg_lo:[0,0,1] neg_hi:[0,0,1]
v_pk_fma_f32 v[46:47], v[46:47], v[172:173], v[172:173] op_sel:[0,0,1] op_sel_hi:[1,0,1] neg_lo:[0,0,1] neg_hi:[0,0,1]
s_setprio 2
v_cvt_pkrtz_f16_f32 v137, v120, v121
v_cvt_pkrtz_f16_f32 v139, v122, v123
v_cvt_pkrtz_f16_f32 v141, v124, v125
v_cvt_pkrtz_f16_f32 v143, v126, v127
v_cvt_pkrtz_f16_f32 v145, v128, v129
v_cvt_pk_f16_f32 v155, v130, v131
v_cvt_pk_f16_f32 v152, v132, v133
v_cvt_pk_f16_f32 v149, v134, v135
s_add_u32 m0, s67, 6656
s_add_u32 s66, s66, 98304
buffer_load_dwordx4 v240, s[4:7], s66 offen lds
ds_read_b128 v[220:223], v249 offset:23552
v_mfma_f32_32x32x16_bf16 v[120:135], v[48:51], v[224:227], 0
v_pk_fma_f16 v154, v155, v155, s48
v_cvt_pk_bf16_f32 v72, v0, v1
v_and_b32 v137, s49, v137
v_pk_fma_f16 v151, v152, v152, s48
v_cvt_pk_bf16_f32 v73, v2, v3
v_and_b32_e64 v139, s49, v139
v_pk_fma_f16 v148, v149, v149, s48
v_pk_mul_f16 v154, v155, v154
v_cvt_pk_bf16_f32 v74, v4, v5
v_bfe_u32 v136, v137, 2, 14
v_pk_mul_f16 v151, v152, v151
v_pk_mul_f16 v148, v149, v148
v_cvt_pk_bf16_f32 v75, v6, v7
v_bfe_u32 v138, v139, 2, 14
ds_read_b128 v[224:227], v248 offset:16384
ds_read_u16_d16 v136, v136
ds_read_u16_d16 v138, v138
v_mfma_f32_32x32x16_bf16 v[120:135], v[52:55], v[228:231], v[120:135]
v_exp_f16_e64 v153, v154
v_cvt_pk_bf16_f32 v76, v8, v9
v_lshrrev_b32 v137, 18, v137
v_exp_f16 v150, v151
v_cvt_pk_bf16_f32 v77, v10, v11
v_lshrrev_b32 v139, 18, v139
v_exp_f16 v147, v148
v_cvt_pk_bf16_f32 v78, v12, v13
v_and_b32 v141, s49, v141
v_and_b32 v143, s49, v143
v_cvt_pk_bf16_f32 v79, v14, v15
s_add_u32 m0, s67, 13312
s_add_u32 s66, s66, 98304
buffer_load_dwordx4 v240, s[4:7], s66 offen lds
ds_read_b128 v[228:231], v248 offset:19456
ds_read_u16_d16_hi v137, v137
ds_read_u16_d16_hi v139, v139
v_mfma_f32_32x32x16_bf16 v[120:135], v[56:59], v[232:235], v[120:135]
v_exp_f16_sdwa v153, v154 dst_sel:WORD_1 dst_unused:UNUSED_PRESERVE src0_sel:WORD_1
v_bfe_u32 v140, v141, 2, 14
v_cvt_pk_bf16_f32 v80, v16, v17
v_exp_f16_sdwa v150, v151 dst_sel:WORD_1 dst_unused:UNUSED_PRESERVE src0_sel:WORD_1
v_bfe_u32 v142, v143, 2, 14
v_cvt_pk_bf16_f32 v81, v18, v19
v_exp_f16_sdwa v147, v148 dst_sel:WORD_1 dst_unused:UNUSED_PRESERVE src0_sel:WORD_1
v_cvt_pk_bf16_f32 v82, v20, v21
v_lshrrev_b32_e64 v141, 18, v141
v_pk_add_f16 v153, v153, 1.0 op_sel_hi:[1,0]
v_lshrrev_b32_e64 v143, 18, v143
ds_read_b128 v[232:235], v248 offset:17408
ds_read_u16_d16 v140, v140
ds_read_u16_d16 v142, v142
ds_read_u16_d16_hi v141, v141
ds_read_u16_d16_hi v143, v143
v_mfma_f32_32x32x16_bf16 v[120:135], v[60:63], v[236:239], v[120:135]
v_cvt_pk_bf16_f32 v83, v22, v23
v_pk_add_f16 v150, v150, 1.0 op_sel_hi:[1,0]
v_pk_add_f16 v147, v147, 1.0 op_sel_hi:[1,0]
v_and_b32_e64 v145, s49, v145
v_cvt_pk_bf16_f32 v84, v24, v25
v_rcp_f16_e64 v154, v153
v_bfe_u32 v144, v145, 2, 14
v_cvt_pk_bf16_f32 v85, v26, v27
v_rcp_f16_e64 v151, v150
v_lshrrev_b32 v145, 18, v145
v_cvt_pk_bf16_f32 v86, v28, v29
s_waitcnt lgkmcnt(5)
s_add_u32 m0, s67, 19968
s_add_u32 s66, s66, 98304
buffer_load_dwordx4 v240, s[4:7], s66 offen lds
ds_read_b128 v[236:239], v248 offset:20480
ds_read_u16_d16 v144, v144
ds_read_u16_d16_hi v145, v145
v_mfma_f32_32x32x16_bf16 v[120:135], v[64:67], v[216:219], v[120:135]
v_rcp_f16_e64 v148, v147
v_cvt_pk_bf16_f32 v87, v30, v31
v_rcp_f16_sdwa v154, v153 dst_sel:WORD_1 dst_unused:UNUSED_PRESERVE src0_sel:WORD_1
v_fma_mix_f32 v166, v136, v136, 0 op_sel:[0,0,0] op_sel_hi:[1,1,0]
v_cvt_pk_bf16_f32 v88, v32, v33
v_fma_mix_f32 v166, v137, v137, v166 op_sel:[1,1,0] op_sel_hi:[1,1,0]
v_rcp_f16_sdwa v151, v150 dst_sel:WORD_1 dst_unused:UNUSED_PRESERVE src0_sel:WORD_1
v_cvt_pk_bf16_f32 v89, v34, v35
v_fma_mix_f32 v166, v138, v138, v166 op_sel:[0,0,0] op_sel_hi:[1,1,0]
v_rcp_f16_sdwa v148, v147 dst_sel:WORD_1 dst_unused:UNUSED_PRESERVE src0_sel:WORD_1
v_cvt_pk_bf16_f32 v90, v36, v37
ds_read_b128 v[216:219], v248 offset:18432
v_mfma_f32_32x32x16_bf16 v[120:135], v[68:71], v[220:223], v[120:135]
v_fma_mix_f32 v166, v139, v139, v166 op_sel:[1,1,0] op_sel_hi:[1,1,0]
v_pk_mul_f16 v155, v155, v154
s_waitcnt lgkmcnt(4)
v_fma_mix_f32 v166, v140, v140, v166 op_sel:[0,0,0] op_sel_hi:[1,1,0]
v_cvt_pk_bf16_f32 v91, v38, v39
v_pk_mul_f16 v152, v152, v151
v_fma_mix_f32 v166, v141, v141, v166 op_sel:[1,1,0] op_sel_hi:[1,1,0]
v_cvt_pk_bf16_f32 v92, v40, v41
v_pk_mul_f16 v149, v149, v148
v_fma_mix_f32 v166, v155, v155, v166 op_sel:[0,0,0] op_sel_hi:[1,1,0]
v_fma_mix_f32 v166, v142, v142, v166 op_sel:[0,0,0] op_sel_hi:[1,1,0]
v_cvt_pk_bf16_f32 v93, v42, v43
v_fma_mix_f32 v166, v155, v155, v166 op_sel:[1,1,0] op_sel_hi:[1,1,0]
v_fma_mix_f32 v166, v143, v143, v166 op_sel:[1,1,0] op_sel_hi:[1,1,0]
v_fma_mix_f32 v166, v152, v152, v166 op_sel:[0,0,0] op_sel_hi:[1,1,0]
v_cvt_pk_bf16_f32 v94, v44, v45
v_fma_mix_f32 v166, v152, v152, v166 op_sel:[1,1,0] op_sel_hi:[1,1,0]
s_waitcnt lgkmcnt(1)
v_fma_mix_f32 v166, v144, v144, v166 op_sel:[0,0,0] op_sel_hi:[1,1,0]
v_fma_mix_f32 v166, v149, v149, v166 op_sel:[0,0,0] op_sel_hi:[1,1,0]
v_cvt_pk_bf16_f32 v95, v46, v47
v_fma_mix_f32 v166, v145, v145, v166 op_sel:[1,1,0] op_sel_hi:[1,1,0]
v_fma_mix_f32 v166, v149, v149, v166 op_sel:[1,1,0] op_sel_hi:[1,1,0]
v_cvt_pkrtz_f16_f32 v137, v120, v121
v_cvt_pkrtz_f16_f32 v139, v122, v123
v_cvt_pkrtz_f16_f32 v141, v124, v125
v_cvt_pkrtz_f16_f32 v143, v126, v127
v_cvt_pkrtz_f16_f32 v145, v128, v129
v_cvt_pk_f16_f32 v155, v130, v131
v_cvt_pk_f16_f32 v152, v132, v133
v_cvt_pk_f16_f32 v149, v134, v135
s_add_u32 m0, s67, 26624
s_add_u32 s66, s66, 98304
buffer_load_dwordx4 v240, s[4:7], s66 offen lds
ds_read_b128 v[220:223], v248 offset:21504
v_mfma_f32_32x32x16_bf16 v[120:135], v[72:75], v[224:227], 0
v_pk_fma_f16 v154, v155, v155, s48
v_and_b32_e64 v137, s49, v137
v_pk_fma_f16 v151, v152, v152, s48
v_and_b32_e64 v139, s49, v139
v_pk_fma_f16 v148, v149, v149, s48
v_pk_mul_f16 v154, v155, v154
v_bfe_u32 v136, v137, 2, 14
v_pk_mul_f16 v151, v152, v151
v_pk_mul_f16 v148, v149, v148
v_bfe_u32 v138, v139, 2, 14
ds_read_b128 v[224:227], v248 offset:22528
ds_read_u16_d16 v136, v136
ds_read_u16_d16 v138, v138
v_mfma_f32_32x32x16_bf16 v[120:135], v[76:79], v[228:231], v[120:135]
v_exp_f16 v153, v154
v_lshrrev_b32 v137, 18, v137
v_exp_f16 v150, v151
v_lshrrev_b32 v139, 18, v139
v_exp_f16 v147, v148
v_and_b32 v141, s49, v141
v_and_b32_e64 v143, s49, v143
ds_read_b128 v[228:231], v248 offset:25600
ds_read_u16_d16_hi v137, v137
ds_read_u16_d16_hi v139, v139
v_mfma_f32_32x32x16_bf16 v[120:135], v[80:83], v[232:235], v[120:135]
v_exp_f16_sdwa v153, v154 dst_sel:WORD_1 dst_unused:UNUSED_PRESERVE src0_sel:WORD_1
v_bfe_u32 v140, v141, 2, 14
v_exp_f16_sdwa v150, v151 dst_sel:WORD_1 dst_unused:UNUSED_PRESERVE src0_sel:WORD_1
v_bfe_u32 v142, v143, 2, 14
v_exp_f16_sdwa v147, v148 dst_sel:WORD_1 dst_unused:UNUSED_PRESERVE src0_sel:WORD_1
v_lshrrev_b32_e64 v141, 18, v141
v_pk_add_f16 v153, v153, 1.0 op_sel_hi:[1,0]
s_add_u32 m0, s67, 33280
s_add_u32 s66, s66, 98304
buffer_load_dwordx4 v240, s[4:7], s66 offen lds
ds_read_b128 v[232:235], v248 offset:23552
ds_read_u16_d16 v140, v140
ds_read_u16_d16 v142, v142
ds_read_u16_d16_hi v141, v141
v_mfma_f32_32x32x16_bf16 v[120:135], v[84:87], v[236:239], v[120:135]
v_lshrrev_b32_e64 v143, 18, v143
v_pk_add_f16 v150, v150, 1.0 op_sel_hi:[1,0]
v_pk_add_f16 v147, v147, 1.0 op_sel_hi:[1,0]
v_and_b32 v145, s49, v145
v_rcp_f16 v154, v153
v_bfe_u32 v144, v145, 2, 14
v_rcp_f16_e64 v151, v150
v_lshrrev_b32 v145, 18, v145
s_waitcnt lgkmcnt(4)
ds_read_b128 v[236:239], v248 offset:26624
ds_read_u16_d16_hi v143, v143
ds_read_u16_d16 v144, v144
ds_read_u16_d16_hi v145, v145
v_mfma_f32_32x32x16_bf16 v[120:135], v[88:91], v[216:219], v[120:135]
v_rcp_f16_e64 v148, v147
v_rcp_f16_sdwa v154, v153 dst_sel:WORD_1 dst_unused:UNUSED_PRESERVE src0_sel:WORD_1
v_fma_mix_f32 v167, v136, v136, 0 op_sel:[0,0,0] op_sel_hi:[1,1,0]
v_fma_mix_f32 v167, v137, v137, v167 op_sel:[1,1,0] op_sel_hi:[1,1,0]
v_rcp_f16_sdwa v151, v150 dst_sel:WORD_1 dst_unused:UNUSED_PRESERVE src0_sel:WORD_1
v_fma_mix_f32 v167, v138, v138, v167 op_sel:[0,0,0] op_sel_hi:[1,1,0]
s_setprio 1
ds_read_b128 v[216:219], v248 offset:24576
v_mfma_f32_32x32x16_bf16 v[120:135], v[92:95], v[220:223], v[120:135]
v_rcp_f16_sdwa v148, v147 dst_sel:WORD_1 dst_unused:UNUSED_PRESERVE src0_sel:WORD_1
v_fma_mix_f32 v167, v139, v139, v167 op_sel:[1,1,0] op_sel_hi:[1,1,0]
v_pk_mul_f16 v155, v155, v154
s_waitcnt lgkmcnt(5)
v_fma_mix_f32 v167, v140, v140, v167 op_sel:[0,0,0] op_sel_hi:[1,1,0]
v_pk_mul_f16 v152, v152, v151
v_fma_mix_f32 v167, v141, v141, v167 op_sel:[1,1,0] op_sel_hi:[1,1,0]
v_pk_mul_f16 v149, v149, v148
v_fma_mix_f32 v167, v155, v155, v167 op_sel:[0,0,0] op_sel_hi:[1,1,0]
v_fma_mix_f32 v167, v142, v142, v167 op_sel:[0,0,0] op_sel_hi:[1,1,0]
v_fma_mix_f32 v167, v155, v155, v167 op_sel:[1,1,0] op_sel_hi:[1,1,0]
s_waitcnt lgkmcnt(3)
v_fma_mix_f32 v167, v143, v143, v167 op_sel:[1,1,0] op_sel_hi:[1,1,0]
v_fma_mix_f32 v167, v152, v152, v167 op_sel:[0,0,0] op_sel_hi:[1,1,0]
v_fma_mix_f32 v167, v152, v152, v167 op_sel:[1,1,0] op_sel_hi:[1,1,0]
s_waitcnt lgkmcnt(1)
v_fma_mix_f32 v167, v144, v144, v167 op_sel:[0,0,0] op_sel_hi:[1,1,0]
v_fma_mix_f32 v167, v149, v149, v167 op_sel:[0,0,0] op_sel_hi:[1,1,0]
v_fma_mix_f32 v167, v145, v145, v167 op_sel:[1,1,0] op_sel_hi:[1,1,0]
v_fma_mix_f32 v167, v149, v149, v167 op_sel:[1,1,0] op_sel_hi:[1,1,0]
v_cvt_pkrtz_f16_f32 v137, v120, v121
v_cvt_pkrtz_f16_f32 v139, v122, v123
v_cvt_pkrtz_f16_f32 v141, v124, v125
v_cvt_pkrtz_f16_f32 v143, v126, v127
v_cvt_pkrtz_f16_f32 v145, v128, v129
v_cvt_pk_f16_f32 v155, v130, v131
v_cvt_pk_f16_f32 v152, v132, v133
v_cvt_pk_f16_f32 v149, v134, v135
ds_read_b128 v[220:223], v248 offset:27648
v_mfma_f32_32x32x16_bf16 v[120:135], v[72:75], v[224:227], 0
v_pk_fma_f16 v154, v155, v155, s48
v_and_b32_e64 v137, s49, v137
v_pk_fma_f16 v151, v152, v152, s48
v_and_b32_e64 v139, s49, v139
v_pk_fma_f16 v148, v149, v149, s48
v_pk_mul_f16 v154, v155, v154
v_bfe_u32 v136, v137, 2, 14
v_pk_mul_f16 v151, v152, v151
v_pk_mul_f16 v148, v149, v148
v_bfe_u32 v138, v139, 2, 14
ds_read_b128 v[224:227], v248 offset:28672
ds_read_u16_d16 v136, v136
ds_read_u16_d16 v138, v138
v_mfma_f32_32x32x16_bf16 v[120:135], v[76:79], v[228:231], v[120:135]
v_exp_f16 v153, v154
v_lshrrev_b32 v137, 18, v137
v_exp_f16 v150, v151
v_lshrrev_b32 v139, 18, v139
v_exp_f16 v147, v148
v_and_b32 v141, s49, v141
v_and_b32_e64 v143, s49, v143
ds_read_b128 v[228:231], v248 offset:31744
ds_read_u16_d16_hi v137, v137
ds_read_u16_d16_hi v139, v139
v_mfma_f32_32x32x16_bf16 v[120:135], v[80:83], v[232:235], v[120:135]
v_exp_f16_sdwa v153, v154 dst_sel:WORD_1 dst_unused:UNUSED_PRESERVE src0_sel:WORD_1
v_bfe_u32 v140, v141, 2, 14
v_exp_f16_sdwa v150, v151 dst_sel:WORD_1 dst_unused:UNUSED_PRESERVE src0_sel:WORD_1
v_bfe_u32 v142, v143, 2, 14
v_exp_f16_sdwa v147, v148 dst_sel:WORD_1 dst_unused:UNUSED_PRESERVE src0_sel:WORD_1
v_lshrrev_b32_e64 v141, 18, v141
v_pk_add_f16 v153, v153, 1.0 op_sel_hi:[1,0]
ds_read_b128 v[232:235], v248 offset:29696
ds_read_u16_d16 v140, v140
ds_read_u16_d16 v142, v142
ds_read_u16_d16_hi v141, v141
v_mfma_f32_32x32x16_bf16 v[120:135], v[84:87], v[236:239], v[120:135]
v_lshrrev_b32_e64 v143, 18, v143
v_pk_add_f16 v150, v150, 1.0 op_sel_hi:[1,0]
v_pk_add_f16 v147, v147, 1.0 op_sel_hi:[1,0]
v_and_b32 v145, s49, v145
v_rcp_f16 v154, v153
v_bfe_u32 v144, v145, 2, 14
v_rcp_f16_e64 v151, v150
v_lshrrev_b32 v145, 18, v145
s_waitcnt lgkmcnt(7)
ds_read_b128 v[236:239], v248 offset:32768
ds_read_u16_d16_hi v143, v143
ds_read_u16_d16 v144, v144
ds_read_u16_d16_hi v145, v145
v_mfma_f32_32x32x16_bf16 v[120:135], v[88:91], v[216:219], v[120:135]
v_rcp_f16_e64 v148, v147
v_rcp_f16_sdwa v154, v153 dst_sel:WORD_1 dst_unused:UNUSED_PRESERVE src0_sel:WORD_1
v_fma_mix_f32 v156, v136, v136, v156 op_sel:[0,0,0] op_sel_hi:[1,1,0]
s_waitcnt lgkmcnt(8)
v_fma_mix_f32 v156, v137, v137, v156 op_sel:[1,1,0] op_sel_hi:[1,1,0]
v_rcp_f16_sdwa v151, v150 dst_sel:WORD_1 dst_unused:UNUSED_PRESERVE src0_sel:WORD_1
v_fma_mix_f32 v156, v138, v138, v156 op_sel:[0,0,0] op_sel_hi:[1,1,0]
ds_read_b128 v[216:219], v248 offset:30720
v_mfma_f32_32x32x16_bf16 v[120:135], v[92:95], v[220:223], v[120:135]
v_rcp_f16_sdwa v148, v147 dst_sel:WORD_1 dst_unused:UNUSED_PRESERVE src0_sel:WORD_1
v_fma_mix_f32 v156, v139, v139, v156 op_sel:[1,1,0] op_sel_hi:[1,1,0]
v_pk_mul_f16 v155, v155, v154
s_waitcnt lgkmcnt(5)
v_fma_mix_f32 v156, v140, v140, v156 op_sel:[0,0,0] op_sel_hi:[1,1,0]
v_pk_mul_f16 v152, v152, v151
v_fma_mix_f32 v156, v141, v141, v156 op_sel:[1,1,0] op_sel_hi:[1,1,0]
v_pk_mul_f16 v149, v149, v148
v_fma_mix_f32 v156, v155, v155, v156 op_sel:[0,0,0] op_sel_hi:[1,1,0]
v_fma_mix_f32 v156, v142, v142, v156 op_sel:[0,0,0] op_sel_hi:[1,1,0]
v_fma_mix_f32 v156, v155, v155, v156 op_sel:[1,1,0] op_sel_hi:[1,1,0]
s_waitcnt lgkmcnt(3)
v_fma_mix_f32 v156, v143, v143, v156 op_sel:[1,1,0] op_sel_hi:[1,1,0]
v_fma_mix_f32 v156, v152, v152, v156 op_sel:[0,0,0] op_sel_hi:[1,1,0]
v_fma_mix_f32 v156, v152, v152, v156 op_sel:[1,1,0] op_sel_hi:[1,1,0]
s_waitcnt lgkmcnt(1)
v_fma_mix_f32 v156, v144, v144, v156 op_sel:[0,0,0] op_sel_hi:[1,1,0]
v_fma_mix_f32 v156, v149, v149, v156 op_sel:[0,0,0] op_sel_hi:[1,1,0]
v_fma_mix_f32 v156, v145, v145, v156 op_sel:[1,1,0] op_sel_hi:[1,1,0]
v_fma_mix_f32 v156, v149, v149, v156 op_sel:[1,1,0] op_sel_hi:[1,1,0]
v_and_b32 v247, 31, v251
v_min_u32 v247, 23, v247
v_lshlrev_b32 v247, 7, v247
v_lshrrev_b32 v252, 5, v251
v_mul_u32_u24 v252, 98304, v252
v_add_u32 v247, v247, v252
s_mov_b32 m0, 163840
s_nop 0
buffer_load_dword v247, s[4:7], s68 offen lds
v_cvt_pkrtz_f16_f32 v137, v120, v121
v_cvt_pkrtz_f16_f32 v139, v122, v123
v_cvt_pkrtz_f16_f32 v141, v124, v125
v_cvt_pkrtz_f16_f32 v143, v126, v127
v_cvt_pkrtz_f16_f32 v145, v128, v129
v_cvt_pk_f16_f32 v155, v130, v131
v_cvt_pk_f16_f32 v152, v132, v133
v_cvt_pk_f16_f32 v149, v134, v135
s_add_u32 s46, s80, 12582912
buffer_store_dwordx4 v[72:75], v241, s[32:35], s46 offen
ds_read_b128 v[220:223], v248 offset:33792
v_mfma_f32_32x32x16_bf16 v[120:135], v[72:75], v[224:227], 0
v_pk_fma_f16 v154, v155, v155, s48
v_and_b32_e64 v137, s49, v137
v_pk_fma_f16 v151, v152, v152, s48
v_and_b32_e64 v139, s49, v139
v_pk_fma_f16 v148, v149, v149, s48
v_pk_mul_f16 v154, v155, v154
v_bfe_u32 v136, v137, 2, 14
v_pk_mul_f16 v151, v152, v151
v_pk_mul_f16 v148, v149, v148
v_bfe_u32 v138, v139, 2, 14
ds_read_b128 v[224:227], v248 offset:34816
ds_read_u16_d16 v136, v136
ds_read_u16_d16 v138, v138
v_mfma_f32_32x32x16_bf16 v[120:135], v[76:79], v[228:231], v[120:135]
v_exp_f16 v153, v154
v_lshrrev_b32 v137, 18, v137
v_exp_f16 v150, v151
v_lshrrev_b32 v139, 18, v139
v_exp_f16 v147, v148
v_and_b32 v141, s49, v141
v_and_b32_e64 v143, s49, v143
ds_read_b128 v[228:231], v248 offset:37888
ds_read_u16_d16_hi v137, v137
ds_read_u16_d16_hi v139, v139
v_mfma_f32_32x32x16_bf16 v[120:135], v[80:83], v[232:235], v[120:135]
v_exp_f16_sdwa v153, v154 dst_sel:WORD_1 dst_unused:UNUSED_PRESERVE src0_sel:WORD_1
v_bfe_u32 v140, v141, 2, 14
v_exp_f16_sdwa v150, v151 dst_sel:WORD_1 dst_unused:UNUSED_PRESERVE src0_sel:WORD_1
v_bfe_u32 v142, v143, 2, 14
v_exp_f16_sdwa v147, v148 dst_sel:WORD_1 dst_unused:UNUSED_PRESERVE src0_sel:WORD_1
v_lshrrev_b32_e64 v141, 18, v141
v_pk_add_f16 v153, v153, 1.0 op_sel_hi:[1,0]
ds_read_b128 v[232:235], v248 offset:35840
ds_read_u16_d16 v140, v140
ds_read_u16_d16 v142, v142
ds_read_u16_d16_hi v141, v141
v_mfma_f32_32x32x16_bf16 v[120:135], v[84:87], v[236:239], v[120:135]
v_lshrrev_b32_e64 v143, 18, v143
v_pk_add_f16 v150, v150, 1.0 op_sel_hi:[1,0]
v_pk_add_f16 v147, v147, 1.0 op_sel_hi:[1,0]
v_and_b32 v145, s49, v145
v_rcp_f16 v154, v153
v_bfe_u32 v144, v145, 2, 14
v_rcp_f16_e64 v151, v150
v_lshrrev_b32 v145, 18, v145
s_waitcnt lgkmcnt(7)
ds_read_b128 v[236:239], v248 offset:38912
ds_read_u16_d16_hi v143, v143
ds_read_u16_d16 v144, v144
ds_read_u16_d16_hi v145, v145
v_mfma_f32_32x32x16_bf16 v[120:135], v[88:91], v[216:219], v[120:135]
v_rcp_f16 v148, v147
v_rcp_f16_sdwa v154, v153 dst_sel:WORD_1 dst_unused:UNUSED_PRESERVE src0_sel:WORD_1
s_setprio 0
v_fma_mix_f32 v157, v136, v136, v157 op_sel:[0,0,0] op_sel_hi:[1,1,0]
s_waitcnt lgkmcnt(8)
v_fma_mix_f32 v157, v137, v137, v157 op_sel:[1,1,0] op_sel_hi:[1,1,0]
v_rcp_f16_sdwa v151, v150 dst_sel:WORD_1 dst_unused:UNUSED_PRESERVE src0_sel:WORD_1
v_fma_mix_f32 v157, v138, v138, v157 op_sel:[0,0,0] op_sel_hi:[1,1,0]
ds_read_b128 v[216:219], v248 offset:36864
v_mfma_f32_32x32x16_bf16 v[120:135], v[92:95], v[220:223], v[120:135]
v_rcp_f16_sdwa v148, v147 dst_sel:WORD_1 dst_unused:UNUSED_PRESERVE src0_sel:WORD_1
v_fma_mix_f32 v157, v139, v139, v157 op_sel:[1,1,0] op_sel_hi:[1,1,0]
v_pk_mul_f16 v155, v155, v154
s_waitcnt lgkmcnt(5)
v_fma_mix_f32 v157, v140, v140, v157 op_sel:[0,0,0] op_sel_hi:[1,1,0]
v_pk_mul_f16 v152, v152, v151
v_fma_mix_f32 v157, v141, v141, v157 op_sel:[1,1,0] op_sel_hi:[1,1,0]
v_pk_mul_f16 v149, v149, v148
v_fma_mix_f32 v157, v155, v155, v157 op_sel:[0,0,0] op_sel_hi:[1,1,0]
v_fma_mix_f32 v157, v142, v142, v157 op_sel:[0,0,0] op_sel_hi:[1,1,0]
v_fma_mix_f32 v157, v155, v155, v157 op_sel:[1,1,0] op_sel_hi:[1,1,0]
s_waitcnt lgkmcnt(3)
v_fma_mix_f32 v157, v143, v143, v157 op_sel:[1,1,0] op_sel_hi:[1,1,0]
v_fma_mix_f32 v157, v152, v152, v157 op_sel:[0,0,0] op_sel_hi:[1,1,0]
v_fma_mix_f32 v157, v152, v152, v157 op_sel:[1,1,0] op_sel_hi:[1,1,0]
s_waitcnt lgkmcnt(1)
v_fma_mix_f32 v157, v144, v144, v157 op_sel:[0,0,0] op_sel_hi:[1,1,0]
v_fma_mix_f32 v157, v149, v149, v157 op_sel:[0,0,0] op_sel_hi:[1,1,0]
v_fma_mix_f32 v157, v145, v145, v157 op_sel:[1,1,0] op_sel_hi:[1,1,0]
v_fma_mix_f32 v157, v149, v149, v157 op_sel:[1,1,0] op_sel_hi:[1,1,0]
s_cmp_lg_u32 s40, 7
s_cbranch_scc1 Lnobias2
s_sub_u32 s43, s2, 96
s_cmp_lt_u32 s43, 96
s_cbranch_scc0 Lnobias2
s_waitcnt vmcnt(24)
v_lshlrev_b32 v176, 16, v176
v_lshlrev_b32 v177, 16, v177
v_lshlrev_b32 v178, 16, v178
v_lshlrev_b32 v179, 16, v179
v_lshlrev_b32 v180, 16, v180
v_lshlrev_b32 v181, 16, v181
v_lshlrev_b32 v182, 16, v182
v_lshlrev_b32 v183, 16, v183
v_lshlrev_b32 v184, 16, v184
v_lshlrev_b32 v185, 16, v185
v_lshlrev_b32 v186, 16, v186
v_lshlrev_b32 v187, 16, v187
v_mul_f32 v174, v176, v182
v_fmac_f32 v174, v177, v183
v_fmac_f32 v174, v178, v184
v_fmac_f32 v174, v179, v185
v_fmac_f32 v174, v180, v186
v_fmac_f32 v174, v181, v187
s_nop 1
v_add_f32_dpp v174, v174, v174 row_ror:8 row_mask:0xf bank_mask:0xf
s_nop 1
v_add_f32_dpp v174, v174, v174 row_ror:4 row_mask:0xf bank_mask:0xf
s_nop 1
v_add_f32_dpp v174, v174, v174 row_ror:2 row_mask:0xf bank_mask:0xf
s_nop 1
v_add_f32_dpp v174, v174, v174 row_ror:1 row_mask:0xf bank_mask:0xf
v_mov_b32 v175, v174
s_nop 1
v_permlane16_swap_b32 v174, v175
v_add_f32 v174, v174, v175
v_mov_b32_e64 v175, v174
s_nop 1
v_permlane32_swap_b32 v174, v175
v_add_f32 v174, v174, v175
s_lshl_b32 s44, s43, 2
s_add_u32 s44, s44, 394752
v_lshlrev_b32 v191, 11, v251
s_mov_b64 exec, 0xff
buffer_store_dword v174, v191, s[32:35], s44 offen sc1
s_mov_b64 exec, -1
Lnobias2:
v_cvt_pkrtz_f16_f32 v137, v120, v121
v_cvt_pkrtz_f16_f32 v139, v122, v123
v_cvt_pkrtz_f16_f32 v141, v124, v125
v_cvt_pkrtz_f16_f32 v143, v126, v127
v_cvt_pkrtz_f16_f32 v145, v128, v129
v_cvt_pk_f16_f32 v155, v130, v131
v_cvt_pk_f16_f32 v152, v132, v133
v_cvt_pk_f16_f32 v149, v134, v135
s_add_u32 s46, s80, 14680064
buffer_store_dwordx4 v[76:79], v241, s[32:35], s46 offen
ds_read_b128 v[220:223], v248 offset:39936
v_mfma_f32_32x32x16_bf16 v[120:135], v[72:75], v[224:227], 0
v_pk_fma_f16 v154, v155, v155, s48
v_and_b32_e64 v137, s49, v137
v_pk_fma_f16 v151, v152, v152, s48
v_and_b32_e64 v139, s49, v139
v_pk_fma_f16 v148, v149, v149, s48
v_pk_mul_f16 v154, v155, v154
v_bfe_u32 v136, v137, 2, 14
v_pk_mul_f16 v151, v152, v151
v_pk_mul_f16 v148, v149, v148
v_bfe_u32 v138, v139, 2, 14
ds_read_b64 v[224:225], v245
ds_read_b64 v[226:227], v246
s_waitcnt vmcnt(3)
s_barrier
ds_read_b128 v[192:195], v242
ds_read_u16_d16 v136, v136
ds_read_u16_d16 v138, v138
v_mfma_f32_32x32x16_bf16 v[120:135], v[76:79], v[228:231], v[120:135]
v_exp_f16 v153, v154
v_lshrrev_b32 v137, 18, v137
v_exp_f16 v150, v151
v_lshrrev_b32 v139, 18, v139
v_exp_f16 v147, v148
v_and_b32 v141, s49, v141
v_and_b32_e64 v143, s49, v143
ds_read_b128 v[228:231], v248 offset:40960
ds_read_u16_d16_hi v137, v137
ds_read_u16_d16_hi v139, v139
v_mfma_f32_32x32x16_bf16 v[120:135], v[80:83], v[232:235], v[120:135]
v_exp_f16_sdwa v153, v154 dst_sel:WORD_1 dst_unused:UNUSED_PRESERVE src0_sel:WORD_1
v_bfe_u32 v140, v141, 2, 14
v_exp_f16_sdwa v150, v151 dst_sel:WORD_1 dst_unused:UNUSED_PRESERVE src0_sel:WORD_1
v_bfe_u32 v142, v143, 2, 14
v_exp_f16_sdwa v147, v148 dst_sel:WORD_1 dst_unused:UNUSED_PRESERVE src0_sel:WORD_1
v_lshrrev_b32 v141, 18, v141
v_pk_add_f16 v153, v153, 1.0 op_sel_hi:[1,0]
s_setprio 2
ds_read_b128 v[232:235], v248 offset:44032
ds_read_u16_d16 v140, v140
ds_read_u16_d16 v142, v142
ds_read_u16_d16_hi v141, v141
v_mfma_f32_32x32x16_bf16 v[120:135], v[84:87], v[236:239], v[120:135]
v_lshrrev_b32_e64 v143, 18, v143
v_pk_add_f16 v150, v150, 1.0 op_sel_hi:[1,0]
v_pk_add_f16 v147, v147, 1.0 op_sel_hi:[1,0]
v_and_b32 v145, s49, v145
v_rcp_f16 v154, v153
v_bfe_u32 v144, v145, 2, 14
v_rcp_f16_e64 v151, v150
v_lshrrev_b32 v145, 18, v145
s_waitcnt lgkmcnt(6)
ds_read_b64 v[236:237], v245 offset:768
ds_read_b64 v[238:239], v246 offset:768
ds_read_b128 v[196:199], v242 offset:64
ds_read_u16_d16_hi v143, v143
ds_read_u16_d16 v144, v144
ds_read_u16_d16_hi v145, v145
v_mfma_f32_32x32x16_bf16 v[120:135], v[88:91], v[216:219], v[120:135]
v_rcp_f16_e64 v148, v147
v_rcp_f16_sdwa v154, v153 dst_sel:WORD_1 dst_unused:UNUSED_PRESERVE src0_sel:WORD_1
v_fma_mix_f32 v158, v136, v136, v158 op_sel:[0,0,0] op_sel_hi:[1,1,0]
s_waitcnt lgkmcnt(10)
v_fma_mix_f32 v158, v137, v137, v158 op_sel:[1,1,0] op_sel_hi:[1,1,0]
v_rcp_f16_sdwa v151, v150 dst_sel:WORD_1 dst_unused:UNUSED_PRESERVE src0_sel:WORD_1
v_fma_mix_f32 v158, v138, v138, v158 op_sel:[0,0,0] op_sel_hi:[1,1,0]
ds_read_b128 v[216:219], v248 offset:41984
v_mfma_f32_32x32x16_bf16 v[120:135], v[92:95], v[220:223], v[120:135]
v_rcp_f16_sdwa v148, v147 dst_sel:WORD_1 dst_unused:UNUSED_PRESERVE src0_sel:WORD_1
v_fma_mix_f32 v158, v139, v139, v158 op_sel:[1,1,0] op_sel_hi:[1,1,0]
v_pk_mul_f16 v155, v155, v154
s_waitcnt lgkmcnt(7)
v_fma_mix_f32 v158, v140, v140, v158 op_sel:[0,0,0] op_sel_hi:[1,1,0]
v_pk_mul_f16 v152, v152, v151
v_fma_mix_f32 v158, v141, v141, v158 op_sel:[1,1,0] op_sel_hi:[1,1,0]
v_pk_mul_f16 v149, v149, v148
v_fma_mix_f32 v158, v155, v155, v158 op_sel:[0,0,0] op_sel_hi:[1,1,0]
v_fma_mix_f32 v158, v142, v142, v158 op_sel:[0,0,0] op_sel_hi:[1,1,0]
v_fma_mix_f32 v158, v155, v155, v158 op_sel:[1,1,0] op_sel_hi:[1,1,0]
s_waitcnt lgkmcnt(3)
v_fma_mix_f32 v158, v143, v143, v158 op_sel:[1,1,0] op_sel_hi:[1,1,0]
v_fma_mix_f32 v158, v152, v152, v158 op_sel:[0,0,0] op_sel_hi:[1,1,0]
v_fma_mix_f32 v158, v152, v152, v158 op_sel:[1,1,0] op_sel_hi:[1,1,0]
s_waitcnt lgkmcnt(1)
v_fma_mix_f32 v158, v144, v144, v158 op_sel:[0,0,0] op_sel_hi:[1,1,0]
v_fma_mix_f32 v158, v149, v149, v158 op_sel:[0,0,0] op_sel_hi:[1,1,0]
v_fma_mix_f32 v158, v145, v145, v158 op_sel:[1,1,0] op_sel_hi:[1,1,0]
v_fma_mix_f32 v158, v149, v149, v158 op_sel:[1,1,0] op_sel_hi:[1,1,0]
v_mfma_f32_16x16x32_bf16 v[0:3], v[224:227], v[192:195], 0
s_add_u32 s46, s80, 16777216
buffer_store_dwordx4 v[80:83], v241, s[32:35], s46 offen
ds_read_b128 v[220:223], v248 offset:45056
v_cvt_pkrtz_f16_f32 v137, v120, v121
v_cvt_pkrtz_f16_f32 v139, v122, v123
v_cvt_pkrtz_f16_f32 v141, v124, v125
v_cvt_pkrtz_f16_f32 v143, v126, v127
v_cvt_pk_f16_f32 v155, v128, v129
v_cvt_pk_f16_f32 v152, v130, v131
v_cvt_pk_f16_f32 v149, v132, v133
v_cvt_pk_f16_f32 v146, v134, v135
v_mfma_f32_32x32x16_bf16 v[120:135], v[72:75], v[228:231], 0
ds_read_b64 v[224:225], v245 offset:1536
ds_read_b64 v[226:227], v246 offset:1536
ds_read_b128 v[200:203], v242 offset:128
v_pk_fma_f16 v154, v155, v155, s48
v_and_b32_e64 v137, s49, v137
v_pk_fma_f16 v151, v152, v152, s48
v_pk_fma_f16 v148, v149, v149, s48
v_and_b32_e64 v139, s49, v139
v_pk_fma_f16 v145, v146, v146, s48
v_mfma_f32_32x32x16_bf16 v[120:135], v[76:79], v[232:235], v[120:135]
ds_read_b128 v[228:231], v248 offset:43008
v_pk_mul_f16 v154, v155, v154
v_bfe_u32 v136, v137, 2, 14
v_pk_mul_f16 v151, v152, v151
v_pk_mul_f16 v148, v149, v148
v_bfe_u32 v138, v139, 2, 14
v_pk_mul_f16 v145, v146, v145
v_exp_f16 v153, v154
v_lshrrev_b32 v137, 18, v137
v_mfma_f32_16x16x32_bf16 v[16:19], v[236:239], v[196:199], 0
ds_read_b64 v[232:233], v245 offset:2304
ds_read_b64 v[234:235], v246 offset:2304
ds_read_b128 v[204:207], v243
ds_read_u16_d16 v136, v136
ds_read_u16_d16 v138, v138
ds_read_u16_d16_hi v137, v137
v_exp_f16 v150, v151
v_lshrrev_b32 v139, 18, v139
v_exp_f16 v147, v148
s_waitcnt lgkmcnt(7)
v_mfma_f32_32x32x16_bf16 v[120:135], v[80:83], v[216:219], v[120:135]
ds_read_b128 v[236:239], v248 offset:46080
ds_read_u16_d16_hi v139, v139
v_and_b32 v141, s49, v141
v_exp_f16 v144, v145
v_and_b32_e64 v143, s49, v143
v_exp_f16_sdwa v153, v154 dst_sel:WORD_1 dst_unused:UNUSED_PRESERVE src0_sel:WORD_1
v_bfe_u32 v140, v141, 2, 14
v_exp_f16_sdwa v150, v151 dst_sel:WORD_1 dst_unused:UNUSED_PRESERVE src0_sel:WORD_1
v_mfma_f32_32x32x16_bf16 v[120:135], v[84:87], v[220:223], v[120:135]
ds_read_b64 v[216:217], v245 offset:3072
ds_read_b64 v[218:219], v246 offset:3072
ds_read_b128 v[208:211], v243 offset:64
ds_read_u16_d16 v140, v140
v_bfe_u32 v142, v143, 2, 14
v_exp_f16_sdwa v147, v148 dst_sel:WORD_1 dst_unused:UNUSED_PRESERVE src0_sel:WORD_1
v_lshrrev_b32_e64 v141, 18, v141
v_exp_f16_sdwa v144, v145 dst_sel:WORD_1 dst_unused:UNUSED_PRESERVE src0_sel:WORD_1
v_lshrrev_b32_e64 v143, 18, v143
v_pk_add_f16 v153, v153, 1.0 op_sel_hi:[1,0]
v_pk_add_f16 v150, v150, 1.0 op_sel_hi:[1,0]
v_mfma_f32_16x16x32_bf16 v[32:35], v[224:227], v[200:203], 0
ds_read_b64 v[220:221], v245 offset:3840
ds_read_b64 v[222:223], v246 offset:3840
ds_read_b128 v[212:215], v243 offset:128
ds_read_u16_d16 v142, v142
ds_read_u16_d16_hi v141, v141
ds_read_u16_d16_hi v143, v143
v_pk_add_f16 v147, v147, 1.0 op_sel_hi:[1,0]
v_pk_add_f16 v144, v144, 1.0 op_sel_hi:[1,0]
v_rcp_f16 v154, v153
s_waitcnt lgkmcnt(10)
v_mfma_f32_32x32x16_bf16 v[120:135], v[88:91], v[228:231], v[120:135]
ds_read_b64 v[224:225], v245 offset:4608
ds_read_b64 v[226:227], v246 offset:4608
ds_read_b128 v[192:195], v244
v_rcp_f16 v151, v150
v_rcp_f16 v148, v147
v_rcp_f16_e64 v145, v144
v_rcp_f16_sdwa v154, v153 dst_sel:WORD_1 dst_unused:UNUSED_PRESERVE src0_sel:WORD_1
v_rcp_f16_sdwa v151, v150 dst_sel:WORD_1 dst_unused:UNUSED_PRESERVE src0_sel:WORD_1
v_mfma_f32_16x16x32_bf16 v[0:3], v[232:235], v[204:207], v[0:3]
ds_read_b128 v[228:231], v248 offset:47104
v_rcp_f16_sdwa v148, v147 dst_sel:WORD_1 dst_unused:UNUSED_PRESERVE src0_sel:WORD_1
v_fma_mix_f32 v159, v136, v136, v159 op_sel:[0,0,0] op_sel_hi:[1,1,0]
v_rcp_f16_sdwa v145, v144 dst_sel:WORD_1 dst_unused:UNUSED_PRESERVE src0_sel:WORD_1
v_mfma_f32_32x32x16_bf16 v[120:135], v[92:95], v[236:239], v[120:135]
ds_read_b128 v[232:235], v248 offset:50176
v_fma_mix_f32 v159, v137, v137, v159 op_sel:[1,1,0] op_sel_hi:[1,1,0]
v_pk_mul_f16 v155, v155, v154
v_fma_mix_f32 v159, v138, v138, v159 op_sel:[0,0,0] op_sel_hi:[1,1,0]
v_pk_mul_f16 v152, v152, v151
v_pk_mul_f16 v149, v149, v148
v_fma_mix_f32 v159, v139, v139, v159 op_sel:[1,1,0] op_sel_hi:[1,1,0]
v_pk_mul_f16 v146, v146, v145
v_fma_mix_f32 v159, v155, v155, v159 op_sel:[0,0,0] op_sel_hi:[1,1,0]
s_waitcnt lgkmcnt(5)
v_fma_mix_f32 v159, v140, v140, v159 op_sel:[0,0,0] op_sel_hi:[1,1,0]
v_mfma_f32_16x16x32_bf16 v[16:19], v[216:219], v[208:211], v[16:19]
ds_read_b64 v[236:237], v245 offset:5376
ds_read_b64 v[238:239], v246 offset:5376
ds_read_b128 v[196:199], v244 offset:64
v_fma_mix_f32 v159, v155, v155, v159 op_sel:[1,1,0] op_sel_hi:[1,1,0]
v_fma_mix_f32 v159, v152, v152, v159 op_sel:[0,0,0] op_sel_hi:[1,1,0]
v_fma_mix_f32 v159, v141, v141, v159 op_sel:[1,1,0] op_sel_hi:[1,1,0]
v_fma_mix_f32 v159, v152, v152, v159 op_sel:[1,1,0] op_sel_hi:[1,1,0]
v_fma_mix_f32 v159, v149, v149, v159 op_sel:[0,0,0] op_sel_hi:[1,1,0]
v_mfma_f32_16x16x32_bf16 v[32:35], v[220:223], v[212:215], v[32:35]
ds_read_b128 v[216:219], v248 offset:48128
v_fma_mix_f32 v159, v142, v142, v159 op_sel:[0,0,0] op_sel_hi:[1,1,0]
v_fma_mix_f32 v159, v149, v149, v159 op_sel:[1,1,0] op_sel_hi:[1,1,0]
v_fma_mix_f32 v159, v146, v146, v159 op_sel:[0,0,0] op_sel_hi:[1,1,0]
v_fma_mix_f32 v159, v143, v143, v159 op_sel:[1,1,0] op_sel_hi:[1,1,0]
v_fma_mix_f32 v159, v146, v146, v159 op_sel:[1,1,0] op_sel_hi:[1,1,0]
s_waitcnt lgkmcnt(4)
v_mfma_f32_16x16x32_bf16 v[0:3], v[224:227], v[192:195], v[0:3]
s_add_u32 s46, s80, 18874368
buffer_store_dwordx4 v[84:87], v241, s[32:35], s46 offen
ds_read_b128 v[220:223], v248 offset:51200
v_cvt_pkrtz_f16_f32 v137, v120, v121
v_cvt_pkrtz_f16_f32 v139, v122, v123
v_cvt_pkrtz_f16_f32 v141, v124, v125
v_cvt_pkrtz_f16_f32 v143, v126, v127
v_cvt_pk_f16_f32 v155, v128, v129
v_cvt_pk_f16_f32 v152, v130, v131
v_cvt_pk_f16_f32 v149, v132, v133
v_cvt_pk_f16_f32 v146, v134, v135
v_mfma_f32_32x32x16_bf16 v[120:135], v[72:75], v[228:231], 0
ds_read_b64 v[224:225], v245 offset:6144
ds_read_b64 v[226:227], v246 offset:6144
ds_read_b128 v[200:203], v244 offset:128
v_pk_fma_f16 v154, v155, v155, s48
v_and_b32_e64 v137, s49, v137
v_pk_fma_f16 v151, v152, v152, s48
v_pk_fma_f16 v148, v149, v149, s48
v_and_b32_e64 v139, s49, v139
v_pk_fma_f16 v145, v146, v146, s48
v_mfma_f32_32x32x16_bf16 v[120:135], v[76:79], v[232:235], v[120:135]
ds_read_b128 v[228:231], v248 offset:49152
v_pk_mul_f16 v154, v155, v154
v_bfe_u32 v136, v137, 2, 14
v_pk_mul_f16 v151, v152, v151
v_pk_mul_f16 v148, v149, v148
v_bfe_u32 v138, v139, 2, 14
v_pk_mul_f16 v145, v146, v145
v_exp_f16 v153, v154
v_lshrrev_b32 v137, 18, v137
s_waitcnt lgkmcnt(4)
v_mfma_f32_16x16x32_bf16 v[16:19], v[236:239], v[196:199], v[16:19]
ds_read_b64 v[232:233], v245 offset:192
ds_read_b64 v[234:235], v246 offset:192
v_xor_b32 v242, 16, v242
ds_read_b128 v[204:207], v242
ds_read_u16_d16 v136, v136
ds_read_u16_d16 v138, v138
ds_read_u16_d16_hi v137, v137
v_exp_f16 v150, v151
v_lshrrev_b32 v139, 18, v139
v_exp_f16_e64 v147, v148
v_mfma_f32_32x32x16_bf16 v[120:135], v[80:83], v[216:219], v[120:135]
ds_read_b128 v[236:239], v248 offset:52224
ds_read_u16_d16_hi v139, v139
v_and_b32 v141, s49, v141
v_exp_f16 v144, v145
v_and_b32_e64 v143, s49, v143
v_exp_f16_sdwa v153, v154 dst_sel:WORD_1 dst_unused:UNUSED_PRESERVE src0_sel:WORD_1
v_bfe_u32 v140, v141, 2, 14
v_exp_f16_sdwa v150, v151 dst_sel:WORD_1 dst_unused:UNUSED_PRESERVE src0_sel:WORD_1
v_mfma_f32_32x32x16_bf16 v[120:135], v[84:87], v[220:223], v[120:135]
ds_read_b64 v[216:217], v245 offset:960
ds_read_b64 v[218:219], v246 offset:960
ds_read_b128 v[208:211], v242 offset:64
ds_read_u16_d16 v140, v140
v_bfe_u32 v142, v143, 2, 14
v_exp_f16_sdwa v147, v148 dst_sel:WORD_1 dst_unused:UNUSED_PRESERVE src0_sel:WORD_1
v_lshrrev_b32_e64 v141, 18, v141
v_exp_f16_sdwa v144, v145 dst_sel:WORD_1 dst_unused:UNUSED_PRESERVE src0_sel:WORD_1
v_lshrrev_b32 v143, 18, v143
v_pk_add_f16 v153, v153, 1.0 op_sel_hi:[1,0]
v_pk_add_f16 v150, v150, 1.0 op_sel_hi:[1,0]
s_waitcnt lgkmcnt(6)
v_mfma_f32_16x16x32_bf16 v[32:35], v[224:227], v[200:203], v[32:35]
ds_read_b64 v[220:221], v245 offset:1728
ds_read_b64 v[222:223], v246 offset:1728
ds_read_b128 v[212:215], v242 offset:128
ds_read_u16_d16 v142, v142
ds_read_u16_d16_hi v141, v141
ds_read_u16_d16_hi v143, v143
v_pk_add_f16 v147, v147, 1.0 op_sel_hi:[1,0]
v_pk_add_f16 v144, v144, 1.0 op_sel_hi:[1,0]
v_rcp_f16_e64 v154, v153
v_mfma_f32_32x32x16_bf16 v[120:135], v[88:91], v[228:231], v[120:135]
ds_read_b64 v[224:225], v245 offset:2496
ds_read_b64 v[226:227], v246 offset:2496
v_xor_b32 v243, 16, v243
ds_read_b128 v[192:195], v243
v_rcp_f16 v151, v150
v_rcp_f16 v148, v147
v_rcp_f16 v145, v144
v_rcp_f16_sdwa v154, v153 dst_sel:WORD_1 dst_unused:UNUSED_PRESERVE src0_sel:WORD_1
v_rcp_f16_sdwa v151, v150 dst_sel:WORD_1 dst_unused:UNUSED_PRESERVE src0_sel:WORD_1
v_mfma_f32_16x16x32_bf16 v[4:7], v[232:235], v[204:207], 0
ds_read_b128 v[228:231], v248 offset:53248
v_rcp_f16_sdwa v148, v147 dst_sel:WORD_1 dst_unused:UNUSED_PRESERVE src0_sel:WORD_1
v_fma_mix_f32 v160, v136, v136, v160 op_sel:[0,0,0] op_sel_hi:[1,1,0]
v_rcp_f16_sdwa v145, v144 dst_sel:WORD_1 dst_unused:UNUSED_PRESERVE src0_sel:WORD_1
s_waitcnt lgkmcnt(10)
v_mfma_f32_32x32x16_bf16 v[120:135], v[92:95], v[236:239], v[120:135]
ds_read_b128 v[232:235], v248 offset:56320
v_fma_mix_f32 v160, v137, v137, v160 op_sel:[1,1,0] op_sel_hi:[1,1,0]
v_pk_mul_f16 v155, v155, v154
v_fma_mix_f32 v160, v138, v138, v160 op_sel:[0,0,0] op_sel_hi:[1,1,0]
v_pk_mul_f16 v152, v152, v151
v_pk_mul_f16 v149, v149, v148
v_fma_mix_f32 v160, v139, v139, v160 op_sel:[1,1,0] op_sel_hi:[1,1,0]
v_pk_mul_f16 v146, v146, v145
v_fma_mix_f32 v160, v155, v155, v160 op_sel:[0,0,0] op_sel_hi:[1,1,0]
v_fma_mix_f32 v160, v140, v140, v160 op_sel:[0,0,0] op_sel_hi:[1,1,0]
v_mfma_f32_16x16x32_bf16 v[20:23], v[216:219], v[208:211], 0
ds_read_b64 v[236:237], v245 offset:3264
ds_read_b64 v[238:239], v246 offset:3264
ds_read_b128 v[196:199], v243 offset:64
v_fma_mix_f32 v160, v155, v155, v160 op_sel:[1,1,0] op_sel_hi:[1,1,0]
v_fma_mix_f32 v160, v152, v152, v160 op_sel:[0,0,0] op_sel_hi:[1,1,0]
s_waitcnt lgkmcnt(5)
v_fma_mix_f32 v160, v141, v141, v160 op_sel:[1,1,0] op_sel_hi:[1,1,0]
v_fma_mix_f32 v160, v152, v152, v160 op_sel:[1,1,0] op_sel_hi:[1,1,0]
v_fma_mix_f32 v160, v149, v149, v160 op_sel:[0,0,0] op_sel_hi:[1,1,0]
v_mfma_f32_16x16x32_bf16 v[36:39], v[220:223], v[212:215], 0
ds_read_b128 v[216:219], v248 offset:54272
v_fma_mix_f32 v160, v142, v142, v160 op_sel:[0,0,0] op_sel_hi:[1,1,0]
v_fma_mix_f32 v160, v149, v149, v160 op_sel:[1,1,0] op_sel_hi:[1,1,0]
v_fma_mix_f32 v160, v146, v146, v160 op_sel:[0,0,0] op_sel_hi:[1,1,0]
v_fma_mix_f32 v160, v143, v143, v160 op_sel:[1,1,0] op_sel_hi:[1,1,0]
v_fma_mix_f32 v160, v146, v146, v160 op_sel:[1,1,0] op_sel_hi:[1,1,0]
v_mfma_f32_16x16x32_bf16 v[4:7], v[224:227], v[192:195], v[4:7]
s_add_u32 s46, s80, 20971520
buffer_store_dwordx4 v[88:91], v241, s[32:35], s46 offen
ds_read_b128 v[220:223], v248 offset:57344
v_cvt_pkrtz_f16_f32 v137, v120, v121
v_cvt_pkrtz_f16_f32 v139, v122, v123
v_cvt_pkrtz_f16_f32 v141, v124, v125
v_cvt_pkrtz_f16_f32 v143, v126, v127
v_cvt_pk_f16_f32 v155, v128, v129
v_cvt_pk_f16_f32 v152, v130, v131
v_cvt_pk_f16_f32 v149, v132, v133
v_cvt_pk_f16_f32 v146, v134, v135
s_waitcnt lgkmcnt(2)
v_mfma_f32_32x32x16_bf16 v[120:135], v[72:75], v[228:231], 0
ds_read_b64 v[224:225], v245 offset:4032
ds_read_b64 v[226:227], v246 offset:4032
ds_read_b128 v[200:203], v243 offset:128
v_pk_fma_f16 v154, v155, v155, s48
v_and_b32 v137, s49, v137
v_pk_fma_f16 v151, v152, v152, s48
v_pk_fma_f16 v148, v149, v149, s48
v_and_b32_e64 v139, s49, v139
v_pk_fma_f16 v145, v146, v146, s48
v_mfma_f32_32x32x16_bf16 v[120:135], v[76:79], v[232:235], v[120:135]
ds_read_b128 v[228:231], v248 offset:55296
v_pk_mul_f16 v154, v155, v154
v_bfe_u32 v136, v137, 2, 14
v_pk_mul_f16 v151, v152, v151
v_pk_mul_f16 v148, v149, v148
v_bfe_u32 v138, v139, 2, 14
v_pk_mul_f16 v145, v146, v145
v_exp_f16_e64 v153, v154
v_lshrrev_b32 v137, 18, v137
v_mfma_f32_16x16x32_bf16 v[20:23], v[236:239], v[196:199], v[20:23]
ds_read_b64 v[232:233], v245 offset:4800
ds_read_b64 v[234:235], v246 offset:4800
v_xor_b32 v244, 16, v244
ds_read_b128 v[204:207], v244
ds_read_u16_d16 v136, v136
ds_read_u16_d16 v138, v138
ds_read_u16_d16_hi v137, v137
v_exp_f16 v150, v151
v_lshrrev_b32 v139, 18, v139
v_exp_f16 v147, v148
s_waitcnt lgkmcnt(7)
v_mfma_f32_32x32x16_bf16 v[120:135], v[80:83], v[216:219], v[120:135]
ds_read_b128 v[236:239], v248 offset:58368
ds_read_u16_d16_hi v139, v139
v_and_b32 v141, s49, v141
v_exp_f16 v144, v145
v_and_b32_e64 v143, s49, v143
v_exp_f16_sdwa v153, v154 dst_sel:WORD_1 dst_unused:UNUSED_PRESERVE src0_sel:WORD_1
v_bfe_u32 v140, v141, 2, 14
v_exp_f16_sdwa v150, v151 dst_sel:WORD_1 dst_unused:UNUSED_PRESERVE src0_sel:WORD_1
v_mfma_f32_32x32x16_bf16 v[120:135], v[84:87], v[220:223], v[120:135]
ds_read_b64 v[216:217], v245 offset:5568
ds_read_b64 v[218:219], v246 offset:5568
ds_read_b128 v[208:211], v244 offset:64
ds_read_u16_d16 v140, v140
v_bfe_u32 v142, v143, 2, 14
v_exp_f16_sdwa v147, v148 dst_sel:WORD_1 dst_unused:UNUSED_PRESERVE src0_sel:WORD_1
v_lshrrev_b32_e64 v141, 18, v141
v_exp_f16_sdwa v144, v145 dst_sel:WORD_1 dst_unused:UNUSED_PRESERVE src0_sel:WORD_1
v_lshrrev_b32_e64 v143, 18, v143
v_pk_add_f16 v153, v153, 1.0 op_sel_hi:[1,0]
v_pk_add_f16 v150, v150, 1.0 op_sel_hi:[1,0]
v_mfma_f32_16x16x32_bf16 v[36:39], v[224:227], v[200:203], v[36:39]
ds_read_b64 v[220:221], v245 offset:6336
ds_read_b64 v[222:223], v246 offset:6336
ds_read_b128 v[212:215], v244 offset:128
ds_read_u16_d16 v142, v142
ds_read_u16_d16_hi v141, v141
ds_read_u16_d16_hi v143, v143
v_pk_add_f16 v147, v147, 1.0 op_sel_hi:[1,0]
v_pk_add_f16 v144, v144, 1.0 op_sel_hi:[1,0]
v_rcp_f16 v154, v153
s_waitcnt lgkmcnt(10)
v_mfma_f32_32x32x16_bf16 v[120:135], v[88:91], v[228:231], v[120:135]
ds_read_b64 v[224:225], v245 offset:576
ds_read_b64 v[226:227], v246 offset:576
v_xor_b32 v242, 32, v242
ds_read_b128 v[192:195], v242
v_rcp_f16 v151, v150
v_rcp_f16_e64 v148, v147
v_rcp_f16 v145, v144
v_rcp_f16_sdwa v154, v153 dst_sel:WORD_1 dst_unused:UNUSED_PRESERVE src0_sel:WORD_1
v_rcp_f16_sdwa v151, v150 dst_sel:WORD_1 dst_unused:UNUSED_PRESERVE src0_sel:WORD_1
v_mfma_f32_16x16x32_bf16 v[4:7], v[232:235], v[204:207], v[4:7]
ds_read_b128 v[228:231], v248 offset:59392
v_rcp_f16_sdwa v148, v147 dst_sel:WORD_1 dst_unused:UNUSED_PRESERVE src0_sel:WORD_1
v_fma_mix_f32 v161, v136, v136, v161 op_sel:[0,0,0] op_sel_hi:[1,1,0]
s_setprio 1
v_rcp_f16_sdwa v145, v144 dst_sel:WORD_1 dst_unused:UNUSED_PRESERVE src0_sel:WORD_1
v_mfma_f32_32x32x16_bf16 v[120:135], v[92:95], v[236:239], v[120:135]
ds_read_b128 v[232:235], v248 offset:62464
v_fma_mix_f32 v161, v137, v137, v161 op_sel:[1,1,0] op_sel_hi:[1,1,0]
v_pk_mul_f16 v155, v155, v154
v_fma_mix_f32 v161, v138, v138, v161 op_sel:[0,0,0] op_sel_hi:[1,1,0]
v_pk_mul_f16 v152, v152, v151
v_pk_mul_f16 v149, v149, v148
v_fma_mix_f32 v161, v139, v139, v161 op_sel:[1,1,0] op_sel_hi:[1,1,0]
v_pk_mul_f16 v146, v146, v145
v_fma_mix_f32 v161, v155, v155, v161 op_sel:[0,0,0] op_sel_hi:[1,1,0]
s_waitcnt lgkmcnt(4)
v_fma_mix_f32 v161, v140, v140, v161 op_sel:[0,0,0] op_sel_hi:[1,1,0]
v_mfma_f32_16x16x32_bf16 v[20:23], v[216:219], v[208:211], v[20:23]
ds_read_b64 v[236:237], v245 offset:1344
ds_read_b64 v[238:239], v246 offset:1344
ds_read_b128 v[196:199], v242 offset:64
v_fma_mix_f32 v161, v155, v155, v161 op_sel:[1,1,0] op_sel_hi:[1,1,0]
v_fma_mix_f32 v161, v152, v152, v161 op_sel:[0,0,0] op_sel_hi:[1,1,0]
v_fma_mix_f32 v161, v141, v141, v161 op_sel:[1,1,0] op_sel_hi:[1,1,0]
v_fma_mix_f32 v161, v152, v152, v161 op_sel:[1,1,0] op_sel_hi:[1,1,0]
v_fma_mix_f32 v161, v149, v149, v161 op_sel:[0,0,0] op_sel_hi:[1,1,0]
v_mfma_f32_16x16x32_bf16 v[36:39], v[220:223], v[212:215], v[36:39]
ds_read_b128 v[216:219], v248 offset:60416
v_fma_mix_f32 v161, v142, v142, v161 op_sel:[0,0,0] op_sel_hi:[1,1,0]
v_fma_mix_f32 v161, v149, v149, v161 op_sel:[1,1,0] op_sel_hi:[1,1,0]
v_fma_mix_f32 v161, v146, v146, v161 op_sel:[0,0,0] op_sel_hi:[1,1,0]
v_fma_mix_f32 v161, v143, v143, v161 op_sel:[1,1,0] op_sel_hi:[1,1,0]
v_fma_mix_f32 v161, v146, v146, v161 op_sel:[1,1,0] op_sel_hi:[1,1,0]
s_waitcnt lgkmcnt(4)
v_mfma_f32_16x16x32_bf16 v[12:15], v[224:227], v[192:195], 0
s_add_u32 s46, s80, 23068672
buffer_store_dwordx4 v[92:95], v241, s[32:35], s46 offen
ds_read_b128 v[220:223], v248 offset:63488
v_cvt_pkrtz_f16_f32 v137, v120, v121
v_cvt_pkrtz_f16_f32 v139, v122, v123
v_cvt_pkrtz_f16_f32 v141, v124, v125
v_cvt_pkrtz_f16_f32 v143, v126, v127
v_cvt_pk_f16_f32 v155, v128, v129
v_cvt_pk_f16_f32 v152, v130, v131
v_cvt_pk_f16_f32 v149, v132, v133
v_cvt_pk_f16_f32 v146, v134, v135
v_mfma_f32_32x32x16_bf16 v[120:135], v[72:75], v[228:231], 0
ds_read_b64 v[224:225], v245 offset:2112
ds_read_b64 v[226:227], v246 offset:2112
ds_read_b128 v[200:203], v242 offset:128
v_pk_fma_f16 v154, v155, v155, s48
v_and_b32_e64 v137, s49, v137
v_pk_fma_f16 v151, v152, v152, s48
v_pk_fma_f16 v148, v149, v149, s48
v_and_b32_e64 v139, s49, v139
v_pk_fma_f16 v145, v146, v146, s48
v_mfma_f32_32x32x16_bf16 v[120:135], v[76:79], v[232:235], v[120:135]
ds_read_b128 v[228:231], v248 offset:61440
v_pk_mul_f16 v154, v155, v154
v_bfe_u32 v136, v137, 2, 14
v_pk_mul_f16 v151, v152, v151
v_pk_mul_f16 v148, v149, v148
v_bfe_u32 v138, v139, 2, 14
v_pk_mul_f16 v145, v146, v145
v_exp_f16 v153, v154
v_lshrrev_b32 v137, 18, v137
s_waitcnt lgkmcnt(4)
v_mfma_f32_16x16x32_bf16 v[28:31], v[236:239], v[196:199], 0
ds_read_b64 v[232:233], v245 offset:2880
ds_read_b64 v[234:235], v246 offset:2880
v_xor_b32 v243, 32, v243
ds_read_b128 v[204:207], v243
ds_read_u16_d16 v136, v136
ds_read_u16_d16 v138, v138
ds_read_u16_d16_hi v137, v137
v_exp_f16 v150, v151
v_lshrrev_b32 v139, 18, v139
v_exp_f16_e64 v147, v148
v_mfma_f32_32x32x16_bf16 v[120:135], v[80:83], v[216:219], v[120:135]
ds_read_b128 v[236:239], v248 offset:64512
ds_read_u16_d16_hi v139, v139
v_and_b32 v141, s49, v141
v_exp_f16 v144, v145
v_and_b32_e64 v143, s49, v143
v_exp_f16_sdwa v153, v154 dst_sel:WORD_1 dst_unused:UNUSED_PRESERVE src0_sel:WORD_1
v_bfe_u32 v140, v141, 2, 14
v_exp_f16_sdwa v150, v151 dst_sel:WORD_1 dst_unused:UNUSED_PRESERVE src0_sel:WORD_1
v_mfma_f32_32x32x16_bf16 v[120:135], v[84:87], v[220:223], v[120:135]
ds_read_b64 v[216:217], v245 offset:3648
ds_read_b64 v[218:219], v246 offset:3648
ds_read_b128 v[208:211], v243 offset:64
ds_read_u16_d16 v140, v140
v_bfe_u32 v142, v143, 2, 14
v_exp_f16_sdwa v147, v148 dst_sel:WORD_1 dst_unused:UNUSED_PRESERVE src0_sel:WORD_1
v_lshrrev_b32_e64 v141, 18, v141
v_exp_f16_sdwa v144, v145 dst_sel:WORD_1 dst_unused:UNUSED_PRESERVE src0_sel:WORD_1
v_lshrrev_b32 v143, 18, v143
v_pk_add_f16 v153, v153, 1.0 op_sel_hi:[1,0]
v_pk_add_f16 v150, v150, 1.0 op_sel_hi:[1,0]
s_waitcnt lgkmcnt(6)
v_mfma_f32_16x16x32_bf16 v[44:47], v[224:227], v[200:203], 0
ds_read_b64 v[220:221], v245 offset:4416
ds_read_b64 v[222:223], v246 offset:4416
ds_read_b128 v[212:215], v243 offset:128
ds_read_u16_d16 v142, v142
ds_read_u16_d16_hi v141, v141
ds_read_u16_d16_hi v143, v143
v_pk_add_f16 v147, v147, 1.0 op_sel_hi:[1,0]
v_pk_add_f16 v144, v144, 1.0 op_sel_hi:[1,0]
v_rcp_f16_e64 v154, v153
v_mfma_f32_32x32x16_bf16 v[120:135], v[88:91], v[228:231], v[120:135]
ds_read_b64 v[224:225], v245 offset:5184
ds_read_b64 v[226:227], v246 offset:5184
v_xor_b32 v244, 32, v244
ds_read_b128 v[192:195], v244
v_rcp_f16 v151, v150
v_rcp_f16 v148, v147
v_rcp_f16 v145, v144
v_rcp_f16_sdwa v154, v153 dst_sel:WORD_1 dst_unused:UNUSED_PRESERVE src0_sel:WORD_1
v_rcp_f16_sdwa v151, v150 dst_sel:WORD_1 dst_unused:UNUSED_PRESERVE src0_sel:WORD_1
v_mfma_f32_16x16x32_bf16 v[12:15], v[232:235], v[204:207], v[12:15]
ds_read_b128 v[228:231], v249
v_rcp_f16_sdwa v148, v147 dst_sel:WORD_1 dst_unused:UNUSED_PRESERVE src0_sel:WORD_1
v_fma_mix_f32 v162, v136, v136, v162 op_sel:[0,0,0] op_sel_hi:[1,1,0]
v_rcp_f16_sdwa v145, v144 dst_sel:WORD_1 dst_unused:UNUSED_PRESERVE src0_sel:WORD_1
s_waitcnt lgkmcnt(10)
v_mfma_f32_32x32x16_bf16 v[120:135], v[92:95], v[236:239], v[120:135]
ds_read_b128 v[232:235], v249 offset:3072
v_fma_mix_f32 v162, v137, v137, v162 op_sel:[1,1,0] op_sel_hi:[1,1,0]
v_pk_mul_f16 v155, v155, v154
v_fma_mix_f32 v162, v138, v138, v162 op_sel:[0,0,0] op_sel_hi:[1,1,0]
v_pk_mul_f16 v152, v152, v151
v_pk_mul_f16 v149, v149, v148
v_fma_mix_f32 v162, v139, v139, v162 op_sel:[1,1,0] op_sel_hi:[1,1,0]
v_pk_mul_f16 v146, v146, v145
v_fma_mix_f32 v162, v155, v155, v162 op_sel:[0,0,0] op_sel_hi:[1,1,0]
v_fma_mix_f32 v162, v140, v140, v162 op_sel:[0,0,0] op_sel_hi:[1,1,0]
v_mfma_f32_16x16x32_bf16 v[28:31], v[216:219], v[208:211], v[28:31]
ds_read_b64 v[236:237], v245 offset:5952
ds_read_b64 v[238:239], v246 offset:5952
ds_read_b128 v[196:199], v244 offset:64
v_fma_mix_f32 v162, v155, v155, v162 op_sel:[1,1,0] op_sel_hi:[1,1,0]
v_fma_mix_f32 v162, v152, v152, v162 op_sel:[0,0,0] op_sel_hi:[1,1,0]
s_waitcnt lgkmcnt(5)
v_fma_mix_f32 v162, v141, v141, v162 op_sel:[1,1,0] op_sel_hi:[1,1,0]
v_fma_mix_f32 v162, v152, v152, v162 op_sel:[1,1,0] op_sel_hi:[1,1,0]
v_fma_mix_f32 v162, v149, v149, v162 op_sel:[0,0,0] op_sel_hi:[1,1,0]
v_mfma_f32_16x16x32_bf16 v[44:47], v[220:223], v[212:215], v[44:47]
ds_read_b128 v[216:219], v249 offset:1024
v_fma_mix_f32 v162, v142, v142, v162 op_sel:[0,0,0] op_sel_hi:[1,1,0]
v_fma_mix_f32 v162, v149, v149, v162 op_sel:[1,1,0] op_sel_hi:[1,1,0]
v_fma_mix_f32 v162, v146, v146, v162 op_sel:[0,0,0] op_sel_hi:[1,1,0]
v_fma_mix_f32 v162, v143, v143, v162 op_sel:[1,1,0] op_sel_hi:[1,1,0]
v_fma_mix_f32 v162, v146, v146, v162 op_sel:[1,1,0] op_sel_hi:[1,1,0]
v_mfma_f32_16x16x32_bf16 v[12:15], v[224:227], v[192:195], v[12:15]
ds_read_b128 v[220:223], v249 offset:4096
v_cvt_pkrtz_f16_f32 v137, v120, v121
v_cvt_pkrtz_f16_f32 v139, v122, v123
v_cvt_pkrtz_f16_f32 v141, v124, v125
v_cvt_pkrtz_f16_f32 v143, v126, v127
v_cvt_pk_f16_f32 v155, v128, v129
v_cvt_pk_f16_f32 v152, v130, v131
v_cvt_pk_f16_f32 v149, v132, v133
v_cvt_pk_f16_f32 v146, v134, v135
s_waitcnt lgkmcnt(3)
v_mfma_f32_32x32x16_bf16 v[120:135], v[72:75], v[228:231], 0
ds_read_b64 v[224:225], v245 offset:6720
ds_read_b64 v[226:227], v246 offset:6720
ds_read_b128 v[200:203], v244 offset:128
v_pk_fma_f16 v154, v155, v155, s48
v_and_b32 v137, s49, v137
v_pk_fma_f16 v151, v152, v152, s48
v_pk_fma_f16 v148, v149, v149, s48
v_and_b32_e64 v139, s49, v139
v_pk_fma_f16 v145, v146, v146, s48
v_mfma_f32_32x32x16_bf16 v[120:135], v[76:79], v[232:235], v[120:135]
ds_read_b128 v[228:231], v249 offset:2048
v_pk_mul_f16 v154, v155, v154
v_bfe_u32 v136, v137, 2, 14
v_pk_mul_f16 v151, v152, v151
v_pk_mul_f16 v148, v149, v148
v_bfe_u32 v138, v139, 2, 14
v_pk_mul_f16 v145, v146, v145
v_exp_f16 v153, v154
v_lshrrev_b32 v137, 18, v137
s_waitcnt lgkmcnt(4)
v_mfma_f32_16x16x32_bf16 v[28:31], v[236:239], v[196:199], v[28:31]
ds_read_b64 v[232:233], v245 offset:384
ds_read_b64 v[234:235], v246 offset:384
v_xor_b32 v242, 16, v242
ds_read_b128 v[204:207], v242
ds_read_u16_d16 v136, v136
ds_read_u16_d16 v138, v138
ds_read_u16_d16_hi v137, v137
v_exp_f16 v150, v151
v_lshrrev_b32 v139, 18, v139
v_exp_f16_e64 v147, v148
v_mfma_f32_32x32x16_bf16 v[120:135], v[80:83], v[216:219], v[120:135]
ds_read_b128 v[236:239], v249 offset:5120
ds_read_u16_d16_hi v139, v139
v_and_b32 v141, s49, v141
v_exp_f16 v144, v145
v_and_b32_e64 v143, s49, v143
v_exp_f16_sdwa v153, v154 dst_sel:WORD_1 dst_unused:UNUSED_PRESERVE src0_sel:WORD_1
v_bfe_u32 v140, v141, 2, 14
v_exp_f16_sdwa v150, v151 dst_sel:WORD_1 dst_unused:UNUSED_PRESERVE src0_sel:WORD_1
v_mfma_f32_32x32x16_bf16 v[120:135], v[84:87], v[220:223], v[120:135]
ds_read_b64 v[216:217], v245 offset:1152
ds_read_b64 v[218:219], v246 offset:1152
ds_read_b128 v[208:211], v242 offset:64
ds_read_u16_d16 v140, v140
v_bfe_u32 v142, v143, 2, 14
v_exp_f16_sdwa v147, v148 dst_sel:WORD_1 dst_unused:UNUSED_PRESERVE src0_sel:WORD_1
v_lshrrev_b32_e64 v141, 18, v141
v_exp_f16_sdwa v144, v145 dst_sel:WORD_1 dst_unused:UNUSED_PRESERVE src0_sel:WORD_1
v_lshrrev_b32 v143, 18, v143
v_pk_add_f16 v153, v153, 1.0 op_sel_hi:[1,0]
v_pk_add_f16 v150, v150, 1.0 op_sel_hi:[1,0]
s_waitcnt lgkmcnt(6)
v_mfma_f32_16x16x32_bf16 v[44:47], v[224:227], v[200:203], v[44:47]
ds_read_b64 v[220:221], v245 offset:1920
ds_read_b64 v[222:223], v246 offset:1920
ds_read_b128 v[212:215], v242 offset:128
ds_read_u16_d16 v142, v142
ds_read_u16_d16_hi v141, v141
ds_read_u16_d16_hi v143, v143
v_pk_add_f16 v147, v147, 1.0 op_sel_hi:[1,0]
v_pk_add_f16 v144, v144, 1.0 op_sel_hi:[1,0]
v_rcp_f16_e64 v154, v153
v_mfma_f32_32x32x16_bf16 v[120:135], v[88:91], v[228:231], v[120:135]
ds_read_b64 v[224:225], v245 offset:2688
ds_read_b64 v[226:227], v246 offset:2688
v_xor_b32 v243, 16, v243
ds_read_b128 v[192:195], v243
v_rcp_f16 v151, v150
v_rcp_f16 v148, v147
v_rcp_f16 v145, v144
v_rcp_f16_sdwa v154, v153 dst_sel:WORD_1 dst_unused:UNUSED_PRESERVE src0_sel:WORD_1
v_rcp_f16_sdwa v151, v150 dst_sel:WORD_1 dst_unused:UNUSED_PRESERVE src0_sel:WORD_1
v_mfma_f32_16x16x32_bf16 v[8:11], v[232:235], v[204:207], 0
ds_read_b128 v[228:231], v249 offset:6144
v_rcp_f16_sdwa v148, v147 dst_sel:WORD_1 dst_unused:UNUSED_PRESERVE src0_sel:WORD_1
v_fma_mix_f32 v163, v136, v136, v163 op_sel:[0,0,0] op_sel_hi:[1,1,0]
v_rcp_f16_sdwa v145, v144 dst_sel:WORD_1 dst_unused:UNUSED_PRESERVE src0_sel:WORD_1
s_waitcnt lgkmcnt(10)
v_mfma_f32_32x32x16_bf16 v[120:135], v[92:95], v[236:239], v[120:135]
ds_read_b128 v[232:235], v249 offset:9216
v_fma_mix_f32 v163, v137, v137, v163 op_sel:[1,1,0] op_sel_hi:[1,1,0]
v_pk_mul_f16 v155, v155, v154
v_fma_mix_f32 v163, v138, v138, v163 op_sel:[0,0,0] op_sel_hi:[1,1,0]
v_pk_mul_f16 v152, v152, v151
v_pk_mul_f16 v149, v149, v148
v_fma_mix_f32 v163, v139, v139, v163 op_sel:[1,1,0] op_sel_hi:[1,1,0]
v_pk_mul_f16 v146, v146, v145
v_fma_mix_f32 v163, v155, v155, v163 op_sel:[0,0,0] op_sel_hi:[1,1,0]
v_fma_mix_f32 v163, v140, v140, v163 op_sel:[0,0,0] op_sel_hi:[1,1,0]
v_mfma_f32_16x16x32_bf16 v[24:27], v[216:219], v[208:211], 0
ds_read_b64 v[236:237], v245 offset:3456
ds_read_b64 v[238:239], v246 offset:3456
ds_read_b128 v[196:199], v243 offset:64
v_fma_mix_f32 v163, v155, v155, v163 op_sel:[1,1,0] op_sel_hi:[1,1,0]
v_fma_mix_f32 v163, v152, v152, v163 op_sel:[0,0,0] op_sel_hi:[1,1,0]
s_waitcnt lgkmcnt(5)
v_fma_mix_f32 v163, v141, v141, v163 op_sel:[1,1,0] op_sel_hi:[1,1,0]
v_fma_mix_f32 v163, v152, v152, v163 op_sel:[1,1,0] op_sel_hi:[1,1,0]
v_fma_mix_f32 v163, v149, v149, v163 op_sel:[0,0,0] op_sel_hi:[1,1,0]
v_mfma_f32_16x16x32_bf16 v[40:43], v[220:223], v[212:215], 0
ds_read_b128 v[216:219], v249 offset:7168
v_fma_mix_f32 v163, v142, v142, v163 op_sel:[0,0,0] op_sel_hi:[1,1,0]
v_fma_mix_f32 v163, v149, v149, v163 op_sel:[1,1,0] op_sel_hi:[1,1,0]
v_fma_mix_f32 v163, v146, v146, v163 op_sel:[0,0,0] op_sel_hi:[1,1,0]
v_fma_mix_f32 v163, v143, v143, v163 op_sel:[1,1,0] op_sel_hi:[1,1,0]
v_fma_mix_f32 v163, v146, v146, v163 op_sel:[1,1,0] op_sel_hi:[1,1,0]
s_cmp_lg_u32 s40, 7
s_cbranch_scc1 Lnoinit
s_waitcnt vmcnt(5)
v_mov_b32 v255, 1
s_mov_b64 exec, 1
buffer_atomic_add v255, v241, s[36:39], 0 offen
s_mov_b64 exec, -1
Lnoinit:
v_mfma_f32_16x16x32_bf16 v[8:11], v[224:227], v[192:195], v[8:11]
ds_read_b128 v[220:223], v249 offset:10240
v_cvt_pkrtz_f16_f32 v137, v120, v121
v_cvt_pkrtz_f16_f32 v139, v122, v123
v_cvt_pkrtz_f16_f32 v141, v124, v125
v_cvt_pkrtz_f16_f32 v143, v126, v127
v_cvt_pk_f16_f32 v155, v128, v129
v_cvt_pk_f16_f32 v152, v130, v131
v_cvt_pk_f16_f32 v149, v132, v133
v_cvt_pk_f16_f32 v146, v134, v135
s_waitcnt lgkmcnt(2)
v_mfma_f32_32x32x16_bf16 v[120:135], v[72:75], v[228:231], 0
ds_read_b64 v[224:225], v245 offset:4224
ds_read_b64 v[226:227], v246 offset:4224
ds_read_b128 v[200:203], v243 offset:128
s_setprio 0
v_pk_fma_f16 v154, v155, v155, s48
v_and_b32_e64 v137, s49, v137
v_pk_fma_f16 v151, v152, v152, s48
v_pk_fma_f16 v148, v149, v149, s48
v_mfma_f32_32x32x16_bf16 v[120:135], v[76:79], v[232:235], v[120:135]
ds_read_b128 v[228:231], v249 offset:8192
v_and_b32_e64 v139, s49, v139
v_pk_fma_f16 v145, v146, v146, s48
v_pk_mul_f16 v154, v155, v154
v_bfe_u32 v136, v137, 2, 14
v_pk_mul_f16 v151, v152, v151
v_pk_mul_f16 v148, v149, v148
v_bfe_u32 v138, v139, 2, 14
v_pk_mul_f16 v145, v146, v145
v_mfma_f32_16x16x32_bf16 v[24:27], v[236:239], v[196:199], v[24:27]
ds_read_b64 v[232:233], v245 offset:4992
ds_read_b64 v[234:235], v246 offset:4992
v_xor_b32 v244, 16, v244
ds_read_b128 v[204:207], v244
ds_read_u16_d16 v136, v136
ds_read_u16_d16 v138, v138
v_exp_f16 v153, v154
v_lshrrev_b32_e64 v137, 18, v137
v_exp_f16 v150, v151
s_waitcnt lgkmcnt(6)
v_mfma_f32_32x32x16_bf16 v[120:135], v[80:83], v[216:219], v[120:135]
ds_read_b128 v[236:239], v249 offset:11264
ds_read_u16_d16_hi v137, v137
v_lshrrev_b32 v139, 18, v139
v_exp_f16 v147, v148
v_and_b32 v141, s49, v141
v_exp_f16 v144, v145
v_and_b32_e64 v143, s49, v143
v_mfma_f32_32x32x16_bf16 v[120:135], v[84:87], v[220:223], v[120:135]
ds_read_b64 v[216:217], v245 offset:5760
ds_read_b64 v[218:219], v246 offset:5760
ds_read_b128 v[208:211], v244 offset:64
ds_read_u16_d16_hi v139, v139
v_exp_f16_sdwa v153, v154 dst_sel:WORD_1 dst_unused:UNUSED_PRESERVE src0_sel:WORD_1
v_bfe_u32 v140, v141, 2, 14
v_exp_f16_sdwa v150, v151 dst_sel:WORD_1 dst_unused:UNUSED_PRESERVE src0_sel:WORD_1
v_bfe_u32 v142, v143, 2, 14
v_exp_f16_sdwa v147, v148 dst_sel:WORD_1 dst_unused:UNUSED_PRESERVE src0_sel:WORD_1
v_lshrrev_b32_e64 v141, 18, v141
v_mfma_f32_16x16x32_bf16 v[40:43], v[224:227], v[200:203], v[40:43]
ds_read_b64 v[220:221], v245 offset:6528
ds_read_b64 v[222:223], v246 offset:6528
ds_read_b128 v[212:215], v244 offset:128
ds_read_u16_d16 v140, v140
ds_read_u16_d16 v142, v142
ds_read_u16_d16_hi v141, v141
v_exp_f16_sdwa v144, v145 dst_sel:WORD_1 dst_unused:UNUSED_PRESERVE src0_sel:WORD_1
v_lshrrev_b32 v143, 18, v143
v_pk_add_f16 v153, v153, 1.0 op_sel_hi:[1,0]
v_pk_add_f16 v150, v150, 1.0 op_sel_hi:[1,0]
s_waitcnt lgkmcnt(10)
v_mfma_f32_32x32x16_bf16 v[120:135], v[88:91], v[228:231], v[120:135]
ds_read_b128 v[224:227], v249 offset:12288
ds_read_u16_d16_hi v143, v143
v_pk_add_f16 v147, v147, 1.0 op_sel_hi:[1,0]
v_pk_add_f16 v144, v144, 1.0 op_sel_hi:[1,0]
v_rcp_f16 v154, v153
v_rcp_f16 v151, v150
v_rcp_f16_e64 v148, v147
v_mfma_f32_16x16x32_bf16 v[8:11], v[232:235], v[204:207], v[8:11]
ds_read_b128 v[228:231], v249 offset:15360
v_rcp_f16 v145, v144
v_rcp_f16_sdwa v154, v153 dst_sel:WORD_1 dst_unused:UNUSED_PRESERVE src0_sel:WORD_1
v_mfma_f32_32x32x16_bf16 v[120:135], v[92:95], v[236:239], v[120:135]
ds_read_b128 v[232:235], v249 offset:13312
v_rcp_f16_sdwa v151, v150 dst_sel:WORD_1 dst_unused:UNUSED_PRESERVE src0_sel:WORD_1
v_rcp_f16_sdwa v148, v147 dst_sel:WORD_1 dst_unused:UNUSED_PRESERVE src0_sel:WORD_1
v_fma_mix_f32 v164, v136, v136, v164 op_sel:[0,0,0] op_sel_hi:[1,1,0]
v_rcp_f16_sdwa v145, v144 dst_sel:WORD_1 dst_unused:UNUSED_PRESERVE src0_sel:WORD_1
v_fma_mix_f32 v164, v137, v137, v164 op_sel:[1,1,0] op_sel_hi:[1,1,0]
v_pk_mul_f16 v155, v155, v154
s_waitcnt lgkmcnt(4)
v_mfma_f32_16x16x32_bf16 v[24:27], v[216:219], v[208:211], v[24:27]
ds_read_b128 v[236:239], v249 offset:16384
v_fma_mix_f32 v164, v138, v138, v164 op_sel:[0,0,0] op_sel_hi:[1,1,0]
v_pk_mul_f16 v152, v152, v151
v_pk_mul_f16 v149, v149, v148
v_fma_mix_f32 v164, v139, v139, v164 op_sel:[1,1,0] op_sel_hi:[1,1,0]
v_mfma_f32_16x16x32_bf16 v[40:43], v[220:223], v[212:215], v[40:43]
ds_read_b128 v[216:219], v249 offset:14336
v_pk_mul_f16 v146, v146, v145
v_fma_mix_f32 v164, v155, v155, v164 op_sel:[0,0,0] op_sel_hi:[1,1,0]
v_fma_mix_f32 v164, v140, v140, v164 op_sel:[0,0,0] op_sel_hi:[1,1,0]
v_fma_mix_f32 v164, v155, v155, v164 op_sel:[1,1,0] op_sel_hi:[1,1,0]
v_fma_mix_f32 v164, v152, v152, v164 op_sel:[0,0,0] op_sel_hi:[1,1,0]
v_fma_mix_f32 v164, v141, v141, v164 op_sel:[1,1,0] op_sel_hi:[1,1,0]
v_fma_mix_f32 v164, v152, v152, v164 op_sel:[1,1,0] op_sel_hi:[1,1,0]
v_fma_mix_f32 v164, v149, v149, v164 op_sel:[0,0,0] op_sel_hi:[1,1,0]
v_fma_mix_f32 v164, v142, v142, v164 op_sel:[0,0,0] op_sel_hi:[1,1,0]
v_fma_mix_f32 v164, v149, v149, v164 op_sel:[1,1,0] op_sel_hi:[1,1,0]
v_fma_mix_f32 v164, v146, v146, v164 op_sel:[0,0,0] op_sel_hi:[1,1,0]
s_waitcnt lgkmcnt(2)
v_fma_mix_f32 v164, v143, v143, v164 op_sel:[1,1,0] op_sel_hi:[1,1,0]
v_fma_mix_f32 v164, v146, v146, v164 op_sel:[1,1,0] op_sel_hi:[1,1,0]
s_setprio 3
v_pk_add_f32 v[168:169], v[0:1], v[2:3]
v_pk_mul_f32 v[170:171], v[0:1], v[0:1]
v_pk_fma_f32 v[170:171], v[2:3], v[2:3], v[170:171]
v_pk_add_f32 v[168:169], v[168:169], v[4:5]
v_pk_fma_f32 v[170:171], v[4:5], v[4:5], v[170:171]
v_pk_add_f32 v[168:169], v[168:169], v[6:7]
v_pk_fma_f32 v[170:171], v[6:7], v[6:7], v[170:171]
v_pk_add_f32 v[168:169], v[168:169], v[8:9]
v_pk_fma_f32 v[170:171], v[8:9], v[8:9], v[170:171]
v_pk_add_f32 v[168:169], v[168:169], v[10:11]
v_pk_fma_f32 v[170:171], v[10:11], v[10:11], v[170:171]
v_pk_add_f32 v[168:169], v[168:169], v[12:13]
v_pk_fma_f32 v[170:171], v[12:13], v[12:13], v[170:171]
v_pk_add_f32 v[168:169], v[168:169], v[14:15]
v_pk_fma_f32 v[170:171], v[14:15], v[14:15], v[170:171]
v_pk_add_f32 v[168:169], v[168:169], v[16:17]
v_pk_fma_f32 v[170:171], v[16:17], v[16:17], v[170:171]
v_pk_add_f32 v[168:169], v[168:169], v[18:19]
v_pk_fma_f32 v[170:171], v[18:19], v[18:19], v[170:171]
v_pk_add_f32 v[168:169], v[168:169], v[20:21]
v_pk_fma_f32 v[170:171], v[20:21], v[20:21], v[170:171]
v_pk_add_f32 v[168:169], v[168:169], v[22:23]
v_pk_fma_f32 v[170:171], v[22:23], v[22:23], v[170:171]
v_pk_add_f32 v[168:169], v[168:169], v[24:25]
v_pk_fma_f32 v[170:171], v[24:25], v[24:25], v[170:171]
v_pk_add_f32 v[168:169], v[168:169], v[26:27]
v_pk_fma_f32 v[170:171], v[26:27], v[26:27], v[170:171]
v_pk_add_f32 v[168:169], v[168:169], v[28:29]
v_pk_fma_f32 v[170:171], v[28:29], v[28:29], v[170:171]
v_pk_add_f32 v[168:169], v[168:169], v[30:31]
v_pk_fma_f32 v[170:171], v[30:31], v[30:31], v[170:171]
v_pk_add_f32 v[168:169], v[168:169], v[32:33]
v_pk_fma_f32 v[170:171], v[32:33], v[32:33], v[170:171]
v_pk_add_f32 v[168:169], v[168:169], v[34:35]
v_pk_fma_f32 v[170:171], v[34:35], v[34:35], v[170:171]
v_pk_add_f32 v[168:169], v[168:169], v[36:37]
v_pk_fma_f32 v[170:171], v[36:37], v[36:37], v[170:171]
v_pk_add_f32 v[168:169], v[168:169], v[38:39]
v_pk_fma_f32 v[170:171], v[38:39], v[38:39], v[170:171]
v_pk_add_f32 v[168:169], v[168:169], v[40:41]
v_pk_fma_f32 v[170:171], v[40:41], v[40:41], v[170:171]
v_pk_add_f32 v[168:169], v[168:169], v[42:43]
v_pk_fma_f32 v[170:171], v[42:43], v[42:43], v[170:171]
v_pk_add_f32 v[168:169], v[168:169], v[44:45]
v_pk_fma_f32 v[170:171], v[44:45], v[44:45], v[170:171]
v_pk_add_f32 v[168:169], v[168:169], v[46:47]
v_pk_fma_f32 v[170:171], v[46:47], v[46:47], v[170:171]
s_setprio 0
s_barrier
v_add_u32 v247, -36864, v242
v_subrev_u32 v252, 66560, v247
v_min_u32_e64 v247, v247, v252
v_add_u32 v247, 90112, v247
v_sub_u32 v252, v247, v242
v_add_u32 v242, v252, v242
v_add_u32_e64 v243, v252, v243
v_add_u32 v244, v252, v244
s_setprio 2
v_cvt_pkrtz_f16_f32 v137, v120, v121
v_cvt_pkrtz_f16_f32 v139, v122, v123
v_cvt_pkrtz_f16_f32 v141, v124, v125
v_cvt_pkrtz_f16_f32 v143, v126, v127
v_cvt_pkrtz_f16_f32 v145, v128, v129
v_cvt_pk_f16_f32 v155, v130, v131
v_cvt_pk_f16_f32 v152, v132, v133
v_cvt_pk_f16_f32 v149, v134, v135
s_add_u32 m0, s67, 39936
s_add_u32 s66, s66, 98304
buffer_load_dwordx4 v240, s[4:7], s66 offen lds
ds_read_b128 v[220:223], v249 offset:17408
v_mfma_f32_32x32x16_bf16 v[120:135], v[72:75], v[224:227], 0
v_pk_fma_f16 v154, v155, v155, s48
v_add_f32 v168, v168, v169
v_and_b32 v137, s49, v137
v_pk_fma_f16 v151, v152, v152, s48
v_and_b32_e64 v139, s49, v139
v_pk_fma_f16 v148, v149, v149, s48
v_add_f32_e64 v170, v170, v171
v_pk_mul_f16 v154, v155, v154
v_bfe_u32 v136, v137, 2, 14
v_pk_mul_f16 v151, v152, v151
v_pk_mul_f16 v148, v149, v148
v_bfe_u32 v138, v139, 2, 14
ds_read_b128 v[224:227], v249 offset:18432
ds_read_u16_d16 v136, v136
ds_read_u16_d16 v138, v138
v_mfma_f32_32x32x16_bf16 v[120:135], v[76:79], v[228:231], v[120:135]
v_permlane32_swap_b32 v168, v170
v_exp_f16 v153, v154
v_lshrrev_b32 v137, 18, v137
v_exp_f16 v150, v151
v_add_f32 v168, v168, v170
v_lshrrev_b32 v139, 18, v139
v_exp_f16 v147, v148
v_and_b32 v141, s49, v141
v_and_b32_e64 v143, s49, v143
v_mul_f32 v168, 1009429163, v168
s_add_u32 m0, s67, 46592
s_add_u32 s66, s66, 98304
buffer_load_dwordx4 v240, s[4:7], s66 offen lds
ds_read_b128 v[228:231], v249 offset:21504
ds_read_u16_d16_hi v137, v137
ds_read_u16_d16_hi v139, v139
v_mfma_f32_32x32x16_bf16 v[120:135], v[80:83], v[232:235], v[120:135]
v_exp_f16_sdwa v153, v154 dst_sel:WORD_1 dst_unused:UNUSED_PRESERVE src0_sel:WORD_1
v_bfe_u32 v140, v141, 2, 14
v_exp_f16_sdwa v150, v151 dst_sel:WORD_1 dst_unused:UNUSED_PRESERVE src0_sel:WORD_1
v_mov_b32_e64 v170, v168
v_bfe_u32 v142, v143, 2, 14
v_exp_f16_sdwa v147, v148 dst_sel:WORD_1 dst_unused:UNUSED_PRESERVE src0_sel:WORD_1
v_lshrrev_b32_e64 v141, 18, v141
v_permlane32_swap_b32 v168, v170
v_pk_add_f16 v153, v153, 1.0 op_sel_hi:[1,0]
s_waitcnt lgkmcnt(3)
ds_read_b128 v[232:235], v249 offset:19456
ds_read_u16_d16 v140, v140
ds_read_u16_d16 v142, v142
ds_read_u16_d16_hi v141, v141
v_mfma_f32_32x32x16_bf16 v[120:135], v[84:87], v[236:239], v[120:135]
v_lshrrev_b32_e64 v143, 18, v143
v_pk_add_f16 v150, v150, 1.0 op_sel_hi:[1,0]
v_pk_add_f16 v147, v147, 1.0 op_sel_hi:[1,0]
v_and_b32_e64 v145, s49, v145
v_fma_f32 v170, -v168, v168, v170
v_rcp_f16_e64 v154, v153
v_bfe_u32 v144, v145, 2, 14
v_rcp_f16 v151, v150
v_max_f32 v170, 0, v170
v_lshrrev_b32_e64 v145, 18, v145
s_add_u32 m0, s67, 53248
s_add_u32 s66, s66, 98304
buffer_load_dwordx4 v240, s[4:7], s66 offen lds
ds_read_b128 v[236:239], v249 offset:22528
ds_read_u16_d16_hi v143, v143
ds_read_u16_d16 v144, v144
ds_read_u16_d16_hi v145, v145
v_mfma_f32_32x32x16_bf16 v[120:135], v[88:91], v[216:219], v[120:135]
v_rcp_f16_e64 v148, v147
v_rcp_f16_sdwa v154, v153 dst_sel:WORD_1 dst_unused:UNUSED_PRESERVE src0_sel:WORD_1
v_add_f32 v170, 925353388, v170
v_fma_mix_f32 v165, v136, v136, v165 op_sel:[0,0,0] op_sel_hi:[1,1,0]
s_waitcnt lgkmcnt(5)
v_fma_mix_f32 v165, v137, v137, v165 op_sel:[1,1,0] op_sel_hi:[1,1,0]
v_rcp_f16_sdwa v151, v150 dst_sel:WORD_1 dst_unused:UNUSED_PRESERVE src0_sel:WORD_1
v_rsq_f32 v170, v170
v_fma_mix_f32 v165, v138, v138, v165 op_sel:[0,0,0] op_sel_hi:[1,1,0]
ds_read_b128 v[216:219], v249 offset:20480
v_mfma_f32_32x32x16_bf16 v[120:135], v[92:95], v[220:223], v[120:135]
v_rcp_f16_sdwa v148, v147 dst_sel:WORD_1 dst_unused:UNUSED_PRESERVE src0_sel:WORD_1
v_fma_mix_f32 v165, v139, v139, v165 op_sel:[1,1,0] op_sel_hi:[1,1,0]
v_pk_mul_f16 v155, v155, v154
v_fma_mix_f32 v165, v140, v140, v165 op_sel:[0,0,0] op_sel_hi:[1,1,0]
v_pk_mul_f16 v152, v152, v151
s_waitcnt lgkmcnt(5)
v_fma_mix_f32 v165, v141, v141, v165 op_sel:[1,1,0] op_sel_hi:[1,1,0]
v_pk_mul_f16 v149, v149, v148
v_fma_mix_f32 v165, v155, v155, v165 op_sel:[0,0,0] op_sel_hi:[1,1,0]
v_mul_f32 v172, 3203391086, v170
v_fma_mix_f32 v165, v142, v142, v165 op_sel:[0,0,0] op_sel_hi:[1,1,0]
v_fma_mix_f32 v165, v155, v155, v165 op_sel:[1,1,0] op_sel_hi:[1,1,0]
s_waitcnt lgkmcnt(1)
v_fma_mix_f32 v165, v143, v143, v165 op_sel:[1,1,0] op_sel_hi:[1,1,0]
v_fma_mix_f32 v165, v152, v152, v165 op_sel:[0,0,0] op_sel_hi:[1,1,0]
v_fma_mix_f32 v165, v152, v152, v165 op_sel:[1,1,0] op_sel_hi:[1,1,0]
v_mul_f32 v173, v168, v172
v_fma_mix_f32 v165, v144, v144, v165 op_sel:[0,0,0] op_sel_hi:[1,1,0]
v_fma_mix_f32 v165, v149, v149, v165 op_sel:[0,0,0] op_sel_hi:[1,1,0]
v_fma_mix_f32 v165, v145, v145, v165 op_sel:[1,1,0] op_sel_hi:[1,1,0]
v_fma_mix_f32 v165, v149, v149, v165 op_sel:[1,1,0] op_sel_hi:[1,1,0]
s_setprio 3
v_pk_fma_f32 v[0:1], v[0:1], v[172:173], v[172:173] op_sel:[0,0,1] op_sel_hi:[1,0,1] neg_lo:[0,0,1] neg_hi:[0,0,1]
v_pk_fma_f32 v[2:3], v[2:3], v[172:173], v[172:173] op_sel:[0,0,1] op_sel_hi:[1,0,1] neg_lo:[0,0,1] neg_hi:[0,0,1]
v_pk_fma_f32 v[4:5], v[4:5], v[172:173], v[172:173] op_sel:[0,0,1] op_sel_hi:[1,0,1] neg_lo:[0,0,1] neg_hi:[0,0,1]
v_pk_fma_f32 v[6:7], v[6:7], v[172:173], v[172:173] op_sel:[0,0,1] op_sel_hi:[1,0,1] neg_lo:[0,0,1] neg_hi:[0,0,1]
v_pk_fma_f32 v[8:9], v[8:9], v[172:173], v[172:173] op_sel:[0,0,1] op_sel_hi:[1,0,1] neg_lo:[0,0,1] neg_hi:[0,0,1]
v_pk_fma_f32 v[10:11], v[10:11], v[172:173], v[172:173] op_sel:[0,0,1] op_sel_hi:[1,0,1] neg_lo:[0,0,1] neg_hi:[0,0,1]
v_pk_fma_f32 v[12:13], v[12:13], v[172:173], v[172:173] op_sel:[0,0,1] op_sel_hi:[1,0,1] neg_lo:[0,0,1] neg_hi:[0,0,1]
v_pk_fma_f32 v[14:15], v[14:15], v[172:173], v[172:173] op_sel:[0,0,1] op_sel_hi:[1,0,1] neg_lo:[0,0,1] neg_hi:[0,0,1]
v_pk_fma_f32 v[16:17], v[16:17], v[172:173], v[172:173] op_sel:[0,0,1] op_sel_hi:[1,0,1] neg_lo:[0,0,1] neg_hi:[0,0,1]
v_pk_fma_f32 v[18:19], v[18:19], v[172:173], v[172:173] op_sel:[0,0,1] op_sel_hi:[1,0,1] neg_lo:[0,0,1] neg_hi:[0,0,1]
v_pk_fma_f32 v[20:21], v[20:21], v[172:173], v[172:173] op_sel:[0,0,1] op_sel_hi:[1,0,1] neg_lo:[0,0,1] neg_hi:[0,0,1]
v_pk_fma_f32 v[22:23], v[22:23], v[172:173], v[172:173] op_sel:[0,0,1] op_sel_hi:[1,0,1] neg_lo:[0,0,1] neg_hi:[0,0,1]
v_pk_fma_f32 v[24:25], v[24:25], v[172:173], v[172:173] op_sel:[0,0,1] op_sel_hi:[1,0,1] neg_lo:[0,0,1] neg_hi:[0,0,1]
v_pk_fma_f32 v[26:27], v[26:27], v[172:173], v[172:173] op_sel:[0,0,1] op_sel_hi:[1,0,1] neg_lo:[0,0,1] neg_hi:[0,0,1]
v_pk_fma_f32 v[28:29], v[28:29], v[172:173], v[172:173] op_sel:[0,0,1] op_sel_hi:[1,0,1] neg_lo:[0,0,1] neg_hi:[0,0,1]
v_pk_fma_f32 v[30:31], v[30:31], v[172:173], v[172:173] op_sel:[0,0,1] op_sel_hi:[1,0,1] neg_lo:[0,0,1] neg_hi:[0,0,1]
v_pk_fma_f32 v[32:33], v[32:33], v[172:173], v[172:173] op_sel:[0,0,1] op_sel_hi:[1,0,1] neg_lo:[0,0,1] neg_hi:[0,0,1]
v_pk_fma_f32 v[34:35], v[34:35], v[172:173], v[172:173] op_sel:[0,0,1] op_sel_hi:[1,0,1] neg_lo:[0,0,1] neg_hi:[0,0,1]
v_pk_fma_f32 v[36:37], v[36:37], v[172:173], v[172:173] op_sel:[0,0,1] op_sel_hi:[1,0,1] neg_lo:[0,0,1] neg_hi:[0,0,1]
v_pk_fma_f32 v[38:39], v[38:39], v[172:173], v[172:173] op_sel:[0,0,1] op_sel_hi:[1,0,1] neg_lo:[0,0,1] neg_hi:[0,0,1]
v_pk_fma_f32 v[40:41], v[40:41], v[172:173], v[172:173] op_sel:[0,0,1] op_sel_hi:[1,0,1] neg_lo:[0,0,1] neg_hi:[0,0,1]
v_pk_fma_f32 v[42:43], v[42:43], v[172:173], v[172:173] op_sel:[0,0,1] op_sel_hi:[1,0,1] neg_lo:[0,0,1] neg_hi:[0,0,1]
v_pk_fma_f32 v[44:45], v[44:45], v[172:173], v[172:173] op_sel:[0,0,1] op_sel_hi:[1,0,1] neg_lo:[0,0,1] neg_hi:[0,0,1]
v_pk_fma_f32 v[46:47], v[46:47], v[172:173], v[172:173] op_sel:[0,0,1] op_sel_hi:[1,0,1] neg_lo:[0,0,1] neg_hi:[0,0,1]
s_setprio 2
v_cvt_pkrtz_f16_f32 v137, v120, v121
v_cvt_pkrtz_f16_f32 v139, v122, v123
v_cvt_pkrtz_f16_f32 v141, v124, v125
v_cvt_pkrtz_f16_f32 v143, v126, v127
v_cvt_pkrtz_f16_f32 v145, v128, v129
v_cvt_pk_f16_f32 v155, v130, v131
v_cvt_pk_f16_f32 v152, v132, v133
v_cvt_pk_f16_f32 v149, v134, v135
s_add_u32 m0, s67, 59904
s_add_u32 s66, s66, 98304
buffer_load_dwordx4 v240, s[4:7], s66 offen lds
ds_read_b128 v[220:223], v249 offset:23552
v_mfma_f32_32x32x16_bf16 v[120:135], v[72:75], v[224:227], 0
v_pk_fma_f16 v154, v155, v155, s48
v_cvt_pk_bf16_f32 v96, v0, v1
v_and_b32 v137, s49, v137
v_pk_fma_f16 v151, v152, v152, s48
v_cvt_pk_bf16_f32 v97, v2, v3
v_and_b32_e64 v139, s49, v139
v_pk_fma_f16 v148, v149, v149, s48
v_pk_mul_f16 v154, v155, v154
v_cvt_pk_bf16_f32 v98, v4, v5
v_bfe_u32 v136, v137, 2, 14
v_pk_mul_f16 v151, v152, v151
v_pk_mul_f16 v148, v149, v148
v_cvt_pk_bf16_f32 v99, v6, v7
v_bfe_u32 v138, v139, 2, 14
ds_read_b128 v[224:227], v248 offset:16384
ds_read_u16_d16 v136, v136
ds_read_u16_d16 v138, v138
v_mfma_f32_32x32x16_bf16 v[120:135], v[76:79], v[228:231], v[120:135]
v_exp_f16_e64 v153, v154
v_cvt_pk_bf16_f32 v100, v8, v9
v_lshrrev_b32 v137, 18, v137
v_exp_f16 v150, v151
v_cvt_pk_bf16_f32 v101, v10, v11
v_lshrrev_b32 v139, 18, v139
v_exp_f16 v147, v148
v_cvt_pk_bf16_f32 v102, v12, v13
v_and_b32_e64 v141, s49, v141
v_and_b32 v143, s49, v143
v_cvt_pk_bf16_f32 v103, v14, v15
s_add_u32 m0, s67, 0
s_add_u32 s66, s66, 98304
buffer_load_dwordx4 v240, s[4:7], s66 offen lds
ds_read_b128 v[228:231], v248 offset:19456
ds_read_u16_d16_hi v137, v137
ds_read_u16_d16_hi v139, v139
v_mfma_f32_32x32x16_bf16 v[120:135], v[80:83], v[232:235], v[120:135]
v_exp_f16_sdwa v153, v154 dst_sel:WORD_1 dst_unused:UNUSED_PRESERVE src0_sel:WORD_1
v_bfe_u32 v140, v141, 2, 14
v_cvt_pk_bf16_f32 v104, v16, v17
v_exp_f16_sdwa v150, v151 dst_sel:WORD_1 dst_unused:UNUSED_PRESERVE src0_sel:WORD_1
v_bfe_u32 v142, v143, 2, 14
v_cvt_pk_bf16_f32 v105, v18, v19
v_exp_f16_sdwa v147, v148 dst_sel:WORD_1 dst_unused:UNUSED_PRESERVE src0_sel:WORD_1
v_cvt_pk_bf16_f32 v106, v20, v21
v_lshrrev_b32_e64 v141, 18, v141
v_pk_add_f16 v153, v153, 1.0 op_sel_hi:[1,0]
v_lshrrev_b32_e64 v143, 18, v143
ds_read_b128 v[232:235], v248 offset:17408
ds_read_u16_d16 v140, v140
ds_read_u16_d16 v142, v142
ds_read_u16_d16_hi v141, v141
ds_read_u16_d16_hi v143, v143
v_mfma_f32_32x32x16_bf16 v[120:135], v[84:87], v[236:239], v[120:135]
v_cvt_pk_bf16_f32 v107, v22, v23
v_pk_add_f16 v150, v150, 1.0 op_sel_hi:[1,0]
v_pk_add_f16 v147, v147, 1.0 op_sel_hi:[1,0]
v_and_b32_e64 v145, s49, v145
v_cvt_pk_bf16_f32 v108, v24, v25
v_rcp_f16_e64 v154, v153
v_bfe_u32 v144, v145, 2, 14
v_cvt_pk_bf16_f32 v109, v26, v27
v_rcp_f16_e64 v151, v150
v_lshrrev_b32 v145, 18, v145
v_cvt_pk_bf16_f32 v110, v28, v29
s_waitcnt lgkmcnt(5)
s_add_u32 m0, s67, 6656
s_add_u32 s66, s66, 98304
buffer_load_dwordx4 v240, s[4:7], s66 offen lds
ds_read_b128 v[236:239], v248 offset:20480
ds_read_u16_d16 v144, v144
ds_read_u16_d16_hi v145, v145
v_mfma_f32_32x32x16_bf16 v[120:135], v[88:91], v[216:219], v[120:135]
v_rcp_f16_e64 v148, v147
v_cvt_pk_bf16_f32 v111, v30, v31
v_rcp_f16_sdwa v154, v153 dst_sel:WORD_1 dst_unused:UNUSED_PRESERVE src0_sel:WORD_1
v_fma_mix_f32 v166, v136, v136, v166 op_sel:[0,0,0] op_sel_hi:[1,1,0]
v_cvt_pk_bf16_f32 v112, v32, v33
v_fma_mix_f32 v166, v137, v137, v166 op_sel:[1,1,0] op_sel_hi:[1,1,0]
v_rcp_f16_sdwa v151, v150 dst_sel:WORD_1 dst_unused:UNUSED_PRESERVE src0_sel:WORD_1
v_cvt_pk_bf16_f32 v113, v34, v35
v_fma_mix_f32 v166, v138, v138, v166 op_sel:[0,0,0] op_sel_hi:[1,1,0]
v_rcp_f16_sdwa v148, v147 dst_sel:WORD_1 dst_unused:UNUSED_PRESERVE src0_sel:WORD_1
v_cvt_pk_bf16_f32 v114, v36, v37
ds_read_b128 v[216:219], v248 offset:18432
v_mfma_f32_32x32x16_bf16 v[120:135], v[92:95], v[220:223], v[120:135]
v_fma_mix_f32 v166, v139, v139, v166 op_sel:[1,1,0] op_sel_hi:[1,1,0]
v_pk_mul_f16 v155, v155, v154
s_waitcnt lgkmcnt(4)
v_fma_mix_f32 v166, v140, v140, v166 op_sel:[0,0,0] op_sel_hi:[1,1,0]
v_cvt_pk_bf16_f32 v115, v38, v39
v_pk_mul_f16 v152, v152, v151
v_fma_mix_f32 v166, v141, v141, v166 op_sel:[1,1,0] op_sel_hi:[1,1,0]
v_cvt_pk_bf16_f32 v116, v40, v41
v_pk_mul_f16 v149, v149, v148
v_fma_mix_f32 v166, v155, v155, v166 op_sel:[0,0,0] op_sel_hi:[1,1,0]
v_fma_mix_f32 v166, v142, v142, v166 op_sel:[0,0,0] op_sel_hi:[1,1,0]
v_cvt_pk_bf16_f32 v117, v42, v43
v_fma_mix_f32 v166, v155, v155, v166 op_sel:[1,1,0] op_sel_hi:[1,1,0]
v_fma_mix_f32 v166, v143, v143, v166 op_sel:[1,1,0] op_sel_hi:[1,1,0]
v_fma_mix_f32 v166, v152, v152, v166 op_sel:[0,0,0] op_sel_hi:[1,1,0]
v_cvt_pk_bf16_f32 v118, v44, v45
v_fma_mix_f32 v166, v152, v152, v166 op_sel:[1,1,0] op_sel_hi:[1,1,0]
s_waitcnt lgkmcnt(1)
v_fma_mix_f32 v166, v144, v144, v166 op_sel:[0,0,0] op_sel_hi:[1,1,0]
v_fma_mix_f32 v166, v149, v149, v166 op_sel:[0,0,0] op_sel_hi:[1,1,0]
v_cvt_pk_bf16_f32 v119, v46, v47
v_fma_mix_f32 v166, v145, v145, v166 op_sel:[1,1,0] op_sel_hi:[1,1,0]
v_fma_mix_f32 v166, v149, v149, v166 op_sel:[1,1,0] op_sel_hi:[1,1,0]
v_cvt_pkrtz_f16_f32 v137, v120, v121
v_cvt_pkrtz_f16_f32 v139, v122, v123
v_cvt_pkrtz_f16_f32 v141, v124, v125
v_cvt_pkrtz_f16_f32 v143, v126, v127
v_cvt_pkrtz_f16_f32 v145, v128, v129
v_cvt_pk_f16_f32 v155, v130, v131
v_cvt_pk_f16_f32 v152, v132, v133
v_cvt_pk_f16_f32 v149, v134, v135
s_add_u32 m0, s67, 13312
s_add_u32 s66, s66, 98304
buffer_load_dwordx4 v240, s[4:7], s66 offen lds
ds_read_b128 v[220:223], v248 offset:21504
v_mfma_f32_32x32x16_bf16 v[120:135], v[96:99], v[224:227], 0
v_pk_fma_f16 v154, v155, v155, s48
v_and_b32_e64 v137, s49, v137
v_pk_fma_f16 v151, v152, v152, s48
v_and_b32_e64 v139, s49, v139
v_pk_fma_f16 v148, v149, v149, s48
v_pk_mul_f16 v154, v155, v154
v_bfe_u32 v136, v137, 2, 14
v_pk_mul_f16 v151, v152, v151
v_pk_mul_f16 v148, v149, v148
v_bfe_u32 v138, v139, 2, 14
ds_read_b128 v[224:227], v248 offset:22528
ds_read_u16_d16 v136, v136
ds_read_u16_d16 v138, v138
v_mfma_f32_32x32x16_bf16 v[120:135], v[100:103], v[228:231], v[120:135]
v_exp_f16 v153, v154
v_lshrrev_b32 v137, 18, v137
v_exp_f16 v150, v151
v_lshrrev_b32 v139, 18, v139
v_exp_f16 v147, v148
v_and_b32 v141, s49, v141
v_and_b32_e64 v143, s49, v143
ds_read_b128 v[228:231], v248 offset:25600
ds_read_u16_d16_hi v137, v137
ds_read_u16_d16_hi v139, v139
v_mfma_f32_32x32x16_bf16 v[120:135], v[104:107], v[232:235], v[120:135]
v_exp_f16_sdwa v153, v154 dst_sel:WORD_1 dst_unused:UNUSED_PRESERVE src0_sel:WORD_1
v_bfe_u32 v140, v141, 2, 14
v_exp_f16_sdwa v150, v151 dst_sel:WORD_1 dst_unused:UNUSED_PRESERVE src0_sel:WORD_1
v_bfe_u32 v142, v143, 2, 14
v_exp_f16_sdwa v147, v148 dst_sel:WORD_1 dst_unused:UNUSED_PRESERVE src0_sel:WORD_1
v_lshrrev_b32_e64 v141, 18, v141
v_pk_add_f16 v153, v153, 1.0 op_sel_hi:[1,0]
s_add_u32 m0, s67, 19968
s_add_u32 s66, s66, 98304
buffer_load_dwordx4 v240, s[4:7], s66 offen lds
ds_read_b128 v[232:235], v248 offset:23552
ds_read_u16_d16 v140, v140
ds_read_u16_d16 v142, v142
ds_read_u16_d16_hi v141, v141
v_mfma_f32_32x32x16_bf16 v[120:135], v[108:111], v[236:239], v[120:135]
v_lshrrev_b32_e64 v143, 18, v143
v_pk_add_f16 v150, v150, 1.0 op_sel_hi:[1,0]
v_pk_add_f16 v147, v147, 1.0 op_sel_hi:[1,0]
v_and_b32 v145, s49, v145
v_rcp_f16 v154, v153
v_bfe_u32 v144, v145, 2, 14
v_rcp_f16_e64 v151, v150
v_lshrrev_b32 v145, 18, v145
s_waitcnt lgkmcnt(4)
ds_read_b128 v[236:239], v248 offset:26624
ds_read_u16_d16_hi v143, v143
ds_read_u16_d16 v144, v144
ds_read_u16_d16_hi v145, v145
v_mfma_f32_32x32x16_bf16 v[120:135], v[112:115], v[216:219], v[120:135]
v_rcp_f16_e64 v148, v147
v_rcp_f16_sdwa v154, v153 dst_sel:WORD_1 dst_unused:UNUSED_PRESERVE src0_sel:WORD_1
v_fma_mix_f32 v167, v136, v136, v167 op_sel:[0,0,0] op_sel_hi:[1,1,0]
v_fma_mix_f32 v167, v137, v137, v167 op_sel:[1,1,0] op_sel_hi:[1,1,0]
v_rcp_f16_sdwa v151, v150 dst_sel:WORD_1 dst_unused:UNUSED_PRESERVE src0_sel:WORD_1
v_fma_mix_f32 v167, v138, v138, v167 op_sel:[0,0,0] op_sel_hi:[1,1,0]
s_setprio 1
ds_read_b128 v[216:219], v248 offset:24576
v_mfma_f32_32x32x16_bf16 v[120:135], v[116:119], v[220:223], v[120:135]
v_rcp_f16_sdwa v148, v147 dst_sel:WORD_1 dst_unused:UNUSED_PRESERVE src0_sel:WORD_1
v_fma_mix_f32 v167, v139, v139, v167 op_sel:[1,1,0] op_sel_hi:[1,1,0]
v_pk_mul_f16 v155, v155, v154
s_waitcnt lgkmcnt(5)
v_fma_mix_f32 v167, v140, v140, v167 op_sel:[0,0,0] op_sel_hi:[1,1,0]
v_pk_mul_f16 v152, v152, v151
v_fma_mix_f32 v167, v141, v141, v167 op_sel:[1,1,0] op_sel_hi:[1,1,0]
v_pk_mul_f16 v149, v149, v148
v_fma_mix_f32 v167, v155, v155, v167 op_sel:[0,0,0] op_sel_hi:[1,1,0]
v_fma_mix_f32 v167, v142, v142, v167 op_sel:[0,0,0] op_sel_hi:[1,1,0]
v_fma_mix_f32 v167, v155, v155, v167 op_sel:[1,1,0] op_sel_hi:[1,1,0]
s_waitcnt lgkmcnt(3)
v_fma_mix_f32 v167, v143, v143, v167 op_sel:[1,1,0] op_sel_hi:[1,1,0]
v_fma_mix_f32 v167, v152, v152, v167 op_sel:[0,0,0] op_sel_hi:[1,1,0]
v_fma_mix_f32 v167, v152, v152, v167 op_sel:[1,1,0] op_sel_hi:[1,1,0]
s_waitcnt lgkmcnt(1)
v_fma_mix_f32 v167, v144, v144, v167 op_sel:[0,0,0] op_sel_hi:[1,1,0]
v_fma_mix_f32 v167, v149, v149, v167 op_sel:[0,0,0] op_sel_hi:[1,1,0]
v_fma_mix_f32 v167, v145, v145, v167 op_sel:[1,1,0] op_sel_hi:[1,1,0]
v_fma_mix_f32 v167, v149, v149, v167 op_sel:[1,1,0] op_sel_hi:[1,1,0]
v_cvt_pkrtz_f16_f32 v137, v120, v121
v_cvt_pkrtz_f16_f32 v139, v122, v123
v_cvt_pkrtz_f16_f32 v141, v124, v125
v_cvt_pkrtz_f16_f32 v143, v126, v127
v_cvt_pkrtz_f16_f32 v145, v128, v129
v_cvt_pk_f16_f32 v155, v130, v131
v_cvt_pk_f16_f32 v152, v132, v133
v_cvt_pk_f16_f32 v149, v134, v135
ds_read_b128 v[220:223], v248 offset:27648
v_mfma_f32_32x32x16_bf16 v[120:135], v[96:99], v[224:227], 0
v_pk_fma_f16 v154, v155, v155, s48
v_and_b32_e64 v137, s49, v137
v_pk_fma_f16 v151, v152, v152, s48
v_and_b32_e64 v139, s49, v139
v_pk_fma_f16 v148, v149, v149, s48
v_pk_mul_f16 v154, v155, v154
v_bfe_u32 v136, v137, 2, 14
v_pk_mul_f16 v151, v152, v151
v_pk_mul_f16 v148, v149, v148
v_bfe_u32 v138, v139, 2, 14
ds_read_b128 v[224:227], v248 offset:28672
ds_read_u16_d16 v136, v136
ds_read_u16_d16 v138, v138
v_mfma_f32_32x32x16_bf16 v[120:135], v[100:103], v[228:231], v[120:135]
v_exp_f16 v153, v154
v_lshrrev_b32 v137, 18, v137
v_exp_f16 v150, v151
v_lshrrev_b32 v139, 18, v139
v_exp_f16 v147, v148
v_and_b32 v141, s49, v141
v_and_b32_e64 v143, s49, v143
ds_read_b128 v[228:231], v248 offset:31744
ds_read_u16_d16_hi v137, v137
ds_read_u16_d16_hi v139, v139
v_mfma_f32_32x32x16_bf16 v[120:135], v[104:107], v[232:235], v[120:135]
v_exp_f16_sdwa v153, v154 dst_sel:WORD_1 dst_unused:UNUSED_PRESERVE src0_sel:WORD_1
v_bfe_u32 v140, v141, 2, 14
v_exp_f16_sdwa v150, v151 dst_sel:WORD_1 dst_unused:UNUSED_PRESERVE src0_sel:WORD_1
v_bfe_u32 v142, v143, 2, 14
v_exp_f16_sdwa v147, v148 dst_sel:WORD_1 dst_unused:UNUSED_PRESERVE src0_sel:WORD_1
v_lshrrev_b32_e64 v141, 18, v141
v_pk_add_f16 v153, v153, 1.0 op_sel_hi:[1,0]
ds_read_b128 v[232:235], v248 offset:29696
ds_read_u16_d16 v140, v140
ds_read_u16_d16 v142, v142
ds_read_u16_d16_hi v141, v141
v_mfma_f32_32x32x16_bf16 v[120:135], v[108:111], v[236:239], v[120:135]
v_lshrrev_b32_e64 v143, 18, v143
v_pk_add_f16 v150, v150, 1.0 op_sel_hi:[1,0]
v_pk_add_f16 v147, v147, 1.0 op_sel_hi:[1,0]
v_and_b32 v145, s49, v145
v_rcp_f16 v154, v153
v_bfe_u32 v144, v145, 2, 14
v_rcp_f16_e64 v151, v150
v_lshrrev_b32 v145, 18, v145
s_waitcnt lgkmcnt(7)
ds_read_b128 v[236:239], v248 offset:32768
ds_read_u16_d16_hi v143, v143
ds_read_u16_d16 v144, v144
ds_read_u16_d16_hi v145, v145
v_mfma_f32_32x32x16_bf16 v[120:135], v[112:115], v[216:219], v[120:135]
v_rcp_f16_e64 v148, v147
v_rcp_f16_sdwa v154, v153 dst_sel:WORD_1 dst_unused:UNUSED_PRESERVE src0_sel:WORD_1
v_fma_mix_f32 v156, v136, v136, v156 op_sel:[0,0,0] op_sel_hi:[1,1,0]
s_waitcnt lgkmcnt(8)
v_fma_mix_f32 v156, v137, v137, v156 op_sel:[1,1,0] op_sel_hi:[1,1,0]
v_rcp_f16_sdwa v151, v150 dst_sel:WORD_1 dst_unused:UNUSED_PRESERVE src0_sel:WORD_1
v_fma_mix_f32 v156, v138, v138, v156 op_sel:[0,0,0] op_sel_hi:[1,1,0]
ds_read_b128 v[216:219], v248 offset:30720
v_mfma_f32_32x32x16_bf16 v[120:135], v[116:119], v[220:223], v[120:135]
v_rcp_f16_sdwa v148, v147 dst_sel:WORD_1 dst_unused:UNUSED_PRESERVE src0_sel:WORD_1
v_fma_mix_f32 v156, v139, v139, v156 op_sel:[1,1,0] op_sel_hi:[1,1,0]
v_pk_mul_f16 v155, v155, v154
s_waitcnt lgkmcnt(5)
v_fma_mix_f32 v156, v140, v140, v156 op_sel:[0,0,0] op_sel_hi:[1,1,0]
v_pk_mul_f16 v152, v152, v151
v_fma_mix_f32 v156, v141, v141, v156 op_sel:[1,1,0] op_sel_hi:[1,1,0]
v_pk_mul_f16 v149, v149, v148
v_fma_mix_f32 v156, v155, v155, v156 op_sel:[0,0,0] op_sel_hi:[1,1,0]
v_fma_mix_f32 v156, v142, v142, v156 op_sel:[0,0,0] op_sel_hi:[1,1,0]
v_fma_mix_f32 v156, v155, v155, v156 op_sel:[1,1,0] op_sel_hi:[1,1,0]
s_waitcnt lgkmcnt(3)
v_fma_mix_f32 v156, v143, v143, v156 op_sel:[1,1,0] op_sel_hi:[1,1,0]
v_fma_mix_f32 v156, v152, v152, v156 op_sel:[0,0,0] op_sel_hi:[1,1,0]
v_fma_mix_f32 v156, v152, v152, v156 op_sel:[1,1,0] op_sel_hi:[1,1,0]
s_waitcnt lgkmcnt(1)
v_fma_mix_f32 v156, v144, v144, v156 op_sel:[0,0,0] op_sel_hi:[1,1,0]
v_fma_mix_f32 v156, v149, v149, v156 op_sel:[0,0,0] op_sel_hi:[1,1,0]
v_fma_mix_f32 v156, v145, v145, v156 op_sel:[1,1,0] op_sel_hi:[1,1,0]
v_fma_mix_f32 v156, v149, v149, v156 op_sel:[1,1,0] op_sel_hi:[1,1,0]
v_cvt_pkrtz_f16_f32 v137, v120, v121
v_cvt_pkrtz_f16_f32 v139, v122, v123
v_cvt_pkrtz_f16_f32 v141, v124, v125
v_cvt_pkrtz_f16_f32 v143, v126, v127
v_cvt_pkrtz_f16_f32 v145, v128, v129
v_cvt_pk_f16_f32 v155, v130, v131
v_cvt_pk_f16_f32 v152, v132, v133
v_cvt_pk_f16_f32 v149, v134, v135
ds_read_b128 v[220:223], v248 offset:33792
v_mfma_f32_32x32x16_bf16 v[120:135], v[96:99], v[224:227], 0
v_pk_fma_f16 v154, v155, v155, s48
v_and_b32_e64 v137, s49, v137
v_pk_fma_f16 v151, v152, v152, s48
v_and_b32_e64 v139, s49, v139
v_pk_fma_f16 v148, v149, v149, s48
v_pk_mul_f16 v154, v155, v154
v_bfe_u32 v136, v137, 2, 14
v_pk_mul_f16 v151, v152, v151
v_pk_mul_f16 v148, v149, v148
v_bfe_u32 v138, v139, 2, 14
ds_read_b128 v[224:227], v248 offset:34816
ds_read_u16_d16 v136, v136
ds_read_u16_d16 v138, v138
v_mfma_f32_32x32x16_bf16 v[120:135], v[100:103], v[228:231], v[120:135]
v_exp_f16 v153, v154
v_lshrrev_b32 v137, 18, v137
v_exp_f16 v150, v151
v_lshrrev_b32 v139, 18, v139
v_exp_f16 v147, v148
v_and_b32 v141, s49, v141
v_and_b32_e64 v143, s49, v143
ds_read_b128 v[228:231], v248 offset:37888
ds_read_u16_d16_hi v137, v137
ds_read_u16_d16_hi v139, v139
v_mfma_f32_32x32x16_bf16 v[120:135], v[104:107], v[232:235], v[120:135]
v_exp_f16_sdwa v153, v154 dst_sel:WORD_1 dst_unused:UNUSED_PRESERVE src0_sel:WORD_1
v_bfe_u32 v140, v141, 2, 14
v_exp_f16_sdwa v150, v151 dst_sel:WORD_1 dst_unused:UNUSED_PRESERVE src0_sel:WORD_1
v_bfe_u32 v142, v143, 2, 14
v_exp_f16_sdwa v147, v148 dst_sel:WORD_1 dst_unused:UNUSED_PRESERVE src0_sel:WORD_1
v_lshrrev_b32_e64 v141, 18, v141
v_pk_add_f16 v153, v153, 1.0 op_sel_hi:[1,0]
ds_read_b128 v[232:235], v248 offset:35840
ds_read_u16_d16 v140, v140
ds_read_u16_d16 v142, v142
ds_read_u16_d16_hi v141, v141
v_mfma_f32_32x32x16_bf16 v[120:135], v[108:111], v[236:239], v[120:135]
v_lshrrev_b32_e64 v143, 18, v143
v_pk_add_f16 v150, v150, 1.0 op_sel_hi:[1,0]
v_pk_add_f16 v147, v147, 1.0 op_sel_hi:[1,0]
v_and_b32 v145, s49, v145
v_rcp_f16 v154, v153
v_bfe_u32 v144, v145, 2, 14
v_rcp_f16_e64 v151, v150
v_lshrrev_b32 v145, 18, v145
s_waitcnt lgkmcnt(7)
ds_read_b128 v[236:239], v248 offset:38912
ds_read_u16_d16_hi v143, v143
ds_read_u16_d16 v144, v144
ds_read_u16_d16_hi v145, v145
v_mfma_f32_32x32x16_bf16 v[120:135], v[112:115], v[216:219], v[120:135]
v_rcp_f16 v148, v147
v_rcp_f16_sdwa v154, v153 dst_sel:WORD_1 dst_unused:UNUSED_PRESERVE src0_sel:WORD_1
s_setprio 0
v_fma_mix_f32 v157, v136, v136, v157 op_sel:[0,0,0] op_sel_hi:[1,1,0]
s_waitcnt lgkmcnt(8)
v_fma_mix_f32 v157, v137, v137, v157 op_sel:[1,1,0] op_sel_hi:[1,1,0]
v_rcp_f16_sdwa v151, v150 dst_sel:WORD_1 dst_unused:UNUSED_PRESERVE src0_sel:WORD_1
v_fma_mix_f32 v157, v138, v138, v157 op_sel:[0,0,0] op_sel_hi:[1,1,0]
ds_read_b128 v[216:219], v248 offset:36864
v_mfma_f32_32x32x16_bf16 v[120:135], v[116:119], v[220:223], v[120:135]
v_rcp_f16_sdwa v148, v147 dst_sel:WORD_1 dst_unused:UNUSED_PRESERVE src0_sel:WORD_1
v_fma_mix_f32 v157, v139, v139, v157 op_sel:[1,1,0] op_sel_hi:[1,1,0]
v_pk_mul_f16 v155, v155, v154
s_waitcnt lgkmcnt(5)
v_fma_mix_f32 v157, v140, v140, v157 op_sel:[0,0,0] op_sel_hi:[1,1,0]
v_pk_mul_f16 v152, v152, v151
v_fma_mix_f32 v157, v141, v141, v157 op_sel:[1,1,0] op_sel_hi:[1,1,0]
v_pk_mul_f16 v149, v149, v148
v_fma_mix_f32 v157, v155, v155, v157 op_sel:[0,0,0] op_sel_hi:[1,1,0]
v_fma_mix_f32 v157, v142, v142, v157 op_sel:[0,0,0] op_sel_hi:[1,1,0]
v_fma_mix_f32 v157, v155, v155, v157 op_sel:[1,1,0] op_sel_hi:[1,1,0]
s_waitcnt lgkmcnt(3)
v_fma_mix_f32 v157, v143, v143, v157 op_sel:[1,1,0] op_sel_hi:[1,1,0]
v_fma_mix_f32 v157, v152, v152, v157 op_sel:[0,0,0] op_sel_hi:[1,1,0]
v_fma_mix_f32 v157, v152, v152, v157 op_sel:[1,1,0] op_sel_hi:[1,1,0]
s_waitcnt lgkmcnt(1)
v_fma_mix_f32 v157, v144, v144, v157 op_sel:[0,0,0] op_sel_hi:[1,1,0]
v_fma_mix_f32 v157, v149, v149, v157 op_sel:[0,0,0] op_sel_hi:[1,1,0]
v_fma_mix_f32 v157, v145, v145, v157 op_sel:[1,1,0] op_sel_hi:[1,1,0]
v_fma_mix_f32 v157, v149, v149, v157 op_sel:[1,1,0] op_sel_hi:[1,1,0]
v_cvt_pkrtz_f16_f32 v137, v120, v121
v_cvt_pkrtz_f16_f32 v139, v122, v123
v_cvt_pkrtz_f16_f32 v141, v124, v125
v_cvt_pkrtz_f16_f32 v143, v126, v127
v_cvt_pkrtz_f16_f32 v145, v128, v129
v_cvt_pk_f16_f32 v155, v130, v131
v_cvt_pk_f16_f32 v152, v132, v133
v_cvt_pk_f16_f32 v149, v134, v135
ds_read_b128 v[220:223], v248 offset:39936
v_mfma_f32_32x32x16_bf16 v[120:135], v[96:99], v[224:227], 0
v_pk_fma_f16 v154, v155, v155, s48
v_and_b32_e64 v137, s49, v137
v_pk_fma_f16 v151, v152, v152, s48
v_and_b32_e64 v139, s49, v139
v_pk_fma_f16 v148, v149, v149, s48
v_pk_mul_f16 v154, v155, v154
v_bfe_u32 v136, v137, 2, 14
v_pk_mul_f16 v151, v152, v151
v_pk_mul_f16 v148, v149, v148
v_bfe_u32 v138, v139, 2, 14
ds_read_b64 v[224:225], v245 offset:384
ds_read_b64 v[226:227], v246 offset:384
s_waitcnt vmcnt(0)
s_barrier
ds_read_b128 v[192:195], v242
ds_read_u16_d16 v136, v136
ds_read_u16_d16 v138, v138
v_mfma_f32_32x32x16_bf16 v[120:135], v[100:103], v[228:231], v[120:135]
v_exp_f16 v153, v154
v_lshrrev_b32 v137, 18, v137
v_exp_f16 v150, v151
v_lshrrev_b32 v139, 18, v139
v_exp_f16 v147, v148
v_and_b32 v141, s49, v141
v_and_b32_e64 v143, s49, v143
ds_read_b128 v[228:231], v248 offset:40960
ds_read_u16_d16_hi v137, v137
ds_read_u16_d16_hi v139, v139
v_mfma_f32_32x32x16_bf16 v[120:135], v[104:107], v[232:235], v[120:135]
v_exp_f16_sdwa v153, v154 dst_sel:WORD_1 dst_unused:UNUSED_PRESERVE src0_sel:WORD_1
v_bfe_u32 v140, v141, 2, 14
v_exp_f16_sdwa v150, v151 dst_sel:WORD_1 dst_unused:UNUSED_PRESERVE src0_sel:WORD_1
v_bfe_u32 v142, v143, 2, 14
v_exp_f16_sdwa v147, v148 dst_sel:WORD_1 dst_unused:UNUSED_PRESERVE src0_sel:WORD_1
v_lshrrev_b32 v141, 18, v141
v_pk_add_f16 v153, v153, 1.0 op_sel_hi:[1,0]
s_setprio 2
ds_read_b128 v[232:235], v248 offset:44032
ds_read_u16_d16 v140, v140
ds_read_u16_d16 v142, v142
ds_read_u16_d16_hi v141, v141
v_mfma_f32_32x32x16_bf16 v[120:135], v[108:111], v[236:239], v[120:135]
v_lshrrev_b32_e64 v143, 18, v143
v_pk_add_f16 v150, v150, 1.0 op_sel_hi:[1,0]
v_pk_add_f16 v147, v147, 1.0 op_sel_hi:[1,0]
v_and_b32 v145, s49, v145
v_rcp_f16 v154, v153
v_bfe_u32 v144, v145, 2, 14
v_rcp_f16_e64 v151, v150
v_lshrrev_b32 v145, 18, v145
s_waitcnt lgkmcnt(6)
ds_read_b64 v[236:237], v245 offset:1152
ds_read_b64 v[238:239], v246 offset:1152
ds_read_b128 v[196:199], v242 offset:64
ds_read_u16_d16_hi v143, v143
ds_read_u16_d16 v144, v144
ds_read_u16_d16_hi v145, v145
v_mfma_f32_32x32x16_bf16 v[120:135], v[112:115], v[216:219], v[120:135]
v_rcp_f16_e64 v148, v147
v_rcp_f16_sdwa v154, v153 dst_sel:WORD_1 dst_unused:UNUSED_PRESERVE src0_sel:WORD_1
v_fma_mix_f32 v158, v136, v136, v158 op_sel:[0,0,0] op_sel_hi:[1,1,0]
s_waitcnt lgkmcnt(10)
v_fma_mix_f32 v158, v137, v137, v158 op_sel:[1,1,0] op_sel_hi:[1,1,0]
v_rcp_f16_sdwa v151, v150 dst_sel:WORD_1 dst_unused:UNUSED_PRESERVE src0_sel:WORD_1
v_fma_mix_f32 v158, v138, v138, v158 op_sel:[0,0,0] op_sel_hi:[1,1,0]
ds_read_b128 v[216:219], v248 offset:41984
v_mfma_f32_32x32x16_bf16 v[120:135], v[116:119], v[220:223], v[120:135]
v_rcp_f16_sdwa v148, v147 dst_sel:WORD_1 dst_unused:UNUSED_PRESERVE src0_sel:WORD_1
v_fma_mix_f32 v158, v139, v139, v158 op_sel:[1,1,0] op_sel_hi:[1,1,0]
v_pk_mul_f16 v155, v155, v154
s_waitcnt lgkmcnt(7)
v_fma_mix_f32 v158, v140, v140, v158 op_sel:[0,0,0] op_sel_hi:[1,1,0]
v_pk_mul_f16 v152, v152, v151
v_fma_mix_f32 v158, v141, v141, v158 op_sel:[1,1,0] op_sel_hi:[1,1,0]
v_pk_mul_f16 v149, v149, v148
v_fma_mix_f32 v158, v155, v155, v158 op_sel:[0,0,0] op_sel_hi:[1,1,0]
v_fma_mix_f32 v158, v142, v142, v158 op_sel:[0,0,0] op_sel_hi:[1,1,0]
v_fma_mix_f32 v158, v155, v155, v158 op_sel:[1,1,0] op_sel_hi:[1,1,0]
s_waitcnt lgkmcnt(3)
v_fma_mix_f32 v158, v143, v143, v158 op_sel:[1,1,0] op_sel_hi:[1,1,0]
v_fma_mix_f32 v158, v152, v152, v158 op_sel:[0,0,0] op_sel_hi:[1,1,0]
v_fma_mix_f32 v158, v152, v152, v158 op_sel:[1,1,0] op_sel_hi:[1,1,0]
s_waitcnt lgkmcnt(1)
v_fma_mix_f32 v158, v144, v144, v158 op_sel:[0,0,0] op_sel_hi:[1,1,0]
v_fma_mix_f32 v158, v149, v149, v158 op_sel:[0,0,0] op_sel_hi:[1,1,0]
v_fma_mix_f32 v158, v145, v145, v158 op_sel:[1,1,0] op_sel_hi:[1,1,0]
v_fma_mix_f32 v158, v149, v149, v158 op_sel:[1,1,0] op_sel_hi:[1,1,0]
v_mfma_f32_16x16x32_bf16 v[8:11], v[224:227], v[192:195], 0
ds_read_b128 v[220:223], v248 offset:45056
v_cvt_pkrtz_f16_f32 v137, v120, v121
v_cvt_pkrtz_f16_f32 v139, v122, v123
v_cvt_pkrtz_f16_f32 v141, v124, v125
v_cvt_pkrtz_f16_f32 v143, v126, v127
v_cvt_pk_f16_f32 v155, v128, v129
v_cvt_pk_f16_f32 v152, v130, v131
v_cvt_pk_f16_f32 v149, v132, v133
v_cvt_pk_f16_f32 v146, v134, v135
v_mfma_f32_32x32x16_bf16 v[120:135], v[96:99], v[228:231], 0
ds_read_b64 v[224:225], v245 offset:1920
ds_read_b64 v[226:227], v246 offset:1920
ds_read_b128 v[200:203], v242 offset:128
v_pk_fma_f16 v154, v155, v155, s48
v_and_b32_e64 v137, s49, v137
v_pk_fma_f16 v151, v152, v152, s48
v_pk_fma_f16 v148, v149, v149, s48
v_and_b32_e64 v139, s49, v139
v_pk_fma_f16 v145, v146, v146, s48
v_mfma_f32_32x32x16_bf16 v[120:135], v[100:103], v[232:235], v[120:135]
ds_read_b128 v[228:231], v248 offset:43008
v_pk_mul_f16 v154, v155, v154
v_bfe_u32 v136, v137, 2, 14
v_pk_mul_f16 v151, v152, v151
v_pk_mul_f16 v148, v149, v148
v_bfe_u32 v138, v139, 2, 14
v_pk_mul_f16 v145, v146, v145
v_exp_f16 v153, v154
v_lshrrev_b32 v137, 18, v137
v_mfma_f32_16x16x32_bf16 v[24:27], v[236:239], v[196:199], 0
ds_read_b64 v[232:233], v245 offset:2688
ds_read_b64 v[234:235], v246 offset:2688
ds_read_b128 v[204:207], v243
ds_read_u16_d16 v136, v136
ds_read_u16_d16 v138, v138
ds_read_u16_d16_hi v137, v137
v_exp_f16 v150, v151
v_lshrrev_b32 v139, 18, v139
v_exp_f16 v147, v148
s_waitcnt lgkmcnt(7)
v_mfma_f32_32x32x16_bf16 v[120:135], v[104:107], v[216:219], v[120:135]
ds_read_b128 v[236:239], v248 offset:46080
ds_read_u16_d16_hi v139, v139
v_and_b32 v141, s49, v141
v_exp_f16 v144, v145
v_and_b32_e64 v143, s49, v143
v_exp_f16_sdwa v153, v154 dst_sel:WORD_1 dst_unused:UNUSED_PRESERVE src0_sel:WORD_1
v_bfe_u32 v140, v141, 2, 14
v_exp_f16_sdwa v150, v151 dst_sel:WORD_1 dst_unused:UNUSED_PRESERVE src0_sel:WORD_1
v_mfma_f32_32x32x16_bf16 v[120:135], v[108:111], v[220:223], v[120:135]
ds_read_b64 v[216:217], v245 offset:3456
ds_read_b64 v[218:219], v246 offset:3456
ds_read_b128 v[208:211], v243 offset:64
ds_read_u16_d16 v140, v140
v_bfe_u32 v142, v143, 2, 14
v_exp_f16_sdwa v147, v148 dst_sel:WORD_1 dst_unused:UNUSED_PRESERVE src0_sel:WORD_1
v_lshrrev_b32_e64 v141, 18, v141
v_exp_f16_sdwa v144, v145 dst_sel:WORD_1 dst_unused:UNUSED_PRESERVE src0_sel:WORD_1
v_lshrrev_b32_e64 v143, 18, v143
v_pk_add_f16 v153, v153, 1.0 op_sel_hi:[1,0]
v_pk_add_f16 v150, v150, 1.0 op_sel_hi:[1,0]
v_mfma_f32_16x16x32_bf16 v[40:43], v[224:227], v[200:203], 0
ds_read_b64 v[220:221], v245 offset:4224
ds_read_b64 v[222:223], v246 offset:4224
ds_read_b128 v[212:215], v243 offset:128
ds_read_u16_d16 v142, v142
ds_read_u16_d16_hi v141, v141
ds_read_u16_d16_hi v143, v143
v_pk_add_f16 v147, v147, 1.0 op_sel_hi:[1,0]
v_pk_add_f16 v144, v144, 1.0 op_sel_hi:[1,0]
v_rcp_f16 v154, v153
s_waitcnt lgkmcnt(10)
v_mfma_f32_32x32x16_bf16 v[120:135], v[112:115], v[228:231], v[120:135]
ds_read_b64 v[224:225], v245 offset:4992
ds_read_b64 v[226:227], v246 offset:4992
ds_read_b128 v[192:195], v244
v_rcp_f16 v151, v150
v_rcp_f16 v148, v147
v_rcp_f16_e64 v145, v144
v_rcp_f16_sdwa v154, v153 dst_sel:WORD_1 dst_unused:UNUSED_PRESERVE src0_sel:WORD_1
v_rcp_f16_sdwa v151, v150 dst_sel:WORD_1 dst_unused:UNUSED_PRESERVE src0_sel:WORD_1
v_mfma_f32_16x16x32_bf16 v[8:11], v[232:235], v[204:207], v[8:11]
ds_read_b128 v[228:231], v248 offset:47104
v_rcp_f16_sdwa v148, v147 dst_sel:WORD_1 dst_unused:UNUSED_PRESERVE src0_sel:WORD_1
v_fma_mix_f32 v159, v136, v136, v159 op_sel:[0,0,0] op_sel_hi:[1,1,0]
v_rcp_f16_sdwa v145, v144 dst_sel:WORD_1 dst_unused:UNUSED_PRESERVE src0_sel:WORD_1
v_mfma_f32_32x32x16_bf16 v[120:135], v[116:119], v[236:239], v[120:135]
ds_read_b128 v[232:235], v248 offset:50176
v_fma_mix_f32 v159, v137, v137, v159 op_sel:[1,1,0] op_sel_hi:[1,1,0]
v_pk_mul_f16 v155, v155, v154
v_fma_mix_f32 v159, v138, v138, v159 op_sel:[0,0,0] op_sel_hi:[1,1,0]
v_pk_mul_f16 v152, v152, v151
v_pk_mul_f16 v149, v149, v148
v_fma_mix_f32 v159, v139, v139, v159 op_sel:[1,1,0] op_sel_hi:[1,1,0]
v_pk_mul_f16 v146, v146, v145
v_fma_mix_f32 v159, v155, v155, v159 op_sel:[0,0,0] op_sel_hi:[1,1,0]
s_waitcnt lgkmcnt(5)
v_fma_mix_f32 v159, v140, v140, v159 op_sel:[0,0,0] op_sel_hi:[1,1,0]
v_mfma_f32_16x16x32_bf16 v[24:27], v[216:219], v[208:211], v[24:27]
ds_read_b64 v[236:237], v245 offset:5760
ds_read_b64 v[238:239], v246 offset:5760
ds_read_b128 v[196:199], v244 offset:64
v_fma_mix_f32 v159, v155, v155, v159 op_sel:[1,1,0] op_sel_hi:[1,1,0]
v_fma_mix_f32 v159, v152, v152, v159 op_sel:[0,0,0] op_sel_hi:[1,1,0]
v_fma_mix_f32 v159, v141, v141, v159 op_sel:[1,1,0] op_sel_hi:[1,1,0]
v_fma_mix_f32 v159, v152, v152, v159 op_sel:[1,1,0] op_sel_hi:[1,1,0]
v_fma_mix_f32 v159, v149, v149, v159 op_sel:[0,0,0] op_sel_hi:[1,1,0]
v_mfma_f32_16x16x32_bf16 v[40:43], v[220:223], v[212:215], v[40:43]
ds_read_b128 v[216:219], v248 offset:48128
v_fma_mix_f32 v159, v142, v142, v159 op_sel:[0,0,0] op_sel_hi:[1,1,0]
v_fma_mix_f32 v159, v149, v149, v159 op_sel:[1,1,0] op_sel_hi:[1,1,0]
v_fma_mix_f32 v159, v146, v146, v159 op_sel:[0,0,0] op_sel_hi:[1,1,0]
v_fma_mix_f32 v159, v143, v143, v159 op_sel:[1,1,0] op_sel_hi:[1,1,0]
v_fma_mix_f32 v159, v146, v146, v159 op_sel:[1,1,0] op_sel_hi:[1,1,0]
s_waitcnt lgkmcnt(4)
v_mfma_f32_16x16x32_bf16 v[8:11], v[224:227], v[192:195], v[8:11]
ds_read_b128 v[220:223], v248 offset:51200
v_cvt_pkrtz_f16_f32 v137, v120, v121
v_cvt_pkrtz_f16_f32 v139, v122, v123
v_cvt_pkrtz_f16_f32 v141, v124, v125
v_cvt_pkrtz_f16_f32 v143, v126, v127
v_cvt_pk_f16_f32 v155, v128, v129
v_cvt_pk_f16_f32 v152, v130, v131
v_cvt_pk_f16_f32 v149, v132, v133
v_cvt_pk_f16_f32 v146, v134, v135
v_mfma_f32_32x32x16_bf16 v[120:135], v[96:99], v[228:231], 0
ds_read_b64 v[224:225], v245 offset:6528
ds_read_b64 v[226:227], v246 offset:6528
ds_read_b128 v[200:203], v244 offset:128
v_pk_fma_f16 v154, v155, v155, s48
v_and_b32_e64 v137, s49, v137
v_pk_fma_f16 v151, v152, v152, s48
v_pk_fma_f16 v148, v149, v149, s48
v_and_b32_e64 v139, s49, v139
v_pk_fma_f16 v145, v146, v146, s48
v_mfma_f32_32x32x16_bf16 v[120:135], v[100:103], v[232:235], v[120:135]
ds_read_b128 v[228:231], v248 offset:49152
v_pk_mul_f16 v154, v155, v154
v_bfe_u32 v136, v137, 2, 14
v_pk_mul_f16 v151, v152, v151
v_pk_mul_f16 v148, v149, v148
v_bfe_u32 v138, v139, 2, 14
v_pk_mul_f16 v145, v146, v145
v_exp_f16 v153, v154
v_lshrrev_b32 v137, 18, v137
s_waitcnt lgkmcnt(4)
v_mfma_f32_16x16x32_bf16 v[24:27], v[236:239], v[196:199], v[24:27]
ds_read_b64 v[232:233], v245 offset:576
ds_read_b64 v[234:235], v246 offset:576
v_xor_b32 v242, 16, v242
ds_read_b128 v[204:207], v242
ds_read_u16_d16 v136, v136
ds_read_u16_d16 v138, v138
ds_read_u16_d16_hi v137, v137
v_exp_f16 v150, v151
v_lshrrev_b32 v139, 18, v139
v_exp_f16_e64 v147, v148
v_mfma_f32_32x32x16_bf16 v[120:135], v[104:107], v[216:219], v[120:135]
ds_read_b128 v[236:239], v248 offset:52224
ds_read_u16_d16_hi v139, v139
v_and_b32 v141, s49, v141
v_exp_f16 v144, v145
v_and_b32_e64 v143, s49, v143
v_exp_f16_sdwa v153, v154 dst_sel:WORD_1 dst_unused:UNUSED_PRESERVE src0_sel:WORD_1
v_bfe_u32 v140, v141, 2, 14
v_exp_f16_sdwa v150, v151 dst_sel:WORD_1 dst_unused:UNUSED_PRESERVE src0_sel:WORD_1
v_mfma_f32_32x32x16_bf16 v[120:135], v[108:111], v[220:223], v[120:135]
ds_read_b64 v[216:217], v245 offset:1344
ds_read_b64 v[218:219], v246 offset:1344
ds_read_b128 v[208:211], v242 offset:64
ds_read_u16_d16 v140, v140
v_bfe_u32 v142, v143, 2, 14
v_exp_f16_sdwa v147, v148 dst_sel:WORD_1 dst_unused:UNUSED_PRESERVE src0_sel:WORD_1
v_lshrrev_b32_e64 v141, 18, v141
v_exp_f16_sdwa v144, v145 dst_sel:WORD_1 dst_unused:UNUSED_PRESERVE src0_sel:WORD_1
v_lshrrev_b32 v143, 18, v143
v_pk_add_f16 v153, v153, 1.0 op_sel_hi:[1,0]
v_pk_add_f16 v150, v150, 1.0 op_sel_hi:[1,0]
s_waitcnt lgkmcnt(6)
v_mfma_f32_16x16x32_bf16 v[40:43], v[224:227], v[200:203], v[40:43]
ds_read_b64 v[220:221], v245 offset:2112
ds_read_b64 v[222:223], v246 offset:2112
ds_read_b128 v[212:215], v242 offset:128
ds_read_u16_d16 v142, v142
ds_read_u16_d16_hi v141, v141
ds_read_u16_d16_hi v143, v143
v_pk_add_f16 v147, v147, 1.0 op_sel_hi:[1,0]
v_pk_add_f16 v144, v144, 1.0 op_sel_hi:[1,0]
v_rcp_f16_e64 v154, v153
v_mfma_f32_32x32x16_bf16 v[120:135], v[112:115], v[228:231], v[120:135]
ds_read_b64 v[224:225], v245 offset:2880
ds_read_b64 v[226:227], v246 offset:2880
v_xor_b32 v243, 16, v243
ds_read_b128 v[192:195], v243
v_rcp_f16 v151, v150
v_rcp_f16 v148, v147
v_rcp_f16 v145, v144
v_rcp_f16_sdwa v154, v153 dst_sel:WORD_1 dst_unused:UNUSED_PRESERVE src0_sel:WORD_1
v_rcp_f16_sdwa v151, v150 dst_sel:WORD_1 dst_unused:UNUSED_PRESERVE src0_sel:WORD_1
v_mfma_f32_16x16x32_bf16 v[12:15], v[232:235], v[204:207], 0
ds_read_b128 v[228:231], v248 offset:53248
v_rcp_f16_sdwa v148, v147 dst_sel:WORD_1 dst_unused:UNUSED_PRESERVE src0_sel:WORD_1
v_fma_mix_f32 v160, v136, v136, v160 op_sel:[0,0,0] op_sel_hi:[1,1,0]
v_rcp_f16_sdwa v145, v144 dst_sel:WORD_1 dst_unused:UNUSED_PRESERVE src0_sel:WORD_1
s_waitcnt lgkmcnt(10)
v_mfma_f32_32x32x16_bf16 v[120:135], v[116:119], v[236:239], v[120:135]
ds_read_b128 v[232:235], v248 offset:56320
v_fma_mix_f32 v160, v137, v137, v160 op_sel:[1,1,0] op_sel_hi:[1,1,0]
v_pk_mul_f16 v155, v155, v154
v_fma_mix_f32 v160, v138, v138, v160 op_sel:[0,0,0] op_sel_hi:[1,1,0]
v_pk_mul_f16 v152, v152, v151
v_pk_mul_f16 v149, v149, v148
v_fma_mix_f32 v160, v139, v139, v160 op_sel:[1,1,0] op_sel_hi:[1,1,0]
v_pk_mul_f16 v146, v146, v145
v_fma_mix_f32 v160, v155, v155, v160 op_sel:[0,0,0] op_sel_hi:[1,1,0]
v_fma_mix_f32 v160, v140, v140, v160 op_sel:[0,0,0] op_sel_hi:[1,1,0]
v_mfma_f32_16x16x32_bf16 v[28:31], v[216:219], v[208:211], 0
ds_read_b64 v[236:237], v245 offset:3648
ds_read_b64 v[238:239], v246 offset:3648
ds_read_b128 v[196:199], v243 offset:64
v_fma_mix_f32 v160, v155, v155, v160 op_sel:[1,1,0] op_sel_hi:[1,1,0]
v_fma_mix_f32 v160, v152, v152, v160 op_sel:[0,0,0] op_sel_hi:[1,1,0]
s_waitcnt lgkmcnt(5)
v_fma_mix_f32 v160, v141, v141, v160 op_sel:[1,1,0] op_sel_hi:[1,1,0]
v_fma_mix_f32 v160, v152, v152, v160 op_sel:[1,1,0] op_sel_hi:[1,1,0]
v_fma_mix_f32 v160, v149, v149, v160 op_sel:[0,0,0] op_sel_hi:[1,1,0]
v_mfma_f32_16x16x32_bf16 v[44:47], v[220:223], v[212:215], 0
ds_read_b128 v[216:219], v248 offset:54272
v_fma_mix_f32 v160, v142, v142, v160 op_sel:[0,0,0] op_sel_hi:[1,1,0]
v_fma_mix_f32 v160, v149, v149, v160 op_sel:[1,1,0] op_sel_hi:[1,1,0]
v_fma_mix_f32 v160, v146, v146, v160 op_sel:[0,0,0] op_sel_hi:[1,1,0]
v_fma_mix_f32 v160, v143, v143, v160 op_sel:[1,1,0] op_sel_hi:[1,1,0]
v_fma_mix_f32 v160, v146, v146, v160 op_sel:[1,1,0] op_sel_hi:[1,1,0]
v_mfma_f32_16x16x32_bf16 v[12:15], v[224:227], v[192:195], v[12:15]
ds_read_b128 v[220:223], v248 offset:57344
v_cvt_pkrtz_f16_f32 v137, v120, v121
v_cvt_pkrtz_f16_f32 v139, v122, v123
v_cvt_pkrtz_f16_f32 v141, v124, v125
v_cvt_pkrtz_f16_f32 v143, v126, v127
v_cvt_pk_f16_f32 v155, v128, v129
v_cvt_pk_f16_f32 v152, v130, v131
v_cvt_pk_f16_f32 v149, v132, v133
v_cvt_pk_f16_f32 v146, v134, v135
s_waitcnt lgkmcnt(3)
v_mfma_f32_32x32x16_bf16 v[120:135], v[96:99], v[228:231], 0
ds_read_b64 v[224:225], v245 offset:4416
ds_read_b64 v[226:227], v246 offset:4416
ds_read_b128 v[200:203], v243 offset:128
v_pk_fma_f16 v154, v155, v155, s48
v_and_b32 v137, s49, v137
v_pk_fma_f16 v151, v152, v152, s48
v_pk_fma_f16 v148, v149, v149, s48
v_and_b32_e64 v139, s49, v139
v_pk_fma_f16 v145, v146, v146, s48
v_mfma_f32_32x32x16_bf16 v[120:135], v[100:103], v[232:235], v[120:135]
ds_read_b128 v[228:231], v248 offset:55296
v_pk_mul_f16 v154, v155, v154
v_bfe_u32 v136, v137, 2, 14
v_pk_mul_f16 v151, v152, v151
v_pk_mul_f16 v148, v149, v148
v_bfe_u32 v138, v139, 2, 14
v_pk_mul_f16 v145, v146, v145
v_exp_f16 v153, v154
v_lshrrev_b32 v137, 18, v137
s_waitcnt lgkmcnt(4)
v_mfma_f32_16x16x32_bf16 v[28:31], v[236:239], v[196:199], v[28:31]
ds_read_b64 v[232:233], v245 offset:5184
ds_read_b64 v[234:235], v246 offset:5184
v_xor_b32 v244, 16, v244
ds_read_b128 v[204:207], v244
ds_read_u16_d16 v136, v136
ds_read_u16_d16 v138, v138
ds_read_u16_d16_hi v137, v137
v_exp_f16 v150, v151
v_lshrrev_b32 v139, 18, v139
v_exp_f16_e64 v147, v148
v_mfma_f32_32x32x16_bf16 v[120:135], v[104:107], v[216:219], v[120:135]
ds_read_b128 v[236:239], v248 offset:58368
ds_read_u16_d16_hi v139, v139
v_and_b32 v141, s49, v141
v_exp_f16 v144, v145
v_and_b32_e64 v143, s49, v143
v_exp_f16_sdwa v153, v154 dst_sel:WORD_1 dst_unused:UNUSED_PRESERVE src0_sel:WORD_1
v_bfe_u32 v140, v141, 2, 14
v_exp_f16_sdwa v150, v151 dst_sel:WORD_1 dst_unused:UNUSED_PRESERVE src0_sel:WORD_1
v_mfma_f32_32x32x16_bf16 v[120:135], v[108:111], v[220:223], v[120:135]
ds_read_b64 v[216:217], v245 offset:5952
ds_read_b64 v[218:219], v246 offset:5952
ds_read_b128 v[208:211], v244 offset:64
ds_read_u16_d16 v140, v140
v_bfe_u32 v142, v143, 2, 14
v_exp_f16_sdwa v147, v148 dst_sel:WORD_1 dst_unused:UNUSED_PRESERVE src0_sel:WORD_1
v_lshrrev_b32_e64 v141, 18, v141
v_exp_f16_sdwa v144, v145 dst_sel:WORD_1 dst_unused:UNUSED_PRESERVE src0_sel:WORD_1
v_lshrrev_b32 v143, 18, v143
v_pk_add_f16 v153, v153, 1.0 op_sel_hi:[1,0]
v_pk_add_f16 v150, v150, 1.0 op_sel_hi:[1,0]
s_waitcnt lgkmcnt(6)
v_mfma_f32_16x16x32_bf16 v[44:47], v[224:227], v[200:203], v[44:47]
ds_read_b64 v[220:221], v245 offset:6720
ds_read_b64 v[222:223], v246 offset:6720
ds_read_b128 v[212:215], v244 offset:128
ds_read_u16_d16 v142, v142
ds_read_u16_d16_hi v141, v141
ds_read_u16_d16_hi v143, v143
v_pk_add_f16 v147, v147, 1.0 op_sel_hi:[1,0]
v_pk_add_f16 v144, v144, 1.0 op_sel_hi:[1,0]
v_rcp_f16_e64 v154, v153
v_mfma_f32_32x32x16_bf16 v[120:135], v[112:115], v[228:231], v[120:135]
ds_read_b64 v[224:225], v245 offset:192
ds_read_b64 v[226:227], v246 offset:192
v_xor_b32 v242, 32, v242
ds_read_b128 v[192:195], v242
v_rcp_f16 v151, v150
v_rcp_f16 v148, v147
v_rcp_f16 v145, v144
v_rcp_f16_sdwa v154, v153 dst_sel:WORD_1 dst_unused:UNUSED_PRESERVE src0_sel:WORD_1
v_rcp_f16_sdwa v151, v150 dst_sel:WORD_1 dst_unused:UNUSED_PRESERVE src0_sel:WORD_1
v_mfma_f32_16x16x32_bf16 v[12:15], v[232:235], v[204:207], v[12:15]
ds_read_b128 v[228:231], v248 offset:59392
v_rcp_f16_sdwa v148, v147 dst_sel:WORD_1 dst_unused:UNUSED_PRESERVE src0_sel:WORD_1
v_fma_mix_f32 v161, v136, v136, v161 op_sel:[0,0,0] op_sel_hi:[1,1,0]
s_setprio 1
v_rcp_f16_sdwa v145, v144 dst_sel:WORD_1 dst_unused:UNUSED_PRESERVE src0_sel:WORD_1
s_waitcnt lgkmcnt(9)
v_mfma_f32_32x32x16_bf16 v[120:135], v[116:119], v[236:239], v[120:135]
ds_read_b128 v[232:235], v248 offset:62464
v_fma_mix_f32 v161, v137, v137, v161 op_sel:[1,1,0] op_sel_hi:[1,1,0]
v_pk_mul_f16 v155, v155, v154
v_fma_mix_f32 v161, v138, v138, v161 op_sel:[0,0,0] op_sel_hi:[1,1,0]
v_pk_mul_f16 v152, v152, v151
v_pk_mul_f16 v149, v149, v148
v_fma_mix_f32 v161, v139, v139, v161 op_sel:[1,1,0] op_sel_hi:[1,1,0]
v_pk_mul_f16 v146, v146, v145
v_fma_mix_f32 v161, v155, v155, v161 op_sel:[0,0,0] op_sel_hi:[1,1,0]
v_fma_mix_f32 v161, v140, v140, v161 op_sel:[0,0,0] op_sel_hi:[1,1,0]
v_mfma_f32_16x16x32_bf16 v[28:31], v[216:219], v[208:211], v[28:31]
ds_read_b64 v[236:237], v245 offset:960
ds_read_b64 v[238:239], v246 offset:960
ds_read_b128 v[196:199], v242 offset:64
v_fma_mix_f32 v161, v155, v155, v161 op_sel:[1,1,0] op_sel_hi:[1,1,0]
v_fma_mix_f32 v161, v152, v152, v161 op_sel:[0,0,0] op_sel_hi:[1,1,0]
s_waitcnt lgkmcnt(5)
v_fma_mix_f32 v161, v141, v141, v161 op_sel:[1,1,0] op_sel_hi:[1,1,0]
v_fma_mix_f32 v161, v152, v152, v161 op_sel:[1,1,0] op_sel_hi:[1,1,0]
v_fma_mix_f32 v161, v149, v149, v161 op_sel:[0,0,0] op_sel_hi:[1,1,0]
v_mfma_f32_16x16x32_bf16 v[44:47], v[220:223], v[212:215], v[44:47]
ds_read_b128 v[216:219], v248 offset:60416
v_fma_mix_f32 v161, v142, v142, v161 op_sel:[0,0,0] op_sel_hi:[1,1,0]
v_fma_mix_f32 v161, v149, v149, v161 op_sel:[1,1,0] op_sel_hi:[1,1,0]
v_fma_mix_f32 v161, v146, v146, v161 op_sel:[0,0,0] op_sel_hi:[1,1,0]
v_fma_mix_f32 v161, v143, v143, v161 op_sel:[1,1,0] op_sel_hi:[1,1,0]
v_fma_mix_f32 v161, v146, v146, v161 op_sel:[1,1,0] op_sel_hi:[1,1,0]
v_mfma_f32_16x16x32_bf16 v[4:7], v[224:227], v[192:195], 0
ds_read_b128 v[220:223], v248 offset:63488
v_cvt_pkrtz_f16_f32 v137, v120, v121
v_cvt_pkrtz_f16_f32 v139, v122, v123
v_cvt_pkrtz_f16_f32 v141, v124, v125
v_cvt_pkrtz_f16_f32 v143, v126, v127
v_cvt_pk_f16_f32 v155, v128, v129
v_cvt_pk_f16_f32 v152, v130, v131
v_cvt_pk_f16_f32 v149, v132, v133
v_cvt_pk_f16_f32 v146, v134, v135
s_waitcnt lgkmcnt(3)
v_mfma_f32_32x32x16_bf16 v[120:135], v[96:99], v[228:231], 0
ds_read_b64 v[224:225], v245 offset:1728
ds_read_b64 v[226:227], v246 offset:1728
ds_read_b128 v[200:203], v242 offset:128
v_pk_fma_f16 v154, v155, v155, s48
v_and_b32_e64 v137, s49, v137
v_pk_fma_f16 v151, v152, v152, s48
v_pk_fma_f16 v148, v149, v149, s48
v_and_b32_e64 v139, s49, v139
v_pk_fma_f16 v145, v146, v146, s48
v_mfma_f32_32x32x16_bf16 v[120:135], v[100:103], v[232:235], v[120:135]
ds_read_b128 v[228:231], v248 offset:61440
v_pk_mul_f16 v154, v155, v154
v_bfe_u32 v136, v137, 2, 14
v_pk_mul_f16 v151, v152, v151
v_pk_mul_f16 v148, v149, v148
v_bfe_u32 v138, v139, 2, 14
v_pk_mul_f16 v145, v146, v145
v_exp_f16 v153, v154
v_lshrrev_b32 v137, 18, v137
s_waitcnt lgkmcnt(4)
v_mfma_f32_16x16x32_bf16 v[20:23], v[236:239], v[196:199], 0
ds_read_b64 v[232:233], v245 offset:2496
ds_read_b64 v[234:235], v246 offset:2496
v_xor_b32 v243, 32, v243
ds_read_b128 v[204:207], v243
ds_read_u16_d16 v136, v136
ds_read_u16_d16 v138, v138
ds_read_u16_d16_hi v137, v137
v_exp_f16 v150, v151
v_lshrrev_b32 v139, 18, v139
v_exp_f16_e64 v147, v148
v_mfma_f32_32x32x16_bf16 v[120:135], v[104:107], v[216:219], v[120:135]
ds_read_b128 v[236:239], v248 offset:64512
ds_read_u16_d16_hi v139, v139
v_and_b32 v141, s49, v141
v_exp_f16 v144, v145
v_and_b32_e64 v143, s49, v143
v_exp_f16_sdwa v153, v154 dst_sel:WORD_1 dst_unused:UNUSED_PRESERVE src0_sel:WORD_1
v_bfe_u32 v140, v141, 2, 14
v_exp_f16_sdwa v150, v151 dst_sel:WORD_1 dst_unused:UNUSED_PRESERVE src0_sel:WORD_1
v_mfma_f32_32x32x16_bf16 v[120:135], v[108:111], v[220:223], v[120:135]
ds_read_b64 v[216:217], v245 offset:3264
ds_read_b64 v[218:219], v246 offset:3264
ds_read_b128 v[208:211], v243 offset:64
ds_read_u16_d16 v140, v140
v_bfe_u32 v142, v143, 2, 14
v_exp_f16_sdwa v147, v148 dst_sel:WORD_1 dst_unused:UNUSED_PRESERVE src0_sel:WORD_1
v_lshrrev_b32_e64 v141, 18, v141
v_exp_f16_sdwa v144, v145 dst_sel:WORD_1 dst_unused:UNUSED_PRESERVE src0_sel:WORD_1
v_lshrrev_b32 v143, 18, v143
v_pk_add_f16 v153, v153, 1.0 op_sel_hi:[1,0]
v_pk_add_f16 v150, v150, 1.0 op_sel_hi:[1,0]
s_waitcnt lgkmcnt(6)
v_mfma_f32_16x16x32_bf16 v[36:39], v[224:227], v[200:203], 0
ds_read_b64 v[220:221], v245 offset:4032
ds_read_b64 v[222:223], v246 offset:4032
ds_read_b128 v[212:215], v243 offset:128
ds_read_u16_d16 v142, v142
ds_read_u16_d16_hi v141, v141
ds_read_u16_d16_hi v143, v143
v_pk_add_f16 v147, v147, 1.0 op_sel_hi:[1,0]
v_pk_add_f16 v144, v144, 1.0 op_sel_hi:[1,0]
v_rcp_f16_e64 v154, v153
v_mfma_f32_32x32x16_bf16 v[120:135], v[112:115], v[228:231], v[120:135]
ds_read_b64 v[224:225], v245 offset:4800
ds_read_b64 v[226:227], v246 offset:4800
v_xor_b32 v244, 32, v244
ds_read_b128 v[192:195], v244
v_rcp_f16 v151, v150
v_rcp_f16 v148, v147
v_rcp_f16 v145, v144
v_rcp_f16_sdwa v154, v153 dst_sel:WORD_1 dst_unused:UNUSED_PRESERVE src0_sel:WORD_1
v_rcp_f16_sdwa v151, v150 dst_sel:WORD_1 dst_unused:UNUSED_PRESERVE src0_sel:WORD_1
v_mfma_f32_16x16x32_bf16 v[4:7], v[232:235], v[204:207], v[4:7]
ds_read_b128 v[228:231], v249
v_rcp_f16_sdwa v148, v147 dst_sel:WORD_1 dst_unused:UNUSED_PRESERVE src0_sel:WORD_1
v_fma_mix_f32 v162, v136, v136, v162 op_sel:[0,0,0] op_sel_hi:[1,1,0]
v_rcp_f16_sdwa v145, v144 dst_sel:WORD_1 dst_unused:UNUSED_PRESERVE src0_sel:WORD_1
s_waitcnt lgkmcnt(10)
v_mfma_f32_32x32x16_bf16 v[120:135], v[116:119], v[236:239], v[120:135]
ds_read_b128 v[232:235], v249 offset:3072
v_fma_mix_f32 v162, v137, v137, v162 op_sel:[1,1,0] op_sel_hi:[1,1,0]
v_pk_mul_f16 v155, v155, v154
v_fma_mix_f32 v162, v138, v138, v162 op_sel:[0,0,0] op_sel_hi:[1,1,0]
v_pk_mul_f16 v152, v152, v151
v_pk_mul_f16 v149, v149, v148
v_fma_mix_f32 v162, v139, v139, v162 op_sel:[1,1,0] op_sel_hi:[1,1,0]
v_pk_mul_f16 v146, v146, v145
v_fma_mix_f32 v162, v155, v155, v162 op_sel:[0,0,0] op_sel_hi:[1,1,0]
v_fma_mix_f32 v162, v140, v140, v162 op_sel:[0,0,0] op_sel_hi:[1,1,0]
v_mfma_f32_16x16x32_bf16 v[20:23], v[216:219], v[208:211], v[20:23]
ds_read_b64 v[236:237], v245 offset:5568
ds_read_b64 v[238:239], v246 offset:5568
ds_read_b128 v[196:199], v244 offset:64
v_fma_mix_f32 v162, v155, v155, v162 op_sel:[1,1,0] op_sel_hi:[1,1,0]
v_fma_mix_f32 v162, v152, v152, v162 op_sel:[0,0,0] op_sel_hi:[1,1,0]
s_waitcnt lgkmcnt(5)
v_fma_mix_f32 v162, v141, v141, v162 op_sel:[1,1,0] op_sel_hi:[1,1,0]
v_fma_mix_f32 v162, v152, v152, v162 op_sel:[1,1,0] op_sel_hi:[1,1,0]
v_fma_mix_f32 v162, v149, v149, v162 op_sel:[0,0,0] op_sel_hi:[1,1,0]
v_mfma_f32_16x16x32_bf16 v[36:39], v[220:223], v[212:215], v[36:39]
ds_read_b128 v[216:219], v249 offset:1024
v_fma_mix_f32 v162, v142, v142, v162 op_sel:[0,0,0] op_sel_hi:[1,1,0]
v_fma_mix_f32 v162, v149, v149, v162 op_sel:[1,1,0] op_sel_hi:[1,1,0]
v_fma_mix_f32 v162, v146, v146, v162 op_sel:[0,0,0] op_sel_hi:[1,1,0]
v_fma_mix_f32 v162, v143, v143, v162 op_sel:[1,1,0] op_sel_hi:[1,1,0]
v_fma_mix_f32 v162, v146, v146, v162 op_sel:[1,1,0] op_sel_hi:[1,1,0]
v_mfma_f32_16x16x32_bf16 v[4:7], v[224:227], v[192:195], v[4:7]
ds_read_b128 v[220:223], v249 offset:4096
v_cvt_pkrtz_f16_f32 v137, v120, v121
v_cvt_pkrtz_f16_f32 v139, v122, v123
v_cvt_pkrtz_f16_f32 v141, v124, v125
v_cvt_pkrtz_f16_f32 v143, v126, v127
v_cvt_pk_f16_f32 v155, v128, v129
v_cvt_pk_f16_f32 v152, v130, v131
v_cvt_pk_f16_f32 v149, v132, v133
v_cvt_pk_f16_f32 v146, v134, v135
s_waitcnt lgkmcnt(3)
v_mfma_f32_32x32x16_bf16 v[120:135], v[96:99], v[228:231], 0
ds_read_b64 v[224:225], v245 offset:6336
ds_read_b64 v[226:227], v246 offset:6336
ds_read_b128 v[200:203], v244 offset:128
v_pk_fma_f16 v154, v155, v155, s48
v_and_b32 v137, s49, v137
v_pk_fma_f16 v151, v152, v152, s48
v_pk_fma_f16 v148, v149, v149, s48
v_and_b32_e64 v139, s49, v139
v_pk_fma_f16 v145, v146, v146, s48
v_mfma_f32_32x32x16_bf16 v[120:135], v[100:103], v[232:235], v[120:135]
ds_read_b128 v[228:231], v249 offset:2048
v_pk_mul_f16 v154, v155, v154
v_bfe_u32 v136, v137, 2, 14
v_pk_mul_f16 v151, v152, v151
v_pk_mul_f16 v148, v149, v148
v_bfe_u32 v138, v139, 2, 14
v_pk_mul_f16 v145, v146, v145
v_exp_f16 v153, v154
v_lshrrev_b32 v137, 18, v137
s_waitcnt lgkmcnt(4)
v_mfma_f32_16x16x32_bf16 v[20:23], v[236:239], v[196:199], v[20:23]
ds_read_b64 v[232:233], v245
ds_read_b64 v[234:235], v246
v_xor_b32 v242, 16, v242
ds_read_b128 v[204:207], v242
ds_read_u16_d16 v136, v136
ds_read_u16_d16 v138, v138
ds_read_u16_d16_hi v137, v137
v_exp_f16 v150, v151
v_lshrrev_b32 v139, 18, v139
v_exp_f16_e64 v147, v148
v_mfma_f32_32x32x16_bf16 v[120:135], v[104:107], v[216:219], v[120:135]
ds_read_b128 v[236:239], v249 offset:5120
ds_read_u16_d16_hi v139, v139
v_and_b32 v141, s49, v141
v_exp_f16 v144, v145
v_and_b32_e64 v143, s49, v143
v_exp_f16_sdwa v153, v154 dst_sel:WORD_1 dst_unused:UNUSED_PRESERVE src0_sel:WORD_1
v_bfe_u32 v140, v141, 2, 14
v_exp_f16_sdwa v150, v151 dst_sel:WORD_1 dst_unused:UNUSED_PRESERVE src0_sel:WORD_1
v_mfma_f32_32x32x16_bf16 v[120:135], v[108:111], v[220:223], v[120:135]
ds_read_b64 v[216:217], v245 offset:768
ds_read_b64 v[218:219], v246 offset:768
ds_read_b128 v[208:211], v242 offset:64
ds_read_u16_d16 v140, v140
v_bfe_u32 v142, v143, 2, 14
v_exp_f16_sdwa v147, v148 dst_sel:WORD_1 dst_unused:UNUSED_PRESERVE src0_sel:WORD_1
v_lshrrev_b32_e64 v141, 18, v141
v_exp_f16_sdwa v144, v145 dst_sel:WORD_1 dst_unused:UNUSED_PRESERVE src0_sel:WORD_1
v_lshrrev_b32 v143, 18, v143
v_pk_add_f16 v153, v153, 1.0 op_sel_hi:[1,0]
v_pk_add_f16 v150, v150, 1.0 op_sel_hi:[1,0]
s_waitcnt lgkmcnt(6)
v_mfma_f32_16x16x32_bf16 v[36:39], v[224:227], v[200:203], v[36:39]
ds_read_b64 v[220:221], v245 offset:1536
ds_read_b64 v[222:223], v246 offset:1536
ds_read_b128 v[212:215], v242 offset:128
ds_read_u16_d16 v142, v142
ds_read_u16_d16_hi v141, v141
ds_read_u16_d16_hi v143, v143
v_pk_add_f16 v147, v147, 1.0 op_sel_hi:[1,0]
v_pk_add_f16 v144, v144, 1.0 op_sel_hi:[1,0]
v_rcp_f16_e64 v154, v153
v_mfma_f32_32x32x16_bf16 v[120:135], v[112:115], v[228:231], v[120:135]
ds_read_b64 v[224:225], v245 offset:2304
ds_read_b64 v[226:227], v246 offset:2304
v_xor_b32 v243, 16, v243
ds_read_b128 v[192:195], v243
v_rcp_f16 v151, v150
v_rcp_f16 v148, v147
v_rcp_f16 v145, v144
v_rcp_f16_sdwa v154, v153 dst_sel:WORD_1 dst_unused:UNUSED_PRESERVE src0_sel:WORD_1
v_rcp_f16_sdwa v151, v150 dst_sel:WORD_1 dst_unused:UNUSED_PRESERVE src0_sel:WORD_1
v_mfma_f32_16x16x32_bf16 v[0:3], v[232:235], v[204:207], 0
ds_read_b128 v[228:231], v249 offset:6144
v_rcp_f16_sdwa v148, v147 dst_sel:WORD_1 dst_unused:UNUSED_PRESERVE src0_sel:WORD_1
v_fma_mix_f32 v163, v136, v136, v163 op_sel:[0,0,0] op_sel_hi:[1,1,0]
v_rcp_f16_sdwa v145, v144 dst_sel:WORD_1 dst_unused:UNUSED_PRESERVE src0_sel:WORD_1
s_waitcnt lgkmcnt(10)
v_mfma_f32_32x32x16_bf16 v[120:135], v[116:119], v[236:239], v[120:135]
ds_read_b128 v[232:235], v249 offset:9216
v_fma_mix_f32 v163, v137, v137, v163 op_sel:[1,1,0] op_sel_hi:[1,1,0]
v_pk_mul_f16 v155, v155, v154
v_fma_mix_f32 v163, v138, v138, v163 op_sel:[0,0,0] op_sel_hi:[1,1,0]
v_pk_mul_f16 v152, v152, v151
v_pk_mul_f16 v149, v149, v148
v_fma_mix_f32 v163, v139, v139, v163 op_sel:[1,1,0] op_sel_hi:[1,1,0]
v_pk_mul_f16 v146, v146, v145
v_fma_mix_f32 v163, v155, v155, v163 op_sel:[0,0,0] op_sel_hi:[1,1,0]
v_fma_mix_f32 v163, v140, v140, v163 op_sel:[0,0,0] op_sel_hi:[1,1,0]
v_mfma_f32_16x16x32_bf16 v[16:19], v[216:219], v[208:211], 0
ds_read_b64 v[236:237], v245 offset:3072
ds_read_b64 v[238:239], v246 offset:3072
ds_read_b128 v[196:199], v243 offset:64
v_fma_mix_f32 v163, v155, v155, v163 op_sel:[1,1,0] op_sel_hi:[1,1,0]
v_fma_mix_f32 v163, v152, v152, v163 op_sel:[0,0,0] op_sel_hi:[1,1,0]
s_waitcnt lgkmcnt(5)
v_fma_mix_f32 v163, v141, v141, v163 op_sel:[1,1,0] op_sel_hi:[1,1,0]
v_fma_mix_f32 v163, v152, v152, v163 op_sel:[1,1,0] op_sel_hi:[1,1,0]
v_fma_mix_f32 v163, v149, v149, v163 op_sel:[0,0,0] op_sel_hi:[1,1,0]
v_mfma_f32_16x16x32_bf16 v[32:35], v[220:223], v[212:215], 0
ds_read_b128 v[216:219], v249 offset:7168
v_fma_mix_f32 v163, v142, v142, v163 op_sel:[0,0,0] op_sel_hi:[1,1,0]
v_fma_mix_f32 v163, v149, v149, v163 op_sel:[1,1,0] op_sel_hi:[1,1,0]
v_fma_mix_f32 v163, v146, v146, v163 op_sel:[0,0,0] op_sel_hi:[1,1,0]
v_fma_mix_f32 v163, v143, v143, v163 op_sel:[1,1,0] op_sel_hi:[1,1,0]
v_fma_mix_f32 v163, v146, v146, v163 op_sel:[1,1,0] op_sel_hi:[1,1,0]
v_mfma_f32_16x16x32_bf16 v[0:3], v[224:227], v[192:195], v[0:3]
ds_read_b128 v[220:223], v249 offset:10240
v_cvt_pkrtz_f16_f32 v137, v120, v121
v_cvt_pkrtz_f16_f32 v139, v122, v123
v_cvt_pkrtz_f16_f32 v141, v124, v125
v_cvt_pkrtz_f16_f32 v143, v126, v127
v_cvt_pk_f16_f32 v155, v128, v129
v_cvt_pk_f16_f32 v152, v130, v131
v_cvt_pk_f16_f32 v149, v132, v133
v_cvt_pk_f16_f32 v146, v134, v135
s_waitcnt lgkmcnt(3)
v_mfma_f32_32x32x16_bf16 v[120:135], v[96:99], v[228:231], 0
ds_read_b64 v[224:225], v245 offset:3840
ds_read_b64 v[226:227], v246 offset:3840
ds_read_b128 v[200:203], v243 offset:128
s_setprio 0
v_pk_fma_f16 v154, v155, v155, s48
v_and_b32_e64 v137, s49, v137
v_pk_fma_f16 v151, v152, v152, s48
v_pk_fma_f16 v148, v149, v149, s48
v_mfma_f32_32x32x16_bf16 v[120:135], v[100:103], v[232:235], v[120:135]
ds_read_b128 v[228:231], v249 offset:8192
v_and_b32_e64 v139, s49, v139
v_pk_fma_f16 v145, v146, v146, s48
v_pk_mul_f16 v154, v155, v154
v_bfe_u32 v136, v137, 2, 14
v_pk_mul_f16 v151, v152, v151
v_pk_mul_f16 v148, v149, v148
v_bfe_u32 v138, v139, 2, 14
v_pk_mul_f16 v145, v146, v145
s_waitcnt lgkmcnt(4)
v_mfma_f32_16x16x32_bf16 v[16:19], v[236:239], v[196:199], v[16:19]
ds_read_b64 v[232:233], v245 offset:4608
ds_read_b64 v[234:235], v246 offset:4608
v_xor_b32 v244, 16, v244
ds_read_b128 v[204:207], v244
ds_read_u16_d16 v136, v136
ds_read_u16_d16 v138, v138
v_exp_f16 v153, v154
v_lshrrev_b32 v137, 18, v137
v_exp_f16_e64 v150, v151
v_mfma_f32_32x32x16_bf16 v[120:135], v[104:107], v[216:219], v[120:135]
ds_read_b128 v[236:239], v249 offset:11264
ds_read_u16_d16_hi v137, v137
v_lshrrev_b32 v139, 18, v139
v_exp_f16 v147, v148
v_and_b32 v141, s49, v141
v_exp_f16 v144, v145
v_and_b32_e64 v143, s49, v143
v_mfma_f32_32x32x16_bf16 v[120:135], v[108:111], v[220:223], v[120:135]
ds_read_b64 v[216:217], v245 offset:5376
ds_read_b64 v[218:219], v246 offset:5376
ds_read_b128 v[208:211], v244 offset:64
ds_read_u16_d16_hi v139, v139
v_exp_f16_sdwa v153, v154 dst_sel:WORD_1 dst_unused:UNUSED_PRESERVE src0_sel:WORD_1
v_bfe_u32 v140, v141, 2, 14
v_exp_f16_sdwa v150, v151 dst_sel:WORD_1 dst_unused:UNUSED_PRESERVE src0_sel:WORD_1
v_bfe_u32 v142, v143, 2, 14
v_exp_f16_sdwa v147, v148 dst_sel:WORD_1 dst_unused:UNUSED_PRESERVE src0_sel:WORD_1
v_lshrrev_b32 v141, 18, v141
s_waitcnt lgkmcnt(8)
v_mfma_f32_16x16x32_bf16 v[32:35], v[224:227], v[200:203], v[32:35]
ds_read_b64 v[220:221], v245 offset:6144
ds_read_b64 v[222:223], v246 offset:6144
ds_read_b128 v[212:215], v244 offset:128
ds_read_u16_d16 v140, v140
ds_read_u16_d16 v142, v142
ds_read_u16_d16_hi v141, v141
v_exp_f16_sdwa v144, v145 dst_sel:WORD_1 dst_unused:UNUSED_PRESERVE src0_sel:WORD_1
v_lshrrev_b32_e64 v143, 18, v143
v_pk_add_f16 v153, v153, 1.0 op_sel_hi:[1,0]
v_pk_add_f16 v150, v150, 1.0 op_sel_hi:[1,0]
v_mfma_f32_32x32x16_bf16 v[120:135], v[112:115], v[228:231], v[120:135]
ds_read_b128 v[224:227], v249 offset:12288
ds_read_u16_d16_hi v143, v143
v_pk_add_f16 v147, v147, 1.0 op_sel_hi:[1,0]
v_pk_add_f16 v144, v144, 1.0 op_sel_hi:[1,0]
v_rcp_f16 v154, v153
v_rcp_f16 v151, v150
v_rcp_f16_e64 v148, v147
v_mfma_f32_16x16x32_bf16 v[0:3], v[232:235], v[204:207], v[0:3]
ds_read_b128 v[228:231], v249 offset:15360
v_rcp_f16 v145, v144
v_rcp_f16_sdwa v154, v153 dst_sel:WORD_1 dst_unused:UNUSED_PRESERVE src0_sel:WORD_1
s_waitcnt lgkmcnt(9)
v_mfma_f32_32x32x16_bf16 v[120:135], v[116:119], v[236:239], v[120:135]
ds_read_b128 v[232:235], v249 offset:13312
v_rcp_f16_sdwa v151, v150 dst_sel:WORD_1 dst_unused:UNUSED_PRESERVE src0_sel:WORD_1
v_rcp_f16_sdwa v148, v147 dst_sel:WORD_1 dst_unused:UNUSED_PRESERVE src0_sel:WORD_1
v_fma_mix_f32 v164, v136, v136, v164 op_sel:[0,0,0] op_sel_hi:[1,1,0]
v_rcp_f16_sdwa v145, v144 dst_sel:WORD_1 dst_unused:UNUSED_PRESERVE src0_sel:WORD_1
v_fma_mix_f32 v164, v137, v137, v164 op_sel:[1,1,0] op_sel_hi:[1,1,0]
v_pk_mul_f16 v155, v155, v154
v_mfma_f32_16x16x32_bf16 v[16:19], v[216:219], v[208:211], v[16:19]
ds_read_b128 v[236:239], v249 offset:16384
v_fma_mix_f32 v164, v138, v138, v164 op_sel:[0,0,0] op_sel_hi:[1,1,0]
v_pk_mul_f16 v152, v152, v151
v_pk_mul_f16 v149, v149, v148
v_fma_mix_f32 v164, v139, v139, v164 op_sel:[1,1,0] op_sel_hi:[1,1,0]
s_waitcnt lgkmcnt(3)
v_mfma_f32_16x16x32_bf16 v[32:35], v[220:223], v[212:215], v[32:35]
ds_read_b128 v[216:219], v249 offset:14336
v_pk_mul_f16 v146, v146, v145
v_fma_mix_f32 v164, v155, v155, v164 op_sel:[0,0,0] op_sel_hi:[1,1,0]
v_fma_mix_f32 v164, v140, v140, v164 op_sel:[0,0,0] op_sel_hi:[1,1,0]
v_fma_mix_f32 v164, v155, v155, v164 op_sel:[1,1,0] op_sel_hi:[1,1,0]
v_fma_mix_f32 v164, v152, v152, v164 op_sel:[0,0,0] op_sel_hi:[1,1,0]
v_fma_mix_f32 v164, v141, v141, v164 op_sel:[1,1,0] op_sel_hi:[1,1,0]
v_fma_mix_f32 v164, v152, v152, v164 op_sel:[1,1,0] op_sel_hi:[1,1,0]
v_fma_mix_f32 v164, v149, v149, v164 op_sel:[0,0,0] op_sel_hi:[1,1,0]
v_fma_mix_f32 v164, v142, v142, v164 op_sel:[0,0,0] op_sel_hi:[1,1,0]
v_fma_mix_f32 v164, v149, v149, v164 op_sel:[1,1,0] op_sel_hi:[1,1,0]
v_fma_mix_f32 v164, v146, v146, v164 op_sel:[0,0,0] op_sel_hi:[1,1,0]
v_fma_mix_f32 v164, v143, v143, v164 op_sel:[1,1,0] op_sel_hi:[1,1,0]
v_fma_mix_f32 v164, v146, v146, v164 op_sel:[1,1,0] op_sel_hi:[1,1,0]
s_setprio 3
v_pk_add_f32 v[168:169], v[0:1], v[2:3]
v_pk_mul_f32 v[170:171], v[0:1], v[0:1]
v_pk_fma_f32 v[170:171], v[2:3], v[2:3], v[170:171]
v_pk_add_f32 v[168:169], v[168:169], v[4:5]
v_pk_fma_f32 v[170:171], v[4:5], v[4:5], v[170:171]
v_pk_add_f32 v[168:169], v[168:169], v[6:7]
v_pk_fma_f32 v[170:171], v[6:7], v[6:7], v[170:171]
v_pk_add_f32 v[168:169], v[168:169], v[8:9]
v_pk_fma_f32 v[170:171], v[8:9], v[8:9], v[170:171]
v_pk_add_f32 v[168:169], v[168:169], v[10:11]
v_pk_fma_f32 v[170:171], v[10:11], v[10:11], v[170:171]
v_pk_add_f32 v[168:169], v[168:169], v[12:13]
v_pk_fma_f32 v[170:171], v[12:13], v[12:13], v[170:171]
v_pk_add_f32 v[168:169], v[168:169], v[14:15]
v_pk_fma_f32 v[170:171], v[14:15], v[14:15], v[170:171]
v_pk_add_f32 v[168:169], v[168:169], v[16:17]
v_pk_fma_f32 v[170:171], v[16:17], v[16:17], v[170:171]
v_pk_add_f32 v[168:169], v[168:169], v[18:19]
v_pk_fma_f32 v[170:171], v[18:19], v[18:19], v[170:171]
v_pk_add_f32 v[168:169], v[168:169], v[20:21]
v_pk_fma_f32 v[170:171], v[20:21], v[20:21], v[170:171]
v_pk_add_f32 v[168:169], v[168:169], v[22:23]
v_pk_fma_f32 v[170:171], v[22:23], v[22:23], v[170:171]
v_pk_add_f32 v[168:169], v[168:169], v[24:25]
v_pk_fma_f32 v[170:171], v[24:25], v[24:25], v[170:171]
v_pk_add_f32 v[168:169], v[168:169], v[26:27]
v_pk_fma_f32 v[170:171], v[26:27], v[26:27], v[170:171]
v_pk_add_f32 v[168:169], v[168:169], v[28:29]
v_pk_fma_f32 v[170:171], v[28:29], v[28:29], v[170:171]
v_pk_add_f32 v[168:169], v[168:169], v[30:31]
v_pk_fma_f32 v[170:171], v[30:31], v[30:31], v[170:171]
v_pk_add_f32 v[168:169], v[168:169], v[32:33]
v_pk_fma_f32 v[170:171], v[32:33], v[32:33], v[170:171]
v_pk_add_f32 v[168:169], v[168:169], v[34:35]
v_pk_fma_f32 v[170:171], v[34:35], v[34:35], v[170:171]
v_pk_add_f32 v[168:169], v[168:169], v[36:37]
v_pk_fma_f32 v[170:171], v[36:37], v[36:37], v[170:171]
v_pk_add_f32 v[168:169], v[168:169], v[38:39]
v_pk_fma_f32 v[170:171], v[38:39], v[38:39], v[170:171]
v_pk_add_f32 v[168:169], v[168:169], v[40:41]
v_pk_fma_f32 v[170:171], v[40:41], v[40:41], v[170:171]
v_pk_add_f32 v[168:169], v[168:169], v[42:43]
v_pk_fma_f32 v[170:171], v[42:43], v[42:43], v[170:171]
v_pk_add_f32 v[168:169], v[168:169], v[44:45]
v_pk_fma_f32 v[170:171], v[44:45], v[44:45], v[170:171]
v_pk_add_f32 v[168:169], v[168:169], v[46:47]
v_pk_fma_f32 v[170:171], v[46:47], v[46:47], v[170:171]
s_setprio 0
s_barrier
v_lshrrev_b32_e64 v240, 2, v251
v_mul_u32_u24 v240, 192, v240
v_and_b32 v247, 3, v251
v_lshl_add_u32 v240, v247, 4, v240
s_setprio 2
v_cvt_pkrtz_f16_f32 v137, v120, v121
v_cvt_pkrtz_f16_f32 v139, v122, v123
v_cvt_pkrtz_f16_f32 v141, v124, v125
v_cvt_pkrtz_f16_f32 v143, v126, v127
v_cvt_pkrtz_f16_f32 v145, v128, v129
v_cvt_pk_f16_f32 v155, v130, v131
v_cvt_pk_f16_f32 v152, v132, v133
v_cvt_pk_f16_f32 v149, v134, v135
s_add_u32 m0, s72, 0
s_add_u32 s43, s82, 0
buffer_load_dwordx4 v240, s[16:19], s43 offen lds
ds_read_b128 v[220:223], v249 offset:17408
v_mfma_f32_32x32x16_bf16 v[120:135], v[96:99], v[224:227], 0
v_pk_fma_f16 v154, v155, v155, s48
v_add_f32 v168, v168, v169
v_and_b32 v137, s49, v137
v_pk_fma_f16 v151, v152, v152, s48
v_and_b32_e64 v139, s49, v139
v_pk_fma_f16 v148, v149, v149, s48
v_add_f32_e64 v170, v170, v171
v_pk_mul_f16 v154, v155, v154
v_bfe_u32 v136, v137, 2, 14
v_pk_mul_f16 v151, v152, v151
v_pk_mul_f16 v148, v149, v148
v_bfe_u32 v138, v139, 2, 14
s_waitcnt lgkmcnt(1)
ds_read_b128 v[224:227], v249 offset:18432
ds_read_u16_d16 v136, v136
ds_read_u16_d16 v138, v138
v_mfma_f32_32x32x16_bf16 v[120:135], v[100:103], v[228:231], v[120:135]
v_permlane32_swap_b32 v168, v170
v_exp_f16 v153, v154
v_lshrrev_b32 v137, 18, v137
v_exp_f16 v150, v151
v_add_f32 v168, v168, v170
v_lshrrev_b32 v139, 18, v139
v_exp_f16 v147, v148
v_and_b32 v141, s49, v141
v_and_b32 v143, s49, v143
v_mul_f32 v168, 1009429163, v168
ds_read_b128 v[228:231], v249 offset:21504
ds_read_u16_d16_hi v137, v137
ds_read_u16_d16_hi v139, v139
v_mfma_f32_32x32x16_bf16 v[120:135], v[104:107], v[232:235], v[120:135]
v_exp_f16_sdwa v153, v154 dst_sel:WORD_1 dst_unused:UNUSED_PRESERVE src0_sel:WORD_1
v_bfe_u32 v140, v141, 2, 14
v_exp_f16_sdwa v150, v151 dst_sel:WORD_1 dst_unused:UNUSED_PRESERVE src0_sel:WORD_1
v_mov_b32_e64 v170, v168
v_bfe_u32 v142, v143, 2, 14
v_exp_f16_sdwa v147, v148 dst_sel:WORD_1 dst_unused:UNUSED_PRESERVE src0_sel:WORD_1
v_lshrrev_b32_e64 v141, 18, v141
v_permlane32_swap_b32 v168, v170
v_pk_add_f16 v153, v153, 1.0 op_sel_hi:[1,0]
s_add_u32 m0, s72, 1024
s_add_u32 s43, s82, 64
buffer_load_dwordx4 v240, s[16:19], s43 offen lds
ds_read_b128 v[232:235], v249 offset:19456
ds_read_u16_d16 v140, v140
ds_read_u16_d16 v142, v142
ds_read_u16_d16_hi v141, v141
v_mfma_f32_32x32x16_bf16 v[120:135], v[108:111], v[236:239], v[120:135]
v_lshrrev_b32_e64 v143, 18, v143
v_pk_add_f16 v150, v150, 1.0 op_sel_hi:[1,0]
v_pk_add_f16 v147, v147, 1.0 op_sel_hi:[1,0]
v_and_b32_e64 v145, s49, v145
v_fma_f32 v170, -v168, v168, v170
v_rcp_f16_e64 v154, v153
v_bfe_u32 v144, v145, 2, 14
v_rcp_f16 v151, v150
v_max_f32 v170, 0, v170
v_lshrrev_b32_e64 v145, 18, v145
ds_read_b128 v[236:239], v249 offset:22528
ds_read_u16_d16_hi v143, v143
ds_read_u16_d16 v144, v144
ds_read_u16_d16_hi v145, v145
v_mfma_f32_32x32x16_bf16 v[120:135], v[112:115], v[216:219], v[120:135]
v_rcp_f16 v148, v147
v_rcp_f16_sdwa v154, v153 dst_sel:WORD_1 dst_unused:UNUSED_PRESERVE src0_sel:WORD_1
v_add_f32 v170, 925353388, v170
s_waitcnt lgkmcnt(8)
v_fma_mix_f32 v165, v136, v136, v165 op_sel:[0,0,0] op_sel_hi:[1,1,0]
v_fma_mix_f32 v165, v137, v137, v165 op_sel:[1,1,0] op_sel_hi:[1,1,0]
v_rcp_f16_sdwa v151, v150 dst_sel:WORD_1 dst_unused:UNUSED_PRESERVE src0_sel:WORD_1
v_rsq_f32_e64 v170, v170
v_fma_mix_f32 v165, v138, v138, v165 op_sel:[0,0,0] op_sel_hi:[1,1,0]
ds_read_b128 v[216:219], v249 offset:20480
v_mfma_f32_32x32x16_bf16 v[120:135], v[116:119], v[220:223], v[120:135]
v_rcp_f16_sdwa v148, v147 dst_sel:WORD_1 dst_unused:UNUSED_PRESERVE src0_sel:WORD_1
v_fma_mix_f32 v165, v139, v139, v165 op_sel:[1,1,0] op_sel_hi:[1,1,0]
v_pk_mul_f16 v155, v155, v154
s_waitcnt lgkmcnt(5)
v_fma_mix_f32 v165, v140, v140, v165 op_sel:[0,0,0] op_sel_hi:[1,1,0]
v_pk_mul_f16 v152, v152, v151
v_fma_mix_f32 v165, v141, v141, v165 op_sel:[1,1,0] op_sel_hi:[1,1,0]
v_pk_mul_f16 v149, v149, v148
v_fma_mix_f32 v165, v155, v155, v165 op_sel:[0,0,0] op_sel_hi:[1,1,0]
v_mul_f32 v172, 3203391086, v170
v_fma_mix_f32 v165, v142, v142, v165 op_sel:[0,0,0] op_sel_hi:[1,1,0]
v_fma_mix_f32 v165, v155, v155, v165 op_sel:[1,1,0] op_sel_hi:[1,1,0]
s_waitcnt lgkmcnt(1)
v_fma_mix_f32 v165, v143, v143, v165 op_sel:[1,1,0] op_sel_hi:[1,1,0]
v_fma_mix_f32 v165, v152, v152, v165 op_sel:[0,0,0] op_sel_hi:[1,1,0]
v_fma_mix_f32 v165, v152, v152, v165 op_sel:[1,1,0] op_sel_hi:[1,1,0]
v_mul_f32 v173, v168, v172
v_fma_mix_f32 v165, v144, v144, v165 op_sel:[0,0,0] op_sel_hi:[1,1,0]
v_fma_mix_f32 v165, v149, v149, v165 op_sel:[0,0,0] op_sel_hi:[1,1,0]
v_fma_mix_f32 v165, v145, v145, v165 op_sel:[1,1,0] op_sel_hi:[1,1,0]
v_fma_mix_f32 v165, v149, v149, v165 op_sel:[1,1,0] op_sel_hi:[1,1,0]
s_setprio 3
v_pk_fma_f32 v[0:1], v[0:1], v[172:173], v[172:173] op_sel:[0,0,1] op_sel_hi:[1,0,1] neg_lo:[0,0,1] neg_hi:[0,0,1]
v_pk_fma_f32 v[2:3], v[2:3], v[172:173], v[172:173] op_sel:[0,0,1] op_sel_hi:[1,0,1] neg_lo:[0,0,1] neg_hi:[0,0,1]
v_pk_fma_f32 v[4:5], v[4:5], v[172:173], v[172:173] op_sel:[0,0,1] op_sel_hi:[1,0,1] neg_lo:[0,0,1] neg_hi:[0,0,1]
v_pk_fma_f32 v[6:7], v[6:7], v[172:173], v[172:173] op_sel:[0,0,1] op_sel_hi:[1,0,1] neg_lo:[0,0,1] neg_hi:[0,0,1]
v_pk_fma_f32 v[8:9], v[8:9], v[172:173], v[172:173] op_sel:[0,0,1] op_sel_hi:[1,0,1] neg_lo:[0,0,1] neg_hi:[0,0,1]
v_pk_fma_f32 v[10:11], v[10:11], v[172:173], v[172:173] op_sel:[0,0,1] op_sel_hi:[1,0,1] neg_lo:[0,0,1] neg_hi:[0,0,1]
v_pk_fma_f32 v[12:13], v[12:13], v[172:173], v[172:173] op_sel:[0,0,1] op_sel_hi:[1,0,1] neg_lo:[0,0,1] neg_hi:[0,0,1]
v_pk_fma_f32 v[14:15], v[14:15], v[172:173], v[172:173] op_sel:[0,0,1] op_sel_hi:[1,0,1] neg_lo:[0,0,1] neg_hi:[0,0,1]
v_pk_fma_f32 v[16:17], v[16:17], v[172:173], v[172:173] op_sel:[0,0,1] op_sel_hi:[1,0,1] neg_lo:[0,0,1] neg_hi:[0,0,1]
v_pk_fma_f32 v[18:19], v[18:19], v[172:173], v[172:173] op_sel:[0,0,1] op_sel_hi:[1,0,1] neg_lo:[0,0,1] neg_hi:[0,0,1]
v_pk_fma_f32 v[20:21], v[20:21], v[172:173], v[172:173] op_sel:[0,0,1] op_sel_hi:[1,0,1] neg_lo:[0,0,1] neg_hi:[0,0,1]
v_pk_fma_f32 v[22:23], v[22:23], v[172:173], v[172:173] op_sel:[0,0,1] op_sel_hi:[1,0,1] neg_lo:[0,0,1] neg_hi:[0,0,1]
v_pk_fma_f32 v[24:25], v[24:25], v[172:173], v[172:173] op_sel:[0,0,1] op_sel_hi:[1,0,1] neg_lo:[0,0,1] neg_hi:[0,0,1]
v_pk_fma_f32 v[26:27], v[26:27], v[172:173], v[172:173] op_sel:[0,0,1] op_sel_hi:[1,0,1] neg_lo:[0,0,1] neg_hi:[0,0,1]
v_pk_fma_f32 v[28:29], v[28:29], v[172:173], v[172:173] op_sel:[0,0,1] op_sel_hi:[1,0,1] neg_lo:[0,0,1] neg_hi:[0,0,1]
v_pk_fma_f32 v[30:31], v[30:31], v[172:173], v[172:173] op_sel:[0,0,1] op_sel_hi:[1,0,1] neg_lo:[0,0,1] neg_hi:[0,0,1]
v_pk_fma_f32 v[32:33], v[32:33], v[172:173], v[172:173] op_sel:[0,0,1] op_sel_hi:[1,0,1] neg_lo:[0,0,1] neg_hi:[0,0,1]
v_pk_fma_f32 v[34:35], v[34:35], v[172:173], v[172:173] op_sel:[0,0,1] op_sel_hi:[1,0,1] neg_lo:[0,0,1] neg_hi:[0,0,1]
v_pk_fma_f32 v[36:37], v[36:37], v[172:173], v[172:173] op_sel:[0,0,1] op_sel_hi:[1,0,1] neg_lo:[0,0,1] neg_hi:[0,0,1]
v_pk_fma_f32 v[38:39], v[38:39], v[172:173], v[172:173] op_sel:[0,0,1] op_sel_hi:[1,0,1] neg_lo:[0,0,1] neg_hi:[0,0,1]
v_pk_fma_f32 v[40:41], v[40:41], v[172:173], v[172:173] op_sel:[0,0,1] op_sel_hi:[1,0,1] neg_lo:[0,0,1] neg_hi:[0,0,1]
v_pk_fma_f32 v[42:43], v[42:43], v[172:173], v[172:173] op_sel:[0,0,1] op_sel_hi:[1,0,1] neg_lo:[0,0,1] neg_hi:[0,0,1]
v_pk_fma_f32 v[44:45], v[44:45], v[172:173], v[172:173] op_sel:[0,0,1] op_sel_hi:[1,0,1] neg_lo:[0,0,1] neg_hi:[0,0,1]
v_pk_fma_f32 v[46:47], v[46:47], v[172:173], v[172:173] op_sel:[0,0,1] op_sel_hi:[1,0,1] neg_lo:[0,0,1] neg_hi:[0,0,1]
s_setprio 2
v_cvt_pkrtz_f16_f32 v137, v120, v121
v_cvt_pkrtz_f16_f32 v139, v122, v123
v_cvt_pkrtz_f16_f32 v141, v124, v125
v_cvt_pkrtz_f16_f32 v143, v126, v127
v_cvt_pkrtz_f16_f32 v145, v128, v129
v_cvt_pk_f16_f32 v155, v130, v131
v_cvt_pk_f16_f32 v152, v132, v133
v_cvt_pk_f16_f32 v149, v134, v135
s_add_u32 m0, s72, 2048
s_add_u32 s43, s82, 128
buffer_load_dwordx4 v240, s[16:19], s43 offen lds
ds_read_b128 v[220:223], v249 offset:23552
v_mfma_f32_32x32x16_bf16 v[120:135], v[96:99], v[224:227], 0
v_pk_fma_f16 v154, v155, v155, s48
v_cvt_pk_bf16_f32 v168, v0, v1
v_and_b32 v137, s49, v137
v_pk_fma_f16 v151, v152, v152, s48
v_cvt_pk_bf16_f32 v169, v2, v3
v_and_b32_e64 v139, s49, v139
v_pk_fma_f16 v148, v149, v149, s48
v_pk_mul_f16 v154, v155, v154
v_cvt_pk_bf16_f32 v170, v4, v5
v_bfe_u32 v136, v137, 2, 14
v_pk_mul_f16 v151, v152, v151
v_pk_mul_f16 v148, v149, v148
v_cvt_pk_bf16_f32 v171, v6, v7
v_bfe_u32 v138, v139, 2, 14
ds_read_b128 v[224:227], v248 offset:16384
ds_read_u16_d16 v136, v136
ds_read_u16_d16 v138, v138
v_mfma_f32_32x32x16_bf16 v[120:135], v[100:103], v[228:231], v[120:135]
v_exp_f16_e64 v153, v154
v_cvt_pk_bf16_f32 v172, v8, v9
v_lshrrev_b32 v137, 18, v137
v_exp_f16 v150, v151
v_cvt_pk_bf16_f32 v173, v10, v11
v_lshrrev_b32 v139, 18, v139
v_exp_f16 v147, v148
v_cvt_pk_bf16_f32 v174, v12, v13
v_and_b32 v141, s49, v141
v_and_b32 v143, s49, v143
v_cvt_pk_bf16_f32 v175, v14, v15
ds_read_b128 v[228:231], v248 offset:19456
ds_read_u16_d16_hi v137, v137
ds_read_u16_d16_hi v139, v139
v_mfma_f32_32x32x16_bf16 v[120:135], v[104:107], v[232:235], v[120:135]
v_exp_f16_sdwa v153, v154 dst_sel:WORD_1 dst_unused:UNUSED_PRESERVE src0_sel:WORD_1
v_bfe_u32 v140, v141, 2, 14
v_cvt_pk_bf16_f32 v176, v16, v17
v_exp_f16_sdwa v150, v151 dst_sel:WORD_1 dst_unused:UNUSED_PRESERVE src0_sel:WORD_1
v_bfe_u32 v142, v143, 2, 14
v_cvt_pk_bf16_f32 v177, v18, v19
v_exp_f16_sdwa v147, v148 dst_sel:WORD_1 dst_unused:UNUSED_PRESERVE src0_sel:WORD_1
v_cvt_pk_bf16_f32 v178, v20, v21
v_lshrrev_b32_e64 v141, 18, v141
v_pk_add_f16 v153, v153, 1.0 op_sel_hi:[1,0]
v_lshrrev_b32_e64 v143, 18, v143
s_add_u32 m0, s72, 3072
s_add_u32 s43, s82, 3072
buffer_load_dwordx4 v240, s[16:19], s43 offen lds
ds_read_b128 v[232:235], v248 offset:17408
ds_read_u16_d16 v140, v140
ds_read_u16_d16 v142, v142
ds_read_u16_d16_hi v141, v141
ds_read_u16_d16_hi v143, v143
v_mfma_f32_32x32x16_bf16 v[120:135], v[108:111], v[236:239], v[120:135]
v_cvt_pk_bf16_f32 v179, v22, v23
v_pk_add_f16 v150, v150, 1.0 op_sel_hi:[1,0]
v_pk_add_f16 v147, v147, 1.0 op_sel_hi:[1,0]
v_and_b32_e64 v145, s49, v145
v_cvt_pk_bf16_f32 v180, v24, v25
v_rcp_f16_e64 v154, v153
v_bfe_u32 v144, v145, 2, 14
v_cvt_pk_bf16_f32 v181, v26, v27
v_rcp_f16_e64 v151, v150
v_lshrrev_b32 v145, 18, v145
v_cvt_pk_bf16_f32 v182, v28, v29
s_waitcnt lgkmcnt(5)
ds_read_b128 v[236:239], v248 offset:20480
ds_read_u16_d16 v144, v144
ds_read_u16_d16_hi v145, v145
v_mfma_f32_32x32x16_bf16 v[120:135], v[112:115], v[216:219], v[120:135]
v_rcp_f16 v148, v147
v_cvt_pk_bf16_f32 v183, v30, v31
v_rcp_f16_sdwa v154, v153 dst_sel:WORD_1 dst_unused:UNUSED_PRESERVE src0_sel:WORD_1
v_fma_mix_f32 v166, v136, v136, v166 op_sel:[0,0,0] op_sel_hi:[1,1,0]
v_cvt_pk_bf16_f32 v184, v32, v33
v_fma_mix_f32 v166, v137, v137, v166 op_sel:[1,1,0] op_sel_hi:[1,1,0]
v_rcp_f16_sdwa v151, v150 dst_sel:WORD_1 dst_unused:UNUSED_PRESERVE src0_sel:WORD_1
v_cvt_pk_bf16_f32 v185, v34, v35
v_fma_mix_f32 v166, v138, v138, v166 op_sel:[0,0,0] op_sel_hi:[1,1,0]
v_rcp_f16_sdwa v148, v147 dst_sel:WORD_1 dst_unused:UNUSED_PRESERVE src0_sel:WORD_1
v_cvt_pk_bf16_f32 v186, v36, v37
ds_read_b128 v[216:219], v248 offset:18432
v_mfma_f32_32x32x16_bf16 v[120:135], v[116:119], v[220:223], v[120:135]
v_fma_mix_f32 v166, v139, v139, v166 op_sel:[1,1,0] op_sel_hi:[1,1,0]
v_pk_mul_f16 v155, v155, v154
s_waitcnt lgkmcnt(4)
v_fma_mix_f32 v166, v140, v140, v166 op_sel:[0,0,0] op_sel_hi:[1,1,0]
v_cvt_pk_bf16_f32 v187, v38, v39
v_pk_mul_f16 v152, v152, v151
v_fma_mix_f32 v166, v141, v141, v166 op_sel:[1,1,0] op_sel_hi:[1,1,0]
v_cvt_pk_bf16_f32 v188, v40, v41
v_pk_mul_f16 v149, v149, v148
v_fma_mix_f32 v166, v155, v155, v166 op_sel:[0,0,0] op_sel_hi:[1,1,0]
v_fma_mix_f32 v166, v142, v142, v166 op_sel:[0,0,0] op_sel_hi:[1,1,0]
v_cvt_pk_bf16_f32 v189, v42, v43
v_fma_mix_f32 v166, v155, v155, v166 op_sel:[1,1,0] op_sel_hi:[1,1,0]
v_fma_mix_f32 v166, v143, v143, v166 op_sel:[1,1,0] op_sel_hi:[1,1,0]
v_fma_mix_f32 v166, v152, v152, v166 op_sel:[0,0,0] op_sel_hi:[1,1,0]
v_cvt_pk_bf16_f32 v190, v44, v45
v_fma_mix_f32 v166, v152, v152, v166 op_sel:[1,1,0] op_sel_hi:[1,1,0]
s_waitcnt lgkmcnt(1)
v_fma_mix_f32 v166, v144, v144, v166 op_sel:[0,0,0] op_sel_hi:[1,1,0]
v_fma_mix_f32 v166, v149, v149, v166 op_sel:[0,0,0] op_sel_hi:[1,1,0]
v_cvt_pk_bf16_f32 v191, v46, v47
v_fma_mix_f32 v166, v145, v145, v166 op_sel:[1,1,0] op_sel_hi:[1,1,0]
v_fma_mix_f32 v166, v149, v149, v166 op_sel:[1,1,0] op_sel_hi:[1,1,0]
s_setprio 1
v_cvt_pkrtz_f16_f32 v137, v120, v121
v_cvt_pkrtz_f16_f32 v139, v122, v123
v_cvt_pkrtz_f16_f32 v141, v124, v125
v_cvt_pkrtz_f16_f32 v143, v126, v127
v_cvt_pkrtz_f16_f32 v145, v128, v129
v_cvt_pk_f16_f32 v155, v130, v131
v_cvt_pk_f16_f32 v152, v132, v133
v_cvt_pk_f16_f32 v149, v134, v135
s_add_u32 m0, s72, 4096
s_add_u32 s43, s82, 3136
buffer_load_dwordx4 v240, s[16:19], s43 offen lds
ds_read_b128 v[220:223], v248 offset:21504
v_mfma_f32_32x32x16_bf16 v[120:135], v[224:227], v[168:171], 0
v_pk_fma_f16 v154, v155, v155, s48
v_and_b32 v247, 1, v251
v_and_b32 v137, s49, v137
v_pk_fma_f16 v151, v152, v152, s48
v_and_b32 v139, s49, v139
v_lshlrev_b32 v247, 4, v247
v_pk_fma_f16 v148, v149, v149, s48
v_pk_mul_f16 v154, v155, v154
v_bfe_u32 v136, v137, 2, 14
v_mov_b32 v252, 15360
v_pk_mul_f16 v151, v152, v151
v_pk_mul_f16 v148, v149, v148
v_bfe_u32 v138, v139, 2, 14
ds_read_b128 v[224:227], v248 offset:22528
ds_read_u16_d16 v136, v136
ds_read_u16_d16 v138, v138
v_mfma_f32_32x32x16_bf16 v[120:135], v[228:231], v[172:175], v[120:135]
v_exp_f16 v153, v154
v_lshlrev_b32 v247, v247, v252
v_lshrrev_b32 v137, 18, v137
v_exp_f16 v150, v151
v_lshrrev_b32 v252, 3, v251
v_lshrrev_b32 v139, 18, v139
v_exp_f16 v147, v148
v_xor_b32 v252, v252, v251
v_and_b32 v141, s49, v141
v_and_b32 v143, s49, v143
ds_read_b128 v[228:231], v248 offset:25600
ds_read_u16_d16_hi v137, v137
ds_read_u16_d16_hi v139, v139
v_mfma_f32_32x32x16_bf16 v[120:135], v[232:235], v[176:179], v[120:135]
v_exp_f16_sdwa v153, v154 dst_sel:WORD_1 dst_unused:UNUSED_PRESERVE src0_sel:WORD_1
v_and_b32_e64 v252, 4, v252
v_bfe_u32 v140, v141, 2, 14
v_exp_f16_sdwa v150, v151 dst_sel:WORD_1 dst_unused:UNUSED_PRESERVE src0_sel:WORD_1
v_bfe_u32 v253, v251, 3, 2
v_bfe_u32 v142, v143, 2, 14
v_exp_f16_sdwa v147, v148 dst_sel:WORD_1 dst_unused:UNUSED_PRESERVE src0_sel:WORD_1
v_lshl_add_u32 v252, v252, 1, 0
v_lshrrev_b32_e64 v141, 18, v141
v_pk_add_f16 v153, v153, 1.0 op_sel_hi:[1,0]
v_lshrrev_b32_e64 v143, 18, v143
s_add_u32 m0, s72, 5120
s_add_u32 s43, s82, 3200
buffer_load_dwordx4 v240, s[16:19], s43 offen lds
ds_read_b128 v[232:235], v248 offset:23552
ds_read_u16_d16 v140, v140
ds_read_u16_d16 v142, v142
ds_read_u16_d16_hi v141, v141
ds_read_u16_d16_hi v143, v143
v_mfma_f32_32x32x16_bf16 v[120:135], v[236:239], v[180:183], v[120:135]
v_lshl_add_u32 v252, v253, 1, v252
v_pk_add_f16 v150, v150, 1.0 op_sel_hi:[1,0]
v_pk_add_f16 v147, v147, 1.0 op_sel_hi:[1,0]
v_and_b32_e64 v145, s49, v145
v_bfe_u32 v253, v251, 1, 1
v_rcp_f16_e64 v154, v153
v_bfe_u32 v144, v145, 2, 14
v_add_u32 v252, v252, v253
v_rcp_f16 v151, v150
v_lshrrev_b32 v145, 18, v145
v_rcp_f16 v148, v147
s_waitcnt lgkmcnt(5)
ds_read_b128 v[236:239], v248 offset:26624
ds_read_u16_d16 v144, v144
ds_read_u16_d16_hi v145, v145
v_mfma_f32_32x32x16_bf16 v[120:135], v[216:219], v[184:187], v[120:135]
v_cmp_eq_u32 vcc, 0, v252
s_nop 1
v_cndmask_b32 v208, 0, v247, vcc
v_rcp_f16_sdwa v154, v153 dst_sel:WORD_1 dst_unused:UNUSED_PRESERVE src0_sel:WORD_1
v_cmp_eq_u32 vcc, 1, v252
s_nop 1
v_cndmask_b32 v209, 0, v247, vcc
v_fma_mix_f32 v167, v136, v136, v167 op_sel:[0,0,0] op_sel_hi:[1,1,0]
v_fma_mix_f32 v167, v137, v137, v167 op_sel:[1,1,0] op_sel_hi:[1,1,0]
v_rcp_f16_sdwa v151, v150 dst_sel:WORD_1 dst_unused:UNUSED_PRESERVE src0_sel:WORD_1
v_cmp_eq_u32 vcc, 2, v252
s_nop 1
v_cndmask_b32 v210, 0, v247, vcc
v_fma_mix_f32 v167, v138, v138, v167 op_sel:[0,0,0] op_sel_hi:[1,1,0]
v_rcp_f16_sdwa v148, v147 dst_sel:WORD_1 dst_unused:UNUSED_PRESERVE src0_sel:WORD_1
v_cmp_eq_u32 vcc, 3, v252
s_nop 1
v_cndmask_b32 v211, 0, v247, vcc
ds_read_b128 v[216:219], v248 offset:24576
v_mfma_f32_32x32x16_bf16 v[120:135], v[220:223], v[188:191], v[120:135]
v_fma_mix_f32 v167, v139, v139, v167 op_sel:[1,1,0] op_sel_hi:[1,1,0]
v_pk_mul_f16 v155, v155, v154
s_waitcnt lgkmcnt(1)
v_fma_mix_f32 v167, v140, v140, v167 op_sel:[0,0,0] op_sel_hi:[1,1,0]
v_cmp_eq_u32 vcc, 4, v252
s_nop 1
v_cndmask_b32 v212, 0, v247, vcc
v_pk_mul_f16 v152, v152, v151
v_fma_mix_f32 v167, v141, v141, v167 op_sel:[1,1,0] op_sel_hi:[1,1,0]
v_pk_mul_f16 v149, v149, v148
v_cmp_eq_u32 vcc, 5, v252
s_nop 1
v_cndmask_b32 v213, 0, v247, vcc
v_fma_mix_f32 v167, v155, v155, v167 op_sel:[0,0,0] op_sel_hi:[1,1,0]
v_fma_mix_f32 v167, v142, v142, v167 op_sel:[0,0,0] op_sel_hi:[1,1,0]
v_fma_mix_f32 v167, v155, v155, v167 op_sel:[1,1,0] op_sel_hi:[1,1,0]
v_fma_mix_f32 v167, v143, v143, v167 op_sel:[1,1,0] op_sel_hi:[1,1,0]
v_cmp_eq_u32 vcc, 6, v252
s_nop 1
v_cndmask_b32 v214, 0, v247, vcc
v_fma_mix_f32 v167, v152, v152, v167 op_sel:[0,0,0] op_sel_hi:[1,1,0]
v_fma_mix_f32 v167, v152, v152, v167 op_sel:[1,1,0] op_sel_hi:[1,1,0]
v_fma_mix_f32 v167, v144, v144, v167 op_sel:[0,0,0] op_sel_hi:[1,1,0]
v_cmp_eq_u32 vcc, 7, v252
s_nop 1
v_cndmask_b32 v215, 0, v247, vcc
v_fma_mix_f32 v167, v149, v149, v167 op_sel:[0,0,0] op_sel_hi:[1,1,0]
v_fma_mix_f32 v167, v145, v145, v167 op_sel:[1,1,0] op_sel_hi:[1,1,0]
v_fma_mix_f32 v167, v149, v149, v167 op_sel:[1,1,0] op_sel_hi:[1,1,0]
v_cvt_pkrtz_f16_f32 v137, v120, v121
v_cvt_pkrtz_f16_f32 v139, v122, v123
v_cvt_pkrtz_f16_f32 v141, v124, v125
v_cvt_pkrtz_f16_f32 v143, v126, v127
v_cvt_pkrtz_f16_f32 v145, v128, v129
v_cvt_pk_f16_f32 v155, v130, v131
v_cvt_pk_f16_f32 v152, v132, v133
v_cvt_pk_f16_f32 v149, v134, v135
s_add_u32 m0, s72, 6144
s_add_u32 s43, s82, 6144
buffer_load_dwordx4 v240, s[16:19], s43 offen lds
ds_read_b128 v[220:223], v248 offset:27648
v_mfma_f32_32x32x16_bf16 v[120:135], v[224:227], v[168:171], 0
v_pk_fma_f16 v154, v155, v155, s48
v_and_b32_e64 v137, s49, v137
v_pk_fma_f16 v151, v152, v152, s48
v_and_b32_e64 v139, s49, v139
v_pk_fma_f16 v148, v149, v149, s48
v_pk_mul_f16 v154, v155, v154
v_bfe_u32 v136, v137, 2, 14
v_pk_mul_f16 v151, v152, v151
ds_read_b128 v[224:227], v248 offset:28672
ds_read_u16_d16 v136, v136
v_mfma_f32_32x32x16_bf16 v[120:135], v[228:231], v[172:175], v[120:135]
v_pk_mul_f16 v148, v149, v148
v_bfe_u32 v138, v139, 2, 14
v_exp_f16 v153, v154
v_lshrrev_b32 v137, 18, v137
v_exp_f16 v150, v151
v_lshrrev_b32 v139, 18, v139
ds_read_b128 v[228:231], v248 offset:31744
ds_read_u16_d16 v138, v138
ds_read_u16_d16_hi v137, v137
ds_read_u16_d16_hi v139, v139
v_mfma_f32_32x32x16_bf16 v[120:135], v[232:235], v[176:179], v[120:135]
v_exp_f16 v147, v148
s_setprio 0
v_and_b32 v141, s49, v141
v_and_b32 v143, s49, v143
v_exp_f16_sdwa v153, v154 dst_sel:WORD_1 dst_unused:UNUSED_PRESERVE src0_sel:WORD_1
v_bfe_u32 v140, v141, 2, 14
v_exp_f16_sdwa v150, v151 dst_sel:WORD_1 dst_unused:UNUSED_PRESERVE src0_sel:WORD_1
ds_read_b128 v[232:235], v248 offset:29696
ds_read_u16_d16 v140, v140
v_mfma_f32_32x32x16_bf16 v[120:135], v[236:239], v[180:183], v[120:135]
v_bfe_u32 v142, v143, 2, 14
v_exp_f16_sdwa v147, v148 dst_sel:WORD_1 dst_unused:UNUSED_PRESERVE src0_sel:WORD_1
v_lshrrev_b32_e64 v141, 18, v141
v_pk_add_f16 v153, v153, 1.0 op_sel_hi:[1,0]
v_lshrrev_b32 v143, 18, v143
v_pk_add_f16 v150, v150, 1.0 op_sel_hi:[1,0]
v_pk_add_f16 v147, v147, 1.0 op_sel_hi:[1,0]
s_waitcnt lgkmcnt(6)
ds_read_b128 v[236:239], v248 offset:32768
ds_read_u16_d16 v142, v142
ds_read_u16_d16_hi v141, v141
ds_read_u16_d16_hi v143, v143
v_mfma_f32_32x32x16_bf16 v[120:135], v[216:219], v[184:187], v[120:135]
v_and_b32 v145, s49, v145
v_rcp_f16 v154, v153
v_bfe_u32 v144, v145, 2, 14
v_rcp_f16 v151, v150
v_lshrrev_b32 v145, 18, v145
ds_read_b128 v[216:219], v248 offset:30720
ds_read_u16_d16 v144, v144
ds_read_u16_d16_hi v145, v145
v_mfma_f32_32x32x16_bf16 v[120:135], v[220:223], v[188:191], v[120:135]
v_rcp_f16 v148, v147
s_waitcnt lgkmcnt(7)
v_or_b32 v0, v136, v137
v_or_b32 v1, v138, v139
v_rcp_f16_sdwa v154, v153 dst_sel:WORD_1 dst_unused:UNUSED_PRESERVE src0_sel:WORD_1
s_waitcnt lgkmcnt(4)
v_or_b32 v2, v140, v141
v_rcp_f16_sdwa v151, v150 dst_sel:WORD_1 dst_unused:UNUSED_PRESERVE src0_sel:WORD_1
s_waitcnt lgkmcnt(3)
v_or_b32 v3, v142, v143
v_rcp_f16_sdwa v148, v147 dst_sel:WORD_1 dst_unused:UNUSED_PRESERVE src0_sel:WORD_1
s_waitcnt lgkmcnt(0)
v_or_b32_e64 v4, v144, v145
v_pk_mul_f16 v5, v155, v154
v_pk_mul_f16 v6, v152, v151
v_pk_mul_f16 v7, v149, v148
s_setprio 2
ds_read_b128 v[220:223], v248 offset:33792
v_mfma_f32_32x32x16_f16 v[192:207], v[0:3], v[208:211], 0
v_cvt_pkrtz_f16_f32 v137, v120, v121
v_cvt_pkrtz_f16_f32 v139, v122, v123
v_cvt_pkrtz_f16_f32 v141, v124, v125
v_cvt_pkrtz_f16_f32 v143, v126, v127
v_cvt_pkrtz_f16_f32 v145, v128, v129
v_mfma_f32_32x32x16_f16 v[192:207], v[4:7], v[212:215], v[192:207]
v_cvt_pk_f16_f32 v155, v130, v131
v_cvt_pk_f16_f32 v152, v132, v133
v_cvt_pk_f16_f32 v149, v134, v135
v_pk_fma_f16 v154, v155, v155, s48
v_and_b32_e64 v137, s49, v137
v_pk_fma_f16 v151, v152, v152, s48
v_mfma_f32_32x32x16_bf16 v[120:135], v[224:227], v[168:171], 0
v_and_b32 v139, s49, v139
v_pk_fma_f16 v148, v149, v149, s48
v_permlane16_swap_b32 v0, v4
v_pk_mul_f16 v154, v155, v154
v_bfe_u32 v136, v137, 2, 14
v_permlane16_swap_b32 v1, v5
v_pk_mul_f16 v151, v152, v151
v_pk_mul_f16 v148, v149, v148
v_bfe_u32 v138, v139, 2, 14
v_permlane16_swap_b32 v2, v6
ds_read_b128 v[224:227], v248 offset:34816
ds_read_u16_d16 v136, v136
ds_read_u16_d16 v138, v138
v_mfma_f32_32x32x16_bf16 v[120:135], v[228:231], v[172:175], v[120:135]
v_exp_f16 v153, v154
v_permlane16_swap_b32 v3, v7
v_lshrrev_b32 v137, 18, v137
v_exp_f16 v150, v151
v_fmac_f32 v156, v192, v192
v_lshrrev_b32 v139, 18, v139
v_exp_f16 v147, v148
v_fmac_f32 v156, v193, v193
v_and_b32_e64 v141, s49, v141
ds_read_b128 v[228:231], v248 offset:37888
ds_read_u16_d16_hi v137, v137
ds_read_u16_d16_hi v139, v139
v_mfma_f32_32x32x16_bf16 v[120:135], v[232:235], v[176:179], v[120:135]
v_and_b32 v143, s49, v143
v_fmac_f32 v156, v194, v194
v_exp_f16_sdwa v153, v154 dst_sel:WORD_1 dst_unused:UNUSED_PRESERVE src0_sel:WORD_1
v_bfe_u32 v140, v141, 2, 14
v_fmac_f32_e64 v156, v195, v195
v_exp_f16_sdwa v150, v151 dst_sel:WORD_1 dst_unused:UNUSED_PRESERVE src0_sel:WORD_1
v_fmac_f32_e64 v156, v196, v196
v_bfe_u32 v142, v143, 2, 14
ds_read_b128 v[232:235], v248 offset:35840
ds_read_u16_d16 v140, v140
ds_read_u16_d16 v142, v142
v_mfma_f32_32x32x16_bf16 v[120:135], v[236:239], v[180:183], v[120:135]
v_exp_f16_sdwa v147, v148 dst_sel:WORD_1 dst_unused:UNUSED_PRESERVE src0_sel:WORD_1
v_fmac_f32 v156, v197, v197
v_lshrrev_b32 v141, 18, v141
v_pk_add_f16 v153, v153, 1.0 op_sel_hi:[1,0]
v_lshrrev_b32 v143, 18, v143
v_fmac_f32 v156, v198, v198
v_pk_add_f16 v150, v150, 1.0 op_sel_hi:[1,0]
v_pk_add_f16 v147, v147, 1.0 op_sel_hi:[1,0]
v_fmac_f32 v156, v199, v199
v_and_b32 v145, s49, v145
ds_read_b128 v[236:239], v248 offset:38912
ds_read_u16_d16_hi v141, v141
ds_read_u16_d16_hi v143, v143
v_mfma_f32_32x32x16_bf16 v[120:135], v[216:219], v[184:187], v[120:135]
v_rcp_f16 v154, v153
v_fmac_f32 v156, v200, v200
v_bfe_u32 v144, v145, 2, 14
v_rcp_f16 v151, v150
v_fmac_f32 v156, v201, v201
v_lshrrev_b32 v145, 18, v145
v_rcp_f16 v148, v147
v_fmac_f32_e64 v156, v202, v202
ds_read_u16_d16 v144, v144
ds_read_u16_d16_hi v145, v145
s_waitcnt lgkmcnt(5)
v_or_b32 v8, v136, v137
ds_read_b128 v[216:219], v248 offset:36864
v_mfma_f32_32x32x16_bf16 v[120:135], v[220:223], v[188:191], v[120:135]
v_or_b32 v9, v138, v139
v_fmac_f32 v156, v203, v203
v_rcp_f16_sdwa v154, v153 dst_sel:WORD_1 dst_unused:UNUSED_PRESERVE src0_sel:WORD_1
v_fmac_f32 v156, v204, v204
s_waitcnt lgkmcnt(4)
v_or_b32_e64 v10, v140, v141
v_rcp_f16_sdwa v151, v150 dst_sel:WORD_1 dst_unused:UNUSED_PRESERVE src0_sel:WORD_1
v_fmac_f32 v156, v205, v205
s_waitcnt lgkmcnt(3)
v_or_b32_e64 v11, v142, v143
v_rcp_f16_sdwa v148, v147 dst_sel:WORD_1 dst_unused:UNUSED_PRESERVE src0_sel:WORD_1
v_fmac_f32 v156, v206, v206
s_waitcnt lgkmcnt(1)
v_or_b32_e64 v12, v144, v145
v_pk_mul_f16 v13, v155, v154
v_fmac_f32_e64 v156, v207, v207
v_pk_mul_f16 v14, v152, v151
v_pk_mul_f16 v15, v149, v148
ds_read_b128 v[220:223], v248 offset:39936
v_mfma_f32_32x32x16_f16 v[192:207], v[8:11], v[208:211], 0
v_cvt_pkrtz_f16_f32 v137, v120, v121
v_cvt_pkrtz_f16_f32 v139, v122, v123
v_cvt_pkrtz_f16_f32 v141, v124, v125
v_cvt_pkrtz_f16_f32 v143, v126, v127
v_cvt_pkrtz_f16_f32 v145, v128, v129
v_mfma_f32_32x32x16_f16 v[192:207], v[12:15], v[212:215], v[192:207]
v_cvt_pk_f16_f32 v155, v130, v131
v_cvt_pk_f16_f32 v152, v132, v133
v_cvt_pk_f16_f32 v149, v134, v135
v_pk_fma_f16 v154, v155, v155, s48
v_and_b32_e64 v137, s49, v137
v_pk_fma_f16 v151, v152, v152, s48
v_mfma_f32_32x32x16_bf16 v[120:135], v[224:227], v[168:171], 0
v_and_b32 v139, s49, v139
v_pk_fma_f16 v148, v149, v149, s48
v_permlane16_swap_b32 v8, v12
v_pk_mul_f16 v154, v155, v154
v_bfe_u32 v136, v137, 2, 14
v_permlane16_swap_b32 v9, v13
v_pk_mul_f16 v151, v152, v151
v_pk_mul_f16 v148, v149, v148
v_bfe_u32 v138, v139, 2, 14
v_permlane16_swap_b32 v10, v14
ds_read_b128 v[224:227], v248 offset:40960
ds_read_u16_d16 v136, v136
ds_read_u16_d16 v138, v138
v_mfma_f32_32x32x16_bf16 v[120:135], v[228:231], v[172:175], v[120:135]
v_exp_f16 v153, v154
v_permlane16_swap_b32 v11, v15
v_lshrrev_b32 v137, 18, v137
v_exp_f16 v150, v151
v_fmac_f32 v157, v192, v192
v_lshrrev_b32 v139, 18, v139
v_exp_f16 v147, v148
v_fmac_f32 v157, v193, v193
v_and_b32_e64 v141, s49, v141
ds_read_b128 v[228:231], v248 offset:44032
ds_read_u16_d16_hi v137, v137
ds_read_u16_d16_hi v139, v139
v_mfma_f32_32x32x16_bf16 v[120:135], v[232:235], v[176:179], v[120:135]
v_and_b32 v143, s49, v143
v_fmac_f32 v157, v194, v194
v_exp_f16_sdwa v153, v154 dst_sel:WORD_1 dst_unused:UNUSED_PRESERVE src0_sel:WORD_1
v_bfe_u32 v140, v141, 2, 14
v_fmac_f32_e64 v157, v195, v195
v_exp_f16_sdwa v150, v151 dst_sel:WORD_1 dst_unused:UNUSED_PRESERVE src0_sel:WORD_1
v_fmac_f32_e64 v157, v196, v196
v_bfe_u32 v142, v143, 2, 14
ds_read_b128 v[232:235], v248 offset:41984
ds_read_u16_d16 v140, v140
ds_read_u16_d16 v142, v142
v_mfma_f32_32x32x16_bf16 v[120:135], v[236:239], v[180:183], v[120:135]
v_exp_f16_sdwa v147, v148 dst_sel:WORD_1 dst_unused:UNUSED_PRESERVE src0_sel:WORD_1
v_fmac_f32 v157, v197, v197
v_lshrrev_b32 v141, 18, v141
v_pk_add_f16 v153, v153, 1.0 op_sel_hi:[1,0]
v_lshrrev_b32 v143, 18, v143
v_fmac_f32 v157, v198, v198
v_pk_add_f16 v150, v150, 1.0 op_sel_hi:[1,0]
v_pk_add_f16 v147, v147, 1.0 op_sel_hi:[1,0]
v_fmac_f32_e64 v157, v199, v199
v_and_b32 v145, s49, v145
s_waitcnt lgkmcnt(4)
ds_read_b128 v[236:239], v248 offset:45056
ds_read_u16_d16_hi v141, v141
ds_read_u16_d16_hi v143, v143
v_mfma_f32_32x32x16_bf16 v[120:135], v[216:219], v[184:187], v[120:135]
v_rcp_f16 v154, v153
v_fmac_f32 v157, v200, v200
v_bfe_u32 v144, v145, 2, 14
v_rcp_f16 v151, v150
v_fmac_f32 v157, v201, v201
v_lshrrev_b32 v145, 18, v145
v_rcp_f16 v148, v147
v_fmac_f32_e64 v157, v202, v202
ds_read_u16_d16 v144, v144
ds_read_u16_d16_hi v145, v145
v_or_b32_e64 v16, v136, v137
ds_read_b128 v[216:219], v248 offset:43008
v_mfma_f32_32x32x16_bf16 v[120:135], v[220:223], v[188:191], v[120:135]
s_waitcnt lgkmcnt(6)
v_or_b32 v17, v138, v139
v_fmac_f32_e64 v157, v203, v203
v_rcp_f16_sdwa v154, v153 dst_sel:WORD_1 dst_unused:UNUSED_PRESERVE src0_sel:WORD_1
v_fmac_f32 v157, v204, v204
s_waitcnt lgkmcnt(4)
v_or_b32_e64 v18, v140, v141
v_rcp_f16_sdwa v151, v150 dst_sel:WORD_1 dst_unused:UNUSED_PRESERVE src0_sel:WORD_1
v_fmac_f32 v157, v205, v205
s_waitcnt lgkmcnt(3)
v_or_b32_e64 v19, v142, v143
v_rcp_f16_sdwa v148, v147 dst_sel:WORD_1 dst_unused:UNUSED_PRESERVE src0_sel:WORD_1
v_fmac_f32 v157, v206, v206
s_waitcnt lgkmcnt(1)
v_or_b32_e64 v20, v144, v145
v_pk_mul_f16 v21, v155, v154
v_fmac_f32 v157, v207, v207
v_pk_mul_f16 v22, v152, v151
v_pk_mul_f16 v23, v149, v148
s_setprio 1
ds_read_b128 v[220:223], v248 offset:46080
v_mfma_f32_32x32x16_f16 v[192:207], v[16:19], v[208:211], 0
v_cvt_pkrtz_f16_f32 v137, v120, v121
v_cvt_pkrtz_f16_f32 v139, v122, v123
v_cvt_pkrtz_f16_f32 v141, v124, v125
v_cvt_pkrtz_f16_f32 v143, v126, v127
v_cvt_pkrtz_f16_f32 v145, v128, v129
v_mfma_f32_32x32x16_f16 v[192:207], v[20:23], v[212:215], v[192:207]
v_cvt_pk_f16_f32 v155, v130, v131
v_cvt_pk_f16_f32 v152, v132, v133
v_cvt_pk_f16_f32 v149, v134, v135
v_pk_fma_f16 v154, v155, v155, s48
v_and_b32_e64 v137, s49, v137
v_pk_fma_f16 v151, v152, v152, s48
v_mfma_f32_32x32x16_bf16 v[120:135], v[224:227], v[168:171], 0
v_and_b32 v139, s49, v139
v_pk_fma_f16 v148, v149, v149, s48
v_permlane16_swap_b32 v16, v20
v_pk_mul_f16 v154, v155, v154
v_bfe_u32 v136, v137, 2, 14
v_permlane16_swap_b32 v17, v21
v_pk_mul_f16 v151, v152, v151
v_pk_mul_f16 v148, v149, v148
v_bfe_u32 v138, v139, 2, 14
v_permlane16_swap_b32 v18, v22
ds_read_b128 v[224:227], v248 offset:47104
ds_read_u16_d16 v136, v136
ds_read_u16_d16 v138, v138
v_mfma_f32_32x32x16_bf16 v[120:135], v[228:231], v[172:175], v[120:135]
v_exp_f16 v153, v154
v_permlane16_swap_b32 v19, v23
v_lshrrev_b32 v137, 18, v137
v_exp_f16 v150, v151
v_fmac_f32 v158, v192, v192
v_lshrrev_b32 v139, 18, v139
v_exp_f16 v147, v148
v_fmac_f32 v158, v193, v193
v_and_b32_e64 v141, s49, v141
ds_read_b128 v[228:231], v248 offset:50176
ds_read_u16_d16_hi v137, v137
ds_read_u16_d16_hi v139, v139
v_mfma_f32_32x32x16_bf16 v[120:135], v[232:235], v[176:179], v[120:135]
v_and_b32 v143, s49, v143
v_fmac_f32 v158, v194, v194
v_exp_f16_sdwa v153, v154 dst_sel:WORD_1 dst_unused:UNUSED_PRESERVE src0_sel:WORD_1
v_bfe_u32 v140, v141, 2, 14
v_fmac_f32_e64 v158, v195, v195
v_exp_f16_sdwa v150, v151 dst_sel:WORD_1 dst_unused:UNUSED_PRESERVE src0_sel:WORD_1
v_fmac_f32_e64 v158, v196, v196
v_bfe_u32 v142, v143, 2, 14
ds_read_b128 v[232:235], v248 offset:48128
ds_read_u16_d16 v140, v140
ds_read_u16_d16 v142, v142
v_mfma_f32_32x32x16_bf16 v[120:135], v[236:239], v[180:183], v[120:135]
v_exp_f16_sdwa v147, v148 dst_sel:WORD_1 dst_unused:UNUSED_PRESERVE src0_sel:WORD_1
v_fmac_f32 v158, v197, v197
v_lshrrev_b32 v141, 18, v141
v_pk_add_f16 v153, v153, 1.0 op_sel_hi:[1,0]
v_lshrrev_b32 v143, 18, v143
v_fmac_f32 v158, v198, v198
v_pk_add_f16 v150, v150, 1.0 op_sel_hi:[1,0]
v_pk_add_f16 v147, v147, 1.0 op_sel_hi:[1,0]
v_fmac_f32_e64 v158, v199, v199
v_and_b32 v145, s49, v145
s_waitcnt lgkmcnt(4)
ds_read_b128 v[236:239], v248 offset:51200
ds_read_u16_d16_hi v141, v141
ds_read_u16_d16_hi v143, v143
v_mfma_f32_32x32x16_bf16 v[120:135], v[216:219], v[184:187], v[120:135]
v_rcp_f16 v154, v153
v_fmac_f32 v158, v200, v200
v_bfe_u32 v144, v145, 2, 14
v_rcp_f16 v151, v150
v_fmac_f32 v158, v201, v201
v_lshrrev_b32 v145, 18, v145
v_rcp_f16 v148, v147
v_fmac_f32_e64 v158, v202, v202
ds_read_u16_d16 v144, v144
ds_read_u16_d16_hi v145, v145
v_or_b32_e64 v24, v136, v137
ds_read_b128 v[216:219], v248 offset:49152
v_mfma_f32_32x32x16_bf16 v[120:135], v[220:223], v[188:191], v[120:135]
s_waitcnt lgkmcnt(6)
v_or_b32 v25, v138, v139
v_fmac_f32_e64 v158, v203, v203
v_rcp_f16_sdwa v154, v153 dst_sel:WORD_1 dst_unused:UNUSED_PRESERVE src0_sel:WORD_1
v_fmac_f32 v158, v204, v204
s_waitcnt lgkmcnt(4)
v_or_b32_e64 v26, v140, v141
v_rcp_f16_sdwa v151, v150 dst_sel:WORD_1 dst_unused:UNUSED_PRESERVE src0_sel:WORD_1
v_fmac_f32 v158, v205, v205
s_waitcnt lgkmcnt(3)
v_or_b32_e64 v27, v142, v143
v_rcp_f16_sdwa v148, v147 dst_sel:WORD_1 dst_unused:UNUSED_PRESERVE src0_sel:WORD_1
v_fmac_f32 v158, v206, v206
s_waitcnt lgkmcnt(1)
v_or_b32_e64 v28, v144, v145
v_pk_mul_f16 v29, v155, v154
v_fmac_f32_e64 v158, v207, v207
v_pk_mul_f16 v30, v152, v151
v_pk_mul_f16 v31, v149, v148
ds_read_b128 v[220:223], v248 offset:52224
v_mfma_f32_32x32x16_f16 v[192:207], v[24:27], v[208:211], 0
v_cvt_pkrtz_f16_f32 v137, v120, v121
v_cvt_pkrtz_f16_f32 v139, v122, v123
v_cvt_pkrtz_f16_f32 v141, v124, v125
v_cvt_pkrtz_f16_f32 v143, v126, v127
v_cvt_pkrtz_f16_f32 v145, v128, v129
v_mfma_f32_32x32x16_f16 v[192:207], v[28:31], v[212:215], v[192:207]
v_cvt_pk_f16_f32 v155, v130, v131
v_cvt_pk_f16_f32 v152, v132, v133
v_cvt_pk_f16_f32 v149, v134, v135
v_pk_fma_f16 v154, v155, v155, s48
v_and_b32_e64 v137, s49, v137
v_pk_fma_f16 v151, v152, v152, s48
v_mfma_f32_32x32x16_bf16 v[120:135], v[224:227], v[168:171], 0
v_and_b32 v139, s49, v139
v_pk_fma_f16 v148, v149, v149, s48
v_permlane16_swap_b32 v24, v28
v_pk_mul_f16 v154, v155, v154
v_bfe_u32 v136, v137, 2, 14
v_permlane16_swap_b32 v25, v29
v_pk_mul_f16 v151, v152, v151
v_pk_mul_f16 v148, v149, v148
v_bfe_u32 v138, v139, 2, 14
v_permlane16_swap_b32 v26, v30
ds_read_b128 v[224:227], v248 offset:53248
ds_read_u16_d16 v136, v136
ds_read_u16_d16 v138, v138
v_mfma_f32_32x32x16_bf16 v[120:135], v[228:231], v[172:175], v[120:135]
v_exp_f16 v153, v154
v_permlane16_swap_b32 v27, v31
v_lshrrev_b32 v137, 18, v137
v_exp_f16 v150, v151
v_fmac_f32 v159, v192, v192
v_lshrrev_b32 v139, 18, v139
v_exp_f16 v147, v148
v_fmac_f32 v159, v193, v193
v_and_b32_e64 v141, s49, v141
ds_read_b128 v[228:231], v248 offset:56320
ds_read_u16_d16_hi v137, v137
ds_read_u16_d16_hi v139, v139
v_mfma_f32_32x32x16_bf16 v[120:135], v[232:235], v[176:179], v[120:135]
v_and_b32 v143, s49, v143
s_setprio 0
v_fmac_f32_e64 v159, v194, v194
v_exp_f16_sdwa v153, v154 dst_sel:WORD_1 dst_unused:UNUSED_PRESERVE src0_sel:WORD_1
v_bfe_u32 v140, v141, 2, 14
v_fmac_f32_e64 v159, v195, v195
v_exp_f16_sdwa v150, v151 dst_sel:WORD_1 dst_unused:UNUSED_PRESERVE src0_sel:WORD_1
v_fmac_f32_e64 v159, v196, v196
v_bfe_u32 v142, v143, 2, 14
ds_read_b128 v[232:235], v248 offset:54272
ds_read_u16_d16 v140, v140
ds_read_u16_d16 v142, v142
v_mfma_f32_32x32x16_bf16 v[120:135], v[236:239], v[180:183], v[120:135]
v_exp_f16_sdwa v147, v148 dst_sel:WORD_1 dst_unused:UNUSED_PRESERVE src0_sel:WORD_1
v_fmac_f32 v159, v197, v197
v_lshrrev_b32 v141, 18, v141
v_pk_add_f16 v153, v153, 1.0 op_sel_hi:[1,0]
v_lshrrev_b32 v143, 18, v143
v_fmac_f32 v159, v198, v198
v_pk_add_f16 v150, v150, 1.0 op_sel_hi:[1,0]
v_pk_add_f16 v147, v147, 1.0 op_sel_hi:[1,0]
v_fmac_f32_e64 v159, v199, v199
v_and_b32 v145, s49, v145
s_waitcnt lgkmcnt(3)
ds_read_b128 v[236:239], v248 offset:57344
ds_read_u16_d16_hi v141, v141
ds_read_u16_d16_hi v143, v143
v_mfma_f32_32x32x16_bf16 v[120:135], v[216:219], v[184:187], v[120:135]
v_rcp_f16 v154, v153
v_fmac_f32 v159, v200, v200
v_bfe_u32 v144, v145, 2, 14
v_rcp_f16 v151, v150
v_fmac_f32 v159, v201, v201
v_lshrrev_b32 v145, 18, v145
v_rcp_f16 v148, v147
v_fmac_f32_e64 v159, v202, v202
ds_read_u16_d16 v144, v144
ds_read_u16_d16_hi v145, v145
v_or_b32_e64 v32, v136, v137
ds_read_b128 v[216:219], v248 offset:55296
v_mfma_f32_32x32x16_bf16 v[120:135], v[220:223], v[188:191], v[120:135]
v_or_b32 v33, v138, v139
v_fmac_f32 v159, v203, v203
v_rcp_f16_sdwa v154, v153 dst_sel:WORD_1 dst_unused:UNUSED_PRESERVE src0_sel:WORD_1
v_fmac_f32 v159, v204, v204
s_waitcnt lgkmcnt(4)
v_or_b32_e64 v34, v140, v141
v_rcp_f16_sdwa v151, v150 dst_sel:WORD_1 dst_unused:UNUSED_PRESERVE src0_sel:WORD_1
v_fmac_f32 v159, v205, v205
s_waitcnt lgkmcnt(3)
v_or_b32_e64 v35, v142, v143
v_rcp_f16_sdwa v148, v147 dst_sel:WORD_1 dst_unused:UNUSED_PRESERVE src0_sel:WORD_1
v_fmac_f32 v159, v206, v206
s_waitcnt lgkmcnt(1)
v_or_b32_e64 v36, v144, v145
v_pk_mul_f16 v37, v155, v154
v_fmac_f32 v159, v207, v207
v_pk_mul_f16 v38, v152, v151
v_pk_mul_f16 v39, v149, v148
s_setprio 2
ds_read_b128 v[220:223], v248 offset:58368
v_mfma_f32_32x32x16_f16 v[192:207], v[32:35], v[208:211], 0
v_cvt_pkrtz_f16_f32 v137, v120, v121
v_cvt_pkrtz_f16_f32 v139, v122, v123
v_cvt_pkrtz_f16_f32 v141, v124, v125
v_cvt_pkrtz_f16_f32 v143, v126, v127
v_cvt_pkrtz_f16_f32 v145, v128, v129
v_mfma_f32_32x32x16_f16 v[192:207], v[36:39], v[212:215], v[192:207]
v_cvt_pk_f16_f32 v155, v130, v131
v_cvt_pk_f16_f32 v152, v132, v133
v_cvt_pk_f16_f32 v149, v134, v135
v_pk_fma_f16 v154, v155, v155, s48
v_and_b32_e64 v137, s49, v137
v_pk_fma_f16 v151, v152, v152, s48
v_mfma_f32_32x32x16_bf16 v[120:135], v[224:227], v[168:171], 0
v_and_b32 v139, s49, v139
v_pk_fma_f16 v148, v149, v149, s48
v_permlane16_swap_b32 v32, v36
v_pk_mul_f16 v154, v155, v154
v_bfe_u32 v136, v137, 2, 14
v_permlane16_swap_b32 v33, v37
v_pk_mul_f16 v151, v152, v151
v_pk_mul_f16 v148, v149, v148
v_bfe_u32 v138, v139, 2, 14
v_permlane16_swap_b32 v34, v38
ds_read_b128 v[224:227], v248 offset:59392
ds_read_u16_d16 v136, v136
ds_read_u16_d16 v138, v138
v_mfma_f32_32x32x16_bf16 v[120:135], v[228:231], v[172:175], v[120:135]
v_exp_f16 v153, v154
v_permlane16_swap_b32 v35, v39
v_lshrrev_b32 v137, 18, v137
v_exp_f16 v150, v151
v_fmac_f32 v160, v192, v192
v_lshrrev_b32 v139, 18, v139
v_exp_f16 v147, v148
v_fmac_f32 v160, v193, v193
v_and_b32_e64 v141, s49, v141
ds_read_b128 v[228:231], v248 offset:62464
ds_read_u16_d16_hi v137, v137
ds_read_u16_d16_hi v139, v139
v_mfma_f32_32x32x16_bf16 v[120:135], v[232:235], v[176:179], v[120:135]
v_and_b32 v143, s49, v143
v_fmac_f32 v160, v194, v194
v_exp_f16_sdwa v153, v154 dst_sel:WORD_1 dst_unused:UNUSED_PRESERVE src0_sel:WORD_1
v_bfe_u32 v140, v141, 2, 14
v_fmac_f32_e64 v160, v195, v195
v_exp_f16_sdwa v150, v151 dst_sel:WORD_1 dst_unused:UNUSED_PRESERVE src0_sel:WORD_1
v_fmac_f32_e64 v160, v196, v196
v_bfe_u32 v142, v143, 2, 14
ds_read_b128 v[232:235], v248 offset:60416
ds_read_u16_d16 v140, v140
ds_read_u16_d16 v142, v142
v_mfma_f32_32x32x16_bf16 v[120:135], v[236:239], v[180:183], v[120:135]
v_exp_f16_sdwa v147, v148 dst_sel:WORD_1 dst_unused:UNUSED_PRESERVE src0_sel:WORD_1
v_fmac_f32 v160, v197, v197
v_lshrrev_b32 v141, 18, v141
v_pk_add_f16 v153, v153, 1.0 op_sel_hi:[1,0]
v_lshrrev_b32 v143, 18, v143
v_fmac_f32 v160, v198, v198
v_pk_add_f16 v150, v150, 1.0 op_sel_hi:[1,0]
v_pk_add_f16 v147, v147, 1.0 op_sel_hi:[1,0]
v_fmac_f32_e64 v160, v199, v199
v_and_b32 v145, s49, v145
s_waitcnt lgkmcnt(4)
ds_read_b128 v[236:239], v248 offset:63488
ds_read_u16_d16_hi v141, v141
ds_read_u16_d16_hi v143, v143
v_mfma_f32_32x32x16_bf16 v[120:135], v[216:219], v[184:187], v[120:135]
v_rcp_f16 v154, v153
v_fmac_f32 v160, v200, v200
v_bfe_u32 v144, v145, 2, 14
v_rcp_f16 v151, v150
v_fmac_f32 v160, v201, v201
v_lshrrev_b32 v145, 18, v145
v_rcp_f16 v148, v147
v_fmac_f32_e64 v160, v202, v202
ds_read_u16_d16 v144, v144
ds_read_u16_d16_hi v145, v145
v_or_b32_e64 v40, v136, v137
ds_read_b128 v[216:219], v248 offset:61440
v_mfma_f32_32x32x16_bf16 v[120:135], v[220:223], v[188:191], v[120:135]
s_waitcnt lgkmcnt(6)
v_or_b32 v41, v138, v139
v_fmac_f32_e64 v160, v203, v203
v_rcp_f16_sdwa v154, v153 dst_sel:WORD_1 dst_unused:UNUSED_PRESERVE src0_sel:WORD_1
v_fmac_f32 v160, v204, v204
s_waitcnt lgkmcnt(4)
v_or_b32_e64 v42, v140, v141
v_rcp_f16_sdwa v151, v150 dst_sel:WORD_1 dst_unused:UNUSED_PRESERVE src0_sel:WORD_1
v_fmac_f32 v160, v205, v205
s_waitcnt lgkmcnt(3)
v_or_b32_e64 v43, v142, v143
v_rcp_f16_sdwa v148, v147 dst_sel:WORD_1 dst_unused:UNUSED_PRESERVE src0_sel:WORD_1
v_fmac_f32 v160, v206, v206
s_waitcnt lgkmcnt(1)
v_or_b32_e64 v44, v144, v145
v_pk_mul_f16 v45, v155, v154
v_fmac_f32_e64 v160, v207, v207
v_pk_mul_f16 v46, v152, v151
v_pk_mul_f16 v47, v149, v148
ds_read_b128 v[220:223], v248 offset:64512
v_mfma_f32_32x32x16_f16 v[192:207], v[40:43], v[208:211], 0
v_cvt_pkrtz_f16_f32 v137, v120, v121
v_cvt_pkrtz_f16_f32 v139, v122, v123
v_cvt_pkrtz_f16_f32 v141, v124, v125
v_cvt_pkrtz_f16_f32 v143, v126, v127
v_cvt_pkrtz_f16_f32 v145, v128, v129
v_mfma_f32_32x32x16_f16 v[192:207], v[44:47], v[212:215], v[192:207]
v_cvt_pk_f16_f32 v155, v130, v131
v_cvt_pk_f16_f32 v152, v132, v133
v_cvt_pk_f16_f32 v149, v134, v135
v_pk_fma_f16 v154, v155, v155, s48
v_and_b32_e64 v137, s49, v137
v_pk_fma_f16 v151, v152, v152, s48
v_mfma_f32_32x32x16_bf16 v[120:135], v[224:227], v[168:171], 0
v_and_b32 v139, s49, v139
v_pk_fma_f16 v148, v149, v149, s48
v_permlane16_swap_b32 v40, v44
v_pk_mul_f16 v154, v155, v154
v_bfe_u32 v136, v137, 2, 14
v_permlane16_swap_b32 v41, v45
v_pk_mul_f16 v151, v152, v151
v_pk_mul_f16 v148, v149, v148
v_bfe_u32 v138, v139, 2, 14
v_permlane16_swap_b32 v42, v46
ds_read_b128 v[224:227], v249
ds_read_u16_d16 v136, v136
ds_read_u16_d16 v138, v138
v_mfma_f32_32x32x16_bf16 v[120:135], v[228:231], v[172:175], v[120:135]
v_exp_f16 v153, v154
v_permlane16_swap_b32 v43, v47
v_lshrrev_b32 v137, 18, v137
v_exp_f16 v150, v151
v_fmac_f32 v161, v192, v192
v_lshrrev_b32 v139, 18, v139
v_exp_f16 v147, v148
v_fmac_f32 v161, v193, v193
v_and_b32_e64 v141, s49, v141
ds_read_b128 v[228:231], v249 offset:3072
ds_read_u16_d16_hi v137, v137
ds_read_u16_d16_hi v139, v139
v_mfma_f32_32x32x16_bf16 v[120:135], v[232:235], v[176:179], v[120:135]
v_and_b32 v143, s49, v143
v_fmac_f32 v161, v194, v194
v_exp_f16_sdwa v153, v154 dst_sel:WORD_1 dst_unused:UNUSED_PRESERVE src0_sel:WORD_1
v_bfe_u32 v140, v141, 2, 14
v_fmac_f32_e64 v161, v195, v195
v_exp_f16_sdwa v150, v151 dst_sel:WORD_1 dst_unused:UNUSED_PRESERVE src0_sel:WORD_1
v_fmac_f32_e64 v161, v196, v196
v_bfe_u32 v142, v143, 2, 14
ds_read_b128 v[232:235], v249 offset:1024
ds_read_u16_d16 v140, v140
ds_read_u16_d16 v142, v142
v_mfma_f32_32x32x16_bf16 v[120:135], v[236:239], v[180:183], v[120:135]
v_exp_f16_sdwa v147, v148 dst_sel:WORD_1 dst_unused:UNUSED_PRESERVE src0_sel:WORD_1
v_fmac_f32 v161, v197, v197
v_lshrrev_b32 v141, 18, v141
v_pk_add_f16 v153, v153, 1.0 op_sel_hi:[1,0]
v_lshrrev_b32 v143, 18, v143
v_fmac_f32 v161, v198, v198
v_pk_add_f16 v150, v150, 1.0 op_sel_hi:[1,0]
v_pk_add_f16 v147, v147, 1.0 op_sel_hi:[1,0]
v_fmac_f32_e64 v161, v199, v199
v_and_b32 v145, s49, v145
s_waitcnt lgkmcnt(4)
ds_read_b128 v[236:239], v249 offset:4096
ds_read_u16_d16_hi v141, v141
ds_read_u16_d16_hi v143, v143
v_mfma_f32_32x32x16_bf16 v[120:135], v[216:219], v[184:187], v[120:135]
v_rcp_f16 v154, v153
v_fmac_f32 v161, v200, v200
v_bfe_u32 v144, v145, 2, 14
v_rcp_f16 v151, v150
v_fmac_f32 v161, v201, v201
v_lshrrev_b32 v145, 18, v145
v_rcp_f16 v148, v147
v_fmac_f32_e64 v161, v202, v202
ds_read_u16_d16 v144, v144
ds_read_u16_d16_hi v145, v145
v_or_b32_e64 v48, v136, v137
ds_read_b128 v[216:219], v249 offset:2048
v_mfma_f32_32x32x16_bf16 v[120:135], v[220:223], v[188:191], v[120:135]
s_waitcnt lgkmcnt(6)
v_or_b32 v49, v138, v139
v_fmac_f32_e64 v161, v203, v203
v_rcp_f16_sdwa v154, v153 dst_sel:WORD_1 dst_unused:UNUSED_PRESERVE src0_sel:WORD_1
v_fmac_f32 v161, v204, v204
s_waitcnt lgkmcnt(4)
v_or_b32_e64 v50, v140, v141
v_rcp_f16_sdwa v151, v150 dst_sel:WORD_1 dst_unused:UNUSED_PRESERVE src0_sel:WORD_1
v_fmac_f32 v161, v205, v205
s_waitcnt lgkmcnt(3)
v_or_b32_e64 v51, v142, v143
v_rcp_f16_sdwa v148, v147 dst_sel:WORD_1 dst_unused:UNUSED_PRESERVE src0_sel:WORD_1
v_fmac_f32 v161, v206, v206
s_waitcnt lgkmcnt(1)
v_or_b32_e64 v52, v144, v145
v_pk_mul_f16 v53, v155, v154
v_fmac_f32 v161, v207, v207
v_pk_mul_f16 v54, v152, v151
v_pk_mul_f16 v55, v149, v148
s_setprio 1
ds_read_b128 v[220:223], v249 offset:5120
v_mfma_f32_32x32x16_f16 v[192:207], v[48:51], v[208:211], 0
v_cvt_pkrtz_f16_f32 v137, v120, v121
v_cvt_pkrtz_f16_f32 v139, v122, v123
v_cvt_pkrtz_f16_f32 v141, v124, v125
v_cvt_pkrtz_f16_f32 v143, v126, v127
v_cvt_pkrtz_f16_f32 v145, v128, v129
v_mfma_f32_32x32x16_f16 v[192:207], v[52:55], v[212:215], v[192:207]
v_cvt_pk_f16_f32 v155, v130, v131
v_cvt_pk_f16_f32 v152, v132, v133
v_cvt_pk_f16_f32 v149, v134, v135
v_pk_fma_f16 v154, v155, v155, s48
v_and_b32_e64 v137, s49, v137
v_pk_fma_f16 v151, v152, v152, s48
v_mfma_f32_32x32x16_bf16 v[120:135], v[224:227], v[168:171], 0
v_and_b32 v139, s49, v139
v_pk_fma_f16 v148, v149, v149, s48
v_permlane16_swap_b32 v48, v52
v_pk_mul_f16 v154, v155, v154
v_bfe_u32 v136, v137, 2, 14
v_permlane16_swap_b32 v49, v53
v_pk_mul_f16 v151, v152, v151
v_pk_mul_f16 v148, v149, v148
v_bfe_u32 v138, v139, 2, 14
v_permlane16_swap_b32 v50, v54
ds_read_b128 v[224:227], v249 offset:6144
ds_read_u16_d16 v136, v136
ds_read_u16_d16 v138, v138
v_mfma_f32_32x32x16_bf16 v[120:135], v[228:231], v[172:175], v[120:135]
v_exp_f16 v153, v154
v_permlane16_swap_b32 v51, v55
v_lshrrev_b32 v137, 18, v137
v_exp_f16 v150, v151
v_fmac_f32 v162, v192, v192
v_lshrrev_b32 v139, 18, v139
v_exp_f16 v147, v148
v_fmac_f32 v162, v193, v193
v_and_b32_e64 v141, s49, v141
ds_read_b128 v[228:231], v249 offset:9216
ds_read_u16_d16_hi v137, v137
ds_read_u16_d16_hi v139, v139
v_mfma_f32_32x32x16_bf16 v[120:135], v[232:235], v[176:179], v[120:135]
v_and_b32 v143, s49, v143
v_fmac_f32 v162, v194, v194
v_exp_f16_sdwa v153, v154 dst_sel:WORD_1 dst_unused:UNUSED_PRESERVE src0_sel:WORD_1
v_bfe_u32 v140, v141, 2, 14
v_fmac_f32_e64 v162, v195, v195
v_exp_f16_sdwa v150, v151 dst_sel:WORD_1 dst_unused:UNUSED_PRESERVE src0_sel:WORD_1
v_fmac_f32_e64 v162, v196, v196
v_bfe_u32 v142, v143, 2, 14
ds_read_b128 v[232:235], v249 offset:7168
ds_read_u16_d16 v140, v140
ds_read_u16_d16 v142, v142
v_mfma_f32_32x32x16_bf16 v[120:135], v[236:239], v[180:183], v[120:135]
v_exp_f16_sdwa v147, v148 dst_sel:WORD_1 dst_unused:UNUSED_PRESERVE src0_sel:WORD_1
v_fmac_f32 v162, v197, v197
v_lshrrev_b32 v141, 18, v141
v_pk_add_f16 v153, v153, 1.0 op_sel_hi:[1,0]
v_lshrrev_b32 v143, 18, v143
v_fmac_f32 v162, v198, v198
v_pk_add_f16 v150, v150, 1.0 op_sel_hi:[1,0]
v_pk_add_f16 v147, v147, 1.0 op_sel_hi:[1,0]
v_fmac_f32_e64 v162, v199, v199
v_and_b32 v145, s49, v145
s_waitcnt lgkmcnt(4)
ds_read_b128 v[236:239], v249 offset:10240
ds_read_u16_d16_hi v141, v141
ds_read_u16_d16_hi v143, v143
v_mfma_f32_32x32x16_bf16 v[120:135], v[216:219], v[184:187], v[120:135]
v_rcp_f16 v154, v153
v_fmac_f32 v162, v200, v200
v_bfe_u32 v144, v145, 2, 14
v_rcp_f16 v151, v150
v_fmac_f32 v162, v201, v201
v_lshrrev_b32 v145, 18, v145
v_rcp_f16 v148, v147
v_fmac_f32_e64 v162, v202, v202
ds_read_u16_d16 v144, v144
ds_read_u16_d16_hi v145, v145
v_or_b32_e64 v56, v136, v137
ds_read_b128 v[216:219], v249 offset:8192
v_mfma_f32_32x32x16_bf16 v[120:135], v[220:223], v[188:191], v[120:135]
s_waitcnt lgkmcnt(6)
v_or_b32 v57, v138, v139
v_fmac_f32_e64 v162, v203, v203
v_rcp_f16_sdwa v154, v153 dst_sel:WORD_1 dst_unused:UNUSED_PRESERVE src0_sel:WORD_1
v_fmac_f32 v162, v204, v204
s_waitcnt lgkmcnt(4)
v_or_b32_e64 v58, v140, v141
v_rcp_f16_sdwa v151, v150 dst_sel:WORD_1 dst_unused:UNUSED_PRESERVE src0_sel:WORD_1
v_fmac_f32 v162, v205, v205
s_waitcnt lgkmcnt(3)
v_or_b32_e64 v59, v142, v143
v_rcp_f16_sdwa v148, v147 dst_sel:WORD_1 dst_unused:UNUSED_PRESERVE src0_sel:WORD_1
v_fmac_f32 v162, v206, v206
s_waitcnt lgkmcnt(1)
v_or_b32_e64 v60, v144, v145
v_pk_mul_f16 v61, v155, v154
v_fmac_f32_e64 v162, v207, v207
v_pk_mul_f16 v62, v152, v151
v_pk_mul_f16 v63, v149, v148
ds_read_b128 v[220:223], v249 offset:11264
v_mfma_f32_32x32x16_f16 v[192:207], v[56:59], v[208:211], 0
v_cvt_pkrtz_f16_f32 v137, v120, v121
v_cvt_pkrtz_f16_f32 v139, v122, v123
v_cvt_pkrtz_f16_f32 v141, v124, v125
v_cvt_pkrtz_f16_f32 v143, v126, v127
v_cvt_pkrtz_f16_f32 v145, v128, v129
v_mfma_f32_32x32x16_f16 v[192:207], v[60:63], v[212:215], v[192:207]
v_cvt_pk_f16_f32 v155, v130, v131
v_cvt_pk_f16_f32 v152, v132, v133
v_cvt_pk_f16_f32 v149, v134, v135
v_pk_fma_f16 v154, v155, v155, s48
v_and_b32_e64 v137, s49, v137
v_pk_fma_f16 v151, v152, v152, s48
v_mfma_f32_32x32x16_bf16 v[120:135], v[224:227], v[168:171], 0
v_and_b32 v139, s49, v139
v_pk_fma_f16 v148, v149, v149, s48
v_permlane16_swap_b32 v56, v60
v_pk_mul_f16 v154, v155, v154
v_bfe_u32 v136, v137, 2, 14
v_permlane16_swap_b32 v57, v61
v_pk_mul_f16 v151, v152, v151
v_pk_mul_f16 v148, v149, v148
v_bfe_u32 v138, v139, 2, 14
v_permlane16_swap_b32 v58, v62
ds_read_b128 v[224:227], v249 offset:12288
ds_read_u16_d16 v136, v136
ds_read_u16_d16 v138, v138
v_mfma_f32_32x32x16_bf16 v[120:135], v[228:231], v[172:175], v[120:135]
v_exp_f16 v153, v154
v_permlane16_swap_b32 v59, v63
v_lshrrev_b32 v137, 18, v137
v_exp_f16 v150, v151
v_fmac_f32 v163, v192, v192
v_lshrrev_b32 v139, 18, v139
v_exp_f16 v147, v148
v_fmac_f32 v163, v193, v193
v_and_b32_e64 v141, s49, v141
ds_read_b128 v[228:231], v249 offset:15360
ds_read_u16_d16_hi v137, v137
ds_read_u16_d16_hi v139, v139
v_mfma_f32_32x32x16_bf16 v[120:135], v[232:235], v[176:179], v[120:135]
v_and_b32 v143, s49, v143
s_setprio 0
v_fmac_f32_e64 v163, v194, v194
v_exp_f16_sdwa v153, v154 dst_sel:WORD_1 dst_unused:UNUSED_PRESERVE src0_sel:WORD_1
v_bfe_u32 v140, v141, 2, 14
v_fmac_f32_e64 v163, v195, v195
v_exp_f16_sdwa v150, v151 dst_sel:WORD_1 dst_unused:UNUSED_PRESERVE src0_sel:WORD_1
v_fmac_f32_e64 v163, v196, v196
v_bfe_u32 v142, v143, 2, 14
ds_read_b128 v[232:235], v249 offset:13312
ds_read_u16_d16 v140, v140
ds_read_u16_d16 v142, v142
v_mfma_f32_32x32x16_bf16 v[120:135], v[236:239], v[180:183], v[120:135]
v_exp_f16_sdwa v147, v148 dst_sel:WORD_1 dst_unused:UNUSED_PRESERVE src0_sel:WORD_1
v_fmac_f32 v163, v197, v197
v_lshrrev_b32 v141, 18, v141
v_pk_add_f16 v153, v153, 1.0 op_sel_hi:[1,0]
v_lshrrev_b32 v143, 18, v143
v_fmac_f32 v163, v198, v198
v_pk_add_f16 v150, v150, 1.0 op_sel_hi:[1,0]
v_pk_add_f16 v147, v147, 1.0 op_sel_hi:[1,0]
v_fmac_f32_e64 v163, v199, v199
v_and_b32 v145, s49, v145
s_waitcnt lgkmcnt(3)
ds_read_b128 v[236:239], v249 offset:16384
ds_read_u16_d16_hi v141, v141
ds_read_u16_d16_hi v143, v143
v_mfma_f32_32x32x16_bf16 v[120:135], v[216:219], v[184:187], v[120:135]
v_rcp_f16 v154, v153
v_fmac_f32 v163, v200, v200
v_bfe_u32 v144, v145, 2, 14
v_rcp_f16 v151, v150
v_fmac_f32 v163, v201, v201
v_lshrrev_b32 v145, 18, v145
v_rcp_f16 v148, v147
v_fmac_f32_e64 v163, v202, v202
ds_read_u16_d16 v144, v144
ds_read_u16_d16_hi v145, v145
v_or_b32_e64 v64, v136, v137
ds_read_b128 v[216:219], v249 offset:14336
v_mfma_f32_32x32x16_bf16 v[120:135], v[220:223], v[188:191], v[120:135]
v_or_b32 v65, v138, v139
v_fmac_f32 v163, v203, v203
v_rcp_f16_sdwa v154, v153 dst_sel:WORD_1 dst_unused:UNUSED_PRESERVE src0_sel:WORD_1
v_fmac_f32 v163, v204, v204
s_waitcnt lgkmcnt(4)
v_or_b32_e64 v66, v140, v141
v_rcp_f16_sdwa v151, v150 dst_sel:WORD_1 dst_unused:UNUSED_PRESERVE src0_sel:WORD_1
v_fmac_f32 v163, v205, v205
s_waitcnt lgkmcnt(3)
v_or_b32_e64 v67, v142, v143
v_rcp_f16_sdwa v148, v147 dst_sel:WORD_1 dst_unused:UNUSED_PRESERVE src0_sel:WORD_1
v_fmac_f32 v163, v206, v206
s_waitcnt lgkmcnt(1)
v_or_b32_e64 v68, v144, v145
v_pk_mul_f16 v69, v155, v154
v_fmac_f32 v163, v207, v207
v_pk_mul_f16 v70, v152, v151
v_pk_mul_f16 v71, v149, v148
s_setprio 2
ds_read_b128 v[220:223], v249 offset:17408
v_mfma_f32_32x32x16_f16 v[192:207], v[64:67], v[208:211], 0
v_cvt_pkrtz_f16_f32 v137, v120, v121
v_cvt_pkrtz_f16_f32 v139, v122, v123
v_cvt_pkrtz_f16_f32 v141, v124, v125
v_cvt_pkrtz_f16_f32 v143, v126, v127
v_cvt_pkrtz_f16_f32 v145, v128, v129
v_mfma_f32_32x32x16_f16 v[192:207], v[68:71], v[212:215], v[192:207]
v_cvt_pk_f16_f32 v155, v130, v131
v_cvt_pk_f16_f32 v152, v132, v133
v_cvt_pk_f16_f32 v149, v134, v135
v_pk_fma_f16 v154, v155, v155, s48
v_and_b32_e64 v137, s49, v137
v_pk_fma_f16 v151, v152, v152, s48
v_mfma_f32_32x32x16_bf16 v[120:135], v[224:227], v[168:171], 0
v_and_b32 v139, s49, v139
v_pk_fma_f16 v148, v149, v149, s48
v_permlane16_swap_b32 v64, v68
v_pk_mul_f16 v154, v155, v154
v_bfe_u32 v136, v137, 2, 14
v_permlane16_swap_b32 v65, v69
v_pk_mul_f16 v151, v152, v151
v_pk_mul_f16 v148, v149, v148
v_bfe_u32 v138, v139, 2, 14
v_permlane16_swap_b32 v66, v70
ds_read_b128 v[224:227], v249 offset:18432
ds_read_u16_d16 v136, v136
ds_read_u16_d16 v138, v138
v_mfma_f32_32x32x16_bf16 v[120:135], v[228:231], v[172:175], v[120:135]
v_exp_f16 v153, v154
v_permlane16_swap_b32 v67, v71
v_lshrrev_b32 v137, 18, v137
v_exp_f16 v150, v151
v_fmac_f32 v164, v192, v192
v_lshrrev_b32 v139, 18, v139
v_exp_f16 v147, v148
v_fmac_f32 v164, v193, v193
v_and_b32_e64 v141, s49, v141
ds_read_b128 v[228:231], v249 offset:21504
ds_read_u16_d16_hi v137, v137
ds_read_u16_d16_hi v139, v139
v_mfma_f32_32x32x16_bf16 v[120:135], v[232:235], v[176:179], v[120:135]
v_and_b32 v143, s49, v143
v_fmac_f32 v164, v194, v194
v_exp_f16_sdwa v153, v154 dst_sel:WORD_1 dst_unused:UNUSED_PRESERVE src0_sel:WORD_1
v_bfe_u32 v140, v141, 2, 14
v_fmac_f32_e64 v164, v195, v195
v_exp_f16_sdwa v150, v151 dst_sel:WORD_1 dst_unused:UNUSED_PRESERVE src0_sel:WORD_1
v_fmac_f32_e64 v164, v196, v196
v_bfe_u32 v142, v143, 2, 14
ds_read_b128 v[232:235], v249 offset:19456
ds_read_u16_d16 v140, v140
ds_read_u16_d16 v142, v142
v_mfma_f32_32x32x16_bf16 v[120:135], v[236:239], v[180:183], v[120:135]
v_exp_f16_sdwa v147, v148 dst_sel:WORD_1 dst_unused:UNUSED_PRESERVE src0_sel:WORD_1
v_fmac_f32 v164, v197, v197
v_lshrrev_b32 v141, 18, v141
v_pk_add_f16 v153, v153, 1.0 op_sel_hi:[1,0]
v_lshrrev_b32 v143, 18, v143
v_fmac_f32 v164, v198, v198
v_pk_add_f16 v150, v150, 1.0 op_sel_hi:[1,0]
v_pk_add_f16 v147, v147, 1.0 op_sel_hi:[1,0]
v_fmac_f32_e64 v164, v199, v199
v_and_b32 v145, s49, v145
s_waitcnt lgkmcnt(4)
ds_read_b128 v[236:239], v249 offset:22528
ds_read_u16_d16_hi v141, v141
ds_read_u16_d16_hi v143, v143
v_mfma_f32_32x32x16_bf16 v[120:135], v[216:219], v[184:187], v[120:135]
v_rcp_f16 v154, v153
v_fmac_f32 v164, v200, v200
v_bfe_u32 v144, v145, 2, 14
v_rcp_f16 v151, v150
v_fmac_f32 v164, v201, v201
v_lshrrev_b32 v145, 18, v145
v_rcp_f16 v148, v147
v_fmac_f32_e64 v164, v202, v202
ds_read_u16_d16 v144, v144
ds_read_u16_d16_hi v145, v145
v_or_b32_e64 v72, v136, v137
ds_read_b128 v[216:219], v249 offset:20480
v_mfma_f32_32x32x16_bf16 v[120:135], v[220:223], v[188:191], v[120:135]
s_waitcnt lgkmcnt(6)
v_or_b32 v73, v138, v139
v_fmac_f32_e64 v164, v203, v203
v_rcp_f16_sdwa v154, v153 dst_sel:WORD_1 dst_unused:UNUSED_PRESERVE src0_sel:WORD_1
v_fmac_f32 v164, v204, v204
s_waitcnt lgkmcnt(4)
v_or_b32_e64 v74, v140, v141
v_rcp_f16_sdwa v151, v150 dst_sel:WORD_1 dst_unused:UNUSED_PRESERVE src0_sel:WORD_1
v_fmac_f32 v164, v205, v205
s_waitcnt lgkmcnt(3)
v_or_b32_e64 v75, v142, v143
v_rcp_f16_sdwa v148, v147 dst_sel:WORD_1 dst_unused:UNUSED_PRESERVE src0_sel:WORD_1
v_fmac_f32 v164, v206, v206
s_waitcnt lgkmcnt(1)
v_or_b32_e64 v76, v144, v145
v_pk_mul_f16 v77, v155, v154
v_fmac_f32_e64 v164, v207, v207
v_pk_mul_f16 v78, v152, v151
v_pk_mul_f16 v79, v149, v148
ds_read_b128 v[220:223], v249 offset:23552
v_mfma_f32_32x32x16_f16 v[192:207], v[72:75], v[208:211], 0
v_cvt_pkrtz_f16_f32 v137, v120, v121
v_cvt_pkrtz_f16_f32 v139, v122, v123
v_cvt_pkrtz_f16_f32 v141, v124, v125
v_cvt_pkrtz_f16_f32 v143, v126, v127
v_cvt_pkrtz_f16_f32 v145, v128, v129
v_mfma_f32_32x32x16_f16 v[192:207], v[76:79], v[212:215], v[192:207]
v_cvt_pk_f16_f32 v155, v130, v131
v_cvt_pk_f16_f32 v152, v132, v133
v_cvt_pk_f16_f32 v149, v134, v135
v_pk_fma_f16 v154, v155, v155, s48
v_and_b32_e64 v137, s49, v137
v_pk_fma_f16 v151, v152, v152, s48
v_mfma_f32_32x32x16_bf16 v[120:135], v[224:227], v[168:171], 0
v_and_b32 v139, s49, v139
v_pk_fma_f16 v148, v149, v149, s48
v_permlane16_swap_b32 v72, v76
v_pk_mul_f16 v154, v155, v154
v_bfe_u32 v136, v137, 2, 14
v_permlane16_swap_b32 v73, v77
v_pk_mul_f16 v151, v152, v151
v_pk_mul_f16 v148, v149, v148
v_bfe_u32 v138, v139, 2, 14
v_permlane16_swap_b32 v74, v78
ds_read_u16_d16 v136, v136
ds_read_u16_d16 v138, v138
v_mfma_f32_32x32x16_bf16 v[120:135], v[228:231], v[172:175], v[120:135]
v_exp_f16 v153, v154
v_permlane16_swap_b32 v75, v79
v_lshrrev_b32 v137, 18, v137
v_exp_f16 v150, v151
v_fmac_f32 v165, v192, v192
v_lshrrev_b32 v139, 18, v139
v_exp_f16 v147, v148
v_fmac_f32 v165, v193, v193
v_and_b32_e64 v141, s49, v141
ds_read_u16_d16_hi v137, v137
ds_read_u16_d16_hi v139, v139
v_mfma_f32_32x32x16_bf16 v[120:135], v[232:235], v[176:179], v[120:135]
v_and_b32 v143, s49, v143
v_fmac_f32 v165, v194, v194
v_exp_f16_sdwa v153, v154 dst_sel:WORD_1 dst_unused:UNUSED_PRESERVE src0_sel:WORD_1
v_bfe_u32 v140, v141, 2, 14
v_fmac_f32_e64 v165, v195, v195
v_exp_f16_sdwa v150, v151 dst_sel:WORD_1 dst_unused:UNUSED_PRESERVE src0_sel:WORD_1
v_fmac_f32_e64 v165, v196, v196
v_bfe_u32 v142, v143, 2, 14
ds_read_u16_d16 v140, v140
ds_read_u16_d16 v142, v142
v_mfma_f32_32x32x16_bf16 v[120:135], v[236:239], v[180:183], v[120:135]
v_exp_f16_sdwa v147, v148 dst_sel:WORD_1 dst_unused:UNUSED_PRESERVE src0_sel:WORD_1
v_fmac_f32 v165, v197, v197
v_lshrrev_b32 v141, 18, v141
v_pk_add_f16 v153, v153, 1.0 op_sel_hi:[1,0]
v_lshrrev_b32 v143, 18, v143
v_fmac_f32 v165, v198, v198
v_pk_add_f16 v150, v150, 1.0 op_sel_hi:[1,0]
v_pk_add_f16 v147, v147, 1.0 op_sel_hi:[1,0]
v_fmac_f32_e64 v165, v199, v199
v_and_b32 v145, s49, v145
s_waitcnt lgkmcnt(4)
ds_read_u16_d16_hi v141, v141
ds_read_u16_d16_hi v143, v143
v_mfma_f32_32x32x16_bf16 v[120:135], v[216:219], v[184:187], v[120:135]
v_rcp_f16 v154, v153
v_fmac_f32 v165, v200, v200
v_bfe_u32 v144, v145, 2, 14
v_rcp_f16 v151, v150
v_fmac_f32 v165, v201, v201
v_lshrrev_b32 v145, 18, v145
v_rcp_f16 v148, v147
v_fmac_f32_e64 v165, v202, v202
ds_read_u16_d16 v144, v144
ds_read_u16_d16_hi v145, v145
s_waitcnt lgkmcnt(4)
v_or_b32 v80, v136, v137
v_mfma_f32_32x32x16_bf16 v[120:135], v[220:223], v[188:191], v[120:135]
v_or_b32 v81, v138, v139
v_fmac_f32 v165, v203, v203
v_rcp_f16_sdwa v154, v153 dst_sel:WORD_1 dst_unused:UNUSED_PRESERVE src0_sel:WORD_1
v_fmac_f32 v165, v204, v204
s_waitcnt lgkmcnt(3)
v_or_b32_e64 v82, v140, v141
v_rcp_f16_sdwa v151, v150 dst_sel:WORD_1 dst_unused:UNUSED_PRESERVE src0_sel:WORD_1
v_fmac_f32 v165, v205, v205
s_waitcnt lgkmcnt(2)
v_or_b32_e64 v83, v142, v143
v_rcp_f16_sdwa v148, v147 dst_sel:WORD_1 dst_unused:UNUSED_PRESERVE src0_sel:WORD_1
v_fmac_f32 v165, v206, v206
s_waitcnt lgkmcnt(0)
v_or_b32_e64 v84, v144, v145
v_pk_mul_f16 v85, v155, v154
v_fmac_f32 v165, v207, v207
v_pk_mul_f16 v86, v152, v151
v_pk_mul_f16 v87, v149, v148
s_setprio 1
v_mfma_f32_32x32x16_f16 v[192:207], v[80:83], v[208:211], 0
v_mfma_f32_32x32x16_f16 v[192:207], v[84:87], v[212:215], v[192:207]
v_cvt_pkrtz_f16_f32 v137, v120, v121
v_cvt_pkrtz_f16_f32 v139, v122, v123
v_cvt_pkrtz_f16_f32 v141, v124, v125
v_cvt_pkrtz_f16_f32 v143, v126, v127
v_cvt_pkrtz_f16_f32 v145, v128, v129
v_cvt_pk_f16_f32 v155, v130, v131
v_cvt_pk_f16_f32 v152, v132, v133
v_cvt_pk_f16_f32 v149, v134, v135
v_pk_fma_f16 v154, v155, v155, s48
v_and_b32_e64 v137, s49, v137
v_pk_fma_f16 v151, v152, v152, s48
v_and_b32_e64 v139, s49, v139
v_pk_fma_f16 v148, v149, v149, s48
v_permlane16_swap_b32 v80, v84
v_pk_mul_f16 v154, v155, v154
v_bfe_u32 v136, v137, 2, 14
v_permlane16_swap_b32 v81, v85
v_pk_mul_f16 v151, v152, v151
v_pk_mul_f16 v148, v149, v148
v_bfe_u32 v138, v139, 2, 14
v_permlane16_swap_b32 v82, v86
v_exp_f16 v153, v154
v_permlane16_swap_b32 v83, v87
v_lshrrev_b32 v137, 18, v137
v_exp_f16 v150, v151
v_fmac_f32 v166, v192, v192
v_lshrrev_b32 v139, 18, v139
v_exp_f16 v147, v148
v_fmac_f32 v166, v193, v193
v_and_b32 v141, s49, v141
v_and_b32_e64 v143, s49, v143
ds_read_u16_d16 v136, v136
ds_read_u16_d16 v138, v138
ds_read_u16_d16_hi v137, v137
ds_read_u16_d16_hi v139, v139
v_fmac_f32_e64 v166, v194, v194
v_exp_f16_sdwa v153, v154 dst_sel:WORD_1 dst_unused:UNUSED_PRESERVE src0_sel:WORD_1
v_bfe_u32 v140, v141, 2, 14
v_fmac_f32_e64 v166, v195, v195
v_exp_f16_sdwa v150, v151 dst_sel:WORD_1 dst_unused:UNUSED_PRESERVE src0_sel:WORD_1
v_fmac_f32_e64 v166, v196, v196
v_bfe_u32 v142, v143, 2, 14
v_exp_f16_sdwa v147, v148 dst_sel:WORD_1 dst_unused:UNUSED_PRESERVE src0_sel:WORD_1
v_fmac_f32 v166, v197, v197
v_lshrrev_b32 v141, 18, v141
v_pk_add_f16 v153, v153, 1.0 op_sel_hi:[1,0]
v_lshrrev_b32 v143, 18, v143
v_fmac_f32 v166, v198, v198
v_pk_add_f16 v150, v150, 1.0 op_sel_hi:[1,0]
v_pk_add_f16 v147, v147, 1.0 op_sel_hi:[1,0]
v_fmac_f32 v166, v199, v199
v_and_b32 v145, s49, v145
v_rcp_f16 v154, v153
v_fmac_f32 v166, v200, v200
v_bfe_u32 v144, v145, 2, 14
v_rcp_f16 v151, v150
v_fmac_f32 v166, v201, v201
v_lshrrev_b32_e64 v145, 18, v145
ds_read_u16_d16 v140, v140
ds_read_u16_d16 v142, v142
ds_read_u16_d16_hi v141, v141
ds_read_u16_d16_hi v143, v143
ds_read_u16_d16 v144, v144
ds_read_u16_d16_hi v145, v145
v_rcp_f16 v148, v147
v_fmac_f32 v166, v202, v202
s_waitcnt lgkmcnt(6)
v_or_b32 v88, v136, v137
v_or_b32 v89, v138, v139
v_fmac_f32 v166, v203, v203
v_rcp_f16_sdwa v154, v153 dst_sel:WORD_1 dst_unused:UNUSED_PRESERVE src0_sel:WORD_1
v_fmac_f32 v166, v204, v204
s_waitcnt lgkmcnt(3)
v_or_b32_e64 v90, v140, v141
v_rcp_f16_sdwa v151, v150 dst_sel:WORD_1 dst_unused:UNUSED_PRESERVE src0_sel:WORD_1
v_fmac_f32 v166, v205, v205
s_waitcnt lgkmcnt(2)
v_or_b32_e64 v91, v142, v143
v_rcp_f16_sdwa v148, v147 dst_sel:WORD_1 dst_unused:UNUSED_PRESERVE src0_sel:WORD_1
v_fmac_f32 v166, v206, v206
s_waitcnt lgkmcnt(0)
v_or_b32_e64 v92, v144, v145
v_pk_mul_f16 v93, v155, v154
v_fmac_f32_e64 v166, v207, v207
v_pk_mul_f16 v94, v152, v151
v_pk_mul_f16 v95, v149, v148
v_mfma_f32_32x32x16_f16 v[192:207], v[88:91], v[208:211], 0
s_nop 0
v_mfma_f32_32x32x16_f16 v[192:207], v[92:95], v[212:215], v[192:207]
v_permlane16_swap_b32 v88, v92
v_permlane16_swap_b32 v89, v93
v_permlane16_swap_b32 v90, v94
v_permlane16_swap_b32 v91, v95
s_nop 7
v_fmac_f32 v167, v192, v192
v_fmac_f32 v167, v193, v193
v_fmac_f32 v167, v194, v194
v_fmac_f32 v167, v195, v195
s_setprio 0
v_fmac_f32 v167, v196, v196
v_fmac_f32 v167, v197, v197
v_fmac_f32 v167, v198, v198
v_fmac_f32 v167, v199, v199
v_fmac_f32 v167, v200, v200
v_fmac_f32 v167, v201, v201
v_fmac_f32 v167, v202, v202
v_fmac_f32 v167, v203, v203
v_fmac_f32 v167, v204, v204
v_fmac_f32 v167, v205, v205
v_fmac_f32 v167, v206, v206
v_fmac_f32 v167, v207, v207
s_setprio 3
v_and_b32_e64 v136, 51, v251
v_bfe_u32 v137, v251, 2, 1
v_lshl_add_u32 v136, v137, 3, v136
v_bfe_u32 v137, v251, 3, 1
v_lshl_add_u32 v136, v137, 2, v136
v_lshl_add_u32 v136, v136, 2, s72
v_permlane32_swap_b32 v156, v157
v_add_f32 v156, v156, v157
ds_write_b32 v136, v156 offset:7168
v_permlane32_swap_b32 v158, v159
v_add_f32 v158, v158, v159
ds_write_b32 v136, v158 offset:7424
v_permlane32_swap_b32 v160, v161
v_add_f32 v160, v160, v161
ds_write_b32 v136, v160 offset:7680
v_permlane32_swap_b32 v162, v163
v_add_f32 v162, v162, v163
ds_write_b32 v136, v162 offset:7936
v_permlane32_swap_b32 v164, v165
v_add_f32 v164, v164, v165
ds_write_b32 v136, v164 offset:8192
v_permlane32_swap_b32 v166, v167
v_add_f32 v166, v166, v167
ds_write_b32 v136, v166 offset:8448
v_mov_b32 v128, 16256
v_mov_b32_e64 v129, 1
s_waitcnt lgkmcnt(0)
s_mov_b64 exec, 1
ds_add_rtn_u32 v130, v128, v129
s_mov_b64 exec, -1
s_waitcnt lgkmcnt(0)
v_readfirstlane_b32 s43, v130
s_nop 1
s_cmp_lg_u32 s43, 7
s_cbranch_scc1 Lnopub
v_min_u32 v131, 47, v251
v_lshlrev_b32 v132, 5, v131
v_add_u32 v132, 97280, v132
ds_read_b128 v[168:171], v132
ds_read_b128 v[172:175], v132 offset:16
ds_read_b128 v[176:179], v132 offset:9216
ds_read_b128 v[180:183], v132 offset:9232
ds_read_b128 v[184:187], v132 offset:18432
ds_read_b128 v[188:191], v132 offset:18448
ds_read_b128 v[192:195], v132 offset:27648
ds_read_b128 v[196:199], v132 offset:27664
ds_read_b128 v[200:203], v132 offset:36864
ds_read_b128 v[204:207], v132 offset:36880
ds_read_b128 v[208:211], v132 offset:46080
ds_read_b128 v[212:215], v132 offset:46096
ds_read_b128 v[216:219], v132 offset:55296
ds_read_b128 v[220:223], v132 offset:55312
ds_read_b128 v[120:123], v132 offset:64512
ds_read_b128 v[124:127], v132 offset:64528
v_lshlrev_b32_e64 v134, 13, v131
v_add_u32 v135, 4096, v134
s_waitcnt lgkmcnt(13)
v_add_f32 v168, v168, v176
v_add_f32 v169, v169, v177
v_add_f32 v170, v170, v178
v_add_f32 v171, v171, v179
s_waitcnt lgkmcnt(12)
v_add_f32 v172, v172, v180
v_add_f32 v173, v173, v181
v_add_f32 v174, v174, v182
v_add_f32 v175, v175, v183
s_waitcnt lgkmcnt(9)
v_add_f32 v184, v184, v192
v_add_f32 v185, v185, v193
v_add_f32 v186, v186, v194
v_add_f32 v187, v187, v195
s_waitcnt lgkmcnt(8)
v_add_f32 v188, v188, v196
v_add_f32 v189, v189, v197
v_add_f32 v190, v190, v198
v_add_f32 v191, v191, v199
s_waitcnt lgkmcnt(5)
v_add_f32 v200, v200, v208
v_add_f32 v201, v201, v209
v_add_f32 v202, v202, v210
v_add_f32 v203, v203, v211
s_waitcnt lgkmcnt(4)
v_add_f32 v204, v204, v212
v_add_f32 v205, v205, v213
v_add_f32 v206, v206, v214
v_add_f32 v207, v207, v215
s_waitcnt lgkmcnt(1)
v_add_f32 v216, v216, v120
v_add_f32 v217, v217, v121
v_add_f32 v218, v218, v122
v_add_f32 v219, v219, v123
s_waitcnt lgkmcnt(0)
v_add_f32 v220, v220, v124
v_add_f32 v221, v221, v125
v_add_f32 v222, v222, v126
v_add_f32 v223, v223, v127
v_add_f32 v168, v168, v184
v_add_f32 v169, v169, v185
v_add_f32 v170, v170, v186
v_add_f32 v171, v171, v187
v_add_f32 v172, v172, v188
v_add_f32 v173, v173, v189
v_add_f32 v174, v174, v190
v_add_f32 v175, v175, v191
v_add_f32 v200, v200, v216
v_add_f32 v201, v201, v217
v_add_f32 v202, v202, v218
v_add_f32 v203, v203, v219
v_add_f32 v204, v204, v220
v_add_f32 v205, v205, v221
v_add_f32 v206, v206, v222
v_add_f32 v207, v207, v223
v_add_f32 v168, v168, v200
v_add_f32 v169, v169, v201
v_add_f32 v170, v170, v202
v_add_f32 v171, v171, v203
v_add_f32 v172, v172, v204
v_add_f32 v173, v173, v205
v_add_f32 v174, v174, v206
v_add_f32 v175, v175, v207
v_min_u32 v176, -2, v168
v_min_u32 v177, -2, v169
v_min_u32 v178, -2, v170
v_min_u32 v179, -2, v171
v_min_u32 v180, -2, v172
v_min_u32 v181, -2, v173
v_min_u32_e64 v182, -2, v174
v_min_u32 v183, -2, v175
s_lshl_b32 s43, s2, 4
buffer_store_dwordx4 v[176:179], v134, s[32:35], s43 offen sc1
buffer_store_dwordx4 v[180:183], v135, s[32:35], s43 offen sc1
ds_write_b32 v128, v129 offset:4
s_waitcnt lgkmcnt(0)
s_nop 1
Lnopub:
v_mov_b32 v252, v240
s_mov_b32 s77, 0
s_cmp_lg_u32 s40, 0
s_cbranch_scc1 Lnorole
v_lshlrev_b32_e64 v255, 2, v251
buffer_load_dword v244, v255, s[24:27], 0 offen
buffer_load_dword v245, v255, s[24:27], 0 offen offset:256
buffer_load_dword v246, v255, s[24:27], 0 offen offset:512
v_mov_b32 v162, 0
s_waitcnt vmcnt(0) lgkmcnt(0)
s_nop 4
Lpi:
buffer_load_dword v163, v162, s[36:39], 0 offen sc1
s_waitcnt vmcnt(0)
v_readfirstlane_b32 s43, v163
s_cmp_eq_u32 s76, 0
s_cbranch_scc1 Lpix
s_sub_u32 s76, s76, 1
s_cmp_lt_u32 s43, 256
s_waitcnt vmcnt(0) lgkmcnt(0)
s_nop 4
s_cbranch_scc1 Lpi
s_waitcnt vmcnt(0) lgkmcnt(0)
s_nop 4
Lpix:
v_min_u32 v247, 47, v251
v_lshlrev_b32_e64 v247, 3, v247
s_and_b32 s44, s2, 7
s_lshl_b32 s44, s44, 11
s_add_u32 s44, s44, 394752
buffer_load_dwordx2 v[166:167], v247, s[32:35], s44 offen sc1
v_add_u32 v255, 7936, v247
v_add_u32 v247, 15872, v247
v_cmp_gt_u32 vcc, 32, v251
s_nop 1
v_cndmask_b32 v247, v247, v255, vcc
s_waitcnt vmcnt(0)
ds_write_b64 v247, v[166:167]
s_waitcnt lgkmcnt(0)
s_cmp_lt_u32 s2, 96
s_cselect_b32 s77, 1, 2
v_mov_b32 v156, -1
v_mov_b32 v157, -1
v_mov_b32 v158, -1
v_mov_b32 v159, -1
v_mov_b32 v160, -1
v_mov_b32 v161, -1
v_mov_b32 v162, -1
v_mov_b32 v163, -1
v_mov_b32 v164, -1
v_mov_b32 v165, -1
v_mov_b32 v166, -1
v_mov_b32 v167, -1
v_mov_b32 v240, -1
v_mov_b32 v241, -1
v_mov_b32 v242, -1
v_mov_b32 v243, -1
s_call_b64 s[78:79], Lpoll
Lnorole:
s_setprio 0
ds_read_b128 v[224:227], v248 offset:47104
ds_read_b128 v[228:231], v248 offset:50176
ds_read_b128 v[232:235], v248 offset:48128
ds_read_b128 v[236:239], v248 offset:51200
s_setprio 2
s_waitcnt lgkmcnt(3)
v_mfma_f32_32x32x16_bf16 v[120:135], v[224:227], v[96:99], 0
s_waitcnt lgkmcnt(2)
ds_read_b128 v[224:227], v248 offset:49152
v_mfma_f32_32x32x16_bf16 v[120:135], v[228:231], v[100:103], v[120:135]
s_waitcnt lgkmcnt(2)
ds_read_b128 v[228:231], v248 offset:52224
v_mfma_f32_32x32x16_bf16 v[120:135], v[232:235], v[104:107], v[120:135]
s_waitcnt lgkmcnt(2)
ds_read_b128 v[232:235], v248 offset:53248
v_mfma_f32_32x32x16_bf16 v[120:135], v[236:239], v[108:111], v[120:135]
s_waitcnt lgkmcnt(2)
ds_read_b128 v[236:239], v248 offset:56320
v_mfma_f32_32x32x16_bf16 v[120:135], v[224:227], v[112:115], v[120:135]
s_waitcnt lgkmcnt(2)
ds_read_b128 v[224:227], v248 offset:54272
v_mfma_f32_32x32x16_bf16 v[120:135], v[228:231], v[116:119], v[120:135]
s_cmp_eq_u32 s77, 0
s_cbranch_scc1 Lpp0
s_call_b64 s[78:79], Lpoll
s_setprio 2
Lpp0:
s_nop 9
v_cvt_pkrtz_f16_f32 v137, v120, v121
v_cvt_pkrtz_f16_f32 v139, v122, v123
v_cvt_pkrtz_f16_f32 v141, v124, v125
v_cvt_pkrtz_f16_f32 v143, v126, v127
v_cvt_pkrtz_f16_f32 v145, v128, v129
v_cvt_pk_f16_f32 v155, v130, v131
v_cvt_pk_f16_f32 v152, v132, v133
v_cvt_pk_f16_f32 v149, v134, v135
s_waitcnt lgkmcnt(1)
ds_read_b128 v[228:231], v248 offset:57344
v_mfma_f32_32x32x16_bf16 v[120:135], v[232:235], v[96:99], 0
v_pk_fma_f16 v154, v155, v155, s48
v_and_b32 v137, s49, v137
v_pk_fma_f16 v151, v152, v152, s48
v_and_b32_e64 v139, s49, v139
v_pk_fma_f16 v148, v149, v149, s48
v_pk_mul_f16 v154, v155, v154
v_bfe_u32 v136, v137, 2, 14
v_pk_mul_f16 v151, v152, v151
ds_read_b128 v[232:235], v248 offset:55296
ds_read_u16_d16 v136, v136
v_mfma_f32_32x32x16_bf16 v[120:135], v[236:239], v[100:103], v[120:135]
v_pk_mul_f16 v148, v149, v148
v_bfe_u32 v138, v139, 2, 14
v_exp_f16 v153, v154
v_lshrrev_b32 v137, 18, v137
v_exp_f16 v150, v151
s_setprio 1
v_lshrrev_b32 v139, 18, v139
s_waitcnt lgkmcnt(3)
ds_read_b128 v[236:239], v248 offset:58368
ds_read_u16_d16 v138, v138
ds_read_u16_d16_hi v137, v137
ds_read_u16_d16_hi v139, v139
v_mfma_f32_32x32x16_bf16 v[120:135], v[224:227], v[104:107], v[120:135]
v_exp_f16 v147, v148
v_and_b32 v141, s49, v141
v_and_b32 v143, s49, v143
v_exp_f16_sdwa v153, v154 dst_sel:WORD_1 dst_unused:UNUSED_PRESERVE src0_sel:WORD_1
v_bfe_u32 v140, v141, 2, 14
v_exp_f16_sdwa v150, v151 dst_sel:WORD_1 dst_unused:UNUSED_PRESERVE src0_sel:WORD_1
s_waitcnt lgkmcnt(6)
ds_read_b128 v[224:227], v248 offset:59392
ds_read_u16_d16 v140, v140
v_mfma_f32_32x32x16_bf16 v[120:135], v[228:231], v[108:111], v[120:135]
v_bfe_u32 v142, v143, 2, 14
v_exp_f16_sdwa v147, v148 dst_sel:WORD_1 dst_unused:UNUSED_PRESERVE src0_sel:WORD_1
v_lshrrev_b32_e64 v141, 18, v141
v_pk_add_f16 v153, v153, 1.0 op_sel_hi:[1,0]
v_lshrrev_b32 v143, 18, v143
v_pk_add_f16 v150, v150, 1.0 op_sel_hi:[1,0]
v_pk_add_f16 v147, v147, 1.0 op_sel_hi:[1,0]
s_waitcnt lgkmcnt(6)
ds_read_b128 v[228:231], v248 offset:62464
ds_read_u16_d16 v142, v142
ds_read_u16_d16_hi v141, v141
ds_read_u16_d16_hi v143, v143
v_mfma_f32_32x32x16_bf16 v[120:135], v[232:235], v[112:115], v[120:135]
v_and_b32 v145, s49, v145
v_rcp_f16 v154, v153
v_bfe_u32 v144, v145, 2, 14
v_rcp_f16_e64 v151, v150
v_lshrrev_b32 v145, 18, v145
s_waitcnt lgkmcnt(6)
ds_read_b128 v[232:235], v248 offset:60416
ds_read_u16_d16 v144, v144
ds_read_u16_d16_hi v145, v145
v_mfma_f32_32x32x16_bf16 v[120:135], v[236:239], v[116:119], v[120:135]
v_rcp_f16 v148, v147
v_or_b32 v168, v136, v137
v_or_b32_e64 v169, v138, v139
v_rcp_f16_sdwa v154, v153 dst_sel:WORD_1 dst_unused:UNUSED_PRESERVE src0_sel:WORD_1
s_waitcnt lgkmcnt(4)
v_or_b32 v170, v140, v141
v_rcp_f16_sdwa v151, v150 dst_sel:WORD_1 dst_unused:UNUSED_PRESERVE src0_sel:WORD_1
s_waitcnt lgkmcnt(3)
v_or_b32 v171, v142, v143
v_rcp_f16_sdwa v148, v147 dst_sel:WORD_1 dst_unused:UNUSED_PRESERVE src0_sel:WORD_1
s_waitcnt lgkmcnt(0)
v_or_b32 v172, v144, v145
v_pk_mul_f16 v173, v155, v154
v_pk_mul_f16 v174, v152, v151
v_pk_mul_f16 v175, v149, v148
s_cmp_eq_u32 s77, 0
s_cbranch_scc1 Lpp1
s_call_b64 s[78:79], Lpoll
s_setprio 1
Lpp1:
v_cvt_pkrtz_f16_f32 v137, v120, v121
v_cvt_pkrtz_f16_f32 v139, v122, v123
v_cvt_pkrtz_f16_f32 v141, v124, v125
v_cvt_pkrtz_f16_f32 v143, v126, v127
v_cvt_pkrtz_f16_f32 v145, v128, v129
v_cvt_pk_f16_f32 v155, v130, v131
v_cvt_pk_f16_f32 v152, v132, v133
v_cvt_pk_f16_f32 v149, v134, v135
ds_read_b128 v[236:239], v248 offset:63488
v_mfma_f32_32x32x16_bf16 v[120:135], v[224:227], v[96:99], 0
v_pk_fma_f16 v154, v155, v155, s48
v_permlane16_swap_b32 v168, v172
v_and_b32 v137, s49, v137
v_pk_fma_f16 v151, v152, v152, s48
v_and_b32_e64 v139, s49, v139
v_pk_fma_f16 v148, v149, v149, s48
v_pk_mul_f16 v154, v155, v154
v_bfe_u32 v136, v137, 2, 14
v_pk_mul_f16 v151, v152, v151
ds_read_b128 v[224:227], v248 offset:61440
ds_read_u16_d16 v136, v136
v_mfma_f32_32x32x16_bf16 v[120:135], v[228:231], v[100:103], v[120:135]
v_pk_mul_f16 v148, v149, v148
v_bfe_u32 v138, v139, 2, 14
v_exp_f16 v153, v154
v_lshrrev_b32 v137, 18, v137
v_exp_f16 v150, v151
v_permlane16_swap_b32 v169, v173
v_lshrrev_b32_e64 v139, 18, v139
ds_read_b128 v[228:231], v248 offset:64512
ds_read_u16_d16 v138, v138
ds_read_u16_d16_hi v137, v137
ds_read_u16_d16_hi v139, v139
v_mfma_f32_32x32x16_bf16 v[120:135], v[232:235], v[104:107], v[120:135]
v_exp_f16 v147, v148
s_setprio 0
v_and_b32_e64 v141, s49, v141
v_and_b32 v143, s49, v143
v_exp_f16_sdwa v153, v154 dst_sel:WORD_1 dst_unused:UNUSED_PRESERVE src0_sel:WORD_1
v_bfe_u32 v140, v141, 2, 14
v_exp_f16_sdwa v150, v151 dst_sel:WORD_1 dst_unused:UNUSED_PRESERVE src0_sel:WORD_1
s_waitcnt lgkmcnt(6)
ds_read_b128 v[232:235], v249
ds_read_u16_d16 v140, v140
v_mfma_f32_32x32x16_bf16 v[120:135], v[236:239], v[108:111], v[120:135]
v_bfe_u32 v142, v143, 2, 14
v_exp_f16_sdwa v147, v148 dst_sel:WORD_1 dst_unused:UNUSED_PRESERVE src0_sel:WORD_1
v_lshrrev_b32 v141, 18, v141
v_permlane16_swap_b32 v170, v174
v_pk_add_f16 v153, v153, 1.0 op_sel_hi:[1,0]
v_lshrrev_b32 v143, 18, v143
v_pk_add_f16 v150, v150, 1.0 op_sel_hi:[1,0]
v_pk_add_f16 v147, v147, 1.0 op_sel_hi:[1,0]
s_waitcnt lgkmcnt(6)
ds_read_b128 v[236:239], v249 offset:3072
ds_read_u16_d16 v142, v142
ds_read_u16_d16_hi v141, v141
ds_read_u16_d16_hi v143, v143
v_mfma_f32_32x32x16_bf16 v[120:135], v[224:227], v[112:115], v[120:135]
v_and_b32 v145, s49, v145
v_rcp_f16 v154, v153
v_bfe_u32 v144, v145, 2, 14
v_rcp_f16 v151, v150
v_lshrrev_b32 v145, 18, v145
v_rcp_f16 v148, v147
s_waitcnt lgkmcnt(6)
ds_read_b128 v[224:227], v249 offset:1024
ds_read_u16_d16 v144, v144
ds_read_u16_d16_hi v145, v145
v_mfma_f32_32x32x16_bf16 v[120:135], v[228:231], v[116:119], v[120:135]
v_or_b32 v176, v136, v137
v_permlane16_swap_b32 v171, v175
v_or_b32_e64 v177, v138, v139
v_rcp_f16_sdwa v154, v153 dst_sel:WORD_1 dst_unused:UNUSED_PRESERVE src0_sel:WORD_1
s_waitcnt lgkmcnt(4)
v_or_b32 v178, v140, v141
v_rcp_f16_sdwa v151, v150 dst_sel:WORD_1 dst_unused:UNUSED_PRESERVE src0_sel:WORD_1
s_waitcnt lgkmcnt(3)
v_or_b32 v179, v142, v143
v_rcp_f16_sdwa v148, v147 dst_sel:WORD_1 dst_unused:UNUSED_PRESERVE src0_sel:WORD_1
s_waitcnt lgkmcnt(0)
v_or_b32_e64 v180, v144, v145
v_pk_mul_f16 v181, v155, v154
v_pk_mul_f16 v182, v152, v151
v_pk_mul_f16 v183, v149, v148
s_cmp_eq_u32 s77, 0
s_cbranch_scc1 Lpp2
s_call_b64 s[78:79], Lpoll
s_setprio 0
Lpp2:
s_setprio 2
v_cvt_pkrtz_f16_f32 v137, v120, v121
v_cvt_pkrtz_f16_f32 v139, v122, v123
v_cvt_pkrtz_f16_f32 v141, v124, v125
v_cvt_pkrtz_f16_f32 v143, v126, v127
v_cvt_pkrtz_f16_f32 v145, v128, v129
v_cvt_pk_f16_f32 v155, v130, v131
v_cvt_pk_f16_f32 v152, v132, v133
v_cvt_pk_f16_f32 v149, v134, v135
ds_read_b128 v[228:231], v249 offset:4096
v_mfma_f32_32x32x16_bf16 v[120:135], v[232:235], v[96:99], 0
v_pk_fma_f16 v154, v155, v155, s48
v_permlane16_swap_b32 v176, v180
v_and_b32 v137, s49, v137
v_pk_fma_f16 v151, v152, v152, s48
v_and_b32_e64 v139, s49, v139
v_pk_fma_f16 v148, v149, v149, s48
v_pk_mul_f16 v154, v155, v154
v_bfe_u32 v136, v137, 2, 14
v_pk_mul_f16 v151, v152, v151
ds_read_b128 v[232:235], v249 offset:2048
ds_read_u16_d16 v136, v136
v_mfma_f32_32x32x16_bf16 v[120:135], v[236:239], v[100:103], v[120:135]
v_pk_mul_f16 v148, v149, v148
v_bfe_u32 v138, v139, 2, 14
v_exp_f16 v153, v154
v_lshrrev_b32 v137, 18, v137
v_exp_f16 v150, v151
v_permlane16_swap_b32 v177, v181
v_lshrrev_b32_e64 v139, 18, v139
ds_read_b128 v[236:239], v249 offset:5120
ds_read_u16_d16 v138, v138
ds_read_u16_d16_hi v137, v137
ds_read_u16_d16_hi v139, v139
v_mfma_f32_32x32x16_bf16 v[120:135], v[224:227], v[104:107], v[120:135]
v_exp_f16 v147, v148
v_and_b32 v141, s49, v141
v_and_b32 v143, s49, v143
v_exp_f16_sdwa v153, v154 dst_sel:WORD_1 dst_unused:UNUSED_PRESERVE src0_sel:WORD_1
v_bfe_u32 v140, v141, 2, 14
v_exp_f16_sdwa v150, v151 dst_sel:WORD_1 dst_unused:UNUSED_PRESERVE src0_sel:WORD_1
s_waitcnt lgkmcnt(6)
ds_read_b128 v[224:227], v249 offset:6144
ds_read_u16_d16 v140, v140
v_mfma_f32_32x32x16_bf16 v[120:135], v[228:231], v[108:111], v[120:135]
v_bfe_u32 v142, v143, 2, 14
v_exp_f16_sdwa v147, v148 dst_sel:WORD_1 dst_unused:UNUSED_PRESERVE src0_sel:WORD_1
v_lshrrev_b32 v141, 18, v141
v_permlane16_swap_b32 v178, v182
v_pk_add_f16 v153, v153, 1.0 op_sel_hi:[1,0]
v_lshrrev_b32 v143, 18, v143
v_pk_add_f16 v150, v150, 1.0 op_sel_hi:[1,0]
v_pk_add_f16 v147, v147, 1.0 op_sel_hi:[1,0]
s_waitcnt lgkmcnt(6)
ds_read_b128 v[228:231], v249 offset:9216
ds_read_u16_d16 v142, v142
ds_read_u16_d16_hi v141, v141
ds_read_u16_d16_hi v143, v143
v_mfma_f32_32x32x16_bf16 v[120:135], v[232:235], v[112:115], v[120:135]
v_and_b32 v145, s49, v145
v_rcp_f16 v154, v153
v_bfe_u32 v144, v145, 2, 14
v_rcp_f16 v151, v150
v_lshrrev_b32 v145, 18, v145
v_rcp_f16 v148, v147
s_waitcnt lgkmcnt(6)
ds_read_b128 v[232:235], v249 offset:7168
ds_read_u16_d16 v144, v144
ds_read_u16_d16_hi v145, v145
v_mfma_f32_32x32x16_bf16 v[120:135], v[236:239], v[116:119], v[120:135]
v_or_b32 v184, v136, v137
v_permlane16_swap_b32 v179, v183
v_or_b32_e64 v185, v138, v139
v_rcp_f16_sdwa v154, v153 dst_sel:WORD_1 dst_unused:UNUSED_PRESERVE src0_sel:WORD_1
s_waitcnt lgkmcnt(4)
v_or_b32 v186, v140, v141
v_rcp_f16_sdwa v151, v150 dst_sel:WORD_1 dst_unused:UNUSED_PRESERVE src0_sel:WORD_1
s_waitcnt lgkmcnt(3)
v_or_b32 v187, v142, v143
v_rcp_f16_sdwa v148, v147 dst_sel:WORD_1 dst_unused:UNUSED_PRESERVE src0_sel:WORD_1
s_waitcnt lgkmcnt(0)
v_or_b32 v188, v144, v145
v_pk_mul_f16 v189, v155, v154
v_pk_mul_f16 v190, v152, v151
v_pk_mul_f16 v191, v149, v148
s_cmp_eq_u32 s77, 0
s_cbranch_scc1 Lpp3
s_call_b64 s[78:79], Lpoll
s_setprio 2
Lpp3:
v_cvt_pkrtz_f16_f32 v137, v120, v121
v_cvt_pkrtz_f16_f32 v139, v122, v123
v_cvt_pkrtz_f16_f32 v141, v124, v125
v_cvt_pkrtz_f16_f32 v143, v126, v127
v_cvt_pkrtz_f16_f32 v145, v128, v129
v_cvt_pk_f16_f32 v155, v130, v131
v_cvt_pk_f16_f32 v152, v132, v133
v_cvt_pk_f16_f32 v149, v134, v135
ds_read_b128 v[236:239], v249 offset:10240
v_mfma_f32_32x32x16_bf16 v[120:135], v[224:227], v[96:99], 0
v_pk_fma_f16 v154, v155, v155, s48
v_permlane16_swap_b32 v184, v188
v_and_b32 v137, s49, v137
v_pk_fma_f16 v151, v152, v152, s48
v_and_b32_e64 v139, s49, v139
v_pk_fma_f16 v148, v149, v149, s48
v_pk_mul_f16 v154, v155, v154
v_bfe_u32 v136, v137, 2, 14
v_pk_mul_f16 v151, v152, v151
ds_read_b128 v[224:227], v249 offset:8192
ds_read_u16_d16 v136, v136
v_mfma_f32_32x32x16_bf16 v[120:135], v[228:231], v[100:103], v[120:135]
v_pk_mul_f16 v148, v149, v148
v_bfe_u32 v138, v139, 2, 14
v_exp_f16 v153, v154
v_lshrrev_b32 v137, 18, v137
v_exp_f16 v150, v151
s_setprio 1
v_permlane16_swap_b32 v185, v189
v_lshrrev_b32 v139, 18, v139
ds_read_b128 v[228:231], v249 offset:11264
ds_read_u16_d16 v138, v138
ds_read_u16_d16_hi v137, v137
ds_read_u16_d16_hi v139, v139
v_mfma_f32_32x32x16_bf16 v[120:135], v[232:235], v[104:107], v[120:135]
v_exp_f16 v147, v148
v_and_b32 v141, s49, v141
v_and_b32 v143, s49, v143
v_exp_f16_sdwa v153, v154 dst_sel:WORD_1 dst_unused:UNUSED_PRESERVE src0_sel:WORD_1
v_bfe_u32 v140, v141, 2, 14
v_exp_f16_sdwa v150, v151 dst_sel:WORD_1 dst_unused:UNUSED_PRESERVE src0_sel:WORD_1
s_waitcnt lgkmcnt(6)
ds_read_b128 v[232:235], v249 offset:12288
ds_read_u16_d16 v140, v140
v_mfma_f32_32x32x16_bf16 v[120:135], v[236:239], v[108:111], v[120:135]
v_bfe_u32 v142, v143, 2, 14
v_exp_f16_sdwa v147, v148 dst_sel:WORD_1 dst_unused:UNUSED_PRESERVE src0_sel:WORD_1
v_lshrrev_b32 v141, 18, v141
v_permlane16_swap_b32 v186, v190
v_pk_add_f16 v153, v153, 1.0 op_sel_hi:[1,0]
v_lshrrev_b32 v143, 18, v143
v_pk_add_f16 v150, v150, 1.0 op_sel_hi:[1,0]
v_pk_add_f16 v147, v147, 1.0 op_sel_hi:[1,0]
s_waitcnt lgkmcnt(6)
ds_read_b128 v[236:239], v249 offset:15360
ds_read_u16_d16 v142, v142
ds_read_u16_d16_hi v141, v141
ds_read_u16_d16_hi v143, v143
v_mfma_f32_32x32x16_bf16 v[120:135], v[224:227], v[112:115], v[120:135]
v_and_b32 v145, s49, v145
v_rcp_f16 v154, v153
v_bfe_u32 v144, v145, 2, 14
v_rcp_f16 v151, v150
v_lshrrev_b32 v145, 18, v145
v_rcp_f16 v148, v147
s_waitcnt lgkmcnt(6)
ds_read_b128 v[224:227], v249 offset:13312
ds_read_u16_d16 v144, v144
ds_read_u16_d16_hi v145, v145
v_mfma_f32_32x32x16_bf16 v[120:135], v[228:231], v[116:119], v[120:135]
v_or_b32 v192, v136, v137
v_permlane16_swap_b32 v187, v191
v_or_b32_e64 v193, v138, v139
v_rcp_f16_sdwa v154, v153 dst_sel:WORD_1 dst_unused:UNUSED_PRESERVE src0_sel:WORD_1
s_waitcnt lgkmcnt(4)
v_or_b32 v194, v140, v141
v_rcp_f16_sdwa v151, v150 dst_sel:WORD_1 dst_unused:UNUSED_PRESERVE src0_sel:WORD_1
s_waitcnt lgkmcnt(3)
v_or_b32 v195, v142, v143
v_rcp_f16_sdwa v148, v147 dst_sel:WORD_1 dst_unused:UNUSED_PRESERVE src0_sel:WORD_1
s_waitcnt lgkmcnt(0)
v_or_b32_e64 v196, v144, v145
v_pk_mul_f16 v197, v155, v154
v_pk_mul_f16 v198, v152, v151
v_pk_mul_f16 v199, v149, v148
s_cmp_eq_u32 s77, 0
s_cbranch_scc1 Lpp4
s_call_b64 s[78:79], Lpoll
s_setprio 1
Lpp4:
v_mov_b32 v253, 16256
Lw2w:
ds_read_b32 v254, v253 offset:4
s_waitcnt lgkmcnt(0)
v_readfirstlane_b32 s43, v254
s_cmp_eq_u32 s76, 0
s_cbranch_scc1 Lw2x
s_sub_u32 s76, s76, 1
s_cmp_lt_u32 s43, 1
s_cbranch_scc0 Lw2x
s_sleep 2
s_branch Lw2w
Lw2x:
s_add_u32 m0, s72, 7168
s_add_u32 s43, s82, 6208
buffer_load_dwordx4 v252, s[16:19], s43 offen lds
s_add_u32 m0, s72, 8192
s_add_u32 s43, s82, 6272
buffer_load_dwordx4 v252, s[16:19], s43 offen lds
v_cvt_pkrtz_f16_f32 v137, v120, v121
v_cvt_pkrtz_f16_f32 v139, v122, v123
v_cvt_pkrtz_f16_f32 v141, v124, v125
v_cvt_pkrtz_f16_f32 v143, v126, v127
v_cvt_pkrtz_f16_f32 v145, v128, v129
v_cvt_pk_f16_f32 v155, v130, v131
v_cvt_pk_f16_f32 v152, v132, v133
v_cvt_pk_f16_f32 v149, v134, v135
ds_read_b128 v[228:231], v249 offset:16384
v_mfma_f32_32x32x16_bf16 v[120:135], v[232:235], v[96:99], 0
v_pk_fma_f16 v154, v155, v155, s48
v_permlane16_swap_b32 v192, v196
v_and_b32 v137, s49, v137
v_pk_fma_f16 v151, v152, v152, s48
v_and_b32_e64 v139, s49, v139
v_pk_fma_f16 v148, v149, v149, s48
v_pk_mul_f16 v154, v155, v154
v_bfe_u32 v136, v137, 2, 14
v_pk_mul_f16 v151, v152, v151
ds_read_b128 v[232:235], v249 offset:14336
ds_read_u16_d16 v136, v136
v_mfma_f32_32x32x16_bf16 v[120:135], v[236:239], v[100:103], v[120:135]
v_pk_mul_f16 v148, v149, v148
v_bfe_u32 v138, v139, 2, 14
v_exp_f16 v153, v154
v_lshrrev_b32 v137, 18, v137
v_exp_f16 v150, v151
v_permlane16_swap_b32 v193, v197
v_lshrrev_b32_e64 v139, 18, v139
ds_read_b128 v[236:239], v249 offset:17408
ds_read_u16_d16 v138, v138
ds_read_u16_d16_hi v137, v137
ds_read_u16_d16_hi v139, v139
v_mfma_f32_32x32x16_bf16 v[120:135], v[224:227], v[104:107], v[120:135]
v_exp_f16 v147, v148
s_setprio 0
v_and_b32_e64 v141, s49, v141
v_and_b32 v143, s49, v143
v_exp_f16_sdwa v153, v154 dst_sel:WORD_1 dst_unused:UNUSED_PRESERVE src0_sel:WORD_1
v_bfe_u32 v140, v141, 2, 14
v_exp_f16_sdwa v150, v151 dst_sel:WORD_1 dst_unused:UNUSED_PRESERVE src0_sel:WORD_1
s_waitcnt lgkmcnt(6)
ds_read_b128 v[224:227], v249 offset:18432
ds_read_u16_d16 v140, v140
v_mfma_f32_32x32x16_bf16 v[120:135], v[228:231], v[108:111], v[120:135]
v_bfe_u32 v142, v143, 2, 14
v_exp_f16_sdwa v147, v148 dst_sel:WORD_1 dst_unused:UNUSED_PRESERVE src0_sel:WORD_1
v_lshrrev_b32 v141, 18, v141
v_permlane16_swap_b32 v194, v198
v_pk_add_f16 v153, v153, 1.0 op_sel_hi:[1,0]
v_lshrrev_b32 v143, 18, v143
v_pk_add_f16 v150, v150, 1.0 op_sel_hi:[1,0]
v_pk_add_f16 v147, v147, 1.0 op_sel_hi:[1,0]
s_waitcnt lgkmcnt(6)
ds_read_b128 v[228:231], v249 offset:21504
ds_read_u16_d16 v142, v142
ds_read_u16_d16_hi v141, v141
ds_read_u16_d16_hi v143, v143
v_mfma_f32_32x32x16_bf16 v[120:135], v[232:235], v[112:115], v[120:135]
v_and_b32 v145, s49, v145
v_rcp_f16 v154, v153
v_bfe_u32 v144, v145, 2, 14
v_rcp_f16 v151, v150
v_lshrrev_b32 v145, 18, v145
v_rcp_f16 v148, v147
s_waitcnt lgkmcnt(6)
ds_read_b128 v[232:235], v249 offset:19456
ds_read_u16_d16 v144, v144
ds_read_u16_d16_hi v145, v145
v_mfma_f32_32x32x16_bf16 v[120:135], v[236:239], v[116:119], v[120:135]
v_or_b32 v200, v136, v137
v_permlane16_swap_b32 v195, v199
v_or_b32_e64 v201, v138, v139
v_rcp_f16_sdwa v154, v153 dst_sel:WORD_1 dst_unused:UNUSED_PRESERVE src0_sel:WORD_1
s_waitcnt lgkmcnt(4)
v_or_b32 v202, v140, v141
v_rcp_f16_sdwa v151, v150 dst_sel:WORD_1 dst_unused:UNUSED_PRESERVE src0_sel:WORD_1
s_waitcnt lgkmcnt(3)
v_or_b32 v203, v142, v143
v_rcp_f16_sdwa v148, v147 dst_sel:WORD_1 dst_unused:UNUSED_PRESERVE src0_sel:WORD_1
s_waitcnt lgkmcnt(0)
v_or_b32_e64 v204, v144, v145
v_pk_mul_f16 v205, v155, v154
v_pk_mul_f16 v206, v152, v151
v_pk_mul_f16 v207, v149, v148
s_cmp_eq_u32 s77, 0
s_cbranch_scc1 Lpp5
s_call_b64 s[78:79], Lpoll
s_setprio 0
Lpp5:
s_setprio 2
v_cvt_pkrtz_f16_f32 v137, v120, v121
v_cvt_pkrtz_f16_f32 v139, v122, v123
v_cvt_pkrtz_f16_f32 v141, v124, v125
v_cvt_pkrtz_f16_f32 v143, v126, v127
v_cvt_pkrtz_f16_f32 v145, v128, v129
v_cvt_pk_f16_f32 v155, v130, v131
v_cvt_pk_f16_f32 v152, v132, v133
v_cvt_pk_f16_f32 v149, v134, v135
ds_read_b128 v[236:239], v249 offset:22528
v_mfma_f32_32x32x16_bf16 v[120:135], v[224:227], v[96:99], 0
v_pk_fma_f16 v154, v155, v155, s48
v_permlane16_swap_b32 v200, v204
v_and_b32 v137, s49, v137
v_pk_fma_f16 v151, v152, v152, s48
v_and_b32_e64 v139, s49, v139
v_pk_fma_f16 v148, v149, v149, s48
v_pk_mul_f16 v154, v155, v154
v_bfe_u32 v136, v137, 2, 14
v_pk_mul_f16 v151, v152, v151
ds_read_b128 v[224:227], v249 offset:20480
ds_read_u16_d16 v136, v136
v_mfma_f32_32x32x16_bf16 v[120:135], v[228:231], v[100:103], v[120:135]
v_pk_mul_f16 v148, v149, v148
v_bfe_u32 v138, v139, 2, 14
v_exp_f16 v153, v154
v_lshrrev_b32 v137, 18, v137
v_exp_f16 v150, v151
v_permlane16_swap_b32 v201, v205
v_lshrrev_b32_e64 v139, 18, v139
ds_read_b128 v[228:231], v249 offset:23552
ds_read_u16_d16 v138, v138
ds_read_u16_d16_hi v137, v137
ds_read_u16_d16_hi v139, v139
v_mfma_f32_32x32x16_bf16 v[120:135], v[232:235], v[104:107], v[120:135]
v_exp_f16 v147, v148
v_and_b32 v141, s49, v141
v_and_b32 v143, s49, v143
v_exp_f16_sdwa v153, v154 dst_sel:WORD_1 dst_unused:UNUSED_PRESERVE src0_sel:WORD_1
v_bfe_u32 v140, v141, 2, 14
v_exp_f16_sdwa v150, v151 dst_sel:WORD_1 dst_unused:UNUSED_PRESERVE src0_sel:WORD_1
s_waitcnt lgkmcnt(6)
ds_read_u16_d16 v140, v140
v_mfma_f32_32x32x16_bf16 v[120:135], v[236:239], v[108:111], v[120:135]
v_bfe_u32 v142, v143, 2, 14
v_exp_f16_sdwa v147, v148 dst_sel:WORD_1 dst_unused:UNUSED_PRESERVE src0_sel:WORD_1
v_lshrrev_b32 v141, 18, v141
v_permlane16_swap_b32 v202, v206
v_pk_add_f16 v153, v153, 1.0 op_sel_hi:[1,0]
v_lshrrev_b32 v143, 18, v143
v_pk_add_f16 v150, v150, 1.0 op_sel_hi:[1,0]
v_pk_add_f16 v147, v147, 1.0 op_sel_hi:[1,0]
s_waitcnt lgkmcnt(5)
ds_read_u16_d16 v142, v142
ds_read_u16_d16_hi v141, v141
ds_read_u16_d16_hi v143, v143
v_mfma_f32_32x32x16_bf16 v[120:135], v[224:227], v[112:115], v[120:135]
v_and_b32 v145, s49, v145
v_rcp_f16 v154, v153
v_bfe_u32 v144, v145, 2, 14
v_rcp_f16 v151, v150
v_lshrrev_b32 v145, 18, v145
v_rcp_f16 v148, v147
s_waitcnt lgkmcnt(4)
ds_read_u16_d16 v144, v144
ds_read_u16_d16_hi v145, v145
v_mfma_f32_32x32x16_bf16 v[120:135], v[228:231], v[116:119], v[120:135]
v_or_b32 v208, v136, v137
v_permlane16_swap_b32 v203, v207
v_or_b32_e64 v209, v138, v139
v_rcp_f16_sdwa v154, v153 dst_sel:WORD_1 dst_unused:UNUSED_PRESERVE src0_sel:WORD_1
s_waitcnt lgkmcnt(3)
v_or_b32 v210, v140, v141
v_rcp_f16_sdwa v151, v150 dst_sel:WORD_1 dst_unused:UNUSED_PRESERVE src0_sel:WORD_1
s_waitcnt lgkmcnt(2)
v_or_b32 v211, v142, v143
v_rcp_f16_sdwa v148, v147 dst_sel:WORD_1 dst_unused:UNUSED_PRESERVE src0_sel:WORD_1
s_waitcnt lgkmcnt(0)
v_or_b32 v212, v144, v145
v_pk_mul_f16 v213, v155, v154
v_pk_mul_f16 v214, v152, v151
v_pk_mul_f16 v215, v149, v148
s_cmp_eq_u32 s77, 0
s_cbranch_scc1 Lpp6
s_call_b64 s[78:79], Lpoll
s_setprio 2
Lpp6:
v_cvt_pkrtz_f16_f32 v137, v120, v121
v_cvt_pkrtz_f16_f32 v139, v122, v123
v_cvt_pkrtz_f16_f32 v141, v124, v125
v_cvt_pkrtz_f16_f32 v143, v126, v127
v_cvt_pkrtz_f16_f32 v145, v128, v129
v_cvt_pk_f16_f32 v155, v130, v131
v_cvt_pk_f16_f32 v152, v132, v133
v_cvt_pk_f16_f32 v149, v134, v135
v_pk_fma_f16 v154, v155, v155, s48
v_permlane16_swap_b32 v96, v100
v_permlane16_swap_b32 v208, v212
v_and_b32_e64 v137, s49, v137
v_pk_fma_f16 v151, v152, v152, s48
v_and_b32 v139, s49, v139
v_pk_fma_f16 v148, v149, v149, s48
v_permlane16_swap_b32 v97, v101
v_pk_mul_f16 v154, v155, v154
v_bfe_u32 v136, v137, 2, 14
v_pk_mul_f16 v151, v152, v151
v_pk_mul_f16 v148, v149, v148
v_bfe_u32 v138, v139, 2, 14
v_permlane16_swap_b32 v98, v102
v_exp_f16 v153, v154
v_lshrrev_b32 v137, 18, v137
v_exp_f16 v150, v151
v_permlane16_swap_b32 v99, v103
s_setprio 1
v_permlane16_swap_b32 v209, v213
v_lshrrev_b32 v139, 18, v139
v_exp_f16 v147, v148
v_and_b32 v141, s49, v141
v_permlane16_swap_b32 v104, v108
v_and_b32 v143, s49, v143
ds_read_u16_d16 v136, v136
ds_read_u16_d16 v138, v138
ds_read_u16_d16_hi v137, v137
ds_read_u16_d16_hi v139, v139
v_exp_f16_sdwa v153, v154 dst_sel:WORD_1 dst_unused:UNUSED_PRESERVE src0_sel:WORD_1
v_bfe_u32 v140, v141, 2, 14
v_exp_f16_sdwa v150, v151 dst_sel:WORD_1 dst_unused:UNUSED_PRESERVE src0_sel:WORD_1
v_permlane16_swap_b32 v105, v109
v_bfe_u32 v142, v143, 2, 14
v_exp_f16_sdwa v147, v148 dst_sel:WORD_1 dst_unused:UNUSED_PRESERVE src0_sel:WORD_1
v_lshrrev_b32 v141, 18, v141
v_permlane16_swap_b32 v106, v110
v_permlane16_swap_b32 v210, v214
v_pk_add_f16 v153, v153, 1.0 op_sel_hi:[1,0]
v_lshrrev_b32_e64 v143, 18, v143
v_pk_add_f16 v150, v150, 1.0 op_sel_hi:[1,0]
v_pk_add_f16 v147, v147, 1.0 op_sel_hi:[1,0]
v_permlane16_swap_b32 v107, v111
v_and_b32 v145, s49, v145
v_rcp_f16_e64 v154, v153
v_bfe_u32 v144, v145, 2, 14
v_rcp_f16 v151, v150
v_permlane16_swap_b32 v112, v116
v_lshrrev_b32_e64 v145, 18, v145
ds_read_u16_d16 v140, v140
ds_read_u16_d16 v142, v142
ds_read_u16_d16_hi v141, v141
ds_read_u16_d16_hi v143, v143
ds_read_u16_d16 v144, v144
ds_read_u16_d16_hi v145, v145
v_rcp_f16 v148, v147
s_waitcnt lgkmcnt(6)
v_or_b32 v216, v136, v137
v_permlane16_swap_b32 v113, v117
v_permlane16_swap_b32 v211, v215
v_or_b32 v217, v138, v139
v_rcp_f16_sdwa v154, v153 dst_sel:WORD_1 dst_unused:UNUSED_PRESERVE src0_sel:WORD_1
s_waitcnt lgkmcnt(3)
v_or_b32 v218, v140, v141
v_permlane16_swap_b32 v114, v118
v_rcp_f16_sdwa v151, v150 dst_sel:WORD_1 dst_unused:UNUSED_PRESERVE src0_sel:WORD_1
s_waitcnt lgkmcnt(2)
v_or_b32_e64 v219, v142, v143
v_rcp_f16_sdwa v148, v147 dst_sel:WORD_1 dst_unused:UNUSED_PRESERVE src0_sel:WORD_1
v_permlane16_swap_b32 v115, v119
s_waitcnt lgkmcnt(0)
v_or_b32_e64 v220, v144, v145
v_pk_mul_f16 v221, v155, v154
v_pk_mul_f16 v222, v152, v151
v_pk_mul_f16 v223, v149, v148
s_cmp_eq_u32 s77, 0
s_cbranch_scc1 Lpp7
s_call_b64 s[78:79], Lpoll
s_setprio 1
Lpp7:
v_permlane16_swap_b32 v216, v220
v_permlane16_swap_b32 v217, v221
s_setprio 0
v_permlane16_swap_b32 v218, v222
v_permlane16_swap_b32 v219, v223
s_cmp_eq_u32 s77, 0
s_cbranch_scc1 Lpp8
s_call_b64 s[78:79], Lpoll
s_setprio 0
Lpp8:
s_setprio 2
v_lshrrev_b32_e64 v225, 5, v251
v_lshl_add_u32 v224, v225, 9, s72
v_lshl_add_u32 v226, v225, 4, s72
v_and_b32 v225, 15, v251
v_lshl_add_u32 v224, v225, 4, v224
v_bfe_u32 v225, v251, 4, 1
v_lshl_add_u32 v224, v225, 3, v224
s_waitcnt vmcnt(0)
ds_read_b64_tr_b16 v[120:121], v224
ds_read_b64_tr_b16 v[122:123], v224 offset:256
ds_read_b64_tr_b16 v[124:125], v224 offset:1024
ds_read_b64_tr_b16 v[126:127], v224 offset:1280
ds_read_b64_tr_b16 v[128:129], v224 offset:2048
ds_read_b64_tr_b16 v[130:131], v224 offset:2304
ds_read_b64_tr_b16 v[132:133], v224 offset:3072
ds_read_b64_tr_b16 v[134:135], v224 offset:3328
ds_read_b64_tr_b16 v[136:137], v224 offset:4096
ds_read_b64_tr_b16 v[138:139], v224 offset:4352
ds_read_b64_tr_b16 v[140:141], v224 offset:5120
ds_read_b64_tr_b16 v[142:143], v224 offset:5376
ds_read_b64_tr_b16 v[144:145], v224 offset:6144
ds_read_b64_tr_b16 v[146:147], v224 offset:6400
ds_read_b64_tr_b16 v[148:149], v224 offset:7168
ds_read_b64_tr_b16 v[150:151], v224 offset:7424
ds_read_b64_tr_b16 v[152:153], v224 offset:8192
ds_read_b64_tr_b16 v[154:155], v224 offset:8448
v_lshrrev_b32 v225, 4, v251
v_and_b32 v227, 15, v251
v_mul_u32_u24 v252, 192, v227
v_lshl_add_u32 v252, v225, 4, v252
v_lshlrev_b32 v254, 5, v225
v_and_b32 v253, 47, v251
v_lshlrev_b32 v253, 4, v253
v_and_b32 v225, 1, v225
v_mul_u32_u24 v227, 3072, v225
v_add_u32_e64 v248, v227, v253
v_add_u32 v249, 65536, v248
v_add_u32 v250, 131072, v248
v_lshl_add_u32 v253, v225, 21, v253
v_mov_b32 v225, 16256
v_mov_b32_e64 v227, 1
s_waitcnt lgkmcnt(0)
s_mov_b64 exec, 1
ds_add_u32 v225, v227 offset:8
s_mov_b64 exec, -1
v_lshlrev_b32 v228, 16, v120
v_and_b32 v229, 4294901760, v120
v_cvt_pk_f16_f32 v120, v228, v229
v_lshlrev_b32_e64 v230, 16, v121
v_and_b32 v231, 4294901760, v121
v_cvt_pk_f16_f32 v121, v230, v231
v_lshlrev_b32_e64 v228, 16, v122
v_and_b32 v229, 4294901760, v122
v_cvt_pk_f16_f32 v122, v228, v229
v_lshlrev_b32_e64 v230, 16, v123
v_and_b32 v231, 4294901760, v123
v_cvt_pk_f16_f32 v123, v230, v231
v_lshlrev_b32_e64 v228, 16, v124
v_and_b32 v229, 4294901760, v124
v_cvt_pk_f16_f32 v124, v228, v229
v_lshlrev_b32_e64 v230, 16, v125
v_and_b32 v231, 4294901760, v125
v_cvt_pk_f16_f32 v125, v230, v231
v_lshlrev_b32_e64 v228, 16, v126
v_and_b32 v229, 4294901760, v126
v_cvt_pk_f16_f32 v126, v228, v229
v_lshlrev_b32_e64 v230, 16, v127
v_and_b32 v231, 4294901760, v127
v_cvt_pk_f16_f32 v127, v230, v231
v_lshlrev_b32_e64 v228, 16, v128
v_and_b32 v229, 4294901760, v128
v_cvt_pk_f16_f32 v128, v228, v229
v_lshlrev_b32_e64 v230, 16, v129
v_and_b32 v231, 4294901760, v129
v_cvt_pk_f16_f32 v129, v230, v231
v_lshlrev_b32_e64 v228, 16, v130
v_and_b32 v229, 4294901760, v130
v_cvt_pk_f16_f32 v130, v228, v229
v_lshlrev_b32_e64 v230, 16, v131
v_and_b32 v231, 4294901760, v131
v_cvt_pk_f16_f32 v131, v230, v231
s_cmp_eq_u32 s77, 0
s_cbranch_scc1 Lpp211
s_call_b64 s[78:79], Lpoll
s_setprio 2
Lpp211:
v_lshlrev_b32_e64 v228, 16, v132
v_and_b32 v229, 4294901760, v132
v_cvt_pk_f16_f32 v132, v228, v229
v_lshlrev_b32_e64 v230, 16, v133
v_and_b32 v231, 4294901760, v133
v_cvt_pk_f16_f32 v133, v230, v231
v_lshlrev_b32_e64 v228, 16, v134
v_and_b32 v229, 4294901760, v134
v_cvt_pk_f16_f32 v134, v228, v229
v_lshlrev_b32_e64 v230, 16, v135
v_and_b32 v231, 4294901760, v135
v_cvt_pk_f16_f32 v135, v230, v231
v_lshlrev_b32_e64 v228, 16, v136
v_and_b32 v229, 4294901760, v136
v_cvt_pk_f16_f32 v136, v228, v229
v_lshlrev_b32_e64 v230, 16, v137
v_and_b32 v231, 4294901760, v137
v_cvt_pk_f16_f32 v137, v230, v231
v_lshlrev_b32_e64 v228, 16, v138
v_and_b32 v229, 4294901760, v138
v_cvt_pk_f16_f32 v138, v228, v229
v_lshlrev_b32_e64 v230, 16, v139
v_and_b32 v231, 4294901760, v139
v_cvt_pk_f16_f32 v139, v230, v231
v_lshlrev_b32_e64 v228, 16, v140
v_and_b32 v229, 4294901760, v140
v_cvt_pk_f16_f32 v140, v228, v229
v_lshlrev_b32_e64 v230, 16, v141
v_and_b32 v231, 4294901760, v141
v_cvt_pk_f16_f32 v141, v230, v231
v_lshlrev_b32_e64 v228, 16, v142
v_and_b32 v229, 4294901760, v142
v_cvt_pk_f16_f32 v142, v228, v229
v_lshlrev_b32_e64 v230, 16, v143
v_and_b32 v231, 4294901760, v143
v_cvt_pk_f16_f32 v143, v230, v231
s_cmp_eq_u32 s77, 0
s_cbranch_scc1 Lpp223
s_call_b64 s[78:79], Lpoll
s_setprio 2
Lpp223:
v_lshlrev_b32_e64 v228, 16, v144
v_and_b32 v229, 4294901760, v144
v_cvt_pk_f16_f32 v144, v228, v229
v_lshlrev_b32_e64 v230, 16, v145
v_and_b32 v231, 4294901760, v145
v_cvt_pk_f16_f32 v145, v230, v231
v_lshlrev_b32_e64 v228, 16, v146
v_and_b32 v229, 4294901760, v146
v_cvt_pk_f16_f32 v146, v228, v229
v_lshlrev_b32_e64 v230, 16, v147
v_and_b32 v231, 4294901760, v147
v_cvt_pk_f16_f32 v147, v230, v231
v_lshlrev_b32_e64 v228, 16, v148
v_and_b32 v229, 4294901760, v148
v_cvt_pk_f16_f32 v148, v228, v229
v_lshlrev_b32_e64 v230, 16, v149
v_and_b32 v231, 4294901760, v149
v_cvt_pk_f16_f32 v149, v230, v231
v_lshlrev_b32_e64 v228, 16, v150
v_and_b32 v229, 4294901760, v150
v_cvt_pk_f16_f32 v150, v228, v229
v_lshlrev_b32_e64 v230, 16, v151
v_and_b32 v231, 4294901760, v151
v_cvt_pk_f16_f32 v151, v230, v231
v_lshlrev_b32_e64 v228, 16, v152
v_and_b32 v229, 4294901760, v152
v_cvt_pk_f16_f32 v152, v228, v229
v_lshlrev_b32_e64 v230, 16, v153
v_and_b32 v231, 4294901760, v153
v_cvt_pk_f16_f32 v153, v230, v231
v_lshlrev_b32_e64 v228, 16, v154
v_and_b32 v229, 4294901760, v154
v_cvt_pk_f16_f32 v154, v228, v229
v_lshlrev_b32_e64 v230, 16, v155
v_and_b32 v231, 4294901760, v155
v_cvt_pk_f16_f32 v155, v230, v231
s_cmp_eq_u32 s77, 0
s_cbranch_scc1 Lpp235
s_call_b64 s[78:79], Lpoll
s_setprio 2
Lpp235:
v_lshl_add_u32 v224, v251, 4, s72
s_cmp_lg_u32 s40, 0
s_cbranch_scc1 Lnofin
Lspin:
s_cmp_eq_u32 s77, 0
s_cbranch_scc1 Lspinx
s_cmp_eq_u32 s76, 0
s_cbranch_scc1 Lspinx
s_sub_u32 s76, s76, 1
s_call_b64 s[78:79], Lpoll
s_branch Lspin
Lspinx:
v_add_u32 v162, 0, v251
v_mul_u32_u24 v165, 2731, v162
v_lshrrev_b32_e64 v165, 16, v165
v_mul_u32_u24 v165, 9120, v165
v_lshl_add_u32 v162, v162, 2, v165
v_add_u32 v162, 90112, v162
v_add_u32_e64 v163, 64, v251
v_mul_u32_u24 v165, 2731, v163
v_lshrrev_b32_e64 v165, 16, v165
v_mul_u32_u24 v165, 9120, v165
v_lshl_add_u32 v163, v163, 2, v165
v_add_u32 v163, 90112, v163
v_add_u32 v164, 128, v251
v_mul_u32_u24 v165, 2731, v164
v_lshrrev_b32_e64 v165, 16, v165
v_mul_u32_u24 v165, 9120, v165
v_lshl_add_u32 v164, v164, 2, v165
v_add_u32 v164, 90112, v164
v_mov_b32 v165, 16256
Lrrw:
ds_read_b32 v166, v165 offset:8
s_waitcnt lgkmcnt(0)
v_readfirstlane_b32 s43, v166
s_cmp_eq_u32 s76, 0
s_cbranch_scc1 Lrrx
s_sub_u32 s76, s76, 1
s_cmp_lt_u32 s43, 8
s_cbranch_scc0 Lrrx
s_sleep 2
s_branch Lrrw
Lrrx:
ds_write_b32 v162, v244
ds_write_b32 v163, v245
ds_write_b32 v164, v246
Lnofin:
s_waitcnt lgkmcnt(0)
s_barrier
ds_read_b128 v[228:231], v226
ds_read_b128 v[232:235], v226 offset:32
ds_read_b128 v[236:239], v226 offset:64
buffer_load_dwordx4 v[240:243], v252, s[4:7], s71 offen
s_add_u32 s46, s71, 98304
buffer_load_dwordx4 v[244:247], v252, s[4:7], s46 offen
s_waitcnt lgkmcnt(0)
v_pk_mul_f16 v120, v120, v228
v_pk_mul_f16 v121, v121, v229
v_pk_mul_f16 v122, v122, v230
v_pk_mul_f16 v123, v123, v231
ds_write_b128 v224, v[120:123]
v_pk_mul_f16 v124, v124, v228
v_pk_mul_f16 v125, v125, v229
v_pk_mul_f16 v126, v126, v230
v_pk_mul_f16 v127, v127, v231
ds_write_b128 v224, v[124:127] offset:1024
v_pk_mul_f16 v128, v128, v228
v_pk_mul_f16 v129, v129, v229
v_pk_mul_f16 v130, v130, v230
v_pk_mul_f16 v131, v131, v231
ds_write_b128 v224, v[128:131] offset:2048
v_pk_mul_f16 v132, v132, v232
v_pk_mul_f16 v133, v133, v233
v_pk_mul_f16 v134, v134, v234
v_pk_mul_f16 v135, v135, v235
ds_write_b128 v224, v[132:135] offset:3072
v_pk_mul_f16 v136, v136, v232
v_pk_mul_f16 v137, v137, v233
v_pk_mul_f16 v138, v138, v234
v_pk_mul_f16 v139, v139, v235
ds_write_b128 v224, v[136:139] offset:4096
v_pk_mul_f16 v140, v140, v232
v_pk_mul_f16 v141, v141, v233
v_pk_mul_f16 v142, v142, v234
v_pk_mul_f16 v143, v143, v235
ds_write_b128 v224, v[140:143] offset:5120
v_pk_mul_f16 v144, v144, v236
v_pk_mul_f16 v145, v145, v237
v_pk_mul_f16 v146, v146, v238
v_pk_mul_f16 v147, v147, v239
ds_write_b128 v224, v[144:147] offset:6144
v_pk_mul_f16 v148, v148, v236
v_pk_mul_f16 v149, v149, v237
v_pk_mul_f16 v150, v150, v238
v_pk_mul_f16 v151, v151, v239
ds_write_b128 v224, v[148:151] offset:7168
v_pk_mul_f16 v152, v152, v236
v_pk_mul_f16 v153, v153, v237
v_pk_mul_f16 v154, v154, v238
v_pk_mul_f16 v155, v155, v239
ds_write_b128 v224, v[152:155] offset:8192
s_waitcnt lgkmcnt(0)
s_barrier
s_setprio 3
ds_read_b128 v[224:227], v249 offset:24576
ds_read_b128 v[228:231], v254 offset:7936
ds_read_b128 v[232:235], v249 offset:24832
ds_read_b128 v[236:239], v254 offset:7952
s_waitcnt lgkmcnt(2)
v_mfma_f32_16x16x32_f16 v[120:123], v[224:227], v[0:3], v[228:231]
v_mfma_f32_16x16x32_f16 v[128:131], v[224:227], v[4:7], v[228:231]
s_waitcnt lgkmcnt(0)
v_mfma_f32_16x16x32_f16 v[124:127], v[232:235], v[0:3], v[236:239]
ds_read_b128 v[224:227], v249 offset:25600
ds_read_b128 v[228:231], v254 offset:8064
v_mfma_f32_16x16x32_f16 v[132:135], v[232:235], v[4:7], v[236:239]
s_waitcnt lgkmcnt(0)
v_mfma_f32_16x16x32_f16 v[136:139], v[224:227], v[0:3], v[228:231]
ds_read_b128 v[232:235], v249 offset:25856
ds_read_b128 v[236:239], v254 offset:8080
v_mfma_f32_16x16x32_f16 v[144:147], v[224:227], v[4:7], v[228:231]
s_waitcnt lgkmcnt(0)
v_mfma_f32_16x16x32_f16 v[140:143], v[232:235], v[0:3], v[236:239]
ds_read_b128 v[224:227], v249 offset:26624
ds_read_b128 v[228:231], v254 offset:16128
v_mfma_f32_16x16x32_f16 v[148:151], v[232:235], v[4:7], v[236:239]
s_waitcnt lgkmcnt(0)
v_mfma_f32_16x16x32_f16 v[152:155], v[224:227], v[0:3], v[228:231]
ds_read_b128 v[232:235], v249 offset:26880
ds_read_b128 v[236:239], v254 offset:16144
v_mfma_f32_16x16x32_f16 v[160:163], v[224:227], v[4:7], v[228:231]
s_waitcnt lgkmcnt(0)
v_mfma_f32_16x16x32_f16 v[156:159], v[232:235], v[0:3], v[236:239]
ds_read_b128 v[224:227], v249 offset:30720
ds_read_b128 v[228:231], v249 offset:30976
v_mfma_f32_16x16x32_f16 v[164:167], v[232:235], v[4:7], v[236:239]
s_waitcnt lgkmcnt(1)
v_mfma_f32_16x16x32_f16 v[120:123], v[224:227], v[8:11], v[120:123]
ds_read_b128 v[232:235], v249 offset:31744
ds_read_b128 v[236:239], v249 offset:32000
v_mfma_f32_16x16x32_f16 v[128:131], v[224:227], v[12:15], v[128:131]
s_waitcnt lgkmcnt(2)
v_mfma_f32_16x16x32_f16 v[124:127], v[228:231], v[8:11], v[124:127]
ds_read_b128 v[224:227], v249 offset:32768
v_mfma_f32_16x16x32_f16 v[132:135], v[228:231], v[12:15], v[132:135]
s_waitcnt lgkmcnt(2)
v_mfma_f32_16x16x32_f16 v[136:139], v[232:235], v[8:11], v[136:139]
ds_read_b128 v[228:231], v249 offset:33024
v_mfma_f32_16x16x32_f16 v[144:147], v[232:235], v[12:15], v[144:147]
s_waitcnt lgkmcnt(2)
v_mfma_f32_16x16x32_f16 v[140:143], v[236:239], v[8:11], v[140:143]
ds_read_b128 v[232:235], v249 offset:36864
v_mfma_f32_16x16x32_f16 v[148:151], v[236:239], v[12:15], v[148:151]
s_waitcnt lgkmcnt(2)
v_mfma_f32_16x16x32_f16 v[152:155], v[224:227], v[8:11], v[152:155]
ds_read_b128 v[236:239], v249 offset:37120
v_mfma_f32_16x16x32_f16 v[160:163], v[224:227], v[12:15], v[160:163]
s_waitcnt lgkmcnt(2)
v_mfma_f32_16x16x32_f16 v[156:159], v[228:231], v[8:11], v[156:159]
ds_read_b128 v[224:227], v249 offset:37888
v_mfma_f32_16x16x32_f16 v[164:167], v[228:231], v[12:15], v[164:167]
s_waitcnt lgkmcnt(2)
v_mfma_f32_16x16x32_f16 v[120:123], v[232:235], v[16:19], v[120:123]
ds_read_b128 v[228:231], v249 offset:38144
v_mfma_f32_16x16x32_f16 v[128:131], v[232:235], v[20:23], v[128:131]
s_waitcnt lgkmcnt(2)
v_mfma_f32_16x16x32_f16 v[124:127], v[236:239], v[16:19], v[124:127]
ds_read_b128 v[232:235], v249 offset:38912
v_mfma_f32_16x16x32_f16 v[132:135], v[236:239], v[20:23], v[132:135]
s_waitcnt lgkmcnt(2)
v_mfma_f32_16x16x32_f16 v[136:139], v[224:227], v[16:19], v[136:139]
ds_read_b128 v[236:239], v249 offset:39168
v_mfma_f32_16x16x32_f16 v[144:147], v[224:227], v[20:23], v[144:147]
s_waitcnt lgkmcnt(2)
v_mfma_f32_16x16x32_f16 v[140:143], v[228:231], v[16:19], v[140:143]
ds_read_b128 v[224:227], v249 offset:43008
v_mfma_f32_16x16x32_f16 v[148:151], v[228:231], v[20:23], v[148:151]
s_waitcnt lgkmcnt(2)
v_mfma_f32_16x16x32_f16 v[152:155], v[232:235], v[16:19], v[152:155]
ds_read_b128 v[228:231], v249 offset:43264
v_mfma_f32_16x16x32_f16 v[160:163], v[232:235], v[20:23], v[160:163]
s_waitcnt lgkmcnt(2)
v_mfma_f32_16x16x32_f16 v[156:159], v[236:239], v[16:19], v[156:159]
ds_read_b128 v[232:235], v249 offset:44032
v_mfma_f32_16x16x32_f16 v[164:167], v[236:239], v[20:23], v[164:167]
s_waitcnt lgkmcnt(2)
v_mfma_f32_16x16x32_f16 v[120:123], v[224:227], v[24:27], v[120:123]
ds_read_b128 v[236:239], v249 offset:44288
v_mfma_f32_16x16x32_f16 v[128:131], v[224:227], v[28:31], v[128:131]
s_waitcnt lgkmcnt(2)
v_mfma_f32_16x16x32_f16 v[124:127], v[228:231], v[24:27], v[124:127]
ds_read_b128 v[224:227], v249 offset:45056
v_mfma_f32_16x16x32_f16 v[132:135], v[228:231], v[28:31], v[132:135]
s_waitcnt lgkmcnt(2)
v_mfma_f32_16x16x32_f16 v[136:139], v[232:235], v[24:27], v[136:139]
ds_read_b128 v[228:231], v249 offset:45312
v_mfma_f32_16x16x32_f16 v[144:147], v[232:235], v[28:31], v[144:147]
s_waitcnt lgkmcnt(2)
v_mfma_f32_16x16x32_f16 v[140:143], v[236:239], v[24:27], v[140:143]
ds_read_b128 v[232:235], v249 offset:49152
v_mfma_f32_16x16x32_f16 v[148:151], v[236:239], v[28:31], v[148:151]
s_waitcnt lgkmcnt(2)
v_mfma_f32_16x16x32_f16 v[152:155], v[224:227], v[24:27], v[152:155]
ds_read_b128 v[236:239], v249 offset:49408
v_mfma_f32_16x16x32_f16 v[160:163], v[224:227], v[28:31], v[160:163]
s_waitcnt lgkmcnt(2)
v_mfma_f32_16x16x32_f16 v[156:159], v[228:231], v[24:27], v[156:159]
ds_read_b128 v[224:227], v249 offset:50176
v_mfma_f32_16x16x32_f16 v[164:167], v[228:231], v[28:31], v[164:167]
s_waitcnt lgkmcnt(2)
v_mfma_f32_16x16x32_f16 v[120:123], v[232:235], v[32:35], v[120:123]
ds_read_b128 v[228:231], v249 offset:50432
v_mfma_f32_16x16x32_f16 v[128:131], v[232:235], v[36:39], v[128:131]
s_waitcnt lgkmcnt(2)
v_mfma_f32_16x16x32_f16 v[124:127], v[236:239], v[32:35], v[124:127]
ds_read_b128 v[232:235], v249 offset:51200
v_mfma_f32_16x16x32_f16 v[132:135], v[236:239], v[36:39], v[132:135]
s_waitcnt lgkmcnt(2)
v_mfma_f32_16x16x32_f16 v[136:139], v[224:227], v[32:35], v[136:139]
ds_read_b128 v[236:239], v249 offset:51456
v_mfma_f32_16x16x32_f16 v[144:147], v[224:227], v[36:39], v[144:147]
s_waitcnt lgkmcnt(2)
v_mfma_f32_16x16x32_f16 v[140:143], v[228:231], v[32:35], v[140:143]
ds_read_b128 v[224:227], v249 offset:55296
v_mfma_f32_16x16x32_f16 v[148:151], v[228:231], v[36:39], v[148:151]
s_waitcnt lgkmcnt(2)
v_mfma_f32_16x16x32_f16 v[152:155], v[232:235], v[32:35], v[152:155]
ds_read_b128 v[228:231], v249 offset:55552
v_mfma_f32_16x16x32_f16 v[160:163], v[232:235], v[36:39], v[160:163]
s_waitcnt lgkmcnt(2)
v_mfma_f32_16x16x32_f16 v[156:159], v[236:239], v[32:35], v[156:159]
ds_read_b128 v[232:235], v249 offset:56320
v_mfma_f32_16x16x32_f16 v[164:167], v[236:239], v[36:39], v[164:167]
s_waitcnt lgkmcnt(2)
v_mfma_f32_16x16x32_f16 v[120:123], v[224:227], v[40:43], v[120:123]
ds_read_b128 v[236:239], v249 offset:56576
v_mfma_f32_16x16x32_f16 v[128:131], v[224:227], v[44:47], v[128:131]
s_waitcnt lgkmcnt(2)
v_mfma_f32_16x16x32_f16 v[124:127], v[228:231], v[40:43], v[124:127]
ds_read_b128 v[224:227], v249 offset:57344
v_mfma_f32_16x16x32_f16 v[132:135], v[228:231], v[44:47], v[132:135]
s_waitcnt lgkmcnt(2)
v_mfma_f32_16x16x32_f16 v[136:139], v[232:235], v[40:43], v[136:139]
ds_read_b128 v[228:231], v249 offset:57600
v_mfma_f32_16x16x32_f16 v[144:147], v[232:235], v[44:47], v[144:147]
s_waitcnt lgkmcnt(2)
v_mfma_f32_16x16x32_f16 v[140:143], v[236:239], v[40:43], v[140:143]
ds_read_b128 v[232:235], v249 offset:61440
v_mfma_f32_16x16x32_f16 v[148:151], v[236:239], v[44:47], v[148:151]
s_waitcnt lgkmcnt(2)
v_mfma_f32_16x16x32_f16 v[152:155], v[224:227], v[40:43], v[152:155]
ds_read_b128 v[236:239], v254 offset:7936
v_mfma_f32_16x16x32_f16 v[160:163], v[224:227], v[44:47], v[160:163]
s_waitcnt lgkmcnt(2)
v_mfma_f32_16x16x32_f16 v[156:159], v[228:231], v[40:43], v[156:159]
ds_read_b128 v[224:227], v249 offset:61696
v_mfma_f32_16x16x32_f16 v[164:167], v[228:231], v[44:47], v[164:167]
s_waitcnt lgkmcnt(2)
v_mfma_f32_16x16x32_f16 v[120:123], v[232:235], v[48:51], v[120:123]
s_waitcnt lgkmcnt(1)
ds_read_b128 v[228:231], v254 offset:7952
v_mfma_f32_16x16x32_f16 v[128:131], v[232:235], v[52:55], v[128:131]
v_mfma_f32_16x16x32_f16 v[0:3], v[232:235], v[176:179], v[236:239]
v_mfma_f32_16x16x32_f16 v[8:11], v[232:235], v[180:183], v[236:239]
s_waitcnt lgkmcnt(1)
v_mfma_f32_16x16x32_f16 v[124:127], v[224:227], v[48:51], v[124:127]
s_waitcnt lgkmcnt(0)
ds_read_b128 v[232:235], v249 offset:62464
ds_read_b128 v[236:239], v254 offset:8064
v_mfma_f32_16x16x32_f16 v[132:135], v[224:227], v[52:55], v[132:135]
v_mfma_f32_16x16x32_f16 v[4:7], v[224:227], v[176:179], v[228:231]
v_mfma_f32_16x16x32_f16 v[12:15], v[224:227], v[180:183], v[228:231]
s_waitcnt lgkmcnt(1)
v_mfma_f32_16x16x32_f16 v[136:139], v[232:235], v[48:51], v[136:139]
s_waitcnt lgkmcnt(0)
ds_read_b128 v[224:227], v249 offset:62720
ds_read_b128 v[228:231], v254 offset:8080
v_mfma_f32_16x16x32_f16 v[144:147], v[232:235], v[52:55], v[144:147]
v_mfma_f32_16x16x32_f16 v[16:19], v[232:235], v[176:179], v[236:239]
v_mfma_f32_16x16x32_f16 v[24:27], v[232:235], v[180:183], v[236:239]
s_waitcnt lgkmcnt(1)
v_mfma_f32_16x16x32_f16 v[140:143], v[224:227], v[48:51], v[140:143]
s_waitcnt lgkmcnt(0)
ds_read_b128 v[232:235], v249 offset:63488
ds_read_b128 v[236:239], v254 offset:16128
v_mfma_f32_16x16x32_f16 v[148:151], v[224:227], v[52:55], v[148:151]
v_mfma_f32_16x16x32_f16 v[20:23], v[224:227], v[176:179], v[228:231]
v_mfma_f32_16x16x32_f16 v[28:31], v[224:227], v[180:183], v[228:231]
s_waitcnt lgkmcnt(1)
v_mfma_f32_16x16x32_f16 v[152:155], v[232:235], v[48:51], v[152:155]
s_waitcnt lgkmcnt(0)
ds_read_b128 v[224:227], v249 offset:63744
ds_read_b128 v[228:231], v254 offset:16144
v_mfma_f32_16x16x32_f16 v[160:163], v[232:235], v[52:55], v[160:163]
v_mfma_f32_16x16x32_f16 v[32:35], v[232:235], v[176:179], v[236:239]
v_mfma_f32_16x16x32_f16 v[40:43], v[232:235], v[180:183], v[236:239]
s_waitcnt lgkmcnt(1)
v_mfma_f32_16x16x32_f16 v[156:159], v[224:227], v[48:51], v[156:159]
s_waitcnt lgkmcnt(0)
ds_read_b128 v[232:235], v250 offset:2048
ds_read_b128 v[236:239], v250 offset:2304
v_mfma_f32_16x16x32_f16 v[164:167], v[224:227], v[52:55], v[164:167]
v_mfma_f32_16x16x32_f16 v[36:39], v[224:227], v[176:179], v[228:231]
v_mfma_f32_16x16x32_f16 v[44:47], v[224:227], v[180:183], v[228:231]
s_waitcnt lgkmcnt(1)
v_mfma_f32_16x16x32_f16 v[120:123], v[232:235], v[56:59], v[120:123]
buffer_load_dwordx4 v[48:51], v253, s[32:35], s80 offen
ds_read_b128 v[224:227], v250 offset:3072
ds_read_b128 v[228:231], v250 offset:3328
v_mfma_f32_16x16x32_f16 v[128:131], v[232:235], v[60:63], v[128:131]
v_mfma_f32_16x16x32_f16 v[0:3], v[232:235], v[184:187], v[0:3]
v_mfma_f32_16x16x32_f16 v[8:11], v[232:235], v[188:191], v[8:11]
s_waitcnt lgkmcnt(2)
v_mfma_f32_16x16x32_f16 v[124:127], v[236:239], v[56:59], v[124:127]
ds_read_b128 v[232:235], v250 offset:4096
v_mfma_f32_16x16x32_f16 v[132:135], v[236:239], v[60:63], v[132:135]
v_mfma_f32_16x16x32_f16 v[4:7], v[236:239], v[184:187], v[4:7]
v_mfma_f32_16x16x32_f16 v[12:15], v[236:239], v[188:191], v[12:15]
s_waitcnt lgkmcnt(2)
v_mfma_f32_16x16x32_f16 v[136:139], v[224:227], v[56:59], v[136:139]
buffer_load_dwordx4 v[52:55], v253, s[32:35], s80 offen offset:256
ds_read_b128 v[236:239], v250 offset:4352
v_mfma_f32_16x16x32_f16 v[144:147], v[224:227], v[60:63], v[144:147]
v_mfma_f32_16x16x32_f16 v[16:19], v[224:227], v[184:187], v[16:19]
v_mfma_f32_16x16x32_f16 v[24:27], v[224:227], v[188:191], v[24:27]
s_waitcnt lgkmcnt(2)
v_mfma_f32_16x16x32_f16 v[140:143], v[228:231], v[56:59], v[140:143]
s_add_u32 s46, s80, 4194304
buffer_load_dwordx4 v[176:179], v253, s[32:35], s46 offen
ds_read_b128 v[224:227], v250 offset:8192
v_mfma_f32_16x16x32_f16 v[148:151], v[228:231], v[60:63], v[148:151]
v_mfma_f32_16x16x32_f16 v[20:23], v[228:231], v[184:187], v[20:23]
v_mfma_f32_16x16x32_f16 v[28:31], v[228:231], v[188:191], v[28:31]
s_waitcnt lgkmcnt(2)
v_mfma_f32_16x16x32_f16 v[152:155], v[232:235], v[56:59], v[152:155]
ds_read_b128 v[228:231], v250 offset:8448
v_mfma_f32_16x16x32_f16 v[160:163], v[232:235], v[60:63], v[160:163]
v_mfma_f32_16x16x32_f16 v[32:35], v[232:235], v[184:187], v[32:35]
v_mfma_f32_16x16x32_f16 v[40:43], v[232:235], v[188:191], v[40:43]
s_waitcnt lgkmcnt(2)
v_mfma_f32_16x16x32_f16 v[156:159], v[236:239], v[56:59], v[156:159]
s_add_u32 s46, s80, 4194304
buffer_load_dwordx4 v[180:183], v253, s[32:35], s46 offen offset:256
ds_read_b128 v[232:235], v250 offset:9216
v_mfma_f32_16x16x32_f16 v[164:167], v[236:239], v[60:63], v[164:167]
v_mfma_f32_16x16x32_f16 v[36:39], v[236:239], v[184:187], v[36:39]
v_mfma_f32_16x16x32_f16 v[44:47], v[236:239], v[188:191], v[44:47]
s_waitcnt lgkmcnt(2)
v_mfma_f32_16x16x32_f16 v[120:123], v[224:227], v[64:67], v[120:123]
s_add_u32 s46, s80, 8388608
buffer_load_dwordx4 v[56:59], v253, s[32:35], s46 offen
ds_read_b128 v[236:239], v250 offset:9472
v_mfma_f32_16x16x32_f16 v[128:131], v[224:227], v[68:71], v[128:131]
v_and_b32_e64 v184, 1, v251
v_mfma_f32_16x16x32_f16 v[0:3], v[224:227], v[192:195], v[0:3]
v_mfma_f32_16x16x32_f16 v[8:11], v[224:227], v[196:199], v[8:11]
v_lshlrev_b32 v184, 4, v184
s_waitcnt lgkmcnt(2)
v_mfma_f32_16x16x32_f16 v[124:127], v[228:231], v[64:67], v[124:127]
ds_read_b128 v[224:227], v250 offset:10240
v_mov_b32 v185, 16256
v_mfma_f32_16x16x32_f16 v[132:135], v[228:231], v[68:71], v[132:135]
v_mfma_f32_16x16x32_f16 v[4:7], v[228:231], v[192:195], v[4:7]
v_lshlrev_b32_e64 v184, v184, v185
v_mfma_f32_16x16x32_f16 v[12:15], v[228:231], v[196:199], v[12:15]
v_lshrrev_b32_e64 v185, 2, v251
s_waitcnt lgkmcnt(2)
v_mfma_f32_16x16x32_f16 v[136:139], v[232:235], v[64:67], v[136:139]
ds_read_b128 v[228:231], v250 offset:10496
v_mfma_f32_16x16x32_f16 v[144:147], v[232:235], v[68:71], v[144:147]
v_xor_b32 v185, v185, v251
v_mfma_f32_16x16x32_f16 v[16:19], v[232:235], v[192:195], v[16:19]
v_mfma_f32_16x16x32_f16 v[24:27], v[232:235], v[196:199], v[24:27]
v_and_b32 v185, 12, v185
s_waitcnt lgkmcnt(2)
v_mfma_f32_16x16x32_f16 v[140:143], v[236:239], v[64:67], v[140:143]
s_add_u32 s46, s80, 8388608
buffer_load_dwordx4 v[60:63], v253, s[32:35], s46 offen offset:256
ds_read_b128 v[232:235], v250 offset:14336
v_and_b32_e64 v188, 2, v251
v_mfma_f32_16x16x32_f16 v[148:151], v[236:239], v[68:71], v[148:151]
v_mfma_f32_16x16x32_f16 v[20:23], v[236:239], v[192:195], v[20:23]
v_or_b32_e64 v185, v185, v188
v_mfma_f32_16x16x32_f16 v[28:31], v[236:239], v[196:199], v[28:31]
v_cmp_eq_u32 vcc, 0, v185
s_nop 1
v_cndmask_b32 v186, 0, v184, vcc
s_waitcnt lgkmcnt(2)
v_mfma_f32_16x16x32_f16 v[152:155], v[224:227], v[64:67], v[152:155]
ds_read_b128 v[236:239], v248 offset:16384
v_mfma_f32_16x16x32_f16 v[160:163], v[224:227], v[68:71], v[160:163]
v_cmp_eq_u32 vcc, 2, v185
s_nop 1
v_cndmask_b32 v187, 0, v184, vcc
v_mfma_f32_16x16x32_f16 v[32:35], v[224:227], v[192:195], v[32:35]
v_mfma_f32_16x16x32_f16 v[40:43], v[224:227], v[196:199], v[40:43]
v_mov_b32_e64 v184, 0
s_waitcnt lgkmcnt(2)
v_mfma_f32_16x16x32_f16 v[156:159], v[228:231], v[64:67], v[156:159]
ds_read_b128 v[224:227], v250 offset:14592
v_mov_b32_e64 v185, 0
v_mfma_f32_16x16x32_f16 v[164:167], v[228:231], v[68:71], v[164:167]
v_mfma_f32_16x16x32_f16 v[36:39], v[228:231], v[192:195], v[36:39]
v_mov_b32_e64 v188, 0
v_mfma_f32_16x16x32_f16 v[44:47], v[228:231], v[196:199], v[44:47]
v_mov_b32_e64 v189, 0
s_waitcnt lgkmcnt(2)
v_mfma_f32_16x16x32_f16 v[120:123], v[232:235], v[72:75], v[120:123]
ds_read_b128 v[228:231], v250 offset:15360
v_mfma_f32_16x16x32_f16 v[128:131], v[232:235], v[76:79], v[128:131]
v_mfma_f32_16x16x32_f16 v[0:3], v[232:235], v[200:203], v[0:3]
v_mfma_f32_16x16x32_f16 v[8:11], v[232:235], v[204:207], v[8:11]
s_waitcnt lgkmcnt(2)
v_mfma_f32_16x16x32_bf16 v[64:67], v[236:239], v[96:99], 0
ds_read_b128 v[232:235], v248 offset:16640
v_mfma_f32_16x16x32_bf16 v[192:195], v[236:239], v[100:103], 0
s_waitcnt lgkmcnt(2)
v_mfma_f32_16x16x32_f16 v[124:127], v[224:227], v[72:75], v[124:127]
ds_read_b128 v[236:239], v250 offset:15616
v_mfma_f32_16x16x32_f16 v[132:135], v[224:227], v[76:79], v[132:135]
v_mfma_f32_16x16x32_f16 v[4:7], v[224:227], v[200:203], v[4:7]
v_mfma_f32_16x16x32_f16 v[12:15], v[224:227], v[204:207], v[12:15]
s_waitcnt lgkmcnt(2)
v_mfma_f32_16x16x32_f16 v[136:139], v[228:231], v[72:75], v[136:139]
ds_read_b128 v[224:227], v250 offset:16384
v_mfma_f32_16x16x32_f16 v[144:147], v[228:231], v[76:79], v[144:147]
v_mfma_f32_16x16x32_f16 v[16:19], v[228:231], v[200:203], v[16:19]
v_mfma_f32_16x16x32_f16 v[24:27], v[228:231], v[204:207], v[24:27]
s_waitcnt lgkmcnt(2)
v_mfma_f32_16x16x32_bf16 v[68:71], v[232:235], v[96:99], 0
ds_read_b128 v[228:231], v248 offset:17408
v_mfma_f32_16x16x32_bf16 v[196:199], v[232:235], v[100:103], 0
s_waitcnt lgkmcnt(2)
v_mfma_f32_16x16x32_f16 v[140:143], v[236:239], v[72:75], v[140:143]
ds_read_b128 v[232:235], v250 offset:16640
v_mfma_f32_16x16x32_f16 v[148:151], v[236:239], v[76:79], v[148:151]
v_mfma_f32_16x16x32_f16 v[20:23], v[236:239], v[200:203], v[20:23]
v_mfma_f32_16x16x32_f16 v[28:31], v[236:239], v[204:207], v[28:31]
s_waitcnt lgkmcnt(2)
v_mfma_f32_16x16x32_f16 v[152:155], v[224:227], v[72:75], v[152:155]
ds_read_b128 v[236:239], v250 offset:20480
v_mfma_f32_16x16x32_f16 v[160:163], v[224:227], v[76:79], v[160:163]
v_mfma_f32_16x16x32_f16 v[32:35], v[224:227], v[200:203], v[32:35]
v_mfma_f32_16x16x32_f16 v[40:43], v[224:227], v[204:207], v[40:43]
s_waitcnt lgkmcnt(2)
v_mfma_f32_16x16x32_bf16 v[64:67], v[228:231], v[104:107], v[64:67]
ds_read_b128 v[224:227], v248 offset:17664
v_mfma_f32_16x16x32_bf16 v[192:195], v[228:231], v[108:111], v[192:195]
s_waitcnt lgkmcnt(2)
v_mfma_f32_16x16x32_f16 v[156:159], v[232:235], v[72:75], v[156:159]
ds_read_b128 v[228:231], v250 offset:20736
v_mfma_f32_16x16x32_f16 v[164:167], v[232:235], v[76:79], v[164:167]
v_mfma_f32_16x16x32_f16 v[36:39], v[232:235], v[200:203], v[36:39]
v_mfma_f32_16x16x32_f16 v[44:47], v[232:235], v[204:207], v[44:47]
s_waitcnt vmcnt(7)
v_mfma_f32_16x16x32_bf16 v[120:123], v[186:189], v[240:243], v[120:123]
ds_read_b128 v[232:235], v250 offset:21504
v_mfma_f32_16x16x32_bf16 v[124:127], v[184:187], v[240:243], v[124:127]
s_waitcnt vmcnt(6)
v_mfma_f32_16x16x32_bf16 v[128:131], v[186:189], v[244:247], v[128:131]
v_mfma_f32_16x16x32_bf16 v[132:135], v[184:187], v[244:247], v[132:135]
s_waitcnt lgkmcnt(3)
v_mfma_f32_16x16x32_f16 v[120:123], v[236:239], v[80:83], v[120:123]
buffer_load_dwordx4 v[240:243], v252, s[4:7], s71 offen offset:64
v_mfma_f32_16x16x32_f16 v[128:131], v[236:239], v[84:87], v[128:131]
v_mfma_f32_16x16x32_f16 v[0:3], v[236:239], v[208:211], v[0:3]
v_mfma_f32_16x16x32_f16 v[8:11], v[236:239], v[212:215], v[8:11]
s_waitcnt lgkmcnt(2)
v_mfma_f32_16x16x32_bf16 v[68:71], v[224:227], v[104:107], v[68:71]
ds_read_b128 v[236:239], v248 offset:18432
v_mfma_f32_16x16x32_bf16 v[196:199], v[224:227], v[108:111], v[196:199]
s_waitcnt lgkmcnt(2)
v_mfma_f32_16x16x32_f16 v[124:127], v[228:231], v[80:83], v[124:127]
ds_read_b128 v[224:227], v250 offset:21760
v_mfma_f32_16x16x32_f16 v[132:135], v[228:231], v[84:87], v[132:135]
v_mfma_f32_16x16x32_f16 v[4:7], v[228:231], v[208:211], v[4:7]
v_mfma_f32_16x16x32_f16 v[12:15], v[228:231], v[212:215], v[12:15]
s_waitcnt lgkmcnt(2)
v_mfma_f32_16x16x32_f16 v[136:139], v[232:235], v[80:83], v[136:139]
ds_read_b128 v[228:231], v250 offset:22528
v_mfma_f32_16x16x32_f16 v[144:147], v[232:235], v[84:87], v[144:147]
v_mfma_f32_16x16x32_f16 v[16:19], v[232:235], v[208:211], v[16:19]
v_mfma_f32_16x16x32_f16 v[24:27], v[232:235], v[212:215], v[24:27]
s_waitcnt lgkmcnt(2)
v_mfma_f32_16x16x32_bf16 v[64:67], v[236:239], v[112:115], v[64:67]
ds_read_b128 v[232:235], v248 offset:18688
v_mfma_f32_16x16x32_bf16 v[192:195], v[236:239], v[116:119], v[192:195]
s_waitcnt lgkmcnt(2)
v_mfma_f32_16x16x32_f16 v[140:143], v[224:227], v[80:83], v[140:143]
s_add_u32 s46, s71, 98304
buffer_load_dwordx4 v[244:247], v252, s[4:7], s46 offen offset:64
ds_read_b128 v[236:239], v250 offset:22784
v_mfma_f32_16x16x32_f16 v[148:151], v[224:227], v[84:87], v[148:151]
v_mfma_f32_16x16x32_f16 v[20:23], v[224:227], v[208:211], v[20:23]
v_mfma_f32_16x16x32_f16 v[28:31], v[224:227], v[212:215], v[28:31]
s_waitcnt lgkmcnt(2)
v_mfma_f32_16x16x32_f16 v[152:155], v[228:231], v[80:83], v[152:155]
ds_read_b128 v[224:227], v250 offset:26624
v_mfma_f32_16x16x32_f16 v[160:163], v[228:231], v[84:87], v[160:163]
v_mfma_f32_16x16x32_f16 v[32:35], v[228:231], v[208:211], v[32:35]
v_mfma_f32_16x16x32_f16 v[40:43], v[228:231], v[212:215], v[40:43]
s_waitcnt lgkmcnt(2)
v_mfma_f32_16x16x32_bf16 v[68:71], v[232:235], v[112:115], v[68:71]
ds_read_b128 v[228:231], v250 offset:26880
v_mfma_f32_16x16x32_bf16 v[196:199], v[232:235], v[116:119], v[196:199]
s_waitcnt lgkmcnt(2)
v_mfma_f32_16x16x32_f16 v[156:159], v[236:239], v[80:83], v[156:159]
ds_read_b128 v[232:235], v248 offset:22528
v_mfma_f32_16x16x32_f16 v[164:167], v[236:239], v[84:87], v[164:167]
v_mfma_f32_16x16x32_f16 v[36:39], v[236:239], v[208:211], v[36:39]
v_mfma_f32_16x16x32_f16 v[44:47], v[236:239], v[212:215], v[44:47]
s_setprio 3
s_waitcnt lgkmcnt(2)
v_mfma_f32_16x16x32_f16 v[120:123], v[224:227], v[88:91], v[120:123]
buffer_load_dwordx4 v[84:87], v252, s[4:7], s71 offen offset:128
ds_read_b128 v[236:239], v250 offset:27648
v_cvt_pkrtz_f16_f32 v73, v64, v65
v_mfma_f32_16x16x32_f16 v[128:131], v[224:227], v[92:95], v[128:131]
v_cvt_pkrtz_f16_f32 v75, v66, v67
v_cvt_pkrtz_f16_f32 v77, v68, v69
v_mfma_f32_16x16x32_f16 v[0:3], v[224:227], v[216:219], v[0:3]
v_cvt_pkrtz_f16_f32 v79, v70, v71
v_mfma_f32_16x16x32_f16 v[8:11], v[224:227], v[220:223], v[8:11]
v_cvt_pkrtz_f16_f32 v201, v192, v193
v_cvt_pk_f16_f32 v83, v194, v195
s_waitcnt lgkmcnt(2)
v_mfma_f32_16x16x32_f16 v[124:127], v[228:231], v[88:91], v[124:127]
ds_read_b128 v[224:227], v248 offset:22784
v_cvt_pk_f16_f32 v80, v196, v197
v_mfma_f32_16x16x32_f16 v[132:135], v[228:231], v[92:95], v[132:135]
v_cvt_pk_f16_f32 v205, v198, v199
v_pk_fma_f16 v82, v83, v83, s48
v_mfma_f32_16x16x32_f16 v[4:7], v[228:231], v[216:219], v[4:7]
v_and_b32 v73, s49, v73
v_mfma_f32_16x16x32_f16 v[12:15], v[228:231], v[220:223], v[12:15]
v_pk_fma_f16 v207, v80, v80, s48
v_and_b32 v75, s49, v75
s_waitcnt lgkmcnt(2)
v_mfma_f32_16x16x32_bf16 v[64:67], v[232:235], v[96:99], 0
ds_read_b128 v[228:231], v250 offset:27904
v_pk_fma_f16 v204, v205, v205, s48
v_bfe_u32 v72, v73, 2, 14
v_mfma_f32_16x16x32_bf16 v[192:195], v[232:235], v[100:103], 0
v_pk_mul_f16 v82, v83, v82
s_waitcnt lgkmcnt(2)
v_mfma_f32_16x16x32_f16 v[136:139], v[236:239], v[88:91], v[136:139]
ds_read_b128 v[232:235], v248 offset:23552
ds_read_u16_d16 v72, v72
v_bfe_u32 v74, v75, 2, 14
v_pk_mul_f16 v207, v80, v207
v_mfma_f32_16x16x32_f16 v[144:147], v[236:239], v[92:95], v[144:147]
v_lshrrev_b32 v73, 18, v73
v_mfma_f32_16x16x32_f16 v[16:19], v[236:239], v[216:219], v[16:19]
v_pk_mul_f16 v204, v205, v204
v_lshrrev_b32 v75, 18, v75
v_mfma_f32_16x16x32_f16 v[24:27], v[236:239], v[220:223], v[24:27]
s_waitcnt lgkmcnt(3)
v_mfma_f32_16x16x32_bf16 v[68:71], v[224:227], v[96:99], 0
ds_read_b128 v[236:239], v250 offset:28672
ds_read_u16_d16 v74, v74
ds_read_u16_d16_hi v73, v73
ds_read_u16_d16_hi v75, v75
v_exp_f16 v81, v82
v_and_b32 v77, s49, v77
v_mfma_f32_16x16x32_bf16 v[196:199], v[224:227], v[100:103], 0
v_and_b32 v79, s49, v79
s_waitcnt lgkmcnt(6)
v_mfma_f32_16x16x32_f16 v[140:143], v[228:231], v[88:91], v[140:143]
ds_read_b128 v[224:227], v250 offset:28928
v_exp_f16_e64 v206, v207
v_mfma_f32_16x16x32_f16 v[148:151], v[228:231], v[92:95], v[148:151]
v_bfe_u32 v76, v77, 2, 14
v_bfe_u32 v78, v79, 2, 14
v_mfma_f32_16x16x32_f16 v[20:23], v[228:231], v[216:219], v[20:23]
v_mfma_f32_16x16x32_f16 v[28:31], v[228:231], v[220:223], v[28:31]
v_exp_f16_e64 v203, v204
v_lshrrev_b32 v77, 18, v77
s_waitcnt lgkmcnt(5)
v_mfma_f32_16x16x32_bf16 v[64:67], v[232:235], v[104:107], v[64:67]
ds_read_b128 v[228:231], v248 offset:23808
ds_read_u16_d16 v76, v76
ds_read_u16_d16 v78, v78
ds_read_u16_d16_hi v77, v77
v_lshrrev_b32 v79, 18, v79
v_mfma_f32_16x16x32_bf16 v[192:195], v[232:235], v[108:111], v[192:195]
v_exp_f16_sdwa v81, v82 dst_sel:WORD_1 dst_unused:UNUSED_PRESERVE src0_sel:WORD_1
s_waitcnt lgkmcnt(5)
v_mfma_f32_16x16x32_f16 v[152:155], v[236:239], v[88:91], v[152:155]
ds_read_b128 v[232:235], v248 offset:24576
ds_read_u16_d16_hi v79, v79
v_and_b32_e64 v201, s49, v201
v_mfma_f32_16x16x32_f16 v[160:163], v[236:239], v[92:95], v[160:163]
v_bfe_u32 v200, v201, 2, 14
v_mfma_f32_16x16x32_f16 v[32:35], v[236:239], v[216:219], v[32:35]
v_exp_f16_sdwa v206, v207 dst_sel:WORD_1 dst_unused:UNUSED_PRESERVE src0_sel:WORD_1
v_mfma_f32_16x16x32_f16 v[40:43], v[236:239], v[220:223], v[40:43]
v_lshrrev_b32 v201, 18, v201
s_waitcnt lgkmcnt(6)
v_mfma_f32_16x16x32_f16 v[156:159], v[224:227], v[88:91], v[156:159]
ds_read_b128 v[236:239], v248 offset:24832
ds_read_u16_d16 v200, v200
ds_read_u16_d16_hi v201, v201
v_exp_f16_sdwa v203, v204 dst_sel:WORD_1 dst_unused:UNUSED_PRESERVE src0_sel:WORD_1
v_pk_add_f16 v81, v81, 1.0 op_sel_hi:[1,0]
v_mfma_f32_16x16x32_f16 v[164:167], v[224:227], v[92:95], v[164:167]
v_pk_add_f16 v206, v206, 1.0 op_sel_hi:[1,0]
v_mfma_f32_16x16x32_f16 v[36:39], v[224:227], v[216:219], v[36:39]
v_pk_add_f16 v203, v203, 1.0 op_sel_hi:[1,0]
v_mfma_f32_16x16x32_f16 v[44:47], v[224:227], v[220:223], v[44:47]
v_rcp_f16 v82, v81
s_waitcnt lgkmcnt(5)
v_mfma_f32_16x16x32_bf16 v[68:71], v[228:231], v[104:107], v[68:71]
ds_read_b128 v[224:227], v249 offset:24576
v_rcp_f16 v207, v206
v_mfma_f32_16x16x32_bf16 v[196:199], v[228:231], v[108:111], v[196:199]
s_waitcnt lgkmcnt(4)
v_mfma_f32_16x16x32_bf16 v[64:67], v[232:235], v[112:115], v[64:67]
ds_read_b128 v[228:231], v249 offset:24832
v_rcp_f16 v204, v203
v_mfma_f32_16x16x32_bf16 v[192:195], v[232:235], v[116:119], v[192:195]
v_rcp_f16_sdwa v82, v81 dst_sel:WORD_1 dst_unused:UNUSED_PRESERVE src0_sel:WORD_1
s_waitcnt lgkmcnt(4)
v_mfma_f32_16x16x32_bf16 v[68:71], v[236:239], v[112:115], v[68:71]
ds_read_b128 v[232:235], v248 offset:28672
v_rcp_f16_sdwa v207, v206 dst_sel:WORD_1 dst_unused:UNUSED_PRESERVE src0_sel:WORD_1
v_mfma_f32_16x16x32_bf16 v[196:199], v[236:239], v[116:119], v[196:199]
v_or_b32 v208, v72, v73
v_or_b32 v209, v74, v75
v_or_b32_e64 v210, v76, v77
v_rcp_f16_sdwa v204, v203 dst_sel:WORD_1 dst_unused:UNUSED_PRESERVE src0_sel:WORD_1
v_or_b32 v211, v78, v79
s_waitcnt lgkmcnt(3)
v_or_b32_e64 v212, v200, v201
v_pk_mul_f16 v213, v83, v82
v_pk_mul_f16 v214, v80, v207
v_pk_mul_f16 v215, v205, v204
s_waitcnt lgkmcnt(2)
v_mfma_f32_16x16x32_f16 v[0:3], v[224:227], v[208:211], v[0:3]
s_add_u32 s46, s71, 98304
buffer_load_dwordx4 v[216:219], v252, s[4:7], s46 offen offset:128
ds_read_b128 v[236:239], v249 offset:25600
ds_read_b128 v[88:91], v248 offset:28928
ds_read_b128 v[92:95], v249 offset:25856
v_cvt_pkrtz_f16_f32 v73, v64, v65
v_cvt_pkrtz_f16_f32 v75, v66, v67
v_mfma_f32_16x16x32_f16 v[8:11], v[224:227], v[212:215], v[8:11]
v_cvt_pkrtz_f16_f32 v77, v68, v69
v_cvt_pkrtz_f16_f32 v79, v70, v71
s_waitcnt lgkmcnt(3)
v_mfma_f32_16x16x32_f16 v[4:7], v[228:231], v[208:211], v[4:7]
ds_read_b128 v[224:227], v248 offset:29696
v_cvt_pkrtz_f16_f32 v201, v192, v193
v_cvt_pk_f16_f32 v83, v194, v195
v_mfma_f32_16x16x32_f16 v[12:15], v[228:231], v[212:215], v[12:15]
v_cvt_pk_f16_f32 v80, v196, v197
v_cvt_pk_f16_f32 v205, v198, v199
v_pk_fma_f16 v82, v83, v83, s48
v_mfma_f32_16x16x32_bf16 v[64:67], v[232:235], v[96:99], 0
ds_read_b128 v[228:231], v249 offset:26624
v_cvt_pk_bf16_f32 v128, v128, v129
v_cvt_pk_bf16_f32 v120, v120, v121
v_mfma_f32_16x16x32_bf16 v[192:195], v[232:235], v[100:103], 0
v_and_b32 v73, s49, v73
v_pk_fma_f16 v207, v80, v80, s48
s_waitcnt lgkmcnt(4)
v_mfma_f32_16x16x32_f16 v[16:19], v[236:239], v[208:211], v[16:19]
ds_read_b128 v[232:235], v249 offset:26880
v_and_b32_e64 v75, s49, v75
v_pk_fma_f16 v204, v205, v205, s48
s_setprio 2
v_mfma_f32_16x16x32_f16 v[24:27], v[236:239], v[212:215], v[24:27]
v_bfe_u32 v72, v73, 2, 14
v_pk_mul_f16 v82, v83, v82
v_bfe_u32 v74, v75, 2, 14
s_waitcnt vmcnt(3)
v_mfma_f32_16x16x32_bf16 v[136:139], v[186:189], v[240:243], v[136:139]
ds_read_b128 v[236:239], v248 offset:29952
ds_read_u16_d16 v72, v72
ds_read_u16_d16 v74, v74
v_pk_mul_f16 v207, v80, v207
v_lshrrev_b32 v73, 18, v73
v_mfma_f32_16x16x32_bf16 v[140:143], v[184:187], v[240:243], v[140:143]
v_cvt_pk_bf16_f32 v129, v130, v131
v_cvt_pk_bf16_f32 v121, v122, v123
s_waitcnt lgkmcnt(4)
v_mfma_f32_16x16x32_bf16 v[68:71], v[88:91], v[96:99], 0
ds_read_u16_d16_hi v73, v73
v_pk_mul_f16 v204, v205, v204
v_lshrrev_b32_e64 v75, 18, v75
v_mfma_f32_16x16x32_bf16 v[196:199], v[88:91], v[100:103], 0
v_exp_f16 v81, v82
v_and_b32 v77, s49, v77
v_mfma_f32_16x16x32_f16 v[20:23], v[92:95], v[208:211], v[20:23]
ds_read_b128 v[88:91], v248 offset:30720
ds_read_u16_d16_hi v75, v75
v_and_b32_e64 v79, s49, v79
v_mfma_f32_16x16x32_f16 v[28:31], v[92:95], v[212:215], v[28:31]
v_exp_f16_e64 v206, v207
v_bfe_u32 v76, v77, 2, 14
v_mfma_f32_16x16x32_bf16 v[64:67], v[224:227], v[104:107], v[64:67]
buffer_load_dwordx4 v[220:223], v252, s[4:7], s70 offen
ds_read_b128 v[92:95], v248 offset:30976
ds_read_u16_d16 v76, v76
v_bfe_u32 v78, v79, 2, 14
v_cvt_pk_bf16_f32 v130, v132, v133
v_cvt_pk_bf16_f32 v122, v124, v125
v_mfma_f32_16x16x32_bf16 v[192:195], v[224:227], v[108:111], v[192:195]
v_exp_f16_e64 v203, v204
v_mfma_f32_16x16x32_f16 v[32:35], v[228:231], v[208:211], v[32:35]
ds_read_b128 v[224:227], v249 offset:30720
ds_read_u16_d16 v78, v78
v_lshrrev_b32 v77, 18, v77
v_lshrrev_b32 v79, 18, v79
v_mfma_f32_16x16x32_f16 v[40:43], v[228:231], v[212:215], v[40:43]
v_exp_f16_sdwa v81, v82 dst_sel:WORD_1 dst_unused:UNUSED_PRESERVE src0_sel:WORD_1
v_and_b32 v201, s49, v201
s_waitcnt lgkmcnt(6)
v_mfma_f32_16x16x32_f16 v[36:39], v[232:235], v[208:211], v[36:39]
ds_read_b128 v[228:231], v249 offset:30976
ds_read_u16_d16_hi v77, v77
ds_read_u16_d16_hi v79, v79
v_bfe_u32 v200, v201, 2, 14
v_mfma_f32_16x16x32_f16 v[44:47], v[232:235], v[212:215], v[44:47]
v_exp_f16_sdwa v206, v207 dst_sel:WORD_1 dst_unused:UNUSED_PRESERVE src0_sel:WORD_1
v_cvt_pk_bf16_f32 v131, v134, v135
s_waitcnt vmcnt(3)
v_mfma_f32_16x16x32_bf16 v[144:147], v[186:189], v[244:247], v[144:147]
ds_read_b128 v[232:235], v248 offset:34816
ds_read_u16_d16 v200, v200
s_add_u32 s46, s71, 98304
buffer_store_dwordx4 v[128:131], v252, s[8:11], s46 offen sc1
v_cvt_pk_bf16_f32 v123, v126, v127
v_lshrrev_b32 v201, 18, v201
v_mfma_f32_16x16x32_bf16 v[148:151], v[184:187], v[244:247], v[148:151]
v_exp_f16_sdwa v203, v204 dst_sel:WORD_1 dst_unused:UNUSED_PRESERVE src0_sel:WORD_1
v_pk_add_f16 v81, v81, 1.0 op_sel_hi:[1,0]
v_mfma_f32_16x16x32_bf16 v[68:71], v[236:239], v[104:107], v[68:71]
buffer_store_dwordx4 v[120:123], v252, s[8:11], s71 offen sc1
ds_read_u16_d16_hi v201, v201
v_pk_add_f16 v206, v206, 1.0 op_sel_hi:[1,0]
v_pk_add_f16 v203, v203, 1.0 op_sel_hi:[1,0]
v_mfma_f32_16x16x32_bf16 v[196:199], v[236:239], v[108:111], v[196:199]
v_rcp_f16 v82, v81
s_waitcnt lgkmcnt(5)
v_mfma_f32_16x16x32_bf16 v[64:67], v[88:91], v[112:115], v[64:67]
ds_read_b128 v[236:239], v249 offset:31744
v_rcp_f16_e64 v207, v206
v_mfma_f32_16x16x32_bf16 v[192:195], v[88:91], v[116:119], v[192:195]
v_rcp_f16_e64 v204, v203
v_mfma_f32_16x16x32_bf16 v[68:71], v[92:95], v[112:115], v[68:71]
ds_read_b128 v[88:91], v248 offset:35072
v_rcp_f16_sdwa v82, v81 dst_sel:WORD_1 dst_unused:UNUSED_PRESERVE src0_sel:WORD_1
v_mfma_f32_16x16x32_bf16 v[196:199], v[92:95], v[116:119], v[196:199]
v_rcp_f16_sdwa v207, v206 dst_sel:WORD_1 dst_unused:UNUSED_PRESERVE src0_sel:WORD_1
v_or_b32 v208, v72, v73
v_or_b32 v209, v74, v75
s_waitcnt lgkmcnt(3)
v_or_b32 v210, v76, v77
v_rcp_f16_sdwa v204, v203 dst_sel:WORD_1 dst_unused:UNUSED_PRESERVE src0_sel:WORD_1
v_or_b32 v211, v78, v79
s_waitcnt lgkmcnt(2)
v_or_b32_e64 v212, v200, v201
v_pk_mul_f16 v213, v83, v82
v_pk_mul_f16 v214, v80, v207
v_pk_mul_f16 v215, v205, v204
v_mfma_f32_16x16x32_f16 v[0:3], v[224:227], v[208:211], v[0:3]
ds_read_b128 v[92:95], v249 offset:32000
v_cvt_pkrtz_f16_f32 v73, v64, v65
v_cvt_pkrtz_f16_f32 v75, v66, v67
v_mfma_f32_16x16x32_f16 v[8:11], v[224:227], v[212:215], v[8:11]
v_cvt_pkrtz_f16_f32 v77, v68, v69
v_cvt_pkrtz_f16_f32 v79, v70, v71
v_mfma_f32_16x16x32_f16 v[4:7], v[228:231], v[208:211], v[4:7]
ds_read_b128 v[224:227], v248 offset:35840
v_cvt_pkrtz_f16_f32 v201, v192, v193
v_cvt_pk_f16_f32 v83, v194, v195
v_mfma_f32_16x16x32_f16 v[12:15], v[228:231], v[212:215], v[12:15]
v_cvt_pk_f16_f32 v80, v196, v197
v_cvt_pk_f16_f32 v205, v198, v199
s_setprio 1
v_pk_fma_f16 v82, v83, v83, s48
v_mfma_f32_16x16x32_bf16 v[64:67], v[232:235], v[96:99], 0
ds_read_b128 v[228:231], v249 offset:32768
v_cvt_pk_bf16_f32 v136, v136, v137
v_and_b32 v73, s49, v73
v_mfma_f32_16x16x32_bf16 v[192:195], v[232:235], v[100:103], 0
v_pk_fma_f16 v207, v80, v80, s48
v_and_b32 v75, s49, v75
s_waitcnt lgkmcnt(3)
v_mfma_f32_16x16x32_f16 v[16:19], v[236:239], v[208:211], v[16:19]
ds_read_b128 v[232:235], v249 offset:33024
v_pk_fma_f16 v204, v205, v205, s48
v_bfe_u32 v72, v73, 2, 14
v_pk_mul_f16 v82, v83, v82
v_mfma_f32_16x16x32_f16 v[24:27], v[236:239], v[212:215], v[24:27]
v_bfe_u32 v74, v75, 2, 14
v_pk_mul_f16 v207, v80, v207
s_waitcnt vmcnt(4)
v_mfma_f32_16x16x32_bf16 v[152:155], v[186:189], v[84:87], v[152:155]
ds_read_b128 v[236:239], v248 offset:36096
ds_read_u16_d16 v72, v72
ds_read_u16_d16 v74, v74
v_lshrrev_b32 v73, 18, v73
v_cvt_pk_bf16_f32 v137, v138, v139
v_mfma_f32_16x16x32_bf16 v[156:159], v[184:187], v[84:87], v[156:159]
v_pk_mul_f16 v204, v205, v204
v_lshrrev_b32_e64 v75, 18, v75
v_mfma_f32_16x16x32_bf16 v[68:71], v[88:91], v[96:99], 0
ds_read_u16_d16_hi v73, v73
ds_read_u16_d16_hi v75, v75
v_exp_f16 v81, v82
v_and_b32 v77, s49, v77
v_mfma_f32_16x16x32_bf16 v[196:199], v[88:91], v[100:103], 0
v_and_b32 v79, s49, v79
s_waitcnt lgkmcnt(6)
v_mfma_f32_16x16x32_f16 v[20:23], v[92:95], v[208:211], v[20:23]
ds_read_b128 v[88:91], v248 offset:36864
v_exp_f16_e64 v206, v207
v_bfe_u32 v76, v77, 2, 14
v_mfma_f32_16x16x32_f16 v[28:31], v[92:95], v[212:215], v[28:31]
v_bfe_u32 v78, v79, 2, 14
v_cvt_pk_bf16_f32 v138, v140, v141
v_mfma_f32_16x16x32_bf16 v[64:67], v[224:227], v[104:107], v[64:67]
ds_read_b128 v[92:95], v248 offset:37120
ds_read_u16_d16 v76, v76
ds_read_u16_d16 v78, v78
v_exp_f16 v203, v204
v_lshrrev_b32 v77, 18, v77
v_mfma_f32_16x16x32_bf16 v[192:195], v[224:227], v[108:111], v[192:195]
v_lshrrev_b32_e64 v79, 18, v79
v_mfma_f32_16x16x32_f16 v[32:35], v[228:231], v[208:211], v[32:35]
ds_read_b128 v[224:227], v249 offset:36864
ds_read_u16_d16_hi v77, v77
ds_read_u16_d16_hi v79, v79
v_exp_f16_sdwa v81, v82 dst_sel:WORD_1 dst_unused:UNUSED_PRESERVE src0_sel:WORD_1
v_and_b32 v201, s49, v201
v_bfe_u32 v200, v201, 2, 14
v_mfma_f32_16x16x32_f16 v[40:43], v[228:231], v[212:215], v[40:43]
v_exp_f16_sdwa v206, v207 dst_sel:WORD_1 dst_unused:UNUSED_PRESERVE src0_sel:WORD_1
s_waitcnt lgkmcnt(7)
v_mfma_f32_16x16x32_f16 v[36:39], v[232:235], v[208:211], v[36:39]
ds_read_b128 v[228:231], v249 offset:37120
ds_read_u16_d16 v200, v200
v_cvt_pk_bf16_f32 v139, v142, v143
v_lshrrev_b32_e64 v201, 18, v201
v_mfma_f32_16x16x32_f16 v[44:47], v[232:235], v[212:215], v[44:47]
v_exp_f16_sdwa v203, v204 dst_sel:WORD_1 dst_unused:UNUSED_PRESERVE src0_sel:WORD_1
v_pk_add_f16 v81, v81, 1.0 op_sel_hi:[1,0]
v_mfma_f32_16x16x32_bf16 v[68:71], v[236:239], v[104:107], v[68:71]
ds_read_b128 v[232:235], v248 offset:40960
buffer_store_dwordx4 v[136:139], v252, s[8:11], s71 offen offset:64 sc1
ds_read_u16_d16_hi v201, v201
v_pk_add_f16 v206, v206, 1.0 op_sel_hi:[1,0]
v_pk_add_f16 v203, v203, 1.0 op_sel_hi:[1,0]
s_setprio 0
v_mfma_f32_16x16x32_bf16 v[196:199], v[236:239], v[108:111], v[196:199]
v_rcp_f16_e64 v82, v81
s_waitcnt lgkmcnt(5)
v_mfma_f32_16x16x32_bf16 v[64:67], v[88:91], v[112:115], v[64:67]
ds_read_b128 v[236:239], v249 offset:37888
v_rcp_f16_e64 v207, v206
v_mfma_f32_16x16x32_bf16 v[192:195], v[88:91], v[116:119], v[192:195]
v_rcp_f16_e64 v204, v203
v_mfma_f32_16x16x32_bf16 v[68:71], v[92:95], v[112:115], v[68:71]
ds_read_b128 v[88:91], v248 offset:41216
v_rcp_f16_sdwa v82, v81 dst_sel:WORD_1 dst_unused:UNUSED_PRESERVE src0_sel:WORD_1
v_mfma_f32_16x16x32_bf16 v[196:199], v[92:95], v[116:119], v[196:199]
v_rcp_f16_sdwa v207, v206 dst_sel:WORD_1 dst_unused:UNUSED_PRESERVE src0_sel:WORD_1
v_or_b32 v208, v72, v73
v_or_b32 v209, v74, v75
v_or_b32 v210, v76, v77
v_rcp_f16_sdwa v204, v203 dst_sel:WORD_1 dst_unused:UNUSED_PRESERVE src0_sel:WORD_1
s_waitcnt lgkmcnt(4)
v_or_b32 v211, v78, v79
s_waitcnt lgkmcnt(2)
v_or_b32 v212, v200, v201
v_pk_mul_f16 v213, v83, v82
v_pk_mul_f16 v214, v80, v207
v_pk_mul_f16 v215, v205, v204
s_setprio 3
v_mfma_f32_16x16x32_f16 v[0:3], v[224:227], v[208:211], v[0:3]
s_add_u32 s46, s70, 98304
buffer_load_dwordx4 v[240:243], v252, s[4:7], s46 offen
ds_read_b128 v[92:95], v249 offset:38144
v_cvt_pkrtz_f16_f32 v73, v64, v65
v_cvt_pkrtz_f16_f32 v75, v66, v67
v_mfma_f32_16x16x32_f16 v[8:11], v[224:227], v[212:215], v[8:11]
v_cvt_pkrtz_f16_f32 v77, v68, v69
v_cvt_pkrtz_f16_f32 v79, v70, v71
v_mfma_f32_16x16x32_f16 v[4:7], v[228:231], v[208:211], v[4:7]
ds_read_b128 v[224:227], v248 offset:41984
v_cvt_pkrtz_f16_f32 v201, v192, v193
v_cvt_pk_f16_f32 v83, v194, v195
v_cvt_pk_f16_f32 v80, v196, v197
v_mfma_f32_16x16x32_f16 v[12:15], v[228:231], v[212:215], v[12:15]
v_cvt_pk_f16_f32 v205, v198, v199
v_pk_fma_f16 v82, v83, v83, s48
v_mfma_f32_16x16x32_bf16 v[64:67], v[232:235], v[96:99], 0
ds_read_b128 v[228:231], v249 offset:38912
v_cvt_pk_bf16_f32 v152, v152, v153
v_cvt_pk_bf16_f32 v144, v144, v145
v_and_b32_e64 v73, s49, v73
v_mfma_f32_16x16x32_bf16 v[192:195], v[232:235], v[100:103], 0
v_pk_fma_f16 v207, v80, v80, s48
v_and_b32 v75, s49, v75
s_waitcnt lgkmcnt(3)
v_mfma_f32_16x16x32_f16 v[16:19], v[236:239], v[208:211], v[16:19]
ds_read_b128 v[232:235], v249 offset:39168
v_pk_fma_f16 v204, v205, v205, s48
v_bfe_u32 v72, v73, 2, 14
v_pk_mul_f16 v82, v83, v82
v_mfma_f32_16x16x32_f16 v[24:27], v[236:239], v[212:215], v[24:27]
v_bfe_u32 v74, v75, 2, 14
v_pk_mul_f16 v207, v80, v207
s_waitcnt vmcnt(5)
v_mfma_f32_16x16x32_bf16 v[160:163], v[186:189], v[216:219], v[160:163]
ds_read_b128 v[236:239], v248 offset:42240
ds_read_u16_d16 v72, v72
ds_read_u16_d16 v74, v74
v_lshrrev_b32 v73, 18, v73
v_cvt_pk_bf16_f32 v153, v154, v155
v_cvt_pk_bf16_f32 v145, v146, v147
v_mfma_f32_16x16x32_bf16 v[164:167], v[184:187], v[216:219], v[164:167]
v_pk_mul_f16 v204, v205, v204
v_lshrrev_b32_e64 v75, 18, v75
v_mfma_f32_16x16x32_bf16 v[68:71], v[88:91], v[96:99], 0
ds_read_u16_d16_hi v73, v73
ds_read_u16_d16_hi v75, v75
v_exp_f16 v81, v82
v_and_b32 v77, s49, v77
v_mfma_f32_16x16x32_bf16 v[196:199], v[88:91], v[100:103], 0
v_and_b32 v79, s49, v79
s_waitcnt lgkmcnt(5)
v_mfma_f32_16x16x32_f16 v[20:23], v[92:95], v[208:211], v[20:23]
ds_read_b128 v[88:91], v248 offset:43008
v_exp_f16_e64 v206, v207
v_bfe_u32 v76, v77, 2, 14
v_bfe_u32 v78, v79, 2, 14
v_mfma_f32_16x16x32_f16 v[28:31], v[92:95], v[212:215], v[28:31]
v_cvt_pk_bf16_f32 v154, v156, v157
v_cvt_pk_bf16_f32 v146, v148, v149
v_mfma_f32_16x16x32_bf16 v[64:67], v[224:227], v[104:107], v[64:67]
ds_read_b128 v[92:95], v248 offset:43264
ds_read_u16_d16 v76, v76
ds_read_u16_d16 v78, v78
v_exp_f16_e64 v203, v204
v_mfma_f32_16x16x32_bf16 v[192:195], v[224:227], v[108:111], v[192:195]
v_lshrrev_b32 v77, 18, v77
v_lshrrev_b32 v79, 18, v79
v_mfma_f32_16x16x32_f16 v[32:35], v[228:231], v[208:211], v[32:35]
ds_read_b128 v[224:227], v249 offset:43008
ds_read_u16_d16_hi v77, v77
ds_read_u16_d16_hi v79, v79
v_exp_f16_sdwa v81, v82 dst_sel:WORD_1 dst_unused:UNUSED_PRESERVE src0_sel:WORD_1
v_and_b32_e64 v201, s49, v201
v_mfma_f32_16x16x32_f16 v[40:43], v[228:231], v[212:215], v[40:43]
v_bfe_u32 v200, v201, 2, 14
v_exp_f16_sdwa v206, v207 dst_sel:WORD_1 dst_unused:UNUSED_PRESERVE src0_sel:WORD_1
v_mfma_f32_16x16x32_f16 v[36:39], v[232:235], v[208:211], v[36:39]
ds_read_b128 v[228:231], v249 offset:43264
ds_read_u16_d16 v200, v200
v_cvt_pk_bf16_f32 v155, v158, v159
v_cvt_pk_bf16_f32 v147, v150, v151
v_mfma_f32_16x16x32_f16 v[44:47], v[232:235], v[212:215], v[44:47]
v_lshrrev_b32 v201, 18, v201
v_exp_f16_sdwa v203, v204 dst_sel:WORD_1 dst_unused:UNUSED_PRESERVE src0_sel:WORD_1
s_waitcnt lgkmcnt(8)
v_mfma_f32_16x16x32_bf16 v[68:71], v[236:239], v[104:107], v[68:71]
ds_read_b128 v[232:235], v248 offset:47104
buffer_store_dwordx4 v[152:155], v252, s[8:11], s71 offen offset:128 sc1
s_add_u32 s46, s71, 98304
buffer_store_dwordx4 v[144:147], v252, s[8:11], s46 offen offset:64 sc1
ds_read_u16_d16_hi v201, v201
v_pk_add_f16 v81, v81, 1.0 op_sel_hi:[1,0]
v_pk_add_f16 v206, v206, 1.0 op_sel_hi:[1,0]
v_mfma_f32_16x16x32_bf16 v[196:199], v[236:239], v[108:111], v[196:199]
v_pk_add_f16 v203, v203, 1.0 op_sel_hi:[1,0]
v_rcp_f16_e64 v82, v81
v_mfma_f32_16x16x32_bf16 v[64:67], v[88:91], v[112:115], v[64:67]
ds_read_b128 v[236:239], v249 offset:44032
v_rcp_f16_e64 v207, v206
v_mfma_f32_16x16x32_bf16 v[192:195], v[88:91], v[116:119], v[192:195]
v_rcp_f16 v204, v203
s_waitcnt lgkmcnt(5)
v_mfma_f32_16x16x32_bf16 v[68:71], v[92:95], v[112:115], v[68:71]
ds_read_b128 v[88:91], v248 offset:47360
v_rcp_f16_sdwa v82, v81 dst_sel:WORD_1 dst_unused:UNUSED_PRESERVE src0_sel:WORD_1
v_mfma_f32_16x16x32_bf16 v[196:199], v[92:95], v[116:119], v[196:199]
v_rcp_f16_sdwa v207, v206 dst_sel:WORD_1 dst_unused:UNUSED_PRESERVE src0_sel:WORD_1
v_or_b32 v208, v72, v73
v_or_b32 v209, v74, v75
v_or_b32_e64 v210, v76, v77
v_rcp_f16_sdwa v204, v203 dst_sel:WORD_1 dst_unused:UNUSED_PRESERVE src0_sel:WORD_1
v_or_b32 v211, v78, v79
s_waitcnt lgkmcnt(2)
v_or_b32_e64 v212, v200, v201
v_pk_mul_f16 v213, v83, v82
v_pk_mul_f16 v214, v80, v207
v_pk_mul_f16 v215, v205, v204
v_mfma_f32_16x16x32_f16 v[0:3], v[224:227], v[208:211], v[0:3]
s_add_u32 s46, s80, 12582912
buffer_load_dwordx4 v[96:99], v253, s[32:35], s46 offen
ds_read_b128 v[92:95], v249 offset:44288
v_cvt_pkrtz_f16_f32 v73, v64, v65
v_cvt_pkrtz_f16_f32 v75, v66, v67
v_mfma_f32_16x16x32_f16 v[8:11], v[224:227], v[212:215], v[8:11]
v_cvt_pkrtz_f16_f32 v77, v68, v69
v_cvt_pkrtz_f16_f32 v79, v70, v71
v_cvt_pkrtz_f16_f32 v201, v192, v193
v_mfma_f32_16x16x32_f16 v[4:7], v[228:231], v[208:211], v[4:7]
ds_read_b128 v[224:227], v248 offset:48128
v_cvt_pk_f16_f32 v83, v194, v195
v_cvt_pk_f16_f32 v80, v196, v197
v_mfma_f32_16x16x32_f16 v[12:15], v[228:231], v[212:215], v[12:15]
v_cvt_pk_f16_f32 v205, v198, v199
v_pk_fma_f16 v82, v83, v83, s48
v_cvt_pk_bf16_f32 v160, v160, v161
v_mfma_f32_16x16x32_bf16 v[64:67], v[232:235], v[48:51], 0
ds_read_b128 v[228:231], v249 offset:45056
v_and_b32_e64 v73, s49, v73
v_pk_fma_f16 v207, v80, v80, s48
v_mfma_f32_16x16x32_bf16 v[192:195], v[232:235], v[52:55], 0
v_and_b32_e64 v75, s49, v75
v_pk_fma_f16 v204, v205, v205, s48
s_setprio 2
v_bfe_u32 v72, v73, 2, 14
s_waitcnt lgkmcnt(3)
v_mfma_f32_16x16x32_f16 v[16:19], v[236:239], v[208:211], v[16:19]
ds_read_b128 v[232:235], v249 offset:45312
ds_read_u16_d16 v72, v72
v_pk_mul_f16 v82, v83, v82
v_bfe_u32 v74, v75, 2, 14
v_mfma_f32_16x16x32_f16 v[24:27], v[236:239], v[212:215], v[24:27]
v_pk_mul_f16 v207, v80, v207
v_lshrrev_b32_e64 v73, 18, v73
v_cvt_pk_bf16_f32 v161, v162, v163
v_mfma_f32_16x16x32_bf16 v[68:71], v[88:91], v[48:51], 0
ds_read_b128 v[236:239], v248 offset:48384
ds_read_u16_d16 v74, v74
ds_read_u16_d16_hi v73, v73
v_pk_mul_f16 v204, v205, v204
v_lshrrev_b32_e64 v75, 18, v75
v_mfma_f32_16x16x32_bf16 v[196:199], v[88:91], v[52:55], 0
v_exp_f16_e64 v81, v82
v_and_b32 v77, s49, v77
s_waitcnt lgkmcnt(5)
v_mfma_f32_16x16x32_f16 v[20:23], v[92:95], v[208:211], v[20:23]
ds_read_b128 v[88:91], v248 offset:49152
ds_read_u16_d16_hi v75, v75
v_and_b32_e64 v79, s49, v79
v_mfma_f32_16x16x32_f16 v[28:31], v[92:95], v[212:215], v[28:31]
v_exp_f16_e64 v206, v207
v_bfe_u32 v76, v77, 2, 14
v_bfe_u32 v78, v79, 2, 14
v_mfma_f32_16x16x32_bf16 v[64:67], v[224:227], v[176:179], v[64:67]
ds_read_b128 v[92:95], v248 offset:49408
ds_read_u16_d16 v76, v76
ds_read_u16_d16 v78, v78
v_cvt_pk_bf16_f32 v162, v164, v165
v_mfma_f32_16x16x32_bf16 v[192:195], v[224:227], v[180:183], v[192:195]
v_exp_f16 v203, v204
v_lshrrev_b32 v77, 18, v77
v_lshrrev_b32_e64 v79, 18, v79
v_mfma_f32_16x16x32_f16 v[32:35], v[228:231], v[208:211], v[32:35]
ds_read_b128 v[224:227], v249 offset:49152
ds_read_u16_d16_hi v77, v77
ds_read_u16_d16_hi v79, v79
v_exp_f16_sdwa v81, v82 dst_sel:WORD_1 dst_unused:UNUSED_PRESERVE src0_sel:WORD_1
v_mfma_f32_16x16x32_f16 v[40:43], v[228:231], v[212:215], v[40:43]
v_and_b32 v201, s49, v201
v_bfe_u32 v200, v201, 2, 14
s_waitcnt lgkmcnt(8)
v_mfma_f32_16x16x32_f16 v[36:39], v[232:235], v[208:211], v[36:39]
ds_read_b128 v[228:231], v249 offset:49408
ds_read_u16_d16 v200, v200
v_exp_f16_sdwa v206, v207 dst_sel:WORD_1 dst_unused:UNUSED_PRESERVE src0_sel:WORD_1
v_cvt_pk_bf16_f32 v163, v166, v167
v_mfma_f32_16x16x32_f16 v[44:47], v[232:235], v[212:215], v[44:47]
v_lshrrev_b32_e64 v201, 18, v201
v_exp_f16_sdwa v203, v204 dst_sel:WORD_1 dst_unused:UNUSED_PRESERVE src0_sel:WORD_1
v_mfma_f32_16x16x32_bf16 v[68:71], v[236:239], v[176:179], v[68:71]
ds_read_b128 v[232:235], v248 offset:16384
s_add_u32 s46, s71, 98304
buffer_store_dwordx4 v[160:163], v252, s[8:11], s46 offen offset:128 sc1
ds_read_u16_d16_hi v201, v201
v_pk_add_f16 v81, v81, 1.0 op_sel_hi:[1,0]
v_pk_add_f16 v206, v206, 1.0 op_sel_hi:[1,0]
v_mfma_f32_16x16x32_bf16 v[196:199], v[236:239], v[180:183], v[196:199]
v_pk_add_f16 v203, v203, 1.0 op_sel_hi:[1,0]
v_rcp_f16 v82, v81
s_waitcnt lgkmcnt(5)
v_mfma_f32_16x16x32_bf16 v[64:67], v[88:91], v[56:59], v[64:67]
ds_read_b128 v[236:239], v249 offset:50176
v_rcp_f16_e64 v207, v206
v_mfma_f32_16x16x32_bf16 v[192:195], v[88:91], v[60:63], v[192:195]
v_rcp_f16_e64 v204, v203
v_mfma_f32_16x16x32_bf16 v[68:71], v[92:95], v[56:59], v[68:71]
ds_read_b128 v[88:91], v248 offset:16640
v_rcp_f16_sdwa v82, v81 dst_sel:WORD_1 dst_unused:UNUSED_PRESERVE src0_sel:WORD_1
v_mfma_f32_16x16x32_bf16 v[196:199], v[92:95], v[60:63], v[196:199]
v_rcp_f16_sdwa v207, v206 dst_sel:WORD_1 dst_unused:UNUSED_PRESERVE src0_sel:WORD_1
v_or_b32 v208, v72, v73
v_or_b32 v209, v74, v75
v_or_b32_e64 v210, v76, v77
v_rcp_f16_sdwa v204, v203 dst_sel:WORD_1 dst_unused:UNUSED_PRESERVE src0_sel:WORD_1
s_waitcnt lgkmcnt(4)
v_or_b32 v211, v78, v79
s_waitcnt lgkmcnt(2)
v_or_b32 v212, v200, v201
v_pk_mul_f16 v213, v83, v82
v_pk_mul_f16 v214, v80, v207
v_pk_mul_f16 v215, v205, v204
v_mfma_f32_16x16x32_f16 v[0:3], v[224:227], v[208:211], v[0:3]
buffer_load_dwordx4 v[244:247], v252, s[4:7], s70 offen offset:64
ds_read_b128 v[92:95], v249 offset:50432
v_cvt_pkrtz_f16_f32 v73, v64, v65
v_cvt_pkrtz_f16_f32 v75, v66, v67
v_mfma_f32_16x16x32_f16 v[8:11], v[224:227], v[212:215], v[8:11]
v_cvt_pkrtz_f16_f32 v77, v68, v69
v_cvt_pkrtz_f16_f32 v79, v70, v71
v_mfma_f32_16x16x32_f16 v[4:7], v[228:231], v[208:211], v[4:7]
ds_read_b128 v[224:227], v248 offset:17408
v_cvt_pkrtz_f16_f32 v201, v192, v193
v_cvt_pk_f16_f32 v83, v194, v195
v_cvt_pk_f16_f32 v80, v196, v197
v_mfma_f32_16x16x32_f16 v[12:15], v[228:231], v[212:215], v[12:15]
v_cvt_pk_f16_f32 v205, v198, v199
s_setprio 1
v_pk_fma_f16 v82, v83, v83, s48
v_mfma_f32_16x16x32_bf16 v[64:67], v[232:235], v[48:51], 0
ds_read_b128 v[228:231], v249 offset:51200
v_and_b32 v73, s49, v73
v_pk_fma_f16 v207, v80, v80, s48
v_mfma_f32_16x16x32_bf16 v[192:195], v[232:235], v[52:55], 0
v_and_b32 v75, s49, v75
v_pk_fma_f16 v204, v205, v205, s48
v_bfe_u32 v72, v73, 2, 14
s_waitcnt lgkmcnt(3)
v_mfma_f32_16x16x32_f16 v[16:19], v[236:239], v[208:211], v[16:19]
ds_read_b128 v[232:235], v249 offset:51456
ds_read_u16_d16 v72, v72
v_pk_mul_f16 v82, v83, v82
v_bfe_u32 v74, v75, 2, 14
v_mfma_f32_16x16x32_f16 v[24:27], v[236:239], v[212:215], v[24:27]
v_pk_mul_f16 v207, v80, v207
v_lshrrev_b32_e64 v73, 18, v73
v_mfma_f32_16x16x32_bf16 v[68:71], v[88:91], v[48:51], 0
ds_read_b128 v[236:239], v248 offset:17664
ds_read_u16_d16 v74, v74
ds_read_u16_d16_hi v73, v73
v_pk_mul_f16 v204, v205, v204
v_lshrrev_b32_e64 v75, 18, v75
v_mfma_f32_16x16x32_bf16 v[196:199], v[88:91], v[52:55], 0
v_exp_f16_e64 v81, v82
v_and_b32 v77, s49, v77
s_waitcnt lgkmcnt(5)
v_mfma_f32_16x16x32_f16 v[20:23], v[92:95], v[208:211], v[20:23]
ds_read_b128 v[88:91], v248 offset:18432
ds_read_u16_d16_hi v75, v75
v_and_b32_e64 v79, s49, v79
v_mfma_f32_16x16x32_f16 v[28:31], v[92:95], v[212:215], v[28:31]
v_exp_f16_e64 v206, v207
v_bfe_u32 v76, v77, 2, 14
v_bfe_u32 v78, v79, 2, 14
v_mfma_f32_16x16x32_bf16 v[64:67], v[224:227], v[176:179], v[64:67]
s_add_u32 s46, s80, 12582912
buffer_load_dwordx4 v[100:103], v253, s[32:35], s46 offen offset:256
ds_read_b128 v[92:95], v248 offset:18688
ds_read_u16_d16 v76, v76
ds_read_u16_d16 v78, v78
v_exp_f16_e64 v203, v204
v_mfma_f32_16x16x32_bf16 v[192:195], v[224:227], v[180:183], v[192:195]
v_lshrrev_b32 v77, 18, v77
v_lshrrev_b32 v79, 18, v79
v_mfma_f32_16x16x32_f16 v[32:35], v[228:231], v[208:211], v[32:35]
ds_read_b128 v[224:227], v249 offset:55296
ds_read_u16_d16_hi v77, v77
ds_read_u16_d16_hi v79, v79
v_exp_f16_sdwa v81, v82 dst_sel:WORD_1 dst_unused:UNUSED_PRESERVE src0_sel:WORD_1
v_and_b32 v201, s49, v201
v_mfma_f32_16x16x32_f16 v[40:43], v[228:231], v[212:215], v[40:43]
v_bfe_u32 v200, v201, 2, 14
s_waitcnt lgkmcnt(7)
v_mfma_f32_16x16x32_f16 v[36:39], v[232:235], v[208:211], v[36:39]
ds_read_b128 v[228:231], v254 offset:7936
ds_read_u16_d16 v200, v200
v_exp_f16_sdwa v206, v207 dst_sel:WORD_1 dst_unused:UNUSED_PRESERVE src0_sel:WORD_1
v_lshrrev_b32_e64 v201, 18, v201
v_mfma_f32_16x16x32_f16 v[44:47], v[232:235], v[212:215], v[44:47]
v_exp_f16_sdwa v203, v204 dst_sel:WORD_1 dst_unused:UNUSED_PRESERVE src0_sel:WORD_1
v_pk_add_f16 v81, v81, 1.0 op_sel_hi:[1,0]
v_mfma_f32_16x16x32_bf16 v[68:71], v[236:239], v[176:179], v[68:71]
ds_read_b128 v[232:235], v249 offset:55552
ds_read_u16_d16_hi v201, v201
v_pk_add_f16 v206, v206, 1.0 op_sel_hi:[1,0]
v_pk_add_f16 v203, v203, 1.0 op_sel_hi:[1,0]
v_mfma_f32_16x16x32_bf16 v[196:199], v[236:239], v[180:183], v[196:199]
v_rcp_f16 v82, v81
s_setprio 0
v_mfma_f32_16x16x32_bf16 v[64:67], v[88:91], v[56:59], v[64:67]
ds_read_b128 v[236:239], v254 offset:7952
v_rcp_f16_e64 v207, v206
v_mfma_f32_16x16x32_bf16 v[192:195], v[88:91], v[60:63], v[192:195]
v_rcp_f16 v204, v203
s_waitcnt lgkmcnt(5)
v_mfma_f32_16x16x32_bf16 v[68:71], v[92:95], v[56:59], v[68:71]
ds_read_b128 v[88:91], v248 offset:22528
v_rcp_f16_sdwa v82, v81 dst_sel:WORD_1 dst_unused:UNUSED_PRESERVE src0_sel:WORD_1
v_mfma_f32_16x16x32_bf16 v[196:199], v[92:95], v[60:63], v[196:199]
v_rcp_f16_sdwa v207, v206 dst_sel:WORD_1 dst_unused:UNUSED_PRESERVE src0_sel:WORD_1
v_or_b32 v208, v72, v73
v_or_b32 v209, v74, v75
v_or_b32_e64 v210, v76, v77
v_rcp_f16_sdwa v204, v203 dst_sel:WORD_1 dst_unused:UNUSED_PRESERVE src0_sel:WORD_1
v_or_b32 v211, v78, v79
s_waitcnt lgkmcnt(2)
v_or_b32_e64 v212, v200, v201
v_pk_mul_f16 v213, v83, v82
v_pk_mul_f16 v214, v80, v207
v_pk_mul_f16 v215, v205, v204
s_setprio 3
v_mfma_f32_16x16x32_f16 v[120:123], v[224:227], v[208:211], v[228:231]
ds_read_b128 v[92:95], v249 offset:56320
v_cvt_pkrtz_f16_f32 v73, v64, v65
v_mfma_f32_16x16x32_f16 v[128:131], v[224:227], v[212:215], v[228:231]
v_cvt_pkrtz_f16_f32 v75, v66, v67
v_mfma_f32_16x16x32_f16 v[0:3], v[224:227], v[168:171], v[0:3]
v_cvt_pkrtz_f16_f32 v77, v68, v69
v_cvt_pkrtz_f16_f32 v79, v70, v71
v_mfma_f32_16x16x32_f16 v[8:11], v[224:227], v[172:175], v[8:11]
v_cvt_pkrtz_f16_f32 v201, v192, v193
s_waitcnt lgkmcnt(1)
v_mfma_f32_16x16x32_f16 v[124:127], v[232:235], v[208:211], v[236:239]
ds_read_b128 v[224:227], v254 offset:8064
ds_read_b128 v[228:231], v248 offset:22784
v_cvt_pk_f16_f32 v83, v194, v195
v_cvt_pk_f16_f32 v80, v196, v197
v_mfma_f32_16x16x32_f16 v[132:135], v[232:235], v[212:215], v[236:239]
v_cvt_pk_f16_f32 v205, v198, v199
v_mfma_f32_16x16x32_f16 v[4:7], v[232:235], v[168:171], v[4:7]
v_pk_fma_f16 v82, v83, v83, s48
v_and_b32_e64 v73, s49, v73
v_mfma_f32_16x16x32_f16 v[12:15], v[232:235], v[172:175], v[12:15]
v_pk_fma_f16 v207, v80, v80, s48
v_mfma_f32_16x16x32_bf16 v[64:67], v[88:91], v[48:51], 0
ds_read_b128 v[232:235], v249 offset:56576
ds_read_b128 v[236:239], v254 offset:8080
v_and_b32 v75, s49, v75
v_pk_fma_f16 v204, v205, v205, s48
v_mfma_f32_16x16x32_bf16 v[192:195], v[88:91], v[52:55], 0
v_bfe_u32 v72, v73, 2, 14
s_waitcnt lgkmcnt(3)
v_mfma_f32_16x16x32_f16 v[136:139], v[92:95], v[208:211], v[224:227]
ds_read_b128 v[88:91], v248 offset:23552
ds_read_u16_d16 v72, v72
v_pk_mul_f16 v82, v83, v82
v_bfe_u32 v74, v75, 2, 14
v_mfma_f32_16x16x32_f16 v[144:147], v[92:95], v[212:215], v[224:227]
v_pk_mul_f16 v207, v80, v207
v_mfma_f32_16x16x32_f16 v[16:19], v[92:95], v[168:171], v[16:19]
v_lshrrev_b32_e64 v73, 18, v73
v_pk_mul_f16 v204, v205, v204
v_mfma_f32_16x16x32_f16 v[24:27], v[92:95], v[172:175], v[24:27]
v_lshrrev_b32 v75, 18, v75
s_waitcnt vmcnt(10)
v_mfma_f32_16x16x32_bf16 v[0:3], v[186:189], v[220:223], v[0:3]
ds_read_b128 v[92:95], v249 offset:57344
ds_read_b128 v[224:227], v254 offset:16128
ds_read_u16_d16 v74, v74
ds_read_u16_d16_hi v73, v73
ds_read_u16_d16_hi v75, v75
v_exp_f16_e64 v81, v82
v_mfma_f32_16x16x32_bf16 v[4:7], v[184:187], v[220:223], v[4:7]
v_and_b32 v77, s49, v77
s_waitcnt lgkmcnt(7)
v_mfma_f32_16x16x32_bf16 v[68:71], v[228:231], v[48:51], 0
v_and_b32_e64 v79, s49, v79
v_mfma_f32_16x16x32_bf16 v[196:199], v[228:231], v[52:55], 0
v_exp_f16_e64 v206, v207
v_mfma_f32_16x16x32_f16 v[140:143], v[232:235], v[208:211], v[236:239]
ds_read_b128 v[228:231], v249 offset:57600
v_bfe_u32 v76, v77, 2, 14
v_mfma_f32_16x16x32_f16 v[148:151], v[232:235], v[212:215], v[236:239]
v_bfe_u32 v78, v79, 2, 14
v_mfma_f32_16x16x32_f16 v[20:23], v[232:235], v[168:171], v[20:23]
v_exp_f16_e64 v203, v204
v_mfma_f32_16x16x32_f16 v[28:31], v[232:235], v[172:175], v[28:31]
v_lshrrev_b32_e64 v77, 18, v77
v_lshrrev_b32 v79, 18, v79
s_waitcnt lgkmcnt(6)
v_mfma_f32_16x16x32_bf16 v[64:67], v[88:91], v[176:179], v[64:67]
ds_read_b128 v[232:235], v254 offset:16144
ds_read_b128 v[236:239], v248 offset:23808
ds_read_u16_d16 v76, v76
ds_read_u16_d16 v78, v78
ds_read_u16_d16_hi v77, v77
ds_read_u16_d16_hi v79, v79
v_mfma_f32_16x16x32_bf16 v[192:195], v[88:91], v[180:183], v[192:195]
v_exp_f16_sdwa v81, v82 dst_sel:WORD_1 dst_unused:UNUSED_PRESERVE src0_sel:WORD_1
v_and_b32 v201, s49, v201
s_waitcnt lgkmcnt(7)
v_mfma_f32_16x16x32_f16 v[152:155], v[92:95], v[208:211], v[224:227]
ds_read_b128 v[88:91], v248 offset:24576
v_bfe_u32 v200, v201, 2, 14
v_mfma_f32_16x16x32_f16 v[160:163], v[92:95], v[212:215], v[224:227]
v_exp_f16_sdwa v206, v207 dst_sel:WORD_1 dst_unused:UNUSED_PRESERVE src0_sel:WORD_1
v_mfma_f32_16x16x32_f16 v[32:35], v[92:95], v[168:171], v[32:35]
v_lshrrev_b32 v201, 18, v201
v_mfma_f32_16x16x32_f16 v[40:43], v[92:95], v[172:175], v[40:43]
v_exp_f16_sdwa v203, v204 dst_sel:WORD_1 dst_unused:UNUSED_PRESERVE src0_sel:WORD_1
s_waitcnt lgkmcnt(6)
v_mfma_f32_16x16x32_f16 v[156:159], v[228:231], v[208:211], v[232:235]
ds_read_b128 v[92:95], v248 offset:24832
ds_read_b128 v[224:227], v249 offset:24576
ds_read_u16_d16 v200, v200
ds_read_u16_d16_hi v201, v201
v_pk_add_f16 v81, v81, 1.0 op_sel_hi:[1,0]
v_mfma_f32_16x16x32_f16 v[164:167], v[228:231], v[212:215], v[232:235]
v_pk_add_f16 v206, v206, 1.0 op_sel_hi:[1,0]
v_pk_add_f16 v203, v203, 1.0 op_sel_hi:[1,0]
v_mfma_f32_16x16x32_f16 v[36:39], v[228:231], v[168:171], v[36:39]
v_mfma_f32_16x16x32_f16 v[44:47], v[228:231], v[172:175], v[44:47]
v_rcp_f16 v82, v81
s_waitcnt lgkmcnt(5)
v_mfma_f32_16x16x32_bf16 v[68:71], v[236:239], v[176:179], v[68:71]
ds_read_b128 v[228:231], v249 offset:24832
ds_read_b128 v[232:235], v248 offset:28672
v_rcp_f16_e64 v207, v206
v_mfma_f32_16x16x32_bf16 v[196:199], v[236:239], v[180:183], v[196:199]
v_rcp_f16 v204, v203
s_waitcnt lgkmcnt(6)
v_mfma_f32_16x16x32_bf16 v[64:67], v[88:91], v[56:59], v[64:67]
ds_read_b128 v[236:239], v249 offset:25600
v_mfma_f32_16x16x32_bf16 v[192:195], v[88:91], v[60:63], v[192:195]
v_rcp_f16_sdwa v82, v81 dst_sel:WORD_1 dst_unused:UNUSED_PRESERVE src0_sel:WORD_1
s_waitcnt lgkmcnt(6)
v_mfma_f32_16x16x32_bf16 v[68:71], v[92:95], v[56:59], v[68:71]
ds_read_b128 v[88:91], v248 offset:28928
v_rcp_f16_sdwa v207, v206 dst_sel:WORD_1 dst_unused:UNUSED_PRESERVE src0_sel:WORD_1
v_mfma_f32_16x16x32_bf16 v[196:199], v[92:95], v[60:63], v[196:199]
v_or_b32 v208, v72, v73
v_or_b32 v209, v74, v75
v_or_b32 v210, v76, v77
v_rcp_f16_sdwa v204, v203 dst_sel:WORD_1 dst_unused:UNUSED_PRESERVE src0_sel:WORD_1
v_or_b32 v211, v78, v79
s_waitcnt lgkmcnt(4)
v_or_b32_e64 v212, v200, v201
v_pk_mul_f16 v213, v83, v82
v_pk_mul_f16 v214, v80, v207
v_pk_mul_f16 v215, v205, v204
v_mfma_f32_16x16x32_f16 v[120:123], v[224:227], v[208:211], v[120:123]
s_add_u32 s46, s70, 98304
buffer_load_dwordx4 v[84:87], v252, s[4:7], s46 offen offset:64
ds_read_b128 v[92:95], v249 offset:25856
v_cvt_pkrtz_f16_f32 v73, v64, v65
v_cvt_pkrtz_f16_f32 v75, v66, v67
v_mfma_f32_16x16x32_f16 v[128:131], v[224:227], v[212:215], v[128:131]
v_cvt_pkrtz_f16_f32 v77, v68, v69
v_cvt_pkrtz_f16_f32 v79, v70, v71
v_cvt_pkrtz_f16_f32 v201, v192, v193
s_waitcnt lgkmcnt(2)
v_mfma_f32_16x16x32_f16 v[124:127], v[228:231], v[208:211], v[124:127]
ds_read_b128 v[224:227], v248 offset:29696
v_cvt_pk_f16_f32 v83, v194, v195
v_cvt_pk_f16_f32 v80, v196, v197
v_mfma_f32_16x16x32_f16 v[132:135], v[228:231], v[212:215], v[132:135]
v_cvt_pk_f16_f32 v205, v198, v199
v_pk_fma_f16 v82, v83, v83, s48
v_cvt_pk_bf16_f32 v0, v0, v1
v_mfma_f32_16x16x32_bf16 v[64:67], v[232:235], v[48:51], 0
ds_read_b128 v[228:231], v249 offset:26624
v_and_b32 v73, s49, v73
v_pk_fma_f16 v207, v80, v80, s48
v_mfma_f32_16x16x32_bf16 v[192:195], v[232:235], v[52:55], 0
v_and_b32 v75, s49, v75
v_pk_fma_f16 v204, v205, v205, s48
s_setprio 2
v_bfe_u32 v72, v73, 2, 14
v_mfma_f32_16x16x32_f16 v[136:139], v[236:239], v[208:211], v[136:139]
ds_read_b128 v[232:235], v249 offset:26880
ds_read_u16_d16 v72, v72
v_pk_mul_f16 v82, v83, v82
v_bfe_u32 v74, v75, 2, 14
v_mfma_f32_16x16x32_f16 v[144:147], v[236:239], v[212:215], v[144:147]
v_pk_mul_f16 v207, v80, v207
v_lshrrev_b32 v73, 18, v73
v_cvt_pk_bf16_f32 v1, v2, v3
s_waitcnt lgkmcnt(3)
v_mfma_f32_16x16x32_bf16 v[68:71], v[88:91], v[48:51], 0
ds_read_b128 v[236:239], v248 offset:29952
ds_read_u16_d16 v74, v74
ds_read_u16_d16_hi v73, v73
v_pk_mul_f16 v204, v205, v204
v_lshrrev_b32_e64 v75, 18, v75
v_mfma_f32_16x16x32_bf16 v[196:199], v[88:91], v[52:55], 0
v_exp_f16 v81, v82
v_and_b32 v77, s49, v77
v_mfma_f32_16x16x32_f16 v[140:143], v[92:95], v[208:211], v[140:143]
ds_read_b128 v[88:91], v248 offset:30720
ds_read_u16_d16_hi v75, v75
v_and_b32_e64 v79, s49, v79
v_mfma_f32_16x16x32_f16 v[148:151], v[92:95], v[212:215], v[148:151]
v_exp_f16_e64 v206, v207
v_bfe_u32 v76, v77, 2, 14
v_bfe_u32 v78, v79, 2, 14
v_mfma_f32_16x16x32_bf16 v[64:67], v[224:227], v[176:179], v[64:67]
s_add_u32 s46, s80, 16777216
buffer_load_dwordx4 v[104:107], v253, s[32:35], s46 offen
ds_read_b128 v[92:95], v248 offset:30976
ds_read_u16_d16 v76, v76
ds_read_u16_d16 v78, v78
v_cvt_pk_bf16_f32 v2, v4, v5
v_mfma_f32_16x16x32_bf16 v[192:195], v[224:227], v[180:183], v[192:195]
v_exp_f16 v203, v204
v_lshrrev_b32 v77, 18, v77
v_lshrrev_b32 v79, 18, v79
s_waitcnt lgkmcnt(5)
v_mfma_f32_16x16x32_f16 v[152:155], v[228:231], v[208:211], v[152:155]
ds_read_b128 v[224:227], v249 offset:30720
ds_read_u16_d16_hi v77, v77
ds_read_u16_d16_hi v79, v79
v_exp_f16_sdwa v81, v82 dst_sel:WORD_1 dst_unused:UNUSED_PRESERVE src0_sel:WORD_1
v_mfma_f32_16x16x32_f16 v[160:163], v[228:231], v[212:215], v[160:163]
v_and_b32_e64 v201, s49, v201
v_bfe_u32 v200, v201, 2, 14
v_mfma_f32_16x16x32_f16 v[156:159], v[232:235], v[208:211], v[156:159]
ds_read_b128 v[228:231], v249 offset:30976
ds_read_u16_d16 v200, v200
v_exp_f16_sdwa v206, v207 dst_sel:WORD_1 dst_unused:UNUSED_PRESERVE src0_sel:WORD_1
v_cvt_pk_bf16_f32 v3, v6, v7
v_mfma_f32_16x16x32_f16 v[164:167], v[232:235], v[212:215], v[164:167]
v_lshrrev_b32_e64 v201, 18, v201
v_exp_f16_sdwa v203, v204 dst_sel:WORD_1 dst_unused:UNUSED_PRESERVE src0_sel:WORD_1
v_mfma_f32_16x16x32_bf16 v[68:71], v[236:239], v[176:179], v[68:71]
ds_read_b128 v[232:235], v248 offset:34816
buffer_store_dwordx4 v[0:3], v252, s[8:11], s70 offen sc1
ds_read_u16_d16_hi v201, v201
v_pk_add_f16 v81, v81, 1.0 op_sel_hi:[1,0]
v_pk_add_f16 v206, v206, 1.0 op_sel_hi:[1,0]
v_mfma_f32_16x16x32_bf16 v[196:199], v[236:239], v[180:183], v[196:199]
v_pk_add_f16 v203, v203, 1.0 op_sel_hi:[1,0]
v_rcp_f16 v82, v81
s_waitcnt lgkmcnt(7)
v_mfma_f32_16x16x32_bf16 v[64:67], v[88:91], v[56:59], v[64:67]
ds_read_b128 v[236:239], v249 offset:31744
v_rcp_f16_e64 v207, v206
v_mfma_f32_16x16x32_bf16 v[192:195], v[88:91], v[60:63], v[192:195]
v_rcp_f16_e64 v204, v203
v_mfma_f32_16x16x32_bf16 v[68:71], v[92:95], v[56:59], v[68:71]
ds_read_b128 v[88:91], v248 offset:35072
v_rcp_f16_sdwa v82, v81 dst_sel:WORD_1 dst_unused:UNUSED_PRESERVE src0_sel:WORD_1
v_mfma_f32_16x16x32_bf16 v[196:199], v[92:95], v[60:63], v[196:199]
v_rcp_f16_sdwa v207, v206 dst_sel:WORD_1 dst_unused:UNUSED_PRESERVE src0_sel:WORD_1
v_or_b32 v208, v72, v73
v_or_b32 v209, v74, v75
s_waitcnt lgkmcnt(4)
v_or_b32 v210, v76, v77
v_rcp_f16_sdwa v204, v203 dst_sel:WORD_1 dst_unused:UNUSED_PRESERVE src0_sel:WORD_1
v_or_b32 v211, v78, v79
s_waitcnt lgkmcnt(2)
v_or_b32_e64 v212, v200, v201
v_pk_mul_f16 v213, v83, v82
v_pk_mul_f16 v214, v80, v207
v_pk_mul_f16 v215, v205, v204
v_mfma_f32_16x16x32_f16 v[120:123], v[224:227], v[208:211], v[120:123]
buffer_load_dwordx4 v[216:219], v252, s[4:7], s68 offen
ds_read_b128 v[92:95], v249 offset:32000
v_cvt_pkrtz_f16_f32 v73, v64, v65
v_cvt_pkrtz_f16_f32 v75, v66, v67
v_mfma_f32_16x16x32_f16 v[128:131], v[224:227], v[212:215], v[128:131]
v_cvt_pkrtz_f16_f32 v77, v68, v69
v_cvt_pkrtz_f16_f32 v79, v70, v71
v_mfma_f32_16x16x32_f16 v[124:127], v[228:231], v[208:211], v[124:127]
ds_read_b128 v[224:227], v248 offset:35840
v_cvt_pkrtz_f16_f32 v201, v192, v193
v_cvt_pk_f16_f32 v83, v194, v195
v_mfma_f32_16x16x32_f16 v[132:135], v[228:231], v[212:215], v[132:135]
v_cvt_pk_f16_f32 v80, v196, v197
v_cvt_pk_f16_f32 v205, v198, v199
s_setprio 1
v_mfma_f32_16x16x32_bf16 v[64:67], v[232:235], v[48:51], 0
ds_read_b128 v[228:231], v249 offset:32768
v_pk_fma_f16 v82, v83, v83, s48
v_and_b32 v73, s49, v73
v_mfma_f32_16x16x32_bf16 v[192:195], v[232:235], v[52:55], 0
v_pk_fma_f16 v207, v80, v80, s48
v_and_b32 v75, s49, v75
s_waitcnt lgkmcnt(3)
v_mfma_f32_16x16x32_f16 v[136:139], v[236:239], v[208:211], v[136:139]
ds_read_b128 v[232:235], v249 offset:33024
v_pk_fma_f16 v204, v205, v205, s48
v_bfe_u32 v72, v73, 2, 14
v_pk_mul_f16 v82, v83, v82
v_mfma_f32_16x16x32_f16 v[144:147], v[236:239], v[212:215], v[144:147]
v_bfe_u32 v74, v75, 2, 14
v_pk_mul_f16 v207, v80, v207
s_waitcnt vmcnt(10)
v_mfma_f32_16x16x32_bf16 v[8:11], v[186:189], v[240:243], v[8:11]
ds_read_b128 v[236:239], v248 offset:36096
ds_read_u16_d16 v72, v72
ds_read_u16_d16 v74, v74
v_lshrrev_b32 v73, 18, v73
v_pk_mul_f16 v204, v205, v204
v_mfma_f32_16x16x32_bf16 v[12:15], v[184:187], v[240:243], v[12:15]
v_lshrrev_b32_e64 v75, 18, v75
v_mfma_f32_16x16x32_bf16 v[68:71], v[88:91], v[48:51], 0
ds_read_u16_d16_hi v73, v73
ds_read_u16_d16_hi v75, v75
v_exp_f16 v81, v82
v_and_b32 v77, s49, v77
v_mfma_f32_16x16x32_bf16 v[196:199], v[88:91], v[52:55], 0
v_and_b32 v79, s49, v79
s_waitcnt lgkmcnt(6)
v_mfma_f32_16x16x32_f16 v[140:143], v[92:95], v[208:211], v[140:143]
ds_read_b128 v[88:91], v248 offset:36864
v_exp_f16_e64 v206, v207
v_bfe_u32 v76, v77, 2, 14
v_mfma_f32_16x16x32_f16 v[148:151], v[92:95], v[212:215], v[148:151]
v_bfe_u32 v78, v79, 2, 14
v_exp_f16_e64 v203, v204
v_mfma_f32_16x16x32_bf16 v[64:67], v[224:227], v[176:179], v[64:67]
s_add_u32 s46, s80, 16777216
buffer_load_dwordx4 v[108:111], v253, s[32:35], s46 offen offset:256
ds_read_b128 v[92:95], v248 offset:37120
ds_read_u16_d16 v76, v76
ds_read_u16_d16 v78, v78
v_lshrrev_b32 v77, 18, v77
v_lshrrev_b32 v79, 18, v79
v_mfma_f32_16x16x32_bf16 v[192:195], v[224:227], v[180:183], v[192:195]
v_exp_f16_sdwa v81, v82 dst_sel:WORD_1 dst_unused:UNUSED_PRESERVE src0_sel:WORD_1
v_mfma_f32_16x16x32_f16 v[152:155], v[228:231], v[208:211], v[152:155]
ds_read_b128 v[224:227], v249 offset:36864
ds_read_u16_d16_hi v77, v77
ds_read_u16_d16_hi v79, v79
v_and_b32 v201, s49, v201
v_bfe_u32 v200, v201, 2, 14
v_mfma_f32_16x16x32_f16 v[160:163], v[228:231], v[212:215], v[160:163]
v_exp_f16_sdwa v206, v207 dst_sel:WORD_1 dst_unused:UNUSED_PRESERVE src0_sel:WORD_1
s_waitcnt lgkmcnt(7)
v_mfma_f32_16x16x32_f16 v[156:159], v[232:235], v[208:211], v[156:159]
ds_read_b128 v[228:231], v249 offset:37120
ds_read_u16_d16 v200, v200
v_lshrrev_b32_e64 v201, 18, v201
v_mfma_f32_16x16x32_f16 v[164:167], v[232:235], v[212:215], v[164:167]
v_exp_f16_sdwa v203, v204 dst_sel:WORD_1 dst_unused:UNUSED_PRESERVE src0_sel:WORD_1
v_pk_add_f16 v81, v81, 1.0 op_sel_hi:[1,0]
v_pk_add_f16 v206, v206, 1.0 op_sel_hi:[1,0]
v_mfma_f32_16x16x32_bf16 v[68:71], v[236:239], v[176:179], v[68:71]
ds_read_b128 v[232:235], v248 offset:40960
ds_read_u16_d16_hi v201, v201
v_pk_add_f16 v203, v203, 1.0 op_sel_hi:[1,0]
v_mfma_f32_16x16x32_bf16 v[196:199], v[236:239], v[180:183], v[196:199]
v_rcp_f16_e64 v82, v81
s_setprio 0
s_waitcnt lgkmcnt(7)
v_mfma_f32_16x16x32_bf16 v[64:67], v[88:91], v[56:59], v[64:67]
ds_read_b128 v[236:239], v249 offset:37888
v_rcp_f16_e64 v207, v206
v_mfma_f32_16x16x32_bf16 v[192:195], v[88:91], v[60:63], v[192:195]
v_rcp_f16_e64 v204, v203
v_mfma_f32_16x16x32_bf16 v[68:71], v[92:95], v[56:59], v[68:71]
ds_read_b128 v[88:91], v248 offset:41216
v_rcp_f16_sdwa v82, v81 dst_sel:WORD_1 dst_unused:UNUSED_PRESERVE src0_sel:WORD_1
v_mfma_f32_16x16x32_bf16 v[196:199], v[92:95], v[60:63], v[196:199]
v_rcp_f16_sdwa v207, v206 dst_sel:WORD_1 dst_unused:UNUSED_PRESERVE src0_sel:WORD_1
v_or_b32 v208, v72, v73
v_or_b32 v209, v74, v75
s_waitcnt lgkmcnt(4)
v_or_b32 v210, v76, v77
v_rcp_f16_sdwa v204, v203 dst_sel:WORD_1 dst_unused:UNUSED_PRESERVE src0_sel:WORD_1
v_or_b32 v211, v78, v79
s_waitcnt lgkmcnt(2)
v_or_b32 v212, v200, v201
v_pk_mul_f16 v213, v83, v82
v_pk_mul_f16 v214, v80, v207
v_pk_mul_f16 v215, v205, v204
s_setprio 3
v_mfma_f32_16x16x32_f16 v[120:123], v[224:227], v[208:211], v[120:123]
buffer_load_dwordx4 v[220:223], v252, s[4:7], s70 offen offset:128
ds_read_b128 v[92:95], v249 offset:38144
v_cvt_pkrtz_f16_f32 v73, v64, v65
v_cvt_pkrtz_f16_f32 v75, v66, v67
v_mfma_f32_16x16x32_f16 v[128:131], v[224:227], v[212:215], v[128:131]
v_cvt_pkrtz_f16_f32 v77, v68, v69
v_cvt_pkrtz_f16_f32 v79, v70, v71
v_cvt_pkrtz_f16_f32 v201, v192, v193
v_mfma_f32_16x16x32_f16 v[124:127], v[228:231], v[208:211], v[124:127]
ds_read_b128 v[224:227], v248 offset:41984
v_cvt_pk_f16_f32 v83, v194, v195
v_cvt_pk_f16_f32 v80, v196, v197
v_mfma_f32_16x16x32_f16 v[132:135], v[228:231], v[212:215], v[132:135]
v_cvt_pk_f16_f32 v205, v198, v199
v_pk_fma_f16 v82, v83, v83, s48
v_cvt_pk_bf16_f32 v8, v8, v9
v_mfma_f32_16x16x32_bf16 v[64:67], v[232:235], v[48:51], 0
ds_read_b128 v[228:231], v249 offset:38912
v_and_b32_e64 v73, s49, v73
v_pk_fma_f16 v207, v80, v80, s48
v_mfma_f32_16x16x32_bf16 v[192:195], v[232:235], v[52:55], 0
v_and_b32 v75, s49, v75
v_pk_fma_f16 v204, v205, v205, s48
v_bfe_u32 v72, v73, 2, 14
s_waitcnt lgkmcnt(3)
v_mfma_f32_16x16x32_f16 v[136:139], v[236:239], v[208:211], v[136:139]
ds_read_b128 v[232:235], v249 offset:39168
ds_read_u16_d16 v72, v72
v_pk_mul_f16 v82, v83, v82
v_bfe_u32 v74, v75, 2, 14
v_mfma_f32_16x16x32_f16 v[144:147], v[236:239], v[212:215], v[144:147]
v_pk_mul_f16 v207, v80, v207
v_lshrrev_b32_e64 v73, 18, v73
v_cvt_pk_bf16_f32 v9, v10, v11
v_mfma_f32_16x16x32_bf16 v[68:71], v[88:91], v[48:51], 0
ds_read_b128 v[236:239], v248 offset:42240
ds_read_u16_d16 v74, v74
ds_read_u16_d16_hi v73, v73
v_pk_mul_f16 v204, v205, v204
v_lshrrev_b32_e64 v75, 18, v75
v_mfma_f32_16x16x32_bf16 v[196:199], v[88:91], v[52:55], 0
v_exp_f16_e64 v81, v82
v_and_b32 v77, s49, v77
s_waitcnt lgkmcnt(5)
v_mfma_f32_16x16x32_f16 v[140:143], v[92:95], v[208:211], v[140:143]
ds_read_b128 v[88:91], v248 offset:43008
ds_read_u16_d16_hi v75, v75
v_and_b32_e64 v79, s49, v79
v_mfma_f32_16x16x32_f16 v[148:151], v[92:95], v[212:215], v[148:151]
v_exp_f16_e64 v206, v207
v_bfe_u32 v76, v77, 2, 14
v_bfe_u32 v78, v79, 2, 14
v_mfma_f32_16x16x32_bf16 v[64:67], v[224:227], v[176:179], v[64:67]
ds_read_b128 v[92:95], v248 offset:43264
ds_read_u16_d16 v76, v76
ds_read_u16_d16 v78, v78
v_cvt_pk_bf16_f32 v10, v12, v13
v_mfma_f32_16x16x32_bf16 v[192:195], v[224:227], v[180:183], v[192:195]
v_exp_f16 v203, v204
v_lshrrev_b32 v77, 18, v77
v_lshrrev_b32_e64 v79, 18, v79
v_mfma_f32_16x16x32_f16 v[152:155], v[228:231], v[208:211], v[152:155]
ds_read_b128 v[224:227], v249 offset:43008
ds_read_u16_d16_hi v77, v77
ds_read_u16_d16_hi v79, v79
v_exp_f16_sdwa v81, v82 dst_sel:WORD_1 dst_unused:UNUSED_PRESERVE src0_sel:WORD_1
v_mfma_f32_16x16x32_f16 v[160:163], v[228:231], v[212:215], v[160:163]
v_and_b32 v201, s49, v201
v_bfe_u32 v200, v201, 2, 14
s_waitcnt lgkmcnt(8)
v_mfma_f32_16x16x32_f16 v[156:159], v[232:235], v[208:211], v[156:159]
ds_read_b128 v[228:231], v249 offset:43264
ds_read_u16_d16 v200, v200
v_exp_f16_sdwa v206, v207 dst_sel:WORD_1 dst_unused:UNUSED_PRESERVE src0_sel:WORD_1
v_cvt_pk_bf16_f32 v11, v14, v15
v_mfma_f32_16x16x32_f16 v[164:167], v[232:235], v[212:215], v[164:167]
v_lshrrev_b32_e64 v201, 18, v201
v_exp_f16_sdwa v203, v204 dst_sel:WORD_1 dst_unused:UNUSED_PRESERVE src0_sel:WORD_1
v_mfma_f32_16x16x32_bf16 v[68:71], v[236:239], v[176:179], v[68:71]
ds_read_b128 v[232:235], v248 offset:53248
s_add_u32 s46, s70, 98304
buffer_store_dwordx4 v[8:11], v252, s[8:11], s46 offen sc1
ds_read_u16_d16_hi v201, v201
v_pk_add_f16 v81, v81, 1.0 op_sel_hi:[1,0]
v_pk_add_f16 v206, v206, 1.0 op_sel_hi:[1,0]
v_mfma_f32_16x16x32_bf16 v[196:199], v[236:239], v[180:183], v[196:199]
v_pk_add_f16 v203, v203, 1.0 op_sel_hi:[1,0]
v_rcp_f16 v82, v81
s_waitcnt lgkmcnt(5)
v_mfma_f32_16x16x32_bf16 v[64:67], v[88:91], v[56:59], v[64:67]
ds_read_b128 v[236:239], v249 offset:44032
v_rcp_f16_e64 v207, v206
v_mfma_f32_16x16x32_bf16 v[192:195], v[88:91], v[60:63], v[192:195]
v_rcp_f16_e64 v204, v203
v_mfma_f32_16x16x32_bf16 v[68:71], v[92:95], v[56:59], v[68:71]
ds_read_b128 v[88:91], v248 offset:53504
v_rcp_f16_sdwa v82, v81 dst_sel:WORD_1 dst_unused:UNUSED_PRESERVE src0_sel:WORD_1
v_mfma_f32_16x16x32_bf16 v[196:199], v[92:95], v[60:63], v[196:199]
v_rcp_f16_sdwa v207, v206 dst_sel:WORD_1 dst_unused:UNUSED_PRESERVE src0_sel:WORD_1
v_or_b32 v208, v72, v73
v_or_b32 v209, v74, v75
v_or_b32_e64 v210, v76, v77
v_rcp_f16_sdwa v204, v203 dst_sel:WORD_1 dst_unused:UNUSED_PRESERVE src0_sel:WORD_1
s_waitcnt lgkmcnt(4)
v_or_b32 v211, v78, v79
s_waitcnt lgkmcnt(2)
v_or_b32 v212, v200, v201
v_pk_mul_f16 v213, v83, v82
v_pk_mul_f16 v214, v80, v207
v_pk_mul_f16 v215, v205, v204
v_mfma_f32_16x16x32_f16 v[120:123], v[224:227], v[208:211], v[120:123]
s_add_u32 s46, s68, 98304
buffer_load_dwordx4 v[240:243], v252, s[4:7], s46 offen
ds_read_b128 v[92:95], v249 offset:44288
v_cvt_pkrtz_f16_f32 v73, v64, v65
v_cvt_pkrtz_f16_f32 v75, v66, v67
v_mfma_f32_16x16x32_f16 v[128:131], v[224:227], v[212:215], v[128:131]
v_cvt_pkrtz_f16_f32 v77, v68, v69
v_cvt_pkrtz_f16_f32 v79, v70, v71
v_mfma_f32_16x16x32_f16 v[124:127], v[228:231], v[208:211], v[124:127]
ds_read_b128 v[224:227], v248 offset:54272
v_cvt_pkrtz_f16_f32 v201, v192, v193
v_cvt_pk_f16_f32 v83, v194, v195
v_mfma_f32_16x16x32_f16 v[132:135], v[228:231], v[212:215], v[132:135]
v_cvt_pk_f16_f32 v80, v196, v197
v_cvt_pk_f16_f32 v205, v198, v199
v_mfma_f32_16x16x32_bf16 v[64:67], v[232:235], v[48:51], 0
ds_read_b128 v[228:231], v249 offset:45056
v_pk_fma_f16 v82, v83, v83, s48
v_and_b32_e64 v73, s49, v73
v_mfma_f32_16x16x32_bf16 v[192:195], v[232:235], v[52:55], 0
v_pk_fma_f16 v207, v80, v80, s48
v_and_b32 v75, s49, v75
s_waitcnt lgkmcnt(3)
v_mfma_f32_16x16x32_f16 v[136:139], v[236:239], v[208:211], v[136:139]
ds_read_b128 v[232:235], v249 offset:45312
v_pk_fma_f16 v204, v205, v205, s48
s_setprio 2
v_bfe_u32 v72, v73, 2, 14
v_pk_mul_f16 v82, v83, v82
v_mfma_f32_16x16x32_f16 v[144:147], v[236:239], v[212:215], v[144:147]
v_bfe_u32 v74, v75, 2, 14
v_pk_mul_f16 v207, v80, v207
s_waitcnt vmcnt(9)
v_mfma_f32_16x16x32_bf16 v[16:19], v[186:189], v[244:247], v[16:19]
ds_read_b128 v[236:239], v248 offset:54528
ds_read_u16_d16 v72, v72
ds_read_u16_d16 v74, v74
v_lshrrev_b32_e64 v73, 18, v73
v_pk_mul_f16 v204, v205, v204
v_mfma_f32_16x16x32_bf16 v[20:23], v[184:187], v[244:247], v[20:23]
v_lshrrev_b32_e64 v75, 18, v75
v_mfma_f32_16x16x32_bf16 v[68:71], v[88:91], v[48:51], 0
ds_read_u16_d16_hi v73, v73
ds_read_u16_d16_hi v75, v75
v_exp_f16 v81, v82
v_and_b32 v77, s49, v77
v_mfma_f32_16x16x32_bf16 v[196:199], v[88:91], v[52:55], 0
v_and_b32 v79, s49, v79
s_waitcnt lgkmcnt(6)
v_mfma_f32_16x16x32_f16 v[140:143], v[92:95], v[208:211], v[140:143]
ds_read_b128 v[88:91], v248 offset:55296
v_exp_f16_e64 v206, v207
v_bfe_u32 v76, v77, 2, 14
v_mfma_f32_16x16x32_f16 v[148:151], v[92:95], v[212:215], v[148:151]
v_bfe_u32 v78, v79, 2, 14
v_exp_f16_e64 v203, v204
v_mfma_f32_16x16x32_bf16 v[64:67], v[224:227], v[176:179], v[64:67]
s_add_u32 s46, s80, 20971520
buffer_load_dwordx4 v[112:115], v253, s[32:35], s46 offen
ds_read_b128 v[92:95], v248 offset:55552
ds_read_u16_d16 v76, v76
ds_read_u16_d16 v78, v78
v_lshrrev_b32 v77, 18, v77
v_lshrrev_b32 v79, 18, v79
v_mfma_f32_16x16x32_bf16 v[192:195], v[224:227], v[180:183], v[192:195]
v_exp_f16_sdwa v81, v82 dst_sel:WORD_1 dst_unused:UNUSED_PRESERVE src0_sel:WORD_1
v_mfma_f32_16x16x32_f16 v[152:155], v[228:231], v[208:211], v[152:155]
ds_read_b128 v[224:227], v249 offset:49152
ds_read_u16_d16_hi v77, v77
ds_read_u16_d16_hi v79, v79
v_and_b32 v201, s49, v201
v_bfe_u32 v200, v201, 2, 14
v_mfma_f32_16x16x32_f16 v[160:163], v[228:231], v[212:215], v[160:163]
v_exp_f16_sdwa v206, v207 dst_sel:WORD_1 dst_unused:UNUSED_PRESERVE src0_sel:WORD_1
s_waitcnt lgkmcnt(7)
v_mfma_f32_16x16x32_f16 v[156:159], v[232:235], v[208:211], v[156:159]
ds_read_b128 v[228:231], v249 offset:49408
ds_read_u16_d16 v200, v200
v_lshrrev_b32_e64 v201, 18, v201
v_mfma_f32_16x16x32_f16 v[164:167], v[232:235], v[212:215], v[164:167]
v_exp_f16_sdwa v203, v204 dst_sel:WORD_1 dst_unused:UNUSED_PRESERVE src0_sel:WORD_1
v_pk_add_f16 v81, v81, 1.0 op_sel_hi:[1,0]
v_pk_add_f16 v206, v206, 1.0 op_sel_hi:[1,0]
v_mfma_f32_16x16x32_bf16 v[68:71], v[236:239], v[176:179], v[68:71]
ds_read_b128 v[232:235], v248 offset:59392
ds_read_u16_d16_hi v201, v201
v_pk_add_f16 v203, v203, 1.0 op_sel_hi:[1,0]
v_mfma_f32_16x16x32_bf16 v[196:199], v[236:239], v[180:183], v[196:199]
v_rcp_f16 v82, v81
s_waitcnt lgkmcnt(7)
v_mfma_f32_16x16x32_bf16 v[64:67], v[88:91], v[56:59], v[64:67]
ds_read_b128 v[236:239], v249 offset:50176
v_rcp_f16_e64 v207, v206
v_mfma_f32_16x16x32_bf16 v[192:195], v[88:91], v[60:63], v[192:195]
v_rcp_f16_e64 v204, v203
v_mfma_f32_16x16x32_bf16 v[68:71], v[92:95], v[56:59], v[68:71]
ds_read_b128 v[88:91], v248 offset:59648
v_rcp_f16_sdwa v82, v81 dst_sel:WORD_1 dst_unused:UNUSED_PRESERVE src0_sel:WORD_1
v_mfma_f32_16x16x32_bf16 v[196:199], v[92:95], v[60:63], v[196:199]
v_rcp_f16_sdwa v207, v206 dst_sel:WORD_1 dst_unused:UNUSED_PRESERVE src0_sel:WORD_1
v_or_b32 v208, v72, v73
v_or_b32 v209, v74, v75
s_waitcnt lgkmcnt(4)
v_or_b32 v210, v76, v77
v_rcp_f16_sdwa v204, v203 dst_sel:WORD_1 dst_unused:UNUSED_PRESERVE src0_sel:WORD_1
v_or_b32 v211, v78, v79
s_waitcnt lgkmcnt(2)
v_or_b32_e64 v212, v200, v201
v_pk_mul_f16 v213, v83, v82
v_pk_mul_f16 v214, v80, v207
v_pk_mul_f16 v215, v205, v204
v_mfma_f32_16x16x32_f16 v[120:123], v[224:227], v[208:211], v[120:123]
s_add_u32 s46, s70, 98304
buffer_load_dwordx4 v[244:247], v252, s[4:7], s46 offen offset:128
ds_read_b128 v[92:95], v249 offset:50432
v_cvt_pkrtz_f16_f32 v73, v64, v65
v_cvt_pkrtz_f16_f32 v75, v66, v67
v_mfma_f32_16x16x32_f16 v[128:131], v[224:227], v[212:215], v[128:131]
v_cvt_pkrtz_f16_f32 v77, v68, v69
v_cvt_pkrtz_f16_f32 v79, v70, v71
v_cvt_pkrtz_f16_f32 v201, v192, v193
v_mfma_f32_16x16x32_f16 v[124:127], v[228:231], v[208:211], v[124:127]
ds_read_b128 v[224:227], v248 offset:60416
v_cvt_pk_f16_f32 v83, v194, v195
v_cvt_pk_f16_f32 v80, v196, v197
v_mfma_f32_16x16x32_f16 v[132:135], v[228:231], v[212:215], v[132:135]
v_cvt_pk_f16_f32 v205, v198, v199
s_setprio 1
v_pk_fma_f16 v82, v83, v83, s48
v_cvt_pk_bf16_f32 v16, v16, v17
v_mfma_f32_16x16x32_bf16 v[64:67], v[232:235], v[48:51], 0
ds_read_b128 v[228:231], v249 offset:51200
v_and_b32 v73, s49, v73
v_pk_fma_f16 v207, v80, v80, s48
v_mfma_f32_16x16x32_bf16 v[192:195], v[232:235], v[52:55], 0
v_and_b32 v75, s49, v75
v_pk_fma_f16 v204, v205, v205, s48
v_bfe_u32 v72, v73, 2, 14
s_waitcnt lgkmcnt(3)
v_mfma_f32_16x16x32_f16 v[136:139], v[236:239], v[208:211], v[136:139]
ds_read_b128 v[232:235], v249 offset:51456
ds_read_u16_d16 v72, v72
v_pk_mul_f16 v82, v83, v82
v_bfe_u32 v74, v75, 2, 14
v_mfma_f32_16x16x32_f16 v[144:147], v[236:239], v[212:215], v[144:147]
v_pk_mul_f16 v207, v80, v207
v_lshrrev_b32_e64 v73, 18, v73
v_cvt_pk_bf16_f32 v17, v18, v19
v_mfma_f32_16x16x32_bf16 v[68:71], v[88:91], v[48:51], 0
ds_read_b128 v[236:239], v248 offset:60672
ds_read_u16_d16 v74, v74
ds_read_u16_d16_hi v73, v73
v_pk_mul_f16 v204, v205, v204
v_lshrrev_b32_e64 v75, 18, v75
v_mfma_f32_16x16x32_bf16 v[196:199], v[88:91], v[52:55], 0
v_exp_f16_e64 v81, v82
v_and_b32 v77, s49, v77
s_waitcnt lgkmcnt(5)
v_mfma_f32_16x16x32_f16 v[140:143], v[92:95], v[208:211], v[140:143]
ds_read_b128 v[88:91], v248 offset:61440
ds_read_u16_d16_hi v75, v75
v_and_b32_e64 v79, s49, v79
v_mfma_f32_16x16x32_f16 v[148:151], v[92:95], v[212:215], v[148:151]
v_exp_f16_e64 v206, v207
v_bfe_u32 v76, v77, 2, 14
v_bfe_u32 v78, v79, 2, 14
v_mfma_f32_16x16x32_bf16 v[64:67], v[224:227], v[176:179], v[64:67]
s_add_u32 s46, s80, 20971520
buffer_load_dwordx4 v[116:119], v253, s[32:35], s46 offen offset:256
ds_read_b128 v[92:95], v248 offset:61696
ds_read_u16_d16 v76, v76
ds_read_u16_d16 v78, v78
v_cvt_pk_bf16_f32 v18, v20, v21
v_mfma_f32_16x16x32_bf16 v[192:195], v[224:227], v[180:183], v[192:195]
v_exp_f16 v203, v204
v_lshrrev_b32 v77, 18, v77
v_lshrrev_b32_e64 v79, 18, v79
v_mfma_f32_16x16x32_f16 v[152:155], v[228:231], v[208:211], v[152:155]
ds_read_b128 v[224:227], v249 offset:61440
ds_read_u16_d16_hi v77, v77
ds_read_u16_d16_hi v79, v79
v_exp_f16_sdwa v81, v82 dst_sel:WORD_1 dst_unused:UNUSED_PRESERVE src0_sel:WORD_1
v_mfma_f32_16x16x32_f16 v[160:163], v[228:231], v[212:215], v[160:163]
v_and_b32 v201, s49, v201
v_bfe_u32 v200, v201, 2, 14
s_waitcnt lgkmcnt(6)
v_mfma_f32_16x16x32_f16 v[156:159], v[232:235], v[208:211], v[156:159]
ds_read_b128 v[228:231], v249 offset:61696
ds_read_u16_d16 v200, v200
v_exp_f16_sdwa v206, v207 dst_sel:WORD_1 dst_unused:UNUSED_PRESERVE src0_sel:WORD_1
v_cvt_pk_bf16_f32 v19, v22, v23
v_mfma_f32_16x16x32_f16 v[164:167], v[232:235], v[212:215], v[164:167]
v_lshrrev_b32_e64 v201, 18, v201
v_exp_f16_sdwa v203, v204 dst_sel:WORD_1 dst_unused:UNUSED_PRESERVE src0_sel:WORD_1
v_mfma_f32_16x16x32_bf16 v[68:71], v[236:239], v[176:179], v[68:71]
ds_read_b128 v[232:235], v249
buffer_store_dwordx4 v[16:19], v252, s[8:11], s70 offen offset:64 sc1
ds_read_u16_d16_hi v201, v201
v_pk_add_f16 v81, v81, 1.0 op_sel_hi:[1,0]
v_pk_add_f16 v206, v206, 1.0 op_sel_hi:[1,0]
v_mfma_f32_16x16x32_bf16 v[196:199], v[236:239], v[180:183], v[196:199]
v_pk_add_f16 v203, v203, 1.0 op_sel_hi:[1,0]
s_setprio 0
v_rcp_f16 v82, v81
v_mfma_f32_16x16x32_bf16 v[64:67], v[88:91], v[56:59], v[64:67]
ds_read_b128 v[236:239], v249 offset:62464
v_rcp_f16_e64 v207, v206
v_mfma_f32_16x16x32_bf16 v[192:195], v[88:91], v[60:63], v[192:195]
v_rcp_f16 v204, v203
s_waitcnt lgkmcnt(5)
v_mfma_f32_16x16x32_bf16 v[68:71], v[92:95], v[56:59], v[68:71]
ds_read_b128 v[88:91], v249 offset:256
v_rcp_f16_sdwa v82, v81 dst_sel:WORD_1 dst_unused:UNUSED_PRESERVE src0_sel:WORD_1
v_mfma_f32_16x16x32_bf16 v[196:199], v[92:95], v[60:63], v[196:199]
v_rcp_f16_sdwa v207, v206 dst_sel:WORD_1 dst_unused:UNUSED_PRESERVE src0_sel:WORD_1
v_or_b32 v208, v72, v73
v_or_b32 v209, v74, v75
v_or_b32_e64 v210, v76, v77
v_rcp_f16_sdwa v204, v203 dst_sel:WORD_1 dst_unused:UNUSED_PRESERVE src0_sel:WORD_1
v_or_b32 v211, v78, v79
s_waitcnt lgkmcnt(2)
v_or_b32 v212, v200, v201
v_pk_mul_f16 v213, v83, v82
v_pk_mul_f16 v214, v80, v207
v_pk_mul_f16 v215, v205, v204
s_setprio 3
v_mfma_f32_16x16x32_f16 v[120:123], v[224:227], v[208:211], v[120:123]
ds_read_b128 v[92:95], v249 offset:62720
v_cvt_pkrtz_f16_f32 v73, v64, v65
v_cvt_pkrtz_f16_f32 v75, v66, v67
v_mfma_f32_16x16x32_f16 v[128:131], v[224:227], v[212:215], v[128:131]
v_cvt_pkrtz_f16_f32 v77, v68, v69
v_cvt_pkrtz_f16_f32 v79, v70, v71
v_mfma_f32_16x16x32_f16 v[124:127], v[228:231], v[208:211], v[124:127]
ds_read_b128 v[224:227], v249 offset:1024
v_cvt_pkrtz_f16_f32 v201, v192, v193
v_cvt_pk_f16_f32 v83, v194, v195
v_mfma_f32_16x16x32_f16 v[132:135], v[228:231], v[212:215], v[132:135]
v_cvt_pk_f16_f32 v80, v196, v197
v_cvt_pk_f16_f32 v205, v198, v199
v_mfma_f32_16x16x32_bf16 v[64:67], v[232:235], v[48:51], 0
ds_read_b128 v[228:231], v249 offset:63488
v_pk_fma_f16 v82, v83, v83, s48
v_and_b32_e64 v73, s49, v73
v_mfma_f32_16x16x32_bf16 v[192:195], v[232:235], v[52:55], 0
v_pk_fma_f16 v207, v80, v80, s48
v_and_b32 v75, s49, v75
s_waitcnt lgkmcnt(3)
v_mfma_f32_16x16x32_f16 v[136:139], v[236:239], v[208:211], v[136:139]
ds_read_b128 v[232:235], v249 offset:63744
v_pk_fma_f16 v204, v205, v205, s48
v_bfe_u32 v72, v73, 2, 14
v_pk_mul_f16 v82, v83, v82
v_mfma_f32_16x16x32_f16 v[144:147], v[236:239], v[212:215], v[144:147]
v_bfe_u32 v74, v75, 2, 14
v_pk_mul_f16 v207, v80, v207
s_waitcnt vmcnt(11)
v_mfma_f32_16x16x32_bf16 v[24:27], v[186:189], v[84:87], v[24:27]
ds_read_b128 v[236:239], v249 offset:1280
ds_read_u16_d16 v72, v72
ds_read_u16_d16 v74, v74
v_lshrrev_b32 v73, 18, v73
v_pk_mul_f16 v204, v205, v204
v_mfma_f32_16x16x32_bf16 v[28:31], v[184:187], v[84:87], v[28:31]
v_lshrrev_b32_e64 v75, 18, v75
v_mfma_f32_16x16x32_bf16 v[68:71], v[88:91], v[48:51], 0
ds_read_u16_d16_hi v73, v73
ds_read_u16_d16_hi v75, v75
v_exp_f16 v81, v82
v_and_b32 v77, s49, v77
v_mfma_f32_16x16x32_bf16 v[196:199], v[88:91], v[52:55], 0
v_and_b32 v79, s49, v79
s_waitcnt lgkmcnt(6)
v_mfma_f32_16x16x32_f16 v[140:143], v[92:95], v[208:211], v[140:143]
ds_read_b128 v[88:91], v249 offset:2048
v_exp_f16_e64 v206, v207
v_bfe_u32 v76, v77, 2, 14
v_mfma_f32_16x16x32_f16 v[148:151], v[92:95], v[212:215], v[148:151]
v_bfe_u32 v78, v79, 2, 14
v_exp_f16_e64 v203, v204
v_mfma_f32_16x16x32_bf16 v[64:67], v[224:227], v[176:179], v[64:67]
ds_read_b128 v[92:95], v249 offset:2304
ds_read_u16_d16 v76, v76
ds_read_u16_d16 v78, v78
v_lshrrev_b32 v77, 18, v77
v_lshrrev_b32 v79, 18, v79
v_mfma_f32_16x16x32_bf16 v[192:195], v[224:227], v[180:183], v[192:195]
v_exp_f16_sdwa v81, v82 dst_sel:WORD_1 dst_unused:UNUSED_PRESERVE src0_sel:WORD_1
v_mfma_f32_16x16x32_f16 v[152:155], v[228:231], v[208:211], v[152:155]
ds_read_b128 v[224:227], v250 offset:2048
ds_read_u16_d16_hi v77, v77
ds_read_u16_d16_hi v79, v79
v_and_b32 v201, s49, v201
v_bfe_u32 v200, v201, 2, 14
v_mfma_f32_16x16x32_f16 v[160:163], v[228:231], v[212:215], v[160:163]
v_exp_f16_sdwa v206, v207 dst_sel:WORD_1 dst_unused:UNUSED_PRESERVE src0_sel:WORD_1
s_waitcnt lgkmcnt(7)
v_mfma_f32_16x16x32_f16 v[156:159], v[232:235], v[208:211], v[156:159]
ds_read_b128 v[228:231], v250 offset:2304
ds_read_u16_d16 v200, v200
v_lshrrev_b32_e64 v201, 18, v201
v_mfma_f32_16x16x32_f16 v[164:167], v[232:235], v[212:215], v[164:167]
v_exp_f16_sdwa v203, v204 dst_sel:WORD_1 dst_unused:UNUSED_PRESERVE src0_sel:WORD_1
v_pk_add_f16 v81, v81, 1.0 op_sel_hi:[1,0]
v_pk_add_f16 v206, v206, 1.0 op_sel_hi:[1,0]
v_mfma_f32_16x16x32_bf16 v[68:71], v[236:239], v[176:179], v[68:71]
ds_read_b128 v[232:235], v249 offset:6144
ds_read_u16_d16_hi v201, v201
v_pk_add_f16 v203, v203, 1.0 op_sel_hi:[1,0]
v_mfma_f32_16x16x32_bf16 v[196:199], v[236:239], v[180:183], v[196:199]
v_rcp_f16 v82, v81
s_waitcnt lgkmcnt(7)
v_mfma_f32_16x16x32_bf16 v[64:67], v[88:91], v[56:59], v[64:67]
ds_read_b128 v[236:239], v250 offset:3072
v_rcp_f16_e64 v207, v206
v_mfma_f32_16x16x32_bf16 v[192:195], v[88:91], v[60:63], v[192:195]
v_rcp_f16_e64 v204, v203
v_mfma_f32_16x16x32_bf16 v[68:71], v[92:95], v[56:59], v[68:71]
ds_read_b128 v[88:91], v249 offset:6400
v_rcp_f16_sdwa v82, v81 dst_sel:WORD_1 dst_unused:UNUSED_PRESERVE src0_sel:WORD_1
v_mfma_f32_16x16x32_bf16 v[196:199], v[92:95], v[60:63], v[196:199]
v_rcp_f16_sdwa v207, v206 dst_sel:WORD_1 dst_unused:UNUSED_PRESERVE src0_sel:WORD_1
v_or_b32 v208, v72, v73
v_or_b32 v209, v74, v75
s_waitcnt lgkmcnt(4)
v_or_b32 v210, v76, v77
v_rcp_f16_sdwa v204, v203 dst_sel:WORD_1 dst_unused:UNUSED_PRESERVE src0_sel:WORD_1
v_or_b32 v211, v78, v79
s_waitcnt lgkmcnt(2)
v_or_b32_e64 v212, v200, v201
v_pk_mul_f16 v213, v83, v82
v_pk_mul_f16 v214, v80, v207
v_pk_mul_f16 v215, v205, v204
v_mfma_f32_16x16x32_f16 v[120:123], v[224:227], v[208:211], v[120:123]
buffer_load_dwordx4 v[84:87], v252, s[4:7], s68 offen offset:64
ds_read_b128 v[92:95], v250 offset:3328
v_cvt_pkrtz_f16_f32 v73, v64, v65
v_cvt_pkrtz_f16_f32 v75, v66, v67
v_mfma_f32_16x16x32_f16 v[128:131], v[224:227], v[212:215], v[128:131]
v_cvt_pkrtz_f16_f32 v77, v68, v69
v_cvt_pkrtz_f16_f32 v79, v70, v71
v_mfma_f32_16x16x32_f16 v[124:127], v[228:231], v[208:211], v[124:127]
ds_read_b128 v[224:227], v249 offset:7168
v_cvt_pkrtz_f16_f32 v201, v192, v193
v_cvt_pk_f16_f32 v83, v194, v195
v_mfma_f32_16x16x32_f16 v[132:135], v[228:231], v[212:215], v[132:135]
v_cvt_pk_f16_f32 v80, v196, v197
v_cvt_pk_f16_f32 v205, v198, v199
v_pk_fma_f16 v82, v83, v83, s48
v_mfma_f32_16x16x32_bf16 v[64:67], v[232:235], v[48:51], 0
ds_read_b128 v[228:231], v250 offset:4096
v_cvt_pk_bf16_f32 v24, v24, v25
v_and_b32_e64 v73, s49, v73
v_mfma_f32_16x16x32_bf16 v[192:195], v[232:235], v[52:55], 0
v_pk_fma_f16 v207, v80, v80, s48
v_and_b32 v75, s49, v75
s_waitcnt lgkmcnt(3)
v_mfma_f32_16x16x32_f16 v[136:139], v[236:239], v[208:211], v[136:139]
ds_read_b128 v[232:235], v250 offset:4352
v_pk_fma_f16 v204, v205, v205, s48
s_setprio 2
v_bfe_u32 v72, v73, 2, 14
v_pk_mul_f16 v82, v83, v82
v_mfma_f32_16x16x32_f16 v[144:147], v[236:239], v[212:215], v[144:147]
v_bfe_u32 v74, v75, 2, 14
v_pk_mul_f16 v207, v80, v207
s_waitcnt vmcnt(9)
v_mfma_f32_16x16x32_bf16 v[120:123], v[186:189], v[216:219], v[120:123]
ds_read_b128 v[236:239], v249 offset:7424
ds_read_u16_d16 v72, v72
ds_read_u16_d16 v74, v74
v_lshrrev_b32_e64 v73, 18, v73
v_cvt_pk_bf16_f32 v25, v26, v27
v_mfma_f32_16x16x32_bf16 v[124:127], v[184:187], v[216:219], v[124:127]
v_pk_mul_f16 v204, v205, v204
v_lshrrev_b32_e64 v75, 18, v75
v_mfma_f32_16x16x32_bf16 v[68:71], v[88:91], v[48:51], 0
ds_read_u16_d16_hi v73, v73
ds_read_u16_d16_hi v75, v75
v_exp_f16 v81, v82
v_and_b32 v77, s49, v77
v_mfma_f32_16x16x32_bf16 v[196:199], v[88:91], v[52:55], 0
v_and_b32 v79, s49, v79
s_waitcnt lgkmcnt(5)
v_mfma_f32_16x16x32_f16 v[140:143], v[92:95], v[208:211], v[140:143]
ds_read_b128 v[88:91], v249 offset:8192
v_exp_f16_e64 v206, v207
v_bfe_u32 v76, v77, 2, 14
v_mfma_f32_16x16x32_f16 v[148:151], v[92:95], v[212:215], v[148:151]
v_bfe_u32 v78, v79, 2, 14
v_cvt_pk_bf16_f32 v26, v28, v29
v_mfma_f32_16x16x32_bf16 v[64:67], v[224:227], v[176:179], v[64:67]
ds_read_b128 v[92:95], v249 offset:8448
ds_read_u16_d16 v76, v76
ds_read_u16_d16 v78, v78
v_exp_f16 v203, v204
v_lshrrev_b32 v77, 18, v77
v_mfma_f32_16x16x32_bf16 v[192:195], v[224:227], v[180:183], v[192:195]
v_lshrrev_b32_e64 v79, 18, v79
v_mfma_f32_16x16x32_f16 v[152:155], v[228:231], v[208:211], v[152:155]
ds_read_b128 v[224:227], v250 offset:8192
ds_read_u16_d16_hi v77, v77
ds_read_u16_d16_hi v79, v79
v_exp_f16_sdwa v81, v82 dst_sel:WORD_1 dst_unused:UNUSED_PRESERVE src0_sel:WORD_1
v_and_b32_e64 v201, s49, v201
v_bfe_u32 v200, v201, 2, 14
v_mfma_f32_16x16x32_f16 v[160:163], v[228:231], v[212:215], v[160:163]
v_exp_f16_sdwa v206, v207 dst_sel:WORD_1 dst_unused:UNUSED_PRESERVE src0_sel:WORD_1
v_mfma_f32_16x16x32_f16 v[156:159], v[232:235], v[208:211], v[156:159]
ds_read_b128 v[228:231], v250 offset:8448
ds_read_u16_d16 v200, v200
v_cvt_pk_bf16_f32 v27, v30, v31
v_lshrrev_b32 v201, 18, v201
v_mfma_f32_16x16x32_f16 v[164:167], v[232:235], v[212:215], v[164:167]
v_exp_f16_sdwa v203, v204 dst_sel:WORD_1 dst_unused:UNUSED_PRESERVE src0_sel:WORD_1
v_pk_add_f16 v81, v81, 1.0 op_sel_hi:[1,0]
s_waitcnt lgkmcnt(8)
v_mfma_f32_16x16x32_bf16 v[68:71], v[236:239], v[176:179], v[68:71]
ds_read_b128 v[232:235], v249 offset:12288
s_add_u32 s46, s70, 98304
buffer_store_dwordx4 v[24:27], v252, s[8:11], s46 offen offset:64 sc1
ds_read_u16_d16_hi v201, v201
v_pk_add_f16 v206, v206, 1.0 op_sel_hi:[1,0]
v_pk_add_f16 v203, v203, 1.0 op_sel_hi:[1,0]
v_mfma_f32_16x16x32_bf16 v[196:199], v[236:239], v[180:183], v[196:199]
v_rcp_f16_e64 v82, v81
v_mfma_f32_16x16x32_bf16 v[64:67], v[88:91], v[56:59], v[64:67]
ds_read_b128 v[236:239], v250 offset:9216
v_rcp_f16_e64 v207, v206
v_mfma_f32_16x16x32_bf16 v[192:195], v[88:91], v[60:63], v[192:195]
v_rcp_f16 v204, v203
s_waitcnt lgkmcnt(5)
v_mfma_f32_16x16x32_bf16 v[68:71], v[92:95], v[56:59], v[68:71]
ds_read_b128 v[88:91], v249 offset:12544
v_rcp_f16_sdwa v82, v81 dst_sel:WORD_1 dst_unused:UNUSED_PRESERVE src0_sel:WORD_1
v_mfma_f32_16x16x32_bf16 v[196:199], v[92:95], v[60:63], v[196:199]
v_rcp_f16_sdwa v207, v206 dst_sel:WORD_1 dst_unused:UNUSED_PRESERVE src0_sel:WORD_1
v_or_b32 v208, v72, v73
v_or_b32 v209, v74, v75
v_or_b32_e64 v210, v76, v77
v_rcp_f16_sdwa v204, v203 dst_sel:WORD_1 dst_unused:UNUSED_PRESERVE src0_sel:WORD_1
v_or_b32 v211, v78, v79
s_waitcnt lgkmcnt(2)
v_or_b32_e64 v212, v200, v201
v_pk_mul_f16 v213, v83, v82
v_pk_mul_f16 v214, v80, v207
v_pk_mul_f16 v215, v205, v204
v_mfma_f32_16x16x32_f16 v[120:123], v[224:227], v[208:211], v[120:123]
s_add_u32 s46, s68, 98304
buffer_load_dwordx4 v[216:219], v252, s[4:7], s46 offen offset:64
ds_read_b128 v[92:95], v250 offset:9472
v_cvt_pkrtz_f16_f32 v73, v64, v65
v_cvt_pkrtz_f16_f32 v75, v66, v67
v_mfma_f32_16x16x32_f16 v[128:131], v[224:227], v[212:215], v[128:131]
v_cvt_pkrtz_f16_f32 v77, v68, v69
v_cvt_pkrtz_f16_f32 v79, v70, v71
v_mfma_f32_16x16x32_f16 v[124:127], v[228:231], v[208:211], v[124:127]
ds_read_b128 v[224:227], v249 offset:13312
v_cvt_pkrtz_f16_f32 v201, v192, v193
v_cvt_pk_f16_f32 v83, v194, v195
v_mfma_f32_16x16x32_f16 v[132:135], v[228:231], v[212:215], v[132:135]
v_cvt_pk_f16_f32 v80, v196, v197
v_cvt_pk_f16_f32 v205, v198, v199
s_setprio 1
v_mfma_f32_16x16x32_bf16 v[64:67], v[232:235], v[48:51], 0
ds_read_b128 v[228:231], v250 offset:10240
v_pk_fma_f16 v82, v83, v83, s48
v_and_b32 v73, s49, v73
v_mfma_f32_16x16x32_bf16 v[192:195], v[232:235], v[52:55], 0
v_pk_fma_f16 v207, v80, v80, s48
v_and_b32 v75, s49, v75
s_waitcnt lgkmcnt(3)
v_mfma_f32_16x16x32_f16 v[136:139], v[236:239], v[208:211], v[136:139]
ds_read_b128 v[232:235], v250 offset:10496
v_pk_fma_f16 v204, v205, v205, s48
v_bfe_u32 v72, v73, 2, 14
v_pk_mul_f16 v82, v83, v82
v_mfma_f32_16x16x32_f16 v[144:147], v[236:239], v[212:215], v[144:147]
v_bfe_u32 v74, v75, 2, 14
v_pk_mul_f16 v207, v80, v207
s_waitcnt vmcnt(9)
v_mfma_f32_16x16x32_bf16 v[32:35], v[186:189], v[220:223], v[32:35]
ds_read_b128 v[236:239], v249 offset:13568
ds_read_u16_d16 v72, v72
ds_read_u16_d16 v74, v74
v_lshrrev_b32 v73, 18, v73
v_pk_mul_f16 v204, v205, v204
v_mfma_f32_16x16x32_bf16 v[36:39], v[184:187], v[220:223], v[36:39]
v_lshrrev_b32_e64 v75, 18, v75
v_mfma_f32_16x16x32_bf16 v[68:71], v[88:91], v[48:51], 0
ds_read_u16_d16_hi v73, v73
ds_read_u16_d16_hi v75, v75
v_exp_f16 v81, v82
v_and_b32 v77, s49, v77
v_mfma_f32_16x16x32_bf16 v[196:199], v[88:91], v[52:55], 0
v_and_b32 v79, s49, v79
s_waitcnt lgkmcnt(6)
v_mfma_f32_16x16x32_f16 v[140:143], v[92:95], v[208:211], v[140:143]
ds_read_b128 v[88:91], v249 offset:14336
v_exp_f16_e64 v206, v207
v_bfe_u32 v76, v77, 2, 14
v_mfma_f32_16x16x32_f16 v[148:151], v[92:95], v[212:215], v[148:151]
v_bfe_u32 v78, v79, 2, 14
v_exp_f16_e64 v203, v204
v_mfma_f32_16x16x32_bf16 v[64:67], v[224:227], v[176:179], v[64:67]
ds_read_b128 v[92:95], v249 offset:14592
ds_read_u16_d16 v76, v76
ds_read_u16_d16 v78, v78
v_lshrrev_b32 v77, 18, v77
v_lshrrev_b32 v79, 18, v79
v_mfma_f32_16x16x32_bf16 v[192:195], v[224:227], v[180:183], v[192:195]
v_exp_f16_sdwa v81, v82 dst_sel:WORD_1 dst_unused:UNUSED_PRESERVE src0_sel:WORD_1
v_mfma_f32_16x16x32_f16 v[152:155], v[228:231], v[208:211], v[152:155]
ds_read_b128 v[224:227], v250 offset:14336
ds_read_u16_d16_hi v77, v77
ds_read_u16_d16_hi v79, v79
v_and_b32 v201, s49, v201
v_bfe_u32 v200, v201, 2, 14
v_mfma_f32_16x16x32_f16 v[160:163], v[228:231], v[212:215], v[160:163]
v_exp_f16_sdwa v206, v207 dst_sel:WORD_1 dst_unused:UNUSED_PRESERVE src0_sel:WORD_1
s_waitcnt lgkmcnt(7)
v_mfma_f32_16x16x32_f16 v[156:159], v[232:235], v[208:211], v[156:159]
ds_read_b128 v[228:231], v250 offset:14592
ds_read_u16_d16 v200, v200
v_lshrrev_b32_e64 v201, 18, v201
v_mfma_f32_16x16x32_f16 v[164:167], v[232:235], v[212:215], v[164:167]
v_exp_f16_sdwa v203, v204 dst_sel:WORD_1 dst_unused:UNUSED_PRESERVE src0_sel:WORD_1
v_pk_add_f16 v81, v81, 1.0 op_sel_hi:[1,0]
v_pk_add_f16 v206, v206, 1.0 op_sel_hi:[1,0]
v_mfma_f32_16x16x32_bf16 v[68:71], v[236:239], v[176:179], v[68:71]
ds_read_b128 v[232:235], v249 offset:18432
ds_read_u16_d16_hi v201, v201
v_pk_add_f16 v203, v203, 1.0 op_sel_hi:[1,0]
v_mfma_f32_16x16x32_bf16 v[196:199], v[236:239], v[180:183], v[196:199]
v_rcp_f16_e64 v82, v81
s_setprio 0
s_waitcnt lgkmcnt(7)
v_mfma_f32_16x16x32_bf16 v[64:67], v[88:91], v[56:59], v[64:67]
ds_read_b128 v[236:239], v250 offset:15360
v_rcp_f16_e64 v207, v206
v_mfma_f32_16x16x32_bf16 v[192:195], v[88:91], v[60:63], v[192:195]
v_rcp_f16_e64 v204, v203
v_mfma_f32_16x16x32_bf16 v[68:71], v[92:95], v[56:59], v[68:71]
ds_read_b128 v[88:91], v249 offset:18688
v_rcp_f16_sdwa v82, v81 dst_sel:WORD_1 dst_unused:UNUSED_PRESERVE src0_sel:WORD_1
v_mfma_f32_16x16x32_bf16 v[196:199], v[92:95], v[60:63], v[196:199]
v_rcp_f16_sdwa v207, v206 dst_sel:WORD_1 dst_unused:UNUSED_PRESERVE src0_sel:WORD_1
v_or_b32 v208, v72, v73
v_or_b32 v209, v74, v75
s_waitcnt lgkmcnt(4)
v_or_b32 v210, v76, v77
v_rcp_f16_sdwa v204, v203 dst_sel:WORD_1 dst_unused:UNUSED_PRESERVE src0_sel:WORD_1
v_or_b32 v211, v78, v79
s_waitcnt lgkmcnt(2)
v_or_b32 v212, v200, v201
v_pk_mul_f16 v213, v83, v82
v_pk_mul_f16 v214, v80, v207
v_pk_mul_f16 v215, v205, v204
s_setprio 3
v_mfma_f32_16x16x32_f16 v[120:123], v[224:227], v[208:211], v[120:123]
buffer_load_dwordx4 v[220:223], v252, s[4:7], s69 offen
ds_read_b128 v[92:95], v250 offset:15616
v_cvt_pkrtz_f16_f32 v73, v64, v65
v_cvt_pkrtz_f16_f32 v75, v66, v67
v_mfma_f32_16x16x32_f16 v[128:131], v[224:227], v[212:215], v[128:131]
v_cvt_pkrtz_f16_f32 v77, v68, v69
v_cvt_pkrtz_f16_f32 v79, v70, v71
v_mfma_f32_16x16x32_f16 v[124:127], v[228:231], v[208:211], v[124:127]
ds_read_b128 v[224:227], v249 offset:19456
v_cvt_pkrtz_f16_f32 v201, v192, v193
v_cvt_pk_f16_f32 v83, v194, v195
v_mfma_f32_16x16x32_f16 v[132:135], v[228:231], v[212:215], v[132:135]
v_cvt_pk_f16_f32 v80, v196, v197
v_cvt_pk_f16_f32 v205, v198, v199
v_pk_fma_f16 v82, v83, v83, s48
v_mfma_f32_16x16x32_bf16 v[64:67], v[232:235], v[48:51], 0
ds_read_b128 v[228:231], v250 offset:16384
v_cvt_pk_bf16_f32 v32, v32, v33
v_and_b32_e64 v73, s49, v73
v_mfma_f32_16x16x32_bf16 v[192:195], v[232:235], v[52:55], 0
v_pk_fma_f16 v207, v80, v80, s48
v_and_b32 v75, s49, v75
s_waitcnt lgkmcnt(3)
v_mfma_f32_16x16x32_f16 v[136:139], v[236:239], v[208:211], v[136:139]
ds_read_b128 v[232:235], v250 offset:16640
v_pk_fma_f16 v204, v205, v205, s48
v_bfe_u32 v72, v73, 2, 14
v_pk_mul_f16 v82, v83, v82
v_mfma_f32_16x16x32_f16 v[144:147], v[236:239], v[212:215], v[144:147]
v_bfe_u32 v74, v75, 2, 14
v_pk_mul_f16 v207, v80, v207
s_waitcnt vmcnt(8)
v_mfma_f32_16x16x32_bf16 v[128:131], v[186:189], v[240:243], v[128:131]
ds_read_b128 v[236:239], v249 offset:19712
ds_read_u16_d16 v72, v72
ds_read_u16_d16 v74, v74
v_lshrrev_b32 v73, 18, v73
v_cvt_pk_bf16_f32 v33, v34, v35
v_mfma_f32_16x16x32_bf16 v[132:135], v[184:187], v[240:243], v[132:135]
v_pk_mul_f16 v204, v205, v204
v_lshrrev_b32_e64 v75, 18, v75
v_mfma_f32_16x16x32_bf16 v[68:71], v[88:91], v[48:51], 0
ds_read_u16_d16_hi v73, v73
ds_read_u16_d16_hi v75, v75
v_exp_f16 v81, v82
v_and_b32 v77, s49, v77
v_mfma_f32_16x16x32_bf16 v[196:199], v[88:91], v[52:55], 0
v_and_b32 v79, s49, v79
s_waitcnt lgkmcnt(6)
v_mfma_f32_16x16x32_f16 v[140:143], v[92:95], v[208:211], v[140:143]
ds_read_b128 v[88:91], v249 offset:20480
v_exp_f16_e64 v206, v207
v_bfe_u32 v76, v77, 2, 14
v_mfma_f32_16x16x32_f16 v[148:151], v[92:95], v[212:215], v[148:151]
v_bfe_u32 v78, v79, 2, 14
v_cvt_pk_bf16_f32 v34, v36, v37
v_mfma_f32_16x16x32_bf16 v[64:67], v[224:227], v[176:179], v[64:67]
ds_read_b128 v[92:95], v249 offset:20736
ds_read_u16_d16 v76, v76
ds_read_u16_d16 v78, v78
v_exp_f16 v203, v204
v_lshrrev_b32 v77, 18, v77
v_mfma_f32_16x16x32_bf16 v[192:195], v[224:227], v[180:183], v[192:195]
v_lshrrev_b32_e64 v79, 18, v79
v_mfma_f32_16x16x32_f16 v[152:155], v[228:231], v[208:211], v[152:155]
ds_read_b128 v[224:227], v250 offset:20480
ds_read_u16_d16_hi v77, v77
ds_read_u16_d16_hi v79, v79
v_exp_f16_sdwa v81, v82 dst_sel:WORD_1 dst_unused:UNUSED_PRESERVE src0_sel:WORD_1
v_and_b32 v201, s49, v201
v_bfe_u32 v200, v201, 2, 14
v_mfma_f32_16x16x32_f16 v[160:163], v[228:231], v[212:215], v[160:163]
v_exp_f16_sdwa v206, v207 dst_sel:WORD_1 dst_unused:UNUSED_PRESERVE src0_sel:WORD_1
s_waitcnt lgkmcnt(7)
v_mfma_f32_16x16x32_f16 v[156:159], v[232:235], v[208:211], v[156:159]
ds_read_b128 v[228:231], v250 offset:20736
ds_read_u16_d16 v200, v200
v_cvt_pk_bf16_f32 v35, v38, v39
v_lshrrev_b32_e64 v201, 18, v201
v_mfma_f32_16x16x32_f16 v[164:167], v[232:235], v[212:215], v[164:167]
v_exp_f16_sdwa v203, v204 dst_sel:WORD_1 dst_unused:UNUSED_PRESERVE src0_sel:WORD_1
v_pk_add_f16 v81, v81, 1.0 op_sel_hi:[1,0]
v_mfma_f32_16x16x32_bf16 v[68:71], v[236:239], v[176:179], v[68:71]
ds_read_b128 v[232:235], v248 offset:16384
buffer_store_dwordx4 v[32:35], v252, s[8:11], s70 offen offset:128 sc1
ds_read_u16_d16_hi v201, v201
v_pk_add_f16 v206, v206, 1.0 op_sel_hi:[1,0]
v_pk_add_f16 v203, v203, 1.0 op_sel_hi:[1,0]
v_mfma_f32_16x16x32_bf16 v[196:199], v[236:239], v[180:183], v[196:199]
v_rcp_f16 v82, v81
s_waitcnt lgkmcnt(6)
v_mfma_f32_16x16x32_bf16 v[64:67], v[88:91], v[56:59], v[64:67]
ds_read_b128 v[236:239], v250 offset:21504
v_rcp_f16_e64 v207, v206
v_mfma_f32_16x16x32_bf16 v[192:195], v[88:91], v[60:63], v[192:195]
v_rcp_f16_e64 v204, v203
v_mfma_f32_16x16x32_bf16 v[68:71], v[92:95], v[56:59], v[68:71]
ds_read_b128 v[88:91], v248 offset:16640
v_rcp_f16_sdwa v82, v81 dst_sel:WORD_1 dst_unused:UNUSED_PRESERVE src0_sel:WORD_1
v_mfma_f32_16x16x32_bf16 v[196:199], v[92:95], v[60:63], v[196:199]
v_rcp_f16_sdwa v207, v206 dst_sel:WORD_1 dst_unused:UNUSED_PRESERVE src0_sel:WORD_1
v_or_b32 v208, v72, v73
v_or_b32 v209, v74, v75
s_waitcnt lgkmcnt(4)
v_or_b32 v210, v76, v77
v_rcp_f16_sdwa v204, v203 dst_sel:WORD_1 dst_unused:UNUSED_PRESERVE src0_sel:WORD_1
v_or_b32 v211, v78, v79
s_waitcnt lgkmcnt(2)
v_or_b32_e64 v212, v200, v201
v_pk_mul_f16 v213, v83, v82
v_pk_mul_f16 v214, v80, v207
v_pk_mul_f16 v215, v205, v204
v_mfma_f32_16x16x32_f16 v[120:123], v[224:227], v[208:211], v[120:123]
buffer_load_dwordx4 v[240:243], v252, s[4:7], s68 offen offset:128
ds_read_b128 v[92:95], v250 offset:21760
v_cvt_pkrtz_f16_f32 v73, v64, v65
v_cvt_pkrtz_f16_f32 v75, v66, v67
v_mfma_f32_16x16x32_f16 v[128:131], v[224:227], v[212:215], v[128:131]
v_cvt_pkrtz_f16_f32 v77, v68, v69
v_cvt_pkrtz_f16_f32 v79, v70, v71
v_mfma_f32_16x16x32_f16 v[124:127], v[228:231], v[208:211], v[124:127]
ds_read_b128 v[224:227], v248 offset:17408
v_cvt_pkrtz_f16_f32 v201, v192, v193
v_cvt_pk_f16_f32 v83, v194, v195
v_mfma_f32_16x16x32_f16 v[132:135], v[228:231], v[212:215], v[132:135]
v_cvt_pk_f16_f32 v80, v196, v197
v_cvt_pk_f16_f32 v205, v198, v199
v_mfma_f32_16x16x32_bf16 v[64:67], v[232:235], v[96:99], 0
ds_read_b128 v[228:231], v250 offset:22528
v_pk_fma_f16 v82, v83, v83, s48
v_and_b32_e64 v73, s49, v73
v_mfma_f32_16x16x32_bf16 v[192:195], v[232:235], v[100:103], 0
v_pk_fma_f16 v207, v80, v80, s48
v_and_b32 v75, s49, v75
s_waitcnt lgkmcnt(3)
v_mfma_f32_16x16x32_f16 v[136:139], v[236:239], v[208:211], v[136:139]
ds_read_b128 v[232:235], v250 offset:22784
v_pk_fma_f16 v204, v205, v205, s48
s_setprio 2
v_bfe_u32 v72, v73, 2, 14
v_pk_mul_f16 v82, v83, v82
v_mfma_f32_16x16x32_f16 v[144:147], v[236:239], v[212:215], v[144:147]
v_bfe_u32 v74, v75, 2, 14
v_pk_mul_f16 v207, v80, v207
s_waitcnt vmcnt(8)
v_mfma_f32_16x16x32_bf16 v[40:43], v[186:189], v[244:247], v[40:43]
ds_read_b128 v[236:239], v248 offset:17664
ds_read_u16_d16 v72, v72
ds_read_u16_d16 v74, v74
v_lshrrev_b32_e64 v73, 18, v73
v_pk_mul_f16 v204, v205, v204
v_mfma_f32_16x16x32_bf16 v[44:47], v[184:187], v[244:247], v[44:47]
v_lshrrev_b32_e64 v75, 18, v75
v_mfma_f32_16x16x32_bf16 v[68:71], v[88:91], v[96:99], 0
ds_read_u16_d16_hi v73, v73
ds_read_u16_d16_hi v75, v75
v_exp_f16 v81, v82
v_and_b32 v77, s49, v77
v_mfma_f32_16x16x32_bf16 v[196:199], v[88:91], v[100:103], 0
v_and_b32 v79, s49, v79
s_waitcnt lgkmcnt(6)
v_mfma_f32_16x16x32_f16 v[140:143], v[92:95], v[208:211], v[140:143]
ds_read_b128 v[88:91], v248 offset:18432
v_exp_f16_e64 v206, v207
v_bfe_u32 v76, v77, 2, 14
v_mfma_f32_16x16x32_f16 v[148:151], v[92:95], v[212:215], v[148:151]
v_bfe_u32 v78, v79, 2, 14
v_exp_f16_e64 v203, v204
v_mfma_f32_16x16x32_bf16 v[64:67], v[224:227], v[104:107], v[64:67]
ds_read_b128 v[92:95], v248 offset:18688
ds_read_u16_d16 v76, v76
ds_read_u16_d16 v78, v78
v_lshrrev_b32 v77, 18, v77
v_lshrrev_b32 v79, 18, v79
v_mfma_f32_16x16x32_bf16 v[192:195], v[224:227], v[108:111], v[192:195]
v_exp_f16_sdwa v81, v82 dst_sel:WORD_1 dst_unused:UNUSED_PRESERVE src0_sel:WORD_1
v_mfma_f32_16x16x32_f16 v[152:155], v[228:231], v[208:211], v[152:155]
ds_read_b128 v[224:227], v250 offset:26624
ds_read_u16_d16_hi v77, v77
ds_read_u16_d16_hi v79, v79
v_and_b32 v201, s49, v201
v_bfe_u32 v200, v201, 2, 14
v_mfma_f32_16x16x32_f16 v[160:163], v[228:231], v[212:215], v[160:163]
v_exp_f16_sdwa v206, v207 dst_sel:WORD_1 dst_unused:UNUSED_PRESERVE src0_sel:WORD_1
s_waitcnt lgkmcnt(7)
v_mfma_f32_16x16x32_f16 v[156:159], v[232:235], v[208:211], v[156:159]
ds_read_b128 v[228:231], v250 offset:26880
ds_read_u16_d16 v200, v200
v_lshrrev_b32_e64 v201, 18, v201
v_mfma_f32_16x16x32_f16 v[164:167], v[232:235], v[212:215], v[164:167]
v_exp_f16_sdwa v203, v204 dst_sel:WORD_1 dst_unused:UNUSED_PRESERVE src0_sel:WORD_1
v_pk_add_f16 v81, v81, 1.0 op_sel_hi:[1,0]
v_pk_add_f16 v206, v206, 1.0 op_sel_hi:[1,0]
v_mfma_f32_16x16x32_bf16 v[68:71], v[236:239], v[104:107], v[68:71]
ds_read_b128 v[232:235], v248 offset:22528
ds_read_u16_d16_hi v201, v201
v_pk_add_f16 v203, v203, 1.0 op_sel_hi:[1,0]
v_mfma_f32_16x16x32_bf16 v[196:199], v[236:239], v[108:111], v[196:199]
v_rcp_f16 v82, v81
s_waitcnt lgkmcnt(7)
v_mfma_f32_16x16x32_bf16 v[64:67], v[88:91], v[112:115], v[64:67]
ds_read_b128 v[236:239], v250 offset:27648
v_rcp_f16 v207, v206
s_waitcnt vmcnt(7)
v_mfma_f32_16x16x32_bf16 v[192:195], v[88:91], v[116:119], v[192:195]
v_rcp_f16_e64 v204, v203
v_mfma_f32_16x16x32_bf16 v[68:71], v[92:95], v[112:115], v[68:71]
ds_read_b128 v[88:91], v248 offset:22784
v_rcp_f16_sdwa v82, v81 dst_sel:WORD_1 dst_unused:UNUSED_PRESERVE src0_sel:WORD_1
v_mfma_f32_16x16x32_bf16 v[196:199], v[92:95], v[116:119], v[196:199]
v_rcp_f16_sdwa v207, v206 dst_sel:WORD_1 dst_unused:UNUSED_PRESERVE src0_sel:WORD_1
v_or_b32 v208, v72, v73
v_or_b32 v209, v74, v75
s_waitcnt lgkmcnt(4)
v_or_b32 v210, v76, v77
v_rcp_f16_sdwa v204, v203 dst_sel:WORD_1 dst_unused:UNUSED_PRESERVE src0_sel:WORD_1
v_or_b32 v211, v78, v79
s_waitcnt lgkmcnt(2)
v_or_b32_e64 v212, v200, v201
v_pk_mul_f16 v213, v83, v82
v_pk_mul_f16 v214, v80, v207
v_pk_mul_f16 v215, v205, v204
v_mfma_f32_16x16x32_f16 v[120:123], v[224:227], v[208:211], v[120:123]
s_add_u32 s46, s69, 98304
buffer_load_dwordx4 v[244:247], v252, s[4:7], s46 offen
ds_read_b128 v[92:95], v250 offset:27904
v_cvt_pkrtz_f16_f32 v73, v64, v65
v_cvt_pkrtz_f16_f32 v75, v66, v67
v_mfma_f32_16x16x32_f16 v[128:131], v[224:227], v[212:215], v[128:131]
v_cvt_pkrtz_f16_f32 v77, v68, v69
v_cvt_pkrtz_f16_f32 v79, v70, v71
v_mfma_f32_16x16x32_f16 v[124:127], v[228:231], v[208:211], v[124:127]
ds_read_b128 v[224:227], v248 offset:23552
v_cvt_pkrtz_f16_f32 v201, v192, v193
v_cvt_pk_f16_f32 v83, v194, v195
v_mfma_f32_16x16x32_f16 v[132:135], v[228:231], v[212:215], v[132:135]
v_cvt_pk_f16_f32 v80, v196, v197
v_cvt_pk_f16_f32 v205, v198, v199
s_setprio 1
v_pk_fma_f16 v82, v83, v83, s48
v_mfma_f32_16x16x32_bf16 v[64:67], v[232:235], v[96:99], 0
ds_read_b128 v[228:231], v250 offset:28672
v_cvt_pk_bf16_f32 v40, v40, v41
v_and_b32 v73, s49, v73
v_mfma_f32_16x16x32_bf16 v[192:195], v[232:235], v[100:103], 0
v_pk_fma_f16 v207, v80, v80, s48
v_and_b32 v75, s49, v75
s_waitcnt lgkmcnt(3)
v_mfma_f32_16x16x32_f16 v[136:139], v[236:239], v[208:211], v[136:139]
ds_read_b128 v[232:235], v250 offset:28928
v_pk_fma_f16 v204, v205, v205, s48
v_bfe_u32 v72, v73, 2, 14
v_pk_mul_f16 v82, v83, v82
v_mfma_f32_16x16x32_f16 v[144:147], v[236:239], v[212:215], v[144:147]
v_bfe_u32 v74, v75, 2, 14
v_pk_mul_f16 v207, v80, v207
s_waitcnt vmcnt(6)
v_mfma_f32_16x16x32_bf16 v[136:139], v[186:189], v[84:87], v[136:139]
ds_read_b128 v[236:239], v248 offset:23808
ds_read_u16_d16 v72, v72
ds_read_u16_d16 v74, v74
v_lshrrev_b32 v73, 18, v73
v_cvt_pk_bf16_f32 v41, v42, v43
v_mfma_f32_16x16x32_bf16 v[140:143], v[184:187], v[84:87], v[140:143]
v_pk_mul_f16 v204, v205, v204
v_lshrrev_b32_e64 v75, 18, v75
v_mfma_f32_16x16x32_bf16 v[68:71], v[88:91], v[96:99], 0
ds_read_u16_d16_hi v73, v73
ds_read_u16_d16_hi v75, v75
v_exp_f16 v81, v82
v_and_b32 v77, s49, v77
v_mfma_f32_16x16x32_bf16 v[196:199], v[88:91], v[100:103], 0
v_and_b32 v79, s49, v79
s_waitcnt lgkmcnt(6)
v_mfma_f32_16x16x32_f16 v[140:143], v[92:95], v[208:211], v[140:143]
ds_read_b128 v[88:91], v248 offset:24576
v_exp_f16_e64 v206, v207
v_bfe_u32 v76, v77, 2, 14
v_mfma_f32_16x16x32_f16 v[148:151], v[92:95], v[212:215], v[148:151]
v_bfe_u32 v78, v79, 2, 14
v_cvt_pk_bf16_f32 v42, v44, v45
v_mfma_f32_16x16x32_bf16 v[64:67], v[224:227], v[104:107], v[64:67]
ds_read_b128 v[92:95], v248 offset:24832
ds_read_u16_d16 v76, v76
ds_read_u16_d16 v78, v78
v_exp_f16 v203, v204
v_lshrrev_b32 v77, 18, v77
v_mfma_f32_16x16x32_bf16 v[192:195], v[224:227], v[108:111], v[192:195]
v_lshrrev_b32_e64 v79, 18, v79
v_mfma_f32_16x16x32_f16 v[152:155], v[228:231], v[208:211], v[152:155]
ds_read_b128 v[224:227], v249 offset:24576
ds_read_u16_d16_hi v77, v77
ds_read_u16_d16_hi v79, v79
v_exp_f16_sdwa v81, v82 dst_sel:WORD_1 dst_unused:UNUSED_PRESERVE src0_sel:WORD_1
v_and_b32 v201, s49, v201
v_bfe_u32 v200, v201, 2, 14
v_mfma_f32_16x16x32_f16 v[160:163], v[228:231], v[212:215], v[160:163]
v_exp_f16_sdwa v206, v207 dst_sel:WORD_1 dst_unused:UNUSED_PRESERVE src0_sel:WORD_1
s_waitcnt lgkmcnt(7)
v_mfma_f32_16x16x32_f16 v[156:159], v[232:235], v[208:211], v[156:159]
ds_read_b128 v[228:231], v254 offset:7936
ds_read_u16_d16 v200, v200
v_cvt_pk_bf16_f32 v43, v46, v47
v_lshrrev_b32_e64 v201, 18, v201
v_mfma_f32_16x16x32_f16 v[164:167], v[232:235], v[212:215], v[164:167]
v_exp_f16_sdwa v203, v204 dst_sel:WORD_1 dst_unused:UNUSED_PRESERVE src0_sel:WORD_1
v_pk_add_f16 v81, v81, 1.0 op_sel_hi:[1,0]
v_mfma_f32_16x16x32_bf16 v[68:71], v[236:239], v[104:107], v[68:71]
ds_read_b128 v[232:235], v249 offset:24832
s_add_u32 s46, s70, 98304
buffer_store_dwordx4 v[40:43], v252, s[8:11], s46 offen offset:128 sc1
ds_read_u16_d16_hi v201, v201
v_pk_add_f16 v206, v206, 1.0 op_sel_hi:[1,0]
v_pk_add_f16 v203, v203, 1.0 op_sel_hi:[1,0]
s_setprio 0
v_mfma_f32_16x16x32_bf16 v[196:199], v[236:239], v[108:111], v[196:199]
v_rcp_f16_e64 v82, v81
s_waitcnt lgkmcnt(4)
v_mfma_f32_16x16x32_bf16 v[64:67], v[88:91], v[112:115], v[64:67]
ds_read_b128 v[236:239], v254 offset:7952
v_rcp_f16_e64 v207, v206
v_mfma_f32_16x16x32_bf16 v[192:195], v[88:91], v[116:119], v[192:195]
v_rcp_f16_e64 v204, v203
v_mfma_f32_16x16x32_bf16 v[68:71], v[92:95], v[112:115], v[68:71]
ds_read_b128 v[88:91], v248 offset:28672
v_rcp_f16_sdwa v82, v81 dst_sel:WORD_1 dst_unused:UNUSED_PRESERVE src0_sel:WORD_1
v_mfma_f32_16x16x32_bf16 v[196:199], v[92:95], v[116:119], v[196:199]
v_rcp_f16_sdwa v207, v206 dst_sel:WORD_1 dst_unused:UNUSED_PRESERVE src0_sel:WORD_1
v_or_b32 v208, v72, v73
v_or_b32 v209, v74, v75
v_or_b32_e64 v210, v76, v77
v_rcp_f16_sdwa v204, v203 dst_sel:WORD_1 dst_unused:UNUSED_PRESERVE src0_sel:WORD_1
v_or_b32 v211, v78, v79
s_waitcnt lgkmcnt(2)
v_or_b32_e64 v212, v200, v201
v_pk_mul_f16 v213, v83, v82
v_pk_mul_f16 v214, v80, v207
v_pk_mul_f16 v215, v205, v204
s_setprio 3
v_mfma_f32_16x16x32_f16 v[0:3], v[224:227], v[208:211], v[228:231]
s_add_u32 s46, s68, 98304
buffer_load_dwordx4 v[84:87], v252, s[4:7], s46 offen offset:128
ds_read_b128 v[92:95], v249 offset:25600
v_cvt_pkrtz_f16_f32 v73, v64, v65
v_cvt_pkrtz_f16_f32 v75, v66, v67
v_mfma_f32_16x16x32_f16 v[8:11], v[224:227], v[212:215], v[228:231]
v_cvt_pkrtz_f16_f32 v77, v68, v69
v_cvt_pkrtz_f16_f32 v79, v70, v71
v_cvt_pkrtz_f16_f32 v201, v192, v193
s_waitcnt lgkmcnt(1)
v_mfma_f32_16x16x32_f16 v[4:7], v[232:235], v[208:211], v[236:239]
ds_read_b128 v[224:227], v254 offset:8064
ds_read_b128 v[228:231], v248 offset:28928
v_cvt_pk_f16_f32 v83, v194, v195
v_cvt_pk_f16_f32 v80, v196, v197
v_mfma_f32_16x16x32_f16 v[12:15], v[232:235], v[212:215], v[236:239]
v_cvt_pk_f16_f32 v205, v198, v199
v_pk_fma_f16 v82, v83, v83, s48
v_cvt_pk_bf16_f32 v120, v120, v121
v_mfma_f32_16x16x32_bf16 v[64:67], v[88:91], v[96:99], 0
ds_read_b128 v[232:235], v249 offset:25856
ds_read_b128 v[236:239], v254 offset:8080
v_and_b32_e64 v73, s49, v73
v_pk_fma_f16 v207, v80, v80, s48
v_mfma_f32_16x16x32_bf16 v[192:195], v[88:91], v[100:103], 0
v_and_b32 v75, s49, v75
v_pk_fma_f16 v204, v205, v205, s48
v_bfe_u32 v72, v73, 2, 14
s_waitcnt lgkmcnt(3)
v_mfma_f32_16x16x32_f16 v[16:19], v[92:95], v[208:211], v[224:227]
ds_read_b128 v[88:91], v248 offset:29696
ds_read_u16_d16 v72, v72
v_pk_mul_f16 v82, v83, v82
v_bfe_u32 v74, v75, 2, 14
v_mfma_f32_16x16x32_f16 v[24:27], v[92:95], v[212:215], v[224:227]
v_pk_mul_f16 v207, v80, v207
v_lshrrev_b32 v73, 18, v73
v_cvt_pk_bf16_f32 v121, v122, v123
s_waitcnt lgkmcnt(4)
v_mfma_f32_16x16x32_bf16 v[68:71], v[228:231], v[96:99], 0
ds_read_b128 v[92:95], v249 offset:26624
ds_read_b128 v[224:227], v254 offset:16128
ds_read_u16_d16 v74, v74
ds_read_u16_d16_hi v73, v73
v_pk_mul_f16 v204, v205, v204
v_lshrrev_b32_e64 v75, 18, v75
v_mfma_f32_16x16x32_bf16 v[196:199], v[228:231], v[100:103], 0
v_exp_f16_e64 v81, v82
v_and_b32 v77, s49, v77
s_waitcnt lgkmcnt(6)
v_mfma_f32_16x16x32_f16 v[20:23], v[232:235], v[208:211], v[236:239]
ds_read_b128 v[228:231], v249 offset:26880
ds_read_u16_d16_hi v75, v75
v_and_b32_e64 v79, s49, v79
v_mfma_f32_16x16x32_f16 v[28:31], v[232:235], v[212:215], v[236:239]
v_exp_f16 v206, v207
v_bfe_u32 v76, v77, 2, 14
v_bfe_u32 v78, v79, 2, 14
s_waitcnt lgkmcnt(6)
v_mfma_f32_16x16x32_bf16 v[64:67], v[88:91], v[104:107], v[64:67]
ds_read_b128 v[232:235], v254 offset:16144
ds_read_b128 v[236:239], v248 offset:29952
ds_read_u16_d16 v76, v76
ds_read_u16_d16 v78, v78
v_cvt_pk_bf16_f32 v122, v124, v125
v_mfma_f32_16x16x32_bf16 v[192:195], v[88:91], v[108:111], v[192:195]
v_exp_f16 v203, v204
v_lshrrev_b32 v77, 18, v77
v_lshrrev_b32 v79, 18, v79
s_waitcnt lgkmcnt(6)
v_mfma_f32_16x16x32_f16 v[32:35], v[92:95], v[208:211], v[224:227]
ds_read_b128 v[88:91], v248 offset:30720
ds_read_u16_d16_hi v77, v77
ds_read_u16_d16_hi v79, v79
v_exp_f16_sdwa v81, v82 dst_sel:WORD_1 dst_unused:UNUSED_PRESERVE src0_sel:WORD_1
v_mfma_f32_16x16x32_f16 v[40:43], v[92:95], v[212:215], v[224:227]
v_and_b32 v201, s49, v201
v_bfe_u32 v200, v201, 2, 14
s_waitcnt lgkmcnt(6)
v_mfma_f32_16x16x32_f16 v[36:39], v[228:231], v[208:211], v[232:235]
ds_read_b128 v[92:95], v248 offset:30976
ds_read_b128 v[224:227], v249 offset:30720
ds_read_u16_d16 v200, v200
v_exp_f16_sdwa v206, v207 dst_sel:WORD_1 dst_unused:UNUSED_PRESERVE src0_sel:WORD_1
v_cvt_pk_bf16_f32 v123, v126, v127
v_mfma_f32_16x16x32_f16 v[44:47], v[228:231], v[212:215], v[232:235]
v_lshrrev_b32 v201, 18, v201
v_exp_f16_sdwa v203, v204 dst_sel:WORD_1 dst_unused:UNUSED_PRESERVE src0_sel:WORD_1
s_waitcnt lgkmcnt(6)
v_mfma_f32_16x16x32_bf16 v[68:71], v[236:239], v[104:107], v[68:71]
ds_read_b128 v[228:231], v249 offset:30976
ds_read_b128 v[232:235], v248 offset:34816
buffer_store_dwordx4 v[120:123], v252, s[8:11], s68 offen sc1
ds_read_u16_d16_hi v201, v201
v_pk_add_f16 v81, v81, 1.0 op_sel_hi:[1,0]
v_pk_add_f16 v206, v206, 1.0 op_sel_hi:[1,0]
v_mfma_f32_16x16x32_bf16 v[196:199], v[236:239], v[108:111], v[196:199]
v_pk_add_f16 v203, v203, 1.0 op_sel_hi:[1,0]
v_rcp_f16 v82, v81
s_waitcnt lgkmcnt(6)
v_mfma_f32_16x16x32_bf16 v[64:67], v[88:91], v[112:115], v[64:67]
ds_read_b128 v[236:239], v249 offset:31744
v_rcp_f16_e64 v207, v206
v_mfma_f32_16x16x32_bf16 v[192:195], v[88:91], v[116:119], v[192:195]
v_rcp_f16 v204, v203
s_waitcnt lgkmcnt(6)
v_mfma_f32_16x16x32_bf16 v[68:71], v[92:95], v[112:115], v[68:71]
ds_read_b128 v[88:91], v248 offset:35072
v_rcp_f16_sdwa v82, v81 dst_sel:WORD_1 dst_unused:UNUSED_PRESERVE src0_sel:WORD_1
v_mfma_f32_16x16x32_bf16 v[196:199], v[92:95], v[116:119], v[196:199]
v_rcp_f16_sdwa v207, v206 dst_sel:WORD_1 dst_unused:UNUSED_PRESERVE src0_sel:WORD_1
v_or_b32 v208, v72, v73
v_or_b32 v209, v74, v75
v_or_b32_e64 v210, v76, v77
v_rcp_f16_sdwa v204, v203 dst_sel:WORD_1 dst_unused:UNUSED_PRESERVE src0_sel:WORD_1
v_or_b32 v211, v78, v79
s_waitcnt lgkmcnt(2)
v_or_b32_e64 v212, v200, v201
v_pk_mul_f16 v213, v83, v82
v_pk_mul_f16 v214, v80, v207
v_pk_mul_f16 v215, v205, v204
v_mfma_f32_16x16x32_f16 v[0:3], v[224:227], v[208:211], v[0:3]
ds_read_b128 v[92:95], v249 offset:32000
v_cvt_pkrtz_f16_f32 v73, v64, v65
v_cvt_pkrtz_f16_f32 v75, v66, v67
v_mfma_f32_16x16x32_f16 v[8:11], v[224:227], v[212:215], v[8:11]
v_cvt_pkrtz_f16_f32 v77, v68, v69
v_cvt_pkrtz_f16_f32 v79, v70, v71
v_mfma_f32_16x16x32_f16 v[4:7], v[228:231], v[208:211], v[4:7]
ds_read_b128 v[224:227], v248 offset:35840
v_cvt_pkrtz_f16_f32 v201, v192, v193
v_cvt_pk_f16_f32 v83, v194, v195
v_mfma_f32_16x16x32_f16 v[12:15], v[228:231], v[212:215], v[12:15]
v_cvt_pk_f16_f32 v80, v196, v197
v_cvt_pk_f16_f32 v205, v198, v199
v_mfma_f32_16x16x32_bf16 v[64:67], v[232:235], v[96:99], 0
ds_read_b128 v[228:231], v249 offset:32768
v_pk_fma_f16 v82, v83, v83, s48
v_and_b32_e64 v73, s49, v73
v_mfma_f32_16x16x32_bf16 v[192:195], v[232:235], v[100:103], 0
v_pk_fma_f16 v207, v80, v80, s48
v_and_b32 v75, s49, v75
s_waitcnt lgkmcnt(3)
v_mfma_f32_16x16x32_f16 v[16:19], v[236:239], v[208:211], v[16:19]
ds_read_b128 v[232:235], v249 offset:33024
v_pk_fma_f16 v204, v205, v205, s48
s_setprio 2
v_bfe_u32 v72, v73, 2, 14
v_mfma_f32_16x16x32_f16 v[24:27], v[236:239], v[212:215], v[24:27]
v_pk_mul_f16 v82, v83, v82
v_bfe_u32 v74, v75, 2, 14
s_waitcnt vmcnt(7)
v_mfma_f32_16x16x32_bf16 v[144:147], v[186:189], v[216:219], v[144:147]
ds_read_b128 v[236:239], v248 offset:36096
ds_read_u16_d16 v72, v72
ds_read_u16_d16 v74, v74
v_pk_mul_f16 v207, v80, v207
v_lshrrev_b32_e64 v73, 18, v73
v_mfma_f32_16x16x32_bf16 v[148:151], v[184:187], v[216:219], v[148:151]
v_pk_mul_f16 v204, v205, v204
v_lshrrev_b32_e64 v75, 18, v75
v_mfma_f32_16x16x32_bf16 v[68:71], v[88:91], v[96:99], 0
ds_read_u16_d16_hi v73, v73
ds_read_u16_d16_hi v75, v75
v_exp_f16_e64 v81, v82
v_mfma_f32_16x16x32_bf16 v[196:199], v[88:91], v[100:103], 0
v_and_b32_e64 v77, s49, v77
v_and_b32 v79, s49, v79
s_waitcnt lgkmcnt(6)
v_mfma_f32_16x16x32_f16 v[20:23], v[92:95], v[208:211], v[20:23]
ds_read_b128 v[88:91], v248 offset:36864
v_exp_f16_e64 v206, v207
v_mfma_f32_16x16x32_f16 v[28:31], v[92:95], v[212:215], v[28:31]
v_bfe_u32 v76, v77, 2, 14
v_bfe_u32 v78, v79, 2, 14
v_mfma_f32_16x16x32_bf16 v[64:67], v[224:227], v[104:107], v[64:67]
ds_read_b128 v[92:95], v248 offset:37120
ds_read_u16_d16 v76, v76
ds_read_u16_d16 v78, v78
v_exp_f16_e64 v203, v204
v_mfma_f32_16x16x32_bf16 v[192:195], v[224:227], v[108:111], v[192:195]
v_lshrrev_b32 v77, 18, v77
v_lshrrev_b32 v79, 18, v79
v_mfma_f32_16x16x32_f16 v[32:35], v[228:231], v[208:211], v[32:35]
ds_read_b128 v[224:227], v249 offset:36864
ds_read_u16_d16_hi v77, v77
ds_read_u16_d16_hi v79, v79
v_exp_f16_sdwa v81, v82 dst_sel:WORD_1 dst_unused:UNUSED_PRESERVE src0_sel:WORD_1
v_mfma_f32_16x16x32_f16 v[40:43], v[228:231], v[212:215], v[40:43]
v_and_b32 v201, s49, v201
v_bfe_u32 v200, v201, 2, 14
s_waitcnt lgkmcnt(7)
v_mfma_f32_16x16x32_f16 v[36:39], v[232:235], v[208:211], v[36:39]
ds_read_b128 v[228:231], v249 offset:37120
ds_read_u16_d16 v200, v200
v_exp_f16_sdwa v206, v207 dst_sel:WORD_1 dst_unused:UNUSED_PRESERVE src0_sel:WORD_1
v_mfma_f32_16x16x32_f16 v[44:47], v[232:235], v[212:215], v[44:47]
v_lshrrev_b32 v201, 18, v201
s_waitcnt vmcnt(6)
v_mfma_f32_16x16x32_bf16 v[0:3], v[186:189], v[220:223], v[0:3]
ds_read_b128 v[232:235], v248 offset:40960
ds_read_u16_d16_hi v201, v201
v_exp_f16_sdwa v203, v204 dst_sel:WORD_1 dst_unused:UNUSED_PRESERVE src0_sel:WORD_1
v_pk_add_f16 v81, v81, 1.0 op_sel_hi:[1,0]
v_mfma_f32_16x16x32_bf16 v[4:7], v[184:187], v[220:223], v[4:7]
v_pk_add_f16 v206, v206, 1.0 op_sel_hi:[1,0]
v_pk_add_f16 v203, v203, 1.0 op_sel_hi:[1,0]
v_mfma_f32_16x16x32_bf16 v[68:71], v[236:239], v[104:107], v[68:71]
v_rcp_f16_e64 v82, v81
v_mfma_f32_16x16x32_bf16 v[196:199], v[236:239], v[108:111], v[196:199]
v_rcp_f16 v207, v206
s_waitcnt lgkmcnt(4)
v_mfma_f32_16x16x32_bf16 v[64:67], v[88:91], v[112:115], v[64:67]
ds_read_b128 v[236:239], v249 offset:37888
v_rcp_f16_e64 v204, v203
v_mfma_f32_16x16x32_bf16 v[192:195], v[88:91], v[116:119], v[192:195]
v_rcp_f16_sdwa v82, v81 dst_sel:WORD_1 dst_unused:UNUSED_PRESERVE src0_sel:WORD_1
v_mfma_f32_16x16x32_bf16 v[68:71], v[92:95], v[112:115], v[68:71]
ds_read_b128 v[88:91], v248 offset:41216
v_rcp_f16_sdwa v207, v206 dst_sel:WORD_1 dst_unused:UNUSED_PRESERVE src0_sel:WORD_1
v_mfma_f32_16x16x32_bf16 v[196:199], v[92:95], v[116:119], v[196:199]
v_or_b32 v208, v72, v73
v_or_b32 v209, v74, v75
v_or_b32_e64 v210, v76, v77
v_rcp_f16_sdwa v204, v203 dst_sel:WORD_1 dst_unused:UNUSED_PRESERVE src0_sel:WORD_1
v_or_b32 v211, v78, v79
s_waitcnt lgkmcnt(2)
v_or_b32_e64 v212, v200, v201
v_pk_mul_f16 v213, v83, v82
v_pk_mul_f16 v214, v80, v207
v_pk_mul_f16 v215, v205, v204
v_mfma_f32_16x16x32_f16 v[0:3], v[224:227], v[208:211], v[0:3]
buffer_load_dwordx4 v[216:219], v252, s[4:7], s69 offen offset:64
ds_read_b128 v[92:95], v249 offset:38144
v_cvt_pkrtz_f16_f32 v73, v64, v65
v_cvt_pkrtz_f16_f32 v75, v66, v67
v_mfma_f32_16x16x32_f16 v[8:11], v[224:227], v[212:215], v[8:11]
v_cvt_pkrtz_f16_f32 v77, v68, v69
v_cvt_pkrtz_f16_f32 v79, v70, v71
v_cvt_pkrtz_f16_f32 v201, v192, v193
v_mfma_f32_16x16x32_f16 v[4:7], v[228:231], v[208:211], v[4:7]
ds_read_b128 v[224:227], v248 offset:41984
v_cvt_pk_f16_f32 v83, v194, v195
v_cvt_pk_f16_f32 v80, v196, v197
v_mfma_f32_16x16x32_f16 v[12:15], v[228:231], v[212:215], v[12:15]
v_cvt_pk_f16_f32 v205, v198, v199
s_setprio 1
v_pk_fma_f16 v82, v83, v83, s48
v_cvt_pk_bf16_f32 v128, v128, v129
v_mfma_f32_16x16x32_bf16 v[64:67], v[232:235], v[96:99], 0
ds_read_b128 v[228:231], v249 offset:38912
v_and_b32 v73, s49, v73
v_pk_fma_f16 v207, v80, v80, s48
v_mfma_f32_16x16x32_bf16 v[192:195], v[232:235], v[100:103], 0
v_and_b32 v75, s49, v75
v_pk_fma_f16 v204, v205, v205, s48
v_bfe_u32 v72, v73, 2, 14
s_waitcnt lgkmcnt(3)
v_mfma_f32_16x16x32_f16 v[16:19], v[236:239], v[208:211], v[16:19]
ds_read_b128 v[232:235], v249 offset:39168
ds_read_u16_d16 v72, v72
v_pk_mul_f16 v82, v83, v82
v_bfe_u32 v74, v75, 2, 14
v_mfma_f32_16x16x32_f16 v[24:27], v[236:239], v[212:215], v[24:27]
v_pk_mul_f16 v207, v80, v207
v_lshrrev_b32_e64 v73, 18, v73
v_cvt_pk_bf16_f32 v129, v130, v131
v_mfma_f32_16x16x32_bf16 v[68:71], v[88:91], v[96:99], 0
ds_read_b128 v[236:239], v248 offset:42240
ds_read_u16_d16 v74, v74
ds_read_u16_d16_hi v73, v73
v_pk_mul_f16 v204, v205, v204
v_lshrrev_b32_e64 v75, 18, v75
v_mfma_f32_16x16x32_bf16 v[196:199], v[88:91], v[100:103], 0
v_exp_f16_e64 v81, v82
v_and_b32 v77, s49, v77
s_waitcnt lgkmcnt(5)
v_mfma_f32_16x16x32_f16 v[20:23], v[92:95], v[208:211], v[20:23]
ds_read_b128 v[88:91], v248 offset:43008
ds_read_u16_d16_hi v75, v75
v_and_b32_e64 v79, s49, v79
v_mfma_f32_16x16x32_f16 v[28:31], v[92:95], v[212:215], v[28:31]
v_exp_f16_e64 v206, v207
v_bfe_u32 v76, v77, 2, 14
v_bfe_u32 v78, v79, 2, 14
v_mfma_f32_16x16x32_bf16 v[64:67], v[224:227], v[104:107], v[64:67]
s_add_u32 s46, s69, 98304
buffer_load_dwordx4 v[220:223], v252, s[4:7], s46 offen offset:64
ds_read_b128 v[92:95], v248 offset:43264
ds_read_u16_d16 v76, v76
ds_read_u16_d16 v78, v78
v_cvt_pk_bf16_f32 v130, v132, v133
v_mfma_f32_16x16x32_bf16 v[192:195], v[224:227], v[108:111], v[192:195]
v_exp_f16 v203, v204
v_lshrrev_b32 v77, 18, v77
v_lshrrev_b32_e64 v79, 18, v79
v_mfma_f32_16x16x32_f16 v[32:35], v[228:231], v[208:211], v[32:35]
ds_read_b128 v[224:227], v249 offset:43008
ds_read_u16_d16_hi v77, v77
ds_read_u16_d16_hi v79, v79
v_exp_f16_sdwa v81, v82 dst_sel:WORD_1 dst_unused:UNUSED_PRESERVE src0_sel:WORD_1
v_mfma_f32_16x16x32_f16 v[40:43], v[228:231], v[212:215], v[40:43]
v_and_b32 v201, s49, v201
v_bfe_u32 v200, v201, 2, 14
s_waitcnt lgkmcnt(6)
v_mfma_f32_16x16x32_f16 v[36:39], v[232:235], v[208:211], v[36:39]
ds_read_b128 v[228:231], v249 offset:43264
ds_read_u16_d16 v200, v200
v_exp_f16_sdwa v206, v207 dst_sel:WORD_1 dst_unused:UNUSED_PRESERVE src0_sel:WORD_1
v_cvt_pk_bf16_f32 v131, v134, v135
v_mfma_f32_16x16x32_f16 v[44:47], v[232:235], v[212:215], v[44:47]
v_lshrrev_b32_e64 v201, 18, v201
v_exp_f16_sdwa v203, v204 dst_sel:WORD_1 dst_unused:UNUSED_PRESERVE src0_sel:WORD_1
v_mfma_f32_16x16x32_bf16 v[68:71], v[236:239], v[104:107], v[68:71]
ds_read_b128 v[232:235], v248 offset:47104
s_add_u32 s46, s68, 98304
buffer_store_dwordx4 v[128:131], v252, s[8:11], s46 offen sc1
ds_read_u16_d16_hi v201, v201
v_pk_add_f16 v81, v81, 1.0 op_sel_hi:[1,0]
v_pk_add_f16 v206, v206, 1.0 op_sel_hi:[1,0]
v_mfma_f32_16x16x32_bf16 v[196:199], v[236:239], v[108:111], v[196:199]
v_pk_add_f16 v203, v203, 1.0 op_sel_hi:[1,0]
s_setprio 0
v_rcp_f16 v82, v81
v_mfma_f32_16x16x32_bf16 v[64:67], v[88:91], v[112:115], v[64:67]
ds_read_b128 v[236:239], v249 offset:44032
v_rcp_f16_e64 v207, v206
v_mfma_f32_16x16x32_bf16 v[192:195], v[88:91], v[116:119], v[192:195]
v_rcp_f16 v204, v203
s_waitcnt lgkmcnt(5)
v_mfma_f32_16x16x32_bf16 v[68:71], v[92:95], v[112:115], v[68:71]
ds_read_b128 v[88:91], v248 offset:47360
v_rcp_f16_sdwa v82, v81 dst_sel:WORD_1 dst_unused:UNUSED_PRESERVE src0_sel:WORD_1
v_mfma_f32_16x16x32_bf16 v[196:199], v[92:95], v[116:119], v[196:199]
v_rcp_f16_sdwa v207, v206 dst_sel:WORD_1 dst_unused:UNUSED_PRESERVE src0_sel:WORD_1
v_or_b32 v208, v72, v73
v_or_b32 v209, v74, v75
v_or_b32_e64 v210, v76, v77
v_rcp_f16_sdwa v204, v203 dst_sel:WORD_1 dst_unused:UNUSED_PRESERVE src0_sel:WORD_1
v_or_b32 v211, v78, v79
s_waitcnt lgkmcnt(2)
v_or_b32 v212, v200, v201
v_pk_mul_f16 v213, v83, v82
v_pk_mul_f16 v214, v80, v207
v_pk_mul_f16 v215, v205, v204
s_setprio 3
v_mfma_f32_16x16x32_f16 v[0:3], v[224:227], v[208:211], v[0:3]
ds_read_b128 v[92:95], v249 offset:44288
v_cvt_pkrtz_f16_f32 v73, v64, v65
v_cvt_pkrtz_f16_f32 v75, v66, v67
v_mfma_f32_16x16x32_f16 v[8:11], v[224:227], v[212:215], v[8:11]
v_cvt_pkrtz_f16_f32 v77, v68, v69
v_cvt_pkrtz_f16_f32 v79, v70, v71
v_mfma_f32_16x16x32_f16 v[4:7], v[228:231], v[208:211], v[4:7]
ds_read_b128 v[224:227], v248 offset:48128
v_cvt_pkrtz_f16_f32 v201, v192, v193
v_cvt_pk_f16_f32 v83, v194, v195
v_mfma_f32_16x16x32_f16 v[12:15], v[228:231], v[212:215], v[12:15]
v_cvt_pk_f16_f32 v80, v196, v197
v_cvt_pk_f16_f32 v205, v198, v199
v_mfma_f32_16x16x32_bf16 v[64:67], v[232:235], v[96:99], 0
ds_read_b128 v[228:231], v249 offset:45056
v_pk_fma_f16 v82, v83, v83, s48
v_and_b32_e64 v73, s49, v73
v_mfma_f32_16x16x32_bf16 v[192:195], v[232:235], v[100:103], 0
v_pk_fma_f16 v207, v80, v80, s48
v_and_b32 v75, s49, v75
s_waitcnt lgkmcnt(3)
v_mfma_f32_16x16x32_f16 v[16:19], v[236:239], v[208:211], v[16:19]
ds_read_b128 v[232:235], v249 offset:45312
v_pk_fma_f16 v204, v205, v205, s48
v_bfe_u32 v72, v73, 2, 14
v_mfma_f32_16x16x32_f16 v[24:27], v[236:239], v[212:215], v[24:27]
v_pk_mul_f16 v82, v83, v82
v_bfe_u32 v74, v75, 2, 14
s_waitcnt vmcnt(7)
v_mfma_f32_16x16x32_bf16 v[152:155], v[186:189], v[240:243], v[152:155]
ds_read_b128 v[236:239], v248 offset:48384
ds_read_u16_d16 v72, v72
ds_read_u16_d16 v74, v74
v_pk_mul_f16 v207, v80, v207
v_lshrrev_b32 v73, 18, v73
v_mfma_f32_16x16x32_bf16 v[156:159], v[184:187], v[240:243], v[156:159]
v_pk_mul_f16 v204, v205, v204
v_lshrrev_b32_e64 v75, 18, v75
v_mfma_f32_16x16x32_bf16 v[68:71], v[88:91], v[96:99], 0
ds_read_u16_d16_hi v73, v73
ds_read_u16_d16_hi v75, v75
v_exp_f16_e64 v81, v82
v_mfma_f32_16x16x32_bf16 v[196:199], v[88:91], v[100:103], 0
v_and_b32_e64 v77, s49, v77
v_and_b32 v79, s49, v79
s_waitcnt lgkmcnt(6)
v_mfma_f32_16x16x32_f16 v[20:23], v[92:95], v[208:211], v[20:23]
ds_read_b128 v[88:91], v248 offset:49152
v_exp_f16_e64 v206, v207
v_mfma_f32_16x16x32_f16 v[28:31], v[92:95], v[212:215], v[28:31]
v_bfe_u32 v76, v77, 2, 14
v_bfe_u32 v78, v79, 2, 14
v_mfma_f32_16x16x32_bf16 v[64:67], v[224:227], v[104:107], v[64:67]
ds_read_b128 v[92:95], v248 offset:49408
ds_read_u16_d16 v76, v76
ds_read_u16_d16 v78, v78
v_exp_f16_e64 v203, v204
v_mfma_f32_16x16x32_bf16 v[192:195], v[224:227], v[108:111], v[192:195]
v_lshrrev_b32 v77, 18, v77
v_lshrrev_b32 v79, 18, v79
v_mfma_f32_16x16x32_f16 v[32:35], v[228:231], v[208:211], v[32:35]
ds_read_b128 v[224:227], v249 offset:49152
ds_read_u16_d16_hi v77, v77
ds_read_u16_d16_hi v79, v79
v_exp_f16_sdwa v81, v82 dst_sel:WORD_1 dst_unused:UNUSED_PRESERVE src0_sel:WORD_1
v_mfma_f32_16x16x32_f16 v[40:43], v[228:231], v[212:215], v[40:43]
v_and_b32 v201, s49, v201
v_bfe_u32 v200, v201, 2, 14
s_waitcnt lgkmcnt(7)
v_mfma_f32_16x16x32_f16 v[36:39], v[232:235], v[208:211], v[36:39]
ds_read_b128 v[228:231], v249 offset:49408
ds_read_u16_d16 v200, v200
v_exp_f16_sdwa v206, v207 dst_sel:WORD_1 dst_unused:UNUSED_PRESERVE src0_sel:WORD_1
v_mfma_f32_16x16x32_f16 v[44:47], v[232:235], v[212:215], v[44:47]
v_lshrrev_b32 v201, 18, v201
s_waitcnt vmcnt(6)
v_mfma_f32_16x16x32_bf16 v[8:11], v[186:189], v[244:247], v[8:11]
ds_read_b128 v[232:235], v248 offset:53248
ds_read_u16_d16_hi v201, v201
v_exp_f16_sdwa v203, v204 dst_sel:WORD_1 dst_unused:UNUSED_PRESERVE src0_sel:WORD_1
v_pk_add_f16 v81, v81, 1.0 op_sel_hi:[1,0]
v_mfma_f32_16x16x32_bf16 v[12:15], v[184:187], v[244:247], v[12:15]
v_pk_add_f16 v206, v206, 1.0 op_sel_hi:[1,0]
v_pk_add_f16 v203, v203, 1.0 op_sel_hi:[1,0]
v_mfma_f32_16x16x32_bf16 v[68:71], v[236:239], v[104:107], v[68:71]
v_rcp_f16_e64 v82, v81
v_mfma_f32_16x16x32_bf16 v[196:199], v[236:239], v[108:111], v[196:199]
v_rcp_f16 v207, v206
s_waitcnt lgkmcnt(4)
v_mfma_f32_16x16x32_bf16 v[64:67], v[88:91], v[112:115], v[64:67]
ds_read_b128 v[236:239], v249 offset:50176
v_rcp_f16_e64 v204, v203
v_mfma_f32_16x16x32_bf16 v[192:195], v[88:91], v[116:119], v[192:195]
v_rcp_f16_sdwa v82, v81 dst_sel:WORD_1 dst_unused:UNUSED_PRESERVE src0_sel:WORD_1
v_mfma_f32_16x16x32_bf16 v[68:71], v[92:95], v[112:115], v[68:71]
ds_read_b128 v[88:91], v248 offset:53504
v_rcp_f16_sdwa v207, v206 dst_sel:WORD_1 dst_unused:UNUSED_PRESERVE src0_sel:WORD_1
v_mfma_f32_16x16x32_bf16 v[196:199], v[92:95], v[116:119], v[196:199]
v_or_b32 v208, v72, v73
v_or_b32 v209, v74, v75
v_or_b32_e64 v210, v76, v77
v_rcp_f16_sdwa v204, v203 dst_sel:WORD_1 dst_unused:UNUSED_PRESERVE src0_sel:WORD_1
v_or_b32 v211, v78, v79
s_waitcnt lgkmcnt(2)
v_or_b32_e64 v212, v200, v201
v_pk_mul_f16 v213, v83, v82
v_pk_mul_f16 v214, v80, v207
v_pk_mul_f16 v215, v205, v204
v_mfma_f32_16x16x32_f16 v[0:3], v[224:227], v[208:211], v[0:3]
buffer_load_dwordx4 v[240:243], v252, s[4:7], s69 offen offset:128
ds_read_b128 v[92:95], v249 offset:50432
v_cvt_pkrtz_f16_f32 v73, v64, v65
v_cvt_pkrtz_f16_f32 v75, v66, v67
v_mfma_f32_16x16x32_f16 v[8:11], v[224:227], v[212:215], v[8:11]
v_cvt_pkrtz_f16_f32 v77, v68, v69
v_cvt_pkrtz_f16_f32 v79, v70, v71
v_cvt_pkrtz_f16_f32 v201, v192, v193
v_mfma_f32_16x16x32_f16 v[4:7], v[228:231], v[208:211], v[4:7]
ds_read_b128 v[224:227], v248 offset:54272
v_cvt_pk_f16_f32 v83, v194, v195
v_cvt_pk_f16_f32 v80, v196, v197
v_mfma_f32_16x16x32_f16 v[12:15], v[228:231], v[212:215], v[12:15]
v_cvt_pk_f16_f32 v205, v198, v199
v_pk_fma_f16 v82, v83, v83, s48
v_cvt_pk_bf16_f32 v136, v136, v137
v_mfma_f32_16x16x32_bf16 v[64:67], v[232:235], v[96:99], 0
ds_read_b128 v[228:231], v249 offset:51200
v_and_b32_e64 v73, s49, v73
v_pk_fma_f16 v207, v80, v80, s48
v_mfma_f32_16x16x32_bf16 v[192:195], v[232:235], v[100:103], 0
v_and_b32_e64 v75, s49, v75
v_pk_fma_f16 v204, v205, v205, s48
s_setprio 2
v_bfe_u32 v72, v73, 2, 14
s_waitcnt lgkmcnt(3)
v_mfma_f32_16x16x32_f16 v[16:19], v[236:239], v[208:211], v[16:19]
ds_read_b128 v[232:235], v249 offset:51456
ds_read_u16_d16 v72, v72
v_pk_mul_f16 v82, v83, v82
v_bfe_u32 v74, v75, 2, 14
v_mfma_f32_16x16x32_f16 v[24:27], v[236:239], v[212:215], v[24:27]
v_pk_mul_f16 v207, v80, v207
v_lshrrev_b32_e64 v73, 18, v73
v_cvt_pk_bf16_f32 v137, v138, v139
v_mfma_f32_16x16x32_bf16 v[68:71], v[88:91], v[96:99], 0
ds_read_b128 v[236:239], v248 offset:54528
ds_read_u16_d16 v74, v74
ds_read_u16_d16_hi v73, v73
v_pk_mul_f16 v204, v205, v204
v_lshrrev_b32_e64 v75, 18, v75
v_mfma_f32_16x16x32_bf16 v[196:199], v[88:91], v[100:103], 0
v_exp_f16_e64 v81, v82
v_and_b32 v77, s49, v77
s_waitcnt lgkmcnt(5)
v_mfma_f32_16x16x32_f16 v[20:23], v[92:95], v[208:211], v[20:23]
ds_read_b128 v[88:91], v248 offset:55296
ds_read_u16_d16_hi v75, v75
v_and_b32_e64 v79, s49, v79
v_mfma_f32_16x16x32_f16 v[28:31], v[92:95], v[212:215], v[28:31]
v_exp_f16_e64 v206, v207
v_bfe_u32 v76, v77, 2, 14
v_bfe_u32 v78, v79, 2, 14
v_mfma_f32_16x16x32_bf16 v[64:67], v[224:227], v[104:107], v[64:67]
ds_read_b128 v[92:95], v248 offset:55552
ds_read_u16_d16 v76, v76
ds_read_u16_d16 v78, v78
v_cvt_pk_bf16_f32 v138, v140, v141
v_mfma_f32_16x16x32_bf16 v[192:195], v[224:227], v[108:111], v[192:195]
v_exp_f16 v203, v204
v_lshrrev_b32 v77, 18, v77
v_lshrrev_b32_e64 v79, 18, v79
v_mfma_f32_16x16x32_f16 v[32:35], v[228:231], v[208:211], v[32:35]
ds_read_b128 v[224:227], v249 offset:55296
ds_read_u16_d16_hi v77, v77
ds_read_u16_d16_hi v79, v79
v_exp_f16_sdwa v81, v82 dst_sel:WORD_1 dst_unused:UNUSED_PRESERVE src0_sel:WORD_1
v_mfma_f32_16x16x32_f16 v[40:43], v[228:231], v[212:215], v[40:43]
v_and_b32 v201, s49, v201
v_bfe_u32 v200, v201, 2, 14
s_waitcnt lgkmcnt(8)
v_mfma_f32_16x16x32_f16 v[36:39], v[232:235], v[208:211], v[36:39]
ds_read_b128 v[228:231], v249 offset:55552
ds_read_u16_d16 v200, v200
v_exp_f16_sdwa v206, v207 dst_sel:WORD_1 dst_unused:UNUSED_PRESERVE src0_sel:WORD_1
v_cvt_pk_bf16_f32 v139, v142, v143
v_mfma_f32_16x16x32_f16 v[44:47], v[232:235], v[212:215], v[44:47]
v_lshrrev_b32_e64 v201, 18, v201
v_exp_f16_sdwa v203, v204 dst_sel:WORD_1 dst_unused:UNUSED_PRESERVE src0_sel:WORD_1
v_mfma_f32_16x16x32_bf16 v[68:71], v[236:239], v[104:107], v[68:71]
ds_read_b128 v[232:235], v248 offset:59392
buffer_store_dwordx4 v[136:139], v252, s[8:11], s68 offen offset:64 sc1
ds_read_u16_d16_hi v201, v201
v_pk_add_f16 v81, v81, 1.0 op_sel_hi:[1,0]
v_pk_add_f16 v206, v206, 1.0 op_sel_hi:[1,0]
v_mfma_f32_16x16x32_bf16 v[196:199], v[236:239], v[108:111], v[196:199]
v_pk_add_f16 v203, v203, 1.0 op_sel_hi:[1,0]
v_rcp_f16 v82, v81
s_waitcnt lgkmcnt(6)
v_mfma_f32_16x16x32_bf16 v[64:67], v[88:91], v[112:115], v[64:67]
ds_read_b128 v[236:239], v249 offset:56320
v_rcp_f16_e64 v207, v206
v_mfma_f32_16x16x32_bf16 v[192:195], v[88:91], v[116:119], v[192:195]
v_rcp_f16_e64 v204, v203
v_mfma_f32_16x16x32_bf16 v[68:71], v[92:95], v[112:115], v[68:71]
ds_read_b128 v[88:91], v248 offset:59648
v_rcp_f16_sdwa v82, v81 dst_sel:WORD_1 dst_unused:UNUSED_PRESERVE src0_sel:WORD_1
v_mfma_f32_16x16x32_bf16 v[196:199], v[92:95], v[116:119], v[196:199]
v_rcp_f16_sdwa v207, v206 dst_sel:WORD_1 dst_unused:UNUSED_PRESERVE src0_sel:WORD_1
v_or_b32 v208, v72, v73
v_or_b32 v209, v74, v75
s_waitcnt lgkmcnt(4)
v_or_b32 v210, v76, v77
v_rcp_f16_sdwa v204, v203 dst_sel:WORD_1 dst_unused:UNUSED_PRESERVE src0_sel:WORD_1
v_or_b32 v211, v78, v79
s_waitcnt lgkmcnt(2)
v_or_b32_e64 v212, v200, v201
v_pk_mul_f16 v213, v83, v82
v_pk_mul_f16 v214, v80, v207
v_pk_mul_f16 v215, v205, v204
v_mfma_f32_16x16x32_f16 v[0:3], v[224:227], v[208:211], v[0:3]
ds_read_b128 v[92:95], v249 offset:56576
v_cvt_pkrtz_f16_f32 v73, v64, v65
v_cvt_pkrtz_f16_f32 v75, v66, v67
v_mfma_f32_16x16x32_f16 v[8:11], v[224:227], v[212:215], v[8:11]
v_cvt_pkrtz_f16_f32 v77, v68, v69
v_cvt_pkrtz_f16_f32 v79, v70, v71
v_mfma_f32_16x16x32_f16 v[4:7], v[228:231], v[208:211], v[4:7]
ds_read_b128 v[224:227], v248 offset:60416
v_cvt_pkrtz_f16_f32 v201, v192, v193
v_cvt_pk_f16_f32 v83, v194, v195
v_mfma_f32_16x16x32_f16 v[12:15], v[228:231], v[212:215], v[12:15]
v_cvt_pk_f16_f32 v80, v196, v197
v_cvt_pk_f16_f32 v205, v198, v199
s_setprio 1
v_mfma_f32_16x16x32_bf16 v[64:67], v[232:235], v[96:99], 0
ds_read_b128 v[228:231], v249 offset:57344
v_pk_fma_f16 v82, v83, v83, s48
v_and_b32 v73, s49, v73
v_mfma_f32_16x16x32_bf16 v[192:195], v[232:235], v[100:103], 0
v_pk_fma_f16 v207, v80, v80, s48
v_and_b32 v75, s49, v75
s_waitcnt lgkmcnt(3)
v_mfma_f32_16x16x32_f16 v[16:19], v[236:239], v[208:211], v[16:19]
ds_read_b128 v[232:235], v249 offset:57600
v_pk_fma_f16 v204, v205, v205, s48
v_bfe_u32 v72, v73, 2, 14
v_mfma_f32_16x16x32_f16 v[24:27], v[236:239], v[212:215], v[24:27]
v_pk_mul_f16 v82, v83, v82
v_bfe_u32 v74, v75, 2, 14
s_waitcnt vmcnt(6)
v_mfma_f32_16x16x32_bf16 v[160:163], v[186:189], v[84:87], v[160:163]
ds_read_b128 v[236:239], v248 offset:60672
ds_read_u16_d16 v72, v72
ds_read_u16_d16 v74, v74
v_pk_mul_f16 v207, v80, v207
v_lshrrev_b32 v73, 18, v73
v_mfma_f32_16x16x32_bf16 v[164:167], v[184:187], v[84:87], v[164:167]
v_pk_mul_f16 v204, v205, v204
v_lshrrev_b32_e64 v75, 18, v75
v_mfma_f32_16x16x32_bf16 v[68:71], v[88:91], v[96:99], 0
ds_read_u16_d16_hi v73, v73
ds_read_u16_d16_hi v75, v75
v_exp_f16_e64 v81, v82
v_mfma_f32_16x16x32_bf16 v[196:199], v[88:91], v[100:103], 0
v_and_b32_e64 v77, s49, v77
v_and_b32 v79, s49, v79
s_waitcnt lgkmcnt(6)
v_mfma_f32_16x16x32_f16 v[20:23], v[92:95], v[208:211], v[20:23]
ds_read_b128 v[88:91], v248 offset:61440
v_exp_f16_e64 v206, v207
v_mfma_f32_16x16x32_f16 v[28:31], v[92:95], v[212:215], v[28:31]
v_bfe_u32 v76, v77, 2, 14
v_bfe_u32 v78, v79, 2, 14
v_mfma_f32_16x16x32_bf16 v[64:67], v[224:227], v[104:107], v[64:67]
ds_read_b128 v[92:95], v248 offset:61696
ds_read_u16_d16 v76, v76
ds_read_u16_d16 v78, v78
v_exp_f16_e64 v203, v204
v_mfma_f32_16x16x32_bf16 v[192:195], v[224:227], v[108:111], v[192:195]
v_lshrrev_b32 v77, 18, v77
v_lshrrev_b32 v79, 18, v79
v_mfma_f32_16x16x32_f16 v[32:35], v[228:231], v[208:211], v[32:35]
ds_read_b128 v[224:227], v249 offset:61440
ds_read_u16_d16_hi v77, v77
ds_read_u16_d16_hi v79, v79
v_exp_f16_sdwa v81, v82 dst_sel:WORD_1 dst_unused:UNUSED_PRESERVE src0_sel:WORD_1
v_mfma_f32_16x16x32_f16 v[40:43], v[228:231], v[212:215], v[40:43]
v_and_b32 v201, s49, v201
v_bfe_u32 v200, v201, 2, 14
s_waitcnt lgkmcnt(7)
v_mfma_f32_16x16x32_f16 v[36:39], v[232:235], v[208:211], v[36:39]
ds_read_b128 v[228:231], v249 offset:61696
ds_read_u16_d16 v200, v200
v_exp_f16_sdwa v206, v207 dst_sel:WORD_1 dst_unused:UNUSED_PRESERVE src0_sel:WORD_1
v_mfma_f32_16x16x32_f16 v[44:47], v[232:235], v[212:215], v[44:47]
v_lshrrev_b32 v201, 18, v201
s_waitcnt vmcnt(4)
v_mfma_f32_16x16x32_bf16 v[16:19], v[186:189], v[216:219], v[16:19]
ds_read_b128 v[232:235], v249
ds_read_u16_d16_hi v201, v201
v_exp_f16_sdwa v203, v204 dst_sel:WORD_1 dst_unused:UNUSED_PRESERVE src0_sel:WORD_1
v_pk_add_f16 v81, v81, 1.0 op_sel_hi:[1,0]
v_mfma_f32_16x16x32_bf16 v[20:23], v[184:187], v[216:219], v[20:23]
v_pk_add_f16 v206, v206, 1.0 op_sel_hi:[1,0]
v_pk_add_f16 v203, v203, 1.0 op_sel_hi:[1,0]
v_mfma_f32_16x16x32_bf16 v[68:71], v[236:239], v[104:107], v[68:71]
v_rcp_f16 v82, v81
s_setprio 0
v_mfma_f32_16x16x32_bf16 v[196:199], v[236:239], v[108:111], v[196:199]
v_rcp_f16 v207, v206
s_waitcnt lgkmcnt(4)
v_mfma_f32_16x16x32_bf16 v[64:67], v[88:91], v[112:115], v[64:67]
ds_read_b128 v[236:239], v249 offset:62464
v_rcp_f16_e64 v204, v203
v_mfma_f32_16x16x32_bf16 v[192:195], v[88:91], v[116:119], v[192:195]
v_rcp_f16_sdwa v82, v81 dst_sel:WORD_1 dst_unused:UNUSED_PRESERVE src0_sel:WORD_1
v_mfma_f32_16x16x32_bf16 v[68:71], v[92:95], v[112:115], v[68:71]
ds_read_b128 v[88:91], v249 offset:256
v_rcp_f16_sdwa v207, v206 dst_sel:WORD_1 dst_unused:UNUSED_PRESERVE src0_sel:WORD_1
v_mfma_f32_16x16x32_bf16 v[196:199], v[92:95], v[116:119], v[196:199]
v_or_b32 v208, v72, v73
v_or_b32 v209, v74, v75
v_or_b32_e64 v210, v76, v77
v_rcp_f16_sdwa v204, v203 dst_sel:WORD_1 dst_unused:UNUSED_PRESERVE src0_sel:WORD_1
v_or_b32 v211, v78, v79
s_waitcnt lgkmcnt(2)
v_or_b32 v212, v200, v201
v_pk_mul_f16 v213, v83, v82
v_pk_mul_f16 v214, v80, v207
v_pk_mul_f16 v215, v205, v204
s_setprio 3
v_mfma_f32_16x16x32_f16 v[0:3], v[224:227], v[208:211], v[0:3]
s_add_u32 s46, s69, 98304
buffer_load_dwordx4 v[244:247], v252, s[4:7], s46 offen offset:128
ds_read_b128 v[92:95], v249 offset:62720
v_cvt_pkrtz_f16_f32 v73, v64, v65
v_cvt_pkrtz_f16_f32 v75, v66, v67
v_mfma_f32_16x16x32_f16 v[8:11], v[224:227], v[212:215], v[8:11]
v_cvt_pkrtz_f16_f32 v77, v68, v69
v_cvt_pkrtz_f16_f32 v79, v70, v71
v_cvt_pkrtz_f16_f32 v201, v192, v193
v_mfma_f32_16x16x32_f16 v[4:7], v[228:231], v[208:211], v[4:7]
ds_read_b128 v[224:227], v249 offset:1024
v_cvt_pk_f16_f32 v83, v194, v195
v_cvt_pk_f16_f32 v80, v196, v197
v_mfma_f32_16x16x32_f16 v[12:15], v[228:231], v[212:215], v[12:15]
v_cvt_pk_f16_f32 v205, v198, v199
v_pk_fma_f16 v82, v83, v83, s48
v_cvt_pk_bf16_f32 v144, v144, v145
v_mfma_f32_16x16x32_bf16 v[64:67], v[232:235], v[96:99], 0
ds_read_b128 v[228:231], v249 offset:63488
v_and_b32_e64 v73, s49, v73
v_pk_fma_f16 v207, v80, v80, s48
v_mfma_f32_16x16x32_bf16 v[192:195], v[232:235], v[100:103], 0
v_and_b32 v75, s49, v75
v_pk_fma_f16 v204, v205, v205, s48
v_bfe_u32 v72, v73, 2, 14
s_waitcnt lgkmcnt(3)
v_mfma_f32_16x16x32_f16 v[16:19], v[236:239], v[208:211], v[16:19]
ds_read_b128 v[232:235], v249 offset:63744
ds_read_u16_d16 v72, v72
v_pk_mul_f16 v82, v83, v82
v_bfe_u32 v74, v75, 2, 14
v_mfma_f32_16x16x32_f16 v[24:27], v[236:239], v[212:215], v[24:27]
v_pk_mul_f16 v207, v80, v207
v_lshrrev_b32_e64 v73, 18, v73
v_cvt_pk_bf16_f32 v145, v146, v147
v_mfma_f32_16x16x32_bf16 v[68:71], v[88:91], v[96:99], 0
ds_read_b128 v[236:239], v249 offset:1280
ds_read_u16_d16 v74, v74
ds_read_u16_d16_hi v73, v73
v_pk_mul_f16 v204, v205, v204
v_lshrrev_b32_e64 v75, 18, v75
v_mfma_f32_16x16x32_bf16 v[196:199], v[88:91], v[100:103], 0
v_exp_f16_e64 v81, v82
v_and_b32 v77, s49, v77
s_waitcnt lgkmcnt(5)
v_mfma_f32_16x16x32_f16 v[20:23], v[92:95], v[208:211], v[20:23]
ds_read_b128 v[88:91], v249 offset:2048
ds_read_u16_d16_hi v75, v75
v_and_b32_e64 v79, s49, v79
v_mfma_f32_16x16x32_f16 v[28:31], v[92:95], v[212:215], v[28:31]
v_exp_f16_e64 v206, v207
v_bfe_u32 v76, v77, 2, 14
v_bfe_u32 v78, v79, 2, 14
v_mfma_f32_16x16x32_bf16 v[64:67], v[224:227], v[104:107], v[64:67]
ds_read_b128 v[92:95], v249 offset:2304
ds_read_u16_d16 v76, v76
ds_read_u16_d16 v78, v78
v_cvt_pk_bf16_f32 v146, v148, v149
v_mfma_f32_16x16x32_bf16 v[192:195], v[224:227], v[108:111], v[192:195]
v_exp_f16 v203, v204
v_lshrrev_b32 v77, 18, v77
v_lshrrev_b32_e64 v79, 18, v79
v_mfma_f32_16x16x32_f16 v[32:35], v[228:231], v[208:211], v[32:35]
ds_read_b128 v[224:227], v250 offset:2048
ds_read_u16_d16_hi v77, v77
ds_read_u16_d16_hi v79, v79
v_exp_f16_sdwa v81, v82 dst_sel:WORD_1 dst_unused:UNUSED_PRESERVE src0_sel:WORD_1
v_mfma_f32_16x16x32_f16 v[40:43], v[228:231], v[212:215], v[40:43]
v_and_b32 v201, s49, v201
v_bfe_u32 v200, v201, 2, 14
s_waitcnt lgkmcnt(8)
v_mfma_f32_16x16x32_f16 v[36:39], v[232:235], v[208:211], v[36:39]
ds_read_b128 v[228:231], v250 offset:2304
ds_read_u16_d16 v200, v200
v_exp_f16_sdwa v206, v207 dst_sel:WORD_1 dst_unused:UNUSED_PRESERVE src0_sel:WORD_1
v_cvt_pk_bf16_f32 v147, v150, v151
v_mfma_f32_16x16x32_f16 v[44:47], v[232:235], v[212:215], v[44:47]
v_lshrrev_b32_e64 v201, 18, v201
v_exp_f16_sdwa v203, v204 dst_sel:WORD_1 dst_unused:UNUSED_PRESERVE src0_sel:WORD_1
v_mfma_f32_16x16x32_bf16 v[68:71], v[236:239], v[104:107], v[68:71]
ds_read_b128 v[232:235], v249 offset:6144
s_add_u32 s46, s68, 98304
buffer_store_dwordx4 v[144:147], v252, s[8:11], s46 offen offset:64 sc1
ds_read_u16_d16_hi v201, v201
v_pk_add_f16 v81, v81, 1.0 op_sel_hi:[1,0]
v_pk_add_f16 v206, v206, 1.0 op_sel_hi:[1,0]
v_mfma_f32_16x16x32_bf16 v[196:199], v[236:239], v[108:111], v[196:199]
v_pk_add_f16 v203, v203, 1.0 op_sel_hi:[1,0]
v_rcp_f16 v82, v81
s_waitcnt lgkmcnt(5)
v_mfma_f32_16x16x32_bf16 v[64:67], v[88:91], v[112:115], v[64:67]
ds_read_b128 v[236:239], v250 offset:3072
v_rcp_f16_e64 v207, v206
v_mfma_f32_16x16x32_bf16 v[192:195], v[88:91], v[116:119], v[192:195]
v_rcp_f16_e64 v204, v203
v_mfma_f32_16x16x32_bf16 v[68:71], v[92:95], v[112:115], v[68:71]
ds_read_b128 v[88:91], v249 offset:6400
v_rcp_f16_sdwa v82, v81 dst_sel:WORD_1 dst_unused:UNUSED_PRESERVE src0_sel:WORD_1
v_mfma_f32_16x16x32_bf16 v[196:199], v[92:95], v[116:119], v[196:199]
v_rcp_f16_sdwa v207, v206 dst_sel:WORD_1 dst_unused:UNUSED_PRESERVE src0_sel:WORD_1
v_or_b32 v208, v72, v73
v_or_b32 v209, v74, v75
v_or_b32_e64 v210, v76, v77
v_rcp_f16_sdwa v204, v203 dst_sel:WORD_1 dst_unused:UNUSED_PRESERVE src0_sel:WORD_1
s_waitcnt lgkmcnt(4)
v_or_b32 v211, v78, v79
s_waitcnt lgkmcnt(2)
v_or_b32 v212, v200, v201
v_pk_mul_f16 v213, v83, v82
v_pk_mul_f16 v214, v80, v207
v_pk_mul_f16 v215, v205, v204
v_mfma_f32_16x16x32_f16 v[0:3], v[224:227], v[208:211], v[0:3]
ds_read_b128 v[92:95], v250 offset:3328
v_cvt_pkrtz_f16_f32 v73, v64, v65
v_cvt_pkrtz_f16_f32 v75, v66, v67
v_mfma_f32_16x16x32_f16 v[8:11], v[224:227], v[212:215], v[8:11]
v_cvt_pkrtz_f16_f32 v77, v68, v69
v_cvt_pkrtz_f16_f32 v79, v70, v71
v_mfma_f32_16x16x32_f16 v[4:7], v[228:231], v[208:211], v[4:7]
ds_read_b128 v[224:227], v249 offset:7168
v_cvt_pkrtz_f16_f32 v201, v192, v193
v_cvt_pk_f16_f32 v83, v194, v195
v_mfma_f32_16x16x32_f16 v[12:15], v[228:231], v[212:215], v[12:15]
v_cvt_pk_f16_f32 v80, v196, v197
v_cvt_pk_f16_f32 v205, v198, v199
v_mfma_f32_16x16x32_bf16 v[64:67], v[232:235], v[96:99], 0
ds_read_b128 v[228:231], v250 offset:4096
v_pk_fma_f16 v82, v83, v83, s48
v_and_b32_e64 v73, s49, v73
v_mfma_f32_16x16x32_bf16 v[192:195], v[232:235], v[100:103], 0
v_pk_fma_f16 v207, v80, v80, s48
v_and_b32 v75, s49, v75
s_waitcnt lgkmcnt(3)
v_mfma_f32_16x16x32_f16 v[16:19], v[236:239], v[208:211], v[16:19]
ds_read_b128 v[232:235], v250 offset:4352
v_pk_fma_f16 v204, v205, v205, s48
s_setprio 2
v_bfe_u32 v72, v73, 2, 14
v_pk_mul_f16 v82, v83, v82
v_mfma_f32_16x16x32_f16 v[24:27], v[236:239], v[212:215], v[24:27]
v_bfe_u32 v74, v75, 2, 14
v_pk_mul_f16 v207, v80, v207
s_waitcnt vmcnt(5)
v_mfma_f32_16x16x32_bf16 v[24:27], v[186:189], v[220:223], v[24:27]
ds_read_b128 v[236:239], v249 offset:7424
ds_read_u16_d16 v72, v72
ds_read_u16_d16 v74, v74
v_lshrrev_b32_e64 v73, 18, v73
v_pk_mul_f16 v204, v205, v204
v_mfma_f32_16x16x32_bf16 v[28:31], v[184:187], v[220:223], v[28:31]
v_lshrrev_b32_e64 v75, 18, v75
v_mfma_f32_16x16x32_bf16 v[68:71], v[88:91], v[96:99], 0
ds_read_u16_d16_hi v73, v73
ds_read_u16_d16_hi v75, v75
v_exp_f16 v81, v82
v_and_b32 v77, s49, v77
v_mfma_f32_16x16x32_bf16 v[196:199], v[88:91], v[100:103], 0
v_and_b32 v79, s49, v79
s_waitcnt lgkmcnt(6)
v_mfma_f32_16x16x32_f16 v[20:23], v[92:95], v[208:211], v[20:23]
ds_read_b128 v[88:91], v249 offset:8192
v_exp_f16_e64 v206, v207
v_bfe_u32 v76, v77, 2, 14
v_mfma_f32_16x16x32_f16 v[28:31], v[92:95], v[212:215], v[28:31]
v_bfe_u32 v78, v79, 2, 14
v_exp_f16_e64 v203, v204
v_mfma_f32_16x16x32_bf16 v[64:67], v[224:227], v[104:107], v[64:67]
ds_read_b128 v[92:95], v249 offset:8448
ds_read_u16_d16 v76, v76
ds_read_u16_d16 v78, v78
v_lshrrev_b32 v77, 18, v77
v_lshrrev_b32 v79, 18, v79
v_mfma_f32_16x16x32_bf16 v[192:195], v[224:227], v[108:111], v[192:195]
v_exp_f16_sdwa v81, v82 dst_sel:WORD_1 dst_unused:UNUSED_PRESERVE src0_sel:WORD_1
v_mfma_f32_16x16x32_f16 v[32:35], v[228:231], v[208:211], v[32:35]
ds_read_b128 v[224:227], v250 offset:8192
ds_read_u16_d16_hi v77, v77
ds_read_u16_d16_hi v79, v79
v_and_b32 v201, s49, v201
v_bfe_u32 v200, v201, 2, 14
v_mfma_f32_16x16x32_f16 v[40:43], v[228:231], v[212:215], v[40:43]
v_exp_f16_sdwa v206, v207 dst_sel:WORD_1 dst_unused:UNUSED_PRESERVE src0_sel:WORD_1
s_waitcnt lgkmcnt(7)
v_mfma_f32_16x16x32_f16 v[36:39], v[232:235], v[208:211], v[36:39]
ds_read_b128 v[228:231], v250 offset:8448
ds_read_u16_d16 v200, v200
v_lshrrev_b32_e64 v201, 18, v201
v_mfma_f32_16x16x32_f16 v[44:47], v[232:235], v[212:215], v[44:47]
v_exp_f16_sdwa v203, v204 dst_sel:WORD_1 dst_unused:UNUSED_PRESERVE src0_sel:WORD_1
v_pk_add_f16 v81, v81, 1.0 op_sel_hi:[1,0]
v_pk_add_f16 v206, v206, 1.0 op_sel_hi:[1,0]
v_mfma_f32_16x16x32_bf16 v[68:71], v[236:239], v[104:107], v[68:71]
ds_read_b128 v[232:235], v249 offset:12288
ds_read_u16_d16_hi v201, v201
v_pk_add_f16 v203, v203, 1.0 op_sel_hi:[1,0]
v_mfma_f32_16x16x32_bf16 v[196:199], v[236:239], v[108:111], v[196:199]
v_rcp_f16 v82, v81
s_waitcnt lgkmcnt(7)
v_mfma_f32_16x16x32_bf16 v[64:67], v[88:91], v[112:115], v[64:67]
ds_read_b128 v[236:239], v250 offset:9216
v_rcp_f16_e64 v207, v206
v_mfma_f32_16x16x32_bf16 v[192:195], v[88:91], v[116:119], v[192:195]
v_rcp_f16_e64 v204, v203
v_mfma_f32_16x16x32_bf16 v[68:71], v[92:95], v[112:115], v[68:71]
ds_read_b128 v[88:91], v249 offset:12544
v_rcp_f16_sdwa v82, v81 dst_sel:WORD_1 dst_unused:UNUSED_PRESERVE src0_sel:WORD_1
v_mfma_f32_16x16x32_bf16 v[196:199], v[92:95], v[116:119], v[196:199]
v_rcp_f16_sdwa v207, v206 dst_sel:WORD_1 dst_unused:UNUSED_PRESERVE src0_sel:WORD_1
v_or_b32 v208, v72, v73
v_or_b32 v209, v74, v75
s_waitcnt lgkmcnt(4)
v_or_b32 v210, v76, v77
v_rcp_f16_sdwa v204, v203 dst_sel:WORD_1 dst_unused:UNUSED_PRESERVE src0_sel:WORD_1
v_or_b32 v211, v78, v79
s_waitcnt lgkmcnt(2)
v_or_b32_e64 v212, v200, v201
v_pk_mul_f16 v213, v83, v82
v_pk_mul_f16 v214, v80, v207
v_pk_mul_f16 v215, v205, v204
v_mfma_f32_16x16x32_f16 v[0:3], v[224:227], v[208:211], v[0:3]
ds_read_b128 v[92:95], v250 offset:9472
v_cvt_pkrtz_f16_f32 v73, v64, v65
v_cvt_pkrtz_f16_f32 v75, v66, v67
v_mfma_f32_16x16x32_f16 v[8:11], v[224:227], v[212:215], v[8:11]
v_cvt_pkrtz_f16_f32 v77, v68, v69
v_cvt_pkrtz_f16_f32 v79, v70, v71
v_cvt_pkrtz_f16_f32 v201, v192, v193
v_mfma_f32_16x16x32_f16 v[4:7], v[228:231], v[208:211], v[4:7]
ds_read_b128 v[224:227], v249 offset:13312
v_cvt_pk_f16_f32 v83, v194, v195
v_cvt_pk_f16_f32 v80, v196, v197
v_mfma_f32_16x16x32_f16 v[12:15], v[228:231], v[212:215], v[12:15]
v_cvt_pk_f16_f32 v205, v198, v199
s_setprio 1
v_pk_fma_f16 v82, v83, v83, s48
v_cvt_pk_bf16_f32 v152, v152, v153
v_mfma_f32_16x16x32_bf16 v[64:67], v[232:235], v[96:99], 0
ds_read_b128 v[228:231], v250 offset:10240
v_and_b32 v73, s49, v73
v_pk_fma_f16 v207, v80, v80, s48
v_mfma_f32_16x16x32_bf16 v[192:195], v[232:235], v[100:103], 0
v_and_b32 v75, s49, v75
v_pk_fma_f16 v204, v205, v205, s48
v_bfe_u32 v72, v73, 2, 14
s_waitcnt lgkmcnt(3)
v_mfma_f32_16x16x32_f16 v[16:19], v[236:239], v[208:211], v[16:19]
ds_read_b128 v[232:235], v250 offset:10496
ds_read_u16_d16 v72, v72
v_pk_mul_f16 v82, v83, v82
v_bfe_u32 v74, v75, 2, 14
v_mfma_f32_16x16x32_f16 v[24:27], v[236:239], v[212:215], v[24:27]
v_pk_mul_f16 v207, v80, v207
v_lshrrev_b32_e64 v73, 18, v73
v_cvt_pk_bf16_f32 v153, v154, v155
v_mfma_f32_16x16x32_bf16 v[68:71], v[88:91], v[96:99], 0
ds_read_b128 v[236:239], v249 offset:13568
ds_read_u16_d16 v74, v74
ds_read_u16_d16_hi v73, v73
v_pk_mul_f16 v204, v205, v204
v_lshrrev_b32_e64 v75, 18, v75
v_mfma_f32_16x16x32_bf16 v[196:199], v[88:91], v[100:103], 0
v_exp_f16_e64 v81, v82
v_and_b32 v77, s49, v77
s_waitcnt lgkmcnt(5)
v_mfma_f32_16x16x32_f16 v[20:23], v[92:95], v[208:211], v[20:23]
ds_read_b128 v[88:91], v249 offset:14336
ds_read_u16_d16_hi v75, v75
v_and_b32_e64 v79, s49, v79
v_mfma_f32_16x16x32_f16 v[28:31], v[92:95], v[212:215], v[28:31]
v_exp_f16_e64 v206, v207
v_bfe_u32 v76, v77, 2, 14
v_bfe_u32 v78, v79, 2, 14
v_mfma_f32_16x16x32_bf16 v[64:67], v[224:227], v[104:107], v[64:67]
ds_read_b128 v[92:95], v249 offset:14592
ds_read_u16_d16 v76, v76
ds_read_u16_d16 v78, v78
v_cvt_pk_bf16_f32 v154, v156, v157
v_mfma_f32_16x16x32_bf16 v[192:195], v[224:227], v[108:111], v[192:195]
v_exp_f16 v203, v204
v_lshrrev_b32 v77, 18, v77
v_lshrrev_b32_e64 v79, 18, v79
v_mfma_f32_16x16x32_f16 v[32:35], v[228:231], v[208:211], v[32:35]
ds_read_b128 v[224:227], v250 offset:14336
ds_read_u16_d16_hi v77, v77
ds_read_u16_d16_hi v79, v79
v_exp_f16_sdwa v81, v82 dst_sel:WORD_1 dst_unused:UNUSED_PRESERVE src0_sel:WORD_1
v_mfma_f32_16x16x32_f16 v[40:43], v[228:231], v[212:215], v[40:43]
v_and_b32 v201, s49, v201
v_bfe_u32 v200, v201, 2, 14
s_waitcnt lgkmcnt(8)
v_mfma_f32_16x16x32_f16 v[36:39], v[232:235], v[208:211], v[36:39]
ds_read_b128 v[228:231], v250 offset:14592
ds_read_u16_d16 v200, v200
v_exp_f16_sdwa v206, v207 dst_sel:WORD_1 dst_unused:UNUSED_PRESERVE src0_sel:WORD_1
v_cvt_pk_bf16_f32 v155, v158, v159
v_mfma_f32_16x16x32_f16 v[44:47], v[232:235], v[212:215], v[44:47]
v_lshrrev_b32_e64 v201, 18, v201
v_exp_f16_sdwa v203, v204 dst_sel:WORD_1 dst_unused:UNUSED_PRESERVE src0_sel:WORD_1
v_mfma_f32_16x16x32_bf16 v[68:71], v[236:239], v[104:107], v[68:71]
ds_read_b128 v[232:235], v249 offset:18432
buffer_store_dwordx4 v[152:155], v252, s[8:11], s68 offen offset:128 sc1
ds_read_u16_d16_hi v201, v201
v_pk_add_f16 v81, v81, 1.0 op_sel_hi:[1,0]
v_pk_add_f16 v206, v206, 1.0 op_sel_hi:[1,0]
v_mfma_f32_16x16x32_bf16 v[196:199], v[236:239], v[108:111], v[196:199]
v_pk_add_f16 v203, v203, 1.0 op_sel_hi:[1,0]
s_setprio 0
v_rcp_f16_e64 v82, v81
s_waitcnt lgkmcnt(5)
v_mfma_f32_16x16x32_bf16 v[64:67], v[88:91], v[112:115], v[64:67]
ds_read_b128 v[236:239], v250 offset:15360
v_rcp_f16_e64 v207, v206
v_mfma_f32_16x16x32_bf16 v[192:195], v[88:91], v[116:119], v[192:195]
v_rcp_f16_e64 v204, v203
v_mfma_f32_16x16x32_bf16 v[68:71], v[92:95], v[112:115], v[68:71]
ds_read_b128 v[88:91], v249 offset:18688
v_rcp_f16_sdwa v82, v81 dst_sel:WORD_1 dst_unused:UNUSED_PRESERVE src0_sel:WORD_1
v_mfma_f32_16x16x32_bf16 v[196:199], v[92:95], v[116:119], v[196:199]
v_rcp_f16_sdwa v207, v206 dst_sel:WORD_1 dst_unused:UNUSED_PRESERVE src0_sel:WORD_1
v_or_b32 v208, v72, v73
v_or_b32 v209, v74, v75
v_or_b32_e64 v210, v76, v77
v_rcp_f16_sdwa v204, v203 dst_sel:WORD_1 dst_unused:UNUSED_PRESERVE src0_sel:WORD_1
s_waitcnt lgkmcnt(4)
v_or_b32 v211, v78, v79
s_waitcnt lgkmcnt(2)
v_or_b32 v212, v200, v201
v_pk_mul_f16 v213, v83, v82
v_pk_mul_f16 v214, v80, v207
v_pk_mul_f16 v215, v205, v204
v_mfma_f32_16x16x32_f16 v[0:3], v[224:227], v[208:211], v[0:3]
ds_read_b128 v[92:95], v250 offset:15616
v_cvt_pkrtz_f16_f32 v73, v64, v65
v_cvt_pkrtz_f16_f32 v75, v66, v67
v_mfma_f32_16x16x32_f16 v[8:11], v[224:227], v[212:215], v[8:11]
v_cvt_pkrtz_f16_f32 v77, v68, v69
v_cvt_pkrtz_f16_f32 v79, v70, v71
v_mfma_f32_16x16x32_f16 v[4:7], v[228:231], v[208:211], v[4:7]
ds_read_b128 v[224:227], v249 offset:19456
v_cvt_pkrtz_f16_f32 v201, v192, v193
v_cvt_pk_f16_f32 v83, v194, v195
v_mfma_f32_16x16x32_f16 v[12:15], v[228:231], v[212:215], v[12:15]
v_cvt_pk_f16_f32 v80, v196, v197
v_cvt_pk_f16_f32 v205, v198, v199
v_mfma_f32_16x16x32_bf16 v[64:67], v[232:235], v[96:99], 0
ds_read_b128 v[228:231], v250 offset:16384
v_pk_fma_f16 v82, v83, v83, s48
v_and_b32_e64 v73, s49, v73
v_mfma_f32_16x16x32_bf16 v[192:195], v[232:235], v[100:103], 0
v_pk_fma_f16 v207, v80, v80, s48
v_and_b32 v75, s49, v75
s_waitcnt lgkmcnt(3)
v_mfma_f32_16x16x32_f16 v[16:19], v[236:239], v[208:211], v[16:19]
ds_read_b128 v[232:235], v250 offset:16640
v_pk_fma_f16 v204, v205, v205, s48
v_bfe_u32 v72, v73, 2, 14
v_pk_mul_f16 v82, v83, v82
v_mfma_f32_16x16x32_f16 v[24:27], v[236:239], v[212:215], v[24:27]
v_bfe_u32 v74, v75, 2, 14
v_pk_mul_f16 v207, v80, v207
s_waitcnt vmcnt(4)
v_mfma_f32_16x16x32_bf16 v[32:35], v[186:189], v[240:243], v[32:35]
ds_read_b128 v[236:239], v249 offset:19712
ds_read_u16_d16 v72, v72
ds_read_u16_d16 v74, v74
v_lshrrev_b32 v73, 18, v73
v_pk_mul_f16 v204, v205, v204
v_mfma_f32_16x16x32_bf16 v[36:39], v[184:187], v[240:243], v[36:39]
v_lshrrev_b32_e64 v75, 18, v75
v_mfma_f32_16x16x32_bf16 v[68:71], v[88:91], v[96:99], 0
ds_read_u16_d16_hi v73, v73
ds_read_u16_d16_hi v75, v75
v_exp_f16 v81, v82
v_and_b32 v77, s49, v77
v_mfma_f32_16x16x32_bf16 v[196:199], v[88:91], v[100:103], 0
v_and_b32 v79, s49, v79
s_waitcnt lgkmcnt(6)
v_mfma_f32_16x16x32_f16 v[20:23], v[92:95], v[208:211], v[20:23]
ds_read_b128 v[88:91], v249 offset:20480
v_exp_f16_e64 v206, v207
v_bfe_u32 v76, v77, 2, 14
v_mfma_f32_16x16x32_f16 v[28:31], v[92:95], v[212:215], v[28:31]
v_bfe_u32 v78, v79, 2, 14
v_exp_f16_e64 v203, v204
v_mfma_f32_16x16x32_bf16 v[64:67], v[224:227], v[104:107], v[64:67]
ds_read_b128 v[92:95], v249 offset:20736
ds_read_u16_d16 v76, v76
ds_read_u16_d16 v78, v78
v_lshrrev_b32 v77, 18, v77
v_lshrrev_b32 v79, 18, v79
v_mfma_f32_16x16x32_bf16 v[192:195], v[224:227], v[108:111], v[192:195]
v_exp_f16_sdwa v81, v82 dst_sel:WORD_1 dst_unused:UNUSED_PRESERVE src0_sel:WORD_1
v_mfma_f32_16x16x32_f16 v[32:35], v[228:231], v[208:211], v[32:35]
ds_read_b128 v[224:227], v250 offset:20480
ds_read_u16_d16_hi v77, v77
ds_read_u16_d16_hi v79, v79
v_and_b32 v201, s49, v201
v_bfe_u32 v200, v201, 2, 14
v_mfma_f32_16x16x32_f16 v[40:43], v[228:231], v[212:215], v[40:43]
v_exp_f16_sdwa v206, v207 dst_sel:WORD_1 dst_unused:UNUSED_PRESERVE src0_sel:WORD_1
s_waitcnt lgkmcnt(7)
v_mfma_f32_16x16x32_f16 v[36:39], v[232:235], v[208:211], v[36:39]
ds_read_b128 v[228:231], v250 offset:20736
ds_read_u16_d16 v200, v200
v_lshrrev_b32_e64 v201, 18, v201
v_mfma_f32_16x16x32_f16 v[44:47], v[232:235], v[212:215], v[44:47]
v_exp_f16_sdwa v203, v204 dst_sel:WORD_1 dst_unused:UNUSED_PRESERVE src0_sel:WORD_1
v_pk_add_f16 v81, v81, 1.0 op_sel_hi:[1,0]
v_pk_add_f16 v206, v206, 1.0 op_sel_hi:[1,0]
v_mfma_f32_16x16x32_bf16 v[68:71], v[236:239], v[104:107], v[68:71]
ds_read_b128 v[232:235], v250 offset:21504
ds_read_u16_d16_hi v201, v201
v_pk_add_f16 v203, v203, 1.0 op_sel_hi:[1,0]
v_mfma_f32_16x16x32_bf16 v[196:199], v[236:239], v[108:111], v[196:199]
v_rcp_f16 v82, v81
s_waitcnt lgkmcnt(7)
v_mfma_f32_16x16x32_bf16 v[64:67], v[88:91], v[112:115], v[64:67]
ds_read_b128 v[236:239], v250 offset:21760
v_rcp_f16_e64 v207, v206
v_mfma_f32_16x16x32_bf16 v[192:195], v[88:91], v[116:119], v[192:195]
v_rcp_f16_e64 v204, v203
v_mfma_f32_16x16x32_bf16 v[68:71], v[92:95], v[112:115], v[68:71]
ds_read_b128 v[88:91], v250 offset:22528
v_rcp_f16_sdwa v82, v81 dst_sel:WORD_1 dst_unused:UNUSED_PRESERVE src0_sel:WORD_1
v_mfma_f32_16x16x32_bf16 v[196:199], v[92:95], v[116:119], v[196:199]
v_rcp_f16_sdwa v207, v206 dst_sel:WORD_1 dst_unused:UNUSED_PRESERVE src0_sel:WORD_1
v_or_b32 v208, v72, v73
v_or_b32 v209, v74, v75
s_waitcnt lgkmcnt(4)
v_or_b32 v210, v76, v77
v_rcp_f16_sdwa v204, v203 dst_sel:WORD_1 dst_unused:UNUSED_PRESERVE src0_sel:WORD_1
v_or_b32 v211, v78, v79
s_waitcnt lgkmcnt(2)
v_or_b32_e64 v212, v200, v201
v_pk_mul_f16 v213, v83, v82
v_pk_mul_f16 v214, v80, v207
v_pk_mul_f16 v215, v205, v204
v_mfma_f32_16x16x32_f16 v[0:3], v[224:227], v[208:211], v[0:3]
ds_read_b128 v[92:95], v250 offset:22784
v_cvt_pkrtz_f16_f32 v73, v64, v65
v_cvt_pkrtz_f16_f32 v75, v66, v67
v_cvt_pkrtz_f16_f32 v77, v68, v69
v_cvt_pkrtz_f16_f32 v79, v70, v71
v_cvt_pkrtz_f16_f32 v201, v192, v193
v_mfma_f32_16x16x32_f16 v[8:11], v[224:227], v[212:215], v[8:11]
v_cvt_pk_f16_f32 v83, v194, v195
v_cvt_pk_f16_f32 v80, v196, v197
v_cvt_pk_f16_f32 v205, v198, v199
v_pk_fma_f16 v82, v83, v83, s48
v_cvt_pk_bf16_f32 v160, v160, v161
v_mfma_f32_16x16x32_f16 v[4:7], v[228:231], v[208:211], v[4:7]
ds_read_b128 v[224:227], v250 offset:26624
v_and_b32_e64 v73, s49, v73
v_pk_fma_f16 v207, v80, v80, s48
v_and_b32_e64 v75, s49, v75
v_pk_fma_f16 v204, v205, v205, s48
v_bfe_u32 v72, v73, 2, 14
v_mfma_f32_16x16x32_f16 v[12:15], v[228:231], v[212:215], v[12:15]
v_pk_mul_f16 v82, v83, v82
v_bfe_u32 v74, v75, 2, 14
v_pk_mul_f16 v207, v80, v207
v_lshrrev_b32_e64 v73, 18, v73
v_cvt_pk_bf16_f32 v161, v162, v163
v_mfma_f32_16x16x32_f16 v[16:19], v[232:235], v[208:211], v[16:19]
ds_read_b128 v[228:231], v250 offset:26880
ds_read_u16_d16 v72, v72
ds_read_u16_d16 v74, v74
ds_read_u16_d16_hi v73, v73
v_pk_mul_f16 v204, v205, v204
v_lshrrev_b32 v75, 18, v75
v_exp_f16 v81, v82
v_and_b32_e64 v77, s49, v77
v_mfma_f32_16x16x32_f16 v[24:27], v[232:235], v[212:215], v[24:27]
v_and_b32_e64 v79, s49, v79
v_exp_f16 v206, v207
v_bfe_u32 v76, v77, 2, 14
v_bfe_u32 v78, v79, 2, 14
s_waitcnt lgkmcnt(4)
v_mfma_f32_16x16x32_f16 v[20:23], v[236:239], v[208:211], v[20:23]
ds_read_b128 v[232:235], v250 offset:27648
ds_read_u16_d16_hi v75, v75
ds_read_u16_d16 v76, v76
ds_read_u16_d16 v78, v78
v_cvt_pk_bf16_f32 v162, v164, v165
v_exp_f16 v203, v204
v_lshrrev_b32 v77, 18, v77
v_lshrrev_b32_e64 v79, 18, v79
v_mfma_f32_16x16x32_f16 v[28:31], v[236:239], v[212:215], v[28:31]
v_exp_f16_sdwa v81, v82 dst_sel:WORD_1 dst_unused:UNUSED_PRESERVE src0_sel:WORD_1
v_and_b32_e64 v201, s49, v201
v_bfe_u32 v200, v201, 2, 14
v_mfma_f32_16x16x32_f16 v[32:35], v[88:91], v[208:211], v[32:35]
ds_read_b128 v[236:239], v250 offset:27904
ds_read_u16_d16_hi v77, v77
ds_read_u16_d16_hi v79, v79
ds_read_u16_d16 v200, v200
v_exp_f16_sdwa v206, v207 dst_sel:WORD_1 dst_unused:UNUSED_PRESERVE src0_sel:WORD_1
v_cvt_pk_bf16_f32 v163, v166, v167
v_lshrrev_b32_e64 v201, 18, v201
v_exp_f16_sdwa v203, v204 dst_sel:WORD_1 dst_unused:UNUSED_PRESERVE src0_sel:WORD_1
v_mfma_f32_16x16x32_f16 v[40:43], v[88:91], v[212:215], v[40:43]
v_pk_add_f16 v81, v81, 1.0 op_sel_hi:[1,0]
v_pk_add_f16 v206, v206, 1.0 op_sel_hi:[1,0]
v_pk_add_f16 v203, v203, 1.0 op_sel_hi:[1,0]
v_rcp_f16_e64 v82, v81
v_mfma_f32_16x16x32_f16 v[36:39], v[92:95], v[208:211], v[36:39]
ds_read_b128 v[88:91], v250 offset:28672
s_add_u32 s46, s68, 98304
buffer_store_dwordx4 v[160:163], v252, s[8:11], s46 offen offset:128 sc1
ds_read_u16_d16_hi v201, v201
v_rcp_f16 v207, v206
v_rcp_f16 v204, v203
v_mfma_f32_16x16x32_f16 v[44:47], v[92:95], v[212:215], v[44:47]
v_rcp_f16_sdwa v82, v81 dst_sel:WORD_1 dst_unused:UNUSED_PRESERVE src0_sel:WORD_1
v_rcp_f16_sdwa v207, v206 dst_sel:WORD_1 dst_unused:UNUSED_PRESERVE src0_sel:WORD_1
s_waitcnt lgkmcnt(6)
v_or_b32 v208, v72, v73
v_or_b32 v209, v74, v75
s_waitcnt lgkmcnt(4)
v_or_b32_e64 v210, v76, v77
v_rcp_f16_sdwa v204, v203 dst_sel:WORD_1 dst_unused:UNUSED_PRESERVE src0_sel:WORD_1
s_waitcnt lgkmcnt(2)
v_or_b32 v211, v78, v79
s_waitcnt lgkmcnt(0)
v_or_b32 v212, v200, v201
v_pk_mul_f16 v213, v83, v82
v_pk_mul_f16 v214, v80, v207
v_pk_mul_f16 v215, v205, v204
v_mfma_f32_16x16x32_f16 v[0:3], v[224:227], v[208:211], v[0:3]
ds_read_b128 v[92:95], v250 offset:28928
v_mfma_f32_16x16x32_f16 v[8:11], v[224:227], v[212:215], v[8:11]
v_mfma_f32_16x16x32_f16 v[4:7], v[228:231], v[208:211], v[4:7]
v_mfma_f32_16x16x32_f16 v[12:15], v[228:231], v[212:215], v[12:15]
v_mfma_f32_16x16x32_f16 v[16:19], v[232:235], v[208:211], v[16:19]
v_mfma_f32_16x16x32_f16 v[24:27], v[232:235], v[212:215], v[24:27]
s_waitcnt vmcnt(3)
v_mfma_f32_16x16x32_bf16 v[40:43], v[186:189], v[244:247], v[40:43]
v_mfma_f32_16x16x32_bf16 v[44:47], v[184:187], v[244:247], v[44:47]
v_mfma_f32_16x16x32_f16 v[20:23], v[236:239], v[208:211], v[20:23]
v_mfma_f32_16x16x32_f16 v[28:31], v[236:239], v[212:215], v[28:31]
v_mfma_f32_16x16x32_f16 v[32:35], v[88:91], v[208:211], v[32:35]
v_mfma_f32_16x16x32_f16 v[40:43], v[88:91], v[212:215], v[40:43]
s_waitcnt lgkmcnt(0)
v_mfma_f32_16x16x32_f16 v[36:39], v[92:95], v[208:211], v[36:39]
v_mfma_f32_16x16x32_f16 v[44:47], v[92:95], v[212:215], v[44:47]
v_cvt_pk_bf16_f32 v0, v0, v1
v_cvt_pk_bf16_f32 v1, v2, v3
v_cvt_pk_bf16_f32 v2, v4, v5
v_cvt_pk_bf16_f32 v3, v6, v7
buffer_store_dwordx4 v[0:3], v252, s[8:11], s69 offen sc1
v_cvt_pk_bf16_f32 v8, v8, v9
v_cvt_pk_bf16_f32 v9, v10, v11
v_cvt_pk_bf16_f32 v10, v12, v13
v_cvt_pk_bf16_f32 v11, v14, v15
s_add_u32 s46, s69, 98304
buffer_store_dwordx4 v[8:11], v252, s[8:11], s46 offen sc1
v_cvt_pk_bf16_f32 v16, v16, v17
v_cvt_pk_bf16_f32 v17, v18, v19
v_cvt_pk_bf16_f32 v18, v20, v21
v_cvt_pk_bf16_f32 v19, v22, v23
buffer_store_dwordx4 v[16:19], v252, s[8:11], s69 offen offset:64 sc1
v_cvt_pk_bf16_f32 v24, v24, v25
v_cvt_pk_bf16_f32 v25, v26, v27
v_cvt_pk_bf16_f32 v26, v28, v29
v_cvt_pk_bf16_f32 v27, v30, v31
s_add_u32 s46, s69, 98304
buffer_store_dwordx4 v[24:27], v252, s[8:11], s46 offen offset:64 sc1
v_cvt_pk_bf16_f32 v32, v32, v33
v_cvt_pk_bf16_f32 v33, v34, v35
v_cvt_pk_bf16_f32 v34, v36, v37
v_cvt_pk_bf16_f32 v35, v38, v39
buffer_store_dwordx4 v[32:35], v252, s[8:11], s69 offen offset:128 sc1
v_cvt_pk_bf16_f32 v40, v40, v41
v_cvt_pk_bf16_f32 v41, v42, v43
v_cvt_pk_bf16_f32 v42, v44, v45
v_cvt_pk_bf16_f32 v43, v46, v47
s_add_u32 s46, s69, 98304
buffer_store_dwordx4 v[40:43], v252, s[8:11], s46 offen offset:128 sc1
s_endpgm
Lpoll:
s_waitcnt vmcnt(0)
s_cmp_eq_u32 s77, 2
s_cbranch_scc1 LpollC
v_max_u32 v255, v156, v157
v_max3_u32 v255, v255, v158, v159
v_max3_u32 v255, v255, v160, v161
v_max3_u32 v255, v255, v162, v163
v_max3_u32 v255, v255, v164, v165
v_max3_u32 v255, v255, v166, v167
v_max3_u32 v255, v255, v240, v241
v_max3_u32 v255, v255, v242, v243
v_cmp_eq_u32 vcc, -1, v255
s_nop 4
s_cbranch_vccz LpollR
v_lshlrev_b32 v247, 4, v251
s_lshl_b32 s44, s2, 12
buffer_load_dwordx4 v[156:159], v247, s[32:35], s44 offen sc1
buffer_load_dwordx4 v[160:163], v247, s[32:35], s44 offen offset:1024 sc1
buffer_load_dwordx4 v[164:167], v247, s[32:35], s44 offen offset:2048 sc1
buffer_load_dwordx4 v[240:243], v247, s[32:35], s44 offen offset:3072 sc1
s_setpc_b64 s[78:79]
LpollR:
s_setprio 3
v_add_f32 v156, v156, v160
v_add_f32 v240, v164, v240
v_add_f32 v240, v156, v240
v_add_f32 v157, v157, v161
v_add_f32 v241, v165, v241
v_add_f32 v241, v157, v241
v_add_f32 v158, v158, v162
v_add_f32 v242, v166, v242
v_add_f32 v242, v158, v242
v_add_f32 v159, v159, v163
v_add_f32 v243, v167, v243
v_add_f32 v243, v159, v243
v_add_f32_dpp v240, v240, v240 row_ror:8 row_mask:0xf bank_mask:0xf
s_nop 1
v_add_f32_dpp v240, v240, v240 row_ror:4 row_mask:0xf bank_mask:0xf
s_nop 1
v_add_f32_dpp v240, v240, v240 row_ror:2 row_mask:0xf bank_mask:0xf
s_nop 1
v_add_f32_dpp v240, v240, v240 row_ror:1 row_mask:0xf bank_mask:0xf
v_mov_b32 v255, v240
s_nop 1
v_permlane16_swap_b32 v240, v255
v_add_f32 v240, v240, v255
v_mov_b32 v255, v240
s_nop 1
v_permlane32_swap_b32 v240, v255
v_add_f32 v240, v240, v255
v_min_u32 v240, -2, v240
v_add_f32_dpp v241, v241, v241 row_ror:8 row_mask:0xf bank_mask:0xf
s_nop 1
v_add_f32_dpp v241, v241, v241 row_ror:4 row_mask:0xf bank_mask:0xf
s_nop 1
v_add_f32_dpp v241, v241, v241 row_ror:2 row_mask:0xf bank_mask:0xf
s_nop 1
v_add_f32_dpp v241, v241, v241 row_ror:1 row_mask:0xf bank_mask:0xf
v_mov_b32 v255, v241
s_nop 1
v_permlane16_swap_b32 v241, v255
v_add_f32 v241, v241, v255
v_mov_b32 v255, v241
s_nop 1
v_permlane32_swap_b32 v241, v255
v_add_f32 v241, v241, v255
v_min_u32 v241, -2, v241
v_add_f32_dpp v242, v242, v242 row_ror:8 row_mask:0xf bank_mask:0xf
s_nop 1
v_add_f32_dpp v242, v242, v242 row_ror:4 row_mask:0xf bank_mask:0xf
s_nop 1
v_add_f32_dpp v242, v242, v242 row_ror:2 row_mask:0xf bank_mask:0xf
s_nop 1
v_add_f32_dpp v242, v242, v242 row_ror:1 row_mask:0xf bank_mask:0xf
v_mov_b32 v255, v242
s_nop 1
v_permlane16_swap_b32 v242, v255
v_add_f32 v242, v242, v255
v_mov_b32 v255, v242
s_nop 1
v_permlane32_swap_b32 v242, v255
v_add_f32 v242, v242, v255
v_min_u32 v242, -2, v242
v_add_f32_dpp v243, v243, v243 row_ror:8 row_mask:0xf bank_mask:0xf
s_nop 1
v_add_f32_dpp v243, v243, v243 row_ror:4 row_mask:0xf bank_mask:0xf
s_nop 1
v_add_f32_dpp v243, v243, v243 row_ror:2 row_mask:0xf bank_mask:0xf
s_nop 1
v_add_f32_dpp v243, v243, v243 row_ror:1 row_mask:0xf bank_mask:0xf
v_mov_b32 v255, v243
s_nop 1
v_permlane16_swap_b32 v243, v255
v_add_f32 v243, v243, v255
v_mov_b32 v255, v243
s_nop 1
v_permlane32_swap_b32 v243, v255
v_add_f32_e64 v243, v243, v255
v_min_u32 v243, -2, v243
s_lshl_b32 s44, s2, 4
s_add_u32 s44, s44, 393216
v_lshlrev_b32_e64 v255, 11, v251
s_mov_b64 exec, 0xff
buffer_store_dwordx4 v[240:243], v255, s[32:35], s44 offen sc1
s_mov_b64 exec, -1
s_mov_b32 s77, 2
v_lshlrev_b32_e64 v247, 3, v251
s_and_b32 s44, s2, 7
s_lshl_b32 s44, s44, 11
s_add_u32 s44, s44, 393216
buffer_load_dwordx2 v[156:157], v247, s[32:35], s44 offen sc1
buffer_load_dwordx2 v[158:159], v247, s[32:35], s44 offen offset:512 sc1
buffer_load_dwordx2 v[160:161], v247, s[32:35], s44 offen offset:1024 sc1
s_setpc_b64 s[78:79]
LpollC:
v_max3_u32 v255, v156, v157, v158
v_max3_u32 v255, v255, v159, v160
v_max_u32 v255, v255, v161
v_cmp_eq_u32 vcc, -1, v255
s_nop 4
s_cbranch_vccz LpollS
v_lshlrev_b32 v247, 3, v251
s_and_b32 s44, s2, 7
s_lshl_b32 s44, s44, 11
s_add_u32 s44, s44, 393216
buffer_load_dwordx2 v[156:157], v247, s[32:35], s44 offen sc1
buffer_load_dwordx2 v[158:159], v247, s[32:35], s44 offen offset:512 sc1
buffer_load_dwordx2 v[160:161], v247, s[32:35], s44 offen offset:1024 sc1
s_setpc_b64 s[78:79]
LpollS:
s_setprio 3
s_mov_b32 s43, 1083296634
v_mov_b32 v162, 897988541
v_fma_f32 v156, v156, s43, v162
v_fma_f32 v157, v157, s43, v162
v_fma_f32 v158, v158, s43, v162
v_fma_f32 v159, v159, s43, v162
v_fma_f32 v160, v160, s43, v162
v_fma_f32 v161, v161, s43, v162
v_sqrt_f32 v156, v156
v_sqrt_f32 v157, v157
v_sqrt_f32 v158, v158
v_sqrt_f32 v159, v159
v_sqrt_f32 v160, v160
v_sqrt_f32 v161, v161
v_add_f32 v163, v156, v157
v_add_f32 v163, v163, v158
v_add_f32 v163, v163, v159
v_add_f32 v163, v163, v160
v_add_f32 v163, v163, v161
s_nop 1
v_add_f32_dpp v163, v163, v163 row_ror:8 row_mask:0xf bank_mask:0xf
s_nop 1
v_add_f32_dpp v163, v163, v163 row_ror:4 row_mask:0xf bank_mask:0xf
s_nop 1
v_add_f32_dpp v163, v163, v163 row_ror:2 row_mask:0xf bank_mask:0xf
s_nop 1
v_add_f32_dpp v163, v163, v163 row_ror:1 row_mask:0xf bank_mask:0xf
v_mov_b32 v255, v163
s_nop 1
v_permlane16_swap_b32 v163, v255
v_add_f32 v163, v163, v255
v_mov_b32 v255, v163
s_nop 1
v_permlane32_swap_b32 v163, v255
v_add_f32_e64 v163, v163, v255
s_mov_b32 s43, 992651947
v_fma_f32 v163, v163, s43, v162
v_rcp_f32_e64 v163, v163
v_mov_b32 v162, 3221789604
v_mul_f32 v163, v163, v162
v_lshlrev_b32 v164, 16, v244
v_and_b32 v165, 4294901760, v244
v_mul_f32 v156, v156, v163
v_mul_f32 v157, v157, v163
v_fma_f32 v164, v164, v156, v162
v_fma_f32 v165, v165, v157, v162
v_cvt_pk_f16_f32 v244, v164, v165
v_lshlrev_b32_e64 v164, 16, v245
v_and_b32 v165, 4294901760, v245
v_mul_f32 v158, v158, v163
v_mul_f32 v159, v159, v163
v_fma_f32 v164, v164, v158, v162
v_fma_f32 v165, v165, v159, v162
v_cvt_pk_f16_f32 v245, v164, v165
v_lshlrev_b32_e64 v164, 16, v246
v_and_b32 v165, 4294901760, v246
v_mul_f32 v160, v160, v163
v_mul_f32 v161, v161, v163
v_fma_f32 v164, v164, v160, v162
v_fma_f32 v165, v165, v161, v162
v_cvt_pk_f16_f32 v246, v164, v165
s_mov_b32 s77, 0
s_setpc_b64 s[78:79]
Lend:
s_endpgm

.section .rodata,"a"
.p2align 6
.amdhsa_kernel standalone__modern_conv_block_convnext_v2__vision_kernel
  .amdhsa_next_free_vgpr 256
  .amdhsa_next_free_sgpr 102
  .amdhsa_accum_offset 256
  .amdhsa_group_segment_fixed_size 0
  .amdhsa_kernarg_size 72
  .amdhsa_user_sgpr_count 2
  .amdhsa_user_sgpr_kernarg_segment_ptr 1
  .amdhsa_system_sgpr_workgroup_id_x 1
.end_amdhsa_kernel
```

```asm
; @launch grid=(256,1,1) block=(512,1,1) lds=163840
.amdgcn_target "amdgcn-amd-amdhsa--gfx950"
.text
.globl standalone__modern_conv_block_convnext_v2__vision_kernel
.p2align 8
.type standalone__modern_conv_block_convnext_v2__vision_kernel,@function
standalone__modern_conv_block_convnext_v2__vision_kernel:
s_branch Lmain
Lconv0:
ds_read_b64 v[224:225], v245
ds_read_b64 v[226:227], v246
ds_read_b128 v[192:195], v242
ds_read_b64 v[228:229], v245 offset:768
ds_read_b64 v[230:231], v246 offset:768
ds_read_b128 v[196:199], v242 offset:64
ds_read_b64 v[232:233], v245 offset:1536
ds_read_b64 v[234:235], v246 offset:1536
ds_read_b128 v[200:203], v242 offset:128
ds_read_b64 v[236:237], v245 offset:2304
ds_read_b64 v[238:239], v246 offset:2304
ds_read_b128 v[204:207], v243
ds_read_b64 v[216:217], v245 offset:3072
ds_read_b64 v[218:219], v246 offset:3072
ds_read_b128 v[208:211], v243 offset:64
ds_read_b64 v[220:221], v245 offset:3840
ds_read_b64 v[222:223], v246 offset:3840
ds_read_b128 v[212:215], v243 offset:128
s_waitcnt lgkmcnt(15)
v_mfma_f32_16x16x32_bf16 v[0:3], v[224:227], v[192:195], 0
s_waitcnt lgkmcnt(12)
v_mfma_f32_16x16x32_bf16 v[16:19], v[228:231], v[196:199], 0
ds_read_b64 v[224:225], v245 offset:4608
ds_read_b64 v[226:227], v246 offset:4608
ds_read_b128 v[192:195], v244
s_waitcnt lgkmcnt(12)
v_mfma_f32_16x16x32_bf16 v[32:35], v[232:235], v[200:203], 0
ds_read_b64 v[228:229], v245 offset:5376
ds_read_b64 v[230:231], v246 offset:5376
ds_read_b128 v[196:199], v244 offset:64
s_waitcnt lgkmcnt(12)
v_mfma_f32_16x16x32_bf16 v[0:3], v[236:239], v[204:207], v[0:3]
ds_read_b64 v[232:233], v245 offset:6144
ds_read_b64 v[234:235], v246 offset:6144
ds_read_b128 v[200:203], v244 offset:128
s_waitcnt lgkmcnt(12)
v_mfma_f32_16x16x32_bf16 v[16:19], v[216:219], v[208:211], v[16:19]
ds_read_b64 v[236:237], v245 offset:192
ds_read_b64 v[238:239], v246 offset:192
v_xor_b32 v242, 16, v242
ds_read_b128 v[204:207], v242
s_waitcnt lgkmcnt(12)
v_mfma_f32_16x16x32_bf16 v[32:35], v[220:223], v[212:215], v[32:35]
ds_read_b64 v[216:217], v245 offset:960
ds_read_b64 v[218:219], v246 offset:960
ds_read_b128 v[208:211], v242 offset:64
s_waitcnt lgkmcnt(12)
v_mfma_f32_16x16x32_bf16 v[0:3], v[224:227], v[192:195], v[0:3]
ds_read_b64 v[220:221], v245 offset:1728
ds_read_b64 v[222:223], v246 offset:1728
ds_read_b128 v[212:215], v242 offset:128
s_waitcnt lgkmcnt(12)
v_mfma_f32_16x16x32_bf16 v[16:19], v[228:231], v[196:199], v[16:19]
ds_read_b64 v[224:225], v245 offset:2496
ds_read_b64 v[226:227], v246 offset:2496
v_xor_b32 v243, 16, v243
ds_read_b128 v[192:195], v243
s_waitcnt lgkmcnt(12)
v_mfma_f32_16x16x32_bf16 v[32:35], v[232:235], v[200:203], v[32:35]
ds_read_b64 v[228:229], v245 offset:3264
ds_read_b64 v[230:231], v246 offset:3264
ds_read_b128 v[196:199], v243 offset:64
s_waitcnt lgkmcnt(12)
v_mfma_f32_16x16x32_bf16 v[4:7], v[236:239], v[204:207], 0
ds_read_b64 v[232:233], v245 offset:4032
ds_read_b64 v[234:235], v246 offset:4032
ds_read_b128 v[200:203], v243 offset:128
s_waitcnt lgkmcnt(12)
v_mfma_f32_16x16x32_bf16 v[20:23], v[216:219], v[208:211], 0
ds_read_b64 v[236:237], v245 offset:4800
ds_read_b64 v[238:239], v246 offset:4800
v_xor_b32 v244, 16, v244
ds_read_b128 v[204:207], v244
s_waitcnt lgkmcnt(12)
v_mfma_f32_16x16x32_bf16 v[36:39], v[220:223], v[212:215], 0
ds_read_b64 v[216:217], v245 offset:5568
ds_read_b64 v[218:219], v246 offset:5568
ds_read_b128 v[208:211], v244 offset:64
s_waitcnt lgkmcnt(12)
v_mfma_f32_16x16x32_bf16 v[4:7], v[224:227], v[192:195], v[4:7]
ds_read_b64 v[220:221], v245 offset:6336
ds_read_b64 v[222:223], v246 offset:6336
ds_read_b128 v[212:215], v244 offset:128
s_waitcnt lgkmcnt(12)
v_mfma_f32_16x16x32_bf16 v[20:23], v[228:231], v[196:199], v[20:23]
ds_read_b64 v[224:225], v245 offset:576
ds_read_b64 v[226:227], v246 offset:576
v_xor_b32 v242, 32, v242
ds_read_b128 v[192:195], v242
s_waitcnt lgkmcnt(12)
v_mfma_f32_16x16x32_bf16 v[36:39], v[232:235], v[200:203], v[36:39]
ds_read_b64 v[228:229], v245 offset:1344
ds_read_b64 v[230:231], v246 offset:1344
ds_read_b128 v[196:199], v242 offset:64
s_waitcnt lgkmcnt(12)
v_mfma_f32_16x16x32_bf16 v[4:7], v[236:239], v[204:207], v[4:7]
ds_read_b64 v[232:233], v245 offset:2112
ds_read_b64 v[234:235], v246 offset:2112
ds_read_b128 v[200:203], v242 offset:128
s_waitcnt lgkmcnt(12)
v_mfma_f32_16x16x32_bf16 v[20:23], v[216:219], v[208:211], v[20:23]
ds_read_b64 v[236:237], v245 offset:2880
ds_read_b64 v[238:239], v246 offset:2880
v_xor_b32 v243, 32, v243
ds_read_b128 v[204:207], v243
s_waitcnt lgkmcnt(12)
v_mfma_f32_16x16x32_bf16 v[36:39], v[220:223], v[212:215], v[36:39]
ds_read_b64 v[216:217], v245 offset:3648
ds_read_b64 v[218:219], v246 offset:3648
ds_read_b128 v[208:211], v243 offset:64
s_waitcnt lgkmcnt(12)
v_mfma_f32_16x16x32_bf16 v[12:15], v[224:227], v[192:195], 0
ds_read_b64 v[220:221], v245 offset:4416
ds_read_b64 v[222:223], v246 offset:4416
ds_read_b128 v[212:215], v243 offset:128
s_waitcnt lgkmcnt(12)
v_mfma_f32_16x16x32_bf16 v[28:31], v[228:231], v[196:199], 0
ds_read_b64 v[224:225], v245 offset:5184
ds_read_b64 v[226:227], v246 offset:5184
v_xor_b32 v244, 32, v244
ds_read_b128 v[192:195], v244
s_waitcnt lgkmcnt(12)
v_mfma_f32_16x16x32_bf16 v[44:47], v[232:235], v[200:203], 0
ds_read_b64 v[228:229], v245 offset:5952
ds_read_b64 v[230:231], v246 offset:5952
ds_read_b128 v[196:199], v244 offset:64
s_waitcnt lgkmcnt(12)
v_mfma_f32_16x16x32_bf16 v[12:15], v[236:239], v[204:207], v[12:15]
ds_read_b64 v[232:233], v245 offset:6720
ds_read_b64 v[234:235], v246 offset:6720
ds_read_b128 v[200:203], v244 offset:128
s_waitcnt lgkmcnt(12)
v_mfma_f32_16x16x32_bf16 v[28:31], v[216:219], v[208:211], v[28:31]
ds_read_b64 v[236:237], v245 offset:384
ds_read_b64 v[238:239], v246 offset:384
v_xor_b32 v242, 16, v242
ds_read_b128 v[204:207], v242
s_waitcnt lgkmcnt(12)
v_mfma_f32_16x16x32_bf16 v[44:47], v[220:223], v[212:215], v[44:47]
ds_read_b64 v[216:217], v245 offset:1152
ds_read_b64 v[218:219], v246 offset:1152
ds_read_b128 v[208:211], v242 offset:64
s_waitcnt lgkmcnt(12)
v_mfma_f32_16x16x32_bf16 v[12:15], v[224:227], v[192:195], v[12:15]
ds_read_b64 v[220:221], v245 offset:1920
ds_read_b64 v[222:223], v246 offset:1920
ds_read_b128 v[212:215], v242 offset:128
s_waitcnt lgkmcnt(12)
v_mfma_f32_16x16x32_bf16 v[28:31], v[228:231], v[196:199], v[28:31]
ds_read_b64 v[224:225], v245 offset:2688
ds_read_b64 v[226:227], v246 offset:2688
v_xor_b32 v243, 16, v243
ds_read_b128 v[192:195], v243
s_waitcnt lgkmcnt(12)
v_mfma_f32_16x16x32_bf16 v[44:47], v[232:235], v[200:203], v[44:47]
ds_read_b64 v[228:229], v245 offset:3456
ds_read_b64 v[230:231], v246 offset:3456
ds_read_b128 v[196:199], v243 offset:64
s_waitcnt lgkmcnt(12)
v_mfma_f32_16x16x32_bf16 v[8:11], v[236:239], v[204:207], 0
ds_read_b64 v[232:233], v245 offset:4224
ds_read_b64 v[234:235], v246 offset:4224
ds_read_b128 v[200:203], v243 offset:128
s_waitcnt lgkmcnt(12)
v_mfma_f32_16x16x32_bf16 v[24:27], v[216:219], v[208:211], 0
ds_read_b64 v[236:237], v245 offset:4992
ds_read_b64 v[238:239], v246 offset:4992
v_xor_b32 v244, 16, v244
ds_read_b128 v[204:207], v244
s_waitcnt lgkmcnt(12)
v_mfma_f32_16x16x32_bf16 v[40:43], v[220:223], v[212:215], 0
ds_read_b64 v[216:217], v245 offset:5760
ds_read_b64 v[218:219], v246 offset:5760
ds_read_b128 v[208:211], v244 offset:64
s_waitcnt lgkmcnt(12)
v_mfma_f32_16x16x32_bf16 v[8:11], v[224:227], v[192:195], v[8:11]
ds_read_b64 v[220:221], v245 offset:6528
ds_read_b64 v[222:223], v246 offset:6528
ds_read_b128 v[212:215], v244 offset:128
s_waitcnt lgkmcnt(12)
v_mfma_f32_16x16x32_bf16 v[24:27], v[228:231], v[196:199], v[24:27]
s_waitcnt lgkmcnt(9)
v_mfma_f32_16x16x32_bf16 v[40:43], v[232:235], v[200:203], v[40:43]
s_waitcnt lgkmcnt(6)
v_mfma_f32_16x16x32_bf16 v[8:11], v[236:239], v[204:207], v[8:11]
s_waitcnt lgkmcnt(3)
v_mfma_f32_16x16x32_bf16 v[24:27], v[216:219], v[208:211], v[24:27]
s_waitcnt lgkmcnt(0)
v_mfma_f32_16x16x32_bf16 v[40:43], v[220:223], v[212:215], v[40:43]
s_nop 11
s_setpc_b64 s[78:79]
Lln0:
v_pk_add_f32 v[168:169], v[0:1], v[2:3]
v_pk_mul_f32 v[170:171], v[0:1], v[0:1]
v_pk_fma_f32 v[170:171], v[2:3], v[2:3], v[170:171]
v_pk_add_f32 v[168:169], v[168:169], v[4:5]
v_pk_fma_f32 v[170:171], v[4:5], v[4:5], v[170:171]
v_pk_add_f32 v[168:169], v[168:169], v[6:7]
v_pk_fma_f32 v[170:171], v[6:7], v[6:7], v[170:171]
v_pk_add_f32 v[168:169], v[168:169], v[8:9]
v_pk_fma_f32 v[170:171], v[8:9], v[8:9], v[170:171]
v_pk_add_f32 v[168:169], v[168:169], v[10:11]
v_pk_fma_f32 v[170:171], v[10:11], v[10:11], v[170:171]
v_pk_add_f32 v[168:169], v[168:169], v[12:13]
v_pk_fma_f32 v[170:171], v[12:13], v[12:13], v[170:171]
v_pk_add_f32 v[168:169], v[168:169], v[14:15]
v_pk_fma_f32 v[170:171], v[14:15], v[14:15], v[170:171]
v_pk_add_f32 v[168:169], v[168:169], v[16:17]
v_pk_fma_f32 v[170:171], v[16:17], v[16:17], v[170:171]
v_pk_add_f32 v[168:169], v[168:169], v[18:19]
v_pk_fma_f32 v[170:171], v[18:19], v[18:19], v[170:171]
v_pk_add_f32 v[168:169], v[168:169], v[20:21]
v_pk_fma_f32 v[170:171], v[20:21], v[20:21], v[170:171]
v_pk_add_f32 v[168:169], v[168:169], v[22:23]
v_pk_fma_f32 v[170:171], v[22:23], v[22:23], v[170:171]
v_pk_add_f32 v[168:169], v[168:169], v[24:25]
v_pk_fma_f32 v[170:171], v[24:25], v[24:25], v[170:171]
v_pk_add_f32 v[168:169], v[168:169], v[26:27]
v_pk_fma_f32 v[170:171], v[26:27], v[26:27], v[170:171]
v_pk_add_f32 v[168:169], v[168:169], v[28:29]
v_pk_fma_f32 v[170:171], v[28:29], v[28:29], v[170:171]
v_pk_add_f32 v[168:169], v[168:169], v[30:31]
v_pk_fma_f32 v[170:171], v[30:31], v[30:31], v[170:171]
v_pk_add_f32 v[168:169], v[168:169], v[32:33]
v_pk_fma_f32 v[170:171], v[32:33], v[32:33], v[170:171]
v_pk_add_f32 v[168:169], v[168:169], v[34:35]
v_pk_fma_f32 v[170:171], v[34:35], v[34:35], v[170:171]
v_pk_add_f32 v[168:169], v[168:169], v[36:37]
v_pk_fma_f32 v[170:171], v[36:37], v[36:37], v[170:171]
v_pk_add_f32 v[168:169], v[168:169], v[38:39]
v_pk_fma_f32 v[170:171], v[38:39], v[38:39], v[170:171]
v_pk_add_f32 v[168:169], v[168:169], v[40:41]
v_pk_fma_f32 v[170:171], v[40:41], v[40:41], v[170:171]
v_pk_add_f32 v[168:169], v[168:169], v[42:43]
v_pk_fma_f32 v[170:171], v[42:43], v[42:43], v[170:171]
v_pk_add_f32 v[168:169], v[168:169], v[44:45]
v_pk_fma_f32 v[170:171], v[44:45], v[44:45], v[170:171]
v_pk_add_f32 v[168:169], v[168:169], v[46:47]
v_pk_fma_f32 v[170:171], v[46:47], v[46:47], v[170:171]
v_add_f32 v168, v168, v169
v_add_f32 v170, v170, v171
s_nop 1
v_permlane32_swap_b32 v168, v170
v_add_f32_e64 v168, v168, v170
v_mul_f32 v168, 1009429163, v168
v_mov_b32_e64 v170, v168
s_nop 1
v_permlane32_swap_b32 v168, v170
v_fma_f32 v170, -v168, v168, v170
v_max_f32_e64 v170, 0, v170
v_add_f32 v170, 925353388, v170
v_rsq_f32 v170, v170
s_nop 0
v_mul_f32 v172, 3203391086, v170
v_mul_f32_e64 v173, v168, v172
v_pk_fma_f32 v[0:1], v[0:1], v[172:173], v[172:173] op_sel:[0,0,1] op_sel_hi:[1,0,1] neg_lo:[0,0,1] neg_hi:[0,0,1]
v_pk_fma_f32 v[2:3], v[2:3], v[172:173], v[172:173] op_sel:[0,0,1] op_sel_hi:[1,0,1] neg_lo:[0,0,1] neg_hi:[0,0,1]
v_pk_fma_f32 v[4:5], v[4:5], v[172:173], v[172:173] op_sel:[0,0,1] op_sel_hi:[1,0,1] neg_lo:[0,0,1] neg_hi:[0,0,1]
v_pk_fma_f32 v[6:7], v[6:7], v[172:173], v[172:173] op_sel:[0,0,1] op_sel_hi:[1,0,1] neg_lo:[0,0,1] neg_hi:[0,0,1]
v_pk_fma_f32 v[8:9], v[8:9], v[172:173], v[172:173] op_sel:[0,0,1] op_sel_hi:[1,0,1] neg_lo:[0,0,1] neg_hi:[0,0,1]
v_pk_fma_f32 v[10:11], v[10:11], v[172:173], v[172:173] op_sel:[0,0,1] op_sel_hi:[1,0,1] neg_lo:[0,0,1] neg_hi:[0,0,1]
v_pk_fma_f32 v[12:13], v[12:13], v[172:173], v[172:173] op_sel:[0,0,1] op_sel_hi:[1,0,1] neg_lo:[0,0,1] neg_hi:[0,0,1]
v_pk_fma_f32 v[14:15], v[14:15], v[172:173], v[172:173] op_sel:[0,0,1] op_sel_hi:[1,0,1] neg_lo:[0,0,1] neg_hi:[0,0,1]
v_pk_fma_f32 v[16:17], v[16:17], v[172:173], v[172:173] op_sel:[0,0,1] op_sel_hi:[1,0,1] neg_lo:[0,0,1] neg_hi:[0,0,1]
v_pk_fma_f32 v[18:19], v[18:19], v[172:173], v[172:173] op_sel:[0,0,1] op_sel_hi:[1,0,1] neg_lo:[0,0,1] neg_hi:[0,0,1]
v_pk_fma_f32 v[20:21], v[20:21], v[172:173], v[172:173] op_sel:[0,0,1] op_sel_hi:[1,0,1] neg_lo:[0,0,1] neg_hi:[0,0,1]
v_pk_fma_f32 v[22:23], v[22:23], v[172:173], v[172:173] op_sel:[0,0,1] op_sel_hi:[1,0,1] neg_lo:[0,0,1] neg_hi:[0,0,1]
v_pk_fma_f32 v[24:25], v[24:25], v[172:173], v[172:173] op_sel:[0,0,1] op_sel_hi:[1,0,1] neg_lo:[0,0,1] neg_hi:[0,0,1]
v_pk_fma_f32 v[26:27], v[26:27], v[172:173], v[172:173] op_sel:[0,0,1] op_sel_hi:[1,0,1] neg_lo:[0,0,1] neg_hi:[0,0,1]
v_pk_fma_f32 v[28:29], v[28:29], v[172:173], v[172:173] op_sel:[0,0,1] op_sel_hi:[1,0,1] neg_lo:[0,0,1] neg_hi:[0,0,1]
v_pk_fma_f32 v[30:31], v[30:31], v[172:173], v[172:173] op_sel:[0,0,1] op_sel_hi:[1,0,1] neg_lo:[0,0,1] neg_hi:[0,0,1]
v_pk_fma_f32 v[32:33], v[32:33], v[172:173], v[172:173] op_sel:[0,0,1] op_sel_hi:[1,0,1] neg_lo:[0,0,1] neg_hi:[0,0,1]
v_pk_fma_f32 v[34:35], v[34:35], v[172:173], v[172:173] op_sel:[0,0,1] op_sel_hi:[1,0,1] neg_lo:[0,0,1] neg_hi:[0,0,1]
v_pk_fma_f32 v[36:37], v[36:37], v[172:173], v[172:173] op_sel:[0,0,1] op_sel_hi:[1,0,1] neg_lo:[0,0,1] neg_hi:[0,0,1]
v_pk_fma_f32 v[38:39], v[38:39], v[172:173], v[172:173] op_sel:[0,0,1] op_sel_hi:[1,0,1] neg_lo:[0,0,1] neg_hi:[0,0,1]
v_pk_fma_f32 v[40:41], v[40:41], v[172:173], v[172:173] op_sel:[0,0,1] op_sel_hi:[1,0,1] neg_lo:[0,0,1] neg_hi:[0,0,1]
v_pk_fma_f32 v[42:43], v[42:43], v[172:173], v[172:173] op_sel:[0,0,1] op_sel_hi:[1,0,1] neg_lo:[0,0,1] neg_hi:[0,0,1]
v_pk_fma_f32 v[44:45], v[44:45], v[172:173], v[172:173] op_sel:[0,0,1] op_sel_hi:[1,0,1] neg_lo:[0,0,1] neg_hi:[0,0,1]
v_pk_fma_f32 v[46:47], v[46:47], v[172:173], v[172:173] op_sel:[0,0,1] op_sel_hi:[1,0,1] neg_lo:[0,0,1] neg_hi:[0,0,1]
v_cvt_pk_bf16_f32 v48, v0, v1
v_cvt_pk_bf16_f32 v49, v2, v3
v_cvt_pk_bf16_f32 v50, v4, v5
v_cvt_pk_bf16_f32 v51, v6, v7
v_cvt_pk_bf16_f32 v52, v8, v9
v_cvt_pk_bf16_f32 v53, v10, v11
v_cvt_pk_bf16_f32 v54, v12, v13
v_cvt_pk_bf16_f32 v55, v14, v15
v_cvt_pk_bf16_f32 v56, v16, v17
v_cvt_pk_bf16_f32 v57, v18, v19
v_cvt_pk_bf16_f32 v58, v20, v21
v_cvt_pk_bf16_f32 v59, v22, v23
v_cvt_pk_bf16_f32 v60, v24, v25
v_cvt_pk_bf16_f32 v61, v26, v27
v_cvt_pk_bf16_f32 v62, v28, v29
v_cvt_pk_bf16_f32 v63, v30, v31
v_cvt_pk_bf16_f32 v64, v32, v33
v_cvt_pk_bf16_f32 v65, v34, v35
v_cvt_pk_bf16_f32 v66, v36, v37
v_cvt_pk_bf16_f32 v67, v38, v39
v_cvt_pk_bf16_f32 v68, v40, v41
v_cvt_pk_bf16_f32 v69, v42, v43
v_cvt_pk_bf16_f32 v70, v44, v45
v_cvt_pk_bf16_f32 v71, v46, v47
s_nop 1
s_setpc_b64 s[78:79]
Lw1a:
s_waitcnt vmcnt(0)
v_add_u32 v148, 65536, v146
v_add_u32 v149, 65536, v147
ds_read_b64_tr_b16 v[72:73], v146
ds_read_b64_tr_b16 v[74:75], v146 offset:512
ds_read_b64_tr_b16 v[76:77], v146 offset:4096
ds_read_b64_tr_b16 v[78:79], v146 offset:4608
ds_read_b64_tr_b16 v[80:81], v146 offset:8192
ds_read_b64_tr_b16 v[82:83], v146 offset:8704
ds_read_b64_tr_b16 v[84:85], v146 offset:12288
ds_read_b64_tr_b16 v[86:87], v146 offset:12800
ds_read_b64_tr_b16 v[88:89], v146 offset:16384
ds_read_b64_tr_b16 v[90:91], v146 offset:16896
ds_read_b64_tr_b16 v[92:93], v146 offset:20480
ds_read_b64_tr_b16 v[94:95], v146 offset:20992
s_waitcnt lgkmcnt(10)
ds_write_b128 v147, v[72:75]
s_waitcnt lgkmcnt(9)
ds_write_b128 v147, v[76:79] offset:4096
s_waitcnt lgkmcnt(8)
ds_write_b128 v147, v[80:83] offset:8192
s_waitcnt lgkmcnt(7)
ds_write_b128 v147, v[84:87] offset:12288
s_waitcnt lgkmcnt(6)
ds_write_b128 v147, v[88:91] offset:16384
s_waitcnt lgkmcnt(5)
ds_write_b128 v147, v[92:95] offset:20480
s_waitcnt lgkmcnt(0)
s_setpc_b64 s[78:79]
Lw1i:
s_and_b32 s43, s40, 3
s_add_u32 s43, s43, 24
s_mul_i32 s44, s43, 43
s_lshr_b32 s44, s44, 8
s_lshl_b32 s45, s43, 10
s_add_u32 m0, s45, 16384
s_mul_i32 s46, s44, 6
s_sub_u32 s43, s43, s46
s_lshl_b32 s43, s43, 1
s_sub_u32 s45, s43, 5
s_cmp_ge_u32 s43, 6
s_cselect_b32 s43, s45, s43
s_mul_i32 s43, s43, 12288
s_lshl_b32 s44, s44, 6
s_add_u32 s43, s43, s44
buffer_load_dwordx4 v145, s[12:15], s43 offen lds
s_and_b32 s43, s40, 3
s_add_u32 s43, s43, 28
s_mul_i32 s44, s43, 43
s_lshr_b32 s44, s44, 8
s_lshl_b32 s45, s43, 10
s_add_u32 m0, s45, 16384
s_mul_i32 s46, s44, 6
s_sub_u32 s43, s43, s46
s_lshl_b32 s43, s43, 1
s_sub_u32 s45, s43, 5
s_cmp_ge_u32 s43, 6
s_cselect_b32 s43, s45, s43
s_mul_i32 s43, s43, 12288
s_lshl_b32 s44, s44, 6
s_add_u32 s43, s43, s44
buffer_load_dwordx4 v145, s[12:15], s43 offen lds
s_and_b32 s43, s40, 3
s_add_u32 s43, s43, 32
s_mul_i32 s44, s43, 43
s_lshr_b32 s44, s44, 8
s_lshl_b32 s45, s43, 10
s_add_u32 m0, s45, 16384
s_mul_i32 s46, s44, 6
s_sub_u32 s43, s43, s46
s_lshl_b32 s43, s43, 1
s_sub_u32 s45, s43, 5
s_cmp_ge_u32 s43, 6
s_cselect_b32 s43, s45, s43
s_mul_i32 s43, s43, 12288
s_lshl_b32 s44, s44, 6
s_add_u32 s43, s43, s44
buffer_load_dwordx4 v145, s[12:15], s43 offen lds
s_and_b32 s43, s40, 3
s_add_u32 s43, s43, 36
s_mul_i32 s44, s43, 43
s_lshr_b32 s44, s44, 8
s_lshl_b32 s45, s43, 10
s_add_u32 m0, s45, 16384
s_mul_i32 s46, s44, 6
s_sub_u32 s43, s43, s46
s_lshl_b32 s43, s43, 1
s_sub_u32 s45, s43, 5
s_cmp_ge_u32 s43, 6
s_cselect_b32 s43, s45, s43
s_mul_i32 s43, s43, 12288
s_lshl_b32 s44, s44, 6
s_add_u32 s43, s43, s44
buffer_load_dwordx4 v145, s[12:15], s43 offen lds
s_and_b32 s43, s40, 3
s_add_u32 s43, s43, 40
s_mul_i32 s44, s43, 43
s_lshr_b32 s44, s44, 8
s_lshl_b32 s45, s43, 10
s_add_u32 m0, s45, 16384
s_mul_i32 s46, s44, 6
s_sub_u32 s43, s43, s46
s_lshl_b32 s43, s43, 1
s_sub_u32 s45, s43, 5
s_cmp_ge_u32 s43, 6
s_cselect_b32 s43, s45, s43
s_mul_i32 s43, s43, 12288
s_lshl_b32 s44, s44, 6
s_add_u32 s43, s43, s44
buffer_load_dwordx4 v145, s[12:15], s43 offen lds
s_and_b32 s43, s40, 3
s_add_u32 s43, s43, 44
s_mul_i32 s44, s43, 43
s_lshr_b32 s44, s44, 8
s_lshl_b32 s45, s43, 10
s_add_u32 m0, s45, 16384
s_mul_i32 s46, s44, 6
s_sub_u32 s43, s43, s46
s_lshl_b32 s43, s43, 1
s_sub_u32 s45, s43, 5
s_cmp_ge_u32 s43, 6
s_cselect_b32 s43, s45, s43
s_mul_i32 s43, s43, 12288
s_lshl_b32 s44, s44, 6
s_add_u32 s43, s43, s44
buffer_load_dwordx4 v145, s[12:15], s43 offen lds
s_and_b32 s43, s40, 3
s_add_u32 s43, s43, 48
s_mul_i32 s44, s43, 43
s_lshr_b32 s44, s44, 8
s_lshl_b32 s45, s43, 10
s_add_u32 m0, s45, 16384
s_mul_i32 s46, s44, 6
s_sub_u32 s43, s43, s46
s_lshl_b32 s43, s43, 1
s_sub_u32 s45, s43, 5
s_cmp_ge_u32 s43, 6
s_cselect_b32 s43, s45, s43
s_mul_i32 s43, s43, 12288
s_lshl_b32 s44, s44, 6
s_add_u32 s43, s43, s44
buffer_load_dwordx4 v145, s[12:15], s43 offen lds
s_and_b32 s43, s40, 3
s_add_u32 s43, s43, 52
s_mul_i32 s44, s43, 43
s_lshr_b32 s44, s44, 8
s_lshl_b32 s45, s43, 10
s_add_u32 m0, s45, 16384
s_mul_i32 s46, s44, 6
s_sub_u32 s43, s43, s46
s_lshl_b32 s43, s43, 1
s_sub_u32 s45, s43, 5
s_cmp_ge_u32 s43, 6
s_cselect_b32 s43, s45, s43
s_mul_i32 s43, s43, 12288
s_lshl_b32 s44, s44, 6
s_add_u32 s43, s43, s44
buffer_load_dwordx4 v145, s[12:15], s43 offen lds
s_and_b32 s43, s40, 3
s_add_u32 s43, s43, 56
s_mul_i32 s44, s43, 43
s_lshr_b32 s44, s44, 8
s_lshl_b32 s45, s43, 10
s_add_u32 m0, s45, 16384
s_mul_i32 s46, s44, 6
s_sub_u32 s43, s43, s46
s_lshl_b32 s43, s43, 1
s_sub_u32 s45, s43, 5
s_cmp_ge_u32 s43, 6
s_cselect_b32 s43, s45, s43
s_mul_i32 s43, s43, 12288
s_lshl_b32 s44, s44, 6
s_add_u32 s43, s43, s44
buffer_load_dwordx4 v145, s[12:15], s43 offen lds
s_and_b32 s43, s40, 3
s_add_u32 s43, s43, 60
s_mul_i32 s44, s43, 43
s_lshr_b32 s44, s44, 8
s_lshl_b32 s45, s43, 10
s_add_u32 m0, s45, 16384
s_mul_i32 s46, s44, 6
s_sub_u32 s43, s43, s46
s_lshl_b32 s43, s43, 1
s_sub_u32 s45, s43, 5
s_cmp_ge_u32 s43, 6
s_cselect_b32 s43, s45, s43
s_mul_i32 s43, s43, 12288
s_lshl_b32 s44, s44, 6
s_add_u32 s43, s43, s44
buffer_load_dwordx4 v145, s[12:15], s43 offen lds
s_and_b32 s43, s40, 3
s_add_u32 s43, s43, 64
s_mul_i32 s44, s43, 43
s_lshr_b32 s44, s44, 8
s_lshl_b32 s45, s43, 10
s_add_u32 m0, s45, 16384
s_mul_i32 s46, s44, 6
s_sub_u32 s43, s43, s46
s_lshl_b32 s43, s43, 1
s_sub_u32 s45, s43, 5
s_cmp_ge_u32 s43, 6
s_cselect_b32 s43, s45, s43
s_mul_i32 s43, s43, 12288
s_lshl_b32 s44, s44, 6
s_add_u32 s43, s43, s44
buffer_load_dwordx4 v145, s[12:15], s43 offen lds
s_and_b32 s43, s40, 3
s_add_u32 s43, s43, 68
s_mul_i32 s44, s43, 43
s_lshr_b32 s44, s44, 8
s_lshl_b32 s45, s43, 10
s_add_u32 m0, s45, 16384
s_mul_i32 s46, s44, 6
s_sub_u32 s43, s43, s46
s_lshl_b32 s43, s43, 1
s_sub_u32 s45, s43, 5
s_cmp_ge_u32 s43, 6
s_cselect_b32 s43, s45, s43
s_mul_i32 s43, s43, 12288
s_lshl_b32 s44, s44, 6
s_add_u32 s43, s43, s44
buffer_load_dwordx4 v145, s[12:15], s43 offen lds
s_setpc_b64 s[78:79]
Lw1b:
s_waitcnt vmcnt(0)
v_add_u32 v148, 65536, v146
v_add_u32 v149, 65536, v147
ds_read_b64_tr_b16 v[72:73], v146 offset:24576
ds_read_b64_tr_b16 v[74:75], v146 offset:25088
ds_read_b64_tr_b16 v[76:77], v146 offset:28672
ds_read_b64_tr_b16 v[78:79], v146 offset:29184
ds_read_b64_tr_b16 v[80:81], v146 offset:32768
ds_read_b64_tr_b16 v[82:83], v146 offset:33280
ds_read_b64_tr_b16 v[84:85], v146 offset:36864
ds_read_b64_tr_b16 v[86:87], v146 offset:37376
ds_read_b64_tr_b16 v[88:89], v146 offset:40960
ds_read_b64_tr_b16 v[90:91], v146 offset:41472
ds_read_b64_tr_b16 v[92:93], v146 offset:45056
ds_read_b64_tr_b16 v[94:95], v146 offset:45568
ds_read_b64_tr_b16 v[96:97], v146 offset:49152
ds_read_b64_tr_b16 v[98:99], v146 offset:49664
ds_read_b64_tr_b16 v[100:101], v146 offset:53248
ds_read_b64_tr_b16 v[102:103], v146 offset:53760
ds_read_b64_tr_b16 v[104:105], v146 offset:57344
ds_read_b64_tr_b16 v[106:107], v146 offset:57856
ds_read_b64_tr_b16 v[108:109], v146 offset:61440
ds_read_b64_tr_b16 v[110:111], v146 offset:61952
ds_read_b64_tr_b16 v[112:113], v148
ds_read_b64_tr_b16 v[114:115], v148 offset:512
ds_read_b64_tr_b16 v[116:117], v148 offset:4096
ds_read_b64_tr_b16 v[118:119], v148 offset:4608
s_waitcnt lgkmcnt(15)
ds_write_b128 v147, v[72:75] offset:24576
ds_write_b128 v147, v[76:79] offset:28672
ds_write_b128 v147, v[80:83] offset:32768
ds_write_b128 v147, v[84:87] offset:36864
s_waitcnt lgkmcnt(15)
ds_write_b128 v147, v[88:91] offset:40960
ds_write_b128 v147, v[92:95] offset:45056
s_waitcnt lgkmcnt(15)
ds_write_b128 v147, v[96:99] offset:49152
s_waitcnt lgkmcnt(15)
ds_write_b128 v147, v[100:103] offset:53248
s_waitcnt lgkmcnt(14)
ds_write_b128 v147, v[104:107] offset:57344
s_waitcnt lgkmcnt(13)
ds_write_b128 v147, v[108:111] offset:61440
s_waitcnt lgkmcnt(12)
ds_write_b128 v149, v[112:115]
s_waitcnt lgkmcnt(11)
ds_write_b128 v149, v[116:119] offset:4096
s_waitcnt lgkmcnt(0)
s_setpc_b64 s[78:79]
Lmain:
s_cmp_ge_u32 s2, 256
s_cbranch_scc1 Lend
s_load_dwordx16 s[80:95], s[0:1], 0
s_load_dwordx2 s[96:97], s[0:1], 64
v_mov_b32 v199, v0
v_and_b32 v251, 63, v0
v_lshrrev_b32 v120, 6, v0
s_nop 0
v_readfirstlane_b32 s40, v120
s_and_b32 s43, s2, 7
s_lshr_b32 s44, s2, 3
s_and_b32 s41, s43, 3
s_lshl_b32 s41, s41, 2
s_and_b32 s45, s44, 3
s_add_u32 s41, s41, s45
s_lshr_b32 s42, s43, 2
s_lshl_b32 s42, s42, 3
s_lshr_b32 s45, s44, 2
s_add_u32 s42, s42, s45
s_lshl_b32 s41, s41, 5
s_lshl_b32 s42, s42, 5
s_lshl_b32 s67, s40, 6
s_cmp_eq_u32 s40, 6
s_cselect_b32 s67, 352, s67
v_add_u32_e64 v125, s67, v251
v_mul_u32_u24 v121, 5462, v125
v_lshrrev_b32 v121, 16, v121
v_mul_u32_u24 v122, 12, v121
v_sub_u32 v122, v125, v122
v_bfe_u32 v123, v121, 2, 2
v_xor_b32 v122, v122, v123
v_add_u32 v123, s41, v121
v_subrev_u32 v123, 1, v123
v_mul_u32_u24 v124, 192, v123
v_lshl_add_u32 v124, v122, 4, v124
v_mov_b32 v240, 2147483648
s_movk_i32 s43, 512
v_cmp_gt_u32 vcc, s43, v123
s_nop 1
v_cndmask_b32 v124, v240, v124, vcc
v_cmp_gt_u32 vcc, 34, v121
s_nop 1
v_cndmask_b32 v240, v240, v124, vcc
v_mov_b32 v128, v199
v_add_u32 v129, 512, v199
v_min_u32 v129, 863, v129
v_lshlrev_b32_e64 v130, 1, v128
v_lshlrev_b32 v131, 1, v129
s_mov_b32 s66, s42
s_add_u32 s43, s42, s40
s_add_u32 s43, s43, 1
s_lshl_b32 s43, s43, 9
s_add_u32 s43, s43, s41
s_mul_i32 s47, s43, 192
s_sub_u32 s47, s47, 256
s_lshl_b32 s67, s67, 4
s_add_u32 s67, s67, 90112
s_waitcnt lgkmcnt(0)
s_mov_b32 s4, s80
s_and_b32 s5, s81, 65535
s_mov_b32 s6, 50331648
s_mov_b32 s7, 131072
s_mov_b32 s20, s82
s_and_b32 s21, s83, 65535
s_mov_b32 s22, 1728
s_mov_b32 s23, 131072
buffer_load_ushort v126, v130, s[20:23], 0 offen
buffer_load_ushort v127, v131, s[20:23], 0 offen
s_cmp_eq_u32 s40, 7
s_cbranch_scc1 Lskipx0
s_add_i32 s43, s66, -1
s_mul_i32 s44, s43, 98304
s_cmp_lt_u32 s43, 512
s_cselect_b32 s45, s44, 1073741824
s_add_u32 m0, s67, 0
s_nop 0
buffer_load_dwordx4 v240, s[4:7], s45 offen nt lds
s_add_i32 s43, s66, 0
s_mul_i32 s44, s43, 98304
s_cmp_lt_u32 s43, 512
s_cselect_b32 s45, s44, 1073741824
s_add_u32 m0, s67, 6656
s_nop 0
buffer_load_dwordx4 v240, s[4:7], s45 offen nt lds
s_add_i32 s43, s66, 1
s_mul_i32 s44, s43, 98304
s_cmp_lt_u32 s43, 512
s_cselect_b32 s45, s44, 1073741824
s_add_u32 m0, s67, 13312
s_nop 0
buffer_load_dwordx4 v240, s[4:7], s45 offen nt lds
s_add_i32 s43, s66, 2
s_mul_i32 s44, s43, 98304
s_cmp_lt_u32 s43, 512
s_cselect_b32 s45, s44, 1073741824
s_add_u32 m0, s67, 19968
s_nop 0
buffer_load_dwordx4 v240, s[4:7], s45 offen nt lds
s_add_i32 s43, s66, 3
s_mul_i32 s44, s43, 98304
s_cmp_lt_u32 s43, 512
s_cselect_b32 s45, s44, 1073741824
s_add_u32 m0, s67, 26624
s_nop 0
buffer_load_dwordx4 v240, s[4:7], s45 offen nt lds
s_add_i32 s43, s66, 4
s_mul_i32 s44, s43, 98304
s_cmp_lt_u32 s43, 512
s_cselect_b32 s45, s44, 1073741824
s_add_u32 m0, s67, 33280
s_nop 0
buffer_load_dwordx4 v240, s[4:7], s45 offen nt lds
Lskipx0:
s_mov_b32 s12, s84
s_and_b32 s13, s85, 65535
s_mov_b32 s14, 73728
s_mov_b32 s15, 131072
v_lshrrev_b32_e64 v145, 2, v251
v_mul_u32_u24 v145, 768, v145
v_and_b32_e64 v125, 3, v251
v_lshl_add_u32 v145, v125, 4, v145
s_mov_b32 s16, s86
s_and_b32 s17, s87, 65535
s_mov_b32 s18, 73728
s_mov_b32 s19, 131072
s_mov_b32 s24, s88
s_and_b32 s25, s89, 65535
s_mov_b32 s26, 768
s_mov_b32 s27, 131072
s_mov_b32 s28, s90
s_and_b32 s29, s91, 65535
s_mov_b32 s30, 768
s_mov_b32 s31, 131072
s_mov_b32 s8, s92
s_and_b32 s9, s93, 65535
s_mov_b32 s10, 50331648
s_mov_b32 s11, 131072
s_mov_b32 s36, s94
s_and_b32 s37, s95, 65535
s_mov_b32 s38, 256
s_mov_b32 s39, 131072
s_mov_b32 s32, s96
s_and_b32 s33, s97, 65535
s_mov_b32 s34, 83886080
s_mov_b32 s35, 131072
v_lshlrev_b32_e64 v24, 6, v199
s_mov_b32 s43, 1065362610
v_mov_b32 v25, 1084047360
v_add_u32 v0, 32772, v24
v_add_u32 v1, 32780, v24
v_add_u32 v2, 32788, v24
v_add_u32 v3, 32796, v24
v_add_u32 v4, 32804, v24
v_add_u32 v5, 32812, v24
v_add_u32 v6, 32820, v24
v_add_u32 v7, 32828, v24
v_cvt_f32_f16 v0, v0
v_cvt_f32_f16 v1, v1
v_cvt_f32_f16 v2, v2
v_cvt_f32_f16 v3, v3
v_cvt_f32_f16 v4, v4
v_cvt_f32_f16 v5, v5
v_cvt_f32_f16 v6, v6
v_cvt_f32_f16 v7, v7
v_mul_f32 v8, v0, v0
v_mul_f32 v9, v1, v1
v_mul_f32 v10, v2, v2
v_mul_f32 v11, v3, v3
v_mul_f32 v12, v4, v4
v_mul_f32 v13, v5, v5
v_mul_f32 v14, v6, v6
v_mul_f32 v15, v7, v7
v_fma_f32 v8, v8, s43, v25
v_fma_f32 v9, v9, s43, v25
v_fma_f32 v10, v10, s43, v25
v_fma_f32 v11, v11, s43, v25
v_fma_f32 v12, v12, s43, v25
v_fma_f32 v13, v13, s43, v25
v_fma_f32 v14, v14, s43, v25
v_fma_f32 v15, v15, s43, v25
v_mul_f32 v8, v0, v8
v_mul_f32 v9, v1, v9
v_mul_f32 v10, v2, v10
v_mul_f32 v11, v3, v11
v_mul_f32 v12, v4, v12
v_mul_f32 v13, v5, v13
v_mul_f32 v14, v6, v14
v_mul_f32 v15, v7, v15
v_exp_f32 v8, v8
v_exp_f32 v9, v9
v_exp_f32 v10, v10
v_exp_f32 v11, v11
v_exp_f32 v12, v12
v_exp_f32 v13, v13
v_exp_f32 v14, v14
v_exp_f32 v15, v15
v_add_f32 v16, 1.0, v8
v_add_f32 v17, 1.0, v9
v_add_f32 v18, 1.0, v10
v_add_f32 v19, 1.0, v11
v_add_f32 v20, 1.0, v12
v_add_f32 v21, 1.0, v13
v_add_f32 v22, 1.0, v14
v_add_f32 v23, 1.0, v15
v_rcp_f32 v16, v16
v_rcp_f32 v17, v17
v_rcp_f32 v18, v18
v_rcp_f32 v19, v19
v_rcp_f32 v20, v20
v_rcp_f32 v21, v21
v_rcp_f32 v22, v22
v_rcp_f32 v23, v23
v_mul_f32 v0, v0, v16
v_mul_f32 v1, v1, v17
v_mul_f32 v2, v2, v18
v_mul_f32 v3, v3, v19
v_mul_f32 v4, v4, v20
v_mul_f32 v5, v5, v21
v_mul_f32 v6, v6, v22
v_mul_f32 v7, v7, v23
v_mul_f32 v8, v8, v0
v_mul_f32 v9, v9, v1
v_mul_f32 v10, v10, v2
v_mul_f32 v11, v11, v3
v_mul_f32 v12, v12, v4
v_mul_f32 v13, v13, v5
v_mul_f32 v14, v14, v6
v_mul_f32 v15, v15, v7
v_cvt_pk_f16_f32 v28, v0, v1
v_cvt_pk_f16_f32 v32, -v8, -v9
v_cvt_pk_f16_f32 v29, v2, v3
v_cvt_pk_f16_f32 v33, -v10, -v11
v_cvt_pk_f16_f32 v30, v4, v5
v_cvt_pk_f16_f32 v34, -v12, -v13
v_cvt_pk_f16_f32 v31, v6, v7
v_cvt_pk_f16_f32 v35, -v14, -v15
v_lshlrev_b32_e64 v24, 4, v199
v_mov_b32 v25, 163840
s_movk_i32 s43, 496
v_cmp_gt_u32 vcc, s43, v199
s_nop 1
v_cndmask_b32 v24, v25, v24, vcc
ds_write_b128 v24, v[32:35]
ds_write_b128 v24, v[28:31] offset:8192
s_and_b32 s43, s40, 1
s_lshl_b32 s46, s43, 4
s_add_u32 s41, s41, s46
s_and_b32 s43, s40, 6
s_add_u32 s42, s42, s43
s_mul_i32 s45, s43, 6656
s_add_u32 s45, s45, 90112
v_and_b32 v131, 15, v251
v_lshrrev_b32_e64 v132, 4, v251
v_mul_u32_u24 v122, 6656, v132
v_add_u32 v122, s45, v122
v_add_u32 v121, s46, v131
v_mul_u32_u24 v123, 192, v121
v_bfe_u32 v124, v121, 2, 2
v_lshl_add_u32 v123, v124, 4, v123
v_add_u32 v242, v122, v123
v_add_u32 v121, 1, v121
v_mul_u32_u24 v123, 192, v121
v_bfe_u32 v124, v121, 2, 2
v_lshl_add_u32 v123, v124, 4, v123
v_add_u32 v243, v122, v123
v_add_u32 v121, 1, v121
v_mul_u32_u24 v123, 192, v121
v_bfe_u32 v124, v121, 2, 2
v_lshl_add_u32 v123, v124, 4, v123
v_add_u32_e64 v244, v122, v123
s_mul_i32 s72, s40, 9216
s_add_u32 s72, s72, 90112
v_mov_b32 v160, 0
v_mov_b32 v161, 0
v_mov_b32 v162, 0
v_mov_b32 v163, 0
v_mov_b32 v140, 16256
ds_write_b128 v140, v[160:163]
v_bfe_u32 v133, v131, 2, 1
v_sub_u32 v133, v132, v133
v_lshrrev_b32 v134, 3, v131
v_and_b32_e64 v135, 3, v131
v_lshl_add_u32 v135, v134, 2, v135
v_lshlrev_b32_e64 v136, 6, v133
v_lshl_add_u32 v136, v135, 3, v136
v_add_u32 v136, 156672, v136
v_mov_b32 v137, 163840
v_cmp_gt_u32 vcc, 3, v133
s_nop 1
v_cndmask_b32 v136, v137, v136, vcc
v_cmp_eq_u32 vcc, 0, v134
s_nop 1
v_cndmask_b32 v245, v137, v136, vcc
v_cndmask_b32 v246, v136, v137, vcc
v_lshlrev_b32 v241, 4, v251
v_and_b32_e64 v133, 35, v251
v_bfe_u32 v134, v251, 2, 2
v_lshl_add_u32 v133, v134, 3, v133
v_bfe_u32 v134, v251, 4, 1
v_lshl_add_u32 v133, v134, 2, v133
v_lshlrev_b32_e64 v248, 4, v133
v_add_u32 v249, 65536, v248
v_add_u32 v250, 131072, v248
s_lshl_b32 s73, s2, 3
s_add_u32 s73, s73, s40
s_lshl_b32 s80, s73, 10
s_add_u32 s80, s80, 4194304
s_mul_i32 s73, s73, 16
s_add_u32 s73, s73, 1048576
s_mul_i32 s46, s41, 192
s_add_u32 s43, s42, 0
s_mul_i32 s43, s43, 98304
s_add_u32 s68, s43, s46
s_add_u32 s43, s42, 8
s_mul_i32 s43, s43, 98304
s_add_u32 s69, s43, s46
s_add_u32 s43, s42, 16
s_mul_i32 s43, s43, 98304
s_add_u32 s70, s43, s46
s_add_u32 s43, s42, 24
s_mul_i32 s43, s43, 98304
s_add_u32 s71, s43, s46
s_mul_i32 s82, s40, 9216
s_mov_b32 s48, 1156203754
s_mov_b32 s49, 4294508536
s_mov_b32 s76, 400000
v_lshrrev_b32 v148, 5, v251
v_lshlrev_b32 v146, 8, v148
v_bfe_u32 v148, v251, 2, 2
v_lshl_add_u32 v146, v148, 6, v146
v_bfe_u32 v148, v251, 4, 1
v_lshl_add_u32 v146, v148, 5, v146
v_bfe_u32 v148, v251, 0, 1
v_lshl_add_u32 v146, v148, 4, v146
v_bfe_u32 v148, v251, 1, 1
v_lshl_add_u32 v146, v148, 3, v146
s_and_b32 s43, s40, 3
s_lshl_b32 s43, s43, 10
s_add_u32 s43, s43, 16384
v_add_u32 v146, s43, v146
v_add_u32 v147, s43, v248
v_mul_u32_u24 v140, 683, v128
v_lshrrev_b32_e64 v140, 16, v140
v_mul_u32_u24 v141, 96, v140
v_sub_u32 v141, v128, v141
v_mul_u32_u24 v142, 11, v140
v_lshrrev_b32 v142, 5, v142
v_mul_u32_u24 v143, 3, v142
v_sub_u32 v143, v140, v143
v_mul_u32_u24 v143, 12, v143
v_lshrrev_b32 v144, 3, v141
v_add_u32 v143, v143, v144
v_mul_u32_u24 v143, 192, v143
v_lshl_add_u32 v143, v142, 6, v143
v_and_b32_e64 v144, 7, v141
v_lshl_add_u32 v143, v144, 3, v143
v_add_u32 v150, 156672, v143
v_mul_u32_u24 v140, 683, v129
v_lshrrev_b32_e64 v140, 16, v140
v_mul_u32_u24 v141, 96, v140
v_sub_u32 v141, v129, v141
v_mul_u32_u24 v142, 11, v140
v_lshrrev_b32 v142, 5, v142
v_mul_u32_u24 v143, 3, v142
v_sub_u32 v143, v140, v143
v_mul_u32_u24 v143, 12, v143
v_lshrrev_b32 v144, 3, v141
v_add_u32 v143, v143, v144
v_mul_u32_u24 v143, 192, v143
v_lshl_add_u32 v143, v142, 6, v143
v_and_b32_e64 v144, 7, v141
v_lshl_add_u32 v143, v144, 3, v143
v_add_u32 v151, 156672, v143
s_waitcnt vmcnt(6)
s_cmp_lg_u32 s40, 7
s_cbranch_scc1 Lw7w
s_waitcnt vmcnt(0)
Lw7w:
v_and_b32 v130, 1, v128
v_lshlrev_b32 v130, 4, v130
v_lshlrev_b32 v126, v130, v126
v_and_b32 v130, 2, v128
v_cmp_eq_u32 vcc, 0, v130
s_nop 1
v_cndmask_b32 v160, 0, v126, vcc
v_sub_u32 v161, v126, v160
ds_write_b64 v150, v[160:161]
v_and_b32 v130, 1, v129
v_lshlrev_b32 v130, 4, v130
v_lshlrev_b32 v127, v130, v127
v_and_b32 v130, 2, v129
v_cmp_eq_u32 vcc, 0, v130
s_nop 1
v_cndmask_b32 v162, 0, v127, vcc
v_sub_u32 v163, v127, v162
ds_write_b64 v151, v[162:163]
s_cmp_lt_u32 s40, 4
s_cbranch_scc1 Lnow1a
s_and_b32 s43, s40, 3
s_add_u32 s43, s43, 0
s_mul_i32 s44, s43, 43
s_lshr_b32 s44, s44, 8
s_lshl_b32 s45, s43, 10
s_add_u32 m0, s45, 16384
s_mul_i32 s46, s44, 6
s_sub_u32 s43, s43, s46
s_lshl_b32 s43, s43, 1
s_sub_u32 s45, s43, 5
s_cmp_ge_u32 s43, 6
s_cselect_b32 s43, s45, s43
s_mul_i32 s43, s43, 12288
s_lshl_b32 s44, s44, 6
s_add_u32 s43, s43, s44
buffer_load_dwordx4 v145, s[12:15], s43 offen lds
s_and_b32 s43, s40, 3
s_add_u32 s43, s43, 4
s_mul_i32 s44, s43, 43
s_lshr_b32 s44, s44, 8
s_lshl_b32 s45, s43, 10
s_add_u32 m0, s45, 16384
s_mul_i32 s46, s44, 6
s_sub_u32 s43, s43, s46
s_lshl_b32 s43, s43, 1
s_sub_u32 s45, s43, 5
s_cmp_ge_u32 s43, 6
s_cselect_b32 s43, s45, s43
s_mul_i32 s43, s43, 12288
s_lshl_b32 s44, s44, 6
s_add_u32 s43, s43, s44
buffer_load_dwordx4 v145, s[12:15], s43 offen lds
s_and_b32 s43, s40, 3
s_add_u32 s43, s43, 8
s_mul_i32 s44, s43, 43
s_lshr_b32 s44, s44, 8
s_lshl_b32 s45, s43, 10
s_add_u32 m0, s45, 16384
s_mul_i32 s46, s44, 6
s_sub_u32 s43, s43, s46
s_lshl_b32 s43, s43, 1
s_sub_u32 s45, s43, 5
s_cmp_ge_u32 s43, 6
s_cselect_b32 s43, s45, s43
s_mul_i32 s43, s43, 12288
s_lshl_b32 s44, s44, 6
s_add_u32 s43, s43, s44
buffer_load_dwordx4 v145, s[12:15], s43 offen lds
s_and_b32 s43, s40, 3
s_add_u32 s43, s43, 12
s_mul_i32 s44, s43, 43
s_lshr_b32 s44, s44, 8
s_lshl_b32 s45, s43, 10
s_add_u32 m0, s45, 16384
s_mul_i32 s46, s44, 6
s_sub_u32 s43, s43, s46
s_lshl_b32 s43, s43, 1
s_sub_u32 s45, s43, 5
s_cmp_ge_u32 s43, 6
s_cselect_b32 s43, s45, s43
s_mul_i32 s43, s43, 12288
s_lshl_b32 s44, s44, 6
s_add_u32 s43, s43, s44
buffer_load_dwordx4 v145, s[12:15], s43 offen lds
s_and_b32 s43, s40, 3
s_add_u32 s43, s43, 16
s_mul_i32 s44, s43, 43
s_lshr_b32 s44, s44, 8
s_lshl_b32 s45, s43, 10
s_add_u32 m0, s45, 16384
s_mul_i32 s46, s44, 6
s_sub_u32 s43, s43, s46
s_lshl_b32 s43, s43, 1
s_sub_u32 s45, s43, 5
s_cmp_ge_u32 s43, 6
s_cselect_b32 s43, s45, s43
s_mul_i32 s43, s43, 12288
s_lshl_b32 s44, s44, 6
s_add_u32 s43, s43, s44
buffer_load_dwordx4 v145, s[12:15], s43 offen lds
s_and_b32 s43, s40, 3
s_add_u32 s43, s43, 20
s_mul_i32 s44, s43, 43
s_lshr_b32 s44, s44, 8
s_lshl_b32 s45, s43, 10
s_add_u32 m0, s45, 16384
s_mul_i32 s46, s44, 6
s_sub_u32 s43, s43, s46
s_lshl_b32 s43, s43, 1
s_sub_u32 s45, s43, 5
s_cmp_ge_u32 s43, 6
s_cselect_b32 s43, s45, s43
s_mul_i32 s43, s43, 12288
s_lshl_b32 s44, s44, 6
s_add_u32 s43, s43, s44
buffer_load_dwordx4 v145, s[12:15], s43 offen lds
Lnow1a:
s_cmp_eq_u32 s40, 7
s_cbranch_scc1 Lskipx1
s_add_i32 s43, s66, 5
s_mul_i32 s44, s43, 98304
s_cmp_lt_u32 s43, 512
s_cselect_b32 s45, s44, 1073741824
s_add_u32 m0, s67, 39936
s_nop 0
buffer_load_dwordx4 v240, s[4:7], s45 offen nt lds
s_add_i32 s43, s66, 6
s_mul_i32 s44, s43, 98304
s_cmp_lt_u32 s43, 512
s_cselect_b32 s45, s44, 1073741824
s_add_u32 m0, s67, 46592
s_nop 0
buffer_load_dwordx4 v240, s[4:7], s45 offen nt lds
s_add_i32 s43, s66, 7
s_mul_i32 s44, s43, 98304
s_cmp_lt_u32 s43, 512
s_cselect_b32 s45, s44, 1073741824
s_add_u32 m0, s67, 53248
s_nop 0
buffer_load_dwordx4 v240, s[4:7], s45 offen nt lds
s_add_i32 s43, s66, 8
s_mul_i32 s44, s43, 98304
s_cmp_lt_u32 s43, 512
s_cselect_b32 s45, s44, 1073741824
s_add_u32 m0, s67, 59904
s_nop 0
buffer_load_dwordx4 v240, s[4:7], s45 offen nt lds
Lskipx1:
s_waitcnt vmcnt(10) lgkmcnt(0)
s_cmp_ge_u32 s40, 4
s_cbranch_scc1 Lwa
s_waitcnt vmcnt(4)
Lwa:
s_barrier
s_setprio 2
s_cmp_lt_u32 s40, 4
s_cbranch_scc0 Lsu0
s_call_b64 s[78:79], Lconv0
s_call_b64 s[78:79], Lln0
s_waitcnt vmcnt(0)
Lsu0:
s_cmp_ge_u32 s40, 4
s_cbranch_scc0 Lsu1
s_call_b64 s[78:79], Lw1a
s_call_b64 s[78:79], Lw1i
Lsu1:
s_barrier
s_cmp_ge_u32 s40, 4
s_cbranch_scc0 Lsu2
s_setprio 3
s_call_b64 s[78:79], Lconv0
s_barrier
s_call_b64 s[78:79], Lw1b
s_barrier
s_call_b64 s[78:79], Lln0
Lsu2:
s_cmp_lg_u32 s40, 7
s_cbranch_scc1 Lnopf
s_getpc_b64 s[74:75]
Lpc:
s_lshr_b32 s43, s2, 3
s_and_b32 s43, s43, 15
s_lshl_b32 s43, s43, 13
v_lshlrev_b32 v176, 7, v251
v_add_u32 v176, s43, v176
v_min_u32 v176, Lend-Lpc, v176
global_load_dword v255, v176, s[74:75]
Lnopf:
s_add_u32 s66, s66, 8
s_mul_i32 s66, s66, 98304
s_cmp_eq_u32 s40, 7
s_cselect_b32 s67, 163840, s67
ds_read_b128 v[224:227], v248 offset:16384
ds_read_b128 v[228:231], v248 offset:19456
ds_read_b128 v[232:235], v248 offset:17408
ds_read_b128 v[236:239], v248 offset:20480
ds_read_b128 v[216:219], v248 offset:18432
ds_read_b128 v[220:223], v248 offset:21504
s_setprio 2
s_waitcnt lgkmcnt(5)
v_mfma_f32_32x32x16_bf16 v[120:135], v[48:51], v[224:227], 0
s_waitcnt lgkmcnt(4)
ds_read_b128 v[224:227], v248 offset:22528
v_mfma_f32_32x32x16_bf16 v[120:135], v[52:55], v[228:231], v[120:135]
s_waitcnt lgkmcnt(4)
ds_read_b128 v[228:231], v248 offset:25600
v_mfma_f32_32x32x16_bf16 v[120:135], v[56:59], v[232:235], v[120:135]
s_waitcnt lgkmcnt(4)
ds_read_b128 v[232:235], v248 offset:23552
v_mfma_f32_32x32x16_bf16 v[120:135], v[60:63], v[236:239], v[120:135]
s_waitcnt lgkmcnt(4)
ds_read_b128 v[236:239], v248 offset:26624
v_mfma_f32_32x32x16_bf16 v[120:135], v[64:67], v[216:219], v[120:135]
s_waitcnt lgkmcnt(4)
ds_read_b128 v[216:219], v248 offset:24576
v_mfma_f32_32x32x16_bf16 v[120:135], v[68:71], v[220:223], v[120:135]
s_nop 11
v_cvt_pkrtz_f16_f32 v137, v120, v121
v_cvt_pkrtz_f16_f32 v139, v122, v123
v_cvt_pkrtz_f16_f32 v141, v124, v125
v_cvt_pkrtz_f16_f32 v143, v126, v127
v_cvt_pkrtz_f16_f32 v145, v128, v129
v_cvt_pk_f16_f32 v155, v130, v131
v_cvt_pk_f16_f32 v152, v132, v133
v_cvt_pk_f16_f32 v149, v134, v135
s_waitcnt lgkmcnt(1)
ds_read_b128 v[220:223], v248 offset:27648
v_mfma_f32_32x32x16_bf16 v[120:135], v[48:51], v[224:227], 0
v_pk_fma_f16 v154, v155, v155, s48
v_and_b32 v137, s49, v137
v_pk_fma_f16 v151, v152, v152, s48
v_and_b32_e64 v139, s49, v139
v_pk_fma_f16 v148, v149, v149, s48
v_pk_mul_f16 v154, v155, v154
v_bfe_u32 v136, v137, 2, 14
v_pk_mul_f16 v151, v152, v151
v_pk_mul_f16 v148, v149, v148
v_bfe_u32 v138, v139, 2, 14
ds_read_b128 v[224:227], v248 offset:28672
ds_read_u16_d16 v136, v136
ds_read_u16_d16 v138, v138
v_mfma_f32_32x32x16_bf16 v[120:135], v[52:55], v[228:231], v[120:135]
v_exp_f16 v153, v154
v_lshrrev_b32 v137, 18, v137
v_exp_f16 v150, v151
v_lshrrev_b32 v139, 18, v139
v_exp_f16 v147, v148
v_and_b32 v141, s49, v141
v_and_b32_e64 v143, s49, v143
ds_read_b128 v[228:231], v248 offset:31744
ds_read_u16_d16_hi v137, v137
ds_read_u16_d16_hi v139, v139
v_mfma_f32_32x32x16_bf16 v[120:135], v[56:59], v[232:235], v[120:135]
v_exp_f16_sdwa v153, v154 dst_sel:WORD_1 dst_unused:UNUSED_PRESERVE src0_sel:WORD_1
v_bfe_u32 v140, v141, 2, 14
v_exp_f16_sdwa v150, v151 dst_sel:WORD_1 dst_unused:UNUSED_PRESERVE src0_sel:WORD_1
v_bfe_u32 v142, v143, 2, 14
v_exp_f16_sdwa v147, v148 dst_sel:WORD_1 dst_unused:UNUSED_PRESERVE src0_sel:WORD_1
v_lshrrev_b32_e64 v141, 18, v141
v_pk_add_f16 v153, v153, 1.0 op_sel_hi:[1,0]
ds_read_b128 v[232:235], v248 offset:29696
ds_read_u16_d16 v140, v140
ds_read_u16_d16 v142, v142
ds_read_u16_d16_hi v141, v141
v_mfma_f32_32x32x16_bf16 v[120:135], v[60:63], v[236:239], v[120:135]
v_lshrrev_b32_e64 v143, 18, v143
v_pk_add_f16 v150, v150, 1.0 op_sel_hi:[1,0]
v_pk_add_f16 v147, v147, 1.0 op_sel_hi:[1,0]
v_and_b32 v145, s49, v145
v_rcp_f16 v154, v153
v_bfe_u32 v144, v145, 2, 14
v_rcp_f16_e64 v151, v150
v_lshrrev_b32 v145, 18, v145
s_waitcnt lgkmcnt(7)
ds_read_b128 v[236:239], v248 offset:32768
ds_read_u16_d16_hi v143, v143
ds_read_u16_d16 v144, v144
ds_read_u16_d16_hi v145, v145
v_mfma_f32_32x32x16_bf16 v[120:135], v[64:67], v[216:219], v[120:135]
v_rcp_f16 v148, v147
v_rcp_f16_sdwa v154, v153 dst_sel:WORD_1 dst_unused:UNUSED_PRESERVE src0_sel:WORD_1
v_fma_mix_f32 v156, v136, v136, 0 op_sel:[0,0,0] op_sel_hi:[1,1,0]
s_waitcnt lgkmcnt(8)
v_fma_mix_f32 v156, v137, v137, v156 op_sel:[1,1,0] op_sel_hi:[1,1,0]
v_rcp_f16_sdwa v151, v150 dst_sel:WORD_1 dst_unused:UNUSED_PRESERVE src0_sel:WORD_1
v_fma_mix_f32 v156, v138, v138, v156 op_sel:[0,0,0] op_sel_hi:[1,1,0]
ds_read_b128 v[216:219], v248 offset:30720
v_mfma_f32_32x32x16_bf16 v[120:135], v[68:71], v[220:223], v[120:135]
v_rcp_f16_sdwa v148, v147 dst_sel:WORD_1 dst_unused:UNUSED_PRESERVE src0_sel:WORD_1
v_fma_mix_f32 v156, v139, v139, v156 op_sel:[1,1,0] op_sel_hi:[1,1,0]
v_pk_mul_f16 v155, v155, v154
s_waitcnt lgkmcnt(5)
v_fma_mix_f32 v156, v140, v140, v156 op_sel:[0,0,0] op_sel_hi:[1,1,0]
v_pk_mul_f16 v152, v152, v151
v_fma_mix_f32 v156, v141, v141, v156 op_sel:[1,1,0] op_sel_hi:[1,1,0]
v_pk_mul_f16 v149, v149, v148
v_fma_mix_f32 v156, v155, v155, v156 op_sel:[0,0,0] op_sel_hi:[1,1,0]
v_fma_mix_f32 v156, v142, v142, v156 op_sel:[0,0,0] op_sel_hi:[1,1,0]
v_fma_mix_f32 v156, v155, v155, v156 op_sel:[1,1,0] op_sel_hi:[1,1,0]
s_waitcnt lgkmcnt(3)
v_fma_mix_f32 v156, v143, v143, v156 op_sel:[1,1,0] op_sel_hi:[1,1,0]
v_fma_mix_f32 v156, v152, v152, v156 op_sel:[0,0,0] op_sel_hi:[1,1,0]
v_fma_mix_f32 v156, v152, v152, v156 op_sel:[1,1,0] op_sel_hi:[1,1,0]
s_waitcnt lgkmcnt(1)
v_fma_mix_f32 v156, v144, v144, v156 op_sel:[0,0,0] op_sel_hi:[1,1,0]
v_fma_mix_f32 v156, v149, v149, v156 op_sel:[0,0,0] op_sel_hi:[1,1,0]
v_fma_mix_f32 v156, v145, v145, v156 op_sel:[1,1,0] op_sel_hi:[1,1,0]
v_fma_mix_f32 v156, v149, v149, v156 op_sel:[1,1,0] op_sel_hi:[1,1,0]
s_cmp_lt_u32 s40, 4
s_cbranch_scc0 Lsu3
s_barrier
Lsu3:
v_add_u32 v247, -36864, v242
v_subrev_u32 v252, 66560, v247
v_min_u32_e64 v247, v247, v252
v_add_u32 v247, 90112, v247
v_sub_u32 v252, v247, v242
v_add_u32 v242, v252, v242
v_add_u32 v243, v252, v243
v_add_u32 v244, v252, v244
v_cvt_pkrtz_f16_f32 v137, v120, v121
v_cvt_pkrtz_f16_f32 v139, v122, v123
v_cvt_pkrtz_f16_f32 v141, v124, v125
v_cvt_pkrtz_f16_f32 v143, v126, v127
v_cvt_pkrtz_f16_f32 v145, v128, v129
v_cvt_pk_f16_f32 v155, v130, v131
v_cvt_pk_f16_f32 v152, v132, v133
v_cvt_pk_f16_f32 v149, v134, v135
s_add_u32 m0, s67, 0
s_add_u32 s66, s66, 98304
buffer_load_dwordx4 v240, s[4:7], s66 offen lds
ds_read_b128 v[220:223], v248 offset:33792
v_mfma_f32_32x32x16_bf16 v[120:135], v[48:51], v[224:227], 0
v_pk_fma_f16 v154, v155, v155, s48
v_and_b32 v137, s49, v137
v_pk_fma_f16 v151, v152, v152, s48
v_and_b32_e64 v139, s49, v139
v_pk_fma_f16 v148, v149, v149, s48
v_pk_mul_f16 v154, v155, v154
v_bfe_u32 v136, v137, 2, 14
v_pk_mul_f16 v151, v152, v151
v_pk_mul_f16 v148, v149, v148
v_bfe_u32 v138, v139, 2, 14
ds_read_b128 v[224:227], v248 offset:34816
ds_read_u16_d16 v136, v136
ds_read_u16_d16 v138, v138
v_mfma_f32_32x32x16_bf16 v[120:135], v[52:55], v[228:231], v[120:135]
v_exp_f16 v153, v154
v_lshrrev_b32 v137, 18, v137
v_exp_f16 v150, v151
v_lshrrev_b32 v139, 18, v139
v_exp_f16 v147, v148
v_and_b32 v141, s49, v141
v_and_b32_e64 v143, s49, v143
s_add_u32 m0, s67, 6656
s_add_u32 s66, s66, 98304
buffer_load_dwordx4 v240, s[4:7], s66 offen lds
ds_read_b128 v[228:231], v248 offset:37888
ds_read_u16_d16_hi v137, v137
ds_read_u16_d16_hi v139, v139
v_mfma_f32_32x32x16_bf16 v[120:135], v[56:59], v[232:235], v[120:135]
v_exp_f16_sdwa v153, v154 dst_sel:WORD_1 dst_unused:UNUSED_PRESERVE src0_sel:WORD_1
v_bfe_u32 v140, v141, 2, 14
v_exp_f16_sdwa v150, v151 dst_sel:WORD_1 dst_unused:UNUSED_PRESERVE src0_sel:WORD_1
v_bfe_u32 v142, v143, 2, 14
v_exp_f16_sdwa v147, v148 dst_sel:WORD_1 dst_unused:UNUSED_PRESERVE src0_sel:WORD_1
v_lshrrev_b32_e64 v141, 18, v141
v_pk_add_f16 v153, v153, 1.0 op_sel_hi:[1,0]
s_add_u32 m0, s67, 13312
s_add_u32 s66, s66, 98304
buffer_load_dwordx4 v240, s[4:7], s66 offen lds
ds_read_b128 v[232:235], v248 offset:35840
ds_read_u16_d16 v140, v140
ds_read_u16_d16 v142, v142
ds_read_u16_d16_hi v141, v141
v_mfma_f32_32x32x16_bf16 v[120:135], v[60:63], v[236:239], v[120:135]
v_lshrrev_b32_e64 v143, 18, v143
v_pk_add_f16 v150, v150, 1.0 op_sel_hi:[1,0]
v_pk_add_f16 v147, v147, 1.0 op_sel_hi:[1,0]
v_and_b32 v145, s49, v145
v_rcp_f16 v154, v153
v_bfe_u32 v144, v145, 2, 14
v_rcp_f16_e64 v151, v150
v_lshrrev_b32 v145, 18, v145
s_waitcnt lgkmcnt(4)
ds_read_b128 v[236:239], v248 offset:38912
ds_read_u16_d16_hi v143, v143
ds_read_u16_d16 v144, v144
ds_read_u16_d16_hi v145, v145
v_mfma_f32_32x32x16_bf16 v[120:135], v[64:67], v[216:219], v[120:135]
v_rcp_f16_e64 v148, v147
v_rcp_f16_sdwa v154, v153 dst_sel:WORD_1 dst_unused:UNUSED_PRESERVE src0_sel:WORD_1
v_fma_mix_f32 v157, v136, v136, 0 op_sel:[0,0,0] op_sel_hi:[1,1,0]
v_fma_mix_f32 v157, v137, v137, v157 op_sel:[1,1,0] op_sel_hi:[1,1,0]
v_rcp_f16_sdwa v151, v150 dst_sel:WORD_1 dst_unused:UNUSED_PRESERVE src0_sel:WORD_1
v_fma_mix_f32 v157, v138, v138, v157 op_sel:[0,0,0] op_sel_hi:[1,1,0]
s_setprio 1
s_add_u32 m0, s67, 19968
s_add_u32 s66, s66, 98304
buffer_load_dwordx4 v240, s[4:7], s66 offen lds
ds_read_b128 v[216:219], v248 offset:36864
v_mfma_f32_32x32x16_bf16 v[120:135], v[68:71], v[220:223], v[120:135]
v_rcp_f16_sdwa v148, v147 dst_sel:WORD_1 dst_unused:UNUSED_PRESERVE src0_sel:WORD_1
v_fma_mix_f32 v157, v139, v139, v157 op_sel:[1,1,0] op_sel_hi:[1,1,0]
v_pk_mul_f16 v155, v155, v154
s_waitcnt lgkmcnt(5)
v_fma_mix_f32 v157, v140, v140, v157 op_sel:[0,0,0] op_sel_hi:[1,1,0]
v_pk_mul_f16 v152, v152, v151
v_fma_mix_f32 v157, v141, v141, v157 op_sel:[1,1,0] op_sel_hi:[1,1,0]
v_pk_mul_f16 v149, v149, v148
v_fma_mix_f32 v157, v155, v155, v157 op_sel:[0,0,0] op_sel_hi:[1,1,0]
v_fma_mix_f32 v157, v142, v142, v157 op_sel:[0,0,0] op_sel_hi:[1,1,0]
v_fma_mix_f32 v157, v155, v155, v157 op_sel:[1,1,0] op_sel_hi:[1,1,0]
s_waitcnt lgkmcnt(1)
v_fma_mix_f32 v157, v143, v143, v157 op_sel:[1,1,0] op_sel_hi:[1,1,0]
v_fma_mix_f32 v157, v152, v152, v157 op_sel:[0,0,0] op_sel_hi:[1,1,0]
v_fma_mix_f32 v157, v152, v152, v157 op_sel:[1,1,0] op_sel_hi:[1,1,0]
v_fma_mix_f32 v157, v144, v144, v157 op_sel:[0,0,0] op_sel_hi:[1,1,0]
v_fma_mix_f32 v157, v149, v149, v157 op_sel:[0,0,0] op_sel_hi:[1,1,0]
v_fma_mix_f32 v157, v145, v145, v157 op_sel:[1,1,0] op_sel_hi:[1,1,0]
v_fma_mix_f32 v157, v149, v149, v157 op_sel:[1,1,0] op_sel_hi:[1,1,0]
s_cmp_lt_u32 s40, 4
s_cbranch_scc0 Lsu4
s_barrier
Lsu4:
v_cvt_pkrtz_f16_f32 v137, v120, v121
v_cvt_pkrtz_f16_f32 v139, v122, v123
v_cvt_pkrtz_f16_f32 v141, v124, v125
v_cvt_pkrtz_f16_f32 v143, v126, v127
v_cvt_pkrtz_f16_f32 v145, v128, v129
v_cvt_pk_f16_f32 v155, v130, v131
v_cvt_pk_f16_f32 v152, v132, v133
v_cvt_pk_f16_f32 v149, v134, v135
s_add_u32 m0, s67, 26624
s_add_u32 s66, s66, 98304
buffer_load_dwordx4 v240, s[4:7], s66 offen lds
ds_read_b128 v[220:223], v248 offset:39936
v_mfma_f32_32x32x16_bf16 v[120:135], v[48:51], v[224:227], 0
v_pk_fma_f16 v154, v155, v155, s48
v_and_b32_e64 v137, s49, v137
v_pk_fma_f16 v151, v152, v152, s48
v_and_b32_e64 v139, s49, v139
v_pk_fma_f16 v148, v149, v149, s48
v_pk_mul_f16 v154, v155, v154
v_bfe_u32 v136, v137, 2, 14
v_pk_mul_f16 v151, v152, v151
v_pk_mul_f16 v148, v149, v148
v_bfe_u32 v138, v139, 2, 14
ds_read_b128 v[224:227], v248 offset:40960
ds_read_u16_d16 v136, v136
ds_read_u16_d16 v138, v138
v_mfma_f32_32x32x16_bf16 v[120:135], v[52:55], v[228:231], v[120:135]
v_exp_f16 v153, v154
v_lshrrev_b32 v137, 18, v137
v_exp_f16 v150, v151
v_lshrrev_b32 v139, 18, v139
v_exp_f16 v147, v148
v_and_b32 v141, s49, v141
v_and_b32_e64 v143, s49, v143
s_add_u32 m0, s67, 33280
s_add_u32 s66, s66, 98304
buffer_load_dwordx4 v240, s[4:7], s66 offen lds
ds_read_b128 v[228:231], v248 offset:44032
ds_read_u16_d16_hi v137, v137
ds_read_u16_d16_hi v139, v139
v_mfma_f32_32x32x16_bf16 v[120:135], v[56:59], v[232:235], v[120:135]
v_exp_f16_sdwa v153, v154 dst_sel:WORD_1 dst_unused:UNUSED_PRESERVE src0_sel:WORD_1
v_bfe_u32 v140, v141, 2, 14
v_exp_f16_sdwa v150, v151 dst_sel:WORD_1 dst_unused:UNUSED_PRESERVE src0_sel:WORD_1
v_bfe_u32 v142, v143, 2, 14
v_exp_f16_sdwa v147, v148 dst_sel:WORD_1 dst_unused:UNUSED_PRESERVE src0_sel:WORD_1
v_lshrrev_b32_e64 v141, 18, v141
v_pk_add_f16 v153, v153, 1.0 op_sel_hi:[1,0]
s_add_u32 m0, s67, 39936
s_add_u32 s66, s66, 98304
buffer_load_dwordx4 v240, s[4:7], s66 offen lds
ds_read_b128 v[232:235], v248 offset:41984
ds_read_u16_d16 v140, v140
ds_read_u16_d16 v142, v142
ds_read_u16_d16_hi v141, v141
v_mfma_f32_32x32x16_bf16 v[120:135], v[60:63], v[236:239], v[120:135]
v_lshrrev_b32_e64 v143, 18, v143
v_pk_add_f16 v150, v150, 1.0 op_sel_hi:[1,0]
v_pk_add_f16 v147, v147, 1.0 op_sel_hi:[1,0]
v_and_b32 v145, s49, v145
v_rcp_f16 v154, v153
v_bfe_u32 v144, v145, 2, 14
v_rcp_f16_e64 v151, v150
v_lshrrev_b32 v145, 18, v145
s_waitcnt lgkmcnt(4)
ds_read_b128 v[236:239], v248 offset:45056
ds_read_u16_d16_hi v143, v143
ds_read_u16_d16 v144, v144
ds_read_u16_d16_hi v145, v145
v_mfma_f32_32x32x16_bf16 v[120:135], v[64:67], v[216:219], v[120:135]
v_rcp_f16 v148, v147
v_rcp_f16_sdwa v154, v153 dst_sel:WORD_1 dst_unused:UNUSED_PRESERVE src0_sel:WORD_1
v_fma_mix_f32 v158, v136, v136, 0 op_sel:[0,0,0] op_sel_hi:[1,1,0]
v_fma_mix_f32 v158, v137, v137, v158 op_sel:[1,1,0] op_sel_hi:[1,1,0]
v_rcp_f16_sdwa v151, v150 dst_sel:WORD_1 dst_unused:UNUSED_PRESERVE src0_sel:WORD_1
v_fma_mix_f32 v158, v138, v138, v158 op_sel:[0,0,0] op_sel_hi:[1,1,0]
s_add_u32 m0, s67, 46592
s_add_u32 s66, s66, 98304
buffer_load_dwordx4 v240, s[4:7], s66 offen lds
ds_read_b128 v[216:219], v248 offset:43008
v_mfma_f32_32x32x16_bf16 v[120:135], v[68:71], v[220:223], v[120:135]
v_rcp_f16_sdwa v148, v147 dst_sel:WORD_1 dst_unused:UNUSED_PRESERVE src0_sel:WORD_1
v_fma_mix_f32 v158, v139, v139, v158 op_sel:[1,1,0] op_sel_hi:[1,1,0]
v_pk_mul_f16 v155, v155, v154
s_waitcnt lgkmcnt(5)
v_fma_mix_f32 v158, v140, v140, v158 op_sel:[0,0,0] op_sel_hi:[1,1,0]
v_pk_mul_f16 v152, v152, v151
v_fma_mix_f32 v158, v141, v141, v158 op_sel:[1,1,0] op_sel_hi:[1,1,0]
v_pk_mul_f16 v149, v149, v148
v_fma_mix_f32 v158, v155, v155, v158 op_sel:[0,0,0] op_sel_hi:[1,1,0]
v_fma_mix_f32 v158, v142, v142, v158 op_sel:[0,0,0] op_sel_hi:[1,1,0]
v_fma_mix_f32 v158, v155, v155, v158 op_sel:[1,1,0] op_sel_hi:[1,1,0]
s_waitcnt lgkmcnt(2)
v_fma_mix_f32 v158, v143, v143, v158 op_sel:[1,1,0] op_sel_hi:[1,1,0]
v_fma_mix_f32 v158, v152, v152, v158 op_sel:[0,0,0] op_sel_hi:[1,1,0]
v_fma_mix_f32 v158, v152, v152, v158 op_sel:[1,1,0] op_sel_hi:[1,1,0]
v_fma_mix_f32 v158, v144, v144, v158 op_sel:[0,0,0] op_sel_hi:[1,1,0]
v_fma_mix_f32 v158, v149, v149, v158 op_sel:[0,0,0] op_sel_hi:[1,1,0]
s_waitcnt lgkmcnt(1)
v_fma_mix_f32 v158, v145, v145, v158 op_sel:[1,1,0] op_sel_hi:[1,1,0]
v_fma_mix_f32 v158, v149, v149, v158 op_sel:[1,1,0] op_sel_hi:[1,1,0]
v_cvt_pkrtz_f16_f32 v137, v120, v121
v_cvt_pkrtz_f16_f32 v139, v122, v123
v_cvt_pkrtz_f16_f32 v141, v124, v125
v_cvt_pkrtz_f16_f32 v143, v126, v127
v_cvt_pkrtz_f16_f32 v145, v128, v129
v_cvt_pk_f16_f32 v155, v130, v131
v_cvt_pk_f16_f32 v152, v132, v133
v_cvt_pk_f16_f32 v149, v134, v135
buffer_store_dwordx4 v[48:51], v241, s[32:35], s80 offen
ds_read_b128 v[220:223], v248 offset:46080
v_mfma_f32_32x32x16_bf16 v[120:135], v[48:51], v[224:227], 0
v_pk_fma_f16 v154, v155, v155, s48
v_and_b32_e64 v137, s49, v137
v_pk_fma_f16 v151, v152, v152, s48
v_and_b32_e64 v139, s49, v139
v_pk_fma_f16 v148, v149, v149, s48
v_pk_mul_f16 v154, v155, v154
v_bfe_u32 v136, v137, 2, 14
v_pk_mul_f16 v151, v152, v151
v_pk_mul_f16 v148, v149, v148
v_bfe_u32 v138, v139, 2, 14
ds_read_b128 v[224:227], v248 offset:47104
ds_read_u16_d16 v136, v136
ds_read_u16_d16 v138, v138
v_mfma_f32_32x32x16_bf16 v[120:135], v[52:55], v[228:231], v[120:135]
v_exp_f16 v153, v154
v_lshrrev_b32 v137, 18, v137
v_exp_f16 v150, v151
v_lshrrev_b32 v139, 18, v139
v_exp_f16 v147, v148
v_and_b32 v141, s49, v141
v_and_b32_e64 v143, s49, v143
ds_read_b128 v[228:231], v248 offset:50176
ds_read_u16_d16_hi v137, v137
ds_read_u16_d16_hi v139, v139
v_mfma_f32_32x32x16_bf16 v[120:135], v[56:59], v[232:235], v[120:135]
v_exp_f16_sdwa v153, v154 dst_sel:WORD_1 dst_unused:UNUSED_PRESERVE src0_sel:WORD_1
v_bfe_u32 v140, v141, 2, 14
v_exp_f16_sdwa v150, v151 dst_sel:WORD_1 dst_unused:UNUSED_PRESERVE src0_sel:WORD_1
v_bfe_u32 v142, v143, 2, 14
v_exp_f16_sdwa v147, v148 dst_sel:WORD_1 dst_unused:UNUSED_PRESERVE src0_sel:WORD_1
v_lshrrev_b32_e64 v141, 18, v141
v_pk_add_f16 v153, v153, 1.0 op_sel_hi:[1,0]
ds_read_b128 v[232:235], v248 offset:48128
ds_read_u16_d16 v140, v140
ds_read_u16_d16 v142, v142
ds_read_u16_d16_hi v141, v141
v_mfma_f32_32x32x16_bf16 v[120:135], v[60:63], v[236:239], v[120:135]
v_lshrrev_b32_e64 v143, 18, v143
v_pk_add_f16 v150, v150, 1.0 op_sel_hi:[1,0]
v_pk_add_f16 v147, v147, 1.0 op_sel_hi:[1,0]
v_and_b32 v145, s49, v145
v_rcp_f16 v154, v153
v_bfe_u32 v144, v145, 2, 14
v_rcp_f16_e64 v151, v150
v_lshrrev_b32 v145, 18, v145
s_waitcnt lgkmcnt(7)
ds_read_b128 v[236:239], v248 offset:51200
ds_read_u16_d16_hi v143, v143
ds_read_u16_d16 v144, v144
ds_read_u16_d16_hi v145, v145
v_mfma_f32_32x32x16_bf16 v[120:135], v[64:67], v[216:219], v[120:135]
v_rcp_f16 v148, v147
v_rcp_f16_sdwa v154, v153 dst_sel:WORD_1 dst_unused:UNUSED_PRESERVE src0_sel:WORD_1
s_setprio 0
v_fma_mix_f32 v159, v136, v136, 0 op_sel:[0,0,0] op_sel_hi:[1,1,0]
s_waitcnt lgkmcnt(8)
v_fma_mix_f32 v159, v137, v137, v159 op_sel:[1,1,0] op_sel_hi:[1,1,0]
v_rcp_f16_sdwa v151, v150 dst_sel:WORD_1 dst_unused:UNUSED_PRESERVE src0_sel:WORD_1
v_fma_mix_f32 v159, v138, v138, v159 op_sel:[0,0,0] op_sel_hi:[1,1,0]
ds_read_b128 v[216:219], v248 offset:49152
v_mfma_f32_32x32x16_bf16 v[120:135], v[68:71], v[220:223], v[120:135]
v_rcp_f16_sdwa v148, v147 dst_sel:WORD_1 dst_unused:UNUSED_PRESERVE src0_sel:WORD_1
v_fma_mix_f32 v159, v139, v139, v159 op_sel:[1,1,0] op_sel_hi:[1,1,0]
v_pk_mul_f16 v155, v155, v154
s_waitcnt lgkmcnt(5)
v_fma_mix_f32 v159, v140, v140, v159 op_sel:[0,0,0] op_sel_hi:[1,1,0]
v_pk_mul_f16 v152, v152, v151
v_fma_mix_f32 v159, v141, v141, v159 op_sel:[1,1,0] op_sel_hi:[1,1,0]
v_pk_mul_f16 v149, v149, v148
v_fma_mix_f32 v159, v155, v155, v159 op_sel:[0,0,0] op_sel_hi:[1,1,0]
v_fma_mix_f32 v159, v142, v142, v159 op_sel:[0,0,0] op_sel_hi:[1,1,0]
v_fma_mix_f32 v159, v155, v155, v159 op_sel:[1,1,0] op_sel_hi:[1,1,0]
s_waitcnt lgkmcnt(3)
v_fma_mix_f32 v159, v143, v143, v159 op_sel:[1,1,0] op_sel_hi:[1,1,0]
v_fma_mix_f32 v159, v152, v152, v159 op_sel:[0,0,0] op_sel_hi:[1,1,0]
v_fma_mix_f32 v159, v152, v152, v159 op_sel:[1,1,0] op_sel_hi:[1,1,0]
s_waitcnt lgkmcnt(1)
v_fma_mix_f32 v159, v144, v144, v159 op_sel:[0,0,0] op_sel_hi:[1,1,0]
v_fma_mix_f32 v159, v149, v149, v159 op_sel:[0,0,0] op_sel_hi:[1,1,0]
v_fma_mix_f32 v159, v145, v145, v159 op_sel:[1,1,0] op_sel_hi:[1,1,0]
v_fma_mix_f32 v159, v149, v149, v159 op_sel:[1,1,0] op_sel_hi:[1,1,0]
v_cvt_pkrtz_f16_f32 v137, v120, v121
v_cvt_pkrtz_f16_f32 v139, v122, v123
v_cvt_pkrtz_f16_f32 v141, v124, v125
v_cvt_pkrtz_f16_f32 v143, v126, v127
v_cvt_pkrtz_f16_f32 v145, v128, v129
v_cvt_pk_f16_f32 v155, v130, v131
v_cvt_pk_f16_f32 v152, v132, v133
v_cvt_pk_f16_f32 v149, v134, v135
s_add_u32 s46, s80, 2097152
buffer_store_dwordx4 v[52:55], v241, s[32:35], s46 offen
ds_read_b128 v[220:223], v248 offset:52224
v_mfma_f32_32x32x16_bf16 v[120:135], v[48:51], v[224:227], 0
v_pk_fma_f16 v154, v155, v155, s48
v_and_b32_e64 v137, s49, v137
v_pk_fma_f16 v151, v152, v152, s48
v_and_b32_e64 v139, s49, v139
v_pk_fma_f16 v148, v149, v149, s48
v_pk_mul_f16 v154, v155, v154
v_bfe_u32 v136, v137, 2, 14
v_pk_mul_f16 v151, v152, v151
v_pk_mul_f16 v148, v149, v148
v_bfe_u32 v138, v139, 2, 14
ds_read_b64 v[224:225], v245 offset:384
ds_read_b64 v[226:227], v246 offset:384
s_cmp_eq_u32 s40, 7
s_cbranch_scc1 Lrdy8
s_waitcnt vmcnt(2)
Lrdy8:
s_barrier
ds_read_b128 v[192:195], v242
ds_read_u16_d16 v136, v136
ds_read_u16_d16 v138, v138
v_mfma_f32_32x32x16_bf16 v[120:135], v[52:55], v[228:231], v[120:135]
v_exp_f16 v153, v154
v_lshrrev_b32 v137, 18, v137
v_exp_f16 v150, v151
v_lshrrev_b32 v139, 18, v139
v_exp_f16 v147, v148
v_and_b32 v141, s49, v141
v_and_b32_e64 v143, s49, v143
ds_read_b128 v[228:231], v248 offset:53248
ds_read_u16_d16_hi v137, v137
ds_read_u16_d16_hi v139, v139
v_mfma_f32_32x32x16_bf16 v[120:135], v[56:59], v[232:235], v[120:135]
v_exp_f16_sdwa v153, v154 dst_sel:WORD_1 dst_unused:UNUSED_PRESERVE src0_sel:WORD_1
v_bfe_u32 v140, v141, 2, 14
v_exp_f16_sdwa v150, v151 dst_sel:WORD_1 dst_unused:UNUSED_PRESERVE src0_sel:WORD_1
v_bfe_u32 v142, v143, 2, 14
v_exp_f16_sdwa v147, v148 dst_sel:WORD_1 dst_unused:UNUSED_PRESERVE src0_sel:WORD_1
v_lshrrev_b32 v141, 18, v141
v_pk_add_f16 v153, v153, 1.0 op_sel_hi:[1,0]
s_setprio 2
ds_read_b64 v[232:233], v245 offset:1152
ds_read_b64 v[234:235], v246 offset:1152
ds_read_b128 v[196:199], v242 offset:64
ds_read_u16_d16 v140, v140
ds_read_u16_d16 v142, v142
ds_read_u16_d16_hi v141, v141
v_mfma_f32_32x32x16_bf16 v[120:135], v[60:63], v[236:239], v[120:135]
v_lshrrev_b32_e64 v143, 18, v143
v_pk_add_f16 v150, v150, 1.0 op_sel_hi:[1,0]
v_pk_add_f16 v147, v147, 1.0 op_sel_hi:[1,0]
v_and_b32 v145, s49, v145
v_rcp_f16 v154, v153
v_bfe_u32 v144, v145, 2, 14
v_rcp_f16_e64 v151, v150
v_lshrrev_b32 v145, 18, v145
s_waitcnt lgkmcnt(6)
ds_read_b128 v[236:239], v248 offset:56320
ds_read_u16_d16_hi v143, v143
ds_read_u16_d16 v144, v144
ds_read_u16_d16_hi v145, v145
v_mfma_f32_32x32x16_bf16 v[120:135], v[64:67], v[216:219], v[120:135]
v_rcp_f16 v148, v147
v_rcp_f16_sdwa v154, v153 dst_sel:WORD_1 dst_unused:UNUSED_PRESERVE src0_sel:WORD_1
v_fma_mix_f32 v160, v136, v136, 0 op_sel:[0,0,0] op_sel_hi:[1,1,0]
v_fma_mix_f32 v160, v137, v137, v160 op_sel:[1,1,0] op_sel_hi:[1,1,0]
v_rcp_f16_sdwa v151, v150 dst_sel:WORD_1 dst_unused:UNUSED_PRESERVE src0_sel:WORD_1
v_fma_mix_f32 v160, v138, v138, v160 op_sel:[0,0,0] op_sel_hi:[1,1,0]
ds_read_b64 v[216:217], v245 offset:1920
ds_read_b64 v[218:219], v246 offset:1920
ds_read_b128 v[200:203], v242 offset:128
v_mfma_f32_32x32x16_bf16 v[120:135], v[68:71], v[220:223], v[120:135]
v_rcp_f16_sdwa v148, v147 dst_sel:WORD_1 dst_unused:UNUSED_PRESERVE src0_sel:WORD_1
v_fma_mix_f32 v160, v139, v139, v160 op_sel:[1,1,0] op_sel_hi:[1,1,0]
v_pk_mul_f16 v155, v155, v154
s_waitcnt lgkmcnt(7)
v_fma_mix_f32 v160, v140, v140, v160 op_sel:[0,0,0] op_sel_hi:[1,1,0]
v_pk_mul_f16 v152, v152, v151
v_fma_mix_f32 v160, v141, v141, v160 op_sel:[1,1,0] op_sel_hi:[1,1,0]
v_pk_mul_f16 v149, v149, v148
v_fma_mix_f32 v160, v155, v155, v160 op_sel:[0,0,0] op_sel_hi:[1,1,0]
v_fma_mix_f32 v160, v142, v142, v160 op_sel:[0,0,0] op_sel_hi:[1,1,0]
v_fma_mix_f32 v160, v155, v155, v160 op_sel:[1,1,0] op_sel_hi:[1,1,0]
s_waitcnt lgkmcnt(5)
v_fma_mix_f32 v160, v143, v143, v160 op_sel:[1,1,0] op_sel_hi:[1,1,0]
v_fma_mix_f32 v160, v152, v152, v160 op_sel:[0,0,0] op_sel_hi:[1,1,0]
v_fma_mix_f32 v160, v152, v152, v160 op_sel:[1,1,0] op_sel_hi:[1,1,0]
s_waitcnt lgkmcnt(3)
v_fma_mix_f32 v160, v144, v144, v160 op_sel:[0,0,0] op_sel_hi:[1,1,0]
v_fma_mix_f32 v160, v149, v149, v160 op_sel:[0,0,0] op_sel_hi:[1,1,0]
v_fma_mix_f32 v160, v145, v145, v160 op_sel:[1,1,0] op_sel_hi:[1,1,0]
v_fma_mix_f32 v160, v149, v149, v160 op_sel:[1,1,0] op_sel_hi:[1,1,0]
v_mfma_f32_16x16x32_bf16 v[8:11], v[224:227], v[192:195], 0
s_add_u32 s46, s80, 4194304
buffer_store_dwordx4 v[56:59], v241, s[32:35], s46 offen
ds_read_b128 v[220:223], v248 offset:54272
v_cvt_pkrtz_f16_f32 v137, v120, v121
v_cvt_pkrtz_f16_f32 v139, v122, v123
v_cvt_pkrtz_f16_f32 v141, v124, v125
v_cvt_pkrtz_f16_f32 v143, v126, v127
v_cvt_pk_f16_f32 v155, v128, v129
v_cvt_pk_f16_f32 v152, v130, v131
v_cvt_pk_f16_f32 v149, v132, v133
v_cvt_pk_f16_f32 v146, v134, v135
v_mfma_f32_32x32x16_bf16 v[120:135], v[48:51], v[228:231], 0
ds_read_b64 v[224:225], v245 offset:2688
ds_read_b64 v[226:227], v246 offset:2688
ds_read_b128 v[204:207], v243
v_pk_fma_f16 v154, v155, v155, s48
v_and_b32_e64 v137, s49, v137
v_pk_fma_f16 v151, v152, v152, s48
v_pk_fma_f16 v148, v149, v149, s48
v_mfma_f32_16x16x32_bf16 v[24:27], v[232:235], v[196:199], 0
ds_read_b128 v[228:231], v248 offset:57344
v_and_b32_e64 v139, s49, v139
v_pk_fma_f16 v145, v146, v146, s48
v_pk_mul_f16 v154, v155, v154
v_bfe_u32 v136, v137, 2, 14
v_mfma_f32_32x32x16_bf16 v[120:135], v[52:55], v[236:239], v[120:135]
ds_read_b64 v[232:233], v245 offset:3456
ds_read_b64 v[234:235], v246 offset:3456
ds_read_b128 v[208:211], v243 offset:64
ds_read_u16_d16 v136, v136
v_pk_mul_f16 v151, v152, v151
v_pk_mul_f16 v148, v149, v148
v_bfe_u32 v138, v139, 2, 14
v_pk_mul_f16 v145, v146, v145
v_exp_f16_e64 v153, v154
v_lshrrev_b32 v137, 18, v137
s_waitcnt lgkmcnt(8)
v_mfma_f32_16x16x32_bf16 v[40:43], v[216:219], v[200:203], 0
ds_read_b128 v[236:239], v248 offset:55296
ds_read_u16_d16 v138, v138
ds_read_u16_d16_hi v137, v137
v_exp_f16 v150, v151
v_lshrrev_b32 v139, 18, v139
v_exp_f16_e64 v147, v148
v_mfma_f32_32x32x16_bf16 v[120:135], v[56:59], v[220:223], v[120:135]
ds_read_b64 v[216:217], v245 offset:4224
ds_read_b64 v[218:219], v246 offset:4224
ds_read_b128 v[212:215], v243 offset:128
ds_read_u16_d16_hi v139, v139
v_and_b32 v141, s49, v141
v_exp_f16 v144, v145
v_and_b32 v143, s49, v143
v_exp_f16_sdwa v153, v154 dst_sel:WORD_1 dst_unused:UNUSED_PRESERVE src0_sel:WORD_1
v_bfe_u32 v140, v141, 2, 14
s_waitcnt lgkmcnt(7)
v_mfma_f32_16x16x32_bf16 v[8:11], v[224:227], v[204:207], v[8:11]
ds_read_b64 v[220:221], v245 offset:4992
ds_read_b64 v[222:223], v246 offset:4992
ds_read_b128 v[192:195], v244
ds_read_u16_d16 v140, v140
v_exp_f16_sdwa v150, v151 dst_sel:WORD_1 dst_unused:UNUSED_PRESERVE src0_sel:WORD_1
v_bfe_u32 v142, v143, 2, 14
v_exp_f16_sdwa v147, v148 dst_sel:WORD_1 dst_unused:UNUSED_PRESERVE src0_sel:WORD_1
v_mfma_f32_32x32x16_bf16 v[120:135], v[60:63], v[228:231], v[120:135]
ds_read_b128 v[224:227], v248 offset:58368
ds_read_u16_d16 v142, v142
v_lshrrev_b32_e64 v141, 18, v141
v_exp_f16_sdwa v144, v145 dst_sel:WORD_1 dst_unused:UNUSED_PRESERVE src0_sel:WORD_1
v_lshrrev_b32_e64 v143, 18, v143
v_pk_add_f16 v153, v153, 1.0 op_sel_hi:[1,0]
v_pk_add_f16 v150, v150, 1.0 op_sel_hi:[1,0]
v_pk_add_f16 v147, v147, 1.0 op_sel_hi:[1,0]
v_pk_add_f16 v144, v144, 1.0 op_sel_hi:[1,0]
v_mfma_f32_16x16x32_bf16 v[24:27], v[232:235], v[208:211], v[24:27]
ds_read_b64 v[228:229], v245 offset:5760
ds_read_b64 v[230:231], v246 offset:5760
ds_read_b128 v[196:199], v244 offset:64
ds_read_u16_d16_hi v141, v141
ds_read_u16_d16_hi v143, v143
v_rcp_f16_e64 v154, v153
v_rcp_f16 v151, v150
s_waitcnt lgkmcnt(10)
v_mfma_f32_32x32x16_bf16 v[120:135], v[64:67], v[236:239], v[120:135]
ds_read_b64 v[232:233], v245 offset:6528
ds_read_b64 v[234:235], v246 offset:6528
ds_read_b128 v[200:203], v244 offset:128
v_rcp_f16 v148, v147
v_rcp_f16 v145, v144
v_rcp_f16_sdwa v154, v153 dst_sel:WORD_1 dst_unused:UNUSED_PRESERVE src0_sel:WORD_1
v_rcp_f16_sdwa v151, v150 dst_sel:WORD_1 dst_unused:UNUSED_PRESERVE src0_sel:WORD_1
v_mfma_f32_16x16x32_bf16 v[40:43], v[216:219], v[212:215], v[40:43]
ds_read_b64 v[236:237], v245 offset:576
ds_read_b64 v[238:239], v246 offset:576
v_xor_b32 v242, 16, v242
ds_read_b128 v[204:207], v242
v_rcp_f16_sdwa v148, v147 dst_sel:WORD_1 dst_unused:UNUSED_PRESERVE src0_sel:WORD_1
v_fma_mix_f32 v161, v136, v136, 0 op_sel:[0,0,0] op_sel_hi:[1,1,0]
s_waitcnt lgkmcnt(11)
v_mfma_f32_16x16x32_bf16 v[8:11], v[220:223], v[192:195], v[8:11]
ds_read_b128 v[216:219], v248 offset:59392
v_rcp_f16_sdwa v145, v144 dst_sel:WORD_1 dst_unused:UNUSED_PRESERVE src0_sel:WORD_1
v_fma_mix_f32 v161, v137, v137, v161 op_sel:[1,1,0] op_sel_hi:[1,1,0]
v_pk_mul_f16 v155, v155, v154
v_fma_mix_f32 v161, v138, v138, v161 op_sel:[0,0,0] op_sel_hi:[1,1,0]
v_mfma_f32_32x32x16_bf16 v[120:135], v[68:71], v[224:227], v[120:135]
ds_read_b64 v[220:221], v245 offset:1344
ds_read_b64 v[222:223], v246 offset:1344
ds_read_b128 v[208:211], v242 offset:64
v_pk_mul_f16 v152, v152, v151
v_pk_mul_f16 v149, v149, v148
v_fma_mix_f32 v161, v139, v139, v161 op_sel:[1,1,0] op_sel_hi:[1,1,0]
v_pk_mul_f16 v146, v146, v145
v_fma_mix_f32 v161, v155, v155, v161 op_sel:[0,0,0] op_sel_hi:[1,1,0]
v_fma_mix_f32 v161, v140, v140, v161 op_sel:[0,0,0] op_sel_hi:[1,1,0]
v_fma_mix_f32 v161, v155, v155, v161 op_sel:[1,1,0] op_sel_hi:[1,1,0]
v_fma_mix_f32 v161, v152, v152, v161 op_sel:[0,0,0] op_sel_hi:[1,1,0]
s_waitcnt lgkmcnt(6)
v_mfma_f32_16x16x32_bf16 v[24:27], v[228:231], v[196:199], v[24:27]
ds_read_b128 v[224:227], v248 offset:62464
v_fma_mix_f32 v161, v141, v141, v161 op_sel:[1,1,0] op_sel_hi:[1,1,0]
v_fma_mix_f32 v161, v152, v152, v161 op_sel:[1,1,0] op_sel_hi:[1,1,0]
v_fma_mix_f32 v161, v149, v149, v161 op_sel:[0,0,0] op_sel_hi:[1,1,0]
v_fma_mix_f32 v161, v142, v142, v161 op_sel:[0,0,0] op_sel_hi:[1,1,0]
v_mfma_f32_16x16x32_bf16 v[40:43], v[232:235], v[200:203], v[40:43]
ds_read_b64 v[228:229], v245 offset:2112
ds_read_b64 v[230:231], v246 offset:2112
ds_read_b128 v[212:215], v242 offset:128
v_fma_mix_f32 v161, v149, v149, v161 op_sel:[1,1,0] op_sel_hi:[1,1,0]
v_fma_mix_f32 v161, v146, v146, v161 op_sel:[0,0,0] op_sel_hi:[1,1,0]
v_fma_mix_f32 v161, v143, v143, v161 op_sel:[1,1,0] op_sel_hi:[1,1,0]
v_fma_mix_f32 v161, v146, v146, v161 op_sel:[1,1,0] op_sel_hi:[1,1,0]
s_cmp_lg_u32 s40, 7
s_cbranch_scc1 Lnosent
v_mov_b32 v188, -1
v_mov_b32 v189, -1
v_mov_b32 v190, -1
v_mov_b32 v191, -1
v_lshlrev_b32 v174, 12, v251
v_add_u32 v175, 262144, v174
v_cmp_gt_u32 vcc, 32, v251
v_mov_b32 v176, 2147483648
s_nop 0
v_cndmask_b32 v175, v176, v175, vcc
s_lshl_b32 s43, s2, 4
buffer_store_dwordx4 v[188:191], v174, s[32:35], s43 offen sc1
buffer_store_dwordx4 v[188:191], v175, s[32:35], s43 offen sc1
s_add_u32 s43, s43, 393216
s_cmp_lt_u32 s2, 96
s_cselect_b32 s43, s43, 1073741824
v_lshlrev_b32_e64 v176, 11, v251
s_mov_b64 exec, 0xff
buffer_store_dwordx4 v[188:191], v176, s[32:35], s43 offen sc1
s_mov_b64 exec, -1
s_sub_u32 s43, s2, 96
s_cmp_lt_u32 s43, 96
s_cbranch_scc0 Lnobias
s_lshl_b32 s44, s43, 1
v_mul_u32_u24 v174, 192, v251
v_lshlrev_b32 v175, 1, v251
s_add_u32 s45, s44, 0
buffer_load_ushort v176, v174, s[16:19], s45 offen
buffer_load_ushort v182, v175, s[28:31], 0 offen offset:0
s_add_u32 s45, s44, 12288
buffer_load_ushort v177, v174, s[16:19], s45 offen
buffer_load_ushort v183, v175, s[28:31], 0 offen offset:128
s_add_u32 s45, s44, 24576
buffer_load_ushort v178, v174, s[16:19], s45 offen
buffer_load_ushort v184, v175, s[28:31], 0 offen offset:256
s_add_u32 s45, s44, 36864
buffer_load_ushort v179, v174, s[16:19], s45 offen
buffer_load_ushort v185, v175, s[28:31], 0 offen offset:384
s_add_u32 s45, s44, 49152
buffer_load_ushort v180, v174, s[16:19], s45 offen
buffer_load_ushort v186, v175, s[28:31], 0 offen offset:512
s_add_u32 s45, s44, 61440
buffer_load_ushort v181, v174, s[16:19], s45 offen
buffer_load_ushort v187, v175, s[28:31], 0 offen offset:640
Lnobias:
s_nop 1
Lnosent:
s_waitcnt lgkmcnt(0)
v_mfma_f32_16x16x32_bf16 v[12:15], v[236:239], v[204:207], 0
s_add_u32 s46, s80, 6291456
buffer_store_dwordx4 v[60:63], v241, s[32:35], s46 offen
ds_read_b128 v[232:235], v248 offset:60416
v_cvt_pkrtz_f16_f32 v137, v120, v121
v_cvt_pkrtz_f16_f32 v139, v122, v123
v_cvt_pkrtz_f16_f32 v141, v124, v125
v_cvt_pkrtz_f16_f32 v143, v126, v127
v_cvt_pk_f16_f32 v155, v128, v129
v_cvt_pk_f16_f32 v152, v130, v131
v_cvt_pk_f16_f32 v149, v132, v133
v_cvt_pk_f16_f32 v146, v134, v135
v_mfma_f32_32x32x16_bf16 v[120:135], v[48:51], v[216:219], 0
ds_read_b64 v[236:237], v245 offset:2880
ds_read_b64 v[238:239], v246 offset:2880
v_xor_b32 v243, 16, v243
ds_read_b128 v[192:195], v243
v_pk_fma_f16 v154, v155, v155, s48
v_and_b32 v137, s49, v137
v_pk_fma_f16 v151, v152, v152, s48
v_pk_fma_f16 v148, v149, v149, s48
v_mfma_f32_16x16x32_bf16 v[28:31], v[220:223], v[208:211], 0
ds_read_b128 v[216:219], v248 offset:63488
v_and_b32_e64 v139, s49, v139
v_pk_fma_f16 v145, v146, v146, s48
v_pk_mul_f16 v154, v155, v154
v_bfe_u32 v136, v137, 2, 14
v_mfma_f32_32x32x16_bf16 v[120:135], v[52:55], v[224:227], v[120:135]
ds_read_b64 v[220:221], v245 offset:3648
ds_read_b64 v[222:223], v246 offset:3648
ds_read_b128 v[196:199], v243 offset:64
ds_read_u16_d16 v136, v136
v_pk_mul_f16 v151, v152, v151
v_pk_mul_f16 v148, v149, v148
v_bfe_u32 v138, v139, 2, 14
v_pk_mul_f16 v145, v146, v145
v_exp_f16 v153, v154
v_lshrrev_b32 v137, 18, v137
v_mfma_f32_16x16x32_bf16 v[44:47], v[228:231], v[212:215], 0
ds_read_b128 v[224:227], v248 offset:61440
ds_read_u16_d16 v138, v138
ds_read_u16_d16_hi v137, v137
v_exp_f16 v150, v151
v_lshrrev_b32 v139, 18, v139
v_exp_f16 v147, v148
s_waitcnt lgkmcnt(8)
v_mfma_f32_32x32x16_bf16 v[120:135], v[56:59], v[232:235], v[120:135]
ds_read_b64 v[228:229], v245 offset:4416
ds_read_b64 v[230:231], v246 offset:4416
ds_read_b128 v[200:203], v243 offset:128
ds_read_u16_d16_hi v139, v139
v_and_b32 v141, s49, v141
v_exp_f16 v144, v145
v_and_b32_e64 v143, s49, v143
v_exp_f16_sdwa v153, v154 dst_sel:WORD_1 dst_unused:UNUSED_PRESERVE src0_sel:WORD_1
v_bfe_u32 v140, v141, 2, 14
v_mfma_f32_16x16x32_bf16 v[12:15], v[236:239], v[192:195], v[12:15]
ds_read_b64 v[232:233], v245 offset:5184
ds_read_b64 v[234:235], v246 offset:5184
v_xor_b32 v244, 16, v244
ds_read_b128 v[204:207], v244
ds_read_u16_d16 v140, v140
v_exp_f16_sdwa v150, v151 dst_sel:WORD_1 dst_unused:UNUSED_PRESERVE src0_sel:WORD_1
v_bfe_u32 v142, v143, 2, 14
v_exp_f16_sdwa v147, v148 dst_sel:WORD_1 dst_unused:UNUSED_PRESERVE src0_sel:WORD_1
s_waitcnt lgkmcnt(9)
v_mfma_f32_32x32x16_bf16 v[120:135], v[60:63], v[216:219], v[120:135]
ds_read_b128 v[236:239], v248 offset:64512
ds_read_u16_d16 v142, v142
v_lshrrev_b32_e64 v141, 18, v141
v_exp_f16_sdwa v144, v145 dst_sel:WORD_1 dst_unused:UNUSED_PRESERVE src0_sel:WORD_1
v_lshrrev_b32_e64 v143, 18, v143
v_pk_add_f16 v153, v153, 1.0 op_sel_hi:[1,0]
v_pk_add_f16 v150, v150, 1.0 op_sel_hi:[1,0]
v_pk_add_f16 v147, v147, 1.0 op_sel_hi:[1,0]
v_pk_add_f16 v144, v144, 1.0 op_sel_hi:[1,0]
v_mfma_f32_16x16x32_bf16 v[28:31], v[220:223], v[196:199], v[28:31]
ds_read_b64 v[216:217], v245 offset:5952
ds_read_b64 v[218:219], v246 offset:5952
ds_read_b128 v[208:211], v244 offset:64
ds_read_u16_d16_hi v141, v141
ds_read_u16_d16_hi v143, v143
v_rcp_f16 v154, v153
v_rcp_f16 v151, v150
v_mfma_f32_32x32x16_bf16 v[120:135], v[64:67], v[224:227], v[120:135]
ds_read_b64 v[220:221], v245 offset:6720
ds_read_b64 v[222:223], v246 offset:6720
ds_read_b128 v[212:215], v244 offset:128
v_rcp_f16_e64 v148, v147
v_rcp_f16 v145, v144
v_rcp_f16_sdwa v154, v153 dst_sel:WORD_1 dst_unused:UNUSED_PRESERVE src0_sel:WORD_1
v_rcp_f16_sdwa v151, v150 dst_sel:WORD_1 dst_unused:UNUSED_PRESERVE src0_sel:WORD_1
s_waitcnt lgkmcnt(9)
v_mfma_f32_16x16x32_bf16 v[44:47], v[228:231], v[200:203], v[44:47]
ds_read_b64 v[224:225], v245 offset:192
ds_read_b64 v[226:227], v246 offset:192
v_xor_b32 v242, 32, v242
ds_read_b128 v[192:195], v242
v_rcp_f16_sdwa v148, v147 dst_sel:WORD_1 dst_unused:UNUSED_PRESERVE src0_sel:WORD_1
v_fma_mix_f32 v162, v136, v136, 0 op_sel:[0,0,0] op_sel_hi:[1,1,0]
s_setprio 1
v_mfma_f32_16x16x32_bf16 v[12:15], v[232:235], v[204:207], v[12:15]
ds_read_b128 v[228:231], v249
v_rcp_f16_sdwa v145, v144 dst_sel:WORD_1 dst_unused:UNUSED_PRESERVE src0_sel:WORD_1
v_fma_mix_f32 v162, v137, v137, v162 op_sel:[1,1,0] op_sel_hi:[1,1,0]
v_pk_mul_f16 v155, v155, v154
v_fma_mix_f32 v162, v138, v138, v162 op_sel:[0,0,0] op_sel_hi:[1,1,0]
v_mfma_f32_32x32x16_bf16 v[120:135], v[68:71], v[236:239], v[120:135]
ds_read_b64 v[232:233], v245 offset:960
ds_read_b64 v[234:235], v246 offset:960
ds_read_b128 v[196:199], v242 offset:64
v_pk_mul_f16 v152, v152, v151
v_pk_mul_f16 v149, v149, v148
v_fma_mix_f32 v162, v139, v139, v162 op_sel:[1,1,0] op_sel_hi:[1,1,0]
v_pk_mul_f16 v146, v146, v145
v_fma_mix_f32 v162, v155, v155, v162 op_sel:[0,0,0] op_sel_hi:[1,1,0]
v_fma_mix_f32 v162, v140, v140, v162 op_sel:[0,0,0] op_sel_hi:[1,1,0]
v_fma_mix_f32 v162, v155, v155, v162 op_sel:[1,1,0] op_sel_hi:[1,1,0]
v_fma_mix_f32 v162, v152, v152, v162 op_sel:[0,0,0] op_sel_hi:[1,1,0]
s_waitcnt lgkmcnt(6)
v_mfma_f32_16x16x32_bf16 v[28:31], v[216:219], v[208:211], v[28:31]
ds_read_b128 v[236:239], v249 offset:3072
v_fma_mix_f32 v162, v141, v141, v162 op_sel:[1,1,0] op_sel_hi:[1,1,0]
v_fma_mix_f32 v162, v152, v152, v162 op_sel:[1,1,0] op_sel_hi:[1,1,0]
v_fma_mix_f32 v162, v149, v149, v162 op_sel:[0,0,0] op_sel_hi:[1,1,0]
v_fma_mix_f32 v162, v142, v142, v162 op_sel:[0,0,0] op_sel_hi:[1,1,0]
v_mfma_f32_16x16x32_bf16 v[44:47], v[220:223], v[212:215], v[44:47]
ds_read_b64 v[216:217], v245 offset:1728
ds_read_b64 v[218:219], v246 offset:1728
ds_read_b128 v[200:203], v242 offset:128
v_fma_mix_f32 v162, v149, v149, v162 op_sel:[1,1,0] op_sel_hi:[1,1,0]
v_fma_mix_f32 v162, v146, v146, v162 op_sel:[0,0,0] op_sel_hi:[1,1,0]
v_fma_mix_f32 v162, v143, v143, v162 op_sel:[1,1,0] op_sel_hi:[1,1,0]
v_fma_mix_f32 v162, v146, v146, v162 op_sel:[1,1,0] op_sel_hi:[1,1,0]
s_waitcnt lgkmcnt(5)
v_mfma_f32_16x16x32_bf16 v[4:7], v[224:227], v[192:195], 0
s_add_u32 s46, s80, 8388608
buffer_store_dwordx4 v[64:67], v241, s[32:35], s46 offen
ds_read_b128 v[220:223], v249 offset:1024
v_cvt_pkrtz_f16_f32 v137, v120, v121
v_cvt_pkrtz_f16_f32 v139, v122, v123
v_cvt_pkrtz_f16_f32 v141, v124, v125
v_cvt_pkrtz_f16_f32 v143, v126, v127
v_cvt_pk_f16_f32 v155, v128, v129
v_cvt_pk_f16_f32 v152, v130, v131
v_cvt_pk_f16_f32 v149, v132, v133
v_cvt_pk_f16_f32 v146, v134, v135
v_mfma_f32_32x32x16_bf16 v[120:135], v[48:51], v[228:231], 0
ds_read_b64 v[224:225], v245 offset:2496
ds_read_b64 v[226:227], v246 offset:2496
v_xor_b32 v243, 32, v243
ds_read_b128 v[204:207], v243
v_pk_fma_f16 v154, v155, v155, s48
v_and_b32 v137, s49, v137
v_pk_fma_f16 v151, v152, v152, s48
v_pk_fma_f16 v148, v149, v149, s48
s_waitcnt lgkmcnt(4)
v_mfma_f32_16x16x32_bf16 v[20:23], v[232:235], v[196:199], 0
ds_read_b128 v[228:231], v249 offset:4096
v_and_b32 v139, s49, v139
v_pk_fma_f16 v145, v146, v146, s48
v_pk_mul_f16 v154, v155, v154
v_bfe_u32 v136, v137, 2, 14
v_mfma_f32_32x32x16_bf16 v[120:135], v[52:55], v[236:239], v[120:135]
ds_read_b64 v[232:233], v245 offset:3264
ds_read_b64 v[234:235], v246 offset:3264
ds_read_b128 v[208:211], v243 offset:64
ds_read_u16_d16 v136, v136
v_pk_mul_f16 v151, v152, v151
v_pk_mul_f16 v148, v149, v148
v_bfe_u32 v138, v139, 2, 14
v_pk_mul_f16 v145, v146, v145
v_exp_f16 v153, v154
v_lshrrev_b32 v137, 18, v137
v_mfma_f32_16x16x32_bf16 v[36:39], v[216:219], v[200:203], 0
ds_read_b128 v[236:239], v249 offset:2048
ds_read_u16_d16 v138, v138
ds_read_u16_d16_hi v137, v137
v_exp_f16 v150, v151
v_lshrrev_b32 v139, 18, v139
v_exp_f16 v147, v148
s_waitcnt lgkmcnt(8)
v_mfma_f32_32x32x16_bf16 v[120:135], v[56:59], v[220:223], v[120:135]
ds_read_b64 v[216:217], v245 offset:4032
ds_read_b64 v[218:219], v246 offset:4032
ds_read_b128 v[212:215], v243 offset:128
ds_read_u16_d16_hi v139, v139
v_and_b32 v141, s49, v141
v_exp_f16 v144, v145
v_and_b32_e64 v143, s49, v143
v_exp_f16_sdwa v153, v154 dst_sel:WORD_1 dst_unused:UNUSED_PRESERVE src0_sel:WORD_1
v_bfe_u32 v140, v141, 2, 14
v_mfma_f32_16x16x32_bf16 v[4:7], v[224:227], v[204:207], v[4:7]
ds_read_b64 v[220:221], v245 offset:4800
ds_read_b64 v[222:223], v246 offset:4800
v_xor_b32 v244, 32, v244
ds_read_b128 v[192:195], v244
ds_read_u16_d16 v140, v140
v_exp_f16_sdwa v150, v151 dst_sel:WORD_1 dst_unused:UNUSED_PRESERVE src0_sel:WORD_1
v_bfe_u32 v142, v143, 2, 14
v_exp_f16_sdwa v147, v148 dst_sel:WORD_1 dst_unused:UNUSED_PRESERVE src0_sel:WORD_1
s_waitcnt lgkmcnt(9)
v_mfma_f32_32x32x16_bf16 v[120:135], v[60:63], v[228:231], v[120:135]
ds_read_b128 v[224:227], v249 offset:5120
ds_read_u16_d16 v142, v142
v_lshrrev_b32_e64 v141, 18, v141
v_exp_f16_sdwa v144, v145 dst_sel:WORD_1 dst_unused:UNUSED_PRESERVE src0_sel:WORD_1
v_lshrrev_b32_e64 v143, 18, v143
v_pk_add_f16 v153, v153, 1.0 op_sel_hi:[1,0]
v_pk_add_f16 v150, v150, 1.0 op_sel_hi:[1,0]
v_pk_add_f16 v147, v147, 1.0 op_sel_hi:[1,0]
v_pk_add_f16 v144, v144, 1.0 op_sel_hi:[1,0]
v_mfma_f32_16x16x32_bf16 v[20:23], v[232:235], v[208:211], v[20:23]
ds_read_b64 v[228:229], v245 offset:5568
ds_read_b64 v[230:231], v246 offset:5568
ds_read_b128 v[196:199], v244 offset:64
ds_read_u16_d16_hi v141, v141
ds_read_u16_d16_hi v143, v143
v_rcp_f16 v154, v153
v_rcp_f16 v151, v150
v_mfma_f32_32x32x16_bf16 v[120:135], v[64:67], v[236:239], v[120:135]
ds_read_b64 v[232:233], v245 offset:6336
ds_read_b64 v[234:235], v246 offset:6336
ds_read_b128 v[200:203], v244 offset:128
v_rcp_f16 v148, v147
v_rcp_f16 v145, v144
v_rcp_f16_sdwa v154, v153 dst_sel:WORD_1 dst_unused:UNUSED_PRESERVE src0_sel:WORD_1
v_rcp_f16_sdwa v151, v150 dst_sel:WORD_1 dst_unused:UNUSED_PRESERVE src0_sel:WORD_1
s_waitcnt lgkmcnt(9)
v_mfma_f32_16x16x32_bf16 v[36:39], v[216:219], v[212:215], v[36:39]
ds_read_b64 v[236:237], v245
ds_read_b64 v[238:239], v246
v_xor_b32 v242, 16, v242
ds_read_b128 v[204:207], v242
v_rcp_f16_sdwa v148, v147 dst_sel:WORD_1 dst_unused:UNUSED_PRESERVE src0_sel:WORD_1
v_fma_mix_f32 v163, v136, v136, 0 op_sel:[0,0,0] op_sel_hi:[1,1,0]
v_mfma_f32_16x16x32_bf16 v[4:7], v[220:223], v[192:195], v[4:7]
ds_read_b128 v[216:219], v249 offset:6144
v_rcp_f16_sdwa v145, v144 dst_sel:WORD_1 dst_unused:UNUSED_PRESERVE src0_sel:WORD_1
v_fma_mix_f32 v163, v137, v137, v163 op_sel:[1,1,0] op_sel_hi:[1,1,0]
v_pk_mul_f16 v155, v155, v154
v_fma_mix_f32 v163, v138, v138, v163 op_sel:[0,0,0] op_sel_hi:[1,1,0]
v_mfma_f32_32x32x16_bf16 v[120:135], v[68:71], v[224:227], v[120:135]
ds_read_b64 v[220:221], v245 offset:768
ds_read_b64 v[222:223], v246 offset:768
ds_read_b128 v[208:211], v242 offset:64
v_pk_mul_f16 v152, v152, v151
v_pk_mul_f16 v149, v149, v148
v_fma_mix_f32 v163, v139, v139, v163 op_sel:[1,1,0] op_sel_hi:[1,1,0]
v_pk_mul_f16 v146, v146, v145
v_fma_mix_f32 v163, v155, v155, v163 op_sel:[0,0,0] op_sel_hi:[1,1,0]
v_fma_mix_f32 v163, v140, v140, v163 op_sel:[0,0,0] op_sel_hi:[1,1,0]
v_fma_mix_f32 v163, v155, v155, v163 op_sel:[1,1,0] op_sel_hi:[1,1,0]
v_fma_mix_f32 v163, v152, v152, v163 op_sel:[0,0,0] op_sel_hi:[1,1,0]
s_waitcnt lgkmcnt(7)
v_mfma_f32_16x16x32_bf16 v[20:23], v[228:231], v[196:199], v[20:23]
ds_read_b128 v[224:227], v249 offset:9216
v_fma_mix_f32 v163, v141, v141, v163 op_sel:[1,1,0] op_sel_hi:[1,1,0]
v_fma_mix_f32 v163, v152, v152, v163 op_sel:[1,1,0] op_sel_hi:[1,1,0]
v_fma_mix_f32 v163, v149, v149, v163 op_sel:[0,0,0] op_sel_hi:[1,1,0]
v_fma_mix_f32 v163, v142, v142, v163 op_sel:[0,0,0] op_sel_hi:[1,1,0]
v_mfma_f32_16x16x32_bf16 v[36:39], v[232:235], v[200:203], v[36:39]
ds_read_b64 v[228:229], v245 offset:1536
ds_read_b64 v[230:231], v246 offset:1536
ds_read_b128 v[212:215], v242 offset:128
v_fma_mix_f32 v163, v149, v149, v163 op_sel:[1,1,0] op_sel_hi:[1,1,0]
v_fma_mix_f32 v163, v146, v146, v163 op_sel:[0,0,0] op_sel_hi:[1,1,0]
v_fma_mix_f32 v163, v143, v143, v163 op_sel:[1,1,0] op_sel_hi:[1,1,0]
v_fma_mix_f32 v163, v146, v146, v163 op_sel:[1,1,0] op_sel_hi:[1,1,0]
s_waitcnt lgkmcnt(5)
v_mfma_f32_16x16x32_bf16 v[0:3], v[236:239], v[204:207], 0
s_add_u32 s46, s80, 10485760
buffer_store_dwordx4 v[68:71], v241, s[32:35], s46 offen
ds_read_b128 v[232:235], v249 offset:7168
v_cvt_pkrtz_f16_f32 v137, v120, v121
v_cvt_pkrtz_f16_f32 v139, v122, v123
v_cvt_pkrtz_f16_f32 v141, v124, v125
v_cvt_pkrtz_f16_f32 v143, v126, v127
v_cvt_pk_f16_f32 v155, v128, v129
v_cvt_pk_f16_f32 v152, v130, v131
v_cvt_pk_f16_f32 v149, v132, v133
v_cvt_pk_f16_f32 v146, v134, v135
v_mfma_f32_32x32x16_bf16 v[120:135], v[48:51], v[216:219], 0
ds_read_b64 v[236:237], v245 offset:2304
ds_read_b64 v[238:239], v246 offset:2304
v_xor_b32 v243, 16, v243
ds_read_b128 v[192:195], v243
v_pk_fma_f16 v154, v155, v155, s48
v_and_b32_e64 v137, s49, v137
s_waitcnt lgkmcnt(4)
v_mfma_f32_16x16x32_bf16 v[16:19], v[220:223], v[208:211], 0
ds_read_b128 v[216:219], v249 offset:10240
v_pk_fma_f16 v151, v152, v152, s48
v_pk_fma_f16 v148, v149, v149, s48
v_and_b32_e64 v139, s49, v139
v_pk_fma_f16 v145, v146, v146, s48
v_mfma_f32_32x32x16_bf16 v[120:135], v[52:55], v[224:227], v[120:135]
ds_read_b64 v[220:221], v245 offset:3072
ds_read_b64 v[222:223], v246 offset:3072
ds_read_b128 v[196:199], v243 offset:64
v_pk_mul_f16 v154, v155, v154
v_bfe_u32 v136, v137, 2, 14
v_pk_mul_f16 v151, v152, v151
v_pk_mul_f16 v148, v149, v148
v_bfe_u32 v138, v139, 2, 14
v_pk_mul_f16 v145, v146, v145
v_mfma_f32_16x16x32_bf16 v[32:35], v[228:231], v[212:215], 0
ds_read_b128 v[224:227], v249 offset:8192
ds_read_u16_d16 v136, v136
ds_read_u16_d16 v138, v138
v_exp_f16 v153, v154
v_lshrrev_b32 v137, 18, v137
v_exp_f16 v150, v151
s_waitcnt lgkmcnt(7)
v_mfma_f32_32x32x16_bf16 v[120:135], v[56:59], v[232:235], v[120:135]
ds_read_b64 v[228:229], v245 offset:3840
ds_read_b64 v[230:231], v246 offset:3840
ds_read_b128 v[200:203], v243 offset:128
ds_read_u16_d16_hi v137, v137
v_lshrrev_b32 v139, 18, v139
v_exp_f16 v147, v148
s_setprio 0
v_and_b32 v141, s49, v141
v_exp_f16 v144, v145
v_and_b32 v143, s49, v143
v_mfma_f32_16x16x32_bf16 v[0:3], v[236:239], v[192:195], v[0:3]
ds_read_b64 v[232:233], v245 offset:4608
ds_read_b64 v[234:235], v246 offset:4608
v_xor_b32 v244, 16, v244
ds_read_b128 v[204:207], v244
ds_read_u16_d16_hi v139, v139
v_exp_f16_sdwa v153, v154 dst_sel:WORD_1 dst_unused:UNUSED_PRESERVE src0_sel:WORD_1
v_bfe_u32 v140, v141, 2, 14
s_waitcnt lgkmcnt(9)
v_mfma_f32_32x32x16_bf16 v[120:135], v[60:63], v[216:219], v[120:135]
ds_read_b128 v[236:239], v249 offset:11264
ds_read_u16_d16 v140, v140
v_exp_f16_sdwa v150, v151 dst_sel:WORD_1 dst_unused:UNUSED_PRESERVE src0_sel:WORD_1
v_bfe_u32 v142, v143, 2, 14
v_exp_f16_sdwa v147, v148 dst_sel:WORD_1 dst_unused:UNUSED_PRESERVE src0_sel:WORD_1
v_lshrrev_b32_e64 v141, 18, v141
v_exp_f16_sdwa v144, v145 dst_sel:WORD_1 dst_unused:UNUSED_PRESERVE src0_sel:WORD_1
v_mfma_f32_16x16x32_bf16 v[16:19], v[220:223], v[196:199], v[16:19]
ds_read_b64 v[216:217], v245 offset:5376
ds_read_b64 v[218:219], v246 offset:5376
ds_read_b128 v[208:211], v244 offset:64
ds_read_u16_d16 v142, v142
ds_read_u16_d16_hi v141, v141
v_lshrrev_b32_e64 v143, 18, v143
v_pk_add_f16 v153, v153, 1.0 op_sel_hi:[1,0]
v_pk_add_f16 v150, v150, 1.0 op_sel_hi:[1,0]
v_pk_add_f16 v147, v147, 1.0 op_sel_hi:[1,0]
v_mfma_f32_32x32x16_bf16 v[120:135], v[64:67], v[224:227], v[120:135]
ds_read_b64 v[220:221], v245 offset:6144
ds_read_b64 v[222:223], v246 offset:6144
ds_read_b128 v[212:215], v244 offset:128
ds_read_u16_d16_hi v143, v143
v_pk_add_f16 v144, v144, 1.0 op_sel_hi:[1,0]
v_rcp_f16 v154, v153
v_rcp_f16 v151, v150
v_rcp_f16 v148, v147
s_waitcnt lgkmcnt(9)
v_mfma_f32_16x16x32_bf16 v[32:35], v[228:231], v[200:203], v[32:35]
ds_read_b128 v[224:227], v249 offset:12288
v_rcp_f16 v145, v144
v_mfma_f32_16x16x32_bf16 v[0:3], v[232:235], v[204:207], v[0:3]
ds_read_b128 v[228:231], v249 offset:15360
v_rcp_f16_sdwa v154, v153 dst_sel:WORD_1 dst_unused:UNUSED_PRESERVE src0_sel:WORD_1
v_rcp_f16_sdwa v151, v150 dst_sel:WORD_1 dst_unused:UNUSED_PRESERVE src0_sel:WORD_1
v_mfma_f32_32x32x16_bf16 v[120:135], v[68:71], v[236:239], v[120:135]
ds_read_b128 v[232:235], v249 offset:13312
v_rcp_f16_sdwa v148, v147 dst_sel:WORD_1 dst_unused:UNUSED_PRESERVE src0_sel:WORD_1
v_fma_mix_f32 v164, v136, v136, 0 op_sel:[0,0,0] op_sel_hi:[1,1,0]
v_rcp_f16_sdwa v145, v144 dst_sel:WORD_1 dst_unused:UNUSED_PRESERVE src0_sel:WORD_1
v_fma_mix_f32 v164, v137, v137, v164 op_sel:[1,1,0] op_sel_hi:[1,1,0]
v_pk_mul_f16 v155, v155, v154
v_fma_mix_f32 v164, v138, v138, v164 op_sel:[0,0,0] op_sel_hi:[1,1,0]
s_waitcnt lgkmcnt(7)
v_mfma_f32_16x16x32_bf16 v[16:19], v[216:219], v[208:211], v[16:19]
ds_read_b128 v[236:239], v249 offset:16384
v_pk_mul_f16 v152, v152, v151
v_pk_mul_f16 v149, v149, v148
v_fma_mix_f32 v164, v139, v139, v164 op_sel:[1,1,0] op_sel_hi:[1,1,0]
v_pk_mul_f16 v146, v146, v145
s_waitcnt lgkmcnt(4)
v_mfma_f32_16x16x32_bf16 v[32:35], v[220:223], v[212:215], v[32:35]
ds_read_b128 v[216:219], v249 offset:14336
v_fma_mix_f32 v164, v155, v155, v164 op_sel:[0,0,0] op_sel_hi:[1,1,0]
v_fma_mix_f32 v164, v140, v140, v164 op_sel:[0,0,0] op_sel_hi:[1,1,0]
v_fma_mix_f32 v164, v155, v155, v164 op_sel:[1,1,0] op_sel_hi:[1,1,0]
v_fma_mix_f32 v164, v152, v152, v164 op_sel:[0,0,0] op_sel_hi:[1,1,0]
v_fma_mix_f32 v164, v141, v141, v164 op_sel:[1,1,0] op_sel_hi:[1,1,0]
v_fma_mix_f32 v164, v152, v152, v164 op_sel:[1,1,0] op_sel_hi:[1,1,0]
v_fma_mix_f32 v164, v149, v149, v164 op_sel:[0,0,0] op_sel_hi:[1,1,0]
v_fma_mix_f32 v164, v142, v142, v164 op_sel:[0,0,0] op_sel_hi:[1,1,0]
v_fma_mix_f32 v164, v149, v149, v164 op_sel:[1,1,0] op_sel_hi:[1,1,0]
v_fma_mix_f32 v164, v146, v146, v164 op_sel:[0,0,0] op_sel_hi:[1,1,0]
v_fma_mix_f32 v164, v143, v143, v164 op_sel:[1,1,0] op_sel_hi:[1,1,0]
v_fma_mix_f32 v164, v146, v146, v164 op_sel:[1,1,0] op_sel_hi:[1,1,0]
s_setprio 3
v_pk_add_f32 v[168:169], v[0:1], v[2:3]
v_pk_mul_f32 v[170:171], v[0:1], v[0:1]
v_pk_fma_f32 v[170:171], v[2:3], v[2:3], v[170:171]
v_pk_add_f32 v[168:169], v[168:169], v[4:5]
v_pk_fma_f32 v[170:171], v[4:5], v[4:5], v[170:171]
v_pk_add_f32 v[168:169], v[168:169], v[6:7]
v_pk_fma_f32 v[170:171], v[6:7], v[6:7], v[170:171]
v_pk_add_f32 v[168:169], v[168:169], v[8:9]
v_pk_fma_f32 v[170:171], v[8:9], v[8:9], v[170:171]
v_pk_add_f32 v[168:169], v[168:169], v[10:11]
v_pk_fma_f32 v[170:171], v[10:11], v[10:11], v[170:171]
v_pk_add_f32 v[168:169], v[168:169], v[12:13]
v_pk_fma_f32 v[170:171], v[12:13], v[12:13], v[170:171]
v_pk_add_f32 v[168:169], v[168:169], v[14:15]
v_pk_fma_f32 v[170:171], v[14:15], v[14:15], v[170:171]
v_pk_add_f32 v[168:169], v[168:169], v[16:17]
v_pk_fma_f32 v[170:171], v[16:17], v[16:17], v[170:171]
v_pk_add_f32 v[168:169], v[168:169], v[18:19]
v_pk_fma_f32 v[170:171], v[18:19], v[18:19], v[170:171]
v_pk_add_f32 v[168:169], v[168:169], v[20:21]
v_pk_fma_f32 v[170:171], v[20:21], v[20:21], v[170:171]
v_pk_add_f32 v[168:169], v[168:169], v[22:23]
v_pk_fma_f32 v[170:171], v[22:23], v[22:23], v[170:171]
v_pk_add_f32 v[168:169], v[168:169], v[24:25]
v_pk_fma_f32 v[170:171], v[24:25], v[24:25], v[170:171]
v_pk_add_f32 v[168:169], v[168:169], v[26:27]
v_pk_fma_f32 v[170:171], v[26:27], v[26:27], v[170:171]
v_pk_add_f32 v[168:169], v[168:169], v[28:29]
v_pk_fma_f32 v[170:171], v[28:29], v[28:29], v[170:171]
v_pk_add_f32 v[168:169], v[168:169], v[30:31]
v_pk_fma_f32 v[170:171], v[30:31], v[30:31], v[170:171]
v_pk_add_f32 v[168:169], v[168:169], v[32:33]
v_pk_fma_f32 v[170:171], v[32:33], v[32:33], v[170:171]
v_pk_add_f32 v[168:169], v[168:169], v[34:35]
v_pk_fma_f32 v[170:171], v[34:35], v[34:35], v[170:171]
v_pk_add_f32 v[168:169], v[168:169], v[36:37]
v_pk_fma_f32 v[170:171], v[36:37], v[36:37], v[170:171]
v_pk_add_f32 v[168:169], v[168:169], v[38:39]
v_pk_fma_f32 v[170:171], v[38:39], v[38:39], v[170:171]
v_pk_add_f32 v[168:169], v[168:169], v[40:41]
v_pk_fma_f32 v[170:171], v[40:41], v[40:41], v[170:171]
v_pk_add_f32 v[168:169], v[168:169], v[42:43]
v_pk_fma_f32 v[170:171], v[42:43], v[42:43], v[170:171]
v_pk_add_f32 v[168:169], v[168:169], v[44:45]
v_pk_fma_f32 v[170:171], v[44:45], v[44:45], v[170:171]
v_pk_add_f32 v[168:169], v[168:169], v[46:47]
v_pk_fma_f32 v[170:171], v[46:47], v[46:47], v[170:171]
s_setprio 0
s_barrier
v_add_u32 v247, -36864, v242
v_subrev_u32 v252, 66560, v247
v_min_u32_e64 v247, v247, v252
v_add_u32 v247, 90112, v247
v_sub_u32 v252, v247, v242
v_add_u32 v242, v252, v242
v_add_u32_e64 v243, v252, v243
v_add_u32 v244, v252, v244
s_setprio 2
v_cvt_pkrtz_f16_f32 v137, v120, v121
v_cvt_pkrtz_f16_f32 v139, v122, v123
v_cvt_pkrtz_f16_f32 v141, v124, v125
v_cvt_pkrtz_f16_f32 v143, v126, v127
v_cvt_pkrtz_f16_f32 v145, v128, v129
v_cvt_pk_f16_f32 v155, v130, v131
v_cvt_pk_f16_f32 v152, v132, v133
v_cvt_pk_f16_f32 v149, v134, v135
s_waitcnt lgkmcnt(0)
s_add_u32 m0, s67, 53248
s_add_u32 s66, s66, 98304
buffer_load_dwordx4 v240, s[4:7], s66 offen lds
ds_read_b128 v[220:223], v249 offset:17408
v_mfma_f32_32x32x16_bf16 v[120:135], v[48:51], v[224:227], 0
v_pk_fma_f16 v154, v155, v155, s48
v_add_f32 v168, v168, v169
v_and_b32_e64 v137, s49, v137
v_pk_fma_f16 v151, v152, v152, s48
v_and_b32_e64 v139, s49, v139
v_pk_fma_f16 v148, v149, v149, s48
v_add_f32_e64 v170, v170, v171
v_pk_mul_f16 v154, v155, v154
v_bfe_u32 v136, v137, 2, 14
v_pk_mul_f16 v151, v152, v151
v_pk_mul_f16 v148, v149, v148
v_bfe_u32 v138, v139, 2, 14
ds_read_b128 v[224:227], v249 offset:18432
ds_read_u16_d16 v136, v136
ds_read_u16_d16 v138, v138
v_mfma_f32_32x32x16_bf16 v[120:135], v[52:55], v[228:231], v[120:135]
v_permlane32_swap_b32 v168, v170
v_exp_f16 v153, v154
v_lshrrev_b32 v137, 18, v137
v_exp_f16 v150, v151
v_add_f32 v168, v168, v170
v_lshrrev_b32 v139, 18, v139
v_exp_f16 v147, v148
v_and_b32 v141, s49, v141
v_and_b32_e64 v143, s49, v143
v_mul_f32 v168, 1009429163, v168
s_add_u32 m0, s67, 59904
s_add_u32 s66, s66, 98304
buffer_load_dwordx4 v240, s[4:7], s66 offen lds
ds_read_b128 v[228:231], v249 offset:21504
ds_read_u16_d16_hi v137, v137
ds_read_u16_d16_hi v139, v139
v_mfma_f32_32x32x16_bf16 v[120:135], v[56:59], v[232:235], v[120:135]
v_exp_f16_sdwa v153, v154 dst_sel:WORD_1 dst_unused:UNUSED_PRESERVE src0_sel:WORD_1
v_bfe_u32 v140, v141, 2, 14
v_exp_f16_sdwa v150, v151 dst_sel:WORD_1 dst_unused:UNUSED_PRESERVE src0_sel:WORD_1
v_mov_b32_e64 v170, v168
v_bfe_u32 v142, v143, 2, 14
v_exp_f16_sdwa v147, v148 dst_sel:WORD_1 dst_unused:UNUSED_PRESERVE src0_sel:WORD_1
v_lshrrev_b32 v141, 18, v141
v_permlane32_swap_b32 v168, v170
v_pk_add_f16 v153, v153, 1.0 op_sel_hi:[1,0]
ds_read_b128 v[232:235], v249 offset:19456
ds_read_u16_d16 v140, v140
ds_read_u16_d16 v142, v142
ds_read_u16_d16_hi v141, v141
v_mfma_f32_32x32x16_bf16 v[120:135], v[60:63], v[236:239], v[120:135]
v_lshrrev_b32_e64 v143, 18, v143
v_pk_add_f16 v150, v150, 1.0 op_sel_hi:[1,0]
v_pk_add_f16 v147, v147, 1.0 op_sel_hi:[1,0]
v_and_b32_e64 v145, s49, v145
v_fma_f32 v170, -v168, v168, v170
v_rcp_f16_e64 v154, v153
v_bfe_u32 v144, v145, 2, 14
v_rcp_f16 v151, v150
v_max_f32 v170, 0, v170
v_lshrrev_b32 v145, 18, v145
s_add_u32 m0, s67, 0
s_add_u32 s66, s66, 98304
buffer_load_dwordx4 v240, s[4:7], s66 offen lds
ds_read_b128 v[236:239], v249 offset:22528
ds_read_u16_d16_hi v143, v143
ds_read_u16_d16 v144, v144
ds_read_u16_d16_hi v145, v145
v_mfma_f32_32x32x16_bf16 v[120:135], v[64:67], v[216:219], v[120:135]
v_rcp_f16 v148, v147
v_rcp_f16_sdwa v154, v153 dst_sel:WORD_1 dst_unused:UNUSED_PRESERVE src0_sel:WORD_1
v_add_f32 v170, 925353388, v170
s_waitcnt lgkmcnt(6)
v_fma_mix_f32 v165, v136, v136, 0 op_sel:[0,0,0] op_sel_hi:[1,1,0]
v_fma_mix_f32 v165, v137, v137, v165 op_sel:[1,1,0] op_sel_hi:[1,1,0]
v_rcp_f16_sdwa v151, v150 dst_sel:WORD_1 dst_unused:UNUSED_PRESERVE src0_sel:WORD_1
v_rsq_f32_e64 v170, v170
v_fma_mix_f32 v165, v138, v138, v165 op_sel:[0,0,0] op_sel_hi:[1,1,0]
ds_read_b128 v[216:219], v249 offset:20480
v_mfma_f32_32x32x16_bf16 v[120:135], v[68:71], v[220:223], v[120:135]
v_rcp_f16_sdwa v148, v147 dst_sel:WORD_1 dst_unused:UNUSED_PRESERVE src0_sel:WORD_1
v_fma_mix_f32 v165, v139, v139, v165 op_sel:[1,1,0] op_sel_hi:[1,1,0]
v_pk_mul_f16 v155, v155, v154
v_fma_mix_f32 v165, v140, v140, v165 op_sel:[0,0,0] op_sel_hi:[1,1,0]
v_pk_mul_f16 v152, v152, v151
s_waitcnt lgkmcnt(5)
v_fma_mix_f32 v165, v141, v141, v165 op_sel:[1,1,0] op_sel_hi:[1,1,0]
v_pk_mul_f16 v149, v149, v148
v_fma_mix_f32 v165, v155, v155, v165 op_sel:[0,0,0] op_sel_hi:[1,1,0]
v_mul_f32 v172, 3203391086, v170
v_fma_mix_f32 v165, v142, v142, v165 op_sel:[0,0,0] op_sel_hi:[1,1,0]
v_fma_mix_f32 v165, v155, v155, v165 op_sel:[1,1,0] op_sel_hi:[1,1,0]
s_waitcnt lgkmcnt(1)
v_fma_mix_f32 v165, v143, v143, v165 op_sel:[1,1,0] op_sel_hi:[1,1,0]
v_fma_mix_f32 v165, v152, v152, v165 op_sel:[0,0,0] op_sel_hi:[1,1,0]
v_fma_mix_f32 v165, v152, v152, v165 op_sel:[1,1,0] op_sel_hi:[1,1,0]
v_mul_f32 v173, v168, v172
v_fma_mix_f32 v165, v144, v144, v165 op_sel:[0,0,0] op_sel_hi:[1,1,0]
v_fma_mix_f32 v165, v149, v149, v165 op_sel:[0,0,0] op_sel_hi:[1,1,0]
v_fma_mix_f32 v165, v145, v145, v165 op_sel:[1,1,0] op_sel_hi:[1,1,0]
v_fma_mix_f32 v165, v149, v149, v165 op_sel:[1,1,0] op_sel_hi:[1,1,0]
s_setprio 3
v_pk_fma_f32 v[0:1], v[0:1], v[172:173], v[172:173] op_sel:[0,0,1] op_sel_hi:[1,0,1] neg_lo:[0,0,1] neg_hi:[0,0,1]
v_pk_fma_f32 v[2:3], v[2:3], v[172:173], v[172:173] op_sel:[0,0,1] op_sel_hi:[1,0,1] neg_lo:[0,0,1] neg_hi:[0,0,1]
v_pk_fma_f32 v[4:5], v[4:5], v[172:173], v[172:173] op_sel:[0,0,1] op_sel_hi:[1,0,1] neg_lo:[0,0,1] neg_hi:[0,0,1]
v_pk_fma_f32 v[6:7], v[6:7], v[172:173], v[172:173] op_sel:[0,0,1] op_sel_hi:[1,0,1] neg_lo:[0,0,1] neg_hi:[0,0,1]
v_pk_fma_f32 v[8:9], v[8:9], v[172:173], v[172:173] op_sel:[0,0,1] op_sel_hi:[1,0,1] neg_lo:[0,0,1] neg_hi:[0,0,1]
v_pk_fma_f32 v[10:11], v[10:11], v[172:173], v[172:173] op_sel:[0,0,1] op_sel_hi:[1,0,1] neg_lo:[0,0,1] neg_hi:[0,0,1]
v_pk_fma_f32 v[12:13], v[12:13], v[172:173], v[172:173] op_sel:[0,0,1] op_sel_hi:[1,0,1] neg_lo:[0,0,1] neg_hi:[0,0,1]
v_pk_fma_f32 v[14:15], v[14:15], v[172:173], v[172:173] op_sel:[0,0,1] op_sel_hi:[1,0,1] neg_lo:[0,0,1] neg_hi:[0,0,1]
v_pk_fma_f32 v[16:17], v[16:17], v[172:173], v[172:173] op_sel:[0,0,1] op_sel_hi:[1,0,1] neg_lo:[0,0,1] neg_hi:[0,0,1]
v_pk_fma_f32 v[18:19], v[18:19], v[172:173], v[172:173] op_sel:[0,0,1] op_sel_hi:[1,0,1] neg_lo:[0,0,1] neg_hi:[0,0,1]
v_pk_fma_f32 v[20:21], v[20:21], v[172:173], v[172:173] op_sel:[0,0,1] op_sel_hi:[1,0,1] neg_lo:[0,0,1] neg_hi:[0,0,1]
v_pk_fma_f32 v[22:23], v[22:23], v[172:173], v[172:173] op_sel:[0,0,1] op_sel_hi:[1,0,1] neg_lo:[0,0,1] neg_hi:[0,0,1]
v_pk_fma_f32 v[24:25], v[24:25], v[172:173], v[172:173] op_sel:[0,0,1] op_sel_hi:[1,0,1] neg_lo:[0,0,1] neg_hi:[0,0,1]
v_pk_fma_f32 v[26:27], v[26:27], v[172:173], v[172:173] op_sel:[0,0,1] op_sel_hi:[1,0,1] neg_lo:[0,0,1] neg_hi:[0,0,1]
v_pk_fma_f32 v[28:29], v[28:29], v[172:173], v[172:173] op_sel:[0,0,1] op_sel_hi:[1,0,1] neg_lo:[0,0,1] neg_hi:[0,0,1]
v_pk_fma_f32 v[30:31], v[30:31], v[172:173], v[172:173] op_sel:[0,0,1] op_sel_hi:[1,0,1] neg_lo:[0,0,1] neg_hi:[0,0,1]
v_pk_fma_f32 v[32:33], v[32:33], v[172:173], v[172:173] op_sel:[0,0,1] op_sel_hi:[1,0,1] neg_lo:[0,0,1] neg_hi:[0,0,1]
v_pk_fma_f32 v[34:35], v[34:35], v[172:173], v[172:173] op_sel:[0,0,1] op_sel_hi:[1,0,1] neg_lo:[0,0,1] neg_hi:[0,0,1]
v_pk_fma_f32 v[36:37], v[36:37], v[172:173], v[172:173] op_sel:[0,0,1] op_sel_hi:[1,0,1] neg_lo:[0,0,1] neg_hi:[0,0,1]
v_pk_fma_f32 v[38:39], v[38:39], v[172:173], v[172:173] op_sel:[0,0,1] op_sel_hi:[1,0,1] neg_lo:[0,0,1] neg_hi:[0,0,1]
v_pk_fma_f32 v[40:41], v[40:41], v[172:173], v[172:173] op_sel:[0,0,1] op_sel_hi:[1,0,1] neg_lo:[0,0,1] neg_hi:[0,0,1]
v_pk_fma_f32 v[42:43], v[42:43], v[172:173], v[172:173] op_sel:[0,0,1] op_sel_hi:[1,0,1] neg_lo:[0,0,1] neg_hi:[0,0,1]
v_pk_fma_f32 v[44:45], v[44:45], v[172:173], v[172:173] op_sel:[0,0,1] op_sel_hi:[1,0,1] neg_lo:[0,0,1] neg_hi:[0,0,1]
v_pk_fma_f32 v[46:47], v[46:47], v[172:173], v[172:173] op_sel:[0,0,1] op_sel_hi:[1,0,1] neg_lo:[0,0,1] neg_hi:[0,0,1]
s_setprio 2
v_cvt_pkrtz_f16_f32 v137, v120, v121
v_cvt_pkrtz_f16_f32 v139, v122, v123
v_cvt_pkrtz_f16_f32 v141, v124, v125
v_cvt_pkrtz_f16_f32 v143, v126, v127
v_cvt_pkrtz_f16_f32 v145, v128, v129
v_cvt_pk_f16_f32 v155, v130, v131
v_cvt_pk_f16_f32 v152, v132, v133
v_cvt_pk_f16_f32 v149, v134, v135
s_add_u32 m0, s67, 6656
s_add_u32 s66, s66, 98304
buffer_load_dwordx4 v240, s[4:7], s66 offen lds
ds_read_b128 v[220:223], v249 offset:23552
v_mfma_f32_32x32x16_bf16 v[120:135], v[48:51], v[224:227], 0
v_pk_fma_f16 v154, v155, v155, s48
v_cvt_pk_bf16_f32 v72, v0, v1
v_and_b32 v137, s49, v137
v_pk_fma_f16 v151, v152, v152, s48
v_cvt_pk_bf16_f32 v73, v2, v3
v_and_b32_e64 v139, s49, v139
v_pk_fma_f16 v148, v149, v149, s48
v_pk_mul_f16 v154, v155, v154
v_cvt_pk_bf16_f32 v74, v4, v5
v_bfe_u32 v136, v137, 2, 14
v_pk_mul_f16 v151, v152, v151
v_pk_mul_f16 v148, v149, v148
v_cvt_pk_bf16_f32 v75, v6, v7
v_bfe_u32 v138, v139, 2, 14
ds_read_b128 v[224:227], v248 offset:16384
ds_read_u16_d16 v136, v136
ds_read_u16_d16 v138, v138
v_mfma_f32_32x32x16_bf16 v[120:135], v[52:55], v[228:231], v[120:135]
v_exp_f16_e64 v153, v154
v_cvt_pk_bf16_f32 v76, v8, v9
v_lshrrev_b32 v137, 18, v137
v_exp_f16 v150, v151
v_cvt_pk_bf16_f32 v77, v10, v11
v_lshrrev_b32 v139, 18, v139
v_exp_f16 v147, v148
v_cvt_pk_bf16_f32 v78, v12, v13
v_and_b32 v141, s49, v141
v_and_b32 v143, s49, v143
v_cvt_pk_bf16_f32 v79, v14, v15
s_add_u32 m0, s67, 13312
s_add_u32 s66, s66, 98304
buffer_load_dwordx4 v240, s[4:7], s66 offen lds
ds_read_b128 v[228:231], v248 offset:19456
ds_read_u16_d16_hi v137, v137
ds_read_u16_d16_hi v139, v139
v_mfma_f32_32x32x16_bf16 v[120:135], v[56:59], v[232:235], v[120:135]
v_exp_f16_sdwa v153, v154 dst_sel:WORD_1 dst_unused:UNUSED_PRESERVE src0_sel:WORD_1
v_bfe_u32 v140, v141, 2, 14
v_cvt_pk_bf16_f32 v80, v16, v17
v_exp_f16_sdwa v150, v151 dst_sel:WORD_1 dst_unused:UNUSED_PRESERVE src0_sel:WORD_1
v_bfe_u32 v142, v143, 2, 14
v_cvt_pk_bf16_f32 v81, v18, v19
v_exp_f16_sdwa v147, v148 dst_sel:WORD_1 dst_unused:UNUSED_PRESERVE src0_sel:WORD_1
v_cvt_pk_bf16_f32 v82, v20, v21
v_lshrrev_b32_e64 v141, 18, v141
v_pk_add_f16 v153, v153, 1.0 op_sel_hi:[1,0]
v_lshrrev_b32_e64 v143, 18, v143
ds_read_b128 v[232:235], v248 offset:17408
ds_read_u16_d16 v140, v140
ds_read_u16_d16 v142, v142
ds_read_u16_d16_hi v141, v141
ds_read_u16_d16_hi v143, v143
v_mfma_f32_32x32x16_bf16 v[120:135], v[60:63], v[236:239], v[120:135]
v_cvt_pk_bf16_f32 v83, v22, v23
v_pk_add_f16 v150, v150, 1.0 op_sel_hi:[1,0]
v_pk_add_f16 v147, v147, 1.0 op_sel_hi:[1,0]
v_and_b32_e64 v145, s49, v145
v_cvt_pk_bf16_f32 v84, v24, v25
v_rcp_f16_e64 v154, v153
v_bfe_u32 v144, v145, 2, 14
v_cvt_pk_bf16_f32 v85, v26, v27
v_rcp_f16_e64 v151, v150
v_lshrrev_b32 v145, 18, v145
v_cvt_pk_bf16_f32 v86, v28, v29
s_waitcnt lgkmcnt(5)
s_add_u32 m0, s67, 19968
s_add_u32 s66, s66, 98304
buffer_load_dwordx4 v240, s[4:7], s66 offen lds
ds_read_b128 v[236:239], v248 offset:20480
ds_read_u16_d16 v144, v144
ds_read_u16_d16_hi v145, v145
v_mfma_f32_32x32x16_bf16 v[120:135], v[64:67], v[216:219], v[120:135]
v_rcp_f16_e64 v148, v147
v_cvt_pk_bf16_f32 v87, v30, v31
v_rcp_f16_sdwa v154, v153 dst_sel:WORD_1 dst_unused:UNUSED_PRESERVE src0_sel:WORD_1
v_fma_mix_f32 v166, v136, v136, 0 op_sel:[0,0,0] op_sel_hi:[1,1,0]
v_cvt_pk_bf16_f32 v88, v32, v33
v_fma_mix_f32 v166, v137, v137, v166 op_sel:[1,1,0] op_sel_hi:[1,1,0]
v_rcp_f16_sdwa v151, v150 dst_sel:WORD_1 dst_unused:UNUSED_PRESERVE src0_sel:WORD_1
v_cvt_pk_bf16_f32 v89, v34, v35
v_fma_mix_f32 v166, v138, v138, v166 op_sel:[0,0,0] op_sel_hi:[1,1,0]
v_rcp_f16_sdwa v148, v147 dst_sel:WORD_1 dst_unused:UNUSED_PRESERVE src0_sel:WORD_1
v_cvt_pk_bf16_f32 v90, v36, v37
ds_read_b128 v[216:219], v248 offset:18432
v_mfma_f32_32x32x16_bf16 v[120:135], v[68:71], v[220:223], v[120:135]
v_fma_mix_f32 v166, v139, v139, v166 op_sel:[1,1,0] op_sel_hi:[1,1,0]
v_pk_mul_f16 v155, v155, v154
s_waitcnt lgkmcnt(4)
v_fma_mix_f32 v166, v140, v140, v166 op_sel:[0,0,0] op_sel_hi:[1,1,0]
v_cvt_pk_bf16_f32 v91, v38, v39
v_pk_mul_f16 v152, v152, v151
v_fma_mix_f32 v166, v141, v141, v166 op_sel:[1,1,0] op_sel_hi:[1,1,0]
v_cvt_pk_bf16_f32 v92, v40, v41
v_pk_mul_f16 v149, v149, v148
v_fma_mix_f32 v166, v155, v155, v166 op_sel:[0,0,0] op_sel_hi:[1,1,0]
v_fma_mix_f32 v166, v142, v142, v166 op_sel:[0,0,0] op_sel_hi:[1,1,0]
v_cvt_pk_bf16_f32 v93, v42, v43
v_fma_mix_f32 v166, v155, v155, v166 op_sel:[1,1,0] op_sel_hi:[1,1,0]
v_fma_mix_f32 v166, v143, v143, v166 op_sel:[1,1,0] op_sel_hi:[1,1,0]
v_fma_mix_f32 v166, v152, v152, v166 op_sel:[0,0,0] op_sel_hi:[1,1,0]
v_cvt_pk_bf16_f32 v94, v44, v45
v_fma_mix_f32 v166, v152, v152, v166 op_sel:[1,1,0] op_sel_hi:[1,1,0]
s_waitcnt lgkmcnt(1)
v_fma_mix_f32 v166, v144, v144, v166 op_sel:[0,0,0] op_sel_hi:[1,1,0]
v_fma_mix_f32 v166, v149, v149, v166 op_sel:[0,0,0] op_sel_hi:[1,1,0]
v_cvt_pk_bf16_f32 v95, v46, v47
v_fma_mix_f32 v166, v145, v145, v166 op_sel:[1,1,0] op_sel_hi:[1,1,0]
v_fma_mix_f32 v166, v149, v149, v166 op_sel:[1,1,0] op_sel_hi:[1,1,0]
v_cvt_pkrtz_f16_f32 v137, v120, v121
v_cvt_pkrtz_f16_f32 v139, v122, v123
v_cvt_pkrtz_f16_f32 v141, v124, v125
v_cvt_pkrtz_f16_f32 v143, v126, v127
v_cvt_pkrtz_f16_f32 v145, v128, v129
v_cvt_pk_f16_f32 v155, v130, v131
v_cvt_pk_f16_f32 v152, v132, v133
v_cvt_pk_f16_f32 v149, v134, v135
s_add_u32 m0, s67, 26624
s_add_u32 s66, s66, 98304
buffer_load_dwordx4 v240, s[4:7], s66 offen lds
ds_read_b128 v[220:223], v248 offset:21504
v_mfma_f32_32x32x16_bf16 v[120:135], v[72:75], v[224:227], 0
v_pk_fma_f16 v154, v155, v155, s48
v_and_b32_e64 v137, s49, v137
v_pk_fma_f16 v151, v152, v152, s48
v_and_b32_e64 v139, s49, v139
v_pk_fma_f16 v148, v149, v149, s48
v_pk_mul_f16 v154, v155, v154
v_bfe_u32 v136, v137, 2, 14
v_pk_mul_f16 v151, v152, v151
v_pk_mul_f16 v148, v149, v148
v_bfe_u32 v138, v139, 2, 14
ds_read_b128 v[224:227], v248 offset:22528
ds_read_u16_d16 v136, v136
ds_read_u16_d16 v138, v138
v_mfma_f32_32x32x16_bf16 v[120:135], v[76:79], v[228:231], v[120:135]
v_exp_f16 v153, v154
v_lshrrev_b32 v137, 18, v137
v_exp_f16 v150, v151
v_lshrrev_b32 v139, 18, v139
v_exp_f16 v147, v148
v_and_b32 v141, s49, v141
v_and_b32_e64 v143, s49, v143
ds_read_b128 v[228:231], v248 offset:25600
ds_read_u16_d16_hi v137, v137
ds_read_u16_d16_hi v139, v139
v_mfma_f32_32x32x16_bf16 v[120:135], v[80:83], v[232:235], v[120:135]
v_exp_f16_sdwa v153, v154 dst_sel:WORD_1 dst_unused:UNUSED_PRESERVE src0_sel:WORD_1
v_bfe_u32 v140, v141, 2, 14
v_exp_f16_sdwa v150, v151 dst_sel:WORD_1 dst_unused:UNUSED_PRESERVE src0_sel:WORD_1
v_bfe_u32 v142, v143, 2, 14
v_exp_f16_sdwa v147, v148 dst_sel:WORD_1 dst_unused:UNUSED_PRESERVE src0_sel:WORD_1
v_lshrrev_b32_e64 v141, 18, v141
v_pk_add_f16 v153, v153, 1.0 op_sel_hi:[1,0]
s_add_u32 m0, s67, 33280
s_add_u32 s66, s66, 98304
buffer_load_dwordx4 v240, s[4:7], s66 offen lds
ds_read_b128 v[232:235], v248 offset:23552
ds_read_u16_d16 v140, v140
ds_read_u16_d16 v142, v142
ds_read_u16_d16_hi v141, v141
v_mfma_f32_32x32x16_bf16 v[120:135], v[84:87], v[236:239], v[120:135]
v_lshrrev_b32_e64 v143, 18, v143
v_pk_add_f16 v150, v150, 1.0 op_sel_hi:[1,0]
v_pk_add_f16 v147, v147, 1.0 op_sel_hi:[1,0]
v_and_b32 v145, s49, v145
v_rcp_f16 v154, v153
v_bfe_u32 v144, v145, 2, 14
v_rcp_f16_e64 v151, v150
v_lshrrev_b32 v145, 18, v145
s_waitcnt lgkmcnt(4)
ds_read_b128 v[236:239], v248 offset:26624
ds_read_u16_d16_hi v143, v143
ds_read_u16_d16 v144, v144
ds_read_u16_d16_hi v145, v145
v_mfma_f32_32x32x16_bf16 v[120:135], v[88:91], v[216:219], v[120:135]
v_rcp_f16_e64 v148, v147
v_rcp_f16_sdwa v154, v153 dst_sel:WORD_1 dst_unused:UNUSED_PRESERVE src0_sel:WORD_1
v_fma_mix_f32 v167, v136, v136, 0 op_sel:[0,0,0] op_sel_hi:[1,1,0]
v_fma_mix_f32 v167, v137, v137, v167 op_sel:[1,1,0] op_sel_hi:[1,1,0]
v_rcp_f16_sdwa v151, v150 dst_sel:WORD_1 dst_unused:UNUSED_PRESERVE src0_sel:WORD_1
v_fma_mix_f32 v167, v138, v138, v167 op_sel:[0,0,0] op_sel_hi:[1,1,0]
s_setprio 1
ds_read_b128 v[216:219], v248 offset:24576
v_mfma_f32_32x32x16_bf16 v[120:135], v[92:95], v[220:223], v[120:135]
v_rcp_f16_sdwa v148, v147 dst_sel:WORD_1 dst_unused:UNUSED_PRESERVE src0_sel:WORD_1
v_fma_mix_f32 v167, v139, v139, v167 op_sel:[1,1,0] op_sel_hi:[1,1,0]
v_pk_mul_f16 v155, v155, v154
s_waitcnt lgkmcnt(5)
v_fma_mix_f32 v167, v140, v140, v167 op_sel:[0,0,0] op_sel_hi:[1,1,0]
v_pk_mul_f16 v152, v152, v151
v_fma_mix_f32 v167, v141, v141, v167 op_sel:[1,1,0] op_sel_hi:[1,1,0]
v_pk_mul_f16 v149, v149, v148
v_fma_mix_f32 v167, v155, v155, v167 op_sel:[0,0,0] op_sel_hi:[1,1,0]
v_fma_mix_f32 v167, v142, v142, v167 op_sel:[0,0,0] op_sel_hi:[1,1,0]
v_fma_mix_f32 v167, v155, v155, v167 op_sel:[1,1,0] op_sel_hi:[1,1,0]
s_waitcnt lgkmcnt(3)
v_fma_mix_f32 v167, v143, v143, v167 op_sel:[1,1,0] op_sel_hi:[1,1,0]
v_fma_mix_f32 v167, v152, v152, v167 op_sel:[0,0,0] op_sel_hi:[1,1,0]
v_fma_mix_f32 v167, v152, v152, v167 op_sel:[1,1,0] op_sel_hi:[1,1,0]
s_waitcnt lgkmcnt(1)
v_fma_mix_f32 v167, v144, v144, v167 op_sel:[0,0,0] op_sel_hi:[1,1,0]
v_fma_mix_f32 v167, v149, v149, v167 op_sel:[0,0,0] op_sel_hi:[1,1,0]
v_fma_mix_f32 v167, v145, v145, v167 op_sel:[1,1,0] op_sel_hi:[1,1,0]
v_fma_mix_f32 v167, v149, v149, v167 op_sel:[1,1,0] op_sel_hi:[1,1,0]
v_cvt_pkrtz_f16_f32 v137, v120, v121
v_cvt_pkrtz_f16_f32 v139, v122, v123
v_cvt_pkrtz_f16_f32 v141, v124, v125
v_cvt_pkrtz_f16_f32 v143, v126, v127
v_cvt_pkrtz_f16_f32 v145, v128, v129
v_cvt_pk_f16_f32 v155, v130, v131
v_cvt_pk_f16_f32 v152, v132, v133
v_cvt_pk_f16_f32 v149, v134, v135
ds_read_b128 v[220:223], v248 offset:27648
v_mfma_f32_32x32x16_bf16 v[120:135], v[72:75], v[224:227], 0
v_pk_fma_f16 v154, v155, v155, s48
v_and_b32_e64 v137, s49, v137
v_pk_fma_f16 v151, v152, v152, s48
v_and_b32_e64 v139, s49, v139
v_pk_fma_f16 v148, v149, v149, s48
v_pk_mul_f16 v154, v155, v154
v_bfe_u32 v136, v137, 2, 14
v_pk_mul_f16 v151, v152, v151
v_pk_mul_f16 v148, v149, v148
v_bfe_u32 v138, v139, 2, 14
ds_read_b128 v[224:227], v248 offset:28672
ds_read_u16_d16 v136, v136
ds_read_u16_d16 v138, v138
v_mfma_f32_32x32x16_bf16 v[120:135], v[76:79], v[228:231], v[120:135]
v_exp_f16 v153, v154
v_lshrrev_b32 v137, 18, v137
v_exp_f16 v150, v151
v_lshrrev_b32 v139, 18, v139
v_exp_f16 v147, v148
v_and_b32 v141, s49, v141
v_and_b32_e64 v143, s49, v143
ds_read_b128 v[228:231], v248 offset:31744
ds_read_u16_d16_hi v137, v137
ds_read_u16_d16_hi v139, v139
v_mfma_f32_32x32x16_bf16 v[120:135], v[80:83], v[232:235], v[120:135]
v_exp_f16_sdwa v153, v154 dst_sel:WORD_1 dst_unused:UNUSED_PRESERVE src0_sel:WORD_1
v_bfe_u32 v140, v141, 2, 14
v_exp_f16_sdwa v150, v151 dst_sel:WORD_1 dst_unused:UNUSED_PRESERVE src0_sel:WORD_1
v_bfe_u32 v142, v143, 2, 14
v_exp_f16_sdwa v147, v148 dst_sel:WORD_1 dst_unused:UNUSED_PRESERVE src0_sel:WORD_1
v_lshrrev_b32_e64 v141, 18, v141
v_pk_add_f16 v153, v153, 1.0 op_sel_hi:[1,0]
ds_read_b128 v[232:235], v248 offset:29696
ds_read_u16_d16 v140, v140
ds_read_u16_d16 v142, v142
ds_read_u16_d16_hi v141, v141
v_mfma_f32_32x32x16_bf16 v[120:135], v[84:87], v[236:239], v[120:135]
v_lshrrev_b32_e64 v143, 18, v143
v_pk_add_f16 v150, v150, 1.0 op_sel_hi:[1,0]
v_pk_add_f16 v147, v147, 1.0 op_sel_hi:[1,0]
v_and_b32 v145, s49, v145
v_rcp_f16 v154, v153
v_bfe_u32 v144, v145, 2, 14
v_rcp_f16_e64 v151, v150
v_lshrrev_b32 v145, 18, v145
s_waitcnt lgkmcnt(7)
ds_read_b128 v[236:239], v248 offset:32768
ds_read_u16_d16_hi v143, v143
ds_read_u16_d16 v144, v144
ds_read_u16_d16_hi v145, v145
v_mfma_f32_32x32x16_bf16 v[120:135], v[88:91], v[216:219], v[120:135]
v_rcp_f16_e64 v148, v147
v_rcp_f16_sdwa v154, v153 dst_sel:WORD_1 dst_unused:UNUSED_PRESERVE src0_sel:WORD_1
v_fma_mix_f32 v156, v136, v136, v156 op_sel:[0,0,0] op_sel_hi:[1,1,0]
s_waitcnt lgkmcnt(8)
v_fma_mix_f32 v156, v137, v137, v156 op_sel:[1,1,0] op_sel_hi:[1,1,0]
v_rcp_f16_sdwa v151, v150 dst_sel:WORD_1 dst_unused:UNUSED_PRESERVE src0_sel:WORD_1
v_fma_mix_f32 v156, v138, v138, v156 op_sel:[0,0,0] op_sel_hi:[1,1,0]
ds_read_b128 v[216:219], v248 offset:30720
v_mfma_f32_32x32x16_bf16 v[120:135], v[92:95], v[220:223], v[120:135]
v_rcp_f16_sdwa v148, v147 dst_sel:WORD_1 dst_unused:UNUSED_PRESERVE src0_sel:WORD_1
v_fma_mix_f32 v156, v139, v139, v156 op_sel:[1,1,0] op_sel_hi:[1,1,0]
v_pk_mul_f16 v155, v155, v154
s_waitcnt lgkmcnt(5)
v_fma_mix_f32 v156, v140, v140, v156 op_sel:[0,0,0] op_sel_hi:[1,1,0]
v_pk_mul_f16 v152, v152, v151
v_fma_mix_f32 v156, v141, v141, v156 op_sel:[1,1,0] op_sel_hi:[1,1,0]
v_pk_mul_f16 v149, v149, v148
v_fma_mix_f32 v156, v155, v155, v156 op_sel:[0,0,0] op_sel_hi:[1,1,0]
v_fma_mix_f32 v156, v142, v142, v156 op_sel:[0,0,0] op_sel_hi:[1,1,0]
v_fma_mix_f32 v156, v155, v155, v156 op_sel:[1,1,0] op_sel_hi:[1,1,0]
s_waitcnt lgkmcnt(3)
v_fma_mix_f32 v156, v143, v143, v156 op_sel:[1,1,0] op_sel_hi:[1,1,0]
v_fma_mix_f32 v156, v152, v152, v156 op_sel:[0,0,0] op_sel_hi:[1,1,0]
v_fma_mix_f32 v156, v152, v152, v156 op_sel:[1,1,0] op_sel_hi:[1,1,0]
s_waitcnt lgkmcnt(1)
v_fma_mix_f32 v156, v144, v144, v156 op_sel:[0,0,0] op_sel_hi:[1,1,0]
v_fma_mix_f32 v156, v149, v149, v156 op_sel:[0,0,0] op_sel_hi:[1,1,0]
v_fma_mix_f32 v156, v145, v145, v156 op_sel:[1,1,0] op_sel_hi:[1,1,0]
v_fma_mix_f32 v156, v149, v149, v156 op_sel:[1,1,0] op_sel_hi:[1,1,0]
v_cvt_pkrtz_f16_f32 v137, v120, v121
v_cvt_pkrtz_f16_f32 v139, v122, v123
v_cvt_pkrtz_f16_f32 v141, v124, v125
v_cvt_pkrtz_f16_f32 v143, v126, v127
v_cvt_pkrtz_f16_f32 v145, v128, v129
v_cvt_pk_f16_f32 v155, v130, v131
v_cvt_pk_f16_f32 v152, v132, v133
v_cvt_pk_f16_f32 v149, v134, v135
s_add_u32 s46, s80, 12582912
buffer_store_dwordx4 v[72:75], v241, s[32:35], s46 offen
ds_read_b128 v[220:223], v248 offset:33792
v_mfma_f32_32x32x16_bf16 v[120:135], v[72:75], v[224:227], 0
v_pk_fma_f16 v154, v155, v155, s48
v_and_b32_e64 v137, s49, v137
v_pk_fma_f16 v151, v152, v152, s48
v_and_b32_e64 v139, s49, v139
v_pk_fma_f16 v148, v149, v149, s48
v_pk_mul_f16 v154, v155, v154
v_bfe_u32 v136, v137, 2, 14
v_pk_mul_f16 v151, v152, v151
v_pk_mul_f16 v148, v149, v148
v_bfe_u32 v138, v139, 2, 14
ds_read_b128 v[224:227], v248 offset:34816
ds_read_u16_d16 v136, v136
ds_read_u16_d16 v138, v138
v_mfma_f32_32x32x16_bf16 v[120:135], v[76:79], v[228:231], v[120:135]
v_exp_f16 v153, v154
v_lshrrev_b32 v137, 18, v137
v_exp_f16 v150, v151
v_lshrrev_b32 v139, 18, v139
v_exp_f16 v147, v148
v_and_b32 v141, s49, v141
v_and_b32_e64 v143, s49, v143
ds_read_b128 v[228:231], v248 offset:37888
ds_read_u16_d16_hi v137, v137
ds_read_u16_d16_hi v139, v139
v_mfma_f32_32x32x16_bf16 v[120:135], v[80:83], v[232:235], v[120:135]
v_exp_f16_sdwa v153, v154 dst_sel:WORD_1 dst_unused:UNUSED_PRESERVE src0_sel:WORD_1
v_bfe_u32 v140, v141, 2, 14
v_exp_f16_sdwa v150, v151 dst_sel:WORD_1 dst_unused:UNUSED_PRESERVE src0_sel:WORD_1
v_bfe_u32 v142, v143, 2, 14
v_exp_f16_sdwa v147, v148 dst_sel:WORD_1 dst_unused:UNUSED_PRESERVE src0_sel:WORD_1
v_lshrrev_b32_e64 v141, 18, v141
v_pk_add_f16 v153, v153, 1.0 op_sel_hi:[1,0]
ds_read_b128 v[232:235], v248 offset:35840
ds_read_u16_d16 v140, v140
ds_read_u16_d16 v142, v142
ds_read_u16_d16_hi v141, v141
v_mfma_f32_32x32x16_bf16 v[120:135], v[84:87], v[236:239], v[120:135]
v_lshrrev_b32_e64 v143, 18, v143
v_pk_add_f16 v150, v150, 1.0 op_sel_hi:[1,0]
v_pk_add_f16 v147, v147, 1.0 op_sel_hi:[1,0]
v_and_b32 v145, s49, v145
v_rcp_f16 v154, v153
v_bfe_u32 v144, v145, 2, 14
v_rcp_f16_e64 v151, v150
v_lshrrev_b32 v145, 18, v145
s_waitcnt lgkmcnt(7)
ds_read_b128 v[236:239], v248 offset:38912
ds_read_u16_d16_hi v143, v143
ds_read_u16_d16 v144, v144
ds_read_u16_d16_hi v145, v145
v_mfma_f32_32x32x16_bf16 v[120:135], v[88:91], v[216:219], v[120:135]
v_rcp_f16 v148, v147
v_rcp_f16_sdwa v154, v153 dst_sel:WORD_1 dst_unused:UNUSED_PRESERVE src0_sel:WORD_1
s_setprio 0
v_fma_mix_f32 v157, v136, v136, v157 op_sel:[0,0,0] op_sel_hi:[1,1,0]
s_waitcnt lgkmcnt(8)
v_fma_mix_f32 v157, v137, v137, v157 op_sel:[1,1,0] op_sel_hi:[1,1,0]
v_rcp_f16_sdwa v151, v150 dst_sel:WORD_1 dst_unused:UNUSED_PRESERVE src0_sel:WORD_1
v_fma_mix_f32 v157, v138, v138, v157 op_sel:[0,0,0] op_sel_hi:[1,1,0]
ds_read_b128 v[216:219], v248 offset:36864
v_mfma_f32_32x32x16_bf16 v[120:135], v[92:95], v[220:223], v[120:135]
v_rcp_f16_sdwa v148, v147 dst_sel:WORD_1 dst_unused:UNUSED_PRESERVE src0_sel:WORD_1
v_fma_mix_f32 v157, v139, v139, v157 op_sel:[1,1,0] op_sel_hi:[1,1,0]
v_pk_mul_f16 v155, v155, v154
s_waitcnt lgkmcnt(5)
v_fma_mix_f32 v157, v140, v140, v157 op_sel:[0,0,0] op_sel_hi:[1,1,0]
v_pk_mul_f16 v152, v152, v151
v_fma_mix_f32 v157, v141, v141, v157 op_sel:[1,1,0] op_sel_hi:[1,1,0]
v_pk_mul_f16 v149, v149, v148
v_fma_mix_f32 v157, v155, v155, v157 op_sel:[0,0,0] op_sel_hi:[1,1,0]
v_fma_mix_f32 v157, v142, v142, v157 op_sel:[0,0,0] op_sel_hi:[1,1,0]
v_fma_mix_f32 v157, v155, v155, v157 op_sel:[1,1,0] op_sel_hi:[1,1,0]
s_waitcnt lgkmcnt(3)
v_fma_mix_f32 v157, v143, v143, v157 op_sel:[1,1,0] op_sel_hi:[1,1,0]
v_fma_mix_f32 v157, v152, v152, v157 op_sel:[0,0,0] op_sel_hi:[1,1,0]
v_fma_mix_f32 v157, v152, v152, v157 op_sel:[1,1,0] op_sel_hi:[1,1,0]
s_waitcnt lgkmcnt(1)
v_fma_mix_f32 v157, v144, v144, v157 op_sel:[0,0,0] op_sel_hi:[1,1,0]
v_fma_mix_f32 v157, v149, v149, v157 op_sel:[0,0,0] op_sel_hi:[1,1,0]
v_fma_mix_f32 v157, v145, v145, v157 op_sel:[1,1,0] op_sel_hi:[1,1,0]
v_fma_mix_f32 v157, v149, v149, v157 op_sel:[1,1,0] op_sel_hi:[1,1,0]
v_cvt_pkrtz_f16_f32 v137, v120, v121
v_cvt_pkrtz_f16_f32 v139, v122, v123
v_cvt_pkrtz_f16_f32 v141, v124, v125
v_cvt_pkrtz_f16_f32 v143, v126, v127
v_cvt_pkrtz_f16_f32 v145, v128, v129
v_cvt_pk_f16_f32 v155, v130, v131
v_cvt_pk_f16_f32 v152, v132, v133
v_cvt_pk_f16_f32 v149, v134, v135
s_add_u32 s46, s80, 14680064
buffer_store_dwordx4 v[76:79], v241, s[32:35], s46 offen
ds_read_b128 v[220:223], v248 offset:39936
v_mfma_f32_32x32x16_bf16 v[120:135], v[72:75], v[224:227], 0
v_pk_fma_f16 v154, v155, v155, s48
v_and_b32_e64 v137, s49, v137
v_pk_fma_f16 v151, v152, v152, s48
v_and_b32_e64 v139, s49, v139
v_pk_fma_f16 v148, v149, v149, s48
v_pk_mul_f16 v154, v155, v154
v_bfe_u32 v136, v137, 2, 14
v_pk_mul_f16 v151, v152, v151
v_pk_mul_f16 v148, v149, v148
v_bfe_u32 v138, v139, 2, 14
ds_read_b64 v[224:225], v245
ds_read_b64 v[226:227], v246
s_cmp_eq_u32 s40, 7
s_cbranch_scc1 Lrdy16
s_waitcnt vmcnt(2)
Lrdy16:
s_barrier
ds_read_b128 v[192:195], v242
ds_read_u16_d16 v136, v136
ds_read_u16_d16 v138, v138
v_mfma_f32_32x32x16_bf16 v[120:135], v[76:79], v[228:231], v[120:135]
v_exp_f16 v153, v154
v_lshrrev_b32 v137, 18, v137
v_exp_f16 v150, v151
v_lshrrev_b32 v139, 18, v139
v_exp_f16 v147, v148
v_and_b32 v141, s49, v141
v_and_b32_e64 v143, s49, v143
ds_read_b128 v[228:231], v248 offset:40960
ds_read_u16_d16_hi v137, v137
ds_read_u16_d16_hi v139, v139
v_mfma_f32_32x32x16_bf16 v[120:135], v[80:83], v[232:235], v[120:135]
v_exp_f16_sdwa v153, v154 dst_sel:WORD_1 dst_unused:UNUSED_PRESERVE src0_sel:WORD_1
v_bfe_u32 v140, v141, 2, 14
v_exp_f16_sdwa v150, v151 dst_sel:WORD_1 dst_unused:UNUSED_PRESERVE src0_sel:WORD_1
v_bfe_u32 v142, v143, 2, 14
v_exp_f16_sdwa v147, v148 dst_sel:WORD_1 dst_unused:UNUSED_PRESERVE src0_sel:WORD_1
v_lshrrev_b32 v141, 18, v141
v_pk_add_f16 v153, v153, 1.0 op_sel_hi:[1,0]
s_setprio 2
ds_read_b128 v[232:235], v248 offset:44032
ds_read_u16_d16 v140, v140
ds_read_u16_d16 v142, v142
ds_read_u16_d16_hi v141, v141
v_mfma_f32_32x32x16_bf16 v[120:135], v[84:87], v[236:239], v[120:135]
v_lshrrev_b32_e64 v143, 18, v143
v_pk_add_f16 v150, v150, 1.0 op_sel_hi:[1,0]
v_pk_add_f16 v147, v147, 1.0 op_sel_hi:[1,0]
v_and_b32 v145, s49, v145
v_rcp_f16 v154, v153
v_bfe_u32 v144, v145, 2, 14
v_rcp_f16_e64 v151, v150
v_lshrrev_b32 v145, 18, v145
s_waitcnt lgkmcnt(6)
ds_read_b64 v[236:237], v245 offset:768
ds_read_b64 v[238:239], v246 offset:768
ds_read_b128 v[196:199], v242 offset:64
ds_read_u16_d16_hi v143, v143
ds_read_u16_d16 v144, v144
ds_read_u16_d16_hi v145, v145
v_mfma_f32_32x32x16_bf16 v[120:135], v[88:91], v[216:219], v[120:135]
v_rcp_f16_e64 v148, v147
v_rcp_f16_sdwa v154, v153 dst_sel:WORD_1 dst_unused:UNUSED_PRESERVE src0_sel:WORD_1
v_fma_mix_f32 v158, v136, v136, v158 op_sel:[0,0,0] op_sel_hi:[1,1,0]
s_waitcnt lgkmcnt(10)
v_fma_mix_f32 v158, v137, v137, v158 op_sel:[1,1,0] op_sel_hi:[1,1,0]
v_rcp_f16_sdwa v151, v150 dst_sel:WORD_1 dst_unused:UNUSED_PRESERVE src0_sel:WORD_1
v_fma_mix_f32 v158, v138, v138, v158 op_sel:[0,0,0] op_sel_hi:[1,1,0]
ds_read_b128 v[216:219], v248 offset:41984
v_mfma_f32_32x32x16_bf16 v[120:135], v[92:95], v[220:223], v[120:135]
v_rcp_f16_sdwa v148, v147 dst_sel:WORD_1 dst_unused:UNUSED_PRESERVE src0_sel:WORD_1
v_fma_mix_f32 v158, v139, v139, v158 op_sel:[1,1,0] op_sel_hi:[1,1,0]
v_pk_mul_f16 v155, v155, v154
s_waitcnt lgkmcnt(7)
v_fma_mix_f32 v158, v140, v140, v158 op_sel:[0,0,0] op_sel_hi:[1,1,0]
v_pk_mul_f16 v152, v152, v151
v_fma_mix_f32 v158, v141, v141, v158 op_sel:[1,1,0] op_sel_hi:[1,1,0]
v_pk_mul_f16 v149, v149, v148
v_fma_mix_f32 v158, v155, v155, v158 op_sel:[0,0,0] op_sel_hi:[1,1,0]
v_fma_mix_f32 v158, v142, v142, v158 op_sel:[0,0,0] op_sel_hi:[1,1,0]
v_fma_mix_f32 v158, v155, v155, v158 op_sel:[1,1,0] op_sel_hi:[1,1,0]
s_waitcnt lgkmcnt(3)
v_fma_mix_f32 v158, v143, v143, v158 op_sel:[1,1,0] op_sel_hi:[1,1,0]
v_fma_mix_f32 v158, v152, v152, v158 op_sel:[0,0,0] op_sel_hi:[1,1,0]
v_fma_mix_f32 v158, v152, v152, v158 op_sel:[1,1,0] op_sel_hi:[1,1,0]
s_waitcnt lgkmcnt(1)
v_fma_mix_f32 v158, v144, v144, v158 op_sel:[0,0,0] op_sel_hi:[1,1,0]
v_fma_mix_f32 v158, v149, v149, v158 op_sel:[0,0,0] op_sel_hi:[1,1,0]
v_fma_mix_f32 v158, v145, v145, v158 op_sel:[1,1,0] op_sel_hi:[1,1,0]
v_fma_mix_f32 v158, v149, v149, v158 op_sel:[1,1,0] op_sel_hi:[1,1,0]
v_mfma_f32_16x16x32_bf16 v[0:3], v[224:227], v[192:195], 0
s_add_u32 s46, s80, 16777216
buffer_store_dwordx4 v[80:83], v241, s[32:35], s46 offen
ds_read_b128 v[220:223], v248 offset:45056
v_cvt_pkrtz_f16_f32 v137, v120, v121
v_cvt_pkrtz_f16_f32 v139, v122, v123
v_cvt_pkrtz_f16_f32 v141, v124, v125
v_cvt_pkrtz_f16_f32 v143, v126, v127
v_cvt_pk_f16_f32 v155, v128, v129
v_cvt_pk_f16_f32 v152, v130, v131
v_cvt_pk_f16_f32 v149, v132, v133
v_cvt_pk_f16_f32 v146, v134, v135
v_mfma_f32_32x32x16_bf16 v[120:135], v[72:75], v[228:231], 0
ds_read_b64 v[224:225], v245 offset:1536
ds_read_b64 v[226:227], v246 offset:1536
ds_read_b128 v[200:203], v242 offset:128
v_pk_fma_f16 v154, v155, v155, s48
v_and_b32_e64 v137, s49, v137
v_pk_fma_f16 v151, v152, v152, s48
v_pk_fma_f16 v148, v149, v149, s48
v_and_b32_e64 v139, s49, v139
v_pk_fma_f16 v145, v146, v146, s48
v_mfma_f32_32x32x16_bf16 v[120:135], v[76:79], v[232:235], v[120:135]
ds_read_b128 v[228:231], v248 offset:43008
v_pk_mul_f16 v154, v155, v154
v_bfe_u32 v136, v137, 2, 14
v_pk_mul_f16 v151, v152, v151
v_pk_mul_f16 v148, v149, v148
v_bfe_u32 v138, v139, 2, 14
v_pk_mul_f16 v145, v146, v145
v_exp_f16 v153, v154
v_lshrrev_b32 v137, 18, v137
v_mfma_f32_16x16x32_bf16 v[16:19], v[236:239], v[196:199], 0
ds_read_b64 v[232:233], v245 offset:2304
ds_read_b64 v[234:235], v246 offset:2304
ds_read_b128 v[204:207], v243
ds_read_u16_d16 v136, v136
ds_read_u16_d16 v138, v138
ds_read_u16_d16_hi v137, v137
v_exp_f16 v150, v151
v_lshrrev_b32 v139, 18, v139
v_exp_f16 v147, v148
s_waitcnt lgkmcnt(7)
v_mfma_f32_32x32x16_bf16 v[120:135], v[80:83], v[216:219], v[120:135]
ds_read_b128 v[236:239], v248 offset:46080
ds_read_u16_d16_hi v139, v139
v_and_b32 v141, s49, v141
v_exp_f16 v144, v145
v_and_b32_e64 v143, s49, v143
v_exp_f16_sdwa v153, v154 dst_sel:WORD_1 dst_unused:UNUSED_PRESERVE src0_sel:WORD_1
v_bfe_u32 v140, v141, 2, 14
v_exp_f16_sdwa v150, v151 dst_sel:WORD_1 dst_unused:UNUSED_PRESERVE src0_sel:WORD_1
v_mfma_f32_32x32x16_bf16 v[120:135], v[84:87], v[220:223], v[120:135]
ds_read_b64 v[216:217], v245 offset:3072
ds_read_b64 v[218:219], v246 offset:3072
ds_read_b128 v[208:211], v243 offset:64
ds_read_u16_d16 v140, v140
v_bfe_u32 v142, v143, 2, 14
v_exp_f16_sdwa v147, v148 dst_sel:WORD_1 dst_unused:UNUSED_PRESERVE src0_sel:WORD_1
v_lshrrev_b32_e64 v141, 18, v141
v_exp_f16_sdwa v144, v145 dst_sel:WORD_1 dst_unused:UNUSED_PRESERVE src0_sel:WORD_1
v_lshrrev_b32_e64 v143, 18, v143
v_pk_add_f16 v153, v153, 1.0 op_sel_hi:[1,0]
v_pk_add_f16 v150, v150, 1.0 op_sel_hi:[1,0]
v_mfma_f32_16x16x32_bf16 v[32:35], v[224:227], v[200:203], 0
ds_read_b64 v[220:221], v245 offset:3840
ds_read_b64 v[222:223], v246 offset:3840
ds_read_b128 v[212:215], v243 offset:128
ds_read_u16_d16 v142, v142
ds_read_u16_d16_hi v141, v141
ds_read_u16_d16_hi v143, v143
v_pk_add_f16 v147, v147, 1.0 op_sel_hi:[1,0]
v_pk_add_f16 v144, v144, 1.0 op_sel_hi:[1,0]
v_rcp_f16 v154, v153
s_waitcnt lgkmcnt(10)
v_mfma_f32_32x32x16_bf16 v[120:135], v[88:91], v[228:231], v[120:135]
ds_read_b64 v[224:225], v245 offset:4608
ds_read_b64 v[226:227], v246 offset:4608
ds_read_b128 v[192:195], v244
v_rcp_f16 v151, v150
v_rcp_f16 v148, v147
v_rcp_f16_e64 v145, v144
v_rcp_f16_sdwa v154, v153 dst_sel:WORD_1 dst_unused:UNUSED_PRESERVE src0_sel:WORD_1
v_rcp_f16_sdwa v151, v150 dst_sel:WORD_1 dst_unused:UNUSED_PRESERVE src0_sel:WORD_1
v_mfma_f32_16x16x32_bf16 v[0:3], v[232:235], v[204:207], v[0:3]
ds_read_b128 v[228:231], v248 offset:47104
v_rcp_f16_sdwa v148, v147 dst_sel:WORD_1 dst_unused:UNUSED_PRESERVE src0_sel:WORD_1
v_fma_mix_f32 v159, v136, v136, v159 op_sel:[0,0,0] op_sel_hi:[1,1,0]
v_rcp_f16_sdwa v145, v144 dst_sel:WORD_1 dst_unused:UNUSED_PRESERVE src0_sel:WORD_1
v_mfma_f32_32x32x16_bf16 v[120:135], v[92:95], v[236:239], v[120:135]
ds_read_b128 v[232:235], v248 offset:50176
v_fma_mix_f32 v159, v137, v137, v159 op_sel:[1,1,0] op_sel_hi:[1,1,0]
v_pk_mul_f16 v155, v155, v154
v_fma_mix_f32 v159, v138, v138, v159 op_sel:[0,0,0] op_sel_hi:[1,1,0]
v_pk_mul_f16 v152, v152, v151
v_pk_mul_f16 v149, v149, v148
v_fma_mix_f32 v159, v139, v139, v159 op_sel:[1,1,0] op_sel_hi:[1,1,0]
v_pk_mul_f16 v146, v146, v145
v_fma_mix_f32 v159, v155, v155, v159 op_sel:[0,0,0] op_sel_hi:[1,1,0]
s_waitcnt lgkmcnt(5)
v_fma_mix_f32 v159, v140, v140, v159 op_sel:[0,0,0] op_sel_hi:[1,1,0]
v_mfma_f32_16x16x32_bf16 v[16:19], v[216:219], v[208:211], v[16:19]
ds_read_b64 v[236:237], v245 offset:5376
ds_read_b64 v[238:239], v246 offset:5376
ds_read_b128 v[196:199], v244 offset:64
v_fma_mix_f32 v159, v155, v155, v159 op_sel:[1,1,0] op_sel_hi:[1,1,0]
v_fma_mix_f32 v159, v152, v152, v159 op_sel:[0,0,0] op_sel_hi:[1,1,0]
v_fma_mix_f32 v159, v141, v141, v159 op_sel:[1,1,0] op_sel_hi:[1,1,0]
v_fma_mix_f32 v159, v152, v152, v159 op_sel:[1,1,0] op_sel_hi:[1,1,0]
v_fma_mix_f32 v159, v149, v149, v159 op_sel:[0,0,0] op_sel_hi:[1,1,0]
v_mfma_f32_16x16x32_bf16 v[32:35], v[220:223], v[212:215], v[32:35]
ds_read_b128 v[216:219], v248 offset:48128
v_fma_mix_f32 v159, v142, v142, v159 op_sel:[0,0,0] op_sel_hi:[1,1,0]
v_fma_mix_f32 v159, v149, v149, v159 op_sel:[1,1,0] op_sel_hi:[1,1,0]
v_fma_mix_f32 v159, v146, v146, v159 op_sel:[0,0,0] op_sel_hi:[1,1,0]
v_fma_mix_f32 v159, v143, v143, v159 op_sel:[1,1,0] op_sel_hi:[1,1,0]
v_fma_mix_f32 v159, v146, v146, v159 op_sel:[1,1,0] op_sel_hi:[1,1,0]
s_waitcnt lgkmcnt(4)
v_mfma_f32_16x16x32_bf16 v[0:3], v[224:227], v[192:195], v[0:3]
s_add_u32 s46, s80, 18874368
buffer_store_dwordx4 v[84:87], v241, s[32:35], s46 offen
ds_read_b128 v[220:223], v248 offset:51200
v_cvt_pkrtz_f16_f32 v137, v120, v121
v_cvt_pkrtz_f16_f32 v139, v122, v123
v_cvt_pkrtz_f16_f32 v141, v124, v125
v_cvt_pkrtz_f16_f32 v143, v126, v127
v_cvt_pk_f16_f32 v155, v128, v129
v_cvt_pk_f16_f32 v152, v130, v131
v_cvt_pk_f16_f32 v149, v132, v133
v_cvt_pk_f16_f32 v146, v134, v135
v_mfma_f32_32x32x16_bf16 v[120:135], v[72:75], v[228:231], 0
ds_read_b64 v[224:225], v245 offset:6144
ds_read_b64 v[226:227], v246 offset:6144
ds_read_b128 v[200:203], v244 offset:128
v_pk_fma_f16 v154, v155, v155, s48
v_and_b32_e64 v137, s49, v137
v_pk_fma_f16 v151, v152, v152, s48
v_pk_fma_f16 v148, v149, v149, s48
v_and_b32_e64 v139, s49, v139
v_pk_fma_f16 v145, v146, v146, s48
v_mfma_f32_32x32x16_bf16 v[120:135], v[76:79], v[232:235], v[120:135]
ds_read_b128 v[228:231], v248 offset:49152
v_pk_mul_f16 v154, v155, v154
v_bfe_u32 v136, v137, 2, 14
v_pk_mul_f16 v151, v152, v151
v_pk_mul_f16 v148, v149, v148
v_bfe_u32 v138, v139, 2, 14
v_pk_mul_f16 v145, v146, v145
v_exp_f16 v153, v154
v_lshrrev_b32 v137, 18, v137
s_waitcnt lgkmcnt(4)
v_mfma_f32_16x16x32_bf16 v[16:19], v[236:239], v[196:199], v[16:19]
ds_read_b64 v[232:233], v245 offset:192
ds_read_b64 v[234:235], v246 offset:192
v_xor_b32 v242, 16, v242
ds_read_b128 v[204:207], v242
ds_read_u16_d16 v136, v136
ds_read_u16_d16 v138, v138
ds_read_u16_d16_hi v137, v137
v_exp_f16 v150, v151
v_lshrrev_b32 v139, 18, v139
v_exp_f16_e64 v147, v148
v_mfma_f32_32x32x16_bf16 v[120:135], v[80:83], v[216:219], v[120:135]
ds_read_b128 v[236:239], v248 offset:52224
ds_read_u16_d16_hi v139, v139
v_and_b32 v141, s49, v141
v_exp_f16 v144, v145
v_and_b32_e64 v143, s49, v143
v_exp_f16_sdwa v153, v154 dst_sel:WORD_1 dst_unused:UNUSED_PRESERVE src0_sel:WORD_1
v_bfe_u32 v140, v141, 2, 14
v_exp_f16_sdwa v150, v151 dst_sel:WORD_1 dst_unused:UNUSED_PRESERVE src0_sel:WORD_1
v_mfma_f32_32x32x16_bf16 v[120:135], v[84:87], v[220:223], v[120:135]
ds_read_b64 v[216:217], v245 offset:960
ds_read_b64 v[218:219], v246 offset:960
ds_read_b128 v[208:211], v242 offset:64
ds_read_u16_d16 v140, v140
v_bfe_u32 v142, v143, 2, 14
v_exp_f16_sdwa v147, v148 dst_sel:WORD_1 dst_unused:UNUSED_PRESERVE src0_sel:WORD_1
v_lshrrev_b32_e64 v141, 18, v141
v_exp_f16_sdwa v144, v145 dst_sel:WORD_1 dst_unused:UNUSED_PRESERVE src0_sel:WORD_1
v_lshrrev_b32 v143, 18, v143
v_pk_add_f16 v153, v153, 1.0 op_sel_hi:[1,0]
v_pk_add_f16 v150, v150, 1.0 op_sel_hi:[1,0]
s_waitcnt lgkmcnt(6)
v_mfma_f32_16x16x32_bf16 v[32:35], v[224:227], v[200:203], v[32:35]
ds_read_b64 v[220:221], v245 offset:1728
ds_read_b64 v[222:223], v246 offset:1728
ds_read_b128 v[212:215], v242 offset:128
ds_read_u16_d16 v142, v142
ds_read_u16_d16_hi v141, v141
ds_read_u16_d16_hi v143, v143
v_pk_add_f16 v147, v147, 1.0 op_sel_hi:[1,0]
v_pk_add_f16 v144, v144, 1.0 op_sel_hi:[1,0]
v_rcp_f16_e64 v154, v153
v_mfma_f32_32x32x16_bf16 v[120:135], v[88:91], v[228:231], v[120:135]
ds_read_b64 v[224:225], v245 offset:2496
ds_read_b64 v[226:227], v246 offset:2496
v_xor_b32 v243, 16, v243
ds_read_b128 v[192:195], v243
v_rcp_f16 v151, v150
v_rcp_f16 v148, v147
v_rcp_f16 v145, v144
v_rcp_f16_sdwa v154, v153 dst_sel:WORD_1 dst_unused:UNUSED_PRESERVE src0_sel:WORD_1
v_rcp_f16_sdwa v151, v150 dst_sel:WORD_1 dst_unused:UNUSED_PRESERVE src0_sel:WORD_1
v_mfma_f32_16x16x32_bf16 v[4:7], v[232:235], v[204:207], 0
ds_read_b128 v[228:231], v248 offset:53248
v_rcp_f16_sdwa v148, v147 dst_sel:WORD_1 dst_unused:UNUSED_PRESERVE src0_sel:WORD_1
v_fma_mix_f32 v160, v136, v136, v160 op_sel:[0,0,0] op_sel_hi:[1,1,0]
v_rcp_f16_sdwa v145, v144 dst_sel:WORD_1 dst_unused:UNUSED_PRESERVE src0_sel:WORD_1
s_waitcnt lgkmcnt(10)
v_mfma_f32_32x32x16_bf16 v[120:135], v[92:95], v[236:239], v[120:135]
ds_read_b128 v[232:235], v248 offset:56320
v_fma_mix_f32 v160, v137, v137, v160 op_sel:[1,1,0] op_sel_hi:[1,1,0]
v_pk_mul_f16 v155, v155, v154
v_fma_mix_f32 v160, v138, v138, v160 op_sel:[0,0,0] op_sel_hi:[1,1,0]
v_pk_mul_f16 v152, v152, v151
v_pk_mul_f16 v149, v149, v148
v_fma_mix_f32 v160, v139, v139, v160 op_sel:[1,1,0] op_sel_hi:[1,1,0]
v_pk_mul_f16 v146, v146, v145
v_fma_mix_f32 v160, v155, v155, v160 op_sel:[0,0,0] op_sel_hi:[1,1,0]
v_fma_mix_f32 v160, v140, v140, v160 op_sel:[0,0,0] op_sel_hi:[1,1,0]
v_mfma_f32_16x16x32_bf16 v[20:23], v[216:219], v[208:211], 0
ds_read_b64 v[236:237], v245 offset:3264
ds_read_b64 v[238:239], v246 offset:3264
ds_read_b128 v[196:199], v243 offset:64
v_fma_mix_f32 v160, v155, v155, v160 op_sel:[1,1,0] op_sel_hi:[1,1,0]
v_fma_mix_f32 v160, v152, v152, v160 op_sel:[0,0,0] op_sel_hi:[1,1,0]
s_waitcnt lgkmcnt(5)
v_fma_mix_f32 v160, v141, v141, v160 op_sel:[1,1,0] op_sel_hi:[1,1,0]
v_fma_mix_f32 v160, v152, v152, v160 op_sel:[1,1,0] op_sel_hi:[1,1,0]
v_fma_mix_f32 v160, v149, v149, v160 op_sel:[0,0,0] op_sel_hi:[1,1,0]
v_mfma_f32_16x16x32_bf16 v[36:39], v[220:223], v[212:215], 0
ds_read_b128 v[216:219], v248 offset:54272
v_fma_mix_f32 v160, v142, v142, v160 op_sel:[0,0,0] op_sel_hi:[1,1,0]
v_fma_mix_f32 v160, v149, v149, v160 op_sel:[1,1,0] op_sel_hi:[1,1,0]
v_fma_mix_f32 v160, v146, v146, v160 op_sel:[0,0,0] op_sel_hi:[1,1,0]
v_fma_mix_f32 v160, v143, v143, v160 op_sel:[1,1,0] op_sel_hi:[1,1,0]
v_fma_mix_f32 v160, v146, v146, v160 op_sel:[1,1,0] op_sel_hi:[1,1,0]
s_cmp_lg_u32 s40, 7
s_cbranch_scc1 Lnobias2
s_sub_u32 s43, s2, 96
s_cmp_lt_u32 s43, 96
s_cbranch_scc0 Lnobias2
s_waitcnt vmcnt(15)
v_lshlrev_b32 v176, 16, v176
v_lshlrev_b32 v177, 16, v177
v_lshlrev_b32 v178, 16, v178
v_lshlrev_b32 v179, 16, v179
v_lshlrev_b32 v180, 16, v180
v_lshlrev_b32 v181, 16, v181
v_lshlrev_b32 v182, 16, v182
v_lshlrev_b32 v183, 16, v183
v_lshlrev_b32 v184, 16, v184
v_lshlrev_b32 v185, 16, v185
v_lshlrev_b32 v186, 16, v186
v_lshlrev_b32 v187, 16, v187
v_mul_f32 v174, v176, v182
v_fmac_f32 v174, v177, v183
v_fmac_f32 v174, v178, v184
v_fmac_f32 v174, v179, v185
v_fmac_f32 v174, v180, v186
v_fmac_f32 v174, v181, v187
s_nop 1
v_add_f32_dpp v174, v174, v174 row_ror:8 row_mask:0xf bank_mask:0xf
s_nop 1
v_add_f32_dpp v174, v174, v174 row_ror:4 row_mask:0xf bank_mask:0xf
s_nop 1
v_add_f32_dpp v174, v174, v174 row_ror:2 row_mask:0xf bank_mask:0xf
s_nop 1
v_add_f32_dpp v174, v174, v174 row_ror:1 row_mask:0xf bank_mask:0xf
v_mov_b32 v175, v174
s_nop 1
v_permlane16_swap_b32 v174, v175
v_add_f32 v174, v174, v175
v_mov_b32_e64 v175, v174
s_nop 1
v_permlane32_swap_b32 v174, v175
v_add_f32 v174, v174, v175
s_lshl_b32 s44, s43, 2
s_add_u32 s44, s44, 394752
v_lshlrev_b32 v191, 11, v251
s_mov_b64 exec, 0xff
buffer_store_dword v174, v191, s[32:35], s44 offen sc1
s_mov_b64 exec, -1
Lnobias2:
v_mfma_f32_16x16x32_bf16 v[4:7], v[224:227], v[192:195], v[4:7]
s_add_u32 s46, s80, 20971520
buffer_store_dwordx4 v[88:91], v241, s[32:35], s46 offen
ds_read_b128 v[220:223], v248 offset:57344
v_cvt_pkrtz_f16_f32 v137, v120, v121
v_cvt_pkrtz_f16_f32 v139, v122, v123
v_cvt_pkrtz_f16_f32 v141, v124, v125
v_cvt_pkrtz_f16_f32 v143, v126, v127
v_cvt_pk_f16_f32 v155, v128, v129
v_cvt_pk_f16_f32 v152, v130, v131
v_cvt_pk_f16_f32 v149, v132, v133
v_cvt_pk_f16_f32 v146, v134, v135
s_waitcnt lgkmcnt(1)
v_mfma_f32_32x32x16_bf16 v[120:135], v[72:75], v[228:231], 0
ds_read_b64 v[224:225], v245 offset:4032
ds_read_b64 v[226:227], v246 offset:4032
ds_read_b128 v[200:203], v243 offset:128
v_pk_fma_f16 v154, v155, v155, s48
v_and_b32 v137, s49, v137
v_pk_fma_f16 v151, v152, v152, s48
v_pk_fma_f16 v148, v149, v149, s48
v_and_b32_e64 v139, s49, v139
v_pk_fma_f16 v145, v146, v146, s48
v_mfma_f32_32x32x16_bf16 v[120:135], v[76:79], v[232:235], v[120:135]
ds_read_b128 v[228:231], v248 offset:55296
v_pk_mul_f16 v154, v155, v154
v_bfe_u32 v136, v137, 2, 14
v_pk_mul_f16 v151, v152, v151
v_pk_mul_f16 v148, v149, v148
v_bfe_u32 v138, v139, 2, 14
v_pk_mul_f16 v145, v146, v145
v_exp_f16_e64 v153, v154
v_lshrrev_b32 v137, 18, v137
v_mfma_f32_16x16x32_bf16 v[20:23], v[236:239], v[196:199], v[20:23]
ds_read_b64 v[232:233], v245 offset:4800
ds_read_b64 v[234:235], v246 offset:4800
v_xor_b32 v244, 16, v244
ds_read_b128 v[204:207], v244
ds_read_u16_d16 v136, v136
ds_read_u16_d16 v138, v138
ds_read_u16_d16_hi v137, v137
v_exp_f16 v150, v151
v_lshrrev_b32 v139, 18, v139
v_exp_f16_e64 v147, v148
v_mfma_f32_32x32x16_bf16 v[120:135], v[80:83], v[216:219], v[120:135]
ds_read_b128 v[236:239], v248 offset:58368
ds_read_u16_d16_hi v139, v139
v_and_b32 v141, s49, v141
v_exp_f16 v144, v145
v_and_b32 v143, s49, v143
v_exp_f16_sdwa v153, v154 dst_sel:WORD_1 dst_unused:UNUSED_PRESERVE src0_sel:WORD_1
v_bfe_u32 v140, v141, 2, 14
v_exp_f16_sdwa v150, v151 dst_sel:WORD_1 dst_unused:UNUSED_PRESERVE src0_sel:WORD_1
s_waitcnt lgkmcnt(8)
v_mfma_f32_32x32x16_bf16 v[120:135], v[84:87], v[220:223], v[120:135]
ds_read_b64 v[216:217], v245 offset:5568
ds_read_b64 v[218:219], v246 offset:5568
ds_read_b128 v[208:211], v244 offset:64
ds_read_u16_d16 v140, v140
v_bfe_u32 v142, v143, 2, 14
v_exp_f16_sdwa v147, v148 dst_sel:WORD_1 dst_unused:UNUSED_PRESERVE src0_sel:WORD_1
v_lshrrev_b32_e64 v141, 18, v141
v_exp_f16_sdwa v144, v145 dst_sel:WORD_1 dst_unused:UNUSED_PRESERVE src0_sel:WORD_1
v_lshrrev_b32_e64 v143, 18, v143
v_pk_add_f16 v153, v153, 1.0 op_sel_hi:[1,0]
v_pk_add_f16 v150, v150, 1.0 op_sel_hi:[1,0]
v_mfma_f32_16x16x32_bf16 v[36:39], v[224:227], v[200:203], v[36:39]
ds_read_b64 v[220:221], v245 offset:6336
ds_read_b64 v[222:223], v246 offset:6336
ds_read_b128 v[212:215], v244 offset:128
ds_read_u16_d16 v142, v142
ds_read_u16_d16_hi v141, v141
ds_read_u16_d16_hi v143, v143
v_pk_add_f16 v147, v147, 1.0 op_sel_hi:[1,0]
v_pk_add_f16 v144, v144, 1.0 op_sel_hi:[1,0]
v_rcp_f16_e64 v154, v153
v_mfma_f32_32x32x16_bf16 v[120:135], v[88:91], v[228:231], v[120:135]
ds_read_b64 v[224:225], v245 offset:576
ds_read_b64 v[226:227], v246 offset:576
v_xor_b32 v242, 32, v242
ds_read_b128 v[192:195], v242
v_rcp_f16 v151, v150
v_rcp_f16_e64 v148, v147
v_rcp_f16 v145, v144
v_rcp_f16_sdwa v154, v153 dst_sel:WORD_1 dst_unused:UNUSED_PRESERVE src0_sel:WORD_1
v_rcp_f16_sdwa v151, v150 dst_sel:WORD_1 dst_unused:UNUSED_PRESERVE src0_sel:WORD_1
s_waitcnt lgkmcnt(9)
v_mfma_f32_16x16x32_bf16 v[4:7], v[232:235], v[204:207], v[4:7]
ds_read_b128 v[228:231], v248 offset:59392
v_rcp_f16_sdwa v148, v147 dst_sel:WORD_1 dst_unused:UNUSED_PRESERVE src0_sel:WORD_1
v_fma_mix_f32 v161, v136, v136, v161 op_sel:[0,0,0] op_sel_hi:[1,1,0]
s_setprio 1
v_rcp_f16_sdwa v145, v144 dst_sel:WORD_1 dst_unused:UNUSED_PRESERVE src0_sel:WORD_1
v_mfma_f32_32x32x16_bf16 v[120:135], v[92:95], v[236:239], v[120:135]
ds_read_b128 v[232:235], v248 offset:62464
v_fma_mix_f32 v161, v137, v137, v161 op_sel:[1,1,0] op_sel_hi:[1,1,0]
v_pk_mul_f16 v155, v155, v154
v_fma_mix_f32 v161, v138, v138, v161 op_sel:[0,0,0] op_sel_hi:[1,1,0]
v_pk_mul_f16 v152, v152, v151
v_pk_mul_f16 v149, v149, v148
v_fma_mix_f32 v161, v139, v139, v161 op_sel:[1,1,0] op_sel_hi:[1,1,0]
v_pk_mul_f16 v146, v146, v145
v_fma_mix_f32 v161, v155, v155, v161 op_sel:[0,0,0] op_sel_hi:[1,1,0]
v_fma_mix_f32 v161, v140, v140, v161 op_sel:[0,0,0] op_sel_hi:[1,1,0]
v_mfma_f32_16x16x32_bf16 v[20:23], v[216:219], v[208:211], v[20:23]
ds_read_b64 v[236:237], v245 offset:1344
ds_read_b64 v[238:239], v246 offset:1344
ds_read_b128 v[196:199], v242 offset:64
v_fma_mix_f32 v161, v155, v155, v161 op_sel:[1,1,0] op_sel_hi:[1,1,0]
v_fma_mix_f32 v161, v152, v152, v161 op_sel:[0,0,0] op_sel_hi:[1,1,0]
s_waitcnt lgkmcnt(5)
v_fma_mix_f32 v161, v141, v141, v161 op_sel:[1,1,0] op_sel_hi:[1,1,0]
v_fma_mix_f32 v161, v152, v152, v161 op_sel:[1,1,0] op_sel_hi:[1,1,0]
v_fma_mix_f32 v161, v149, v149, v161 op_sel:[0,0,0] op_sel_hi:[1,1,0]
v_mfma_f32_16x16x32_bf16 v[36:39], v[220:223], v[212:215], v[36:39]
ds_read_b128 v[216:219], v248 offset:60416
v_fma_mix_f32 v161, v142, v142, v161 op_sel:[0,0,0] op_sel_hi:[1,1,0]
v_fma_mix_f32 v161, v149, v149, v161 op_sel:[1,1,0] op_sel_hi:[1,1,0]
v_fma_mix_f32 v161, v146, v146, v161 op_sel:[0,0,0] op_sel_hi:[1,1,0]
v_fma_mix_f32 v161, v143, v143, v161 op_sel:[1,1,0] op_sel_hi:[1,1,0]
v_fma_mix_f32 v161, v146, v146, v161 op_sel:[1,1,0] op_sel_hi:[1,1,0]
v_mfma_f32_16x16x32_bf16 v[12:15], v[224:227], v[192:195], 0
s_add_u32 s46, s80, 23068672
buffer_store_dwordx4 v[92:95], v241, s[32:35], s46 offen
ds_read_b128 v[220:223], v248 offset:63488
v_cvt_pkrtz_f16_f32 v137, v120, v121
v_cvt_pkrtz_f16_f32 v139, v122, v123
v_cvt_pkrtz_f16_f32 v141, v124, v125
v_cvt_pkrtz_f16_f32 v143, v126, v127
v_cvt_pk_f16_f32 v155, v128, v129
v_cvt_pk_f16_f32 v152, v130, v131
v_cvt_pk_f16_f32 v149, v132, v133
v_cvt_pk_f16_f32 v146, v134, v135
s_waitcnt lgkmcnt(2)
v_mfma_f32_32x32x16_bf16 v[120:135], v[72:75], v[228:231], 0
ds_read_b64 v[224:225], v245 offset:2112
ds_read_b64 v[226:227], v246 offset:2112
ds_read_b128 v[200:203], v242 offset:128
v_pk_fma_f16 v154, v155, v155, s48
v_and_b32 v137, s49, v137
v_pk_fma_f16 v151, v152, v152, s48
v_pk_fma_f16 v148, v149, v149, s48
v_and_b32_e64 v139, s49, v139
v_pk_fma_f16 v145, v146, v146, s48
v_mfma_f32_32x32x16_bf16 v[120:135], v[76:79], v[232:235], v[120:135]
ds_read_b128 v[228:231], v248 offset:61440
v_pk_mul_f16 v154, v155, v154
v_bfe_u32 v136, v137, 2, 14
v_pk_mul_f16 v151, v152, v151
v_pk_mul_f16 v148, v149, v148
v_bfe_u32 v138, v139, 2, 14
v_pk_mul_f16 v145, v146, v145
v_exp_f16_e64 v153, v154
v_lshrrev_b32 v137, 18, v137
v_mfma_f32_16x16x32_bf16 v[28:31], v[236:239], v[196:199], 0
ds_read_b64 v[232:233], v245 offset:2880
ds_read_b64 v[234:235], v246 offset:2880
v_xor_b32 v243, 32, v243
ds_read_b128 v[204:207], v243
ds_read_u16_d16 v136, v136
ds_read_u16_d16 v138, v138
ds_read_u16_d16_hi v137, v137
v_exp_f16 v150, v151
v_lshrrev_b32 v139, 18, v139
v_exp_f16 v147, v148
s_waitcnt lgkmcnt(7)
v_mfma_f32_32x32x16_bf16 v[120:135], v[80:83], v[216:219], v[120:135]
ds_read_b128 v[236:239], v248 offset:64512
ds_read_u16_d16_hi v139, v139
v_and_b32 v141, s49, v141
v_exp_f16 v144, v145
v_and_b32_e64 v143, s49, v143
v_exp_f16_sdwa v153, v154 dst_sel:WORD_1 dst_unused:UNUSED_PRESERVE src0_sel:WORD_1
v_bfe_u32 v140, v141, 2, 14
v_exp_f16_sdwa v150, v151 dst_sel:WORD_1 dst_unused:UNUSED_PRESERVE src0_sel:WORD_1
v_mfma_f32_32x32x16_bf16 v[120:135], v[84:87], v[220:223], v[120:135]
ds_read_b64 v[216:217], v245 offset:3648
ds_read_b64 v[218:219], v246 offset:3648
ds_read_b128 v[208:211], v243 offset:64
ds_read_u16_d16 v140, v140
v_bfe_u32 v142, v143, 2, 14
v_exp_f16_sdwa v147, v148 dst_sel:WORD_1 dst_unused:UNUSED_PRESERVE src0_sel:WORD_1
v_lshrrev_b32_e64 v141, 18, v141
v_exp_f16_sdwa v144, v145 dst_sel:WORD_1 dst_unused:UNUSED_PRESERVE src0_sel:WORD_1
v_lshrrev_b32_e64 v143, 18, v143
v_pk_add_f16 v153, v153, 1.0 op_sel_hi:[1,0]
v_pk_add_f16 v150, v150, 1.0 op_sel_hi:[1,0]
v_mfma_f32_16x16x32_bf16 v[44:47], v[224:227], v[200:203], 0
ds_read_b64 v[220:221], v245 offset:4416
ds_read_b64 v[222:223], v246 offset:4416
ds_read_b128 v[212:215], v243 offset:128
ds_read_u16_d16 v142, v142
ds_read_u16_d16_hi v141, v141
ds_read_u16_d16_hi v143, v143
v_pk_add_f16 v147, v147, 1.0 op_sel_hi:[1,0]
v_pk_add_f16 v144, v144, 1.0 op_sel_hi:[1,0]
v_rcp_f16 v154, v153
s_waitcnt lgkmcnt(10)
v_mfma_f32_32x32x16_bf16 v[120:135], v[88:91], v[228:231], v[120:135]
ds_read_b64 v[224:225], v245 offset:5184
ds_read_b64 v[226:227], v246 offset:5184
v_xor_b32 v244, 32, v244
ds_read_b128 v[192:195], v244
v_rcp_f16 v151, v150
v_rcp_f16 v148, v147
v_rcp_f16 v145, v144
v_rcp_f16_sdwa v154, v153 dst_sel:WORD_1 dst_unused:UNUSED_PRESERVE src0_sel:WORD_1
v_rcp_f16_sdwa v151, v150 dst_sel:WORD_1 dst_unused:UNUSED_PRESERVE src0_sel:WORD_1
v_mfma_f32_16x16x32_bf16 v[12:15], v[232:235], v[204:207], v[12:15]
ds_read_b128 v[228:231], v249
v_rcp_f16_sdwa v148, v147 dst_sel:WORD_1 dst_unused:UNUSED_PRESERVE src0_sel:WORD_1
v_fma_mix_f32 v162, v136, v136, v162 op_sel:[0,0,0] op_sel_hi:[1,1,0]
v_rcp_f16_sdwa v145, v144 dst_sel:WORD_1 dst_unused:UNUSED_PRESERVE src0_sel:WORD_1
v_mfma_f32_32x32x16_bf16 v[120:135], v[92:95], v[236:239], v[120:135]
ds_read_b128 v[232:235], v249 offset:3072
v_fma_mix_f32 v162, v137, v137, v162 op_sel:[1,1,0] op_sel_hi:[1,1,0]
v_pk_mul_f16 v155, v155, v154
v_fma_mix_f32 v162, v138, v138, v162 op_sel:[0,0,0] op_sel_hi:[1,1,0]
v_pk_mul_f16 v152, v152, v151
v_pk_mul_f16 v149, v149, v148
v_fma_mix_f32 v162, v139, v139, v162 op_sel:[1,1,0] op_sel_hi:[1,1,0]
v_pk_mul_f16 v146, v146, v145
v_fma_mix_f32 v162, v155, v155, v162 op_sel:[0,0,0] op_sel_hi:[1,1,0]
s_waitcnt lgkmcnt(5)
v_fma_mix_f32 v162, v140, v140, v162 op_sel:[0,0,0] op_sel_hi:[1,1,0]
v_mfma_f32_16x16x32_bf16 v[28:31], v[216:219], v[208:211], v[28:31]
ds_read_b64 v[236:237], v245 offset:5952
ds_read_b64 v[238:239], v246 offset:5952
ds_read_b128 v[196:199], v244 offset:64
v_fma_mix_f32 v162, v155, v155, v162 op_sel:[1,1,0] op_sel_hi:[1,1,0]
v_fma_mix_f32 v162, v152, v152, v162 op_sel:[0,0,0] op_sel_hi:[1,1,0]
v_fma_mix_f32 v162, v141, v141, v162 op_sel:[1,1,0] op_sel_hi:[1,1,0]
v_fma_mix_f32 v162, v152, v152, v162 op_sel:[1,1,0] op_sel_hi:[1,1,0]
v_fma_mix_f32 v162, v149, v149, v162 op_sel:[0,0,0] op_sel_hi:[1,1,0]
v_mfma_f32_16x16x32_bf16 v[44:47], v[220:223], v[212:215], v[44:47]
ds_read_b128 v[216:219], v249 offset:1024
v_fma_mix_f32 v162, v142, v142, v162 op_sel:[0,0,0] op_sel_hi:[1,1,0]
v_fma_mix_f32 v162, v149, v149, v162 op_sel:[1,1,0] op_sel_hi:[1,1,0]
v_fma_mix_f32 v162, v146, v146, v162 op_sel:[0,0,0] op_sel_hi:[1,1,0]
v_fma_mix_f32 v162, v143, v143, v162 op_sel:[1,1,0] op_sel_hi:[1,1,0]
v_fma_mix_f32 v162, v146, v146, v162 op_sel:[1,1,0] op_sel_hi:[1,1,0]
s_waitcnt lgkmcnt(4)
v_mfma_f32_16x16x32_bf16 v[12:15], v[224:227], v[192:195], v[12:15]
ds_read_b128 v[220:223], v249 offset:4096
v_cvt_pkrtz_f16_f32 v137, v120, v121
v_cvt_pkrtz_f16_f32 v139, v122, v123
v_cvt_pkrtz_f16_f32 v141, v124, v125
v_cvt_pkrtz_f16_f32 v143, v126, v127
v_cvt_pk_f16_f32 v155, v128, v129
v_cvt_pk_f16_f32 v152, v130, v131
v_cvt_pk_f16_f32 v149, v132, v133
v_cvt_pk_f16_f32 v146, v134, v135
v_mfma_f32_32x32x16_bf16 v[120:135], v[72:75], v[228:231], 0
ds_read_b64 v[224:225], v245 offset:6720
ds_read_b64 v[226:227], v246 offset:6720
ds_read_b128 v[200:203], v244 offset:128
v_pk_fma_f16 v154, v155, v155, s48
v_and_b32_e64 v137, s49, v137
v_pk_fma_f16 v151, v152, v152, s48
v_pk_fma_f16 v148, v149, v149, s48
v_and_b32_e64 v139, s49, v139
v_pk_fma_f16 v145, v146, v146, s48
v_mfma_f32_32x32x16_bf16 v[120:135], v[76:79], v[232:235], v[120:135]
ds_read_b128 v[228:231], v249 offset:2048
v_pk_mul_f16 v154, v155, v154
v_bfe_u32 v136, v137, 2, 14
v_pk_mul_f16 v151, v152, v151
v_pk_mul_f16 v148, v149, v148
v_bfe_u32 v138, v139, 2, 14
v_pk_mul_f16 v145, v146, v145
v_exp_f16 v153, v154
v_lshrrev_b32 v137, 18, v137
s_waitcnt lgkmcnt(4)
v_mfma_f32_16x16x32_bf16 v[28:31], v[236:239], v[196:199], v[28:31]
ds_read_b64 v[232:233], v245 offset:384
ds_read_b64 v[234:235], v246 offset:384
v_xor_b32 v242, 16, v242
ds_read_b128 v[204:207], v242
ds_read_u16_d16 v136, v136
ds_read_u16_d16 v138, v138
ds_read_u16_d16_hi v137, v137
v_exp_f16 v150, v151
v_lshrrev_b32 v139, 18, v139
v_exp_f16_e64 v147, v148
v_mfma_f32_32x32x16_bf16 v[120:135], v[80:83], v[216:219], v[120:135]
ds_read_b128 v[236:239], v249 offset:5120
ds_read_u16_d16_hi v139, v139
v_and_b32 v141, s49, v141
v_exp_f16 v144, v145
v_and_b32_e64 v143, s49, v143
v_exp_f16_sdwa v153, v154 dst_sel:WORD_1 dst_unused:UNUSED_PRESERVE src0_sel:WORD_1
v_bfe_u32 v140, v141, 2, 14
v_exp_f16_sdwa v150, v151 dst_sel:WORD_1 dst_unused:UNUSED_PRESERVE src0_sel:WORD_1
v_mfma_f32_32x32x16_bf16 v[120:135], v[84:87], v[220:223], v[120:135]
ds_read_b64 v[216:217], v245 offset:1152
ds_read_b64 v[218:219], v246 offset:1152
ds_read_b128 v[208:211], v242 offset:64
ds_read_u16_d16 v140, v140
v_bfe_u32 v142, v143, 2, 14
v_exp_f16_sdwa v147, v148 dst_sel:WORD_1 dst_unused:UNUSED_PRESERVE src0_sel:WORD_1
v_lshrrev_b32_e64 v141, 18, v141
v_exp_f16_sdwa v144, v145 dst_sel:WORD_1 dst_unused:UNUSED_PRESERVE src0_sel:WORD_1
v_lshrrev_b32 v143, 18, v143
v_pk_add_f16 v153, v153, 1.0 op_sel_hi:[1,0]
v_pk_add_f16 v150, v150, 1.0 op_sel_hi:[1,0]
s_waitcnt lgkmcnt(6)
v_mfma_f32_16x16x32_bf16 v[44:47], v[224:227], v[200:203], v[44:47]
ds_read_b64 v[220:221], v245 offset:1920
ds_read_b64 v[222:223], v246 offset:1920
ds_read_b128 v[212:215], v242 offset:128
ds_read_u16_d16 v142, v142
ds_read_u16_d16_hi v141, v141
ds_read_u16_d16_hi v143, v143
v_pk_add_f16 v147, v147, 1.0 op_sel_hi:[1,0]
v_pk_add_f16 v144, v144, 1.0 op_sel_hi:[1,0]
v_rcp_f16_e64 v154, v153
v_mfma_f32_32x32x16_bf16 v[120:135], v[88:91], v[228:231], v[120:135]
ds_read_b64 v[224:225], v245 offset:2688
ds_read_b64 v[226:227], v246 offset:2688
v_xor_b32 v243, 16, v243
ds_read_b128 v[192:195], v243
v_rcp_f16 v151, v150
v_rcp_f16 v148, v147
v_rcp_f16 v145, v144
v_rcp_f16_sdwa v154, v153 dst_sel:WORD_1 dst_unused:UNUSED_PRESERVE src0_sel:WORD_1
v_rcp_f16_sdwa v151, v150 dst_sel:WORD_1 dst_unused:UNUSED_PRESERVE src0_sel:WORD_1
v_mfma_f32_16x16x32_bf16 v[8:11], v[232:235], v[204:207], 0
ds_read_b128 v[228:231], v249 offset:6144
v_rcp_f16_sdwa v148, v147 dst_sel:WORD_1 dst_unused:UNUSED_PRESERVE src0_sel:WORD_1
v_fma_mix_f32 v163, v136, v136, v163 op_sel:[0,0,0] op_sel_hi:[1,1,0]
v_rcp_f16_sdwa v145, v144 dst_sel:WORD_1 dst_unused:UNUSED_PRESERVE src0_sel:WORD_1
s_waitcnt lgkmcnt(10)
v_mfma_f32_32x32x16_bf16 v[120:135], v[92:95], v[236:239], v[120:135]
ds_read_b128 v[232:235], v249 offset:9216
v_fma_mix_f32 v163, v137, v137, v163 op_sel:[1,1,0] op_sel_hi:[1,1,0]
v_pk_mul_f16 v155, v155, v154
v_fma_mix_f32 v163, v138, v138, v163 op_sel:[0,0,0] op_sel_hi:[1,1,0]
v_pk_mul_f16 v152, v152, v151
v_pk_mul_f16 v149, v149, v148
v_fma_mix_f32 v163, v139, v139, v163 op_sel:[1,1,0] op_sel_hi:[1,1,0]
v_pk_mul_f16 v146, v146, v145
v_fma_mix_f32 v163, v155, v155, v163 op_sel:[0,0,0] op_sel_hi:[1,1,0]
v_fma_mix_f32 v163, v140, v140, v163 op_sel:[0,0,0] op_sel_hi:[1,1,0]
v_mfma_f32_16x16x32_bf16 v[24:27], v[216:219], v[208:211], 0
ds_read_b64 v[236:237], v245 offset:3456
ds_read_b64 v[238:239], v246 offset:3456
ds_read_b128 v[196:199], v243 offset:64
v_fma_mix_f32 v163, v155, v155, v163 op_sel:[1,1,0] op_sel_hi:[1,1,0]
v_fma_mix_f32 v163, v152, v152, v163 op_sel:[0,0,0] op_sel_hi:[1,1,0]
s_waitcnt lgkmcnt(5)
v_fma_mix_f32 v163, v141, v141, v163 op_sel:[1,1,0] op_sel_hi:[1,1,0]
v_fma_mix_f32 v163, v152, v152, v163 op_sel:[1,1,0] op_sel_hi:[1,1,0]
v_fma_mix_f32 v163, v149, v149, v163 op_sel:[0,0,0] op_sel_hi:[1,1,0]
v_mfma_f32_16x16x32_bf16 v[40:43], v[220:223], v[212:215], 0
ds_read_b128 v[216:219], v249 offset:7168
v_fma_mix_f32 v163, v142, v142, v163 op_sel:[0,0,0] op_sel_hi:[1,1,0]
v_fma_mix_f32 v163, v149, v149, v163 op_sel:[1,1,0] op_sel_hi:[1,1,0]
v_fma_mix_f32 v163, v146, v146, v163 op_sel:[0,0,0] op_sel_hi:[1,1,0]
v_fma_mix_f32 v163, v143, v143, v163 op_sel:[1,1,0] op_sel_hi:[1,1,0]
v_fma_mix_f32 v163, v146, v146, v163 op_sel:[1,1,0] op_sel_hi:[1,1,0]
v_mfma_f32_16x16x32_bf16 v[8:11], v[224:227], v[192:195], v[8:11]
ds_read_b128 v[220:223], v249 offset:10240
v_cvt_pkrtz_f16_f32 v137, v120, v121
v_cvt_pkrtz_f16_f32 v139, v122, v123
v_cvt_pkrtz_f16_f32 v141, v124, v125
v_cvt_pkrtz_f16_f32 v143, v126, v127
v_cvt_pk_f16_f32 v155, v128, v129
v_cvt_pk_f16_f32 v152, v130, v131
v_cvt_pk_f16_f32 v149, v132, v133
v_cvt_pk_f16_f32 v146, v134, v135
s_waitcnt lgkmcnt(3)
v_mfma_f32_32x32x16_bf16 v[120:135], v[72:75], v[228:231], 0
ds_read_b64 v[224:225], v245 offset:4224
ds_read_b64 v[226:227], v246 offset:4224
ds_read_b128 v[200:203], v243 offset:128
s_setprio 0
v_pk_fma_f16 v154, v155, v155, s48
v_and_b32_e64 v137, s49, v137
v_pk_fma_f16 v151, v152, v152, s48
v_pk_fma_f16 v148, v149, v149, s48
v_mfma_f32_32x32x16_bf16 v[120:135], v[76:79], v[232:235], v[120:135]
ds_read_b128 v[228:231], v249 offset:8192
v_and_b32_e64 v139, s49, v139
v_pk_fma_f16 v145, v146, v146, s48
v_pk_mul_f16 v154, v155, v154
v_bfe_u32 v136, v137, 2, 14
v_pk_mul_f16 v151, v152, v151
v_pk_mul_f16 v148, v149, v148
v_bfe_u32 v138, v139, 2, 14
v_pk_mul_f16 v145, v146, v145
s_waitcnt lgkmcnt(4)
v_mfma_f32_16x16x32_bf16 v[24:27], v[236:239], v[196:199], v[24:27]
ds_read_b64 v[232:233], v245 offset:4992
ds_read_b64 v[234:235], v246 offset:4992
v_xor_b32 v244, 16, v244
ds_read_b128 v[204:207], v244
ds_read_u16_d16 v136, v136
ds_read_u16_d16 v138, v138
v_exp_f16 v153, v154
v_lshrrev_b32 v137, 18, v137
v_exp_f16_e64 v150, v151
v_mfma_f32_32x32x16_bf16 v[120:135], v[80:83], v[216:219], v[120:135]
ds_read_b128 v[236:239], v249 offset:11264
ds_read_u16_d16_hi v137, v137
v_lshrrev_b32 v139, 18, v139
v_exp_f16 v147, v148
v_and_b32 v141, s49, v141
v_exp_f16 v144, v145
v_and_b32_e64 v143, s49, v143
v_mfma_f32_32x32x16_bf16 v[120:135], v[84:87], v[220:223], v[120:135]
ds_read_b64 v[216:217], v245 offset:5760
ds_read_b64 v[218:219], v246 offset:5760
ds_read_b128 v[208:211], v244 offset:64
ds_read_u16_d16_hi v139, v139
v_exp_f16_sdwa v153, v154 dst_sel:WORD_1 dst_unused:UNUSED_PRESERVE src0_sel:WORD_1
v_bfe_u32 v140, v141, 2, 14
v_exp_f16_sdwa v150, v151 dst_sel:WORD_1 dst_unused:UNUSED_PRESERVE src0_sel:WORD_1
v_bfe_u32 v142, v143, 2, 14
v_exp_f16_sdwa v147, v148 dst_sel:WORD_1 dst_unused:UNUSED_PRESERVE src0_sel:WORD_1
v_lshrrev_b32 v141, 18, v141
s_waitcnt lgkmcnt(8)
v_mfma_f32_16x16x32_bf16 v[40:43], v[224:227], v[200:203], v[40:43]
ds_read_b64 v[220:221], v245 offset:6528
ds_read_b64 v[222:223], v246 offset:6528
ds_read_b128 v[212:215], v244 offset:128
ds_read_u16_d16 v140, v140
ds_read_u16_d16 v142, v142
ds_read_u16_d16_hi v141, v141
v_exp_f16_sdwa v144, v145 dst_sel:WORD_1 dst_unused:UNUSED_PRESERVE src0_sel:WORD_1
v_lshrrev_b32_e64 v143, 18, v143
v_pk_add_f16 v153, v153, 1.0 op_sel_hi:[1,0]
v_pk_add_f16 v150, v150, 1.0 op_sel_hi:[1,0]
v_mfma_f32_32x32x16_bf16 v[120:135], v[88:91], v[228:231], v[120:135]
ds_read_b128 v[224:227], v249 offset:12288
ds_read_u16_d16_hi v143, v143
v_pk_add_f16 v147, v147, 1.0 op_sel_hi:[1,0]
v_pk_add_f16 v144, v144, 1.0 op_sel_hi:[1,0]
v_rcp_f16 v154, v153
v_rcp_f16 v151, v150
v_rcp_f16_e64 v148, v147
v_mfma_f32_16x16x32_bf16 v[8:11], v[232:235], v[204:207], v[8:11]
ds_read_b128 v[228:231], v249 offset:15360
v_rcp_f16 v145, v144
v_rcp_f16_sdwa v154, v153 dst_sel:WORD_1 dst_unused:UNUSED_PRESERVE src0_sel:WORD_1
s_waitcnt lgkmcnt(9)
v_mfma_f32_32x32x16_bf16 v[120:135], v[92:95], v[236:239], v[120:135]
ds_read_b128 v[232:235], v249 offset:13312
v_rcp_f16_sdwa v151, v150 dst_sel:WORD_1 dst_unused:UNUSED_PRESERVE src0_sel:WORD_1
v_rcp_f16_sdwa v148, v147 dst_sel:WORD_1 dst_unused:UNUSED_PRESERVE src0_sel:WORD_1
v_fma_mix_f32 v164, v136, v136, v164 op_sel:[0,0,0] op_sel_hi:[1,1,0]
v_rcp_f16_sdwa v145, v144 dst_sel:WORD_1 dst_unused:UNUSED_PRESERVE src0_sel:WORD_1
v_fma_mix_f32 v164, v137, v137, v164 op_sel:[1,1,0] op_sel_hi:[1,1,0]
v_pk_mul_f16 v155, v155, v154
v_mfma_f32_16x16x32_bf16 v[24:27], v[216:219], v[208:211], v[24:27]
ds_read_b128 v[236:239], v249 offset:16384
v_fma_mix_f32 v164, v138, v138, v164 op_sel:[0,0,0] op_sel_hi:[1,1,0]
v_pk_mul_f16 v152, v152, v151
v_pk_mul_f16 v149, v149, v148
v_fma_mix_f32 v164, v139, v139, v164 op_sel:[1,1,0] op_sel_hi:[1,1,0]
s_waitcnt lgkmcnt(3)
v_mfma_f32_16x16x32_bf16 v[40:43], v[220:223], v[212:215], v[40:43]
ds_read_b128 v[216:219], v249 offset:14336
v_pk_mul_f16 v146, v146, v145
v_fma_mix_f32 v164, v155, v155, v164 op_sel:[0,0,0] op_sel_hi:[1,1,0]
v_fma_mix_f32 v164, v140, v140, v164 op_sel:[0,0,0] op_sel_hi:[1,1,0]
v_fma_mix_f32 v164, v155, v155, v164 op_sel:[1,1,0] op_sel_hi:[1,1,0]
v_fma_mix_f32 v164, v152, v152, v164 op_sel:[0,0,0] op_sel_hi:[1,1,0]
v_fma_mix_f32 v164, v141, v141, v164 op_sel:[1,1,0] op_sel_hi:[1,1,0]
v_fma_mix_f32 v164, v152, v152, v164 op_sel:[1,1,0] op_sel_hi:[1,1,0]
v_fma_mix_f32 v164, v149, v149, v164 op_sel:[0,0,0] op_sel_hi:[1,1,0]
v_fma_mix_f32 v164, v142, v142, v164 op_sel:[0,0,0] op_sel_hi:[1,1,0]
v_fma_mix_f32 v164, v149, v149, v164 op_sel:[1,1,0] op_sel_hi:[1,1,0]
v_fma_mix_f32 v164, v146, v146, v164 op_sel:[0,0,0] op_sel_hi:[1,1,0]
v_fma_mix_f32 v164, v143, v143, v164 op_sel:[1,1,0] op_sel_hi:[1,1,0]
v_fma_mix_f32 v164, v146, v146, v164 op_sel:[1,1,0] op_sel_hi:[1,1,0]
s_setprio 3
v_pk_add_f32 v[168:169], v[0:1], v[2:3]
v_pk_mul_f32 v[170:171], v[0:1], v[0:1]
v_pk_fma_f32 v[170:171], v[2:3], v[2:3], v[170:171]
v_pk_add_f32 v[168:169], v[168:169], v[4:5]
v_pk_fma_f32 v[170:171], v[4:5], v[4:5], v[170:171]
v_pk_add_f32 v[168:169], v[168:169], v[6:7]
v_pk_fma_f32 v[170:171], v[6:7], v[6:7], v[170:171]
v_pk_add_f32 v[168:169], v[168:169], v[8:9]
v_pk_fma_f32 v[170:171], v[8:9], v[8:9], v[170:171]
v_pk_add_f32 v[168:169], v[168:169], v[10:11]
v_pk_fma_f32 v[170:171], v[10:11], v[10:11], v[170:171]
v_pk_add_f32 v[168:169], v[168:169], v[12:13]
v_pk_fma_f32 v[170:171], v[12:13], v[12:13], v[170:171]
v_pk_add_f32 v[168:169], v[168:169], v[14:15]
v_pk_fma_f32 v[170:171], v[14:15], v[14:15], v[170:171]
v_pk_add_f32 v[168:169], v[168:169], v[16:17]
v_pk_fma_f32 v[170:171], v[16:17], v[16:17], v[170:171]
v_pk_add_f32 v[168:169], v[168:169], v[18:19]
v_pk_fma_f32 v[170:171], v[18:19], v[18:19], v[170:171]
v_pk_add_f32 v[168:169], v[168:169], v[20:21]
v_pk_fma_f32 v[170:171], v[20:21], v[20:21], v[170:171]
v_pk_add_f32 v[168:169], v[168:169], v[22:23]
v_pk_fma_f32 v[170:171], v[22:23], v[22:23], v[170:171]
v_pk_add_f32 v[168:169], v[168:169], v[24:25]
v_pk_fma_f32 v[170:171], v[24:25], v[24:25], v[170:171]
v_pk_add_f32 v[168:169], v[168:169], v[26:27]
v_pk_fma_f32 v[170:171], v[26:27], v[26:27], v[170:171]
v_pk_add_f32 v[168:169], v[168:169], v[28:29]
v_pk_fma_f32 v[170:171], v[28:29], v[28:29], v[170:171]
v_pk_add_f32 v[168:169], v[168:169], v[30:31]
v_pk_fma_f32 v[170:171], v[30:31], v[30:31], v[170:171]
v_pk_add_f32 v[168:169], v[168:169], v[32:33]
v_pk_fma_f32 v[170:171], v[32:33], v[32:33], v[170:171]
v_pk_add_f32 v[168:169], v[168:169], v[34:35]
v_pk_fma_f32 v[170:171], v[34:35], v[34:35], v[170:171]
v_pk_add_f32 v[168:169], v[168:169], v[36:37]
v_pk_fma_f32 v[170:171], v[36:37], v[36:37], v[170:171]
v_pk_add_f32 v[168:169], v[168:169], v[38:39]
v_pk_fma_f32 v[170:171], v[38:39], v[38:39], v[170:171]
v_pk_add_f32 v[168:169], v[168:169], v[40:41]
v_pk_fma_f32 v[170:171], v[40:41], v[40:41], v[170:171]
v_pk_add_f32 v[168:169], v[168:169], v[42:43]
v_pk_fma_f32 v[170:171], v[42:43], v[42:43], v[170:171]
v_pk_add_f32 v[168:169], v[168:169], v[44:45]
v_pk_fma_f32 v[170:171], v[44:45], v[44:45], v[170:171]
v_pk_add_f32 v[168:169], v[168:169], v[46:47]
v_pk_fma_f32 v[170:171], v[46:47], v[46:47], v[170:171]
s_setprio 0
s_barrier
v_add_u32 v247, -36864, v242
v_subrev_u32 v252, 66560, v247
v_min_u32_e64 v247, v247, v252
v_add_u32 v247, 90112, v247
v_sub_u32 v252, v247, v242
v_add_u32 v242, v252, v242
v_add_u32_e64 v243, v252, v243
v_add_u32 v244, v252, v244
s_setprio 2
v_cvt_pkrtz_f16_f32 v137, v120, v121
v_cvt_pkrtz_f16_f32 v139, v122, v123
v_cvt_pkrtz_f16_f32 v141, v124, v125
v_cvt_pkrtz_f16_f32 v143, v126, v127
v_cvt_pkrtz_f16_f32 v145, v128, v129
v_cvt_pk_f16_f32 v155, v130, v131
v_cvt_pk_f16_f32 v152, v132, v133
v_cvt_pk_f16_f32 v149, v134, v135
s_add_u32 m0, s67, 39936
s_add_u32 s66, s66, 98304
buffer_load_dwordx4 v240, s[4:7], s66 offen lds
ds_read_b128 v[220:223], v249 offset:17408
v_mfma_f32_32x32x16_bf16 v[120:135], v[72:75], v[224:227], 0
v_pk_fma_f16 v154, v155, v155, s48
v_add_f32 v168, v168, v169
v_and_b32 v137, s49, v137
v_pk_fma_f16 v151, v152, v152, s48
v_and_b32_e64 v139, s49, v139
v_pk_fma_f16 v148, v149, v149, s48
v_add_f32_e64 v170, v170, v171
v_pk_mul_f16 v154, v155, v154
v_bfe_u32 v136, v137, 2, 14
v_pk_mul_f16 v151, v152, v151
v_pk_mul_f16 v148, v149, v148
v_bfe_u32 v138, v139, 2, 14
s_waitcnt lgkmcnt(1)
ds_read_b128 v[224:227], v249 offset:18432
ds_read_u16_d16 v136, v136
ds_read_u16_d16 v138, v138
v_mfma_f32_32x32x16_bf16 v[120:135], v[76:79], v[228:231], v[120:135]
v_permlane32_swap_b32 v168, v170
v_exp_f16 v153, v154
v_lshrrev_b32 v137, 18, v137
v_exp_f16 v150, v151
v_add_f32 v168, v168, v170
v_lshrrev_b32 v139, 18, v139
v_exp_f16 v147, v148
v_and_b32 v141, s49, v141
v_and_b32 v143, s49, v143
v_mul_f32 v168, 1009429163, v168
s_add_u32 m0, s67, 46592
s_add_u32 s66, s66, 98304
buffer_load_dwordx4 v240, s[4:7], s66 offen lds
ds_read_b128 v[228:231], v249 offset:21504
ds_read_u16_d16_hi v137, v137
ds_read_u16_d16_hi v139, v139
v_mfma_f32_32x32x16_bf16 v[120:135], v[80:83], v[232:235], v[120:135]
v_exp_f16_sdwa v153, v154 dst_sel:WORD_1 dst_unused:UNUSED_PRESERVE src0_sel:WORD_1
v_bfe_u32 v140, v141, 2, 14
v_exp_f16_sdwa v150, v151 dst_sel:WORD_1 dst_unused:UNUSED_PRESERVE src0_sel:WORD_1
v_mov_b32_e64 v170, v168
v_bfe_u32 v142, v143, 2, 14
v_exp_f16_sdwa v147, v148 dst_sel:WORD_1 dst_unused:UNUSED_PRESERVE src0_sel:WORD_1
v_lshrrev_b32 v141, 18, v141
v_permlane32_swap_b32 v168, v170
v_pk_add_f16 v153, v153, 1.0 op_sel_hi:[1,0]
ds_read_b128 v[232:235], v249 offset:19456
ds_read_u16_d16 v140, v140
ds_read_u16_d16 v142, v142
ds_read_u16_d16_hi v141, v141
v_mfma_f32_32x32x16_bf16 v[120:135], v[84:87], v[236:239], v[120:135]
v_lshrrev_b32_e64 v143, 18, v143
v_pk_add_f16 v150, v150, 1.0 op_sel_hi:[1,0]
v_pk_add_f16 v147, v147, 1.0 op_sel_hi:[1,0]
v_and_b32_e64 v145, s49, v145
v_fma_f32 v170, -v168, v168, v170
v_rcp_f16_e64 v154, v153
v_bfe_u32 v144, v145, 2, 14
v_rcp_f16 v151, v150
v_max_f32 v170, 0, v170
v_lshrrev_b32_e64 v145, 18, v145
s_add_u32 m0, s67, 53248
s_add_u32 s66, s66, 98304
buffer_load_dwordx4 v240, s[4:7], s66 offen lds
ds_read_b128 v[236:239], v249 offset:22528
ds_read_u16_d16_hi v143, v143
ds_read_u16_d16 v144, v144
ds_read_u16_d16_hi v145, v145
v_mfma_f32_32x32x16_bf16 v[120:135], v[88:91], v[216:219], v[120:135]
v_rcp_f16 v148, v147
v_rcp_f16_sdwa v154, v153 dst_sel:WORD_1 dst_unused:UNUSED_PRESERVE src0_sel:WORD_1
v_add_f32 v170, 925353388, v170
s_waitcnt lgkmcnt(6)
v_fma_mix_f32 v165, v136, v136, v165 op_sel:[0,0,0] op_sel_hi:[1,1,0]
v_fma_mix_f32 v165, v137, v137, v165 op_sel:[1,1,0] op_sel_hi:[1,1,0]
v_rcp_f16_sdwa v151, v150 dst_sel:WORD_1 dst_unused:UNUSED_PRESERVE src0_sel:WORD_1
v_rsq_f32_e64 v170, v170
v_fma_mix_f32 v165, v138, v138, v165 op_sel:[0,0,0] op_sel_hi:[1,1,0]
ds_read_b128 v[216:219], v249 offset:20480
v_mfma_f32_32x32x16_bf16 v[120:135], v[92:95], v[220:223], v[120:135]
v_rcp_f16_sdwa v148, v147 dst_sel:WORD_1 dst_unused:UNUSED_PRESERVE src0_sel:WORD_1
v_fma_mix_f32 v165, v139, v139, v165 op_sel:[1,1,0] op_sel_hi:[1,1,0]
v_pk_mul_f16 v155, v155, v154
v_fma_mix_f32 v165, v140, v140, v165 op_sel:[0,0,0] op_sel_hi:[1,1,0]
v_pk_mul_f16 v152, v152, v151
s_waitcnt lgkmcnt(5)
v_fma_mix_f32 v165, v141, v141, v165 op_sel:[1,1,0] op_sel_hi:[1,1,0]
v_pk_mul_f16 v149, v149, v148
v_fma_mix_f32 v165, v155, v155, v165 op_sel:[0,0,0] op_sel_hi:[1,1,0]
v_mul_f32 v172, 3203391086, v170
v_fma_mix_f32 v165, v142, v142, v165 op_sel:[0,0,0] op_sel_hi:[1,1,0]
v_fma_mix_f32 v165, v155, v155, v165 op_sel:[1,1,0] op_sel_hi:[1,1,0]
s_waitcnt lgkmcnt(1)
v_fma_mix_f32 v165, v143, v143, v165 op_sel:[1,1,0] op_sel_hi:[1,1,0]
v_fma_mix_f32 v165, v152, v152, v165 op_sel:[0,0,0] op_sel_hi:[1,1,0]
v_fma_mix_f32 v165, v152, v152, v165 op_sel:[1,1,0] op_sel_hi:[1,1,0]
v_mul_f32 v173, v168, v172
v_fma_mix_f32 v165, v144, v144, v165 op_sel:[0,0,0] op_sel_hi:[1,1,0]
v_fma_mix_f32 v165, v149, v149, v165 op_sel:[0,0,0] op_sel_hi:[1,1,0]
v_fma_mix_f32 v165, v145, v145, v165 op_sel:[1,1,0] op_sel_hi:[1,1,0]
v_fma_mix_f32 v165, v149, v149, v165 op_sel:[1,1,0] op_sel_hi:[1,1,0]
s_setprio 3
v_pk_fma_f32 v[0:1], v[0:1], v[172:173], v[172:173] op_sel:[0,0,1] op_sel_hi:[1,0,1] neg_lo:[0,0,1] neg_hi:[0,0,1]
v_pk_fma_f32 v[2:3], v[2:3], v[172:173], v[172:173] op_sel:[0,0,1] op_sel_hi:[1,0,1] neg_lo:[0,0,1] neg_hi:[0,0,1]
v_pk_fma_f32 v[4:5], v[4:5], v[172:173], v[172:173] op_sel:[0,0,1] op_sel_hi:[1,0,1] neg_lo:[0,0,1] neg_hi:[0,0,1]
v_pk_fma_f32 v[6:7], v[6:7], v[172:173], v[172:173] op_sel:[0,0,1] op_sel_hi:[1,0,1] neg_lo:[0,0,1] neg_hi:[0,0,1]
v_pk_fma_f32 v[8:9], v[8:9], v[172:173], v[172:173] op_sel:[0,0,1] op_sel_hi:[1,0,1] neg_lo:[0,0,1] neg_hi:[0,0,1]
v_pk_fma_f32 v[10:11], v[10:11], v[172:173], v[172:173] op_sel:[0,0,1] op_sel_hi:[1,0,1] neg_lo:[0,0,1] neg_hi:[0,0,1]
v_pk_fma_f32 v[12:13], v[12:13], v[172:173], v[172:173] op_sel:[0,0,1] op_sel_hi:[1,0,1] neg_lo:[0,0,1] neg_hi:[0,0,1]
v_pk_fma_f32 v[14:15], v[14:15], v[172:173], v[172:173] op_sel:[0,0,1] op_sel_hi:[1,0,1] neg_lo:[0,0,1] neg_hi:[0,0,1]
v_pk_fma_f32 v[16:17], v[16:17], v[172:173], v[172:173] op_sel:[0,0,1] op_sel_hi:[1,0,1] neg_lo:[0,0,1] neg_hi:[0,0,1]
v_pk_fma_f32 v[18:19], v[18:19], v[172:173], v[172:173] op_sel:[0,0,1] op_sel_hi:[1,0,1] neg_lo:[0,0,1] neg_hi:[0,0,1]
v_pk_fma_f32 v[20:21], v[20:21], v[172:173], v[172:173] op_sel:[0,0,1] op_sel_hi:[1,0,1] neg_lo:[0,0,1] neg_hi:[0,0,1]
v_pk_fma_f32 v[22:23], v[22:23], v[172:173], v[172:173] op_sel:[0,0,1] op_sel_hi:[1,0,1] neg_lo:[0,0,1] neg_hi:[0,0,1]
v_pk_fma_f32 v[24:25], v[24:25], v[172:173], v[172:173] op_sel:[0,0,1] op_sel_hi:[1,0,1] neg_lo:[0,0,1] neg_hi:[0,0,1]
v_pk_fma_f32 v[26:27], v[26:27], v[172:173], v[172:173] op_sel:[0,0,1] op_sel_hi:[1,0,1] neg_lo:[0,0,1] neg_hi:[0,0,1]
v_pk_fma_f32 v[28:29], v[28:29], v[172:173], v[172:173] op_sel:[0,0,1] op_sel_hi:[1,0,1] neg_lo:[0,0,1] neg_hi:[0,0,1]
v_pk_fma_f32 v[30:31], v[30:31], v[172:173], v[172:173] op_sel:[0,0,1] op_sel_hi:[1,0,1] neg_lo:[0,0,1] neg_hi:[0,0,1]
v_pk_fma_f32 v[32:33], v[32:33], v[172:173], v[172:173] op_sel:[0,0,1] op_sel_hi:[1,0,1] neg_lo:[0,0,1] neg_hi:[0,0,1]
v_pk_fma_f32 v[34:35], v[34:35], v[172:173], v[172:173] op_sel:[0,0,1] op_sel_hi:[1,0,1] neg_lo:[0,0,1] neg_hi:[0,0,1]
v_pk_fma_f32 v[36:37], v[36:37], v[172:173], v[172:173] op_sel:[0,0,1] op_sel_hi:[1,0,1] neg_lo:[0,0,1] neg_hi:[0,0,1]
v_pk_fma_f32 v[38:39], v[38:39], v[172:173], v[172:173] op_sel:[0,0,1] op_sel_hi:[1,0,1] neg_lo:[0,0,1] neg_hi:[0,0,1]
v_pk_fma_f32 v[40:41], v[40:41], v[172:173], v[172:173] op_sel:[0,0,1] op_sel_hi:[1,0,1] neg_lo:[0,0,1] neg_hi:[0,0,1]
v_pk_fma_f32 v[42:43], v[42:43], v[172:173], v[172:173] op_sel:[0,0,1] op_sel_hi:[1,0,1] neg_lo:[0,0,1] neg_hi:[0,0,1]
v_pk_fma_f32 v[44:45], v[44:45], v[172:173], v[172:173] op_sel:[0,0,1] op_sel_hi:[1,0,1] neg_lo:[0,0,1] neg_hi:[0,0,1]
v_pk_fma_f32 v[46:47], v[46:47], v[172:173], v[172:173] op_sel:[0,0,1] op_sel_hi:[1,0,1] neg_lo:[0,0,1] neg_hi:[0,0,1]
s_setprio 2
v_cvt_pkrtz_f16_f32 v137, v120, v121
v_cvt_pkrtz_f16_f32 v139, v122, v123
v_cvt_pkrtz_f16_f32 v141, v124, v125
v_cvt_pkrtz_f16_f32 v143, v126, v127
v_cvt_pkrtz_f16_f32 v145, v128, v129
v_cvt_pk_f16_f32 v155, v130, v131
v_cvt_pk_f16_f32 v152, v132, v133
v_cvt_pk_f16_f32 v149, v134, v135
s_add_u32 m0, s67, 59904
s_add_u32 s66, s66, 98304
buffer_load_dwordx4 v240, s[4:7], s66 offen lds
ds_read_b128 v[220:223], v249 offset:23552
v_mfma_f32_32x32x16_bf16 v[120:135], v[72:75], v[224:227], 0
v_pk_fma_f16 v154, v155, v155, s48
v_cvt_pk_bf16_f32 v96, v0, v1
v_and_b32 v137, s49, v137
v_pk_fma_f16 v151, v152, v152, s48
v_cvt_pk_bf16_f32 v97, v2, v3
v_and_b32_e64 v139, s49, v139
v_pk_fma_f16 v148, v149, v149, s48
v_pk_mul_f16 v154, v155, v154
v_cvt_pk_bf16_f32 v98, v4, v5
v_bfe_u32 v136, v137, 2, 14
v_pk_mul_f16 v151, v152, v151
v_pk_mul_f16 v148, v149, v148
v_cvt_pk_bf16_f32 v99, v6, v7
v_bfe_u32 v138, v139, 2, 14
ds_read_b128 v[224:227], v248 offset:16384
ds_read_u16_d16 v136, v136
ds_read_u16_d16 v138, v138
v_mfma_f32_32x32x16_bf16 v[120:135], v[76:79], v[228:231], v[120:135]
v_exp_f16_e64 v153, v154
v_cvt_pk_bf16_f32 v100, v8, v9
v_lshrrev_b32 v137, 18, v137
v_exp_f16 v150, v151
v_cvt_pk_bf16_f32 v101, v10, v11
v_lshrrev_b32 v139, 18, v139
v_exp_f16 v147, v148
v_cvt_pk_bf16_f32 v102, v12, v13
v_and_b32_e64 v141, s49, v141
v_and_b32 v143, s49, v143
v_cvt_pk_bf16_f32 v103, v14, v15
s_add_u32 m0, s67, 0
s_add_u32 s66, s66, 98304
buffer_load_dwordx4 v240, s[4:7], s66 offen lds
ds_read_b128 v[228:231], v248 offset:19456
ds_read_u16_d16_hi v137, v137
ds_read_u16_d16_hi v139, v139
v_mfma_f32_32x32x16_bf16 v[120:135], v[80:83], v[232:235], v[120:135]
v_exp_f16_sdwa v153, v154 dst_sel:WORD_1 dst_unused:UNUSED_PRESERVE src0_sel:WORD_1
v_bfe_u32 v140, v141, 2, 14
v_cvt_pk_bf16_f32 v104, v16, v17
v_exp_f16_sdwa v150, v151 dst_sel:WORD_1 dst_unused:UNUSED_PRESERVE src0_sel:WORD_1
v_bfe_u32 v142, v143, 2, 14
v_cvt_pk_bf16_f32 v105, v18, v19
v_exp_f16_sdwa v147, v148 dst_sel:WORD_1 dst_unused:UNUSED_PRESERVE src0_sel:WORD_1
v_cvt_pk_bf16_f32 v106, v20, v21
v_lshrrev_b32_e64 v141, 18, v141
v_pk_add_f16 v153, v153, 1.0 op_sel_hi:[1,0]
v_lshrrev_b32_e64 v143, 18, v143
ds_read_b128 v[232:235], v248 offset:17408
ds_read_u16_d16 v140, v140
ds_read_u16_d16 v142, v142
ds_read_u16_d16_hi v141, v141
ds_read_u16_d16_hi v143, v143
v_mfma_f32_32x32x16_bf16 v[120:135], v[84:87], v[236:239], v[120:135]
v_cvt_pk_bf16_f32 v107, v22, v23
v_pk_add_f16 v150, v150, 1.0 op_sel_hi:[1,0]
v_pk_add_f16 v147, v147, 1.0 op_sel_hi:[1,0]
v_and_b32_e64 v145, s49, v145
v_cvt_pk_bf16_f32 v108, v24, v25
v_rcp_f16_e64 v154, v153
v_bfe_u32 v144, v145, 2, 14
v_cvt_pk_bf16_f32 v109, v26, v27
v_rcp_f16_e64 v151, v150
v_lshrrev_b32 v145, 18, v145
v_cvt_pk_bf16_f32 v110, v28, v29
s_waitcnt lgkmcnt(5)
s_add_u32 m0, s67, 6656
s_add_u32 s66, s66, 98304
buffer_load_dwordx4 v240, s[4:7], s66 offen lds
ds_read_b128 v[236:239], v248 offset:20480
ds_read_u16_d16 v144, v144
ds_read_u16_d16_hi v145, v145
v_mfma_f32_32x32x16_bf16 v[120:135], v[88:91], v[216:219], v[120:135]
v_rcp_f16_e64 v148, v147
v_cvt_pk_bf16_f32 v111, v30, v31
v_rcp_f16_sdwa v154, v153 dst_sel:WORD_1 dst_unused:UNUSED_PRESERVE src0_sel:WORD_1
v_fma_mix_f32 v166, v136, v136, v166 op_sel:[0,0,0] op_sel_hi:[1,1,0]
v_cvt_pk_bf16_f32 v112, v32, v33
v_fma_mix_f32 v166, v137, v137, v166 op_sel:[1,1,0] op_sel_hi:[1,1,0]
v_rcp_f16_sdwa v151, v150 dst_sel:WORD_1 dst_unused:UNUSED_PRESERVE src0_sel:WORD_1
v_cvt_pk_bf16_f32 v113, v34, v35
v_fma_mix_f32 v166, v138, v138, v166 op_sel:[0,0,0] op_sel_hi:[1,1,0]
v_rcp_f16_sdwa v148, v147 dst_sel:WORD_1 dst_unused:UNUSED_PRESERVE src0_sel:WORD_1
v_cvt_pk_bf16_f32 v114, v36, v37
ds_read_b128 v[216:219], v248 offset:18432
v_mfma_f32_32x32x16_bf16 v[120:135], v[92:95], v[220:223], v[120:135]
v_fma_mix_f32 v166, v139, v139, v166 op_sel:[1,1,0] op_sel_hi:[1,1,0]
v_pk_mul_f16 v155, v155, v154
s_waitcnt lgkmcnt(4)
v_fma_mix_f32 v166, v140, v140, v166 op_sel:[0,0,0] op_sel_hi:[1,1,0]
v_cvt_pk_bf16_f32 v115, v38, v39
v_pk_mul_f16 v152, v152, v151
v_fma_mix_f32 v166, v141, v141, v166 op_sel:[1,1,0] op_sel_hi:[1,1,0]
v_cvt_pk_bf16_f32 v116, v40, v41
v_pk_mul_f16 v149, v149, v148
v_fma_mix_f32 v166, v155, v155, v166 op_sel:[0,0,0] op_sel_hi:[1,1,0]
v_fma_mix_f32 v166, v142, v142, v166 op_sel:[0,0,0] op_sel_hi:[1,1,0]
v_cvt_pk_bf16_f32 v117, v42, v43
v_fma_mix_f32 v166, v155, v155, v166 op_sel:[1,1,0] op_sel_hi:[1,1,0]
v_fma_mix_f32 v166, v143, v143, v166 op_sel:[1,1,0] op_sel_hi:[1,1,0]
v_fma_mix_f32 v166, v152, v152, v166 op_sel:[0,0,0] op_sel_hi:[1,1,0]
v_cvt_pk_bf16_f32 v118, v44, v45
v_fma_mix_f32 v166, v152, v152, v166 op_sel:[1,1,0] op_sel_hi:[1,1,0]
s_waitcnt lgkmcnt(1)
v_fma_mix_f32 v166, v144, v144, v166 op_sel:[0,0,0] op_sel_hi:[1,1,0]
v_fma_mix_f32 v166, v149, v149, v166 op_sel:[0,0,0] op_sel_hi:[1,1,0]
v_cvt_pk_bf16_f32 v119, v46, v47
v_fma_mix_f32 v166, v145, v145, v166 op_sel:[1,1,0] op_sel_hi:[1,1,0]
v_fma_mix_f32 v166, v149, v149, v166 op_sel:[1,1,0] op_sel_hi:[1,1,0]
v_cvt_pkrtz_f16_f32 v137, v120, v121
v_cvt_pkrtz_f16_f32 v139, v122, v123
v_cvt_pkrtz_f16_f32 v141, v124, v125
v_cvt_pkrtz_f16_f32 v143, v126, v127
v_cvt_pkrtz_f16_f32 v145, v128, v129
v_cvt_pk_f16_f32 v155, v130, v131
v_cvt_pk_f16_f32 v152, v132, v133
v_cvt_pk_f16_f32 v149, v134, v135
s_add_u32 m0, s67, 13312
s_add_u32 s66, s66, 98304
buffer_load_dwordx4 v240, s[4:7], s66 offen lds
ds_read_b128 v[220:223], v248 offset:21504
v_mfma_f32_32x32x16_bf16 v[120:135], v[96:99], v[224:227], 0
v_pk_fma_f16 v154, v155, v155, s48
v_and_b32_e64 v137, s49, v137
v_pk_fma_f16 v151, v152, v152, s48
v_and_b32_e64 v139, s49, v139
v_pk_fma_f16 v148, v149, v149, s48
v_pk_mul_f16 v154, v155, v154
v_bfe_u32 v136, v137, 2, 14
v_pk_mul_f16 v151, v152, v151
v_pk_mul_f16 v148, v149, v148
v_bfe_u32 v138, v139, 2, 14
ds_read_b128 v[224:227], v248 offset:22528
ds_read_u16_d16 v136, v136
ds_read_u16_d16 v138, v138
v_mfma_f32_32x32x16_bf16 v[120:135], v[100:103], v[228:231], v[120:135]
v_exp_f16 v153, v154
v_lshrrev_b32 v137, 18, v137
v_exp_f16 v150, v151
v_lshrrev_b32 v139, 18, v139
v_exp_f16 v147, v148
v_and_b32 v141, s49, v141
v_and_b32_e64 v143, s49, v143
ds_read_b128 v[228:231], v248 offset:25600
ds_read_u16_d16_hi v137, v137
ds_read_u16_d16_hi v139, v139
v_mfma_f32_32x32x16_bf16 v[120:135], v[104:107], v[232:235], v[120:135]
v_exp_f16_sdwa v153, v154 dst_sel:WORD_1 dst_unused:UNUSED_PRESERVE src0_sel:WORD_1
v_bfe_u32 v140, v141, 2, 14
v_exp_f16_sdwa v150, v151 dst_sel:WORD_1 dst_unused:UNUSED_PRESERVE src0_sel:WORD_1
v_bfe_u32 v142, v143, 2, 14
v_exp_f16_sdwa v147, v148 dst_sel:WORD_1 dst_unused:UNUSED_PRESERVE src0_sel:WORD_1
v_lshrrev_b32_e64 v141, 18, v141
v_pk_add_f16 v153, v153, 1.0 op_sel_hi:[1,0]
s_add_u32 m0, s67, 19968
s_add_u32 s66, s66, 98304
buffer_load_dwordx4 v240, s[4:7], s66 offen lds
ds_read_b128 v[232:235], v248 offset:23552
ds_read_u16_d16 v140, v140
ds_read_u16_d16 v142, v142
ds_read_u16_d16_hi v141, v141
v_mfma_f32_32x32x16_bf16 v[120:135], v[108:111], v[236:239], v[120:135]
v_lshrrev_b32_e64 v143, 18, v143
v_pk_add_f16 v150, v150, 1.0 op_sel_hi:[1,0]
v_pk_add_f16 v147, v147, 1.0 op_sel_hi:[1,0]
v_and_b32 v145, s49, v145
v_rcp_f16 v154, v153
v_bfe_u32 v144, v145, 2, 14
v_rcp_f16_e64 v151, v150
v_lshrrev_b32 v145, 18, v145
s_waitcnt lgkmcnt(4)
ds_read_b128 v[236:239], v248 offset:26624
ds_read_u16_d16_hi v143, v143
ds_read_u16_d16 v144, v144
ds_read_u16_d16_hi v145, v145
v_mfma_f32_32x32x16_bf16 v[120:135], v[112:115], v[216:219], v[120:135]
v_rcp_f16_e64 v148, v147
v_rcp_f16_sdwa v154, v153 dst_sel:WORD_1 dst_unused:UNUSED_PRESERVE src0_sel:WORD_1
v_fma_mix_f32 v167, v136, v136, v167 op_sel:[0,0,0] op_sel_hi:[1,1,0]
v_fma_mix_f32 v167, v137, v137, v167 op_sel:[1,1,0] op_sel_hi:[1,1,0]
v_rcp_f16_sdwa v151, v150 dst_sel:WORD_1 dst_unused:UNUSED_PRESERVE src0_sel:WORD_1
v_fma_mix_f32 v167, v138, v138, v167 op_sel:[0,0,0] op_sel_hi:[1,1,0]
s_setprio 1
ds_read_b128 v[216:219], v248 offset:24576
v_mfma_f32_32x32x16_bf16 v[120:135], v[116:119], v[220:223], v[120:135]
v_rcp_f16_sdwa v148, v147 dst_sel:WORD_1 dst_unused:UNUSED_PRESERVE src0_sel:WORD_1
v_fma_mix_f32 v167, v139, v139, v167 op_sel:[1,1,0] op_sel_hi:[1,1,0]
v_pk_mul_f16 v155, v155, v154
s_waitcnt lgkmcnt(5)
v_fma_mix_f32 v167, v140, v140, v167 op_sel:[0,0,0] op_sel_hi:[1,1,0]
v_pk_mul_f16 v152, v152, v151
v_fma_mix_f32 v167, v141, v141, v167 op_sel:[1,1,0] op_sel_hi:[1,1,0]
v_pk_mul_f16 v149, v149, v148
v_fma_mix_f32 v167, v155, v155, v167 op_sel:[0,0,0] op_sel_hi:[1,1,0]
v_fma_mix_f32 v167, v142, v142, v167 op_sel:[0,0,0] op_sel_hi:[1,1,0]
v_fma_mix_f32 v167, v155, v155, v167 op_sel:[1,1,0] op_sel_hi:[1,1,0]
s_waitcnt lgkmcnt(3)
v_fma_mix_f32 v167, v143, v143, v167 op_sel:[1,1,0] op_sel_hi:[1,1,0]
v_fma_mix_f32 v167, v152, v152, v167 op_sel:[0,0,0] op_sel_hi:[1,1,0]
v_fma_mix_f32 v167, v152, v152, v167 op_sel:[1,1,0] op_sel_hi:[1,1,0]
s_waitcnt lgkmcnt(1)
v_fma_mix_f32 v167, v144, v144, v167 op_sel:[0,0,0] op_sel_hi:[1,1,0]
v_fma_mix_f32 v167, v149, v149, v167 op_sel:[0,0,0] op_sel_hi:[1,1,0]
v_fma_mix_f32 v167, v145, v145, v167 op_sel:[1,1,0] op_sel_hi:[1,1,0]
v_fma_mix_f32 v167, v149, v149, v167 op_sel:[1,1,0] op_sel_hi:[1,1,0]
s_cmp_lg_u32 s40, 7
s_cbranch_scc1 Lnoinit
s_waitcnt vmcnt(10)
v_mov_b32 v255, 1
s_mov_b64 exec, 1
buffer_atomic_add v255, v241, s[36:39], 0 offen
s_mov_b64 exec, -1
Lnoinit:
v_cvt_pkrtz_f16_f32 v137, v120, v121
v_cvt_pkrtz_f16_f32 v139, v122, v123
v_cvt_pkrtz_f16_f32 v141, v124, v125
v_cvt_pkrtz_f16_f32 v143, v126, v127
v_cvt_pkrtz_f16_f32 v145, v128, v129
v_cvt_pk_f16_f32 v155, v130, v131
v_cvt_pk_f16_f32 v152, v132, v133
v_cvt_pk_f16_f32 v149, v134, v135
ds_read_b128 v[220:223], v248 offset:27648
v_mfma_f32_32x32x16_bf16 v[120:135], v[96:99], v[224:227], 0
v_pk_fma_f16 v154, v155, v155, s48
v_and_b32_e64 v137, s49, v137
v_pk_fma_f16 v151, v152, v152, s48
v_and_b32_e64 v139, s49, v139
v_pk_fma_f16 v148, v149, v149, s48
v_pk_mul_f16 v154, v155, v154
v_bfe_u32 v136, v137, 2, 14
v_pk_mul_f16 v151, v152, v151
v_pk_mul_f16 v148, v149, v148
v_bfe_u32 v138, v139, 2, 14
ds_read_b128 v[224:227], v248 offset:28672
ds_read_u16_d16 v136, v136
ds_read_u16_d16 v138, v138
v_mfma_f32_32x32x16_bf16 v[120:135], v[100:103], v[228:231], v[120:135]
v_exp_f16 v153, v154
v_lshrrev_b32 v137, 18, v137
v_exp_f16 v150, v151
v_lshrrev_b32 v139, 18, v139
v_exp_f16 v147, v148
v_and_b32 v141, s49, v141
v_and_b32_e64 v143, s49, v143
ds_read_b128 v[228:231], v248 offset:31744
ds_read_u16_d16_hi v137, v137
ds_read_u16_d16_hi v139, v139
v_mfma_f32_32x32x16_bf16 v[120:135], v[104:107], v[232:235], v[120:135]
v_exp_f16_sdwa v153, v154 dst_sel:WORD_1 dst_unused:UNUSED_PRESERVE src0_sel:WORD_1
v_bfe_u32 v140, v141, 2, 14
v_exp_f16_sdwa v150, v151 dst_sel:WORD_1 dst_unused:UNUSED_PRESERVE src0_sel:WORD_1
v_bfe_u32 v142, v143, 2, 14
v_exp_f16_sdwa v147, v148 dst_sel:WORD_1 dst_unused:UNUSED_PRESERVE src0_sel:WORD_1
v_lshrrev_b32_e64 v141, 18, v141
v_pk_add_f16 v153, v153, 1.0 op_sel_hi:[1,0]
ds_read_b128 v[232:235], v248 offset:29696
ds_read_u16_d16 v140, v140
ds_read_u16_d16 v142, v142
ds_read_u16_d16_hi v141, v141
v_mfma_f32_32x32x16_bf16 v[120:135], v[108:111], v[236:239], v[120:135]
v_lshrrev_b32_e64 v143, 18, v143
v_pk_add_f16 v150, v150, 1.0 op_sel_hi:[1,0]
v_pk_add_f16 v147, v147, 1.0 op_sel_hi:[1,0]
v_and_b32 v145, s49, v145
v_rcp_f16 v154, v153
v_bfe_u32 v144, v145, 2, 14
v_rcp_f16_e64 v151, v150
v_lshrrev_b32 v145, 18, v145
s_waitcnt lgkmcnt(7)
ds_read_b128 v[236:239], v248 offset:32768
ds_read_u16_d16_hi v143, v143
ds_read_u16_d16 v144, v144
ds_read_u16_d16_hi v145, v145
v_mfma_f32_32x32x16_bf16 v[120:135], v[112:115], v[216:219], v[120:135]
v_rcp_f16_e64 v148, v147
v_rcp_f16_sdwa v154, v153 dst_sel:WORD_1 dst_unused:UNUSED_PRESERVE src0_sel:WORD_1
v_fma_mix_f32 v156, v136, v136, v156 op_sel:[0,0,0] op_sel_hi:[1,1,0]
s_waitcnt lgkmcnt(8)
v_fma_mix_f32 v156, v137, v137, v156 op_sel:[1,1,0] op_sel_hi:[1,1,0]
v_rcp_f16_sdwa v151, v150 dst_sel:WORD_1 dst_unused:UNUSED_PRESERVE src0_sel:WORD_1
v_fma_mix_f32 v156, v138, v138, v156 op_sel:[0,0,0] op_sel_hi:[1,1,0]
ds_read_b128 v[216:219], v248 offset:30720
v_mfma_f32_32x32x16_bf16 v[120:135], v[116:119], v[220:223], v[120:135]
v_rcp_f16_sdwa v148, v147 dst_sel:WORD_1 dst_unused:UNUSED_PRESERVE src0_sel:WORD_1
v_fma_mix_f32 v156, v139, v139, v156 op_sel:[1,1,0] op_sel_hi:[1,1,0]
v_pk_mul_f16 v155, v155, v154
s_waitcnt lgkmcnt(5)
v_fma_mix_f32 v156, v140, v140, v156 op_sel:[0,0,0] op_sel_hi:[1,1,0]
v_pk_mul_f16 v152, v152, v151
v_fma_mix_f32 v156, v141, v141, v156 op_sel:[1,1,0] op_sel_hi:[1,1,0]
v_pk_mul_f16 v149, v149, v148
v_fma_mix_f32 v156, v155, v155, v156 op_sel:[0,0,0] op_sel_hi:[1,1,0]
v_fma_mix_f32 v156, v142, v142, v156 op_sel:[0,0,0] op_sel_hi:[1,1,0]
v_fma_mix_f32 v156, v155, v155, v156 op_sel:[1,1,0] op_sel_hi:[1,1,0]
s_waitcnt lgkmcnt(3)
v_fma_mix_f32 v156, v143, v143, v156 op_sel:[1,1,0] op_sel_hi:[1,1,0]
v_fma_mix_f32 v156, v152, v152, v156 op_sel:[0,0,0] op_sel_hi:[1,1,0]
v_fma_mix_f32 v156, v152, v152, v156 op_sel:[1,1,0] op_sel_hi:[1,1,0]
s_waitcnt lgkmcnt(1)
v_fma_mix_f32 v156, v144, v144, v156 op_sel:[0,0,0] op_sel_hi:[1,1,0]
v_fma_mix_f32 v156, v149, v149, v156 op_sel:[0,0,0] op_sel_hi:[1,1,0]
v_fma_mix_f32 v156, v145, v145, v156 op_sel:[1,1,0] op_sel_hi:[1,1,0]
v_fma_mix_f32 v156, v149, v149, v156 op_sel:[1,1,0] op_sel_hi:[1,1,0]
v_cvt_pkrtz_f16_f32 v137, v120, v121
v_cvt_pkrtz_f16_f32 v139, v122, v123
v_cvt_pkrtz_f16_f32 v141, v124, v125
v_cvt_pkrtz_f16_f32 v143, v126, v127
v_cvt_pkrtz_f16_f32 v145, v128, v129
v_cvt_pk_f16_f32 v155, v130, v131
v_cvt_pk_f16_f32 v152, v132, v133
v_cvt_pk_f16_f32 v149, v134, v135
ds_read_b128 v[220:223], v248 offset:33792
v_mfma_f32_32x32x16_bf16 v[120:135], v[96:99], v[224:227], 0
v_pk_fma_f16 v154, v155, v155, s48
v_and_b32_e64 v137, s49, v137
v_pk_fma_f16 v151, v152, v152, s48
v_and_b32_e64 v139, s49, v139
v_pk_fma_f16 v148, v149, v149, s48
v_pk_mul_f16 v154, v155, v154
v_bfe_u32 v136, v137, 2, 14
v_pk_mul_f16 v151, v152, v151
v_pk_mul_f16 v148, v149, v148
v_bfe_u32 v138, v139, 2, 14
ds_read_b128 v[224:227], v248 offset:34816
ds_read_u16_d16 v136, v136
ds_read_u16_d16 v138, v138
v_mfma_f32_32x32x16_bf16 v[120:135], v[100:103], v[228:231], v[120:135]
v_exp_f16 v153, v154
v_lshrrev_b32 v137, 18, v137
v_exp_f16 v150, v151
v_lshrrev_b32 v139, 18, v139
v_exp_f16 v147, v148
v_and_b32 v141, s49, v141
v_and_b32_e64 v143, s49, v143
ds_read_b128 v[228:231], v248 offset:37888
ds_read_u16_d16_hi v137, v137
ds_read_u16_d16_hi v139, v139
v_mfma_f32_32x32x16_bf16 v[120:135], v[104:107], v[232:235], v[120:135]
v_exp_f16_sdwa v153, v154 dst_sel:WORD_1 dst_unused:UNUSED_PRESERVE src0_sel:WORD_1
v_bfe_u32 v140, v141, 2, 14
v_exp_f16_sdwa v150, v151 dst_sel:WORD_1 dst_unused:UNUSED_PRESERVE src0_sel:WORD_1
v_bfe_u32 v142, v143, 2, 14
v_exp_f16_sdwa v147, v148 dst_sel:WORD_1 dst_unused:UNUSED_PRESERVE src0_sel:WORD_1
v_lshrrev_b32_e64 v141, 18, v141
v_pk_add_f16 v153, v153, 1.0 op_sel_hi:[1,0]
ds_read_b128 v[232:235], v248 offset:35840
ds_read_u16_d16 v140, v140
ds_read_u16_d16 v142, v142
ds_read_u16_d16_hi v141, v141
v_mfma_f32_32x32x16_bf16 v[120:135], v[108:111], v[236:239], v[120:135]
v_lshrrev_b32_e64 v143, 18, v143
v_pk_add_f16 v150, v150, 1.0 op_sel_hi:[1,0]
v_pk_add_f16 v147, v147, 1.0 op_sel_hi:[1,0]
v_and_b32 v145, s49, v145
v_rcp_f16 v154, v153
v_bfe_u32 v144, v145, 2, 14
v_rcp_f16_e64 v151, v150
v_lshrrev_b32 v145, 18, v145
s_waitcnt lgkmcnt(7)
ds_read_b128 v[236:239], v248 offset:38912
ds_read_u16_d16_hi v143, v143
ds_read_u16_d16 v144, v144
ds_read_u16_d16_hi v145, v145
v_mfma_f32_32x32x16_bf16 v[120:135], v[112:115], v[216:219], v[120:135]
v_rcp_f16 v148, v147
v_rcp_f16_sdwa v154, v153 dst_sel:WORD_1 dst_unused:UNUSED_PRESERVE src0_sel:WORD_1
s_setprio 0
v_fma_mix_f32 v157, v136, v136, v157 op_sel:[0,0,0] op_sel_hi:[1,1,0]
s_waitcnt lgkmcnt(8)
v_fma_mix_f32 v157, v137, v137, v157 op_sel:[1,1,0] op_sel_hi:[1,1,0]
v_rcp_f16_sdwa v151, v150 dst_sel:WORD_1 dst_unused:UNUSED_PRESERVE src0_sel:WORD_1
v_fma_mix_f32 v157, v138, v138, v157 op_sel:[0,0,0] op_sel_hi:[1,1,0]
ds_read_b128 v[216:219], v248 offset:36864
v_mfma_f32_32x32x16_bf16 v[120:135], v[116:119], v[220:223], v[120:135]
v_rcp_f16_sdwa v148, v147 dst_sel:WORD_1 dst_unused:UNUSED_PRESERVE src0_sel:WORD_1
v_fma_mix_f32 v157, v139, v139, v157 op_sel:[1,1,0] op_sel_hi:[1,1,0]
v_pk_mul_f16 v155, v155, v154
s_waitcnt lgkmcnt(5)
v_fma_mix_f32 v157, v140, v140, v157 op_sel:[0,0,0] op_sel_hi:[1,1,0]
v_pk_mul_f16 v152, v152, v151
v_fma_mix_f32 v157, v141, v141, v157 op_sel:[1,1,0] op_sel_hi:[1,1,0]
v_pk_mul_f16 v149, v149, v148
v_fma_mix_f32 v157, v155, v155, v157 op_sel:[0,0,0] op_sel_hi:[1,1,0]
v_fma_mix_f32 v157, v142, v142, v157 op_sel:[0,0,0] op_sel_hi:[1,1,0]
v_fma_mix_f32 v157, v155, v155, v157 op_sel:[1,1,0] op_sel_hi:[1,1,0]
s_waitcnt lgkmcnt(3)
v_fma_mix_f32 v157, v143, v143, v157 op_sel:[1,1,0] op_sel_hi:[1,1,0]
v_fma_mix_f32 v157, v152, v152, v157 op_sel:[0,0,0] op_sel_hi:[1,1,0]
v_fma_mix_f32 v157, v152, v152, v157 op_sel:[1,1,0] op_sel_hi:[1,1,0]
s_waitcnt lgkmcnt(1)
v_fma_mix_f32 v157, v144, v144, v157 op_sel:[0,0,0] op_sel_hi:[1,1,0]
v_fma_mix_f32 v157, v149, v149, v157 op_sel:[0,0,0] op_sel_hi:[1,1,0]
v_fma_mix_f32 v157, v145, v145, v157 op_sel:[1,1,0] op_sel_hi:[1,1,0]
v_fma_mix_f32 v157, v149, v149, v157 op_sel:[1,1,0] op_sel_hi:[1,1,0]
v_cvt_pkrtz_f16_f32 v137, v120, v121
v_cvt_pkrtz_f16_f32 v139, v122, v123
v_cvt_pkrtz_f16_f32 v141, v124, v125
v_cvt_pkrtz_f16_f32 v143, v126, v127
v_cvt_pkrtz_f16_f32 v145, v128, v129
v_cvt_pk_f16_f32 v155, v130, v131
v_cvt_pk_f16_f32 v152, v132, v133
v_cvt_pk_f16_f32 v149, v134, v135
ds_read_b128 v[220:223], v248 offset:39936
v_mfma_f32_32x32x16_bf16 v[120:135], v[96:99], v[224:227], 0
v_pk_fma_f16 v154, v155, v155, s48
v_and_b32_e64 v137, s49, v137
v_pk_fma_f16 v151, v152, v152, s48
v_and_b32_e64 v139, s49, v139
v_pk_fma_f16 v148, v149, v149, s48
v_pk_mul_f16 v154, v155, v154
v_bfe_u32 v136, v137, 2, 14
v_pk_mul_f16 v151, v152, v151
v_pk_mul_f16 v148, v149, v148
v_bfe_u32 v138, v139, 2, 14
ds_read_b64 v[224:225], v245 offset:384
ds_read_b64 v[226:227], v246 offset:384
s_cmp_eq_u32 s40, 7
s_cbranch_scc1 Lrdy24
s_waitcnt vmcnt(0)
Lrdy24:
s_barrier
ds_read_b128 v[192:195], v242
ds_read_u16_d16 v136, v136
ds_read_u16_d16 v138, v138
v_mfma_f32_32x32x16_bf16 v[120:135], v[100:103], v[228:231], v[120:135]
v_exp_f16 v153, v154
v_lshrrev_b32 v137, 18, v137
v_exp_f16 v150, v151
v_lshrrev_b32 v139, 18, v139
v_exp_f16 v147, v148
v_and_b32 v141, s49, v141
v_and_b32_e64 v143, s49, v143
ds_read_b128 v[228:231], v248 offset:40960
ds_read_u16_d16_hi v137, v137
ds_read_u16_d16_hi v139, v139
v_mfma_f32_32x32x16_bf16 v[120:135], v[104:107], v[232:235], v[120:135]
v_exp_f16_sdwa v153, v154 dst_sel:WORD_1 dst_unused:UNUSED_PRESERVE src0_sel:WORD_1
v_bfe_u32 v140, v141, 2, 14
v_exp_f16_sdwa v150, v151 dst_sel:WORD_1 dst_unused:UNUSED_PRESERVE src0_sel:WORD_1
v_bfe_u32 v142, v143, 2, 14
v_exp_f16_sdwa v147, v148 dst_sel:WORD_1 dst_unused:UNUSED_PRESERVE src0_sel:WORD_1
v_lshrrev_b32 v141, 18, v141
v_pk_add_f16 v153, v153, 1.0 op_sel_hi:[1,0]
s_setprio 2
ds_read_b128 v[232:235], v248 offset:44032
ds_read_u16_d16 v140, v140
ds_read_u16_d16 v142, v142
ds_read_u16_d16_hi v141, v141
v_mfma_f32_32x32x16_bf16 v[120:135], v[108:111], v[236:239], v[120:135]
v_lshrrev_b32_e64 v143, 18, v143
v_pk_add_f16 v150, v150, 1.0 op_sel_hi:[1,0]
v_pk_add_f16 v147, v147, 1.0 op_sel_hi:[1,0]
v_and_b32 v145, s49, v145
v_rcp_f16 v154, v153
v_bfe_u32 v144, v145, 2, 14
v_rcp_f16_e64 v151, v150
v_lshrrev_b32 v145, 18, v145
s_waitcnt lgkmcnt(6)
ds_read_b64 v[236:237], v245 offset:1152
ds_read_b64 v[238:239], v246 offset:1152
ds_read_b128 v[196:199], v242 offset:64
ds_read_u16_d16_hi v143, v143
ds_read_u16_d16 v144, v144
ds_read_u16_d16_hi v145, v145
v_mfma_f32_32x32x16_bf16 v[120:135], v[112:115], v[216:219], v[120:135]
v_rcp_f16_e64 v148, v147
v_rcp_f16_sdwa v154, v153 dst_sel:WORD_1 dst_unused:UNUSED_PRESERVE src0_sel:WORD_1
v_fma_mix_f32 v158, v136, v136, v158 op_sel:[0,0,0] op_sel_hi:[1,1,0]
s_waitcnt lgkmcnt(10)
v_fma_mix_f32 v158, v137, v137, v158 op_sel:[1,1,0] op_sel_hi:[1,1,0]
v_rcp_f16_sdwa v151, v150 dst_sel:WORD_1 dst_unused:UNUSED_PRESERVE src0_sel:WORD_1
v_fma_mix_f32 v158, v138, v138, v158 op_sel:[0,0,0] op_sel_hi:[1,1,0]
ds_read_b128 v[216:219], v248 offset:41984
v_mfma_f32_32x32x16_bf16 v[120:135], v[116:119], v[220:223], v[120:135]
v_rcp_f16_sdwa v148, v147 dst_sel:WORD_1 dst_unused:UNUSED_PRESERVE src0_sel:WORD_1
v_fma_mix_f32 v158, v139, v139, v158 op_sel:[1,1,0] op_sel_hi:[1,1,0]
v_pk_mul_f16 v155, v155, v154
s_waitcnt lgkmcnt(7)
v_fma_mix_f32 v158, v140, v140, v158 op_sel:[0,0,0] op_sel_hi:[1,1,0]
v_pk_mul_f16 v152, v152, v151
v_fma_mix_f32 v158, v141, v141, v158 op_sel:[1,1,0] op_sel_hi:[1,1,0]
v_pk_mul_f16 v149, v149, v148
v_fma_mix_f32 v158, v155, v155, v158 op_sel:[0,0,0] op_sel_hi:[1,1,0]
v_fma_mix_f32 v158, v142, v142, v158 op_sel:[0,0,0] op_sel_hi:[1,1,0]
v_fma_mix_f32 v158, v155, v155, v158 op_sel:[1,1,0] op_sel_hi:[1,1,0]
s_waitcnt lgkmcnt(3)
v_fma_mix_f32 v158, v143, v143, v158 op_sel:[1,1,0] op_sel_hi:[1,1,0]
v_fma_mix_f32 v158, v152, v152, v158 op_sel:[0,0,0] op_sel_hi:[1,1,0]
v_fma_mix_f32 v158, v152, v152, v158 op_sel:[1,1,0] op_sel_hi:[1,1,0]
s_waitcnt lgkmcnt(1)
v_fma_mix_f32 v158, v144, v144, v158 op_sel:[0,0,0] op_sel_hi:[1,1,0]
v_fma_mix_f32 v158, v149, v149, v158 op_sel:[0,0,0] op_sel_hi:[1,1,0]
v_fma_mix_f32 v158, v145, v145, v158 op_sel:[1,1,0] op_sel_hi:[1,1,0]
v_fma_mix_f32 v158, v149, v149, v158 op_sel:[1,1,0] op_sel_hi:[1,1,0]
v_mfma_f32_16x16x32_bf16 v[8:11], v[224:227], v[192:195], 0
ds_read_b128 v[220:223], v248 offset:45056
v_cvt_pkrtz_f16_f32 v137, v120, v121
v_cvt_pkrtz_f16_f32 v139, v122, v123
v_cvt_pkrtz_f16_f32 v141, v124, v125
v_cvt_pkrtz_f16_f32 v143, v126, v127
v_cvt_pk_f16_f32 v155, v128, v129
v_cvt_pk_f16_f32 v152, v130, v131
v_cvt_pk_f16_f32 v149, v132, v133
v_cvt_pk_f16_f32 v146, v134, v135
v_mfma_f32_32x32x16_bf16 v[120:135], v[96:99], v[228:231], 0
ds_read_b64 v[224:225], v245 offset:1920
ds_read_b64 v[226:227], v246 offset:1920
ds_read_b128 v[200:203], v242 offset:128
v_pk_fma_f16 v154, v155, v155, s48
v_and_b32_e64 v137, s49, v137
v_pk_fma_f16 v151, v152, v152, s48
v_pk_fma_f16 v148, v149, v149, s48
v_and_b32_e64 v139, s49, v139
v_pk_fma_f16 v145, v146, v146, s48
v_mfma_f32_32x32x16_bf16 v[120:135], v[100:103], v[232:235], v[120:135]
ds_read_b128 v[228:231], v248 offset:43008
v_pk_mul_f16 v154, v155, v154
v_bfe_u32 v136, v137, 2, 14
v_pk_mul_f16 v151, v152, v151
v_pk_mul_f16 v148, v149, v148
v_bfe_u32 v138, v139, 2, 14
v_pk_mul_f16 v145, v146, v145
v_exp_f16 v153, v154
v_lshrrev_b32 v137, 18, v137
v_mfma_f32_16x16x32_bf16 v[24:27], v[236:239], v[196:199], 0
ds_read_b64 v[232:233], v245 offset:2688
ds_read_b64 v[234:235], v246 offset:2688
ds_read_b128 v[204:207], v243
ds_read_u16_d16 v136, v136
ds_read_u16_d16 v138, v138
ds_read_u16_d16_hi v137, v137
v_exp_f16 v150, v151
v_lshrrev_b32 v139, 18, v139
v_exp_f16 v147, v148
s_waitcnt lgkmcnt(7)
v_mfma_f32_32x32x16_bf16 v[120:135], v[104:107], v[216:219], v[120:135]
ds_read_b128 v[236:239], v248 offset:46080
ds_read_u16_d16_hi v139, v139
v_and_b32 v141, s49, v141
v_exp_f16 v144, v145
v_and_b32_e64 v143, s49, v143
v_exp_f16_sdwa v153, v154 dst_sel:WORD_1 dst_unused:UNUSED_PRESERVE src0_sel:WORD_1
v_bfe_u32 v140, v141, 2, 14
v_exp_f16_sdwa v150, v151 dst_sel:WORD_1 dst_unused:UNUSED_PRESERVE src0_sel:WORD_1
v_mfma_f32_32x32x16_bf16 v[120:135], v[108:111], v[220:223], v[120:135]
ds_read_b64 v[216:217], v245 offset:3456
ds_read_b64 v[218:219], v246 offset:3456
ds_read_b128 v[208:211], v243 offset:64
ds_read_u16_d16 v140, v140
v_bfe_u32 v142, v143, 2, 14
v_exp_f16_sdwa v147, v148 dst_sel:WORD_1 dst_unused:UNUSED_PRESERVE src0_sel:WORD_1
v_lshrrev_b32_e64 v141, 18, v141
v_exp_f16_sdwa v144, v145 dst_sel:WORD_1 dst_unused:UNUSED_PRESERVE src0_sel:WORD_1
v_lshrrev_b32_e64 v143, 18, v143
v_pk_add_f16 v153, v153, 1.0 op_sel_hi:[1,0]
v_pk_add_f16 v150, v150, 1.0 op_sel_hi:[1,0]
v_mfma_f32_16x16x32_bf16 v[40:43], v[224:227], v[200:203], 0
ds_read_b64 v[220:221], v245 offset:4224
ds_read_b64 v[222:223], v246 offset:4224
ds_read_b128 v[212:215], v243 offset:128
ds_read_u16_d16 v142, v142
ds_read_u16_d16_hi v141, v141
ds_read_u16_d16_hi v143, v143
v_pk_add_f16 v147, v147, 1.0 op_sel_hi:[1,0]
v_pk_add_f16 v144, v144, 1.0 op_sel_hi:[1,0]
v_rcp_f16 v154, v153
s_waitcnt lgkmcnt(10)
v_mfma_f32_32x32x16_bf16 v[120:135], v[112:115], v[228:231], v[120:135]
ds_read_b64 v[224:225], v245 offset:4992
ds_read_b64 v[226:227], v246 offset:4992
ds_read_b128 v[192:195], v244
v_rcp_f16 v151, v150
v_rcp_f16 v148, v147
v_rcp_f16_e64 v145, v144
v_rcp_f16_sdwa v154, v153 dst_sel:WORD_1 dst_unused:UNUSED_PRESERVE src0_sel:WORD_1
v_rcp_f16_sdwa v151, v150 dst_sel:WORD_1 dst_unused:UNUSED_PRESERVE src0_sel:WORD_1
v_mfma_f32_16x16x32_bf16 v[8:11], v[232:235], v[204:207], v[8:11]
ds_read_b128 v[228:231], v248 offset:47104
v_rcp_f16_sdwa v148, v147 dst_sel:WORD_1 dst_unused:UNUSED_PRESERVE src0_sel:WORD_1
v_fma_mix_f32 v159, v136, v136, v159 op_sel:[0,0,0] op_sel_hi:[1,1,0]
v_rcp_f16_sdwa v145, v144 dst_sel:WORD_1 dst_unused:UNUSED_PRESERVE src0_sel:WORD_1
v_mfma_f32_32x32x16_bf16 v[120:135], v[116:119], v[236:239], v[120:135]
ds_read_b128 v[232:235], v248 offset:50176
v_fma_mix_f32 v159, v137, v137, v159 op_sel:[1,1,0] op_sel_hi:[1,1,0]
v_pk_mul_f16 v155, v155, v154
v_fma_mix_f32 v159, v138, v138, v159 op_sel:[0,0,0] op_sel_hi:[1,1,0]
v_pk_mul_f16 v152, v152, v151
v_pk_mul_f16 v149, v149, v148
v_fma_mix_f32 v159, v139, v139, v159 op_sel:[1,1,0] op_sel_hi:[1,1,0]
v_pk_mul_f16 v146, v146, v145
v_fma_mix_f32 v159, v155, v155, v159 op_sel:[0,0,0] op_sel_hi:[1,1,0]
s_waitcnt lgkmcnt(5)
v_fma_mix_f32 v159, v140, v140, v159 op_sel:[0,0,0] op_sel_hi:[1,1,0]
v_mfma_f32_16x16x32_bf16 v[24:27], v[216:219], v[208:211], v[24:27]
ds_read_b64 v[236:237], v245 offset:5760
ds_read_b64 v[238:239], v246 offset:5760
ds_read_b128 v[196:199], v244 offset:64
v_fma_mix_f32 v159, v155, v155, v159 op_sel:[1,1,0] op_sel_hi:[1,1,0]
v_fma_mix_f32 v159, v152, v152, v159 op_sel:[0,0,0] op_sel_hi:[1,1,0]
v_fma_mix_f32 v159, v141, v141, v159 op_sel:[1,1,0] op_sel_hi:[1,1,0]
v_fma_mix_f32 v159, v152, v152, v159 op_sel:[1,1,0] op_sel_hi:[1,1,0]
v_fma_mix_f32 v159, v149, v149, v159 op_sel:[0,0,0] op_sel_hi:[1,1,0]
v_mfma_f32_16x16x32_bf16 v[40:43], v[220:223], v[212:215], v[40:43]
ds_read_b128 v[216:219], v248 offset:48128
v_fma_mix_f32 v159, v142, v142, v159 op_sel:[0,0,0] op_sel_hi:[1,1,0]
v_fma_mix_f32 v159, v149, v149, v159 op_sel:[1,1,0] op_sel_hi:[1,1,0]
v_fma_mix_f32 v159, v146, v146, v159 op_sel:[0,0,0] op_sel_hi:[1,1,0]
v_fma_mix_f32 v159, v143, v143, v159 op_sel:[1,1,0] op_sel_hi:[1,1,0]
v_fma_mix_f32 v159, v146, v146, v159 op_sel:[1,1,0] op_sel_hi:[1,1,0]
s_waitcnt lgkmcnt(4)
v_mfma_f32_16x16x32_bf16 v[8:11], v[224:227], v[192:195], v[8:11]
ds_read_b128 v[220:223], v248 offset:51200
v_cvt_pkrtz_f16_f32 v137, v120, v121
v_cvt_pkrtz_f16_f32 v139, v122, v123
v_cvt_pkrtz_f16_f32 v141, v124, v125
v_cvt_pkrtz_f16_f32 v143, v126, v127
v_cvt_pk_f16_f32 v155, v128, v129
v_cvt_pk_f16_f32 v152, v130, v131
v_cvt_pk_f16_f32 v149, v132, v133
v_cvt_pk_f16_f32 v146, v134, v135
v_mfma_f32_32x32x16_bf16 v[120:135], v[96:99], v[228:231], 0
ds_read_b64 v[224:225], v245 offset:6528
ds_read_b64 v[226:227], v246 offset:6528
ds_read_b128 v[200:203], v244 offset:128
v_pk_fma_f16 v154, v155, v155, s48
v_and_b32_e64 v137, s49, v137
v_pk_fma_f16 v151, v152, v152, s48
v_pk_fma_f16 v148, v149, v149, s48
v_and_b32_e64 v139, s49, v139
v_pk_fma_f16 v145, v146, v146, s48
v_mfma_f32_32x32x16_bf16 v[120:135], v[100:103], v[232:235], v[120:135]
ds_read_b128 v[228:231], v248 offset:49152
v_pk_mul_f16 v154, v155, v154
v_bfe_u32 v136, v137, 2, 14
v_pk_mul_f16 v151, v152, v151
v_pk_mul_f16 v148, v149, v148
v_bfe_u32 v138, v139, 2, 14
v_pk_mul_f16 v145, v146, v145
v_exp_f16 v153, v154
v_lshrrev_b32 v137, 18, v137
s_waitcnt lgkmcnt(4)
v_mfma_f32_16x16x32_bf16 v[24:27], v[236:239], v[196:199], v[24:27]
ds_read_b64 v[232:233], v245 offset:576
ds_read_b64 v[234:235], v246 offset:576
v_xor_b32 v242, 16, v242
ds_read_b128 v[204:207], v242
ds_read_u16_d16 v136, v136
ds_read_u16_d16 v138, v138
ds_read_u16_d16_hi v137, v137
v_exp_f16 v150, v151
v_lshrrev_b32 v139, 18, v139
v_exp_f16_e64 v147, v148
v_mfma_f32_32x32x16_bf16 v[120:135], v[104:107], v[216:219], v[120:135]
ds_read_b128 v[236:239], v248 offset:52224
ds_read_u16_d16_hi v139, v139
v_and_b32 v141, s49, v141
v_exp_f16 v144, v145
v_and_b32_e64 v143, s49, v143
v_exp_f16_sdwa v153, v154 dst_sel:WORD_1 dst_unused:UNUSED_PRESERVE src0_sel:WORD_1
v_bfe_u32 v140, v141, 2, 14
v_exp_f16_sdwa v150, v151 dst_sel:WORD_1 dst_unused:UNUSED_PRESERVE src0_sel:WORD_1
v_mfma_f32_32x32x16_bf16 v[120:135], v[108:111], v[220:223], v[120:135]
ds_read_b64 v[216:217], v245 offset:1344
ds_read_b64 v[218:219], v246 offset:1344
ds_read_b128 v[208:211], v242 offset:64
ds_read_u16_d16 v140, v140
v_bfe_u32 v142, v143, 2, 14
v_exp_f16_sdwa v147, v148 dst_sel:WORD_1 dst_unused:UNUSED_PRESERVE src0_sel:WORD_1
v_lshrrev_b32_e64 v141, 18, v141
v_exp_f16_sdwa v144, v145 dst_sel:WORD_1 dst_unused:UNUSED_PRESERVE src0_sel:WORD_1
v_lshrrev_b32 v143, 18, v143
v_pk_add_f16 v153, v153, 1.0 op_sel_hi:[1,0]
v_pk_add_f16 v150, v150, 1.0 op_sel_hi:[1,0]
s_waitcnt lgkmcnt(6)
v_mfma_f32_16x16x32_bf16 v[40:43], v[224:227], v[200:203], v[40:43]
ds_read_b64 v[220:221], v245 offset:2112
ds_read_b64 v[222:223], v246 offset:2112
ds_read_b128 v[212:215], v242 offset:128
ds_read_u16_d16 v142, v142
ds_read_u16_d16_hi v141, v141
ds_read_u16_d16_hi v143, v143
v_pk_add_f16 v147, v147, 1.0 op_sel_hi:[1,0]
v_pk_add_f16 v144, v144, 1.0 op_sel_hi:[1,0]
v_rcp_f16_e64 v154, v153
v_mfma_f32_32x32x16_bf16 v[120:135], v[112:115], v[228:231], v[120:135]
ds_read_b64 v[224:225], v245 offset:2880
ds_read_b64 v[226:227], v246 offset:2880
v_xor_b32 v243, 16, v243
ds_read_b128 v[192:195], v243
v_rcp_f16 v151, v150
v_rcp_f16 v148, v147
v_rcp_f16 v145, v144
v_rcp_f16_sdwa v154, v153 dst_sel:WORD_1 dst_unused:UNUSED_PRESERVE src0_sel:WORD_1
v_rcp_f16_sdwa v151, v150 dst_sel:WORD_1 dst_unused:UNUSED_PRESERVE src0_sel:WORD_1
v_mfma_f32_16x16x32_bf16 v[12:15], v[232:235], v[204:207], 0
ds_read_b128 v[228:231], v248 offset:53248
v_rcp_f16_sdwa v148, v147 dst_sel:WORD_1 dst_unused:UNUSED_PRESERVE src0_sel:WORD_1
v_fma_mix_f32 v160, v136, v136, v160 op_sel:[0,0,0] op_sel_hi:[1,1,0]
v_rcp_f16_sdwa v145, v144 dst_sel:WORD_1 dst_unused:UNUSED_PRESERVE src0_sel:WORD_1
s_waitcnt lgkmcnt(10)
v_mfma_f32_32x32x16_bf16 v[120:135], v[116:119], v[236:239], v[120:135]
ds_read_b128 v[232:235], v248 offset:56320
v_fma_mix_f32 v160, v137, v137, v160 op_sel:[1,1,0] op_sel_hi:[1,1,0]
v_pk_mul_f16 v155, v155, v154
v_fma_mix_f32 v160, v138, v138, v160 op_sel:[0,0,0] op_sel_hi:[1,1,0]
v_pk_mul_f16 v152, v152, v151
v_pk_mul_f16 v149, v149, v148
v_fma_mix_f32 v160, v139, v139, v160 op_sel:[1,1,0] op_sel_hi:[1,1,0]
v_pk_mul_f16 v146, v146, v145
v_fma_mix_f32 v160, v155, v155, v160 op_sel:[0,0,0] op_sel_hi:[1,1,0]
v_fma_mix_f32 v160, v140, v140, v160 op_sel:[0,0,0] op_sel_hi:[1,1,0]
v_mfma_f32_16x16x32_bf16 v[28:31], v[216:219], v[208:211], 0
ds_read_b64 v[236:237], v245 offset:3648
ds_read_b64 v[238:239], v246 offset:3648
ds_read_b128 v[196:199], v243 offset:64
v_fma_mix_f32 v160, v155, v155, v160 op_sel:[1,1,0] op_sel_hi:[1,1,0]
v_fma_mix_f32 v160, v152, v152, v160 op_sel:[0,0,0] op_sel_hi:[1,1,0]
s_waitcnt lgkmcnt(5)
v_fma_mix_f32 v160, v141, v141, v160 op_sel:[1,1,0] op_sel_hi:[1,1,0]
v_fma_mix_f32 v160, v152, v152, v160 op_sel:[1,1,0] op_sel_hi:[1,1,0]
v_fma_mix_f32 v160, v149, v149, v160 op_sel:[0,0,0] op_sel_hi:[1,1,0]
v_mfma_f32_16x16x32_bf16 v[44:47], v[220:223], v[212:215], 0
ds_read_b128 v[216:219], v248 offset:54272
v_fma_mix_f32 v160, v142, v142, v160 op_sel:[0,0,0] op_sel_hi:[1,1,0]
v_fma_mix_f32 v160, v149, v149, v160 op_sel:[1,1,0] op_sel_hi:[1,1,0]
v_fma_mix_f32 v160, v146, v146, v160 op_sel:[0,0,0] op_sel_hi:[1,1,0]
v_fma_mix_f32 v160, v143, v143, v160 op_sel:[1,1,0] op_sel_hi:[1,1,0]
v_fma_mix_f32 v160, v146, v146, v160 op_sel:[1,1,0] op_sel_hi:[1,1,0]
v_mfma_f32_16x16x32_bf16 v[12:15], v[224:227], v[192:195], v[12:15]
ds_read_b128 v[220:223], v248 offset:57344
v_cvt_pkrtz_f16_f32 v137, v120, v121
v_cvt_pkrtz_f16_f32 v139, v122, v123
v_cvt_pkrtz_f16_f32 v141, v124, v125
v_cvt_pkrtz_f16_f32 v143, v126, v127
v_cvt_pk_f16_f32 v155, v128, v129
v_cvt_pk_f16_f32 v152, v130, v131
v_cvt_pk_f16_f32 v149, v132, v133
v_cvt_pk_f16_f32 v146, v134, v135
s_waitcnt lgkmcnt(3)
v_mfma_f32_32x32x16_bf16 v[120:135], v[96:99], v[228:231], 0
ds_read_b64 v[224:225], v245 offset:4416
ds_read_b64 v[226:227], v246 offset:4416
ds_read_b128 v[200:203], v243 offset:128
v_pk_fma_f16 v154, v155, v155, s48
v_and_b32 v137, s49, v137
v_pk_fma_f16 v151, v152, v152, s48
v_pk_fma_f16 v148, v149, v149, s48
v_and_b32_e64 v139, s49, v139
v_pk_fma_f16 v145, v146, v146, s48
v_mfma_f32_32x32x16_bf16 v[120:135], v[100:103], v[232:235], v[120:135]
ds_read_b128 v[228:231], v248 offset:55296
v_pk_mul_f16 v154, v155, v154
v_bfe_u32 v136, v137, 2, 14
v_pk_mul_f16 v151, v152, v151
v_pk_mul_f16 v148, v149, v148
v_bfe_u32 v138, v139, 2, 14
v_pk_mul_f16 v145, v146, v145
v_exp_f16 v153, v154
v_lshrrev_b32 v137, 18, v137
s_waitcnt lgkmcnt(4)
v_mfma_f32_16x16x32_bf16 v[28:31], v[236:239], v[196:199], v[28:31]
ds_read_b64 v[232:233], v245 offset:5184
ds_read_b64 v[234:235], v246 offset:5184
v_xor_b32 v244, 16, v244
ds_read_b128 v[204:207], v244
ds_read_u16_d16 v136, v136
ds_read_u16_d16 v138, v138
ds_read_u16_d16_hi v137, v137
v_exp_f16 v150, v151
v_lshrrev_b32 v139, 18, v139
v_exp_f16_e64 v147, v148
v_mfma_f32_32x32x16_bf16 v[120:135], v[104:107], v[216:219], v[120:135]
ds_read_b128 v[236:239], v248 offset:58368
ds_read_u16_d16_hi v139, v139
v_and_b32 v141, s49, v141
v_exp_f16 v144, v145
v_and_b32_e64 v143, s49, v143
v_exp_f16_sdwa v153, v154 dst_sel:WORD_1 dst_unused:UNUSED_PRESERVE src0_sel:WORD_1
v_bfe_u32 v140, v141, 2, 14
v_exp_f16_sdwa v150, v151 dst_sel:WORD_1 dst_unused:UNUSED_PRESERVE src0_sel:WORD_1
v_mfma_f32_32x32x16_bf16 v[120:135], v[108:111], v[220:223], v[120:135]
ds_read_b64 v[216:217], v245 offset:5952
ds_read_b64 v[218:219], v246 offset:5952
ds_read_b128 v[208:211], v244 offset:64
ds_read_u16_d16 v140, v140
v_bfe_u32 v142, v143, 2, 14
v_exp_f16_sdwa v147, v148 dst_sel:WORD_1 dst_unused:UNUSED_PRESERVE src0_sel:WORD_1
v_lshrrev_b32_e64 v141, 18, v141
v_exp_f16_sdwa v144, v145 dst_sel:WORD_1 dst_unused:UNUSED_PRESERVE src0_sel:WORD_1
v_lshrrev_b32 v143, 18, v143
v_pk_add_f16 v153, v153, 1.0 op_sel_hi:[1,0]
v_pk_add_f16 v150, v150, 1.0 op_sel_hi:[1,0]
s_waitcnt lgkmcnt(6)
v_mfma_f32_16x16x32_bf16 v[44:47], v[224:227], v[200:203], v[44:47]
ds_read_b64 v[220:221], v245 offset:6720
ds_read_b64 v[222:223], v246 offset:6720
ds_read_b128 v[212:215], v244 offset:128
ds_read_u16_d16 v142, v142
ds_read_u16_d16_hi v141, v141
ds_read_u16_d16_hi v143, v143
v_pk_add_f16 v147, v147, 1.0 op_sel_hi:[1,0]
v_pk_add_f16 v144, v144, 1.0 op_sel_hi:[1,0]
v_rcp_f16_e64 v154, v153
v_mfma_f32_32x32x16_bf16 v[120:135], v[112:115], v[228:231], v[120:135]
ds_read_b64 v[224:225], v245 offset:192
ds_read_b64 v[226:227], v246 offset:192
v_xor_b32 v242, 32, v242
ds_read_b128 v[192:195], v242
v_rcp_f16 v151, v150
v_rcp_f16 v148, v147
v_rcp_f16 v145, v144
v_rcp_f16_sdwa v154, v153 dst_sel:WORD_1 dst_unused:UNUSED_PRESERVE src0_sel:WORD_1
v_rcp_f16_sdwa v151, v150 dst_sel:WORD_1 dst_unused:UNUSED_PRESERVE src0_sel:WORD_1
v_mfma_f32_16x16x32_bf16 v[12:15], v[232:235], v[204:207], v[12:15]
ds_read_b128 v[228:231], v248 offset:59392
v_rcp_f16_sdwa v148, v147 dst_sel:WORD_1 dst_unused:UNUSED_PRESERVE src0_sel:WORD_1
v_fma_mix_f32 v161, v136, v136, v161 op_sel:[0,0,0] op_sel_hi:[1,1,0]
s_setprio 1
v_rcp_f16_sdwa v145, v144 dst_sel:WORD_1 dst_unused:UNUSED_PRESERVE src0_sel:WORD_1
s_waitcnt lgkmcnt(9)
v_mfma_f32_32x32x16_bf16 v[120:135], v[116:119], v[236:239], v[120:135]
ds_read_b128 v[232:235], v248 offset:62464
v_fma_mix_f32 v161, v137, v137, v161 op_sel:[1,1,0] op_sel_hi:[1,1,0]
v_pk_mul_f16 v155, v155, v154
v_fma_mix_f32 v161, v138, v138, v161 op_sel:[0,0,0] op_sel_hi:[1,1,0]
v_pk_mul_f16 v152, v152, v151
v_pk_mul_f16 v149, v149, v148
v_fma_mix_f32 v161, v139, v139, v161 op_sel:[1,1,0] op_sel_hi:[1,1,0]
v_pk_mul_f16 v146, v146, v145
v_fma_mix_f32 v161, v155, v155, v161 op_sel:[0,0,0] op_sel_hi:[1,1,0]
v_fma_mix_f32 v161, v140, v140, v161 op_sel:[0,0,0] op_sel_hi:[1,1,0]
v_mfma_f32_16x16x32_bf16 v[28:31], v[216:219], v[208:211], v[28:31]
ds_read_b64 v[236:237], v245 offset:960
ds_read_b64 v[238:239], v246 offset:960
ds_read_b128 v[196:199], v242 offset:64
v_fma_mix_f32 v161, v155, v155, v161 op_sel:[1,1,0] op_sel_hi:[1,1,0]
v_fma_mix_f32 v161, v152, v152, v161 op_sel:[0,0,0] op_sel_hi:[1,1,0]
s_waitcnt lgkmcnt(5)
v_fma_mix_f32 v161, v141, v141, v161 op_sel:[1,1,0] op_sel_hi:[1,1,0]
v_fma_mix_f32 v161, v152, v152, v161 op_sel:[1,1,0] op_sel_hi:[1,1,0]
v_fma_mix_f32 v161, v149, v149, v161 op_sel:[0,0,0] op_sel_hi:[1,1,0]
v_mfma_f32_16x16x32_bf16 v[44:47], v[220:223], v[212:215], v[44:47]
ds_read_b128 v[216:219], v248 offset:60416
v_fma_mix_f32 v161, v142, v142, v161 op_sel:[0,0,0] op_sel_hi:[1,1,0]
v_fma_mix_f32 v161, v149, v149, v161 op_sel:[1,1,0] op_sel_hi:[1,1,0]
v_fma_mix_f32 v161, v146, v146, v161 op_sel:[0,0,0] op_sel_hi:[1,1,0]
v_fma_mix_f32 v161, v143, v143, v161 op_sel:[1,1,0] op_sel_hi:[1,1,0]
v_fma_mix_f32 v161, v146, v146, v161 op_sel:[1,1,0] op_sel_hi:[1,1,0]
v_mfma_f32_16x16x32_bf16 v[4:7], v[224:227], v[192:195], 0
ds_read_b128 v[220:223], v248 offset:63488
v_cvt_pkrtz_f16_f32 v137, v120, v121
v_cvt_pkrtz_f16_f32 v139, v122, v123
v_cvt_pkrtz_f16_f32 v141, v124, v125
v_cvt_pkrtz_f16_f32 v143, v126, v127
v_cvt_pk_f16_f32 v155, v128, v129
v_cvt_pk_f16_f32 v152, v130, v131
v_cvt_pk_f16_f32 v149, v132, v133
v_cvt_pk_f16_f32 v146, v134, v135
s_waitcnt lgkmcnt(3)
v_mfma_f32_32x32x16_bf16 v[120:135], v[96:99], v[228:231], 0
ds_read_b64 v[224:225], v245 offset:1728
ds_read_b64 v[226:227], v246 offset:1728
ds_read_b128 v[200:203], v242 offset:128
v_pk_fma_f16 v154, v155, v155, s48
v_and_b32_e64 v137, s49, v137
v_pk_fma_f16 v151, v152, v152, s48
v_pk_fma_f16 v148, v149, v149, s48
v_and_b32_e64 v139, s49, v139
v_pk_fma_f16 v145, v146, v146, s48
v_mfma_f32_32x32x16_bf16 v[120:135], v[100:103], v[232:235], v[120:135]
ds_read_b128 v[228:231], v248 offset:61440
v_pk_mul_f16 v154, v155, v154
v_bfe_u32 v136, v137, 2, 14
v_pk_mul_f16 v151, v152, v151
v_pk_mul_f16 v148, v149, v148
v_bfe_u32 v138, v139, 2, 14
v_pk_mul_f16 v145, v146, v145
v_exp_f16 v153, v154
v_lshrrev_b32 v137, 18, v137
s_waitcnt lgkmcnt(4)
v_mfma_f32_16x16x32_bf16 v[20:23], v[236:239], v[196:199], 0
ds_read_b64 v[232:233], v245 offset:2496
ds_read_b64 v[234:235], v246 offset:2496
v_xor_b32 v243, 32, v243
ds_read_b128 v[204:207], v243
ds_read_u16_d16 v136, v136
ds_read_u16_d16 v138, v138
ds_read_u16_d16_hi v137, v137
v_exp_f16 v150, v151
v_lshrrev_b32 v139, 18, v139
v_exp_f16_e64 v147, v148
v_mfma_f32_32x32x16_bf16 v[120:135], v[104:107], v[216:219], v[120:135]
ds_read_b128 v[236:239], v248 offset:64512
ds_read_u16_d16_hi v139, v139
v_and_b32 v141, s49, v141
v_exp_f16 v144, v145
v_and_b32_e64 v143, s49, v143
v_exp_f16_sdwa v153, v154 dst_sel:WORD_1 dst_unused:UNUSED_PRESERVE src0_sel:WORD_1
v_bfe_u32 v140, v141, 2, 14
v_exp_f16_sdwa v150, v151 dst_sel:WORD_1 dst_unused:UNUSED_PRESERVE src0_sel:WORD_1
v_mfma_f32_32x32x16_bf16 v[120:135], v[108:111], v[220:223], v[120:135]
ds_read_b64 v[216:217], v245 offset:3264
ds_read_b64 v[218:219], v246 offset:3264
ds_read_b128 v[208:211], v243 offset:64
ds_read_u16_d16 v140, v140
v_bfe_u32 v142, v143, 2, 14
v_exp_f16_sdwa v147, v148 dst_sel:WORD_1 dst_unused:UNUSED_PRESERVE src0_sel:WORD_1
v_lshrrev_b32_e64 v141, 18, v141
v_exp_f16_sdwa v144, v145 dst_sel:WORD_1 dst_unused:UNUSED_PRESERVE src0_sel:WORD_1
v_lshrrev_b32 v143, 18, v143
v_pk_add_f16 v153, v153, 1.0 op_sel_hi:[1,0]
v_pk_add_f16 v150, v150, 1.0 op_sel_hi:[1,0]
s_waitcnt lgkmcnt(6)
v_mfma_f32_16x16x32_bf16 v[36:39], v[224:227], v[200:203], 0
ds_read_b64 v[220:221], v245 offset:4032
ds_read_b64 v[222:223], v246 offset:4032
ds_read_b128 v[212:215], v243 offset:128
ds_read_u16_d16 v142, v142
ds_read_u16_d16_hi v141, v141
ds_read_u16_d16_hi v143, v143
v_pk_add_f16 v147, v147, 1.0 op_sel_hi:[1,0]
v_pk_add_f16 v144, v144, 1.0 op_sel_hi:[1,0]
v_rcp_f16_e64 v154, v153
v_mfma_f32_32x32x16_bf16 v[120:135], v[112:115], v[228:231], v[120:135]
ds_read_b64 v[224:225], v245 offset:4800
ds_read_b64 v[226:227], v246 offset:4800
v_xor_b32 v244, 32, v244
ds_read_b128 v[192:195], v244
v_rcp_f16 v151, v150
v_rcp_f16 v148, v147
v_rcp_f16 v145, v144
v_rcp_f16_sdwa v154, v153 dst_sel:WORD_1 dst_unused:UNUSED_PRESERVE src0_sel:WORD_1
v_rcp_f16_sdwa v151, v150 dst_sel:WORD_1 dst_unused:UNUSED_PRESERVE src0_sel:WORD_1
v_mfma_f32_16x16x32_bf16 v[4:7], v[232:235], v[204:207], v[4:7]
ds_read_b128 v[228:231], v249
v_rcp_f16_sdwa v148, v147 dst_sel:WORD_1 dst_unused:UNUSED_PRESERVE src0_sel:WORD_1
v_fma_mix_f32 v162, v136, v136, v162 op_sel:[0,0,0] op_sel_hi:[1,1,0]
v_rcp_f16_sdwa v145, v144 dst_sel:WORD_1 dst_unused:UNUSED_PRESERVE src0_sel:WORD_1
s_waitcnt lgkmcnt(10)
v_mfma_f32_32x32x16_bf16 v[120:135], v[116:119], v[236:239], v[120:135]
ds_read_b128 v[232:235], v249 offset:3072
v_fma_mix_f32 v162, v137, v137, v162 op_sel:[1,1,0] op_sel_hi:[1,1,0]
v_pk_mul_f16 v155, v155, v154
v_fma_mix_f32 v162, v138, v138, v162 op_sel:[0,0,0] op_sel_hi:[1,1,0]
v_pk_mul_f16 v152, v152, v151
v_pk_mul_f16 v149, v149, v148
v_fma_mix_f32 v162, v139, v139, v162 op_sel:[1,1,0] op_sel_hi:[1,1,0]
v_pk_mul_f16 v146, v146, v145
v_fma_mix_f32 v162, v155, v155, v162 op_sel:[0,0,0] op_sel_hi:[1,1,0]
v_fma_mix_f32 v162, v140, v140, v162 op_sel:[0,0,0] op_sel_hi:[1,1,0]
v_mfma_f32_16x16x32_bf16 v[20:23], v[216:219], v[208:211], v[20:23]
ds_read_b64 v[236:237], v245 offset:5568
ds_read_b64 v[238:239], v246 offset:5568
ds_read_b128 v[196:199], v244 offset:64
v_fma_mix_f32 v162, v155, v155, v162 op_sel:[1,1,0] op_sel_hi:[1,1,0]
v_fma_mix_f32 v162, v152, v152, v162 op_sel:[0,0,0] op_sel_hi:[1,1,0]
s_waitcnt lgkmcnt(5)
v_fma_mix_f32 v162, v141, v141, v162 op_sel:[1,1,0] op_sel_hi:[1,1,0]
v_fma_mix_f32 v162, v152, v152, v162 op_sel:[1,1,0] op_sel_hi:[1,1,0]
v_fma_mix_f32 v162, v149, v149, v162 op_sel:[0,0,0] op_sel_hi:[1,1,0]
v_mfma_f32_16x16x32_bf16 v[36:39], v[220:223], v[212:215], v[36:39]
ds_read_b128 v[216:219], v249 offset:1024
v_fma_mix_f32 v162, v142, v142, v162 op_sel:[0,0,0] op_sel_hi:[1,1,0]
v_fma_mix_f32 v162, v149, v149, v162 op_sel:[1,1,0] op_sel_hi:[1,1,0]
v_fma_mix_f32 v162, v146, v146, v162 op_sel:[0,0,0] op_sel_hi:[1,1,0]
v_fma_mix_f32 v162, v143, v143, v162 op_sel:[1,1,0] op_sel_hi:[1,1,0]
v_fma_mix_f32 v162, v146, v146, v162 op_sel:[1,1,0] op_sel_hi:[1,1,0]
v_mfma_f32_16x16x32_bf16 v[4:7], v[224:227], v[192:195], v[4:7]
ds_read_b128 v[220:223], v249 offset:4096
v_cvt_pkrtz_f16_f32 v137, v120, v121
v_cvt_pkrtz_f16_f32 v139, v122, v123
v_cvt_pkrtz_f16_f32 v141, v124, v125
v_cvt_pkrtz_f16_f32 v143, v126, v127
v_cvt_pk_f16_f32 v155, v128, v129
v_cvt_pk_f16_f32 v152, v130, v131
v_cvt_pk_f16_f32 v149, v132, v133
v_cvt_pk_f16_f32 v146, v134, v135
s_waitcnt lgkmcnt(3)
v_mfma_f32_32x32x16_bf16 v[120:135], v[96:99], v[228:231], 0
ds_read_b64 v[224:225], v245 offset:6336
ds_read_b64 v[226:227], v246 offset:6336
ds_read_b128 v[200:203], v244 offset:128
v_pk_fma_f16 v154, v155, v155, s48
v_and_b32 v137, s49, v137
v_pk_fma_f16 v151, v152, v152, s48
v_pk_fma_f16 v148, v149, v149, s48
v_and_b32_e64 v139, s49, v139
v_pk_fma_f16 v145, v146, v146, s48
v_mfma_f32_32x32x16_bf16 v[120:135], v[100:103], v[232:235], v[120:135]
ds_read_b128 v[228:231], v249 offset:2048
v_pk_mul_f16 v154, v155, v154
v_bfe_u32 v136, v137, 2, 14
v_pk_mul_f16 v151, v152, v151
v_pk_mul_f16 v148, v149, v148
v_bfe_u32 v138, v139, 2, 14
v_pk_mul_f16 v145, v146, v145
v_exp_f16 v153, v154
v_lshrrev_b32 v137, 18, v137
s_waitcnt lgkmcnt(4)
v_mfma_f32_16x16x32_bf16 v[20:23], v[236:239], v[196:199], v[20:23]
ds_read_b64 v[232:233], v245
ds_read_b64 v[234:235], v246
v_xor_b32 v242, 16, v242
ds_read_b128 v[204:207], v242
ds_read_u16_d16 v136, v136
ds_read_u16_d16 v138, v138
ds_read_u16_d16_hi v137, v137
v_exp_f16 v150, v151
v_lshrrev_b32 v139, 18, v139
v_exp_f16_e64 v147, v148
v_mfma_f32_32x32x16_bf16 v[120:135], v[104:107], v[216:219], v[120:135]
ds_read_b128 v[236:239], v249 offset:5120
ds_read_u16_d16_hi v139, v139
v_and_b32 v141, s49, v141
v_exp_f16 v144, v145
v_and_b32_e64 v143, s49, v143
v_exp_f16_sdwa v153, v154 dst_sel:WORD_1 dst_unused:UNUSED_PRESERVE src0_sel:WORD_1
v_bfe_u32 v140, v141, 2, 14
v_exp_f16_sdwa v150, v151 dst_sel:WORD_1 dst_unused:UNUSED_PRESERVE src0_sel:WORD_1
v_mfma_f32_32x32x16_bf16 v[120:135], v[108:111], v[220:223], v[120:135]
ds_read_b64 v[216:217], v245 offset:768
ds_read_b64 v[218:219], v246 offset:768
ds_read_b128 v[208:211], v242 offset:64
ds_read_u16_d16 v140, v140
v_bfe_u32 v142, v143, 2, 14
v_exp_f16_sdwa v147, v148 dst_sel:WORD_1 dst_unused:UNUSED_PRESERVE src0_sel:WORD_1
v_lshrrev_b32_e64 v141, 18, v141
v_exp_f16_sdwa v144, v145 dst_sel:WORD_1 dst_unused:UNUSED_PRESERVE src0_sel:WORD_1
v_lshrrev_b32 v143, 18, v143
v_pk_add_f16 v153, v153, 1.0 op_sel_hi:[1,0]
v_pk_add_f16 v150, v150, 1.0 op_sel_hi:[1,0]
s_waitcnt lgkmcnt(6)
v_mfma_f32_16x16x32_bf16 v[36:39], v[224:227], v[200:203], v[36:39]
ds_read_b64 v[220:221], v245 offset:1536
ds_read_b64 v[222:223], v246 offset:1536
ds_read_b128 v[212:215], v242 offset:128
ds_read_u16_d16 v142, v142
ds_read_u16_d16_hi v141, v141
ds_read_u16_d16_hi v143, v143
v_pk_add_f16 v147, v147, 1.0 op_sel_hi:[1,0]
v_pk_add_f16 v144, v144, 1.0 op_sel_hi:[1,0]
v_rcp_f16_e64 v154, v153
v_mfma_f32_32x32x16_bf16 v[120:135], v[112:115], v[228:231], v[120:135]
ds_read_b64 v[224:225], v245 offset:2304
ds_read_b64 v[226:227], v246 offset:2304
v_xor_b32 v243, 16, v243
ds_read_b128 v[192:195], v243
v_rcp_f16 v151, v150
v_rcp_f16 v148, v147
v_rcp_f16 v145, v144
v_rcp_f16_sdwa v154, v153 dst_sel:WORD_1 dst_unused:UNUSED_PRESERVE src0_sel:WORD_1
v_rcp_f16_sdwa v151, v150 dst_sel:WORD_1 dst_unused:UNUSED_PRESERVE src0_sel:WORD_1
v_mfma_f32_16x16x32_bf16 v[0:3], v[232:235], v[204:207], 0
ds_read_b128 v[228:231], v249 offset:6144
v_rcp_f16_sdwa v148, v147 dst_sel:WORD_1 dst_unused:UNUSED_PRESERVE src0_sel:WORD_1
v_fma_mix_f32 v163, v136, v136, v163 op_sel:[0,0,0] op_sel_hi:[1,1,0]
v_rcp_f16_sdwa v145, v144 dst_sel:WORD_1 dst_unused:UNUSED_PRESERVE src0_sel:WORD_1
s_waitcnt lgkmcnt(10)
v_mfma_f32_32x32x16_bf16 v[120:135], v[116:119], v[236:239], v[120:135]
ds_read_b128 v[232:235], v249 offset:9216
v_fma_mix_f32 v163, v137, v137, v163 op_sel:[1,1,0] op_sel_hi:[1,1,0]
v_pk_mul_f16 v155, v155, v154
v_fma_mix_f32 v163, v138, v138, v163 op_sel:[0,0,0] op_sel_hi:[1,1,0]
v_pk_mul_f16 v152, v152, v151
v_pk_mul_f16 v149, v149, v148
v_fma_mix_f32 v163, v139, v139, v163 op_sel:[1,1,0] op_sel_hi:[1,1,0]
v_pk_mul_f16 v146, v146, v145
v_fma_mix_f32 v163, v155, v155, v163 op_sel:[0,0,0] op_sel_hi:[1,1,0]
v_fma_mix_f32 v163, v140, v140, v163 op_sel:[0,0,0] op_sel_hi:[1,1,0]
v_mfma_f32_16x16x32_bf16 v[16:19], v[216:219], v[208:211], 0
ds_read_b64 v[236:237], v245 offset:3072
ds_read_b64 v[238:239], v246 offset:3072
ds_read_b128 v[196:199], v243 offset:64
v_fma_mix_f32 v163, v155, v155, v163 op_sel:[1,1,0] op_sel_hi:[1,1,0]
v_fma_mix_f32 v163, v152, v152, v163 op_sel:[0,0,0] op_sel_hi:[1,1,0]
s_waitcnt lgkmcnt(5)
v_fma_mix_f32 v163, v141, v141, v163 op_sel:[1,1,0] op_sel_hi:[1,1,0]
v_fma_mix_f32 v163, v152, v152, v163 op_sel:[1,1,0] op_sel_hi:[1,1,0]
v_fma_mix_f32 v163, v149, v149, v163 op_sel:[0,0,0] op_sel_hi:[1,1,0]
v_mfma_f32_16x16x32_bf16 v[32:35], v[220:223], v[212:215], 0
ds_read_b128 v[216:219], v249 offset:7168
v_fma_mix_f32 v163, v142, v142, v163 op_sel:[0,0,0] op_sel_hi:[1,1,0]
v_fma_mix_f32 v163, v149, v149, v163 op_sel:[1,1,0] op_sel_hi:[1,1,0]
v_fma_mix_f32 v163, v146, v146, v163 op_sel:[0,0,0] op_sel_hi:[1,1,0]
v_fma_mix_f32 v163, v143, v143, v163 op_sel:[1,1,0] op_sel_hi:[1,1,0]
v_fma_mix_f32 v163, v146, v146, v163 op_sel:[1,1,0] op_sel_hi:[1,1,0]
v_mfma_f32_16x16x32_bf16 v[0:3], v[224:227], v[192:195], v[0:3]
ds_read_b128 v[220:223], v249 offset:10240
v_cvt_pkrtz_f16_f32 v137, v120, v121
v_cvt_pkrtz_f16_f32 v139, v122, v123
v_cvt_pkrtz_f16_f32 v141, v124, v125
v_cvt_pkrtz_f16_f32 v143, v126, v127
v_cvt_pk_f16_f32 v155, v128, v129
v_cvt_pk_f16_f32 v152, v130, v131
v_cvt_pk_f16_f32 v149, v132, v133
v_cvt_pk_f16_f32 v146, v134, v135
s_waitcnt lgkmcnt(3)
v_mfma_f32_32x32x16_bf16 v[120:135], v[96:99], v[228:231], 0
ds_read_b64 v[224:225], v245 offset:3840
ds_read_b64 v[226:227], v246 offset:3840
ds_read_b128 v[200:203], v243 offset:128
s_setprio 0
v_pk_fma_f16 v154, v155, v155, s48
v_and_b32_e64 v137, s49, v137
v_pk_fma_f16 v151, v152, v152, s48
v_pk_fma_f16 v148, v149, v149, s48
v_mfma_f32_32x32x16_bf16 v[120:135], v[100:103], v[232:235], v[120:135]
ds_read_b128 v[228:231], v249 offset:8192
v_and_b32_e64 v139, s49, v139
v_pk_fma_f16 v145, v146, v146, s48
v_pk_mul_f16 v154, v155, v154
v_bfe_u32 v136, v137, 2, 14
v_pk_mul_f16 v151, v152, v151
v_pk_mul_f16 v148, v149, v148
v_bfe_u32 v138, v139, 2, 14
v_pk_mul_f16 v145, v146, v145
s_waitcnt lgkmcnt(4)
v_mfma_f32_16x16x32_bf16 v[16:19], v[236:239], v[196:199], v[16:19]
ds_read_b64 v[232:233], v245 offset:4608
ds_read_b64 v[234:235], v246 offset:4608
v_xor_b32 v244, 16, v244
ds_read_b128 v[204:207], v244
ds_read_u16_d16 v136, v136
ds_read_u16_d16 v138, v138
v_exp_f16 v153, v154
v_lshrrev_b32 v137, 18, v137
v_exp_f16_e64 v150, v151
v_mfma_f32_32x32x16_bf16 v[120:135], v[104:107], v[216:219], v[120:135]
ds_read_b128 v[236:239], v249 offset:11264
ds_read_u16_d16_hi v137, v137
v_lshrrev_b32 v139, 18, v139
v_exp_f16 v147, v148
v_and_b32 v141, s49, v141
v_exp_f16 v144, v145
v_and_b32_e64 v143, s49, v143
v_mfma_f32_32x32x16_bf16 v[120:135], v[108:111], v[220:223], v[120:135]
ds_read_b64 v[216:217], v245 offset:5376
ds_read_b64 v[218:219], v246 offset:5376
ds_read_b128 v[208:211], v244 offset:64
ds_read_u16_d16_hi v139, v139
v_exp_f16_sdwa v153, v154 dst_sel:WORD_1 dst_unused:UNUSED_PRESERVE src0_sel:WORD_1
v_bfe_u32 v140, v141, 2, 14
v_exp_f16_sdwa v150, v151 dst_sel:WORD_1 dst_unused:UNUSED_PRESERVE src0_sel:WORD_1
v_bfe_u32 v142, v143, 2, 14
v_exp_f16_sdwa v147, v148 dst_sel:WORD_1 dst_unused:UNUSED_PRESERVE src0_sel:WORD_1
v_lshrrev_b32 v141, 18, v141
s_waitcnt lgkmcnt(8)
v_mfma_f32_16x16x32_bf16 v[32:35], v[224:227], v[200:203], v[32:35]
ds_read_b64 v[220:221], v245 offset:6144
ds_read_b64 v[222:223], v246 offset:6144
ds_read_b128 v[212:215], v244 offset:128
ds_read_u16_d16 v140, v140
ds_read_u16_d16 v142, v142
ds_read_u16_d16_hi v141, v141
v_exp_f16_sdwa v144, v145 dst_sel:WORD_1 dst_unused:UNUSED_PRESERVE src0_sel:WORD_1
v_lshrrev_b32_e64 v143, 18, v143
v_pk_add_f16 v153, v153, 1.0 op_sel_hi:[1,0]
v_pk_add_f16 v150, v150, 1.0 op_sel_hi:[1,0]
v_mfma_f32_32x32x16_bf16 v[120:135], v[112:115], v[228:231], v[120:135]
ds_read_b128 v[224:227], v249 offset:12288
ds_read_u16_d16_hi v143, v143
v_pk_add_f16 v147, v147, 1.0 op_sel_hi:[1,0]
v_pk_add_f16 v144, v144, 1.0 op_sel_hi:[1,0]
v_rcp_f16 v154, v153
v_rcp_f16 v151, v150
v_rcp_f16_e64 v148, v147
v_mfma_f32_16x16x32_bf16 v[0:3], v[232:235], v[204:207], v[0:3]
ds_read_b128 v[228:231], v249 offset:15360
v_rcp_f16 v145, v144
v_rcp_f16_sdwa v154, v153 dst_sel:WORD_1 dst_unused:UNUSED_PRESERVE src0_sel:WORD_1
s_waitcnt lgkmcnt(9)
v_mfma_f32_32x32x16_bf16 v[120:135], v[116:119], v[236:239], v[120:135]
ds_read_b128 v[232:235], v249 offset:13312
v_rcp_f16_sdwa v151, v150 dst_sel:WORD_1 dst_unused:UNUSED_PRESERVE src0_sel:WORD_1
v_rcp_f16_sdwa v148, v147 dst_sel:WORD_1 dst_unused:UNUSED_PRESERVE src0_sel:WORD_1
v_fma_mix_f32 v164, v136, v136, v164 op_sel:[0,0,0] op_sel_hi:[1,1,0]
v_rcp_f16_sdwa v145, v144 dst_sel:WORD_1 dst_unused:UNUSED_PRESERVE src0_sel:WORD_1
v_fma_mix_f32 v164, v137, v137, v164 op_sel:[1,1,0] op_sel_hi:[1,1,0]
v_pk_mul_f16 v155, v155, v154
v_mfma_f32_16x16x32_bf16 v[16:19], v[216:219], v[208:211], v[16:19]
ds_read_b128 v[236:239], v249 offset:16384
v_fma_mix_f32 v164, v138, v138, v164 op_sel:[0,0,0] op_sel_hi:[1,1,0]
v_pk_mul_f16 v152, v152, v151
v_pk_mul_f16 v149, v149, v148
v_fma_mix_f32 v164, v139, v139, v164 op_sel:[1,1,0] op_sel_hi:[1,1,0]
s_waitcnt lgkmcnt(3)
v_mfma_f32_16x16x32_bf16 v[32:35], v[220:223], v[212:215], v[32:35]
ds_read_b128 v[216:219], v249 offset:14336
v_pk_mul_f16 v146, v146, v145
v_fma_mix_f32 v164, v155, v155, v164 op_sel:[0,0,0] op_sel_hi:[1,1,0]
v_fma_mix_f32 v164, v140, v140, v164 op_sel:[0,0,0] op_sel_hi:[1,1,0]
v_fma_mix_f32 v164, v155, v155, v164 op_sel:[1,1,0] op_sel_hi:[1,1,0]
v_fma_mix_f32 v164, v152, v152, v164 op_sel:[0,0,0] op_sel_hi:[1,1,0]
v_fma_mix_f32 v164, v141, v141, v164 op_sel:[1,1,0] op_sel_hi:[1,1,0]
v_fma_mix_f32 v164, v152, v152, v164 op_sel:[1,1,0] op_sel_hi:[1,1,0]
v_fma_mix_f32 v164, v149, v149, v164 op_sel:[0,0,0] op_sel_hi:[1,1,0]
v_fma_mix_f32 v164, v142, v142, v164 op_sel:[0,0,0] op_sel_hi:[1,1,0]
v_fma_mix_f32 v164, v149, v149, v164 op_sel:[1,1,0] op_sel_hi:[1,1,0]
v_fma_mix_f32 v164, v146, v146, v164 op_sel:[0,0,0] op_sel_hi:[1,1,0]
v_fma_mix_f32 v164, v143, v143, v164 op_sel:[1,1,0] op_sel_hi:[1,1,0]
v_fma_mix_f32 v164, v146, v146, v164 op_sel:[1,1,0] op_sel_hi:[1,1,0]
s_setprio 3
v_pk_add_f32 v[168:169], v[0:1], v[2:3]
v_pk_mul_f32 v[170:171], v[0:1], v[0:1]
v_pk_fma_f32 v[170:171], v[2:3], v[2:3], v[170:171]
v_pk_add_f32 v[168:169], v[168:169], v[4:5]
v_pk_fma_f32 v[170:171], v[4:5], v[4:5], v[170:171]
v_pk_add_f32 v[168:169], v[168:169], v[6:7]
v_pk_fma_f32 v[170:171], v[6:7], v[6:7], v[170:171]
v_pk_add_f32 v[168:169], v[168:169], v[8:9]
v_pk_fma_f32 v[170:171], v[8:9], v[8:9], v[170:171]
v_pk_add_f32 v[168:169], v[168:169], v[10:11]
v_pk_fma_f32 v[170:171], v[10:11], v[10:11], v[170:171]
v_pk_add_f32 v[168:169], v[168:169], v[12:13]
v_pk_fma_f32 v[170:171], v[12:13], v[12:13], v[170:171]
v_pk_add_f32 v[168:169], v[168:169], v[14:15]
v_pk_fma_f32 v[170:171], v[14:15], v[14:15], v[170:171]
v_pk_add_f32 v[168:169], v[168:169], v[16:17]
v_pk_fma_f32 v[170:171], v[16:17], v[16:17], v[170:171]
v_pk_add_f32 v[168:169], v[168:169], v[18:19]
v_pk_fma_f32 v[170:171], v[18:19], v[18:19], v[170:171]
v_pk_add_f32 v[168:169], v[168:169], v[20:21]
v_pk_fma_f32 v[170:171], v[20:21], v[20:21], v[170:171]
v_pk_add_f32 v[168:169], v[168:169], v[22:23]
v_pk_fma_f32 v[170:171], v[22:23], v[22:23], v[170:171]
v_pk_add_f32 v[168:169], v[168:169], v[24:25]
v_pk_fma_f32 v[170:171], v[24:25], v[24:25], v[170:171]
v_pk_add_f32 v[168:169], v[168:169], v[26:27]
v_pk_fma_f32 v[170:171], v[26:27], v[26:27], v[170:171]
v_pk_add_f32 v[168:169], v[168:169], v[28:29]
v_pk_fma_f32 v[170:171], v[28:29], v[28:29], v[170:171]
v_pk_add_f32 v[168:169], v[168:169], v[30:31]
v_pk_fma_f32 v[170:171], v[30:31], v[30:31], v[170:171]
v_pk_add_f32 v[168:169], v[168:169], v[32:33]
v_pk_fma_f32 v[170:171], v[32:33], v[32:33], v[170:171]
v_pk_add_f32 v[168:169], v[168:169], v[34:35]
v_pk_fma_f32 v[170:171], v[34:35], v[34:35], v[170:171]
v_pk_add_f32 v[168:169], v[168:169], v[36:37]
v_pk_fma_f32 v[170:171], v[36:37], v[36:37], v[170:171]
v_pk_add_f32 v[168:169], v[168:169], v[38:39]
v_pk_fma_f32 v[170:171], v[38:39], v[38:39], v[170:171]
v_pk_add_f32 v[168:169], v[168:169], v[40:41]
v_pk_fma_f32 v[170:171], v[40:41], v[40:41], v[170:171]
v_pk_add_f32 v[168:169], v[168:169], v[42:43]
v_pk_fma_f32 v[170:171], v[42:43], v[42:43], v[170:171]
v_pk_add_f32 v[168:169], v[168:169], v[44:45]
v_pk_fma_f32 v[170:171], v[44:45], v[44:45], v[170:171]
v_pk_add_f32 v[168:169], v[168:169], v[46:47]
v_pk_fma_f32 v[170:171], v[46:47], v[46:47], v[170:171]
s_setprio 0
s_barrier
v_lshrrev_b32_e64 v240, 2, v251
v_mul_u32_u24 v240, 192, v240
v_and_b32 v247, 3, v251
v_lshl_add_u32 v240, v247, 4, v240
s_setprio 2
v_cvt_pkrtz_f16_f32 v137, v120, v121
v_cvt_pkrtz_f16_f32 v139, v122, v123
v_cvt_pkrtz_f16_f32 v141, v124, v125
v_cvt_pkrtz_f16_f32 v143, v126, v127
v_cvt_pkrtz_f16_f32 v145, v128, v129
v_cvt_pk_f16_f32 v155, v130, v131
v_cvt_pk_f16_f32 v152, v132, v133
v_cvt_pk_f16_f32 v149, v134, v135
s_add_u32 m0, s72, 0
s_add_u32 s43, s82, 0
buffer_load_dwordx4 v240, s[16:19], s43 offen lds
ds_read_b128 v[220:223], v249 offset:17408
v_mfma_f32_32x32x16_bf16 v[120:135], v[96:99], v[224:227], 0
v_pk_fma_f16 v154, v155, v155, s48
v_add_f32 v168, v168, v169
v_and_b32 v137, s49, v137
v_pk_fma_f16 v151, v152, v152, s48
v_and_b32_e64 v139, s49, v139
v_pk_fma_f16 v148, v149, v149, s48
v_add_f32_e64 v170, v170, v171
v_pk_mul_f16 v154, v155, v154
v_bfe_u32 v136, v137, 2, 14
v_pk_mul_f16 v151, v152, v151
v_pk_mul_f16 v148, v149, v148
v_bfe_u32 v138, v139, 2, 14
s_waitcnt lgkmcnt(1)
ds_read_b128 v[224:227], v249 offset:18432
ds_read_u16_d16 v136, v136
ds_read_u16_d16 v138, v138
v_mfma_f32_32x32x16_bf16 v[120:135], v[100:103], v[228:231], v[120:135]
v_permlane32_swap_b32 v168, v170
v_exp_f16 v153, v154
v_lshrrev_b32 v137, 18, v137
v_exp_f16 v150, v151
v_add_f32 v168, v168, v170
v_lshrrev_b32 v139, 18, v139
v_exp_f16 v147, v148
v_and_b32 v141, s49, v141
v_and_b32 v143, s49, v143
v_mul_f32 v168, 1009429163, v168
ds_read_b128 v[228:231], v249 offset:21504
ds_read_u16_d16_hi v137, v137
ds_read_u16_d16_hi v139, v139
v_mfma_f32_32x32x16_bf16 v[120:135], v[104:107], v[232:235], v[120:135]
v_exp_f16_sdwa v153, v154 dst_sel:WORD_1 dst_unused:UNUSED_PRESERVE src0_sel:WORD_1
v_bfe_u32 v140, v141, 2, 14
v_exp_f16_sdwa v150, v151 dst_sel:WORD_1 dst_unused:UNUSED_PRESERVE src0_sel:WORD_1
v_mov_b32_e64 v170, v168
v_bfe_u32 v142, v143, 2, 14
v_exp_f16_sdwa v147, v148 dst_sel:WORD_1 dst_unused:UNUSED_PRESERVE src0_sel:WORD_1
v_lshrrev_b32_e64 v141, 18, v141
v_permlane32_swap_b32 v168, v170
v_pk_add_f16 v153, v153, 1.0 op_sel_hi:[1,0]
s_add_u32 m0, s72, 1024
s_add_u32 s43, s82, 64
buffer_load_dwordx4 v240, s[16:19], s43 offen lds
ds_read_b128 v[232:235], v249 offset:19456
ds_read_u16_d16 v140, v140
ds_read_u16_d16 v142, v142
ds_read_u16_d16_hi v141, v141
v_mfma_f32_32x32x16_bf16 v[120:135], v[108:111], v[236:239], v[120:135]
v_lshrrev_b32_e64 v143, 18, v143
v_pk_add_f16 v150, v150, 1.0 op_sel_hi:[1,0]
v_pk_add_f16 v147, v147, 1.0 op_sel_hi:[1,0]
v_and_b32_e64 v145, s49, v145
v_fma_f32 v170, -v168, v168, v170
v_rcp_f16_e64 v154, v153
v_bfe_u32 v144, v145, 2, 14
v_rcp_f16 v151, v150
v_max_f32 v170, 0, v170
v_lshrrev_b32_e64 v145, 18, v145
ds_read_b128 v[236:239], v249 offset:22528
ds_read_u16_d16_hi v143, v143
ds_read_u16_d16 v144, v144
ds_read_u16_d16_hi v145, v145
v_mfma_f32_32x32x16_bf16 v[120:135], v[112:115], v[216:219], v[120:135]
v_rcp_f16 v148, v147
v_rcp_f16_sdwa v154, v153 dst_sel:WORD_1 dst_unused:UNUSED_PRESERVE src0_sel:WORD_1
v_add_f32 v170, 925353388, v170
s_waitcnt lgkmcnt(8)
v_fma_mix_f32 v165, v136, v136, v165 op_sel:[0,0,0] op_sel_hi:[1,1,0]
v_fma_mix_f32 v165, v137, v137, v165 op_sel:[1,1,0] op_sel_hi:[1,1,0]
v_rcp_f16_sdwa v151, v150 dst_sel:WORD_1 dst_unused:UNUSED_PRESERVE src0_sel:WORD_1
v_rsq_f32_e64 v170, v170
v_fma_mix_f32 v165, v138, v138, v165 op_sel:[0,0,0] op_sel_hi:[1,1,0]
ds_read_b128 v[216:219], v249 offset:20480
v_mfma_f32_32x32x16_bf16 v[120:135], v[116:119], v[220:223], v[120:135]
v_rcp_f16_sdwa v148, v147 dst_sel:WORD_1 dst_unused:UNUSED_PRESERVE src0_sel:WORD_1
v_fma_mix_f32 v165, v139, v139, v165 op_sel:[1,1,0] op_sel_hi:[1,1,0]
v_pk_mul_f16 v155, v155, v154
s_waitcnt lgkmcnt(5)
v_fma_mix_f32 v165, v140, v140, v165 op_sel:[0,0,0] op_sel_hi:[1,1,0]
v_pk_mul_f16 v152, v152, v151
v_fma_mix_f32 v165, v141, v141, v165 op_sel:[1,1,0] op_sel_hi:[1,1,0]
v_pk_mul_f16 v149, v149, v148
v_fma_mix_f32 v165, v155, v155, v165 op_sel:[0,0,0] op_sel_hi:[1,1,0]
v_mul_f32 v172, 3203391086, v170
v_fma_mix_f32 v165, v142, v142, v165 op_sel:[0,0,0] op_sel_hi:[1,1,0]
v_fma_mix_f32 v165, v155, v155, v165 op_sel:[1,1,0] op_sel_hi:[1,1,0]
s_waitcnt lgkmcnt(1)
v_fma_mix_f32 v165, v143, v143, v165 op_sel:[1,1,0] op_sel_hi:[1,1,0]
v_fma_mix_f32 v165, v152, v152, v165 op_sel:[0,0,0] op_sel_hi:[1,1,0]
v_fma_mix_f32 v165, v152, v152, v165 op_sel:[1,1,0] op_sel_hi:[1,1,0]
v_mul_f32 v173, v168, v172
v_fma_mix_f32 v165, v144, v144, v165 op_sel:[0,0,0] op_sel_hi:[1,1,0]
v_fma_mix_f32 v165, v149, v149, v165 op_sel:[0,0,0] op_sel_hi:[1,1,0]
v_fma_mix_f32 v165, v145, v145, v165 op_sel:[1,1,0] op_sel_hi:[1,1,0]
v_fma_mix_f32 v165, v149, v149, v165 op_sel:[1,1,0] op_sel_hi:[1,1,0]
s_setprio 3
v_pk_fma_f32 v[0:1], v[0:1], v[172:173], v[172:173] op_sel:[0,0,1] op_sel_hi:[1,0,1] neg_lo:[0,0,1] neg_hi:[0,0,1]
v_pk_fma_f32 v[2:3], v[2:3], v[172:173], v[172:173] op_sel:[0,0,1] op_sel_hi:[1,0,1] neg_lo:[0,0,1] neg_hi:[0,0,1]
v_pk_fma_f32 v[4:5], v[4:5], v[172:173], v[172:173] op_sel:[0,0,1] op_sel_hi:[1,0,1] neg_lo:[0,0,1] neg_hi:[0,0,1]
v_pk_fma_f32 v[6:7], v[6:7], v[172:173], v[172:173] op_sel:[0,0,1] op_sel_hi:[1,0,1] neg_lo:[0,0,1] neg_hi:[0,0,1]
v_pk_fma_f32 v[8:9], v[8:9], v[172:173], v[172:173] op_sel:[0,0,1] op_sel_hi:[1,0,1] neg_lo:[0,0,1] neg_hi:[0,0,1]
v_pk_fma_f32 v[10:11], v[10:11], v[172:173], v[172:173] op_sel:[0,0,1] op_sel_hi:[1,0,1] neg_lo:[0,0,1] neg_hi:[0,0,1]
v_pk_fma_f32 v[12:13], v[12:13], v[172:173], v[172:173] op_sel:[0,0,1] op_sel_hi:[1,0,1] neg_lo:[0,0,1] neg_hi:[0,0,1]
v_pk_fma_f32 v[14:15], v[14:15], v[172:173], v[172:173] op_sel:[0,0,1] op_sel_hi:[1,0,1] neg_lo:[0,0,1] neg_hi:[0,0,1]
v_pk_fma_f32 v[16:17], v[16:17], v[172:173], v[172:173] op_sel:[0,0,1] op_sel_hi:[1,0,1] neg_lo:[0,0,1] neg_hi:[0,0,1]
v_pk_fma_f32 v[18:19], v[18:19], v[172:173], v[172:173] op_sel:[0,0,1] op_sel_hi:[1,0,1] neg_lo:[0,0,1] neg_hi:[0,0,1]
v_pk_fma_f32 v[20:21], v[20:21], v[172:173], v[172:173] op_sel:[0,0,1] op_sel_hi:[1,0,1] neg_lo:[0,0,1] neg_hi:[0,0,1]
v_pk_fma_f32 v[22:23], v[22:23], v[172:173], v[172:173] op_sel:[0,0,1] op_sel_hi:[1,0,1] neg_lo:[0,0,1] neg_hi:[0,0,1]
v_pk_fma_f32 v[24:25], v[24:25], v[172:173], v[172:173] op_sel:[0,0,1] op_sel_hi:[1,0,1] neg_lo:[0,0,1] neg_hi:[0,0,1]
v_pk_fma_f32 v[26:27], v[26:27], v[172:173], v[172:173] op_sel:[0,0,1] op_sel_hi:[1,0,1] neg_lo:[0,0,1] neg_hi:[0,0,1]
v_pk_fma_f32 v[28:29], v[28:29], v[172:173], v[172:173] op_sel:[0,0,1] op_sel_hi:[1,0,1] neg_lo:[0,0,1] neg_hi:[0,0,1]
v_pk_fma_f32 v[30:31], v[30:31], v[172:173], v[172:173] op_sel:[0,0,1] op_sel_hi:[1,0,1] neg_lo:[0,0,1] neg_hi:[0,0,1]
v_pk_fma_f32 v[32:33], v[32:33], v[172:173], v[172:173] op_sel:[0,0,1] op_sel_hi:[1,0,1] neg_lo:[0,0,1] neg_hi:[0,0,1]
v_pk_fma_f32 v[34:35], v[34:35], v[172:173], v[172:173] op_sel:[0,0,1] op_sel_hi:[1,0,1] neg_lo:[0,0,1] neg_hi:[0,0,1]
v_pk_fma_f32 v[36:37], v[36:37], v[172:173], v[172:173] op_sel:[0,0,1] op_sel_hi:[1,0,1] neg_lo:[0,0,1] neg_hi:[0,0,1]
v_pk_fma_f32 v[38:39], v[38:39], v[172:173], v[172:173] op_sel:[0,0,1] op_sel_hi:[1,0,1] neg_lo:[0,0,1] neg_hi:[0,0,1]
v_pk_fma_f32 v[40:41], v[40:41], v[172:173], v[172:173] op_sel:[0,0,1] op_sel_hi:[1,0,1] neg_lo:[0,0,1] neg_hi:[0,0,1]
v_pk_fma_f32 v[42:43], v[42:43], v[172:173], v[172:173] op_sel:[0,0,1] op_sel_hi:[1,0,1] neg_lo:[0,0,1] neg_hi:[0,0,1]
v_pk_fma_f32 v[44:45], v[44:45], v[172:173], v[172:173] op_sel:[0,0,1] op_sel_hi:[1,0,1] neg_lo:[0,0,1] neg_hi:[0,0,1]
v_pk_fma_f32 v[46:47], v[46:47], v[172:173], v[172:173] op_sel:[0,0,1] op_sel_hi:[1,0,1] neg_lo:[0,0,1] neg_hi:[0,0,1]
s_setprio 2
v_cvt_pkrtz_f16_f32 v137, v120, v121
v_cvt_pkrtz_f16_f32 v139, v122, v123
v_cvt_pkrtz_f16_f32 v141, v124, v125
v_cvt_pkrtz_f16_f32 v143, v126, v127
v_cvt_pkrtz_f16_f32 v145, v128, v129
v_cvt_pk_f16_f32 v155, v130, v131
v_cvt_pk_f16_f32 v152, v132, v133
v_cvt_pk_f16_f32 v149, v134, v135
s_add_u32 m0, s72, 2048
s_add_u32 s43, s82, 128
buffer_load_dwordx4 v240, s[16:19], s43 offen lds
ds_read_b128 v[220:223], v249 offset:23552
v_mfma_f32_32x32x16_bf16 v[120:135], v[96:99], v[224:227], 0
v_pk_fma_f16 v154, v155, v155, s48
v_cvt_pk_bf16_f32 v168, v0, v1
v_and_b32 v137, s49, v137
v_pk_fma_f16 v151, v152, v152, s48
v_cvt_pk_bf16_f32 v169, v2, v3
v_and_b32_e64 v139, s49, v139
v_pk_fma_f16 v148, v149, v149, s48
v_pk_mul_f16 v154, v155, v154
v_cvt_pk_bf16_f32 v170, v4, v5
v_bfe_u32 v136, v137, 2, 14
v_pk_mul_f16 v151, v152, v151
v_pk_mul_f16 v148, v149, v148
v_cvt_pk_bf16_f32 v171, v6, v7
v_bfe_u32 v138, v139, 2, 14
ds_read_b128 v[224:227], v248 offset:16384
ds_read_u16_d16 v136, v136
ds_read_u16_d16 v138, v138
v_mfma_f32_32x32x16_bf16 v[120:135], v[100:103], v[228:231], v[120:135]
v_exp_f16_e64 v153, v154
v_cvt_pk_bf16_f32 v172, v8, v9
v_lshrrev_b32 v137, 18, v137
v_exp_f16 v150, v151
v_cvt_pk_bf16_f32 v173, v10, v11
v_lshrrev_b32 v139, 18, v139
v_exp_f16 v147, v148
v_cvt_pk_bf16_f32 v174, v12, v13
v_and_b32 v141, s49, v141
v_and_b32 v143, s49, v143
v_cvt_pk_bf16_f32 v175, v14, v15
ds_read_b128 v[228:231], v248 offset:19456
ds_read_u16_d16_hi v137, v137
ds_read_u16_d16_hi v139, v139
v_mfma_f32_32x32x16_bf16 v[120:135], v[104:107], v[232:235], v[120:135]
v_exp_f16_sdwa v153, v154 dst_sel:WORD_1 dst_unused:UNUSED_PRESERVE src0_sel:WORD_1
v_bfe_u32 v140, v141, 2, 14
v_cvt_pk_bf16_f32 v176, v16, v17
v_exp_f16_sdwa v150, v151 dst_sel:WORD_1 dst_unused:UNUSED_PRESERVE src0_sel:WORD_1
v_bfe_u32 v142, v143, 2, 14
v_cvt_pk_bf16_f32 v177, v18, v19
v_exp_f16_sdwa v147, v148 dst_sel:WORD_1 dst_unused:UNUSED_PRESERVE src0_sel:WORD_1
v_cvt_pk_bf16_f32 v178, v20, v21
v_lshrrev_b32_e64 v141, 18, v141
v_pk_add_f16 v153, v153, 1.0 op_sel_hi:[1,0]
v_lshrrev_b32_e64 v143, 18, v143
s_add_u32 m0, s72, 3072
s_add_u32 s43, s82, 3072
buffer_load_dwordx4 v240, s[16:19], s43 offen lds
ds_read_b128 v[232:235], v248 offset:17408
ds_read_u16_d16 v140, v140
ds_read_u16_d16 v142, v142
ds_read_u16_d16_hi v141, v141
ds_read_u16_d16_hi v143, v143
v_mfma_f32_32x32x16_bf16 v[120:135], v[108:111], v[236:239], v[120:135]
v_cvt_pk_bf16_f32 v179, v22, v23
v_pk_add_f16 v150, v150, 1.0 op_sel_hi:[1,0]
v_pk_add_f16 v147, v147, 1.0 op_sel_hi:[1,0]
v_and_b32_e64 v145, s49, v145
v_cvt_pk_bf16_f32 v180, v24, v25
v_rcp_f16_e64 v154, v153
v_bfe_u32 v144, v145, 2, 14
v_cvt_pk_bf16_f32 v181, v26, v27
v_rcp_f16_e64 v151, v150
v_lshrrev_b32 v145, 18, v145
v_cvt_pk_bf16_f32 v182, v28, v29
s_waitcnt lgkmcnt(5)
ds_read_b128 v[236:239], v248 offset:20480
ds_read_u16_d16 v144, v144
ds_read_u16_d16_hi v145, v145
v_mfma_f32_32x32x16_bf16 v[120:135], v[112:115], v[216:219], v[120:135]
v_rcp_f16 v148, v147
v_cvt_pk_bf16_f32 v183, v30, v31
v_rcp_f16_sdwa v154, v153 dst_sel:WORD_1 dst_unused:UNUSED_PRESERVE src0_sel:WORD_1
v_fma_mix_f32 v166, v136, v136, v166 op_sel:[0,0,0] op_sel_hi:[1,1,0]
v_cvt_pk_bf16_f32 v184, v32, v33
v_fma_mix_f32 v166, v137, v137, v166 op_sel:[1,1,0] op_sel_hi:[1,1,0]
v_rcp_f16_sdwa v151, v150 dst_sel:WORD_1 dst_unused:UNUSED_PRESERVE src0_sel:WORD_1
v_cvt_pk_bf16_f32 v185, v34, v35
v_fma_mix_f32 v166, v138, v138, v166 op_sel:[0,0,0] op_sel_hi:[1,1,0]
v_rcp_f16_sdwa v148, v147 dst_sel:WORD_1 dst_unused:UNUSED_PRESERVE src0_sel:WORD_1
v_cvt_pk_bf16_f32 v186, v36, v37
ds_read_b128 v[216:219], v248 offset:18432
v_mfma_f32_32x32x16_bf16 v[120:135], v[116:119], v[220:223], v[120:135]
v_fma_mix_f32 v166, v139, v139, v166 op_sel:[1,1,0] op_sel_hi:[1,1,0]
v_pk_mul_f16 v155, v155, v154
s_waitcnt lgkmcnt(4)
v_fma_mix_f32 v166, v140, v140, v166 op_sel:[0,0,0] op_sel_hi:[1,1,0]
v_cvt_pk_bf16_f32 v187, v38, v39
v_pk_mul_f16 v152, v152, v151
v_fma_mix_f32 v166, v141, v141, v166 op_sel:[1,1,0] op_sel_hi:[1,1,0]
v_cvt_pk_bf16_f32 v188, v40, v41
v_pk_mul_f16 v149, v149, v148
v_fma_mix_f32 v166, v155, v155, v166 op_sel:[0,0,0] op_sel_hi:[1,1,0]
v_fma_mix_f32 v166, v142, v142, v166 op_sel:[0,0,0] op_sel_hi:[1,1,0]
v_cvt_pk_bf16_f32 v189, v42, v43
v_fma_mix_f32 v166, v155, v155, v166 op_sel:[1,1,0] op_sel_hi:[1,1,0]
v_fma_mix_f32 v166, v143, v143, v166 op_sel:[1,1,0] op_sel_hi:[1,1,0]
v_fma_mix_f32 v166, v152, v152, v166 op_sel:[0,0,0] op_sel_hi:[1,1,0]
v_cvt_pk_bf16_f32 v190, v44, v45
v_fma_mix_f32 v166, v152, v152, v166 op_sel:[1,1,0] op_sel_hi:[1,1,0]
s_waitcnt lgkmcnt(1)
v_fma_mix_f32 v166, v144, v144, v166 op_sel:[0,0,0] op_sel_hi:[1,1,0]
v_fma_mix_f32 v166, v149, v149, v166 op_sel:[0,0,0] op_sel_hi:[1,1,0]
v_cvt_pk_bf16_f32 v191, v46, v47
v_fma_mix_f32 v166, v145, v145, v166 op_sel:[1,1,0] op_sel_hi:[1,1,0]
v_fma_mix_f32 v166, v149, v149, v166 op_sel:[1,1,0] op_sel_hi:[1,1,0]
s_setprio 1
v_cvt_pkrtz_f16_f32 v137, v120, v121
v_cvt_pkrtz_f16_f32 v139, v122, v123
v_cvt_pkrtz_f16_f32 v141, v124, v125
v_cvt_pkrtz_f16_f32 v143, v126, v127
v_cvt_pkrtz_f16_f32 v145, v128, v129
v_cvt_pk_f16_f32 v155, v130, v131
v_cvt_pk_f16_f32 v152, v132, v133
v_cvt_pk_f16_f32 v149, v134, v135
s_add_u32 m0, s72, 4096
s_add_u32 s43, s82, 3136
buffer_load_dwordx4 v240, s[16:19], s43 offen lds
ds_read_b128 v[220:223], v248 offset:21504
v_mfma_f32_32x32x16_bf16 v[120:135], v[224:227], v[168:171], 0
v_pk_fma_f16 v154, v155, v155, s48
v_and_b32 v247, 1, v251
v_and_b32 v137, s49, v137
v_pk_fma_f16 v151, v152, v152, s48
v_and_b32 v139, s49, v139
v_lshlrev_b32 v247, 4, v247
v_pk_fma_f16 v148, v149, v149, s48
v_pk_mul_f16 v154, v155, v154
v_bfe_u32 v136, v137, 2, 14
v_mov_b32 v252, 15360
v_pk_mul_f16 v151, v152, v151
v_pk_mul_f16 v148, v149, v148
v_bfe_u32 v138, v139, 2, 14
ds_read_b128 v[224:227], v248 offset:22528
ds_read_u16_d16 v136, v136
ds_read_u16_d16 v138, v138
v_mfma_f32_32x32x16_bf16 v[120:135], v[228:231], v[172:175], v[120:135]
v_exp_f16 v153, v154
v_lshlrev_b32 v247, v247, v252
v_lshrrev_b32 v137, 18, v137
v_exp_f16 v150, v151
v_lshrrev_b32 v252, 3, v251
v_lshrrev_b32 v139, 18, v139
v_exp_f16 v147, v148
v_xor_b32 v252, v252, v251
v_and_b32 v141, s49, v141
v_and_b32 v143, s49, v143
ds_read_b128 v[228:231], v248 offset:25600
ds_read_u16_d16_hi v137, v137
ds_read_u16_d16_hi v139, v139
v_mfma_f32_32x32x16_bf16 v[120:135], v[232:235], v[176:179], v[120:135]
v_exp_f16_sdwa v153, v154 dst_sel:WORD_1 dst_unused:UNUSED_PRESERVE src0_sel:WORD_1
v_and_b32_e64 v252, 4, v252
v_bfe_u32 v140, v141, 2, 14
v_exp_f16_sdwa v150, v151 dst_sel:WORD_1 dst_unused:UNUSED_PRESERVE src0_sel:WORD_1
v_bfe_u32 v253, v251, 3, 2
v_bfe_u32 v142, v143, 2, 14
v_exp_f16_sdwa v147, v148 dst_sel:WORD_1 dst_unused:UNUSED_PRESERVE src0_sel:WORD_1
v_lshl_add_u32 v252, v252, 1, 0
v_lshrrev_b32_e64 v141, 18, v141
v_pk_add_f16 v153, v153, 1.0 op_sel_hi:[1,0]
v_lshrrev_b32_e64 v143, 18, v143
s_add_u32 m0, s72, 5120
s_add_u32 s43, s82, 3200
buffer_load_dwordx4 v240, s[16:19], s43 offen lds
ds_read_b128 v[232:235], v248 offset:23552
ds_read_u16_d16 v140, v140
ds_read_u16_d16 v142, v142
ds_read_u16_d16_hi v141, v141
ds_read_u16_d16_hi v143, v143
v_mfma_f32_32x32x16_bf16 v[120:135], v[236:239], v[180:183], v[120:135]
v_lshl_add_u32 v252, v253, 1, v252
v_pk_add_f16 v150, v150, 1.0 op_sel_hi:[1,0]
v_pk_add_f16 v147, v147, 1.0 op_sel_hi:[1,0]
v_and_b32_e64 v145, s49, v145
v_bfe_u32 v253, v251, 1, 1
v_rcp_f16_e64 v154, v153
v_bfe_u32 v144, v145, 2, 14
v_add_u32 v252, v252, v253
v_rcp_f16 v151, v150
v_lshrrev_b32 v145, 18, v145
v_rcp_f16 v148, v147
s_waitcnt lgkmcnt(5)
ds_read_b128 v[236:239], v248 offset:26624
ds_read_u16_d16 v144, v144
ds_read_u16_d16_hi v145, v145
v_mfma_f32_32x32x16_bf16 v[120:135], v[216:219], v[184:187], v[120:135]
v_cmp_eq_u32 vcc, 0, v252
s_nop 1
v_cndmask_b32 v208, 0, v247, vcc
v_rcp_f16_sdwa v154, v153 dst_sel:WORD_1 dst_unused:UNUSED_PRESERVE src0_sel:WORD_1
v_cmp_eq_u32 vcc, 1, v252
s_nop 1
v_cndmask_b32 v209, 0, v247, vcc
v_fma_mix_f32 v167, v136, v136, v167 op_sel:[0,0,0] op_sel_hi:[1,1,0]
v_fma_mix_f32 v167, v137, v137, v167 op_sel:[1,1,0] op_sel_hi:[1,1,0]
v_rcp_f16_sdwa v151, v150 dst_sel:WORD_1 dst_unused:UNUSED_PRESERVE src0_sel:WORD_1
v_cmp_eq_u32 vcc, 2, v252
s_nop 1
v_cndmask_b32 v210, 0, v247, vcc
v_fma_mix_f32 v167, v138, v138, v167 op_sel:[0,0,0] op_sel_hi:[1,1,0]
v_rcp_f16_sdwa v148, v147 dst_sel:WORD_1 dst_unused:UNUSED_PRESERVE src0_sel:WORD_1
v_cmp_eq_u32 vcc, 3, v252
s_nop 1
v_cndmask_b32 v211, 0, v247, vcc
ds_read_b128 v[216:219], v248 offset:24576
v_mfma_f32_32x32x16_bf16 v[120:135], v[220:223], v[188:191], v[120:135]
v_fma_mix_f32 v167, v139, v139, v167 op_sel:[1,1,0] op_sel_hi:[1,1,0]
v_pk_mul_f16 v155, v155, v154
s_waitcnt lgkmcnt(1)
v_fma_mix_f32 v167, v140, v140, v167 op_sel:[0,0,0] op_sel_hi:[1,1,0]
v_cmp_eq_u32 vcc, 4, v252
s_nop 1
v_cndmask_b32 v212, 0, v247, vcc
v_pk_mul_f16 v152, v152, v151
v_fma_mix_f32 v167, v141, v141, v167 op_sel:[1,1,0] op_sel_hi:[1,1,0]
v_pk_mul_f16 v149, v149, v148
v_cmp_eq_u32 vcc, 5, v252
s_nop 1
v_cndmask_b32 v213, 0, v247, vcc
v_fma_mix_f32 v167, v155, v155, v167 op_sel:[0,0,0] op_sel_hi:[1,1,0]
v_fma_mix_f32 v167, v142, v142, v167 op_sel:[0,0,0] op_sel_hi:[1,1,0]
v_fma_mix_f32 v167, v155, v155, v167 op_sel:[1,1,0] op_sel_hi:[1,1,0]
v_fma_mix_f32 v167, v143, v143, v167 op_sel:[1,1,0] op_sel_hi:[1,1,0]
v_cmp_eq_u32 vcc, 6, v252
s_nop 1
v_cndmask_b32 v214, 0, v247, vcc
v_fma_mix_f32 v167, v152, v152, v167 op_sel:[0,0,0] op_sel_hi:[1,1,0]
v_fma_mix_f32 v167, v152, v152, v167 op_sel:[1,1,0] op_sel_hi:[1,1,0]
v_fma_mix_f32 v167, v144, v144, v167 op_sel:[0,0,0] op_sel_hi:[1,1,0]
v_cmp_eq_u32 vcc, 7, v252
s_nop 1
v_cndmask_b32 v215, 0, v247, vcc
v_fma_mix_f32 v167, v149, v149, v167 op_sel:[0,0,0] op_sel_hi:[1,1,0]
v_fma_mix_f32 v167, v145, v145, v167 op_sel:[1,1,0] op_sel_hi:[1,1,0]
v_fma_mix_f32 v167, v149, v149, v167 op_sel:[1,1,0] op_sel_hi:[1,1,0]
v_cvt_pkrtz_f16_f32 v137, v120, v121
v_cvt_pkrtz_f16_f32 v139, v122, v123
v_cvt_pkrtz_f16_f32 v141, v124, v125
v_cvt_pkrtz_f16_f32 v143, v126, v127
v_cvt_pkrtz_f16_f32 v145, v128, v129
v_cvt_pk_f16_f32 v155, v130, v131
v_cvt_pk_f16_f32 v152, v132, v133
v_cvt_pk_f16_f32 v149, v134, v135
s_add_u32 m0, s72, 6144
s_add_u32 s43, s82, 6144
buffer_load_dwordx4 v240, s[16:19], s43 offen lds
ds_read_b128 v[220:223], v248 offset:27648
v_mfma_f32_32x32x16_bf16 v[120:135], v[224:227], v[168:171], 0
v_pk_fma_f16 v154, v155, v155, s48
v_and_b32_e64 v137, s49, v137
v_pk_fma_f16 v151, v152, v152, s48
v_and_b32_e64 v139, s49, v139
v_pk_fma_f16 v148, v149, v149, s48
v_pk_mul_f16 v154, v155, v154
v_bfe_u32 v136, v137, 2, 14
v_pk_mul_f16 v151, v152, v151
ds_read_b128 v[224:227], v248 offset:28672
ds_read_u16_d16 v136, v136
v_mfma_f32_32x32x16_bf16 v[120:135], v[228:231], v[172:175], v[120:135]
v_pk_mul_f16 v148, v149, v148
v_bfe_u32 v138, v139, 2, 14
v_exp_f16 v153, v154
v_lshrrev_b32 v137, 18, v137
v_exp_f16 v150, v151
v_lshrrev_b32 v139, 18, v139
ds_read_b128 v[228:231], v248 offset:31744
ds_read_u16_d16 v138, v138
ds_read_u16_d16_hi v137, v137
ds_read_u16_d16_hi v139, v139
v_mfma_f32_32x32x16_bf16 v[120:135], v[232:235], v[176:179], v[120:135]
v_exp_f16 v147, v148
s_setprio 0
v_and_b32 v141, s49, v141
v_and_b32 v143, s49, v143
v_exp_f16_sdwa v153, v154 dst_sel:WORD_1 dst_unused:UNUSED_PRESERVE src0_sel:WORD_1
v_bfe_u32 v140, v141, 2, 14
v_exp_f16_sdwa v150, v151 dst_sel:WORD_1 dst_unused:UNUSED_PRESERVE src0_sel:WORD_1
ds_read_b128 v[232:235], v248 offset:29696
ds_read_u16_d16 v140, v140
v_mfma_f32_32x32x16_bf16 v[120:135], v[236:239], v[180:183], v[120:135]
v_bfe_u32 v142, v143, 2, 14
v_exp_f16_sdwa v147, v148 dst_sel:WORD_1 dst_unused:UNUSED_PRESERVE src0_sel:WORD_1
v_lshrrev_b32_e64 v141, 18, v141
v_pk_add_f16 v153, v153, 1.0 op_sel_hi:[1,0]
v_lshrrev_b32 v143, 18, v143
v_pk_add_f16 v150, v150, 1.0 op_sel_hi:[1,0]
v_pk_add_f16 v147, v147, 1.0 op_sel_hi:[1,0]
s_waitcnt lgkmcnt(6)
ds_read_b128 v[236:239], v248 offset:32768
ds_read_u16_d16 v142, v142
ds_read_u16_d16_hi v141, v141
ds_read_u16_d16_hi v143, v143
v_mfma_f32_32x32x16_bf16 v[120:135], v[216:219], v[184:187], v[120:135]
v_and_b32 v145, s49, v145
v_rcp_f16 v154, v153
v_bfe_u32 v144, v145, 2, 14
v_rcp_f16 v151, v150
v_lshrrev_b32 v145, 18, v145
ds_read_b128 v[216:219], v248 offset:30720
ds_read_u16_d16 v144, v144
ds_read_u16_d16_hi v145, v145
v_mfma_f32_32x32x16_bf16 v[120:135], v[220:223], v[188:191], v[120:135]
v_rcp_f16 v148, v147
s_waitcnt lgkmcnt(7)
v_or_b32 v0, v136, v137
v_or_b32 v1, v138, v139
v_rcp_f16_sdwa v154, v153 dst_sel:WORD_1 dst_unused:UNUSED_PRESERVE src0_sel:WORD_1
s_waitcnt lgkmcnt(4)
v_or_b32 v2, v140, v141
v_rcp_f16_sdwa v151, v150 dst_sel:WORD_1 dst_unused:UNUSED_PRESERVE src0_sel:WORD_1
s_waitcnt lgkmcnt(3)
v_or_b32 v3, v142, v143
v_rcp_f16_sdwa v148, v147 dst_sel:WORD_1 dst_unused:UNUSED_PRESERVE src0_sel:WORD_1
s_waitcnt lgkmcnt(0)
v_or_b32_e64 v4, v144, v145
v_pk_mul_f16 v5, v155, v154
v_pk_mul_f16 v6, v152, v151
v_pk_mul_f16 v7, v149, v148
s_setprio 2
ds_read_b128 v[220:223], v248 offset:33792
v_mfma_f32_32x32x16_f16 v[192:207], v[0:3], v[208:211], 0
v_cvt_pkrtz_f16_f32 v137, v120, v121
v_cvt_pkrtz_f16_f32 v139, v122, v123
v_cvt_pkrtz_f16_f32 v141, v124, v125
v_cvt_pkrtz_f16_f32 v143, v126, v127
v_cvt_pkrtz_f16_f32 v145, v128, v129
v_mfma_f32_32x32x16_f16 v[192:207], v[4:7], v[212:215], v[192:207]
v_cvt_pk_f16_f32 v155, v130, v131
v_cvt_pk_f16_f32 v152, v132, v133
v_cvt_pk_f16_f32 v149, v134, v135
v_pk_fma_f16 v154, v155, v155, s48
v_and_b32_e64 v137, s49, v137
v_pk_fma_f16 v151, v152, v152, s48
v_mfma_f32_32x32x16_bf16 v[120:135], v[224:227], v[168:171], 0
v_and_b32 v139, s49, v139
v_pk_fma_f16 v148, v149, v149, s48
v_permlane16_swap_b32 v0, v4
v_pk_mul_f16 v154, v155, v154
v_bfe_u32 v136, v137, 2, 14
v_permlane16_swap_b32 v1, v5
v_pk_mul_f16 v151, v152, v151
v_pk_mul_f16 v148, v149, v148
v_bfe_u32 v138, v139, 2, 14
v_permlane16_swap_b32 v2, v6
ds_read_b128 v[224:227], v248 offset:34816
ds_read_u16_d16 v136, v136
ds_read_u16_d16 v138, v138
v_mfma_f32_32x32x16_bf16 v[120:135], v[228:231], v[172:175], v[120:135]
v_exp_f16 v153, v154
v_permlane16_swap_b32 v3, v7
v_lshrrev_b32 v137, 18, v137
v_exp_f16 v150, v151
v_fmac_f32 v156, v192, v192
v_lshrrev_b32 v139, 18, v139
v_exp_f16 v147, v148
v_fmac_f32 v156, v193, v193
v_and_b32_e64 v141, s49, v141
ds_read_b128 v[228:231], v248 offset:37888
ds_read_u16_d16_hi v137, v137
ds_read_u16_d16_hi v139, v139
v_mfma_f32_32x32x16_bf16 v[120:135], v[232:235], v[176:179], v[120:135]
v_and_b32 v143, s49, v143
v_fmac_f32 v156, v194, v194
v_exp_f16_sdwa v153, v154 dst_sel:WORD_1 dst_unused:UNUSED_PRESERVE src0_sel:WORD_1
v_bfe_u32 v140, v141, 2, 14
v_fmac_f32_e64 v156, v195, v195
v_exp_f16_sdwa v150, v151 dst_sel:WORD_1 dst_unused:UNUSED_PRESERVE src0_sel:WORD_1
v_fmac_f32_e64 v156, v196, v196
v_bfe_u32 v142, v143, 2, 14
ds_read_b128 v[232:235], v248 offset:35840
ds_read_u16_d16 v140, v140
ds_read_u16_d16 v142, v142
v_mfma_f32_32x32x16_bf16 v[120:135], v[236:239], v[180:183], v[120:135]
v_exp_f16_sdwa v147, v148 dst_sel:WORD_1 dst_unused:UNUSED_PRESERVE src0_sel:WORD_1
v_fmac_f32 v156, v197, v197
v_lshrrev_b32 v141, 18, v141
v_pk_add_f16 v153, v153, 1.0 op_sel_hi:[1,0]
v_lshrrev_b32 v143, 18, v143
v_fmac_f32 v156, v198, v198
v_pk_add_f16 v150, v150, 1.0 op_sel_hi:[1,0]
v_pk_add_f16 v147, v147, 1.0 op_sel_hi:[1,0]
v_fmac_f32 v156, v199, v199
v_and_b32 v145, s49, v145
ds_read_b128 v[236:239], v248 offset:38912
ds_read_u16_d16_hi v141, v141
ds_read_u16_d16_hi v143, v143
v_mfma_f32_32x32x16_bf16 v[120:135], v[216:219], v[184:187], v[120:135]
v_rcp_f16 v154, v153
v_fmac_f32 v156, v200, v200
v_bfe_u32 v144, v145, 2, 14
v_rcp_f16 v151, v150
v_fmac_f32 v156, v201, v201
v_lshrrev_b32 v145, 18, v145
v_rcp_f16 v148, v147
v_fmac_f32_e64 v156, v202, v202
ds_read_u16_d16 v144, v144
ds_read_u16_d16_hi v145, v145
s_waitcnt lgkmcnt(5)
v_or_b32 v8, v136, v137
ds_read_b128 v[216:219], v248 offset:36864
v_mfma_f32_32x32x16_bf16 v[120:135], v[220:223], v[188:191], v[120:135]
v_or_b32 v9, v138, v139
v_fmac_f32 v156, v203, v203
v_rcp_f16_sdwa v154, v153 dst_sel:WORD_1 dst_unused:UNUSED_PRESERVE src0_sel:WORD_1
v_fmac_f32 v156, v204, v204
s_waitcnt lgkmcnt(4)
v_or_b32_e64 v10, v140, v141
v_rcp_f16_sdwa v151, v150 dst_sel:WORD_1 dst_unused:UNUSED_PRESERVE src0_sel:WORD_1
v_fmac_f32 v156, v205, v205
s_waitcnt lgkmcnt(3)
v_or_b32_e64 v11, v142, v143
v_rcp_f16_sdwa v148, v147 dst_sel:WORD_1 dst_unused:UNUSED_PRESERVE src0_sel:WORD_1
v_fmac_f32 v156, v206, v206
s_waitcnt lgkmcnt(1)
v_or_b32_e64 v12, v144, v145
v_pk_mul_f16 v13, v155, v154
v_fmac_f32_e64 v156, v207, v207
v_pk_mul_f16 v14, v152, v151
v_pk_mul_f16 v15, v149, v148
ds_read_b128 v[220:223], v248 offset:39936
v_mfma_f32_32x32x16_f16 v[192:207], v[8:11], v[208:211], 0
v_cvt_pkrtz_f16_f32 v137, v120, v121
v_cvt_pkrtz_f16_f32 v139, v122, v123
v_cvt_pkrtz_f16_f32 v141, v124, v125
v_cvt_pkrtz_f16_f32 v143, v126, v127
v_cvt_pkrtz_f16_f32 v145, v128, v129
v_mfma_f32_32x32x16_f16 v[192:207], v[12:15], v[212:215], v[192:207]
v_cvt_pk_f16_f32 v155, v130, v131
v_cvt_pk_f16_f32 v152, v132, v133
v_cvt_pk_f16_f32 v149, v134, v135
v_pk_fma_f16 v154, v155, v155, s48
v_and_b32_e64 v137, s49, v137
v_pk_fma_f16 v151, v152, v152, s48
v_mfma_f32_32x32x16_bf16 v[120:135], v[224:227], v[168:171], 0
v_and_b32 v139, s49, v139
v_pk_fma_f16 v148, v149, v149, s48
v_permlane16_swap_b32 v8, v12
v_pk_mul_f16 v154, v155, v154
v_bfe_u32 v136, v137, 2, 14
v_permlane16_swap_b32 v9, v13
v_pk_mul_f16 v151, v152, v151
v_pk_mul_f16 v148, v149, v148
v_bfe_u32 v138, v139, 2, 14
v_permlane16_swap_b32 v10, v14
ds_read_b128 v[224:227], v248 offset:40960
ds_read_u16_d16 v136, v136
ds_read_u16_d16 v138, v138
v_mfma_f32_32x32x16_bf16 v[120:135], v[228:231], v[172:175], v[120:135]
v_exp_f16 v153, v154
v_permlane16_swap_b32 v11, v15
v_lshrrev_b32 v137, 18, v137
v_exp_f16 v150, v151
v_fmac_f32 v157, v192, v192
v_lshrrev_b32 v139, 18, v139
v_exp_f16 v147, v148
v_fmac_f32 v157, v193, v193
v_and_b32_e64 v141, s49, v141
ds_read_b128 v[228:231], v248 offset:44032
ds_read_u16_d16_hi v137, v137
ds_read_u16_d16_hi v139, v139
v_mfma_f32_32x32x16_bf16 v[120:135], v[232:235], v[176:179], v[120:135]
v_and_b32 v143, s49, v143
v_fmac_f32 v157, v194, v194
v_exp_f16_sdwa v153, v154 dst_sel:WORD_1 dst_unused:UNUSED_PRESERVE src0_sel:WORD_1
v_bfe_u32 v140, v141, 2, 14
v_fmac_f32_e64 v157, v195, v195
v_exp_f16_sdwa v150, v151 dst_sel:WORD_1 dst_unused:UNUSED_PRESERVE src0_sel:WORD_1
v_fmac_f32_e64 v157, v196, v196
v_bfe_u32 v142, v143, 2, 14
ds_read_b128 v[232:235], v248 offset:41984
ds_read_u16_d16 v140, v140
ds_read_u16_d16 v142, v142
v_mfma_f32_32x32x16_bf16 v[120:135], v[236:239], v[180:183], v[120:135]
v_exp_f16_sdwa v147, v148 dst_sel:WORD_1 dst_unused:UNUSED_PRESERVE src0_sel:WORD_1
v_fmac_f32 v157, v197, v197
v_lshrrev_b32 v141, 18, v141
v_pk_add_f16 v153, v153, 1.0 op_sel_hi:[1,0]
v_lshrrev_b32 v143, 18, v143
v_fmac_f32 v157, v198, v198
v_pk_add_f16 v150, v150, 1.0 op_sel_hi:[1,0]
v_pk_add_f16 v147, v147, 1.0 op_sel_hi:[1,0]
v_fmac_f32_e64 v157, v199, v199
v_and_b32 v145, s49, v145
s_waitcnt lgkmcnt(4)
ds_read_b128 v[236:239], v248 offset:45056
ds_read_u16_d16_hi v141, v141
ds_read_u16_d16_hi v143, v143
v_mfma_f32_32x32x16_bf16 v[120:135], v[216:219], v[184:187], v[120:135]
v_rcp_f16 v154, v153
v_fmac_f32 v157, v200, v200
v_bfe_u32 v144, v145, 2, 14
v_rcp_f16 v151, v150
v_fmac_f32 v157, v201, v201
v_lshrrev_b32 v145, 18, v145
v_rcp_f16 v148, v147
v_fmac_f32_e64 v157, v202, v202
ds_read_u16_d16 v144, v144
ds_read_u16_d16_hi v145, v145
v_or_b32_e64 v16, v136, v137
ds_read_b128 v[216:219], v248 offset:43008
v_mfma_f32_32x32x16_bf16 v[120:135], v[220:223], v[188:191], v[120:135]
s_waitcnt lgkmcnt(6)
v_or_b32 v17, v138, v139
v_fmac_f32_e64 v157, v203, v203
v_rcp_f16_sdwa v154, v153 dst_sel:WORD_1 dst_unused:UNUSED_PRESERVE src0_sel:WORD_1
v_fmac_f32 v157, v204, v204
s_waitcnt lgkmcnt(4)
v_or_b32_e64 v18, v140, v141
v_rcp_f16_sdwa v151, v150 dst_sel:WORD_1 dst_unused:UNUSED_PRESERVE src0_sel:WORD_1
v_fmac_f32 v157, v205, v205
s_waitcnt lgkmcnt(3)
v_or_b32_e64 v19, v142, v143
v_rcp_f16_sdwa v148, v147 dst_sel:WORD_1 dst_unused:UNUSED_PRESERVE src0_sel:WORD_1
v_fmac_f32 v157, v206, v206
s_waitcnt lgkmcnt(1)
v_or_b32_e64 v20, v144, v145
v_pk_mul_f16 v21, v155, v154
v_fmac_f32 v157, v207, v207
v_pk_mul_f16 v22, v152, v151
v_pk_mul_f16 v23, v149, v148
s_setprio 1
ds_read_b128 v[220:223], v248 offset:46080
v_mfma_f32_32x32x16_f16 v[192:207], v[16:19], v[208:211], 0
v_cvt_pkrtz_f16_f32 v137, v120, v121
v_cvt_pkrtz_f16_f32 v139, v122, v123
v_cvt_pkrtz_f16_f32 v141, v124, v125
v_cvt_pkrtz_f16_f32 v143, v126, v127
v_cvt_pkrtz_f16_f32 v145, v128, v129
v_mfma_f32_32x32x16_f16 v[192:207], v[20:23], v[212:215], v[192:207]
v_cvt_pk_f16_f32 v155, v130, v131
v_cvt_pk_f16_f32 v152, v132, v133
v_cvt_pk_f16_f32 v149, v134, v135
v_pk_fma_f16 v154, v155, v155, s48
v_and_b32_e64 v137, s49, v137
v_pk_fma_f16 v151, v152, v152, s48
v_mfma_f32_32x32x16_bf16 v[120:135], v[224:227], v[168:171], 0
v_and_b32 v139, s49, v139
v_pk_fma_f16 v148, v149, v149, s48
v_permlane16_swap_b32 v16, v20
v_pk_mul_f16 v154, v155, v154
v_bfe_u32 v136, v137, 2, 14
v_permlane16_swap_b32 v17, v21
v_pk_mul_f16 v151, v152, v151
v_pk_mul_f16 v148, v149, v148
v_bfe_u32 v138, v139, 2, 14
v_permlane16_swap_b32 v18, v22
ds_read_b128 v[224:227], v248 offset:47104
ds_read_u16_d16 v136, v136
ds_read_u16_d16 v138, v138
v_mfma_f32_32x32x16_bf16 v[120:135], v[228:231], v[172:175], v[120:135]
v_exp_f16 v153, v154
v_permlane16_swap_b32 v19, v23
v_lshrrev_b32 v137, 18, v137
v_exp_f16 v150, v151
v_fmac_f32 v158, v192, v192
v_lshrrev_b32 v139, 18, v139
v_exp_f16 v147, v148
v_fmac_f32 v158, v193, v193
v_and_b32_e64 v141, s49, v141
ds_read_b128 v[228:231], v248 offset:50176
ds_read_u16_d16_hi v137, v137
ds_read_u16_d16_hi v139, v139
v_mfma_f32_32x32x16_bf16 v[120:135], v[232:235], v[176:179], v[120:135]
v_and_b32 v143, s49, v143
v_fmac_f32 v158, v194, v194
v_exp_f16_sdwa v153, v154 dst_sel:WORD_1 dst_unused:UNUSED_PRESERVE src0_sel:WORD_1
v_bfe_u32 v140, v141, 2, 14
v_fmac_f32_e64 v158, v195, v195
v_exp_f16_sdwa v150, v151 dst_sel:WORD_1 dst_unused:UNUSED_PRESERVE src0_sel:WORD_1
v_fmac_f32_e64 v158, v196, v196
v_bfe_u32 v142, v143, 2, 14
ds_read_b128 v[232:235], v248 offset:48128
ds_read_u16_d16 v140, v140
ds_read_u16_d16 v142, v142
v_mfma_f32_32x32x16_bf16 v[120:135], v[236:239], v[180:183], v[120:135]
v_exp_f16_sdwa v147, v148 dst_sel:WORD_1 dst_unused:UNUSED_PRESERVE src0_sel:WORD_1
v_fmac_f32 v158, v197, v197
v_lshrrev_b32 v141, 18, v141
v_pk_add_f16 v153, v153, 1.0 op_sel_hi:[1,0]
v_lshrrev_b32 v143, 18, v143
v_fmac_f32 v158, v198, v198
v_pk_add_f16 v150, v150, 1.0 op_sel_hi:[1,0]
v_pk_add_f16 v147, v147, 1.0 op_sel_hi:[1,0]
v_fmac_f32_e64 v158, v199, v199
v_and_b32 v145, s49, v145
s_waitcnt lgkmcnt(4)
ds_read_b128 v[236:239], v248 offset:51200
ds_read_u16_d16_hi v141, v141
ds_read_u16_d16_hi v143, v143
v_mfma_f32_32x32x16_bf16 v[120:135], v[216:219], v[184:187], v[120:135]
v_rcp_f16 v154, v153
v_fmac_f32 v158, v200, v200
v_bfe_u32 v144, v145, 2, 14
v_rcp_f16 v151, v150
v_fmac_f32 v158, v201, v201
v_lshrrev_b32 v145, 18, v145
v_rcp_f16 v148, v147
v_fmac_f32_e64 v158, v202, v202
ds_read_u16_d16 v144, v144
ds_read_u16_d16_hi v145, v145
v_or_b32_e64 v24, v136, v137
ds_read_b128 v[216:219], v248 offset:49152
v_mfma_f32_32x32x16_bf16 v[120:135], v[220:223], v[188:191], v[120:135]
s_waitcnt lgkmcnt(6)
v_or_b32 v25, v138, v139
v_fmac_f32_e64 v158, v203, v203
v_rcp_f16_sdwa v154, v153 dst_sel:WORD_1 dst_unused:UNUSED_PRESERVE src0_sel:WORD_1
v_fmac_f32 v158, v204, v204
s_waitcnt lgkmcnt(4)
v_or_b32_e64 v26, v140, v141
v_rcp_f16_sdwa v151, v150 dst_sel:WORD_1 dst_unused:UNUSED_PRESERVE src0_sel:WORD_1
v_fmac_f32 v158, v205, v205
s_waitcnt lgkmcnt(3)
v_or_b32_e64 v27, v142, v143
v_rcp_f16_sdwa v148, v147 dst_sel:WORD_1 dst_unused:UNUSED_PRESERVE src0_sel:WORD_1
v_fmac_f32 v158, v206, v206
s_waitcnt lgkmcnt(1)
v_or_b32_e64 v28, v144, v145
v_pk_mul_f16 v29, v155, v154
v_fmac_f32_e64 v158, v207, v207
v_pk_mul_f16 v30, v152, v151
v_pk_mul_f16 v31, v149, v148
ds_read_b128 v[220:223], v248 offset:52224
v_mfma_f32_32x32x16_f16 v[192:207], v[24:27], v[208:211], 0
v_cvt_pkrtz_f16_f32 v137, v120, v121
v_cvt_pkrtz_f16_f32 v139, v122, v123
v_cvt_pkrtz_f16_f32 v141, v124, v125
v_cvt_pkrtz_f16_f32 v143, v126, v127
v_cvt_pkrtz_f16_f32 v145, v128, v129
v_mfma_f32_32x32x16_f16 v[192:207], v[28:31], v[212:215], v[192:207]
v_cvt_pk_f16_f32 v155, v130, v131
v_cvt_pk_f16_f32 v152, v132, v133
v_cvt_pk_f16_f32 v149, v134, v135
v_pk_fma_f16 v154, v155, v155, s48
v_and_b32_e64 v137, s49, v137
v_pk_fma_f16 v151, v152, v152, s48
v_mfma_f32_32x32x16_bf16 v[120:135], v[224:227], v[168:171], 0
v_and_b32 v139, s49, v139
v_pk_fma_f16 v148, v149, v149, s48
v_permlane16_swap_b32 v24, v28
v_pk_mul_f16 v154, v155, v154
v_bfe_u32 v136, v137, 2, 14
v_permlane16_swap_b32 v25, v29
v_pk_mul_f16 v151, v152, v151
v_pk_mul_f16 v148, v149, v148
v_bfe_u32 v138, v139, 2, 14
v_permlane16_swap_b32 v26, v30
ds_read_b128 v[224:227], v248 offset:53248
ds_read_u16_d16 v136, v136
ds_read_u16_d16 v138, v138
v_mfma_f32_32x32x16_bf16 v[120:135], v[228:231], v[172:175], v[120:135]
v_exp_f16 v153, v154
v_permlane16_swap_b32 v27, v31
v_lshrrev_b32 v137, 18, v137
v_exp_f16 v150, v151
v_fmac_f32 v159, v192, v192
v_lshrrev_b32 v139, 18, v139
v_exp_f16 v147, v148
v_fmac_f32 v159, v193, v193
v_and_b32_e64 v141, s49, v141
ds_read_b128 v[228:231], v248 offset:56320
ds_read_u16_d16_hi v137, v137
ds_read_u16_d16_hi v139, v139
v_mfma_f32_32x32x16_bf16 v[120:135], v[232:235], v[176:179], v[120:135]
v_and_b32 v143, s49, v143
s_setprio 0
v_fmac_f32_e64 v159, v194, v194
v_exp_f16_sdwa v153, v154 dst_sel:WORD_1 dst_unused:UNUSED_PRESERVE src0_sel:WORD_1
v_bfe_u32 v140, v141, 2, 14
v_fmac_f32_e64 v159, v195, v195
v_exp_f16_sdwa v150, v151 dst_sel:WORD_1 dst_unused:UNUSED_PRESERVE src0_sel:WORD_1
v_fmac_f32_e64 v159, v196, v196
v_bfe_u32 v142, v143, 2, 14
ds_read_b128 v[232:235], v248 offset:54272
ds_read_u16_d16 v140, v140
ds_read_u16_d16 v142, v142
v_mfma_f32_32x32x16_bf16 v[120:135], v[236:239], v[180:183], v[120:135]
v_exp_f16_sdwa v147, v148 dst_sel:WORD_1 dst_unused:UNUSED_PRESERVE src0_sel:WORD_1
v_fmac_f32 v159, v197, v197
v_lshrrev_b32 v141, 18, v141
v_pk_add_f16 v153, v153, 1.0 op_sel_hi:[1,0]
v_lshrrev_b32 v143, 18, v143
v_fmac_f32 v159, v198, v198
v_pk_add_f16 v150, v150, 1.0 op_sel_hi:[1,0]
v_pk_add_f16 v147, v147, 1.0 op_sel_hi:[1,0]
v_fmac_f32_e64 v159, v199, v199
v_and_b32 v145, s49, v145
s_waitcnt lgkmcnt(3)
ds_read_b128 v[236:239], v248 offset:57344
ds_read_u16_d16_hi v141, v141
ds_read_u16_d16_hi v143, v143
v_mfma_f32_32x32x16_bf16 v[120:135], v[216:219], v[184:187], v[120:135]
v_rcp_f16 v154, v153
v_fmac_f32 v159, v200, v200
v_bfe_u32 v144, v145, 2, 14
v_rcp_f16 v151, v150
v_fmac_f32 v159, v201, v201
v_lshrrev_b32 v145, 18, v145
v_rcp_f16 v148, v147
v_fmac_f32_e64 v159, v202, v202
ds_read_u16_d16 v144, v144
ds_read_u16_d16_hi v145, v145
v_or_b32_e64 v32, v136, v137
ds_read_b128 v[216:219], v248 offset:55296
v_mfma_f32_32x32x16_bf16 v[120:135], v[220:223], v[188:191], v[120:135]
v_or_b32 v33, v138, v139
v_fmac_f32 v159, v203, v203
v_rcp_f16_sdwa v154, v153 dst_sel:WORD_1 dst_unused:UNUSED_PRESERVE src0_sel:WORD_1
v_fmac_f32 v159, v204, v204
s_waitcnt lgkmcnt(4)
v_or_b32_e64 v34, v140, v141
v_rcp_f16_sdwa v151, v150 dst_sel:WORD_1 dst_unused:UNUSED_PRESERVE src0_sel:WORD_1
v_fmac_f32 v159, v205, v205
s_waitcnt lgkmcnt(3)
v_or_b32_e64 v35, v142, v143
v_rcp_f16_sdwa v148, v147 dst_sel:WORD_1 dst_unused:UNUSED_PRESERVE src0_sel:WORD_1
v_fmac_f32 v159, v206, v206
s_waitcnt lgkmcnt(1)
v_or_b32_e64 v36, v144, v145
v_pk_mul_f16 v37, v155, v154
v_fmac_f32 v159, v207, v207
v_pk_mul_f16 v38, v152, v151
v_pk_mul_f16 v39, v149, v148
s_setprio 2
ds_read_b128 v[220:223], v248 offset:58368
v_mfma_f32_32x32x16_f16 v[192:207], v[32:35], v[208:211], 0
v_cvt_pkrtz_f16_f32 v137, v120, v121
v_cvt_pkrtz_f16_f32 v139, v122, v123
v_cvt_pkrtz_f16_f32 v141, v124, v125
v_cvt_pkrtz_f16_f32 v143, v126, v127
v_cvt_pkrtz_f16_f32 v145, v128, v129
v_mfma_f32_32x32x16_f16 v[192:207], v[36:39], v[212:215], v[192:207]
v_cvt_pk_f16_f32 v155, v130, v131
v_cvt_pk_f16_f32 v152, v132, v133
v_cvt_pk_f16_f32 v149, v134, v135
v_pk_fma_f16 v154, v155, v155, s48
v_and_b32_e64 v137, s49, v137
v_pk_fma_f16 v151, v152, v152, s48
v_mfma_f32_32x32x16_bf16 v[120:135], v[224:227], v[168:171], 0
v_and_b32 v139, s49, v139
v_pk_fma_f16 v148, v149, v149, s48
v_permlane16_swap_b32 v32, v36
v_pk_mul_f16 v154, v155, v154
v_bfe_u32 v136, v137, 2, 14
v_permlane16_swap_b32 v33, v37
v_pk_mul_f16 v151, v152, v151
v_pk_mul_f16 v148, v149, v148
v_bfe_u32 v138, v139, 2, 14
v_permlane16_swap_b32 v34, v38
ds_read_b128 v[224:227], v248 offset:59392
ds_read_u16_d16 v136, v136
ds_read_u16_d16 v138, v138
v_mfma_f32_32x32x16_bf16 v[120:135], v[228:231], v[172:175], v[120:135]
v_exp_f16 v153, v154
v_permlane16_swap_b32 v35, v39
v_lshrrev_b32 v137, 18, v137
v_exp_f16 v150, v151
v_fmac_f32 v160, v192, v192
v_lshrrev_b32 v139, 18, v139
v_exp_f16 v147, v148
v_fmac_f32 v160, v193, v193
v_and_b32_e64 v141, s49, v141
ds_read_b128 v[228:231], v248 offset:62464
ds_read_u16_d16_hi v137, v137
ds_read_u16_d16_hi v139, v139
v_mfma_f32_32x32x16_bf16 v[120:135], v[232:235], v[176:179], v[120:135]
v_and_b32 v143, s49, v143
v_fmac_f32 v160, v194, v194
v_exp_f16_sdwa v153, v154 dst_sel:WORD_1 dst_unused:UNUSED_PRESERVE src0_sel:WORD_1
v_bfe_u32 v140, v141, 2, 14
v_fmac_f32_e64 v160, v195, v195
v_exp_f16_sdwa v150, v151 dst_sel:WORD_1 dst_unused:UNUSED_PRESERVE src0_sel:WORD_1
v_fmac_f32_e64 v160, v196, v196
v_bfe_u32 v142, v143, 2, 14
ds_read_b128 v[232:235], v248 offset:60416
ds_read_u16_d16 v140, v140
ds_read_u16_d16 v142, v142
v_mfma_f32_32x32x16_bf16 v[120:135], v[236:239], v[180:183], v[120:135]
v_exp_f16_sdwa v147, v148 dst_sel:WORD_1 dst_unused:UNUSED_PRESERVE src0_sel:WORD_1
v_fmac_f32 v160, v197, v197
v_lshrrev_b32 v141, 18, v141
v_pk_add_f16 v153, v153, 1.0 op_sel_hi:[1,0]
v_lshrrev_b32 v143, 18, v143
v_fmac_f32 v160, v198, v198
v_pk_add_f16 v150, v150, 1.0 op_sel_hi:[1,0]
v_pk_add_f16 v147, v147, 1.0 op_sel_hi:[1,0]
v_fmac_f32_e64 v160, v199, v199
v_and_b32 v145, s49, v145
s_waitcnt lgkmcnt(4)
ds_read_b128 v[236:239], v248 offset:63488
ds_read_u16_d16_hi v141, v141
ds_read_u16_d16_hi v143, v143
v_mfma_f32_32x32x16_bf16 v[120:135], v[216:219], v[184:187], v[120:135]
v_rcp_f16 v154, v153
v_fmac_f32 v160, v200, v200
v_bfe_u32 v144, v145, 2, 14
v_rcp_f16 v151, v150
v_fmac_f32 v160, v201, v201
v_lshrrev_b32 v145, 18, v145
v_rcp_f16 v148, v147
v_fmac_f32_e64 v160, v202, v202
ds_read_u16_d16 v144, v144
ds_read_u16_d16_hi v145, v145
v_or_b32_e64 v40, v136, v137
ds_read_b128 v[216:219], v248 offset:61440
v_mfma_f32_32x32x16_bf16 v[120:135], v[220:223], v[188:191], v[120:135]
s_waitcnt lgkmcnt(6)
v_or_b32 v41, v138, v139
v_fmac_f32_e64 v160, v203, v203
v_rcp_f16_sdwa v154, v153 dst_sel:WORD_1 dst_unused:UNUSED_PRESERVE src0_sel:WORD_1
v_fmac_f32 v160, v204, v204
s_waitcnt lgkmcnt(4)
v_or_b32_e64 v42, v140, v141
v_rcp_f16_sdwa v151, v150 dst_sel:WORD_1 dst_unused:UNUSED_PRESERVE src0_sel:WORD_1
v_fmac_f32 v160, v205, v205
s_waitcnt lgkmcnt(3)
v_or_b32_e64 v43, v142, v143
v_rcp_f16_sdwa v148, v147 dst_sel:WORD_1 dst_unused:UNUSED_PRESERVE src0_sel:WORD_1
v_fmac_f32 v160, v206, v206
s_waitcnt lgkmcnt(1)
v_or_b32_e64 v44, v144, v145
v_pk_mul_f16 v45, v155, v154
v_fmac_f32_e64 v160, v207, v207
v_pk_mul_f16 v46, v152, v151
v_pk_mul_f16 v47, v149, v148
ds_read_b128 v[220:223], v248 offset:64512
v_mfma_f32_32x32x16_f16 v[192:207], v[40:43], v[208:211], 0
v_cvt_pkrtz_f16_f32 v137, v120, v121
v_cvt_pkrtz_f16_f32 v139, v122, v123
v_cvt_pkrtz_f16_f32 v141, v124, v125
v_cvt_pkrtz_f16_f32 v143, v126, v127
v_cvt_pkrtz_f16_f32 v145, v128, v129
v_mfma_f32_32x32x16_f16 v[192:207], v[44:47], v[212:215], v[192:207]
v_cvt_pk_f16_f32 v155, v130, v131
v_cvt_pk_f16_f32 v152, v132, v133
v_cvt_pk_f16_f32 v149, v134, v135
v_pk_fma_f16 v154, v155, v155, s48
v_and_b32_e64 v137, s49, v137
v_pk_fma_f16 v151, v152, v152, s48
v_mfma_f32_32x32x16_bf16 v[120:135], v[224:227], v[168:171], 0
v_and_b32 v139, s49, v139
v_pk_fma_f16 v148, v149, v149, s48
v_permlane16_swap_b32 v40, v44
v_pk_mul_f16 v154, v155, v154
v_bfe_u32 v136, v137, 2, 14
v_permlane16_swap_b32 v41, v45
v_pk_mul_f16 v151, v152, v151
v_pk_mul_f16 v148, v149, v148
v_bfe_u32 v138, v139, 2, 14
v_permlane16_swap_b32 v42, v46
ds_read_b128 v[224:227], v249
ds_read_u16_d16 v136, v136
ds_read_u16_d16 v138, v138
v_mfma_f32_32x32x16_bf16 v[120:135], v[228:231], v[172:175], v[120:135]
v_exp_f16 v153, v154
v_permlane16_swap_b32 v43, v47
v_lshrrev_b32 v137, 18, v137
v_exp_f16 v150, v151
v_fmac_f32 v161, v192, v192
v_lshrrev_b32 v139, 18, v139
v_exp_f16 v147, v148
v_fmac_f32 v161, v193, v193
v_and_b32_e64 v141, s49, v141
ds_read_b128 v[228:231], v249 offset:3072
ds_read_u16_d16_hi v137, v137
ds_read_u16_d16_hi v139, v139
v_mfma_f32_32x32x16_bf16 v[120:135], v[232:235], v[176:179], v[120:135]
v_and_b32 v143, s49, v143
v_fmac_f32 v161, v194, v194
v_exp_f16_sdwa v153, v154 dst_sel:WORD_1 dst_unused:UNUSED_PRESERVE src0_sel:WORD_1
v_bfe_u32 v140, v141, 2, 14
v_fmac_f32_e64 v161, v195, v195
v_exp_f16_sdwa v150, v151 dst_sel:WORD_1 dst_unused:UNUSED_PRESERVE src0_sel:WORD_1
v_fmac_f32_e64 v161, v196, v196
v_bfe_u32 v142, v143, 2, 14
ds_read_b128 v[232:235], v249 offset:1024
ds_read_u16_d16 v140, v140
ds_read_u16_d16 v142, v142
v_mfma_f32_32x32x16_bf16 v[120:135], v[236:239], v[180:183], v[120:135]
v_exp_f16_sdwa v147, v148 dst_sel:WORD_1 dst_unused:UNUSED_PRESERVE src0_sel:WORD_1
v_fmac_f32 v161, v197, v197
v_lshrrev_b32 v141, 18, v141
v_pk_add_f16 v153, v153, 1.0 op_sel_hi:[1,0]
v_lshrrev_b32 v143, 18, v143
v_fmac_f32 v161, v198, v198
v_pk_add_f16 v150, v150, 1.0 op_sel_hi:[1,0]
v_pk_add_f16 v147, v147, 1.0 op_sel_hi:[1,0]
v_fmac_f32_e64 v161, v199, v199
v_and_b32 v145, s49, v145
s_waitcnt lgkmcnt(4)
ds_read_b128 v[236:239], v249 offset:4096
ds_read_u16_d16_hi v141, v141
ds_read_u16_d16_hi v143, v143
v_mfma_f32_32x32x16_bf16 v[120:135], v[216:219], v[184:187], v[120:135]
v_rcp_f16 v154, v153
v_fmac_f32 v161, v200, v200
v_bfe_u32 v144, v145, 2, 14
v_rcp_f16 v151, v150
v_fmac_f32 v161, v201, v201
v_lshrrev_b32 v145, 18, v145
v_rcp_f16 v148, v147
v_fmac_f32_e64 v161, v202, v202
ds_read_u16_d16 v144, v144
ds_read_u16_d16_hi v145, v145
v_or_b32_e64 v48, v136, v137
ds_read_b128 v[216:219], v249 offset:2048
v_mfma_f32_32x32x16_bf16 v[120:135], v[220:223], v[188:191], v[120:135]
s_waitcnt lgkmcnt(6)
v_or_b32 v49, v138, v139
v_fmac_f32_e64 v161, v203, v203
v_rcp_f16_sdwa v154, v153 dst_sel:WORD_1 dst_unused:UNUSED_PRESERVE src0_sel:WORD_1
v_fmac_f32 v161, v204, v204
s_waitcnt lgkmcnt(4)
v_or_b32_e64 v50, v140, v141
v_rcp_f16_sdwa v151, v150 dst_sel:WORD_1 dst_unused:UNUSED_PRESERVE src0_sel:WORD_1
v_fmac_f32 v161, v205, v205
s_waitcnt lgkmcnt(3)
v_or_b32_e64 v51, v142, v143
v_rcp_f16_sdwa v148, v147 dst_sel:WORD_1 dst_unused:UNUSED_PRESERVE src0_sel:WORD_1
v_fmac_f32 v161, v206, v206
s_waitcnt lgkmcnt(1)
v_or_b32_e64 v52, v144, v145
v_pk_mul_f16 v53, v155, v154
v_fmac_f32 v161, v207, v207
v_pk_mul_f16 v54, v152, v151
v_pk_mul_f16 v55, v149, v148
s_setprio 1
ds_read_b128 v[220:223], v249 offset:5120
v_mfma_f32_32x32x16_f16 v[192:207], v[48:51], v[208:211], 0
v_cvt_pkrtz_f16_f32 v137, v120, v121
v_cvt_pkrtz_f16_f32 v139, v122, v123
v_cvt_pkrtz_f16_f32 v141, v124, v125
v_cvt_pkrtz_f16_f32 v143, v126, v127
v_cvt_pkrtz_f16_f32 v145, v128, v129
v_mfma_f32_32x32x16_f16 v[192:207], v[52:55], v[212:215], v[192:207]
v_cvt_pk_f16_f32 v155, v130, v131
v_cvt_pk_f16_f32 v152, v132, v133
v_cvt_pk_f16_f32 v149, v134, v135
v_pk_fma_f16 v154, v155, v155, s48
v_and_b32_e64 v137, s49, v137
v_pk_fma_f16 v151, v152, v152, s48
v_mfma_f32_32x32x16_bf16 v[120:135], v[224:227], v[168:171], 0
v_and_b32 v139, s49, v139
v_pk_fma_f16 v148, v149, v149, s48
v_permlane16_swap_b32 v48, v52
v_pk_mul_f16 v154, v155, v154
v_bfe_u32 v136, v137, 2, 14
v_permlane16_swap_b32 v49, v53
v_pk_mul_f16 v151, v152, v151
v_pk_mul_f16 v148, v149, v148
v_bfe_u32 v138, v139, 2, 14
v_permlane16_swap_b32 v50, v54
ds_read_b128 v[224:227], v249 offset:6144
ds_read_u16_d16 v136, v136
ds_read_u16_d16 v138, v138
v_mfma_f32_32x32x16_bf16 v[120:135], v[228:231], v[172:175], v[120:135]
v_exp_f16 v153, v154
v_permlane16_swap_b32 v51, v55
v_lshrrev_b32 v137, 18, v137
v_exp_f16 v150, v151
v_fmac_f32 v162, v192, v192
v_lshrrev_b32 v139, 18, v139
v_exp_f16 v147, v148
v_fmac_f32 v162, v193, v193
v_and_b32_e64 v141, s49, v141
ds_read_b128 v[228:231], v249 offset:9216
ds_read_u16_d16_hi v137, v137
ds_read_u16_d16_hi v139, v139
v_mfma_f32_32x32x16_bf16 v[120:135], v[232:235], v[176:179], v[120:135]
v_and_b32 v143, s49, v143
v_fmac_f32 v162, v194, v194
v_exp_f16_sdwa v153, v154 dst_sel:WORD_1 dst_unused:UNUSED_PRESERVE src0_sel:WORD_1
v_bfe_u32 v140, v141, 2, 14
v_fmac_f32_e64 v162, v195, v195
v_exp_f16_sdwa v150, v151 dst_sel:WORD_1 dst_unused:UNUSED_PRESERVE src0_sel:WORD_1
v_fmac_f32_e64 v162, v196, v196
v_bfe_u32 v142, v143, 2, 14
ds_read_b128 v[232:235], v249 offset:7168
ds_read_u16_d16 v140, v140
ds_read_u16_d16 v142, v142
v_mfma_f32_32x32x16_bf16 v[120:135], v[236:239], v[180:183], v[120:135]
v_exp_f16_sdwa v147, v148 dst_sel:WORD_1 dst_unused:UNUSED_PRESERVE src0_sel:WORD_1
v_fmac_f32 v162, v197, v197
v_lshrrev_b32 v141, 18, v141
v_pk_add_f16 v153, v153, 1.0 op_sel_hi:[1,0]
v_lshrrev_b32 v143, 18, v143
v_fmac_f32 v162, v198, v198
v_pk_add_f16 v150, v150, 1.0 op_sel_hi:[1,0]
v_pk_add_f16 v147, v147, 1.0 op_sel_hi:[1,0]
v_fmac_f32_e64 v162, v199, v199
v_and_b32 v145, s49, v145
s_waitcnt lgkmcnt(4)
ds_read_b128 v[236:239], v249 offset:10240
ds_read_u16_d16_hi v141, v141
ds_read_u16_d16_hi v143, v143
v_mfma_f32_32x32x16_bf16 v[120:135], v[216:219], v[184:187], v[120:135]
v_rcp_f16 v154, v153
v_fmac_f32 v162, v200, v200
v_bfe_u32 v144, v145, 2, 14
v_rcp_f16 v151, v150
v_fmac_f32 v162, v201, v201
v_lshrrev_b32 v145, 18, v145
v_rcp_f16 v148, v147
v_fmac_f32_e64 v162, v202, v202
ds_read_u16_d16 v144, v144
ds_read_u16_d16_hi v145, v145
v_or_b32_e64 v56, v136, v137
ds_read_b128 v[216:219], v249 offset:8192
v_mfma_f32_32x32x16_bf16 v[120:135], v[220:223], v[188:191], v[120:135]
s_waitcnt lgkmcnt(6)
v_or_b32 v57, v138, v139
v_fmac_f32_e64 v162, v203, v203
v_rcp_f16_sdwa v154, v153 dst_sel:WORD_1 dst_unused:UNUSED_PRESERVE src0_sel:WORD_1
v_fmac_f32 v162, v204, v204
s_waitcnt lgkmcnt(4)
v_or_b32_e64 v58, v140, v141
v_rcp_f16_sdwa v151, v150 dst_sel:WORD_1 dst_unused:UNUSED_PRESERVE src0_sel:WORD_1
v_fmac_f32 v162, v205, v205
s_waitcnt lgkmcnt(3)
v_or_b32_e64 v59, v142, v143
v_rcp_f16_sdwa v148, v147 dst_sel:WORD_1 dst_unused:UNUSED_PRESERVE src0_sel:WORD_1
v_fmac_f32 v162, v206, v206
s_waitcnt lgkmcnt(1)
v_or_b32_e64 v60, v144, v145
v_pk_mul_f16 v61, v155, v154
v_fmac_f32_e64 v162, v207, v207
v_pk_mul_f16 v62, v152, v151
v_pk_mul_f16 v63, v149, v148
ds_read_b128 v[220:223], v249 offset:11264
v_mfma_f32_32x32x16_f16 v[192:207], v[56:59], v[208:211], 0
v_cvt_pkrtz_f16_f32 v137, v120, v121
v_cvt_pkrtz_f16_f32 v139, v122, v123
v_cvt_pkrtz_f16_f32 v141, v124, v125
v_cvt_pkrtz_f16_f32 v143, v126, v127
v_cvt_pkrtz_f16_f32 v145, v128, v129
v_mfma_f32_32x32x16_f16 v[192:207], v[60:63], v[212:215], v[192:207]
v_cvt_pk_f16_f32 v155, v130, v131
v_cvt_pk_f16_f32 v152, v132, v133
v_cvt_pk_f16_f32 v149, v134, v135
v_pk_fma_f16 v154, v155, v155, s48
v_and_b32_e64 v137, s49, v137
v_pk_fma_f16 v151, v152, v152, s48
v_mfma_f32_32x32x16_bf16 v[120:135], v[224:227], v[168:171], 0
v_and_b32 v139, s49, v139
v_pk_fma_f16 v148, v149, v149, s48
v_permlane16_swap_b32 v56, v60
v_pk_mul_f16 v154, v155, v154
v_bfe_u32 v136, v137, 2, 14
v_permlane16_swap_b32 v57, v61
v_pk_mul_f16 v151, v152, v151
v_pk_mul_f16 v148, v149, v148
v_bfe_u32 v138, v139, 2, 14
v_permlane16_swap_b32 v58, v62
ds_read_b128 v[224:227], v249 offset:12288
ds_read_u16_d16 v136, v136
ds_read_u16_d16 v138, v138
v_mfma_f32_32x32x16_bf16 v[120:135], v[228:231], v[172:175], v[120:135]
v_exp_f16 v153, v154
v_permlane16_swap_b32 v59, v63
v_lshrrev_b32 v137, 18, v137
v_exp_f16 v150, v151
v_fmac_f32 v163, v192, v192
v_lshrrev_b32 v139, 18, v139
v_exp_f16 v147, v148
v_fmac_f32 v163, v193, v193
v_and_b32_e64 v141, s49, v141
ds_read_b128 v[228:231], v249 offset:15360
ds_read_u16_d16_hi v137, v137
ds_read_u16_d16_hi v139, v139
v_mfma_f32_32x32x16_bf16 v[120:135], v[232:235], v[176:179], v[120:135]
v_and_b32 v143, s49, v143
s_setprio 0
v_fmac_f32_e64 v163, v194, v194
v_exp_f16_sdwa v153, v154 dst_sel:WORD_1 dst_unused:UNUSED_PRESERVE src0_sel:WORD_1
v_bfe_u32 v140, v141, 2, 14
v_fmac_f32_e64 v163, v195, v195
v_exp_f16_sdwa v150, v151 dst_sel:WORD_1 dst_unused:UNUSED_PRESERVE src0_sel:WORD_1
v_fmac_f32_e64 v163, v196, v196
v_bfe_u32 v142, v143, 2, 14
ds_read_b128 v[232:235], v249 offset:13312
ds_read_u16_d16 v140, v140
ds_read_u16_d16 v142, v142
v_mfma_f32_32x32x16_bf16 v[120:135], v[236:239], v[180:183], v[120:135]
v_exp_f16_sdwa v147, v148 dst_sel:WORD_1 dst_unused:UNUSED_PRESERVE src0_sel:WORD_1
v_fmac_f32 v163, v197, v197
v_lshrrev_b32 v141, 18, v141
v_pk_add_f16 v153, v153, 1.0 op_sel_hi:[1,0]
v_lshrrev_b32 v143, 18, v143
v_fmac_f32 v163, v198, v198
v_pk_add_f16 v150, v150, 1.0 op_sel_hi:[1,0]
v_pk_add_f16 v147, v147, 1.0 op_sel_hi:[1,0]
v_fmac_f32_e64 v163, v199, v199
v_and_b32 v145, s49, v145
s_waitcnt lgkmcnt(3)
ds_read_b128 v[236:239], v249 offset:16384
ds_read_u16_d16_hi v141, v141
ds_read_u16_d16_hi v143, v143
v_mfma_f32_32x32x16_bf16 v[120:135], v[216:219], v[184:187], v[120:135]
v_rcp_f16 v154, v153
v_fmac_f32 v163, v200, v200
v_bfe_u32 v144, v145, 2, 14
v_rcp_f16 v151, v150
v_fmac_f32 v163, v201, v201
v_lshrrev_b32 v145, 18, v145
v_rcp_f16 v148, v147
v_fmac_f32_e64 v163, v202, v202
ds_read_u16_d16 v144, v144
ds_read_u16_d16_hi v145, v145
v_or_b32_e64 v64, v136, v137
ds_read_b128 v[216:219], v249 offset:14336
v_mfma_f32_32x32x16_bf16 v[120:135], v[220:223], v[188:191], v[120:135]
v_or_b32 v65, v138, v139
v_fmac_f32 v163, v203, v203
v_rcp_f16_sdwa v154, v153 dst_sel:WORD_1 dst_unused:UNUSED_PRESERVE src0_sel:WORD_1
v_fmac_f32 v163, v204, v204
s_waitcnt lgkmcnt(4)
v_or_b32_e64 v66, v140, v141
v_rcp_f16_sdwa v151, v150 dst_sel:WORD_1 dst_unused:UNUSED_PRESERVE src0_sel:WORD_1
v_fmac_f32 v163, v205, v205
s_waitcnt lgkmcnt(3)
v_or_b32_e64 v67, v142, v143
v_rcp_f16_sdwa v148, v147 dst_sel:WORD_1 dst_unused:UNUSED_PRESERVE src0_sel:WORD_1
v_fmac_f32 v163, v206, v206
s_waitcnt lgkmcnt(1)
v_or_b32_e64 v68, v144, v145
v_pk_mul_f16 v69, v155, v154
v_fmac_f32 v163, v207, v207
v_pk_mul_f16 v70, v152, v151
v_pk_mul_f16 v71, v149, v148
s_setprio 2
ds_read_b128 v[220:223], v249 offset:17408
v_mfma_f32_32x32x16_f16 v[192:207], v[64:67], v[208:211], 0
v_cvt_pkrtz_f16_f32 v137, v120, v121
v_cvt_pkrtz_f16_f32 v139, v122, v123
v_cvt_pkrtz_f16_f32 v141, v124, v125
v_cvt_pkrtz_f16_f32 v143, v126, v127
v_cvt_pkrtz_f16_f32 v145, v128, v129
v_mfma_f32_32x32x16_f16 v[192:207], v[68:71], v[212:215], v[192:207]
v_cvt_pk_f16_f32 v155, v130, v131
v_cvt_pk_f16_f32 v152, v132, v133
v_cvt_pk_f16_f32 v149, v134, v135
v_pk_fma_f16 v154, v155, v155, s48
v_and_b32_e64 v137, s49, v137
v_pk_fma_f16 v151, v152, v152, s48
v_mfma_f32_32x32x16_bf16 v[120:135], v[224:227], v[168:171], 0
v_and_b32 v139, s49, v139
v_pk_fma_f16 v148, v149, v149, s48
v_permlane16_swap_b32 v64, v68
v_pk_mul_f16 v154, v155, v154
v_bfe_u32 v136, v137, 2, 14
v_permlane16_swap_b32 v65, v69
v_pk_mul_f16 v151, v152, v151
v_pk_mul_f16 v148, v149, v148
v_bfe_u32 v138, v139, 2, 14
v_permlane16_swap_b32 v66, v70
ds_read_b128 v[224:227], v249 offset:18432
ds_read_u16_d16 v136, v136
ds_read_u16_d16 v138, v138
v_mfma_f32_32x32x16_bf16 v[120:135], v[228:231], v[172:175], v[120:135]
v_exp_f16 v153, v154
v_permlane16_swap_b32 v67, v71
v_lshrrev_b32 v137, 18, v137
v_exp_f16 v150, v151
v_fmac_f32 v164, v192, v192
v_lshrrev_b32 v139, 18, v139
v_exp_f16 v147, v148
v_fmac_f32 v164, v193, v193
v_and_b32_e64 v141, s49, v141
ds_read_b128 v[228:231], v249 offset:21504
ds_read_u16_d16_hi v137, v137
ds_read_u16_d16_hi v139, v139
v_mfma_f32_32x32x16_bf16 v[120:135], v[232:235], v[176:179], v[120:135]
v_and_b32 v143, s49, v143
v_fmac_f32 v164, v194, v194
v_exp_f16_sdwa v153, v154 dst_sel:WORD_1 dst_unused:UNUSED_PRESERVE src0_sel:WORD_1
v_bfe_u32 v140, v141, 2, 14
v_fmac_f32_e64 v164, v195, v195
v_exp_f16_sdwa v150, v151 dst_sel:WORD_1 dst_unused:UNUSED_PRESERVE src0_sel:WORD_1
v_fmac_f32_e64 v164, v196, v196
v_bfe_u32 v142, v143, 2, 14
ds_read_b128 v[232:235], v249 offset:19456
ds_read_u16_d16 v140, v140
ds_read_u16_d16 v142, v142
v_mfma_f32_32x32x16_bf16 v[120:135], v[236:239], v[180:183], v[120:135]
v_exp_f16_sdwa v147, v148 dst_sel:WORD_1 dst_unused:UNUSED_PRESERVE src0_sel:WORD_1
v_fmac_f32 v164, v197, v197
v_lshrrev_b32 v141, 18, v141
v_pk_add_f16 v153, v153, 1.0 op_sel_hi:[1,0]
v_lshrrev_b32 v143, 18, v143
v_fmac_f32 v164, v198, v198
v_pk_add_f16 v150, v150, 1.0 op_sel_hi:[1,0]
v_pk_add_f16 v147, v147, 1.0 op_sel_hi:[1,0]
v_fmac_f32_e64 v164, v199, v199
v_and_b32 v145, s49, v145
s_waitcnt lgkmcnt(4)
ds_read_b128 v[236:239], v249 offset:22528
ds_read_u16_d16_hi v141, v141
ds_read_u16_d16_hi v143, v143
v_mfma_f32_32x32x16_bf16 v[120:135], v[216:219], v[184:187], v[120:135]
v_rcp_f16 v154, v153
v_fmac_f32 v164, v200, v200
v_bfe_u32 v144, v145, 2, 14
v_rcp_f16 v151, v150
v_fmac_f32 v164, v201, v201
v_lshrrev_b32 v145, 18, v145
v_rcp_f16 v148, v147
v_fmac_f32_e64 v164, v202, v202
ds_read_u16_d16 v144, v144
ds_read_u16_d16_hi v145, v145
v_or_b32_e64 v72, v136, v137
ds_read_b128 v[216:219], v249 offset:20480
v_mfma_f32_32x32x16_bf16 v[120:135], v[220:223], v[188:191], v[120:135]
s_waitcnt lgkmcnt(6)
v_or_b32 v73, v138, v139
v_fmac_f32_e64 v164, v203, v203
v_rcp_f16_sdwa v154, v153 dst_sel:WORD_1 dst_unused:UNUSED_PRESERVE src0_sel:WORD_1
v_fmac_f32 v164, v204, v204
s_waitcnt lgkmcnt(4)
v_or_b32_e64 v74, v140, v141
v_rcp_f16_sdwa v151, v150 dst_sel:WORD_1 dst_unused:UNUSED_PRESERVE src0_sel:WORD_1
v_fmac_f32 v164, v205, v205
s_waitcnt lgkmcnt(3)
v_or_b32_e64 v75, v142, v143
v_rcp_f16_sdwa v148, v147 dst_sel:WORD_1 dst_unused:UNUSED_PRESERVE src0_sel:WORD_1
v_fmac_f32 v164, v206, v206
s_waitcnt lgkmcnt(1)
v_or_b32_e64 v76, v144, v145
v_pk_mul_f16 v77, v155, v154
v_fmac_f32_e64 v164, v207, v207
v_pk_mul_f16 v78, v152, v151
v_pk_mul_f16 v79, v149, v148
ds_read_b128 v[220:223], v249 offset:23552
v_mfma_f32_32x32x16_f16 v[192:207], v[72:75], v[208:211], 0
v_cvt_pkrtz_f16_f32 v137, v120, v121
v_cvt_pkrtz_f16_f32 v139, v122, v123
v_cvt_pkrtz_f16_f32 v141, v124, v125
v_cvt_pkrtz_f16_f32 v143, v126, v127
v_cvt_pkrtz_f16_f32 v145, v128, v129
v_mfma_f32_32x32x16_f16 v[192:207], v[76:79], v[212:215], v[192:207]
v_cvt_pk_f16_f32 v155, v130, v131
v_cvt_pk_f16_f32 v152, v132, v133
v_cvt_pk_f16_f32 v149, v134, v135
v_pk_fma_f16 v154, v155, v155, s48
v_and_b32_e64 v137, s49, v137
v_pk_fma_f16 v151, v152, v152, s48
v_mfma_f32_32x32x16_bf16 v[120:135], v[224:227], v[168:171], 0
v_and_b32 v139, s49, v139
v_pk_fma_f16 v148, v149, v149, s48
v_permlane16_swap_b32 v72, v76
v_pk_mul_f16 v154, v155, v154
v_bfe_u32 v136, v137, 2, 14
v_permlane16_swap_b32 v73, v77
v_pk_mul_f16 v151, v152, v151
v_pk_mul_f16 v148, v149, v148
v_bfe_u32 v138, v139, 2, 14
v_permlane16_swap_b32 v74, v78
ds_read_u16_d16 v136, v136
ds_read_u16_d16 v138, v138
v_mfma_f32_32x32x16_bf16 v[120:135], v[228:231], v[172:175], v[120:135]
v_exp_f16 v153, v154
v_permlane16_swap_b32 v75, v79
v_lshrrev_b32 v137, 18, v137
v_exp_f16 v150, v151
v_fmac_f32 v165, v192, v192
v_lshrrev_b32 v139, 18, v139
v_exp_f16 v147, v148
v_fmac_f32 v165, v193, v193
v_and_b32_e64 v141, s49, v141
ds_read_u16_d16_hi v137, v137
ds_read_u16_d16_hi v139, v139
v_mfma_f32_32x32x16_bf16 v[120:135], v[232:235], v[176:179], v[120:135]
v_and_b32 v143, s49, v143
v_fmac_f32 v165, v194, v194
v_exp_f16_sdwa v153, v154 dst_sel:WORD_1 dst_unused:UNUSED_PRESERVE src0_sel:WORD_1
v_bfe_u32 v140, v141, 2, 14
v_fmac_f32_e64 v165, v195, v195
v_exp_f16_sdwa v150, v151 dst_sel:WORD_1 dst_unused:UNUSED_PRESERVE src0_sel:WORD_1
v_fmac_f32_e64 v165, v196, v196
v_bfe_u32 v142, v143, 2, 14
ds_read_u16_d16 v140, v140
ds_read_u16_d16 v142, v142
v_mfma_f32_32x32x16_bf16 v[120:135], v[236:239], v[180:183], v[120:135]
v_exp_f16_sdwa v147, v148 dst_sel:WORD_1 dst_unused:UNUSED_PRESERVE src0_sel:WORD_1
v_fmac_f32 v165, v197, v197
v_lshrrev_b32 v141, 18, v141
v_pk_add_f16 v153, v153, 1.0 op_sel_hi:[1,0]
v_lshrrev_b32 v143, 18, v143
v_fmac_f32 v165, v198, v198
v_pk_add_f16 v150, v150, 1.0 op_sel_hi:[1,0]
v_pk_add_f16 v147, v147, 1.0 op_sel_hi:[1,0]
v_fmac_f32_e64 v165, v199, v199
v_and_b32 v145, s49, v145
s_waitcnt lgkmcnt(4)
ds_read_u16_d16_hi v141, v141
ds_read_u16_d16_hi v143, v143
v_mfma_f32_32x32x16_bf16 v[120:135], v[216:219], v[184:187], v[120:135]
v_rcp_f16 v154, v153
v_fmac_f32 v165, v200, v200
v_bfe_u32 v144, v145, 2, 14
v_rcp_f16 v151, v150
v_fmac_f32 v165, v201, v201
v_lshrrev_b32 v145, 18, v145
v_rcp_f16 v148, v147
v_fmac_f32_e64 v165, v202, v202
ds_read_u16_d16 v144, v144
ds_read_u16_d16_hi v145, v145
s_waitcnt lgkmcnt(4)
v_or_b32 v80, v136, v137
v_mfma_f32_32x32x16_bf16 v[120:135], v[220:223], v[188:191], v[120:135]
v_or_b32 v81, v138, v139
v_fmac_f32 v165, v203, v203
v_rcp_f16_sdwa v154, v153 dst_sel:WORD_1 dst_unused:UNUSED_PRESERVE src0_sel:WORD_1
v_fmac_f32 v165, v204, v204
s_waitcnt lgkmcnt(3)
v_or_b32_e64 v82, v140, v141
v_rcp_f16_sdwa v151, v150 dst_sel:WORD_1 dst_unused:UNUSED_PRESERVE src0_sel:WORD_1
v_fmac_f32 v165, v205, v205
s_waitcnt lgkmcnt(2)
v_or_b32_e64 v83, v142, v143
v_rcp_f16_sdwa v148, v147 dst_sel:WORD_1 dst_unused:UNUSED_PRESERVE src0_sel:WORD_1
v_fmac_f32 v165, v206, v206
s_waitcnt lgkmcnt(0)
v_or_b32_e64 v84, v144, v145
v_pk_mul_f16 v85, v155, v154
v_fmac_f32 v165, v207, v207
v_pk_mul_f16 v86, v152, v151
v_pk_mul_f16 v87, v149, v148
s_setprio 1
v_mfma_f32_32x32x16_f16 v[192:207], v[80:83], v[208:211], 0
v_mfma_f32_32x32x16_f16 v[192:207], v[84:87], v[212:215], v[192:207]
v_cvt_pkrtz_f16_f32 v137, v120, v121
v_cvt_pkrtz_f16_f32 v139, v122, v123
v_cvt_pkrtz_f16_f32 v141, v124, v125
v_cvt_pkrtz_f16_f32 v143, v126, v127
v_cvt_pkrtz_f16_f32 v145, v128, v129
v_cvt_pk_f16_f32 v155, v130, v131
v_cvt_pk_f16_f32 v152, v132, v133
v_cvt_pk_f16_f32 v149, v134, v135
v_pk_fma_f16 v154, v155, v155, s48
v_and_b32_e64 v137, s49, v137
v_pk_fma_f16 v151, v152, v152, s48
v_and_b32_e64 v139, s49, v139
v_pk_fma_f16 v148, v149, v149, s48
v_permlane16_swap_b32 v80, v84
v_pk_mul_f16 v154, v155, v154
v_bfe_u32 v136, v137, 2, 14
v_permlane16_swap_b32 v81, v85
v_pk_mul_f16 v151, v152, v151
v_pk_mul_f16 v148, v149, v148
v_bfe_u32 v138, v139, 2, 14
v_permlane16_swap_b32 v82, v86
v_exp_f16 v153, v154
v_permlane16_swap_b32 v83, v87
v_lshrrev_b32 v137, 18, v137
v_exp_f16 v150, v151
v_fmac_f32 v166, v192, v192
v_lshrrev_b32 v139, 18, v139
v_exp_f16 v147, v148
v_fmac_f32 v166, v193, v193
v_and_b32 v141, s49, v141
v_and_b32_e64 v143, s49, v143
ds_read_u16_d16 v136, v136
ds_read_u16_d16 v138, v138
ds_read_u16_d16_hi v137, v137
ds_read_u16_d16_hi v139, v139
v_fmac_f32_e64 v166, v194, v194
v_exp_f16_sdwa v153, v154 dst_sel:WORD_1 dst_unused:UNUSED_PRESERVE src0_sel:WORD_1
v_bfe_u32 v140, v141, 2, 14
v_fmac_f32_e64 v166, v195, v195
v_exp_f16_sdwa v150, v151 dst_sel:WORD_1 dst_unused:UNUSED_PRESERVE src0_sel:WORD_1
v_fmac_f32_e64 v166, v196, v196
v_bfe_u32 v142, v143, 2, 14
v_exp_f16_sdwa v147, v148 dst_sel:WORD_1 dst_unused:UNUSED_PRESERVE src0_sel:WORD_1
v_fmac_f32 v166, v197, v197
v_lshrrev_b32 v141, 18, v141
v_pk_add_f16 v153, v153, 1.0 op_sel_hi:[1,0]
v_lshrrev_b32 v143, 18, v143
v_fmac_f32 v166, v198, v198
v_pk_add_f16 v150, v150, 1.0 op_sel_hi:[1,0]
v_pk_add_f16 v147, v147, 1.0 op_sel_hi:[1,0]
v_fmac_f32 v166, v199, v199
v_and_b32 v145, s49, v145
v_rcp_f16 v154, v153
v_fmac_f32 v166, v200, v200
v_bfe_u32 v144, v145, 2, 14
v_rcp_f16 v151, v150
v_fmac_f32 v166, v201, v201
v_lshrrev_b32_e64 v145, 18, v145
ds_read_u16_d16 v140, v140
ds_read_u16_d16 v142, v142
ds_read_u16_d16_hi v141, v141
ds_read_u16_d16_hi v143, v143
ds_read_u16_d16 v144, v144
ds_read_u16_d16_hi v145, v145
v_rcp_f16 v148, v147
v_fmac_f32 v166, v202, v202
s_waitcnt lgkmcnt(6)
v_or_b32 v88, v136, v137
v_or_b32 v89, v138, v139
v_fmac_f32 v166, v203, v203
v_rcp_f16_sdwa v154, v153 dst_sel:WORD_1 dst_unused:UNUSED_PRESERVE src0_sel:WORD_1
v_fmac_f32 v166, v204, v204
s_waitcnt lgkmcnt(3)
v_or_b32_e64 v90, v140, v141
v_rcp_f16_sdwa v151, v150 dst_sel:WORD_1 dst_unused:UNUSED_PRESERVE src0_sel:WORD_1
v_fmac_f32 v166, v205, v205
s_waitcnt lgkmcnt(2)
v_or_b32_e64 v91, v142, v143
v_rcp_f16_sdwa v148, v147 dst_sel:WORD_1 dst_unused:UNUSED_PRESERVE src0_sel:WORD_1
v_fmac_f32 v166, v206, v206
s_waitcnt lgkmcnt(0)
v_or_b32_e64 v92, v144, v145
v_pk_mul_f16 v93, v155, v154
v_fmac_f32_e64 v166, v207, v207
v_pk_mul_f16 v94, v152, v151
v_pk_mul_f16 v95, v149, v148
v_mfma_f32_32x32x16_f16 v[192:207], v[88:91], v[208:211], 0
s_nop 0
v_mfma_f32_32x32x16_f16 v[192:207], v[92:95], v[212:215], v[192:207]
v_permlane16_swap_b32 v88, v92
v_permlane16_swap_b32 v89, v93
v_permlane16_swap_b32 v90, v94
v_permlane16_swap_b32 v91, v95
s_nop 7
v_fmac_f32 v167, v192, v192
v_fmac_f32 v167, v193, v193
v_fmac_f32 v167, v194, v194
v_fmac_f32 v167, v195, v195
s_setprio 0
v_fmac_f32 v167, v196, v196
v_fmac_f32 v167, v197, v197
v_fmac_f32 v167, v198, v198
v_fmac_f32 v167, v199, v199
v_fmac_f32 v167, v200, v200
v_fmac_f32 v167, v201, v201
v_fmac_f32 v167, v202, v202
v_fmac_f32 v167, v203, v203
v_fmac_f32 v167, v204, v204
v_fmac_f32 v167, v205, v205
v_fmac_f32 v167, v206, v206
v_fmac_f32 v167, v207, v207
s_setprio 3
v_and_b32_e64 v136, 51, v251
v_bfe_u32 v137, v251, 2, 1
v_lshl_add_u32 v136, v137, 3, v136
v_bfe_u32 v137, v251, 3, 1
v_lshl_add_u32 v136, v137, 2, v136
v_lshl_add_u32 v136, v136, 2, s72
v_permlane32_swap_b32 v156, v157
v_add_f32 v156, v156, v157
ds_write_b32 v136, v156 offset:7168
v_permlane32_swap_b32 v158, v159
v_add_f32 v158, v158, v159
ds_write_b32 v136, v158 offset:7424
v_permlane32_swap_b32 v160, v161
v_add_f32 v160, v160, v161
ds_write_b32 v136, v160 offset:7680
v_permlane32_swap_b32 v162, v163
v_add_f32 v162, v162, v163
ds_write_b32 v136, v162 offset:7936
v_permlane32_swap_b32 v164, v165
v_add_f32 v164, v164, v165
ds_write_b32 v136, v164 offset:8192
v_permlane32_swap_b32 v166, v167
v_add_f32 v166, v166, v167
ds_write_b32 v136, v166 offset:8448
v_mov_b32 v128, 16256
v_mov_b32_e64 v129, 1
s_waitcnt lgkmcnt(0)
s_mov_b64 exec, 1
ds_add_rtn_u32 v130, v128, v129
s_mov_b64 exec, -1
s_waitcnt lgkmcnt(0)
v_readfirstlane_b32 s43, v130
s_nop 1
s_cmp_lg_u32 s43, 7
s_cbranch_scc1 Lnopub
v_min_u32 v131, 47, v251
v_lshlrev_b32 v132, 5, v131
v_add_u32 v132, 97280, v132
ds_read_b128 v[168:171], v132
ds_read_b128 v[172:175], v132 offset:16
ds_read_b128 v[176:179], v132 offset:9216
ds_read_b128 v[180:183], v132 offset:9232
ds_read_b128 v[184:187], v132 offset:18432
ds_read_b128 v[188:191], v132 offset:18448
ds_read_b128 v[192:195], v132 offset:27648
ds_read_b128 v[196:199], v132 offset:27664
ds_read_b128 v[200:203], v132 offset:36864
ds_read_b128 v[204:207], v132 offset:36880
ds_read_b128 v[208:211], v132 offset:46080
ds_read_b128 v[212:215], v132 offset:46096
ds_read_b128 v[216:219], v132 offset:55296
ds_read_b128 v[220:223], v132 offset:55312
ds_read_b128 v[120:123], v132 offset:64512
ds_read_b128 v[124:127], v132 offset:64528
v_lshlrev_b32_e64 v134, 13, v131
v_add_u32 v135, 4096, v134
s_waitcnt lgkmcnt(13)
v_add_f32 v168, v168, v176
v_add_f32 v169, v169, v177
v_add_f32 v170, v170, v178
v_add_f32 v171, v171, v179
s_waitcnt lgkmcnt(12)
v_add_f32 v172, v172, v180
v_add_f32 v173, v173, v181
v_add_f32 v174, v174, v182
v_add_f32 v175, v175, v183
s_waitcnt lgkmcnt(9)
v_add_f32 v184, v184, v192
v_add_f32 v185, v185, v193
v_add_f32 v186, v186, v194
v_add_f32 v187, v187, v195
s_waitcnt lgkmcnt(8)
v_add_f32 v188, v188, v196
v_add_f32 v189, v189, v197
v_add_f32 v190, v190, v198
v_add_f32 v191, v191, v199
s_waitcnt lgkmcnt(5)
v_add_f32 v200, v200, v208
v_add_f32 v201, v201, v209
v_add_f32 v202, v202, v210
v_add_f32 v203, v203, v211
s_waitcnt lgkmcnt(4)
v_add_f32 v204, v204, v212
v_add_f32 v205, v205, v213
v_add_f32 v206, v206, v214
v_add_f32 v207, v207, v215
s_waitcnt lgkmcnt(1)
v_add_f32 v216, v216, v120
v_add_f32 v217, v217, v121
v_add_f32 v218, v218, v122
v_add_f32 v219, v219, v123
s_waitcnt lgkmcnt(0)
v_add_f32 v220, v220, v124
v_add_f32 v221, v221, v125
v_add_f32 v222, v222, v126
v_add_f32 v223, v223, v127
v_add_f32 v168, v168, v184
v_add_f32 v169, v169, v185
v_add_f32 v170, v170, v186
v_add_f32 v171, v171, v187
v_add_f32 v172, v172, v188
v_add_f32 v173, v173, v189
v_add_f32 v174, v174, v190
v_add_f32 v175, v175, v191
v_add_f32 v200, v200, v216
v_add_f32 v201, v201, v217
v_add_f32 v202, v202, v218
v_add_f32 v203, v203, v219
v_add_f32 v204, v204, v220
v_add_f32 v205, v205, v221
v_add_f32 v206, v206, v222
v_add_f32 v207, v207, v223
v_add_f32 v168, v168, v200
v_add_f32 v169, v169, v201
v_add_f32 v170, v170, v202
v_add_f32 v171, v171, v203
v_add_f32 v172, v172, v204
v_add_f32 v173, v173, v205
v_add_f32 v174, v174, v206
v_add_f32 v175, v175, v207
v_min_u32 v176, -2, v168
v_min_u32 v177, -2, v169
v_min_u32 v178, -2, v170
v_min_u32 v179, -2, v171
v_min_u32 v180, -2, v172
v_min_u32 v181, -2, v173
v_min_u32_e64 v182, -2, v174
v_min_u32 v183, -2, v175
s_lshl_b32 s43, s2, 4
buffer_store_dwordx4 v[176:179], v134, s[32:35], s43 offen sc1
buffer_store_dwordx4 v[180:183], v135, s[32:35], s43 offen sc1
ds_write_b32 v128, v129 offset:4
s_waitcnt lgkmcnt(0)
s_nop 1
Lnopub:
v_mov_b32 v252, v240
s_mov_b32 s77, 0
s_cmp_lg_u32 s40, 0
s_cbranch_scc1 Lnorole
v_lshlrev_b32_e64 v255, 2, v251
buffer_load_dword v244, v255, s[24:27], 0 offen
buffer_load_dword v245, v255, s[24:27], 0 offen offset:256
buffer_load_dword v246, v255, s[24:27], 0 offen offset:512
v_mov_b32 v162, 0
s_waitcnt vmcnt(0) lgkmcnt(0)
s_nop 4
Lpi:
buffer_load_dword v163, v162, s[36:39], 0 offen sc1
s_waitcnt vmcnt(0)
v_readfirstlane_b32 s43, v163
s_cmp_eq_u32 s76, 0
s_cbranch_scc1 Lpix
s_sub_u32 s76, s76, 1
s_cmp_lt_u32 s43, 256
s_waitcnt vmcnt(0) lgkmcnt(0)
s_nop 4
s_cbranch_scc1 Lpi
s_waitcnt vmcnt(0) lgkmcnt(0)
s_nop 4
Lpix:
v_min_u32 v247, 47, v251
v_lshlrev_b32_e64 v247, 3, v247
s_and_b32 s44, s2, 7
s_lshl_b32 s44, s44, 11
s_add_u32 s44, s44, 394752
buffer_load_dwordx2 v[166:167], v247, s[32:35], s44 offen sc1
v_add_u32 v255, 7936, v247
v_add_u32 v247, 15872, v247
v_cmp_gt_u32 vcc, 32, v251
s_nop 1
v_cndmask_b32 v247, v247, v255, vcc
s_waitcnt vmcnt(0)
ds_write_b64 v247, v[166:167]
s_waitcnt lgkmcnt(0)
s_cmp_lt_u32 s2, 96
s_cselect_b32 s77, 1, 2
v_mov_b32 v156, -1
v_mov_b32 v157, -1
v_mov_b32 v158, -1
v_mov_b32 v159, -1
v_mov_b32 v160, -1
v_mov_b32 v161, -1
v_mov_b32 v162, -1
v_mov_b32 v163, -1
v_mov_b32 v164, -1
v_mov_b32 v165, -1
v_mov_b32 v166, -1
v_mov_b32 v167, -1
v_mov_b32 v240, -1
v_mov_b32 v241, -1
v_mov_b32_e64 v242, -1
v_mov_b32 v243, -1
s_call_b64 s[78:79], Lpoll
Lnorole:
s_setprio 0
ds_read_b128 v[224:227], v248 offset:47104
ds_read_b128 v[228:231], v248 offset:50176
ds_read_b128 v[232:235], v248 offset:48128
ds_read_b128 v[236:239], v248 offset:51200
s_setprio 2
s_waitcnt lgkmcnt(3)
v_mfma_f32_32x32x16_bf16 v[120:135], v[224:227], v[96:99], 0
s_waitcnt lgkmcnt(2)
ds_read_b128 v[224:227], v248 offset:49152
v_mfma_f32_32x32x16_bf16 v[120:135], v[228:231], v[100:103], v[120:135]
s_waitcnt lgkmcnt(2)
ds_read_b128 v[228:231], v248 offset:52224
v_mfma_f32_32x32x16_bf16 v[120:135], v[232:235], v[104:107], v[120:135]
s_waitcnt lgkmcnt(2)
ds_read_b128 v[232:235], v248 offset:53248
v_mfma_f32_32x32x16_bf16 v[120:135], v[236:239], v[108:111], v[120:135]
s_waitcnt lgkmcnt(2)
ds_read_b128 v[236:239], v248 offset:56320
v_mfma_f32_32x32x16_bf16 v[120:135], v[224:227], v[112:115], v[120:135]
s_waitcnt lgkmcnt(2)
ds_read_b128 v[224:227], v248 offset:54272
v_mfma_f32_32x32x16_bf16 v[120:135], v[228:231], v[116:119], v[120:135]
s_cmp_eq_u32 s77, 0
s_cbranch_scc1 Lpp0
s_getreg_b32 s43, hwreg(HW_REG_IB_STS, 0, 4)
s_cmp_lg_u32 s43, 0
s_cbranch_scc1 Lpp0
s_call_b64 s[78:79], Lpoll
s_setprio 2
Lpp0:
s_nop 9
v_cvt_pkrtz_f16_f32 v137, v120, v121
v_cvt_pkrtz_f16_f32 v139, v122, v123
v_cvt_pkrtz_f16_f32 v141, v124, v125
v_cvt_pkrtz_f16_f32 v143, v126, v127
v_cvt_pkrtz_f16_f32 v145, v128, v129
v_cvt_pk_f16_f32 v155, v130, v131
v_cvt_pk_f16_f32 v152, v132, v133
v_cvt_pk_f16_f32 v149, v134, v135
s_waitcnt lgkmcnt(0)
ds_read_b128 v[228:231], v248 offset:57344
v_mfma_f32_32x32x16_bf16 v[120:135], v[232:235], v[96:99], 0
v_pk_fma_f16 v154, v155, v155, s48
v_and_b32 v137, s49, v137
v_pk_fma_f16 v151, v152, v152, s48
v_and_b32_e64 v139, s49, v139
v_pk_fma_f16 v148, v149, v149, s48
v_pk_mul_f16 v154, v155, v154
v_bfe_u32 v136, v137, 2, 14
v_pk_mul_f16 v151, v152, v151
ds_read_b128 v[232:235], v248 offset:55296
ds_read_u16_d16 v136, v136
v_mfma_f32_32x32x16_bf16 v[120:135], v[236:239], v[100:103], v[120:135]
v_pk_mul_f16 v148, v149, v148
v_bfe_u32 v138, v139, 2, 14
v_exp_f16 v153, v154
v_lshrrev_b32 v137, 18, v137
v_exp_f16 v150, v151
s_setprio 1
v_lshrrev_b32_e64 v139, 18, v139
ds_read_b128 v[236:239], v248 offset:58368
ds_read_u16_d16 v138, v138
ds_read_u16_d16_hi v137, v137
ds_read_u16_d16_hi v139, v139
v_mfma_f32_32x32x16_bf16 v[120:135], v[224:227], v[104:107], v[120:135]
v_exp_f16 v147, v148
v_and_b32 v141, s49, v141
v_and_b32_e64 v143, s49, v143
v_exp_f16_sdwa v153, v154 dst_sel:WORD_1 dst_unused:UNUSED_PRESERVE src0_sel:WORD_1
v_bfe_u32 v140, v141, 2, 14
v_exp_f16_sdwa v150, v151 dst_sel:WORD_1 dst_unused:UNUSED_PRESERVE src0_sel:WORD_1
s_cmp_eq_u32 s77, 0
s_cbranch_scc1 Lpp101
s_getreg_b32 s43, hwreg(HW_REG_IB_STS, 0, 4)
s_cmp_lg_u32 s43, 0
s_cbranch_scc1 Lpp101
s_call_b64 s[78:79], Lpoll
s_setprio 1
Lpp101:
s_waitcnt lgkmcnt(4)
ds_read_b128 v[224:227], v248 offset:59392
ds_read_u16_d16 v140, v140
v_mfma_f32_32x32x16_bf16 v[120:135], v[228:231], v[108:111], v[120:135]
v_bfe_u32 v142, v143, 2, 14
v_exp_f16_sdwa v147, v148 dst_sel:WORD_1 dst_unused:UNUSED_PRESERVE src0_sel:WORD_1
v_lshrrev_b32_e64 v141, 18, v141
v_pk_add_f16 v153, v153, 1.0 op_sel_hi:[1,0]
v_lshrrev_b32_e64 v143, 18, v143
v_pk_add_f16 v150, v150, 1.0 op_sel_hi:[1,0]
v_pk_add_f16 v147, v147, 1.0 op_sel_hi:[1,0]
ds_read_b128 v[228:231], v248 offset:62464
ds_read_u16_d16 v142, v142
ds_read_u16_d16_hi v141, v141
ds_read_u16_d16_hi v143, v143
v_mfma_f32_32x32x16_bf16 v[120:135], v[232:235], v[112:115], v[120:135]
v_and_b32 v145, s49, v145
v_rcp_f16 v154, v153
v_bfe_u32 v144, v145, 2, 14
v_rcp_f16_e64 v151, v150
v_lshrrev_b32 v145, 18, v145
s_waitcnt lgkmcnt(6)
ds_read_b128 v[232:235], v248 offset:60416
ds_read_u16_d16 v144, v144
ds_read_u16_d16_hi v145, v145
v_mfma_f32_32x32x16_bf16 v[120:135], v[236:239], v[116:119], v[120:135]
v_rcp_f16 v148, v147
v_or_b32 v168, v136, v137
v_or_b32_e64 v169, v138, v139
v_rcp_f16_sdwa v154, v153 dst_sel:WORD_1 dst_unused:UNUSED_PRESERVE src0_sel:WORD_1
s_waitcnt lgkmcnt(4)
v_or_b32 v170, v140, v141
v_rcp_f16_sdwa v151, v150 dst_sel:WORD_1 dst_unused:UNUSED_PRESERVE src0_sel:WORD_1
s_waitcnt lgkmcnt(3)
v_or_b32 v171, v142, v143
v_rcp_f16_sdwa v148, v147 dst_sel:WORD_1 dst_unused:UNUSED_PRESERVE src0_sel:WORD_1
s_waitcnt lgkmcnt(0)
v_or_b32_e64 v172, v144, v145
v_pk_mul_f16 v173, v155, v154
v_pk_mul_f16 v174, v152, v151
v_pk_mul_f16 v175, v149, v148
s_cmp_eq_u32 s77, 0
s_cbranch_scc1 Lpp1
s_getreg_b32 s43, hwreg(HW_REG_IB_STS, 0, 4)
s_cmp_lg_u32 s43, 0
s_cbranch_scc1 Lpp1
s_call_b64 s[78:79], Lpoll
s_setprio 1
Lpp1:
v_cvt_pkrtz_f16_f32 v137, v120, v121
v_cvt_pkrtz_f16_f32 v139, v122, v123
v_cvt_pkrtz_f16_f32 v141, v124, v125
v_cvt_pkrtz_f16_f32 v143, v126, v127
v_cvt_pkrtz_f16_f32 v145, v128, v129
v_cvt_pk_f16_f32 v155, v130, v131
v_cvt_pk_f16_f32 v152, v132, v133
v_cvt_pk_f16_f32 v149, v134, v135
ds_read_b128 v[236:239], v248 offset:63488
v_mfma_f32_32x32x16_bf16 v[120:135], v[224:227], v[96:99], 0
v_pk_fma_f16 v154, v155, v155, s48
v_permlane16_swap_b32 v168, v172
v_and_b32 v137, s49, v137
v_pk_fma_f16 v151, v152, v152, s48
v_and_b32_e64 v139, s49, v139
v_pk_fma_f16 v148, v149, v149, s48
v_pk_mul_f16 v154, v155, v154
v_bfe_u32 v136, v137, 2, 14
v_pk_mul_f16 v151, v152, v151
ds_read_b128 v[224:227], v248 offset:61440
ds_read_u16_d16 v136, v136
v_mfma_f32_32x32x16_bf16 v[120:135], v[228:231], v[100:103], v[120:135]
v_pk_mul_f16 v148, v149, v148
v_bfe_u32 v138, v139, 2, 14
v_exp_f16 v153, v154
v_lshrrev_b32 v137, 18, v137
v_exp_f16 v150, v151
v_permlane16_swap_b32 v169, v173
v_lshrrev_b32_e64 v139, 18, v139
ds_read_b128 v[228:231], v248 offset:64512
ds_read_u16_d16 v138, v138
ds_read_u16_d16_hi v137, v137
ds_read_u16_d16_hi v139, v139
v_mfma_f32_32x32x16_bf16 v[120:135], v[232:235], v[104:107], v[120:135]
v_exp_f16 v147, v148
s_setprio 0
v_and_b32 v141, s49, v141
v_and_b32 v143, s49, v143
v_exp_f16_sdwa v153, v154 dst_sel:WORD_1 dst_unused:UNUSED_PRESERVE src0_sel:WORD_1
v_bfe_u32 v140, v141, 2, 14
v_exp_f16_sdwa v150, v151 dst_sel:WORD_1 dst_unused:UNUSED_PRESERVE src0_sel:WORD_1
s_cmp_eq_u32 s77, 0
s_cbranch_scc1 Lpp102
s_getreg_b32 s43, hwreg(HW_REG_IB_STS, 0, 4)
s_cmp_lg_u32 s43, 0
s_cbranch_scc1 Lpp102
s_call_b64 s[78:79], Lpoll
s_setprio 0
Lpp102:
s_waitcnt lgkmcnt(4)
ds_read_b128 v[232:235], v249
ds_read_u16_d16 v140, v140
v_mfma_f32_32x32x16_bf16 v[120:135], v[236:239], v[108:111], v[120:135]
v_bfe_u32 v142, v143, 2, 14
v_exp_f16_sdwa v147, v148 dst_sel:WORD_1 dst_unused:UNUSED_PRESERVE src0_sel:WORD_1
v_lshrrev_b32 v141, 18, v141
v_permlane16_swap_b32 v170, v174
v_pk_add_f16 v153, v153, 1.0 op_sel_hi:[1,0]
v_lshrrev_b32_e64 v143, 18, v143
v_pk_add_f16 v150, v150, 1.0 op_sel_hi:[1,0]
v_pk_add_f16 v147, v147, 1.0 op_sel_hi:[1,0]
ds_read_b128 v[236:239], v249 offset:3072
ds_read_u16_d16 v142, v142
ds_read_u16_d16_hi v141, v141
ds_read_u16_d16_hi v143, v143
v_mfma_f32_32x32x16_bf16 v[120:135], v[224:227], v[112:115], v[120:135]
v_and_b32 v145, s49, v145
v_rcp_f16 v154, v153
v_bfe_u32 v144, v145, 2, 14
v_rcp_f16 v151, v150
v_lshrrev_b32 v145, 18, v145
v_rcp_f16 v148, v147
s_waitcnt lgkmcnt(6)
ds_read_b128 v[224:227], v249 offset:1024
ds_read_u16_d16 v144, v144
ds_read_u16_d16_hi v145, v145
v_mfma_f32_32x32x16_bf16 v[120:135], v[228:231], v[116:119], v[120:135]
v_or_b32 v176, v136, v137
v_permlane16_swap_b32 v171, v175
v_or_b32_e64 v177, v138, v139
v_rcp_f16_sdwa v154, v153 dst_sel:WORD_1 dst_unused:UNUSED_PRESERVE src0_sel:WORD_1
s_waitcnt lgkmcnt(4)
v_or_b32 v178, v140, v141
v_rcp_f16_sdwa v151, v150 dst_sel:WORD_1 dst_unused:UNUSED_PRESERVE src0_sel:WORD_1
s_waitcnt lgkmcnt(3)
v_or_b32 v179, v142, v143
v_rcp_f16_sdwa v148, v147 dst_sel:WORD_1 dst_unused:UNUSED_PRESERVE src0_sel:WORD_1
s_waitcnt lgkmcnt(0)
v_or_b32 v180, v144, v145
v_pk_mul_f16 v181, v155, v154
v_pk_mul_f16 v182, v152, v151
v_pk_mul_f16 v183, v149, v148
s_cmp_eq_u32 s77, 0
s_cbranch_scc1 Lpp2
s_getreg_b32 s43, hwreg(HW_REG_IB_STS, 0, 4)
s_cmp_lg_u32 s43, 0
s_cbranch_scc1 Lpp2
s_call_b64 s[78:79], Lpoll
s_setprio 0
Lpp2:
s_setprio 2
v_cvt_pkrtz_f16_f32 v137, v120, v121
v_cvt_pkrtz_f16_f32 v139, v122, v123
v_cvt_pkrtz_f16_f32 v141, v124, v125
v_cvt_pkrtz_f16_f32 v143, v126, v127
v_cvt_pkrtz_f16_f32 v145, v128, v129
v_cvt_pk_f16_f32 v155, v130, v131
v_cvt_pk_f16_f32 v152, v132, v133
v_cvt_pk_f16_f32 v149, v134, v135
ds_read_b128 v[228:231], v249 offset:4096
v_mfma_f32_32x32x16_bf16 v[120:135], v[232:235], v[96:99], 0
v_pk_fma_f16 v154, v155, v155, s48
v_permlane16_swap_b32 v176, v180
v_and_b32 v137, s49, v137
v_pk_fma_f16 v151, v152, v152, s48
v_and_b32_e64 v139, s49, v139
v_pk_fma_f16 v148, v149, v149, s48
v_pk_mul_f16 v154, v155, v154
v_bfe_u32 v136, v137, 2, 14
v_pk_mul_f16 v151, v152, v151
ds_read_b128 v[232:235], v249 offset:2048
ds_read_u16_d16 v136, v136
v_mfma_f32_32x32x16_bf16 v[120:135], v[236:239], v[100:103], v[120:135]
v_pk_mul_f16 v148, v149, v148
v_bfe_u32 v138, v139, 2, 14
v_exp_f16 v153, v154
v_lshrrev_b32 v137, 18, v137
v_exp_f16 v150, v151
v_permlane16_swap_b32 v177, v181
v_lshrrev_b32_e64 v139, 18, v139
ds_read_b128 v[236:239], v249 offset:5120
ds_read_u16_d16 v138, v138
ds_read_u16_d16_hi v137, v137
ds_read_u16_d16_hi v139, v139
v_mfma_f32_32x32x16_bf16 v[120:135], v[224:227], v[104:107], v[120:135]
v_exp_f16 v147, v148
v_and_b32 v141, s49, v141
v_and_b32_e64 v143, s49, v143
v_exp_f16_sdwa v153, v154 dst_sel:WORD_1 dst_unused:UNUSED_PRESERVE src0_sel:WORD_1
v_bfe_u32 v140, v141, 2, 14
v_exp_f16_sdwa v150, v151 dst_sel:WORD_1 dst_unused:UNUSED_PRESERVE src0_sel:WORD_1
s_cmp_eq_u32 s77, 0
s_cbranch_scc1 Lpp103
s_getreg_b32 s43, hwreg(HW_REG_IB_STS, 0, 4)
s_cmp_lg_u32 s43, 0
s_cbranch_scc1 Lpp103
s_call_b64 s[78:79], Lpoll
s_setprio 2
Lpp103:
s_waitcnt lgkmcnt(4)
ds_read_b128 v[224:227], v249 offset:6144
ds_read_u16_d16 v140, v140
v_mfma_f32_32x32x16_bf16 v[120:135], v[228:231], v[108:111], v[120:135]
v_bfe_u32 v142, v143, 2, 14
v_exp_f16_sdwa v147, v148 dst_sel:WORD_1 dst_unused:UNUSED_PRESERVE src0_sel:WORD_1
v_lshrrev_b32 v141, 18, v141
v_permlane16_swap_b32 v178, v182
v_pk_add_f16 v153, v153, 1.0 op_sel_hi:[1,0]
v_lshrrev_b32_e64 v143, 18, v143
v_pk_add_f16 v150, v150, 1.0 op_sel_hi:[1,0]
v_pk_add_f16 v147, v147, 1.0 op_sel_hi:[1,0]
ds_read_b128 v[228:231], v249 offset:9216
ds_read_u16_d16 v142, v142
ds_read_u16_d16_hi v141, v141
ds_read_u16_d16_hi v143, v143
v_mfma_f32_32x32x16_bf16 v[120:135], v[232:235], v[112:115], v[120:135]
v_and_b32 v145, s49, v145
v_rcp_f16 v154, v153
v_bfe_u32 v144, v145, 2, 14
v_rcp_f16 v151, v150
v_lshrrev_b32 v145, 18, v145
v_rcp_f16 v148, v147
s_waitcnt lgkmcnt(6)
ds_read_b128 v[232:235], v249 offset:7168
ds_read_u16_d16 v144, v144
ds_read_u16_d16_hi v145, v145
v_mfma_f32_32x32x16_bf16 v[120:135], v[236:239], v[116:119], v[120:135]
v_or_b32 v184, v136, v137
v_permlane16_swap_b32 v179, v183
v_or_b32_e64 v185, v138, v139
v_rcp_f16_sdwa v154, v153 dst_sel:WORD_1 dst_unused:UNUSED_PRESERVE src0_sel:WORD_1
s_waitcnt lgkmcnt(4)
v_or_b32 v186, v140, v141
v_rcp_f16_sdwa v151, v150 dst_sel:WORD_1 dst_unused:UNUSED_PRESERVE src0_sel:WORD_1
s_waitcnt lgkmcnt(3)
v_or_b32 v187, v142, v143
v_rcp_f16_sdwa v148, v147 dst_sel:WORD_1 dst_unused:UNUSED_PRESERVE src0_sel:WORD_1
s_waitcnt lgkmcnt(0)
v_or_b32_e64 v188, v144, v145
v_pk_mul_f16 v189, v155, v154
v_pk_mul_f16 v190, v152, v151
v_pk_mul_f16 v191, v149, v148
s_cmp_eq_u32 s77, 0
s_cbranch_scc1 Lpp3
s_getreg_b32 s43, hwreg(HW_REG_IB_STS, 0, 4)
s_cmp_lg_u32 s43, 0
s_cbranch_scc1 Lpp3
s_call_b64 s[78:79], Lpoll
s_setprio 2
Lpp3:
v_cvt_pkrtz_f16_f32 v137, v120, v121
v_cvt_pkrtz_f16_f32 v139, v122, v123
v_cvt_pkrtz_f16_f32 v141, v124, v125
v_cvt_pkrtz_f16_f32 v143, v126, v127
v_cvt_pkrtz_f16_f32 v145, v128, v129
v_cvt_pk_f16_f32 v155, v130, v131
v_cvt_pk_f16_f32 v152, v132, v133
v_cvt_pk_f16_f32 v149, v134, v135
ds_read_b128 v[236:239], v249 offset:10240
v_mfma_f32_32x32x16_bf16 v[120:135], v[224:227], v[96:99], 0
v_pk_fma_f16 v154, v155, v155, s48
v_permlane16_swap_b32 v184, v188
v_and_b32 v137, s49, v137
v_pk_fma_f16 v151, v152, v152, s48
v_and_b32_e64 v139, s49, v139
v_pk_fma_f16 v148, v149, v149, s48
v_pk_mul_f16 v154, v155, v154
v_bfe_u32 v136, v137, 2, 14
v_pk_mul_f16 v151, v152, v151
ds_read_b128 v[224:227], v249 offset:8192
ds_read_u16_d16 v136, v136
v_mfma_f32_32x32x16_bf16 v[120:135], v[228:231], v[100:103], v[120:135]
v_pk_mul_f16 v148, v149, v148
v_bfe_u32 v138, v139, 2, 14
v_exp_f16 v153, v154
v_lshrrev_b32 v137, 18, v137
v_exp_f16 v150, v151
s_setprio 1
v_permlane16_swap_b32 v185, v189
v_lshrrev_b32 v139, 18, v139
ds_read_b128 v[228:231], v249 offset:11264
ds_read_u16_d16 v138, v138
ds_read_u16_d16_hi v137, v137
ds_read_u16_d16_hi v139, v139
v_mfma_f32_32x32x16_bf16 v[120:135], v[232:235], v[104:107], v[120:135]
v_exp_f16 v147, v148
v_and_b32 v141, s49, v141
v_and_b32_e64 v143, s49, v143
v_exp_f16_sdwa v153, v154 dst_sel:WORD_1 dst_unused:UNUSED_PRESERVE src0_sel:WORD_1
v_bfe_u32 v140, v141, 2, 14
v_exp_f16_sdwa v150, v151 dst_sel:WORD_1 dst_unused:UNUSED_PRESERVE src0_sel:WORD_1
s_cmp_eq_u32 s77, 0
s_cbranch_scc1 Lpp104
s_getreg_b32 s43, hwreg(HW_REG_IB_STS, 0, 4)
s_cmp_lg_u32 s43, 0
s_cbranch_scc1 Lpp104
s_call_b64 s[78:79], Lpoll
s_setprio 1
Lpp104:
s_waitcnt lgkmcnt(4)
ds_read_b128 v[232:235], v249 offset:12288
ds_read_u16_d16 v140, v140
v_mfma_f32_32x32x16_bf16 v[120:135], v[236:239], v[108:111], v[120:135]
v_bfe_u32 v142, v143, 2, 14
v_exp_f16_sdwa v147, v148 dst_sel:WORD_1 dst_unused:UNUSED_PRESERVE src0_sel:WORD_1
v_lshrrev_b32 v141, 18, v141
v_permlane16_swap_b32 v186, v190
v_pk_add_f16 v153, v153, 1.0 op_sel_hi:[1,0]
v_lshrrev_b32_e64 v143, 18, v143
v_pk_add_f16 v150, v150, 1.0 op_sel_hi:[1,0]
v_pk_add_f16 v147, v147, 1.0 op_sel_hi:[1,0]
ds_read_b128 v[236:239], v249 offset:15360
ds_read_u16_d16 v142, v142
ds_read_u16_d16_hi v141, v141
ds_read_u16_d16_hi v143, v143
v_mfma_f32_32x32x16_bf16 v[120:135], v[224:227], v[112:115], v[120:135]
v_and_b32 v145, s49, v145
v_rcp_f16 v154, v153
v_bfe_u32 v144, v145, 2, 14
v_rcp_f16 v151, v150
v_lshrrev_b32 v145, 18, v145
v_rcp_f16 v148, v147
s_waitcnt lgkmcnt(6)
ds_read_b128 v[224:227], v249 offset:13312
ds_read_u16_d16 v144, v144
ds_read_u16_d16_hi v145, v145
v_mfma_f32_32x32x16_bf16 v[120:135], v[228:231], v[116:119], v[120:135]
v_or_b32 v192, v136, v137
v_permlane16_swap_b32 v187, v191
v_or_b32_e64 v193, v138, v139
v_rcp_f16_sdwa v154, v153 dst_sel:WORD_1 dst_unused:UNUSED_PRESERVE src0_sel:WORD_1
s_waitcnt lgkmcnt(4)
v_or_b32 v194, v140, v141
v_rcp_f16_sdwa v151, v150 dst_sel:WORD_1 dst_unused:UNUSED_PRESERVE src0_sel:WORD_1
s_waitcnt lgkmcnt(3)
v_or_b32 v195, v142, v143
v_rcp_f16_sdwa v148, v147 dst_sel:WORD_1 dst_unused:UNUSED_PRESERVE src0_sel:WORD_1
s_waitcnt lgkmcnt(0)
v_or_b32 v196, v144, v145
v_pk_mul_f16 v197, v155, v154
v_pk_mul_f16 v198, v152, v151
v_pk_mul_f16 v199, v149, v148
s_cmp_eq_u32 s77, 0
s_cbranch_scc1 Lpp4
s_getreg_b32 s43, hwreg(HW_REG_IB_STS, 0, 4)
s_cmp_lg_u32 s43, 0
s_cbranch_scc1 Lpp4
s_call_b64 s[78:79], Lpoll
s_setprio 1
Lpp4:
v_mov_b32 v253, 16256
Lw2w:
ds_read_b32 v254, v253 offset:4
s_waitcnt lgkmcnt(0)
v_readfirstlane_b32 s43, v254
s_cmp_eq_u32 s76, 0
s_cbranch_scc1 Lw2x
s_sub_u32 s76, s76, 1
s_cmp_lt_u32 s43, 1
s_cbranch_scc0 Lw2x
s_sleep 2
s_branch Lw2w
Lw2x:
s_add_u32 m0, s72, 7168
s_add_u32 s43, s82, 6208
buffer_load_dwordx4 v252, s[16:19], s43 offen lds
s_add_u32 m0, s72, 8192
s_add_u32 s43, s82, 6272
buffer_load_dwordx4 v252, s[16:19], s43 offen lds
v_cvt_pkrtz_f16_f32 v137, v120, v121
v_cvt_pkrtz_f16_f32 v139, v122, v123
v_cvt_pkrtz_f16_f32 v141, v124, v125
v_cvt_pkrtz_f16_f32 v143, v126, v127
v_cvt_pkrtz_f16_f32 v145, v128, v129
v_cvt_pk_f16_f32 v155, v130, v131
v_cvt_pk_f16_f32 v152, v132, v133
v_cvt_pk_f16_f32 v149, v134, v135
ds_read_b128 v[228:231], v249 offset:16384
v_mfma_f32_32x32x16_bf16 v[120:135], v[232:235], v[96:99], 0
v_pk_fma_f16 v154, v155, v155, s48
v_permlane16_swap_b32 v192, v196
v_and_b32 v137, s49, v137
v_pk_fma_f16 v151, v152, v152, s48
v_and_b32_e64 v139, s49, v139
v_pk_fma_f16 v148, v149, v149, s48
v_pk_mul_f16 v154, v155, v154
v_bfe_u32 v136, v137, 2, 14
v_pk_mul_f16 v151, v152, v151
ds_read_b128 v[232:235], v249 offset:14336
ds_read_u16_d16 v136, v136
v_mfma_f32_32x32x16_bf16 v[120:135], v[236:239], v[100:103], v[120:135]
v_pk_mul_f16 v148, v149, v148
v_bfe_u32 v138, v139, 2, 14
v_exp_f16 v153, v154
v_lshrrev_b32 v137, 18, v137
v_exp_f16 v150, v151
v_permlane16_swap_b32 v193, v197
v_lshrrev_b32_e64 v139, 18, v139
ds_read_b128 v[236:239], v249 offset:17408
ds_read_u16_d16 v138, v138
ds_read_u16_d16_hi v137, v137
ds_read_u16_d16_hi v139, v139
v_mfma_f32_32x32x16_bf16 v[120:135], v[224:227], v[104:107], v[120:135]
v_exp_f16 v147, v148
s_setprio 0
v_and_b32 v141, s49, v141
v_and_b32 v143, s49, v143
v_exp_f16_sdwa v153, v154 dst_sel:WORD_1 dst_unused:UNUSED_PRESERVE src0_sel:WORD_1
v_bfe_u32 v140, v141, 2, 14
v_exp_f16_sdwa v150, v151 dst_sel:WORD_1 dst_unused:UNUSED_PRESERVE src0_sel:WORD_1
s_cmp_eq_u32 s77, 0
s_cbranch_scc1 Lpp105
s_getreg_b32 s43, hwreg(HW_REG_IB_STS, 0, 4)
s_cmp_lg_u32 s43, 0
s_cbranch_scc1 Lpp105
s_call_b64 s[78:79], Lpoll
s_setprio 0
Lpp105:
s_waitcnt lgkmcnt(4)
ds_read_b128 v[224:227], v249 offset:18432
ds_read_u16_d16 v140, v140
v_mfma_f32_32x32x16_bf16 v[120:135], v[228:231], v[108:111], v[120:135]
v_bfe_u32 v142, v143, 2, 14
v_exp_f16_sdwa v147, v148 dst_sel:WORD_1 dst_unused:UNUSED_PRESERVE src0_sel:WORD_1
v_lshrrev_b32 v141, 18, v141
v_permlane16_swap_b32 v194, v198
v_pk_add_f16 v153, v153, 1.0 op_sel_hi:[1,0]
v_lshrrev_b32_e64 v143, 18, v143
v_pk_add_f16 v150, v150, 1.0 op_sel_hi:[1,0]
v_pk_add_f16 v147, v147, 1.0 op_sel_hi:[1,0]
ds_read_b128 v[228:231], v249 offset:21504
ds_read_u16_d16 v142, v142
ds_read_u16_d16_hi v141, v141
ds_read_u16_d16_hi v143, v143
v_mfma_f32_32x32x16_bf16 v[120:135], v[232:235], v[112:115], v[120:135]
v_and_b32 v145, s49, v145
v_rcp_f16 v154, v153
v_bfe_u32 v144, v145, 2, 14
v_rcp_f16 v151, v150
v_lshrrev_b32 v145, 18, v145
v_rcp_f16 v148, v147
s_waitcnt lgkmcnt(6)
ds_read_b128 v[232:235], v249 offset:19456
ds_read_u16_d16 v144, v144
ds_read_u16_d16_hi v145, v145
v_mfma_f32_32x32x16_bf16 v[120:135], v[236:239], v[116:119], v[120:135]
v_or_b32 v200, v136, v137
v_permlane16_swap_b32 v195, v199
v_or_b32_e64 v201, v138, v139
v_rcp_f16_sdwa v154, v153 dst_sel:WORD_1 dst_unused:UNUSED_PRESERVE src0_sel:WORD_1
s_waitcnt lgkmcnt(4)
v_or_b32 v202, v140, v141
v_rcp_f16_sdwa v151, v150 dst_sel:WORD_1 dst_unused:UNUSED_PRESERVE src0_sel:WORD_1
s_waitcnt lgkmcnt(3)
v_or_b32 v203, v142, v143
v_rcp_f16_sdwa v148, v147 dst_sel:WORD_1 dst_unused:UNUSED_PRESERVE src0_sel:WORD_1
s_waitcnt lgkmcnt(0)
v_or_b32 v204, v144, v145
v_pk_mul_f16 v205, v155, v154
v_pk_mul_f16 v206, v152, v151
v_pk_mul_f16 v207, v149, v148
s_cmp_eq_u32 s77, 0
s_cbranch_scc1 Lpp5
s_getreg_b32 s43, hwreg(HW_REG_IB_STS, 0, 4)
s_cmp_lg_u32 s43, 0
s_cbranch_scc1 Lpp5
s_call_b64 s[78:79], Lpoll
s_setprio 0
Lpp5:
s_setprio 2
v_cvt_pkrtz_f16_f32 v137, v120, v121
v_cvt_pkrtz_f16_f32 v139, v122, v123
v_cvt_pkrtz_f16_f32 v141, v124, v125
v_cvt_pkrtz_f16_f32 v143, v126, v127
v_cvt_pkrtz_f16_f32 v145, v128, v129
v_cvt_pk_f16_f32 v155, v130, v131
v_cvt_pk_f16_f32 v152, v132, v133
v_cvt_pk_f16_f32 v149, v134, v135
ds_read_b128 v[236:239], v249 offset:22528
v_mfma_f32_32x32x16_bf16 v[120:135], v[224:227], v[96:99], 0
v_pk_fma_f16 v154, v155, v155, s48
v_permlane16_swap_b32 v200, v204
v_and_b32 v137, s49, v137
v_pk_fma_f16 v151, v152, v152, s48
v_and_b32_e64 v139, s49, v139
v_pk_fma_f16 v148, v149, v149, s48
v_pk_mul_f16 v154, v155, v154
v_bfe_u32 v136, v137, 2, 14
v_pk_mul_f16 v151, v152, v151
ds_read_b128 v[224:227], v249 offset:20480
ds_read_u16_d16 v136, v136
v_mfma_f32_32x32x16_bf16 v[120:135], v[228:231], v[100:103], v[120:135]
v_pk_mul_f16 v148, v149, v148
v_bfe_u32 v138, v139, 2, 14
v_exp_f16 v153, v154
v_lshrrev_b32 v137, 18, v137
v_exp_f16 v150, v151
v_permlane16_swap_b32 v201, v205
v_lshrrev_b32_e64 v139, 18, v139
ds_read_b128 v[228:231], v249 offset:23552
ds_read_u16_d16 v138, v138
ds_read_u16_d16_hi v137, v137
ds_read_u16_d16_hi v139, v139
v_mfma_f32_32x32x16_bf16 v[120:135], v[232:235], v[104:107], v[120:135]
v_exp_f16 v147, v148
v_and_b32 v141, s49, v141
v_and_b32_e64 v143, s49, v143
v_exp_f16_sdwa v153, v154 dst_sel:WORD_1 dst_unused:UNUSED_PRESERVE src0_sel:WORD_1
v_bfe_u32 v140, v141, 2, 14
v_exp_f16_sdwa v150, v151 dst_sel:WORD_1 dst_unused:UNUSED_PRESERVE src0_sel:WORD_1
s_cmp_eq_u32 s77, 0
s_cbranch_scc1 Lpp106
s_getreg_b32 s43, hwreg(HW_REG_IB_STS, 0, 4)
s_cmp_lg_u32 s43, 0
s_cbranch_scc1 Lpp106
s_call_b64 s[78:79], Lpoll
s_setprio 2
Lpp106:
s_waitcnt lgkmcnt(4)
ds_read_u16_d16 v140, v140
v_mfma_f32_32x32x16_bf16 v[120:135], v[236:239], v[108:111], v[120:135]
v_bfe_u32 v142, v143, 2, 14
v_exp_f16_sdwa v147, v148 dst_sel:WORD_1 dst_unused:UNUSED_PRESERVE src0_sel:WORD_1
v_lshrrev_b32 v141, 18, v141
v_permlane16_swap_b32 v202, v206
v_pk_add_f16 v153, v153, 1.0 op_sel_hi:[1,0]
v_lshrrev_b32_e64 v143, 18, v143
v_pk_add_f16 v150, v150, 1.0 op_sel_hi:[1,0]
v_pk_add_f16 v147, v147, 1.0 op_sel_hi:[1,0]
ds_read_u16_d16 v142, v142
ds_read_u16_d16_hi v141, v141
ds_read_u16_d16_hi v143, v143
v_mfma_f32_32x32x16_bf16 v[120:135], v[224:227], v[112:115], v[120:135]
v_and_b32 v145, s49, v145
v_rcp_f16 v154, v153
v_bfe_u32 v144, v145, 2, 14
v_rcp_f16 v151, v150
v_lshrrev_b32 v145, 18, v145
v_rcp_f16 v148, v147
s_waitcnt lgkmcnt(4)
ds_read_u16_d16 v144, v144
ds_read_u16_d16_hi v145, v145
v_mfma_f32_32x32x16_bf16 v[120:135], v[228:231], v[116:119], v[120:135]
v_or_b32 v208, v136, v137
v_permlane16_swap_b32 v203, v207
v_or_b32_e64 v209, v138, v139
v_rcp_f16_sdwa v154, v153 dst_sel:WORD_1 dst_unused:UNUSED_PRESERVE src0_sel:WORD_1
s_waitcnt lgkmcnt(3)
v_or_b32 v210, v140, v141
v_rcp_f16_sdwa v151, v150 dst_sel:WORD_1 dst_unused:UNUSED_PRESERVE src0_sel:WORD_1
s_waitcnt lgkmcnt(2)
v_or_b32 v211, v142, v143
v_rcp_f16_sdwa v148, v147 dst_sel:WORD_1 dst_unused:UNUSED_PRESERVE src0_sel:WORD_1
s_waitcnt lgkmcnt(0)
v_or_b32_e64 v212, v144, v145
v_pk_mul_f16 v213, v155, v154
v_pk_mul_f16 v214, v152, v151
v_pk_mul_f16 v215, v149, v148
s_cmp_eq_u32 s77, 0
s_cbranch_scc1 Lpp6
s_getreg_b32 s43, hwreg(HW_REG_IB_STS, 0, 4)
s_cmp_lg_u32 s43, 0
s_cbranch_scc1 Lpp6
s_call_b64 s[78:79], Lpoll
s_setprio 2
Lpp6:
v_cvt_pkrtz_f16_f32 v137, v120, v121
v_cvt_pkrtz_f16_f32 v139, v122, v123
v_cvt_pkrtz_f16_f32 v141, v124, v125
v_cvt_pkrtz_f16_f32 v143, v126, v127
v_cvt_pkrtz_f16_f32 v145, v128, v129
v_cvt_pk_f16_f32 v155, v130, v131
v_cvt_pk_f16_f32 v152, v132, v133
v_cvt_pk_f16_f32 v149, v134, v135
v_pk_fma_f16 v154, v155, v155, s48
v_permlane16_swap_b32 v96, v100
v_permlane16_swap_b32 v208, v212
v_and_b32_e64 v137, s49, v137
v_pk_fma_f16 v151, v152, v152, s48
v_and_b32 v139, s49, v139
v_pk_fma_f16 v148, v149, v149, s48
v_permlane16_swap_b32 v97, v101
v_pk_mul_f16 v154, v155, v154
v_bfe_u32 v136, v137, 2, 14
v_pk_mul_f16 v151, v152, v151
v_pk_mul_f16 v148, v149, v148
v_bfe_u32 v138, v139, 2, 14
v_permlane16_swap_b32 v98, v102
v_exp_f16 v153, v154
v_lshrrev_b32 v137, 18, v137
v_exp_f16 v150, v151
v_permlane16_swap_b32 v99, v103
s_setprio 1
v_permlane16_swap_b32 v209, v213
v_lshrrev_b32 v139, 18, v139
v_exp_f16 v147, v148
v_and_b32 v141, s49, v141
v_permlane16_swap_b32 v104, v108
v_and_b32 v143, s49, v143
ds_read_u16_d16 v136, v136
ds_read_u16_d16 v138, v138
ds_read_u16_d16_hi v137, v137
ds_read_u16_d16_hi v139, v139
v_exp_f16_sdwa v153, v154 dst_sel:WORD_1 dst_unused:UNUSED_PRESERVE src0_sel:WORD_1
v_bfe_u32 v140, v141, 2, 14
v_exp_f16_sdwa v150, v151 dst_sel:WORD_1 dst_unused:UNUSED_PRESERVE src0_sel:WORD_1
s_cmp_eq_u32 s77, 0
s_cbranch_scc1 Lpp107
s_getreg_b32 s43, hwreg(HW_REG_IB_STS, 0, 4)
s_cmp_lg_u32 s43, 0
s_cbranch_scc1 Lpp107
s_call_b64 s[78:79], Lpoll
s_setprio 1
Lpp107:
v_permlane16_swap_b32 v105, v109
v_bfe_u32 v142, v143, 2, 14
v_exp_f16_sdwa v147, v148 dst_sel:WORD_1 dst_unused:UNUSED_PRESERVE src0_sel:WORD_1
v_lshrrev_b32_e64 v141, 18, v141
v_permlane16_swap_b32 v106, v110
v_permlane16_swap_b32 v210, v214
v_pk_add_f16 v153, v153, 1.0 op_sel_hi:[1,0]
v_lshrrev_b32_e64 v143, 18, v143
v_pk_add_f16 v150, v150, 1.0 op_sel_hi:[1,0]
v_pk_add_f16 v147, v147, 1.0 op_sel_hi:[1,0]
v_permlane16_swap_b32 v107, v111
v_and_b32 v145, s49, v145
v_rcp_f16_e64 v154, v153
v_bfe_u32 v144, v145, 2, 14
v_rcp_f16 v151, v150
v_permlane16_swap_b32 v112, v116
v_lshrrev_b32_e64 v145, 18, v145
ds_read_u16_d16 v140, v140
ds_read_u16_d16 v142, v142
ds_read_u16_d16_hi v141, v141
ds_read_u16_d16_hi v143, v143
ds_read_u16_d16 v144, v144
ds_read_u16_d16_hi v145, v145
v_rcp_f16 v148, v147
s_waitcnt lgkmcnt(6)
v_or_b32 v216, v136, v137
v_permlane16_swap_b32 v113, v117
v_permlane16_swap_b32 v211, v215
v_or_b32 v217, v138, v139
v_rcp_f16_sdwa v154, v153 dst_sel:WORD_1 dst_unused:UNUSED_PRESERVE src0_sel:WORD_1
s_waitcnt lgkmcnt(3)
v_or_b32 v218, v140, v141
v_permlane16_swap_b32 v114, v118
v_rcp_f16_sdwa v151, v150 dst_sel:WORD_1 dst_unused:UNUSED_PRESERVE src0_sel:WORD_1
s_waitcnt lgkmcnt(2)
v_or_b32_e64 v219, v142, v143
v_rcp_f16_sdwa v148, v147 dst_sel:WORD_1 dst_unused:UNUSED_PRESERVE src0_sel:WORD_1
v_permlane16_swap_b32 v115, v119
s_waitcnt lgkmcnt(0)
v_or_b32_e64 v220, v144, v145
v_pk_mul_f16 v221, v155, v154
v_pk_mul_f16 v222, v152, v151
v_pk_mul_f16 v223, v149, v148
s_cmp_eq_u32 s77, 0
s_cbranch_scc1 Lpp7
s_getreg_b32 s43, hwreg(HW_REG_IB_STS, 0, 4)
s_cmp_lg_u32 s43, 0
s_cbranch_scc1 Lpp7
s_call_b64 s[78:79], Lpoll
s_setprio 1
Lpp7:
v_permlane16_swap_b32 v216, v220
v_permlane16_swap_b32 v217, v221
s_setprio 0
v_permlane16_swap_b32 v218, v222
v_permlane16_swap_b32 v219, v223
s_cmp_eq_u32 s77, 0
s_cbranch_scc1 Lpp8
s_getreg_b32 s43, hwreg(HW_REG_IB_STS, 0, 4)
s_cmp_lg_u32 s43, 0
s_cbranch_scc1 Lpp8
s_call_b64 s[78:79], Lpoll
s_setprio 0
Lpp8:
s_setprio 2
v_lshrrev_b32_e64 v225, 5, v251
v_lshl_add_u32 v224, v225, 9, s72
v_lshl_add_u32 v226, v225, 4, s72
v_and_b32 v225, 15, v251
v_lshl_add_u32 v224, v225, 4, v224
v_bfe_u32 v225, v251, 4, 1
v_lshl_add_u32 v224, v225, 3, v224
s_waitcnt vmcnt(0)
ds_read_b64_tr_b16 v[120:121], v224
ds_read_b64_tr_b16 v[122:123], v224 offset:256
ds_read_b64_tr_b16 v[124:125], v224 offset:1024
ds_read_b64_tr_b16 v[126:127], v224 offset:1280
ds_read_b64_tr_b16 v[128:129], v224 offset:2048
ds_read_b64_tr_b16 v[130:131], v224 offset:2304
ds_read_b64_tr_b16 v[132:133], v224 offset:3072
ds_read_b64_tr_b16 v[134:135], v224 offset:3328
ds_read_b64_tr_b16 v[136:137], v224 offset:4096
ds_read_b64_tr_b16 v[138:139], v224 offset:4352
ds_read_b64_tr_b16 v[140:141], v224 offset:5120
ds_read_b64_tr_b16 v[142:143], v224 offset:5376
ds_read_b64_tr_b16 v[144:145], v224 offset:6144
ds_read_b64_tr_b16 v[146:147], v224 offset:6400
ds_read_b64_tr_b16 v[148:149], v224 offset:7168
ds_read_b64_tr_b16 v[150:151], v224 offset:7424
ds_read_b64_tr_b16 v[152:153], v224 offset:8192
ds_read_b64_tr_b16 v[154:155], v224 offset:8448
v_lshrrev_b32 v225, 4, v251
v_and_b32 v227, 15, v251
v_mul_u32_u24 v252, 192, v227
v_lshl_add_u32 v252, v225, 4, v252
v_lshlrev_b32 v254, 5, v225
v_and_b32 v253, 47, v251
v_lshlrev_b32 v253, 4, v253
v_and_b32 v225, 1, v225
v_mul_u32_u24 v227, 3072, v225
v_add_u32_e64 v248, v227, v253
v_add_u32 v249, 65536, v248
v_add_u32 v250, 131072, v248
v_lshl_add_u32 v253, v225, 21, v253
v_mov_b32 v225, 16256
v_mov_b32_e64 v227, 1
s_waitcnt lgkmcnt(0)
s_mov_b64 exec, 1
ds_add_u32 v225, v227 offset:8
s_mov_b64 exec, -1
v_lshlrev_b32 v228, 16, v120
v_and_b32 v229, 4294901760, v120
v_cvt_pk_f16_f32 v120, v228, v229
v_lshlrev_b32_e64 v230, 16, v121
v_and_b32 v231, 4294901760, v121
v_cvt_pk_f16_f32 v121, v230, v231
v_lshlrev_b32_e64 v228, 16, v122
v_and_b32 v229, 4294901760, v122
v_cvt_pk_f16_f32 v122, v228, v229
v_lshlrev_b32_e64 v230, 16, v123
v_and_b32 v231, 4294901760, v123
v_cvt_pk_f16_f32 v123, v230, v231
v_lshlrev_b32_e64 v228, 16, v124
v_and_b32 v229, 4294901760, v124
v_cvt_pk_f16_f32 v124, v228, v229
v_lshlrev_b32_e64 v230, 16, v125
v_and_b32 v231, 4294901760, v125
v_cvt_pk_f16_f32 v125, v230, v231
v_lshlrev_b32_e64 v228, 16, v126
v_and_b32 v229, 4294901760, v126
v_cvt_pk_f16_f32 v126, v228, v229
v_lshlrev_b32_e64 v230, 16, v127
v_and_b32 v231, 4294901760, v127
v_cvt_pk_f16_f32 v127, v230, v231
v_lshlrev_b32_e64 v228, 16, v128
v_and_b32 v229, 4294901760, v128
v_cvt_pk_f16_f32 v128, v228, v229
v_lshlrev_b32_e64 v230, 16, v129
v_and_b32 v231, 4294901760, v129
v_cvt_pk_f16_f32 v129, v230, v231
v_lshlrev_b32_e64 v228, 16, v130
v_and_b32 v229, 4294901760, v130
v_cvt_pk_f16_f32 v130, v228, v229
v_lshlrev_b32_e64 v230, 16, v131
v_and_b32 v231, 4294901760, v131
v_cvt_pk_f16_f32 v131, v230, v231
s_cmp_eq_u32 s77, 0
s_cbranch_scc1 Lpp911
s_getreg_b32 s43, hwreg(HW_REG_IB_STS, 0, 4)
s_cmp_lg_u32 s43, 0
s_cbranch_scc1 Lpp911
s_call_b64 s[78:79], Lpoll
s_setprio 2
Lpp911:
v_lshlrev_b32 v228, 16, v132
v_and_b32 v229, 4294901760, v132
v_cvt_pk_f16_f32 v132, v228, v229
v_lshlrev_b32_e64 v230, 16, v133
v_and_b32 v231, 4294901760, v133
v_cvt_pk_f16_f32 v133, v230, v231
v_lshlrev_b32_e64 v228, 16, v134
v_and_b32 v229, 4294901760, v134
v_cvt_pk_f16_f32 v134, v228, v229
v_lshlrev_b32_e64 v230, 16, v135
v_and_b32 v231, 4294901760, v135
v_cvt_pk_f16_f32 v135, v230, v231
v_lshlrev_b32_e64 v228, 16, v136
v_and_b32 v229, 4294901760, v136
v_cvt_pk_f16_f32 v136, v228, v229
v_lshlrev_b32_e64 v230, 16, v137
v_and_b32 v231, 4294901760, v137
v_cvt_pk_f16_f32 v137, v230, v231
v_lshlrev_b32_e64 v228, 16, v138
v_and_b32 v229, 4294901760, v138
v_cvt_pk_f16_f32 v138, v228, v229
v_lshlrev_b32_e64 v230, 16, v139
v_and_b32 v231, 4294901760, v139
v_cvt_pk_f16_f32 v139, v230, v231
v_lshlrev_b32_e64 v228, 16, v140
v_and_b32 v229, 4294901760, v140
v_cvt_pk_f16_f32 v140, v228, v229
v_lshlrev_b32_e64 v230, 16, v141
v_and_b32 v231, 4294901760, v141
v_cvt_pk_f16_f32 v141, v230, v231
v_lshlrev_b32_e64 v228, 16, v142
v_and_b32 v229, 4294901760, v142
v_cvt_pk_f16_f32 v142, v228, v229
v_lshlrev_b32_e64 v230, 16, v143
v_and_b32 v231, 4294901760, v143
v_cvt_pk_f16_f32 v143, v230, v231
s_cmp_eq_u32 s77, 0
s_cbranch_scc1 Lpp923
s_getreg_b32 s43, hwreg(HW_REG_IB_STS, 0, 4)
s_cmp_lg_u32 s43, 0
s_cbranch_scc1 Lpp923
s_call_b64 s[78:79], Lpoll
s_setprio 2
Lpp923:
v_lshlrev_b32 v228, 16, v144
v_and_b32 v229, 4294901760, v144
v_cvt_pk_f16_f32 v144, v228, v229
v_lshlrev_b32_e64 v230, 16, v145
v_and_b32 v231, 4294901760, v145
v_cvt_pk_f16_f32 v145, v230, v231
v_lshlrev_b32_e64 v228, 16, v146
v_and_b32 v229, 4294901760, v146
v_cvt_pk_f16_f32 v146, v228, v229
v_lshlrev_b32_e64 v230, 16, v147
v_and_b32 v231, 4294901760, v147
v_cvt_pk_f16_f32 v147, v230, v231
v_lshlrev_b32_e64 v228, 16, v148
v_and_b32 v229, 4294901760, v148
v_cvt_pk_f16_f32 v148, v228, v229
v_lshlrev_b32_e64 v230, 16, v149
v_and_b32 v231, 4294901760, v149
v_cvt_pk_f16_f32 v149, v230, v231
v_lshlrev_b32_e64 v228, 16, v150
v_and_b32 v229, 4294901760, v150
v_cvt_pk_f16_f32 v150, v228, v229
v_lshlrev_b32_e64 v230, 16, v151
v_and_b32 v231, 4294901760, v151
v_cvt_pk_f16_f32 v151, v230, v231
v_lshlrev_b32_e64 v228, 16, v152
v_and_b32 v229, 4294901760, v152
v_cvt_pk_f16_f32 v152, v228, v229
v_lshlrev_b32_e64 v230, 16, v153
v_and_b32 v231, 4294901760, v153
v_cvt_pk_f16_f32 v153, v230, v231
v_lshlrev_b32_e64 v228, 16, v154
v_and_b32 v229, 4294901760, v154
v_cvt_pk_f16_f32 v154, v228, v229
v_lshlrev_b32_e64 v230, 16, v155
v_and_b32 v231, 4294901760, v155
v_cvt_pk_f16_f32 v155, v230, v231
s_cmp_eq_u32 s77, 0
s_cbranch_scc1 Lpp935
s_getreg_b32 s43, hwreg(HW_REG_IB_STS, 0, 4)
s_cmp_lg_u32 s43, 0
s_cbranch_scc1 Lpp935
s_call_b64 s[78:79], Lpoll
s_setprio 2
Lpp935:
v_lshl_add_u32 v224, v251, 4, s72
s_cmp_lg_u32 s40, 0
s_cbranch_scc1 Lnofin
Lspin:
s_cmp_eq_u32 s77, 0
s_cbranch_scc1 Lspinx
s_cmp_eq_u32 s76, 0
s_cbranch_scc1 Lspinx
s_sub_u32 s76, s76, 1
s_call_b64 s[78:79], Lpoll
s_branch Lspin
Lspinx:
v_add_u32_e64 v162, 0, v251
v_mul_u32_u24 v165, 2731, v162
v_lshrrev_b32_e64 v165, 16, v165
v_mul_u32_u24 v165, 9120, v165
v_lshl_add_u32 v162, v162, 2, v165
v_add_u32 v162, 90112, v162
v_add_u32_e64 v163, 64, v251
v_mul_u32_u24 v165, 2731, v163
v_lshrrev_b32_e64 v165, 16, v165
v_mul_u32_u24 v165, 9120, v165
v_lshl_add_u32 v163, v163, 2, v165
v_add_u32 v163, 90112, v163
v_add_u32 v164, 128, v251
v_mul_u32_u24 v165, 2731, v164
v_lshrrev_b32_e64 v165, 16, v165
v_mul_u32_u24 v165, 9120, v165
v_lshl_add_u32 v164, v164, 2, v165
v_add_u32 v164, 90112, v164
v_mov_b32 v165, 16256
Lrrw:
ds_read_b32 v166, v165 offset:8
s_waitcnt lgkmcnt(0)
v_readfirstlane_b32 s43, v166
s_cmp_eq_u32 s76, 0
s_cbranch_scc1 Lrrx
s_sub_u32 s76, s76, 1
s_cmp_lt_u32 s43, 8
s_cbranch_scc0 Lrrx
s_sleep 2
s_branch Lrrw
Lrrx:
ds_write_b32 v162, v244
ds_write_b32 v163, v245
ds_write_b32 v164, v246
Lnofin:
s_waitcnt lgkmcnt(0)
s_barrier
ds_read_b128 v[228:231], v226
ds_read_b128 v[232:235], v226 offset:32
ds_read_b128 v[236:239], v226 offset:64
buffer_load_dwordx4 v[240:243], v252, s[4:7], s71 offen
buffer_load_dwordx4 v[244:247], v252, s[4:7], s71 offen offset:64
s_waitcnt lgkmcnt(0)
v_pk_mul_f16 v120, v120, v228
v_pk_mul_f16 v121, v121, v229
v_pk_mul_f16 v122, v122, v230
v_pk_mul_f16 v123, v123, v231
ds_write_b128 v224, v[120:123]
v_pk_mul_f16 v124, v124, v228
v_pk_mul_f16 v125, v125, v229
v_pk_mul_f16 v126, v126, v230
v_pk_mul_f16 v127, v127, v231
ds_write_b128 v224, v[124:127] offset:1024
v_pk_mul_f16 v128, v128, v228
v_pk_mul_f16 v129, v129, v229
v_pk_mul_f16 v130, v130, v230
v_pk_mul_f16 v131, v131, v231
ds_write_b128 v224, v[128:131] offset:2048
v_pk_mul_f16 v132, v132, v232
v_pk_mul_f16 v133, v133, v233
v_pk_mul_f16 v134, v134, v234
v_pk_mul_f16 v135, v135, v235
ds_write_b128 v224, v[132:135] offset:3072
v_pk_mul_f16 v136, v136, v232
v_pk_mul_f16 v137, v137, v233
v_pk_mul_f16 v138, v138, v234
v_pk_mul_f16 v139, v139, v235
ds_write_b128 v224, v[136:139] offset:4096
v_pk_mul_f16 v140, v140, v232
v_pk_mul_f16 v141, v141, v233
v_pk_mul_f16 v142, v142, v234
v_pk_mul_f16 v143, v143, v235
ds_write_b128 v224, v[140:143] offset:5120
v_pk_mul_f16 v144, v144, v236
v_pk_mul_f16 v145, v145, v237
v_pk_mul_f16 v146, v146, v238
v_pk_mul_f16 v147, v147, v239
ds_write_b128 v224, v[144:147] offset:6144
v_pk_mul_f16 v148, v148, v236
v_pk_mul_f16 v149, v149, v237
v_pk_mul_f16 v150, v150, v238
v_pk_mul_f16 v151, v151, v239
ds_write_b128 v224, v[148:151] offset:7168
v_pk_mul_f16 v152, v152, v236
v_pk_mul_f16 v153, v153, v237
v_pk_mul_f16 v154, v154, v238
v_pk_mul_f16 v155, v155, v239
ds_write_b128 v224, v[152:155] offset:8192
s_waitcnt lgkmcnt(0)
s_barrier
s_setprio 3
ds_read_b128 v[224:227], v249 offset:24576
ds_read_b128 v[228:231], v254 offset:7936
ds_read_b128 v[232:235], v249 offset:24832
ds_read_b128 v[236:239], v254 offset:7952
s_waitcnt lgkmcnt(2)
v_mfma_f32_16x16x32_f16 v[120:123], v[224:227], v[0:3], v[228:231]
v_mfma_f32_16x16x32_f16 v[128:131], v[224:227], v[4:7], v[228:231]
s_waitcnt lgkmcnt(0)
v_mfma_f32_16x16x32_f16 v[124:127], v[232:235], v[0:3], v[236:239]
ds_read_b128 v[224:227], v249 offset:25600
ds_read_b128 v[228:231], v254 offset:8064
v_mfma_f32_16x16x32_f16 v[132:135], v[232:235], v[4:7], v[236:239]
s_waitcnt lgkmcnt(0)
v_mfma_f32_16x16x32_f16 v[136:139], v[224:227], v[0:3], v[228:231]
ds_read_b128 v[232:235], v249 offset:25856
ds_read_b128 v[236:239], v254 offset:8080
v_mfma_f32_16x16x32_f16 v[144:147], v[224:227], v[4:7], v[228:231]
s_waitcnt lgkmcnt(0)
v_mfma_f32_16x16x32_f16 v[140:143], v[232:235], v[0:3], v[236:239]
ds_read_b128 v[224:227], v249 offset:26624
ds_read_b128 v[228:231], v254 offset:16128
v_mfma_f32_16x16x32_f16 v[148:151], v[232:235], v[4:7], v[236:239]
s_waitcnt lgkmcnt(0)
v_mfma_f32_16x16x32_f16 v[152:155], v[224:227], v[0:3], v[228:231]
ds_read_b128 v[232:235], v249 offset:26880
ds_read_b128 v[236:239], v254 offset:16144
v_mfma_f32_16x16x32_f16 v[160:163], v[224:227], v[4:7], v[228:231]
s_waitcnt lgkmcnt(0)
v_mfma_f32_16x16x32_f16 v[156:159], v[232:235], v[0:3], v[236:239]
ds_read_b128 v[224:227], v249 offset:30720
ds_read_b128 v[228:231], v249 offset:30976
v_mfma_f32_16x16x32_f16 v[164:167], v[232:235], v[4:7], v[236:239]
s_waitcnt lgkmcnt(1)
v_mfma_f32_16x16x32_f16 v[120:123], v[224:227], v[8:11], v[120:123]
ds_read_b128 v[232:235], v249 offset:31744
ds_read_b128 v[236:239], v249 offset:32000
v_mfma_f32_16x16x32_f16 v[128:131], v[224:227], v[12:15], v[128:131]
s_waitcnt lgkmcnt(2)
v_mfma_f32_16x16x32_f16 v[124:127], v[228:231], v[8:11], v[124:127]
ds_read_b128 v[224:227], v249 offset:32768
v_mfma_f32_16x16x32_f16 v[132:135], v[228:231], v[12:15], v[132:135]
s_waitcnt lgkmcnt(2)
v_mfma_f32_16x16x32_f16 v[136:139], v[232:235], v[8:11], v[136:139]
ds_read_b128 v[228:231], v249 offset:33024
v_mfma_f32_16x16x32_f16 v[144:147], v[232:235], v[12:15], v[144:147]
s_waitcnt lgkmcnt(2)
v_mfma_f32_16x16x32_f16 v[140:143], v[236:239], v[8:11], v[140:143]
ds_read_b128 v[232:235], v249 offset:36864
v_mfma_f32_16x16x32_f16 v[148:151], v[236:239], v[12:15], v[148:151]
s_waitcnt lgkmcnt(2)
v_mfma_f32_16x16x32_f16 v[152:155], v[224:227], v[8:11], v[152:155]
ds_read_b128 v[236:239], v249 offset:37120
v_mfma_f32_16x16x32_f16 v[160:163], v[224:227], v[12:15], v[160:163]
s_waitcnt lgkmcnt(2)
v_mfma_f32_16x16x32_f16 v[156:159], v[228:231], v[8:11], v[156:159]
ds_read_b128 v[224:227], v249 offset:37888
v_mfma_f32_16x16x32_f16 v[164:167], v[228:231], v[12:15], v[164:167]
s_waitcnt lgkmcnt(2)
v_mfma_f32_16x16x32_f16 v[120:123], v[232:235], v[16:19], v[120:123]
buffer_load_dwordx4 v[12:15], v252, s[4:7], s71 offen offset:128
ds_read_b128 v[228:231], v249 offset:38144
v_mfma_f32_16x16x32_f16 v[128:131], v[232:235], v[20:23], v[128:131]
s_waitcnt lgkmcnt(2)
v_mfma_f32_16x16x32_f16 v[124:127], v[236:239], v[16:19], v[124:127]
ds_read_b128 v[232:235], v249 offset:38912
v_mfma_f32_16x16x32_f16 v[132:135], v[236:239], v[20:23], v[132:135]
s_waitcnt lgkmcnt(2)
v_mfma_f32_16x16x32_f16 v[136:139], v[224:227], v[16:19], v[136:139]
ds_read_b128 v[236:239], v249 offset:39168
v_mfma_f32_16x16x32_f16 v[144:147], v[224:227], v[20:23], v[144:147]
s_waitcnt lgkmcnt(2)
v_mfma_f32_16x16x32_f16 v[140:143], v[228:231], v[16:19], v[140:143]
s_add_u32 s46, s71, 98304
buffer_load_dwordx4 v[8:11], v252, s[4:7], s46 offen
ds_read_b128 v[224:227], v249 offset:43008
v_mfma_f32_16x16x32_f16 v[148:151], v[228:231], v[20:23], v[148:151]
s_waitcnt lgkmcnt(2)
v_mfma_f32_16x16x32_f16 v[152:155], v[232:235], v[16:19], v[152:155]
ds_read_b128 v[228:231], v249 offset:43264
v_mfma_f32_16x16x32_f16 v[160:163], v[232:235], v[20:23], v[160:163]
s_waitcnt lgkmcnt(2)
v_mfma_f32_16x16x32_f16 v[156:159], v[236:239], v[16:19], v[156:159]
ds_read_b128 v[232:235], v249 offset:44032
v_mfma_f32_16x16x32_f16 v[164:167], v[236:239], v[20:23], v[164:167]
s_waitcnt lgkmcnt(2)
v_mfma_f32_16x16x32_f16 v[120:123], v[224:227], v[24:27], v[120:123]
s_add_u32 s46, s71, 98304
buffer_load_dwordx4 v[4:7], v252, s[4:7], s46 offen offset:64
ds_read_b128 v[236:239], v249 offset:44288
v_mfma_f32_16x16x32_f16 v[128:131], v[224:227], v[28:31], v[128:131]
s_waitcnt lgkmcnt(2)
v_mfma_f32_16x16x32_f16 v[124:127], v[228:231], v[24:27], v[124:127]
ds_read_b128 v[224:227], v249 offset:45056
v_mfma_f32_16x16x32_f16 v[132:135], v[228:231], v[28:31], v[132:135]
s_waitcnt lgkmcnt(2)
v_mfma_f32_16x16x32_f16 v[136:139], v[232:235], v[24:27], v[136:139]
ds_read_b128 v[228:231], v249 offset:45312
v_mfma_f32_16x16x32_f16 v[144:147], v[232:235], v[28:31], v[144:147]
s_waitcnt lgkmcnt(2)
v_mfma_f32_16x16x32_f16 v[140:143], v[236:239], v[24:27], v[140:143]
s_add_u32 s46, s71, 98304
buffer_load_dwordx4 v[0:3], v252, s[4:7], s46 offen offset:128
ds_read_b128 v[232:235], v249 offset:49152
v_mfma_f32_16x16x32_f16 v[148:151], v[236:239], v[28:31], v[148:151]
s_waitcnt lgkmcnt(2)
v_mfma_f32_16x16x32_f16 v[152:155], v[224:227], v[24:27], v[152:155]
ds_read_b128 v[236:239], v249 offset:49408
v_mfma_f32_16x16x32_f16 v[160:163], v[224:227], v[28:31], v[160:163]
s_waitcnt lgkmcnt(2)
v_mfma_f32_16x16x32_f16 v[156:159], v[228:231], v[24:27], v[156:159]
ds_read_b128 v[224:227], v249 offset:50176
v_mfma_f32_16x16x32_f16 v[164:167], v[228:231], v[28:31], v[164:167]
s_waitcnt lgkmcnt(2)
v_mfma_f32_16x16x32_f16 v[120:123], v[232:235], v[32:35], v[120:123]
buffer_load_dwordx4 v[24:27], v253, s[32:35], s80 offen
ds_read_b128 v[228:231], v249 offset:50432
v_mfma_f32_16x16x32_f16 v[128:131], v[232:235], v[36:39], v[128:131]
v_and_b32 v16, 1, v251
s_waitcnt lgkmcnt(2)
v_mfma_f32_16x16x32_f16 v[124:127], v[236:239], v[32:35], v[124:127]
ds_read_b128 v[232:235], v249 offset:51200
v_mfma_f32_16x16x32_f16 v[132:135], v[236:239], v[36:39], v[132:135]
v_lshlrev_b32 v16, 4, v16
s_waitcnt lgkmcnt(2)
v_mfma_f32_16x16x32_f16 v[136:139], v[224:227], v[32:35], v[136:139]
ds_read_b128 v[236:239], v249 offset:51456
v_mov_b32 v17, 16256
v_mfma_f32_16x16x32_f16 v[144:147], v[224:227], v[36:39], v[144:147]
s_waitcnt lgkmcnt(2)
v_mfma_f32_16x16x32_f16 v[140:143], v[228:231], v[32:35], v[140:143]
ds_read_b128 v[224:227], v249 offset:55296
v_lshlrev_b32 v16, v16, v17
v_mfma_f32_16x16x32_f16 v[148:151], v[228:231], v[36:39], v[148:151]
v_lshrrev_b32 v17, 2, v251
s_waitcnt lgkmcnt(2)
v_mfma_f32_16x16x32_f16 v[152:155], v[232:235], v[32:35], v[152:155]
ds_read_b128 v[228:231], v249 offset:55552
v_mfma_f32_16x16x32_f16 v[160:163], v[232:235], v[36:39], v[160:163]
v_xor_b32 v17, v17, v251
s_waitcnt lgkmcnt(2)
v_mfma_f32_16x16x32_f16 v[156:159], v[236:239], v[32:35], v[156:159]
ds_read_b128 v[232:235], v249 offset:56320
v_mfma_f32_16x16x32_f16 v[164:167], v[236:239], v[36:39], v[164:167]
v_and_b32 v17, 12, v17
s_waitcnt lgkmcnt(2)
v_mfma_f32_16x16x32_f16 v[120:123], v[224:227], v[40:43], v[120:123]
buffer_load_dwordx4 v[28:31], v253, s[32:35], s80 offen offset:256
ds_read_b128 v[236:239], v249 offset:56576
v_and_b32 v20, 2, v251
v_mfma_f32_16x16x32_f16 v[128:131], v[224:227], v[44:47], v[128:131]
s_waitcnt lgkmcnt(2)
v_mfma_f32_16x16x32_f16 v[124:127], v[228:231], v[40:43], v[124:127]
ds_read_b128 v[224:227], v249 offset:57344
v_or_b32_e64 v17, v17, v20
v_mfma_f32_16x16x32_f16 v[132:135], v[228:231], v[44:47], v[132:135]
v_cmp_eq_u32 vcc, 0, v17
s_nop 1
v_cndmask_b32 v18, 0, v16, vcc
s_waitcnt lgkmcnt(2)
v_mfma_f32_16x16x32_f16 v[136:139], v[232:235], v[40:43], v[136:139]
ds_read_b128 v[228:231], v249 offset:57600
v_mfma_f32_16x16x32_f16 v[144:147], v[232:235], v[44:47], v[144:147]
v_cmp_eq_u32 vcc, 2, v17
s_nop 1
v_cndmask_b32 v19, 0, v16, vcc
s_waitcnt lgkmcnt(2)
v_mfma_f32_16x16x32_f16 v[140:143], v[236:239], v[40:43], v[140:143]
ds_read_b128 v[232:235], v249 offset:61440
v_mfma_f32_16x16x32_f16 v[148:151], v[236:239], v[44:47], v[148:151]
v_mov_b32 v16, 0
s_waitcnt lgkmcnt(2)
v_mfma_f32_16x16x32_f16 v[152:155], v[224:227], v[40:43], v[152:155]
ds_read_b128 v[236:239], v249 offset:61696
v_mov_b32 v17, 0
v_mfma_f32_16x16x32_f16 v[160:163], v[224:227], v[44:47], v[160:163]
s_waitcnt lgkmcnt(2)
v_mfma_f32_16x16x32_f16 v[156:159], v[228:231], v[40:43], v[156:159]
ds_read_b128 v[224:227], v249 offset:62464
v_mov_b32_e64 v20, 0
v_mfma_f32_16x16x32_f16 v[164:167], v[228:231], v[44:47], v[164:167]
v_mov_b32 v21, 0
s_waitcnt lgkmcnt(2)
v_mfma_f32_16x16x32_f16 v[120:123], v[232:235], v[48:51], v[120:123]
s_add_u32 s46, s80, 4194304
buffer_load_dwordx4 v[32:35], v253, s[32:35], s46 offen
ds_read_b128 v[228:231], v249 offset:62720
v_mfma_f32_16x16x32_f16 v[128:131], v[232:235], v[52:55], v[128:131]
s_waitcnt lgkmcnt(2)
v_mfma_f32_16x16x32_f16 v[124:127], v[236:239], v[48:51], v[124:127]
ds_read_b128 v[232:235], v249 offset:63488
v_mfma_f32_16x16x32_f16 v[132:135], v[236:239], v[52:55], v[132:135]
s_waitcnt lgkmcnt(2)
v_mfma_f32_16x16x32_f16 v[136:139], v[224:227], v[48:51], v[136:139]
ds_read_b128 v[236:239], v249 offset:63744
v_mfma_f32_16x16x32_f16 v[144:147], v[224:227], v[52:55], v[144:147]
s_waitcnt lgkmcnt(2)
v_mfma_f32_16x16x32_f16 v[140:143], v[228:231], v[48:51], v[140:143]
ds_read_b128 v[224:227], v250 offset:2048
v_mfma_f32_16x16x32_f16 v[148:151], v[228:231], v[52:55], v[148:151]
s_waitcnt lgkmcnt(2)
v_mfma_f32_16x16x32_f16 v[152:155], v[232:235], v[48:51], v[152:155]
ds_read_b128 v[228:231], v250 offset:2304
v_mfma_f32_16x16x32_f16 v[160:163], v[232:235], v[52:55], v[160:163]
s_waitcnt lgkmcnt(2)
v_mfma_f32_16x16x32_f16 v[156:159], v[236:239], v[48:51], v[156:159]
ds_read_b128 v[232:235], v250 offset:3072
v_mfma_f32_16x16x32_f16 v[164:167], v[236:239], v[52:55], v[164:167]
s_waitcnt lgkmcnt(2)
v_mfma_f32_16x16x32_f16 v[120:123], v[224:227], v[56:59], v[120:123]
ds_read_b128 v[236:239], v250 offset:3328
v_mfma_f32_16x16x32_f16 v[128:131], v[224:227], v[60:63], v[128:131]
s_waitcnt lgkmcnt(2)
v_mfma_f32_16x16x32_f16 v[124:127], v[228:231], v[56:59], v[124:127]
s_add_u32 s46, s80, 4194304
buffer_load_dwordx4 v[36:39], v253, s[32:35], s46 offen offset:256
ds_read_b128 v[224:227], v250 offset:4096
v_mfma_f32_16x16x32_f16 v[132:135], v[228:231], v[60:63], v[132:135]
s_waitcnt lgkmcnt(2)
v_mfma_f32_16x16x32_f16 v[136:139], v[232:235], v[56:59], v[136:139]
ds_read_b128 v[228:231], v250 offset:4352
v_mfma_f32_16x16x32_f16 v[144:147], v[232:235], v[60:63], v[144:147]
s_waitcnt lgkmcnt(2)
v_mfma_f32_16x16x32_f16 v[140:143], v[236:239], v[56:59], v[140:143]
ds_read_b128 v[232:235], v250 offset:8192
v_mfma_f32_16x16x32_f16 v[148:151], v[236:239], v[60:63], v[148:151]
s_waitcnt lgkmcnt(2)
v_mfma_f32_16x16x32_f16 v[152:155], v[224:227], v[56:59], v[152:155]
ds_read_b128 v[236:239], v250 offset:8448
v_mfma_f32_16x16x32_f16 v[160:163], v[224:227], v[60:63], v[160:163]
s_waitcnt lgkmcnt(2)
v_mfma_f32_16x16x32_f16 v[156:159], v[228:231], v[56:59], v[156:159]
ds_read_b128 v[224:227], v250 offset:9216
v_mfma_f32_16x16x32_f16 v[164:167], v[228:231], v[60:63], v[164:167]
s_waitcnt vmcnt(9)
v_mfma_f32_16x16x32_bf16 v[120:123], v[18:21], v[240:243], v[120:123]
ds_read_b128 v[228:231], v250 offset:9472
v_mfma_f32_16x16x32_bf16 v[124:127], v[16:19], v[240:243], v[124:127]
s_waitcnt vmcnt(8)
v_mfma_f32_16x16x32_bf16 v[136:139], v[18:21], v[244:247], v[136:139]
v_mfma_f32_16x16x32_bf16 v[140:143], v[16:19], v[244:247], v[140:143]
s_waitcnt lgkmcnt(3)
v_mfma_f32_16x16x32_f16 v[120:123], v[232:235], v[64:67], v[120:123]
s_add_u32 s46, s80, 8388608
buffer_load_dwordx4 v[40:43], v253, s[32:35], s46 offen
v_mfma_f32_16x16x32_f16 v[128:131], v[232:235], v[68:71], v[128:131]
s_waitcnt lgkmcnt(2)
v_mfma_f32_16x16x32_f16 v[124:127], v[236:239], v[64:67], v[124:127]
ds_read_b128 v[232:235], v250 offset:10240
v_mfma_f32_16x16x32_f16 v[132:135], v[236:239], v[68:71], v[132:135]
s_waitcnt lgkmcnt(2)
v_mfma_f32_16x16x32_f16 v[136:139], v[224:227], v[64:67], v[136:139]
ds_read_b128 v[236:239], v250 offset:10496
v_mfma_f32_16x16x32_f16 v[144:147], v[224:227], v[68:71], v[144:147]
s_waitcnt lgkmcnt(2)
v_mfma_f32_16x16x32_f16 v[140:143], v[228:231], v[64:67], v[140:143]
ds_read_b128 v[224:227], v250 offset:14336
v_mfma_f32_16x16x32_f16 v[148:151], v[228:231], v[68:71], v[148:151]
s_waitcnt lgkmcnt(2)
v_mfma_f32_16x16x32_f16 v[152:155], v[232:235], v[64:67], v[152:155]
ds_read_b128 v[228:231], v250 offset:14592
v_mfma_f32_16x16x32_f16 v[160:163], v[232:235], v[68:71], v[160:163]
s_waitcnt lgkmcnt(2)
v_mfma_f32_16x16x32_f16 v[156:159], v[236:239], v[64:67], v[156:159]
ds_read_b128 v[232:235], v250 offset:15360
v_mfma_f32_16x16x32_f16 v[164:167], v[236:239], v[68:71], v[164:167]
s_waitcnt lgkmcnt(2)
v_mfma_f32_16x16x32_f16 v[120:123], v[224:227], v[72:75], v[120:123]
ds_read_b128 v[236:239], v250 offset:15616
v_mfma_f32_16x16x32_f16 v[128:131], v[224:227], v[76:79], v[128:131]
s_waitcnt lgkmcnt(2)
v_mfma_f32_16x16x32_f16 v[124:127], v[228:231], v[72:75], v[124:127]
s_add_u32 s46, s80, 8388608
buffer_load_dwordx4 v[44:47], v253, s[32:35], s46 offen offset:256
ds_read_b128 v[224:227], v250 offset:16384
v_mfma_f32_16x16x32_f16 v[132:135], v[228:231], v[76:79], v[132:135]
s_waitcnt lgkmcnt(2)
v_mfma_f32_16x16x32_f16 v[136:139], v[232:235], v[72:75], v[136:139]
ds_read_b128 v[228:231], v250 offset:16640
v_mfma_f32_16x16x32_f16 v[144:147], v[232:235], v[76:79], v[144:147]
s_waitcnt lgkmcnt(2)
v_mfma_f32_16x16x32_f16 v[140:143], v[236:239], v[72:75], v[140:143]
ds_read_b128 v[232:235], v250 offset:20480
v_mfma_f32_16x16x32_f16 v[148:151], v[236:239], v[76:79], v[148:151]
s_waitcnt lgkmcnt(2)
v_mfma_f32_16x16x32_f16 v[152:155], v[224:227], v[72:75], v[152:155]
ds_read_b128 v[236:239], v250 offset:20736
v_mfma_f32_16x16x32_f16 v[160:163], v[224:227], v[76:79], v[160:163]
s_waitcnt lgkmcnt(2)
v_mfma_f32_16x16x32_f16 v[156:159], v[228:231], v[72:75], v[156:159]
ds_read_b128 v[224:227], v250 offset:21504
v_mfma_f32_16x16x32_f16 v[164:167], v[228:231], v[76:79], v[164:167]
s_waitcnt vmcnt(9)
v_mfma_f32_16x16x32_bf16 v[152:155], v[18:21], v[12:15], v[152:155]
ds_read_b128 v[228:231], v250 offset:21760
v_mfma_f32_16x16x32_bf16 v[156:159], v[16:19], v[12:15], v[156:159]
s_waitcnt vmcnt(8)
v_mfma_f32_16x16x32_bf16 v[128:131], v[18:21], v[8:11], v[128:131]
v_mfma_f32_16x16x32_bf16 v[132:135], v[16:19], v[8:11], v[132:135]
v_and_b32 v255, 1, v251
v_lshlrev_b32 v255, 7, v255
v_sub_u32 v255, v252, v255
s_mov_b32 s74, 1431655765
s_mov_b32 s75, 1431655765
s_waitcnt lgkmcnt(3)
v_mfma_f32_16x16x32_f16 v[120:123], v[232:235], v[80:83], v[120:123]
buffer_load_dwordx4 v[12:15], v252, s[4:7], s70 offen
v_mfma_f32_16x16x32_f16 v[128:131], v[232:235], v[84:87], v[128:131]
s_waitcnt lgkmcnt(2)
v_mfma_f32_16x16x32_f16 v[124:127], v[236:239], v[80:83], v[124:127]
ds_read_b128 v[232:235], v250 offset:22528
v_mfma_f32_16x16x32_f16 v[132:135], v[236:239], v[84:87], v[132:135]
s_waitcnt lgkmcnt(2)
v_mfma_f32_16x16x32_f16 v[136:139], v[224:227], v[80:83], v[136:139]
ds_read_b128 v[236:239], v250 offset:22784
v_mfma_f32_16x16x32_f16 v[144:147], v[224:227], v[84:87], v[144:147]
s_waitcnt lgkmcnt(2)
v_mfma_f32_16x16x32_f16 v[140:143], v[228:231], v[80:83], v[140:143]
ds_read_b128 v[224:227], v250 offset:26624
v_mfma_f32_16x16x32_f16 v[148:151], v[228:231], v[84:87], v[148:151]
s_waitcnt lgkmcnt(2)
v_mfma_f32_16x16x32_f16 v[152:155], v[232:235], v[80:83], v[152:155]
ds_read_b128 v[228:231], v250 offset:26880
v_mfma_f32_16x16x32_f16 v[160:163], v[232:235], v[84:87], v[160:163]
s_waitcnt lgkmcnt(2)
v_mfma_f32_16x16x32_f16 v[156:159], v[236:239], v[80:83], v[156:159]
ds_read_b128 v[232:235], v250 offset:27648
v_mfma_f32_16x16x32_f16 v[164:167], v[236:239], v[84:87], v[164:167]
s_waitcnt lgkmcnt(2)
v_mfma_f32_16x16x32_f16 v[120:123], v[224:227], v[88:91], v[120:123]
ds_read_b128 v[236:239], v250 offset:27904
v_mfma_f32_16x16x32_f16 v[128:131], v[224:227], v[92:95], v[128:131]
s_waitcnt lgkmcnt(2)
v_mfma_f32_16x16x32_f16 v[124:127], v[228:231], v[88:91], v[124:127]
buffer_load_dwordx4 v[8:11], v252, s[4:7], s70 offen offset:64
ds_read_b128 v[224:227], v250 offset:28672
v_mfma_f32_16x16x32_f16 v[132:135], v[228:231], v[92:95], v[132:135]
s_waitcnt lgkmcnt(2)
v_mfma_f32_16x16x32_f16 v[136:139], v[232:235], v[88:91], v[136:139]
ds_read_b128 v[228:231], v250 offset:28928
v_mfma_f32_16x16x32_f16 v[144:147], v[232:235], v[92:95], v[144:147]
s_waitcnt lgkmcnt(2)
v_mfma_f32_16x16x32_f16 v[140:143], v[236:239], v[88:91], v[140:143]
ds_read_b128 v[232:235], v249 offset:55296
v_mfma_f32_16x16x32_f16 v[148:151], v[236:239], v[92:95], v[148:151]
s_waitcnt lgkmcnt(2)
v_mfma_f32_16x16x32_f16 v[152:155], v[224:227], v[88:91], v[152:155]
ds_read_b128 v[236:239], v254 offset:7936
v_mfma_f32_16x16x32_f16 v[160:163], v[224:227], v[92:95], v[160:163]
s_waitcnt lgkmcnt(2)
v_mfma_f32_16x16x32_f16 v[156:159], v[228:231], v[88:91], v[156:159]
ds_read_b128 v[224:227], v249 offset:55552
v_mfma_f32_16x16x32_f16 v[164:167], v[228:231], v[92:95], v[164:167]
s_waitcnt vmcnt(9)
v_mfma_f32_16x16x32_bf16 v[144:147], v[18:21], v[4:7], v[144:147]
ds_read_b128 v[228:231], v254 offset:7952
v_mfma_f32_16x16x32_bf16 v[148:151], v[16:19], v[4:7], v[148:151]
s_waitcnt vmcnt(8)
v_mfma_f32_16x16x32_bf16 v[160:163], v[18:21], v[0:3], v[160:163]
v_mfma_f32_16x16x32_bf16 v[164:167], v[16:19], v[0:3], v[164:167]
s_waitcnt lgkmcnt(2)
v_mfma_f32_16x16x32_f16 v[48:51], v[232:235], v[168:171], v[236:239]
buffer_load_dwordx4 v[4:7], v252, s[4:7], s70 offen offset:128
v_mfma_f32_16x16x32_f16 v[56:59], v[232:235], v[172:175], v[236:239]
s_waitcnt lgkmcnt(0)
v_mfma_f32_16x16x32_f16 v[52:55], v[224:227], v[168:171], v[228:231]
ds_read_b128 v[232:235], v249 offset:56320
ds_read_b128 v[236:239], v254 offset:8064
v_mfma_f32_16x16x32_f16 v[60:63], v[224:227], v[172:175], v[228:231]
s_waitcnt lgkmcnt(0)
v_mfma_f32_16x16x32_f16 v[64:67], v[232:235], v[168:171], v[236:239]
ds_read_b128 v[224:227], v249 offset:56576
ds_read_b128 v[228:231], v254 offset:8080
v_mfma_f32_16x16x32_f16 v[72:75], v[232:235], v[172:175], v[236:239]
v_cvt_pk_bf16_f32 v136, v136, v137
s_waitcnt lgkmcnt(0)
v_mfma_f32_16x16x32_f16 v[68:71], v[224:227], v[168:171], v[228:231]
ds_read_b128 v[232:235], v249 offset:57344
ds_read_b128 v[236:239], v254 offset:16128
v_cvt_pk_bf16_f32 v137, v138, v139
v_mfma_f32_16x16x32_f16 v[76:79], v[224:227], v[172:175], v[228:231]
v_cvt_pk_bf16_f32 v138, v140, v141
v_cvt_pk_bf16_f32 v139, v142, v143
s_waitcnt lgkmcnt(0)
v_mfma_f32_16x16x32_f16 v[80:83], v[232:235], v[168:171], v[236:239]
ds_read_b128 v[224:227], v249 offset:57600
ds_read_b128 v[228:231], v254 offset:16144
v_cvt_pk_bf16_f32 v120, v120, v121
v_mfma_f32_16x16x32_f16 v[88:91], v[232:235], v[172:175], v[236:239]
v_cvt_pk_bf16_f32 v121, v122, v123
s_waitcnt lgkmcnt(0)
v_mfma_f32_16x16x32_f16 v[84:87], v[224:227], v[168:171], v[228:231]
ds_read_b128 v[232:235], v249 offset:61440
ds_read_b128 v[236:239], v249 offset:61696
v_cvt_pk_bf16_f32 v122, v124, v125
v_mfma_f32_16x16x32_f16 v[92:95], v[224:227], v[172:175], v[228:231]
v_cvt_pk_bf16_f32 v123, v126, v127
v_cvt_pk_bf16_f32 v152, v152, v153
s_waitcnt lgkmcnt(1)
v_mfma_f32_16x16x32_f16 v[48:51], v[232:235], v[176:179], v[48:51]
ds_read_b128 v[224:227], v249 offset:62464
ds_read_b128 v[228:231], v249 offset:62720
v_cvt_pk_bf16_f32 v153, v154, v155
v_mfma_f32_16x16x32_f16 v[56:59], v[232:235], v[180:183], v[56:59]
v_cvt_pk_bf16_f32 v154, v156, v157
s_waitcnt lgkmcnt(2)
v_mfma_f32_16x16x32_f16 v[52:55], v[236:239], v[176:179], v[52:55]
ds_read_b128 v[232:235], v249 offset:63488
v_cvt_pk_bf16_f32 v155, v158, v159
s_mov_b64 vcc, s[74:75]
v_mfma_f32_16x16x32_f16 v[60:63], v[236:239], v[180:183], v[60:63]
v_cndmask_b32 v140, v120, v152, vcc
v_cndmask_b32 v141, v121, v153, vcc
s_waitcnt lgkmcnt(2)
v_mfma_f32_16x16x32_f16 v[64:67], v[224:227], v[176:179], v[64:67]
ds_read_b128 v[236:239], v249 offset:63744
v_cndmask_b32 v142, v122, v154, vcc
v_mfma_f32_16x16x32_f16 v[72:75], v[224:227], v[180:183], v[72:75]
v_cndmask_b32 v143, v123, v155, vcc
s_waitcnt lgkmcnt(2)
v_mfma_f32_16x16x32_f16 v[68:71], v[228:231], v[176:179], v[68:71]
ds_read_b128 v[224:227], v250 offset:2048
v_cndmask_b32_dpp v120, v136, v120, vcc quad_perm:[1,0,3,2] row_mask:0xf bank_mask:0xf
v_mfma_f32_16x16x32_f16 v[76:79], v[228:231], v[180:183], v[76:79]
v_cndmask_b32_dpp v121, v137, v121, vcc quad_perm:[1,0,3,2] row_mask:0xf bank_mask:0xf
v_cndmask_b32_dpp v122, v138, v122, vcc quad_perm:[1,0,3,2] row_mask:0xf bank_mask:0xf
s_waitcnt lgkmcnt(2)
v_mfma_f32_16x16x32_f16 v[80:83], v[232:235], v[176:179], v[80:83]
ds_read_b128 v[228:231], v250 offset:2304
v_cndmask_b32_dpp v123, v139, v123, vcc quad_perm:[1,0,3,2] row_mask:0xf bank_mask:0xf
s_not_b64 vcc, s[74:75]
v_mfma_f32_16x16x32_f16 v[88:91], v[232:235], v[180:183], v[88:91]
v_cndmask_b32_dpp v152, v136, v152, vcc quad_perm:[1,0,3,2] row_mask:0xf bank_mask:0xf
s_waitcnt lgkmcnt(2)
v_mfma_f32_16x16x32_f16 v[84:87], v[236:239], v[176:179], v[84:87]
ds_read_b128 v[232:235], v248 offset:16384
v_cndmask_b32_dpp v153, v137, v153, vcc quad_perm:[1,0,3,2] row_mask:0xf bank_mask:0xf
v_mfma_f32_16x16x32_f16 v[92:95], v[236:239], v[180:183], v[92:95]
v_cndmask_b32_dpp v154, v138, v154, vcc quad_perm:[1,0,3,2] row_mask:0xf bank_mask:0xf
v_cndmask_b32_dpp v155, v139, v155, vcc quad_perm:[1,0,3,2] row_mask:0xf bank_mask:0xf
s_waitcnt lgkmcnt(2)
v_mfma_f32_16x16x32_f16 v[48:51], v[224:227], v[184:187], v[48:51]
s_add_u32 s46, s70, 98304
buffer_load_dwordx4 v[0:3], v252, s[4:7], s46 offen
ds_read_b128 v[236:239], v250 offset:3072
buffer_store_dwordx4 v[120:123], v255, s[8:11], s71 offen sc1
v_mfma_f32_16x16x32_f16 v[56:59], v[224:227], v[188:191], v[56:59]
s_waitcnt lgkmcnt(2)
v_mfma_f32_16x16x32_f16 v[52:55], v[228:231], v[184:187], v[52:55]
ds_read_b128 v[224:227], v250 offset:3328
v_mfma_f32_16x16x32_f16 v[60:63], v[228:231], v[188:191], v[60:63]
s_waitcnt lgkmcnt(2)
v_mfma_f32_16x16x32_bf16 v[168:171], v[232:235], v[96:99], 0
ds_read_b128 v[228:231], v250 offset:4096
v_mfma_f32_16x16x32_bf16 v[176:179], v[232:235], v[100:103], 0
s_waitcnt lgkmcnt(2)
v_mfma_f32_16x16x32_f16 v[64:67], v[236:239], v[184:187], v[64:67]
ds_read_b128 v[232:235], v250 offset:4352
v_mfma_f32_16x16x32_f16 v[72:75], v[236:239], v[188:191], v[72:75]
s_waitcnt lgkmcnt(2)
v_mfma_f32_16x16x32_f16 v[68:71], v[224:227], v[184:187], v[68:71]
ds_read_b128 v[236:239], v248 offset:16640
v_mfma_f32_16x16x32_f16 v[76:79], v[224:227], v[188:191], v[76:79]
s_waitcnt lgkmcnt(2)
v_mfma_f32_16x16x32_f16 v[80:83], v[228:231], v[184:187], v[80:83]
ds_read_b128 v[224:227], v250 offset:8192
v_mfma_f32_16x16x32_f16 v[88:91], v[228:231], v[188:191], v[88:91]
s_waitcnt lgkmcnt(2)
v_mfma_f32_16x16x32_f16 v[84:87], v[232:235], v[184:187], v[84:87]
ds_read_b128 v[228:231], v250 offset:8448
v_mfma_f32_16x16x32_f16 v[92:95], v[232:235], v[188:191], v[92:95]
s_waitcnt lgkmcnt(2)
v_mfma_f32_16x16x32_bf16 v[172:175], v[236:239], v[96:99], 0
ds_read_b128 v[232:235], v250 offset:9216
v_mfma_f32_16x16x32_bf16 v[180:183], v[236:239], v[100:103], 0
s_waitcnt lgkmcnt(2)
v_mfma_f32_16x16x32_f16 v[48:51], v[224:227], v[192:195], v[48:51]
buffer_store_dwordx4 v[140:143], v255, s[8:11], s71 offen offset:128 sc1
ds_read_b128 v[236:239], v250 offset:9472
v_mfma_f32_16x16x32_f16 v[56:59], v[224:227], v[196:199], v[56:59]
s_waitcnt lgkmcnt(2)
v_mfma_f32_16x16x32_f16 v[52:55], v[228:231], v[192:195], v[52:55]
ds_read_b128 v[224:227], v248 offset:17408
v_mfma_f32_16x16x32_f16 v[60:63], v[228:231], v[196:199], v[60:63]
s_waitcnt lgkmcnt(2)
v_mfma_f32_16x16x32_f16 v[64:67], v[232:235], v[192:195], v[64:67]
ds_read_b128 v[228:231], v250 offset:10240
v_mfma_f32_16x16x32_f16 v[72:75], v[232:235], v[196:199], v[72:75]
s_waitcnt lgkmcnt(2)
v_mfma_f32_16x16x32_f16 v[68:71], v[236:239], v[192:195], v[68:71]
ds_read_b128 v[232:235], v250 offset:10496
v_mfma_f32_16x16x32_f16 v[76:79], v[236:239], v[196:199], v[76:79]
s_waitcnt lgkmcnt(2)
v_mfma_f32_16x16x32_bf16 v[168:171], v[224:227], v[104:107], v[168:171]
ds_read_b128 v[236:239], v250 offset:14336
v_mfma_f32_16x16x32_bf16 v[176:179], v[224:227], v[108:111], v[176:179]
s_waitcnt lgkmcnt(2)
v_mfma_f32_16x16x32_f16 v[80:83], v[228:231], v[192:195], v[80:83]
ds_read_b128 v[224:227], v250 offset:14592
v_mfma_f32_16x16x32_f16 v[88:91], v[228:231], v[196:199], v[88:91]
s_waitcnt lgkmcnt(2)
v_mfma_f32_16x16x32_f16 v[84:87], v[232:235], v[192:195], v[84:87]
ds_read_b128 v[228:231], v248 offset:17664
v_mfma_f32_16x16x32_f16 v[92:95], v[232:235], v[196:199], v[92:95]
s_waitcnt lgkmcnt(2)
v_mfma_f32_16x16x32_f16 v[48:51], v[236:239], v[200:203], v[48:51]
s_add_u32 s46, s70, 98304
buffer_load_dwordx4 v[244:247], v252, s[4:7], s46 offen offset:64
ds_read_b128 v[232:235], v250 offset:15360
v_mfma_f32_16x16x32_f16 v[56:59], v[236:239], v[204:207], v[56:59]
s_waitcnt lgkmcnt(2)
v_mfma_f32_16x16x32_f16 v[52:55], v[224:227], v[200:203], v[52:55]
ds_read_b128 v[236:239], v250 offset:15616
v_mfma_f32_16x16x32_f16 v[60:63], v[224:227], v[204:207], v[60:63]
s_waitcnt lgkmcnt(2)
v_mfma_f32_16x16x32_bf16 v[172:175], v[228:231], v[104:107], v[172:175]
ds_read_b128 v[224:227], v250 offset:16384
v_mfma_f32_16x16x32_bf16 v[180:183], v[228:231], v[108:111], v[180:183]
s_waitcnt lgkmcnt(2)
v_mfma_f32_16x16x32_f16 v[64:67], v[232:235], v[200:203], v[64:67]
ds_read_b128 v[228:231], v250 offset:16640
v_mfma_f32_16x16x32_f16 v[72:75], v[232:235], v[204:207], v[72:75]
s_waitcnt lgkmcnt(2)
v_mfma_f32_16x16x32_f16 v[68:71], v[236:239], v[200:203], v[68:71]
ds_read_b128 v[232:235], v248 offset:18432
v_mfma_f32_16x16x32_f16 v[76:79], v[236:239], v[204:207], v[76:79]
s_waitcnt lgkmcnt(2)
v_mfma_f32_16x16x32_f16 v[80:83], v[224:227], v[200:203], v[80:83]
ds_read_b128 v[236:239], v250 offset:20480
v_mfma_f32_16x16x32_f16 v[88:91], v[224:227], v[204:207], v[88:91]
s_waitcnt lgkmcnt(2)
v_mfma_f32_16x16x32_f16 v[84:87], v[228:231], v[200:203], v[84:87]
ds_read_b128 v[224:227], v250 offset:20736
v_mfma_f32_16x16x32_f16 v[92:95], v[228:231], v[204:207], v[92:95]
s_waitcnt lgkmcnt(2)
v_mfma_f32_16x16x32_bf16 v[168:171], v[232:235], v[112:115], v[168:171]
ds_read_b128 v[228:231], v250 offset:21504
v_mfma_f32_16x16x32_bf16 v[176:179], v[232:235], v[116:119], v[176:179]
s_waitcnt lgkmcnt(2)
v_mfma_f32_16x16x32_f16 v[48:51], v[236:239], v[208:211], v[48:51]
ds_read_b128 v[232:235], v250 offset:21760
v_mfma_f32_16x16x32_f16 v[56:59], v[236:239], v[212:215], v[56:59]
s_waitcnt lgkmcnt(2)
v_mfma_f32_16x16x32_f16 v[52:55], v[224:227], v[208:211], v[52:55]
ds_read_b128 v[236:239], v248 offset:18688
v_mfma_f32_16x16x32_f16 v[60:63], v[224:227], v[212:215], v[60:63]
s_waitcnt lgkmcnt(2)
v_mfma_f32_16x16x32_f16 v[64:67], v[228:231], v[208:211], v[64:67]
ds_read_b128 v[224:227], v250 offset:22528
v_mfma_f32_16x16x32_f16 v[72:75], v[228:231], v[212:215], v[72:75]
s_waitcnt lgkmcnt(2)
v_mfma_f32_16x16x32_f16 v[68:71], v[232:235], v[208:211], v[68:71]
ds_read_b128 v[228:231], v250 offset:22784
v_mfma_f32_16x16x32_f16 v[76:79], v[232:235], v[212:215], v[76:79]
s_waitcnt lgkmcnt(2)
v_mfma_f32_16x16x32_bf16 v[172:175], v[236:239], v[112:115], v[172:175]
ds_read_b128 v[232:235], v250 offset:26624
v_mfma_f32_16x16x32_bf16 v[180:183], v[236:239], v[116:119], v[180:183]
s_waitcnt lgkmcnt(2)
v_mfma_f32_16x16x32_f16 v[80:83], v[224:227], v[208:211], v[80:83]
ds_read_b128 v[236:239], v250 offset:26880
v_mfma_f32_16x16x32_f16 v[88:91], v[224:227], v[212:215], v[88:91]
s_waitcnt lgkmcnt(2)
v_mfma_f32_16x16x32_f16 v[84:87], v[228:231], v[208:211], v[84:87]
ds_read_b128 v[224:227], v248 offset:22528
v_mfma_f32_16x16x32_f16 v[92:95], v[228:231], v[212:215], v[92:95]
s_setprio 3
s_waitcnt lgkmcnt(2)
v_mfma_f32_16x16x32_f16 v[48:51], v[232:235], v[216:219], v[48:51]
s_add_u32 s46, s70, 98304
buffer_load_dwordx4 v[204:207], v252, s[4:7], s46 offen offset:128
ds_read_b128 v[228:231], v250 offset:27648
v_cvt_pkrtz_f16_f32 v185, v168, v169
v_cvt_pkrtz_f16_f32 v187, v170, v171
v_mfma_f32_16x16x32_f16 v[56:59], v[232:235], v[220:223], v[56:59]
v_cvt_pkrtz_f16_f32 v189, v172, v173
v_cvt_pkrtz_f16_f32 v191, v174, v175
s_waitcnt lgkmcnt(2)
v_mfma_f32_16x16x32_f16 v[52:55], v[236:239], v[216:219], v[52:55]
ds_read_b128 v[232:235], v248 offset:22784
v_cvt_pkrtz_f16_f32 v193, v176, v177
v_cvt_pk_f16_f32 v203, v178, v179
v_cvt_pk_f16_f32 v200, v180, v181
v_mfma_f32_16x16x32_f16 v[60:63], v[236:239], v[220:223], v[60:63]
v_cvt_pk_f16_f32 v197, v182, v183
v_pk_fma_f16 v202, v203, v203, s48
s_waitcnt lgkmcnt(2)
v_mfma_f32_16x16x32_bf16 v[168:171], v[224:227], v[96:99], 0
ds_read_b128 v[236:239], v250 offset:27904
v_and_b32_e64 v185, s49, v185
v_pk_fma_f16 v199, v200, v200, s48
v_mfma_f32_16x16x32_bf16 v[176:179], v[224:227], v[100:103], 0
v_and_b32 v187, s49, v187
v_pk_fma_f16 v196, v197, v197, s48
v_bfe_u32 v184, v185, 2, 14
s_waitcnt lgkmcnt(2)
v_mfma_f32_16x16x32_f16 v[64:67], v[228:231], v[216:219], v[64:67]
ds_read_b128 v[224:227], v248 offset:23552
ds_read_u16_d16 v184, v184
v_pk_mul_f16 v202, v203, v202
v_bfe_u32 v186, v187, 2, 14
v_mfma_f32_16x16x32_f16 v[72:75], v[228:231], v[220:223], v[72:75]
v_pk_mul_f16 v199, v200, v199
v_lshrrev_b32 v185, 18, v185
s_waitcnt lgkmcnt(3)
v_mfma_f32_16x16x32_bf16 v[172:175], v[232:235], v[96:99], 0
ds_read_b128 v[228:231], v250 offset:28672
ds_read_u16_d16 v186, v186
ds_read_u16_d16_hi v185, v185
v_pk_mul_f16 v196, v197, v196
v_lshrrev_b32_e64 v187, 18, v187
v_mfma_f32_16x16x32_bf16 v[180:183], v[232:235], v[100:103], 0
v_exp_f16_e64 v201, v202
v_and_b32 v189, s49, v189
s_waitcnt lgkmcnt(5)
v_mfma_f32_16x16x32_f16 v[68:71], v[236:239], v[216:219], v[68:71]
ds_read_b128 v[232:235], v250 offset:28928
ds_read_u16_d16_hi v187, v187
v_and_b32_e64 v191, s49, v191
v_mfma_f32_16x16x32_f16 v[76:79], v[236:239], v[220:223], v[76:79]
v_exp_f16 v198, v199
v_bfe_u32 v188, v189, 2, 14
v_bfe_u32 v190, v191, 2, 14
s_waitcnt lgkmcnt(5)
v_mfma_f32_16x16x32_bf16 v[168:171], v[224:227], v[104:107], v[168:171]
buffer_store_dwordx4 v[152:155], v255, s[8:11], s71 offen offset:256 sc1
ds_read_b128 v[236:239], v248 offset:23808
ds_read_u16_d16 v188, v188
ds_read_u16_d16 v190, v190
v_exp_f16_e64 v195, v196
v_mfma_f32_16x16x32_bf16 v[176:179], v[224:227], v[108:111], v[176:179]
v_lshrrev_b32_e64 v189, 18, v189
v_lshrrev_b32 v191, 18, v191
s_waitcnt lgkmcnt(5)
v_mfma_f32_16x16x32_f16 v[80:83], v[228:231], v[216:219], v[80:83]
ds_read_b128 v[224:227], v248 offset:24576
ds_read_u16_d16_hi v189, v189
ds_read_u16_d16_hi v191, v191
v_exp_f16_sdwa v201, v202 dst_sel:WORD_1 dst_unused:UNUSED_PRESERVE src0_sel:WORD_1
v_and_b32 v193, s49, v193
v_mfma_f32_16x16x32_f16 v[88:91], v[228:231], v[220:223], v[88:91]
v_bfe_u32 v192, v193, 2, 14
s_waitcnt lgkmcnt(6)
v_mfma_f32_16x16x32_f16 v[84:87], v[232:235], v[216:219], v[84:87]
ds_read_b128 v[228:231], v248 offset:24832
ds_read_u16_d16 v192, v192
v_exp_f16_sdwa v198, v199 dst_sel:WORD_1 dst_unused:UNUSED_PRESERVE src0_sel:WORD_1
v_lshrrev_b32 v193, 18, v193
v_mfma_f32_16x16x32_f16 v[92:95], v[232:235], v[220:223], v[92:95]
v_exp_f16_sdwa v195, v196 dst_sel:WORD_1 dst_unused:UNUSED_PRESERVE src0_sel:WORD_1
v_pk_add_f16 v201, v201, 1.0 op_sel_hi:[1,0]
s_waitcnt lgkmcnt(7)
v_mfma_f32_16x16x32_bf16 v[172:175], v[236:239], v[104:107], v[172:175]
ds_read_u16_d16_hi v193, v193
v_pk_add_f16 v198, v198, 1.0 op_sel_hi:[1,0]
v_pk_add_f16 v195, v195, 1.0 op_sel_hi:[1,0]
v_mfma_f32_16x16x32_bf16 v[180:183], v[236:239], v[108:111], v[180:183]
v_rcp_f16 v202, v201
s_waitcnt lgkmcnt(5)
v_mfma_f32_16x16x32_bf16 v[168:171], v[224:227], v[112:115], v[168:171]
v_rcp_f16_e64 v199, v198
v_mfma_f32_16x16x32_bf16 v[176:179], v[224:227], v[116:119], v[176:179]
v_rcp_f16 v196, v195
s_waitcnt lgkmcnt(2)
v_mfma_f32_16x16x32_bf16 v[172:175], v[228:231], v[112:115], v[172:175]
ds_read_b128 v[224:227], v249 offset:24576
v_rcp_f16_sdwa v202, v201 dst_sel:WORD_1 dst_unused:UNUSED_PRESERVE src0_sel:WORD_1
v_mfma_f32_16x16x32_bf16 v[180:183], v[228:231], v[116:119], v[180:183]
v_rcp_f16_sdwa v199, v198 dst_sel:WORD_1 dst_unused:UNUSED_PRESERVE src0_sel:WORD_1
v_or_b32 v208, v184, v185
v_or_b32 v209, v186, v187
v_or_b32_e64 v210, v188, v189
v_rcp_f16_sdwa v196, v195 dst_sel:WORD_1 dst_unused:UNUSED_PRESERVE src0_sel:WORD_1
v_or_b32 v211, v190, v191
s_waitcnt lgkmcnt(1)
v_or_b32 v212, v192, v193
v_pk_mul_f16 v213, v203, v202
v_pk_mul_f16 v214, v200, v199
v_pk_mul_f16 v215, v197, v196
s_waitcnt lgkmcnt(0)
v_mfma_f32_16x16x32_f16 v[48:51], v[224:227], v[208:211], v[48:51]
ds_read_b128 v[228:231], v249 offset:24832
ds_read_b128 v[232:235], v248 offset:28672
ds_read_b128 v[236:239], v249 offset:25600
ds_read_b128 v[216:219], v248 offset:28928
ds_read_b128 v[220:223], v249 offset:25856
v_cvt_pkrtz_f16_f32 v185, v168, v169
v_cvt_pkrtz_f16_f32 v187, v170, v171
v_cvt_pkrtz_f16_f32 v189, v172, v173
v_mfma_f32_16x16x32_f16 v[56:59], v[224:227], v[212:215], v[56:59]
v_cvt_pkrtz_f16_f32 v191, v174, v175
v_cvt_pkrtz_f16_f32 v193, v176, v177
v_cvt_pk_f16_f32 v203, v178, v179
s_waitcnt lgkmcnt(4)
v_mfma_f32_16x16x32_f16 v[52:55], v[228:231], v[208:211], v[52:55]
ds_read_b128 v[224:227], v248 offset:29696
v_cvt_pk_f16_f32 v200, v180, v181
v_cvt_pk_f16_f32 v197, v182, v183
v_pk_fma_f16 v202, v203, v203, s48
v_cvt_pk_bf16_f32 v144, v144, v145
v_mfma_f32_16x16x32_f16 v[60:63], v[228:231], v[212:215], v[60:63]
v_and_b32 v185, s49, v185
v_cvt_pk_bf16_f32 v145, v146, v147
v_pk_fma_f16 v199, v200, v200, s48
s_waitcnt lgkmcnt(4)
v_mfma_f32_16x16x32_bf16 v[168:171], v[232:235], v[96:99], 0
ds_read_b128 v[228:231], v249 offset:26624
v_and_b32 v187, s49, v187
v_cvt_pk_bf16_f32 v146, v148, v149
v_pk_fma_f16 v196, v197, v197, s48
v_mfma_f32_16x16x32_bf16 v[176:179], v[232:235], v[100:103], 0
v_cvt_pk_bf16_f32 v147, v150, v151
v_bfe_u32 v184, v185, 2, 14
s_setprio 2
v_pk_mul_f16 v202, v203, v202
v_cvt_pk_bf16_f32 v128, v128, v129
s_waitcnt lgkmcnt(2)
v_mfma_f32_16x16x32_f16 v[64:67], v[236:239], v[208:211], v[64:67]
ds_read_b128 v[232:235], v249 offset:26880
ds_read_u16_d16 v184, v184
v_bfe_u32 v186, v187, 2, 14
v_cvt_pk_bf16_f32 v129, v130, v131
v_pk_mul_f16 v199, v200, v199
v_mfma_f32_16x16x32_f16 v[72:75], v[236:239], v[212:215], v[72:75]
v_lshrrev_b32_e64 v185, 18, v185
v_cvt_pk_bf16_f32 v130, v132, v133
v_pk_mul_f16 v196, v197, v196
v_mfma_f32_16x16x32_bf16 v[172:175], v[216:219], v[96:99], 0
ds_read_b128 v[236:239], v248 offset:29952
ds_read_u16_d16 v186, v186
ds_read_u16_d16_hi v185, v185
v_lshrrev_b32_e64 v187, 18, v187
v_cvt_pk_bf16_f32 v131, v134, v135
v_exp_f16_e64 v201, v202
v_mfma_f32_16x16x32_bf16 v[180:183], v[216:219], v[100:103], 0
v_cvt_pk_bf16_f32 v160, v160, v161
v_and_b32_e64 v189, s49, v189
v_cvt_pk_bf16_f32 v161, v162, v163
v_mfma_f32_16x16x32_f16 v[68:71], v[220:223], v[208:211], v[68:71]
ds_read_b128 v[216:219], v248 offset:30720
ds_read_u16_d16_hi v187, v187
v_and_b32_e64 v191, s49, v191
v_cvt_pk_bf16_f32 v162, v164, v165
v_mfma_f32_16x16x32_f16 v[76:79], v[220:223], v[212:215], v[76:79]
v_exp_f16_e64 v198, v199
v_cvt_pk_bf16_f32 v163, v166, v167
s_mov_b64 vcc, s[74:75]
v_bfe_u32 v188, v189, 2, 14
v_bfe_u32 v190, v191, 2, 14
s_waitcnt lgkmcnt(5)
v_mfma_f32_16x16x32_bf16 v[168:171], v[224:227], v[104:107], v[168:171]
ds_read_b128 v[220:223], v248 offset:30976
ds_read_u16_d16 v188, v188
ds_read_u16_d16 v190, v190
v_cndmask_b32 v148, v128, v160, vcc
v_exp_f16 v195, v196
v_mfma_f32_16x16x32_bf16 v[176:179], v[224:227], v[108:111], v[176:179]
v_cndmask_b32 v149, v129, v161, vcc
v_lshrrev_b32_e64 v189, 18, v189
v_cndmask_b32 v150, v130, v162, vcc
v_mfma_f32_16x16x32_f16 v[80:83], v[228:231], v[208:211], v[80:83]
ds_read_b128 v[224:227], v249 offset:30720
ds_read_u16_d16_hi v189, v189
v_lshrrev_b32 v191, 18, v191
v_cndmask_b32 v151, v131, v163, vcc
v_exp_f16_sdwa v201, v202 dst_sel:WORD_1 dst_unused:UNUSED_PRESERVE src0_sel:WORD_1
v_mfma_f32_16x16x32_f16 v[88:91], v[228:231], v[212:215], v[88:91]
v_cndmask_b32_dpp v128, v144, v128, vcc quad_perm:[1,0,3,2] row_mask:0xf bank_mask:0xf
v_and_b32_e64 v193, s49, v193
v_cndmask_b32_dpp v129, v145, v129, vcc quad_perm:[1,0,3,2] row_mask:0xf bank_mask:0xf
v_mfma_f32_16x16x32_f16 v[84:87], v[232:235], v[208:211], v[84:87]
ds_read_b128 v[228:231], v249 offset:30976
ds_read_u16_d16_hi v191, v191
v_bfe_u32 v192, v193, 2, 14
v_exp_f16_sdwa v198, v199 dst_sel:WORD_1 dst_unused:UNUSED_PRESERVE src0_sel:WORD_1
v_mfma_f32_16x16x32_f16 v[92:95], v[232:235], v[212:215], v[92:95]
v_cndmask_b32_dpp v130, v146, v130, vcc quad_perm:[1,0,3,2] row_mask:0xf bank_mask:0xf
v_lshrrev_b32_e64 v193, 18, v193
v_cndmask_b32_dpp v131, v147, v131, vcc quad_perm:[1,0,3,2] row_mask:0xf bank_mask:0xf
s_not_b64 vcc, s[74:75]
s_waitcnt lgkmcnt(4)
v_mfma_f32_16x16x32_bf16 v[172:175], v[236:239], v[104:107], v[172:175]
ds_read_b128 v[232:235], v248 offset:34816
ds_read_u16_d16 v192, v192
ds_read_u16_d16_hi v193, v193
v_exp_f16_sdwa v195, v196 dst_sel:WORD_1 dst_unused:UNUSED_PRESERVE src0_sel:WORD_1
v_cndmask_b32_dpp v160, v144, v160, vcc quad_perm:[1,0,3,2] row_mask:0xf bank_mask:0xf
v_pk_add_f16 v201, v201, 1.0 op_sel_hi:[1,0]
v_mfma_f32_16x16x32_bf16 v[180:183], v[236:239], v[108:111], v[180:183]
v_cndmask_b32_dpp v161, v145, v161, vcc quad_perm:[1,0,3,2] row_mask:0xf bank_mask:0xf
v_pk_add_f16 v198, v198, 1.0 op_sel_hi:[1,0]
v_cndmask_b32_dpp v162, v146, v162, vcc quad_perm:[1,0,3,2] row_mask:0xf bank_mask:0xf
v_mfma_f32_16x16x32_bf16 v[168:171], v[216:219], v[112:115], v[168:171]
ds_read_b128 v[236:239], v249 offset:31744
v_pk_add_f16 v195, v195, 1.0 op_sel_hi:[1,0]
v_rcp_f16_e64 v202, v201
v_cndmask_b32_dpp v163, v147, v163, vcc quad_perm:[1,0,3,2] row_mask:0xf bank_mask:0xf
v_mfma_f32_16x16x32_bf16 v[176:179], v[216:219], v[116:119], v[176:179]
v_rcp_f16_e64 v199, v198
v_mfma_f32_16x16x32_bf16 v[172:175], v[220:223], v[112:115], v[172:175]
ds_read_b128 v[216:219], v248 offset:35072
s_add_u32 s46, s71, 98304
buffer_store_dwordx4 v[128:131], v255, s[8:11], s46 offen sc1
v_rcp_f16_e64 v196, v195
v_rcp_f16_sdwa v202, v201 dst_sel:WORD_1 dst_unused:UNUSED_PRESERVE src0_sel:WORD_1
v_mfma_f32_16x16x32_bf16 v[180:183], v[220:223], v[116:119], v[180:183]
v_rcp_f16_sdwa v199, v198 dst_sel:WORD_1 dst_unused:UNUSED_PRESERVE src0_sel:WORD_1
v_or_b32 v208, v184, v185
v_or_b32 v209, v186, v187
s_waitcnt lgkmcnt(2)
v_or_b32 v210, v188, v189
v_rcp_f16_sdwa v196, v195 dst_sel:WORD_1 dst_unused:UNUSED_PRESERVE src0_sel:WORD_1
v_or_b32 v211, v190, v191
v_or_b32 v212, v192, v193
v_pk_mul_f16 v213, v203, v202
v_pk_mul_f16 v214, v200, v199
v_pk_mul_f16 v215, v197, v196
v_mfma_f32_16x16x32_f16 v[48:51], v[224:227], v[208:211], v[48:51]
ds_read_b128 v[220:223], v249 offset:32000
v_cvt_pkrtz_f16_f32 v185, v168, v169
v_cvt_pkrtz_f16_f32 v187, v170, v171
v_mfma_f32_16x16x32_f16 v[56:59], v[224:227], v[212:215], v[56:59]
v_cvt_pkrtz_f16_f32 v189, v172, v173
v_cvt_pkrtz_f16_f32 v191, v174, v175
v_mfma_f32_16x16x32_f16 v[52:55], v[228:231], v[208:211], v[52:55]
ds_read_b128 v[224:227], v248 offset:35840
v_cvt_pkrtz_f16_f32 v193, v176, v177
v_cvt_pk_f16_f32 v203, v178, v179
v_mfma_f32_16x16x32_f16 v[60:63], v[228:231], v[212:215], v[60:63]
v_cvt_pk_f16_f32 v200, v180, v181
v_cvt_pk_f16_f32 v197, v182, v183
s_setprio 1
v_mfma_f32_16x16x32_bf16 v[168:171], v[232:235], v[96:99], 0
ds_read_b128 v[228:231], v249 offset:32768
v_pk_fma_f16 v202, v203, v203, s48
v_and_b32 v185, s49, v185
v_mfma_f32_16x16x32_bf16 v[176:179], v[232:235], v[100:103], 0
v_pk_fma_f16 v199, v200, v200, s48
v_and_b32 v187, s49, v187
s_waitcnt lgkmcnt(3)
v_mfma_f32_16x16x32_f16 v[64:67], v[236:239], v[208:211], v[64:67]
ds_read_b128 v[232:235], v249 offset:33024
v_pk_fma_f16 v196, v197, v197, s48
v_bfe_u32 v184, v185, 2, 14
v_pk_mul_f16 v202, v203, v202
v_mfma_f32_16x16x32_f16 v[72:75], v[236:239], v[212:215], v[72:75]
v_bfe_u32 v186, v187, 2, 14
v_pk_mul_f16 v199, v200, v199
s_waitcnt vmcnt(9)
v_mfma_f32_16x16x32_bf16 v[48:51], v[18:21], v[12:15], v[48:51]
ds_read_b128 v[236:239], v248 offset:36096
ds_read_u16_d16 v184, v184
ds_read_u16_d16 v186, v186
v_lshrrev_b32 v185, 18, v185
v_pk_mul_f16 v196, v197, v196
v_mfma_f32_16x16x32_bf16 v[52:55], v[16:19], v[12:15], v[52:55]
v_lshrrev_b32_e64 v187, 18, v187
v_mfma_f32_16x16x32_bf16 v[172:175], v[216:219], v[96:99], 0
ds_read_u16_d16_hi v185, v185
ds_read_u16_d16_hi v187, v187
v_exp_f16 v201, v202
v_and_b32 v189, s49, v189
v_mfma_f32_16x16x32_bf16 v[180:183], v[216:219], v[100:103], 0
v_and_b32 v191, s49, v191
s_waitcnt lgkmcnt(6)
v_mfma_f32_16x16x32_f16 v[68:71], v[220:223], v[208:211], v[68:71]
ds_read_b128 v[216:219], v248 offset:36864
v_exp_f16_e64 v198, v199
v_bfe_u32 v188, v189, 2, 14
v_mfma_f32_16x16x32_f16 v[76:79], v[220:223], v[212:215], v[76:79]
v_bfe_u32 v190, v191, 2, 14
v_exp_f16_e64 v195, v196
v_mfma_f32_16x16x32_bf16 v[168:171], v[224:227], v[104:107], v[168:171]
ds_read_b128 v[220:223], v248 offset:37120
ds_read_u16_d16 v188, v188
ds_read_u16_d16 v190, v190
v_lshrrev_b32 v189, 18, v189
v_lshrrev_b32 v191, 18, v191
v_mfma_f32_16x16x32_bf16 v[176:179], v[224:227], v[108:111], v[176:179]
v_exp_f16_sdwa v201, v202 dst_sel:WORD_1 dst_unused:UNUSED_PRESERVE src0_sel:WORD_1
v_mfma_f32_16x16x32_f16 v[80:83], v[228:231], v[208:211], v[80:83]
ds_read_b128 v[224:227], v249 offset:36864
ds_read_u16_d16_hi v189, v189
ds_read_u16_d16_hi v191, v191
v_and_b32 v193, s49, v193
v_bfe_u32 v192, v193, 2, 14
v_mfma_f32_16x16x32_f16 v[88:91], v[228:231], v[212:215], v[88:91]
v_exp_f16_sdwa v198, v199 dst_sel:WORD_1 dst_unused:UNUSED_PRESERVE src0_sel:WORD_1
s_waitcnt lgkmcnt(7)
v_mfma_f32_16x16x32_f16 v[84:87], v[232:235], v[208:211], v[84:87]
ds_read_b128 v[228:231], v249 offset:37120
ds_read_u16_d16 v192, v192
v_lshrrev_b32_e64 v193, 18, v193
v_mfma_f32_16x16x32_f16 v[92:95], v[232:235], v[212:215], v[92:95]
v_exp_f16_sdwa v195, v196 dst_sel:WORD_1 dst_unused:UNUSED_PRESERVE src0_sel:WORD_1
v_pk_add_f16 v201, v201, 1.0 op_sel_hi:[1,0]
v_pk_add_f16 v198, v198, 1.0 op_sel_hi:[1,0]
v_mfma_f32_16x16x32_bf16 v[172:175], v[236:239], v[104:107], v[172:175]
ds_read_b128 v[232:235], v248 offset:40960
ds_read_u16_d16_hi v193, v193
v_pk_add_f16 v195, v195, 1.0 op_sel_hi:[1,0]
v_mfma_f32_16x16x32_bf16 v[180:183], v[236:239], v[108:111], v[180:183]
v_rcp_f16_e64 v202, v201
s_setprio 0
s_waitcnt lgkmcnt(7)
v_mfma_f32_16x16x32_bf16 v[168:171], v[216:219], v[112:115], v[168:171]
ds_read_b128 v[236:239], v249 offset:37888
v_rcp_f16_e64 v199, v198
v_mfma_f32_16x16x32_bf16 v[176:179], v[216:219], v[116:119], v[176:179]
v_rcp_f16_e64 v196, v195
v_mfma_f32_16x16x32_bf16 v[172:175], v[220:223], v[112:115], v[172:175]
ds_read_b128 v[216:219], v248 offset:41216
v_rcp_f16_sdwa v202, v201 dst_sel:WORD_1 dst_unused:UNUSED_PRESERVE src0_sel:WORD_1
v_mfma_f32_16x16x32_bf16 v[180:183], v[220:223], v[116:119], v[180:183]
v_rcp_f16_sdwa v199, v198 dst_sel:WORD_1 dst_unused:UNUSED_PRESERVE src0_sel:WORD_1
v_or_b32 v208, v184, v185
v_or_b32 v209, v186, v187
s_waitcnt lgkmcnt(4)
v_or_b32 v210, v188, v189
v_rcp_f16_sdwa v196, v195 dst_sel:WORD_1 dst_unused:UNUSED_PRESERVE src0_sel:WORD_1
v_or_b32 v211, v190, v191
s_waitcnt lgkmcnt(2)
v_or_b32 v212, v192, v193
v_pk_mul_f16 v213, v203, v202
v_pk_mul_f16 v214, v200, v199
v_pk_mul_f16 v215, v197, v196
s_setprio 3
v_mfma_f32_16x16x32_f16 v[48:51], v[224:227], v[208:211], v[48:51]
s_add_u32 s46, s71, 98304
buffer_store_dwordx4 v[148:151], v255, s[8:11], s46 offen offset:128 sc1
ds_read_b128 v[220:223], v249 offset:38144
v_cvt_pkrtz_f16_f32 v185, v168, v169
v_cvt_pkrtz_f16_f32 v187, v170, v171
v_mfma_f32_16x16x32_f16 v[56:59], v[224:227], v[212:215], v[56:59]
v_cvt_pkrtz_f16_f32 v189, v172, v173
v_cvt_pkrtz_f16_f32 v191, v174, v175
v_mfma_f32_16x16x32_f16 v[52:55], v[228:231], v[208:211], v[52:55]
ds_read_b128 v[224:227], v248 offset:41984
v_cvt_pkrtz_f16_f32 v193, v176, v177
v_cvt_pk_f16_f32 v203, v178, v179
v_mfma_f32_16x16x32_f16 v[60:63], v[228:231], v[212:215], v[60:63]
v_cvt_pk_f16_f32 v200, v180, v181
v_cvt_pk_f16_f32 v197, v182, v183
v_mfma_f32_16x16x32_bf16 v[168:171], v[232:235], v[96:99], 0
ds_read_b128 v[228:231], v249 offset:38912
v_pk_fma_f16 v202, v203, v203, s48
v_and_b32_e64 v185, s49, v185
v_mfma_f32_16x16x32_bf16 v[176:179], v[232:235], v[100:103], 0
v_pk_fma_f16 v199, v200, v200, s48
v_and_b32 v187, s49, v187
s_waitcnt lgkmcnt(3)
v_mfma_f32_16x16x32_f16 v[64:67], v[236:239], v[208:211], v[64:67]
ds_read_b128 v[232:235], v249 offset:39168
v_pk_fma_f16 v196, v197, v197, s48
v_bfe_u32 v184, v185, 2, 14
v_pk_mul_f16 v202, v203, v202
v_mfma_f32_16x16x32_f16 v[72:75], v[236:239], v[212:215], v[72:75]
v_bfe_u32 v186, v187, 2, 14
v_pk_mul_f16 v199, v200, v199
s_waitcnt vmcnt(9)
v_mfma_f32_16x16x32_bf16 v[64:67], v[18:21], v[8:11], v[64:67]
ds_read_b128 v[236:239], v248 offset:42240
ds_read_u16_d16 v184, v184
ds_read_u16_d16 v186, v186
v_lshrrev_b32 v185, 18, v185
v_pk_mul_f16 v196, v197, v196
v_mfma_f32_16x16x32_bf16 v[68:71], v[16:19], v[8:11], v[68:71]
v_lshrrev_b32_e64 v187, 18, v187
v_mfma_f32_16x16x32_bf16 v[172:175], v[216:219], v[96:99], 0
ds_read_u16_d16_hi v185, v185
ds_read_u16_d16_hi v187, v187
v_exp_f16 v201, v202
v_and_b32 v189, s49, v189
v_mfma_f32_16x16x32_bf16 v[180:183], v[216:219], v[100:103], 0
v_and_b32 v191, s49, v191
s_waitcnt lgkmcnt(6)
v_mfma_f32_16x16x32_f16 v[68:71], v[220:223], v[208:211], v[68:71]
ds_read_b128 v[216:219], v248 offset:43008
v_exp_f16_e64 v198, v199
v_bfe_u32 v188, v189, 2, 14
v_mfma_f32_16x16x32_f16 v[76:79], v[220:223], v[212:215], v[76:79]
v_bfe_u32 v190, v191, 2, 14
v_exp_f16_e64 v195, v196
v_mfma_f32_16x16x32_bf16 v[168:171], v[224:227], v[104:107], v[168:171]
ds_read_b128 v[220:223], v248 offset:43264
ds_read_u16_d16 v188, v188
ds_read_u16_d16 v190, v190
v_lshrrev_b32 v189, 18, v189
v_lshrrev_b32 v191, 18, v191
v_mfma_f32_16x16x32_bf16 v[176:179], v[224:227], v[108:111], v[176:179]
v_exp_f16_sdwa v201, v202 dst_sel:WORD_1 dst_unused:UNUSED_PRESERVE src0_sel:WORD_1
v_mfma_f32_16x16x32_f16 v[80:83], v[228:231], v[208:211], v[80:83]
ds_read_b128 v[224:227], v249 offset:43008
ds_read_u16_d16_hi v189, v189
ds_read_u16_d16_hi v191, v191
v_and_b32 v193, s49, v193
v_bfe_u32 v192, v193, 2, 14
v_mfma_f32_16x16x32_f16 v[88:91], v[228:231], v[212:215], v[88:91]
v_exp_f16_sdwa v198, v199 dst_sel:WORD_1 dst_unused:UNUSED_PRESERVE src0_sel:WORD_1
s_waitcnt lgkmcnt(7)
v_mfma_f32_16x16x32_f16 v[84:87], v[232:235], v[208:211], v[84:87]
ds_read_b128 v[228:231], v249 offset:43264
ds_read_u16_d16 v192, v192
v_lshrrev_b32_e64 v193, 18, v193
v_mfma_f32_16x16x32_f16 v[92:95], v[232:235], v[212:215], v[92:95]
v_exp_f16_sdwa v195, v196 dst_sel:WORD_1 dst_unused:UNUSED_PRESERVE src0_sel:WORD_1
v_pk_add_f16 v201, v201, 1.0 op_sel_hi:[1,0]
v_pk_add_f16 v198, v198, 1.0 op_sel_hi:[1,0]
v_mfma_f32_16x16x32_bf16 v[172:175], v[236:239], v[104:107], v[172:175]
ds_read_b128 v[232:235], v248 offset:16384
ds_read_u16_d16_hi v193, v193
v_pk_add_f16 v195, v195, 1.0 op_sel_hi:[1,0]
v_mfma_f32_16x16x32_bf16 v[180:183], v[236:239], v[108:111], v[180:183]
v_rcp_f16 v202, v201
s_waitcnt lgkmcnt(7)
v_mfma_f32_16x16x32_bf16 v[168:171], v[216:219], v[112:115], v[168:171]
ds_read_b128 v[236:239], v249 offset:44032
v_rcp_f16_e64 v199, v198
v_mfma_f32_16x16x32_bf16 v[176:179], v[216:219], v[116:119], v[176:179]
v_rcp_f16_e64 v196, v195
v_mfma_f32_16x16x32_bf16 v[172:175], v[220:223], v[112:115], v[172:175]
ds_read_b128 v[216:219], v248 offset:16640
v_rcp_f16_sdwa v202, v201 dst_sel:WORD_1 dst_unused:UNUSED_PRESERVE src0_sel:WORD_1
v_mfma_f32_16x16x32_bf16 v[180:183], v[220:223], v[116:119], v[180:183]
v_rcp_f16_sdwa v199, v198 dst_sel:WORD_1 dst_unused:UNUSED_PRESERVE src0_sel:WORD_1
v_or_b32 v208, v184, v185
v_or_b32 v209, v186, v187
s_waitcnt lgkmcnt(4)
v_or_b32 v210, v188, v189
v_rcp_f16_sdwa v196, v195 dst_sel:WORD_1 dst_unused:UNUSED_PRESERVE src0_sel:WORD_1
v_or_b32 v211, v190, v191
s_waitcnt lgkmcnt(2)
v_or_b32_e64 v212, v192, v193
v_pk_mul_f16 v213, v203, v202
v_pk_mul_f16 v214, v200, v199
v_pk_mul_f16 v215, v197, v196
v_mfma_f32_16x16x32_f16 v[48:51], v[224:227], v[208:211], v[48:51]
s_add_u32 s46, s71, 98304
buffer_store_dwordx4 v[160:163], v255, s[8:11], s46 offen offset:256 sc1
ds_read_b128 v[220:223], v249 offset:44288
v_cvt_pkrtz_f16_f32 v185, v168, v169
v_cvt_pkrtz_f16_f32 v187, v170, v171
v_mfma_f32_16x16x32_f16 v[56:59], v[224:227], v[212:215], v[56:59]
v_cvt_pkrtz_f16_f32 v189, v172, v173
v_cvt_pkrtz_f16_f32 v191, v174, v175
v_mfma_f32_16x16x32_f16 v[52:55], v[228:231], v[208:211], v[52:55]
ds_read_b128 v[224:227], v248 offset:17408
v_cvt_pkrtz_f16_f32 v193, v176, v177
v_cvt_pk_f16_f32 v203, v178, v179
v_mfma_f32_16x16x32_f16 v[60:63], v[228:231], v[212:215], v[60:63]
v_cvt_pk_f16_f32 v200, v180, v181
v_cvt_pk_f16_f32 v197, v182, v183
v_mfma_f32_16x16x32_bf16 v[168:171], v[232:235], v[24:27], 0
ds_read_b128 v[228:231], v249 offset:45056
v_pk_fma_f16 v202, v203, v203, s48
v_and_b32_e64 v185, s49, v185
v_mfma_f32_16x16x32_bf16 v[176:179], v[232:235], v[28:31], 0
v_pk_fma_f16 v199, v200, v200, s48
v_and_b32 v187, s49, v187
s_waitcnt lgkmcnt(3)
v_mfma_f32_16x16x32_f16 v[64:67], v[236:239], v[208:211], v[64:67]
ds_read_b128 v[232:235], v249 offset:45312
v_pk_fma_f16 v196, v197, v197, s48
s_setprio 2
v_bfe_u32 v184, v185, 2, 14
v_pk_mul_f16 v202, v203, v202
v_mfma_f32_16x16x32_f16 v[72:75], v[236:239], v[212:215], v[72:75]
v_bfe_u32 v186, v187, 2, 14
v_pk_mul_f16 v199, v200, v199
s_waitcnt vmcnt(9)
v_mfma_f32_16x16x32_bf16 v[80:83], v[18:21], v[4:7], v[80:83]
ds_read_b128 v[236:239], v248 offset:17664
ds_read_u16_d16 v184, v184
ds_read_u16_d16 v186, v186
v_lshrrev_b32_e64 v185, 18, v185
v_pk_mul_f16 v196, v197, v196
v_mfma_f32_16x16x32_bf16 v[84:87], v[16:19], v[4:7], v[84:87]
v_lshrrev_b32_e64 v187, 18, v187
v_mfma_f32_16x16x32_bf16 v[172:175], v[216:219], v[24:27], 0
ds_read_u16_d16_hi v185, v185
ds_read_u16_d16_hi v187, v187
v_exp_f16 v201, v202
v_and_b32 v189, s49, v189
v_mfma_f32_16x16x32_bf16 v[180:183], v[216:219], v[28:31], 0
v_and_b32 v191, s49, v191
s_waitcnt lgkmcnt(6)
v_mfma_f32_16x16x32_f16 v[68:71], v[220:223], v[208:211], v[68:71]
ds_read_b128 v[216:219], v248 offset:18432
v_exp_f16_e64 v198, v199
v_bfe_u32 v188, v189, 2, 14
v_mfma_f32_16x16x32_f16 v[76:79], v[220:223], v[212:215], v[76:79]
v_bfe_u32 v190, v191, 2, 14
v_exp_f16_e64 v195, v196
v_mfma_f32_16x16x32_bf16 v[168:171], v[224:227], v[32:35], v[168:171]
s_add_u32 s46, s80, 12582912
buffer_load_dwordx4 v[96:99], v253, s[32:35], s46 offen
ds_read_b128 v[220:223], v248 offset:18688
ds_read_u16_d16 v188, v188
ds_read_u16_d16 v190, v190
v_lshrrev_b32 v189, 18, v189
v_lshrrev_b32 v191, 18, v191
v_mfma_f32_16x16x32_bf16 v[176:179], v[224:227], v[36:39], v[176:179]
v_exp_f16_sdwa v201, v202 dst_sel:WORD_1 dst_unused:UNUSED_PRESERVE src0_sel:WORD_1
v_mfma_f32_16x16x32_f16 v[80:83], v[228:231], v[208:211], v[80:83]
ds_read_b128 v[224:227], v249 offset:49152
ds_read_u16_d16_hi v189, v189
ds_read_u16_d16_hi v191, v191
v_and_b32 v193, s49, v193
v_bfe_u32 v192, v193, 2, 14
v_mfma_f32_16x16x32_f16 v[88:91], v[228:231], v[212:215], v[88:91]
v_exp_f16_sdwa v198, v199 dst_sel:WORD_1 dst_unused:UNUSED_PRESERVE src0_sel:WORD_1
s_waitcnt lgkmcnt(7)
v_mfma_f32_16x16x32_f16 v[84:87], v[232:235], v[208:211], v[84:87]
ds_read_b128 v[228:231], v249 offset:49408
ds_read_u16_d16 v192, v192
v_lshrrev_b32_e64 v193, 18, v193
v_mfma_f32_16x16x32_f16 v[92:95], v[232:235], v[212:215], v[92:95]
v_exp_f16_sdwa v195, v196 dst_sel:WORD_1 dst_unused:UNUSED_PRESERVE src0_sel:WORD_1
v_pk_add_f16 v201, v201, 1.0 op_sel_hi:[1,0]
v_pk_add_f16 v198, v198, 1.0 op_sel_hi:[1,0]
v_mfma_f32_16x16x32_bf16 v[172:175], v[236:239], v[32:35], v[172:175]
ds_read_b128 v[232:235], v248 offset:22528
ds_read_u16_d16_hi v193, v193
v_pk_add_f16 v195, v195, 1.0 op_sel_hi:[1,0]
v_mfma_f32_16x16x32_bf16 v[180:183], v[236:239], v[36:39], v[180:183]
v_rcp_f16 v202, v201
s_waitcnt lgkmcnt(7)
v_mfma_f32_16x16x32_bf16 v[168:171], v[216:219], v[40:43], v[168:171]
ds_read_b128 v[236:239], v249 offset:50176
v_rcp_f16_e64 v199, v198
v_mfma_f32_16x16x32_bf16 v[176:179], v[216:219], v[44:47], v[176:179]
v_rcp_f16_e64 v196, v195
v_mfma_f32_16x16x32_bf16 v[172:175], v[220:223], v[40:43], v[172:175]
ds_read_b128 v[216:219], v248 offset:22784
v_rcp_f16_sdwa v202, v201 dst_sel:WORD_1 dst_unused:UNUSED_PRESERVE src0_sel:WORD_1
v_mfma_f32_16x16x32_bf16 v[180:183], v[220:223], v[44:47], v[180:183]
v_rcp_f16_sdwa v199, v198 dst_sel:WORD_1 dst_unused:UNUSED_PRESERVE src0_sel:WORD_1
v_or_b32 v208, v184, v185
v_or_b32 v209, v186, v187
s_waitcnt lgkmcnt(4)
v_or_b32 v210, v188, v189
v_rcp_f16_sdwa v196, v195 dst_sel:WORD_1 dst_unused:UNUSED_PRESERVE src0_sel:WORD_1
v_or_b32 v211, v190, v191
s_waitcnt lgkmcnt(2)
v_or_b32_e64 v212, v192, v193
v_pk_mul_f16 v213, v203, v202
v_pk_mul_f16 v214, v200, v199
v_pk_mul_f16 v215, v197, v196
v_mfma_f32_16x16x32_f16 v[48:51], v[224:227], v[208:211], v[48:51]
ds_read_b128 v[220:223], v249 offset:50432
v_cvt_pkrtz_f16_f32 v185, v168, v169
v_cvt_pkrtz_f16_f32 v187, v170, v171
v_mfma_f32_16x16x32_f16 v[56:59], v[224:227], v[212:215], v[56:59]
v_cvt_pkrtz_f16_f32 v189, v172, v173
v_cvt_pkrtz_f16_f32 v191, v174, v175
v_mfma_f32_16x16x32_f16 v[52:55], v[228:231], v[208:211], v[52:55]
ds_read_b128 v[224:227], v248 offset:23552
v_cvt_pkrtz_f16_f32 v193, v176, v177
v_cvt_pk_f16_f32 v203, v178, v179
v_mfma_f32_16x16x32_f16 v[60:63], v[228:231], v[212:215], v[60:63]
v_cvt_pk_f16_f32 v200, v180, v181
v_cvt_pk_f16_f32 v197, v182, v183
s_setprio 1
v_mfma_f32_16x16x32_bf16 v[168:171], v[232:235], v[24:27], 0
ds_read_b128 v[228:231], v249 offset:51200
v_pk_fma_f16 v202, v203, v203, s48
v_and_b32 v185, s49, v185
v_mfma_f32_16x16x32_bf16 v[176:179], v[232:235], v[28:31], 0
v_pk_fma_f16 v199, v200, v200, s48
v_and_b32 v187, s49, v187
s_waitcnt lgkmcnt(3)
v_mfma_f32_16x16x32_f16 v[64:67], v[236:239], v[208:211], v[64:67]
ds_read_b128 v[232:235], v249 offset:51456
v_pk_fma_f16 v196, v197, v197, s48
v_bfe_u32 v184, v185, 2, 14
v_pk_mul_f16 v202, v203, v202
v_mfma_f32_16x16x32_f16 v[72:75], v[236:239], v[212:215], v[72:75]
v_bfe_u32 v186, v187, 2, 14
v_pk_mul_f16 v199, v200, v199
s_waitcnt vmcnt(9)
v_mfma_f32_16x16x32_bf16 v[56:59], v[18:21], v[0:3], v[56:59]
ds_read_b128 v[236:239], v248 offset:23808
ds_read_u16_d16 v184, v184
ds_read_u16_d16 v186, v186
v_lshrrev_b32 v185, 18, v185
v_pk_mul_f16 v196, v197, v196
v_mfma_f32_16x16x32_bf16 v[60:63], v[16:19], v[0:3], v[60:63]
v_lshrrev_b32_e64 v187, 18, v187
v_mfma_f32_16x16x32_bf16 v[172:175], v[216:219], v[24:27], 0
ds_read_u16_d16_hi v185, v185
ds_read_u16_d16_hi v187, v187
v_exp_f16 v201, v202
v_and_b32 v189, s49, v189
v_mfma_f32_16x16x32_bf16 v[180:183], v[216:219], v[28:31], 0
v_and_b32 v191, s49, v191
s_waitcnt lgkmcnt(6)
v_mfma_f32_16x16x32_f16 v[68:71], v[220:223], v[208:211], v[68:71]
ds_read_b128 v[216:219], v248 offset:24576
v_exp_f16_e64 v198, v199
v_bfe_u32 v188, v189, 2, 14
v_mfma_f32_16x16x32_f16 v[76:79], v[220:223], v[212:215], v[76:79]
v_bfe_u32 v190, v191, 2, 14
v_exp_f16_e64 v195, v196
v_mfma_f32_16x16x32_bf16 v[168:171], v[224:227], v[32:35], v[168:171]
ds_read_b128 v[220:223], v248 offset:24832
ds_read_u16_d16 v188, v188
ds_read_u16_d16 v190, v190
v_lshrrev_b32 v189, 18, v189
v_lshrrev_b32 v191, 18, v191
v_mfma_f32_16x16x32_bf16 v[176:179], v[224:227], v[36:39], v[176:179]
v_exp_f16_sdwa v201, v202 dst_sel:WORD_1 dst_unused:UNUSED_PRESERVE src0_sel:WORD_1
v_mfma_f32_16x16x32_f16 v[80:83], v[228:231], v[208:211], v[80:83]
ds_read_b128 v[224:227], v249 offset:24576
ds_read_u16_d16_hi v189, v189
ds_read_u16_d16_hi v191, v191
v_and_b32 v193, s49, v193
v_bfe_u32 v192, v193, 2, 14
v_mfma_f32_16x16x32_f16 v[88:91], v[228:231], v[212:215], v[88:91]
v_exp_f16_sdwa v198, v199 dst_sel:WORD_1 dst_unused:UNUSED_PRESERVE src0_sel:WORD_1
s_waitcnt lgkmcnt(7)
v_mfma_f32_16x16x32_f16 v[84:87], v[232:235], v[208:211], v[84:87]
ds_read_b128 v[228:231], v254 offset:7936
ds_read_u16_d16 v192, v192
v_lshrrev_b32_e64 v193, 18, v193
v_mfma_f32_16x16x32_f16 v[92:95], v[232:235], v[212:215], v[92:95]
v_exp_f16_sdwa v195, v196 dst_sel:WORD_1 dst_unused:UNUSED_PRESERVE src0_sel:WORD_1
v_pk_add_f16 v201, v201, 1.0 op_sel_hi:[1,0]
v_pk_add_f16 v198, v198, 1.0 op_sel_hi:[1,0]
v_mfma_f32_16x16x32_bf16 v[172:175], v[236:239], v[32:35], v[172:175]
ds_read_b128 v[232:235], v249 offset:24832
ds_read_u16_d16_hi v193, v193
v_pk_add_f16 v195, v195, 1.0 op_sel_hi:[1,0]
v_mfma_f32_16x16x32_bf16 v[180:183], v[236:239], v[36:39], v[180:183]
v_rcp_f16_e64 v202, v201
s_setprio 0
s_waitcnt lgkmcnt(7)
v_mfma_f32_16x16x32_bf16 v[168:171], v[216:219], v[40:43], v[168:171]
ds_read_b128 v[236:239], v254 offset:7952
v_rcp_f16_e64 v199, v198
v_mfma_f32_16x16x32_bf16 v[176:179], v[216:219], v[44:47], v[176:179]
v_rcp_f16_e64 v196, v195
v_mfma_f32_16x16x32_bf16 v[172:175], v[220:223], v[40:43], v[172:175]
ds_read_b128 v[216:219], v248 offset:28672
v_rcp_f16_sdwa v202, v201 dst_sel:WORD_1 dst_unused:UNUSED_PRESERVE src0_sel:WORD_1
v_mfma_f32_16x16x32_bf16 v[180:183], v[220:223], v[44:47], v[180:183]
v_rcp_f16_sdwa v199, v198 dst_sel:WORD_1 dst_unused:UNUSED_PRESERVE src0_sel:WORD_1
v_or_b32 v208, v184, v185
v_or_b32 v209, v186, v187
s_waitcnt lgkmcnt(4)
v_or_b32 v210, v188, v189
v_rcp_f16_sdwa v196, v195 dst_sel:WORD_1 dst_unused:UNUSED_PRESERVE src0_sel:WORD_1
v_or_b32 v211, v190, v191
s_waitcnt lgkmcnt(2)
v_or_b32_e64 v212, v192, v193
v_pk_mul_f16 v213, v203, v202
v_pk_mul_f16 v214, v200, v199
v_pk_mul_f16 v215, v197, v196
s_setprio 3
v_mfma_f32_16x16x32_f16 v[120:123], v[224:227], v[208:211], v[228:231]
s_add_u32 s46, s80, 12582912
buffer_load_dwordx4 v[100:103], v253, s[32:35], s46 offen offset:256
ds_read_b128 v[220:223], v249 offset:25600
v_cvt_pkrtz_f16_f32 v185, v168, v169
v_cvt_pkrtz_f16_f32 v187, v170, v171
v_mfma_f32_16x16x32_f16 v[128:131], v[224:227], v[212:215], v[228:231]
v_cvt_pkrtz_f16_f32 v189, v172, v173
v_cvt_pkrtz_f16_f32 v191, v174, v175
s_waitcnt lgkmcnt(1)
v_mfma_f32_16x16x32_f16 v[124:127], v[232:235], v[208:211], v[236:239]
ds_read_b128 v[224:227], v254 offset:8064
ds_read_b128 v[228:231], v248 offset:28928
v_cvt_pkrtz_f16_f32 v193, v176, v177
v_cvt_pk_f16_f32 v203, v178, v179
v_mfma_f32_16x16x32_f16 v[132:135], v[232:235], v[212:215], v[236:239]
v_cvt_pk_f16_f32 v200, v180, v181
v_cvt_pk_f16_f32 v197, v182, v183
v_mfma_f32_16x16x32_bf16 v[168:171], v[216:219], v[24:27], 0
ds_read_b128 v[232:235], v249 offset:25856
ds_read_b128 v[236:239], v254 offset:8080
v_pk_fma_f16 v202, v203, v203, s48
v_and_b32_e64 v185, s49, v185
v_mfma_f32_16x16x32_bf16 v[176:179], v[216:219], v[28:31], 0
v_pk_fma_f16 v199, v200, v200, s48
v_and_b32 v187, s49, v187
s_waitcnt lgkmcnt(3)
v_mfma_f32_16x16x32_f16 v[136:139], v[220:223], v[208:211], v[224:227]
ds_read_b128 v[216:219], v248 offset:29696
v_pk_fma_f16 v196, v197, v197, s48
v_bfe_u32 v184, v185, 2, 14
v_pk_mul_f16 v202, v203, v202
v_mfma_f32_16x16x32_f16 v[144:147], v[220:223], v[212:215], v[224:227]
v_bfe_u32 v186, v187, 2, 14
v_pk_mul_f16 v199, v200, v199
s_waitcnt vmcnt(7)
v_mfma_f32_16x16x32_bf16 v[72:75], v[18:21], v[244:247], v[72:75]
ds_read_b128 v[220:223], v249 offset:26624
ds_read_b128 v[224:227], v254 offset:16128
ds_read_u16_d16 v184, v184
ds_read_u16_d16 v186, v186
v_lshrrev_b32 v185, 18, v185
v_pk_mul_f16 v196, v197, v196
v_mfma_f32_16x16x32_bf16 v[76:79], v[16:19], v[244:247], v[76:79]
v_lshrrev_b32 v187, 18, v187
s_waitcnt lgkmcnt(5)
v_mfma_f32_16x16x32_bf16 v[172:175], v[228:231], v[24:27], 0
ds_read_u16_d16_hi v185, v185
ds_read_u16_d16_hi v187, v187
v_exp_f16 v201, v202
v_and_b32 v189, s49, v189
v_mfma_f32_16x16x32_bf16 v[180:183], v[228:231], v[28:31], 0
v_and_b32_e64 v191, s49, v191
v_mfma_f32_16x16x32_f16 v[140:143], v[232:235], v[208:211], v[236:239]
ds_read_b128 v[228:231], v249 offset:26880
v_exp_f16_e64 v198, v199
v_bfe_u32 v188, v189, 2, 14
v_mfma_f32_16x16x32_f16 v[148:151], v[232:235], v[212:215], v[236:239]
v_bfe_u32 v190, v191, 2, 14
v_exp_f16 v195, v196
s_waitcnt lgkmcnt(7)
v_mfma_f32_16x16x32_bf16 v[168:171], v[216:219], v[32:35], v[168:171]
ds_read_b128 v[232:235], v254 offset:16144
ds_read_b128 v[236:239], v248 offset:29952
ds_read_u16_d16 v188, v188
ds_read_u16_d16 v190, v190
v_lshrrev_b32_e64 v189, 18, v189
v_lshrrev_b32 v191, 18, v191
v_mfma_f32_16x16x32_bf16 v[176:179], v[216:219], v[36:39], v[176:179]
v_exp_f16_sdwa v201, v202 dst_sel:WORD_1 dst_unused:UNUSED_PRESERVE src0_sel:WORD_1
s_waitcnt lgkmcnt(7)
v_mfma_f32_16x16x32_f16 v[152:155], v[220:223], v[208:211], v[224:227]
ds_read_b128 v[216:219], v248 offset:30720
ds_read_u16_d16_hi v189, v189
ds_read_u16_d16_hi v191, v191
v_and_b32 v193, s49, v193
v_bfe_u32 v192, v193, 2, 14
v_mfma_f32_16x16x32_f16 v[160:163], v[220:223], v[212:215], v[224:227]
v_exp_f16_sdwa v198, v199 dst_sel:WORD_1 dst_unused:UNUSED_PRESERVE src0_sel:WORD_1
s_waitcnt lgkmcnt(6)
v_mfma_f32_16x16x32_f16 v[156:159], v[228:231], v[208:211], v[232:235]
ds_read_b128 v[220:223], v248 offset:30976
ds_read_b128 v[224:227], v249 offset:30720
ds_read_u16_d16 v192, v192
v_lshrrev_b32 v193, 18, v193
v_mfma_f32_16x16x32_f16 v[164:167], v[228:231], v[212:215], v[232:235]
v_exp_f16_sdwa v195, v196 dst_sel:WORD_1 dst_unused:UNUSED_PRESERVE src0_sel:WORD_1
v_pk_add_f16 v201, v201, 1.0 op_sel_hi:[1,0]
v_pk_add_f16 v198, v198, 1.0 op_sel_hi:[1,0]
s_waitcnt lgkmcnt(7)
v_mfma_f32_16x16x32_bf16 v[172:175], v[236:239], v[32:35], v[172:175]
ds_read_b128 v[228:231], v249 offset:30976
ds_read_b128 v[232:235], v248 offset:34816
ds_read_u16_d16_hi v193, v193
v_pk_add_f16 v195, v195, 1.0 op_sel_hi:[1,0]
v_mfma_f32_16x16x32_bf16 v[180:183], v[236:239], v[36:39], v[180:183]
v_rcp_f16 v202, v201
s_waitcnt lgkmcnt(8)
v_mfma_f32_16x16x32_bf16 v[168:171], v[216:219], v[40:43], v[168:171]
ds_read_b128 v[236:239], v249 offset:31744
v_rcp_f16_e64 v199, v198
v_mfma_f32_16x16x32_bf16 v[176:179], v[216:219], v[44:47], v[176:179]
v_rcp_f16 v196, v195
s_waitcnt lgkmcnt(6)
v_mfma_f32_16x16x32_bf16 v[172:175], v[220:223], v[40:43], v[172:175]
ds_read_b128 v[216:219], v248 offset:35072
v_rcp_f16_sdwa v202, v201 dst_sel:WORD_1 dst_unused:UNUSED_PRESERVE src0_sel:WORD_1
v_mfma_f32_16x16x32_bf16 v[180:183], v[220:223], v[44:47], v[180:183]
v_rcp_f16_sdwa v199, v198 dst_sel:WORD_1 dst_unused:UNUSED_PRESERVE src0_sel:WORD_1
v_or_b32 v208, v184, v185
v_or_b32 v209, v186, v187
v_or_b32_e64 v210, v188, v189
v_rcp_f16_sdwa v196, v195 dst_sel:WORD_1 dst_unused:UNUSED_PRESERVE src0_sel:WORD_1
v_or_b32 v211, v190, v191
s_waitcnt lgkmcnt(2)
v_or_b32_e64 v212, v192, v193
v_pk_mul_f16 v213, v203, v202
v_pk_mul_f16 v214, v200, v199
v_pk_mul_f16 v215, v197, v196
v_mfma_f32_16x16x32_f16 v[120:123], v[224:227], v[208:211], v[120:123]
ds_read_b128 v[220:223], v249 offset:32000
v_cvt_pkrtz_f16_f32 v185, v168, v169
v_cvt_pkrtz_f16_f32 v187, v170, v171
v_cvt_pkrtz_f16_f32 v189, v172, v173
v_mfma_f32_16x16x32_f16 v[128:131], v[224:227], v[212:215], v[128:131]
v_cvt_pkrtz_f16_f32 v191, v174, v175
v_cvt_pkrtz_f16_f32 v193, v176, v177
v_cvt_pk_f16_f32 v203, v178, v179
v_mfma_f32_16x16x32_f16 v[124:127], v[228:231], v[208:211], v[124:127]
ds_read_b128 v[224:227], v248 offset:35840
v_cvt_pk_f16_f32 v200, v180, v181
v_cvt_pk_f16_f32 v197, v182, v183
v_pk_fma_f16 v202, v203, v203, s48
v_mfma_f32_16x16x32_f16 v[132:135], v[228:231], v[212:215], v[132:135]
v_cvt_pk_bf16_f32 v64, v64, v65
v_and_b32_e64 v185, s49, v185
v_cvt_pk_bf16_f32 v65, v66, v67
v_mfma_f32_16x16x32_bf16 v[168:171], v[232:235], v[24:27], 0
ds_read_b128 v[228:231], v249 offset:32768
v_pk_fma_f16 v199, v200, v200, s48
v_and_b32_e64 v187, s49, v187
v_cvt_pk_bf16_f32 v66, v68, v69
v_mfma_f32_16x16x32_bf16 v[176:179], v[232:235], v[28:31], 0
v_pk_fma_f16 v196, v197, v197, s48
v_cvt_pk_bf16_f32 v67, v70, v71
v_bfe_u32 v184, v185, 2, 14
s_setprio 2
s_waitcnt lgkmcnt(2)
v_mfma_f32_16x16x32_f16 v[136:139], v[236:239], v[208:211], v[136:139]
ds_read_b128 v[232:235], v249 offset:33024
ds_read_u16_d16 v184, v184
v_pk_mul_f16 v202, v203, v202
v_cvt_pk_bf16_f32 v48, v48, v49
v_bfe_u32 v186, v187, 2, 14
v_mfma_f32_16x16x32_f16 v[144:147], v[236:239], v[212:215], v[144:147]
v_cvt_pk_bf16_f32 v49, v50, v51
v_pk_mul_f16 v199, v200, v199
v_lshrrev_b32 v185, 18, v185
s_waitcnt vmcnt(6)
v_mfma_f32_16x16x32_bf16 v[88:91], v[18:21], v[204:207], v[88:91]
ds_read_b128 v[236:239], v248 offset:36096
ds_read_u16_d16 v186, v186
ds_read_u16_d16_hi v185, v185
v_cvt_pk_bf16_f32 v50, v52, v53
v_pk_mul_f16 v196, v197, v196
v_lshrrev_b32_e64 v187, 18, v187
v_mfma_f32_16x16x32_bf16 v[92:95], v[16:19], v[204:207], v[92:95]
v_cvt_pk_bf16_f32 v51, v54, v55
v_exp_f16_e64 v201, v202
v_mfma_f32_16x16x32_bf16 v[172:175], v[216:219], v[24:27], 0
ds_read_u16_d16_hi v187, v187
v_cvt_pk_bf16_f32 v80, v80, v81
v_and_b32_e64 v189, s49, v189
v_cvt_pk_bf16_f32 v81, v82, v83
v_mfma_f32_16x16x32_bf16 v[180:183], v[216:219], v[28:31], 0
v_and_b32_e64 v191, s49, v191
v_cvt_pk_bf16_f32 v82, v84, v85
v_mfma_f32_16x16x32_f16 v[140:143], v[220:223], v[208:211], v[140:143]
ds_read_b128 v[216:219], v248 offset:36864
v_exp_f16 v198, v199
v_cvt_pk_bf16_f32 v83, v86, v87
s_mov_b64 vcc, s[74:75]
v_bfe_u32 v188, v189, 2, 14
v_bfe_u32 v190, v191, 2, 14
v_mfma_f32_16x16x32_f16 v[148:151], v[220:223], v[212:215], v[148:151]
v_cndmask_b32 v68, v48, v80, vcc
v_exp_f16_e64 v195, v196
s_waitcnt lgkmcnt(2)
v_mfma_f32_16x16x32_bf16 v[168:171], v[224:227], v[32:35], v[168:171]
ds_read_b128 v[220:223], v248 offset:37120
ds_read_u16_d16 v188, v188
ds_read_u16_d16 v190, v190
v_cndmask_b32 v69, v49, v81, vcc
v_lshrrev_b32_e64 v189, 18, v189
v_cndmask_b32 v70, v50, v82, vcc
v_mfma_f32_16x16x32_bf16 v[176:179], v[224:227], v[36:39], v[176:179]
v_lshrrev_b32 v191, 18, v191
v_cndmask_b32 v71, v51, v83, vcc
v_mfma_f32_16x16x32_f16 v[152:155], v[228:231], v[208:211], v[152:155]
ds_read_b128 v[224:227], v249 offset:36864
ds_read_u16_d16_hi v189, v189
ds_read_u16_d16_hi v191, v191
v_exp_f16_sdwa v201, v202 dst_sel:WORD_1 dst_unused:UNUSED_PRESERVE src0_sel:WORD_1
v_cndmask_b32_dpp v48, v64, v48, vcc quad_perm:[1,0,3,2] row_mask:0xf bank_mask:0xf
v_and_b32_e64 v193, s49, v193
v_mfma_f32_16x16x32_f16 v[160:163], v[228:231], v[212:215], v[160:163]
v_cndmask_b32_dpp v49, v65, v49, vcc quad_perm:[1,0,3,2] row_mask:0xf bank_mask:0xf
v_bfe_u32 v192, v193, 2, 14
v_mfma_f32_16x16x32_f16 v[156:159], v[232:235], v[208:211], v[156:159]
ds_read_b128 v[228:231], v249 offset:37120
ds_read_u16_d16 v192, v192
v_exp_f16_sdwa v198, v199 dst_sel:WORD_1 dst_unused:UNUSED_PRESERVE src0_sel:WORD_1
v_cndmask_b32_dpp v50, v66, v50, vcc quad_perm:[1,0,3,2] row_mask:0xf bank_mask:0xf
v_lshrrev_b32 v193, 18, v193
v_mfma_f32_16x16x32_f16 v[164:167], v[232:235], v[212:215], v[164:167]
v_cndmask_b32_dpp v51, v67, v51, vcc quad_perm:[1,0,3,2] row_mask:0xf bank_mask:0xf
s_not_b64 vcc, s[74:75]
v_exp_f16_sdwa v195, v196 dst_sel:WORD_1 dst_unused:UNUSED_PRESERVE src0_sel:WORD_1
v_mfma_f32_16x16x32_bf16 v[172:175], v[236:239], v[32:35], v[172:175]
ds_read_b128 v[232:235], v248 offset:40960
ds_read_u16_d16_hi v193, v193
v_cndmask_b32_dpp v80, v64, v80, vcc quad_perm:[1,0,3,2] row_mask:0xf bank_mask:0xf
v_pk_add_f16 v201, v201, 1.0 op_sel_hi:[1,0]
v_cndmask_b32_dpp v81, v65, v81, vcc quad_perm:[1,0,3,2] row_mask:0xf bank_mask:0xf
v_mfma_f32_16x16x32_bf16 v[180:183], v[236:239], v[36:39], v[180:183]
v_pk_add_f16 v198, v198, 1.0 op_sel_hi:[1,0]
v_cndmask_b32_dpp v82, v66, v82, vcc quad_perm:[1,0,3,2] row_mask:0xf bank_mask:0xf
v_pk_add_f16 v195, v195, 1.0 op_sel_hi:[1,0]
s_waitcnt lgkmcnt(4)
v_mfma_f32_16x16x32_bf16 v[168:171], v[216:219], v[40:43], v[168:171]
ds_read_b128 v[236:239], v249 offset:37888
v_rcp_f16 v202, v201
v_cndmask_b32_dpp v83, v67, v83, vcc quad_perm:[1,0,3,2] row_mask:0xf bank_mask:0xf
v_mfma_f32_16x16x32_bf16 v[176:179], v[216:219], v[44:47], v[176:179]
v_rcp_f16_e64 v199, v198
v_mfma_f32_16x16x32_bf16 v[172:175], v[220:223], v[40:43], v[172:175]
ds_read_b128 v[216:219], v248 offset:41216
buffer_store_dwordx4 v[48:51], v255, s[8:11], s70 offen sc1
v_rcp_f16_e64 v196, v195
v_rcp_f16_sdwa v202, v201 dst_sel:WORD_1 dst_unused:UNUSED_PRESERVE src0_sel:WORD_1
v_mfma_f32_16x16x32_bf16 v[180:183], v[220:223], v[44:47], v[180:183]
v_rcp_f16_sdwa v199, v198 dst_sel:WORD_1 dst_unused:UNUSED_PRESERVE src0_sel:WORD_1
v_or_b32 v208, v184, v185
v_or_b32 v209, v186, v187
v_or_b32_e64 v210, v188, v189
v_rcp_f16_sdwa v196, v195 dst_sel:WORD_1 dst_unused:UNUSED_PRESERVE src0_sel:WORD_1
v_or_b32 v211, v190, v191
s_waitcnt lgkmcnt(2)
v_or_b32_e64 v212, v192, v193
v_pk_mul_f16 v213, v203, v202
v_pk_mul_f16 v214, v200, v199
v_pk_mul_f16 v215, v197, v196
v_mfma_f32_16x16x32_f16 v[120:123], v[224:227], v[208:211], v[120:123]
s_add_u32 s46, s80, 16777216
buffer_load_dwordx4 v[104:107], v253, s[32:35], s46 offen
ds_read_b128 v[220:223], v249 offset:38144
v_cvt_pkrtz_f16_f32 v185, v168, v169
v_cvt_pkrtz_f16_f32 v187, v170, v171
v_mfma_f32_16x16x32_f16 v[128:131], v[224:227], v[212:215], v[128:131]
v_cvt_pkrtz_f16_f32 v189, v172, v173
v_cvt_pkrtz_f16_f32 v191, v174, v175
v_mfma_f32_16x16x32_f16 v[124:127], v[228:231], v[208:211], v[124:127]
ds_read_b128 v[224:227], v248 offset:41984
v_cvt_pkrtz_f16_f32 v193, v176, v177
v_cvt_pk_f16_f32 v203, v178, v179
v_cvt_pk_f16_f32 v200, v180, v181
v_mfma_f32_16x16x32_f16 v[132:135], v[228:231], v[212:215], v[132:135]
v_cvt_pk_f16_f32 v197, v182, v183
s_setprio 1
v_pk_fma_f16 v202, v203, v203, s48
v_mfma_f32_16x16x32_bf16 v[168:171], v[232:235], v[24:27], 0
ds_read_b128 v[228:231], v249 offset:38912
v_and_b32 v185, s49, v185
v_pk_fma_f16 v199, v200, v200, s48
v_mfma_f32_16x16x32_bf16 v[176:179], v[232:235], v[28:31], 0
v_and_b32 v187, s49, v187
v_pk_fma_f16 v196, v197, v197, s48
v_bfe_u32 v184, v185, 2, 14
s_waitcnt lgkmcnt(3)
v_mfma_f32_16x16x32_f16 v[136:139], v[236:239], v[208:211], v[136:139]
ds_read_b128 v[232:235], v249 offset:39168
ds_read_u16_d16 v184, v184
v_pk_mul_f16 v202, v203, v202
v_bfe_u32 v186, v187, 2, 14
v_mfma_f32_16x16x32_f16 v[144:147], v[236:239], v[212:215], v[144:147]
v_pk_mul_f16 v199, v200, v199
v_lshrrev_b32_e64 v185, 18, v185
v_mfma_f32_16x16x32_bf16 v[172:175], v[216:219], v[24:27], 0
ds_read_b128 v[236:239], v248 offset:42240
ds_read_u16_d16 v186, v186
ds_read_u16_d16_hi v185, v185
v_pk_mul_f16 v196, v197, v196
v_lshrrev_b32_e64 v187, 18, v187
v_mfma_f32_16x16x32_bf16 v[180:183], v[216:219], v[28:31], 0
v_exp_f16_e64 v201, v202
v_and_b32 v189, s49, v189
s_waitcnt lgkmcnt(5)
v_mfma_f32_16x16x32_f16 v[140:143], v[220:223], v[208:211], v[140:143]
ds_read_b128 v[216:219], v248 offset:43008
ds_read_u16_d16_hi v187, v187
v_and_b32_e64 v191, s49, v191
v_mfma_f32_16x16x32_f16 v[148:151], v[220:223], v[212:215], v[148:151]
v_exp_f16_e64 v198, v199
v_bfe_u32 v188, v189, 2, 14
v_bfe_u32 v190, v191, 2, 14
v_mfma_f32_16x16x32_bf16 v[168:171], v[224:227], v[32:35], v[168:171]
ds_read_b128 v[220:223], v248 offset:43264
ds_read_u16_d16 v188, v188
ds_read_u16_d16 v190, v190
v_exp_f16_e64 v195, v196
v_mfma_f32_16x16x32_bf16 v[176:179], v[224:227], v[36:39], v[176:179]
v_lshrrev_b32 v189, 18, v189
v_lshrrev_b32 v191, 18, v191
v_mfma_f32_16x16x32_f16 v[152:155], v[228:231], v[208:211], v[152:155]
ds_read_b128 v[224:227], v249 offset:43008
ds_read_u16_d16_hi v189, v189
ds_read_u16_d16_hi v191, v191
v_exp_f16_sdwa v201, v202 dst_sel:WORD_1 dst_unused:UNUSED_PRESERVE src0_sel:WORD_1
v_and_b32 v193, s49, v193
v_mfma_f32_16x16x32_f16 v[160:163], v[228:231], v[212:215], v[160:163]
v_bfe_u32 v192, v193, 2, 14
s_waitcnt lgkmcnt(8)
v_mfma_f32_16x16x32_f16 v[156:159], v[232:235], v[208:211], v[156:159]
ds_read_b128 v[228:231], v249 offset:43264
ds_read_u16_d16 v192, v192
v_exp_f16_sdwa v198, v199 dst_sel:WORD_1 dst_unused:UNUSED_PRESERVE src0_sel:WORD_1
v_lshrrev_b32_e64 v193, 18, v193
v_mfma_f32_16x16x32_f16 v[164:167], v[232:235], v[212:215], v[164:167]
v_exp_f16_sdwa v195, v196 dst_sel:WORD_1 dst_unused:UNUSED_PRESERVE src0_sel:WORD_1
v_pk_add_f16 v201, v201, 1.0 op_sel_hi:[1,0]
v_mfma_f32_16x16x32_bf16 v[172:175], v[236:239], v[32:35], v[172:175]
ds_read_b128 v[232:235], v248 offset:47104
ds_read_u16_d16_hi v193, v193
v_pk_add_f16 v198, v198, 1.0 op_sel_hi:[1,0]
v_pk_add_f16 v195, v195, 1.0 op_sel_hi:[1,0]
v_mfma_f32_16x16x32_bf16 v[180:183], v[236:239], v[36:39], v[180:183]
v_rcp_f16_e64 v202, v201
s_setprio 0
s_waitcnt lgkmcnt(7)
v_mfma_f32_16x16x32_bf16 v[168:171], v[216:219], v[40:43], v[168:171]
ds_read_b128 v[236:239], v249 offset:44032
v_rcp_f16_e64 v199, v198
v_mfma_f32_16x16x32_bf16 v[176:179], v[216:219], v[44:47], v[176:179]
v_rcp_f16_e64 v196, v195
v_mfma_f32_16x16x32_bf16 v[172:175], v[220:223], v[40:43], v[172:175]
ds_read_b128 v[216:219], v248 offset:47360
v_rcp_f16_sdwa v202, v201 dst_sel:WORD_1 dst_unused:UNUSED_PRESERVE src0_sel:WORD_1
v_mfma_f32_16x16x32_bf16 v[180:183], v[220:223], v[44:47], v[180:183]
v_rcp_f16_sdwa v199, v198 dst_sel:WORD_1 dst_unused:UNUSED_PRESERVE src0_sel:WORD_1
v_or_b32 v208, v184, v185
v_or_b32 v209, v186, v187
s_waitcnt lgkmcnt(4)
v_or_b32 v210, v188, v189
v_rcp_f16_sdwa v196, v195 dst_sel:WORD_1 dst_unused:UNUSED_PRESERVE src0_sel:WORD_1
v_or_b32 v211, v190, v191
s_waitcnt lgkmcnt(2)
v_or_b32 v212, v192, v193
v_pk_mul_f16 v213, v203, v202
v_pk_mul_f16 v214, v200, v199
v_pk_mul_f16 v215, v197, v196
s_setprio 3
v_mfma_f32_16x16x32_f16 v[120:123], v[224:227], v[208:211], v[120:123]
buffer_store_dwordx4 v[68:71], v255, s[8:11], s70 offen offset:128 sc1
ds_read_b128 v[220:223], v249 offset:44288
v_cvt_pkrtz_f16_f32 v185, v168, v169
v_cvt_pkrtz_f16_f32 v187, v170, v171
v_mfma_f32_16x16x32_f16 v[128:131], v[224:227], v[212:215], v[128:131]
v_cvt_pkrtz_f16_f32 v189, v172, v173
v_cvt_pkrtz_f16_f32 v191, v174, v175
v_mfma_f32_16x16x32_f16 v[124:127], v[228:231], v[208:211], v[124:127]
ds_read_b128 v[224:227], v248 offset:48128
v_cvt_pkrtz_f16_f32 v193, v176, v177
v_cvt_pk_f16_f32 v203, v178, v179
v_cvt_pk_f16_f32 v200, v180, v181
v_mfma_f32_16x16x32_f16 v[132:135], v[228:231], v[212:215], v[132:135]
v_cvt_pk_f16_f32 v197, v182, v183
v_pk_fma_f16 v202, v203, v203, s48
v_mfma_f32_16x16x32_bf16 v[168:171], v[232:235], v[24:27], 0
ds_read_b128 v[228:231], v249 offset:45056
v_and_b32_e64 v185, s49, v185
v_pk_fma_f16 v199, v200, v200, s48
v_mfma_f32_16x16x32_bf16 v[176:179], v[232:235], v[28:31], 0
v_and_b32 v187, s49, v187
v_pk_fma_f16 v196, v197, v197, s48
v_bfe_u32 v184, v185, 2, 14
s_waitcnt lgkmcnt(3)
v_mfma_f32_16x16x32_f16 v[136:139], v[236:239], v[208:211], v[136:139]
ds_read_b128 v[232:235], v249 offset:45312
ds_read_u16_d16 v184, v184
v_pk_mul_f16 v202, v203, v202
v_bfe_u32 v186, v187, 2, 14
v_mfma_f32_16x16x32_f16 v[144:147], v[236:239], v[212:215], v[144:147]
v_pk_mul_f16 v199, v200, v199
v_lshrrev_b32_e64 v185, 18, v185
v_mfma_f32_16x16x32_bf16 v[172:175], v[216:219], v[24:27], 0
ds_read_b128 v[236:239], v248 offset:48384
ds_read_u16_d16 v186, v186
ds_read_u16_d16_hi v185, v185
v_pk_mul_f16 v196, v197, v196
v_lshrrev_b32_e64 v187, 18, v187
v_mfma_f32_16x16x32_bf16 v[180:183], v[216:219], v[28:31], 0
v_exp_f16_e64 v201, v202
v_and_b32 v189, s49, v189
s_waitcnt lgkmcnt(5)
v_mfma_f32_16x16x32_f16 v[140:143], v[220:223], v[208:211], v[140:143]
ds_read_b128 v[216:219], v248 offset:49152
ds_read_u16_d16_hi v187, v187
v_and_b32_e64 v191, s49, v191
v_mfma_f32_16x16x32_f16 v[148:151], v[220:223], v[212:215], v[148:151]
v_exp_f16_e64 v198, v199
v_bfe_u32 v188, v189, 2, 14
v_bfe_u32 v190, v191, 2, 14
v_mfma_f32_16x16x32_bf16 v[168:171], v[224:227], v[32:35], v[168:171]
ds_read_b128 v[220:223], v248 offset:49408
ds_read_u16_d16 v188, v188
ds_read_u16_d16 v190, v190
v_exp_f16_e64 v195, v196
v_mfma_f32_16x16x32_bf16 v[176:179], v[224:227], v[36:39], v[176:179]
v_lshrrev_b32 v189, 18, v189
v_lshrrev_b32 v191, 18, v191
v_mfma_f32_16x16x32_f16 v[152:155], v[228:231], v[208:211], v[152:155]
ds_read_b128 v[224:227], v249 offset:49152
ds_read_u16_d16_hi v189, v189
ds_read_u16_d16_hi v191, v191
v_exp_f16_sdwa v201, v202 dst_sel:WORD_1 dst_unused:UNUSED_PRESERVE src0_sel:WORD_1
v_and_b32 v193, s49, v193
v_mfma_f32_16x16x32_f16 v[160:163], v[228:231], v[212:215], v[160:163]
v_bfe_u32 v192, v193, 2, 14
s_waitcnt lgkmcnt(8)
v_mfma_f32_16x16x32_f16 v[156:159], v[232:235], v[208:211], v[156:159]
ds_read_b128 v[228:231], v249 offset:49408
ds_read_u16_d16 v192, v192
v_exp_f16_sdwa v198, v199 dst_sel:WORD_1 dst_unused:UNUSED_PRESERVE src0_sel:WORD_1
v_lshrrev_b32_e64 v193, 18, v193
v_mfma_f32_16x16x32_f16 v[164:167], v[232:235], v[212:215], v[164:167]
v_exp_f16_sdwa v195, v196 dst_sel:WORD_1 dst_unused:UNUSED_PRESERVE src0_sel:WORD_1
v_pk_add_f16 v201, v201, 1.0 op_sel_hi:[1,0]
v_mfma_f32_16x16x32_bf16 v[172:175], v[236:239], v[32:35], v[172:175]
ds_read_b128 v[232:235], v248 offset:53248
ds_read_u16_d16_hi v193, v193
v_pk_add_f16 v198, v198, 1.0 op_sel_hi:[1,0]
v_pk_add_f16 v195, v195, 1.0 op_sel_hi:[1,0]
v_mfma_f32_16x16x32_bf16 v[180:183], v[236:239], v[36:39], v[180:183]
v_rcp_f16 v202, v201
s_waitcnt lgkmcnt(7)
v_mfma_f32_16x16x32_bf16 v[168:171], v[216:219], v[40:43], v[168:171]
ds_read_b128 v[236:239], v249 offset:50176
v_rcp_f16_e64 v199, v198
v_mfma_f32_16x16x32_bf16 v[176:179], v[216:219], v[44:47], v[176:179]
v_rcp_f16_e64 v196, v195
v_mfma_f32_16x16x32_bf16 v[172:175], v[220:223], v[40:43], v[172:175]
ds_read_b128 v[216:219], v248 offset:53504
v_rcp_f16_sdwa v202, v201 dst_sel:WORD_1 dst_unused:UNUSED_PRESERVE src0_sel:WORD_1
v_mfma_f32_16x16x32_bf16 v[180:183], v[220:223], v[44:47], v[180:183]
v_rcp_f16_sdwa v199, v198 dst_sel:WORD_1 dst_unused:UNUSED_PRESERVE src0_sel:WORD_1
v_or_b32 v208, v184, v185
v_or_b32 v209, v186, v187
s_waitcnt lgkmcnt(4)
v_or_b32 v210, v188, v189
v_rcp_f16_sdwa v196, v195 dst_sel:WORD_1 dst_unused:UNUSED_PRESERVE src0_sel:WORD_1
v_or_b32 v211, v190, v191
s_waitcnt lgkmcnt(2)
v_or_b32_e64 v212, v192, v193
v_pk_mul_f16 v213, v203, v202
v_pk_mul_f16 v214, v200, v199
v_pk_mul_f16 v215, v197, v196
v_mfma_f32_16x16x32_f16 v[120:123], v[224:227], v[208:211], v[120:123]
s_add_u32 s46, s80, 16777216
buffer_load_dwordx4 v[108:111], v253, s[32:35], s46 offen offset:256
ds_read_b128 v[220:223], v249 offset:50432
v_cvt_pkrtz_f16_f32 v185, v168, v169
v_cvt_pkrtz_f16_f32 v187, v170, v171
v_mfma_f32_16x16x32_f16 v[128:131], v[224:227], v[212:215], v[128:131]
v_cvt_pkrtz_f16_f32 v189, v172, v173
v_cvt_pkrtz_f16_f32 v191, v174, v175
v_mfma_f32_16x16x32_f16 v[124:127], v[228:231], v[208:211], v[124:127]
ds_read_b128 v[224:227], v248 offset:54272
v_cvt_pkrtz_f16_f32 v193, v176, v177
v_cvt_pk_f16_f32 v203, v178, v179
v_cvt_pk_f16_f32 v200, v180, v181
v_mfma_f32_16x16x32_f16 v[132:135], v[228:231], v[212:215], v[132:135]
v_cvt_pk_f16_f32 v197, v182, v183
v_pk_fma_f16 v202, v203, v203, s48
v_mfma_f32_16x16x32_bf16 v[168:171], v[232:235], v[24:27], 0
ds_read_b128 v[228:231], v249 offset:51200
v_and_b32_e64 v185, s49, v185
v_pk_fma_f16 v199, v200, v200, s48
v_mfma_f32_16x16x32_bf16 v[176:179], v[232:235], v[28:31], 0
v_and_b32_e64 v187, s49, v187
v_pk_fma_f16 v196, v197, v197, s48
s_setprio 2
v_bfe_u32 v184, v185, 2, 14
s_waitcnt lgkmcnt(3)
v_mfma_f32_16x16x32_f16 v[136:139], v[236:239], v[208:211], v[136:139]
ds_read_b128 v[232:235], v249 offset:51456
ds_read_u16_d16 v184, v184
v_pk_mul_f16 v202, v203, v202
v_bfe_u32 v186, v187, 2, 14
v_mfma_f32_16x16x32_f16 v[144:147], v[236:239], v[212:215], v[144:147]
v_pk_mul_f16 v199, v200, v199
v_lshrrev_b32_e64 v185, 18, v185
v_mfma_f32_16x16x32_bf16 v[172:175], v[216:219], v[24:27], 0
ds_read_b128 v[236:239], v248 offset:54528
ds_read_u16_d16 v186, v186
ds_read_u16_d16_hi v185, v185
v_pk_mul_f16 v196, v197, v196
v_lshrrev_b32_e64 v187, 18, v187
v_mfma_f32_16x16x32_bf16 v[180:183], v[216:219], v[28:31], 0
v_exp_f16_e64 v201, v202
v_and_b32 v189, s49, v189
s_waitcnt lgkmcnt(5)
v_mfma_f32_16x16x32_f16 v[140:143], v[220:223], v[208:211], v[140:143]
ds_read_b128 v[216:219], v248 offset:55296
ds_read_u16_d16_hi v187, v187
v_and_b32_e64 v191, s49, v191
v_mfma_f32_16x16x32_f16 v[148:151], v[220:223], v[212:215], v[148:151]
v_exp_f16_e64 v198, v199
v_bfe_u32 v188, v189, 2, 14
v_bfe_u32 v190, v191, 2, 14
v_mfma_f32_16x16x32_bf16 v[168:171], v[224:227], v[32:35], v[168:171]
ds_read_b128 v[220:223], v248 offset:55552
ds_read_u16_d16 v188, v188
ds_read_u16_d16 v190, v190
v_exp_f16_e64 v195, v196
v_mfma_f32_16x16x32_bf16 v[176:179], v[224:227], v[36:39], v[176:179]
v_lshrrev_b32 v189, 18, v189
v_lshrrev_b32 v191, 18, v191
v_mfma_f32_16x16x32_f16 v[152:155], v[228:231], v[208:211], v[152:155]
ds_read_b128 v[224:227], v249 offset:55296
ds_read_u16_d16_hi v189, v189
ds_read_u16_d16_hi v191, v191
v_exp_f16_sdwa v201, v202 dst_sel:WORD_1 dst_unused:UNUSED_PRESERVE src0_sel:WORD_1
v_and_b32 v193, s49, v193
v_mfma_f32_16x16x32_f16 v[160:163], v[228:231], v[212:215], v[160:163]
v_bfe_u32 v192, v193, 2, 14
s_waitcnt lgkmcnt(8)
v_mfma_f32_16x16x32_f16 v[156:159], v[232:235], v[208:211], v[156:159]
ds_read_b128 v[228:231], v249 offset:55552
ds_read_u16_d16 v192, v192
v_exp_f16_sdwa v198, v199 dst_sel:WORD_1 dst_unused:UNUSED_PRESERVE src0_sel:WORD_1
v_lshrrev_b32_e64 v193, 18, v193
v_mfma_f32_16x16x32_f16 v[164:167], v[232:235], v[212:215], v[164:167]
v_exp_f16_sdwa v195, v196 dst_sel:WORD_1 dst_unused:UNUSED_PRESERVE src0_sel:WORD_1
v_pk_add_f16 v201, v201, 1.0 op_sel_hi:[1,0]
v_mfma_f32_16x16x32_bf16 v[172:175], v[236:239], v[32:35], v[172:175]
ds_read_b128 v[232:235], v248 offset:59392
ds_read_u16_d16_hi v193, v193
v_pk_add_f16 v198, v198, 1.0 op_sel_hi:[1,0]
v_pk_add_f16 v195, v195, 1.0 op_sel_hi:[1,0]
v_mfma_f32_16x16x32_bf16 v[180:183], v[236:239], v[36:39], v[180:183]
v_rcp_f16 v202, v201
s_waitcnt lgkmcnt(7)
v_mfma_f32_16x16x32_bf16 v[168:171], v[216:219], v[40:43], v[168:171]
ds_read_b128 v[236:239], v249 offset:56320
v_rcp_f16_e64 v199, v198
v_mfma_f32_16x16x32_bf16 v[176:179], v[216:219], v[44:47], v[176:179]
v_rcp_f16_e64 v196, v195
v_mfma_f32_16x16x32_bf16 v[172:175], v[220:223], v[40:43], v[172:175]
ds_read_b128 v[216:219], v248 offset:59648
v_rcp_f16_sdwa v202, v201 dst_sel:WORD_1 dst_unused:UNUSED_PRESERVE src0_sel:WORD_1
v_mfma_f32_16x16x32_bf16 v[180:183], v[220:223], v[44:47], v[180:183]
v_rcp_f16_sdwa v199, v198 dst_sel:WORD_1 dst_unused:UNUSED_PRESERVE src0_sel:WORD_1
v_or_b32 v208, v184, v185
v_or_b32 v209, v186, v187
s_waitcnt lgkmcnt(4)
v_or_b32 v210, v188, v189
v_rcp_f16_sdwa v196, v195 dst_sel:WORD_1 dst_unused:UNUSED_PRESERVE src0_sel:WORD_1
v_or_b32 v211, v190, v191
s_waitcnt lgkmcnt(2)
v_or_b32_e64 v212, v192, v193
v_pk_mul_f16 v213, v203, v202
v_pk_mul_f16 v214, v200, v199
v_pk_mul_f16 v215, v197, v196
v_mfma_f32_16x16x32_f16 v[120:123], v[224:227], v[208:211], v[120:123]
buffer_load_dwordx4 v[204:207], v252, s[4:7], s68 offen
ds_read_b128 v[220:223], v249 offset:56576
v_cvt_pkrtz_f16_f32 v185, v168, v169
v_cvt_pkrtz_f16_f32 v187, v170, v171
v_mfma_f32_16x16x32_f16 v[128:131], v[224:227], v[212:215], v[128:131]
v_cvt_pkrtz_f16_f32 v189, v172, v173
v_cvt_pkrtz_f16_f32 v191, v174, v175
v_mfma_f32_16x16x32_f16 v[124:127], v[228:231], v[208:211], v[124:127]
ds_read_b128 v[224:227], v248 offset:60416
v_cvt_pkrtz_f16_f32 v193, v176, v177
v_cvt_pk_f16_f32 v203, v178, v179
v_cvt_pk_f16_f32 v200, v180, v181
v_mfma_f32_16x16x32_f16 v[132:135], v[228:231], v[212:215], v[132:135]
v_cvt_pk_f16_f32 v197, v182, v183
s_setprio 1
v_pk_fma_f16 v202, v203, v203, s48
v_mfma_f32_16x16x32_bf16 v[168:171], v[232:235], v[24:27], 0
ds_read_b128 v[228:231], v249 offset:57344
v_and_b32 v185, s49, v185
v_pk_fma_f16 v199, v200, v200, s48
v_mfma_f32_16x16x32_bf16 v[176:179], v[232:235], v[28:31], 0
v_and_b32 v187, s49, v187
v_pk_fma_f16 v196, v197, v197, s48
v_bfe_u32 v184, v185, 2, 14
s_waitcnt lgkmcnt(3)
v_mfma_f32_16x16x32_f16 v[136:139], v[236:239], v[208:211], v[136:139]
ds_read_b128 v[232:235], v249 offset:57600
ds_read_u16_d16 v184, v184
v_pk_mul_f16 v202, v203, v202
v_bfe_u32 v186, v187, 2, 14
v_mfma_f32_16x16x32_f16 v[144:147], v[236:239], v[212:215], v[144:147]
v_pk_mul_f16 v199, v200, v199
v_lshrrev_b32_e64 v185, 18, v185
v_mfma_f32_16x16x32_bf16 v[172:175], v[216:219], v[24:27], 0
ds_read_b128 v[236:239], v248 offset:60672
ds_read_u16_d16 v186, v186
ds_read_u16_d16_hi v185, v185
v_pk_mul_f16 v196, v197, v196
v_lshrrev_b32_e64 v187, 18, v187
v_mfma_f32_16x16x32_bf16 v[180:183], v[216:219], v[28:31], 0
v_exp_f16_e64 v201, v202
v_and_b32 v189, s49, v189
s_waitcnt lgkmcnt(5)
v_mfma_f32_16x16x32_f16 v[140:143], v[220:223], v[208:211], v[140:143]
ds_read_b128 v[216:219], v248 offset:61440
ds_read_u16_d16_hi v187, v187
v_and_b32_e64 v191, s49, v191
v_mfma_f32_16x16x32_f16 v[148:151], v[220:223], v[212:215], v[148:151]
v_exp_f16_e64 v198, v199
v_bfe_u32 v188, v189, 2, 14
v_bfe_u32 v190, v191, 2, 14
v_mfma_f32_16x16x32_bf16 v[168:171], v[224:227], v[32:35], v[168:171]
buffer_store_dwordx4 v[80:83], v255, s[8:11], s70 offen offset:256 sc1
ds_read_b128 v[220:223], v248 offset:61696
ds_read_u16_d16 v188, v188
ds_read_u16_d16 v190, v190
v_exp_f16_e64 v195, v196
v_mfma_f32_16x16x32_bf16 v[176:179], v[224:227], v[36:39], v[176:179]
v_lshrrev_b32 v189, 18, v189
v_lshrrev_b32 v191, 18, v191
v_mfma_f32_16x16x32_f16 v[152:155], v[228:231], v[208:211], v[152:155]
ds_read_b128 v[224:227], v249 offset:61440
ds_read_u16_d16_hi v189, v189
ds_read_u16_d16_hi v191, v191
v_exp_f16_sdwa v201, v202 dst_sel:WORD_1 dst_unused:UNUSED_PRESERVE src0_sel:WORD_1
v_and_b32 v193, s49, v193
v_mfma_f32_16x16x32_f16 v[160:163], v[228:231], v[212:215], v[160:163]
v_bfe_u32 v192, v193, 2, 14
s_waitcnt lgkmcnt(8)
v_mfma_f32_16x16x32_f16 v[156:159], v[232:235], v[208:211], v[156:159]
ds_read_b128 v[228:231], v249 offset:61696
ds_read_u16_d16 v192, v192
v_exp_f16_sdwa v198, v199 dst_sel:WORD_1 dst_unused:UNUSED_PRESERVE src0_sel:WORD_1
v_lshrrev_b32_e64 v193, 18, v193
v_mfma_f32_16x16x32_f16 v[164:167], v[232:235], v[212:215], v[164:167]
v_exp_f16_sdwa v195, v196 dst_sel:WORD_1 dst_unused:UNUSED_PRESERVE src0_sel:WORD_1
v_pk_add_f16 v201, v201, 1.0 op_sel_hi:[1,0]
v_mfma_f32_16x16x32_bf16 v[172:175], v[236:239], v[32:35], v[172:175]
ds_read_b128 v[232:235], v249
ds_read_u16_d16_hi v193, v193
v_pk_add_f16 v198, v198, 1.0 op_sel_hi:[1,0]
v_pk_add_f16 v195, v195, 1.0 op_sel_hi:[1,0]
v_mfma_f32_16x16x32_bf16 v[180:183], v[236:239], v[36:39], v[180:183]
v_rcp_f16_e64 v202, v201
s_setprio 0
s_waitcnt lgkmcnt(7)
v_mfma_f32_16x16x32_bf16 v[168:171], v[216:219], v[40:43], v[168:171]
ds_read_b128 v[236:239], v249 offset:62464
v_rcp_f16_e64 v199, v198
v_mfma_f32_16x16x32_bf16 v[176:179], v[216:219], v[44:47], v[176:179]
v_rcp_f16_e64 v196, v195
v_mfma_f32_16x16x32_bf16 v[172:175], v[220:223], v[40:43], v[172:175]
ds_read_b128 v[216:219], v249 offset:256
v_rcp_f16_sdwa v202, v201 dst_sel:WORD_1 dst_unused:UNUSED_PRESERVE src0_sel:WORD_1
v_mfma_f32_16x16x32_bf16 v[180:183], v[220:223], v[44:47], v[180:183]
v_rcp_f16_sdwa v199, v198 dst_sel:WORD_1 dst_unused:UNUSED_PRESERVE src0_sel:WORD_1
v_or_b32 v208, v184, v185
v_or_b32 v209, v186, v187
s_waitcnt lgkmcnt(4)
v_or_b32 v210, v188, v189
v_rcp_f16_sdwa v196, v195 dst_sel:WORD_1 dst_unused:UNUSED_PRESERVE src0_sel:WORD_1
v_or_b32 v211, v190, v191
s_waitcnt lgkmcnt(2)
v_or_b32 v212, v192, v193
v_pk_mul_f16 v213, v203, v202
v_pk_mul_f16 v214, v200, v199
v_pk_mul_f16 v215, v197, v196
s_setprio 3
v_mfma_f32_16x16x32_f16 v[120:123], v[224:227], v[208:211], v[120:123]
buffer_load_dwordx4 v[244:247], v252, s[4:7], s68 offen offset:64
ds_read_b128 v[220:223], v249 offset:62720
v_cvt_pkrtz_f16_f32 v185, v168, v169
v_cvt_pkrtz_f16_f32 v187, v170, v171
v_mfma_f32_16x16x32_f16 v[128:131], v[224:227], v[212:215], v[128:131]
v_cvt_pkrtz_f16_f32 v189, v172, v173
v_cvt_pkrtz_f16_f32 v191, v174, v175
v_mfma_f32_16x16x32_f16 v[124:127], v[228:231], v[208:211], v[124:127]
ds_read_b128 v[224:227], v249 offset:1024
v_cvt_pkrtz_f16_f32 v193, v176, v177
v_cvt_pk_f16_f32 v203, v178, v179
v_cvt_pk_f16_f32 v200, v180, v181
v_mfma_f32_16x16x32_f16 v[132:135], v[228:231], v[212:215], v[132:135]
v_cvt_pk_f16_f32 v197, v182, v183
v_pk_fma_f16 v202, v203, v203, s48
v_mfma_f32_16x16x32_bf16 v[168:171], v[232:235], v[24:27], 0
ds_read_b128 v[228:231], v249 offset:63488
v_and_b32_e64 v185, s49, v185
v_pk_fma_f16 v199, v200, v200, s48
v_mfma_f32_16x16x32_bf16 v[176:179], v[232:235], v[28:31], 0
v_and_b32 v187, s49, v187
v_pk_fma_f16 v196, v197, v197, s48
v_bfe_u32 v184, v185, 2, 14
s_waitcnt lgkmcnt(3)
v_mfma_f32_16x16x32_f16 v[136:139], v[236:239], v[208:211], v[136:139]
ds_read_b128 v[232:235], v249 offset:63744
ds_read_u16_d16 v184, v184
v_pk_mul_f16 v202, v203, v202
v_bfe_u32 v186, v187, 2, 14
v_mfma_f32_16x16x32_f16 v[144:147], v[236:239], v[212:215], v[144:147]
v_pk_mul_f16 v199, v200, v199
v_lshrrev_b32_e64 v185, 18, v185
v_mfma_f32_16x16x32_bf16 v[172:175], v[216:219], v[24:27], 0
ds_read_b128 v[236:239], v249 offset:1280
ds_read_u16_d16 v186, v186
ds_read_u16_d16_hi v185, v185
v_pk_mul_f16 v196, v197, v196
v_lshrrev_b32_e64 v187, 18, v187
v_mfma_f32_16x16x32_bf16 v[180:183], v[216:219], v[28:31], 0
v_exp_f16_e64 v201, v202
v_and_b32 v189, s49, v189
s_waitcnt lgkmcnt(5)
v_mfma_f32_16x16x32_f16 v[140:143], v[220:223], v[208:211], v[140:143]
ds_read_b128 v[216:219], v249 offset:2048
ds_read_u16_d16_hi v187, v187
v_and_b32_e64 v191, s49, v191
v_mfma_f32_16x16x32_f16 v[148:151], v[220:223], v[212:215], v[148:151]
v_exp_f16_e64 v198, v199
v_bfe_u32 v188, v189, 2, 14
v_bfe_u32 v190, v191, 2, 14
v_mfma_f32_16x16x32_bf16 v[168:171], v[224:227], v[32:35], v[168:171]
s_add_u32 s46, s80, 20971520
buffer_load_dwordx4 v[112:115], v253, s[32:35], s46 offen
ds_read_b128 v[220:223], v249 offset:2304
ds_read_u16_d16 v188, v188
ds_read_u16_d16 v190, v190
v_exp_f16_e64 v195, v196
v_mfma_f32_16x16x32_bf16 v[176:179], v[224:227], v[36:39], v[176:179]
v_lshrrev_b32 v189, 18, v189
v_lshrrev_b32 v191, 18, v191
v_mfma_f32_16x16x32_f16 v[152:155], v[228:231], v[208:211], v[152:155]
ds_read_b128 v[224:227], v250 offset:2048
ds_read_u16_d16_hi v189, v189
ds_read_u16_d16_hi v191, v191
v_exp_f16_sdwa v201, v202 dst_sel:WORD_1 dst_unused:UNUSED_PRESERVE src0_sel:WORD_1
v_and_b32 v193, s49, v193
v_mfma_f32_16x16x32_f16 v[160:163], v[228:231], v[212:215], v[160:163]
v_bfe_u32 v192, v193, 2, 14
s_waitcnt lgkmcnt(7)
v_mfma_f32_16x16x32_f16 v[156:159], v[232:235], v[208:211], v[156:159]
ds_read_b128 v[228:231], v250 offset:2304
ds_read_u16_d16 v192, v192
v_exp_f16_sdwa v198, v199 dst_sel:WORD_1 dst_unused:UNUSED_PRESERVE src0_sel:WORD_1
v_lshrrev_b32_e64 v193, 18, v193
v_mfma_f32_16x16x32_f16 v[164:167], v[232:235], v[212:215], v[164:167]
v_exp_f16_sdwa v195, v196 dst_sel:WORD_1 dst_unused:UNUSED_PRESERVE src0_sel:WORD_1
v_pk_add_f16 v201, v201, 1.0 op_sel_hi:[1,0]
v_mfma_f32_16x16x32_bf16 v[172:175], v[236:239], v[32:35], v[172:175]
ds_read_b128 v[232:235], v249 offset:6144
ds_read_u16_d16_hi v193, v193
v_pk_add_f16 v198, v198, 1.0 op_sel_hi:[1,0]
v_pk_add_f16 v195, v195, 1.0 op_sel_hi:[1,0]
v_mfma_f32_16x16x32_bf16 v[180:183], v[236:239], v[36:39], v[180:183]
v_rcp_f16_e64 v202, v201
v_mfma_f32_16x16x32_bf16 v[168:171], v[216:219], v[40:43], v[168:171]
ds_read_b128 v[236:239], v250 offset:3072
v_rcp_f16_e64 v199, v198
v_mfma_f32_16x16x32_bf16 v[176:179], v[216:219], v[44:47], v[176:179]
v_rcp_f16 v196, v195
s_waitcnt lgkmcnt(5)
v_mfma_f32_16x16x32_bf16 v[172:175], v[220:223], v[40:43], v[172:175]
ds_read_b128 v[216:219], v249 offset:6400
v_rcp_f16_sdwa v202, v201 dst_sel:WORD_1 dst_unused:UNUSED_PRESERVE src0_sel:WORD_1
v_mfma_f32_16x16x32_bf16 v[180:183], v[220:223], v[44:47], v[180:183]
v_rcp_f16_sdwa v199, v198 dst_sel:WORD_1 dst_unused:UNUSED_PRESERVE src0_sel:WORD_1
v_or_b32 v208, v184, v185
v_or_b32 v209, v186, v187
v_or_b32_e64 v210, v188, v189
v_rcp_f16_sdwa v196, v195 dst_sel:WORD_1 dst_unused:UNUSED_PRESERVE src0_sel:WORD_1
v_or_b32 v211, v190, v191
s_waitcnt lgkmcnt(2)
v_or_b32_e64 v212, v192, v193
v_pk_mul_f16 v213, v203, v202
v_pk_mul_f16 v214, v200, v199
v_pk_mul_f16 v215, v197, v196
v_mfma_f32_16x16x32_f16 v[120:123], v[224:227], v[208:211], v[120:123]
buffer_load_dwordx4 v[0:3], v252, s[4:7], s68 offen offset:128
ds_read_b128 v[220:223], v250 offset:3328
v_cvt_pkrtz_f16_f32 v185, v168, v169
v_cvt_pkrtz_f16_f32 v187, v170, v171
v_cvt_pkrtz_f16_f32 v189, v172, v173
v_mfma_f32_16x16x32_f16 v[128:131], v[224:227], v[212:215], v[128:131]
v_cvt_pkrtz_f16_f32 v191, v174, v175
v_cvt_pkrtz_f16_f32 v193, v176, v177
v_cvt_pk_f16_f32 v203, v178, v179
v_mfma_f32_16x16x32_f16 v[124:127], v[228:231], v[208:211], v[124:127]
ds_read_b128 v[224:227], v249 offset:7168
v_cvt_pk_f16_f32 v200, v180, v181
v_cvt_pk_f16_f32 v197, v182, v183
v_pk_fma_f16 v202, v203, v203, s48
v_cvt_pk_bf16_f32 v72, v72, v73
v_mfma_f32_16x16x32_f16 v[132:135], v[228:231], v[212:215], v[132:135]
v_and_b32_e64 v185, s49, v185
v_cvt_pk_bf16_f32 v73, v74, v75
v_pk_fma_f16 v199, v200, v200, s48
v_mfma_f32_16x16x32_bf16 v[168:171], v[232:235], v[24:27], 0
ds_read_b128 v[228:231], v250 offset:4096
v_and_b32_e64 v187, s49, v187
v_cvt_pk_bf16_f32 v74, v76, v77
v_pk_fma_f16 v196, v197, v197, s48
v_mfma_f32_16x16x32_bf16 v[176:179], v[232:235], v[28:31], 0
v_cvt_pk_bf16_f32 v75, v78, v79
v_bfe_u32 v184, v185, 2, 14
s_setprio 2
v_pk_mul_f16 v202, v203, v202
v_cvt_pk_bf16_f32 v56, v56, v57
s_waitcnt lgkmcnt(2)
v_mfma_f32_16x16x32_f16 v[136:139], v[236:239], v[208:211], v[136:139]
ds_read_b128 v[232:235], v250 offset:4352
ds_read_u16_d16 v184, v184
v_bfe_u32 v186, v187, 2, 14
v_cvt_pk_bf16_f32 v57, v58, v59
v_pk_mul_f16 v199, v200, v199
v_mfma_f32_16x16x32_f16 v[144:147], v[236:239], v[212:215], v[144:147]
v_lshrrev_b32_e64 v185, 18, v185
v_cvt_pk_bf16_f32 v58, v60, v61
v_pk_mul_f16 v196, v197, v196
v_mfma_f32_16x16x32_bf16 v[172:175], v[216:219], v[24:27], 0
ds_read_b128 v[236:239], v249 offset:7424
ds_read_u16_d16 v186, v186
ds_read_u16_d16_hi v185, v185
v_lshrrev_b32_e64 v187, 18, v187
v_cvt_pk_bf16_f32 v59, v62, v63
v_exp_f16_e64 v201, v202
v_mfma_f32_16x16x32_bf16 v[180:183], v[216:219], v[28:31], 0
v_cvt_pk_bf16_f32 v88, v88, v89
v_and_b32_e64 v189, s49, v189
v_cvt_pk_bf16_f32 v89, v90, v91
v_mfma_f32_16x16x32_f16 v[140:143], v[220:223], v[208:211], v[140:143]
ds_read_b128 v[216:219], v249 offset:8192
ds_read_u16_d16_hi v187, v187
v_and_b32_e64 v191, s49, v191
v_cvt_pk_bf16_f32 v90, v92, v93
v_mfma_f32_16x16x32_f16 v[148:151], v[220:223], v[212:215], v[148:151]
v_exp_f16_e64 v198, v199
v_cvt_pk_bf16_f32 v91, v94, v95
s_mov_b64 vcc, s[74:75]
v_bfe_u32 v188, v189, 2, 14
v_bfe_u32 v190, v191, 2, 14
s_waitcnt lgkmcnt(5)
v_mfma_f32_16x16x32_bf16 v[168:171], v[224:227], v[32:35], v[168:171]
ds_read_b128 v[220:223], v249 offset:8448
ds_read_u16_d16 v188, v188
ds_read_u16_d16 v190, v190
v_cndmask_b32 v76, v56, v88, vcc
v_exp_f16 v195, v196
v_mfma_f32_16x16x32_bf16 v[176:179], v[224:227], v[36:39], v[176:179]
v_cndmask_b32 v77, v57, v89, vcc
v_lshrrev_b32_e64 v189, 18, v189
v_cndmask_b32 v78, v58, v90, vcc
v_mfma_f32_16x16x32_f16 v[152:155], v[228:231], v[208:211], v[152:155]
ds_read_b128 v[224:227], v250 offset:8192
ds_read_u16_d16_hi v189, v189
v_lshrrev_b32 v191, 18, v191
v_cndmask_b32 v79, v59, v91, vcc
v_exp_f16_sdwa v201, v202 dst_sel:WORD_1 dst_unused:UNUSED_PRESERVE src0_sel:WORD_1
v_mfma_f32_16x16x32_f16 v[160:163], v[228:231], v[212:215], v[160:163]
v_cndmask_b32_dpp v56, v72, v56, vcc quad_perm:[1,0,3,2] row_mask:0xf bank_mask:0xf
v_and_b32_e64 v193, s49, v193
v_cndmask_b32_dpp v57, v73, v57, vcc quad_perm:[1,0,3,2] row_mask:0xf bank_mask:0xf
v_mfma_f32_16x16x32_f16 v[156:159], v[232:235], v[208:211], v[156:159]
ds_read_b128 v[228:231], v250 offset:8448
ds_read_u16_d16_hi v191, v191
v_bfe_u32 v192, v193, 2, 14
v_exp_f16_sdwa v198, v199 dst_sel:WORD_1 dst_unused:UNUSED_PRESERVE src0_sel:WORD_1
v_mfma_f32_16x16x32_f16 v[164:167], v[232:235], v[212:215], v[164:167]
v_cndmask_b32_dpp v58, v74, v58, vcc quad_perm:[1,0,3,2] row_mask:0xf bank_mask:0xf
v_lshrrev_b32_e64 v193, 18, v193
v_cndmask_b32_dpp v59, v75, v59, vcc quad_perm:[1,0,3,2] row_mask:0xf bank_mask:0xf
s_not_b64 vcc, s[74:75]
s_waitcnt lgkmcnt(4)
v_mfma_f32_16x16x32_bf16 v[172:175], v[236:239], v[32:35], v[172:175]
ds_read_b128 v[232:235], v249 offset:12288
ds_read_u16_d16 v192, v192
ds_read_u16_d16_hi v193, v193
v_exp_f16_sdwa v195, v196 dst_sel:WORD_1 dst_unused:UNUSED_PRESERVE src0_sel:WORD_1
v_cndmask_b32_dpp v88, v72, v88, vcc quad_perm:[1,0,3,2] row_mask:0xf bank_mask:0xf
v_pk_add_f16 v201, v201, 1.0 op_sel_hi:[1,0]
v_mfma_f32_16x16x32_bf16 v[180:183], v[236:239], v[36:39], v[180:183]
v_cndmask_b32_dpp v89, v73, v89, vcc quad_perm:[1,0,3,2] row_mask:0xf bank_mask:0xf
v_pk_add_f16 v198, v198, 1.0 op_sel_hi:[1,0]
v_cndmask_b32_dpp v90, v74, v90, vcc quad_perm:[1,0,3,2] row_mask:0xf bank_mask:0xf
v_mfma_f32_16x16x32_bf16 v[168:171], v[216:219], v[40:43], v[168:171]
ds_read_b128 v[236:239], v250 offset:9216
v_pk_add_f16 v195, v195, 1.0 op_sel_hi:[1,0]
v_rcp_f16_e64 v202, v201
v_cndmask_b32_dpp v91, v75, v91, vcc quad_perm:[1,0,3,2] row_mask:0xf bank_mask:0xf
v_mfma_f32_16x16x32_bf16 v[176:179], v[216:219], v[44:47], v[176:179]
v_rcp_f16_e64 v199, v198
v_mfma_f32_16x16x32_bf16 v[172:175], v[220:223], v[40:43], v[172:175]
ds_read_b128 v[216:219], v249 offset:12544
s_add_u32 s46, s70, 98304
buffer_store_dwordx4 v[56:59], v255, s[8:11], s46 offen sc1
v_rcp_f16_e64 v196, v195
v_rcp_f16_sdwa v202, v201 dst_sel:WORD_1 dst_unused:UNUSED_PRESERVE src0_sel:WORD_1
v_mfma_f32_16x16x32_bf16 v[180:183], v[220:223], v[44:47], v[180:183]
v_rcp_f16_sdwa v199, v198 dst_sel:WORD_1 dst_unused:UNUSED_PRESERVE src0_sel:WORD_1
v_or_b32 v208, v184, v185
v_or_b32 v209, v186, v187
s_waitcnt lgkmcnt(2)
v_or_b32 v210, v188, v189
v_rcp_f16_sdwa v196, v195 dst_sel:WORD_1 dst_unused:UNUSED_PRESERVE src0_sel:WORD_1
v_or_b32 v211, v190, v191
v_or_b32 v212, v192, v193
v_pk_mul_f16 v213, v203, v202
v_pk_mul_f16 v214, v200, v199
v_pk_mul_f16 v215, v197, v196
v_mfma_f32_16x16x32_f16 v[120:123], v[224:227], v[208:211], v[120:123]
s_add_u32 s46, s68, 98304
buffer_load_dwordx4 v[4:7], v252, s[4:7], s46 offen
ds_read_b128 v[220:223], v250 offset:9472
v_cvt_pkrtz_f16_f32 v185, v168, v169
v_cvt_pkrtz_f16_f32 v187, v170, v171
v_mfma_f32_16x16x32_f16 v[128:131], v[224:227], v[212:215], v[128:131]
v_cvt_pkrtz_f16_f32 v189, v172, v173
v_cvt_pkrtz_f16_f32 v191, v174, v175
v_mfma_f32_16x16x32_f16 v[124:127], v[228:231], v[208:211], v[124:127]
ds_read_b128 v[224:227], v249 offset:13312
v_cvt_pkrtz_f16_f32 v193, v176, v177
v_cvt_pk_f16_f32 v203, v178, v179
v_cvt_pk_f16_f32 v200, v180, v181
v_mfma_f32_16x16x32_f16 v[132:135], v[228:231], v[212:215], v[132:135]
v_cvt_pk_f16_f32 v197, v182, v183
s_setprio 1
v_pk_fma_f16 v202, v203, v203, s48
v_mfma_f32_16x16x32_bf16 v[168:171], v[232:235], v[24:27], 0
ds_read_b128 v[228:231], v250 offset:10240
v_and_b32 v185, s49, v185
v_pk_fma_f16 v199, v200, v200, s48
v_mfma_f32_16x16x32_bf16 v[176:179], v[232:235], v[28:31], 0
v_and_b32 v187, s49, v187
v_pk_fma_f16 v196, v197, v197, s48
v_bfe_u32 v184, v185, 2, 14
s_waitcnt lgkmcnt(3)
v_mfma_f32_16x16x32_f16 v[136:139], v[236:239], v[208:211], v[136:139]
ds_read_b128 v[232:235], v250 offset:10496
ds_read_u16_d16 v184, v184
v_pk_mul_f16 v202, v203, v202
v_bfe_u32 v186, v187, 2, 14
v_mfma_f32_16x16x32_f16 v[144:147], v[236:239], v[212:215], v[144:147]
v_pk_mul_f16 v199, v200, v199
v_lshrrev_b32_e64 v185, 18, v185
v_mfma_f32_16x16x32_bf16 v[172:175], v[216:219], v[24:27], 0
ds_read_b128 v[236:239], v249 offset:13568
ds_read_u16_d16 v186, v186
ds_read_u16_d16_hi v185, v185
v_pk_mul_f16 v196, v197, v196
v_lshrrev_b32_e64 v187, 18, v187
v_mfma_f32_16x16x32_bf16 v[180:183], v[216:219], v[28:31], 0
v_exp_f16_e64 v201, v202
v_and_b32 v189, s49, v189
s_waitcnt lgkmcnt(5)
v_mfma_f32_16x16x32_f16 v[140:143], v[220:223], v[208:211], v[140:143]
ds_read_b128 v[216:219], v249 offset:14336
ds_read_u16_d16_hi v187, v187
v_and_b32_e64 v191, s49, v191
v_mfma_f32_16x16x32_f16 v[148:151], v[220:223], v[212:215], v[148:151]
v_exp_f16_e64 v198, v199
v_bfe_u32 v188, v189, 2, 14
v_bfe_u32 v190, v191, 2, 14
v_mfma_f32_16x16x32_bf16 v[168:171], v[224:227], v[32:35], v[168:171]
s_add_u32 s46, s80, 20971520
buffer_load_dwordx4 v[116:119], v253, s[32:35], s46 offen offset:256
ds_read_b128 v[220:223], v249 offset:14592
ds_read_u16_d16 v188, v188
ds_read_u16_d16 v190, v190
v_exp_f16_e64 v195, v196
v_mfma_f32_16x16x32_bf16 v[176:179], v[224:227], v[36:39], v[176:179]
v_lshrrev_b32 v189, 18, v189
v_lshrrev_b32 v191, 18, v191
v_mfma_f32_16x16x32_f16 v[152:155], v[228:231], v[208:211], v[152:155]
ds_read_b128 v[224:227], v250 offset:14336
ds_read_u16_d16_hi v189, v189
ds_read_u16_d16_hi v191, v191
v_exp_f16_sdwa v201, v202 dst_sel:WORD_1 dst_unused:UNUSED_PRESERVE src0_sel:WORD_1
v_and_b32 v193, s49, v193
v_mfma_f32_16x16x32_f16 v[160:163], v[228:231], v[212:215], v[160:163]
v_bfe_u32 v192, v193, 2, 14
s_waitcnt lgkmcnt(7)
v_mfma_f32_16x16x32_f16 v[156:159], v[232:235], v[208:211], v[156:159]
ds_read_b128 v[228:231], v250 offset:14592
ds_read_u16_d16 v192, v192
v_exp_f16_sdwa v198, v199 dst_sel:WORD_1 dst_unused:UNUSED_PRESERVE src0_sel:WORD_1
v_lshrrev_b32_e64 v193, 18, v193
v_mfma_f32_16x16x32_f16 v[164:167], v[232:235], v[212:215], v[164:167]
v_exp_f16_sdwa v195, v196 dst_sel:WORD_1 dst_unused:UNUSED_PRESERVE src0_sel:WORD_1
v_pk_add_f16 v201, v201, 1.0 op_sel_hi:[1,0]
v_mfma_f32_16x16x32_bf16 v[172:175], v[236:239], v[32:35], v[172:175]
ds_read_b128 v[232:235], v249 offset:18432
ds_read_u16_d16_hi v193, v193
v_pk_add_f16 v198, v198, 1.0 op_sel_hi:[1,0]
v_pk_add_f16 v195, v195, 1.0 op_sel_hi:[1,0]
v_mfma_f32_16x16x32_bf16 v[180:183], v[236:239], v[36:39], v[180:183]
v_rcp_f16 v202, v201
s_setprio 0
v_mfma_f32_16x16x32_bf16 v[168:171], v[216:219], v[40:43], v[168:171]
ds_read_b128 v[236:239], v250 offset:15360
v_rcp_f16_e64 v199, v198
v_mfma_f32_16x16x32_bf16 v[176:179], v[216:219], v[44:47], v[176:179]
v_rcp_f16 v196, v195
s_waitcnt lgkmcnt(5)
v_mfma_f32_16x16x32_bf16 v[172:175], v[220:223], v[40:43], v[172:175]
ds_read_b128 v[216:219], v249 offset:18688
v_rcp_f16_sdwa v202, v201 dst_sel:WORD_1 dst_unused:UNUSED_PRESERVE src0_sel:WORD_1
v_mfma_f32_16x16x32_bf16 v[180:183], v[220:223], v[44:47], v[180:183]
v_rcp_f16_sdwa v199, v198 dst_sel:WORD_1 dst_unused:UNUSED_PRESERVE src0_sel:WORD_1
v_or_b32 v208, v184, v185
v_or_b32 v209, v186, v187
v_or_b32_e64 v210, v188, v189
v_rcp_f16_sdwa v196, v195 dst_sel:WORD_1 dst_unused:UNUSED_PRESERVE src0_sel:WORD_1
v_or_b32 v211, v190, v191
s_waitcnt lgkmcnt(2)
v_or_b32 v212, v192, v193
v_pk_mul_f16 v213, v203, v202
v_pk_mul_f16 v214, v200, v199
v_pk_mul_f16 v215, v197, v196
s_setprio 3
v_mfma_f32_16x16x32_f16 v[120:123], v[224:227], v[208:211], v[120:123]
s_add_u32 s46, s68, 98304
buffer_load_dwordx4 v[8:11], v252, s[4:7], s46 offen offset:64
ds_read_b128 v[220:223], v250 offset:15616
v_cvt_pkrtz_f16_f32 v185, v168, v169
v_cvt_pkrtz_f16_f32 v187, v170, v171
v_mfma_f32_16x16x32_f16 v[128:131], v[224:227], v[212:215], v[128:131]
v_cvt_pkrtz_f16_f32 v189, v172, v173
v_cvt_pkrtz_f16_f32 v191, v174, v175
v_mfma_f32_16x16x32_f16 v[124:127], v[228:231], v[208:211], v[124:127]
ds_read_b128 v[224:227], v249 offset:19456
v_cvt_pkrtz_f16_f32 v193, v176, v177
v_cvt_pk_f16_f32 v203, v178, v179
v_cvt_pk_f16_f32 v200, v180, v181
v_mfma_f32_16x16x32_f16 v[132:135], v[228:231], v[212:215], v[132:135]
v_cvt_pk_f16_f32 v197, v182, v183
v_pk_fma_f16 v202, v203, v203, s48
v_mfma_f32_16x16x32_bf16 v[168:171], v[232:235], v[24:27], 0
ds_read_b128 v[228:231], v250 offset:16384
v_and_b32_e64 v185, s49, v185
v_pk_fma_f16 v199, v200, v200, s48
v_mfma_f32_16x16x32_bf16 v[176:179], v[232:235], v[28:31], 0
v_and_b32 v187, s49, v187
v_pk_fma_f16 v196, v197, v197, s48
v_bfe_u32 v184, v185, 2, 14
s_waitcnt lgkmcnt(3)
v_mfma_f32_16x16x32_f16 v[136:139], v[236:239], v[208:211], v[136:139]
ds_read_b128 v[232:235], v250 offset:16640
ds_read_u16_d16 v184, v184
v_pk_mul_f16 v202, v203, v202
v_bfe_u32 v186, v187, 2, 14
v_mfma_f32_16x16x32_f16 v[144:147], v[236:239], v[212:215], v[144:147]
v_pk_mul_f16 v199, v200, v199
v_lshrrev_b32_e64 v185, 18, v185
v_mfma_f32_16x16x32_bf16 v[172:175], v[216:219], v[24:27], 0
ds_read_b128 v[236:239], v249 offset:19712
ds_read_u16_d16 v186, v186
ds_read_u16_d16_hi v185, v185
v_pk_mul_f16 v196, v197, v196
v_lshrrev_b32_e64 v187, 18, v187
v_mfma_f32_16x16x32_bf16 v[180:183], v[216:219], v[28:31], 0
v_exp_f16_e64 v201, v202
v_and_b32 v189, s49, v189
s_waitcnt lgkmcnt(5)
v_mfma_f32_16x16x32_f16 v[140:143], v[220:223], v[208:211], v[140:143]
ds_read_b128 v[216:219], v249 offset:20480
ds_read_u16_d16_hi v187, v187
v_and_b32_e64 v191, s49, v191
v_mfma_f32_16x16x32_f16 v[148:151], v[220:223], v[212:215], v[148:151]
v_exp_f16_e64 v198, v199
v_bfe_u32 v188, v189, 2, 14
v_bfe_u32 v190, v191, 2, 14
v_mfma_f32_16x16x32_bf16 v[168:171], v[224:227], v[32:35], v[168:171]
s_add_u32 s46, s70, 98304
buffer_store_dwordx4 v[76:79], v255, s[8:11], s46 offen offset:128 sc1
ds_read_b128 v[220:223], v249 offset:20736
ds_read_u16_d16 v188, v188
ds_read_u16_d16 v190, v190
v_exp_f16_e64 v195, v196
v_mfma_f32_16x16x32_bf16 v[176:179], v[224:227], v[36:39], v[176:179]
v_lshrrev_b32 v189, 18, v189
v_lshrrev_b32 v191, 18, v191
v_mfma_f32_16x16x32_f16 v[152:155], v[228:231], v[208:211], v[152:155]
ds_read_b128 v[224:227], v250 offset:20480
ds_read_u16_d16_hi v189, v189
ds_read_u16_d16_hi v191, v191
v_exp_f16_sdwa v201, v202 dst_sel:WORD_1 dst_unused:UNUSED_PRESERVE src0_sel:WORD_1
v_and_b32 v193, s49, v193
v_mfma_f32_16x16x32_f16 v[160:163], v[228:231], v[212:215], v[160:163]
v_bfe_u32 v192, v193, 2, 14
s_waitcnt lgkmcnt(7)
v_mfma_f32_16x16x32_f16 v[156:159], v[232:235], v[208:211], v[156:159]
ds_read_b128 v[228:231], v250 offset:20736
ds_read_u16_d16 v192, v192
v_exp_f16_sdwa v198, v199 dst_sel:WORD_1 dst_unused:UNUSED_PRESERVE src0_sel:WORD_1
v_lshrrev_b32_e64 v193, 18, v193
v_mfma_f32_16x16x32_f16 v[164:167], v[232:235], v[212:215], v[164:167]
v_exp_f16_sdwa v195, v196 dst_sel:WORD_1 dst_unused:UNUSED_PRESERVE src0_sel:WORD_1
v_pk_add_f16 v201, v201, 1.0 op_sel_hi:[1,0]
v_mfma_f32_16x16x32_bf16 v[172:175], v[236:239], v[32:35], v[172:175]
ds_read_b128 v[232:235], v248 offset:16384
ds_read_u16_d16_hi v193, v193
v_pk_add_f16 v198, v198, 1.0 op_sel_hi:[1,0]
v_pk_add_f16 v195, v195, 1.0 op_sel_hi:[1,0]
v_mfma_f32_16x16x32_bf16 v[180:183], v[236:239], v[36:39], v[180:183]
v_rcp_f16_e64 v202, v201
v_mfma_f32_16x16x32_bf16 v[168:171], v[216:219], v[40:43], v[168:171]
ds_read_b128 v[236:239], v250 offset:21504
v_rcp_f16_e64 v199, v198
v_mfma_f32_16x16x32_bf16 v[176:179], v[216:219], v[44:47], v[176:179]
v_rcp_f16 v196, v195
s_waitcnt lgkmcnt(5)
v_mfma_f32_16x16x32_bf16 v[172:175], v[220:223], v[40:43], v[172:175]
ds_read_b128 v[216:219], v248 offset:16640
v_rcp_f16_sdwa v202, v201 dst_sel:WORD_1 dst_unused:UNUSED_PRESERVE src0_sel:WORD_1
v_mfma_f32_16x16x32_bf16 v[180:183], v[220:223], v[44:47], v[180:183]
v_rcp_f16_sdwa v199, v198 dst_sel:WORD_1 dst_unused:UNUSED_PRESERVE src0_sel:WORD_1
v_or_b32 v208, v184, v185
v_or_b32 v209, v186, v187
v_or_b32_e64 v210, v188, v189
v_rcp_f16_sdwa v196, v195 dst_sel:WORD_1 dst_unused:UNUSED_PRESERVE src0_sel:WORD_1
v_or_b32 v211, v190, v191
s_waitcnt lgkmcnt(2)
v_or_b32_e64 v212, v192, v193
v_pk_mul_f16 v213, v203, v202
v_pk_mul_f16 v214, v200, v199
v_pk_mul_f16 v215, v197, v196
v_mfma_f32_16x16x32_f16 v[120:123], v[224:227], v[208:211], v[120:123]
ds_read_b128 v[220:223], v250 offset:21760
v_cvt_pkrtz_f16_f32 v185, v168, v169
v_cvt_pkrtz_f16_f32 v187, v170, v171
v_mfma_f32_16x16x32_f16 v[128:131], v[224:227], v[212:215], v[128:131]
v_cvt_pkrtz_f16_f32 v189, v172, v173
v_cvt_pkrtz_f16_f32 v191, v174, v175
v_mfma_f32_16x16x32_f16 v[124:127], v[228:231], v[208:211], v[124:127]
ds_read_b128 v[224:227], v248 offset:17408
v_cvt_pkrtz_f16_f32 v193, v176, v177
v_cvt_pk_f16_f32 v203, v178, v179
v_mfma_f32_16x16x32_f16 v[132:135], v[228:231], v[212:215], v[132:135]
v_cvt_pk_f16_f32 v200, v180, v181
v_cvt_pk_f16_f32 v197, v182, v183
s_waitcnt vmcnt(15)
v_mfma_f32_16x16x32_bf16 v[168:171], v[232:235], v[96:99], 0
ds_read_b128 v[228:231], v250 offset:22528
v_pk_fma_f16 v202, v203, v203, s48
v_and_b32_e64 v185, s49, v185
s_waitcnt vmcnt(14)
v_mfma_f32_16x16x32_bf16 v[176:179], v[232:235], v[100:103], 0
v_pk_fma_f16 v199, v200, v200, s48
v_and_b32 v187, s49, v187
s_waitcnt lgkmcnt(3)
v_mfma_f32_16x16x32_f16 v[136:139], v[236:239], v[208:211], v[136:139]
ds_read_b128 v[232:235], v250 offset:22784
v_pk_fma_f16 v196, v197, v197, s48
s_setprio 2
v_bfe_u32 v184, v185, 2, 14
v_pk_mul_f16 v202, v203, v202
v_mfma_f32_16x16x32_f16 v[144:147], v[236:239], v[212:215], v[144:147]
v_bfe_u32 v186, v187, 2, 14
v_pk_mul_f16 v199, v200, v199
s_waitcnt vmcnt(9)
v_mfma_f32_16x16x32_bf16 v[120:123], v[18:21], v[204:207], v[120:123]
ds_read_b128 v[236:239], v248 offset:17664
ds_read_u16_d16 v184, v184
ds_read_u16_d16 v186, v186
v_lshrrev_b32_e64 v185, 18, v185
v_pk_mul_f16 v196, v197, v196
v_mfma_f32_16x16x32_bf16 v[124:127], v[16:19], v[204:207], v[124:127]
v_lshrrev_b32_e64 v187, 18, v187
v_mfma_f32_16x16x32_bf16 v[172:175], v[216:219], v[96:99], 0
ds_read_u16_d16_hi v185, v185
ds_read_u16_d16_hi v187, v187
v_exp_f16 v201, v202
v_and_b32 v189, s49, v189
v_mfma_f32_16x16x32_bf16 v[180:183], v[216:219], v[100:103], 0
v_and_b32 v191, s49, v191
s_waitcnt lgkmcnt(6)
v_mfma_f32_16x16x32_f16 v[140:143], v[220:223], v[208:211], v[140:143]
ds_read_b128 v[216:219], v248 offset:18432
v_exp_f16_e64 v198, v199
v_bfe_u32 v188, v189, 2, 14
v_mfma_f32_16x16x32_f16 v[148:151], v[220:223], v[212:215], v[148:151]
v_bfe_u32 v190, v191, 2, 14
v_exp_f16_e64 v195, v196
v_mfma_f32_16x16x32_bf16 v[168:171], v[224:227], v[104:107], v[168:171]
ds_read_b128 v[220:223], v248 offset:18688
ds_read_u16_d16 v188, v188
ds_read_u16_d16 v190, v190
v_lshrrev_b32 v189, 18, v189
v_lshrrev_b32 v191, 18, v191
v_mfma_f32_16x16x32_bf16 v[176:179], v[224:227], v[108:111], v[176:179]
v_exp_f16_sdwa v201, v202 dst_sel:WORD_1 dst_unused:UNUSED_PRESERVE src0_sel:WORD_1
v_mfma_f32_16x16x32_f16 v[152:155], v[228:231], v[208:211], v[152:155]
ds_read_b128 v[224:227], v250 offset:26624
ds_read_u16_d16_hi v189, v189
ds_read_u16_d16_hi v191, v191
v_and_b32 v193, s49, v193
v_bfe_u32 v192, v193, 2, 14
v_mfma_f32_16x16x32_f16 v[160:163], v[228:231], v[212:215], v[160:163]
v_exp_f16_sdwa v198, v199 dst_sel:WORD_1 dst_unused:UNUSED_PRESERVE src0_sel:WORD_1
s_waitcnt lgkmcnt(7)
v_mfma_f32_16x16x32_f16 v[156:159], v[232:235], v[208:211], v[156:159]
ds_read_b128 v[228:231], v250 offset:26880
ds_read_u16_d16 v192, v192
v_lshrrev_b32_e64 v193, 18, v193
v_mfma_f32_16x16x32_f16 v[164:167], v[232:235], v[212:215], v[164:167]
v_exp_f16_sdwa v195, v196 dst_sel:WORD_1 dst_unused:UNUSED_PRESERVE src0_sel:WORD_1
v_pk_add_f16 v201, v201, 1.0 op_sel_hi:[1,0]
v_pk_add_f16 v198, v198, 1.0 op_sel_hi:[1,0]
v_mfma_f32_16x16x32_bf16 v[172:175], v[236:239], v[104:107], v[172:175]
ds_read_b128 v[232:235], v248 offset:22528
ds_read_u16_d16_hi v193, v193
v_pk_add_f16 v195, v195, 1.0 op_sel_hi:[1,0]
v_mfma_f32_16x16x32_bf16 v[180:183], v[236:239], v[108:111], v[180:183]
v_rcp_f16 v202, v201
s_waitcnt vmcnt(6) lgkmcnt(7)
v_mfma_f32_16x16x32_bf16 v[168:171], v[216:219], v[112:115], v[168:171]
ds_read_b128 v[236:239], v250 offset:27648
v_rcp_f16 v199, v198
s_waitcnt vmcnt(2)
v_mfma_f32_16x16x32_bf16 v[176:179], v[216:219], v[116:119], v[176:179]
v_rcp_f16_e64 v196, v195
v_mfma_f32_16x16x32_bf16 v[172:175], v[220:223], v[112:115], v[172:175]
ds_read_b128 v[216:219], v248 offset:22784
v_rcp_f16_sdwa v202, v201 dst_sel:WORD_1 dst_unused:UNUSED_PRESERVE src0_sel:WORD_1
v_mfma_f32_16x16x32_bf16 v[180:183], v[220:223], v[116:119], v[180:183]
v_rcp_f16_sdwa v199, v198 dst_sel:WORD_1 dst_unused:UNUSED_PRESERVE src0_sel:WORD_1
v_or_b32 v208, v184, v185
v_or_b32 v209, v186, v187
s_waitcnt lgkmcnt(4)
v_or_b32 v210, v188, v189
v_rcp_f16_sdwa v196, v195 dst_sel:WORD_1 dst_unused:UNUSED_PRESERVE src0_sel:WORD_1
v_or_b32 v211, v190, v191
s_waitcnt lgkmcnt(2)
v_or_b32_e64 v212, v192, v193
v_pk_mul_f16 v213, v203, v202
v_pk_mul_f16 v214, v200, v199
v_pk_mul_f16 v215, v197, v196
v_mfma_f32_16x16x32_f16 v[120:123], v[224:227], v[208:211], v[120:123]
s_add_u32 s46, s68, 98304
buffer_load_dwordx4 v[204:207], v252, s[4:7], s46 offen offset:128
ds_read_b128 v[220:223], v250 offset:27904
v_cvt_pkrtz_f16_f32 v185, v168, v169
v_cvt_pkrtz_f16_f32 v187, v170, v171
v_mfma_f32_16x16x32_f16 v[128:131], v[224:227], v[212:215], v[128:131]
v_cvt_pkrtz_f16_f32 v189, v172, v173
v_cvt_pkrtz_f16_f32 v191, v174, v175
v_mfma_f32_16x16x32_f16 v[124:127], v[228:231], v[208:211], v[124:127]
ds_read_b128 v[224:227], v248 offset:23552
v_cvt_pkrtz_f16_f32 v193, v176, v177
v_cvt_pk_f16_f32 v203, v178, v179
v_mfma_f32_16x16x32_f16 v[132:135], v[228:231], v[212:215], v[132:135]
v_cvt_pk_f16_f32 v200, v180, v181
v_cvt_pk_f16_f32 v197, v182, v183
s_setprio 1
v_mfma_f32_16x16x32_bf16 v[168:171], v[232:235], v[96:99], 0
ds_read_b128 v[228:231], v250 offset:28672
v_pk_fma_f16 v202, v203, v203, s48
v_and_b32 v185, s49, v185
v_mfma_f32_16x16x32_bf16 v[176:179], v[232:235], v[100:103], 0
v_pk_fma_f16 v199, v200, v200, s48
v_and_b32 v187, s49, v187
s_waitcnt lgkmcnt(3)
v_mfma_f32_16x16x32_f16 v[136:139], v[236:239], v[208:211], v[136:139]
ds_read_b128 v[232:235], v250 offset:28928
v_pk_fma_f16 v196, v197, v197, s48
v_bfe_u32 v184, v185, 2, 14
v_pk_mul_f16 v202, v203, v202
v_mfma_f32_16x16x32_f16 v[144:147], v[236:239], v[212:215], v[144:147]
v_bfe_u32 v186, v187, 2, 14
v_pk_mul_f16 v199, v200, v199
v_mfma_f32_16x16x32_bf16 v[136:139], v[18:21], v[244:247], v[136:139]
ds_read_b128 v[236:239], v248 offset:23808
ds_read_u16_d16 v184, v184
ds_read_u16_d16 v186, v186
v_lshrrev_b32_e64 v185, 18, v185
v_pk_mul_f16 v196, v197, v196
v_mfma_f32_16x16x32_bf16 v[140:143], v[16:19], v[244:247], v[140:143]
v_lshrrev_b32_e64 v187, 18, v187
v_mfma_f32_16x16x32_bf16 v[172:175], v[216:219], v[96:99], 0
ds_read_u16_d16_hi v185, v185
ds_read_u16_d16_hi v187, v187
v_exp_f16 v201, v202
v_and_b32 v189, s49, v189
v_mfma_f32_16x16x32_bf16 v[180:183], v[216:219], v[100:103], 0
v_and_b32 v191, s49, v191
s_waitcnt lgkmcnt(6)
v_mfma_f32_16x16x32_f16 v[140:143], v[220:223], v[208:211], v[140:143]
ds_read_b128 v[216:219], v248 offset:24576
v_exp_f16_e64 v198, v199
v_bfe_u32 v188, v189, 2, 14
v_mfma_f32_16x16x32_f16 v[148:151], v[220:223], v[212:215], v[148:151]
v_bfe_u32 v190, v191, 2, 14
v_exp_f16_e64 v195, v196
v_mfma_f32_16x16x32_bf16 v[168:171], v[224:227], v[104:107], v[168:171]
s_add_u32 s46, s70, 98304
buffer_store_dwordx4 v[88:91], v255, s[8:11], s46 offen offset:256 sc1
ds_read_b128 v[220:223], v248 offset:24832
ds_read_u16_d16 v188, v188
ds_read_u16_d16 v190, v190
v_lshrrev_b32 v189, 18, v189
v_lshrrev_b32 v191, 18, v191
v_mfma_f32_16x16x32_bf16 v[176:179], v[224:227], v[108:111], v[176:179]
v_exp_f16_sdwa v201, v202 dst_sel:WORD_1 dst_unused:UNUSED_PRESERVE src0_sel:WORD_1
v_mfma_f32_16x16x32_f16 v[152:155], v[228:231], v[208:211], v[152:155]
ds_read_b128 v[224:227], v249 offset:24576
ds_read_u16_d16_hi v189, v189
ds_read_u16_d16_hi v191, v191
v_and_b32 v193, s49, v193
v_bfe_u32 v192, v193, 2, 14
v_mfma_f32_16x16x32_f16 v[160:163], v[228:231], v[212:215], v[160:163]
v_exp_f16_sdwa v198, v199 dst_sel:WORD_1 dst_unused:UNUSED_PRESERVE src0_sel:WORD_1
s_waitcnt lgkmcnt(7)
v_mfma_f32_16x16x32_f16 v[156:159], v[232:235], v[208:211], v[156:159]
ds_read_b128 v[228:231], v254 offset:7936
ds_read_u16_d16 v192, v192
v_lshrrev_b32_e64 v193, 18, v193
v_mfma_f32_16x16x32_f16 v[164:167], v[232:235], v[212:215], v[164:167]
v_exp_f16_sdwa v195, v196 dst_sel:WORD_1 dst_unused:UNUSED_PRESERVE src0_sel:WORD_1
v_pk_add_f16 v201, v201, 1.0 op_sel_hi:[1,0]
v_pk_add_f16 v198, v198, 1.0 op_sel_hi:[1,0]
v_mfma_f32_16x16x32_bf16 v[172:175], v[236:239], v[104:107], v[172:175]
ds_read_b128 v[232:235], v249 offset:24832
ds_read_u16_d16_hi v193, v193
v_pk_add_f16 v195, v195, 1.0 op_sel_hi:[1,0]
v_mfma_f32_16x16x32_bf16 v[180:183], v[236:239], v[108:111], v[180:183]
v_rcp_f16_e64 v202, v201
s_setprio 0
s_waitcnt lgkmcnt(7)
v_mfma_f32_16x16x32_bf16 v[168:171], v[216:219], v[112:115], v[168:171]
ds_read_b128 v[236:239], v254 offset:7952
v_rcp_f16_e64 v199, v198
v_mfma_f32_16x16x32_bf16 v[176:179], v[216:219], v[116:119], v[176:179]
v_rcp_f16_e64 v196, v195
v_mfma_f32_16x16x32_bf16 v[172:175], v[220:223], v[112:115], v[172:175]
ds_read_b128 v[216:219], v248 offset:28672
v_rcp_f16_sdwa v202, v201 dst_sel:WORD_1 dst_unused:UNUSED_PRESERVE src0_sel:WORD_1
v_mfma_f32_16x16x32_bf16 v[180:183], v[220:223], v[116:119], v[180:183]
v_rcp_f16_sdwa v199, v198 dst_sel:WORD_1 dst_unused:UNUSED_PRESERVE src0_sel:WORD_1
v_or_b32 v208, v184, v185
v_or_b32 v209, v186, v187
s_waitcnt lgkmcnt(4)
v_or_b32 v210, v188, v189
v_rcp_f16_sdwa v196, v195 dst_sel:WORD_1 dst_unused:UNUSED_PRESERVE src0_sel:WORD_1
v_or_b32 v211, v190, v191
s_waitcnt lgkmcnt(2)
v_or_b32 v212, v192, v193
v_pk_mul_f16 v213, v203, v202
v_pk_mul_f16 v214, v200, v199
v_pk_mul_f16 v215, v197, v196
s_setprio 3
v_mfma_f32_16x16x32_f16 v[48:51], v[224:227], v[208:211], v[228:231]
ds_read_b128 v[220:223], v249 offset:25600
v_cvt_pkrtz_f16_f32 v185, v168, v169
v_cvt_pkrtz_f16_f32 v187, v170, v171
v_mfma_f32_16x16x32_f16 v[56:59], v[224:227], v[212:215], v[228:231]
v_cvt_pkrtz_f16_f32 v189, v172, v173
v_cvt_pkrtz_f16_f32 v191, v174, v175
s_waitcnt lgkmcnt(2)
v_mfma_f32_16x16x32_f16 v[52:55], v[232:235], v[208:211], v[236:239]
ds_read_b128 v[224:227], v254 offset:8064
ds_read_b128 v[228:231], v248 offset:28928
v_cvt_pkrtz_f16_f32 v193, v176, v177
v_cvt_pk_f16_f32 v203, v178, v179
v_mfma_f32_16x16x32_f16 v[60:63], v[232:235], v[212:215], v[236:239]
v_cvt_pk_f16_f32 v200, v180, v181
v_cvt_pk_f16_f32 v197, v182, v183
s_waitcnt lgkmcnt(3)
v_mfma_f32_16x16x32_bf16 v[168:171], v[216:219], v[96:99], 0
ds_read_b128 v[232:235], v249 offset:25856
ds_read_b128 v[236:239], v254 offset:8080
v_pk_fma_f16 v202, v203, v203, s48
v_and_b32_e64 v185, s49, v185
v_mfma_f32_16x16x32_bf16 v[176:179], v[216:219], v[100:103], 0
v_pk_fma_f16 v199, v200, v200, s48
v_and_b32 v187, s49, v187
s_waitcnt lgkmcnt(3)
v_mfma_f32_16x16x32_f16 v[64:67], v[220:223], v[208:211], v[224:227]
ds_read_b128 v[216:219], v248 offset:29696
v_pk_fma_f16 v196, v197, v197, s48
v_bfe_u32 v184, v185, 2, 14
v_pk_mul_f16 v202, v203, v202
v_mfma_f32_16x16x32_f16 v[72:75], v[220:223], v[212:215], v[224:227]
v_bfe_u32 v186, v187, 2, 14
v_pk_mul_f16 v199, v200, v199
v_mfma_f32_16x16x32_bf16 v[152:155], v[18:21], v[0:3], v[152:155]
ds_read_b128 v[220:223], v249 offset:26624
ds_read_b128 v[224:227], v254 offset:16128
ds_read_u16_d16 v184, v184
ds_read_u16_d16 v186, v186
v_lshrrev_b32_e64 v185, 18, v185
v_pk_mul_f16 v196, v197, v196
v_mfma_f32_16x16x32_bf16 v[156:159], v[16:19], v[0:3], v[156:159]
v_lshrrev_b32 v187, 18, v187
s_waitcnt lgkmcnt(6)
v_mfma_f32_16x16x32_bf16 v[172:175], v[228:231], v[96:99], 0
ds_read_u16_d16_hi v185, v185
ds_read_u16_d16_hi v187, v187
v_exp_f16 v201, v202
v_and_b32 v189, s49, v189
v_mfma_f32_16x16x32_bf16 v[180:183], v[228:231], v[100:103], 0
v_and_b32 v191, s49, v191
s_waitcnt lgkmcnt(7)
v_mfma_f32_16x16x32_f16 v[68:71], v[232:235], v[208:211], v[236:239]
ds_read_b128 v[228:231], v249 offset:26880
v_exp_f16_e64 v198, v199
v_bfe_u32 v188, v189, 2, 14
v_mfma_f32_16x16x32_f16 v[76:79], v[232:235], v[212:215], v[236:239]
v_bfe_u32 v190, v191, 2, 14
v_exp_f16 v195, v196
s_waitcnt lgkmcnt(7)
v_mfma_f32_16x16x32_bf16 v[168:171], v[216:219], v[104:107], v[168:171]
ds_read_b128 v[232:235], v254 offset:16144
ds_read_b128 v[236:239], v248 offset:29952
ds_read_u16_d16 v188, v188
ds_read_u16_d16 v190, v190
v_lshrrev_b32_e64 v189, 18, v189
v_lshrrev_b32 v191, 18, v191
v_mfma_f32_16x16x32_bf16 v[176:179], v[216:219], v[108:111], v[176:179]
v_exp_f16_sdwa v201, v202 dst_sel:WORD_1 dst_unused:UNUSED_PRESERVE src0_sel:WORD_1
s_waitcnt lgkmcnt(7)
v_mfma_f32_16x16x32_f16 v[80:83], v[220:223], v[208:211], v[224:227]
ds_read_b128 v[216:219], v248 offset:30720
ds_read_u16_d16_hi v189, v189
ds_read_u16_d16_hi v191, v191
v_and_b32 v193, s49, v193
v_bfe_u32 v192, v193, 2, 14
v_mfma_f32_16x16x32_f16 v[88:91], v[220:223], v[212:215], v[224:227]
v_exp_f16_sdwa v198, v199 dst_sel:WORD_1 dst_unused:UNUSED_PRESERVE src0_sel:WORD_1
s_waitcnt lgkmcnt(6)
v_mfma_f32_16x16x32_f16 v[84:87], v[228:231], v[208:211], v[232:235]
ds_read_b128 v[220:223], v248 offset:30976
ds_read_b128 v[224:227], v249 offset:30720
ds_read_u16_d16 v192, v192
v_lshrrev_b32 v193, 18, v193
v_mfma_f32_16x16x32_f16 v[92:95], v[228:231], v[212:215], v[232:235]
v_exp_f16_sdwa v195, v196 dst_sel:WORD_1 dst_unused:UNUSED_PRESERVE src0_sel:WORD_1
v_pk_add_f16 v201, v201, 1.0 op_sel_hi:[1,0]
v_pk_add_f16 v198, v198, 1.0 op_sel_hi:[1,0]
s_waitcnt lgkmcnt(7)
v_mfma_f32_16x16x32_bf16 v[172:175], v[236:239], v[104:107], v[172:175]
ds_read_b128 v[228:231], v249 offset:30976
ds_read_b128 v[232:235], v248 offset:34816
ds_read_u16_d16_hi v193, v193
v_pk_add_f16 v195, v195, 1.0 op_sel_hi:[1,0]
v_mfma_f32_16x16x32_bf16 v[180:183], v[236:239], v[108:111], v[180:183]
v_rcp_f16 v202, v201
s_waitcnt lgkmcnt(8)
v_mfma_f32_16x16x32_bf16 v[168:171], v[216:219], v[112:115], v[168:171]
ds_read_b128 v[236:239], v249 offset:31744
v_rcp_f16_e64 v199, v198
v_mfma_f32_16x16x32_bf16 v[176:179], v[216:219], v[116:119], v[176:179]
v_rcp_f16 v196, v195
s_waitcnt lgkmcnt(6)
v_mfma_f32_16x16x32_bf16 v[172:175], v[220:223], v[112:115], v[172:175]
ds_read_b128 v[216:219], v248 offset:35072
v_rcp_f16_sdwa v202, v201 dst_sel:WORD_1 dst_unused:UNUSED_PRESERVE src0_sel:WORD_1
v_mfma_f32_16x16x32_bf16 v[180:183], v[220:223], v[116:119], v[180:183]
v_rcp_f16_sdwa v199, v198 dst_sel:WORD_1 dst_unused:UNUSED_PRESERVE src0_sel:WORD_1
v_or_b32 v208, v184, v185
v_or_b32 v209, v186, v187
v_or_b32_e64 v210, v188, v189
v_rcp_f16_sdwa v196, v195 dst_sel:WORD_1 dst_unused:UNUSED_PRESERVE src0_sel:WORD_1
v_or_b32 v211, v190, v191
s_waitcnt lgkmcnt(2)
v_or_b32_e64 v212, v192, v193
v_pk_mul_f16 v213, v203, v202
v_pk_mul_f16 v214, v200, v199
v_pk_mul_f16 v215, v197, v196
v_mfma_f32_16x16x32_f16 v[48:51], v[224:227], v[208:211], v[48:51]
buffer_load_dwordx4 v[0:3], v252, s[4:7], s69 offen
ds_read_b128 v[220:223], v249 offset:32000
v_cvt_pkrtz_f16_f32 v185, v168, v169
v_cvt_pkrtz_f16_f32 v187, v170, v171
v_cvt_pkrtz_f16_f32 v189, v172, v173
v_mfma_f32_16x16x32_f16 v[56:59], v[224:227], v[212:215], v[56:59]
v_cvt_pkrtz_f16_f32 v191, v174, v175
v_cvt_pkrtz_f16_f32 v193, v176, v177
v_cvt_pk_f16_f32 v203, v178, v179
v_mfma_f32_16x16x32_f16 v[52:55], v[228:231], v[208:211], v[52:55]
ds_read_b128 v[224:227], v248 offset:35840
v_cvt_pk_f16_f32 v200, v180, v181
v_cvt_pk_f16_f32 v197, v182, v183
v_pk_fma_f16 v202, v203, v203, s48
v_mfma_f32_16x16x32_f16 v[60:63], v[228:231], v[212:215], v[60:63]
v_cvt_pk_bf16_f32 v136, v136, v137
v_and_b32_e64 v185, s49, v185
v_cvt_pk_bf16_f32 v137, v138, v139
v_mfma_f32_16x16x32_bf16 v[168:171], v[232:235], v[96:99], 0
ds_read_b128 v[228:231], v249 offset:32768
v_pk_fma_f16 v199, v200, v200, s48
v_and_b32_e64 v187, s49, v187
v_cvt_pk_bf16_f32 v138, v140, v141
v_mfma_f32_16x16x32_bf16 v[176:179], v[232:235], v[100:103], 0
v_pk_fma_f16 v196, v197, v197, s48
v_cvt_pk_bf16_f32 v139, v142, v143
v_bfe_u32 v184, v185, 2, 14
s_setprio 2
s_waitcnt lgkmcnt(2)
v_mfma_f32_16x16x32_f16 v[64:67], v[236:239], v[208:211], v[64:67]
ds_read_b128 v[232:235], v249 offset:33024
ds_read_u16_d16 v184, v184
v_pk_mul_f16 v202, v203, v202
v_cvt_pk_bf16_f32 v120, v120, v121
v_bfe_u32 v186, v187, 2, 14
v_mfma_f32_16x16x32_f16 v[72:75], v[236:239], v[212:215], v[72:75]
v_cvt_pk_bf16_f32 v121, v122, v123
v_pk_mul_f16 v199, v200, v199
v_lshrrev_b32_e64 v185, 18, v185
v_mfma_f32_16x16x32_bf16 v[128:131], v[18:21], v[4:7], v[128:131]
ds_read_b128 v[236:239], v248 offset:36096
ds_read_u16_d16 v186, v186
ds_read_u16_d16_hi v185, v185
v_cvt_pk_bf16_f32 v122, v124, v125
v_pk_mul_f16 v196, v197, v196
v_lshrrev_b32_e64 v187, 18, v187
v_mfma_f32_16x16x32_bf16 v[132:135], v[16:19], v[4:7], v[132:135]
v_cvt_pk_bf16_f32 v123, v126, v127
v_exp_f16_e64 v201, v202
v_mfma_f32_16x16x32_bf16 v[172:175], v[216:219], v[96:99], 0
ds_read_u16_d16_hi v187, v187
v_cvt_pk_bf16_f32 v152, v152, v153
v_and_b32_e64 v189, s49, v189
v_cvt_pk_bf16_f32 v153, v154, v155
v_mfma_f32_16x16x32_bf16 v[180:183], v[216:219], v[100:103], 0
v_and_b32_e64 v191, s49, v191
v_cvt_pk_bf16_f32 v154, v156, v157
v_mfma_f32_16x16x32_f16 v[68:71], v[220:223], v[208:211], v[68:71]
ds_read_b128 v[216:219], v248 offset:36864
v_exp_f16 v198, v199
v_cvt_pk_bf16_f32 v155, v158, v159
s_mov_b64 vcc, s[74:75]
v_bfe_u32 v188, v189, 2, 14
v_bfe_u32 v190, v191, 2, 14
v_mfma_f32_16x16x32_f16 v[76:79], v[220:223], v[212:215], v[76:79]
v_cndmask_b32 v140, v120, v152, vcc
v_exp_f16_e64 v195, v196
s_waitcnt lgkmcnt(2)
v_mfma_f32_16x16x32_bf16 v[168:171], v[224:227], v[104:107], v[168:171]
ds_read_b128 v[220:223], v248 offset:37120
ds_read_u16_d16 v188, v188
ds_read_u16_d16 v190, v190
v_cndmask_b32 v141, v121, v153, vcc
v_lshrrev_b32_e64 v189, 18, v189
v_cndmask_b32 v142, v122, v154, vcc
v_mfma_f32_16x16x32_bf16 v[176:179], v[224:227], v[108:111], v[176:179]
v_lshrrev_b32 v191, 18, v191
v_cndmask_b32 v143, v123, v155, vcc
v_mfma_f32_16x16x32_f16 v[80:83], v[228:231], v[208:211], v[80:83]
ds_read_b128 v[224:227], v249 offset:36864
ds_read_u16_d16_hi v189, v189
ds_read_u16_d16_hi v191, v191
v_exp_f16_sdwa v201, v202 dst_sel:WORD_1 dst_unused:UNUSED_PRESERVE src0_sel:WORD_1
v_cndmask_b32_dpp v120, v136, v120, vcc quad_perm:[1,0,3,2] row_mask:0xf bank_mask:0xf
v_and_b32_e64 v193, s49, v193
v_mfma_f32_16x16x32_f16 v[88:91], v[228:231], v[212:215], v[88:91]
v_cndmask_b32_dpp v121, v137, v121, vcc quad_perm:[1,0,3,2] row_mask:0xf bank_mask:0xf
v_bfe_u32 v192, v193, 2, 14
v_mfma_f32_16x16x32_f16 v[84:87], v[232:235], v[208:211], v[84:87]
ds_read_b128 v[228:231], v249 offset:37120
ds_read_u16_d16 v192, v192
v_exp_f16_sdwa v198, v199 dst_sel:WORD_1 dst_unused:UNUSED_PRESERVE src0_sel:WORD_1
v_cndmask_b32_dpp v122, v138, v122, vcc quad_perm:[1,0,3,2] row_mask:0xf bank_mask:0xf
v_lshrrev_b32 v193, 18, v193
v_mfma_f32_16x16x32_f16 v[92:95], v[232:235], v[212:215], v[92:95]
v_cndmask_b32_dpp v123, v139, v123, vcc quad_perm:[1,0,3,2] row_mask:0xf bank_mask:0xf
s_not_b64 vcc, s[74:75]
v_exp_f16_sdwa v195, v196 dst_sel:WORD_1 dst_unused:UNUSED_PRESERVE src0_sel:WORD_1
v_mfma_f32_16x16x32_bf16 v[172:175], v[236:239], v[104:107], v[172:175]
ds_read_b128 v[232:235], v248 offset:40960
ds_read_u16_d16_hi v193, v193
v_cndmask_b32_dpp v152, v136, v152, vcc quad_perm:[1,0,3,2] row_mask:0xf bank_mask:0xf
v_pk_add_f16 v201, v201, 1.0 op_sel_hi:[1,0]
v_cndmask_b32_dpp v153, v137, v153, vcc quad_perm:[1,0,3,2] row_mask:0xf bank_mask:0xf
v_mfma_f32_16x16x32_bf16 v[180:183], v[236:239], v[108:111], v[180:183]
v_pk_add_f16 v198, v198, 1.0 op_sel_hi:[1,0]
v_cndmask_b32_dpp v154, v138, v154, vcc quad_perm:[1,0,3,2] row_mask:0xf bank_mask:0xf
v_pk_add_f16 v195, v195, 1.0 op_sel_hi:[1,0]
s_waitcnt lgkmcnt(4)
v_mfma_f32_16x16x32_bf16 v[168:171], v[216:219], v[112:115], v[168:171]
ds_read_b128 v[236:239], v249 offset:37888
v_rcp_f16 v202, v201
v_cndmask_b32_dpp v155, v139, v155, vcc quad_perm:[1,0,3,2] row_mask:0xf bank_mask:0xf
v_mfma_f32_16x16x32_bf16 v[176:179], v[216:219], v[116:119], v[176:179]
v_rcp_f16_e64 v199, v198
v_mfma_f32_16x16x32_bf16 v[172:175], v[220:223], v[112:115], v[172:175]
ds_read_b128 v[216:219], v248 offset:41216
buffer_store_dwordx4 v[120:123], v255, s[8:11], s68 offen sc1
v_rcp_f16_e64 v196, v195
v_rcp_f16_sdwa v202, v201 dst_sel:WORD_1 dst_unused:UNUSED_PRESERVE src0_sel:WORD_1
v_mfma_f32_16x16x32_bf16 v[180:183], v[220:223], v[116:119], v[180:183]
v_rcp_f16_sdwa v199, v198 dst_sel:WORD_1 dst_unused:UNUSED_PRESERVE src0_sel:WORD_1
v_or_b32 v208, v184, v185
v_or_b32 v209, v186, v187
v_or_b32_e64 v210, v188, v189
v_rcp_f16_sdwa v196, v195 dst_sel:WORD_1 dst_unused:UNUSED_PRESERVE src0_sel:WORD_1
v_or_b32 v211, v190, v191
s_waitcnt lgkmcnt(2)
v_or_b32_e64 v212, v192, v193
v_pk_mul_f16 v213, v203, v202
v_pk_mul_f16 v214, v200, v199
v_pk_mul_f16 v215, v197, v196
v_mfma_f32_16x16x32_f16 v[48:51], v[224:227], v[208:211], v[48:51]
buffer_load_dwordx4 v[4:7], v252, s[4:7], s69 offen offset:64
ds_read_b128 v[220:223], v249 offset:38144
v_cvt_pkrtz_f16_f32 v185, v168, v169
v_cvt_pkrtz_f16_f32 v187, v170, v171
v_mfma_f32_16x16x32_f16 v[56:59], v[224:227], v[212:215], v[56:59]
v_cvt_pkrtz_f16_f32 v189, v172, v173
v_cvt_pkrtz_f16_f32 v191, v174, v175
v_mfma_f32_16x16x32_f16 v[52:55], v[228:231], v[208:211], v[52:55]
ds_read_b128 v[224:227], v248 offset:41984
v_cvt_pkrtz_f16_f32 v193, v176, v177
v_cvt_pk_f16_f32 v203, v178, v179
v_mfma_f32_16x16x32_f16 v[60:63], v[228:231], v[212:215], v[60:63]
v_cvt_pk_f16_f32 v200, v180, v181
v_cvt_pk_f16_f32 v197, v182, v183
s_setprio 1
v_mfma_f32_16x16x32_bf16 v[168:171], v[232:235], v[96:99], 0
ds_read_b128 v[228:231], v249 offset:38912
v_pk_fma_f16 v202, v203, v203, s48
v_and_b32 v185, s49, v185
v_mfma_f32_16x16x32_bf16 v[176:179], v[232:235], v[100:103], 0
v_pk_fma_f16 v199, v200, v200, s48
v_and_b32 v187, s49, v187
s_waitcnt lgkmcnt(3)
v_mfma_f32_16x16x32_f16 v[64:67], v[236:239], v[208:211], v[64:67]
ds_read_b128 v[232:235], v249 offset:39168
v_pk_fma_f16 v196, v197, v197, s48
v_bfe_u32 v184, v185, 2, 14
v_pk_mul_f16 v202, v203, v202
v_mfma_f32_16x16x32_f16 v[72:75], v[236:239], v[212:215], v[72:75]
v_bfe_u32 v186, v187, 2, 14
v_pk_mul_f16 v199, v200, v199
s_waitcnt vmcnt(6)
v_mfma_f32_16x16x32_bf16 v[144:147], v[18:21], v[8:11], v[144:147]
ds_read_b128 v[236:239], v248 offset:42240
ds_read_u16_d16 v184, v184
ds_read_u16_d16 v186, v186
v_lshrrev_b32 v185, 18, v185
v_pk_mul_f16 v196, v197, v196
v_mfma_f32_16x16x32_bf16 v[148:151], v[16:19], v[8:11], v[148:151]
v_lshrrev_b32_e64 v187, 18, v187
v_mfma_f32_16x16x32_bf16 v[172:175], v[216:219], v[96:99], 0
ds_read_u16_d16_hi v185, v185
ds_read_u16_d16_hi v187, v187
v_exp_f16 v201, v202
v_and_b32 v189, s49, v189
v_mfma_f32_16x16x32_bf16 v[180:183], v[216:219], v[100:103], 0
v_and_b32 v191, s49, v191
s_waitcnt lgkmcnt(6)
v_mfma_f32_16x16x32_f16 v[68:71], v[220:223], v[208:211], v[68:71]
ds_read_b128 v[216:219], v248 offset:43008
v_exp_f16_e64 v198, v199
v_bfe_u32 v188, v189, 2, 14
v_mfma_f32_16x16x32_f16 v[76:79], v[220:223], v[212:215], v[76:79]
v_bfe_u32 v190, v191, 2, 14
v_exp_f16_e64 v195, v196
v_mfma_f32_16x16x32_bf16 v[168:171], v[224:227], v[104:107], v[168:171]
ds_read_b128 v[220:223], v248 offset:43264
ds_read_u16_d16 v188, v188
ds_read_u16_d16 v190, v190
v_lshrrev_b32 v189, 18, v189
v_lshrrev_b32 v191, 18, v191
v_mfma_f32_16x16x32_bf16 v[176:179], v[224:227], v[108:111], v[176:179]
v_exp_f16_sdwa v201, v202 dst_sel:WORD_1 dst_unused:UNUSED_PRESERVE src0_sel:WORD_1
v_mfma_f32_16x16x32_f16 v[80:83], v[228:231], v[208:211], v[80:83]
ds_read_b128 v[224:227], v249 offset:43008
ds_read_u16_d16_hi v189, v189
ds_read_u16_d16_hi v191, v191
v_and_b32 v193, s49, v193
v_bfe_u32 v192, v193, 2, 14
v_mfma_f32_16x16x32_f16 v[88:91], v[228:231], v[212:215], v[88:91]
v_exp_f16_sdwa v198, v199 dst_sel:WORD_1 dst_unused:UNUSED_PRESERVE src0_sel:WORD_1
s_waitcnt lgkmcnt(7)
v_mfma_f32_16x16x32_f16 v[84:87], v[232:235], v[208:211], v[84:87]
ds_read_b128 v[228:231], v249 offset:43264
ds_read_u16_d16 v192, v192
v_lshrrev_b32_e64 v193, 18, v193
v_mfma_f32_16x16x32_f16 v[92:95], v[232:235], v[212:215], v[92:95]
v_exp_f16_sdwa v195, v196 dst_sel:WORD_1 dst_unused:UNUSED_PRESERVE src0_sel:WORD_1
v_pk_add_f16 v201, v201, 1.0 op_sel_hi:[1,0]
v_pk_add_f16 v198, v198, 1.0 op_sel_hi:[1,0]
v_mfma_f32_16x16x32_bf16 v[172:175], v[236:239], v[104:107], v[172:175]
ds_read_b128 v[232:235], v248 offset:47104
ds_read_u16_d16_hi v193, v193
v_pk_add_f16 v195, v195, 1.0 op_sel_hi:[1,0]
v_mfma_f32_16x16x32_bf16 v[180:183], v[236:239], v[108:111], v[180:183]
v_rcp_f16_e64 v202, v201
s_setprio 0
s_waitcnt lgkmcnt(7)
v_mfma_f32_16x16x32_bf16 v[168:171], v[216:219], v[112:115], v[168:171]
ds_read_b128 v[236:239], v249 offset:44032
v_rcp_f16_e64 v199, v198
v_mfma_f32_16x16x32_bf16 v[176:179], v[216:219], v[116:119], v[176:179]
v_rcp_f16_e64 v196, v195
v_mfma_f32_16x16x32_bf16 v[172:175], v[220:223], v[112:115], v[172:175]
ds_read_b128 v[216:219], v248 offset:47360
v_rcp_f16_sdwa v202, v201 dst_sel:WORD_1 dst_unused:UNUSED_PRESERVE src0_sel:WORD_1
v_mfma_f32_16x16x32_bf16 v[180:183], v[220:223], v[116:119], v[180:183]
v_rcp_f16_sdwa v199, v198 dst_sel:WORD_1 dst_unused:UNUSED_PRESERVE src0_sel:WORD_1
v_or_b32 v208, v184, v185
v_or_b32 v209, v186, v187
s_waitcnt lgkmcnt(4)
v_or_b32 v210, v188, v189
v_rcp_f16_sdwa v196, v195 dst_sel:WORD_1 dst_unused:UNUSED_PRESERVE src0_sel:WORD_1
v_or_b32 v211, v190, v191
s_waitcnt lgkmcnt(2)
v_or_b32 v212, v192, v193
v_pk_mul_f16 v213, v203, v202
v_pk_mul_f16 v214, v200, v199
v_pk_mul_f16 v215, v197, v196
s_setprio 3
v_mfma_f32_16x16x32_f16 v[48:51], v[224:227], v[208:211], v[48:51]
buffer_load_dwordx4 v[8:11], v252, s[4:7], s69 offen offset:128
ds_read_b128 v[220:223], v249 offset:44288
v_cvt_pkrtz_f16_f32 v185, v168, v169
v_cvt_pkrtz_f16_f32 v187, v170, v171
v_mfma_f32_16x16x32_f16 v[56:59], v[224:227], v[212:215], v[56:59]
v_cvt_pkrtz_f16_f32 v189, v172, v173
v_cvt_pkrtz_f16_f32 v191, v174, v175
v_mfma_f32_16x16x32_f16 v[52:55], v[228:231], v[208:211], v[52:55]
ds_read_b128 v[224:227], v248 offset:48128
v_cvt_pkrtz_f16_f32 v193, v176, v177
v_cvt_pk_f16_f32 v203, v178, v179
v_cvt_pk_f16_f32 v200, v180, v181
v_mfma_f32_16x16x32_f16 v[60:63], v[228:231], v[212:215], v[60:63]
v_cvt_pk_f16_f32 v197, v182, v183
v_pk_fma_f16 v202, v203, v203, s48
v_mfma_f32_16x16x32_bf16 v[168:171], v[232:235], v[96:99], 0
ds_read_b128 v[228:231], v249 offset:45056
v_and_b32_e64 v185, s49, v185
v_pk_fma_f16 v199, v200, v200, s48
v_mfma_f32_16x16x32_bf16 v[176:179], v[232:235], v[100:103], 0
v_and_b32 v187, s49, v187
v_pk_fma_f16 v196, v197, v197, s48
v_bfe_u32 v184, v185, 2, 14
s_waitcnt lgkmcnt(3)
v_mfma_f32_16x16x32_f16 v[64:67], v[236:239], v[208:211], v[64:67]
ds_read_b128 v[232:235], v249 offset:45312
ds_read_u16_d16 v184, v184
v_pk_mul_f16 v202, v203, v202
v_bfe_u32 v186, v187, 2, 14
v_mfma_f32_16x16x32_f16 v[72:75], v[236:239], v[212:215], v[72:75]
v_pk_mul_f16 v199, v200, v199
v_lshrrev_b32_e64 v185, 18, v185
v_mfma_f32_16x16x32_bf16 v[172:175], v[216:219], v[96:99], 0
ds_read_b128 v[236:239], v248 offset:48384
ds_read_u16_d16 v186, v186
ds_read_u16_d16_hi v185, v185
v_pk_mul_f16 v196, v197, v196
v_lshrrev_b32_e64 v187, 18, v187
v_mfma_f32_16x16x32_bf16 v[180:183], v[216:219], v[100:103], 0
v_exp_f16_e64 v201, v202
v_and_b32 v189, s49, v189
s_waitcnt lgkmcnt(5)
v_mfma_f32_16x16x32_f16 v[68:71], v[220:223], v[208:211], v[68:71]
ds_read_b128 v[216:219], v248 offset:49152
ds_read_u16_d16_hi v187, v187
v_and_b32_e64 v191, s49, v191
v_mfma_f32_16x16x32_f16 v[76:79], v[220:223], v[212:215], v[76:79]
v_exp_f16_e64 v198, v199
v_bfe_u32 v188, v189, 2, 14
v_bfe_u32 v190, v191, 2, 14
v_mfma_f32_16x16x32_bf16 v[168:171], v[224:227], v[104:107], v[168:171]
buffer_store_dwordx4 v[140:143], v255, s[8:11], s68 offen offset:128 sc1
ds_read_b128 v[220:223], v248 offset:49408
ds_read_u16_d16 v188, v188
ds_read_u16_d16 v190, v190
v_exp_f16_e64 v195, v196
v_mfma_f32_16x16x32_bf16 v[176:179], v[224:227], v[108:111], v[176:179]
v_lshrrev_b32 v189, 18, v189
v_lshrrev_b32 v191, 18, v191
v_mfma_f32_16x16x32_f16 v[80:83], v[228:231], v[208:211], v[80:83]
ds_read_b128 v[224:227], v249 offset:49152
ds_read_u16_d16_hi v189, v189
ds_read_u16_d16_hi v191, v191
v_exp_f16_sdwa v201, v202 dst_sel:WORD_1 dst_unused:UNUSED_PRESERVE src0_sel:WORD_1
v_and_b32 v193, s49, v193
v_mfma_f32_16x16x32_f16 v[88:91], v[228:231], v[212:215], v[88:91]
v_bfe_u32 v192, v193, 2, 14
s_waitcnt lgkmcnt(8)
v_mfma_f32_16x16x32_f16 v[84:87], v[232:235], v[208:211], v[84:87]
ds_read_b128 v[228:231], v249 offset:49408
ds_read_u16_d16 v192, v192
v_exp_f16_sdwa v198, v199 dst_sel:WORD_1 dst_unused:UNUSED_PRESERVE src0_sel:WORD_1
v_lshrrev_b32_e64 v193, 18, v193
v_mfma_f32_16x16x32_f16 v[92:95], v[232:235], v[212:215], v[92:95]
v_exp_f16_sdwa v195, v196 dst_sel:WORD_1 dst_unused:UNUSED_PRESERVE src0_sel:WORD_1
v_pk_add_f16 v201, v201, 1.0 op_sel_hi:[1,0]
v_mfma_f32_16x16x32_bf16 v[172:175], v[236:239], v[104:107], v[172:175]
ds_read_b128 v[232:235], v248 offset:53248
ds_read_u16_d16_hi v193, v193
v_pk_add_f16 v198, v198, 1.0 op_sel_hi:[1,0]
v_pk_add_f16 v195, v195, 1.0 op_sel_hi:[1,0]
v_mfma_f32_16x16x32_bf16 v[180:183], v[236:239], v[108:111], v[180:183]
v_rcp_f16 v202, v201
s_waitcnt lgkmcnt(7)
v_mfma_f32_16x16x32_bf16 v[168:171], v[216:219], v[112:115], v[168:171]
ds_read_b128 v[236:239], v249 offset:50176
v_rcp_f16_e64 v199, v198
v_mfma_f32_16x16x32_bf16 v[176:179], v[216:219], v[116:119], v[176:179]
v_rcp_f16_e64 v196, v195
v_mfma_f32_16x16x32_bf16 v[172:175], v[220:223], v[112:115], v[172:175]
ds_read_b128 v[216:219], v248 offset:53504
v_rcp_f16_sdwa v202, v201 dst_sel:WORD_1 dst_unused:UNUSED_PRESERVE src0_sel:WORD_1
v_mfma_f32_16x16x32_bf16 v[180:183], v[220:223], v[116:119], v[180:183]
v_rcp_f16_sdwa v199, v198 dst_sel:WORD_1 dst_unused:UNUSED_PRESERVE src0_sel:WORD_1
v_or_b32 v208, v184, v185
v_or_b32 v209, v186, v187
s_waitcnt lgkmcnt(4)
v_or_b32 v210, v188, v189
v_rcp_f16_sdwa v196, v195 dst_sel:WORD_1 dst_unused:UNUSED_PRESERVE src0_sel:WORD_1
v_or_b32 v211, v190, v191
s_waitcnt lgkmcnt(2)
v_or_b32_e64 v212, v192, v193
v_pk_mul_f16 v213, v203, v202
v_pk_mul_f16 v214, v200, v199
v_pk_mul_f16 v215, v197, v196
v_mfma_f32_16x16x32_f16 v[48:51], v[224:227], v[208:211], v[48:51]
s_add_u32 s46, s69, 98304
buffer_load_dwordx4 v[244:247], v252, s[4:7], s46 offen
ds_read_b128 v[220:223], v249 offset:50432
v_cvt_pkrtz_f16_f32 v185, v168, v169
v_cvt_pkrtz_f16_f32 v187, v170, v171
v_mfma_f32_16x16x32_f16 v[56:59], v[224:227], v[212:215], v[56:59]
v_cvt_pkrtz_f16_f32 v189, v172, v173
v_cvt_pkrtz_f16_f32 v191, v174, v175
v_mfma_f32_16x16x32_f16 v[52:55], v[228:231], v[208:211], v[52:55]
ds_read_b128 v[224:227], v248 offset:54272
v_cvt_pkrtz_f16_f32 v193, v176, v177
v_cvt_pk_f16_f32 v203, v178, v179
v_mfma_f32_16x16x32_f16 v[60:63], v[228:231], v[212:215], v[60:63]
v_cvt_pk_f16_f32 v200, v180, v181
v_cvt_pk_f16_f32 v197, v182, v183
v_mfma_f32_16x16x32_bf16 v[168:171], v[232:235], v[96:99], 0
ds_read_b128 v[228:231], v249 offset:51200
v_pk_fma_f16 v202, v203, v203, s48
v_and_b32_e64 v185, s49, v185
v_mfma_f32_16x16x32_bf16 v[176:179], v[232:235], v[100:103], 0
v_pk_fma_f16 v199, v200, v200, s48
v_and_b32 v187, s49, v187
s_waitcnt lgkmcnt(3)
v_mfma_f32_16x16x32_f16 v[64:67], v[236:239], v[208:211], v[64:67]
ds_read_b128 v[232:235], v249 offset:51456
v_pk_fma_f16 v196, v197, v197, s48
s_setprio 2
v_bfe_u32 v184, v185, 2, 14
v_pk_mul_f16 v202, v203, v202
v_mfma_f32_16x16x32_f16 v[72:75], v[236:239], v[212:215], v[72:75]
v_bfe_u32 v186, v187, 2, 14
v_pk_mul_f16 v199, v200, v199
s_waitcnt vmcnt(7)
v_mfma_f32_16x16x32_bf16 v[160:163], v[18:21], v[204:207], v[160:163]
ds_read_b128 v[236:239], v248 offset:54528
ds_read_u16_d16 v184, v184
ds_read_u16_d16 v186, v186
v_lshrrev_b32_e64 v185, 18, v185
v_pk_mul_f16 v196, v197, v196
v_mfma_f32_16x16x32_bf16 v[164:167], v[16:19], v[204:207], v[164:167]
v_lshrrev_b32_e64 v187, 18, v187
v_mfma_f32_16x16x32_bf16 v[172:175], v[216:219], v[96:99], 0
ds_read_u16_d16_hi v185, v185
ds_read_u16_d16_hi v187, v187
v_exp_f16 v201, v202
v_and_b32 v189, s49, v189
v_mfma_f32_16x16x32_bf16 v[180:183], v[216:219], v[100:103], 0
v_and_b32 v191, s49, v191
s_waitcnt lgkmcnt(6)
v_mfma_f32_16x16x32_f16 v[68:71], v[220:223], v[208:211], v[68:71]
ds_read_b128 v[216:219], v248 offset:55296
v_exp_f16_e64 v198, v199
v_bfe_u32 v188, v189, 2, 14
v_mfma_f32_16x16x32_f16 v[76:79], v[220:223], v[212:215], v[76:79]
v_bfe_u32 v190, v191, 2, 14
v_exp_f16_e64 v195, v196
v_mfma_f32_16x16x32_bf16 v[168:171], v[224:227], v[104:107], v[168:171]
ds_read_b128 v[220:223], v248 offset:55552
ds_read_u16_d16 v188, v188
ds_read_u16_d16 v190, v190
v_lshrrev_b32 v189, 18, v189
v_lshrrev_b32 v191, 18, v191
v_mfma_f32_16x16x32_bf16 v[176:179], v[224:227], v[108:111], v[176:179]
v_exp_f16_sdwa v201, v202 dst_sel:WORD_1 dst_unused:UNUSED_PRESERVE src0_sel:WORD_1
v_mfma_f32_16x16x32_f16 v[80:83], v[228:231], v[208:211], v[80:83]
ds_read_b128 v[224:227], v249 offset:55296
ds_read_u16_d16_hi v189, v189
ds_read_u16_d16_hi v191, v191
v_and_b32 v193, s49, v193
v_bfe_u32 v192, v193, 2, 14
v_mfma_f32_16x16x32_f16 v[88:91], v[228:231], v[212:215], v[88:91]
v_exp_f16_sdwa v198, v199 dst_sel:WORD_1 dst_unused:UNUSED_PRESERVE src0_sel:WORD_1
s_waitcnt lgkmcnt(7)
v_mfma_f32_16x16x32_f16 v[84:87], v[232:235], v[208:211], v[84:87]
ds_read_b128 v[228:231], v249 offset:55552
ds_read_u16_d16 v192, v192
v_lshrrev_b32_e64 v193, 18, v193
v_mfma_f32_16x16x32_f16 v[92:95], v[232:235], v[212:215], v[92:95]
v_exp_f16_sdwa v195, v196 dst_sel:WORD_1 dst_unused:UNUSED_PRESERVE src0_sel:WORD_1
v_pk_add_f16 v201, v201, 1.0 op_sel_hi:[1,0]
v_pk_add_f16 v198, v198, 1.0 op_sel_hi:[1,0]
v_mfma_f32_16x16x32_bf16 v[172:175], v[236:239], v[104:107], v[172:175]
ds_read_b128 v[232:235], v248 offset:59392
ds_read_u16_d16_hi v193, v193
v_pk_add_f16 v195, v195, 1.0 op_sel_hi:[1,0]
v_mfma_f32_16x16x32_bf16 v[180:183], v[236:239], v[108:111], v[180:183]
v_rcp_f16 v202, v201
s_waitcnt lgkmcnt(7)
v_mfma_f32_16x16x32_bf16 v[168:171], v[216:219], v[112:115], v[168:171]
ds_read_b128 v[236:239], v249 offset:56320
v_rcp_f16_e64 v199, v198
v_mfma_f32_16x16x32_bf16 v[176:179], v[216:219], v[116:119], v[176:179]
v_rcp_f16_e64 v196, v195
v_mfma_f32_16x16x32_bf16 v[172:175], v[220:223], v[112:115], v[172:175]
ds_read_b128 v[216:219], v248 offset:59648
v_rcp_f16_sdwa v202, v201 dst_sel:WORD_1 dst_unused:UNUSED_PRESERVE src0_sel:WORD_1
v_mfma_f32_16x16x32_bf16 v[180:183], v[220:223], v[116:119], v[180:183]
v_rcp_f16_sdwa v199, v198 dst_sel:WORD_1 dst_unused:UNUSED_PRESERVE src0_sel:WORD_1
v_or_b32 v208, v184, v185
v_or_b32 v209, v186, v187
s_waitcnt lgkmcnt(4)
v_or_b32 v210, v188, v189
v_rcp_f16_sdwa v196, v195 dst_sel:WORD_1 dst_unused:UNUSED_PRESERVE src0_sel:WORD_1
v_or_b32 v211, v190, v191
s_waitcnt lgkmcnt(2)
v_or_b32_e64 v212, v192, v193
v_pk_mul_f16 v213, v203, v202
v_pk_mul_f16 v214, v200, v199
v_pk_mul_f16 v215, v197, v196
v_mfma_f32_16x16x32_f16 v[48:51], v[224:227], v[208:211], v[48:51]
s_add_u32 s46, s69, 98304
buffer_load_dwordx4 v[204:207], v252, s[4:7], s46 offen offset:64
ds_read_b128 v[220:223], v249 offset:56576
v_cvt_pkrtz_f16_f32 v185, v168, v169
v_cvt_pkrtz_f16_f32 v187, v170, v171
v_mfma_f32_16x16x32_f16 v[56:59], v[224:227], v[212:215], v[56:59]
v_cvt_pkrtz_f16_f32 v189, v172, v173
v_cvt_pkrtz_f16_f32 v191, v174, v175
v_mfma_f32_16x16x32_f16 v[52:55], v[228:231], v[208:211], v[52:55]
ds_read_b128 v[224:227], v248 offset:60416
v_cvt_pkrtz_f16_f32 v193, v176, v177
v_cvt_pk_f16_f32 v203, v178, v179
v_cvt_pk_f16_f32 v200, v180, v181
v_mfma_f32_16x16x32_f16 v[60:63], v[228:231], v[212:215], v[60:63]
v_cvt_pk_f16_f32 v197, v182, v183
s_setprio 1
v_pk_fma_f16 v202, v203, v203, s48
v_mfma_f32_16x16x32_bf16 v[168:171], v[232:235], v[96:99], 0
ds_read_b128 v[228:231], v249 offset:57344
v_and_b32 v185, s49, v185
v_pk_fma_f16 v199, v200, v200, s48
v_mfma_f32_16x16x32_bf16 v[176:179], v[232:235], v[100:103], 0
v_and_b32 v187, s49, v187
v_pk_fma_f16 v196, v197, v197, s48
v_bfe_u32 v184, v185, 2, 14
s_waitcnt lgkmcnt(3)
v_mfma_f32_16x16x32_f16 v[64:67], v[236:239], v[208:211], v[64:67]
ds_read_b128 v[232:235], v249 offset:57600
ds_read_u16_d16 v184, v184
v_pk_mul_f16 v202, v203, v202
v_bfe_u32 v186, v187, 2, 14
v_mfma_f32_16x16x32_f16 v[72:75], v[236:239], v[212:215], v[72:75]
v_pk_mul_f16 v199, v200, v199
v_lshrrev_b32_e64 v185, 18, v185
v_mfma_f32_16x16x32_bf16 v[172:175], v[216:219], v[96:99], 0
ds_read_b128 v[236:239], v248 offset:60672
ds_read_u16_d16 v186, v186
ds_read_u16_d16_hi v185, v185
v_pk_mul_f16 v196, v197, v196
v_lshrrev_b32_e64 v187, 18, v187
v_mfma_f32_16x16x32_bf16 v[180:183], v[216:219], v[100:103], 0
v_exp_f16_e64 v201, v202
v_and_b32 v189, s49, v189
s_waitcnt lgkmcnt(5)
v_mfma_f32_16x16x32_f16 v[68:71], v[220:223], v[208:211], v[68:71]
ds_read_b128 v[216:219], v248 offset:61440
ds_read_u16_d16_hi v187, v187
v_and_b32_e64 v191, s49, v191
v_mfma_f32_16x16x32_f16 v[76:79], v[220:223], v[212:215], v[76:79]
v_exp_f16_e64 v198, v199
v_bfe_u32 v188, v189, 2, 14
v_bfe_u32 v190, v191, 2, 14
v_mfma_f32_16x16x32_bf16 v[168:171], v[224:227], v[104:107], v[168:171]
buffer_store_dwordx4 v[152:155], v255, s[8:11], s68 offen offset:256 sc1
ds_read_b128 v[220:223], v248 offset:61696
ds_read_u16_d16 v188, v188
ds_read_u16_d16 v190, v190
v_exp_f16_e64 v195, v196
v_mfma_f32_16x16x32_bf16 v[176:179], v[224:227], v[108:111], v[176:179]
v_lshrrev_b32 v189, 18, v189
v_lshrrev_b32 v191, 18, v191
v_mfma_f32_16x16x32_f16 v[80:83], v[228:231], v[208:211], v[80:83]
ds_read_b128 v[224:227], v249 offset:61440
ds_read_u16_d16_hi v189, v189
ds_read_u16_d16_hi v191, v191
v_exp_f16_sdwa v201, v202 dst_sel:WORD_1 dst_unused:UNUSED_PRESERVE src0_sel:WORD_1
v_and_b32 v193, s49, v193
v_mfma_f32_16x16x32_f16 v[88:91], v[228:231], v[212:215], v[88:91]
v_bfe_u32 v192, v193, 2, 14
s_waitcnt lgkmcnt(8)
v_mfma_f32_16x16x32_f16 v[84:87], v[232:235], v[208:211], v[84:87]
ds_read_b128 v[228:231], v249 offset:61696
ds_read_u16_d16 v192, v192
v_exp_f16_sdwa v198, v199 dst_sel:WORD_1 dst_unused:UNUSED_PRESERVE src0_sel:WORD_1
v_lshrrev_b32_e64 v193, 18, v193
v_mfma_f32_16x16x32_f16 v[92:95], v[232:235], v[212:215], v[92:95]
v_exp_f16_sdwa v195, v196 dst_sel:WORD_1 dst_unused:UNUSED_PRESERVE src0_sel:WORD_1
v_pk_add_f16 v201, v201, 1.0 op_sel_hi:[1,0]
v_mfma_f32_16x16x32_bf16 v[172:175], v[236:239], v[104:107], v[172:175]
ds_read_b128 v[232:235], v249
ds_read_u16_d16_hi v193, v193
v_pk_add_f16 v198, v198, 1.0 op_sel_hi:[1,0]
v_pk_add_f16 v195, v195, 1.0 op_sel_hi:[1,0]
v_mfma_f32_16x16x32_bf16 v[180:183], v[236:239], v[108:111], v[180:183]
v_rcp_f16_e64 v202, v201
s_setprio 0
s_waitcnt lgkmcnt(7)
v_mfma_f32_16x16x32_bf16 v[168:171], v[216:219], v[112:115], v[168:171]
ds_read_b128 v[236:239], v249 offset:62464
v_rcp_f16_e64 v199, v198
v_mfma_f32_16x16x32_bf16 v[176:179], v[216:219], v[116:119], v[176:179]
v_rcp_f16_e64 v196, v195
v_mfma_f32_16x16x32_bf16 v[172:175], v[220:223], v[112:115], v[172:175]
ds_read_b128 v[216:219], v249 offset:256
v_rcp_f16_sdwa v202, v201 dst_sel:WORD_1 dst_unused:UNUSED_PRESERVE src0_sel:WORD_1
v_mfma_f32_16x16x32_bf16 v[180:183], v[220:223], v[116:119], v[180:183]
v_rcp_f16_sdwa v199, v198 dst_sel:WORD_1 dst_unused:UNUSED_PRESERVE src0_sel:WORD_1
v_or_b32 v208, v184, v185
v_or_b32 v209, v186, v187
s_waitcnt lgkmcnt(4)
v_or_b32 v210, v188, v189
v_rcp_f16_sdwa v196, v195 dst_sel:WORD_1 dst_unused:UNUSED_PRESERVE src0_sel:WORD_1
v_or_b32 v211, v190, v191
s_waitcnt lgkmcnt(2)
v_or_b32_e64 v212, v192, v193
v_pk_mul_f16 v213, v203, v202
v_pk_mul_f16 v214, v200, v199
v_pk_mul_f16 v215, v197, v196
v_mfma_f32_16x16x32_f16 v[48:51], v[224:227], v[208:211], v[48:51]
ds_read_b128 v[220:223], v249 offset:62720
v_cvt_pkrtz_f16_f32 v185, v168, v169
v_cvt_pkrtz_f16_f32 v187, v170, v171
v_mfma_f32_16x16x32_f16 v[56:59], v[224:227], v[212:215], v[56:59]
v_cvt_pkrtz_f16_f32 v189, v172, v173
v_cvt_pkrtz_f16_f32 v191, v174, v175
v_mfma_f32_16x16x32_f16 v[52:55], v[228:231], v[208:211], v[52:55]
ds_read_b128 v[224:227], v249 offset:1024
v_cvt_pkrtz_f16_f32 v193, v176, v177
v_cvt_pk_f16_f32 v203, v178, v179
v_mfma_f32_16x16x32_f16 v[60:63], v[228:231], v[212:215], v[60:63]
v_cvt_pk_f16_f32 v200, v180, v181
v_cvt_pk_f16_f32 v197, v182, v183
v_mfma_f32_16x16x32_bf16 v[168:171], v[232:235], v[96:99], 0
ds_read_b128 v[228:231], v249 offset:63488
v_pk_fma_f16 v202, v203, v203, s48
v_and_b32_e64 v185, s49, v185
v_mfma_f32_16x16x32_bf16 v[176:179], v[232:235], v[100:103], 0
v_pk_fma_f16 v199, v200, v200, s48
v_and_b32 v187, s49, v187
s_waitcnt lgkmcnt(3)
v_mfma_f32_16x16x32_f16 v[64:67], v[236:239], v[208:211], v[64:67]
ds_read_b128 v[232:235], v249 offset:63744
v_pk_fma_f16 v196, v197, v197, s48
v_bfe_u32 v184, v185, 2, 14
v_pk_mul_f16 v202, v203, v202
v_mfma_f32_16x16x32_f16 v[72:75], v[236:239], v[212:215], v[72:75]
v_bfe_u32 v186, v187, 2, 14
v_pk_mul_f16 v199, v200, v199
s_waitcnt vmcnt(7)
v_mfma_f32_16x16x32_bf16 v[48:51], v[18:21], v[0:3], v[48:51]
ds_read_b128 v[236:239], v249 offset:1280
ds_read_u16_d16 v184, v184
ds_read_u16_d16 v186, v186
v_lshrrev_b32 v185, 18, v185
v_pk_mul_f16 v196, v197, v196
v_mfma_f32_16x16x32_bf16 v[52:55], v[16:19], v[0:3], v[52:55]
v_lshrrev_b32_e64 v187, 18, v187
v_mfma_f32_16x16x32_bf16 v[172:175], v[216:219], v[96:99], 0
ds_read_u16_d16_hi v185, v185
ds_read_u16_d16_hi v187, v187
v_exp_f16 v201, v202
v_and_b32 v189, s49, v189
v_mfma_f32_16x16x32_bf16 v[180:183], v[216:219], v[100:103], 0
v_and_b32 v191, s49, v191
s_waitcnt lgkmcnt(6)
v_mfma_f32_16x16x32_f16 v[68:71], v[220:223], v[208:211], v[68:71]
ds_read_b128 v[216:219], v249 offset:2048
v_exp_f16_e64 v198, v199
v_bfe_u32 v188, v189, 2, 14
v_mfma_f32_16x16x32_f16 v[76:79], v[220:223], v[212:215], v[76:79]
v_bfe_u32 v190, v191, 2, 14
v_exp_f16_e64 v195, v196
v_mfma_f32_16x16x32_bf16 v[168:171], v[224:227], v[104:107], v[168:171]
ds_read_b128 v[220:223], v249 offset:2304
ds_read_u16_d16 v188, v188
ds_read_u16_d16 v190, v190
v_lshrrev_b32 v189, 18, v189
v_lshrrev_b32 v191, 18, v191
v_mfma_f32_16x16x32_bf16 v[176:179], v[224:227], v[108:111], v[176:179]
v_exp_f16_sdwa v201, v202 dst_sel:WORD_1 dst_unused:UNUSED_PRESERVE src0_sel:WORD_1
v_mfma_f32_16x16x32_f16 v[80:83], v[228:231], v[208:211], v[80:83]
ds_read_b128 v[224:227], v250 offset:2048
ds_read_u16_d16_hi v189, v189
ds_read_u16_d16_hi v191, v191
v_and_b32 v193, s49, v193
v_bfe_u32 v192, v193, 2, 14
v_mfma_f32_16x16x32_f16 v[88:91], v[228:231], v[212:215], v[88:91]
v_exp_f16_sdwa v198, v199 dst_sel:WORD_1 dst_unused:UNUSED_PRESERVE src0_sel:WORD_1
s_waitcnt lgkmcnt(7)
v_mfma_f32_16x16x32_f16 v[84:87], v[232:235], v[208:211], v[84:87]
ds_read_b128 v[228:231], v250 offset:2304
ds_read_u16_d16 v192, v192
v_lshrrev_b32_e64 v193, 18, v193
v_mfma_f32_16x16x32_f16 v[92:95], v[232:235], v[212:215], v[92:95]
v_exp_f16_sdwa v195, v196 dst_sel:WORD_1 dst_unused:UNUSED_PRESERVE src0_sel:WORD_1
v_pk_add_f16 v201, v201, 1.0 op_sel_hi:[1,0]
v_pk_add_f16 v198, v198, 1.0 op_sel_hi:[1,0]
v_mfma_f32_16x16x32_bf16 v[172:175], v[236:239], v[104:107], v[172:175]
ds_read_b128 v[232:235], v249 offset:6144
ds_read_u16_d16_hi v193, v193
v_pk_add_f16 v195, v195, 1.0 op_sel_hi:[1,0]
v_mfma_f32_16x16x32_bf16 v[180:183], v[236:239], v[108:111], v[180:183]
v_rcp_f16 v202, v201
s_waitcnt lgkmcnt(7)
v_mfma_f32_16x16x32_bf16 v[168:171], v[216:219], v[112:115], v[168:171]
ds_read_b128 v[236:239], v250 offset:3072
v_rcp_f16_e64 v199, v198
v_mfma_f32_16x16x32_bf16 v[176:179], v[216:219], v[116:119], v[176:179]
v_rcp_f16_e64 v196, v195
v_mfma_f32_16x16x32_bf16 v[172:175], v[220:223], v[112:115], v[172:175]
ds_read_b128 v[216:219], v249 offset:6400
v_rcp_f16_sdwa v202, v201 dst_sel:WORD_1 dst_unused:UNUSED_PRESERVE src0_sel:WORD_1
v_mfma_f32_16x16x32_bf16 v[180:183], v[220:223], v[116:119], v[180:183]
v_rcp_f16_sdwa v199, v198 dst_sel:WORD_1 dst_unused:UNUSED_PRESERVE src0_sel:WORD_1
v_or_b32 v208, v184, v185
v_or_b32 v209, v186, v187
s_waitcnt lgkmcnt(4)
v_or_b32 v210, v188, v189
v_rcp_f16_sdwa v196, v195 dst_sel:WORD_1 dst_unused:UNUSED_PRESERVE src0_sel:WORD_1
v_or_b32 v211, v190, v191
s_waitcnt lgkmcnt(2)
v_or_b32_e64 v212, v192, v193
v_pk_mul_f16 v213, v203, v202
v_pk_mul_f16 v214, v200, v199
v_pk_mul_f16 v215, v197, v196
v_mfma_f32_16x16x32_f16 v[48:51], v[224:227], v[208:211], v[48:51]
s_add_u32 s46, s69, 98304
buffer_load_dwordx4 v[0:3], v252, s[4:7], s46 offen offset:128
ds_read_b128 v[220:223], v250 offset:3328
v_cvt_pkrtz_f16_f32 v185, v168, v169
v_cvt_pkrtz_f16_f32 v187, v170, v171
v_cvt_pkrtz_f16_f32 v189, v172, v173
v_mfma_f32_16x16x32_f16 v[56:59], v[224:227], v[212:215], v[56:59]
v_cvt_pkrtz_f16_f32 v191, v174, v175
v_cvt_pkrtz_f16_f32 v193, v176, v177
v_cvt_pk_f16_f32 v203, v178, v179
v_mfma_f32_16x16x32_f16 v[52:55], v[228:231], v[208:211], v[52:55]
ds_read_b128 v[224:227], v249 offset:7168
v_cvt_pk_f16_f32 v200, v180, v181
v_cvt_pk_f16_f32 v197, v182, v183
v_pk_fma_f16 v202, v203, v203, s48
v_mfma_f32_16x16x32_f16 v[60:63], v[228:231], v[212:215], v[60:63]
v_cvt_pk_bf16_f32 v144, v144, v145
v_and_b32_e64 v185, s49, v185
v_cvt_pk_bf16_f32 v145, v146, v147
v_mfma_f32_16x16x32_bf16 v[168:171], v[232:235], v[96:99], 0
ds_read_b128 v[228:231], v250 offset:4096
v_pk_fma_f16 v199, v200, v200, s48
v_and_b32 v187, s49, v187
v_cvt_pk_bf16_f32 v146, v148, v149
v_mfma_f32_16x16x32_bf16 v[176:179], v[232:235], v[100:103], 0
v_pk_fma_f16 v196, v197, v197, s48
v_cvt_pk_bf16_f32 v147, v150, v151
v_bfe_u32 v184, v185, 2, 14
s_waitcnt lgkmcnt(2)
v_mfma_f32_16x16x32_f16 v[64:67], v[236:239], v[208:211], v[64:67]
ds_read_b128 v[232:235], v250 offset:4352
ds_read_u16_d16 v184, v184
v_pk_mul_f16 v202, v203, v202
v_cvt_pk_bf16_f32 v128, v128, v129
v_bfe_u32 v186, v187, 2, 14
v_mfma_f32_16x16x32_f16 v[72:75], v[236:239], v[212:215], v[72:75]
v_cvt_pk_bf16_f32 v129, v130, v131
v_pk_mul_f16 v199, v200, v199
v_lshrrev_b32 v185, 18, v185
s_waitcnt vmcnt(6)
v_mfma_f32_16x16x32_bf16 v[64:67], v[18:21], v[4:7], v[64:67]
ds_read_b128 v[236:239], v249 offset:7424
ds_read_u16_d16 v186, v186
ds_read_u16_d16_hi v185, v185
v_cvt_pk_bf16_f32 v130, v132, v133
v_pk_mul_f16 v196, v197, v196
v_lshrrev_b32_e64 v187, 18, v187
v_mfma_f32_16x16x32_bf16 v[68:71], v[16:19], v[4:7], v[68:71]
v_cvt_pk_bf16_f32 v131, v134, v135
v_exp_f16_e64 v201, v202
v_mfma_f32_16x16x32_bf16 v[172:175], v[216:219], v[96:99], 0
ds_read_u16_d16_hi v187, v187
v_cvt_pk_bf16_f32 v160, v160, v161
v_and_b32_e64 v189, s49, v189
v_cvt_pk_bf16_f32 v161, v162, v163
v_mfma_f32_16x16x32_bf16 v[180:183], v[216:219], v[100:103], 0
v_and_b32_e64 v191, s49, v191
v_cvt_pk_bf16_f32 v162, v164, v165
v_mfma_f32_16x16x32_f16 v[68:71], v[220:223], v[208:211], v[68:71]
ds_read_b128 v[216:219], v249 offset:8192
v_exp_f16 v198, v199
v_cvt_pk_bf16_f32 v163, v166, v167
s_mov_b64 vcc, s[74:75]
v_bfe_u32 v188, v189, 2, 14
v_bfe_u32 v190, v191, 2, 14
v_mfma_f32_16x16x32_f16 v[76:79], v[220:223], v[212:215], v[76:79]
v_cndmask_b32 v148, v128, v160, vcc
v_exp_f16_e64 v195, v196
s_waitcnt lgkmcnt(2)
v_mfma_f32_16x16x32_bf16 v[168:171], v[224:227], v[104:107], v[168:171]
ds_read_b128 v[220:223], v249 offset:8448
ds_read_u16_d16 v188, v188
ds_read_u16_d16 v190, v190
v_cndmask_b32 v149, v129, v161, vcc
v_lshrrev_b32_e64 v189, 18, v189
v_cndmask_b32 v150, v130, v162, vcc
v_mfma_f32_16x16x32_bf16 v[176:179], v[224:227], v[108:111], v[176:179]
v_lshrrev_b32 v191, 18, v191
v_cndmask_b32 v151, v131, v163, vcc
v_mfma_f32_16x16x32_f16 v[80:83], v[228:231], v[208:211], v[80:83]
ds_read_b128 v[224:227], v250 offset:8192
ds_read_u16_d16_hi v189, v189
ds_read_u16_d16_hi v191, v191
v_exp_f16_sdwa v201, v202 dst_sel:WORD_1 dst_unused:UNUSED_PRESERVE src0_sel:WORD_1
v_cndmask_b32_dpp v128, v144, v128, vcc quad_perm:[1,0,3,2] row_mask:0xf bank_mask:0xf
v_and_b32_e64 v193, s49, v193
v_mfma_f32_16x16x32_f16 v[88:91], v[228:231], v[212:215], v[88:91]
v_cndmask_b32_dpp v129, v145, v129, vcc quad_perm:[1,0,3,2] row_mask:0xf bank_mask:0xf
v_bfe_u32 v192, v193, 2, 14
v_mfma_f32_16x16x32_f16 v[84:87], v[232:235], v[208:211], v[84:87]
ds_read_b128 v[228:231], v250 offset:8448
ds_read_u16_d16 v192, v192
v_exp_f16_sdwa v198, v199 dst_sel:WORD_1 dst_unused:UNUSED_PRESERVE src0_sel:WORD_1
v_cndmask_b32_dpp v130, v146, v130, vcc quad_perm:[1,0,3,2] row_mask:0xf bank_mask:0xf
v_lshrrev_b32 v193, 18, v193
v_mfma_f32_16x16x32_f16 v[92:95], v[232:235], v[212:215], v[92:95]
v_cndmask_b32_dpp v131, v147, v131, vcc quad_perm:[1,0,3,2] row_mask:0xf bank_mask:0xf
s_not_b64 vcc, s[74:75]
v_exp_f16_sdwa v195, v196 dst_sel:WORD_1 dst_unused:UNUSED_PRESERVE src0_sel:WORD_1
v_mfma_f32_16x16x32_bf16 v[172:175], v[236:239], v[104:107], v[172:175]
ds_read_b128 v[232:235], v249 offset:12288
ds_read_u16_d16_hi v193, v193
v_cndmask_b32_dpp v160, v144, v160, vcc quad_perm:[1,0,3,2] row_mask:0xf bank_mask:0xf
v_pk_add_f16 v201, v201, 1.0 op_sel_hi:[1,0]
v_cndmask_b32_dpp v161, v145, v161, vcc quad_perm:[1,0,3,2] row_mask:0xf bank_mask:0xf
v_mfma_f32_16x16x32_bf16 v[180:183], v[236:239], v[108:111], v[180:183]
v_pk_add_f16 v198, v198, 1.0 op_sel_hi:[1,0]
v_cndmask_b32_dpp v162, v146, v162, vcc quad_perm:[1,0,3,2] row_mask:0xf bank_mask:0xf
v_pk_add_f16 v195, v195, 1.0 op_sel_hi:[1,0]
s_waitcnt lgkmcnt(4)
v_mfma_f32_16x16x32_bf16 v[168:171], v[216:219], v[112:115], v[168:171]
ds_read_b128 v[236:239], v250 offset:9216
v_rcp_f16 v202, v201
v_cndmask_b32_dpp v163, v147, v163, vcc quad_perm:[1,0,3,2] row_mask:0xf bank_mask:0xf
v_mfma_f32_16x16x32_bf16 v[176:179], v[216:219], v[116:119], v[176:179]
v_rcp_f16_e64 v199, v198
v_mfma_f32_16x16x32_bf16 v[172:175], v[220:223], v[112:115], v[172:175]
ds_read_b128 v[216:219], v249 offset:12544
s_add_u32 s46, s68, 98304
buffer_store_dwordx4 v[128:131], v255, s[8:11], s46 offen sc1
v_rcp_f16_e64 v196, v195
v_rcp_f16_sdwa v202, v201 dst_sel:WORD_1 dst_unused:UNUSED_PRESERVE src0_sel:WORD_1
v_mfma_f32_16x16x32_bf16 v[180:183], v[220:223], v[116:119], v[180:183]
v_rcp_f16_sdwa v199, v198 dst_sel:WORD_1 dst_unused:UNUSED_PRESERVE src0_sel:WORD_1
v_or_b32 v208, v184, v185
v_or_b32 v209, v186, v187
v_or_b32_e64 v210, v188, v189
v_rcp_f16_sdwa v196, v195 dst_sel:WORD_1 dst_unused:UNUSED_PRESERVE src0_sel:WORD_1
v_or_b32 v211, v190, v191
s_waitcnt lgkmcnt(2)
v_or_b32_e64 v212, v192, v193
v_pk_mul_f16 v213, v203, v202
v_pk_mul_f16 v214, v200, v199
v_pk_mul_f16 v215, v197, v196
v_mfma_f32_16x16x32_f16 v[48:51], v[224:227], v[208:211], v[48:51]
ds_read_b128 v[220:223], v250 offset:9472
v_cvt_pkrtz_f16_f32 v185, v168, v169
v_cvt_pkrtz_f16_f32 v187, v170, v171
v_mfma_f32_16x16x32_f16 v[56:59], v[224:227], v[212:215], v[56:59]
v_cvt_pkrtz_f16_f32 v189, v172, v173
v_cvt_pkrtz_f16_f32 v191, v174, v175
v_mfma_f32_16x16x32_f16 v[52:55], v[228:231], v[208:211], v[52:55]
ds_read_b128 v[224:227], v249 offset:13312
v_cvt_pkrtz_f16_f32 v193, v176, v177
v_cvt_pk_f16_f32 v203, v178, v179
v_mfma_f32_16x16x32_f16 v[60:63], v[228:231], v[212:215], v[60:63]
v_cvt_pk_f16_f32 v200, v180, v181
v_cvt_pk_f16_f32 v197, v182, v183
v_mfma_f32_16x16x32_bf16 v[168:171], v[232:235], v[96:99], 0
ds_read_b128 v[228:231], v250 offset:10240
v_pk_fma_f16 v202, v203, v203, s48
v_and_b32_e64 v185, s49, v185
v_mfma_f32_16x16x32_bf16 v[176:179], v[232:235], v[100:103], 0
v_pk_fma_f16 v199, v200, v200, s48
v_and_b32 v187, s49, v187
s_waitcnt lgkmcnt(3)
v_mfma_f32_16x16x32_f16 v[64:67], v[236:239], v[208:211], v[64:67]
ds_read_b128 v[232:235], v250 offset:10496
v_pk_fma_f16 v196, v197, v197, s48
v_bfe_u32 v184, v185, 2, 14
v_pk_mul_f16 v202, v203, v202
v_mfma_f32_16x16x32_f16 v[72:75], v[236:239], v[212:215], v[72:75]
v_bfe_u32 v186, v187, 2, 14
v_pk_mul_f16 v199, v200, v199
s_waitcnt vmcnt(6)
v_mfma_f32_16x16x32_bf16 v[80:83], v[18:21], v[8:11], v[80:83]
ds_read_b128 v[236:239], v249 offset:13568
ds_read_u16_d16 v184, v184
ds_read_u16_d16 v186, v186
v_lshrrev_b32 v185, 18, v185
v_pk_mul_f16 v196, v197, v196
v_mfma_f32_16x16x32_bf16 v[84:87], v[16:19], v[8:11], v[84:87]
v_lshrrev_b32_e64 v187, 18, v187
v_mfma_f32_16x16x32_bf16 v[172:175], v[216:219], v[96:99], 0
ds_read_u16_d16_hi v185, v185
ds_read_u16_d16_hi v187, v187
v_exp_f16 v201, v202
v_and_b32 v189, s49, v189
v_mfma_f32_16x16x32_bf16 v[180:183], v[216:219], v[100:103], 0
v_and_b32 v191, s49, v191
s_waitcnt lgkmcnt(6)
v_mfma_f32_16x16x32_f16 v[68:71], v[220:223], v[208:211], v[68:71]
ds_read_b128 v[216:219], v249 offset:14336
v_exp_f16_e64 v198, v199
v_bfe_u32 v188, v189, 2, 14
v_mfma_f32_16x16x32_f16 v[76:79], v[220:223], v[212:215], v[76:79]
v_bfe_u32 v190, v191, 2, 14
v_exp_f16_e64 v195, v196
v_mfma_f32_16x16x32_bf16 v[168:171], v[224:227], v[104:107], v[168:171]
ds_read_b128 v[220:223], v249 offset:14592
ds_read_u16_d16 v188, v188
ds_read_u16_d16 v190, v190
v_lshrrev_b32 v189, 18, v189
v_lshrrev_b32 v191, 18, v191
v_mfma_f32_16x16x32_bf16 v[176:179], v[224:227], v[108:111], v[176:179]
v_exp_f16_sdwa v201, v202 dst_sel:WORD_1 dst_unused:UNUSED_PRESERVE src0_sel:WORD_1
v_mfma_f32_16x16x32_f16 v[80:83], v[228:231], v[208:211], v[80:83]
ds_read_b128 v[224:227], v250 offset:14336
ds_read_u16_d16_hi v189, v189
ds_read_u16_d16_hi v191, v191
v_and_b32 v193, s49, v193
v_bfe_u32 v192, v193, 2, 14
v_mfma_f32_16x16x32_f16 v[88:91], v[228:231], v[212:215], v[88:91]
v_exp_f16_sdwa v198, v199 dst_sel:WORD_1 dst_unused:UNUSED_PRESERVE src0_sel:WORD_1
s_waitcnt lgkmcnt(7)
v_mfma_f32_16x16x32_f16 v[84:87], v[232:235], v[208:211], v[84:87]
ds_read_b128 v[228:231], v250 offset:14592
ds_read_u16_d16 v192, v192
v_lshrrev_b32_e64 v193, 18, v193
v_mfma_f32_16x16x32_f16 v[92:95], v[232:235], v[212:215], v[92:95]
v_exp_f16_sdwa v195, v196 dst_sel:WORD_1 dst_unused:UNUSED_PRESERVE src0_sel:WORD_1
v_pk_add_f16 v201, v201, 1.0 op_sel_hi:[1,0]
v_pk_add_f16 v198, v198, 1.0 op_sel_hi:[1,0]
v_mfma_f32_16x16x32_bf16 v[172:175], v[236:239], v[104:107], v[172:175]
ds_read_b128 v[232:235], v249 offset:18432
ds_read_u16_d16_hi v193, v193
v_pk_add_f16 v195, v195, 1.0 op_sel_hi:[1,0]
v_mfma_f32_16x16x32_bf16 v[180:183], v[236:239], v[108:111], v[180:183]
v_rcp_f16 v202, v201
s_waitcnt lgkmcnt(7)
v_mfma_f32_16x16x32_bf16 v[168:171], v[216:219], v[112:115], v[168:171]
ds_read_b128 v[236:239], v250 offset:15360
v_rcp_f16_e64 v199, v198
v_mfma_f32_16x16x32_bf16 v[176:179], v[216:219], v[116:119], v[176:179]
v_rcp_f16_e64 v196, v195
v_mfma_f32_16x16x32_bf16 v[172:175], v[220:223], v[112:115], v[172:175]
ds_read_b128 v[216:219], v249 offset:18688
v_rcp_f16_sdwa v202, v201 dst_sel:WORD_1 dst_unused:UNUSED_PRESERVE src0_sel:WORD_1
v_mfma_f32_16x16x32_bf16 v[180:183], v[220:223], v[116:119], v[180:183]
v_rcp_f16_sdwa v199, v198 dst_sel:WORD_1 dst_unused:UNUSED_PRESERVE src0_sel:WORD_1
v_or_b32 v208, v184, v185
v_or_b32 v209, v186, v187
s_waitcnt lgkmcnt(4)
v_or_b32 v210, v188, v189
v_rcp_f16_sdwa v196, v195 dst_sel:WORD_1 dst_unused:UNUSED_PRESERVE src0_sel:WORD_1
v_or_b32 v211, v190, v191
s_waitcnt lgkmcnt(2)
v_or_b32_e64 v212, v192, v193
v_pk_mul_f16 v213, v203, v202
v_pk_mul_f16 v214, v200, v199
v_pk_mul_f16 v215, v197, v196
v_mfma_f32_16x16x32_f16 v[48:51], v[224:227], v[208:211], v[48:51]
s_add_u32 s46, s68, 98304
buffer_store_dwordx4 v[148:151], v255, s[8:11], s46 offen offset:128 sc1
ds_read_b128 v[220:223], v250 offset:15616
v_cvt_pkrtz_f16_f32 v185, v168, v169
v_cvt_pkrtz_f16_f32 v187, v170, v171
v_mfma_f32_16x16x32_f16 v[56:59], v[224:227], v[212:215], v[56:59]
v_cvt_pkrtz_f16_f32 v189, v172, v173
v_cvt_pkrtz_f16_f32 v191, v174, v175
v_mfma_f32_16x16x32_f16 v[52:55], v[228:231], v[208:211], v[52:55]
ds_read_b128 v[224:227], v249 offset:19456
v_cvt_pkrtz_f16_f32 v193, v176, v177
v_cvt_pk_f16_f32 v203, v178, v179
v_mfma_f32_16x16x32_f16 v[60:63], v[228:231], v[212:215], v[60:63]
v_cvt_pk_f16_f32 v200, v180, v181
v_cvt_pk_f16_f32 v197, v182, v183
v_mfma_f32_16x16x32_bf16 v[168:171], v[232:235], v[96:99], 0
ds_read_b128 v[228:231], v250 offset:16384
v_pk_fma_f16 v202, v203, v203, s48
v_and_b32_e64 v185, s49, v185
v_mfma_f32_16x16x32_bf16 v[176:179], v[232:235], v[100:103], 0
v_pk_fma_f16 v199, v200, v200, s48
v_and_b32 v187, s49, v187
s_waitcnt lgkmcnt(3)
v_mfma_f32_16x16x32_f16 v[64:67], v[236:239], v[208:211], v[64:67]
ds_read_b128 v[232:235], v250 offset:16640
v_pk_fma_f16 v196, v197, v197, s48
v_bfe_u32 v184, v185, 2, 14
v_pk_mul_f16 v202, v203, v202
v_mfma_f32_16x16x32_f16 v[72:75], v[236:239], v[212:215], v[72:75]
v_bfe_u32 v186, v187, 2, 14
v_pk_mul_f16 v199, v200, v199
s_waitcnt vmcnt(5)
v_mfma_f32_16x16x32_bf16 v[56:59], v[18:21], v[244:247], v[56:59]
ds_read_b128 v[236:239], v249 offset:19712
ds_read_u16_d16 v184, v184
ds_read_u16_d16 v186, v186
v_lshrrev_b32 v185, 18, v185
v_pk_mul_f16 v196, v197, v196
v_mfma_f32_16x16x32_bf16 v[60:63], v[16:19], v[244:247], v[60:63]
v_lshrrev_b32_e64 v187, 18, v187
v_mfma_f32_16x16x32_bf16 v[172:175], v[216:219], v[96:99], 0
ds_read_u16_d16_hi v185, v185
ds_read_u16_d16_hi v187, v187
v_exp_f16 v201, v202
v_and_b32 v189, s49, v189
v_mfma_f32_16x16x32_bf16 v[180:183], v[216:219], v[100:103], 0
v_and_b32 v191, s49, v191
s_waitcnt lgkmcnt(6)
v_mfma_f32_16x16x32_f16 v[68:71], v[220:223], v[208:211], v[68:71]
ds_read_b128 v[216:219], v249 offset:20480
v_exp_f16_e64 v198, v199
v_bfe_u32 v188, v189, 2, 14
v_mfma_f32_16x16x32_f16 v[76:79], v[220:223], v[212:215], v[76:79]
v_bfe_u32 v190, v191, 2, 14
v_exp_f16_e64 v195, v196
v_mfma_f32_16x16x32_bf16 v[168:171], v[224:227], v[104:107], v[168:171]
ds_read_b128 v[220:223], v249 offset:20736
ds_read_u16_d16 v188, v188
ds_read_u16_d16 v190, v190
v_lshrrev_b32 v189, 18, v189
v_lshrrev_b32 v191, 18, v191
v_mfma_f32_16x16x32_bf16 v[176:179], v[224:227], v[108:111], v[176:179]
v_exp_f16_sdwa v201, v202 dst_sel:WORD_1 dst_unused:UNUSED_PRESERVE src0_sel:WORD_1
v_mfma_f32_16x16x32_f16 v[80:83], v[228:231], v[208:211], v[80:83]
ds_read_b128 v[224:227], v250 offset:20480
ds_read_u16_d16_hi v189, v189
ds_read_u16_d16_hi v191, v191
v_and_b32 v193, s49, v193
v_bfe_u32 v192, v193, 2, 14
v_mfma_f32_16x16x32_f16 v[88:91], v[228:231], v[212:215], v[88:91]
v_exp_f16_sdwa v198, v199 dst_sel:WORD_1 dst_unused:UNUSED_PRESERVE src0_sel:WORD_1
s_waitcnt lgkmcnt(7)
v_mfma_f32_16x16x32_f16 v[84:87], v[232:235], v[208:211], v[84:87]
ds_read_b128 v[228:231], v250 offset:20736
ds_read_u16_d16 v192, v192
v_lshrrev_b32_e64 v193, 18, v193
v_mfma_f32_16x16x32_f16 v[92:95], v[232:235], v[212:215], v[92:95]
v_exp_f16_sdwa v195, v196 dst_sel:WORD_1 dst_unused:UNUSED_PRESERVE src0_sel:WORD_1
v_pk_add_f16 v201, v201, 1.0 op_sel_hi:[1,0]
v_pk_add_f16 v198, v198, 1.0 op_sel_hi:[1,0]
v_mfma_f32_16x16x32_bf16 v[172:175], v[236:239], v[104:107], v[172:175]
ds_read_b128 v[232:235], v250 offset:21504
ds_read_u16_d16_hi v193, v193
v_pk_add_f16 v195, v195, 1.0 op_sel_hi:[1,0]
v_mfma_f32_16x16x32_bf16 v[180:183], v[236:239], v[108:111], v[180:183]
v_rcp_f16 v202, v201
s_waitcnt lgkmcnt(7)
v_mfma_f32_16x16x32_bf16 v[168:171], v[216:219], v[112:115], v[168:171]
ds_read_b128 v[236:239], v250 offset:21760
v_rcp_f16_e64 v199, v198
v_mfma_f32_16x16x32_bf16 v[176:179], v[216:219], v[116:119], v[176:179]
v_rcp_f16_e64 v196, v195
v_mfma_f32_16x16x32_bf16 v[172:175], v[220:223], v[112:115], v[172:175]
ds_read_b128 v[216:219], v250 offset:22528
v_rcp_f16_sdwa v202, v201 dst_sel:WORD_1 dst_unused:UNUSED_PRESERVE src0_sel:WORD_1
v_mfma_f32_16x16x32_bf16 v[180:183], v[220:223], v[116:119], v[180:183]
v_rcp_f16_sdwa v199, v198 dst_sel:WORD_1 dst_unused:UNUSED_PRESERVE src0_sel:WORD_1
v_or_b32 v208, v184, v185
v_or_b32 v209, v186, v187
s_waitcnt lgkmcnt(4)
v_or_b32 v210, v188, v189
v_rcp_f16_sdwa v196, v195 dst_sel:WORD_1 dst_unused:UNUSED_PRESERVE src0_sel:WORD_1
v_or_b32 v211, v190, v191
s_waitcnt lgkmcnt(2)
v_or_b32_e64 v212, v192, v193
v_pk_mul_f16 v213, v203, v202
v_pk_mul_f16 v214, v200, v199
v_pk_mul_f16 v215, v197, v196
v_mfma_f32_16x16x32_f16 v[48:51], v[224:227], v[208:211], v[48:51]
ds_read_b128 v[220:223], v250 offset:22784
v_cvt_pkrtz_f16_f32 v185, v168, v169
v_cvt_pkrtz_f16_f32 v187, v170, v171
v_cvt_pkrtz_f16_f32 v189, v172, v173
v_cvt_pkrtz_f16_f32 v191, v174, v175
v_mfma_f32_16x16x32_f16 v[56:59], v[224:227], v[212:215], v[56:59]
v_cvt_pkrtz_f16_f32 v193, v176, v177
v_cvt_pk_f16_f32 v203, v178, v179
v_cvt_pk_f16_f32 v200, v180, v181
v_cvt_pk_f16_f32 v197, v182, v183
v_mfma_f32_16x16x32_f16 v[52:55], v[228:231], v[208:211], v[52:55]
ds_read_b128 v[224:227], v250 offset:26624
v_pk_fma_f16 v202, v203, v203, s48
v_and_b32_e64 v185, s49, v185
v_pk_fma_f16 v199, v200, v200, s48
v_and_b32_e64 v187, s49, v187
v_mfma_f32_16x16x32_f16 v[60:63], v[228:231], v[212:215], v[60:63]
v_pk_fma_f16 v196, v197, v197, s48
v_bfe_u32 v184, v185, 2, 14
v_pk_mul_f16 v202, v203, v202
v_bfe_u32 v186, v187, 2, 14
v_mfma_f32_16x16x32_f16 v[64:67], v[232:235], v[208:211], v[64:67]
ds_read_b128 v[228:231], v250 offset:26880
ds_read_u16_d16 v184, v184
ds_read_u16_d16 v186, v186
v_pk_mul_f16 v199, v200, v199
v_lshrrev_b32_e64 v185, 18, v185
v_pk_mul_f16 v196, v197, v196
v_lshrrev_b32_e64 v187, 18, v187
v_mfma_f32_16x16x32_f16 v[72:75], v[232:235], v[212:215], v[72:75]
v_exp_f16 v201, v202
v_and_b32 v189, s49, v189
v_and_b32 v191, s49, v191
s_waitcnt vmcnt(4)
v_mfma_f32_16x16x32_bf16 v[72:75], v[18:21], v[204:207], v[72:75]
ds_read_b128 v[232:235], v250 offset:27648
ds_read_u16_d16_hi v185, v185
ds_read_u16_d16_hi v187, v187
v_exp_f16_e64 v198, v199
v_bfe_u32 v188, v189, 2, 14
v_bfe_u32 v190, v191, 2, 14
v_mfma_f32_16x16x32_bf16 v[76:79], v[16:19], v[204:207], v[76:79]
v_exp_f16 v195, v196
v_lshrrev_b32 v189, 18, v189
v_lshrrev_b32 v191, 18, v191
s_waitcnt lgkmcnt(6)
v_mfma_f32_16x16x32_f16 v[68:71], v[236:239], v[208:211], v[68:71]
ds_read_u16_d16 v188, v188
ds_read_u16_d16 v190, v190
ds_read_u16_d16_hi v189, v189
ds_read_u16_d16_hi v191, v191
v_exp_f16_sdwa v201, v202 dst_sel:WORD_1 dst_unused:UNUSED_PRESERVE src0_sel:WORD_1
v_and_b32_e64 v193, s49, v193
v_bfe_u32 v192, v193, 2, 14
v_mfma_f32_16x16x32_f16 v[76:79], v[236:239], v[212:215], v[76:79]
v_exp_f16_sdwa v198, v199 dst_sel:WORD_1 dst_unused:UNUSED_PRESERVE src0_sel:WORD_1
v_lshrrev_b32_e64 v193, 18, v193
v_mfma_f32_16x16x32_f16 v[80:83], v[216:219], v[208:211], v[80:83]
ds_read_b128 v[236:239], v250 offset:27904
ds_read_u16_d16 v192, v192
ds_read_u16_d16_hi v193, v193
v_exp_f16_sdwa v195, v196 dst_sel:WORD_1 dst_unused:UNUSED_PRESERVE src0_sel:WORD_1
v_pk_add_f16 v201, v201, 1.0 op_sel_hi:[1,0]
v_pk_add_f16 v198, v198, 1.0 op_sel_hi:[1,0]
v_pk_add_f16 v195, v195, 1.0 op_sel_hi:[1,0]
v_mfma_f32_16x16x32_f16 v[88:91], v[216:219], v[212:215], v[88:91]
v_rcp_f16 v202, v201
v_rcp_f16 v199, v198
v_mfma_f32_16x16x32_f16 v[84:87], v[220:223], v[208:211], v[84:87]
ds_read_b128 v[216:219], v250 offset:28672
v_rcp_f16_e64 v196, v195
v_rcp_f16_sdwa v202, v201 dst_sel:WORD_1 dst_unused:UNUSED_PRESERVE src0_sel:WORD_1
v_mfma_f32_16x16x32_f16 v[92:95], v[220:223], v[212:215], v[92:95]
v_rcp_f16_sdwa v199, v198 dst_sel:WORD_1 dst_unused:UNUSED_PRESERVE src0_sel:WORD_1
s_waitcnt lgkmcnt(5)
v_or_b32 v208, v184, v185
v_or_b32_e64 v209, v186, v187
v_or_b32 v210, v188, v189
v_rcp_f16_sdwa v196, v195 dst_sel:WORD_1 dst_unused:UNUSED_PRESERVE src0_sel:WORD_1
s_waitcnt lgkmcnt(4)
v_or_b32 v211, v190, v191
s_waitcnt lgkmcnt(1)
v_or_b32 v212, v192, v193
v_pk_mul_f16 v213, v203, v202
v_pk_mul_f16 v214, v200, v199
v_pk_mul_f16 v215, v197, v196
v_mfma_f32_16x16x32_f16 v[48:51], v[224:227], v[208:211], v[48:51]
s_add_u32 s46, s68, 98304
buffer_store_dwordx4 v[160:163], v255, s[8:11], s46 offen offset:256 sc1
ds_read_b128 v[220:223], v250 offset:28928
v_mfma_f32_16x16x32_f16 v[56:59], v[224:227], v[212:215], v[56:59]
v_mfma_f32_16x16x32_f16 v[52:55], v[228:231], v[208:211], v[52:55]
v_mfma_f32_16x16x32_f16 v[60:63], v[228:231], v[212:215], v[60:63]
v_mfma_f32_16x16x32_f16 v[64:67], v[232:235], v[208:211], v[64:67]
v_mfma_f32_16x16x32_f16 v[72:75], v[232:235], v[212:215], v[72:75]
s_waitcnt vmcnt(3)
v_mfma_f32_16x16x32_bf16 v[88:91], v[18:21], v[0:3], v[88:91]
v_mfma_f32_16x16x32_bf16 v[92:95], v[16:19], v[0:3], v[92:95]
v_mfma_f32_16x16x32_f16 v[68:71], v[236:239], v[208:211], v[68:71]
v_mfma_f32_16x16x32_f16 v[76:79], v[236:239], v[212:215], v[76:79]
s_waitcnt lgkmcnt(1)
v_mfma_f32_16x16x32_f16 v[80:83], v[216:219], v[208:211], v[80:83]
v_mfma_f32_16x16x32_f16 v[88:91], v[216:219], v[212:215], v[88:91]
s_waitcnt lgkmcnt(0)
v_mfma_f32_16x16x32_f16 v[84:87], v[220:223], v[208:211], v[84:87]
v_mfma_f32_16x16x32_f16 v[92:95], v[220:223], v[212:215], v[92:95]
v_cvt_pk_bf16_f32 v64, v64, v65
v_cvt_pk_bf16_f32 v65, v66, v67
v_cvt_pk_bf16_f32 v66, v68, v69
v_cvt_pk_bf16_f32 v67, v70, v71
v_cvt_pk_bf16_f32 v48, v48, v49
v_cvt_pk_bf16_f32 v49, v50, v51
v_cvt_pk_bf16_f32 v50, v52, v53
v_cvt_pk_bf16_f32 v51, v54, v55
v_cvt_pk_bf16_f32 v80, v80, v81
v_cvt_pk_bf16_f32 v81, v82, v83
v_cvt_pk_bf16_f32 v82, v84, v85
v_cvt_pk_bf16_f32 v83, v86, v87
s_mov_b64 vcc, s[74:75]
v_cndmask_b32 v68, v48, v80, vcc
v_cndmask_b32 v69, v49, v81, vcc
v_cndmask_b32 v70, v50, v82, vcc
v_cndmask_b32 v71, v51, v83, vcc
v_cndmask_b32_dpp v48, v64, v48, vcc quad_perm:[1,0,3,2] row_mask:0xf bank_mask:0xf
v_cndmask_b32_dpp v49, v65, v49, vcc quad_perm:[1,0,3,2] row_mask:0xf bank_mask:0xf
v_cndmask_b32_dpp v50, v66, v50, vcc quad_perm:[1,0,3,2] row_mask:0xf bank_mask:0xf
v_cndmask_b32_dpp v51, v67, v51, vcc quad_perm:[1,0,3,2] row_mask:0xf bank_mask:0xf
s_not_b64 vcc, s[74:75]
v_cndmask_b32_dpp v80, v64, v80, vcc quad_perm:[1,0,3,2] row_mask:0xf bank_mask:0xf
v_cndmask_b32_dpp v81, v65, v81, vcc quad_perm:[1,0,3,2] row_mask:0xf bank_mask:0xf
v_cndmask_b32_dpp v82, v66, v82, vcc quad_perm:[1,0,3,2] row_mask:0xf bank_mask:0xf
v_cndmask_b32_dpp v83, v67, v83, vcc quad_perm:[1,0,3,2] row_mask:0xf bank_mask:0xf
buffer_store_dwordx4 v[48:51], v255, s[8:11], s69 offen sc1
buffer_store_dwordx4 v[68:71], v255, s[8:11], s69 offen offset:128 sc1
buffer_store_dwordx4 v[80:83], v255, s[8:11], s69 offen offset:256 sc1
v_cvt_pk_bf16_f32 v72, v72, v73
v_cvt_pk_bf16_f32 v73, v74, v75
v_cvt_pk_bf16_f32 v74, v76, v77
v_cvt_pk_bf16_f32 v75, v78, v79
v_cvt_pk_bf16_f32 v56, v56, v57
v_cvt_pk_bf16_f32 v57, v58, v59
v_cvt_pk_bf16_f32 v58, v60, v61
v_cvt_pk_bf16_f32 v59, v62, v63
v_cvt_pk_bf16_f32 v88, v88, v89
v_cvt_pk_bf16_f32 v89, v90, v91
v_cvt_pk_bf16_f32 v90, v92, v93
v_cvt_pk_bf16_f32 v91, v94, v95
s_mov_b64 vcc, s[74:75]
v_cndmask_b32 v76, v56, v88, vcc
v_cndmask_b32 v77, v57, v89, vcc
v_cndmask_b32 v78, v58, v90, vcc
v_cndmask_b32 v79, v59, v91, vcc
v_cndmask_b32_dpp v56, v72, v56, vcc quad_perm:[1,0,3,2] row_mask:0xf bank_mask:0xf
v_cndmask_b32_dpp v57, v73, v57, vcc quad_perm:[1,0,3,2] row_mask:0xf bank_mask:0xf
v_cndmask_b32_dpp v58, v74, v58, vcc quad_perm:[1,0,3,2] row_mask:0xf bank_mask:0xf
v_cndmask_b32_dpp v59, v75, v59, vcc quad_perm:[1,0,3,2] row_mask:0xf bank_mask:0xf
s_not_b64 vcc, s[74:75]
v_cndmask_b32_dpp v88, v72, v88, vcc quad_perm:[1,0,3,2] row_mask:0xf bank_mask:0xf
v_cndmask_b32_dpp v89, v73, v89, vcc quad_perm:[1,0,3,2] row_mask:0xf bank_mask:0xf
v_cndmask_b32_dpp v90, v74, v90, vcc quad_perm:[1,0,3,2] row_mask:0xf bank_mask:0xf
v_cndmask_b32_dpp v91, v75, v91, vcc quad_perm:[1,0,3,2] row_mask:0xf bank_mask:0xf
s_add_u32 s46, s69, 98304
buffer_store_dwordx4 v[56:59], v255, s[8:11], s46 offen sc1
s_add_u32 s46, s69, 98304
buffer_store_dwordx4 v[76:79], v255, s[8:11], s46 offen offset:128 sc1
s_add_u32 s46, s69, 98304
buffer_store_dwordx4 v[88:91], v255, s[8:11], s46 offen offset:256 sc1
s_endpgm
Lpoll:
s_waitcnt vmcnt(0)
s_cmp_eq_u32 s77, 2
s_cbranch_scc1 LpollC
v_max_u32 v255, v156, v157
v_max3_u32 v255, v255, v158, v159
v_max3_u32 v255, v255, v160, v161
v_max3_u32 v255, v255, v162, v163
v_max3_u32 v255, v255, v164, v165
v_max3_u32 v255, v255, v166, v167
v_max3_u32 v255, v255, v240, v241
v_max3_u32 v255, v255, v242, v243
v_cmp_eq_u32 vcc, -1, v255
s_nop 4
s_cbranch_vccz LpollR
v_lshlrev_b32 v247, 4, v251
s_lshl_b32 s44, s2, 12
buffer_load_dwordx4 v[156:159], v247, s[32:35], s44 offen sc1
buffer_load_dwordx4 v[160:163], v247, s[32:35], s44 offen offset:1024 sc1
buffer_load_dwordx4 v[164:167], v247, s[32:35], s44 offen offset:2048 sc1
buffer_load_dwordx4 v[240:243], v247, s[32:35], s44 offen offset:3072 sc1
s_setpc_b64 s[78:79]
LpollR:
s_setprio 3
v_add_f32 v156, v156, v160
v_add_f32 v240, v164, v240
v_add_f32 v240, v156, v240
v_add_f32 v157, v157, v161
v_add_f32 v241, v165, v241
v_add_f32 v241, v157, v241
v_add_f32 v158, v158, v162
v_add_f32 v242, v166, v242
v_add_f32 v242, v158, v242
v_add_f32 v159, v159, v163
v_add_f32 v243, v167, v243
v_add_f32 v243, v159, v243
v_add_f32_dpp v240, v240, v240 row_ror:8 row_mask:0xf bank_mask:0xf
s_nop 1
v_add_f32_dpp v240, v240, v240 row_ror:4 row_mask:0xf bank_mask:0xf
s_nop 1
v_add_f32_dpp v240, v240, v240 row_ror:2 row_mask:0xf bank_mask:0xf
s_nop 1
v_add_f32_dpp v240, v240, v240 row_ror:1 row_mask:0xf bank_mask:0xf
v_mov_b32 v255, v240
s_nop 1
v_permlane16_swap_b32 v240, v255
v_add_f32 v240, v240, v255
v_mov_b32 v255, v240
s_nop 1
v_permlane32_swap_b32 v240, v255
v_add_f32 v240, v240, v255
v_min_u32 v240, -2, v240
v_add_f32_dpp v241, v241, v241 row_ror:8 row_mask:0xf bank_mask:0xf
s_nop 1
v_add_f32_dpp v241, v241, v241 row_ror:4 row_mask:0xf bank_mask:0xf
s_nop 1
v_add_f32_dpp v241, v241, v241 row_ror:2 row_mask:0xf bank_mask:0xf
s_nop 1
v_add_f32_dpp v241, v241, v241 row_ror:1 row_mask:0xf bank_mask:0xf
v_mov_b32 v255, v241
s_nop 1
v_permlane16_swap_b32 v241, v255
v_add_f32 v241, v241, v255
v_mov_b32 v255, v241
s_nop 1
v_permlane32_swap_b32 v241, v255
v_add_f32 v241, v241, v255
v_min_u32 v241, -2, v241
v_add_f32_dpp v242, v242, v242 row_ror:8 row_mask:0xf bank_mask:0xf
s_nop 1
v_add_f32_dpp v242, v242, v242 row_ror:4 row_mask:0xf bank_mask:0xf
s_nop 1
v_add_f32_dpp v242, v242, v242 row_ror:2 row_mask:0xf bank_mask:0xf
s_nop 1
v_add_f32_dpp v242, v242, v242 row_ror:1 row_mask:0xf bank_mask:0xf
v_mov_b32 v255, v242
s_nop 1
v_permlane16_swap_b32 v242, v255
v_add_f32 v242, v242, v255
v_mov_b32 v255, v242
s_nop 1
v_permlane32_swap_b32 v242, v255
v_add_f32 v242, v242, v255
v_min_u32 v242, -2, v242
v_add_f32_dpp v243, v243, v243 row_ror:8 row_mask:0xf bank_mask:0xf
s_nop 1
v_add_f32_dpp v243, v243, v243 row_ror:4 row_mask:0xf bank_mask:0xf
s_nop 1
v_add_f32_dpp v243, v243, v243 row_ror:2 row_mask:0xf bank_mask:0xf
s_nop 1
v_add_f32_dpp v243, v243, v243 row_ror:1 row_mask:0xf bank_mask:0xf
v_mov_b32 v255, v243
s_nop 1
v_permlane16_swap_b32 v243, v255
v_add_f32 v243, v243, v255
v_mov_b32 v255, v243
s_nop 1
v_permlane32_swap_b32 v243, v255
v_add_f32_e64 v243, v243, v255
v_min_u32 v243, -2, v243
s_lshl_b32 s44, s2, 4
s_add_u32 s44, s44, 393216
v_lshlrev_b32_e64 v255, 11, v251
s_mov_b64 exec, 0xff
buffer_store_dwordx4 v[240:243], v255, s[32:35], s44 offen sc1
s_mov_b64 exec, -1
s_mov_b32 s77, 2
v_lshlrev_b32_e64 v247, 3, v251
s_and_b32 s44, s2, 7
s_lshl_b32 s44, s44, 11
s_add_u32 s44, s44, 393216
buffer_load_dwordx2 v[156:157], v247, s[32:35], s44 offen sc1
buffer_load_dwordx2 v[158:159], v247, s[32:35], s44 offen offset:512 sc1
buffer_load_dwordx2 v[160:161], v247, s[32:35], s44 offen offset:1024 sc1
s_setpc_b64 s[78:79]
LpollC:
v_max3_u32 v255, v156, v157, v158
v_max3_u32 v255, v255, v159, v160
v_max_u32 v255, v255, v161
v_cmp_eq_u32 vcc, -1, v255
s_nop 4
s_cbranch_vccz LpollS
v_lshlrev_b32 v247, 3, v251
s_and_b32 s44, s2, 7
s_lshl_b32 s44, s44, 11
s_add_u32 s44, s44, 393216
buffer_load_dwordx2 v[156:157], v247, s[32:35], s44 offen sc1
buffer_load_dwordx2 v[158:159], v247, s[32:35], s44 offen offset:512 sc1
buffer_load_dwordx2 v[160:161], v247, s[32:35], s44 offen offset:1024 sc1
s_setpc_b64 s[78:79]
LpollS:
s_setprio 3
s_mov_b32 s43, 1083296634
v_mov_b32 v162, 897988541
v_fma_f32 v156, v156, s43, v162
v_fma_f32 v157, v157, s43, v162
v_fma_f32 v158, v158, s43, v162
v_fma_f32 v159, v159, s43, v162
v_fma_f32 v160, v160, s43, v162
v_fma_f32 v161, v161, s43, v162
v_sqrt_f32 v156, v156
v_sqrt_f32 v157, v157
v_sqrt_f32 v158, v158
v_sqrt_f32 v159, v159
v_sqrt_f32 v160, v160
v_sqrt_f32 v161, v161
v_add_f32 v163, v156, v157
v_add_f32 v163, v163, v158
v_add_f32 v163, v163, v159
v_add_f32 v163, v163, v160
v_add_f32 v163, v163, v161
s_nop 1
v_add_f32_dpp v163, v163, v163 row_ror:8 row_mask:0xf bank_mask:0xf
s_nop 1
v_add_f32_dpp v163, v163, v163 row_ror:4 row_mask:0xf bank_mask:0xf
s_nop 1
v_add_f32_dpp v163, v163, v163 row_ror:2 row_mask:0xf bank_mask:0xf
s_nop 1
v_add_f32_dpp v163, v163, v163 row_ror:1 row_mask:0xf bank_mask:0xf
v_mov_b32 v255, v163
s_nop 1
v_permlane16_swap_b32 v163, v255
v_add_f32 v163, v163, v255
v_mov_b32 v255, v163
s_nop 1
v_permlane32_swap_b32 v163, v255
v_add_f32_e64 v163, v163, v255
s_mov_b32 s43, 992651947
v_fma_f32 v163, v163, s43, v162
v_rcp_f32_e64 v163, v163
v_mov_b32 v162, 3221789604
v_mul_f32 v163, v163, v162
v_lshlrev_b32 v164, 16, v244
v_and_b32 v165, 4294901760, v244
v_mul_f32 v156, v156, v163
v_mul_f32 v157, v157, v163
v_fma_f32 v164, v164, v156, v162
v_fma_f32 v165, v165, v157, v162
v_cvt_pk_f16_f32 v244, v164, v165
v_lshlrev_b32_e64 v164, 16, v245
v_and_b32 v165, 4294901760, v245
v_mul_f32 v158, v158, v163
v_mul_f32 v159, v159, v163
v_fma_f32 v164, v164, v158, v162
v_fma_f32 v165, v165, v159, v162
v_cvt_pk_f16_f32 v245, v164, v165
v_lshlrev_b32_e64 v164, 16, v246
v_and_b32 v165, 4294901760, v246
v_mul_f32 v160, v160, v163
v_mul_f32 v161, v161, v163
v_fma_f32 v164, v164, v160, v162
v_fma_f32 v165, v165, v161, v162
v_cvt_pk_f16_f32 v246, v164, v165
s_mov_b32 s77, 0
s_setpc_b64 s[78:79]
Lend:
s_endpgm

.section .rodata,"a"
.p2align 6
.amdhsa_kernel standalone__modern_conv_block_convnext_v2__vision_kernel
  .amdhsa_next_free_vgpr 256
  .amdhsa_next_free_sgpr 102
  .amdhsa_accum_offset 256
  .amdhsa_group_segment_fixed_size 0
  .amdhsa_kernarg_size 72
  .amdhsa_user_sgpr_count 2
  .amdhsa_user_sgpr_kernarg_segment_ptr 1
  .amdhsa_system_sgpr_workgroup_id_x 1
.end_amdhsa_kernel
```

```asm
; @launch grid=(256,1,1) block=(512,1,1) lds=163840
.amdgcn_target "amdgcn-amd-amdhsa--gfx950"
.text
.globl standalone__modern_conv_block_convnext_v2__vision_kernel
.p2align 8
.type standalone__modern_conv_block_convnext_v2__vision_kernel,@function
standalone__modern_conv_block_convnext_v2__vision_kernel:
s_branch Lmain
Lconv0:
ds_read_b128 v[192:195], v242
ds_read_b128 v[196:199], v242 offset:64
ds_read_b128 v[200:203], v242 offset:128
ds_read_b128 v[204:207], v243
ds_read_b128 v[208:211], v243 offset:64
ds_read_b128 v[212:215], v243 offset:128
ds_read_b128 v[224:227], v244
ds_read_b128 v[228:231], v244 offset:64
ds_read_b128 v[232:235], v244 offset:128
v_xor_b32 v242, 16, v242
ds_read_b128 v[236:239], v242
ds_read_b128 v[216:219], v242 offset:64
ds_read_b128 v[220:223], v242 offset:128
s_waitcnt lgkmcnt(11)
v_smfmac_f32_16x16x32_bf16 v[0:3], v[48:49], v[192:195], v246
s_waitcnt lgkmcnt(10)
v_smfmac_f32_16x16x32_bf16 v[16:19], v[50:51], v[196:199], v246
s_waitcnt lgkmcnt(9)
v_smfmac_f32_16x16x32_bf16 v[32:35], v[52:53], v[200:203], v246
s_waitcnt lgkmcnt(8)
v_xor_b32 v243, 16, v243
ds_read_b128 v[192:195], v243
ds_read_b128 v[196:199], v243 offset:64
v_smfmac_f32_16x16x32_bf16 v[0:3], v[54:55], v[204:207], v246
s_waitcnt lgkmcnt(9)
v_smfmac_f32_16x16x32_bf16 v[16:19], v[56:57], v[208:211], v246
s_waitcnt lgkmcnt(8)
ds_read_b128 v[200:203], v243 offset:128
v_xor_b32 v244, 16, v244
ds_read_b128 v[204:207], v244
v_smfmac_f32_16x16x32_bf16 v[32:35], v[58:59], v[212:215], v246
s_waitcnt lgkmcnt(9)
v_smfmac_f32_16x16x32_bf16 v[0:3], v[60:61], v[224:227], v246
s_waitcnt lgkmcnt(8)
ds_read_b128 v[208:211], v244 offset:64
ds_read_b128 v[212:215], v244 offset:128
v_smfmac_f32_16x16x32_bf16 v[16:19], v[62:63], v[228:231], v246
s_waitcnt lgkmcnt(9)
v_smfmac_f32_16x16x32_bf16 v[32:35], v[64:65], v[232:235], v246
s_waitcnt lgkmcnt(8)
v_xor_b32 v242, 32, v242
ds_read_b128 v[224:227], v242
ds_read_b128 v[228:231], v242 offset:64
v_smfmac_f32_16x16x32_bf16 v[4:7], v[66:67], v[236:239], v246
s_waitcnt lgkmcnt(9)
v_smfmac_f32_16x16x32_bf16 v[20:23], v[68:69], v[216:219], v246
s_waitcnt lgkmcnt(8)
ds_read_b128 v[232:235], v242 offset:128
v_xor_b32 v243, 32, v243
ds_read_b128 v[236:239], v243
v_smfmac_f32_16x16x32_bf16 v[36:39], v[70:71], v[220:223], v246
s_waitcnt lgkmcnt(9)
v_smfmac_f32_16x16x32_bf16 v[4:7], v[72:73], v[192:195], v246
s_waitcnt lgkmcnt(8)
ds_read_b128 v[216:219], v243 offset:64
ds_read_b128 v[220:223], v243 offset:128
v_smfmac_f32_16x16x32_bf16 v[20:23], v[74:75], v[196:199], v246
s_waitcnt lgkmcnt(9)
v_smfmac_f32_16x16x32_bf16 v[36:39], v[76:77], v[200:203], v246
s_waitcnt lgkmcnt(8)
v_xor_b32 v244, 32, v244
ds_read_b128 v[192:195], v244
ds_read_b128 v[196:199], v244 offset:64
v_smfmac_f32_16x16x32_bf16 v[4:7], v[78:79], v[204:207], v246
s_waitcnt lgkmcnt(9)
v_smfmac_f32_16x16x32_bf16 v[20:23], v[80:81], v[208:211], v246
s_waitcnt lgkmcnt(8)
ds_read_b128 v[200:203], v244 offset:128
v_xor_b32 v242, 16, v242
ds_read_b128 v[204:207], v242
v_smfmac_f32_16x16x32_bf16 v[36:39], v[82:83], v[212:215], v246
s_waitcnt lgkmcnt(9)
v_smfmac_f32_16x16x32_bf16 v[12:15], v[84:85], v[224:227], v246
s_waitcnt lgkmcnt(8)
ds_read_b128 v[208:211], v242 offset:64
ds_read_b128 v[212:215], v242 offset:128
v_smfmac_f32_16x16x32_bf16 v[28:31], v[86:87], v[228:231], v246
s_waitcnt lgkmcnt(9)
v_smfmac_f32_16x16x32_bf16 v[44:47], v[88:89], v[232:235], v246
s_waitcnt lgkmcnt(8)
v_xor_b32 v243, 16, v243
ds_read_b128 v[224:227], v243
ds_read_b128 v[228:231], v243 offset:64
v_smfmac_f32_16x16x32_bf16 v[12:15], v[90:91], v[236:239], v246
s_waitcnt lgkmcnt(9)
v_smfmac_f32_16x16x32_bf16 v[28:31], v[92:93], v[216:219], v246
s_waitcnt lgkmcnt(8)
ds_read_b128 v[232:235], v243 offset:128
v_xor_b32 v244, 16, v244
ds_read_b128 v[236:239], v244
v_smfmac_f32_16x16x32_bf16 v[44:47], v[94:95], v[220:223], v246
s_waitcnt lgkmcnt(9)
v_smfmac_f32_16x16x32_bf16 v[12:15], v[96:97], v[192:195], v246
s_waitcnt lgkmcnt(8)
ds_read_b128 v[216:219], v244 offset:64
ds_read_b128 v[220:223], v244 offset:128
v_smfmac_f32_16x16x32_bf16 v[28:31], v[98:99], v[196:199], v246
s_waitcnt lgkmcnt(9)
v_smfmac_f32_16x16x32_bf16 v[44:47], v[100:101], v[200:203], v246
s_waitcnt lgkmcnt(8)
v_smfmac_f32_16x16x32_bf16 v[8:11], v[102:103], v[204:207], v246
s_waitcnt lgkmcnt(7)
v_smfmac_f32_16x16x32_bf16 v[24:27], v[104:105], v[208:211], v246
s_waitcnt lgkmcnt(6)
v_smfmac_f32_16x16x32_bf16 v[40:43], v[106:107], v[212:215], v246
s_waitcnt lgkmcnt(5)
v_smfmac_f32_16x16x32_bf16 v[8:11], v[108:109], v[224:227], v246
s_waitcnt lgkmcnt(4)
v_smfmac_f32_16x16x32_bf16 v[24:27], v[110:111], v[228:231], v246
s_waitcnt lgkmcnt(3)
v_smfmac_f32_16x16x32_bf16 v[40:43], v[112:113], v[232:235], v246
s_waitcnt lgkmcnt(2)
v_smfmac_f32_16x16x32_bf16 v[8:11], v[114:115], v[236:239], v246
s_waitcnt lgkmcnt(1)
v_smfmac_f32_16x16x32_bf16 v[24:27], v[116:117], v[216:219], v246
s_waitcnt lgkmcnt(0)
v_smfmac_f32_16x16x32_bf16 v[40:43], v[118:119], v[220:223], v246
s_nop 11
s_setpc_b64 s[78:79]
Lln0:
v_pk_add_f32 v[168:169], v[0:1], v[2:3]
v_pk_mul_f32 v[170:171], v[0:1], v[0:1]
v_pk_fma_f32 v[170:171], v[2:3], v[2:3], v[170:171]
v_pk_add_f32 v[168:169], v[168:169], v[4:5]
v_pk_fma_f32 v[170:171], v[4:5], v[4:5], v[170:171]
v_pk_add_f32 v[168:169], v[168:169], v[6:7]
v_pk_fma_f32 v[170:171], v[6:7], v[6:7], v[170:171]
v_pk_add_f32 v[168:169], v[168:169], v[8:9]
v_pk_fma_f32 v[170:171], v[8:9], v[8:9], v[170:171]
v_pk_add_f32 v[168:169], v[168:169], v[10:11]
v_pk_fma_f32 v[170:171], v[10:11], v[10:11], v[170:171]
v_pk_add_f32 v[168:169], v[168:169], v[12:13]
v_pk_fma_f32 v[170:171], v[12:13], v[12:13], v[170:171]
v_pk_add_f32 v[168:169], v[168:169], v[14:15]
v_pk_fma_f32 v[170:171], v[14:15], v[14:15], v[170:171]
v_pk_add_f32 v[168:169], v[168:169], v[16:17]
v_pk_fma_f32 v[170:171], v[16:17], v[16:17], v[170:171]
v_pk_add_f32 v[168:169], v[168:169], v[18:19]
v_pk_fma_f32 v[170:171], v[18:19], v[18:19], v[170:171]
v_pk_add_f32 v[168:169], v[168:169], v[20:21]
v_pk_fma_f32 v[170:171], v[20:21], v[20:21], v[170:171]
v_pk_add_f32 v[168:169], v[168:169], v[22:23]
v_pk_fma_f32 v[170:171], v[22:23], v[22:23], v[170:171]
v_pk_add_f32 v[168:169], v[168:169], v[24:25]
v_pk_fma_f32 v[170:171], v[24:25], v[24:25], v[170:171]
v_pk_add_f32 v[168:169], v[168:169], v[26:27]
v_pk_fma_f32 v[170:171], v[26:27], v[26:27], v[170:171]
v_pk_add_f32 v[168:169], v[168:169], v[28:29]
v_pk_fma_f32 v[170:171], v[28:29], v[28:29], v[170:171]
v_pk_add_f32 v[168:169], v[168:169], v[30:31]
v_pk_fma_f32 v[170:171], v[30:31], v[30:31], v[170:171]
v_pk_add_f32 v[168:169], v[168:169], v[32:33]
v_pk_fma_f32 v[170:171], v[32:33], v[32:33], v[170:171]
v_pk_add_f32 v[168:169], v[168:169], v[34:35]
v_pk_fma_f32 v[170:171], v[34:35], v[34:35], v[170:171]
v_pk_add_f32 v[168:169], v[168:169], v[36:37]
v_pk_fma_f32 v[170:171], v[36:37], v[36:37], v[170:171]
v_pk_add_f32 v[168:169], v[168:169], v[38:39]
v_pk_fma_f32 v[170:171], v[38:39], v[38:39], v[170:171]
v_pk_add_f32 v[168:169], v[168:169], v[40:41]
v_pk_fma_f32 v[170:171], v[40:41], v[40:41], v[170:171]
v_pk_add_f32 v[168:169], v[168:169], v[42:43]
v_pk_fma_f32 v[170:171], v[42:43], v[42:43], v[170:171]
v_pk_add_f32 v[168:169], v[168:169], v[44:45]
v_pk_fma_f32 v[170:171], v[44:45], v[44:45], v[170:171]
v_pk_add_f32 v[168:169], v[168:169], v[46:47]
v_pk_fma_f32 v[170:171], v[46:47], v[46:47], v[170:171]
v_add_f32 v168, v168, v169
v_add_f32 v170, v170, v171
s_nop 1
v_permlane32_swap_b32 v168, v170
v_add_f32_e64 v168, v168, v170
v_mul_f32 v168, 1009429163, v168
v_mov_b32_e64 v170, v168
s_nop 1
v_permlane32_swap_b32 v168, v170
v_fma_f32 v170, -v168, v168, v170
v_max_f32_e64 v170, 0, v170
v_add_f32 v170, 925353388, v170
v_rsq_f32 v170, v170
s_nop 0
v_mul_f32 v172, 3203391086, v170
v_mul_f32_e64 v173, v168, v172
v_pk_fma_f32 v[0:1], v[0:1], v[172:173], v[172:173] op_sel:[0,0,1] op_sel_hi:[1,0,1] neg_lo:[0,0,1] neg_hi:[0,0,1]
v_pk_fma_f32 v[2:3], v[2:3], v[172:173], v[172:173] op_sel:[0,0,1] op_sel_hi:[1,0,1] neg_lo:[0,0,1] neg_hi:[0,0,1]
v_pk_fma_f32 v[4:5], v[4:5], v[172:173], v[172:173] op_sel:[0,0,1] op_sel_hi:[1,0,1] neg_lo:[0,0,1] neg_hi:[0,0,1]
v_pk_fma_f32 v[6:7], v[6:7], v[172:173], v[172:173] op_sel:[0,0,1] op_sel_hi:[1,0,1] neg_lo:[0,0,1] neg_hi:[0,0,1]
v_pk_fma_f32 v[8:9], v[8:9], v[172:173], v[172:173] op_sel:[0,0,1] op_sel_hi:[1,0,1] neg_lo:[0,0,1] neg_hi:[0,0,1]
v_pk_fma_f32 v[10:11], v[10:11], v[172:173], v[172:173] op_sel:[0,0,1] op_sel_hi:[1,0,1] neg_lo:[0,0,1] neg_hi:[0,0,1]
v_pk_fma_f32 v[12:13], v[12:13], v[172:173], v[172:173] op_sel:[0,0,1] op_sel_hi:[1,0,1] neg_lo:[0,0,1] neg_hi:[0,0,1]
v_pk_fma_f32 v[14:15], v[14:15], v[172:173], v[172:173] op_sel:[0,0,1] op_sel_hi:[1,0,1] neg_lo:[0,0,1] neg_hi:[0,0,1]
v_pk_fma_f32 v[16:17], v[16:17], v[172:173], v[172:173] op_sel:[0,0,1] op_sel_hi:[1,0,1] neg_lo:[0,0,1] neg_hi:[0,0,1]
v_pk_fma_f32 v[18:19], v[18:19], v[172:173], v[172:173] op_sel:[0,0,1] op_sel_hi:[1,0,1] neg_lo:[0,0,1] neg_hi:[0,0,1]
v_pk_fma_f32 v[20:21], v[20:21], v[172:173], v[172:173] op_sel:[0,0,1] op_sel_hi:[1,0,1] neg_lo:[0,0,1] neg_hi:[0,0,1]
v_pk_fma_f32 v[22:23], v[22:23], v[172:173], v[172:173] op_sel:[0,0,1] op_sel_hi:[1,0,1] neg_lo:[0,0,1] neg_hi:[0,0,1]
v_pk_fma_f32 v[24:25], v[24:25], v[172:173], v[172:173] op_sel:[0,0,1] op_sel_hi:[1,0,1] neg_lo:[0,0,1] neg_hi:[0,0,1]
v_pk_fma_f32 v[26:27], v[26:27], v[172:173], v[172:173] op_sel:[0,0,1] op_sel_hi:[1,0,1] neg_lo:[0,0,1] neg_hi:[0,0,1]
v_pk_fma_f32 v[28:29], v[28:29], v[172:173], v[172:173] op_sel:[0,0,1] op_sel_hi:[1,0,1] neg_lo:[0,0,1] neg_hi:[0,0,1]
v_pk_fma_f32 v[30:31], v[30:31], v[172:173], v[172:173] op_sel:[0,0,1] op_sel_hi:[1,0,1] neg_lo:[0,0,1] neg_hi:[0,0,1]
v_pk_fma_f32 v[32:33], v[32:33], v[172:173], v[172:173] op_sel:[0,0,1] op_sel_hi:[1,0,1] neg_lo:[0,0,1] neg_hi:[0,0,1]
v_pk_fma_f32 v[34:35], v[34:35], v[172:173], v[172:173] op_sel:[0,0,1] op_sel_hi:[1,0,1] neg_lo:[0,0,1] neg_hi:[0,0,1]
v_pk_fma_f32 v[36:37], v[36:37], v[172:173], v[172:173] op_sel:[0,0,1] op_sel_hi:[1,0,1] neg_lo:[0,0,1] neg_hi:[0,0,1]
v_pk_fma_f32 v[38:39], v[38:39], v[172:173], v[172:173] op_sel:[0,0,1] op_sel_hi:[1,0,1] neg_lo:[0,0,1] neg_hi:[0,0,1]
v_pk_fma_f32 v[40:41], v[40:41], v[172:173], v[172:173] op_sel:[0,0,1] op_sel_hi:[1,0,1] neg_lo:[0,0,1] neg_hi:[0,0,1]
v_pk_fma_f32 v[42:43], v[42:43], v[172:173], v[172:173] op_sel:[0,0,1] op_sel_hi:[1,0,1] neg_lo:[0,0,1] neg_hi:[0,0,1]
v_pk_fma_f32 v[44:45], v[44:45], v[172:173], v[172:173] op_sel:[0,0,1] op_sel_hi:[1,0,1] neg_lo:[0,0,1] neg_hi:[0,0,1]
v_pk_fma_f32 v[46:47], v[46:47], v[172:173], v[172:173] op_sel:[0,0,1] op_sel_hi:[1,0,1] neg_lo:[0,0,1] neg_hi:[0,0,1]
v_cvt_pk_bf16_f32 v48, v0, v1
v_cvt_pk_bf16_f32 v49, v2, v3
v_cvt_pk_bf16_f32 v50, v4, v5
v_cvt_pk_bf16_f32 v51, v6, v7
v_cvt_pk_bf16_f32 v52, v8, v9
v_cvt_pk_bf16_f32 v53, v10, v11
v_cvt_pk_bf16_f32 v54, v12, v13
v_cvt_pk_bf16_f32 v55, v14, v15
v_cvt_pk_bf16_f32 v56, v16, v17
v_cvt_pk_bf16_f32 v57, v18, v19
v_cvt_pk_bf16_f32 v58, v20, v21
v_cvt_pk_bf16_f32 v59, v22, v23
v_cvt_pk_bf16_f32 v60, v24, v25
v_cvt_pk_bf16_f32 v61, v26, v27
v_cvt_pk_bf16_f32 v62, v28, v29
v_cvt_pk_bf16_f32 v63, v30, v31
v_cvt_pk_bf16_f32 v64, v32, v33
v_cvt_pk_bf16_f32 v65, v34, v35
v_cvt_pk_bf16_f32 v66, v36, v37
v_cvt_pk_bf16_f32 v67, v38, v39
v_cvt_pk_bf16_f32 v68, v40, v41
v_cvt_pk_bf16_f32 v69, v42, v43
v_cvt_pk_bf16_f32 v70, v44, v45
v_cvt_pk_bf16_f32 v71, v46, v47
s_nop 1
s_setpc_b64 s[78:79]
Lw1a:
ds_read_b64_tr_b16 v[148:149], v146
ds_read_b64_tr_b16 v[150:151], v146 offset:512
ds_read_b64_tr_b16 v[152:153], v146 offset:1024
ds_read_b64_tr_b16 v[154:155], v146 offset:1536
ds_read_b64_tr_b16 v[156:157], v146 offset:2048
ds_read_b64_tr_b16 v[158:159], v146 offset:2560
ds_read_b64_tr_b16 v[160:161], v146 offset:3072
ds_read_b64_tr_b16 v[162:163], v146 offset:3584
ds_read_b64_tr_b16 v[164:165], v146 offset:4096
ds_read_b64_tr_b16 v[166:167], v146 offset:4608
ds_read_b64_tr_b16 v[168:169], v146 offset:5120
ds_read_b64_tr_b16 v[170:171], v146 offset:5632
s_waitcnt lgkmcnt(10)
ds_write_b128 v147, v[148:151]
s_waitcnt lgkmcnt(9)
ds_write_b128 v147, v[152:155] offset:1024
s_waitcnt lgkmcnt(8)
ds_write_b128 v147, v[156:159] offset:2048
s_waitcnt lgkmcnt(7)
ds_write_b128 v147, v[160:163] offset:3072
s_waitcnt lgkmcnt(6)
ds_write_b128 v147, v[164:167] offset:4096
s_waitcnt lgkmcnt(5)
ds_write_b128 v147, v[168:171] offset:5120
s_waitcnt lgkmcnt(0)
s_setpc_b64 s[78:79]
Lw1i:
s_add_u32 m0, s77, 24576
s_add_u32 s43, s3, 256
buffer_load_dwordx4 v145, s[12:15], s43 offen lds
s_add_u32 m0, s77, 25600
s_add_u32 s43, s3, 24832
buffer_load_dwordx4 v145, s[12:15], s43 offen lds
s_add_u32 m0, s77, 26624
s_add_u32 s43, s3, 49408
buffer_load_dwordx4 v145, s[12:15], s43 offen lds
s_add_u32 m0, s77, 27648
s_add_u32 s43, s3, 12544
buffer_load_dwordx4 v145, s[12:15], s43 offen lds
s_add_u32 m0, s77, 28672
s_add_u32 s43, s3, 37120
buffer_load_dwordx4 v145, s[12:15], s43 offen lds
s_add_u32 m0, s77, 29696
s_add_u32 s43, s3, 61696
buffer_load_dwordx4 v145, s[12:15], s43 offen lds
s_add_u32 m0, s77, 49152
s_add_u32 s43, s3, 512
buffer_load_dwordx4 v145, s[12:15], s43 offen lds
s_add_u32 m0, s77, 50176
s_add_u32 s43, s3, 25088
buffer_load_dwordx4 v145, s[12:15], s43 offen lds
s_add_u32 m0, s77, 51200
s_add_u32 s43, s3, 49664
buffer_load_dwordx4 v145, s[12:15], s43 offen lds
s_add_u32 m0, s77, 52224
s_add_u32 s43, s3, 12800
buffer_load_dwordx4 v145, s[12:15], s43 offen lds
s_add_u32 m0, s77, 53248
s_add_u32 s43, s3, 37376
buffer_load_dwordx4 v145, s[12:15], s43 offen lds
s_add_u32 m0, s77, 54272
s_add_u32 s43, s3, 61952
buffer_load_dwordx4 v145, s[12:15], s43 offen lds
s_setpc_b64 s[78:79]
Lw1b:
s_waitcnt vmcnt(0)
ds_read_b64_tr_b16 v[72:73], v146 offset:24576
ds_read_b64_tr_b16 v[74:75], v146 offset:25088
ds_read_b64_tr_b16 v[76:77], v146 offset:25600
ds_read_b64_tr_b16 v[78:79], v146 offset:26112
ds_read_b64_tr_b16 v[80:81], v146 offset:26624
ds_read_b64_tr_b16 v[82:83], v146 offset:27136
ds_read_b64_tr_b16 v[84:85], v146 offset:27648
ds_read_b64_tr_b16 v[86:87], v146 offset:28160
ds_read_b64_tr_b16 v[88:89], v146 offset:28672
ds_read_b64_tr_b16 v[90:91], v146 offset:29184
ds_read_b64_tr_b16 v[92:93], v146 offset:29696
ds_read_b64_tr_b16 v[94:95], v146 offset:30208
ds_read_b64_tr_b16 v[96:97], v146 offset:49152
ds_read_b64_tr_b16 v[98:99], v146 offset:49664
ds_read_b64_tr_b16 v[100:101], v146 offset:50176
ds_read_b64_tr_b16 v[102:103], v146 offset:50688
ds_read_b64_tr_b16 v[104:105], v146 offset:51200
ds_read_b64_tr_b16 v[106:107], v146 offset:51712
ds_read_b64_tr_b16 v[108:109], v146 offset:52224
ds_read_b64_tr_b16 v[110:111], v146 offset:52736
ds_read_b64_tr_b16 v[112:113], v146 offset:53248
ds_read_b64_tr_b16 v[114:115], v146 offset:53760
ds_read_b64_tr_b16 v[116:117], v146 offset:54272
ds_read_b64_tr_b16 v[118:119], v146 offset:54784
s_waitcnt lgkmcnt(15)
ds_write_b128 v147, v[72:75] offset:24576
ds_write_b128 v147, v[76:79] offset:25600
ds_write_b128 v147, v[80:83] offset:26624
ds_write_b128 v147, v[84:87] offset:27648
s_waitcnt lgkmcnt(15)
ds_write_b128 v147, v[88:91] offset:28672
ds_write_b128 v147, v[92:95] offset:29696
s_waitcnt lgkmcnt(15)
ds_write_b128 v147, v[96:99] offset:49152
s_waitcnt lgkmcnt(15)
ds_write_b128 v147, v[100:103] offset:50176
s_waitcnt lgkmcnt(14)
ds_write_b128 v147, v[104:107] offset:51200
s_waitcnt lgkmcnt(13)
ds_write_b128 v147, v[108:111] offset:52224
s_waitcnt lgkmcnt(12)
ds_write_b128 v147, v[112:115] offset:53248
s_waitcnt lgkmcnt(11)
ds_write_b128 v147, v[116:119] offset:54272
s_waitcnt lgkmcnt(0)
s_setpc_b64 s[78:79]
Lpre:
ds_read_b128 v[48:51], v245
ds_read_b128 v[52:55], v245 offset:384
ds_read_b128 v[56:59], v245 offset:768
ds_read_b128 v[60:63], v245 offset:1152
ds_read_b128 v[64:67], v245 offset:1536
ds_read_b128 v[68:71], v245 offset:1920
ds_read_b128 v[72:75], v245 offset:2304
ds_read_b128 v[76:79], v245 offset:2688
ds_read_b128 v[80:83], v245 offset:3072
ds_read_b128 v[84:87], v245 offset:3456
ds_read_b128 v[88:91], v245 offset:3840
ds_read_b128 v[92:95], v245 offset:4224
ds_read_b128 v[96:99], v245 offset:4608
ds_read_b128 v[100:103], v245 offset:4992
ds_read_b128 v[104:107], v245 offset:5376
ds_read_b128 v[108:111], v245 offset:5760
ds_read_b128 v[112:115], v245 offset:6144
ds_read_b128 v[116:119], v245 offset:6528
v_mov_b32 v0, 0
v_mov_b32 v1, 0
v_mov_b32 v2, 0
v_mov_b32 v3, 0
v_mov_b32 v4, 0
v_mov_b32 v5, 0
v_mov_b32 v6, 0
v_mov_b32 v7, 0
v_mov_b32 v8, 0
v_mov_b32 v9, 0
v_mov_b32 v10, 0
v_mov_b32 v11, 0
v_mov_b32 v12, 0
v_mov_b32 v13, 0
v_mov_b32 v14, 0
v_mov_b32 v15, 0
v_mov_b32 v16, 0
v_mov_b32 v17, 0
v_mov_b32 v18, 0
v_mov_b32 v19, 0
v_mov_b32 v20, 0
v_mov_b32 v21, 0
v_mov_b32 v22, 0
v_mov_b32 v23, 0
v_mov_b32 v24, 0
v_mov_b32 v25, 0
v_mov_b32 v26, 0
v_mov_b32 v27, 0
v_mov_b32 v28, 0
v_mov_b32 v29, 0
v_mov_b32 v30, 0
v_mov_b32 v31, 0
v_mov_b32 v32, 0
v_mov_b32 v33, 0
v_mov_b32 v34, 0
v_mov_b32 v35, 0
v_mov_b32 v36, 0
v_mov_b32 v37, 0
v_mov_b32 v38, 0
v_mov_b32 v39, 0
v_mov_b32 v40, 0
v_mov_b32 v41, 0
v_mov_b32 v42, 0
v_mov_b32 v43, 0
v_mov_b32 v44, 0
v_mov_b32 v45, 0
v_mov_b32_e64 v46, 0
v_mov_b32 v47, 0
s_waitcnt lgkmcnt(0)
s_setpc_b64 s[78:79]
Lrb:
s_add_u32 m0, s67, 39936
s_add_u32 s45, s66, 491520
buffer_load_dwordx4 v240, s[4:7], s45 offen nt lds
s_add_u32 m0, s67, 46592
s_add_u32 s45, s66, 589824
buffer_load_dwordx4 v240, s[4:7], s45 offen nt lds
s_add_u32 m0, s67, 53248
s_add_u32 s45, s66, 688128
buffer_load_dwordx4 v240, s[4:7], s45 offen nt lds
s_add_u32 m0, s67, 59904
s_add_u32 s45, s66, 786432
buffer_load_dwordx4 v240, s[4:7], s45 offen nt lds
s_setpc_b64 s[78:79]
Lw1f:
s_add_u32 m0, s77, 0
s_add_u32 s43, s3, 0
buffer_load_dwordx4 v145, s[12:15], s43 offen lds
s_add_u32 m0, s77, 1024
s_add_u32 s43, s3, 24576
buffer_load_dwordx4 v145, s[12:15], s43 offen lds
s_add_u32 m0, s77, 2048
s_add_u32 s43, s3, 49152
buffer_load_dwordx4 v145, s[12:15], s43 offen lds
s_add_u32 m0, s77, 3072
s_add_u32 s43, s3, 12288
buffer_load_dwordx4 v145, s[12:15], s43 offen lds
s_add_u32 m0, s77, 4096
s_add_u32 s43, s3, 36864
buffer_load_dwordx4 v145, s[12:15], s43 offen lds
s_add_u32 m0, s77, 5120
s_add_u32 s43, s3, 61440
buffer_load_dwordx4 v145, s[12:15], s43 offen lds
s_setpc_b64 s[78:79]
Lmain:
s_cmp_ge_u32 s2, 256
s_cbranch_scc1 Lend
s_load_dwordx16 s[80:95], s[0:1], 0
s_load_dwordx2 s[96:97], s[0:1], 64
s_getpc_b64 s[74:75]
Lpc0:
s_sub_u32 s74, s74, Lpc0-Lconv0+4
s_subb_u32 s75, s75, 0
v_lshlrev_b32_e64 v159, 7, v0
s_movk_i32 s43, 64
v_cmp_gt_u32 vcc, s43, v0
s_and_saveexec_b64 s[78:79], vcc
s_cbranch_execz Lpf0x
global_load_dword v255, v159, s[74:75]
Lpf0x:
s_mov_b64 exec, s[78:79]
v_mov_b32 v199, v0
v_and_b32 v251, 63, v0
v_lshrrev_b32 v120, 6, v0
s_nop 0
v_readfirstlane_b32 s40, v120
s_and_b32 s43, s2, 7
s_lshr_b32 s44, s2, 3
s_and_b32 s41, s43, 3
s_lshl_b32 s41, s41, 2
s_and_b32 s45, s44, 3
s_add_u32 s41, s41, s45
s_lshr_b32 s42, s43, 2
s_lshl_b32 s42, s42, 3
s_lshr_b32 s45, s44, 2
s_add_u32 s42, s42, s45
s_lshl_b32 s41, s41, 5
s_lshl_b32 s42, s42, 5
s_lshl_b32 s67, s40, 6
s_cmp_eq_u32 s40, 6
s_cselect_b32 s67, 352, s67
v_add_u32_e64 v125, s67, v251
v_mul_u32_u24 v121, 5462, v125
v_lshrrev_b32 v121, 16, v121
v_mul_u32_u24 v122, 12, v121
v_sub_u32 v122, v125, v122
v_bfe_u32 v123, v121, 2, 2
v_xor_b32 v122, v122, v123
v_add_u32 v123, s41, v121
v_subrev_u32 v123, 1, v123
v_mul_u32_u24 v124, 192, v123
v_lshl_add_u32 v124, v122, 4, v124
v_mov_b32 v240, 2147483648
s_movk_i32 s43, 512
v_cmp_gt_u32 vcc, s43, v123
s_nop 1
v_cndmask_b32 v124, v240, v124, vcc
v_cmp_gt_u32 vcc, 34, v121
s_nop 1
v_cndmask_b32 v240, v240, v124, vcc
s_add_i32 s43, s42, -1
s_mul_i32 s44, s43, 98304
s_cmp_lt_u32 s43, 512
s_cselect_b32 s46, s44, 1073741824
s_mul_i32 s66, s42, 98304
s_mov_b32 s6, 50331648
s_mov_b32 s7, 131072
s_lshl_b32 s67, s67, 4
s_add_u32 s67, s67, 90112
s_cmp_eq_u32 s40, 7
s_cselect_b32 s67, 163840, s67
v_lshlrev_b32 v130, 1, v199
v_add_u32 v155, 768, v199
v_min_u32 v155, 863, v155
v_lshlrev_b32_e64 v131, 1, v155
s_waitcnt lgkmcnt(0)
s_mov_b32 s4, s80
s_and_b32 s5, s81, 65535
s_cmp_ge_u32 s40, 4
s_cbranch_scc1 Lnodw
s_mov_b32 s20, s82
s_and_b32 s21, s83, 65535
s_mov_b32 s22, 1728
s_mov_b32 s23, 131072
buffer_load_ushort v126, v130, s[20:23], 0 offen offset:0
buffer_load_ushort v127, v130, s[20:23], 0 offen offset:512
buffer_load_ushort v128, v130, s[20:23], 0 offen offset:1024
buffer_load_ushort v129, v131, s[20:23], 0 offen offset:0
Lnodw:
s_cmp_eq_u32 s40, 7
s_cbranch_scc1 Lskipx0
s_add_u32 m0, s67, 0
s_nop 0
buffer_load_dwordx4 v240, s[4:7], s46 offen nt lds
s_add_u32 m0, s67, 6656
s_nop 0
buffer_load_dwordx4 v240, s[4:7], s66 offen nt lds
s_add_u32 m0, s67, 13312
s_add_u32 s45, s66, 98304
buffer_load_dwordx4 v240, s[4:7], s45 offen nt lds
s_add_u32 m0, s67, 19968
s_add_u32 s45, s66, 196608
buffer_load_dwordx4 v240, s[4:7], s45 offen nt lds
s_add_u32 m0, s67, 26624
s_add_u32 s45, s66, 294912
buffer_load_dwordx4 v240, s[4:7], s45 offen nt lds
s_add_u32 m0, s67, 33280
s_add_u32 s45, s66, 393216
buffer_load_dwordx4 v240, s[4:7], s45 offen nt lds
Lskipx0:
s_mov_b32 s12, s84
s_and_b32 s13, s85, 65535
s_mov_b32 s14, 73728
s_mov_b32 s15, 131072
v_lshrrev_b32 v145, 2, v251
v_mul_u32_u24 v145, 768, v145
v_and_b32_e64 v125, 3, v251
v_lshl_add_u32 v145, v125, 4, v145
s_and_b32 s43, s40, 3
s_lshl_b32 s3, s43, 6
s_mul_i32 s77, s43, 6144
s_add_u32 s77, s77, 16384
v_mov_b32 v253, 16256
v_mov_b32 v254, 1
s_add_u32 s43, s42, s40
s_add_u32 s43, s43, 1
s_lshl_b32 s43, s43, 9
s_add_u32 s43, s43, s41
s_mul_i32 s47, s43, 192
s_sub_u32 s47, s47, 256
s_and_b32 s43, s40, 1
s_lshl_b32 s46, s43, 4
s_add_u32 s41, s41, s46
s_and_b32 s43, s40, 6
s_add_u32 s42, s42, s43
s_mul_i32 s45, s43, 6656
s_add_u32 s45, s45, 90112
v_and_b32 v131, 15, v251
v_lshrrev_b32 v132, 4, v251
v_mul_u32_u24 v122, 6656, v132
v_add_u32 v122, s45, v122
v_add_u32 v121, s46, v131
v_mul_u32_u24 v123, 192, v121
v_bfe_u32 v124, v121, 2, 2
v_lshl_add_u32 v123, v124, 4, v123
v_add_u32 v242, v122, v123
v_add_u32 v121, 1, v121
v_mul_u32_u24 v123, 192, v121
v_bfe_u32 v124, v121, 2, 2
v_lshl_add_u32 v123, v124, 4, v123
v_add_u32 v243, v122, v123
v_add_u32 v121, 1, v121
v_mul_u32_u24 v123, 192, v121
v_bfe_u32 v124, v121, 2, 2
v_lshl_add_u32 v123, v124, 4, v123
v_add_u32_e64 v244, v122, v123
s_mul_i32 s72, s40, 9216
s_add_u32 s72, s72, 90112
v_bfe_u32 v133, v131, 2, 1
v_sub_u32 v133, v132, v133
v_lshrrev_b32 v134, 3, v131
v_and_b32_e64 v135, 3, v131
v_lshl_add_u32 v135, v134, 2, v135
v_lshlrev_b32_e64 v136, 7, v133
v_lshl_add_u32 v136, v135, 4, v136
v_add_u32 v136, 156672, v136
v_mov_b32 v135, 163840
v_cmp_gt_u32 vcc, 3, v133
s_nop 1
v_cndmask_b32 v245, v135, v136, vcc
v_and_b32 v135, 3, v131
v_mul_u32_u24 v246, 85, v135
s_mov_b32 s16, s86
s_and_b32 s17, s87, 65535
s_mov_b32 s18, 73728
s_mov_b32 s19, 131072
s_mov_b32 s24, s88
s_and_b32 s25, s89, 65535
s_mov_b32 s26, 768
s_mov_b32 s27, 131072
s_mov_b32 s28, s90
s_and_b32 s29, s91, 65535
s_mov_b32 s30, 768
s_mov_b32 s31, 131072
s_mov_b32 s8, s92
s_and_b32 s9, s93, 65535
s_mov_b32 s10, 50331648
s_mov_b32 s11, 131072
s_mov_b32 s36, s94
s_and_b32 s37, s95, 65535
s_mov_b32 s38, 256
s_mov_b32 s39, 131072
s_mov_b32 s32, s96
s_and_b32 s33, s97, 65535
s_mov_b32 s34, 83886080
s_mov_b32 s35, 131072
v_lshlrev_b32 v241, 4, v251
v_and_b32 v133, 35, v251
v_bfe_u32 v134, v251, 2, 2
v_lshl_add_u32 v133, v134, 3, v133
v_bfe_u32 v134, v251, 4, 1
v_lshl_add_u32 v133, v134, 2, v133
v_lshlrev_b32_e64 v248, 4, v133
v_add_u32 v249, 65536, v248
v_add_u32 v250, 131072, v248
s_lshl_b32 s73, s2, 3
s_add_u32 s73, s73, s40
s_lshl_b32 s80, s73, 10
s_add_u32 s80, s80, 4194304
s_mul_i32 s73, s73, 16
s_add_u32 s73, s73, 1048576
s_mul_i32 s46, s41, 192
s_add_u32 s43, s42, 0
s_mul_i32 s43, s43, 98304
s_add_u32 s68, s43, s46
s_add_u32 s43, s42, 8
s_mul_i32 s43, s43, 98304
s_add_u32 s69, s43, s46
s_add_u32 s43, s42, 16
s_mul_i32 s43, s43, 98304
s_add_u32 s70, s43, s46
s_add_u32 s43, s42, 24
s_mul_i32 s43, s43, 98304
s_add_u32 s71, s43, s46
s_mul_i32 s82, s40, 9216
s_mov_b32 s48, 1156203754
s_mov_b32 s49, 4294508536
s_mov_b32 s76, 400000
v_lshrrev_b32 v148, 5, v251
v_lshlrev_b32 v146, 8, v148
v_bfe_u32 v148, v251, 2, 2
v_lshl_add_u32 v146, v148, 6, v146
v_bfe_u32 v148, v251, 4, 1
v_lshl_add_u32 v146, v148, 5, v146
v_bfe_u32 v148, v251, 0, 1
v_lshl_add_u32 v146, v148, 4, v146
v_bfe_u32 v148, v251, 1, 1
v_lshl_add_u32 v146, v148, 3, v146
v_add_u32 v146, s77, v146
v_add_u32 v147, s77, v248
s_cmp_lt_u32 s40, 4
s_cbranch_scc1 Lnoy
v_lshlrev_b32_e64 v24, 6, v199
s_mov_b32 s43, 1065362610
v_mov_b32 v25, 1084047360
v_add_u32 v0, 32772, v24
v_add_u32 v1, 32780, v24
v_add_u32 v2, 32788, v24
v_add_u32 v3, 32796, v24
v_add_u32 v4, 32804, v24
v_add_u32 v5, 32812, v24
v_add_u32 v6, 32820, v24
v_add_u32 v7, 32828, v24
v_cvt_f32_f16 v0, v0
v_cvt_f32_f16 v1, v1
v_cvt_f32_f16 v2, v2
v_cvt_f32_f16 v3, v3
v_cvt_f32_f16 v4, v4
v_cvt_f32_f16 v5, v5
v_cvt_f32_f16 v6, v6
v_cvt_f32_f16 v7, v7
v_mul_f32 v8, v0, v0
v_mul_f32 v9, v1, v1
v_mul_f32 v10, v2, v2
v_mul_f32 v11, v3, v3
v_mul_f32 v12, v4, v4
v_mul_f32 v13, v5, v5
v_mul_f32 v14, v6, v6
v_mul_f32 v15, v7, v7
v_fma_f32 v8, v8, s43, v25
v_fma_f32 v9, v9, s43, v25
v_fma_f32 v10, v10, s43, v25
v_fma_f32 v11, v11, s43, v25
v_fma_f32 v12, v12, s43, v25
v_fma_f32 v13, v13, s43, v25
v_fma_f32 v14, v14, s43, v25
v_fma_f32 v15, v15, s43, v25
v_mul_f32 v8, v0, v8
v_mul_f32 v9, v1, v9
v_mul_f32 v10, v2, v10
v_mul_f32 v11, v3, v11
v_mul_f32 v12, v4, v12
v_mul_f32 v13, v5, v13
v_mul_f32 v14, v6, v14
v_mul_f32 v15, v7, v15
v_exp_f32 v8, v8
v_exp_f32 v9, v9
v_exp_f32 v10, v10
v_exp_f32 v11, v11
v_exp_f32 v12, v12
v_exp_f32 v13, v13
v_exp_f32 v14, v14
v_exp_f32 v15, v15
v_add_f32 v16, 1.0, v8
v_add_f32 v17, 1.0, v9
v_add_f32 v18, 1.0, v10
v_add_f32 v19, 1.0, v11
v_add_f32 v20, 1.0, v12
v_add_f32 v21, 1.0, v13
v_add_f32 v22, 1.0, v14
v_add_f32 v23, 1.0, v15
v_rcp_f32 v16, v16
v_rcp_f32 v17, v17
v_rcp_f32 v18, v18
v_rcp_f32 v19, v19
v_rcp_f32 v20, v20
v_rcp_f32 v21, v21
v_rcp_f32 v22, v22
v_rcp_f32 v23, v23
v_mul_f32 v0, v0, v16
v_mul_f32 v1, v1, v17
v_mul_f32 v2, v2, v18
v_mul_f32 v3, v3, v19
v_mul_f32 v4, v4, v20
v_mul_f32 v5, v5, v21
v_mul_f32 v6, v6, v22
v_mul_f32 v7, v7, v23
v_mul_f32 v8, v8, v0
v_mul_f32 v9, v9, v1
v_mul_f32 v10, v10, v2
v_mul_f32 v11, v11, v3
v_mul_f32 v12, v12, v4
v_mul_f32 v13, v13, v5
v_mul_f32 v14, v14, v6
v_mul_f32 v15, v15, v7
v_cvt_pk_f16_f32 v28, v0, v1
v_cvt_pk_f16_f32 v32, -v8, -v9
v_cvt_pk_f16_f32 v29, v2, v3
v_cvt_pk_f16_f32 v33, -v10, -v11
v_cvt_pk_f16_f32 v30, v4, v5
v_cvt_pk_f16_f32 v34, -v12, -v13
v_cvt_pk_f16_f32 v31, v6, v7
v_cvt_pk_f16_f32 v35, -v14, -v15
v_lshlrev_b32_e64 v24, 4, v199
v_mov_b32 v25, 163840
s_movk_i32 s43, 496
v_cmp_gt_u32 vcc, s43, v199
s_nop 1
v_cndmask_b32 v24, v25, v24, vcc
ds_write_b128 v24, v[32:35]
ds_write_b128 v24, v[28:31] offset:8192
Lnoy:
s_cmp_ge_u32 s40, 4
s_cbranch_scc1 Lnoo
v_add_u32_e64 v152, 0, v199
v_mul_u32_u24 v140, 683, v152
v_lshrrev_b32 v140, 16, v140
v_mul_u32_u24 v142, 11, v140
v_lshrrev_b32 v142, 5, v142
v_lshrrev_b32 v143, 5, v152
v_bfe_u32 v141, v152, 3, 2
v_bfe_u32 v144, v152, 4, 1
v_xor_b32 v141, v141, v144
v_sub_u32 v141, v141, v142
v_mul_i32_i24 v141, 9, v141
v_add_u32 v143, v143, v141
v_lshrrev_b32_e64 v141, 1, v143
v_mul_u32_u24 v141, 368, v141
v_lshl_add_u32 v143, v143, 3, v141
v_lshl_add_u32 v143, v142, 7, v143
v_and_b32_e64 v144, 7, v152
v_lshl_add_u32 v143, v144, 4, v143
v_add_u32 v156, 156672, v143
v_add_u32 v153, 256, v199
v_mul_u32_u24 v140, 683, v153
v_lshrrev_b32 v140, 16, v140
v_mul_u32_u24 v142, 11, v140
v_lshrrev_b32 v142, 5, v142
v_lshrrev_b32 v143, 5, v153
v_bfe_u32 v141, v153, 3, 2
v_bfe_u32 v144, v153, 4, 1
v_xor_b32 v141, v141, v144
v_sub_u32 v141, v141, v142
v_mul_i32_i24 v141, 9, v141
v_add_u32 v143, v143, v141
v_lshrrev_b32_e64 v141, 1, v143
v_mul_u32_u24 v141, 368, v141
v_lshl_add_u32 v143, v143, 3, v141
v_lshl_add_u32 v143, v142, 7, v143
v_and_b32_e64 v144, 7, v153
v_lshl_add_u32 v143, v144, 4, v143
v_add_u32 v157, 156672, v143
v_add_u32 v154, 512, v199
v_mul_u32_u24 v140, 683, v154
v_lshrrev_b32 v140, 16, v140
v_mul_u32_u24 v142, 11, v140
v_lshrrev_b32 v142, 5, v142
v_lshrrev_b32 v143, 5, v154
v_bfe_u32 v141, v154, 3, 2
v_bfe_u32 v144, v154, 4, 1
v_xor_b32 v141, v141, v144
v_sub_u32 v141, v141, v142
v_mul_i32_i24 v141, 9, v141
v_add_u32 v143, v143, v141
v_lshrrev_b32_e64 v141, 1, v143
v_mul_u32_u24 v141, 368, v141
v_lshl_add_u32 v143, v143, 3, v141
v_lshl_add_u32 v143, v142, 7, v143
v_and_b32_e64 v144, 7, v154
v_lshl_add_u32 v143, v144, 4, v143
v_add_u32 v158, 156672, v143
v_mul_u32_u24 v140, 683, v155
v_lshrrev_b32 v140, 16, v140
v_mul_u32_u24 v142, 11, v140
v_lshrrev_b32 v142, 5, v142
v_lshrrev_b32 v143, 5, v155
v_bfe_u32 v141, v155, 3, 2
v_bfe_u32 v144, v155, 4, 1
v_xor_b32 v141, v141, v144
v_sub_u32 v141, v141, v142
v_mul_i32_i24 v141, 9, v141
v_add_u32 v143, v143, v141
v_lshrrev_b32_e64 v141, 1, v143
v_mul_u32_u24 v141, 368, v141
v_lshl_add_u32 v143, v143, 3, v141
v_lshl_add_u32 v143, v142, 7, v143
v_and_b32_e64 v144, 7, v155
v_lshl_add_u32 v143, v144, 4, v143
v_add_u32 v159, 156672, v143
v_mov_b32 v160, 0
v_mov_b32 v161, 0
v_mov_b32_e64 v162, 0
v_mov_b32 v163, 0
s_mov_b64 exec, 1
ds_write_b128 v253, v[160:163]
ds_write_b128 v253, v[160:163] offset:16
s_mov_b64 exec, -1
s_waitcnt vmcnt(6)
v_and_b32_e64 v130, 4, v152
v_cmp_eq_u32 vcc, 0, v130
s_nop 1
v_cndmask_b32 v164, 0, v126, vcc
v_sub_u32 v165, v126, v164
ds_write_b64 v156, v[164:165]
v_and_b32_e64 v130, 4, v153
v_cmp_eq_u32 vcc, 0, v130
s_nop 1
v_cndmask_b32 v166, 0, v127, vcc
v_sub_u32 v167, v127, v166
ds_write_b64 v157, v[166:167]
v_and_b32_e64 v130, 4, v154
v_cmp_eq_u32 vcc, 0, v130
s_nop 1
v_cndmask_b32 v168, 0, v128, vcc
v_sub_u32 v169, v128, v168
ds_write_b64 v158, v[168:169]
v_and_b32_e64 v130, 4, v155
v_cmp_eq_u32 vcc, 0, v130
s_nop 1
v_cndmask_b32 v170, 0, v129, vcc
v_sub_u32 v171, v129, v170
ds_write_b64 v159, v[170:171]
s_waitcnt lgkmcnt(0)
Lnoo:
s_barrier
s_cmp_lt_u32 s40, 4
s_cbranch_scc1 Lnoy2
v_subrev_u32 v199, 256, v199
v_lshlrev_b32_e64 v24, 6, v199
s_mov_b32 s43, 1065362610
v_mov_b32 v25, 1084047360
v_add_u32 v0, 32772, v24
v_add_u32 v1, 32780, v24
v_add_u32 v2, 32788, v24
v_add_u32 v3, 32796, v24
v_add_u32 v4, 32804, v24
v_add_u32 v5, 32812, v24
v_add_u32 v6, 32820, v24
v_add_u32 v7, 32828, v24
v_cvt_f32_f16 v0, v0
v_cvt_f32_f16 v1, v1
v_cvt_f32_f16 v2, v2
v_cvt_f32_f16 v3, v3
v_cvt_f32_f16 v4, v4
v_cvt_f32_f16 v5, v5
v_cvt_f32_f16 v6, v6
v_cvt_f32_f16 v7, v7
v_mul_f32 v8, v0, v0
v_mul_f32 v9, v1, v1
v_mul_f32 v10, v2, v2
v_mul_f32 v11, v3, v3
v_mul_f32 v12, v4, v4
v_mul_f32 v13, v5, v5
v_mul_f32 v14, v6, v6
v_mul_f32 v15, v7, v7
v_fma_f32 v8, v8, s43, v25
v_fma_f32 v9, v9, s43, v25
v_fma_f32 v10, v10, s43, v25
v_fma_f32 v11, v11, s43, v25
v_fma_f32 v12, v12, s43, v25
v_fma_f32 v13, v13, s43, v25
v_fma_f32 v14, v14, s43, v25
v_fma_f32 v15, v15, s43, v25
v_mul_f32 v8, v0, v8
v_mul_f32 v9, v1, v9
v_mul_f32 v10, v2, v10
v_mul_f32 v11, v3, v11
v_mul_f32 v12, v4, v12
v_mul_f32 v13, v5, v13
v_mul_f32 v14, v6, v14
v_mul_f32 v15, v7, v15
v_exp_f32 v8, v8
v_exp_f32 v9, v9
v_exp_f32 v10, v10
v_exp_f32 v11, v11
v_exp_f32 v12, v12
v_exp_f32 v13, v13
v_exp_f32 v14, v14
v_exp_f32 v15, v15
v_add_f32 v16, 1.0, v8
v_add_f32 v17, 1.0, v9
v_add_f32 v18, 1.0, v10
v_add_f32 v19, 1.0, v11
v_add_f32 v20, 1.0, v12
v_add_f32 v21, 1.0, v13
v_add_f32 v22, 1.0, v14
v_add_f32 v23, 1.0, v15
v_rcp_f32 v16, v16
v_rcp_f32 v17, v17
v_rcp_f32 v18, v18
v_rcp_f32 v19, v19
v_rcp_f32 v20, v20
v_rcp_f32 v21, v21
v_rcp_f32 v22, v22
v_rcp_f32 v23, v23
v_mul_f32 v0, v0, v16
v_mul_f32 v1, v1, v17
v_mul_f32 v2, v2, v18
v_mul_f32 v3, v3, v19
v_mul_f32 v4, v4, v20
v_mul_f32 v5, v5, v21
v_mul_f32 v6, v6, v22
v_mul_f32 v7, v7, v23
v_mul_f32 v8, v8, v0
v_mul_f32 v9, v9, v1
v_mul_f32 v10, v10, v2
v_mul_f32 v11, v11, v3
v_mul_f32 v12, v12, v4
v_mul_f32 v13, v13, v5
v_mul_f32 v14, v14, v6
v_mul_f32 v15, v15, v7
v_cvt_pk_f16_f32 v28, v0, v1
v_cvt_pk_f16_f32 v32, -v8, -v9
v_cvt_pk_f16_f32 v29, v2, v3
v_cvt_pk_f16_f32 v33, -v10, -v11
v_cvt_pk_f16_f32 v30, v4, v5
v_cvt_pk_f16_f32 v34, -v12, -v13
v_cvt_pk_f16_f32 v31, v6, v7
v_cvt_pk_f16_f32 v35, -v14, -v15
v_lshlrev_b32 v24, 4, v199
v_mov_b32 v25, 163840
s_movk_i32 s43, 496
v_cmp_gt_u32 vcc, s43, v199
s_nop 1
v_cndmask_b32 v24, v25, v24, vcc
ds_write_b128 v24, v[32:35]
ds_write_b128 v24, v[28:31] offset:8192
Lnoy2:
s_setprio 2
s_cmp_lt_u32 s40, 4
s_cbranch_scc0 Lsu0
s_call_b64 s[78:79], Lpre
s_call_b64 s[78:79], Lrb
s_waitcnt vmcnt(4)
s_mov_b64 exec, 1
ds_add_u32 v253, v254 offset:28
s_mov_b64 exec, -1
v_mov_b32 v253, 16256
Lsw288w:
ds_read_b32 v247, v253 offset:28
s_waitcnt lgkmcnt(0)
v_readfirstlane_b32 s43, v247
s_cmp_eq_u32 s76, 0
s_cbranch_scc1 Lsw288x
s_sub_u32 s76, s76, 1
s_cmp_lt_u32 s43, 8
s_cbranch_scc0 Lsw288x
s_sleep 2
s_branch Lsw288w
Lsw288x:
s_call_b64 s[78:79], Lconv0
s_mov_b64 exec, 1
ds_add_u32 v253, v254 offset:16
s_mov_b64 exec, -1
s_call_b64 s[78:79], Lln0
s_waitcnt vmcnt(0)
s_mov_b64 exec, 1
ds_add_u32 v253, v254 offset:12
s_mov_b64 exec, -1
Lsu0:
s_cmp_ge_u32 s40, 4
s_cbranch_scc0 Lsu2
s_setprio 3
s_call_b64 s[78:79], Lw1f
s_waitcnt vmcnt(6)
s_mov_b64 exec, 1
ds_add_u32 v253, v254 offset:28
s_mov_b64 exec, -1
s_call_b64 s[78:79], Lrb
s_waitcnt vmcnt(4)
s_call_b64 s[78:79], Lw1a
s_mov_b64 exec, 1
ds_add_u32 v253, v254 offset:20
s_mov_b64 exec, -1
s_call_b64 s[78:79], Lw1i
s_call_b64 s[78:79], Lpre
s_waitcnt vmcnt(12)
s_mov_b64 exec, 1
ds_add_u32 v253, v254 offset:12
s_mov_b64 exec, -1
v_mov_b32 v253, 16256
Lsw128w:
ds_read_b32 v247, v253 offset:12
s_waitcnt lgkmcnt(0)
v_readfirstlane_b32 s43, v247
s_cmp_eq_u32 s76, 0
s_cbranch_scc1 Lsw128x
s_sub_u32 s76, s76, 1
s_cmp_lt_u32 s43, 8
s_cbranch_scc0 Lsw128x
s_sleep 2
s_branch Lsw128w
Lsw128x:
s_call_b64 s[78:79], Lconv0
s_mov_b64 exec, 1
ds_add_u32 v253, v254 offset:16
s_mov_b64 exec, -1
s_call_b64 s[78:79], Lw1b
s_mov_b64 exec, 1
ds_add_u32 v253, v254 offset:24
s_mov_b64 exec, -1
s_call_b64 s[78:79], Lln0
Lsu2:
v_mov_b32 v253, 16256
Lsw204w:
ds_read_b32 v247, v253 offset:20
s_waitcnt lgkmcnt(0)
v_readfirstlane_b32 s43, v247
s_cmp_eq_u32 s76, 0
s_cbranch_scc1 Lsw204x
s_sub_u32 s76, s76, 1
s_cmp_lt_u32 s43, 4
s_cbranch_scc0 Lsw204x
s_sleep 2
s_branch Lsw204w
Lsw204x:
s_cmp_lg_u32 s40, 7
s_cbranch_scc1 Lnopf
s_getpc_b64 s[74:75]
Lpc:
s_lshr_b32 s43, s2, 3
s_and_b32 s43, s43, 15
s_lshl_b32 s43, s43, 13
v_lshlrev_b32 v178, 7, v251
v_add_u32_e64 v178, s43, v178
v_min_u32 v178, Lend-Lpc, v178
global_load_dword v255, v178, s[74:75]
Lnopf:
s_add_u32 s66, s66, 786432
ds_read_b128 v[224:227], v248 offset:16384
ds_read_b128 v[228:231], v248 offset:19456
ds_read_b128 v[232:235], v248 offset:17408
ds_read_b128 v[236:239], v248 offset:20480
ds_read_b128 v[216:219], v248 offset:18432
ds_read_b128 v[220:223], v248 offset:21504
s_setprio 2
s_waitcnt lgkmcnt(5)
v_mfma_f32_32x32x16_bf16 v[120:135], v[48:51], v[224:227], 0
s_waitcnt lgkmcnt(4)
ds_read_b128 v[224:227], v248 offset:22528
v_mfma_f32_32x32x16_bf16 v[120:135], v[52:55], v[228:231], v[120:135]
s_waitcnt lgkmcnt(4)
ds_read_b128 v[228:231], v248 offset:25600
v_mfma_f32_32x32x16_bf16 v[120:135], v[56:59], v[232:235], v[120:135]
s_waitcnt lgkmcnt(4)
ds_read_b128 v[232:235], v248 offset:23552
v_mfma_f32_32x32x16_bf16 v[120:135], v[60:63], v[236:239], v[120:135]
s_waitcnt lgkmcnt(4)
ds_read_b128 v[236:239], v248 offset:26624
v_mfma_f32_32x32x16_bf16 v[120:135], v[64:67], v[216:219], v[120:135]
s_waitcnt lgkmcnt(4)
ds_read_b128 v[216:219], v248 offset:24576
v_mfma_f32_32x32x16_bf16 v[120:135], v[68:71], v[220:223], v[120:135]
v_add_u32 v174, -36864, v242
v_subrev_u32 v175, 66560, v174
v_min_u32 v174, v174, v175
v_add_u32 v174, 90112, v174
v_sub_u32 v175, v174, v242
v_add_u32 v242, v175, v242
v_add_u32_e64 v243, v175, v243
v_add_u32 v244, v175, v244
s_nop 3
v_cvt_pkrtz_f16_f32 v137, v120, v121
v_cvt_pkrtz_f16_f32 v139, v122, v123
v_cvt_pkrtz_f16_f32 v141, v124, v125
v_cvt_pkrtz_f16_f32 v143, v126, v127
v_cvt_pkrtz_f16_f32 v145, v128, v129
v_cvt_pk_f16_f32 v155, v130, v131
v_cvt_pk_f16_f32 v152, v132, v133
v_cvt_pk_f16_f32 v149, v134, v135
s_waitcnt lgkmcnt(1)
ds_read_b128 v[220:223], v248 offset:27648
v_mfma_f32_32x32x16_bf16 v[120:135], v[48:51], v[224:227], 0
v_pk_fma_f16 v154, v155, v155, s48
v_and_b32 v137, s49, v137
v_pk_fma_f16 v151, v152, v152, s48
v_and_b32_e64 v139, s49, v139
v_pk_fma_f16 v148, v149, v149, s48
v_pk_mul_f16 v154, v155, v154
v_bfe_u32 v136, v137, 2, 14
v_pk_mul_f16 v151, v152, v151
v_pk_mul_f16 v148, v149, v148
v_bfe_u32 v138, v139, 2, 14
ds_read_b128 v[224:227], v248 offset:28672
ds_read_u16_d16 v136, v136
ds_read_u16_d16 v138, v138
v_mfma_f32_32x32x16_bf16 v[120:135], v[52:55], v[228:231], v[120:135]
v_exp_f16 v153, v154
v_lshrrev_b32 v137, 18, v137
v_exp_f16 v150, v151
v_lshrrev_b32 v139, 18, v139
v_exp_f16 v147, v148
v_and_b32 v141, s49, v141
v_and_b32_e64 v143, s49, v143
ds_read_b128 v[228:231], v248 offset:31744
ds_read_u16_d16_hi v137, v137
ds_read_u16_d16_hi v139, v139
v_mfma_f32_32x32x16_bf16 v[120:135], v[56:59], v[232:235], v[120:135]
v_exp_f16_sdwa v153, v154 dst_sel:WORD_1 dst_unused:UNUSED_PRESERVE src0_sel:WORD_1
v_bfe_u32 v140, v141, 2, 14
v_exp_f16_sdwa v150, v151 dst_sel:WORD_1 dst_unused:UNUSED_PRESERVE src0_sel:WORD_1
v_bfe_u32 v142, v143, 2, 14
v_exp_f16_sdwa v147, v148 dst_sel:WORD_1 dst_unused:UNUSED_PRESERVE src0_sel:WORD_1
v_lshrrev_b32_e64 v141, 18, v141
v_pk_add_f16 v153, v153, 1.0 op_sel_hi:[1,0]
ds_read_b128 v[232:235], v248 offset:29696
ds_read_u16_d16 v140, v140
ds_read_u16_d16 v142, v142
ds_read_u16_d16_hi v141, v141
v_mfma_f32_32x32x16_bf16 v[120:135], v[60:63], v[236:239], v[120:135]
v_lshrrev_b32_e64 v143, 18, v143
v_pk_add_f16 v150, v150, 1.0 op_sel_hi:[1,0]
v_pk_add_f16 v147, v147, 1.0 op_sel_hi:[1,0]
v_and_b32 v145, s49, v145
v_rcp_f16 v154, v153
v_bfe_u32 v144, v145, 2, 14
v_rcp_f16_e64 v151, v150
v_lshrrev_b32 v145, 18, v145
s_waitcnt lgkmcnt(7)
ds_read_b128 v[236:239], v248 offset:32768
ds_read_u16_d16_hi v143, v143
ds_read_u16_d16 v144, v144
ds_read_u16_d16_hi v145, v145
v_mfma_f32_32x32x16_bf16 v[120:135], v[64:67], v[216:219], v[120:135]
v_rcp_f16_e64 v148, v147
v_rcp_f16_sdwa v154, v153 dst_sel:WORD_1 dst_unused:UNUSED_PRESERVE src0_sel:WORD_1
v_fma_mix_f32 v156, v136, v136, 0 op_sel:[0,0,0] op_sel_hi:[1,1,0]
ds_read_b32 v247, v253 offset:16
s_waitcnt lgkmcnt(9)
v_fma_mix_f32 v156, v137, v137, v156 op_sel:[1,1,0] op_sel_hi:[1,1,0]
v_rcp_f16_sdwa v151, v150 dst_sel:WORD_1 dst_unused:UNUSED_PRESERVE src0_sel:WORD_1
v_fma_mix_f32 v156, v138, v138, v156 op_sel:[0,0,0] op_sel_hi:[1,1,0]
ds_read_b128 v[216:219], v248 offset:30720
v_mfma_f32_32x32x16_bf16 v[120:135], v[68:71], v[220:223], v[120:135]
v_rcp_f16_sdwa v148, v147 dst_sel:WORD_1 dst_unused:UNUSED_PRESERVE src0_sel:WORD_1
v_fma_mix_f32 v156, v139, v139, v156 op_sel:[1,1,0] op_sel_hi:[1,1,0]
v_pk_mul_f16 v155, v155, v154
s_waitcnt lgkmcnt(6)
v_fma_mix_f32 v156, v140, v140, v156 op_sel:[0,0,0] op_sel_hi:[1,1,0]
v_pk_mul_f16 v152, v152, v151
v_fma_mix_f32 v156, v141, v141, v156 op_sel:[1,1,0] op_sel_hi:[1,1,0]
v_pk_mul_f16 v149, v149, v148
v_fma_mix_f32 v156, v155, v155, v156 op_sel:[0,0,0] op_sel_hi:[1,1,0]
v_fma_mix_f32 v156, v142, v142, v156 op_sel:[0,0,0] op_sel_hi:[1,1,0]
v_fma_mix_f32 v156, v155, v155, v156 op_sel:[1,1,0] op_sel_hi:[1,1,0]
s_waitcnt lgkmcnt(4)
v_fma_mix_f32 v156, v143, v143, v156 op_sel:[1,1,0] op_sel_hi:[1,1,0]
v_fma_mix_f32 v156, v152, v152, v156 op_sel:[0,0,0] op_sel_hi:[1,1,0]
v_fma_mix_f32 v156, v152, v152, v156 op_sel:[1,1,0] op_sel_hi:[1,1,0]
s_waitcnt lgkmcnt(2)
v_fma_mix_f32 v156, v144, v144, v156 op_sel:[0,0,0] op_sel_hi:[1,1,0]
v_fma_mix_f32 v156, v149, v149, v156 op_sel:[0,0,0] op_sel_hi:[1,1,0]
v_fma_mix_f32 v156, v145, v145, v156 op_sel:[1,1,0] op_sel_hi:[1,1,0]
v_fma_mix_f32 v156, v149, v149, v156 op_sel:[1,1,0] op_sel_hi:[1,1,0]
s_waitcnt lgkmcnt(1)
v_readfirstlane_b32 s43, v247
s_nop 1
s_cmp_ge_u32 s43, 8
s_cbranch_scc1 Lev1
Lev1w:
s_sleep 1
ds_read_b32 v247, v253 offset:16
s_waitcnt lgkmcnt(0)
v_readfirstlane_b32 s43, v247
s_cmp_eq_u32 s76, 0
s_cbranch_scc1 Lev1
s_sub_u32 s76, s76, 1
s_cmp_lt_u32 s43, 8
s_cbranch_scc1 Lev1w
Lev1:
v_cvt_pkrtz_f16_f32 v137, v120, v121
v_cvt_pkrtz_f16_f32 v139, v122, v123
v_cvt_pkrtz_f16_f32 v141, v124, v125
v_cvt_pkrtz_f16_f32 v143, v126, v127
v_cvt_pkrtz_f16_f32 v145, v128, v129
v_cvt_pk_f16_f32 v155, v130, v131
v_cvt_pk_f16_f32 v152, v132, v133
v_cvt_pk_f16_f32 v149, v134, v135
s_add_u32 m0, s67, 0
s_add_u32 s66, s66, 98304
buffer_load_dwordx4 v240, s[4:7], s66 offen lds
ds_read_b128 v[220:223], v248 offset:33792
v_mfma_f32_32x32x16_bf16 v[120:135], v[48:51], v[224:227], 0
v_pk_fma_f16 v154, v155, v155, s48
v_and_b32_e64 v137, s49, v137
v_pk_fma_f16 v151, v152, v152, s48
v_and_b32_e64 v139, s49, v139
v_pk_fma_f16 v148, v149, v149, s48
v_pk_mul_f16 v154, v155, v154
v_bfe_u32 v136, v137, 2, 14
v_pk_mul_f16 v151, v152, v151
v_pk_mul_f16 v148, v149, v148
v_bfe_u32 v138, v139, 2, 14
s_add_u32 m0, s67, 6656
s_add_u32 s66, s66, 98304
buffer_load_dwordx4 v240, s[4:7], s66 offen lds
ds_read_b128 v[224:227], v248 offset:34816
ds_read_u16_d16 v136, v136
ds_read_u16_d16 v138, v138
v_mfma_f32_32x32x16_bf16 v[120:135], v[52:55], v[228:231], v[120:135]
v_exp_f16 v153, v154
v_lshrrev_b32 v137, 18, v137
v_exp_f16 v150, v151
v_lshrrev_b32 v139, 18, v139
v_exp_f16 v147, v148
v_and_b32 v141, s49, v141
v_and_b32_e64 v143, s49, v143
s_add_u32 m0, s67, 13312
s_add_u32 s66, s66, 98304
buffer_load_dwordx4 v240, s[4:7], s66 offen lds
ds_read_b128 v[228:231], v248 offset:37888
ds_read_u16_d16_hi v137, v137
ds_read_u16_d16_hi v139, v139
v_mfma_f32_32x32x16_bf16 v[120:135], v[56:59], v[232:235], v[120:135]
v_exp_f16_sdwa v153, v154 dst_sel:WORD_1 dst_unused:UNUSED_PRESERVE src0_sel:WORD_1
v_bfe_u32 v140, v141, 2, 14
v_exp_f16_sdwa v150, v151 dst_sel:WORD_1 dst_unused:UNUSED_PRESERVE src0_sel:WORD_1
v_bfe_u32 v142, v143, 2, 14
v_exp_f16_sdwa v147, v148 dst_sel:WORD_1 dst_unused:UNUSED_PRESERVE src0_sel:WORD_1
v_lshrrev_b32_e64 v141, 18, v141
v_pk_add_f16 v153, v153, 1.0 op_sel_hi:[1,0]
s_add_u32 m0, s67, 19968
s_add_u32 s66, s66, 98304
buffer_load_dwordx4 v240, s[4:7], s66 offen lds
s_add_u32 m0, s67, 26624
s_add_u32 s66, s66, 98304
buffer_load_dwordx4 v240, s[4:7], s66 offen lds
ds_read_b128 v[232:235], v248 offset:35840
ds_read_u16_d16 v140, v140
ds_read_u16_d16 v142, v142
ds_read_u16_d16_hi v141, v141
v_mfma_f32_32x32x16_bf16 v[120:135], v[60:63], v[236:239], v[120:135]
v_lshrrev_b32_e64 v143, 18, v143
v_pk_add_f16 v150, v150, 1.0 op_sel_hi:[1,0]
v_pk_add_f16 v147, v147, 1.0 op_sel_hi:[1,0]
v_and_b32 v145, s49, v145
v_rcp_f16 v154, v153
v_bfe_u32 v144, v145, 2, 14
v_rcp_f16_e64 v151, v150
v_lshrrev_b32 v145, 18, v145
s_waitcnt lgkmcnt(4)
s_add_u32 m0, s67, 33280
s_add_u32 s66, s66, 98304
buffer_load_dwordx4 v240, s[4:7], s66 offen lds
ds_read_b128 v[236:239], v248 offset:38912
ds_read_u16_d16_hi v143, v143
ds_read_u16_d16 v144, v144
ds_read_u16_d16_hi v145, v145
v_mfma_f32_32x32x16_bf16 v[120:135], v[64:67], v[216:219], v[120:135]
v_rcp_f16 v148, v147
v_rcp_f16_sdwa v154, v153 dst_sel:WORD_1 dst_unused:UNUSED_PRESERVE src0_sel:WORD_1
v_fma_mix_f32 v157, v136, v136, 0 op_sel:[0,0,0] op_sel_hi:[1,1,0]
v_fma_mix_f32 v157, v137, v137, v157 op_sel:[1,1,0] op_sel_hi:[1,1,0]
v_rcp_f16_sdwa v151, v150 dst_sel:WORD_1 dst_unused:UNUSED_PRESERVE src0_sel:WORD_1
v_fma_mix_f32 v157, v138, v138, v157 op_sel:[0,0,0] op_sel_hi:[1,1,0]
s_add_u32 m0, s67, 39936
s_add_u32 s66, s66, 98304
buffer_load_dwordx4 v240, s[4:7], s66 offen lds
ds_read_b128 v[216:219], v248 offset:36864
v_mfma_f32_32x32x16_bf16 v[120:135], v[68:71], v[220:223], v[120:135]
v_rcp_f16_sdwa v148, v147 dst_sel:WORD_1 dst_unused:UNUSED_PRESERVE src0_sel:WORD_1
v_fma_mix_f32 v157, v139, v139, v157 op_sel:[1,1,0] op_sel_hi:[1,1,0]
v_pk_mul_f16 v155, v155, v154
s_waitcnt lgkmcnt(5)
v_fma_mix_f32 v157, v140, v140, v157 op_sel:[0,0,0] op_sel_hi:[1,1,0]
v_pk_mul_f16 v152, v152, v151
v_fma_mix_f32 v157, v141, v141, v157 op_sel:[1,1,0] op_sel_hi:[1,1,0]
v_pk_mul_f16 v149, v149, v148
v_fma_mix_f32 v157, v155, v155, v157 op_sel:[0,0,0] op_sel_hi:[1,1,0]
v_fma_mix_f32 v157, v142, v142, v157 op_sel:[0,0,0] op_sel_hi:[1,1,0]
v_fma_mix_f32 v157, v155, v155, v157 op_sel:[1,1,0] op_sel_hi:[1,1,0]
s_add_u32 m0, s67, 46592
s_add_u32 s66, s66, 98304
buffer_load_dwordx4 v240, s[4:7], s66 offen lds
s_waitcnt lgkmcnt(1)
v_fma_mix_f32 v157, v143, v143, v157 op_sel:[1,1,0] op_sel_hi:[1,1,0]
v_fma_mix_f32 v157, v152, v152, v157 op_sel:[0,0,0] op_sel_hi:[1,1,0]
v_fma_mix_f32 v157, v152, v152, v157 op_sel:[1,1,0] op_sel_hi:[1,1,0]
v_fma_mix_f32 v157, v144, v144, v157 op_sel:[0,0,0] op_sel_hi:[1,1,0]
v_fma_mix_f32 v157, v149, v149, v157 op_sel:[0,0,0] op_sel_hi:[1,1,0]
v_fma_mix_f32 v157, v145, v145, v157 op_sel:[1,1,0] op_sel_hi:[1,1,0]
v_fma_mix_f32 v157, v149, v149, v157 op_sel:[1,1,0] op_sel_hi:[1,1,0]
s_setprio 1
v_cvt_pkrtz_f16_f32 v137, v120, v121
v_cvt_pkrtz_f16_f32 v139, v122, v123
v_cvt_pkrtz_f16_f32 v141, v124, v125
v_cvt_pkrtz_f16_f32 v143, v126, v127
v_cvt_pkrtz_f16_f32 v145, v128, v129
v_cvt_pk_f16_f32 v155, v130, v131
v_cvt_pk_f16_f32 v152, v132, v133
v_cvt_pk_f16_f32 v149, v134, v135
ds_read_b128 v[220:223], v248 offset:39936
v_mfma_f32_32x32x16_bf16 v[120:135], v[48:51], v[224:227], 0
v_pk_fma_f16 v154, v155, v155, s48
v_and_b32_e64 v137, s49, v137
v_pk_fma_f16 v151, v152, v152, s48
v_and_b32_e64 v139, s49, v139
v_pk_fma_f16 v148, v149, v149, s48
v_pk_mul_f16 v154, v155, v154
v_bfe_u32 v136, v137, 2, 14
v_pk_mul_f16 v151, v152, v151
v_pk_mul_f16 v148, v149, v148
v_bfe_u32 v138, v139, 2, 14
ds_read_u16_d16 v136, v136
ds_read_b32 v247, v253 offset:24
ds_read_u16_d16 v138, v138
v_mfma_f32_32x32x16_bf16 v[120:135], v[52:55], v[228:231], v[120:135]
v_exp_f16 v153, v154
v_lshrrev_b32 v137, 18, v137
v_exp_f16 v150, v151
v_lshrrev_b32 v139, 18, v139
v_exp_f16 v147, v148
v_and_b32 v141, s49, v141
v_and_b32_e64 v143, s49, v143
ds_read_u16_d16_hi v137, v137
ds_read_u16_d16_hi v139, v139
v_mfma_f32_32x32x16_bf16 v[120:135], v[56:59], v[232:235], v[120:135]
v_exp_f16_sdwa v153, v154 dst_sel:WORD_1 dst_unused:UNUSED_PRESERVE src0_sel:WORD_1
v_bfe_u32 v140, v141, 2, 14
v_exp_f16_sdwa v150, v151 dst_sel:WORD_1 dst_unused:UNUSED_PRESERVE src0_sel:WORD_1
v_bfe_u32 v142, v143, 2, 14
v_exp_f16_sdwa v147, v148 dst_sel:WORD_1 dst_unused:UNUSED_PRESERVE src0_sel:WORD_1
v_lshrrev_b32_e64 v141, 18, v141
v_pk_add_f16 v153, v153, 1.0 op_sel_hi:[1,0]
ds_read_u16_d16 v140, v140
ds_read_u16_d16 v142, v142
ds_read_u16_d16_hi v141, v141
s_waitcnt lgkmcnt(6)
v_readfirstlane_b32 s43, v247
s_nop 1
s_cmp_ge_u32 s43, 4
s_cbranch_scc1 Lev2
Lev2w:
s_sleep 1
ds_read_b32 v247, v253 offset:24
s_waitcnt lgkmcnt(0)
v_readfirstlane_b32 s43, v247
s_cmp_eq_u32 s76, 0
s_cbranch_scc1 Lev2
s_sub_u32 s76, s76, 1
s_cmp_lt_u32 s43, 4
s_cbranch_scc1 Lev2w
Lev2:
ds_read_b128 v[224:227], v248 offset:40960
ds_read_b128 v[228:231], v248 offset:44032
ds_read_b128 v[232:235], v248 offset:41984
v_mfma_f32_32x32x16_bf16 v[120:135], v[60:63], v[236:239], v[120:135]
v_lshrrev_b32 v143, 18, v143
v_pk_add_f16 v150, v150, 1.0 op_sel_hi:[1,0]
v_pk_add_f16 v147, v147, 1.0 op_sel_hi:[1,0]
v_and_b32 v145, s49, v145
v_rcp_f16 v154, v153
v_bfe_u32 v144, v145, 2, 14
v_rcp_f16 v151, v150
v_lshrrev_b32 v145, 18, v145
ds_read_b128 v[236:239], v248 offset:45056
ds_read_u16_d16_hi v143, v143
ds_read_u16_d16 v144, v144
ds_read_u16_d16_hi v145, v145
v_mfma_f32_32x32x16_bf16 v[120:135], v[64:67], v[216:219], v[120:135]
v_rcp_f16 v148, v147
v_rcp_f16_sdwa v154, v153 dst_sel:WORD_1 dst_unused:UNUSED_PRESERVE src0_sel:WORD_1
v_fma_mix_f32 v158, v136, v136, 0 op_sel:[0,0,0] op_sel_hi:[1,1,0]
s_waitcnt lgkmcnt(7)
v_fma_mix_f32 v158, v137, v137, v158 op_sel:[1,1,0] op_sel_hi:[1,1,0]
v_rcp_f16_sdwa v151, v150 dst_sel:WORD_1 dst_unused:UNUSED_PRESERVE src0_sel:WORD_1
v_fma_mix_f32 v158, v138, v138, v158 op_sel:[0,0,0] op_sel_hi:[1,1,0]
ds_read_b128 v[216:219], v248 offset:43008
v_mfma_f32_32x32x16_bf16 v[120:135], v[68:71], v[220:223], v[120:135]
v_rcp_f16_sdwa v148, v147 dst_sel:WORD_1 dst_unused:UNUSED_PRESERVE src0_sel:WORD_1
v_fma_mix_f32 v158, v139, v139, v158 op_sel:[1,1,0] op_sel_hi:[1,1,0]
v_pk_mul_f16 v155, v155, v154
v_fma_mix_f32 v158, v140, v140, v158 op_sel:[0,0,0] op_sel_hi:[1,1,0]
v_pk_mul_f16 v152, v152, v151
v_fma_mix_f32 v158, v141, v141, v158 op_sel:[1,1,0] op_sel_hi:[1,1,0]
v_pk_mul_f16 v149, v149, v148
v_fma_mix_f32 v158, v155, v155, v158 op_sel:[0,0,0] op_sel_hi:[1,1,0]
v_fma_mix_f32 v158, v142, v142, v158 op_sel:[0,0,0] op_sel_hi:[1,1,0]
v_fma_mix_f32 v158, v155, v155, v158 op_sel:[1,1,0] op_sel_hi:[1,1,0]
s_waitcnt lgkmcnt(3)
v_fma_mix_f32 v158, v143, v143, v158 op_sel:[1,1,0] op_sel_hi:[1,1,0]
v_fma_mix_f32 v158, v152, v152, v158 op_sel:[0,0,0] op_sel_hi:[1,1,0]
v_fma_mix_f32 v158, v152, v152, v158 op_sel:[1,1,0] op_sel_hi:[1,1,0]
s_waitcnt lgkmcnt(1)
v_fma_mix_f32 v158, v144, v144, v158 op_sel:[0,0,0] op_sel_hi:[1,1,0]
v_fma_mix_f32 v158, v149, v149, v158 op_sel:[0,0,0] op_sel_hi:[1,1,0]
v_fma_mix_f32 v158, v145, v145, v158 op_sel:[1,1,0] op_sel_hi:[1,1,0]
v_fma_mix_f32 v158, v149, v149, v158 op_sel:[1,1,0] op_sel_hi:[1,1,0]
v_cvt_pkrtz_f16_f32 v137, v120, v121
v_cvt_pkrtz_f16_f32 v139, v122, v123
v_cvt_pkrtz_f16_f32 v141, v124, v125
v_cvt_pkrtz_f16_f32 v143, v126, v127
v_cvt_pkrtz_f16_f32 v145, v128, v129
v_cvt_pk_f16_f32 v155, v130, v131
v_cvt_pk_f16_f32 v152, v132, v133
v_cvt_pk_f16_f32 v149, v134, v135
buffer_store_dwordx4 v[48:51], v241, s[32:35], s80 offen sc1
ds_read_b128 v[220:223], v248 offset:46080
v_mfma_f32_32x32x16_bf16 v[120:135], v[48:51], v[224:227], 0
v_pk_fma_f16 v154, v155, v155, s48
v_and_b32_e64 v137, s49, v137
v_pk_fma_f16 v151, v152, v152, s48
v_and_b32_e64 v139, s49, v139
v_pk_fma_f16 v148, v149, v149, s48
v_pk_mul_f16 v154, v155, v154
v_bfe_u32 v136, v137, 2, 14
v_pk_mul_f16 v151, v152, v151
v_pk_mul_f16 v148, v149, v148
v_bfe_u32 v138, v139, 2, 14
ds_read_b128 v[224:227], v248 offset:47104
ds_read_u16_d16 v136, v136
ds_read_u16_d16 v138, v138
v_mfma_f32_32x32x16_bf16 v[120:135], v[52:55], v[228:231], v[120:135]
v_exp_f16 v153, v154
v_lshrrev_b32 v137, 18, v137
v_exp_f16 v150, v151
v_lshrrev_b32 v139, 18, v139
v_exp_f16 v147, v148
v_and_b32 v141, s49, v141
v_and_b32_e64 v143, s49, v143
ds_read_b128 v[228:231], v248 offset:50176
ds_read_u16_d16_hi v137, v137
ds_read_u16_d16_hi v139, v139
v_mfma_f32_32x32x16_bf16 v[120:135], v[56:59], v[232:235], v[120:135]
v_exp_f16_sdwa v153, v154 dst_sel:WORD_1 dst_unused:UNUSED_PRESERVE src0_sel:WORD_1
v_bfe_u32 v140, v141, 2, 14
v_exp_f16_sdwa v150, v151 dst_sel:WORD_1 dst_unused:UNUSED_PRESERVE src0_sel:WORD_1
v_bfe_u32 v142, v143, 2, 14
v_exp_f16_sdwa v147, v148 dst_sel:WORD_1 dst_unused:UNUSED_PRESERVE src0_sel:WORD_1
v_lshrrev_b32_e64 v141, 18, v141
v_pk_add_f16 v153, v153, 1.0 op_sel_hi:[1,0]
ds_read_b128 v[232:235], v248 offset:48128
ds_read_u16_d16 v140, v140
ds_read_u16_d16 v142, v142
ds_read_u16_d16_hi v141, v141
v_mfma_f32_32x32x16_bf16 v[120:135], v[60:63], v[236:239], v[120:135]
v_lshrrev_b32_e64 v143, 18, v143
v_pk_add_f16 v150, v150, 1.0 op_sel_hi:[1,0]
v_pk_add_f16 v147, v147, 1.0 op_sel_hi:[1,0]
v_and_b32 v145, s49, v145
v_rcp_f16 v154, v153
v_bfe_u32 v144, v145, 2, 14
v_rcp_f16_e64 v151, v150
v_lshrrev_b32 v145, 18, v145
s_waitcnt lgkmcnt(7)
ds_read_b128 v[236:239], v248 offset:51200
ds_read_u16_d16_hi v143, v143
ds_read_u16_d16 v144, v144
ds_read_u16_d16_hi v145, v145
v_mfma_f32_32x32x16_bf16 v[120:135], v[64:67], v[216:219], v[120:135]
v_rcp_f16 v148, v147
v_rcp_f16_sdwa v154, v153 dst_sel:WORD_1 dst_unused:UNUSED_PRESERVE src0_sel:WORD_1
v_fma_mix_f32 v159, v136, v136, 0 op_sel:[0,0,0] op_sel_hi:[1,1,0]
s_waitcnt lgkmcnt(8)
v_fma_mix_f32 v159, v137, v137, v159 op_sel:[1,1,0] op_sel_hi:[1,1,0]
v_rcp_f16_sdwa v151, v150 dst_sel:WORD_1 dst_unused:UNUSED_PRESERVE src0_sel:WORD_1
v_fma_mix_f32 v159, v138, v138, v159 op_sel:[0,0,0] op_sel_hi:[1,1,0]
ds_read_b128 v[216:219], v248 offset:49152
v_mfma_f32_32x32x16_bf16 v[120:135], v[68:71], v[220:223], v[120:135]
v_rcp_f16_sdwa v148, v147 dst_sel:WORD_1 dst_unused:UNUSED_PRESERVE src0_sel:WORD_1
v_fma_mix_f32 v159, v139, v139, v159 op_sel:[1,1,0] op_sel_hi:[1,1,0]
s_cmp_eq_u32 s40, 7
s_cbranch_scc1 Lrdy8
s_waitcnt vmcnt(1)
Lrdy8:
s_mov_b64 exec, 1
ds_add_u32 v253, v254 offset:12
s_mov_b64 exec, -1
v_pk_mul_f16 v155, v155, v154
s_waitcnt lgkmcnt(6)
v_fma_mix_f32 v159, v140, v140, v159 op_sel:[0,0,0] op_sel_hi:[1,1,0]
v_pk_mul_f16 v152, v152, v151
v_fma_mix_f32 v159, v141, v141, v159 op_sel:[1,1,0] op_sel_hi:[1,1,0]
v_pk_mul_f16 v149, v149, v148
v_fma_mix_f32 v159, v155, v155, v159 op_sel:[0,0,0] op_sel_hi:[1,1,0]
v_fma_mix_f32 v159, v142, v142, v159 op_sel:[0,0,0] op_sel_hi:[1,1,0]
v_fma_mix_f32 v159, v155, v155, v159 op_sel:[1,1,0] op_sel_hi:[1,1,0]
s_waitcnt lgkmcnt(2)
v_fma_mix_f32 v159, v143, v143, v159 op_sel:[1,1,0] op_sel_hi:[1,1,0]
v_fma_mix_f32 v159, v152, v152, v159 op_sel:[0,0,0] op_sel_hi:[1,1,0]
v_fma_mix_f32 v159, v152, v152, v159 op_sel:[1,1,0] op_sel_hi:[1,1,0]
v_fma_mix_f32 v159, v144, v144, v159 op_sel:[0,0,0] op_sel_hi:[1,1,0]
v_fma_mix_f32 v159, v149, v149, v159 op_sel:[0,0,0] op_sel_hi:[1,1,0]
v_fma_mix_f32 v159, v145, v145, v159 op_sel:[1,1,0] op_sel_hi:[1,1,0]
v_fma_mix_f32 v159, v149, v149, v159 op_sel:[1,1,0] op_sel_hi:[1,1,0]
v_cvt_pkrtz_f16_f32 v137, v120, v121
v_cvt_pkrtz_f16_f32 v139, v122, v123
v_cvt_pkrtz_f16_f32 v141, v124, v125
v_cvt_pkrtz_f16_f32 v143, v126, v127
v_cvt_pkrtz_f16_f32 v145, v128, v129
v_cvt_pk_f16_f32 v155, v130, v131
v_cvt_pk_f16_f32 v152, v132, v133
v_cvt_pk_f16_f32 v149, v134, v135
s_setprio 0
s_add_u32 s46, s80, 2097152
buffer_store_dwordx4 v[52:55], v241, s[32:35], s46 offen sc1
ds_read_b128 v[220:223], v248 offset:52224
v_mfma_f32_32x32x16_bf16 v[120:135], v[48:51], v[224:227], 0
v_pk_fma_f16 v154, v155, v155, s48
v_and_b32_e64 v137, s49, v137
v_pk_fma_f16 v151, v152, v152, s48
v_and_b32_e64 v139, s49, v139
v_pk_fma_f16 v148, v149, v149, s48
v_pk_mul_f16 v154, v155, v154
v_bfe_u32 v136, v137, 2, 14
v_pk_mul_f16 v151, v152, v151
v_pk_mul_f16 v148, v149, v148
v_bfe_u32 v138, v139, 2, 14
ds_read_b128 v[224:227], v250 offset:65520
ds_read_u16_d16 v136, v136
ds_read_u16_d16 v138, v138
v_mfma_f32_32x32x16_bf16 v[120:135], v[52:55], v[228:231], v[120:135]
v_exp_f16 v153, v154
v_lshrrev_b32 v137, 18, v137
v_exp_f16 v150, v151
v_lshrrev_b32 v139, 18, v139
v_exp_f16 v147, v148
v_and_b32 v141, s49, v141
v_and_b32_e64 v143, s49, v143
ds_read_b128 v[228:231], v248 offset:53248
ds_read_u16_d16_hi v137, v137
ds_read_b32 v247, v253 offset:12
ds_read_u16_d16_hi v139, v139
v_mfma_f32_32x32x16_bf16 v[120:135], v[56:59], v[232:235], v[120:135]
v_exp_f16_sdwa v153, v154 dst_sel:WORD_1 dst_unused:UNUSED_PRESERVE src0_sel:WORD_1
v_bfe_u32 v140, v141, 2, 14
v_exp_f16_sdwa v150, v151 dst_sel:WORD_1 dst_unused:UNUSED_PRESERVE src0_sel:WORD_1
v_bfe_u32 v142, v143, 2, 14
v_exp_f16_sdwa v147, v148 dst_sel:WORD_1 dst_unused:UNUSED_PRESERVE src0_sel:WORD_1
v_lshrrev_b32_e64 v141, 18, v141
v_pk_add_f16 v153, v153, 1.0 op_sel_hi:[1,0]
ds_read_b128 v[232:235], v248 offset:56320
ds_read_u16_d16 v140, v140
ds_read_u16_d16 v142, v142
ds_read_u16_d16_hi v141, v141
v_mfma_f32_32x32x16_bf16 v[120:135], v[60:63], v[236:239], v[120:135]
v_lshrrev_b32_e64 v143, 18, v143
v_pk_add_f16 v150, v150, 1.0 op_sel_hi:[1,0]
v_pk_add_f16 v147, v147, 1.0 op_sel_hi:[1,0]
v_and_b32 v145, s49, v145
v_rcp_f16 v154, v153
v_bfe_u32 v144, v145, 2, 14
ds_read_u16_d16_hi v143, v143
ds_read_u16_d16 v144, v144
s_waitcnt lgkmcnt(7)
v_readfirstlane_b32 s43, v247
s_nop 1
s_cmp_ge_u32 s43, 16
s_cbranch_scc1 Lev3
Lev3w:
s_sleep 1
ds_read_b32 v247, v253 offset:12
s_waitcnt lgkmcnt(0)
v_readfirstlane_b32 s43, v247
s_cmp_eq_u32 s76, 0
s_cbranch_scc1 Lev3
s_sub_u32 s76, s76, 1
s_cmp_lt_u32 s43, 16
s_cbranch_scc1 Lev3w
Lev3:
v_rcp_f16 v151, v150
v_lshrrev_b32_e64 v145, 18, v145
ds_read_b128 v[236:239], v245 offset:6528
ds_read_b128 v[192:195], v244 offset:128
ds_read_b128 v[196:199], v244 offset:64
ds_read_u16_d16_hi v145, v145
v_mfma_f32_32x32x16_bf16 v[120:135], v[64:67], v[216:219], v[120:135]
v_rcp_f16 v148, v147
v_rcp_f16_sdwa v154, v153 dst_sel:WORD_1 dst_unused:UNUSED_PRESERVE src0_sel:WORD_1
v_fma_mix_f32 v160, v136, v136, 0 op_sel:[0,0,0] op_sel_hi:[1,1,0]
v_fma_mix_f32 v160, v137, v137, v160 op_sel:[1,1,0] op_sel_hi:[1,1,0]
v_rcp_f16_sdwa v151, v150 dst_sel:WORD_1 dst_unused:UNUSED_PRESERVE src0_sel:WORD_1
v_fma_mix_f32 v160, v138, v138, v160 op_sel:[0,0,0] op_sel_hi:[1,1,0]
ds_read_b128 v[216:219], v248 offset:54272
v_mfma_f32_32x32x16_bf16 v[120:135], v[68:71], v[220:223], v[120:135]
v_rcp_f16_sdwa v148, v147 dst_sel:WORD_1 dst_unused:UNUSED_PRESERVE src0_sel:WORD_1
s_waitcnt lgkmcnt(5)
v_fma_mix_f32 v160, v139, v139, v160 op_sel:[1,1,0] op_sel_hi:[1,1,0]
v_pk_mul_f16 v155, v155, v154
v_fma_mix_f32 v160, v140, v140, v160 op_sel:[0,0,0] op_sel_hi:[1,1,0]
v_pk_mul_f16 v152, v152, v151
v_fma_mix_f32 v160, v141, v141, v160 op_sel:[1,1,0] op_sel_hi:[1,1,0]
v_pk_mul_f16 v149, v149, v148
v_fma_mix_f32 v160, v155, v155, v160 op_sel:[0,0,0] op_sel_hi:[1,1,0]
v_fma_mix_f32 v160, v142, v142, v160 op_sel:[0,0,0] op_sel_hi:[1,1,0]
v_fma_mix_f32 v160, v155, v155, v160 op_sel:[1,1,0] op_sel_hi:[1,1,0]
v_fma_mix_f32 v160, v143, v143, v160 op_sel:[1,1,0] op_sel_hi:[1,1,0]
v_fma_mix_f32 v160, v152, v152, v160 op_sel:[0,0,0] op_sel_hi:[1,1,0]
v_fma_mix_f32 v160, v152, v152, v160 op_sel:[1,1,0] op_sel_hi:[1,1,0]
v_fma_mix_f32 v160, v144, v144, v160 op_sel:[0,0,0] op_sel_hi:[1,1,0]
v_fma_mix_f32 v160, v149, v149, v160 op_sel:[0,0,0] op_sel_hi:[1,1,0]
s_waitcnt lgkmcnt(1)
v_fma_mix_f32 v160, v145, v145, v160 op_sel:[1,1,0] op_sel_hi:[1,1,0]
v_fma_mix_f32 v160, v149, v149, v160 op_sel:[1,1,0] op_sel_hi:[1,1,0]
v_lshlrev_b32 v252, 7, v251
s_add_u32 s46, s47, 1572864
s_mov_b32 exec_lo, 131071
s_mov_b32 exec_hi, 0
s_mov_b32 m0, 16288
s_nop 0
buffer_load_dword v252, s[4:7], s46 offen lds
s_mov_b64 exec, -1
s_setprio 2
v_mfma_f32_32x32x16_bf16 v[0:15], v[224:227], v[224:227], 0
s_add_u32 s46, s80, 4194304
buffer_store_dwordx4 v[56:59], v241, s[32:35], s46 offen sc1
ds_read_b128 v[220:223], v245 offset:6144
ds_read_b128 v[200:203], v244
ds_read_b128 v[204:207], v243 offset:128
v_cvt_pkrtz_f16_f32 v137, v120, v121
v_cvt_pkrtz_f16_f32 v139, v122, v123
v_cvt_pkrtz_f16_f32 v141, v124, v125
v_mfma_f32_32x32x16_bf16 v[16:31], v[224:227], v[224:227], 0
v_cvt_pkrtz_f16_f32 v143, v126, v127
v_cvt_pkrtz_f16_f32 v145, v128, v129
v_cvt_pk_f16_f32 v155, v130, v131
v_mfma_f32_32x32x16_bf16 v[32:47], v[224:227], v[224:227], 0
v_cvt_pk_f16_f32 v152, v132, v133
v_cvt_pk_f16_f32 v149, v134, v135
v_pk_fma_f16 v154, v155, v155, s48
v_mfma_f32_32x32x16_bf16 v[120:135], v[48:51], v[228:231], 0
ds_read_b128 v[224:227], v248 offset:57344
v_and_b32_e64 v137, s49, v137
v_pk_fma_f16 v151, v152, v152, s48
v_and_b32_e64 v139, s49, v139
v_pk_fma_f16 v148, v149, v149, s48
v_pk_mul_f16 v154, v155, v154
v_bfe_u32 v136, v137, 2, 14
v_mfma_f32_32x32x16_bf16 v[120:135], v[52:55], v[232:235], v[120:135]
ds_read_b128 v[228:231], v245 offset:5760
ds_read_b128 v[208:211], v243 offset:64
ds_read_b128 v[212:215], v243
ds_read_u16_d16 v136, v136
v_pk_mul_f16 v151, v152, v151
v_pk_mul_f16 v148, v149, v148
v_bfe_u32 v138, v139, 2, 14
v_exp_f16 v153, v154
v_lshrrev_b32 v137, 18, v137
v_smfmac_f32_16x16x32_bf16 v[40:43], v[238:239], v[192:195], v246
ds_read_b128 v[232:235], v248 offset:55296
ds_read_u16_d16 v138, v138
ds_read_u16_d16_hi v137, v137
v_exp_f16 v150, v151
v_lshrrev_b32 v139, 18, v139
v_smfmac_f32_16x16x32_bf16 v[24:27], v[236:237], v[196:199], v246
v_exp_f16_e64 v147, v148
v_and_b32 v141, s49, v141
s_waitcnt lgkmcnt(7)
v_mfma_f32_32x32x16_bf16 v[120:135], v[56:59], v[216:219], v[120:135]
ds_read_b128 v[236:239], v245 offset:5376
ds_read_b128 v[192:195], v242 offset:128
ds_read_b128 v[196:199], v242 offset:64
ds_read_u16_d16_hi v139, v139
v_and_b32_e64 v143, s49, v143
v_exp_f16_sdwa v153, v154 dst_sel:WORD_1 dst_unused:UNUSED_PRESERVE src0_sel:WORD_1
v_bfe_u32 v140, v141, 2, 14
v_exp_f16_sdwa v150, v151 dst_sel:WORD_1 dst_unused:UNUSED_PRESERVE src0_sel:WORD_1
v_smfmac_f32_16x16x32_bf16 v[8:11], v[222:223], v[200:203], v246
ds_read_b128 v[216:219], v248 offset:58368
ds_read_u16_d16 v140, v140
v_bfe_u32 v142, v143, 2, 14
v_exp_f16_sdwa v147, v148 dst_sel:WORD_1 dst_unused:UNUSED_PRESERVE src0_sel:WORD_1
v_smfmac_f32_16x16x32_bf16 v[40:43], v[220:221], v[204:207], v246
v_lshrrev_b32_e64 v141, 18, v141
v_pk_add_f16 v153, v153, 1.0 op_sel_hi:[1,0]
v_lshrrev_b32 v143, 18, v143
v_mfma_f32_32x32x16_bf16 v[120:135], v[60:63], v[224:227], v[120:135]
ds_read_b128 v[220:223], v245 offset:4992
ds_read_b128 v[200:203], v242
v_xor_b32 v244, 16, v244
ds_read_b128 v[204:207], v244 offset:128
ds_read_u16_d16 v142, v142
ds_read_u16_d16_hi v141, v141
ds_read_u16_d16_hi v143, v143
v_pk_add_f16 v150, v150, 1.0 op_sel_hi:[1,0]
v_pk_add_f16 v147, v147, 1.0 op_sel_hi:[1,0]
v_and_b32_e64 v145, s49, v145
v_rcp_f16 v154, v153
v_bfe_u32 v144, v145, 2, 14
s_waitcnt lgkmcnt(8)
v_smfmac_f32_16x16x32_bf16 v[24:27], v[230:231], v[208:211], v246
ds_read_b128 v[224:227], v245 offset:4608
ds_read_u16_d16 v144, v144
v_rcp_f16 v151, v150
v_lshrrev_b32 v145, 18, v145
v_smfmac_f32_16x16x32_bf16 v[8:11], v[228:229], v[212:215], v246
v_rcp_f16_e64 v148, v147
v_mfma_f32_32x32x16_bf16 v[120:135], v[64:67], v[232:235], v[120:135]
ds_read_b128 v[208:211], v244 offset:64
ds_read_b128 v[212:215], v244
ds_read_b128 v[228:231], v248 offset:59392
ds_read_u16_d16_hi v145, v145
v_rcp_f16_sdwa v154, v153 dst_sel:WORD_1 dst_unused:UNUSED_PRESERVE src0_sel:WORD_1
v_fma_mix_f32 v161, v136, v136, 0 op_sel:[0,0,0] op_sel_hi:[1,1,0]
v_fma_mix_f32 v161, v137, v137, v161 op_sel:[1,1,0] op_sel_hi:[1,1,0]
v_rcp_f16_sdwa v151, v150 dst_sel:WORD_1 dst_unused:UNUSED_PRESERVE src0_sel:WORD_1
v_fma_mix_f32 v161, v138, v138, v161 op_sel:[0,0,0] op_sel_hi:[1,1,0]
v_smfmac_f32_16x16x32_bf16 v[40:43], v[238:239], v[192:195], v246
ds_read_b128 v[232:235], v248 offset:62464
v_rcp_f16_sdwa v148, v147 dst_sel:WORD_1 dst_unused:UNUSED_PRESERVE src0_sel:WORD_1
v_fma_mix_f32 v161, v139, v139, v161 op_sel:[1,1,0] op_sel_hi:[1,1,0]
v_smfmac_f32_16x16x32_bf16 v[24:27], v[236:237], v[196:199], v246
v_pk_mul_f16 v155, v155, v154
s_waitcnt lgkmcnt(7)
v_fma_mix_f32 v161, v140, v140, v161 op_sel:[0,0,0] op_sel_hi:[1,1,0]
v_pk_mul_f16 v152, v152, v151
v_mfma_f32_32x32x16_bf16 v[120:135], v[68:71], v[216:219], v[120:135]
ds_read_b128 v[236:239], v248 offset:60416
v_fma_mix_f32 v161, v141, v141, v161 op_sel:[1,1,0] op_sel_hi:[1,1,0]
v_pk_mul_f16 v149, v149, v148
v_fma_mix_f32 v161, v155, v155, v161 op_sel:[0,0,0] op_sel_hi:[1,1,0]
v_fma_mix_f32 v161, v142, v142, v161 op_sel:[0,0,0] op_sel_hi:[1,1,0]
v_fma_mix_f32 v161, v155, v155, v161 op_sel:[1,1,0] op_sel_hi:[1,1,0]
v_fma_mix_f32 v161, v143, v143, v161 op_sel:[1,1,0] op_sel_hi:[1,1,0]
v_smfmac_f32_16x16x32_bf16 v[8:11], v[222:223], v[200:203], v246
ds_read_b128 v[216:219], v245 offset:4224
v_xor_b32 v243, 16, v243
ds_read_b128 v[192:195], v243 offset:128
ds_read_b128 v[196:199], v243 offset:64
v_fma_mix_f32 v161, v152, v152, v161 op_sel:[0,0,0] op_sel_hi:[1,1,0]
v_fma_mix_f32 v161, v152, v152, v161 op_sel:[1,1,0] op_sel_hi:[1,1,0]
s_waitcnt lgkmcnt(5)
v_fma_mix_f32 v161, v144, v144, v161 op_sel:[0,0,0] op_sel_hi:[1,1,0]
v_smfmac_f32_16x16x32_bf16 v[44:47], v[220:221], v[204:207], v246
v_fma_mix_f32 v161, v149, v149, v161 op_sel:[0,0,0] op_sel_hi:[1,1,0]
v_fma_mix_f32 v161, v145, v145, v161 op_sel:[1,1,0] op_sel_hi:[1,1,0]
v_fma_mix_f32 v161, v149, v149, v161 op_sel:[1,1,0] op_sel_hi:[1,1,0]
s_cmp_lg_u32 s40, 7
s_cbranch_scc1 Lnosent
v_mov_b32 v180, -1
v_mov_b32 v181, -1
v_mov_b32 v182, -1
v_mov_b32 v183, -1
v_lshlrev_b32 v176, 12, v251
v_add_u32 v177, 262144, v176
v_cmp_gt_u32 vcc, 32, v251
v_mov_b32 v178, 2147483648
s_nop 0
v_cndmask_b32 v177, v178, v177, vcc
s_lshl_b32 s43, s2, 4
buffer_store_dwordx4 v[180:183], v176, s[32:35], s43 offen sc1
buffer_store_dwordx4 v[180:183], v177, s[32:35], s43 offen sc1
s_add_u32 s43, s43, 393216
s_cmp_lt_u32 s2, 96
s_cselect_b32 s43, s43, 1073741824
v_lshlrev_b32_e64 v178, 11, v251
s_mov_b64 exec, 0xff
buffer_store_dwordx4 v[180:183], v178, s[32:35], s43 offen sc1
s_mov_b64 exec, -1
s_sub_u32 s43, s2, 96
s_cmp_lt_u32 s43, 96
s_cbranch_scc0 Lnobias
s_lshl_b32 s44, s43, 1
v_mul_u32_u24 v176, 192, v251
v_lshlrev_b32 v177, 1, v251
s_add_u32 s45, s44, 0
buffer_load_ushort v178, v176, s[16:19], s45 offen
buffer_load_ushort v184, v177, s[28:31], 0 offen offset:0
s_add_u32 s45, s44, 12288
buffer_load_ushort v179, v176, s[16:19], s45 offen
buffer_load_ushort v185, v177, s[28:31], 0 offen offset:128
s_add_u32 s45, s44, 24576
buffer_load_ushort v180, v176, s[16:19], s45 offen
buffer_load_ushort v186, v177, s[28:31], 0 offen offset:256
s_add_u32 s45, s44, 36864
buffer_load_ushort v181, v176, s[16:19], s45 offen
buffer_load_ushort v187, v177, s[28:31], 0 offen offset:384
s_add_u32 s45, s44, 49152
buffer_load_ushort v182, v176, s[16:19], s45 offen
buffer_load_ushort v188, v177, s[28:31], 0 offen offset:512
s_add_u32 s45, s44, 61440
buffer_load_ushort v183, v176, s[16:19], s45 offen
buffer_load_ushort v189, v177, s[28:31], 0 offen offset:640
Lnobias:
s_nop 1
Lnosent:
v_lshlrev_b32 v252, 7, v251
s_add_u32 s46, s47, 1572864
s_mov_b32 exec_lo, 4294836224
s_mov_b32 exec_hi, 3
s_mov_b32 m0, 16220
s_nop 0
buffer_load_dword v252, s[4:7], s46 offen lds
s_mov_b64 exec, -1
s_setprio 1
v_smfmac_f32_16x16x32_bf16 v[28:31], v[226:227], v[208:211], v246
s_add_u32 s46, s80, 6291456
buffer_store_dwordx4 v[60:63], v241, s[32:35], s46 offen sc1
ds_read_b128 v[220:223], v248 offset:63488
v_cvt_pkrtz_f16_f32 v137, v120, v121
v_cvt_pkrtz_f16_f32 v139, v122, v123
v_cvt_pkrtz_f16_f32 v141, v124, v125
v_cvt_pkrtz_f16_f32 v143, v126, v127
v_smfmac_f32_16x16x32_bf16 v[12:15], v[224:225], v[212:215], v246
v_cvt_pk_f16_f32 v155, v128, v129
v_cvt_pk_f16_f32 v152, v130, v131
v_cvt_pk_f16_f32 v149, v132, v133
v_cvt_pk_f16_f32 v146, v134, v135
v_mfma_f32_32x32x16_bf16 v[120:135], v[48:51], v[228:231], 0
ds_read_b128 v[224:227], v248 offset:61440
v_pk_fma_f16 v154, v155, v155, s48
v_and_b32_e64 v137, s49, v137
v_pk_fma_f16 v151, v152, v152, s48
v_pk_fma_f16 v148, v149, v149, s48
v_and_b32_e64 v139, s49, v139
v_pk_fma_f16 v145, v146, v146, s48
v_pk_mul_f16 v154, v155, v154
v_bfe_u32 v136, v137, 2, 14
s_waitcnt lgkmcnt(2)
v_mfma_f32_32x32x16_bf16 v[120:135], v[52:55], v[232:235], v[120:135]
ds_read_b128 v[228:231], v245 offset:3840
ds_read_b128 v[200:203], v243
v_xor_b32 v242, 16, v242
ds_read_b128 v[204:207], v242 offset:128
ds_read_u16_d16 v136, v136
v_pk_mul_f16 v151, v152, v151
v_pk_mul_f16 v148, v149, v148
v_bfe_u32 v138, v139, 2, 14
v_pk_mul_f16 v145, v146, v145
v_exp_f16 v153, v154
v_lshrrev_b32 v137, 18, v137
v_exp_f16_e64 v150, v151
v_mfma_f32_32x32x16_bf16 v[120:135], v[56:59], v[236:239], v[120:135]
ds_read_b128 v[232:235], v248 offset:64512
ds_read_u16_d16 v138, v138
ds_read_u16_d16_hi v137, v137
v_lshrrev_b32 v139, 18, v139
v_exp_f16 v147, v148
v_and_b32 v141, s49, v141
v_exp_f16 v144, v145
v_and_b32_e64 v143, s49, v143
v_smfmac_f32_16x16x32_bf16 v[44:47], v[218:219], v[192:195], v246
ds_read_b128 v[236:239], v245 offset:3456
ds_read_b128 v[208:211], v242 offset:64
ds_read_b128 v[212:215], v242
ds_read_u16_d16_hi v139, v139
v_exp_f16_sdwa v153, v154 dst_sel:WORD_1 dst_unused:UNUSED_PRESERVE src0_sel:WORD_1
v_bfe_u32 v140, v141, 2, 14
v_exp_f16_sdwa v150, v151 dst_sel:WORD_1 dst_unused:UNUSED_PRESERVE src0_sel:WORD_1
v_smfmac_f32_16x16x32_bf16 v[28:31], v[216:217], v[196:199], v246
v_bfe_u32 v142, v143, 2, 14
v_exp_f16_sdwa v147, v148 dst_sel:WORD_1 dst_unused:UNUSED_PRESERVE src0_sel:WORD_1
v_lshrrev_b32_e64 v141, 18, v141
s_waitcnt lgkmcnt(7)
v_mfma_f32_32x32x16_bf16 v[120:135], v[60:63], v[220:223], v[120:135]
ds_read_b128 v[216:219], v245 offset:3072
v_xor_b32 v244, 32, v244
ds_read_b128 v[192:195], v244 offset:128
ds_read_b128 v[196:199], v244 offset:64
ds_read_u16_d16 v140, v140
ds_read_u16_d16 v142, v142
ds_read_u16_d16_hi v141, v141
v_exp_f16_sdwa v144, v145 dst_sel:WORD_1 dst_unused:UNUSED_PRESERVE src0_sel:WORD_1
v_lshrrev_b32_e64 v143, 18, v143
v_pk_add_f16 v153, v153, 1.0 op_sel_hi:[1,0]
v_pk_add_f16 v150, v150, 1.0 op_sel_hi:[1,0]
v_pk_add_f16 v147, v147, 1.0 op_sel_hi:[1,0]
v_pk_add_f16 v144, v144, 1.0 op_sel_hi:[1,0]
v_rcp_f16_e64 v154, v153
v_mfma_f32_32x32x16_bf16 v[120:135], v[64:67], v[224:227], v[120:135]
ds_read_b128 v[220:223], v249
ds_read_u16_d16_hi v143, v143
v_rcp_f16 v151, v150
v_rcp_f16 v148, v147
v_rcp_f16_e64 v145, v144
v_rcp_f16_sdwa v154, v153 dst_sel:WORD_1 dst_unused:UNUSED_PRESERVE src0_sel:WORD_1
v_smfmac_f32_16x16x32_bf16 v[12:15], v[230:231], v[200:203], v246
ds_read_b128 v[224:227], v249 offset:3072
v_rcp_f16_sdwa v151, v150 dst_sel:WORD_1 dst_unused:UNUSED_PRESERVE src0_sel:WORD_1
s_setprio 0
v_rcp_f16_sdwa v148, v147 dst_sel:WORD_1 dst_unused:UNUSED_PRESERVE src0_sel:WORD_1
v_fma_mix_f32 v162, v136, v136, 0 op_sel:[0,0,0] op_sel_hi:[1,1,0]
v_smfmac_f32_16x16x32_bf16 v[44:47], v[228:229], v[204:207], v246
v_rcp_f16_sdwa v145, v144 dst_sel:WORD_1 dst_unused:UNUSED_PRESERVE src0_sel:WORD_1
s_waitcnt lgkmcnt(5)
v_fma_mix_f32 v162, v137, v137, v162 op_sel:[1,1,0] op_sel_hi:[1,1,0]
v_pk_mul_f16 v155, v155, v154
v_mfma_f32_32x32x16_bf16 v[120:135], v[68:71], v[232:235], v[120:135]
ds_read_b128 v[228:231], v245 offset:2688
ds_read_b128 v[200:203], v244
v_xor_b32 v243, 32, v243
ds_read_b128 v[204:207], v243 offset:128
v_fma_mix_f32 v162, v138, v138, v162 op_sel:[0,0,0] op_sel_hi:[1,1,0]
v_pk_mul_f16 v152, v152, v151
v_pk_mul_f16 v149, v149, v148
v_fma_mix_f32 v162, v139, v139, v162 op_sel:[1,1,0] op_sel_hi:[1,1,0]
v_pk_mul_f16 v146, v146, v145
v_fma_mix_f32 v162, v155, v155, v162 op_sel:[0,0,0] op_sel_hi:[1,1,0]
v_fma_mix_f32 v162, v140, v140, v162 op_sel:[0,0,0] op_sel_hi:[1,1,0]
v_fma_mix_f32 v162, v155, v155, v162 op_sel:[1,1,0] op_sel_hi:[1,1,0]
v_smfmac_f32_16x16x32_bf16 v[28:31], v[238:239], v[208:211], v246
ds_read_b128 v[232:235], v249 offset:1024
v_fma_mix_f32 v162, v152, v152, v162 op_sel:[0,0,0] op_sel_hi:[1,1,0]
s_waitcnt lgkmcnt(4)
v_fma_mix_f32 v162, v141, v141, v162 op_sel:[1,1,0] op_sel_hi:[1,1,0]
v_fma_mix_f32 v162, v152, v152, v162 op_sel:[1,1,0] op_sel_hi:[1,1,0]
v_fma_mix_f32 v162, v149, v149, v162 op_sel:[0,0,0] op_sel_hi:[1,1,0]
v_smfmac_f32_16x16x32_bf16 v[12:15], v[236:237], v[212:215], v246
v_fma_mix_f32 v162, v142, v142, v162 op_sel:[0,0,0] op_sel_hi:[1,1,0]
v_fma_mix_f32 v162, v149, v149, v162 op_sel:[1,1,0] op_sel_hi:[1,1,0]
v_fma_mix_f32 v162, v146, v146, v162 op_sel:[0,0,0] op_sel_hi:[1,1,0]
v_fma_mix_f32 v162, v143, v143, v162 op_sel:[1,1,0] op_sel_hi:[1,1,0]
v_fma_mix_f32 v162, v146, v146, v162 op_sel:[1,1,0] op_sel_hi:[1,1,0]
v_lshlrev_b32_e64 v252, 7, v251
s_add_u32 s46, s47, 1572864
s_mov_b32 exec_lo, 0
s_mov_b32 exec_hi, 1048572
s_mov_b32 m0, 16152
s_nop 0
buffer_load_dword v252, s[4:7], s46 offen lds
s_mov_b64 exec, -1
s_setprio 2
v_smfmac_f32_16x16x32_bf16 v[36:39], v[218:219], v[192:195], v246
s_add_u32 s46, s80, 8388608
buffer_store_dwordx4 v[64:67], v241, s[32:35], s46 offen sc1
ds_read_b128 v[236:239], v249 offset:4096
v_cvt_pkrtz_f16_f32 v137, v120, v121
v_cvt_pkrtz_f16_f32 v139, v122, v123
v_cvt_pkrtz_f16_f32 v141, v124, v125
v_smfmac_f32_16x16x32_bf16 v[20:23], v[216:217], v[196:199], v246
v_cvt_pkrtz_f16_f32 v143, v126, v127
v_cvt_pkrtz_f16_f32 v145, v128, v129
v_cvt_pk_f16_f32 v155, v130, v131
v_cvt_pk_f16_f32 v152, v132, v133
v_cvt_pk_f16_f32 v149, v134, v135
v_mfma_f32_32x32x16_bf16 v[120:135], v[48:51], v[220:223], 0
ds_read_b128 v[216:219], v245 offset:2304
ds_read_b128 v[208:211], v243 offset:64
ds_read_b128 v[212:215], v243
v_pk_fma_f16 v154, v155, v155, s48
v_and_b32_e64 v137, s49, v137
v_pk_fma_f16 v151, v152, v152, s48
v_and_b32_e64 v139, s49, v139
v_pk_fma_f16 v148, v149, v149, s48
v_mfma_f32_32x32x16_bf16 v[120:135], v[52:55], v[224:227], v[120:135]
ds_read_b128 v[220:223], v249 offset:2048
v_pk_mul_f16 v154, v155, v154
v_bfe_u32 v136, v137, 2, 14
v_pk_mul_f16 v151, v152, v151
v_pk_mul_f16 v148, v149, v148
v_bfe_u32 v138, v139, 2, 14
v_exp_f16_e64 v153, v154
s_waitcnt lgkmcnt(4)
v_smfmac_f32_16x16x32_bf16 v[4:7], v[230:231], v[200:203], v246
ds_read_b128 v[224:227], v245 offset:1920
v_xor_b32 v242, 32, v242
ds_read_b128 v[192:195], v242 offset:128
ds_read_b128 v[196:199], v242 offset:64
ds_read_u16_d16 v136, v136
ds_read_u16_d16 v138, v138
v_lshrrev_b32 v137, 18, v137
v_exp_f16 v150, v151
v_smfmac_f32_16x16x32_bf16 v[36:39], v[228:229], v[204:207], v246
v_lshrrev_b32 v139, 18, v139
v_exp_f16 v147, v148
v_and_b32_e64 v141, s49, v141
v_mfma_f32_32x32x16_bf16 v[120:135], v[56:59], v[232:235], v[120:135]
ds_read_b128 v[228:231], v249 offset:5120
ds_read_u16_d16_hi v137, v137
ds_read_u16_d16_hi v139, v139
v_and_b32_e64 v143, s49, v143
v_exp_f16_sdwa v153, v154 dst_sel:WORD_1 dst_unused:UNUSED_PRESERVE src0_sel:WORD_1
v_bfe_u32 v140, v141, 2, 14
v_exp_f16_sdwa v150, v151 dst_sel:WORD_1 dst_unused:UNUSED_PRESERVE src0_sel:WORD_1
v_bfe_u32 v142, v143, 2, 14
v_mfma_f32_32x32x16_bf16 v[120:135], v[60:63], v[236:239], v[120:135]
ds_read_b128 v[232:235], v245 offset:1536
ds_read_b128 v[200:203], v242
v_xor_b32 v244, 16, v244
ds_read_b128 v[204:207], v244 offset:128
ds_read_u16_d16 v140, v140
ds_read_u16_d16 v142, v142
v_exp_f16_sdwa v147, v148 dst_sel:WORD_1 dst_unused:UNUSED_PRESERVE src0_sel:WORD_1
v_lshrrev_b32 v141, 18, v141
v_pk_add_f16 v153, v153, 1.0 op_sel_hi:[1,0]
v_lshrrev_b32 v143, 18, v143
v_pk_add_f16 v150, v150, 1.0 op_sel_hi:[1,0]
s_waitcnt lgkmcnt(8)
v_smfmac_f32_16x16x32_bf16 v[20:23], v[218:219], v[208:211], v246
ds_read_b128 v[236:239], v245 offset:1152
ds_read_u16_d16_hi v141, v141
ds_read_u16_d16_hi v143, v143
v_pk_add_f16 v147, v147, 1.0 op_sel_hi:[1,0]
v_and_b32 v145, s49, v145
v_rcp_f16 v154, v153
v_smfmac_f32_16x16x32_bf16 v[4:7], v[216:217], v[212:215], v246
v_bfe_u32 v144, v145, 2, 14
v_rcp_f16_e64 v151, v150
v_mfma_f32_32x32x16_bf16 v[120:135], v[64:67], v[220:223], v[120:135]
ds_read_b128 v[208:211], v244 offset:64
ds_read_b128 v[212:215], v244
ds_read_b128 v[216:219], v249 offset:6144
ds_read_u16_d16 v144, v144
v_lshrrev_b32_e64 v145, 18, v145
v_rcp_f16 v148, v147
v_rcp_f16_sdwa v154, v153 dst_sel:WORD_1 dst_unused:UNUSED_PRESERVE src0_sel:WORD_1
ds_read_u16_d16_hi v145, v145
v_fma_mix_f32 v163, v136, v136, 0 op_sel:[0,0,0] op_sel_hi:[1,1,0]
s_waitcnt lgkmcnt(8)
v_fma_mix_f32 v163, v137, v137, v163 op_sel:[1,1,0] op_sel_hi:[1,1,0]
v_smfmac_f32_16x16x32_bf16 v[36:39], v[226:227], v[192:195], v246
ds_read_b128 v[220:223], v249 offset:9216
v_rcp_f16_sdwa v151, v150 dst_sel:WORD_1 dst_unused:UNUSED_PRESERVE src0_sel:WORD_1
v_fma_mix_f32 v163, v138, v138, v163 op_sel:[0,0,0] op_sel_hi:[1,1,0]
v_smfmac_f32_16x16x32_bf16 v[20:23], v[224:225], v[196:199], v246
v_rcp_f16_sdwa v148, v147 dst_sel:WORD_1 dst_unused:UNUSED_PRESERVE src0_sel:WORD_1
v_fma_mix_f32 v163, v139, v139, v163 op_sel:[1,1,0] op_sel_hi:[1,1,0]
v_pk_mul_f16 v155, v155, v154
v_mfma_f32_32x32x16_bf16 v[120:135], v[68:71], v[228:231], v[120:135]
ds_read_b128 v[224:227], v249 offset:7168
v_fma_mix_f32 v163, v140, v140, v163 op_sel:[0,0,0] op_sel_hi:[1,1,0]
v_pk_mul_f16 v152, v152, v151
s_waitcnt lgkmcnt(7)
v_fma_mix_f32 v163, v141, v141, v163 op_sel:[1,1,0] op_sel_hi:[1,1,0]
v_pk_mul_f16 v149, v149, v148
v_fma_mix_f32 v163, v155, v155, v163 op_sel:[0,0,0] op_sel_hi:[1,1,0]
v_fma_mix_f32 v163, v142, v142, v163 op_sel:[0,0,0] op_sel_hi:[1,1,0]
v_fma_mix_f32 v163, v155, v155, v163 op_sel:[1,1,0] op_sel_hi:[1,1,0]
v_smfmac_f32_16x16x32_bf16 v[4:7], v[234:235], v[200:203], v246
ds_read_b128 v[228:231], v245 offset:768
v_xor_b32 v243, 16, v243
ds_read_b128 v[192:195], v243 offset:128
ds_read_b128 v[196:199], v243 offset:64
v_fma_mix_f32 v163, v143, v143, v163 op_sel:[1,1,0] op_sel_hi:[1,1,0]
v_fma_mix_f32 v163, v152, v152, v163 op_sel:[0,0,0] op_sel_hi:[1,1,0]
v_fma_mix_f32 v163, v152, v152, v163 op_sel:[1,1,0] op_sel_hi:[1,1,0]
v_smfmac_f32_16x16x32_bf16 v[32:35], v[232:233], v[204:207], v246
s_waitcnt lgkmcnt(4)
v_fma_mix_f32 v163, v144, v144, v163 op_sel:[0,0,0] op_sel_hi:[1,1,0]
v_fma_mix_f32 v163, v149, v149, v163 op_sel:[0,0,0] op_sel_hi:[1,1,0]
v_fma_mix_f32 v163, v145, v145, v163 op_sel:[1,1,0] op_sel_hi:[1,1,0]
v_fma_mix_f32 v163, v149, v149, v163 op_sel:[1,1,0] op_sel_hi:[1,1,0]
s_setprio 1
v_smfmac_f32_16x16x32_bf16 v[16:19], v[238:239], v[208:211], v246
s_add_u32 s46, s80, 10485760
buffer_store_dwordx4 v[68:71], v241, s[32:35], s46 offen sc1
ds_read_b128 v[232:235], v249 offset:10240
v_cvt_pkrtz_f16_f32 v137, v120, v121
v_cvt_pkrtz_f16_f32 v139, v122, v123
v_cvt_pkrtz_f16_f32 v141, v124, v125
v_smfmac_f32_16x16x32_bf16 v[0:3], v[236:237], v[212:215], v246
v_cvt_pkrtz_f16_f32 v143, v126, v127
v_cvt_pk_f16_f32 v155, v128, v129
v_cvt_pk_f16_f32 v152, v130, v131
v_cvt_pk_f16_f32 v149, v132, v133
v_cvt_pk_f16_f32 v146, v134, v135
v_mfma_f32_32x32x16_bf16 v[120:135], v[48:51], v[216:219], 0
ds_read_b128 v[236:239], v249 offset:8192
v_pk_fma_f16 v154, v155, v155, s48
v_and_b32_e64 v137, s49, v137
v_pk_fma_f16 v151, v152, v152, s48
v_pk_fma_f16 v148, v149, v149, s48
v_and_b32 v139, s49, v139
v_pk_fma_f16 v145, v146, v146, s48
v_pk_mul_f16 v154, v155, v154
v_mfma_f32_32x32x16_bf16 v[120:135], v[52:55], v[220:223], v[120:135]
ds_read_b128 v[216:219], v245 offset:384
ds_read_b128 v[200:203], v243
v_xor_b32 v242, 16, v242
ds_read_b128 v[204:207], v242 offset:128
v_bfe_u32 v136, v137, 2, 14
v_pk_mul_f16 v151, v152, v151
v_pk_mul_f16 v148, v149, v148
v_bfe_u32 v138, v139, 2, 14
v_pk_mul_f16 v145, v146, v145
v_exp_f16 v153, v154
s_waitcnt lgkmcnt(4)
v_mfma_f32_32x32x16_bf16 v[120:135], v[56:59], v[224:227], v[120:135]
ds_read_b128 v[220:223], v249 offset:11264
ds_read_u16_d16 v136, v136
ds_read_u16_d16 v138, v138
v_lshrrev_b32 v137, 18, v137
v_exp_f16 v150, v151
v_lshrrev_b32 v139, 18, v139
v_exp_f16 v147, v148
v_and_b32_e64 v141, s49, v141
v_smfmac_f32_16x16x32_bf16 v[32:35], v[230:231], v[192:195], v246
ds_read_b128 v[224:227], v245
ds_read_b128 v[208:211], v242 offset:64
ds_read_b128 v[212:215], v242
ds_read_u16_d16_hi v137, v137
ds_read_u16_d16_hi v139, v139
v_exp_f16 v144, v145
v_and_b32 v143, s49, v143
v_exp_f16_sdwa v153, v154 dst_sel:WORD_1 dst_unused:UNUSED_PRESERVE src0_sel:WORD_1
v_smfmac_f32_16x16x32_bf16 v[16:19], v[228:229], v[196:199], v246
v_bfe_u32 v140, v141, 2, 14
v_exp_f16_sdwa v150, v151 dst_sel:WORD_1 dst_unused:UNUSED_PRESERVE src0_sel:WORD_1
v_mfma_f32_32x32x16_bf16 v[120:135], v[60:63], v[232:235], v[120:135]
ds_read_b128 v[228:231], v249 offset:12288
ds_read_u16_d16 v140, v140
v_bfe_u32 v142, v143, 2, 14
v_exp_f16_sdwa v147, v148 dst_sel:WORD_1 dst_unused:UNUSED_PRESERVE src0_sel:WORD_1
v_lshrrev_b32_e64 v141, 18, v141
v_exp_f16_sdwa v144, v145 dst_sel:WORD_1 dst_unused:UNUSED_PRESERVE src0_sel:WORD_1
v_lshrrev_b32 v143, 18, v143
v_pk_add_f16 v153, v153, 1.0 op_sel_hi:[1,0]
s_waitcnt lgkmcnt(7)
v_mfma_f32_32x32x16_bf16 v[120:135], v[64:67], v[236:239], v[120:135]
ds_read_b128 v[232:235], v249 offset:15360
ds_read_u16_d16 v142, v142
ds_read_u16_d16_hi v141, v141
ds_read_u16_d16_hi v143, v143
v_pk_add_f16 v150, v150, 1.0 op_sel_hi:[1,0]
v_pk_add_f16 v147, v147, 1.0 op_sel_hi:[1,0]
v_pk_add_f16 v144, v144, 1.0 op_sel_hi:[1,0]
v_rcp_f16 v154, v153
v_rcp_f16 v151, v150
v_smfmac_f32_16x16x32_bf16 v[0:3], v[218:219], v[200:203], v246
ds_read_b128 v[236:239], v249 offset:13312
v_rcp_f16 v148, v147
v_rcp_f16 v145, v144
v_smfmac_f32_16x16x32_bf16 v[32:35], v[216:217], v[204:207], v246
v_rcp_f16_sdwa v154, v153 dst_sel:WORD_1 dst_unused:UNUSED_PRESERVE src0_sel:WORD_1
v_rcp_f16_sdwa v151, v150 dst_sel:WORD_1 dst_unused:UNUSED_PRESERVE src0_sel:WORD_1
s_setprio 0
v_mfma_f32_32x32x16_bf16 v[120:135], v[68:71], v[220:223], v[120:135]
ds_read_b128 v[216:219], v249 offset:16384
v_rcp_f16_sdwa v148, v147 dst_sel:WORD_1 dst_unused:UNUSED_PRESERVE src0_sel:WORD_1
v_fma_mix_f32 v164, v136, v136, 0 op_sel:[0,0,0] op_sel_hi:[1,1,0]
v_rcp_f16_sdwa v145, v144 dst_sel:WORD_1 dst_unused:UNUSED_PRESERVE src0_sel:WORD_1
s_waitcnt lgkmcnt(6)
v_fma_mix_f32 v164, v137, v137, v164 op_sel:[1,1,0] op_sel_hi:[1,1,0]
v_pk_mul_f16 v155, v155, v154
v_fma_mix_f32 v164, v138, v138, v164 op_sel:[0,0,0] op_sel_hi:[1,1,0]
v_smfmac_f32_16x16x32_bf16 v[16:19], v[226:227], v[208:211], v246
ds_read_b128 v[220:223], v249 offset:14336
v_pk_mul_f16 v152, v152, v151
v_pk_mul_f16 v149, v149, v148
v_fma_mix_f32 v164, v139, v139, v164 op_sel:[1,1,0] op_sel_hi:[1,1,0]
v_pk_mul_f16 v146, v146, v145
v_smfmac_f32_16x16x32_bf16 v[0:3], v[224:225], v[212:215], v246
s_mov_b64 exec, 1
ds_add_u32 v253, v254 offset:16
s_mov_b64 exec, -1
v_fma_mix_f32 v164, v155, v155, v164 op_sel:[0,0,0] op_sel_hi:[1,1,0]
v_fma_mix_f32 v164, v140, v140, v164 op_sel:[0,0,0] op_sel_hi:[1,1,0]
v_fma_mix_f32 v164, v155, v155, v164 op_sel:[1,1,0] op_sel_hi:[1,1,0]
v_fma_mix_f32 v164, v152, v152, v164 op_sel:[0,0,0] op_sel_hi:[1,1,0]
s_waitcnt lgkmcnt(3)
v_fma_mix_f32 v164, v141, v141, v164 op_sel:[1,1,0] op_sel_hi:[1,1,0]
v_fma_mix_f32 v164, v152, v152, v164 op_sel:[1,1,0] op_sel_hi:[1,1,0]
v_fma_mix_f32 v164, v149, v149, v164 op_sel:[0,0,0] op_sel_hi:[1,1,0]
v_fma_mix_f32 v164, v142, v142, v164 op_sel:[0,0,0] op_sel_hi:[1,1,0]
v_fma_mix_f32 v164, v149, v149, v164 op_sel:[1,1,0] op_sel_hi:[1,1,0]
v_fma_mix_f32 v164, v146, v146, v164 op_sel:[0,0,0] op_sel_hi:[1,1,0]
v_fma_mix_f32 v164, v143, v143, v164 op_sel:[1,1,0] op_sel_hi:[1,1,0]
v_fma_mix_f32 v164, v146, v146, v164 op_sel:[1,1,0] op_sel_hi:[1,1,0]
s_setprio 3
v_pk_add_f32 v[168:169], v[0:1], v[2:3]
v_pk_mul_f32 v[170:171], v[0:1], v[0:1]
v_pk_fma_f32 v[170:171], v[2:3], v[2:3], v[170:171]
v_pk_add_f32 v[168:169], v[168:169], v[4:5]
v_pk_fma_f32 v[170:171], v[4:5], v[4:5], v[170:171]
v_pk_add_f32 v[168:169], v[168:169], v[6:7]
v_pk_fma_f32 v[170:171], v[6:7], v[6:7], v[170:171]
v_pk_add_f32 v[168:169], v[168:169], v[8:9]
v_pk_fma_f32 v[170:171], v[8:9], v[8:9], v[170:171]
v_pk_add_f32 v[168:169], v[168:169], v[10:11]
v_pk_fma_f32 v[170:171], v[10:11], v[10:11], v[170:171]
v_pk_add_f32 v[168:169], v[168:169], v[12:13]
v_pk_fma_f32 v[170:171], v[12:13], v[12:13], v[170:171]
v_pk_add_f32 v[168:169], v[168:169], v[14:15]
v_pk_fma_f32 v[170:171], v[14:15], v[14:15], v[170:171]
v_pk_add_f32 v[168:169], v[168:169], v[16:17]
v_pk_fma_f32 v[170:171], v[16:17], v[16:17], v[170:171]
v_pk_add_f32 v[168:169], v[168:169], v[18:19]
v_pk_fma_f32 v[170:171], v[18:19], v[18:19], v[170:171]
v_pk_add_f32 v[168:169], v[168:169], v[20:21]
v_pk_fma_f32 v[170:171], v[20:21], v[20:21], v[170:171]
v_pk_add_f32 v[168:169], v[168:169], v[22:23]
v_pk_fma_f32 v[170:171], v[22:23], v[22:23], v[170:171]
v_pk_add_f32 v[168:169], v[168:169], v[24:25]
v_pk_fma_f32 v[170:171], v[24:25], v[24:25], v[170:171]
v_pk_add_f32 v[168:169], v[168:169], v[26:27]
v_pk_fma_f32 v[170:171], v[26:27], v[26:27], v[170:171]
v_pk_add_f32 v[168:169], v[168:169], v[28:29]
v_pk_fma_f32 v[170:171], v[28:29], v[28:29], v[170:171]
v_pk_add_f32 v[168:169], v[168:169], v[30:31]
v_pk_fma_f32 v[170:171], v[30:31], v[30:31], v[170:171]
v_pk_add_f32 v[168:169], v[168:169], v[32:33]
v_pk_fma_f32 v[170:171], v[32:33], v[32:33], v[170:171]
v_pk_add_f32 v[168:169], v[168:169], v[34:35]
v_pk_fma_f32 v[170:171], v[34:35], v[34:35], v[170:171]
v_pk_add_f32 v[168:169], v[168:169], v[36:37]
v_pk_fma_f32 v[170:171], v[36:37], v[36:37], v[170:171]
v_pk_add_f32 v[168:169], v[168:169], v[38:39]
v_pk_fma_f32 v[170:171], v[38:39], v[38:39], v[170:171]
v_pk_add_f32 v[168:169], v[168:169], v[40:41]
v_pk_fma_f32 v[170:171], v[40:41], v[40:41], v[170:171]
v_pk_add_f32 v[168:169], v[168:169], v[42:43]
v_pk_fma_f32 v[170:171], v[42:43], v[42:43], v[170:171]
v_pk_add_f32 v[168:169], v[168:169], v[44:45]
v_pk_fma_f32 v[170:171], v[44:45], v[44:45], v[170:171]
v_pk_add_f32 v[168:169], v[168:169], v[46:47]
v_pk_fma_f32 v[170:171], v[46:47], v[46:47], v[170:171]
s_setprio 0
v_add_u32 v174, -36864, v242
v_subrev_u32 v175, 66560, v174
v_min_u32 v174, v174, v175
v_add_u32 v174, 90112, v174
v_sub_u32 v175, v174, v242
v_add_u32 v242, v175, v242
v_add_u32_e64 v243, v175, v243
v_add_u32 v244, v175, v244
s_setprio 2
v_cvt_pkrtz_f16_f32 v137, v120, v121
v_cvt_pkrtz_f16_f32 v139, v122, v123
v_cvt_pkrtz_f16_f32 v141, v124, v125
v_cvt_pkrtz_f16_f32 v143, v126, v127
v_cvt_pkrtz_f16_f32 v145, v128, v129
v_cvt_pk_f16_f32 v155, v130, v131
v_cvt_pk_f16_f32 v152, v132, v133
v_cvt_pk_f16_f32 v149, v134, v135
ds_read_b128 v[224:227], v249 offset:17408
v_mfma_f32_32x32x16_bf16 v[120:135], v[48:51], v[228:231], 0
v_pk_fma_f16 v154, v155, v155, s48
v_add_f32 v168, v168, v169
v_and_b32 v137, s49, v137
v_pk_fma_f16 v151, v152, v152, s48
v_and_b32_e64 v139, s49, v139
v_pk_fma_f16 v148, v149, v149, s48
v_add_f32_e64 v170, v170, v171
v_pk_mul_f16 v154, v155, v154
v_bfe_u32 v136, v137, 2, 14
v_pk_mul_f16 v151, v152, v151
v_pk_mul_f16 v148, v149, v148
v_bfe_u32 v138, v139, 2, 14
ds_read_b128 v[228:231], v249 offset:18432
ds_read_u16_d16 v136, v136
ds_read_u16_d16 v138, v138
v_mfma_f32_32x32x16_bf16 v[120:135], v[52:55], v[232:235], v[120:135]
v_permlane32_swap_b32 v168, v170
v_exp_f16 v153, v154
v_lshrrev_b32 v137, 18, v137
v_exp_f16 v150, v151
v_add_f32 v168, v168, v170
v_lshrrev_b32 v139, 18, v139
v_exp_f16 v147, v148
v_and_b32 v141, s49, v141
v_and_b32_e64 v143, s49, v143
v_mul_f32 v168, 1009429163, v168
ds_read_b128 v[232:235], v249 offset:21504
ds_read_u16_d16_hi v137, v137
ds_read_u16_d16_hi v139, v139
v_mfma_f32_32x32x16_bf16 v[120:135], v[56:59], v[236:239], v[120:135]
v_exp_f16_sdwa v153, v154 dst_sel:WORD_1 dst_unused:UNUSED_PRESERVE src0_sel:WORD_1
v_bfe_u32 v140, v141, 2, 14
v_exp_f16_sdwa v150, v151 dst_sel:WORD_1 dst_unused:UNUSED_PRESERVE src0_sel:WORD_1
v_mov_b32_e64 v170, v168
v_bfe_u32 v142, v143, 2, 14
v_exp_f16_sdwa v147, v148 dst_sel:WORD_1 dst_unused:UNUSED_PRESERVE src0_sel:WORD_1
v_lshrrev_b32_e64 v141, 18, v141
v_permlane32_swap_b32 v168, v170
v_pk_add_f16 v153, v153, 1.0 op_sel_hi:[1,0]
s_waitcnt lgkmcnt(8)
ds_read_b128 v[236:239], v249 offset:19456
ds_read_u16_d16 v140, v140
ds_read_u16_d16 v142, v142
ds_read_u16_d16_hi v141, v141
v_mfma_f32_32x32x16_bf16 v[120:135], v[60:63], v[216:219], v[120:135]
v_lshrrev_b32_e64 v143, 18, v143
v_pk_add_f16 v150, v150, 1.0 op_sel_hi:[1,0]
v_pk_add_f16 v147, v147, 1.0 op_sel_hi:[1,0]
v_and_b32_e64 v145, s49, v145
v_fma_f32 v170, -v168, v168, v170
v_rcp_f16_e64 v154, v153
v_bfe_u32 v144, v145, 2, 14
v_rcp_f16 v151, v150
v_max_f32 v170, 0, v170
v_lshrrev_b32_e64 v145, 18, v145
ds_read_b128 v[216:219], v249 offset:22528
ds_read_u16_d16_hi v143, v143
ds_read_u16_d16 v144, v144
ds_read_u16_d16_hi v145, v145
v_mfma_f32_32x32x16_bf16 v[120:135], v[64:67], v[220:223], v[120:135]
v_rcp_f16 v148, v147
v_rcp_f16_sdwa v154, v153 dst_sel:WORD_1 dst_unused:UNUSED_PRESERVE src0_sel:WORD_1
v_add_f32 v170, 925353388, v170
s_waitcnt lgkmcnt(8)
v_fma_mix_f32 v165, v136, v136, 0 op_sel:[0,0,0] op_sel_hi:[1,1,0]
ds_read_b32 v247, v253 offset:16
v_fma_mix_f32 v165, v137, v137, v165 op_sel:[1,1,0] op_sel_hi:[1,1,0]
v_rcp_f16_sdwa v151, v150 dst_sel:WORD_1 dst_unused:UNUSED_PRESERVE src0_sel:WORD_1
v_rsq_f32_e64 v170, v170
v_fma_mix_f32 v165, v138, v138, v165 op_sel:[0,0,0] op_sel_hi:[1,1,0]
ds_read_b128 v[220:223], v249 offset:20480
v_mfma_f32_32x32x16_bf16 v[120:135], v[68:71], v[224:227], v[120:135]
v_rcp_f16_sdwa v148, v147 dst_sel:WORD_1 dst_unused:UNUSED_PRESERVE src0_sel:WORD_1
v_fma_mix_f32 v165, v139, v139, v165 op_sel:[1,1,0] op_sel_hi:[1,1,0]
v_pk_mul_f16 v155, v155, v154
s_waitcnt lgkmcnt(6)
v_fma_mix_f32 v165, v140, v140, v165 op_sel:[0,0,0] op_sel_hi:[1,1,0]
v_pk_mul_f16 v152, v152, v151
v_fma_mix_f32 v165, v141, v141, v165 op_sel:[1,1,0] op_sel_hi:[1,1,0]
v_pk_mul_f16 v149, v149, v148
v_fma_mix_f32 v165, v155, v155, v165 op_sel:[0,0,0] op_sel_hi:[1,1,0]
v_mul_f32 v172, 3203391086, v170
v_fma_mix_f32 v165, v142, v142, v165 op_sel:[0,0,0] op_sel_hi:[1,1,0]
v_fma_mix_f32 v165, v155, v155, v165 op_sel:[1,1,0] op_sel_hi:[1,1,0]
s_waitcnt lgkmcnt(2)
v_fma_mix_f32 v165, v143, v143, v165 op_sel:[1,1,0] op_sel_hi:[1,1,0]
v_fma_mix_f32 v165, v152, v152, v165 op_sel:[0,0,0] op_sel_hi:[1,1,0]
v_fma_mix_f32 v165, v152, v152, v165 op_sel:[1,1,0] op_sel_hi:[1,1,0]
v_mul_f32 v173, v168, v172
v_fma_mix_f32 v165, v144, v144, v165 op_sel:[0,0,0] op_sel_hi:[1,1,0]
v_fma_mix_f32 v165, v149, v149, v165 op_sel:[0,0,0] op_sel_hi:[1,1,0]
v_fma_mix_f32 v165, v145, v145, v165 op_sel:[1,1,0] op_sel_hi:[1,1,0]
v_fma_mix_f32 v165, v149, v149, v165 op_sel:[1,1,0] op_sel_hi:[1,1,0]
s_setprio 3
v_pk_fma_f32 v[0:1], v[0:1], v[172:173], v[172:173] op_sel:[0,0,1] op_sel_hi:[1,0,1] neg_lo:[0,0,1] neg_hi:[0,0,1]
v_pk_fma_f32 v[2:3], v[2:3], v[172:173], v[172:173] op_sel:[0,0,1] op_sel_hi:[1,0,1] neg_lo:[0,0,1] neg_hi:[0,0,1]
v_pk_fma_f32 v[4:5], v[4:5], v[172:173], v[172:173] op_sel:[0,0,1] op_sel_hi:[1,0,1] neg_lo:[0,0,1] neg_hi:[0,0,1]
v_pk_fma_f32 v[6:7], v[6:7], v[172:173], v[172:173] op_sel:[0,0,1] op_sel_hi:[1,0,1] neg_lo:[0,0,1] neg_hi:[0,0,1]
v_pk_fma_f32 v[8:9], v[8:9], v[172:173], v[172:173] op_sel:[0,0,1] op_sel_hi:[1,0,1] neg_lo:[0,0,1] neg_hi:[0,0,1]
v_pk_fma_f32 v[10:11], v[10:11], v[172:173], v[172:173] op_sel:[0,0,1] op_sel_hi:[1,0,1] neg_lo:[0,0,1] neg_hi:[0,0,1]
v_pk_fma_f32 v[12:13], v[12:13], v[172:173], v[172:173] op_sel:[0,0,1] op_sel_hi:[1,0,1] neg_lo:[0,0,1] neg_hi:[0,0,1]
v_pk_fma_f32 v[14:15], v[14:15], v[172:173], v[172:173] op_sel:[0,0,1] op_sel_hi:[1,0,1] neg_lo:[0,0,1] neg_hi:[0,0,1]
v_pk_fma_f32 v[16:17], v[16:17], v[172:173], v[172:173] op_sel:[0,0,1] op_sel_hi:[1,0,1] neg_lo:[0,0,1] neg_hi:[0,0,1]
v_pk_fma_f32 v[18:19], v[18:19], v[172:173], v[172:173] op_sel:[0,0,1] op_sel_hi:[1,0,1] neg_lo:[0,0,1] neg_hi:[0,0,1]
v_pk_fma_f32 v[20:21], v[20:21], v[172:173], v[172:173] op_sel:[0,0,1] op_sel_hi:[1,0,1] neg_lo:[0,0,1] neg_hi:[0,0,1]
v_pk_fma_f32 v[22:23], v[22:23], v[172:173], v[172:173] op_sel:[0,0,1] op_sel_hi:[1,0,1] neg_lo:[0,0,1] neg_hi:[0,0,1]
v_pk_fma_f32 v[24:25], v[24:25], v[172:173], v[172:173] op_sel:[0,0,1] op_sel_hi:[1,0,1] neg_lo:[0,0,1] neg_hi:[0,0,1]
v_pk_fma_f32 v[26:27], v[26:27], v[172:173], v[172:173] op_sel:[0,0,1] op_sel_hi:[1,0,1] neg_lo:[0,0,1] neg_hi:[0,0,1]
v_pk_fma_f32 v[28:29], v[28:29], v[172:173], v[172:173] op_sel:[0,0,1] op_sel_hi:[1,0,1] neg_lo:[0,0,1] neg_hi:[0,0,1]
v_pk_fma_f32 v[30:31], v[30:31], v[172:173], v[172:173] op_sel:[0,0,1] op_sel_hi:[1,0,1] neg_lo:[0,0,1] neg_hi:[0,0,1]
v_pk_fma_f32 v[32:33], v[32:33], v[172:173], v[172:173] op_sel:[0,0,1] op_sel_hi:[1,0,1] neg_lo:[0,0,1] neg_hi:[0,0,1]
v_pk_fma_f32 v[34:35], v[34:35], v[172:173], v[172:173] op_sel:[0,0,1] op_sel_hi:[1,0,1] neg_lo:[0,0,1] neg_hi:[0,0,1]
v_pk_fma_f32 v[36:37], v[36:37], v[172:173], v[172:173] op_sel:[0,0,1] op_sel_hi:[1,0,1] neg_lo:[0,0,1] neg_hi:[0,0,1]
v_pk_fma_f32 v[38:39], v[38:39], v[172:173], v[172:173] op_sel:[0,0,1] op_sel_hi:[1,0,1] neg_lo:[0,0,1] neg_hi:[0,0,1]
v_pk_fma_f32 v[40:41], v[40:41], v[172:173], v[172:173] op_sel:[0,0,1] op_sel_hi:[1,0,1] neg_lo:[0,0,1] neg_hi:[0,0,1]
v_pk_fma_f32 v[42:43], v[42:43], v[172:173], v[172:173] op_sel:[0,0,1] op_sel_hi:[1,0,1] neg_lo:[0,0,1] neg_hi:[0,0,1]
v_pk_fma_f32 v[44:45], v[44:45], v[172:173], v[172:173] op_sel:[0,0,1] op_sel_hi:[1,0,1] neg_lo:[0,0,1] neg_hi:[0,0,1]
v_pk_fma_f32 v[46:47], v[46:47], v[172:173], v[172:173] op_sel:[0,0,1] op_sel_hi:[1,0,1] neg_lo:[0,0,1] neg_hi:[0,0,1]
s_setprio 2
s_waitcnt lgkmcnt(0)
v_readfirstlane_b32 s43, v247
s_nop 1
s_cmp_ge_u32 s43, 16
s_cbranch_scc1 Lev4
Lev4w:
s_sleep 1
ds_read_b32 v247, v253 offset:16
s_waitcnt lgkmcnt(0)
v_readfirstlane_b32 s43, v247
s_cmp_eq_u32 s76, 0
s_cbranch_scc1 Lev4
s_sub_u32 s76, s76, 1
s_cmp_lt_u32 s43, 16
s_cbranch_scc1 Lev4w
Lev4:
s_setprio 1
v_cvt_pkrtz_f16_f32 v137, v120, v121
v_cvt_pkrtz_f16_f32 v139, v122, v123
v_cvt_pkrtz_f16_f32 v141, v124, v125
v_cvt_pkrtz_f16_f32 v143, v126, v127
v_cvt_pkrtz_f16_f32 v145, v128, v129
v_cvt_pk_f16_f32 v155, v130, v131
v_cvt_pk_f16_f32 v152, v132, v133
v_cvt_pk_f16_f32 v149, v134, v135
s_add_u32 m0, s67, 53248
s_add_u32 s66, s66, 98304
buffer_load_dwordx4 v240, s[4:7], s66 offen lds
ds_read_b128 v[224:227], v249 offset:23552
v_mfma_f32_32x32x16_bf16 v[120:135], v[48:51], v[228:231], 0
v_pk_fma_f16 v154, v155, v155, s48
v_cvt_pk_bf16_f32 v72, v0, v1
v_and_b32 v137, s49, v137
v_pk_fma_f16 v151, v152, v152, s48
v_cvt_pk_bf16_f32 v73, v2, v3
v_and_b32_e64 v139, s49, v139
v_pk_fma_f16 v148, v149, v149, s48
v_pk_mul_f16 v154, v155, v154
v_cvt_pk_bf16_f32 v74, v4, v5
v_bfe_u32 v136, v137, 2, 14
v_pk_mul_f16 v151, v152, v151
v_pk_mul_f16 v148, v149, v148
v_cvt_pk_bf16_f32 v75, v6, v7
v_bfe_u32 v138, v139, 2, 14
s_add_u32 m0, s67, 59904
s_add_u32 s66, s66, 98304
buffer_load_dwordx4 v240, s[4:7], s66 offen lds
ds_read_b128 v[228:231], v248 offset:16384
ds_read_u16_d16 v136, v136
ds_read_u16_d16 v138, v138
v_mfma_f32_32x32x16_bf16 v[120:135], v[52:55], v[232:235], v[120:135]
v_exp_f16_e64 v153, v154
v_cvt_pk_bf16_f32 v76, v8, v9
v_lshrrev_b32 v137, 18, v137
v_exp_f16 v150, v151
v_cvt_pk_bf16_f32 v77, v10, v11
v_lshrrev_b32 v139, 18, v139
v_exp_f16 v147, v148
v_cvt_pk_bf16_f32 v78, v12, v13
v_and_b32_e64 v141, s49, v141
v_and_b32 v143, s49, v143
v_cvt_pk_bf16_f32 v79, v14, v15
s_add_u32 m0, s67, 0
s_add_u32 s66, s66, 98304
buffer_load_dwordx4 v240, s[4:7], s66 offen lds
ds_read_b128 v[232:235], v248 offset:19456
ds_read_u16_d16_hi v137, v137
ds_read_u16_d16_hi v139, v139
v_mfma_f32_32x32x16_bf16 v[120:135], v[56:59], v[236:239], v[120:135]
v_exp_f16_sdwa v153, v154 dst_sel:WORD_1 dst_unused:UNUSED_PRESERVE src0_sel:WORD_1
v_bfe_u32 v140, v141, 2, 14
v_cvt_pk_bf16_f32 v80, v16, v17
v_exp_f16_sdwa v150, v151 dst_sel:WORD_1 dst_unused:UNUSED_PRESERVE src0_sel:WORD_1
v_bfe_u32 v142, v143, 2, 14
v_cvt_pk_bf16_f32 v81, v18, v19
v_exp_f16_sdwa v147, v148 dst_sel:WORD_1 dst_unused:UNUSED_PRESERVE src0_sel:WORD_1
v_cvt_pk_bf16_f32 v82, v20, v21
v_lshrrev_b32_e64 v141, 18, v141
v_pk_add_f16 v153, v153, 1.0 op_sel_hi:[1,0]
v_lshrrev_b32_e64 v143, 18, v143
s_add_u32 m0, s67, 6656
s_add_u32 s66, s66, 98304
buffer_load_dwordx4 v240, s[4:7], s66 offen lds
s_add_u32 m0, s67, 13312
s_add_u32 s66, s66, 98304
buffer_load_dwordx4 v240, s[4:7], s66 offen lds
ds_read_b128 v[236:239], v248 offset:17408
ds_read_u16_d16 v140, v140
ds_read_u16_d16 v142, v142
ds_read_u16_d16_hi v141, v141
ds_read_u16_d16_hi v143, v143
v_mfma_f32_32x32x16_bf16 v[120:135], v[60:63], v[216:219], v[120:135]
v_cvt_pk_bf16_f32 v83, v22, v23
v_pk_add_f16 v150, v150, 1.0 op_sel_hi:[1,0]
v_pk_add_f16 v147, v147, 1.0 op_sel_hi:[1,0]
v_and_b32_e64 v145, s49, v145
v_cvt_pk_bf16_f32 v84, v24, v25
v_rcp_f16_e64 v154, v153
v_bfe_u32 v144, v145, 2, 14
v_cvt_pk_bf16_f32 v85, v26, v27
v_rcp_f16 v151, v150
v_lshrrev_b32 v145, 18, v145
v_cvt_pk_bf16_f32 v86, v28, v29
s_add_u32 m0, s67, 19968
s_add_u32 s66, s66, 98304
buffer_load_dwordx4 v240, s[4:7], s66 offen lds
ds_read_b128 v[216:219], v248 offset:20480
ds_read_u16_d16 v144, v144
ds_read_u16_d16_hi v145, v145
v_mfma_f32_32x32x16_bf16 v[120:135], v[64:67], v[220:223], v[120:135]
v_rcp_f16_e64 v148, v147
v_cvt_pk_bf16_f32 v87, v30, v31
v_rcp_f16_sdwa v154, v153 dst_sel:WORD_1 dst_unused:UNUSED_PRESERVE src0_sel:WORD_1
s_waitcnt lgkmcnt(5)
v_fma_mix_f32 v166, v136, v136, 0 op_sel:[0,0,0] op_sel_hi:[1,1,0]
v_cvt_pk_bf16_f32 v88, v32, v33
s_setprio 0
v_fma_mix_f32 v166, v137, v137, v166 op_sel:[1,1,0] op_sel_hi:[1,1,0]
v_rcp_f16_sdwa v151, v150 dst_sel:WORD_1 dst_unused:UNUSED_PRESERVE src0_sel:WORD_1
v_cvt_pk_bf16_f32 v89, v34, v35
v_fma_mix_f32 v166, v138, v138, v166 op_sel:[0,0,0] op_sel_hi:[1,1,0]
v_rcp_f16_sdwa v148, v147 dst_sel:WORD_1 dst_unused:UNUSED_PRESERVE src0_sel:WORD_1
v_cvt_pk_bf16_f32 v90, v36, v37
s_add_u32 m0, s67, 26624
s_add_u32 s66, s66, 98304
buffer_load_dwordx4 v240, s[4:7], s66 offen lds
ds_read_b128 v[220:223], v248 offset:18432
v_mfma_f32_32x32x16_bf16 v[120:135], v[68:71], v[224:227], v[120:135]
v_fma_mix_f32 v166, v139, v139, v166 op_sel:[1,1,0] op_sel_hi:[1,1,0]
v_pk_mul_f16 v155, v155, v154
v_fma_mix_f32 v166, v140, v140, v166 op_sel:[0,0,0] op_sel_hi:[1,1,0]
v_cvt_pk_bf16_f32 v91, v38, v39
v_pk_mul_f16 v152, v152, v151
s_waitcnt lgkmcnt(1)
v_fma_mix_f32 v166, v141, v141, v166 op_sel:[1,1,0] op_sel_hi:[1,1,0]
v_cvt_pk_bf16_f32 v92, v40, v41
v_pk_mul_f16 v149, v149, v148
v_fma_mix_f32 v166, v155, v155, v166 op_sel:[0,0,0] op_sel_hi:[1,1,0]
v_fma_mix_f32 v166, v142, v142, v166 op_sel:[0,0,0] op_sel_hi:[1,1,0]
v_cvt_pk_bf16_f32 v93, v42, v43
v_fma_mix_f32 v166, v155, v155, v166 op_sel:[1,1,0] op_sel_hi:[1,1,0]
v_fma_mix_f32 v166, v143, v143, v166 op_sel:[1,1,0] op_sel_hi:[1,1,0]
v_fma_mix_f32 v166, v152, v152, v166 op_sel:[0,0,0] op_sel_hi:[1,1,0]
s_add_u32 m0, s67, 33280
s_add_u32 s66, s66, 98304
buffer_load_dwordx4 v240, s[4:7], s66 offen lds
v_cvt_pk_bf16_f32 v94, v44, v45
v_fma_mix_f32 v166, v152, v152, v166 op_sel:[1,1,0] op_sel_hi:[1,1,0]
v_fma_mix_f32 v166, v144, v144, v166 op_sel:[0,0,0] op_sel_hi:[1,1,0]
v_fma_mix_f32 v166, v149, v149, v166 op_sel:[0,0,0] op_sel_hi:[1,1,0]
v_cvt_pk_bf16_f32 v95, v46, v47
v_fma_mix_f32 v166, v145, v145, v166 op_sel:[1,1,0] op_sel_hi:[1,1,0]
v_fma_mix_f32 v166, v149, v149, v166 op_sel:[1,1,0] op_sel_hi:[1,1,0]
s_setprio 2
v_cvt_pkrtz_f16_f32 v137, v120, v121
v_cvt_pkrtz_f16_f32 v139, v122, v123
v_cvt_pkrtz_f16_f32 v141, v124, v125
v_cvt_pkrtz_f16_f32 v143, v126, v127
v_cvt_pkrtz_f16_f32 v145, v128, v129
v_cvt_pk_f16_f32 v155, v130, v131
v_cvt_pk_f16_f32 v152, v132, v133
v_cvt_pk_f16_f32 v149, v134, v135
ds_read_b128 v[224:227], v248 offset:21504
v_mfma_f32_32x32x16_bf16 v[120:135], v[72:75], v[228:231], 0
v_pk_fma_f16 v154, v155, v155, s48
v_and_b32_e64 v137, s49, v137
v_pk_fma_f16 v151, v152, v152, s48
v_and_b32_e64 v139, s49, v139
v_pk_fma_f16 v148, v149, v149, s48
v_pk_mul_f16 v154, v155, v154
v_bfe_u32 v136, v137, 2, 14
v_pk_mul_f16 v151, v152, v151
v_pk_mul_f16 v148, v149, v148
v_bfe_u32 v138, v139, 2, 14
ds_read_b128 v[228:231], v248 offset:22528
ds_read_u16_d16 v136, v136
ds_read_u16_d16 v138, v138
v_mfma_f32_32x32x16_bf16 v[120:135], v[76:79], v[232:235], v[120:135]
v_exp_f16 v153, v154
v_lshrrev_b32 v137, 18, v137
v_exp_f16 v150, v151
v_lshrrev_b32 v139, 18, v139
v_exp_f16 v147, v148
v_and_b32 v141, s49, v141
v_and_b32_e64 v143, s49, v143
ds_read_b128 v[232:235], v248 offset:25600
ds_read_u16_d16_hi v137, v137
ds_read_u16_d16_hi v139, v139
v_mfma_f32_32x32x16_bf16 v[120:135], v[80:83], v[236:239], v[120:135]
v_exp_f16_sdwa v153, v154 dst_sel:WORD_1 dst_unused:UNUSED_PRESERVE src0_sel:WORD_1
v_bfe_u32 v140, v141, 2, 14
v_exp_f16_sdwa v150, v151 dst_sel:WORD_1 dst_unused:UNUSED_PRESERVE src0_sel:WORD_1
v_bfe_u32 v142, v143, 2, 14
v_exp_f16_sdwa v147, v148 dst_sel:WORD_1 dst_unused:UNUSED_PRESERVE src0_sel:WORD_1
v_lshrrev_b32_e64 v141, 18, v141
v_pk_add_f16 v153, v153, 1.0 op_sel_hi:[1,0]
ds_read_b128 v[236:239], v248 offset:23552
ds_read_u16_d16 v140, v140
ds_read_u16_d16 v142, v142
ds_read_u16_d16_hi v141, v141
v_mfma_f32_32x32x16_bf16 v[120:135], v[84:87], v[216:219], v[120:135]
v_lshrrev_b32_e64 v143, 18, v143
v_pk_add_f16 v150, v150, 1.0 op_sel_hi:[1,0]
v_pk_add_f16 v147, v147, 1.0 op_sel_hi:[1,0]
v_and_b32 v145, s49, v145
v_rcp_f16 v154, v153
v_bfe_u32 v144, v145, 2, 14
v_rcp_f16_e64 v151, v150
v_lshrrev_b32 v145, 18, v145
s_waitcnt lgkmcnt(7)
ds_read_b128 v[216:219], v248 offset:26624
ds_read_u16_d16_hi v143, v143
ds_read_u16_d16 v144, v144
ds_read_u16_d16_hi v145, v145
v_mfma_f32_32x32x16_bf16 v[120:135], v[88:91], v[220:223], v[120:135]
v_rcp_f16 v148, v147
v_rcp_f16_sdwa v154, v153 dst_sel:WORD_1 dst_unused:UNUSED_PRESERVE src0_sel:WORD_1
v_fma_mix_f32 v167, v136, v136, 0 op_sel:[0,0,0] op_sel_hi:[1,1,0]
s_waitcnt lgkmcnt(8)
v_fma_mix_f32 v167, v137, v137, v167 op_sel:[1,1,0] op_sel_hi:[1,1,0]
v_rcp_f16_sdwa v151, v150 dst_sel:WORD_1 dst_unused:UNUSED_PRESERVE src0_sel:WORD_1
v_fma_mix_f32 v167, v138, v138, v167 op_sel:[0,0,0] op_sel_hi:[1,1,0]
ds_read_b128 v[220:223], v248 offset:24576
v_mfma_f32_32x32x16_bf16 v[120:135], v[92:95], v[224:227], v[120:135]
v_rcp_f16_sdwa v148, v147 dst_sel:WORD_1 dst_unused:UNUSED_PRESERVE src0_sel:WORD_1
v_fma_mix_f32 v167, v139, v139, v167 op_sel:[1,1,0] op_sel_hi:[1,1,0]
v_pk_mul_f16 v155, v155, v154
s_waitcnt lgkmcnt(5)
v_fma_mix_f32 v167, v140, v140, v167 op_sel:[0,0,0] op_sel_hi:[1,1,0]
v_pk_mul_f16 v152, v152, v151
v_fma_mix_f32 v167, v141, v141, v167 op_sel:[1,1,0] op_sel_hi:[1,1,0]
v_pk_mul_f16 v149, v149, v148
v_fma_mix_f32 v167, v155, v155, v167 op_sel:[0,0,0] op_sel_hi:[1,1,0]
v_fma_mix_f32 v167, v142, v142, v167 op_sel:[0,0,0] op_sel_hi:[1,1,0]
v_fma_mix_f32 v167, v155, v155, v167 op_sel:[1,1,0] op_sel_hi:[1,1,0]
s_waitcnt lgkmcnt(3)
v_fma_mix_f32 v167, v143, v143, v167 op_sel:[1,1,0] op_sel_hi:[1,1,0]
v_fma_mix_f32 v167, v152, v152, v167 op_sel:[0,0,0] op_sel_hi:[1,1,0]
v_fma_mix_f32 v167, v152, v152, v167 op_sel:[1,1,0] op_sel_hi:[1,1,0]
s_waitcnt lgkmcnt(1)
v_fma_mix_f32 v167, v144, v144, v167 op_sel:[0,0,0] op_sel_hi:[1,1,0]
v_fma_mix_f32 v167, v149, v149, v167 op_sel:[0,0,0] op_sel_hi:[1,1,0]
v_fma_mix_f32 v167, v145, v145, v167 op_sel:[1,1,0] op_sel_hi:[1,1,0]
v_fma_mix_f32 v167, v149, v149, v167 op_sel:[1,1,0] op_sel_hi:[1,1,0]
s_setprio 1
v_cvt_pkrtz_f16_f32 v137, v120, v121
v_cvt_pkrtz_f16_f32 v139, v122, v123
v_cvt_pkrtz_f16_f32 v141, v124, v125
v_cvt_pkrtz_f16_f32 v143, v126, v127
v_cvt_pkrtz_f16_f32 v145, v128, v129
v_cvt_pk_f16_f32 v155, v130, v131
v_cvt_pk_f16_f32 v152, v132, v133
v_cvt_pk_f16_f32 v149, v134, v135
ds_read_b128 v[224:227], v248 offset:27648
v_mfma_f32_32x32x16_bf16 v[120:135], v[72:75], v[228:231], 0
v_pk_fma_f16 v154, v155, v155, s48
v_and_b32_e64 v137, s49, v137
v_pk_fma_f16 v151, v152, v152, s48
v_and_b32_e64 v139, s49, v139
v_pk_fma_f16 v148, v149, v149, s48
v_pk_mul_f16 v154, v155, v154
v_bfe_u32 v136, v137, 2, 14
v_pk_mul_f16 v151, v152, v151
v_pk_mul_f16 v148, v149, v148
v_bfe_u32 v138, v139, 2, 14
ds_read_b128 v[228:231], v248 offset:28672
ds_read_u16_d16 v136, v136
ds_read_u16_d16 v138, v138
v_mfma_f32_32x32x16_bf16 v[120:135], v[76:79], v[232:235], v[120:135]
v_exp_f16 v153, v154
v_lshrrev_b32 v137, 18, v137
v_exp_f16 v150, v151
v_lshrrev_b32 v139, 18, v139
v_exp_f16 v147, v148
v_and_b32 v141, s49, v141
v_and_b32_e64 v143, s49, v143
ds_read_b128 v[232:235], v248 offset:31744
ds_read_u16_d16_hi v137, v137
ds_read_u16_d16_hi v139, v139
v_mfma_f32_32x32x16_bf16 v[120:135], v[80:83], v[236:239], v[120:135]
v_exp_f16_sdwa v153, v154 dst_sel:WORD_1 dst_unused:UNUSED_PRESERVE src0_sel:WORD_1
v_bfe_u32 v140, v141, 2, 14
v_exp_f16_sdwa v150, v151 dst_sel:WORD_1 dst_unused:UNUSED_PRESERVE src0_sel:WORD_1
v_bfe_u32 v142, v143, 2, 14
v_exp_f16_sdwa v147, v148 dst_sel:WORD_1 dst_unused:UNUSED_PRESERVE src0_sel:WORD_1
v_lshrrev_b32_e64 v141, 18, v141
v_pk_add_f16 v153, v153, 1.0 op_sel_hi:[1,0]
ds_read_b128 v[236:239], v248 offset:29696
ds_read_u16_d16 v140, v140
ds_read_u16_d16 v142, v142
ds_read_u16_d16_hi v141, v141
v_mfma_f32_32x32x16_bf16 v[120:135], v[84:87], v[216:219], v[120:135]
v_lshrrev_b32_e64 v143, 18, v143
v_pk_add_f16 v150, v150, 1.0 op_sel_hi:[1,0]
v_pk_add_f16 v147, v147, 1.0 op_sel_hi:[1,0]
v_and_b32 v145, s49, v145
v_rcp_f16 v154, v153
v_bfe_u32 v144, v145, 2, 14
v_rcp_f16_e64 v151, v150
v_lshrrev_b32 v145, 18, v145
s_waitcnt lgkmcnt(7)
ds_read_b128 v[216:219], v248 offset:32768
ds_read_u16_d16_hi v143, v143
ds_read_u16_d16 v144, v144
ds_read_u16_d16_hi v145, v145
v_mfma_f32_32x32x16_bf16 v[120:135], v[88:91], v[220:223], v[120:135]
v_rcp_f16_e64 v148, v147
v_rcp_f16_sdwa v154, v153 dst_sel:WORD_1 dst_unused:UNUSED_PRESERVE src0_sel:WORD_1
v_fma_mix_f32 v156, v136, v136, v156 op_sel:[0,0,0] op_sel_hi:[1,1,0]
s_setprio 0
s_waitcnt lgkmcnt(8)
v_fma_mix_f32 v156, v137, v137, v156 op_sel:[1,1,0] op_sel_hi:[1,1,0]
v_rcp_f16_sdwa v151, v150 dst_sel:WORD_1 dst_unused:UNUSED_PRESERVE src0_sel:WORD_1
v_fma_mix_f32 v156, v138, v138, v156 op_sel:[0,0,0] op_sel_hi:[1,1,0]
ds_read_b128 v[220:223], v248 offset:30720
v_mfma_f32_32x32x16_bf16 v[120:135], v[92:95], v[224:227], v[120:135]
v_rcp_f16_sdwa v148, v147 dst_sel:WORD_1 dst_unused:UNUSED_PRESERVE src0_sel:WORD_1
v_fma_mix_f32 v156, v139, v139, v156 op_sel:[1,1,0] op_sel_hi:[1,1,0]
v_pk_mul_f16 v155, v155, v154
s_cmp_eq_u32 s40, 7
s_cbranch_scc1 Lrdy16
s_waitcnt vmcnt(0)
Lrdy16:
s_mov_b64 exec, 1
ds_add_u32 v253, v254 offset:12
s_mov_b64 exec, -1
s_waitcnt lgkmcnt(6)
v_fma_mix_f32 v156, v140, v140, v156 op_sel:[0,0,0] op_sel_hi:[1,1,0]
v_pk_mul_f16 v152, v152, v151
v_fma_mix_f32 v156, v141, v141, v156 op_sel:[1,1,0] op_sel_hi:[1,1,0]
v_pk_mul_f16 v149, v149, v148
v_fma_mix_f32 v156, v155, v155, v156 op_sel:[0,0,0] op_sel_hi:[1,1,0]
v_fma_mix_f32 v156, v142, v142, v156 op_sel:[0,0,0] op_sel_hi:[1,1,0]
v_fma_mix_f32 v156, v155, v155, v156 op_sel:[1,1,0] op_sel_hi:[1,1,0]
s_waitcnt lgkmcnt(2)
v_fma_mix_f32 v156, v143, v143, v156 op_sel:[1,1,0] op_sel_hi:[1,1,0]
v_fma_mix_f32 v156, v152, v152, v156 op_sel:[0,0,0] op_sel_hi:[1,1,0]
v_fma_mix_f32 v156, v152, v152, v156 op_sel:[1,1,0] op_sel_hi:[1,1,0]
v_fma_mix_f32 v156, v144, v144, v156 op_sel:[0,0,0] op_sel_hi:[1,1,0]
v_fma_mix_f32 v156, v149, v149, v156 op_sel:[0,0,0] op_sel_hi:[1,1,0]
v_fma_mix_f32 v156, v145, v145, v156 op_sel:[1,1,0] op_sel_hi:[1,1,0]
v_fma_mix_f32 v156, v149, v149, v156 op_sel:[1,1,0] op_sel_hi:[1,1,0]
s_setprio 2
v_cvt_pkrtz_f16_f32 v137, v120, v121
v_cvt_pkrtz_f16_f32 v139, v122, v123
v_cvt_pkrtz_f16_f32 v141, v124, v125
v_cvt_pkrtz_f16_f32 v143, v126, v127
v_cvt_pkrtz_f16_f32 v145, v128, v129
v_cvt_pk_f16_f32 v155, v130, v131
v_cvt_pk_f16_f32 v152, v132, v133
v_cvt_pk_f16_f32 v149, v134, v135
s_add_u32 s46, s80, 12582912
buffer_store_dwordx4 v[72:75], v241, s[32:35], s46 offen sc1
ds_read_b128 v[224:227], v248 offset:33792
v_mfma_f32_32x32x16_bf16 v[120:135], v[72:75], v[228:231], 0
v_pk_fma_f16 v154, v155, v155, s48
v_and_b32_e64 v137, s49, v137
v_pk_fma_f16 v151, v152, v152, s48
v_and_b32_e64 v139, s49, v139
v_pk_fma_f16 v148, v149, v149, s48
v_pk_mul_f16 v154, v155, v154
v_bfe_u32 v136, v137, 2, 14
v_pk_mul_f16 v151, v152, v151
v_pk_mul_f16 v148, v149, v148
v_bfe_u32 v138, v139, 2, 14
ds_read_b128 v[228:231], v250 offset:65520
ds_read_u16_d16 v136, v136
ds_read_u16_d16 v138, v138
v_mfma_f32_32x32x16_bf16 v[120:135], v[76:79], v[232:235], v[120:135]
v_exp_f16 v153, v154
v_lshrrev_b32 v137, 18, v137
v_exp_f16 v150, v151
v_lshrrev_b32 v139, 18, v139
v_exp_f16 v147, v148
v_and_b32 v141, s49, v141
v_and_b32_e64 v143, s49, v143
ds_read_b128 v[232:235], v248 offset:34816
ds_read_u16_d16_hi v137, v137
ds_read_b32 v247, v253 offset:12
ds_read_u16_d16_hi v139, v139
v_mfma_f32_32x32x16_bf16 v[120:135], v[80:83], v[236:239], v[120:135]
v_exp_f16_sdwa v153, v154 dst_sel:WORD_1 dst_unused:UNUSED_PRESERVE src0_sel:WORD_1
v_bfe_u32 v140, v141, 2, 14
v_exp_f16_sdwa v150, v151 dst_sel:WORD_1 dst_unused:UNUSED_PRESERVE src0_sel:WORD_1
v_bfe_u32 v142, v143, 2, 14
v_exp_f16_sdwa v147, v148 dst_sel:WORD_1 dst_unused:UNUSED_PRESERVE src0_sel:WORD_1
v_lshrrev_b32_e64 v141, 18, v141
v_pk_add_f16 v153, v153, 1.0 op_sel_hi:[1,0]
ds_read_b128 v[236:239], v248 offset:37888
ds_read_u16_d16 v140, v140
ds_read_u16_d16 v142, v142
ds_read_u16_d16_hi v141, v141
v_mfma_f32_32x32x16_bf16 v[120:135], v[84:87], v[216:219], v[120:135]
v_lshrrev_b32_e64 v143, 18, v143
v_pk_add_f16 v150, v150, 1.0 op_sel_hi:[1,0]
v_pk_add_f16 v147, v147, 1.0 op_sel_hi:[1,0]
v_and_b32 v145, s49, v145
v_rcp_f16 v154, v153
v_bfe_u32 v144, v145, 2, 14
ds_read_u16_d16_hi v143, v143
ds_read_u16_d16 v144, v144
s_waitcnt lgkmcnt(7)
v_readfirstlane_b32 s43, v247
s_nop 1
s_cmp_ge_u32 s43, 24
s_cbranch_scc1 Lev5
Lev5w:
s_sleep 1
ds_read_b32 v247, v253 offset:12
s_waitcnt lgkmcnt(0)
v_readfirstlane_b32 s43, v247
s_cmp_eq_u32 s76, 0
s_cbranch_scc1 Lev5
s_sub_u32 s76, s76, 1
s_cmp_lt_u32 s43, 24
s_cbranch_scc1 Lev5w
Lev5:
v_rcp_f16 v151, v150
v_lshrrev_b32_e64 v145, 18, v145
ds_read_b128 v[216:219], v248 offset:35840
ds_read_u16_d16_hi v145, v145
v_mfma_f32_32x32x16_bf16 v[120:135], v[88:91], v[220:223], v[120:135]
v_rcp_f16 v148, v147
v_rcp_f16_sdwa v154, v153 dst_sel:WORD_1 dst_unused:UNUSED_PRESERVE src0_sel:WORD_1
v_fma_mix_f32 v157, v136, v136, v157 op_sel:[0,0,0] op_sel_hi:[1,1,0]
v_fma_mix_f32 v157, v137, v137, v157 op_sel:[1,1,0] op_sel_hi:[1,1,0]
v_rcp_f16_sdwa v151, v150 dst_sel:WORD_1 dst_unused:UNUSED_PRESERVE src0_sel:WORD_1
v_fma_mix_f32 v157, v138, v138, v157 op_sel:[0,0,0] op_sel_hi:[1,1,0]
ds_read_b128 v[220:223], v245
ds_read_b128 v[192:195], v242
ds_read_b128 v[196:199], v242 offset:64
v_mfma_f32_32x32x16_bf16 v[120:135], v[92:95], v[224:227], v[120:135]
v_rcp_f16_sdwa v148, v147 dst_sel:WORD_1 dst_unused:UNUSED_PRESERVE src0_sel:WORD_1
s_waitcnt lgkmcnt(5)
v_fma_mix_f32 v157, v139, v139, v157 op_sel:[1,1,0] op_sel_hi:[1,1,0]
v_pk_mul_f16 v155, v155, v154
v_fma_mix_f32 v157, v140, v140, v157 op_sel:[0,0,0] op_sel_hi:[1,1,0]
v_pk_mul_f16 v152, v152, v151
v_fma_mix_f32 v157, v141, v141, v157 op_sel:[1,1,0] op_sel_hi:[1,1,0]
v_pk_mul_f16 v149, v149, v148
v_fma_mix_f32 v157, v155, v155, v157 op_sel:[0,0,0] op_sel_hi:[1,1,0]
v_fma_mix_f32 v157, v142, v142, v157 op_sel:[0,0,0] op_sel_hi:[1,1,0]
v_fma_mix_f32 v157, v155, v155, v157 op_sel:[1,1,0] op_sel_hi:[1,1,0]
v_fma_mix_f32 v157, v143, v143, v157 op_sel:[1,1,0] op_sel_hi:[1,1,0]
v_fma_mix_f32 v157, v152, v152, v157 op_sel:[0,0,0] op_sel_hi:[1,1,0]
v_fma_mix_f32 v157, v152, v152, v157 op_sel:[1,1,0] op_sel_hi:[1,1,0]
v_fma_mix_f32 v157, v144, v144, v157 op_sel:[0,0,0] op_sel_hi:[1,1,0]
v_fma_mix_f32 v157, v149, v149, v157 op_sel:[0,0,0] op_sel_hi:[1,1,0]
s_waitcnt lgkmcnt(3)
v_fma_mix_f32 v157, v145, v145, v157 op_sel:[1,1,0] op_sel_hi:[1,1,0]
v_fma_mix_f32 v157, v149, v149, v157 op_sel:[1,1,0] op_sel_hi:[1,1,0]
s_setprio 1
v_mfma_f32_32x32x16_bf16 v[0:15], v[228:231], v[228:231], 0
s_add_u32 s46, s80, 14680064
buffer_store_dwordx4 v[76:79], v241, s[32:35], s46 offen sc1
ds_read_b128 v[224:227], v248 offset:38912
v_cvt_pkrtz_f16_f32 v137, v120, v121
v_cvt_pkrtz_f16_f32 v139, v122, v123
v_cvt_pkrtz_f16_f32 v141, v124, v125
v_cvt_pkrtz_f16_f32 v143, v126, v127
v_mfma_f32_32x32x16_bf16 v[16:31], v[228:231], v[228:231], 0
v_cvt_pk_f16_f32 v155, v128, v129
v_cvt_pk_f16_f32 v152, v130, v131
v_cvt_pk_f16_f32 v149, v132, v133
v_cvt_pk_f16_f32 v146, v134, v135
v_mfma_f32_32x32x16_bf16 v[32:47], v[228:231], v[228:231], 0
v_pk_fma_f16 v154, v155, v155, s48
v_and_b32_e64 v137, s49, v137
v_pk_fma_f16 v151, v152, v152, s48
v_pk_fma_f16 v148, v149, v149, s48
v_mfma_f32_32x32x16_bf16 v[120:135], v[72:75], v[232:235], 0
ds_read_b128 v[228:231], v248 offset:36864
v_and_b32_e64 v139, s49, v139
v_pk_fma_f16 v145, v146, v146, s48
v_pk_mul_f16 v154, v155, v154
v_bfe_u32 v136, v137, 2, 14
v_pk_mul_f16 v151, v152, v151
v_pk_mul_f16 v148, v149, v148
v_bfe_u32 v138, v139, 2, 14
v_pk_mul_f16 v145, v146, v145
v_mfma_f32_32x32x16_bf16 v[120:135], v[76:79], v[236:239], v[120:135]
ds_read_b128 v[232:235], v245 offset:384
ds_read_b128 v[200:203], v242 offset:128
ds_read_b128 v[204:207], v243
ds_read_u16_d16 v136, v136
ds_read_u16_d16 v138, v138
v_exp_f16 v153, v154
v_lshrrev_b32 v137, 18, v137
v_exp_f16 v150, v151
v_lshrrev_b32 v139, 18, v139
v_exp_f16_e64 v147, v148
v_mfma_f32_32x32x16_bf16 v[120:135], v[80:83], v[216:219], v[120:135]
ds_read_b128 v[236:239], v248 offset:39936
ds_read_u16_d16_hi v137, v137
ds_read_u16_d16_hi v139, v139
v_and_b32 v141, s49, v141
v_exp_f16 v144, v145
v_and_b32 v143, s49, v143
v_exp_f16_sdwa v153, v154 dst_sel:WORD_1 dst_unused:UNUSED_PRESERVE src0_sel:WORD_1
v_bfe_u32 v140, v141, 2, 14
s_waitcnt lgkmcnt(8)
v_smfmac_f32_16x16x32_bf16 v[0:3], v[220:221], v[192:195], v246
ds_read_b128 v[216:219], v245 offset:768
ds_read_b128 v[208:211], v243 offset:64
ds_read_b128 v[212:215], v243 offset:128
ds_read_u16_d16 v140, v140
v_exp_f16_sdwa v150, v151 dst_sel:WORD_1 dst_unused:UNUSED_PRESERVE src0_sel:WORD_1
v_bfe_u32 v142, v143, 2, 14
v_exp_f16_sdwa v147, v148 dst_sel:WORD_1 dst_unused:UNUSED_PRESERVE src0_sel:WORD_1
v_smfmac_f32_16x16x32_bf16 v[16:19], v[222:223], v[196:199], v246
v_lshrrev_b32_e64 v141, 18, v141
v_exp_f16_sdwa v144, v145 dst_sel:WORD_1 dst_unused:UNUSED_PRESERVE src0_sel:WORD_1
v_lshrrev_b32_e64 v143, 18, v143
v_mfma_f32_32x32x16_bf16 v[120:135], v[84:87], v[224:227], v[120:135]
ds_read_b128 v[220:223], v245 offset:1152
ds_read_b128 v[192:195], v244
ds_read_b128 v[196:199], v244 offset:64
ds_read_u16_d16 v142, v142
ds_read_u16_d16_hi v141, v141
ds_read_u16_d16_hi v143, v143
v_pk_add_f16 v153, v153, 1.0 op_sel_hi:[1,0]
v_pk_add_f16 v150, v150, 1.0 op_sel_hi:[1,0]
v_pk_add_f16 v147, v147, 1.0 op_sel_hi:[1,0]
v_pk_add_f16 v144, v144, 1.0 op_sel_hi:[1,0]
v_rcp_f16 v154, v153
v_rcp_f16 v151, v150
v_mfma_f32_32x32x16_bf16 v[120:135], v[88:91], v[228:231], v[120:135]
ds_read_b128 v[224:227], v248 offset:40960
v_rcp_f16 v148, v147
v_rcp_f16 v145, v144
v_rcp_f16_sdwa v154, v153 dst_sel:WORD_1 dst_unused:UNUSED_PRESERVE src0_sel:WORD_1
v_rcp_f16_sdwa v151, v150 dst_sel:WORD_1 dst_unused:UNUSED_PRESERVE src0_sel:WORD_1
s_setprio 0
s_waitcnt lgkmcnt(7)
v_smfmac_f32_16x16x32_bf16 v[32:35], v[232:233], v[200:203], v246
ds_read_b128 v[228:231], v248 offset:44032
v_rcp_f16_sdwa v148, v147 dst_sel:WORD_1 dst_unused:UNUSED_PRESERVE src0_sel:WORD_1
v_fma_mix_f32 v158, v136, v136, v158 op_sel:[0,0,0] op_sel_hi:[1,1,0]
v_smfmac_f32_16x16x32_bf16 v[0:3], v[234:235], v[204:207], v246
v_rcp_f16_sdwa v145, v144 dst_sel:WORD_1 dst_unused:UNUSED_PRESERVE src0_sel:WORD_1
v_fma_mix_f32 v158, v137, v137, v158 op_sel:[1,1,0] op_sel_hi:[1,1,0]
v_pk_mul_f16 v155, v155, v154
v_fma_mix_f32 v158, v138, v138, v158 op_sel:[0,0,0] op_sel_hi:[1,1,0]
v_mfma_f32_32x32x16_bf16 v[120:135], v[92:95], v[236:239], v[120:135]
ds_read_b128 v[232:235], v248 offset:41984
v_pk_mul_f16 v152, v152, v151
v_pk_mul_f16 v149, v149, v148
v_fma_mix_f32 v158, v139, v139, v158 op_sel:[1,1,0] op_sel_hi:[1,1,0]
v_pk_mul_f16 v146, v146, v145
v_fma_mix_f32 v158, v155, v155, v158 op_sel:[0,0,0] op_sel_hi:[1,1,0]
v_fma_mix_f32 v158, v140, v140, v158 op_sel:[0,0,0] op_sel_hi:[1,1,0]
v_fma_mix_f32 v158, v155, v155, v158 op_sel:[1,1,0] op_sel_hi:[1,1,0]
v_fma_mix_f32 v158, v152, v152, v158 op_sel:[0,0,0] op_sel_hi:[1,1,0]
v_smfmac_f32_16x16x32_bf16 v[16:19], v[216:217], v[208:211], v246
ds_read_b128 v[236:239], v248 offset:45056
s_waitcnt lgkmcnt(3)
v_fma_mix_f32 v158, v141, v141, v158 op_sel:[1,1,0] op_sel_hi:[1,1,0]
v_fma_mix_f32 v158, v152, v152, v158 op_sel:[1,1,0] op_sel_hi:[1,1,0]
v_fma_mix_f32 v158, v149, v149, v158 op_sel:[0,0,0] op_sel_hi:[1,1,0]
v_fma_mix_f32 v158, v142, v142, v158 op_sel:[0,0,0] op_sel_hi:[1,1,0]
v_smfmac_f32_16x16x32_bf16 v[32:35], v[218:219], v[212:215], v246
v_fma_mix_f32 v158, v149, v149, v158 op_sel:[1,1,0] op_sel_hi:[1,1,0]
v_fma_mix_f32 v158, v146, v146, v158 op_sel:[0,0,0] op_sel_hi:[1,1,0]
v_fma_mix_f32 v158, v143, v143, v158 op_sel:[1,1,0] op_sel_hi:[1,1,0]
v_fma_mix_f32 v158, v146, v146, v158 op_sel:[1,1,0] op_sel_hi:[1,1,0]
s_setprio 2
v_smfmac_f32_16x16x32_bf16 v[0:3], v[220:221], v[192:195], v246
s_add_u32 s46, s80, 16777216
buffer_store_dwordx4 v[80:83], v241, s[32:35], s46 offen sc1
ds_read_b128 v[216:219], v248 offset:43008
v_cvt_pkrtz_f16_f32 v137, v120, v121
v_cvt_pkrtz_f16_f32 v139, v122, v123
v_cvt_pkrtz_f16_f32 v141, v124, v125
v_cvt_pkrtz_f16_f32 v143, v126, v127
v_smfmac_f32_16x16x32_bf16 v[16:19], v[222:223], v[196:199], v246
v_cvt_pkrtz_f16_f32 v145, v128, v129
v_cvt_pk_f16_f32 v155, v130, v131
v_cvt_pk_f16_f32 v152, v132, v133
v_cvt_pk_f16_f32 v149, v134, v135
v_mfma_f32_32x32x16_bf16 v[120:135], v[72:75], v[224:227], 0
ds_read_b128 v[220:223], v245 offset:1536
ds_read_b128 v[200:203], v244 offset:128
v_xor_b32 v242, 16, v242
ds_read_b128 v[204:207], v242
v_pk_fma_f16 v154, v155, v155, s48
v_and_b32 v137, s49, v137
v_pk_fma_f16 v151, v152, v152, s48
v_and_b32 v139, s49, v139
v_pk_fma_f16 v148, v149, v149, s48
v_pk_mul_f16 v154, v155, v154
v_bfe_u32 v136, v137, 2, 14
v_pk_mul_f16 v151, v152, v151
s_waitcnt lgkmcnt(4)
v_mfma_f32_32x32x16_bf16 v[120:135], v[76:79], v[228:231], v[120:135]
ds_read_b128 v[224:227], v248 offset:46080
ds_read_u16_d16 v136, v136
v_pk_mul_f16 v148, v149, v148
v_bfe_u32 v138, v139, 2, 14
v_exp_f16 v153, v154
v_lshrrev_b32 v137, 18, v137
v_exp_f16 v150, v151
v_lshrrev_b32 v139, 18, v139
v_mfma_f32_32x32x16_bf16 v[120:135], v[80:83], v[232:235], v[120:135]
ds_read_b128 v[228:231], v245 offset:1920
ds_read_b128 v[208:211], v242 offset:64
ds_read_b128 v[212:215], v242 offset:128
ds_read_u16_d16 v138, v138
ds_read_u16_d16_hi v137, v137
ds_read_u16_d16_hi v139, v139
v_exp_f16 v147, v148
v_and_b32 v141, s49, v141
v_and_b32 v143, s49, v143
v_exp_f16_sdwa v153, v154 dst_sel:WORD_1 dst_unused:UNUSED_PRESERVE src0_sel:WORD_1
v_bfe_u32 v140, v141, 2, 14
v_exp_f16_sdwa v150, v151 dst_sel:WORD_1 dst_unused:UNUSED_PRESERVE src0_sel:WORD_1
v_mfma_f32_32x32x16_bf16 v[120:135], v[84:87], v[236:239], v[120:135]
ds_read_b128 v[232:235], v245 offset:2304
v_xor_b32 v243, 16, v243
ds_read_b128 v[192:195], v243
ds_read_b128 v[196:199], v243 offset:64
ds_read_u16_d16 v140, v140
v_bfe_u32 v142, v143, 2, 14
v_exp_f16_sdwa v147, v148 dst_sel:WORD_1 dst_unused:UNUSED_PRESERVE src0_sel:WORD_1
v_lshrrev_b32_e64 v141, 18, v141
v_pk_add_f16 v153, v153, 1.0 op_sel_hi:[1,0]
v_lshrrev_b32 v143, 18, v143
v_pk_add_f16 v150, v150, 1.0 op_sel_hi:[1,0]
v_pk_add_f16 v147, v147, 1.0 op_sel_hi:[1,0]
s_waitcnt lgkmcnt(9)
v_mfma_f32_32x32x16_bf16 v[120:135], v[88:91], v[216:219], v[120:135]
ds_read_b128 v[236:239], v248 offset:47104
ds_read_u16_d16 v142, v142
ds_read_u16_d16_hi v141, v141
ds_read_u16_d16_hi v143, v143
v_and_b32 v145, s49, v145
v_rcp_f16 v154, v153
v_bfe_u32 v144, v145, 2, 14
v_rcp_f16 v151, v150
v_lshrrev_b32 v145, 18, v145
v_rcp_f16_e64 v148, v147
v_smfmac_f32_16x16x32_bf16 v[32:35], v[220:221], v[200:203], v246
ds_read_b128 v[216:219], v248 offset:50176
ds_read_u16_d16 v144, v144
ds_read_u16_d16_hi v145, v145
v_rcp_f16_sdwa v154, v153 dst_sel:WORD_1 dst_unused:UNUSED_PRESERVE src0_sel:WORD_1
v_fma_mix_f32 v159, v136, v136, v159 op_sel:[0,0,0] op_sel_hi:[1,1,0]
s_waitcnt lgkmcnt(7)
v_fma_mix_f32 v159, v137, v137, v159 op_sel:[1,1,0] op_sel_hi:[1,1,0]
v_smfmac_f32_16x16x32_bf16 v[4:7], v[222:223], v[204:207], v246
v_rcp_f16_sdwa v151, v150 dst_sel:WORD_1 dst_unused:UNUSED_PRESERVE src0_sel:WORD_1
v_fma_mix_f32 v159, v138, v138, v159 op_sel:[0,0,0] op_sel_hi:[1,1,0]
v_mfma_f32_32x32x16_bf16 v[120:135], v[92:95], v[224:227], v[120:135]
ds_read_b128 v[220:223], v248 offset:48128
v_rcp_f16_sdwa v148, v147 dst_sel:WORD_1 dst_unused:UNUSED_PRESERVE src0_sel:WORD_1
v_fma_mix_f32 v159, v139, v139, v159 op_sel:[1,1,0] op_sel_hi:[1,1,0]
v_pk_mul_f16 v155, v155, v154
v_fma_mix_f32 v159, v140, v140, v159 op_sel:[0,0,0] op_sel_hi:[1,1,0]
v_pk_mul_f16 v152, v152, v151
s_waitcnt lgkmcnt(4)
v_fma_mix_f32 v159, v141, v141, v159 op_sel:[1,1,0] op_sel_hi:[1,1,0]
v_pk_mul_f16 v149, v149, v148
v_fma_mix_f32 v159, v155, v155, v159 op_sel:[0,0,0] op_sel_hi:[1,1,0]
v_smfmac_f32_16x16x32_bf16 v[20:23], v[228:229], v[208:211], v246
ds_read_b128 v[224:227], v248 offset:51200
v_fma_mix_f32 v159, v142, v142, v159 op_sel:[0,0,0] op_sel_hi:[1,1,0]
v_fma_mix_f32 v159, v155, v155, v159 op_sel:[1,1,0] op_sel_hi:[1,1,0]
v_fma_mix_f32 v159, v143, v143, v159 op_sel:[1,1,0] op_sel_hi:[1,1,0]
v_fma_mix_f32 v159, v152, v152, v159 op_sel:[0,0,0] op_sel_hi:[1,1,0]
v_smfmac_f32_16x16x32_bf16 v[36:39], v[230:231], v[212:215], v246
v_fma_mix_f32 v159, v152, v152, v159 op_sel:[1,1,0] op_sel_hi:[1,1,0]
s_waitcnt lgkmcnt(2)
v_fma_mix_f32 v159, v144, v144, v159 op_sel:[0,0,0] op_sel_hi:[1,1,0]
v_fma_mix_f32 v159, v149, v149, v159 op_sel:[0,0,0] op_sel_hi:[1,1,0]
v_fma_mix_f32 v159, v145, v145, v159 op_sel:[1,1,0] op_sel_hi:[1,1,0]
v_fma_mix_f32 v159, v149, v149, v159 op_sel:[1,1,0] op_sel_hi:[1,1,0]
s_setprio 1
v_smfmac_f32_16x16x32_bf16 v[4:7], v[232:233], v[192:195], v246
s_add_u32 s46, s80, 18874368
buffer_store_dwordx4 v[84:87], v241, s[32:35], s46 offen sc1
ds_read_b128 v[228:231], v248 offset:49152
v_cvt_pkrtz_f16_f32 v137, v120, v121
v_cvt_pkrtz_f16_f32 v139, v122, v123
v_cvt_pkrtz_f16_f32 v141, v124, v125
v_cvt_pkrtz_f16_f32 v143, v126, v127
v_cvt_pk_f16_f32 v155, v128, v129
v_smfmac_f32_16x16x32_bf16 v[20:23], v[234:235], v[196:199], v246
v_cvt_pk_f16_f32 v152, v130, v131
v_cvt_pk_f16_f32 v149, v132, v133
v_cvt_pk_f16_f32 v146, v134, v135
v_pk_fma_f16 v154, v155, v155, s48
v_and_b32_e64 v137, s49, v137
v_mfma_f32_32x32x16_bf16 v[120:135], v[72:75], v[236:239], 0
ds_read_b128 v[232:235], v248 offset:52224
v_pk_fma_f16 v151, v152, v152, s48
v_pk_fma_f16 v148, v149, v149, s48
v_and_b32_e64 v139, s49, v139
v_pk_fma_f16 v145, v146, v146, s48
v_pk_mul_f16 v154, v155, v154
v_bfe_u32 v136, v137, 2, 14
v_pk_mul_f16 v151, v152, v151
v_pk_mul_f16 v148, v149, v148
v_bfe_u32 v138, v139, 2, 14
v_pk_mul_f16 v145, v146, v145
v_mfma_f32_32x32x16_bf16 v[120:135], v[76:79], v[216:219], v[120:135]
ds_read_b128 v[236:239], v245 offset:2688
ds_read_b128 v[200:203], v243 offset:128
v_xor_b32 v244, 16, v244
ds_read_b128 v[204:207], v244
ds_read_u16_d16 v136, v136
ds_read_u16_d16 v138, v138
v_exp_f16 v153, v154
v_lshrrev_b32 v137, 18, v137
v_exp_f16 v150, v151
v_lshrrev_b32 v139, 18, v139
v_exp_f16 v147, v148
v_and_b32_e64 v141, s49, v141
v_exp_f16 v144, v145
s_waitcnt lgkmcnt(5)
v_mfma_f32_32x32x16_bf16 v[120:135], v[80:83], v[220:223], v[120:135]
ds_read_b128 v[216:219], v245 offset:3072
ds_read_b128 v[208:211], v244 offset:64
ds_read_b128 v[212:215], v244 offset:128
ds_read_u16_d16_hi v137, v137
ds_read_u16_d16_hi v139, v139
v_and_b32_e64 v143, s49, v143
v_exp_f16_sdwa v153, v154 dst_sel:WORD_1 dst_unused:UNUSED_PRESERVE src0_sel:WORD_1
v_bfe_u32 v140, v141, 2, 14
v_exp_f16_sdwa v150, v151 dst_sel:WORD_1 dst_unused:UNUSED_PRESERVE src0_sel:WORD_1
v_bfe_u32 v142, v143, 2, 14
v_exp_f16_sdwa v147, v148 dst_sel:WORD_1 dst_unused:UNUSED_PRESERVE src0_sel:WORD_1
v_lshrrev_b32_e64 v141, 18, v141
v_mfma_f32_32x32x16_bf16 v[120:135], v[84:87], v[224:227], v[120:135]
ds_read_b128 v[220:223], v248 offset:53248
ds_read_u16_d16 v140, v140
ds_read_u16_d16 v142, v142
ds_read_u16_d16_hi v141, v141
v_exp_f16_sdwa v144, v145 dst_sel:WORD_1 dst_unused:UNUSED_PRESERVE src0_sel:WORD_1
v_lshrrev_b32_e64 v143, 18, v143
v_pk_add_f16 v153, v153, 1.0 op_sel_hi:[1,0]
v_pk_add_f16 v150, v150, 1.0 op_sel_hi:[1,0]
v_pk_add_f16 v147, v147, 1.0 op_sel_hi:[1,0]
v_pk_add_f16 v144, v144, 1.0 op_sel_hi:[1,0]
v_rcp_f16 v154, v153
v_rcp_f16 v151, v150
v_mfma_f32_32x32x16_bf16 v[120:135], v[88:91], v[228:231], v[120:135]
ds_read_b128 v[224:227], v248 offset:56320
ds_read_u16_d16_hi v143, v143
v_rcp_f16 v148, v147
v_rcp_f16 v145, v144
v_rcp_f16_sdwa v154, v153 dst_sel:WORD_1 dst_unused:UNUSED_PRESERVE src0_sel:WORD_1
v_rcp_f16_sdwa v151, v150 dst_sel:WORD_1 dst_unused:UNUSED_PRESERVE src0_sel:WORD_1
s_setprio 0
v_rcp_f16_sdwa v148, v147 dst_sel:WORD_1 dst_unused:UNUSED_PRESERVE src0_sel:WORD_1
s_waitcnt lgkmcnt(6)
v_fma_mix_f32 v160, v136, v136, v160 op_sel:[0,0,0] op_sel_hi:[1,1,0]
v_mfma_f32_32x32x16_bf16 v[120:135], v[92:95], v[232:235], v[120:135]
ds_read_b128 v[228:231], v248 offset:54272
v_rcp_f16_sdwa v145, v144 dst_sel:WORD_1 dst_unused:UNUSED_PRESERVE src0_sel:WORD_1
v_fma_mix_f32 v160, v137, v137, v160 op_sel:[1,1,0] op_sel_hi:[1,1,0]
v_pk_mul_f16 v155, v155, v154
v_fma_mix_f32 v160, v138, v138, v160 op_sel:[0,0,0] op_sel_hi:[1,1,0]
v_pk_mul_f16 v152, v152, v151
v_pk_mul_f16 v149, v149, v148
v_fma_mix_f32 v160, v139, v139, v160 op_sel:[1,1,0] op_sel_hi:[1,1,0]
v_pk_mul_f16 v146, v146, v145
v_fma_mix_f32 v160, v155, v155, v160 op_sel:[0,0,0] op_sel_hi:[1,1,0]
v_smfmac_f32_16x16x32_bf16 v[36:39], v[236:237], v[200:203], v246
ds_read_b128 v[232:235], v248 offset:57344
s_waitcnt lgkmcnt(4)
v_fma_mix_f32 v160, v140, v140, v160 op_sel:[0,0,0] op_sel_hi:[1,1,0]
v_fma_mix_f32 v160, v155, v155, v160 op_sel:[1,1,0] op_sel_hi:[1,1,0]
v_fma_mix_f32 v160, v152, v152, v160 op_sel:[0,0,0] op_sel_hi:[1,1,0]
v_fma_mix_f32 v160, v141, v141, v160 op_sel:[1,1,0] op_sel_hi:[1,1,0]
v_fma_mix_f32 v160, v152, v152, v160 op_sel:[1,1,0] op_sel_hi:[1,1,0]
v_smfmac_f32_16x16x32_bf16 v[4:7], v[238:239], v[204:207], v246
v_fma_mix_f32 v160, v149, v149, v160 op_sel:[0,0,0] op_sel_hi:[1,1,0]
v_fma_mix_f32 v160, v142, v142, v160 op_sel:[0,0,0] op_sel_hi:[1,1,0]
v_fma_mix_f32 v160, v149, v149, v160 op_sel:[1,1,0] op_sel_hi:[1,1,0]
v_fma_mix_f32 v160, v146, v146, v160 op_sel:[0,0,0] op_sel_hi:[1,1,0]
s_waitcnt lgkmcnt(2)
v_fma_mix_f32 v160, v143, v143, v160 op_sel:[1,1,0] op_sel_hi:[1,1,0]
v_fma_mix_f32 v160, v146, v146, v160 op_sel:[1,1,0] op_sel_hi:[1,1,0]
s_cmp_lg_u32 s40, 7
s_cbranch_scc1 Lnobias2
s_sub_u32 s43, s2, 96
s_cmp_lt_u32 s43, 96
s_cbranch_scc0 Lnobias2
s_waitcnt vmcnt(17)
v_lshlrev_b32 v178, 16, v178
v_lshlrev_b32 v179, 16, v179
v_lshlrev_b32 v180, 16, v180
v_lshlrev_b32 v181, 16, v181
v_lshlrev_b32 v182, 16, v182
v_lshlrev_b32 v183, 16, v183
v_lshlrev_b32 v184, 16, v184
v_lshlrev_b32 v185, 16, v185
v_lshlrev_b32 v186, 16, v186
v_lshlrev_b32 v187, 16, v187
v_lshlrev_b32 v188, 16, v188
v_lshlrev_b32 v189, 16, v189
v_mul_f32 v176, v178, v184
v_fmac_f32 v176, v179, v185
v_fmac_f32 v176, v180, v186
v_fmac_f32 v176, v181, v187
v_fmac_f32 v176, v182, v188
v_fmac_f32 v176, v183, v189
s_nop 1
v_add_f32_dpp v176, v176, v176 row_ror:8 row_mask:0xf bank_mask:0xf
s_nop 1
v_add_f32_dpp v176, v176, v176 row_ror:4 row_mask:0xf bank_mask:0xf
s_nop 1
v_add_f32_dpp v176, v176, v176 row_ror:2 row_mask:0xf bank_mask:0xf
s_nop 1
v_add_f32_dpp v176, v176, v176 row_ror:1 row_mask:0xf bank_mask:0xf
v_mov_b32 v177, v176
s_nop 1
v_permlane16_swap_b32 v176, v177
v_add_f32 v176, v176, v177
v_mov_b32_e64 v177, v176
s_nop 1
v_permlane32_swap_b32 v176, v177
v_add_f32 v176, v176, v177
s_lshl_b32 s44, s43, 2
s_add_u32 s44, s44, 394752
v_lshlrev_b32_e64 v191, 11, v251
s_mov_b64 exec, 0xff
buffer_store_dword v176, v191, s[32:35], s44 offen sc1
s_mov_b64 exec, -1
Lnobias2:
v_lshlrev_b32 v252, 7, v251
s_add_u32 s46, s47, 2359296
s_mov_b32 exec_lo, 131071
s_mov_b32 exec_hi, 0
s_mov_b32 m0, 16288
s_nop 0
buffer_load_dword v252, s[4:7], s46 offen lds
s_mov_b64 exec, -1
s_setprio 2
v_smfmac_f32_16x16x32_bf16 v[20:23], v[216:217], v[208:211], v246
s_add_u32 s46, s80, 20971520
buffer_store_dwordx4 v[88:91], v241, s[32:35], s46 offen sc1
ds_read_b128 v[236:239], v248 offset:55296
v_cvt_pkrtz_f16_f32 v137, v120, v121
v_cvt_pkrtz_f16_f32 v139, v122, v123
v_cvt_pkrtz_f16_f32 v141, v124, v125
v_cvt_pkrtz_f16_f32 v143, v126, v127
v_smfmac_f32_16x16x32_bf16 v[36:39], v[218:219], v[212:215], v246
v_cvt_pkrtz_f16_f32 v145, v128, v129
v_cvt_pk_f16_f32 v155, v130, v131
v_cvt_pk_f16_f32 v152, v132, v133
v_cvt_pk_f16_f32 v149, v134, v135
v_mfma_f32_32x32x16_bf16 v[120:135], v[72:75], v[220:223], 0
ds_read_b128 v[216:219], v245 offset:3456
v_xor_b32 v242, 32, v242
ds_read_b128 v[192:195], v242
ds_read_b128 v[196:199], v242 offset:64
v_pk_fma_f16 v154, v155, v155, s48
v_and_b32 v137, s49, v137
v_pk_fma_f16 v151, v152, v152, s48
v_and_b32_e64 v139, s49, v139
v_pk_fma_f16 v148, v149, v149, s48
v_pk_mul_f16 v154, v155, v154
v_bfe_u32 v136, v137, 2, 14
v_pk_mul_f16 v151, v152, v151
v_mfma_f32_32x32x16_bf16 v[120:135], v[76:79], v[224:227], v[120:135]
ds_read_b128 v[220:223], v248 offset:58368
ds_read_u16_d16 v136, v136
v_pk_mul_f16 v148, v149, v148
v_bfe_u32 v138, v139, 2, 14
v_exp_f16 v153, v154
v_lshrrev_b32 v137, 18, v137
v_exp_f16 v150, v151
v_lshrrev_b32 v139, 18, v139
s_waitcnt lgkmcnt(5)
v_mfma_f32_32x32x16_bf16 v[120:135], v[80:83], v[228:231], v[120:135]
ds_read_b128 v[224:227], v245 offset:3840
ds_read_b128 v[200:203], v242 offset:128
v_xor_b32 v243, 32, v243
ds_read_b128 v[204:207], v243
ds_read_u16_d16 v138, v138
ds_read_u16_d16_hi v137, v137
ds_read_u16_d16_hi v139, v139
v_exp_f16 v147, v148
v_and_b32 v141, s49, v141
v_and_b32_e64 v143, s49, v143
v_exp_f16_sdwa v153, v154 dst_sel:WORD_1 dst_unused:UNUSED_PRESERVE src0_sel:WORD_1
v_bfe_u32 v140, v141, 2, 14
v_exp_f16_sdwa v150, v151 dst_sel:WORD_1 dst_unused:UNUSED_PRESERVE src0_sel:WORD_1
v_mfma_f32_32x32x16_bf16 v[120:135], v[84:87], v[232:235], v[120:135]
ds_read_b128 v[228:231], v245 offset:4224
ds_read_b128 v[208:211], v243 offset:64
ds_read_b128 v[212:215], v243 offset:128
ds_read_u16_d16 v140, v140
v_bfe_u32 v142, v143, 2, 14
v_exp_f16_sdwa v147, v148 dst_sel:WORD_1 dst_unused:UNUSED_PRESERVE src0_sel:WORD_1
v_lshrrev_b32_e64 v141, 18, v141
v_pk_add_f16 v153, v153, 1.0 op_sel_hi:[1,0]
v_lshrrev_b32_e64 v143, 18, v143
v_pk_add_f16 v150, v150, 1.0 op_sel_hi:[1,0]
v_pk_add_f16 v147, v147, 1.0 op_sel_hi:[1,0]
v_mfma_f32_32x32x16_bf16 v[120:135], v[88:91], v[236:239], v[120:135]
ds_read_b128 v[232:235], v248 offset:59392
ds_read_u16_d16 v142, v142
ds_read_u16_d16_hi v141, v141
ds_read_u16_d16_hi v143, v143
v_and_b32 v145, s49, v145
v_rcp_f16 v154, v153
v_bfe_u32 v144, v145, 2, 14
v_rcp_f16 v151, v150
v_lshrrev_b32 v145, 18, v145
v_rcp_f16 v148, v147
s_waitcnt lgkmcnt(8)
v_smfmac_f32_16x16x32_bf16 v[12:15], v[216:217], v[192:195], v246
ds_read_b128 v[236:239], v248 offset:62464
ds_read_u16_d16 v144, v144
ds_read_u16_d16_hi v145, v145
v_rcp_f16_sdwa v154, v153 dst_sel:WORD_1 dst_unused:UNUSED_PRESERVE src0_sel:WORD_1
v_fma_mix_f32 v161, v136, v136, v161 op_sel:[0,0,0] op_sel_hi:[1,1,0]
v_fma_mix_f32 v161, v137, v137, v161 op_sel:[1,1,0] op_sel_hi:[1,1,0]
v_smfmac_f32_16x16x32_bf16 v[28:31], v[218:219], v[196:199], v246
v_rcp_f16_sdwa v151, v150 dst_sel:WORD_1 dst_unused:UNUSED_PRESERVE src0_sel:WORD_1
v_fma_mix_f32 v161, v138, v138, v161 op_sel:[0,0,0] op_sel_hi:[1,1,0]
v_mfma_f32_32x32x16_bf16 v[120:135], v[92:95], v[220:223], v[120:135]
ds_read_b128 v[216:219], v248 offset:60416
v_rcp_f16_sdwa v148, v147 dst_sel:WORD_1 dst_unused:UNUSED_PRESERVE src0_sel:WORD_1
v_fma_mix_f32 v161, v139, v139, v161 op_sel:[1,1,0] op_sel_hi:[1,1,0]
v_pk_mul_f16 v155, v155, v154
s_waitcnt lgkmcnt(6)
v_fma_mix_f32 v161, v140, v140, v161 op_sel:[0,0,0] op_sel_hi:[1,1,0]
v_pk_mul_f16 v152, v152, v151
s_waitcnt lgkmcnt(4)
v_fma_mix_f32 v161, v141, v141, v161 op_sel:[1,1,0] op_sel_hi:[1,1,0]
v_pk_mul_f16 v149, v149, v148
v_fma_mix_f32 v161, v155, v155, v161 op_sel:[0,0,0] op_sel_hi:[1,1,0]
v_smfmac_f32_16x16x32_bf16 v[44:47], v[224:225], v[200:203], v246
ds_read_b128 v[220:223], v248 offset:63488
v_fma_mix_f32 v161, v142, v142, v161 op_sel:[0,0,0] op_sel_hi:[1,1,0]
v_fma_mix_f32 v161, v155, v155, v161 op_sel:[1,1,0] op_sel_hi:[1,1,0]
v_fma_mix_f32 v161, v143, v143, v161 op_sel:[1,1,0] op_sel_hi:[1,1,0]
v_fma_mix_f32 v161, v152, v152, v161 op_sel:[0,0,0] op_sel_hi:[1,1,0]
v_smfmac_f32_16x16x32_bf16 v[12:15], v[226:227], v[204:207], v246
v_fma_mix_f32 v161, v152, v152, v161 op_sel:[1,1,0] op_sel_hi:[1,1,0]
s_waitcnt lgkmcnt(2)
v_fma_mix_f32 v161, v144, v144, v161 op_sel:[0,0,0] op_sel_hi:[1,1,0]
v_fma_mix_f32 v161, v149, v149, v161 op_sel:[0,0,0] op_sel_hi:[1,1,0]
v_fma_mix_f32 v161, v145, v145, v161 op_sel:[1,1,0] op_sel_hi:[1,1,0]
v_fma_mix_f32 v161, v149, v149, v161 op_sel:[1,1,0] op_sel_hi:[1,1,0]
v_lshlrev_b32 v252, 7, v251
s_add_u32 s46, s47, 2359296
s_mov_b32 exec_lo, 4294836224
s_mov_b32 exec_hi, 3
s_mov_b32 m0, 16220
s_nop 0
buffer_load_dword v252, s[4:7], s46 offen lds
s_mov_b64 exec, -1
s_setprio 1
v_smfmac_f32_16x16x32_bf16 v[28:31], v[228:229], v[208:211], v246
s_add_u32 s46, s80, 23068672
buffer_store_dwordx4 v[92:95], v241, s[32:35], s46 offen sc1
ds_read_b128 v[224:227], v248 offset:61440
v_cvt_pkrtz_f16_f32 v137, v120, v121
v_cvt_pkrtz_f16_f32 v139, v122, v123
v_cvt_pkrtz_f16_f32 v141, v124, v125
v_cvt_pkrtz_f16_f32 v143, v126, v127
v_cvt_pk_f16_f32 v155, v128, v129
v_smfmac_f32_16x16x32_bf16 v[44:47], v[230:231], v[212:215], v246
v_cvt_pk_f16_f32 v152, v130, v131
v_cvt_pk_f16_f32 v149, v132, v133
v_cvt_pk_f16_f32 v146, v134, v135
v_pk_fma_f16 v154, v155, v155, s48
v_and_b32_e64 v137, s49, v137
v_mfma_f32_32x32x16_bf16 v[120:135], v[72:75], v[232:235], 0
ds_read_b128 v[228:231], v248 offset:64512
v_pk_fma_f16 v151, v152, v152, s48
v_pk_fma_f16 v148, v149, v149, s48
v_and_b32_e64 v139, s49, v139
v_pk_fma_f16 v145, v146, v146, s48
v_pk_mul_f16 v154, v155, v154
v_bfe_u32 v136, v137, 2, 14
v_pk_mul_f16 v151, v152, v151
v_pk_mul_f16 v148, v149, v148
v_bfe_u32 v138, v139, 2, 14
v_pk_mul_f16 v145, v146, v145
v_mfma_f32_32x32x16_bf16 v[120:135], v[76:79], v[236:239], v[120:135]
ds_read_b128 v[232:235], v245 offset:4608
v_xor_b32 v244, 32, v244
ds_read_b128 v[192:195], v244
ds_read_b128 v[196:199], v244 offset:64
ds_read_u16_d16 v136, v136
ds_read_u16_d16 v138, v138
v_exp_f16 v153, v154
v_lshrrev_b32 v137, 18, v137
v_exp_f16 v150, v151
v_lshrrev_b32 v139, 18, v139
v_exp_f16 v147, v148
v_and_b32 v141, s49, v141
v_exp_f16 v144, v145
s_waitcnt lgkmcnt(5)
v_mfma_f32_32x32x16_bf16 v[120:135], v[80:83], v[216:219], v[120:135]
ds_read_b128 v[236:239], v245 offset:4992
ds_read_b128 v[200:203], v244 offset:128
v_xor_b32 v242, 16, v242
ds_read_b128 v[204:207], v242
ds_read_u16_d16_hi v137, v137
ds_read_u16_d16_hi v139, v139
v_and_b32_e64 v143, s49, v143
v_exp_f16_sdwa v153, v154 dst_sel:WORD_1 dst_unused:UNUSED_PRESERVE src0_sel:WORD_1
v_bfe_u32 v140, v141, 2, 14
v_exp_f16_sdwa v150, v151 dst_sel:WORD_1 dst_unused:UNUSED_PRESERVE src0_sel:WORD_1
v_bfe_u32 v142, v143, 2, 14
v_exp_f16_sdwa v147, v148 dst_sel:WORD_1 dst_unused:UNUSED_PRESERVE src0_sel:WORD_1
v_lshrrev_b32_e64 v141, 18, v141
v_mfma_f32_32x32x16_bf16 v[120:135], v[84:87], v[220:223], v[120:135]
ds_read_b128 v[216:219], v249
ds_read_u16_d16 v140, v140
ds_read_u16_d16 v142, v142
ds_read_u16_d16_hi v141, v141
v_exp_f16_sdwa v144, v145 dst_sel:WORD_1 dst_unused:UNUSED_PRESERVE src0_sel:WORD_1
v_lshrrev_b32_e64 v143, 18, v143
v_pk_add_f16 v153, v153, 1.0 op_sel_hi:[1,0]
v_pk_add_f16 v150, v150, 1.0 op_sel_hi:[1,0]
v_pk_add_f16 v147, v147, 1.0 op_sel_hi:[1,0]
v_pk_add_f16 v144, v144, 1.0 op_sel_hi:[1,0]
v_rcp_f16 v154, v153
v_rcp_f16 v151, v150
v_mfma_f32_32x32x16_bf16 v[120:135], v[88:91], v[224:227], v[120:135]
ds_read_b128 v[220:223], v249 offset:3072
ds_read_u16_d16_hi v143, v143
v_rcp_f16 v148, v147
v_rcp_f16 v145, v144
v_rcp_f16_sdwa v154, v153 dst_sel:WORD_1 dst_unused:UNUSED_PRESERVE src0_sel:WORD_1
v_rcp_f16_sdwa v151, v150 dst_sel:WORD_1 dst_unused:UNUSED_PRESERVE src0_sel:WORD_1
s_setprio 0
v_rcp_f16_sdwa v148, v147 dst_sel:WORD_1 dst_unused:UNUSED_PRESERVE src0_sel:WORD_1
s_waitcnt lgkmcnt(6)
v_fma_mix_f32 v162, v136, v136, v162 op_sel:[0,0,0] op_sel_hi:[1,1,0]
v_mfma_f32_32x32x16_bf16 v[120:135], v[92:95], v[228:231], v[120:135]
ds_read_b128 v[224:227], v249 offset:1024
v_rcp_f16_sdwa v145, v144 dst_sel:WORD_1 dst_unused:UNUSED_PRESERVE src0_sel:WORD_1
v_fma_mix_f32 v162, v137, v137, v162 op_sel:[1,1,0] op_sel_hi:[1,1,0]
v_pk_mul_f16 v155, v155, v154
v_fma_mix_f32 v162, v138, v138, v162 op_sel:[0,0,0] op_sel_hi:[1,1,0]
v_pk_mul_f16 v152, v152, v151
v_pk_mul_f16 v149, v149, v148
v_fma_mix_f32 v162, v139, v139, v162 op_sel:[1,1,0] op_sel_hi:[1,1,0]
v_pk_mul_f16 v146, v146, v145
v_fma_mix_f32 v162, v155, v155, v162 op_sel:[0,0,0] op_sel_hi:[1,1,0]
v_smfmac_f32_16x16x32_bf16 v[12:15], v[232:233], v[192:195], v246
ds_read_b128 v[228:231], v249 offset:4096
s_waitcnt lgkmcnt(4)
v_fma_mix_f32 v162, v140, v140, v162 op_sel:[0,0,0] op_sel_hi:[1,1,0]
v_fma_mix_f32 v162, v155, v155, v162 op_sel:[1,1,0] op_sel_hi:[1,1,0]
v_fma_mix_f32 v162, v152, v152, v162 op_sel:[0,0,0] op_sel_hi:[1,1,0]
v_fma_mix_f32 v162, v141, v141, v162 op_sel:[1,1,0] op_sel_hi:[1,1,0]
v_fma_mix_f32 v162, v152, v152, v162 op_sel:[1,1,0] op_sel_hi:[1,1,0]
v_smfmac_f32_16x16x32_bf16 v[28:31], v[234:235], v[196:199], v246
v_fma_mix_f32 v162, v149, v149, v162 op_sel:[0,0,0] op_sel_hi:[1,1,0]
v_fma_mix_f32 v162, v142, v142, v162 op_sel:[0,0,0] op_sel_hi:[1,1,0]
v_fma_mix_f32 v162, v149, v149, v162 op_sel:[1,1,0] op_sel_hi:[1,1,0]
v_fma_mix_f32 v162, v146, v146, v162 op_sel:[0,0,0] op_sel_hi:[1,1,0]
s_waitcnt lgkmcnt(2)
v_fma_mix_f32 v162, v143, v143, v162 op_sel:[1,1,0] op_sel_hi:[1,1,0]
v_fma_mix_f32 v162, v146, v146, v162 op_sel:[1,1,0] op_sel_hi:[1,1,0]
v_lshlrev_b32_e64 v252, 7, v251
s_add_u32 s46, s47, 2359296
s_mov_b32 exec_lo, 0
s_mov_b32 exec_hi, 1048572
s_mov_b32 m0, 16152
s_nop 0
buffer_load_dword v252, s[4:7], s46 offen lds
s_mov_b64 exec, -1
s_setprio 2
v_smfmac_f32_16x16x32_bf16 v[44:47], v[236:237], v[200:203], v246
ds_read_b128 v[232:235], v249 offset:2048
v_cvt_pkrtz_f16_f32 v137, v120, v121
v_cvt_pkrtz_f16_f32 v139, v122, v123
v_cvt_pkrtz_f16_f32 v141, v124, v125
v_cvt_pkrtz_f16_f32 v143, v126, v127
v_smfmac_f32_16x16x32_bf16 v[8:11], v[238:239], v[204:207], v246
v_cvt_pkrtz_f16_f32 v145, v128, v129
v_cvt_pk_f16_f32 v155, v130, v131
v_cvt_pk_f16_f32 v152, v132, v133
v_cvt_pk_f16_f32 v149, v134, v135
v_mfma_f32_32x32x16_bf16 v[120:135], v[72:75], v[216:219], 0
ds_read_b128 v[236:239], v245 offset:5376
ds_read_b128 v[208:211], v242 offset:64
ds_read_b128 v[212:215], v242 offset:128
v_pk_fma_f16 v154, v155, v155, s48
v_and_b32_e64 v137, s49, v137
v_pk_fma_f16 v151, v152, v152, s48
v_and_b32_e64 v139, s49, v139
v_pk_fma_f16 v148, v149, v149, s48
v_pk_mul_f16 v154, v155, v154
v_bfe_u32 v136, v137, 2, 14
v_pk_mul_f16 v151, v152, v151
v_mfma_f32_32x32x16_bf16 v[120:135], v[76:79], v[220:223], v[120:135]
ds_read_b128 v[216:219], v249 offset:5120
ds_read_u16_d16 v136, v136
v_pk_mul_f16 v148, v149, v148
v_bfe_u32 v138, v139, 2, 14
v_exp_f16 v153, v154
v_lshrrev_b32 v137, 18, v137
v_exp_f16 v150, v151
v_lshrrev_b32 v139, 18, v139
s_waitcnt lgkmcnt(5)
v_mfma_f32_32x32x16_bf16 v[120:135], v[80:83], v[224:227], v[120:135]
ds_read_b128 v[220:223], v245 offset:5760
v_xor_b32 v243, 16, v243
ds_read_b128 v[192:195], v243
ds_read_b128 v[196:199], v243 offset:64
ds_read_u16_d16 v138, v138
ds_read_u16_d16_hi v137, v137
ds_read_u16_d16_hi v139, v139
v_exp_f16 v147, v148
v_and_b32 v141, s49, v141
v_and_b32_e64 v143, s49, v143
v_exp_f16_sdwa v153, v154 dst_sel:WORD_1 dst_unused:UNUSED_PRESERVE src0_sel:WORD_1
v_bfe_u32 v140, v141, 2, 14
v_exp_f16_sdwa v150, v151 dst_sel:WORD_1 dst_unused:UNUSED_PRESERVE src0_sel:WORD_1
v_mfma_f32_32x32x16_bf16 v[120:135], v[84:87], v[228:231], v[120:135]
ds_read_b128 v[224:227], v245 offset:6144
ds_read_b128 v[200:203], v243 offset:128
v_xor_b32 v244, 16, v244
ds_read_b128 v[204:207], v244
ds_read_u16_d16 v140, v140
v_bfe_u32 v142, v143, 2, 14
v_exp_f16_sdwa v147, v148 dst_sel:WORD_1 dst_unused:UNUSED_PRESERVE src0_sel:WORD_1
v_lshrrev_b32 v141, 18, v141
v_pk_add_f16 v153, v153, 1.0 op_sel_hi:[1,0]
v_lshrrev_b32_e64 v143, 18, v143
v_pk_add_f16 v150, v150, 1.0 op_sel_hi:[1,0]
v_pk_add_f16 v147, v147, 1.0 op_sel_hi:[1,0]
v_mfma_f32_32x32x16_bf16 v[120:135], v[88:91], v[232:235], v[120:135]
ds_read_b128 v[228:231], v249 offset:6144
ds_read_u16_d16 v142, v142
ds_read_u16_d16_hi v141, v141
ds_read_u16_d16_hi v143, v143
v_and_b32 v145, s49, v145
v_rcp_f16 v154, v153
v_bfe_u32 v144, v145, 2, 14
v_rcp_f16 v151, v150
v_lshrrev_b32 v145, 18, v145
v_rcp_f16 v148, v147
s_waitcnt lgkmcnt(8)
v_smfmac_f32_16x16x32_bf16 v[24:27], v[236:237], v[208:211], v246
ds_read_b128 v[232:235], v249 offset:9216
ds_read_u16_d16 v144, v144
ds_read_u16_d16_hi v145, v145
v_rcp_f16_sdwa v154, v153 dst_sel:WORD_1 dst_unused:UNUSED_PRESERVE src0_sel:WORD_1
v_fma_mix_f32 v163, v136, v136, v163 op_sel:[0,0,0] op_sel_hi:[1,1,0]
v_fma_mix_f32 v163, v137, v137, v163 op_sel:[1,1,0] op_sel_hi:[1,1,0]
v_smfmac_f32_16x16x32_bf16 v[40:43], v[238:239], v[212:215], v246
v_rcp_f16_sdwa v151, v150 dst_sel:WORD_1 dst_unused:UNUSED_PRESERVE src0_sel:WORD_1
v_fma_mix_f32 v163, v138, v138, v163 op_sel:[0,0,0] op_sel_hi:[1,1,0]
v_mfma_f32_32x32x16_bf16 v[120:135], v[92:95], v[216:219], v[120:135]
ds_read_b128 v[236:239], v249 offset:7168
v_rcp_f16_sdwa v148, v147 dst_sel:WORD_1 dst_unused:UNUSED_PRESERVE src0_sel:WORD_1
v_fma_mix_f32 v163, v139, v139, v163 op_sel:[1,1,0] op_sel_hi:[1,1,0]
v_pk_mul_f16 v155, v155, v154
s_waitcnt lgkmcnt(6)
v_fma_mix_f32 v163, v140, v140, v163 op_sel:[0,0,0] op_sel_hi:[1,1,0]
v_pk_mul_f16 v152, v152, v151
s_waitcnt lgkmcnt(4)
v_fma_mix_f32 v163, v141, v141, v163 op_sel:[1,1,0] op_sel_hi:[1,1,0]
v_pk_mul_f16 v149, v149, v148
v_fma_mix_f32 v163, v155, v155, v163 op_sel:[0,0,0] op_sel_hi:[1,1,0]
v_smfmac_f32_16x16x32_bf16 v[8:11], v[220:221], v[192:195], v246
ds_read_b128 v[216:219], v249 offset:10240
v_fma_mix_f32 v163, v142, v142, v163 op_sel:[0,0,0] op_sel_hi:[1,1,0]
v_fma_mix_f32 v163, v155, v155, v163 op_sel:[1,1,0] op_sel_hi:[1,1,0]
v_fma_mix_f32 v163, v143, v143, v163 op_sel:[1,1,0] op_sel_hi:[1,1,0]
v_fma_mix_f32 v163, v152, v152, v163 op_sel:[0,0,0] op_sel_hi:[1,1,0]
v_smfmac_f32_16x16x32_bf16 v[24:27], v[222:223], v[196:199], v246
v_fma_mix_f32 v163, v152, v152, v163 op_sel:[1,1,0] op_sel_hi:[1,1,0]
s_waitcnt lgkmcnt(2)
v_fma_mix_f32 v163, v144, v144, v163 op_sel:[0,0,0] op_sel_hi:[1,1,0]
v_fma_mix_f32 v163, v149, v149, v163 op_sel:[0,0,0] op_sel_hi:[1,1,0]
v_fma_mix_f32 v163, v145, v145, v163 op_sel:[1,1,0] op_sel_hi:[1,1,0]
v_fma_mix_f32 v163, v149, v149, v163 op_sel:[1,1,0] op_sel_hi:[1,1,0]
s_setprio 1
v_smfmac_f32_16x16x32_bf16 v[40:43], v[224:225], v[200:203], v246
ds_read_b128 v[220:223], v249 offset:8192
v_cvt_pkrtz_f16_f32 v137, v120, v121
v_cvt_pkrtz_f16_f32 v139, v122, v123
v_cvt_pkrtz_f16_f32 v141, v124, v125
v_cvt_pkrtz_f16_f32 v143, v126, v127
v_smfmac_f32_16x16x32_bf16 v[8:11], v[226:227], v[204:207], v246
v_cvt_pk_f16_f32 v155, v128, v129
v_cvt_pk_f16_f32 v152, v130, v131
v_cvt_pk_f16_f32 v149, v132, v133
v_cvt_pk_f16_f32 v146, v134, v135
v_pk_fma_f16 v154, v155, v155, s48
v_mfma_f32_32x32x16_bf16 v[120:135], v[72:75], v[228:231], 0
ds_read_b128 v[224:227], v249 offset:11264
v_and_b32_e64 v137, s49, v137
v_pk_fma_f16 v151, v152, v152, s48
v_pk_fma_f16 v148, v149, v149, s48
v_and_b32_e64 v139, s49, v139
v_pk_fma_f16 v145, v146, v146, s48
v_pk_mul_f16 v154, v155, v154
v_bfe_u32 v136, v137, 2, 14
v_pk_mul_f16 v151, v152, v151
v_pk_mul_f16 v148, v149, v148
v_bfe_u32 v138, v139, 2, 14
v_mfma_f32_32x32x16_bf16 v[120:135], v[76:79], v[232:235], v[120:135]
ds_read_b128 v[228:231], v245 offset:6528
ds_read_b128 v[208:211], v244 offset:64
ds_read_b128 v[212:215], v244 offset:128
ds_read_u16_d16 v136, v136
ds_read_u16_d16 v138, v138
v_pk_mul_f16 v145, v146, v145
v_exp_f16 v153, v154
v_lshrrev_b32 v137, 18, v137
v_exp_f16 v150, v151
v_lshrrev_b32 v139, 18, v139
v_exp_f16 v147, v148
s_waitcnt lgkmcnt(6)
v_mfma_f32_32x32x16_bf16 v[120:135], v[80:83], v[236:239], v[120:135]
ds_read_b128 v[232:235], v249 offset:12288
ds_read_u16_d16_hi v137, v137
ds_read_u16_d16_hi v139, v139
v_and_b32 v141, s49, v141
v_exp_f16 v144, v145
v_and_b32_e64 v143, s49, v143
v_exp_f16_sdwa v153, v154 dst_sel:WORD_1 dst_unused:UNUSED_PRESERVE src0_sel:WORD_1
v_bfe_u32 v140, v141, 2, 14
v_exp_f16_sdwa v150, v151 dst_sel:WORD_1 dst_unused:UNUSED_PRESERVE src0_sel:WORD_1
v_bfe_u32 v142, v143, 2, 14
v_mfma_f32_32x32x16_bf16 v[120:135], v[84:87], v[216:219], v[120:135]
ds_read_b128 v[236:239], v249 offset:15360
ds_read_u16_d16 v140, v140
ds_read_u16_d16 v142, v142
v_exp_f16_sdwa v147, v148 dst_sel:WORD_1 dst_unused:UNUSED_PRESERVE src0_sel:WORD_1
v_lshrrev_b32_e64 v141, 18, v141
v_exp_f16_sdwa v144, v145 dst_sel:WORD_1 dst_unused:UNUSED_PRESERVE src0_sel:WORD_1
v_lshrrev_b32_e64 v143, 18, v143
v_pk_add_f16 v153, v153, 1.0 op_sel_hi:[1,0]
v_pk_add_f16 v150, v150, 1.0 op_sel_hi:[1,0]
v_pk_add_f16 v147, v147, 1.0 op_sel_hi:[1,0]
v_mfma_f32_32x32x16_bf16 v[120:135], v[88:91], v[220:223], v[120:135]
ds_read_b128 v[216:219], v249 offset:13312
ds_read_u16_d16_hi v141, v141
ds_read_u16_d16_hi v143, v143
v_pk_add_f16 v144, v144, 1.0 op_sel_hi:[1,0]
v_rcp_f16 v154, v153
v_rcp_f16 v151, v150
v_rcp_f16 v148, v147
v_rcp_f16 v145, v144
s_waitcnt lgkmcnt(6)
v_mfma_f32_32x32x16_bf16 v[120:135], v[92:95], v[224:227], v[120:135]
ds_read_b128 v[220:223], v249 offset:16384
v_rcp_f16_sdwa v154, v153 dst_sel:WORD_1 dst_unused:UNUSED_PRESERVE src0_sel:WORD_1
v_rcp_f16_sdwa v151, v150 dst_sel:WORD_1 dst_unused:UNUSED_PRESERVE src0_sel:WORD_1
s_setprio 0
v_rcp_f16_sdwa v148, v147 dst_sel:WORD_1 dst_unused:UNUSED_PRESERVE src0_sel:WORD_1
v_fma_mix_f32 v164, v136, v136, v164 op_sel:[0,0,0] op_sel_hi:[1,1,0]
v_rcp_f16_sdwa v145, v144 dst_sel:WORD_1 dst_unused:UNUSED_PRESERVE src0_sel:WORD_1
v_fma_mix_f32 v164, v137, v137, v164 op_sel:[1,1,0] op_sel_hi:[1,1,0]
v_smfmac_f32_16x16x32_bf16 v[24:27], v[228:229], v[208:211], v246
ds_read_b128 v[224:227], v249 offset:14336
v_pk_mul_f16 v155, v155, v154
v_fma_mix_f32 v164, v138, v138, v164 op_sel:[0,0,0] op_sel_hi:[1,1,0]
v_pk_mul_f16 v152, v152, v151
v_pk_mul_f16 v149, v149, v148
v_fma_mix_f32 v164, v139, v139, v164 op_sel:[1,1,0] op_sel_hi:[1,1,0]
v_smfmac_f32_16x16x32_bf16 v[40:43], v[230:231], v[212:215], v246
s_mov_b64 exec, 1
ds_add_u32 v253, v254 offset:16
s_mov_b64 exec, -1
v_pk_mul_f16 v146, v146, v145
v_fma_mix_f32 v164, v155, v155, v164 op_sel:[0,0,0] op_sel_hi:[1,1,0]
s_waitcnt lgkmcnt(3)
v_fma_mix_f32 v164, v140, v140, v164 op_sel:[0,0,0] op_sel_hi:[1,1,0]
v_fma_mix_f32 v164, v155, v155, v164 op_sel:[1,1,0] op_sel_hi:[1,1,0]
v_fma_mix_f32 v164, v152, v152, v164 op_sel:[0,0,0] op_sel_hi:[1,1,0]
v_fma_mix_f32 v164, v141, v141, v164 op_sel:[1,1,0] op_sel_hi:[1,1,0]
v_fma_mix_f32 v164, v152, v152, v164 op_sel:[1,1,0] op_sel_hi:[1,1,0]
v_fma_mix_f32 v164, v149, v149, v164 op_sel:[0,0,0] op_sel_hi:[1,1,0]
v_fma_mix_f32 v164, v142, v142, v164 op_sel:[0,0,0] op_sel_hi:[1,1,0]
v_fma_mix_f32 v164, v149, v149, v164 op_sel:[1,1,0] op_sel_hi:[1,1,0]
v_fma_mix_f32 v164, v146, v146, v164 op_sel:[0,0,0] op_sel_hi:[1,1,0]
v_fma_mix_f32 v164, v143, v143, v164 op_sel:[1,1,0] op_sel_hi:[1,1,0]
v_fma_mix_f32 v164, v146, v146, v164 op_sel:[1,1,0] op_sel_hi:[1,1,0]
s_setprio 3
v_pk_add_f32 v[168:169], v[0:1], v[2:3]
v_pk_mul_f32 v[170:171], v[0:1], v[0:1]
v_pk_fma_f32 v[170:171], v[2:3], v[2:3], v[170:171]
v_pk_add_f32 v[168:169], v[168:169], v[4:5]
v_pk_fma_f32 v[170:171], v[4:5], v[4:5], v[170:171]
v_pk_add_f32 v[168:169], v[168:169], v[6:7]
v_pk_fma_f32 v[170:171], v[6:7], v[6:7], v[170:171]
v_pk_add_f32 v[168:169], v[168:169], v[8:9]
v_pk_fma_f32 v[170:171], v[8:9], v[8:9], v[170:171]
v_pk_add_f32 v[168:169], v[168:169], v[10:11]
v_pk_fma_f32 v[170:171], v[10:11], v[10:11], v[170:171]
v_pk_add_f32 v[168:169], v[168:169], v[12:13]
v_pk_fma_f32 v[170:171], v[12:13], v[12:13], v[170:171]
v_pk_add_f32 v[168:169], v[168:169], v[14:15]
v_pk_fma_f32 v[170:171], v[14:15], v[14:15], v[170:171]
v_pk_add_f32 v[168:169], v[168:169], v[16:17]
v_pk_fma_f32 v[170:171], v[16:17], v[16:17], v[170:171]
v_pk_add_f32 v[168:169], v[168:169], v[18:19]
v_pk_fma_f32 v[170:171], v[18:19], v[18:19], v[170:171]
v_pk_add_f32 v[168:169], v[168:169], v[20:21]
v_pk_fma_f32 v[170:171], v[20:21], v[20:21], v[170:171]
v_pk_add_f32 v[168:169], v[168:169], v[22:23]
v_pk_fma_f32 v[170:171], v[22:23], v[22:23], v[170:171]
v_pk_add_f32 v[168:169], v[168:169], v[24:25]
v_pk_fma_f32 v[170:171], v[24:25], v[24:25], v[170:171]
v_pk_add_f32 v[168:169], v[168:169], v[26:27]
v_pk_fma_f32 v[170:171], v[26:27], v[26:27], v[170:171]
v_pk_add_f32 v[168:169], v[168:169], v[28:29]
v_pk_fma_f32 v[170:171], v[28:29], v[28:29], v[170:171]
v_pk_add_f32 v[168:169], v[168:169], v[30:31]
v_pk_fma_f32 v[170:171], v[30:31], v[30:31], v[170:171]
v_pk_add_f32 v[168:169], v[168:169], v[32:33]
v_pk_fma_f32 v[170:171], v[32:33], v[32:33], v[170:171]
v_pk_add_f32 v[168:169], v[168:169], v[34:35]
v_pk_fma_f32 v[170:171], v[34:35], v[34:35], v[170:171]
v_pk_add_f32 v[168:169], v[168:169], v[36:37]
v_pk_fma_f32 v[170:171], v[36:37], v[36:37], v[170:171]
v_pk_add_f32 v[168:169], v[168:169], v[38:39]
v_pk_fma_f32 v[170:171], v[38:39], v[38:39], v[170:171]
v_pk_add_f32 v[168:169], v[168:169], v[40:41]
v_pk_fma_f32 v[170:171], v[40:41], v[40:41], v[170:171]
v_pk_add_f32 v[168:169], v[168:169], v[42:43]
v_pk_fma_f32 v[170:171], v[42:43], v[42:43], v[170:171]
v_pk_add_f32 v[168:169], v[168:169], v[44:45]
v_pk_fma_f32 v[170:171], v[44:45], v[44:45], v[170:171]
v_pk_add_f32 v[168:169], v[168:169], v[46:47]
v_pk_fma_f32 v[170:171], v[46:47], v[46:47], v[170:171]
s_setprio 0
v_add_u32 v174, -36864, v242
v_subrev_u32 v175, 66560, v174
v_min_u32 v174, v174, v175
v_add_u32 v174, 90112, v174
v_sub_u32 v175, v174, v242
v_add_u32 v242, v175, v242
v_add_u32_e64 v243, v175, v243
v_add_u32 v244, v175, v244
s_setprio 2
v_cvt_pkrtz_f16_f32 v137, v120, v121
v_cvt_pkrtz_f16_f32 v139, v122, v123
v_cvt_pkrtz_f16_f32 v141, v124, v125
v_cvt_pkrtz_f16_f32 v143, v126, v127
v_cvt_pkrtz_f16_f32 v145, v128, v129
v_cvt_pk_f16_f32 v155, v130, v131
v_cvt_pk_f16_f32 v152, v132, v133
v_cvt_pk_f16_f32 v149, v134, v135
ds_read_b128 v[228:231], v249 offset:17408
v_mfma_f32_32x32x16_bf16 v[120:135], v[72:75], v[232:235], 0
v_pk_fma_f16 v154, v155, v155, s48
v_add_f32 v168, v168, v169
v_and_b32 v137, s49, v137
v_pk_fma_f16 v151, v152, v152, s48
v_and_b32_e64 v139, s49, v139
v_pk_fma_f16 v148, v149, v149, s48
v_add_f32_e64 v170, v170, v171
v_pk_mul_f16 v154, v155, v154
v_bfe_u32 v136, v137, 2, 14
v_pk_mul_f16 v151, v152, v151
v_pk_mul_f16 v148, v149, v148
v_bfe_u32 v138, v139, 2, 14
ds_read_b128 v[232:235], v249 offset:18432
ds_read_u16_d16 v136, v136
ds_read_u16_d16 v138, v138
v_mfma_f32_32x32x16_bf16 v[120:135], v[76:79], v[236:239], v[120:135]
v_permlane32_swap_b32 v168, v170
v_exp_f16 v153, v154
v_lshrrev_b32 v137, 18, v137
v_exp_f16 v150, v151
v_add_f32 v168, v168, v170
v_lshrrev_b32 v139, 18, v139
v_exp_f16 v147, v148
v_and_b32 v141, s49, v141
v_and_b32_e64 v143, s49, v143
v_mul_f32 v168, 1009429163, v168
ds_read_b128 v[236:239], v249 offset:21504
ds_read_u16_d16_hi v137, v137
ds_read_u16_d16_hi v139, v139
v_mfma_f32_32x32x16_bf16 v[120:135], v[80:83], v[216:219], v[120:135]
v_exp_f16_sdwa v153, v154 dst_sel:WORD_1 dst_unused:UNUSED_PRESERVE src0_sel:WORD_1
v_bfe_u32 v140, v141, 2, 14
v_exp_f16_sdwa v150, v151 dst_sel:WORD_1 dst_unused:UNUSED_PRESERVE src0_sel:WORD_1
v_mov_b32_e64 v170, v168
v_bfe_u32 v142, v143, 2, 14
v_exp_f16_sdwa v147, v148 dst_sel:WORD_1 dst_unused:UNUSED_PRESERVE src0_sel:WORD_1
v_lshrrev_b32_e64 v141, 18, v141
v_permlane32_swap_b32 v168, v170
v_pk_add_f16 v153, v153, 1.0 op_sel_hi:[1,0]
s_waitcnt lgkmcnt(8)
ds_read_b128 v[216:219], v249 offset:19456
ds_read_u16_d16 v140, v140
ds_read_u16_d16 v142, v142
ds_read_u16_d16_hi v141, v141
v_mfma_f32_32x32x16_bf16 v[120:135], v[84:87], v[220:223], v[120:135]
v_lshrrev_b32_e64 v143, 18, v143
v_pk_add_f16 v150, v150, 1.0 op_sel_hi:[1,0]
v_pk_add_f16 v147, v147, 1.0 op_sel_hi:[1,0]
v_and_b32_e64 v145, s49, v145
v_fma_f32 v170, -v168, v168, v170
v_rcp_f16_e64 v154, v153
v_bfe_u32 v144, v145, 2, 14
v_rcp_f16 v151, v150
v_max_f32 v170, 0, v170
v_lshrrev_b32_e64 v145, 18, v145
ds_read_b128 v[220:223], v249 offset:22528
ds_read_u16_d16_hi v143, v143
ds_read_u16_d16 v144, v144
ds_read_u16_d16_hi v145, v145
v_mfma_f32_32x32x16_bf16 v[120:135], v[88:91], v[224:227], v[120:135]
v_rcp_f16 v148, v147
v_rcp_f16_sdwa v154, v153 dst_sel:WORD_1 dst_unused:UNUSED_PRESERVE src0_sel:WORD_1
v_add_f32 v170, 925353388, v170
s_waitcnt lgkmcnt(8)
v_fma_mix_f32 v165, v136, v136, v165 op_sel:[0,0,0] op_sel_hi:[1,1,0]
ds_read_b32 v247, v253 offset:16
v_fma_mix_f32 v165, v137, v137, v165 op_sel:[1,1,0] op_sel_hi:[1,1,0]
v_rcp_f16_sdwa v151, v150 dst_sel:WORD_1 dst_unused:UNUSED_PRESERVE src0_sel:WORD_1
v_rsq_f32_e64 v170, v170
v_fma_mix_f32 v165, v138, v138, v165 op_sel:[0,0,0] op_sel_hi:[1,1,0]
ds_read_b128 v[224:227], v249 offset:20480
v_mfma_f32_32x32x16_bf16 v[120:135], v[92:95], v[228:231], v[120:135]
v_rcp_f16_sdwa v148, v147 dst_sel:WORD_1 dst_unused:UNUSED_PRESERVE src0_sel:WORD_1
v_fma_mix_f32 v165, v139, v139, v165 op_sel:[1,1,0] op_sel_hi:[1,1,0]
v_pk_mul_f16 v155, v155, v154
s_waitcnt lgkmcnt(6)
v_fma_mix_f32 v165, v140, v140, v165 op_sel:[0,0,0] op_sel_hi:[1,1,0]
v_pk_mul_f16 v152, v152, v151
v_fma_mix_f32 v165, v141, v141, v165 op_sel:[1,1,0] op_sel_hi:[1,1,0]
v_pk_mul_f16 v149, v149, v148
v_fma_mix_f32 v165, v155, v155, v165 op_sel:[0,0,0] op_sel_hi:[1,1,0]
v_mul_f32 v172, 3203391086, v170
v_fma_mix_f32 v165, v142, v142, v165 op_sel:[0,0,0] op_sel_hi:[1,1,0]
v_fma_mix_f32 v165, v155, v155, v165 op_sel:[1,1,0] op_sel_hi:[1,1,0]
s_waitcnt lgkmcnt(2)
v_fma_mix_f32 v165, v143, v143, v165 op_sel:[1,1,0] op_sel_hi:[1,1,0]
v_fma_mix_f32 v165, v152, v152, v165 op_sel:[0,0,0] op_sel_hi:[1,1,0]
v_fma_mix_f32 v165, v152, v152, v165 op_sel:[1,1,0] op_sel_hi:[1,1,0]
v_mul_f32 v173, v168, v172
v_fma_mix_f32 v165, v144, v144, v165 op_sel:[0,0,0] op_sel_hi:[1,1,0]
v_fma_mix_f32 v165, v149, v149, v165 op_sel:[0,0,0] op_sel_hi:[1,1,0]
v_fma_mix_f32 v165, v145, v145, v165 op_sel:[1,1,0] op_sel_hi:[1,1,0]
v_fma_mix_f32 v165, v149, v149, v165 op_sel:[1,1,0] op_sel_hi:[1,1,0]
s_setprio 3
v_pk_fma_f32 v[0:1], v[0:1], v[172:173], v[172:173] op_sel:[0,0,1] op_sel_hi:[1,0,1] neg_lo:[0,0,1] neg_hi:[0,0,1]
v_pk_fma_f32 v[2:3], v[2:3], v[172:173], v[172:173] op_sel:[0,0,1] op_sel_hi:[1,0,1] neg_lo:[0,0,1] neg_hi:[0,0,1]
v_pk_fma_f32 v[4:5], v[4:5], v[172:173], v[172:173] op_sel:[0,0,1] op_sel_hi:[1,0,1] neg_lo:[0,0,1] neg_hi:[0,0,1]
v_pk_fma_f32 v[6:7], v[6:7], v[172:173], v[172:173] op_sel:[0,0,1] op_sel_hi:[1,0,1] neg_lo:[0,0,1] neg_hi:[0,0,1]
v_pk_fma_f32 v[8:9], v[8:9], v[172:173], v[172:173] op_sel:[0,0,1] op_sel_hi:[1,0,1] neg_lo:[0,0,1] neg_hi:[0,0,1]
v_pk_fma_f32 v[10:11], v[10:11], v[172:173], v[172:173] op_sel:[0,0,1] op_sel_hi:[1,0,1] neg_lo:[0,0,1] neg_hi:[0,0,1]
v_pk_fma_f32 v[12:13], v[12:13], v[172:173], v[172:173] op_sel:[0,0,1] op_sel_hi:[1,0,1] neg_lo:[0,0,1] neg_hi:[0,0,1]
v_pk_fma_f32 v[14:15], v[14:15], v[172:173], v[172:173] op_sel:[0,0,1] op_sel_hi:[1,0,1] neg_lo:[0,0,1] neg_hi:[0,0,1]
v_pk_fma_f32 v[16:17], v[16:17], v[172:173], v[172:173] op_sel:[0,0,1] op_sel_hi:[1,0,1] neg_lo:[0,0,1] neg_hi:[0,0,1]
v_pk_fma_f32 v[18:19], v[18:19], v[172:173], v[172:173] op_sel:[0,0,1] op_sel_hi:[1,0,1] neg_lo:[0,0,1] neg_hi:[0,0,1]
v_pk_fma_f32 v[20:21], v[20:21], v[172:173], v[172:173] op_sel:[0,0,1] op_sel_hi:[1,0,1] neg_lo:[0,0,1] neg_hi:[0,0,1]
v_pk_fma_f32 v[22:23], v[22:23], v[172:173], v[172:173] op_sel:[0,0,1] op_sel_hi:[1,0,1] neg_lo:[0,0,1] neg_hi:[0,0,1]
v_pk_fma_f32 v[24:25], v[24:25], v[172:173], v[172:173] op_sel:[0,0,1] op_sel_hi:[1,0,1] neg_lo:[0,0,1] neg_hi:[0,0,1]
v_pk_fma_f32 v[26:27], v[26:27], v[172:173], v[172:173] op_sel:[0,0,1] op_sel_hi:[1,0,1] neg_lo:[0,0,1] neg_hi:[0,0,1]
v_pk_fma_f32 v[28:29], v[28:29], v[172:173], v[172:173] op_sel:[0,0,1] op_sel_hi:[1,0,1] neg_lo:[0,0,1] neg_hi:[0,0,1]
v_pk_fma_f32 v[30:31], v[30:31], v[172:173], v[172:173] op_sel:[0,0,1] op_sel_hi:[1,0,1] neg_lo:[0,0,1] neg_hi:[0,0,1]
v_pk_fma_f32 v[32:33], v[32:33], v[172:173], v[172:173] op_sel:[0,0,1] op_sel_hi:[1,0,1] neg_lo:[0,0,1] neg_hi:[0,0,1]
v_pk_fma_f32 v[34:35], v[34:35], v[172:173], v[172:173] op_sel:[0,0,1] op_sel_hi:[1,0,1] neg_lo:[0,0,1] neg_hi:[0,0,1]
v_pk_fma_f32 v[36:37], v[36:37], v[172:173], v[172:173] op_sel:[0,0,1] op_sel_hi:[1,0,1] neg_lo:[0,0,1] neg_hi:[0,0,1]
v_pk_fma_f32 v[38:39], v[38:39], v[172:173], v[172:173] op_sel:[0,0,1] op_sel_hi:[1,0,1] neg_lo:[0,0,1] neg_hi:[0,0,1]
v_pk_fma_f32 v[40:41], v[40:41], v[172:173], v[172:173] op_sel:[0,0,1] op_sel_hi:[1,0,1] neg_lo:[0,0,1] neg_hi:[0,0,1]
v_pk_fma_f32 v[42:43], v[42:43], v[172:173], v[172:173] op_sel:[0,0,1] op_sel_hi:[1,0,1] neg_lo:[0,0,1] neg_hi:[0,0,1]
v_pk_fma_f32 v[44:45], v[44:45], v[172:173], v[172:173] op_sel:[0,0,1] op_sel_hi:[1,0,1] neg_lo:[0,0,1] neg_hi:[0,0,1]
v_pk_fma_f32 v[46:47], v[46:47], v[172:173], v[172:173] op_sel:[0,0,1] op_sel_hi:[1,0,1] neg_lo:[0,0,1] neg_hi:[0,0,1]
s_setprio 2
s_waitcnt lgkmcnt(0)
v_readfirstlane_b32 s43, v247
s_nop 1
s_cmp_ge_u32 s43, 24
s_cbranch_scc1 Lev6
Lev6w:
s_sleep 1
ds_read_b32 v247, v253 offset:16
s_waitcnt lgkmcnt(0)
v_readfirstlane_b32 s43, v247
s_cmp_eq_u32 s76, 0
s_cbranch_scc1 Lev6
s_sub_u32 s76, s76, 1
s_cmp_lt_u32 s43, 24
s_cbranch_scc1 Lev6w
Lev6:
s_setprio 1
v_cvt_pkrtz_f16_f32 v137, v120, v121
v_cvt_pkrtz_f16_f32 v139, v122, v123
v_cvt_pkrtz_f16_f32 v141, v124, v125
v_cvt_pkrtz_f16_f32 v143, v126, v127
v_cvt_pkrtz_f16_f32 v145, v128, v129
v_cvt_pk_f16_f32 v155, v130, v131
v_cvt_pk_f16_f32 v152, v132, v133
v_cvt_pk_f16_f32 v149, v134, v135
s_add_u32 m0, s67, 39936
s_add_u32 s66, s66, 98304
buffer_load_dwordx4 v240, s[4:7], s66 offen lds
ds_read_b128 v[228:231], v249 offset:23552
v_mfma_f32_32x32x16_bf16 v[120:135], v[72:75], v[232:235], 0
v_pk_fma_f16 v154, v155, v155, s48
v_cvt_pk_bf16_f32 v96, v0, v1
v_and_b32 v137, s49, v137
v_pk_fma_f16 v151, v152, v152, s48
v_cvt_pk_bf16_f32 v97, v2, v3
v_and_b32_e64 v139, s49, v139
v_pk_fma_f16 v148, v149, v149, s48
v_pk_mul_f16 v154, v155, v154
v_cvt_pk_bf16_f32 v98, v4, v5
v_bfe_u32 v136, v137, 2, 14
v_pk_mul_f16 v151, v152, v151
v_pk_mul_f16 v148, v149, v148
v_cvt_pk_bf16_f32 v99, v6, v7
v_bfe_u32 v138, v139, 2, 14
s_add_u32 m0, s67, 46592
s_add_u32 s66, s66, 98304
buffer_load_dwordx4 v240, s[4:7], s66 offen lds
ds_read_b128 v[232:235], v248 offset:16384
ds_read_u16_d16 v136, v136
ds_read_u16_d16 v138, v138
v_mfma_f32_32x32x16_bf16 v[120:135], v[76:79], v[236:239], v[120:135]
v_exp_f16_e64 v153, v154
v_cvt_pk_bf16_f32 v100, v8, v9
v_lshrrev_b32 v137, 18, v137
v_exp_f16 v150, v151
v_cvt_pk_bf16_f32 v101, v10, v11
v_lshrrev_b32 v139, 18, v139
v_exp_f16 v147, v148
v_cvt_pk_bf16_f32 v102, v12, v13
v_and_b32 v141, s49, v141
v_and_b32 v143, s49, v143
v_cvt_pk_bf16_f32 v103, v14, v15
s_add_u32 m0, s67, 53248
s_add_u32 s66, s66, 98304
buffer_load_dwordx4 v240, s[4:7], s66 offen lds
ds_read_b128 v[236:239], v248 offset:19456
ds_read_u16_d16_hi v137, v137
ds_read_u16_d16_hi v139, v139
v_mfma_f32_32x32x16_bf16 v[120:135], v[80:83], v[216:219], v[120:135]
v_exp_f16_sdwa v153, v154 dst_sel:WORD_1 dst_unused:UNUSED_PRESERVE src0_sel:WORD_1
v_bfe_u32 v140, v141, 2, 14
v_cvt_pk_bf16_f32 v104, v16, v17
v_exp_f16_sdwa v150, v151 dst_sel:WORD_1 dst_unused:UNUSED_PRESERVE src0_sel:WORD_1
v_bfe_u32 v142, v143, 2, 14
v_cvt_pk_bf16_f32 v105, v18, v19
v_exp_f16_sdwa v147, v148 dst_sel:WORD_1 dst_unused:UNUSED_PRESERVE src0_sel:WORD_1
v_cvt_pk_bf16_f32 v106, v20, v21
v_lshrrev_b32_e64 v141, 18, v141
v_pk_add_f16 v153, v153, 1.0 op_sel_hi:[1,0]
v_lshrrev_b32 v143, 18, v143
s_add_u32 m0, s67, 59904
s_add_u32 s66, s66, 98304
buffer_load_dwordx4 v240, s[4:7], s66 offen lds
s_add_u32 m0, s67, 0
s_add_u32 s66, s66, 98304
buffer_load_dwordx4 v240, s[4:7], s66 offen lds
ds_read_b128 v[216:219], v248 offset:17408
ds_read_u16_d16 v140, v140
ds_read_u16_d16 v142, v142
ds_read_u16_d16_hi v141, v141
ds_read_u16_d16_hi v143, v143
v_mfma_f32_32x32x16_bf16 v[120:135], v[84:87], v[220:223], v[120:135]
v_cvt_pk_bf16_f32 v107, v22, v23
v_pk_add_f16 v150, v150, 1.0 op_sel_hi:[1,0]
v_pk_add_f16 v147, v147, 1.0 op_sel_hi:[1,0]
v_and_b32_e64 v145, s49, v145
v_cvt_pk_bf16_f32 v108, v24, v25
v_rcp_f16_e64 v154, v153
v_bfe_u32 v144, v145, 2, 14
v_cvt_pk_bf16_f32 v109, v26, v27
v_rcp_f16 v151, v150
v_lshrrev_b32 v145, 18, v145
v_cvt_pk_bf16_f32 v110, v28, v29
s_add_u32 m0, s67, 6656
s_add_u32 s66, s66, 98304
buffer_load_dwordx4 v240, s[4:7], s66 offen lds
ds_read_b128 v[220:223], v248 offset:20480
ds_read_u16_d16 v144, v144
ds_read_u16_d16_hi v145, v145
v_mfma_f32_32x32x16_bf16 v[120:135], v[88:91], v[224:227], v[120:135]
v_rcp_f16_e64 v148, v147
v_cvt_pk_bf16_f32 v111, v30, v31
v_rcp_f16_sdwa v154, v153 dst_sel:WORD_1 dst_unused:UNUSED_PRESERVE src0_sel:WORD_1
s_waitcnt lgkmcnt(5)
v_fma_mix_f32 v166, v136, v136, v166 op_sel:[0,0,0] op_sel_hi:[1,1,0]
v_cvt_pk_bf16_f32 v112, v32, v33
s_setprio 0
v_fma_mix_f32 v166, v137, v137, v166 op_sel:[1,1,0] op_sel_hi:[1,1,0]
v_rcp_f16_sdwa v151, v150 dst_sel:WORD_1 dst_unused:UNUSED_PRESERVE src0_sel:WORD_1
v_cvt_pk_bf16_f32 v113, v34, v35
v_fma_mix_f32 v166, v138, v138, v166 op_sel:[0,0,0] op_sel_hi:[1,1,0]
v_rcp_f16_sdwa v148, v147 dst_sel:WORD_1 dst_unused:UNUSED_PRESERVE src0_sel:WORD_1
v_cvt_pk_bf16_f32 v114, v36, v37
s_add_u32 m0, s67, 13312
s_add_u32 s66, s66, 98304
buffer_load_dwordx4 v240, s[4:7], s66 offen lds
ds_read_b128 v[224:227], v248 offset:18432
v_mfma_f32_32x32x16_bf16 v[120:135], v[92:95], v[228:231], v[120:135]
v_fma_mix_f32 v166, v139, v139, v166 op_sel:[1,1,0] op_sel_hi:[1,1,0]
v_pk_mul_f16 v155, v155, v154
v_fma_mix_f32 v166, v140, v140, v166 op_sel:[0,0,0] op_sel_hi:[1,1,0]
v_cvt_pk_bf16_f32 v115, v38, v39
v_pk_mul_f16 v152, v152, v151
s_waitcnt lgkmcnt(1)
v_fma_mix_f32 v166, v141, v141, v166 op_sel:[1,1,0] op_sel_hi:[1,1,0]
v_cvt_pk_bf16_f32 v116, v40, v41
v_pk_mul_f16 v149, v149, v148
v_fma_mix_f32 v166, v155, v155, v166 op_sel:[0,0,0] op_sel_hi:[1,1,0]
v_fma_mix_f32 v166, v142, v142, v166 op_sel:[0,0,0] op_sel_hi:[1,1,0]
v_cvt_pk_bf16_f32 v117, v42, v43
v_fma_mix_f32 v166, v155, v155, v166 op_sel:[1,1,0] op_sel_hi:[1,1,0]
v_fma_mix_f32 v166, v143, v143, v166 op_sel:[1,1,0] op_sel_hi:[1,1,0]
v_fma_mix_f32 v166, v152, v152, v166 op_sel:[0,0,0] op_sel_hi:[1,1,0]
s_add_u32 m0, s67, 19968
s_add_u32 s66, s66, 98304
buffer_load_dwordx4 v240, s[4:7], s66 offen lds
v_cvt_pk_bf16_f32 v118, v44, v45
v_fma_mix_f32 v166, v152, v152, v166 op_sel:[1,1,0] op_sel_hi:[1,1,0]
v_fma_mix_f32 v166, v144, v144, v166 op_sel:[0,0,0] op_sel_hi:[1,1,0]
v_fma_mix_f32 v166, v149, v149, v166 op_sel:[0,0,0] op_sel_hi:[1,1,0]
v_cvt_pk_bf16_f32 v119, v46, v47
v_fma_mix_f32 v166, v145, v145, v166 op_sel:[1,1,0] op_sel_hi:[1,1,0]
v_fma_mix_f32 v166, v149, v149, v166 op_sel:[1,1,0] op_sel_hi:[1,1,0]
s_setprio 2
v_cvt_pkrtz_f16_f32 v137, v120, v121
v_cvt_pkrtz_f16_f32 v139, v122, v123
v_cvt_pkrtz_f16_f32 v141, v124, v125
v_cvt_pkrtz_f16_f32 v143, v126, v127
v_cvt_pkrtz_f16_f32 v145, v128, v129
v_cvt_pk_f16_f32 v155, v130, v131
v_cvt_pk_f16_f32 v152, v132, v133
v_cvt_pk_f16_f32 v149, v134, v135
ds_read_b128 v[228:231], v248 offset:21504
v_mfma_f32_32x32x16_bf16 v[120:135], v[96:99], v[232:235], 0
v_pk_fma_f16 v154, v155, v155, s48
v_and_b32_e64 v137, s49, v137
v_pk_fma_f16 v151, v152, v152, s48
v_and_b32_e64 v139, s49, v139
v_pk_fma_f16 v148, v149, v149, s48
v_pk_mul_f16 v154, v155, v154
v_bfe_u32 v136, v137, 2, 14
v_pk_mul_f16 v151, v152, v151
v_pk_mul_f16 v148, v149, v148
v_bfe_u32 v138, v139, 2, 14
ds_read_b128 v[232:235], v248 offset:22528
ds_read_u16_d16 v136, v136
ds_read_u16_d16 v138, v138
v_mfma_f32_32x32x16_bf16 v[120:135], v[100:103], v[236:239], v[120:135]
v_exp_f16 v153, v154
v_lshrrev_b32 v137, 18, v137
v_exp_f16 v150, v151
v_lshrrev_b32 v139, 18, v139
v_exp_f16 v147, v148
v_and_b32 v141, s49, v141
v_and_b32_e64 v143, s49, v143
ds_read_b128 v[236:239], v248 offset:25600
ds_read_u16_d16_hi v137, v137
ds_read_u16_d16_hi v139, v139
v_mfma_f32_32x32x16_bf16 v[120:135], v[104:107], v[216:219], v[120:135]
v_exp_f16_sdwa v153, v154 dst_sel:WORD_1 dst_unused:UNUSED_PRESERVE src0_sel:WORD_1
v_bfe_u32 v140, v141, 2, 14
v_exp_f16_sdwa v150, v151 dst_sel:WORD_1 dst_unused:UNUSED_PRESERVE src0_sel:WORD_1
v_bfe_u32 v142, v143, 2, 14
v_exp_f16_sdwa v147, v148 dst_sel:WORD_1 dst_unused:UNUSED_PRESERVE src0_sel:WORD_1
v_lshrrev_b32_e64 v141, 18, v141
v_pk_add_f16 v153, v153, 1.0 op_sel_hi:[1,0]
ds_read_b128 v[216:219], v248 offset:23552
ds_read_u16_d16 v140, v140
ds_read_u16_d16 v142, v142
ds_read_u16_d16_hi v141, v141
v_mfma_f32_32x32x16_bf16 v[120:135], v[108:111], v[220:223], v[120:135]
v_lshrrev_b32_e64 v143, 18, v143
v_pk_add_f16 v150, v150, 1.0 op_sel_hi:[1,0]
v_pk_add_f16 v147, v147, 1.0 op_sel_hi:[1,0]
v_and_b32 v145, s49, v145
v_rcp_f16 v154, v153
v_bfe_u32 v144, v145, 2, 14
v_rcp_f16_e64 v151, v150
v_lshrrev_b32 v145, 18, v145
s_waitcnt lgkmcnt(7)
ds_read_b128 v[220:223], v248 offset:26624
ds_read_u16_d16_hi v143, v143
ds_read_u16_d16 v144, v144
ds_read_u16_d16_hi v145, v145
v_mfma_f32_32x32x16_bf16 v[120:135], v[112:115], v[224:227], v[120:135]
v_rcp_f16_e64 v148, v147
v_rcp_f16_sdwa v154, v153 dst_sel:WORD_1 dst_unused:UNUSED_PRESERVE src0_sel:WORD_1
v_fma_mix_f32 v167, v136, v136, v167 op_sel:[0,0,0] op_sel_hi:[1,1,0]
s_waitcnt lgkmcnt(8)
v_fma_mix_f32 v167, v137, v137, v167 op_sel:[1,1,0] op_sel_hi:[1,1,0]
v_rcp_f16_sdwa v151, v150 dst_sel:WORD_1 dst_unused:UNUSED_PRESERVE src0_sel:WORD_1
v_fma_mix_f32 v167, v138, v138, v167 op_sel:[0,0,0] op_sel_hi:[1,1,0]
ds_read_b128 v[224:227], v248 offset:24576
v_mfma_f32_32x32x16_bf16 v[120:135], v[116:119], v[228:231], v[120:135]
v_rcp_f16_sdwa v148, v147 dst_sel:WORD_1 dst_unused:UNUSED_PRESERVE src0_sel:WORD_1
v_fma_mix_f32 v167, v139, v139, v167 op_sel:[1,1,0] op_sel_hi:[1,1,0]
v_pk_mul_f16 v155, v155, v154
s_waitcnt lgkmcnt(5)
v_fma_mix_f32 v167, v140, v140, v167 op_sel:[0,0,0] op_sel_hi:[1,1,0]
v_pk_mul_f16 v152, v152, v151
v_fma_mix_f32 v167, v141, v141, v167 op_sel:[1,1,0] op_sel_hi:[1,1,0]
v_pk_mul_f16 v149, v149, v148
v_fma_mix_f32 v167, v155, v155, v167 op_sel:[0,0,0] op_sel_hi:[1,1,0]
v_fma_mix_f32 v167, v142, v142, v167 op_sel:[0,0,0] op_sel_hi:[1,1,0]
v_fma_mix_f32 v167, v155, v155, v167 op_sel:[1,1,0] op_sel_hi:[1,1,0]
s_waitcnt lgkmcnt(3)
v_fma_mix_f32 v167, v143, v143, v167 op_sel:[1,1,0] op_sel_hi:[1,1,0]
v_fma_mix_f32 v167, v152, v152, v167 op_sel:[0,0,0] op_sel_hi:[1,1,0]
v_fma_mix_f32 v167, v152, v152, v167 op_sel:[1,1,0] op_sel_hi:[1,1,0]
s_waitcnt lgkmcnt(1)
v_fma_mix_f32 v167, v144, v144, v167 op_sel:[0,0,0] op_sel_hi:[1,1,0]
v_fma_mix_f32 v167, v149, v149, v167 op_sel:[0,0,0] op_sel_hi:[1,1,0]
v_fma_mix_f32 v167, v145, v145, v167 op_sel:[1,1,0] op_sel_hi:[1,1,0]
v_fma_mix_f32 v167, v149, v149, v167 op_sel:[1,1,0] op_sel_hi:[1,1,0]
s_cmp_lg_u32 s40, 7
s_cbranch_scc1 Lnoinit
s_waitcnt vmcnt(13)
v_mov_b32_e64 v255, 1
s_mov_b64 exec, 1
buffer_atomic_add v255, v241, s[36:39], 0 offen
s_mov_b64 exec, -1
Lnoinit:
s_setprio 1
v_cvt_pkrtz_f16_f32 v137, v120, v121
v_cvt_pkrtz_f16_f32 v139, v122, v123
v_cvt_pkrtz_f16_f32 v141, v124, v125
v_cvt_pkrtz_f16_f32 v143, v126, v127
v_cvt_pkrtz_f16_f32 v145, v128, v129
v_cvt_pk_f16_f32 v155, v130, v131
v_cvt_pk_f16_f32 v152, v132, v133
v_cvt_pk_f16_f32 v149, v134, v135
ds_read_b128 v[228:231], v248 offset:27648
v_mfma_f32_32x32x16_bf16 v[120:135], v[96:99], v[232:235], 0
v_pk_fma_f16 v154, v155, v155, s48
v_and_b32_e64 v137, s49, v137
v_pk_fma_f16 v151, v152, v152, s48
v_and_b32_e64 v139, s49, v139
v_pk_fma_f16 v148, v149, v149, s48
v_pk_mul_f16 v154, v155, v154
v_bfe_u32 v136, v137, 2, 14
v_pk_mul_f16 v151, v152, v151
v_pk_mul_f16 v148, v149, v148
v_bfe_u32 v138, v139, 2, 14
ds_read_b128 v[232:235], v248 offset:28672
ds_read_u16_d16 v136, v136
ds_read_u16_d16 v138, v138
v_mfma_f32_32x32x16_bf16 v[120:135], v[100:103], v[236:239], v[120:135]
v_exp_f16 v153, v154
v_lshrrev_b32 v137, 18, v137
v_exp_f16 v150, v151
v_lshrrev_b32 v139, 18, v139
v_exp_f16 v147, v148
v_and_b32 v141, s49, v141
v_and_b32_e64 v143, s49, v143
ds_read_b128 v[236:239], v248 offset:31744
ds_read_u16_d16_hi v137, v137
ds_read_u16_d16_hi v139, v139
v_mfma_f32_32x32x16_bf16 v[120:135], v[104:107], v[216:219], v[120:135]
v_exp_f16_sdwa v153, v154 dst_sel:WORD_1 dst_unused:UNUSED_PRESERVE src0_sel:WORD_1
v_bfe_u32 v140, v141, 2, 14
v_exp_f16_sdwa v150, v151 dst_sel:WORD_1 dst_unused:UNUSED_PRESERVE src0_sel:WORD_1
v_bfe_u32 v142, v143, 2, 14
v_exp_f16_sdwa v147, v148 dst_sel:WORD_1 dst_unused:UNUSED_PRESERVE src0_sel:WORD_1
v_lshrrev_b32_e64 v141, 18, v141
v_pk_add_f16 v153, v153, 1.0 op_sel_hi:[1,0]
ds_read_b128 v[216:219], v248 offset:29696
ds_read_u16_d16 v140, v140
ds_read_u16_d16 v142, v142
ds_read_u16_d16_hi v141, v141
v_mfma_f32_32x32x16_bf16 v[120:135], v[108:111], v[220:223], v[120:135]
v_lshrrev_b32_e64 v143, 18, v143
v_pk_add_f16 v150, v150, 1.0 op_sel_hi:[1,0]
v_pk_add_f16 v147, v147, 1.0 op_sel_hi:[1,0]
v_and_b32 v145, s49, v145
v_rcp_f16 v154, v153
v_bfe_u32 v144, v145, 2, 14
v_rcp_f16_e64 v151, v150
v_lshrrev_b32 v145, 18, v145
s_waitcnt lgkmcnt(7)
ds_read_b128 v[220:223], v248 offset:32768
ds_read_u16_d16_hi v143, v143
ds_read_u16_d16 v144, v144
ds_read_u16_d16_hi v145, v145
v_mfma_f32_32x32x16_bf16 v[120:135], v[112:115], v[224:227], v[120:135]
v_rcp_f16_e64 v148, v147
v_rcp_f16_sdwa v154, v153 dst_sel:WORD_1 dst_unused:UNUSED_PRESERVE src0_sel:WORD_1
v_fma_mix_f32 v156, v136, v136, v156 op_sel:[0,0,0] op_sel_hi:[1,1,0]
s_setprio 0
s_waitcnt lgkmcnt(8)
v_fma_mix_f32 v156, v137, v137, v156 op_sel:[1,1,0] op_sel_hi:[1,1,0]
v_rcp_f16_sdwa v151, v150 dst_sel:WORD_1 dst_unused:UNUSED_PRESERVE src0_sel:WORD_1
v_fma_mix_f32 v156, v138, v138, v156 op_sel:[0,0,0] op_sel_hi:[1,1,0]
ds_read_b128 v[224:227], v248 offset:30720
v_mfma_f32_32x32x16_bf16 v[120:135], v[116:119], v[228:231], v[120:135]
v_rcp_f16_sdwa v148, v147 dst_sel:WORD_1 dst_unused:UNUSED_PRESERVE src0_sel:WORD_1
v_fma_mix_f32 v156, v139, v139, v156 op_sel:[1,1,0] op_sel_hi:[1,1,0]
v_pk_mul_f16 v155, v155, v154
s_cmp_eq_u32 s40, 7
s_cbranch_scc1 Lrdy24
s_waitcnt vmcnt(0)
Lrdy24:
s_mov_b64 exec, 1
ds_add_u32 v253, v254 offset:12
s_mov_b64 exec, -1
s_waitcnt lgkmcnt(6)
v_fma_mix_f32 v156, v140, v140, v156 op_sel:[0,0,0] op_sel_hi:[1,1,0]
v_pk_mul_f16 v152, v152, v151
v_fma_mix_f32 v156, v141, v141, v156 op_sel:[1,1,0] op_sel_hi:[1,1,0]
v_pk_mul_f16 v149, v149, v148
v_fma_mix_f32 v156, v155, v155, v156 op_sel:[0,0,0] op_sel_hi:[1,1,0]
v_fma_mix_f32 v156, v142, v142, v156 op_sel:[0,0,0] op_sel_hi:[1,1,0]
v_fma_mix_f32 v156, v155, v155, v156 op_sel:[1,1,0] op_sel_hi:[1,1,0]
s_waitcnt lgkmcnt(2)
v_fma_mix_f32 v156, v143, v143, v156 op_sel:[1,1,0] op_sel_hi:[1,1,0]
v_fma_mix_f32 v156, v152, v152, v156 op_sel:[0,0,0] op_sel_hi:[1,1,0]
v_fma_mix_f32 v156, v152, v152, v156 op_sel:[1,1,0] op_sel_hi:[1,1,0]
v_fma_mix_f32 v156, v144, v144, v156 op_sel:[0,0,0] op_sel_hi:[1,1,0]
v_fma_mix_f32 v156, v149, v149, v156 op_sel:[0,0,0] op_sel_hi:[1,1,0]
v_fma_mix_f32 v156, v145, v145, v156 op_sel:[1,1,0] op_sel_hi:[1,1,0]
v_fma_mix_f32 v156, v149, v149, v156 op_sel:[1,1,0] op_sel_hi:[1,1,0]
s_setprio 2
v_cvt_pkrtz_f16_f32 v137, v120, v121
v_cvt_pkrtz_f16_f32 v139, v122, v123
v_cvt_pkrtz_f16_f32 v141, v124, v125
v_cvt_pkrtz_f16_f32 v143, v126, v127
v_cvt_pkrtz_f16_f32 v145, v128, v129
v_cvt_pk_f16_f32 v155, v130, v131
v_cvt_pk_f16_f32 v152, v132, v133
v_cvt_pk_f16_f32 v149, v134, v135
ds_read_b128 v[228:231], v248 offset:33792
v_mfma_f32_32x32x16_bf16 v[120:135], v[96:99], v[232:235], 0
v_pk_fma_f16 v154, v155, v155, s48
v_and_b32_e64 v137, s49, v137
v_pk_fma_f16 v151, v152, v152, s48
v_and_b32_e64 v139, s49, v139
v_pk_fma_f16 v148, v149, v149, s48
v_pk_mul_f16 v154, v155, v154
v_bfe_u32 v136, v137, 2, 14
v_pk_mul_f16 v151, v152, v151
v_pk_mul_f16 v148, v149, v148
v_bfe_u32 v138, v139, 2, 14
ds_read_b128 v[232:235], v250 offset:65520
ds_read_u16_d16 v136, v136
ds_read_u16_d16 v138, v138
v_mfma_f32_32x32x16_bf16 v[120:135], v[100:103], v[236:239], v[120:135]
v_exp_f16 v153, v154
v_lshrrev_b32 v137, 18, v137
v_exp_f16 v150, v151
v_lshrrev_b32 v139, 18, v139
v_exp_f16 v147, v148
v_and_b32 v141, s49, v141
v_and_b32_e64 v143, s49, v143
ds_read_b128 v[236:239], v248 offset:34816
ds_read_u16_d16_hi v137, v137
ds_read_b32 v247, v253 offset:12
ds_read_u16_d16_hi v139, v139
v_mfma_f32_32x32x16_bf16 v[120:135], v[104:107], v[216:219], v[120:135]
v_exp_f16_sdwa v153, v154 dst_sel:WORD_1 dst_unused:UNUSED_PRESERVE src0_sel:WORD_1
v_bfe_u32 v140, v141, 2, 14
v_exp_f16_sdwa v150, v151 dst_sel:WORD_1 dst_unused:UNUSED_PRESERVE src0_sel:WORD_1
v_bfe_u32 v142, v143, 2, 14
v_exp_f16_sdwa v147, v148 dst_sel:WORD_1 dst_unused:UNUSED_PRESERVE src0_sel:WORD_1
v_lshrrev_b32_e64 v141, 18, v141
v_pk_add_f16 v153, v153, 1.0 op_sel_hi:[1,0]
ds_read_b128 v[216:219], v248 offset:37888
ds_read_u16_d16 v140, v140
ds_read_u16_d16 v142, v142
ds_read_u16_d16_hi v141, v141
v_mfma_f32_32x32x16_bf16 v[120:135], v[108:111], v[220:223], v[120:135]
v_lshrrev_b32_e64 v143, 18, v143
v_pk_add_f16 v150, v150, 1.0 op_sel_hi:[1,0]
v_pk_add_f16 v147, v147, 1.0 op_sel_hi:[1,0]
v_and_b32 v145, s49, v145
v_rcp_f16 v154, v153
v_bfe_u32 v144, v145, 2, 14
v_rcp_f16_e64 v151, v150
ds_read_u16_d16_hi v143, v143
ds_read_u16_d16 v144, v144
s_waitcnt lgkmcnt(7)
v_readfirstlane_b32 s43, v247
s_nop 1
s_cmp_ge_u32 s43, 32
s_cbranch_scc1 Lev7
Lev7w:
s_sleep 1
ds_read_b32 v247, v253 offset:12
s_waitcnt lgkmcnt(0)
v_readfirstlane_b32 s43, v247
s_cmp_eq_u32 s76, 0
s_cbranch_scc1 Lev7
s_sub_u32 s76, s76, 1
s_cmp_lt_u32 s43, 32
s_cbranch_scc1 Lev7w
Lev7:
v_lshrrev_b32 v145, 18, v145
ds_read_b128 v[220:223], v248 offset:35840
ds_read_u16_d16_hi v145, v145
v_mfma_f32_32x32x16_bf16 v[120:135], v[112:115], v[224:227], v[120:135]
v_rcp_f16 v148, v147
v_rcp_f16_sdwa v154, v153 dst_sel:WORD_1 dst_unused:UNUSED_PRESERVE src0_sel:WORD_1
v_fma_mix_f32 v157, v136, v136, v157 op_sel:[0,0,0] op_sel_hi:[1,1,0]
v_fma_mix_f32 v157, v137, v137, v157 op_sel:[1,1,0] op_sel_hi:[1,1,0]
v_rcp_f16_sdwa v151, v150 dst_sel:WORD_1 dst_unused:UNUSED_PRESERVE src0_sel:WORD_1
v_fma_mix_f32 v157, v138, v138, v157 op_sel:[0,0,0] op_sel_hi:[1,1,0]
ds_read_b128 v[224:227], v245 offset:6528
ds_read_b128 v[192:195], v244 offset:128
ds_read_b128 v[196:199], v244 offset:64
v_mfma_f32_32x32x16_bf16 v[120:135], v[116:119], v[228:231], v[120:135]
v_rcp_f16_sdwa v148, v147 dst_sel:WORD_1 dst_unused:UNUSED_PRESERVE src0_sel:WORD_1
s_waitcnt lgkmcnt(5)
v_fma_mix_f32 v157, v139, v139, v157 op_sel:[1,1,0] op_sel_hi:[1,1,0]
v_pk_mul_f16 v155, v155, v154
v_fma_mix_f32 v157, v140, v140, v157 op_sel:[0,0,0] op_sel_hi:[1,1,0]
v_pk_mul_f16 v152, v152, v151
v_fma_mix_f32 v157, v141, v141, v157 op_sel:[1,1,0] op_sel_hi:[1,1,0]
v_pk_mul_f16 v149, v149, v148
v_fma_mix_f32 v157, v155, v155, v157 op_sel:[0,0,0] op_sel_hi:[1,1,0]
v_fma_mix_f32 v157, v142, v142, v157 op_sel:[0,0,0] op_sel_hi:[1,1,0]
v_fma_mix_f32 v157, v155, v155, v157 op_sel:[1,1,0] op_sel_hi:[1,1,0]
v_fma_mix_f32 v157, v143, v143, v157 op_sel:[1,1,0] op_sel_hi:[1,1,0]
v_fma_mix_f32 v157, v152, v152, v157 op_sel:[0,0,0] op_sel_hi:[1,1,0]
v_fma_mix_f32 v157, v152, v152, v157 op_sel:[1,1,0] op_sel_hi:[1,1,0]
v_fma_mix_f32 v157, v144, v144, v157 op_sel:[0,0,0] op_sel_hi:[1,1,0]
v_fma_mix_f32 v157, v149, v149, v157 op_sel:[0,0,0] op_sel_hi:[1,1,0]
s_waitcnt lgkmcnt(3)
v_fma_mix_f32 v157, v145, v145, v157 op_sel:[1,1,0] op_sel_hi:[1,1,0]
v_fma_mix_f32 v157, v149, v149, v157 op_sel:[1,1,0] op_sel_hi:[1,1,0]
s_setprio 1
v_mfma_f32_32x32x16_bf16 v[0:15], v[232:235], v[232:235], 0
ds_read_b128 v[228:231], v248 offset:38912
v_cvt_pkrtz_f16_f32 v137, v120, v121
v_cvt_pkrtz_f16_f32 v139, v122, v123
v_cvt_pkrtz_f16_f32 v141, v124, v125
v_cvt_pkrtz_f16_f32 v143, v126, v127
v_mfma_f32_32x32x16_bf16 v[16:31], v[232:235], v[232:235], 0
v_cvt_pk_f16_f32 v155, v128, v129
v_cvt_pk_f16_f32 v152, v130, v131
v_cvt_pk_f16_f32 v149, v132, v133
v_cvt_pk_f16_f32 v146, v134, v135
v_mfma_f32_32x32x16_bf16 v[32:47], v[232:235], v[232:235], 0
v_pk_fma_f16 v154, v155, v155, s48
v_and_b32_e64 v137, s49, v137
v_pk_fma_f16 v151, v152, v152, s48
v_pk_fma_f16 v148, v149, v149, s48
v_mfma_f32_32x32x16_bf16 v[120:135], v[96:99], v[236:239], 0
ds_read_b128 v[232:235], v248 offset:36864
v_and_b32_e64 v139, s49, v139
v_pk_fma_f16 v145, v146, v146, s48
v_pk_mul_f16 v154, v155, v154
v_bfe_u32 v136, v137, 2, 14
v_pk_mul_f16 v151, v152, v151
v_pk_mul_f16 v148, v149, v148
v_bfe_u32 v138, v139, 2, 14
v_pk_mul_f16 v145, v146, v145
v_mfma_f32_32x32x16_bf16 v[120:135], v[100:103], v[216:219], v[120:135]
ds_read_b128 v[236:239], v245 offset:6144
ds_read_b128 v[200:203], v244
ds_read_b128 v[204:207], v243 offset:128
ds_read_u16_d16 v136, v136
ds_read_u16_d16 v138, v138
v_exp_f16 v153, v154
v_lshrrev_b32 v137, 18, v137
v_exp_f16 v150, v151
v_lshrrev_b32 v139, 18, v139
v_exp_f16_e64 v147, v148
v_mfma_f32_32x32x16_bf16 v[120:135], v[104:107], v[220:223], v[120:135]
ds_read_b128 v[216:219], v248 offset:39936
ds_read_u16_d16_hi v137, v137
ds_read_u16_d16_hi v139, v139
v_and_b32 v141, s49, v141
v_exp_f16 v144, v145
v_and_b32 v143, s49, v143
v_exp_f16_sdwa v153, v154 dst_sel:WORD_1 dst_unused:UNUSED_PRESERVE src0_sel:WORD_1
v_bfe_u32 v140, v141, 2, 14
s_waitcnt lgkmcnt(8)
v_smfmac_f32_16x16x32_bf16 v[40:43], v[226:227], v[192:195], v246
ds_read_b128 v[220:223], v245 offset:5760
ds_read_b128 v[208:211], v243 offset:64
ds_read_b128 v[212:215], v243
ds_read_u16_d16 v140, v140
v_exp_f16_sdwa v150, v151 dst_sel:WORD_1 dst_unused:UNUSED_PRESERVE src0_sel:WORD_1
v_bfe_u32 v142, v143, 2, 14
v_exp_f16_sdwa v147, v148 dst_sel:WORD_1 dst_unused:UNUSED_PRESERVE src0_sel:WORD_1
v_smfmac_f32_16x16x32_bf16 v[24:27], v[224:225], v[196:199], v246
v_lshrrev_b32_e64 v141, 18, v141
v_exp_f16_sdwa v144, v145 dst_sel:WORD_1 dst_unused:UNUSED_PRESERVE src0_sel:WORD_1
v_lshrrev_b32_e64 v143, 18, v143
v_mfma_f32_32x32x16_bf16 v[120:135], v[108:111], v[228:231], v[120:135]
ds_read_b128 v[224:227], v245 offset:5376
ds_read_b128 v[192:195], v242 offset:128
ds_read_b128 v[196:199], v242 offset:64
ds_read_u16_d16 v142, v142
ds_read_u16_d16_hi v141, v141
ds_read_u16_d16_hi v143, v143
v_pk_add_f16 v153, v153, 1.0 op_sel_hi:[1,0]
v_pk_add_f16 v150, v150, 1.0 op_sel_hi:[1,0]
v_pk_add_f16 v147, v147, 1.0 op_sel_hi:[1,0]
v_pk_add_f16 v144, v144, 1.0 op_sel_hi:[1,0]
v_rcp_f16 v154, v153
v_rcp_f16 v151, v150
v_mfma_f32_32x32x16_bf16 v[120:135], v[112:115], v[232:235], v[120:135]
ds_read_b128 v[228:231], v248 offset:40960
v_rcp_f16 v148, v147
v_rcp_f16 v145, v144
v_rcp_f16_sdwa v154, v153 dst_sel:WORD_1 dst_unused:UNUSED_PRESERVE src0_sel:WORD_1
v_rcp_f16_sdwa v151, v150 dst_sel:WORD_1 dst_unused:UNUSED_PRESERVE src0_sel:WORD_1
s_setprio 0
s_waitcnt lgkmcnt(7)
v_smfmac_f32_16x16x32_bf16 v[8:11], v[238:239], v[200:203], v246
ds_read_b128 v[232:235], v248 offset:44032
v_rcp_f16_sdwa v148, v147 dst_sel:WORD_1 dst_unused:UNUSED_PRESERVE src0_sel:WORD_1
v_fma_mix_f32 v158, v136, v136, v158 op_sel:[0,0,0] op_sel_hi:[1,1,0]
v_smfmac_f32_16x16x32_bf16 v[40:43], v[236:237], v[204:207], v246
v_rcp_f16_sdwa v145, v144 dst_sel:WORD_1 dst_unused:UNUSED_PRESERVE src0_sel:WORD_1
v_fma_mix_f32 v158, v137, v137, v158 op_sel:[1,1,0] op_sel_hi:[1,1,0]
v_pk_mul_f16 v155, v155, v154
v_fma_mix_f32 v158, v138, v138, v158 op_sel:[0,0,0] op_sel_hi:[1,1,0]
v_mfma_f32_32x32x16_bf16 v[120:135], v[116:119], v[216:219], v[120:135]
ds_read_b128 v[236:239], v248 offset:41984
v_pk_mul_f16 v152, v152, v151
v_pk_mul_f16 v149, v149, v148
v_fma_mix_f32 v158, v139, v139, v158 op_sel:[1,1,0] op_sel_hi:[1,1,0]
v_pk_mul_f16 v146, v146, v145
v_fma_mix_f32 v158, v155, v155, v158 op_sel:[0,0,0] op_sel_hi:[1,1,0]
v_fma_mix_f32 v158, v140, v140, v158 op_sel:[0,0,0] op_sel_hi:[1,1,0]
v_fma_mix_f32 v158, v155, v155, v158 op_sel:[1,1,0] op_sel_hi:[1,1,0]
v_fma_mix_f32 v158, v152, v152, v158 op_sel:[0,0,0] op_sel_hi:[1,1,0]
v_smfmac_f32_16x16x32_bf16 v[24:27], v[222:223], v[208:211], v246
ds_read_b128 v[216:219], v248 offset:45056
s_waitcnt lgkmcnt(3)
v_fma_mix_f32 v158, v141, v141, v158 op_sel:[1,1,0] op_sel_hi:[1,1,0]
v_fma_mix_f32 v158, v152, v152, v158 op_sel:[1,1,0] op_sel_hi:[1,1,0]
v_fma_mix_f32 v158, v149, v149, v158 op_sel:[0,0,0] op_sel_hi:[1,1,0]
v_fma_mix_f32 v158, v142, v142, v158 op_sel:[0,0,0] op_sel_hi:[1,1,0]
v_smfmac_f32_16x16x32_bf16 v[8:11], v[220:221], v[212:215], v246
v_fma_mix_f32 v158, v149, v149, v158 op_sel:[1,1,0] op_sel_hi:[1,1,0]
v_fma_mix_f32 v158, v146, v146, v158 op_sel:[0,0,0] op_sel_hi:[1,1,0]
v_fma_mix_f32 v158, v143, v143, v158 op_sel:[1,1,0] op_sel_hi:[1,1,0]
v_fma_mix_f32 v158, v146, v146, v158 op_sel:[1,1,0] op_sel_hi:[1,1,0]
s_setprio 2
v_smfmac_f32_16x16x32_bf16 v[40:43], v[226:227], v[192:195], v246
ds_read_b128 v[220:223], v248 offset:43008
v_cvt_pkrtz_f16_f32 v137, v120, v121
v_cvt_pkrtz_f16_f32 v139, v122, v123
v_cvt_pkrtz_f16_f32 v141, v124, v125
v_cvt_pkrtz_f16_f32 v143, v126, v127
v_smfmac_f32_16x16x32_bf16 v[24:27], v[224:225], v[196:199], v246
v_cvt_pkrtz_f16_f32 v145, v128, v129
v_cvt_pk_f16_f32 v155, v130, v131
v_cvt_pk_f16_f32 v152, v132, v133
v_cvt_pk_f16_f32 v149, v134, v135
v_mfma_f32_32x32x16_bf16 v[120:135], v[96:99], v[228:231], 0
ds_read_b128 v[224:227], v245 offset:4992
ds_read_b128 v[200:203], v242
v_xor_b32 v244, 16, v244
ds_read_b128 v[204:207], v244 offset:128
v_pk_fma_f16 v154, v155, v155, s48
v_and_b32 v137, s49, v137
v_pk_fma_f16 v151, v152, v152, s48
v_and_b32 v139, s49, v139
v_pk_fma_f16 v148, v149, v149, s48
v_pk_mul_f16 v154, v155, v154
v_bfe_u32 v136, v137, 2, 14
v_pk_mul_f16 v151, v152, v151
s_waitcnt lgkmcnt(4)
v_mfma_f32_32x32x16_bf16 v[120:135], v[100:103], v[232:235], v[120:135]
ds_read_b128 v[228:231], v248 offset:46080
ds_read_u16_d16 v136, v136
v_pk_mul_f16 v148, v149, v148
v_bfe_u32 v138, v139, 2, 14
v_exp_f16 v153, v154
v_lshrrev_b32 v137, 18, v137
v_exp_f16 v150, v151
v_lshrrev_b32 v139, 18, v139
v_mfma_f32_32x32x16_bf16 v[120:135], v[104:107], v[236:239], v[120:135]
ds_read_b128 v[232:235], v245 offset:4608
ds_read_b128 v[208:211], v244 offset:64
ds_read_b128 v[212:215], v244
ds_read_u16_d16 v138, v138
ds_read_u16_d16_hi v137, v137
ds_read_u16_d16_hi v139, v139
v_exp_f16 v147, v148
v_and_b32 v141, s49, v141
v_and_b32 v143, s49, v143
v_exp_f16_sdwa v153, v154 dst_sel:WORD_1 dst_unused:UNUSED_PRESERVE src0_sel:WORD_1
v_bfe_u32 v140, v141, 2, 14
v_exp_f16_sdwa v150, v151 dst_sel:WORD_1 dst_unused:UNUSED_PRESERVE src0_sel:WORD_1
v_mfma_f32_32x32x16_bf16 v[120:135], v[108:111], v[216:219], v[120:135]
ds_read_b128 v[236:239], v245 offset:4224
v_xor_b32 v243, 16, v243
ds_read_b128 v[192:195], v243 offset:128
ds_read_b128 v[196:199], v243 offset:64
ds_read_u16_d16 v140, v140
v_bfe_u32 v142, v143, 2, 14
v_exp_f16_sdwa v147, v148 dst_sel:WORD_1 dst_unused:UNUSED_PRESERVE src0_sel:WORD_1
v_lshrrev_b32_e64 v141, 18, v141
v_pk_add_f16 v153, v153, 1.0 op_sel_hi:[1,0]
v_lshrrev_b32 v143, 18, v143
v_pk_add_f16 v150, v150, 1.0 op_sel_hi:[1,0]
v_pk_add_f16 v147, v147, 1.0 op_sel_hi:[1,0]
s_waitcnt lgkmcnt(9)
v_mfma_f32_32x32x16_bf16 v[120:135], v[112:115], v[220:223], v[120:135]
ds_read_b128 v[216:219], v248 offset:47104
ds_read_u16_d16 v142, v142
ds_read_u16_d16_hi v141, v141
ds_read_u16_d16_hi v143, v143
v_and_b32 v145, s49, v145
v_rcp_f16 v154, v153
v_bfe_u32 v144, v145, 2, 14
v_rcp_f16 v151, v150
v_lshrrev_b32 v145, 18, v145
v_rcp_f16_e64 v148, v147
v_smfmac_f32_16x16x32_bf16 v[8:11], v[226:227], v[200:203], v246
ds_read_b128 v[220:223], v248 offset:50176
ds_read_u16_d16 v144, v144
ds_read_u16_d16_hi v145, v145
v_rcp_f16_sdwa v154, v153 dst_sel:WORD_1 dst_unused:UNUSED_PRESERVE src0_sel:WORD_1
v_fma_mix_f32 v159, v136, v136, v159 op_sel:[0,0,0] op_sel_hi:[1,1,0]
s_waitcnt lgkmcnt(7)
v_fma_mix_f32 v159, v137, v137, v159 op_sel:[1,1,0] op_sel_hi:[1,1,0]
v_smfmac_f32_16x16x32_bf16 v[44:47], v[224:225], v[204:207], v246
v_rcp_f16_sdwa v151, v150 dst_sel:WORD_1 dst_unused:UNUSED_PRESERVE src0_sel:WORD_1
v_fma_mix_f32 v159, v138, v138, v159 op_sel:[0,0,0] op_sel_hi:[1,1,0]
v_mfma_f32_32x32x16_bf16 v[120:135], v[116:119], v[228:231], v[120:135]
ds_read_b128 v[224:227], v248 offset:48128
v_rcp_f16_sdwa v148, v147 dst_sel:WORD_1 dst_unused:UNUSED_PRESERVE src0_sel:WORD_1
v_fma_mix_f32 v159, v139, v139, v159 op_sel:[1,1,0] op_sel_hi:[1,1,0]
v_pk_mul_f16 v155, v155, v154
v_fma_mix_f32 v159, v140, v140, v159 op_sel:[0,0,0] op_sel_hi:[1,1,0]
v_pk_mul_f16 v152, v152, v151
s_waitcnt lgkmcnt(4)
v_fma_mix_f32 v159, v141, v141, v159 op_sel:[1,1,0] op_sel_hi:[1,1,0]
v_pk_mul_f16 v149, v149, v148
v_fma_mix_f32 v159, v155, v155, v159 op_sel:[0,0,0] op_sel_hi:[1,1,0]
v_smfmac_f32_16x16x32_bf16 v[28:31], v[234:235], v[208:211], v246
ds_read_b128 v[228:231], v248 offset:51200
v_fma_mix_f32 v159, v142, v142, v159 op_sel:[0,0,0] op_sel_hi:[1,1,0]
v_fma_mix_f32 v159, v155, v155, v159 op_sel:[1,1,0] op_sel_hi:[1,1,0]
v_fma_mix_f32 v159, v143, v143, v159 op_sel:[1,1,0] op_sel_hi:[1,1,0]
v_fma_mix_f32 v159, v152, v152, v159 op_sel:[0,0,0] op_sel_hi:[1,1,0]
v_smfmac_f32_16x16x32_bf16 v[12:15], v[232:233], v[212:215], v246
v_fma_mix_f32 v159, v152, v152, v159 op_sel:[1,1,0] op_sel_hi:[1,1,0]
s_waitcnt lgkmcnt(2)
v_fma_mix_f32 v159, v144, v144, v159 op_sel:[0,0,0] op_sel_hi:[1,1,0]
v_fma_mix_f32 v159, v149, v149, v159 op_sel:[0,0,0] op_sel_hi:[1,1,0]
v_fma_mix_f32 v159, v145, v145, v159 op_sel:[1,1,0] op_sel_hi:[1,1,0]
v_fma_mix_f32 v159, v149, v149, v159 op_sel:[1,1,0] op_sel_hi:[1,1,0]
s_setprio 1
v_smfmac_f32_16x16x32_bf16 v[44:47], v[238:239], v[192:195], v246
ds_read_b128 v[232:235], v248 offset:49152
v_cvt_pkrtz_f16_f32 v137, v120, v121
v_cvt_pkrtz_f16_f32 v139, v122, v123
v_cvt_pkrtz_f16_f32 v141, v124, v125
v_cvt_pkrtz_f16_f32 v143, v126, v127
v_cvt_pk_f16_f32 v155, v128, v129
v_smfmac_f32_16x16x32_bf16 v[28:31], v[236:237], v[196:199], v246
v_cvt_pk_f16_f32 v152, v130, v131
v_cvt_pk_f16_f32 v149, v132, v133
v_cvt_pk_f16_f32 v146, v134, v135
v_pk_fma_f16 v154, v155, v155, s48
v_and_b32_e64 v137, s49, v137
v_mfma_f32_32x32x16_bf16 v[120:135], v[96:99], v[216:219], 0
ds_read_b128 v[236:239], v248 offset:52224
v_pk_fma_f16 v151, v152, v152, s48
v_pk_fma_f16 v148, v149, v149, s48
v_and_b32_e64 v139, s49, v139
v_pk_fma_f16 v145, v146, v146, s48
v_pk_mul_f16 v154, v155, v154
v_bfe_u32 v136, v137, 2, 14
v_pk_mul_f16 v151, v152, v151
v_pk_mul_f16 v148, v149, v148
v_bfe_u32 v138, v139, 2, 14
v_pk_mul_f16 v145, v146, v145
v_mfma_f32_32x32x16_bf16 v[120:135], v[100:103], v[220:223], v[120:135]
ds_read_b128 v[216:219], v245 offset:3840
ds_read_b128 v[200:203], v243
v_xor_b32 v242, 16, v242
ds_read_b128 v[204:207], v242 offset:128
ds_read_u16_d16 v136, v136
ds_read_u16_d16 v138, v138
v_exp_f16 v153, v154
v_lshrrev_b32 v137, 18, v137
v_exp_f16 v150, v151
v_lshrrev_b32 v139, 18, v139
v_exp_f16 v147, v148
v_and_b32_e64 v141, s49, v141
v_exp_f16 v144, v145
s_waitcnt lgkmcnt(5)
v_mfma_f32_32x32x16_bf16 v[120:135], v[104:107], v[224:227], v[120:135]
ds_read_b128 v[220:223], v245 offset:3456
ds_read_b128 v[208:211], v242 offset:64
ds_read_b128 v[212:215], v242
ds_read_u16_d16_hi v137, v137
ds_read_u16_d16_hi v139, v139
v_and_b32_e64 v143, s49, v143
v_exp_f16_sdwa v153, v154 dst_sel:WORD_1 dst_unused:UNUSED_PRESERVE src0_sel:WORD_1
v_bfe_u32 v140, v141, 2, 14
v_exp_f16_sdwa v150, v151 dst_sel:WORD_1 dst_unused:UNUSED_PRESERVE src0_sel:WORD_1
v_bfe_u32 v142, v143, 2, 14
v_exp_f16_sdwa v147, v148 dst_sel:WORD_1 dst_unused:UNUSED_PRESERVE src0_sel:WORD_1
v_lshrrev_b32_e64 v141, 18, v141
v_mfma_f32_32x32x16_bf16 v[120:135], v[108:111], v[228:231], v[120:135]
ds_read_b128 v[224:227], v248 offset:53248
ds_read_u16_d16 v140, v140
ds_read_u16_d16 v142, v142
ds_read_u16_d16_hi v141, v141
v_exp_f16_sdwa v144, v145 dst_sel:WORD_1 dst_unused:UNUSED_PRESERVE src0_sel:WORD_1
v_lshrrev_b32_e64 v143, 18, v143
v_pk_add_f16 v153, v153, 1.0 op_sel_hi:[1,0]
v_pk_add_f16 v150, v150, 1.0 op_sel_hi:[1,0]
v_pk_add_f16 v147, v147, 1.0 op_sel_hi:[1,0]
v_pk_add_f16 v144, v144, 1.0 op_sel_hi:[1,0]
v_rcp_f16 v154, v153
v_rcp_f16 v151, v150
v_mfma_f32_32x32x16_bf16 v[120:135], v[112:115], v[232:235], v[120:135]
ds_read_b128 v[228:231], v248 offset:56320
ds_read_u16_d16_hi v143, v143
v_rcp_f16_e64 v148, v147
v_rcp_f16 v145, v144
v_rcp_f16_sdwa v154, v153 dst_sel:WORD_1 dst_unused:UNUSED_PRESERVE src0_sel:WORD_1
v_rcp_f16_sdwa v151, v150 dst_sel:WORD_1 dst_unused:UNUSED_PRESERVE src0_sel:WORD_1
s_setprio 0
v_rcp_f16_sdwa v148, v147 dst_sel:WORD_1 dst_unused:UNUSED_PRESERVE src0_sel:WORD_1
s_waitcnt lgkmcnt(6)
v_fma_mix_f32 v160, v136, v136, v160 op_sel:[0,0,0] op_sel_hi:[1,1,0]
v_mfma_f32_32x32x16_bf16 v[120:135], v[116:119], v[236:239], v[120:135]
ds_read_b128 v[232:235], v248 offset:54272
v_rcp_f16_sdwa v145, v144 dst_sel:WORD_1 dst_unused:UNUSED_PRESERVE src0_sel:WORD_1
v_fma_mix_f32 v160, v137, v137, v160 op_sel:[1,1,0] op_sel_hi:[1,1,0]
v_pk_mul_f16 v155, v155, v154
v_fma_mix_f32 v160, v138, v138, v160 op_sel:[0,0,0] op_sel_hi:[1,1,0]
v_pk_mul_f16 v152, v152, v151
v_pk_mul_f16 v149, v149, v148
v_fma_mix_f32 v160, v139, v139, v160 op_sel:[1,1,0] op_sel_hi:[1,1,0]
v_pk_mul_f16 v146, v146, v145
v_fma_mix_f32 v160, v155, v155, v160 op_sel:[0,0,0] op_sel_hi:[1,1,0]
v_smfmac_f32_16x16x32_bf16 v[12:15], v[218:219], v[200:203], v246
ds_read_b128 v[236:239], v248 offset:57344
s_waitcnt lgkmcnt(4)
v_fma_mix_f32 v160, v140, v140, v160 op_sel:[0,0,0] op_sel_hi:[1,1,0]
v_fma_mix_f32 v160, v155, v155, v160 op_sel:[1,1,0] op_sel_hi:[1,1,0]
v_fma_mix_f32 v160, v152, v152, v160 op_sel:[0,0,0] op_sel_hi:[1,1,0]
v_fma_mix_f32 v160, v141, v141, v160 op_sel:[1,1,0] op_sel_hi:[1,1,0]
v_fma_mix_f32 v160, v152, v152, v160 op_sel:[1,1,0] op_sel_hi:[1,1,0]
v_smfmac_f32_16x16x32_bf16 v[44:47], v[216:217], v[204:207], v246
v_fma_mix_f32 v160, v149, v149, v160 op_sel:[0,0,0] op_sel_hi:[1,1,0]
v_fma_mix_f32 v160, v142, v142, v160 op_sel:[0,0,0] op_sel_hi:[1,1,0]
v_fma_mix_f32 v160, v149, v149, v160 op_sel:[1,1,0] op_sel_hi:[1,1,0]
v_fma_mix_f32 v160, v146, v146, v160 op_sel:[0,0,0] op_sel_hi:[1,1,0]
s_waitcnt lgkmcnt(2)
v_fma_mix_f32 v160, v143, v143, v160 op_sel:[1,1,0] op_sel_hi:[1,1,0]
v_fma_mix_f32 v160, v146, v146, v160 op_sel:[1,1,0] op_sel_hi:[1,1,0]
s_setprio 2
v_smfmac_f32_16x16x32_bf16 v[28:31], v[222:223], v[208:211], v246
ds_read_b128 v[216:219], v248 offset:55296
v_cvt_pkrtz_f16_f32 v137, v120, v121
v_cvt_pkrtz_f16_f32 v139, v122, v123
v_cvt_pkrtz_f16_f32 v141, v124, v125
v_cvt_pkrtz_f16_f32 v143, v126, v127
v_smfmac_f32_16x16x32_bf16 v[12:15], v[220:221], v[212:215], v246
v_cvt_pkrtz_f16_f32 v145, v128, v129
v_cvt_pk_f16_f32 v155, v130, v131
v_cvt_pk_f16_f32 v152, v132, v133
v_cvt_pk_f16_f32 v149, v134, v135
v_mfma_f32_32x32x16_bf16 v[120:135], v[96:99], v[224:227], 0
ds_read_b128 v[220:223], v245 offset:3072
v_xor_b32 v244, 32, v244
ds_read_b128 v[192:195], v244 offset:128
ds_read_b128 v[196:199], v244 offset:64
v_pk_fma_f16 v154, v155, v155, s48
v_and_b32 v137, s49, v137
v_pk_fma_f16 v151, v152, v152, s48
v_and_b32_e64 v139, s49, v139
v_pk_fma_f16 v148, v149, v149, s48
v_pk_mul_f16 v154, v155, v154
v_bfe_u32 v136, v137, 2, 14
v_pk_mul_f16 v151, v152, v151
v_mfma_f32_32x32x16_bf16 v[120:135], v[100:103], v[228:231], v[120:135]
ds_read_b128 v[224:227], v248 offset:58368
ds_read_u16_d16 v136, v136
v_pk_mul_f16 v148, v149, v148
v_bfe_u32 v138, v139, 2, 14
v_exp_f16 v153, v154
v_lshrrev_b32 v137, 18, v137
v_exp_f16 v150, v151
v_lshrrev_b32 v139, 18, v139
s_waitcnt lgkmcnt(5)
v_mfma_f32_32x32x16_bf16 v[120:135], v[104:107], v[232:235], v[120:135]
ds_read_b128 v[228:231], v245 offset:2688
ds_read_b128 v[200:203], v244
v_xor_b32 v243, 32, v243
ds_read_b128 v[204:207], v243 offset:128
ds_read_u16_d16 v138, v138
ds_read_u16_d16_hi v137, v137
ds_read_u16_d16_hi v139, v139
v_exp_f16 v147, v148
v_and_b32 v141, s49, v141
v_and_b32_e64 v143, s49, v143
v_exp_f16_sdwa v153, v154 dst_sel:WORD_1 dst_unused:UNUSED_PRESERVE src0_sel:WORD_1
v_bfe_u32 v140, v141, 2, 14
v_exp_f16_sdwa v150, v151 dst_sel:WORD_1 dst_unused:UNUSED_PRESERVE src0_sel:WORD_1
v_mfma_f32_32x32x16_bf16 v[120:135], v[108:111], v[236:239], v[120:135]
ds_read_b128 v[232:235], v245 offset:2304
ds_read_b128 v[208:211], v243 offset:64
ds_read_b128 v[212:215], v243
ds_read_u16_d16 v140, v140
v_bfe_u32 v142, v143, 2, 14
v_exp_f16_sdwa v147, v148 dst_sel:WORD_1 dst_unused:UNUSED_PRESERVE src0_sel:WORD_1
v_lshrrev_b32_e64 v141, 18, v141
v_pk_add_f16 v153, v153, 1.0 op_sel_hi:[1,0]
v_lshrrev_b32_e64 v143, 18, v143
v_pk_add_f16 v150, v150, 1.0 op_sel_hi:[1,0]
v_pk_add_f16 v147, v147, 1.0 op_sel_hi:[1,0]
v_mfma_f32_32x32x16_bf16 v[120:135], v[112:115], v[216:219], v[120:135]
ds_read_b128 v[236:239], v248 offset:59392
ds_read_u16_d16 v142, v142
ds_read_u16_d16_hi v141, v141
ds_read_u16_d16_hi v143, v143
v_and_b32 v145, s49, v145
v_rcp_f16 v154, v153
v_bfe_u32 v144, v145, 2, 14
v_rcp_f16 v151, v150
v_lshrrev_b32 v145, 18, v145
v_rcp_f16 v148, v147
s_waitcnt lgkmcnt(8)
v_smfmac_f32_16x16x32_bf16 v[36:39], v[222:223], v[192:195], v246
ds_read_b128 v[216:219], v248 offset:62464
ds_read_u16_d16 v144, v144
ds_read_u16_d16_hi v145, v145
v_rcp_f16_sdwa v154, v153 dst_sel:WORD_1 dst_unused:UNUSED_PRESERVE src0_sel:WORD_1
v_fma_mix_f32 v161, v136, v136, v161 op_sel:[0,0,0] op_sel_hi:[1,1,0]
v_fma_mix_f32 v161, v137, v137, v161 op_sel:[1,1,0] op_sel_hi:[1,1,0]
v_smfmac_f32_16x16x32_bf16 v[20:23], v[220:221], v[196:199], v246
v_rcp_f16_sdwa v151, v150 dst_sel:WORD_1 dst_unused:UNUSED_PRESERVE src0_sel:WORD_1
v_fma_mix_f32 v161, v138, v138, v161 op_sel:[0,0,0] op_sel_hi:[1,1,0]
v_mfma_f32_32x32x16_bf16 v[120:135], v[116:119], v[224:227], v[120:135]
ds_read_b128 v[220:223], v248 offset:60416
v_rcp_f16_sdwa v148, v147 dst_sel:WORD_1 dst_unused:UNUSED_PRESERVE src0_sel:WORD_1
v_fma_mix_f32 v161, v139, v139, v161 op_sel:[1,1,0] op_sel_hi:[1,1,0]
v_pk_mul_f16 v155, v155, v154
s_waitcnt lgkmcnt(6)
v_fma_mix_f32 v161, v140, v140, v161 op_sel:[0,0,0] op_sel_hi:[1,1,0]
v_pk_mul_f16 v152, v152, v151
s_waitcnt lgkmcnt(4)
v_fma_mix_f32 v161, v141, v141, v161 op_sel:[1,1,0] op_sel_hi:[1,1,0]
v_pk_mul_f16 v149, v149, v148
v_fma_mix_f32 v161, v155, v155, v161 op_sel:[0,0,0] op_sel_hi:[1,1,0]
v_smfmac_f32_16x16x32_bf16 v[4:7], v[230:231], v[200:203], v246
ds_read_b128 v[224:227], v248 offset:63488
v_fma_mix_f32 v161, v142, v142, v161 op_sel:[0,0,0] op_sel_hi:[1,1,0]
v_fma_mix_f32 v161, v155, v155, v161 op_sel:[1,1,0] op_sel_hi:[1,1,0]
v_fma_mix_f32 v161, v143, v143, v161 op_sel:[1,1,0] op_sel_hi:[1,1,0]
v_fma_mix_f32 v161, v152, v152, v161 op_sel:[0,0,0] op_sel_hi:[1,1,0]
v_smfmac_f32_16x16x32_bf16 v[36:39], v[228:229], v[204:207], v246
v_fma_mix_f32 v161, v152, v152, v161 op_sel:[1,1,0] op_sel_hi:[1,1,0]
s_waitcnt lgkmcnt(2)
v_fma_mix_f32 v161, v144, v144, v161 op_sel:[0,0,0] op_sel_hi:[1,1,0]
v_fma_mix_f32 v161, v149, v149, v161 op_sel:[0,0,0] op_sel_hi:[1,1,0]
v_fma_mix_f32 v161, v145, v145, v161 op_sel:[1,1,0] op_sel_hi:[1,1,0]
v_fma_mix_f32 v161, v149, v149, v161 op_sel:[1,1,0] op_sel_hi:[1,1,0]
s_setprio 1
v_smfmac_f32_16x16x32_bf16 v[20:23], v[234:235], v[208:211], v246
ds_read_b128 v[228:231], v248 offset:61440
v_cvt_pkrtz_f16_f32 v137, v120, v121
v_cvt_pkrtz_f16_f32 v139, v122, v123
v_cvt_pkrtz_f16_f32 v141, v124, v125
v_cvt_pkrtz_f16_f32 v143, v126, v127
v_cvt_pk_f16_f32 v155, v128, v129
v_smfmac_f32_16x16x32_bf16 v[4:7], v[232:233], v[212:215], v246
v_cvt_pk_f16_f32 v152, v130, v131
v_cvt_pk_f16_f32 v149, v132, v133
v_cvt_pk_f16_f32 v146, v134, v135
v_pk_fma_f16 v154, v155, v155, s48
v_and_b32_e64 v137, s49, v137
v_mfma_f32_32x32x16_bf16 v[120:135], v[96:99], v[236:239], 0
ds_read_b128 v[232:235], v248 offset:64512
v_pk_fma_f16 v151, v152, v152, s48
v_pk_fma_f16 v148, v149, v149, s48
v_and_b32_e64 v139, s49, v139
v_pk_fma_f16 v145, v146, v146, s48
v_pk_mul_f16 v154, v155, v154
v_bfe_u32 v136, v137, 2, 14
v_pk_mul_f16 v151, v152, v151
v_pk_mul_f16 v148, v149, v148
v_bfe_u32 v138, v139, 2, 14
v_pk_mul_f16 v145, v146, v145
v_mfma_f32_32x32x16_bf16 v[120:135], v[100:103], v[216:219], v[120:135]
ds_read_b128 v[236:239], v245 offset:1920
v_xor_b32 v242, 32, v242
ds_read_b128 v[192:195], v242 offset:128
ds_read_b128 v[196:199], v242 offset:64
ds_read_u16_d16 v136, v136
ds_read_u16_d16 v138, v138
v_exp_f16 v153, v154
v_lshrrev_b32 v137, 18, v137
v_exp_f16 v150, v151
v_lshrrev_b32 v139, 18, v139
v_exp_f16 v147, v148
v_and_b32 v141, s49, v141
v_exp_f16 v144, v145
s_waitcnt lgkmcnt(5)
v_mfma_f32_32x32x16_bf16 v[120:135], v[104:107], v[220:223], v[120:135]
ds_read_b128 v[216:219], v245 offset:1536
ds_read_b128 v[200:203], v242
v_xor_b32 v244, 16, v244
ds_read_b128 v[204:207], v244 offset:128
ds_read_u16_d16_hi v137, v137
ds_read_u16_d16_hi v139, v139
v_and_b32_e64 v143, s49, v143
v_exp_f16_sdwa v153, v154 dst_sel:WORD_1 dst_unused:UNUSED_PRESERVE src0_sel:WORD_1
v_bfe_u32 v140, v141, 2, 14
v_exp_f16_sdwa v150, v151 dst_sel:WORD_1 dst_unused:UNUSED_PRESERVE src0_sel:WORD_1
v_bfe_u32 v142, v143, 2, 14
v_exp_f16_sdwa v147, v148 dst_sel:WORD_1 dst_unused:UNUSED_PRESERVE src0_sel:WORD_1
v_lshrrev_b32_e64 v141, 18, v141
v_mfma_f32_32x32x16_bf16 v[120:135], v[108:111], v[224:227], v[120:135]
ds_read_b128 v[220:223], v249
ds_read_u16_d16 v140, v140
ds_read_u16_d16 v142, v142
ds_read_u16_d16_hi v141, v141
v_exp_f16_sdwa v144, v145 dst_sel:WORD_1 dst_unused:UNUSED_PRESERVE src0_sel:WORD_1
v_lshrrev_b32_e64 v143, 18, v143
v_pk_add_f16 v153, v153, 1.0 op_sel_hi:[1,0]
v_pk_add_f16 v150, v150, 1.0 op_sel_hi:[1,0]
v_pk_add_f16 v147, v147, 1.0 op_sel_hi:[1,0]
v_pk_add_f16 v144, v144, 1.0 op_sel_hi:[1,0]
v_rcp_f16 v154, v153
v_rcp_f16 v151, v150
v_mfma_f32_32x32x16_bf16 v[120:135], v[112:115], v[228:231], v[120:135]
ds_read_b128 v[224:227], v249 offset:3072
ds_read_u16_d16_hi v143, v143
v_rcp_f16_e64 v148, v147
v_rcp_f16 v145, v144
v_rcp_f16_sdwa v154, v153 dst_sel:WORD_1 dst_unused:UNUSED_PRESERVE src0_sel:WORD_1
v_rcp_f16_sdwa v151, v150 dst_sel:WORD_1 dst_unused:UNUSED_PRESERVE src0_sel:WORD_1
s_setprio 0
v_rcp_f16_sdwa v148, v147 dst_sel:WORD_1 dst_unused:UNUSED_PRESERVE src0_sel:WORD_1
s_waitcnt lgkmcnt(6)
v_fma_mix_f32 v162, v136, v136, v162 op_sel:[0,0,0] op_sel_hi:[1,1,0]
v_mfma_f32_32x32x16_bf16 v[120:135], v[116:119], v[232:235], v[120:135]
ds_read_b128 v[228:231], v249 offset:1024
v_rcp_f16_sdwa v145, v144 dst_sel:WORD_1 dst_unused:UNUSED_PRESERVE src0_sel:WORD_1
v_fma_mix_f32 v162, v137, v137, v162 op_sel:[1,1,0] op_sel_hi:[1,1,0]
v_pk_mul_f16 v155, v155, v154
v_fma_mix_f32 v162, v138, v138, v162 op_sel:[0,0,0] op_sel_hi:[1,1,0]
v_pk_mul_f16 v152, v152, v151
v_pk_mul_f16 v149, v149, v148
v_fma_mix_f32 v162, v139, v139, v162 op_sel:[1,1,0] op_sel_hi:[1,1,0]
v_pk_mul_f16 v146, v146, v145
v_fma_mix_f32 v162, v155, v155, v162 op_sel:[0,0,0] op_sel_hi:[1,1,0]
v_smfmac_f32_16x16x32_bf16 v[36:39], v[238:239], v[192:195], v246
ds_read_b128 v[232:235], v249 offset:4096
s_waitcnt lgkmcnt(4)
v_fma_mix_f32 v162, v140, v140, v162 op_sel:[0,0,0] op_sel_hi:[1,1,0]
v_fma_mix_f32 v162, v155, v155, v162 op_sel:[1,1,0] op_sel_hi:[1,1,0]
v_fma_mix_f32 v162, v152, v152, v162 op_sel:[0,0,0] op_sel_hi:[1,1,0]
v_fma_mix_f32 v162, v141, v141, v162 op_sel:[1,1,0] op_sel_hi:[1,1,0]
v_fma_mix_f32 v162, v152, v152, v162 op_sel:[1,1,0] op_sel_hi:[1,1,0]
v_smfmac_f32_16x16x32_bf16 v[20:23], v[236:237], v[196:199], v246
v_fma_mix_f32 v162, v149, v149, v162 op_sel:[0,0,0] op_sel_hi:[1,1,0]
v_fma_mix_f32 v162, v142, v142, v162 op_sel:[0,0,0] op_sel_hi:[1,1,0]
v_fma_mix_f32 v162, v149, v149, v162 op_sel:[1,1,0] op_sel_hi:[1,1,0]
v_fma_mix_f32 v162, v146, v146, v162 op_sel:[0,0,0] op_sel_hi:[1,1,0]
s_waitcnt lgkmcnt(2)
v_fma_mix_f32 v162, v143, v143, v162 op_sel:[1,1,0] op_sel_hi:[1,1,0]
v_fma_mix_f32 v162, v146, v146, v162 op_sel:[1,1,0] op_sel_hi:[1,1,0]
s_setprio 2
v_smfmac_f32_16x16x32_bf16 v[4:7], v[218:219], v[200:203], v246
ds_read_b128 v[236:239], v249 offset:2048
v_cvt_pkrtz_f16_f32 v137, v120, v121
v_cvt_pkrtz_f16_f32 v139, v122, v123
v_cvt_pkrtz_f16_f32 v141, v124, v125
v_cvt_pkrtz_f16_f32 v143, v126, v127
v_smfmac_f32_16x16x32_bf16 v[32:35], v[216:217], v[204:207], v246
v_cvt_pkrtz_f16_f32 v145, v128, v129
v_cvt_pk_f16_f32 v155, v130, v131
v_cvt_pk_f16_f32 v152, v132, v133
v_cvt_pk_f16_f32 v149, v134, v135
v_mfma_f32_32x32x16_bf16 v[120:135], v[96:99], v[220:223], 0
ds_read_b128 v[216:219], v245 offset:1152
ds_read_b128 v[208:211], v244 offset:64
ds_read_b128 v[212:215], v244
v_pk_fma_f16 v154, v155, v155, s48
v_and_b32_e64 v137, s49, v137
v_pk_fma_f16 v151, v152, v152, s48
v_and_b32_e64 v139, s49, v139
v_pk_fma_f16 v148, v149, v149, s48
v_pk_mul_f16 v154, v155, v154
v_bfe_u32 v136, v137, 2, 14
v_pk_mul_f16 v151, v152, v151
v_mfma_f32_32x32x16_bf16 v[120:135], v[100:103], v[224:227], v[120:135]
ds_read_b128 v[220:223], v249 offset:5120
ds_read_u16_d16 v136, v136
v_pk_mul_f16 v148, v149, v148
v_bfe_u32 v138, v139, 2, 14
v_exp_f16 v153, v154
v_lshrrev_b32 v137, 18, v137
v_exp_f16 v150, v151
v_lshrrev_b32 v139, 18, v139
s_waitcnt lgkmcnt(5)
v_mfma_f32_32x32x16_bf16 v[120:135], v[104:107], v[228:231], v[120:135]
ds_read_b128 v[224:227], v245 offset:768
v_xor_b32 v243, 16, v243
ds_read_b128 v[192:195], v243 offset:128
ds_read_b128 v[196:199], v243 offset:64
ds_read_u16_d16 v138, v138
ds_read_u16_d16_hi v137, v137
ds_read_u16_d16_hi v139, v139
v_exp_f16 v147, v148
v_and_b32 v141, s49, v141
v_and_b32_e64 v143, s49, v143
v_exp_f16_sdwa v153, v154 dst_sel:WORD_1 dst_unused:UNUSED_PRESERVE src0_sel:WORD_1
v_bfe_u32 v140, v141, 2, 14
v_exp_f16_sdwa v150, v151 dst_sel:WORD_1 dst_unused:UNUSED_PRESERVE src0_sel:WORD_1
v_mfma_f32_32x32x16_bf16 v[120:135], v[108:111], v[232:235], v[120:135]
ds_read_b128 v[228:231], v245 offset:384
ds_read_b128 v[200:203], v243
v_xor_b32 v242, 16, v242
ds_read_b128 v[204:207], v242 offset:128
ds_read_u16_d16 v140, v140
v_bfe_u32 v142, v143, 2, 14
v_exp_f16_sdwa v147, v148 dst_sel:WORD_1 dst_unused:UNUSED_PRESERVE src0_sel:WORD_1
v_lshrrev_b32 v141, 18, v141
v_pk_add_f16 v153, v153, 1.0 op_sel_hi:[1,0]
v_lshrrev_b32_e64 v143, 18, v143
v_pk_add_f16 v150, v150, 1.0 op_sel_hi:[1,0]
v_pk_add_f16 v147, v147, 1.0 op_sel_hi:[1,0]
v_mfma_f32_32x32x16_bf16 v[120:135], v[112:115], v[236:239], v[120:135]
ds_read_b128 v[232:235], v249 offset:6144
ds_read_u16_d16 v142, v142
ds_read_u16_d16_hi v141, v141
ds_read_u16_d16_hi v143, v143
v_and_b32 v145, s49, v145
v_rcp_f16 v154, v153
v_bfe_u32 v144, v145, 2, 14
v_rcp_f16 v151, v150
v_lshrrev_b32 v145, 18, v145
v_rcp_f16 v148, v147
s_waitcnt lgkmcnt(8)
v_smfmac_f32_16x16x32_bf16 v[16:19], v[218:219], v[208:211], v246
ds_read_b128 v[236:239], v249 offset:9216
ds_read_u16_d16 v144, v144
ds_read_u16_d16_hi v145, v145
v_rcp_f16_sdwa v154, v153 dst_sel:WORD_1 dst_unused:UNUSED_PRESERVE src0_sel:WORD_1
v_fma_mix_f32 v163, v136, v136, v163 op_sel:[0,0,0] op_sel_hi:[1,1,0]
v_fma_mix_f32 v163, v137, v137, v163 op_sel:[1,1,0] op_sel_hi:[1,1,0]
v_smfmac_f32_16x16x32_bf16 v[0:3], v[216:217], v[212:215], v246
v_rcp_f16_sdwa v151, v150 dst_sel:WORD_1 dst_unused:UNUSED_PRESERVE src0_sel:WORD_1
v_fma_mix_f32 v163, v138, v138, v163 op_sel:[0,0,0] op_sel_hi:[1,1,0]
v_mfma_f32_32x32x16_bf16 v[120:135], v[116:119], v[220:223], v[120:135]
ds_read_b128 v[216:219], v249 offset:7168
v_rcp_f16_sdwa v148, v147 dst_sel:WORD_1 dst_unused:UNUSED_PRESERVE src0_sel:WORD_1
v_fma_mix_f32 v163, v139, v139, v163 op_sel:[1,1,0] op_sel_hi:[1,1,0]
v_pk_mul_f16 v155, v155, v154
s_waitcnt lgkmcnt(6)
v_fma_mix_f32 v163, v140, v140, v163 op_sel:[0,0,0] op_sel_hi:[1,1,0]
v_pk_mul_f16 v152, v152, v151
s_waitcnt lgkmcnt(4)
v_fma_mix_f32 v163, v141, v141, v163 op_sel:[1,1,0] op_sel_hi:[1,1,0]
v_pk_mul_f16 v149, v149, v148
v_fma_mix_f32 v163, v155, v155, v163 op_sel:[0,0,0] op_sel_hi:[1,1,0]
v_smfmac_f32_16x16x32_bf16 v[32:35], v[226:227], v[192:195], v246
ds_read_b128 v[220:223], v249 offset:10240
v_fma_mix_f32 v163, v142, v142, v163 op_sel:[0,0,0] op_sel_hi:[1,1,0]
v_fma_mix_f32 v163, v155, v155, v163 op_sel:[1,1,0] op_sel_hi:[1,1,0]
v_fma_mix_f32 v163, v143, v143, v163 op_sel:[1,1,0] op_sel_hi:[1,1,0]
v_fma_mix_f32 v163, v152, v152, v163 op_sel:[0,0,0] op_sel_hi:[1,1,0]
v_smfmac_f32_16x16x32_bf16 v[16:19], v[224:225], v[196:199], v246
v_fma_mix_f32 v163, v152, v152, v163 op_sel:[1,1,0] op_sel_hi:[1,1,0]
s_waitcnt lgkmcnt(2)
v_fma_mix_f32 v163, v144, v144, v163 op_sel:[0,0,0] op_sel_hi:[1,1,0]
v_fma_mix_f32 v163, v149, v149, v163 op_sel:[0,0,0] op_sel_hi:[1,1,0]
v_fma_mix_f32 v163, v145, v145, v163 op_sel:[1,1,0] op_sel_hi:[1,1,0]
v_fma_mix_f32 v163, v149, v149, v163 op_sel:[1,1,0] op_sel_hi:[1,1,0]
s_setprio 1
v_smfmac_f32_16x16x32_bf16 v[0:3], v[230:231], v[200:203], v246
ds_read_b128 v[224:227], v249 offset:8192
v_cvt_pkrtz_f16_f32 v137, v120, v121
v_cvt_pkrtz_f16_f32 v139, v122, v123
v_cvt_pkrtz_f16_f32 v141, v124, v125
v_cvt_pkrtz_f16_f32 v143, v126, v127
v_smfmac_f32_16x16x32_bf16 v[32:35], v[228:229], v[204:207], v246
v_cvt_pk_f16_f32 v155, v128, v129
v_cvt_pk_f16_f32 v152, v130, v131
v_cvt_pk_f16_f32 v149, v132, v133
v_cvt_pk_f16_f32 v146, v134, v135
v_pk_fma_f16 v154, v155, v155, s48
v_mfma_f32_32x32x16_bf16 v[120:135], v[96:99], v[232:235], 0
ds_read_b128 v[228:231], v249 offset:11264
v_and_b32_e64 v137, s49, v137
v_pk_fma_f16 v151, v152, v152, s48
v_pk_fma_f16 v148, v149, v149, s48
v_and_b32_e64 v139, s49, v139
v_pk_fma_f16 v145, v146, v146, s48
v_pk_mul_f16 v154, v155, v154
v_bfe_u32 v136, v137, 2, 14
v_pk_mul_f16 v151, v152, v151
v_pk_mul_f16 v148, v149, v148
v_bfe_u32 v138, v139, 2, 14
v_mfma_f32_32x32x16_bf16 v[120:135], v[100:103], v[236:239], v[120:135]
ds_read_b128 v[232:235], v245
ds_read_b128 v[208:211], v242 offset:64
ds_read_b128 v[212:215], v242
ds_read_u16_d16 v136, v136
ds_read_u16_d16 v138, v138
v_pk_mul_f16 v145, v146, v145
v_exp_f16 v153, v154
v_lshrrev_b32 v137, 18, v137
v_exp_f16 v150, v151
v_lshrrev_b32 v139, 18, v139
v_exp_f16 v147, v148
s_waitcnt lgkmcnt(6)
v_mfma_f32_32x32x16_bf16 v[120:135], v[104:107], v[216:219], v[120:135]
ds_read_b128 v[236:239], v249 offset:12288
ds_read_u16_d16_hi v137, v137
ds_read_u16_d16_hi v139, v139
v_and_b32 v141, s49, v141
v_exp_f16 v144, v145
v_and_b32_e64 v143, s49, v143
v_exp_f16_sdwa v153, v154 dst_sel:WORD_1 dst_unused:UNUSED_PRESERVE src0_sel:WORD_1
v_bfe_u32 v140, v141, 2, 14
v_exp_f16_sdwa v150, v151 dst_sel:WORD_1 dst_unused:UNUSED_PRESERVE src0_sel:WORD_1
v_bfe_u32 v142, v143, 2, 14
v_mfma_f32_32x32x16_bf16 v[120:135], v[108:111], v[220:223], v[120:135]
ds_read_b128 v[216:219], v249 offset:15360
ds_read_u16_d16 v140, v140
ds_read_u16_d16 v142, v142
v_exp_f16_sdwa v147, v148 dst_sel:WORD_1 dst_unused:UNUSED_PRESERVE src0_sel:WORD_1
v_lshrrev_b32_e64 v141, 18, v141
v_exp_f16_sdwa v144, v145 dst_sel:WORD_1 dst_unused:UNUSED_PRESERVE src0_sel:WORD_1
v_lshrrev_b32_e64 v143, 18, v143
v_pk_add_f16 v153, v153, 1.0 op_sel_hi:[1,0]
v_pk_add_f16 v150, v150, 1.0 op_sel_hi:[1,0]
v_pk_add_f16 v147, v147, 1.0 op_sel_hi:[1,0]
v_mfma_f32_32x32x16_bf16 v[120:135], v[112:115], v[224:227], v[120:135]
ds_read_b128 v[220:223], v249 offset:13312
ds_read_u16_d16_hi v141, v141
ds_read_u16_d16_hi v143, v143
v_pk_add_f16 v144, v144, 1.0 op_sel_hi:[1,0]
v_rcp_f16 v154, v153
v_rcp_f16 v151, v150
v_rcp_f16 v148, v147
v_rcp_f16 v145, v144
s_waitcnt lgkmcnt(6)
v_mfma_f32_32x32x16_bf16 v[120:135], v[116:119], v[228:231], v[120:135]
ds_read_b128 v[224:227], v249 offset:16384
v_rcp_f16_sdwa v154, v153 dst_sel:WORD_1 dst_unused:UNUSED_PRESERVE src0_sel:WORD_1
v_rcp_f16_sdwa v151, v150 dst_sel:WORD_1 dst_unused:UNUSED_PRESERVE src0_sel:WORD_1
s_setprio 0
v_rcp_f16_sdwa v148, v147 dst_sel:WORD_1 dst_unused:UNUSED_PRESERVE src0_sel:WORD_1
v_fma_mix_f32 v164, v136, v136, v164 op_sel:[0,0,0] op_sel_hi:[1,1,0]
v_rcp_f16_sdwa v145, v144 dst_sel:WORD_1 dst_unused:UNUSED_PRESERVE src0_sel:WORD_1
v_fma_mix_f32 v164, v137, v137, v164 op_sel:[1,1,0] op_sel_hi:[1,1,0]
v_smfmac_f32_16x16x32_bf16 v[16:19], v[234:235], v[208:211], v246
ds_read_b128 v[228:231], v249 offset:14336
v_pk_mul_f16 v155, v155, v154
v_fma_mix_f32 v164, v138, v138, v164 op_sel:[0,0,0] op_sel_hi:[1,1,0]
v_pk_mul_f16 v152, v152, v151
v_pk_mul_f16 v149, v149, v148
v_fma_mix_f32 v164, v139, v139, v164 op_sel:[1,1,0] op_sel_hi:[1,1,0]
v_smfmac_f32_16x16x32_bf16 v[0:3], v[232:233], v[212:215], v246
s_mov_b64 exec, 1
ds_add_u32 v253, v254 offset:16
s_mov_b64 exec, -1
v_pk_mul_f16 v146, v146, v145
v_fma_mix_f32 v164, v155, v155, v164 op_sel:[0,0,0] op_sel_hi:[1,1,0]
s_waitcnt lgkmcnt(3)
v_fma_mix_f32 v164, v140, v140, v164 op_sel:[0,0,0] op_sel_hi:[1,1,0]
v_fma_mix_f32 v164, v155, v155, v164 op_sel:[1,1,0] op_sel_hi:[1,1,0]
v_fma_mix_f32 v164, v152, v152, v164 op_sel:[0,0,0] op_sel_hi:[1,1,0]
v_fma_mix_f32 v164, v141, v141, v164 op_sel:[1,1,0] op_sel_hi:[1,1,0]
v_fma_mix_f32 v164, v152, v152, v164 op_sel:[1,1,0] op_sel_hi:[1,1,0]
v_fma_mix_f32 v164, v149, v149, v164 op_sel:[0,0,0] op_sel_hi:[1,1,0]
v_fma_mix_f32 v164, v142, v142, v164 op_sel:[0,0,0] op_sel_hi:[1,1,0]
v_fma_mix_f32 v164, v149, v149, v164 op_sel:[1,1,0] op_sel_hi:[1,1,0]
v_fma_mix_f32 v164, v146, v146, v164 op_sel:[0,0,0] op_sel_hi:[1,1,0]
v_fma_mix_f32 v164, v143, v143, v164 op_sel:[1,1,0] op_sel_hi:[1,1,0]
v_fma_mix_f32 v164, v146, v146, v164 op_sel:[1,1,0] op_sel_hi:[1,1,0]
s_setprio 3
v_pk_add_f32 v[168:169], v[0:1], v[2:3]
v_pk_mul_f32 v[170:171], v[0:1], v[0:1]
v_pk_fma_f32 v[170:171], v[2:3], v[2:3], v[170:171]
v_pk_add_f32 v[168:169], v[168:169], v[4:5]
v_pk_fma_f32 v[170:171], v[4:5], v[4:5], v[170:171]
v_pk_add_f32 v[168:169], v[168:169], v[6:7]
v_pk_fma_f32 v[170:171], v[6:7], v[6:7], v[170:171]
v_pk_add_f32 v[168:169], v[168:169], v[8:9]
v_pk_fma_f32 v[170:171], v[8:9], v[8:9], v[170:171]
v_pk_add_f32 v[168:169], v[168:169], v[10:11]
v_pk_fma_f32 v[170:171], v[10:11], v[10:11], v[170:171]
v_pk_add_f32 v[168:169], v[168:169], v[12:13]
v_pk_fma_f32 v[170:171], v[12:13], v[12:13], v[170:171]
v_pk_add_f32 v[168:169], v[168:169], v[14:15]
v_pk_fma_f32 v[170:171], v[14:15], v[14:15], v[170:171]
v_pk_add_f32 v[168:169], v[168:169], v[16:17]
v_pk_fma_f32 v[170:171], v[16:17], v[16:17], v[170:171]
v_pk_add_f32 v[168:169], v[168:169], v[18:19]
v_pk_fma_f32 v[170:171], v[18:19], v[18:19], v[170:171]
v_pk_add_f32 v[168:169], v[168:169], v[20:21]
v_pk_fma_f32 v[170:171], v[20:21], v[20:21], v[170:171]
v_pk_add_f32 v[168:169], v[168:169], v[22:23]
v_pk_fma_f32 v[170:171], v[22:23], v[22:23], v[170:171]
v_pk_add_f32 v[168:169], v[168:169], v[24:25]
v_pk_fma_f32 v[170:171], v[24:25], v[24:25], v[170:171]
v_pk_add_f32 v[168:169], v[168:169], v[26:27]
v_pk_fma_f32 v[170:171], v[26:27], v[26:27], v[170:171]
v_pk_add_f32 v[168:169], v[168:169], v[28:29]
v_pk_fma_f32 v[170:171], v[28:29], v[28:29], v[170:171]
v_pk_add_f32 v[168:169], v[168:169], v[30:31]
v_pk_fma_f32 v[170:171], v[30:31], v[30:31], v[170:171]
v_pk_add_f32 v[168:169], v[168:169], v[32:33]
v_pk_fma_f32 v[170:171], v[32:33], v[32:33], v[170:171]
v_pk_add_f32 v[168:169], v[168:169], v[34:35]
v_pk_fma_f32 v[170:171], v[34:35], v[34:35], v[170:171]
v_pk_add_f32 v[168:169], v[168:169], v[36:37]
v_pk_fma_f32 v[170:171], v[36:37], v[36:37], v[170:171]
v_pk_add_f32 v[168:169], v[168:169], v[38:39]
v_pk_fma_f32 v[170:171], v[38:39], v[38:39], v[170:171]
v_pk_add_f32 v[168:169], v[168:169], v[40:41]
v_pk_fma_f32 v[170:171], v[40:41], v[40:41], v[170:171]
v_pk_add_f32 v[168:169], v[168:169], v[42:43]
v_pk_fma_f32 v[170:171], v[42:43], v[42:43], v[170:171]
v_pk_add_f32 v[168:169], v[168:169], v[44:45]
v_pk_fma_f32 v[170:171], v[44:45], v[44:45], v[170:171]
v_pk_add_f32 v[168:169], v[168:169], v[46:47]
v_pk_fma_f32 v[170:171], v[46:47], v[46:47], v[170:171]
s_setprio 0
v_lshrrev_b32 v240, 2, v251
v_mul_u32_u24 v240, 192, v240
v_and_b32 v252, 3, v251
v_lshl_add_u32 v240, v252, 4, v240
s_setprio 2
v_cvt_pkrtz_f16_f32 v137, v120, v121
v_cvt_pkrtz_f16_f32 v139, v122, v123
v_cvt_pkrtz_f16_f32 v141, v124, v125
v_cvt_pkrtz_f16_f32 v143, v126, v127
v_cvt_pkrtz_f16_f32 v145, v128, v129
v_cvt_pk_f16_f32 v155, v130, v131
v_cvt_pk_f16_f32 v152, v132, v133
v_cvt_pk_f16_f32 v149, v134, v135
ds_read_b128 v[232:235], v249 offset:17408
v_mfma_f32_32x32x16_bf16 v[120:135], v[96:99], v[236:239], 0
v_pk_fma_f16 v154, v155, v155, s48
v_add_f32 v168, v168, v169
v_and_b32 v137, s49, v137
v_pk_fma_f16 v151, v152, v152, s48
v_and_b32_e64 v139, s49, v139
v_pk_fma_f16 v148, v149, v149, s48
v_add_f32_e64 v170, v170, v171
v_pk_mul_f16 v154, v155, v154
v_bfe_u32 v136, v137, 2, 14
v_pk_mul_f16 v151, v152, v151
v_pk_mul_f16 v148, v149, v148
v_bfe_u32 v138, v139, 2, 14
ds_read_b128 v[236:239], v249 offset:18432
ds_read_u16_d16 v136, v136
ds_read_u16_d16 v138, v138
v_mfma_f32_32x32x16_bf16 v[120:135], v[100:103], v[216:219], v[120:135]
v_permlane32_swap_b32 v168, v170
v_exp_f16 v153, v154
v_lshrrev_b32 v137, 18, v137
v_exp_f16 v150, v151
v_add_f32 v168, v168, v170
v_lshrrev_b32 v139, 18, v139
v_exp_f16 v147, v148
v_and_b32 v141, s49, v141
v_and_b32_e64 v143, s49, v143
v_mul_f32 v168, 1009429163, v168
ds_read_b128 v[216:219], v249 offset:21504
ds_read_u16_d16_hi v137, v137
ds_read_u16_d16_hi v139, v139
v_mfma_f32_32x32x16_bf16 v[120:135], v[104:107], v[220:223], v[120:135]
v_exp_f16_sdwa v153, v154 dst_sel:WORD_1 dst_unused:UNUSED_PRESERVE src0_sel:WORD_1
v_bfe_u32 v140, v141, 2, 14
v_exp_f16_sdwa v150, v151 dst_sel:WORD_1 dst_unused:UNUSED_PRESERVE src0_sel:WORD_1
v_mov_b32_e64 v170, v168
v_bfe_u32 v142, v143, 2, 14
v_exp_f16_sdwa v147, v148 dst_sel:WORD_1 dst_unused:UNUSED_PRESERVE src0_sel:WORD_1
v_lshrrev_b32_e64 v141, 18, v141
v_permlane32_swap_b32 v168, v170
v_pk_add_f16 v153, v153, 1.0 op_sel_hi:[1,0]
s_waitcnt lgkmcnt(8)
ds_read_b128 v[220:223], v249 offset:19456
ds_read_u16_d16 v140, v140
ds_read_u16_d16 v142, v142
ds_read_u16_d16_hi v141, v141
v_mfma_f32_32x32x16_bf16 v[120:135], v[108:111], v[224:227], v[120:135]
v_lshrrev_b32_e64 v143, 18, v143
v_pk_add_f16 v150, v150, 1.0 op_sel_hi:[1,0]
v_pk_add_f16 v147, v147, 1.0 op_sel_hi:[1,0]
v_and_b32_e64 v145, s49, v145
v_fma_f32 v170, -v168, v168, v170
v_rcp_f16_e64 v154, v153
v_bfe_u32 v144, v145, 2, 14
v_rcp_f16 v151, v150
v_max_f32 v170, 0, v170
v_lshrrev_b32_e64 v145, 18, v145
ds_read_b128 v[224:227], v249 offset:22528
ds_read_u16_d16_hi v143, v143
ds_read_u16_d16 v144, v144
ds_read_u16_d16_hi v145, v145
v_mfma_f32_32x32x16_bf16 v[120:135], v[112:115], v[228:231], v[120:135]
v_rcp_f16 v148, v147
v_rcp_f16_sdwa v154, v153 dst_sel:WORD_1 dst_unused:UNUSED_PRESERVE src0_sel:WORD_1
v_add_f32 v170, 925353388, v170
s_waitcnt lgkmcnt(8)
v_fma_mix_f32 v165, v136, v136, v165 op_sel:[0,0,0] op_sel_hi:[1,1,0]
ds_read_b32 v247, v253 offset:16
v_fma_mix_f32 v165, v137, v137, v165 op_sel:[1,1,0] op_sel_hi:[1,1,0]
v_rcp_f16_sdwa v151, v150 dst_sel:WORD_1 dst_unused:UNUSED_PRESERVE src0_sel:WORD_1
v_rsq_f32_e64 v170, v170
v_fma_mix_f32 v165, v138, v138, v165 op_sel:[0,0,0] op_sel_hi:[1,1,0]
ds_read_b128 v[228:231], v249 offset:20480
v_mfma_f32_32x32x16_bf16 v[120:135], v[116:119], v[232:235], v[120:135]
v_rcp_f16_sdwa v148, v147 dst_sel:WORD_1 dst_unused:UNUSED_PRESERVE src0_sel:WORD_1
v_fma_mix_f32 v165, v139, v139, v165 op_sel:[1,1,0] op_sel_hi:[1,1,0]
v_pk_mul_f16 v155, v155, v154
s_waitcnt lgkmcnt(6)
v_fma_mix_f32 v165, v140, v140, v165 op_sel:[0,0,0] op_sel_hi:[1,1,0]
v_pk_mul_f16 v152, v152, v151
v_fma_mix_f32 v165, v141, v141, v165 op_sel:[1,1,0] op_sel_hi:[1,1,0]
v_pk_mul_f16 v149, v149, v148
v_fma_mix_f32 v165, v155, v155, v165 op_sel:[0,0,0] op_sel_hi:[1,1,0]
v_mul_f32 v172, 3203391086, v170
v_fma_mix_f32 v165, v142, v142, v165 op_sel:[0,0,0] op_sel_hi:[1,1,0]
v_fma_mix_f32 v165, v155, v155, v165 op_sel:[1,1,0] op_sel_hi:[1,1,0]
s_waitcnt lgkmcnt(2)
v_fma_mix_f32 v165, v143, v143, v165 op_sel:[1,1,0] op_sel_hi:[1,1,0]
v_fma_mix_f32 v165, v152, v152, v165 op_sel:[0,0,0] op_sel_hi:[1,1,0]
v_fma_mix_f32 v165, v152, v152, v165 op_sel:[1,1,0] op_sel_hi:[1,1,0]
v_mul_f32 v173, v168, v172
v_fma_mix_f32 v165, v144, v144, v165 op_sel:[0,0,0] op_sel_hi:[1,1,0]
v_fma_mix_f32 v165, v149, v149, v165 op_sel:[0,0,0] op_sel_hi:[1,1,0]
v_fma_mix_f32 v165, v145, v145, v165 op_sel:[1,1,0] op_sel_hi:[1,1,0]
v_fma_mix_f32 v165, v149, v149, v165 op_sel:[1,1,0] op_sel_hi:[1,1,0]
s_setprio 3
v_pk_fma_f32 v[0:1], v[0:1], v[172:173], v[172:173] op_sel:[0,0,1] op_sel_hi:[1,0,1] neg_lo:[0,0,1] neg_hi:[0,0,1]
v_pk_fma_f32 v[2:3], v[2:3], v[172:173], v[172:173] op_sel:[0,0,1] op_sel_hi:[1,0,1] neg_lo:[0,0,1] neg_hi:[0,0,1]
v_pk_fma_f32 v[4:5], v[4:5], v[172:173], v[172:173] op_sel:[0,0,1] op_sel_hi:[1,0,1] neg_lo:[0,0,1] neg_hi:[0,0,1]
v_pk_fma_f32 v[6:7], v[6:7], v[172:173], v[172:173] op_sel:[0,0,1] op_sel_hi:[1,0,1] neg_lo:[0,0,1] neg_hi:[0,0,1]
v_pk_fma_f32 v[8:9], v[8:9], v[172:173], v[172:173] op_sel:[0,0,1] op_sel_hi:[1,0,1] neg_lo:[0,0,1] neg_hi:[0,0,1]
v_pk_fma_f32 v[10:11], v[10:11], v[172:173], v[172:173] op_sel:[0,0,1] op_sel_hi:[1,0,1] neg_lo:[0,0,1] neg_hi:[0,0,1]
v_pk_fma_f32 v[12:13], v[12:13], v[172:173], v[172:173] op_sel:[0,0,1] op_sel_hi:[1,0,1] neg_lo:[0,0,1] neg_hi:[0,0,1]
v_pk_fma_f32 v[14:15], v[14:15], v[172:173], v[172:173] op_sel:[0,0,1] op_sel_hi:[1,0,1] neg_lo:[0,0,1] neg_hi:[0,0,1]
v_pk_fma_f32 v[16:17], v[16:17], v[172:173], v[172:173] op_sel:[0,0,1] op_sel_hi:[1,0,1] neg_lo:[0,0,1] neg_hi:[0,0,1]
v_pk_fma_f32 v[18:19], v[18:19], v[172:173], v[172:173] op_sel:[0,0,1] op_sel_hi:[1,0,1] neg_lo:[0,0,1] neg_hi:[0,0,1]
v_pk_fma_f32 v[20:21], v[20:21], v[172:173], v[172:173] op_sel:[0,0,1] op_sel_hi:[1,0,1] neg_lo:[0,0,1] neg_hi:[0,0,1]
v_pk_fma_f32 v[22:23], v[22:23], v[172:173], v[172:173] op_sel:[0,0,1] op_sel_hi:[1,0,1] neg_lo:[0,0,1] neg_hi:[0,0,1]
v_pk_fma_f32 v[24:25], v[24:25], v[172:173], v[172:173] op_sel:[0,0,1] op_sel_hi:[1,0,1] neg_lo:[0,0,1] neg_hi:[0,0,1]
v_pk_fma_f32 v[26:27], v[26:27], v[172:173], v[172:173] op_sel:[0,0,1] op_sel_hi:[1,0,1] neg_lo:[0,0,1] neg_hi:[0,0,1]
v_pk_fma_f32 v[28:29], v[28:29], v[172:173], v[172:173] op_sel:[0,0,1] op_sel_hi:[1,0,1] neg_lo:[0,0,1] neg_hi:[0,0,1]
v_pk_fma_f32 v[30:31], v[30:31], v[172:173], v[172:173] op_sel:[0,0,1] op_sel_hi:[1,0,1] neg_lo:[0,0,1] neg_hi:[0,0,1]
v_pk_fma_f32 v[32:33], v[32:33], v[172:173], v[172:173] op_sel:[0,0,1] op_sel_hi:[1,0,1] neg_lo:[0,0,1] neg_hi:[0,0,1]
v_pk_fma_f32 v[34:35], v[34:35], v[172:173], v[172:173] op_sel:[0,0,1] op_sel_hi:[1,0,1] neg_lo:[0,0,1] neg_hi:[0,0,1]
v_pk_fma_f32 v[36:37], v[36:37], v[172:173], v[172:173] op_sel:[0,0,1] op_sel_hi:[1,0,1] neg_lo:[0,0,1] neg_hi:[0,0,1]
v_pk_fma_f32 v[38:39], v[38:39], v[172:173], v[172:173] op_sel:[0,0,1] op_sel_hi:[1,0,1] neg_lo:[0,0,1] neg_hi:[0,0,1]
v_pk_fma_f32 v[40:41], v[40:41], v[172:173], v[172:173] op_sel:[0,0,1] op_sel_hi:[1,0,1] neg_lo:[0,0,1] neg_hi:[0,0,1]
v_pk_fma_f32 v[42:43], v[42:43], v[172:173], v[172:173] op_sel:[0,0,1] op_sel_hi:[1,0,1] neg_lo:[0,0,1] neg_hi:[0,0,1]
v_pk_fma_f32 v[44:45], v[44:45], v[172:173], v[172:173] op_sel:[0,0,1] op_sel_hi:[1,0,1] neg_lo:[0,0,1] neg_hi:[0,0,1]
v_pk_fma_f32 v[46:47], v[46:47], v[172:173], v[172:173] op_sel:[0,0,1] op_sel_hi:[1,0,1] neg_lo:[0,0,1] neg_hi:[0,0,1]
s_setprio 2
s_waitcnt lgkmcnt(0)
v_readfirstlane_b32 s43, v247
s_nop 1
s_cmp_ge_u32 s43, 32
s_cbranch_scc1 Lev8
Lev8w:
s_sleep 1
ds_read_b32 v247, v253 offset:16
s_waitcnt lgkmcnt(0)
v_readfirstlane_b32 s43, v247
s_cmp_eq_u32 s76, 0
s_cbranch_scc1 Lev8
s_sub_u32 s76, s76, 1
s_cmp_lt_u32 s43, 32
s_cbranch_scc1 Lev8w
Lev8:
s_setprio 1
v_cvt_pkrtz_f16_f32 v137, v120, v121
v_cvt_pkrtz_f16_f32 v139, v122, v123
v_cvt_pkrtz_f16_f32 v141, v124, v125
v_cvt_pkrtz_f16_f32 v143, v126, v127
v_cvt_pkrtz_f16_f32 v145, v128, v129
v_cvt_pk_f16_f32 v155, v130, v131
v_cvt_pk_f16_f32 v152, v132, v133
v_cvt_pk_f16_f32 v149, v134, v135
s_add_u32 m0, s72, 0
s_add_u32 s43, s82, 0
buffer_load_dwordx4 v240, s[16:19], s43 offen lds
ds_read_b128 v[232:235], v249 offset:23552
v_mfma_f32_32x32x16_bf16 v[120:135], v[96:99], v[236:239], 0
v_pk_fma_f16 v154, v155, v155, s48
v_cvt_pk_bf16_f32 v168, v0, v1
v_and_b32 v137, s49, v137
v_pk_fma_f16 v151, v152, v152, s48
v_cvt_pk_bf16_f32 v169, v2, v3
v_and_b32_e64 v139, s49, v139
v_pk_fma_f16 v148, v149, v149, s48
v_pk_mul_f16 v154, v155, v154
v_cvt_pk_bf16_f32 v170, v4, v5
v_bfe_u32 v136, v137, 2, 14
v_pk_mul_f16 v151, v152, v151
v_pk_mul_f16 v148, v149, v148
v_cvt_pk_bf16_f32 v171, v6, v7
v_bfe_u32 v138, v139, 2, 14
ds_read_b128 v[236:239], v248 offset:16384
ds_read_u16_d16 v136, v136
ds_read_u16_d16 v138, v138
v_mfma_f32_32x32x16_bf16 v[120:135], v[100:103], v[216:219], v[120:135]
v_exp_f16_e64 v153, v154
v_cvt_pk_bf16_f32 v172, v8, v9
v_lshrrev_b32 v137, 18, v137
v_exp_f16 v150, v151
v_cvt_pk_bf16_f32 v173, v10, v11
v_lshrrev_b32 v139, 18, v139
v_exp_f16 v147, v148
v_cvt_pk_bf16_f32 v174, v12, v13
v_and_b32_e64 v141, s49, v141
v_and_b32 v143, s49, v143
v_cvt_pk_bf16_f32 v175, v14, v15
s_add_u32 m0, s72, 1024
s_add_u32 s43, s82, 64
buffer_load_dwordx4 v240, s[16:19], s43 offen lds
ds_read_b128 v[216:219], v248 offset:19456
ds_read_u16_d16_hi v137, v137
ds_read_u16_d16_hi v139, v139
v_mfma_f32_32x32x16_bf16 v[120:135], v[104:107], v[220:223], v[120:135]
v_exp_f16_sdwa v153, v154 dst_sel:WORD_1 dst_unused:UNUSED_PRESERVE src0_sel:WORD_1
v_bfe_u32 v140, v141, 2, 14
v_cvt_pk_bf16_f32 v176, v16, v17
v_exp_f16_sdwa v150, v151 dst_sel:WORD_1 dst_unused:UNUSED_PRESERVE src0_sel:WORD_1
v_bfe_u32 v142, v143, 2, 14
v_cvt_pk_bf16_f32 v177, v18, v19
v_exp_f16_sdwa v147, v148 dst_sel:WORD_1 dst_unused:UNUSED_PRESERVE src0_sel:WORD_1
v_cvt_pk_bf16_f32 v178, v20, v21
v_lshrrev_b32_e64 v141, 18, v141
v_pk_add_f16 v153, v153, 1.0 op_sel_hi:[1,0]
v_lshrrev_b32_e64 v143, 18, v143
ds_read_b128 v[220:223], v248 offset:17408
ds_read_u16_d16 v140, v140
ds_read_u16_d16 v142, v142
ds_read_u16_d16_hi v141, v141
ds_read_u16_d16_hi v143, v143
v_mfma_f32_32x32x16_bf16 v[120:135], v[108:111], v[224:227], v[120:135]
v_cvt_pk_bf16_f32 v179, v22, v23
v_pk_add_f16 v150, v150, 1.0 op_sel_hi:[1,0]
v_pk_add_f16 v147, v147, 1.0 op_sel_hi:[1,0]
v_and_b32_e64 v145, s49, v145
v_cvt_pk_bf16_f32 v180, v24, v25
v_rcp_f16_e64 v154, v153
v_bfe_u32 v144, v145, 2, 14
v_cvt_pk_bf16_f32 v181, v26, v27
v_rcp_f16 v151, v150
v_lshrrev_b32 v145, 18, v145
v_cvt_pk_bf16_f32 v182, v28, v29
s_add_u32 m0, s72, 2048
s_add_u32 s43, s82, 128
buffer_load_dwordx4 v240, s[16:19], s43 offen lds
ds_read_b128 v[224:227], v248 offset:20480
ds_read_u16_d16 v144, v144
ds_read_u16_d16_hi v145, v145
v_mfma_f32_32x32x16_bf16 v[120:135], v[112:115], v[228:231], v[120:135]
v_rcp_f16 v148, v147
v_cvt_pk_bf16_f32 v183, v30, v31
v_rcp_f16_sdwa v154, v153 dst_sel:WORD_1 dst_unused:UNUSED_PRESERVE src0_sel:WORD_1
s_waitcnt lgkmcnt(5)
v_fma_mix_f32 v166, v136, v136, v166 op_sel:[0,0,0] op_sel_hi:[1,1,0]
v_cvt_pk_bf16_f32 v184, v32, v33
s_setprio 0
v_fma_mix_f32 v166, v137, v137, v166 op_sel:[1,1,0] op_sel_hi:[1,1,0]
v_rcp_f16_sdwa v151, v150 dst_sel:WORD_1 dst_unused:UNUSED_PRESERVE src0_sel:WORD_1
v_cvt_pk_bf16_f32 v185, v34, v35
v_fma_mix_f32 v166, v138, v138, v166 op_sel:[0,0,0] op_sel_hi:[1,1,0]
v_rcp_f16_sdwa v148, v147 dst_sel:WORD_1 dst_unused:UNUSED_PRESERVE src0_sel:WORD_1
v_cvt_pk_bf16_f32 v186, v36, v37
ds_read_b128 v[228:231], v248 offset:18432
v_mfma_f32_32x32x16_bf16 v[120:135], v[116:119], v[232:235], v[120:135]
v_fma_mix_f32 v166, v139, v139, v166 op_sel:[1,1,0] op_sel_hi:[1,1,0]
v_pk_mul_f16 v155, v155, v154
v_fma_mix_f32 v166, v140, v140, v166 op_sel:[0,0,0] op_sel_hi:[1,1,0]
v_cvt_pk_bf16_f32 v187, v38, v39
v_pk_mul_f16 v152, v152, v151
s_waitcnt lgkmcnt(4)
v_fma_mix_f32 v166, v141, v141, v166 op_sel:[1,1,0] op_sel_hi:[1,1,0]
v_cvt_pk_bf16_f32 v188, v40, v41
v_pk_mul_f16 v149, v149, v148
v_fma_mix_f32 v166, v155, v155, v166 op_sel:[0,0,0] op_sel_hi:[1,1,0]
v_fma_mix_f32 v166, v142, v142, v166 op_sel:[0,0,0] op_sel_hi:[1,1,0]
v_cvt_pk_bf16_f32 v189, v42, v43
v_fma_mix_f32 v166, v155, v155, v166 op_sel:[1,1,0] op_sel_hi:[1,1,0]
v_fma_mix_f32 v166, v143, v143, v166 op_sel:[1,1,0] op_sel_hi:[1,1,0]
v_fma_mix_f32 v166, v152, v152, v166 op_sel:[0,0,0] op_sel_hi:[1,1,0]
v_cvt_pk_bf16_f32 v190, v44, v45
v_fma_mix_f32 v166, v152, v152, v166 op_sel:[1,1,0] op_sel_hi:[1,1,0]
s_waitcnt lgkmcnt(1)
v_fma_mix_f32 v166, v144, v144, v166 op_sel:[0,0,0] op_sel_hi:[1,1,0]
v_fma_mix_f32 v166, v149, v149, v166 op_sel:[0,0,0] op_sel_hi:[1,1,0]
v_cvt_pk_bf16_f32 v191, v46, v47
v_fma_mix_f32 v166, v145, v145, v166 op_sel:[1,1,0] op_sel_hi:[1,1,0]
v_fma_mix_f32 v166, v149, v149, v166 op_sel:[1,1,0] op_sel_hi:[1,1,0]
s_setprio 2
v_cvt_pkrtz_f16_f32 v137, v120, v121
v_cvt_pkrtz_f16_f32 v139, v122, v123
v_cvt_pkrtz_f16_f32 v141, v124, v125
v_cvt_pkrtz_f16_f32 v143, v126, v127
v_cvt_pkrtz_f16_f32 v145, v128, v129
v_cvt_pk_f16_f32 v155, v130, v131
v_cvt_pk_f16_f32 v152, v132, v133
v_cvt_pk_f16_f32 v149, v134, v135
s_add_u32 m0, s72, 3072
s_add_u32 s43, s82, 3072
buffer_load_dwordx4 v240, s[16:19], s43 offen lds
ds_read_b128 v[232:235], v248 offset:21504
v_mfma_f32_32x32x16_bf16 v[120:135], v[236:239], v[168:171], 0
v_pk_fma_f16 v154, v155, v155, s48
v_and_b32 v247, 1, v251
v_and_b32 v137, s49, v137
v_pk_fma_f16 v151, v152, v152, s48
v_and_b32 v139, s49, v139
v_lshlrev_b32 v247, 4, v247
v_pk_fma_f16 v148, v149, v149, s48
v_pk_mul_f16 v154, v155, v154
v_bfe_u32 v136, v137, 2, 14
v_mov_b32 v252, 15360
v_pk_mul_f16 v151, v152, v151
v_pk_mul_f16 v148, v149, v148
v_bfe_u32 v138, v139, 2, 14
ds_read_b128 v[236:239], v248 offset:22528
ds_read_u16_d16 v136, v136
ds_read_u16_d16 v138, v138
v_mfma_f32_32x32x16_bf16 v[120:135], v[216:219], v[172:175], v[120:135]
v_exp_f16 v153, v154
v_lshlrev_b32 v247, v247, v252
v_lshrrev_b32 v137, 18, v137
v_exp_f16 v150, v151
v_lshrrev_b32 v252, 3, v251
v_lshrrev_b32 v139, 18, v139
v_exp_f16 v147, v148
v_xor_b32 v252, v252, v251
v_and_b32 v141, s49, v141
v_and_b32 v143, s49, v143
s_add_u32 m0, s72, 4096
s_add_u32 s43, s82, 3136
buffer_load_dwordx4 v240, s[16:19], s43 offen lds
ds_read_b128 v[216:219], v248 offset:25600
ds_read_u16_d16_hi v137, v137
ds_read_u16_d16_hi v139, v139
v_mfma_f32_32x32x16_bf16 v[120:135], v[220:223], v[176:179], v[120:135]
v_exp_f16_sdwa v153, v154 dst_sel:WORD_1 dst_unused:UNUSED_PRESERVE src0_sel:WORD_1
v_and_b32_e64 v252, 4, v252
v_bfe_u32 v140, v141, 2, 14
v_exp_f16_sdwa v150, v151 dst_sel:WORD_1 dst_unused:UNUSED_PRESERVE src0_sel:WORD_1
v_bfe_u32 v253, v251, 3, 2
v_bfe_u32 v142, v143, 2, 14
v_exp_f16_sdwa v147, v148 dst_sel:WORD_1 dst_unused:UNUSED_PRESERVE src0_sel:WORD_1
v_lshl_add_u32 v252, v252, 1, 0
v_lshrrev_b32_e64 v141, 18, v141
v_pk_add_f16 v153, v153, 1.0 op_sel_hi:[1,0]
v_lshrrev_b32_e64 v143, 18, v143
ds_read_b128 v[220:223], v248 offset:23552
ds_read_u16_d16 v140, v140
ds_read_u16_d16 v142, v142
ds_read_u16_d16_hi v141, v141
ds_read_u16_d16_hi v143, v143
v_mfma_f32_32x32x16_bf16 v[120:135], v[224:227], v[180:183], v[120:135]
v_lshl_add_u32 v252, v253, 1, v252
v_pk_add_f16 v150, v150, 1.0 op_sel_hi:[1,0]
v_pk_add_f16 v147, v147, 1.0 op_sel_hi:[1,0]
v_and_b32_e64 v145, s49, v145
v_bfe_u32 v253, v251, 1, 1
v_rcp_f16_e64 v154, v153
v_bfe_u32 v144, v145, 2, 14
v_add_u32 v252, v252, v253
v_rcp_f16 v151, v150
v_lshrrev_b32_e64 v145, 18, v145
v_rcp_f16 v148, v147
s_waitcnt lgkmcnt(5)
s_add_u32 m0, s72, 5120
s_add_u32 s43, s82, 3200
buffer_load_dwordx4 v240, s[16:19], s43 offen lds
ds_read_b128 v[224:227], v248 offset:26624
ds_read_u16_d16 v144, v144
ds_read_u16_d16_hi v145, v145
v_mfma_f32_32x32x16_bf16 v[120:135], v[228:231], v[184:187], v[120:135]
v_cmp_eq_u32 vcc, 0, v252
s_nop 1
v_cndmask_b32 v208, 0, v247, vcc
v_rcp_f16_sdwa v154, v153 dst_sel:WORD_1 dst_unused:UNUSED_PRESERVE src0_sel:WORD_1
v_cmp_eq_u32 vcc, 1, v252
s_nop 1
v_cndmask_b32 v209, 0, v247, vcc
v_fma_mix_f32 v167, v136, v136, v167 op_sel:[0,0,0] op_sel_hi:[1,1,0]
v_fma_mix_f32 v167, v137, v137, v167 op_sel:[1,1,0] op_sel_hi:[1,1,0]
v_rcp_f16_sdwa v151, v150 dst_sel:WORD_1 dst_unused:UNUSED_PRESERVE src0_sel:WORD_1
v_cmp_eq_u32 vcc, 2, v252
s_nop 1
v_cndmask_b32 v210, 0, v247, vcc
v_fma_mix_f32 v167, v138, v138, v167 op_sel:[0,0,0] op_sel_hi:[1,1,0]
v_rcp_f16_sdwa v148, v147 dst_sel:WORD_1 dst_unused:UNUSED_PRESERVE src0_sel:WORD_1
v_cmp_eq_u32 vcc, 3, v252
s_nop 1
v_cndmask_b32 v211, 0, v247, vcc
ds_read_b128 v[228:231], v248 offset:24576
v_mfma_f32_32x32x16_bf16 v[120:135], v[232:235], v[188:191], v[120:135]
v_fma_mix_f32 v167, v139, v139, v167 op_sel:[1,1,0] op_sel_hi:[1,1,0]
v_pk_mul_f16 v155, v155, v154
s_waitcnt lgkmcnt(1)
v_fma_mix_f32 v167, v140, v140, v167 op_sel:[0,0,0] op_sel_hi:[1,1,0]
v_cmp_eq_u32 vcc, 4, v252
s_nop 1
v_cndmask_b32 v212, 0, v247, vcc
v_pk_mul_f16 v152, v152, v151
v_fma_mix_f32 v167, v141, v141, v167 op_sel:[1,1,0] op_sel_hi:[1,1,0]
v_pk_mul_f16 v149, v149, v148
v_cmp_eq_u32 vcc, 5, v252
s_nop 1
v_cndmask_b32 v213, 0, v247, vcc
v_fma_mix_f32 v167, v155, v155, v167 op_sel:[0,0,0] op_sel_hi:[1,1,0]
v_fma_mix_f32 v167, v142, v142, v167 op_sel:[0,0,0] op_sel_hi:[1,1,0]
v_fma_mix_f32 v167, v155, v155, v167 op_sel:[1,1,0] op_sel_hi:[1,1,0]
v_fma_mix_f32 v167, v143, v143, v167 op_sel:[1,1,0] op_sel_hi:[1,1,0]
v_cmp_eq_u32 vcc, 6, v252
s_nop 1
v_cndmask_b32 v214, 0, v247, vcc
v_fma_mix_f32 v167, v152, v152, v167 op_sel:[0,0,0] op_sel_hi:[1,1,0]
v_fma_mix_f32 v167, v152, v152, v167 op_sel:[1,1,0] op_sel_hi:[1,1,0]
v_fma_mix_f32 v167, v144, v144, v167 op_sel:[0,0,0] op_sel_hi:[1,1,0]
v_cmp_eq_u32 vcc, 7, v252
s_nop 1
v_cndmask_b32 v215, 0, v247, vcc
v_fma_mix_f32 v167, v149, v149, v167 op_sel:[0,0,0] op_sel_hi:[1,1,0]
v_fma_mix_f32 v167, v145, v145, v167 op_sel:[1,1,0] op_sel_hi:[1,1,0]
v_fma_mix_f32 v167, v149, v149, v167 op_sel:[1,1,0] op_sel_hi:[1,1,0]
s_setprio 1
v_cvt_pkrtz_f16_f32 v137, v120, v121
v_cvt_pkrtz_f16_f32 v139, v122, v123
v_cvt_pkrtz_f16_f32 v141, v124, v125
v_cvt_pkrtz_f16_f32 v143, v126, v127
v_cvt_pkrtz_f16_f32 v145, v128, v129
v_cvt_pk_f16_f32 v155, v130, v131
v_cvt_pk_f16_f32 v152, v132, v133
v_cvt_pk_f16_f32 v149, v134, v135
s_add_u32 m0, s72, 6144
s_add_u32 s43, s82, 6144
buffer_load_dwordx4 v240, s[16:19], s43 offen lds
ds_read_b128 v[232:235], v248 offset:27648
v_mfma_f32_32x32x16_bf16 v[120:135], v[236:239], v[168:171], 0
v_pk_fma_f16 v154, v155, v155, s48
v_and_b32_e64 v137, s49, v137
v_pk_fma_f16 v151, v152, v152, s48
v_and_b32_e64 v139, s49, v139
v_pk_fma_f16 v148, v149, v149, s48
v_pk_mul_f16 v154, v155, v154
v_bfe_u32 v136, v137, 2, 14
v_pk_mul_f16 v151, v152, v151
ds_read_b128 v[236:239], v248 offset:28672
ds_read_u16_d16 v136, v136
v_mfma_f32_32x32x16_bf16 v[120:135], v[216:219], v[172:175], v[120:135]
v_pk_mul_f16 v148, v149, v148
v_bfe_u32 v138, v139, 2, 14
v_exp_f16 v153, v154
v_lshrrev_b32 v137, 18, v137
v_exp_f16 v150, v151
v_lshrrev_b32 v139, 18, v139
ds_read_b128 v[216:219], v248 offset:31744
ds_read_u16_d16 v138, v138
ds_read_u16_d16_hi v137, v137
ds_read_u16_d16_hi v139, v139
v_mfma_f32_32x32x16_bf16 v[120:135], v[220:223], v[176:179], v[120:135]
v_exp_f16 v147, v148
v_and_b32 v141, s49, v141
v_and_b32_e64 v143, s49, v143
v_exp_f16_sdwa v153, v154 dst_sel:WORD_1 dst_unused:UNUSED_PRESERVE src0_sel:WORD_1
v_bfe_u32 v140, v141, 2, 14
v_exp_f16_sdwa v150, v151 dst_sel:WORD_1 dst_unused:UNUSED_PRESERVE src0_sel:WORD_1
ds_read_b128 v[220:223], v248 offset:29696
ds_read_u16_d16 v140, v140
v_mfma_f32_32x32x16_bf16 v[120:135], v[224:227], v[180:183], v[120:135]
v_bfe_u32 v142, v143, 2, 14
v_exp_f16_sdwa v147, v148 dst_sel:WORD_1 dst_unused:UNUSED_PRESERVE src0_sel:WORD_1
v_lshrrev_b32_e64 v141, 18, v141
v_pk_add_f16 v153, v153, 1.0 op_sel_hi:[1,0]
v_lshrrev_b32 v143, 18, v143
v_pk_add_f16 v150, v150, 1.0 op_sel_hi:[1,0]
v_pk_add_f16 v147, v147, 1.0 op_sel_hi:[1,0]
s_waitcnt lgkmcnt(6)
ds_read_b128 v[224:227], v248 offset:32768
ds_read_u16_d16 v142, v142
ds_read_u16_d16_hi v141, v141
ds_read_u16_d16_hi v143, v143
v_mfma_f32_32x32x16_bf16 v[120:135], v[228:231], v[184:187], v[120:135]
v_and_b32 v145, s49, v145
v_rcp_f16 v154, v153
v_bfe_u32 v144, v145, 2, 14
s_setprio 0
v_rcp_f16 v151, v150
v_lshrrev_b32_e64 v145, 18, v145
ds_read_b128 v[228:231], v248 offset:30720
ds_read_u16_d16 v144, v144
ds_read_u16_d16_hi v145, v145
v_mfma_f32_32x32x16_bf16 v[120:135], v[232:235], v[188:191], v[120:135]
v_rcp_f16 v148, v147
s_waitcnt lgkmcnt(7)
v_or_b32 v0, v136, v137
v_or_b32 v1, v138, v139
v_rcp_f16_sdwa v154, v153 dst_sel:WORD_1 dst_unused:UNUSED_PRESERVE src0_sel:WORD_1
s_waitcnt lgkmcnt(4)
v_or_b32 v2, v140, v141
v_rcp_f16_sdwa v151, v150 dst_sel:WORD_1 dst_unused:UNUSED_PRESERVE src0_sel:WORD_1
s_waitcnt lgkmcnt(3)
v_or_b32 v3, v142, v143
v_rcp_f16_sdwa v148, v147 dst_sel:WORD_1 dst_unused:UNUSED_PRESERVE src0_sel:WORD_1
s_waitcnt lgkmcnt(0)
v_or_b32_e64 v4, v144, v145
v_pk_mul_f16 v5, v155, v154
v_pk_mul_f16 v6, v152, v151
v_pk_mul_f16 v7, v149, v148
s_setprio 2
ds_read_b128 v[232:235], v248 offset:33792
v_mfma_f32_32x32x16_f16 v[192:207], v[0:3], v[208:211], 0
v_cvt_pkrtz_f16_f32 v137, v120, v121
v_cvt_pkrtz_f16_f32 v139, v122, v123
v_cvt_pkrtz_f16_f32 v141, v124, v125
v_cvt_pkrtz_f16_f32 v143, v126, v127
v_cvt_pkrtz_f16_f32 v145, v128, v129
v_mfma_f32_32x32x16_f16 v[192:207], v[4:7], v[212:215], v[192:207]
v_cvt_pk_f16_f32 v155, v130, v131
v_cvt_pk_f16_f32 v152, v132, v133
v_cvt_pk_f16_f32 v149, v134, v135
v_pk_fma_f16 v154, v155, v155, s48
v_and_b32_e64 v137, s49, v137
v_pk_fma_f16 v151, v152, v152, s48
v_mfma_f32_32x32x16_bf16 v[120:135], v[236:239], v[168:171], 0
v_and_b32 v139, s49, v139
v_pk_fma_f16 v148, v149, v149, s48
v_permlane16_swap_b32 v0, v4
v_pk_mul_f16 v154, v155, v154
v_bfe_u32 v136, v137, 2, 14
v_permlane16_swap_b32 v1, v5
v_pk_mul_f16 v151, v152, v151
v_pk_mul_f16 v148, v149, v148
v_bfe_u32 v138, v139, 2, 14
v_permlane16_swap_b32 v2, v6
ds_read_b128 v[236:239], v248 offset:34816
ds_read_u16_d16 v136, v136
ds_read_u16_d16 v138, v138
v_mfma_f32_32x32x16_bf16 v[120:135], v[216:219], v[172:175], v[120:135]
v_exp_f16 v153, v154
v_permlane16_swap_b32 v3, v7
v_lshrrev_b32 v137, 18, v137
v_exp_f16 v150, v151
v_fmac_f32 v156, v192, v192
v_lshrrev_b32 v139, 18, v139
v_exp_f16 v147, v148
v_fmac_f32 v156, v193, v193
v_and_b32_e64 v141, s49, v141
ds_read_b128 v[216:219], v248 offset:37888
ds_read_u16_d16_hi v137, v137
ds_read_u16_d16_hi v139, v139
v_mfma_f32_32x32x16_bf16 v[120:135], v[220:223], v[176:179], v[120:135]
v_and_b32 v143, s49, v143
v_fmac_f32 v156, v194, v194
v_exp_f16_sdwa v153, v154 dst_sel:WORD_1 dst_unused:UNUSED_PRESERVE src0_sel:WORD_1
v_bfe_u32 v140, v141, 2, 14
v_fmac_f32_e64 v156, v195, v195
v_exp_f16_sdwa v150, v151 dst_sel:WORD_1 dst_unused:UNUSED_PRESERVE src0_sel:WORD_1
v_fmac_f32_e64 v156, v196, v196
v_bfe_u32 v142, v143, 2, 14
ds_read_b128 v[220:223], v248 offset:35840
ds_read_u16_d16 v140, v140
ds_read_u16_d16 v142, v142
v_mfma_f32_32x32x16_bf16 v[120:135], v[224:227], v[180:183], v[120:135]
v_exp_f16_sdwa v147, v148 dst_sel:WORD_1 dst_unused:UNUSED_PRESERVE src0_sel:WORD_1
v_fmac_f32 v156, v197, v197
v_lshrrev_b32 v141, 18, v141
v_pk_add_f16 v153, v153, 1.0 op_sel_hi:[1,0]
v_lshrrev_b32 v143, 18, v143
v_fmac_f32 v156, v198, v198
v_pk_add_f16 v150, v150, 1.0 op_sel_hi:[1,0]
v_pk_add_f16 v147, v147, 1.0 op_sel_hi:[1,0]
v_fmac_f32 v156, v199, v199
v_and_b32 v145, s49, v145
ds_read_b128 v[224:227], v248 offset:38912
ds_read_u16_d16_hi v141, v141
ds_read_u16_d16_hi v143, v143
v_mfma_f32_32x32x16_bf16 v[120:135], v[228:231], v[184:187], v[120:135]
v_rcp_f16 v154, v153
v_fmac_f32 v156, v200, v200
v_bfe_u32 v144, v145, 2, 14
v_rcp_f16 v151, v150
v_fmac_f32 v156, v201, v201
v_lshrrev_b32 v145, 18, v145
v_rcp_f16 v148, v147
v_fmac_f32_e64 v156, v202, v202
ds_read_u16_d16 v144, v144
ds_read_u16_d16_hi v145, v145
s_waitcnt lgkmcnt(5)
v_or_b32 v8, v136, v137
ds_read_b128 v[228:231], v248 offset:36864
v_mfma_f32_32x32x16_bf16 v[120:135], v[232:235], v[188:191], v[120:135]
v_or_b32 v9, v138, v139
v_fmac_f32 v156, v203, v203
v_rcp_f16_sdwa v154, v153 dst_sel:WORD_1 dst_unused:UNUSED_PRESERVE src0_sel:WORD_1
v_fmac_f32 v156, v204, v204
s_waitcnt lgkmcnt(4)
v_or_b32_e64 v10, v140, v141
v_rcp_f16_sdwa v151, v150 dst_sel:WORD_1 dst_unused:UNUSED_PRESERVE src0_sel:WORD_1
v_fmac_f32 v156, v205, v205
s_waitcnt lgkmcnt(3)
v_or_b32_e64 v11, v142, v143
v_rcp_f16_sdwa v148, v147 dst_sel:WORD_1 dst_unused:UNUSED_PRESERVE src0_sel:WORD_1
v_fmac_f32 v156, v206, v206
s_waitcnt lgkmcnt(1)
v_or_b32_e64 v12, v144, v145
v_pk_mul_f16 v13, v155, v154
v_fmac_f32_e64 v156, v207, v207
v_pk_mul_f16 v14, v152, v151
v_pk_mul_f16 v15, v149, v148
s_cmp_lg_u32 s40, 0
s_cbranch_scc1 Lrs0
v_lshlrev_b32_e64 v89, 2, v251
v_mov_b32 v90, 0
buffer_load_dword v244, v89, s[24:27], 0 offen offset:0
buffer_load_dword v245, v89, s[24:27], 0 offen offset:256
buffer_load_dword v246, v89, s[24:27], 0 offen offset:512
buffer_load_dword v91, v90, s[36:39], 0 offen sc1
Lrs0:
s_setprio 1
ds_read_b128 v[232:235], v248 offset:39936
v_mfma_f32_32x32x16_f16 v[192:207], v[8:11], v[208:211], 0
v_cvt_pkrtz_f16_f32 v137, v120, v121
v_cvt_pkrtz_f16_f32 v139, v122, v123
v_cvt_pkrtz_f16_f32 v141, v124, v125
v_cvt_pkrtz_f16_f32 v143, v126, v127
v_cvt_pkrtz_f16_f32 v145, v128, v129
v_mfma_f32_32x32x16_f16 v[192:207], v[12:15], v[212:215], v[192:207]
v_cvt_pk_f16_f32 v155, v130, v131
v_cvt_pk_f16_f32 v152, v132, v133
v_cvt_pk_f16_f32 v149, v134, v135
v_pk_fma_f16 v154, v155, v155, s48
v_and_b32_e64 v137, s49, v137
v_pk_fma_f16 v151, v152, v152, s48
v_mfma_f32_32x32x16_bf16 v[120:135], v[236:239], v[168:171], 0
v_and_b32 v139, s49, v139
v_pk_fma_f16 v148, v149, v149, s48
v_permlane16_swap_b32 v8, v12
v_pk_mul_f16 v154, v155, v154
v_bfe_u32 v136, v137, 2, 14
v_permlane16_swap_b32 v9, v13
v_pk_mul_f16 v151, v152, v151
v_pk_mul_f16 v148, v149, v148
v_bfe_u32 v138, v139, 2, 14
v_permlane16_swap_b32 v10, v14
ds_read_b128 v[236:239], v248 offset:40960
ds_read_u16_d16 v136, v136
ds_read_u16_d16 v138, v138
v_mfma_f32_32x32x16_bf16 v[120:135], v[216:219], v[172:175], v[120:135]
v_exp_f16 v153, v154
v_permlane16_swap_b32 v11, v15
v_lshrrev_b32 v137, 18, v137
v_exp_f16 v150, v151
v_fmac_f32 v157, v192, v192
v_lshrrev_b32 v139, 18, v139
v_exp_f16 v147, v148
v_fmac_f32 v157, v193, v193
v_and_b32_e64 v141, s49, v141
ds_read_b128 v[216:219], v248 offset:44032
ds_read_u16_d16_hi v137, v137
ds_read_u16_d16_hi v139, v139
v_mfma_f32_32x32x16_bf16 v[120:135], v[220:223], v[176:179], v[120:135]
v_and_b32 v143, s49, v143
v_fmac_f32 v157, v194, v194
v_exp_f16_sdwa v153, v154 dst_sel:WORD_1 dst_unused:UNUSED_PRESERVE src0_sel:WORD_1
v_bfe_u32 v140, v141, 2, 14
v_fmac_f32_e64 v157, v195, v195
v_exp_f16_sdwa v150, v151 dst_sel:WORD_1 dst_unused:UNUSED_PRESERVE src0_sel:WORD_1
v_fmac_f32_e64 v157, v196, v196
v_bfe_u32 v142, v143, 2, 14
ds_read_b128 v[220:223], v248 offset:41984
ds_read_u16_d16 v140, v140
ds_read_u16_d16 v142, v142
v_mfma_f32_32x32x16_bf16 v[120:135], v[224:227], v[180:183], v[120:135]
v_exp_f16_sdwa v147, v148 dst_sel:WORD_1 dst_unused:UNUSED_PRESERVE src0_sel:WORD_1
v_fmac_f32 v157, v197, v197
v_lshrrev_b32 v141, 18, v141
v_pk_add_f16 v153, v153, 1.0 op_sel_hi:[1,0]
v_lshrrev_b32 v143, 18, v143
v_fmac_f32 v157, v198, v198
v_pk_add_f16 v150, v150, 1.0 op_sel_hi:[1,0]
v_pk_add_f16 v147, v147, 1.0 op_sel_hi:[1,0]
v_fmac_f32_e64 v157, v199, v199
v_and_b32 v145, s49, v145
s_waitcnt lgkmcnt(4)
ds_read_b128 v[224:227], v248 offset:45056
ds_read_u16_d16_hi v141, v141
ds_read_u16_d16_hi v143, v143
v_mfma_f32_32x32x16_bf16 v[120:135], v[228:231], v[184:187], v[120:135]
v_rcp_f16 v154, v153
v_fmac_f32 v157, v200, v200
v_bfe_u32 v144, v145, 2, 14
v_rcp_f16 v151, v150
s_setprio 0
v_fmac_f32 v157, v201, v201
v_lshrrev_b32 v145, 18, v145
v_rcp_f16 v148, v147
v_fmac_f32 v157, v202, v202
ds_read_u16_d16 v144, v144
ds_read_u16_d16_hi v145, v145
v_or_b32_e64 v16, v136, v137
ds_read_b128 v[228:231], v248 offset:43008
v_mfma_f32_32x32x16_bf16 v[120:135], v[232:235], v[188:191], v[120:135]
s_waitcnt lgkmcnt(6)
v_or_b32 v17, v138, v139
v_fmac_f32_e64 v157, v203, v203
v_rcp_f16_sdwa v154, v153 dst_sel:WORD_1 dst_unused:UNUSED_PRESERVE src0_sel:WORD_1
v_fmac_f32 v157, v204, v204
s_waitcnt lgkmcnt(4)
v_or_b32_e64 v18, v140, v141
v_rcp_f16_sdwa v151, v150 dst_sel:WORD_1 dst_unused:UNUSED_PRESERVE src0_sel:WORD_1
v_fmac_f32 v157, v205, v205
s_waitcnt lgkmcnt(3)
v_or_b32_e64 v19, v142, v143
v_rcp_f16_sdwa v148, v147 dst_sel:WORD_1 dst_unused:UNUSED_PRESERVE src0_sel:WORD_1
v_fmac_f32 v157, v206, v206
s_waitcnt lgkmcnt(1)
v_or_b32_e64 v20, v144, v145
v_pk_mul_f16 v21, v155, v154
v_fmac_f32 v157, v207, v207
v_pk_mul_f16 v22, v152, v151
v_pk_mul_f16 v23, v149, v148
s_setprio 2
ds_read_b128 v[232:235], v248 offset:46080
v_mfma_f32_32x32x16_f16 v[192:207], v[16:19], v[208:211], 0
v_cvt_pkrtz_f16_f32 v137, v120, v121
v_cvt_pkrtz_f16_f32 v139, v122, v123
v_cvt_pkrtz_f16_f32 v141, v124, v125
v_cvt_pkrtz_f16_f32 v143, v126, v127
v_cvt_pkrtz_f16_f32 v145, v128, v129
v_mfma_f32_32x32x16_f16 v[192:207], v[20:23], v[212:215], v[192:207]
v_cvt_pk_f16_f32 v155, v130, v131
v_cvt_pk_f16_f32 v152, v132, v133
v_cvt_pk_f16_f32 v149, v134, v135
v_pk_fma_f16 v154, v155, v155, s48
v_and_b32_e64 v137, s49, v137
v_pk_fma_f16 v151, v152, v152, s48
v_mfma_f32_32x32x16_bf16 v[120:135], v[236:239], v[168:171], 0
v_and_b32 v139, s49, v139
v_pk_fma_f16 v148, v149, v149, s48
v_permlane16_swap_b32 v16, v20
v_pk_mul_f16 v154, v155, v154
v_bfe_u32 v136, v137, 2, 14
v_permlane16_swap_b32 v17, v21
v_pk_mul_f16 v151, v152, v151
v_pk_mul_f16 v148, v149, v148
v_bfe_u32 v138, v139, 2, 14
v_permlane16_swap_b32 v18, v22
ds_read_b128 v[236:239], v248 offset:47104
ds_read_u16_d16 v136, v136
ds_read_u16_d16 v138, v138
v_mfma_f32_32x32x16_bf16 v[120:135], v[216:219], v[172:175], v[120:135]
v_exp_f16 v153, v154
v_permlane16_swap_b32 v19, v23
v_lshrrev_b32 v137, 18, v137
v_exp_f16 v150, v151
v_fmac_f32 v158, v192, v192
v_lshrrev_b32 v139, 18, v139
v_exp_f16 v147, v148
v_fmac_f32 v158, v193, v193
v_and_b32_e64 v141, s49, v141
ds_read_b128 v[216:219], v248 offset:50176
ds_read_u16_d16_hi v137, v137
ds_read_u16_d16_hi v139, v139
v_mfma_f32_32x32x16_bf16 v[120:135], v[220:223], v[176:179], v[120:135]
v_and_b32 v143, s49, v143
v_fmac_f32 v158, v194, v194
v_exp_f16_sdwa v153, v154 dst_sel:WORD_1 dst_unused:UNUSED_PRESERVE src0_sel:WORD_1
v_bfe_u32 v140, v141, 2, 14
v_fmac_f32_e64 v158, v195, v195
v_exp_f16_sdwa v150, v151 dst_sel:WORD_1 dst_unused:UNUSED_PRESERVE src0_sel:WORD_1
v_fmac_f32_e64 v158, v196, v196
v_bfe_u32 v142, v143, 2, 14
ds_read_b128 v[220:223], v248 offset:48128
ds_read_u16_d16 v140, v140
ds_read_u16_d16 v142, v142
v_mfma_f32_32x32x16_bf16 v[120:135], v[224:227], v[180:183], v[120:135]
v_exp_f16_sdwa v147, v148 dst_sel:WORD_1 dst_unused:UNUSED_PRESERVE src0_sel:WORD_1
v_fmac_f32 v158, v197, v197
v_lshrrev_b32 v141, 18, v141
v_pk_add_f16 v153, v153, 1.0 op_sel_hi:[1,0]
v_lshrrev_b32 v143, 18, v143
v_fmac_f32 v158, v198, v198
v_pk_add_f16 v150, v150, 1.0 op_sel_hi:[1,0]
v_pk_add_f16 v147, v147, 1.0 op_sel_hi:[1,0]
v_fmac_f32_e64 v158, v199, v199
v_and_b32 v145, s49, v145
s_waitcnt lgkmcnt(4)
ds_read_b128 v[224:227], v248 offset:51200
ds_read_u16_d16_hi v141, v141
ds_read_u16_d16_hi v143, v143
v_mfma_f32_32x32x16_bf16 v[120:135], v[228:231], v[184:187], v[120:135]
v_rcp_f16 v154, v153
v_fmac_f32 v158, v200, v200
v_bfe_u32 v144, v145, 2, 14
v_rcp_f16 v151, v150
v_fmac_f32 v158, v201, v201
v_lshrrev_b32 v145, 18, v145
v_rcp_f16 v148, v147
v_fmac_f32_e64 v158, v202, v202
ds_read_u16_d16 v144, v144
ds_read_u16_d16_hi v145, v145
v_or_b32_e64 v24, v136, v137
ds_read_b128 v[228:231], v248 offset:49152
v_mfma_f32_32x32x16_bf16 v[120:135], v[232:235], v[188:191], v[120:135]
s_waitcnt lgkmcnt(6)
v_or_b32 v25, v138, v139
v_fmac_f32_e64 v158, v203, v203
v_rcp_f16_sdwa v154, v153 dst_sel:WORD_1 dst_unused:UNUSED_PRESERVE src0_sel:WORD_1
v_fmac_f32 v158, v204, v204
s_waitcnt lgkmcnt(4)
v_or_b32_e64 v26, v140, v141
v_rcp_f16_sdwa v151, v150 dst_sel:WORD_1 dst_unused:UNUSED_PRESERVE src0_sel:WORD_1
v_fmac_f32 v158, v205, v205
s_waitcnt lgkmcnt(3)
v_or_b32_e64 v27, v142, v143
v_rcp_f16_sdwa v148, v147 dst_sel:WORD_1 dst_unused:UNUSED_PRESERVE src0_sel:WORD_1
v_fmac_f32 v158, v206, v206
s_waitcnt lgkmcnt(1)
v_or_b32_e64 v28, v144, v145
v_pk_mul_f16 v29, v155, v154
v_fmac_f32 v158, v207, v207
v_pk_mul_f16 v30, v152, v151
v_pk_mul_f16 v31, v149, v148
s_setprio 1
ds_read_b128 v[232:235], v248 offset:52224
v_mfma_f32_32x32x16_f16 v[192:207], v[24:27], v[208:211], 0
v_cvt_pkrtz_f16_f32 v137, v120, v121
v_cvt_pkrtz_f16_f32 v139, v122, v123
v_cvt_pkrtz_f16_f32 v141, v124, v125
v_cvt_pkrtz_f16_f32 v143, v126, v127
v_cvt_pkrtz_f16_f32 v145, v128, v129
v_mfma_f32_32x32x16_f16 v[192:207], v[28:31], v[212:215], v[192:207]
v_cvt_pk_f16_f32 v155, v130, v131
v_cvt_pk_f16_f32 v152, v132, v133
v_cvt_pk_f16_f32 v149, v134, v135
v_pk_fma_f16 v154, v155, v155, s48
v_and_b32_e64 v137, s49, v137
v_pk_fma_f16 v151, v152, v152, s48
v_mfma_f32_32x32x16_bf16 v[120:135], v[236:239], v[168:171], 0
v_and_b32 v139, s49, v139
v_pk_fma_f16 v148, v149, v149, s48
v_permlane16_swap_b32 v24, v28
v_pk_mul_f16 v154, v155, v154
v_bfe_u32 v136, v137, 2, 14
v_permlane16_swap_b32 v25, v29
v_pk_mul_f16 v151, v152, v151
v_pk_mul_f16 v148, v149, v148
v_bfe_u32 v138, v139, 2, 14
v_permlane16_swap_b32 v26, v30
ds_read_b128 v[236:239], v248 offset:53248
ds_read_u16_d16 v136, v136
ds_read_u16_d16 v138, v138
v_mfma_f32_32x32x16_bf16 v[120:135], v[216:219], v[172:175], v[120:135]
v_exp_f16 v153, v154
v_permlane16_swap_b32 v27, v31
v_lshrrev_b32 v137, 18, v137
v_exp_f16 v150, v151
v_fmac_f32 v159, v192, v192
v_lshrrev_b32 v139, 18, v139
v_exp_f16 v147, v148
v_fmac_f32 v159, v193, v193
v_and_b32_e64 v141, s49, v141
ds_read_b128 v[216:219], v248 offset:56320
ds_read_u16_d16_hi v137, v137
ds_read_u16_d16_hi v139, v139
v_mfma_f32_32x32x16_bf16 v[120:135], v[220:223], v[176:179], v[120:135]
v_and_b32 v143, s49, v143
v_fmac_f32 v159, v194, v194
v_exp_f16_sdwa v153, v154 dst_sel:WORD_1 dst_unused:UNUSED_PRESERVE src0_sel:WORD_1
v_bfe_u32 v140, v141, 2, 14
v_fmac_f32_e64 v159, v195, v195
v_exp_f16_sdwa v150, v151 dst_sel:WORD_1 dst_unused:UNUSED_PRESERVE src0_sel:WORD_1
v_fmac_f32_e64 v159, v196, v196
v_bfe_u32 v142, v143, 2, 14
ds_read_b128 v[220:223], v248 offset:54272
ds_read_u16_d16 v140, v140
ds_read_u16_d16 v142, v142
v_mfma_f32_32x32x16_bf16 v[120:135], v[224:227], v[180:183], v[120:135]
v_exp_f16_sdwa v147, v148 dst_sel:WORD_1 dst_unused:UNUSED_PRESERVE src0_sel:WORD_1
v_fmac_f32 v159, v197, v197
v_lshrrev_b32 v141, 18, v141
v_pk_add_f16 v153, v153, 1.0 op_sel_hi:[1,0]
v_lshrrev_b32 v143, 18, v143
v_fmac_f32 v159, v198, v198
v_pk_add_f16 v150, v150, 1.0 op_sel_hi:[1,0]
v_pk_add_f16 v147, v147, 1.0 op_sel_hi:[1,0]
v_fmac_f32_e64 v159, v199, v199
v_and_b32 v145, s49, v145
s_waitcnt lgkmcnt(4)
ds_read_b128 v[224:227], v248 offset:57344
ds_read_u16_d16_hi v141, v141
ds_read_u16_d16_hi v143, v143
v_mfma_f32_32x32x16_bf16 v[120:135], v[228:231], v[184:187], v[120:135]
v_rcp_f16 v154, v153
v_fmac_f32 v159, v200, v200
v_bfe_u32 v144, v145, 2, 14
v_rcp_f16 v151, v150
s_setprio 0
v_fmac_f32 v159, v201, v201
v_lshrrev_b32 v145, 18, v145
v_rcp_f16 v148, v147
v_fmac_f32 v159, v202, v202
ds_read_u16_d16 v144, v144
ds_read_u16_d16_hi v145, v145
v_or_b32_e64 v32, v136, v137
ds_read_b128 v[228:231], v248 offset:55296
v_mfma_f32_32x32x16_bf16 v[120:135], v[232:235], v[188:191], v[120:135]
s_waitcnt lgkmcnt(6)
v_or_b32 v33, v138, v139
v_fmac_f32_e64 v159, v203, v203
v_rcp_f16_sdwa v154, v153 dst_sel:WORD_1 dst_unused:UNUSED_PRESERVE src0_sel:WORD_1
v_fmac_f32 v159, v204, v204
s_waitcnt lgkmcnt(4)
v_or_b32_e64 v34, v140, v141
v_rcp_f16_sdwa v151, v150 dst_sel:WORD_1 dst_unused:UNUSED_PRESERVE src0_sel:WORD_1
v_fmac_f32 v159, v205, v205
s_waitcnt lgkmcnt(3)
v_or_b32_e64 v35, v142, v143
v_rcp_f16_sdwa v148, v147 dst_sel:WORD_1 dst_unused:UNUSED_PRESERVE src0_sel:WORD_1
v_fmac_f32 v159, v206, v206
s_waitcnt lgkmcnt(1)
v_or_b32_e64 v36, v144, v145
v_pk_mul_f16 v37, v155, v154
v_fmac_f32 v159, v207, v207
v_pk_mul_f16 v38, v152, v151
v_pk_mul_f16 v39, v149, v148
s_setprio 2
ds_read_b128 v[232:235], v248 offset:58368
v_mfma_f32_32x32x16_f16 v[192:207], v[32:35], v[208:211], 0
v_cvt_pkrtz_f16_f32 v137, v120, v121
v_cvt_pkrtz_f16_f32 v139, v122, v123
v_cvt_pkrtz_f16_f32 v141, v124, v125
v_cvt_pkrtz_f16_f32 v143, v126, v127
v_cvt_pkrtz_f16_f32 v145, v128, v129
v_mfma_f32_32x32x16_f16 v[192:207], v[36:39], v[212:215], v[192:207]
v_cvt_pk_f16_f32 v155, v130, v131
v_cvt_pk_f16_f32 v152, v132, v133
v_cvt_pk_f16_f32 v149, v134, v135
v_pk_fma_f16 v154, v155, v155, s48
v_and_b32_e64 v137, s49, v137
v_pk_fma_f16 v151, v152, v152, s48
v_mfma_f32_32x32x16_bf16 v[120:135], v[236:239], v[168:171], 0
v_and_b32 v139, s49, v139
v_pk_fma_f16 v148, v149, v149, s48
v_permlane16_swap_b32 v32, v36
v_pk_mul_f16 v154, v155, v154
v_bfe_u32 v136, v137, 2, 14
v_permlane16_swap_b32 v33, v37
v_pk_mul_f16 v151, v152, v151
v_pk_mul_f16 v148, v149, v148
v_bfe_u32 v138, v139, 2, 14
v_permlane16_swap_b32 v34, v38
ds_read_b128 v[236:239], v248 offset:59392
ds_read_u16_d16 v136, v136
ds_read_u16_d16 v138, v138
v_mfma_f32_32x32x16_bf16 v[120:135], v[216:219], v[172:175], v[120:135]
v_exp_f16 v153, v154
v_permlane16_swap_b32 v35, v39
v_lshrrev_b32 v137, 18, v137
v_exp_f16 v150, v151
v_fmac_f32 v160, v192, v192
v_lshrrev_b32 v139, 18, v139
v_exp_f16 v147, v148
v_fmac_f32 v160, v193, v193
v_and_b32_e64 v141, s49, v141
ds_read_b128 v[216:219], v248 offset:62464
ds_read_u16_d16_hi v137, v137
ds_read_u16_d16_hi v139, v139
v_mfma_f32_32x32x16_bf16 v[120:135], v[220:223], v[176:179], v[120:135]
v_and_b32 v143, s49, v143
v_fmac_f32 v160, v194, v194
v_exp_f16_sdwa v153, v154 dst_sel:WORD_1 dst_unused:UNUSED_PRESERVE src0_sel:WORD_1
v_bfe_u32 v140, v141, 2, 14
v_fmac_f32_e64 v160, v195, v195
v_exp_f16_sdwa v150, v151 dst_sel:WORD_1 dst_unused:UNUSED_PRESERVE src0_sel:WORD_1
v_fmac_f32_e64 v160, v196, v196
v_bfe_u32 v142, v143, 2, 14
ds_read_b128 v[220:223], v248 offset:60416
ds_read_u16_d16 v140, v140
ds_read_u16_d16 v142, v142
v_mfma_f32_32x32x16_bf16 v[120:135], v[224:227], v[180:183], v[120:135]
v_exp_f16_sdwa v147, v148 dst_sel:WORD_1 dst_unused:UNUSED_PRESERVE src0_sel:WORD_1
v_fmac_f32 v160, v197, v197
v_lshrrev_b32 v141, 18, v141
v_pk_add_f16 v153, v153, 1.0 op_sel_hi:[1,0]
v_lshrrev_b32 v143, 18, v143
v_fmac_f32 v160, v198, v198
v_pk_add_f16 v150, v150, 1.0 op_sel_hi:[1,0]
v_pk_add_f16 v147, v147, 1.0 op_sel_hi:[1,0]
v_fmac_f32_e64 v160, v199, v199
v_and_b32 v145, s49, v145
s_waitcnt lgkmcnt(4)
ds_read_b128 v[224:227], v248 offset:63488
ds_read_u16_d16_hi v141, v141
ds_read_u16_d16_hi v143, v143
v_mfma_f32_32x32x16_bf16 v[120:135], v[228:231], v[184:187], v[120:135]
v_rcp_f16 v154, v153
v_fmac_f32 v160, v200, v200
v_bfe_u32 v144, v145, 2, 14
v_rcp_f16 v151, v150
v_fmac_f32 v160, v201, v201
v_lshrrev_b32 v145, 18, v145
v_rcp_f16 v148, v147
v_fmac_f32_e64 v160, v202, v202
ds_read_u16_d16 v144, v144
ds_read_u16_d16_hi v145, v145
v_or_b32_e64 v40, v136, v137
ds_read_b128 v[228:231], v248 offset:61440
v_mfma_f32_32x32x16_bf16 v[120:135], v[232:235], v[188:191], v[120:135]
s_waitcnt lgkmcnt(6)
v_or_b32 v41, v138, v139
v_fmac_f32_e64 v160, v203, v203
v_rcp_f16_sdwa v154, v153 dst_sel:WORD_1 dst_unused:UNUSED_PRESERVE src0_sel:WORD_1
v_fmac_f32 v160, v204, v204
s_waitcnt lgkmcnt(4)
v_or_b32_e64 v42, v140, v141
v_rcp_f16_sdwa v151, v150 dst_sel:WORD_1 dst_unused:UNUSED_PRESERVE src0_sel:WORD_1
v_fmac_f32 v160, v205, v205
s_waitcnt lgkmcnt(3)
v_or_b32_e64 v43, v142, v143
v_rcp_f16_sdwa v148, v147 dst_sel:WORD_1 dst_unused:UNUSED_PRESERVE src0_sel:WORD_1
v_fmac_f32 v160, v206, v206
s_waitcnt lgkmcnt(1)
v_or_b32_e64 v44, v144, v145
v_pk_mul_f16 v45, v155, v154
v_fmac_f32_e64 v160, v207, v207
v_pk_mul_f16 v46, v152, v151
v_pk_mul_f16 v47, v149, v148
s_cmp_lg_u32 s40, 0
s_cbranch_scc1 Lrs1
v_mov_b32 v90, 0
Lpi:
s_waitcnt vmcnt(0)
v_readfirstlane_b32 s43, v91
s_cmp_eq_u32 s76, 0
s_cbranch_scc1 Lpix
s_sub_u32 s76, s76, 1
s_cmp_ge_u32 s43, 256
s_cbranch_scc1 Lpix
buffer_load_dword v91, v90, s[36:39], 0 offen sc1
s_branch Lpi
Lpix:
v_min_u32_e64 v88, 47, v251
v_lshlrev_b32 v88, 3, v88
s_and_b32 s44, s2, 7
s_lshl_b32 s44, s44, 11
s_add_u32 s44, s44, 394752
buffer_load_dwordx2 v[92:93], v88, s[32:35], s44 offen sc1
Lrs1:
s_setprio 1
ds_read_b128 v[232:235], v248 offset:64512
v_mfma_f32_32x32x16_f16 v[192:207], v[40:43], v[208:211], 0
v_cvt_pkrtz_f16_f32 v137, v120, v121
v_cvt_pkrtz_f16_f32 v139, v122, v123
v_cvt_pkrtz_f16_f32 v141, v124, v125
v_cvt_pkrtz_f16_f32 v143, v126, v127
v_cvt_pkrtz_f16_f32 v145, v128, v129
v_mfma_f32_32x32x16_f16 v[192:207], v[44:47], v[212:215], v[192:207]
v_cvt_pk_f16_f32 v155, v130, v131
v_cvt_pk_f16_f32 v152, v132, v133
v_cvt_pk_f16_f32 v149, v134, v135
v_pk_fma_f16 v154, v155, v155, s48
v_and_b32_e64 v137, s49, v137
v_pk_fma_f16 v151, v152, v152, s48
v_mfma_f32_32x32x16_bf16 v[120:135], v[236:239], v[168:171], 0
v_and_b32 v139, s49, v139
v_pk_fma_f16 v148, v149, v149, s48
v_permlane16_swap_b32 v40, v44
v_pk_mul_f16 v154, v155, v154
v_bfe_u32 v136, v137, 2, 14
v_permlane16_swap_b32 v41, v45
v_pk_mul_f16 v151, v152, v151
v_pk_mul_f16 v148, v149, v148
v_bfe_u32 v138, v139, 2, 14
v_permlane16_swap_b32 v42, v46
ds_read_b128 v[236:239], v249
ds_read_u16_d16 v136, v136
ds_read_u16_d16 v138, v138
v_mfma_f32_32x32x16_bf16 v[120:135], v[216:219], v[172:175], v[120:135]
v_exp_f16 v153, v154
v_permlane16_swap_b32 v43, v47
v_lshrrev_b32 v137, 18, v137
v_exp_f16 v150, v151
v_fmac_f32 v161, v192, v192
v_lshrrev_b32 v139, 18, v139
v_exp_f16 v147, v148
v_fmac_f32 v161, v193, v193
v_and_b32_e64 v141, s49, v141
ds_read_b128 v[216:219], v249 offset:3072
ds_read_u16_d16_hi v137, v137
ds_read_u16_d16_hi v139, v139
v_mfma_f32_32x32x16_bf16 v[120:135], v[220:223], v[176:179], v[120:135]
v_and_b32 v143, s49, v143
v_fmac_f32 v161, v194, v194
v_exp_f16_sdwa v153, v154 dst_sel:WORD_1 dst_unused:UNUSED_PRESERVE src0_sel:WORD_1
v_bfe_u32 v140, v141, 2, 14
v_fmac_f32_e64 v161, v195, v195
v_exp_f16_sdwa v150, v151 dst_sel:WORD_1 dst_unused:UNUSED_PRESERVE src0_sel:WORD_1
v_fmac_f32_e64 v161, v196, v196
v_bfe_u32 v142, v143, 2, 14
ds_read_b128 v[220:223], v249 offset:1024
ds_read_u16_d16 v140, v140
ds_read_u16_d16 v142, v142
v_mfma_f32_32x32x16_bf16 v[120:135], v[224:227], v[180:183], v[120:135]
v_exp_f16_sdwa v147, v148 dst_sel:WORD_1 dst_unused:UNUSED_PRESERVE src0_sel:WORD_1
v_fmac_f32 v161, v197, v197
v_lshrrev_b32 v141, 18, v141
v_pk_add_f16 v153, v153, 1.0 op_sel_hi:[1,0]
v_lshrrev_b32 v143, 18, v143
v_fmac_f32 v161, v198, v198
v_pk_add_f16 v150, v150, 1.0 op_sel_hi:[1,0]
v_pk_add_f16 v147, v147, 1.0 op_sel_hi:[1,0]
v_fmac_f32_e64 v161, v199, v199
v_and_b32 v145, s49, v145
s_waitcnt lgkmcnt(4)
ds_read_b128 v[224:227], v249 offset:4096
ds_read_u16_d16_hi v141, v141
ds_read_u16_d16_hi v143, v143
v_mfma_f32_32x32x16_bf16 v[120:135], v[228:231], v[184:187], v[120:135]
v_rcp_f16 v154, v153
v_fmac_f32 v161, v200, v200
v_bfe_u32 v144, v145, 2, 14
v_rcp_f16 v151, v150
s_setprio 0
v_fmac_f32 v161, v201, v201
v_lshrrev_b32 v145, 18, v145
v_rcp_f16 v148, v147
v_fmac_f32 v161, v202, v202
ds_read_u16_d16 v144, v144
ds_read_u16_d16_hi v145, v145
v_or_b32_e64 v48, v136, v137
ds_read_b128 v[228:231], v249 offset:2048
v_mfma_f32_32x32x16_bf16 v[120:135], v[232:235], v[188:191], v[120:135]
s_waitcnt lgkmcnt(6)
v_or_b32 v49, v138, v139
v_fmac_f32_e64 v161, v203, v203
v_rcp_f16_sdwa v154, v153 dst_sel:WORD_1 dst_unused:UNUSED_PRESERVE src0_sel:WORD_1
v_fmac_f32 v161, v204, v204
s_waitcnt lgkmcnt(4)
v_or_b32_e64 v50, v140, v141
v_rcp_f16_sdwa v151, v150 dst_sel:WORD_1 dst_unused:UNUSED_PRESERVE src0_sel:WORD_1
v_fmac_f32 v161, v205, v205
s_waitcnt lgkmcnt(3)
v_or_b32_e64 v51, v142, v143
v_rcp_f16_sdwa v148, v147 dst_sel:WORD_1 dst_unused:UNUSED_PRESERVE src0_sel:WORD_1
v_fmac_f32 v161, v206, v206
s_waitcnt lgkmcnt(1)
v_or_b32_e64 v52, v144, v145
v_pk_mul_f16 v53, v155, v154
v_fmac_f32 v161, v207, v207
v_pk_mul_f16 v54, v152, v151
v_pk_mul_f16 v55, v149, v148
s_setprio 2
ds_read_b128 v[232:235], v249 offset:5120
v_mfma_f32_32x32x16_f16 v[192:207], v[48:51], v[208:211], 0
v_cvt_pkrtz_f16_f32 v137, v120, v121
v_cvt_pkrtz_f16_f32 v139, v122, v123
v_cvt_pkrtz_f16_f32 v141, v124, v125
v_cvt_pkrtz_f16_f32 v143, v126, v127
v_cvt_pkrtz_f16_f32 v145, v128, v129
v_mfma_f32_32x32x16_f16 v[192:207], v[52:55], v[212:215], v[192:207]
v_cvt_pk_f16_f32 v155, v130, v131
v_cvt_pk_f16_f32 v152, v132, v133
v_cvt_pk_f16_f32 v149, v134, v135
v_pk_fma_f16 v154, v155, v155, s48
v_and_b32_e64 v137, s49, v137
v_pk_fma_f16 v151, v152, v152, s48
v_mfma_f32_32x32x16_bf16 v[120:135], v[236:239], v[168:171], 0
v_and_b32 v139, s49, v139
v_pk_fma_f16 v148, v149, v149, s48
v_permlane16_swap_b32 v48, v52
v_pk_mul_f16 v154, v155, v154
v_bfe_u32 v136, v137, 2, 14
v_permlane16_swap_b32 v49, v53
v_pk_mul_f16 v151, v152, v151
v_pk_mul_f16 v148, v149, v148
v_bfe_u32 v138, v139, 2, 14
v_permlane16_swap_b32 v50, v54
ds_read_b128 v[236:239], v249 offset:6144
ds_read_u16_d16 v136, v136
ds_read_u16_d16 v138, v138
v_mfma_f32_32x32x16_bf16 v[120:135], v[216:219], v[172:175], v[120:135]
v_exp_f16 v153, v154
v_permlane16_swap_b32 v51, v55
v_lshrrev_b32 v137, 18, v137
v_exp_f16 v150, v151
v_fmac_f32 v162, v192, v192
v_lshrrev_b32 v139, 18, v139
v_exp_f16 v147, v148
v_fmac_f32 v162, v193, v193
v_and_b32_e64 v141, s49, v141
ds_read_b128 v[216:219], v249 offset:9216
ds_read_u16_d16_hi v137, v137
ds_read_u16_d16_hi v139, v139
v_mfma_f32_32x32x16_bf16 v[120:135], v[220:223], v[176:179], v[120:135]
v_and_b32 v143, s49, v143
v_fmac_f32 v162, v194, v194
v_exp_f16_sdwa v153, v154 dst_sel:WORD_1 dst_unused:UNUSED_PRESERVE src0_sel:WORD_1
v_bfe_u32 v140, v141, 2, 14
v_fmac_f32_e64 v162, v195, v195
v_exp_f16_sdwa v150, v151 dst_sel:WORD_1 dst_unused:UNUSED_PRESERVE src0_sel:WORD_1
v_fmac_f32_e64 v162, v196, v196
v_bfe_u32 v142, v143, 2, 14
ds_read_b128 v[220:223], v249 offset:7168
ds_read_u16_d16 v140, v140
ds_read_u16_d16 v142, v142
v_mfma_f32_32x32x16_bf16 v[120:135], v[224:227], v[180:183], v[120:135]
v_exp_f16_sdwa v147, v148 dst_sel:WORD_1 dst_unused:UNUSED_PRESERVE src0_sel:WORD_1
v_fmac_f32 v162, v197, v197
v_lshrrev_b32 v141, 18, v141
v_pk_add_f16 v153, v153, 1.0 op_sel_hi:[1,0]
v_lshrrev_b32 v143, 18, v143
v_fmac_f32 v162, v198, v198
v_pk_add_f16 v150, v150, 1.0 op_sel_hi:[1,0]
v_pk_add_f16 v147, v147, 1.0 op_sel_hi:[1,0]
v_fmac_f32_e64 v162, v199, v199
v_and_b32 v145, s49, v145
s_waitcnt lgkmcnt(4)
ds_read_b128 v[224:227], v249 offset:10240
ds_read_u16_d16_hi v141, v141
ds_read_u16_d16_hi v143, v143
v_mfma_f32_32x32x16_bf16 v[120:135], v[228:231], v[184:187], v[120:135]
v_rcp_f16 v154, v153
v_fmac_f32 v162, v200, v200
v_bfe_u32 v144, v145, 2, 14
v_rcp_f16 v151, v150
v_fmac_f32 v162, v201, v201
v_lshrrev_b32 v145, 18, v145
v_rcp_f16 v148, v147
v_fmac_f32_e64 v162, v202, v202
ds_read_u16_d16 v144, v144
ds_read_u16_d16_hi v145, v145
v_or_b32_e64 v56, v136, v137
ds_read_b128 v[228:231], v249 offset:8192
v_mfma_f32_32x32x16_bf16 v[120:135], v[232:235], v[188:191], v[120:135]
s_waitcnt lgkmcnt(6)
v_or_b32 v57, v138, v139
v_fmac_f32_e64 v162, v203, v203
v_rcp_f16_sdwa v154, v153 dst_sel:WORD_1 dst_unused:UNUSED_PRESERVE src0_sel:WORD_1
v_fmac_f32 v162, v204, v204
s_waitcnt lgkmcnt(4)
v_or_b32_e64 v58, v140, v141
v_rcp_f16_sdwa v151, v150 dst_sel:WORD_1 dst_unused:UNUSED_PRESERVE src0_sel:WORD_1
v_fmac_f32 v162, v205, v205
s_waitcnt lgkmcnt(3)
v_or_b32_e64 v59, v142, v143
v_rcp_f16_sdwa v148, v147 dst_sel:WORD_1 dst_unused:UNUSED_PRESERVE src0_sel:WORD_1
v_fmac_f32 v162, v206, v206
s_waitcnt lgkmcnt(1)
v_or_b32_e64 v60, v144, v145
v_pk_mul_f16 v61, v155, v154
v_fmac_f32 v162, v207, v207
v_pk_mul_f16 v62, v152, v151
v_pk_mul_f16 v63, v149, v148
s_setprio 1
ds_read_b128 v[232:235], v249 offset:11264
v_mfma_f32_32x32x16_f16 v[192:207], v[56:59], v[208:211], 0
v_cvt_pkrtz_f16_f32 v137, v120, v121
v_cvt_pkrtz_f16_f32 v139, v122, v123
v_cvt_pkrtz_f16_f32 v141, v124, v125
v_cvt_pkrtz_f16_f32 v143, v126, v127
v_cvt_pkrtz_f16_f32 v145, v128, v129
v_mfma_f32_32x32x16_f16 v[192:207], v[60:63], v[212:215], v[192:207]
v_cvt_pk_f16_f32 v155, v130, v131
v_cvt_pk_f16_f32 v152, v132, v133
v_cvt_pk_f16_f32 v149, v134, v135
v_pk_fma_f16 v154, v155, v155, s48
v_and_b32_e64 v137, s49, v137
v_pk_fma_f16 v151, v152, v152, s48
v_mfma_f32_32x32x16_bf16 v[120:135], v[236:239], v[168:171], 0
v_and_b32 v139, s49, v139
v_pk_fma_f16 v148, v149, v149, s48
v_permlane16_swap_b32 v56, v60
v_pk_mul_f16 v154, v155, v154
v_bfe_u32 v136, v137, 2, 14
v_permlane16_swap_b32 v57, v61
v_pk_mul_f16 v151, v152, v151
v_pk_mul_f16 v148, v149, v148
v_bfe_u32 v138, v139, 2, 14
v_permlane16_swap_b32 v58, v62
ds_read_b128 v[236:239], v249 offset:12288
ds_read_u16_d16 v136, v136
ds_read_u16_d16 v138, v138
v_mfma_f32_32x32x16_bf16 v[120:135], v[216:219], v[172:175], v[120:135]
v_exp_f16 v153, v154
v_permlane16_swap_b32 v59, v63
v_lshrrev_b32 v137, 18, v137
v_exp_f16 v150, v151
v_fmac_f32 v163, v192, v192
v_lshrrev_b32 v139, 18, v139
v_exp_f16 v147, v148
v_fmac_f32 v163, v193, v193
v_and_b32_e64 v141, s49, v141
ds_read_b128 v[216:219], v249 offset:15360
ds_read_u16_d16_hi v137, v137
ds_read_u16_d16_hi v139, v139
v_mfma_f32_32x32x16_bf16 v[120:135], v[220:223], v[176:179], v[120:135]
v_and_b32 v143, s49, v143
v_fmac_f32 v163, v194, v194
v_exp_f16_sdwa v153, v154 dst_sel:WORD_1 dst_unused:UNUSED_PRESERVE src0_sel:WORD_1
v_bfe_u32 v140, v141, 2, 14
v_fmac_f32_e64 v163, v195, v195
v_exp_f16_sdwa v150, v151 dst_sel:WORD_1 dst_unused:UNUSED_PRESERVE src0_sel:WORD_1
v_fmac_f32_e64 v163, v196, v196
v_bfe_u32 v142, v143, 2, 14
ds_read_b128 v[220:223], v249 offset:13312
ds_read_u16_d16 v140, v140
ds_read_u16_d16 v142, v142
v_mfma_f32_32x32x16_bf16 v[120:135], v[224:227], v[180:183], v[120:135]
v_exp_f16_sdwa v147, v148 dst_sel:WORD_1 dst_unused:UNUSED_PRESERVE src0_sel:WORD_1
v_fmac_f32 v163, v197, v197
v_lshrrev_b32 v141, 18, v141
v_pk_add_f16 v153, v153, 1.0 op_sel_hi:[1,0]
v_lshrrev_b32 v143, 18, v143
v_fmac_f32 v163, v198, v198
v_pk_add_f16 v150, v150, 1.0 op_sel_hi:[1,0]
v_pk_add_f16 v147, v147, 1.0 op_sel_hi:[1,0]
v_fmac_f32_e64 v163, v199, v199
v_and_b32 v145, s49, v145
s_waitcnt lgkmcnt(4)
ds_read_b128 v[224:227], v249 offset:16384
ds_read_u16_d16_hi v141, v141
ds_read_u16_d16_hi v143, v143
v_mfma_f32_32x32x16_bf16 v[120:135], v[228:231], v[184:187], v[120:135]
v_rcp_f16 v154, v153
v_fmac_f32 v163, v200, v200
v_bfe_u32 v144, v145, 2, 14
v_rcp_f16 v151, v150
s_setprio 0
v_fmac_f32 v163, v201, v201
v_lshrrev_b32 v145, 18, v145
v_rcp_f16 v148, v147
v_fmac_f32 v163, v202, v202
ds_read_u16_d16 v144, v144
ds_read_u16_d16_hi v145, v145
v_or_b32_e64 v64, v136, v137
ds_read_b128 v[228:231], v249 offset:14336
v_mfma_f32_32x32x16_bf16 v[120:135], v[232:235], v[188:191], v[120:135]
s_waitcnt lgkmcnt(6)
v_or_b32 v65, v138, v139
v_fmac_f32_e64 v163, v203, v203
v_rcp_f16_sdwa v154, v153 dst_sel:WORD_1 dst_unused:UNUSED_PRESERVE src0_sel:WORD_1
v_fmac_f32 v163, v204, v204
s_waitcnt lgkmcnt(4)
v_or_b32_e64 v66, v140, v141
v_rcp_f16_sdwa v151, v150 dst_sel:WORD_1 dst_unused:UNUSED_PRESERVE src0_sel:WORD_1
v_fmac_f32 v163, v205, v205
s_waitcnt lgkmcnt(3)
v_or_b32_e64 v67, v142, v143
v_rcp_f16_sdwa v148, v147 dst_sel:WORD_1 dst_unused:UNUSED_PRESERVE src0_sel:WORD_1
v_fmac_f32 v163, v206, v206
s_waitcnt lgkmcnt(1)
v_or_b32_e64 v68, v144, v145
v_pk_mul_f16 v69, v155, v154
v_fmac_f32 v163, v207, v207
v_pk_mul_f16 v70, v152, v151
v_pk_mul_f16 v71, v149, v148
s_setprio 2
ds_read_b128 v[232:235], v249 offset:17408
v_mfma_f32_32x32x16_f16 v[192:207], v[64:67], v[208:211], 0
v_cvt_pkrtz_f16_f32 v137, v120, v121
v_cvt_pkrtz_f16_f32 v139, v122, v123
v_cvt_pkrtz_f16_f32 v141, v124, v125
v_cvt_pkrtz_f16_f32 v143, v126, v127
v_cvt_pkrtz_f16_f32 v145, v128, v129
v_mfma_f32_32x32x16_f16 v[192:207], v[68:71], v[212:215], v[192:207]
v_cvt_pk_f16_f32 v155, v130, v131
v_cvt_pk_f16_f32 v152, v132, v133
v_cvt_pk_f16_f32 v149, v134, v135
v_pk_fma_f16 v154, v155, v155, s48
v_and_b32_e64 v137, s49, v137
v_pk_fma_f16 v151, v152, v152, s48
v_mfma_f32_32x32x16_bf16 v[120:135], v[236:239], v[168:171], 0
v_and_b32 v139, s49, v139
v_pk_fma_f16 v148, v149, v149, s48
v_permlane16_swap_b32 v64, v68
v_pk_mul_f16 v154, v155, v154
v_bfe_u32 v136, v137, 2, 14
v_permlane16_swap_b32 v65, v69
v_pk_mul_f16 v151, v152, v151
v_pk_mul_f16 v148, v149, v148
v_bfe_u32 v138, v139, 2, 14
v_permlane16_swap_b32 v66, v70
ds_read_b128 v[236:239], v249 offset:18432
ds_read_u16_d16 v136, v136
ds_read_u16_d16 v138, v138
v_mfma_f32_32x32x16_bf16 v[120:135], v[216:219], v[172:175], v[120:135]
v_exp_f16 v153, v154
v_permlane16_swap_b32 v67, v71
v_lshrrev_b32 v137, 18, v137
v_exp_f16 v150, v151
v_fmac_f32 v164, v192, v192
v_lshrrev_b32 v139, 18, v139
v_exp_f16 v147, v148
v_fmac_f32 v164, v193, v193
v_and_b32_e64 v141, s49, v141
ds_read_b128 v[216:219], v249 offset:21504
ds_read_u16_d16_hi v137, v137
ds_read_u16_d16_hi v139, v139
v_mfma_f32_32x32x16_bf16 v[120:135], v[220:223], v[176:179], v[120:135]
v_and_b32 v143, s49, v143
v_fmac_f32 v164, v194, v194
v_exp_f16_sdwa v153, v154 dst_sel:WORD_1 dst_unused:UNUSED_PRESERVE src0_sel:WORD_1
v_bfe_u32 v140, v141, 2, 14
v_fmac_f32_e64 v164, v195, v195
v_exp_f16_sdwa v150, v151 dst_sel:WORD_1 dst_unused:UNUSED_PRESERVE src0_sel:WORD_1
v_fmac_f32_e64 v164, v196, v196
v_bfe_u32 v142, v143, 2, 14
ds_read_b128 v[220:223], v249 offset:19456
ds_read_u16_d16 v140, v140
ds_read_u16_d16 v142, v142
v_mfma_f32_32x32x16_bf16 v[120:135], v[224:227], v[180:183], v[120:135]
v_exp_f16_sdwa v147, v148 dst_sel:WORD_1 dst_unused:UNUSED_PRESERVE src0_sel:WORD_1
v_fmac_f32 v164, v197, v197
v_lshrrev_b32 v141, 18, v141
v_pk_add_f16 v153, v153, 1.0 op_sel_hi:[1,0]
v_lshrrev_b32 v143, 18, v143
v_fmac_f32 v164, v198, v198
v_pk_add_f16 v150, v150, 1.0 op_sel_hi:[1,0]
v_pk_add_f16 v147, v147, 1.0 op_sel_hi:[1,0]
v_fmac_f32_e64 v164, v199, v199
v_and_b32 v145, s49, v145
s_waitcnt lgkmcnt(4)
ds_read_b128 v[224:227], v249 offset:22528
ds_read_u16_d16_hi v141, v141
ds_read_u16_d16_hi v143, v143
v_mfma_f32_32x32x16_bf16 v[120:135], v[228:231], v[184:187], v[120:135]
v_rcp_f16 v154, v153
v_fmac_f32 v164, v200, v200
v_bfe_u32 v144, v145, 2, 14
v_rcp_f16 v151, v150
v_fmac_f32 v164, v201, v201
v_lshrrev_b32 v145, 18, v145
v_rcp_f16 v148, v147
v_fmac_f32_e64 v164, v202, v202
ds_read_u16_d16 v144, v144
ds_read_u16_d16_hi v145, v145
v_or_b32_e64 v72, v136, v137
ds_read_b128 v[228:231], v249 offset:20480
v_mfma_f32_32x32x16_bf16 v[120:135], v[232:235], v[188:191], v[120:135]
s_waitcnt lgkmcnt(6)
v_or_b32 v73, v138, v139
v_fmac_f32_e64 v164, v203, v203
v_rcp_f16_sdwa v154, v153 dst_sel:WORD_1 dst_unused:UNUSED_PRESERVE src0_sel:WORD_1
v_fmac_f32 v164, v204, v204
s_waitcnt lgkmcnt(4)
v_or_b32_e64 v74, v140, v141
v_rcp_f16_sdwa v151, v150 dst_sel:WORD_1 dst_unused:UNUSED_PRESERVE src0_sel:WORD_1
v_fmac_f32 v164, v205, v205
s_waitcnt lgkmcnt(3)
v_or_b32_e64 v75, v142, v143
v_rcp_f16_sdwa v148, v147 dst_sel:WORD_1 dst_unused:UNUSED_PRESERVE src0_sel:WORD_1
v_fmac_f32 v164, v206, v206
s_waitcnt lgkmcnt(1)
v_or_b32_e64 v76, v144, v145
v_pk_mul_f16 v77, v155, v154
v_fmac_f32_e64 v164, v207, v207
v_pk_mul_f16 v78, v152, v151
v_pk_mul_f16 v79, v149, v148
s_cmp_lg_u32 s40, 0
s_cbranch_scc1 Lrs2
v_min_u32_e64 v88, 47, v251
v_lshlrev_b32 v88, 3, v88
v_add_u32 v89, 7936, v88
v_add_u32 v88, 15872, v88
v_cmp_gt_u32 vcc, 32, v251
s_nop 1
v_cndmask_b32 v88, v88, v89, vcc
s_waitcnt vmcnt(0)
ds_write_b64 v88, v[92:93]
Lrs2:
s_setprio 1
ds_read_b128 v[232:235], v249 offset:23552
v_mfma_f32_32x32x16_f16 v[192:207], v[72:75], v[208:211], 0
v_cvt_pkrtz_f16_f32 v137, v120, v121
v_cvt_pkrtz_f16_f32 v139, v122, v123
v_cvt_pkrtz_f16_f32 v141, v124, v125
v_cvt_pkrtz_f16_f32 v143, v126, v127
v_cvt_pkrtz_f16_f32 v145, v128, v129
v_mfma_f32_32x32x16_f16 v[192:207], v[76:79], v[212:215], v[192:207]
v_cvt_pk_f16_f32 v155, v130, v131
v_cvt_pk_f16_f32 v152, v132, v133
v_cvt_pk_f16_f32 v149, v134, v135
v_pk_fma_f16 v154, v155, v155, s48
v_and_b32_e64 v137, s49, v137
v_pk_fma_f16 v151, v152, v152, s48
v_mfma_f32_32x32x16_bf16 v[120:135], v[236:239], v[168:171], 0
v_and_b32 v139, s49, v139
v_pk_fma_f16 v148, v149, v149, s48
v_permlane16_swap_b32 v72, v76
v_pk_mul_f16 v154, v155, v154
v_bfe_u32 v136, v137, 2, 14
v_permlane16_swap_b32 v73, v77
v_pk_mul_f16 v151, v152, v151
v_pk_mul_f16 v148, v149, v148
v_bfe_u32 v138, v139, 2, 14
v_permlane16_swap_b32 v74, v78
ds_read_u16_d16 v136, v136
ds_read_u16_d16 v138, v138
v_mfma_f32_32x32x16_bf16 v[120:135], v[216:219], v[172:175], v[120:135]
v_exp_f16 v153, v154
v_permlane16_swap_b32 v75, v79
v_lshrrev_b32 v137, 18, v137
v_exp_f16 v150, v151
v_fmac_f32 v165, v192, v192
v_lshrrev_b32 v139, 18, v139
v_exp_f16 v147, v148
v_fmac_f32 v165, v193, v193
v_and_b32_e64 v141, s49, v141
ds_read_u16_d16_hi v137, v137
ds_read_u16_d16_hi v139, v139
v_mfma_f32_32x32x16_bf16 v[120:135], v[220:223], v[176:179], v[120:135]
v_and_b32 v143, s49, v143
v_fmac_f32 v165, v194, v194
v_exp_f16_sdwa v153, v154 dst_sel:WORD_1 dst_unused:UNUSED_PRESERVE src0_sel:WORD_1
v_bfe_u32 v140, v141, 2, 14
v_fmac_f32_e64 v165, v195, v195
v_exp_f16_sdwa v150, v151 dst_sel:WORD_1 dst_unused:UNUSED_PRESERVE src0_sel:WORD_1
v_fmac_f32_e64 v165, v196, v196
v_bfe_u32 v142, v143, 2, 14
ds_read_u16_d16 v140, v140
ds_read_u16_d16 v142, v142
v_mfma_f32_32x32x16_bf16 v[120:135], v[224:227], v[180:183], v[120:135]
v_exp_f16_sdwa v147, v148 dst_sel:WORD_1 dst_unused:UNUSED_PRESERVE src0_sel:WORD_1
v_fmac_f32 v165, v197, v197
v_lshrrev_b32 v141, 18, v141
v_pk_add_f16 v153, v153, 1.0 op_sel_hi:[1,0]
v_lshrrev_b32 v143, 18, v143
v_fmac_f32 v165, v198, v198
v_pk_add_f16 v150, v150, 1.0 op_sel_hi:[1,0]
v_pk_add_f16 v147, v147, 1.0 op_sel_hi:[1,0]
v_fmac_f32_e64 v165, v199, v199
v_and_b32 v145, s49, v145
s_waitcnt lgkmcnt(4)
ds_read_u16_d16_hi v141, v141
ds_read_u16_d16_hi v143, v143
v_mfma_f32_32x32x16_bf16 v[120:135], v[228:231], v[184:187], v[120:135]
v_rcp_f16 v154, v153
v_fmac_f32 v165, v200, v200
v_bfe_u32 v144, v145, 2, 14
v_rcp_f16 v151, v150
s_setprio 0
v_fmac_f32 v165, v201, v201
v_lshrrev_b32 v145, 18, v145
v_rcp_f16 v148, v147
v_fmac_f32 v165, v202, v202
ds_read_u16_d16 v144, v144
ds_read_u16_d16_hi v145, v145
s_waitcnt lgkmcnt(4)
v_or_b32 v80, v136, v137
v_mfma_f32_32x32x16_bf16 v[120:135], v[232:235], v[188:191], v[120:135]
v_or_b32 v81, v138, v139
v_fmac_f32 v165, v203, v203
v_rcp_f16_sdwa v154, v153 dst_sel:WORD_1 dst_unused:UNUSED_PRESERVE src0_sel:WORD_1
v_fmac_f32 v165, v204, v204
s_waitcnt lgkmcnt(3)
v_or_b32_e64 v82, v140, v141
v_rcp_f16_sdwa v151, v150 dst_sel:WORD_1 dst_unused:UNUSED_PRESERVE src0_sel:WORD_1
v_fmac_f32 v165, v205, v205
s_waitcnt lgkmcnt(2)
v_or_b32_e64 v83, v142, v143
v_rcp_f16_sdwa v148, v147 dst_sel:WORD_1 dst_unused:UNUSED_PRESERVE src0_sel:WORD_1
v_fmac_f32 v165, v206, v206
s_waitcnt lgkmcnt(0)
v_or_b32_e64 v84, v144, v145
v_pk_mul_f16 v85, v155, v154
v_fmac_f32 v165, v207, v207
v_pk_mul_f16 v86, v152, v151
v_pk_mul_f16 v87, v149, v148
s_setprio 2
v_mfma_f32_32x32x16_f16 v[192:207], v[80:83], v[208:211], 0
v_mfma_f32_32x32x16_f16 v[192:207], v[84:87], v[212:215], v[192:207]
v_cvt_pkrtz_f16_f32 v137, v120, v121
v_cvt_pkrtz_f16_f32 v139, v122, v123
v_cvt_pkrtz_f16_f32 v141, v124, v125
v_cvt_pkrtz_f16_f32 v143, v126, v127
v_cvt_pkrtz_f16_f32 v145, v128, v129
v_cvt_pk_f16_f32 v155, v130, v131
v_cvt_pk_f16_f32 v152, v132, v133
v_cvt_pk_f16_f32 v149, v134, v135
v_pk_fma_f16 v154, v155, v155, s48
v_and_b32_e64 v137, s49, v137
v_pk_fma_f16 v151, v152, v152, s48
v_and_b32_e64 v139, s49, v139
v_pk_fma_f16 v148, v149, v149, s48
v_permlane16_swap_b32 v80, v84
v_pk_mul_f16 v154, v155, v154
v_bfe_u32 v136, v137, 2, 14
v_permlane16_swap_b32 v81, v85
v_pk_mul_f16 v151, v152, v151
v_pk_mul_f16 v148, v149, v148
v_bfe_u32 v138, v139, 2, 14
v_permlane16_swap_b32 v82, v86
v_exp_f16 v153, v154
v_permlane16_swap_b32 v83, v87
v_lshrrev_b32 v137, 18, v137
v_exp_f16 v150, v151
v_fmac_f32 v166, v192, v192
v_lshrrev_b32 v139, 18, v139
v_exp_f16 v147, v148
v_fmac_f32 v166, v193, v193
v_and_b32 v141, s49, v141
v_and_b32_e64 v143, s49, v143
ds_read_u16_d16 v136, v136
ds_read_u16_d16 v138, v138
ds_read_u16_d16_hi v137, v137
ds_read_u16_d16_hi v139, v139
v_fmac_f32_e64 v166, v194, v194
v_exp_f16_sdwa v153, v154 dst_sel:WORD_1 dst_unused:UNUSED_PRESERVE src0_sel:WORD_1
v_bfe_u32 v140, v141, 2, 14
v_fmac_f32_e64 v166, v195, v195
v_exp_f16_sdwa v150, v151 dst_sel:WORD_1 dst_unused:UNUSED_PRESERVE src0_sel:WORD_1
v_fmac_f32_e64 v166, v196, v196
v_bfe_u32 v142, v143, 2, 14
v_exp_f16_sdwa v147, v148 dst_sel:WORD_1 dst_unused:UNUSED_PRESERVE src0_sel:WORD_1
v_fmac_f32 v166, v197, v197
v_lshrrev_b32 v141, 18, v141
v_pk_add_f16 v153, v153, 1.0 op_sel_hi:[1,0]
v_lshrrev_b32 v143, 18, v143
v_fmac_f32 v166, v198, v198
v_pk_add_f16 v150, v150, 1.0 op_sel_hi:[1,0]
v_pk_add_f16 v147, v147, 1.0 op_sel_hi:[1,0]
v_fmac_f32 v166, v199, v199
v_and_b32 v145, s49, v145
v_rcp_f16 v154, v153
v_fmac_f32 v166, v200, v200
v_bfe_u32 v144, v145, 2, 14
v_rcp_f16 v151, v150
v_fmac_f32 v166, v201, v201
v_lshrrev_b32_e64 v145, 18, v145
ds_read_u16_d16 v140, v140
ds_read_u16_d16 v142, v142
ds_read_u16_d16_hi v141, v141
ds_read_u16_d16_hi v143, v143
ds_read_u16_d16 v144, v144
ds_read_u16_d16_hi v145, v145
v_rcp_f16 v148, v147
v_fmac_f32 v166, v202, v202
s_waitcnt lgkmcnt(6)
v_or_b32 v88, v136, v137
v_or_b32 v89, v138, v139
v_fmac_f32 v166, v203, v203
v_rcp_f16_sdwa v154, v153 dst_sel:WORD_1 dst_unused:UNUSED_PRESERVE src0_sel:WORD_1
v_fmac_f32 v166, v204, v204
s_waitcnt lgkmcnt(3)
v_or_b32_e64 v90, v140, v141
v_rcp_f16_sdwa v151, v150 dst_sel:WORD_1 dst_unused:UNUSED_PRESERVE src0_sel:WORD_1
v_fmac_f32 v166, v205, v205
s_waitcnt lgkmcnt(2)
v_or_b32_e64 v91, v142, v143
v_rcp_f16_sdwa v148, v147 dst_sel:WORD_1 dst_unused:UNUSED_PRESERVE src0_sel:WORD_1
v_fmac_f32 v166, v206, v206
s_waitcnt lgkmcnt(0)
v_or_b32_e64 v92, v144, v145
v_pk_mul_f16 v93, v155, v154
v_fmac_f32 v166, v207, v207
v_pk_mul_f16 v94, v152, v151
v_pk_mul_f16 v95, v149, v148
s_setprio 1
v_mfma_f32_32x32x16_f16 v[192:207], v[88:91], v[208:211], 0
v_mfma_f32_32x32x16_f16 v[192:207], v[92:95], v[212:215], v[192:207]
v_permlane16_swap_b32 v88, v92
v_permlane16_swap_b32 v89, v93
v_permlane16_swap_b32 v90, v94
v_permlane16_swap_b32 v91, v95
s_nop 7
v_fmac_f32 v167, v192, v192
v_fmac_f32 v167, v193, v193
v_fmac_f32 v167, v194, v194
v_fmac_f32 v167, v195, v195
v_fmac_f32 v167, v196, v196
v_fmac_f32 v167, v197, v197
v_fmac_f32 v167, v198, v198
v_fmac_f32 v167, v199, v199
v_fmac_f32 v167, v200, v200
v_fmac_f32 v167, v201, v201
v_fmac_f32 v167, v202, v202
s_setprio 0
v_fmac_f32 v167, v203, v203
v_fmac_f32 v167, v204, v204
v_fmac_f32 v167, v205, v205
v_fmac_f32 v167, v206, v206
v_fmac_f32 v167, v207, v207
s_setprio 3
v_and_b32 v136, 51, v251
v_bfe_u32 v137, v251, 2, 1
v_lshl_add_u32 v136, v137, 3, v136
v_bfe_u32 v137, v251, 3, 1
v_lshl_add_u32 v136, v137, 2, v136
v_lshl_add_u32 v136, v136, 2, s72
v_permlane32_swap_b32 v156, v157
v_add_f32 v156, v156, v157
ds_write_b32 v136, v156 offset:7168
v_permlane32_swap_b32 v158, v159
v_add_f32 v158, v158, v159
ds_write_b32 v136, v158 offset:7424
v_permlane32_swap_b32 v160, v161
v_add_f32 v160, v160, v161
ds_write_b32 v136, v160 offset:7680
v_permlane32_swap_b32 v162, v163
v_add_f32 v162, v162, v163
ds_write_b32 v136, v162 offset:7936
v_permlane32_swap_b32 v164, v165
v_add_f32 v164, v164, v165
ds_write_b32 v136, v164 offset:8192
v_permlane32_swap_b32 v166, v167
v_add_f32 v166, v166, v167
ds_write_b32 v136, v166 offset:8448
v_mov_b32 v128, 16256
v_mov_b32_e64 v129, 1
s_waitcnt lgkmcnt(0)
s_mov_b64 exec, 1
ds_add_rtn_u32 v130, v128, v129
s_mov_b64 exec, -1
s_waitcnt lgkmcnt(0)
v_readfirstlane_b32 s43, v130
s_nop 1
s_cmp_lg_u32 s43, 7
s_cbranch_scc1 Lnopub
v_min_u32 v131, 47, v251
v_lshlrev_b32 v132, 5, v131
v_add_u32 v132, 97280, v132
ds_read_b128 v[168:171], v132
ds_read_b128 v[172:175], v132 offset:16
ds_read_b128 v[176:179], v132 offset:9216
ds_read_b128 v[180:183], v132 offset:9232
ds_read_b128 v[184:187], v132 offset:18432
ds_read_b128 v[188:191], v132 offset:18448
ds_read_b128 v[192:195], v132 offset:27648
ds_read_b128 v[196:199], v132 offset:27664
ds_read_b128 v[200:203], v132 offset:36864
ds_read_b128 v[204:207], v132 offset:36880
ds_read_b128 v[208:211], v132 offset:46080
ds_read_b128 v[212:215], v132 offset:46096
ds_read_b128 v[216:219], v132 offset:55296
ds_read_b128 v[220:223], v132 offset:55312
ds_read_b128 v[120:123], v132 offset:64512
ds_read_b128 v[124:127], v132 offset:64528
v_lshlrev_b32_e64 v134, 13, v131
v_add_u32 v135, 4096, v134
s_waitcnt lgkmcnt(13)
v_add_f32 v168, v168, v176
v_add_f32 v169, v169, v177
v_add_f32 v170, v170, v178
v_add_f32 v171, v171, v179
s_waitcnt lgkmcnt(12)
v_add_f32 v172, v172, v180
v_add_f32 v173, v173, v181
v_add_f32 v174, v174, v182
v_add_f32 v175, v175, v183
s_waitcnt lgkmcnt(9)
v_add_f32 v184, v184, v192
v_add_f32 v185, v185, v193
v_add_f32 v186, v186, v194
v_add_f32 v187, v187, v195
s_waitcnt lgkmcnt(8)
v_add_f32 v188, v188, v196
v_add_f32 v189, v189, v197
v_add_f32 v190, v190, v198
v_add_f32 v191, v191, v199
s_waitcnt lgkmcnt(5)
v_add_f32 v200, v200, v208
v_add_f32 v201, v201, v209
v_add_f32 v202, v202, v210
v_add_f32 v203, v203, v211
s_waitcnt lgkmcnt(4)
v_add_f32 v204, v204, v212
v_add_f32 v205, v205, v213
v_add_f32 v206, v206, v214
v_add_f32 v207, v207, v215
s_waitcnt lgkmcnt(1)
v_add_f32 v216, v216, v120
v_add_f32 v217, v217, v121
v_add_f32 v218, v218, v122
v_add_f32 v219, v219, v123
s_waitcnt lgkmcnt(0)
v_add_f32 v220, v220, v124
v_add_f32 v221, v221, v125
v_add_f32 v222, v222, v126
v_add_f32 v223, v223, v127
v_add_f32 v168, v168, v184
v_add_f32 v169, v169, v185
v_add_f32 v170, v170, v186
v_add_f32 v171, v171, v187
v_add_f32 v172, v172, v188
v_add_f32 v173, v173, v189
v_add_f32 v174, v174, v190
v_add_f32 v175, v175, v191
v_add_f32 v200, v200, v216
v_add_f32 v201, v201, v217
v_add_f32 v202, v202, v218
v_add_f32 v203, v203, v219
v_add_f32 v204, v204, v220
v_add_f32 v205, v205, v221
v_add_f32 v206, v206, v222
v_add_f32 v207, v207, v223
v_add_f32 v168, v168, v200
v_add_f32 v169, v169, v201
v_add_f32 v170, v170, v202
v_add_f32 v171, v171, v203
v_add_f32 v172, v172, v204
v_add_f32 v173, v173, v205
v_add_f32 v174, v174, v206
v_add_f32 v175, v175, v207
v_min_u32 v176, -2, v168
v_min_u32 v177, -2, v169
v_min_u32 v178, -2, v170
v_min_u32 v179, -2, v171
v_min_u32 v180, -2, v172
v_min_u32 v181, -2, v173
v_min_u32_e64 v182, -2, v174
v_min_u32 v183, -2, v175
s_lshl_b32 s43, s2, 4
buffer_store_dwordx4 v[176:179], v134, s[32:35], s43 offen sc1
buffer_store_dwordx4 v[180:183], v135, s[32:35], s43 offen sc1
ds_write_b32 v128, v129 offset:4
s_waitcnt lgkmcnt(0)
s_nop 1
Lnopub:
v_mov_b32 v252, v240
s_mov_b32 s77, 0
s_cmp_lg_u32 s40, 0
s_cbranch_scc1 Lnorole
s_cmp_lt_u32 s2, 96
s_cselect_b32 s77, 1, 2
v_mov_b32 v156, -1
v_mov_b32 v157, -1
v_mov_b32 v158, -1
v_mov_b32 v159, -1
v_mov_b32 v160, -1
v_mov_b32 v161, -1
v_mov_b32 v162, -1
v_mov_b32 v163, -1
v_mov_b32 v164, -1
v_mov_b32 v165, -1
v_mov_b32 v166, -1
v_mov_b32 v167, -1
v_mov_b32 v240, -1
v_mov_b32 v241, -1
v_mov_b32 v242, -1
v_mov_b32 v243, -1
s_call_b64 s[78:79], Lpoll
Lnorole:
s_setprio 0
ds_read_b128 v[224:227], v248 offset:47104
ds_read_b128 v[228:231], v248 offset:50176
ds_read_b128 v[232:235], v248 offset:48128
ds_read_b128 v[236:239], v248 offset:51200
s_setprio 2
s_waitcnt lgkmcnt(3)
v_mfma_f32_32x32x16_bf16 v[120:135], v[224:227], v[96:99], 0
s_waitcnt lgkmcnt(2)
ds_read_b128 v[224:227], v248 offset:49152
v_mfma_f32_32x32x16_bf16 v[120:135], v[228:231], v[100:103], v[120:135]
s_waitcnt lgkmcnt(2)
ds_read_b128 v[228:231], v248 offset:52224
v_mfma_f32_32x32x16_bf16 v[120:135], v[232:235], v[104:107], v[120:135]
s_waitcnt lgkmcnt(2)
ds_read_b128 v[232:235], v248 offset:53248
v_mfma_f32_32x32x16_bf16 v[120:135], v[236:239], v[108:111], v[120:135]
s_waitcnt lgkmcnt(2)
ds_read_b128 v[236:239], v248 offset:56320
v_mfma_f32_32x32x16_bf16 v[120:135], v[224:227], v[112:115], v[120:135]
s_waitcnt lgkmcnt(2)
ds_read_b128 v[224:227], v248 offset:54272
v_mfma_f32_32x32x16_bf16 v[120:135], v[228:231], v[116:119], v[120:135]
s_cmp_eq_u32 s77, 0
s_cbranch_scc1 Lpp0
s_getreg_b32 s43, hwreg(HW_REG_IB_STS, 0, 4)
s_cmp_lg_u32 s43, 0
s_cbranch_scc1 Lpp0
s_call_b64 s[78:79], Lpoll
s_setprio 2
Lpp0:
s_nop 9
v_cvt_pkrtz_f16_f32 v137, v120, v121
v_cvt_pkrtz_f16_f32 v139, v122, v123
v_cvt_pkrtz_f16_f32 v141, v124, v125
v_cvt_pkrtz_f16_f32 v143, v126, v127
v_cvt_pkrtz_f16_f32 v145, v128, v129
v_cvt_pk_f16_f32 v155, v130, v131
v_cvt_pk_f16_f32 v152, v132, v133
v_cvt_pk_f16_f32 v149, v134, v135
s_waitcnt lgkmcnt(0)
ds_read_b128 v[228:231], v248 offset:57344
v_mfma_f32_32x32x16_bf16 v[120:135], v[232:235], v[96:99], 0
v_pk_fma_f16 v154, v155, v155, s48
v_and_b32 v137, s49, v137
v_pk_fma_f16 v151, v152, v152, s48
v_and_b32_e64 v139, s49, v139
v_pk_fma_f16 v148, v149, v149, s48
v_pk_mul_f16 v154, v155, v154
v_bfe_u32 v136, v137, 2, 14
v_pk_mul_f16 v151, v152, v151
ds_read_b128 v[232:235], v248 offset:55296
ds_read_u16_d16 v136, v136
v_mfma_f32_32x32x16_bf16 v[120:135], v[236:239], v[100:103], v[120:135]
v_pk_mul_f16 v148, v149, v148
v_bfe_u32 v138, v139, 2, 14
v_exp_f16 v153, v154
v_lshrrev_b32 v137, 18, v137
v_exp_f16 v150, v151
s_setprio 1
v_lshrrev_b32_e64 v139, 18, v139
ds_read_b128 v[236:239], v248 offset:58368
ds_read_u16_d16 v138, v138
ds_read_u16_d16_hi v137, v137
ds_read_u16_d16_hi v139, v139
v_mfma_f32_32x32x16_bf16 v[120:135], v[224:227], v[104:107], v[120:135]
v_exp_f16 v147, v148
v_and_b32 v141, s49, v141
v_and_b32 v143, s49, v143
v_exp_f16_sdwa v153, v154 dst_sel:WORD_1 dst_unused:UNUSED_PRESERVE src0_sel:WORD_1
v_bfe_u32 v140, v141, 2, 14
v_exp_f16_sdwa v150, v151 dst_sel:WORD_1 dst_unused:UNUSED_PRESERVE src0_sel:WORD_1
s_waitcnt lgkmcnt(6)
ds_read_b128 v[224:227], v248 offset:59392
ds_read_u16_d16 v140, v140
v_mfma_f32_32x32x16_bf16 v[120:135], v[228:231], v[108:111], v[120:135]
v_bfe_u32 v142, v143, 2, 14
v_exp_f16_sdwa v147, v148 dst_sel:WORD_1 dst_unused:UNUSED_PRESERVE src0_sel:WORD_1
v_lshrrev_b32_e64 v141, 18, v141
v_pk_add_f16 v153, v153, 1.0 op_sel_hi:[1,0]
v_lshrrev_b32 v143, 18, v143
v_pk_add_f16 v150, v150, 1.0 op_sel_hi:[1,0]
v_pk_add_f16 v147, v147, 1.0 op_sel_hi:[1,0]
s_waitcnt lgkmcnt(6)
ds_read_b128 v[228:231], v248 offset:62464
ds_read_u16_d16 v142, v142
ds_read_u16_d16_hi v141, v141
ds_read_u16_d16_hi v143, v143
v_mfma_f32_32x32x16_bf16 v[120:135], v[232:235], v[112:115], v[120:135]
v_and_b32 v145, s49, v145
v_rcp_f16 v154, v153
v_bfe_u32 v144, v145, 2, 14
v_rcp_f16_e64 v151, v150
v_lshrrev_b32 v145, 18, v145
s_waitcnt lgkmcnt(6)
ds_read_b128 v[232:235], v248 offset:60416
ds_read_u16_d16 v144, v144
ds_read_u16_d16_hi v145, v145
v_mfma_f32_32x32x16_bf16 v[120:135], v[236:239], v[116:119], v[120:135]
v_rcp_f16 v148, v147
v_or_b32 v168, v136, v137
v_or_b32_e64 v169, v138, v139
v_rcp_f16_sdwa v154, v153 dst_sel:WORD_1 dst_unused:UNUSED_PRESERVE src0_sel:WORD_1
s_waitcnt lgkmcnt(4)
v_or_b32 v170, v140, v141
v_rcp_f16_sdwa v151, v150 dst_sel:WORD_1 dst_unused:UNUSED_PRESERVE src0_sel:WORD_1
s_waitcnt lgkmcnt(3)
v_or_b32 v171, v142, v143
v_rcp_f16_sdwa v148, v147 dst_sel:WORD_1 dst_unused:UNUSED_PRESERVE src0_sel:WORD_1
s_waitcnt lgkmcnt(0)
v_or_b32_e64 v172, v144, v145
v_pk_mul_f16 v173, v155, v154
v_pk_mul_f16 v174, v152, v151
v_pk_mul_f16 v175, v149, v148
s_cmp_eq_u32 s77, 0
s_cbranch_scc1 Lpp1
s_getreg_b32 s43, hwreg(HW_REG_IB_STS, 0, 4)
s_cmp_lg_u32 s43, 0
s_cbranch_scc1 Lpp1
s_call_b64 s[78:79], Lpoll
s_setprio 1
Lpp1:
v_cvt_pkrtz_f16_f32 v137, v120, v121
v_cvt_pkrtz_f16_f32 v139, v122, v123
v_cvt_pkrtz_f16_f32 v141, v124, v125
v_cvt_pkrtz_f16_f32 v143, v126, v127
v_cvt_pkrtz_f16_f32 v145, v128, v129
v_cvt_pk_f16_f32 v155, v130, v131
v_cvt_pk_f16_f32 v152, v132, v133
v_cvt_pk_f16_f32 v149, v134, v135
ds_read_b128 v[236:239], v248 offset:63488
v_mfma_f32_32x32x16_bf16 v[120:135], v[224:227], v[96:99], 0
v_pk_fma_f16 v154, v155, v155, s48
v_permlane16_swap_b32 v168, v172
v_and_b32 v137, s49, v137
v_pk_fma_f16 v151, v152, v152, s48
v_and_b32_e64 v139, s49, v139
v_pk_fma_f16 v148, v149, v149, s48
v_pk_mul_f16 v154, v155, v154
v_bfe_u32 v136, v137, 2, 14
v_pk_mul_f16 v151, v152, v151
ds_read_b128 v[224:227], v248 offset:61440
ds_read_u16_d16 v136, v136
v_mfma_f32_32x32x16_bf16 v[120:135], v[228:231], v[100:103], v[120:135]
v_pk_mul_f16 v148, v149, v148
v_bfe_u32 v138, v139, 2, 14
v_exp_f16 v153, v154
v_lshrrev_b32 v137, 18, v137
v_exp_f16 v150, v151
v_permlane16_swap_b32 v169, v173
v_lshrrev_b32_e64 v139, 18, v139
ds_read_b128 v[228:231], v248 offset:64512
ds_read_u16_d16 v138, v138
ds_read_u16_d16_hi v137, v137
ds_read_u16_d16_hi v139, v139
v_mfma_f32_32x32x16_bf16 v[120:135], v[232:235], v[104:107], v[120:135]
v_exp_f16 v147, v148
s_setprio 0
v_and_b32_e64 v141, s49, v141
v_and_b32 v143, s49, v143
v_exp_f16_sdwa v153, v154 dst_sel:WORD_1 dst_unused:UNUSED_PRESERVE src0_sel:WORD_1
v_bfe_u32 v140, v141, 2, 14
v_exp_f16_sdwa v150, v151 dst_sel:WORD_1 dst_unused:UNUSED_PRESERVE src0_sel:WORD_1
s_waitcnt lgkmcnt(6)
ds_read_b128 v[232:235], v249
ds_read_u16_d16 v140, v140
v_mfma_f32_32x32x16_bf16 v[120:135], v[236:239], v[108:111], v[120:135]
v_bfe_u32 v142, v143, 2, 14
v_exp_f16_sdwa v147, v148 dst_sel:WORD_1 dst_unused:UNUSED_PRESERVE src0_sel:WORD_1
v_lshrrev_b32 v141, 18, v141
v_permlane16_swap_b32 v170, v174
v_pk_add_f16 v153, v153, 1.0 op_sel_hi:[1,0]
v_lshrrev_b32 v143, 18, v143
v_pk_add_f16 v150, v150, 1.0 op_sel_hi:[1,0]
v_pk_add_f16 v147, v147, 1.0 op_sel_hi:[1,0]
s_waitcnt lgkmcnt(6)
ds_read_b128 v[236:239], v249 offset:3072
ds_read_u16_d16 v142, v142
ds_read_u16_d16_hi v141, v141
ds_read_u16_d16_hi v143, v143
v_mfma_f32_32x32x16_bf16 v[120:135], v[224:227], v[112:115], v[120:135]
v_and_b32 v145, s49, v145
v_rcp_f16 v154, v153
v_bfe_u32 v144, v145, 2, 14
v_rcp_f16 v151, v150
v_lshrrev_b32 v145, 18, v145
v_rcp_f16 v148, v147
s_waitcnt lgkmcnt(6)
ds_read_b128 v[224:227], v249 offset:1024
ds_read_u16_d16 v144, v144
ds_read_u16_d16_hi v145, v145
v_mfma_f32_32x32x16_bf16 v[120:135], v[228:231], v[116:119], v[120:135]
v_or_b32 v176, v136, v137
v_permlane16_swap_b32 v171, v175
v_or_b32_e64 v177, v138, v139
v_rcp_f16_sdwa v154, v153 dst_sel:WORD_1 dst_unused:UNUSED_PRESERVE src0_sel:WORD_1
s_waitcnt lgkmcnt(4)
v_or_b32 v178, v140, v141
v_rcp_f16_sdwa v151, v150 dst_sel:WORD_1 dst_unused:UNUSED_PRESERVE src0_sel:WORD_1
s_waitcnt lgkmcnt(3)
v_or_b32 v179, v142, v143
v_rcp_f16_sdwa v148, v147 dst_sel:WORD_1 dst_unused:UNUSED_PRESERVE src0_sel:WORD_1
s_waitcnt lgkmcnt(0)
v_or_b32 v180, v144, v145
v_pk_mul_f16 v181, v155, v154
v_pk_mul_f16 v182, v152, v151
v_pk_mul_f16 v183, v149, v148
s_cmp_eq_u32 s77, 0
s_cbranch_scc1 Lpp2
s_getreg_b32 s43, hwreg(HW_REG_IB_STS, 0, 4)
s_cmp_lg_u32 s43, 0
s_cbranch_scc1 Lpp2
s_call_b64 s[78:79], Lpoll
s_setprio 0
Lpp2:
s_setprio 2
v_cvt_pkrtz_f16_f32 v137, v120, v121
v_cvt_pkrtz_f16_f32 v139, v122, v123
v_cvt_pkrtz_f16_f32 v141, v124, v125
v_cvt_pkrtz_f16_f32 v143, v126, v127
v_cvt_pkrtz_f16_f32 v145, v128, v129
v_cvt_pk_f16_f32 v155, v130, v131
v_cvt_pk_f16_f32 v152, v132, v133
v_cvt_pk_f16_f32 v149, v134, v135
ds_read_b128 v[228:231], v249 offset:4096
v_mfma_f32_32x32x16_bf16 v[120:135], v[232:235], v[96:99], 0
v_pk_fma_f16 v154, v155, v155, s48
v_permlane16_swap_b32 v176, v180
v_and_b32 v137, s49, v137
v_pk_fma_f16 v151, v152, v152, s48
v_and_b32_e64 v139, s49, v139
v_pk_fma_f16 v148, v149, v149, s48
v_pk_mul_f16 v154, v155, v154
v_bfe_u32 v136, v137, 2, 14
v_pk_mul_f16 v151, v152, v151
ds_read_b128 v[232:235], v249 offset:2048
ds_read_u16_d16 v136, v136
v_mfma_f32_32x32x16_bf16 v[120:135], v[236:239], v[100:103], v[120:135]
v_pk_mul_f16 v148, v149, v148
v_bfe_u32 v138, v139, 2, 14
v_exp_f16 v153, v154
v_lshrrev_b32 v137, 18, v137
v_exp_f16 v150, v151
v_permlane16_swap_b32 v177, v181
v_lshrrev_b32_e64 v139, 18, v139
ds_read_b128 v[236:239], v249 offset:5120
ds_read_u16_d16 v138, v138
ds_read_u16_d16_hi v137, v137
ds_read_u16_d16_hi v139, v139
v_mfma_f32_32x32x16_bf16 v[120:135], v[224:227], v[104:107], v[120:135]
v_exp_f16 v147, v148
v_and_b32 v141, s49, v141
v_and_b32 v143, s49, v143
v_exp_f16_sdwa v153, v154 dst_sel:WORD_1 dst_unused:UNUSED_PRESERVE src0_sel:WORD_1
v_bfe_u32 v140, v141, 2, 14
v_exp_f16_sdwa v150, v151 dst_sel:WORD_1 dst_unused:UNUSED_PRESERVE src0_sel:WORD_1
s_waitcnt lgkmcnt(6)
ds_read_b128 v[224:227], v249 offset:6144
ds_read_u16_d16 v140, v140
v_mfma_f32_32x32x16_bf16 v[120:135], v[228:231], v[108:111], v[120:135]
v_bfe_u32 v142, v143, 2, 14
v_exp_f16_sdwa v147, v148 dst_sel:WORD_1 dst_unused:UNUSED_PRESERVE src0_sel:WORD_1
v_lshrrev_b32 v141, 18, v141
v_permlane16_swap_b32 v178, v182
v_pk_add_f16 v153, v153, 1.0 op_sel_hi:[1,0]
v_lshrrev_b32 v143, 18, v143
v_pk_add_f16 v150, v150, 1.0 op_sel_hi:[1,0]
v_pk_add_f16 v147, v147, 1.0 op_sel_hi:[1,0]
s_waitcnt lgkmcnt(6)
ds_read_b128 v[228:231], v249 offset:9216
ds_read_u16_d16 v142, v142
ds_read_u16_d16_hi v141, v141
ds_read_u16_d16_hi v143, v143
v_mfma_f32_32x32x16_bf16 v[120:135], v[232:235], v[112:115], v[120:135]
v_and_b32 v145, s49, v145
v_rcp_f16 v154, v153
v_bfe_u32 v144, v145, 2, 14
v_rcp_f16 v151, v150
v_lshrrev_b32 v145, 18, v145
v_rcp_f16 v148, v147
s_waitcnt lgkmcnt(6)
ds_read_b128 v[232:235], v249 offset:7168
ds_read_u16_d16 v144, v144
ds_read_u16_d16_hi v145, v145
v_mfma_f32_32x32x16_bf16 v[120:135], v[236:239], v[116:119], v[120:135]
v_or_b32 v184, v136, v137
v_permlane16_swap_b32 v179, v183
v_or_b32_e64 v185, v138, v139
v_rcp_f16_sdwa v154, v153 dst_sel:WORD_1 dst_unused:UNUSED_PRESERVE src0_sel:WORD_1
s_waitcnt lgkmcnt(4)
v_or_b32 v186, v140, v141
v_rcp_f16_sdwa v151, v150 dst_sel:WORD_1 dst_unused:UNUSED_PRESERVE src0_sel:WORD_1
s_waitcnt lgkmcnt(3)
v_or_b32 v187, v142, v143
v_rcp_f16_sdwa v148, v147 dst_sel:WORD_1 dst_unused:UNUSED_PRESERVE src0_sel:WORD_1
s_waitcnt lgkmcnt(0)
v_or_b32_e64 v188, v144, v145
v_pk_mul_f16 v189, v155, v154
v_pk_mul_f16 v190, v152, v151
v_pk_mul_f16 v191, v149, v148
s_cmp_eq_u32 s77, 0
s_cbranch_scc1 Lpp3
s_getreg_b32 s43, hwreg(HW_REG_IB_STS, 0, 4)
s_cmp_lg_u32 s43, 0
s_cbranch_scc1 Lpp3
s_call_b64 s[78:79], Lpoll
s_setprio 2
Lpp3:
v_cvt_pkrtz_f16_f32 v137, v120, v121
v_cvt_pkrtz_f16_f32 v139, v122, v123
v_cvt_pkrtz_f16_f32 v141, v124, v125
v_cvt_pkrtz_f16_f32 v143, v126, v127
v_cvt_pkrtz_f16_f32 v145, v128, v129
v_cvt_pk_f16_f32 v155, v130, v131
v_cvt_pk_f16_f32 v152, v132, v133
v_cvt_pk_f16_f32 v149, v134, v135
ds_read_b128 v[236:239], v249 offset:10240
v_mfma_f32_32x32x16_bf16 v[120:135], v[224:227], v[96:99], 0
v_pk_fma_f16 v154, v155, v155, s48
v_permlane16_swap_b32 v184, v188
v_and_b32 v137, s49, v137
v_pk_fma_f16 v151, v152, v152, s48
v_and_b32_e64 v139, s49, v139
v_pk_fma_f16 v148, v149, v149, s48
v_pk_mul_f16 v154, v155, v154
v_bfe_u32 v136, v137, 2, 14
v_pk_mul_f16 v151, v152, v151
ds_read_b128 v[224:227], v249 offset:8192
ds_read_u16_d16 v136, v136
v_mfma_f32_32x32x16_bf16 v[120:135], v[228:231], v[100:103], v[120:135]
v_pk_mul_f16 v148, v149, v148
v_bfe_u32 v138, v139, 2, 14
v_exp_f16 v153, v154
v_lshrrev_b32 v137, 18, v137
v_exp_f16 v150, v151
s_setprio 1
v_permlane16_swap_b32 v185, v189
v_lshrrev_b32 v139, 18, v139
ds_read_b128 v[228:231], v249 offset:11264
ds_read_u16_d16 v138, v138
ds_read_u16_d16_hi v137, v137
ds_read_u16_d16_hi v139, v139
v_mfma_f32_32x32x16_bf16 v[120:135], v[232:235], v[104:107], v[120:135]
v_exp_f16 v147, v148
v_and_b32 v141, s49, v141
v_and_b32 v143, s49, v143
v_exp_f16_sdwa v153, v154 dst_sel:WORD_1 dst_unused:UNUSED_PRESERVE src0_sel:WORD_1
v_bfe_u32 v140, v141, 2, 14
v_exp_f16_sdwa v150, v151 dst_sel:WORD_1 dst_unused:UNUSED_PRESERVE src0_sel:WORD_1
s_waitcnt lgkmcnt(6)
ds_read_b128 v[232:235], v249 offset:12288
ds_read_u16_d16 v140, v140
v_mfma_f32_32x32x16_bf16 v[120:135], v[236:239], v[108:111], v[120:135]
v_bfe_u32 v142, v143, 2, 14
v_exp_f16_sdwa v147, v148 dst_sel:WORD_1 dst_unused:UNUSED_PRESERVE src0_sel:WORD_1
v_lshrrev_b32 v141, 18, v141
v_permlane16_swap_b32 v186, v190
v_pk_add_f16 v153, v153, 1.0 op_sel_hi:[1,0]
v_lshrrev_b32 v143, 18, v143
v_pk_add_f16 v150, v150, 1.0 op_sel_hi:[1,0]
v_pk_add_f16 v147, v147, 1.0 op_sel_hi:[1,0]
s_waitcnt lgkmcnt(6)
ds_read_b128 v[236:239], v249 offset:15360
ds_read_u16_d16 v142, v142
ds_read_u16_d16_hi v141, v141
ds_read_u16_d16_hi v143, v143
v_mfma_f32_32x32x16_bf16 v[120:135], v[224:227], v[112:115], v[120:135]
v_and_b32 v145, s49, v145
v_rcp_f16 v154, v153
v_bfe_u32 v144, v145, 2, 14
v_rcp_f16 v151, v150
v_lshrrev_b32 v145, 18, v145
v_rcp_f16 v148, v147
s_waitcnt lgkmcnt(6)
ds_read_b128 v[224:227], v249 offset:13312
ds_read_u16_d16 v144, v144
ds_read_u16_d16_hi v145, v145
v_mfma_f32_32x32x16_bf16 v[120:135], v[228:231], v[116:119], v[120:135]
v_or_b32 v192, v136, v137
v_permlane16_swap_b32 v187, v191
v_or_b32_e64 v193, v138, v139
v_rcp_f16_sdwa v154, v153 dst_sel:WORD_1 dst_unused:UNUSED_PRESERVE src0_sel:WORD_1
s_waitcnt lgkmcnt(4)
v_or_b32 v194, v140, v141
v_rcp_f16_sdwa v151, v150 dst_sel:WORD_1 dst_unused:UNUSED_PRESERVE src0_sel:WORD_1
s_waitcnt lgkmcnt(3)
v_or_b32 v195, v142, v143
v_rcp_f16_sdwa v148, v147 dst_sel:WORD_1 dst_unused:UNUSED_PRESERVE src0_sel:WORD_1
s_waitcnt lgkmcnt(0)
v_or_b32 v196, v144, v145
v_pk_mul_f16 v197, v155, v154
v_pk_mul_f16 v198, v152, v151
v_pk_mul_f16 v199, v149, v148
s_cmp_eq_u32 s77, 0
s_cbranch_scc1 Lpp4
s_getreg_b32 s43, hwreg(HW_REG_IB_STS, 0, 4)
s_cmp_lg_u32 s43, 0
s_cbranch_scc1 Lpp4
s_call_b64 s[78:79], Lpoll
s_setprio 1
Lpp4:
v_mov_b32 v253, 16256
Lw2w:
ds_read_b32 v254, v253 offset:4
s_waitcnt lgkmcnt(0)
v_readfirstlane_b32 s43, v254
s_cmp_eq_u32 s76, 0
s_cbranch_scc1 Lw2x
s_sub_u32 s76, s76, 1
s_cmp_lt_u32 s43, 1
s_cbranch_scc0 Lw2x
s_sleep 2
s_branch Lw2w
Lw2x:
s_add_u32 m0, s72, 7168
s_add_u32 s43, s82, 6208
buffer_load_dwordx4 v252, s[16:19], s43 offen lds
s_add_u32 m0, s72, 8192
s_add_u32 s43, s82, 6272
buffer_load_dwordx4 v252, s[16:19], s43 offen lds
v_cvt_pkrtz_f16_f32 v137, v120, v121
v_cvt_pkrtz_f16_f32 v139, v122, v123
v_cvt_pkrtz_f16_f32 v141, v124, v125
v_cvt_pkrtz_f16_f32 v143, v126, v127
v_cvt_pkrtz_f16_f32 v145, v128, v129
v_cvt_pk_f16_f32 v155, v130, v131
v_cvt_pk_f16_f32 v152, v132, v133
v_cvt_pk_f16_f32 v149, v134, v135
ds_read_b128 v[228:231], v249 offset:16384
v_mfma_f32_32x32x16_bf16 v[120:135], v[232:235], v[96:99], 0
v_pk_fma_f16 v154, v155, v155, s48
v_permlane16_swap_b32 v192, v196
v_and_b32 v137, s49, v137
v_pk_fma_f16 v151, v152, v152, s48
v_and_b32_e64 v139, s49, v139
v_pk_fma_f16 v148, v149, v149, s48
v_pk_mul_f16 v154, v155, v154
v_bfe_u32 v136, v137, 2, 14
v_pk_mul_f16 v151, v152, v151
ds_read_b128 v[232:235], v249 offset:14336
ds_read_u16_d16 v136, v136
v_mfma_f32_32x32x16_bf16 v[120:135], v[236:239], v[100:103], v[120:135]
v_pk_mul_f16 v148, v149, v148
v_bfe_u32 v138, v139, 2, 14
v_exp_f16 v153, v154
v_lshrrev_b32 v137, 18, v137
v_exp_f16 v150, v151
v_permlane16_swap_b32 v193, v197
v_lshrrev_b32_e64 v139, 18, v139
ds_read_b128 v[236:239], v249 offset:17408
ds_read_u16_d16 v138, v138
ds_read_u16_d16_hi v137, v137
ds_read_u16_d16_hi v139, v139
v_mfma_f32_32x32x16_bf16 v[120:135], v[224:227], v[104:107], v[120:135]
v_exp_f16 v147, v148
s_setprio 0
v_and_b32_e64 v141, s49, v141
v_and_b32 v143, s49, v143
v_exp_f16_sdwa v153, v154 dst_sel:WORD_1 dst_unused:UNUSED_PRESERVE src0_sel:WORD_1
v_bfe_u32 v140, v141, 2, 14
v_exp_f16_sdwa v150, v151 dst_sel:WORD_1 dst_unused:UNUSED_PRESERVE src0_sel:WORD_1
s_waitcnt lgkmcnt(6)
ds_read_b128 v[224:227], v249 offset:18432
ds_read_u16_d16 v140, v140
v_mfma_f32_32x32x16_bf16 v[120:135], v[228:231], v[108:111], v[120:135]
v_bfe_u32 v142, v143, 2, 14
v_exp_f16_sdwa v147, v148 dst_sel:WORD_1 dst_unused:UNUSED_PRESERVE src0_sel:WORD_1
v_lshrrev_b32 v141, 18, v141
v_permlane16_swap_b32 v194, v198
v_pk_add_f16 v153, v153, 1.0 op_sel_hi:[1,0]
v_lshrrev_b32 v143, 18, v143
v_pk_add_f16 v150, v150, 1.0 op_sel_hi:[1,0]
v_pk_add_f16 v147, v147, 1.0 op_sel_hi:[1,0]
s_waitcnt lgkmcnt(6)
ds_read_b128 v[228:231], v249 offset:21504
ds_read_u16_d16 v142, v142
ds_read_u16_d16_hi v141, v141
ds_read_u16_d16_hi v143, v143
v_mfma_f32_32x32x16_bf16 v[120:135], v[232:235], v[112:115], v[120:135]
v_and_b32 v145, s49, v145
v_rcp_f16 v154, v153
v_bfe_u32 v144, v145, 2, 14
v_rcp_f16 v151, v150
v_lshrrev_b32 v145, 18, v145
v_rcp_f16 v148, v147
s_waitcnt lgkmcnt(6)
ds_read_b128 v[232:235], v249 offset:19456
ds_read_u16_d16 v144, v144
ds_read_u16_d16_hi v145, v145
v_mfma_f32_32x32x16_bf16 v[120:135], v[236:239], v[116:119], v[120:135]
v_or_b32 v200, v136, v137
v_permlane16_swap_b32 v195, v199
v_or_b32_e64 v201, v138, v139
v_rcp_f16_sdwa v154, v153 dst_sel:WORD_1 dst_unused:UNUSED_PRESERVE src0_sel:WORD_1
s_waitcnt lgkmcnt(4)
v_or_b32 v202, v140, v141
v_rcp_f16_sdwa v151, v150 dst_sel:WORD_1 dst_unused:UNUSED_PRESERVE src0_sel:WORD_1
s_waitcnt lgkmcnt(3)
v_or_b32 v203, v142, v143
v_rcp_f16_sdwa v148, v147 dst_sel:WORD_1 dst_unused:UNUSED_PRESERVE src0_sel:WORD_1
s_waitcnt lgkmcnt(0)
v_or_b32 v204, v144, v145
v_pk_mul_f16 v205, v155, v154
v_pk_mul_f16 v206, v152, v151
v_pk_mul_f16 v207, v149, v148
s_cmp_eq_u32 s77, 0
s_cbranch_scc1 Lpp5
s_getreg_b32 s43, hwreg(HW_REG_IB_STS, 0, 4)
s_cmp_lg_u32 s43, 0
s_cbranch_scc1 Lpp5
s_call_b64 s[78:79], Lpoll
s_setprio 0
Lpp5:
s_setprio 2
v_cvt_pkrtz_f16_f32 v137, v120, v121
v_cvt_pkrtz_f16_f32 v139, v122, v123
v_cvt_pkrtz_f16_f32 v141, v124, v125
v_cvt_pkrtz_f16_f32 v143, v126, v127
v_cvt_pkrtz_f16_f32 v145, v128, v129
v_cvt_pk_f16_f32 v155, v130, v131
v_cvt_pk_f16_f32 v152, v132, v133
v_cvt_pk_f16_f32 v149, v134, v135
ds_read_b128 v[236:239], v249 offset:22528
v_mfma_f32_32x32x16_bf16 v[120:135], v[224:227], v[96:99], 0
v_pk_fma_f16 v154, v155, v155, s48
v_permlane16_swap_b32 v200, v204
v_and_b32 v137, s49, v137
v_pk_fma_f16 v151, v152, v152, s48
v_and_b32_e64 v139, s49, v139
v_pk_fma_f16 v148, v149, v149, s48
v_pk_mul_f16 v154, v155, v154
v_bfe_u32 v136, v137, 2, 14
v_pk_mul_f16 v151, v152, v151
ds_read_b128 v[224:227], v249 offset:20480
ds_read_u16_d16 v136, v136
v_mfma_f32_32x32x16_bf16 v[120:135], v[228:231], v[100:103], v[120:135]
v_pk_mul_f16 v148, v149, v148
v_bfe_u32 v138, v139, 2, 14
v_exp_f16 v153, v154
v_lshrrev_b32 v137, 18, v137
v_exp_f16 v150, v151
v_permlane16_swap_b32 v201, v205
v_lshrrev_b32_e64 v139, 18, v139
ds_read_b128 v[228:231], v249 offset:23552
ds_read_u16_d16 v138, v138
ds_read_u16_d16_hi v137, v137
ds_read_u16_d16_hi v139, v139
v_mfma_f32_32x32x16_bf16 v[120:135], v[232:235], v[104:107], v[120:135]
v_exp_f16 v147, v148
v_and_b32 v141, s49, v141
v_and_b32 v143, s49, v143
v_exp_f16_sdwa v153, v154 dst_sel:WORD_1 dst_unused:UNUSED_PRESERVE src0_sel:WORD_1
v_bfe_u32 v140, v141, 2, 14
v_exp_f16_sdwa v150, v151 dst_sel:WORD_1 dst_unused:UNUSED_PRESERVE src0_sel:WORD_1
s_waitcnt lgkmcnt(6)
ds_read_u16_d16 v140, v140
v_mfma_f32_32x32x16_bf16 v[120:135], v[236:239], v[108:111], v[120:135]
v_bfe_u32 v142, v143, 2, 14
v_exp_f16_sdwa v147, v148 dst_sel:WORD_1 dst_unused:UNUSED_PRESERVE src0_sel:WORD_1
v_lshrrev_b32 v141, 18, v141
v_permlane16_swap_b32 v202, v206
v_pk_add_f16 v153, v153, 1.0 op_sel_hi:[1,0]
v_lshrrev_b32 v143, 18, v143
v_pk_add_f16 v150, v150, 1.0 op_sel_hi:[1,0]
v_pk_add_f16 v147, v147, 1.0 op_sel_hi:[1,0]
s_waitcnt lgkmcnt(5)
ds_read_u16_d16 v142, v142
ds_read_u16_d16_hi v141, v141
ds_read_u16_d16_hi v143, v143
v_mfma_f32_32x32x16_bf16 v[120:135], v[224:227], v[112:115], v[120:135]
v_and_b32 v145, s49, v145
v_rcp_f16 v154, v153
v_bfe_u32 v144, v145, 2, 14
v_rcp_f16 v151, v150
v_lshrrev_b32 v145, 18, v145
v_rcp_f16 v148, v147
s_waitcnt lgkmcnt(4)
ds_read_u16_d16 v144, v144
ds_read_u16_d16_hi v145, v145
v_mfma_f32_32x32x16_bf16 v[120:135], v[228:231], v[116:119], v[120:135]
v_or_b32 v208, v136, v137
v_permlane16_swap_b32 v203, v207
v_or_b32_e64 v209, v138, v139
v_rcp_f16_sdwa v154, v153 dst_sel:WORD_1 dst_unused:UNUSED_PRESERVE src0_sel:WORD_1
s_waitcnt lgkmcnt(3)
v_or_b32 v210, v140, v141
v_rcp_f16_sdwa v151, v150 dst_sel:WORD_1 dst_unused:UNUSED_PRESERVE src0_sel:WORD_1
s_waitcnt lgkmcnt(2)
v_or_b32 v211, v142, v143
v_rcp_f16_sdwa v148, v147 dst_sel:WORD_1 dst_unused:UNUSED_PRESERVE src0_sel:WORD_1
s_waitcnt lgkmcnt(0)
v_or_b32_e64 v212, v144, v145
v_pk_mul_f16 v213, v155, v154
v_pk_mul_f16 v214, v152, v151
v_pk_mul_f16 v215, v149, v148
s_cmp_eq_u32 s77, 0
s_cbranch_scc1 Lpp6
s_getreg_b32 s43, hwreg(HW_REG_IB_STS, 0, 4)
s_cmp_lg_u32 s43, 0
s_cbranch_scc1 Lpp6
s_call_b64 s[78:79], Lpoll
s_setprio 2
Lpp6:
v_cvt_pkrtz_f16_f32 v137, v120, v121
v_cvt_pkrtz_f16_f32 v139, v122, v123
v_cvt_pkrtz_f16_f32 v141, v124, v125
v_cvt_pkrtz_f16_f32 v143, v126, v127
v_cvt_pkrtz_f16_f32 v145, v128, v129
v_cvt_pk_f16_f32 v155, v130, v131
v_cvt_pk_f16_f32 v152, v132, v133
v_cvt_pk_f16_f32 v149, v134, v135
v_pk_fma_f16 v154, v155, v155, s48
v_permlane16_swap_b32 v96, v100
v_permlane16_swap_b32 v208, v212
v_and_b32_e64 v137, s49, v137
v_pk_fma_f16 v151, v152, v152, s48
v_and_b32 v139, s49, v139
v_pk_fma_f16 v148, v149, v149, s48
v_permlane16_swap_b32 v97, v101
v_pk_mul_f16 v154, v155, v154
v_bfe_u32 v136, v137, 2, 14
v_pk_mul_f16 v151, v152, v151
v_pk_mul_f16 v148, v149, v148
v_bfe_u32 v138, v139, 2, 14
v_permlane16_swap_b32 v98, v102
v_exp_f16 v153, v154
v_lshrrev_b32 v137, 18, v137
v_exp_f16 v150, v151
v_permlane16_swap_b32 v99, v103
s_setprio 1
v_permlane16_swap_b32 v209, v213
v_lshrrev_b32 v139, 18, v139
v_exp_f16 v147, v148
v_and_b32 v141, s49, v141
v_permlane16_swap_b32 v104, v108
v_and_b32 v143, s49, v143
ds_read_u16_d16 v136, v136
ds_read_u16_d16 v138, v138
ds_read_u16_d16_hi v137, v137
ds_read_u16_d16_hi v139, v139
v_exp_f16_sdwa v153, v154 dst_sel:WORD_1 dst_unused:UNUSED_PRESERVE src0_sel:WORD_1
v_bfe_u32 v140, v141, 2, 14
v_exp_f16_sdwa v150, v151 dst_sel:WORD_1 dst_unused:UNUSED_PRESERVE src0_sel:WORD_1
v_permlane16_swap_b32 v105, v109
v_bfe_u32 v142, v143, 2, 14
v_exp_f16_sdwa v147, v148 dst_sel:WORD_1 dst_unused:UNUSED_PRESERVE src0_sel:WORD_1
v_lshrrev_b32 v141, 18, v141
v_permlane16_swap_b32 v106, v110
v_permlane16_swap_b32 v210, v214
v_pk_add_f16 v153, v153, 1.0 op_sel_hi:[1,0]
v_lshrrev_b32_e64 v143, 18, v143
v_pk_add_f16 v150, v150, 1.0 op_sel_hi:[1,0]
v_pk_add_f16 v147, v147, 1.0 op_sel_hi:[1,0]
v_permlane16_swap_b32 v107, v111
v_and_b32 v145, s49, v145
v_rcp_f16_e64 v154, v153
v_bfe_u32 v144, v145, 2, 14
v_rcp_f16 v151, v150
v_permlane16_swap_b32 v112, v116
v_lshrrev_b32_e64 v145, 18, v145
ds_read_u16_d16 v140, v140
ds_read_u16_d16 v142, v142
ds_read_u16_d16_hi v141, v141
ds_read_u16_d16_hi v143, v143
ds_read_u16_d16 v144, v144
ds_read_u16_d16_hi v145, v145
v_rcp_f16 v148, v147
s_waitcnt lgkmcnt(6)
v_or_b32 v216, v136, v137
v_permlane16_swap_b32 v113, v117
v_permlane16_swap_b32 v211, v215
v_or_b32 v217, v138, v139
v_rcp_f16_sdwa v154, v153 dst_sel:WORD_1 dst_unused:UNUSED_PRESERVE src0_sel:WORD_1
s_waitcnt lgkmcnt(3)
v_or_b32 v218, v140, v141
v_permlane16_swap_b32 v114, v118
v_rcp_f16_sdwa v151, v150 dst_sel:WORD_1 dst_unused:UNUSED_PRESERVE src0_sel:WORD_1
s_waitcnt lgkmcnt(2)
v_or_b32_e64 v219, v142, v143
v_rcp_f16_sdwa v148, v147 dst_sel:WORD_1 dst_unused:UNUSED_PRESERVE src0_sel:WORD_1
v_permlane16_swap_b32 v115, v119
s_waitcnt lgkmcnt(0)
v_or_b32_e64 v220, v144, v145
v_pk_mul_f16 v221, v155, v154
v_pk_mul_f16 v222, v152, v151
v_pk_mul_f16 v223, v149, v148
s_cmp_eq_u32 s77, 0
s_cbranch_scc1 Lpp7
s_getreg_b32 s43, hwreg(HW_REG_IB_STS, 0, 4)
s_cmp_lg_u32 s43, 0
s_cbranch_scc1 Lpp7
s_call_b64 s[78:79], Lpoll
s_setprio 1
Lpp7:
v_permlane16_swap_b32 v216, v220
v_permlane16_swap_b32 v217, v221
s_setprio 0
v_permlane16_swap_b32 v218, v222
v_permlane16_swap_b32 v219, v223
s_cmp_eq_u32 s77, 0
s_cbranch_scc1 Lpp8
s_getreg_b32 s43, hwreg(HW_REG_IB_STS, 0, 4)
s_cmp_lg_u32 s43, 0
s_cbranch_scc1 Lpp8
s_call_b64 s[78:79], Lpoll
s_setprio 0
Lpp8:
s_setprio 2
v_lshrrev_b32_e64 v225, 5, v251
v_lshl_add_u32 v224, v225, 9, s72
v_lshl_add_u32 v226, v225, 4, s72
v_and_b32 v225, 15, v251
v_lshl_add_u32 v224, v225, 4, v224
v_bfe_u32 v225, v251, 4, 1
v_lshl_add_u32 v224, v225, 3, v224
s_waitcnt vmcnt(0)
ds_read_b64_tr_b16 v[120:121], v224
ds_read_b64_tr_b16 v[122:123], v224 offset:256
ds_read_b64_tr_b16 v[124:125], v224 offset:1024
ds_read_b64_tr_b16 v[126:127], v224 offset:1280
ds_read_b64_tr_b16 v[128:129], v224 offset:2048
ds_read_b64_tr_b16 v[130:131], v224 offset:2304
ds_read_b64_tr_b16 v[132:133], v224 offset:3072
ds_read_b64_tr_b16 v[134:135], v224 offset:3328
ds_read_b64_tr_b16 v[136:137], v224 offset:4096
ds_read_b64_tr_b16 v[138:139], v224 offset:4352
ds_read_b64_tr_b16 v[140:141], v224 offset:5120
ds_read_b64_tr_b16 v[142:143], v224 offset:5376
ds_read_b64_tr_b16 v[144:145], v224 offset:6144
ds_read_b64_tr_b16 v[146:147], v224 offset:6400
ds_read_b64_tr_b16 v[148:149], v224 offset:7168
ds_read_b64_tr_b16 v[150:151], v224 offset:7424
ds_read_b64_tr_b16 v[152:153], v224 offset:8192
ds_read_b64_tr_b16 v[154:155], v224 offset:8448
v_lshrrev_b32 v225, 4, v251
v_and_b32 v227, 15, v251
v_mul_u32_u24 v252, 192, v227
v_lshl_add_u32 v252, v225, 4, v252
v_lshlrev_b32 v254, 5, v225
v_and_b32 v253, 47, v251
v_lshlrev_b32 v253, 4, v253
v_and_b32 v225, 1, v225
v_mul_u32_u24 v227, 3072, v225
v_add_u32_e64 v248, v227, v253
v_add_u32 v249, 65536, v248
v_add_u32 v250, 131072, v248
v_lshl_add_u32 v253, v225, 21, v253
v_mov_b32 v225, 16256
v_mov_b32_e64 v227, 1
s_waitcnt lgkmcnt(0)
s_mov_b64 exec, 1
ds_add_u32 v225, v227 offset:8
s_mov_b64 exec, -1
v_lshlrev_b32 v228, 16, v120
v_and_b32 v229, 4294901760, v120
v_cvt_pk_f16_f32 v120, v228, v229
v_lshlrev_b32_e64 v230, 16, v121
v_and_b32 v231, 4294901760, v121
v_cvt_pk_f16_f32 v121, v230, v231
v_lshlrev_b32_e64 v228, 16, v122
v_and_b32 v229, 4294901760, v122
v_cvt_pk_f16_f32 v122, v228, v229
v_lshlrev_b32_e64 v230, 16, v123
v_and_b32 v231, 4294901760, v123
v_cvt_pk_f16_f32 v123, v230, v231
v_lshlrev_b32_e64 v228, 16, v124
v_and_b32 v229, 4294901760, v124
v_cvt_pk_f16_f32 v124, v228, v229
v_lshlrev_b32_e64 v230, 16, v125
v_and_b32 v231, 4294901760, v125
v_cvt_pk_f16_f32 v125, v230, v231
v_lshlrev_b32_e64 v228, 16, v126
v_and_b32 v229, 4294901760, v126
v_cvt_pk_f16_f32 v126, v228, v229
v_lshlrev_b32_e64 v230, 16, v127
v_and_b32 v231, 4294901760, v127
v_cvt_pk_f16_f32 v127, v230, v231
v_lshlrev_b32_e64 v228, 16, v128
v_and_b32 v229, 4294901760, v128
v_cvt_pk_f16_f32 v128, v228, v229
v_lshlrev_b32_e64 v230, 16, v129
v_and_b32 v231, 4294901760, v129
v_cvt_pk_f16_f32 v129, v230, v231
v_lshlrev_b32_e64 v228, 16, v130
v_and_b32 v229, 4294901760, v130
v_cvt_pk_f16_f32 v130, v228, v229
v_lshlrev_b32_e64 v230, 16, v131
v_and_b32 v231, 4294901760, v131
v_cvt_pk_f16_f32 v131, v230, v231
s_cmp_eq_u32 s77, 0
s_cbranch_scc1 Lpp911
s_getreg_b32 s43, hwreg(HW_REG_IB_STS, 0, 4)
s_cmp_lg_u32 s43, 0
s_cbranch_scc1 Lpp911
s_call_b64 s[78:79], Lpoll
s_setprio 2
Lpp911:
v_lshlrev_b32 v228, 16, v132
v_and_b32 v229, 4294901760, v132
v_cvt_pk_f16_f32 v132, v228, v229
v_lshlrev_b32_e64 v230, 16, v133
v_and_b32 v231, 4294901760, v133
v_cvt_pk_f16_f32 v133, v230, v231
v_lshlrev_b32_e64 v228, 16, v134
v_and_b32 v229, 4294901760, v134
v_cvt_pk_f16_f32 v134, v228, v229
v_lshlrev_b32_e64 v230, 16, v135
v_and_b32 v231, 4294901760, v135
v_cvt_pk_f16_f32 v135, v230, v231
v_lshlrev_b32_e64 v228, 16, v136
v_and_b32 v229, 4294901760, v136
v_cvt_pk_f16_f32 v136, v228, v229
v_lshlrev_b32_e64 v230, 16, v137
v_and_b32 v231, 4294901760, v137
v_cvt_pk_f16_f32 v137, v230, v231
v_lshlrev_b32_e64 v228, 16, v138
v_and_b32 v229, 4294901760, v138
v_cvt_pk_f16_f32 v138, v228, v229
v_lshlrev_b32_e64 v230, 16, v139
v_and_b32 v231, 4294901760, v139
v_cvt_pk_f16_f32 v139, v230, v231
v_lshlrev_b32_e64 v228, 16, v140
v_and_b32 v229, 4294901760, v140
v_cvt_pk_f16_f32 v140, v228, v229
v_lshlrev_b32_e64 v230, 16, v141
v_and_b32 v231, 4294901760, v141
v_cvt_pk_f16_f32 v141, v230, v231
v_lshlrev_b32_e64 v228, 16, v142
v_and_b32 v229, 4294901760, v142
v_cvt_pk_f16_f32 v142, v228, v229
v_lshlrev_b32_e64 v230, 16, v143
v_and_b32 v231, 4294901760, v143
v_cvt_pk_f16_f32 v143, v230, v231
s_cmp_eq_u32 s77, 0
s_cbranch_scc1 Lpp923
s_getreg_b32 s43, hwreg(HW_REG_IB_STS, 0, 4)
s_cmp_lg_u32 s43, 0
s_cbranch_scc1 Lpp923
s_call_b64 s[78:79], Lpoll
s_setprio 2
Lpp923:
v_lshlrev_b32 v228, 16, v144
v_and_b32 v229, 4294901760, v144
v_cvt_pk_f16_f32 v144, v228, v229
v_lshlrev_b32_e64 v230, 16, v145
v_and_b32 v231, 4294901760, v145
v_cvt_pk_f16_f32 v145, v230, v231
v_lshlrev_b32_e64 v228, 16, v146
v_and_b32 v229, 4294901760, v146
v_cvt_pk_f16_f32 v146, v228, v229
v_lshlrev_b32_e64 v230, 16, v147
v_and_b32 v231, 4294901760, v147
v_cvt_pk_f16_f32 v147, v230, v231
v_lshlrev_b32_e64 v228, 16, v148
v_and_b32 v229, 4294901760, v148
v_cvt_pk_f16_f32 v148, v228, v229
v_lshlrev_b32_e64 v230, 16, v149
v_and_b32 v231, 4294901760, v149
v_cvt_pk_f16_f32 v149, v230, v231
v_lshlrev_b32_e64 v228, 16, v150
v_and_b32 v229, 4294901760, v150
v_cvt_pk_f16_f32 v150, v228, v229
v_lshlrev_b32_e64 v230, 16, v151
v_and_b32 v231, 4294901760, v151
v_cvt_pk_f16_f32 v151, v230, v231
v_lshlrev_b32_e64 v228, 16, v152
v_and_b32 v229, 4294901760, v152
v_cvt_pk_f16_f32 v152, v228, v229
v_lshlrev_b32_e64 v230, 16, v153
v_and_b32 v231, 4294901760, v153
v_cvt_pk_f16_f32 v153, v230, v231
v_lshlrev_b32_e64 v228, 16, v154
v_and_b32 v229, 4294901760, v154
v_cvt_pk_f16_f32 v154, v228, v229
v_lshlrev_b32_e64 v230, 16, v155
v_and_b32 v231, 4294901760, v155
v_cvt_pk_f16_f32 v155, v230, v231
s_cmp_eq_u32 s77, 0
s_cbranch_scc1 Lpp935
s_getreg_b32 s43, hwreg(HW_REG_IB_STS, 0, 4)
s_cmp_lg_u32 s43, 0
s_cbranch_scc1 Lpp935
s_call_b64 s[78:79], Lpoll
s_setprio 2
Lpp935:
v_lshl_add_u32 v224, v251, 4, s72
s_cmp_lg_u32 s40, 0
s_cbranch_scc1 Lnofin
Lspin:
s_cmp_eq_u32 s77, 0
s_cbranch_scc1 Lspinx
s_cmp_eq_u32 s76, 0
s_cbranch_scc1 Lspinx
s_sub_u32 s76, s76, 1
s_call_b64 s[78:79], Lpoll
s_branch Lspin
Lspinx:
v_add_u32_e64 v162, 0, v251
v_mul_u32_u24 v165, 2731, v162
v_lshrrev_b32_e64 v165, 16, v165
v_mul_u32_u24 v165, 9120, v165
v_lshl_add_u32 v162, v162, 2, v165
v_add_u32 v162, 90112, v162
v_add_u32_e64 v163, 64, v251
v_mul_u32_u24 v165, 2731, v163
v_lshrrev_b32_e64 v165, 16, v165
v_mul_u32_u24 v165, 9120, v165
v_lshl_add_u32 v163, v163, 2, v165
v_add_u32 v163, 90112, v163
v_add_u32 v164, 128, v251
v_mul_u32_u24 v165, 2731, v164
v_lshrrev_b32_e64 v165, 16, v165
v_mul_u32_u24 v165, 9120, v165
v_lshl_add_u32 v164, v164, 2, v165
v_add_u32 v164, 90112, v164
v_mov_b32 v165, 16256
Lrrw:
ds_read_b32 v166, v165 offset:8
s_waitcnt lgkmcnt(0)
v_readfirstlane_b32 s43, v166
s_cmp_eq_u32 s76, 0
s_cbranch_scc1 Lrrx
s_sub_u32 s76, s76, 1
s_cmp_lt_u32 s43, 8
s_cbranch_scc0 Lrrx
s_sleep 2
s_branch Lrrw
Lrrx:
ds_write_b32 v162, v244
ds_write_b32 v163, v245
ds_write_b32 v164, v246
Lnofin:
s_waitcnt lgkmcnt(0)
s_barrier
ds_read_b128 v[228:231], v226
ds_read_b128 v[232:235], v226 offset:32
ds_read_b128 v[236:239], v226 offset:64
buffer_load_dwordx4 v[240:243], v252, s[4:7], s71 offen
buffer_load_dwordx4 v[244:247], v252, s[4:7], s71 offen offset:64
s_waitcnt lgkmcnt(0)
v_pk_mul_f16 v120, v120, v228
v_pk_mul_f16 v121, v121, v229
v_pk_mul_f16 v122, v122, v230
v_pk_mul_f16 v123, v123, v231
ds_write_b128 v224, v[120:123]
v_pk_mul_f16 v124, v124, v228
v_pk_mul_f16 v125, v125, v229
v_pk_mul_f16 v126, v126, v230
v_pk_mul_f16 v127, v127, v231
ds_write_b128 v224, v[124:127] offset:1024
v_pk_mul_f16 v128, v128, v228
v_pk_mul_f16 v129, v129, v229
v_pk_mul_f16 v130, v130, v230
v_pk_mul_f16 v131, v131, v231
ds_write_b128 v224, v[128:131] offset:2048
v_pk_mul_f16 v132, v132, v232
v_pk_mul_f16 v133, v133, v233
v_pk_mul_f16 v134, v134, v234
v_pk_mul_f16 v135, v135, v235
ds_write_b128 v224, v[132:135] offset:3072
v_pk_mul_f16 v136, v136, v232
v_pk_mul_f16 v137, v137, v233
v_pk_mul_f16 v138, v138, v234
v_pk_mul_f16 v139, v139, v235
ds_write_b128 v224, v[136:139] offset:4096
v_pk_mul_f16 v140, v140, v232
v_pk_mul_f16 v141, v141, v233
v_pk_mul_f16 v142, v142, v234
v_pk_mul_f16 v143, v143, v235
ds_write_b128 v224, v[140:143] offset:5120
v_pk_mul_f16 v144, v144, v236
v_pk_mul_f16 v145, v145, v237
v_pk_mul_f16 v146, v146, v238
v_pk_mul_f16 v147, v147, v239
ds_write_b128 v224, v[144:147] offset:6144
v_pk_mul_f16 v148, v148, v236
v_pk_mul_f16 v149, v149, v237
v_pk_mul_f16 v150, v150, v238
v_pk_mul_f16 v151, v151, v239
ds_write_b128 v224, v[148:151] offset:7168
v_pk_mul_f16 v152, v152, v236
v_pk_mul_f16 v153, v153, v237
v_pk_mul_f16 v154, v154, v238
v_pk_mul_f16 v155, v155, v239
ds_write_b128 v224, v[152:155] offset:8192
s_waitcnt lgkmcnt(0)
s_barrier
s_setprio 3
ds_read_b128 v[224:227], v249 offset:24576
ds_read_b128 v[228:231], v254 offset:7936
ds_read_b128 v[232:235], v249 offset:24832
ds_read_b128 v[236:239], v254 offset:7952
s_waitcnt lgkmcnt(2)
v_mfma_f32_16x16x32_f16 v[120:123], v[224:227], v[0:3], v[228:231]
v_mfma_f32_16x16x32_f16 v[128:131], v[224:227], v[4:7], v[228:231]
s_waitcnt lgkmcnt(0)
v_mfma_f32_16x16x32_f16 v[124:127], v[232:235], v[0:3], v[236:239]
ds_read_b128 v[224:227], v249 offset:25600
ds_read_b128 v[228:231], v254 offset:8064
v_mfma_f32_16x16x32_f16 v[132:135], v[232:235], v[4:7], v[236:239]
s_waitcnt lgkmcnt(0)
v_mfma_f32_16x16x32_f16 v[136:139], v[224:227], v[0:3], v[228:231]
ds_read_b128 v[232:235], v249 offset:25856
ds_read_b128 v[236:239], v254 offset:8080
v_mfma_f32_16x16x32_f16 v[144:147], v[224:227], v[4:7], v[228:231]
s_waitcnt lgkmcnt(0)
v_mfma_f32_16x16x32_f16 v[140:143], v[232:235], v[0:3], v[236:239]
ds_read_b128 v[224:227], v249 offset:26624
ds_read_b128 v[228:231], v254 offset:16128
v_mfma_f32_16x16x32_f16 v[148:151], v[232:235], v[4:7], v[236:239]
s_waitcnt lgkmcnt(0)
v_mfma_f32_16x16x32_f16 v[152:155], v[224:227], v[0:3], v[228:231]
ds_read_b128 v[232:235], v249 offset:26880
ds_read_b128 v[236:239], v254 offset:16144
v_mfma_f32_16x16x32_f16 v[160:163], v[224:227], v[4:7], v[228:231]
s_waitcnt lgkmcnt(0)
v_mfma_f32_16x16x32_f16 v[156:159], v[232:235], v[0:3], v[236:239]
ds_read_b128 v[224:227], v249 offset:30720
ds_read_b128 v[228:231], v249 offset:30976
v_mfma_f32_16x16x32_f16 v[164:167], v[232:235], v[4:7], v[236:239]
s_waitcnt lgkmcnt(1)
v_mfma_f32_16x16x32_f16 v[120:123], v[224:227], v[8:11], v[120:123]
ds_read_b128 v[232:235], v249 offset:31744
ds_read_b128 v[236:239], v249 offset:32000
v_mfma_f32_16x16x32_f16 v[128:131], v[224:227], v[12:15], v[128:131]
s_waitcnt lgkmcnt(2)
v_mfma_f32_16x16x32_f16 v[124:127], v[228:231], v[8:11], v[124:127]
ds_read_b128 v[224:227], v249 offset:32768
v_mfma_f32_16x16x32_f16 v[132:135], v[228:231], v[12:15], v[132:135]
s_waitcnt lgkmcnt(2)
v_mfma_f32_16x16x32_f16 v[136:139], v[232:235], v[8:11], v[136:139]
ds_read_b128 v[228:231], v249 offset:33024
v_mfma_f32_16x16x32_f16 v[144:147], v[232:235], v[12:15], v[144:147]
s_waitcnt lgkmcnt(2)
v_mfma_f32_16x16x32_f16 v[140:143], v[236:239], v[8:11], v[140:143]
ds_read_b128 v[232:235], v249 offset:36864
v_mfma_f32_16x16x32_f16 v[148:151], v[236:239], v[12:15], v[148:151]
s_waitcnt lgkmcnt(2)
v_mfma_f32_16x16x32_f16 v[152:155], v[224:227], v[8:11], v[152:155]
ds_read_b128 v[236:239], v249 offset:37120
v_mfma_f32_16x16x32_f16 v[160:163], v[224:227], v[12:15], v[160:163]
s_waitcnt lgkmcnt(2)
v_mfma_f32_16x16x32_f16 v[156:159], v[228:231], v[8:11], v[156:159]
ds_read_b128 v[224:227], v249 offset:37888
v_mfma_f32_16x16x32_f16 v[164:167], v[228:231], v[12:15], v[164:167]
s_waitcnt lgkmcnt(2)
v_mfma_f32_16x16x32_f16 v[120:123], v[232:235], v[16:19], v[120:123]
buffer_load_dwordx4 v[12:15], v252, s[4:7], s71 offen offset:128
ds_read_b128 v[228:231], v249 offset:38144
v_mfma_f32_16x16x32_f16 v[128:131], v[232:235], v[20:23], v[128:131]
s_waitcnt lgkmcnt(2)
v_mfma_f32_16x16x32_f16 v[124:127], v[236:239], v[16:19], v[124:127]
ds_read_b128 v[232:235], v249 offset:38912
v_mfma_f32_16x16x32_f16 v[132:135], v[236:239], v[20:23], v[132:135]
s_waitcnt lgkmcnt(2)
v_mfma_f32_16x16x32_f16 v[136:139], v[224:227], v[16:19], v[136:139]
ds_read_b128 v[236:239], v249 offset:39168
v_mfma_f32_16x16x32_f16 v[144:147], v[224:227], v[20:23], v[144:147]
s_waitcnt lgkmcnt(2)
v_mfma_f32_16x16x32_f16 v[140:143], v[228:231], v[16:19], v[140:143]
s_add_u32 s46, s71, 98304
buffer_load_dwordx4 v[8:11], v252, s[4:7], s46 offen
ds_read_b128 v[224:227], v249 offset:43008
v_mfma_f32_16x16x32_f16 v[148:151], v[228:231], v[20:23], v[148:151]
s_waitcnt lgkmcnt(2)
v_mfma_f32_16x16x32_f16 v[152:155], v[232:235], v[16:19], v[152:155]
ds_read_b128 v[228:231], v249 offset:43264
v_mfma_f32_16x16x32_f16 v[160:163], v[232:235], v[20:23], v[160:163]
s_waitcnt lgkmcnt(2)
v_mfma_f32_16x16x32_f16 v[156:159], v[236:239], v[16:19], v[156:159]
ds_read_b128 v[232:235], v249 offset:44032
v_mfma_f32_16x16x32_f16 v[164:167], v[236:239], v[20:23], v[164:167]
s_waitcnt lgkmcnt(2)
v_mfma_f32_16x16x32_f16 v[120:123], v[224:227], v[24:27], v[120:123]
s_add_u32 s46, s71, 98304
buffer_load_dwordx4 v[4:7], v252, s[4:7], s46 offen offset:64
ds_read_b128 v[236:239], v249 offset:44288
v_mfma_f32_16x16x32_f16 v[128:131], v[224:227], v[28:31], v[128:131]
s_waitcnt lgkmcnt(2)
v_mfma_f32_16x16x32_f16 v[124:127], v[228:231], v[24:27], v[124:127]
ds_read_b128 v[224:227], v249 offset:45056
v_mfma_f32_16x16x32_f16 v[132:135], v[228:231], v[28:31], v[132:135]
s_waitcnt lgkmcnt(2)
v_mfma_f32_16x16x32_f16 v[136:139], v[232:235], v[24:27], v[136:139]
ds_read_b128 v[228:231], v249 offset:45312
v_mfma_f32_16x16x32_f16 v[144:147], v[232:235], v[28:31], v[144:147]
s_waitcnt lgkmcnt(2)
v_mfma_f32_16x16x32_f16 v[140:143], v[236:239], v[24:27], v[140:143]
s_add_u32 s46, s71, 98304
buffer_load_dwordx4 v[0:3], v252, s[4:7], s46 offen offset:128
ds_read_b128 v[232:235], v249 offset:49152
v_mfma_f32_16x16x32_f16 v[148:151], v[236:239], v[28:31], v[148:151]
s_waitcnt lgkmcnt(2)
v_mfma_f32_16x16x32_f16 v[152:155], v[224:227], v[24:27], v[152:155]
ds_read_b128 v[236:239], v249 offset:49408
v_mfma_f32_16x16x32_f16 v[160:163], v[224:227], v[28:31], v[160:163]
s_waitcnt lgkmcnt(2)
v_mfma_f32_16x16x32_f16 v[156:159], v[228:231], v[24:27], v[156:159]
ds_read_b128 v[224:227], v249 offset:50176
v_mfma_f32_16x16x32_f16 v[164:167], v[228:231], v[28:31], v[164:167]
s_waitcnt lgkmcnt(2)
v_mfma_f32_16x16x32_f16 v[120:123], v[232:235], v[32:35], v[120:123]
buffer_load_dwordx4 v[24:27], v253, s[32:35], s80 offen
ds_read_b128 v[228:231], v249 offset:50432
v_mfma_f32_16x16x32_f16 v[128:131], v[232:235], v[36:39], v[128:131]
v_and_b32 v16, 1, v251
s_waitcnt lgkmcnt(2)
v_mfma_f32_16x16x32_f16 v[124:127], v[236:239], v[32:35], v[124:127]
ds_read_b128 v[232:235], v249 offset:51200
v_mfma_f32_16x16x32_f16 v[132:135], v[236:239], v[36:39], v[132:135]
v_lshlrev_b32 v16, 4, v16
s_waitcnt lgkmcnt(2)
v_mfma_f32_16x16x32_f16 v[136:139], v[224:227], v[32:35], v[136:139]
ds_read_b128 v[236:239], v249 offset:51456
v_mov_b32 v17, 16256
v_mfma_f32_16x16x32_f16 v[144:147], v[224:227], v[36:39], v[144:147]
s_waitcnt lgkmcnt(2)
v_mfma_f32_16x16x32_f16 v[140:143], v[228:231], v[32:35], v[140:143]
ds_read_b128 v[224:227], v249 offset:55296
v_lshlrev_b32 v16, v16, v17
v_mfma_f32_16x16x32_f16 v[148:151], v[228:231], v[36:39], v[148:151]
v_lshrrev_b32 v17, 2, v251
s_waitcnt lgkmcnt(2)
v_mfma_f32_16x16x32_f16 v[152:155], v[232:235], v[32:35], v[152:155]
ds_read_b128 v[228:231], v249 offset:55552
v_mfma_f32_16x16x32_f16 v[160:163], v[232:235], v[36:39], v[160:163]
v_xor_b32 v17, v17, v251
s_waitcnt lgkmcnt(2)
v_mfma_f32_16x16x32_f16 v[156:159], v[236:239], v[32:35], v[156:159]
ds_read_b128 v[232:235], v249 offset:56320
v_mfma_f32_16x16x32_f16 v[164:167], v[236:239], v[36:39], v[164:167]
v_and_b32 v17, 12, v17
s_waitcnt lgkmcnt(2)
v_mfma_f32_16x16x32_f16 v[120:123], v[224:227], v[40:43], v[120:123]
buffer_load_dwordx4 v[28:31], v253, s[32:35], s80 offen offset:256
ds_read_b128 v[236:239], v249 offset:56576
v_and_b32 v20, 2, v251
v_mfma_f32_16x16x32_f16 v[128:131], v[224:227], v[44:47], v[128:131]
s_waitcnt lgkmcnt(2)
v_mfma_f32_16x16x32_f16 v[124:127], v[228:231], v[40:43], v[124:127]
ds_read_b128 v[224:227], v249 offset:57344
v_or_b32_e64 v17, v17, v20
v_mfma_f32_16x16x32_f16 v[132:135], v[228:231], v[44:47], v[132:135]
v_cmp_eq_u32 vcc, 0, v17
s_nop 1
v_cndmask_b32 v18, 0, v16, vcc
s_waitcnt lgkmcnt(2)
v_mfma_f32_16x16x32_f16 v[136:139], v[232:235], v[40:43], v[136:139]
ds_read_b128 v[228:231], v249 offset:57600
v_mfma_f32_16x16x32_f16 v[144:147], v[232:235], v[44:47], v[144:147]
v_cmp_eq_u32 vcc, 2, v17
s_nop 1
v_cndmask_b32 v19, 0, v16, vcc
s_waitcnt lgkmcnt(2)
v_mfma_f32_16x16x32_f16 v[140:143], v[236:239], v[40:43], v[140:143]
ds_read_b128 v[232:235], v249 offset:61440
v_mfma_f32_16x16x32_f16 v[148:151], v[236:239], v[44:47], v[148:151]
v_mov_b32 v16, 0
s_waitcnt lgkmcnt(2)
v_mfma_f32_16x16x32_f16 v[152:155], v[224:227], v[40:43], v[152:155]
ds_read_b128 v[236:239], v249 offset:61696
v_mov_b32 v17, 0
v_mfma_f32_16x16x32_f16 v[160:163], v[224:227], v[44:47], v[160:163]
s_waitcnt lgkmcnt(2)
v_mfma_f32_16x16x32_f16 v[156:159], v[228:231], v[40:43], v[156:159]
ds_read_b128 v[224:227], v249 offset:62464
v_mov_b32_e64 v20, 0
v_mfma_f32_16x16x32_f16 v[164:167], v[228:231], v[44:47], v[164:167]
v_mov_b32 v21, 0
s_waitcnt lgkmcnt(2)
v_mfma_f32_16x16x32_f16 v[120:123], v[232:235], v[48:51], v[120:123]
s_add_u32 s46, s80, 4194304
buffer_load_dwordx4 v[32:35], v253, s[32:35], s46 offen
ds_read_b128 v[228:231], v249 offset:62720
v_mfma_f32_16x16x32_f16 v[128:131], v[232:235], v[52:55], v[128:131]
s_waitcnt lgkmcnt(2)
v_mfma_f32_16x16x32_f16 v[124:127], v[236:239], v[48:51], v[124:127]
ds_read_b128 v[232:235], v249 offset:63488
v_mfma_f32_16x16x32_f16 v[132:135], v[236:239], v[52:55], v[132:135]
s_waitcnt lgkmcnt(2)
v_mfma_f32_16x16x32_f16 v[136:139], v[224:227], v[48:51], v[136:139]
ds_read_b128 v[236:239], v249 offset:63744
v_mfma_f32_16x16x32_f16 v[144:147], v[224:227], v[52:55], v[144:147]
s_waitcnt lgkmcnt(2)
v_mfma_f32_16x16x32_f16 v[140:143], v[228:231], v[48:51], v[140:143]
ds_read_b128 v[224:227], v250 offset:2048
v_mfma_f32_16x16x32_f16 v[148:151], v[228:231], v[52:55], v[148:151]
s_waitcnt lgkmcnt(2)
v_mfma_f32_16x16x32_f16 v[152:155], v[232:235], v[48:51], v[152:155]
ds_read_b128 v[228:231], v250 offset:2304
v_mfma_f32_16x16x32_f16 v[160:163], v[232:235], v[52:55], v[160:163]
s_waitcnt lgkmcnt(2)
v_mfma_f32_16x16x32_f16 v[156:159], v[236:239], v[48:51], v[156:159]
ds_read_b128 v[232:235], v250 offset:3072
v_mfma_f32_16x16x32_f16 v[164:167], v[236:239], v[52:55], v[164:167]
s_waitcnt lgkmcnt(2)
v_mfma_f32_16x16x32_f16 v[120:123], v[224:227], v[56:59], v[120:123]
ds_read_b128 v[236:239], v250 offset:3328
v_mfma_f32_16x16x32_f16 v[128:131], v[224:227], v[60:63], v[128:131]
s_waitcnt lgkmcnt(2)
v_mfma_f32_16x16x32_f16 v[124:127], v[228:231], v[56:59], v[124:127]
s_add_u32 s46, s80, 4194304
buffer_load_dwordx4 v[36:39], v253, s[32:35], s46 offen offset:256
ds_read_b128 v[224:227], v250 offset:4096
v_mfma_f32_16x16x32_f16 v[132:135], v[228:231], v[60:63], v[132:135]
s_waitcnt lgkmcnt(2)
v_mfma_f32_16x16x32_f16 v[136:139], v[232:235], v[56:59], v[136:139]
ds_read_b128 v[228:231], v250 offset:4352
v_mfma_f32_16x16x32_f16 v[144:147], v[232:235], v[60:63], v[144:147]
s_waitcnt lgkmcnt(2)
v_mfma_f32_16x16x32_f16 v[140:143], v[236:239], v[56:59], v[140:143]
ds_read_b128 v[232:235], v250 offset:8192
v_mfma_f32_16x16x32_f16 v[148:151], v[236:239], v[60:63], v[148:151]
s_waitcnt lgkmcnt(2)
v_mfma_f32_16x16x32_f16 v[152:155], v[224:227], v[56:59], v[152:155]
ds_read_b128 v[236:239], v250 offset:8448
v_mfma_f32_16x16x32_f16 v[160:163], v[224:227], v[60:63], v[160:163]
s_waitcnt lgkmcnt(2)
v_mfma_f32_16x16x32_f16 v[156:159], v[228:231], v[56:59], v[156:159]
ds_read_b128 v[224:227], v250 offset:9216
v_mfma_f32_16x16x32_f16 v[164:167], v[228:231], v[60:63], v[164:167]
s_waitcnt vmcnt(9)
v_mfma_f32_16x16x32_bf16 v[120:123], v[18:21], v[240:243], v[120:123]
ds_read_b128 v[228:231], v250 offset:9472
v_mfma_f32_16x16x32_bf16 v[124:127], v[16:19], v[240:243], v[124:127]
s_waitcnt vmcnt(8)
v_mfma_f32_16x16x32_bf16 v[136:139], v[18:21], v[244:247], v[136:139]
v_mfma_f32_16x16x32_bf16 v[140:143], v[16:19], v[244:247], v[140:143]
s_waitcnt lgkmcnt(3)
v_mfma_f32_16x16x32_f16 v[120:123], v[232:235], v[64:67], v[120:123]
s_add_u32 s46, s80, 8388608
buffer_load_dwordx4 v[40:43], v253, s[32:35], s46 offen
v_mfma_f32_16x16x32_f16 v[128:131], v[232:235], v[68:71], v[128:131]
s_waitcnt lgkmcnt(2)
v_mfma_f32_16x16x32_f16 v[124:127], v[236:239], v[64:67], v[124:127]
ds_read_b128 v[232:235], v250 offset:10240
v_mfma_f32_16x16x32_f16 v[132:135], v[236:239], v[68:71], v[132:135]
s_waitcnt lgkmcnt(2)
v_mfma_f32_16x16x32_f16 v[136:139], v[224:227], v[64:67], v[136:139]
ds_read_b128 v[236:239], v250 offset:10496
v_mfma_f32_16x16x32_f16 v[144:147], v[224:227], v[68:71], v[144:147]
s_waitcnt lgkmcnt(2)
v_mfma_f32_16x16x32_f16 v[140:143], v[228:231], v[64:67], v[140:143]
ds_read_b128 v[224:227], v250 offset:14336
v_mfma_f32_16x16x32_f16 v[148:151], v[228:231], v[68:71], v[148:151]
s_waitcnt lgkmcnt(2)
v_mfma_f32_16x16x32_f16 v[152:155], v[232:235], v[64:67], v[152:155]
ds_read_b128 v[228:231], v250 offset:14592
v_mfma_f32_16x16x32_f16 v[160:163], v[232:235], v[68:71], v[160:163]
s_waitcnt lgkmcnt(2)
v_mfma_f32_16x16x32_f16 v[156:159], v[236:239], v[64:67], v[156:159]
ds_read_b128 v[232:235], v250 offset:15360
v_mfma_f32_16x16x32_f16 v[164:167], v[236:239], v[68:71], v[164:167]
s_waitcnt lgkmcnt(2)
v_mfma_f32_16x16x32_f16 v[120:123], v[224:227], v[72:75], v[120:123]
ds_read_b128 v[236:239], v250 offset:15616
v_mfma_f32_16x16x32_f16 v[128:131], v[224:227], v[76:79], v[128:131]
s_waitcnt lgkmcnt(2)
v_mfma_f32_16x16x32_f16 v[124:127], v[228:231], v[72:75], v[124:127]
s_add_u32 s46, s80, 8388608
buffer_load_dwordx4 v[44:47], v253, s[32:35], s46 offen offset:256
ds_read_b128 v[224:227], v250 offset:16384
v_mfma_f32_16x16x32_f16 v[132:135], v[228:231], v[76:79], v[132:135]
s_waitcnt lgkmcnt(2)
v_mfma_f32_16x16x32_f16 v[136:139], v[232:235], v[72:75], v[136:139]
ds_read_b128 v[228:231], v250 offset:16640
v_mfma_f32_16x16x32_f16 v[144:147], v[232:235], v[76:79], v[144:147]
s_waitcnt lgkmcnt(2)
v_mfma_f32_16x16x32_f16 v[140:143], v[236:239], v[72:75], v[140:143]
ds_read_b128 v[232:235], v250 offset:20480
v_mfma_f32_16x16x32_f16 v[148:151], v[236:239], v[76:79], v[148:151]
s_waitcnt lgkmcnt(2)
v_mfma_f32_16x16x32_f16 v[152:155], v[224:227], v[72:75], v[152:155]
ds_read_b128 v[236:239], v250 offset:20736
v_mfma_f32_16x16x32_f16 v[160:163], v[224:227], v[76:79], v[160:163]
s_waitcnt lgkmcnt(2)
v_mfma_f32_16x16x32_f16 v[156:159], v[228:231], v[72:75], v[156:159]
ds_read_b128 v[224:227], v250 offset:21504
v_mfma_f32_16x16x32_f16 v[164:167], v[228:231], v[76:79], v[164:167]
s_waitcnt vmcnt(9)
v_mfma_f32_16x16x32_bf16 v[152:155], v[18:21], v[12:15], v[152:155]
ds_read_b128 v[228:231], v250 offset:21760
v_mfma_f32_16x16x32_bf16 v[156:159], v[16:19], v[12:15], v[156:159]
s_waitcnt vmcnt(8)
v_mfma_f32_16x16x32_bf16 v[128:131], v[18:21], v[8:11], v[128:131]
v_mfma_f32_16x16x32_bf16 v[132:135], v[16:19], v[8:11], v[132:135]
v_and_b32 v255, 1, v251
v_lshlrev_b32 v255, 7, v255
v_sub_u32 v255, v252, v255
s_mov_b32 s74, 1431655765
s_mov_b32 s75, 1431655765
s_waitcnt lgkmcnt(3)
v_mfma_f32_16x16x32_f16 v[120:123], v[232:235], v[80:83], v[120:123]
buffer_load_dwordx4 v[12:15], v252, s[4:7], s70 offen
v_mfma_f32_16x16x32_f16 v[128:131], v[232:235], v[84:87], v[128:131]
s_waitcnt lgkmcnt(2)
v_mfma_f32_16x16x32_f16 v[124:127], v[236:239], v[80:83], v[124:127]
ds_read_b128 v[232:235], v250 offset:22528
v_mfma_f32_16x16x32_f16 v[132:135], v[236:239], v[84:87], v[132:135]
s_waitcnt lgkmcnt(2)
v_mfma_f32_16x16x32_f16 v[136:139], v[224:227], v[80:83], v[136:139]
ds_read_b128 v[236:239], v250 offset:22784
v_mfma_f32_16x16x32_f16 v[144:147], v[224:227], v[84:87], v[144:147]
s_waitcnt lgkmcnt(2)
v_mfma_f32_16x16x32_f16 v[140:143], v[228:231], v[80:83], v[140:143]
ds_read_b128 v[224:227], v250 offset:26624
v_mfma_f32_16x16x32_f16 v[148:151], v[228:231], v[84:87], v[148:151]
s_waitcnt lgkmcnt(2)
v_mfma_f32_16x16x32_f16 v[152:155], v[232:235], v[80:83], v[152:155]
ds_read_b128 v[228:231], v250 offset:26880
v_mfma_f32_16x16x32_f16 v[160:163], v[232:235], v[84:87], v[160:163]
s_waitcnt lgkmcnt(2)
v_mfma_f32_16x16x32_f16 v[156:159], v[236:239], v[80:83], v[156:159]
ds_read_b128 v[232:235], v250 offset:27648
v_mfma_f32_16x16x32_f16 v[164:167], v[236:239], v[84:87], v[164:167]
s_waitcnt lgkmcnt(2)
v_mfma_f32_16x16x32_f16 v[120:123], v[224:227], v[88:91], v[120:123]
ds_read_b128 v[236:239], v250 offset:27904
v_mfma_f32_16x16x32_f16 v[128:131], v[224:227], v[92:95], v[128:131]
s_waitcnt lgkmcnt(2)
v_mfma_f32_16x16x32_f16 v[124:127], v[228:231], v[88:91], v[124:127]
buffer_load_dwordx4 v[8:11], v252, s[4:7], s70 offen offset:64
ds_read_b128 v[224:227], v250 offset:28672
v_mfma_f32_16x16x32_f16 v[132:135], v[228:231], v[92:95], v[132:135]
s_waitcnt lgkmcnt(2)
v_mfma_f32_16x16x32_f16 v[136:139], v[232:235], v[88:91], v[136:139]
ds_read_b128 v[228:231], v250 offset:28928
v_mfma_f32_16x16x32_f16 v[144:147], v[232:235], v[92:95], v[144:147]
s_waitcnt lgkmcnt(2)
v_mfma_f32_16x16x32_f16 v[140:143], v[236:239], v[88:91], v[140:143]
ds_read_b128 v[232:235], v249 offset:55296
v_mfma_f32_16x16x32_f16 v[148:151], v[236:239], v[92:95], v[148:151]
s_waitcnt lgkmcnt(2)
v_mfma_f32_16x16x32_f16 v[152:155], v[224:227], v[88:91], v[152:155]
ds_read_b128 v[236:239], v254 offset:7936
v_mfma_f32_16x16x32_f16 v[160:163], v[224:227], v[92:95], v[160:163]
s_waitcnt lgkmcnt(2)
v_mfma_f32_16x16x32_f16 v[156:159], v[228:231], v[88:91], v[156:159]
ds_read_b128 v[224:227], v249 offset:55552
v_mfma_f32_16x16x32_f16 v[164:167], v[228:231], v[92:95], v[164:167]
s_waitcnt vmcnt(9)
v_mfma_f32_16x16x32_bf16 v[144:147], v[18:21], v[4:7], v[144:147]
ds_read_b128 v[228:231], v254 offset:7952
v_mfma_f32_16x16x32_bf16 v[148:151], v[16:19], v[4:7], v[148:151]
s_waitcnt vmcnt(8)
v_mfma_f32_16x16x32_bf16 v[160:163], v[18:21], v[0:3], v[160:163]
v_mfma_f32_16x16x32_bf16 v[164:167], v[16:19], v[0:3], v[164:167]
s_waitcnt lgkmcnt(2)
v_mfma_f32_16x16x32_f16 v[48:51], v[232:235], v[168:171], v[236:239]
buffer_load_dwordx4 v[4:7], v252, s[4:7], s70 offen offset:128
v_mfma_f32_16x16x32_f16 v[56:59], v[232:235], v[172:175], v[236:239]
s_waitcnt lgkmcnt(0)
v_mfma_f32_16x16x32_f16 v[52:55], v[224:227], v[168:171], v[228:231]
ds_read_b128 v[232:235], v249 offset:56320
ds_read_b128 v[236:239], v254 offset:8064
v_mfma_f32_16x16x32_f16 v[60:63], v[224:227], v[172:175], v[228:231]
s_waitcnt lgkmcnt(0)
v_mfma_f32_16x16x32_f16 v[64:67], v[232:235], v[168:171], v[236:239]
ds_read_b128 v[224:227], v249 offset:56576
ds_read_b128 v[228:231], v254 offset:8080
v_mfma_f32_16x16x32_f16 v[72:75], v[232:235], v[172:175], v[236:239]
v_cvt_pk_bf16_f32 v136, v136, v137
s_waitcnt lgkmcnt(0)
v_mfma_f32_16x16x32_f16 v[68:71], v[224:227], v[168:171], v[228:231]
ds_read_b128 v[232:235], v249 offset:57344
ds_read_b128 v[236:239], v254 offset:16128
v_cvt_pk_bf16_f32 v137, v138, v139
v_mfma_f32_16x16x32_f16 v[76:79], v[224:227], v[172:175], v[228:231]
v_cvt_pk_bf16_f32 v138, v140, v141
v_cvt_pk_bf16_f32 v139, v142, v143
s_waitcnt lgkmcnt(0)
v_mfma_f32_16x16x32_f16 v[80:83], v[232:235], v[168:171], v[236:239]
ds_read_b128 v[224:227], v249 offset:57600
ds_read_b128 v[228:231], v254 offset:16144
v_cvt_pk_bf16_f32 v120, v120, v121
v_mfma_f32_16x16x32_f16 v[88:91], v[232:235], v[172:175], v[236:239]
v_cvt_pk_bf16_f32 v121, v122, v123
s_waitcnt lgkmcnt(0)
v_mfma_f32_16x16x32_f16 v[84:87], v[224:227], v[168:171], v[228:231]
ds_read_b128 v[232:235], v249 offset:61440
ds_read_b128 v[236:239], v249 offset:61696
v_cvt_pk_bf16_f32 v122, v124, v125
v_mfma_f32_16x16x32_f16 v[92:95], v[224:227], v[172:175], v[228:231]
v_cvt_pk_bf16_f32 v123, v126, v127
v_cvt_pk_bf16_f32 v152, v152, v153
s_waitcnt lgkmcnt(1)
v_mfma_f32_16x16x32_f16 v[48:51], v[232:235], v[176:179], v[48:51]
ds_read_b128 v[224:227], v249 offset:62464
ds_read_b128 v[228:231], v249 offset:62720
v_cvt_pk_bf16_f32 v153, v154, v155
v_mfma_f32_16x16x32_f16 v[56:59], v[232:235], v[180:183], v[56:59]
v_cvt_pk_bf16_f32 v154, v156, v157
s_waitcnt lgkmcnt(2)
v_mfma_f32_16x16x32_f16 v[52:55], v[236:239], v[176:179], v[52:55]
ds_read_b128 v[232:235], v249 offset:63488
v_cvt_pk_bf16_f32 v155, v158, v159
s_mov_b64 vcc, s[74:75]
v_mfma_f32_16x16x32_f16 v[60:63], v[236:239], v[180:183], v[60:63]
v_cndmask_b32 v140, v120, v152, vcc
v_cndmask_b32 v141, v121, v153, vcc
s_waitcnt lgkmcnt(2)
v_mfma_f32_16x16x32_f16 v[64:67], v[224:227], v[176:179], v[64:67]
ds_read_b128 v[236:239], v249 offset:63744
v_cndmask_b32 v142, v122, v154, vcc
v_mfma_f32_16x16x32_f16 v[72:75], v[224:227], v[180:183], v[72:75]
v_cndmask_b32 v143, v123, v155, vcc
s_waitcnt lgkmcnt(2)
v_mfma_f32_16x16x32_f16 v[68:71], v[228:231], v[176:179], v[68:71]
ds_read_b128 v[224:227], v250 offset:2048
v_cndmask_b32_dpp v120, v136, v120, vcc quad_perm:[1,0,3,2] row_mask:0xf bank_mask:0xf
v_mfma_f32_16x16x32_f16 v[76:79], v[228:231], v[180:183], v[76:79]
v_cndmask_b32_dpp v121, v137, v121, vcc quad_perm:[1,0,3,2] row_mask:0xf bank_mask:0xf
v_cndmask_b32_dpp v122, v138, v122, vcc quad_perm:[1,0,3,2] row_mask:0xf bank_mask:0xf
s_waitcnt lgkmcnt(2)
v_mfma_f32_16x16x32_f16 v[80:83], v[232:235], v[176:179], v[80:83]
ds_read_b128 v[228:231], v250 offset:2304
v_cndmask_b32_dpp v123, v139, v123, vcc quad_perm:[1,0,3,2] row_mask:0xf bank_mask:0xf
s_not_b64 vcc, s[74:75]
v_mfma_f32_16x16x32_f16 v[88:91], v[232:235], v[180:183], v[88:91]
v_cndmask_b32_dpp v152, v136, v152, vcc quad_perm:[1,0,3,2] row_mask:0xf bank_mask:0xf
s_waitcnt lgkmcnt(2)
v_mfma_f32_16x16x32_f16 v[84:87], v[236:239], v[176:179], v[84:87]
ds_read_b128 v[232:235], v248 offset:16384
v_cndmask_b32_dpp v153, v137, v153, vcc quad_perm:[1,0,3,2] row_mask:0xf bank_mask:0xf
v_mfma_f32_16x16x32_f16 v[92:95], v[236:239], v[180:183], v[92:95]
v_cndmask_b32_dpp v154, v138, v154, vcc quad_perm:[1,0,3,2] row_mask:0xf bank_mask:0xf
v_cndmask_b32_dpp v155, v139, v155, vcc quad_perm:[1,0,3,2] row_mask:0xf bank_mask:0xf
s_waitcnt lgkmcnt(2)
v_mfma_f32_16x16x32_f16 v[48:51], v[224:227], v[184:187], v[48:51]
s_add_u32 s46, s70, 98304
buffer_load_dwordx4 v[0:3], v252, s[4:7], s46 offen
ds_read_b128 v[236:239], v250 offset:3072
buffer_store_dwordx4 v[120:123], v255, s[8:11], s71 offen sc1
v_mfma_f32_16x16x32_f16 v[56:59], v[224:227], v[188:191], v[56:59]
s_waitcnt lgkmcnt(2)
v_mfma_f32_16x16x32_f16 v[52:55], v[228:231], v[184:187], v[52:55]
ds_read_b128 v[224:227], v250 offset:3328
v_mfma_f32_16x16x32_f16 v[60:63], v[228:231], v[188:191], v[60:63]
s_waitcnt lgkmcnt(2)
v_mfma_f32_16x16x32_bf16 v[168:171], v[232:235], v[96:99], 0
ds_read_b128 v[228:231], v250 offset:4096
v_mfma_f32_16x16x32_bf16 v[176:179], v[232:235], v[100:103], 0
s_waitcnt lgkmcnt(2)
v_mfma_f32_16x16x32_f16 v[64:67], v[236:239], v[184:187], v[64:67]
ds_read_b128 v[232:235], v250 offset:4352
v_mfma_f32_16x16x32_f16 v[72:75], v[236:239], v[188:191], v[72:75]
s_waitcnt lgkmcnt(2)
v_mfma_f32_16x16x32_f16 v[68:71], v[224:227], v[184:187], v[68:71]
ds_read_b128 v[236:239], v248 offset:16640
v_mfma_f32_16x16x32_f16 v[76:79], v[224:227], v[188:191], v[76:79]
s_waitcnt lgkmcnt(2)
v_mfma_f32_16x16x32_f16 v[80:83], v[228:231], v[184:187], v[80:83]
ds_read_b128 v[224:227], v250 offset:8192
v_mfma_f32_16x16x32_f16 v[88:91], v[228:231], v[188:191], v[88:91]
s_waitcnt lgkmcnt(2)
v_mfma_f32_16x16x32_f16 v[84:87], v[232:235], v[184:187], v[84:87]
ds_read_b128 v[228:231], v250 offset:8448
v_mfma_f32_16x16x32_f16 v[92:95], v[232:235], v[188:191], v[92:95]
s_waitcnt lgkmcnt(2)
v_mfma_f32_16x16x32_bf16 v[172:175], v[236:239], v[96:99], 0
ds_read_b128 v[232:235], v250 offset:9216
v_mfma_f32_16x16x32_bf16 v[180:183], v[236:239], v[100:103], 0
s_waitcnt lgkmcnt(2)
v_mfma_f32_16x16x32_f16 v[48:51], v[224:227], v[192:195], v[48:51]
buffer_store_dwordx4 v[140:143], v255, s[8:11], s71 offen offset:128 sc1
ds_read_b128 v[236:239], v250 offset:9472
v_mfma_f32_16x16x32_f16 v[56:59], v[224:227], v[196:199], v[56:59]
s_waitcnt lgkmcnt(2)
v_mfma_f32_16x16x32_f16 v[52:55], v[228:231], v[192:195], v[52:55]
ds_read_b128 v[224:227], v248 offset:17408
v_mfma_f32_16x16x32_f16 v[60:63], v[228:231], v[196:199], v[60:63]
s_waitcnt lgkmcnt(2)
v_mfma_f32_16x16x32_f16 v[64:67], v[232:235], v[192:195], v[64:67]
ds_read_b128 v[228:231], v250 offset:10240
v_mfma_f32_16x16x32_f16 v[72:75], v[232:235], v[196:199], v[72:75]
s_waitcnt lgkmcnt(2)
v_mfma_f32_16x16x32_f16 v[68:71], v[236:239], v[192:195], v[68:71]
ds_read_b128 v[232:235], v250 offset:10496
v_mfma_f32_16x16x32_f16 v[76:79], v[236:239], v[196:199], v[76:79]
s_waitcnt lgkmcnt(2)
v_mfma_f32_16x16x32_bf16 v[168:171], v[224:227], v[104:107], v[168:171]
ds_read_b128 v[236:239], v250 offset:14336
v_mfma_f32_16x16x32_bf16 v[176:179], v[224:227], v[108:111], v[176:179]
s_waitcnt lgkmcnt(2)
v_mfma_f32_16x16x32_f16 v[80:83], v[228:231], v[192:195], v[80:83]
ds_read_b128 v[224:227], v250 offset:14592
v_mfma_f32_16x16x32_f16 v[88:91], v[228:231], v[196:199], v[88:91]
s_waitcnt lgkmcnt(2)
v_mfma_f32_16x16x32_f16 v[84:87], v[232:235], v[192:195], v[84:87]
ds_read_b128 v[228:231], v248 offset:17664
v_mfma_f32_16x16x32_f16 v[92:95], v[232:235], v[196:199], v[92:95]
s_waitcnt lgkmcnt(2)
v_mfma_f32_16x16x32_f16 v[48:51], v[236:239], v[200:203], v[48:51]
s_add_u32 s46, s70, 98304
buffer_load_dwordx4 v[244:247], v252, s[4:7], s46 offen offset:64
ds_read_b128 v[232:235], v250 offset:15360
v_mfma_f32_16x16x32_f16 v[56:59], v[236:239], v[204:207], v[56:59]
s_waitcnt lgkmcnt(2)
v_mfma_f32_16x16x32_f16 v[52:55], v[224:227], v[200:203], v[52:55]
ds_read_b128 v[236:239], v250 offset:15616
v_mfma_f32_16x16x32_f16 v[60:63], v[224:227], v[204:207], v[60:63]
s_waitcnt lgkmcnt(2)
v_mfma_f32_16x16x32_bf16 v[172:175], v[228:231], v[104:107], v[172:175]
ds_read_b128 v[224:227], v250 offset:16384
v_mfma_f32_16x16x32_bf16 v[180:183], v[228:231], v[108:111], v[180:183]
s_waitcnt lgkmcnt(2)
v_mfma_f32_16x16x32_f16 v[64:67], v[232:235], v[200:203], v[64:67]
ds_read_b128 v[228:231], v250 offset:16640
v_mfma_f32_16x16x32_f16 v[72:75], v[232:235], v[204:207], v[72:75]
s_waitcnt lgkmcnt(2)
v_mfma_f32_16x16x32_f16 v[68:71], v[236:239], v[200:203], v[68:71]
ds_read_b128 v[232:235], v248 offset:18432
v_mfma_f32_16x16x32_f16 v[76:79], v[236:239], v[204:207], v[76:79]
s_waitcnt lgkmcnt(2)
v_mfma_f32_16x16x32_f16 v[80:83], v[224:227], v[200:203], v[80:83]
ds_read_b128 v[236:239], v250 offset:20480
v_mfma_f32_16x16x32_f16 v[88:91], v[224:227], v[204:207], v[88:91]
s_waitcnt lgkmcnt(2)
v_mfma_f32_16x16x32_f16 v[84:87], v[228:231], v[200:203], v[84:87]
ds_read_b128 v[224:227], v250 offset:20736
v_mfma_f32_16x16x32_f16 v[92:95], v[228:231], v[204:207], v[92:95]
s_waitcnt lgkmcnt(2)
v_mfma_f32_16x16x32_bf16 v[168:171], v[232:235], v[112:115], v[168:171]
ds_read_b128 v[228:231], v250 offset:21504
v_mfma_f32_16x16x32_bf16 v[176:179], v[232:235], v[116:119], v[176:179]
s_waitcnt lgkmcnt(2)
v_mfma_f32_16x16x32_f16 v[48:51], v[236:239], v[208:211], v[48:51]
ds_read_b128 v[232:235], v250 offset:21760
v_mfma_f32_16x16x32_f16 v[56:59], v[236:239], v[212:215], v[56:59]
s_waitcnt lgkmcnt(2)
v_mfma_f32_16x16x32_f16 v[52:55], v[224:227], v[208:211], v[52:55]
ds_read_b128 v[236:239], v248 offset:18688
v_mfma_f32_16x16x32_f16 v[60:63], v[224:227], v[212:215], v[60:63]
s_waitcnt lgkmcnt(2)
v_mfma_f32_16x16x32_f16 v[64:67], v[228:231], v[208:211], v[64:67]
ds_read_b128 v[224:227], v250 offset:22528
v_mfma_f32_16x16x32_f16 v[72:75], v[228:231], v[212:215], v[72:75]
s_waitcnt lgkmcnt(2)
v_mfma_f32_16x16x32_f16 v[68:71], v[232:235], v[208:211], v[68:71]
ds_read_b128 v[228:231], v250 offset:22784
v_mfma_f32_16x16x32_f16 v[76:79], v[232:235], v[212:215], v[76:79]
s_waitcnt lgkmcnt(2)
v_mfma_f32_16x16x32_bf16 v[172:175], v[236:239], v[112:115], v[172:175]
ds_read_b128 v[232:235], v250 offset:26624
v_mfma_f32_16x16x32_bf16 v[180:183], v[236:239], v[116:119], v[180:183]
s_waitcnt lgkmcnt(2)
v_mfma_f32_16x16x32_f16 v[80:83], v[224:227], v[208:211], v[80:83]
ds_read_b128 v[236:239], v250 offset:26880
v_mfma_f32_16x16x32_f16 v[88:91], v[224:227], v[212:215], v[88:91]
s_waitcnt lgkmcnt(2)
v_mfma_f32_16x16x32_f16 v[84:87], v[228:231], v[208:211], v[84:87]
ds_read_b128 v[224:227], v248 offset:22528
v_mfma_f32_16x16x32_f16 v[92:95], v[228:231], v[212:215], v[92:95]
s_setprio 3
s_waitcnt lgkmcnt(2)
v_mfma_f32_16x16x32_f16 v[48:51], v[232:235], v[216:219], v[48:51]
s_add_u32 s46, s70, 98304
buffer_load_dwordx4 v[204:207], v252, s[4:7], s46 offen offset:128
ds_read_b128 v[228:231], v250 offset:27648
v_cvt_pkrtz_f16_f32 v185, v168, v169
v_cvt_pkrtz_f16_f32 v187, v170, v171
v_mfma_f32_16x16x32_f16 v[56:59], v[232:235], v[220:223], v[56:59]
v_cvt_pkrtz_f16_f32 v189, v172, v173
v_cvt_pkrtz_f16_f32 v191, v174, v175
s_waitcnt lgkmcnt(2)
v_mfma_f32_16x16x32_f16 v[52:55], v[236:239], v[216:219], v[52:55]
ds_read_b128 v[232:235], v248 offset:22784
v_cvt_pkrtz_f16_f32 v193, v176, v177
v_cvt_pk_f16_f32 v203, v178, v179
v_cvt_pk_f16_f32 v200, v180, v181
v_mfma_f32_16x16x32_f16 v[60:63], v[236:239], v[220:223], v[60:63]
v_cvt_pk_f16_f32 v197, v182, v183
v_pk_fma_f16 v202, v203, v203, s48
s_waitcnt lgkmcnt(2)
v_mfma_f32_16x16x32_bf16 v[168:171], v[224:227], v[96:99], 0
ds_read_b128 v[236:239], v250 offset:27904
v_and_b32_e64 v185, s49, v185
v_pk_fma_f16 v199, v200, v200, s48
v_mfma_f32_16x16x32_bf16 v[176:179], v[224:227], v[100:103], 0
v_and_b32 v187, s49, v187
v_pk_fma_f16 v196, v197, v197, s48
v_bfe_u32 v184, v185, 2, 14
s_waitcnt lgkmcnt(2)
v_mfma_f32_16x16x32_f16 v[64:67], v[228:231], v[216:219], v[64:67]
ds_read_b128 v[224:227], v248 offset:23552
ds_read_u16_d16 v184, v184
v_pk_mul_f16 v202, v203, v202
v_bfe_u32 v186, v187, 2, 14
v_mfma_f32_16x16x32_f16 v[72:75], v[228:231], v[220:223], v[72:75]
v_pk_mul_f16 v199, v200, v199
v_lshrrev_b32 v185, 18, v185
s_waitcnt lgkmcnt(3)
v_mfma_f32_16x16x32_bf16 v[172:175], v[232:235], v[96:99], 0
ds_read_b128 v[228:231], v250 offset:28672
ds_read_u16_d16 v186, v186
ds_read_u16_d16_hi v185, v185
v_pk_mul_f16 v196, v197, v196
v_lshrrev_b32_e64 v187, 18, v187
v_mfma_f32_16x16x32_bf16 v[180:183], v[232:235], v[100:103], 0
v_exp_f16_e64 v201, v202
v_and_b32 v189, s49, v189
s_waitcnt lgkmcnt(5)
v_mfma_f32_16x16x32_f16 v[68:71], v[236:239], v[216:219], v[68:71]
ds_read_b128 v[232:235], v250 offset:28928
ds_read_u16_d16_hi v187, v187
v_and_b32_e64 v191, s49, v191
v_mfma_f32_16x16x32_f16 v[76:79], v[236:239], v[220:223], v[76:79]
v_exp_f16 v198, v199
v_bfe_u32 v188, v189, 2, 14
v_bfe_u32 v190, v191, 2, 14
s_waitcnt lgkmcnt(5)
v_mfma_f32_16x16x32_bf16 v[168:171], v[224:227], v[104:107], v[168:171]
buffer_store_dwordx4 v[152:155], v255, s[8:11], s71 offen offset:256 sc1
ds_read_b128 v[236:239], v248 offset:23808
ds_read_u16_d16 v188, v188
ds_read_u16_d16 v190, v190
v_exp_f16_e64 v195, v196
v_mfma_f32_16x16x32_bf16 v[176:179], v[224:227], v[108:111], v[176:179]
v_lshrrev_b32_e64 v189, 18, v189
v_lshrrev_b32 v191, 18, v191
s_waitcnt lgkmcnt(5)
v_mfma_f32_16x16x32_f16 v[80:83], v[228:231], v[216:219], v[80:83]
ds_read_b128 v[224:227], v248 offset:24576
ds_read_u16_d16_hi v189, v189
ds_read_u16_d16_hi v191, v191
v_exp_f16_sdwa v201, v202 dst_sel:WORD_1 dst_unused:UNUSED_PRESERVE src0_sel:WORD_1
v_and_b32 v193, s49, v193
v_mfma_f32_16x16x32_f16 v[88:91], v[228:231], v[220:223], v[88:91]
v_bfe_u32 v192, v193, 2, 14
s_waitcnt lgkmcnt(6)
v_mfma_f32_16x16x32_f16 v[84:87], v[232:235], v[216:219], v[84:87]
ds_read_b128 v[228:231], v248 offset:24832
ds_read_u16_d16 v192, v192
v_exp_f16_sdwa v198, v199 dst_sel:WORD_1 dst_unused:UNUSED_PRESERVE src0_sel:WORD_1
v_lshrrev_b32 v193, 18, v193
v_mfma_f32_16x16x32_f16 v[92:95], v[232:235], v[220:223], v[92:95]
v_exp_f16_sdwa v195, v196 dst_sel:WORD_1 dst_unused:UNUSED_PRESERVE src0_sel:WORD_1
v_pk_add_f16 v201, v201, 1.0 op_sel_hi:[1,0]
s_waitcnt lgkmcnt(7)
v_mfma_f32_16x16x32_bf16 v[172:175], v[236:239], v[104:107], v[172:175]
ds_read_u16_d16_hi v193, v193
v_pk_add_f16 v198, v198, 1.0 op_sel_hi:[1,0]
v_pk_add_f16 v195, v195, 1.0 op_sel_hi:[1,0]
v_mfma_f32_16x16x32_bf16 v[180:183], v[236:239], v[108:111], v[180:183]
v_rcp_f16 v202, v201
s_waitcnt lgkmcnt(5)
v_mfma_f32_16x16x32_bf16 v[168:171], v[224:227], v[112:115], v[168:171]
v_rcp_f16_e64 v199, v198
v_mfma_f32_16x16x32_bf16 v[176:179], v[224:227], v[116:119], v[176:179]
v_rcp_f16 v196, v195
s_waitcnt lgkmcnt(2)
v_mfma_f32_16x16x32_bf16 v[172:175], v[228:231], v[112:115], v[172:175]
ds_read_b128 v[224:227], v249 offset:24576
v_rcp_f16_sdwa v202, v201 dst_sel:WORD_1 dst_unused:UNUSED_PRESERVE src0_sel:WORD_1
v_mfma_f32_16x16x32_bf16 v[180:183], v[228:231], v[116:119], v[180:183]
v_rcp_f16_sdwa v199, v198 dst_sel:WORD_1 dst_unused:UNUSED_PRESERVE src0_sel:WORD_1
v_or_b32 v208, v184, v185
v_or_b32 v209, v186, v187
v_or_b32_e64 v210, v188, v189
v_rcp_f16_sdwa v196, v195 dst_sel:WORD_1 dst_unused:UNUSED_PRESERVE src0_sel:WORD_1
v_or_b32 v211, v190, v191
s_waitcnt lgkmcnt(1)
v_or_b32 v212, v192, v193
v_pk_mul_f16 v213, v203, v202
v_pk_mul_f16 v214, v200, v199
v_pk_mul_f16 v215, v197, v196
s_waitcnt lgkmcnt(0)
v_mfma_f32_16x16x32_f16 v[48:51], v[224:227], v[208:211], v[48:51]
ds_read_b128 v[228:231], v249 offset:24832
ds_read_b128 v[232:235], v248 offset:28672
ds_read_b128 v[236:239], v249 offset:25600
ds_read_b128 v[216:219], v248 offset:28928
ds_read_b128 v[220:223], v249 offset:25856
v_cvt_pkrtz_f16_f32 v185, v168, v169
v_cvt_pkrtz_f16_f32 v187, v170, v171
v_cvt_pkrtz_f16_f32 v189, v172, v173
v_mfma_f32_16x16x32_f16 v[56:59], v[224:227], v[212:215], v[56:59]
v_cvt_pkrtz_f16_f32 v191, v174, v175
v_cvt_pkrtz_f16_f32 v193, v176, v177
v_cvt_pk_f16_f32 v203, v178, v179
s_waitcnt lgkmcnt(4)
v_mfma_f32_16x16x32_f16 v[52:55], v[228:231], v[208:211], v[52:55]
ds_read_b128 v[224:227], v248 offset:29696
v_cvt_pk_f16_f32 v200, v180, v181
v_cvt_pk_f16_f32 v197, v182, v183
v_pk_fma_f16 v202, v203, v203, s48
v_cvt_pk_bf16_f32 v144, v144, v145
v_mfma_f32_16x16x32_f16 v[60:63], v[228:231], v[212:215], v[60:63]
v_and_b32 v185, s49, v185
v_cvt_pk_bf16_f32 v145, v146, v147
v_pk_fma_f16 v199, v200, v200, s48
s_waitcnt lgkmcnt(4)
v_mfma_f32_16x16x32_bf16 v[168:171], v[232:235], v[96:99], 0
ds_read_b128 v[228:231], v249 offset:26624
v_and_b32 v187, s49, v187
v_cvt_pk_bf16_f32 v146, v148, v149
v_pk_fma_f16 v196, v197, v197, s48
v_mfma_f32_16x16x32_bf16 v[176:179], v[232:235], v[100:103], 0
v_cvt_pk_bf16_f32 v147, v150, v151
v_bfe_u32 v184, v185, 2, 14
s_setprio 2
v_pk_mul_f16 v202, v203, v202
v_cvt_pk_bf16_f32 v128, v128, v129
s_waitcnt lgkmcnt(2)
v_mfma_f32_16x16x32_f16 v[64:67], v[236:239], v[208:211], v[64:67]
ds_read_b128 v[232:235], v249 offset:26880
ds_read_u16_d16 v184, v184
v_bfe_u32 v186, v187, 2, 14
v_cvt_pk_bf16_f32 v129, v130, v131
v_pk_mul_f16 v199, v200, v199
v_mfma_f32_16x16x32_f16 v[72:75], v[236:239], v[212:215], v[72:75]
v_lshrrev_b32_e64 v185, 18, v185
v_cvt_pk_bf16_f32 v130, v132, v133
v_pk_mul_f16 v196, v197, v196
v_mfma_f32_16x16x32_bf16 v[172:175], v[216:219], v[96:99], 0
ds_read_b128 v[236:239], v248 offset:29952
ds_read_u16_d16 v186, v186
ds_read_u16_d16_hi v185, v185
v_lshrrev_b32_e64 v187, 18, v187
v_cvt_pk_bf16_f32 v131, v134, v135
v_exp_f16_e64 v201, v202
v_mfma_f32_16x16x32_bf16 v[180:183], v[216:219], v[100:103], 0
v_cvt_pk_bf16_f32 v160, v160, v161
v_and_b32_e64 v189, s49, v189
v_cvt_pk_bf16_f32 v161, v162, v163
v_mfma_f32_16x16x32_f16 v[68:71], v[220:223], v[208:211], v[68:71]
ds_read_b128 v[216:219], v248 offset:30720
ds_read_u16_d16_hi v187, v187
v_and_b32_e64 v191, s49, v191
v_cvt_pk_bf16_f32 v162, v164, v165
v_mfma_f32_16x16x32_f16 v[76:79], v[220:223], v[212:215], v[76:79]
v_exp_f16_e64 v198, v199
v_cvt_pk_bf16_f32 v163, v166, v167
s_mov_b64 vcc, s[74:75]
v_bfe_u32 v188, v189, 2, 14
v_bfe_u32 v190, v191, 2, 14
s_waitcnt lgkmcnt(5)
v_mfma_f32_16x16x32_bf16 v[168:171], v[224:227], v[104:107], v[168:171]
ds_read_b128 v[220:223], v248 offset:30976
ds_read_u16_d16 v188, v188
ds_read_u16_d16 v190, v190
v_cndmask_b32 v148, v128, v160, vcc
v_exp_f16 v195, v196
v_mfma_f32_16x16x32_bf16 v[176:179], v[224:227], v[108:111], v[176:179]
v_cndmask_b32 v149, v129, v161, vcc
v_lshrrev_b32_e64 v189, 18, v189
v_cndmask_b32 v150, v130, v162, vcc
v_mfma_f32_16x16x32_f16 v[80:83], v[228:231], v[208:211], v[80:83]
ds_read_b128 v[224:227], v249 offset:30720
ds_read_u16_d16_hi v189, v189
v_lshrrev_b32 v191, 18, v191
v_cndmask_b32 v151, v131, v163, vcc
v_exp_f16_sdwa v201, v202 dst_sel:WORD_1 dst_unused:UNUSED_PRESERVE src0_sel:WORD_1
v_mfma_f32_16x16x32_f16 v[88:91], v[228:231], v[212:215], v[88:91]
v_cndmask_b32_dpp v128, v144, v128, vcc quad_perm:[1,0,3,2] row_mask:0xf bank_mask:0xf
v_and_b32_e64 v193, s49, v193
v_cndmask_b32_dpp v129, v145, v129, vcc quad_perm:[1,0,3,2] row_mask:0xf bank_mask:0xf
v_mfma_f32_16x16x32_f16 v[84:87], v[232:235], v[208:211], v[84:87]
ds_read_b128 v[228:231], v249 offset:30976
ds_read_u16_d16_hi v191, v191
v_bfe_u32 v192, v193, 2, 14
v_exp_f16_sdwa v198, v199 dst_sel:WORD_1 dst_unused:UNUSED_PRESERVE src0_sel:WORD_1
v_mfma_f32_16x16x32_f16 v[92:95], v[232:235], v[212:215], v[92:95]
v_cndmask_b32_dpp v130, v146, v130, vcc quad_perm:[1,0,3,2] row_mask:0xf bank_mask:0xf
v_lshrrev_b32_e64 v193, 18, v193
v_cndmask_b32_dpp v131, v147, v131, vcc quad_perm:[1,0,3,2] row_mask:0xf bank_mask:0xf
s_not_b64 vcc, s[74:75]
s_waitcnt lgkmcnt(4)
v_mfma_f32_16x16x32_bf16 v[172:175], v[236:239], v[104:107], v[172:175]
ds_read_b128 v[232:235], v248 offset:34816
ds_read_u16_d16 v192, v192
ds_read_u16_d16_hi v193, v193
v_exp_f16_sdwa v195, v196 dst_sel:WORD_1 dst_unused:UNUSED_PRESERVE src0_sel:WORD_1
v_cndmask_b32_dpp v160, v144, v160, vcc quad_perm:[1,0,3,2] row_mask:0xf bank_mask:0xf
v_pk_add_f16 v201, v201, 1.0 op_sel_hi:[1,0]
v_mfma_f32_16x16x32_bf16 v[180:183], v[236:239], v[108:111], v[180:183]
v_cndmask_b32_dpp v161, v145, v161, vcc quad_perm:[1,0,3,2] row_mask:0xf bank_mask:0xf
v_pk_add_f16 v198, v198, 1.0 op_sel_hi:[1,0]
v_cndmask_b32_dpp v162, v146, v162, vcc quad_perm:[1,0,3,2] row_mask:0xf bank_mask:0xf
v_mfma_f32_16x16x32_bf16 v[168:171], v[216:219], v[112:115], v[168:171]
ds_read_b128 v[236:239], v249 offset:31744
v_pk_add_f16 v195, v195, 1.0 op_sel_hi:[1,0]
v_rcp_f16_e64 v202, v201
v_cndmask_b32_dpp v163, v147, v163, vcc quad_perm:[1,0,3,2] row_mask:0xf bank_mask:0xf
v_mfma_f32_16x16x32_bf16 v[176:179], v[216:219], v[116:119], v[176:179]
v_rcp_f16_e64 v199, v198
v_mfma_f32_16x16x32_bf16 v[172:175], v[220:223], v[112:115], v[172:175]
ds_read_b128 v[216:219], v248 offset:35072
s_add_u32 s46, s71, 98304
buffer_store_dwordx4 v[128:131], v255, s[8:11], s46 offen sc1
v_rcp_f16_e64 v196, v195
v_rcp_f16_sdwa v202, v201 dst_sel:WORD_1 dst_unused:UNUSED_PRESERVE src0_sel:WORD_1
v_mfma_f32_16x16x32_bf16 v[180:183], v[220:223], v[116:119], v[180:183]
v_rcp_f16_sdwa v199, v198 dst_sel:WORD_1 dst_unused:UNUSED_PRESERVE src0_sel:WORD_1
v_or_b32 v208, v184, v185
v_or_b32 v209, v186, v187
s_waitcnt lgkmcnt(2)
v_or_b32 v210, v188, v189
v_rcp_f16_sdwa v196, v195 dst_sel:WORD_1 dst_unused:UNUSED_PRESERVE src0_sel:WORD_1
v_or_b32 v211, v190, v191
v_or_b32 v212, v192, v193
v_pk_mul_f16 v213, v203, v202
v_pk_mul_f16 v214, v200, v199
v_pk_mul_f16 v215, v197, v196
v_mfma_f32_16x16x32_f16 v[48:51], v[224:227], v[208:211], v[48:51]
ds_read_b128 v[220:223], v249 offset:32000
v_cvt_pkrtz_f16_f32 v185, v168, v169
v_cvt_pkrtz_f16_f32 v187, v170, v171
v_mfma_f32_16x16x32_f16 v[56:59], v[224:227], v[212:215], v[56:59]
v_cvt_pkrtz_f16_f32 v189, v172, v173
v_cvt_pkrtz_f16_f32 v191, v174, v175
v_mfma_f32_16x16x32_f16 v[52:55], v[228:231], v[208:211], v[52:55]
ds_read_b128 v[224:227], v248 offset:35840
v_cvt_pkrtz_f16_f32 v193, v176, v177
v_cvt_pk_f16_f32 v203, v178, v179
v_mfma_f32_16x16x32_f16 v[60:63], v[228:231], v[212:215], v[60:63]
v_cvt_pk_f16_f32 v200, v180, v181
v_cvt_pk_f16_f32 v197, v182, v183
s_setprio 1
v_mfma_f32_16x16x32_bf16 v[168:171], v[232:235], v[96:99], 0
ds_read_b128 v[228:231], v249 offset:32768
v_pk_fma_f16 v202, v203, v203, s48
v_and_b32 v185, s49, v185
v_mfma_f32_16x16x32_bf16 v[176:179], v[232:235], v[100:103], 0
v_pk_fma_f16 v199, v200, v200, s48
v_and_b32 v187, s49, v187
s_waitcnt lgkmcnt(3)
v_mfma_f32_16x16x32_f16 v[64:67], v[236:239], v[208:211], v[64:67]
ds_read_b128 v[232:235], v249 offset:33024
v_pk_fma_f16 v196, v197, v197, s48
v_bfe_u32 v184, v185, 2, 14
v_pk_mul_f16 v202, v203, v202
v_mfma_f32_16x16x32_f16 v[72:75], v[236:239], v[212:215], v[72:75]
v_bfe_u32 v186, v187, 2, 14
v_pk_mul_f16 v199, v200, v199
s_waitcnt vmcnt(9)
v_mfma_f32_16x16x32_bf16 v[48:51], v[18:21], v[12:15], v[48:51]
ds_read_b128 v[236:239], v248 offset:36096
ds_read_u16_d16 v184, v184
ds_read_u16_d16 v186, v186
v_lshrrev_b32 v185, 18, v185
v_pk_mul_f16 v196, v197, v196
v_mfma_f32_16x16x32_bf16 v[52:55], v[16:19], v[12:15], v[52:55]
v_lshrrev_b32_e64 v187, 18, v187
v_mfma_f32_16x16x32_bf16 v[172:175], v[216:219], v[96:99], 0
ds_read_u16_d16_hi v185, v185
ds_read_u16_d16_hi v187, v187
v_exp_f16 v201, v202
v_and_b32 v189, s49, v189
v_mfma_f32_16x16x32_bf16 v[180:183], v[216:219], v[100:103], 0
v_and_b32 v191, s49, v191
s_waitcnt lgkmcnt(6)
v_mfma_f32_16x16x32_f16 v[68:71], v[220:223], v[208:211], v[68:71]
ds_read_b128 v[216:219], v248 offset:36864
v_exp_f16_e64 v198, v199
v_bfe_u32 v188, v189, 2, 14
v_mfma_f32_16x16x32_f16 v[76:79], v[220:223], v[212:215], v[76:79]
v_bfe_u32 v190, v191, 2, 14
v_exp_f16_e64 v195, v196
v_mfma_f32_16x16x32_bf16 v[168:171], v[224:227], v[104:107], v[168:171]
ds_read_b128 v[220:223], v248 offset:37120
ds_read_u16_d16 v188, v188
ds_read_u16_d16 v190, v190
v_lshrrev_b32 v189, 18, v189
v_lshrrev_b32 v191, 18, v191
v_mfma_f32_16x16x32_bf16 v[176:179], v[224:227], v[108:111], v[176:179]
v_exp_f16_sdwa v201, v202 dst_sel:WORD_1 dst_unused:UNUSED_PRESERVE src0_sel:WORD_1
v_mfma_f32_16x16x32_f16 v[80:83], v[228:231], v[208:211], v[80:83]
ds_read_b128 v[224:227], v249 offset:36864
ds_read_u16_d16_hi v189, v189
ds_read_u16_d16_hi v191, v191
v_and_b32 v193, s49, v193
v_bfe_u32 v192, v193, 2, 14
v_mfma_f32_16x16x32_f16 v[88:91], v[228:231], v[212:215], v[88:91]
v_exp_f16_sdwa v198, v199 dst_sel:WORD_1 dst_unused:UNUSED_PRESERVE src0_sel:WORD_1
s_waitcnt lgkmcnt(7)
v_mfma_f32_16x16x32_f16 v[84:87], v[232:235], v[208:211], v[84:87]
ds_read_b128 v[228:231], v249 offset:37120
ds_read_u16_d16 v192, v192
v_lshrrev_b32_e64 v193, 18, v193
v_mfma_f32_16x16x32_f16 v[92:95], v[232:235], v[212:215], v[92:95]
v_exp_f16_sdwa v195, v196 dst_sel:WORD_1 dst_unused:UNUSED_PRESERVE src0_sel:WORD_1
v_pk_add_f16 v201, v201, 1.0 op_sel_hi:[1,0]
v_pk_add_f16 v198, v198, 1.0 op_sel_hi:[1,0]
v_mfma_f32_16x16x32_bf16 v[172:175], v[236:239], v[104:107], v[172:175]
ds_read_b128 v[232:235], v248 offset:40960
ds_read_u16_d16_hi v193, v193
v_pk_add_f16 v195, v195, 1.0 op_sel_hi:[1,0]
v_mfma_f32_16x16x32_bf16 v[180:183], v[236:239], v[108:111], v[180:183]
v_rcp_f16_e64 v202, v201
s_setprio 0
s_waitcnt lgkmcnt(7)
v_mfma_f32_16x16x32_bf16 v[168:171], v[216:219], v[112:115], v[168:171]
ds_read_b128 v[236:239], v249 offset:37888
v_rcp_f16_e64 v199, v198
v_mfma_f32_16x16x32_bf16 v[176:179], v[216:219], v[116:119], v[176:179]
v_rcp_f16_e64 v196, v195
v_mfma_f32_16x16x32_bf16 v[172:175], v[220:223], v[112:115], v[172:175]
ds_read_b128 v[216:219], v248 offset:41216
v_rcp_f16_sdwa v202, v201 dst_sel:WORD_1 dst_unused:UNUSED_PRESERVE src0_sel:WORD_1
v_mfma_f32_16x16x32_bf16 v[180:183], v[220:223], v[116:119], v[180:183]
v_rcp_f16_sdwa v199, v198 dst_sel:WORD_1 dst_unused:UNUSED_PRESERVE src0_sel:WORD_1
v_or_b32 v208, v184, v185
v_or_b32 v209, v186, v187
s_waitcnt lgkmcnt(4)
v_or_b32 v210, v188, v189
v_rcp_f16_sdwa v196, v195 dst_sel:WORD_1 dst_unused:UNUSED_PRESERVE src0_sel:WORD_1
v_or_b32 v211, v190, v191
s_waitcnt lgkmcnt(2)
v_or_b32 v212, v192, v193
v_pk_mul_f16 v213, v203, v202
v_pk_mul_f16 v214, v200, v199
v_pk_mul_f16 v215, v197, v196
s_setprio 3
v_mfma_f32_16x16x32_f16 v[48:51], v[224:227], v[208:211], v[48:51]
s_add_u32 s46, s71, 98304
buffer_store_dwordx4 v[148:151], v255, s[8:11], s46 offen offset:128 sc1
ds_read_b128 v[220:223], v249 offset:38144
v_cvt_pkrtz_f16_f32 v185, v168, v169
v_cvt_pkrtz_f16_f32 v187, v170, v171
v_mfma_f32_16x16x32_f16 v[56:59], v[224:227], v[212:215], v[56:59]
v_cvt_pkrtz_f16_f32 v189, v172, v173
v_cvt_pkrtz_f16_f32 v191, v174, v175
v_mfma_f32_16x16x32_f16 v[52:55], v[228:231], v[208:211], v[52:55]
ds_read_b128 v[224:227], v248 offset:41984
v_cvt_pkrtz_f16_f32 v193, v176, v177
v_cvt_pk_f16_f32 v203, v178, v179
v_mfma_f32_16x16x32_f16 v[60:63], v[228:231], v[212:215], v[60:63]
v_cvt_pk_f16_f32 v200, v180, v181
v_cvt_pk_f16_f32 v197, v182, v183
v_mfma_f32_16x16x32_bf16 v[168:171], v[232:235], v[96:99], 0
ds_read_b128 v[228:231], v249 offset:38912
v_pk_fma_f16 v202, v203, v203, s48
v_and_b32_e64 v185, s49, v185
v_mfma_f32_16x16x32_bf16 v[176:179], v[232:235], v[100:103], 0
v_pk_fma_f16 v199, v200, v200, s48
v_and_b32 v187, s49, v187
s_waitcnt lgkmcnt(3)
v_mfma_f32_16x16x32_f16 v[64:67], v[236:239], v[208:211], v[64:67]
ds_read_b128 v[232:235], v249 offset:39168
v_pk_fma_f16 v196, v197, v197, s48
v_bfe_u32 v184, v185, 2, 14
v_pk_mul_f16 v202, v203, v202
v_mfma_f32_16x16x32_f16 v[72:75], v[236:239], v[212:215], v[72:75]
v_bfe_u32 v186, v187, 2, 14
v_pk_mul_f16 v199, v200, v199
s_waitcnt vmcnt(9)
v_mfma_f32_16x16x32_bf16 v[64:67], v[18:21], v[8:11], v[64:67]
ds_read_b128 v[236:239], v248 offset:42240
ds_read_u16_d16 v184, v184
ds_read_u16_d16 v186, v186
v_lshrrev_b32 v185, 18, v185
v_pk_mul_f16 v196, v197, v196
v_mfma_f32_16x16x32_bf16 v[68:71], v[16:19], v[8:11], v[68:71]
v_lshrrev_b32_e64 v187, 18, v187
v_mfma_f32_16x16x32_bf16 v[172:175], v[216:219], v[96:99], 0
ds_read_u16_d16_hi v185, v185
ds_read_u16_d16_hi v187, v187
v_exp_f16 v201, v202
v_and_b32 v189, s49, v189
v_mfma_f32_16x16x32_bf16 v[180:183], v[216:219], v[100:103], 0
v_and_b32 v191, s49, v191
s_waitcnt lgkmcnt(6)
v_mfma_f32_16x16x32_f16 v[68:71], v[220:223], v[208:211], v[68:71]
ds_read_b128 v[216:219], v248 offset:43008
v_exp_f16_e64 v198, v199
v_bfe_u32 v188, v189, 2, 14
v_mfma_f32_16x16x32_f16 v[76:79], v[220:223], v[212:215], v[76:79]
v_bfe_u32 v190, v191, 2, 14
v_exp_f16_e64 v195, v196
v_mfma_f32_16x16x32_bf16 v[168:171], v[224:227], v[104:107], v[168:171]
ds_read_b128 v[220:223], v248 offset:43264
ds_read_u16_d16 v188, v188
ds_read_u16_d16 v190, v190
v_lshrrev_b32 v189, 18, v189
v_lshrrev_b32 v191, 18, v191
v_mfma_f32_16x16x32_bf16 v[176:179], v[224:227], v[108:111], v[176:179]
v_exp_f16_sdwa v201, v202 dst_sel:WORD_1 dst_unused:UNUSED_PRESERVE src0_sel:WORD_1
v_mfma_f32_16x16x32_f16 v[80:83], v[228:231], v[208:211], v[80:83]
ds_read_b128 v[224:227], v249 offset:43008
ds_read_u16_d16_hi v189, v189
ds_read_u16_d16_hi v191, v191
v_and_b32 v193, s49, v193
v_bfe_u32 v192, v193, 2, 14
v_mfma_f32_16x16x32_f16 v[88:91], v[228:231], v[212:215], v[88:91]
v_exp_f16_sdwa v198, v199 dst_sel:WORD_1 dst_unused:UNUSED_PRESERVE src0_sel:WORD_1
s_waitcnt lgkmcnt(7)
v_mfma_f32_16x16x32_f16 v[84:87], v[232:235], v[208:211], v[84:87]
ds_read_b128 v[228:231], v249 offset:43264
ds_read_u16_d16 v192, v192
v_lshrrev_b32_e64 v193, 18, v193
v_mfma_f32_16x16x32_f16 v[92:95], v[232:235], v[212:215], v[92:95]
v_exp_f16_sdwa v195, v196 dst_sel:WORD_1 dst_unused:UNUSED_PRESERVE src0_sel:WORD_1
v_pk_add_f16 v201, v201, 1.0 op_sel_hi:[1,0]
v_pk_add_f16 v198, v198, 1.0 op_sel_hi:[1,0]
v_mfma_f32_16x16x32_bf16 v[172:175], v[236:239], v[104:107], v[172:175]
ds_read_b128 v[232:235], v248 offset:16384
ds_read_u16_d16_hi v193, v193
v_pk_add_f16 v195, v195, 1.0 op_sel_hi:[1,0]
v_mfma_f32_16x16x32_bf16 v[180:183], v[236:239], v[108:111], v[180:183]
v_rcp_f16 v202, v201
s_waitcnt lgkmcnt(7)
v_mfma_f32_16x16x32_bf16 v[168:171], v[216:219], v[112:115], v[168:171]
ds_read_b128 v[236:239], v249 offset:44032
v_rcp_f16_e64 v199, v198
v_mfma_f32_16x16x32_bf16 v[176:179], v[216:219], v[116:119], v[176:179]
v_rcp_f16_e64 v196, v195
v_mfma_f32_16x16x32_bf16 v[172:175], v[220:223], v[112:115], v[172:175]
ds_read_b128 v[216:219], v248 offset:16640
v_rcp_f16_sdwa v202, v201 dst_sel:WORD_1 dst_unused:UNUSED_PRESERVE src0_sel:WORD_1
v_mfma_f32_16x16x32_bf16 v[180:183], v[220:223], v[116:119], v[180:183]
v_rcp_f16_sdwa v199, v198 dst_sel:WORD_1 dst_unused:UNUSED_PRESERVE src0_sel:WORD_1
v_or_b32 v208, v184, v185
v_or_b32 v209, v186, v187
s_waitcnt lgkmcnt(4)
v_or_b32 v210, v188, v189
v_rcp_f16_sdwa v196, v195 dst_sel:WORD_1 dst_unused:UNUSED_PRESERVE src0_sel:WORD_1
v_or_b32 v211, v190, v191
s_waitcnt lgkmcnt(2)
v_or_b32_e64 v212, v192, v193
v_pk_mul_f16 v213, v203, v202
v_pk_mul_f16 v214, v200, v199
v_pk_mul_f16 v215, v197, v196
v_mfma_f32_16x16x32_f16 v[48:51], v[224:227], v[208:211], v[48:51]
s_add_u32 s46, s71, 98304
buffer_store_dwordx4 v[160:163], v255, s[8:11], s46 offen offset:256 sc1
ds_read_b128 v[220:223], v249 offset:44288
v_cvt_pkrtz_f16_f32 v185, v168, v169
v_cvt_pkrtz_f16_f32 v187, v170, v171
v_mfma_f32_16x16x32_f16 v[56:59], v[224:227], v[212:215], v[56:59]
v_cvt_pkrtz_f16_f32 v189, v172, v173
v_cvt_pkrtz_f16_f32 v191, v174, v175
v_mfma_f32_16x16x32_f16 v[52:55], v[228:231], v[208:211], v[52:55]
ds_read_b128 v[224:227], v248 offset:17408
v_cvt_pkrtz_f16_f32 v193, v176, v177
v_cvt_pk_f16_f32 v203, v178, v179
v_mfma_f32_16x16x32_f16 v[60:63], v[228:231], v[212:215], v[60:63]
v_cvt_pk_f16_f32 v200, v180, v181
v_cvt_pk_f16_f32 v197, v182, v183
v_mfma_f32_16x16x32_bf16 v[168:171], v[232:235], v[24:27], 0
ds_read_b128 v[228:231], v249 offset:45056
v_pk_fma_f16 v202, v203, v203, s48
v_and_b32_e64 v185, s49, v185
v_mfma_f32_16x16x32_bf16 v[176:179], v[232:235], v[28:31], 0
v_pk_fma_f16 v199, v200, v200, s48
v_and_b32 v187, s49, v187
s_waitcnt lgkmcnt(3)
v_mfma_f32_16x16x32_f16 v[64:67], v[236:239], v[208:211], v[64:67]
ds_read_b128 v[232:235], v249 offset:45312
v_pk_fma_f16 v196, v197, v197, s48
s_setprio 2
v_bfe_u32 v184, v185, 2, 14
v_pk_mul_f16 v202, v203, v202
v_mfma_f32_16x16x32_f16 v[72:75], v[236:239], v[212:215], v[72:75]
v_bfe_u32 v186, v187, 2, 14
v_pk_mul_f16 v199, v200, v199
s_waitcnt vmcnt(9)
v_mfma_f32_16x16x32_bf16 v[80:83], v[18:21], v[4:7], v[80:83]
ds_read_b128 v[236:239], v248 offset:17664
ds_read_u16_d16 v184, v184
ds_read_u16_d16 v186, v186
v_lshrrev_b32_e64 v185, 18, v185
v_pk_mul_f16 v196, v197, v196
v_mfma_f32_16x16x32_bf16 v[84:87], v[16:19], v[4:7], v[84:87]
v_lshrrev_b32_e64 v187, 18, v187
v_mfma_f32_16x16x32_bf16 v[172:175], v[216:219], v[24:27], 0
ds_read_u16_d16_hi v185, v185
ds_read_u16_d16_hi v187, v187
v_exp_f16 v201, v202
v_and_b32 v189, s49, v189
v_mfma_f32_16x16x32_bf16 v[180:183], v[216:219], v[28:31], 0
v_and_b32 v191, s49, v191
s_waitcnt lgkmcnt(6)
v_mfma_f32_16x16x32_f16 v[68:71], v[220:223], v[208:211], v[68:71]
ds_read_b128 v[216:219], v248 offset:18432
v_exp_f16_e64 v198, v199
v_bfe_u32 v188, v189, 2, 14
v_mfma_f32_16x16x32_f16 v[76:79], v[220:223], v[212:215], v[76:79]
v_bfe_u32 v190, v191, 2, 14
v_exp_f16_e64 v195, v196
v_mfma_f32_16x16x32_bf16 v[168:171], v[224:227], v[32:35], v[168:171]
s_add_u32 s46, s80, 12582912
buffer_load_dwordx4 v[96:99], v253, s[32:35], s46 offen
ds_read_b128 v[220:223], v248 offset:18688
ds_read_u16_d16 v188, v188
ds_read_u16_d16 v190, v190
v_lshrrev_b32 v189, 18, v189
v_lshrrev_b32 v191, 18, v191
v_mfma_f32_16x16x32_bf16 v[176:179], v[224:227], v[36:39], v[176:179]
v_exp_f16_sdwa v201, v202 dst_sel:WORD_1 dst_unused:UNUSED_PRESERVE src0_sel:WORD_1
v_mfma_f32_16x16x32_f16 v[80:83], v[228:231], v[208:211], v[80:83]
ds_read_b128 v[224:227], v249 offset:49152
ds_read_u16_d16_hi v189, v189
ds_read_u16_d16_hi v191, v191
v_and_b32 v193, s49, v193
v_bfe_u32 v192, v193, 2, 14
v_mfma_f32_16x16x32_f16 v[88:91], v[228:231], v[212:215], v[88:91]
v_exp_f16_sdwa v198, v199 dst_sel:WORD_1 dst_unused:UNUSED_PRESERVE src0_sel:WORD_1
s_waitcnt lgkmcnt(7)
v_mfma_f32_16x16x32_f16 v[84:87], v[232:235], v[208:211], v[84:87]
ds_read_b128 v[228:231], v249 offset:49408
ds_read_u16_d16 v192, v192
v_lshrrev_b32_e64 v193, 18, v193
v_mfma_f32_16x16x32_f16 v[92:95], v[232:235], v[212:215], v[92:95]
v_exp_f16_sdwa v195, v196 dst_sel:WORD_1 dst_unused:UNUSED_PRESERVE src0_sel:WORD_1
v_pk_add_f16 v201, v201, 1.0 op_sel_hi:[1,0]
v_pk_add_f16 v198, v198, 1.0 op_sel_hi:[1,0]
v_mfma_f32_16x16x32_bf16 v[172:175], v[236:239], v[32:35], v[172:175]
ds_read_b128 v[232:235], v248 offset:22528
ds_read_u16_d16_hi v193, v193
v_pk_add_f16 v195, v195, 1.0 op_sel_hi:[1,0]
v_mfma_f32_16x16x32_bf16 v[180:183], v[236:239], v[36:39], v[180:183]
v_rcp_f16 v202, v201
s_waitcnt lgkmcnt(7)
v_mfma_f32_16x16x32_bf16 v[168:171], v[216:219], v[40:43], v[168:171]
ds_read_b128 v[236:239], v249 offset:50176
v_rcp_f16_e64 v199, v198
v_mfma_f32_16x16x32_bf16 v[176:179], v[216:219], v[44:47], v[176:179]
v_rcp_f16_e64 v196, v195
v_mfma_f32_16x16x32_bf16 v[172:175], v[220:223], v[40:43], v[172:175]
ds_read_b128 v[216:219], v248 offset:22784
v_rcp_f16_sdwa v202, v201 dst_sel:WORD_1 dst_unused:UNUSED_PRESERVE src0_sel:WORD_1
v_mfma_f32_16x16x32_bf16 v[180:183], v[220:223], v[44:47], v[180:183]
v_rcp_f16_sdwa v199, v198 dst_sel:WORD_1 dst_unused:UNUSED_PRESERVE src0_sel:WORD_1
v_or_b32 v208, v184, v185
v_or_b32 v209, v186, v187
s_waitcnt lgkmcnt(4)
v_or_b32 v210, v188, v189
v_rcp_f16_sdwa v196, v195 dst_sel:WORD_1 dst_unused:UNUSED_PRESERVE src0_sel:WORD_1
v_or_b32 v211, v190, v191
s_waitcnt lgkmcnt(2)
v_or_b32_e64 v212, v192, v193
v_pk_mul_f16 v213, v203, v202
v_pk_mul_f16 v214, v200, v199
v_pk_mul_f16 v215, v197, v196
v_mfma_f32_16x16x32_f16 v[48:51], v[224:227], v[208:211], v[48:51]
ds_read_b128 v[220:223], v249 offset:50432
v_cvt_pkrtz_f16_f32 v185, v168, v169
v_cvt_pkrtz_f16_f32 v187, v170, v171
v_mfma_f32_16x16x32_f16 v[56:59], v[224:227], v[212:215], v[56:59]
v_cvt_pkrtz_f16_f32 v189, v172, v173
v_cvt_pkrtz_f16_f32 v191, v174, v175
v_mfma_f32_16x16x32_f16 v[52:55], v[228:231], v[208:211], v[52:55]
ds_read_b128 v[224:227], v248 offset:23552
v_cvt_pkrtz_f16_f32 v193, v176, v177
v_cvt_pk_f16_f32 v203, v178, v179
v_mfma_f32_16x16x32_f16 v[60:63], v[228:231], v[212:215], v[60:63]
v_cvt_pk_f16_f32 v200, v180, v181
v_cvt_pk_f16_f32 v197, v182, v183
s_setprio 1
v_mfma_f32_16x16x32_bf16 v[168:171], v[232:235], v[24:27], 0
ds_read_b128 v[228:231], v249 offset:51200
v_pk_fma_f16 v202, v203, v203, s48
v_and_b32 v185, s49, v185
v_mfma_f32_16x16x32_bf16 v[176:179], v[232:235], v[28:31], 0
v_pk_fma_f16 v199, v200, v200, s48
v_and_b32 v187, s49, v187
s_waitcnt lgkmcnt(3)
v_mfma_f32_16x16x32_f16 v[64:67], v[236:239], v[208:211], v[64:67]
ds_read_b128 v[232:235], v249 offset:51456
v_pk_fma_f16 v196, v197, v197, s48
v_bfe_u32 v184, v185, 2, 14
v_pk_mul_f16 v202, v203, v202
v_mfma_f32_16x16x32_f16 v[72:75], v[236:239], v[212:215], v[72:75]
v_bfe_u32 v186, v187, 2, 14
v_pk_mul_f16 v199, v200, v199
s_waitcnt vmcnt(9)
v_mfma_f32_16x16x32_bf16 v[56:59], v[18:21], v[0:3], v[56:59]
ds_read_b128 v[236:239], v248 offset:23808
ds_read_u16_d16 v184, v184
ds_read_u16_d16 v186, v186
v_lshrrev_b32 v185, 18, v185
v_pk_mul_f16 v196, v197, v196
v_mfma_f32_16x16x32_bf16 v[60:63], v[16:19], v[0:3], v[60:63]
v_lshrrev_b32_e64 v187, 18, v187
v_mfma_f32_16x16x32_bf16 v[172:175], v[216:219], v[24:27], 0
ds_read_u16_d16_hi v185, v185
ds_read_u16_d16_hi v187, v187
v_exp_f16 v201, v202
v_and_b32 v189, s49, v189
v_mfma_f32_16x16x32_bf16 v[180:183], v[216:219], v[28:31], 0
v_and_b32 v191, s49, v191
s_waitcnt lgkmcnt(6)
v_mfma_f32_16x16x32_f16 v[68:71], v[220:223], v[208:211], v[68:71]
ds_read_b128 v[216:219], v248 offset:24576
v_exp_f16_e64 v198, v199
v_bfe_u32 v188, v189, 2, 14
v_mfma_f32_16x16x32_f16 v[76:79], v[220:223], v[212:215], v[76:79]
v_bfe_u32 v190, v191, 2, 14
v_exp_f16_e64 v195, v196
v_mfma_f32_16x16x32_bf16 v[168:171], v[224:227], v[32:35], v[168:171]
ds_read_b128 v[220:223], v248 offset:24832
ds_read_u16_d16 v188, v188
ds_read_u16_d16 v190, v190
v_lshrrev_b32 v189, 18, v189
v_lshrrev_b32 v191, 18, v191
v_mfma_f32_16x16x32_bf16 v[176:179], v[224:227], v[36:39], v[176:179]
v_exp_f16_sdwa v201, v202 dst_sel:WORD_1 dst_unused:UNUSED_PRESERVE src0_sel:WORD_1
v_mfma_f32_16x16x32_f16 v[80:83], v[228:231], v[208:211], v[80:83]
ds_read_b128 v[224:227], v249 offset:24576
ds_read_u16_d16_hi v189, v189
ds_read_u16_d16_hi v191, v191
v_and_b32 v193, s49, v193
v_bfe_u32 v192, v193, 2, 14
v_mfma_f32_16x16x32_f16 v[88:91], v[228:231], v[212:215], v[88:91]
v_exp_f16_sdwa v198, v199 dst_sel:WORD_1 dst_unused:UNUSED_PRESERVE src0_sel:WORD_1
s_waitcnt lgkmcnt(7)
v_mfma_f32_16x16x32_f16 v[84:87], v[232:235], v[208:211], v[84:87]
ds_read_b128 v[228:231], v254 offset:7936
ds_read_u16_d16 v192, v192
v_lshrrev_b32_e64 v193, 18, v193
v_mfma_f32_16x16x32_f16 v[92:95], v[232:235], v[212:215], v[92:95]
v_exp_f16_sdwa v195, v196 dst_sel:WORD_1 dst_unused:UNUSED_PRESERVE src0_sel:WORD_1
v_pk_add_f16 v201, v201, 1.0 op_sel_hi:[1,0]
v_pk_add_f16 v198, v198, 1.0 op_sel_hi:[1,0]
v_mfma_f32_16x16x32_bf16 v[172:175], v[236:239], v[32:35], v[172:175]
ds_read_b128 v[232:235], v249 offset:24832
ds_read_u16_d16_hi v193, v193
v_pk_add_f16 v195, v195, 1.0 op_sel_hi:[1,0]
v_mfma_f32_16x16x32_bf16 v[180:183], v[236:239], v[36:39], v[180:183]
v_rcp_f16_e64 v202, v201
s_setprio 0
s_waitcnt lgkmcnt(7)
v_mfma_f32_16x16x32_bf16 v[168:171], v[216:219], v[40:43], v[168:171]
ds_read_b128 v[236:239], v254 offset:7952
v_rcp_f16_e64 v199, v198
v_mfma_f32_16x16x32_bf16 v[176:179], v[216:219], v[44:47], v[176:179]
v_rcp_f16_e64 v196, v195
v_mfma_f32_16x16x32_bf16 v[172:175], v[220:223], v[40:43], v[172:175]
ds_read_b128 v[216:219], v248 offset:28672
v_rcp_f16_sdwa v202, v201 dst_sel:WORD_1 dst_unused:UNUSED_PRESERVE src0_sel:WORD_1
v_mfma_f32_16x16x32_bf16 v[180:183], v[220:223], v[44:47], v[180:183]
v_rcp_f16_sdwa v199, v198 dst_sel:WORD_1 dst_unused:UNUSED_PRESERVE src0_sel:WORD_1
v_or_b32 v208, v184, v185
v_or_b32 v209, v186, v187
s_waitcnt lgkmcnt(4)
v_or_b32 v210, v188, v189
v_rcp_f16_sdwa v196, v195 dst_sel:WORD_1 dst_unused:UNUSED_PRESERVE src0_sel:WORD_1
v_or_b32 v211, v190, v191
s_waitcnt lgkmcnt(2)
v_or_b32_e64 v212, v192, v193
v_pk_mul_f16 v213, v203, v202
v_pk_mul_f16 v214, v200, v199
v_pk_mul_f16 v215, v197, v196
s_setprio 3
v_mfma_f32_16x16x32_f16 v[120:123], v[224:227], v[208:211], v[228:231]
s_add_u32 s46, s80, 12582912
buffer_load_dwordx4 v[100:103], v253, s[32:35], s46 offen offset:256
ds_read_b128 v[220:223], v249 offset:25600
v_cvt_pkrtz_f16_f32 v185, v168, v169
v_cvt_pkrtz_f16_f32 v187, v170, v171
v_mfma_f32_16x16x32_f16 v[128:131], v[224:227], v[212:215], v[228:231]
v_cvt_pkrtz_f16_f32 v189, v172, v173
v_cvt_pkrtz_f16_f32 v191, v174, v175
s_waitcnt lgkmcnt(1)
v_mfma_f32_16x16x32_f16 v[124:127], v[232:235], v[208:211], v[236:239]
ds_read_b128 v[224:227], v254 offset:8064
ds_read_b128 v[228:231], v248 offset:28928
v_cvt_pkrtz_f16_f32 v193, v176, v177
v_cvt_pk_f16_f32 v203, v178, v179
v_mfma_f32_16x16x32_f16 v[132:135], v[232:235], v[212:215], v[236:239]
v_cvt_pk_f16_f32 v200, v180, v181
v_cvt_pk_f16_f32 v197, v182, v183
v_mfma_f32_16x16x32_bf16 v[168:171], v[216:219], v[24:27], 0
ds_read_b128 v[232:235], v249 offset:25856
ds_read_b128 v[236:239], v254 offset:8080
v_pk_fma_f16 v202, v203, v203, s48
v_and_b32_e64 v185, s49, v185
v_mfma_f32_16x16x32_bf16 v[176:179], v[216:219], v[28:31], 0
v_pk_fma_f16 v199, v200, v200, s48
v_and_b32 v187, s49, v187
s_waitcnt lgkmcnt(3)
v_mfma_f32_16x16x32_f16 v[136:139], v[220:223], v[208:211], v[224:227]
ds_read_b128 v[216:219], v248 offset:29696
v_pk_fma_f16 v196, v197, v197, s48
v_bfe_u32 v184, v185, 2, 14
v_pk_mul_f16 v202, v203, v202
v_mfma_f32_16x16x32_f16 v[144:147], v[220:223], v[212:215], v[224:227]
v_bfe_u32 v186, v187, 2, 14
v_pk_mul_f16 v199, v200, v199
s_waitcnt vmcnt(7)
v_mfma_f32_16x16x32_bf16 v[72:75], v[18:21], v[244:247], v[72:75]
ds_read_b128 v[220:223], v249 offset:26624
ds_read_b128 v[224:227], v254 offset:16128
ds_read_u16_d16 v184, v184
ds_read_u16_d16 v186, v186
v_lshrrev_b32 v185, 18, v185
v_pk_mul_f16 v196, v197, v196
v_mfma_f32_16x16x32_bf16 v[76:79], v[16:19], v[244:247], v[76:79]
v_lshrrev_b32 v187, 18, v187
s_waitcnt lgkmcnt(5)
v_mfma_f32_16x16x32_bf16 v[172:175], v[228:231], v[24:27], 0
ds_read_u16_d16_hi v185, v185
ds_read_u16_d16_hi v187, v187
v_exp_f16 v201, v202
v_and_b32 v189, s49, v189
v_mfma_f32_16x16x32_bf16 v[180:183], v[228:231], v[28:31], 0
v_and_b32_e64 v191, s49, v191
v_mfma_f32_16x16x32_f16 v[140:143], v[232:235], v[208:211], v[236:239]
ds_read_b128 v[228:231], v249 offset:26880
v_exp_f16_e64 v198, v199
v_bfe_u32 v188, v189, 2, 14
v_mfma_f32_16x16x32_f16 v[148:151], v[232:235], v[212:215], v[236:239]
v_bfe_u32 v190, v191, 2, 14
v_exp_f16 v195, v196
s_waitcnt lgkmcnt(7)
v_mfma_f32_16x16x32_bf16 v[168:171], v[216:219], v[32:35], v[168:171]
ds_read_b128 v[232:235], v254 offset:16144
ds_read_b128 v[236:239], v248 offset:29952
ds_read_u16_d16 v188, v188
ds_read_u16_d16 v190, v190
v_lshrrev_b32_e64 v189, 18, v189
v_lshrrev_b32 v191, 18, v191
v_mfma_f32_16x16x32_bf16 v[176:179], v[216:219], v[36:39], v[176:179]
v_exp_f16_sdwa v201, v202 dst_sel:WORD_1 dst_unused:UNUSED_PRESERVE src0_sel:WORD_1
s_waitcnt lgkmcnt(7)
v_mfma_f32_16x16x32_f16 v[152:155], v[220:223], v[208:211], v[224:227]
ds_read_b128 v[216:219], v248 offset:30720
ds_read_u16_d16_hi v189, v189
ds_read_u16_d16_hi v191, v191
v_and_b32 v193, s49, v193
v_bfe_u32 v192, v193, 2, 14
v_mfma_f32_16x16x32_f16 v[160:163], v[220:223], v[212:215], v[224:227]
v_exp_f16_sdwa v198, v199 dst_sel:WORD_1 dst_unused:UNUSED_PRESERVE src0_sel:WORD_1
s_waitcnt lgkmcnt(6)
v_mfma_f32_16x16x32_f16 v[156:159], v[228:231], v[208:211], v[232:235]
ds_read_b128 v[220:223], v248 offset:30976
ds_read_b128 v[224:227], v249 offset:30720
ds_read_u16_d16 v192, v192
v_lshrrev_b32 v193, 18, v193
v_mfma_f32_16x16x32_f16 v[164:167], v[228:231], v[212:215], v[232:235]
v_exp_f16_sdwa v195, v196 dst_sel:WORD_1 dst_unused:UNUSED_PRESERVE src0_sel:WORD_1
v_pk_add_f16 v201, v201, 1.0 op_sel_hi:[1,0]
v_pk_add_f16 v198, v198, 1.0 op_sel_hi:[1,0]
s_waitcnt lgkmcnt(7)
v_mfma_f32_16x16x32_bf16 v[172:175], v[236:239], v[32:35], v[172:175]
ds_read_b128 v[228:231], v249 offset:30976
ds_read_b128 v[232:235], v248 offset:34816
ds_read_u16_d16_hi v193, v193
v_pk_add_f16 v195, v195, 1.0 op_sel_hi:[1,0]
v_mfma_f32_16x16x32_bf16 v[180:183], v[236:239], v[36:39], v[180:183]
v_rcp_f16 v202, v201
s_waitcnt lgkmcnt(8)
v_mfma_f32_16x16x32_bf16 v[168:171], v[216:219], v[40:43], v[168:171]
ds_read_b128 v[236:239], v249 offset:31744
v_rcp_f16_e64 v199, v198
v_mfma_f32_16x16x32_bf16 v[176:179], v[216:219], v[44:47], v[176:179]
v_rcp_f16 v196, v195
s_waitcnt lgkmcnt(6)
v_mfma_f32_16x16x32_bf16 v[172:175], v[220:223], v[40:43], v[172:175]
ds_read_b128 v[216:219], v248 offset:35072
v_rcp_f16_sdwa v202, v201 dst_sel:WORD_1 dst_unused:UNUSED_PRESERVE src0_sel:WORD_1
v_mfma_f32_16x16x32_bf16 v[180:183], v[220:223], v[44:47], v[180:183]
v_rcp_f16_sdwa v199, v198 dst_sel:WORD_1 dst_unused:UNUSED_PRESERVE src0_sel:WORD_1
v_or_b32 v208, v184, v185
v_or_b32 v209, v186, v187
v_or_b32_e64 v210, v188, v189
v_rcp_f16_sdwa v196, v195 dst_sel:WORD_1 dst_unused:UNUSED_PRESERVE src0_sel:WORD_1
v_or_b32 v211, v190, v191
s_waitcnt lgkmcnt(2)
v_or_b32_e64 v212, v192, v193
v_pk_mul_f16 v213, v203, v202
v_pk_mul_f16 v214, v200, v199
v_pk_mul_f16 v215, v197, v196
v_mfma_f32_16x16x32_f16 v[120:123], v[224:227], v[208:211], v[120:123]
ds_read_b128 v[220:223], v249 offset:32000
v_cvt_pkrtz_f16_f32 v185, v168, v169
v_cvt_pkrtz_f16_f32 v187, v170, v171
v_cvt_pkrtz_f16_f32 v189, v172, v173
v_mfma_f32_16x16x32_f16 v[128:131], v[224:227], v[212:215], v[128:131]
v_cvt_pkrtz_f16_f32 v191, v174, v175
v_cvt_pkrtz_f16_f32 v193, v176, v177
v_cvt_pk_f16_f32 v203, v178, v179
v_mfma_f32_16x16x32_f16 v[124:127], v[228:231], v[208:211], v[124:127]
ds_read_b128 v[224:227], v248 offset:35840
v_cvt_pk_f16_f32 v200, v180, v181
v_cvt_pk_f16_f32 v197, v182, v183
v_pk_fma_f16 v202, v203, v203, s48
v_mfma_f32_16x16x32_f16 v[132:135], v[228:231], v[212:215], v[132:135]
v_cvt_pk_bf16_f32 v64, v64, v65
v_and_b32_e64 v185, s49, v185
v_cvt_pk_bf16_f32 v65, v66, v67
v_mfma_f32_16x16x32_bf16 v[168:171], v[232:235], v[24:27], 0
ds_read_b128 v[228:231], v249 offset:32768
v_pk_fma_f16 v199, v200, v200, s48
v_and_b32_e64 v187, s49, v187
v_cvt_pk_bf16_f32 v66, v68, v69
v_mfma_f32_16x16x32_bf16 v[176:179], v[232:235], v[28:31], 0
v_pk_fma_f16 v196, v197, v197, s48
v_cvt_pk_bf16_f32 v67, v70, v71
v_bfe_u32 v184, v185, 2, 14
s_setprio 2
s_waitcnt lgkmcnt(2)
v_mfma_f32_16x16x32_f16 v[136:139], v[236:239], v[208:211], v[136:139]
ds_read_b128 v[232:235], v249 offset:33024
ds_read_u16_d16 v184, v184
v_pk_mul_f16 v202, v203, v202
v_cvt_pk_bf16_f32 v48, v48, v49
v_bfe_u32 v186, v187, 2, 14
v_mfma_f32_16x16x32_f16 v[144:147], v[236:239], v[212:215], v[144:147]
v_cvt_pk_bf16_f32 v49, v50, v51
v_pk_mul_f16 v199, v200, v199
v_lshrrev_b32 v185, 18, v185
s_waitcnt vmcnt(6)
v_mfma_f32_16x16x32_bf16 v[88:91], v[18:21], v[204:207], v[88:91]
ds_read_b128 v[236:239], v248 offset:36096
ds_read_u16_d16 v186, v186
ds_read_u16_d16_hi v185, v185
v_cvt_pk_bf16_f32 v50, v52, v53
v_pk_mul_f16 v196, v197, v196
v_lshrrev_b32_e64 v187, 18, v187
v_mfma_f32_16x16x32_bf16 v[92:95], v[16:19], v[204:207], v[92:95]
v_cvt_pk_bf16_f32 v51, v54, v55
v_exp_f16_e64 v201, v202
v_mfma_f32_16x16x32_bf16 v[172:175], v[216:219], v[24:27], 0
ds_read_u16_d16_hi v187, v187
v_cvt_pk_bf16_f32 v80, v80, v81
v_and_b32_e64 v189, s49, v189
v_cvt_pk_bf16_f32 v81, v82, v83
v_mfma_f32_16x16x32_bf16 v[180:183], v[216:219], v[28:31], 0
v_and_b32_e64 v191, s49, v191
v_cvt_pk_bf16_f32 v82, v84, v85
v_mfma_f32_16x16x32_f16 v[140:143], v[220:223], v[208:211], v[140:143]
ds_read_b128 v[216:219], v248 offset:36864
v_exp_f16 v198, v199
v_cvt_pk_bf16_f32 v83, v86, v87
s_mov_b64 vcc, s[74:75]
v_bfe_u32 v188, v189, 2, 14
v_bfe_u32 v190, v191, 2, 14
v_mfma_f32_16x16x32_f16 v[148:151], v[220:223], v[212:215], v[148:151]
v_cndmask_b32 v68, v48, v80, vcc
v_exp_f16_e64 v195, v196
s_waitcnt lgkmcnt(2)
v_mfma_f32_16x16x32_bf16 v[168:171], v[224:227], v[32:35], v[168:171]
ds_read_b128 v[220:223], v248 offset:37120
ds_read_u16_d16 v188, v188
ds_read_u16_d16 v190, v190
v_cndmask_b32 v69, v49, v81, vcc
v_lshrrev_b32_e64 v189, 18, v189
v_cndmask_b32 v70, v50, v82, vcc
v_mfma_f32_16x16x32_bf16 v[176:179], v[224:227], v[36:39], v[176:179]
v_lshrrev_b32 v191, 18, v191
v_cndmask_b32 v71, v51, v83, vcc
v_mfma_f32_16x16x32_f16 v[152:155], v[228:231], v[208:211], v[152:155]
ds_read_b128 v[224:227], v249 offset:36864
ds_read_u16_d16_hi v189, v189
ds_read_u16_d16_hi v191, v191
v_exp_f16_sdwa v201, v202 dst_sel:WORD_1 dst_unused:UNUSED_PRESERVE src0_sel:WORD_1
v_cndmask_b32_dpp v48, v64, v48, vcc quad_perm:[1,0,3,2] row_mask:0xf bank_mask:0xf
v_and_b32_e64 v193, s49, v193
v_mfma_f32_16x16x32_f16 v[160:163], v[228:231], v[212:215], v[160:163]
v_cndmask_b32_dpp v49, v65, v49, vcc quad_perm:[1,0,3,2] row_mask:0xf bank_mask:0xf
v_bfe_u32 v192, v193, 2, 14
v_mfma_f32_16x16x32_f16 v[156:159], v[232:235], v[208:211], v[156:159]
ds_read_b128 v[228:231], v249 offset:37120
ds_read_u16_d16 v192, v192
v_exp_f16_sdwa v198, v199 dst_sel:WORD_1 dst_unused:UNUSED_PRESERVE src0_sel:WORD_1
v_cndmask_b32_dpp v50, v66, v50, vcc quad_perm:[1,0,3,2] row_mask:0xf bank_mask:0xf
v_lshrrev_b32 v193, 18, v193
v_mfma_f32_16x16x32_f16 v[164:167], v[232:235], v[212:215], v[164:167]
v_cndmask_b32_dpp v51, v67, v51, vcc quad_perm:[1,0,3,2] row_mask:0xf bank_mask:0xf
s_not_b64 vcc, s[74:75]
v_exp_f16_sdwa v195, v196 dst_sel:WORD_1 dst_unused:UNUSED_PRESERVE src0_sel:WORD_1
v_mfma_f32_16x16x32_bf16 v[172:175], v[236:239], v[32:35], v[172:175]
ds_read_b128 v[232:235], v248 offset:40960
ds_read_u16_d16_hi v193, v193
v_cndmask_b32_dpp v80, v64, v80, vcc quad_perm:[1,0,3,2] row_mask:0xf bank_mask:0xf
v_pk_add_f16 v201, v201, 1.0 op_sel_hi:[1,0]
v_cndmask_b32_dpp v81, v65, v81, vcc quad_perm:[1,0,3,2] row_mask:0xf bank_mask:0xf
v_mfma_f32_16x16x32_bf16 v[180:183], v[236:239], v[36:39], v[180:183]
v_pk_add_f16 v198, v198, 1.0 op_sel_hi:[1,0]
v_cndmask_b32_dpp v82, v66, v82, vcc quad_perm:[1,0,3,2] row_mask:0xf bank_mask:0xf
v_pk_add_f16 v195, v195, 1.0 op_sel_hi:[1,0]
s_waitcnt lgkmcnt(4)
v_mfma_f32_16x16x32_bf16 v[168:171], v[216:219], v[40:43], v[168:171]
ds_read_b128 v[236:239], v249 offset:37888
v_rcp_f16 v202, v201
v_cndmask_b32_dpp v83, v67, v83, vcc quad_perm:[1,0,3,2] row_mask:0xf bank_mask:0xf
v_mfma_f32_16x16x32_bf16 v[176:179], v[216:219], v[44:47], v[176:179]
v_rcp_f16_e64 v199, v198
v_mfma_f32_16x16x32_bf16 v[172:175], v[220:223], v[40:43], v[172:175]
ds_read_b128 v[216:219], v248 offset:41216
buffer_store_dwordx4 v[48:51], v255, s[8:11], s70 offen sc1
v_rcp_f16_e64 v196, v195
v_rcp_f16_sdwa v202, v201 dst_sel:WORD_1 dst_unused:UNUSED_PRESERVE src0_sel:WORD_1
v_mfma_f32_16x16x32_bf16 v[180:183], v[220:223], v[44:47], v[180:183]
v_rcp_f16_sdwa v199, v198 dst_sel:WORD_1 dst_unused:UNUSED_PRESERVE src0_sel:WORD_1
v_or_b32 v208, v184, v185
v_or_b32 v209, v186, v187
v_or_b32_e64 v210, v188, v189
v_rcp_f16_sdwa v196, v195 dst_sel:WORD_1 dst_unused:UNUSED_PRESERVE src0_sel:WORD_1
v_or_b32 v211, v190, v191
s_waitcnt lgkmcnt(2)
v_or_b32_e64 v212, v192, v193
v_pk_mul_f16 v213, v203, v202
v_pk_mul_f16 v214, v200, v199
v_pk_mul_f16 v215, v197, v196
v_mfma_f32_16x16x32_f16 v[120:123], v[224:227], v[208:211], v[120:123]
s_add_u32 s46, s80, 16777216
buffer_load_dwordx4 v[104:107], v253, s[32:35], s46 offen
ds_read_b128 v[220:223], v249 offset:38144
v_cvt_pkrtz_f16_f32 v185, v168, v169
v_cvt_pkrtz_f16_f32 v187, v170, v171
v_mfma_f32_16x16x32_f16 v[128:131], v[224:227], v[212:215], v[128:131]
v_cvt_pkrtz_f16_f32 v189, v172, v173
v_cvt_pkrtz_f16_f32 v191, v174, v175
v_mfma_f32_16x16x32_f16 v[124:127], v[228:231], v[208:211], v[124:127]
ds_read_b128 v[224:227], v248 offset:41984
v_cvt_pkrtz_f16_f32 v193, v176, v177
v_cvt_pk_f16_f32 v203, v178, v179
v_cvt_pk_f16_f32 v200, v180, v181
v_mfma_f32_16x16x32_f16 v[132:135], v[228:231], v[212:215], v[132:135]
v_cvt_pk_f16_f32 v197, v182, v183
s_setprio 1
v_pk_fma_f16 v202, v203, v203, s48
v_mfma_f32_16x16x32_bf16 v[168:171], v[232:235], v[24:27], 0
ds_read_b128 v[228:231], v249 offset:38912
v_and_b32 v185, s49, v185
v_pk_fma_f16 v199, v200, v200, s48
v_mfma_f32_16x16x32_bf16 v[176:179], v[232:235], v[28:31], 0
v_and_b32 v187, s49, v187
v_pk_fma_f16 v196, v197, v197, s48
v_bfe_u32 v184, v185, 2, 14
s_waitcnt lgkmcnt(3)
v_mfma_f32_16x16x32_f16 v[136:139], v[236:239], v[208:211], v[136:139]
ds_read_b128 v[232:235], v249 offset:39168
ds_read_u16_d16 v184, v184
v_pk_mul_f16 v202, v203, v202
v_bfe_u32 v186, v187, 2, 14
v_mfma_f32_16x16x32_f16 v[144:147], v[236:239], v[212:215], v[144:147]
v_pk_mul_f16 v199, v200, v199
v_lshrrev_b32_e64 v185, 18, v185
v_mfma_f32_16x16x32_bf16 v[172:175], v[216:219], v[24:27], 0
ds_read_b128 v[236:239], v248 offset:42240
ds_read_u16_d16 v186, v186
ds_read_u16_d16_hi v185, v185
v_pk_mul_f16 v196, v197, v196
v_lshrrev_b32_e64 v187, 18, v187
v_mfma_f32_16x16x32_bf16 v[180:183], v[216:219], v[28:31], 0
v_exp_f16_e64 v201, v202
v_and_b32 v189, s49, v189
s_waitcnt lgkmcnt(5)
v_mfma_f32_16x16x32_f16 v[140:143], v[220:223], v[208:211], v[140:143]
ds_read_b128 v[216:219], v248 offset:43008
ds_read_u16_d16_hi v187, v187
v_and_b32_e64 v191, s49, v191
v_mfma_f32_16x16x32_f16 v[148:151], v[220:223], v[212:215], v[148:151]
v_exp_f16_e64 v198, v199
v_bfe_u32 v188, v189, 2, 14
v_bfe_u32 v190, v191, 2, 14
v_mfma_f32_16x16x32_bf16 v[168:171], v[224:227], v[32:35], v[168:171]
ds_read_b128 v[220:223], v248 offset:43264
ds_read_u16_d16 v188, v188
ds_read_u16_d16 v190, v190
v_exp_f16_e64 v195, v196
v_mfma_f32_16x16x32_bf16 v[176:179], v[224:227], v[36:39], v[176:179]
v_lshrrev_b32 v189, 18, v189
v_lshrrev_b32 v191, 18, v191
v_mfma_f32_16x16x32_f16 v[152:155], v[228:231], v[208:211], v[152:155]
ds_read_b128 v[224:227], v249 offset:43008
ds_read_u16_d16_hi v189, v189
ds_read_u16_d16_hi v191, v191
v_exp_f16_sdwa v201, v202 dst_sel:WORD_1 dst_unused:UNUSED_PRESERVE src0_sel:WORD_1
v_and_b32 v193, s49, v193
v_mfma_f32_16x16x32_f16 v[160:163], v[228:231], v[212:215], v[160:163]
v_bfe_u32 v192, v193, 2, 14
s_waitcnt lgkmcnt(8)
v_mfma_f32_16x16x32_f16 v[156:159], v[232:235], v[208:211], v[156:159]
ds_read_b128 v[228:231], v249 offset:43264
ds_read_u16_d16 v192, v192
v_exp_f16_sdwa v198, v199 dst_sel:WORD_1 dst_unused:UNUSED_PRESERVE src0_sel:WORD_1
v_lshrrev_b32_e64 v193, 18, v193
v_mfma_f32_16x16x32_f16 v[164:167], v[232:235], v[212:215], v[164:167]
v_exp_f16_sdwa v195, v196 dst_sel:WORD_1 dst_unused:UNUSED_PRESERVE src0_sel:WORD_1
v_pk_add_f16 v201, v201, 1.0 op_sel_hi:[1,0]
v_mfma_f32_16x16x32_bf16 v[172:175], v[236:239], v[32:35], v[172:175]
ds_read_b128 v[232:235], v248 offset:47104
ds_read_u16_d16_hi v193, v193
v_pk_add_f16 v198, v198, 1.0 op_sel_hi:[1,0]
v_pk_add_f16 v195, v195, 1.0 op_sel_hi:[1,0]
v_mfma_f32_16x16x32_bf16 v[180:183], v[236:239], v[36:39], v[180:183]
v_rcp_f16_e64 v202, v201
s_setprio 0
s_waitcnt lgkmcnt(7)
v_mfma_f32_16x16x32_bf16 v[168:171], v[216:219], v[40:43], v[168:171]
ds_read_b128 v[236:239], v249 offset:44032
v_rcp_f16_e64 v199, v198
v_mfma_f32_16x16x32_bf16 v[176:179], v[216:219], v[44:47], v[176:179]
v_rcp_f16_e64 v196, v195
v_mfma_f32_16x16x32_bf16 v[172:175], v[220:223], v[40:43], v[172:175]
ds_read_b128 v[216:219], v248 offset:47360
v_rcp_f16_sdwa v202, v201 dst_sel:WORD_1 dst_unused:UNUSED_PRESERVE src0_sel:WORD_1
v_mfma_f32_16x16x32_bf16 v[180:183], v[220:223], v[44:47], v[180:183]
v_rcp_f16_sdwa v199, v198 dst_sel:WORD_1 dst_unused:UNUSED_PRESERVE src0_sel:WORD_1
v_or_b32 v208, v184, v185
v_or_b32 v209, v186, v187
s_waitcnt lgkmcnt(4)
v_or_b32 v210, v188, v189
v_rcp_f16_sdwa v196, v195 dst_sel:WORD_1 dst_unused:UNUSED_PRESERVE src0_sel:WORD_1
v_or_b32 v211, v190, v191
s_waitcnt lgkmcnt(2)
v_or_b32 v212, v192, v193
v_pk_mul_f16 v213, v203, v202
v_pk_mul_f16 v214, v200, v199
v_pk_mul_f16 v215, v197, v196
s_setprio 3
v_mfma_f32_16x16x32_f16 v[120:123], v[224:227], v[208:211], v[120:123]
buffer_store_dwordx4 v[68:71], v255, s[8:11], s70 offen offset:128 sc1
ds_read_b128 v[220:223], v249 offset:44288
v_cvt_pkrtz_f16_f32 v185, v168, v169
v_cvt_pkrtz_f16_f32 v187, v170, v171
v_mfma_f32_16x16x32_f16 v[128:131], v[224:227], v[212:215], v[128:131]
v_cvt_pkrtz_f16_f32 v189, v172, v173
v_cvt_pkrtz_f16_f32 v191, v174, v175
v_mfma_f32_16x16x32_f16 v[124:127], v[228:231], v[208:211], v[124:127]
ds_read_b128 v[224:227], v248 offset:48128
v_cvt_pkrtz_f16_f32 v193, v176, v177
v_cvt_pk_f16_f32 v203, v178, v179
v_cvt_pk_f16_f32 v200, v180, v181
v_mfma_f32_16x16x32_f16 v[132:135], v[228:231], v[212:215], v[132:135]
v_cvt_pk_f16_f32 v197, v182, v183
v_pk_fma_f16 v202, v203, v203, s48
v_mfma_f32_16x16x32_bf16 v[168:171], v[232:235], v[24:27], 0
ds_read_b128 v[228:231], v249 offset:45056
v_and_b32_e64 v185, s49, v185
v_pk_fma_f16 v199, v200, v200, s48
v_mfma_f32_16x16x32_bf16 v[176:179], v[232:235], v[28:31], 0
v_and_b32 v187, s49, v187
v_pk_fma_f16 v196, v197, v197, s48
v_bfe_u32 v184, v185, 2, 14
s_waitcnt lgkmcnt(3)
v_mfma_f32_16x16x32_f16 v[136:139], v[236:239], v[208:211], v[136:139]
ds_read_b128 v[232:235], v249 offset:45312
ds_read_u16_d16 v184, v184
v_pk_mul_f16 v202, v203, v202
v_bfe_u32 v186, v187, 2, 14
v_mfma_f32_16x16x32_f16 v[144:147], v[236:239], v[212:215], v[144:147]
v_pk_mul_f16 v199, v200, v199
v_lshrrev_b32_e64 v185, 18, v185
v_mfma_f32_16x16x32_bf16 v[172:175], v[216:219], v[24:27], 0
ds_read_b128 v[236:239], v248 offset:48384
ds_read_u16_d16 v186, v186
ds_read_u16_d16_hi v185, v185
v_pk_mul_f16 v196, v197, v196
v_lshrrev_b32_e64 v187, 18, v187
v_mfma_f32_16x16x32_bf16 v[180:183], v[216:219], v[28:31], 0
v_exp_f16_e64 v201, v202
v_and_b32 v189, s49, v189
s_waitcnt lgkmcnt(5)
v_mfma_f32_16x16x32_f16 v[140:143], v[220:223], v[208:211], v[140:143]
ds_read_b128 v[216:219], v248 offset:49152
ds_read_u16_d16_hi v187, v187
v_and_b32_e64 v191, s49, v191
v_mfma_f32_16x16x32_f16 v[148:151], v[220:223], v[212:215], v[148:151]
v_exp_f16_e64 v198, v199
v_bfe_u32 v188, v189, 2, 14
v_bfe_u32 v190, v191, 2, 14
v_mfma_f32_16x16x32_bf16 v[168:171], v[224:227], v[32:35], v[168:171]
ds_read_b128 v[220:223], v248 offset:49408
ds_read_u16_d16 v188, v188
ds_read_u16_d16 v190, v190
v_exp_f16_e64 v195, v196
v_mfma_f32_16x16x32_bf16 v[176:179], v[224:227], v[36:39], v[176:179]
v_lshrrev_b32 v189, 18, v189
v_lshrrev_b32 v191, 18, v191
v_mfma_f32_16x16x32_f16 v[152:155], v[228:231], v[208:211], v[152:155]
ds_read_b128 v[224:227], v249 offset:49152
ds_read_u16_d16_hi v189, v189
ds_read_u16_d16_hi v191, v191
v_exp_f16_sdwa v201, v202 dst_sel:WORD_1 dst_unused:UNUSED_PRESERVE src0_sel:WORD_1
v_and_b32 v193, s49, v193
v_mfma_f32_16x16x32_f16 v[160:163], v[228:231], v[212:215], v[160:163]
v_bfe_u32 v192, v193, 2, 14
s_waitcnt lgkmcnt(8)
v_mfma_f32_16x16x32_f16 v[156:159], v[232:235], v[208:211], v[156:159]
ds_read_b128 v[228:231], v249 offset:49408
ds_read_u16_d16 v192, v192
v_exp_f16_sdwa v198, v199 dst_sel:WORD_1 dst_unused:UNUSED_PRESERVE src0_sel:WORD_1
v_lshrrev_b32_e64 v193, 18, v193
v_mfma_f32_16x16x32_f16 v[164:167], v[232:235], v[212:215], v[164:167]
v_exp_f16_sdwa v195, v196 dst_sel:WORD_1 dst_unused:UNUSED_PRESERVE src0_sel:WORD_1
v_pk_add_f16 v201, v201, 1.0 op_sel_hi:[1,0]
v_mfma_f32_16x16x32_bf16 v[172:175], v[236:239], v[32:35], v[172:175]
ds_read_b128 v[232:235], v248 offset:53248
ds_read_u16_d16_hi v193, v193
v_pk_add_f16 v198, v198, 1.0 op_sel_hi:[1,0]
v_pk_add_f16 v195, v195, 1.0 op_sel_hi:[1,0]
v_mfma_f32_16x16x32_bf16 v[180:183], v[236:239], v[36:39], v[180:183]
v_rcp_f16 v202, v201
s_waitcnt lgkmcnt(7)
v_mfma_f32_16x16x32_bf16 v[168:171], v[216:219], v[40:43], v[168:171]
ds_read_b128 v[236:239], v249 offset:50176
v_rcp_f16_e64 v199, v198
v_mfma_f32_16x16x32_bf16 v[176:179], v[216:219], v[44:47], v[176:179]
v_rcp_f16_e64 v196, v195
v_mfma_f32_16x16x32_bf16 v[172:175], v[220:223], v[40:43], v[172:175]
ds_read_b128 v[216:219], v248 offset:53504
v_rcp_f16_sdwa v202, v201 dst_sel:WORD_1 dst_unused:UNUSED_PRESERVE src0_sel:WORD_1
v_mfma_f32_16x16x32_bf16 v[180:183], v[220:223], v[44:47], v[180:183]
v_rcp_f16_sdwa v199, v198 dst_sel:WORD_1 dst_unused:UNUSED_PRESERVE src0_sel:WORD_1
v_or_b32 v208, v184, v185
v_or_b32 v209, v186, v187
s_waitcnt lgkmcnt(4)
v_or_b32 v210, v188, v189
v_rcp_f16_sdwa v196, v195 dst_sel:WORD_1 dst_unused:UNUSED_PRESERVE src0_sel:WORD_1
v_or_b32 v211, v190, v191
s_waitcnt lgkmcnt(2)
v_or_b32_e64 v212, v192, v193
v_pk_mul_f16 v213, v203, v202
v_pk_mul_f16 v214, v200, v199
v_pk_mul_f16 v215, v197, v196
v_mfma_f32_16x16x32_f16 v[120:123], v[224:227], v[208:211], v[120:123]
s_add_u32 s46, s80, 16777216
buffer_load_dwordx4 v[108:111], v253, s[32:35], s46 offen offset:256
ds_read_b128 v[220:223], v249 offset:50432
v_cvt_pkrtz_f16_f32 v185, v168, v169
v_cvt_pkrtz_f16_f32 v187, v170, v171
v_mfma_f32_16x16x32_f16 v[128:131], v[224:227], v[212:215], v[128:131]
v_cvt_pkrtz_f16_f32 v189, v172, v173
v_cvt_pkrtz_f16_f32 v191, v174, v175
v_mfma_f32_16x16x32_f16 v[124:127], v[228:231], v[208:211], v[124:127]
ds_read_b128 v[224:227], v248 offset:54272
v_cvt_pkrtz_f16_f32 v193, v176, v177
v_cvt_pk_f16_f32 v203, v178, v179
v_cvt_pk_f16_f32 v200, v180, v181
v_mfma_f32_16x16x32_f16 v[132:135], v[228:231], v[212:215], v[132:135]
v_cvt_pk_f16_f32 v197, v182, v183
v_pk_fma_f16 v202, v203, v203, s48
v_mfma_f32_16x16x32_bf16 v[168:171], v[232:235], v[24:27], 0
ds_read_b128 v[228:231], v249 offset:51200
v_and_b32_e64 v185, s49, v185
v_pk_fma_f16 v199, v200, v200, s48
v_mfma_f32_16x16x32_bf16 v[176:179], v[232:235], v[28:31], 0
v_and_b32_e64 v187, s49, v187
v_pk_fma_f16 v196, v197, v197, s48
s_setprio 2
v_bfe_u32 v184, v185, 2, 14
s_waitcnt lgkmcnt(3)
v_mfma_f32_16x16x32_f16 v[136:139], v[236:239], v[208:211], v[136:139]
ds_read_b128 v[232:235], v249 offset:51456
ds_read_u16_d16 v184, v184
v_pk_mul_f16 v202, v203, v202
v_bfe_u32 v186, v187, 2, 14
v_mfma_f32_16x16x32_f16 v[144:147], v[236:239], v[212:215], v[144:147]
v_pk_mul_f16 v199, v200, v199
v_lshrrev_b32_e64 v185, 18, v185
v_mfma_f32_16x16x32_bf16 v[172:175], v[216:219], v[24:27], 0
ds_read_b128 v[236:239], v248 offset:54528
ds_read_u16_d16 v186, v186
ds_read_u16_d16_hi v185, v185
v_pk_mul_f16 v196, v197, v196
v_lshrrev_b32_e64 v187, 18, v187
v_mfma_f32_16x16x32_bf16 v[180:183], v[216:219], v[28:31], 0
v_exp_f16_e64 v201, v202
v_and_b32 v189, s49, v189
s_waitcnt lgkmcnt(5)
v_mfma_f32_16x16x32_f16 v[140:143], v[220:223], v[208:211], v[140:143]
ds_read_b128 v[216:219], v248 offset:55296
ds_read_u16_d16_hi v187, v187
v_and_b32_e64 v191, s49, v191
v_mfma_f32_16x16x32_f16 v[148:151], v[220:223], v[212:215], v[148:151]
v_exp_f16_e64 v198, v199
v_bfe_u32 v188, v189, 2, 14
v_bfe_u32 v190, v191, 2, 14
v_mfma_f32_16x16x32_bf16 v[168:171], v[224:227], v[32:35], v[168:171]
ds_read_b128 v[220:223], v248 offset:55552
ds_read_u16_d16 v188, v188
ds_read_u16_d16 v190, v190
v_exp_f16_e64 v195, v196
v_mfma_f32_16x16x32_bf16 v[176:179], v[224:227], v[36:39], v[176:179]
v_lshrrev_b32 v189, 18, v189
v_lshrrev_b32 v191, 18, v191
v_mfma_f32_16x16x32_f16 v[152:155], v[228:231], v[208:211], v[152:155]
ds_read_b128 v[224:227], v249 offset:55296
ds_read_u16_d16_hi v189, v189
ds_read_u16_d16_hi v191, v191
v_exp_f16_sdwa v201, v202 dst_sel:WORD_1 dst_unused:UNUSED_PRESERVE src0_sel:WORD_1
v_and_b32 v193, s49, v193
v_mfma_f32_16x16x32_f16 v[160:163], v[228:231], v[212:215], v[160:163]
v_bfe_u32 v192, v193, 2, 14
s_waitcnt lgkmcnt(8)
v_mfma_f32_16x16x32_f16 v[156:159], v[232:235], v[208:211], v[156:159]
ds_read_b128 v[228:231], v249 offset:55552
ds_read_u16_d16 v192, v192
v_exp_f16_sdwa v198, v199 dst_sel:WORD_1 dst_unused:UNUSED_PRESERVE src0_sel:WORD_1
v_lshrrev_b32_e64 v193, 18, v193
v_mfma_f32_16x16x32_f16 v[164:167], v[232:235], v[212:215], v[164:167]
v_exp_f16_sdwa v195, v196 dst_sel:WORD_1 dst_unused:UNUSED_PRESERVE src0_sel:WORD_1
v_pk_add_f16 v201, v201, 1.0 op_sel_hi:[1,0]
v_mfma_f32_16x16x32_bf16 v[172:175], v[236:239], v[32:35], v[172:175]
ds_read_b128 v[232:235], v248 offset:59392
ds_read_u16_d16_hi v193, v193
v_pk_add_f16 v198, v198, 1.0 op_sel_hi:[1,0]
v_pk_add_f16 v195, v195, 1.0 op_sel_hi:[1,0]
v_mfma_f32_16x16x32_bf16 v[180:183], v[236:239], v[36:39], v[180:183]
v_rcp_f16 v202, v201
s_waitcnt lgkmcnt(7)
v_mfma_f32_16x16x32_bf16 v[168:171], v[216:219], v[40:43], v[168:171]
ds_read_b128 v[236:239], v249 offset:56320
v_rcp_f16_e64 v199, v198
v_mfma_f32_16x16x32_bf16 v[176:179], v[216:219], v[44:47], v[176:179]
v_rcp_f16_e64 v196, v195
v_mfma_f32_16x16x32_bf16 v[172:175], v[220:223], v[40:43], v[172:175]
ds_read_b128 v[216:219], v248 offset:59648
v_rcp_f16_sdwa v202, v201 dst_sel:WORD_1 dst_unused:UNUSED_PRESERVE src0_sel:WORD_1
v_mfma_f32_16x16x32_bf16 v[180:183], v[220:223], v[44:47], v[180:183]
v_rcp_f16_sdwa v199, v198 dst_sel:WORD_1 dst_unused:UNUSED_PRESERVE src0_sel:WORD_1
v_or_b32 v208, v184, v185
v_or_b32 v209, v186, v187
s_waitcnt lgkmcnt(4)
v_or_b32 v210, v188, v189
v_rcp_f16_sdwa v196, v195 dst_sel:WORD_1 dst_unused:UNUSED_PRESERVE src0_sel:WORD_1
v_or_b32 v211, v190, v191
s_waitcnt lgkmcnt(2)
v_or_b32_e64 v212, v192, v193
v_pk_mul_f16 v213, v203, v202
v_pk_mul_f16 v214, v200, v199
v_pk_mul_f16 v215, v197, v196
v_mfma_f32_16x16x32_f16 v[120:123], v[224:227], v[208:211], v[120:123]
buffer_load_dwordx4 v[204:207], v252, s[4:7], s68 offen
ds_read_b128 v[220:223], v249 offset:56576
v_cvt_pkrtz_f16_f32 v185, v168, v169
v_cvt_pkrtz_f16_f32 v187, v170, v171
v_mfma_f32_16x16x32_f16 v[128:131], v[224:227], v[212:215], v[128:131]
v_cvt_pkrtz_f16_f32 v189, v172, v173
v_cvt_pkrtz_f16_f32 v191, v174, v175
v_mfma_f32_16x16x32_f16 v[124:127], v[228:231], v[208:211], v[124:127]
ds_read_b128 v[224:227], v248 offset:60416
v_cvt_pkrtz_f16_f32 v193, v176, v177
v_cvt_pk_f16_f32 v203, v178, v179
v_cvt_pk_f16_f32 v200, v180, v181
v_mfma_f32_16x16x32_f16 v[132:135], v[228:231], v[212:215], v[132:135]
v_cvt_pk_f16_f32 v197, v182, v183
s_setprio 1
v_pk_fma_f16 v202, v203, v203, s48
v_mfma_f32_16x16x32_bf16 v[168:171], v[232:235], v[24:27], 0
ds_read_b128 v[228:231], v249 offset:57344
v_and_b32 v185, s49, v185
v_pk_fma_f16 v199, v200, v200, s48
v_mfma_f32_16x16x32_bf16 v[176:179], v[232:235], v[28:31], 0
v_and_b32 v187, s49, v187
v_pk_fma_f16 v196, v197, v197, s48
v_bfe_u32 v184, v185, 2, 14
s_waitcnt lgkmcnt(3)
v_mfma_f32_16x16x32_f16 v[136:139], v[236:239], v[208:211], v[136:139]
ds_read_b128 v[232:235], v249 offset:57600
ds_read_u16_d16 v184, v184
v_pk_mul_f16 v202, v203, v202
v_bfe_u32 v186, v187, 2, 14
v_mfma_f32_16x16x32_f16 v[144:147], v[236:239], v[212:215], v[144:147]
v_pk_mul_f16 v199, v200, v199
v_lshrrev_b32_e64 v185, 18, v185
v_mfma_f32_16x16x32_bf16 v[172:175], v[216:219], v[24:27], 0
ds_read_b128 v[236:239], v248 offset:60672
ds_read_u16_d16 v186, v186
ds_read_u16_d16_hi v185, v185
v_pk_mul_f16 v196, v197, v196
v_lshrrev_b32_e64 v187, 18, v187
v_mfma_f32_16x16x32_bf16 v[180:183], v[216:219], v[28:31], 0
v_exp_f16_e64 v201, v202
v_and_b32 v189, s49, v189
s_waitcnt lgkmcnt(5)
v_mfma_f32_16x16x32_f16 v[140:143], v[220:223], v[208:211], v[140:143]
ds_read_b128 v[216:219], v248 offset:61440
ds_read_u16_d16_hi v187, v187
v_and_b32_e64 v191, s49, v191
v_mfma_f32_16x16x32_f16 v[148:151], v[220:223], v[212:215], v[148:151]
v_exp_f16_e64 v198, v199
v_bfe_u32 v188, v189, 2, 14
v_bfe_u32 v190, v191, 2, 14
v_mfma_f32_16x16x32_bf16 v[168:171], v[224:227], v[32:35], v[168:171]
buffer_store_dwordx4 v[80:83], v255, s[8:11], s70 offen offset:256 sc1
ds_read_b128 v[220:223], v248 offset:61696
ds_read_u16_d16 v188, v188
ds_read_u16_d16 v190, v190
v_exp_f16_e64 v195, v196
v_mfma_f32_16x16x32_bf16 v[176:179], v[224:227], v[36:39], v[176:179]
v_lshrrev_b32 v189, 18, v189
v_lshrrev_b32 v191, 18, v191
v_mfma_f32_16x16x32_f16 v[152:155], v[228:231], v[208:211], v[152:155]
ds_read_b128 v[224:227], v249 offset:61440
ds_read_u16_d16_hi v189, v189
ds_read_u16_d16_hi v191, v191
v_exp_f16_sdwa v201, v202 dst_sel:WORD_1 dst_unused:UNUSED_PRESERVE src0_sel:WORD_1
v_and_b32 v193, s49, v193
v_mfma_f32_16x16x32_f16 v[160:163], v[228:231], v[212:215], v[160:163]
v_bfe_u32 v192, v193, 2, 14
s_waitcnt lgkmcnt(8)
v_mfma_f32_16x16x32_f16 v[156:159], v[232:235], v[208:211], v[156:159]
ds_read_b128 v[228:231], v249 offset:61696
ds_read_u16_d16 v192, v192
v_exp_f16_sdwa v198, v199 dst_sel:WORD_1 dst_unused:UNUSED_PRESERVE src0_sel:WORD_1
v_lshrrev_b32_e64 v193, 18, v193
v_mfma_f32_16x16x32_f16 v[164:167], v[232:235], v[212:215], v[164:167]
v_exp_f16_sdwa v195, v196 dst_sel:WORD_1 dst_unused:UNUSED_PRESERVE src0_sel:WORD_1
v_pk_add_f16 v201, v201, 1.0 op_sel_hi:[1,0]
v_mfma_f32_16x16x32_bf16 v[172:175], v[236:239], v[32:35], v[172:175]
ds_read_b128 v[232:235], v249
ds_read_u16_d16_hi v193, v193
v_pk_add_f16 v198, v198, 1.0 op_sel_hi:[1,0]
v_pk_add_f16 v195, v195, 1.0 op_sel_hi:[1,0]
v_mfma_f32_16x16x32_bf16 v[180:183], v[236:239], v[36:39], v[180:183]
v_rcp_f16_e64 v202, v201
s_setprio 0
s_waitcnt lgkmcnt(7)
v_mfma_f32_16x16x32_bf16 v[168:171], v[216:219], v[40:43], v[168:171]
ds_read_b128 v[236:239], v249 offset:62464
v_rcp_f16_e64 v199, v198
v_mfma_f32_16x16x32_bf16 v[176:179], v[216:219], v[44:47], v[176:179]
v_rcp_f16_e64 v196, v195
v_mfma_f32_16x16x32_bf16 v[172:175], v[220:223], v[40:43], v[172:175]
ds_read_b128 v[216:219], v249 offset:256
v_rcp_f16_sdwa v202, v201 dst_sel:WORD_1 dst_unused:UNUSED_PRESERVE src0_sel:WORD_1
v_mfma_f32_16x16x32_bf16 v[180:183], v[220:223], v[44:47], v[180:183]
v_rcp_f16_sdwa v199, v198 dst_sel:WORD_1 dst_unused:UNUSED_PRESERVE src0_sel:WORD_1
v_or_b32 v208, v184, v185
v_or_b32 v209, v186, v187
s_waitcnt lgkmcnt(4)
v_or_b32 v210, v188, v189
v_rcp_f16_sdwa v196, v195 dst_sel:WORD_1 dst_unused:UNUSED_PRESERVE src0_sel:WORD_1
v_or_b32 v211, v190, v191
s_waitcnt lgkmcnt(2)
v_or_b32 v212, v192, v193
v_pk_mul_f16 v213, v203, v202
v_pk_mul_f16 v214, v200, v199
v_pk_mul_f16 v215, v197, v196
s_setprio 3
v_mfma_f32_16x16x32_f16 v[120:123], v[224:227], v[208:211], v[120:123]
buffer_load_dwordx4 v[244:247], v252, s[4:7], s68 offen offset:64
ds_read_b128 v[220:223], v249 offset:62720
v_cvt_pkrtz_f16_f32 v185, v168, v169
v_cvt_pkrtz_f16_f32 v187, v170, v171
v_mfma_f32_16x16x32_f16 v[128:131], v[224:227], v[212:215], v[128:131]
v_cvt_pkrtz_f16_f32 v189, v172, v173
v_cvt_pkrtz_f16_f32 v191, v174, v175
v_mfma_f32_16x16x32_f16 v[124:127], v[228:231], v[208:211], v[124:127]
ds_read_b128 v[224:227], v249 offset:1024
v_cvt_pkrtz_f16_f32 v193, v176, v177
v_cvt_pk_f16_f32 v203, v178, v179
v_cvt_pk_f16_f32 v200, v180, v181
v_mfma_f32_16x16x32_f16 v[132:135], v[228:231], v[212:215], v[132:135]
v_cvt_pk_f16_f32 v197, v182, v183
v_pk_fma_f16 v202, v203, v203, s48
v_mfma_f32_16x16x32_bf16 v[168:171], v[232:235], v[24:27], 0
ds_read_b128 v[228:231], v249 offset:63488
v_and_b32_e64 v185, s49, v185
v_pk_fma_f16 v199, v200, v200, s48
v_mfma_f32_16x16x32_bf16 v[176:179], v[232:235], v[28:31], 0
v_and_b32 v187, s49, v187
v_pk_fma_f16 v196, v197, v197, s48
v_bfe_u32 v184, v185, 2, 14
s_waitcnt lgkmcnt(3)
v_mfma_f32_16x16x32_f16 v[136:139], v[236:239], v[208:211], v[136:139]
ds_read_b128 v[232:235], v249 offset:63744
ds_read_u16_d16 v184, v184
v_pk_mul_f16 v202, v203, v202
v_bfe_u32 v186, v187, 2, 14
v_mfma_f32_16x16x32_f16 v[144:147], v[236:239], v[212:215], v[144:147]
v_pk_mul_f16 v199, v200, v199
v_lshrrev_b32_e64 v185, 18, v185
v_mfma_f32_16x16x32_bf16 v[172:175], v[216:219], v[24:27], 0
ds_read_b128 v[236:239], v249 offset:1280
ds_read_u16_d16 v186, v186
ds_read_u16_d16_hi v185, v185
v_pk_mul_f16 v196, v197, v196
v_lshrrev_b32_e64 v187, 18, v187
v_mfma_f32_16x16x32_bf16 v[180:183], v[216:219], v[28:31], 0
v_exp_f16_e64 v201, v202
v_and_b32 v189, s49, v189
s_waitcnt lgkmcnt(5)
v_mfma_f32_16x16x32_f16 v[140:143], v[220:223], v[208:211], v[140:143]
ds_read_b128 v[216:219], v249 offset:2048
ds_read_u16_d16_hi v187, v187
v_and_b32_e64 v191, s49, v191
v_mfma_f32_16x16x32_f16 v[148:151], v[220:223], v[212:215], v[148:151]
v_exp_f16_e64 v198, v199
v_bfe_u32 v188, v189, 2, 14
v_bfe_u32 v190, v191, 2, 14
v_mfma_f32_16x16x32_bf16 v[168:171], v[224:227], v[32:35], v[168:171]
s_add_u32 s46, s80, 20971520
buffer_load_dwordx4 v[112:115], v253, s[32:35], s46 offen
ds_read_b128 v[220:223], v249 offset:2304
ds_read_u16_d16 v188, v188
ds_read_u16_d16 v190, v190
v_exp_f16_e64 v195, v196
v_mfma_f32_16x16x32_bf16 v[176:179], v[224:227], v[36:39], v[176:179]
v_lshrrev_b32 v189, 18, v189
v_lshrrev_b32 v191, 18, v191
v_mfma_f32_16x16x32_f16 v[152:155], v[228:231], v[208:211], v[152:155]
ds_read_b128 v[224:227], v250 offset:2048
ds_read_u16_d16_hi v189, v189
ds_read_u16_d16_hi v191, v191
v_exp_f16_sdwa v201, v202 dst_sel:WORD_1 dst_unused:UNUSED_PRESERVE src0_sel:WORD_1
v_and_b32 v193, s49, v193
v_mfma_f32_16x16x32_f16 v[160:163], v[228:231], v[212:215], v[160:163]
v_bfe_u32 v192, v193, 2, 14
s_waitcnt lgkmcnt(7)
v_mfma_f32_16x16x32_f16 v[156:159], v[232:235], v[208:211], v[156:159]
ds_read_b128 v[228:231], v250 offset:2304
ds_read_u16_d16 v192, v192
v_exp_f16_sdwa v198, v199 dst_sel:WORD_1 dst_unused:UNUSED_PRESERVE src0_sel:WORD_1
v_lshrrev_b32_e64 v193, 18, v193
v_mfma_f32_16x16x32_f16 v[164:167], v[232:235], v[212:215], v[164:167]
v_exp_f16_sdwa v195, v196 dst_sel:WORD_1 dst_unused:UNUSED_PRESERVE src0_sel:WORD_1
v_pk_add_f16 v201, v201, 1.0 op_sel_hi:[1,0]
v_mfma_f32_16x16x32_bf16 v[172:175], v[236:239], v[32:35], v[172:175]
ds_read_b128 v[232:235], v249 offset:6144
ds_read_u16_d16_hi v193, v193
v_pk_add_f16 v198, v198, 1.0 op_sel_hi:[1,0]
v_pk_add_f16 v195, v195, 1.0 op_sel_hi:[1,0]
v_mfma_f32_16x16x32_bf16 v[180:183], v[236:239], v[36:39], v[180:183]
v_rcp_f16_e64 v202, v201
v_mfma_f32_16x16x32_bf16 v[168:171], v[216:219], v[40:43], v[168:171]
ds_read_b128 v[236:239], v250 offset:3072
v_rcp_f16_e64 v199, v198
v_mfma_f32_16x16x32_bf16 v[176:179], v[216:219], v[44:47], v[176:179]
v_rcp_f16 v196, v195
s_waitcnt lgkmcnt(5)
v_mfma_f32_16x16x32_bf16 v[172:175], v[220:223], v[40:43], v[172:175]
ds_read_b128 v[216:219], v249 offset:6400
v_rcp_f16_sdwa v202, v201 dst_sel:WORD_1 dst_unused:UNUSED_PRESERVE src0_sel:WORD_1
v_mfma_f32_16x16x32_bf16 v[180:183], v[220:223], v[44:47], v[180:183]
v_rcp_f16_sdwa v199, v198 dst_sel:WORD_1 dst_unused:UNUSED_PRESERVE src0_sel:WORD_1
v_or_b32 v208, v184, v185
v_or_b32 v209, v186, v187
v_or_b32_e64 v210, v188, v189
v_rcp_f16_sdwa v196, v195 dst_sel:WORD_1 dst_unused:UNUSED_PRESERVE src0_sel:WORD_1
v_or_b32 v211, v190, v191
s_waitcnt lgkmcnt(2)
v_or_b32_e64 v212, v192, v193
v_pk_mul_f16 v213, v203, v202
v_pk_mul_f16 v214, v200, v199
v_pk_mul_f16 v215, v197, v196
v_mfma_f32_16x16x32_f16 v[120:123], v[224:227], v[208:211], v[120:123]
buffer_load_dwordx4 v[0:3], v252, s[4:7], s68 offen offset:128
ds_read_b128 v[220:223], v250 offset:3328
v_cvt_pkrtz_f16_f32 v185, v168, v169
v_cvt_pkrtz_f16_f32 v187, v170, v171
v_cvt_pkrtz_f16_f32 v189, v172, v173
v_mfma_f32_16x16x32_f16 v[128:131], v[224:227], v[212:215], v[128:131]
v_cvt_pkrtz_f16_f32 v191, v174, v175
v_cvt_pkrtz_f16_f32 v193, v176, v177
v_cvt_pk_f16_f32 v203, v178, v179
v_mfma_f32_16x16x32_f16 v[124:127], v[228:231], v[208:211], v[124:127]
ds_read_b128 v[224:227], v249 offset:7168
v_cvt_pk_f16_f32 v200, v180, v181
v_cvt_pk_f16_f32 v197, v182, v183
v_pk_fma_f16 v202, v203, v203, s48
v_cvt_pk_bf16_f32 v72, v72, v73
v_mfma_f32_16x16x32_f16 v[132:135], v[228:231], v[212:215], v[132:135]
v_and_b32_e64 v185, s49, v185
v_cvt_pk_bf16_f32 v73, v74, v75
v_pk_fma_f16 v199, v200, v200, s48
v_mfma_f32_16x16x32_bf16 v[168:171], v[232:235], v[24:27], 0
ds_read_b128 v[228:231], v250 offset:4096
v_and_b32_e64 v187, s49, v187
v_cvt_pk_bf16_f32 v74, v76, v77
v_pk_fma_f16 v196, v197, v197, s48
v_mfma_f32_16x16x32_bf16 v[176:179], v[232:235], v[28:31], 0
v_cvt_pk_bf16_f32 v75, v78, v79
v_bfe_u32 v184, v185, 2, 14
s_setprio 2
v_pk_mul_f16 v202, v203, v202
v_cvt_pk_bf16_f32 v56, v56, v57
s_waitcnt lgkmcnt(2)
v_mfma_f32_16x16x32_f16 v[136:139], v[236:239], v[208:211], v[136:139]
ds_read_b128 v[232:235], v250 offset:4352
ds_read_u16_d16 v184, v184
v_bfe_u32 v186, v187, 2, 14
v_cvt_pk_bf16_f32 v57, v58, v59
v_pk_mul_f16 v199, v200, v199
v_mfma_f32_16x16x32_f16 v[144:147], v[236:239], v[212:215], v[144:147]
v_lshrrev_b32_e64 v185, 18, v185
v_cvt_pk_bf16_f32 v58, v60, v61
v_pk_mul_f16 v196, v197, v196
v_mfma_f32_16x16x32_bf16 v[172:175], v[216:219], v[24:27], 0
ds_read_b128 v[236:239], v249 offset:7424
ds_read_u16_d16 v186, v186
ds_read_u16_d16_hi v185, v185
v_lshrrev_b32_e64 v187, 18, v187
v_cvt_pk_bf16_f32 v59, v62, v63
v_exp_f16_e64 v201, v202
v_mfma_f32_16x16x32_bf16 v[180:183], v[216:219], v[28:31], 0
v_cvt_pk_bf16_f32 v88, v88, v89
v_and_b32_e64 v189, s49, v189
v_cvt_pk_bf16_f32 v89, v90, v91
v_mfma_f32_16x16x32_f16 v[140:143], v[220:223], v[208:211], v[140:143]
ds_read_b128 v[216:219], v249 offset:8192
ds_read_u16_d16_hi v187, v187
v_and_b32_e64 v191, s49, v191
v_cvt_pk_bf16_f32 v90, v92, v93
v_mfma_f32_16x16x32_f16 v[148:151], v[220:223], v[212:215], v[148:151]
v_exp_f16_e64 v198, v199
v_cvt_pk_bf16_f32 v91, v94, v95
s_mov_b64 vcc, s[74:75]
v_bfe_u32 v188, v189, 2, 14
v_bfe_u32 v190, v191, 2, 14
s_waitcnt lgkmcnt(5)
v_mfma_f32_16x16x32_bf16 v[168:171], v[224:227], v[32:35], v[168:171]
ds_read_b128 v[220:223], v249 offset:8448
ds_read_u16_d16 v188, v188
ds_read_u16_d16 v190, v190
v_cndmask_b32 v76, v56, v88, vcc
v_exp_f16 v195, v196
v_mfma_f32_16x16x32_bf16 v[176:179], v[224:227], v[36:39], v[176:179]
v_cndmask_b32 v77, v57, v89, vcc
v_lshrrev_b32_e64 v189, 18, v189
v_cndmask_b32 v78, v58, v90, vcc
v_mfma_f32_16x16x32_f16 v[152:155], v[228:231], v[208:211], v[152:155]
ds_read_b128 v[224:227], v250 offset:8192
ds_read_u16_d16_hi v189, v189
v_lshrrev_b32 v191, 18, v191
v_cndmask_b32 v79, v59, v91, vcc
v_exp_f16_sdwa v201, v202 dst_sel:WORD_1 dst_unused:UNUSED_PRESERVE src0_sel:WORD_1
v_mfma_f32_16x16x32_f16 v[160:163], v[228:231], v[212:215], v[160:163]
v_cndmask_b32_dpp v56, v72, v56, vcc quad_perm:[1,0,3,2] row_mask:0xf bank_mask:0xf
v_and_b32_e64 v193, s49, v193
v_cndmask_b32_dpp v57, v73, v57, vcc quad_perm:[1,0,3,2] row_mask:0xf bank_mask:0xf
v_mfma_f32_16x16x32_f16 v[156:159], v[232:235], v[208:211], v[156:159]
ds_read_b128 v[228:231], v250 offset:8448
ds_read_u16_d16_hi v191, v191
v_bfe_u32 v192, v193, 2, 14
v_exp_f16_sdwa v198, v199 dst_sel:WORD_1 dst_unused:UNUSED_PRESERVE src0_sel:WORD_1
v_mfma_f32_16x16x32_f16 v[164:167], v[232:235], v[212:215], v[164:167]
v_cndmask_b32_dpp v58, v74, v58, vcc quad_perm:[1,0,3,2] row_mask:0xf bank_mask:0xf
v_lshrrev_b32_e64 v193, 18, v193
v_cndmask_b32_dpp v59, v75, v59, vcc quad_perm:[1,0,3,2] row_mask:0xf bank_mask:0xf
s_not_b64 vcc, s[74:75]
s_waitcnt lgkmcnt(4)
v_mfma_f32_16x16x32_bf16 v[172:175], v[236:239], v[32:35], v[172:175]
ds_read_b128 v[232:235], v249 offset:12288
ds_read_u16_d16 v192, v192
ds_read_u16_d16_hi v193, v193
v_exp_f16_sdwa v195, v196 dst_sel:WORD_1 dst_unused:UNUSED_PRESERVE src0_sel:WORD_1
v_cndmask_b32_dpp v88, v72, v88, vcc quad_perm:[1,0,3,2] row_mask:0xf bank_mask:0xf
v_pk_add_f16 v201, v201, 1.0 op_sel_hi:[1,0]
v_mfma_f32_16x16x32_bf16 v[180:183], v[236:239], v[36:39], v[180:183]
v_cndmask_b32_dpp v89, v73, v89, vcc quad_perm:[1,0,3,2] row_mask:0xf bank_mask:0xf
v_pk_add_f16 v198, v198, 1.0 op_sel_hi:[1,0]
v_cndmask_b32_dpp v90, v74, v90, vcc quad_perm:[1,0,3,2] row_mask:0xf bank_mask:0xf
v_mfma_f32_16x16x32_bf16 v[168:171], v[216:219], v[40:43], v[168:171]
ds_read_b128 v[236:239], v250 offset:9216
v_pk_add_f16 v195, v195, 1.0 op_sel_hi:[1,0]
v_rcp_f16_e64 v202, v201
v_cndmask_b32_dpp v91, v75, v91, vcc quad_perm:[1,0,3,2] row_mask:0xf bank_mask:0xf
v_mfma_f32_16x16x32_bf16 v[176:179], v[216:219], v[44:47], v[176:179]
v_rcp_f16_e64 v199, v198
v_mfma_f32_16x16x32_bf16 v[172:175], v[220:223], v[40:43], v[172:175]
ds_read_b128 v[216:219], v249 offset:12544
s_add_u32 s46, s70, 98304
buffer_store_dwordx4 v[56:59], v255, s[8:11], s46 offen sc1
v_rcp_f16_e64 v196, v195
v_rcp_f16_sdwa v202, v201 dst_sel:WORD_1 dst_unused:UNUSED_PRESERVE src0_sel:WORD_1
v_mfma_f32_16x16x32_bf16 v[180:183], v[220:223], v[44:47], v[180:183]
v_rcp_f16_sdwa v199, v198 dst_sel:WORD_1 dst_unused:UNUSED_PRESERVE src0_sel:WORD_1
v_or_b32 v208, v184, v185
v_or_b32 v209, v186, v187
s_waitcnt lgkmcnt(2)
v_or_b32 v210, v188, v189
v_rcp_f16_sdwa v196, v195 dst_sel:WORD_1 dst_unused:UNUSED_PRESERVE src0_sel:WORD_1
v_or_b32 v211, v190, v191
v_or_b32 v212, v192, v193
v_pk_mul_f16 v213, v203, v202
v_pk_mul_f16 v214, v200, v199
v_pk_mul_f16 v215, v197, v196
v_mfma_f32_16x16x32_f16 v[120:123], v[224:227], v[208:211], v[120:123]
s_add_u32 s46, s68, 98304
buffer_load_dwordx4 v[4:7], v252, s[4:7], s46 offen
ds_read_b128 v[220:223], v250 offset:9472
v_cvt_pkrtz_f16_f32 v185, v168, v169
v_cvt_pkrtz_f16_f32 v187, v170, v171
v_mfma_f32_16x16x32_f16 v[128:131], v[224:227], v[212:215], v[128:131]
v_cvt_pkrtz_f16_f32 v189, v172, v173
v_cvt_pkrtz_f16_f32 v191, v174, v175
v_mfma_f32_16x16x32_f16 v[124:127], v[228:231], v[208:211], v[124:127]
ds_read_b128 v[224:227], v249 offset:13312
v_cvt_pkrtz_f16_f32 v193, v176, v177
v_cvt_pk_f16_f32 v203, v178, v179
v_cvt_pk_f16_f32 v200, v180, v181
v_mfma_f32_16x16x32_f16 v[132:135], v[228:231], v[212:215], v[132:135]
v_cvt_pk_f16_f32 v197, v182, v183
s_setprio 1
v_pk_fma_f16 v202, v203, v203, s48
v_mfma_f32_16x16x32_bf16 v[168:171], v[232:235], v[24:27], 0
ds_read_b128 v[228:231], v250 offset:10240
v_and_b32 v185, s49, v185
v_pk_fma_f16 v199, v200, v200, s48
v_mfma_f32_16x16x32_bf16 v[176:179], v[232:235], v[28:31], 0
v_and_b32 v187, s49, v187
v_pk_fma_f16 v196, v197, v197, s48
v_bfe_u32 v184, v185, 2, 14
s_waitcnt lgkmcnt(3)
v_mfma_f32_16x16x32_f16 v[136:139], v[236:239], v[208:211], v[136:139]
ds_read_b128 v[232:235], v250 offset:10496
ds_read_u16_d16 v184, v184
v_pk_mul_f16 v202, v203, v202
v_bfe_u32 v186, v187, 2, 14
v_mfma_f32_16x16x32_f16 v[144:147], v[236:239], v[212:215], v[144:147]
v_pk_mul_f16 v199, v200, v199
v_lshrrev_b32_e64 v185, 18, v185
v_mfma_f32_16x16x32_bf16 v[172:175], v[216:219], v[24:27], 0
ds_read_b128 v[236:239], v249 offset:13568
ds_read_u16_d16 v186, v186
ds_read_u16_d16_hi v185, v185
v_pk_mul_f16 v196, v197, v196
v_lshrrev_b32_e64 v187, 18, v187
v_mfma_f32_16x16x32_bf16 v[180:183], v[216:219], v[28:31], 0
v_exp_f16_e64 v201, v202
v_and_b32 v189, s49, v189
s_waitcnt lgkmcnt(5)
v_mfma_f32_16x16x32_f16 v[140:143], v[220:223], v[208:211], v[140:143]
ds_read_b128 v[216:219], v249 offset:14336
ds_read_u16_d16_hi v187, v187
v_and_b32_e64 v191, s49, v191
v_mfma_f32_16x16x32_f16 v[148:151], v[220:223], v[212:215], v[148:151]
v_exp_f16_e64 v198, v199
v_bfe_u32 v188, v189, 2, 14
v_bfe_u32 v190, v191, 2, 14
v_mfma_f32_16x16x32_bf16 v[168:171], v[224:227], v[32:35], v[168:171]
s_add_u32 s46, s80, 20971520
buffer_load_dwordx4 v[116:119], v253, s[32:35], s46 offen offset:256
ds_read_b128 v[220:223], v249 offset:14592
ds_read_u16_d16 v188, v188
ds_read_u16_d16 v190, v190
v_exp_f16_e64 v195, v196
v_mfma_f32_16x16x32_bf16 v[176:179], v[224:227], v[36:39], v[176:179]
v_lshrrev_b32 v189, 18, v189
v_lshrrev_b32 v191, 18, v191
v_mfma_f32_16x16x32_f16 v[152:155], v[228:231], v[208:211], v[152:155]
ds_read_b128 v[224:227], v250 offset:14336
ds_read_u16_d16_hi v189, v189
ds_read_u16_d16_hi v191, v191
v_exp_f16_sdwa v201, v202 dst_sel:WORD_1 dst_unused:UNUSED_PRESERVE src0_sel:WORD_1
v_and_b32 v193, s49, v193
v_mfma_f32_16x16x32_f16 v[160:163], v[228:231], v[212:215], v[160:163]
v_bfe_u32 v192, v193, 2, 14
s_waitcnt lgkmcnt(7)
v_mfma_f32_16x16x32_f16 v[156:159], v[232:235], v[208:211], v[156:159]
ds_read_b128 v[228:231], v250 offset:14592
ds_read_u16_d16 v192, v192
v_exp_f16_sdwa v198, v199 dst_sel:WORD_1 dst_unused:UNUSED_PRESERVE src0_sel:WORD_1
v_lshrrev_b32_e64 v193, 18, v193
v_mfma_f32_16x16x32_f16 v[164:167], v[232:235], v[212:215], v[164:167]
v_exp_f16_sdwa v195, v196 dst_sel:WORD_1 dst_unused:UNUSED_PRESERVE src0_sel:WORD_1
v_pk_add_f16 v201, v201, 1.0 op_sel_hi:[1,0]
v_mfma_f32_16x16x32_bf16 v[172:175], v[236:239], v[32:35], v[172:175]
ds_read_b128 v[232:235], v249 offset:18432
ds_read_u16_d16_hi v193, v193
v_pk_add_f16 v198, v198, 1.0 op_sel_hi:[1,0]
v_pk_add_f16 v195, v195, 1.0 op_sel_hi:[1,0]
v_mfma_f32_16x16x32_bf16 v[180:183], v[236:239], v[36:39], v[180:183]
v_rcp_f16 v202, v201
s_setprio 0
v_mfma_f32_16x16x32_bf16 v[168:171], v[216:219], v[40:43], v[168:171]
ds_read_b128 v[236:239], v250 offset:15360
v_rcp_f16_e64 v199, v198
v_mfma_f32_16x16x32_bf16 v[176:179], v[216:219], v[44:47], v[176:179]
v_rcp_f16 v196, v195
s_waitcnt lgkmcnt(5)
v_mfma_f32_16x16x32_bf16 v[172:175], v[220:223], v[40:43], v[172:175]
ds_read_b128 v[216:219], v249 offset:18688
v_rcp_f16_sdwa v202, v201 dst_sel:WORD_1 dst_unused:UNUSED_PRESERVE src0_sel:WORD_1
v_mfma_f32_16x16x32_bf16 v[180:183], v[220:223], v[44:47], v[180:183]
v_rcp_f16_sdwa v199, v198 dst_sel:WORD_1 dst_unused:UNUSED_PRESERVE src0_sel:WORD_1
v_or_b32 v208, v184, v185
v_or_b32 v209, v186, v187
v_or_b32_e64 v210, v188, v189
v_rcp_f16_sdwa v196, v195 dst_sel:WORD_1 dst_unused:UNUSED_PRESERVE src0_sel:WORD_1
v_or_b32 v211, v190, v191
s_waitcnt lgkmcnt(2)
v_or_b32 v212, v192, v193
v_pk_mul_f16 v213, v203, v202
v_pk_mul_f16 v214, v200, v199
v_pk_mul_f16 v215, v197, v196
s_setprio 3
v_mfma_f32_16x16x32_f16 v[120:123], v[224:227], v[208:211], v[120:123]
s_add_u32 s46, s68, 98304
buffer_load_dwordx4 v[8:11], v252, s[4:7], s46 offen offset:64
ds_read_b128 v[220:223], v250 offset:15616
v_cvt_pkrtz_f16_f32 v185, v168, v169
v_cvt_pkrtz_f16_f32 v187, v170, v171
v_mfma_f32_16x16x32_f16 v[128:131], v[224:227], v[212:215], v[128:131]
v_cvt_pkrtz_f16_f32 v189, v172, v173
v_cvt_pkrtz_f16_f32 v191, v174, v175
v_mfma_f32_16x16x32_f16 v[124:127], v[228:231], v[208:211], v[124:127]
ds_read_b128 v[224:227], v249 offset:19456
v_cvt_pkrtz_f16_f32 v193, v176, v177
v_cvt_pk_f16_f32 v203, v178, v179
v_cvt_pk_f16_f32 v200, v180, v181
v_mfma_f32_16x16x32_f16 v[132:135], v[228:231], v[212:215], v[132:135]
v_cvt_pk_f16_f32 v197, v182, v183
v_pk_fma_f16 v202, v203, v203, s48
v_mfma_f32_16x16x32_bf16 v[168:171], v[232:235], v[24:27], 0
ds_read_b128 v[228:231], v250 offset:16384
v_and_b32_e64 v185, s49, v185
v_pk_fma_f16 v199, v200, v200, s48
v_mfma_f32_16x16x32_bf16 v[176:179], v[232:235], v[28:31], 0
v_and_b32 v187, s49, v187
v_pk_fma_f16 v196, v197, v197, s48
v_bfe_u32 v184, v185, 2, 14
s_waitcnt lgkmcnt(3)
v_mfma_f32_16x16x32_f16 v[136:139], v[236:239], v[208:211], v[136:139]
ds_read_b128 v[232:235], v250 offset:16640
ds_read_u16_d16 v184, v184
v_pk_mul_f16 v202, v203, v202
v_bfe_u32 v186, v187, 2, 14
v_mfma_f32_16x16x32_f16 v[144:147], v[236:239], v[212:215], v[144:147]
v_pk_mul_f16 v199, v200, v199
v_lshrrev_b32_e64 v185, 18, v185
v_mfma_f32_16x16x32_bf16 v[172:175], v[216:219], v[24:27], 0
ds_read_b128 v[236:239], v249 offset:19712
ds_read_u16_d16 v186, v186
ds_read_u16_d16_hi v185, v185
v_pk_mul_f16 v196, v197, v196
v_lshrrev_b32_e64 v187, 18, v187
v_mfma_f32_16x16x32_bf16 v[180:183], v[216:219], v[28:31], 0
v_exp_f16_e64 v201, v202
v_and_b32 v189, s49, v189
s_waitcnt lgkmcnt(5)
v_mfma_f32_16x16x32_f16 v[140:143], v[220:223], v[208:211], v[140:143]
ds_read_b128 v[216:219], v249 offset:20480
ds_read_u16_d16_hi v187, v187
v_and_b32_e64 v191, s49, v191
v_mfma_f32_16x16x32_f16 v[148:151], v[220:223], v[212:215], v[148:151]
v_exp_f16_e64 v198, v199
v_bfe_u32 v188, v189, 2, 14
v_bfe_u32 v190, v191, 2, 14
v_mfma_f32_16x16x32_bf16 v[168:171], v[224:227], v[32:35], v[168:171]
s_add_u32 s46, s70, 98304
buffer_store_dwordx4 v[76:79], v255, s[8:11], s46 offen offset:128 sc1
ds_read_b128 v[220:223], v249 offset:20736
ds_read_u16_d16 v188, v188
ds_read_u16_d16 v190, v190
v_exp_f16_e64 v195, v196
v_mfma_f32_16x16x32_bf16 v[176:179], v[224:227], v[36:39], v[176:179]
v_lshrrev_b32 v189, 18, v189
v_lshrrev_b32 v191, 18, v191
v_mfma_f32_16x16x32_f16 v[152:155], v[228:231], v[208:211], v[152:155]
ds_read_b128 v[224:227], v250 offset:20480
ds_read_u16_d16_hi v189, v189
ds_read_u16_d16_hi v191, v191
v_exp_f16_sdwa v201, v202 dst_sel:WORD_1 dst_unused:UNUSED_PRESERVE src0_sel:WORD_1
v_and_b32 v193, s49, v193
v_mfma_f32_16x16x32_f16 v[160:163], v[228:231], v[212:215], v[160:163]
v_bfe_u32 v192, v193, 2, 14
s_waitcnt lgkmcnt(7)
v_mfma_f32_16x16x32_f16 v[156:159], v[232:235], v[208:211], v[156:159]
ds_read_b128 v[228:231], v250 offset:20736
ds_read_u16_d16 v192, v192
v_exp_f16_sdwa v198, v199 dst_sel:WORD_1 dst_unused:UNUSED_PRESERVE src0_sel:WORD_1
v_lshrrev_b32_e64 v193, 18, v193
v_mfma_f32_16x16x32_f16 v[164:167], v[232:235], v[212:215], v[164:167]
v_exp_f16_sdwa v195, v196 dst_sel:WORD_1 dst_unused:UNUSED_PRESERVE src0_sel:WORD_1
v_pk_add_f16 v201, v201, 1.0 op_sel_hi:[1,0]
v_mfma_f32_16x16x32_bf16 v[172:175], v[236:239], v[32:35], v[172:175]
ds_read_b128 v[232:235], v248 offset:16384
ds_read_u16_d16_hi v193, v193
v_pk_add_f16 v198, v198, 1.0 op_sel_hi:[1,0]
v_pk_add_f16 v195, v195, 1.0 op_sel_hi:[1,0]
v_mfma_f32_16x16x32_bf16 v[180:183], v[236:239], v[36:39], v[180:183]
v_rcp_f16_e64 v202, v201
v_mfma_f32_16x16x32_bf16 v[168:171], v[216:219], v[40:43], v[168:171]
ds_read_b128 v[236:239], v250 offset:21504
v_rcp_f16_e64 v199, v198
v_mfma_f32_16x16x32_bf16 v[176:179], v[216:219], v[44:47], v[176:179]
v_rcp_f16 v196, v195
s_waitcnt lgkmcnt(5)
v_mfma_f32_16x16x32_bf16 v[172:175], v[220:223], v[40:43], v[172:175]
ds_read_b128 v[216:219], v248 offset:16640
v_rcp_f16_sdwa v202, v201 dst_sel:WORD_1 dst_unused:UNUSED_PRESERVE src0_sel:WORD_1
v_mfma_f32_16x16x32_bf16 v[180:183], v[220:223], v[44:47], v[180:183]
v_rcp_f16_sdwa v199, v198 dst_sel:WORD_1 dst_unused:UNUSED_PRESERVE src0_sel:WORD_1
v_or_b32 v208, v184, v185
v_or_b32 v209, v186, v187
v_or_b32_e64 v210, v188, v189
v_rcp_f16_sdwa v196, v195 dst_sel:WORD_1 dst_unused:UNUSED_PRESERVE src0_sel:WORD_1
v_or_b32 v211, v190, v191
s_waitcnt lgkmcnt(2)
v_or_b32_e64 v212, v192, v193
v_pk_mul_f16 v213, v203, v202
v_pk_mul_f16 v214, v200, v199
v_pk_mul_f16 v215, v197, v196
v_mfma_f32_16x16x32_f16 v[120:123], v[224:227], v[208:211], v[120:123]
ds_read_b128 v[220:223], v250 offset:21760
v_cvt_pkrtz_f16_f32 v185, v168, v169
v_cvt_pkrtz_f16_f32 v187, v170, v171
v_mfma_f32_16x16x32_f16 v[128:131], v[224:227], v[212:215], v[128:131]
v_cvt_pkrtz_f16_f32 v189, v172, v173
v_cvt_pkrtz_f16_f32 v191, v174, v175
v_mfma_f32_16x16x32_f16 v[124:127], v[228:231], v[208:211], v[124:127]
ds_read_b128 v[224:227], v248 offset:17408
v_cvt_pkrtz_f16_f32 v193, v176, v177
v_cvt_pk_f16_f32 v203, v178, v179
v_mfma_f32_16x16x32_f16 v[132:135], v[228:231], v[212:215], v[132:135]
v_cvt_pk_f16_f32 v200, v180, v181
v_cvt_pk_f16_f32 v197, v182, v183
s_waitcnt vmcnt(15)
v_mfma_f32_16x16x32_bf16 v[168:171], v[232:235], v[96:99], 0
ds_read_b128 v[228:231], v250 offset:22528
v_pk_fma_f16 v202, v203, v203, s48
v_and_b32_e64 v185, s49, v185
s_waitcnt vmcnt(14)
v_mfma_f32_16x16x32_bf16 v[176:179], v[232:235], v[100:103], 0
v_pk_fma_f16 v199, v200, v200, s48
v_and_b32 v187, s49, v187
s_waitcnt lgkmcnt(3)
v_mfma_f32_16x16x32_f16 v[136:139], v[236:239], v[208:211], v[136:139]
ds_read_b128 v[232:235], v250 offset:22784
v_pk_fma_f16 v196, v197, v197, s48
s_setprio 2
v_bfe_u32 v184, v185, 2, 14
v_pk_mul_f16 v202, v203, v202
v_mfma_f32_16x16x32_f16 v[144:147], v[236:239], v[212:215], v[144:147]
v_bfe_u32 v186, v187, 2, 14
v_pk_mul_f16 v199, v200, v199
s_waitcnt vmcnt(9)
v_mfma_f32_16x16x32_bf16 v[120:123], v[18:21], v[204:207], v[120:123]
ds_read_b128 v[236:239], v248 offset:17664
ds_read_u16_d16 v184, v184
ds_read_u16_d16 v186, v186
v_lshrrev_b32_e64 v185, 18, v185
v_pk_mul_f16 v196, v197, v196
v_mfma_f32_16x16x32_bf16 v[124:127], v[16:19], v[204:207], v[124:127]
v_lshrrev_b32_e64 v187, 18, v187
v_mfma_f32_16x16x32_bf16 v[172:175], v[216:219], v[96:99], 0
ds_read_u16_d16_hi v185, v185
ds_read_u16_d16_hi v187, v187
v_exp_f16 v201, v202
v_and_b32 v189, s49, v189
v_mfma_f32_16x16x32_bf16 v[180:183], v[216:219], v[100:103], 0
v_and_b32 v191, s49, v191
s_waitcnt lgkmcnt(6)
v_mfma_f32_16x16x32_f16 v[140:143], v[220:223], v[208:211], v[140:143]
ds_read_b128 v[216:219], v248 offset:18432
v_exp_f16_e64 v198, v199
v_bfe_u32 v188, v189, 2, 14
v_mfma_f32_16x16x32_f16 v[148:151], v[220:223], v[212:215], v[148:151]
v_bfe_u32 v190, v191, 2, 14
v_exp_f16_e64 v195, v196
v_mfma_f32_16x16x32_bf16 v[168:171], v[224:227], v[104:107], v[168:171]
ds_read_b128 v[220:223], v248 offset:18688
ds_read_u16_d16 v188, v188
ds_read_u16_d16 v190, v190
v_lshrrev_b32 v189, 18, v189
v_lshrrev_b32 v191, 18, v191
v_mfma_f32_16x16x32_bf16 v[176:179], v[224:227], v[108:111], v[176:179]
v_exp_f16_sdwa v201, v202 dst_sel:WORD_1 dst_unused:UNUSED_PRESERVE src0_sel:WORD_1
v_mfma_f32_16x16x32_f16 v[152:155], v[228:231], v[208:211], v[152:155]
ds_read_b128 v[224:227], v250 offset:26624
ds_read_u16_d16_hi v189, v189
ds_read_u16_d16_hi v191, v191
v_and_b32 v193, s49, v193
v_bfe_u32 v192, v193, 2, 14
v_mfma_f32_16x16x32_f16 v[160:163], v[228:231], v[212:215], v[160:163]
v_exp_f16_sdwa v198, v199 dst_sel:WORD_1 dst_unused:UNUSED_PRESERVE src0_sel:WORD_1
s_waitcnt lgkmcnt(7)
v_mfma_f32_16x16x32_f16 v[156:159], v[232:235], v[208:211], v[156:159]
ds_read_b128 v[228:231], v250 offset:26880
ds_read_u16_d16 v192, v192
v_lshrrev_b32_e64 v193, 18, v193
v_mfma_f32_16x16x32_f16 v[164:167], v[232:235], v[212:215], v[164:167]
v_exp_f16_sdwa v195, v196 dst_sel:WORD_1 dst_unused:UNUSED_PRESERVE src0_sel:WORD_1
v_pk_add_f16 v201, v201, 1.0 op_sel_hi:[1,0]
v_pk_add_f16 v198, v198, 1.0 op_sel_hi:[1,0]
v_mfma_f32_16x16x32_bf16 v[172:175], v[236:239], v[104:107], v[172:175]
ds_read_b128 v[232:235], v248 offset:22528
ds_read_u16_d16_hi v193, v193
v_pk_add_f16 v195, v195, 1.0 op_sel_hi:[1,0]
v_mfma_f32_16x16x32_bf16 v[180:183], v[236:239], v[108:111], v[180:183]
v_rcp_f16 v202, v201
s_waitcnt vmcnt(6) lgkmcnt(7)
v_mfma_f32_16x16x32_bf16 v[168:171], v[216:219], v[112:115], v[168:171]
ds_read_b128 v[236:239], v250 offset:27648
v_rcp_f16 v199, v198
s_waitcnt vmcnt(2)
v_mfma_f32_16x16x32_bf16 v[176:179], v[216:219], v[116:119], v[176:179]
v_rcp_f16_e64 v196, v195
v_mfma_f32_16x16x32_bf16 v[172:175], v[220:223], v[112:115], v[172:175]
ds_read_b128 v[216:219], v248 offset:22784
v_rcp_f16_sdwa v202, v201 dst_sel:WORD_1 dst_unused:UNUSED_PRESERVE src0_sel:WORD_1
v_mfma_f32_16x16x32_bf16 v[180:183], v[220:223], v[116:119], v[180:183]
v_rcp_f16_sdwa v199, v198 dst_sel:WORD_1 dst_unused:UNUSED_PRESERVE src0_sel:WORD_1
v_or_b32 v208, v184, v185
v_or_b32 v209, v186, v187
s_waitcnt lgkmcnt(4)
v_or_b32 v210, v188, v189
v_rcp_f16_sdwa v196, v195 dst_sel:WORD_1 dst_unused:UNUSED_PRESERVE src0_sel:WORD_1
v_or_b32 v211, v190, v191
s_waitcnt lgkmcnt(2)
v_or_b32_e64 v212, v192, v193
v_pk_mul_f16 v213, v203, v202
v_pk_mul_f16 v214, v200, v199
v_pk_mul_f16 v215, v197, v196
v_mfma_f32_16x16x32_f16 v[120:123], v[224:227], v[208:211], v[120:123]
s_add_u32 s46, s68, 98304
buffer_load_dwordx4 v[204:207], v252, s[4:7], s46 offen offset:128
ds_read_b128 v[220:223], v250 offset:27904
v_cvt_pkrtz_f16_f32 v185, v168, v169
v_cvt_pkrtz_f16_f32 v187, v170, v171
v_mfma_f32_16x16x32_f16 v[128:131], v[224:227], v[212:215], v[128:131]
v_cvt_pkrtz_f16_f32 v189, v172, v173
v_cvt_pkrtz_f16_f32 v191, v174, v175
v_mfma_f32_16x16x32_f16 v[124:127], v[228:231], v[208:211], v[124:127]
ds_read_b128 v[224:227], v248 offset:23552
v_cvt_pkrtz_f16_f32 v193, v176, v177
v_cvt_pk_f16_f32 v203, v178, v179
v_mfma_f32_16x16x32_f16 v[132:135], v[228:231], v[212:215], v[132:135]
v_cvt_pk_f16_f32 v200, v180, v181
v_cvt_pk_f16_f32 v197, v182, v183
s_setprio 1
v_mfma_f32_16x16x32_bf16 v[168:171], v[232:235], v[96:99], 0
ds_read_b128 v[228:231], v250 offset:28672
v_pk_fma_f16 v202, v203, v203, s48
v_and_b32 v185, s49, v185
v_mfma_f32_16x16x32_bf16 v[176:179], v[232:235], v[100:103], 0
v_pk_fma_f16 v199, v200, v200, s48
v_and_b32 v187, s49, v187
s_waitcnt lgkmcnt(3)
v_mfma_f32_16x16x32_f16 v[136:139], v[236:239], v[208:211], v[136:139]
ds_read_b128 v[232:235], v250 offset:28928
v_pk_fma_f16 v196, v197, v197, s48
v_bfe_u32 v184, v185, 2, 14
v_pk_mul_f16 v202, v203, v202
v_mfma_f32_16x16x32_f16 v[144:147], v[236:239], v[212:215], v[144:147]
v_bfe_u32 v186, v187, 2, 14
v_pk_mul_f16 v199, v200, v199
v_mfma_f32_16x16x32_bf16 v[136:139], v[18:21], v[244:247], v[136:139]
ds_read_b128 v[236:239], v248 offset:23808
ds_read_u16_d16 v184, v184
ds_read_u16_d16 v186, v186
v_lshrrev_b32_e64 v185, 18, v185
v_pk_mul_f16 v196, v197, v196
v_mfma_f32_16x16x32_bf16 v[140:143], v[16:19], v[244:247], v[140:143]
v_lshrrev_b32_e64 v187, 18, v187
v_mfma_f32_16x16x32_bf16 v[172:175], v[216:219], v[96:99], 0
ds_read_u16_d16_hi v185, v185
ds_read_u16_d16_hi v187, v187
v_exp_f16 v201, v202
v_and_b32 v189, s49, v189
v_mfma_f32_16x16x32_bf16 v[180:183], v[216:219], v[100:103], 0
v_and_b32 v191, s49, v191
s_waitcnt lgkmcnt(6)
v_mfma_f32_16x16x32_f16 v[140:143], v[220:223], v[208:211], v[140:143]
ds_read_b128 v[216:219], v248 offset:24576
v_exp_f16_e64 v198, v199
v_bfe_u32 v188, v189, 2, 14
v_mfma_f32_16x16x32_f16 v[148:151], v[220:223], v[212:215], v[148:151]
v_bfe_u32 v190, v191, 2, 14
v_exp_f16_e64 v195, v196
v_mfma_f32_16x16x32_bf16 v[168:171], v[224:227], v[104:107], v[168:171]
s_add_u32 s46, s70, 98304
buffer_store_dwordx4 v[88:91], v255, s[8:11], s46 offen offset:256 sc1
ds_read_b128 v[220:223], v248 offset:24832
ds_read_u16_d16 v188, v188
ds_read_u16_d16 v190, v190
v_lshrrev_b32 v189, 18, v189
v_lshrrev_b32 v191, 18, v191
v_mfma_f32_16x16x32_bf16 v[176:179], v[224:227], v[108:111], v[176:179]
v_exp_f16_sdwa v201, v202 dst_sel:WORD_1 dst_unused:UNUSED_PRESERVE src0_sel:WORD_1
v_mfma_f32_16x16x32_f16 v[152:155], v[228:231], v[208:211], v[152:155]
ds_read_b128 v[224:227], v249 offset:24576
ds_read_u16_d16_hi v189, v189
ds_read_u16_d16_hi v191, v191
v_and_b32 v193, s49, v193
v_bfe_u32 v192, v193, 2, 14
v_mfma_f32_16x16x32_f16 v[160:163], v[228:231], v[212:215], v[160:163]
v_exp_f16_sdwa v198, v199 dst_sel:WORD_1 dst_unused:UNUSED_PRESERVE src0_sel:WORD_1
s_waitcnt lgkmcnt(7)
v_mfma_f32_16x16x32_f16 v[156:159], v[232:235], v[208:211], v[156:159]
ds_read_b128 v[228:231], v254 offset:7936
ds_read_u16_d16 v192, v192
v_lshrrev_b32_e64 v193, 18, v193
v_mfma_f32_16x16x32_f16 v[164:167], v[232:235], v[212:215], v[164:167]
v_exp_f16_sdwa v195, v196 dst_sel:WORD_1 dst_unused:UNUSED_PRESERVE src0_sel:WORD_1
v_pk_add_f16 v201, v201, 1.0 op_sel_hi:[1,0]
v_pk_add_f16 v198, v198, 1.0 op_sel_hi:[1,0]
v_mfma_f32_16x16x32_bf16 v[172:175], v[236:239], v[104:107], v[172:175]
ds_read_b128 v[232:235], v249 offset:24832
ds_read_u16_d16_hi v193, v193
v_pk_add_f16 v195, v195, 1.0 op_sel_hi:[1,0]
v_mfma_f32_16x16x32_bf16 v[180:183], v[236:239], v[108:111], v[180:183]
v_rcp_f16_e64 v202, v201
s_setprio 0
s_waitcnt lgkmcnt(7)
v_mfma_f32_16x16x32_bf16 v[168:171], v[216:219], v[112:115], v[168:171]
ds_read_b128 v[236:239], v254 offset:7952
v_rcp_f16_e64 v199, v198
v_mfma_f32_16x16x32_bf16 v[176:179], v[216:219], v[116:119], v[176:179]
v_rcp_f16_e64 v196, v195
v_mfma_f32_16x16x32_bf16 v[172:175], v[220:223], v[112:115], v[172:175]
ds_read_b128 v[216:219], v248 offset:28672
v_rcp_f16_sdwa v202, v201 dst_sel:WORD_1 dst_unused:UNUSED_PRESERVE src0_sel:WORD_1
v_mfma_f32_16x16x32_bf16 v[180:183], v[220:223], v[116:119], v[180:183]
v_rcp_f16_sdwa v199, v198 dst_sel:WORD_1 dst_unused:UNUSED_PRESERVE src0_sel:WORD_1
v_or_b32 v208, v184, v185
v_or_b32 v209, v186, v187
s_waitcnt lgkmcnt(4)
v_or_b32 v210, v188, v189
v_rcp_f16_sdwa v196, v195 dst_sel:WORD_1 dst_unused:UNUSED_PRESERVE src0_sel:WORD_1
v_or_b32 v211, v190, v191
s_waitcnt lgkmcnt(2)
v_or_b32 v212, v192, v193
v_pk_mul_f16 v213, v203, v202
v_pk_mul_f16 v214, v200, v199
v_pk_mul_f16 v215, v197, v196
s_setprio 3
v_mfma_f32_16x16x32_f16 v[48:51], v[224:227], v[208:211], v[228:231]
ds_read_b128 v[220:223], v249 offset:25600
v_cvt_pkrtz_f16_f32 v185, v168, v169
v_cvt_pkrtz_f16_f32 v187, v170, v171
v_mfma_f32_16x16x32_f16 v[56:59], v[224:227], v[212:215], v[228:231]
v_cvt_pkrtz_f16_f32 v189, v172, v173
v_cvt_pkrtz_f16_f32 v191, v174, v175
s_waitcnt lgkmcnt(2)
v_mfma_f32_16x16x32_f16 v[52:55], v[232:235], v[208:211], v[236:239]
ds_read_b128 v[224:227], v254 offset:8064
ds_read_b128 v[228:231], v248 offset:28928
v_cvt_pkrtz_f16_f32 v193, v176, v177
v_cvt_pk_f16_f32 v203, v178, v179
v_mfma_f32_16x16x32_f16 v[60:63], v[232:235], v[212:215], v[236:239]
v_cvt_pk_f16_f32 v200, v180, v181
v_cvt_pk_f16_f32 v197, v182, v183
s_waitcnt lgkmcnt(3)
v_mfma_f32_16x16x32_bf16 v[168:171], v[216:219], v[96:99], 0
ds_read_b128 v[232:235], v249 offset:25856
ds_read_b128 v[236:239], v254 offset:8080
v_pk_fma_f16 v202, v203, v203, s48
v_and_b32_e64 v185, s49, v185
v_mfma_f32_16x16x32_bf16 v[176:179], v[216:219], v[100:103], 0
v_pk_fma_f16 v199, v200, v200, s48
v_and_b32 v187, s49, v187
s_waitcnt lgkmcnt(3)
v_mfma_f32_16x16x32_f16 v[64:67], v[220:223], v[208:211], v[224:227]
ds_read_b128 v[216:219], v248 offset:29696
v_pk_fma_f16 v196, v197, v197, s48
v_bfe_u32 v184, v185, 2, 14
v_pk_mul_f16 v202, v203, v202
v_mfma_f32_16x16x32_f16 v[72:75], v[220:223], v[212:215], v[224:227]
v_bfe_u32 v186, v187, 2, 14
v_pk_mul_f16 v199, v200, v199
v_mfma_f32_16x16x32_bf16 v[152:155], v[18:21], v[0:3], v[152:155]
ds_read_b128 v[220:223], v249 offset:26624
ds_read_b128 v[224:227], v254 offset:16128
ds_read_u16_d16 v184, v184
ds_read_u16_d16 v186, v186
v_lshrrev_b32_e64 v185, 18, v185
v_pk_mul_f16 v196, v197, v196
v_mfma_f32_16x16x32_bf16 v[156:159], v[16:19], v[0:3], v[156:159]
v_lshrrev_b32 v187, 18, v187
s_waitcnt lgkmcnt(6)
v_mfma_f32_16x16x32_bf16 v[172:175], v[228:231], v[96:99], 0
ds_read_u16_d16_hi v185, v185
ds_read_u16_d16_hi v187, v187
v_exp_f16 v201, v202
v_and_b32 v189, s49, v189
v_mfma_f32_16x16x32_bf16 v[180:183], v[228:231], v[100:103], 0
v_and_b32 v191, s49, v191
s_waitcnt lgkmcnt(7)
v_mfma_f32_16x16x32_f16 v[68:71], v[232:235], v[208:211], v[236:239]
ds_read_b128 v[228:231], v249 offset:26880
v_exp_f16_e64 v198, v199
v_bfe_u32 v188, v189, 2, 14
v_mfma_f32_16x16x32_f16 v[76:79], v[232:235], v[212:215], v[236:239]
v_bfe_u32 v190, v191, 2, 14
v_exp_f16 v195, v196
s_waitcnt lgkmcnt(7)
v_mfma_f32_16x16x32_bf16 v[168:171], v[216:219], v[104:107], v[168:171]
ds_read_b128 v[232:235], v254 offset:16144
ds_read_b128 v[236:239], v248 offset:29952
ds_read_u16_d16 v188, v188
ds_read_u16_d16 v190, v190
v_lshrrev_b32_e64 v189, 18, v189
v_lshrrev_b32 v191, 18, v191
v_mfma_f32_16x16x32_bf16 v[176:179], v[216:219], v[108:111], v[176:179]
v_exp_f16_sdwa v201, v202 dst_sel:WORD_1 dst_unused:UNUSED_PRESERVE src0_sel:WORD_1
s_waitcnt lgkmcnt(7)
v_mfma_f32_16x16x32_f16 v[80:83], v[220:223], v[208:211], v[224:227]
ds_read_b128 v[216:219], v248 offset:30720
ds_read_u16_d16_hi v189, v189
ds_read_u16_d16_hi v191, v191
v_and_b32 v193, s49, v193
v_bfe_u32 v192, v193, 2, 14
v_mfma_f32_16x16x32_f16 v[88:91], v[220:223], v[212:215], v[224:227]
v_exp_f16_sdwa v198, v199 dst_sel:WORD_1 dst_unused:UNUSED_PRESERVE src0_sel:WORD_1
s_waitcnt lgkmcnt(6)
v_mfma_f32_16x16x32_f16 v[84:87], v[228:231], v[208:211], v[232:235]
ds_read_b128 v[220:223], v248 offset:30976
ds_read_b128 v[224:227], v249 offset:30720
ds_read_u16_d16 v192, v192
v_lshrrev_b32 v193, 18, v193
v_mfma_f32_16x16x32_f16 v[92:95], v[228:231], v[212:215], v[232:235]
v_exp_f16_sdwa v195, v196 dst_sel:WORD_1 dst_unused:UNUSED_PRESERVE src0_sel:WORD_1
v_pk_add_f16 v201, v201, 1.0 op_sel_hi:[1,0]
v_pk_add_f16 v198, v198, 1.0 op_sel_hi:[1,0]
s_waitcnt lgkmcnt(7)
v_mfma_f32_16x16x32_bf16 v[172:175], v[236:239], v[104:107], v[172:175]
ds_read_b128 v[228:231], v249 offset:30976
ds_read_b128 v[232:235], v248 offset:34816
ds_read_u16_d16_hi v193, v193
v_pk_add_f16 v195, v195, 1.0 op_sel_hi:[1,0]
v_mfma_f32_16x16x32_bf16 v[180:183], v[236:239], v[108:111], v[180:183]
v_rcp_f16 v202, v201
s_waitcnt lgkmcnt(8)
v_mfma_f32_16x16x32_bf16 v[168:171], v[216:219], v[112:115], v[168:171]
ds_read_b128 v[236:239], v249 offset:31744
v_rcp_f16_e64 v199, v198
v_mfma_f32_16x16x32_bf16 v[176:179], v[216:219], v[116:119], v[176:179]
v_rcp_f16 v196, v195
s_waitcnt lgkmcnt(6)
v_mfma_f32_16x16x32_bf16 v[172:175], v[220:223], v[112:115], v[172:175]
ds_read_b128 v[216:219], v248 offset:35072
v_rcp_f16_sdwa v202, v201 dst_sel:WORD_1 dst_unused:UNUSED_PRESERVE src0_sel:WORD_1
v_mfma_f32_16x16x32_bf16 v[180:183], v[220:223], v[116:119], v[180:183]
v_rcp_f16_sdwa v199, v198 dst_sel:WORD_1 dst_unused:UNUSED_PRESERVE src0_sel:WORD_1
v_or_b32 v208, v184, v185
v_or_b32 v209, v186, v187
v_or_b32_e64 v210, v188, v189
v_rcp_f16_sdwa v196, v195 dst_sel:WORD_1 dst_unused:UNUSED_PRESERVE src0_sel:WORD_1
v_or_b32 v211, v190, v191
s_waitcnt lgkmcnt(2)
v_or_b32_e64 v212, v192, v193
v_pk_mul_f16 v213, v203, v202
v_pk_mul_f16 v214, v200, v199
v_pk_mul_f16 v215, v197, v196
v_mfma_f32_16x16x32_f16 v[48:51], v[224:227], v[208:211], v[48:51]
buffer_load_dwordx4 v[0:3], v252, s[4:7], s69 offen
ds_read_b128 v[220:223], v249 offset:32000
v_cvt_pkrtz_f16_f32 v185, v168, v169
v_cvt_pkrtz_f16_f32 v187, v170, v171
v_cvt_pkrtz_f16_f32 v189, v172, v173
v_mfma_f32_16x16x32_f16 v[56:59], v[224:227], v[212:215], v[56:59]
v_cvt_pkrtz_f16_f32 v191, v174, v175
v_cvt_pkrtz_f16_f32 v193, v176, v177
v_cvt_pk_f16_f32 v203, v178, v179
v_mfma_f32_16x16x32_f16 v[52:55], v[228:231], v[208:211], v[52:55]
ds_read_b128 v[224:227], v248 offset:35840
v_cvt_pk_f16_f32 v200, v180, v181
v_cvt_pk_f16_f32 v197, v182, v183
v_pk_fma_f16 v202, v203, v203, s48
v_mfma_f32_16x16x32_f16 v[60:63], v[228:231], v[212:215], v[60:63]
v_cvt_pk_bf16_f32 v136, v136, v137
v_and_b32_e64 v185, s49, v185
v_cvt_pk_bf16_f32 v137, v138, v139
v_mfma_f32_16x16x32_bf16 v[168:171], v[232:235], v[96:99], 0
ds_read_b128 v[228:231], v249 offset:32768
v_pk_fma_f16 v199, v200, v200, s48
v_and_b32_e64 v187, s49, v187
v_cvt_pk_bf16_f32 v138, v140, v141
v_mfma_f32_16x16x32_bf16 v[176:179], v[232:235], v[100:103], 0
v_pk_fma_f16 v196, v197, v197, s48
v_cvt_pk_bf16_f32 v139, v142, v143
v_bfe_u32 v184, v185, 2, 14
s_setprio 2
s_waitcnt lgkmcnt(2)
v_mfma_f32_16x16x32_f16 v[64:67], v[236:239], v[208:211], v[64:67]
ds_read_b128 v[232:235], v249 offset:33024
ds_read_u16_d16 v184, v184
v_pk_mul_f16 v202, v203, v202
v_cvt_pk_bf16_f32 v120, v120, v121
v_bfe_u32 v186, v187, 2, 14
v_mfma_f32_16x16x32_f16 v[72:75], v[236:239], v[212:215], v[72:75]
v_cvt_pk_bf16_f32 v121, v122, v123
v_pk_mul_f16 v199, v200, v199
v_lshrrev_b32_e64 v185, 18, v185
v_mfma_f32_16x16x32_bf16 v[128:131], v[18:21], v[4:7], v[128:131]
ds_read_b128 v[236:239], v248 offset:36096
ds_read_u16_d16 v186, v186
ds_read_u16_d16_hi v185, v185
v_cvt_pk_bf16_f32 v122, v124, v125
v_pk_mul_f16 v196, v197, v196
v_lshrrev_b32_e64 v187, 18, v187
v_mfma_f32_16x16x32_bf16 v[132:135], v[16:19], v[4:7], v[132:135]
v_cvt_pk_bf16_f32 v123, v126, v127
v_exp_f16_e64 v201, v202
v_mfma_f32_16x16x32_bf16 v[172:175], v[216:219], v[96:99], 0
ds_read_u16_d16_hi v187, v187
v_cvt_pk_bf16_f32 v152, v152, v153
v_and_b32_e64 v189, s49, v189
v_cvt_pk_bf16_f32 v153, v154, v155
v_mfma_f32_16x16x32_bf16 v[180:183], v[216:219], v[100:103], 0
v_and_b32_e64 v191, s49, v191
v_cvt_pk_bf16_f32 v154, v156, v157
v_mfma_f32_16x16x32_f16 v[68:71], v[220:223], v[208:211], v[68:71]
ds_read_b128 v[216:219], v248 offset:36864
v_exp_f16 v198, v199
v_cvt_pk_bf16_f32 v155, v158, v159
s_mov_b64 vcc, s[74:75]
v_bfe_u32 v188, v189, 2, 14
v_bfe_u32 v190, v191, 2, 14
v_mfma_f32_16x16x32_f16 v[76:79], v[220:223], v[212:215], v[76:79]
v_cndmask_b32 v140, v120, v152, vcc
v_exp_f16_e64 v195, v196
s_waitcnt lgkmcnt(2)
v_mfma_f32_16x16x32_bf16 v[168:171], v[224:227], v[104:107], v[168:171]
ds_read_b128 v[220:223], v248 offset:37120
ds_read_u16_d16 v188, v188
ds_read_u16_d16 v190, v190
v_cndmask_b32 v141, v121, v153, vcc
v_lshrrev_b32_e64 v189, 18, v189
v_cndmask_b32 v142, v122, v154, vcc
v_mfma_f32_16x16x32_bf16 v[176:179], v[224:227], v[108:111], v[176:179]
v_lshrrev_b32 v191, 18, v191
v_cndmask_b32 v143, v123, v155, vcc
v_mfma_f32_16x16x32_f16 v[80:83], v[228:231], v[208:211], v[80:83]
ds_read_b128 v[224:227], v249 offset:36864
ds_read_u16_d16_hi v189, v189
ds_read_u16_d16_hi v191, v191
v_exp_f16_sdwa v201, v202 dst_sel:WORD_1 dst_unused:UNUSED_PRESERVE src0_sel:WORD_1
v_cndmask_b32_dpp v120, v136, v120, vcc quad_perm:[1,0,3,2] row_mask:0xf bank_mask:0xf
v_and_b32_e64 v193, s49, v193
v_mfma_f32_16x16x32_f16 v[88:91], v[228:231], v[212:215], v[88:91]
v_cndmask_b32_dpp v121, v137, v121, vcc quad_perm:[1,0,3,2] row_mask:0xf bank_mask:0xf
v_bfe_u32 v192, v193, 2, 14
v_mfma_f32_16x16x32_f16 v[84:87], v[232:235], v[208:211], v[84:87]
ds_read_b128 v[228:231], v249 offset:37120
ds_read_u16_d16 v192, v192
v_exp_f16_sdwa v198, v199 dst_sel:WORD_1 dst_unused:UNUSED_PRESERVE src0_sel:WORD_1
v_cndmask_b32_dpp v122, v138, v122, vcc quad_perm:[1,0,3,2] row_mask:0xf bank_mask:0xf
v_lshrrev_b32 v193, 18, v193
v_mfma_f32_16x16x32_f16 v[92:95], v[232:235], v[212:215], v[92:95]
v_cndmask_b32_dpp v123, v139, v123, vcc quad_perm:[1,0,3,2] row_mask:0xf bank_mask:0xf
s_not_b64 vcc, s[74:75]
v_exp_f16_sdwa v195, v196 dst_sel:WORD_1 dst_unused:UNUSED_PRESERVE src0_sel:WORD_1
v_mfma_f32_16x16x32_bf16 v[172:175], v[236:239], v[104:107], v[172:175]
ds_read_b128 v[232:235], v248 offset:40960
ds_read_u16_d16_hi v193, v193
v_cndmask_b32_dpp v152, v136, v152, vcc quad_perm:[1,0,3,2] row_mask:0xf bank_mask:0xf
v_pk_add_f16 v201, v201, 1.0 op_sel_hi:[1,0]
v_cndmask_b32_dpp v153, v137, v153, vcc quad_perm:[1,0,3,2] row_mask:0xf bank_mask:0xf
v_mfma_f32_16x16x32_bf16 v[180:183], v[236:239], v[108:111], v[180:183]
v_pk_add_f16 v198, v198, 1.0 op_sel_hi:[1,0]
v_cndmask_b32_dpp v154, v138, v154, vcc quad_perm:[1,0,3,2] row_mask:0xf bank_mask:0xf
v_pk_add_f16 v195, v195, 1.0 op_sel_hi:[1,0]
s_waitcnt lgkmcnt(4)
v_mfma_f32_16x16x32_bf16 v[168:171], v[216:219], v[112:115], v[168:171]
ds_read_b128 v[236:239], v249 offset:37888
v_rcp_f16 v202, v201
v_cndmask_b32_dpp v155, v139, v155, vcc quad_perm:[1,0,3,2] row_mask:0xf bank_mask:0xf
v_mfma_f32_16x16x32_bf16 v[176:179], v[216:219], v[116:119], v[176:179]
v_rcp_f16_e64 v199, v198
v_mfma_f32_16x16x32_bf16 v[172:175], v[220:223], v[112:115], v[172:175]
ds_read_b128 v[216:219], v248 offset:41216
buffer_store_dwordx4 v[120:123], v255, s[8:11], s68 offen sc1
v_rcp_f16_e64 v196, v195
v_rcp_f16_sdwa v202, v201 dst_sel:WORD_1 dst_unused:UNUSED_PRESERVE src0_sel:WORD_1
v_mfma_f32_16x16x32_bf16 v[180:183], v[220:223], v[116:119], v[180:183]
v_rcp_f16_sdwa v199, v198 dst_sel:WORD_1 dst_unused:UNUSED_PRESERVE src0_sel:WORD_1
v_or_b32 v208, v184, v185
v_or_b32 v209, v186, v187
v_or_b32_e64 v210, v188, v189
v_rcp_f16_sdwa v196, v195 dst_sel:WORD_1 dst_unused:UNUSED_PRESERVE src0_sel:WORD_1
v_or_b32 v211, v190, v191
s_waitcnt lgkmcnt(2)
v_or_b32_e64 v212, v192, v193
v_pk_mul_f16 v213, v203, v202
v_pk_mul_f16 v214, v200, v199
v_pk_mul_f16 v215, v197, v196
v_mfma_f32_16x16x32_f16 v[48:51], v[224:227], v[208:211], v[48:51]
buffer_load_dwordx4 v[4:7], v252, s[4:7], s69 offen offset:64
ds_read_b128 v[220:223], v249 offset:38144
v_cvt_pkrtz_f16_f32 v185, v168, v169
v_cvt_pkrtz_f16_f32 v187, v170, v171
v_mfma_f32_16x16x32_f16 v[56:59], v[224:227], v[212:215], v[56:59]
v_cvt_pkrtz_f16_f32 v189, v172, v173
v_cvt_pkrtz_f16_f32 v191, v174, v175
v_mfma_f32_16x16x32_f16 v[52:55], v[228:231], v[208:211], v[52:55]
ds_read_b128 v[224:227], v248 offset:41984
v_cvt_pkrtz_f16_f32 v193, v176, v177
v_cvt_pk_f16_f32 v203, v178, v179
v_mfma_f32_16x16x32_f16 v[60:63], v[228:231], v[212:215], v[60:63]
v_cvt_pk_f16_f32 v200, v180, v181
v_cvt_pk_f16_f32 v197, v182, v183
s_setprio 1
v_mfma_f32_16x16x32_bf16 v[168:171], v[232:235], v[96:99], 0
ds_read_b128 v[228:231], v249 offset:38912
v_pk_fma_f16 v202, v203, v203, s48
v_and_b32 v185, s49, v185
v_mfma_f32_16x16x32_bf16 v[176:179], v[232:235], v[100:103], 0
v_pk_fma_f16 v199, v200, v200, s48
v_and_b32 v187, s49, v187
s_waitcnt lgkmcnt(3)
v_mfma_f32_16x16x32_f16 v[64:67], v[236:239], v[208:211], v[64:67]
ds_read_b128 v[232:235], v249 offset:39168
v_pk_fma_f16 v196, v197, v197, s48
v_bfe_u32 v184, v185, 2, 14
v_pk_mul_f16 v202, v203, v202
v_mfma_f32_16x16x32_f16 v[72:75], v[236:239], v[212:215], v[72:75]
v_bfe_u32 v186, v187, 2, 14
v_pk_mul_f16 v199, v200, v199
s_waitcnt vmcnt(6)
v_mfma_f32_16x16x32_bf16 v[144:147], v[18:21], v[8:11], v[144:147]
ds_read_b128 v[236:239], v248 offset:42240
ds_read_u16_d16 v184, v184
ds_read_u16_d16 v186, v186
v_lshrrev_b32 v185, 18, v185
v_pk_mul_f16 v196, v197, v196
v_mfma_f32_16x16x32_bf16 v[148:151], v[16:19], v[8:11], v[148:151]
v_lshrrev_b32_e64 v187, 18, v187
v_mfma_f32_16x16x32_bf16 v[172:175], v[216:219], v[96:99], 0
ds_read_u16_d16_hi v185, v185
ds_read_u16_d16_hi v187, v187
v_exp_f16 v201, v202
v_and_b32 v189, s49, v189
v_mfma_f32_16x16x32_bf16 v[180:183], v[216:219], v[100:103], 0
v_and_b32 v191, s49, v191
s_waitcnt lgkmcnt(6)
v_mfma_f32_16x16x32_f16 v[68:71], v[220:223], v[208:211], v[68:71]
ds_read_b128 v[216:219], v248 offset:43008
v_exp_f16_e64 v198, v199
v_bfe_u32 v188, v189, 2, 14
v_mfma_f32_16x16x32_f16 v[76:79], v[220:223], v[212:215], v[76:79]
v_bfe_u32 v190, v191, 2, 14
v_exp_f16_e64 v195, v196
v_mfma_f32_16x16x32_bf16 v[168:171], v[224:227], v[104:107], v[168:171]
ds_read_b128 v[220:223], v248 offset:43264
ds_read_u16_d16 v188, v188
ds_read_u16_d16 v190, v190
v_lshrrev_b32 v189, 18, v189
v_lshrrev_b32 v191, 18, v191
v_mfma_f32_16x16x32_bf16 v[176:179], v[224:227], v[108:111], v[176:179]
v_exp_f16_sdwa v201, v202 dst_sel:WORD_1 dst_unused:UNUSED_PRESERVE src0_sel:WORD_1
v_mfma_f32_16x16x32_f16 v[80:83], v[228:231], v[208:211], v[80:83]
ds_read_b128 v[224:227], v249 offset:43008
ds_read_u16_d16_hi v189, v189
ds_read_u16_d16_hi v191, v191
v_and_b32 v193, s49, v193
v_bfe_u32 v192, v193, 2, 14
v_mfma_f32_16x16x32_f16 v[88:91], v[228:231], v[212:215], v[88:91]
v_exp_f16_sdwa v198, v199 dst_sel:WORD_1 dst_unused:UNUSED_PRESERVE src0_sel:WORD_1
s_waitcnt lgkmcnt(7)
v_mfma_f32_16x16x32_f16 v[84:87], v[232:235], v[208:211], v[84:87]
ds_read_b128 v[228:231], v249 offset:43264
ds_read_u16_d16 v192, v192
v_lshrrev_b32_e64 v193, 18, v193
v_mfma_f32_16x16x32_f16 v[92:95], v[232:235], v[212:215], v[92:95]
v_exp_f16_sdwa v195, v196 dst_sel:WORD_1 dst_unused:UNUSED_PRESERVE src0_sel:WORD_1
v_pk_add_f16 v201, v201, 1.0 op_sel_hi:[1,0]
v_pk_add_f16 v198, v198, 1.0 op_sel_hi:[1,0]
v_mfma_f32_16x16x32_bf16 v[172:175], v[236:239], v[104:107], v[172:175]
ds_read_b128 v[232:235], v248 offset:47104
ds_read_u16_d16_hi v193, v193
v_pk_add_f16 v195, v195, 1.0 op_sel_hi:[1,0]
v_mfma_f32_16x16x32_bf16 v[180:183], v[236:239], v[108:111], v[180:183]
v_rcp_f16_e64 v202, v201
s_setprio 0
s_waitcnt lgkmcnt(7)
v_mfma_f32_16x16x32_bf16 v[168:171], v[216:219], v[112:115], v[168:171]
ds_read_b128 v[236:239], v249 offset:44032
v_rcp_f16_e64 v199, v198
v_mfma_f32_16x16x32_bf16 v[176:179], v[216:219], v[116:119], v[176:179]
v_rcp_f16_e64 v196, v195
v_mfma_f32_16x16x32_bf16 v[172:175], v[220:223], v[112:115], v[172:175]
ds_read_b128 v[216:219], v248 offset:47360
v_rcp_f16_sdwa v202, v201 dst_sel:WORD_1 dst_unused:UNUSED_PRESERVE src0_sel:WORD_1
v_mfma_f32_16x16x32_bf16 v[180:183], v[220:223], v[116:119], v[180:183]
v_rcp_f16_sdwa v199, v198 dst_sel:WORD_1 dst_unused:UNUSED_PRESERVE src0_sel:WORD_1
v_or_b32 v208, v184, v185
v_or_b32 v209, v186, v187
s_waitcnt lgkmcnt(4)
v_or_b32 v210, v188, v189
v_rcp_f16_sdwa v196, v195 dst_sel:WORD_1 dst_unused:UNUSED_PRESERVE src0_sel:WORD_1
v_or_b32 v211, v190, v191
s_waitcnt lgkmcnt(2)
v_or_b32 v212, v192, v193
v_pk_mul_f16 v213, v203, v202
v_pk_mul_f16 v214, v200, v199
v_pk_mul_f16 v215, v197, v196
s_setprio 3
v_mfma_f32_16x16x32_f16 v[48:51], v[224:227], v[208:211], v[48:51]
buffer_load_dwordx4 v[8:11], v252, s[4:7], s69 offen offset:128
ds_read_b128 v[220:223], v249 offset:44288
v_cvt_pkrtz_f16_f32 v185, v168, v169
v_cvt_pkrtz_f16_f32 v187, v170, v171
v_mfma_f32_16x16x32_f16 v[56:59], v[224:227], v[212:215], v[56:59]
v_cvt_pkrtz_f16_f32 v189, v172, v173
v_cvt_pkrtz_f16_f32 v191, v174, v175
v_mfma_f32_16x16x32_f16 v[52:55], v[228:231], v[208:211], v[52:55]
ds_read_b128 v[224:227], v248 offset:48128
v_cvt_pkrtz_f16_f32 v193, v176, v177
v_cvt_pk_f16_f32 v203, v178, v179
v_cvt_pk_f16_f32 v200, v180, v181
v_mfma_f32_16x16x32_f16 v[60:63], v[228:231], v[212:215], v[60:63]
v_cvt_pk_f16_f32 v197, v182, v183
v_pk_fma_f16 v202, v203, v203, s48
v_mfma_f32_16x16x32_bf16 v[168:171], v[232:235], v[96:99], 0
ds_read_b128 v[228:231], v249 offset:45056
v_and_b32_e64 v185, s49, v185
v_pk_fma_f16 v199, v200, v200, s48
v_mfma_f32_16x16x32_bf16 v[176:179], v[232:235], v[100:103], 0
v_and_b32 v187, s49, v187
v_pk_fma_f16 v196, v197, v197, s48
v_bfe_u32 v184, v185, 2, 14
s_waitcnt lgkmcnt(3)
v_mfma_f32_16x16x32_f16 v[64:67], v[236:239], v[208:211], v[64:67]
ds_read_b128 v[232:235], v249 offset:45312
ds_read_u16_d16 v184, v184
v_pk_mul_f16 v202, v203, v202
v_bfe_u32 v186, v187, 2, 14
v_mfma_f32_16x16x32_f16 v[72:75], v[236:239], v[212:215], v[72:75]
v_pk_mul_f16 v199, v200, v199
v_lshrrev_b32_e64 v185, 18, v185
v_mfma_f32_16x16x32_bf16 v[172:175], v[216:219], v[96:99], 0
ds_read_b128 v[236:239], v248 offset:48384
ds_read_u16_d16 v186, v186
ds_read_u16_d16_hi v185, v185
v_pk_mul_f16 v196, v197, v196
v_lshrrev_b32_e64 v187, 18, v187
v_mfma_f32_16x16x32_bf16 v[180:183], v[216:219], v[100:103], 0
v_exp_f16_e64 v201, v202
v_and_b32 v189, s49, v189
s_waitcnt lgkmcnt(5)
v_mfma_f32_16x16x32_f16 v[68:71], v[220:223], v[208:211], v[68:71]
ds_read_b128 v[216:219], v248 offset:49152
ds_read_u16_d16_hi v187, v187
v_and_b32_e64 v191, s49, v191
v_mfma_f32_16x16x32_f16 v[76:79], v[220:223], v[212:215], v[76:79]
v_exp_f16_e64 v198, v199
v_bfe_u32 v188, v189, 2, 14
v_bfe_u32 v190, v191, 2, 14
v_mfma_f32_16x16x32_bf16 v[168:171], v[224:227], v[104:107], v[168:171]
buffer_store_dwordx4 v[140:143], v255, s[8:11], s68 offen offset:128 sc1
ds_read_b128 v[220:223], v248 offset:49408
ds_read_u16_d16 v188, v188
ds_read_u16_d16 v190, v190
v_exp_f16_e64 v195, v196
v_mfma_f32_16x16x32_bf16 v[176:179], v[224:227], v[108:111], v[176:179]
v_lshrrev_b32 v189, 18, v189
v_lshrrev_b32 v191, 18, v191
v_mfma_f32_16x16x32_f16 v[80:83], v[228:231], v[208:211], v[80:83]
ds_read_b128 v[224:227], v249 offset:49152
ds_read_u16_d16_hi v189, v189
ds_read_u16_d16_hi v191, v191
v_exp_f16_sdwa v201, v202 dst_sel:WORD_1 dst_unused:UNUSED_PRESERVE src0_sel:WORD_1
v_and_b32 v193, s49, v193
v_mfma_f32_16x16x32_f16 v[88:91], v[228:231], v[212:215], v[88:91]
v_bfe_u32 v192, v193, 2, 14
s_waitcnt lgkmcnt(8)
v_mfma_f32_16x16x32_f16 v[84:87], v[232:235], v[208:211], v[84:87]
ds_read_b128 v[228:231], v249 offset:49408
ds_read_u16_d16 v192, v192
v_exp_f16_sdwa v198, v199 dst_sel:WORD_1 dst_unused:UNUSED_PRESERVE src0_sel:WORD_1
v_lshrrev_b32_e64 v193, 18, v193
v_mfma_f32_16x16x32_f16 v[92:95], v[232:235], v[212:215], v[92:95]
v_exp_f16_sdwa v195, v196 dst_sel:WORD_1 dst_unused:UNUSED_PRESERVE src0_sel:WORD_1
v_pk_add_f16 v201, v201, 1.0 op_sel_hi:[1,0]
v_mfma_f32_16x16x32_bf16 v[172:175], v[236:239], v[104:107], v[172:175]
ds_read_b128 v[232:235], v248 offset:53248
ds_read_u16_d16_hi v193, v193
v_pk_add_f16 v198, v198, 1.0 op_sel_hi:[1,0]
v_pk_add_f16 v195, v195, 1.0 op_sel_hi:[1,0]
v_mfma_f32_16x16x32_bf16 v[180:183], v[236:239], v[108:111], v[180:183]
v_rcp_f16 v202, v201
s_waitcnt lgkmcnt(7)
v_mfma_f32_16x16x32_bf16 v[168:171], v[216:219], v[112:115], v[168:171]
ds_read_b128 v[236:239], v249 offset:50176
v_rcp_f16_e64 v199, v198
v_mfma_f32_16x16x32_bf16 v[176:179], v[216:219], v[116:119], v[176:179]
v_rcp_f16_e64 v196, v195
v_mfma_f32_16x16x32_bf16 v[172:175], v[220:223], v[112:115], v[172:175]
ds_read_b128 v[216:219], v248 offset:53504
v_rcp_f16_sdwa v202, v201 dst_sel:WORD_1 dst_unused:UNUSED_PRESERVE src0_sel:WORD_1
v_mfma_f32_16x16x32_bf16 v[180:183], v[220:223], v[116:119], v[180:183]
v_rcp_f16_sdwa v199, v198 dst_sel:WORD_1 dst_unused:UNUSED_PRESERVE src0_sel:WORD_1
v_or_b32 v208, v184, v185
v_or_b32 v209, v186, v187
s_waitcnt lgkmcnt(4)
v_or_b32 v210, v188, v189
v_rcp_f16_sdwa v196, v195 dst_sel:WORD_1 dst_unused:UNUSED_PRESERVE src0_sel:WORD_1
v_or_b32 v211, v190, v191
s_waitcnt lgkmcnt(2)
v_or_b32_e64 v212, v192, v193
v_pk_mul_f16 v213, v203, v202
v_pk_mul_f16 v214, v200, v199
v_pk_mul_f16 v215, v197, v196
v_mfma_f32_16x16x32_f16 v[48:51], v[224:227], v[208:211], v[48:51]
s_add_u32 s46, s69, 98304
buffer_load_dwordx4 v[244:247], v252, s[4:7], s46 offen
ds_read_b128 v[220:223], v249 offset:50432
v_cvt_pkrtz_f16_f32 v185, v168, v169
v_cvt_pkrtz_f16_f32 v187, v170, v171
v_mfma_f32_16x16x32_f16 v[56:59], v[224:227], v[212:215], v[56:59]
v_cvt_pkrtz_f16_f32 v189, v172, v173
v_cvt_pkrtz_f16_f32 v191, v174, v175
v_mfma_f32_16x16x32_f16 v[52:55], v[228:231], v[208:211], v[52:55]
ds_read_b128 v[224:227], v248 offset:54272
v_cvt_pkrtz_f16_f32 v193, v176, v177
v_cvt_pk_f16_f32 v203, v178, v179
v_mfma_f32_16x16x32_f16 v[60:63], v[228:231], v[212:215], v[60:63]
v_cvt_pk_f16_f32 v200, v180, v181
v_cvt_pk_f16_f32 v197, v182, v183
v_mfma_f32_16x16x32_bf16 v[168:171], v[232:235], v[96:99], 0
ds_read_b128 v[228:231], v249 offset:51200
v_pk_fma_f16 v202, v203, v203, s48
v_and_b32_e64 v185, s49, v185
v_mfma_f32_16x16x32_bf16 v[176:179], v[232:235], v[100:103], 0
v_pk_fma_f16 v199, v200, v200, s48
v_and_b32 v187, s49, v187
s_waitcnt lgkmcnt(3)
v_mfma_f32_16x16x32_f16 v[64:67], v[236:239], v[208:211], v[64:67]
ds_read_b128 v[232:235], v249 offset:51456
v_pk_fma_f16 v196, v197, v197, s48
s_setprio 2
v_bfe_u32 v184, v185, 2, 14
v_pk_mul_f16 v202, v203, v202
v_mfma_f32_16x16x32_f16 v[72:75], v[236:239], v[212:215], v[72:75]
v_bfe_u32 v186, v187, 2, 14
v_pk_mul_f16 v199, v200, v199
s_waitcnt vmcnt(7)
v_mfma_f32_16x16x32_bf16 v[160:163], v[18:21], v[204:207], v[160:163]
ds_read_b128 v[236:239], v248 offset:54528
ds_read_u16_d16 v184, v184
ds_read_u16_d16 v186, v186
v_lshrrev_b32_e64 v185, 18, v185
v_pk_mul_f16 v196, v197, v196
v_mfma_f32_16x16x32_bf16 v[164:167], v[16:19], v[204:207], v[164:167]
v_lshrrev_b32_e64 v187, 18, v187
v_mfma_f32_16x16x32_bf16 v[172:175], v[216:219], v[96:99], 0
ds_read_u16_d16_hi v185, v185
ds_read_u16_d16_hi v187, v187
v_exp_f16 v201, v202
v_and_b32 v189, s49, v189
v_mfma_f32_16x16x32_bf16 v[180:183], v[216:219], v[100:103], 0
v_and_b32 v191, s49, v191
s_waitcnt lgkmcnt(6)
v_mfma_f32_16x16x32_f16 v[68:71], v[220:223], v[208:211], v[68:71]
ds_read_b128 v[216:219], v248 offset:55296
v_exp_f16_e64 v198, v199
v_bfe_u32 v188, v189, 2, 14
v_mfma_f32_16x16x32_f16 v[76:79], v[220:223], v[212:215], v[76:79]
v_bfe_u32 v190, v191, 2, 14
v_exp_f16_e64 v195, v196
v_mfma_f32_16x16x32_bf16 v[168:171], v[224:227], v[104:107], v[168:171]
ds_read_b128 v[220:223], v248 offset:55552
ds_read_u16_d16 v188, v188
ds_read_u16_d16 v190, v190
v_lshrrev_b32 v189, 18, v189
v_lshrrev_b32 v191, 18, v191
v_mfma_f32_16x16x32_bf16 v[176:179], v[224:227], v[108:111], v[176:179]
v_exp_f16_sdwa v201, v202 dst_sel:WORD_1 dst_unused:UNUSED_PRESERVE src0_sel:WORD_1
v_mfma_f32_16x16x32_f16 v[80:83], v[228:231], v[208:211], v[80:83]
ds_read_b128 v[224:227], v249 offset:55296
ds_read_u16_d16_hi v189, v189
ds_read_u16_d16_hi v191, v191
v_and_b32 v193, s49, v193
v_bfe_u32 v192, v193, 2, 14
v_mfma_f32_16x16x32_f16 v[88:91], v[228:231], v[212:215], v[88:91]
v_exp_f16_sdwa v198, v199 dst_sel:WORD_1 dst_unused:UNUSED_PRESERVE src0_sel:WORD_1
s_waitcnt lgkmcnt(7)
v_mfma_f32_16x16x32_f16 v[84:87], v[232:235], v[208:211], v[84:87]
ds_read_b128 v[228:231], v249 offset:55552
ds_read_u16_d16 v192, v192
v_lshrrev_b32_e64 v193, 18, v193
v_mfma_f32_16x16x32_f16 v[92:95], v[232:235], v[212:215], v[92:95]
v_exp_f16_sdwa v195, v196 dst_sel:WORD_1 dst_unused:UNUSED_PRESERVE src0_sel:WORD_1
v_pk_add_f16 v201, v201, 1.0 op_sel_hi:[1,0]
v_pk_add_f16 v198, v198, 1.0 op_sel_hi:[1,0]
v_mfma_f32_16x16x32_bf16 v[172:175], v[236:239], v[104:107], v[172:175]
ds_read_b128 v[232:235], v248 offset:59392
ds_read_u16_d16_hi v193, v193
v_pk_add_f16 v195, v195, 1.0 op_sel_hi:[1,0]
v_mfma_f32_16x16x32_bf16 v[180:183], v[236:239], v[108:111], v[180:183]
v_rcp_f16 v202, v201
s_waitcnt lgkmcnt(7)
v_mfma_f32_16x16x32_bf16 v[168:171], v[216:219], v[112:115], v[168:171]
ds_read_b128 v[236:239], v249 offset:56320
v_rcp_f16_e64 v199, v198
v_mfma_f32_16x16x32_bf16 v[176:179], v[216:219], v[116:119], v[176:179]
v_rcp_f16_e64 v196, v195
v_mfma_f32_16x16x32_bf16 v[172:175], v[220:223], v[112:115], v[172:175]
ds_read_b128 v[216:219], v248 offset:59648
v_rcp_f16_sdwa v202, v201 dst_sel:WORD_1 dst_unused:UNUSED_PRESERVE src0_sel:WORD_1
v_mfma_f32_16x16x32_bf16 v[180:183], v[220:223], v[116:119], v[180:183]
v_rcp_f16_sdwa v199, v198 dst_sel:WORD_1 dst_unused:UNUSED_PRESERVE src0_sel:WORD_1
v_or_b32 v208, v184, v185
v_or_b32 v209, v186, v187
s_waitcnt lgkmcnt(4)
v_or_b32 v210, v188, v189
v_rcp_f16_sdwa v196, v195 dst_sel:WORD_1 dst_unused:UNUSED_PRESERVE src0_sel:WORD_1
v_or_b32 v211, v190, v191
s_waitcnt lgkmcnt(2)
v_or_b32_e64 v212, v192, v193
v_pk_mul_f16 v213, v203, v202
v_pk_mul_f16 v214, v200, v199
v_pk_mul_f16 v215, v197, v196
v_mfma_f32_16x16x32_f16 v[48:51], v[224:227], v[208:211], v[48:51]
s_add_u32 s46, s69, 98304
buffer_load_dwordx4 v[204:207], v252, s[4:7], s46 offen offset:64
ds_read_b128 v[220:223], v249 offset:56576
v_cvt_pkrtz_f16_f32 v185, v168, v169
v_cvt_pkrtz_f16_f32 v187, v170, v171
v_mfma_f32_16x16x32_f16 v[56:59], v[224:227], v[212:215], v[56:59]
v_cvt_pkrtz_f16_f32 v189, v172, v173
v_cvt_pkrtz_f16_f32 v191, v174, v175
v_mfma_f32_16x16x32_f16 v[52:55], v[228:231], v[208:211], v[52:55]
ds_read_b128 v[224:227], v248 offset:60416
v_cvt_pkrtz_f16_f32 v193, v176, v177
v_cvt_pk_f16_f32 v203, v178, v179
v_cvt_pk_f16_f32 v200, v180, v181
v_mfma_f32_16x16x32_f16 v[60:63], v[228:231], v[212:215], v[60:63]
v_cvt_pk_f16_f32 v197, v182, v183
s_setprio 1
v_pk_fma_f16 v202, v203, v203, s48
v_mfma_f32_16x16x32_bf16 v[168:171], v[232:235], v[96:99], 0
ds_read_b128 v[228:231], v249 offset:57344
v_and_b32 v185, s49, v185
v_pk_fma_f16 v199, v200, v200, s48
v_mfma_f32_16x16x32_bf16 v[176:179], v[232:235], v[100:103], 0
v_and_b32 v187, s49, v187
v_pk_fma_f16 v196, v197, v197, s48
v_bfe_u32 v184, v185, 2, 14
s_waitcnt lgkmcnt(3)
v_mfma_f32_16x16x32_f16 v[64:67], v[236:239], v[208:211], v[64:67]
ds_read_b128 v[232:235], v249 offset:57600
ds_read_u16_d16 v184, v184
v_pk_mul_f16 v202, v203, v202
v_bfe_u32 v186, v187, 2, 14
v_mfma_f32_16x16x32_f16 v[72:75], v[236:239], v[212:215], v[72:75]
v_pk_mul_f16 v199, v200, v199
v_lshrrev_b32_e64 v185, 18, v185
v_mfma_f32_16x16x32_bf16 v[172:175], v[216:219], v[96:99], 0
ds_read_b128 v[236:239], v248 offset:60672
ds_read_u16_d16 v186, v186
ds_read_u16_d16_hi v185, v185
v_pk_mul_f16 v196, v197, v196
v_lshrrev_b32_e64 v187, 18, v187
v_mfma_f32_16x16x32_bf16 v[180:183], v[216:219], v[100:103], 0
v_exp_f16_e64 v201, v202
v_and_b32 v189, s49, v189
s_waitcnt lgkmcnt(5)
v_mfma_f32_16x16x32_f16 v[68:71], v[220:223], v[208:211], v[68:71]
ds_read_b128 v[216:219], v248 offset:61440
ds_read_u16_d16_hi v187, v187
v_and_b32_e64 v191, s49, v191
v_mfma_f32_16x16x32_f16 v[76:79], v[220:223], v[212:215], v[76:79]
v_exp_f16_e64 v198, v199
v_bfe_u32 v188, v189, 2, 14
v_bfe_u32 v190, v191, 2, 14
v_mfma_f32_16x16x32_bf16 v[168:171], v[224:227], v[104:107], v[168:171]
buffer_store_dwordx4 v[152:155], v255, s[8:11], s68 offen offset:256 sc1
ds_read_b128 v[220:223], v248 offset:61696
ds_read_u16_d16 v188, v188
ds_read_u16_d16 v190, v190
v_exp_f16_e64 v195, v196
v_mfma_f32_16x16x32_bf16 v[176:179], v[224:227], v[108:111], v[176:179]
v_lshrrev_b32 v189, 18, v189
v_lshrrev_b32 v191, 18, v191
v_mfma_f32_16x16x32_f16 v[80:83], v[228:231], v[208:211], v[80:83]
ds_read_b128 v[224:227], v249 offset:61440
ds_read_u16_d16_hi v189, v189
ds_read_u16_d16_hi v191, v191
v_exp_f16_sdwa v201, v202 dst_sel:WORD_1 dst_unused:UNUSED_PRESERVE src0_sel:WORD_1
v_and_b32 v193, s49, v193
v_mfma_f32_16x16x32_f16 v[88:91], v[228:231], v[212:215], v[88:91]
v_bfe_u32 v192, v193, 2, 14
s_waitcnt lgkmcnt(8)
v_mfma_f32_16x16x32_f16 v[84:87], v[232:235], v[208:211], v[84:87]
ds_read_b128 v[228:231], v249 offset:61696
ds_read_u16_d16 v192, v192
v_exp_f16_sdwa v198, v199 dst_sel:WORD_1 dst_unused:UNUSED_PRESERVE src0_sel:WORD_1
v_lshrrev_b32_e64 v193, 18, v193
v_mfma_f32_16x16x32_f16 v[92:95], v[232:235], v[212:215], v[92:95]
v_exp_f16_sdwa v195, v196 dst_sel:WORD_1 dst_unused:UNUSED_PRESERVE src0_sel:WORD_1
v_pk_add_f16 v201, v201, 1.0 op_sel_hi:[1,0]
v_mfma_f32_16x16x32_bf16 v[172:175], v[236:239], v[104:107], v[172:175]
ds_read_b128 v[232:235], v249
ds_read_u16_d16_hi v193, v193
v_pk_add_f16 v198, v198, 1.0 op_sel_hi:[1,0]
v_pk_add_f16 v195, v195, 1.0 op_sel_hi:[1,0]
v_mfma_f32_16x16x32_bf16 v[180:183], v[236:239], v[108:111], v[180:183]
v_rcp_f16_e64 v202, v201
s_setprio 0
s_waitcnt lgkmcnt(7)
v_mfma_f32_16x16x32_bf16 v[168:171], v[216:219], v[112:115], v[168:171]
ds_read_b128 v[236:239], v249 offset:62464
v_rcp_f16_e64 v199, v198
v_mfma_f32_16x16x32_bf16 v[176:179], v[216:219], v[116:119], v[176:179]
v_rcp_f16_e64 v196, v195
v_mfma_f32_16x16x32_bf16 v[172:175], v[220:223], v[112:115], v[172:175]
ds_read_b128 v[216:219], v249 offset:256
v_rcp_f16_sdwa v202, v201 dst_sel:WORD_1 dst_unused:UNUSED_PRESERVE src0_sel:WORD_1
v_mfma_f32_16x16x32_bf16 v[180:183], v[220:223], v[116:119], v[180:183]
v_rcp_f16_sdwa v199, v198 dst_sel:WORD_1 dst_unused:UNUSED_PRESERVE src0_sel:WORD_1
v_or_b32 v208, v184, v185
v_or_b32 v209, v186, v187
s_waitcnt lgkmcnt(4)
v_or_b32 v210, v188, v189
v_rcp_f16_sdwa v196, v195 dst_sel:WORD_1 dst_unused:UNUSED_PRESERVE src0_sel:WORD_1
v_or_b32 v211, v190, v191
s_waitcnt lgkmcnt(2)
v_or_b32_e64 v212, v192, v193
v_pk_mul_f16 v213, v203, v202
v_pk_mul_f16 v214, v200, v199
v_pk_mul_f16 v215, v197, v196
v_mfma_f32_16x16x32_f16 v[48:51], v[224:227], v[208:211], v[48:51]
ds_read_b128 v[220:223], v249 offset:62720
v_cvt_pkrtz_f16_f32 v185, v168, v169
v_cvt_pkrtz_f16_f32 v187, v170, v171
v_mfma_f32_16x16x32_f16 v[56:59], v[224:227], v[212:215], v[56:59]
v_cvt_pkrtz_f16_f32 v189, v172, v173
v_cvt_pkrtz_f16_f32 v191, v174, v175
v_mfma_f32_16x16x32_f16 v[52:55], v[228:231], v[208:211], v[52:55]
ds_read_b128 v[224:227], v249 offset:1024
v_cvt_pkrtz_f16_f32 v193, v176, v177
v_cvt_pk_f16_f32 v203, v178, v179
v_mfma_f32_16x16x32_f16 v[60:63], v[228:231], v[212:215], v[60:63]
v_cvt_pk_f16_f32 v200, v180, v181
v_cvt_pk_f16_f32 v197, v182, v183
v_mfma_f32_16x16x32_bf16 v[168:171], v[232:235], v[96:99], 0
ds_read_b128 v[228:231], v249 offset:63488
v_pk_fma_f16 v202, v203, v203, s48
v_and_b32_e64 v185, s49, v185
v_mfma_f32_16x16x32_bf16 v[176:179], v[232:235], v[100:103], 0
v_pk_fma_f16 v199, v200, v200, s48
v_and_b32 v187, s49, v187
s_waitcnt lgkmcnt(3)
v_mfma_f32_16x16x32_f16 v[64:67], v[236:239], v[208:211], v[64:67]
ds_read_b128 v[232:235], v249 offset:63744
v_pk_fma_f16 v196, v197, v197, s48
v_bfe_u32 v184, v185, 2, 14
v_pk_mul_f16 v202, v203, v202
v_mfma_f32_16x16x32_f16 v[72:75], v[236:239], v[212:215], v[72:75]
v_bfe_u32 v186, v187, 2, 14
v_pk_mul_f16 v199, v200, v199
s_waitcnt vmcnt(7)
v_mfma_f32_16x16x32_bf16 v[48:51], v[18:21], v[0:3], v[48:51]
ds_read_b128 v[236:239], v249 offset:1280
ds_read_u16_d16 v184, v184
ds_read_u16_d16 v186, v186
v_lshrrev_b32 v185, 18, v185
v_pk_mul_f16 v196, v197, v196
v_mfma_f32_16x16x32_bf16 v[52:55], v[16:19], v[0:3], v[52:55]
v_lshrrev_b32_e64 v187, 18, v187
v_mfma_f32_16x16x32_bf16 v[172:175], v[216:219], v[96:99], 0
ds_read_u16_d16_hi v185, v185
ds_read_u16_d16_hi v187, v187
v_exp_f16 v201, v202
v_and_b32 v189, s49, v189
v_mfma_f32_16x16x32_bf16 v[180:183], v[216:219], v[100:103], 0
v_and_b32 v191, s49, v191
s_waitcnt lgkmcnt(6)
v_mfma_f32_16x16x32_f16 v[68:71], v[220:223], v[208:211], v[68:71]
ds_read_b128 v[216:219], v249 offset:2048
v_exp_f16_e64 v198, v199
v_bfe_u32 v188, v189, 2, 14
v_mfma_f32_16x16x32_f16 v[76:79], v[220:223], v[212:215], v[76:79]
v_bfe_u32 v190, v191, 2, 14
v_exp_f16_e64 v195, v196
v_mfma_f32_16x16x32_bf16 v[168:171], v[224:227], v[104:107], v[168:171]
ds_read_b128 v[220:223], v249 offset:2304
ds_read_u16_d16 v188, v188
ds_read_u16_d16 v190, v190
v_lshrrev_b32 v189, 18, v189
v_lshrrev_b32 v191, 18, v191
v_mfma_f32_16x16x32_bf16 v[176:179], v[224:227], v[108:111], v[176:179]
v_exp_f16_sdwa v201, v202 dst_sel:WORD_1 dst_unused:UNUSED_PRESERVE src0_sel:WORD_1
v_mfma_f32_16x16x32_f16 v[80:83], v[228:231], v[208:211], v[80:83]
ds_read_b128 v[224:227], v250 offset:2048
ds_read_u16_d16_hi v189, v189
ds_read_u16_d16_hi v191, v191
v_and_b32 v193, s49, v193
v_bfe_u32 v192, v193, 2, 14
v_mfma_f32_16x16x32_f16 v[88:91], v[228:231], v[212:215], v[88:91]
v_exp_f16_sdwa v198, v199 dst_sel:WORD_1 dst_unused:UNUSED_PRESERVE src0_sel:WORD_1
s_waitcnt lgkmcnt(7)
v_mfma_f32_16x16x32_f16 v[84:87], v[232:235], v[208:211], v[84:87]
ds_read_b128 v[228:231], v250 offset:2304
ds_read_u16_d16 v192, v192
v_lshrrev_b32_e64 v193, 18, v193
v_mfma_f32_16x16x32_f16 v[92:95], v[232:235], v[212:215], v[92:95]
v_exp_f16_sdwa v195, v196 dst_sel:WORD_1 dst_unused:UNUSED_PRESERVE src0_sel:WORD_1
v_pk_add_f16 v201, v201, 1.0 op_sel_hi:[1,0]
v_pk_add_f16 v198, v198, 1.0 op_sel_hi:[1,0]
v_mfma_f32_16x16x32_bf16 v[172:175], v[236:239], v[104:107], v[172:175]
ds_read_b128 v[232:235], v249 offset:6144
ds_read_u16_d16_hi v193, v193
v_pk_add_f16 v195, v195, 1.0 op_sel_hi:[1,0]
v_mfma_f32_16x16x32_bf16 v[180:183], v[236:239], v[108:111], v[180:183]
v_rcp_f16 v202, v201
s_waitcnt lgkmcnt(7)
v_mfma_f32_16x16x32_bf16 v[168:171], v[216:219], v[112:115], v[168:171]
ds_read_b128 v[236:239], v250 offset:3072
v_rcp_f16_e64 v199, v198
v_mfma_f32_16x16x32_bf16 v[176:179], v[216:219], v[116:119], v[176:179]
v_rcp_f16_e64 v196, v195
v_mfma_f32_16x16x32_bf16 v[172:175], v[220:223], v[112:115], v[172:175]
ds_read_b128 v[216:219], v249 offset:6400
v_rcp_f16_sdwa v202, v201 dst_sel:WORD_1 dst_unused:UNUSED_PRESERVE src0_sel:WORD_1
v_mfma_f32_16x16x32_bf16 v[180:183], v[220:223], v[116:119], v[180:183]
v_rcp_f16_sdwa v199, v198 dst_sel:WORD_1 dst_unused:UNUSED_PRESERVE src0_sel:WORD_1
v_or_b32 v208, v184, v185
v_or_b32 v209, v186, v187
s_waitcnt lgkmcnt(4)
v_or_b32 v210, v188, v189
v_rcp_f16_sdwa v196, v195 dst_sel:WORD_1 dst_unused:UNUSED_PRESERVE src0_sel:WORD_1
v_or_b32 v211, v190, v191
s_waitcnt lgkmcnt(2)
v_or_b32_e64 v212, v192, v193
v_pk_mul_f16 v213, v203, v202
v_pk_mul_f16 v214, v200, v199
v_pk_mul_f16 v215, v197, v196
v_mfma_f32_16x16x32_f16 v[48:51], v[224:227], v[208:211], v[48:51]
s_add_u32 s46, s69, 98304
buffer_load_dwordx4 v[0:3], v252, s[4:7], s46 offen offset:128
ds_read_b128 v[220:223], v250 offset:3328
v_cvt_pkrtz_f16_f32 v185, v168, v169
v_cvt_pkrtz_f16_f32 v187, v170, v171
v_cvt_pkrtz_f16_f32 v189, v172, v173
v_mfma_f32_16x16x32_f16 v[56:59], v[224:227], v[212:215], v[56:59]
v_cvt_pkrtz_f16_f32 v191, v174, v175
v_cvt_pkrtz_f16_f32 v193, v176, v177
v_cvt_pk_f16_f32 v203, v178, v179
v_mfma_f32_16x16x32_f16 v[52:55], v[228:231], v[208:211], v[52:55]
ds_read_b128 v[224:227], v249 offset:7168
v_cvt_pk_f16_f32 v200, v180, v181
v_cvt_pk_f16_f32 v197, v182, v183
v_pk_fma_f16 v202, v203, v203, s48
v_mfma_f32_16x16x32_f16 v[60:63], v[228:231], v[212:215], v[60:63]
v_cvt_pk_bf16_f32 v144, v144, v145
v_and_b32_e64 v185, s49, v185
v_cvt_pk_bf16_f32 v145, v146, v147
v_mfma_f32_16x16x32_bf16 v[168:171], v[232:235], v[96:99], 0
ds_read_b128 v[228:231], v250 offset:4096
v_pk_fma_f16 v199, v200, v200, s48
v_and_b32 v187, s49, v187
v_cvt_pk_bf16_f32 v146, v148, v149
v_mfma_f32_16x16x32_bf16 v[176:179], v[232:235], v[100:103], 0
v_pk_fma_f16 v196, v197, v197, s48
v_cvt_pk_bf16_f32 v147, v150, v151
v_bfe_u32 v184, v185, 2, 14
s_waitcnt lgkmcnt(2)
v_mfma_f32_16x16x32_f16 v[64:67], v[236:239], v[208:211], v[64:67]
ds_read_b128 v[232:235], v250 offset:4352
ds_read_u16_d16 v184, v184
v_pk_mul_f16 v202, v203, v202
v_cvt_pk_bf16_f32 v128, v128, v129
v_bfe_u32 v186, v187, 2, 14
v_mfma_f32_16x16x32_f16 v[72:75], v[236:239], v[212:215], v[72:75]
v_cvt_pk_bf16_f32 v129, v130, v131
v_pk_mul_f16 v199, v200, v199
v_lshrrev_b32 v185, 18, v185
s_waitcnt vmcnt(6)
v_mfma_f32_16x16x32_bf16 v[64:67], v[18:21], v[4:7], v[64:67]
ds_read_b128 v[236:239], v249 offset:7424
ds_read_u16_d16 v186, v186
ds_read_u16_d16_hi v185, v185
v_cvt_pk_bf16_f32 v130, v132, v133
v_pk_mul_f16 v196, v197, v196
v_lshrrev_b32_e64 v187, 18, v187
v_mfma_f32_16x16x32_bf16 v[68:71], v[16:19], v[4:7], v[68:71]
v_cvt_pk_bf16_f32 v131, v134, v135
v_exp_f16_e64 v201, v202
v_mfma_f32_16x16x32_bf16 v[172:175], v[216:219], v[96:99], 0
ds_read_u16_d16_hi v187, v187
v_cvt_pk_bf16_f32 v160, v160, v161
v_and_b32_e64 v189, s49, v189
v_cvt_pk_bf16_f32 v161, v162, v163
v_mfma_f32_16x16x32_bf16 v[180:183], v[216:219], v[100:103], 0
v_and_b32_e64 v191, s49, v191
v_cvt_pk_bf16_f32 v162, v164, v165
v_mfma_f32_16x16x32_f16 v[68:71], v[220:223], v[208:211], v[68:71]
ds_read_b128 v[216:219], v249 offset:8192
v_exp_f16 v198, v199
v_cvt_pk_bf16_f32 v163, v166, v167
s_mov_b64 vcc, s[74:75]
v_bfe_u32 v188, v189, 2, 14
v_bfe_u32 v190, v191, 2, 14
v_mfma_f32_16x16x32_f16 v[76:79], v[220:223], v[212:215], v[76:79]
v_cndmask_b32 v148, v128, v160, vcc
v_exp_f16_e64 v195, v196
s_waitcnt lgkmcnt(2)
v_mfma_f32_16x16x32_bf16 v[168:171], v[224:227], v[104:107], v[168:171]
ds_read_b128 v[220:223], v249 offset:8448
ds_read_u16_d16 v188, v188
ds_read_u16_d16 v190, v190
v_cndmask_b32 v149, v129, v161, vcc
v_lshrrev_b32_e64 v189, 18, v189
v_cndmask_b32 v150, v130, v162, vcc
v_mfma_f32_16x16x32_bf16 v[176:179], v[224:227], v[108:111], v[176:179]
v_lshrrev_b32 v191, 18, v191
v_cndmask_b32 v151, v131, v163, vcc
v_mfma_f32_16x16x32_f16 v[80:83], v[228:231], v[208:211], v[80:83]
ds_read_b128 v[224:227], v250 offset:8192
ds_read_u16_d16_hi v189, v189
ds_read_u16_d16_hi v191, v191
v_exp_f16_sdwa v201, v202 dst_sel:WORD_1 dst_unused:UNUSED_PRESERVE src0_sel:WORD_1
v_cndmask_b32_dpp v128, v144, v128, vcc quad_perm:[1,0,3,2] row_mask:0xf bank_mask:0xf
v_and_b32_e64 v193, s49, v193
v_mfma_f32_16x16x32_f16 v[88:91], v[228:231], v[212:215], v[88:91]
v_cndmask_b32_dpp v129, v145, v129, vcc quad_perm:[1,0,3,2] row_mask:0xf bank_mask:0xf
v_bfe_u32 v192, v193, 2, 14
v_mfma_f32_16x16x32_f16 v[84:87], v[232:235], v[208:211], v[84:87]
ds_read_b128 v[228:231], v250 offset:8448
ds_read_u16_d16 v192, v192
v_exp_f16_sdwa v198, v199 dst_sel:WORD_1 dst_unused:UNUSED_PRESERVE src0_sel:WORD_1
v_cndmask_b32_dpp v130, v146, v130, vcc quad_perm:[1,0,3,2] row_mask:0xf bank_mask:0xf
v_lshrrev_b32 v193, 18, v193
v_mfma_f32_16x16x32_f16 v[92:95], v[232:235], v[212:215], v[92:95]
v_cndmask_b32_dpp v131, v147, v131, vcc quad_perm:[1,0,3,2] row_mask:0xf bank_mask:0xf
s_not_b64 vcc, s[74:75]
v_exp_f16_sdwa v195, v196 dst_sel:WORD_1 dst_unused:UNUSED_PRESERVE src0_sel:WORD_1
v_mfma_f32_16x16x32_bf16 v[172:175], v[236:239], v[104:107], v[172:175]
ds_read_b128 v[232:235], v249 offset:12288
ds_read_u16_d16_hi v193, v193
v_cndmask_b32_dpp v160, v144, v160, vcc quad_perm:[1,0,3,2] row_mask:0xf bank_mask:0xf
v_pk_add_f16 v201, v201, 1.0 op_sel_hi:[1,0]
v_cndmask_b32_dpp v161, v145, v161, vcc quad_perm:[1,0,3,2] row_mask:0xf bank_mask:0xf
v_mfma_f32_16x16x32_bf16 v[180:183], v[236:239], v[108:111], v[180:183]
v_pk_add_f16 v198, v198, 1.0 op_sel_hi:[1,0]
v_cndmask_b32_dpp v162, v146, v162, vcc quad_perm:[1,0,3,2] row_mask:0xf bank_mask:0xf
v_pk_add_f16 v195, v195, 1.0 op_sel_hi:[1,0]
s_waitcnt lgkmcnt(4)
v_mfma_f32_16x16x32_bf16 v[168:171], v[216:219], v[112:115], v[168:171]
ds_read_b128 v[236:239], v250 offset:9216
v_rcp_f16 v202, v201
v_cndmask_b32_dpp v163, v147, v163, vcc quad_perm:[1,0,3,2] row_mask:0xf bank_mask:0xf
v_mfma_f32_16x16x32_bf16 v[176:179], v[216:219], v[116:119], v[176:179]
v_rcp_f16_e64 v199, v198
v_mfma_f32_16x16x32_bf16 v[172:175], v[220:223], v[112:115], v[172:175]
ds_read_b128 v[216:219], v249 offset:12544
s_add_u32 s46, s68, 98304
buffer_store_dwordx4 v[128:131], v255, s[8:11], s46 offen sc1
v_rcp_f16_e64 v196, v195
v_rcp_f16_sdwa v202, v201 dst_sel:WORD_1 dst_unused:UNUSED_PRESERVE src0_sel:WORD_1
v_mfma_f32_16x16x32_bf16 v[180:183], v[220:223], v[116:119], v[180:183]
v_rcp_f16_sdwa v199, v198 dst_sel:WORD_1 dst_unused:UNUSED_PRESERVE src0_sel:WORD_1
v_or_b32 v208, v184, v185
v_or_b32 v209, v186, v187
v_or_b32_e64 v210, v188, v189
v_rcp_f16_sdwa v196, v195 dst_sel:WORD_1 dst_unused:UNUSED_PRESERVE src0_sel:WORD_1
v_or_b32 v211, v190, v191
s_waitcnt lgkmcnt(2)
v_or_b32_e64 v212, v192, v193
v_pk_mul_f16 v213, v203, v202
v_pk_mul_f16 v214, v200, v199
v_pk_mul_f16 v215, v197, v196
v_mfma_f32_16x16x32_f16 v[48:51], v[224:227], v[208:211], v[48:51]
ds_read_b128 v[220:223], v250 offset:9472
v_cvt_pkrtz_f16_f32 v185, v168, v169
v_cvt_pkrtz_f16_f32 v187, v170, v171
v_mfma_f32_16x16x32_f16 v[56:59], v[224:227], v[212:215], v[56:59]
v_cvt_pkrtz_f16_f32 v189, v172, v173
v_cvt_pkrtz_f16_f32 v191, v174, v175
v_mfma_f32_16x16x32_f16 v[52:55], v[228:231], v[208:211], v[52:55]
ds_read_b128 v[224:227], v249 offset:13312
v_cvt_pkrtz_f16_f32 v193, v176, v177
v_cvt_pk_f16_f32 v203, v178, v179
v_mfma_f32_16x16x32_f16 v[60:63], v[228:231], v[212:215], v[60:63]
v_cvt_pk_f16_f32 v200, v180, v181
v_cvt_pk_f16_f32 v197, v182, v183
v_mfma_f32_16x16x32_bf16 v[168:171], v[232:235], v[96:99], 0
ds_read_b128 v[228:231], v250 offset:10240
v_pk_fma_f16 v202, v203, v203, s48
v_and_b32_e64 v185, s49, v185
v_mfma_f32_16x16x32_bf16 v[176:179], v[232:235], v[100:103], 0
v_pk_fma_f16 v199, v200, v200, s48
v_and_b32 v187, s49, v187
s_waitcnt lgkmcnt(3)
v_mfma_f32_16x16x32_f16 v[64:67], v[236:239], v[208:211], v[64:67]
ds_read_b128 v[232:235], v250 offset:10496
v_pk_fma_f16 v196, v197, v197, s48
v_bfe_u32 v184, v185, 2, 14
v_pk_mul_f16 v202, v203, v202
v_mfma_f32_16x16x32_f16 v[72:75], v[236:239], v[212:215], v[72:75]
v_bfe_u32 v186, v187, 2, 14
v_pk_mul_f16 v199, v200, v199
s_waitcnt vmcnt(6)
v_mfma_f32_16x16x32_bf16 v[80:83], v[18:21], v[8:11], v[80:83]
ds_read_b128 v[236:239], v249 offset:13568
ds_read_u16_d16 v184, v184
ds_read_u16_d16 v186, v186
v_lshrrev_b32 v185, 18, v185
v_pk_mul_f16 v196, v197, v196
v_mfma_f32_16x16x32_bf16 v[84:87], v[16:19], v[8:11], v[84:87]
v_lshrrev_b32_e64 v187, 18, v187
v_mfma_f32_16x16x32_bf16 v[172:175], v[216:219], v[96:99], 0
ds_read_u16_d16_hi v185, v185
ds_read_u16_d16_hi v187, v187
v_exp_f16 v201, v202
v_and_b32 v189, s49, v189
v_mfma_f32_16x16x32_bf16 v[180:183], v[216:219], v[100:103], 0
v_and_b32 v191, s49, v191
s_waitcnt lgkmcnt(6)
v_mfma_f32_16x16x32_f16 v[68:71], v[220:223], v[208:211], v[68:71]
ds_read_b128 v[216:219], v249 offset:14336
v_exp_f16_e64 v198, v199
v_bfe_u32 v188, v189, 2, 14
v_mfma_f32_16x16x32_f16 v[76:79], v[220:223], v[212:215], v[76:79]
v_bfe_u32 v190, v191, 2, 14
v_exp_f16_e64 v195, v196
v_mfma_f32_16x16x32_bf16 v[168:171], v[224:227], v[104:107], v[168:171]
ds_read_b128 v[220:223], v249 offset:14592
ds_read_u16_d16 v188, v188
ds_read_u16_d16 v190, v190
v_lshrrev_b32 v189, 18, v189
v_lshrrev_b32 v191, 18, v191
v_mfma_f32_16x16x32_bf16 v[176:179], v[224:227], v[108:111], v[176:179]
v_exp_f16_sdwa v201, v202 dst_sel:WORD_1 dst_unused:UNUSED_PRESERVE src0_sel:WORD_1
v_mfma_f32_16x16x32_f16 v[80:83], v[228:231], v[208:211], v[80:83]
ds_read_b128 v[224:227], v250 offset:14336
ds_read_u16_d16_hi v189, v189
ds_read_u16_d16_hi v191, v191
v_and_b32 v193, s49, v193
v_bfe_u32 v192, v193, 2, 14
v_mfma_f32_16x16x32_f16 v[88:91], v[228:231], v[212:215], v[88:91]
v_exp_f16_sdwa v198, v199 dst_sel:WORD_1 dst_unused:UNUSED_PRESERVE src0_sel:WORD_1
s_waitcnt lgkmcnt(7)
v_mfma_f32_16x16x32_f16 v[84:87], v[232:235], v[208:211], v[84:87]
ds_read_b128 v[228:231], v250 offset:14592
ds_read_u16_d16 v192, v192
v_lshrrev_b32_e64 v193, 18, v193
v_mfma_f32_16x16x32_f16 v[92:95], v[232:235], v[212:215], v[92:95]
v_exp_f16_sdwa v195, v196 dst_sel:WORD_1 dst_unused:UNUSED_PRESERVE src0_sel:WORD_1
v_pk_add_f16 v201, v201, 1.0 op_sel_hi:[1,0]
v_pk_add_f16 v198, v198, 1.0 op_sel_hi:[1,0]
v_mfma_f32_16x16x32_bf16 v[172:175], v[236:239], v[104:107], v[172:175]
ds_read_b128 v[232:235], v249 offset:18432
ds_read_u16_d16_hi v193, v193
v_pk_add_f16 v195, v195, 1.0 op_sel_hi:[1,0]
v_mfma_f32_16x16x32_bf16 v[180:183], v[236:239], v[108:111], v[180:183]
v_rcp_f16 v202, v201
s_waitcnt lgkmcnt(7)
v_mfma_f32_16x16x32_bf16 v[168:171], v[216:219], v[112:115], v[168:171]
ds_read_b128 v[236:239], v250 offset:15360
v_rcp_f16_e64 v199, v198
v_mfma_f32_16x16x32_bf16 v[176:179], v[216:219], v[116:119], v[176:179]
v_rcp_f16_e64 v196, v195
v_mfma_f32_16x16x32_bf16 v[172:175], v[220:223], v[112:115], v[172:175]
ds_read_b128 v[216:219], v249 offset:18688
v_rcp_f16_sdwa v202, v201 dst_sel:WORD_1 dst_unused:UNUSED_PRESERVE src0_sel:WORD_1
v_mfma_f32_16x16x32_bf16 v[180:183], v[220:223], v[116:119], v[180:183]
v_rcp_f16_sdwa v199, v198 dst_sel:WORD_1 dst_unused:UNUSED_PRESERVE src0_sel:WORD_1
v_or_b32 v208, v184, v185
v_or_b32 v209, v186, v187
s_waitcnt lgkmcnt(4)
v_or_b32 v210, v188, v189
v_rcp_f16_sdwa v196, v195 dst_sel:WORD_1 dst_unused:UNUSED_PRESERVE src0_sel:WORD_1
v_or_b32 v211, v190, v191
s_waitcnt lgkmcnt(2)
v_or_b32_e64 v212, v192, v193
v_pk_mul_f16 v213, v203, v202
v_pk_mul_f16 v214, v200, v199
v_pk_mul_f16 v215, v197, v196
v_mfma_f32_16x16x32_f16 v[48:51], v[224:227], v[208:211], v[48:51]
s_add_u32 s46, s68, 98304
buffer_store_dwordx4 v[148:151], v255, s[8:11], s46 offen offset:128 sc1
ds_read_b128 v[220:223], v250 offset:15616
v_cvt_pkrtz_f16_f32 v185, v168, v169
v_cvt_pkrtz_f16_f32 v187, v170, v171
v_mfma_f32_16x16x32_f16 v[56:59], v[224:227], v[212:215], v[56:59]
v_cvt_pkrtz_f16_f32 v189, v172, v173
v_cvt_pkrtz_f16_f32 v191, v174, v175
v_mfma_f32_16x16x32_f16 v[52:55], v[228:231], v[208:211], v[52:55]
ds_read_b128 v[224:227], v249 offset:19456
v_cvt_pkrtz_f16_f32 v193, v176, v177
v_cvt_pk_f16_f32 v203, v178, v179
v_mfma_f32_16x16x32_f16 v[60:63], v[228:231], v[212:215], v[60:63]
v_cvt_pk_f16_f32 v200, v180, v181
v_cvt_pk_f16_f32 v197, v182, v183
v_mfma_f32_16x16x32_bf16 v[168:171], v[232:235], v[96:99], 0
ds_read_b128 v[228:231], v250 offset:16384
v_pk_fma_f16 v202, v203, v203, s48
v_and_b32_e64 v185, s49, v185
v_mfma_f32_16x16x32_bf16 v[176:179], v[232:235], v[100:103], 0
v_pk_fma_f16 v199, v200, v200, s48
v_and_b32 v187, s49, v187
s_waitcnt lgkmcnt(3)
v_mfma_f32_16x16x32_f16 v[64:67], v[236:239], v[208:211], v[64:67]
ds_read_b128 v[232:235], v250 offset:16640
v_pk_fma_f16 v196, v197, v197, s48
v_bfe_u32 v184, v185, 2, 14
v_pk_mul_f16 v202, v203, v202
v_mfma_f32_16x16x32_f16 v[72:75], v[236:239], v[212:215], v[72:75]
v_bfe_u32 v186, v187, 2, 14
v_pk_mul_f16 v199, v200, v199
s_waitcnt vmcnt(5)
v_mfma_f32_16x16x32_bf16 v[56:59], v[18:21], v[244:247], v[56:59]
ds_read_b128 v[236:239], v249 offset:19712
ds_read_u16_d16 v184, v184
ds_read_u16_d16 v186, v186
v_lshrrev_b32 v185, 18, v185
v_pk_mul_f16 v196, v197, v196
v_mfma_f32_16x16x32_bf16 v[60:63], v[16:19], v[244:247], v[60:63]
v_lshrrev_b32_e64 v187, 18, v187
v_mfma_f32_16x16x32_bf16 v[172:175], v[216:219], v[96:99], 0
ds_read_u16_d16_hi v185, v185
ds_read_u16_d16_hi v187, v187
v_exp_f16 v201, v202
v_and_b32 v189, s49, v189
v_mfma_f32_16x16x32_bf16 v[180:183], v[216:219], v[100:103], 0
v_and_b32 v191, s49, v191
s_waitcnt lgkmcnt(6)
v_mfma_f32_16x16x32_f16 v[68:71], v[220:223], v[208:211], v[68:71]
ds_read_b128 v[216:219], v249 offset:20480
v_exp_f16_e64 v198, v199
v_bfe_u32 v188, v189, 2, 14
v_mfma_f32_16x16x32_f16 v[76:79], v[220:223], v[212:215], v[76:79]
v_bfe_u32 v190, v191, 2, 14
v_exp_f16_e64 v195, v196
v_mfma_f32_16x16x32_bf16 v[168:171], v[224:227], v[104:107], v[168:171]
ds_read_b128 v[220:223], v249 offset:20736
ds_read_u16_d16 v188, v188
ds_read_u16_d16 v190, v190
v_lshrrev_b32 v189, 18, v189
v_lshrrev_b32 v191, 18, v191
v_mfma_f32_16x16x32_bf16 v[176:179], v[224:227], v[108:111], v[176:179]
v_exp_f16_sdwa v201, v202 dst_sel:WORD_1 dst_unused:UNUSED_PRESERVE src0_sel:WORD_1
v_mfma_f32_16x16x32_f16 v[80:83], v[228:231], v[208:211], v[80:83]
ds_read_b128 v[224:227], v250 offset:20480
ds_read_u16_d16_hi v189, v189
ds_read_u16_d16_hi v191, v191
v_and_b32 v193, s49, v193
v_bfe_u32 v192, v193, 2, 14
v_mfma_f32_16x16x32_f16 v[88:91], v[228:231], v[212:215], v[88:91]
v_exp_f16_sdwa v198, v199 dst_sel:WORD_1 dst_unused:UNUSED_PRESERVE src0_sel:WORD_1
s_waitcnt lgkmcnt(7)
v_mfma_f32_16x16x32_f16 v[84:87], v[232:235], v[208:211], v[84:87]
ds_read_b128 v[228:231], v250 offset:20736
ds_read_u16_d16 v192, v192
v_lshrrev_b32_e64 v193, 18, v193
v_mfma_f32_16x16x32_f16 v[92:95], v[232:235], v[212:215], v[92:95]
v_exp_f16_sdwa v195, v196 dst_sel:WORD_1 dst_unused:UNUSED_PRESERVE src0_sel:WORD_1
v_pk_add_f16 v201, v201, 1.0 op_sel_hi:[1,0]
v_pk_add_f16 v198, v198, 1.0 op_sel_hi:[1,0]
v_mfma_f32_16x16x32_bf16 v[172:175], v[236:239], v[104:107], v[172:175]
ds_read_b128 v[232:235], v250 offset:21504
ds_read_u16_d16_hi v193, v193
v_pk_add_f16 v195, v195, 1.0 op_sel_hi:[1,0]
v_mfma_f32_16x16x32_bf16 v[180:183], v[236:239], v[108:111], v[180:183]
v_rcp_f16 v202, v201
s_waitcnt lgkmcnt(7)
v_mfma_f32_16x16x32_bf16 v[168:171], v[216:219], v[112:115], v[168:171]
ds_read_b128 v[236:239], v250 offset:21760
v_rcp_f16_e64 v199, v198
v_mfma_f32_16x16x32_bf16 v[176:179], v[216:219], v[116:119], v[176:179]
v_rcp_f16_e64 v196, v195
v_mfma_f32_16x16x32_bf16 v[172:175], v[220:223], v[112:115], v[172:175]
ds_read_b128 v[216:219], v250 offset:22528
v_rcp_f16_sdwa v202, v201 dst_sel:WORD_1 dst_unused:UNUSED_PRESERVE src0_sel:WORD_1
v_mfma_f32_16x16x32_bf16 v[180:183], v[220:223], v[116:119], v[180:183]
v_rcp_f16_sdwa v199, v198 dst_sel:WORD_1 dst_unused:UNUSED_PRESERVE src0_sel:WORD_1
v_or_b32 v208, v184, v185
v_or_b32 v209, v186, v187
s_waitcnt lgkmcnt(4)
v_or_b32 v210, v188, v189
v_rcp_f16_sdwa v196, v195 dst_sel:WORD_1 dst_unused:UNUSED_PRESERVE src0_sel:WORD_1
v_or_b32 v211, v190, v191
s_waitcnt lgkmcnt(2)
v_or_b32_e64 v212, v192, v193
v_pk_mul_f16 v213, v203, v202
v_pk_mul_f16 v214, v200, v199
v_pk_mul_f16 v215, v197, v196
v_mfma_f32_16x16x32_f16 v[48:51], v[224:227], v[208:211], v[48:51]
ds_read_b128 v[220:223], v250 offset:22784
v_cvt_pkrtz_f16_f32 v185, v168, v169
v_cvt_pkrtz_f16_f32 v187, v170, v171
v_cvt_pkrtz_f16_f32 v189, v172, v173
v_cvt_pkrtz_f16_f32 v191, v174, v175
v_mfma_f32_16x16x32_f16 v[56:59], v[224:227], v[212:215], v[56:59]
v_cvt_pkrtz_f16_f32 v193, v176, v177
v_cvt_pk_f16_f32 v203, v178, v179
v_cvt_pk_f16_f32 v200, v180, v181
v_cvt_pk_f16_f32 v197, v182, v183
v_mfma_f32_16x16x32_f16 v[52:55], v[228:231], v[208:211], v[52:55]
ds_read_b128 v[224:227], v250 offset:26624
v_pk_fma_f16 v202, v203, v203, s48
v_and_b32_e64 v185, s49, v185
v_pk_fma_f16 v199, v200, v200, s48
v_and_b32_e64 v187, s49, v187
v_mfma_f32_16x16x32_f16 v[60:63], v[228:231], v[212:215], v[60:63]
v_pk_fma_f16 v196, v197, v197, s48
v_bfe_u32 v184, v185, 2, 14
v_pk_mul_f16 v202, v203, v202
v_bfe_u32 v186, v187, 2, 14
v_mfma_f32_16x16x32_f16 v[64:67], v[232:235], v[208:211], v[64:67]
ds_read_b128 v[228:231], v250 offset:26880
ds_read_u16_d16 v184, v184
ds_read_u16_d16 v186, v186
v_pk_mul_f16 v199, v200, v199
v_lshrrev_b32_e64 v185, 18, v185
v_pk_mul_f16 v196, v197, v196
v_lshrrev_b32_e64 v187, 18, v187
v_mfma_f32_16x16x32_f16 v[72:75], v[232:235], v[212:215], v[72:75]
v_exp_f16 v201, v202
v_and_b32 v189, s49, v189
v_and_b32 v191, s49, v191
s_waitcnt vmcnt(4)
v_mfma_f32_16x16x32_bf16 v[72:75], v[18:21], v[204:207], v[72:75]
ds_read_b128 v[232:235], v250 offset:27648
ds_read_u16_d16_hi v185, v185
ds_read_u16_d16_hi v187, v187
v_exp_f16_e64 v198, v199
v_bfe_u32 v188, v189, 2, 14
v_bfe_u32 v190, v191, 2, 14
v_mfma_f32_16x16x32_bf16 v[76:79], v[16:19], v[204:207], v[76:79]
v_exp_f16 v195, v196
v_lshrrev_b32 v189, 18, v189
v_lshrrev_b32 v191, 18, v191
s_waitcnt lgkmcnt(6)
v_mfma_f32_16x16x32_f16 v[68:71], v[236:239], v[208:211], v[68:71]
ds_read_u16_d16 v188, v188
ds_read_u16_d16 v190, v190
ds_read_u16_d16_hi v189, v189
ds_read_u16_d16_hi v191, v191
v_exp_f16_sdwa v201, v202 dst_sel:WORD_1 dst_unused:UNUSED_PRESERVE src0_sel:WORD_1
v_and_b32_e64 v193, s49, v193
v_bfe_u32 v192, v193, 2, 14
v_mfma_f32_16x16x32_f16 v[76:79], v[236:239], v[212:215], v[76:79]
v_exp_f16_sdwa v198, v199 dst_sel:WORD_1 dst_unused:UNUSED_PRESERVE src0_sel:WORD_1
v_lshrrev_b32_e64 v193, 18, v193
v_mfma_f32_16x16x32_f16 v[80:83], v[216:219], v[208:211], v[80:83]
ds_read_b128 v[236:239], v250 offset:27904
ds_read_u16_d16 v192, v192
ds_read_u16_d16_hi v193, v193
v_exp_f16_sdwa v195, v196 dst_sel:WORD_1 dst_unused:UNUSED_PRESERVE src0_sel:WORD_1
v_pk_add_f16 v201, v201, 1.0 op_sel_hi:[1,0]
v_pk_add_f16 v198, v198, 1.0 op_sel_hi:[1,0]
v_pk_add_f16 v195, v195, 1.0 op_sel_hi:[1,0]
v_mfma_f32_16x16x32_f16 v[88:91], v[216:219], v[212:215], v[88:91]
v_rcp_f16 v202, v201
v_rcp_f16 v199, v198
v_mfma_f32_16x16x32_f16 v[84:87], v[220:223], v[208:211], v[84:87]
ds_read_b128 v[216:219], v250 offset:28672
v_rcp_f16_e64 v196, v195
v_rcp_f16_sdwa v202, v201 dst_sel:WORD_1 dst_unused:UNUSED_PRESERVE src0_sel:WORD_1
v_mfma_f32_16x16x32_f16 v[92:95], v[220:223], v[212:215], v[92:95]
v_rcp_f16_sdwa v199, v198 dst_sel:WORD_1 dst_unused:UNUSED_PRESERVE src0_sel:WORD_1
s_waitcnt lgkmcnt(5)
v_or_b32 v208, v184, v185
v_or_b32_e64 v209, v186, v187
v_or_b32 v210, v188, v189
v_rcp_f16_sdwa v196, v195 dst_sel:WORD_1 dst_unused:UNUSED_PRESERVE src0_sel:WORD_1
s_waitcnt lgkmcnt(4)
v_or_b32 v211, v190, v191
s_waitcnt lgkmcnt(1)
v_or_b32 v212, v192, v193
v_pk_mul_f16 v213, v203, v202
v_pk_mul_f16 v214, v200, v199
v_pk_mul_f16 v215, v197, v196
v_mfma_f32_16x16x32_f16 v[48:51], v[224:227], v[208:211], v[48:51]
s_add_u32 s46, s68, 98304
buffer_store_dwordx4 v[160:163], v255, s[8:11], s46 offen offset:256 sc1
ds_read_b128 v[220:223], v250 offset:28928
v_mfma_f32_16x16x32_f16 v[56:59], v[224:227], v[212:215], v[56:59]
v_mfma_f32_16x16x32_f16 v[52:55], v[228:231], v[208:211], v[52:55]
v_mfma_f32_16x16x32_f16 v[60:63], v[228:231], v[212:215], v[60:63]
v_mfma_f32_16x16x32_f16 v[64:67], v[232:235], v[208:211], v[64:67]
v_mfma_f32_16x16x32_f16 v[72:75], v[232:235], v[212:215], v[72:75]
s_waitcnt vmcnt(3)
v_mfma_f32_16x16x32_bf16 v[88:91], v[18:21], v[0:3], v[88:91]
v_mfma_f32_16x16x32_bf16 v[92:95], v[16:19], v[0:3], v[92:95]
v_mfma_f32_16x16x32_f16 v[68:71], v[236:239], v[208:211], v[68:71]
v_mfma_f32_16x16x32_f16 v[76:79], v[236:239], v[212:215], v[76:79]
s_waitcnt lgkmcnt(1)
v_mfma_f32_16x16x32_f16 v[80:83], v[216:219], v[208:211], v[80:83]
v_mfma_f32_16x16x32_f16 v[88:91], v[216:219], v[212:215], v[88:91]
s_waitcnt lgkmcnt(0)
v_mfma_f32_16x16x32_f16 v[84:87], v[220:223], v[208:211], v[84:87]
v_mfma_f32_16x16x32_f16 v[92:95], v[220:223], v[212:215], v[92:95]
v_cvt_pk_bf16_f32 v64, v64, v65
v_cvt_pk_bf16_f32 v65, v66, v67
v_cvt_pk_bf16_f32 v66, v68, v69
v_cvt_pk_bf16_f32 v67, v70, v71
v_cvt_pk_bf16_f32 v48, v48, v49
v_cvt_pk_bf16_f32 v49, v50, v51
v_cvt_pk_bf16_f32 v50, v52, v53
v_cvt_pk_bf16_f32 v51, v54, v55
v_cvt_pk_bf16_f32 v80, v80, v81
v_cvt_pk_bf16_f32 v81, v82, v83
v_cvt_pk_bf16_f32 v82, v84, v85
v_cvt_pk_bf16_f32 v83, v86, v87
s_mov_b64 vcc, s[74:75]
v_cndmask_b32 v68, v48, v80, vcc
v_cndmask_b32 v69, v49, v81, vcc
v_cndmask_b32 v70, v50, v82, vcc
v_cndmask_b32 v71, v51, v83, vcc
v_cndmask_b32_dpp v48, v64, v48, vcc quad_perm:[1,0,3,2] row_mask:0xf bank_mask:0xf
v_cndmask_b32_dpp v49, v65, v49, vcc quad_perm:[1,0,3,2] row_mask:0xf bank_mask:0xf
v_cndmask_b32_dpp v50, v66, v50, vcc quad_perm:[1,0,3,2] row_mask:0xf bank_mask:0xf
v_cndmask_b32_dpp v51, v67, v51, vcc quad_perm:[1,0,3,2] row_mask:0xf bank_mask:0xf
s_not_b64 vcc, s[74:75]
v_cndmask_b32_dpp v80, v64, v80, vcc quad_perm:[1,0,3,2] row_mask:0xf bank_mask:0xf
v_cndmask_b32_dpp v81, v65, v81, vcc quad_perm:[1,0,3,2] row_mask:0xf bank_mask:0xf
v_cndmask_b32_dpp v82, v66, v82, vcc quad_perm:[1,0,3,2] row_mask:0xf bank_mask:0xf
v_cndmask_b32_dpp v83, v67, v83, vcc quad_perm:[1,0,3,2] row_mask:0xf bank_mask:0xf
buffer_store_dwordx4 v[48:51], v255, s[8:11], s69 offen sc1
buffer_store_dwordx4 v[68:71], v255, s[8:11], s69 offen offset:128 sc1
buffer_store_dwordx4 v[80:83], v255, s[8:11], s69 offen offset:256 sc1
v_cvt_pk_bf16_f32 v72, v72, v73
v_cvt_pk_bf16_f32 v73, v74, v75
v_cvt_pk_bf16_f32 v74, v76, v77
v_cvt_pk_bf16_f32 v75, v78, v79
v_cvt_pk_bf16_f32 v56, v56, v57
v_cvt_pk_bf16_f32 v57, v58, v59
v_cvt_pk_bf16_f32 v58, v60, v61
v_cvt_pk_bf16_f32 v59, v62, v63
v_cvt_pk_bf16_f32 v88, v88, v89
v_cvt_pk_bf16_f32 v89, v90, v91
v_cvt_pk_bf16_f32 v90, v92, v93
v_cvt_pk_bf16_f32 v91, v94, v95
s_mov_b64 vcc, s[74:75]
v_cndmask_b32 v76, v56, v88, vcc
v_cndmask_b32 v77, v57, v89, vcc
v_cndmask_b32 v78, v58, v90, vcc
v_cndmask_b32 v79, v59, v91, vcc
v_cndmask_b32_dpp v56, v72, v56, vcc quad_perm:[1,0,3,2] row_mask:0xf bank_mask:0xf
v_cndmask_b32_dpp v57, v73, v57, vcc quad_perm:[1,0,3,2] row_mask:0xf bank_mask:0xf
v_cndmask_b32_dpp v58, v74, v58, vcc quad_perm:[1,0,3,2] row_mask:0xf bank_mask:0xf
v_cndmask_b32_dpp v59, v75, v59, vcc quad_perm:[1,0,3,2] row_mask:0xf bank_mask:0xf
s_not_b64 vcc, s[74:75]
v_cndmask_b32_dpp v88, v72, v88, vcc quad_perm:[1,0,3,2] row_mask:0xf bank_mask:0xf
v_cndmask_b32_dpp v89, v73, v89, vcc quad_perm:[1,0,3,2] row_mask:0xf bank_mask:0xf
v_cndmask_b32_dpp v90, v74, v90, vcc quad_perm:[1,0,3,2] row_mask:0xf bank_mask:0xf
v_cndmask_b32_dpp v91, v75, v91, vcc quad_perm:[1,0,3,2] row_mask:0xf bank_mask:0xf
s_add_u32 s46, s69, 98304
buffer_store_dwordx4 v[56:59], v255, s[8:11], s46 offen sc1
s_add_u32 s46, s69, 98304
buffer_store_dwordx4 v[76:79], v255, s[8:11], s46 offen offset:128 sc1
s_add_u32 s46, s69, 98304
buffer_store_dwordx4 v[88:91], v255, s[8:11], s46 offen offset:256 sc1
s_endpgm
Lpoll:
s_waitcnt vmcnt(0)
s_cmp_eq_u32 s77, 2
s_cbranch_scc1 LpollC
v_max_u32 v255, v156, v157
v_max3_u32 v255, v255, v158, v159
v_max3_u32 v255, v255, v160, v161
v_max3_u32 v255, v255, v162, v163
v_max3_u32 v255, v255, v164, v165
v_max3_u32 v255, v255, v166, v167
v_max3_u32 v255, v255, v240, v241
v_max3_u32 v255, v255, v242, v243
v_cmp_eq_u32 vcc, -1, v255
s_nop 4
s_cbranch_vccz LpollR
v_lshlrev_b32 v247, 4, v251
s_lshl_b32 s44, s2, 12
buffer_load_dwordx4 v[156:159], v247, s[32:35], s44 offen sc1
buffer_load_dwordx4 v[160:163], v247, s[32:35], s44 offen offset:1024 sc1
buffer_load_dwordx4 v[164:167], v247, s[32:35], s44 offen offset:2048 sc1
buffer_load_dwordx4 v[240:243], v247, s[32:35], s44 offen offset:3072 sc1
s_setpc_b64 s[78:79]
LpollR:
s_setprio 3
v_add_f32 v156, v156, v160
v_add_f32 v240, v164, v240
v_add_f32 v240, v156, v240
v_add_f32 v157, v157, v161
v_add_f32 v241, v165, v241
v_add_f32 v241, v157, v241
v_add_f32 v158, v158, v162
v_add_f32 v242, v166, v242
v_add_f32 v242, v158, v242
v_add_f32 v159, v159, v163
v_add_f32 v243, v167, v243
v_add_f32 v243, v159, v243
v_add_f32_dpp v240, v240, v240 row_ror:8 row_mask:0xf bank_mask:0xf
s_nop 1
v_add_f32_dpp v240, v240, v240 row_ror:4 row_mask:0xf bank_mask:0xf
s_nop 1
v_add_f32_dpp v240, v240, v240 row_ror:2 row_mask:0xf bank_mask:0xf
s_nop 1
v_add_f32_dpp v240, v240, v240 row_ror:1 row_mask:0xf bank_mask:0xf
v_mov_b32 v255, v240
s_nop 1
v_permlane16_swap_b32 v240, v255
v_add_f32 v240, v240, v255
v_mov_b32 v255, v240
s_nop 1
v_permlane32_swap_b32 v240, v255
v_add_f32 v240, v240, v255
v_min_u32 v240, -2, v240
v_add_f32_dpp v241, v241, v241 row_ror:8 row_mask:0xf bank_mask:0xf
s_nop 1
v_add_f32_dpp v241, v241, v241 row_ror:4 row_mask:0xf bank_mask:0xf
s_nop 1
v_add_f32_dpp v241, v241, v241 row_ror:2 row_mask:0xf bank_mask:0xf
s_nop 1
v_add_f32_dpp v241, v241, v241 row_ror:1 row_mask:0xf bank_mask:0xf
v_mov_b32 v255, v241
s_nop 1
v_permlane16_swap_b32 v241, v255
v_add_f32 v241, v241, v255
v_mov_b32 v255, v241
s_nop 1
v_permlane32_swap_b32 v241, v255
v_add_f32 v241, v241, v255
v_min_u32 v241, -2, v241
v_add_f32_dpp v242, v242, v242 row_ror:8 row_mask:0xf bank_mask:0xf
s_nop 1
v_add_f32_dpp v242, v242, v242 row_ror:4 row_mask:0xf bank_mask:0xf
s_nop 1
v_add_f32_dpp v242, v242, v242 row_ror:2 row_mask:0xf bank_mask:0xf
s_nop 1
v_add_f32_dpp v242, v242, v242 row_ror:1 row_mask:0xf bank_mask:0xf
v_mov_b32 v255, v242
s_nop 1
v_permlane16_swap_b32 v242, v255
v_add_f32 v242, v242, v255
v_mov_b32 v255, v242
s_nop 1
v_permlane32_swap_b32 v242, v255
v_add_f32 v242, v242, v255
v_min_u32 v242, -2, v242
v_add_f32_dpp v243, v243, v243 row_ror:8 row_mask:0xf bank_mask:0xf
s_nop 1
v_add_f32_dpp v243, v243, v243 row_ror:4 row_mask:0xf bank_mask:0xf
s_nop 1
v_add_f32_dpp v243, v243, v243 row_ror:2 row_mask:0xf bank_mask:0xf
s_nop 1
v_add_f32_dpp v243, v243, v243 row_ror:1 row_mask:0xf bank_mask:0xf
v_mov_b32 v255, v243
s_nop 1
v_permlane16_swap_b32 v243, v255
v_add_f32 v243, v243, v255
v_mov_b32 v255, v243
s_nop 1
v_permlane32_swap_b32 v243, v255
v_add_f32_e64 v243, v243, v255
v_min_u32 v243, -2, v243
s_lshl_b32 s44, s2, 4
s_add_u32 s44, s44, 393216
v_lshlrev_b32_e64 v255, 11, v251
s_mov_b64 exec, 0xff
buffer_store_dwordx4 v[240:243], v255, s[32:35], s44 offen sc1
s_mov_b64 exec, -1
s_mov_b32 s77, 2
v_lshlrev_b32_e64 v247, 3, v251
s_and_b32 s44, s2, 7
s_lshl_b32 s44, s44, 11
s_add_u32 s44, s44, 393216
buffer_load_dwordx2 v[156:157], v247, s[32:35], s44 offen sc1
buffer_load_dwordx2 v[158:159], v247, s[32:35], s44 offen offset:512 sc1
buffer_load_dwordx2 v[160:161], v247, s[32:35], s44 offen offset:1024 sc1
s_setpc_b64 s[78:79]
LpollC:
v_max3_u32 v255, v156, v157, v158
v_max3_u32 v255, v255, v159, v160
v_max_u32 v255, v255, v161
v_cmp_eq_u32 vcc, -1, v255
s_nop 4
s_cbranch_vccz LpollS
v_lshlrev_b32 v247, 3, v251
s_and_b32 s44, s2, 7
s_lshl_b32 s44, s44, 11
s_add_u32 s44, s44, 393216
buffer_load_dwordx2 v[156:157], v247, s[32:35], s44 offen sc1
buffer_load_dwordx2 v[158:159], v247, s[32:35], s44 offen offset:512 sc1
buffer_load_dwordx2 v[160:161], v247, s[32:35], s44 offen offset:1024 sc1
s_setpc_b64 s[78:79]
LpollS:
s_setprio 3
s_mov_b32 s43, 1083296634
v_mov_b32 v162, 897988541
v_fma_f32 v156, v156, s43, v162
v_fma_f32 v157, v157, s43, v162
v_fma_f32 v158, v158, s43, v162
v_fma_f32 v159, v159, s43, v162
v_fma_f32 v160, v160, s43, v162
v_fma_f32 v161, v161, s43, v162
v_sqrt_f32 v156, v156
v_sqrt_f32 v157, v157
v_sqrt_f32 v158, v158
v_sqrt_f32 v159, v159
v_sqrt_f32 v160, v160
v_sqrt_f32 v161, v161
v_add_f32 v163, v156, v157
v_add_f32 v163, v163, v158
v_add_f32 v163, v163, v159
v_add_f32 v163, v163, v160
v_add_f32 v163, v163, v161
s_nop 1
v_add_f32_dpp v163, v163, v163 row_ror:8 row_mask:0xf bank_mask:0xf
s_nop 1
v_add_f32_dpp v163, v163, v163 row_ror:4 row_mask:0xf bank_mask:0xf
s_nop 1
v_add_f32_dpp v163, v163, v163 row_ror:2 row_mask:0xf bank_mask:0xf
s_nop 1
v_add_f32_dpp v163, v163, v163 row_ror:1 row_mask:0xf bank_mask:0xf
v_mov_b32 v255, v163
s_nop 1
v_permlane16_swap_b32 v163, v255
v_add_f32 v163, v163, v255
v_mov_b32 v255, v163
s_nop 1
v_permlane32_swap_b32 v163, v255
v_add_f32_e64 v163, v163, v255
s_mov_b32 s43, 992651947
v_fma_f32 v163, v163, s43, v162
v_rcp_f32_e64 v163, v163
v_mov_b32 v162, 3221789604
v_mul_f32 v163, v163, v162
v_lshlrev_b32 v164, 16, v244
v_and_b32 v165, 4294901760, v244
v_mul_f32 v156, v156, v163
v_mul_f32 v157, v157, v163
v_fma_f32 v164, v164, v156, v162
v_fma_f32 v165, v165, v157, v162
v_cvt_pk_f16_f32 v244, v164, v165
v_lshlrev_b32_e64 v164, 16, v245
v_and_b32 v165, 4294901760, v245
v_mul_f32 v158, v158, v163
v_mul_f32 v159, v159, v163
v_fma_f32 v164, v164, v158, v162
v_fma_f32 v165, v165, v159, v162
v_cvt_pk_f16_f32 v245, v164, v165
v_lshlrev_b32_e64 v164, 16, v246
v_and_b32 v165, 4294901760, v246
v_mul_f32 v160, v160, v163
v_mul_f32 v161, v161, v163
v_fma_f32 v164, v164, v160, v162
v_fma_f32 v165, v165, v161, v162
v_cvt_pk_f16_f32 v246, v164, v165
s_mov_b32 s77, 0
s_setpc_b64 s[78:79]
Lend:
s_endpgm

.section .rodata,"a"
.p2align 6
.amdhsa_kernel standalone__modern_conv_block_convnext_v2__vision_kernel
  .amdhsa_next_free_vgpr 256
  .amdhsa_next_free_sgpr 102
  .amdhsa_accum_offset 256
  .amdhsa_group_segment_fixed_size 0
  .amdhsa_kernarg_size 72
  .amdhsa_user_sgpr_count 2
  .amdhsa_user_sgpr_kernarg_segment_ptr 1
  .amdhsa_system_sgpr_workgroup_id_x 1
.end_amdhsa_kernel
```

```asm
; @launch grid=(256,1,1) block=(512,1,1) lds=163840
.amdgcn_target "amdgcn-amd-amdhsa--gfx950"
.text
.globl standalone__modern_conv_block_convnext_v2__vision_kernel
.p2align 8
.type standalone__modern_conv_block_convnext_v2__vision_kernel,@function
standalone__modern_conv_block_convnext_v2__vision_kernel:
Lmain:
s_cmp_ge_u32 s2, 256
s_cbranch_scc1 Lend
s_load_dwordx16 s[80:95], s[0:1], 0
s_load_dwordx2 s[96:97], s[0:1], 64
s_getpc_b64 s[74:75]
Lpc0:
s_sub_u32 s74, s74, Lpc0-Lmain
s_subb_u32 s75, s75, 0
v_lshlrev_b32 v159, 7, v0
s_movk_i32 s43, 64
v_cmp_gt_u32 vcc, s43, v0
s_and_saveexec_b64 s[78:79], vcc
s_cbranch_execz Lpf0x
global_load_dword v255, v159, s[74:75]
Lpf0x:
s_mov_b64 exec, s[78:79]
v_mov_b32 v199, v0
v_and_b32 v251, 63, v0
v_lshrrev_b32 v120, 6, v0
s_nop 0
v_readfirstlane_b32 s40, v120
s_and_b32 s43, s2, 7
s_lshr_b32 s44, s2, 3
s_and_b32 s41, s43, 3
s_lshl_b32 s41, s41, 2
s_and_b32 s45, s44, 3
s_add_u32 s41, s41, s45
s_lshr_b32 s42, s43, 2
s_lshl_b32 s42, s42, 3
s_lshr_b32 s45, s44, 2
s_add_u32 s42, s42, s45
s_lshl_b32 s41, s41, 5
s_lshl_b32 s42, s42, 5
s_lshl_b32 s67, s40, 6
s_cmp_eq_u32 s40, 6
s_cselect_b32 s67, 352, s67
v_add_u32_e64 v125, s67, v251
v_mul_u32_u24 v121, 5462, v125
v_lshrrev_b32 v121, 16, v121
v_mul_u32_u24 v122, 12, v121
v_sub_u32 v122, v125, v122
v_bfe_u32 v123, v121, 2, 2
v_xor_b32 v122, v122, v123
v_add_u32 v123, s41, v121
v_subrev_u32 v123, 1, v123
v_mul_u32_u24 v124, 192, v123
v_lshl_add_u32 v124, v122, 4, v124
v_mov_b32 v240, 2147483648
s_movk_i32 s43, 512
v_cmp_gt_u32 vcc, s43, v123
s_nop 1
v_cndmask_b32 v124, v240, v124, vcc
v_cmp_gt_u32 vcc, 34, v121
s_nop 1
v_cndmask_b32 v240, v240, v124, vcc
s_add_i32 s43, s42, -1
s_mul_i32 s44, s43, 98304
s_cmp_lt_u32 s43, 512
s_cselect_b32 s46, s44, 1073741824
s_mul_i32 s66, s42, 98304
s_mov_b32 s6, 50331648
s_mov_b32 s7, 131072
s_lshl_b32 s67, s67, 4
s_add_u32 s67, s67, 90112
s_cmp_eq_u32 s40, 7
s_cselect_b32 s67, 163840, s67
v_lshlrev_b32 v130, 1, v199
v_add_u32 v155, 768, v199
v_min_u32 v155, 863, v155
v_lshlrev_b32_e64 v131, 1, v155
s_waitcnt lgkmcnt(0)
s_mov_b32 s4, s80
s_and_b32 s5, s81, 65535
s_cmp_ge_u32 s40, 4
s_cbranch_scc1 Lnodw
s_mov_b32 s20, s82
s_and_b32 s21, s83, 65535
s_mov_b32 s22, 1728
s_mov_b32 s23, 131072
buffer_load_ushort v126, v130, s[20:23], 0 offen offset:0
buffer_load_ushort v127, v130, s[20:23], 0 offen offset:512
buffer_load_ushort v128, v130, s[20:23], 0 offen offset:1024
buffer_load_ushort v129, v131, s[20:23], 0 offen offset:0
Lnodw:
s_cmp_eq_u32 s40, 7
s_cbranch_scc1 Lskipx0
s_add_u32 m0, s67, 0
s_nop 0
buffer_load_dwordx4 v240, s[4:7], s46 offen nt lds
s_add_u32 m0, s67, 6656
s_nop 0
buffer_load_dwordx4 v240, s[4:7], s66 offen nt lds
s_add_u32 m0, s67, 13312
s_add_u32 s45, s66, 98304
buffer_load_dwordx4 v240, s[4:7], s45 offen nt lds
s_add_u32 m0, s67, 19968
s_add_u32 s45, s66, 196608
buffer_load_dwordx4 v240, s[4:7], s45 offen nt lds
s_add_u32 m0, s67, 26624
s_add_u32 s45, s66, 294912
buffer_load_dwordx4 v240, s[4:7], s45 offen nt lds
s_add_u32 m0, s67, 33280
s_add_u32 s45, s66, 393216
buffer_load_dwordx4 v240, s[4:7], s45 offen nt lds
Lskipx0:
s_mov_b32 s12, s84
s_and_b32 s13, s85, 65535
s_mov_b32 s14, 73728
s_mov_b32 s15, 131072
v_lshrrev_b32 v145, 2, v251
v_mul_u32_u24 v145, 768, v145
v_and_b32_e64 v125, 3, v251
v_lshl_add_u32 v145, v125, 4, v145
s_and_b32 s43, s40, 3
s_lshl_b32 s3, s43, 6
s_mul_i32 s77, s43, 6144
s_add_u32 s77, s77, 16384
v_mov_b32 v253, 16256
v_mov_b32 v254, 1
s_add_u32 s43, s42, s40
s_add_u32 s43, s43, 1
s_lshl_b32 s43, s43, 9
s_add_u32 s43, s43, s41
s_mul_i32 s47, s43, 192
s_sub_u32 s47, s47, 256
s_and_b32 s43, s40, 1
s_lshl_b32 s46, s43, 4
s_add_u32 s41, s41, s46
s_and_b32 s43, s40, 6
s_add_u32 s42, s42, s43
s_mul_i32 s45, s43, 6656
s_add_u32 s45, s45, 90112
v_and_b32 v131, 15, v251
v_lshrrev_b32 v132, 4, v251
v_mul_u32_u24 v122, 6656, v132
v_add_u32 v122, s45, v122
v_add_u32 v121, s46, v131
v_mul_u32_u24 v123, 192, v121
v_bfe_u32 v124, v121, 2, 2
v_lshl_add_u32 v123, v124, 4, v123
v_add_u32 v242, v122, v123
v_add_u32 v121, 1, v121
v_mul_u32_u24 v123, 192, v121
v_bfe_u32 v124, v121, 2, 2
v_lshl_add_u32 v123, v124, 4, v123
v_add_u32 v243, v122, v123
v_add_u32 v121, 1, v121
v_mul_u32_u24 v123, 192, v121
v_bfe_u32 v124, v121, 2, 2
v_lshl_add_u32 v123, v124, 4, v123
v_add_u32_e64 v244, v122, v123
s_mul_i32 s72, s40, 9216
s_add_u32 s72, s72, 90112
v_bfe_u32 v133, v131, 2, 1
v_sub_u32 v133, v132, v133
v_lshrrev_b32 v134, 3, v131
v_and_b32_e64 v135, 3, v131
v_lshl_add_u32 v135, v134, 2, v135
v_lshlrev_b32_e64 v136, 7, v133
v_lshl_add_u32 v136, v135, 4, v136
v_add_u32 v136, 156672, v136
v_mov_b32 v135, 163840
v_cmp_gt_u32 vcc, 3, v133
s_nop 1
v_cndmask_b32 v245, v135, v136, vcc
v_and_b32 v135, 3, v131
v_mul_u32_u24 v246, 85, v135
s_mov_b32 s16, s86
s_and_b32 s17, s87, 65535
s_mov_b32 s18, 73728
s_mov_b32 s19, 131072
s_mov_b32 s24, s88
s_and_b32 s25, s89, 65535
s_mov_b32 s26, 768
s_mov_b32 s27, 131072
s_mov_b32 s28, s90
s_and_b32 s29, s91, 65535
s_mov_b32 s30, 768
s_mov_b32 s31, 131072
s_mov_b32 s8, s92
s_and_b32 s9, s93, 65535
s_mov_b32 s10, 50331648
s_mov_b32 s11, 131072
s_mov_b32 s36, s94
s_and_b32 s37, s95, 65535
s_mov_b32 s38, 256
s_mov_b32 s39, 131072
s_mov_b32 s32, s96
s_and_b32 s33, s97, 65535
s_mov_b32 s34, 83886080
s_mov_b32 s35, 131072
v_lshlrev_b32 v241, 4, v251
v_and_b32 v133, 35, v251
v_bfe_u32 v134, v251, 2, 2
v_lshl_add_u32 v133, v134, 3, v133
v_bfe_u32 v134, v251, 4, 1
v_lshl_add_u32 v133, v134, 2, v133
v_lshlrev_b32_e64 v248, 4, v133
v_add_u32 v249, 65536, v248
v_add_u32 v250, 131072, v248
s_lshl_b32 s73, s2, 3
s_add_u32 s73, s73, s40
s_lshl_b32 s80, s73, 10
s_add_u32 s80, s80, 4194304
s_mul_i32 s73, s73, 16
s_add_u32 s73, s73, 1048576
s_mul_i32 s46, s41, 192
s_add_u32 s43, s42, 0
s_mul_i32 s43, s43, 98304
s_add_u32 s68, s43, s46
s_add_u32 s43, s42, 8
s_mul_i32 s43, s43, 98304
s_add_u32 s69, s43, s46
s_add_u32 s43, s42, 16
s_mul_i32 s43, s43, 98304
s_add_u32 s70, s43, s46
s_add_u32 s43, s42, 24
s_mul_i32 s43, s43, 98304
s_add_u32 s71, s43, s46
s_mul_i32 s82, s40, 9216
s_mov_b32 s48, 1156203754
s_mov_b32 s49, 4294508536
s_mov_b32 s76, 400000
v_lshrrev_b32 v148, 5, v251
v_lshlrev_b32 v146, 8, v148
v_bfe_u32 v148, v251, 2, 2
v_lshl_add_u32 v146, v148, 6, v146
v_bfe_u32 v148, v251, 4, 1
v_lshl_add_u32 v146, v148, 5, v146
v_bfe_u32 v148, v251, 0, 1
v_lshl_add_u32 v146, v148, 4, v146
v_bfe_u32 v148, v251, 1, 1
v_lshl_add_u32 v146, v148, 3, v146
v_add_u32 v146, s77, v146
v_add_u32 v147, s77, v248
s_cmp_lt_u32 s40, 4
s_cbranch_scc1 Lnoy
v_lshlrev_b32_e64 v24, 6, v199
s_mov_b32 s43, 1065362610
v_mov_b32 v25, 1084047360
v_add_u32 v0, 32772, v24
v_add_u32 v1, 32780, v24
v_add_u32 v2, 32788, v24
v_add_u32 v3, 32796, v24
v_add_u32 v4, 32804, v24
v_add_u32 v5, 32812, v24
v_add_u32 v6, 32820, v24
v_add_u32 v7, 32828, v24
v_cvt_f32_f16 v0, v0
v_cvt_f32_f16 v1, v1
v_cvt_f32_f16 v2, v2
v_cvt_f32_f16 v3, v3
v_cvt_f32_f16 v4, v4
v_cvt_f32_f16 v5, v5
v_cvt_f32_f16 v6, v6
v_cvt_f32_f16 v7, v7
v_mul_f32 v8, v0, v0
v_mul_f32 v9, v1, v1
v_mul_f32 v10, v2, v2
v_mul_f32 v11, v3, v3
v_mul_f32 v12, v4, v4
v_mul_f32 v13, v5, v5
v_mul_f32 v14, v6, v6
v_mul_f32 v15, v7, v7
v_fma_f32 v8, v8, s43, v25
v_fma_f32 v9, v9, s43, v25
v_fma_f32 v10, v10, s43, v25
v_fma_f32 v11, v11, s43, v25
v_fma_f32 v12, v12, s43, v25
v_fma_f32 v13, v13, s43, v25
v_fma_f32 v14, v14, s43, v25
v_fma_f32 v15, v15, s43, v25
v_mul_f32 v8, v0, v8
v_mul_f32 v9, v1, v9
v_mul_f32 v10, v2, v10
v_mul_f32 v11, v3, v11
v_mul_f32 v12, v4, v12
v_mul_f32 v13, v5, v13
v_mul_f32 v14, v6, v14
v_mul_f32 v15, v7, v15
v_exp_f32 v8, v8
v_exp_f32 v9, v9
v_exp_f32 v10, v10
v_exp_f32 v11, v11
v_exp_f32 v12, v12
v_exp_f32 v13, v13
v_exp_f32 v14, v14
v_exp_f32 v15, v15
v_add_f32 v16, 1.0, v8
v_add_f32 v17, 1.0, v9
v_add_f32 v18, 1.0, v10
v_add_f32 v19, 1.0, v11
v_add_f32 v20, 1.0, v12
v_add_f32 v21, 1.0, v13
v_add_f32 v22, 1.0, v14
v_add_f32 v23, 1.0, v15
v_rcp_f32 v16, v16
v_rcp_f32 v17, v17
v_rcp_f32 v18, v18
v_rcp_f32 v19, v19
v_rcp_f32 v20, v20
v_rcp_f32 v21, v21
v_rcp_f32 v22, v22
v_rcp_f32 v23, v23
v_mul_f32 v0, v0, v16
v_mul_f32 v1, v1, v17
v_mul_f32 v2, v2, v18
v_mul_f32 v3, v3, v19
v_mul_f32 v4, v4, v20
v_mul_f32 v5, v5, v21
v_mul_f32 v6, v6, v22
v_mul_f32 v7, v7, v23
v_mul_f32 v8, v8, v0
v_mul_f32 v9, v9, v1
v_mul_f32 v10, v10, v2
v_mul_f32 v11, v11, v3
v_mul_f32 v12, v12, v4
v_mul_f32 v13, v13, v5
v_mul_f32 v14, v14, v6
v_mul_f32 v15, v15, v7
v_cvt_pk_f16_f32 v28, v0, v1
v_cvt_pk_f16_f32 v32, -v8, -v9
v_cvt_pk_f16_f32 v29, v2, v3
v_cvt_pk_f16_f32 v33, -v10, -v11
v_cvt_pk_f16_f32 v30, v4, v5
v_cvt_pk_f16_f32 v34, -v12, -v13
v_cvt_pk_f16_f32 v31, v6, v7
v_cvt_pk_f16_f32 v35, -v14, -v15
v_lshlrev_b32_e64 v24, 4, v199
v_mov_b32 v25, 163840
s_movk_i32 s43, 496
v_cmp_gt_u32 vcc, s43, v199
s_nop 1
v_cndmask_b32 v24, v25, v24, vcc
ds_write_b128 v24, v[32:35]
ds_write_b128 v24, v[28:31] offset:8192
Lnoy:
s_cmp_ge_u32 s40, 4
s_cbranch_scc1 Lnoo
v_add_u32_e64 v152, 0, v199
v_mul_u32_u24 v140, 683, v152
v_lshrrev_b32 v140, 16, v140
v_mul_u32_u24 v142, 11, v140
v_lshrrev_b32 v142, 5, v142
v_lshrrev_b32 v143, 5, v152
v_bfe_u32 v141, v152, 3, 2
v_bfe_u32 v144, v152, 4, 1
v_xor_b32 v141, v141, v144
v_sub_u32 v141, v141, v142
v_mul_i32_i24 v141, 9, v141
v_add_u32 v143, v143, v141
v_lshrrev_b32_e64 v141, 1, v143
v_mul_u32_u24 v141, 368, v141
v_lshl_add_u32 v143, v143, 3, v141
v_lshl_add_u32 v143, v142, 7, v143
v_and_b32_e64 v144, 7, v152
v_lshl_add_u32 v143, v144, 4, v143
v_add_u32 v156, 156672, v143
v_add_u32 v153, 256, v199
v_mul_u32_u24 v140, 683, v153
v_lshrrev_b32 v140, 16, v140
v_mul_u32_u24 v142, 11, v140
v_lshrrev_b32 v142, 5, v142
v_lshrrev_b32 v143, 5, v153
v_bfe_u32 v141, v153, 3, 2
v_bfe_u32 v144, v153, 4, 1
v_xor_b32 v141, v141, v144
v_sub_u32 v141, v141, v142
v_mul_i32_i24 v141, 9, v141
v_add_u32 v143, v143, v141
v_lshrrev_b32_e64 v141, 1, v143
v_mul_u32_u24 v141, 368, v141
v_lshl_add_u32 v143, v143, 3, v141
v_lshl_add_u32 v143, v142, 7, v143
v_and_b32_e64 v144, 7, v153
v_lshl_add_u32 v143, v144, 4, v143
v_add_u32 v157, 156672, v143
v_add_u32 v154, 512, v199
v_mul_u32_u24 v140, 683, v154
v_lshrrev_b32 v140, 16, v140
v_mul_u32_u24 v142, 11, v140
v_lshrrev_b32 v142, 5, v142
v_lshrrev_b32 v143, 5, v154
v_bfe_u32 v141, v154, 3, 2
v_bfe_u32 v144, v154, 4, 1
v_xor_b32 v141, v141, v144
v_sub_u32 v141, v141, v142
v_mul_i32_i24 v141, 9, v141
v_add_u32 v143, v143, v141
v_lshrrev_b32_e64 v141, 1, v143
v_mul_u32_u24 v141, 368, v141
v_lshl_add_u32 v143, v143, 3, v141
v_lshl_add_u32 v143, v142, 7, v143
v_and_b32_e64 v144, 7, v154
v_lshl_add_u32 v143, v144, 4, v143
v_add_u32 v158, 156672, v143
v_mul_u32_u24 v140, 683, v155
v_lshrrev_b32 v140, 16, v140
v_mul_u32_u24 v142, 11, v140
v_lshrrev_b32 v142, 5, v142
v_lshrrev_b32 v143, 5, v155
v_bfe_u32 v141, v155, 3, 2
v_bfe_u32 v144, v155, 4, 1
v_xor_b32 v141, v141, v144
v_sub_u32 v141, v141, v142
v_mul_i32_i24 v141, 9, v141
v_add_u32 v143, v143, v141
v_lshrrev_b32_e64 v141, 1, v143
v_mul_u32_u24 v141, 368, v141
v_lshl_add_u32 v143, v143, 3, v141
v_lshl_add_u32 v143, v142, 7, v143
v_and_b32_e64 v144, 7, v155
v_lshl_add_u32 v143, v144, 4, v143
v_add_u32 v159, 156672, v143
v_mov_b32 v160, 0
v_mov_b32 v161, 0
v_mov_b32_e64 v162, 0
v_mov_b32 v163, 0
s_mov_b64 exec, 1
ds_write_b128 v253, v[160:163]
ds_write_b128 v253, v[160:163] offset:16
s_mov_b64 exec, -1
s_waitcnt vmcnt(6)
v_and_b32_e64 v130, 4, v152
v_cmp_eq_u32 vcc, 0, v130
s_nop 1
v_cndmask_b32 v164, 0, v126, vcc
v_sub_u32 v165, v126, v164
ds_write_b64 v156, v[164:165]
v_and_b32_e64 v130, 4, v153
v_cmp_eq_u32 vcc, 0, v130
s_nop 1
v_cndmask_b32 v166, 0, v127, vcc
v_sub_u32 v167, v127, v166
ds_write_b64 v157, v[166:167]
v_and_b32_e64 v130, 4, v154
v_cmp_eq_u32 vcc, 0, v130
s_nop 1
v_cndmask_b32 v168, 0, v128, vcc
v_sub_u32 v169, v128, v168
ds_write_b64 v158, v[168:169]
v_and_b32_e64 v130, 4, v155
v_cmp_eq_u32 vcc, 0, v130
s_nop 1
v_cndmask_b32 v170, 0, v129, vcc
v_sub_u32 v171, v129, v170
ds_write_b64 v159, v[170:171]
s_waitcnt lgkmcnt(0)
Lnoo:
s_barrier
s_cmp_lt_u32 s40, 4
s_cbranch_scc1 Lnoy2
v_subrev_u32 v199, 256, v199
v_lshlrev_b32_e64 v24, 6, v199
s_mov_b32 s43, 1065362610
v_mov_b32 v25, 1084047360
v_add_u32 v0, 32772, v24
v_add_u32 v1, 32780, v24
v_add_u32 v2, 32788, v24
v_add_u32 v3, 32796, v24
v_add_u32 v4, 32804, v24
v_add_u32 v5, 32812, v24
v_add_u32 v6, 32820, v24
v_add_u32 v7, 32828, v24
v_cvt_f32_f16 v0, v0
v_cvt_f32_f16 v1, v1
v_cvt_f32_f16 v2, v2
v_cvt_f32_f16 v3, v3
v_cvt_f32_f16 v4, v4
v_cvt_f32_f16 v5, v5
v_cvt_f32_f16 v6, v6
v_cvt_f32_f16 v7, v7
v_mul_f32 v8, v0, v0
v_mul_f32 v9, v1, v1
v_mul_f32 v10, v2, v2
v_mul_f32 v11, v3, v3
v_mul_f32 v12, v4, v4
v_mul_f32 v13, v5, v5
v_mul_f32 v14, v6, v6
v_mul_f32 v15, v7, v7
v_fma_f32 v8, v8, s43, v25
v_fma_f32 v9, v9, s43, v25
v_fma_f32 v10, v10, s43, v25
v_fma_f32 v11, v11, s43, v25
v_fma_f32 v12, v12, s43, v25
v_fma_f32 v13, v13, s43, v25
v_fma_f32 v14, v14, s43, v25
v_fma_f32 v15, v15, s43, v25
v_mul_f32 v8, v0, v8
v_mul_f32 v9, v1, v9
v_mul_f32 v10, v2, v10
v_mul_f32 v11, v3, v11
v_mul_f32 v12, v4, v12
v_mul_f32 v13, v5, v13
v_mul_f32 v14, v6, v14
v_mul_f32 v15, v7, v15
v_exp_f32 v8, v8
v_exp_f32 v9, v9
v_exp_f32 v10, v10
v_exp_f32 v11, v11
v_exp_f32 v12, v12
v_exp_f32 v13, v13
v_exp_f32 v14, v14
v_exp_f32 v15, v15
v_add_f32 v16, 1.0, v8
v_add_f32 v17, 1.0, v9
v_add_f32 v18, 1.0, v10
v_add_f32 v19, 1.0, v11
v_add_f32 v20, 1.0, v12
v_add_f32 v21, 1.0, v13
v_add_f32 v22, 1.0, v14
v_add_f32 v23, 1.0, v15
v_rcp_f32 v16, v16
v_rcp_f32 v17, v17
v_rcp_f32 v18, v18
v_rcp_f32 v19, v19
v_rcp_f32 v20, v20
v_rcp_f32 v21, v21
v_rcp_f32 v22, v22
v_rcp_f32 v23, v23
v_mul_f32 v0, v0, v16
v_mul_f32 v1, v1, v17
v_mul_f32 v2, v2, v18
v_mul_f32 v3, v3, v19
v_mul_f32 v4, v4, v20
v_mul_f32 v5, v5, v21
v_mul_f32 v6, v6, v22
v_mul_f32 v7, v7, v23
v_mul_f32 v8, v8, v0
v_mul_f32 v9, v9, v1
v_mul_f32 v10, v10, v2
v_mul_f32 v11, v11, v3
v_mul_f32 v12, v12, v4
v_mul_f32 v13, v13, v5
v_mul_f32 v14, v14, v6
v_mul_f32 v15, v15, v7
v_cvt_pk_f16_f32 v28, v0, v1
v_cvt_pk_f16_f32 v32, -v8, -v9
v_cvt_pk_f16_f32 v29, v2, v3
v_cvt_pk_f16_f32 v33, -v10, -v11
v_cvt_pk_f16_f32 v30, v4, v5
v_cvt_pk_f16_f32 v34, -v12, -v13
v_cvt_pk_f16_f32 v31, v6, v7
v_cvt_pk_f16_f32 v35, -v14, -v15
v_lshlrev_b32 v24, 4, v199
v_mov_b32 v25, 163840
s_movk_i32 s43, 496
v_cmp_gt_u32 vcc, s43, v199
s_nop 1
v_cndmask_b32 v24, v25, v24, vcc
ds_write_b128 v24, v[32:35]
ds_write_b128 v24, v[28:31] offset:8192
Lnoy2:
s_setprio 2
s_cmp_lt_u32 s40, 4
s_cbranch_scc0 Lsu0
s_call_b64 s[78:79], Lpre
s_call_b64 s[78:79], Lrb
s_waitcnt vmcnt(4)
s_mov_b64 exec, 1
ds_add_u32 v253, v254 offset:28
s_mov_b64 exec, -1
v_mov_b32 v253, 16256
Lsw288w:
ds_read_b32 v247, v253 offset:28
s_waitcnt lgkmcnt(0)
v_readfirstlane_b32 s43, v247
s_cmp_eq_u32 s76, 0
s_cbranch_scc1 Lsw288x
s_sub_u32 s76, s76, 1
s_cmp_lt_u32 s43, 8
s_cbranch_scc0 Lsw288x
s_sleep 2
s_branch Lsw288w
Lsw288x:
s_call_b64 s[78:79], Lconv0
s_mov_b64 exec, 1
ds_add_u32 v253, v254 offset:16
s_mov_b64 exec, -1
s_call_b64 s[78:79], Lln0
s_waitcnt vmcnt(0)
s_mov_b64 exec, 1
ds_add_u32 v253, v254 offset:12
s_mov_b64 exec, -1
Lsu0:
s_cmp_ge_u32 s40, 4
s_cbranch_scc0 Lsu2
s_setprio 3
s_call_b64 s[78:79], Lw1f
s_waitcnt vmcnt(6)
s_mov_b64 exec, 1
ds_add_u32 v253, v254 offset:28
s_mov_b64 exec, -1
s_call_b64 s[78:79], Lrb
s_waitcnt vmcnt(4)
s_call_b64 s[78:79], Lw1a
s_mov_b64 exec, 1
ds_add_u32 v253, v254 offset:20
s_mov_b64 exec, -1
s_call_b64 s[78:79], Lw1i
s_call_b64 s[78:79], Lpre
s_waitcnt vmcnt(12)
s_mov_b64 exec, 1
ds_add_u32 v253, v254 offset:12
s_mov_b64 exec, -1
v_mov_b32 v253, 16256
Lsw128w:
ds_read_b32 v247, v253 offset:12
s_waitcnt lgkmcnt(0)
v_readfirstlane_b32 s43, v247
s_cmp_eq_u32 s76, 0
s_cbranch_scc1 Lsw128x
s_sub_u32 s76, s76, 1
s_cmp_lt_u32 s43, 8
s_cbranch_scc0 Lsw128x
s_sleep 2
s_branch Lsw128w
Lsw128x:
s_call_b64 s[78:79], Lconv0
s_mov_b64 exec, 1
ds_add_u32 v253, v254 offset:16
s_mov_b64 exec, -1
s_call_b64 s[78:79], Lw1b
s_mov_b64 exec, 1
ds_add_u32 v253, v254 offset:24
s_mov_b64 exec, -1
s_call_b64 s[78:79], Lln0
Lsu2:
s_branch Lgo
Lconv0:
ds_read_b128 v[192:195], v242
ds_read_b128 v[196:199], v242 offset:64
ds_read_b128 v[200:203], v242 offset:128
ds_read_b128 v[204:207], v243
ds_read_b128 v[208:211], v243 offset:64
ds_read_b128 v[212:215], v243 offset:128
ds_read_b128 v[224:227], v244
ds_read_b128 v[228:231], v244 offset:64
ds_read_b128 v[232:235], v244 offset:128
v_xor_b32 v242, 16, v242
ds_read_b128 v[236:239], v242
ds_read_b128 v[216:219], v242 offset:64
ds_read_b128 v[220:223], v242 offset:128
s_waitcnt lgkmcnt(11)
v_smfmac_f32_16x16x32_bf16 v[0:3], v[48:49], v[192:195], v246
s_waitcnt lgkmcnt(10)
v_smfmac_f32_16x16x32_bf16 v[16:19], v[50:51], v[196:199], v246
s_waitcnt lgkmcnt(9)
v_smfmac_f32_16x16x32_bf16 v[32:35], v[52:53], v[200:203], v246
s_waitcnt lgkmcnt(8)
v_xor_b32 v243, 16, v243
ds_read_b128 v[192:195], v243
ds_read_b128 v[196:199], v243 offset:64
v_smfmac_f32_16x16x32_bf16 v[0:3], v[54:55], v[204:207], v246
s_waitcnt lgkmcnt(9)
v_smfmac_f32_16x16x32_bf16 v[16:19], v[56:57], v[208:211], v246
s_waitcnt lgkmcnt(8)
ds_read_b128 v[200:203], v243 offset:128
v_xor_b32 v244, 16, v244
ds_read_b128 v[204:207], v244
v_smfmac_f32_16x16x32_bf16 v[32:35], v[58:59], v[212:215], v246
s_waitcnt lgkmcnt(9)
v_smfmac_f32_16x16x32_bf16 v[0:3], v[60:61], v[224:227], v246
s_waitcnt lgkmcnt(8)
ds_read_b128 v[208:211], v244 offset:64
ds_read_b128 v[212:215], v244 offset:128
v_smfmac_f32_16x16x32_bf16 v[16:19], v[62:63], v[228:231], v246
s_waitcnt lgkmcnt(9)
v_smfmac_f32_16x16x32_bf16 v[32:35], v[64:65], v[232:235], v246
s_waitcnt lgkmcnt(8)
v_xor_b32 v242, 32, v242
ds_read_b128 v[224:227], v242
ds_read_b128 v[228:231], v242 offset:64
v_smfmac_f32_16x16x32_bf16 v[4:7], v[66:67], v[236:239], v246
s_waitcnt lgkmcnt(9)
v_smfmac_f32_16x16x32_bf16 v[20:23], v[68:69], v[216:219], v246
s_waitcnt lgkmcnt(8)
ds_read_b128 v[232:235], v242 offset:128
v_xor_b32 v243, 32, v243
ds_read_b128 v[236:239], v243
v_smfmac_f32_16x16x32_bf16 v[36:39], v[70:71], v[220:223], v246
s_waitcnt lgkmcnt(9)
v_smfmac_f32_16x16x32_bf16 v[4:7], v[72:73], v[192:195], v246
s_waitcnt lgkmcnt(8)
ds_read_b128 v[216:219], v243 offset:64
ds_read_b128 v[220:223], v243 offset:128
v_smfmac_f32_16x16x32_bf16 v[20:23], v[74:75], v[196:199], v246
s_waitcnt lgkmcnt(9)
v_smfmac_f32_16x16x32_bf16 v[36:39], v[76:77], v[200:203], v246
s_waitcnt lgkmcnt(8)
v_xor_b32 v244, 32, v244
ds_read_b128 v[192:195], v244
ds_read_b128 v[196:199], v244 offset:64
v_smfmac_f32_16x16x32_bf16 v[4:7], v[78:79], v[204:207], v246
s_waitcnt lgkmcnt(9)
v_smfmac_f32_16x16x32_bf16 v[20:23], v[80:81], v[208:211], v246
s_waitcnt lgkmcnt(8)
ds_read_b128 v[200:203], v244 offset:128
v_xor_b32 v242, 16, v242
ds_read_b128 v[204:207], v242
v_smfmac_f32_16x16x32_bf16 v[36:39], v[82:83], v[212:215], v246
s_waitcnt lgkmcnt(9)
v_smfmac_f32_16x16x32_bf16 v[12:15], v[84:85], v[224:227], v246
s_waitcnt lgkmcnt(8)
ds_read_b128 v[208:211], v242 offset:64
ds_read_b128 v[212:215], v242 offset:128
v_smfmac_f32_16x16x32_bf16 v[28:31], v[86:87], v[228:231], v246
s_waitcnt lgkmcnt(9)
v_smfmac_f32_16x16x32_bf16 v[44:47], v[88:89], v[232:235], v246
s_waitcnt lgkmcnt(8)
v_xor_b32 v243, 16, v243
ds_read_b128 v[224:227], v243
ds_read_b128 v[228:231], v243 offset:64
v_smfmac_f32_16x16x32_bf16 v[12:15], v[90:91], v[236:239], v246
s_waitcnt lgkmcnt(9)
v_smfmac_f32_16x16x32_bf16 v[28:31], v[92:93], v[216:219], v246
s_waitcnt lgkmcnt(8)
ds_read_b128 v[232:235], v243 offset:128
v_xor_b32 v244, 16, v244
ds_read_b128 v[236:239], v244
v_smfmac_f32_16x16x32_bf16 v[44:47], v[94:95], v[220:223], v246
s_waitcnt lgkmcnt(9)
v_smfmac_f32_16x16x32_bf16 v[12:15], v[96:97], v[192:195], v246
s_waitcnt lgkmcnt(8)
ds_read_b128 v[216:219], v244 offset:64
ds_read_b128 v[220:223], v244 offset:128
v_smfmac_f32_16x16x32_bf16 v[28:31], v[98:99], v[196:199], v246
s_waitcnt lgkmcnt(9)
v_smfmac_f32_16x16x32_bf16 v[44:47], v[100:101], v[200:203], v246
s_waitcnt lgkmcnt(8)
v_smfmac_f32_16x16x32_bf16 v[8:11], v[102:103], v[204:207], v246
s_waitcnt lgkmcnt(7)
v_smfmac_f32_16x16x32_bf16 v[24:27], v[104:105], v[208:211], v246
s_waitcnt lgkmcnt(6)
v_smfmac_f32_16x16x32_bf16 v[40:43], v[106:107], v[212:215], v246
s_waitcnt lgkmcnt(5)
v_smfmac_f32_16x16x32_bf16 v[8:11], v[108:109], v[224:227], v246
s_waitcnt lgkmcnt(4)
v_smfmac_f32_16x16x32_bf16 v[24:27], v[110:111], v[228:231], v246
s_waitcnt lgkmcnt(3)
v_smfmac_f32_16x16x32_bf16 v[40:43], v[112:113], v[232:235], v246
s_waitcnt lgkmcnt(2)
v_smfmac_f32_16x16x32_bf16 v[8:11], v[114:115], v[236:239], v246
s_waitcnt lgkmcnt(1)
v_smfmac_f32_16x16x32_bf16 v[24:27], v[116:117], v[216:219], v246
s_waitcnt lgkmcnt(0)
v_smfmac_f32_16x16x32_bf16 v[40:43], v[118:119], v[220:223], v246
s_nop 11
s_setpc_b64 s[78:79]
Lln0:
v_pk_add_f32 v[168:169], v[0:1], v[2:3]
v_pk_mul_f32 v[170:171], v[0:1], v[0:1]
v_pk_fma_f32 v[170:171], v[2:3], v[2:3], v[170:171]
v_pk_add_f32 v[168:169], v[168:169], v[4:5]
v_pk_fma_f32 v[170:171], v[4:5], v[4:5], v[170:171]
v_pk_add_f32 v[168:169], v[168:169], v[6:7]
v_pk_fma_f32 v[170:171], v[6:7], v[6:7], v[170:171]
v_pk_add_f32 v[168:169], v[168:169], v[8:9]
v_pk_fma_f32 v[170:171], v[8:9], v[8:9], v[170:171]
v_pk_add_f32 v[168:169], v[168:169], v[10:11]
v_pk_fma_f32 v[170:171], v[10:11], v[10:11], v[170:171]
v_pk_add_f32 v[168:169], v[168:169], v[12:13]
v_pk_fma_f32 v[170:171], v[12:13], v[12:13], v[170:171]
v_pk_add_f32 v[168:169], v[168:169], v[14:15]
v_pk_fma_f32 v[170:171], v[14:15], v[14:15], v[170:171]
v_pk_add_f32 v[168:169], v[168:169], v[16:17]
v_pk_fma_f32 v[170:171], v[16:17], v[16:17], v[170:171]
v_pk_add_f32 v[168:169], v[168:169], v[18:19]
v_pk_fma_f32 v[170:171], v[18:19], v[18:19], v[170:171]
v_pk_add_f32 v[168:169], v[168:169], v[20:21]
v_pk_fma_f32 v[170:171], v[20:21], v[20:21], v[170:171]
v_pk_add_f32 v[168:169], v[168:169], v[22:23]
v_pk_fma_f32 v[170:171], v[22:23], v[22:23], v[170:171]
v_pk_add_f32 v[168:169], v[168:169], v[24:25]
v_pk_fma_f32 v[170:171], v[24:25], v[24:25], v[170:171]
v_pk_add_f32 v[168:169], v[168:169], v[26:27]
v_pk_fma_f32 v[170:171], v[26:27], v[26:27], v[170:171]
v_pk_add_f32 v[168:169], v[168:169], v[28:29]
v_pk_fma_f32 v[170:171], v[28:29], v[28:29], v[170:171]
v_pk_add_f32 v[168:169], v[168:169], v[30:31]
v_pk_fma_f32 v[170:171], v[30:31], v[30:31], v[170:171]
v_pk_add_f32 v[168:169], v[168:169], v[32:33]
v_pk_fma_f32 v[170:171], v[32:33], v[32:33], v[170:171]
v_pk_add_f32 v[168:169], v[168:169], v[34:35]
v_pk_fma_f32 v[170:171], v[34:35], v[34:35], v[170:171]
v_pk_add_f32 v[168:169], v[168:169], v[36:37]
v_pk_fma_f32 v[170:171], v[36:37], v[36:37], v[170:171]
v_pk_add_f32 v[168:169], v[168:169], v[38:39]
v_pk_fma_f32 v[170:171], v[38:39], v[38:39], v[170:171]
v_pk_add_f32 v[168:169], v[168:169], v[40:41]
v_pk_fma_f32 v[170:171], v[40:41], v[40:41], v[170:171]
v_pk_add_f32 v[168:169], v[168:169], v[42:43]
v_pk_fma_f32 v[170:171], v[42:43], v[42:43], v[170:171]
v_pk_add_f32 v[168:169], v[168:169], v[44:45]
v_pk_fma_f32 v[170:171], v[44:45], v[44:45], v[170:171]
v_pk_add_f32 v[168:169], v[168:169], v[46:47]
v_pk_fma_f32 v[170:171], v[46:47], v[46:47], v[170:171]
v_add_f32 v168, v168, v169
v_add_f32 v170, v170, v171
s_nop 1
v_permlane32_swap_b32 v168, v170
v_add_f32_e64 v168, v168, v170
v_mul_f32 v168, 1009429163, v168
v_mov_b32_e64 v170, v168
s_nop 1
v_permlane32_swap_b32 v168, v170
v_fma_f32 v170, -v168, v168, v170
v_max_f32_e64 v170, 0, v170
v_add_f32 v170, 925353388, v170
v_rsq_f32 v170, v170
s_nop 0
v_mul_f32 v172, 3203391086, v170
v_mul_f32_e64 v173, v168, v172
v_pk_fma_f32 v[0:1], v[0:1], v[172:173], v[172:173] op_sel:[0,0,1] op_sel_hi:[1,0,1] neg_lo:[0,0,1] neg_hi:[0,0,1]
v_pk_fma_f32 v[2:3], v[2:3], v[172:173], v[172:173] op_sel:[0,0,1] op_sel_hi:[1,0,1] neg_lo:[0,0,1] neg_hi:[0,0,1]
v_pk_fma_f32 v[4:5], v[4:5], v[172:173], v[172:173] op_sel:[0,0,1] op_sel_hi:[1,0,1] neg_lo:[0,0,1] neg_hi:[0,0,1]
v_pk_fma_f32 v[6:7], v[6:7], v[172:173], v[172:173] op_sel:[0,0,1] op_sel_hi:[1,0,1] neg_lo:[0,0,1] neg_hi:[0,0,1]
v_pk_fma_f32 v[8:9], v[8:9], v[172:173], v[172:173] op_sel:[0,0,1] op_sel_hi:[1,0,1] neg_lo:[0,0,1] neg_hi:[0,0,1]
v_pk_fma_f32 v[10:11], v[10:11], v[172:173], v[172:173] op_sel:[0,0,1] op_sel_hi:[1,0,1] neg_lo:[0,0,1] neg_hi:[0,0,1]
v_pk_fma_f32 v[12:13], v[12:13], v[172:173], v[172:173] op_sel:[0,0,1] op_sel_hi:[1,0,1] neg_lo:[0,0,1] neg_hi:[0,0,1]
v_pk_fma_f32 v[14:15], v[14:15], v[172:173], v[172:173] op_sel:[0,0,1] op_sel_hi:[1,0,1] neg_lo:[0,0,1] neg_hi:[0,0,1]
v_pk_fma_f32 v[16:17], v[16:17], v[172:173], v[172:173] op_sel:[0,0,1] op_sel_hi:[1,0,1] neg_lo:[0,0,1] neg_hi:[0,0,1]
v_pk_fma_f32 v[18:19], v[18:19], v[172:173], v[172:173] op_sel:[0,0,1] op_sel_hi:[1,0,1] neg_lo:[0,0,1] neg_hi:[0,0,1]
v_pk_fma_f32 v[20:21], v[20:21], v[172:173], v[172:173] op_sel:[0,0,1] op_sel_hi:[1,0,1] neg_lo:[0,0,1] neg_hi:[0,0,1]
v_pk_fma_f32 v[22:23], v[22:23], v[172:173], v[172:173] op_sel:[0,0,1] op_sel_hi:[1,0,1] neg_lo:[0,0,1] neg_hi:[0,0,1]
v_pk_fma_f32 v[24:25], v[24:25], v[172:173], v[172:173] op_sel:[0,0,1] op_sel_hi:[1,0,1] neg_lo:[0,0,1] neg_hi:[0,0,1]
v_pk_fma_f32 v[26:27], v[26:27], v[172:173], v[172:173] op_sel:[0,0,1] op_sel_hi:[1,0,1] neg_lo:[0,0,1] neg_hi:[0,0,1]
v_pk_fma_f32 v[28:29], v[28:29], v[172:173], v[172:173] op_sel:[0,0,1] op_sel_hi:[1,0,1] neg_lo:[0,0,1] neg_hi:[0,0,1]
v_pk_fma_f32 v[30:31], v[30:31], v[172:173], v[172:173] op_sel:[0,0,1] op_sel_hi:[1,0,1] neg_lo:[0,0,1] neg_hi:[0,0,1]
v_pk_fma_f32 v[32:33], v[32:33], v[172:173], v[172:173] op_sel:[0,0,1] op_sel_hi:[1,0,1] neg_lo:[0,0,1] neg_hi:[0,0,1]
v_pk_fma_f32 v[34:35], v[34:35], v[172:173], v[172:173] op_sel:[0,0,1] op_sel_hi:[1,0,1] neg_lo:[0,0,1] neg_hi:[0,0,1]
v_pk_fma_f32 v[36:37], v[36:37], v[172:173], v[172:173] op_sel:[0,0,1] op_sel_hi:[1,0,1] neg_lo:[0,0,1] neg_hi:[0,0,1]
v_pk_fma_f32 v[38:39], v[38:39], v[172:173], v[172:173] op_sel:[0,0,1] op_sel_hi:[1,0,1] neg_lo:[0,0,1] neg_hi:[0,0,1]
v_pk_fma_f32 v[40:41], v[40:41], v[172:173], v[172:173] op_sel:[0,0,1] op_sel_hi:[1,0,1] neg_lo:[0,0,1] neg_hi:[0,0,1]
v_pk_fma_f32 v[42:43], v[42:43], v[172:173], v[172:173] op_sel:[0,0,1] op_sel_hi:[1,0,1] neg_lo:[0,0,1] neg_hi:[0,0,1]
v_pk_fma_f32 v[44:45], v[44:45], v[172:173], v[172:173] op_sel:[0,0,1] op_sel_hi:[1,0,1] neg_lo:[0,0,1] neg_hi:[0,0,1]
v_pk_fma_f32 v[46:47], v[46:47], v[172:173], v[172:173] op_sel:[0,0,1] op_sel_hi:[1,0,1] neg_lo:[0,0,1] neg_hi:[0,0,1]
v_cvt_pk_bf16_f32 v48, v0, v1
v_cvt_pk_bf16_f32 v49, v2, v3
v_cvt_pk_bf16_f32 v50, v4, v5
v_cvt_pk_bf16_f32 v51, v6, v7
v_cvt_pk_bf16_f32 v52, v8, v9
v_cvt_pk_bf16_f32 v53, v10, v11
v_cvt_pk_bf16_f32 v54, v12, v13
v_cvt_pk_bf16_f32 v55, v14, v15
v_cvt_pk_bf16_f32 v56, v16, v17
v_cvt_pk_bf16_f32 v57, v18, v19
v_cvt_pk_bf16_f32 v58, v20, v21
v_cvt_pk_bf16_f32 v59, v22, v23
v_cvt_pk_bf16_f32 v60, v24, v25
v_cvt_pk_bf16_f32 v61, v26, v27
v_cvt_pk_bf16_f32 v62, v28, v29
v_cvt_pk_bf16_f32 v63, v30, v31
v_cvt_pk_bf16_f32 v64, v32, v33
v_cvt_pk_bf16_f32 v65, v34, v35
v_cvt_pk_bf16_f32 v66, v36, v37
v_cvt_pk_bf16_f32 v67, v38, v39
v_cvt_pk_bf16_f32 v68, v40, v41
v_cvt_pk_bf16_f32 v69, v42, v43
v_cvt_pk_bf16_f32 v70, v44, v45
v_cvt_pk_bf16_f32 v71, v46, v47
s_nop 1
s_setpc_b64 s[78:79]
Lw1a:
ds_read_b64_tr_b16 v[148:149], v146
ds_read_b64_tr_b16 v[150:151], v146 offset:512
ds_read_b64_tr_b16 v[152:153], v146 offset:1024
ds_read_b64_tr_b16 v[154:155], v146 offset:1536
ds_read_b64_tr_b16 v[156:157], v146 offset:2048
ds_read_b64_tr_b16 v[158:159], v146 offset:2560
ds_read_b64_tr_b16 v[160:161], v146 offset:3072
ds_read_b64_tr_b16 v[162:163], v146 offset:3584
ds_read_b64_tr_b16 v[164:165], v146 offset:4096
ds_read_b64_tr_b16 v[166:167], v146 offset:4608
ds_read_b64_tr_b16 v[168:169], v146 offset:5120
ds_read_b64_tr_b16 v[170:171], v146 offset:5632
s_waitcnt lgkmcnt(10)
ds_write_b128 v147, v[148:151]
s_waitcnt lgkmcnt(9)
ds_write_b128 v147, v[152:155] offset:1024
s_waitcnt lgkmcnt(8)
ds_write_b128 v147, v[156:159] offset:2048
s_waitcnt lgkmcnt(7)
ds_write_b128 v147, v[160:163] offset:3072
s_waitcnt lgkmcnt(6)
ds_write_b128 v147, v[164:167] offset:4096
s_waitcnt lgkmcnt(5)
ds_write_b128 v147, v[168:171] offset:5120
s_waitcnt lgkmcnt(0)
s_setpc_b64 s[78:79]
Lw1i:
s_add_u32 m0, s77, 24576
s_add_u32 s43, s3, 256
buffer_load_dwordx4 v145, s[12:15], s43 offen lds
s_add_u32 m0, s77, 25600
s_add_u32 s43, s3, 24832
buffer_load_dwordx4 v145, s[12:15], s43 offen lds
s_add_u32 m0, s77, 26624
s_add_u32 s43, s3, 49408
buffer_load_dwordx4 v145, s[12:15], s43 offen lds
s_add_u32 m0, s77, 27648
s_add_u32 s43, s3, 12544
buffer_load_dwordx4 v145, s[12:15], s43 offen lds
s_add_u32 m0, s77, 28672
s_add_u32 s43, s3, 37120
buffer_load_dwordx4 v145, s[12:15], s43 offen lds
s_add_u32 m0, s77, 29696
s_add_u32 s43, s3, 61696
buffer_load_dwordx4 v145, s[12:15], s43 offen lds
s_add_u32 m0, s77, 49152
s_add_u32 s43, s3, 512
buffer_load_dwordx4 v145, s[12:15], s43 offen lds
s_add_u32 m0, s77, 50176
s_add_u32 s43, s3, 25088
buffer_load_dwordx4 v145, s[12:15], s43 offen lds
s_add_u32 m0, s77, 51200
s_add_u32 s43, s3, 49664
buffer_load_dwordx4 v145, s[12:15], s43 offen lds
s_add_u32 m0, s77, 52224
s_add_u32 s43, s3, 12800
buffer_load_dwordx4 v145, s[12:15], s43 offen lds
s_add_u32 m0, s77, 53248
s_add_u32 s43, s3, 37376
buffer_load_dwordx4 v145, s[12:15], s43 offen lds
s_add_u32 m0, s77, 54272
s_add_u32 s43, s3, 61952
buffer_load_dwordx4 v145, s[12:15], s43 offen lds
s_setpc_b64 s[78:79]
Lw1b:
s_waitcnt vmcnt(0)
ds_read_b64_tr_b16 v[72:73], v146 offset:24576
ds_read_b64_tr_b16 v[74:75], v146 offset:25088
ds_read_b64_tr_b16 v[76:77], v146 offset:25600
ds_read_b64_tr_b16 v[78:79], v146 offset:26112
ds_read_b64_tr_b16 v[80:81], v146 offset:26624
ds_read_b64_tr_b16 v[82:83], v146 offset:27136
ds_read_b64_tr_b16 v[84:85], v146 offset:27648
ds_read_b64_tr_b16 v[86:87], v146 offset:28160
ds_read_b64_tr_b16 v[88:89], v146 offset:28672
ds_read_b64_tr_b16 v[90:91], v146 offset:29184
ds_read_b64_tr_b16 v[92:93], v146 offset:29696
ds_read_b64_tr_b16 v[94:95], v146 offset:30208
ds_read_b64_tr_b16 v[96:97], v146 offset:49152
ds_read_b64_tr_b16 v[98:99], v146 offset:49664
ds_read_b64_tr_b16 v[100:101], v146 offset:50176
ds_read_b64_tr_b16 v[102:103], v146 offset:50688
ds_read_b64_tr_b16 v[104:105], v146 offset:51200
ds_read_b64_tr_b16 v[106:107], v146 offset:51712
ds_read_b64_tr_b16 v[108:109], v146 offset:52224
ds_read_b64_tr_b16 v[110:111], v146 offset:52736
ds_read_b64_tr_b16 v[112:113], v146 offset:53248
ds_read_b64_tr_b16 v[114:115], v146 offset:53760
ds_read_b64_tr_b16 v[116:117], v146 offset:54272
ds_read_b64_tr_b16 v[118:119], v146 offset:54784
s_waitcnt lgkmcnt(15)
ds_write_b128 v147, v[72:75] offset:24576
ds_write_b128 v147, v[76:79] offset:25600
ds_write_b128 v147, v[80:83] offset:26624
ds_write_b128 v147, v[84:87] offset:27648
s_waitcnt lgkmcnt(15)
ds_write_b128 v147, v[88:91] offset:28672
ds_write_b128 v147, v[92:95] offset:29696
s_waitcnt lgkmcnt(15)
ds_write_b128 v147, v[96:99] offset:49152
s_waitcnt lgkmcnt(15)
ds_write_b128 v147, v[100:103] offset:50176
s_waitcnt lgkmcnt(14)
ds_write_b128 v147, v[104:107] offset:51200
s_waitcnt lgkmcnt(13)
ds_write_b128 v147, v[108:111] offset:52224
s_waitcnt lgkmcnt(12)
ds_write_b128 v147, v[112:115] offset:53248
s_waitcnt lgkmcnt(11)
ds_write_b128 v147, v[116:119] offset:54272
s_waitcnt lgkmcnt(0)
s_setpc_b64 s[78:79]
Lpre:
ds_read_b128 v[48:51], v245
ds_read_b128 v[52:55], v245 offset:384
ds_read_b128 v[56:59], v245 offset:768
ds_read_b128 v[60:63], v245 offset:1152
ds_read_b128 v[64:67], v245 offset:1536
ds_read_b128 v[68:71], v245 offset:1920
ds_read_b128 v[72:75], v245 offset:2304
ds_read_b128 v[76:79], v245 offset:2688
ds_read_b128 v[80:83], v245 offset:3072
ds_read_b128 v[84:87], v245 offset:3456
ds_read_b128 v[88:91], v245 offset:3840
ds_read_b128 v[92:95], v245 offset:4224
ds_read_b128 v[96:99], v245 offset:4608
ds_read_b128 v[100:103], v245 offset:4992
ds_read_b128 v[104:107], v245 offset:5376
ds_read_b128 v[108:111], v245 offset:5760
ds_read_b128 v[112:115], v245 offset:6144
ds_read_b128 v[116:119], v245 offset:6528
v_mov_b32 v0, 0
v_mov_b32 v1, 0
v_mov_b32 v2, 0
v_mov_b32 v3, 0
v_mov_b32 v4, 0
v_mov_b32 v5, 0
v_mov_b32 v6, 0
v_mov_b32 v7, 0
v_mov_b32 v8, 0
v_mov_b32 v9, 0
v_mov_b32 v10, 0
v_mov_b32 v11, 0
v_mov_b32 v12, 0
v_mov_b32 v13, 0
v_mov_b32 v14, 0
v_mov_b32 v15, 0
v_mov_b32 v16, 0
v_mov_b32 v17, 0
v_mov_b32 v18, 0
v_mov_b32 v19, 0
v_mov_b32 v20, 0
v_mov_b32 v21, 0
v_mov_b32 v22, 0
v_mov_b32 v23, 0
v_mov_b32 v24, 0
v_mov_b32 v25, 0
v_mov_b32 v26, 0
v_mov_b32 v27, 0
v_mov_b32 v28, 0
v_mov_b32 v29, 0
v_mov_b32 v30, 0
v_mov_b32 v31, 0
v_mov_b32 v32, 0
v_mov_b32 v33, 0
v_mov_b32 v34, 0
v_mov_b32 v35, 0
v_mov_b32 v36, 0
v_mov_b32 v37, 0
v_mov_b32 v38, 0
v_mov_b32 v39, 0
v_mov_b32 v40, 0
v_mov_b32 v41, 0
v_mov_b32 v42, 0
v_mov_b32 v43, 0
v_mov_b32 v44, 0
v_mov_b32 v45, 0
v_mov_b32_e64 v46, 0
v_mov_b32 v47, 0
s_waitcnt lgkmcnt(0)
s_setpc_b64 s[78:79]
Lrb:
s_add_u32 m0, s67, 39936
s_add_u32 s45, s66, 491520
buffer_load_dwordx4 v240, s[4:7], s45 offen nt lds
s_add_u32 m0, s67, 46592
s_add_u32 s45, s66, 589824
buffer_load_dwordx4 v240, s[4:7], s45 offen nt lds
s_add_u32 m0, s67, 53248
s_add_u32 s45, s66, 688128
buffer_load_dwordx4 v240, s[4:7], s45 offen nt lds
s_add_u32 m0, s67, 59904
s_add_u32 s45, s66, 786432
buffer_load_dwordx4 v240, s[4:7], s45 offen nt lds
s_setpc_b64 s[78:79]
Lw1f:
s_add_u32 m0, s77, 0
s_add_u32 s43, s3, 0
buffer_load_dwordx4 v145, s[12:15], s43 offen lds
s_add_u32 m0, s77, 1024
s_add_u32 s43, s3, 24576
buffer_load_dwordx4 v145, s[12:15], s43 offen lds
s_add_u32 m0, s77, 2048
s_add_u32 s43, s3, 49152
buffer_load_dwordx4 v145, s[12:15], s43 offen lds
s_add_u32 m0, s77, 3072
s_add_u32 s43, s3, 12288
buffer_load_dwordx4 v145, s[12:15], s43 offen lds
s_add_u32 m0, s77, 4096
s_add_u32 s43, s3, 36864
buffer_load_dwordx4 v145, s[12:15], s43 offen lds
s_add_u32 m0, s77, 5120
s_add_u32 s43, s3, 61440
buffer_load_dwordx4 v145, s[12:15], s43 offen lds
s_setpc_b64 s[78:79]
Lgo:
v_mov_b32 v253, 16256
Lsw204w:
ds_read_b32 v247, v253 offset:20
s_waitcnt lgkmcnt(0)
v_readfirstlane_b32 s43, v247
s_cmp_eq_u32 s76, 0
s_cbranch_scc1 Lsw204x
s_sub_u32 s76, s76, 1
s_cmp_lt_u32 s43, 4
s_cbranch_scc0 Lsw204x
s_sleep 2
s_branch Lsw204w
Lsw204x:
s_cmp_lg_u32 s40, 7
s_cbranch_scc1 Lnopf
s_getpc_b64 s[74:75]
Lpc:
s_lshr_b32 s43, s2, 3
s_and_b32 s43, s43, 15
s_lshl_b32 s43, s43, 13
v_lshlrev_b32 v178, 7, v251
v_add_u32 v178, s43, v178
v_min_u32 v178, Lend-Lpc, v178
global_load_dword v255, v178, s[74:75]
Lnopf:
s_add_u32 s66, s66, 786432
ds_read_b128 v[224:227], v248 offset:16384
ds_read_b128 v[228:231], v248 offset:19456
ds_read_b128 v[232:235], v248 offset:17408
ds_read_b128 v[236:239], v248 offset:20480
ds_read_b128 v[216:219], v248 offset:18432
ds_read_b128 v[220:223], v248 offset:21504
s_setprio 2
s_waitcnt lgkmcnt(5)
v_mfma_f32_32x32x16_bf16 v[120:135], v[48:51], v[224:227], 0
s_waitcnt lgkmcnt(4)
ds_read_b128 v[224:227], v248 offset:22528
v_mfma_f32_32x32x16_bf16 v[120:135], v[52:55], v[228:231], v[120:135]
s_waitcnt lgkmcnt(4)
ds_read_b128 v[228:231], v248 offset:25600
v_mfma_f32_32x32x16_bf16 v[120:135], v[56:59], v[232:235], v[120:135]
s_waitcnt lgkmcnt(4)
ds_read_b128 v[232:235], v248 offset:23552
v_mfma_f32_32x32x16_bf16 v[120:135], v[60:63], v[236:239], v[120:135]
s_waitcnt lgkmcnt(4)
ds_read_b128 v[236:239], v248 offset:26624
v_mfma_f32_32x32x16_bf16 v[120:135], v[64:67], v[216:219], v[120:135]
s_waitcnt lgkmcnt(4)
ds_read_b128 v[216:219], v248 offset:24576
v_mfma_f32_32x32x16_bf16 v[120:135], v[68:71], v[220:223], v[120:135]
v_add_u32 v174, -36864, v242
v_subrev_u32 v175, 66560, v174
v_min_u32 v174, v174, v175
v_add_u32 v174, 90112, v174
v_sub_u32 v175, v174, v242
v_add_u32 v242, v175, v242
v_add_u32_e64 v243, v175, v243
v_add_u32 v244, v175, v244
s_nop 3
v_cvt_pkrtz_f16_f32 v137, v120, v121
v_cvt_pkrtz_f16_f32 v139, v122, v123
v_cvt_pkrtz_f16_f32 v141, v124, v125
v_cvt_pkrtz_f16_f32 v143, v126, v127
v_cvt_pkrtz_f16_f32 v145, v128, v129
v_cvt_pk_f16_f32 v155, v130, v131
v_cvt_pk_f16_f32 v152, v132, v133
v_cvt_pk_f16_f32 v149, v134, v135
s_waitcnt lgkmcnt(1)
ds_read_b128 v[220:223], v248 offset:27648
v_mfma_f32_32x32x16_bf16 v[120:135], v[48:51], v[224:227], 0
v_pk_fma_f16 v154, v155, v155, s48
v_and_b32 v137, s49, v137
v_pk_fma_f16 v151, v152, v152, s48
v_and_b32_e64 v139, s49, v139
v_pk_fma_f16 v148, v149, v149, s48
v_pk_mul_f16 v154, v155, v154
v_bfe_u32 v136, v137, 2, 14
v_pk_mul_f16 v151, v152, v151
v_pk_mul_f16 v148, v149, v148
v_bfe_u32 v138, v139, 2, 14
ds_read_b128 v[224:227], v248 offset:28672
ds_read_u16_d16 v136, v136
ds_read_u16_d16 v138, v138
v_mfma_f32_32x32x16_bf16 v[120:135], v[52:55], v[228:231], v[120:135]
v_exp_f16 v153, v154
v_lshrrev_b32 v137, 18, v137
v_exp_f16 v150, v151
v_lshrrev_b32 v139, 18, v139
v_exp_f16 v147, v148
v_and_b32 v141, s49, v141
v_and_b32_e64 v143, s49, v143
ds_read_b128 v[228:231], v248 offset:31744
ds_read_u16_d16_hi v137, v137
ds_read_u16_d16_hi v139, v139
v_mfma_f32_32x32x16_bf16 v[120:135], v[56:59], v[232:235], v[120:135]
v_exp_f16_sdwa v153, v154 dst_sel:WORD_1 dst_unused:UNUSED_PRESERVE src0_sel:WORD_1
v_bfe_u32 v140, v141, 2, 14
v_exp_f16_sdwa v150, v151 dst_sel:WORD_1 dst_unused:UNUSED_PRESERVE src0_sel:WORD_1
v_bfe_u32 v142, v143, 2, 14
v_exp_f16_sdwa v147, v148 dst_sel:WORD_1 dst_unused:UNUSED_PRESERVE src0_sel:WORD_1
v_lshrrev_b32_e64 v141, 18, v141
v_pk_add_f16 v153, v153, 1.0 op_sel_hi:[1,0]
ds_read_b128 v[232:235], v248 offset:29696
ds_read_u16_d16 v140, v140
ds_read_u16_d16 v142, v142
ds_read_u16_d16_hi v141, v141
v_mfma_f32_32x32x16_bf16 v[120:135], v[60:63], v[236:239], v[120:135]
v_lshrrev_b32_e64 v143, 18, v143
v_pk_add_f16 v150, v150, 1.0 op_sel_hi:[1,0]
v_pk_add_f16 v147, v147, 1.0 op_sel_hi:[1,0]
v_and_b32 v145, s49, v145
v_rcp_f16 v154, v153
v_bfe_u32 v144, v145, 2, 14
v_rcp_f16_e64 v151, v150
v_lshrrev_b32 v145, 18, v145
s_waitcnt lgkmcnt(7)
ds_read_b128 v[236:239], v248 offset:32768
ds_read_u16_d16_hi v143, v143
ds_read_u16_d16 v144, v144
ds_read_u16_d16_hi v145, v145
v_mfma_f32_32x32x16_bf16 v[120:135], v[64:67], v[216:219], v[120:135]
v_rcp_f16_e64 v148, v147
v_rcp_f16_sdwa v154, v153 dst_sel:WORD_1 dst_unused:UNUSED_PRESERVE src0_sel:WORD_1
v_fma_mix_f32 v156, v136, v136, 0 op_sel:[0,0,0] op_sel_hi:[1,1,0]
ds_read_b32 v247, v253 offset:16
s_waitcnt lgkmcnt(9)
v_fma_mix_f32 v156, v137, v137, v156 op_sel:[1,1,0] op_sel_hi:[1,1,0]
v_rcp_f16_sdwa v151, v150 dst_sel:WORD_1 dst_unused:UNUSED_PRESERVE src0_sel:WORD_1
v_fma_mix_f32 v156, v138, v138, v156 op_sel:[0,0,0] op_sel_hi:[1,1,0]
ds_read_b128 v[216:219], v248 offset:30720
v_mfma_f32_32x32x16_bf16 v[120:135], v[68:71], v[220:223], v[120:135]
v_rcp_f16_sdwa v148, v147 dst_sel:WORD_1 dst_unused:UNUSED_PRESERVE src0_sel:WORD_1
v_fma_mix_f32 v156, v139, v139, v156 op_sel:[1,1,0] op_sel_hi:[1,1,0]
v_pk_mul_f16 v155, v155, v154
s_waitcnt lgkmcnt(6)
v_fma_mix_f32 v156, v140, v140, v156 op_sel:[0,0,0] op_sel_hi:[1,1,0]
v_pk_mul_f16 v152, v152, v151
v_fma_mix_f32 v156, v141, v141, v156 op_sel:[1,1,0] op_sel_hi:[1,1,0]
v_pk_mul_f16 v149, v149, v148
v_fma_mix_f32 v156, v155, v155, v156 op_sel:[0,0,0] op_sel_hi:[1,1,0]
v_fma_mix_f32 v156, v142, v142, v156 op_sel:[0,0,0] op_sel_hi:[1,1,0]
v_fma_mix_f32 v156, v155, v155, v156 op_sel:[1,1,0] op_sel_hi:[1,1,0]
s_waitcnt lgkmcnt(4)
v_fma_mix_f32 v156, v143, v143, v156 op_sel:[1,1,0] op_sel_hi:[1,1,0]
v_fma_mix_f32 v156, v152, v152, v156 op_sel:[0,0,0] op_sel_hi:[1,1,0]
v_fma_mix_f32 v156, v152, v152, v156 op_sel:[1,1,0] op_sel_hi:[1,1,0]
s_waitcnt lgkmcnt(2)
v_fma_mix_f32 v156, v144, v144, v156 op_sel:[0,0,0] op_sel_hi:[1,1,0]
v_fma_mix_f32 v156, v149, v149, v156 op_sel:[0,0,0] op_sel_hi:[1,1,0]
v_fma_mix_f32 v156, v145, v145, v156 op_sel:[1,1,0] op_sel_hi:[1,1,0]
v_fma_mix_f32 v156, v149, v149, v156 op_sel:[1,1,0] op_sel_hi:[1,1,0]
s_waitcnt lgkmcnt(1)
v_readfirstlane_b32 s43, v247
s_nop 1
s_cmp_ge_u32 s43, 8
s_cbranch_scc1 Lev1
Lev1w:
s_sleep 1
ds_read_b32 v247, v253 offset:16
s_waitcnt lgkmcnt(0)
v_readfirstlane_b32 s43, v247
s_cmp_eq_u32 s76, 0
s_cbranch_scc1 Lev1
s_sub_u32 s76, s76, 1
s_cmp_lt_u32 s43, 8
s_cbranch_scc1 Lev1w
Lev1:
v_cvt_pkrtz_f16_f32 v137, v120, v121
v_cvt_pkrtz_f16_f32 v139, v122, v123
v_cvt_pkrtz_f16_f32 v141, v124, v125
v_cvt_pkrtz_f16_f32 v143, v126, v127
v_cvt_pkrtz_f16_f32 v145, v128, v129
v_cvt_pk_f16_f32 v155, v130, v131
v_cvt_pk_f16_f32 v152, v132, v133
v_cvt_pk_f16_f32 v149, v134, v135
s_add_u32 m0, s67, 0
s_add_u32 s66, s66, 98304
buffer_load_dwordx4 v240, s[4:7], s66 offen lds
ds_read_b128 v[220:223], v248 offset:33792
v_mfma_f32_32x32x16_bf16 v[120:135], v[48:51], v[224:227], 0
v_pk_fma_f16 v154, v155, v155, s48
v_and_b32_e64 v137, s49, v137
v_pk_fma_f16 v151, v152, v152, s48
v_and_b32_e64 v139, s49, v139
v_pk_fma_f16 v148, v149, v149, s48
v_pk_mul_f16 v154, v155, v154
v_bfe_u32 v136, v137, 2, 14
v_pk_mul_f16 v151, v152, v151
v_pk_mul_f16 v148, v149, v148
v_bfe_u32 v138, v139, 2, 14
s_add_u32 m0, s67, 6656
s_add_u32 s66, s66, 98304
buffer_load_dwordx4 v240, s[4:7], s66 offen lds
ds_read_b128 v[224:227], v248 offset:34816
ds_read_u16_d16 v136, v136
ds_read_u16_d16 v138, v138
v_mfma_f32_32x32x16_bf16 v[120:135], v[52:55], v[228:231], v[120:135]
v_exp_f16 v153, v154
v_lshrrev_b32 v137, 18, v137
v_exp_f16 v150, v151
v_lshrrev_b32 v139, 18, v139
v_exp_f16 v147, v148
v_and_b32 v141, s49, v141
v_and_b32_e64 v143, s49, v143
s_add_u32 m0, s67, 13312
s_add_u32 s66, s66, 98304
buffer_load_dwordx4 v240, s[4:7], s66 offen lds
ds_read_b128 v[228:231], v248 offset:37888
ds_read_u16_d16_hi v137, v137
ds_read_u16_d16_hi v139, v139
v_mfma_f32_32x32x16_bf16 v[120:135], v[56:59], v[232:235], v[120:135]
v_exp_f16_sdwa v153, v154 dst_sel:WORD_1 dst_unused:UNUSED_PRESERVE src0_sel:WORD_1
v_bfe_u32 v140, v141, 2, 14
v_exp_f16_sdwa v150, v151 dst_sel:WORD_1 dst_unused:UNUSED_PRESERVE src0_sel:WORD_1
v_bfe_u32 v142, v143, 2, 14
v_exp_f16_sdwa v147, v148 dst_sel:WORD_1 dst_unused:UNUSED_PRESERVE src0_sel:WORD_1
v_lshrrev_b32_e64 v141, 18, v141
v_pk_add_f16 v153, v153, 1.0 op_sel_hi:[1,0]
s_add_u32 m0, s67, 19968
s_add_u32 s66, s66, 98304
buffer_load_dwordx4 v240, s[4:7], s66 offen lds
s_add_u32 m0, s67, 26624
s_add_u32 s66, s66, 98304
buffer_load_dwordx4 v240, s[4:7], s66 offen lds
ds_read_b128 v[232:235], v248 offset:35840
ds_read_u16_d16 v140, v140
ds_read_u16_d16 v142, v142
ds_read_u16_d16_hi v141, v141
v_mfma_f32_32x32x16_bf16 v[120:135], v[60:63], v[236:239], v[120:135]
v_lshrrev_b32_e64 v143, 18, v143
v_pk_add_f16 v150, v150, 1.0 op_sel_hi:[1,0]
v_pk_add_f16 v147, v147, 1.0 op_sel_hi:[1,0]
v_and_b32 v145, s49, v145
v_rcp_f16 v154, v153
v_bfe_u32 v144, v145, 2, 14
v_rcp_f16_e64 v151, v150
v_lshrrev_b32 v145, 18, v145
s_waitcnt lgkmcnt(4)
s_add_u32 m0, s67, 33280
s_add_u32 s66, s66, 98304
buffer_load_dwordx4 v240, s[4:7], s66 offen lds
ds_read_b128 v[236:239], v248 offset:38912
ds_read_u16_d16_hi v143, v143
ds_read_u16_d16 v144, v144
ds_read_u16_d16_hi v145, v145
v_mfma_f32_32x32x16_bf16 v[120:135], v[64:67], v[216:219], v[120:135]
v_rcp_f16 v148, v147
v_rcp_f16_sdwa v154, v153 dst_sel:WORD_1 dst_unused:UNUSED_PRESERVE src0_sel:WORD_1
v_fma_mix_f32 v157, v136, v136, 0 op_sel:[0,0,0] op_sel_hi:[1,1,0]
v_fma_mix_f32 v157, v137, v137, v157 op_sel:[1,1,0] op_sel_hi:[1,1,0]
v_rcp_f16_sdwa v151, v150 dst_sel:WORD_1 dst_unused:UNUSED_PRESERVE src0_sel:WORD_1
v_fma_mix_f32 v157, v138, v138, v157 op_sel:[0,0,0] op_sel_hi:[1,1,0]
s_add_u32 m0, s67, 39936
s_add_u32 s66, s66, 98304
buffer_load_dwordx4 v240, s[4:7], s66 offen lds
ds_read_b128 v[216:219], v248 offset:36864
v_mfma_f32_32x32x16_bf16 v[120:135], v[68:71], v[220:223], v[120:135]
v_rcp_f16_sdwa v148, v147 dst_sel:WORD_1 dst_unused:UNUSED_PRESERVE src0_sel:WORD_1
v_fma_mix_f32 v157, v139, v139, v157 op_sel:[1,1,0] op_sel_hi:[1,1,0]
v_pk_mul_f16 v155, v155, v154
s_waitcnt lgkmcnt(5)
v_fma_mix_f32 v157, v140, v140, v157 op_sel:[0,0,0] op_sel_hi:[1,1,0]
v_pk_mul_f16 v152, v152, v151
v_fma_mix_f32 v157, v141, v141, v157 op_sel:[1,1,0] op_sel_hi:[1,1,0]
v_pk_mul_f16 v149, v149, v148
v_fma_mix_f32 v157, v155, v155, v157 op_sel:[0,0,0] op_sel_hi:[1,1,0]
v_fma_mix_f32 v157, v142, v142, v157 op_sel:[0,0,0] op_sel_hi:[1,1,0]
v_fma_mix_f32 v157, v155, v155, v157 op_sel:[1,1,0] op_sel_hi:[1,1,0]
s_add_u32 m0, s67, 46592
s_add_u32 s66, s66, 98304
buffer_load_dwordx4 v240, s[4:7], s66 offen lds
s_waitcnt lgkmcnt(1)
v_fma_mix_f32 v157, v143, v143, v157 op_sel:[1,1,0] op_sel_hi:[1,1,0]
v_fma_mix_f32 v157, v152, v152, v157 op_sel:[0,0,0] op_sel_hi:[1,1,0]
v_fma_mix_f32 v157, v152, v152, v157 op_sel:[1,1,0] op_sel_hi:[1,1,0]
v_fma_mix_f32 v157, v144, v144, v157 op_sel:[0,0,0] op_sel_hi:[1,1,0]
v_fma_mix_f32 v157, v149, v149, v157 op_sel:[0,0,0] op_sel_hi:[1,1,0]
v_fma_mix_f32 v157, v145, v145, v157 op_sel:[1,1,0] op_sel_hi:[1,1,0]
v_fma_mix_f32 v157, v149, v149, v157 op_sel:[1,1,0] op_sel_hi:[1,1,0]
s_setprio 1
v_cvt_pkrtz_f16_f32 v137, v120, v121
v_cvt_pkrtz_f16_f32 v139, v122, v123
v_cvt_pkrtz_f16_f32 v141, v124, v125
v_cvt_pkrtz_f16_f32 v143, v126, v127
v_cvt_pkrtz_f16_f32 v145, v128, v129
v_cvt_pk_f16_f32 v155, v130, v131
v_cvt_pk_f16_f32 v152, v132, v133
v_cvt_pk_f16_f32 v149, v134, v135
ds_read_b128 v[220:223], v248 offset:39936
v_mfma_f32_32x32x16_bf16 v[120:135], v[48:51], v[224:227], 0
v_pk_fma_f16 v154, v155, v155, s48
v_and_b32_e64 v137, s49, v137
v_pk_fma_f16 v151, v152, v152, s48
v_and_b32_e64 v139, s49, v139
v_pk_fma_f16 v148, v149, v149, s48
v_pk_mul_f16 v154, v155, v154
v_bfe_u32 v136, v137, 2, 14
v_pk_mul_f16 v151, v152, v151
v_pk_mul_f16 v148, v149, v148
v_bfe_u32 v138, v139, 2, 14
ds_read_u16_d16 v136, v136
ds_read_b32 v247, v253 offset:24
ds_read_u16_d16 v138, v138
v_mfma_f32_32x32x16_bf16 v[120:135], v[52:55], v[228:231], v[120:135]
v_exp_f16 v153, v154
v_lshrrev_b32 v137, 18, v137
v_exp_f16 v150, v151
v_lshrrev_b32 v139, 18, v139
v_exp_f16 v147, v148
v_and_b32 v141, s49, v141
v_and_b32_e64 v143, s49, v143
ds_read_u16_d16_hi v137, v137
ds_read_u16_d16_hi v139, v139
v_mfma_f32_32x32x16_bf16 v[120:135], v[56:59], v[232:235], v[120:135]
v_exp_f16_sdwa v153, v154 dst_sel:WORD_1 dst_unused:UNUSED_PRESERVE src0_sel:WORD_1
v_bfe_u32 v140, v141, 2, 14
v_exp_f16_sdwa v150, v151 dst_sel:WORD_1 dst_unused:UNUSED_PRESERVE src0_sel:WORD_1
v_bfe_u32 v142, v143, 2, 14
v_exp_f16_sdwa v147, v148 dst_sel:WORD_1 dst_unused:UNUSED_PRESERVE src0_sel:WORD_1
v_lshrrev_b32_e64 v141, 18, v141
v_pk_add_f16 v153, v153, 1.0 op_sel_hi:[1,0]
ds_read_u16_d16 v140, v140
ds_read_u16_d16 v142, v142
ds_read_u16_d16_hi v141, v141
s_waitcnt lgkmcnt(6)
v_readfirstlane_b32 s43, v247
s_nop 1
s_cmp_ge_u32 s43, 4
s_cbranch_scc1 Lev2
Lev2w:
s_sleep 1
ds_read_b32 v247, v253 offset:24
s_waitcnt lgkmcnt(0)
v_readfirstlane_b32 s43, v247
s_cmp_eq_u32 s76, 0
s_cbranch_scc1 Lev2
s_sub_u32 s76, s76, 1
s_cmp_lt_u32 s43, 4
s_cbranch_scc1 Lev2w
Lev2:
ds_read_b128 v[224:227], v248 offset:40960
ds_read_b128 v[228:231], v248 offset:44032
ds_read_b128 v[232:235], v248 offset:41984
v_mfma_f32_32x32x16_bf16 v[120:135], v[60:63], v[236:239], v[120:135]
v_lshrrev_b32 v143, 18, v143
v_pk_add_f16 v150, v150, 1.0 op_sel_hi:[1,0]
v_pk_add_f16 v147, v147, 1.0 op_sel_hi:[1,0]
v_and_b32 v145, s49, v145
v_rcp_f16 v154, v153
v_bfe_u32 v144, v145, 2, 14
v_rcp_f16 v151, v150
v_lshrrev_b32 v145, 18, v145
ds_read_b128 v[236:239], v248 offset:45056
ds_read_u16_d16_hi v143, v143
ds_read_u16_d16 v144, v144
ds_read_u16_d16_hi v145, v145
v_mfma_f32_32x32x16_bf16 v[120:135], v[64:67], v[216:219], v[120:135]
v_rcp_f16 v148, v147
v_rcp_f16_sdwa v154, v153 dst_sel:WORD_1 dst_unused:UNUSED_PRESERVE src0_sel:WORD_1
v_fma_mix_f32 v158, v136, v136, 0 op_sel:[0,0,0] op_sel_hi:[1,1,0]
s_waitcnt lgkmcnt(7)
v_fma_mix_f32 v158, v137, v137, v158 op_sel:[1,1,0] op_sel_hi:[1,1,0]
v_rcp_f16_sdwa v151, v150 dst_sel:WORD_1 dst_unused:UNUSED_PRESERVE src0_sel:WORD_1
v_fma_mix_f32 v158, v138, v138, v158 op_sel:[0,0,0] op_sel_hi:[1,1,0]
ds_read_b128 v[216:219], v248 offset:43008
v_mfma_f32_32x32x16_bf16 v[120:135], v[68:71], v[220:223], v[120:135]
v_rcp_f16_sdwa v148, v147 dst_sel:WORD_1 dst_unused:UNUSED_PRESERVE src0_sel:WORD_1
v_fma_mix_f32 v158, v139, v139, v158 op_sel:[1,1,0] op_sel_hi:[1,1,0]
v_pk_mul_f16 v155, v155, v154
v_fma_mix_f32 v158, v140, v140, v158 op_sel:[0,0,0] op_sel_hi:[1,1,0]
v_pk_mul_f16 v152, v152, v151
v_fma_mix_f32 v158, v141, v141, v158 op_sel:[1,1,0] op_sel_hi:[1,1,0]
v_pk_mul_f16 v149, v149, v148
v_fma_mix_f32 v158, v155, v155, v158 op_sel:[0,0,0] op_sel_hi:[1,1,0]
v_fma_mix_f32 v158, v142, v142, v158 op_sel:[0,0,0] op_sel_hi:[1,1,0]
v_fma_mix_f32 v158, v155, v155, v158 op_sel:[1,1,0] op_sel_hi:[1,1,0]
s_waitcnt lgkmcnt(3)
v_fma_mix_f32 v158, v143, v143, v158 op_sel:[1,1,0] op_sel_hi:[1,1,0]
v_fma_mix_f32 v158, v152, v152, v158 op_sel:[0,0,0] op_sel_hi:[1,1,0]
v_fma_mix_f32 v158, v152, v152, v158 op_sel:[1,1,0] op_sel_hi:[1,1,0]
s_waitcnt lgkmcnt(1)
v_fma_mix_f32 v158, v144, v144, v158 op_sel:[0,0,0] op_sel_hi:[1,1,0]
v_fma_mix_f32 v158, v149, v149, v158 op_sel:[0,0,0] op_sel_hi:[1,1,0]
v_fma_mix_f32 v158, v145, v145, v158 op_sel:[1,1,0] op_sel_hi:[1,1,0]
v_fma_mix_f32 v158, v149, v149, v158 op_sel:[1,1,0] op_sel_hi:[1,1,0]
v_cvt_pkrtz_f16_f32 v137, v120, v121
v_cvt_pkrtz_f16_f32 v139, v122, v123
v_cvt_pkrtz_f16_f32 v141, v124, v125
v_cvt_pkrtz_f16_f32 v143, v126, v127
v_cvt_pkrtz_f16_f32 v145, v128, v129
v_cvt_pk_f16_f32 v155, v130, v131
v_cvt_pk_f16_f32 v152, v132, v133
v_cvt_pk_f16_f32 v149, v134, v135
buffer_store_dwordx4 v[48:51], v241, s[32:35], s80 offen sc1
ds_read_b128 v[220:223], v248 offset:46080
v_mfma_f32_32x32x16_bf16 v[120:135], v[48:51], v[224:227], 0
v_pk_fma_f16 v154, v155, v155, s48
v_and_b32_e64 v137, s49, v137
v_pk_fma_f16 v151, v152, v152, s48
v_and_b32_e64 v139, s49, v139
v_pk_fma_f16 v148, v149, v149, s48
v_pk_mul_f16 v154, v155, v154
v_bfe_u32 v136, v137, 2, 14
v_pk_mul_f16 v151, v152, v151
v_pk_mul_f16 v148, v149, v148
v_bfe_u32 v138, v139, 2, 14
ds_read_b128 v[224:227], v248 offset:47104
ds_read_u16_d16 v136, v136
ds_read_u16_d16 v138, v138
v_mfma_f32_32x32x16_bf16 v[120:135], v[52:55], v[228:231], v[120:135]
v_exp_f16 v153, v154
v_lshrrev_b32 v137, 18, v137
v_exp_f16 v150, v151
v_lshrrev_b32 v139, 18, v139
v_exp_f16 v147, v148
v_and_b32 v141, s49, v141
v_and_b32_e64 v143, s49, v143
ds_read_b128 v[228:231], v248 offset:50176
ds_read_u16_d16_hi v137, v137
ds_read_u16_d16_hi v139, v139
v_mfma_f32_32x32x16_bf16 v[120:135], v[56:59], v[232:235], v[120:135]
v_exp_f16_sdwa v153, v154 dst_sel:WORD_1 dst_unused:UNUSED_PRESERVE src0_sel:WORD_1
v_bfe_u32 v140, v141, 2, 14
v_exp_f16_sdwa v150, v151 dst_sel:WORD_1 dst_unused:UNUSED_PRESERVE src0_sel:WORD_1
v_bfe_u32 v142, v143, 2, 14
v_exp_f16_sdwa v147, v148 dst_sel:WORD_1 dst_unused:UNUSED_PRESERVE src0_sel:WORD_1
v_lshrrev_b32_e64 v141, 18, v141
v_pk_add_f16 v153, v153, 1.0 op_sel_hi:[1,0]
ds_read_b128 v[232:235], v248 offset:48128
ds_read_u16_d16 v140, v140
ds_read_u16_d16 v142, v142
ds_read_u16_d16_hi v141, v141
v_mfma_f32_32x32x16_bf16 v[120:135], v[60:63], v[236:239], v[120:135]
v_lshrrev_b32_e64 v143, 18, v143
v_pk_add_f16 v150, v150, 1.0 op_sel_hi:[1,0]
v_pk_add_f16 v147, v147, 1.0 op_sel_hi:[1,0]
v_and_b32 v145, s49, v145
v_rcp_f16 v154, v153
v_bfe_u32 v144, v145, 2, 14
v_rcp_f16_e64 v151, v150
v_lshrrev_b32 v145, 18, v145
s_waitcnt lgkmcnt(7)
ds_read_b128 v[236:239], v248 offset:51200
ds_read_u16_d16_hi v143, v143
ds_read_u16_d16 v144, v144
ds_read_u16_d16_hi v145, v145
v_mfma_f32_32x32x16_bf16 v[120:135], v[64:67], v[216:219], v[120:135]
v_rcp_f16 v148, v147
v_rcp_f16_sdwa v154, v153 dst_sel:WORD_1 dst_unused:UNUSED_PRESERVE src0_sel:WORD_1
v_fma_mix_f32 v159, v136, v136, 0 op_sel:[0,0,0] op_sel_hi:[1,1,0]
s_waitcnt lgkmcnt(8)
v_fma_mix_f32 v159, v137, v137, v159 op_sel:[1,1,0] op_sel_hi:[1,1,0]
v_rcp_f16_sdwa v151, v150 dst_sel:WORD_1 dst_unused:UNUSED_PRESERVE src0_sel:WORD_1
v_fma_mix_f32 v159, v138, v138, v159 op_sel:[0,0,0] op_sel_hi:[1,1,0]
ds_read_b128 v[216:219], v248 offset:49152
v_mfma_f32_32x32x16_bf16 v[120:135], v[68:71], v[220:223], v[120:135]
v_rcp_f16_sdwa v148, v147 dst_sel:WORD_1 dst_unused:UNUSED_PRESERVE src0_sel:WORD_1
v_fma_mix_f32 v159, v139, v139, v159 op_sel:[1,1,0] op_sel_hi:[1,1,0]
s_cmp_eq_u32 s40, 7
s_cbranch_scc1 Lrdy8
s_waitcnt vmcnt(1)
Lrdy8:
s_mov_b64 exec, 1
ds_add_u32 v253, v254 offset:12
s_mov_b64 exec, -1
v_pk_mul_f16 v155, v155, v154
s_waitcnt lgkmcnt(6)
v_fma_mix_f32 v159, v140, v140, v159 op_sel:[0,0,0] op_sel_hi:[1,1,0]
v_pk_mul_f16 v152, v152, v151
v_fma_mix_f32 v159, v141, v141, v159 op_sel:[1,1,0] op_sel_hi:[1,1,0]
v_pk_mul_f16 v149, v149, v148
v_fma_mix_f32 v159, v155, v155, v159 op_sel:[0,0,0] op_sel_hi:[1,1,0]
v_fma_mix_f32 v159, v142, v142, v159 op_sel:[0,0,0] op_sel_hi:[1,1,0]
v_fma_mix_f32 v159, v155, v155, v159 op_sel:[1,1,0] op_sel_hi:[1,1,0]
s_waitcnt lgkmcnt(2)
v_fma_mix_f32 v159, v143, v143, v159 op_sel:[1,1,0] op_sel_hi:[1,1,0]
v_fma_mix_f32 v159, v152, v152, v159 op_sel:[0,0,0] op_sel_hi:[1,1,0]
v_fma_mix_f32 v159, v152, v152, v159 op_sel:[1,1,0] op_sel_hi:[1,1,0]
v_fma_mix_f32 v159, v144, v144, v159 op_sel:[0,0,0] op_sel_hi:[1,1,0]
v_fma_mix_f32 v159, v149, v149, v159 op_sel:[0,0,0] op_sel_hi:[1,1,0]
v_fma_mix_f32 v159, v145, v145, v159 op_sel:[1,1,0] op_sel_hi:[1,1,0]
v_fma_mix_f32 v159, v149, v149, v159 op_sel:[1,1,0] op_sel_hi:[1,1,0]
v_cvt_pkrtz_f16_f32 v137, v120, v121
v_cvt_pkrtz_f16_f32 v139, v122, v123
v_cvt_pkrtz_f16_f32 v141, v124, v125
v_cvt_pkrtz_f16_f32 v143, v126, v127
v_cvt_pkrtz_f16_f32 v145, v128, v129
v_cvt_pk_f16_f32 v155, v130, v131
v_cvt_pk_f16_f32 v152, v132, v133
v_cvt_pk_f16_f32 v149, v134, v135
s_setprio 0
s_add_u32 s46, s80, 2097152
buffer_store_dwordx4 v[52:55], v241, s[32:35], s46 offen sc1
ds_read_b128 v[220:223], v248 offset:52224
v_mfma_f32_32x32x16_bf16 v[120:135], v[48:51], v[224:227], 0
v_pk_fma_f16 v154, v155, v155, s48
v_and_b32_e64 v137, s49, v137
v_pk_fma_f16 v151, v152, v152, s48
v_and_b32_e64 v139, s49, v139
v_pk_fma_f16 v148, v149, v149, s48
v_pk_mul_f16 v154, v155, v154
v_bfe_u32 v136, v137, 2, 14
v_pk_mul_f16 v151, v152, v151
v_pk_mul_f16 v148, v149, v148
v_bfe_u32 v138, v139, 2, 14
ds_read_b128 v[224:227], v250 offset:65520
ds_read_u16_d16 v136, v136
ds_read_u16_d16 v138, v138
v_mfma_f32_32x32x16_bf16 v[120:135], v[52:55], v[228:231], v[120:135]
v_exp_f16 v153, v154
v_lshrrev_b32 v137, 18, v137
v_exp_f16 v150, v151
v_lshrrev_b32 v139, 18, v139
v_exp_f16 v147, v148
v_and_b32 v141, s49, v141
v_and_b32_e64 v143, s49, v143
ds_read_b128 v[228:231], v248 offset:53248
ds_read_u16_d16_hi v137, v137
ds_read_b32 v247, v253 offset:12
ds_read_u16_d16_hi v139, v139
v_mfma_f32_32x32x16_bf16 v[120:135], v[56:59], v[232:235], v[120:135]
v_exp_f16_sdwa v153, v154 dst_sel:WORD_1 dst_unused:UNUSED_PRESERVE src0_sel:WORD_1
v_bfe_u32 v140, v141, 2, 14
v_exp_f16_sdwa v150, v151 dst_sel:WORD_1 dst_unused:UNUSED_PRESERVE src0_sel:WORD_1
v_bfe_u32 v142, v143, 2, 14
v_exp_f16_sdwa v147, v148 dst_sel:WORD_1 dst_unused:UNUSED_PRESERVE src0_sel:WORD_1
v_lshrrev_b32_e64 v141, 18, v141
v_pk_add_f16 v153, v153, 1.0 op_sel_hi:[1,0]
ds_read_b128 v[232:235], v248 offset:56320
ds_read_u16_d16 v140, v140
ds_read_u16_d16 v142, v142
ds_read_u16_d16_hi v141, v141
v_mfma_f32_32x32x16_bf16 v[120:135], v[60:63], v[236:239], v[120:135]
v_lshrrev_b32_e64 v143, 18, v143
v_pk_add_f16 v150, v150, 1.0 op_sel_hi:[1,0]
v_pk_add_f16 v147, v147, 1.0 op_sel_hi:[1,0]
v_and_b32 v145, s49, v145
v_rcp_f16 v154, v153
v_bfe_u32 v144, v145, 2, 14
ds_read_u16_d16_hi v143, v143
ds_read_u16_d16 v144, v144
s_waitcnt lgkmcnt(7)
v_readfirstlane_b32 s43, v247
s_nop 1
s_cmp_ge_u32 s43, 16
s_cbranch_scc1 Lev3
Lev3w:
s_sleep 1
ds_read_b32 v247, v253 offset:12
s_waitcnt lgkmcnt(0)
v_readfirstlane_b32 s43, v247
s_cmp_eq_u32 s76, 0
s_cbranch_scc1 Lev3
s_sub_u32 s76, s76, 1
s_cmp_lt_u32 s43, 16
s_cbranch_scc1 Lev3w
Lev3:
v_rcp_f16 v151, v150
v_lshrrev_b32_e64 v145, 18, v145
ds_read_b128 v[236:239], v245 offset:6528
ds_read_b128 v[192:195], v244 offset:128
ds_read_b128 v[196:199], v244 offset:64
ds_read_u16_d16_hi v145, v145
v_mfma_f32_32x32x16_bf16 v[120:135], v[64:67], v[216:219], v[120:135]
v_rcp_f16 v148, v147
v_rcp_f16_sdwa v154, v153 dst_sel:WORD_1 dst_unused:UNUSED_PRESERVE src0_sel:WORD_1
v_fma_mix_f32 v160, v136, v136, 0 op_sel:[0,0,0] op_sel_hi:[1,1,0]
v_fma_mix_f32 v160, v137, v137, v160 op_sel:[1,1,0] op_sel_hi:[1,1,0]
v_rcp_f16_sdwa v151, v150 dst_sel:WORD_1 dst_unused:UNUSED_PRESERVE src0_sel:WORD_1
v_fma_mix_f32 v160, v138, v138, v160 op_sel:[0,0,0] op_sel_hi:[1,1,0]
ds_read_b128 v[216:219], v248 offset:54272
v_mfma_f32_32x32x16_bf16 v[120:135], v[68:71], v[220:223], v[120:135]
v_rcp_f16_sdwa v148, v147 dst_sel:WORD_1 dst_unused:UNUSED_PRESERVE src0_sel:WORD_1
s_waitcnt lgkmcnt(5)
v_fma_mix_f32 v160, v139, v139, v160 op_sel:[1,1,0] op_sel_hi:[1,1,0]
v_pk_mul_f16 v155, v155, v154
v_fma_mix_f32 v160, v140, v140, v160 op_sel:[0,0,0] op_sel_hi:[1,1,0]
v_pk_mul_f16 v152, v152, v151
v_fma_mix_f32 v160, v141, v141, v160 op_sel:[1,1,0] op_sel_hi:[1,1,0]
v_pk_mul_f16 v149, v149, v148
v_fma_mix_f32 v160, v155, v155, v160 op_sel:[0,0,0] op_sel_hi:[1,1,0]
v_fma_mix_f32 v160, v142, v142, v160 op_sel:[0,0,0] op_sel_hi:[1,1,0]
v_fma_mix_f32 v160, v155, v155, v160 op_sel:[1,1,0] op_sel_hi:[1,1,0]
v_fma_mix_f32 v160, v143, v143, v160 op_sel:[1,1,0] op_sel_hi:[1,1,0]
v_fma_mix_f32 v160, v152, v152, v160 op_sel:[0,0,0] op_sel_hi:[1,1,0]
v_fma_mix_f32 v160, v152, v152, v160 op_sel:[1,1,0] op_sel_hi:[1,1,0]
v_fma_mix_f32 v160, v144, v144, v160 op_sel:[0,0,0] op_sel_hi:[1,1,0]
v_fma_mix_f32 v160, v149, v149, v160 op_sel:[0,0,0] op_sel_hi:[1,1,0]
s_waitcnt lgkmcnt(1)
v_fma_mix_f32 v160, v145, v145, v160 op_sel:[1,1,0] op_sel_hi:[1,1,0]
v_fma_mix_f32 v160, v149, v149, v160 op_sel:[1,1,0] op_sel_hi:[1,1,0]
v_lshlrev_b32 v252, 7, v251
s_add_u32 s46, s47, 1572864
s_mov_b32 exec_lo, 131071
s_mov_b32 exec_hi, 0
s_mov_b32 m0, 16288
s_nop 0
buffer_load_dword v252, s[4:7], s46 offen lds
s_mov_b64 exec, -1
s_setprio 2
v_mfma_f32_32x32x16_bf16 v[0:15], v[224:227], v[224:227], 0
s_add_u32 s46, s80, 4194304
buffer_store_dwordx4 v[56:59], v241, s[32:35], s46 offen sc1
ds_read_b128 v[220:223], v245 offset:6144
ds_read_b128 v[200:203], v244
ds_read_b128 v[204:207], v243 offset:128
v_cvt_pkrtz_f16_f32 v137, v120, v121
v_cvt_pkrtz_f16_f32 v139, v122, v123
v_cvt_pkrtz_f16_f32 v141, v124, v125
v_mfma_f32_32x32x16_bf16 v[16:31], v[224:227], v[224:227], 0
v_cvt_pkrtz_f16_f32 v143, v126, v127
v_cvt_pkrtz_f16_f32 v145, v128, v129
v_cvt_pk_f16_f32 v155, v130, v131
v_mfma_f32_32x32x16_bf16 v[32:47], v[224:227], v[224:227], 0
v_cvt_pk_f16_f32 v152, v132, v133
v_cvt_pk_f16_f32 v149, v134, v135
v_pk_fma_f16 v154, v155, v155, s48
v_mfma_f32_32x32x16_bf16 v[120:135], v[48:51], v[228:231], 0
ds_read_b128 v[224:227], v248 offset:57344
v_and_b32_e64 v137, s49, v137
v_pk_fma_f16 v151, v152, v152, s48
v_and_b32_e64 v139, s49, v139
v_pk_fma_f16 v148, v149, v149, s48
v_pk_mul_f16 v154, v155, v154
v_bfe_u32 v136, v137, 2, 14
v_mfma_f32_32x32x16_bf16 v[120:135], v[52:55], v[232:235], v[120:135]
ds_read_b128 v[228:231], v245 offset:5760
ds_read_b128 v[208:211], v243 offset:64
ds_read_b128 v[212:215], v243
ds_read_u16_d16 v136, v136
v_pk_mul_f16 v151, v152, v151
v_pk_mul_f16 v148, v149, v148
v_bfe_u32 v138, v139, 2, 14
v_exp_f16 v153, v154
v_lshrrev_b32 v137, 18, v137
v_smfmac_f32_16x16x32_bf16 v[40:43], v[238:239], v[192:195], v246
ds_read_b128 v[232:235], v248 offset:55296
ds_read_u16_d16 v138, v138
ds_read_u16_d16_hi v137, v137
v_exp_f16 v150, v151
v_lshrrev_b32 v139, 18, v139
v_smfmac_f32_16x16x32_bf16 v[24:27], v[236:237], v[196:199], v246
v_exp_f16_e64 v147, v148
v_and_b32 v141, s49, v141
s_waitcnt lgkmcnt(7)
v_mfma_f32_32x32x16_bf16 v[120:135], v[56:59], v[216:219], v[120:135]
ds_read_b128 v[236:239], v245 offset:5376
ds_read_b128 v[192:195], v242 offset:128
ds_read_b128 v[196:199], v242 offset:64
ds_read_u16_d16_hi v139, v139
v_and_b32_e64 v143, s49, v143
v_exp_f16_sdwa v153, v154 dst_sel:WORD_1 dst_unused:UNUSED_PRESERVE src0_sel:WORD_1
v_bfe_u32 v140, v141, 2, 14
v_exp_f16_sdwa v150, v151 dst_sel:WORD_1 dst_unused:UNUSED_PRESERVE src0_sel:WORD_1
v_smfmac_f32_16x16x32_bf16 v[8:11], v[222:223], v[200:203], v246
ds_read_b128 v[216:219], v248 offset:58368
ds_read_u16_d16 v140, v140
v_bfe_u32 v142, v143, 2, 14
v_exp_f16_sdwa v147, v148 dst_sel:WORD_1 dst_unused:UNUSED_PRESERVE src0_sel:WORD_1
v_smfmac_f32_16x16x32_bf16 v[40:43], v[220:221], v[204:207], v246
v_lshrrev_b32_e64 v141, 18, v141
v_pk_add_f16 v153, v153, 1.0 op_sel_hi:[1,0]
v_lshrrev_b32 v143, 18, v143
v_mfma_f32_32x32x16_bf16 v[120:135], v[60:63], v[224:227], v[120:135]
ds_read_b128 v[220:223], v245 offset:4992
ds_read_b128 v[200:203], v242
v_xor_b32 v244, 16, v244
ds_read_b128 v[204:207], v244 offset:128
ds_read_u16_d16 v142, v142
ds_read_u16_d16_hi v141, v141
ds_read_u16_d16_hi v143, v143
v_pk_add_f16 v150, v150, 1.0 op_sel_hi:[1,0]
v_pk_add_f16 v147, v147, 1.0 op_sel_hi:[1,0]
v_and_b32_e64 v145, s49, v145
v_rcp_f16 v154, v153
v_bfe_u32 v144, v145, 2, 14
s_waitcnt lgkmcnt(8)
v_smfmac_f32_16x16x32_bf16 v[24:27], v[230:231], v[208:211], v246
ds_read_b128 v[224:227], v245 offset:4608
ds_read_u16_d16 v144, v144
v_rcp_f16 v151, v150
v_lshrrev_b32 v145, 18, v145
v_smfmac_f32_16x16x32_bf16 v[8:11], v[228:229], v[212:215], v246
v_rcp_f16_e64 v148, v147
v_mfma_f32_32x32x16_bf16 v[120:135], v[64:67], v[232:235], v[120:135]
ds_read_b128 v[208:211], v244 offset:64
ds_read_b128 v[212:215], v244
ds_read_b128 v[228:231], v248 offset:59392
ds_read_u16_d16_hi v145, v145
v_rcp_f16_sdwa v154, v153 dst_sel:WORD_1 dst_unused:UNUSED_PRESERVE src0_sel:WORD_1
v_fma_mix_f32 v161, v136, v136, 0 op_sel:[0,0,0] op_sel_hi:[1,1,0]
v_fma_mix_f32 v161, v137, v137, v161 op_sel:[1,1,0] op_sel_hi:[1,1,0]
v_rcp_f16_sdwa v151, v150 dst_sel:WORD_1 dst_unused:UNUSED_PRESERVE src0_sel:WORD_1
v_fma_mix_f32 v161, v138, v138, v161 op_sel:[0,0,0] op_sel_hi:[1,1,0]
v_smfmac_f32_16x16x32_bf16 v[40:43], v[238:239], v[192:195], v246
ds_read_b128 v[232:235], v248 offset:62464
v_rcp_f16_sdwa v148, v147 dst_sel:WORD_1 dst_unused:UNUSED_PRESERVE src0_sel:WORD_1
v_fma_mix_f32 v161, v139, v139, v161 op_sel:[1,1,0] op_sel_hi:[1,1,0]
v_smfmac_f32_16x16x32_bf16 v[24:27], v[236:237], v[196:199], v246
v_pk_mul_f16 v155, v155, v154
s_waitcnt lgkmcnt(7)
v_fma_mix_f32 v161, v140, v140, v161 op_sel:[0,0,0] op_sel_hi:[1,1,0]
v_pk_mul_f16 v152, v152, v151
v_mfma_f32_32x32x16_bf16 v[120:135], v[68:71], v[216:219], v[120:135]
ds_read_b128 v[236:239], v248 offset:60416
v_fma_mix_f32 v161, v141, v141, v161 op_sel:[1,1,0] op_sel_hi:[1,1,0]
v_pk_mul_f16 v149, v149, v148
v_fma_mix_f32 v161, v155, v155, v161 op_sel:[0,0,0] op_sel_hi:[1,1,0]
v_fma_mix_f32 v161, v142, v142, v161 op_sel:[0,0,0] op_sel_hi:[1,1,0]
v_fma_mix_f32 v161, v155, v155, v161 op_sel:[1,1,0] op_sel_hi:[1,1,0]
v_fma_mix_f32 v161, v143, v143, v161 op_sel:[1,1,0] op_sel_hi:[1,1,0]
v_smfmac_f32_16x16x32_bf16 v[8:11], v[222:223], v[200:203], v246
ds_read_b128 v[216:219], v245 offset:4224
v_xor_b32 v243, 16, v243
ds_read_b128 v[192:195], v243 offset:128
ds_read_b128 v[196:199], v243 offset:64
v_fma_mix_f32 v161, v152, v152, v161 op_sel:[0,0,0] op_sel_hi:[1,1,0]
v_fma_mix_f32 v161, v152, v152, v161 op_sel:[1,1,0] op_sel_hi:[1,1,0]
s_waitcnt lgkmcnt(5)
v_fma_mix_f32 v161, v144, v144, v161 op_sel:[0,0,0] op_sel_hi:[1,1,0]
v_smfmac_f32_16x16x32_bf16 v[44:47], v[220:221], v[204:207], v246
v_fma_mix_f32 v161, v149, v149, v161 op_sel:[0,0,0] op_sel_hi:[1,1,0]
v_fma_mix_f32 v161, v145, v145, v161 op_sel:[1,1,0] op_sel_hi:[1,1,0]
v_fma_mix_f32 v161, v149, v149, v161 op_sel:[1,1,0] op_sel_hi:[1,1,0]
s_cmp_lg_u32 s40, 7
s_cbranch_scc1 Lnosent
v_mov_b32 v180, -1
v_mov_b32 v181, -1
v_mov_b32 v182, -1
v_mov_b32 v183, -1
v_lshlrev_b32 v176, 12, v251
v_add_u32 v177, 262144, v176
v_cmp_gt_u32 vcc, 32, v251
v_mov_b32 v178, 2147483648
s_nop 0
v_cndmask_b32 v177, v178, v177, vcc
s_lshl_b32 s43, s2, 4
buffer_store_dwordx4 v[180:183], v176, s[32:35], s43 offen sc1
buffer_store_dwordx4 v[180:183], v177, s[32:35], s43 offen sc1
s_add_u32 s43, s43, 393216
s_cmp_lt_u32 s2, 96
s_cselect_b32 s43, s43, 1073741824
v_lshlrev_b32_e64 v178, 11, v251
s_mov_b64 exec, 0xff
buffer_store_dwordx4 v[180:183], v178, s[32:35], s43 offen sc1
s_mov_b64 exec, -1
s_sub_u32 s43, s2, 96
s_cmp_lt_u32 s43, 96
s_cbranch_scc0 Lnobias
s_lshl_b32 s44, s43, 1
v_mul_u32_u24 v176, 192, v251
v_lshlrev_b32 v177, 1, v251
s_add_u32 s45, s44, 0
buffer_load_ushort v178, v176, s[16:19], s45 offen
buffer_load_ushort v184, v177, s[28:31], 0 offen offset:0
s_add_u32 s45, s44, 12288
buffer_load_ushort v179, v176, s[16:19], s45 offen
buffer_load_ushort v185, v177, s[28:31], 0 offen offset:128
s_add_u32 s45, s44, 24576
buffer_load_ushort v180, v176, s[16:19], s45 offen
buffer_load_ushort v186, v177, s[28:31], 0 offen offset:256
s_add_u32 s45, s44, 36864
buffer_load_ushort v181, v176, s[16:19], s45 offen
buffer_load_ushort v187, v177, s[28:31], 0 offen offset:384
s_add_u32 s45, s44, 49152
buffer_load_ushort v182, v176, s[16:19], s45 offen
buffer_load_ushort v188, v177, s[28:31], 0 offen offset:512
s_add_u32 s45, s44, 61440
buffer_load_ushort v183, v176, s[16:19], s45 offen
buffer_load_ushort v189, v177, s[28:31], 0 offen offset:640
Lnobias:
s_nop 1
Lnosent:
v_lshlrev_b32 v252, 7, v251
s_add_u32 s46, s47, 1572864
s_mov_b32 exec_lo, 4294836224
s_mov_b32 exec_hi, 3
s_mov_b32 m0, 16220
s_nop 0
buffer_load_dword v252, s[4:7], s46 offen lds
s_mov_b64 exec, -1
s_setprio 1
v_smfmac_f32_16x16x32_bf16 v[28:31], v[226:227], v[208:211], v246
s_add_u32 s46, s80, 6291456
buffer_store_dwordx4 v[60:63], v241, s[32:35], s46 offen sc1
ds_read_b128 v[220:223], v248 offset:63488
v_cvt_pkrtz_f16_f32 v137, v120, v121
v_cvt_pkrtz_f16_f32 v139, v122, v123
v_cvt_pkrtz_f16_f32 v141, v124, v125
v_cvt_pkrtz_f16_f32 v143, v126, v127
v_smfmac_f32_16x16x32_bf16 v[12:15], v[224:225], v[212:215], v246
v_cvt_pk_f16_f32 v155, v128, v129
v_cvt_pk_f16_f32 v152, v130, v131
v_cvt_pk_f16_f32 v149, v132, v133
v_cvt_pk_f16_f32 v146, v134, v135
v_mfma_f32_32x32x16_bf16 v[120:135], v[48:51], v[228:231], 0
ds_read_b128 v[224:227], v248 offset:61440
v_pk_fma_f16 v154, v155, v155, s48
v_and_b32_e64 v137, s49, v137
v_pk_fma_f16 v151, v152, v152, s48
v_pk_fma_f16 v148, v149, v149, s48
v_and_b32_e64 v139, s49, v139
v_pk_fma_f16 v145, v146, v146, s48
v_pk_mul_f16 v154, v155, v154
v_bfe_u32 v136, v137, 2, 14
s_waitcnt lgkmcnt(2)
v_mfma_f32_32x32x16_bf16 v[120:135], v[52:55], v[232:235], v[120:135]
ds_read_b128 v[228:231], v245 offset:3840
ds_read_b128 v[200:203], v243
v_xor_b32 v242, 16, v242
ds_read_b128 v[204:207], v242 offset:128
ds_read_u16_d16 v136, v136
v_pk_mul_f16 v151, v152, v151
v_pk_mul_f16 v148, v149, v148
v_bfe_u32 v138, v139, 2, 14
v_pk_mul_f16 v145, v146, v145
v_exp_f16 v153, v154
v_lshrrev_b32 v137, 18, v137
v_exp_f16_e64 v150, v151
v_mfma_f32_32x32x16_bf16 v[120:135], v[56:59], v[236:239], v[120:135]
ds_read_b128 v[232:235], v248 offset:64512
ds_read_u16_d16 v138, v138
ds_read_u16_d16_hi v137, v137
v_lshrrev_b32 v139, 18, v139
v_exp_f16 v147, v148
v_and_b32 v141, s49, v141
v_exp_f16 v144, v145
v_and_b32_e64 v143, s49, v143
v_smfmac_f32_16x16x32_bf16 v[44:47], v[218:219], v[192:195], v246
ds_read_b128 v[236:239], v245 offset:3456
ds_read_b128 v[208:211], v242 offset:64
ds_read_b128 v[212:215], v242
ds_read_u16_d16_hi v139, v139
v_exp_f16_sdwa v153, v154 dst_sel:WORD_1 dst_unused:UNUSED_PRESERVE src0_sel:WORD_1
v_bfe_u32 v140, v141, 2, 14
v_exp_f16_sdwa v150, v151 dst_sel:WORD_1 dst_unused:UNUSED_PRESERVE src0_sel:WORD_1
v_smfmac_f32_16x16x32_bf16 v[28:31], v[216:217], v[196:199], v246
v_bfe_u32 v142, v143, 2, 14
v_exp_f16_sdwa v147, v148 dst_sel:WORD_1 dst_unused:UNUSED_PRESERVE src0_sel:WORD_1
v_lshrrev_b32_e64 v141, 18, v141
s_waitcnt lgkmcnt(7)
v_mfma_f32_32x32x16_bf16 v[120:135], v[60:63], v[220:223], v[120:135]
ds_read_b128 v[216:219], v245 offset:3072
v_xor_b32 v244, 32, v244
ds_read_b128 v[192:195], v244 offset:128
ds_read_b128 v[196:199], v244 offset:64
ds_read_u16_d16 v140, v140
ds_read_u16_d16 v142, v142
ds_read_u16_d16_hi v141, v141
v_exp_f16_sdwa v144, v145 dst_sel:WORD_1 dst_unused:UNUSED_PRESERVE src0_sel:WORD_1
v_lshrrev_b32_e64 v143, 18, v143
v_pk_add_f16 v153, v153, 1.0 op_sel_hi:[1,0]
v_pk_add_f16 v150, v150, 1.0 op_sel_hi:[1,0]
v_pk_add_f16 v147, v147, 1.0 op_sel_hi:[1,0]
v_pk_add_f16 v144, v144, 1.0 op_sel_hi:[1,0]
v_rcp_f16_e64 v154, v153
v_mfma_f32_32x32x16_bf16 v[120:135], v[64:67], v[224:227], v[120:135]
ds_read_b128 v[220:223], v249
ds_read_u16_d16_hi v143, v143
v_rcp_f16 v151, v150
v_rcp_f16 v148, v147
v_rcp_f16_e64 v145, v144
v_rcp_f16_sdwa v154, v153 dst_sel:WORD_1 dst_unused:UNUSED_PRESERVE src0_sel:WORD_1
v_smfmac_f32_16x16x32_bf16 v[12:15], v[230:231], v[200:203], v246
ds_read_b128 v[224:227], v249 offset:3072
v_rcp_f16_sdwa v151, v150 dst_sel:WORD_1 dst_unused:UNUSED_PRESERVE src0_sel:WORD_1
s_setprio 0
v_rcp_f16_sdwa v148, v147 dst_sel:WORD_1 dst_unused:UNUSED_PRESERVE src0_sel:WORD_1
v_fma_mix_f32 v162, v136, v136, 0 op_sel:[0,0,0] op_sel_hi:[1,1,0]
v_smfmac_f32_16x16x32_bf16 v[44:47], v[228:229], v[204:207], v246
v_rcp_f16_sdwa v145, v144 dst_sel:WORD_1 dst_unused:UNUSED_PRESERVE src0_sel:WORD_1
s_waitcnt lgkmcnt(5)
v_fma_mix_f32 v162, v137, v137, v162 op_sel:[1,1,0] op_sel_hi:[1,1,0]
v_pk_mul_f16 v155, v155, v154
v_mfma_f32_32x32x16_bf16 v[120:135], v[68:71], v[232:235], v[120:135]
ds_read_b128 v[228:231], v245 offset:2688
ds_read_b128 v[200:203], v244
v_xor_b32 v243, 32, v243
ds_read_b128 v[204:207], v243 offset:128
v_fma_mix_f32 v162, v138, v138, v162 op_sel:[0,0,0] op_sel_hi:[1,1,0]
v_pk_mul_f16 v152, v152, v151
v_pk_mul_f16 v149, v149, v148
v_fma_mix_f32 v162, v139, v139, v162 op_sel:[1,1,0] op_sel_hi:[1,1,0]
v_pk_mul_f16 v146, v146, v145
v_fma_mix_f32 v162, v155, v155, v162 op_sel:[0,0,0] op_sel_hi:[1,1,0]
v_fma_mix_f32 v162, v140, v140, v162 op_sel:[0,0,0] op_sel_hi:[1,1,0]
v_fma_mix_f32 v162, v155, v155, v162 op_sel:[1,1,0] op_sel_hi:[1,1,0]
v_smfmac_f32_16x16x32_bf16 v[28:31], v[238:239], v[208:211], v246
ds_read_b128 v[232:235], v249 offset:1024
v_fma_mix_f32 v162, v152, v152, v162 op_sel:[0,0,0] op_sel_hi:[1,1,0]
s_waitcnt lgkmcnt(4)
v_fma_mix_f32 v162, v141, v141, v162 op_sel:[1,1,0] op_sel_hi:[1,1,0]
v_fma_mix_f32 v162, v152, v152, v162 op_sel:[1,1,0] op_sel_hi:[1,1,0]
v_fma_mix_f32 v162, v149, v149, v162 op_sel:[0,0,0] op_sel_hi:[1,1,0]
v_smfmac_f32_16x16x32_bf16 v[12:15], v[236:237], v[212:215], v246
v_fma_mix_f32 v162, v142, v142, v162 op_sel:[0,0,0] op_sel_hi:[1,1,0]
v_fma_mix_f32 v162, v149, v149, v162 op_sel:[1,1,0] op_sel_hi:[1,1,0]
v_fma_mix_f32 v162, v146, v146, v162 op_sel:[0,0,0] op_sel_hi:[1,1,0]
v_fma_mix_f32 v162, v143, v143, v162 op_sel:[1,1,0] op_sel_hi:[1,1,0]
v_fma_mix_f32 v162, v146, v146, v162 op_sel:[1,1,0] op_sel_hi:[1,1,0]
v_lshlrev_b32_e64 v252, 7, v251
s_add_u32 s46, s47, 1572864
s_mov_b32 exec_lo, 0
s_mov_b32 exec_hi, 1048572
s_mov_b32 m0, 16152
s_nop 0
buffer_load_dword v252, s[4:7], s46 offen lds
s_mov_b64 exec, -1
s_setprio 2
v_smfmac_f32_16x16x32_bf16 v[36:39], v[218:219], v[192:195], v246
s_add_u32 s46, s80, 8388608
buffer_store_dwordx4 v[64:67], v241, s[32:35], s46 offen sc1
ds_read_b128 v[236:239], v249 offset:4096
v_cvt_pkrtz_f16_f32 v137, v120, v121
v_cvt_pkrtz_f16_f32 v139, v122, v123
v_cvt_pkrtz_f16_f32 v141, v124, v125
v_smfmac_f32_16x16x32_bf16 v[20:23], v[216:217], v[196:199], v246
v_cvt_pkrtz_f16_f32 v143, v126, v127
v_cvt_pkrtz_f16_f32 v145, v128, v129
v_cvt_pk_f16_f32 v155, v130, v131
v_cvt_pk_f16_f32 v152, v132, v133
v_cvt_pk_f16_f32 v149, v134, v135
v_mfma_f32_32x32x16_bf16 v[120:135], v[48:51], v[220:223], 0
ds_read_b128 v[216:219], v245 offset:2304
ds_read_b128 v[208:211], v243 offset:64
ds_read_b128 v[212:215], v243
v_pk_fma_f16 v154, v155, v155, s48
v_and_b32_e64 v137, s49, v137
v_pk_fma_f16 v151, v152, v152, s48
v_and_b32_e64 v139, s49, v139
v_pk_fma_f16 v148, v149, v149, s48
v_mfma_f32_32x32x16_bf16 v[120:135], v[52:55], v[224:227], v[120:135]
ds_read_b128 v[220:223], v249 offset:2048
v_pk_mul_f16 v154, v155, v154
v_bfe_u32 v136, v137, 2, 14
v_pk_mul_f16 v151, v152, v151
v_pk_mul_f16 v148, v149, v148
v_bfe_u32 v138, v139, 2, 14
v_exp_f16_e64 v153, v154
s_waitcnt lgkmcnt(4)
v_smfmac_f32_16x16x32_bf16 v[4:7], v[230:231], v[200:203], v246
ds_read_b128 v[224:227], v245 offset:1920
v_xor_b32 v242, 32, v242
ds_read_b128 v[192:195], v242 offset:128
ds_read_b128 v[196:199], v242 offset:64
ds_read_u16_d16 v136, v136
ds_read_u16_d16 v138, v138
v_lshrrev_b32 v137, 18, v137
v_exp_f16 v150, v151
v_smfmac_f32_16x16x32_bf16 v[36:39], v[228:229], v[204:207], v246
v_lshrrev_b32 v139, 18, v139
v_exp_f16 v147, v148
v_and_b32_e64 v141, s49, v141
v_mfma_f32_32x32x16_bf16 v[120:135], v[56:59], v[232:235], v[120:135]
ds_read_b128 v[228:231], v249 offset:5120
ds_read_u16_d16_hi v137, v137
ds_read_u16_d16_hi v139, v139
v_and_b32_e64 v143, s49, v143
v_exp_f16_sdwa v153, v154 dst_sel:WORD_1 dst_unused:UNUSED_PRESERVE src0_sel:WORD_1
v_bfe_u32 v140, v141, 2, 14
v_exp_f16_sdwa v150, v151 dst_sel:WORD_1 dst_unused:UNUSED_PRESERVE src0_sel:WORD_1
v_bfe_u32 v142, v143, 2, 14
v_mfma_f32_32x32x16_bf16 v[120:135], v[60:63], v[236:239], v[120:135]
ds_read_b128 v[232:235], v245 offset:1536
ds_read_b128 v[200:203], v242
v_xor_b32 v244, 16, v244
ds_read_b128 v[204:207], v244 offset:128
ds_read_u16_d16 v140, v140
ds_read_u16_d16 v142, v142
v_exp_f16_sdwa v147, v148 dst_sel:WORD_1 dst_unused:UNUSED_PRESERVE src0_sel:WORD_1
v_lshrrev_b32 v141, 18, v141
v_pk_add_f16 v153, v153, 1.0 op_sel_hi:[1,0]
v_lshrrev_b32 v143, 18, v143
v_pk_add_f16 v150, v150, 1.0 op_sel_hi:[1,0]
s_waitcnt lgkmcnt(8)
v_smfmac_f32_16x16x32_bf16 v[20:23], v[218:219], v[208:211], v246
ds_read_b128 v[236:239], v245 offset:1152
ds_read_u16_d16_hi v141, v141
ds_read_u16_d16_hi v143, v143
v_pk_add_f16 v147, v147, 1.0 op_sel_hi:[1,0]
v_and_b32 v145, s49, v145
v_rcp_f16 v154, v153
v_smfmac_f32_16x16x32_bf16 v[4:7], v[216:217], v[212:215], v246
v_bfe_u32 v144, v145, 2, 14
v_rcp_f16_e64 v151, v150
v_mfma_f32_32x32x16_bf16 v[120:135], v[64:67], v[220:223], v[120:135]
ds_read_b128 v[208:211], v244 offset:64
ds_read_b128 v[212:215], v244
ds_read_b128 v[216:219], v249 offset:6144
ds_read_u16_d16 v144, v144
v_lshrrev_b32_e64 v145, 18, v145
v_rcp_f16 v148, v147
v_rcp_f16_sdwa v154, v153 dst_sel:WORD_1 dst_unused:UNUSED_PRESERVE src0_sel:WORD_1
ds_read_u16_d16_hi v145, v145
v_fma_mix_f32 v163, v136, v136, 0 op_sel:[0,0,0] op_sel_hi:[1,1,0]
s_waitcnt lgkmcnt(8)
v_fma_mix_f32 v163, v137, v137, v163 op_sel:[1,1,0] op_sel_hi:[1,1,0]
v_smfmac_f32_16x16x32_bf16 v[36:39], v[226:227], v[192:195], v246
ds_read_b128 v[220:223], v249 offset:9216
v_rcp_f16_sdwa v151, v150 dst_sel:WORD_1 dst_unused:UNUSED_PRESERVE src0_sel:WORD_1
v_fma_mix_f32 v163, v138, v138, v163 op_sel:[0,0,0] op_sel_hi:[1,1,0]
v_smfmac_f32_16x16x32_bf16 v[20:23], v[224:225], v[196:199], v246
v_rcp_f16_sdwa v148, v147 dst_sel:WORD_1 dst_unused:UNUSED_PRESERVE src0_sel:WORD_1
v_fma_mix_f32 v163, v139, v139, v163 op_sel:[1,1,0] op_sel_hi:[1,1,0]
v_pk_mul_f16 v155, v155, v154
v_mfma_f32_32x32x16_bf16 v[120:135], v[68:71], v[228:231], v[120:135]
ds_read_b128 v[224:227], v249 offset:7168
v_fma_mix_f32 v163, v140, v140, v163 op_sel:[0,0,0] op_sel_hi:[1,1,0]
v_pk_mul_f16 v152, v152, v151
s_waitcnt lgkmcnt(7)
v_fma_mix_f32 v163, v141, v141, v163 op_sel:[1,1,0] op_sel_hi:[1,1,0]
v_pk_mul_f16 v149, v149, v148
v_fma_mix_f32 v163, v155, v155, v163 op_sel:[0,0,0] op_sel_hi:[1,1,0]
v_fma_mix_f32 v163, v142, v142, v163 op_sel:[0,0,0] op_sel_hi:[1,1,0]
v_fma_mix_f32 v163, v155, v155, v163 op_sel:[1,1,0] op_sel_hi:[1,1,0]
v_smfmac_f32_16x16x32_bf16 v[4:7], v[234:235], v[200:203], v246
ds_read_b128 v[228:231], v245 offset:768
v_xor_b32 v243, 16, v243
ds_read_b128 v[192:195], v243 offset:128
ds_read_b128 v[196:199], v243 offset:64
v_fma_mix_f32 v163, v143, v143, v163 op_sel:[1,1,0] op_sel_hi:[1,1,0]
v_fma_mix_f32 v163, v152, v152, v163 op_sel:[0,0,0] op_sel_hi:[1,1,0]
v_fma_mix_f32 v163, v152, v152, v163 op_sel:[1,1,0] op_sel_hi:[1,1,0]
v_smfmac_f32_16x16x32_bf16 v[32:35], v[232:233], v[204:207], v246
s_waitcnt lgkmcnt(4)
v_fma_mix_f32 v163, v144, v144, v163 op_sel:[0,0,0] op_sel_hi:[1,1,0]
v_fma_mix_f32 v163, v149, v149, v163 op_sel:[0,0,0] op_sel_hi:[1,1,0]
v_fma_mix_f32 v163, v145, v145, v163 op_sel:[1,1,0] op_sel_hi:[1,1,0]
v_fma_mix_f32 v163, v149, v149, v163 op_sel:[1,1,0] op_sel_hi:[1,1,0]
s_setprio 1
v_smfmac_f32_16x16x32_bf16 v[16:19], v[238:239], v[208:211], v246
s_add_u32 s46, s80, 10485760
buffer_store_dwordx4 v[68:71], v241, s[32:35], s46 offen sc1
ds_read_b128 v[232:235], v249 offset:10240
v_cvt_pkrtz_f16_f32 v137, v120, v121
v_cvt_pkrtz_f16_f32 v139, v122, v123
v_cvt_pkrtz_f16_f32 v141, v124, v125
v_smfmac_f32_16x16x32_bf16 v[0:3], v[236:237], v[212:215], v246
v_cvt_pkrtz_f16_f32 v143, v126, v127
v_cvt_pk_f16_f32 v155, v128, v129
v_cvt_pk_f16_f32 v152, v130, v131
v_cvt_pk_f16_f32 v149, v132, v133
v_cvt_pk_f16_f32 v146, v134, v135
v_mfma_f32_32x32x16_bf16 v[120:135], v[48:51], v[216:219], 0
ds_read_b128 v[236:239], v249 offset:8192
v_pk_fma_f16 v154, v155, v155, s48
v_and_b32_e64 v137, s49, v137
v_pk_fma_f16 v151, v152, v152, s48
v_pk_fma_f16 v148, v149, v149, s48
v_and_b32 v139, s49, v139
v_pk_fma_f16 v145, v146, v146, s48
v_pk_mul_f16 v154, v155, v154
v_mfma_f32_32x32x16_bf16 v[120:135], v[52:55], v[220:223], v[120:135]
ds_read_b128 v[216:219], v245 offset:384
ds_read_b128 v[200:203], v243
v_xor_b32 v242, 16, v242
ds_read_b128 v[204:207], v242 offset:128
v_bfe_u32 v136, v137, 2, 14
v_pk_mul_f16 v151, v152, v151
v_pk_mul_f16 v148, v149, v148
v_bfe_u32 v138, v139, 2, 14
v_pk_mul_f16 v145, v146, v145
v_exp_f16 v153, v154
s_waitcnt lgkmcnt(4)
v_mfma_f32_32x32x16_bf16 v[120:135], v[56:59], v[224:227], v[120:135]
ds_read_b128 v[220:223], v249 offset:11264
ds_read_u16_d16 v136, v136
ds_read_u16_d16 v138, v138
v_lshrrev_b32 v137, 18, v137
v_exp_f16 v150, v151
v_lshrrev_b32 v139, 18, v139
v_exp_f16 v147, v148
v_and_b32_e64 v141, s49, v141
v_smfmac_f32_16x16x32_bf16 v[32:35], v[230:231], v[192:195], v246
ds_read_b128 v[224:227], v245
ds_read_b128 v[208:211], v242 offset:64
ds_read_b128 v[212:215], v242
ds_read_u16_d16_hi v137, v137
ds_read_u16_d16_hi v139, v139
v_exp_f16 v144, v145
v_and_b32 v143, s49, v143
v_exp_f16_sdwa v153, v154 dst_sel:WORD_1 dst_unused:UNUSED_PRESERVE src0_sel:WORD_1
v_smfmac_f32_16x16x32_bf16 v[16:19], v[228:229], v[196:199], v246
v_bfe_u32 v140, v141, 2, 14
v_exp_f16_sdwa v150, v151 dst_sel:WORD_1 dst_unused:UNUSED_PRESERVE src0_sel:WORD_1
v_mfma_f32_32x32x16_bf16 v[120:135], v[60:63], v[232:235], v[120:135]
ds_read_b128 v[228:231], v249 offset:12288
ds_read_u16_d16 v140, v140
v_bfe_u32 v142, v143, 2, 14
v_exp_f16_sdwa v147, v148 dst_sel:WORD_1 dst_unused:UNUSED_PRESERVE src0_sel:WORD_1
v_lshrrev_b32_e64 v141, 18, v141
v_exp_f16_sdwa v144, v145 dst_sel:WORD_1 dst_unused:UNUSED_PRESERVE src0_sel:WORD_1
v_lshrrev_b32 v143, 18, v143
v_pk_add_f16 v153, v153, 1.0 op_sel_hi:[1,0]
s_waitcnt lgkmcnt(7)
v_mfma_f32_32x32x16_bf16 v[120:135], v[64:67], v[236:239], v[120:135]
ds_read_b128 v[232:235], v249 offset:15360
ds_read_u16_d16 v142, v142
ds_read_u16_d16_hi v141, v141
ds_read_u16_d16_hi v143, v143
v_pk_add_f16 v150, v150, 1.0 op_sel_hi:[1,0]
v_pk_add_f16 v147, v147, 1.0 op_sel_hi:[1,0]
v_pk_add_f16 v144, v144, 1.0 op_sel_hi:[1,0]
v_rcp_f16 v154, v153
v_rcp_f16 v151, v150
v_smfmac_f32_16x16x32_bf16 v[0:3], v[218:219], v[200:203], v246
ds_read_b128 v[236:239], v249 offset:13312
v_rcp_f16 v148, v147
v_rcp_f16 v145, v144
v_smfmac_f32_16x16x32_bf16 v[32:35], v[216:217], v[204:207], v246
v_rcp_f16_sdwa v154, v153 dst_sel:WORD_1 dst_unused:UNUSED_PRESERVE src0_sel:WORD_1
v_rcp_f16_sdwa v151, v150 dst_sel:WORD_1 dst_unused:UNUSED_PRESERVE src0_sel:WORD_1
s_setprio 0
v_mfma_f32_32x32x16_bf16 v[120:135], v[68:71], v[220:223], v[120:135]
ds_read_b128 v[216:219], v249 offset:16384
v_rcp_f16_sdwa v148, v147 dst_sel:WORD_1 dst_unused:UNUSED_PRESERVE src0_sel:WORD_1
v_fma_mix_f32 v164, v136, v136, 0 op_sel:[0,0,0] op_sel_hi:[1,1,0]
v_rcp_f16_sdwa v145, v144 dst_sel:WORD_1 dst_unused:UNUSED_PRESERVE src0_sel:WORD_1
s_waitcnt lgkmcnt(6)
v_fma_mix_f32 v164, v137, v137, v164 op_sel:[1,1,0] op_sel_hi:[1,1,0]
v_pk_mul_f16 v155, v155, v154
v_fma_mix_f32 v164, v138, v138, v164 op_sel:[0,0,0] op_sel_hi:[1,1,0]
v_smfmac_f32_16x16x32_bf16 v[16:19], v[226:227], v[208:211], v246
ds_read_b128 v[220:223], v249 offset:14336
v_pk_mul_f16 v152, v152, v151
v_pk_mul_f16 v149, v149, v148
v_fma_mix_f32 v164, v139, v139, v164 op_sel:[1,1,0] op_sel_hi:[1,1,0]
v_pk_mul_f16 v146, v146, v145
v_smfmac_f32_16x16x32_bf16 v[0:3], v[224:225], v[212:215], v246
s_mov_b64 exec, 1
ds_add_u32 v253, v254 offset:16
s_mov_b64 exec, -1
v_fma_mix_f32 v164, v155, v155, v164 op_sel:[0,0,0] op_sel_hi:[1,1,0]
v_fma_mix_f32 v164, v140, v140, v164 op_sel:[0,0,0] op_sel_hi:[1,1,0]
v_fma_mix_f32 v164, v155, v155, v164 op_sel:[1,1,0] op_sel_hi:[1,1,0]
v_fma_mix_f32 v164, v152, v152, v164 op_sel:[0,0,0] op_sel_hi:[1,1,0]
s_waitcnt lgkmcnt(3)
v_fma_mix_f32 v164, v141, v141, v164 op_sel:[1,1,0] op_sel_hi:[1,1,0]
v_fma_mix_f32 v164, v152, v152, v164 op_sel:[1,1,0] op_sel_hi:[1,1,0]
v_fma_mix_f32 v164, v149, v149, v164 op_sel:[0,0,0] op_sel_hi:[1,1,0]
v_fma_mix_f32 v164, v142, v142, v164 op_sel:[0,0,0] op_sel_hi:[1,1,0]
v_fma_mix_f32 v164, v149, v149, v164 op_sel:[1,1,0] op_sel_hi:[1,1,0]
v_fma_mix_f32 v164, v146, v146, v164 op_sel:[0,0,0] op_sel_hi:[1,1,0]
v_fma_mix_f32 v164, v143, v143, v164 op_sel:[1,1,0] op_sel_hi:[1,1,0]
v_fma_mix_f32 v164, v146, v146, v164 op_sel:[1,1,0] op_sel_hi:[1,1,0]
s_setprio 3
v_pk_add_f32 v[168:169], v[0:1], v[2:3]
v_pk_mul_f32 v[170:171], v[0:1], v[0:1]
v_pk_fma_f32 v[170:171], v[2:3], v[2:3], v[170:171]
v_pk_add_f32 v[168:169], v[168:169], v[4:5]
v_pk_fma_f32 v[170:171], v[4:5], v[4:5], v[170:171]
v_pk_add_f32 v[168:169], v[168:169], v[6:7]
v_pk_fma_f32 v[170:171], v[6:7], v[6:7], v[170:171]
v_pk_add_f32 v[168:169], v[168:169], v[8:9]
v_pk_fma_f32 v[170:171], v[8:9], v[8:9], v[170:171]
v_pk_add_f32 v[168:169], v[168:169], v[10:11]
v_pk_fma_f32 v[170:171], v[10:11], v[10:11], v[170:171]
v_pk_add_f32 v[168:169], v[168:169], v[12:13]
v_pk_fma_f32 v[170:171], v[12:13], v[12:13], v[170:171]
v_pk_add_f32 v[168:169], v[168:169], v[14:15]
v_pk_fma_f32 v[170:171], v[14:15], v[14:15], v[170:171]
v_pk_add_f32 v[168:169], v[168:169], v[16:17]
v_pk_fma_f32 v[170:171], v[16:17], v[16:17], v[170:171]
v_pk_add_f32 v[168:169], v[168:169], v[18:19]
v_pk_fma_f32 v[170:171], v[18:19], v[18:19], v[170:171]
v_pk_add_f32 v[168:169], v[168:169], v[20:21]
v_pk_fma_f32 v[170:171], v[20:21], v[20:21], v[170:171]
v_pk_add_f32 v[168:169], v[168:169], v[22:23]
v_pk_fma_f32 v[170:171], v[22:23], v[22:23], v[170:171]
v_pk_add_f32 v[168:169], v[168:169], v[24:25]
v_pk_fma_f32 v[170:171], v[24:25], v[24:25], v[170:171]
v_pk_add_f32 v[168:169], v[168:169], v[26:27]
v_pk_fma_f32 v[170:171], v[26:27], v[26:27], v[170:171]
v_pk_add_f32 v[168:169], v[168:169], v[28:29]
v_pk_fma_f32 v[170:171], v[28:29], v[28:29], v[170:171]
v_pk_add_f32 v[168:169], v[168:169], v[30:31]
v_pk_fma_f32 v[170:171], v[30:31], v[30:31], v[170:171]
v_pk_add_f32 v[168:169], v[168:169], v[32:33]
v_pk_fma_f32 v[170:171], v[32:33], v[32:33], v[170:171]
v_pk_add_f32 v[168:169], v[168:169], v[34:35]
v_pk_fma_f32 v[170:171], v[34:35], v[34:35], v[170:171]
v_pk_add_f32 v[168:169], v[168:169], v[36:37]
v_pk_fma_f32 v[170:171], v[36:37], v[36:37], v[170:171]
v_pk_add_f32 v[168:169], v[168:169], v[38:39]
v_pk_fma_f32 v[170:171], v[38:39], v[38:39], v[170:171]
v_pk_add_f32 v[168:169], v[168:169], v[40:41]
v_pk_fma_f32 v[170:171], v[40:41], v[40:41], v[170:171]
v_pk_add_f32 v[168:169], v[168:169], v[42:43]
v_pk_fma_f32 v[170:171], v[42:43], v[42:43], v[170:171]
v_pk_add_f32 v[168:169], v[168:169], v[44:45]
v_pk_fma_f32 v[170:171], v[44:45], v[44:45], v[170:171]
v_pk_add_f32 v[168:169], v[168:169], v[46:47]
v_pk_fma_f32 v[170:171], v[46:47], v[46:47], v[170:171]
s_setprio 0
v_add_u32 v174, -36864, v242
v_subrev_u32 v175, 66560, v174
v_min_u32 v174, v174, v175
v_add_u32 v174, 90112, v174
v_sub_u32 v175, v174, v242
v_add_u32 v242, v175, v242
v_add_u32_e64 v243, v175, v243
v_add_u32 v244, v175, v244
s_setprio 2
v_cvt_pkrtz_f16_f32 v137, v120, v121
v_cvt_pkrtz_f16_f32 v139, v122, v123
v_cvt_pkrtz_f16_f32 v141, v124, v125
v_cvt_pkrtz_f16_f32 v143, v126, v127
v_cvt_pkrtz_f16_f32 v145, v128, v129
v_cvt_pk_f16_f32 v155, v130, v131
v_cvt_pk_f16_f32 v152, v132, v133
v_cvt_pk_f16_f32 v149, v134, v135
ds_read_b128 v[224:227], v249 offset:17408
v_mfma_f32_32x32x16_bf16 v[120:135], v[48:51], v[228:231], 0
v_pk_fma_f16 v154, v155, v155, s48
v_add_f32 v168, v168, v169
v_and_b32 v137, s49, v137
v_pk_fma_f16 v151, v152, v152, s48
v_and_b32_e64 v139, s49, v139
v_pk_fma_f16 v148, v149, v149, s48
v_add_f32_e64 v170, v170, v171
v_pk_mul_f16 v154, v155, v154
v_bfe_u32 v136, v137, 2, 14
v_pk_mul_f16 v151, v152, v151
v_pk_mul_f16 v148, v149, v148
v_bfe_u32 v138, v139, 2, 14
ds_read_b128 v[228:231], v249 offset:18432
ds_read_u16_d16 v136, v136
ds_read_u16_d16 v138, v138
v_mfma_f32_32x32x16_bf16 v[120:135], v[52:55], v[232:235], v[120:135]
v_permlane32_swap_b32 v168, v170
v_exp_f16 v153, v154
v_lshrrev_b32 v137, 18, v137
v_exp_f16 v150, v151
v_add_f32 v168, v168, v170
v_lshrrev_b32 v139, 18, v139
v_exp_f16 v147, v148
v_and_b32 v141, s49, v141
v_and_b32_e64 v143, s49, v143
v_mul_f32 v168, 1009429163, v168
ds_read_b128 v[232:235], v249 offset:21504
ds_read_u16_d16_hi v137, v137
ds_read_u16_d16_hi v139, v139
v_mfma_f32_32x32x16_bf16 v[120:135], v[56:59], v[236:239], v[120:135]
v_exp_f16_sdwa v153, v154 dst_sel:WORD_1 dst_unused:UNUSED_PRESERVE src0_sel:WORD_1
v_bfe_u32 v140, v141, 2, 14
v_exp_f16_sdwa v150, v151 dst_sel:WORD_1 dst_unused:UNUSED_PRESERVE src0_sel:WORD_1
v_mov_b32_e64 v170, v168
v_bfe_u32 v142, v143, 2, 14
v_exp_f16_sdwa v147, v148 dst_sel:WORD_1 dst_unused:UNUSED_PRESERVE src0_sel:WORD_1
v_lshrrev_b32_e64 v141, 18, v141
v_permlane32_swap_b32 v168, v170
v_pk_add_f16 v153, v153, 1.0 op_sel_hi:[1,0]
s_waitcnt lgkmcnt(8)
ds_read_b128 v[236:239], v249 offset:19456
ds_read_u16_d16 v140, v140
ds_read_u16_d16 v142, v142
ds_read_u16_d16_hi v141, v141
v_mfma_f32_32x32x16_bf16 v[120:135], v[60:63], v[216:219], v[120:135]
v_lshrrev_b32_e64 v143, 18, v143
v_pk_add_f16 v150, v150, 1.0 op_sel_hi:[1,0]
v_pk_add_f16 v147, v147, 1.0 op_sel_hi:[1,0]
v_and_b32_e64 v145, s49, v145
v_fma_f32 v170, -v168, v168, v170
v_rcp_f16_e64 v154, v153
v_bfe_u32 v144, v145, 2, 14
v_rcp_f16 v151, v150
v_max_f32 v170, 0, v170
v_lshrrev_b32_e64 v145, 18, v145
ds_read_b128 v[216:219], v249 offset:22528
ds_read_u16_d16_hi v143, v143
ds_read_u16_d16 v144, v144
ds_read_u16_d16_hi v145, v145
v_mfma_f32_32x32x16_bf16 v[120:135], v[64:67], v[220:223], v[120:135]
v_rcp_f16 v148, v147
v_rcp_f16_sdwa v154, v153 dst_sel:WORD_1 dst_unused:UNUSED_PRESERVE src0_sel:WORD_1
v_add_f32 v170, 925353388, v170
s_waitcnt lgkmcnt(8)
v_fma_mix_f32 v165, v136, v136, 0 op_sel:[0,0,0] op_sel_hi:[1,1,0]
ds_read_b32 v247, v253 offset:16
v_fma_mix_f32 v165, v137, v137, v165 op_sel:[1,1,0] op_sel_hi:[1,1,0]
v_rcp_f16_sdwa v151, v150 dst_sel:WORD_1 dst_unused:UNUSED_PRESERVE src0_sel:WORD_1
v_rsq_f32_e64 v170, v170
v_fma_mix_f32 v165, v138, v138, v165 op_sel:[0,0,0] op_sel_hi:[1,1,0]
ds_read_b128 v[220:223], v249 offset:20480
v_mfma_f32_32x32x16_bf16 v[120:135], v[68:71], v[224:227], v[120:135]
v_rcp_f16_sdwa v148, v147 dst_sel:WORD_1 dst_unused:UNUSED_PRESERVE src0_sel:WORD_1
v_fma_mix_f32 v165, v139, v139, v165 op_sel:[1,1,0] op_sel_hi:[1,1,0]
v_pk_mul_f16 v155, v155, v154
s_waitcnt lgkmcnt(6)
v_fma_mix_f32 v165, v140, v140, v165 op_sel:[0,0,0] op_sel_hi:[1,1,0]
v_pk_mul_f16 v152, v152, v151
v_fma_mix_f32 v165, v141, v141, v165 op_sel:[1,1,0] op_sel_hi:[1,1,0]
v_pk_mul_f16 v149, v149, v148
v_fma_mix_f32 v165, v155, v155, v165 op_sel:[0,0,0] op_sel_hi:[1,1,0]
v_mul_f32 v172, 3203391086, v170
v_fma_mix_f32 v165, v142, v142, v165 op_sel:[0,0,0] op_sel_hi:[1,1,0]
v_fma_mix_f32 v165, v155, v155, v165 op_sel:[1,1,0] op_sel_hi:[1,1,0]
s_waitcnt lgkmcnt(2)
v_fma_mix_f32 v165, v143, v143, v165 op_sel:[1,1,0] op_sel_hi:[1,1,0]
v_fma_mix_f32 v165, v152, v152, v165 op_sel:[0,0,0] op_sel_hi:[1,1,0]
v_fma_mix_f32 v165, v152, v152, v165 op_sel:[1,1,0] op_sel_hi:[1,1,0]
v_mul_f32 v173, v168, v172
v_fma_mix_f32 v165, v144, v144, v165 op_sel:[0,0,0] op_sel_hi:[1,1,0]
v_fma_mix_f32 v165, v149, v149, v165 op_sel:[0,0,0] op_sel_hi:[1,1,0]
v_fma_mix_f32 v165, v145, v145, v165 op_sel:[1,1,0] op_sel_hi:[1,1,0]
v_fma_mix_f32 v165, v149, v149, v165 op_sel:[1,1,0] op_sel_hi:[1,1,0]
s_setprio 3
v_pk_fma_f32 v[0:1], v[0:1], v[172:173], v[172:173] op_sel:[0,0,1] op_sel_hi:[1,0,1] neg_lo:[0,0,1] neg_hi:[0,0,1]
v_pk_fma_f32 v[2:3], v[2:3], v[172:173], v[172:173] op_sel:[0,0,1] op_sel_hi:[1,0,1] neg_lo:[0,0,1] neg_hi:[0,0,1]
v_pk_fma_f32 v[4:5], v[4:5], v[172:173], v[172:173] op_sel:[0,0,1] op_sel_hi:[1,0,1] neg_lo:[0,0,1] neg_hi:[0,0,1]
v_pk_fma_f32 v[6:7], v[6:7], v[172:173], v[172:173] op_sel:[0,0,1] op_sel_hi:[1,0,1] neg_lo:[0,0,1] neg_hi:[0,0,1]
v_pk_fma_f32 v[8:9], v[8:9], v[172:173], v[172:173] op_sel:[0,0,1] op_sel_hi:[1,0,1] neg_lo:[0,0,1] neg_hi:[0,0,1]
v_pk_fma_f32 v[10:11], v[10:11], v[172:173], v[172:173] op_sel:[0,0,1] op_sel_hi:[1,0,1] neg_lo:[0,0,1] neg_hi:[0,0,1]
v_pk_fma_f32 v[12:13], v[12:13], v[172:173], v[172:173] op_sel:[0,0,1] op_sel_hi:[1,0,1] neg_lo:[0,0,1] neg_hi:[0,0,1]
v_pk_fma_f32 v[14:15], v[14:15], v[172:173], v[172:173] op_sel:[0,0,1] op_sel_hi:[1,0,1] neg_lo:[0,0,1] neg_hi:[0,0,1]
v_pk_fma_f32 v[16:17], v[16:17], v[172:173], v[172:173] op_sel:[0,0,1] op_sel_hi:[1,0,1] neg_lo:[0,0,1] neg_hi:[0,0,1]
v_pk_fma_f32 v[18:19], v[18:19], v[172:173], v[172:173] op_sel:[0,0,1] op_sel_hi:[1,0,1] neg_lo:[0,0,1] neg_hi:[0,0,1]
v_pk_fma_f32 v[20:21], v[20:21], v[172:173], v[172:173] op_sel:[0,0,1] op_sel_hi:[1,0,1] neg_lo:[0,0,1] neg_hi:[0,0,1]
v_pk_fma_f32 v[22:23], v[22:23], v[172:173], v[172:173] op_sel:[0,0,1] op_sel_hi:[1,0,1] neg_lo:[0,0,1] neg_hi:[0,0,1]
v_pk_fma_f32 v[24:25], v[24:25], v[172:173], v[172:173] op_sel:[0,0,1] op_sel_hi:[1,0,1] neg_lo:[0,0,1] neg_hi:[0,0,1]
v_pk_fma_f32 v[26:27], v[26:27], v[172:173], v[172:173] op_sel:[0,0,1] op_sel_hi:[1,0,1] neg_lo:[0,0,1] neg_hi:[0,0,1]
v_pk_fma_f32 v[28:29], v[28:29], v[172:173], v[172:173] op_sel:[0,0,1] op_sel_hi:[1,0,1] neg_lo:[0,0,1] neg_hi:[0,0,1]
v_pk_fma_f32 v[30:31], v[30:31], v[172:173], v[172:173] op_sel:[0,0,1] op_sel_hi:[1,0,1] neg_lo:[0,0,1] neg_hi:[0,0,1]
v_pk_fma_f32 v[32:33], v[32:33], v[172:173], v[172:173] op_sel:[0,0,1] op_sel_hi:[1,0,1] neg_lo:[0,0,1] neg_hi:[0,0,1]
v_pk_fma_f32 v[34:35], v[34:35], v[172:173], v[172:173] op_sel:[0,0,1] op_sel_hi:[1,0,1] neg_lo:[0,0,1] neg_hi:[0,0,1]
v_pk_fma_f32 v[36:37], v[36:37], v[172:173], v[172:173] op_sel:[0,0,1] op_sel_hi:[1,0,1] neg_lo:[0,0,1] neg_hi:[0,0,1]
v_pk_fma_f32 v[38:39], v[38:39], v[172:173], v[172:173] op_sel:[0,0,1] op_sel_hi:[1,0,1] neg_lo:[0,0,1] neg_hi:[0,0,1]
v_pk_fma_f32 v[40:41], v[40:41], v[172:173], v[172:173] op_sel:[0,0,1] op_sel_hi:[1,0,1] neg_lo:[0,0,1] neg_hi:[0,0,1]
v_pk_fma_f32 v[42:43], v[42:43], v[172:173], v[172:173] op_sel:[0,0,1] op_sel_hi:[1,0,1] neg_lo:[0,0,1] neg_hi:[0,0,1]
v_pk_fma_f32 v[44:45], v[44:45], v[172:173], v[172:173] op_sel:[0,0,1] op_sel_hi:[1,0,1] neg_lo:[0,0,1] neg_hi:[0,0,1]
v_pk_fma_f32 v[46:47], v[46:47], v[172:173], v[172:173] op_sel:[0,0,1] op_sel_hi:[1,0,1] neg_lo:[0,0,1] neg_hi:[0,0,1]
s_setprio 2
s_waitcnt lgkmcnt(0)
v_readfirstlane_b32 s43, v247
s_nop 1
s_cmp_ge_u32 s43, 16
s_cbranch_scc1 Lev4
Lev4w:
s_sleep 1
ds_read_b32 v247, v253 offset:16
s_waitcnt lgkmcnt(0)
v_readfirstlane_b32 s43, v247
s_cmp_eq_u32 s76, 0
s_cbranch_scc1 Lev4
s_sub_u32 s76, s76, 1
s_cmp_lt_u32 s43, 16
s_cbranch_scc1 Lev4w
Lev4:
s_setprio 1
v_cvt_pkrtz_f16_f32 v137, v120, v121
v_cvt_pkrtz_f16_f32 v139, v122, v123
v_cvt_pkrtz_f16_f32 v141, v124, v125
v_cvt_pkrtz_f16_f32 v143, v126, v127
v_cvt_pkrtz_f16_f32 v145, v128, v129
v_cvt_pk_f16_f32 v155, v130, v131
v_cvt_pk_f16_f32 v152, v132, v133
v_cvt_pk_f16_f32 v149, v134, v135
s_add_u32 m0, s67, 53248
s_add_u32 s66, s66, 98304
buffer_load_dwordx4 v240, s[4:7], s66 offen lds
ds_read_b128 v[224:227], v249 offset:23552
v_mfma_f32_32x32x16_bf16 v[120:135], v[48:51], v[228:231], 0
v_pk_fma_f16 v154, v155, v155, s48
v_cvt_pk_bf16_f32 v72, v0, v1
v_and_b32 v137, s49, v137
v_pk_fma_f16 v151, v152, v152, s48
v_cvt_pk_bf16_f32 v73, v2, v3
v_and_b32_e64 v139, s49, v139
v_pk_fma_f16 v148, v149, v149, s48
v_pk_mul_f16 v154, v155, v154
v_cvt_pk_bf16_f32 v74, v4, v5
v_bfe_u32 v136, v137, 2, 14
v_pk_mul_f16 v151, v152, v151
v_pk_mul_f16 v148, v149, v148
v_cvt_pk_bf16_f32 v75, v6, v7
v_bfe_u32 v138, v139, 2, 14
s_add_u32 m0, s67, 59904
s_add_u32 s66, s66, 98304
buffer_load_dwordx4 v240, s[4:7], s66 offen lds
ds_read_b128 v[228:231], v248 offset:16384
ds_read_u16_d16 v136, v136
ds_read_u16_d16 v138, v138
v_mfma_f32_32x32x16_bf16 v[120:135], v[52:55], v[232:235], v[120:135]
v_exp_f16_e64 v153, v154
v_cvt_pk_bf16_f32 v76, v8, v9
v_lshrrev_b32 v137, 18, v137
v_exp_f16 v150, v151
v_cvt_pk_bf16_f32 v77, v10, v11
v_lshrrev_b32 v139, 18, v139
v_exp_f16 v147, v148
v_cvt_pk_bf16_f32 v78, v12, v13
v_and_b32_e64 v141, s49, v141
v_and_b32 v143, s49, v143
v_cvt_pk_bf16_f32 v79, v14, v15
s_add_u32 m0, s67, 0
s_add_u32 s66, s66, 98304
buffer_load_dwordx4 v240, s[4:7], s66 offen lds
ds_read_b128 v[232:235], v248 offset:19456
ds_read_u16_d16_hi v137, v137
ds_read_u16_d16_hi v139, v139
v_mfma_f32_32x32x16_bf16 v[120:135], v[56:59], v[236:239], v[120:135]
v_exp_f16_sdwa v153, v154 dst_sel:WORD_1 dst_unused:UNUSED_PRESERVE src0_sel:WORD_1
v_bfe_u32 v140, v141, 2, 14
v_cvt_pk_bf16_f32 v80, v16, v17
v_exp_f16_sdwa v150, v151 dst_sel:WORD_1 dst_unused:UNUSED_PRESERVE src0_sel:WORD_1
v_bfe_u32 v142, v143, 2, 14
v_cvt_pk_bf16_f32 v81, v18, v19
v_exp_f16_sdwa v147, v148 dst_sel:WORD_1 dst_unused:UNUSED_PRESERVE src0_sel:WORD_1
v_cvt_pk_bf16_f32 v82, v20, v21
v_lshrrev_b32_e64 v141, 18, v141
v_pk_add_f16 v153, v153, 1.0 op_sel_hi:[1,0]
v_lshrrev_b32_e64 v143, 18, v143
s_add_u32 m0, s67, 6656
s_add_u32 s66, s66, 98304
buffer_load_dwordx4 v240, s[4:7], s66 offen lds
s_add_u32 m0, s67, 13312
s_add_u32 s66, s66, 98304
buffer_load_dwordx4 v240, s[4:7], s66 offen lds
ds_read_b128 v[236:239], v248 offset:17408
ds_read_u16_d16 v140, v140
ds_read_u16_d16 v142, v142
ds_read_u16_d16_hi v141, v141
ds_read_u16_d16_hi v143, v143
v_mfma_f32_32x32x16_bf16 v[120:135], v[60:63], v[216:219], v[120:135]
v_cvt_pk_bf16_f32 v83, v22, v23
v_pk_add_f16 v150, v150, 1.0 op_sel_hi:[1,0]
v_pk_add_f16 v147, v147, 1.0 op_sel_hi:[1,0]
v_and_b32_e64 v145, s49, v145
v_cvt_pk_bf16_f32 v84, v24, v25
v_rcp_f16_e64 v154, v153
v_bfe_u32 v144, v145, 2, 14
v_cvt_pk_bf16_f32 v85, v26, v27
v_rcp_f16 v151, v150
v_lshrrev_b32 v145, 18, v145
v_cvt_pk_bf16_f32 v86, v28, v29
s_add_u32 m0, s67, 19968
s_add_u32 s66, s66, 98304
buffer_load_dwordx4 v240, s[4:7], s66 offen lds
ds_read_b128 v[216:219], v248 offset:20480
ds_read_u16_d16 v144, v144
ds_read_u16_d16_hi v145, v145
v_mfma_f32_32x32x16_bf16 v[120:135], v[64:67], v[220:223], v[120:135]
v_rcp_f16_e64 v148, v147
v_cvt_pk_bf16_f32 v87, v30, v31
v_rcp_f16_sdwa v154, v153 dst_sel:WORD_1 dst_unused:UNUSED_PRESERVE src0_sel:WORD_1
s_waitcnt lgkmcnt(5)
v_fma_mix_f32 v166, v136, v136, 0 op_sel:[0,0,0] op_sel_hi:[1,1,0]
v_cvt_pk_bf16_f32 v88, v32, v33
s_setprio 0
v_fma_mix_f32 v166, v137, v137, v166 op_sel:[1,1,0] op_sel_hi:[1,1,0]
v_rcp_f16_sdwa v151, v150 dst_sel:WORD_1 dst_unused:UNUSED_PRESERVE src0_sel:WORD_1
v_cvt_pk_bf16_f32 v89, v34, v35
v_fma_mix_f32 v166, v138, v138, v166 op_sel:[0,0,0] op_sel_hi:[1,1,0]
v_rcp_f16_sdwa v148, v147 dst_sel:WORD_1 dst_unused:UNUSED_PRESERVE src0_sel:WORD_1
v_cvt_pk_bf16_f32 v90, v36, v37
s_add_u32 m0, s67, 26624
s_add_u32 s66, s66, 98304
buffer_load_dwordx4 v240, s[4:7], s66 offen lds
ds_read_b128 v[220:223], v248 offset:18432
v_mfma_f32_32x32x16_bf16 v[120:135], v[68:71], v[224:227], v[120:135]
v_fma_mix_f32 v166, v139, v139, v166 op_sel:[1,1,0] op_sel_hi:[1,1,0]
v_pk_mul_f16 v155, v155, v154
v_fma_mix_f32 v166, v140, v140, v166 op_sel:[0,0,0] op_sel_hi:[1,1,0]
v_cvt_pk_bf16_f32 v91, v38, v39
v_pk_mul_f16 v152, v152, v151
s_waitcnt lgkmcnt(1)
v_fma_mix_f32 v166, v141, v141, v166 op_sel:[1,1,0] op_sel_hi:[1,1,0]
v_cvt_pk_bf16_f32 v92, v40, v41
v_pk_mul_f16 v149, v149, v148
v_fma_mix_f32 v166, v155, v155, v166 op_sel:[0,0,0] op_sel_hi:[1,1,0]
v_fma_mix_f32 v166, v142, v142, v166 op_sel:[0,0,0] op_sel_hi:[1,1,0]
v_cvt_pk_bf16_f32 v93, v42, v43
v_fma_mix_f32 v166, v155, v155, v166 op_sel:[1,1,0] op_sel_hi:[1,1,0]
v_fma_mix_f32 v166, v143, v143, v166 op_sel:[1,1,0] op_sel_hi:[1,1,0]
v_fma_mix_f32 v166, v152, v152, v166 op_sel:[0,0,0] op_sel_hi:[1,1,0]
s_add_u32 m0, s67, 33280
s_add_u32 s66, s66, 98304
buffer_load_dwordx4 v240, s[4:7], s66 offen lds
v_cvt_pk_bf16_f32 v94, v44, v45
v_fma_mix_f32 v166, v152, v152, v166 op_sel:[1,1,0] op_sel_hi:[1,1,0]
v_fma_mix_f32 v166, v144, v144, v166 op_sel:[0,0,0] op_sel_hi:[1,1,0]
v_fma_mix_f32 v166, v149, v149, v166 op_sel:[0,0,0] op_sel_hi:[1,1,0]
v_cvt_pk_bf16_f32 v95, v46, v47
v_fma_mix_f32 v166, v145, v145, v166 op_sel:[1,1,0] op_sel_hi:[1,1,0]
v_fma_mix_f32 v166, v149, v149, v166 op_sel:[1,1,0] op_sel_hi:[1,1,0]
s_setprio 2
v_cvt_pkrtz_f16_f32 v137, v120, v121
v_cvt_pkrtz_f16_f32 v139, v122, v123
v_cvt_pkrtz_f16_f32 v141, v124, v125
v_cvt_pkrtz_f16_f32 v143, v126, v127
v_cvt_pkrtz_f16_f32 v145, v128, v129
v_cvt_pk_f16_f32 v155, v130, v131
v_cvt_pk_f16_f32 v152, v132, v133
v_cvt_pk_f16_f32 v149, v134, v135
ds_read_b128 v[224:227], v248 offset:21504
v_mfma_f32_32x32x16_bf16 v[120:135], v[72:75], v[228:231], 0
v_pk_fma_f16 v154, v155, v155, s48
v_and_b32_e64 v137, s49, v137
v_pk_fma_f16 v151, v152, v152, s48
v_and_b32_e64 v139, s49, v139
v_pk_fma_f16 v148, v149, v149, s48
v_pk_mul_f16 v154, v155, v154
v_bfe_u32 v136, v137, 2, 14
v_pk_mul_f16 v151, v152, v151
v_pk_mul_f16 v148, v149, v148
v_bfe_u32 v138, v139, 2, 14
ds_read_b128 v[228:231], v248 offset:22528
ds_read_u16_d16 v136, v136
ds_read_u16_d16 v138, v138
v_mfma_f32_32x32x16_bf16 v[120:135], v[76:79], v[232:235], v[120:135]
v_exp_f16 v153, v154
v_lshrrev_b32 v137, 18, v137
v_exp_f16 v150, v151
v_lshrrev_b32 v139, 18, v139
v_exp_f16 v147, v148
v_and_b32 v141, s49, v141
v_and_b32_e64 v143, s49, v143
ds_read_b128 v[232:235], v248 offset:25600
ds_read_u16_d16_hi v137, v137
ds_read_u16_d16_hi v139, v139
v_mfma_f32_32x32x16_bf16 v[120:135], v[80:83], v[236:239], v[120:135]
v_exp_f16_sdwa v153, v154 dst_sel:WORD_1 dst_unused:UNUSED_PRESERVE src0_sel:WORD_1
v_bfe_u32 v140, v141, 2, 14
v_exp_f16_sdwa v150, v151 dst_sel:WORD_1 dst_unused:UNUSED_PRESERVE src0_sel:WORD_1
v_bfe_u32 v142, v143, 2, 14
v_exp_f16_sdwa v147, v148 dst_sel:WORD_1 dst_unused:UNUSED_PRESERVE src0_sel:WORD_1
v_lshrrev_b32_e64 v141, 18, v141
v_pk_add_f16 v153, v153, 1.0 op_sel_hi:[1,0]
ds_read_b128 v[236:239], v248 offset:23552
ds_read_u16_d16 v140, v140
ds_read_u16_d16 v142, v142
ds_read_u16_d16_hi v141, v141
v_mfma_f32_32x32x16_bf16 v[120:135], v[84:87], v[216:219], v[120:135]
v_lshrrev_b32_e64 v143, 18, v143
v_pk_add_f16 v150, v150, 1.0 op_sel_hi:[1,0]
v_pk_add_f16 v147, v147, 1.0 op_sel_hi:[1,0]
v_and_b32 v145, s49, v145
v_rcp_f16 v154, v153
v_bfe_u32 v144, v145, 2, 14
v_rcp_f16_e64 v151, v150
v_lshrrev_b32 v145, 18, v145
s_waitcnt lgkmcnt(7)
ds_read_b128 v[216:219], v248 offset:26624
ds_read_u16_d16_hi v143, v143
ds_read_u16_d16 v144, v144
ds_read_u16_d16_hi v145, v145
v_mfma_f32_32x32x16_bf16 v[120:135], v[88:91], v[220:223], v[120:135]
v_rcp_f16 v148, v147
v_rcp_f16_sdwa v154, v153 dst_sel:WORD_1 dst_unused:UNUSED_PRESERVE src0_sel:WORD_1
v_fma_mix_f32 v167, v136, v136, 0 op_sel:[0,0,0] op_sel_hi:[1,1,0]
s_waitcnt lgkmcnt(8)
v_fma_mix_f32 v167, v137, v137, v167 op_sel:[1,1,0] op_sel_hi:[1,1,0]
v_rcp_f16_sdwa v151, v150 dst_sel:WORD_1 dst_unused:UNUSED_PRESERVE src0_sel:WORD_1
v_fma_mix_f32 v167, v138, v138, v167 op_sel:[0,0,0] op_sel_hi:[1,1,0]
ds_read_b128 v[220:223], v248 offset:24576
v_mfma_f32_32x32x16_bf16 v[120:135], v[92:95], v[224:227], v[120:135]
v_rcp_f16_sdwa v148, v147 dst_sel:WORD_1 dst_unused:UNUSED_PRESERVE src0_sel:WORD_1
v_fma_mix_f32 v167, v139, v139, v167 op_sel:[1,1,0] op_sel_hi:[1,1,0]
v_pk_mul_f16 v155, v155, v154
s_waitcnt lgkmcnt(5)
v_fma_mix_f32 v167, v140, v140, v167 op_sel:[0,0,0] op_sel_hi:[1,1,0]
v_pk_mul_f16 v152, v152, v151
v_fma_mix_f32 v167, v141, v141, v167 op_sel:[1,1,0] op_sel_hi:[1,1,0]
v_pk_mul_f16 v149, v149, v148
v_fma_mix_f32 v167, v155, v155, v167 op_sel:[0,0,0] op_sel_hi:[1,1,0]
v_fma_mix_f32 v167, v142, v142, v167 op_sel:[0,0,0] op_sel_hi:[1,1,0]
v_fma_mix_f32 v167, v155, v155, v167 op_sel:[1,1,0] op_sel_hi:[1,1,0]
s_waitcnt lgkmcnt(3)
v_fma_mix_f32 v167, v143, v143, v167 op_sel:[1,1,0] op_sel_hi:[1,1,0]
v_fma_mix_f32 v167, v152, v152, v167 op_sel:[0,0,0] op_sel_hi:[1,1,0]
v_fma_mix_f32 v167, v152, v152, v167 op_sel:[1,1,0] op_sel_hi:[1,1,0]
s_waitcnt lgkmcnt(1)
v_fma_mix_f32 v167, v144, v144, v167 op_sel:[0,0,0] op_sel_hi:[1,1,0]
v_fma_mix_f32 v167, v149, v149, v167 op_sel:[0,0,0] op_sel_hi:[1,1,0]
v_fma_mix_f32 v167, v145, v145, v167 op_sel:[1,1,0] op_sel_hi:[1,1,0]
v_fma_mix_f32 v167, v149, v149, v167 op_sel:[1,1,0] op_sel_hi:[1,1,0]
s_setprio 1
v_cvt_pkrtz_f16_f32 v137, v120, v121
v_cvt_pkrtz_f16_f32 v139, v122, v123
v_cvt_pkrtz_f16_f32 v141, v124, v125
v_cvt_pkrtz_f16_f32 v143, v126, v127
v_cvt_pkrtz_f16_f32 v145, v128, v129
v_cvt_pk_f16_f32 v155, v130, v131
v_cvt_pk_f16_f32 v152, v132, v133
v_cvt_pk_f16_f32 v149, v134, v135
ds_read_b128 v[224:227], v248 offset:27648
v_mfma_f32_32x32x16_bf16 v[120:135], v[72:75], v[228:231], 0
v_pk_fma_f16 v154, v155, v155, s48
v_and_b32_e64 v137, s49, v137
v_pk_fma_f16 v151, v152, v152, s48
v_and_b32_e64 v139, s49, v139
v_pk_fma_f16 v148, v149, v149, s48
v_pk_mul_f16 v154, v155, v154
v_bfe_u32 v136, v137, 2, 14
v_pk_mul_f16 v151, v152, v151
v_pk_mul_f16 v148, v149, v148
v_bfe_u32 v138, v139, 2, 14
ds_read_b128 v[228:231], v248 offset:28672
ds_read_u16_d16 v136, v136
ds_read_u16_d16 v138, v138
v_mfma_f32_32x32x16_bf16 v[120:135], v[76:79], v[232:235], v[120:135]
v_exp_f16 v153, v154
v_lshrrev_b32 v137, 18, v137
v_exp_f16 v150, v151
v_lshrrev_b32 v139, 18, v139
v_exp_f16 v147, v148
v_and_b32 v141, s49, v141
v_and_b32_e64 v143, s49, v143
ds_read_b128 v[232:235], v248 offset:31744
ds_read_u16_d16_hi v137, v137
ds_read_u16_d16_hi v139, v139
v_mfma_f32_32x32x16_bf16 v[120:135], v[80:83], v[236:239], v[120:135]
v_exp_f16_sdwa v153, v154 dst_sel:WORD_1 dst_unused:UNUSED_PRESERVE src0_sel:WORD_1
v_bfe_u32 v140, v141, 2, 14
v_exp_f16_sdwa v150, v151 dst_sel:WORD_1 dst_unused:UNUSED_PRESERVE src0_sel:WORD_1
v_bfe_u32 v142, v143, 2, 14
v_exp_f16_sdwa v147, v148 dst_sel:WORD_1 dst_unused:UNUSED_PRESERVE src0_sel:WORD_1
v_lshrrev_b32_e64 v141, 18, v141
v_pk_add_f16 v153, v153, 1.0 op_sel_hi:[1,0]
ds_read_b128 v[236:239], v248 offset:29696
ds_read_u16_d16 v140, v140
ds_read_u16_d16 v142, v142
ds_read_u16_d16_hi v141, v141
v_mfma_f32_32x32x16_bf16 v[120:135], v[84:87], v[216:219], v[120:135]
v_lshrrev_b32_e64 v143, 18, v143
v_pk_add_f16 v150, v150, 1.0 op_sel_hi:[1,0]
v_pk_add_f16 v147, v147, 1.0 op_sel_hi:[1,0]
v_and_b32 v145, s49, v145
v_rcp_f16 v154, v153
v_bfe_u32 v144, v145, 2, 14
v_rcp_f16_e64 v151, v150
v_lshrrev_b32 v145, 18, v145
s_waitcnt lgkmcnt(7)
ds_read_b128 v[216:219], v248 offset:32768
ds_read_u16_d16_hi v143, v143
ds_read_u16_d16 v144, v144
ds_read_u16_d16_hi v145, v145
v_mfma_f32_32x32x16_bf16 v[120:135], v[88:91], v[220:223], v[120:135]
v_rcp_f16_e64 v148, v147
v_rcp_f16_sdwa v154, v153 dst_sel:WORD_1 dst_unused:UNUSED_PRESERVE src0_sel:WORD_1
v_fma_mix_f32 v156, v136, v136, v156 op_sel:[0,0,0] op_sel_hi:[1,1,0]
s_setprio 0
s_waitcnt lgkmcnt(8)
v_fma_mix_f32 v156, v137, v137, v156 op_sel:[1,1,0] op_sel_hi:[1,1,0]
v_rcp_f16_sdwa v151, v150 dst_sel:WORD_1 dst_unused:UNUSED_PRESERVE src0_sel:WORD_1
v_fma_mix_f32 v156, v138, v138, v156 op_sel:[0,0,0] op_sel_hi:[1,1,0]
ds_read_b128 v[220:223], v248 offset:30720
v_mfma_f32_32x32x16_bf16 v[120:135], v[92:95], v[224:227], v[120:135]
v_rcp_f16_sdwa v148, v147 dst_sel:WORD_1 dst_unused:UNUSED_PRESERVE src0_sel:WORD_1
v_fma_mix_f32 v156, v139, v139, v156 op_sel:[1,1,0] op_sel_hi:[1,1,0]
v_pk_mul_f16 v155, v155, v154
s_cmp_eq_u32 s40, 7
s_cbranch_scc1 Lrdy16
s_waitcnt vmcnt(0)
Lrdy16:
s_mov_b64 exec, 1
ds_add_u32 v253, v254 offset:12
s_mov_b64 exec, -1
s_waitcnt lgkmcnt(6)
v_fma_mix_f32 v156, v140, v140, v156 op_sel:[0,0,0] op_sel_hi:[1,1,0]
v_pk_mul_f16 v152, v152, v151
v_fma_mix_f32 v156, v141, v141, v156 op_sel:[1,1,0] op_sel_hi:[1,1,0]
v_pk_mul_f16 v149, v149, v148
v_fma_mix_f32 v156, v155, v155, v156 op_sel:[0,0,0] op_sel_hi:[1,1,0]
v_fma_mix_f32 v156, v142, v142, v156 op_sel:[0,0,0] op_sel_hi:[1,1,0]
v_fma_mix_f32 v156, v155, v155, v156 op_sel:[1,1,0] op_sel_hi:[1,1,0]
s_waitcnt lgkmcnt(2)
v_fma_mix_f32 v156, v143, v143, v156 op_sel:[1,1,0] op_sel_hi:[1,1,0]
v_fma_mix_f32 v156, v152, v152, v156 op_sel:[0,0,0] op_sel_hi:[1,1,0]
v_fma_mix_f32 v156, v152, v152, v156 op_sel:[1,1,0] op_sel_hi:[1,1,0]
v_fma_mix_f32 v156, v144, v144, v156 op_sel:[0,0,0] op_sel_hi:[1,1,0]
v_fma_mix_f32 v156, v149, v149, v156 op_sel:[0,0,0] op_sel_hi:[1,1,0]
v_fma_mix_f32 v156, v145, v145, v156 op_sel:[1,1,0] op_sel_hi:[1,1,0]
v_fma_mix_f32 v156, v149, v149, v156 op_sel:[1,1,0] op_sel_hi:[1,1,0]
s_setprio 2
v_cvt_pkrtz_f16_f32 v137, v120, v121
v_cvt_pkrtz_f16_f32 v139, v122, v123
v_cvt_pkrtz_f16_f32 v141, v124, v125
v_cvt_pkrtz_f16_f32 v143, v126, v127
v_cvt_pkrtz_f16_f32 v145, v128, v129
v_cvt_pk_f16_f32 v155, v130, v131
v_cvt_pk_f16_f32 v152, v132, v133
v_cvt_pk_f16_f32 v149, v134, v135
s_add_u32 s46, s80, 12582912
buffer_store_dwordx4 v[72:75], v241, s[32:35], s46 offen sc1
ds_read_b128 v[224:227], v248 offset:33792
v_mfma_f32_32x32x16_bf16 v[120:135], v[72:75], v[228:231], 0
v_pk_fma_f16 v154, v155, v155, s48
v_and_b32_e64 v137, s49, v137
v_pk_fma_f16 v151, v152, v152, s48
v_and_b32_e64 v139, s49, v139
v_pk_fma_f16 v148, v149, v149, s48
v_pk_mul_f16 v154, v155, v154
v_bfe_u32 v136, v137, 2, 14
v_pk_mul_f16 v151, v152, v151
v_pk_mul_f16 v148, v149, v148
v_bfe_u32 v138, v139, 2, 14
ds_read_b128 v[228:231], v250 offset:65520
ds_read_u16_d16 v136, v136
ds_read_u16_d16 v138, v138
v_mfma_f32_32x32x16_bf16 v[120:135], v[76:79], v[232:235], v[120:135]
v_exp_f16 v153, v154
v_lshrrev_b32 v137, 18, v137
v_exp_f16 v150, v151
v_lshrrev_b32 v139, 18, v139
v_exp_f16 v147, v148
v_and_b32 v141, s49, v141
v_and_b32_e64 v143, s49, v143
ds_read_b128 v[232:235], v248 offset:34816
ds_read_u16_d16_hi v137, v137
ds_read_b32 v247, v253 offset:12
ds_read_u16_d16_hi v139, v139
v_mfma_f32_32x32x16_bf16 v[120:135], v[80:83], v[236:239], v[120:135]
v_exp_f16_sdwa v153, v154 dst_sel:WORD_1 dst_unused:UNUSED_PRESERVE src0_sel:WORD_1
v_bfe_u32 v140, v141, 2, 14
v_exp_f16_sdwa v150, v151 dst_sel:WORD_1 dst_unused:UNUSED_PRESERVE src0_sel:WORD_1
v_bfe_u32 v142, v143, 2, 14
v_exp_f16_sdwa v147, v148 dst_sel:WORD_1 dst_unused:UNUSED_PRESERVE src0_sel:WORD_1
v_lshrrev_b32_e64 v141, 18, v141
v_pk_add_f16 v153, v153, 1.0 op_sel_hi:[1,0]
ds_read_b128 v[236:239], v248 offset:37888
ds_read_u16_d16 v140, v140
ds_read_u16_d16 v142, v142
ds_read_u16_d16_hi v141, v141
v_mfma_f32_32x32x16_bf16 v[120:135], v[84:87], v[216:219], v[120:135]
v_lshrrev_b32_e64 v143, 18, v143
v_pk_add_f16 v150, v150, 1.0 op_sel_hi:[1,0]
v_pk_add_f16 v147, v147, 1.0 op_sel_hi:[1,0]
v_and_b32 v145, s49, v145
v_rcp_f16 v154, v153
v_bfe_u32 v144, v145, 2, 14
ds_read_u16_d16_hi v143, v143
ds_read_u16_d16 v144, v144
s_waitcnt lgkmcnt(7)
v_readfirstlane_b32 s43, v247
s_nop 1
s_cmp_ge_u32 s43, 24
s_cbranch_scc1 Lev5
Lev5w:
s_sleep 1
ds_read_b32 v247, v253 offset:12
s_waitcnt lgkmcnt(0)
v_readfirstlane_b32 s43, v247
s_cmp_eq_u32 s76, 0
s_cbranch_scc1 Lev5
s_sub_u32 s76, s76, 1
s_cmp_lt_u32 s43, 24
s_cbranch_scc1 Lev5w
Lev5:
v_rcp_f16 v151, v150
v_lshrrev_b32_e64 v145, 18, v145
ds_read_b128 v[216:219], v248 offset:35840
ds_read_u16_d16_hi v145, v145
v_mfma_f32_32x32x16_bf16 v[120:135], v[88:91], v[220:223], v[120:135]
v_rcp_f16 v148, v147
v_rcp_f16_sdwa v154, v153 dst_sel:WORD_1 dst_unused:UNUSED_PRESERVE src0_sel:WORD_1
v_fma_mix_f32 v157, v136, v136, v157 op_sel:[0,0,0] op_sel_hi:[1,1,0]
v_fma_mix_f32 v157, v137, v137, v157 op_sel:[1,1,0] op_sel_hi:[1,1,0]
v_rcp_f16_sdwa v151, v150 dst_sel:WORD_1 dst_unused:UNUSED_PRESERVE src0_sel:WORD_1
v_fma_mix_f32 v157, v138, v138, v157 op_sel:[0,0,0] op_sel_hi:[1,1,0]
ds_read_b128 v[220:223], v245
ds_read_b128 v[192:195], v242
ds_read_b128 v[196:199], v242 offset:64
v_mfma_f32_32x32x16_bf16 v[120:135], v[92:95], v[224:227], v[120:135]
v_rcp_f16_sdwa v148, v147 dst_sel:WORD_1 dst_unused:UNUSED_PRESERVE src0_sel:WORD_1
s_waitcnt lgkmcnt(5)
v_fma_mix_f32 v157, v139, v139, v157 op_sel:[1,1,0] op_sel_hi:[1,1,0]
v_pk_mul_f16 v155, v155, v154
v_fma_mix_f32 v157, v140, v140, v157 op_sel:[0,0,0] op_sel_hi:[1,1,0]
v_pk_mul_f16 v152, v152, v151
v_fma_mix_f32 v157, v141, v141, v157 op_sel:[1,1,0] op_sel_hi:[1,1,0]
v_pk_mul_f16 v149, v149, v148
v_fma_mix_f32 v157, v155, v155, v157 op_sel:[0,0,0] op_sel_hi:[1,1,0]
v_fma_mix_f32 v157, v142, v142, v157 op_sel:[0,0,0] op_sel_hi:[1,1,0]
v_fma_mix_f32 v157, v155, v155, v157 op_sel:[1,1,0] op_sel_hi:[1,1,0]
v_fma_mix_f32 v157, v143, v143, v157 op_sel:[1,1,0] op_sel_hi:[1,1,0]
v_fma_mix_f32 v157, v152, v152, v157 op_sel:[0,0,0] op_sel_hi:[1,1,0]
v_fma_mix_f32 v157, v152, v152, v157 op_sel:[1,1,0] op_sel_hi:[1,1,0]
v_fma_mix_f32 v157, v144, v144, v157 op_sel:[0,0,0] op_sel_hi:[1,1,0]
v_fma_mix_f32 v157, v149, v149, v157 op_sel:[0,0,0] op_sel_hi:[1,1,0]
s_waitcnt lgkmcnt(3)
v_fma_mix_f32 v157, v145, v145, v157 op_sel:[1,1,0] op_sel_hi:[1,1,0]
v_fma_mix_f32 v157, v149, v149, v157 op_sel:[1,1,0] op_sel_hi:[1,1,0]
s_setprio 1
v_mfma_f32_32x32x16_bf16 v[0:15], v[228:231], v[228:231], 0
s_add_u32 s46, s80, 14680064
buffer_store_dwordx4 v[76:79], v241, s[32:35], s46 offen sc1
ds_read_b128 v[224:227], v248 offset:38912
v_cvt_pkrtz_f16_f32 v137, v120, v121
v_cvt_pkrtz_f16_f32 v139, v122, v123
v_cvt_pkrtz_f16_f32 v141, v124, v125
v_cvt_pkrtz_f16_f32 v143, v126, v127
v_mfma_f32_32x32x16_bf16 v[16:31], v[228:231], v[228:231], 0
v_cvt_pk_f16_f32 v155, v128, v129
v_cvt_pk_f16_f32 v152, v130, v131
v_cvt_pk_f16_f32 v149, v132, v133
v_cvt_pk_f16_f32 v146, v134, v135
v_mfma_f32_32x32x16_bf16 v[32:47], v[228:231], v[228:231], 0
v_pk_fma_f16 v154, v155, v155, s48
v_and_b32_e64 v137, s49, v137
v_pk_fma_f16 v151, v152, v152, s48
v_pk_fma_f16 v148, v149, v149, s48
v_mfma_f32_32x32x16_bf16 v[120:135], v[72:75], v[232:235], 0
ds_read_b128 v[228:231], v248 offset:36864
v_and_b32_e64 v139, s49, v139
v_pk_fma_f16 v145, v146, v146, s48
v_pk_mul_f16 v154, v155, v154
v_bfe_u32 v136, v137, 2, 14
v_pk_mul_f16 v151, v152, v151
v_pk_mul_f16 v148, v149, v148
v_bfe_u32 v138, v139, 2, 14
v_pk_mul_f16 v145, v146, v145
v_mfma_f32_32x32x16_bf16 v[120:135], v[76:79], v[236:239], v[120:135]
ds_read_b128 v[232:235], v245 offset:384
ds_read_b128 v[200:203], v242 offset:128
ds_read_b128 v[204:207], v243
ds_read_u16_d16 v136, v136
ds_read_u16_d16 v138, v138
v_exp_f16 v153, v154
v_lshrrev_b32 v137, 18, v137
v_exp_f16 v150, v151
v_lshrrev_b32 v139, 18, v139
v_exp_f16_e64 v147, v148
v_mfma_f32_32x32x16_bf16 v[120:135], v[80:83], v[216:219], v[120:135]
ds_read_b128 v[236:239], v248 offset:39936
ds_read_u16_d16_hi v137, v137
ds_read_u16_d16_hi v139, v139
v_and_b32 v141, s49, v141
v_exp_f16 v144, v145
v_and_b32 v143, s49, v143
v_exp_f16_sdwa v153, v154 dst_sel:WORD_1 dst_unused:UNUSED_PRESERVE src0_sel:WORD_1
v_bfe_u32 v140, v141, 2, 14
s_waitcnt lgkmcnt(8)
v_smfmac_f32_16x16x32_bf16 v[0:3], v[220:221], v[192:195], v246
ds_read_b128 v[216:219], v245 offset:768
ds_read_b128 v[208:211], v243 offset:64
ds_read_b128 v[212:215], v243 offset:128
ds_read_u16_d16 v140, v140
v_exp_f16_sdwa v150, v151 dst_sel:WORD_1 dst_unused:UNUSED_PRESERVE src0_sel:WORD_1
v_bfe_u32 v142, v143, 2, 14
v_exp_f16_sdwa v147, v148 dst_sel:WORD_1 dst_unused:UNUSED_PRESERVE src0_sel:WORD_1
v_smfmac_f32_16x16x32_bf16 v[16:19], v[222:223], v[196:199], v246
v_lshrrev_b32_e64 v141, 18, v141
v_exp_f16_sdwa v144, v145 dst_sel:WORD_1 dst_unused:UNUSED_PRESERVE src0_sel:WORD_1
v_lshrrev_b32_e64 v143, 18, v143
v_mfma_f32_32x32x16_bf16 v[120:135], v[84:87], v[224:227], v[120:135]
ds_read_b128 v[220:223], v245 offset:1152
ds_read_b128 v[192:195], v244
ds_read_b128 v[196:199], v244 offset:64
ds_read_u16_d16 v142, v142
ds_read_u16_d16_hi v141, v141
ds_read_u16_d16_hi v143, v143
v_pk_add_f16 v153, v153, 1.0 op_sel_hi:[1,0]
v_pk_add_f16 v150, v150, 1.0 op_sel_hi:[1,0]
v_pk_add_f16 v147, v147, 1.0 op_sel_hi:[1,0]
v_pk_add_f16 v144, v144, 1.0 op_sel_hi:[1,0]
v_rcp_f16 v154, v153
v_rcp_f16 v151, v150
v_mfma_f32_32x32x16_bf16 v[120:135], v[88:91], v[228:231], v[120:135]
ds_read_b128 v[224:227], v248 offset:40960
v_rcp_f16 v148, v147
v_rcp_f16 v145, v144
v_rcp_f16_sdwa v154, v153 dst_sel:WORD_1 dst_unused:UNUSED_PRESERVE src0_sel:WORD_1
v_rcp_f16_sdwa v151, v150 dst_sel:WORD_1 dst_unused:UNUSED_PRESERVE src0_sel:WORD_1
s_setprio 0
s_waitcnt lgkmcnt(7)
v_smfmac_f32_16x16x32_bf16 v[32:35], v[232:233], v[200:203], v246
ds_read_b128 v[228:231], v248 offset:44032
v_rcp_f16_sdwa v148, v147 dst_sel:WORD_1 dst_unused:UNUSED_PRESERVE src0_sel:WORD_1
v_fma_mix_f32 v158, v136, v136, v158 op_sel:[0,0,0] op_sel_hi:[1,1,0]
v_smfmac_f32_16x16x32_bf16 v[0:3], v[234:235], v[204:207], v246
v_rcp_f16_sdwa v145, v144 dst_sel:WORD_1 dst_unused:UNUSED_PRESERVE src0_sel:WORD_1
v_fma_mix_f32 v158, v137, v137, v158 op_sel:[1,1,0] op_sel_hi:[1,1,0]
v_pk_mul_f16 v155, v155, v154
v_fma_mix_f32 v158, v138, v138, v158 op_sel:[0,0,0] op_sel_hi:[1,1,0]
v_mfma_f32_32x32x16_bf16 v[120:135], v[92:95], v[236:239], v[120:135]
ds_read_b128 v[232:235], v248 offset:41984
v_pk_mul_f16 v152, v152, v151
v_pk_mul_f16 v149, v149, v148
v_fma_mix_f32 v158, v139, v139, v158 op_sel:[1,1,0] op_sel_hi:[1,1,0]
v_pk_mul_f16 v146, v146, v145
v_fma_mix_f32 v158, v155, v155, v158 op_sel:[0,0,0] op_sel_hi:[1,1,0]
v_fma_mix_f32 v158, v140, v140, v158 op_sel:[0,0,0] op_sel_hi:[1,1,0]
v_fma_mix_f32 v158, v155, v155, v158 op_sel:[1,1,0] op_sel_hi:[1,1,0]
v_fma_mix_f32 v158, v152, v152, v158 op_sel:[0,0,0] op_sel_hi:[1,1,0]
v_smfmac_f32_16x16x32_bf16 v[16:19], v[216:217], v[208:211], v246
ds_read_b128 v[236:239], v248 offset:45056
s_waitcnt lgkmcnt(3)
v_fma_mix_f32 v158, v141, v141, v158 op_sel:[1,1,0] op_sel_hi:[1,1,0]
v_fma_mix_f32 v158, v152, v152, v158 op_sel:[1,1,0] op_sel_hi:[1,1,0]
v_fma_mix_f32 v158, v149, v149, v158 op_sel:[0,0,0] op_sel_hi:[1,1,0]
v_fma_mix_f32 v158, v142, v142, v158 op_sel:[0,0,0] op_sel_hi:[1,1,0]
v_smfmac_f32_16x16x32_bf16 v[32:35], v[218:219], v[212:215], v246
v_fma_mix_f32 v158, v149, v149, v158 op_sel:[1,1,0] op_sel_hi:[1,1,0]
v_fma_mix_f32 v158, v146, v146, v158 op_sel:[0,0,0] op_sel_hi:[1,1,0]
v_fma_mix_f32 v158, v143, v143, v158 op_sel:[1,1,0] op_sel_hi:[1,1,0]
v_fma_mix_f32 v158, v146, v146, v158 op_sel:[1,1,0] op_sel_hi:[1,1,0]
s_setprio 2
v_smfmac_f32_16x16x32_bf16 v[0:3], v[220:221], v[192:195], v246
s_add_u32 s46, s80, 16777216
buffer_store_dwordx4 v[80:83], v241, s[32:35], s46 offen sc1
ds_read_b128 v[216:219], v248 offset:43008
v_cvt_pkrtz_f16_f32 v137, v120, v121
v_cvt_pkrtz_f16_f32 v139, v122, v123
v_cvt_pkrtz_f16_f32 v141, v124, v125
v_cvt_pkrtz_f16_f32 v143, v126, v127
v_smfmac_f32_16x16x32_bf16 v[16:19], v[222:223], v[196:199], v246
v_cvt_pkrtz_f16_f32 v145, v128, v129
v_cvt_pk_f16_f32 v155, v130, v131
v_cvt_pk_f16_f32 v152, v132, v133
v_cvt_pk_f16_f32 v149, v134, v135
v_mfma_f32_32x32x16_bf16 v[120:135], v[72:75], v[224:227], 0
ds_read_b128 v[220:223], v245 offset:1536
ds_read_b128 v[200:203], v244 offset:128
v_xor_b32 v242, 16, v242
ds_read_b128 v[204:207], v242
v_pk_fma_f16 v154, v155, v155, s48
v_and_b32 v137, s49, v137
v_pk_fma_f16 v151, v152, v152, s48
v_and_b32 v139, s49, v139
v_pk_fma_f16 v148, v149, v149, s48
v_pk_mul_f16 v154, v155, v154
v_bfe_u32 v136, v137, 2, 14
v_pk_mul_f16 v151, v152, v151
s_waitcnt lgkmcnt(4)
v_mfma_f32_32x32x16_bf16 v[120:135], v[76:79], v[228:231], v[120:135]
ds_read_b128 v[224:227], v248 offset:46080
ds_read_u16_d16 v136, v136
v_pk_mul_f16 v148, v149, v148
v_bfe_u32 v138, v139, 2, 14
v_exp_f16 v153, v154
v_lshrrev_b32 v137, 18, v137
v_exp_f16 v150, v151
v_lshrrev_b32 v139, 18, v139
v_mfma_f32_32x32x16_bf16 v[120:135], v[80:83], v[232:235], v[120:135]
ds_read_b128 v[228:231], v245 offset:1920
ds_read_b128 v[208:211], v242 offset:64
ds_read_b128 v[212:215], v242 offset:128
ds_read_u16_d16 v138, v138
ds_read_u16_d16_hi v137, v137
ds_read_u16_d16_hi v139, v139
v_exp_f16 v147, v148
v_and_b32 v141, s49, v141
v_and_b32 v143, s49, v143
v_exp_f16_sdwa v153, v154 dst_sel:WORD_1 dst_unused:UNUSED_PRESERVE src0_sel:WORD_1
v_bfe_u32 v140, v141, 2, 14
v_exp_f16_sdwa v150, v151 dst_sel:WORD_1 dst_unused:UNUSED_PRESERVE src0_sel:WORD_1
v_mfma_f32_32x32x16_bf16 v[120:135], v[84:87], v[236:239], v[120:135]
ds_read_b128 v[232:235], v245 offset:2304
v_xor_b32 v243, 16, v243
ds_read_b128 v[192:195], v243
ds_read_b128 v[196:199], v243 offset:64
ds_read_u16_d16 v140, v140
v_bfe_u32 v142, v143, 2, 14
v_exp_f16_sdwa v147, v148 dst_sel:WORD_1 dst_unused:UNUSED_PRESERVE src0_sel:WORD_1
v_lshrrev_b32_e64 v141, 18, v141
v_pk_add_f16 v153, v153, 1.0 op_sel_hi:[1,0]
v_lshrrev_b32 v143, 18, v143
v_pk_add_f16 v150, v150, 1.0 op_sel_hi:[1,0]
v_pk_add_f16 v147, v147, 1.0 op_sel_hi:[1,0]
s_waitcnt lgkmcnt(9)
v_mfma_f32_32x32x16_bf16 v[120:135], v[88:91], v[216:219], v[120:135]
ds_read_b128 v[236:239], v248 offset:47104
ds_read_u16_d16 v142, v142
ds_read_u16_d16_hi v141, v141
ds_read_u16_d16_hi v143, v143
v_and_b32 v145, s49, v145
v_rcp_f16 v154, v153
v_bfe_u32 v144, v145, 2, 14
v_rcp_f16 v151, v150
v_lshrrev_b32 v145, 18, v145
v_rcp_f16_e64 v148, v147
v_smfmac_f32_16x16x32_bf16 v[32:35], v[220:221], v[200:203], v246
ds_read_b128 v[216:219], v248 offset:50176
ds_read_u16_d16 v144, v144
ds_read_u16_d16_hi v145, v145
v_rcp_f16_sdwa v154, v153 dst_sel:WORD_1 dst_unused:UNUSED_PRESERVE src0_sel:WORD_1
v_fma_mix_f32 v159, v136, v136, v159 op_sel:[0,0,0] op_sel_hi:[1,1,0]
s_waitcnt lgkmcnt(7)
v_fma_mix_f32 v159, v137, v137, v159 op_sel:[1,1,0] op_sel_hi:[1,1,0]
v_smfmac_f32_16x16x32_bf16 v[4:7], v[222:223], v[204:207], v246
v_rcp_f16_sdwa v151, v150 dst_sel:WORD_1 dst_unused:UNUSED_PRESERVE src0_sel:WORD_1
v_fma_mix_f32 v159, v138, v138, v159 op_sel:[0,0,0] op_sel_hi:[1,1,0]
v_mfma_f32_32x32x16_bf16 v[120:135], v[92:95], v[224:227], v[120:135]
ds_read_b128 v[220:223], v248 offset:48128
v_rcp_f16_sdwa v148, v147 dst_sel:WORD_1 dst_unused:UNUSED_PRESERVE src0_sel:WORD_1
v_fma_mix_f32 v159, v139, v139, v159 op_sel:[1,1,0] op_sel_hi:[1,1,0]
v_pk_mul_f16 v155, v155, v154
v_fma_mix_f32 v159, v140, v140, v159 op_sel:[0,0,0] op_sel_hi:[1,1,0]
v_pk_mul_f16 v152, v152, v151
s_waitcnt lgkmcnt(4)
v_fma_mix_f32 v159, v141, v141, v159 op_sel:[1,1,0] op_sel_hi:[1,1,0]
v_pk_mul_f16 v149, v149, v148
v_fma_mix_f32 v159, v155, v155, v159 op_sel:[0,0,0] op_sel_hi:[1,1,0]
v_smfmac_f32_16x16x32_bf16 v[20:23], v[228:229], v[208:211], v246
ds_read_b128 v[224:227], v248 offset:51200
v_fma_mix_f32 v159, v142, v142, v159 op_sel:[0,0,0] op_sel_hi:[1,1,0]
v_fma_mix_f32 v159, v155, v155, v159 op_sel:[1,1,0] op_sel_hi:[1,1,0]
v_fma_mix_f32 v159, v143, v143, v159 op_sel:[1,1,0] op_sel_hi:[1,1,0]
v_fma_mix_f32 v159, v152, v152, v159 op_sel:[0,0,0] op_sel_hi:[1,1,0]
v_smfmac_f32_16x16x32_bf16 v[36:39], v[230:231], v[212:215], v246
v_fma_mix_f32 v159, v152, v152, v159 op_sel:[1,1,0] op_sel_hi:[1,1,0]
s_waitcnt lgkmcnt(2)
v_fma_mix_f32 v159, v144, v144, v159 op_sel:[0,0,0] op_sel_hi:[1,1,0]
v_fma_mix_f32 v159, v149, v149, v159 op_sel:[0,0,0] op_sel_hi:[1,1,0]
v_fma_mix_f32 v159, v145, v145, v159 op_sel:[1,1,0] op_sel_hi:[1,1,0]
v_fma_mix_f32 v159, v149, v149, v159 op_sel:[1,1,0] op_sel_hi:[1,1,0]
s_setprio 1
v_smfmac_f32_16x16x32_bf16 v[4:7], v[232:233], v[192:195], v246
s_add_u32 s46, s80, 18874368
buffer_store_dwordx4 v[84:87], v241, s[32:35], s46 offen sc1
ds_read_b128 v[228:231], v248 offset:49152
v_cvt_pkrtz_f16_f32 v137, v120, v121
v_cvt_pkrtz_f16_f32 v139, v122, v123
v_cvt_pkrtz_f16_f32 v141, v124, v125
v_cvt_pkrtz_f16_f32 v143, v126, v127
v_cvt_pk_f16_f32 v155, v128, v129
v_smfmac_f32_16x16x32_bf16 v[20:23], v[234:235], v[196:199], v246
v_cvt_pk_f16_f32 v152, v130, v131
v_cvt_pk_f16_f32 v149, v132, v133
v_cvt_pk_f16_f32 v146, v134, v135
v_pk_fma_f16 v154, v155, v155, s48
v_and_b32_e64 v137, s49, v137
v_mfma_f32_32x32x16_bf16 v[120:135], v[72:75], v[236:239], 0
ds_read_b128 v[232:235], v248 offset:52224
v_pk_fma_f16 v151, v152, v152, s48
v_pk_fma_f16 v148, v149, v149, s48
v_and_b32_e64 v139, s49, v139
v_pk_fma_f16 v145, v146, v146, s48
v_pk_mul_f16 v154, v155, v154
v_bfe_u32 v136, v137, 2, 14
v_pk_mul_f16 v151, v152, v151
v_pk_mul_f16 v148, v149, v148
v_bfe_u32 v138, v139, 2, 14
v_pk_mul_f16 v145, v146, v145
v_mfma_f32_32x32x16_bf16 v[120:135], v[76:79], v[216:219], v[120:135]
ds_read_b128 v[236:239], v245 offset:2688
ds_read_b128 v[200:203], v243 offset:128
v_xor_b32 v244, 16, v244
ds_read_b128 v[204:207], v244
ds_read_u16_d16 v136, v136
ds_read_u16_d16 v138, v138
v_exp_f16 v153, v154
v_lshrrev_b32 v137, 18, v137
v_exp_f16 v150, v151
v_lshrrev_b32 v139, 18, v139
v_exp_f16 v147, v148
v_and_b32_e64 v141, s49, v141
v_exp_f16 v144, v145
s_waitcnt lgkmcnt(5)
v_mfma_f32_32x32x16_bf16 v[120:135], v[80:83], v[220:223], v[120:135]
ds_read_b128 v[216:219], v245 offset:3072
ds_read_b128 v[208:211], v244 offset:64
ds_read_b128 v[212:215], v244 offset:128
ds_read_u16_d16_hi v137, v137
ds_read_u16_d16_hi v139, v139
v_and_b32_e64 v143, s49, v143
v_exp_f16_sdwa v153, v154 dst_sel:WORD_1 dst_unused:UNUSED_PRESERVE src0_sel:WORD_1
v_bfe_u32 v140, v141, 2, 14
v_exp_f16_sdwa v150, v151 dst_sel:WORD_1 dst_unused:UNUSED_PRESERVE src0_sel:WORD_1
v_bfe_u32 v142, v143, 2, 14
v_exp_f16_sdwa v147, v148 dst_sel:WORD_1 dst_unused:UNUSED_PRESERVE src0_sel:WORD_1
v_lshrrev_b32_e64 v141, 18, v141
v_mfma_f32_32x32x16_bf16 v[120:135], v[84:87], v[224:227], v[120:135]
ds_read_b128 v[220:223], v248 offset:53248
ds_read_u16_d16 v140, v140
ds_read_u16_d16 v142, v142
ds_read_u16_d16_hi v141, v141
v_exp_f16_sdwa v144, v145 dst_sel:WORD_1 dst_unused:UNUSED_PRESERVE src0_sel:WORD_1
v_lshrrev_b32_e64 v143, 18, v143
v_pk_add_f16 v153, v153, 1.0 op_sel_hi:[1,0]
v_pk_add_f16 v150, v150, 1.0 op_sel_hi:[1,0]
v_pk_add_f16 v147, v147, 1.0 op_sel_hi:[1,0]
v_pk_add_f16 v144, v144, 1.0 op_sel_hi:[1,0]
v_rcp_f16 v154, v153
v_rcp_f16 v151, v150
v_mfma_f32_32x32x16_bf16 v[120:135], v[88:91], v[228:231], v[120:135]
ds_read_b128 v[224:227], v248 offset:56320
ds_read_u16_d16_hi v143, v143
v_rcp_f16 v148, v147
v_rcp_f16 v145, v144
v_rcp_f16_sdwa v154, v153 dst_sel:WORD_1 dst_unused:UNUSED_PRESERVE src0_sel:WORD_1
v_rcp_f16_sdwa v151, v150 dst_sel:WORD_1 dst_unused:UNUSED_PRESERVE src0_sel:WORD_1
s_setprio 0
v_rcp_f16_sdwa v148, v147 dst_sel:WORD_1 dst_unused:UNUSED_PRESERVE src0_sel:WORD_1
s_waitcnt lgkmcnt(6)
v_fma_mix_f32 v160, v136, v136, v160 op_sel:[0,0,0] op_sel_hi:[1,1,0]
v_mfma_f32_32x32x16_bf16 v[120:135], v[92:95], v[232:235], v[120:135]
ds_read_b128 v[228:231], v248 offset:54272
v_rcp_f16_sdwa v145, v144 dst_sel:WORD_1 dst_unused:UNUSED_PRESERVE src0_sel:WORD_1
v_fma_mix_f32 v160, v137, v137, v160 op_sel:[1,1,0] op_sel_hi:[1,1,0]
v_pk_mul_f16 v155, v155, v154
v_fma_mix_f32 v160, v138, v138, v160 op_sel:[0,0,0] op_sel_hi:[1,1,0]
v_pk_mul_f16 v152, v152, v151
v_pk_mul_f16 v149, v149, v148
v_fma_mix_f32 v160, v139, v139, v160 op_sel:[1,1,0] op_sel_hi:[1,1,0]
v_pk_mul_f16 v146, v146, v145
v_fma_mix_f32 v160, v155, v155, v160 op_sel:[0,0,0] op_sel_hi:[1,1,0]
v_smfmac_f32_16x16x32_bf16 v[36:39], v[236:237], v[200:203], v246
ds_read_b128 v[232:235], v248 offset:57344
s_waitcnt lgkmcnt(4)
v_fma_mix_f32 v160, v140, v140, v160 op_sel:[0,0,0] op_sel_hi:[1,1,0]
v_fma_mix_f32 v160, v155, v155, v160 op_sel:[1,1,0] op_sel_hi:[1,1,0]
v_fma_mix_f32 v160, v152, v152, v160 op_sel:[0,0,0] op_sel_hi:[1,1,0]
v_fma_mix_f32 v160, v141, v141, v160 op_sel:[1,1,0] op_sel_hi:[1,1,0]
v_fma_mix_f32 v160, v152, v152, v160 op_sel:[1,1,0] op_sel_hi:[1,1,0]
v_smfmac_f32_16x16x32_bf16 v[4:7], v[238:239], v[204:207], v246
v_fma_mix_f32 v160, v149, v149, v160 op_sel:[0,0,0] op_sel_hi:[1,1,0]
v_fma_mix_f32 v160, v142, v142, v160 op_sel:[0,0,0] op_sel_hi:[1,1,0]
v_fma_mix_f32 v160, v149, v149, v160 op_sel:[1,1,0] op_sel_hi:[1,1,0]
v_fma_mix_f32 v160, v146, v146, v160 op_sel:[0,0,0] op_sel_hi:[1,1,0]
s_waitcnt lgkmcnt(2)
v_fma_mix_f32 v160, v143, v143, v160 op_sel:[1,1,0] op_sel_hi:[1,1,0]
v_fma_mix_f32 v160, v146, v146, v160 op_sel:[1,1,0] op_sel_hi:[1,1,0]
s_cmp_lg_u32 s40, 7
s_cbranch_scc1 Lnobias2
s_sub_u32 s43, s2, 96
s_cmp_lt_u32 s43, 96
s_cbranch_scc0 Lnobias2
s_waitcnt vmcnt(17)
v_lshlrev_b32 v178, 16, v178
v_lshlrev_b32 v179, 16, v179
v_lshlrev_b32 v180, 16, v180
v_lshlrev_b32 v181, 16, v181
v_lshlrev_b32 v182, 16, v182
v_lshlrev_b32 v183, 16, v183
v_lshlrev_b32 v184, 16, v184
v_lshlrev_b32 v185, 16, v185
v_lshlrev_b32 v186, 16, v186
v_lshlrev_b32 v187, 16, v187
v_lshlrev_b32 v188, 16, v188
v_lshlrev_b32 v189, 16, v189
v_mul_f32 v176, v178, v184
v_fmac_f32 v176, v179, v185
v_fmac_f32 v176, v180, v186
v_fmac_f32 v176, v181, v187
v_fmac_f32 v176, v182, v188
v_fmac_f32 v176, v183, v189
s_nop 1
v_add_f32_dpp v176, v176, v176 row_ror:8 row_mask:0xf bank_mask:0xf
s_nop 1
v_add_f32_dpp v176, v176, v176 row_ror:4 row_mask:0xf bank_mask:0xf
s_nop 1
v_add_f32_dpp v176, v176, v176 row_ror:2 row_mask:0xf bank_mask:0xf
s_nop 1
v_add_f32_dpp v176, v176, v176 row_ror:1 row_mask:0xf bank_mask:0xf
v_mov_b32 v177, v176
s_nop 1
v_permlane16_swap_b32 v176, v177
v_add_f32 v176, v176, v177
v_mov_b32_e64 v177, v176
s_nop 1
v_permlane32_swap_b32 v176, v177
v_add_f32 v176, v176, v177
s_lshl_b32 s44, s43, 2
s_add_u32 s44, s44, 394752
v_lshlrev_b32_e64 v191, 11, v251
s_mov_b64 exec, 0xff
buffer_store_dword v176, v191, s[32:35], s44 offen sc1
s_mov_b64 exec, -1
Lnobias2:
v_lshlrev_b32 v252, 7, v251
s_add_u32 s46, s47, 2359296
s_mov_b32 exec_lo, 131071
s_mov_b32 exec_hi, 0
s_mov_b32 m0, 16288
s_nop 0
buffer_load_dword v252, s[4:7], s46 offen lds
s_mov_b64 exec, -1
s_setprio 2
v_smfmac_f32_16x16x32_bf16 v[20:23], v[216:217], v[208:211], v246
s_add_u32 s46, s80, 20971520
buffer_store_dwordx4 v[88:91], v241, s[32:35], s46 offen sc1
ds_read_b128 v[236:239], v248 offset:55296
v_cvt_pkrtz_f16_f32 v137, v120, v121
v_cvt_pkrtz_f16_f32 v139, v122, v123
v_cvt_pkrtz_f16_f32 v141, v124, v125
v_cvt_pkrtz_f16_f32 v143, v126, v127
v_smfmac_f32_16x16x32_bf16 v[36:39], v[218:219], v[212:215], v246
v_cvt_pkrtz_f16_f32 v145, v128, v129
v_cvt_pk_f16_f32 v155, v130, v131
v_cvt_pk_f16_f32 v152, v132, v133
v_cvt_pk_f16_f32 v149, v134, v135
v_mfma_f32_32x32x16_bf16 v[120:135], v[72:75], v[220:223], 0
ds_read_b128 v[216:219], v245 offset:3456
v_xor_b32 v242, 32, v242
ds_read_b128 v[192:195], v242
ds_read_b128 v[196:199], v242 offset:64
v_pk_fma_f16 v154, v155, v155, s48
v_and_b32 v137, s49, v137
v_pk_fma_f16 v151, v152, v152, s48
v_and_b32_e64 v139, s49, v139
v_pk_fma_f16 v148, v149, v149, s48
v_pk_mul_f16 v154, v155, v154
v_bfe_u32 v136, v137, 2, 14
v_pk_mul_f16 v151, v152, v151
v_mfma_f32_32x32x16_bf16 v[120:135], v[76:79], v[224:227], v[120:135]
ds_read_b128 v[220:223], v248 offset:58368
ds_read_u16_d16 v136, v136
v_pk_mul_f16 v148, v149, v148
v_bfe_u32 v138, v139, 2, 14
v_exp_f16 v153, v154
v_lshrrev_b32 v137, 18, v137
v_exp_f16 v150, v151
v_lshrrev_b32 v139, 18, v139
s_waitcnt lgkmcnt(5)
v_mfma_f32_32x32x16_bf16 v[120:135], v[80:83], v[228:231], v[120:135]
ds_read_b128 v[224:227], v245 offset:3840
ds_read_b128 v[200:203], v242 offset:128
v_xor_b32 v243, 32, v243
ds_read_b128 v[204:207], v243
ds_read_u16_d16 v138, v138
ds_read_u16_d16_hi v137, v137
ds_read_u16_d16_hi v139, v139
v_exp_f16 v147, v148
v_and_b32 v141, s49, v141
v_and_b32_e64 v143, s49, v143
v_exp_f16_sdwa v153, v154 dst_sel:WORD_1 dst_unused:UNUSED_PRESERVE src0_sel:WORD_1
v_bfe_u32 v140, v141, 2, 14
v_exp_f16_sdwa v150, v151 dst_sel:WORD_1 dst_unused:UNUSED_PRESERVE src0_sel:WORD_1
v_mfma_f32_32x32x16_bf16 v[120:135], v[84:87], v[232:235], v[120:135]
ds_read_b128 v[228:231], v245 offset:4224
ds_read_b128 v[208:211], v243 offset:64
ds_read_b128 v[212:215], v243 offset:128
ds_read_u16_d16 v140, v140
v_bfe_u32 v142, v143, 2, 14
v_exp_f16_sdwa v147, v148 dst_sel:WORD_1 dst_unused:UNUSED_PRESERVE src0_sel:WORD_1
v_lshrrev_b32_e64 v141, 18, v141
v_pk_add_f16 v153, v153, 1.0 op_sel_hi:[1,0]
v_lshrrev_b32_e64 v143, 18, v143
v_pk_add_f16 v150, v150, 1.0 op_sel_hi:[1,0]
v_pk_add_f16 v147, v147, 1.0 op_sel_hi:[1,0]
v_mfma_f32_32x32x16_bf16 v[120:135], v[88:91], v[236:239], v[120:135]
ds_read_b128 v[232:235], v248 offset:59392
ds_read_u16_d16 v142, v142
ds_read_u16_d16_hi v141, v141
ds_read_u16_d16_hi v143, v143
v_and_b32 v145, s49, v145
v_rcp_f16 v154, v153
v_bfe_u32 v144, v145, 2, 14
v_rcp_f16 v151, v150
v_lshrrev_b32 v145, 18, v145
v_rcp_f16 v148, v147
s_waitcnt lgkmcnt(8)
v_smfmac_f32_16x16x32_bf16 v[12:15], v[216:217], v[192:195], v246
ds_read_b128 v[236:239], v248 offset:62464
ds_read_u16_d16 v144, v144
ds_read_u16_d16_hi v145, v145
v_rcp_f16_sdwa v154, v153 dst_sel:WORD_1 dst_unused:UNUSED_PRESERVE src0_sel:WORD_1
v_fma_mix_f32 v161, v136, v136, v161 op_sel:[0,0,0] op_sel_hi:[1,1,0]
v_fma_mix_f32 v161, v137, v137, v161 op_sel:[1,1,0] op_sel_hi:[1,1,0]
v_smfmac_f32_16x16x32_bf16 v[28:31], v[218:219], v[196:199], v246
v_rcp_f16_sdwa v151, v150 dst_sel:WORD_1 dst_unused:UNUSED_PRESERVE src0_sel:WORD_1
v_fma_mix_f32 v161, v138, v138, v161 op_sel:[0,0,0] op_sel_hi:[1,1,0]
v_mfma_f32_32x32x16_bf16 v[120:135], v[92:95], v[220:223], v[120:135]
ds_read_b128 v[216:219], v248 offset:60416
v_rcp_f16_sdwa v148, v147 dst_sel:WORD_1 dst_unused:UNUSED_PRESERVE src0_sel:WORD_1
v_fma_mix_f32 v161, v139, v139, v161 op_sel:[1,1,0] op_sel_hi:[1,1,0]
v_pk_mul_f16 v155, v155, v154
s_waitcnt lgkmcnt(6)
v_fma_mix_f32 v161, v140, v140, v161 op_sel:[0,0,0] op_sel_hi:[1,1,0]
v_pk_mul_f16 v152, v152, v151
s_waitcnt lgkmcnt(4)
v_fma_mix_f32 v161, v141, v141, v161 op_sel:[1,1,0] op_sel_hi:[1,1,0]
v_pk_mul_f16 v149, v149, v148
v_fma_mix_f32 v161, v155, v155, v161 op_sel:[0,0,0] op_sel_hi:[1,1,0]
v_smfmac_f32_16x16x32_bf16 v[44:47], v[224:225], v[200:203], v246
ds_read_b128 v[220:223], v248 offset:63488
v_fma_mix_f32 v161, v142, v142, v161 op_sel:[0,0,0] op_sel_hi:[1,1,0]
v_fma_mix_f32 v161, v155, v155, v161 op_sel:[1,1,0] op_sel_hi:[1,1,0]
v_fma_mix_f32 v161, v143, v143, v161 op_sel:[1,1,0] op_sel_hi:[1,1,0]
v_fma_mix_f32 v161, v152, v152, v161 op_sel:[0,0,0] op_sel_hi:[1,1,0]
v_smfmac_f32_16x16x32_bf16 v[12:15], v[226:227], v[204:207], v246
v_fma_mix_f32 v161, v152, v152, v161 op_sel:[1,1,0] op_sel_hi:[1,1,0]
s_waitcnt lgkmcnt(2)
v_fma_mix_f32 v161, v144, v144, v161 op_sel:[0,0,0] op_sel_hi:[1,1,0]
v_fma_mix_f32 v161, v149, v149, v161 op_sel:[0,0,0] op_sel_hi:[1,1,0]
v_fma_mix_f32 v161, v145, v145, v161 op_sel:[1,1,0] op_sel_hi:[1,1,0]
v_fma_mix_f32 v161, v149, v149, v161 op_sel:[1,1,0] op_sel_hi:[1,1,0]
v_lshlrev_b32 v252, 7, v251
s_add_u32 s46, s47, 2359296
s_mov_b32 exec_lo, 4294836224
s_mov_b32 exec_hi, 3
s_mov_b32 m0, 16220
s_nop 0
buffer_load_dword v252, s[4:7], s46 offen lds
s_mov_b64 exec, -1
s_setprio 1
v_smfmac_f32_16x16x32_bf16 v[28:31], v[228:229], v[208:211], v246
s_add_u32 s46, s80, 23068672
buffer_store_dwordx4 v[92:95], v241, s[32:35], s46 offen sc1
ds_read_b128 v[224:227], v248 offset:61440
v_cvt_pkrtz_f16_f32 v137, v120, v121
v_cvt_pkrtz_f16_f32 v139, v122, v123
v_cvt_pkrtz_f16_f32 v141, v124, v125
v_cvt_pkrtz_f16_f32 v143, v126, v127
v_cvt_pk_f16_f32 v155, v128, v129
v_smfmac_f32_16x16x32_bf16 v[44:47], v[230:231], v[212:215], v246
v_cvt_pk_f16_f32 v152, v130, v131
v_cvt_pk_f16_f32 v149, v132, v133
v_cvt_pk_f16_f32 v146, v134, v135
v_pk_fma_f16 v154, v155, v155, s48
v_and_b32_e64 v137, s49, v137
v_mfma_f32_32x32x16_bf16 v[120:135], v[72:75], v[232:235], 0
ds_read_b128 v[228:231], v248 offset:64512
v_pk_fma_f16 v151, v152, v152, s48
v_pk_fma_f16 v148, v149, v149, s48
v_and_b32_e64 v139, s49, v139
v_pk_fma_f16 v145, v146, v146, s48
v_pk_mul_f16 v154, v155, v154
v_bfe_u32 v136, v137, 2, 14
v_pk_mul_f16 v151, v152, v151
v_pk_mul_f16 v148, v149, v148
v_bfe_u32 v138, v139, 2, 14
v_pk_mul_f16 v145, v146, v145
v_mfma_f32_32x32x16_bf16 v[120:135], v[76:79], v[236:239], v[120:135]
ds_read_b128 v[232:235], v245 offset:4608
v_xor_b32 v244, 32, v244
ds_read_b128 v[192:195], v244
ds_read_b128 v[196:199], v244 offset:64
ds_read_u16_d16 v136, v136
ds_read_u16_d16 v138, v138
v_exp_f16 v153, v154
v_lshrrev_b32 v137, 18, v137
v_exp_f16 v150, v151
v_lshrrev_b32 v139, 18, v139
v_exp_f16 v147, v148
v_and_b32 v141, s49, v141
v_exp_f16 v144, v145
s_waitcnt lgkmcnt(5)
v_mfma_f32_32x32x16_bf16 v[120:135], v[80:83], v[216:219], v[120:135]
ds_read_b128 v[236:239], v245 offset:4992
ds_read_b128 v[200:203], v244 offset:128
v_xor_b32 v242, 16, v242
ds_read_b128 v[204:207], v242
ds_read_u16_d16_hi v137, v137
ds_read_u16_d16_hi v139, v139
v_and_b32_e64 v143, s49, v143
v_exp_f16_sdwa v153, v154 dst_sel:WORD_1 dst_unused:UNUSED_PRESERVE src0_sel:WORD_1
v_bfe_u32 v140, v141, 2, 14
v_exp_f16_sdwa v150, v151 dst_sel:WORD_1 dst_unused:UNUSED_PRESERVE src0_sel:WORD_1
v_bfe_u32 v142, v143, 2, 14
v_exp_f16_sdwa v147, v148 dst_sel:WORD_1 dst_unused:UNUSED_PRESERVE src0_sel:WORD_1
v_lshrrev_b32_e64 v141, 18, v141
v_mfma_f32_32x32x16_bf16 v[120:135], v[84:87], v[220:223], v[120:135]
ds_read_b128 v[216:219], v249
ds_read_u16_d16 v140, v140
ds_read_u16_d16 v142, v142
ds_read_u16_d16_hi v141, v141
v_exp_f16_sdwa v144, v145 dst_sel:WORD_1 dst_unused:UNUSED_PRESERVE src0_sel:WORD_1
v_lshrrev_b32_e64 v143, 18, v143
v_pk_add_f16 v153, v153, 1.0 op_sel_hi:[1,0]
v_pk_add_f16 v150, v150, 1.0 op_sel_hi:[1,0]
v_pk_add_f16 v147, v147, 1.0 op_sel_hi:[1,0]
v_pk_add_f16 v144, v144, 1.0 op_sel_hi:[1,0]
v_rcp_f16 v154, v153
v_rcp_f16 v151, v150
v_mfma_f32_32x32x16_bf16 v[120:135], v[88:91], v[224:227], v[120:135]
ds_read_b128 v[220:223], v249 offset:3072
ds_read_u16_d16_hi v143, v143
v_rcp_f16 v148, v147
v_rcp_f16 v145, v144
v_rcp_f16_sdwa v154, v153 dst_sel:WORD_1 dst_unused:UNUSED_PRESERVE src0_sel:WORD_1
v_rcp_f16_sdwa v151, v150 dst_sel:WORD_1 dst_unused:UNUSED_PRESERVE src0_sel:WORD_1
s_setprio 0
v_rcp_f16_sdwa v148, v147 dst_sel:WORD_1 dst_unused:UNUSED_PRESERVE src0_sel:WORD_1
s_waitcnt lgkmcnt(6)
v_fma_mix_f32 v162, v136, v136, v162 op_sel:[0,0,0] op_sel_hi:[1,1,0]
v_mfma_f32_32x32x16_bf16 v[120:135], v[92:95], v[228:231], v[120:135]
ds_read_b128 v[224:227], v249 offset:1024
v_rcp_f16_sdwa v145, v144 dst_sel:WORD_1 dst_unused:UNUSED_PRESERVE src0_sel:WORD_1
v_fma_mix_f32 v162, v137, v137, v162 op_sel:[1,1,0] op_sel_hi:[1,1,0]
v_pk_mul_f16 v155, v155, v154
v_fma_mix_f32 v162, v138, v138, v162 op_sel:[0,0,0] op_sel_hi:[1,1,0]
v_pk_mul_f16 v152, v152, v151
v_pk_mul_f16 v149, v149, v148
v_fma_mix_f32 v162, v139, v139, v162 op_sel:[1,1,0] op_sel_hi:[1,1,0]
v_pk_mul_f16 v146, v146, v145
v_fma_mix_f32 v162, v155, v155, v162 op_sel:[0,0,0] op_sel_hi:[1,1,0]
v_smfmac_f32_16x16x32_bf16 v[12:15], v[232:233], v[192:195], v246
ds_read_b128 v[228:231], v249 offset:4096
s_waitcnt lgkmcnt(4)
v_fma_mix_f32 v162, v140, v140, v162 op_sel:[0,0,0] op_sel_hi:[1,1,0]
v_fma_mix_f32 v162, v155, v155, v162 op_sel:[1,1,0] op_sel_hi:[1,1,0]
v_fma_mix_f32 v162, v152, v152, v162 op_sel:[0,0,0] op_sel_hi:[1,1,0]
v_fma_mix_f32 v162, v141, v141, v162 op_sel:[1,1,0] op_sel_hi:[1,1,0]
v_fma_mix_f32 v162, v152, v152, v162 op_sel:[1,1,0] op_sel_hi:[1,1,0]
v_smfmac_f32_16x16x32_bf16 v[28:31], v[234:235], v[196:199], v246
v_fma_mix_f32 v162, v149, v149, v162 op_sel:[0,0,0] op_sel_hi:[1,1,0]
v_fma_mix_f32 v162, v142, v142, v162 op_sel:[0,0,0] op_sel_hi:[1,1,0]
v_fma_mix_f32 v162, v149, v149, v162 op_sel:[1,1,0] op_sel_hi:[1,1,0]
v_fma_mix_f32 v162, v146, v146, v162 op_sel:[0,0,0] op_sel_hi:[1,1,0]
s_waitcnt lgkmcnt(2)
v_fma_mix_f32 v162, v143, v143, v162 op_sel:[1,1,0] op_sel_hi:[1,1,0]
v_fma_mix_f32 v162, v146, v146, v162 op_sel:[1,1,0] op_sel_hi:[1,1,0]
v_lshlrev_b32_e64 v252, 7, v251
s_add_u32 s46, s47, 2359296
s_mov_b32 exec_lo, 0
s_mov_b32 exec_hi, 1048572
s_mov_b32 m0, 16152
s_nop 0
buffer_load_dword v252, s[4:7], s46 offen lds
s_mov_b64 exec, -1
s_setprio 2
v_smfmac_f32_16x16x32_bf16 v[44:47], v[236:237], v[200:203], v246
ds_read_b128 v[232:235], v249 offset:2048
v_cvt_pkrtz_f16_f32 v137, v120, v121
v_cvt_pkrtz_f16_f32 v139, v122, v123
v_cvt_pkrtz_f16_f32 v141, v124, v125
v_cvt_pkrtz_f16_f32 v143, v126, v127
v_smfmac_f32_16x16x32_bf16 v[8:11], v[238:239], v[204:207], v246
v_cvt_pkrtz_f16_f32 v145, v128, v129
v_cvt_pk_f16_f32 v155, v130, v131
v_cvt_pk_f16_f32 v152, v132, v133
v_cvt_pk_f16_f32 v149, v134, v135
v_mfma_f32_32x32x16_bf16 v[120:135], v[72:75], v[216:219], 0
ds_read_b128 v[236:239], v245 offset:5376
ds_read_b128 v[208:211], v242 offset:64
ds_read_b128 v[212:215], v242 offset:128
v_pk_fma_f16 v154, v155, v155, s48
v_and_b32_e64 v137, s49, v137
v_pk_fma_f16 v151, v152, v152, s48
v_and_b32_e64 v139, s49, v139
v_pk_fma_f16 v148, v149, v149, s48
v_pk_mul_f16 v154, v155, v154
v_bfe_u32 v136, v137, 2, 14
v_pk_mul_f16 v151, v152, v151
v_mfma_f32_32x32x16_bf16 v[120:135], v[76:79], v[220:223], v[120:135]
ds_read_b128 v[216:219], v249 offset:5120
ds_read_u16_d16 v136, v136
v_pk_mul_f16 v148, v149, v148
v_bfe_u32 v138, v139, 2, 14
v_exp_f16 v153, v154
v_lshrrev_b32 v137, 18, v137
v_exp_f16 v150, v151
v_lshrrev_b32 v139, 18, v139
s_waitcnt lgkmcnt(5)
v_mfma_f32_32x32x16_bf16 v[120:135], v[80:83], v[224:227], v[120:135]
ds_read_b128 v[220:223], v245 offset:5760
v_xor_b32 v243, 16, v243
ds_read_b128 v[192:195], v243
ds_read_b128 v[196:199], v243 offset:64
ds_read_u16_d16 v138, v138
ds_read_u16_d16_hi v137, v137
ds_read_u16_d16_hi v139, v139
v_exp_f16 v147, v148
v_and_b32 v141, s49, v141
v_and_b32_e64 v143, s49, v143
v_exp_f16_sdwa v153, v154 dst_sel:WORD_1 dst_unused:UNUSED_PRESERVE src0_sel:WORD_1
v_bfe_u32 v140, v141, 2, 14
v_exp_f16_sdwa v150, v151 dst_sel:WORD_1 dst_unused:UNUSED_PRESERVE src0_sel:WORD_1
v_mfma_f32_32x32x16_bf16 v[120:135], v[84:87], v[228:231], v[120:135]
ds_read_b128 v[224:227], v245 offset:6144
ds_read_b128 v[200:203], v243 offset:128
v_xor_b32 v244, 16, v244
ds_read_b128 v[204:207], v244
ds_read_u16_d16 v140, v140
v_bfe_u32 v142, v143, 2, 14
v_exp_f16_sdwa v147, v148 dst_sel:WORD_1 dst_unused:UNUSED_PRESERVE src0_sel:WORD_1
v_lshrrev_b32 v141, 18, v141
v_pk_add_f16 v153, v153, 1.0 op_sel_hi:[1,0]
v_lshrrev_b32_e64 v143, 18, v143
v_pk_add_f16 v150, v150, 1.0 op_sel_hi:[1,0]
v_pk_add_f16 v147, v147, 1.0 op_sel_hi:[1,0]
v_mfma_f32_32x32x16_bf16 v[120:135], v[88:91], v[232:235], v[120:135]
ds_read_b128 v[228:231], v249 offset:6144
ds_read_u16_d16 v142, v142
ds_read_u16_d16_hi v141, v141
ds_read_u16_d16_hi v143, v143
v_and_b32 v145, s49, v145
v_rcp_f16 v154, v153
v_bfe_u32 v144, v145, 2, 14
v_rcp_f16 v151, v150
v_lshrrev_b32 v145, 18, v145
v_rcp_f16 v148, v147
s_waitcnt lgkmcnt(8)
v_smfmac_f32_16x16x32_bf16 v[24:27], v[236:237], v[208:211], v246
ds_read_b128 v[232:235], v249 offset:9216
ds_read_u16_d16 v144, v144
ds_read_u16_d16_hi v145, v145
v_rcp_f16_sdwa v154, v153 dst_sel:WORD_1 dst_unused:UNUSED_PRESERVE src0_sel:WORD_1
v_fma_mix_f32 v163, v136, v136, v163 op_sel:[0,0,0] op_sel_hi:[1,1,0]
v_fma_mix_f32 v163, v137, v137, v163 op_sel:[1,1,0] op_sel_hi:[1,1,0]
v_smfmac_f32_16x16x32_bf16 v[40:43], v[238:239], v[212:215], v246
v_rcp_f16_sdwa v151, v150 dst_sel:WORD_1 dst_unused:UNUSED_PRESERVE src0_sel:WORD_1
v_fma_mix_f32 v163, v138, v138, v163 op_sel:[0,0,0] op_sel_hi:[1,1,0]
v_mfma_f32_32x32x16_bf16 v[120:135], v[92:95], v[216:219], v[120:135]
ds_read_b128 v[236:239], v249 offset:7168
v_rcp_f16_sdwa v148, v147 dst_sel:WORD_1 dst_unused:UNUSED_PRESERVE src0_sel:WORD_1
v_fma_mix_f32 v163, v139, v139, v163 op_sel:[1,1,0] op_sel_hi:[1,1,0]
v_pk_mul_f16 v155, v155, v154
s_waitcnt lgkmcnt(6)
v_fma_mix_f32 v163, v140, v140, v163 op_sel:[0,0,0] op_sel_hi:[1,1,0]
v_pk_mul_f16 v152, v152, v151
s_waitcnt lgkmcnt(4)
v_fma_mix_f32 v163, v141, v141, v163 op_sel:[1,1,0] op_sel_hi:[1,1,0]
v_pk_mul_f16 v149, v149, v148
v_fma_mix_f32 v163, v155, v155, v163 op_sel:[0,0,0] op_sel_hi:[1,1,0]
v_smfmac_f32_16x16x32_bf16 v[8:11], v[220:221], v[192:195], v246
ds_read_b128 v[216:219], v249 offset:10240
v_fma_mix_f32 v163, v142, v142, v163 op_sel:[0,0,0] op_sel_hi:[1,1,0]
v_fma_mix_f32 v163, v155, v155, v163 op_sel:[1,1,0] op_sel_hi:[1,1,0]
v_fma_mix_f32 v163, v143, v143, v163 op_sel:[1,1,0] op_sel_hi:[1,1,0]
v_fma_mix_f32 v163, v152, v152, v163 op_sel:[0,0,0] op_sel_hi:[1,1,0]
v_smfmac_f32_16x16x32_bf16 v[24:27], v[222:223], v[196:199], v246
v_fma_mix_f32 v163, v152, v152, v163 op_sel:[1,1,0] op_sel_hi:[1,1,0]
s_waitcnt lgkmcnt(2)
v_fma_mix_f32 v163, v144, v144, v163 op_sel:[0,0,0] op_sel_hi:[1,1,0]
v_fma_mix_f32 v163, v149, v149, v163 op_sel:[0,0,0] op_sel_hi:[1,1,0]
v_fma_mix_f32 v163, v145, v145, v163 op_sel:[1,1,0] op_sel_hi:[1,1,0]
v_fma_mix_f32 v163, v149, v149, v163 op_sel:[1,1,0] op_sel_hi:[1,1,0]
s_setprio 1
v_smfmac_f32_16x16x32_bf16 v[40:43], v[224:225], v[200:203], v246
ds_read_b128 v[220:223], v249 offset:8192
v_cvt_pkrtz_f16_f32 v137, v120, v121
v_cvt_pkrtz_f16_f32 v139, v122, v123
v_cvt_pkrtz_f16_f32 v141, v124, v125
v_cvt_pkrtz_f16_f32 v143, v126, v127
v_smfmac_f32_16x16x32_bf16 v[8:11], v[226:227], v[204:207], v246
v_cvt_pk_f16_f32 v155, v128, v129
v_cvt_pk_f16_f32 v152, v130, v131
v_cvt_pk_f16_f32 v149, v132, v133
v_cvt_pk_f16_f32 v146, v134, v135
v_pk_fma_f16 v154, v155, v155, s48
v_mfma_f32_32x32x16_bf16 v[120:135], v[72:75], v[228:231], 0
ds_read_b128 v[224:227], v249 offset:11264
v_and_b32_e64 v137, s49, v137
v_pk_fma_f16 v151, v152, v152, s48
v_pk_fma_f16 v148, v149, v149, s48
v_and_b32_e64 v139, s49, v139
v_pk_fma_f16 v145, v146, v146, s48
v_pk_mul_f16 v154, v155, v154
v_bfe_u32 v136, v137, 2, 14
v_pk_mul_f16 v151, v152, v151
v_pk_mul_f16 v148, v149, v148
v_bfe_u32 v138, v139, 2, 14
v_mfma_f32_32x32x16_bf16 v[120:135], v[76:79], v[232:235], v[120:135]
ds_read_b128 v[228:231], v245 offset:6528
ds_read_b128 v[208:211], v244 offset:64
ds_read_b128 v[212:215], v244 offset:128
ds_read_u16_d16 v136, v136
ds_read_u16_d16 v138, v138
v_pk_mul_f16 v145, v146, v145
v_exp_f16 v153, v154
v_lshrrev_b32 v137, 18, v137
v_exp_f16 v150, v151
v_lshrrev_b32 v139, 18, v139
v_exp_f16 v147, v148
s_waitcnt lgkmcnt(6)
v_mfma_f32_32x32x16_bf16 v[120:135], v[80:83], v[236:239], v[120:135]
ds_read_b128 v[232:235], v249 offset:12288
ds_read_u16_d16_hi v137, v137
ds_read_u16_d16_hi v139, v139
v_and_b32 v141, s49, v141
v_exp_f16 v144, v145
v_and_b32_e64 v143, s49, v143
v_exp_f16_sdwa v153, v154 dst_sel:WORD_1 dst_unused:UNUSED_PRESERVE src0_sel:WORD_1
v_bfe_u32 v140, v141, 2, 14
v_exp_f16_sdwa v150, v151 dst_sel:WORD_1 dst_unused:UNUSED_PRESERVE src0_sel:WORD_1
v_bfe_u32 v142, v143, 2, 14
v_mfma_f32_32x32x16_bf16 v[120:135], v[84:87], v[216:219], v[120:135]
ds_read_b128 v[236:239], v249 offset:15360
ds_read_u16_d16 v140, v140
ds_read_u16_d16 v142, v142
v_exp_f16_sdwa v147, v148 dst_sel:WORD_1 dst_unused:UNUSED_PRESERVE src0_sel:WORD_1
v_lshrrev_b32_e64 v141, 18, v141
v_exp_f16_sdwa v144, v145 dst_sel:WORD_1 dst_unused:UNUSED_PRESERVE src0_sel:WORD_1
v_lshrrev_b32_e64 v143, 18, v143
v_pk_add_f16 v153, v153, 1.0 op_sel_hi:[1,0]
v_pk_add_f16 v150, v150, 1.0 op_sel_hi:[1,0]
v_pk_add_f16 v147, v147, 1.0 op_sel_hi:[1,0]
v_mfma_f32_32x32x16_bf16 v[120:135], v[88:91], v[220:223], v[120:135]
ds_read_b128 v[216:219], v249 offset:13312
ds_read_u16_d16_hi v141, v141
ds_read_u16_d16_hi v143, v143
v_pk_add_f16 v144, v144, 1.0 op_sel_hi:[1,0]
v_rcp_f16 v154, v153
v_rcp_f16 v151, v150
v_rcp_f16 v148, v147
v_rcp_f16 v145, v144
s_waitcnt lgkmcnt(6)
v_mfma_f32_32x32x16_bf16 v[120:135], v[92:95], v[224:227], v[120:135]
ds_read_b128 v[220:223], v249 offset:16384
v_rcp_f16_sdwa v154, v153 dst_sel:WORD_1 dst_unused:UNUSED_PRESERVE src0_sel:WORD_1
v_rcp_f16_sdwa v151, v150 dst_sel:WORD_1 dst_unused:UNUSED_PRESERVE src0_sel:WORD_1
s_setprio 0
v_rcp_f16_sdwa v148, v147 dst_sel:WORD_1 dst_unused:UNUSED_PRESERVE src0_sel:WORD_1
v_fma_mix_f32 v164, v136, v136, v164 op_sel:[0,0,0] op_sel_hi:[1,1,0]
v_rcp_f16_sdwa v145, v144 dst_sel:WORD_1 dst_unused:UNUSED_PRESERVE src0_sel:WORD_1
v_fma_mix_f32 v164, v137, v137, v164 op_sel:[1,1,0] op_sel_hi:[1,1,0]
v_smfmac_f32_16x16x32_bf16 v[24:27], v[228:229], v[208:211], v246
ds_read_b128 v[224:227], v249 offset:14336
v_pk_mul_f16 v155, v155, v154
v_fma_mix_f32 v164, v138, v138, v164 op_sel:[0,0,0] op_sel_hi:[1,1,0]
v_pk_mul_f16 v152, v152, v151
v_pk_mul_f16 v149, v149, v148
v_fma_mix_f32 v164, v139, v139, v164 op_sel:[1,1,0] op_sel_hi:[1,1,0]
v_smfmac_f32_16x16x32_bf16 v[40:43], v[230:231], v[212:215], v246
s_mov_b64 exec, 1
ds_add_u32 v253, v254 offset:16
s_mov_b64 exec, -1
v_pk_mul_f16 v146, v146, v145
v_fma_mix_f32 v164, v155, v155, v164 op_sel:[0,0,0] op_sel_hi:[1,1,0]
s_waitcnt lgkmcnt(3)
v_fma_mix_f32 v164, v140, v140, v164 op_sel:[0,0,0] op_sel_hi:[1,1,0]
v_fma_mix_f32 v164, v155, v155, v164 op_sel:[1,1,0] op_sel_hi:[1,1,0]
v_fma_mix_f32 v164, v152, v152, v164 op_sel:[0,0,0] op_sel_hi:[1,1,0]
v_fma_mix_f32 v164, v141, v141, v164 op_sel:[1,1,0] op_sel_hi:[1,1,0]
v_fma_mix_f32 v164, v152, v152, v164 op_sel:[1,1,0] op_sel_hi:[1,1,0]
v_fma_mix_f32 v164, v149, v149, v164 op_sel:[0,0,0] op_sel_hi:[1,1,0]
v_fma_mix_f32 v164, v142, v142, v164 op_sel:[0,0,0] op_sel_hi:[1,1,0]
v_fma_mix_f32 v164, v149, v149, v164 op_sel:[1,1,0] op_sel_hi:[1,1,0]
v_fma_mix_f32 v164, v146, v146, v164 op_sel:[0,0,0] op_sel_hi:[1,1,0]
v_fma_mix_f32 v164, v143, v143, v164 op_sel:[1,1,0] op_sel_hi:[1,1,0]
v_fma_mix_f32 v164, v146, v146, v164 op_sel:[1,1,0] op_sel_hi:[1,1,0]
s_setprio 3
v_pk_add_f32 v[168:169], v[0:1], v[2:3]
v_pk_mul_f32 v[170:171], v[0:1], v[0:1]
v_pk_fma_f32 v[170:171], v[2:3], v[2:3], v[170:171]
v_pk_add_f32 v[168:169], v[168:169], v[4:5]
v_pk_fma_f32 v[170:171], v[4:5], v[4:5], v[170:171]
v_pk_add_f32 v[168:169], v[168:169], v[6:7]
v_pk_fma_f32 v[170:171], v[6:7], v[6:7], v[170:171]
v_pk_add_f32 v[168:169], v[168:169], v[8:9]
v_pk_fma_f32 v[170:171], v[8:9], v[8:9], v[170:171]
v_pk_add_f32 v[168:169], v[168:169], v[10:11]
v_pk_fma_f32 v[170:171], v[10:11], v[10:11], v[170:171]
v_pk_add_f32 v[168:169], v[168:169], v[12:13]
v_pk_fma_f32 v[170:171], v[12:13], v[12:13], v[170:171]
v_pk_add_f32 v[168:169], v[168:169], v[14:15]
v_pk_fma_f32 v[170:171], v[14:15], v[14:15], v[170:171]
v_pk_add_f32 v[168:169], v[168:169], v[16:17]
v_pk_fma_f32 v[170:171], v[16:17], v[16:17], v[170:171]
v_pk_add_f32 v[168:169], v[168:169], v[18:19]
v_pk_fma_f32 v[170:171], v[18:19], v[18:19], v[170:171]
v_pk_add_f32 v[168:169], v[168:169], v[20:21]
v_pk_fma_f32 v[170:171], v[20:21], v[20:21], v[170:171]
v_pk_add_f32 v[168:169], v[168:169], v[22:23]
v_pk_fma_f32 v[170:171], v[22:23], v[22:23], v[170:171]
v_pk_add_f32 v[168:169], v[168:169], v[24:25]
v_pk_fma_f32 v[170:171], v[24:25], v[24:25], v[170:171]
v_pk_add_f32 v[168:169], v[168:169], v[26:27]
v_pk_fma_f32 v[170:171], v[26:27], v[26:27], v[170:171]
v_pk_add_f32 v[168:169], v[168:169], v[28:29]
v_pk_fma_f32 v[170:171], v[28:29], v[28:29], v[170:171]
v_pk_add_f32 v[168:169], v[168:169], v[30:31]
v_pk_fma_f32 v[170:171], v[30:31], v[30:31], v[170:171]
v_pk_add_f32 v[168:169], v[168:169], v[32:33]
v_pk_fma_f32 v[170:171], v[32:33], v[32:33], v[170:171]
v_pk_add_f32 v[168:169], v[168:169], v[34:35]
v_pk_fma_f32 v[170:171], v[34:35], v[34:35], v[170:171]
v_pk_add_f32 v[168:169], v[168:169], v[36:37]
v_pk_fma_f32 v[170:171], v[36:37], v[36:37], v[170:171]
v_pk_add_f32 v[168:169], v[168:169], v[38:39]
v_pk_fma_f32 v[170:171], v[38:39], v[38:39], v[170:171]
v_pk_add_f32 v[168:169], v[168:169], v[40:41]
v_pk_fma_f32 v[170:171], v[40:41], v[40:41], v[170:171]
v_pk_add_f32 v[168:169], v[168:169], v[42:43]
v_pk_fma_f32 v[170:171], v[42:43], v[42:43], v[170:171]
v_pk_add_f32 v[168:169], v[168:169], v[44:45]
v_pk_fma_f32 v[170:171], v[44:45], v[44:45], v[170:171]
v_pk_add_f32 v[168:169], v[168:169], v[46:47]
v_pk_fma_f32 v[170:171], v[46:47], v[46:47], v[170:171]
s_setprio 0
v_add_u32 v174, -36864, v242
v_subrev_u32 v175, 66560, v174
v_min_u32 v174, v174, v175
v_add_u32 v174, 90112, v174
v_sub_u32 v175, v174, v242
v_add_u32 v242, v175, v242
v_add_u32_e64 v243, v175, v243
v_add_u32 v244, v175, v244
s_setprio 2
v_cvt_pkrtz_f16_f32 v137, v120, v121
v_cvt_pkrtz_f16_f32 v139, v122, v123
v_cvt_pkrtz_f16_f32 v141, v124, v125
v_cvt_pkrtz_f16_f32 v143, v126, v127
v_cvt_pkrtz_f16_f32 v145, v128, v129
v_cvt_pk_f16_f32 v155, v130, v131
v_cvt_pk_f16_f32 v152, v132, v133
v_cvt_pk_f16_f32 v149, v134, v135
ds_read_b128 v[228:231], v249 offset:17408
v_mfma_f32_32x32x16_bf16 v[120:135], v[72:75], v[232:235], 0
v_pk_fma_f16 v154, v155, v155, s48
v_add_f32 v168, v168, v169
v_and_b32 v137, s49, v137
v_pk_fma_f16 v151, v152, v152, s48
v_and_b32_e64 v139, s49, v139
v_pk_fma_f16 v148, v149, v149, s48
v_add_f32_e64 v170, v170, v171
v_pk_mul_f16 v154, v155, v154
v_bfe_u32 v136, v137, 2, 14
v_pk_mul_f16 v151, v152, v151
v_pk_mul_f16 v148, v149, v148
v_bfe_u32 v138, v139, 2, 14
ds_read_b128 v[232:235], v249 offset:18432
ds_read_u16_d16 v136, v136
ds_read_u16_d16 v138, v138
v_mfma_f32_32x32x16_bf16 v[120:135], v[76:79], v[236:239], v[120:135]
v_permlane32_swap_b32 v168, v170
v_exp_f16 v153, v154
v_lshrrev_b32 v137, 18, v137
v_exp_f16 v150, v151
v_add_f32 v168, v168, v170
v_lshrrev_b32 v139, 18, v139
v_exp_f16 v147, v148
v_and_b32 v141, s49, v141
v_and_b32_e64 v143, s49, v143
v_mul_f32 v168, 1009429163, v168
ds_read_b128 v[236:239], v249 offset:21504
ds_read_u16_d16_hi v137, v137
ds_read_u16_d16_hi v139, v139
v_mfma_f32_32x32x16_bf16 v[120:135], v[80:83], v[216:219], v[120:135]
v_exp_f16_sdwa v153, v154 dst_sel:WORD_1 dst_unused:UNUSED_PRESERVE src0_sel:WORD_1
v_bfe_u32 v140, v141, 2, 14
v_exp_f16_sdwa v150, v151 dst_sel:WORD_1 dst_unused:UNUSED_PRESERVE src0_sel:WORD_1
v_mov_b32_e64 v170, v168
v_bfe_u32 v142, v143, 2, 14
v_exp_f16_sdwa v147, v148 dst_sel:WORD_1 dst_unused:UNUSED_PRESERVE src0_sel:WORD_1
v_lshrrev_b32_e64 v141, 18, v141
v_permlane32_swap_b32 v168, v170
v_pk_add_f16 v153, v153, 1.0 op_sel_hi:[1,0]
s_waitcnt lgkmcnt(8)
ds_read_b128 v[216:219], v249 offset:19456
ds_read_u16_d16 v140, v140
ds_read_u16_d16 v142, v142
ds_read_u16_d16_hi v141, v141
v_mfma_f32_32x32x16_bf16 v[120:135], v[84:87], v[220:223], v[120:135]
v_lshrrev_b32_e64 v143, 18, v143
v_pk_add_f16 v150, v150, 1.0 op_sel_hi:[1,0]
v_pk_add_f16 v147, v147, 1.0 op_sel_hi:[1,0]
v_and_b32_e64 v145, s49, v145
v_fma_f32 v170, -v168, v168, v170
v_rcp_f16_e64 v154, v153
v_bfe_u32 v144, v145, 2, 14
v_rcp_f16 v151, v150
v_max_f32 v170, 0, v170
v_lshrrev_b32_e64 v145, 18, v145
ds_read_b128 v[220:223], v249 offset:22528
ds_read_u16_d16_hi v143, v143
ds_read_u16_d16 v144, v144
ds_read_u16_d16_hi v145, v145
v_mfma_f32_32x32x16_bf16 v[120:135], v[88:91], v[224:227], v[120:135]
v_rcp_f16 v148, v147
v_rcp_f16_sdwa v154, v153 dst_sel:WORD_1 dst_unused:UNUSED_PRESERVE src0_sel:WORD_1
v_add_f32 v170, 925353388, v170
s_waitcnt lgkmcnt(8)
v_fma_mix_f32 v165, v136, v136, v165 op_sel:[0,0,0] op_sel_hi:[1,1,0]
ds_read_b32 v247, v253 offset:16
v_fma_mix_f32 v165, v137, v137, v165 op_sel:[1,1,0] op_sel_hi:[1,1,0]
v_rcp_f16_sdwa v151, v150 dst_sel:WORD_1 dst_unused:UNUSED_PRESERVE src0_sel:WORD_1
v_rsq_f32_e64 v170, v170
v_fma_mix_f32 v165, v138, v138, v165 op_sel:[0,0,0] op_sel_hi:[1,1,0]
ds_read_b128 v[224:227], v249 offset:20480
v_mfma_f32_32x32x16_bf16 v[120:135], v[92:95], v[228:231], v[120:135]
v_rcp_f16_sdwa v148, v147 dst_sel:WORD_1 dst_unused:UNUSED_PRESERVE src0_sel:WORD_1
v_fma_mix_f32 v165, v139, v139, v165 op_sel:[1,1,0] op_sel_hi:[1,1,0]
v_pk_mul_f16 v155, v155, v154
s_waitcnt lgkmcnt(6)
v_fma_mix_f32 v165, v140, v140, v165 op_sel:[0,0,0] op_sel_hi:[1,1,0]
v_pk_mul_f16 v152, v152, v151
v_fma_mix_f32 v165, v141, v141, v165 op_sel:[1,1,0] op_sel_hi:[1,1,0]
v_pk_mul_f16 v149, v149, v148
v_fma_mix_f32 v165, v155, v155, v165 op_sel:[0,0,0] op_sel_hi:[1,1,0]
v_mul_f32 v172, 3203391086, v170
v_fma_mix_f32 v165, v142, v142, v165 op_sel:[0,0,0] op_sel_hi:[1,1,0]
v_fma_mix_f32 v165, v155, v155, v165 op_sel:[1,1,0] op_sel_hi:[1,1,0]
s_waitcnt lgkmcnt(2)
v_fma_mix_f32 v165, v143, v143, v165 op_sel:[1,1,0] op_sel_hi:[1,1,0]
v_fma_mix_f32 v165, v152, v152, v165 op_sel:[0,0,0] op_sel_hi:[1,1,0]
v_fma_mix_f32 v165, v152, v152, v165 op_sel:[1,1,0] op_sel_hi:[1,1,0]
v_mul_f32 v173, v168, v172
v_fma_mix_f32 v165, v144, v144, v165 op_sel:[0,0,0] op_sel_hi:[1,1,0]
v_fma_mix_f32 v165, v149, v149, v165 op_sel:[0,0,0] op_sel_hi:[1,1,0]
v_fma_mix_f32 v165, v145, v145, v165 op_sel:[1,1,0] op_sel_hi:[1,1,0]
v_fma_mix_f32 v165, v149, v149, v165 op_sel:[1,1,0] op_sel_hi:[1,1,0]
s_setprio 3
v_pk_fma_f32 v[0:1], v[0:1], v[172:173], v[172:173] op_sel:[0,0,1] op_sel_hi:[1,0,1] neg_lo:[0,0,1] neg_hi:[0,0,1]
v_pk_fma_f32 v[2:3], v[2:3], v[172:173], v[172:173] op_sel:[0,0,1] op_sel_hi:[1,0,1] neg_lo:[0,0,1] neg_hi:[0,0,1]
v_pk_fma_f32 v[4:5], v[4:5], v[172:173], v[172:173] op_sel:[0,0,1] op_sel_hi:[1,0,1] neg_lo:[0,0,1] neg_hi:[0,0,1]
v_pk_fma_f32 v[6:7], v[6:7], v[172:173], v[172:173] op_sel:[0,0,1] op_sel_hi:[1,0,1] neg_lo:[0,0,1] neg_hi:[0,0,1]
v_pk_fma_f32 v[8:9], v[8:9], v[172:173], v[172:173] op_sel:[0,0,1] op_sel_hi:[1,0,1] neg_lo:[0,0,1] neg_hi:[0,0,1]
v_pk_fma_f32 v[10:11], v[10:11], v[172:173], v[172:173] op_sel:[0,0,1] op_sel_hi:[1,0,1] neg_lo:[0,0,1] neg_hi:[0,0,1]
v_pk_fma_f32 v[12:13], v[12:13], v[172:173], v[172:173] op_sel:[0,0,1] op_sel_hi:[1,0,1] neg_lo:[0,0,1] neg_hi:[0,0,1]
v_pk_fma_f32 v[14:15], v[14:15], v[172:173], v[172:173] op_sel:[0,0,1] op_sel_hi:[1,0,1] neg_lo:[0,0,1] neg_hi:[0,0,1]
v_pk_fma_f32 v[16:17], v[16:17], v[172:173], v[172:173] op_sel:[0,0,1] op_sel_hi:[1,0,1] neg_lo:[0,0,1] neg_hi:[0,0,1]
v_pk_fma_f32 v[18:19], v[18:19], v[172:173], v[172:173] op_sel:[0,0,1] op_sel_hi:[1,0,1] neg_lo:[0,0,1] neg_hi:[0,0,1]
v_pk_fma_f32 v[20:21], v[20:21], v[172:173], v[172:173] op_sel:[0,0,1] op_sel_hi:[1,0,1] neg_lo:[0,0,1] neg_hi:[0,0,1]
v_pk_fma_f32 v[22:23], v[22:23], v[172:173], v[172:173] op_sel:[0,0,1] op_sel_hi:[1,0,1] neg_lo:[0,0,1] neg_hi:[0,0,1]
v_pk_fma_f32 v[24:25], v[24:25], v[172:173], v[172:173] op_sel:[0,0,1] op_sel_hi:[1,0,1] neg_lo:[0,0,1] neg_hi:[0,0,1]
v_pk_fma_f32 v[26:27], v[26:27], v[172:173], v[172:173] op_sel:[0,0,1] op_sel_hi:[1,0,1] neg_lo:[0,0,1] neg_hi:[0,0,1]
v_pk_fma_f32 v[28:29], v[28:29], v[172:173], v[172:173] op_sel:[0,0,1] op_sel_hi:[1,0,1] neg_lo:[0,0,1] neg_hi:[0,0,1]
v_pk_fma_f32 v[30:31], v[30:31], v[172:173], v[172:173] op_sel:[0,0,1] op_sel_hi:[1,0,1] neg_lo:[0,0,1] neg_hi:[0,0,1]
v_pk_fma_f32 v[32:33], v[32:33], v[172:173], v[172:173] op_sel:[0,0,1] op_sel_hi:[1,0,1] neg_lo:[0,0,1] neg_hi:[0,0,1]
v_pk_fma_f32 v[34:35], v[34:35], v[172:173], v[172:173] op_sel:[0,0,1] op_sel_hi:[1,0,1] neg_lo:[0,0,1] neg_hi:[0,0,1]
v_pk_fma_f32 v[36:37], v[36:37], v[172:173], v[172:173] op_sel:[0,0,1] op_sel_hi:[1,0,1] neg_lo:[0,0,1] neg_hi:[0,0,1]
v_pk_fma_f32 v[38:39], v[38:39], v[172:173], v[172:173] op_sel:[0,0,1] op_sel_hi:[1,0,1] neg_lo:[0,0,1] neg_hi:[0,0,1]
v_pk_fma_f32 v[40:41], v[40:41], v[172:173], v[172:173] op_sel:[0,0,1] op_sel_hi:[1,0,1] neg_lo:[0,0,1] neg_hi:[0,0,1]
v_pk_fma_f32 v[42:43], v[42:43], v[172:173], v[172:173] op_sel:[0,0,1] op_sel_hi:[1,0,1] neg_lo:[0,0,1] neg_hi:[0,0,1]
v_pk_fma_f32 v[44:45], v[44:45], v[172:173], v[172:173] op_sel:[0,0,1] op_sel_hi:[1,0,1] neg_lo:[0,0,1] neg_hi:[0,0,1]
v_pk_fma_f32 v[46:47], v[46:47], v[172:173], v[172:173] op_sel:[0,0,1] op_sel_hi:[1,0,1] neg_lo:[0,0,1] neg_hi:[0,0,1]
s_setprio 2
s_waitcnt lgkmcnt(0)
v_readfirstlane_b32 s43, v247
s_nop 1
s_cmp_ge_u32 s43, 24
s_cbranch_scc1 Lev6
Lev6w:
s_sleep 1
ds_read_b32 v247, v253 offset:16
s_waitcnt lgkmcnt(0)
v_readfirstlane_b32 s43, v247
s_cmp_eq_u32 s76, 0
s_cbranch_scc1 Lev6
s_sub_u32 s76, s76, 1
s_cmp_lt_u32 s43, 24
s_cbranch_scc1 Lev6w
Lev6:
s_setprio 1
v_cvt_pkrtz_f16_f32 v137, v120, v121
v_cvt_pkrtz_f16_f32 v139, v122, v123
v_cvt_pkrtz_f16_f32 v141, v124, v125
v_cvt_pkrtz_f16_f32 v143, v126, v127
v_cvt_pkrtz_f16_f32 v145, v128, v129
v_cvt_pk_f16_f32 v155, v130, v131
v_cvt_pk_f16_f32 v152, v132, v133
v_cvt_pk_f16_f32 v149, v134, v135
s_add_u32 m0, s67, 39936
s_add_u32 s66, s66, 98304
buffer_load_dwordx4 v240, s[4:7], s66 offen lds
ds_read_b128 v[228:231], v249 offset:23552
v_mfma_f32_32x32x16_bf16 v[120:135], v[72:75], v[232:235], 0
v_pk_fma_f16 v154, v155, v155, s48
v_cvt_pk_bf16_f32 v96, v0, v1
v_and_b32 v137, s49, v137
v_pk_fma_f16 v151, v152, v152, s48
v_cvt_pk_bf16_f32 v97, v2, v3
v_and_b32_e64 v139, s49, v139
v_pk_fma_f16 v148, v149, v149, s48
v_pk_mul_f16 v154, v155, v154
v_cvt_pk_bf16_f32 v98, v4, v5
v_bfe_u32 v136, v137, 2, 14
v_pk_mul_f16 v151, v152, v151
v_pk_mul_f16 v148, v149, v148
v_cvt_pk_bf16_f32 v99, v6, v7
v_bfe_u32 v138, v139, 2, 14
s_add_u32 m0, s67, 46592
s_add_u32 s66, s66, 98304
buffer_load_dwordx4 v240, s[4:7], s66 offen lds
ds_read_b128 v[232:235], v248 offset:16384
ds_read_u16_d16 v136, v136
ds_read_u16_d16 v138, v138
v_mfma_f32_32x32x16_bf16 v[120:135], v[76:79], v[236:239], v[120:135]
v_exp_f16_e64 v153, v154
v_cvt_pk_bf16_f32 v100, v8, v9
v_lshrrev_b32 v137, 18, v137
v_exp_f16 v150, v151
v_cvt_pk_bf16_f32 v101, v10, v11
v_lshrrev_b32 v139, 18, v139
v_exp_f16 v147, v148
v_cvt_pk_bf16_f32 v102, v12, v13
v_and_b32 v141, s49, v141
v_and_b32 v143, s49, v143
v_cvt_pk_bf16_f32 v103, v14, v15
s_add_u32 m0, s67, 53248
s_add_u32 s66, s66, 98304
buffer_load_dwordx4 v240, s[4:7], s66 offen lds
ds_read_b128 v[236:239], v248 offset:19456
ds_read_u16_d16_hi v137, v137
ds_read_u16_d16_hi v139, v139
v_mfma_f32_32x32x16_bf16 v[120:135], v[80:83], v[216:219], v[120:135]
v_exp_f16_sdwa v153, v154 dst_sel:WORD_1 dst_unused:UNUSED_PRESERVE src0_sel:WORD_1
v_bfe_u32 v140, v141, 2, 14
v_cvt_pk_bf16_f32 v104, v16, v17
v_exp_f16_sdwa v150, v151 dst_sel:WORD_1 dst_unused:UNUSED_PRESERVE src0_sel:WORD_1
v_bfe_u32 v142, v143, 2, 14
v_cvt_pk_bf16_f32 v105, v18, v19
v_exp_f16_sdwa v147, v148 dst_sel:WORD_1 dst_unused:UNUSED_PRESERVE src0_sel:WORD_1
v_cvt_pk_bf16_f32 v106, v20, v21
v_lshrrev_b32_e64 v141, 18, v141
v_pk_add_f16 v153, v153, 1.0 op_sel_hi:[1,0]
v_lshrrev_b32 v143, 18, v143
s_add_u32 m0, s67, 59904
s_add_u32 s66, s66, 98304
buffer_load_dwordx4 v240, s[4:7], s66 offen lds
s_add_u32 m0, s67, 0
s_add_u32 s66, s66, 98304
buffer_load_dwordx4 v240, s[4:7], s66 offen lds
ds_read_b128 v[216:219], v248 offset:17408
ds_read_u16_d16 v140, v140
ds_read_u16_d16 v142, v142
ds_read_u16_d16_hi v141, v141
ds_read_u16_d16_hi v143, v143
v_mfma_f32_32x32x16_bf16 v[120:135], v[84:87], v[220:223], v[120:135]
v_cvt_pk_bf16_f32 v107, v22, v23
v_pk_add_f16 v150, v150, 1.0 op_sel_hi:[1,0]
v_pk_add_f16 v147, v147, 1.0 op_sel_hi:[1,0]
v_and_b32_e64 v145, s49, v145
v_cvt_pk_bf16_f32 v108, v24, v25
v_rcp_f16_e64 v154, v153
v_bfe_u32 v144, v145, 2, 14
v_cvt_pk_bf16_f32 v109, v26, v27
v_rcp_f16 v151, v150
v_lshrrev_b32 v145, 18, v145
v_cvt_pk_bf16_f32 v110, v28, v29
s_add_u32 m0, s67, 6656
s_add_u32 s66, s66, 98304
buffer_load_dwordx4 v240, s[4:7], s66 offen lds
ds_read_b128 v[220:223], v248 offset:20480
ds_read_u16_d16 v144, v144
ds_read_u16_d16_hi v145, v145
v_mfma_f32_32x32x16_bf16 v[120:135], v[88:91], v[224:227], v[120:135]
v_rcp_f16_e64 v148, v147
v_cvt_pk_bf16_f32 v111, v30, v31
v_rcp_f16_sdwa v154, v153 dst_sel:WORD_1 dst_unused:UNUSED_PRESERVE src0_sel:WORD_1
s_waitcnt lgkmcnt(5)
v_fma_mix_f32 v166, v136, v136, v166 op_sel:[0,0,0] op_sel_hi:[1,1,0]
v_cvt_pk_bf16_f32 v112, v32, v33
s_setprio 0
v_fma_mix_f32 v166, v137, v137, v166 op_sel:[1,1,0] op_sel_hi:[1,1,0]
v_rcp_f16_sdwa v151, v150 dst_sel:WORD_1 dst_unused:UNUSED_PRESERVE src0_sel:WORD_1
v_cvt_pk_bf16_f32 v113, v34, v35
v_fma_mix_f32 v166, v138, v138, v166 op_sel:[0,0,0] op_sel_hi:[1,1,0]
v_rcp_f16_sdwa v148, v147 dst_sel:WORD_1 dst_unused:UNUSED_PRESERVE src0_sel:WORD_1
v_cvt_pk_bf16_f32 v114, v36, v37
s_add_u32 m0, s67, 13312
s_add_u32 s66, s66, 98304
buffer_load_dwordx4 v240, s[4:7], s66 offen lds
ds_read_b128 v[224:227], v248 offset:18432
v_mfma_f32_32x32x16_bf16 v[120:135], v[92:95], v[228:231], v[120:135]
v_fma_mix_f32 v166, v139, v139, v166 op_sel:[1,1,0] op_sel_hi:[1,1,0]
v_pk_mul_f16 v155, v155, v154
v_fma_mix_f32 v166, v140, v140, v166 op_sel:[0,0,0] op_sel_hi:[1,1,0]
v_cvt_pk_bf16_f32 v115, v38, v39
v_pk_mul_f16 v152, v152, v151
s_waitcnt lgkmcnt(1)
v_fma_mix_f32 v166, v141, v141, v166 op_sel:[1,1,0] op_sel_hi:[1,1,0]
v_cvt_pk_bf16_f32 v116, v40, v41
v_pk_mul_f16 v149, v149, v148
v_fma_mix_f32 v166, v155, v155, v166 op_sel:[0,0,0] op_sel_hi:[1,1,0]
v_fma_mix_f32 v166, v142, v142, v166 op_sel:[0,0,0] op_sel_hi:[1,1,0]
v_cvt_pk_bf16_f32 v117, v42, v43
v_fma_mix_f32 v166, v155, v155, v166 op_sel:[1,1,0] op_sel_hi:[1,1,0]
v_fma_mix_f32 v166, v143, v143, v166 op_sel:[1,1,0] op_sel_hi:[1,1,0]
v_fma_mix_f32 v166, v152, v152, v166 op_sel:[0,0,0] op_sel_hi:[1,1,0]
s_add_u32 m0, s67, 19968
s_add_u32 s66, s66, 98304
buffer_load_dwordx4 v240, s[4:7], s66 offen lds
v_cvt_pk_bf16_f32 v118, v44, v45
v_fma_mix_f32 v166, v152, v152, v166 op_sel:[1,1,0] op_sel_hi:[1,1,0]
v_fma_mix_f32 v166, v144, v144, v166 op_sel:[0,0,0] op_sel_hi:[1,1,0]
v_fma_mix_f32 v166, v149, v149, v166 op_sel:[0,0,0] op_sel_hi:[1,1,0]
v_cvt_pk_bf16_f32 v119, v46, v47
v_fma_mix_f32 v166, v145, v145, v166 op_sel:[1,1,0] op_sel_hi:[1,1,0]
v_fma_mix_f32 v166, v149, v149, v166 op_sel:[1,1,0] op_sel_hi:[1,1,0]
s_setprio 2
v_cvt_pkrtz_f16_f32 v137, v120, v121
v_cvt_pkrtz_f16_f32 v139, v122, v123
v_cvt_pkrtz_f16_f32 v141, v124, v125
v_cvt_pkrtz_f16_f32 v143, v126, v127
v_cvt_pkrtz_f16_f32 v145, v128, v129
v_cvt_pk_f16_f32 v155, v130, v131
v_cvt_pk_f16_f32 v152, v132, v133
v_cvt_pk_f16_f32 v149, v134, v135
ds_read_b128 v[228:231], v248 offset:21504
v_mfma_f32_32x32x16_bf16 v[120:135], v[96:99], v[232:235], 0
v_pk_fma_f16 v154, v155, v155, s48
v_and_b32_e64 v137, s49, v137
v_pk_fma_f16 v151, v152, v152, s48
v_and_b32_e64 v139, s49, v139
v_pk_fma_f16 v148, v149, v149, s48
v_pk_mul_f16 v154, v155, v154
v_bfe_u32 v136, v137, 2, 14
v_pk_mul_f16 v151, v152, v151
v_pk_mul_f16 v148, v149, v148
v_bfe_u32 v138, v139, 2, 14
ds_read_b128 v[232:235], v248 offset:22528
ds_read_u16_d16 v136, v136
ds_read_u16_d16 v138, v138
v_mfma_f32_32x32x16_bf16 v[120:135], v[100:103], v[236:239], v[120:135]
v_exp_f16 v153, v154
v_lshrrev_b32 v137, 18, v137
v_exp_f16 v150, v151
v_lshrrev_b32 v139, 18, v139
v_exp_f16 v147, v148
v_and_b32 v141, s49, v141
v_and_b32_e64 v143, s49, v143
ds_read_b128 v[236:239], v248 offset:25600
ds_read_u16_d16_hi v137, v137
ds_read_u16_d16_hi v139, v139
v_mfma_f32_32x32x16_bf16 v[120:135], v[104:107], v[216:219], v[120:135]
v_exp_f16_sdwa v153, v154 dst_sel:WORD_1 dst_unused:UNUSED_PRESERVE src0_sel:WORD_1
v_bfe_u32 v140, v141, 2, 14
v_exp_f16_sdwa v150, v151 dst_sel:WORD_1 dst_unused:UNUSED_PRESERVE src0_sel:WORD_1
v_bfe_u32 v142, v143, 2, 14
v_exp_f16_sdwa v147, v148 dst_sel:WORD_1 dst_unused:UNUSED_PRESERVE src0_sel:WORD_1
v_lshrrev_b32_e64 v141, 18, v141
v_pk_add_f16 v153, v153, 1.0 op_sel_hi:[1,0]
ds_read_b128 v[216:219], v248 offset:23552
ds_read_u16_d16 v140, v140
ds_read_u16_d16 v142, v142
ds_read_u16_d16_hi v141, v141
v_mfma_f32_32x32x16_bf16 v[120:135], v[108:111], v[220:223], v[120:135]
v_lshrrev_b32_e64 v143, 18, v143
v_pk_add_f16 v150, v150, 1.0 op_sel_hi:[1,0]
v_pk_add_f16 v147, v147, 1.0 op_sel_hi:[1,0]
v_and_b32 v145, s49, v145
v_rcp_f16 v154, v153
v_bfe_u32 v144, v145, 2, 14
v_rcp_f16_e64 v151, v150
v_lshrrev_b32 v145, 18, v145
s_waitcnt lgkmcnt(7)
ds_read_b128 v[220:223], v248 offset:26624
ds_read_u16_d16_hi v143, v143
ds_read_u16_d16 v144, v144
ds_read_u16_d16_hi v145, v145
v_mfma_f32_32x32x16_bf16 v[120:135], v[112:115], v[224:227], v[120:135]
v_rcp_f16_e64 v148, v147
v_rcp_f16_sdwa v154, v153 dst_sel:WORD_1 dst_unused:UNUSED_PRESERVE src0_sel:WORD_1
v_fma_mix_f32 v167, v136, v136, v167 op_sel:[0,0,0] op_sel_hi:[1,1,0]
s_waitcnt lgkmcnt(8)
v_fma_mix_f32 v167, v137, v137, v167 op_sel:[1,1,0] op_sel_hi:[1,1,0]
v_rcp_f16_sdwa v151, v150 dst_sel:WORD_1 dst_unused:UNUSED_PRESERVE src0_sel:WORD_1
v_fma_mix_f32 v167, v138, v138, v167 op_sel:[0,0,0] op_sel_hi:[1,1,0]
ds_read_b128 v[224:227], v248 offset:24576
v_mfma_f32_32x32x16_bf16 v[120:135], v[116:119], v[228:231], v[120:135]
v_rcp_f16_sdwa v148, v147 dst_sel:WORD_1 dst_unused:UNUSED_PRESERVE src0_sel:WORD_1
v_fma_mix_f32 v167, v139, v139, v167 op_sel:[1,1,0] op_sel_hi:[1,1,0]
v_pk_mul_f16 v155, v155, v154
s_waitcnt lgkmcnt(5)
v_fma_mix_f32 v167, v140, v140, v167 op_sel:[0,0,0] op_sel_hi:[1,1,0]
v_pk_mul_f16 v152, v152, v151
v_fma_mix_f32 v167, v141, v141, v167 op_sel:[1,1,0] op_sel_hi:[1,1,0]
v_pk_mul_f16 v149, v149, v148
v_fma_mix_f32 v167, v155, v155, v167 op_sel:[0,0,0] op_sel_hi:[1,1,0]
v_fma_mix_f32 v167, v142, v142, v167 op_sel:[0,0,0] op_sel_hi:[1,1,0]
v_fma_mix_f32 v167, v155, v155, v167 op_sel:[1,1,0] op_sel_hi:[1,1,0]
s_waitcnt lgkmcnt(3)
v_fma_mix_f32 v167, v143, v143, v167 op_sel:[1,1,0] op_sel_hi:[1,1,0]
v_fma_mix_f32 v167, v152, v152, v167 op_sel:[0,0,0] op_sel_hi:[1,1,0]
v_fma_mix_f32 v167, v152, v152, v167 op_sel:[1,1,0] op_sel_hi:[1,1,0]
s_waitcnt lgkmcnt(1)
v_fma_mix_f32 v167, v144, v144, v167 op_sel:[0,0,0] op_sel_hi:[1,1,0]
v_fma_mix_f32 v167, v149, v149, v167 op_sel:[0,0,0] op_sel_hi:[1,1,0]
v_fma_mix_f32 v167, v145, v145, v167 op_sel:[1,1,0] op_sel_hi:[1,1,0]
v_fma_mix_f32 v167, v149, v149, v167 op_sel:[1,1,0] op_sel_hi:[1,1,0]
s_cmp_lg_u32 s40, 7
s_cbranch_scc1 Lnoinit
s_waitcnt vmcnt(13)
v_mov_b32_e64 v255, 1
s_mov_b64 exec, 1
buffer_atomic_add v255, v241, s[36:39], 0 offen
s_mov_b64 exec, -1
Lnoinit:
s_setprio 1
v_cvt_pkrtz_f16_f32 v137, v120, v121
v_cvt_pkrtz_f16_f32 v139, v122, v123
v_cvt_pkrtz_f16_f32 v141, v124, v125
v_cvt_pkrtz_f16_f32 v143, v126, v127
v_cvt_pkrtz_f16_f32 v145, v128, v129
v_cvt_pk_f16_f32 v155, v130, v131
v_cvt_pk_f16_f32 v152, v132, v133
v_cvt_pk_f16_f32 v149, v134, v135
ds_read_b128 v[228:231], v248 offset:27648
v_mfma_f32_32x32x16_bf16 v[120:135], v[96:99], v[232:235], 0
v_pk_fma_f16 v154, v155, v155, s48
v_and_b32_e64 v137, s49, v137
v_pk_fma_f16 v151, v152, v152, s48
v_and_b32_e64 v139, s49, v139
v_pk_fma_f16 v148, v149, v149, s48
v_pk_mul_f16 v154, v155, v154
v_bfe_u32 v136, v137, 2, 14
v_pk_mul_f16 v151, v152, v151
v_pk_mul_f16 v148, v149, v148
v_bfe_u32 v138, v139, 2, 14
ds_read_b128 v[232:235], v248 offset:28672
ds_read_u16_d16 v136, v136
ds_read_u16_d16 v138, v138
v_mfma_f32_32x32x16_bf16 v[120:135], v[100:103], v[236:239], v[120:135]
v_exp_f16 v153, v154
v_lshrrev_b32 v137, 18, v137
v_exp_f16 v150, v151
v_lshrrev_b32 v139, 18, v139
v_exp_f16 v147, v148
v_and_b32 v141, s49, v141
v_and_b32_e64 v143, s49, v143
ds_read_b128 v[236:239], v248 offset:31744
ds_read_u16_d16_hi v137, v137
ds_read_u16_d16_hi v139, v139
v_mfma_f32_32x32x16_bf16 v[120:135], v[104:107], v[216:219], v[120:135]
v_exp_f16_sdwa v153, v154 dst_sel:WORD_1 dst_unused:UNUSED_PRESERVE src0_sel:WORD_1
v_bfe_u32 v140, v141, 2, 14
v_exp_f16_sdwa v150, v151 dst_sel:WORD_1 dst_unused:UNUSED_PRESERVE src0_sel:WORD_1
v_bfe_u32 v142, v143, 2, 14
v_exp_f16_sdwa v147, v148 dst_sel:WORD_1 dst_unused:UNUSED_PRESERVE src0_sel:WORD_1
v_lshrrev_b32_e64 v141, 18, v141
v_pk_add_f16 v153, v153, 1.0 op_sel_hi:[1,0]
ds_read_b128 v[216:219], v248 offset:29696
ds_read_u16_d16 v140, v140
ds_read_u16_d16 v142, v142
ds_read_u16_d16_hi v141, v141
v_mfma_f32_32x32x16_bf16 v[120:135], v[108:111], v[220:223], v[120:135]
v_lshrrev_b32_e64 v143, 18, v143
v_pk_add_f16 v150, v150, 1.0 op_sel_hi:[1,0]
v_pk_add_f16 v147, v147, 1.0 op_sel_hi:[1,0]
v_and_b32 v145, s49, v145
v_rcp_f16 v154, v153
v_bfe_u32 v144, v145, 2, 14
v_rcp_f16_e64 v151, v150
v_lshrrev_b32 v145, 18, v145
s_waitcnt lgkmcnt(7)
ds_read_b128 v[220:223], v248 offset:32768
ds_read_u16_d16_hi v143, v143
ds_read_u16_d16 v144, v144
ds_read_u16_d16_hi v145, v145
v_mfma_f32_32x32x16_bf16 v[120:135], v[112:115], v[224:227], v[120:135]
v_rcp_f16_e64 v148, v147
v_rcp_f16_sdwa v154, v153 dst_sel:WORD_1 dst_unused:UNUSED_PRESERVE src0_sel:WORD_1
v_fma_mix_f32 v156, v136, v136, v156 op_sel:[0,0,0] op_sel_hi:[1,1,0]
s_setprio 0
s_waitcnt lgkmcnt(8)
v_fma_mix_f32 v156, v137, v137, v156 op_sel:[1,1,0] op_sel_hi:[1,1,0]
v_rcp_f16_sdwa v151, v150 dst_sel:WORD_1 dst_unused:UNUSED_PRESERVE src0_sel:WORD_1
v_fma_mix_f32 v156, v138, v138, v156 op_sel:[0,0,0] op_sel_hi:[1,1,0]
ds_read_b128 v[224:227], v248 offset:30720
v_mfma_f32_32x32x16_bf16 v[120:135], v[116:119], v[228:231], v[120:135]
v_rcp_f16_sdwa v148, v147 dst_sel:WORD_1 dst_unused:UNUSED_PRESERVE src0_sel:WORD_1
v_fma_mix_f32 v156, v139, v139, v156 op_sel:[1,1,0] op_sel_hi:[1,1,0]
v_pk_mul_f16 v155, v155, v154
s_cmp_eq_u32 s40, 7
s_cbranch_scc1 Lrdy24
s_waitcnt vmcnt(0)
Lrdy24:
s_mov_b64 exec, 1
ds_add_u32 v253, v254 offset:12
s_mov_b64 exec, -1
s_waitcnt lgkmcnt(6)
v_fma_mix_f32 v156, v140, v140, v156 op_sel:[0,0,0] op_sel_hi:[1,1,0]
v_pk_mul_f16 v152, v152, v151
v_fma_mix_f32 v156, v141, v141, v156 op_sel:[1,1,0] op_sel_hi:[1,1,0]
v_pk_mul_f16 v149, v149, v148
v_fma_mix_f32 v156, v155, v155, v156 op_sel:[0,0,0] op_sel_hi:[1,1,0]
v_fma_mix_f32 v156, v142, v142, v156 op_sel:[0,0,0] op_sel_hi:[1,1,0]
v_fma_mix_f32 v156, v155, v155, v156 op_sel:[1,1,0] op_sel_hi:[1,1,0]
s_waitcnt lgkmcnt(2)
v_fma_mix_f32 v156, v143, v143, v156 op_sel:[1,1,0] op_sel_hi:[1,1,0]
v_fma_mix_f32 v156, v152, v152, v156 op_sel:[0,0,0] op_sel_hi:[1,1,0]
v_fma_mix_f32 v156, v152, v152, v156 op_sel:[1,1,0] op_sel_hi:[1,1,0]
v_fma_mix_f32 v156, v144, v144, v156 op_sel:[0,0,0] op_sel_hi:[1,1,0]
v_fma_mix_f32 v156, v149, v149, v156 op_sel:[0,0,0] op_sel_hi:[1,1,0]
v_fma_mix_f32 v156, v145, v145, v156 op_sel:[1,1,0] op_sel_hi:[1,1,0]
v_fma_mix_f32 v156, v149, v149, v156 op_sel:[1,1,0] op_sel_hi:[1,1,0]
s_setprio 2
v_cvt_pkrtz_f16_f32 v137, v120, v121
v_cvt_pkrtz_f16_f32 v139, v122, v123
v_cvt_pkrtz_f16_f32 v141, v124, v125
v_cvt_pkrtz_f16_f32 v143, v126, v127
v_cvt_pkrtz_f16_f32 v145, v128, v129
v_cvt_pk_f16_f32 v155, v130, v131
v_cvt_pk_f16_f32 v152, v132, v133
v_cvt_pk_f16_f32 v149, v134, v135
ds_read_b128 v[228:231], v248 offset:33792
v_mfma_f32_32x32x16_bf16 v[120:135], v[96:99], v[232:235], 0
v_pk_fma_f16 v154, v155, v155, s48
v_and_b32_e64 v137, s49, v137
v_pk_fma_f16 v151, v152, v152, s48
v_and_b32_e64 v139, s49, v139
v_pk_fma_f16 v148, v149, v149, s48
v_pk_mul_f16 v154, v155, v154
v_bfe_u32 v136, v137, 2, 14
v_pk_mul_f16 v151, v152, v151
v_pk_mul_f16 v148, v149, v148
v_bfe_u32 v138, v139, 2, 14
ds_read_b128 v[232:235], v250 offset:65520
ds_read_u16_d16 v136, v136
ds_read_u16_d16 v138, v138
v_mfma_f32_32x32x16_bf16 v[120:135], v[100:103], v[236:239], v[120:135]
v_exp_f16 v153, v154
v_lshrrev_b32 v137, 18, v137
v_exp_f16 v150, v151
v_lshrrev_b32 v139, 18, v139
v_exp_f16 v147, v148
v_and_b32 v141, s49, v141
v_and_b32_e64 v143, s49, v143
ds_read_b128 v[236:239], v248 offset:34816
ds_read_u16_d16_hi v137, v137
ds_read_b32 v247, v253 offset:12
ds_read_u16_d16_hi v139, v139
v_mfma_f32_32x32x16_bf16 v[120:135], v[104:107], v[216:219], v[120:135]
v_exp_f16_sdwa v153, v154 dst_sel:WORD_1 dst_unused:UNUSED_PRESERVE src0_sel:WORD_1
v_bfe_u32 v140, v141, 2, 14
v_exp_f16_sdwa v150, v151 dst_sel:WORD_1 dst_unused:UNUSED_PRESERVE src0_sel:WORD_1
v_bfe_u32 v142, v143, 2, 14
v_exp_f16_sdwa v147, v148 dst_sel:WORD_1 dst_unused:UNUSED_PRESERVE src0_sel:WORD_1
v_lshrrev_b32_e64 v141, 18, v141
v_pk_add_f16 v153, v153, 1.0 op_sel_hi:[1,0]
ds_read_b128 v[216:219], v248 offset:37888
ds_read_u16_d16 v140, v140
ds_read_u16_d16 v142, v142
ds_read_u16_d16_hi v141, v141
v_mfma_f32_32x32x16_bf16 v[120:135], v[108:111], v[220:223], v[120:135]
v_lshrrev_b32_e64 v143, 18, v143
v_pk_add_f16 v150, v150, 1.0 op_sel_hi:[1,0]
v_pk_add_f16 v147, v147, 1.0 op_sel_hi:[1,0]
v_and_b32 v145, s49, v145
v_rcp_f16 v154, v153
v_bfe_u32 v144, v145, 2, 14
v_rcp_f16_e64 v151, v150
ds_read_u16_d16_hi v143, v143
ds_read_u16_d16 v144, v144
s_waitcnt lgkmcnt(7)
v_readfirstlane_b32 s43, v247
s_nop 1
s_cmp_ge_u32 s43, 32
s_cbranch_scc1 Lev7
Lev7w:
s_sleep 1
ds_read_b32 v247, v253 offset:12
s_waitcnt lgkmcnt(0)
v_readfirstlane_b32 s43, v247
s_cmp_eq_u32 s76, 0
s_cbranch_scc1 Lev7
s_sub_u32 s76, s76, 1
s_cmp_lt_u32 s43, 32
s_cbranch_scc1 Lev7w
Lev7:
v_lshrrev_b32 v145, 18, v145
ds_read_b128 v[220:223], v248 offset:35840
ds_read_u16_d16_hi v145, v145
v_mfma_f32_32x32x16_bf16 v[120:135], v[112:115], v[224:227], v[120:135]
v_rcp_f16 v148, v147
v_rcp_f16_sdwa v154, v153 dst_sel:WORD_1 dst_unused:UNUSED_PRESERVE src0_sel:WORD_1
v_fma_mix_f32 v157, v136, v136, v157 op_sel:[0,0,0] op_sel_hi:[1,1,0]
v_fma_mix_f32 v157, v137, v137, v157 op_sel:[1,1,0] op_sel_hi:[1,1,0]
v_rcp_f16_sdwa v151, v150 dst_sel:WORD_1 dst_unused:UNUSED_PRESERVE src0_sel:WORD_1
v_fma_mix_f32 v157, v138, v138, v157 op_sel:[0,0,0] op_sel_hi:[1,1,0]
ds_read_b128 v[224:227], v245 offset:6528
ds_read_b128 v[192:195], v244 offset:128
ds_read_b128 v[196:199], v244 offset:64
v_mfma_f32_32x32x16_bf16 v[120:135], v[116:119], v[228:231], v[120:135]
v_rcp_f16_sdwa v148, v147 dst_sel:WORD_1 dst_unused:UNUSED_PRESERVE src0_sel:WORD_1
s_waitcnt lgkmcnt(5)
v_fma_mix_f32 v157, v139, v139, v157 op_sel:[1,1,0] op_sel_hi:[1,1,0]
v_pk_mul_f16 v155, v155, v154
v_fma_mix_f32 v157, v140, v140, v157 op_sel:[0,0,0] op_sel_hi:[1,1,0]
v_pk_mul_f16 v152, v152, v151
v_fma_mix_f32 v157, v141, v141, v157 op_sel:[1,1,0] op_sel_hi:[1,1,0]
v_pk_mul_f16 v149, v149, v148
v_fma_mix_f32 v157, v155, v155, v157 op_sel:[0,0,0] op_sel_hi:[1,1,0]
v_fma_mix_f32 v157, v142, v142, v157 op_sel:[0,0,0] op_sel_hi:[1,1,0]
v_fma_mix_f32 v157, v155, v155, v157 op_sel:[1,1,0] op_sel_hi:[1,1,0]
v_fma_mix_f32 v157, v143, v143, v157 op_sel:[1,1,0] op_sel_hi:[1,1,0]
v_fma_mix_f32 v157, v152, v152, v157 op_sel:[0,0,0] op_sel_hi:[1,1,0]
v_fma_mix_f32 v157, v152, v152, v157 op_sel:[1,1,0] op_sel_hi:[1,1,0]
v_fma_mix_f32 v157, v144, v144, v157 op_sel:[0,0,0] op_sel_hi:[1,1,0]
v_fma_mix_f32 v157, v149, v149, v157 op_sel:[0,0,0] op_sel_hi:[1,1,0]
s_waitcnt lgkmcnt(3)
v_fma_mix_f32 v157, v145, v145, v157 op_sel:[1,1,0] op_sel_hi:[1,1,0]
v_fma_mix_f32 v157, v149, v149, v157 op_sel:[1,1,0] op_sel_hi:[1,1,0]
s_setprio 1
v_mfma_f32_32x32x16_bf16 v[0:15], v[232:235], v[232:235], 0
ds_read_b128 v[228:231], v248 offset:38912
v_cvt_pkrtz_f16_f32 v137, v120, v121
v_cvt_pkrtz_f16_f32 v139, v122, v123
v_cvt_pkrtz_f16_f32 v141, v124, v125
v_cvt_pkrtz_f16_f32 v143, v126, v127
v_mfma_f32_32x32x16_bf16 v[16:31], v[232:235], v[232:235], 0
v_cvt_pk_f16_f32 v155, v128, v129
v_cvt_pk_f16_f32 v152, v130, v131
v_cvt_pk_f16_f32 v149, v132, v133
v_cvt_pk_f16_f32 v146, v134, v135
v_mfma_f32_32x32x16_bf16 v[32:47], v[232:235], v[232:235], 0
v_pk_fma_f16 v154, v155, v155, s48
v_and_b32_e64 v137, s49, v137
v_pk_fma_f16 v151, v152, v152, s48
v_pk_fma_f16 v148, v149, v149, s48
v_mfma_f32_32x32x16_bf16 v[120:135], v[96:99], v[236:239], 0
ds_read_b128 v[232:235], v248 offset:36864
v_and_b32_e64 v139, s49, v139
v_pk_fma_f16 v145, v146, v146, s48
v_pk_mul_f16 v154, v155, v154
v_bfe_u32 v136, v137, 2, 14
v_pk_mul_f16 v151, v152, v151
v_pk_mul_f16 v148, v149, v148
v_bfe_u32 v138, v139, 2, 14
v_pk_mul_f16 v145, v146, v145
v_mfma_f32_32x32x16_bf16 v[120:135], v[100:103], v[216:219], v[120:135]
ds_read_b128 v[236:239], v245 offset:6144
ds_read_b128 v[200:203], v244
ds_read_b128 v[204:207], v243 offset:128
ds_read_u16_d16 v136, v136
ds_read_u16_d16 v138, v138
v_exp_f16 v153, v154
v_lshrrev_b32 v137, 18, v137
v_exp_f16 v150, v151
v_lshrrev_b32 v139, 18, v139
v_exp_f16_e64 v147, v148
v_mfma_f32_32x32x16_bf16 v[120:135], v[104:107], v[220:223], v[120:135]
ds_read_b128 v[216:219], v248 offset:39936
ds_read_u16_d16_hi v137, v137
ds_read_u16_d16_hi v139, v139
v_and_b32 v141, s49, v141
v_exp_f16 v144, v145
v_and_b32 v143, s49, v143
v_exp_f16_sdwa v153, v154 dst_sel:WORD_1 dst_unused:UNUSED_PRESERVE src0_sel:WORD_1
v_bfe_u32 v140, v141, 2, 14
s_waitcnt lgkmcnt(8)
v_smfmac_f32_16x16x32_bf16 v[40:43], v[226:227], v[192:195], v246
ds_read_b128 v[220:223], v245 offset:5760
ds_read_b128 v[208:211], v243 offset:64
ds_read_b128 v[212:215], v243
ds_read_u16_d16 v140, v140
v_exp_f16_sdwa v150, v151 dst_sel:WORD_1 dst_unused:UNUSED_PRESERVE src0_sel:WORD_1
v_bfe_u32 v142, v143, 2, 14
v_exp_f16_sdwa v147, v148 dst_sel:WORD_1 dst_unused:UNUSED_PRESERVE src0_sel:WORD_1
v_smfmac_f32_16x16x32_bf16 v[24:27], v[224:225], v[196:199], v246
v_lshrrev_b32_e64 v141, 18, v141
v_exp_f16_sdwa v144, v145 dst_sel:WORD_1 dst_unused:UNUSED_PRESERVE src0_sel:WORD_1
v_lshrrev_b32_e64 v143, 18, v143
v_mfma_f32_32x32x16_bf16 v[120:135], v[108:111], v[228:231], v[120:135]
ds_read_b128 v[224:227], v245 offset:5376
ds_read_b128 v[192:195], v242 offset:128
ds_read_b128 v[196:199], v242 offset:64
ds_read_u16_d16 v142, v142
ds_read_u16_d16_hi v141, v141
ds_read_u16_d16_hi v143, v143
v_pk_add_f16 v153, v153, 1.0 op_sel_hi:[1,0]
v_pk_add_f16 v150, v150, 1.0 op_sel_hi:[1,0]
v_pk_add_f16 v147, v147, 1.0 op_sel_hi:[1,0]
v_pk_add_f16 v144, v144, 1.0 op_sel_hi:[1,0]
v_rcp_f16 v154, v153
v_rcp_f16 v151, v150
v_mfma_f32_32x32x16_bf16 v[120:135], v[112:115], v[232:235], v[120:135]
ds_read_b128 v[228:231], v248 offset:40960
v_rcp_f16 v148, v147
v_rcp_f16 v145, v144
v_rcp_f16_sdwa v154, v153 dst_sel:WORD_1 dst_unused:UNUSED_PRESERVE src0_sel:WORD_1
v_rcp_f16_sdwa v151, v150 dst_sel:WORD_1 dst_unused:UNUSED_PRESERVE src0_sel:WORD_1
s_setprio 0
s_waitcnt lgkmcnt(7)
v_smfmac_f32_16x16x32_bf16 v[8:11], v[238:239], v[200:203], v246
ds_read_b128 v[232:235], v248 offset:44032
v_rcp_f16_sdwa v148, v147 dst_sel:WORD_1 dst_unused:UNUSED_PRESERVE src0_sel:WORD_1
v_fma_mix_f32 v158, v136, v136, v158 op_sel:[0,0,0] op_sel_hi:[1,1,0]
v_smfmac_f32_16x16x32_bf16 v[40:43], v[236:237], v[204:207], v246
v_rcp_f16_sdwa v145, v144 dst_sel:WORD_1 dst_unused:UNUSED_PRESERVE src0_sel:WORD_1
v_fma_mix_f32 v158, v137, v137, v158 op_sel:[1,1,0] op_sel_hi:[1,1,0]
v_pk_mul_f16 v155, v155, v154
v_fma_mix_f32 v158, v138, v138, v158 op_sel:[0,0,0] op_sel_hi:[1,1,0]
v_mfma_f32_32x32x16_bf16 v[120:135], v[116:119], v[216:219], v[120:135]
ds_read_b128 v[236:239], v248 offset:41984
v_pk_mul_f16 v152, v152, v151
v_pk_mul_f16 v149, v149, v148
v_fma_mix_f32 v158, v139, v139, v158 op_sel:[1,1,0] op_sel_hi:[1,1,0]
v_pk_mul_f16 v146, v146, v145
v_fma_mix_f32 v158, v155, v155, v158 op_sel:[0,0,0] op_sel_hi:[1,1,0]
v_fma_mix_f32 v158, v140, v140, v158 op_sel:[0,0,0] op_sel_hi:[1,1,0]
v_fma_mix_f32 v158, v155, v155, v158 op_sel:[1,1,0] op_sel_hi:[1,1,0]
v_fma_mix_f32 v158, v152, v152, v158 op_sel:[0,0,0] op_sel_hi:[1,1,0]
v_smfmac_f32_16x16x32_bf16 v[24:27], v[222:223], v[208:211], v246
ds_read_b128 v[216:219], v248 offset:45056
s_waitcnt lgkmcnt(3)
v_fma_mix_f32 v158, v141, v141, v158 op_sel:[1,1,0] op_sel_hi:[1,1,0]
v_fma_mix_f32 v158, v152, v152, v158 op_sel:[1,1,0] op_sel_hi:[1,1,0]
v_fma_mix_f32 v158, v149, v149, v158 op_sel:[0,0,0] op_sel_hi:[1,1,0]
v_fma_mix_f32 v158, v142, v142, v158 op_sel:[0,0,0] op_sel_hi:[1,1,0]
v_smfmac_f32_16x16x32_bf16 v[8:11], v[220:221], v[212:215], v246
v_fma_mix_f32 v158, v149, v149, v158 op_sel:[1,1,0] op_sel_hi:[1,1,0]
v_fma_mix_f32 v158, v146, v146, v158 op_sel:[0,0,0] op_sel_hi:[1,1,0]
v_fma_mix_f32 v158, v143, v143, v158 op_sel:[1,1,0] op_sel_hi:[1,1,0]
v_fma_mix_f32 v158, v146, v146, v158 op_sel:[1,1,0] op_sel_hi:[1,1,0]
s_setprio 2
v_smfmac_f32_16x16x32_bf16 v[40:43], v[226:227], v[192:195], v246
ds_read_b128 v[220:223], v248 offset:43008
v_cvt_pkrtz_f16_f32 v137, v120, v121
v_cvt_pkrtz_f16_f32 v139, v122, v123
v_cvt_pkrtz_f16_f32 v141, v124, v125
v_cvt_pkrtz_f16_f32 v143, v126, v127
v_smfmac_f32_16x16x32_bf16 v[24:27], v[224:225], v[196:199], v246
v_cvt_pkrtz_f16_f32 v145, v128, v129
v_cvt_pk_f16_f32 v155, v130, v131
v_cvt_pk_f16_f32 v152, v132, v133
v_cvt_pk_f16_f32 v149, v134, v135
v_mfma_f32_32x32x16_bf16 v[120:135], v[96:99], v[228:231], 0
ds_read_b128 v[224:227], v245 offset:4992
ds_read_b128 v[200:203], v242
v_xor_b32 v244, 16, v244
ds_read_b128 v[204:207], v244 offset:128
v_pk_fma_f16 v154, v155, v155, s48
v_and_b32 v137, s49, v137
v_pk_fma_f16 v151, v152, v152, s48
v_and_b32 v139, s49, v139
v_pk_fma_f16 v148, v149, v149, s48
v_pk_mul_f16 v154, v155, v154
v_bfe_u32 v136, v137, 2, 14
v_pk_mul_f16 v151, v152, v151
s_waitcnt lgkmcnt(4)
v_mfma_f32_32x32x16_bf16 v[120:135], v[100:103], v[232:235], v[120:135]
ds_read_b128 v[228:231], v248 offset:46080
ds_read_u16_d16 v136, v136
v_pk_mul_f16 v148, v149, v148
v_bfe_u32 v138, v139, 2, 14
v_exp_f16 v153, v154
v_lshrrev_b32 v137, 18, v137
v_exp_f16 v150, v151
v_lshrrev_b32 v139, 18, v139
v_mfma_f32_32x32x16_bf16 v[120:135], v[104:107], v[236:239], v[120:135]
ds_read_b128 v[232:235], v245 offset:4608
ds_read_b128 v[208:211], v244 offset:64
ds_read_b128 v[212:215], v244
ds_read_u16_d16 v138, v138
ds_read_u16_d16_hi v137, v137
ds_read_u16_d16_hi v139, v139
v_exp_f16 v147, v148
v_and_b32 v141, s49, v141
v_and_b32 v143, s49, v143
v_exp_f16_sdwa v153, v154 dst_sel:WORD_1 dst_unused:UNUSED_PRESERVE src0_sel:WORD_1
v_bfe_u32 v140, v141, 2, 14
v_exp_f16_sdwa v150, v151 dst_sel:WORD_1 dst_unused:UNUSED_PRESERVE src0_sel:WORD_1
v_mfma_f32_32x32x16_bf16 v[120:135], v[108:111], v[216:219], v[120:135]
ds_read_b128 v[236:239], v245 offset:4224
v_xor_b32 v243, 16, v243
ds_read_b128 v[192:195], v243 offset:128
ds_read_b128 v[196:199], v243 offset:64
ds_read_u16_d16 v140, v140
v_bfe_u32 v142, v143, 2, 14
v_exp_f16_sdwa v147, v148 dst_sel:WORD_1 dst_unused:UNUSED_PRESERVE src0_sel:WORD_1
v_lshrrev_b32_e64 v141, 18, v141
v_pk_add_f16 v153, v153, 1.0 op_sel_hi:[1,0]
v_lshrrev_b32 v143, 18, v143
v_pk_add_f16 v150, v150, 1.0 op_sel_hi:[1,0]
v_pk_add_f16 v147, v147, 1.0 op_sel_hi:[1,0]
s_waitcnt lgkmcnt(9)
v_mfma_f32_32x32x16_bf16 v[120:135], v[112:115], v[220:223], v[120:135]
ds_read_b128 v[216:219], v248 offset:47104
ds_read_u16_d16 v142, v142
ds_read_u16_d16_hi v141, v141
ds_read_u16_d16_hi v143, v143
v_and_b32 v145, s49, v145
v_rcp_f16 v154, v153
v_bfe_u32 v144, v145, 2, 14
v_rcp_f16 v151, v150
v_lshrrev_b32 v145, 18, v145
v_rcp_f16_e64 v148, v147
v_smfmac_f32_16x16x32_bf16 v[8:11], v[226:227], v[200:203], v246
ds_read_b128 v[220:223], v248 offset:50176
ds_read_u16_d16 v144, v144
ds_read_u16_d16_hi v145, v145
v_rcp_f16_sdwa v154, v153 dst_sel:WORD_1 dst_unused:UNUSED_PRESERVE src0_sel:WORD_1
v_fma_mix_f32 v159, v136, v136, v159 op_sel:[0,0,0] op_sel_hi:[1,1,0]
s_waitcnt lgkmcnt(7)
v_fma_mix_f32 v159, v137, v137, v159 op_sel:[1,1,0] op_sel_hi:[1,1,0]
v_smfmac_f32_16x16x32_bf16 v[44:47], v[224:225], v[204:207], v246
v_rcp_f16_sdwa v151, v150 dst_sel:WORD_1 dst_unused:UNUSED_PRESERVE src0_sel:WORD_1
v_fma_mix_f32 v159, v138, v138, v159 op_sel:[0,0,0] op_sel_hi:[1,1,0]
v_mfma_f32_32x32x16_bf16 v[120:135], v[116:119], v[228:231], v[120:135]
ds_read_b128 v[224:227], v248 offset:48128
v_rcp_f16_sdwa v148, v147 dst_sel:WORD_1 dst_unused:UNUSED_PRESERVE src0_sel:WORD_1
v_fma_mix_f32 v159, v139, v139, v159 op_sel:[1,1,0] op_sel_hi:[1,1,0]
v_pk_mul_f16 v155, v155, v154
v_fma_mix_f32 v159, v140, v140, v159 op_sel:[0,0,0] op_sel_hi:[1,1,0]
v_pk_mul_f16 v152, v152, v151
s_waitcnt lgkmcnt(4)
v_fma_mix_f32 v159, v141, v141, v159 op_sel:[1,1,0] op_sel_hi:[1,1,0]
v_pk_mul_f16 v149, v149, v148
v_fma_mix_f32 v159, v155, v155, v159 op_sel:[0,0,0] op_sel_hi:[1,1,0]
v_smfmac_f32_16x16x32_bf16 v[28:31], v[234:235], v[208:211], v246
ds_read_b128 v[228:231], v248 offset:51200
v_fma_mix_f32 v159, v142, v142, v159 op_sel:[0,0,0] op_sel_hi:[1,1,0]
v_fma_mix_f32 v159, v155, v155, v159 op_sel:[1,1,0] op_sel_hi:[1,1,0]
v_fma_mix_f32 v159, v143, v143, v159 op_sel:[1,1,0] op_sel_hi:[1,1,0]
v_fma_mix_f32 v159, v152, v152, v159 op_sel:[0,0,0] op_sel_hi:[1,1,0]
v_smfmac_f32_16x16x32_bf16 v[12:15], v[232:233], v[212:215], v246
v_fma_mix_f32 v159, v152, v152, v159 op_sel:[1,1,0] op_sel_hi:[1,1,0]
s_waitcnt lgkmcnt(2)
v_fma_mix_f32 v159, v144, v144, v159 op_sel:[0,0,0] op_sel_hi:[1,1,0]
v_fma_mix_f32 v159, v149, v149, v159 op_sel:[0,0,0] op_sel_hi:[1,1,0]
v_fma_mix_f32 v159, v145, v145, v159 op_sel:[1,1,0] op_sel_hi:[1,1,0]
v_fma_mix_f32 v159, v149, v149, v159 op_sel:[1,1,0] op_sel_hi:[1,1,0]
s_setprio 1
v_smfmac_f32_16x16x32_bf16 v[44:47], v[238:239], v[192:195], v246
ds_read_b128 v[232:235], v248 offset:49152
v_cvt_pkrtz_f16_f32 v137, v120, v121
v_cvt_pkrtz_f16_f32 v139, v122, v123
v_cvt_pkrtz_f16_f32 v141, v124, v125
v_cvt_pkrtz_f16_f32 v143, v126, v127
v_cvt_pk_f16_f32 v155, v128, v129
v_smfmac_f32_16x16x32_bf16 v[28:31], v[236:237], v[196:199], v246
v_cvt_pk_f16_f32 v152, v130, v131
v_cvt_pk_f16_f32 v149, v132, v133
v_cvt_pk_f16_f32 v146, v134, v135
v_pk_fma_f16 v154, v155, v155, s48
v_and_b32_e64 v137, s49, v137
v_mfma_f32_32x32x16_bf16 v[120:135], v[96:99], v[216:219], 0
ds_read_b128 v[236:239], v248 offset:52224
v_pk_fma_f16 v151, v152, v152, s48
v_pk_fma_f16 v148, v149, v149, s48
v_and_b32_e64 v139, s49, v139
v_pk_fma_f16 v145, v146, v146, s48
v_pk_mul_f16 v154, v155, v154
v_bfe_u32 v136, v137, 2, 14
v_pk_mul_f16 v151, v152, v151
v_pk_mul_f16 v148, v149, v148
v_bfe_u32 v138, v139, 2, 14
v_pk_mul_f16 v145, v146, v145
v_mfma_f32_32x32x16_bf16 v[120:135], v[100:103], v[220:223], v[120:135]
ds_read_b128 v[216:219], v245 offset:3840
ds_read_b128 v[200:203], v243
v_xor_b32 v242, 16, v242
ds_read_b128 v[204:207], v242 offset:128
ds_read_u16_d16 v136, v136
ds_read_u16_d16 v138, v138
v_exp_f16 v153, v154
v_lshrrev_b32 v137, 18, v137
v_exp_f16 v150, v151
v_lshrrev_b32 v139, 18, v139
v_exp_f16 v147, v148
v_and_b32_e64 v141, s49, v141
v_exp_f16 v144, v145
s_waitcnt lgkmcnt(5)
v_mfma_f32_32x32x16_bf16 v[120:135], v[104:107], v[224:227], v[120:135]
ds_read_b128 v[220:223], v245 offset:3456
ds_read_b128 v[208:211], v242 offset:64
ds_read_b128 v[212:215], v242
ds_read_u16_d16_hi v137, v137
ds_read_u16_d16_hi v139, v139
v_and_b32_e64 v143, s49, v143
v_exp_f16_sdwa v153, v154 dst_sel:WORD_1 dst_unused:UNUSED_PRESERVE src0_sel:WORD_1
v_bfe_u32 v140, v141, 2, 14
v_exp_f16_sdwa v150, v151 dst_sel:WORD_1 dst_unused:UNUSED_PRESERVE src0_sel:WORD_1
v_bfe_u32 v142, v143, 2, 14
v_exp_f16_sdwa v147, v148 dst_sel:WORD_1 dst_unused:UNUSED_PRESERVE src0_sel:WORD_1
v_lshrrev_b32_e64 v141, 18, v141
v_mfma_f32_32x32x16_bf16 v[120:135], v[108:111], v[228:231], v[120:135]
ds_read_b128 v[224:227], v248 offset:53248
ds_read_u16_d16 v140, v140
ds_read_u16_d16 v142, v142
ds_read_u16_d16_hi v141, v141
v_exp_f16_sdwa v144, v145 dst_sel:WORD_1 dst_unused:UNUSED_PRESERVE src0_sel:WORD_1
v_lshrrev_b32_e64 v143, 18, v143
v_pk_add_f16 v153, v153, 1.0 op_sel_hi:[1,0]
v_pk_add_f16 v150, v150, 1.0 op_sel_hi:[1,0]
v_pk_add_f16 v147, v147, 1.0 op_sel_hi:[1,0]
v_pk_add_f16 v144, v144, 1.0 op_sel_hi:[1,0]
v_rcp_f16 v154, v153
v_rcp_f16 v151, v150
v_mfma_f32_32x32x16_bf16 v[120:135], v[112:115], v[232:235], v[120:135]
ds_read_b128 v[228:231], v248 offset:56320
ds_read_u16_d16_hi v143, v143
v_rcp_f16_e64 v148, v147
v_rcp_f16 v145, v144
v_rcp_f16_sdwa v154, v153 dst_sel:WORD_1 dst_unused:UNUSED_PRESERVE src0_sel:WORD_1
v_rcp_f16_sdwa v151, v150 dst_sel:WORD_1 dst_unused:UNUSED_PRESERVE src0_sel:WORD_1
s_setprio 0
v_rcp_f16_sdwa v148, v147 dst_sel:WORD_1 dst_unused:UNUSED_PRESERVE src0_sel:WORD_1
s_waitcnt lgkmcnt(6)
v_fma_mix_f32 v160, v136, v136, v160 op_sel:[0,0,0] op_sel_hi:[1,1,0]
v_mfma_f32_32x32x16_bf16 v[120:135], v[116:119], v[236:239], v[120:135]
ds_read_b128 v[232:235], v248 offset:54272
v_rcp_f16_sdwa v145, v144 dst_sel:WORD_1 dst_unused:UNUSED_PRESERVE src0_sel:WORD_1
v_fma_mix_f32 v160, v137, v137, v160 op_sel:[1,1,0] op_sel_hi:[1,1,0]
v_pk_mul_f16 v155, v155, v154
v_fma_mix_f32 v160, v138, v138, v160 op_sel:[0,0,0] op_sel_hi:[1,1,0]
v_pk_mul_f16 v152, v152, v151
v_pk_mul_f16 v149, v149, v148
v_fma_mix_f32 v160, v139, v139, v160 op_sel:[1,1,0] op_sel_hi:[1,1,0]
v_pk_mul_f16 v146, v146, v145
v_fma_mix_f32 v160, v155, v155, v160 op_sel:[0,0,0] op_sel_hi:[1,1,0]
v_smfmac_f32_16x16x32_bf16 v[12:15], v[218:219], v[200:203], v246
ds_read_b128 v[236:239], v248 offset:57344
s_waitcnt lgkmcnt(4)
v_fma_mix_f32 v160, v140, v140, v160 op_sel:[0,0,0] op_sel_hi:[1,1,0]
v_fma_mix_f32 v160, v155, v155, v160 op_sel:[1,1,0] op_sel_hi:[1,1,0]
v_fma_mix_f32 v160, v152, v152, v160 op_sel:[0,0,0] op_sel_hi:[1,1,0]
v_fma_mix_f32 v160, v141, v141, v160 op_sel:[1,1,0] op_sel_hi:[1,1,0]
v_fma_mix_f32 v160, v152, v152, v160 op_sel:[1,1,0] op_sel_hi:[1,1,0]
v_smfmac_f32_16x16x32_bf16 v[44:47], v[216:217], v[204:207], v246
v_fma_mix_f32 v160, v149, v149, v160 op_sel:[0,0,0] op_sel_hi:[1,1,0]
v_fma_mix_f32 v160, v142, v142, v160 op_sel:[0,0,0] op_sel_hi:[1,1,0]
v_fma_mix_f32 v160, v149, v149, v160 op_sel:[1,1,0] op_sel_hi:[1,1,0]
v_fma_mix_f32 v160, v146, v146, v160 op_sel:[0,0,0] op_sel_hi:[1,1,0]
s_waitcnt lgkmcnt(2)
v_fma_mix_f32 v160, v143, v143, v160 op_sel:[1,1,0] op_sel_hi:[1,1,0]
v_fma_mix_f32 v160, v146, v146, v160 op_sel:[1,1,0] op_sel_hi:[1,1,0]
s_setprio 2
v_smfmac_f32_16x16x32_bf16 v[28:31], v[222:223], v[208:211], v246
ds_read_b128 v[216:219], v248 offset:55296
v_cvt_pkrtz_f16_f32 v137, v120, v121
v_cvt_pkrtz_f16_f32 v139, v122, v123
v_cvt_pkrtz_f16_f32 v141, v124, v125
v_cvt_pkrtz_f16_f32 v143, v126, v127
v_smfmac_f32_16x16x32_bf16 v[12:15], v[220:221], v[212:215], v246
v_cvt_pkrtz_f16_f32 v145, v128, v129
v_cvt_pk_f16_f32 v155, v130, v131
v_cvt_pk_f16_f32 v152, v132, v133
v_cvt_pk_f16_f32 v149, v134, v135
v_mfma_f32_32x32x16_bf16 v[120:135], v[96:99], v[224:227], 0
ds_read_b128 v[220:223], v245 offset:3072
v_xor_b32 v244, 32, v244
ds_read_b128 v[192:195], v244 offset:128
ds_read_b128 v[196:199], v244 offset:64
v_pk_fma_f16 v154, v155, v155, s48
v_and_b32 v137, s49, v137
v_pk_fma_f16 v151, v152, v152, s48
v_and_b32_e64 v139, s49, v139
v_pk_fma_f16 v148, v149, v149, s48
v_pk_mul_f16 v154, v155, v154
v_bfe_u32 v136, v137, 2, 14
v_pk_mul_f16 v151, v152, v151
v_mfma_f32_32x32x16_bf16 v[120:135], v[100:103], v[228:231], v[120:135]
ds_read_b128 v[224:227], v248 offset:58368
ds_read_u16_d16 v136, v136
v_pk_mul_f16 v148, v149, v148
v_bfe_u32 v138, v139, 2, 14
v_exp_f16 v153, v154
v_lshrrev_b32 v137, 18, v137
v_exp_f16 v150, v151
v_lshrrev_b32 v139, 18, v139
s_waitcnt lgkmcnt(5)
v_mfma_f32_32x32x16_bf16 v[120:135], v[104:107], v[232:235], v[120:135]
ds_read_b128 v[228:231], v245 offset:2688
ds_read_b128 v[200:203], v244
v_xor_b32 v243, 32, v243
ds_read_b128 v[204:207], v243 offset:128
ds_read_u16_d16 v138, v138
ds_read_u16_d16_hi v137, v137
ds_read_u16_d16_hi v139, v139
v_exp_f16 v147, v148
v_and_b32 v141, s49, v141
v_and_b32_e64 v143, s49, v143
v_exp_f16_sdwa v153, v154 dst_sel:WORD_1 dst_unused:UNUSED_PRESERVE src0_sel:WORD_1
v_bfe_u32 v140, v141, 2, 14
v_exp_f16_sdwa v150, v151 dst_sel:WORD_1 dst_unused:UNUSED_PRESERVE src0_sel:WORD_1
v_mfma_f32_32x32x16_bf16 v[120:135], v[108:111], v[236:239], v[120:135]
ds_read_b128 v[232:235], v245 offset:2304
ds_read_b128 v[208:211], v243 offset:64
ds_read_b128 v[212:215], v243
ds_read_u16_d16 v140, v140
v_bfe_u32 v142, v143, 2, 14
v_exp_f16_sdwa v147, v148 dst_sel:WORD_1 dst_unused:UNUSED_PRESERVE src0_sel:WORD_1
v_lshrrev_b32_e64 v141, 18, v141
v_pk_add_f16 v153, v153, 1.0 op_sel_hi:[1,0]
v_lshrrev_b32_e64 v143, 18, v143
v_pk_add_f16 v150, v150, 1.0 op_sel_hi:[1,0]
v_pk_add_f16 v147, v147, 1.0 op_sel_hi:[1,0]
v_mfma_f32_32x32x16_bf16 v[120:135], v[112:115], v[216:219], v[120:135]
ds_read_b128 v[236:239], v248 offset:59392
ds_read_u16_d16 v142, v142
ds_read_u16_d16_hi v141, v141
ds_read_u16_d16_hi v143, v143
v_and_b32 v145, s49, v145
v_rcp_f16 v154, v153
v_bfe_u32 v144, v145, 2, 14
v_rcp_f16 v151, v150
v_lshrrev_b32 v145, 18, v145
v_rcp_f16 v148, v147
s_waitcnt lgkmcnt(8)
v_smfmac_f32_16x16x32_bf16 v[36:39], v[222:223], v[192:195], v246
ds_read_b128 v[216:219], v248 offset:62464
ds_read_u16_d16 v144, v144
ds_read_u16_d16_hi v145, v145
v_rcp_f16_sdwa v154, v153 dst_sel:WORD_1 dst_unused:UNUSED_PRESERVE src0_sel:WORD_1
v_fma_mix_f32 v161, v136, v136, v161 op_sel:[0,0,0] op_sel_hi:[1,1,0]
v_fma_mix_f32 v161, v137, v137, v161 op_sel:[1,1,0] op_sel_hi:[1,1,0]
v_smfmac_f32_16x16x32_bf16 v[20:23], v[220:221], v[196:199], v246
v_rcp_f16_sdwa v151, v150 dst_sel:WORD_1 dst_unused:UNUSED_PRESERVE src0_sel:WORD_1
v_fma_mix_f32 v161, v138, v138, v161 op_sel:[0,0,0] op_sel_hi:[1,1,0]
v_mfma_f32_32x32x16_bf16 v[120:135], v[116:119], v[224:227], v[120:135]
ds_read_b128 v[220:223], v248 offset:60416
v_rcp_f16_sdwa v148, v147 dst_sel:WORD_1 dst_unused:UNUSED_PRESERVE src0_sel:WORD_1
v_fma_mix_f32 v161, v139, v139, v161 op_sel:[1,1,0] op_sel_hi:[1,1,0]
v_pk_mul_f16 v155, v155, v154
s_waitcnt lgkmcnt(6)
v_fma_mix_f32 v161, v140, v140, v161 op_sel:[0,0,0] op_sel_hi:[1,1,0]
v_pk_mul_f16 v152, v152, v151
s_waitcnt lgkmcnt(4)
v_fma_mix_f32 v161, v141, v141, v161 op_sel:[1,1,0] op_sel_hi:[1,1,0]
v_pk_mul_f16 v149, v149, v148
v_fma_mix_f32 v161, v155, v155, v161 op_sel:[0,0,0] op_sel_hi:[1,1,0]
v_smfmac_f32_16x16x32_bf16 v[4:7], v[230:231], v[200:203], v246
ds_read_b128 v[224:227], v248 offset:63488
v_fma_mix_f32 v161, v142, v142, v161 op_sel:[0,0,0] op_sel_hi:[1,1,0]
v_fma_mix_f32 v161, v155, v155, v161 op_sel:[1,1,0] op_sel_hi:[1,1,0]
v_fma_mix_f32 v161, v143, v143, v161 op_sel:[1,1,0] op_sel_hi:[1,1,0]
v_fma_mix_f32 v161, v152, v152, v161 op_sel:[0,0,0] op_sel_hi:[1,1,0]
v_smfmac_f32_16x16x32_bf16 v[36:39], v[228:229], v[204:207], v246
v_fma_mix_f32 v161, v152, v152, v161 op_sel:[1,1,0] op_sel_hi:[1,1,0]
s_waitcnt lgkmcnt(2)
v_fma_mix_f32 v161, v144, v144, v161 op_sel:[0,0,0] op_sel_hi:[1,1,0]
v_fma_mix_f32 v161, v149, v149, v161 op_sel:[0,0,0] op_sel_hi:[1,1,0]
v_fma_mix_f32 v161, v145, v145, v161 op_sel:[1,1,0] op_sel_hi:[1,1,0]
v_fma_mix_f32 v161, v149, v149, v161 op_sel:[1,1,0] op_sel_hi:[1,1,0]
s_setprio 1
v_smfmac_f32_16x16x32_bf16 v[20:23], v[234:235], v[208:211], v246
ds_read_b128 v[228:231], v248 offset:61440
v_cvt_pkrtz_f16_f32 v137, v120, v121
v_cvt_pkrtz_f16_f32 v139, v122, v123
v_cvt_pkrtz_f16_f32 v141, v124, v125
v_cvt_pkrtz_f16_f32 v143, v126, v127
v_cvt_pk_f16_f32 v155, v128, v129
v_smfmac_f32_16x16x32_bf16 v[4:7], v[232:233], v[212:215], v246
v_cvt_pk_f16_f32 v152, v130, v131
v_cvt_pk_f16_f32 v149, v132, v133
v_cvt_pk_f16_f32 v146, v134, v135
v_pk_fma_f16 v154, v155, v155, s48
v_and_b32_e64 v137, s49, v137
v_mfma_f32_32x32x16_bf16 v[120:135], v[96:99], v[236:239], 0
ds_read_b128 v[232:235], v248 offset:64512
v_pk_fma_f16 v151, v152, v152, s48
v_pk_fma_f16 v148, v149, v149, s48
v_and_b32_e64 v139, s49, v139
v_pk_fma_f16 v145, v146, v146, s48
v_pk_mul_f16 v154, v155, v154
v_bfe_u32 v136, v137, 2, 14
v_pk_mul_f16 v151, v152, v151
v_pk_mul_f16 v148, v149, v148
v_bfe_u32 v138, v139, 2, 14
v_pk_mul_f16 v145, v146, v145
v_mfma_f32_32x32x16_bf16 v[120:135], v[100:103], v[216:219], v[120:135]
ds_read_b128 v[236:239], v245 offset:1920
v_xor_b32 v242, 32, v242
ds_read_b128 v[192:195], v242 offset:128
ds_read_b128 v[196:199], v242 offset:64
ds_read_u16_d16 v136, v136
ds_read_u16_d16 v138, v138
v_exp_f16 v153, v154
v_lshrrev_b32 v137, 18, v137
v_exp_f16 v150, v151
v_lshrrev_b32 v139, 18, v139
v_exp_f16 v147, v148
v_and_b32 v141, s49, v141
v_exp_f16 v144, v145
s_waitcnt lgkmcnt(5)
v_mfma_f32_32x32x16_bf16 v[120:135], v[104:107], v[220:223], v[120:135]
ds_read_b128 v[216:219], v245 offset:1536
ds_read_b128 v[200:203], v242
v_xor_b32 v244, 16, v244
ds_read_b128 v[204:207], v244 offset:128
ds_read_u16_d16_hi v137, v137
ds_read_u16_d16_hi v139, v139
v_and_b32_e64 v143, s49, v143
v_exp_f16_sdwa v153, v154 dst_sel:WORD_1 dst_unused:UNUSED_PRESERVE src0_sel:WORD_1
v_bfe_u32 v140, v141, 2, 14
v_exp_f16_sdwa v150, v151 dst_sel:WORD_1 dst_unused:UNUSED_PRESERVE src0_sel:WORD_1
v_bfe_u32 v142, v143, 2, 14
v_exp_f16_sdwa v147, v148 dst_sel:WORD_1 dst_unused:UNUSED_PRESERVE src0_sel:WORD_1
v_lshrrev_b32_e64 v141, 18, v141
v_mfma_f32_32x32x16_bf16 v[120:135], v[108:111], v[224:227], v[120:135]
ds_read_b128 v[220:223], v249
ds_read_u16_d16 v140, v140
ds_read_u16_d16 v142, v142
ds_read_u16_d16_hi v141, v141
v_exp_f16_sdwa v144, v145 dst_sel:WORD_1 dst_unused:UNUSED_PRESERVE src0_sel:WORD_1
v_lshrrev_b32_e64 v143, 18, v143
v_pk_add_f16 v153, v153, 1.0 op_sel_hi:[1,0]
v_pk_add_f16 v150, v150, 1.0 op_sel_hi:[1,0]
v_pk_add_f16 v147, v147, 1.0 op_sel_hi:[1,0]
v_pk_add_f16 v144, v144, 1.0 op_sel_hi:[1,0]
v_rcp_f16 v154, v153
v_rcp_f16 v151, v150
v_mfma_f32_32x32x16_bf16 v[120:135], v[112:115], v[228:231], v[120:135]
ds_read_b128 v[224:227], v249 offset:3072
ds_read_u16_d16_hi v143, v143
v_rcp_f16_e64 v148, v147
v_rcp_f16 v145, v144
v_rcp_f16_sdwa v154, v153 dst_sel:WORD_1 dst_unused:UNUSED_PRESERVE src0_sel:WORD_1
v_rcp_f16_sdwa v151, v150 dst_sel:WORD_1 dst_unused:UNUSED_PRESERVE src0_sel:WORD_1
s_setprio 0
v_rcp_f16_sdwa v148, v147 dst_sel:WORD_1 dst_unused:UNUSED_PRESERVE src0_sel:WORD_1
s_waitcnt lgkmcnt(6)
v_fma_mix_f32 v162, v136, v136, v162 op_sel:[0,0,0] op_sel_hi:[1,1,0]
v_mfma_f32_32x32x16_bf16 v[120:135], v[116:119], v[232:235], v[120:135]
ds_read_b128 v[228:231], v249 offset:1024
v_rcp_f16_sdwa v145, v144 dst_sel:WORD_1 dst_unused:UNUSED_PRESERVE src0_sel:WORD_1
v_fma_mix_f32 v162, v137, v137, v162 op_sel:[1,1,0] op_sel_hi:[1,1,0]
v_pk_mul_f16 v155, v155, v154
v_fma_mix_f32 v162, v138, v138, v162 op_sel:[0,0,0] op_sel_hi:[1,1,0]
v_pk_mul_f16 v152, v152, v151
v_pk_mul_f16 v149, v149, v148
v_fma_mix_f32 v162, v139, v139, v162 op_sel:[1,1,0] op_sel_hi:[1,1,0]
v_pk_mul_f16 v146, v146, v145
v_fma_mix_f32 v162, v155, v155, v162 op_sel:[0,0,0] op_sel_hi:[1,1,0]
v_smfmac_f32_16x16x32_bf16 v[36:39], v[238:239], v[192:195], v246
ds_read_b128 v[232:235], v249 offset:4096
s_waitcnt lgkmcnt(4)
v_fma_mix_f32 v162, v140, v140, v162 op_sel:[0,0,0] op_sel_hi:[1,1,0]
v_fma_mix_f32 v162, v155, v155, v162 op_sel:[1,1,0] op_sel_hi:[1,1,0]
v_fma_mix_f32 v162, v152, v152, v162 op_sel:[0,0,0] op_sel_hi:[1,1,0]
v_fma_mix_f32 v162, v141, v141, v162 op_sel:[1,1,0] op_sel_hi:[1,1,0]
v_fma_mix_f32 v162, v152, v152, v162 op_sel:[1,1,0] op_sel_hi:[1,1,0]
v_smfmac_f32_16x16x32_bf16 v[20:23], v[236:237], v[196:199], v246
v_fma_mix_f32 v162, v149, v149, v162 op_sel:[0,0,0] op_sel_hi:[1,1,0]
v_fma_mix_f32 v162, v142, v142, v162 op_sel:[0,0,0] op_sel_hi:[1,1,0]
v_fma_mix_f32 v162, v149, v149, v162 op_sel:[1,1,0] op_sel_hi:[1,1,0]
v_fma_mix_f32 v162, v146, v146, v162 op_sel:[0,0,0] op_sel_hi:[1,1,0]
s_waitcnt lgkmcnt(2)
v_fma_mix_f32 v162, v143, v143, v162 op_sel:[1,1,0] op_sel_hi:[1,1,0]
v_fma_mix_f32 v162, v146, v146, v162 op_sel:[1,1,0] op_sel_hi:[1,1,0]
s_setprio 2
v_smfmac_f32_16x16x32_bf16 v[4:7], v[218:219], v[200:203], v246
ds_read_b128 v[236:239], v249 offset:2048
v_cvt_pkrtz_f16_f32 v137, v120, v121
v_cvt_pkrtz_f16_f32 v139, v122, v123
v_cvt_pkrtz_f16_f32 v141, v124, v125
v_cvt_pkrtz_f16_f32 v143, v126, v127
v_smfmac_f32_16x16x32_bf16 v[32:35], v[216:217], v[204:207], v246
v_cvt_pkrtz_f16_f32 v145, v128, v129
v_cvt_pk_f16_f32 v155, v130, v131
v_cvt_pk_f16_f32 v152, v132, v133
v_cvt_pk_f16_f32 v149, v134, v135
v_mfma_f32_32x32x16_bf16 v[120:135], v[96:99], v[220:223], 0
ds_read_b128 v[216:219], v245 offset:1152
ds_read_b128 v[208:211], v244 offset:64
ds_read_b128 v[212:215], v244
v_pk_fma_f16 v154, v155, v155, s48
v_and_b32_e64 v137, s49, v137
v_pk_fma_f16 v151, v152, v152, s48
v_and_b32_e64 v139, s49, v139
v_pk_fma_f16 v148, v149, v149, s48
v_pk_mul_f16 v154, v155, v154
v_bfe_u32 v136, v137, 2, 14
v_pk_mul_f16 v151, v152, v151
v_mfma_f32_32x32x16_bf16 v[120:135], v[100:103], v[224:227], v[120:135]
ds_read_b128 v[220:223], v249 offset:5120
ds_read_u16_d16 v136, v136
v_pk_mul_f16 v148, v149, v148
v_bfe_u32 v138, v139, 2, 14
v_exp_f16 v153, v154
v_lshrrev_b32 v137, 18, v137
v_exp_f16 v150, v151
v_lshrrev_b32 v139, 18, v139
s_waitcnt lgkmcnt(5)
v_mfma_f32_32x32x16_bf16 v[120:135], v[104:107], v[228:231], v[120:135]
ds_read_b128 v[224:227], v245 offset:768
v_xor_b32 v243, 16, v243
ds_read_b128 v[192:195], v243 offset:128
ds_read_b128 v[196:199], v243 offset:64
ds_read_u16_d16 v138, v138
ds_read_u16_d16_hi v137, v137
ds_read_u16_d16_hi v139, v139
v_exp_f16 v147, v148
v_and_b32 v141, s49, v141
v_and_b32_e64 v143, s49, v143
v_exp_f16_sdwa v153, v154 dst_sel:WORD_1 dst_unused:UNUSED_PRESERVE src0_sel:WORD_1
v_bfe_u32 v140, v141, 2, 14
v_exp_f16_sdwa v150, v151 dst_sel:WORD_1 dst_unused:UNUSED_PRESERVE src0_sel:WORD_1
v_mfma_f32_32x32x16_bf16 v[120:135], v[108:111], v[232:235], v[120:135]
ds_read_b128 v[228:231], v245 offset:384
ds_read_b128 v[200:203], v243
v_xor_b32 v242, 16, v242
ds_read_b128 v[204:207], v242 offset:128
ds_read_u16_d16 v140, v140
v_bfe_u32 v142, v143, 2, 14
v_exp_f16_sdwa v147, v148 dst_sel:WORD_1 dst_unused:UNUSED_PRESERVE src0_sel:WORD_1
v_lshrrev_b32 v141, 18, v141
v_pk_add_f16 v153, v153, 1.0 op_sel_hi:[1,0]
v_lshrrev_b32_e64 v143, 18, v143
v_pk_add_f16 v150, v150, 1.0 op_sel_hi:[1,0]
v_pk_add_f16 v147, v147, 1.0 op_sel_hi:[1,0]
v_mfma_f32_32x32x16_bf16 v[120:135], v[112:115], v[236:239], v[120:135]
ds_read_b128 v[232:235], v249 offset:6144
ds_read_u16_d16 v142, v142
ds_read_u16_d16_hi v141, v141
ds_read_u16_d16_hi v143, v143
v_and_b32 v145, s49, v145
v_rcp_f16 v154, v153
v_bfe_u32 v144, v145, 2, 14
v_rcp_f16 v151, v150
v_lshrrev_b32 v145, 18, v145
v_rcp_f16 v148, v147
s_waitcnt lgkmcnt(8)
v_smfmac_f32_16x16x32_bf16 v[16:19], v[218:219], v[208:211], v246
ds_read_b128 v[236:239], v249 offset:9216
ds_read_u16_d16 v144, v144
ds_read_u16_d16_hi v145, v145
v_rcp_f16_sdwa v154, v153 dst_sel:WORD_1 dst_unused:UNUSED_PRESERVE src0_sel:WORD_1
v_fma_mix_f32 v163, v136, v136, v163 op_sel:[0,0,0] op_sel_hi:[1,1,0]
v_fma_mix_f32 v163, v137, v137, v163 op_sel:[1,1,0] op_sel_hi:[1,1,0]
v_smfmac_f32_16x16x32_bf16 v[0:3], v[216:217], v[212:215], v246
v_rcp_f16_sdwa v151, v150 dst_sel:WORD_1 dst_unused:UNUSED_PRESERVE src0_sel:WORD_1
v_fma_mix_f32 v163, v138, v138, v163 op_sel:[0,0,0] op_sel_hi:[1,1,0]
v_mfma_f32_32x32x16_bf16 v[120:135], v[116:119], v[220:223], v[120:135]
ds_read_b128 v[216:219], v249 offset:7168
v_rcp_f16_sdwa v148, v147 dst_sel:WORD_1 dst_unused:UNUSED_PRESERVE src0_sel:WORD_1
v_fma_mix_f32 v163, v139, v139, v163 op_sel:[1,1,0] op_sel_hi:[1,1,0]
v_pk_mul_f16 v155, v155, v154
s_waitcnt lgkmcnt(6)
v_fma_mix_f32 v163, v140, v140, v163 op_sel:[0,0,0] op_sel_hi:[1,1,0]
v_pk_mul_f16 v152, v152, v151
s_waitcnt lgkmcnt(4)
v_fma_mix_f32 v163, v141, v141, v163 op_sel:[1,1,0] op_sel_hi:[1,1,0]
v_pk_mul_f16 v149, v149, v148
v_fma_mix_f32 v163, v155, v155, v163 op_sel:[0,0,0] op_sel_hi:[1,1,0]
v_smfmac_f32_16x16x32_bf16 v[32:35], v[226:227], v[192:195], v246
ds_read_b128 v[220:223], v249 offset:10240
v_fma_mix_f32 v163, v142, v142, v163 op_sel:[0,0,0] op_sel_hi:[1,1,0]
v_fma_mix_f32 v163, v155, v155, v163 op_sel:[1,1,0] op_sel_hi:[1,1,0]
v_fma_mix_f32 v163, v143, v143, v163 op_sel:[1,1,0] op_sel_hi:[1,1,0]
v_fma_mix_f32 v163, v152, v152, v163 op_sel:[0,0,0] op_sel_hi:[1,1,0]
v_smfmac_f32_16x16x32_bf16 v[16:19], v[224:225], v[196:199], v246
v_fma_mix_f32 v163, v152, v152, v163 op_sel:[1,1,0] op_sel_hi:[1,1,0]
s_waitcnt lgkmcnt(2)
v_fma_mix_f32 v163, v144, v144, v163 op_sel:[0,0,0] op_sel_hi:[1,1,0]
v_fma_mix_f32 v163, v149, v149, v163 op_sel:[0,0,0] op_sel_hi:[1,1,0]
v_fma_mix_f32 v163, v145, v145, v163 op_sel:[1,1,0] op_sel_hi:[1,1,0]
v_fma_mix_f32 v163, v149, v149, v163 op_sel:[1,1,0] op_sel_hi:[1,1,0]
s_setprio 1
v_smfmac_f32_16x16x32_bf16 v[0:3], v[230:231], v[200:203], v246
ds_read_b128 v[224:227], v249 offset:8192
v_cvt_pkrtz_f16_f32 v137, v120, v121
v_cvt_pkrtz_f16_f32 v139, v122, v123
v_cvt_pkrtz_f16_f32 v141, v124, v125
v_cvt_pkrtz_f16_f32 v143, v126, v127
v_smfmac_f32_16x16x32_bf16 v[32:35], v[228:229], v[204:207], v246
v_cvt_pk_f16_f32 v155, v128, v129
v_cvt_pk_f16_f32 v152, v130, v131
v_cvt_pk_f16_f32 v149, v132, v133
v_cvt_pk_f16_f32 v146, v134, v135
v_pk_fma_f16 v154, v155, v155, s48
v_mfma_f32_32x32x16_bf16 v[120:135], v[96:99], v[232:235], 0
ds_read_b128 v[228:231], v249 offset:11264
v_and_b32_e64 v137, s49, v137
v_pk_fma_f16 v151, v152, v152, s48
v_pk_fma_f16 v148, v149, v149, s48
v_and_b32_e64 v139, s49, v139
v_pk_fma_f16 v145, v146, v146, s48
v_pk_mul_f16 v154, v155, v154
v_bfe_u32 v136, v137, 2, 14
v_pk_mul_f16 v151, v152, v151
v_pk_mul_f16 v148, v149, v148
v_bfe_u32 v138, v139, 2, 14
v_mfma_f32_32x32x16_bf16 v[120:135], v[100:103], v[236:239], v[120:135]
ds_read_b128 v[232:235], v245
ds_read_b128 v[208:211], v242 offset:64
ds_read_b128 v[212:215], v242
ds_read_u16_d16 v136, v136
ds_read_u16_d16 v138, v138
v_pk_mul_f16 v145, v146, v145
v_exp_f16 v153, v154
v_lshrrev_b32 v137, 18, v137
v_exp_f16 v150, v151
v_lshrrev_b32 v139, 18, v139
v_exp_f16 v147, v148
s_waitcnt lgkmcnt(6)
v_mfma_f32_32x32x16_bf16 v[120:135], v[104:107], v[216:219], v[120:135]
ds_read_b128 v[236:239], v249 offset:12288
ds_read_u16_d16_hi v137, v137
ds_read_u16_d16_hi v139, v139
v_and_b32 v141, s49, v141
v_exp_f16 v144, v145
v_and_b32_e64 v143, s49, v143
v_exp_f16_sdwa v153, v154 dst_sel:WORD_1 dst_unused:UNUSED_PRESERVE src0_sel:WORD_1
v_bfe_u32 v140, v141, 2, 14
v_exp_f16_sdwa v150, v151 dst_sel:WORD_1 dst_unused:UNUSED_PRESERVE src0_sel:WORD_1
v_bfe_u32 v142, v143, 2, 14
v_mfma_f32_32x32x16_bf16 v[120:135], v[108:111], v[220:223], v[120:135]
ds_read_b128 v[216:219], v249 offset:15360
ds_read_u16_d16 v140, v140
ds_read_u16_d16 v142, v142
v_exp_f16_sdwa v147, v148 dst_sel:WORD_1 dst_unused:UNUSED_PRESERVE src0_sel:WORD_1
v_lshrrev_b32_e64 v141, 18, v141
v_exp_f16_sdwa v144, v145 dst_sel:WORD_1 dst_unused:UNUSED_PRESERVE src0_sel:WORD_1
v_lshrrev_b32_e64 v143, 18, v143
v_pk_add_f16 v153, v153, 1.0 op_sel_hi:[1,0]
v_pk_add_f16 v150, v150, 1.0 op_sel_hi:[1,0]
v_pk_add_f16 v147, v147, 1.0 op_sel_hi:[1,0]
v_mfma_f32_32x32x16_bf16 v[120:135], v[112:115], v[224:227], v[120:135]
ds_read_b128 v[220:223], v249 offset:13312
ds_read_u16_d16_hi v141, v141
ds_read_u16_d16_hi v143, v143
v_pk_add_f16 v144, v144, 1.0 op_sel_hi:[1,0]
v_rcp_f16 v154, v153
v_rcp_f16 v151, v150
v_rcp_f16 v148, v147
v_rcp_f16 v145, v144
s_waitcnt lgkmcnt(6)
v_mfma_f32_32x32x16_bf16 v[120:135], v[116:119], v[228:231], v[120:135]
ds_read_b128 v[224:227], v249 offset:16384
v_rcp_f16_sdwa v154, v153 dst_sel:WORD_1 dst_unused:UNUSED_PRESERVE src0_sel:WORD_1
v_rcp_f16_sdwa v151, v150 dst_sel:WORD_1 dst_unused:UNUSED_PRESERVE src0_sel:WORD_1
s_setprio 0
v_rcp_f16_sdwa v148, v147 dst_sel:WORD_1 dst_unused:UNUSED_PRESERVE src0_sel:WORD_1
v_fma_mix_f32 v164, v136, v136, v164 op_sel:[0,0,0] op_sel_hi:[1,1,0]
v_rcp_f16_sdwa v145, v144 dst_sel:WORD_1 dst_unused:UNUSED_PRESERVE src0_sel:WORD_1
v_fma_mix_f32 v164, v137, v137, v164 op_sel:[1,1,0] op_sel_hi:[1,1,0]
v_smfmac_f32_16x16x32_bf16 v[16:19], v[234:235], v[208:211], v246
ds_read_b128 v[228:231], v249 offset:14336
v_pk_mul_f16 v155, v155, v154
v_fma_mix_f32 v164, v138, v138, v164 op_sel:[0,0,0] op_sel_hi:[1,1,0]
v_pk_mul_f16 v152, v152, v151
v_pk_mul_f16 v149, v149, v148
v_fma_mix_f32 v164, v139, v139, v164 op_sel:[1,1,0] op_sel_hi:[1,1,0]
v_smfmac_f32_16x16x32_bf16 v[0:3], v[232:233], v[212:215], v246
s_mov_b64 exec, 1
ds_add_u32 v253, v254 offset:16
s_mov_b64 exec, -1
v_pk_mul_f16 v146, v146, v145
v_fma_mix_f32 v164, v155, v155, v164 op_sel:[0,0,0] op_sel_hi:[1,1,0]
s_waitcnt lgkmcnt(3)
v_fma_mix_f32 v164, v140, v140, v164 op_sel:[0,0,0] op_sel_hi:[1,1,0]
v_fma_mix_f32 v164, v155, v155, v164 op_sel:[1,1,0] op_sel_hi:[1,1,0]
v_fma_mix_f32 v164, v152, v152, v164 op_sel:[0,0,0] op_sel_hi:[1,1,0]
v_fma_mix_f32 v164, v141, v141, v164 op_sel:[1,1,0] op_sel_hi:[1,1,0]
v_fma_mix_f32 v164, v152, v152, v164 op_sel:[1,1,0] op_sel_hi:[1,1,0]
v_fma_mix_f32 v164, v149, v149, v164 op_sel:[0,0,0] op_sel_hi:[1,1,0]
v_fma_mix_f32 v164, v142, v142, v164 op_sel:[0,0,0] op_sel_hi:[1,1,0]
v_fma_mix_f32 v164, v149, v149, v164 op_sel:[1,1,0] op_sel_hi:[1,1,0]
v_fma_mix_f32 v164, v146, v146, v164 op_sel:[0,0,0] op_sel_hi:[1,1,0]
v_fma_mix_f32 v164, v143, v143, v164 op_sel:[1,1,0] op_sel_hi:[1,1,0]
v_fma_mix_f32 v164, v146, v146, v164 op_sel:[1,1,0] op_sel_hi:[1,1,0]
s_setprio 3
v_pk_add_f32 v[168:169], v[0:1], v[2:3]
v_pk_mul_f32 v[170:171], v[0:1], v[0:1]
v_pk_fma_f32 v[170:171], v[2:3], v[2:3], v[170:171]
v_pk_add_f32 v[168:169], v[168:169], v[4:5]
v_pk_fma_f32 v[170:171], v[4:5], v[4:5], v[170:171]
v_pk_add_f32 v[168:169], v[168:169], v[6:7]
v_pk_fma_f32 v[170:171], v[6:7], v[6:7], v[170:171]
v_pk_add_f32 v[168:169], v[168:169], v[8:9]
v_pk_fma_f32 v[170:171], v[8:9], v[8:9], v[170:171]
v_pk_add_f32 v[168:169], v[168:169], v[10:11]
v_pk_fma_f32 v[170:171], v[10:11], v[10:11], v[170:171]
v_pk_add_f32 v[168:169], v[168:169], v[12:13]
v_pk_fma_f32 v[170:171], v[12:13], v[12:13], v[170:171]
v_pk_add_f32 v[168:169], v[168:169], v[14:15]
v_pk_fma_f32 v[170:171], v[14:15], v[14:15], v[170:171]
v_pk_add_f32 v[168:169], v[168:169], v[16:17]
v_pk_fma_f32 v[170:171], v[16:17], v[16:17], v[170:171]
v_pk_add_f32 v[168:169], v[168:169], v[18:19]
v_pk_fma_f32 v[170:171], v[18:19], v[18:19], v[170:171]
v_pk_add_f32 v[168:169], v[168:169], v[20:21]
v_pk_fma_f32 v[170:171], v[20:21], v[20:21], v[170:171]
v_pk_add_f32 v[168:169], v[168:169], v[22:23]
v_pk_fma_f32 v[170:171], v[22:23], v[22:23], v[170:171]
v_pk_add_f32 v[168:169], v[168:169], v[24:25]
v_pk_fma_f32 v[170:171], v[24:25], v[24:25], v[170:171]
v_pk_add_f32 v[168:169], v[168:169], v[26:27]
v_pk_fma_f32 v[170:171], v[26:27], v[26:27], v[170:171]
v_pk_add_f32 v[168:169], v[168:169], v[28:29]
v_pk_fma_f32 v[170:171], v[28:29], v[28:29], v[170:171]
v_pk_add_f32 v[168:169], v[168:169], v[30:31]
v_pk_fma_f32 v[170:171], v[30:31], v[30:31], v[170:171]
v_pk_add_f32 v[168:169], v[168:169], v[32:33]
v_pk_fma_f32 v[170:171], v[32:33], v[32:33], v[170:171]
v_pk_add_f32 v[168:169], v[168:169], v[34:35]
v_pk_fma_f32 v[170:171], v[34:35], v[34:35], v[170:171]
v_pk_add_f32 v[168:169], v[168:169], v[36:37]
v_pk_fma_f32 v[170:171], v[36:37], v[36:37], v[170:171]
v_pk_add_f32 v[168:169], v[168:169], v[38:39]
v_pk_fma_f32 v[170:171], v[38:39], v[38:39], v[170:171]
v_pk_add_f32 v[168:169], v[168:169], v[40:41]
v_pk_fma_f32 v[170:171], v[40:41], v[40:41], v[170:171]
v_pk_add_f32 v[168:169], v[168:169], v[42:43]
v_pk_fma_f32 v[170:171], v[42:43], v[42:43], v[170:171]
v_pk_add_f32 v[168:169], v[168:169], v[44:45]
v_pk_fma_f32 v[170:171], v[44:45], v[44:45], v[170:171]
v_pk_add_f32 v[168:169], v[168:169], v[46:47]
v_pk_fma_f32 v[170:171], v[46:47], v[46:47], v[170:171]
s_setprio 0
v_lshrrev_b32 v240, 2, v251
v_mul_u32_u24 v240, 192, v240
v_and_b32 v252, 3, v251
v_lshl_add_u32 v240, v252, 4, v240
s_setprio 2
v_cvt_pkrtz_f16_f32 v137, v120, v121
v_cvt_pkrtz_f16_f32 v139, v122, v123
v_cvt_pkrtz_f16_f32 v141, v124, v125
v_cvt_pkrtz_f16_f32 v143, v126, v127
v_cvt_pkrtz_f16_f32 v145, v128, v129
v_cvt_pk_f16_f32 v155, v130, v131
v_cvt_pk_f16_f32 v152, v132, v133
v_cvt_pk_f16_f32 v149, v134, v135
ds_read_b128 v[232:235], v249 offset:17408
v_mfma_f32_32x32x16_bf16 v[120:135], v[96:99], v[236:239], 0
v_pk_fma_f16 v154, v155, v155, s48
v_add_f32 v168, v168, v169
v_and_b32 v137, s49, v137
v_pk_fma_f16 v151, v152, v152, s48
v_and_b32_e64 v139, s49, v139
v_pk_fma_f16 v148, v149, v149, s48
v_add_f32_e64 v170, v170, v171
v_pk_mul_f16 v154, v155, v154
v_bfe_u32 v136, v137, 2, 14
v_pk_mul_f16 v151, v152, v151
v_pk_mul_f16 v148, v149, v148
v_bfe_u32 v138, v139, 2, 14
ds_read_b128 v[236:239], v249 offset:18432
ds_read_u16_d16 v136, v136
ds_read_u16_d16 v138, v138
v_mfma_f32_32x32x16_bf16 v[120:135], v[100:103], v[216:219], v[120:135]
v_permlane32_swap_b32 v168, v170
v_exp_f16 v153, v154
v_lshrrev_b32 v137, 18, v137
v_exp_f16 v150, v151
v_add_f32 v168, v168, v170
v_lshrrev_b32 v139, 18, v139
v_exp_f16 v147, v148
v_and_b32 v141, s49, v141
v_and_b32_e64 v143, s49, v143
v_mul_f32 v168, 1009429163, v168
ds_read_b128 v[216:219], v249 offset:21504
ds_read_u16_d16_hi v137, v137
ds_read_u16_d16_hi v139, v139
v_mfma_f32_32x32x16_bf16 v[120:135], v[104:107], v[220:223], v[120:135]
v_exp_f16_sdwa v153, v154 dst_sel:WORD_1 dst_unused:UNUSED_PRESERVE src0_sel:WORD_1
v_bfe_u32 v140, v141, 2, 14
v_exp_f16_sdwa v150, v151 dst_sel:WORD_1 dst_unused:UNUSED_PRESERVE src0_sel:WORD_1
v_mov_b32_e64 v170, v168
v_bfe_u32 v142, v143, 2, 14
v_exp_f16_sdwa v147, v148 dst_sel:WORD_1 dst_unused:UNUSED_PRESERVE src0_sel:WORD_1
v_lshrrev_b32_e64 v141, 18, v141
v_permlane32_swap_b32 v168, v170
v_pk_add_f16 v153, v153, 1.0 op_sel_hi:[1,0]
s_waitcnt lgkmcnt(8)
ds_read_b128 v[220:223], v249 offset:19456
ds_read_u16_d16 v140, v140
ds_read_u16_d16 v142, v142
ds_read_u16_d16_hi v141, v141
v_mfma_f32_32x32x16_bf16 v[120:135], v[108:111], v[224:227], v[120:135]
v_lshrrev_b32_e64 v143, 18, v143
v_pk_add_f16 v150, v150, 1.0 op_sel_hi:[1,0]
v_pk_add_f16 v147, v147, 1.0 op_sel_hi:[1,0]
v_and_b32_e64 v145, s49, v145
v_fma_f32 v170, -v168, v168, v170
v_rcp_f16_e64 v154, v153
v_bfe_u32 v144, v145, 2, 14
v_rcp_f16 v151, v150
v_max_f32 v170, 0, v170
v_lshrrev_b32_e64 v145, 18, v145
ds_read_b128 v[224:227], v249 offset:22528
ds_read_u16_d16_hi v143, v143
ds_read_u16_d16 v144, v144
ds_read_u16_d16_hi v145, v145
v_mfma_f32_32x32x16_bf16 v[120:135], v[112:115], v[228:231], v[120:135]
v_rcp_f16 v148, v147
v_rcp_f16_sdwa v154, v153 dst_sel:WORD_1 dst_unused:UNUSED_PRESERVE src0_sel:WORD_1
v_add_f32 v170, 925353388, v170
s_waitcnt lgkmcnt(8)
v_fma_mix_f32 v165, v136, v136, v165 op_sel:[0,0,0] op_sel_hi:[1,1,0]
ds_read_b32 v247, v253 offset:16
v_fma_mix_f32 v165, v137, v137, v165 op_sel:[1,1,0] op_sel_hi:[1,1,0]
v_rcp_f16_sdwa v151, v150 dst_sel:WORD_1 dst_unused:UNUSED_PRESERVE src0_sel:WORD_1
v_rsq_f32_e64 v170, v170
v_fma_mix_f32 v165, v138, v138, v165 op_sel:[0,0,0] op_sel_hi:[1,1,0]
ds_read_b128 v[228:231], v249 offset:20480
v_mfma_f32_32x32x16_bf16 v[120:135], v[116:119], v[232:235], v[120:135]
v_rcp_f16_sdwa v148, v147 dst_sel:WORD_1 dst_unused:UNUSED_PRESERVE src0_sel:WORD_1
v_fma_mix_f32 v165, v139, v139, v165 op_sel:[1,1,0] op_sel_hi:[1,1,0]
v_pk_mul_f16 v155, v155, v154
s_waitcnt lgkmcnt(6)
v_fma_mix_f32 v165, v140, v140, v165 op_sel:[0,0,0] op_sel_hi:[1,1,0]
v_pk_mul_f16 v152, v152, v151
v_fma_mix_f32 v165, v141, v141, v165 op_sel:[1,1,0] op_sel_hi:[1,1,0]
v_pk_mul_f16 v149, v149, v148
v_fma_mix_f32 v165, v155, v155, v165 op_sel:[0,0,0] op_sel_hi:[1,1,0]
v_mul_f32 v172, 3203391086, v170
v_fma_mix_f32 v165, v142, v142, v165 op_sel:[0,0,0] op_sel_hi:[1,1,0]
v_fma_mix_f32 v165, v155, v155, v165 op_sel:[1,1,0] op_sel_hi:[1,1,0]
s_waitcnt lgkmcnt(2)
v_fma_mix_f32 v165, v143, v143, v165 op_sel:[1,1,0] op_sel_hi:[1,1,0]
v_fma_mix_f32 v165, v152, v152, v165 op_sel:[0,0,0] op_sel_hi:[1,1,0]
v_fma_mix_f32 v165, v152, v152, v165 op_sel:[1,1,0] op_sel_hi:[1,1,0]
v_mul_f32 v173, v168, v172
v_fma_mix_f32 v165, v144, v144, v165 op_sel:[0,0,0] op_sel_hi:[1,1,0]
v_fma_mix_f32 v165, v149, v149, v165 op_sel:[0,0,0] op_sel_hi:[1,1,0]
v_fma_mix_f32 v165, v145, v145, v165 op_sel:[1,1,0] op_sel_hi:[1,1,0]
v_fma_mix_f32 v165, v149, v149, v165 op_sel:[1,1,0] op_sel_hi:[1,1,0]
s_setprio 3
v_pk_fma_f32 v[0:1], v[0:1], v[172:173], v[172:173] op_sel:[0,0,1] op_sel_hi:[1,0,1] neg_lo:[0,0,1] neg_hi:[0,0,1]
v_pk_fma_f32 v[2:3], v[2:3], v[172:173], v[172:173] op_sel:[0,0,1] op_sel_hi:[1,0,1] neg_lo:[0,0,1] neg_hi:[0,0,1]
v_pk_fma_f32 v[4:5], v[4:5], v[172:173], v[172:173] op_sel:[0,0,1] op_sel_hi:[1,0,1] neg_lo:[0,0,1] neg_hi:[0,0,1]
v_pk_fma_f32 v[6:7], v[6:7], v[172:173], v[172:173] op_sel:[0,0,1] op_sel_hi:[1,0,1] neg_lo:[0,0,1] neg_hi:[0,0,1]
v_pk_fma_f32 v[8:9], v[8:9], v[172:173], v[172:173] op_sel:[0,0,1] op_sel_hi:[1,0,1] neg_lo:[0,0,1] neg_hi:[0,0,1]
v_pk_fma_f32 v[10:11], v[10:11], v[172:173], v[172:173] op_sel:[0,0,1] op_sel_hi:[1,0,1] neg_lo:[0,0,1] neg_hi:[0,0,1]
v_pk_fma_f32 v[12:13], v[12:13], v[172:173], v[172:173] op_sel:[0,0,1] op_sel_hi:[1,0,1] neg_lo:[0,0,1] neg_hi:[0,0,1]
v_pk_fma_f32 v[14:15], v[14:15], v[172:173], v[172:173] op_sel:[0,0,1] op_sel_hi:[1,0,1] neg_lo:[0,0,1] neg_hi:[0,0,1]
v_pk_fma_f32 v[16:17], v[16:17], v[172:173], v[172:173] op_sel:[0,0,1] op_sel_hi:[1,0,1] neg_lo:[0,0,1] neg_hi:[0,0,1]
v_pk_fma_f32 v[18:19], v[18:19], v[172:173], v[172:173] op_sel:[0,0,1] op_sel_hi:[1,0,1] neg_lo:[0,0,1] neg_hi:[0,0,1]
v_pk_fma_f32 v[20:21], v[20:21], v[172:173], v[172:173] op_sel:[0,0,1] op_sel_hi:[1,0,1] neg_lo:[0,0,1] neg_hi:[0,0,1]
v_pk_fma_f32 v[22:23], v[22:23], v[172:173], v[172:173] op_sel:[0,0,1] op_sel_hi:[1,0,1] neg_lo:[0,0,1] neg_hi:[0,0,1]
v_pk_fma_f32 v[24:25], v[24:25], v[172:173], v[172:173] op_sel:[0,0,1] op_sel_hi:[1,0,1] neg_lo:[0,0,1] neg_hi:[0,0,1]
v_pk_fma_f32 v[26:27], v[26:27], v[172:173], v[172:173] op_sel:[0,0,1] op_sel_hi:[1,0,1] neg_lo:[0,0,1] neg_hi:[0,0,1]
v_pk_fma_f32 v[28:29], v[28:29], v[172:173], v[172:173] op_sel:[0,0,1] op_sel_hi:[1,0,1] neg_lo:[0,0,1] neg_hi:[0,0,1]
v_pk_fma_f32 v[30:31], v[30:31], v[172:173], v[172:173] op_sel:[0,0,1] op_sel_hi:[1,0,1] neg_lo:[0,0,1] neg_hi:[0,0,1]
v_pk_fma_f32 v[32:33], v[32:33], v[172:173], v[172:173] op_sel:[0,0,1] op_sel_hi:[1,0,1] neg_lo:[0,0,1] neg_hi:[0,0,1]
v_pk_fma_f32 v[34:35], v[34:35], v[172:173], v[172:173] op_sel:[0,0,1] op_sel_hi:[1,0,1] neg_lo:[0,0,1] neg_hi:[0,0,1]
v_pk_fma_f32 v[36:37], v[36:37], v[172:173], v[172:173] op_sel:[0,0,1] op_sel_hi:[1,0,1] neg_lo:[0,0,1] neg_hi:[0,0,1]
v_pk_fma_f32 v[38:39], v[38:39], v[172:173], v[172:173] op_sel:[0,0,1] op_sel_hi:[1,0,1] neg_lo:[0,0,1] neg_hi:[0,0,1]
v_pk_fma_f32 v[40:41], v[40:41], v[172:173], v[172:173] op_sel:[0,0,1] op_sel_hi:[1,0,1] neg_lo:[0,0,1] neg_hi:[0,0,1]
v_pk_fma_f32 v[42:43], v[42:43], v[172:173], v[172:173] op_sel:[0,0,1] op_sel_hi:[1,0,1] neg_lo:[0,0,1] neg_hi:[0,0,1]
v_pk_fma_f32 v[44:45], v[44:45], v[172:173], v[172:173] op_sel:[0,0,1] op_sel_hi:[1,0,1] neg_lo:[0,0,1] neg_hi:[0,0,1]
v_pk_fma_f32 v[46:47], v[46:47], v[172:173], v[172:173] op_sel:[0,0,1] op_sel_hi:[1,0,1] neg_lo:[0,0,1] neg_hi:[0,0,1]
s_setprio 2
s_waitcnt lgkmcnt(0)
v_readfirstlane_b32 s43, v247
s_nop 1
s_cmp_ge_u32 s43, 32
s_cbranch_scc1 Lev8
Lev8w:
s_sleep 1
ds_read_b32 v247, v253 offset:16
s_waitcnt lgkmcnt(0)
v_readfirstlane_b32 s43, v247
s_cmp_eq_u32 s76, 0
s_cbranch_scc1 Lev8
s_sub_u32 s76, s76, 1
s_cmp_lt_u32 s43, 32
s_cbranch_scc1 Lev8w
Lev8:
s_setprio 1
v_cvt_pkrtz_f16_f32 v137, v120, v121
v_cvt_pkrtz_f16_f32 v139, v122, v123
v_cvt_pkrtz_f16_f32 v141, v124, v125
v_cvt_pkrtz_f16_f32 v143, v126, v127
v_cvt_pkrtz_f16_f32 v145, v128, v129
v_cvt_pk_f16_f32 v155, v130, v131
v_cvt_pk_f16_f32 v152, v132, v133
v_cvt_pk_f16_f32 v149, v134, v135
s_add_u32 m0, s72, 0
s_add_u32 s43, s82, 0
buffer_load_dwordx4 v240, s[16:19], s43 offen lds
ds_read_b128 v[232:235], v249 offset:23552
v_mfma_f32_32x32x16_bf16 v[120:135], v[96:99], v[236:239], 0
v_pk_fma_f16 v154, v155, v155, s48
v_cvt_pk_bf16_f32 v168, v0, v1
v_and_b32 v137, s49, v137
v_pk_fma_f16 v151, v152, v152, s48
v_cvt_pk_bf16_f32 v169, v2, v3
v_and_b32_e64 v139, s49, v139
v_pk_fma_f16 v148, v149, v149, s48
v_pk_mul_f16 v154, v155, v154
v_cvt_pk_bf16_f32 v170, v4, v5
v_bfe_u32 v136, v137, 2, 14
v_pk_mul_f16 v151, v152, v151
v_pk_mul_f16 v148, v149, v148
v_cvt_pk_bf16_f32 v171, v6, v7
v_bfe_u32 v138, v139, 2, 14
ds_read_b128 v[236:239], v248 offset:16384
ds_read_u16_d16 v136, v136
ds_read_u16_d16 v138, v138
v_mfma_f32_32x32x16_bf16 v[120:135], v[100:103], v[216:219], v[120:135]
v_exp_f16_e64 v153, v154
v_cvt_pk_bf16_f32 v172, v8, v9
v_lshrrev_b32 v137, 18, v137
v_exp_f16 v150, v151
v_cvt_pk_bf16_f32 v173, v10, v11
v_lshrrev_b32 v139, 18, v139
v_exp_f16 v147, v148
v_cvt_pk_bf16_f32 v174, v12, v13
v_and_b32_e64 v141, s49, v141
v_and_b32 v143, s49, v143
v_cvt_pk_bf16_f32 v175, v14, v15
s_add_u32 m0, s72, 1024
s_add_u32 s43, s82, 64
buffer_load_dwordx4 v240, s[16:19], s43 offen lds
ds_read_b128 v[216:219], v248 offset:19456
ds_read_u16_d16_hi v137, v137
ds_read_u16_d16_hi v139, v139
v_mfma_f32_32x32x16_bf16 v[120:135], v[104:107], v[220:223], v[120:135]
v_exp_f16_sdwa v153, v154 dst_sel:WORD_1 dst_unused:UNUSED_PRESERVE src0_sel:WORD_1
v_bfe_u32 v140, v141, 2, 14
v_cvt_pk_bf16_f32 v176, v16, v17
v_exp_f16_sdwa v150, v151 dst_sel:WORD_1 dst_unused:UNUSED_PRESERVE src0_sel:WORD_1
v_bfe_u32 v142, v143, 2, 14
v_cvt_pk_bf16_f32 v177, v18, v19
v_exp_f16_sdwa v147, v148 dst_sel:WORD_1 dst_unused:UNUSED_PRESERVE src0_sel:WORD_1
v_cvt_pk_bf16_f32 v178, v20, v21
v_lshrrev_b32_e64 v141, 18, v141
v_pk_add_f16 v153, v153, 1.0 op_sel_hi:[1,0]
v_lshrrev_b32_e64 v143, 18, v143
ds_read_b128 v[220:223], v248 offset:17408
ds_read_u16_d16 v140, v140
ds_read_u16_d16 v142, v142
ds_read_u16_d16_hi v141, v141
ds_read_u16_d16_hi v143, v143
v_mfma_f32_32x32x16_bf16 v[120:135], v[108:111], v[224:227], v[120:135]
v_cvt_pk_bf16_f32 v179, v22, v23
v_pk_add_f16 v150, v150, 1.0 op_sel_hi:[1,0]
v_pk_add_f16 v147, v147, 1.0 op_sel_hi:[1,0]
v_and_b32_e64 v145, s49, v145
v_cvt_pk_bf16_f32 v180, v24, v25
v_rcp_f16_e64 v154, v153
v_bfe_u32 v144, v145, 2, 14
v_cvt_pk_bf16_f32 v181, v26, v27
v_rcp_f16 v151, v150
v_lshrrev_b32 v145, 18, v145
v_cvt_pk_bf16_f32 v182, v28, v29
s_add_u32 m0, s72, 2048
s_add_u32 s43, s82, 128
buffer_load_dwordx4 v240, s[16:19], s43 offen lds
ds_read_b128 v[224:227], v248 offset:20480
ds_read_u16_d16 v144, v144
ds_read_u16_d16_hi v145, v145
v_mfma_f32_32x32x16_bf16 v[120:135], v[112:115], v[228:231], v[120:135]
v_rcp_f16 v148, v147
v_cvt_pk_bf16_f32 v183, v30, v31
v_rcp_f16_sdwa v154, v153 dst_sel:WORD_1 dst_unused:UNUSED_PRESERVE src0_sel:WORD_1
s_waitcnt lgkmcnt(5)
v_fma_mix_f32 v166, v136, v136, v166 op_sel:[0,0,0] op_sel_hi:[1,1,0]
v_cvt_pk_bf16_f32 v184, v32, v33
s_setprio 0
v_fma_mix_f32 v166, v137, v137, v166 op_sel:[1,1,0] op_sel_hi:[1,1,0]
v_rcp_f16_sdwa v151, v150 dst_sel:WORD_1 dst_unused:UNUSED_PRESERVE src0_sel:WORD_1
v_cvt_pk_bf16_f32 v185, v34, v35
v_fma_mix_f32 v166, v138, v138, v166 op_sel:[0,0,0] op_sel_hi:[1,1,0]
v_rcp_f16_sdwa v148, v147 dst_sel:WORD_1 dst_unused:UNUSED_PRESERVE src0_sel:WORD_1
v_cvt_pk_bf16_f32 v186, v36, v37
ds_read_b128 v[228:231], v248 offset:18432
v_mfma_f32_32x32x16_bf16 v[120:135], v[116:119], v[232:235], v[120:135]
v_fma_mix_f32 v166, v139, v139, v166 op_sel:[1,1,0] op_sel_hi:[1,1,0]
v_pk_mul_f16 v155, v155, v154
v_fma_mix_f32 v166, v140, v140, v166 op_sel:[0,0,0] op_sel_hi:[1,1,0]
v_cvt_pk_bf16_f32 v187, v38, v39
v_pk_mul_f16 v152, v152, v151
s_waitcnt lgkmcnt(4)
v_fma_mix_f32 v166, v141, v141, v166 op_sel:[1,1,0] op_sel_hi:[1,1,0]
v_cvt_pk_bf16_f32 v188, v40, v41
v_pk_mul_f16 v149, v149, v148
v_fma_mix_f32 v166, v155, v155, v166 op_sel:[0,0,0] op_sel_hi:[1,1,0]
v_fma_mix_f32 v166, v142, v142, v166 op_sel:[0,0,0] op_sel_hi:[1,1,0]
v_cvt_pk_bf16_f32 v189, v42, v43
v_fma_mix_f32 v166, v155, v155, v166 op_sel:[1,1,0] op_sel_hi:[1,1,0]
v_fma_mix_f32 v166, v143, v143, v166 op_sel:[1,1,0] op_sel_hi:[1,1,0]
v_fma_mix_f32 v166, v152, v152, v166 op_sel:[0,0,0] op_sel_hi:[1,1,0]
v_cvt_pk_bf16_f32 v190, v44, v45
v_fma_mix_f32 v166, v152, v152, v166 op_sel:[1,1,0] op_sel_hi:[1,1,0]
s_waitcnt lgkmcnt(1)
v_fma_mix_f32 v166, v144, v144, v166 op_sel:[0,0,0] op_sel_hi:[1,1,0]
v_fma_mix_f32 v166, v149, v149, v166 op_sel:[0,0,0] op_sel_hi:[1,1,0]
v_cvt_pk_bf16_f32 v191, v46, v47
v_fma_mix_f32 v166, v145, v145, v166 op_sel:[1,1,0] op_sel_hi:[1,1,0]
v_fma_mix_f32 v166, v149, v149, v166 op_sel:[1,1,0] op_sel_hi:[1,1,0]
s_setprio 2
v_cvt_pkrtz_f16_f32 v137, v120, v121
v_cvt_pkrtz_f16_f32 v139, v122, v123
v_cvt_pkrtz_f16_f32 v141, v124, v125
v_cvt_pkrtz_f16_f32 v143, v126, v127
v_cvt_pkrtz_f16_f32 v145, v128, v129
v_cvt_pk_f16_f32 v155, v130, v131
v_cvt_pk_f16_f32 v152, v132, v133
v_cvt_pk_f16_f32 v149, v134, v135
s_add_u32 m0, s72, 3072
s_add_u32 s43, s82, 3072
buffer_load_dwordx4 v240, s[16:19], s43 offen lds
ds_read_b128 v[232:235], v248 offset:21504
v_mfma_f32_32x32x16_bf16 v[120:135], v[236:239], v[168:171], 0
v_pk_fma_f16 v154, v155, v155, s48
v_and_b32 v247, 1, v251
v_and_b32 v137, s49, v137
v_pk_fma_f16 v151, v152, v152, s48
v_and_b32 v139, s49, v139
v_lshlrev_b32 v247, 4, v247
v_pk_fma_f16 v148, v149, v149, s48
v_pk_mul_f16 v154, v155, v154
v_bfe_u32 v136, v137, 2, 14
v_mov_b32 v252, 15360
v_pk_mul_f16 v151, v152, v151
v_pk_mul_f16 v148, v149, v148
v_bfe_u32 v138, v139, 2, 14
ds_read_b128 v[236:239], v248 offset:22528
ds_read_u16_d16 v136, v136
ds_read_u16_d16 v138, v138
v_mfma_f32_32x32x16_bf16 v[120:135], v[216:219], v[172:175], v[120:135]
v_exp_f16 v153, v154
v_lshlrev_b32 v247, v247, v252
v_lshrrev_b32 v137, 18, v137
v_exp_f16 v150, v151
v_lshrrev_b32 v252, 3, v251
v_lshrrev_b32 v139, 18, v139
v_exp_f16 v147, v148
v_xor_b32 v252, v252, v251
v_and_b32 v141, s49, v141
v_and_b32 v143, s49, v143
s_add_u32 m0, s72, 4096
s_add_u32 s43, s82, 3136
buffer_load_dwordx4 v240, s[16:19], s43 offen lds
ds_read_b128 v[216:219], v248 offset:25600
ds_read_u16_d16_hi v137, v137
ds_read_u16_d16_hi v139, v139
v_mfma_f32_32x32x16_bf16 v[120:135], v[220:223], v[176:179], v[120:135]
v_exp_f16_sdwa v153, v154 dst_sel:WORD_1 dst_unused:UNUSED_PRESERVE src0_sel:WORD_1
v_and_b32_e64 v252, 4, v252
v_bfe_u32 v140, v141, 2, 14
v_exp_f16_sdwa v150, v151 dst_sel:WORD_1 dst_unused:UNUSED_PRESERVE src0_sel:WORD_1
v_bfe_u32 v253, v251, 3, 2
v_bfe_u32 v142, v143, 2, 14
v_exp_f16_sdwa v147, v148 dst_sel:WORD_1 dst_unused:UNUSED_PRESERVE src0_sel:WORD_1
v_lshl_add_u32 v252, v252, 1, 0
v_lshrrev_b32_e64 v141, 18, v141
v_pk_add_f16 v153, v153, 1.0 op_sel_hi:[1,0]
v_lshrrev_b32_e64 v143, 18, v143
ds_read_b128 v[220:223], v248 offset:23552
ds_read_u16_d16 v140, v140
ds_read_u16_d16 v142, v142
ds_read_u16_d16_hi v141, v141
ds_read_u16_d16_hi v143, v143
v_mfma_f32_32x32x16_bf16 v[120:135], v[224:227], v[180:183], v[120:135]
v_lshl_add_u32 v252, v253, 1, v252
v_pk_add_f16 v150, v150, 1.0 op_sel_hi:[1,0]
v_pk_add_f16 v147, v147, 1.0 op_sel_hi:[1,0]
v_and_b32_e64 v145, s49, v145
v_bfe_u32 v253, v251, 1, 1
v_rcp_f16_e64 v154, v153
v_bfe_u32 v144, v145, 2, 14
v_add_u32 v252, v252, v253
v_rcp_f16 v151, v150
v_lshrrev_b32_e64 v145, 18, v145
v_rcp_f16 v148, v147
s_waitcnt lgkmcnt(5)
s_add_u32 m0, s72, 5120
s_add_u32 s43, s82, 3200
buffer_load_dwordx4 v240, s[16:19], s43 offen lds
ds_read_b128 v[224:227], v248 offset:26624
ds_read_u16_d16 v144, v144
ds_read_u16_d16_hi v145, v145
v_mfma_f32_32x32x16_bf16 v[120:135], v[228:231], v[184:187], v[120:135]
v_cmp_eq_u32 vcc, 0, v252
s_nop 1
v_cndmask_b32 v208, 0, v247, vcc
v_rcp_f16_sdwa v154, v153 dst_sel:WORD_1 dst_unused:UNUSED_PRESERVE src0_sel:WORD_1
v_cmp_eq_u32 vcc, 1, v252
s_nop 1
v_cndmask_b32 v209, 0, v247, vcc
v_fma_mix_f32 v167, v136, v136, v167 op_sel:[0,0,0] op_sel_hi:[1,1,0]
v_fma_mix_f32 v167, v137, v137, v167 op_sel:[1,1,0] op_sel_hi:[1,1,0]
v_rcp_f16_sdwa v151, v150 dst_sel:WORD_1 dst_unused:UNUSED_PRESERVE src0_sel:WORD_1
v_cmp_eq_u32 vcc, 2, v252
s_nop 1
v_cndmask_b32 v210, 0, v247, vcc
v_fma_mix_f32 v167, v138, v138, v167 op_sel:[0,0,0] op_sel_hi:[1,1,0]
v_rcp_f16_sdwa v148, v147 dst_sel:WORD_1 dst_unused:UNUSED_PRESERVE src0_sel:WORD_1
v_cmp_eq_u32 vcc, 3, v252
s_nop 1
v_cndmask_b32 v211, 0, v247, vcc
ds_read_b128 v[228:231], v248 offset:24576
v_mfma_f32_32x32x16_bf16 v[120:135], v[232:235], v[188:191], v[120:135]
v_fma_mix_f32 v167, v139, v139, v167 op_sel:[1,1,0] op_sel_hi:[1,1,0]
v_pk_mul_f16 v155, v155, v154
s_waitcnt lgkmcnt(1)
v_fma_mix_f32 v167, v140, v140, v167 op_sel:[0,0,0] op_sel_hi:[1,1,0]
v_cmp_eq_u32 vcc, 4, v252
s_nop 1
v_cndmask_b32 v212, 0, v247, vcc
v_pk_mul_f16 v152, v152, v151
v_fma_mix_f32 v167, v141, v141, v167 op_sel:[1,1,0] op_sel_hi:[1,1,0]
v_pk_mul_f16 v149, v149, v148
v_cmp_eq_u32 vcc, 5, v252
s_nop 1
v_cndmask_b32 v213, 0, v247, vcc
v_fma_mix_f32 v167, v155, v155, v167 op_sel:[0,0,0] op_sel_hi:[1,1,0]
v_fma_mix_f32 v167, v142, v142, v167 op_sel:[0,0,0] op_sel_hi:[1,1,0]
v_fma_mix_f32 v167, v155, v155, v167 op_sel:[1,1,0] op_sel_hi:[1,1,0]
v_fma_mix_f32 v167, v143, v143, v167 op_sel:[1,1,0] op_sel_hi:[1,1,0]
v_cmp_eq_u32 vcc, 6, v252
s_nop 1
v_cndmask_b32 v214, 0, v247, vcc
v_fma_mix_f32 v167, v152, v152, v167 op_sel:[0,0,0] op_sel_hi:[1,1,0]
v_fma_mix_f32 v167, v152, v152, v167 op_sel:[1,1,0] op_sel_hi:[1,1,0]
v_fma_mix_f32 v167, v144, v144, v167 op_sel:[0,0,0] op_sel_hi:[1,1,0]
v_cmp_eq_u32 vcc, 7, v252
s_nop 1
v_cndmask_b32 v215, 0, v247, vcc
v_fma_mix_f32 v167, v149, v149, v167 op_sel:[0,0,0] op_sel_hi:[1,1,0]
v_fma_mix_f32 v167, v145, v145, v167 op_sel:[1,1,0] op_sel_hi:[1,1,0]
v_fma_mix_f32 v167, v149, v149, v167 op_sel:[1,1,0] op_sel_hi:[1,1,0]
s_setprio 1
v_cvt_pkrtz_f16_f32 v137, v120, v121
v_cvt_pkrtz_f16_f32 v139, v122, v123
v_cvt_pkrtz_f16_f32 v141, v124, v125
v_cvt_pkrtz_f16_f32 v143, v126, v127
v_cvt_pkrtz_f16_f32 v145, v128, v129
v_cvt_pk_f16_f32 v155, v130, v131
v_cvt_pk_f16_f32 v152, v132, v133
v_cvt_pk_f16_f32 v149, v134, v135
s_add_u32 m0, s72, 6144
s_add_u32 s43, s82, 6144
buffer_load_dwordx4 v240, s[16:19], s43 offen lds
ds_read_b128 v[232:235], v248 offset:27648
v_mfma_f32_32x32x16_bf16 v[120:135], v[236:239], v[168:171], 0
v_pk_fma_f16 v154, v155, v155, s48
v_and_b32_e64 v137, s49, v137
v_pk_fma_f16 v151, v152, v152, s48
v_and_b32_e64 v139, s49, v139
v_pk_fma_f16 v148, v149, v149, s48
v_pk_mul_f16 v154, v155, v154
v_bfe_u32 v136, v137, 2, 14
v_pk_mul_f16 v151, v152, v151
ds_read_b128 v[236:239], v248 offset:28672
ds_read_u16_d16 v136, v136
v_mfma_f32_32x32x16_bf16 v[120:135], v[216:219], v[172:175], v[120:135]
v_pk_mul_f16 v148, v149, v148
v_bfe_u32 v138, v139, 2, 14
v_exp_f16 v153, v154
v_lshrrev_b32 v137, 18, v137
v_exp_f16 v150, v151
v_lshrrev_b32 v139, 18, v139
ds_read_b128 v[216:219], v248 offset:31744
ds_read_u16_d16 v138, v138
ds_read_u16_d16_hi v137, v137
ds_read_u16_d16_hi v139, v139
v_mfma_f32_32x32x16_bf16 v[120:135], v[220:223], v[176:179], v[120:135]
v_exp_f16 v147, v148
v_and_b32 v141, s49, v141
v_and_b32_e64 v143, s49, v143
v_exp_f16_sdwa v153, v154 dst_sel:WORD_1 dst_unused:UNUSED_PRESERVE src0_sel:WORD_1
v_bfe_u32 v140, v141, 2, 14
v_exp_f16_sdwa v150, v151 dst_sel:WORD_1 dst_unused:UNUSED_PRESERVE src0_sel:WORD_1
ds_read_b128 v[220:223], v248 offset:29696
ds_read_u16_d16 v140, v140
v_mfma_f32_32x32x16_bf16 v[120:135], v[224:227], v[180:183], v[120:135]
v_bfe_u32 v142, v143, 2, 14
v_exp_f16_sdwa v147, v148 dst_sel:WORD_1 dst_unused:UNUSED_PRESERVE src0_sel:WORD_1
v_lshrrev_b32_e64 v141, 18, v141
v_pk_add_f16 v153, v153, 1.0 op_sel_hi:[1,0]
v_lshrrev_b32 v143, 18, v143
v_pk_add_f16 v150, v150, 1.0 op_sel_hi:[1,0]
v_pk_add_f16 v147, v147, 1.0 op_sel_hi:[1,0]
s_waitcnt lgkmcnt(6)
ds_read_b128 v[224:227], v248 offset:32768
ds_read_u16_d16 v142, v142
ds_read_u16_d16_hi v141, v141
ds_read_u16_d16_hi v143, v143
v_mfma_f32_32x32x16_bf16 v[120:135], v[228:231], v[184:187], v[120:135]
v_and_b32 v145, s49, v145
v_rcp_f16 v154, v153
v_bfe_u32 v144, v145, 2, 14
s_setprio 0
v_rcp_f16 v151, v150
v_lshrrev_b32_e64 v145, 18, v145
ds_read_b128 v[228:231], v248 offset:30720
ds_read_u16_d16 v144, v144
ds_read_u16_d16_hi v145, v145
v_mfma_f32_32x32x16_bf16 v[120:135], v[232:235], v[188:191], v[120:135]
v_rcp_f16 v148, v147
s_waitcnt lgkmcnt(7)
v_or_b32 v0, v136, v137
v_or_b32 v1, v138, v139
v_rcp_f16_sdwa v154, v153 dst_sel:WORD_1 dst_unused:UNUSED_PRESERVE src0_sel:WORD_1
s_waitcnt lgkmcnt(4)
v_or_b32 v2, v140, v141
v_rcp_f16_sdwa v151, v150 dst_sel:WORD_1 dst_unused:UNUSED_PRESERVE src0_sel:WORD_1
s_waitcnt lgkmcnt(3)
v_or_b32 v3, v142, v143
v_rcp_f16_sdwa v148, v147 dst_sel:WORD_1 dst_unused:UNUSED_PRESERVE src0_sel:WORD_1
s_waitcnt lgkmcnt(0)
v_or_b32_e64 v4, v144, v145
v_pk_mul_f16 v5, v155, v154
v_pk_mul_f16 v6, v152, v151
v_pk_mul_f16 v7, v149, v148
s_setprio 2
ds_read_b128 v[232:235], v248 offset:33792
v_mfma_f32_32x32x16_f16 v[192:207], v[0:3], v[208:211], 0
v_cvt_pkrtz_f16_f32 v137, v120, v121
v_cvt_pkrtz_f16_f32 v139, v122, v123
v_cvt_pkrtz_f16_f32 v141, v124, v125
v_cvt_pkrtz_f16_f32 v143, v126, v127
v_cvt_pkrtz_f16_f32 v145, v128, v129
v_mfma_f32_32x32x16_f16 v[192:207], v[4:7], v[212:215], v[192:207]
v_cvt_pk_f16_f32 v155, v130, v131
v_cvt_pk_f16_f32 v152, v132, v133
v_cvt_pk_f16_f32 v149, v134, v135
v_pk_fma_f16 v154, v155, v155, s48
v_and_b32_e64 v137, s49, v137
v_pk_fma_f16 v151, v152, v152, s48
v_mfma_f32_32x32x16_bf16 v[120:135], v[236:239], v[168:171], 0
v_and_b32 v139, s49, v139
v_pk_fma_f16 v148, v149, v149, s48
v_permlane16_swap_b32 v0, v4
v_pk_mul_f16 v154, v155, v154
v_bfe_u32 v136, v137, 2, 14
v_permlane16_swap_b32 v1, v5
v_pk_mul_f16 v151, v152, v151
v_pk_mul_f16 v148, v149, v148
v_bfe_u32 v138, v139, 2, 14
v_permlane16_swap_b32 v2, v6
ds_read_b128 v[236:239], v248 offset:34816
ds_read_u16_d16 v136, v136
ds_read_u16_d16 v138, v138
v_mfma_f32_32x32x16_bf16 v[120:135], v[216:219], v[172:175], v[120:135]
v_exp_f16 v153, v154
v_permlane16_swap_b32 v3, v7
v_lshrrev_b32 v137, 18, v137
v_exp_f16 v150, v151
v_fmac_f32 v156, v192, v192
v_lshrrev_b32 v139, 18, v139
v_exp_f16 v147, v148
v_fmac_f32 v156, v193, v193
v_and_b32_e64 v141, s49, v141
ds_read_b128 v[216:219], v248 offset:37888
ds_read_u16_d16_hi v137, v137
ds_read_u16_d16_hi v139, v139
v_mfma_f32_32x32x16_bf16 v[120:135], v[220:223], v[176:179], v[120:135]
v_and_b32 v143, s49, v143
v_fmac_f32 v156, v194, v194
v_exp_f16_sdwa v153, v154 dst_sel:WORD_1 dst_unused:UNUSED_PRESERVE src0_sel:WORD_1
v_bfe_u32 v140, v141, 2, 14
v_fmac_f32_e64 v156, v195, v195
v_exp_f16_sdwa v150, v151 dst_sel:WORD_1 dst_unused:UNUSED_PRESERVE src0_sel:WORD_1
v_fmac_f32_e64 v156, v196, v196
v_bfe_u32 v142, v143, 2, 14
ds_read_b128 v[220:223], v248 offset:35840
ds_read_u16_d16 v140, v140
ds_read_u16_d16 v142, v142
v_mfma_f32_32x32x16_bf16 v[120:135], v[224:227], v[180:183], v[120:135]
v_exp_f16_sdwa v147, v148 dst_sel:WORD_1 dst_unused:UNUSED_PRESERVE src0_sel:WORD_1
v_fmac_f32 v156, v197, v197
v_lshrrev_b32 v141, 18, v141
v_pk_add_f16 v153, v153, 1.0 op_sel_hi:[1,0]
v_lshrrev_b32 v143, 18, v143
v_fmac_f32 v156, v198, v198
v_pk_add_f16 v150, v150, 1.0 op_sel_hi:[1,0]
v_pk_add_f16 v147, v147, 1.0 op_sel_hi:[1,0]
v_fmac_f32 v156, v199, v199
v_and_b32 v145, s49, v145
ds_read_b128 v[224:227], v248 offset:38912
ds_read_u16_d16_hi v141, v141
ds_read_u16_d16_hi v143, v143
v_mfma_f32_32x32x16_bf16 v[120:135], v[228:231], v[184:187], v[120:135]
v_rcp_f16 v154, v153
v_fmac_f32 v156, v200, v200
v_bfe_u32 v144, v145, 2, 14
v_rcp_f16 v151, v150
v_fmac_f32 v156, v201, v201
v_lshrrev_b32 v145, 18, v145
v_rcp_f16 v148, v147
v_fmac_f32_e64 v156, v202, v202
ds_read_u16_d16 v144, v144
ds_read_u16_d16_hi v145, v145
s_waitcnt lgkmcnt(5)
v_or_b32 v8, v136, v137
ds_read_b128 v[228:231], v248 offset:36864
v_mfma_f32_32x32x16_bf16 v[120:135], v[232:235], v[188:191], v[120:135]
v_or_b32 v9, v138, v139
v_fmac_f32 v156, v203, v203
v_rcp_f16_sdwa v154, v153 dst_sel:WORD_1 dst_unused:UNUSED_PRESERVE src0_sel:WORD_1
v_fmac_f32 v156, v204, v204
s_waitcnt lgkmcnt(4)
v_or_b32_e64 v10, v140, v141
v_rcp_f16_sdwa v151, v150 dst_sel:WORD_1 dst_unused:UNUSED_PRESERVE src0_sel:WORD_1
v_fmac_f32 v156, v205, v205
s_waitcnt lgkmcnt(3)
v_or_b32_e64 v11, v142, v143
v_rcp_f16_sdwa v148, v147 dst_sel:WORD_1 dst_unused:UNUSED_PRESERVE src0_sel:WORD_1
v_fmac_f32 v156, v206, v206
s_waitcnt lgkmcnt(1)
v_or_b32_e64 v12, v144, v145
v_pk_mul_f16 v13, v155, v154
v_fmac_f32_e64 v156, v207, v207
v_pk_mul_f16 v14, v152, v151
v_pk_mul_f16 v15, v149, v148
s_cmp_lg_u32 s40, 0
s_cbranch_scc1 Lrs0
v_lshlrev_b32_e64 v89, 2, v251
v_mov_b32 v90, 0
buffer_load_dword v244, v89, s[24:27], 0 offen offset:0
buffer_load_dword v245, v89, s[24:27], 0 offen offset:256
buffer_load_dword v246, v89, s[24:27], 0 offen offset:512
buffer_load_dword v91, v90, s[36:39], 0 offen sc1
Lrs0:
s_setprio 1
ds_read_b128 v[232:235], v248 offset:39936
v_mfma_f32_32x32x16_f16 v[192:207], v[8:11], v[208:211], 0
v_cvt_pkrtz_f16_f32 v137, v120, v121
v_cvt_pkrtz_f16_f32 v139, v122, v123
v_cvt_pkrtz_f16_f32 v141, v124, v125
v_cvt_pkrtz_f16_f32 v143, v126, v127
v_cvt_pkrtz_f16_f32 v145, v128, v129
v_mfma_f32_32x32x16_f16 v[192:207], v[12:15], v[212:215], v[192:207]
v_cvt_pk_f16_f32 v155, v130, v131
v_cvt_pk_f16_f32 v152, v132, v133
v_cvt_pk_f16_f32 v149, v134, v135
v_pk_fma_f16 v154, v155, v155, s48
v_and_b32_e64 v137, s49, v137
v_pk_fma_f16 v151, v152, v152, s48
v_mfma_f32_32x32x16_bf16 v[120:135], v[236:239], v[168:171], 0
v_and_b32 v139, s49, v139
v_pk_fma_f16 v148, v149, v149, s48
v_permlane16_swap_b32 v8, v12
v_pk_mul_f16 v154, v155, v154
v_bfe_u32 v136, v137, 2, 14
v_permlane16_swap_b32 v9, v13
v_pk_mul_f16 v151, v152, v151
v_pk_mul_f16 v148, v149, v148
v_bfe_u32 v138, v139, 2, 14
v_permlane16_swap_b32 v10, v14
ds_read_b128 v[236:239], v248 offset:40960
ds_read_u16_d16 v136, v136
ds_read_u16_d16 v138, v138
v_mfma_f32_32x32x16_bf16 v[120:135], v[216:219], v[172:175], v[120:135]
v_exp_f16 v153, v154
v_permlane16_swap_b32 v11, v15
v_lshrrev_b32 v137, 18, v137
v_exp_f16 v150, v151
v_fmac_f32 v157, v192, v192
v_lshrrev_b32 v139, 18, v139
v_exp_f16 v147, v148
v_fmac_f32 v157, v193, v193
v_and_b32_e64 v141, s49, v141
ds_read_b128 v[216:219], v248 offset:44032
ds_read_u16_d16_hi v137, v137
ds_read_u16_d16_hi v139, v139
v_mfma_f32_32x32x16_bf16 v[120:135], v[220:223], v[176:179], v[120:135]
v_and_b32 v143, s49, v143
v_fmac_f32 v157, v194, v194
v_exp_f16_sdwa v153, v154 dst_sel:WORD_1 dst_unused:UNUSED_PRESERVE src0_sel:WORD_1
v_bfe_u32 v140, v141, 2, 14
v_fmac_f32_e64 v157, v195, v195
v_exp_f16_sdwa v150, v151 dst_sel:WORD_1 dst_unused:UNUSED_PRESERVE src0_sel:WORD_1
v_fmac_f32_e64 v157, v196, v196
v_bfe_u32 v142, v143, 2, 14
ds_read_b128 v[220:223], v248 offset:41984
ds_read_u16_d16 v140, v140
ds_read_u16_d16 v142, v142
v_mfma_f32_32x32x16_bf16 v[120:135], v[224:227], v[180:183], v[120:135]
v_exp_f16_sdwa v147, v148 dst_sel:WORD_1 dst_unused:UNUSED_PRESERVE src0_sel:WORD_1
v_fmac_f32 v157, v197, v197
v_lshrrev_b32 v141, 18, v141
v_pk_add_f16 v153, v153, 1.0 op_sel_hi:[1,0]
v_lshrrev_b32 v143, 18, v143
v_fmac_f32 v157, v198, v198
v_pk_add_f16 v150, v150, 1.0 op_sel_hi:[1,0]
v_pk_add_f16 v147, v147, 1.0 op_sel_hi:[1,0]
v_fmac_f32_e64 v157, v199, v199
v_and_b32 v145, s49, v145
s_waitcnt lgkmcnt(4)
ds_read_b128 v[224:227], v248 offset:45056
ds_read_u16_d16_hi v141, v141
ds_read_u16_d16_hi v143, v143
v_mfma_f32_32x32x16_bf16 v[120:135], v[228:231], v[184:187], v[120:135]
v_rcp_f16 v154, v153
v_fmac_f32 v157, v200, v200
v_bfe_u32 v144, v145, 2, 14
v_rcp_f16 v151, v150
s_setprio 0
v_fmac_f32 v157, v201, v201
v_lshrrev_b32 v145, 18, v145
v_rcp_f16 v148, v147
v_fmac_f32 v157, v202, v202
ds_read_u16_d16 v144, v144
ds_read_u16_d16_hi v145, v145
v_or_b32_e64 v16, v136, v137
ds_read_b128 v[228:231], v248 offset:43008
v_mfma_f32_32x32x16_bf16 v[120:135], v[232:235], v[188:191], v[120:135]
s_waitcnt lgkmcnt(6)
v_or_b32 v17, v138, v139
v_fmac_f32_e64 v157, v203, v203
v_rcp_f16_sdwa v154, v153 dst_sel:WORD_1 dst_unused:UNUSED_PRESERVE src0_sel:WORD_1
v_fmac_f32 v157, v204, v204
s_waitcnt lgkmcnt(4)
v_or_b32_e64 v18, v140, v141
v_rcp_f16_sdwa v151, v150 dst_sel:WORD_1 dst_unused:UNUSED_PRESERVE src0_sel:WORD_1
v_fmac_f32 v157, v205, v205
s_waitcnt lgkmcnt(3)
v_or_b32_e64 v19, v142, v143
v_rcp_f16_sdwa v148, v147 dst_sel:WORD_1 dst_unused:UNUSED_PRESERVE src0_sel:WORD_1
v_fmac_f32 v157, v206, v206
s_waitcnt lgkmcnt(1)
v_or_b32_e64 v20, v144, v145
v_pk_mul_f16 v21, v155, v154
v_fmac_f32 v157, v207, v207
v_pk_mul_f16 v22, v152, v151
v_pk_mul_f16 v23, v149, v148
s_setprio 2
ds_read_b128 v[232:235], v248 offset:46080
v_mfma_f32_32x32x16_f16 v[192:207], v[16:19], v[208:211], 0
v_cvt_pkrtz_f16_f32 v137, v120, v121
v_cvt_pkrtz_f16_f32 v139, v122, v123
v_cvt_pkrtz_f16_f32 v141, v124, v125
v_cvt_pkrtz_f16_f32 v143, v126, v127
v_cvt_pkrtz_f16_f32 v145, v128, v129
v_mfma_f32_32x32x16_f16 v[192:207], v[20:23], v[212:215], v[192:207]
v_cvt_pk_f16_f32 v155, v130, v131
v_cvt_pk_f16_f32 v152, v132, v133
v_cvt_pk_f16_f32 v149, v134, v135
v_pk_fma_f16 v154, v155, v155, s48
v_and_b32_e64 v137, s49, v137
v_pk_fma_f16 v151, v152, v152, s48
v_mfma_f32_32x32x16_bf16 v[120:135], v[236:239], v[168:171], 0
v_and_b32 v139, s49, v139
v_pk_fma_f16 v148, v149, v149, s48
v_permlane16_swap_b32 v16, v20
v_pk_mul_f16 v154, v155, v154
v_bfe_u32 v136, v137, 2, 14
v_permlane16_swap_b32 v17, v21
v_pk_mul_f16 v151, v152, v151
v_pk_mul_f16 v148, v149, v148
v_bfe_u32 v138, v139, 2, 14
v_permlane16_swap_b32 v18, v22
ds_read_b128 v[236:239], v248 offset:47104
ds_read_u16_d16 v136, v136
ds_read_u16_d16 v138, v138
v_mfma_f32_32x32x16_bf16 v[120:135], v[216:219], v[172:175], v[120:135]
v_exp_f16 v153, v154
v_permlane16_swap_b32 v19, v23
v_lshrrev_b32 v137, 18, v137
v_exp_f16 v150, v151
v_fmac_f32 v158, v192, v192
v_lshrrev_b32 v139, 18, v139
v_exp_f16 v147, v148
v_fmac_f32 v158, v193, v193
v_and_b32_e64 v141, s49, v141
ds_read_b128 v[216:219], v248 offset:50176
ds_read_u16_d16_hi v137, v137
ds_read_u16_d16_hi v139, v139
v_mfma_f32_32x32x16_bf16 v[120:135], v[220:223], v[176:179], v[120:135]
v_and_b32 v143, s49, v143
v_fmac_f32 v158, v194, v194
v_exp_f16_sdwa v153, v154 dst_sel:WORD_1 dst_unused:UNUSED_PRESERVE src0_sel:WORD_1
v_bfe_u32 v140, v141, 2, 14
v_fmac_f32_e64 v158, v195, v195
v_exp_f16_sdwa v150, v151 dst_sel:WORD_1 dst_unused:UNUSED_PRESERVE src0_sel:WORD_1
v_fmac_f32_e64 v158, v196, v196
v_bfe_u32 v142, v143, 2, 14
ds_read_b128 v[220:223], v248 offset:48128
ds_read_u16_d16 v140, v140
ds_read_u16_d16 v142, v142
v_mfma_f32_32x32x16_bf16 v[120:135], v[224:227], v[180:183], v[120:135]
v_exp_f16_sdwa v147, v148 dst_sel:WORD_1 dst_unused:UNUSED_PRESERVE src0_sel:WORD_1
v_fmac_f32 v158, v197, v197
v_lshrrev_b32 v141, 18, v141
v_pk_add_f16 v153, v153, 1.0 op_sel_hi:[1,0]
v_lshrrev_b32 v143, 18, v143
v_fmac_f32 v158, v198, v198
v_pk_add_f16 v150, v150, 1.0 op_sel_hi:[1,0]
v_pk_add_f16 v147, v147, 1.0 op_sel_hi:[1,0]
v_fmac_f32_e64 v158, v199, v199
v_and_b32 v145, s49, v145
s_waitcnt lgkmcnt(4)
ds_read_b128 v[224:227], v248 offset:51200
ds_read_u16_d16_hi v141, v141
ds_read_u16_d16_hi v143, v143
v_mfma_f32_32x32x16_bf16 v[120:135], v[228:231], v[184:187], v[120:135]
v_rcp_f16 v154, v153
v_fmac_f32 v158, v200, v200
v_bfe_u32 v144, v145, 2, 14
v_rcp_f16 v151, v150
v_fmac_f32 v158, v201, v201
v_lshrrev_b32 v145, 18, v145
v_rcp_f16 v148, v147
v_fmac_f32_e64 v158, v202, v202
ds_read_u16_d16 v144, v144
ds_read_u16_d16_hi v145, v145
v_or_b32_e64 v24, v136, v137
ds_read_b128 v[228:231], v248 offset:49152
v_mfma_f32_32x32x16_bf16 v[120:135], v[232:235], v[188:191], v[120:135]
s_waitcnt lgkmcnt(6)
v_or_b32 v25, v138, v139
v_fmac_f32_e64 v158, v203, v203
v_rcp_f16_sdwa v154, v153 dst_sel:WORD_1 dst_unused:UNUSED_PRESERVE src0_sel:WORD_1
v_fmac_f32 v158, v204, v204
s_waitcnt lgkmcnt(4)
v_or_b32_e64 v26, v140, v141
v_rcp_f16_sdwa v151, v150 dst_sel:WORD_1 dst_unused:UNUSED_PRESERVE src0_sel:WORD_1
v_fmac_f32 v158, v205, v205
s_waitcnt lgkmcnt(3)
v_or_b32_e64 v27, v142, v143
v_rcp_f16_sdwa v148, v147 dst_sel:WORD_1 dst_unused:UNUSED_PRESERVE src0_sel:WORD_1
v_fmac_f32 v158, v206, v206
s_waitcnt lgkmcnt(1)
v_or_b32_e64 v28, v144, v145
v_pk_mul_f16 v29, v155, v154
v_fmac_f32 v158, v207, v207
v_pk_mul_f16 v30, v152, v151
v_pk_mul_f16 v31, v149, v148
s_setprio 1
ds_read_b128 v[232:235], v248 offset:52224
v_mfma_f32_32x32x16_f16 v[192:207], v[24:27], v[208:211], 0
v_cvt_pkrtz_f16_f32 v137, v120, v121
v_cvt_pkrtz_f16_f32 v139, v122, v123
v_cvt_pkrtz_f16_f32 v141, v124, v125
v_cvt_pkrtz_f16_f32 v143, v126, v127
v_cvt_pkrtz_f16_f32 v145, v128, v129
v_mfma_f32_32x32x16_f16 v[192:207], v[28:31], v[212:215], v[192:207]
v_cvt_pk_f16_f32 v155, v130, v131
v_cvt_pk_f16_f32 v152, v132, v133
v_cvt_pk_f16_f32 v149, v134, v135
v_pk_fma_f16 v154, v155, v155, s48
v_and_b32_e64 v137, s49, v137
v_pk_fma_f16 v151, v152, v152, s48
v_mfma_f32_32x32x16_bf16 v[120:135], v[236:239], v[168:171], 0
v_and_b32 v139, s49, v139
v_pk_fma_f16 v148, v149, v149, s48
v_permlane16_swap_b32 v24, v28
v_pk_mul_f16 v154, v155, v154
v_bfe_u32 v136, v137, 2, 14
v_permlane16_swap_b32 v25, v29
v_pk_mul_f16 v151, v152, v151
v_pk_mul_f16 v148, v149, v148
v_bfe_u32 v138, v139, 2, 14
v_permlane16_swap_b32 v26, v30
ds_read_b128 v[236:239], v248 offset:53248
ds_read_u16_d16 v136, v136
ds_read_u16_d16 v138, v138
v_mfma_f32_32x32x16_bf16 v[120:135], v[216:219], v[172:175], v[120:135]
v_exp_f16 v153, v154
v_permlane16_swap_b32 v27, v31
v_lshrrev_b32 v137, 18, v137
v_exp_f16 v150, v151
v_fmac_f32 v159, v192, v192
v_lshrrev_b32 v139, 18, v139
v_exp_f16 v147, v148
v_fmac_f32 v159, v193, v193
v_and_b32_e64 v141, s49, v141
ds_read_b128 v[216:219], v248 offset:56320
ds_read_u16_d16_hi v137, v137
ds_read_u16_d16_hi v139, v139
v_mfma_f32_32x32x16_bf16 v[120:135], v[220:223], v[176:179], v[120:135]
v_and_b32 v143, s49, v143
v_fmac_f32 v159, v194, v194
v_exp_f16_sdwa v153, v154 dst_sel:WORD_1 dst_unused:UNUSED_PRESERVE src0_sel:WORD_1
v_bfe_u32 v140, v141, 2, 14
v_fmac_f32_e64 v159, v195, v195
v_exp_f16_sdwa v150, v151 dst_sel:WORD_1 dst_unused:UNUSED_PRESERVE src0_sel:WORD_1
v_fmac_f32_e64 v159, v196, v196
v_bfe_u32 v142, v143, 2, 14
ds_read_b128 v[220:223], v248 offset:54272
ds_read_u16_d16 v140, v140
ds_read_u16_d16 v142, v142
v_mfma_f32_32x32x16_bf16 v[120:135], v[224:227], v[180:183], v[120:135]
v_exp_f16_sdwa v147, v148 dst_sel:WORD_1 dst_unused:UNUSED_PRESERVE src0_sel:WORD_1
v_fmac_f32 v159, v197, v197
v_lshrrev_b32 v141, 18, v141
v_pk_add_f16 v153, v153, 1.0 op_sel_hi:[1,0]
v_lshrrev_b32 v143, 18, v143
v_fmac_f32 v159, v198, v198
v_pk_add_f16 v150, v150, 1.0 op_sel_hi:[1,0]
v_pk_add_f16 v147, v147, 1.0 op_sel_hi:[1,0]
v_fmac_f32_e64 v159, v199, v199
v_and_b32 v145, s49, v145
s_waitcnt lgkmcnt(4)
ds_read_b128 v[224:227], v248 offset:57344
ds_read_u16_d16_hi v141, v141
ds_read_u16_d16_hi v143, v143
v_mfma_f32_32x32x16_bf16 v[120:135], v[228:231], v[184:187], v[120:135]
v_rcp_f16 v154, v153
v_fmac_f32 v159, v200, v200
v_bfe_u32 v144, v145, 2, 14
v_rcp_f16 v151, v150
s_setprio 0
v_fmac_f32 v159, v201, v201
v_lshrrev_b32 v145, 18, v145
v_rcp_f16 v148, v147
v_fmac_f32 v159, v202, v202
ds_read_u16_d16 v144, v144
ds_read_u16_d16_hi v145, v145
v_or_b32_e64 v32, v136, v137
ds_read_b128 v[228:231], v248 offset:55296
v_mfma_f32_32x32x16_bf16 v[120:135], v[232:235], v[188:191], v[120:135]
s_waitcnt lgkmcnt(6)
v_or_b32 v33, v138, v139
v_fmac_f32_e64 v159, v203, v203
v_rcp_f16_sdwa v154, v153 dst_sel:WORD_1 dst_unused:UNUSED_PRESERVE src0_sel:WORD_1
v_fmac_f32 v159, v204, v204
s_waitcnt lgkmcnt(4)
v_or_b32_e64 v34, v140, v141
v_rcp_f16_sdwa v151, v150 dst_sel:WORD_1 dst_unused:UNUSED_PRESERVE src0_sel:WORD_1
v_fmac_f32 v159, v205, v205
s_waitcnt lgkmcnt(3)
v_or_b32_e64 v35, v142, v143
v_rcp_f16_sdwa v148, v147 dst_sel:WORD_1 dst_unused:UNUSED_PRESERVE src0_sel:WORD_1
v_fmac_f32 v159, v206, v206
s_waitcnt lgkmcnt(1)
v_or_b32_e64 v36, v144, v145
v_pk_mul_f16 v37, v155, v154
v_fmac_f32 v159, v207, v207
v_pk_mul_f16 v38, v152, v151
v_pk_mul_f16 v39, v149, v148
s_setprio 2
ds_read_b128 v[232:235], v248 offset:58368
v_mfma_f32_32x32x16_f16 v[192:207], v[32:35], v[208:211], 0
v_cvt_pkrtz_f16_f32 v137, v120, v121
v_cvt_pkrtz_f16_f32 v139, v122, v123
v_cvt_pkrtz_f16_f32 v141, v124, v125
v_cvt_pkrtz_f16_f32 v143, v126, v127
v_cvt_pkrtz_f16_f32 v145, v128, v129
v_mfma_f32_32x32x16_f16 v[192:207], v[36:39], v[212:215], v[192:207]
v_cvt_pk_f16_f32 v155, v130, v131
v_cvt_pk_f16_f32 v152, v132, v133
v_cvt_pk_f16_f32 v149, v134, v135
v_pk_fma_f16 v154, v155, v155, s48
v_and_b32_e64 v137, s49, v137
v_pk_fma_f16 v151, v152, v152, s48
v_mfma_f32_32x32x16_bf16 v[120:135], v[236:239], v[168:171], 0
v_and_b32 v139, s49, v139
v_pk_fma_f16 v148, v149, v149, s48
v_permlane16_swap_b32 v32, v36
v_pk_mul_f16 v154, v155, v154
v_bfe_u32 v136, v137, 2, 14
v_permlane16_swap_b32 v33, v37
v_pk_mul_f16 v151, v152, v151
v_pk_mul_f16 v148, v149, v148
v_bfe_u32 v138, v139, 2, 14
v_permlane16_swap_b32 v34, v38
ds_read_b128 v[236:239], v248 offset:59392
ds_read_u16_d16 v136, v136
ds_read_u16_d16 v138, v138
v_mfma_f32_32x32x16_bf16 v[120:135], v[216:219], v[172:175], v[120:135]
v_exp_f16 v153, v154
v_permlane16_swap_b32 v35, v39
v_lshrrev_b32 v137, 18, v137
v_exp_f16 v150, v151
v_fmac_f32 v160, v192, v192
v_lshrrev_b32 v139, 18, v139
v_exp_f16 v147, v148
v_fmac_f32 v160, v193, v193
v_and_b32_e64 v141, s49, v141
ds_read_b128 v[216:219], v248 offset:62464
ds_read_u16_d16_hi v137, v137
ds_read_u16_d16_hi v139, v139
v_mfma_f32_32x32x16_bf16 v[120:135], v[220:223], v[176:179], v[120:135]
v_and_b32 v143, s49, v143
v_fmac_f32 v160, v194, v194
v_exp_f16_sdwa v153, v154 dst_sel:WORD_1 dst_unused:UNUSED_PRESERVE src0_sel:WORD_1
v_bfe_u32 v140, v141, 2, 14
v_fmac_f32_e64 v160, v195, v195
v_exp_f16_sdwa v150, v151 dst_sel:WORD_1 dst_unused:UNUSED_PRESERVE src0_sel:WORD_1
v_fmac_f32_e64 v160, v196, v196
v_bfe_u32 v142, v143, 2, 14
ds_read_b128 v[220:223], v248 offset:60416
ds_read_u16_d16 v140, v140
ds_read_u16_d16 v142, v142
v_mfma_f32_32x32x16_bf16 v[120:135], v[224:227], v[180:183], v[120:135]
v_exp_f16_sdwa v147, v148 dst_sel:WORD_1 dst_unused:UNUSED_PRESERVE src0_sel:WORD_1
v_fmac_f32 v160, v197, v197
v_lshrrev_b32 v141, 18, v141
v_pk_add_f16 v153, v153, 1.0 op_sel_hi:[1,0]
v_lshrrev_b32 v143, 18, v143
v_fmac_f32 v160, v198, v198
v_pk_add_f16 v150, v150, 1.0 op_sel_hi:[1,0]
v_pk_add_f16 v147, v147, 1.0 op_sel_hi:[1,0]
v_fmac_f32_e64 v160, v199, v199
v_and_b32 v145, s49, v145
s_waitcnt lgkmcnt(4)
ds_read_b128 v[224:227], v248 offset:63488
ds_read_u16_d16_hi v141, v141
ds_read_u16_d16_hi v143, v143
v_mfma_f32_32x32x16_bf16 v[120:135], v[228:231], v[184:187], v[120:135]
v_rcp_f16 v154, v153
v_fmac_f32 v160, v200, v200
v_bfe_u32 v144, v145, 2, 14
v_rcp_f16 v151, v150
v_fmac_f32 v160, v201, v201
v_lshrrev_b32 v145, 18, v145
v_rcp_f16 v148, v147
v_fmac_f32_e64 v160, v202, v202
ds_read_u16_d16 v144, v144
ds_read_u16_d16_hi v145, v145
v_or_b32_e64 v40, v136, v137
ds_read_b128 v[228:231], v248 offset:61440
v_mfma_f32_32x32x16_bf16 v[120:135], v[232:235], v[188:191], v[120:135]
s_waitcnt lgkmcnt(6)
v_or_b32 v41, v138, v139
v_fmac_f32_e64 v160, v203, v203
v_rcp_f16_sdwa v154, v153 dst_sel:WORD_1 dst_unused:UNUSED_PRESERVE src0_sel:WORD_1
v_fmac_f32 v160, v204, v204
s_waitcnt lgkmcnt(4)
v_or_b32_e64 v42, v140, v141
v_rcp_f16_sdwa v151, v150 dst_sel:WORD_1 dst_unused:UNUSED_PRESERVE src0_sel:WORD_1
v_fmac_f32 v160, v205, v205
s_waitcnt lgkmcnt(3)
v_or_b32_e64 v43, v142, v143
v_rcp_f16_sdwa v148, v147 dst_sel:WORD_1 dst_unused:UNUSED_PRESERVE src0_sel:WORD_1
v_fmac_f32 v160, v206, v206
s_waitcnt lgkmcnt(1)
v_or_b32_e64 v44, v144, v145
v_pk_mul_f16 v45, v155, v154
v_fmac_f32_e64 v160, v207, v207
v_pk_mul_f16 v46, v152, v151
v_pk_mul_f16 v47, v149, v148
s_cmp_lg_u32 s40, 0
s_cbranch_scc1 Lrs1
v_mov_b32 v90, 0
Lpi:
s_waitcnt vmcnt(0)
v_readfirstlane_b32 s43, v91
s_cmp_eq_u32 s76, 0
s_cbranch_scc1 Lpix
s_sub_u32 s76, s76, 1
s_cmp_ge_u32 s43, 256
s_cbranch_scc1 Lpix
buffer_load_dword v91, v90, s[36:39], 0 offen sc1
s_branch Lpi
Lpix:
v_min_u32_e64 v88, 47, v251
v_lshlrev_b32 v88, 3, v88
s_and_b32 s44, s2, 7
s_lshl_b32 s44, s44, 11
s_add_u32 s44, s44, 394752
buffer_load_dwordx2 v[92:93], v88, s[32:35], s44 offen sc1
Lrs1:
s_setprio 1
ds_read_b128 v[232:235], v248 offset:64512
v_mfma_f32_32x32x16_f16 v[192:207], v[40:43], v[208:211], 0
v_cvt_pkrtz_f16_f32 v137, v120, v121
v_cvt_pkrtz_f16_f32 v139, v122, v123
v_cvt_pkrtz_f16_f32 v141, v124, v125
v_cvt_pkrtz_f16_f32 v143, v126, v127
v_cvt_pkrtz_f16_f32 v145, v128, v129
v_mfma_f32_32x32x16_f16 v[192:207], v[44:47], v[212:215], v[192:207]
v_cvt_pk_f16_f32 v155, v130, v131
v_cvt_pk_f16_f32 v152, v132, v133
v_cvt_pk_f16_f32 v149, v134, v135
v_pk_fma_f16 v154, v155, v155, s48
v_and_b32_e64 v137, s49, v137
v_pk_fma_f16 v151, v152, v152, s48
v_mfma_f32_32x32x16_bf16 v[120:135], v[236:239], v[168:171], 0
v_and_b32 v139, s49, v139
v_pk_fma_f16 v148, v149, v149, s48
v_permlane16_swap_b32 v40, v44
v_pk_mul_f16 v154, v155, v154
v_bfe_u32 v136, v137, 2, 14
v_permlane16_swap_b32 v41, v45
v_pk_mul_f16 v151, v152, v151
v_pk_mul_f16 v148, v149, v148
v_bfe_u32 v138, v139, 2, 14
v_permlane16_swap_b32 v42, v46
ds_read_b128 v[236:239], v249
ds_read_u16_d16 v136, v136
ds_read_u16_d16 v138, v138
v_mfma_f32_32x32x16_bf16 v[120:135], v[216:219], v[172:175], v[120:135]
v_exp_f16 v153, v154
v_permlane16_swap_b32 v43, v47
v_lshrrev_b32 v137, 18, v137
v_exp_f16 v150, v151
v_fmac_f32 v161, v192, v192
v_lshrrev_b32 v139, 18, v139
v_exp_f16 v147, v148
v_fmac_f32 v161, v193, v193
v_and_b32_e64 v141, s49, v141
ds_read_b128 v[216:219], v249 offset:3072
ds_read_u16_d16_hi v137, v137
ds_read_u16_d16_hi v139, v139
v_mfma_f32_32x32x16_bf16 v[120:135], v[220:223], v[176:179], v[120:135]
v_and_b32 v143, s49, v143
v_fmac_f32 v161, v194, v194
v_exp_f16_sdwa v153, v154 dst_sel:WORD_1 dst_unused:UNUSED_PRESERVE src0_sel:WORD_1
v_bfe_u32 v140, v141, 2, 14
v_fmac_f32_e64 v161, v195, v195
v_exp_f16_sdwa v150, v151 dst_sel:WORD_1 dst_unused:UNUSED_PRESERVE src0_sel:WORD_1
v_fmac_f32_e64 v161, v196, v196
v_bfe_u32 v142, v143, 2, 14
ds_read_b128 v[220:223], v249 offset:1024
ds_read_u16_d16 v140, v140
ds_read_u16_d16 v142, v142
v_mfma_f32_32x32x16_bf16 v[120:135], v[224:227], v[180:183], v[120:135]
v_exp_f16_sdwa v147, v148 dst_sel:WORD_1 dst_unused:UNUSED_PRESERVE src0_sel:WORD_1
v_fmac_f32 v161, v197, v197
v_lshrrev_b32 v141, 18, v141
v_pk_add_f16 v153, v153, 1.0 op_sel_hi:[1,0]
v_lshrrev_b32 v143, 18, v143
v_fmac_f32 v161, v198, v198
v_pk_add_f16 v150, v150, 1.0 op_sel_hi:[1,0]
v_pk_add_f16 v147, v147, 1.0 op_sel_hi:[1,0]
v_fmac_f32_e64 v161, v199, v199
v_and_b32 v145, s49, v145
s_waitcnt lgkmcnt(4)
ds_read_b128 v[224:227], v249 offset:4096
ds_read_u16_d16_hi v141, v141
ds_read_u16_d16_hi v143, v143
v_mfma_f32_32x32x16_bf16 v[120:135], v[228:231], v[184:187], v[120:135]
v_rcp_f16 v154, v153
v_fmac_f32 v161, v200, v200
v_bfe_u32 v144, v145, 2, 14
v_rcp_f16 v151, v150
s_setprio 0
v_fmac_f32 v161, v201, v201
v_lshrrev_b32 v145, 18, v145
v_rcp_f16 v148, v147
v_fmac_f32 v161, v202, v202
ds_read_u16_d16 v144, v144
ds_read_u16_d16_hi v145, v145
v_or_b32_e64 v48, v136, v137
ds_read_b128 v[228:231], v249 offset:2048
v_mfma_f32_32x32x16_bf16 v[120:135], v[232:235], v[188:191], v[120:135]
s_waitcnt lgkmcnt(6)
v_or_b32 v49, v138, v139
v_fmac_f32_e64 v161, v203, v203
v_rcp_f16_sdwa v154, v153 dst_sel:WORD_1 dst_unused:UNUSED_PRESERVE src0_sel:WORD_1
v_fmac_f32 v161, v204, v204
s_waitcnt lgkmcnt(4)
v_or_b32_e64 v50, v140, v141
v_rcp_f16_sdwa v151, v150 dst_sel:WORD_1 dst_unused:UNUSED_PRESERVE src0_sel:WORD_1
v_fmac_f32 v161, v205, v205
s_waitcnt lgkmcnt(3)
v_or_b32_e64 v51, v142, v143
v_rcp_f16_sdwa v148, v147 dst_sel:WORD_1 dst_unused:UNUSED_PRESERVE src0_sel:WORD_1
v_fmac_f32 v161, v206, v206
s_waitcnt lgkmcnt(1)
v_or_b32_e64 v52, v144, v145
v_pk_mul_f16 v53, v155, v154
v_fmac_f32 v161, v207, v207
v_pk_mul_f16 v54, v152, v151
v_pk_mul_f16 v55, v149, v148
s_setprio 2
ds_read_b128 v[232:235], v249 offset:5120
v_mfma_f32_32x32x16_f16 v[192:207], v[48:51], v[208:211], 0
v_cvt_pkrtz_f16_f32 v137, v120, v121
v_cvt_pkrtz_f16_f32 v139, v122, v123
v_cvt_pkrtz_f16_f32 v141, v124, v125
v_cvt_pkrtz_f16_f32 v143, v126, v127
v_cvt_pkrtz_f16_f32 v145, v128, v129
v_mfma_f32_32x32x16_f16 v[192:207], v[52:55], v[212:215], v[192:207]
v_cvt_pk_f16_f32 v155, v130, v131
v_cvt_pk_f16_f32 v152, v132, v133
v_cvt_pk_f16_f32 v149, v134, v135
v_pk_fma_f16 v154, v155, v155, s48
v_and_b32_e64 v137, s49, v137
v_pk_fma_f16 v151, v152, v152, s48
v_mfma_f32_32x32x16_bf16 v[120:135], v[236:239], v[168:171], 0
v_and_b32 v139, s49, v139
v_pk_fma_f16 v148, v149, v149, s48
v_permlane16_swap_b32 v48, v52
v_pk_mul_f16 v154, v155, v154
v_bfe_u32 v136, v137, 2, 14
v_permlane16_swap_b32 v49, v53
v_pk_mul_f16 v151, v152, v151
v_pk_mul_f16 v148, v149, v148
v_bfe_u32 v138, v139, 2, 14
v_permlane16_swap_b32 v50, v54
ds_read_b128 v[236:239], v249 offset:6144
ds_read_u16_d16 v136, v136
ds_read_u16_d16 v138, v138
v_mfma_f32_32x32x16_bf16 v[120:135], v[216:219], v[172:175], v[120:135]
v_exp_f16 v153, v154
v_permlane16_swap_b32 v51, v55
v_lshrrev_b32 v137, 18, v137
v_exp_f16 v150, v151
v_fmac_f32 v162, v192, v192
v_lshrrev_b32 v139, 18, v139
v_exp_f16 v147, v148
v_fmac_f32 v162, v193, v193
v_and_b32_e64 v141, s49, v141
ds_read_b128 v[216:219], v249 offset:9216
ds_read_u16_d16_hi v137, v137
ds_read_u16_d16_hi v139, v139
v_mfma_f32_32x32x16_bf16 v[120:135], v[220:223], v[176:179], v[120:135]
v_and_b32 v143, s49, v143
v_fmac_f32 v162, v194, v194
v_exp_f16_sdwa v153, v154 dst_sel:WORD_1 dst_unused:UNUSED_PRESERVE src0_sel:WORD_1
v_bfe_u32 v140, v141, 2, 14
v_fmac_f32_e64 v162, v195, v195
v_exp_f16_sdwa v150, v151 dst_sel:WORD_1 dst_unused:UNUSED_PRESERVE src0_sel:WORD_1
v_fmac_f32_e64 v162, v196, v196
v_bfe_u32 v142, v143, 2, 14
ds_read_b128 v[220:223], v249 offset:7168
ds_read_u16_d16 v140, v140
ds_read_u16_d16 v142, v142
v_mfma_f32_32x32x16_bf16 v[120:135], v[224:227], v[180:183], v[120:135]
v_exp_f16_sdwa v147, v148 dst_sel:WORD_1 dst_unused:UNUSED_PRESERVE src0_sel:WORD_1
v_fmac_f32 v162, v197, v197
v_lshrrev_b32 v141, 18, v141
v_pk_add_f16 v153, v153, 1.0 op_sel_hi:[1,0]
v_lshrrev_b32 v143, 18, v143
v_fmac_f32 v162, v198, v198
v_pk_add_f16 v150, v150, 1.0 op_sel_hi:[1,0]
v_pk_add_f16 v147, v147, 1.0 op_sel_hi:[1,0]
v_fmac_f32_e64 v162, v199, v199
v_and_b32 v145, s49, v145
s_waitcnt lgkmcnt(4)
ds_read_b128 v[224:227], v249 offset:10240
ds_read_u16_d16_hi v141, v141
ds_read_u16_d16_hi v143, v143
v_mfma_f32_32x32x16_bf16 v[120:135], v[228:231], v[184:187], v[120:135]
v_rcp_f16 v154, v153
v_fmac_f32 v162, v200, v200
v_bfe_u32 v144, v145, 2, 14
v_rcp_f16 v151, v150
v_fmac_f32 v162, v201, v201
v_lshrrev_b32 v145, 18, v145
v_rcp_f16 v148, v147
v_fmac_f32_e64 v162, v202, v202
ds_read_u16_d16 v144, v144
ds_read_u16_d16_hi v145, v145
v_or_b32_e64 v56, v136, v137
ds_read_b128 v[228:231], v249 offset:8192
v_mfma_f32_32x32x16_bf16 v[120:135], v[232:235], v[188:191], v[120:135]
s_waitcnt lgkmcnt(6)
v_or_b32 v57, v138, v139
v_fmac_f32_e64 v162, v203, v203
v_rcp_f16_sdwa v154, v153 dst_sel:WORD_1 dst_unused:UNUSED_PRESERVE src0_sel:WORD_1
v_fmac_f32 v162, v204, v204
s_waitcnt lgkmcnt(4)
v_or_b32_e64 v58, v140, v141
v_rcp_f16_sdwa v151, v150 dst_sel:WORD_1 dst_unused:UNUSED_PRESERVE src0_sel:WORD_1
v_fmac_f32 v162, v205, v205
s_waitcnt lgkmcnt(3)
v_or_b32_e64 v59, v142, v143
v_rcp_f16_sdwa v148, v147 dst_sel:WORD_1 dst_unused:UNUSED_PRESERVE src0_sel:WORD_1
v_fmac_f32 v162, v206, v206
s_waitcnt lgkmcnt(1)
v_or_b32_e64 v60, v144, v145
v_pk_mul_f16 v61, v155, v154
v_fmac_f32 v162, v207, v207
v_pk_mul_f16 v62, v152, v151
v_pk_mul_f16 v63, v149, v148
s_setprio 1
ds_read_b128 v[232:235], v249 offset:11264
v_mfma_f32_32x32x16_f16 v[192:207], v[56:59], v[208:211], 0
v_cvt_pkrtz_f16_f32 v137, v120, v121
v_cvt_pkrtz_f16_f32 v139, v122, v123
v_cvt_pkrtz_f16_f32 v141, v124, v125
v_cvt_pkrtz_f16_f32 v143, v126, v127
v_cvt_pkrtz_f16_f32 v145, v128, v129
v_mfma_f32_32x32x16_f16 v[192:207], v[60:63], v[212:215], v[192:207]
v_cvt_pk_f16_f32 v155, v130, v131
v_cvt_pk_f16_f32 v152, v132, v133
v_cvt_pk_f16_f32 v149, v134, v135
v_pk_fma_f16 v154, v155, v155, s48
v_and_b32_e64 v137, s49, v137
v_pk_fma_f16 v151, v152, v152, s48
v_mfma_f32_32x32x16_bf16 v[120:135], v[236:239], v[168:171], 0
v_and_b32 v139, s49, v139
v_pk_fma_f16 v148, v149, v149, s48
v_permlane16_swap_b32 v56, v60
v_pk_mul_f16 v154, v155, v154
v_bfe_u32 v136, v137, 2, 14
v_permlane16_swap_b32 v57, v61
v_pk_mul_f16 v151, v152, v151
v_pk_mul_f16 v148, v149, v148
v_bfe_u32 v138, v139, 2, 14
v_permlane16_swap_b32 v58, v62
ds_read_b128 v[236:239], v249 offset:12288
ds_read_u16_d16 v136, v136
ds_read_u16_d16 v138, v138
v_mfma_f32_32x32x16_bf16 v[120:135], v[216:219], v[172:175], v[120:135]
v_exp_f16 v153, v154
v_permlane16_swap_b32 v59, v63
v_lshrrev_b32 v137, 18, v137
v_exp_f16 v150, v151
v_fmac_f32 v163, v192, v192
v_lshrrev_b32 v139, 18, v139
v_exp_f16 v147, v148
v_fmac_f32 v163, v193, v193
v_and_b32_e64 v141, s49, v141
ds_read_b128 v[216:219], v249 offset:15360
ds_read_u16_d16_hi v137, v137
ds_read_u16_d16_hi v139, v139
v_mfma_f32_32x32x16_bf16 v[120:135], v[220:223], v[176:179], v[120:135]
v_and_b32 v143, s49, v143
v_fmac_f32 v163, v194, v194
v_exp_f16_sdwa v153, v154 dst_sel:WORD_1 dst_unused:UNUSED_PRESERVE src0_sel:WORD_1
v_bfe_u32 v140, v141, 2, 14
v_fmac_f32_e64 v163, v195, v195
v_exp_f16_sdwa v150, v151 dst_sel:WORD_1 dst_unused:UNUSED_PRESERVE src0_sel:WORD_1
v_fmac_f32_e64 v163, v196, v196
v_bfe_u32 v142, v143, 2, 14
ds_read_b128 v[220:223], v249 offset:13312
ds_read_u16_d16 v140, v140
ds_read_u16_d16 v142, v142
v_mfma_f32_32x32x16_bf16 v[120:135], v[224:227], v[180:183], v[120:135]
v_exp_f16_sdwa v147, v148 dst_sel:WORD_1 dst_unused:UNUSED_PRESERVE src0_sel:WORD_1
v_fmac_f32 v163, v197, v197
v_lshrrev_b32 v141, 18, v141
v_pk_add_f16 v153, v153, 1.0 op_sel_hi:[1,0]
v_lshrrev_b32 v143, 18, v143
v_fmac_f32 v163, v198, v198
v_pk_add_f16 v150, v150, 1.0 op_sel_hi:[1,0]
v_pk_add_f16 v147, v147, 1.0 op_sel_hi:[1,0]
v_fmac_f32_e64 v163, v199, v199
v_and_b32 v145, s49, v145
s_waitcnt lgkmcnt(4)
ds_read_b128 v[224:227], v249 offset:16384
ds_read_u16_d16_hi v141, v141
ds_read_u16_d16_hi v143, v143
v_mfma_f32_32x32x16_bf16 v[120:135], v[228:231], v[184:187], v[120:135]
v_rcp_f16 v154, v153
v_fmac_f32 v163, v200, v200
v_bfe_u32 v144, v145, 2, 14
v_rcp_f16 v151, v150
s_setprio 0
v_fmac_f32 v163, v201, v201
v_lshrrev_b32 v145, 18, v145
v_rcp_f16 v148, v147
v_fmac_f32 v163, v202, v202
ds_read_u16_d16 v144, v144
ds_read_u16_d16_hi v145, v145
v_or_b32_e64 v64, v136, v137
ds_read_b128 v[228:231], v249 offset:14336
v_mfma_f32_32x32x16_bf16 v[120:135], v[232:235], v[188:191], v[120:135]
s_waitcnt lgkmcnt(6)
v_or_b32 v65, v138, v139
v_fmac_f32_e64 v163, v203, v203
v_rcp_f16_sdwa v154, v153 dst_sel:WORD_1 dst_unused:UNUSED_PRESERVE src0_sel:WORD_1
v_fmac_f32 v163, v204, v204
s_waitcnt lgkmcnt(4)
v_or_b32_e64 v66, v140, v141
v_rcp_f16_sdwa v151, v150 dst_sel:WORD_1 dst_unused:UNUSED_PRESERVE src0_sel:WORD_1
v_fmac_f32 v163, v205, v205
s_waitcnt lgkmcnt(3)
v_or_b32_e64 v67, v142, v143
v_rcp_f16_sdwa v148, v147 dst_sel:WORD_1 dst_unused:UNUSED_PRESERVE src0_sel:WORD_1
v_fmac_f32 v163, v206, v206
s_waitcnt lgkmcnt(1)
v_or_b32_e64 v68, v144, v145
v_pk_mul_f16 v69, v155, v154
v_fmac_f32 v163, v207, v207
v_pk_mul_f16 v70, v152, v151
v_pk_mul_f16 v71, v149, v148
s_setprio 2
ds_read_b128 v[232:235], v249 offset:17408
v_mfma_f32_32x32x16_f16 v[192:207], v[64:67], v[208:211], 0
v_cvt_pkrtz_f16_f32 v137, v120, v121
v_cvt_pkrtz_f16_f32 v139, v122, v123
v_cvt_pkrtz_f16_f32 v141, v124, v125
v_cvt_pkrtz_f16_f32 v143, v126, v127
v_cvt_pkrtz_f16_f32 v145, v128, v129
v_mfma_f32_32x32x16_f16 v[192:207], v[68:71], v[212:215], v[192:207]
v_cvt_pk_f16_f32 v155, v130, v131
v_cvt_pk_f16_f32 v152, v132, v133
v_cvt_pk_f16_f32 v149, v134, v135
v_pk_fma_f16 v154, v155, v155, s48
v_and_b32_e64 v137, s49, v137
v_pk_fma_f16 v151, v152, v152, s48
v_mfma_f32_32x32x16_bf16 v[120:135], v[236:239], v[168:171], 0
v_and_b32 v139, s49, v139
v_pk_fma_f16 v148, v149, v149, s48
v_permlane16_swap_b32 v64, v68
v_pk_mul_f16 v154, v155, v154
v_bfe_u32 v136, v137, 2, 14
v_permlane16_swap_b32 v65, v69
v_pk_mul_f16 v151, v152, v151
v_pk_mul_f16 v148, v149, v148
v_bfe_u32 v138, v139, 2, 14
v_permlane16_swap_b32 v66, v70
ds_read_b128 v[236:239], v249 offset:18432
ds_read_u16_d16 v136, v136
ds_read_u16_d16 v138, v138
v_mfma_f32_32x32x16_bf16 v[120:135], v[216:219], v[172:175], v[120:135]
v_exp_f16 v153, v154
v_permlane16_swap_b32 v67, v71
v_lshrrev_b32 v137, 18, v137
v_exp_f16 v150, v151
v_fmac_f32 v164, v192, v192
v_lshrrev_b32 v139, 18, v139
v_exp_f16 v147, v148
v_fmac_f32 v164, v193, v193
v_and_b32_e64 v141, s49, v141
ds_read_b128 v[216:219], v249 offset:21504
ds_read_u16_d16_hi v137, v137
ds_read_u16_d16_hi v139, v139
v_mfma_f32_32x32x16_bf16 v[120:135], v[220:223], v[176:179], v[120:135]
v_and_b32 v143, s49, v143
v_fmac_f32 v164, v194, v194
v_exp_f16_sdwa v153, v154 dst_sel:WORD_1 dst_unused:UNUSED_PRESERVE src0_sel:WORD_1
v_bfe_u32 v140, v141, 2, 14
v_fmac_f32_e64 v164, v195, v195
v_exp_f16_sdwa v150, v151 dst_sel:WORD_1 dst_unused:UNUSED_PRESERVE src0_sel:WORD_1
v_fmac_f32_e64 v164, v196, v196
v_bfe_u32 v142, v143, 2, 14
ds_read_b128 v[220:223], v249 offset:19456
ds_read_u16_d16 v140, v140
ds_read_u16_d16 v142, v142
v_mfma_f32_32x32x16_bf16 v[120:135], v[224:227], v[180:183], v[120:135]
v_exp_f16_sdwa v147, v148 dst_sel:WORD_1 dst_unused:UNUSED_PRESERVE src0_sel:WORD_1
v_fmac_f32 v164, v197, v197
v_lshrrev_b32 v141, 18, v141
v_pk_add_f16 v153, v153, 1.0 op_sel_hi:[1,0]
v_lshrrev_b32 v143, 18, v143
v_fmac_f32 v164, v198, v198
v_pk_add_f16 v150, v150, 1.0 op_sel_hi:[1,0]
v_pk_add_f16 v147, v147, 1.0 op_sel_hi:[1,0]
v_fmac_f32_e64 v164, v199, v199
v_and_b32 v145, s49, v145
s_waitcnt lgkmcnt(4)
ds_read_b128 v[224:227], v249 offset:22528
ds_read_u16_d16_hi v141, v141
ds_read_u16_d16_hi v143, v143
v_mfma_f32_32x32x16_bf16 v[120:135], v[228:231], v[184:187], v[120:135]
v_rcp_f16 v154, v153
v_fmac_f32 v164, v200, v200
v_bfe_u32 v144, v145, 2, 14
v_rcp_f16 v151, v150
v_fmac_f32 v164, v201, v201
v_lshrrev_b32 v145, 18, v145
v_rcp_f16 v148, v147
v_fmac_f32_e64 v164, v202, v202
ds_read_u16_d16 v144, v144
ds_read_u16_d16_hi v145, v145
v_or_b32_e64 v72, v136, v137
ds_read_b128 v[228:231], v249 offset:20480
v_mfma_f32_32x32x16_bf16 v[120:135], v[232:235], v[188:191], v[120:135]
s_waitcnt lgkmcnt(6)
v_or_b32 v73, v138, v139
v_fmac_f32_e64 v164, v203, v203
v_rcp_f16_sdwa v154, v153 dst_sel:WORD_1 dst_unused:UNUSED_PRESERVE src0_sel:WORD_1
v_fmac_f32 v164, v204, v204
s_waitcnt lgkmcnt(4)
v_or_b32_e64 v74, v140, v141
v_rcp_f16_sdwa v151, v150 dst_sel:WORD_1 dst_unused:UNUSED_PRESERVE src0_sel:WORD_1
v_fmac_f32 v164, v205, v205
s_waitcnt lgkmcnt(3)
v_or_b32_e64 v75, v142, v143
v_rcp_f16_sdwa v148, v147 dst_sel:WORD_1 dst_unused:UNUSED_PRESERVE src0_sel:WORD_1
v_fmac_f32 v164, v206, v206
s_waitcnt lgkmcnt(1)
v_or_b32_e64 v76, v144, v145
v_pk_mul_f16 v77, v155, v154
v_fmac_f32_e64 v164, v207, v207
v_pk_mul_f16 v78, v152, v151
v_pk_mul_f16 v79, v149, v148
s_cmp_lg_u32 s40, 0
s_cbranch_scc1 Lrs2
v_min_u32_e64 v88, 47, v251
v_lshlrev_b32 v88, 3, v88
v_add_u32 v89, 7936, v88
v_add_u32 v88, 15872, v88
v_cmp_gt_u32 vcc, 32, v251
s_nop 1
v_cndmask_b32 v88, v88, v89, vcc
s_waitcnt vmcnt(0)
ds_write_b64 v88, v[92:93]
Lrs2:
s_setprio 1
ds_read_b128 v[232:235], v249 offset:23552
v_mfma_f32_32x32x16_f16 v[192:207], v[72:75], v[208:211], 0
v_cvt_pkrtz_f16_f32 v137, v120, v121
v_cvt_pkrtz_f16_f32 v139, v122, v123
v_cvt_pkrtz_f16_f32 v141, v124, v125
v_cvt_pkrtz_f16_f32 v143, v126, v127
v_cvt_pkrtz_f16_f32 v145, v128, v129
v_mfma_f32_32x32x16_f16 v[192:207], v[76:79], v[212:215], v[192:207]
v_cvt_pk_f16_f32 v155, v130, v131
v_cvt_pk_f16_f32 v152, v132, v133
v_cvt_pk_f16_f32 v149, v134, v135
v_pk_fma_f16 v154, v155, v155, s48
v_and_b32_e64 v137, s49, v137
v_pk_fma_f16 v151, v152, v152, s48
v_mfma_f32_32x32x16_bf16 v[120:135], v[236:239], v[168:171], 0
v_and_b32 v139, s49, v139
v_pk_fma_f16 v148, v149, v149, s48
v_permlane16_swap_b32 v72, v76
v_pk_mul_f16 v154, v155, v154
v_bfe_u32 v136, v137, 2, 14
v_permlane16_swap_b32 v73, v77
v_pk_mul_f16 v151, v152, v151
v_pk_mul_f16 v148, v149, v148
v_bfe_u32 v138, v139, 2, 14
v_permlane16_swap_b32 v74, v78
ds_read_u16_d16 v136, v136
ds_read_u16_d16 v138, v138
v_mfma_f32_32x32x16_bf16 v[120:135], v[216:219], v[172:175], v[120:135]
v_exp_f16 v153, v154
v_permlane16_swap_b32 v75, v79
v_lshrrev_b32 v137, 18, v137
v_exp_f16 v150, v151
v_fmac_f32 v165, v192, v192
v_lshrrev_b32 v139, 18, v139
v_exp_f16 v147, v148
v_fmac_f32 v165, v193, v193
v_and_b32_e64 v141, s49, v141
ds_read_u16_d16_hi v137, v137
ds_read_u16_d16_hi v139, v139
v_mfma_f32_32x32x16_bf16 v[120:135], v[220:223], v[176:179], v[120:135]
v_and_b32 v143, s49, v143
v_fmac_f32 v165, v194, v194
v_exp_f16_sdwa v153, v154 dst_sel:WORD_1 dst_unused:UNUSED_PRESERVE src0_sel:WORD_1
v_bfe_u32 v140, v141, 2, 14
v_fmac_f32_e64 v165, v195, v195
v_exp_f16_sdwa v150, v151 dst_sel:WORD_1 dst_unused:UNUSED_PRESERVE src0_sel:WORD_1
v_fmac_f32_e64 v165, v196, v196
v_bfe_u32 v142, v143, 2, 14
ds_read_u16_d16 v140, v140
ds_read_u16_d16 v142, v142
v_mfma_f32_32x32x16_bf16 v[120:135], v[224:227], v[180:183], v[120:135]
v_exp_f16_sdwa v147, v148 dst_sel:WORD_1 dst_unused:UNUSED_PRESERVE src0_sel:WORD_1
v_fmac_f32 v165, v197, v197
v_lshrrev_b32 v141, 18, v141
v_pk_add_f16 v153, v153, 1.0 op_sel_hi:[1,0]
v_lshrrev_b32 v143, 18, v143
v_fmac_f32 v165, v198, v198
v_pk_add_f16 v150, v150, 1.0 op_sel_hi:[1,0]
v_pk_add_f16 v147, v147, 1.0 op_sel_hi:[1,0]
v_fmac_f32_e64 v165, v199, v199
v_and_b32 v145, s49, v145
s_waitcnt lgkmcnt(4)
ds_read_u16_d16_hi v141, v141
ds_read_u16_d16_hi v143, v143
v_mfma_f32_32x32x16_bf16 v[120:135], v[228:231], v[184:187], v[120:135]
v_rcp_f16 v154, v153
v_fmac_f32 v165, v200, v200
v_bfe_u32 v144, v145, 2, 14
v_rcp_f16 v151, v150
s_setprio 0
v_fmac_f32 v165, v201, v201
v_lshrrev_b32 v145, 18, v145
v_rcp_f16 v148, v147
v_fmac_f32 v165, v202, v202
ds_read_u16_d16 v144, v144
ds_read_u16_d16_hi v145, v145
s_waitcnt lgkmcnt(4)
v_or_b32 v80, v136, v137
v_mfma_f32_32x32x16_bf16 v[120:135], v[232:235], v[188:191], v[120:135]
v_or_b32 v81, v138, v139
v_fmac_f32 v165, v203, v203
v_rcp_f16_sdwa v154, v153 dst_sel:WORD_1 dst_unused:UNUSED_PRESERVE src0_sel:WORD_1
v_fmac_f32 v165, v204, v204
s_waitcnt lgkmcnt(3)
v_or_b32_e64 v82, v140, v141
v_rcp_f16_sdwa v151, v150 dst_sel:WORD_1 dst_unused:UNUSED_PRESERVE src0_sel:WORD_1
v_fmac_f32 v165, v205, v205
s_waitcnt lgkmcnt(2)
v_or_b32_e64 v83, v142, v143
v_rcp_f16_sdwa v148, v147 dst_sel:WORD_1 dst_unused:UNUSED_PRESERVE src0_sel:WORD_1
v_fmac_f32 v165, v206, v206
s_waitcnt lgkmcnt(0)
v_or_b32_e64 v84, v144, v145
v_pk_mul_f16 v85, v155, v154
v_fmac_f32 v165, v207, v207
v_pk_mul_f16 v86, v152, v151
v_pk_mul_f16 v87, v149, v148
s_setprio 2
v_mfma_f32_32x32x16_f16 v[192:207], v[80:83], v[208:211], 0
v_mfma_f32_32x32x16_f16 v[192:207], v[84:87], v[212:215], v[192:207]
v_cvt_pkrtz_f16_f32 v137, v120, v121
v_cvt_pkrtz_f16_f32 v139, v122, v123
v_cvt_pkrtz_f16_f32 v141, v124, v125
v_cvt_pkrtz_f16_f32 v143, v126, v127
v_cvt_pkrtz_f16_f32 v145, v128, v129
v_cvt_pk_f16_f32 v155, v130, v131
v_cvt_pk_f16_f32 v152, v132, v133
v_cvt_pk_f16_f32 v149, v134, v135
v_pk_fma_f16 v154, v155, v155, s48
v_and_b32_e64 v137, s49, v137
v_pk_fma_f16 v151, v152, v152, s48
v_and_b32_e64 v139, s49, v139
v_pk_fma_f16 v148, v149, v149, s48
v_permlane16_swap_b32 v80, v84
v_pk_mul_f16 v154, v155, v154
v_bfe_u32 v136, v137, 2, 14
v_permlane16_swap_b32 v81, v85
v_pk_mul_f16 v151, v152, v151
v_pk_mul_f16 v148, v149, v148
v_bfe_u32 v138, v139, 2, 14
v_permlane16_swap_b32 v82, v86
v_exp_f16 v153, v154
v_permlane16_swap_b32 v83, v87
v_lshrrev_b32 v137, 18, v137
v_exp_f16 v150, v151
v_fmac_f32 v166, v192, v192
v_lshrrev_b32 v139, 18, v139
v_exp_f16 v147, v148
v_fmac_f32 v166, v193, v193
v_and_b32 v141, s49, v141
v_and_b32_e64 v143, s49, v143
ds_read_u16_d16 v136, v136
ds_read_u16_d16 v138, v138
ds_read_u16_d16_hi v137, v137
ds_read_u16_d16_hi v139, v139
v_fmac_f32_e64 v166, v194, v194
v_exp_f16_sdwa v153, v154 dst_sel:WORD_1 dst_unused:UNUSED_PRESERVE src0_sel:WORD_1
v_bfe_u32 v140, v141, 2, 14
v_fmac_f32_e64 v166, v195, v195
v_exp_f16_sdwa v150, v151 dst_sel:WORD_1 dst_unused:UNUSED_PRESERVE src0_sel:WORD_1
v_fmac_f32_e64 v166, v196, v196
v_bfe_u32 v142, v143, 2, 14
v_exp_f16_sdwa v147, v148 dst_sel:WORD_1 dst_unused:UNUSED_PRESERVE src0_sel:WORD_1
v_fmac_f32 v166, v197, v197
v_lshrrev_b32 v141, 18, v141
v_pk_add_f16 v153, v153, 1.0 op_sel_hi:[1,0]
v_lshrrev_b32 v143, 18, v143
v_fmac_f32 v166, v198, v198
v_pk_add_f16 v150, v150, 1.0 op_sel_hi:[1,0]
v_pk_add_f16 v147, v147, 1.0 op_sel_hi:[1,0]
v_fmac_f32 v166, v199, v199
v_and_b32 v145, s49, v145
v_rcp_f16 v154, v153
v_fmac_f32 v166, v200, v200
v_bfe_u32 v144, v145, 2, 14
v_rcp_f16 v151, v150
v_fmac_f32 v166, v201, v201
v_lshrrev_b32_e64 v145, 18, v145
ds_read_u16_d16 v140, v140
ds_read_u16_d16 v142, v142
ds_read_u16_d16_hi v141, v141
ds_read_u16_d16_hi v143, v143
ds_read_u16_d16 v144, v144
ds_read_u16_d16_hi v145, v145
v_rcp_f16 v148, v147
v_fmac_f32 v166, v202, v202
s_waitcnt lgkmcnt(6)
v_or_b32 v88, v136, v137
v_or_b32 v89, v138, v139
v_fmac_f32 v166, v203, v203
v_rcp_f16_sdwa v154, v153 dst_sel:WORD_1 dst_unused:UNUSED_PRESERVE src0_sel:WORD_1
v_fmac_f32 v166, v204, v204
s_waitcnt lgkmcnt(3)
v_or_b32_e64 v90, v140, v141
v_rcp_f16_sdwa v151, v150 dst_sel:WORD_1 dst_unused:UNUSED_PRESERVE src0_sel:WORD_1
v_fmac_f32 v166, v205, v205
s_waitcnt lgkmcnt(2)
v_or_b32_e64 v91, v142, v143
v_rcp_f16_sdwa v148, v147 dst_sel:WORD_1 dst_unused:UNUSED_PRESERVE src0_sel:WORD_1
v_fmac_f32 v166, v206, v206
s_waitcnt lgkmcnt(0)
v_or_b32_e64 v92, v144, v145
v_pk_mul_f16 v93, v155, v154
v_fmac_f32 v166, v207, v207
v_pk_mul_f16 v94, v152, v151
v_pk_mul_f16 v95, v149, v148
s_setprio 1
v_mfma_f32_32x32x16_f16 v[192:207], v[88:91], v[208:211], 0
v_mfma_f32_32x32x16_f16 v[192:207], v[92:95], v[212:215], v[192:207]
v_permlane16_swap_b32 v88, v92
v_permlane16_swap_b32 v89, v93
v_permlane16_swap_b32 v90, v94
v_permlane16_swap_b32 v91, v95
s_nop 7
v_fmac_f32 v167, v192, v192
v_fmac_f32 v167, v193, v193
v_fmac_f32 v167, v194, v194
v_fmac_f32 v167, v195, v195
v_fmac_f32 v167, v196, v196
v_fmac_f32 v167, v197, v197
v_fmac_f32 v167, v198, v198
v_fmac_f32 v167, v199, v199
v_fmac_f32 v167, v200, v200
v_fmac_f32 v167, v201, v201
v_fmac_f32 v167, v202, v202
s_setprio 0
v_fmac_f32 v167, v203, v203
v_fmac_f32 v167, v204, v204
v_fmac_f32 v167, v205, v205
v_fmac_f32 v167, v206, v206
v_fmac_f32 v167, v207, v207
s_setprio 3
v_and_b32 v136, 51, v251
v_bfe_u32 v137, v251, 2, 1
v_lshl_add_u32 v136, v137, 3, v136
v_bfe_u32 v137, v251, 3, 1
v_lshl_add_u32 v136, v137, 2, v136
v_lshl_add_u32 v136, v136, 2, s72
v_permlane32_swap_b32 v156, v157
v_add_f32 v156, v156, v157
ds_write_b32 v136, v156 offset:7168
v_permlane32_swap_b32 v158, v159
v_add_f32 v158, v158, v159
ds_write_b32 v136, v158 offset:7424
v_permlane32_swap_b32 v160, v161
v_add_f32 v160, v160, v161
ds_write_b32 v136, v160 offset:7680
v_permlane32_swap_b32 v162, v163
v_add_f32 v162, v162, v163
ds_write_b32 v136, v162 offset:7936
v_permlane32_swap_b32 v164, v165
v_add_f32 v164, v164, v165
ds_write_b32 v136, v164 offset:8192
v_permlane32_swap_b32 v166, v167
v_add_f32 v166, v166, v167
ds_write_b32 v136, v166 offset:8448
v_mov_b32 v128, 16256
v_mov_b32_e64 v129, 1
s_waitcnt lgkmcnt(0)
s_mov_b64 exec, 1
ds_add_rtn_u32 v130, v128, v129
s_mov_b64 exec, -1
s_waitcnt lgkmcnt(0)
v_readfirstlane_b32 s43, v130
s_nop 1
s_cmp_lg_u32 s43, 7
s_cbranch_scc1 Lnopub
v_min_u32 v131, 47, v251
v_lshlrev_b32 v132, 5, v131
v_add_u32 v132, 97280, v132
ds_read_b128 v[168:171], v132
ds_read_b128 v[172:175], v132 offset:16
ds_read_b128 v[176:179], v132 offset:9216
ds_read_b128 v[180:183], v132 offset:9232
ds_read_b128 v[184:187], v132 offset:18432
ds_read_b128 v[188:191], v132 offset:18448
ds_read_b128 v[192:195], v132 offset:27648
ds_read_b128 v[196:199], v132 offset:27664
ds_read_b128 v[200:203], v132 offset:36864
ds_read_b128 v[204:207], v132 offset:36880
ds_read_b128 v[208:211], v132 offset:46080
ds_read_b128 v[212:215], v132 offset:46096
ds_read_b128 v[216:219], v132 offset:55296
ds_read_b128 v[220:223], v132 offset:55312
ds_read_b128 v[120:123], v132 offset:64512
ds_read_b128 v[124:127], v132 offset:64528
v_lshlrev_b32_e64 v134, 13, v131
v_add_u32 v135, 4096, v134
s_waitcnt lgkmcnt(13)
v_add_f32 v168, v168, v176
v_add_f32 v169, v169, v177
v_add_f32 v170, v170, v178
v_add_f32 v171, v171, v179
s_waitcnt lgkmcnt(12)
v_add_f32 v172, v172, v180
v_add_f32 v173, v173, v181
v_add_f32 v174, v174, v182
v_add_f32 v175, v175, v183
s_waitcnt lgkmcnt(9)
v_add_f32 v184, v184, v192
v_add_f32 v185, v185, v193
v_add_f32 v186, v186, v194
v_add_f32 v187, v187, v195
s_waitcnt lgkmcnt(8)
v_add_f32 v188, v188, v196
v_add_f32 v189, v189, v197
v_add_f32 v190, v190, v198
v_add_f32 v191, v191, v199
s_waitcnt lgkmcnt(5)
v_add_f32 v200, v200, v208
v_add_f32 v201, v201, v209
v_add_f32 v202, v202, v210
v_add_f32 v203, v203, v211
s_waitcnt lgkmcnt(4)
v_add_f32 v204, v204, v212
v_add_f32 v205, v205, v213
v_add_f32 v206, v206, v214
v_add_f32 v207, v207, v215
s_waitcnt lgkmcnt(1)
v_add_f32 v216, v216, v120
v_add_f32 v217, v217, v121
v_add_f32 v218, v218, v122
v_add_f32 v219, v219, v123
s_waitcnt lgkmcnt(0)
v_add_f32 v220, v220, v124
v_add_f32 v221, v221, v125
v_add_f32 v222, v222, v126
v_add_f32 v223, v223, v127
v_add_f32 v168, v168, v184
v_add_f32 v169, v169, v185
v_add_f32 v170, v170, v186
v_add_f32 v171, v171, v187
v_add_f32 v172, v172, v188
v_add_f32 v173, v173, v189
v_add_f32 v174, v174, v190
v_add_f32 v175, v175, v191
v_add_f32 v200, v200, v216
v_add_f32 v201, v201, v217
v_add_f32 v202, v202, v218
v_add_f32 v203, v203, v219
v_add_f32 v204, v204, v220
v_add_f32 v205, v205, v221
v_add_f32 v206, v206, v222
v_add_f32 v207, v207, v223
v_add_f32 v168, v168, v200
v_add_f32 v169, v169, v201
v_add_f32 v170, v170, v202
v_add_f32 v171, v171, v203
v_add_f32 v172, v172, v204
v_add_f32 v173, v173, v205
v_add_f32 v174, v174, v206
v_add_f32 v175, v175, v207
v_min_u32 v176, -2, v168
v_min_u32 v177, -2, v169
v_min_u32 v178, -2, v170
v_min_u32 v179, -2, v171
v_min_u32 v180, -2, v172
v_min_u32 v181, -2, v173
v_min_u32_e64 v182, -2, v174
v_min_u32 v183, -2, v175
s_lshl_b32 s43, s2, 4
buffer_store_dwordx4 v[176:179], v134, s[32:35], s43 offen sc1
buffer_store_dwordx4 v[180:183], v135, s[32:35], s43 offen sc1
ds_write_b32 v128, v129 offset:4
s_waitcnt lgkmcnt(0)
s_nop 1
Lnopub:
v_mov_b32 v252, v240
s_mov_b32 s77, 0
s_cmp_lg_u32 s40, 0
s_cbranch_scc1 Lnorole
s_cmp_lt_u32 s2, 96
s_cselect_b32 s77, 1, 2
v_mov_b32 v156, -1
v_mov_b32 v157, -1
v_mov_b32 v158, -1
v_mov_b32 v159, -1
v_mov_b32 v160, -1
v_mov_b32 v161, -1
v_mov_b32 v162, -1
v_mov_b32 v163, -1
v_mov_b32 v164, -1
v_mov_b32 v165, -1
v_mov_b32 v166, -1
v_mov_b32 v167, -1
v_mov_b32 v240, -1
v_mov_b32 v241, -1
v_mov_b32 v242, -1
v_mov_b32 v243, -1
s_call_b64 s[78:79], Lpoll
Lnorole:
s_setprio 0
ds_read_b128 v[224:227], v248 offset:47104
ds_read_b128 v[228:231], v248 offset:50176
ds_read_b128 v[232:235], v248 offset:48128
ds_read_b128 v[236:239], v248 offset:51200
s_setprio 2
s_waitcnt lgkmcnt(3)
v_mfma_f32_32x32x16_bf16 v[120:135], v[224:227], v[96:99], 0
s_waitcnt lgkmcnt(2)
ds_read_b128 v[224:227], v248 offset:49152
v_mfma_f32_32x32x16_bf16 v[120:135], v[228:231], v[100:103], v[120:135]
s_waitcnt lgkmcnt(2)
ds_read_b128 v[228:231], v248 offset:52224
v_mfma_f32_32x32x16_bf16 v[120:135], v[232:235], v[104:107], v[120:135]
s_waitcnt lgkmcnt(2)
ds_read_b128 v[232:235], v248 offset:53248
v_mfma_f32_32x32x16_bf16 v[120:135], v[236:239], v[108:111], v[120:135]
s_waitcnt lgkmcnt(2)
ds_read_b128 v[236:239], v248 offset:56320
v_mfma_f32_32x32x16_bf16 v[120:135], v[224:227], v[112:115], v[120:135]
s_waitcnt lgkmcnt(2)
ds_read_b128 v[224:227], v248 offset:54272
v_mfma_f32_32x32x16_bf16 v[120:135], v[228:231], v[116:119], v[120:135]
s_cmp_eq_u32 s77, 0
s_cbranch_scc1 Lpp0
s_getreg_b32 s43, hwreg(HW_REG_IB_STS, 0, 4)
s_cmp_lg_u32 s43, 0
s_cbranch_scc1 Lpp0
s_call_b64 s[78:79], Lpoll
s_setprio 2
Lpp0:
s_nop 9
v_cvt_pkrtz_f16_f32 v137, v120, v121
v_cvt_pkrtz_f16_f32 v139, v122, v123
v_cvt_pkrtz_f16_f32 v141, v124, v125
v_cvt_pkrtz_f16_f32 v143, v126, v127
v_cvt_pkrtz_f16_f32 v145, v128, v129
v_cvt_pk_f16_f32 v155, v130, v131
v_cvt_pk_f16_f32 v152, v132, v133
v_cvt_pk_f16_f32 v149, v134, v135
s_waitcnt lgkmcnt(0)
ds_read_b128 v[228:231], v248 offset:57344
v_mfma_f32_32x32x16_bf16 v[120:135], v[232:235], v[96:99], 0
v_pk_fma_f16 v154, v155, v155, s48
v_and_b32 v137, s49, v137
v_pk_fma_f16 v151, v152, v152, s48
v_and_b32_e64 v139, s49, v139
v_pk_fma_f16 v148, v149, v149, s48
v_pk_mul_f16 v154, v155, v154
v_bfe_u32 v136, v137, 2, 14
v_pk_mul_f16 v151, v152, v151
ds_read_b128 v[232:235], v248 offset:55296
ds_read_u16_d16 v136, v136
v_mfma_f32_32x32x16_bf16 v[120:135], v[236:239], v[100:103], v[120:135]
v_pk_mul_f16 v148, v149, v148
v_bfe_u32 v138, v139, 2, 14
v_exp_f16 v153, v154
v_lshrrev_b32 v137, 18, v137
v_exp_f16 v150, v151
s_setprio 1
v_lshrrev_b32_e64 v139, 18, v139
ds_read_b128 v[236:239], v248 offset:58368
ds_read_u16_d16 v138, v138
ds_read_u16_d16_hi v137, v137
ds_read_u16_d16_hi v139, v139
v_mfma_f32_32x32x16_bf16 v[120:135], v[224:227], v[104:107], v[120:135]
v_exp_f16 v147, v148
v_and_b32 v141, s49, v141
v_and_b32 v143, s49, v143
v_exp_f16_sdwa v153, v154 dst_sel:WORD_1 dst_unused:UNUSED_PRESERVE src0_sel:WORD_1
v_bfe_u32 v140, v141, 2, 14
v_exp_f16_sdwa v150, v151 dst_sel:WORD_1 dst_unused:UNUSED_PRESERVE src0_sel:WORD_1
s_waitcnt lgkmcnt(6)
ds_read_b128 v[224:227], v248 offset:59392
ds_read_u16_d16 v140, v140
v_mfma_f32_32x32x16_bf16 v[120:135], v[228:231], v[108:111], v[120:135]
v_bfe_u32 v142, v143, 2, 14
v_exp_f16_sdwa v147, v148 dst_sel:WORD_1 dst_unused:UNUSED_PRESERVE src0_sel:WORD_1
v_lshrrev_b32_e64 v141, 18, v141
v_pk_add_f16 v153, v153, 1.0 op_sel_hi:[1,0]
v_lshrrev_b32 v143, 18, v143
v_pk_add_f16 v150, v150, 1.0 op_sel_hi:[1,0]
v_pk_add_f16 v147, v147, 1.0 op_sel_hi:[1,0]
s_waitcnt lgkmcnt(6)
ds_read_b128 v[228:231], v248 offset:62464
ds_read_u16_d16 v142, v142
ds_read_u16_d16_hi v141, v141
ds_read_u16_d16_hi v143, v143
v_mfma_f32_32x32x16_bf16 v[120:135], v[232:235], v[112:115], v[120:135]
v_and_b32 v145, s49, v145
v_rcp_f16 v154, v153
v_bfe_u32 v144, v145, 2, 14
v_rcp_f16_e64 v151, v150
v_lshrrev_b32 v145, 18, v145
s_waitcnt lgkmcnt(6)
ds_read_b128 v[232:235], v248 offset:60416
ds_read_u16_d16 v144, v144
ds_read_u16_d16_hi v145, v145
v_mfma_f32_32x32x16_bf16 v[120:135], v[236:239], v[116:119], v[120:135]
v_rcp_f16 v148, v147
v_or_b32 v168, v136, v137
v_or_b32_e64 v169, v138, v139
v_rcp_f16_sdwa v154, v153 dst_sel:WORD_1 dst_unused:UNUSED_PRESERVE src0_sel:WORD_1
s_waitcnt lgkmcnt(4)
v_or_b32 v170, v140, v141
v_rcp_f16_sdwa v151, v150 dst_sel:WORD_1 dst_unused:UNUSED_PRESERVE src0_sel:WORD_1
s_waitcnt lgkmcnt(3)
v_or_b32 v171, v142, v143
v_rcp_f16_sdwa v148, v147 dst_sel:WORD_1 dst_unused:UNUSED_PRESERVE src0_sel:WORD_1
s_waitcnt lgkmcnt(0)
v_or_b32_e64 v172, v144, v145
v_pk_mul_f16 v173, v155, v154
v_pk_mul_f16 v174, v152, v151
v_pk_mul_f16 v175, v149, v148
s_cmp_eq_u32 s77, 0
s_cbranch_scc1 Lpp1
s_getreg_b32 s43, hwreg(HW_REG_IB_STS, 0, 4)
s_cmp_lg_u32 s43, 0
s_cbranch_scc1 Lpp1
s_call_b64 s[78:79], Lpoll
s_setprio 1
Lpp1:
v_cvt_pkrtz_f16_f32 v137, v120, v121
v_cvt_pkrtz_f16_f32 v139, v122, v123
v_cvt_pkrtz_f16_f32 v141, v124, v125
v_cvt_pkrtz_f16_f32 v143, v126, v127
v_cvt_pkrtz_f16_f32 v145, v128, v129
v_cvt_pk_f16_f32 v155, v130, v131
v_cvt_pk_f16_f32 v152, v132, v133
v_cvt_pk_f16_f32 v149, v134, v135
ds_read_b128 v[236:239], v248 offset:63488
v_mfma_f32_32x32x16_bf16 v[120:135], v[224:227], v[96:99], 0
v_pk_fma_f16 v154, v155, v155, s48
v_permlane16_swap_b32 v168, v172
v_and_b32 v137, s49, v137
v_pk_fma_f16 v151, v152, v152, s48
v_and_b32_e64 v139, s49, v139
v_pk_fma_f16 v148, v149, v149, s48
v_pk_mul_f16 v154, v155, v154
v_bfe_u32 v136, v137, 2, 14
v_pk_mul_f16 v151, v152, v151
ds_read_b128 v[224:227], v248 offset:61440
ds_read_u16_d16 v136, v136
v_mfma_f32_32x32x16_bf16 v[120:135], v[228:231], v[100:103], v[120:135]
v_pk_mul_f16 v148, v149, v148
v_bfe_u32 v138, v139, 2, 14
v_exp_f16 v153, v154
v_lshrrev_b32 v137, 18, v137
v_exp_f16 v150, v151
v_permlane16_swap_b32 v169, v173
v_lshrrev_b32_e64 v139, 18, v139
ds_read_b128 v[228:231], v248 offset:64512
ds_read_u16_d16 v138, v138
ds_read_u16_d16_hi v137, v137
ds_read_u16_d16_hi v139, v139
v_mfma_f32_32x32x16_bf16 v[120:135], v[232:235], v[104:107], v[120:135]
v_exp_f16 v147, v148
s_setprio 0
v_and_b32_e64 v141, s49, v141
v_and_b32 v143, s49, v143
v_exp_f16_sdwa v153, v154 dst_sel:WORD_1 dst_unused:UNUSED_PRESERVE src0_sel:WORD_1
v_bfe_u32 v140, v141, 2, 14
v_exp_f16_sdwa v150, v151 dst_sel:WORD_1 dst_unused:UNUSED_PRESERVE src0_sel:WORD_1
s_waitcnt lgkmcnt(6)
ds_read_b128 v[232:235], v249
ds_read_u16_d16 v140, v140
v_mfma_f32_32x32x16_bf16 v[120:135], v[236:239], v[108:111], v[120:135]
v_bfe_u32 v142, v143, 2, 14
v_exp_f16_sdwa v147, v148 dst_sel:WORD_1 dst_unused:UNUSED_PRESERVE src0_sel:WORD_1
v_lshrrev_b32 v141, 18, v141
v_permlane16_swap_b32 v170, v174
v_pk_add_f16 v153, v153, 1.0 op_sel_hi:[1,0]
v_lshrrev_b32 v143, 18, v143
v_pk_add_f16 v150, v150, 1.0 op_sel_hi:[1,0]
v_pk_add_f16 v147, v147, 1.0 op_sel_hi:[1,0]
s_waitcnt lgkmcnt(6)
ds_read_b128 v[236:239], v249 offset:3072
ds_read_u16_d16 v142, v142
ds_read_u16_d16_hi v141, v141
ds_read_u16_d16_hi v143, v143
v_mfma_f32_32x32x16_bf16 v[120:135], v[224:227], v[112:115], v[120:135]
v_and_b32 v145, s49, v145
v_rcp_f16 v154, v153
v_bfe_u32 v144, v145, 2, 14
v_rcp_f16 v151, v150
v_lshrrev_b32 v145, 18, v145
v_rcp_f16 v148, v147
s_waitcnt lgkmcnt(6)
ds_read_b128 v[224:227], v249 offset:1024
ds_read_u16_d16 v144, v144
ds_read_u16_d16_hi v145, v145
v_mfma_f32_32x32x16_bf16 v[120:135], v[228:231], v[116:119], v[120:135]
v_or_b32 v176, v136, v137
v_permlane16_swap_b32 v171, v175
v_or_b32_e64 v177, v138, v139
v_rcp_f16_sdwa v154, v153 dst_sel:WORD_1 dst_unused:UNUSED_PRESERVE src0_sel:WORD_1
s_waitcnt lgkmcnt(4)
v_or_b32 v178, v140, v141
v_rcp_f16_sdwa v151, v150 dst_sel:WORD_1 dst_unused:UNUSED_PRESERVE src0_sel:WORD_1
s_waitcnt lgkmcnt(3)
v_or_b32 v179, v142, v143
v_rcp_f16_sdwa v148, v147 dst_sel:WORD_1 dst_unused:UNUSED_PRESERVE src0_sel:WORD_1
s_waitcnt lgkmcnt(0)
v_or_b32 v180, v144, v145
v_pk_mul_f16 v181, v155, v154
v_pk_mul_f16 v182, v152, v151
v_pk_mul_f16 v183, v149, v148
s_cmp_eq_u32 s77, 0
s_cbranch_scc1 Lpp2
s_getreg_b32 s43, hwreg(HW_REG_IB_STS, 0, 4)
s_cmp_lg_u32 s43, 0
s_cbranch_scc1 Lpp2
s_call_b64 s[78:79], Lpoll
s_setprio 0
Lpp2:
s_setprio 2
v_cvt_pkrtz_f16_f32 v137, v120, v121
v_cvt_pkrtz_f16_f32 v139, v122, v123
v_cvt_pkrtz_f16_f32 v141, v124, v125
v_cvt_pkrtz_f16_f32 v143, v126, v127
v_cvt_pkrtz_f16_f32 v145, v128, v129
v_cvt_pk_f16_f32 v155, v130, v131
v_cvt_pk_f16_f32 v152, v132, v133
v_cvt_pk_f16_f32 v149, v134, v135
ds_read_b128 v[228:231], v249 offset:4096
v_mfma_f32_32x32x16_bf16 v[120:135], v[232:235], v[96:99], 0
v_pk_fma_f16 v154, v155, v155, s48
v_permlane16_swap_b32 v176, v180
v_and_b32 v137, s49, v137
v_pk_fma_f16 v151, v152, v152, s48
v_and_b32_e64 v139, s49, v139
v_pk_fma_f16 v148, v149, v149, s48
v_pk_mul_f16 v154, v155, v154
v_bfe_u32 v136, v137, 2, 14
v_pk_mul_f16 v151, v152, v151
ds_read_b128 v[232:235], v249 offset:2048
ds_read_u16_d16 v136, v136
v_mfma_f32_32x32x16_bf16 v[120:135], v[236:239], v[100:103], v[120:135]
v_pk_mul_f16 v148, v149, v148
v_bfe_u32 v138, v139, 2, 14
v_exp_f16 v153, v154
v_lshrrev_b32 v137, 18, v137
v_exp_f16 v150, v151
v_permlane16_swap_b32 v177, v181
v_lshrrev_b32_e64 v139, 18, v139
ds_read_b128 v[236:239], v249 offset:5120
ds_read_u16_d16 v138, v138
ds_read_u16_d16_hi v137, v137
ds_read_u16_d16_hi v139, v139
v_mfma_f32_32x32x16_bf16 v[120:135], v[224:227], v[104:107], v[120:135]
v_exp_f16 v147, v148
v_and_b32 v141, s49, v141
v_and_b32 v143, s49, v143
v_exp_f16_sdwa v153, v154 dst_sel:WORD_1 dst_unused:UNUSED_PRESERVE src0_sel:WORD_1
v_bfe_u32 v140, v141, 2, 14
v_exp_f16_sdwa v150, v151 dst_sel:WORD_1 dst_unused:UNUSED_PRESERVE src0_sel:WORD_1
s_waitcnt lgkmcnt(6)
ds_read_b128 v[224:227], v249 offset:6144
ds_read_u16_d16 v140, v140
v_mfma_f32_32x32x16_bf16 v[120:135], v[228:231], v[108:111], v[120:135]
v_bfe_u32 v142, v143, 2, 14
v_exp_f16_sdwa v147, v148 dst_sel:WORD_1 dst_unused:UNUSED_PRESERVE src0_sel:WORD_1
v_lshrrev_b32 v141, 18, v141
v_permlane16_swap_b32 v178, v182
v_pk_add_f16 v153, v153, 1.0 op_sel_hi:[1,0]
v_lshrrev_b32 v143, 18, v143
v_pk_add_f16 v150, v150, 1.0 op_sel_hi:[1,0]
v_pk_add_f16 v147, v147, 1.0 op_sel_hi:[1,0]
s_waitcnt lgkmcnt(6)
ds_read_b128 v[228:231], v249 offset:9216
ds_read_u16_d16 v142, v142
ds_read_u16_d16_hi v141, v141
ds_read_u16_d16_hi v143, v143
v_mfma_f32_32x32x16_bf16 v[120:135], v[232:235], v[112:115], v[120:135]
v_and_b32 v145, s49, v145
v_rcp_f16 v154, v153
v_bfe_u32 v144, v145, 2, 14
v_rcp_f16 v151, v150
v_lshrrev_b32 v145, 18, v145
v_rcp_f16 v148, v147
s_waitcnt lgkmcnt(6)
ds_read_b128 v[232:235], v249 offset:7168
ds_read_u16_d16 v144, v144
ds_read_u16_d16_hi v145, v145
v_mfma_f32_32x32x16_bf16 v[120:135], v[236:239], v[116:119], v[120:135]
v_or_b32 v184, v136, v137
v_permlane16_swap_b32 v179, v183
v_or_b32_e64 v185, v138, v139
v_rcp_f16_sdwa v154, v153 dst_sel:WORD_1 dst_unused:UNUSED_PRESERVE src0_sel:WORD_1
s_waitcnt lgkmcnt(4)
v_or_b32 v186, v140, v141
v_rcp_f16_sdwa v151, v150 dst_sel:WORD_1 dst_unused:UNUSED_PRESERVE src0_sel:WORD_1
s_waitcnt lgkmcnt(3)
v_or_b32 v187, v142, v143
v_rcp_f16_sdwa v148, v147 dst_sel:WORD_1 dst_unused:UNUSED_PRESERVE src0_sel:WORD_1
s_waitcnt lgkmcnt(0)
v_or_b32_e64 v188, v144, v145
v_pk_mul_f16 v189, v155, v154
v_pk_mul_f16 v190, v152, v151
v_pk_mul_f16 v191, v149, v148
s_cmp_eq_u32 s77, 0
s_cbranch_scc1 Lpp3
s_getreg_b32 s43, hwreg(HW_REG_IB_STS, 0, 4)
s_cmp_lg_u32 s43, 0
s_cbranch_scc1 Lpp3
s_call_b64 s[78:79], Lpoll
s_setprio 2
Lpp3:
v_cvt_pkrtz_f16_f32 v137, v120, v121
v_cvt_pkrtz_f16_f32 v139, v122, v123
v_cvt_pkrtz_f16_f32 v141, v124, v125
v_cvt_pkrtz_f16_f32 v143, v126, v127
v_cvt_pkrtz_f16_f32 v145, v128, v129
v_cvt_pk_f16_f32 v155, v130, v131
v_cvt_pk_f16_f32 v152, v132, v133
v_cvt_pk_f16_f32 v149, v134, v135
ds_read_b128 v[236:239], v249 offset:10240
v_mfma_f32_32x32x16_bf16 v[120:135], v[224:227], v[96:99], 0
v_pk_fma_f16 v154, v155, v155, s48
v_permlane16_swap_b32 v184, v188
v_and_b32 v137, s49, v137
v_pk_fma_f16 v151, v152, v152, s48
v_and_b32_e64 v139, s49, v139
v_pk_fma_f16 v148, v149, v149, s48
v_pk_mul_f16 v154, v155, v154
v_bfe_u32 v136, v137, 2, 14
v_pk_mul_f16 v151, v152, v151
ds_read_b128 v[224:227], v249 offset:8192
ds_read_u16_d16 v136, v136
v_mfma_f32_32x32x16_bf16 v[120:135], v[228:231], v[100:103], v[120:135]
v_pk_mul_f16 v148, v149, v148
v_bfe_u32 v138, v139, 2, 14
v_exp_f16 v153, v154
v_lshrrev_b32 v137, 18, v137
v_exp_f16 v150, v151
s_setprio 1
v_permlane16_swap_b32 v185, v189
v_lshrrev_b32 v139, 18, v139
ds_read_b128 v[228:231], v249 offset:11264
ds_read_u16_d16 v138, v138
ds_read_u16_d16_hi v137, v137
ds_read_u16_d16_hi v139, v139
v_mfma_f32_32x32x16_bf16 v[120:135], v[232:235], v[104:107], v[120:135]
v_exp_f16 v147, v148
v_and_b32 v141, s49, v141
v_and_b32 v143, s49, v143
v_exp_f16_sdwa v153, v154 dst_sel:WORD_1 dst_unused:UNUSED_PRESERVE src0_sel:WORD_1
v_bfe_u32 v140, v141, 2, 14
v_exp_f16_sdwa v150, v151 dst_sel:WORD_1 dst_unused:UNUSED_PRESERVE src0_sel:WORD_1
s_waitcnt lgkmcnt(6)
ds_read_b128 v[232:235], v249 offset:12288
ds_read_u16_d16 v140, v140
v_mfma_f32_32x32x16_bf16 v[120:135], v[236:239], v[108:111], v[120:135]
v_bfe_u32 v142, v143, 2, 14
v_exp_f16_sdwa v147, v148 dst_sel:WORD_1 dst_unused:UNUSED_PRESERVE src0_sel:WORD_1
v_lshrrev_b32 v141, 18, v141
v_permlane16_swap_b32 v186, v190
v_pk_add_f16 v153, v153, 1.0 op_sel_hi:[1,0]
v_lshrrev_b32 v143, 18, v143
v_pk_add_f16 v150, v150, 1.0 op_sel_hi:[1,0]
v_pk_add_f16 v147, v147, 1.0 op_sel_hi:[1,0]
s_waitcnt lgkmcnt(6)
ds_read_b128 v[236:239], v249 offset:15360
ds_read_u16_d16 v142, v142
ds_read_u16_d16_hi v141, v141
ds_read_u16_d16_hi v143, v143
v_mfma_f32_32x32x16_bf16 v[120:135], v[224:227], v[112:115], v[120:135]
v_and_b32 v145, s49, v145
v_rcp_f16 v154, v153
v_bfe_u32 v144, v145, 2, 14
v_rcp_f16 v151, v150
v_lshrrev_b32 v145, 18, v145
v_rcp_f16 v148, v147
s_waitcnt lgkmcnt(6)
ds_read_b128 v[224:227], v249 offset:13312
ds_read_u16_d16 v144, v144
ds_read_u16_d16_hi v145, v145
v_mfma_f32_32x32x16_bf16 v[120:135], v[228:231], v[116:119], v[120:135]
v_or_b32 v192, v136, v137
v_permlane16_swap_b32 v187, v191
v_or_b32_e64 v193, v138, v139
v_rcp_f16_sdwa v154, v153 dst_sel:WORD_1 dst_unused:UNUSED_PRESERVE src0_sel:WORD_1
s_waitcnt lgkmcnt(4)
v_or_b32 v194, v140, v141
v_rcp_f16_sdwa v151, v150 dst_sel:WORD_1 dst_unused:UNUSED_PRESERVE src0_sel:WORD_1
s_waitcnt lgkmcnt(3)
v_or_b32 v195, v142, v143
v_rcp_f16_sdwa v148, v147 dst_sel:WORD_1 dst_unused:UNUSED_PRESERVE src0_sel:WORD_1
s_waitcnt lgkmcnt(0)
v_or_b32 v196, v144, v145
v_pk_mul_f16 v197, v155, v154
v_pk_mul_f16 v198, v152, v151
v_pk_mul_f16 v199, v149, v148
s_cmp_eq_u32 s77, 0
s_cbranch_scc1 Lpp4
s_getreg_b32 s43, hwreg(HW_REG_IB_STS, 0, 4)
s_cmp_lg_u32 s43, 0
s_cbranch_scc1 Lpp4
s_call_b64 s[78:79], Lpoll
s_setprio 1
Lpp4:
v_mov_b32 v253, 16256
Lw2w:
ds_read_b32 v254, v253 offset:4
s_waitcnt lgkmcnt(0)
v_readfirstlane_b32 s43, v254
s_cmp_eq_u32 s76, 0
s_cbranch_scc1 Lw2x
s_sub_u32 s76, s76, 1
s_cmp_lt_u32 s43, 1
s_cbranch_scc0 Lw2x
s_sleep 2
s_branch Lw2w
Lw2x:
s_add_u32 m0, s72, 7168
s_add_u32 s43, s82, 6208
buffer_load_dwordx4 v252, s[16:19], s43 offen lds
s_add_u32 m0, s72, 8192
s_add_u32 s43, s82, 6272
buffer_load_dwordx4 v252, s[16:19], s43 offen lds
v_cvt_pkrtz_f16_f32 v137, v120, v121
v_cvt_pkrtz_f16_f32 v139, v122, v123
v_cvt_pkrtz_f16_f32 v141, v124, v125
v_cvt_pkrtz_f16_f32 v143, v126, v127
v_cvt_pkrtz_f16_f32 v145, v128, v129
v_cvt_pk_f16_f32 v155, v130, v131
v_cvt_pk_f16_f32 v152, v132, v133
v_cvt_pk_f16_f32 v149, v134, v135
ds_read_b128 v[228:231], v249 offset:16384
v_mfma_f32_32x32x16_bf16 v[120:135], v[232:235], v[96:99], 0
v_pk_fma_f16 v154, v155, v155, s48
v_permlane16_swap_b32 v192, v196
v_and_b32 v137, s49, v137
v_pk_fma_f16 v151, v152, v152, s48
v_and_b32_e64 v139, s49, v139
v_pk_fma_f16 v148, v149, v149, s48
v_pk_mul_f16 v154, v155, v154
v_bfe_u32 v136, v137, 2, 14
v_pk_mul_f16 v151, v152, v151
ds_read_b128 v[232:235], v249 offset:14336
ds_read_u16_d16 v136, v136
v_mfma_f32_32x32x16_bf16 v[120:135], v[236:239], v[100:103], v[120:135]
v_pk_mul_f16 v148, v149, v148
v_bfe_u32 v138, v139, 2, 14
v_exp_f16 v153, v154
v_lshrrev_b32 v137, 18, v137
v_exp_f16 v150, v151
v_permlane16_swap_b32 v193, v197
v_lshrrev_b32_e64 v139, 18, v139
ds_read_b128 v[236:239], v249 offset:17408
ds_read_u16_d16 v138, v138
ds_read_u16_d16_hi v137, v137
ds_read_u16_d16_hi v139, v139
v_mfma_f32_32x32x16_bf16 v[120:135], v[224:227], v[104:107], v[120:135]
v_exp_f16 v147, v148
s_setprio 0
v_and_b32_e64 v141, s49, v141
v_and_b32 v143, s49, v143
v_exp_f16_sdwa v153, v154 dst_sel:WORD_1 dst_unused:UNUSED_PRESERVE src0_sel:WORD_1
v_bfe_u32 v140, v141, 2, 14
v_exp_f16_sdwa v150, v151 dst_sel:WORD_1 dst_unused:UNUSED_PRESERVE src0_sel:WORD_1
s_waitcnt lgkmcnt(6)
ds_read_b128 v[224:227], v249 offset:18432
ds_read_u16_d16 v140, v140
v_mfma_f32_32x32x16_bf16 v[120:135], v[228:231], v[108:111], v[120:135]
v_bfe_u32 v142, v143, 2, 14
v_exp_f16_sdwa v147, v148 dst_sel:WORD_1 dst_unused:UNUSED_PRESERVE src0_sel:WORD_1
v_lshrrev_b32 v141, 18, v141
v_permlane16_swap_b32 v194, v198
v_pk_add_f16 v153, v153, 1.0 op_sel_hi:[1,0]
v_lshrrev_b32 v143, 18, v143
v_pk_add_f16 v150, v150, 1.0 op_sel_hi:[1,0]
v_pk_add_f16 v147, v147, 1.0 op_sel_hi:[1,0]
s_waitcnt lgkmcnt(6)
ds_read_b128 v[228:231], v249 offset:21504
ds_read_u16_d16 v142, v142
ds_read_u16_d16_hi v141, v141
ds_read_u16_d16_hi v143, v143
v_mfma_f32_32x32x16_bf16 v[120:135], v[232:235], v[112:115], v[120:135]
v_and_b32 v145, s49, v145
v_rcp_f16 v154, v153
v_bfe_u32 v144, v145, 2, 14
v_rcp_f16 v151, v150
v_lshrrev_b32 v145, 18, v145
v_rcp_f16 v148, v147
s_waitcnt lgkmcnt(6)
ds_read_b128 v[232:235], v249 offset:19456
ds_read_u16_d16 v144, v144
ds_read_u16_d16_hi v145, v145
v_mfma_f32_32x32x16_bf16 v[120:135], v[236:239], v[116:119], v[120:135]
v_or_b32 v200, v136, v137
v_permlane16_swap_b32 v195, v199
v_or_b32_e64 v201, v138, v139
v_rcp_f16_sdwa v154, v153 dst_sel:WORD_1 dst_unused:UNUSED_PRESERVE src0_sel:WORD_1
s_waitcnt lgkmcnt(4)
v_or_b32 v202, v140, v141
v_rcp_f16_sdwa v151, v150 dst_sel:WORD_1 dst_unused:UNUSED_PRESERVE src0_sel:WORD_1
s_waitcnt lgkmcnt(3)
v_or_b32 v203, v142, v143
v_rcp_f16_sdwa v148, v147 dst_sel:WORD_1 dst_unused:UNUSED_PRESERVE src0_sel:WORD_1
s_waitcnt lgkmcnt(0)
v_or_b32 v204, v144, v145
v_pk_mul_f16 v205, v155, v154
v_pk_mul_f16 v206, v152, v151
v_pk_mul_f16 v207, v149, v148
s_cmp_eq_u32 s77, 0
s_cbranch_scc1 Lpp5
s_getreg_b32 s43, hwreg(HW_REG_IB_STS, 0, 4)
s_cmp_lg_u32 s43, 0
s_cbranch_scc1 Lpp5
s_call_b64 s[78:79], Lpoll
s_setprio 0
Lpp5:
s_setprio 2
v_cvt_pkrtz_f16_f32 v137, v120, v121
v_cvt_pkrtz_f16_f32 v139, v122, v123
v_cvt_pkrtz_f16_f32 v141, v124, v125
v_cvt_pkrtz_f16_f32 v143, v126, v127
v_cvt_pkrtz_f16_f32 v145, v128, v129
v_cvt_pk_f16_f32 v155, v130, v131
v_cvt_pk_f16_f32 v152, v132, v133
v_cvt_pk_f16_f32 v149, v134, v135
ds_read_b128 v[236:239], v249 offset:22528
v_mfma_f32_32x32x16_bf16 v[120:135], v[224:227], v[96:99], 0
v_pk_fma_f16 v154, v155, v155, s48
v_permlane16_swap_b32 v200, v204
v_and_b32 v137, s49, v137
v_pk_fma_f16 v151, v152, v152, s48
v_and_b32_e64 v139, s49, v139
v_pk_fma_f16 v148, v149, v149, s48
v_pk_mul_f16 v154, v155, v154
v_bfe_u32 v136, v137, 2, 14
v_pk_mul_f16 v151, v152, v151
ds_read_b128 v[224:227], v249 offset:20480
ds_read_u16_d16 v136, v136
v_mfma_f32_32x32x16_bf16 v[120:135], v[228:231], v[100:103], v[120:135]
v_pk_mul_f16 v148, v149, v148
v_bfe_u32 v138, v139, 2, 14
v_exp_f16 v153, v154
v_lshrrev_b32 v137, 18, v137
v_exp_f16 v150, v151
v_permlane16_swap_b32 v201, v205
v_lshrrev_b32_e64 v139, 18, v139
ds_read_b128 v[228:231], v249 offset:23552
ds_read_u16_d16 v138, v138
ds_read_u16_d16_hi v137, v137
ds_read_u16_d16_hi v139, v139
v_mfma_f32_32x32x16_bf16 v[120:135], v[232:235], v[104:107], v[120:135]
v_exp_f16 v147, v148
v_and_b32 v141, s49, v141
v_and_b32 v143, s49, v143
v_exp_f16_sdwa v153, v154 dst_sel:WORD_1 dst_unused:UNUSED_PRESERVE src0_sel:WORD_1
v_bfe_u32 v140, v141, 2, 14
v_exp_f16_sdwa v150, v151 dst_sel:WORD_1 dst_unused:UNUSED_PRESERVE src0_sel:WORD_1
s_waitcnt lgkmcnt(6)
ds_read_u16_d16 v140, v140
v_mfma_f32_32x32x16_bf16 v[120:135], v[236:239], v[108:111], v[120:135]
v_bfe_u32 v142, v143, 2, 14
v_exp_f16_sdwa v147, v148 dst_sel:WORD_1 dst_unused:UNUSED_PRESERVE src0_sel:WORD_1
v_lshrrev_b32 v141, 18, v141
v_permlane16_swap_b32 v202, v206
v_pk_add_f16 v153, v153, 1.0 op_sel_hi:[1,0]
v_lshrrev_b32 v143, 18, v143
v_pk_add_f16 v150, v150, 1.0 op_sel_hi:[1,0]
v_pk_add_f16 v147, v147, 1.0 op_sel_hi:[1,0]
s_waitcnt lgkmcnt(5)
ds_read_u16_d16 v142, v142
ds_read_u16_d16_hi v141, v141
ds_read_u16_d16_hi v143, v143
v_mfma_f32_32x32x16_bf16 v[120:135], v[224:227], v[112:115], v[120:135]
v_and_b32 v145, s49, v145
v_rcp_f16 v154, v153
v_bfe_u32 v144, v145, 2, 14
v_rcp_f16 v151, v150
v_lshrrev_b32 v145, 18, v145
v_rcp_f16 v148, v147
s_waitcnt lgkmcnt(4)
ds_read_u16_d16 v144, v144
ds_read_u16_d16_hi v145, v145
v_mfma_f32_32x32x16_bf16 v[120:135], v[228:231], v[116:119], v[120:135]
v_or_b32 v208, v136, v137
v_permlane16_swap_b32 v203, v207
v_or_b32_e64 v209, v138, v139
v_rcp_f16_sdwa v154, v153 dst_sel:WORD_1 dst_unused:UNUSED_PRESERVE src0_sel:WORD_1
s_waitcnt lgkmcnt(3)
v_or_b32 v210, v140, v141
v_rcp_f16_sdwa v151, v150 dst_sel:WORD_1 dst_unused:UNUSED_PRESERVE src0_sel:WORD_1
s_waitcnt lgkmcnt(2)
v_or_b32 v211, v142, v143
v_rcp_f16_sdwa v148, v147 dst_sel:WORD_1 dst_unused:UNUSED_PRESERVE src0_sel:WORD_1
s_waitcnt lgkmcnt(0)
v_or_b32_e64 v212, v144, v145
v_pk_mul_f16 v213, v155, v154
v_pk_mul_f16 v214, v152, v151
v_pk_mul_f16 v215, v149, v148
s_cmp_eq_u32 s77, 0
s_cbranch_scc1 Lpp6
s_getreg_b32 s43, hwreg(HW_REG_IB_STS, 0, 4)
s_cmp_lg_u32 s43, 0
s_cbranch_scc1 Lpp6
s_call_b64 s[78:79], Lpoll
s_setprio 2
Lpp6:
v_cvt_pkrtz_f16_f32 v137, v120, v121
v_cvt_pkrtz_f16_f32 v139, v122, v123
v_cvt_pkrtz_f16_f32 v141, v124, v125
v_cvt_pkrtz_f16_f32 v143, v126, v127
v_cvt_pkrtz_f16_f32 v145, v128, v129
v_cvt_pk_f16_f32 v155, v130, v131
v_cvt_pk_f16_f32 v152, v132, v133
v_cvt_pk_f16_f32 v149, v134, v135
v_pk_fma_f16 v154, v155, v155, s48
v_permlane16_swap_b32 v96, v100
v_permlane16_swap_b32 v208, v212
v_and_b32_e64 v137, s49, v137
v_pk_fma_f16 v151, v152, v152, s48
v_and_b32 v139, s49, v139
v_pk_fma_f16 v148, v149, v149, s48
v_permlane16_swap_b32 v97, v101
v_pk_mul_f16 v154, v155, v154
v_bfe_u32 v136, v137, 2, 14
v_pk_mul_f16 v151, v152, v151
v_pk_mul_f16 v148, v149, v148
v_bfe_u32 v138, v139, 2, 14
v_permlane16_swap_b32 v98, v102
v_exp_f16 v153, v154
v_lshrrev_b32 v137, 18, v137
v_exp_f16 v150, v151
v_permlane16_swap_b32 v99, v103
s_setprio 1
v_permlane16_swap_b32 v209, v213
v_lshrrev_b32 v139, 18, v139
v_exp_f16 v147, v148
v_and_b32 v141, s49, v141
v_permlane16_swap_b32 v104, v108
v_and_b32 v143, s49, v143
ds_read_u16_d16 v136, v136
ds_read_u16_d16 v138, v138
ds_read_u16_d16_hi v137, v137
ds_read_u16_d16_hi v139, v139
v_exp_f16_sdwa v153, v154 dst_sel:WORD_1 dst_unused:UNUSED_PRESERVE src0_sel:WORD_1
v_bfe_u32 v140, v141, 2, 14
v_exp_f16_sdwa v150, v151 dst_sel:WORD_1 dst_unused:UNUSED_PRESERVE src0_sel:WORD_1
v_permlane16_swap_b32 v105, v109
v_bfe_u32 v142, v143, 2, 14
v_exp_f16_sdwa v147, v148 dst_sel:WORD_1 dst_unused:UNUSED_PRESERVE src0_sel:WORD_1
v_lshrrev_b32 v141, 18, v141
v_permlane16_swap_b32 v106, v110
v_permlane16_swap_b32 v210, v214
v_pk_add_f16 v153, v153, 1.0 op_sel_hi:[1,0]
v_lshrrev_b32_e64 v143, 18, v143
v_pk_add_f16 v150, v150, 1.0 op_sel_hi:[1,0]
v_pk_add_f16 v147, v147, 1.0 op_sel_hi:[1,0]
v_permlane16_swap_b32 v107, v111
v_and_b32 v145, s49, v145
v_rcp_f16_e64 v154, v153
v_bfe_u32 v144, v145, 2, 14
v_rcp_f16 v151, v150
v_permlane16_swap_b32 v112, v116
v_lshrrev_b32_e64 v145, 18, v145
ds_read_u16_d16 v140, v140
ds_read_u16_d16 v142, v142
ds_read_u16_d16_hi v141, v141
ds_read_u16_d16_hi v143, v143
ds_read_u16_d16 v144, v144
ds_read_u16_d16_hi v145, v145
v_rcp_f16 v148, v147
s_waitcnt lgkmcnt(6)
v_or_b32 v216, v136, v137
v_permlane16_swap_b32 v113, v117
v_permlane16_swap_b32 v211, v215
v_or_b32 v217, v138, v139
v_rcp_f16_sdwa v154, v153 dst_sel:WORD_1 dst_unused:UNUSED_PRESERVE src0_sel:WORD_1
s_waitcnt lgkmcnt(3)
v_or_b32 v218, v140, v141
v_permlane16_swap_b32 v114, v118
v_rcp_f16_sdwa v151, v150 dst_sel:WORD_1 dst_unused:UNUSED_PRESERVE src0_sel:WORD_1
s_waitcnt lgkmcnt(2)
v_or_b32_e64 v219, v142, v143
v_rcp_f16_sdwa v148, v147 dst_sel:WORD_1 dst_unused:UNUSED_PRESERVE src0_sel:WORD_1
v_permlane16_swap_b32 v115, v119
s_waitcnt lgkmcnt(0)
v_or_b32_e64 v220, v144, v145
v_pk_mul_f16 v221, v155, v154
v_pk_mul_f16 v222, v152, v151
v_pk_mul_f16 v223, v149, v148
s_cmp_eq_u32 s77, 0
s_cbranch_scc1 Lpp7
s_getreg_b32 s43, hwreg(HW_REG_IB_STS, 0, 4)
s_cmp_lg_u32 s43, 0
s_cbranch_scc1 Lpp7
s_call_b64 s[78:79], Lpoll
s_setprio 1
Lpp7:
v_permlane16_swap_b32 v216, v220
v_permlane16_swap_b32 v217, v221
s_setprio 0
v_permlane16_swap_b32 v218, v222
v_permlane16_swap_b32 v219, v223
s_cmp_eq_u32 s77, 0
s_cbranch_scc1 Lpp8
s_getreg_b32 s43, hwreg(HW_REG_IB_STS, 0, 4)
s_cmp_lg_u32 s43, 0
s_cbranch_scc1 Lpp8
s_call_b64 s[78:79], Lpoll
s_setprio 0
Lpp8:
s_setprio 2
v_lshrrev_b32_e64 v225, 5, v251
v_lshl_add_u32 v224, v225, 9, s72
v_lshl_add_u32 v226, v225, 4, s72
v_and_b32 v225, 15, v251
v_lshl_add_u32 v224, v225, 4, v224
v_bfe_u32 v225, v251, 4, 1
v_lshl_add_u32 v224, v225, 3, v224
s_waitcnt vmcnt(0)
ds_read_b64_tr_b16 v[120:121], v224
ds_read_b64_tr_b16 v[122:123], v224 offset:256
ds_read_b64_tr_b16 v[124:125], v224 offset:1024
ds_read_b64_tr_b16 v[126:127], v224 offset:1280
ds_read_b64_tr_b16 v[128:129], v224 offset:2048
ds_read_b64_tr_b16 v[130:131], v224 offset:2304
ds_read_b64_tr_b16 v[132:133], v224 offset:3072
ds_read_b64_tr_b16 v[134:135], v224 offset:3328
ds_read_b64_tr_b16 v[136:137], v224 offset:4096
ds_read_b64_tr_b16 v[138:139], v224 offset:4352
ds_read_b64_tr_b16 v[140:141], v224 offset:5120
ds_read_b64_tr_b16 v[142:143], v224 offset:5376
ds_read_b64_tr_b16 v[144:145], v224 offset:6144
ds_read_b64_tr_b16 v[146:147], v224 offset:6400
ds_read_b64_tr_b16 v[148:149], v224 offset:7168
ds_read_b64_tr_b16 v[150:151], v224 offset:7424
ds_read_b64_tr_b16 v[152:153], v224 offset:8192
ds_read_b64_tr_b16 v[154:155], v224 offset:8448
v_lshrrev_b32 v225, 4, v251
v_and_b32 v227, 15, v251
v_mul_u32_u24 v252, 192, v227
v_lshl_add_u32 v252, v225, 4, v252
v_lshlrev_b32 v254, 5, v225
v_and_b32 v253, 47, v251
v_lshlrev_b32 v253, 4, v253
v_and_b32 v225, 1, v225
v_mul_u32_u24 v227, 3072, v225
v_add_u32_e64 v248, v227, v253
v_add_u32 v249, 65536, v248
v_add_u32 v250, 131072, v248
v_lshl_add_u32 v253, v225, 21, v253
v_mov_b32 v225, 16256
v_mov_b32_e64 v227, 1
s_waitcnt lgkmcnt(0)
s_mov_b64 exec, 1
ds_add_u32 v225, v227 offset:8
s_mov_b64 exec, -1
v_lshlrev_b32 v228, 16, v120
v_and_b32 v229, 4294901760, v120
v_cvt_pk_f16_f32 v120, v228, v229
v_lshlrev_b32_e64 v230, 16, v121
v_and_b32 v231, 4294901760, v121
v_cvt_pk_f16_f32 v121, v230, v231
v_lshlrev_b32_e64 v228, 16, v122
v_and_b32 v229, 4294901760, v122
v_cvt_pk_f16_f32 v122, v228, v229
v_lshlrev_b32_e64 v230, 16, v123
v_and_b32 v231, 4294901760, v123
v_cvt_pk_f16_f32 v123, v230, v231
v_lshlrev_b32_e64 v228, 16, v124
v_and_b32 v229, 4294901760, v124
v_cvt_pk_f16_f32 v124, v228, v229
v_lshlrev_b32_e64 v230, 16, v125
v_and_b32 v231, 4294901760, v125
v_cvt_pk_f16_f32 v125, v230, v231
v_lshlrev_b32_e64 v228, 16, v126
v_and_b32 v229, 4294901760, v126
v_cvt_pk_f16_f32 v126, v228, v229
v_lshlrev_b32_e64 v230, 16, v127
v_and_b32 v231, 4294901760, v127
v_cvt_pk_f16_f32 v127, v230, v231
v_lshlrev_b32_e64 v228, 16, v128
v_and_b32 v229, 4294901760, v128
v_cvt_pk_f16_f32 v128, v228, v229
v_lshlrev_b32_e64 v230, 16, v129
v_and_b32 v231, 4294901760, v129
v_cvt_pk_f16_f32 v129, v230, v231
v_lshlrev_b32_e64 v228, 16, v130
v_and_b32 v229, 4294901760, v130
v_cvt_pk_f16_f32 v130, v228, v229
v_lshlrev_b32_e64 v230, 16, v131
v_and_b32 v231, 4294901760, v131
v_cvt_pk_f16_f32 v131, v230, v231
s_cmp_eq_u32 s77, 0
s_cbranch_scc1 Lpp911
s_getreg_b32 s43, hwreg(HW_REG_IB_STS, 0, 4)
s_cmp_lg_u32 s43, 0
s_cbranch_scc1 Lpp911
s_call_b64 s[78:79], Lpoll
s_setprio 2
Lpp911:
v_lshlrev_b32 v228, 16, v132
v_and_b32 v229, 4294901760, v132
v_cvt_pk_f16_f32 v132, v228, v229
v_lshlrev_b32_e64 v230, 16, v133
v_and_b32 v231, 4294901760, v133
v_cvt_pk_f16_f32 v133, v230, v231
v_lshlrev_b32_e64 v228, 16, v134
v_and_b32 v229, 4294901760, v134
v_cvt_pk_f16_f32 v134, v228, v229
v_lshlrev_b32_e64 v230, 16, v135
v_and_b32 v231, 4294901760, v135
v_cvt_pk_f16_f32 v135, v230, v231
v_lshlrev_b32_e64 v228, 16, v136
v_and_b32 v229, 4294901760, v136
v_cvt_pk_f16_f32 v136, v228, v229
v_lshlrev_b32_e64 v230, 16, v137
v_and_b32 v231, 4294901760, v137
v_cvt_pk_f16_f32 v137, v230, v231
v_lshlrev_b32_e64 v228, 16, v138
v_and_b32 v229, 4294901760, v138
v_cvt_pk_f16_f32 v138, v228, v229
v_lshlrev_b32_e64 v230, 16, v139
v_and_b32 v231, 4294901760, v139
v_cvt_pk_f16_f32 v139, v230, v231
v_lshlrev_b32_e64 v228, 16, v140
v_and_b32 v229, 4294901760, v140
v_cvt_pk_f16_f32 v140, v228, v229
v_lshlrev_b32_e64 v230, 16, v141
v_and_b32 v231, 4294901760, v141
v_cvt_pk_f16_f32 v141, v230, v231
v_lshlrev_b32_e64 v228, 16, v142
v_and_b32 v229, 4294901760, v142
v_cvt_pk_f16_f32 v142, v228, v229
v_lshlrev_b32_e64 v230, 16, v143
v_and_b32 v231, 4294901760, v143
v_cvt_pk_f16_f32 v143, v230, v231
s_cmp_eq_u32 s77, 0
s_cbranch_scc1 Lpp923
s_getreg_b32 s43, hwreg(HW_REG_IB_STS, 0, 4)
s_cmp_lg_u32 s43, 0
s_cbranch_scc1 Lpp923
s_call_b64 s[78:79], Lpoll
s_setprio 2
Lpp923:
v_lshlrev_b32 v228, 16, v144
v_and_b32 v229, 4294901760, v144
v_cvt_pk_f16_f32 v144, v228, v229
v_lshlrev_b32_e64 v230, 16, v145
v_and_b32 v231, 4294901760, v145
v_cvt_pk_f16_f32 v145, v230, v231
v_lshlrev_b32_e64 v228, 16, v146
v_and_b32 v229, 4294901760, v146
v_cvt_pk_f16_f32 v146, v228, v229
v_lshlrev_b32_e64 v230, 16, v147
v_and_b32 v231, 4294901760, v147
v_cvt_pk_f16_f32 v147, v230, v231
v_lshlrev_b32_e64 v228, 16, v148
v_and_b32 v229, 4294901760, v148
v_cvt_pk_f16_f32 v148, v228, v229
v_lshlrev_b32_e64 v230, 16, v149
v_and_b32 v231, 4294901760, v149
v_cvt_pk_f16_f32 v149, v230, v231
v_lshlrev_b32_e64 v228, 16, v150
v_and_b32 v229, 4294901760, v150
v_cvt_pk_f16_f32 v150, v228, v229
v_lshlrev_b32_e64 v230, 16, v151
v_and_b32 v231, 4294901760, v151
v_cvt_pk_f16_f32 v151, v230, v231
v_lshlrev_b32_e64 v228, 16, v152
v_and_b32 v229, 4294901760, v152
v_cvt_pk_f16_f32 v152, v228, v229
v_lshlrev_b32_e64 v230, 16, v153
v_and_b32 v231, 4294901760, v153
v_cvt_pk_f16_f32 v153, v230, v231
v_lshlrev_b32_e64 v228, 16, v154
v_and_b32 v229, 4294901760, v154
v_cvt_pk_f16_f32 v154, v228, v229
v_lshlrev_b32_e64 v230, 16, v155
v_and_b32 v231, 4294901760, v155
v_cvt_pk_f16_f32 v155, v230, v231
s_cmp_eq_u32 s77, 0
s_cbranch_scc1 Lpp935
s_getreg_b32 s43, hwreg(HW_REG_IB_STS, 0, 4)
s_cmp_lg_u32 s43, 0
s_cbranch_scc1 Lpp935
s_call_b64 s[78:79], Lpoll
s_setprio 2
Lpp935:
v_lshl_add_u32 v224, v251, 4, s72
s_cmp_lg_u32 s40, 0
s_cbranch_scc1 Lnofin
Lspin:
s_cmp_eq_u32 s77, 0
s_cbranch_scc1 Lspinx
s_cmp_eq_u32 s76, 0
s_cbranch_scc1 Lspinx
s_sub_u32 s76, s76, 1
s_call_b64 s[78:79], Lpoll
s_branch Lspin
Lspinx:
v_add_u32_e64 v162, 0, v251
v_mul_u32_u24 v165, 2731, v162
v_lshrrev_b32_e64 v165, 16, v165
v_mul_u32_u24 v165, 9120, v165
v_lshl_add_u32 v162, v162, 2, v165
v_add_u32 v162, 90112, v162
v_add_u32_e64 v163, 64, v251
v_mul_u32_u24 v165, 2731, v163
v_lshrrev_b32_e64 v165, 16, v165
v_mul_u32_u24 v165, 9120, v165
v_lshl_add_u32 v163, v163, 2, v165
v_add_u32 v163, 90112, v163
v_add_u32 v164, 128, v251
v_mul_u32_u24 v165, 2731, v164
v_lshrrev_b32_e64 v165, 16, v165
v_mul_u32_u24 v165, 9120, v165
v_lshl_add_u32 v164, v164, 2, v165
v_add_u32 v164, 90112, v164
v_mov_b32 v165, 16256
Lrrw:
ds_read_b32 v166, v165 offset:8
s_waitcnt lgkmcnt(0)
v_readfirstlane_b32 s43, v166
s_cmp_eq_u32 s76, 0
s_cbranch_scc1 Lrrx
s_sub_u32 s76, s76, 1
s_cmp_lt_u32 s43, 8
s_cbranch_scc0 Lrrx
s_sleep 2
s_branch Lrrw
Lrrx:
ds_write_b32 v162, v244
ds_write_b32 v163, v245
ds_write_b32 v164, v246
Lnofin:
s_waitcnt lgkmcnt(0)
s_barrier
ds_read_b128 v[228:231], v226
ds_read_b128 v[232:235], v226 offset:32
ds_read_b128 v[236:239], v226 offset:64
buffer_load_dwordx4 v[240:243], v252, s[4:7], s71 offen
buffer_load_dwordx4 v[244:247], v252, s[4:7], s71 offen offset:64
s_waitcnt lgkmcnt(0)
v_pk_mul_f16 v120, v120, v228
v_pk_mul_f16 v121, v121, v229
v_pk_mul_f16 v122, v122, v230
v_pk_mul_f16 v123, v123, v231
ds_write_b128 v224, v[120:123]
v_pk_mul_f16 v124, v124, v228
v_pk_mul_f16 v125, v125, v229
v_pk_mul_f16 v126, v126, v230
v_pk_mul_f16 v127, v127, v231
ds_write_b128 v224, v[124:127] offset:1024
v_pk_mul_f16 v128, v128, v228
v_pk_mul_f16 v129, v129, v229
v_pk_mul_f16 v130, v130, v230
v_pk_mul_f16 v131, v131, v231
ds_write_b128 v224, v[128:131] offset:2048
v_pk_mul_f16 v132, v132, v232
v_pk_mul_f16 v133, v133, v233
v_pk_mul_f16 v134, v134, v234
v_pk_mul_f16 v135, v135, v235
ds_write_b128 v224, v[132:135] offset:3072
v_pk_mul_f16 v136, v136, v232
v_pk_mul_f16 v137, v137, v233
v_pk_mul_f16 v138, v138, v234
v_pk_mul_f16 v139, v139, v235
ds_write_b128 v224, v[136:139] offset:4096
v_pk_mul_f16 v140, v140, v232
v_pk_mul_f16 v141, v141, v233
v_pk_mul_f16 v142, v142, v234
v_pk_mul_f16 v143, v143, v235
ds_write_b128 v224, v[140:143] offset:5120
v_pk_mul_f16 v144, v144, v236
v_pk_mul_f16 v145, v145, v237
v_pk_mul_f16 v146, v146, v238
v_pk_mul_f16 v147, v147, v239
ds_write_b128 v224, v[144:147] offset:6144
v_pk_mul_f16 v148, v148, v236
v_pk_mul_f16 v149, v149, v237
v_pk_mul_f16 v150, v150, v238
v_pk_mul_f16 v151, v151, v239
ds_write_b128 v224, v[148:151] offset:7168
v_pk_mul_f16 v152, v152, v236
v_pk_mul_f16 v153, v153, v237
v_pk_mul_f16 v154, v154, v238
v_pk_mul_f16 v155, v155, v239
ds_write_b128 v224, v[152:155] offset:8192
s_waitcnt lgkmcnt(0)
s_barrier
s_setprio 3
ds_read_b128 v[224:227], v249 offset:24576
ds_read_b128 v[228:231], v254 offset:7936
ds_read_b128 v[232:235], v249 offset:24832
ds_read_b128 v[236:239], v254 offset:7952
s_waitcnt lgkmcnt(2)
v_mfma_f32_16x16x32_f16 v[120:123], v[224:227], v[0:3], v[228:231]
v_mfma_f32_16x16x32_f16 v[128:131], v[224:227], v[4:7], v[228:231]
s_waitcnt lgkmcnt(0)
v_mfma_f32_16x16x32_f16 v[124:127], v[232:235], v[0:3], v[236:239]
ds_read_b128 v[224:227], v249 offset:25600
ds_read_b128 v[228:231], v254 offset:8064
v_mfma_f32_16x16x32_f16 v[132:135], v[232:235], v[4:7], v[236:239]
s_waitcnt lgkmcnt(0)
v_mfma_f32_16x16x32_f16 v[136:139], v[224:227], v[0:3], v[228:231]
ds_read_b128 v[232:235], v249 offset:25856
ds_read_b128 v[236:239], v254 offset:8080
v_mfma_f32_16x16x32_f16 v[144:147], v[224:227], v[4:7], v[228:231]
s_waitcnt lgkmcnt(0)
v_mfma_f32_16x16x32_f16 v[140:143], v[232:235], v[0:3], v[236:239]
ds_read_b128 v[224:227], v249 offset:26624
ds_read_b128 v[228:231], v254 offset:16128
v_mfma_f32_16x16x32_f16 v[148:151], v[232:235], v[4:7], v[236:239]
s_waitcnt lgkmcnt(0)
v_mfma_f32_16x16x32_f16 v[152:155], v[224:227], v[0:3], v[228:231]
ds_read_b128 v[232:235], v249 offset:26880
ds_read_b128 v[236:239], v254 offset:16144
v_mfma_f32_16x16x32_f16 v[160:163], v[224:227], v[4:7], v[228:231]
s_waitcnt lgkmcnt(0)
v_mfma_f32_16x16x32_f16 v[156:159], v[232:235], v[0:3], v[236:239]
ds_read_b128 v[224:227], v249 offset:30720
ds_read_b128 v[228:231], v249 offset:30976
v_mfma_f32_16x16x32_f16 v[164:167], v[232:235], v[4:7], v[236:239]
s_waitcnt lgkmcnt(1)
v_mfma_f32_16x16x32_f16 v[120:123], v[224:227], v[8:11], v[120:123]
ds_read_b128 v[232:235], v249 offset:31744
ds_read_b128 v[236:239], v249 offset:32000
v_mfma_f32_16x16x32_f16 v[128:131], v[224:227], v[12:15], v[128:131]
s_waitcnt lgkmcnt(2)
v_mfma_f32_16x16x32_f16 v[124:127], v[228:231], v[8:11], v[124:127]
ds_read_b128 v[224:227], v249 offset:32768
v_mfma_f32_16x16x32_f16 v[132:135], v[228:231], v[12:15], v[132:135]
s_waitcnt lgkmcnt(2)
v_mfma_f32_16x16x32_f16 v[136:139], v[232:235], v[8:11], v[136:139]
ds_read_b128 v[228:231], v249 offset:33024
v_mfma_f32_16x16x32_f16 v[144:147], v[232:235], v[12:15], v[144:147]
s_waitcnt lgkmcnt(2)
v_mfma_f32_16x16x32_f16 v[140:143], v[236:239], v[8:11], v[140:143]
ds_read_b128 v[232:235], v249 offset:36864
v_mfma_f32_16x16x32_f16 v[148:151], v[236:239], v[12:15], v[148:151]
s_waitcnt lgkmcnt(2)
v_mfma_f32_16x16x32_f16 v[152:155], v[224:227], v[8:11], v[152:155]
ds_read_b128 v[236:239], v249 offset:37120
v_mfma_f32_16x16x32_f16 v[160:163], v[224:227], v[12:15], v[160:163]
s_waitcnt lgkmcnt(2)
v_mfma_f32_16x16x32_f16 v[156:159], v[228:231], v[8:11], v[156:159]
ds_read_b128 v[224:227], v249 offset:37888
v_mfma_f32_16x16x32_f16 v[164:167], v[228:231], v[12:15], v[164:167]
s_waitcnt lgkmcnt(2)
v_mfma_f32_16x16x32_f16 v[120:123], v[232:235], v[16:19], v[120:123]
buffer_load_dwordx4 v[12:15], v252, s[4:7], s71 offen offset:128
ds_read_b128 v[228:231], v249 offset:38144
v_mfma_f32_16x16x32_f16 v[128:131], v[232:235], v[20:23], v[128:131]
s_waitcnt lgkmcnt(2)
v_mfma_f32_16x16x32_f16 v[124:127], v[236:239], v[16:19], v[124:127]
ds_read_b128 v[232:235], v249 offset:38912
v_mfma_f32_16x16x32_f16 v[132:135], v[236:239], v[20:23], v[132:135]
s_waitcnt lgkmcnt(2)
v_mfma_f32_16x16x32_f16 v[136:139], v[224:227], v[16:19], v[136:139]
ds_read_b128 v[236:239], v249 offset:39168
v_mfma_f32_16x16x32_f16 v[144:147], v[224:227], v[20:23], v[144:147]
s_waitcnt lgkmcnt(2)
v_mfma_f32_16x16x32_f16 v[140:143], v[228:231], v[16:19], v[140:143]
s_add_u32 s46, s71, 98304
buffer_load_dwordx4 v[8:11], v252, s[4:7], s46 offen
ds_read_b128 v[224:227], v249 offset:43008
v_mfma_f32_16x16x32_f16 v[148:151], v[228:231], v[20:23], v[148:151]
s_waitcnt lgkmcnt(2)
v_mfma_f32_16x16x32_f16 v[152:155], v[232:235], v[16:19], v[152:155]
ds_read_b128 v[228:231], v249 offset:43264
v_mfma_f32_16x16x32_f16 v[160:163], v[232:235], v[20:23], v[160:163]
s_waitcnt lgkmcnt(2)
v_mfma_f32_16x16x32_f16 v[156:159], v[236:239], v[16:19], v[156:159]
ds_read_b128 v[232:235], v249 offset:44032
v_mfma_f32_16x16x32_f16 v[164:167], v[236:239], v[20:23], v[164:167]
s_waitcnt lgkmcnt(2)
v_mfma_f32_16x16x32_f16 v[120:123], v[224:227], v[24:27], v[120:123]
s_add_u32 s46, s71, 98304
buffer_load_dwordx4 v[4:7], v252, s[4:7], s46 offen offset:64
ds_read_b128 v[236:239], v249 offset:44288
v_mfma_f32_16x16x32_f16 v[128:131], v[224:227], v[28:31], v[128:131]
s_waitcnt lgkmcnt(2)
v_mfma_f32_16x16x32_f16 v[124:127], v[228:231], v[24:27], v[124:127]
ds_read_b128 v[224:227], v249 offset:45056
v_mfma_f32_16x16x32_f16 v[132:135], v[228:231], v[28:31], v[132:135]
s_waitcnt lgkmcnt(2)
v_mfma_f32_16x16x32_f16 v[136:139], v[232:235], v[24:27], v[136:139]
ds_read_b128 v[228:231], v249 offset:45312
v_mfma_f32_16x16x32_f16 v[144:147], v[232:235], v[28:31], v[144:147]
s_waitcnt lgkmcnt(2)
v_mfma_f32_16x16x32_f16 v[140:143], v[236:239], v[24:27], v[140:143]
s_add_u32 s46, s71, 98304
buffer_load_dwordx4 v[0:3], v252, s[4:7], s46 offen offset:128
ds_read_b128 v[232:235], v249 offset:49152
v_mfma_f32_16x16x32_f16 v[148:151], v[236:239], v[28:31], v[148:151]
s_waitcnt lgkmcnt(2)
v_mfma_f32_16x16x32_f16 v[152:155], v[224:227], v[24:27], v[152:155]
ds_read_b128 v[236:239], v249 offset:49408
v_mfma_f32_16x16x32_f16 v[160:163], v[224:227], v[28:31], v[160:163]
s_waitcnt lgkmcnt(2)
v_mfma_f32_16x16x32_f16 v[156:159], v[228:231], v[24:27], v[156:159]
ds_read_b128 v[224:227], v249 offset:50176
v_mfma_f32_16x16x32_f16 v[164:167], v[228:231], v[28:31], v[164:167]
s_waitcnt lgkmcnt(2)
v_mfma_f32_16x16x32_f16 v[120:123], v[232:235], v[32:35], v[120:123]
buffer_load_dwordx4 v[24:27], v253, s[32:35], s80 offen nt
ds_read_b128 v[228:231], v249 offset:50432
v_mfma_f32_16x16x32_f16 v[128:131], v[232:235], v[36:39], v[128:131]
v_and_b32 v16, 1, v251
s_waitcnt lgkmcnt(2)
v_mfma_f32_16x16x32_f16 v[124:127], v[236:239], v[32:35], v[124:127]
ds_read_b128 v[232:235], v249 offset:51200
v_mfma_f32_16x16x32_f16 v[132:135], v[236:239], v[36:39], v[132:135]
v_lshlrev_b32 v16, 4, v16
s_waitcnt lgkmcnt(2)
v_mfma_f32_16x16x32_f16 v[136:139], v[224:227], v[32:35], v[136:139]
ds_read_b128 v[236:239], v249 offset:51456
v_mov_b32 v17, 16256
v_mfma_f32_16x16x32_f16 v[144:147], v[224:227], v[36:39], v[144:147]
s_waitcnt lgkmcnt(2)
v_mfma_f32_16x16x32_f16 v[140:143], v[228:231], v[32:35], v[140:143]
ds_read_b128 v[224:227], v249 offset:55296
v_lshlrev_b32 v16, v16, v17
v_mfma_f32_16x16x32_f16 v[148:151], v[228:231], v[36:39], v[148:151]
v_lshrrev_b32 v17, 2, v251
s_waitcnt lgkmcnt(2)
v_mfma_f32_16x16x32_f16 v[152:155], v[232:235], v[32:35], v[152:155]
ds_read_b128 v[228:231], v249 offset:55552
v_mfma_f32_16x16x32_f16 v[160:163], v[232:235], v[36:39], v[160:163]
v_xor_b32 v17, v17, v251
s_waitcnt lgkmcnt(2)
v_mfma_f32_16x16x32_f16 v[156:159], v[236:239], v[32:35], v[156:159]
ds_read_b128 v[232:235], v249 offset:56320
v_mfma_f32_16x16x32_f16 v[164:167], v[236:239], v[36:39], v[164:167]
v_and_b32 v17, 12, v17
s_waitcnt lgkmcnt(2)
v_mfma_f32_16x16x32_f16 v[120:123], v[224:227], v[40:43], v[120:123]
buffer_load_dwordx4 v[28:31], v253, s[32:35], s80 offen offset:256 nt
ds_read_b128 v[236:239], v249 offset:56576
v_and_b32 v20, 2, v251
v_mfma_f32_16x16x32_f16 v[128:131], v[224:227], v[44:47], v[128:131]
s_waitcnt lgkmcnt(2)
v_mfma_f32_16x16x32_f16 v[124:127], v[228:231], v[40:43], v[124:127]
ds_read_b128 v[224:227], v249 offset:57344
v_or_b32_e64 v17, v17, v20
v_mfma_f32_16x16x32_f16 v[132:135], v[228:231], v[44:47], v[132:135]
v_cmp_eq_u32 vcc, 0, v17
s_nop 1
v_cndmask_b32 v18, 0, v16, vcc
s_waitcnt lgkmcnt(2)
v_mfma_f32_16x16x32_f16 v[136:139], v[232:235], v[40:43], v[136:139]
ds_read_b128 v[228:231], v249 offset:57600
v_mfma_f32_16x16x32_f16 v[144:147], v[232:235], v[44:47], v[144:147]
v_cmp_eq_u32 vcc, 2, v17
s_nop 1
v_cndmask_b32 v19, 0, v16, vcc
s_waitcnt lgkmcnt(2)
v_mfma_f32_16x16x32_f16 v[140:143], v[236:239], v[40:43], v[140:143]
ds_read_b128 v[232:235], v249 offset:61440
v_mfma_f32_16x16x32_f16 v[148:151], v[236:239], v[44:47], v[148:151]
v_mov_b32 v16, 0
s_waitcnt lgkmcnt(2)
v_mfma_f32_16x16x32_f16 v[152:155], v[224:227], v[40:43], v[152:155]
ds_read_b128 v[236:239], v249 offset:61696
v_mov_b32 v17, 0
v_mfma_f32_16x16x32_f16 v[160:163], v[224:227], v[44:47], v[160:163]
s_waitcnt lgkmcnt(2)
v_mfma_f32_16x16x32_f16 v[156:159], v[228:231], v[40:43], v[156:159]
ds_read_b128 v[224:227], v249 offset:62464
v_mov_b32_e64 v20, 0
v_mfma_f32_16x16x32_f16 v[164:167], v[228:231], v[44:47], v[164:167]
v_mov_b32 v21, 0
s_waitcnt lgkmcnt(2)
v_mfma_f32_16x16x32_f16 v[120:123], v[232:235], v[48:51], v[120:123]
s_add_u32 s46, s80, 4194304
buffer_load_dwordx4 v[32:35], v253, s[32:35], s46 offen nt
ds_read_b128 v[228:231], v249 offset:62720
v_mfma_f32_16x16x32_f16 v[128:131], v[232:235], v[52:55], v[128:131]
s_waitcnt lgkmcnt(2)
v_mfma_f32_16x16x32_f16 v[124:127], v[236:239], v[48:51], v[124:127]
ds_read_b128 v[232:235], v249 offset:63488
v_mfma_f32_16x16x32_f16 v[132:135], v[236:239], v[52:55], v[132:135]
s_waitcnt lgkmcnt(2)
v_mfma_f32_16x16x32_f16 v[136:139], v[224:227], v[48:51], v[136:139]
ds_read_b128 v[236:239], v249 offset:63744
v_mfma_f32_16x16x32_f16 v[144:147], v[224:227], v[52:55], v[144:147]
s_waitcnt lgkmcnt(2)
v_mfma_f32_16x16x32_f16 v[140:143], v[228:231], v[48:51], v[140:143]
ds_read_b128 v[224:227], v250 offset:2048
v_mfma_f32_16x16x32_f16 v[148:151], v[228:231], v[52:55], v[148:151]
s_waitcnt lgkmcnt(2)
v_mfma_f32_16x16x32_f16 v[152:155], v[232:235], v[48:51], v[152:155]
ds_read_b128 v[228:231], v250 offset:2304
v_mfma_f32_16x16x32_f16 v[160:163], v[232:235], v[52:55], v[160:163]
s_waitcnt lgkmcnt(2)
v_mfma_f32_16x16x32_f16 v[156:159], v[236:239], v[48:51], v[156:159]
ds_read_b128 v[232:235], v250 offset:3072
v_mfma_f32_16x16x32_f16 v[164:167], v[236:239], v[52:55], v[164:167]
s_waitcnt lgkmcnt(2)
v_mfma_f32_16x16x32_f16 v[120:123], v[224:227], v[56:59], v[120:123]
ds_read_b128 v[236:239], v250 offset:3328
v_mfma_f32_16x16x32_f16 v[128:131], v[224:227], v[60:63], v[128:131]
s_waitcnt lgkmcnt(2)
v_mfma_f32_16x16x32_f16 v[124:127], v[228:231], v[56:59], v[124:127]
s_add_u32 s46, s80, 4194304
buffer_load_dwordx4 v[36:39], v253, s[32:35], s46 offen offset:256 nt
ds_read_b128 v[224:227], v250 offset:4096
v_mfma_f32_16x16x32_f16 v[132:135], v[228:231], v[60:63], v[132:135]
s_waitcnt lgkmcnt(2)
v_mfma_f32_16x16x32_f16 v[136:139], v[232:235], v[56:59], v[136:139]
ds_read_b128 v[228:231], v250 offset:4352
v_mfma_f32_16x16x32_f16 v[144:147], v[232:235], v[60:63], v[144:147]
s_waitcnt lgkmcnt(2)
v_mfma_f32_16x16x32_f16 v[140:143], v[236:239], v[56:59], v[140:143]
ds_read_b128 v[232:235], v250 offset:8192
v_mfma_f32_16x16x32_f16 v[148:151], v[236:239], v[60:63], v[148:151]
s_waitcnt lgkmcnt(2)
v_mfma_f32_16x16x32_f16 v[152:155], v[224:227], v[56:59], v[152:155]
ds_read_b128 v[236:239], v250 offset:8448
v_mfma_f32_16x16x32_f16 v[160:163], v[224:227], v[60:63], v[160:163]
s_waitcnt lgkmcnt(2)
v_mfma_f32_16x16x32_f16 v[156:159], v[228:231], v[56:59], v[156:159]
ds_read_b128 v[224:227], v250 offset:9216
v_mfma_f32_16x16x32_f16 v[164:167], v[228:231], v[60:63], v[164:167]
s_waitcnt vmcnt(9)
v_mfma_f32_16x16x32_bf16 v[120:123], v[18:21], v[240:243], v[120:123]
ds_read_b128 v[228:231], v250 offset:9472
v_mfma_f32_16x16x32_bf16 v[124:127], v[16:19], v[240:243], v[124:127]
s_waitcnt vmcnt(8)
v_mfma_f32_16x16x32_bf16 v[136:139], v[18:21], v[244:247], v[136:139]
v_mfma_f32_16x16x32_bf16 v[140:143], v[16:19], v[244:247], v[140:143]
s_waitcnt lgkmcnt(3)
v_mfma_f32_16x16x32_f16 v[120:123], v[232:235], v[64:67], v[120:123]
s_add_u32 s46, s80, 8388608
buffer_load_dwordx4 v[40:43], v253, s[32:35], s46 offen nt
v_mfma_f32_16x16x32_f16 v[128:131], v[232:235], v[68:71], v[128:131]
s_waitcnt lgkmcnt(2)
v_mfma_f32_16x16x32_f16 v[124:127], v[236:239], v[64:67], v[124:127]
ds_read_b128 v[232:235], v250 offset:10240
v_mfma_f32_16x16x32_f16 v[132:135], v[236:239], v[68:71], v[132:135]
s_waitcnt lgkmcnt(2)
v_mfma_f32_16x16x32_f16 v[136:139], v[224:227], v[64:67], v[136:139]
ds_read_b128 v[236:239], v250 offset:10496
v_mfma_f32_16x16x32_f16 v[144:147], v[224:227], v[68:71], v[144:147]
s_waitcnt lgkmcnt(2)
v_mfma_f32_16x16x32_f16 v[140:143], v[228:231], v[64:67], v[140:143]
ds_read_b128 v[224:227], v250 offset:14336
v_mfma_f32_16x16x32_f16 v[148:151], v[228:231], v[68:71], v[148:151]
s_waitcnt lgkmcnt(2)
v_mfma_f32_16x16x32_f16 v[152:155], v[232:235], v[64:67], v[152:155]
ds_read_b128 v[228:231], v250 offset:14592
v_mfma_f32_16x16x32_f16 v[160:163], v[232:235], v[68:71], v[160:163]
s_waitcnt lgkmcnt(2)
v_mfma_f32_16x16x32_f16 v[156:159], v[236:239], v[64:67], v[156:159]
ds_read_b128 v[232:235], v250 offset:15360
v_mfma_f32_16x16x32_f16 v[164:167], v[236:239], v[68:71], v[164:167]
s_waitcnt lgkmcnt(2)
v_mfma_f32_16x16x32_f16 v[120:123], v[224:227], v[72:75], v[120:123]
ds_read_b128 v[236:239], v250 offset:15616
v_mfma_f32_16x16x32_f16 v[128:131], v[224:227], v[76:79], v[128:131]
s_waitcnt lgkmcnt(2)
v_mfma_f32_16x16x32_f16 v[124:127], v[228:231], v[72:75], v[124:127]
s_add_u32 s46, s80, 8388608
buffer_load_dwordx4 v[44:47], v253, s[32:35], s46 offen offset:256 nt
ds_read_b128 v[224:227], v250 offset:16384
v_mfma_f32_16x16x32_f16 v[132:135], v[228:231], v[76:79], v[132:135]
s_waitcnt lgkmcnt(2)
v_mfma_f32_16x16x32_f16 v[136:139], v[232:235], v[72:75], v[136:139]
ds_read_b128 v[228:231], v250 offset:16640
v_mfma_f32_16x16x32_f16 v[144:147], v[232:235], v[76:79], v[144:147]
s_waitcnt lgkmcnt(2)
v_mfma_f32_16x16x32_f16 v[140:143], v[236:239], v[72:75], v[140:143]
ds_read_b128 v[232:235], v250 offset:20480
v_mfma_f32_16x16x32_f16 v[148:151], v[236:239], v[76:79], v[148:151]
s_waitcnt lgkmcnt(2)
v_mfma_f32_16x16x32_f16 v[152:155], v[224:227], v[72:75], v[152:155]
ds_read_b128 v[236:239], v250 offset:20736
v_mfma_f32_16x16x32_f16 v[160:163], v[224:227], v[76:79], v[160:163]
s_waitcnt lgkmcnt(2)
v_mfma_f32_16x16x32_f16 v[156:159], v[228:231], v[72:75], v[156:159]
ds_read_b128 v[224:227], v250 offset:21504
v_mfma_f32_16x16x32_f16 v[164:167], v[228:231], v[76:79], v[164:167]
s_waitcnt vmcnt(9)
v_mfma_f32_16x16x32_bf16 v[152:155], v[18:21], v[12:15], v[152:155]
ds_read_b128 v[228:231], v250 offset:21760
v_mfma_f32_16x16x32_bf16 v[156:159], v[16:19], v[12:15], v[156:159]
s_waitcnt vmcnt(8)
v_mfma_f32_16x16x32_bf16 v[128:131], v[18:21], v[8:11], v[128:131]
v_mfma_f32_16x16x32_bf16 v[132:135], v[16:19], v[8:11], v[132:135]
v_and_b32 v255, 1, v251
v_lshlrev_b32 v255, 7, v255
v_sub_u32 v255, v252, v255
s_mov_b32 s74, 1431655765
s_mov_b32 s75, 1431655765
s_waitcnt lgkmcnt(3)
v_mfma_f32_16x16x32_f16 v[120:123], v[232:235], v[80:83], v[120:123]
buffer_load_dwordx4 v[12:15], v252, s[4:7], s70 offen
v_mfma_f32_16x16x32_f16 v[128:131], v[232:235], v[84:87], v[128:131]
s_waitcnt lgkmcnt(2)
v_mfma_f32_16x16x32_f16 v[124:127], v[236:239], v[80:83], v[124:127]
ds_read_b128 v[232:235], v250 offset:22528
v_mfma_f32_16x16x32_f16 v[132:135], v[236:239], v[84:87], v[132:135]
s_waitcnt lgkmcnt(2)
v_mfma_f32_16x16x32_f16 v[136:139], v[224:227], v[80:83], v[136:139]
ds_read_b128 v[236:239], v250 offset:22784
v_mfma_f32_16x16x32_f16 v[144:147], v[224:227], v[84:87], v[144:147]
s_waitcnt lgkmcnt(2)
v_mfma_f32_16x16x32_f16 v[140:143], v[228:231], v[80:83], v[140:143]
ds_read_b128 v[224:227], v250 offset:26624
v_mfma_f32_16x16x32_f16 v[148:151], v[228:231], v[84:87], v[148:151]
s_waitcnt lgkmcnt(2)
v_mfma_f32_16x16x32_f16 v[152:155], v[232:235], v[80:83], v[152:155]
ds_read_b128 v[228:231], v250 offset:26880
v_mfma_f32_16x16x32_f16 v[160:163], v[232:235], v[84:87], v[160:163]
s_waitcnt lgkmcnt(2)
v_mfma_f32_16x16x32_f16 v[156:159], v[236:239], v[80:83], v[156:159]
ds_read_b128 v[232:235], v250 offset:27648
v_mfma_f32_16x16x32_f16 v[164:167], v[236:239], v[84:87], v[164:167]
s_waitcnt lgkmcnt(2)
v_mfma_f32_16x16x32_f16 v[120:123], v[224:227], v[88:91], v[120:123]
ds_read_b128 v[236:239], v250 offset:27904
v_mfma_f32_16x16x32_f16 v[128:131], v[224:227], v[92:95], v[128:131]
s_waitcnt lgkmcnt(2)
v_mfma_f32_16x16x32_f16 v[124:127], v[228:231], v[88:91], v[124:127]
buffer_load_dwordx4 v[8:11], v252, s[4:7], s70 offen offset:64
ds_read_b128 v[224:227], v250 offset:28672
v_mfma_f32_16x16x32_f16 v[132:135], v[228:231], v[92:95], v[132:135]
s_waitcnt lgkmcnt(2)
v_mfma_f32_16x16x32_f16 v[136:139], v[232:235], v[88:91], v[136:139]
ds_read_b128 v[228:231], v250 offset:28928
v_mfma_f32_16x16x32_f16 v[144:147], v[232:235], v[92:95], v[144:147]
s_waitcnt lgkmcnt(2)
v_mfma_f32_16x16x32_f16 v[140:143], v[236:239], v[88:91], v[140:143]
ds_read_b128 v[232:235], v249 offset:55296
v_mfma_f32_16x16x32_f16 v[148:151], v[236:239], v[92:95], v[148:151]
s_waitcnt lgkmcnt(2)
v_mfma_f32_16x16x32_f16 v[152:155], v[224:227], v[88:91], v[152:155]
ds_read_b128 v[236:239], v254 offset:7936
v_mfma_f32_16x16x32_f16 v[160:163], v[224:227], v[92:95], v[160:163]
s_waitcnt lgkmcnt(2)
v_mfma_f32_16x16x32_f16 v[156:159], v[228:231], v[88:91], v[156:159]
ds_read_b128 v[224:227], v249 offset:55552
v_mfma_f32_16x16x32_f16 v[164:167], v[228:231], v[92:95], v[164:167]
s_waitcnt vmcnt(9)
v_mfma_f32_16x16x32_bf16 v[144:147], v[18:21], v[4:7], v[144:147]
ds_read_b128 v[228:231], v254 offset:7952
v_mfma_f32_16x16x32_bf16 v[148:151], v[16:19], v[4:7], v[148:151]
s_waitcnt vmcnt(8)
v_mfma_f32_16x16x32_bf16 v[160:163], v[18:21], v[0:3], v[160:163]
v_mfma_f32_16x16x32_bf16 v[164:167], v[16:19], v[0:3], v[164:167]
s_waitcnt lgkmcnt(2)
v_mfma_f32_16x16x32_f16 v[48:51], v[232:235], v[168:171], v[236:239]
buffer_load_dwordx4 v[4:7], v252, s[4:7], s70 offen offset:128
v_mfma_f32_16x16x32_f16 v[56:59], v[232:235], v[172:175], v[236:239]
s_waitcnt lgkmcnt(0)
v_mfma_f32_16x16x32_f16 v[52:55], v[224:227], v[168:171], v[228:231]
ds_read_b128 v[232:235], v249 offset:56320
ds_read_b128 v[236:239], v254 offset:8064
v_mfma_f32_16x16x32_f16 v[60:63], v[224:227], v[172:175], v[228:231]
s_waitcnt lgkmcnt(0)
v_mfma_f32_16x16x32_f16 v[64:67], v[232:235], v[168:171], v[236:239]
ds_read_b128 v[224:227], v249 offset:56576
ds_read_b128 v[228:231], v254 offset:8080
v_mfma_f32_16x16x32_f16 v[72:75], v[232:235], v[172:175], v[236:239]
v_cvt_pk_bf16_f32 v136, v136, v137
s_waitcnt lgkmcnt(0)
v_mfma_f32_16x16x32_f16 v[68:71], v[224:227], v[168:171], v[228:231]
ds_read_b128 v[232:235], v249 offset:57344
ds_read_b128 v[236:239], v254 offset:16128
v_cvt_pk_bf16_f32 v137, v138, v139
v_mfma_f32_16x16x32_f16 v[76:79], v[224:227], v[172:175], v[228:231]
v_cvt_pk_bf16_f32 v138, v140, v141
v_cvt_pk_bf16_f32 v139, v142, v143
s_waitcnt lgkmcnt(0)
v_mfma_f32_16x16x32_f16 v[80:83], v[232:235], v[168:171], v[236:239]
ds_read_b128 v[224:227], v249 offset:57600
ds_read_b128 v[228:231], v254 offset:16144
v_cvt_pk_bf16_f32 v120, v120, v121
v_mfma_f32_16x16x32_f16 v[88:91], v[232:235], v[172:175], v[236:239]
v_cvt_pk_bf16_f32 v121, v122, v123
s_waitcnt lgkmcnt(0)
v_mfma_f32_16x16x32_f16 v[84:87], v[224:227], v[168:171], v[228:231]
ds_read_b128 v[232:235], v249 offset:61440
ds_read_b128 v[236:239], v249 offset:61696
v_cvt_pk_bf16_f32 v122, v124, v125
v_mfma_f32_16x16x32_f16 v[92:95], v[224:227], v[172:175], v[228:231]
v_cvt_pk_bf16_f32 v123, v126, v127
v_cvt_pk_bf16_f32 v152, v152, v153
s_waitcnt lgkmcnt(1)
v_mfma_f32_16x16x32_f16 v[48:51], v[232:235], v[176:179], v[48:51]
ds_read_b128 v[224:227], v249 offset:62464
ds_read_b128 v[228:231], v249 offset:62720
v_cvt_pk_bf16_f32 v153, v154, v155
v_mfma_f32_16x16x32_f16 v[56:59], v[232:235], v[180:183], v[56:59]
v_cvt_pk_bf16_f32 v154, v156, v157
s_waitcnt lgkmcnt(2)
v_mfma_f32_16x16x32_f16 v[52:55], v[236:239], v[176:179], v[52:55]
ds_read_b128 v[232:235], v249 offset:63488
v_cvt_pk_bf16_f32 v155, v158, v159
s_mov_b64 vcc, s[74:75]
v_mfma_f32_16x16x32_f16 v[60:63], v[236:239], v[180:183], v[60:63]
v_cndmask_b32 v140, v120, v152, vcc
v_cndmask_b32 v141, v121, v153, vcc
s_waitcnt lgkmcnt(2)
v_mfma_f32_16x16x32_f16 v[64:67], v[224:227], v[176:179], v[64:67]
ds_read_b128 v[236:239], v249 offset:63744
v_cndmask_b32 v142, v122, v154, vcc
v_mfma_f32_16x16x32_f16 v[72:75], v[224:227], v[180:183], v[72:75]
v_cndmask_b32 v143, v123, v155, vcc
s_waitcnt lgkmcnt(2)
v_mfma_f32_16x16x32_f16 v[68:71], v[228:231], v[176:179], v[68:71]
ds_read_b128 v[224:227], v250 offset:2048
v_cndmask_b32_dpp v120, v136, v120, vcc quad_perm:[1,0,3,2] row_mask:0xf bank_mask:0xf
v_mfma_f32_16x16x32_f16 v[76:79], v[228:231], v[180:183], v[76:79]
v_cndmask_b32_dpp v121, v137, v121, vcc quad_perm:[1,0,3,2] row_mask:0xf bank_mask:0xf
v_cndmask_b32_dpp v122, v138, v122, vcc quad_perm:[1,0,3,2] row_mask:0xf bank_mask:0xf
s_waitcnt lgkmcnt(2)
v_mfma_f32_16x16x32_f16 v[80:83], v[232:235], v[176:179], v[80:83]
ds_read_b128 v[228:231], v250 offset:2304
v_cndmask_b32_dpp v123, v139, v123, vcc quad_perm:[1,0,3,2] row_mask:0xf bank_mask:0xf
s_not_b64 vcc, s[74:75]
v_mfma_f32_16x16x32_f16 v[88:91], v[232:235], v[180:183], v[88:91]
v_cndmask_b32_dpp v152, v136, v152, vcc quad_perm:[1,0,3,2] row_mask:0xf bank_mask:0xf
s_waitcnt lgkmcnt(2)
v_mfma_f32_16x16x32_f16 v[84:87], v[236:239], v[176:179], v[84:87]
ds_read_b128 v[232:235], v248 offset:16384
v_cndmask_b32_dpp v153, v137, v153, vcc quad_perm:[1,0,3,2] row_mask:0xf bank_mask:0xf
v_mfma_f32_16x16x32_f16 v[92:95], v[236:239], v[180:183], v[92:95]
v_cndmask_b32_dpp v154, v138, v154, vcc quad_perm:[1,0,3,2] row_mask:0xf bank_mask:0xf
v_cndmask_b32_dpp v155, v139, v155, vcc quad_perm:[1,0,3,2] row_mask:0xf bank_mask:0xf
s_waitcnt lgkmcnt(2)
v_mfma_f32_16x16x32_f16 v[48:51], v[224:227], v[184:187], v[48:51]
s_add_u32 s46, s70, 98304
buffer_load_dwordx4 v[0:3], v252, s[4:7], s46 offen
ds_read_b128 v[236:239], v250 offset:3072
buffer_store_dwordx4 v[120:123], v255, s[8:11], s71 offen sc1
v_mfma_f32_16x16x32_f16 v[56:59], v[224:227], v[188:191], v[56:59]
s_waitcnt lgkmcnt(2)
v_mfma_f32_16x16x32_f16 v[52:55], v[228:231], v[184:187], v[52:55]
ds_read_b128 v[224:227], v250 offset:3328
v_mfma_f32_16x16x32_f16 v[60:63], v[228:231], v[188:191], v[60:63]
s_waitcnt lgkmcnt(2)
v_mfma_f32_16x16x32_bf16 v[168:171], v[232:235], v[96:99], 0
ds_read_b128 v[228:231], v250 offset:4096
v_mfma_f32_16x16x32_bf16 v[176:179], v[232:235], v[100:103], 0
s_waitcnt lgkmcnt(2)
v_mfma_f32_16x16x32_f16 v[64:67], v[236:239], v[184:187], v[64:67]
ds_read_b128 v[232:235], v250 offset:4352
v_mfma_f32_16x16x32_f16 v[72:75], v[236:239], v[188:191], v[72:75]
s_waitcnt lgkmcnt(2)
v_mfma_f32_16x16x32_f16 v[68:71], v[224:227], v[184:187], v[68:71]
ds_read_b128 v[236:239], v248 offset:16640
v_mfma_f32_16x16x32_f16 v[76:79], v[224:227], v[188:191], v[76:79]
s_waitcnt lgkmcnt(2)
v_mfma_f32_16x16x32_f16 v[80:83], v[228:231], v[184:187], v[80:83]
ds_read_b128 v[224:227], v250 offset:8192
v_mfma_f32_16x16x32_f16 v[88:91], v[228:231], v[188:191], v[88:91]
s_waitcnt lgkmcnt(2)
v_mfma_f32_16x16x32_f16 v[84:87], v[232:235], v[184:187], v[84:87]
ds_read_b128 v[228:231], v250 offset:8448
v_mfma_f32_16x16x32_f16 v[92:95], v[232:235], v[188:191], v[92:95]
s_waitcnt lgkmcnt(2)
v_mfma_f32_16x16x32_bf16 v[172:175], v[236:239], v[96:99], 0
ds_read_b128 v[232:235], v250 offset:9216
v_mfma_f32_16x16x32_bf16 v[180:183], v[236:239], v[100:103], 0
s_waitcnt lgkmcnt(2)
v_mfma_f32_16x16x32_f16 v[48:51], v[224:227], v[192:195], v[48:51]
buffer_store_dwordx4 v[140:143], v255, s[8:11], s71 offen offset:128 sc1
ds_read_b128 v[236:239], v250 offset:9472
v_mfma_f32_16x16x32_f16 v[56:59], v[224:227], v[196:199], v[56:59]
s_waitcnt lgkmcnt(2)
v_mfma_f32_16x16x32_f16 v[52:55], v[228:231], v[192:195], v[52:55]
ds_read_b128 v[224:227], v248 offset:17408
v_mfma_f32_16x16x32_f16 v[60:63], v[228:231], v[196:199], v[60:63]
s_waitcnt lgkmcnt(2)
v_mfma_f32_16x16x32_f16 v[64:67], v[232:235], v[192:195], v[64:67]
ds_read_b128 v[228:231], v250 offset:10240
v_mfma_f32_16x16x32_f16 v[72:75], v[232:235], v[196:199], v[72:75]
s_waitcnt lgkmcnt(2)
v_mfma_f32_16x16x32_f16 v[68:71], v[236:239], v[192:195], v[68:71]
ds_read_b128 v[232:235], v250 offset:10496
v_mfma_f32_16x16x32_f16 v[76:79], v[236:239], v[196:199], v[76:79]
s_waitcnt lgkmcnt(2)
v_mfma_f32_16x16x32_bf16 v[168:171], v[224:227], v[104:107], v[168:171]
ds_read_b128 v[236:239], v250 offset:14336
v_mfma_f32_16x16x32_bf16 v[176:179], v[224:227], v[108:111], v[176:179]
s_waitcnt lgkmcnt(2)
v_mfma_f32_16x16x32_f16 v[80:83], v[228:231], v[192:195], v[80:83]
ds_read_b128 v[224:227], v250 offset:14592
v_mfma_f32_16x16x32_f16 v[88:91], v[228:231], v[196:199], v[88:91]
s_waitcnt lgkmcnt(2)
v_mfma_f32_16x16x32_f16 v[84:87], v[232:235], v[192:195], v[84:87]
ds_read_b128 v[228:231], v248 offset:17664
v_mfma_f32_16x16x32_f16 v[92:95], v[232:235], v[196:199], v[92:95]
s_waitcnt lgkmcnt(2)
v_mfma_f32_16x16x32_f16 v[48:51], v[236:239], v[200:203], v[48:51]
s_add_u32 s46, s70, 98304
buffer_load_dwordx4 v[244:247], v252, s[4:7], s46 offen offset:64
ds_read_b128 v[232:235], v250 offset:15360
v_mfma_f32_16x16x32_f16 v[56:59], v[236:239], v[204:207], v[56:59]
s_waitcnt lgkmcnt(2)
v_mfma_f32_16x16x32_f16 v[52:55], v[224:227], v[200:203], v[52:55]
ds_read_b128 v[236:239], v250 offset:15616
v_mfma_f32_16x16x32_f16 v[60:63], v[224:227], v[204:207], v[60:63]
s_waitcnt lgkmcnt(2)
v_mfma_f32_16x16x32_bf16 v[172:175], v[228:231], v[104:107], v[172:175]
ds_read_b128 v[224:227], v250 offset:16384
v_mfma_f32_16x16x32_bf16 v[180:183], v[228:231], v[108:111], v[180:183]
s_waitcnt lgkmcnt(2)
v_mfma_f32_16x16x32_f16 v[64:67], v[232:235], v[200:203], v[64:67]
ds_read_b128 v[228:231], v250 offset:16640
v_mfma_f32_16x16x32_f16 v[72:75], v[232:235], v[204:207], v[72:75]
s_waitcnt lgkmcnt(2)
v_mfma_f32_16x16x32_f16 v[68:71], v[236:239], v[200:203], v[68:71]
ds_read_b128 v[232:235], v248 offset:18432
v_mfma_f32_16x16x32_f16 v[76:79], v[236:239], v[204:207], v[76:79]
s_waitcnt lgkmcnt(2)
v_mfma_f32_16x16x32_f16 v[80:83], v[224:227], v[200:203], v[80:83]
ds_read_b128 v[236:239], v250 offset:20480
v_mfma_f32_16x16x32_f16 v[88:91], v[224:227], v[204:207], v[88:91]
s_waitcnt lgkmcnt(2)
v_mfma_f32_16x16x32_f16 v[84:87], v[228:231], v[200:203], v[84:87]
ds_read_b128 v[224:227], v250 offset:20736
v_mfma_f32_16x16x32_f16 v[92:95], v[228:231], v[204:207], v[92:95]
s_waitcnt lgkmcnt(2)
v_mfma_f32_16x16x32_bf16 v[168:171], v[232:235], v[112:115], v[168:171]
ds_read_b128 v[228:231], v250 offset:21504
v_mfma_f32_16x16x32_bf16 v[176:179], v[232:235], v[116:119], v[176:179]
s_waitcnt lgkmcnt(2)
v_mfma_f32_16x16x32_f16 v[48:51], v[236:239], v[208:211], v[48:51]
ds_read_b128 v[232:235], v250 offset:21760
v_mfma_f32_16x16x32_f16 v[56:59], v[236:239], v[212:215], v[56:59]
s_waitcnt lgkmcnt(2)
v_mfma_f32_16x16x32_f16 v[52:55], v[224:227], v[208:211], v[52:55]
ds_read_b128 v[236:239], v248 offset:18688
v_mfma_f32_16x16x32_f16 v[60:63], v[224:227], v[212:215], v[60:63]
s_waitcnt lgkmcnt(2)
v_mfma_f32_16x16x32_f16 v[64:67], v[228:231], v[208:211], v[64:67]
ds_read_b128 v[224:227], v250 offset:22528
v_mfma_f32_16x16x32_f16 v[72:75], v[228:231], v[212:215], v[72:75]
s_waitcnt lgkmcnt(2)
v_mfma_f32_16x16x32_f16 v[68:71], v[232:235], v[208:211], v[68:71]
ds_read_b128 v[228:231], v250 offset:22784
v_mfma_f32_16x16x32_f16 v[76:79], v[232:235], v[212:215], v[76:79]
s_waitcnt lgkmcnt(2)
v_mfma_f32_16x16x32_bf16 v[172:175], v[236:239], v[112:115], v[172:175]
ds_read_b128 v[232:235], v250 offset:26624
v_mfma_f32_16x16x32_bf16 v[180:183], v[236:239], v[116:119], v[180:183]
s_waitcnt lgkmcnt(2)
v_mfma_f32_16x16x32_f16 v[80:83], v[224:227], v[208:211], v[80:83]
ds_read_b128 v[236:239], v250 offset:26880
v_mfma_f32_16x16x32_f16 v[88:91], v[224:227], v[212:215], v[88:91]
s_waitcnt lgkmcnt(2)
v_mfma_f32_16x16x32_f16 v[84:87], v[228:231], v[208:211], v[84:87]
ds_read_b128 v[224:227], v248 offset:22528
v_mfma_f32_16x16x32_f16 v[92:95], v[228:231], v[212:215], v[92:95]
s_setprio 3
s_waitcnt lgkmcnt(2)
v_mfma_f32_16x16x32_f16 v[48:51], v[232:235], v[216:219], v[48:51]
s_add_u32 s46, s70, 98304
buffer_load_dwordx4 v[204:207], v252, s[4:7], s46 offen offset:128
ds_read_b128 v[228:231], v250 offset:27648
v_cvt_pkrtz_f16_f32 v185, v168, v169
v_cvt_pkrtz_f16_f32 v187, v170, v171
v_mfma_f32_16x16x32_f16 v[56:59], v[232:235], v[220:223], v[56:59]
v_cvt_pkrtz_f16_f32 v189, v172, v173
v_cvt_pkrtz_f16_f32 v191, v174, v175
s_waitcnt lgkmcnt(2)
v_mfma_f32_16x16x32_f16 v[52:55], v[236:239], v[216:219], v[52:55]
ds_read_b128 v[232:235], v248 offset:22784
v_cvt_pkrtz_f16_f32 v193, v176, v177
v_cvt_pk_f16_f32 v203, v178, v179
v_cvt_pk_f16_f32 v200, v180, v181
v_mfma_f32_16x16x32_f16 v[60:63], v[236:239], v[220:223], v[60:63]
v_cvt_pk_f16_f32 v197, v182, v183
v_pk_fma_f16 v202, v203, v203, s48
s_waitcnt lgkmcnt(2)
v_mfma_f32_16x16x32_bf16 v[168:171], v[224:227], v[96:99], 0
ds_read_b128 v[236:239], v250 offset:27904
v_and_b32_e64 v185, s49, v185
v_pk_fma_f16 v199, v200, v200, s48
v_mfma_f32_16x16x32_bf16 v[176:179], v[224:227], v[100:103], 0
v_and_b32 v187, s49, v187
v_pk_fma_f16 v196, v197, v197, s48
v_bfe_u32 v184, v185, 2, 14
s_waitcnt lgkmcnt(2)
v_mfma_f32_16x16x32_f16 v[64:67], v[228:231], v[216:219], v[64:67]
ds_read_b128 v[224:227], v248 offset:23552
ds_read_u16_d16 v184, v184
v_pk_mul_f16 v202, v203, v202
v_bfe_u32 v186, v187, 2, 14
v_mfma_f32_16x16x32_f16 v[72:75], v[228:231], v[220:223], v[72:75]
v_pk_mul_f16 v199, v200, v199
v_lshrrev_b32 v185, 18, v185
s_waitcnt lgkmcnt(3)
v_mfma_f32_16x16x32_bf16 v[172:175], v[232:235], v[96:99], 0
ds_read_b128 v[228:231], v250 offset:28672
ds_read_u16_d16 v186, v186
ds_read_u16_d16_hi v185, v185
v_pk_mul_f16 v196, v197, v196
v_lshrrev_b32_e64 v187, 18, v187
v_mfma_f32_16x16x32_bf16 v[180:183], v[232:235], v[100:103], 0
v_exp_f16_e64 v201, v202
v_and_b32 v189, s49, v189
s_waitcnt lgkmcnt(5)
v_mfma_f32_16x16x32_f16 v[68:71], v[236:239], v[216:219], v[68:71]
ds_read_b128 v[232:235], v250 offset:28928
ds_read_u16_d16_hi v187, v187
v_and_b32_e64 v191, s49, v191
v_mfma_f32_16x16x32_f16 v[76:79], v[236:239], v[220:223], v[76:79]
v_exp_f16 v198, v199
v_bfe_u32 v188, v189, 2, 14
v_bfe_u32 v190, v191, 2, 14
s_waitcnt lgkmcnt(5)
v_mfma_f32_16x16x32_bf16 v[168:171], v[224:227], v[104:107], v[168:171]
buffer_store_dwordx4 v[152:155], v255, s[8:11], s71 offen offset:256 sc1
ds_read_b128 v[236:239], v248 offset:23808
ds_read_u16_d16 v188, v188
ds_read_u16_d16 v190, v190
v_exp_f16_e64 v195, v196
v_mfma_f32_16x16x32_bf16 v[176:179], v[224:227], v[108:111], v[176:179]
v_lshrrev_b32_e64 v189, 18, v189
v_lshrrev_b32 v191, 18, v191
s_waitcnt lgkmcnt(5)
v_mfma_f32_16x16x32_f16 v[80:83], v[228:231], v[216:219], v[80:83]
ds_read_b128 v[224:227], v248 offset:24576
ds_read_u16_d16_hi v189, v189
ds_read_u16_d16_hi v191, v191
v_exp_f16_sdwa v201, v202 dst_sel:WORD_1 dst_unused:UNUSED_PRESERVE src0_sel:WORD_1
v_and_b32 v193, s49, v193
v_mfma_f32_16x16x32_f16 v[88:91], v[228:231], v[220:223], v[88:91]
v_bfe_u32 v192, v193, 2, 14
s_waitcnt lgkmcnt(6)
v_mfma_f32_16x16x32_f16 v[84:87], v[232:235], v[216:219], v[84:87]
ds_read_b128 v[228:231], v248 offset:24832
ds_read_u16_d16 v192, v192
v_exp_f16_sdwa v198, v199 dst_sel:WORD_1 dst_unused:UNUSED_PRESERVE src0_sel:WORD_1
v_lshrrev_b32 v193, 18, v193
v_mfma_f32_16x16x32_f16 v[92:95], v[232:235], v[220:223], v[92:95]
v_exp_f16_sdwa v195, v196 dst_sel:WORD_1 dst_unused:UNUSED_PRESERVE src0_sel:WORD_1
v_pk_add_f16 v201, v201, 1.0 op_sel_hi:[1,0]
s_waitcnt lgkmcnt(7)
v_mfma_f32_16x16x32_bf16 v[172:175], v[236:239], v[104:107], v[172:175]
ds_read_u16_d16_hi v193, v193
v_pk_add_f16 v198, v198, 1.0 op_sel_hi:[1,0]
v_pk_add_f16 v195, v195, 1.0 op_sel_hi:[1,0]
v_mfma_f32_16x16x32_bf16 v[180:183], v[236:239], v[108:111], v[180:183]
v_rcp_f16 v202, v201
s_waitcnt lgkmcnt(5)
v_mfma_f32_16x16x32_bf16 v[168:171], v[224:227], v[112:115], v[168:171]
v_rcp_f16_e64 v199, v198
v_mfma_f32_16x16x32_bf16 v[176:179], v[224:227], v[116:119], v[176:179]
v_rcp_f16 v196, v195
s_waitcnt lgkmcnt(2)
v_mfma_f32_16x16x32_bf16 v[172:175], v[228:231], v[112:115], v[172:175]
ds_read_b128 v[224:227], v249 offset:24576
v_rcp_f16_sdwa v202, v201 dst_sel:WORD_1 dst_unused:UNUSED_PRESERVE src0_sel:WORD_1
v_mfma_f32_16x16x32_bf16 v[180:183], v[228:231], v[116:119], v[180:183]
v_rcp_f16_sdwa v199, v198 dst_sel:WORD_1 dst_unused:UNUSED_PRESERVE src0_sel:WORD_1
v_or_b32 v208, v184, v185
v_or_b32 v209, v186, v187
v_or_b32_e64 v210, v188, v189
v_rcp_f16_sdwa v196, v195 dst_sel:WORD_1 dst_unused:UNUSED_PRESERVE src0_sel:WORD_1
v_or_b32 v211, v190, v191
s_waitcnt lgkmcnt(1)
v_or_b32 v212, v192, v193
v_pk_mul_f16 v213, v203, v202
v_pk_mul_f16 v214, v200, v199
v_pk_mul_f16 v215, v197, v196
s_waitcnt lgkmcnt(0)
v_mfma_f32_16x16x32_f16 v[48:51], v[224:227], v[208:211], v[48:51]
ds_read_b128 v[228:231], v249 offset:24832
ds_read_b128 v[232:235], v248 offset:28672
ds_read_b128 v[236:239], v249 offset:25600
ds_read_b128 v[216:219], v248 offset:28928
ds_read_b128 v[220:223], v249 offset:25856
v_cvt_pkrtz_f16_f32 v185, v168, v169
v_cvt_pkrtz_f16_f32 v187, v170, v171
v_cvt_pkrtz_f16_f32 v189, v172, v173
v_mfma_f32_16x16x32_f16 v[56:59], v[224:227], v[212:215], v[56:59]
v_cvt_pkrtz_f16_f32 v191, v174, v175
v_cvt_pkrtz_f16_f32 v193, v176, v177
v_cvt_pk_f16_f32 v203, v178, v179
s_waitcnt lgkmcnt(4)
v_mfma_f32_16x16x32_f16 v[52:55], v[228:231], v[208:211], v[52:55]
ds_read_b128 v[224:227], v248 offset:29696
v_cvt_pk_f16_f32 v200, v180, v181
v_cvt_pk_f16_f32 v197, v182, v183
v_pk_fma_f16 v202, v203, v203, s48
v_cvt_pk_bf16_f32 v144, v144, v145
v_mfma_f32_16x16x32_f16 v[60:63], v[228:231], v[212:215], v[60:63]
v_and_b32 v185, s49, v185
v_cvt_pk_bf16_f32 v145, v146, v147
v_pk_fma_f16 v199, v200, v200, s48
s_waitcnt lgkmcnt(4)
v_mfma_f32_16x16x32_bf16 v[168:171], v[232:235], v[96:99], 0
ds_read_b128 v[228:231], v249 offset:26624
v_and_b32 v187, s49, v187
v_cvt_pk_bf16_f32 v146, v148, v149
v_pk_fma_f16 v196, v197, v197, s48
v_mfma_f32_16x16x32_bf16 v[176:179], v[232:235], v[100:103], 0
v_cvt_pk_bf16_f32 v147, v150, v151
v_bfe_u32 v184, v185, 2, 14
s_setprio 2
v_pk_mul_f16 v202, v203, v202
v_cvt_pk_bf16_f32 v128, v128, v129
s_waitcnt lgkmcnt(2)
v_mfma_f32_16x16x32_f16 v[64:67], v[236:239], v[208:211], v[64:67]
ds_read_b128 v[232:235], v249 offset:26880
ds_read_u16_d16 v184, v184
v_bfe_u32 v186, v187, 2, 14
v_cvt_pk_bf16_f32 v129, v130, v131
v_pk_mul_f16 v199, v200, v199
v_mfma_f32_16x16x32_f16 v[72:75], v[236:239], v[212:215], v[72:75]
v_lshrrev_b32_e64 v185, 18, v185
v_cvt_pk_bf16_f32 v130, v132, v133
v_pk_mul_f16 v196, v197, v196
v_mfma_f32_16x16x32_bf16 v[172:175], v[216:219], v[96:99], 0
ds_read_b128 v[236:239], v248 offset:29952
ds_read_u16_d16 v186, v186
ds_read_u16_d16_hi v185, v185
v_lshrrev_b32_e64 v187, 18, v187
v_cvt_pk_bf16_f32 v131, v134, v135
v_exp_f16_e64 v201, v202
v_mfma_f32_16x16x32_bf16 v[180:183], v[216:219], v[100:103], 0
v_cvt_pk_bf16_f32 v160, v160, v161
v_and_b32_e64 v189, s49, v189
v_cvt_pk_bf16_f32 v161, v162, v163
v_mfma_f32_16x16x32_f16 v[68:71], v[220:223], v[208:211], v[68:71]
ds_read_b128 v[216:219], v248 offset:30720
ds_read_u16_d16_hi v187, v187
v_and_b32_e64 v191, s49, v191
v_cvt_pk_bf16_f32 v162, v164, v165
v_mfma_f32_16x16x32_f16 v[76:79], v[220:223], v[212:215], v[76:79]
v_exp_f16_e64 v198, v199
v_cvt_pk_bf16_f32 v163, v166, v167
s_mov_b64 vcc, s[74:75]
v_bfe_u32 v188, v189, 2, 14
v_bfe_u32 v190, v191, 2, 14
s_waitcnt lgkmcnt(5)
v_mfma_f32_16x16x32_bf16 v[168:171], v[224:227], v[104:107], v[168:171]
ds_read_b128 v[220:223], v248 offset:30976
ds_read_u16_d16 v188, v188
ds_read_u16_d16 v190, v190
v_cndmask_b32 v148, v128, v160, vcc
v_exp_f16 v195, v196
v_mfma_f32_16x16x32_bf16 v[176:179], v[224:227], v[108:111], v[176:179]
v_cndmask_b32 v149, v129, v161, vcc
v_lshrrev_b32_e64 v189, 18, v189
v_cndmask_b32 v150, v130, v162, vcc
v_mfma_f32_16x16x32_f16 v[80:83], v[228:231], v[208:211], v[80:83]
ds_read_b128 v[224:227], v249 offset:30720
ds_read_u16_d16_hi v189, v189
v_lshrrev_b32 v191, 18, v191
v_cndmask_b32 v151, v131, v163, vcc
v_exp_f16_sdwa v201, v202 dst_sel:WORD_1 dst_unused:UNUSED_PRESERVE src0_sel:WORD_1
v_mfma_f32_16x16x32_f16 v[88:91], v[228:231], v[212:215], v[88:91]
v_cndmask_b32_dpp v128, v144, v128, vcc quad_perm:[1,0,3,2] row_mask:0xf bank_mask:0xf
v_and_b32_e64 v193, s49, v193
v_cndmask_b32_dpp v129, v145, v129, vcc quad_perm:[1,0,3,2] row_mask:0xf bank_mask:0xf
v_mfma_f32_16x16x32_f16 v[84:87], v[232:235], v[208:211], v[84:87]
ds_read_b128 v[228:231], v249 offset:30976
ds_read_u16_d16_hi v191, v191
v_bfe_u32 v192, v193, 2, 14
v_exp_f16_sdwa v198, v199 dst_sel:WORD_1 dst_unused:UNUSED_PRESERVE src0_sel:WORD_1
v_mfma_f32_16x16x32_f16 v[92:95], v[232:235], v[212:215], v[92:95]
v_cndmask_b32_dpp v130, v146, v130, vcc quad_perm:[1,0,3,2] row_mask:0xf bank_mask:0xf
v_lshrrev_b32_e64 v193, 18, v193
v_cndmask_b32_dpp v131, v147, v131, vcc quad_perm:[1,0,3,2] row_mask:0xf bank_mask:0xf
s_not_b64 vcc, s[74:75]
s_waitcnt lgkmcnt(4)
v_mfma_f32_16x16x32_bf16 v[172:175], v[236:239], v[104:107], v[172:175]
ds_read_b128 v[232:235], v248 offset:34816
ds_read_u16_d16 v192, v192
ds_read_u16_d16_hi v193, v193
v_exp_f16_sdwa v195, v196 dst_sel:WORD_1 dst_unused:UNUSED_PRESERVE src0_sel:WORD_1
v_cndmask_b32_dpp v160, v144, v160, vcc quad_perm:[1,0,3,2] row_mask:0xf bank_mask:0xf
v_pk_add_f16 v201, v201, 1.0 op_sel_hi:[1,0]
v_mfma_f32_16x16x32_bf16 v[180:183], v[236:239], v[108:111], v[180:183]
v_cndmask_b32_dpp v161, v145, v161, vcc quad_perm:[1,0,3,2] row_mask:0xf bank_mask:0xf
v_pk_add_f16 v198, v198, 1.0 op_sel_hi:[1,0]
v_cndmask_b32_dpp v162, v146, v162, vcc quad_perm:[1,0,3,2] row_mask:0xf bank_mask:0xf
v_mfma_f32_16x16x32_bf16 v[168:171], v[216:219], v[112:115], v[168:171]
ds_read_b128 v[236:239], v249 offset:31744
v_pk_add_f16 v195, v195, 1.0 op_sel_hi:[1,0]
v_rcp_f16_e64 v202, v201
v_cndmask_b32_dpp v163, v147, v163, vcc quad_perm:[1,0,3,2] row_mask:0xf bank_mask:0xf
v_mfma_f32_16x16x32_bf16 v[176:179], v[216:219], v[116:119], v[176:179]
v_rcp_f16_e64 v199, v198
v_mfma_f32_16x16x32_bf16 v[172:175], v[220:223], v[112:115], v[172:175]
ds_read_b128 v[216:219], v248 offset:35072
s_add_u32 s46, s71, 98304
buffer_store_dwordx4 v[128:131], v255, s[8:11], s46 offen sc1
v_rcp_f16_e64 v196, v195
v_rcp_f16_sdwa v202, v201 dst_sel:WORD_1 dst_unused:UNUSED_PRESERVE src0_sel:WORD_1
v_mfma_f32_16x16x32_bf16 v[180:183], v[220:223], v[116:119], v[180:183]
v_rcp_f16_sdwa v199, v198 dst_sel:WORD_1 dst_unused:UNUSED_PRESERVE src0_sel:WORD_1
v_or_b32 v208, v184, v185
v_or_b32 v209, v186, v187
s_waitcnt lgkmcnt(2)
v_or_b32 v210, v188, v189
v_rcp_f16_sdwa v196, v195 dst_sel:WORD_1 dst_unused:UNUSED_PRESERVE src0_sel:WORD_1
v_or_b32 v211, v190, v191
v_or_b32 v212, v192, v193
v_pk_mul_f16 v213, v203, v202
v_pk_mul_f16 v214, v200, v199
v_pk_mul_f16 v215, v197, v196
v_mfma_f32_16x16x32_f16 v[48:51], v[224:227], v[208:211], v[48:51]
ds_read_b128 v[220:223], v249 offset:32000
v_cvt_pkrtz_f16_f32 v185, v168, v169
v_cvt_pkrtz_f16_f32 v187, v170, v171
v_mfma_f32_16x16x32_f16 v[56:59], v[224:227], v[212:215], v[56:59]
v_cvt_pkrtz_f16_f32 v189, v172, v173
v_cvt_pkrtz_f16_f32 v191, v174, v175
v_mfma_f32_16x16x32_f16 v[52:55], v[228:231], v[208:211], v[52:55]
ds_read_b128 v[224:227], v248 offset:35840
v_cvt_pkrtz_f16_f32 v193, v176, v177
v_cvt_pk_f16_f32 v203, v178, v179
v_mfma_f32_16x16x32_f16 v[60:63], v[228:231], v[212:215], v[60:63]
v_cvt_pk_f16_f32 v200, v180, v181
v_cvt_pk_f16_f32 v197, v182, v183
s_setprio 1
v_mfma_f32_16x16x32_bf16 v[168:171], v[232:235], v[96:99], 0
ds_read_b128 v[228:231], v249 offset:32768
v_pk_fma_f16 v202, v203, v203, s48
v_and_b32 v185, s49, v185
v_mfma_f32_16x16x32_bf16 v[176:179], v[232:235], v[100:103], 0
v_pk_fma_f16 v199, v200, v200, s48
v_and_b32 v187, s49, v187
s_waitcnt lgkmcnt(3)
v_mfma_f32_16x16x32_f16 v[64:67], v[236:239], v[208:211], v[64:67]
ds_read_b128 v[232:235], v249 offset:33024
v_pk_fma_f16 v196, v197, v197, s48
v_bfe_u32 v184, v185, 2, 14
v_pk_mul_f16 v202, v203, v202
v_mfma_f32_16x16x32_f16 v[72:75], v[236:239], v[212:215], v[72:75]
v_bfe_u32 v186, v187, 2, 14
v_pk_mul_f16 v199, v200, v199
s_waitcnt vmcnt(9)
v_mfma_f32_16x16x32_bf16 v[48:51], v[18:21], v[12:15], v[48:51]
ds_read_b128 v[236:239], v248 offset:36096
ds_read_u16_d16 v184, v184
ds_read_u16_d16 v186, v186
v_lshrrev_b32 v185, 18, v185
v_pk_mul_f16 v196, v197, v196
v_mfma_f32_16x16x32_bf16 v[52:55], v[16:19], v[12:15], v[52:55]
v_lshrrev_b32_e64 v187, 18, v187
v_mfma_f32_16x16x32_bf16 v[172:175], v[216:219], v[96:99], 0
ds_read_u16_d16_hi v185, v185
ds_read_u16_d16_hi v187, v187
v_exp_f16 v201, v202
v_and_b32 v189, s49, v189
v_mfma_f32_16x16x32_bf16 v[180:183], v[216:219], v[100:103], 0
v_and_b32 v191, s49, v191
s_waitcnt lgkmcnt(6)
v_mfma_f32_16x16x32_f16 v[68:71], v[220:223], v[208:211], v[68:71]
ds_read_b128 v[216:219], v248 offset:36864
v_exp_f16_e64 v198, v199
v_bfe_u32 v188, v189, 2, 14
v_mfma_f32_16x16x32_f16 v[76:79], v[220:223], v[212:215], v[76:79]
v_bfe_u32 v190, v191, 2, 14
v_exp_f16_e64 v195, v196
v_mfma_f32_16x16x32_bf16 v[168:171], v[224:227], v[104:107], v[168:171]
ds_read_b128 v[220:223], v248 offset:37120
ds_read_u16_d16 v188, v188
ds_read_u16_d16 v190, v190
v_lshrrev_b32 v189, 18, v189
v_lshrrev_b32 v191, 18, v191
v_mfma_f32_16x16x32_bf16 v[176:179], v[224:227], v[108:111], v[176:179]
v_exp_f16_sdwa v201, v202 dst_sel:WORD_1 dst_unused:UNUSED_PRESERVE src0_sel:WORD_1
v_mfma_f32_16x16x32_f16 v[80:83], v[228:231], v[208:211], v[80:83]
ds_read_b128 v[224:227], v249 offset:36864
ds_read_u16_d16_hi v189, v189
ds_read_u16_d16_hi v191, v191
v_and_b32 v193, s49, v193
v_bfe_u32 v192, v193, 2, 14
v_mfma_f32_16x16x32_f16 v[88:91], v[228:231], v[212:215], v[88:91]
v_exp_f16_sdwa v198, v199 dst_sel:WORD_1 dst_unused:UNUSED_PRESERVE src0_sel:WORD_1
s_waitcnt lgkmcnt(7)
v_mfma_f32_16x16x32_f16 v[84:87], v[232:235], v[208:211], v[84:87]
ds_read_b128 v[228:231], v249 offset:37120
ds_read_u16_d16 v192, v192
v_lshrrev_b32_e64 v193, 18, v193
v_mfma_f32_16x16x32_f16 v[92:95], v[232:235], v[212:215], v[92:95]
v_exp_f16_sdwa v195, v196 dst_sel:WORD_1 dst_unused:UNUSED_PRESERVE src0_sel:WORD_1
v_pk_add_f16 v201, v201, 1.0 op_sel_hi:[1,0]
v_pk_add_f16 v198, v198, 1.0 op_sel_hi:[1,0]
v_mfma_f32_16x16x32_bf16 v[172:175], v[236:239], v[104:107], v[172:175]
ds_read_b128 v[232:235], v248 offset:40960
ds_read_u16_d16_hi v193, v193
v_pk_add_f16 v195, v195, 1.0 op_sel_hi:[1,0]
v_mfma_f32_16x16x32_bf16 v[180:183], v[236:239], v[108:111], v[180:183]
v_rcp_f16_e64 v202, v201
s_setprio 0
s_waitcnt lgkmcnt(7)
v_mfma_f32_16x16x32_bf16 v[168:171], v[216:219], v[112:115], v[168:171]
ds_read_b128 v[236:239], v249 offset:37888
v_rcp_f16_e64 v199, v198
v_mfma_f32_16x16x32_bf16 v[176:179], v[216:219], v[116:119], v[176:179]
v_rcp_f16_e64 v196, v195
v_mfma_f32_16x16x32_bf16 v[172:175], v[220:223], v[112:115], v[172:175]
ds_read_b128 v[216:219], v248 offset:41216
v_rcp_f16_sdwa v202, v201 dst_sel:WORD_1 dst_unused:UNUSED_PRESERVE src0_sel:WORD_1
v_mfma_f32_16x16x32_bf16 v[180:183], v[220:223], v[116:119], v[180:183]
v_rcp_f16_sdwa v199, v198 dst_sel:WORD_1 dst_unused:UNUSED_PRESERVE src0_sel:WORD_1
v_or_b32 v208, v184, v185
v_or_b32 v209, v186, v187
s_waitcnt lgkmcnt(4)
v_or_b32 v210, v188, v189
v_rcp_f16_sdwa v196, v195 dst_sel:WORD_1 dst_unused:UNUSED_PRESERVE src0_sel:WORD_1
v_or_b32 v211, v190, v191
s_waitcnt lgkmcnt(2)
v_or_b32 v212, v192, v193
v_pk_mul_f16 v213, v203, v202
v_pk_mul_f16 v214, v200, v199
v_pk_mul_f16 v215, v197, v196
s_setprio 3
v_mfma_f32_16x16x32_f16 v[48:51], v[224:227], v[208:211], v[48:51]
s_add_u32 s46, s71, 98304
buffer_store_dwordx4 v[148:151], v255, s[8:11], s46 offen offset:128 sc1
ds_read_b128 v[220:223], v249 offset:38144
v_cvt_pkrtz_f16_f32 v185, v168, v169
v_cvt_pkrtz_f16_f32 v187, v170, v171
v_mfma_f32_16x16x32_f16 v[56:59], v[224:227], v[212:215], v[56:59]
v_cvt_pkrtz_f16_f32 v189, v172, v173
v_cvt_pkrtz_f16_f32 v191, v174, v175
v_mfma_f32_16x16x32_f16 v[52:55], v[228:231], v[208:211], v[52:55]
ds_read_b128 v[224:227], v248 offset:41984
v_cvt_pkrtz_f16_f32 v193, v176, v177
v_cvt_pk_f16_f32 v203, v178, v179
v_mfma_f32_16x16x32_f16 v[60:63], v[228:231], v[212:215], v[60:63]
v_cvt_pk_f16_f32 v200, v180, v181
v_cvt_pk_f16_f32 v197, v182, v183
v_mfma_f32_16x16x32_bf16 v[168:171], v[232:235], v[96:99], 0
ds_read_b128 v[228:231], v249 offset:38912
v_pk_fma_f16 v202, v203, v203, s48
v_and_b32_e64 v185, s49, v185
v_mfma_f32_16x16x32_bf16 v[176:179], v[232:235], v[100:103], 0
v_pk_fma_f16 v199, v200, v200, s48
v_and_b32 v187, s49, v187
s_waitcnt lgkmcnt(3)
v_mfma_f32_16x16x32_f16 v[64:67], v[236:239], v[208:211], v[64:67]
ds_read_b128 v[232:235], v249 offset:39168
v_pk_fma_f16 v196, v197, v197, s48
v_bfe_u32 v184, v185, 2, 14
v_pk_mul_f16 v202, v203, v202
v_mfma_f32_16x16x32_f16 v[72:75], v[236:239], v[212:215], v[72:75]
v_bfe_u32 v186, v187, 2, 14
v_pk_mul_f16 v199, v200, v199
s_waitcnt vmcnt(9)
v_mfma_f32_16x16x32_bf16 v[64:67], v[18:21], v[8:11], v[64:67]
ds_read_b128 v[236:239], v248 offset:42240
ds_read_u16_d16 v184, v184
ds_read_u16_d16 v186, v186
v_lshrrev_b32 v185, 18, v185
v_pk_mul_f16 v196, v197, v196
v_mfma_f32_16x16x32_bf16 v[68:71], v[16:19], v[8:11], v[68:71]
v_lshrrev_b32_e64 v187, 18, v187
v_mfma_f32_16x16x32_bf16 v[172:175], v[216:219], v[96:99], 0
ds_read_u16_d16_hi v185, v185
ds_read_u16_d16_hi v187, v187
v_exp_f16 v201, v202
v_and_b32 v189, s49, v189
v_mfma_f32_16x16x32_bf16 v[180:183], v[216:219], v[100:103], 0
v_and_b32 v191, s49, v191
s_waitcnt lgkmcnt(6)
v_mfma_f32_16x16x32_f16 v[68:71], v[220:223], v[208:211], v[68:71]
ds_read_b128 v[216:219], v248 offset:43008
v_exp_f16_e64 v198, v199
v_bfe_u32 v188, v189, 2, 14
v_mfma_f32_16x16x32_f16 v[76:79], v[220:223], v[212:215], v[76:79]
v_bfe_u32 v190, v191, 2, 14
v_exp_f16_e64 v195, v196
v_mfma_f32_16x16x32_bf16 v[168:171], v[224:227], v[104:107], v[168:171]
ds_read_b128 v[220:223], v248 offset:43264
ds_read_u16_d16 v188, v188
ds_read_u16_d16 v190, v190
v_lshrrev_b32 v189, 18, v189
v_lshrrev_b32 v191, 18, v191
v_mfma_f32_16x16x32_bf16 v[176:179], v[224:227], v[108:111], v[176:179]
v_exp_f16_sdwa v201, v202 dst_sel:WORD_1 dst_unused:UNUSED_PRESERVE src0_sel:WORD_1
v_mfma_f32_16x16x32_f16 v[80:83], v[228:231], v[208:211], v[80:83]
ds_read_b128 v[224:227], v249 offset:43008
ds_read_u16_d16_hi v189, v189
ds_read_u16_d16_hi v191, v191
v_and_b32 v193, s49, v193
v_bfe_u32 v192, v193, 2, 14
v_mfma_f32_16x16x32_f16 v[88:91], v[228:231], v[212:215], v[88:91]
v_exp_f16_sdwa v198, v199 dst_sel:WORD_1 dst_unused:UNUSED_PRESERVE src0_sel:WORD_1
s_waitcnt lgkmcnt(7)
v_mfma_f32_16x16x32_f16 v[84:87], v[232:235], v[208:211], v[84:87]
ds_read_b128 v[228:231], v249 offset:43264
ds_read_u16_d16 v192, v192
v_lshrrev_b32_e64 v193, 18, v193
v_mfma_f32_16x16x32_f16 v[92:95], v[232:235], v[212:215], v[92:95]
v_exp_f16_sdwa v195, v196 dst_sel:WORD_1 dst_unused:UNUSED_PRESERVE src0_sel:WORD_1
v_pk_add_f16 v201, v201, 1.0 op_sel_hi:[1,0]
v_pk_add_f16 v198, v198, 1.0 op_sel_hi:[1,0]
v_mfma_f32_16x16x32_bf16 v[172:175], v[236:239], v[104:107], v[172:175]
ds_read_b128 v[232:235], v248 offset:16384
ds_read_u16_d16_hi v193, v193
v_pk_add_f16 v195, v195, 1.0 op_sel_hi:[1,0]
v_mfma_f32_16x16x32_bf16 v[180:183], v[236:239], v[108:111], v[180:183]
v_rcp_f16 v202, v201
s_waitcnt lgkmcnt(7)
v_mfma_f32_16x16x32_bf16 v[168:171], v[216:219], v[112:115], v[168:171]
ds_read_b128 v[236:239], v249 offset:44032
v_rcp_f16_e64 v199, v198
v_mfma_f32_16x16x32_bf16 v[176:179], v[216:219], v[116:119], v[176:179]
v_rcp_f16_e64 v196, v195
v_mfma_f32_16x16x32_bf16 v[172:175], v[220:223], v[112:115], v[172:175]
ds_read_b128 v[216:219], v248 offset:16640
v_rcp_f16_sdwa v202, v201 dst_sel:WORD_1 dst_unused:UNUSED_PRESERVE src0_sel:WORD_1
v_mfma_f32_16x16x32_bf16 v[180:183], v[220:223], v[116:119], v[180:183]
v_rcp_f16_sdwa v199, v198 dst_sel:WORD_1 dst_unused:UNUSED_PRESERVE src0_sel:WORD_1
v_or_b32 v208, v184, v185
v_or_b32 v209, v186, v187
s_waitcnt lgkmcnt(4)
v_or_b32 v210, v188, v189
v_rcp_f16_sdwa v196, v195 dst_sel:WORD_1 dst_unused:UNUSED_PRESERVE src0_sel:WORD_1
v_or_b32 v211, v190, v191
s_waitcnt lgkmcnt(2)
v_or_b32_e64 v212, v192, v193
v_pk_mul_f16 v213, v203, v202
v_pk_mul_f16 v214, v200, v199
v_pk_mul_f16 v215, v197, v196
v_mfma_f32_16x16x32_f16 v[48:51], v[224:227], v[208:211], v[48:51]
s_add_u32 s46, s71, 98304
buffer_store_dwordx4 v[160:163], v255, s[8:11], s46 offen offset:256 sc1
ds_read_b128 v[220:223], v249 offset:44288
v_cvt_pkrtz_f16_f32 v185, v168, v169
v_cvt_pkrtz_f16_f32 v187, v170, v171
v_mfma_f32_16x16x32_f16 v[56:59], v[224:227], v[212:215], v[56:59]
v_cvt_pkrtz_f16_f32 v189, v172, v173
v_cvt_pkrtz_f16_f32 v191, v174, v175
v_mfma_f32_16x16x32_f16 v[52:55], v[228:231], v[208:211], v[52:55]
ds_read_b128 v[224:227], v248 offset:17408
v_cvt_pkrtz_f16_f32 v193, v176, v177
v_cvt_pk_f16_f32 v203, v178, v179
v_mfma_f32_16x16x32_f16 v[60:63], v[228:231], v[212:215], v[60:63]
v_cvt_pk_f16_f32 v200, v180, v181
v_cvt_pk_f16_f32 v197, v182, v183
v_mfma_f32_16x16x32_bf16 v[168:171], v[232:235], v[24:27], 0
ds_read_b128 v[228:231], v249 offset:45056
v_pk_fma_f16 v202, v203, v203, s48
v_and_b32_e64 v185, s49, v185
v_mfma_f32_16x16x32_bf16 v[176:179], v[232:235], v[28:31], 0
v_pk_fma_f16 v199, v200, v200, s48
v_and_b32 v187, s49, v187
s_waitcnt lgkmcnt(3)
v_mfma_f32_16x16x32_f16 v[64:67], v[236:239], v[208:211], v[64:67]
ds_read_b128 v[232:235], v249 offset:45312
v_pk_fma_f16 v196, v197, v197, s48
s_setprio 2
v_bfe_u32 v184, v185, 2, 14
v_pk_mul_f16 v202, v203, v202
v_mfma_f32_16x16x32_f16 v[72:75], v[236:239], v[212:215], v[72:75]
v_bfe_u32 v186, v187, 2, 14
v_pk_mul_f16 v199, v200, v199
s_waitcnt vmcnt(9)
v_mfma_f32_16x16x32_bf16 v[80:83], v[18:21], v[4:7], v[80:83]
ds_read_b128 v[236:239], v248 offset:17664
ds_read_u16_d16 v184, v184
ds_read_u16_d16 v186, v186
v_lshrrev_b32_e64 v185, 18, v185
v_pk_mul_f16 v196, v197, v196
v_mfma_f32_16x16x32_bf16 v[84:87], v[16:19], v[4:7], v[84:87]
v_lshrrev_b32_e64 v187, 18, v187
v_mfma_f32_16x16x32_bf16 v[172:175], v[216:219], v[24:27], 0
ds_read_u16_d16_hi v185, v185
ds_read_u16_d16_hi v187, v187
v_exp_f16 v201, v202
v_and_b32 v189, s49, v189
v_mfma_f32_16x16x32_bf16 v[180:183], v[216:219], v[28:31], 0
v_and_b32 v191, s49, v191
s_waitcnt lgkmcnt(6)
v_mfma_f32_16x16x32_f16 v[68:71], v[220:223], v[208:211], v[68:71]
ds_read_b128 v[216:219], v248 offset:18432
v_exp_f16_e64 v198, v199
v_bfe_u32 v188, v189, 2, 14
v_mfma_f32_16x16x32_f16 v[76:79], v[220:223], v[212:215], v[76:79]
v_bfe_u32 v190, v191, 2, 14
v_exp_f16_e64 v195, v196
v_mfma_f32_16x16x32_bf16 v[168:171], v[224:227], v[32:35], v[168:171]
s_add_u32 s46, s80, 12582912
buffer_load_dwordx4 v[96:99], v253, s[32:35], s46 offen nt
ds_read_b128 v[220:223], v248 offset:18688
ds_read_u16_d16 v188, v188
ds_read_u16_d16 v190, v190
v_lshrrev_b32 v189, 18, v189
v_lshrrev_b32 v191, 18, v191
v_mfma_f32_16x16x32_bf16 v[176:179], v[224:227], v[36:39], v[176:179]
v_exp_f16_sdwa v201, v202 dst_sel:WORD_1 dst_unused:UNUSED_PRESERVE src0_sel:WORD_1
v_mfma_f32_16x16x32_f16 v[80:83], v[228:231], v[208:211], v[80:83]
ds_read_b128 v[224:227], v249 offset:49152
ds_read_u16_d16_hi v189, v189
ds_read_u16_d16_hi v191, v191
v_and_b32 v193, s49, v193
v_bfe_u32 v192, v193, 2, 14
v_mfma_f32_16x16x32_f16 v[88:91], v[228:231], v[212:215], v[88:91]
v_exp_f16_sdwa v198, v199 dst_sel:WORD_1 dst_unused:UNUSED_PRESERVE src0_sel:WORD_1
s_waitcnt lgkmcnt(7)
v_mfma_f32_16x16x32_f16 v[84:87], v[232:235], v[208:211], v[84:87]
ds_read_b128 v[228:231], v249 offset:49408
ds_read_u16_d16 v192, v192
v_lshrrev_b32_e64 v193, 18, v193
v_mfma_f32_16x16x32_f16 v[92:95], v[232:235], v[212:215], v[92:95]
v_exp_f16_sdwa v195, v196 dst_sel:WORD_1 dst_unused:UNUSED_PRESERVE src0_sel:WORD_1
v_pk_add_f16 v201, v201, 1.0 op_sel_hi:[1,0]
v_pk_add_f16 v198, v198, 1.0 op_sel_hi:[1,0]
v_mfma_f32_16x16x32_bf16 v[172:175], v[236:239], v[32:35], v[172:175]
ds_read_b128 v[232:235], v248 offset:22528
ds_read_u16_d16_hi v193, v193
v_pk_add_f16 v195, v195, 1.0 op_sel_hi:[1,0]
v_mfma_f32_16x16x32_bf16 v[180:183], v[236:239], v[36:39], v[180:183]
v_rcp_f16 v202, v201
s_waitcnt lgkmcnt(7)
v_mfma_f32_16x16x32_bf16 v[168:171], v[216:219], v[40:43], v[168:171]
ds_read_b128 v[236:239], v249 offset:50176
v_rcp_f16_e64 v199, v198
v_mfma_f32_16x16x32_bf16 v[176:179], v[216:219], v[44:47], v[176:179]
v_rcp_f16_e64 v196, v195
v_mfma_f32_16x16x32_bf16 v[172:175], v[220:223], v[40:43], v[172:175]
ds_read_b128 v[216:219], v248 offset:22784
v_rcp_f16_sdwa v202, v201 dst_sel:WORD_1 dst_unused:UNUSED_PRESERVE src0_sel:WORD_1
v_mfma_f32_16x16x32_bf16 v[180:183], v[220:223], v[44:47], v[180:183]
v_rcp_f16_sdwa v199, v198 dst_sel:WORD_1 dst_unused:UNUSED_PRESERVE src0_sel:WORD_1
v_or_b32 v208, v184, v185
v_or_b32 v209, v186, v187
s_waitcnt lgkmcnt(4)
v_or_b32 v210, v188, v189
v_rcp_f16_sdwa v196, v195 dst_sel:WORD_1 dst_unused:UNUSED_PRESERVE src0_sel:WORD_1
v_or_b32 v211, v190, v191
s_waitcnt lgkmcnt(2)
v_or_b32_e64 v212, v192, v193
v_pk_mul_f16 v213, v203, v202
v_pk_mul_f16 v214, v200, v199
v_pk_mul_f16 v215, v197, v196
v_mfma_f32_16x16x32_f16 v[48:51], v[224:227], v[208:211], v[48:51]
s_add_u32 s46, s80, 12582912
buffer_load_dwordx4 v[100:103], v253, s[32:35], s46 offen offset:256 nt
ds_read_b128 v[220:223], v249 offset:50432
v_cvt_pkrtz_f16_f32 v185, v168, v169
v_cvt_pkrtz_f16_f32 v187, v170, v171
v_mfma_f32_16x16x32_f16 v[56:59], v[224:227], v[212:215], v[56:59]
v_cvt_pkrtz_f16_f32 v189, v172, v173
v_cvt_pkrtz_f16_f32 v191, v174, v175
v_mfma_f32_16x16x32_f16 v[52:55], v[228:231], v[208:211], v[52:55]
ds_read_b128 v[224:227], v248 offset:23552
v_cvt_pkrtz_f16_f32 v193, v176, v177
v_cvt_pk_f16_f32 v203, v178, v179
v_mfma_f32_16x16x32_f16 v[60:63], v[228:231], v[212:215], v[60:63]
v_cvt_pk_f16_f32 v200, v180, v181
v_cvt_pk_f16_f32 v197, v182, v183
s_setprio 1
v_mfma_f32_16x16x32_bf16 v[168:171], v[232:235], v[24:27], 0
ds_read_b128 v[228:231], v249 offset:51200
v_pk_fma_f16 v202, v203, v203, s48
v_and_b32 v185, s49, v185
v_mfma_f32_16x16x32_bf16 v[176:179], v[232:235], v[28:31], 0
v_pk_fma_f16 v199, v200, v200, s48
v_and_b32 v187, s49, v187
s_waitcnt lgkmcnt(3)
v_mfma_f32_16x16x32_f16 v[64:67], v[236:239], v[208:211], v[64:67]
ds_read_b128 v[232:235], v249 offset:51456
v_pk_fma_f16 v196, v197, v197, s48
v_bfe_u32 v184, v185, 2, 14
v_pk_mul_f16 v202, v203, v202
v_mfma_f32_16x16x32_f16 v[72:75], v[236:239], v[212:215], v[72:75]
v_bfe_u32 v186, v187, 2, 14
v_pk_mul_f16 v199, v200, v199
s_waitcnt vmcnt(10)
v_mfma_f32_16x16x32_bf16 v[56:59], v[18:21], v[0:3], v[56:59]
ds_read_b128 v[236:239], v248 offset:23808
ds_read_u16_d16 v184, v184
ds_read_u16_d16 v186, v186
v_lshrrev_b32 v185, 18, v185
v_pk_mul_f16 v196, v197, v196
v_mfma_f32_16x16x32_bf16 v[60:63], v[16:19], v[0:3], v[60:63]
v_lshrrev_b32_e64 v187, 18, v187
v_mfma_f32_16x16x32_bf16 v[172:175], v[216:219], v[24:27], 0
ds_read_u16_d16_hi v185, v185
ds_read_u16_d16_hi v187, v187
v_exp_f16 v201, v202
v_and_b32 v189, s49, v189
v_mfma_f32_16x16x32_bf16 v[180:183], v[216:219], v[28:31], 0
v_and_b32 v191, s49, v191
s_waitcnt lgkmcnt(6)
v_mfma_f32_16x16x32_f16 v[68:71], v[220:223], v[208:211], v[68:71]
ds_read_b128 v[216:219], v248 offset:24576
v_exp_f16_e64 v198, v199
v_bfe_u32 v188, v189, 2, 14
v_mfma_f32_16x16x32_f16 v[76:79], v[220:223], v[212:215], v[76:79]
v_bfe_u32 v190, v191, 2, 14
v_exp_f16_e64 v195, v196
v_mfma_f32_16x16x32_bf16 v[168:171], v[224:227], v[32:35], v[168:171]
ds_read_b128 v[220:223], v248 offset:24832
ds_read_u16_d16 v188, v188
ds_read_u16_d16 v190, v190
v_lshrrev_b32 v189, 18, v189
v_lshrrev_b32 v191, 18, v191
v_mfma_f32_16x16x32_bf16 v[176:179], v[224:227], v[36:39], v[176:179]
v_exp_f16_sdwa v201, v202 dst_sel:WORD_1 dst_unused:UNUSED_PRESERVE src0_sel:WORD_1
v_mfma_f32_16x16x32_f16 v[80:83], v[228:231], v[208:211], v[80:83]
ds_read_b128 v[224:227], v249 offset:24576
ds_read_u16_d16_hi v189, v189
ds_read_u16_d16_hi v191, v191
v_and_b32 v193, s49, v193
v_bfe_u32 v192, v193, 2, 14
v_mfma_f32_16x16x32_f16 v[88:91], v[228:231], v[212:215], v[88:91]
v_exp_f16_sdwa v198, v199 dst_sel:WORD_1 dst_unused:UNUSED_PRESERVE src0_sel:WORD_1
s_waitcnt lgkmcnt(7)
v_mfma_f32_16x16x32_f16 v[84:87], v[232:235], v[208:211], v[84:87]
ds_read_b128 v[228:231], v254 offset:7936
ds_read_u16_d16 v192, v192
v_lshrrev_b32_e64 v193, 18, v193
v_mfma_f32_16x16x32_f16 v[92:95], v[232:235], v[212:215], v[92:95]
v_exp_f16_sdwa v195, v196 dst_sel:WORD_1 dst_unused:UNUSED_PRESERVE src0_sel:WORD_1
v_pk_add_f16 v201, v201, 1.0 op_sel_hi:[1,0]
v_pk_add_f16 v198, v198, 1.0 op_sel_hi:[1,0]
v_mfma_f32_16x16x32_bf16 v[172:175], v[236:239], v[32:35], v[172:175]
ds_read_b128 v[232:235], v249 offset:24832
ds_read_u16_d16_hi v193, v193
v_pk_add_f16 v195, v195, 1.0 op_sel_hi:[1,0]
v_mfma_f32_16x16x32_bf16 v[180:183], v[236:239], v[36:39], v[180:183]
v_rcp_f16_e64 v202, v201
s_setprio 0
s_waitcnt lgkmcnt(7)
v_mfma_f32_16x16x32_bf16 v[168:171], v[216:219], v[40:43], v[168:171]
ds_read_b128 v[236:239], v254 offset:7952
v_rcp_f16_e64 v199, v198
v_mfma_f32_16x16x32_bf16 v[176:179], v[216:219], v[44:47], v[176:179]
v_rcp_f16_e64 v196, v195
v_mfma_f32_16x16x32_bf16 v[172:175], v[220:223], v[40:43], v[172:175]
ds_read_b128 v[216:219], v248 offset:28672
v_rcp_f16_sdwa v202, v201 dst_sel:WORD_1 dst_unused:UNUSED_PRESERVE src0_sel:WORD_1
v_mfma_f32_16x16x32_bf16 v[180:183], v[220:223], v[44:47], v[180:183]
v_rcp_f16_sdwa v199, v198 dst_sel:WORD_1 dst_unused:UNUSED_PRESERVE src0_sel:WORD_1
v_or_b32 v208, v184, v185
v_or_b32 v209, v186, v187
s_waitcnt lgkmcnt(4)
v_or_b32 v210, v188, v189
v_rcp_f16_sdwa v196, v195 dst_sel:WORD_1 dst_unused:UNUSED_PRESERVE src0_sel:WORD_1
v_or_b32 v211, v190, v191
s_waitcnt lgkmcnt(2)
v_or_b32_e64 v212, v192, v193
v_pk_mul_f16 v213, v203, v202
v_pk_mul_f16 v214, v200, v199
v_pk_mul_f16 v215, v197, v196
s_setprio 3
v_mfma_f32_16x16x32_f16 v[120:123], v[224:227], v[208:211], v[228:231]
s_add_u32 s46, s80, 16777216
buffer_load_dwordx4 v[104:107], v253, s[32:35], s46 offen nt
ds_read_b128 v[220:223], v249 offset:25600
v_cvt_pkrtz_f16_f32 v185, v168, v169
v_cvt_pkrtz_f16_f32 v187, v170, v171
v_mfma_f32_16x16x32_f16 v[128:131], v[224:227], v[212:215], v[228:231]
v_cvt_pkrtz_f16_f32 v189, v172, v173
v_cvt_pkrtz_f16_f32 v191, v174, v175
s_waitcnt lgkmcnt(1)
v_mfma_f32_16x16x32_f16 v[124:127], v[232:235], v[208:211], v[236:239]
ds_read_b128 v[224:227], v254 offset:8064
ds_read_b128 v[228:231], v248 offset:28928
v_cvt_pkrtz_f16_f32 v193, v176, v177
v_cvt_pk_f16_f32 v203, v178, v179
v_mfma_f32_16x16x32_f16 v[132:135], v[232:235], v[212:215], v[236:239]
v_cvt_pk_f16_f32 v200, v180, v181
v_cvt_pk_f16_f32 v197, v182, v183
v_mfma_f32_16x16x32_bf16 v[168:171], v[216:219], v[24:27], 0
ds_read_b128 v[232:235], v249 offset:25856
ds_read_b128 v[236:239], v254 offset:8080
v_pk_fma_f16 v202, v203, v203, s48
v_and_b32_e64 v185, s49, v185
v_mfma_f32_16x16x32_bf16 v[176:179], v[216:219], v[28:31], 0
v_pk_fma_f16 v199, v200, v200, s48
v_and_b32 v187, s49, v187
s_waitcnt lgkmcnt(3)
v_mfma_f32_16x16x32_f16 v[136:139], v[220:223], v[208:211], v[224:227]
ds_read_b128 v[216:219], v248 offset:29696
v_pk_fma_f16 v196, v197, v197, s48
v_bfe_u32 v184, v185, 2, 14
v_pk_mul_f16 v202, v203, v202
v_mfma_f32_16x16x32_f16 v[144:147], v[220:223], v[212:215], v[224:227]
v_bfe_u32 v186, v187, 2, 14
v_pk_mul_f16 v199, v200, v199
s_waitcnt vmcnt(8)
v_mfma_f32_16x16x32_bf16 v[72:75], v[18:21], v[244:247], v[72:75]
ds_read_b128 v[220:223], v249 offset:26624
ds_read_b128 v[224:227], v254 offset:16128
ds_read_u16_d16 v184, v184
ds_read_u16_d16 v186, v186
v_lshrrev_b32 v185, 18, v185
v_pk_mul_f16 v196, v197, v196
v_mfma_f32_16x16x32_bf16 v[76:79], v[16:19], v[244:247], v[76:79]
v_lshrrev_b32 v187, 18, v187
s_waitcnt lgkmcnt(5)
v_mfma_f32_16x16x32_bf16 v[172:175], v[228:231], v[24:27], 0
ds_read_u16_d16_hi v185, v185
ds_read_u16_d16_hi v187, v187
v_exp_f16 v201, v202
v_and_b32 v189, s49, v189
v_mfma_f32_16x16x32_bf16 v[180:183], v[228:231], v[28:31], 0
v_and_b32_e64 v191, s49, v191
v_mfma_f32_16x16x32_f16 v[140:143], v[232:235], v[208:211], v[236:239]
ds_read_b128 v[228:231], v249 offset:26880
v_exp_f16_e64 v198, v199
v_bfe_u32 v188, v189, 2, 14
v_mfma_f32_16x16x32_f16 v[148:151], v[232:235], v[212:215], v[236:239]
v_bfe_u32 v190, v191, 2, 14
v_exp_f16 v195, v196
s_waitcnt lgkmcnt(7)
v_mfma_f32_16x16x32_bf16 v[168:171], v[216:219], v[32:35], v[168:171]
ds_read_b128 v[232:235], v254 offset:16144
ds_read_b128 v[236:239], v248 offset:29952
ds_read_u16_d16 v188, v188
ds_read_u16_d16 v190, v190
v_lshrrev_b32_e64 v189, 18, v189
v_lshrrev_b32 v191, 18, v191
v_mfma_f32_16x16x32_bf16 v[176:179], v[216:219], v[36:39], v[176:179]
v_exp_f16_sdwa v201, v202 dst_sel:WORD_1 dst_unused:UNUSED_PRESERVE src0_sel:WORD_1
s_waitcnt lgkmcnt(7)
v_mfma_f32_16x16x32_f16 v[152:155], v[220:223], v[208:211], v[224:227]
ds_read_b128 v[216:219], v248 offset:30720
ds_read_u16_d16_hi v189, v189
ds_read_u16_d16_hi v191, v191
v_and_b32 v193, s49, v193
v_bfe_u32 v192, v193, 2, 14
v_mfma_f32_16x16x32_f16 v[160:163], v[220:223], v[212:215], v[224:227]
v_exp_f16_sdwa v198, v199 dst_sel:WORD_1 dst_unused:UNUSED_PRESERVE src0_sel:WORD_1
s_waitcnt lgkmcnt(6)
v_mfma_f32_16x16x32_f16 v[156:159], v[228:231], v[208:211], v[232:235]
ds_read_b128 v[220:223], v248 offset:30976
ds_read_b128 v[224:227], v249 offset:30720
ds_read_u16_d16 v192, v192
v_lshrrev_b32 v193, 18, v193
v_mfma_f32_16x16x32_f16 v[164:167], v[228:231], v[212:215], v[232:235]
v_exp_f16_sdwa v195, v196 dst_sel:WORD_1 dst_unused:UNUSED_PRESERVE src0_sel:WORD_1
v_pk_add_f16 v201, v201, 1.0 op_sel_hi:[1,0]
v_pk_add_f16 v198, v198, 1.0 op_sel_hi:[1,0]
s_waitcnt lgkmcnt(7)
v_mfma_f32_16x16x32_bf16 v[172:175], v[236:239], v[32:35], v[172:175]
ds_read_b128 v[228:231], v249 offset:30976
ds_read_b128 v[232:235], v248 offset:34816
ds_read_u16_d16_hi v193, v193
v_pk_add_f16 v195, v195, 1.0 op_sel_hi:[1,0]
v_mfma_f32_16x16x32_bf16 v[180:183], v[236:239], v[36:39], v[180:183]
v_rcp_f16 v202, v201
s_waitcnt lgkmcnt(8)
v_mfma_f32_16x16x32_bf16 v[168:171], v[216:219], v[40:43], v[168:171]
ds_read_b128 v[236:239], v249 offset:31744
v_rcp_f16_e64 v199, v198
v_mfma_f32_16x16x32_bf16 v[176:179], v[216:219], v[44:47], v[176:179]
v_rcp_f16 v196, v195
s_waitcnt lgkmcnt(6)
v_mfma_f32_16x16x32_bf16 v[172:175], v[220:223], v[40:43], v[172:175]
ds_read_b128 v[216:219], v248 offset:35072
v_rcp_f16_sdwa v202, v201 dst_sel:WORD_1 dst_unused:UNUSED_PRESERVE src0_sel:WORD_1
v_mfma_f32_16x16x32_bf16 v[180:183], v[220:223], v[44:47], v[180:183]
v_rcp_f16_sdwa v199, v198 dst_sel:WORD_1 dst_unused:UNUSED_PRESERVE src0_sel:WORD_1
v_or_b32 v208, v184, v185
v_or_b32 v209, v186, v187
v_or_b32_e64 v210, v188, v189
v_rcp_f16_sdwa v196, v195 dst_sel:WORD_1 dst_unused:UNUSED_PRESERVE src0_sel:WORD_1
v_or_b32 v211, v190, v191
s_waitcnt lgkmcnt(2)
v_or_b32_e64 v212, v192, v193
v_pk_mul_f16 v213, v203, v202
v_pk_mul_f16 v214, v200, v199
v_pk_mul_f16 v215, v197, v196
v_mfma_f32_16x16x32_f16 v[120:123], v[224:227], v[208:211], v[120:123]
s_add_u32 s46, s80, 16777216
buffer_load_dwordx4 v[108:111], v253, s[32:35], s46 offen offset:256 nt
ds_read_b128 v[220:223], v249 offset:32000
v_cvt_pkrtz_f16_f32 v185, v168, v169
v_cvt_pkrtz_f16_f32 v187, v170, v171
v_mfma_f32_16x16x32_f16 v[128:131], v[224:227], v[212:215], v[128:131]
v_cvt_pkrtz_f16_f32 v189, v172, v173
v_cvt_pkrtz_f16_f32 v191, v174, v175
v_mfma_f32_16x16x32_f16 v[124:127], v[228:231], v[208:211], v[124:127]
ds_read_b128 v[224:227], v248 offset:35840
v_cvt_pkrtz_f16_f32 v193, v176, v177
v_cvt_pk_f16_f32 v203, v178, v179
v_mfma_f32_16x16x32_f16 v[132:135], v[228:231], v[212:215], v[132:135]
v_cvt_pk_f16_f32 v200, v180, v181
v_cvt_pk_f16_f32 v197, v182, v183
v_mfma_f32_16x16x32_bf16 v[168:171], v[232:235], v[24:27], 0
ds_read_b128 v[228:231], v249 offset:32768
v_pk_fma_f16 v202, v203, v203, s48
v_and_b32_e64 v185, s49, v185
v_mfma_f32_16x16x32_bf16 v[176:179], v[232:235], v[28:31], 0
v_pk_fma_f16 v199, v200, v200, s48
v_and_b32 v187, s49, v187
s_waitcnt lgkmcnt(3)
v_mfma_f32_16x16x32_f16 v[136:139], v[236:239], v[208:211], v[136:139]
ds_read_b128 v[232:235], v249 offset:33024
v_pk_fma_f16 v196, v197, v197, s48
s_setprio 2
v_bfe_u32 v184, v185, 2, 14
v_pk_mul_f16 v202, v203, v202
v_mfma_f32_16x16x32_f16 v[144:147], v[236:239], v[212:215], v[144:147]
v_bfe_u32 v186, v187, 2, 14
v_pk_mul_f16 v199, v200, v199
s_waitcnt vmcnt(8)
v_mfma_f32_16x16x32_bf16 v[88:91], v[18:21], v[204:207], v[88:91]
ds_read_b128 v[236:239], v248 offset:36096
ds_read_u16_d16 v184, v184
ds_read_u16_d16 v186, v186
v_lshrrev_b32_e64 v185, 18, v185
v_pk_mul_f16 v196, v197, v196
v_mfma_f32_16x16x32_bf16 v[92:95], v[16:19], v[204:207], v[92:95]
v_lshrrev_b32_e64 v187, 18, v187
v_mfma_f32_16x16x32_bf16 v[172:175], v[216:219], v[24:27], 0
ds_read_u16_d16_hi v185, v185
ds_read_u16_d16_hi v187, v187
v_exp_f16 v201, v202
v_and_b32 v189, s49, v189
v_mfma_f32_16x16x32_bf16 v[180:183], v[216:219], v[28:31], 0
v_and_b32 v191, s49, v191
s_waitcnt lgkmcnt(6)
v_mfma_f32_16x16x32_f16 v[140:143], v[220:223], v[208:211], v[140:143]
ds_read_b128 v[216:219], v248 offset:36864
v_exp_f16_e64 v198, v199
v_bfe_u32 v188, v189, 2, 14
v_mfma_f32_16x16x32_f16 v[148:151], v[220:223], v[212:215], v[148:151]
v_bfe_u32 v190, v191, 2, 14
v_exp_f16_e64 v195, v196
v_mfma_f32_16x16x32_bf16 v[168:171], v[224:227], v[32:35], v[168:171]
ds_read_b128 v[220:223], v248 offset:37120
ds_read_u16_d16 v188, v188
ds_read_u16_d16 v190, v190
v_lshrrev_b32 v189, 18, v189
v_lshrrev_b32 v191, 18, v191
v_mfma_f32_16x16x32_bf16 v[176:179], v[224:227], v[36:39], v[176:179]
v_exp_f16_sdwa v201, v202 dst_sel:WORD_1 dst_unused:UNUSED_PRESERVE src0_sel:WORD_1
v_mfma_f32_16x16x32_f16 v[152:155], v[228:231], v[208:211], v[152:155]
ds_read_b128 v[224:227], v249 offset:36864
ds_read_u16_d16_hi v189, v189
ds_read_u16_d16_hi v191, v191
v_and_b32 v193, s49, v193
v_bfe_u32 v192, v193, 2, 14
v_mfma_f32_16x16x32_f16 v[160:163], v[228:231], v[212:215], v[160:163]
v_exp_f16_sdwa v198, v199 dst_sel:WORD_1 dst_unused:UNUSED_PRESERVE src0_sel:WORD_1
s_waitcnt lgkmcnt(7)
v_mfma_f32_16x16x32_f16 v[156:159], v[232:235], v[208:211], v[156:159]
ds_read_b128 v[228:231], v249 offset:37120
ds_read_u16_d16 v192, v192
v_lshrrev_b32_e64 v193, 18, v193
v_mfma_f32_16x16x32_f16 v[164:167], v[232:235], v[212:215], v[164:167]
v_exp_f16_sdwa v195, v196 dst_sel:WORD_1 dst_unused:UNUSED_PRESERVE src0_sel:WORD_1
v_pk_add_f16 v201, v201, 1.0 op_sel_hi:[1,0]
v_pk_add_f16 v198, v198, 1.0 op_sel_hi:[1,0]
v_mfma_f32_16x16x32_bf16 v[172:175], v[236:239], v[32:35], v[172:175]
ds_read_b128 v[232:235], v248 offset:40960
ds_read_u16_d16_hi v193, v193
v_pk_add_f16 v195, v195, 1.0 op_sel_hi:[1,0]
v_mfma_f32_16x16x32_bf16 v[180:183], v[236:239], v[36:39], v[180:183]
v_rcp_f16 v202, v201
s_waitcnt lgkmcnt(7)
v_mfma_f32_16x16x32_bf16 v[168:171], v[216:219], v[40:43], v[168:171]
ds_read_b128 v[236:239], v249 offset:37888
v_rcp_f16_e64 v199, v198
v_mfma_f32_16x16x32_bf16 v[176:179], v[216:219], v[44:47], v[176:179]
v_rcp_f16_e64 v196, v195
v_mfma_f32_16x16x32_bf16 v[172:175], v[220:223], v[40:43], v[172:175]
ds_read_b128 v[216:219], v248 offset:41216
v_rcp_f16_sdwa v202, v201 dst_sel:WORD_1 dst_unused:UNUSED_PRESERVE src0_sel:WORD_1
v_mfma_f32_16x16x32_bf16 v[180:183], v[220:223], v[44:47], v[180:183]
v_rcp_f16_sdwa v199, v198 dst_sel:WORD_1 dst_unused:UNUSED_PRESERVE src0_sel:WORD_1
v_or_b32 v208, v184, v185
v_or_b32 v209, v186, v187
s_waitcnt lgkmcnt(4)
v_or_b32 v210, v188, v189
v_rcp_f16_sdwa v196, v195 dst_sel:WORD_1 dst_unused:UNUSED_PRESERVE src0_sel:WORD_1
v_or_b32 v211, v190, v191
s_waitcnt lgkmcnt(2)
v_or_b32_e64 v212, v192, v193
v_pk_mul_f16 v213, v203, v202
v_pk_mul_f16 v214, v200, v199
v_pk_mul_f16 v215, v197, v196
v_mfma_f32_16x16x32_f16 v[120:123], v[224:227], v[208:211], v[120:123]
s_add_u32 s46, s80, 20971520
buffer_load_dwordx4 v[112:115], v253, s[32:35], s46 offen nt
ds_read_b128 v[220:223], v249 offset:38144
v_cvt_pkrtz_f16_f32 v185, v168, v169
v_cvt_pkrtz_f16_f32 v187, v170, v171
v_cvt_pkrtz_f16_f32 v189, v172, v173
v_mfma_f32_16x16x32_f16 v[128:131], v[224:227], v[212:215], v[128:131]
v_cvt_pkrtz_f16_f32 v191, v174, v175
v_cvt_pkrtz_f16_f32 v193, v176, v177
v_cvt_pk_f16_f32 v203, v178, v179
v_mfma_f32_16x16x32_f16 v[124:127], v[228:231], v[208:211], v[124:127]
ds_read_b128 v[224:227], v248 offset:41984
v_cvt_pk_f16_f32 v200, v180, v181
v_cvt_pk_f16_f32 v197, v182, v183
v_pk_fma_f16 v202, v203, v203, s48
s_setprio 1
v_cvt_pk_bf16_f32 v64, v64, v65
v_mfma_f32_16x16x32_f16 v[132:135], v[228:231], v[212:215], v[132:135]
v_and_b32 v185, s49, v185
v_cvt_pk_bf16_f32 v65, v66, v67
v_pk_fma_f16 v199, v200, v200, s48
v_mfma_f32_16x16x32_bf16 v[168:171], v[232:235], v[24:27], 0
ds_read_b128 v[228:231], v249 offset:38912
v_and_b32 v187, s49, v187
v_cvt_pk_bf16_f32 v66, v68, v69
v_pk_fma_f16 v196, v197, v197, s48
v_mfma_f32_16x16x32_bf16 v[176:179], v[232:235], v[28:31], 0
v_cvt_pk_bf16_f32 v67, v70, v71
v_bfe_u32 v184, v185, 2, 14
v_pk_mul_f16 v202, v203, v202
v_cvt_pk_bf16_f32 v48, v48, v49
s_waitcnt lgkmcnt(2)
v_mfma_f32_16x16x32_f16 v[136:139], v[236:239], v[208:211], v[136:139]
ds_read_b128 v[232:235], v249 offset:39168
ds_read_u16_d16 v184, v184
v_bfe_u32 v186, v187, 2, 14
v_cvt_pk_bf16_f32 v49, v50, v51
v_pk_mul_f16 v199, v200, v199
v_mfma_f32_16x16x32_f16 v[144:147], v[236:239], v[212:215], v[144:147]
v_lshrrev_b32_e64 v185, 18, v185
v_cvt_pk_bf16_f32 v50, v52, v53
v_pk_mul_f16 v196, v197, v196
v_mfma_f32_16x16x32_bf16 v[172:175], v[216:219], v[24:27], 0
ds_read_b128 v[236:239], v248 offset:42240
ds_read_u16_d16 v186, v186
ds_read_u16_d16_hi v185, v185
v_lshrrev_b32_e64 v187, 18, v187
v_cvt_pk_bf16_f32 v51, v54, v55
v_exp_f16_e64 v201, v202
v_mfma_f32_16x16x32_bf16 v[180:183], v[216:219], v[28:31], 0
v_cvt_pk_bf16_f32 v80, v80, v81
v_and_b32_e64 v189, s49, v189
v_cvt_pk_bf16_f32 v81, v82, v83
v_mfma_f32_16x16x32_f16 v[140:143], v[220:223], v[208:211], v[140:143]
ds_read_b128 v[216:219], v248 offset:43008
ds_read_u16_d16_hi v187, v187
v_and_b32_e64 v191, s49, v191
v_cvt_pk_bf16_f32 v82, v84, v85
v_mfma_f32_16x16x32_f16 v[148:151], v[220:223], v[212:215], v[148:151]
v_exp_f16_e64 v198, v199
v_cvt_pk_bf16_f32 v83, v86, v87
s_mov_b64 vcc, s[74:75]
v_bfe_u32 v188, v189, 2, 14
v_bfe_u32 v190, v191, 2, 14
s_waitcnt lgkmcnt(5)
v_mfma_f32_16x16x32_bf16 v[168:171], v[224:227], v[32:35], v[168:171]
ds_read_b128 v[220:223], v248 offset:43264
ds_read_u16_d16 v188, v188
ds_read_u16_d16 v190, v190
v_cndmask_b32 v68, v48, v80, vcc
v_exp_f16 v195, v196
v_mfma_f32_16x16x32_bf16 v[176:179], v[224:227], v[36:39], v[176:179]
v_cndmask_b32 v69, v49, v81, vcc
v_lshrrev_b32_e64 v189, 18, v189
v_cndmask_b32 v70, v50, v82, vcc
v_mfma_f32_16x16x32_f16 v[152:155], v[228:231], v[208:211], v[152:155]
ds_read_b128 v[224:227], v249 offset:43008
ds_read_u16_d16_hi v189, v189
v_lshrrev_b32 v191, 18, v191
v_cndmask_b32 v71, v51, v83, vcc
v_exp_f16_sdwa v201, v202 dst_sel:WORD_1 dst_unused:UNUSED_PRESERVE src0_sel:WORD_1
v_mfma_f32_16x16x32_f16 v[160:163], v[228:231], v[212:215], v[160:163]
v_cndmask_b32_dpp v48, v64, v48, vcc quad_perm:[1,0,3,2] row_mask:0xf bank_mask:0xf
v_and_b32_e64 v193, s49, v193
v_cndmask_b32_dpp v49, v65, v49, vcc quad_perm:[1,0,3,2] row_mask:0xf bank_mask:0xf
v_mfma_f32_16x16x32_f16 v[156:159], v[232:235], v[208:211], v[156:159]
ds_read_b128 v[228:231], v249 offset:43264
ds_read_u16_d16_hi v191, v191
v_bfe_u32 v192, v193, 2, 14
v_exp_f16_sdwa v198, v199 dst_sel:WORD_1 dst_unused:UNUSED_PRESERVE src0_sel:WORD_1
v_mfma_f32_16x16x32_f16 v[164:167], v[232:235], v[212:215], v[164:167]
v_cndmask_b32_dpp v50, v66, v50, vcc quad_perm:[1,0,3,2] row_mask:0xf bank_mask:0xf
v_lshrrev_b32 v193, 18, v193
v_cndmask_b32_dpp v51, v67, v51, vcc quad_perm:[1,0,3,2] row_mask:0xf bank_mask:0xf
s_not_b64 vcc, s[74:75]
s_waitcnt lgkmcnt(4)
v_mfma_f32_16x16x32_bf16 v[172:175], v[236:239], v[32:35], v[172:175]
ds_read_b128 v[232:235], v248 offset:47104
ds_read_u16_d16 v192, v192
ds_read_u16_d16_hi v193, v193
v_exp_f16_sdwa v195, v196 dst_sel:WORD_1 dst_unused:UNUSED_PRESERVE src0_sel:WORD_1
v_cndmask_b32_dpp v80, v64, v80, vcc quad_perm:[1,0,3,2] row_mask:0xf bank_mask:0xf
s_setprio 0
v_pk_add_f16 v201, v201, 1.0 op_sel_hi:[1,0]
v_mfma_f32_16x16x32_bf16 v[180:183], v[236:239], v[36:39], v[180:183]
v_cndmask_b32_dpp v81, v65, v81, vcc quad_perm:[1,0,3,2] row_mask:0xf bank_mask:0xf
v_pk_add_f16 v198, v198, 1.0 op_sel_hi:[1,0]
v_cndmask_b32_dpp v82, v66, v82, vcc quad_perm:[1,0,3,2] row_mask:0xf bank_mask:0xf
v_mfma_f32_16x16x32_bf16 v[168:171], v[216:219], v[40:43], v[168:171]
ds_read_b128 v[236:239], v249 offset:44032
v_pk_add_f16 v195, v195, 1.0 op_sel_hi:[1,0]
v_rcp_f16_e64 v202, v201
v_cndmask_b32_dpp v83, v67, v83, vcc quad_perm:[1,0,3,2] row_mask:0xf bank_mask:0xf
v_mfma_f32_16x16x32_bf16 v[176:179], v[216:219], v[44:47], v[176:179]
v_rcp_f16_e64 v199, v198
v_mfma_f32_16x16x32_bf16 v[172:175], v[220:223], v[40:43], v[172:175]
ds_read_b128 v[216:219], v248 offset:47360
buffer_store_dwordx4 v[48:51], v255, s[8:11], s70 offen sc1
v_rcp_f16_e64 v196, v195
v_rcp_f16_sdwa v202, v201 dst_sel:WORD_1 dst_unused:UNUSED_PRESERVE src0_sel:WORD_1
v_mfma_f32_16x16x32_bf16 v[180:183], v[220:223], v[44:47], v[180:183]
v_rcp_f16_sdwa v199, v198 dst_sel:WORD_1 dst_unused:UNUSED_PRESERVE src0_sel:WORD_1
v_or_b32 v208, v184, v185
v_or_b32 v209, v186, v187
s_waitcnt lgkmcnt(2)
v_or_b32 v210, v188, v189
v_rcp_f16_sdwa v196, v195 dst_sel:WORD_1 dst_unused:UNUSED_PRESERVE src0_sel:WORD_1
v_or_b32_e64 v211, v190, v191
v_or_b32 v212, v192, v193
v_pk_mul_f16 v213, v203, v202
v_pk_mul_f16 v214, v200, v199
v_pk_mul_f16 v215, v197, v196
s_setprio 3
v_mfma_f32_16x16x32_f16 v[120:123], v[224:227], v[208:211], v[120:123]
buffer_store_dwordx4 v[68:71], v255, s[8:11], s70 offen offset:128 sc1
ds_read_b128 v[220:223], v249 offset:44288
v_cvt_pkrtz_f16_f32 v185, v168, v169
v_cvt_pkrtz_f16_f32 v187, v170, v171
v_mfma_f32_16x16x32_f16 v[128:131], v[224:227], v[212:215], v[128:131]
v_cvt_pkrtz_f16_f32 v189, v172, v173
v_cvt_pkrtz_f16_f32 v191, v174, v175
v_mfma_f32_16x16x32_f16 v[124:127], v[228:231], v[208:211], v[124:127]
ds_read_b128 v[224:227], v248 offset:48128
v_cvt_pkrtz_f16_f32 v193, v176, v177
v_cvt_pk_f16_f32 v203, v178, v179
v_cvt_pk_f16_f32 v200, v180, v181
v_mfma_f32_16x16x32_f16 v[132:135], v[228:231], v[212:215], v[132:135]
v_cvt_pk_f16_f32 v197, v182, v183
v_pk_fma_f16 v202, v203, v203, s48
v_mfma_f32_16x16x32_bf16 v[168:171], v[232:235], v[24:27], 0
ds_read_b128 v[228:231], v249 offset:45056
v_and_b32_e64 v185, s49, v185
v_pk_fma_f16 v199, v200, v200, s48
v_mfma_f32_16x16x32_bf16 v[176:179], v[232:235], v[28:31], 0
v_and_b32 v187, s49, v187
v_pk_fma_f16 v196, v197, v197, s48
v_bfe_u32 v184, v185, 2, 14
s_waitcnt lgkmcnt(3)
v_mfma_f32_16x16x32_f16 v[136:139], v[236:239], v[208:211], v[136:139]
ds_read_b128 v[232:235], v249 offset:45312
ds_read_u16_d16 v184, v184
v_pk_mul_f16 v202, v203, v202
v_bfe_u32 v186, v187, 2, 14
v_mfma_f32_16x16x32_f16 v[144:147], v[236:239], v[212:215], v[144:147]
v_pk_mul_f16 v199, v200, v199
v_lshrrev_b32_e64 v185, 18, v185
v_mfma_f32_16x16x32_bf16 v[172:175], v[216:219], v[24:27], 0
ds_read_b128 v[236:239], v248 offset:48384
ds_read_u16_d16 v186, v186
ds_read_u16_d16_hi v185, v185
v_pk_mul_f16 v196, v197, v196
v_lshrrev_b32_e64 v187, 18, v187
v_mfma_f32_16x16x32_bf16 v[180:183], v[216:219], v[28:31], 0
v_exp_f16_e64 v201, v202
v_and_b32 v189, s49, v189
s_waitcnt lgkmcnt(5)
v_mfma_f32_16x16x32_f16 v[140:143], v[220:223], v[208:211], v[140:143]
ds_read_b128 v[216:219], v248 offset:49152
ds_read_u16_d16_hi v187, v187
v_and_b32_e64 v191, s49, v191
v_mfma_f32_16x16x32_f16 v[148:151], v[220:223], v[212:215], v[148:151]
v_exp_f16_e64 v198, v199
v_bfe_u32 v188, v189, 2, 14
v_bfe_u32 v190, v191, 2, 14
v_mfma_f32_16x16x32_bf16 v[168:171], v[224:227], v[32:35], v[168:171]
s_add_u32 s46, s80, 20971520
buffer_load_dwordx4 v[116:119], v253, s[32:35], s46 offen offset:256 nt
ds_read_b128 v[220:223], v248 offset:49408
ds_read_u16_d16 v188, v188
ds_read_u16_d16 v190, v190
v_exp_f16_e64 v195, v196
v_mfma_f32_16x16x32_bf16 v[176:179], v[224:227], v[36:39], v[176:179]
v_lshrrev_b32 v189, 18, v189
v_lshrrev_b32 v191, 18, v191
v_mfma_f32_16x16x32_f16 v[152:155], v[228:231], v[208:211], v[152:155]
ds_read_b128 v[224:227], v249 offset:49152
ds_read_u16_d16_hi v189, v189
ds_read_u16_d16_hi v191, v191
v_exp_f16_sdwa v201, v202 dst_sel:WORD_1 dst_unused:UNUSED_PRESERVE src0_sel:WORD_1
v_and_b32 v193, s49, v193
v_mfma_f32_16x16x32_f16 v[160:163], v[228:231], v[212:215], v[160:163]
v_bfe_u32 v192, v193, 2, 14
s_waitcnt lgkmcnt(7)
v_mfma_f32_16x16x32_f16 v[156:159], v[232:235], v[208:211], v[156:159]
ds_read_b128 v[228:231], v249 offset:49408
ds_read_u16_d16 v192, v192
v_exp_f16_sdwa v198, v199 dst_sel:WORD_1 dst_unused:UNUSED_PRESERVE src0_sel:WORD_1
v_lshrrev_b32_e64 v193, 18, v193
v_mfma_f32_16x16x32_f16 v[164:167], v[232:235], v[212:215], v[164:167]
v_exp_f16_sdwa v195, v196 dst_sel:WORD_1 dst_unused:UNUSED_PRESERVE src0_sel:WORD_1
v_pk_add_f16 v201, v201, 1.0 op_sel_hi:[1,0]
v_mfma_f32_16x16x32_bf16 v[172:175], v[236:239], v[32:35], v[172:175]
ds_read_b128 v[232:235], v248 offset:53248
ds_read_u16_d16_hi v193, v193
v_pk_add_f16 v198, v198, 1.0 op_sel_hi:[1,0]
v_pk_add_f16 v195, v195, 1.0 op_sel_hi:[1,0]
v_mfma_f32_16x16x32_bf16 v[180:183], v[236:239], v[36:39], v[180:183]
v_rcp_f16_e64 v202, v201
v_mfma_f32_16x16x32_bf16 v[168:171], v[216:219], v[40:43], v[168:171]
ds_read_b128 v[236:239], v249 offset:50176
v_rcp_f16_e64 v199, v198
v_mfma_f32_16x16x32_bf16 v[176:179], v[216:219], v[44:47], v[176:179]
v_rcp_f16 v196, v195
s_waitcnt lgkmcnt(5)
v_mfma_f32_16x16x32_bf16 v[172:175], v[220:223], v[40:43], v[172:175]
ds_read_b128 v[216:219], v248 offset:53504
v_rcp_f16_sdwa v202, v201 dst_sel:WORD_1 dst_unused:UNUSED_PRESERVE src0_sel:WORD_1
v_mfma_f32_16x16x32_bf16 v[180:183], v[220:223], v[44:47], v[180:183]
v_rcp_f16_sdwa v199, v198 dst_sel:WORD_1 dst_unused:UNUSED_PRESERVE src0_sel:WORD_1
v_or_b32 v208, v184, v185
v_or_b32 v209, v186, v187
v_or_b32_e64 v210, v188, v189
v_rcp_f16_sdwa v196, v195 dst_sel:WORD_1 dst_unused:UNUSED_PRESERVE src0_sel:WORD_1
v_or_b32 v211, v190, v191
s_waitcnt lgkmcnt(2)
v_or_b32_e64 v212, v192, v193
v_pk_mul_f16 v213, v203, v202
v_pk_mul_f16 v214, v200, v199
v_pk_mul_f16 v215, v197, v196
v_mfma_f32_16x16x32_f16 v[120:123], v[224:227], v[208:211], v[120:123]
ds_read_b128 v[220:223], v249 offset:50432
v_cvt_pkrtz_f16_f32 v185, v168, v169
v_cvt_pkrtz_f16_f32 v187, v170, v171
v_mfma_f32_16x16x32_f16 v[128:131], v[224:227], v[212:215], v[128:131]
v_cvt_pkrtz_f16_f32 v189, v172, v173
v_cvt_pkrtz_f16_f32 v191, v174, v175
v_mfma_f32_16x16x32_f16 v[124:127], v[228:231], v[208:211], v[124:127]
ds_read_b128 v[224:227], v248 offset:54272
v_cvt_pkrtz_f16_f32 v193, v176, v177
v_cvt_pk_f16_f32 v203, v178, v179
v_cvt_pk_f16_f32 v200, v180, v181
v_mfma_f32_16x16x32_f16 v[132:135], v[228:231], v[212:215], v[132:135]
v_cvt_pk_f16_f32 v197, v182, v183
v_pk_fma_f16 v202, v203, v203, s48
v_mfma_f32_16x16x32_bf16 v[168:171], v[232:235], v[24:27], 0
ds_read_b128 v[228:231], v249 offset:51200
v_and_b32_e64 v185, s49, v185
v_pk_fma_f16 v199, v200, v200, s48
v_mfma_f32_16x16x32_bf16 v[176:179], v[232:235], v[28:31], 0
v_and_b32_e64 v187, s49, v187
v_pk_fma_f16 v196, v197, v197, s48
s_setprio 2
v_bfe_u32 v184, v185, 2, 14
s_waitcnt lgkmcnt(3)
v_mfma_f32_16x16x32_f16 v[136:139], v[236:239], v[208:211], v[136:139]
ds_read_b128 v[232:235], v249 offset:51456
ds_read_u16_d16 v184, v184
v_pk_mul_f16 v202, v203, v202
v_bfe_u32 v186, v187, 2, 14
v_mfma_f32_16x16x32_f16 v[144:147], v[236:239], v[212:215], v[144:147]
v_pk_mul_f16 v199, v200, v199
v_lshrrev_b32_e64 v185, 18, v185
v_mfma_f32_16x16x32_bf16 v[172:175], v[216:219], v[24:27], 0
ds_read_b128 v[236:239], v248 offset:54528
ds_read_u16_d16 v186, v186
ds_read_u16_d16_hi v185, v185
v_pk_mul_f16 v196, v197, v196
v_lshrrev_b32_e64 v187, 18, v187
v_mfma_f32_16x16x32_bf16 v[180:183], v[216:219], v[28:31], 0
v_exp_f16_e64 v201, v202
v_and_b32 v189, s49, v189
s_waitcnt lgkmcnt(5)
v_mfma_f32_16x16x32_f16 v[140:143], v[220:223], v[208:211], v[140:143]
ds_read_b128 v[216:219], v248 offset:55296
ds_read_u16_d16_hi v187, v187
v_and_b32_e64 v191, s49, v191
v_mfma_f32_16x16x32_f16 v[148:151], v[220:223], v[212:215], v[148:151]
v_exp_f16_e64 v198, v199
v_bfe_u32 v188, v189, 2, 14
v_bfe_u32 v190, v191, 2, 14
v_mfma_f32_16x16x32_bf16 v[168:171], v[224:227], v[32:35], v[168:171]
ds_read_b128 v[220:223], v248 offset:55552
ds_read_u16_d16 v188, v188
ds_read_u16_d16 v190, v190
v_exp_f16_e64 v195, v196
v_mfma_f32_16x16x32_bf16 v[176:179], v[224:227], v[36:39], v[176:179]
v_lshrrev_b32 v189, 18, v189
v_lshrrev_b32 v191, 18, v191
v_mfma_f32_16x16x32_f16 v[152:155], v[228:231], v[208:211], v[152:155]
ds_read_b128 v[224:227], v249 offset:55296
ds_read_u16_d16_hi v189, v189
ds_read_u16_d16_hi v191, v191
v_exp_f16_sdwa v201, v202 dst_sel:WORD_1 dst_unused:UNUSED_PRESERVE src0_sel:WORD_1
v_and_b32 v193, s49, v193
v_mfma_f32_16x16x32_f16 v[160:163], v[228:231], v[212:215], v[160:163]
v_bfe_u32 v192, v193, 2, 14
s_waitcnt lgkmcnt(8)
v_mfma_f32_16x16x32_f16 v[156:159], v[232:235], v[208:211], v[156:159]
ds_read_b128 v[228:231], v249 offset:55552
ds_read_u16_d16 v192, v192
v_exp_f16_sdwa v198, v199 dst_sel:WORD_1 dst_unused:UNUSED_PRESERVE src0_sel:WORD_1
v_lshrrev_b32_e64 v193, 18, v193
v_mfma_f32_16x16x32_f16 v[164:167], v[232:235], v[212:215], v[164:167]
v_exp_f16_sdwa v195, v196 dst_sel:WORD_1 dst_unused:UNUSED_PRESERVE src0_sel:WORD_1
v_pk_add_f16 v201, v201, 1.0 op_sel_hi:[1,0]
v_mfma_f32_16x16x32_bf16 v[172:175], v[236:239], v[32:35], v[172:175]
ds_read_b128 v[232:235], v248 offset:59392
ds_read_u16_d16_hi v193, v193
v_pk_add_f16 v198, v198, 1.0 op_sel_hi:[1,0]
v_pk_add_f16 v195, v195, 1.0 op_sel_hi:[1,0]
v_mfma_f32_16x16x32_bf16 v[180:183], v[236:239], v[36:39], v[180:183]
v_rcp_f16 v202, v201
s_waitcnt lgkmcnt(7)
v_mfma_f32_16x16x32_bf16 v[168:171], v[216:219], v[40:43], v[168:171]
ds_read_b128 v[236:239], v249 offset:56320
v_rcp_f16_e64 v199, v198
v_mfma_f32_16x16x32_bf16 v[176:179], v[216:219], v[44:47], v[176:179]
v_rcp_f16_e64 v196, v195
v_mfma_f32_16x16x32_bf16 v[172:175], v[220:223], v[40:43], v[172:175]
ds_read_b128 v[216:219], v248 offset:59648
v_rcp_f16_sdwa v202, v201 dst_sel:WORD_1 dst_unused:UNUSED_PRESERVE src0_sel:WORD_1
v_mfma_f32_16x16x32_bf16 v[180:183], v[220:223], v[44:47], v[180:183]
v_rcp_f16_sdwa v199, v198 dst_sel:WORD_1 dst_unused:UNUSED_PRESERVE src0_sel:WORD_1
v_or_b32 v208, v184, v185
v_or_b32 v209, v186, v187
s_waitcnt lgkmcnt(4)
v_or_b32 v210, v188, v189
v_rcp_f16_sdwa v196, v195 dst_sel:WORD_1 dst_unused:UNUSED_PRESERVE src0_sel:WORD_1
v_or_b32 v211, v190, v191
s_waitcnt lgkmcnt(2)
v_or_b32_e64 v212, v192, v193
v_pk_mul_f16 v213, v203, v202
v_pk_mul_f16 v214, v200, v199
v_pk_mul_f16 v215, v197, v196
v_mfma_f32_16x16x32_f16 v[120:123], v[224:227], v[208:211], v[120:123]
buffer_load_dwordx4 v[204:207], v252, s[4:7], s68 offen
ds_read_b128 v[220:223], v249 offset:56576
v_cvt_pkrtz_f16_f32 v185, v168, v169
v_cvt_pkrtz_f16_f32 v187, v170, v171
v_mfma_f32_16x16x32_f16 v[128:131], v[224:227], v[212:215], v[128:131]
v_cvt_pkrtz_f16_f32 v189, v172, v173
v_cvt_pkrtz_f16_f32 v191, v174, v175
v_mfma_f32_16x16x32_f16 v[124:127], v[228:231], v[208:211], v[124:127]
ds_read_b128 v[224:227], v248 offset:60416
v_cvt_pkrtz_f16_f32 v193, v176, v177
v_cvt_pk_f16_f32 v203, v178, v179
v_cvt_pk_f16_f32 v200, v180, v181
v_mfma_f32_16x16x32_f16 v[132:135], v[228:231], v[212:215], v[132:135]
v_cvt_pk_f16_f32 v197, v182, v183
s_setprio 1
v_pk_fma_f16 v202, v203, v203, s48
v_mfma_f32_16x16x32_bf16 v[168:171], v[232:235], v[24:27], 0
ds_read_b128 v[228:231], v249 offset:57344
v_and_b32 v185, s49, v185
v_pk_fma_f16 v199, v200, v200, s48
v_mfma_f32_16x16x32_bf16 v[176:179], v[232:235], v[28:31], 0
v_and_b32 v187, s49, v187
v_pk_fma_f16 v196, v197, v197, s48
v_bfe_u32 v184, v185, 2, 14
s_waitcnt lgkmcnt(3)
v_mfma_f32_16x16x32_f16 v[136:139], v[236:239], v[208:211], v[136:139]
ds_read_b128 v[232:235], v249 offset:57600
ds_read_u16_d16 v184, v184
v_pk_mul_f16 v202, v203, v202
v_bfe_u32 v186, v187, 2, 14
v_mfma_f32_16x16x32_f16 v[144:147], v[236:239], v[212:215], v[144:147]
v_pk_mul_f16 v199, v200, v199
v_lshrrev_b32_e64 v185, 18, v185
v_mfma_f32_16x16x32_bf16 v[172:175], v[216:219], v[24:27], 0
ds_read_b128 v[236:239], v248 offset:60672
ds_read_u16_d16 v186, v186
ds_read_u16_d16_hi v185, v185
v_pk_mul_f16 v196, v197, v196
v_lshrrev_b32_e64 v187, 18, v187
v_mfma_f32_16x16x32_bf16 v[180:183], v[216:219], v[28:31], 0
v_exp_f16_e64 v201, v202
v_and_b32 v189, s49, v189
s_waitcnt lgkmcnt(5)
v_mfma_f32_16x16x32_f16 v[140:143], v[220:223], v[208:211], v[140:143]
ds_read_b128 v[216:219], v248 offset:61440
ds_read_u16_d16_hi v187, v187
v_and_b32_e64 v191, s49, v191
v_mfma_f32_16x16x32_f16 v[148:151], v[220:223], v[212:215], v[148:151]
v_exp_f16_e64 v198, v199
v_bfe_u32 v188, v189, 2, 14
v_bfe_u32 v190, v191, 2, 14
v_mfma_f32_16x16x32_bf16 v[168:171], v[224:227], v[32:35], v[168:171]
buffer_store_dwordx4 v[80:83], v255, s[8:11], s70 offen offset:256 sc1
ds_read_b128 v[220:223], v248 offset:61696
ds_read_u16_d16 v188, v188
ds_read_u16_d16 v190, v190
v_exp_f16_e64 v195, v196
v_mfma_f32_16x16x32_bf16 v[176:179], v[224:227], v[36:39], v[176:179]
v_lshrrev_b32 v189, 18, v189
v_lshrrev_b32 v191, 18, v191
v_mfma_f32_16x16x32_f16 v[152:155], v[228:231], v[208:211], v[152:155]
ds_read_b128 v[224:227], v249 offset:61440
ds_read_u16_d16_hi v189, v189
ds_read_u16_d16_hi v191, v191
v_exp_f16_sdwa v201, v202 dst_sel:WORD_1 dst_unused:UNUSED_PRESERVE src0_sel:WORD_1
v_and_b32 v193, s49, v193
v_mfma_f32_16x16x32_f16 v[160:163], v[228:231], v[212:215], v[160:163]
v_bfe_u32 v192, v193, 2, 14
s_waitcnt lgkmcnt(8)
v_mfma_f32_16x16x32_f16 v[156:159], v[232:235], v[208:211], v[156:159]
ds_read_b128 v[228:231], v249 offset:61696
ds_read_u16_d16 v192, v192
v_exp_f16_sdwa v198, v199 dst_sel:WORD_1 dst_unused:UNUSED_PRESERVE src0_sel:WORD_1
v_lshrrev_b32_e64 v193, 18, v193
v_mfma_f32_16x16x32_f16 v[164:167], v[232:235], v[212:215], v[164:167]
v_exp_f16_sdwa v195, v196 dst_sel:WORD_1 dst_unused:UNUSED_PRESERVE src0_sel:WORD_1
v_pk_add_f16 v201, v201, 1.0 op_sel_hi:[1,0]
v_mfma_f32_16x16x32_bf16 v[172:175], v[236:239], v[32:35], v[172:175]
ds_read_b128 v[232:235], v249
ds_read_u16_d16_hi v193, v193
v_pk_add_f16 v198, v198, 1.0 op_sel_hi:[1,0]
v_pk_add_f16 v195, v195, 1.0 op_sel_hi:[1,0]
v_mfma_f32_16x16x32_bf16 v[180:183], v[236:239], v[36:39], v[180:183]
v_rcp_f16_e64 v202, v201
s_setprio 0
s_waitcnt lgkmcnt(7)
v_mfma_f32_16x16x32_bf16 v[168:171], v[216:219], v[40:43], v[168:171]
ds_read_b128 v[236:239], v249 offset:62464
v_rcp_f16_e64 v199, v198
v_mfma_f32_16x16x32_bf16 v[176:179], v[216:219], v[44:47], v[176:179]
v_rcp_f16_e64 v196, v195
v_mfma_f32_16x16x32_bf16 v[172:175], v[220:223], v[40:43], v[172:175]
ds_read_b128 v[216:219], v249 offset:256
v_rcp_f16_sdwa v202, v201 dst_sel:WORD_1 dst_unused:UNUSED_PRESERVE src0_sel:WORD_1
v_mfma_f32_16x16x32_bf16 v[180:183], v[220:223], v[44:47], v[180:183]
v_rcp_f16_sdwa v199, v198 dst_sel:WORD_1 dst_unused:UNUSED_PRESERVE src0_sel:WORD_1
v_or_b32 v208, v184, v185
v_or_b32 v209, v186, v187
s_waitcnt lgkmcnt(4)
v_or_b32 v210, v188, v189
v_rcp_f16_sdwa v196, v195 dst_sel:WORD_1 dst_unused:UNUSED_PRESERVE src0_sel:WORD_1
v_or_b32 v211, v190, v191
s_waitcnt lgkmcnt(2)
v_or_b32 v212, v192, v193
v_pk_mul_f16 v213, v203, v202
v_pk_mul_f16 v214, v200, v199
v_pk_mul_f16 v215, v197, v196
s_setprio 3
v_mfma_f32_16x16x32_f16 v[120:123], v[224:227], v[208:211], v[120:123]
buffer_load_dwordx4 v[244:247], v252, s[4:7], s68 offen offset:64
ds_read_b128 v[220:223], v249 offset:62720
v_cvt_pkrtz_f16_f32 v185, v168, v169
v_cvt_pkrtz_f16_f32 v187, v170, v171
v_mfma_f32_16x16x32_f16 v[128:131], v[224:227], v[212:215], v[128:131]
v_cvt_pkrtz_f16_f32 v189, v172, v173
v_cvt_pkrtz_f16_f32 v191, v174, v175
v_mfma_f32_16x16x32_f16 v[124:127], v[228:231], v[208:211], v[124:127]
ds_read_b128 v[224:227], v249 offset:1024
v_cvt_pkrtz_f16_f32 v193, v176, v177
v_cvt_pk_f16_f32 v203, v178, v179
v_cvt_pk_f16_f32 v200, v180, v181
v_mfma_f32_16x16x32_f16 v[132:135], v[228:231], v[212:215], v[132:135]
v_cvt_pk_f16_f32 v197, v182, v183
v_pk_fma_f16 v202, v203, v203, s48
v_mfma_f32_16x16x32_bf16 v[168:171], v[232:235], v[24:27], 0
ds_read_b128 v[228:231], v249 offset:63488
v_and_b32_e64 v185, s49, v185
v_pk_fma_f16 v199, v200, v200, s48
v_mfma_f32_16x16x32_bf16 v[176:179], v[232:235], v[28:31], 0
v_and_b32 v187, s49, v187
v_pk_fma_f16 v196, v197, v197, s48
v_bfe_u32 v184, v185, 2, 14
s_waitcnt lgkmcnt(3)
v_mfma_f32_16x16x32_f16 v[136:139], v[236:239], v[208:211], v[136:139]
ds_read_b128 v[232:235], v249 offset:63744
ds_read_u16_d16 v184, v184
v_pk_mul_f16 v202, v203, v202
v_bfe_u32 v186, v187, 2, 14
v_mfma_f32_16x16x32_f16 v[144:147], v[236:239], v[212:215], v[144:147]
v_pk_mul_f16 v199, v200, v199
v_lshrrev_b32_e64 v185, 18, v185
v_mfma_f32_16x16x32_bf16 v[172:175], v[216:219], v[24:27], 0
ds_read_b128 v[236:239], v249 offset:1280
ds_read_u16_d16 v186, v186
ds_read_u16_d16_hi v185, v185
v_pk_mul_f16 v196, v197, v196
v_lshrrev_b32_e64 v187, 18, v187
v_mfma_f32_16x16x32_bf16 v[180:183], v[216:219], v[28:31], 0
v_exp_f16_e64 v201, v202
v_and_b32 v189, s49, v189
s_waitcnt lgkmcnt(5)
v_mfma_f32_16x16x32_f16 v[140:143], v[220:223], v[208:211], v[140:143]
ds_read_b128 v[216:219], v249 offset:2048
ds_read_u16_d16_hi v187, v187
v_and_b32_e64 v191, s49, v191
v_mfma_f32_16x16x32_f16 v[148:151], v[220:223], v[212:215], v[148:151]
v_exp_f16_e64 v198, v199
v_bfe_u32 v188, v189, 2, 14
v_bfe_u32 v190, v191, 2, 14
v_mfma_f32_16x16x32_bf16 v[168:171], v[224:227], v[32:35], v[168:171]
ds_read_b128 v[220:223], v249 offset:2304
ds_read_u16_d16 v188, v188
ds_read_u16_d16 v190, v190
v_exp_f16_e64 v195, v196
v_mfma_f32_16x16x32_bf16 v[176:179], v[224:227], v[36:39], v[176:179]
v_lshrrev_b32 v189, 18, v189
v_lshrrev_b32 v191, 18, v191
v_mfma_f32_16x16x32_f16 v[152:155], v[228:231], v[208:211], v[152:155]
ds_read_b128 v[224:227], v250 offset:2048
ds_read_u16_d16_hi v189, v189
ds_read_u16_d16_hi v191, v191
v_exp_f16_sdwa v201, v202 dst_sel:WORD_1 dst_unused:UNUSED_PRESERVE src0_sel:WORD_1
v_and_b32 v193, s49, v193
v_mfma_f32_16x16x32_f16 v[160:163], v[228:231], v[212:215], v[160:163]
v_bfe_u32 v192, v193, 2, 14
s_waitcnt lgkmcnt(8)
v_mfma_f32_16x16x32_f16 v[156:159], v[232:235], v[208:211], v[156:159]
ds_read_b128 v[228:231], v250 offset:2304
ds_read_u16_d16 v192, v192
v_exp_f16_sdwa v198, v199 dst_sel:WORD_1 dst_unused:UNUSED_PRESERVE src0_sel:WORD_1
v_lshrrev_b32_e64 v193, 18, v193
v_mfma_f32_16x16x32_f16 v[164:167], v[232:235], v[212:215], v[164:167]
v_exp_f16_sdwa v195, v196 dst_sel:WORD_1 dst_unused:UNUSED_PRESERVE src0_sel:WORD_1
v_pk_add_f16 v201, v201, 1.0 op_sel_hi:[1,0]
v_mfma_f32_16x16x32_bf16 v[172:175], v[236:239], v[32:35], v[172:175]
ds_read_b128 v[232:235], v249 offset:6144
ds_read_u16_d16_hi v193, v193
v_pk_add_f16 v198, v198, 1.0 op_sel_hi:[1,0]
v_pk_add_f16 v195, v195, 1.0 op_sel_hi:[1,0]
v_mfma_f32_16x16x32_bf16 v[180:183], v[236:239], v[36:39], v[180:183]
v_rcp_f16 v202, v201
s_waitcnt lgkmcnt(7)
v_mfma_f32_16x16x32_bf16 v[168:171], v[216:219], v[40:43], v[168:171]
ds_read_b128 v[236:239], v250 offset:3072
v_rcp_f16_e64 v199, v198
v_mfma_f32_16x16x32_bf16 v[176:179], v[216:219], v[44:47], v[176:179]
v_rcp_f16_e64 v196, v195
v_mfma_f32_16x16x32_bf16 v[172:175], v[220:223], v[40:43], v[172:175]
ds_read_b128 v[216:219], v249 offset:6400
v_rcp_f16_sdwa v202, v201 dst_sel:WORD_1 dst_unused:UNUSED_PRESERVE src0_sel:WORD_1
v_mfma_f32_16x16x32_bf16 v[180:183], v[220:223], v[44:47], v[180:183]
v_rcp_f16_sdwa v199, v198 dst_sel:WORD_1 dst_unused:UNUSED_PRESERVE src0_sel:WORD_1
v_or_b32 v208, v184, v185
v_or_b32 v209, v186, v187
s_waitcnt lgkmcnt(4)
v_or_b32 v210, v188, v189
v_rcp_f16_sdwa v196, v195 dst_sel:WORD_1 dst_unused:UNUSED_PRESERVE src0_sel:WORD_1
v_or_b32 v211, v190, v191
s_waitcnt lgkmcnt(2)
v_or_b32_e64 v212, v192, v193
v_pk_mul_f16 v213, v203, v202
v_pk_mul_f16 v214, v200, v199
v_pk_mul_f16 v215, v197, v196
v_mfma_f32_16x16x32_f16 v[120:123], v[224:227], v[208:211], v[120:123]
ds_read_b128 v[220:223], v250 offset:3328
v_cvt_pkrtz_f16_f32 v185, v168, v169
v_cvt_pkrtz_f16_f32 v187, v170, v171
v_cvt_pkrtz_f16_f32 v189, v172, v173
v_mfma_f32_16x16x32_f16 v[128:131], v[224:227], v[212:215], v[128:131]
v_cvt_pkrtz_f16_f32 v191, v174, v175
v_cvt_pkrtz_f16_f32 v193, v176, v177
v_cvt_pk_f16_f32 v203, v178, v179
v_mfma_f32_16x16x32_f16 v[124:127], v[228:231], v[208:211], v[124:127]
ds_read_b128 v[224:227], v249 offset:7168
v_cvt_pk_f16_f32 v200, v180, v181
v_cvt_pk_f16_f32 v197, v182, v183
v_pk_fma_f16 v202, v203, v203, s48
v_cvt_pk_bf16_f32 v72, v72, v73
v_mfma_f32_16x16x32_f16 v[132:135], v[228:231], v[212:215], v[132:135]
v_and_b32_e64 v185, s49, v185
v_cvt_pk_bf16_f32 v73, v74, v75
v_pk_fma_f16 v199, v200, v200, s48
v_mfma_f32_16x16x32_bf16 v[168:171], v[232:235], v[24:27], 0
ds_read_b128 v[228:231], v250 offset:4096
v_and_b32_e64 v187, s49, v187
v_cvt_pk_bf16_f32 v74, v76, v77
v_pk_fma_f16 v196, v197, v197, s48
v_mfma_f32_16x16x32_bf16 v[176:179], v[232:235], v[28:31], 0
v_cvt_pk_bf16_f32 v75, v78, v79
v_bfe_u32 v184, v185, 2, 14
s_setprio 2
v_pk_mul_f16 v202, v203, v202
v_cvt_pk_bf16_f32 v56, v56, v57
s_waitcnt lgkmcnt(2)
v_mfma_f32_16x16x32_f16 v[136:139], v[236:239], v[208:211], v[136:139]
ds_read_b128 v[232:235], v250 offset:4352
ds_read_u16_d16 v184, v184
v_bfe_u32 v186, v187, 2, 14
v_cvt_pk_bf16_f32 v57, v58, v59
v_pk_mul_f16 v199, v200, v199
v_mfma_f32_16x16x32_f16 v[144:147], v[236:239], v[212:215], v[144:147]
v_lshrrev_b32_e64 v185, 18, v185
v_cvt_pk_bf16_f32 v58, v60, v61
v_pk_mul_f16 v196, v197, v196
v_mfma_f32_16x16x32_bf16 v[172:175], v[216:219], v[24:27], 0
ds_read_b128 v[236:239], v249 offset:7424
ds_read_u16_d16 v186, v186
ds_read_u16_d16_hi v185, v185
v_lshrrev_b32_e64 v187, 18, v187
v_cvt_pk_bf16_f32 v59, v62, v63
v_exp_f16_e64 v201, v202
v_mfma_f32_16x16x32_bf16 v[180:183], v[216:219], v[28:31], 0
v_cvt_pk_bf16_f32 v88, v88, v89
v_and_b32_e64 v189, s49, v189
v_cvt_pk_bf16_f32 v89, v90, v91
v_mfma_f32_16x16x32_f16 v[140:143], v[220:223], v[208:211], v[140:143]
ds_read_b128 v[216:219], v249 offset:8192
ds_read_u16_d16_hi v187, v187
v_and_b32_e64 v191, s49, v191
v_cvt_pk_bf16_f32 v90, v92, v93
v_mfma_f32_16x16x32_f16 v[148:151], v[220:223], v[212:215], v[148:151]
v_exp_f16_e64 v198, v199
v_cvt_pk_bf16_f32 v91, v94, v95
s_mov_b64 vcc, s[74:75]
v_bfe_u32 v188, v189, 2, 14
v_bfe_u32 v190, v191, 2, 14
s_waitcnt lgkmcnt(5)
v_mfma_f32_16x16x32_bf16 v[168:171], v[224:227], v[32:35], v[168:171]
ds_read_b128 v[220:223], v249 offset:8448
ds_read_u16_d16 v188, v188
ds_read_u16_d16 v190, v190
v_cndmask_b32 v76, v56, v88, vcc
v_exp_f16 v195, v196
v_mfma_f32_16x16x32_bf16 v[176:179], v[224:227], v[36:39], v[176:179]
v_cndmask_b32 v77, v57, v89, vcc
v_lshrrev_b32_e64 v189, 18, v189
v_cndmask_b32 v78, v58, v90, vcc
v_mfma_f32_16x16x32_f16 v[152:155], v[228:231], v[208:211], v[152:155]
ds_read_b128 v[224:227], v250 offset:8192
ds_read_u16_d16_hi v189, v189
v_lshrrev_b32 v191, 18, v191
v_cndmask_b32 v79, v59, v91, vcc
v_exp_f16_sdwa v201, v202 dst_sel:WORD_1 dst_unused:UNUSED_PRESERVE src0_sel:WORD_1
v_mfma_f32_16x16x32_f16 v[160:163], v[228:231], v[212:215], v[160:163]
v_cndmask_b32_dpp v56, v72, v56, vcc quad_perm:[1,0,3,2] row_mask:0xf bank_mask:0xf
v_and_b32_e64 v193, s49, v193
v_cndmask_b32_dpp v57, v73, v57, vcc quad_perm:[1,0,3,2] row_mask:0xf bank_mask:0xf
v_mfma_f32_16x16x32_f16 v[156:159], v[232:235], v[208:211], v[156:159]
ds_read_b128 v[228:231], v250 offset:8448
ds_read_u16_d16_hi v191, v191
v_bfe_u32 v192, v193, 2, 14
v_exp_f16_sdwa v198, v199 dst_sel:WORD_1 dst_unused:UNUSED_PRESERVE src0_sel:WORD_1
v_mfma_f32_16x16x32_f16 v[164:167], v[232:235], v[212:215], v[164:167]
v_cndmask_b32_dpp v58, v74, v58, vcc quad_perm:[1,0,3,2] row_mask:0xf bank_mask:0xf
v_lshrrev_b32_e64 v193, 18, v193
v_cndmask_b32_dpp v59, v75, v59, vcc quad_perm:[1,0,3,2] row_mask:0xf bank_mask:0xf
s_not_b64 vcc, s[74:75]
s_waitcnt lgkmcnt(4)
v_mfma_f32_16x16x32_bf16 v[172:175], v[236:239], v[32:35], v[172:175]
ds_read_b128 v[232:235], v249 offset:12288
ds_read_u16_d16 v192, v192
ds_read_u16_d16_hi v193, v193
v_exp_f16_sdwa v195, v196 dst_sel:WORD_1 dst_unused:UNUSED_PRESERVE src0_sel:WORD_1
v_cndmask_b32_dpp v88, v72, v88, vcc quad_perm:[1,0,3,2] row_mask:0xf bank_mask:0xf
v_pk_add_f16 v201, v201, 1.0 op_sel_hi:[1,0]
v_mfma_f32_16x16x32_bf16 v[180:183], v[236:239], v[36:39], v[180:183]
v_cndmask_b32_dpp v89, v73, v89, vcc quad_perm:[1,0,3,2] row_mask:0xf bank_mask:0xf
v_pk_add_f16 v198, v198, 1.0 op_sel_hi:[1,0]
v_cndmask_b32_dpp v90, v74, v90, vcc quad_perm:[1,0,3,2] row_mask:0xf bank_mask:0xf
v_mfma_f32_16x16x32_bf16 v[168:171], v[216:219], v[40:43], v[168:171]
ds_read_b128 v[236:239], v250 offset:9216
v_pk_add_f16 v195, v195, 1.0 op_sel_hi:[1,0]
v_rcp_f16_e64 v202, v201
v_cndmask_b32_dpp v91, v75, v91, vcc quad_perm:[1,0,3,2] row_mask:0xf bank_mask:0xf
v_mfma_f32_16x16x32_bf16 v[176:179], v[216:219], v[44:47], v[176:179]
v_rcp_f16_e64 v199, v198
v_mfma_f32_16x16x32_bf16 v[172:175], v[220:223], v[40:43], v[172:175]
ds_read_b128 v[216:219], v249 offset:12544
s_add_u32 s46, s70, 98304
buffer_store_dwordx4 v[56:59], v255, s[8:11], s46 offen sc1
v_rcp_f16_e64 v196, v195
v_rcp_f16_sdwa v202, v201 dst_sel:WORD_1 dst_unused:UNUSED_PRESERVE src0_sel:WORD_1
v_mfma_f32_16x16x32_bf16 v[180:183], v[220:223], v[44:47], v[180:183]
v_rcp_f16_sdwa v199, v198 dst_sel:WORD_1 dst_unused:UNUSED_PRESERVE src0_sel:WORD_1
v_or_b32 v208, v184, v185
v_or_b32 v209, v186, v187
s_waitcnt lgkmcnt(2)
v_or_b32 v210, v188, v189
v_rcp_f16_sdwa v196, v195 dst_sel:WORD_1 dst_unused:UNUSED_PRESERVE src0_sel:WORD_1
v_or_b32 v211, v190, v191
v_or_b32 v212, v192, v193
v_pk_mul_f16 v213, v203, v202
v_pk_mul_f16 v214, v200, v199
v_pk_mul_f16 v215, v197, v196
v_mfma_f32_16x16x32_f16 v[120:123], v[224:227], v[208:211], v[120:123]
buffer_load_dwordx4 v[0:3], v252, s[4:7], s68 offen offset:128
ds_read_b128 v[220:223], v250 offset:9472
v_cvt_pkrtz_f16_f32 v185, v168, v169
v_cvt_pkrtz_f16_f32 v187, v170, v171
v_mfma_f32_16x16x32_f16 v[128:131], v[224:227], v[212:215], v[128:131]
v_cvt_pkrtz_f16_f32 v189, v172, v173
v_cvt_pkrtz_f16_f32 v191, v174, v175
v_mfma_f32_16x16x32_f16 v[124:127], v[228:231], v[208:211], v[124:127]
ds_read_b128 v[224:227], v249 offset:13312
v_cvt_pkrtz_f16_f32 v193, v176, v177
v_cvt_pk_f16_f32 v203, v178, v179
v_cvt_pk_f16_f32 v200, v180, v181
v_mfma_f32_16x16x32_f16 v[132:135], v[228:231], v[212:215], v[132:135]
v_cvt_pk_f16_f32 v197, v182, v183
s_setprio 1
v_pk_fma_f16 v202, v203, v203, s48
v_mfma_f32_16x16x32_bf16 v[168:171], v[232:235], v[24:27], 0
ds_read_b128 v[228:231], v250 offset:10240
v_and_b32 v185, s49, v185
v_pk_fma_f16 v199, v200, v200, s48
v_mfma_f32_16x16x32_bf16 v[176:179], v[232:235], v[28:31], 0
v_and_b32 v187, s49, v187
v_pk_fma_f16 v196, v197, v197, s48
v_bfe_u32 v184, v185, 2, 14
s_waitcnt lgkmcnt(3)
v_mfma_f32_16x16x32_f16 v[136:139], v[236:239], v[208:211], v[136:139]
ds_read_b128 v[232:235], v250 offset:10496
ds_read_u16_d16 v184, v184
v_pk_mul_f16 v202, v203, v202
v_bfe_u32 v186, v187, 2, 14
v_mfma_f32_16x16x32_f16 v[144:147], v[236:239], v[212:215], v[144:147]
v_pk_mul_f16 v199, v200, v199
v_lshrrev_b32_e64 v185, 18, v185
v_mfma_f32_16x16x32_bf16 v[172:175], v[216:219], v[24:27], 0
ds_read_b128 v[236:239], v249 offset:13568
ds_read_u16_d16 v186, v186
ds_read_u16_d16_hi v185, v185
v_pk_mul_f16 v196, v197, v196
v_lshrrev_b32_e64 v187, 18, v187
v_mfma_f32_16x16x32_bf16 v[180:183], v[216:219], v[28:31], 0
v_exp_f16_e64 v201, v202
v_and_b32 v189, s49, v189
s_waitcnt lgkmcnt(5)
v_mfma_f32_16x16x32_f16 v[140:143], v[220:223], v[208:211], v[140:143]
ds_read_b128 v[216:219], v249 offset:14336
ds_read_u16_d16_hi v187, v187
v_and_b32_e64 v191, s49, v191
v_mfma_f32_16x16x32_f16 v[148:151], v[220:223], v[212:215], v[148:151]
v_exp_f16_e64 v198, v199
v_bfe_u32 v188, v189, 2, 14
v_bfe_u32 v190, v191, 2, 14
v_mfma_f32_16x16x32_bf16 v[168:171], v[224:227], v[32:35], v[168:171]
ds_read_b128 v[220:223], v249 offset:14592
ds_read_u16_d16 v188, v188
ds_read_u16_d16 v190, v190
v_exp_f16_e64 v195, v196
v_mfma_f32_16x16x32_bf16 v[176:179], v[224:227], v[36:39], v[176:179]
v_lshrrev_b32 v189, 18, v189
v_lshrrev_b32 v191, 18, v191
v_mfma_f32_16x16x32_f16 v[152:155], v[228:231], v[208:211], v[152:155]
ds_read_b128 v[224:227], v250 offset:14336
ds_read_u16_d16_hi v189, v189
ds_read_u16_d16_hi v191, v191
v_exp_f16_sdwa v201, v202 dst_sel:WORD_1 dst_unused:UNUSED_PRESERVE src0_sel:WORD_1
v_and_b32 v193, s49, v193
v_mfma_f32_16x16x32_f16 v[160:163], v[228:231], v[212:215], v[160:163]
v_bfe_u32 v192, v193, 2, 14
s_waitcnt lgkmcnt(8)
v_mfma_f32_16x16x32_f16 v[156:159], v[232:235], v[208:211], v[156:159]
ds_read_b128 v[228:231], v250 offset:14592
ds_read_u16_d16 v192, v192
v_exp_f16_sdwa v198, v199 dst_sel:WORD_1 dst_unused:UNUSED_PRESERVE src0_sel:WORD_1
v_lshrrev_b32_e64 v193, 18, v193
v_mfma_f32_16x16x32_f16 v[164:167], v[232:235], v[212:215], v[164:167]
v_exp_f16_sdwa v195, v196 dst_sel:WORD_1 dst_unused:UNUSED_PRESERVE src0_sel:WORD_1
v_pk_add_f16 v201, v201, 1.0 op_sel_hi:[1,0]
v_mfma_f32_16x16x32_bf16 v[172:175], v[236:239], v[32:35], v[172:175]
ds_read_b128 v[232:235], v249 offset:18432
ds_read_u16_d16_hi v193, v193
v_pk_add_f16 v198, v198, 1.0 op_sel_hi:[1,0]
v_pk_add_f16 v195, v195, 1.0 op_sel_hi:[1,0]
v_mfma_f32_16x16x32_bf16 v[180:183], v[236:239], v[36:39], v[180:183]
v_rcp_f16_e64 v202, v201
s_setprio 0
s_waitcnt lgkmcnt(7)
v_mfma_f32_16x16x32_bf16 v[168:171], v[216:219], v[40:43], v[168:171]
ds_read_b128 v[236:239], v250 offset:15360
v_rcp_f16_e64 v199, v198
v_mfma_f32_16x16x32_bf16 v[176:179], v[216:219], v[44:47], v[176:179]
v_rcp_f16_e64 v196, v195
v_mfma_f32_16x16x32_bf16 v[172:175], v[220:223], v[40:43], v[172:175]
ds_read_b128 v[216:219], v249 offset:18688
v_rcp_f16_sdwa v202, v201 dst_sel:WORD_1 dst_unused:UNUSED_PRESERVE src0_sel:WORD_1
v_mfma_f32_16x16x32_bf16 v[180:183], v[220:223], v[44:47], v[180:183]
v_rcp_f16_sdwa v199, v198 dst_sel:WORD_1 dst_unused:UNUSED_PRESERVE src0_sel:WORD_1
v_or_b32 v208, v184, v185
v_or_b32 v209, v186, v187
s_waitcnt lgkmcnt(4)
v_or_b32 v210, v188, v189
v_rcp_f16_sdwa v196, v195 dst_sel:WORD_1 dst_unused:UNUSED_PRESERVE src0_sel:WORD_1
v_or_b32 v211, v190, v191
s_waitcnt lgkmcnt(2)
v_or_b32 v212, v192, v193
v_pk_mul_f16 v213, v203, v202
v_pk_mul_f16 v214, v200, v199
v_pk_mul_f16 v215, v197, v196
s_setprio 3
v_mfma_f32_16x16x32_f16 v[120:123], v[224:227], v[208:211], v[120:123]
s_add_u32 s46, s68, 98304
buffer_load_dwordx4 v[4:7], v252, s[4:7], s46 offen
ds_read_b128 v[220:223], v250 offset:15616
v_cvt_pkrtz_f16_f32 v185, v168, v169
v_cvt_pkrtz_f16_f32 v187, v170, v171
v_mfma_f32_16x16x32_f16 v[128:131], v[224:227], v[212:215], v[128:131]
v_cvt_pkrtz_f16_f32 v189, v172, v173
v_cvt_pkrtz_f16_f32 v191, v174, v175
v_mfma_f32_16x16x32_f16 v[124:127], v[228:231], v[208:211], v[124:127]
ds_read_b128 v[224:227], v249 offset:19456
v_cvt_pkrtz_f16_f32 v193, v176, v177
v_cvt_pk_f16_f32 v203, v178, v179
v_cvt_pk_f16_f32 v200, v180, v181
v_mfma_f32_16x16x32_f16 v[132:135], v[228:231], v[212:215], v[132:135]
v_cvt_pk_f16_f32 v197, v182, v183
v_pk_fma_f16 v202, v203, v203, s48
v_mfma_f32_16x16x32_bf16 v[168:171], v[232:235], v[24:27], 0
ds_read_b128 v[228:231], v250 offset:16384
v_and_b32_e64 v185, s49, v185
v_pk_fma_f16 v199, v200, v200, s48
v_mfma_f32_16x16x32_bf16 v[176:179], v[232:235], v[28:31], 0
v_and_b32 v187, s49, v187
v_pk_fma_f16 v196, v197, v197, s48
v_bfe_u32 v184, v185, 2, 14
s_waitcnt lgkmcnt(3)
v_mfma_f32_16x16x32_f16 v[136:139], v[236:239], v[208:211], v[136:139]
ds_read_b128 v[232:235], v250 offset:16640
ds_read_u16_d16 v184, v184
v_pk_mul_f16 v202, v203, v202
v_bfe_u32 v186, v187, 2, 14
v_mfma_f32_16x16x32_f16 v[144:147], v[236:239], v[212:215], v[144:147]
v_pk_mul_f16 v199, v200, v199
v_lshrrev_b32_e64 v185, 18, v185
v_mfma_f32_16x16x32_bf16 v[172:175], v[216:219], v[24:27], 0
ds_read_b128 v[236:239], v249 offset:19712
ds_read_u16_d16 v186, v186
ds_read_u16_d16_hi v185, v185
v_pk_mul_f16 v196, v197, v196
v_lshrrev_b32_e64 v187, 18, v187
v_mfma_f32_16x16x32_bf16 v[180:183], v[216:219], v[28:31], 0
v_exp_f16_e64 v201, v202
v_and_b32 v189, s49, v189
s_waitcnt lgkmcnt(5)
v_mfma_f32_16x16x32_f16 v[140:143], v[220:223], v[208:211], v[140:143]
ds_read_b128 v[216:219], v249 offset:20480
ds_read_u16_d16_hi v187, v187
v_and_b32_e64 v191, s49, v191
v_mfma_f32_16x16x32_f16 v[148:151], v[220:223], v[212:215], v[148:151]
v_exp_f16_e64 v198, v199
v_bfe_u32 v188, v189, 2, 14
v_bfe_u32 v190, v191, 2, 14
v_mfma_f32_16x16x32_bf16 v[168:171], v[224:227], v[32:35], v[168:171]
s_add_u32 s46, s70, 98304
buffer_store_dwordx4 v[76:79], v255, s[8:11], s46 offen offset:128 sc1
ds_read_b128 v[220:223], v249 offset:20736
ds_read_u16_d16 v188, v188
ds_read_u16_d16 v190, v190
v_exp_f16_e64 v195, v196
v_mfma_f32_16x16x32_bf16 v[176:179], v[224:227], v[36:39], v[176:179]
v_lshrrev_b32 v189, 18, v189
v_lshrrev_b32 v191, 18, v191
v_mfma_f32_16x16x32_f16 v[152:155], v[228:231], v[208:211], v[152:155]
ds_read_b128 v[224:227], v250 offset:20480
ds_read_u16_d16_hi v189, v189
ds_read_u16_d16_hi v191, v191
v_exp_f16_sdwa v201, v202 dst_sel:WORD_1 dst_unused:UNUSED_PRESERVE src0_sel:WORD_1
v_and_b32 v193, s49, v193
v_mfma_f32_16x16x32_f16 v[160:163], v[228:231], v[212:215], v[160:163]
v_bfe_u32 v192, v193, 2, 14
s_waitcnt lgkmcnt(7)
v_mfma_f32_16x16x32_f16 v[156:159], v[232:235], v[208:211], v[156:159]
ds_read_b128 v[228:231], v250 offset:20736
ds_read_u16_d16 v192, v192
v_exp_f16_sdwa v198, v199 dst_sel:WORD_1 dst_unused:UNUSED_PRESERVE src0_sel:WORD_1
v_lshrrev_b32_e64 v193, 18, v193
v_mfma_f32_16x16x32_f16 v[164:167], v[232:235], v[212:215], v[164:167]
v_exp_f16_sdwa v195, v196 dst_sel:WORD_1 dst_unused:UNUSED_PRESERVE src0_sel:WORD_1
v_pk_add_f16 v201, v201, 1.0 op_sel_hi:[1,0]
v_mfma_f32_16x16x32_bf16 v[172:175], v[236:239], v[32:35], v[172:175]
ds_read_b128 v[232:235], v248 offset:16384
ds_read_u16_d16_hi v193, v193
v_pk_add_f16 v198, v198, 1.0 op_sel_hi:[1,0]
v_pk_add_f16 v195, v195, 1.0 op_sel_hi:[1,0]
v_mfma_f32_16x16x32_bf16 v[180:183], v[236:239], v[36:39], v[180:183]
v_rcp_f16_e64 v202, v201
v_mfma_f32_16x16x32_bf16 v[168:171], v[216:219], v[40:43], v[168:171]
ds_read_b128 v[236:239], v250 offset:21504
v_rcp_f16_e64 v199, v198
v_mfma_f32_16x16x32_bf16 v[176:179], v[216:219], v[44:47], v[176:179]
v_rcp_f16 v196, v195
s_waitcnt lgkmcnt(5)
v_mfma_f32_16x16x32_bf16 v[172:175], v[220:223], v[40:43], v[172:175]
ds_read_b128 v[216:219], v248 offset:16640
v_rcp_f16_sdwa v202, v201 dst_sel:WORD_1 dst_unused:UNUSED_PRESERVE src0_sel:WORD_1
v_mfma_f32_16x16x32_bf16 v[180:183], v[220:223], v[44:47], v[180:183]
v_rcp_f16_sdwa v199, v198 dst_sel:WORD_1 dst_unused:UNUSED_PRESERVE src0_sel:WORD_1
v_or_b32 v208, v184, v185
v_or_b32 v209, v186, v187
v_or_b32_e64 v210, v188, v189
v_rcp_f16_sdwa v196, v195 dst_sel:WORD_1 dst_unused:UNUSED_PRESERVE src0_sel:WORD_1
v_or_b32 v211, v190, v191
s_waitcnt lgkmcnt(2)
v_or_b32_e64 v212, v192, v193
v_pk_mul_f16 v213, v203, v202
v_pk_mul_f16 v214, v200, v199
v_pk_mul_f16 v215, v197, v196
v_mfma_f32_16x16x32_f16 v[120:123], v[224:227], v[208:211], v[120:123]
ds_read_b128 v[220:223], v250 offset:21760
v_cvt_pkrtz_f16_f32 v185, v168, v169
v_cvt_pkrtz_f16_f32 v187, v170, v171
v_mfma_f32_16x16x32_f16 v[128:131], v[224:227], v[212:215], v[128:131]
v_cvt_pkrtz_f16_f32 v189, v172, v173
v_cvt_pkrtz_f16_f32 v191, v174, v175
v_mfma_f32_16x16x32_f16 v[124:127], v[228:231], v[208:211], v[124:127]
ds_read_b128 v[224:227], v248 offset:17408
v_cvt_pkrtz_f16_f32 v193, v176, v177
v_cvt_pk_f16_f32 v203, v178, v179
v_cvt_pk_f16_f32 v200, v180, v181
v_mfma_f32_16x16x32_f16 v[132:135], v[228:231], v[212:215], v[132:135]
v_cvt_pk_f16_f32 v197, v182, v183
v_pk_fma_f16 v202, v203, v203, s48
s_waitcnt vmcnt(14)
v_mfma_f32_16x16x32_bf16 v[168:171], v[232:235], v[96:99], 0
ds_read_b128 v[228:231], v250 offset:22528
v_and_b32 v185, s49, v185
v_pk_fma_f16 v199, v200, v200, s48
s_waitcnt vmcnt(13)
v_mfma_f32_16x16x32_bf16 v[176:179], v[232:235], v[100:103], 0
v_and_b32 v187, s49, v187
v_pk_fma_f16 v196, v197, v197, s48
s_setprio 2
v_bfe_u32 v184, v185, 2, 14
s_waitcnt lgkmcnt(2)
v_mfma_f32_16x16x32_f16 v[136:139], v[236:239], v[208:211], v[136:139]
ds_read_b128 v[232:235], v250 offset:22784
ds_read_u16_d16 v184, v184
v_pk_mul_f16 v202, v203, v202
v_bfe_u32 v186, v187, 2, 14
v_mfma_f32_16x16x32_f16 v[144:147], v[236:239], v[212:215], v[144:147]
v_pk_mul_f16 v199, v200, v199
v_lshrrev_b32_e64 v185, 18, v185
v_mfma_f32_16x16x32_bf16 v[172:175], v[216:219], v[96:99], 0
ds_read_b128 v[236:239], v248 offset:17664
ds_read_u16_d16 v186, v186
ds_read_u16_d16_hi v185, v185
v_pk_mul_f16 v196, v197, v196
v_lshrrev_b32_e64 v187, 18, v187
v_mfma_f32_16x16x32_bf16 v[180:183], v[216:219], v[100:103], 0
v_exp_f16 v201, v202
v_and_b32 v189, s49, v189
v_mfma_f32_16x16x32_f16 v[140:143], v[220:223], v[208:211], v[140:143]
ds_read_b128 v[216:219], v248 offset:18432
ds_read_u16_d16_hi v187, v187
v_and_b32_e64 v191, s49, v191
v_mfma_f32_16x16x32_f16 v[148:151], v[220:223], v[212:215], v[148:151]
v_exp_f16 v198, v199
v_bfe_u32 v188, v189, 2, 14
v_bfe_u32 v190, v191, 2, 14
s_waitcnt vmcnt(12) lgkmcnt(7)
v_mfma_f32_16x16x32_bf16 v[168:171], v[224:227], v[104:107], v[168:171]
ds_read_b128 v[220:223], v248 offset:18688
ds_read_u16_d16 v188, v188
ds_read_u16_d16 v190, v190
v_exp_f16 v195, v196
s_waitcnt vmcnt(11)
v_mfma_f32_16x16x32_bf16 v[176:179], v[224:227], v[108:111], v[176:179]
v_lshrrev_b32 v189, 18, v189
v_lshrrev_b32 v191, 18, v191
v_mfma_f32_16x16x32_f16 v[152:155], v[228:231], v[208:211], v[152:155]
ds_read_b128 v[224:227], v250 offset:26624
ds_read_u16_d16_hi v189, v189
ds_read_u16_d16_hi v191, v191
v_exp_f16_sdwa v201, v202 dst_sel:WORD_1 dst_unused:UNUSED_PRESERVE src0_sel:WORD_1
v_and_b32 v193, s49, v193
v_mfma_f32_16x16x32_f16 v[160:163], v[228:231], v[212:215], v[160:163]
v_bfe_u32 v192, v193, 2, 14
s_waitcnt lgkmcnt(7)
v_mfma_f32_16x16x32_f16 v[156:159], v[232:235], v[208:211], v[156:159]
ds_read_b128 v[228:231], v250 offset:26880
ds_read_u16_d16 v192, v192
v_exp_f16_sdwa v198, v199 dst_sel:WORD_1 dst_unused:UNUSED_PRESERVE src0_sel:WORD_1
v_lshrrev_b32_e64 v193, 18, v193
v_mfma_f32_16x16x32_f16 v[164:167], v[232:235], v[212:215], v[164:167]
v_exp_f16_sdwa v195, v196 dst_sel:WORD_1 dst_unused:UNUSED_PRESERVE src0_sel:WORD_1
v_pk_add_f16 v201, v201, 1.0 op_sel_hi:[1,0]
v_mfma_f32_16x16x32_bf16 v[172:175], v[236:239], v[104:107], v[172:175]
ds_read_b128 v[232:235], v248 offset:22528
ds_read_u16_d16_hi v193, v193
v_pk_add_f16 v198, v198, 1.0 op_sel_hi:[1,0]
v_pk_add_f16 v195, v195, 1.0 op_sel_hi:[1,0]
v_mfma_f32_16x16x32_bf16 v[180:183], v[236:239], v[108:111], v[180:183]
v_rcp_f16 v202, v201
s_waitcnt vmcnt(10)
v_mfma_f32_16x16x32_bf16 v[168:171], v[216:219], v[112:115], v[168:171]
ds_read_b128 v[236:239], v250 offset:27648
v_rcp_f16 v199, v198
s_waitcnt vmcnt(7)
v_mfma_f32_16x16x32_bf16 v[176:179], v[216:219], v[116:119], v[176:179]
v_rcp_f16 v196, v195
s_waitcnt lgkmcnt(5)
v_mfma_f32_16x16x32_bf16 v[172:175], v[220:223], v[112:115], v[172:175]
ds_read_b128 v[216:219], v248 offset:22784
v_rcp_f16_sdwa v202, v201 dst_sel:WORD_1 dst_unused:UNUSED_PRESERVE src0_sel:WORD_1
v_mfma_f32_16x16x32_bf16 v[180:183], v[220:223], v[116:119], v[180:183]
v_rcp_f16_sdwa v199, v198 dst_sel:WORD_1 dst_unused:UNUSED_PRESERVE src0_sel:WORD_1
v_or_b32 v208, v184, v185
v_or_b32 v209, v186, v187
v_or_b32_e64 v210, v188, v189
v_rcp_f16_sdwa v196, v195 dst_sel:WORD_1 dst_unused:UNUSED_PRESERVE src0_sel:WORD_1
v_or_b32 v211, v190, v191
s_waitcnt lgkmcnt(2)
v_or_b32_e64 v212, v192, v193
v_pk_mul_f16 v213, v203, v202
v_pk_mul_f16 v214, v200, v199
v_pk_mul_f16 v215, v197, v196
v_mfma_f32_16x16x32_f16 v[120:123], v[224:227], v[208:211], v[120:123]
s_add_u32 s46, s68, 98304
buffer_load_dwordx4 v[44:47], v252, s[4:7], s46 offen offset:64
ds_read_b128 v[220:223], v250 offset:27904
v_cvt_pkrtz_f16_f32 v185, v168, v169
v_cvt_pkrtz_f16_f32 v187, v170, v171
v_mfma_f32_16x16x32_f16 v[128:131], v[224:227], v[212:215], v[128:131]
v_cvt_pkrtz_f16_f32 v189, v172, v173
v_cvt_pkrtz_f16_f32 v191, v174, v175
v_mfma_f32_16x16x32_f16 v[124:127], v[228:231], v[208:211], v[124:127]
ds_read_b128 v[224:227], v248 offset:23552
v_cvt_pkrtz_f16_f32 v193, v176, v177
v_cvt_pk_f16_f32 v203, v178, v179
v_mfma_f32_16x16x32_f16 v[132:135], v[228:231], v[212:215], v[132:135]
v_cvt_pk_f16_f32 v200, v180, v181
v_cvt_pk_f16_f32 v197, v182, v183
s_setprio 1
v_mfma_f32_16x16x32_bf16 v[168:171], v[232:235], v[96:99], 0
ds_read_b128 v[228:231], v250 offset:28672
v_pk_fma_f16 v202, v203, v203, s48
v_and_b32 v185, s49, v185
v_mfma_f32_16x16x32_bf16 v[176:179], v[232:235], v[100:103], 0
v_pk_fma_f16 v199, v200, v200, s48
v_and_b32 v187, s49, v187
s_waitcnt lgkmcnt(3)
v_mfma_f32_16x16x32_f16 v[136:139], v[236:239], v[208:211], v[136:139]
ds_read_b128 v[232:235], v250 offset:28928
v_pk_fma_f16 v196, v197, v197, s48
v_bfe_u32 v184, v185, 2, 14
v_pk_mul_f16 v202, v203, v202
v_mfma_f32_16x16x32_f16 v[144:147], v[236:239], v[212:215], v[144:147]
v_bfe_u32 v186, v187, 2, 14
v_pk_mul_f16 v199, v200, v199
s_waitcnt vmcnt(7)
v_mfma_f32_16x16x32_bf16 v[120:123], v[18:21], v[204:207], v[120:123]
ds_read_b128 v[236:239], v248 offset:23808
ds_read_u16_d16 v184, v184
ds_read_u16_d16 v186, v186
v_lshrrev_b32 v185, 18, v185
v_pk_mul_f16 v196, v197, v196
v_mfma_f32_16x16x32_bf16 v[124:127], v[16:19], v[204:207], v[124:127]
v_lshrrev_b32_e64 v187, 18, v187
v_mfma_f32_16x16x32_bf16 v[172:175], v[216:219], v[96:99], 0
ds_read_u16_d16_hi v185, v185
ds_read_u16_d16_hi v187, v187
v_exp_f16 v201, v202
v_and_b32 v189, s49, v189
v_mfma_f32_16x16x32_bf16 v[180:183], v[216:219], v[100:103], 0
v_and_b32 v191, s49, v191
s_waitcnt lgkmcnt(6)
v_mfma_f32_16x16x32_f16 v[140:143], v[220:223], v[208:211], v[140:143]
ds_read_b128 v[216:219], v248 offset:24576
v_exp_f16_e64 v198, v199
v_bfe_u32 v188, v189, 2, 14
v_mfma_f32_16x16x32_f16 v[148:151], v[220:223], v[212:215], v[148:151]
v_bfe_u32 v190, v191, 2, 14
v_exp_f16_e64 v195, v196
v_mfma_f32_16x16x32_bf16 v[168:171], v[224:227], v[104:107], v[168:171]
s_add_u32 s46, s70, 98304
buffer_store_dwordx4 v[88:91], v255, s[8:11], s46 offen offset:256 sc1
ds_read_b128 v[220:223], v248 offset:24832
ds_read_u16_d16 v188, v188
ds_read_u16_d16 v190, v190
v_lshrrev_b32 v189, 18, v189
v_lshrrev_b32 v191, 18, v191
v_mfma_f32_16x16x32_bf16 v[176:179], v[224:227], v[108:111], v[176:179]
v_exp_f16_sdwa v201, v202 dst_sel:WORD_1 dst_unused:UNUSED_PRESERVE src0_sel:WORD_1
v_mfma_f32_16x16x32_f16 v[152:155], v[228:231], v[208:211], v[152:155]
ds_read_b128 v[224:227], v249 offset:24576
ds_read_u16_d16_hi v189, v189
ds_read_u16_d16_hi v191, v191
v_and_b32 v193, s49, v193
v_bfe_u32 v192, v193, 2, 14
v_mfma_f32_16x16x32_f16 v[160:163], v[228:231], v[212:215], v[160:163]
v_exp_f16_sdwa v198, v199 dst_sel:WORD_1 dst_unused:UNUSED_PRESERVE src0_sel:WORD_1
s_waitcnt lgkmcnt(7)
v_mfma_f32_16x16x32_f16 v[156:159], v[232:235], v[208:211], v[156:159]
ds_read_b128 v[228:231], v254 offset:7936
ds_read_u16_d16 v192, v192
v_lshrrev_b32_e64 v193, 18, v193
v_mfma_f32_16x16x32_f16 v[164:167], v[232:235], v[212:215], v[164:167]
v_exp_f16_sdwa v195, v196 dst_sel:WORD_1 dst_unused:UNUSED_PRESERVE src0_sel:WORD_1
v_pk_add_f16 v201, v201, 1.0 op_sel_hi:[1,0]
v_pk_add_f16 v198, v198, 1.0 op_sel_hi:[1,0]
v_mfma_f32_16x16x32_bf16 v[172:175], v[236:239], v[104:107], v[172:175]
ds_read_b128 v[232:235], v249 offset:24832
ds_read_u16_d16_hi v193, v193
v_pk_add_f16 v195, v195, 1.0 op_sel_hi:[1,0]
v_mfma_f32_16x16x32_bf16 v[180:183], v[236:239], v[108:111], v[180:183]
v_rcp_f16_e64 v202, v201
s_setprio 0
s_waitcnt lgkmcnt(7)
v_mfma_f32_16x16x32_bf16 v[168:171], v[216:219], v[112:115], v[168:171]
ds_read_b128 v[236:239], v254 offset:7952
v_rcp_f16_e64 v199, v198
v_mfma_f32_16x16x32_bf16 v[176:179], v[216:219], v[116:119], v[176:179]
v_rcp_f16_e64 v196, v195
v_mfma_f32_16x16x32_bf16 v[172:175], v[220:223], v[112:115], v[172:175]
ds_read_b128 v[216:219], v248 offset:28672
v_rcp_f16_sdwa v202, v201 dst_sel:WORD_1 dst_unused:UNUSED_PRESERVE src0_sel:WORD_1
v_mfma_f32_16x16x32_bf16 v[180:183], v[220:223], v[116:119], v[180:183]
v_rcp_f16_sdwa v199, v198 dst_sel:WORD_1 dst_unused:UNUSED_PRESERVE src0_sel:WORD_1
v_or_b32 v208, v184, v185
v_or_b32 v209, v186, v187
s_waitcnt lgkmcnt(4)
v_or_b32 v210, v188, v189
v_rcp_f16_sdwa v196, v195 dst_sel:WORD_1 dst_unused:UNUSED_PRESERVE src0_sel:WORD_1
v_or_b32 v211, v190, v191
s_waitcnt lgkmcnt(2)
v_or_b32 v212, v192, v193
v_pk_mul_f16 v213, v203, v202
v_pk_mul_f16 v214, v200, v199
v_pk_mul_f16 v215, v197, v196
s_setprio 3
v_mfma_f32_16x16x32_f16 v[48:51], v[224:227], v[208:211], v[228:231]
ds_read_b128 v[220:223], v249 offset:25600
v_cvt_pkrtz_f16_f32 v185, v168, v169
v_cvt_pkrtz_f16_f32 v187, v170, v171
v_mfma_f32_16x16x32_f16 v[56:59], v[224:227], v[212:215], v[228:231]
v_cvt_pkrtz_f16_f32 v189, v172, v173
v_cvt_pkrtz_f16_f32 v191, v174, v175
s_waitcnt lgkmcnt(2)
v_mfma_f32_16x16x32_f16 v[52:55], v[232:235], v[208:211], v[236:239]
ds_read_b128 v[224:227], v254 offset:8064
ds_read_b128 v[228:231], v248 offset:28928
v_cvt_pkrtz_f16_f32 v193, v176, v177
v_cvt_pk_f16_f32 v203, v178, v179
v_mfma_f32_16x16x32_f16 v[60:63], v[232:235], v[212:215], v[236:239]
v_cvt_pk_f16_f32 v200, v180, v181
v_cvt_pk_f16_f32 v197, v182, v183
s_waitcnt lgkmcnt(3)
v_mfma_f32_16x16x32_bf16 v[168:171], v[216:219], v[96:99], 0
ds_read_b128 v[232:235], v249 offset:25856
ds_read_b128 v[236:239], v254 offset:8080
v_pk_fma_f16 v202, v203, v203, s48
v_and_b32_e64 v185, s49, v185
v_mfma_f32_16x16x32_bf16 v[176:179], v[216:219], v[100:103], 0
v_pk_fma_f16 v199, v200, v200, s48
v_and_b32 v187, s49, v187
s_waitcnt lgkmcnt(3)
v_mfma_f32_16x16x32_f16 v[64:67], v[220:223], v[208:211], v[224:227]
ds_read_b128 v[216:219], v248 offset:29696
v_pk_fma_f16 v196, v197, v197, s48
v_bfe_u32 v184, v185, 2, 14
v_pk_mul_f16 v202, v203, v202
v_mfma_f32_16x16x32_f16 v[72:75], v[220:223], v[212:215], v[224:227]
v_bfe_u32 v186, v187, 2, 14
v_pk_mul_f16 v199, v200, v199
s_waitcnt vmcnt(6)
v_mfma_f32_16x16x32_bf16 v[136:139], v[18:21], v[244:247], v[136:139]
ds_read_b128 v[220:223], v249 offset:26624
ds_read_b128 v[224:227], v254 offset:16128
ds_read_u16_d16 v184, v184
ds_read_u16_d16 v186, v186
v_lshrrev_b32 v185, 18, v185
v_pk_mul_f16 v196, v197, v196
v_mfma_f32_16x16x32_bf16 v[140:143], v[16:19], v[244:247], v[140:143]
v_lshrrev_b32 v187, 18, v187
s_waitcnt lgkmcnt(5)
v_mfma_f32_16x16x32_bf16 v[172:175], v[228:231], v[96:99], 0
ds_read_u16_d16_hi v185, v185
ds_read_u16_d16_hi v187, v187
v_exp_f16 v201, v202
v_and_b32 v189, s49, v189
v_mfma_f32_16x16x32_bf16 v[180:183], v[228:231], v[100:103], 0
v_and_b32_e64 v191, s49, v191
v_mfma_f32_16x16x32_f16 v[68:71], v[232:235], v[208:211], v[236:239]
ds_read_b128 v[228:231], v249 offset:26880
v_exp_f16_e64 v198, v199
v_bfe_u32 v188, v189, 2, 14
v_mfma_f32_16x16x32_f16 v[76:79], v[232:235], v[212:215], v[236:239]
v_bfe_u32 v190, v191, 2, 14
v_exp_f16 v195, v196
s_waitcnt lgkmcnt(7)
v_mfma_f32_16x16x32_bf16 v[168:171], v[216:219], v[104:107], v[168:171]
ds_read_b128 v[232:235], v254 offset:16144
ds_read_b128 v[236:239], v248 offset:29952
ds_read_u16_d16 v188, v188
ds_read_u16_d16 v190, v190
v_lshrrev_b32_e64 v189, 18, v189
v_lshrrev_b32 v191, 18, v191
v_mfma_f32_16x16x32_bf16 v[176:179], v[216:219], v[108:111], v[176:179]
v_exp_f16_sdwa v201, v202 dst_sel:WORD_1 dst_unused:UNUSED_PRESERVE src0_sel:WORD_1
s_waitcnt lgkmcnt(7)
v_mfma_f32_16x16x32_f16 v[80:83], v[220:223], v[208:211], v[224:227]
ds_read_b128 v[216:219], v248 offset:30720
ds_read_u16_d16_hi v189, v189
ds_read_u16_d16_hi v191, v191
v_and_b32 v193, s49, v193
v_bfe_u32 v192, v193, 2, 14
v_mfma_f32_16x16x32_f16 v[88:91], v[220:223], v[212:215], v[224:227]
v_exp_f16_sdwa v198, v199 dst_sel:WORD_1 dst_unused:UNUSED_PRESERVE src0_sel:WORD_1
s_waitcnt lgkmcnt(6)
v_mfma_f32_16x16x32_f16 v[84:87], v[228:231], v[208:211], v[232:235]
ds_read_b128 v[220:223], v248 offset:30976
ds_read_b128 v[224:227], v249 offset:30720
ds_read_u16_d16 v192, v192
v_lshrrev_b32 v193, 18, v193
v_mfma_f32_16x16x32_f16 v[92:95], v[228:231], v[212:215], v[232:235]
v_exp_f16_sdwa v195, v196 dst_sel:WORD_1 dst_unused:UNUSED_PRESERVE src0_sel:WORD_1
v_pk_add_f16 v201, v201, 1.0 op_sel_hi:[1,0]
v_pk_add_f16 v198, v198, 1.0 op_sel_hi:[1,0]
s_waitcnt lgkmcnt(7)
v_mfma_f32_16x16x32_bf16 v[172:175], v[236:239], v[104:107], v[172:175]
ds_read_b128 v[228:231], v249 offset:30976
ds_read_b128 v[232:235], v248 offset:34816
ds_read_u16_d16_hi v193, v193
v_pk_add_f16 v195, v195, 1.0 op_sel_hi:[1,0]
v_mfma_f32_16x16x32_bf16 v[180:183], v[236:239], v[108:111], v[180:183]
v_rcp_f16 v202, v201
s_waitcnt lgkmcnt(8)
v_mfma_f32_16x16x32_bf16 v[168:171], v[216:219], v[112:115], v[168:171]
ds_read_b128 v[236:239], v249 offset:31744
v_rcp_f16_e64 v199, v198
v_mfma_f32_16x16x32_bf16 v[176:179], v[216:219], v[116:119], v[176:179]
v_rcp_f16 v196, v195
s_waitcnt lgkmcnt(6)
v_mfma_f32_16x16x32_bf16 v[172:175], v[220:223], v[112:115], v[172:175]
ds_read_b128 v[216:219], v248 offset:35072
v_rcp_f16_sdwa v202, v201 dst_sel:WORD_1 dst_unused:UNUSED_PRESERVE src0_sel:WORD_1
v_mfma_f32_16x16x32_bf16 v[180:183], v[220:223], v[116:119], v[180:183]
v_rcp_f16_sdwa v199, v198 dst_sel:WORD_1 dst_unused:UNUSED_PRESERVE src0_sel:WORD_1
v_or_b32 v208, v184, v185
v_or_b32 v209, v186, v187
v_or_b32_e64 v210, v188, v189
v_rcp_f16_sdwa v196, v195 dst_sel:WORD_1 dst_unused:UNUSED_PRESERVE src0_sel:WORD_1
v_or_b32 v211, v190, v191
s_waitcnt lgkmcnt(2)
v_or_b32_e64 v212, v192, v193
v_pk_mul_f16 v213, v203, v202
v_pk_mul_f16 v214, v200, v199
v_pk_mul_f16 v215, v197, v196
v_mfma_f32_16x16x32_f16 v[48:51], v[224:227], v[208:211], v[48:51]
s_add_u32 s46, s68, 98304
buffer_load_dwordx4 v[244:247], v252, s[4:7], s46 offen offset:128
ds_read_b128 v[220:223], v249 offset:32000
v_cvt_pkrtz_f16_f32 v185, v168, v169
v_cvt_pkrtz_f16_f32 v187, v170, v171
v_mfma_f32_16x16x32_f16 v[56:59], v[224:227], v[212:215], v[56:59]
v_cvt_pkrtz_f16_f32 v189, v172, v173
v_cvt_pkrtz_f16_f32 v191, v174, v175
v_mfma_f32_16x16x32_f16 v[52:55], v[228:231], v[208:211], v[52:55]
ds_read_b128 v[224:227], v248 offset:35840
v_cvt_pkrtz_f16_f32 v193, v176, v177
v_cvt_pk_f16_f32 v203, v178, v179
v_mfma_f32_16x16x32_f16 v[60:63], v[228:231], v[212:215], v[60:63]
v_cvt_pk_f16_f32 v200, v180, v181
v_cvt_pk_f16_f32 v197, v182, v183
v_mfma_f32_16x16x32_bf16 v[168:171], v[232:235], v[96:99], 0
ds_read_b128 v[228:231], v249 offset:32768
v_pk_fma_f16 v202, v203, v203, s48
v_and_b32_e64 v185, s49, v185
v_mfma_f32_16x16x32_bf16 v[176:179], v[232:235], v[100:103], 0
v_pk_fma_f16 v199, v200, v200, s48
v_and_b32 v187, s49, v187
s_waitcnt lgkmcnt(3)
v_mfma_f32_16x16x32_f16 v[64:67], v[236:239], v[208:211], v[64:67]
ds_read_b128 v[232:235], v249 offset:33024
v_pk_fma_f16 v196, v197, v197, s48
s_setprio 2
v_bfe_u32 v184, v185, 2, 14
v_pk_mul_f16 v202, v203, v202
v_mfma_f32_16x16x32_f16 v[72:75], v[236:239], v[212:215], v[72:75]
v_bfe_u32 v186, v187, 2, 14
v_pk_mul_f16 v199, v200, v199
s_waitcnt vmcnt(5)
v_mfma_f32_16x16x32_bf16 v[152:155], v[18:21], v[0:3], v[152:155]
ds_read_b128 v[236:239], v248 offset:36096
ds_read_u16_d16 v184, v184
ds_read_u16_d16 v186, v186
v_lshrrev_b32_e64 v185, 18, v185
v_pk_mul_f16 v196, v197, v196
v_mfma_f32_16x16x32_bf16 v[156:159], v[16:19], v[0:3], v[156:159]
v_lshrrev_b32_e64 v187, 18, v187
v_mfma_f32_16x16x32_bf16 v[172:175], v[216:219], v[96:99], 0
ds_read_u16_d16_hi v185, v185
ds_read_u16_d16_hi v187, v187
v_exp_f16 v201, v202
v_and_b32 v189, s49, v189
v_mfma_f32_16x16x32_bf16 v[180:183], v[216:219], v[100:103], 0
v_and_b32 v191, s49, v191
s_waitcnt lgkmcnt(6)
v_mfma_f32_16x16x32_f16 v[68:71], v[220:223], v[208:211], v[68:71]
ds_read_b128 v[216:219], v248 offset:36864
v_exp_f16_e64 v198, v199
v_bfe_u32 v188, v189, 2, 14
v_mfma_f32_16x16x32_f16 v[76:79], v[220:223], v[212:215], v[76:79]
v_bfe_u32 v190, v191, 2, 14
v_exp_f16_e64 v195, v196
v_mfma_f32_16x16x32_bf16 v[168:171], v[224:227], v[104:107], v[168:171]
ds_read_b128 v[220:223], v248 offset:37120
ds_read_u16_d16 v188, v188
ds_read_u16_d16 v190, v190
v_lshrrev_b32 v189, 18, v189
v_lshrrev_b32 v191, 18, v191
v_mfma_f32_16x16x32_bf16 v[176:179], v[224:227], v[108:111], v[176:179]
v_exp_f16_sdwa v201, v202 dst_sel:WORD_1 dst_unused:UNUSED_PRESERVE src0_sel:WORD_1
v_mfma_f32_16x16x32_f16 v[80:83], v[228:231], v[208:211], v[80:83]
ds_read_b128 v[224:227], v249 offset:36864
ds_read_u16_d16_hi v189, v189
ds_read_u16_d16_hi v191, v191
v_and_b32 v193, s49, v193
v_bfe_u32 v192, v193, 2, 14
v_mfma_f32_16x16x32_f16 v[88:91], v[228:231], v[212:215], v[88:91]
v_exp_f16_sdwa v198, v199 dst_sel:WORD_1 dst_unused:UNUSED_PRESERVE src0_sel:WORD_1
s_waitcnt lgkmcnt(7)
v_mfma_f32_16x16x32_f16 v[84:87], v[232:235], v[208:211], v[84:87]
ds_read_b128 v[228:231], v249 offset:37120
ds_read_u16_d16 v192, v192
v_lshrrev_b32_e64 v193, 18, v193
v_mfma_f32_16x16x32_f16 v[92:95], v[232:235], v[212:215], v[92:95]
v_exp_f16_sdwa v195, v196 dst_sel:WORD_1 dst_unused:UNUSED_PRESERVE src0_sel:WORD_1
v_pk_add_f16 v201, v201, 1.0 op_sel_hi:[1,0]
v_pk_add_f16 v198, v198, 1.0 op_sel_hi:[1,0]
v_mfma_f32_16x16x32_bf16 v[172:175], v[236:239], v[104:107], v[172:175]
ds_read_b128 v[232:235], v248 offset:40960
ds_read_u16_d16_hi v193, v193
v_pk_add_f16 v195, v195, 1.0 op_sel_hi:[1,0]
v_mfma_f32_16x16x32_bf16 v[180:183], v[236:239], v[108:111], v[180:183]
v_rcp_f16 v202, v201
s_waitcnt lgkmcnt(7)
v_mfma_f32_16x16x32_bf16 v[168:171], v[216:219], v[112:115], v[168:171]
ds_read_b128 v[236:239], v249 offset:37888
v_rcp_f16_e64 v199, v198
v_mfma_f32_16x16x32_bf16 v[176:179], v[216:219], v[116:119], v[176:179]
v_rcp_f16_e64 v196, v195
v_mfma_f32_16x16x32_bf16 v[172:175], v[220:223], v[112:115], v[172:175]
ds_read_b128 v[216:219], v248 offset:41216
v_rcp_f16_sdwa v202, v201 dst_sel:WORD_1 dst_unused:UNUSED_PRESERVE src0_sel:WORD_1
v_mfma_f32_16x16x32_bf16 v[180:183], v[220:223], v[116:119], v[180:183]
v_rcp_f16_sdwa v199, v198 dst_sel:WORD_1 dst_unused:UNUSED_PRESERVE src0_sel:WORD_1
v_or_b32 v208, v184, v185
v_or_b32 v209, v186, v187
s_waitcnt lgkmcnt(4)
v_or_b32 v210, v188, v189
v_rcp_f16_sdwa v196, v195 dst_sel:WORD_1 dst_unused:UNUSED_PRESERVE src0_sel:WORD_1
v_or_b32 v211, v190, v191
s_waitcnt lgkmcnt(2)
v_or_b32_e64 v212, v192, v193
v_pk_mul_f16 v213, v203, v202
v_pk_mul_f16 v214, v200, v199
v_pk_mul_f16 v215, v197, v196
v_mfma_f32_16x16x32_f16 v[48:51], v[224:227], v[208:211], v[48:51]
buffer_load_dwordx4 v[0:3], v252, s[4:7], s69 offen
ds_read_b128 v[220:223], v249 offset:38144
v_cvt_pkrtz_f16_f32 v185, v168, v169
v_cvt_pkrtz_f16_f32 v187, v170, v171
v_cvt_pkrtz_f16_f32 v189, v172, v173
v_mfma_f32_16x16x32_f16 v[56:59], v[224:227], v[212:215], v[56:59]
v_cvt_pkrtz_f16_f32 v191, v174, v175
v_cvt_pkrtz_f16_f32 v193, v176, v177
v_cvt_pk_f16_f32 v203, v178, v179
v_mfma_f32_16x16x32_f16 v[52:55], v[228:231], v[208:211], v[52:55]
ds_read_b128 v[224:227], v248 offset:41984
v_cvt_pk_f16_f32 v200, v180, v181
v_cvt_pk_f16_f32 v197, v182, v183
v_pk_fma_f16 v202, v203, v203, s48
s_setprio 1
v_cvt_pk_bf16_f32 v136, v136, v137
v_mfma_f32_16x16x32_f16 v[60:63], v[228:231], v[212:215], v[60:63]
v_and_b32 v185, s49, v185
v_cvt_pk_bf16_f32 v137, v138, v139
v_pk_fma_f16 v199, v200, v200, s48
v_mfma_f32_16x16x32_bf16 v[168:171], v[232:235], v[96:99], 0
ds_read_b128 v[228:231], v249 offset:38912
v_and_b32 v187, s49, v187
v_cvt_pk_bf16_f32 v138, v140, v141
v_pk_fma_f16 v196, v197, v197, s48
v_mfma_f32_16x16x32_bf16 v[176:179], v[232:235], v[100:103], 0
v_cvt_pk_bf16_f32 v139, v142, v143
v_bfe_u32 v184, v185, 2, 14
v_pk_mul_f16 v202, v203, v202
v_cvt_pk_bf16_f32 v120, v120, v121
s_waitcnt lgkmcnt(2)
v_mfma_f32_16x16x32_f16 v[64:67], v[236:239], v[208:211], v[64:67]
ds_read_b128 v[232:235], v249 offset:39168
ds_read_u16_d16 v184, v184
v_bfe_u32 v186, v187, 2, 14
v_cvt_pk_bf16_f32 v121, v122, v123
v_pk_mul_f16 v199, v200, v199
v_mfma_f32_16x16x32_f16 v[72:75], v[236:239], v[212:215], v[72:75]
v_lshrrev_b32_e64 v185, 18, v185
v_cvt_pk_bf16_f32 v122, v124, v125
v_pk_mul_f16 v196, v197, v196
v_mfma_f32_16x16x32_bf16 v[172:175], v[216:219], v[96:99], 0
ds_read_b128 v[236:239], v248 offset:42240
ds_read_u16_d16 v186, v186
ds_read_u16_d16_hi v185, v185
v_lshrrev_b32_e64 v187, 18, v187
v_cvt_pk_bf16_f32 v123, v126, v127
v_exp_f16_e64 v201, v202
v_mfma_f32_16x16x32_bf16 v[180:183], v[216:219], v[100:103], 0
v_cvt_pk_bf16_f32 v152, v152, v153
v_and_b32_e64 v189, s49, v189
v_cvt_pk_bf16_f32 v153, v154, v155
v_mfma_f32_16x16x32_f16 v[68:71], v[220:223], v[208:211], v[68:71]
ds_read_b128 v[216:219], v248 offset:43008
ds_read_u16_d16_hi v187, v187
v_and_b32_e64 v191, s49, v191
v_cvt_pk_bf16_f32 v154, v156, v157
v_mfma_f32_16x16x32_f16 v[76:79], v[220:223], v[212:215], v[76:79]
v_exp_f16_e64 v198, v199
v_cvt_pk_bf16_f32 v155, v158, v159
s_mov_b64 vcc, s[74:75]
v_bfe_u32 v188, v189, 2, 14
v_bfe_u32 v190, v191, 2, 14
s_waitcnt lgkmcnt(5)
v_mfma_f32_16x16x32_bf16 v[168:171], v[224:227], v[104:107], v[168:171]
ds_read_b128 v[220:223], v248 offset:43264
ds_read_u16_d16 v188, v188
ds_read_u16_d16 v190, v190
v_cndmask_b32 v140, v120, v152, vcc
v_exp_f16 v195, v196
v_mfma_f32_16x16x32_bf16 v[176:179], v[224:227], v[108:111], v[176:179]
v_cndmask_b32 v141, v121, v153, vcc
v_lshrrev_b32_e64 v189, 18, v189
v_cndmask_b32 v142, v122, v154, vcc
v_mfma_f32_16x16x32_f16 v[80:83], v[228:231], v[208:211], v[80:83]
ds_read_b128 v[224:227], v249 offset:43008
ds_read_u16_d16_hi v189, v189
v_lshrrev_b32 v191, 18, v191
v_cndmask_b32 v143, v123, v155, vcc
v_exp_f16_sdwa v201, v202 dst_sel:WORD_1 dst_unused:UNUSED_PRESERVE src0_sel:WORD_1
v_mfma_f32_16x16x32_f16 v[88:91], v[228:231], v[212:215], v[88:91]
v_cndmask_b32_dpp v120, v136, v120, vcc quad_perm:[1,0,3,2] row_mask:0xf bank_mask:0xf
v_and_b32_e64 v193, s49, v193
v_cndmask_b32_dpp v121, v137, v121, vcc quad_perm:[1,0,3,2] row_mask:0xf bank_mask:0xf
v_mfma_f32_16x16x32_f16 v[84:87], v[232:235], v[208:211], v[84:87]
ds_read_b128 v[228:231], v249 offset:43264
ds_read_u16_d16_hi v191, v191
v_bfe_u32 v192, v193, 2, 14
v_exp_f16_sdwa v198, v199 dst_sel:WORD_1 dst_unused:UNUSED_PRESERVE src0_sel:WORD_1
v_mfma_f32_16x16x32_f16 v[92:95], v[232:235], v[212:215], v[92:95]
v_cndmask_b32_dpp v122, v138, v122, vcc quad_perm:[1,0,3,2] row_mask:0xf bank_mask:0xf
v_lshrrev_b32 v193, 18, v193
v_cndmask_b32_dpp v123, v139, v123, vcc quad_perm:[1,0,3,2] row_mask:0xf bank_mask:0xf
s_not_b64 vcc, s[74:75]
s_waitcnt lgkmcnt(4)
v_mfma_f32_16x16x32_bf16 v[172:175], v[236:239], v[104:107], v[172:175]
ds_read_b128 v[232:235], v248 offset:47104
ds_read_u16_d16 v192, v192
ds_read_u16_d16_hi v193, v193
v_exp_f16_sdwa v195, v196 dst_sel:WORD_1 dst_unused:UNUSED_PRESERVE src0_sel:WORD_1
v_cndmask_b32_dpp v152, v136, v152, vcc quad_perm:[1,0,3,2] row_mask:0xf bank_mask:0xf
s_setprio 0
v_pk_add_f16 v201, v201, 1.0 op_sel_hi:[1,0]
v_mfma_f32_16x16x32_bf16 v[180:183], v[236:239], v[108:111], v[180:183]
v_cndmask_b32_dpp v153, v137, v153, vcc quad_perm:[1,0,3,2] row_mask:0xf bank_mask:0xf
v_pk_add_f16 v198, v198, 1.0 op_sel_hi:[1,0]
v_cndmask_b32_dpp v154, v138, v154, vcc quad_perm:[1,0,3,2] row_mask:0xf bank_mask:0xf
v_mfma_f32_16x16x32_bf16 v[168:171], v[216:219], v[112:115], v[168:171]
ds_read_b128 v[236:239], v249 offset:44032
v_pk_add_f16 v195, v195, 1.0 op_sel_hi:[1,0]
v_rcp_f16_e64 v202, v201
v_cndmask_b32_dpp v155, v139, v155, vcc quad_perm:[1,0,3,2] row_mask:0xf bank_mask:0xf
v_mfma_f32_16x16x32_bf16 v[176:179], v[216:219], v[116:119], v[176:179]
v_rcp_f16_e64 v199, v198
v_mfma_f32_16x16x32_bf16 v[172:175], v[220:223], v[112:115], v[172:175]
ds_read_b128 v[216:219], v248 offset:47360
buffer_store_dwordx4 v[120:123], v255, s[8:11], s68 offen sc1
v_rcp_f16_e64 v196, v195
v_rcp_f16_sdwa v202, v201 dst_sel:WORD_1 dst_unused:UNUSED_PRESERVE src0_sel:WORD_1
v_mfma_f32_16x16x32_bf16 v[180:183], v[220:223], v[116:119], v[180:183]
v_rcp_f16_sdwa v199, v198 dst_sel:WORD_1 dst_unused:UNUSED_PRESERVE src0_sel:WORD_1
v_or_b32 v208, v184, v185
v_or_b32 v209, v186, v187
s_waitcnt lgkmcnt(2)
v_or_b32 v210, v188, v189
v_rcp_f16_sdwa v196, v195 dst_sel:WORD_1 dst_unused:UNUSED_PRESERVE src0_sel:WORD_1
v_or_b32_e64 v211, v190, v191
v_or_b32 v212, v192, v193
v_pk_mul_f16 v213, v203, v202
v_pk_mul_f16 v214, v200, v199
v_pk_mul_f16 v215, v197, v196
s_setprio 3
v_mfma_f32_16x16x32_f16 v[48:51], v[224:227], v[208:211], v[48:51]
buffer_load_dwordx4 v[204:207], v252, s[4:7], s69 offen offset:64
ds_read_b128 v[220:223], v249 offset:44288
v_cvt_pkrtz_f16_f32 v185, v168, v169
v_cvt_pkrtz_f16_f32 v187, v170, v171
v_mfma_f32_16x16x32_f16 v[56:59], v[224:227], v[212:215], v[56:59]
v_cvt_pkrtz_f16_f32 v189, v172, v173
v_cvt_pkrtz_f16_f32 v191, v174, v175
v_mfma_f32_16x16x32_f16 v[52:55], v[228:231], v[208:211], v[52:55]
ds_read_b128 v[224:227], v248 offset:48128
v_cvt_pkrtz_f16_f32 v193, v176, v177
v_cvt_pk_f16_f32 v203, v178, v179
v_mfma_f32_16x16x32_f16 v[60:63], v[228:231], v[212:215], v[60:63]
v_cvt_pk_f16_f32 v200, v180, v181
v_cvt_pk_f16_f32 v197, v182, v183
v_mfma_f32_16x16x32_bf16 v[168:171], v[232:235], v[96:99], 0
ds_read_b128 v[228:231], v249 offset:45056
v_pk_fma_f16 v202, v203, v203, s48
v_and_b32_e64 v185, s49, v185
v_mfma_f32_16x16x32_bf16 v[176:179], v[232:235], v[100:103], 0
v_pk_fma_f16 v199, v200, v200, s48
v_and_b32 v187, s49, v187
s_waitcnt lgkmcnt(3)
v_mfma_f32_16x16x32_f16 v[64:67], v[236:239], v[208:211], v[64:67]
ds_read_b128 v[232:235], v249 offset:45312
v_pk_fma_f16 v196, v197, v197, s48
v_bfe_u32 v184, v185, 2, 14
v_pk_mul_f16 v202, v203, v202
v_mfma_f32_16x16x32_f16 v[72:75], v[236:239], v[212:215], v[72:75]
v_bfe_u32 v186, v187, 2, 14
v_pk_mul_f16 v199, v200, v199
s_waitcnt vmcnt(7)
v_mfma_f32_16x16x32_bf16 v[128:131], v[18:21], v[4:7], v[128:131]
ds_read_b128 v[236:239], v248 offset:48384
ds_read_u16_d16 v184, v184
ds_read_u16_d16 v186, v186
v_lshrrev_b32 v185, 18, v185
v_pk_mul_f16 v196, v197, v196
v_mfma_f32_16x16x32_bf16 v[132:135], v[16:19], v[4:7], v[132:135]
v_lshrrev_b32_e64 v187, 18, v187
v_mfma_f32_16x16x32_bf16 v[172:175], v[216:219], v[96:99], 0
ds_read_u16_d16_hi v185, v185
ds_read_u16_d16_hi v187, v187
v_exp_f16 v201, v202
v_and_b32 v189, s49, v189
v_mfma_f32_16x16x32_bf16 v[180:183], v[216:219], v[100:103], 0
v_and_b32 v191, s49, v191
s_waitcnt lgkmcnt(6)
v_mfma_f32_16x16x32_f16 v[68:71], v[220:223], v[208:211], v[68:71]
ds_read_b128 v[216:219], v248 offset:49152
v_exp_f16_e64 v198, v199
v_bfe_u32 v188, v189, 2, 14
v_mfma_f32_16x16x32_f16 v[76:79], v[220:223], v[212:215], v[76:79]
v_bfe_u32 v190, v191, 2, 14
v_exp_f16_e64 v195, v196
v_mfma_f32_16x16x32_bf16 v[168:171], v[224:227], v[104:107], v[168:171]
buffer_store_dwordx4 v[140:143], v255, s[8:11], s68 offen offset:128 sc1
ds_read_b128 v[220:223], v248 offset:49408
ds_read_u16_d16 v188, v188
ds_read_u16_d16 v190, v190
v_lshrrev_b32 v189, 18, v189
v_lshrrev_b32 v191, 18, v191
v_mfma_f32_16x16x32_bf16 v[176:179], v[224:227], v[108:111], v[176:179]
v_exp_f16_sdwa v201, v202 dst_sel:WORD_1 dst_unused:UNUSED_PRESERVE src0_sel:WORD_1
v_mfma_f32_16x16x32_f16 v[80:83], v[228:231], v[208:211], v[80:83]
ds_read_b128 v[224:227], v249 offset:49152
ds_read_u16_d16_hi v189, v189
ds_read_u16_d16_hi v191, v191
v_and_b32 v193, s49, v193
v_bfe_u32 v192, v193, 2, 14
v_mfma_f32_16x16x32_f16 v[88:91], v[228:231], v[212:215], v[88:91]
v_exp_f16_sdwa v198, v199 dst_sel:WORD_1 dst_unused:UNUSED_PRESERVE src0_sel:WORD_1
s_waitcnt lgkmcnt(7)
v_mfma_f32_16x16x32_f16 v[84:87], v[232:235], v[208:211], v[84:87]
ds_read_b128 v[228:231], v249 offset:49408
ds_read_u16_d16 v192, v192
v_lshrrev_b32_e64 v193, 18, v193
v_mfma_f32_16x16x32_f16 v[92:95], v[232:235], v[212:215], v[92:95]
v_exp_f16_sdwa v195, v196 dst_sel:WORD_1 dst_unused:UNUSED_PRESERVE src0_sel:WORD_1
v_pk_add_f16 v201, v201, 1.0 op_sel_hi:[1,0]
v_pk_add_f16 v198, v198, 1.0 op_sel_hi:[1,0]
v_mfma_f32_16x16x32_bf16 v[172:175], v[236:239], v[104:107], v[172:175]
ds_read_b128 v[232:235], v248 offset:53248
ds_read_u16_d16_hi v193, v193
v_pk_add_f16 v195, v195, 1.0 op_sel_hi:[1,0]
v_mfma_f32_16x16x32_bf16 v[180:183], v[236:239], v[108:111], v[180:183]
v_rcp_f16 v202, v201
s_waitcnt lgkmcnt(7)
v_mfma_f32_16x16x32_bf16 v[168:171], v[216:219], v[112:115], v[168:171]
ds_read_b128 v[236:239], v249 offset:50176
v_rcp_f16_e64 v199, v198
v_mfma_f32_16x16x32_bf16 v[176:179], v[216:219], v[116:119], v[176:179]
v_rcp_f16_e64 v196, v195
v_mfma_f32_16x16x32_bf16 v[172:175], v[220:223], v[112:115], v[172:175]
ds_read_b128 v[216:219], v248 offset:53504
v_rcp_f16_sdwa v202, v201 dst_sel:WORD_1 dst_unused:UNUSED_PRESERVE src0_sel:WORD_1
v_mfma_f32_16x16x32_bf16 v[180:183], v[220:223], v[116:119], v[180:183]
v_rcp_f16_sdwa v199, v198 dst_sel:WORD_1 dst_unused:UNUSED_PRESERVE src0_sel:WORD_1
v_or_b32 v208, v184, v185
v_or_b32 v209, v186, v187
s_waitcnt lgkmcnt(4)
v_or_b32 v210, v188, v189
v_rcp_f16_sdwa v196, v195 dst_sel:WORD_1 dst_unused:UNUSED_PRESERVE src0_sel:WORD_1
v_or_b32 v211, v190, v191
s_waitcnt lgkmcnt(2)
v_or_b32_e64 v212, v192, v193
v_pk_mul_f16 v213, v203, v202
v_pk_mul_f16 v214, v200, v199
v_pk_mul_f16 v215, v197, v196
v_mfma_f32_16x16x32_f16 v[48:51], v[224:227], v[208:211], v[48:51]
buffer_load_dwordx4 v[4:7], v252, s[4:7], s69 offen offset:128
ds_read_b128 v[220:223], v249 offset:50432
v_cvt_pkrtz_f16_f32 v185, v168, v169
v_cvt_pkrtz_f16_f32 v187, v170, v171
v_mfma_f32_16x16x32_f16 v[56:59], v[224:227], v[212:215], v[56:59]
v_cvt_pkrtz_f16_f32 v189, v172, v173
v_cvt_pkrtz_f16_f32 v191, v174, v175
v_mfma_f32_16x16x32_f16 v[52:55], v[228:231], v[208:211], v[52:55]
ds_read_b128 v[224:227], v248 offset:54272
v_cvt_pkrtz_f16_f32 v193, v176, v177
v_cvt_pk_f16_f32 v203, v178, v179
v_mfma_f32_16x16x32_f16 v[60:63], v[228:231], v[212:215], v[60:63]
v_cvt_pk_f16_f32 v200, v180, v181
v_cvt_pk_f16_f32 v197, v182, v183
v_mfma_f32_16x16x32_bf16 v[168:171], v[232:235], v[96:99], 0
ds_read_b128 v[228:231], v249 offset:51200
v_pk_fma_f16 v202, v203, v203, s48
v_and_b32_e64 v185, s49, v185
v_mfma_f32_16x16x32_bf16 v[176:179], v[232:235], v[100:103], 0
v_pk_fma_f16 v199, v200, v200, s48
v_and_b32 v187, s49, v187
s_waitcnt lgkmcnt(3)
v_mfma_f32_16x16x32_f16 v[64:67], v[236:239], v[208:211], v[64:67]
ds_read_b128 v[232:235], v249 offset:51456
v_pk_fma_f16 v196, v197, v197, s48
s_setprio 2
v_bfe_u32 v184, v185, 2, 14
v_pk_mul_f16 v202, v203, v202
v_mfma_f32_16x16x32_f16 v[72:75], v[236:239], v[212:215], v[72:75]
v_bfe_u32 v186, v187, 2, 14
v_pk_mul_f16 v199, v200, v199
s_waitcnt vmcnt(7)
v_mfma_f32_16x16x32_bf16 v[144:147], v[18:21], v[44:47], v[144:147]
ds_read_b128 v[236:239], v248 offset:54528
ds_read_u16_d16 v184, v184
ds_read_u16_d16 v186, v186
v_lshrrev_b32_e64 v185, 18, v185
v_pk_mul_f16 v196, v197, v196
v_mfma_f32_16x16x32_bf16 v[148:151], v[16:19], v[44:47], v[148:151]
v_lshrrev_b32_e64 v187, 18, v187
v_mfma_f32_16x16x32_bf16 v[172:175], v[216:219], v[96:99], 0
ds_read_u16_d16_hi v185, v185
ds_read_u16_d16_hi v187, v187
v_exp_f16 v201, v202
v_and_b32 v189, s49, v189
v_mfma_f32_16x16x32_bf16 v[180:183], v[216:219], v[100:103], 0
v_and_b32 v191, s49, v191
s_waitcnt lgkmcnt(6)
v_mfma_f32_16x16x32_f16 v[68:71], v[220:223], v[208:211], v[68:71]
ds_read_b128 v[216:219], v248 offset:55296
v_exp_f16_e64 v198, v199
v_bfe_u32 v188, v189, 2, 14
v_mfma_f32_16x16x32_f16 v[76:79], v[220:223], v[212:215], v[76:79]
v_bfe_u32 v190, v191, 2, 14
v_exp_f16_e64 v195, v196
v_mfma_f32_16x16x32_bf16 v[168:171], v[224:227], v[104:107], v[168:171]
ds_read_b128 v[220:223], v248 offset:55552
ds_read_u16_d16 v188, v188
ds_read_u16_d16 v190, v190
v_lshrrev_b32 v189, 18, v189
v_lshrrev_b32 v191, 18, v191
v_mfma_f32_16x16x32_bf16 v[176:179], v[224:227], v[108:111], v[176:179]
v_exp_f16_sdwa v201, v202 dst_sel:WORD_1 dst_unused:UNUSED_PRESERVE src0_sel:WORD_1
v_mfma_f32_16x16x32_f16 v[80:83], v[228:231], v[208:211], v[80:83]
ds_read_b128 v[224:227], v249 offset:55296
ds_read_u16_d16_hi v189, v189
ds_read_u16_d16_hi v191, v191
v_and_b32 v193, s49, v193
v_bfe_u32 v192, v193, 2, 14
v_mfma_f32_16x16x32_f16 v[88:91], v[228:231], v[212:215], v[88:91]
v_exp_f16_sdwa v198, v199 dst_sel:WORD_1 dst_unused:UNUSED_PRESERVE src0_sel:WORD_1
s_waitcnt lgkmcnt(7)
v_mfma_f32_16x16x32_f16 v[84:87], v[232:235], v[208:211], v[84:87]
ds_read_b128 v[228:231], v249 offset:55552
ds_read_u16_d16 v192, v192
v_lshrrev_b32_e64 v193, 18, v193
v_mfma_f32_16x16x32_f16 v[92:95], v[232:235], v[212:215], v[92:95]
v_exp_f16_sdwa v195, v196 dst_sel:WORD_1 dst_unused:UNUSED_PRESERVE src0_sel:WORD_1
v_pk_add_f16 v201, v201, 1.0 op_sel_hi:[1,0]
v_pk_add_f16 v198, v198, 1.0 op_sel_hi:[1,0]
v_mfma_f32_16x16x32_bf16 v[172:175], v[236:239], v[104:107], v[172:175]
ds_read_b128 v[232:235], v248 offset:59392
ds_read_u16_d16_hi v193, v193
v_pk_add_f16 v195, v195, 1.0 op_sel_hi:[1,0]
v_mfma_f32_16x16x32_bf16 v[180:183], v[236:239], v[108:111], v[180:183]
v_rcp_f16 v202, v201
s_waitcnt lgkmcnt(7)
v_mfma_f32_16x16x32_bf16 v[168:171], v[216:219], v[112:115], v[168:171]
ds_read_b128 v[236:239], v249 offset:56320
v_rcp_f16_e64 v199, v198
v_mfma_f32_16x16x32_bf16 v[176:179], v[216:219], v[116:119], v[176:179]
v_rcp_f16_e64 v196, v195
v_mfma_f32_16x16x32_bf16 v[172:175], v[220:223], v[112:115], v[172:175]
ds_read_b128 v[216:219], v248 offset:59648
v_rcp_f16_sdwa v202, v201 dst_sel:WORD_1 dst_unused:UNUSED_PRESERVE src0_sel:WORD_1
v_mfma_f32_16x16x32_bf16 v[180:183], v[220:223], v[116:119], v[180:183]
v_rcp_f16_sdwa v199, v198 dst_sel:WORD_1 dst_unused:UNUSED_PRESERVE src0_sel:WORD_1
v_or_b32 v208, v184, v185
v_or_b32 v209, v186, v187
s_waitcnt lgkmcnt(4)
v_or_b32 v210, v188, v189
v_rcp_f16_sdwa v196, v195 dst_sel:WORD_1 dst_unused:UNUSED_PRESERVE src0_sel:WORD_1
v_or_b32 v211, v190, v191
s_waitcnt lgkmcnt(2)
v_or_b32_e64 v212, v192, v193
v_pk_mul_f16 v213, v203, v202
v_pk_mul_f16 v214, v200, v199
v_pk_mul_f16 v215, v197, v196
v_mfma_f32_16x16x32_f16 v[48:51], v[224:227], v[208:211], v[48:51]
s_add_u32 s46, s69, 98304
buffer_load_dwordx4 v[44:47], v252, s[4:7], s46 offen
ds_read_b128 v[220:223], v249 offset:56576
v_cvt_pkrtz_f16_f32 v185, v168, v169
v_cvt_pkrtz_f16_f32 v187, v170, v171
v_mfma_f32_16x16x32_f16 v[56:59], v[224:227], v[212:215], v[56:59]
v_cvt_pkrtz_f16_f32 v189, v172, v173
v_cvt_pkrtz_f16_f32 v191, v174, v175
v_mfma_f32_16x16x32_f16 v[52:55], v[228:231], v[208:211], v[52:55]
ds_read_b128 v[224:227], v248 offset:60416
v_cvt_pkrtz_f16_f32 v193, v176, v177
v_cvt_pk_f16_f32 v203, v178, v179
v_cvt_pk_f16_f32 v200, v180, v181
v_mfma_f32_16x16x32_f16 v[60:63], v[228:231], v[212:215], v[60:63]
v_cvt_pk_f16_f32 v197, v182, v183
s_setprio 1
v_pk_fma_f16 v202, v203, v203, s48
v_mfma_f32_16x16x32_bf16 v[168:171], v[232:235], v[96:99], 0
ds_read_b128 v[228:231], v249 offset:57344
v_and_b32 v185, s49, v185
v_pk_fma_f16 v199, v200, v200, s48
v_mfma_f32_16x16x32_bf16 v[176:179], v[232:235], v[100:103], 0
v_and_b32 v187, s49, v187
v_pk_fma_f16 v196, v197, v197, s48
v_bfe_u32 v184, v185, 2, 14
s_waitcnt lgkmcnt(3)
v_mfma_f32_16x16x32_f16 v[64:67], v[236:239], v[208:211], v[64:67]
ds_read_b128 v[232:235], v249 offset:57600
ds_read_u16_d16 v184, v184
v_pk_mul_f16 v202, v203, v202
v_bfe_u32 v186, v187, 2, 14
v_mfma_f32_16x16x32_f16 v[72:75], v[236:239], v[212:215], v[72:75]
v_pk_mul_f16 v199, v200, v199
v_lshrrev_b32_e64 v185, 18, v185
v_mfma_f32_16x16x32_bf16 v[172:175], v[216:219], v[96:99], 0
ds_read_b128 v[236:239], v248 offset:60672
ds_read_u16_d16 v186, v186
ds_read_u16_d16_hi v185, v185
v_pk_mul_f16 v196, v197, v196
v_lshrrev_b32_e64 v187, 18, v187
v_mfma_f32_16x16x32_bf16 v[180:183], v[216:219], v[100:103], 0
v_exp_f16_e64 v201, v202
v_and_b32 v189, s49, v189
s_waitcnt lgkmcnt(5)
v_mfma_f32_16x16x32_f16 v[68:71], v[220:223], v[208:211], v[68:71]
ds_read_b128 v[216:219], v248 offset:61440
ds_read_u16_d16_hi v187, v187
v_and_b32_e64 v191, s49, v191
v_mfma_f32_16x16x32_f16 v[76:79], v[220:223], v[212:215], v[76:79]
v_exp_f16_e64 v198, v199
v_bfe_u32 v188, v189, 2, 14
v_bfe_u32 v190, v191, 2, 14
v_mfma_f32_16x16x32_bf16 v[168:171], v[224:227], v[104:107], v[168:171]
buffer_store_dwordx4 v[152:155], v255, s[8:11], s68 offen offset:256 sc1
ds_read_b128 v[220:223], v248 offset:61696
ds_read_u16_d16 v188, v188
ds_read_u16_d16 v190, v190
v_exp_f16_e64 v195, v196
v_mfma_f32_16x16x32_bf16 v[176:179], v[224:227], v[108:111], v[176:179]
v_lshrrev_b32 v189, 18, v189
v_lshrrev_b32 v191, 18, v191
v_mfma_f32_16x16x32_f16 v[80:83], v[228:231], v[208:211], v[80:83]
ds_read_b128 v[224:227], v249 offset:61440
ds_read_u16_d16_hi v189, v189
ds_read_u16_d16_hi v191, v191
v_exp_f16_sdwa v201, v202 dst_sel:WORD_1 dst_unused:UNUSED_PRESERVE src0_sel:WORD_1
v_and_b32 v193, s49, v193
v_mfma_f32_16x16x32_f16 v[88:91], v[228:231], v[212:215], v[88:91]
v_bfe_u32 v192, v193, 2, 14
s_waitcnt lgkmcnt(8)
v_mfma_f32_16x16x32_f16 v[84:87], v[232:235], v[208:211], v[84:87]
ds_read_b128 v[228:231], v249 offset:61696
ds_read_u16_d16 v192, v192
v_exp_f16_sdwa v198, v199 dst_sel:WORD_1 dst_unused:UNUSED_PRESERVE src0_sel:WORD_1
v_lshrrev_b32_e64 v193, 18, v193
v_mfma_f32_16x16x32_f16 v[92:95], v[232:235], v[212:215], v[92:95]
v_exp_f16_sdwa v195, v196 dst_sel:WORD_1 dst_unused:UNUSED_PRESERVE src0_sel:WORD_1
v_pk_add_f16 v201, v201, 1.0 op_sel_hi:[1,0]
v_mfma_f32_16x16x32_bf16 v[172:175], v[236:239], v[104:107], v[172:175]
ds_read_b128 v[232:235], v249
ds_read_u16_d16_hi v193, v193
v_pk_add_f16 v198, v198, 1.0 op_sel_hi:[1,0]
v_pk_add_f16 v195, v195, 1.0 op_sel_hi:[1,0]
v_mfma_f32_16x16x32_bf16 v[180:183], v[236:239], v[108:111], v[180:183]
v_rcp_f16_e64 v202, v201
s_setprio 0
s_waitcnt lgkmcnt(7)
v_mfma_f32_16x16x32_bf16 v[168:171], v[216:219], v[112:115], v[168:171]
ds_read_b128 v[236:239], v249 offset:62464
v_rcp_f16_e64 v199, v198
v_mfma_f32_16x16x32_bf16 v[176:179], v[216:219], v[116:119], v[176:179]
v_rcp_f16_e64 v196, v195
v_mfma_f32_16x16x32_bf16 v[172:175], v[220:223], v[112:115], v[172:175]
ds_read_b128 v[216:219], v249 offset:256
v_rcp_f16_sdwa v202, v201 dst_sel:WORD_1 dst_unused:UNUSED_PRESERVE src0_sel:WORD_1
v_mfma_f32_16x16x32_bf16 v[180:183], v[220:223], v[116:119], v[180:183]
v_rcp_f16_sdwa v199, v198 dst_sel:WORD_1 dst_unused:UNUSED_PRESERVE src0_sel:WORD_1
v_or_b32 v208, v184, v185
v_or_b32 v209, v186, v187
s_waitcnt lgkmcnt(4)
v_or_b32 v210, v188, v189
v_rcp_f16_sdwa v196, v195 dst_sel:WORD_1 dst_unused:UNUSED_PRESERVE src0_sel:WORD_1
v_or_b32 v211, v190, v191
s_waitcnt lgkmcnt(2)
v_or_b32_e64 v212, v192, v193
v_pk_mul_f16 v213, v203, v202
v_pk_mul_f16 v214, v200, v199
v_pk_mul_f16 v215, v197, v196
v_mfma_f32_16x16x32_f16 v[48:51], v[224:227], v[208:211], v[48:51]
s_add_u32 s46, s69, 98304
buffer_load_dwordx4 v[40:43], v252, s[4:7], s46 offen offset:64
ds_read_b128 v[220:223], v249 offset:62720
v_cvt_pkrtz_f16_f32 v185, v168, v169
v_cvt_pkrtz_f16_f32 v187, v170, v171
v_mfma_f32_16x16x32_f16 v[56:59], v[224:227], v[212:215], v[56:59]
v_cvt_pkrtz_f16_f32 v189, v172, v173
v_cvt_pkrtz_f16_f32 v191, v174, v175
v_mfma_f32_16x16x32_f16 v[52:55], v[228:231], v[208:211], v[52:55]
ds_read_b128 v[224:227], v249 offset:1024
v_cvt_pkrtz_f16_f32 v193, v176, v177
v_cvt_pk_f16_f32 v203, v178, v179
v_mfma_f32_16x16x32_f16 v[60:63], v[228:231], v[212:215], v[60:63]
v_cvt_pk_f16_f32 v200, v180, v181
v_cvt_pk_f16_f32 v197, v182, v183
v_mfma_f32_16x16x32_bf16 v[168:171], v[232:235], v[96:99], 0
ds_read_b128 v[228:231], v249 offset:63488
v_pk_fma_f16 v202, v203, v203, s48
v_and_b32_e64 v185, s49, v185
v_mfma_f32_16x16x32_bf16 v[176:179], v[232:235], v[100:103], 0
v_pk_fma_f16 v199, v200, v200, s48
v_and_b32 v187, s49, v187
s_waitcnt lgkmcnt(3)
v_mfma_f32_16x16x32_f16 v[64:67], v[236:239], v[208:211], v[64:67]
ds_read_b128 v[232:235], v249 offset:63744
v_pk_fma_f16 v196, v197, v197, s48
v_bfe_u32 v184, v185, 2, 14
v_mfma_f32_16x16x32_f16 v[72:75], v[236:239], v[212:215], v[72:75]
v_pk_mul_f16 v202, v203, v202
v_bfe_u32 v186, v187, 2, 14
s_waitcnt vmcnt(8)
v_mfma_f32_16x16x32_bf16 v[160:163], v[18:21], v[244:247], v[160:163]
ds_read_b128 v[236:239], v249 offset:1280
ds_read_u16_d16 v184, v184
ds_read_u16_d16 v186, v186
v_pk_mul_f16 v199, v200, v199
v_lshrrev_b32 v185, 18, v185
v_mfma_f32_16x16x32_bf16 v[164:167], v[16:19], v[244:247], v[164:167]
v_pk_mul_f16 v196, v197, v196
v_lshrrev_b32_e64 v187, 18, v187
v_mfma_f32_16x16x32_bf16 v[172:175], v[216:219], v[96:99], 0
ds_read_u16_d16_hi v185, v185
ds_read_u16_d16_hi v187, v187
v_exp_f16_e64 v201, v202
v_mfma_f32_16x16x32_bf16 v[180:183], v[216:219], v[100:103], 0
v_and_b32_e64 v189, s49, v189
v_and_b32 v191, s49, v191
s_waitcnt lgkmcnt(6)
v_mfma_f32_16x16x32_f16 v[68:71], v[220:223], v[208:211], v[68:71]
ds_read_b128 v[216:219], v249 offset:2048
v_exp_f16_e64 v198, v199
v_mfma_f32_16x16x32_f16 v[76:79], v[220:223], v[212:215], v[76:79]
v_bfe_u32 v188, v189, 2, 14
v_bfe_u32 v190, v191, 2, 14
v_mfma_f32_16x16x32_bf16 v[168:171], v[224:227], v[104:107], v[168:171]
ds_read_b128 v[220:223], v249 offset:2304
ds_read_u16_d16 v188, v188
ds_read_u16_d16 v190, v190
v_exp_f16_e64 v195, v196
v_mfma_f32_16x16x32_bf16 v[176:179], v[224:227], v[108:111], v[176:179]
v_lshrrev_b32 v189, 18, v189
v_lshrrev_b32 v191, 18, v191
v_mfma_f32_16x16x32_f16 v[80:83], v[228:231], v[208:211], v[80:83]
ds_read_b128 v[224:227], v250 offset:2048
ds_read_u16_d16_hi v189, v189
ds_read_u16_d16_hi v191, v191
v_exp_f16_sdwa v201, v202 dst_sel:WORD_1 dst_unused:UNUSED_PRESERVE src0_sel:WORD_1
v_mfma_f32_16x16x32_f16 v[88:91], v[228:231], v[212:215], v[88:91]
v_and_b32 v193, s49, v193
v_bfe_u32 v192, v193, 2, 14
s_waitcnt lgkmcnt(7)
v_mfma_f32_16x16x32_f16 v[84:87], v[232:235], v[208:211], v[84:87]
ds_read_b128 v[228:231], v250 offset:2304
ds_read_u16_d16 v192, v192
v_exp_f16_sdwa v198, v199 dst_sel:WORD_1 dst_unused:UNUSED_PRESERVE src0_sel:WORD_1
v_mfma_f32_16x16x32_f16 v[92:95], v[232:235], v[212:215], v[92:95]
v_lshrrev_b32 v193, 18, v193
s_waitcnt vmcnt(7)
v_mfma_f32_16x16x32_bf16 v[48:51], v[18:21], v[0:3], v[48:51]
ds_read_b128 v[232:235], v249 offset:6144
ds_read_u16_d16_hi v193, v193
v_exp_f16_sdwa v195, v196 dst_sel:WORD_1 dst_unused:UNUSED_PRESERVE src0_sel:WORD_1
v_pk_add_f16 v201, v201, 1.0 op_sel_hi:[1,0]
v_mfma_f32_16x16x32_bf16 v[52:55], v[16:19], v[0:3], v[52:55]
v_pk_add_f16 v198, v198, 1.0 op_sel_hi:[1,0]
v_pk_add_f16 v195, v195, 1.0 op_sel_hi:[1,0]
v_mfma_f32_16x16x32_bf16 v[172:175], v[236:239], v[104:107], v[172:175]
v_rcp_f16_e64 v202, v201
v_mfma_f32_16x16x32_bf16 v[180:183], v[236:239], v[108:111], v[180:183]
v_rcp_f16 v199, v198
s_waitcnt lgkmcnt(4)
v_mfma_f32_16x16x32_bf16 v[168:171], v[216:219], v[112:115], v[168:171]
ds_read_b128 v[236:239], v250 offset:3072
v_rcp_f16_e64 v196, v195
v_mfma_f32_16x16x32_bf16 v[176:179], v[216:219], v[116:119], v[176:179]
v_rcp_f16_sdwa v202, v201 dst_sel:WORD_1 dst_unused:UNUSED_PRESERVE src0_sel:WORD_1
v_mfma_f32_16x16x32_bf16 v[172:175], v[220:223], v[112:115], v[172:175]
ds_read_b128 v[216:219], v249 offset:6400
v_rcp_f16_sdwa v199, v198 dst_sel:WORD_1 dst_unused:UNUSED_PRESERVE src0_sel:WORD_1
v_mfma_f32_16x16x32_bf16 v[180:183], v[220:223], v[116:119], v[180:183]
v_or_b32 v208, v184, v185
v_or_b32 v209, v186, v187
v_or_b32_e64 v210, v188, v189
v_rcp_f16_sdwa v196, v195 dst_sel:WORD_1 dst_unused:UNUSED_PRESERVE src0_sel:WORD_1
v_or_b32 v211, v190, v191
s_waitcnt lgkmcnt(2)
v_or_b32_e64 v212, v192, v193
v_pk_mul_f16 v213, v203, v202
v_pk_mul_f16 v214, v200, v199
v_pk_mul_f16 v215, v197, v196
v_mfma_f32_16x16x32_f16 v[48:51], v[224:227], v[208:211], v[48:51]
s_add_u32 s46, s69, 98304
buffer_load_dwordx4 v[0:3], v252, s[4:7], s46 offen offset:128
ds_read_b128 v[220:223], v250 offset:3328
v_cvt_pkrtz_f16_f32 v185, v168, v169
v_cvt_pkrtz_f16_f32 v187, v170, v171
v_cvt_pkrtz_f16_f32 v189, v172, v173
v_mfma_f32_16x16x32_f16 v[56:59], v[224:227], v[212:215], v[56:59]
v_cvt_pkrtz_f16_f32 v191, v174, v175
v_cvt_pkrtz_f16_f32 v193, v176, v177
v_cvt_pk_f16_f32 v203, v178, v179
v_mfma_f32_16x16x32_f16 v[52:55], v[228:231], v[208:211], v[52:55]
ds_read_b128 v[224:227], v249 offset:7168
v_cvt_pk_f16_f32 v200, v180, v181
v_cvt_pk_f16_f32 v197, v182, v183
v_pk_fma_f16 v202, v203, v203, s48
v_mfma_f32_16x16x32_f16 v[60:63], v[228:231], v[212:215], v[60:63]
v_cvt_pk_bf16_f32 v144, v144, v145
v_and_b32_e64 v185, s49, v185
v_cvt_pk_bf16_f32 v145, v146, v147
v_mfma_f32_16x16x32_bf16 v[168:171], v[232:235], v[96:99], 0
ds_read_b128 v[228:231], v250 offset:4096
v_pk_fma_f16 v199, v200, v200, s48
v_and_b32 v187, s49, v187
v_cvt_pk_bf16_f32 v146, v148, v149
v_mfma_f32_16x16x32_bf16 v[176:179], v[232:235], v[100:103], 0
v_pk_fma_f16 v196, v197, v197, s48
v_cvt_pk_bf16_f32 v147, v150, v151
v_bfe_u32 v184, v185, 2, 14
s_waitcnt lgkmcnt(2)
v_mfma_f32_16x16x32_f16 v[64:67], v[236:239], v[208:211], v[64:67]
ds_read_b128 v[232:235], v250 offset:4352
ds_read_u16_d16 v184, v184
v_pk_mul_f16 v202, v203, v202
v_cvt_pk_bf16_f32 v128, v128, v129
v_bfe_u32 v186, v187, 2, 14
v_mfma_f32_16x16x32_f16 v[72:75], v[236:239], v[212:215], v[72:75]
v_cvt_pk_bf16_f32 v129, v130, v131
v_pk_mul_f16 v199, v200, v199
v_lshrrev_b32 v185, 18, v185
s_waitcnt vmcnt(6)
v_mfma_f32_16x16x32_bf16 v[64:67], v[18:21], v[204:207], v[64:67]
ds_read_b128 v[236:239], v249 offset:7424
ds_read_u16_d16 v186, v186
ds_read_u16_d16_hi v185, v185
v_cvt_pk_bf16_f32 v130, v132, v133
v_pk_mul_f16 v196, v197, v196
v_lshrrev_b32_e64 v187, 18, v187
v_mfma_f32_16x16x32_bf16 v[68:71], v[16:19], v[204:207], v[68:71]
v_cvt_pk_bf16_f32 v131, v134, v135
v_exp_f16_e64 v201, v202
v_mfma_f32_16x16x32_bf16 v[172:175], v[216:219], v[96:99], 0
ds_read_u16_d16_hi v187, v187
v_cvt_pk_bf16_f32 v160, v160, v161
v_and_b32_e64 v189, s49, v189
v_cvt_pk_bf16_f32 v161, v162, v163
v_mfma_f32_16x16x32_bf16 v[180:183], v[216:219], v[100:103], 0
v_and_b32_e64 v191, s49, v191
v_cvt_pk_bf16_f32 v162, v164, v165
v_mfma_f32_16x16x32_f16 v[68:71], v[220:223], v[208:211], v[68:71]
ds_read_b128 v[216:219], v249 offset:8192
v_exp_f16 v198, v199
v_cvt_pk_bf16_f32 v163, v166, v167
s_mov_b64 vcc, s[74:75]
v_bfe_u32 v188, v189, 2, 14
v_bfe_u32 v190, v191, 2, 14
v_mfma_f32_16x16x32_f16 v[76:79], v[220:223], v[212:215], v[76:79]
v_cndmask_b32 v148, v128, v160, vcc
v_exp_f16_e64 v195, v196
s_waitcnt lgkmcnt(2)
v_mfma_f32_16x16x32_bf16 v[168:171], v[224:227], v[104:107], v[168:171]
ds_read_b128 v[220:223], v249 offset:8448
ds_read_u16_d16 v188, v188
ds_read_u16_d16 v190, v190
v_cndmask_b32 v149, v129, v161, vcc
v_lshrrev_b32_e64 v189, 18, v189
v_cndmask_b32 v150, v130, v162, vcc
v_mfma_f32_16x16x32_bf16 v[176:179], v[224:227], v[108:111], v[176:179]
v_lshrrev_b32 v191, 18, v191
v_cndmask_b32 v151, v131, v163, vcc
v_mfma_f32_16x16x32_f16 v[80:83], v[228:231], v[208:211], v[80:83]
ds_read_b128 v[224:227], v250 offset:8192
ds_read_u16_d16_hi v189, v189
ds_read_u16_d16_hi v191, v191
v_exp_f16_sdwa v201, v202 dst_sel:WORD_1 dst_unused:UNUSED_PRESERVE src0_sel:WORD_1
v_cndmask_b32_dpp v128, v144, v128, vcc quad_perm:[1,0,3,2] row_mask:0xf bank_mask:0xf
v_and_b32_e64 v193, s49, v193
v_mfma_f32_16x16x32_f16 v[88:91], v[228:231], v[212:215], v[88:91]
v_cndmask_b32_dpp v129, v145, v129, vcc quad_perm:[1,0,3,2] row_mask:0xf bank_mask:0xf
v_bfe_u32 v192, v193, 2, 14
v_mfma_f32_16x16x32_f16 v[84:87], v[232:235], v[208:211], v[84:87]
ds_read_b128 v[228:231], v250 offset:8448
ds_read_u16_d16 v192, v192
v_exp_f16_sdwa v198, v199 dst_sel:WORD_1 dst_unused:UNUSED_PRESERVE src0_sel:WORD_1
v_cndmask_b32_dpp v130, v146, v130, vcc quad_perm:[1,0,3,2] row_mask:0xf bank_mask:0xf
v_lshrrev_b32 v193, 18, v193
v_mfma_f32_16x16x32_f16 v[92:95], v[232:235], v[212:215], v[92:95]
v_cndmask_b32_dpp v131, v147, v131, vcc quad_perm:[1,0,3,2] row_mask:0xf bank_mask:0xf
s_not_b64 vcc, s[74:75]
v_exp_f16_sdwa v195, v196 dst_sel:WORD_1 dst_unused:UNUSED_PRESERVE src0_sel:WORD_1
v_mfma_f32_16x16x32_bf16 v[172:175], v[236:239], v[104:107], v[172:175]
ds_read_b128 v[232:235], v249 offset:12288
ds_read_u16_d16_hi v193, v193
v_cndmask_b32_dpp v160, v144, v160, vcc quad_perm:[1,0,3,2] row_mask:0xf bank_mask:0xf
v_pk_add_f16 v201, v201, 1.0 op_sel_hi:[1,0]
v_cndmask_b32_dpp v161, v145, v161, vcc quad_perm:[1,0,3,2] row_mask:0xf bank_mask:0xf
v_mfma_f32_16x16x32_bf16 v[180:183], v[236:239], v[108:111], v[180:183]
v_pk_add_f16 v198, v198, 1.0 op_sel_hi:[1,0]
v_cndmask_b32_dpp v162, v146, v162, vcc quad_perm:[1,0,3,2] row_mask:0xf bank_mask:0xf
v_pk_add_f16 v195, v195, 1.0 op_sel_hi:[1,0]
s_waitcnt lgkmcnt(4)
v_mfma_f32_16x16x32_bf16 v[168:171], v[216:219], v[112:115], v[168:171]
ds_read_b128 v[236:239], v250 offset:9216
v_rcp_f16 v202, v201
v_cndmask_b32_dpp v163, v147, v163, vcc quad_perm:[1,0,3,2] row_mask:0xf bank_mask:0xf
v_mfma_f32_16x16x32_bf16 v[176:179], v[216:219], v[116:119], v[176:179]
v_rcp_f16_e64 v199, v198
v_mfma_f32_16x16x32_bf16 v[172:175], v[220:223], v[112:115], v[172:175]
ds_read_b128 v[216:219], v249 offset:12544
s_add_u32 s46, s68, 98304
buffer_store_dwordx4 v[128:131], v255, s[8:11], s46 offen sc1
v_rcp_f16_e64 v196, v195
v_rcp_f16_sdwa v202, v201 dst_sel:WORD_1 dst_unused:UNUSED_PRESERVE src0_sel:WORD_1
v_mfma_f32_16x16x32_bf16 v[180:183], v[220:223], v[116:119], v[180:183]
v_rcp_f16_sdwa v199, v198 dst_sel:WORD_1 dst_unused:UNUSED_PRESERVE src0_sel:WORD_1
v_or_b32 v208, v184, v185
v_or_b32 v209, v186, v187
v_or_b32_e64 v210, v188, v189
v_rcp_f16_sdwa v196, v195 dst_sel:WORD_1 dst_unused:UNUSED_PRESERVE src0_sel:WORD_1
v_or_b32 v211, v190, v191
s_waitcnt lgkmcnt(2)
v_or_b32_e64 v212, v192, v193
v_pk_mul_f16 v213, v203, v202
v_pk_mul_f16 v214, v200, v199
v_pk_mul_f16 v215, v197, v196
v_mfma_f32_16x16x32_f16 v[48:51], v[224:227], v[208:211], v[48:51]
s_add_u32 s46, s68, 98304
buffer_store_dwordx4 v[148:151], v255, s[8:11], s46 offen offset:128 sc1
ds_read_b128 v[220:223], v250 offset:9472
v_cvt_pkrtz_f16_f32 v185, v168, v169
v_cvt_pkrtz_f16_f32 v187, v170, v171
v_mfma_f32_16x16x32_f16 v[56:59], v[224:227], v[212:215], v[56:59]
v_cvt_pkrtz_f16_f32 v189, v172, v173
v_cvt_pkrtz_f16_f32 v191, v174, v175
v_mfma_f32_16x16x32_f16 v[52:55], v[228:231], v[208:211], v[52:55]
ds_read_b128 v[224:227], v249 offset:13312
v_cvt_pkrtz_f16_f32 v193, v176, v177
v_cvt_pk_f16_f32 v203, v178, v179
v_mfma_f32_16x16x32_f16 v[60:63], v[228:231], v[212:215], v[60:63]
v_cvt_pk_f16_f32 v200, v180, v181
v_cvt_pk_f16_f32 v197, v182, v183
v_mfma_f32_16x16x32_bf16 v[168:171], v[232:235], v[96:99], 0
ds_read_b128 v[228:231], v250 offset:10240
v_pk_fma_f16 v202, v203, v203, s48
v_and_b32_e64 v185, s49, v185
v_mfma_f32_16x16x32_bf16 v[176:179], v[232:235], v[100:103], 0
v_pk_fma_f16 v199, v200, v200, s48
v_and_b32 v187, s49, v187
s_waitcnt lgkmcnt(3)
v_mfma_f32_16x16x32_f16 v[64:67], v[236:239], v[208:211], v[64:67]
ds_read_b128 v[232:235], v250 offset:10496
v_pk_fma_f16 v196, v197, v197, s48
v_bfe_u32 v184, v185, 2, 14
v_pk_mul_f16 v202, v203, v202
v_mfma_f32_16x16x32_f16 v[72:75], v[236:239], v[212:215], v[72:75]
v_bfe_u32 v186, v187, 2, 14
v_pk_mul_f16 v199, v200, v199
s_waitcnt vmcnt(6)
v_mfma_f32_16x16x32_bf16 v[80:83], v[18:21], v[4:7], v[80:83]
ds_read_b128 v[236:239], v249 offset:13568
ds_read_u16_d16 v184, v184
ds_read_u16_d16 v186, v186
v_lshrrev_b32 v185, 18, v185
v_pk_mul_f16 v196, v197, v196
v_mfma_f32_16x16x32_bf16 v[84:87], v[16:19], v[4:7], v[84:87]
v_lshrrev_b32_e64 v187, 18, v187
v_mfma_f32_16x16x32_bf16 v[172:175], v[216:219], v[96:99], 0
ds_read_u16_d16_hi v185, v185
ds_read_u16_d16_hi v187, v187
v_exp_f16 v201, v202
v_and_b32 v189, s49, v189
v_mfma_f32_16x16x32_bf16 v[180:183], v[216:219], v[100:103], 0
v_and_b32 v191, s49, v191
s_waitcnt lgkmcnt(6)
v_mfma_f32_16x16x32_f16 v[68:71], v[220:223], v[208:211], v[68:71]
ds_read_b128 v[216:219], v249 offset:14336
v_exp_f16_e64 v198, v199
v_bfe_u32 v188, v189, 2, 14
v_mfma_f32_16x16x32_f16 v[76:79], v[220:223], v[212:215], v[76:79]
v_bfe_u32 v190, v191, 2, 14
v_exp_f16_e64 v195, v196
v_mfma_f32_16x16x32_bf16 v[168:171], v[224:227], v[104:107], v[168:171]
ds_read_b128 v[220:223], v249 offset:14592
ds_read_u16_d16 v188, v188
ds_read_u16_d16 v190, v190
v_lshrrev_b32 v189, 18, v189
v_lshrrev_b32 v191, 18, v191
v_mfma_f32_16x16x32_bf16 v[176:179], v[224:227], v[108:111], v[176:179]
v_exp_f16_sdwa v201, v202 dst_sel:WORD_1 dst_unused:UNUSED_PRESERVE src0_sel:WORD_1
v_mfma_f32_16x16x32_f16 v[80:83], v[228:231], v[208:211], v[80:83]
ds_read_b128 v[224:227], v250 offset:14336
ds_read_u16_d16_hi v189, v189
ds_read_u16_d16_hi v191, v191
v_and_b32 v193, s49, v193
v_bfe_u32 v192, v193, 2, 14
v_mfma_f32_16x16x32_f16 v[88:91], v[228:231], v[212:215], v[88:91]
v_exp_f16_sdwa v198, v199 dst_sel:WORD_1 dst_unused:UNUSED_PRESERVE src0_sel:WORD_1
s_waitcnt lgkmcnt(7)
v_mfma_f32_16x16x32_f16 v[84:87], v[232:235], v[208:211], v[84:87]
ds_read_b128 v[228:231], v250 offset:14592
ds_read_u16_d16 v192, v192
v_lshrrev_b32_e64 v193, 18, v193
v_mfma_f32_16x16x32_f16 v[92:95], v[232:235], v[212:215], v[92:95]
v_exp_f16_sdwa v195, v196 dst_sel:WORD_1 dst_unused:UNUSED_PRESERVE src0_sel:WORD_1
v_pk_add_f16 v201, v201, 1.0 op_sel_hi:[1,0]
v_pk_add_f16 v198, v198, 1.0 op_sel_hi:[1,0]
v_mfma_f32_16x16x32_bf16 v[172:175], v[236:239], v[104:107], v[172:175]
ds_read_b128 v[232:235], v249 offset:18432
ds_read_u16_d16_hi v193, v193
v_pk_add_f16 v195, v195, 1.0 op_sel_hi:[1,0]
v_mfma_f32_16x16x32_bf16 v[180:183], v[236:239], v[108:111], v[180:183]
v_rcp_f16 v202, v201
s_waitcnt lgkmcnt(7)
v_mfma_f32_16x16x32_bf16 v[168:171], v[216:219], v[112:115], v[168:171]
ds_read_b128 v[236:239], v250 offset:15360
v_rcp_f16_e64 v199, v198
v_mfma_f32_16x16x32_bf16 v[176:179], v[216:219], v[116:119], v[176:179]
v_rcp_f16_e64 v196, v195
v_mfma_f32_16x16x32_bf16 v[172:175], v[220:223], v[112:115], v[172:175]
ds_read_b128 v[216:219], v249 offset:18688
v_rcp_f16_sdwa v202, v201 dst_sel:WORD_1 dst_unused:UNUSED_PRESERVE src0_sel:WORD_1
v_mfma_f32_16x16x32_bf16 v[180:183], v[220:223], v[116:119], v[180:183]
v_rcp_f16_sdwa v199, v198 dst_sel:WORD_1 dst_unused:UNUSED_PRESERVE src0_sel:WORD_1
v_or_b32 v208, v184, v185
v_or_b32 v209, v186, v187
s_waitcnt lgkmcnt(4)
v_or_b32 v210, v188, v189
v_rcp_f16_sdwa v196, v195 dst_sel:WORD_1 dst_unused:UNUSED_PRESERVE src0_sel:WORD_1
v_or_b32 v211, v190, v191
s_waitcnt lgkmcnt(2)
v_or_b32_e64 v212, v192, v193
v_pk_mul_f16 v213, v203, v202
v_pk_mul_f16 v214, v200, v199
v_pk_mul_f16 v215, v197, v196
v_mfma_f32_16x16x32_f16 v[48:51], v[224:227], v[208:211], v[48:51]
ds_read_b128 v[220:223], v250 offset:15616
v_cvt_pkrtz_f16_f32 v185, v168, v169
v_cvt_pkrtz_f16_f32 v187, v170, v171
v_mfma_f32_16x16x32_f16 v[56:59], v[224:227], v[212:215], v[56:59]
v_cvt_pkrtz_f16_f32 v189, v172, v173
v_cvt_pkrtz_f16_f32 v191, v174, v175
v_mfma_f32_16x16x32_f16 v[52:55], v[228:231], v[208:211], v[52:55]
ds_read_b128 v[224:227], v249 offset:19456
v_cvt_pkrtz_f16_f32 v193, v176, v177
v_cvt_pk_f16_f32 v203, v178, v179
v_mfma_f32_16x16x32_f16 v[60:63], v[228:231], v[212:215], v[60:63]
v_cvt_pk_f16_f32 v200, v180, v181
v_cvt_pk_f16_f32 v197, v182, v183
v_mfma_f32_16x16x32_bf16 v[168:171], v[232:235], v[96:99], 0
ds_read_b128 v[228:231], v250 offset:16384
v_pk_fma_f16 v202, v203, v203, s48
v_and_b32_e64 v185, s49, v185
v_mfma_f32_16x16x32_bf16 v[176:179], v[232:235], v[100:103], 0
v_pk_fma_f16 v199, v200, v200, s48
v_and_b32 v187, s49, v187
s_waitcnt lgkmcnt(3)
v_mfma_f32_16x16x32_f16 v[64:67], v[236:239], v[208:211], v[64:67]
ds_read_b128 v[232:235], v250 offset:16640
v_pk_fma_f16 v196, v197, v197, s48
v_bfe_u32 v184, v185, 2, 14
v_pk_mul_f16 v202, v203, v202
v_mfma_f32_16x16x32_f16 v[72:75], v[236:239], v[212:215], v[72:75]
v_bfe_u32 v186, v187, 2, 14
v_pk_mul_f16 v199, v200, v199
s_waitcnt vmcnt(5)
v_mfma_f32_16x16x32_bf16 v[56:59], v[18:21], v[44:47], v[56:59]
ds_read_b128 v[236:239], v249 offset:19712
ds_read_u16_d16 v184, v184
ds_read_u16_d16 v186, v186
v_lshrrev_b32 v185, 18, v185
v_pk_mul_f16 v196, v197, v196
v_mfma_f32_16x16x32_bf16 v[60:63], v[16:19], v[44:47], v[60:63]
v_lshrrev_b32_e64 v187, 18, v187
v_mfma_f32_16x16x32_bf16 v[172:175], v[216:219], v[96:99], 0
ds_read_u16_d16_hi v185, v185
ds_read_u16_d16_hi v187, v187
v_exp_f16 v201, v202
v_and_b32 v189, s49, v189
v_mfma_f32_16x16x32_bf16 v[180:183], v[216:219], v[100:103], 0
v_and_b32 v191, s49, v191
s_waitcnt lgkmcnt(6)
v_mfma_f32_16x16x32_f16 v[68:71], v[220:223], v[208:211], v[68:71]
ds_read_b128 v[216:219], v249 offset:20480
v_exp_f16_e64 v198, v199
v_bfe_u32 v188, v189, 2, 14
v_mfma_f32_16x16x32_f16 v[76:79], v[220:223], v[212:215], v[76:79]
v_bfe_u32 v190, v191, 2, 14
v_exp_f16_e64 v195, v196
v_mfma_f32_16x16x32_bf16 v[168:171], v[224:227], v[104:107], v[168:171]
ds_read_b128 v[220:223], v249 offset:20736
ds_read_u16_d16 v188, v188
ds_read_u16_d16 v190, v190
v_lshrrev_b32 v189, 18, v189
v_lshrrev_b32 v191, 18, v191
v_mfma_f32_16x16x32_bf16 v[176:179], v[224:227], v[108:111], v[176:179]
v_exp_f16_sdwa v201, v202 dst_sel:WORD_1 dst_unused:UNUSED_PRESERVE src0_sel:WORD_1
v_mfma_f32_16x16x32_f16 v[80:83], v[228:231], v[208:211], v[80:83]
ds_read_b128 v[224:227], v250 offset:20480
ds_read_u16_d16_hi v189, v189
ds_read_u16_d16_hi v191, v191
v_and_b32 v193, s49, v193
v_bfe_u32 v192, v193, 2, 14
v_mfma_f32_16x16x32_f16 v[88:91], v[228:231], v[212:215], v[88:91]
v_exp_f16_sdwa v198, v199 dst_sel:WORD_1 dst_unused:UNUSED_PRESERVE src0_sel:WORD_1
s_waitcnt lgkmcnt(7)
v_mfma_f32_16x16x32_f16 v[84:87], v[232:235], v[208:211], v[84:87]
ds_read_b128 v[228:231], v250 offset:20736
ds_read_u16_d16 v192, v192
v_lshrrev_b32_e64 v193, 18, v193
v_mfma_f32_16x16x32_f16 v[92:95], v[232:235], v[212:215], v[92:95]
v_exp_f16_sdwa v195, v196 dst_sel:WORD_1 dst_unused:UNUSED_PRESERVE src0_sel:WORD_1
v_pk_add_f16 v201, v201, 1.0 op_sel_hi:[1,0]
v_pk_add_f16 v198, v198, 1.0 op_sel_hi:[1,0]
v_mfma_f32_16x16x32_bf16 v[172:175], v[236:239], v[104:107], v[172:175]
ds_read_b128 v[232:235], v250 offset:21504
ds_read_u16_d16_hi v193, v193
v_pk_add_f16 v195, v195, 1.0 op_sel_hi:[1,0]
v_mfma_f32_16x16x32_bf16 v[180:183], v[236:239], v[108:111], v[180:183]
v_rcp_f16 v202, v201
s_waitcnt lgkmcnt(7)
v_mfma_f32_16x16x32_bf16 v[168:171], v[216:219], v[112:115], v[168:171]
ds_read_b128 v[236:239], v250 offset:21760
v_rcp_f16_e64 v199, v198
v_mfma_f32_16x16x32_bf16 v[176:179], v[216:219], v[116:119], v[176:179]
v_rcp_f16_e64 v196, v195
v_mfma_f32_16x16x32_bf16 v[172:175], v[220:223], v[112:115], v[172:175]
ds_read_b128 v[216:219], v250 offset:22528
v_rcp_f16_sdwa v202, v201 dst_sel:WORD_1 dst_unused:UNUSED_PRESERVE src0_sel:WORD_1
v_mfma_f32_16x16x32_bf16 v[180:183], v[220:223], v[116:119], v[180:183]
v_rcp_f16_sdwa v199, v198 dst_sel:WORD_1 dst_unused:UNUSED_PRESERVE src0_sel:WORD_1
v_or_b32 v208, v184, v185
v_or_b32 v209, v186, v187
s_waitcnt lgkmcnt(4)
v_or_b32 v210, v188, v189
v_rcp_f16_sdwa v196, v195 dst_sel:WORD_1 dst_unused:UNUSED_PRESERVE src0_sel:WORD_1
v_or_b32 v211, v190, v191
s_waitcnt lgkmcnt(2)
v_or_b32_e64 v212, v192, v193
v_pk_mul_f16 v213, v203, v202
v_pk_mul_f16 v214, v200, v199
v_pk_mul_f16 v215, v197, v196
v_mfma_f32_16x16x32_f16 v[48:51], v[224:227], v[208:211], v[48:51]
s_add_u32 s46, s68, 98304
buffer_store_dwordx4 v[160:163], v255, s[8:11], s46 offen offset:256 sc1
ds_read_b128 v[220:223], v250 offset:22784
v_cvt_pkrtz_f16_f32 v185, v168, v169
v_cvt_pkrtz_f16_f32 v187, v170, v171
v_cvt_pkrtz_f16_f32 v189, v172, v173
v_cvt_pkrtz_f16_f32 v191, v174, v175
v_mfma_f32_16x16x32_f16 v[56:59], v[224:227], v[212:215], v[56:59]
v_cvt_pkrtz_f16_f32 v193, v176, v177
v_cvt_pk_f16_f32 v203, v178, v179
v_cvt_pk_f16_f32 v200, v180, v181
v_cvt_pk_f16_f32 v197, v182, v183
v_mfma_f32_16x16x32_f16 v[52:55], v[228:231], v[208:211], v[52:55]
ds_read_b128 v[224:227], v250 offset:26624
v_pk_fma_f16 v202, v203, v203, s48
v_and_b32_e64 v185, s49, v185
v_pk_fma_f16 v199, v200, v200, s48
v_and_b32_e64 v187, s49, v187
v_mfma_f32_16x16x32_f16 v[60:63], v[228:231], v[212:215], v[60:63]
v_pk_fma_f16 v196, v197, v197, s48
v_bfe_u32 v184, v185, 2, 14
v_pk_mul_f16 v202, v203, v202
v_bfe_u32 v186, v187, 2, 14
v_mfma_f32_16x16x32_f16 v[64:67], v[232:235], v[208:211], v[64:67]
ds_read_b128 v[228:231], v250 offset:26880
ds_read_u16_d16 v184, v184
ds_read_u16_d16 v186, v186
v_pk_mul_f16 v199, v200, v199
v_lshrrev_b32_e64 v185, 18, v185
v_pk_mul_f16 v196, v197, v196
v_lshrrev_b32_e64 v187, 18, v187
v_mfma_f32_16x16x32_f16 v[72:75], v[232:235], v[212:215], v[72:75]
v_exp_f16 v201, v202
v_and_b32 v189, s49, v189
v_and_b32 v191, s49, v191
s_waitcnt vmcnt(4)
v_mfma_f32_16x16x32_bf16 v[72:75], v[18:21], v[40:43], v[72:75]
ds_read_b128 v[232:235], v250 offset:27648
ds_read_u16_d16_hi v185, v185
ds_read_u16_d16_hi v187, v187
v_exp_f16_e64 v198, v199
v_bfe_u32 v188, v189, 2, 14
v_bfe_u32 v190, v191, 2, 14
v_mfma_f32_16x16x32_bf16 v[76:79], v[16:19], v[40:43], v[76:79]
v_exp_f16 v195, v196
v_lshrrev_b32 v189, 18, v189
v_lshrrev_b32 v191, 18, v191
s_waitcnt lgkmcnt(6)
v_mfma_f32_16x16x32_f16 v[68:71], v[236:239], v[208:211], v[68:71]
ds_read_u16_d16 v188, v188
ds_read_u16_d16 v190, v190
ds_read_u16_d16_hi v189, v189
ds_read_u16_d16_hi v191, v191
v_exp_f16_sdwa v201, v202 dst_sel:WORD_1 dst_unused:UNUSED_PRESERVE src0_sel:WORD_1
v_and_b32_e64 v193, s49, v193
v_bfe_u32 v192, v193, 2, 14
v_mfma_f32_16x16x32_f16 v[76:79], v[236:239], v[212:215], v[76:79]
v_exp_f16_sdwa v198, v199 dst_sel:WORD_1 dst_unused:UNUSED_PRESERVE src0_sel:WORD_1
v_lshrrev_b32_e64 v193, 18, v193
v_mfma_f32_16x16x32_f16 v[80:83], v[216:219], v[208:211], v[80:83]
ds_read_b128 v[236:239], v250 offset:27904
ds_read_u16_d16 v192, v192
ds_read_u16_d16_hi v193, v193
v_exp_f16_sdwa v195, v196 dst_sel:WORD_1 dst_unused:UNUSED_PRESERVE src0_sel:WORD_1
v_pk_add_f16 v201, v201, 1.0 op_sel_hi:[1,0]
v_pk_add_f16 v198, v198, 1.0 op_sel_hi:[1,0]
v_pk_add_f16 v195, v195, 1.0 op_sel_hi:[1,0]
v_mfma_f32_16x16x32_f16 v[88:91], v[216:219], v[212:215], v[88:91]
v_rcp_f16 v202, v201
v_rcp_f16 v199, v198
v_mfma_f32_16x16x32_f16 v[84:87], v[220:223], v[208:211], v[84:87]
ds_read_b128 v[216:219], v250 offset:28672
v_rcp_f16_e64 v196, v195
v_rcp_f16_sdwa v202, v201 dst_sel:WORD_1 dst_unused:UNUSED_PRESERVE src0_sel:WORD_1
v_mfma_f32_16x16x32_f16 v[92:95], v[220:223], v[212:215], v[92:95]
v_rcp_f16_sdwa v199, v198 dst_sel:WORD_1 dst_unused:UNUSED_PRESERVE src0_sel:WORD_1
s_waitcnt lgkmcnt(5)
v_or_b32 v208, v184, v185
v_or_b32_e64 v209, v186, v187
v_or_b32 v210, v188, v189
v_rcp_f16_sdwa v196, v195 dst_sel:WORD_1 dst_unused:UNUSED_PRESERVE src0_sel:WORD_1
s_waitcnt lgkmcnt(4)
v_or_b32 v211, v190, v191
s_waitcnt lgkmcnt(1)
v_or_b32 v212, v192, v193
v_pk_mul_f16 v213, v203, v202
v_pk_mul_f16 v214, v200, v199
v_pk_mul_f16 v215, v197, v196
v_mfma_f32_16x16x32_f16 v[48:51], v[224:227], v[208:211], v[48:51]
ds_read_b128 v[220:223], v250 offset:28928
v_mfma_f32_16x16x32_f16 v[56:59], v[224:227], v[212:215], v[56:59]
v_mfma_f32_16x16x32_f16 v[52:55], v[228:231], v[208:211], v[52:55]
v_mfma_f32_16x16x32_f16 v[60:63], v[228:231], v[212:215], v[60:63]
v_mfma_f32_16x16x32_f16 v[64:67], v[232:235], v[208:211], v[64:67]
v_mfma_f32_16x16x32_f16 v[72:75], v[232:235], v[212:215], v[72:75]
s_waitcnt vmcnt(3)
v_mfma_f32_16x16x32_bf16 v[88:91], v[18:21], v[0:3], v[88:91]
v_mfma_f32_16x16x32_bf16 v[92:95], v[16:19], v[0:3], v[92:95]
v_mfma_f32_16x16x32_f16 v[68:71], v[236:239], v[208:211], v[68:71]
v_mfma_f32_16x16x32_f16 v[76:79], v[236:239], v[212:215], v[76:79]
s_waitcnt lgkmcnt(1)
v_mfma_f32_16x16x32_f16 v[80:83], v[216:219], v[208:211], v[80:83]
v_mfma_f32_16x16x32_f16 v[88:91], v[216:219], v[212:215], v[88:91]
s_waitcnt lgkmcnt(0)
v_mfma_f32_16x16x32_f16 v[84:87], v[220:223], v[208:211], v[84:87]
v_mfma_f32_16x16x32_f16 v[92:95], v[220:223], v[212:215], v[92:95]
v_cvt_pk_bf16_f32 v64, v64, v65
v_cvt_pk_bf16_f32 v65, v66, v67
v_cvt_pk_bf16_f32 v66, v68, v69
v_cvt_pk_bf16_f32 v67, v70, v71
v_cvt_pk_bf16_f32 v48, v48, v49
v_cvt_pk_bf16_f32 v49, v50, v51
v_cvt_pk_bf16_f32 v50, v52, v53
v_cvt_pk_bf16_f32 v51, v54, v55
v_cvt_pk_bf16_f32 v80, v80, v81
v_cvt_pk_bf16_f32 v81, v82, v83
v_cvt_pk_bf16_f32 v82, v84, v85
v_cvt_pk_bf16_f32 v83, v86, v87
s_mov_b64 vcc, s[74:75]
v_cndmask_b32 v68, v48, v80, vcc
v_cndmask_b32 v69, v49, v81, vcc
v_cndmask_b32 v70, v50, v82, vcc
v_cndmask_b32 v71, v51, v83, vcc
v_cndmask_b32_dpp v48, v64, v48, vcc quad_perm:[1,0,3,2] row_mask:0xf bank_mask:0xf
v_cndmask_b32_dpp v49, v65, v49, vcc quad_perm:[1,0,3,2] row_mask:0xf bank_mask:0xf
v_cndmask_b32_dpp v50, v66, v50, vcc quad_perm:[1,0,3,2] row_mask:0xf bank_mask:0xf
v_cndmask_b32_dpp v51, v67, v51, vcc quad_perm:[1,0,3,2] row_mask:0xf bank_mask:0xf
s_not_b64 vcc, s[74:75]
v_cndmask_b32_dpp v80, v64, v80, vcc quad_perm:[1,0,3,2] row_mask:0xf bank_mask:0xf
v_cndmask_b32_dpp v81, v65, v81, vcc quad_perm:[1,0,3,2] row_mask:0xf bank_mask:0xf
v_cndmask_b32_dpp v82, v66, v82, vcc quad_perm:[1,0,3,2] row_mask:0xf bank_mask:0xf
v_cndmask_b32_dpp v83, v67, v83, vcc quad_perm:[1,0,3,2] row_mask:0xf bank_mask:0xf
buffer_store_dwordx4 v[48:51], v255, s[8:11], s69 offen sc1
buffer_store_dwordx4 v[68:71], v255, s[8:11], s69 offen offset:128 sc1
buffer_store_dwordx4 v[80:83], v255, s[8:11], s69 offen offset:256 sc1
v_cvt_pk_bf16_f32 v72, v72, v73
v_cvt_pk_bf16_f32 v73, v74, v75
v_cvt_pk_bf16_f32 v74, v76, v77
v_cvt_pk_bf16_f32 v75, v78, v79
v_cvt_pk_bf16_f32 v56, v56, v57
v_cvt_pk_bf16_f32 v57, v58, v59
v_cvt_pk_bf16_f32 v58, v60, v61
v_cvt_pk_bf16_f32 v59, v62, v63
v_cvt_pk_bf16_f32 v88, v88, v89
v_cvt_pk_bf16_f32 v89, v90, v91
v_cvt_pk_bf16_f32 v90, v92, v93
v_cvt_pk_bf16_f32 v91, v94, v95
s_mov_b64 vcc, s[74:75]
v_cndmask_b32 v76, v56, v88, vcc
v_cndmask_b32 v77, v57, v89, vcc
v_cndmask_b32 v78, v58, v90, vcc
v_cndmask_b32 v79, v59, v91, vcc
v_cndmask_b32_dpp v56, v72, v56, vcc quad_perm:[1,0,3,2] row_mask:0xf bank_mask:0xf
v_cndmask_b32_dpp v57, v73, v57, vcc quad_perm:[1,0,3,2] row_mask:0xf bank_mask:0xf
v_cndmask_b32_dpp v58, v74, v58, vcc quad_perm:[1,0,3,2] row_mask:0xf bank_mask:0xf
v_cndmask_b32_dpp v59, v75, v59, vcc quad_perm:[1,0,3,2] row_mask:0xf bank_mask:0xf
s_not_b64 vcc, s[74:75]
v_cndmask_b32_dpp v88, v72, v88, vcc quad_perm:[1,0,3,2] row_mask:0xf bank_mask:0xf
v_cndmask_b32_dpp v89, v73, v89, vcc quad_perm:[1,0,3,2] row_mask:0xf bank_mask:0xf
v_cndmask_b32_dpp v90, v74, v90, vcc quad_perm:[1,0,3,2] row_mask:0xf bank_mask:0xf
v_cndmask_b32_dpp v91, v75, v91, vcc quad_perm:[1,0,3,2] row_mask:0xf bank_mask:0xf
s_add_u32 s46, s69, 98304
buffer_store_dwordx4 v[56:59], v255, s[8:11], s46 offen sc1
s_add_u32 s46, s69, 98304
buffer_store_dwordx4 v[76:79], v255, s[8:11], s46 offen offset:128 sc1
s_add_u32 s46, s69, 98304
buffer_store_dwordx4 v[88:91], v255, s[8:11], s46 offen offset:256 sc1
s_endpgm
Lpoll:
s_waitcnt vmcnt(0)
s_cmp_eq_u32 s77, 2
s_cbranch_scc1 LpollC
v_max_u32 v255, v156, v157
v_max3_u32 v255, v255, v158, v159
v_max3_u32 v255, v255, v160, v161
v_max3_u32 v255, v255, v162, v163
v_max3_u32 v255, v255, v164, v165
v_max3_u32 v255, v255, v166, v167
v_max3_u32 v255, v255, v240, v241
v_max3_u32 v255, v255, v242, v243
v_cmp_eq_u32 vcc, -1, v255
s_nop 4
s_cbranch_vccz LpollR
v_lshlrev_b32 v247, 4, v251
s_lshl_b32 s44, s2, 12
buffer_load_dwordx4 v[156:159], v247, s[32:35], s44 offen sc1
buffer_load_dwordx4 v[160:163], v247, s[32:35], s44 offen offset:1024 sc1
buffer_load_dwordx4 v[164:167], v247, s[32:35], s44 offen offset:2048 sc1
buffer_load_dwordx4 v[240:243], v247, s[32:35], s44 offen offset:3072 sc1
s_setpc_b64 s[78:79]
LpollR:
s_setprio 3
v_add_f32 v156, v156, v160
v_add_f32 v240, v164, v240
v_add_f32 v240, v156, v240
v_add_f32 v157, v157, v161
v_add_f32 v241, v165, v241
v_add_f32 v241, v157, v241
v_add_f32 v158, v158, v162
v_add_f32 v242, v166, v242
v_add_f32 v242, v158, v242
v_add_f32 v159, v159, v163
v_add_f32 v243, v167, v243
v_add_f32 v243, v159, v243
v_add_f32_dpp v240, v240, v240 row_ror:8 row_mask:0xf bank_mask:0xf
s_nop 1
v_add_f32_dpp v240, v240, v240 row_ror:4 row_mask:0xf bank_mask:0xf
s_nop 1
v_add_f32_dpp v240, v240, v240 row_ror:2 row_mask:0xf bank_mask:0xf
s_nop 1
v_add_f32_dpp v240, v240, v240 row_ror:1 row_mask:0xf bank_mask:0xf
v_mov_b32 v255, v240
s_nop 1
v_permlane16_swap_b32 v240, v255
v_add_f32 v240, v240, v255
v_mov_b32 v255, v240
s_nop 1
v_permlane32_swap_b32 v240, v255
v_add_f32 v240, v240, v255
v_min_u32 v240, -2, v240
v_add_f32_dpp v241, v241, v241 row_ror:8 row_mask:0xf bank_mask:0xf
s_nop 1
v_add_f32_dpp v241, v241, v241 row_ror:4 row_mask:0xf bank_mask:0xf
s_nop 1
v_add_f32_dpp v241, v241, v241 row_ror:2 row_mask:0xf bank_mask:0xf
s_nop 1
v_add_f32_dpp v241, v241, v241 row_ror:1 row_mask:0xf bank_mask:0xf
v_mov_b32 v255, v241
s_nop 1
v_permlane16_swap_b32 v241, v255
v_add_f32 v241, v241, v255
v_mov_b32 v255, v241
s_nop 1
v_permlane32_swap_b32 v241, v255
v_add_f32 v241, v241, v255
v_min_u32 v241, -2, v241
v_add_f32_dpp v242, v242, v242 row_ror:8 row_mask:0xf bank_mask:0xf
s_nop 1
v_add_f32_dpp v242, v242, v242 row_ror:4 row_mask:0xf bank_mask:0xf
s_nop 1
v_add_f32_dpp v242, v242, v242 row_ror:2 row_mask:0xf bank_mask:0xf
s_nop 1
v_add_f32_dpp v242, v242, v242 row_ror:1 row_mask:0xf bank_mask:0xf
v_mov_b32 v255, v242
s_nop 1
v_permlane16_swap_b32 v242, v255
v_add_f32 v242, v242, v255
v_mov_b32 v255, v242
s_nop 1
v_permlane32_swap_b32 v242, v255
v_add_f32 v242, v242, v255
v_min_u32 v242, -2, v242
v_add_f32_dpp v243, v243, v243 row_ror:8 row_mask:0xf bank_mask:0xf
s_nop 1
v_add_f32_dpp v243, v243, v243 row_ror:4 row_mask:0xf bank_mask:0xf
s_nop 1
v_add_f32_dpp v243, v243, v243 row_ror:2 row_mask:0xf bank_mask:0xf
s_nop 1
v_add_f32_dpp v243, v243, v243 row_ror:1 row_mask:0xf bank_mask:0xf
v_mov_b32 v255, v243
s_nop 1
v_permlane16_swap_b32 v243, v255
v_add_f32 v243, v243, v255
v_mov_b32 v255, v243
s_nop 1
v_permlane32_swap_b32 v243, v255
v_add_f32_e64 v243, v243, v255
v_min_u32 v243, -2, v243
s_lshl_b32 s44, s2, 4
s_add_u32 s44, s44, 393216
v_lshlrev_b32_e64 v255, 11, v251
s_mov_b64 exec, 0xff
buffer_store_dwordx4 v[240:243], v255, s[32:35], s44 offen sc1
s_mov_b64 exec, -1
s_mov_b32 s77, 2
v_lshlrev_b32_e64 v247, 3, v251
s_and_b32 s44, s2, 7
s_lshl_b32 s44, s44, 11
s_add_u32 s44, s44, 393216
buffer_load_dwordx2 v[156:157], v247, s[32:35], s44 offen sc1
buffer_load_dwordx2 v[158:159], v247, s[32:35], s44 offen offset:512 sc1
buffer_load_dwordx2 v[160:161], v247, s[32:35], s44 offen offset:1024 sc1
s_setpc_b64 s[78:79]
LpollC:
v_max3_u32 v255, v156, v157, v158
v_max3_u32 v255, v255, v159, v160
v_max_u32 v255, v255, v161
v_cmp_eq_u32 vcc, -1, v255
s_nop 4
s_cbranch_vccz LpollS
v_lshlrev_b32 v247, 3, v251
s_and_b32 s44, s2, 7
s_lshl_b32 s44, s44, 11
s_add_u32 s44, s44, 393216
buffer_load_dwordx2 v[156:157], v247, s[32:35], s44 offen sc1
buffer_load_dwordx2 v[158:159], v247, s[32:35], s44 offen offset:512 sc1
buffer_load_dwordx2 v[160:161], v247, s[32:35], s44 offen offset:1024 sc1
s_setpc_b64 s[78:79]
LpollS:
s_setprio 3
s_mov_b32 s43, 1083296634
v_mov_b32 v162, 897988541
v_fma_f32 v156, v156, s43, v162
v_fma_f32 v157, v157, s43, v162
v_fma_f32 v158, v158, s43, v162
v_fma_f32 v159, v159, s43, v162
v_fma_f32 v160, v160, s43, v162
v_fma_f32 v161, v161, s43, v162
v_sqrt_f32 v156, v156
v_sqrt_f32 v157, v157
v_sqrt_f32 v158, v158
v_sqrt_f32 v159, v159
v_sqrt_f32 v160, v160
v_sqrt_f32 v161, v161
v_add_f32 v163, v156, v157
v_add_f32 v163, v163, v158
v_add_f32 v163, v163, v159
v_add_f32 v163, v163, v160
v_add_f32 v163, v163, v161
s_nop 1
v_add_f32_dpp v163, v163, v163 row_ror:8 row_mask:0xf bank_mask:0xf
s_nop 1
v_add_f32_dpp v163, v163, v163 row_ror:4 row_mask:0xf bank_mask:0xf
s_nop 1
v_add_f32_dpp v163, v163, v163 row_ror:2 row_mask:0xf bank_mask:0xf
s_nop 1
v_add_f32_dpp v163, v163, v163 row_ror:1 row_mask:0xf bank_mask:0xf
v_mov_b32 v255, v163
s_nop 1
v_permlane16_swap_b32 v163, v255
v_add_f32 v163, v163, v255
v_mov_b32 v255, v163
s_nop 1
v_permlane32_swap_b32 v163, v255
v_add_f32_e64 v163, v163, v255
s_mov_b32 s43, 992651947
v_fma_f32 v163, v163, s43, v162
v_rcp_f32_e64 v163, v163
v_mov_b32 v162, 3221789604
v_mul_f32 v163, v163, v162
v_lshlrev_b32 v164, 16, v244
v_and_b32 v165, 4294901760, v244
v_mul_f32 v156, v156, v163
v_mul_f32 v157, v157, v163
v_fma_f32 v164, v164, v156, v162
v_fma_f32 v165, v165, v157, v162
v_cvt_pk_f16_f32 v244, v164, v165
v_lshlrev_b32_e64 v164, 16, v245
v_and_b32 v165, 4294901760, v245
v_mul_f32 v158, v158, v163
v_mul_f32 v159, v159, v163
v_fma_f32 v164, v164, v158, v162
v_fma_f32 v165, v165, v159, v162
v_cvt_pk_f16_f32 v245, v164, v165
v_lshlrev_b32_e64 v164, 16, v246
v_and_b32 v165, 4294901760, v246
v_mul_f32 v160, v160, v163
v_mul_f32 v161, v161, v163
v_fma_f32 v164, v164, v160, v162
v_fma_f32 v165, v165, v161, v162
v_cvt_pk_f16_f32 v246, v164, v165
s_mov_b32 s77, 0
s_setpc_b64 s[78:79]
Lend:
s_endpgm

.section .rodata,"a"
.p2align 6
.amdhsa_kernel standalone__modern_conv_block_convnext_v2__vision_kernel
  .amdhsa_next_free_vgpr 256
  .amdhsa_next_free_sgpr 102
  .amdhsa_accum_offset 256
  .amdhsa_group_segment_fixed_size 0
  .amdhsa_kernarg_size 72
  .amdhsa_user_sgpr_count 2
  .amdhsa_user_sgpr_kernarg_segment_ptr 1
  .amdhsa_system_sgpr_workgroup_id_x 1
.end_amdhsa_kernel
```

```asm
; @launch grid=(256,1,1) block=(512,1,1) lds=163840
.amdgcn_target "amdgcn-amd-amdhsa--gfx950"
.text
.globl standalone__modern_conv_block_convnext_v2__vision_kernel
.p2align 8
.type standalone__modern_conv_block_convnext_v2__vision_kernel,@function
standalone__modern_conv_block_convnext_v2__vision_kernel:
Lmain:
s_cmp_ge_u32 s2, 256
s_cbranch_scc1 Lend
s_load_dwordx16 s[80:95], s[0:1], 0
s_load_dwordx2 s[96:97], s[0:1], 64
s_getpc_b64 s[74:75]
Lpc0:
s_sub_u32 s74, s74, Lpc0-Lmain
s_subb_u32 s75, s75, 0
v_lshlrev_b32 v159, 7, v0
s_movk_i32 s43, 64
v_cmp_gt_u32 vcc, s43, v0
s_and_saveexec_b64 s[78:79], vcc
s_cbranch_execz Lpf0x
global_load_dword v255, v159, s[74:75]
Lpf0x:
s_mov_b64 exec, s[78:79]
v_mov_b32 v199, v0
v_and_b32 v251, 63, v0
v_lshrrev_b32 v120, 6, v0
s_nop 0
v_readfirstlane_b32 s40, v120
s_and_b32 s43, s2, 7
s_lshr_b32 s44, s2, 3
s_and_b32 s41, s43, 3
s_lshl_b32 s41, s41, 2
s_and_b32 s45, s44, 3
s_add_u32 s41, s41, s45
s_lshr_b32 s42, s43, 2
s_lshl_b32 s42, s42, 3
s_lshr_b32 s45, s44, 2
s_add_u32 s42, s42, s45
s_lshl_b32 s41, s41, 5
s_lshl_b32 s42, s42, 5
s_lshl_b32 s67, s40, 6
s_cmp_eq_u32 s40, 6
s_cselect_b32 s67, 352, s67
v_add_u32_e64 v125, s67, v251
v_mul_u32_u24 v121, 5462, v125
v_lshrrev_b32 v121, 16, v121
v_mul_u32_u24 v122, 12, v121
v_sub_u32 v122, v125, v122
v_bfe_u32 v123, v121, 2, 2
v_xor_b32 v122, v122, v123
v_add_u32 v123, s41, v121
v_subrev_u32 v123, 1, v123
v_mul_u32_u24 v124, 192, v123
v_lshl_add_u32 v124, v122, 4, v124
v_mov_b32 v240, 2147483648
s_movk_i32 s43, 512
v_cmp_gt_u32 vcc, s43, v123
s_nop 1
v_cndmask_b32 v124, v240, v124, vcc
v_cmp_gt_u32 vcc, 34, v121
s_nop 1
v_cndmask_b32 v240, v240, v124, vcc
s_add_i32 s43, s42, -1
s_mul_i32 s44, s43, 98304
s_cmp_lt_u32 s43, 512
s_cselect_b32 s46, s44, 1073741824
s_mul_i32 s66, s42, 98304
s_mov_b32 s6, 50331648
s_mov_b32 s7, 131072
s_lshl_b32 s67, s67, 4
s_add_u32 s67, s67, 90112
s_cmp_eq_u32 s40, 7
s_cselect_b32 s67, 163840, s67
v_lshlrev_b32 v130, 1, v199
v_add_u32 v155, 768, v199
v_min_u32 v155, 863, v155
v_lshlrev_b32_e64 v131, 1, v155
s_waitcnt lgkmcnt(0)
s_mov_b32 s4, s80
s_and_b32 s5, s81, 65535
s_cmp_ge_u32 s40, 4
s_cbranch_scc1 Lnodw
s_mov_b32 s20, s82
s_and_b32 s21, s83, 65535
s_mov_b32 s22, 1728
s_mov_b32 s23, 131072
buffer_load_ushort v126, v130, s[20:23], 0 offen offset:0
buffer_load_ushort v127, v130, s[20:23], 0 offen offset:512
buffer_load_ushort v128, v130, s[20:23], 0 offen offset:1024
buffer_load_ushort v129, v131, s[20:23], 0 offen offset:0
Lnodw:
s_cmp_eq_u32 s40, 7
s_cbranch_scc1 Lskipx0
s_add_u32 m0, s67, 0
s_nop 0
buffer_load_dwordx4 v240, s[4:7], s46 offen nt lds
s_add_u32 m0, s67, 6656
s_nop 0
buffer_load_dwordx4 v240, s[4:7], s66 offen nt lds
s_add_u32 m0, s67, 13312
s_add_u32 s45, s66, 98304
buffer_load_dwordx4 v240, s[4:7], s45 offen nt lds
s_add_u32 m0, s67, 19968
s_add_u32 s45, s66, 196608
buffer_load_dwordx4 v240, s[4:7], s45 offen nt lds
s_add_u32 m0, s67, 26624
s_add_u32 s45, s66, 294912
buffer_load_dwordx4 v240, s[4:7], s45 offen nt lds
s_add_u32 m0, s67, 33280
s_add_u32 s45, s66, 393216
buffer_load_dwordx4 v240, s[4:7], s45 offen nt lds
Lskipx0:
s_mov_b32 s12, s84
s_and_b32 s13, s85, 65535
s_mov_b32 s14, 73728
s_mov_b32 s15, 131072
v_lshrrev_b32 v145, 2, v251
v_mul_u32_u24 v145, 768, v145
v_and_b32_e64 v125, 3, v251
v_lshl_add_u32 v145, v125, 4, v145
s_and_b32 s43, s40, 3
s_lshl_b32 s3, s43, 6
s_mul_i32 s77, s43, 6144
s_add_u32 s77, s77, 16384
v_mov_b32 v253, 16256
v_mov_b32 v254, 1
s_add_u32 s43, s42, s40
s_add_u32 s43, s43, 1
s_lshl_b32 s43, s43, 9
s_add_u32 s43, s43, s41
s_mul_i32 s47, s43, 192
s_sub_u32 s47, s47, 256
s_and_b32 s43, s40, 1
s_lshl_b32 s46, s43, 4
s_add_u32 s41, s41, s46
s_and_b32 s43, s40, 6
s_add_u32 s42, s42, s43
s_mul_i32 s45, s43, 6656
s_add_u32 s45, s45, 90112
v_and_b32 v131, 15, v251
v_lshrrev_b32 v132, 4, v251
v_mul_u32_u24 v122, 6656, v132
v_add_u32 v122, s45, v122
v_add_u32 v121, s46, v131
v_mul_u32_u24 v123, 192, v121
v_bfe_u32 v124, v121, 2, 2
v_lshl_add_u32 v123, v124, 4, v123
v_add_u32 v242, v122, v123
v_add_u32 v121, 1, v121
v_mul_u32_u24 v123, 192, v121
v_bfe_u32 v124, v121, 2, 2
v_lshl_add_u32 v123, v124, 4, v123
v_add_u32 v243, v122, v123
v_add_u32 v121, 1, v121
v_mul_u32_u24 v123, 192, v121
v_bfe_u32 v124, v121, 2, 2
v_lshl_add_u32 v123, v124, 4, v123
v_add_u32_e64 v244, v122, v123
s_mul_i32 s72, s40, 9216
s_add_u32 s72, s72, 90112
v_bfe_u32 v133, v131, 2, 1
v_sub_u32 v133, v132, v133
v_lshrrev_b32 v134, 3, v131
v_and_b32_e64 v135, 3, v131
v_lshl_add_u32 v135, v134, 2, v135
v_lshlrev_b32_e64 v136, 7, v133
v_lshl_add_u32 v136, v135, 4, v136
v_add_u32 v136, 156672, v136
v_mov_b32 v135, 163840
v_cmp_gt_u32 vcc, 3, v133
s_nop 1
v_cndmask_b32 v245, v135, v136, vcc
v_and_b32 v135, 3, v131
v_mul_u32_u24 v246, 85, v135
s_mov_b32 s16, s86
s_and_b32 s17, s87, 65535
s_mov_b32 s18, 73728
s_mov_b32 s19, 131072
s_mov_b32 s24, s88
s_and_b32 s25, s89, 65535
s_mov_b32 s26, 768
s_mov_b32 s27, 131072
s_mov_b32 s28, s90
s_and_b32 s29, s91, 65535
s_mov_b32 s30, 768
s_mov_b32 s31, 131072
s_mov_b32 s8, s92
s_and_b32 s9, s93, 65535
s_mov_b32 s10, 50331648
s_mov_b32 s11, 131072
s_mov_b32 s36, s94
s_and_b32 s37, s95, 65535
s_mov_b32 s38, 256
s_mov_b32 s39, 131072
s_mov_b32 s32, s96
s_and_b32 s33, s97, 65535
s_mov_b32 s34, 83886080
s_mov_b32 s35, 131072
v_lshlrev_b32 v241, 4, v251
v_and_b32 v133, 35, v251
v_bfe_u32 v134, v251, 2, 2
v_lshl_add_u32 v133, v134, 3, v133
v_bfe_u32 v134, v251, 4, 1
v_lshl_add_u32 v133, v134, 2, v133
v_lshlrev_b32_e64 v248, 4, v133
v_add_u32 v249, 65536, v248
v_add_u32 v250, 131072, v248
s_lshl_b32 s73, s2, 3
s_add_u32 s73, s73, s40
s_lshl_b32 s80, s73, 10
s_add_u32 s80, s80, 4194304
s_mul_i32 s73, s73, 16
s_add_u32 s73, s73, 1048576
s_mul_i32 s46, s41, 192
s_add_u32 s43, s42, 0
s_mul_i32 s43, s43, 98304
s_add_u32 s68, s43, s46
s_add_u32 s43, s42, 8
s_mul_i32 s43, s43, 98304
s_add_u32 s69, s43, s46
s_add_u32 s43, s42, 16
s_mul_i32 s43, s43, 98304
s_add_u32 s70, s43, s46
s_add_u32 s43, s42, 24
s_mul_i32 s43, s43, 98304
s_add_u32 s71, s43, s46
s_mul_i32 s82, s40, 9216
s_mov_b32 s48, 1156203754
s_mov_b32 s49, 4294508536
s_mov_b32 s76, 400000
v_lshrrev_b32 v148, 5, v251
v_lshlrev_b32 v146, 8, v148
v_bfe_u32 v148, v251, 2, 2
v_lshl_add_u32 v146, v148, 6, v146
v_bfe_u32 v148, v251, 4, 1
v_lshl_add_u32 v146, v148, 5, v146
v_bfe_u32 v148, v251, 0, 1
v_lshl_add_u32 v146, v148, 4, v146
v_bfe_u32 v148, v251, 1, 1
v_lshl_add_u32 v146, v148, 3, v146
v_add_u32 v146, s77, v146
v_add_u32 v147, s77, v248
s_cmp_lt_u32 s40, 4
s_cbranch_scc1 Lnoy
v_lshlrev_b32_e64 v24, 6, v199
s_mov_b32 s43, 1065362610
v_mov_b32 v25, 1084047360
v_add_u32 v0, 32772, v24
v_add_u32 v1, 32780, v24
v_add_u32 v2, 32788, v24
v_add_u32 v3, 32796, v24
v_add_u32 v4, 32804, v24
v_add_u32 v5, 32812, v24
v_add_u32 v6, 32820, v24
v_add_u32 v7, 32828, v24
v_cvt_f32_f16 v0, v0
v_cvt_f32_f16 v1, v1
v_cvt_f32_f16 v2, v2
v_cvt_f32_f16 v3, v3
v_cvt_f32_f16 v4, v4
v_cvt_f32_f16 v5, v5
v_cvt_f32_f16 v6, v6
v_cvt_f32_f16 v7, v7
v_mul_f32 v8, v0, v0
v_mul_f32 v9, v1, v1
v_mul_f32 v10, v2, v2
v_mul_f32 v11, v3, v3
v_mul_f32 v12, v4, v4
v_mul_f32 v13, v5, v5
v_mul_f32 v14, v6, v6
v_mul_f32 v15, v7, v7
v_fma_f32 v8, v8, s43, v25
v_fma_f32 v9, v9, s43, v25
v_fma_f32 v10, v10, s43, v25
v_fma_f32 v11, v11, s43, v25
v_fma_f32 v12, v12, s43, v25
v_fma_f32 v13, v13, s43, v25
v_fma_f32 v14, v14, s43, v25
v_fma_f32 v15, v15, s43, v25
v_mul_f32 v8, v0, v8
v_mul_f32 v9, v1, v9
v_mul_f32 v10, v2, v10
v_mul_f32 v11, v3, v11
v_mul_f32 v12, v4, v12
v_mul_f32 v13, v5, v13
v_mul_f32 v14, v6, v14
v_mul_f32 v15, v7, v15
v_exp_f32 v8, v8
v_exp_f32 v9, v9
v_exp_f32 v10, v10
v_exp_f32 v11, v11
v_exp_f32 v12, v12
v_exp_f32 v13, v13
v_exp_f32 v14, v14
v_exp_f32 v15, v15
v_add_f32 v16, 1.0, v8
v_add_f32 v17, 1.0, v9
v_add_f32 v18, 1.0, v10
v_add_f32 v19, 1.0, v11
v_add_f32 v20, 1.0, v12
v_add_f32 v21, 1.0, v13
v_add_f32 v22, 1.0, v14
v_add_f32 v23, 1.0, v15
v_rcp_f32 v16, v16
v_rcp_f32 v17, v17
v_rcp_f32 v18, v18
v_rcp_f32 v19, v19
v_rcp_f32 v20, v20
v_rcp_f32 v21, v21
v_rcp_f32 v22, v22
v_rcp_f32 v23, v23
v_mul_f32 v0, v0, v16
v_mul_f32 v1, v1, v17
v_mul_f32 v2, v2, v18
v_mul_f32 v3, v3, v19
v_mul_f32 v4, v4, v20
v_mul_f32 v5, v5, v21
v_mul_f32 v6, v6, v22
v_mul_f32 v7, v7, v23
v_mul_f32 v8, v8, v0
v_mul_f32 v9, v9, v1
v_mul_f32 v10, v10, v2
v_mul_f32 v11, v11, v3
v_mul_f32 v12, v12, v4
v_mul_f32 v13, v13, v5
v_mul_f32 v14, v14, v6
v_mul_f32 v15, v15, v7
v_cvt_pk_f16_f32 v28, v0, v1
v_cvt_pk_f16_f32 v32, -v8, -v9
v_cvt_pk_f16_f32 v29, v2, v3
v_cvt_pk_f16_f32 v33, -v10, -v11
v_cvt_pk_f16_f32 v30, v4, v5
v_cvt_pk_f16_f32 v34, -v12, -v13
v_cvt_pk_f16_f32 v31, v6, v7
v_cvt_pk_f16_f32 v35, -v14, -v15
v_lshlrev_b32_e64 v24, 4, v199
v_mov_b32 v25, 163840
s_movk_i32 s43, 496
v_cmp_gt_u32 vcc, s43, v199
s_nop 1
v_cndmask_b32 v24, v25, v24, vcc
ds_write_b128 v24, v[32:35]
ds_write_b128 v24, v[28:31] offset:8192
Lnoy:
s_cmp_ge_u32 s40, 4
s_cbranch_scc1 Lnoo
v_add_u32_e64 v152, 0, v199
v_mul_u32_u24 v140, 683, v152
v_lshrrev_b32 v140, 16, v140
v_mul_u32_u24 v142, 11, v140
v_lshrrev_b32 v142, 5, v142
v_lshrrev_b32 v143, 5, v152
v_bfe_u32 v141, v152, 3, 2
v_bfe_u32 v144, v152, 4, 1
v_xor_b32 v141, v141, v144
v_sub_u32 v141, v141, v142
v_mul_i32_i24 v141, 9, v141
v_add_u32 v143, v143, v141
v_lshrrev_b32_e64 v141, 1, v143
v_mul_u32_u24 v141, 368, v141
v_lshl_add_u32 v143, v143, 3, v141
v_lshl_add_u32 v143, v142, 7, v143
v_and_b32_e64 v144, 7, v152
v_lshl_add_u32 v143, v144, 4, v143
v_add_u32 v156, 156672, v143
v_add_u32 v153, 256, v199
v_mul_u32_u24 v140, 683, v153
v_lshrrev_b32 v140, 16, v140
v_mul_u32_u24 v142, 11, v140
v_lshrrev_b32 v142, 5, v142
v_lshrrev_b32 v143, 5, v153
v_bfe_u32 v141, v153, 3, 2
v_bfe_u32 v144, v153, 4, 1
v_xor_b32 v141, v141, v144
v_sub_u32 v141, v141, v142
v_mul_i32_i24 v141, 9, v141
v_add_u32 v143, v143, v141
v_lshrrev_b32_e64 v141, 1, v143
v_mul_u32_u24 v141, 368, v141
v_lshl_add_u32 v143, v143, 3, v141
v_lshl_add_u32 v143, v142, 7, v143
v_and_b32_e64 v144, 7, v153
v_lshl_add_u32 v143, v144, 4, v143
v_add_u32 v157, 156672, v143
v_add_u32 v154, 512, v199
v_mul_u32_u24 v140, 683, v154
v_lshrrev_b32 v140, 16, v140
v_mul_u32_u24 v142, 11, v140
v_lshrrev_b32 v142, 5, v142
v_lshrrev_b32 v143, 5, v154
v_bfe_u32 v141, v154, 3, 2
v_bfe_u32 v144, v154, 4, 1
v_xor_b32 v141, v141, v144
v_sub_u32 v141, v141, v142
v_mul_i32_i24 v141, 9, v141
v_add_u32 v143, v143, v141
v_lshrrev_b32_e64 v141, 1, v143
v_mul_u32_u24 v141, 368, v141
v_lshl_add_u32 v143, v143, 3, v141
v_lshl_add_u32 v143, v142, 7, v143
v_and_b32_e64 v144, 7, v154
v_lshl_add_u32 v143, v144, 4, v143
v_add_u32 v158, 156672, v143
v_mul_u32_u24 v140, 683, v155
v_lshrrev_b32 v140, 16, v140
v_mul_u32_u24 v142, 11, v140
v_lshrrev_b32 v142, 5, v142
v_lshrrev_b32 v143, 5, v155
v_bfe_u32 v141, v155, 3, 2
v_bfe_u32 v144, v155, 4, 1
v_xor_b32 v141, v141, v144
v_sub_u32 v141, v141, v142
v_mul_i32_i24 v141, 9, v141
v_add_u32 v143, v143, v141
v_lshrrev_b32_e64 v141, 1, v143
v_mul_u32_u24 v141, 368, v141
v_lshl_add_u32 v143, v143, 3, v141
v_lshl_add_u32 v143, v142, 7, v143
v_and_b32_e64 v144, 7, v155
v_lshl_add_u32 v143, v144, 4, v143
v_add_u32 v159, 156672, v143
v_mov_b32 v160, 0
v_mov_b32 v161, 0
v_mov_b32_e64 v162, 0
v_mov_b32 v163, 0
s_mov_b64 exec, 1
ds_write_b128 v253, v[160:163]
ds_write_b128 v253, v[160:163] offset:16
s_mov_b64 exec, -1
s_waitcnt vmcnt(6)
v_and_b32_e64 v130, 4, v152
v_cmp_eq_u32 vcc, 0, v130
s_nop 1
v_cndmask_b32 v164, 0, v126, vcc
v_sub_u32 v165, v126, v164
ds_write_b64 v156, v[164:165]
v_and_b32_e64 v130, 4, v153
v_cmp_eq_u32 vcc, 0, v130
s_nop 1
v_cndmask_b32 v166, 0, v127, vcc
v_sub_u32 v167, v127, v166
ds_write_b64 v157, v[166:167]
v_and_b32_e64 v130, 4, v154
v_cmp_eq_u32 vcc, 0, v130
s_nop 1
v_cndmask_b32 v168, 0, v128, vcc
v_sub_u32 v169, v128, v168
ds_write_b64 v158, v[168:169]
v_and_b32_e64 v130, 4, v155
v_cmp_eq_u32 vcc, 0, v130
s_nop 1
v_cndmask_b32 v170, 0, v129, vcc
v_sub_u32 v171, v129, v170
ds_write_b64 v159, v[170:171]
s_waitcnt lgkmcnt(0)
Lnoo:
s_barrier
s_cmp_lt_u32 s40, 4
s_cbranch_scc1 Lnoy2
v_subrev_u32 v199, 256, v199
v_lshlrev_b32_e64 v24, 6, v199
s_mov_b32 s43, 1065362610
v_mov_b32 v25, 1084047360
v_add_u32 v0, 32772, v24
v_add_u32 v1, 32780, v24
v_add_u32 v2, 32788, v24
v_add_u32 v3, 32796, v24
v_add_u32 v4, 32804, v24
v_add_u32 v5, 32812, v24
v_add_u32 v6, 32820, v24
v_add_u32 v7, 32828, v24
v_cvt_f32_f16 v0, v0
v_cvt_f32_f16 v1, v1
v_cvt_f32_f16 v2, v2
v_cvt_f32_f16 v3, v3
v_cvt_f32_f16 v4, v4
v_cvt_f32_f16 v5, v5
v_cvt_f32_f16 v6, v6
v_cvt_f32_f16 v7, v7
v_mul_f32 v8, v0, v0
v_mul_f32 v9, v1, v1
v_mul_f32 v10, v2, v2
v_mul_f32 v11, v3, v3
v_mul_f32 v12, v4, v4
v_mul_f32 v13, v5, v5
v_mul_f32 v14, v6, v6
v_mul_f32 v15, v7, v7
v_fma_f32 v8, v8, s43, v25
v_fma_f32 v9, v9, s43, v25
v_fma_f32 v10, v10, s43, v25
v_fma_f32 v11, v11, s43, v25
v_fma_f32 v12, v12, s43, v25
v_fma_f32 v13, v13, s43, v25
v_fma_f32 v14, v14, s43, v25
v_fma_f32 v15, v15, s43, v25
v_mul_f32 v8, v0, v8
v_mul_f32 v9, v1, v9
v_mul_f32 v10, v2, v10
v_mul_f32 v11, v3, v11
v_mul_f32 v12, v4, v12
v_mul_f32 v13, v5, v13
v_mul_f32 v14, v6, v14
v_mul_f32 v15, v7, v15
v_exp_f32 v8, v8
v_exp_f32 v9, v9
v_exp_f32 v10, v10
v_exp_f32 v11, v11
v_exp_f32 v12, v12
v_exp_f32 v13, v13
v_exp_f32 v14, v14
v_exp_f32 v15, v15
v_add_f32 v16, 1.0, v8
v_add_f32 v17, 1.0, v9
v_add_f32 v18, 1.0, v10
v_add_f32 v19, 1.0, v11
v_add_f32 v20, 1.0, v12
v_add_f32 v21, 1.0, v13
v_add_f32 v22, 1.0, v14
v_add_f32 v23, 1.0, v15
v_rcp_f32 v16, v16
v_rcp_f32 v17, v17
v_rcp_f32 v18, v18
v_rcp_f32 v19, v19
v_rcp_f32 v20, v20
v_rcp_f32 v21, v21
v_rcp_f32 v22, v22
v_rcp_f32 v23, v23
v_mul_f32 v0, v0, v16
v_mul_f32 v1, v1, v17
v_mul_f32 v2, v2, v18
v_mul_f32 v3, v3, v19
v_mul_f32 v4, v4, v20
v_mul_f32 v5, v5, v21
v_mul_f32 v6, v6, v22
v_mul_f32 v7, v7, v23
v_mul_f32 v8, v8, v0
v_mul_f32 v9, v9, v1
v_mul_f32 v10, v10, v2
v_mul_f32 v11, v11, v3
v_mul_f32 v12, v12, v4
v_mul_f32 v13, v13, v5
v_mul_f32 v14, v14, v6
v_mul_f32 v15, v15, v7
v_cvt_pk_f16_f32 v28, v0, v1
v_cvt_pk_f16_f32 v32, -v8, -v9
v_cvt_pk_f16_f32 v29, v2, v3
v_cvt_pk_f16_f32 v33, -v10, -v11
v_cvt_pk_f16_f32 v30, v4, v5
v_cvt_pk_f16_f32 v34, -v12, -v13
v_cvt_pk_f16_f32 v31, v6, v7
v_cvt_pk_f16_f32 v35, -v14, -v15
v_lshlrev_b32 v24, 4, v199
v_mov_b32 v25, 163840
s_movk_i32 s43, 496
v_cmp_gt_u32 vcc, s43, v199
s_nop 1
v_cndmask_b32 v24, v25, v24, vcc
ds_write_b128 v24, v[32:35]
ds_write_b128 v24, v[28:31] offset:8192
Lnoy2:
s_setprio 2
s_cmp_lt_u32 s40, 4
s_cbranch_scc0 Lsu0
s_call_b64 s[78:79], Lpre
s_call_b64 s[78:79], Lrb
s_waitcnt vmcnt(4)
s_mov_b64 exec, 1
ds_add_u32 v253, v254 offset:28
s_mov_b64 exec, -1
v_mov_b32 v253, 16256
Lsw288w:
ds_read_b32 v247, v253 offset:28
s_waitcnt lgkmcnt(0)
v_readfirstlane_b32 s43, v247
s_cmp_eq_u32 s76, 0
s_cbranch_scc1 Lsw288x
s_sub_u32 s76, s76, 1
s_cmp_lt_u32 s43, 8
s_cbranch_scc0 Lsw288x
s_sleep 2
s_branch Lsw288w
Lsw288x:
s_call_b64 s[78:79], Lconv0
s_mov_b64 exec, 1
ds_add_u32 v253, v254 offset:16
s_mov_b64 exec, -1
s_call_b64 s[78:79], Lln0
s_waitcnt vmcnt(0)
s_mov_b64 exec, 1
ds_add_u32 v253, v254 offset:12
s_mov_b64 exec, -1
Lsu0:
s_cmp_ge_u32 s40, 4
s_cbranch_scc0 Lsu2
s_setprio 3
s_call_b64 s[78:79], Lw1f
s_waitcnt vmcnt(6)
s_mov_b64 exec, 1
ds_add_u32 v253, v254 offset:28
s_mov_b64 exec, -1
s_call_b64 s[78:79], Lrb
s_waitcnt vmcnt(4)
s_call_b64 s[78:79], Lw1a
s_mov_b64 exec, 1
ds_add_u32 v253, v254 offset:20
s_mov_b64 exec, -1
s_call_b64 s[78:79], Lw1i
s_call_b64 s[78:79], Lpre
s_waitcnt vmcnt(12)
s_mov_b64 exec, 1
ds_add_u32 v253, v254 offset:12
s_mov_b64 exec, -1
v_mov_b32 v253, 16256
Lsw128w:
ds_read_b32 v247, v253 offset:12
s_waitcnt lgkmcnt(0)
v_readfirstlane_b32 s43, v247
s_cmp_eq_u32 s76, 0
s_cbranch_scc1 Lsw128x
s_sub_u32 s76, s76, 1
s_cmp_lt_u32 s43, 8
s_cbranch_scc0 Lsw128x
s_sleep 2
s_branch Lsw128w
Lsw128x:
s_call_b64 s[78:79], Lconv0
s_mov_b64 exec, 1
ds_add_u32 v253, v254 offset:16
s_mov_b64 exec, -1
s_call_b64 s[78:79], Lw1b
s_mov_b64 exec, 1
ds_add_u32 v253, v254 offset:24
s_mov_b64 exec, -1
s_call_b64 s[78:79], Lln0
Lsu2:
s_branch Lgo
Lconv0:
ds_read_b128 v[192:195], v242
ds_read_b128 v[196:199], v242 offset:64
ds_read_b128 v[200:203], v242 offset:128
ds_read_b128 v[204:207], v243
ds_read_b128 v[208:211], v243 offset:64
ds_read_b128 v[212:215], v243 offset:128
ds_read_b128 v[224:227], v244
ds_read_b128 v[228:231], v244 offset:64
ds_read_b128 v[232:235], v244 offset:128
v_xor_b32 v242, 16, v242
ds_read_b128 v[236:239], v242
ds_read_b128 v[216:219], v242 offset:64
ds_read_b128 v[220:223], v242 offset:128
s_waitcnt lgkmcnt(11)
v_smfmac_f32_16x16x32_bf16 v[0:3], v[48:49], v[192:195], v246
s_waitcnt lgkmcnt(10)
v_smfmac_f32_16x16x32_bf16 v[16:19], v[50:51], v[196:199], v246
s_waitcnt lgkmcnt(9)
v_smfmac_f32_16x16x32_bf16 v[32:35], v[52:53], v[200:203], v246
s_waitcnt lgkmcnt(8)
v_xor_b32 v243, 16, v243
ds_read_b128 v[192:195], v243
ds_read_b128 v[196:199], v243 offset:64
v_smfmac_f32_16x16x32_bf16 v[0:3], v[54:55], v[204:207], v246
s_waitcnt lgkmcnt(9)
v_smfmac_f32_16x16x32_bf16 v[16:19], v[56:57], v[208:211], v246
s_waitcnt lgkmcnt(8)
ds_read_b128 v[200:203], v243 offset:128
v_xor_b32 v244, 16, v244
ds_read_b128 v[204:207], v244
v_smfmac_f32_16x16x32_bf16 v[32:35], v[58:59], v[212:215], v246
s_waitcnt lgkmcnt(9)
v_smfmac_f32_16x16x32_bf16 v[0:3], v[60:61], v[224:227], v246
s_waitcnt lgkmcnt(8)
ds_read_b128 v[208:211], v244 offset:64
ds_read_b128 v[212:215], v244 offset:128
v_smfmac_f32_16x16x32_bf16 v[16:19], v[62:63], v[228:231], v246
s_waitcnt lgkmcnt(9)
v_smfmac_f32_16x16x32_bf16 v[32:35], v[64:65], v[232:235], v246
s_waitcnt lgkmcnt(8)
v_xor_b32 v242, 32, v242
ds_read_b128 v[224:227], v242
ds_read_b128 v[228:231], v242 offset:64
v_smfmac_f32_16x16x32_bf16 v[4:7], v[66:67], v[236:239], v246
s_waitcnt lgkmcnt(9)
v_smfmac_f32_16x16x32_bf16 v[20:23], v[68:69], v[216:219], v246
s_waitcnt lgkmcnt(8)
ds_read_b128 v[232:235], v242 offset:128
v_xor_b32 v243, 32, v243
ds_read_b128 v[236:239], v243
v_smfmac_f32_16x16x32_bf16 v[36:39], v[70:71], v[220:223], v246
s_waitcnt lgkmcnt(9)
v_smfmac_f32_16x16x32_bf16 v[4:7], v[72:73], v[192:195], v246
s_waitcnt lgkmcnt(8)
ds_read_b128 v[216:219], v243 offset:64
ds_read_b128 v[220:223], v243 offset:128
v_smfmac_f32_16x16x32_bf16 v[20:23], v[74:75], v[196:199], v246
s_waitcnt lgkmcnt(9)
v_smfmac_f32_16x16x32_bf16 v[36:39], v[76:77], v[200:203], v246
s_waitcnt lgkmcnt(8)
v_xor_b32 v244, 32, v244
ds_read_b128 v[192:195], v244
ds_read_b128 v[196:199], v244 offset:64
v_smfmac_f32_16x16x32_bf16 v[4:7], v[78:79], v[204:207], v246
s_waitcnt lgkmcnt(9)
v_smfmac_f32_16x16x32_bf16 v[20:23], v[80:81], v[208:211], v246
s_waitcnt lgkmcnt(8)
ds_read_b128 v[200:203], v244 offset:128
v_xor_b32 v242, 16, v242
ds_read_b128 v[204:207], v242
v_smfmac_f32_16x16x32_bf16 v[36:39], v[82:83], v[212:215], v246
s_waitcnt lgkmcnt(9)
v_smfmac_f32_16x16x32_bf16 v[12:15], v[84:85], v[224:227], v246
s_waitcnt lgkmcnt(8)
ds_read_b128 v[208:211], v242 offset:64
ds_read_b128 v[212:215], v242 offset:128
v_smfmac_f32_16x16x32_bf16 v[28:31], v[86:87], v[228:231], v246
s_waitcnt lgkmcnt(9)
v_smfmac_f32_16x16x32_bf16 v[44:47], v[88:89], v[232:235], v246
s_waitcnt lgkmcnt(8)
v_xor_b32 v243, 16, v243
ds_read_b128 v[224:227], v243
ds_read_b128 v[228:231], v243 offset:64
v_smfmac_f32_16x16x32_bf16 v[12:15], v[90:91], v[236:239], v246
s_waitcnt lgkmcnt(9)
v_smfmac_f32_16x16x32_bf16 v[28:31], v[92:93], v[216:219], v246
s_waitcnt lgkmcnt(8)
ds_read_b128 v[232:235], v243 offset:128
v_xor_b32 v244, 16, v244
ds_read_b128 v[236:239], v244
v_smfmac_f32_16x16x32_bf16 v[44:47], v[94:95], v[220:223], v246
s_waitcnt lgkmcnt(9)
v_smfmac_f32_16x16x32_bf16 v[12:15], v[96:97], v[192:195], v246
s_waitcnt lgkmcnt(8)
ds_read_b128 v[216:219], v244 offset:64
ds_read_b128 v[220:223], v244 offset:128
v_smfmac_f32_16x16x32_bf16 v[28:31], v[98:99], v[196:199], v246
s_waitcnt lgkmcnt(9)
v_smfmac_f32_16x16x32_bf16 v[44:47], v[100:101], v[200:203], v246
s_waitcnt lgkmcnt(8)
v_smfmac_f32_16x16x32_bf16 v[8:11], v[102:103], v[204:207], v246
s_waitcnt lgkmcnt(7)
v_smfmac_f32_16x16x32_bf16 v[24:27], v[104:105], v[208:211], v246
s_waitcnt lgkmcnt(6)
v_smfmac_f32_16x16x32_bf16 v[40:43], v[106:107], v[212:215], v246
s_waitcnt lgkmcnt(5)
v_smfmac_f32_16x16x32_bf16 v[8:11], v[108:109], v[224:227], v246
s_waitcnt lgkmcnt(4)
v_smfmac_f32_16x16x32_bf16 v[24:27], v[110:111], v[228:231], v246
s_waitcnt lgkmcnt(3)
v_smfmac_f32_16x16x32_bf16 v[40:43], v[112:113], v[232:235], v246
s_waitcnt lgkmcnt(2)
v_smfmac_f32_16x16x32_bf16 v[8:11], v[114:115], v[236:239], v246
s_waitcnt lgkmcnt(1)
v_smfmac_f32_16x16x32_bf16 v[24:27], v[116:117], v[216:219], v246
s_waitcnt lgkmcnt(0)
v_smfmac_f32_16x16x32_bf16 v[40:43], v[118:119], v[220:223], v246
s_nop 11
s_setpc_b64 s[78:79]
Lln0:
v_pk_add_f32 v[168:169], v[0:1], v[2:3]
v_pk_mul_f32 v[170:171], v[0:1], v[0:1]
v_pk_fma_f32 v[170:171], v[2:3], v[2:3], v[170:171]
v_pk_add_f32 v[168:169], v[168:169], v[4:5]
v_pk_fma_f32 v[170:171], v[4:5], v[4:5], v[170:171]
v_pk_add_f32 v[168:169], v[168:169], v[6:7]
v_pk_fma_f32 v[170:171], v[6:7], v[6:7], v[170:171]
v_pk_add_f32 v[168:169], v[168:169], v[8:9]
v_pk_fma_f32 v[170:171], v[8:9], v[8:9], v[170:171]
v_pk_add_f32 v[168:169], v[168:169], v[10:11]
v_pk_fma_f32 v[170:171], v[10:11], v[10:11], v[170:171]
v_pk_add_f32 v[168:169], v[168:169], v[12:13]
v_pk_fma_f32 v[170:171], v[12:13], v[12:13], v[170:171]
v_pk_add_f32 v[168:169], v[168:169], v[14:15]
v_pk_fma_f32 v[170:171], v[14:15], v[14:15], v[170:171]
v_pk_add_f32 v[168:169], v[168:169], v[16:17]
v_pk_fma_f32 v[170:171], v[16:17], v[16:17], v[170:171]
v_pk_add_f32 v[168:169], v[168:169], v[18:19]
v_pk_fma_f32 v[170:171], v[18:19], v[18:19], v[170:171]
v_pk_add_f32 v[168:169], v[168:169], v[20:21]
v_pk_fma_f32 v[170:171], v[20:21], v[20:21], v[170:171]
v_pk_add_f32 v[168:169], v[168:169], v[22:23]
v_pk_fma_f32 v[170:171], v[22:23], v[22:23], v[170:171]
v_pk_add_f32 v[168:169], v[168:169], v[24:25]
v_pk_fma_f32 v[170:171], v[24:25], v[24:25], v[170:171]
v_pk_add_f32 v[168:169], v[168:169], v[26:27]
v_pk_fma_f32 v[170:171], v[26:27], v[26:27], v[170:171]
v_pk_add_f32 v[168:169], v[168:169], v[28:29]
v_pk_fma_f32 v[170:171], v[28:29], v[28:29], v[170:171]
v_pk_add_f32 v[168:169], v[168:169], v[30:31]
v_pk_fma_f32 v[170:171], v[30:31], v[30:31], v[170:171]
v_pk_add_f32 v[168:169], v[168:169], v[32:33]
v_pk_fma_f32 v[170:171], v[32:33], v[32:33], v[170:171]
v_pk_add_f32 v[168:169], v[168:169], v[34:35]
v_pk_fma_f32 v[170:171], v[34:35], v[34:35], v[170:171]
v_pk_add_f32 v[168:169], v[168:169], v[36:37]
v_pk_fma_f32 v[170:171], v[36:37], v[36:37], v[170:171]
v_pk_add_f32 v[168:169], v[168:169], v[38:39]
v_pk_fma_f32 v[170:171], v[38:39], v[38:39], v[170:171]
v_pk_add_f32 v[168:169], v[168:169], v[40:41]
v_pk_fma_f32 v[170:171], v[40:41], v[40:41], v[170:171]
v_pk_add_f32 v[168:169], v[168:169], v[42:43]
v_pk_fma_f32 v[170:171], v[42:43], v[42:43], v[170:171]
v_pk_add_f32 v[168:169], v[168:169], v[44:45]
v_pk_fma_f32 v[170:171], v[44:45], v[44:45], v[170:171]
v_pk_add_f32 v[168:169], v[168:169], v[46:47]
v_pk_fma_f32 v[170:171], v[46:47], v[46:47], v[170:171]
v_add_f32 v168, v168, v169
v_add_f32 v170, v170, v171
s_nop 1
v_permlane32_swap_b32 v168, v170
v_add_f32_e64 v168, v168, v170
v_mul_f32 v168, 1009429163, v168
v_mov_b32_e64 v170, v168
s_nop 1
v_permlane32_swap_b32 v168, v170
v_fma_f32 v170, -v168, v168, v170
v_max_f32_e64 v170, 0, v170
v_add_f32 v170, 925353388, v170
v_rsq_f32 v170, v170
s_nop 0
v_mul_f32 v172, 3203391086, v170
v_mul_f32_e64 v173, v168, v172
v_pk_fma_f32 v[0:1], v[0:1], v[172:173], v[172:173] op_sel:[0,0,1] op_sel_hi:[1,0,1] neg_lo:[0,0,1] neg_hi:[0,0,1]
v_pk_fma_f32 v[2:3], v[2:3], v[172:173], v[172:173] op_sel:[0,0,1] op_sel_hi:[1,0,1] neg_lo:[0,0,1] neg_hi:[0,0,1]
v_pk_fma_f32 v[4:5], v[4:5], v[172:173], v[172:173] op_sel:[0,0,1] op_sel_hi:[1,0,1] neg_lo:[0,0,1] neg_hi:[0,0,1]
v_pk_fma_f32 v[6:7], v[6:7], v[172:173], v[172:173] op_sel:[0,0,1] op_sel_hi:[1,0,1] neg_lo:[0,0,1] neg_hi:[0,0,1]
v_pk_fma_f32 v[8:9], v[8:9], v[172:173], v[172:173] op_sel:[0,0,1] op_sel_hi:[1,0,1] neg_lo:[0,0,1] neg_hi:[0,0,1]
v_pk_fma_f32 v[10:11], v[10:11], v[172:173], v[172:173] op_sel:[0,0,1] op_sel_hi:[1,0,1] neg_lo:[0,0,1] neg_hi:[0,0,1]
v_pk_fma_f32 v[12:13], v[12:13], v[172:173], v[172:173] op_sel:[0,0,1] op_sel_hi:[1,0,1] neg_lo:[0,0,1] neg_hi:[0,0,1]
v_pk_fma_f32 v[14:15], v[14:15], v[172:173], v[172:173] op_sel:[0,0,1] op_sel_hi:[1,0,1] neg_lo:[0,0,1] neg_hi:[0,0,1]
v_pk_fma_f32 v[16:17], v[16:17], v[172:173], v[172:173] op_sel:[0,0,1] op_sel_hi:[1,0,1] neg_lo:[0,0,1] neg_hi:[0,0,1]
v_pk_fma_f32 v[18:19], v[18:19], v[172:173], v[172:173] op_sel:[0,0,1] op_sel_hi:[1,0,1] neg_lo:[0,0,1] neg_hi:[0,0,1]
v_pk_fma_f32 v[20:21], v[20:21], v[172:173], v[172:173] op_sel:[0,0,1] op_sel_hi:[1,0,1] neg_lo:[0,0,1] neg_hi:[0,0,1]
v_pk_fma_f32 v[22:23], v[22:23], v[172:173], v[172:173] op_sel:[0,0,1] op_sel_hi:[1,0,1] neg_lo:[0,0,1] neg_hi:[0,0,1]
v_pk_fma_f32 v[24:25], v[24:25], v[172:173], v[172:173] op_sel:[0,0,1] op_sel_hi:[1,0,1] neg_lo:[0,0,1] neg_hi:[0,0,1]
v_pk_fma_f32 v[26:27], v[26:27], v[172:173], v[172:173] op_sel:[0,0,1] op_sel_hi:[1,0,1] neg_lo:[0,0,1] neg_hi:[0,0,1]
v_pk_fma_f32 v[28:29], v[28:29], v[172:173], v[172:173] op_sel:[0,0,1] op_sel_hi:[1,0,1] neg_lo:[0,0,1] neg_hi:[0,0,1]
v_pk_fma_f32 v[30:31], v[30:31], v[172:173], v[172:173] op_sel:[0,0,1] op_sel_hi:[1,0,1] neg_lo:[0,0,1] neg_hi:[0,0,1]
v_pk_fma_f32 v[32:33], v[32:33], v[172:173], v[172:173] op_sel:[0,0,1] op_sel_hi:[1,0,1] neg_lo:[0,0,1] neg_hi:[0,0,1]
v_pk_fma_f32 v[34:35], v[34:35], v[172:173], v[172:173] op_sel:[0,0,1] op_sel_hi:[1,0,1] neg_lo:[0,0,1] neg_hi:[0,0,1]
v_pk_fma_f32 v[36:37], v[36:37], v[172:173], v[172:173] op_sel:[0,0,1] op_sel_hi:[1,0,1] neg_lo:[0,0,1] neg_hi:[0,0,1]
v_pk_fma_f32 v[38:39], v[38:39], v[172:173], v[172:173] op_sel:[0,0,1] op_sel_hi:[1,0,1] neg_lo:[0,0,1] neg_hi:[0,0,1]
v_pk_fma_f32 v[40:41], v[40:41], v[172:173], v[172:173] op_sel:[0,0,1] op_sel_hi:[1,0,1] neg_lo:[0,0,1] neg_hi:[0,0,1]
v_pk_fma_f32 v[42:43], v[42:43], v[172:173], v[172:173] op_sel:[0,0,1] op_sel_hi:[1,0,1] neg_lo:[0,0,1] neg_hi:[0,0,1]
v_pk_fma_f32 v[44:45], v[44:45], v[172:173], v[172:173] op_sel:[0,0,1] op_sel_hi:[1,0,1] neg_lo:[0,0,1] neg_hi:[0,0,1]
v_pk_fma_f32 v[46:47], v[46:47], v[172:173], v[172:173] op_sel:[0,0,1] op_sel_hi:[1,0,1] neg_lo:[0,0,1] neg_hi:[0,0,1]
v_cvt_pk_bf16_f32 v48, v0, v1
v_cvt_pk_bf16_f32 v49, v2, v3
v_cvt_pk_bf16_f32 v50, v4, v5
v_cvt_pk_bf16_f32 v51, v6, v7
v_cvt_pk_bf16_f32 v52, v8, v9
v_cvt_pk_bf16_f32 v53, v10, v11
v_cvt_pk_bf16_f32 v54, v12, v13
v_cvt_pk_bf16_f32 v55, v14, v15
v_cvt_pk_bf16_f32 v56, v16, v17
v_cvt_pk_bf16_f32 v57, v18, v19
v_cvt_pk_bf16_f32 v58, v20, v21
v_cvt_pk_bf16_f32 v59, v22, v23
v_cvt_pk_bf16_f32 v60, v24, v25
v_cvt_pk_bf16_f32 v61, v26, v27
v_cvt_pk_bf16_f32 v62, v28, v29
v_cvt_pk_bf16_f32 v63, v30, v31
v_cvt_pk_bf16_f32 v64, v32, v33
v_cvt_pk_bf16_f32 v65, v34, v35
v_cvt_pk_bf16_f32 v66, v36, v37
v_cvt_pk_bf16_f32 v67, v38, v39
v_cvt_pk_bf16_f32 v68, v40, v41
v_cvt_pk_bf16_f32 v69, v42, v43
v_cvt_pk_bf16_f32 v70, v44, v45
v_cvt_pk_bf16_f32 v71, v46, v47
s_nop 1
s_setpc_b64 s[78:79]
Lw1a:
ds_read_b64_tr_b16 v[148:149], v146
ds_read_b64_tr_b16 v[150:151], v146 offset:512
ds_read_b64_tr_b16 v[152:153], v146 offset:1024
ds_read_b64_tr_b16 v[154:155], v146 offset:1536
ds_read_b64_tr_b16 v[156:157], v146 offset:2048
ds_read_b64_tr_b16 v[158:159], v146 offset:2560
ds_read_b64_tr_b16 v[160:161], v146 offset:3072
ds_read_b64_tr_b16 v[162:163], v146 offset:3584
ds_read_b64_tr_b16 v[164:165], v146 offset:4096
ds_read_b64_tr_b16 v[166:167], v146 offset:4608
ds_read_b64_tr_b16 v[168:169], v146 offset:5120
ds_read_b64_tr_b16 v[170:171], v146 offset:5632
s_waitcnt lgkmcnt(10)
ds_write_b128 v147, v[148:151]
s_waitcnt lgkmcnt(9)
ds_write_b128 v147, v[152:155] offset:1024
s_waitcnt lgkmcnt(8)
ds_write_b128 v147, v[156:159] offset:2048
s_waitcnt lgkmcnt(7)
ds_write_b128 v147, v[160:163] offset:3072
s_waitcnt lgkmcnt(6)
ds_write_b128 v147, v[164:167] offset:4096
s_waitcnt lgkmcnt(5)
ds_write_b128 v147, v[168:171] offset:5120
s_waitcnt lgkmcnt(0)
s_setpc_b64 s[78:79]
Lw1i:
s_add_u32 m0, s77, 24576
s_add_u32 s43, s3, 256
buffer_load_dwordx4 v145, s[12:15], s43 offen lds
s_add_u32 m0, s77, 25600
s_add_u32 s43, s3, 24832
buffer_load_dwordx4 v145, s[12:15], s43 offen lds
s_add_u32 m0, s77, 26624
s_add_u32 s43, s3, 49408
buffer_load_dwordx4 v145, s[12:15], s43 offen lds
s_add_u32 m0, s77, 27648
s_add_u32 s43, s3, 12544
buffer_load_dwordx4 v145, s[12:15], s43 offen lds
s_add_u32 m0, s77, 28672
s_add_u32 s43, s3, 37120
buffer_load_dwordx4 v145, s[12:15], s43 offen lds
s_add_u32 m0, s77, 29696
s_add_u32 s43, s3, 61696
buffer_load_dwordx4 v145, s[12:15], s43 offen lds
s_add_u32 m0, s77, 49152
s_add_u32 s43, s3, 512
buffer_load_dwordx4 v145, s[12:15], s43 offen lds
s_add_u32 m0, s77, 50176
s_add_u32 s43, s3, 25088
buffer_load_dwordx4 v145, s[12:15], s43 offen lds
s_add_u32 m0, s77, 51200
s_add_u32 s43, s3, 49664
buffer_load_dwordx4 v145, s[12:15], s43 offen lds
s_add_u32 m0, s77, 52224
s_add_u32 s43, s3, 12800
buffer_load_dwordx4 v145, s[12:15], s43 offen lds
s_add_u32 m0, s77, 53248
s_add_u32 s43, s3, 37376
buffer_load_dwordx4 v145, s[12:15], s43 offen lds
s_add_u32 m0, s77, 54272
s_add_u32 s43, s3, 61952
buffer_load_dwordx4 v145, s[12:15], s43 offen lds
s_setpc_b64 s[78:79]
Lw1b:
s_waitcnt vmcnt(0)
ds_read_b64_tr_b16 v[72:73], v146 offset:24576
ds_read_b64_tr_b16 v[74:75], v146 offset:25088
ds_read_b64_tr_b16 v[76:77], v146 offset:25600
ds_read_b64_tr_b16 v[78:79], v146 offset:26112
ds_read_b64_tr_b16 v[80:81], v146 offset:26624
ds_read_b64_tr_b16 v[82:83], v146 offset:27136
ds_read_b64_tr_b16 v[84:85], v146 offset:27648
ds_read_b64_tr_b16 v[86:87], v146 offset:28160
ds_read_b64_tr_b16 v[88:89], v146 offset:28672
ds_read_b64_tr_b16 v[90:91], v146 offset:29184
ds_read_b64_tr_b16 v[92:93], v146 offset:29696
ds_read_b64_tr_b16 v[94:95], v146 offset:30208
ds_read_b64_tr_b16 v[96:97], v146 offset:49152
ds_read_b64_tr_b16 v[98:99], v146 offset:49664
ds_read_b64_tr_b16 v[100:101], v146 offset:50176
ds_read_b64_tr_b16 v[102:103], v146 offset:50688
ds_read_b64_tr_b16 v[104:105], v146 offset:51200
ds_read_b64_tr_b16 v[106:107], v146 offset:51712
ds_read_b64_tr_b16 v[108:109], v146 offset:52224
ds_read_b64_tr_b16 v[110:111], v146 offset:52736
ds_read_b64_tr_b16 v[112:113], v146 offset:53248
ds_read_b64_tr_b16 v[114:115], v146 offset:53760
ds_read_b64_tr_b16 v[116:117], v146 offset:54272
ds_read_b64_tr_b16 v[118:119], v146 offset:54784
s_waitcnt lgkmcnt(15)
ds_write_b128 v147, v[72:75] offset:24576
ds_write_b128 v147, v[76:79] offset:25600
ds_write_b128 v147, v[80:83] offset:26624
ds_write_b128 v147, v[84:87] offset:27648
s_waitcnt lgkmcnt(15)
ds_write_b128 v147, v[88:91] offset:28672
ds_write_b128 v147, v[92:95] offset:29696
s_waitcnt lgkmcnt(15)
ds_write_b128 v147, v[96:99] offset:49152
s_waitcnt lgkmcnt(15)
ds_write_b128 v147, v[100:103] offset:50176
s_waitcnt lgkmcnt(14)
ds_write_b128 v147, v[104:107] offset:51200
s_waitcnt lgkmcnt(13)
ds_write_b128 v147, v[108:111] offset:52224
s_waitcnt lgkmcnt(12)
ds_write_b128 v147, v[112:115] offset:53248
s_waitcnt lgkmcnt(11)
ds_write_b128 v147, v[116:119] offset:54272
s_waitcnt lgkmcnt(0)
s_setpc_b64 s[78:79]
Lpre:
ds_read_b128 v[48:51], v245
ds_read_b128 v[52:55], v245 offset:384
ds_read_b128 v[56:59], v245 offset:768
ds_read_b128 v[60:63], v245 offset:1152
ds_read_b128 v[64:67], v245 offset:1536
ds_read_b128 v[68:71], v245 offset:1920
ds_read_b128 v[72:75], v245 offset:2304
ds_read_b128 v[76:79], v245 offset:2688
ds_read_b128 v[80:83], v245 offset:3072
ds_read_b128 v[84:87], v245 offset:3456
ds_read_b128 v[88:91], v245 offset:3840
ds_read_b128 v[92:95], v245 offset:4224
ds_read_b128 v[96:99], v245 offset:4608
ds_read_b128 v[100:103], v245 offset:4992
ds_read_b128 v[104:107], v245 offset:5376
ds_read_b128 v[108:111], v245 offset:5760
ds_read_b128 v[112:115], v245 offset:6144
ds_read_b128 v[116:119], v245 offset:6528
v_mov_b32 v0, 0
v_mov_b32 v1, 0
v_mov_b32 v2, 0
v_mov_b32 v3, 0
v_mov_b32 v4, 0
v_mov_b32 v5, 0
v_mov_b32 v6, 0
v_mov_b32 v7, 0
v_mov_b32 v8, 0
v_mov_b32 v9, 0
v_mov_b32 v10, 0
v_mov_b32 v11, 0
v_mov_b32 v12, 0
v_mov_b32 v13, 0
v_mov_b32 v14, 0
v_mov_b32 v15, 0
v_mov_b32 v16, 0
v_mov_b32 v17, 0
v_mov_b32 v18, 0
v_mov_b32 v19, 0
v_mov_b32 v20, 0
v_mov_b32 v21, 0
v_mov_b32 v22, 0
v_mov_b32 v23, 0
v_mov_b32 v24, 0
v_mov_b32 v25, 0
v_mov_b32 v26, 0
v_mov_b32 v27, 0
v_mov_b32 v28, 0
v_mov_b32 v29, 0
v_mov_b32 v30, 0
v_mov_b32 v31, 0
v_mov_b32 v32, 0
v_mov_b32 v33, 0
v_mov_b32 v34, 0
v_mov_b32 v35, 0
v_mov_b32 v36, 0
v_mov_b32 v37, 0
v_mov_b32 v38, 0
v_mov_b32 v39, 0
v_mov_b32 v40, 0
v_mov_b32 v41, 0
v_mov_b32 v42, 0
v_mov_b32 v43, 0
v_mov_b32 v44, 0
v_mov_b32 v45, 0
v_mov_b32_e64 v46, 0
v_mov_b32 v47, 0
s_waitcnt lgkmcnt(0)
s_setpc_b64 s[78:79]
Lrb:
s_add_u32 m0, s67, 39936
s_add_u32 s45, s66, 491520
buffer_load_dwordx4 v240, s[4:7], s45 offen nt lds
s_add_u32 m0, s67, 46592
s_add_u32 s45, s66, 589824
buffer_load_dwordx4 v240, s[4:7], s45 offen nt lds
s_add_u32 m0, s67, 53248
s_add_u32 s45, s66, 688128
buffer_load_dwordx4 v240, s[4:7], s45 offen nt lds
s_add_u32 m0, s67, 59904
s_add_u32 s45, s66, 786432
buffer_load_dwordx4 v240, s[4:7], s45 offen nt lds
s_setpc_b64 s[78:79]
Lw1f:
s_add_u32 m0, s77, 0
s_add_u32 s43, s3, 0
buffer_load_dwordx4 v145, s[12:15], s43 offen lds
s_add_u32 m0, s77, 1024
s_add_u32 s43, s3, 24576
buffer_load_dwordx4 v145, s[12:15], s43 offen lds
s_add_u32 m0, s77, 2048
s_add_u32 s43, s3, 49152
buffer_load_dwordx4 v145, s[12:15], s43 offen lds
s_add_u32 m0, s77, 3072
s_add_u32 s43, s3, 12288
buffer_load_dwordx4 v145, s[12:15], s43 offen lds
s_add_u32 m0, s77, 4096
s_add_u32 s43, s3, 36864
buffer_load_dwordx4 v145, s[12:15], s43 offen lds
s_add_u32 m0, s77, 5120
s_add_u32 s43, s3, 61440
buffer_load_dwordx4 v145, s[12:15], s43 offen lds
s_setpc_b64 s[78:79]
Lgo:
v_mov_b32 v253, 16256
Lsw204w:
ds_read_b32 v247, v253 offset:20
s_waitcnt lgkmcnt(0)
v_readfirstlane_b32 s43, v247
s_cmp_eq_u32 s76, 0
s_cbranch_scc1 Lsw204x
s_sub_u32 s76, s76, 1
s_cmp_lt_u32 s43, 4
s_cbranch_scc0 Lsw204x
s_sleep 2
s_branch Lsw204w
Lsw204x:
s_cmp_lg_u32 s40, 7
s_cbranch_scc1 Lnopf
s_getpc_b64 s[74:75]
Lpc:
s_lshr_b32 s43, s2, 3
s_and_b32 s43, s43, 15
s_lshl_b32 s43, s43, 13
v_lshlrev_b32 v178, 7, v251
v_add_u32 v178, s43, v178
v_min_u32 v178, Lend-Lpc, v178
global_load_dword v255, v178, s[74:75]
Lnopf:
s_add_u32 s66, s66, 786432
ds_read_b128 v[224:227], v248 offset:16384
ds_read_b128 v[228:231], v248 offset:19456
ds_read_b128 v[232:235], v248 offset:17408
ds_read_b128 v[236:239], v248 offset:20480
ds_read_b128 v[216:219], v248 offset:18432
ds_read_b128 v[220:223], v248 offset:21504
s_setprio 2
s_waitcnt lgkmcnt(5)
v_mfma_f32_32x32x16_bf16 v[120:135], v[48:51], v[224:227], 0
s_waitcnt lgkmcnt(4)
ds_read_b128 v[224:227], v248 offset:22528
v_mfma_f32_32x32x16_bf16 v[120:135], v[52:55], v[228:231], v[120:135]
s_waitcnt lgkmcnt(4)
ds_read_b128 v[228:231], v248 offset:25600
v_mfma_f32_32x32x16_bf16 v[120:135], v[56:59], v[232:235], v[120:135]
s_waitcnt lgkmcnt(4)
ds_read_b128 v[232:235], v248 offset:23552
v_mfma_f32_32x32x16_bf16 v[120:135], v[60:63], v[236:239], v[120:135]
s_waitcnt lgkmcnt(4)
ds_read_b128 v[236:239], v248 offset:26624
v_mfma_f32_32x32x16_bf16 v[120:135], v[64:67], v[216:219], v[120:135]
s_waitcnt lgkmcnt(4)
ds_read_b128 v[216:219], v248 offset:24576
v_mfma_f32_32x32x16_bf16 v[120:135], v[68:71], v[220:223], v[120:135]
v_add_u32 v174, -36864, v242
v_subrev_u32 v175, 66560, v174
v_min_u32 v174, v174, v175
v_add_u32 v174, 90112, v174
v_sub_u32 v175, v174, v242
v_add_u32 v242, v175, v242
v_add_u32_e64 v243, v175, v243
v_add_u32 v244, v175, v244
s_nop 3
v_cvt_pkrtz_f16_f32 v137, v120, v121
v_cvt_pkrtz_f16_f32 v139, v122, v123
v_cvt_pkrtz_f16_f32 v141, v124, v125
v_cvt_pkrtz_f16_f32 v143, v126, v127
v_cvt_pkrtz_f16_f32 v145, v128, v129
v_cvt_pk_f16_f32 v155, v130, v131
v_cvt_pk_f16_f32 v152, v132, v133
v_cvt_pk_f16_f32 v149, v134, v135
s_waitcnt lgkmcnt(1)
ds_read_b128 v[220:223], v248 offset:27648
v_mfma_f32_32x32x16_bf16 v[120:135], v[48:51], v[224:227], 0
v_pk_fma_f16 v154, v155, v155, s48
v_and_b32 v137, s49, v137
v_pk_fma_f16 v151, v152, v152, s48
v_and_b32_e64 v139, s49, v139
v_pk_fma_f16 v148, v149, v149, s48
v_pk_mul_f16 v154, v155, v154
v_bfe_u32 v136, v137, 2, 14
v_pk_mul_f16 v151, v152, v151
v_pk_mul_f16 v148, v149, v148
v_bfe_u32 v138, v139, 2, 14
ds_read_b128 v[224:227], v248 offset:28672
ds_read_u16_d16 v136, v136
ds_read_u16_d16 v138, v138
v_mfma_f32_32x32x16_bf16 v[120:135], v[52:55], v[228:231], v[120:135]
v_exp_f16 v153, v154
v_lshrrev_b32 v137, 18, v137
v_exp_f16 v150, v151
v_lshrrev_b32 v139, 18, v139
v_exp_f16 v147, v148
v_and_b32 v141, s49, v141
v_and_b32_e64 v143, s49, v143
ds_read_b128 v[228:231], v248 offset:31744
ds_read_u16_d16_hi v137, v137
ds_read_u16_d16_hi v139, v139
v_mfma_f32_32x32x16_bf16 v[120:135], v[56:59], v[232:235], v[120:135]
v_exp_f16_sdwa v153, v154 dst_sel:WORD_1 dst_unused:UNUSED_PRESERVE src0_sel:WORD_1
v_bfe_u32 v140, v141, 2, 14
v_exp_f16_sdwa v150, v151 dst_sel:WORD_1 dst_unused:UNUSED_PRESERVE src0_sel:WORD_1
v_bfe_u32 v142, v143, 2, 14
v_exp_f16_sdwa v147, v148 dst_sel:WORD_1 dst_unused:UNUSED_PRESERVE src0_sel:WORD_1
v_lshrrev_b32_e64 v141, 18, v141
v_pk_add_f16 v153, v153, 1.0 op_sel_hi:[1,0]
ds_read_b128 v[232:235], v248 offset:29696
ds_read_u16_d16 v140, v140
ds_read_u16_d16 v142, v142
ds_read_u16_d16_hi v141, v141
v_mfma_f32_32x32x16_bf16 v[120:135], v[60:63], v[236:239], v[120:135]
v_lshrrev_b32_e64 v143, 18, v143
v_pk_add_f16 v150, v150, 1.0 op_sel_hi:[1,0]
v_pk_add_f16 v147, v147, 1.0 op_sel_hi:[1,0]
v_and_b32 v145, s49, v145
v_rcp_f16 v154, v153
v_bfe_u32 v144, v145, 2, 14
v_rcp_f16_e64 v151, v150
v_lshrrev_b32 v145, 18, v145
s_waitcnt lgkmcnt(7)
ds_read_b128 v[236:239], v248 offset:32768
ds_read_u16_d16_hi v143, v143
ds_read_u16_d16 v144, v144
ds_read_u16_d16_hi v145, v145
v_mfma_f32_32x32x16_bf16 v[120:135], v[64:67], v[216:219], v[120:135]
v_rcp_f16_e64 v148, v147
v_rcp_f16_sdwa v154, v153 dst_sel:WORD_1 dst_unused:UNUSED_PRESERVE src0_sel:WORD_1
v_fma_mix_f32 v156, v136, v136, 0 op_sel:[0,0,0] op_sel_hi:[1,1,0]
ds_read_b32 v247, v253 offset:16
s_waitcnt lgkmcnt(9)
v_fma_mix_f32 v156, v137, v137, v156 op_sel:[1,1,0] op_sel_hi:[1,1,0]
v_rcp_f16_sdwa v151, v150 dst_sel:WORD_1 dst_unused:UNUSED_PRESERVE src0_sel:WORD_1
v_fma_mix_f32 v156, v138, v138, v156 op_sel:[0,0,0] op_sel_hi:[1,1,0]
ds_read_b128 v[216:219], v248 offset:30720
v_mfma_f32_32x32x16_bf16 v[120:135], v[68:71], v[220:223], v[120:135]
v_rcp_f16_sdwa v148, v147 dst_sel:WORD_1 dst_unused:UNUSED_PRESERVE src0_sel:WORD_1
v_fma_mix_f32 v156, v139, v139, v156 op_sel:[1,1,0] op_sel_hi:[1,1,0]
v_pk_mul_f16 v155, v155, v154
s_waitcnt lgkmcnt(6)
v_fma_mix_f32 v156, v140, v140, v156 op_sel:[0,0,0] op_sel_hi:[1,1,0]
v_pk_mul_f16 v152, v152, v151
v_fma_mix_f32 v156, v141, v141, v156 op_sel:[1,1,0] op_sel_hi:[1,1,0]
v_pk_mul_f16 v149, v149, v148
v_fma_mix_f32 v156, v155, v155, v156 op_sel:[0,0,0] op_sel_hi:[1,1,0]
v_fma_mix_f32 v156, v142, v142, v156 op_sel:[0,0,0] op_sel_hi:[1,1,0]
v_fma_mix_f32 v156, v155, v155, v156 op_sel:[1,1,0] op_sel_hi:[1,1,0]
s_waitcnt lgkmcnt(4)
v_fma_mix_f32 v156, v143, v143, v156 op_sel:[1,1,0] op_sel_hi:[1,1,0]
v_fma_mix_f32 v156, v152, v152, v156 op_sel:[0,0,0] op_sel_hi:[1,1,0]
v_fma_mix_f32 v156, v152, v152, v156 op_sel:[1,1,0] op_sel_hi:[1,1,0]
s_waitcnt lgkmcnt(2)
v_fma_mix_f32 v156, v144, v144, v156 op_sel:[0,0,0] op_sel_hi:[1,1,0]
v_fma_mix_f32 v156, v149, v149, v156 op_sel:[0,0,0] op_sel_hi:[1,1,0]
v_fma_mix_f32 v156, v145, v145, v156 op_sel:[1,1,0] op_sel_hi:[1,1,0]
v_fma_mix_f32 v156, v149, v149, v156 op_sel:[1,1,0] op_sel_hi:[1,1,0]
s_waitcnt lgkmcnt(1)
v_readfirstlane_b32 s43, v247
s_nop 1
s_cmp_ge_u32 s43, 8
s_cbranch_scc1 Lev1
Lev1w:
s_sleep 1
ds_read_b32 v247, v253 offset:16
s_waitcnt lgkmcnt(0)
v_readfirstlane_b32 s43, v247
s_cmp_eq_u32 s76, 0
s_cbranch_scc1 Lev1
s_sub_u32 s76, s76, 1
s_cmp_lt_u32 s43, 8
s_cbranch_scc1 Lev1w
Lev1:
v_cvt_pkrtz_f16_f32 v137, v120, v121
v_cvt_pkrtz_f16_f32 v139, v122, v123
v_cvt_pkrtz_f16_f32 v141, v124, v125
v_cvt_pkrtz_f16_f32 v143, v126, v127
v_cvt_pkrtz_f16_f32 v145, v128, v129
v_cvt_pk_f16_f32 v155, v130, v131
v_cvt_pk_f16_f32 v152, v132, v133
v_cvt_pk_f16_f32 v149, v134, v135
s_add_u32 m0, s67, 0
s_add_u32 s66, s66, 98304
buffer_load_dwordx4 v240, s[4:7], s66 offen lds
ds_read_b128 v[220:223], v248 offset:33792
v_mfma_f32_32x32x16_bf16 v[120:135], v[48:51], v[224:227], 0
v_pk_fma_f16 v154, v155, v155, s48
v_and_b32_e64 v137, s49, v137
v_pk_fma_f16 v151, v152, v152, s48
v_and_b32_e64 v139, s49, v139
v_pk_fma_f16 v148, v149, v149, s48
v_pk_mul_f16 v154, v155, v154
v_bfe_u32 v136, v137, 2, 14
v_pk_mul_f16 v151, v152, v151
v_pk_mul_f16 v148, v149, v148
v_bfe_u32 v138, v139, 2, 14
s_add_u32 m0, s67, 6656
s_add_u32 s66, s66, 98304
buffer_load_dwordx4 v240, s[4:7], s66 offen lds
ds_read_b128 v[224:227], v248 offset:34816
ds_read_u16_d16 v136, v136
ds_read_u16_d16 v138, v138
v_mfma_f32_32x32x16_bf16 v[120:135], v[52:55], v[228:231], v[120:135]
v_exp_f16 v153, v154
v_lshrrev_b32 v137, 18, v137
v_exp_f16 v150, v151
v_lshrrev_b32 v139, 18, v139
v_exp_f16 v147, v148
v_and_b32 v141, s49, v141
v_and_b32_e64 v143, s49, v143
s_add_u32 m0, s67, 13312
s_add_u32 s66, s66, 98304
buffer_load_dwordx4 v240, s[4:7], s66 offen lds
ds_read_b128 v[228:231], v248 offset:37888
ds_read_u16_d16_hi v137, v137
ds_read_u16_d16_hi v139, v139
v_mfma_f32_32x32x16_bf16 v[120:135], v[56:59], v[232:235], v[120:135]
v_exp_f16_sdwa v153, v154 dst_sel:WORD_1 dst_unused:UNUSED_PRESERVE src0_sel:WORD_1
v_bfe_u32 v140, v141, 2, 14
v_exp_f16_sdwa v150, v151 dst_sel:WORD_1 dst_unused:UNUSED_PRESERVE src0_sel:WORD_1
v_bfe_u32 v142, v143, 2, 14
v_exp_f16_sdwa v147, v148 dst_sel:WORD_1 dst_unused:UNUSED_PRESERVE src0_sel:WORD_1
v_lshrrev_b32_e64 v141, 18, v141
v_pk_add_f16 v153, v153, 1.0 op_sel_hi:[1,0]
s_add_u32 m0, s67, 19968
s_add_u32 s66, s66, 98304
buffer_load_dwordx4 v240, s[4:7], s66 offen lds
s_add_u32 m0, s67, 26624
s_add_u32 s66, s66, 98304
buffer_load_dwordx4 v240, s[4:7], s66 offen lds
ds_read_b128 v[232:235], v248 offset:35840
ds_read_u16_d16 v140, v140
ds_read_u16_d16 v142, v142
ds_read_u16_d16_hi v141, v141
v_mfma_f32_32x32x16_bf16 v[120:135], v[60:63], v[236:239], v[120:135]
v_lshrrev_b32_e64 v143, 18, v143
v_pk_add_f16 v150, v150, 1.0 op_sel_hi:[1,0]
v_pk_add_f16 v147, v147, 1.0 op_sel_hi:[1,0]
v_and_b32 v145, s49, v145
v_rcp_f16 v154, v153
v_bfe_u32 v144, v145, 2, 14
v_rcp_f16_e64 v151, v150
v_lshrrev_b32 v145, 18, v145
s_waitcnt lgkmcnt(4)
s_add_u32 m0, s67, 33280
s_add_u32 s66, s66, 98304
buffer_load_dwordx4 v240, s[4:7], s66 offen lds
ds_read_b128 v[236:239], v248 offset:38912
ds_read_u16_d16_hi v143, v143
ds_read_u16_d16 v144, v144
ds_read_u16_d16_hi v145, v145
v_mfma_f32_32x32x16_bf16 v[120:135], v[64:67], v[216:219], v[120:135]
v_rcp_f16 v148, v147
v_rcp_f16_sdwa v154, v153 dst_sel:WORD_1 dst_unused:UNUSED_PRESERVE src0_sel:WORD_1
v_fma_mix_f32 v157, v136, v136, 0 op_sel:[0,0,0] op_sel_hi:[1,1,0]
v_fma_mix_f32 v157, v137, v137, v157 op_sel:[1,1,0] op_sel_hi:[1,1,0]
v_rcp_f16_sdwa v151, v150 dst_sel:WORD_1 dst_unused:UNUSED_PRESERVE src0_sel:WORD_1
v_fma_mix_f32 v157, v138, v138, v157 op_sel:[0,0,0] op_sel_hi:[1,1,0]
s_add_u32 m0, s67, 39936
s_add_u32 s66, s66, 98304
buffer_load_dwordx4 v240, s[4:7], s66 offen lds
ds_read_b128 v[216:219], v248 offset:36864
v_mfma_f32_32x32x16_bf16 v[120:135], v[68:71], v[220:223], v[120:135]
v_rcp_f16_sdwa v148, v147 dst_sel:WORD_1 dst_unused:UNUSED_PRESERVE src0_sel:WORD_1
v_fma_mix_f32 v157, v139, v139, v157 op_sel:[1,1,0] op_sel_hi:[1,1,0]
v_pk_mul_f16 v155, v155, v154
s_waitcnt lgkmcnt(5)
v_fma_mix_f32 v157, v140, v140, v157 op_sel:[0,0,0] op_sel_hi:[1,1,0]
v_pk_mul_f16 v152, v152, v151
v_fma_mix_f32 v157, v141, v141, v157 op_sel:[1,1,0] op_sel_hi:[1,1,0]
v_pk_mul_f16 v149, v149, v148
v_fma_mix_f32 v157, v155, v155, v157 op_sel:[0,0,0] op_sel_hi:[1,1,0]
v_fma_mix_f32 v157, v142, v142, v157 op_sel:[0,0,0] op_sel_hi:[1,1,0]
v_fma_mix_f32 v157, v155, v155, v157 op_sel:[1,1,0] op_sel_hi:[1,1,0]
s_add_u32 m0, s67, 46592
s_add_u32 s66, s66, 98304
buffer_load_dwordx4 v240, s[4:7], s66 offen lds
s_waitcnt lgkmcnt(1)
v_fma_mix_f32 v157, v143, v143, v157 op_sel:[1,1,0] op_sel_hi:[1,1,0]
v_fma_mix_f32 v157, v152, v152, v157 op_sel:[0,0,0] op_sel_hi:[1,1,0]
v_fma_mix_f32 v157, v152, v152, v157 op_sel:[1,1,0] op_sel_hi:[1,1,0]
v_fma_mix_f32 v157, v144, v144, v157 op_sel:[0,0,0] op_sel_hi:[1,1,0]
v_fma_mix_f32 v157, v149, v149, v157 op_sel:[0,0,0] op_sel_hi:[1,1,0]
v_fma_mix_f32 v157, v145, v145, v157 op_sel:[1,1,0] op_sel_hi:[1,1,0]
v_fma_mix_f32 v157, v149, v149, v157 op_sel:[1,1,0] op_sel_hi:[1,1,0]
s_setprio 1
v_cvt_pkrtz_f16_f32 v137, v120, v121
v_cvt_pkrtz_f16_f32 v139, v122, v123
v_cvt_pkrtz_f16_f32 v141, v124, v125
v_cvt_pkrtz_f16_f32 v143, v126, v127
v_cvt_pkrtz_f16_f32 v145, v128, v129
v_cvt_pk_f16_f32 v155, v130, v131
v_cvt_pk_f16_f32 v152, v132, v133
v_cvt_pk_f16_f32 v149, v134, v135
ds_read_b128 v[220:223], v248 offset:39936
v_mfma_f32_32x32x16_bf16 v[120:135], v[48:51], v[224:227], 0
v_pk_fma_f16 v154, v155, v155, s48
v_and_b32_e64 v137, s49, v137
v_pk_fma_f16 v151, v152, v152, s48
v_and_b32_e64 v139, s49, v139
v_pk_fma_f16 v148, v149, v149, s48
v_pk_mul_f16 v154, v155, v154
v_bfe_u32 v136, v137, 2, 14
v_pk_mul_f16 v151, v152, v151
v_pk_mul_f16 v148, v149, v148
v_bfe_u32 v138, v139, 2, 14
ds_read_u16_d16 v136, v136
ds_read_b32 v247, v253 offset:24
ds_read_u16_d16 v138, v138
v_mfma_f32_32x32x16_bf16 v[120:135], v[52:55], v[228:231], v[120:135]
v_exp_f16 v153, v154
v_lshrrev_b32 v137, 18, v137
v_exp_f16 v150, v151
v_lshrrev_b32 v139, 18, v139
v_exp_f16 v147, v148
v_and_b32 v141, s49, v141
v_and_b32_e64 v143, s49, v143
ds_read_u16_d16_hi v137, v137
ds_read_u16_d16_hi v139, v139
v_mfma_f32_32x32x16_bf16 v[120:135], v[56:59], v[232:235], v[120:135]
v_exp_f16_sdwa v153, v154 dst_sel:WORD_1 dst_unused:UNUSED_PRESERVE src0_sel:WORD_1
v_bfe_u32 v140, v141, 2, 14
v_exp_f16_sdwa v150, v151 dst_sel:WORD_1 dst_unused:UNUSED_PRESERVE src0_sel:WORD_1
v_bfe_u32 v142, v143, 2, 14
v_exp_f16_sdwa v147, v148 dst_sel:WORD_1 dst_unused:UNUSED_PRESERVE src0_sel:WORD_1
v_lshrrev_b32_e64 v141, 18, v141
v_pk_add_f16 v153, v153, 1.0 op_sel_hi:[1,0]
ds_read_u16_d16 v140, v140
ds_read_u16_d16 v142, v142
ds_read_u16_d16_hi v141, v141
s_waitcnt lgkmcnt(6)
v_readfirstlane_b32 s43, v247
s_nop 1
s_cmp_ge_u32 s43, 4
s_cbranch_scc1 Lev2
Lev2w:
s_sleep 1
ds_read_b32 v247, v253 offset:24
s_waitcnt lgkmcnt(0)
v_readfirstlane_b32 s43, v247
s_cmp_eq_u32 s76, 0
s_cbranch_scc1 Lev2
s_sub_u32 s76, s76, 1
s_cmp_lt_u32 s43, 4
s_cbranch_scc1 Lev2w
Lev2:
ds_read_b128 v[224:227], v248 offset:40960
ds_read_b128 v[228:231], v248 offset:44032
ds_read_b128 v[232:235], v248 offset:41984
v_mfma_f32_32x32x16_bf16 v[120:135], v[60:63], v[236:239], v[120:135]
v_lshrrev_b32 v143, 18, v143
v_pk_add_f16 v150, v150, 1.0 op_sel_hi:[1,0]
v_pk_add_f16 v147, v147, 1.0 op_sel_hi:[1,0]
v_and_b32 v145, s49, v145
v_rcp_f16 v154, v153
v_bfe_u32 v144, v145, 2, 14
v_rcp_f16 v151, v150
v_lshrrev_b32 v145, 18, v145
ds_read_b128 v[236:239], v248 offset:45056
ds_read_u16_d16_hi v143, v143
ds_read_u16_d16 v144, v144
ds_read_u16_d16_hi v145, v145
v_mfma_f32_32x32x16_bf16 v[120:135], v[64:67], v[216:219], v[120:135]
v_rcp_f16 v148, v147
v_rcp_f16_sdwa v154, v153 dst_sel:WORD_1 dst_unused:UNUSED_PRESERVE src0_sel:WORD_1
v_fma_mix_f32 v158, v136, v136, 0 op_sel:[0,0,0] op_sel_hi:[1,1,0]
s_waitcnt lgkmcnt(7)
v_fma_mix_f32 v158, v137, v137, v158 op_sel:[1,1,0] op_sel_hi:[1,1,0]
v_rcp_f16_sdwa v151, v150 dst_sel:WORD_1 dst_unused:UNUSED_PRESERVE src0_sel:WORD_1
v_fma_mix_f32 v158, v138, v138, v158 op_sel:[0,0,0] op_sel_hi:[1,1,0]
ds_read_b128 v[216:219], v248 offset:43008
v_mfma_f32_32x32x16_bf16 v[120:135], v[68:71], v[220:223], v[120:135]
v_rcp_f16_sdwa v148, v147 dst_sel:WORD_1 dst_unused:UNUSED_PRESERVE src0_sel:WORD_1
v_fma_mix_f32 v158, v139, v139, v158 op_sel:[1,1,0] op_sel_hi:[1,1,0]
v_pk_mul_f16 v155, v155, v154
v_fma_mix_f32 v158, v140, v140, v158 op_sel:[0,0,0] op_sel_hi:[1,1,0]
v_pk_mul_f16 v152, v152, v151
v_fma_mix_f32 v158, v141, v141, v158 op_sel:[1,1,0] op_sel_hi:[1,1,0]
v_pk_mul_f16 v149, v149, v148
v_fma_mix_f32 v158, v155, v155, v158 op_sel:[0,0,0] op_sel_hi:[1,1,0]
v_fma_mix_f32 v158, v142, v142, v158 op_sel:[0,0,0] op_sel_hi:[1,1,0]
v_fma_mix_f32 v158, v155, v155, v158 op_sel:[1,1,0] op_sel_hi:[1,1,0]
s_waitcnt lgkmcnt(3)
v_fma_mix_f32 v158, v143, v143, v158 op_sel:[1,1,0] op_sel_hi:[1,1,0]
v_fma_mix_f32 v158, v152, v152, v158 op_sel:[0,0,0] op_sel_hi:[1,1,0]
v_fma_mix_f32 v158, v152, v152, v158 op_sel:[1,1,0] op_sel_hi:[1,1,0]
s_waitcnt lgkmcnt(1)
v_fma_mix_f32 v158, v144, v144, v158 op_sel:[0,0,0] op_sel_hi:[1,1,0]
v_fma_mix_f32 v158, v149, v149, v158 op_sel:[0,0,0] op_sel_hi:[1,1,0]
v_fma_mix_f32 v158, v145, v145, v158 op_sel:[1,1,0] op_sel_hi:[1,1,0]
v_fma_mix_f32 v158, v149, v149, v158 op_sel:[1,1,0] op_sel_hi:[1,1,0]
v_cvt_pkrtz_f16_f32 v137, v120, v121
v_cvt_pkrtz_f16_f32 v139, v122, v123
v_cvt_pkrtz_f16_f32 v141, v124, v125
v_cvt_pkrtz_f16_f32 v143, v126, v127
v_cvt_pkrtz_f16_f32 v145, v128, v129
v_cvt_pk_f16_f32 v155, v130, v131
v_cvt_pk_f16_f32 v152, v132, v133
v_cvt_pk_f16_f32 v149, v134, v135
ds_read_b128 v[220:223], v248 offset:46080
v_mfma_f32_32x32x16_bf16 v[120:135], v[48:51], v[224:227], 0
v_pk_fma_f16 v154, v155, v155, s48
v_and_b32_e64 v137, s49, v137
v_pk_fma_f16 v151, v152, v152, s48
v_and_b32_e64 v139, s49, v139
v_pk_fma_f16 v148, v149, v149, s48
v_pk_mul_f16 v154, v155, v154
v_bfe_u32 v136, v137, 2, 14
v_pk_mul_f16 v151, v152, v151
v_pk_mul_f16 v148, v149, v148
v_bfe_u32 v138, v139, 2, 14
ds_read_b128 v[224:227], v248 offset:47104
ds_read_u16_d16 v136, v136
ds_read_u16_d16 v138, v138
v_mfma_f32_32x32x16_bf16 v[120:135], v[52:55], v[228:231], v[120:135]
v_exp_f16 v153, v154
v_lshrrev_b32 v137, 18, v137
v_exp_f16 v150, v151
v_lshrrev_b32 v139, 18, v139
v_exp_f16 v147, v148
v_and_b32 v141, s49, v141
v_and_b32_e64 v143, s49, v143
ds_read_b128 v[228:231], v248 offset:50176
ds_read_u16_d16_hi v137, v137
ds_read_u16_d16_hi v139, v139
v_mfma_f32_32x32x16_bf16 v[120:135], v[56:59], v[232:235], v[120:135]
v_exp_f16_sdwa v153, v154 dst_sel:WORD_1 dst_unused:UNUSED_PRESERVE src0_sel:WORD_1
v_bfe_u32 v140, v141, 2, 14
v_exp_f16_sdwa v150, v151 dst_sel:WORD_1 dst_unused:UNUSED_PRESERVE src0_sel:WORD_1
v_bfe_u32 v142, v143, 2, 14
v_exp_f16_sdwa v147, v148 dst_sel:WORD_1 dst_unused:UNUSED_PRESERVE src0_sel:WORD_1
v_lshrrev_b32_e64 v141, 18, v141
v_pk_add_f16 v153, v153, 1.0 op_sel_hi:[1,0]
ds_read_b128 v[232:235], v248 offset:48128
ds_read_u16_d16 v140, v140
ds_read_u16_d16 v142, v142
ds_read_u16_d16_hi v141, v141
v_mfma_f32_32x32x16_bf16 v[120:135], v[60:63], v[236:239], v[120:135]
v_lshrrev_b32_e64 v143, 18, v143
v_pk_add_f16 v150, v150, 1.0 op_sel_hi:[1,0]
v_pk_add_f16 v147, v147, 1.0 op_sel_hi:[1,0]
v_and_b32 v145, s49, v145
v_rcp_f16 v154, v153
v_bfe_u32 v144, v145, 2, 14
v_rcp_f16_e64 v151, v150
v_lshrrev_b32 v145, 18, v145
s_waitcnt lgkmcnt(7)
ds_read_b128 v[236:239], v248 offset:51200
ds_read_u16_d16_hi v143, v143
ds_read_u16_d16 v144, v144
ds_read_u16_d16_hi v145, v145
v_mfma_f32_32x32x16_bf16 v[120:135], v[64:67], v[216:219], v[120:135]
v_rcp_f16 v148, v147
v_rcp_f16_sdwa v154, v153 dst_sel:WORD_1 dst_unused:UNUSED_PRESERVE src0_sel:WORD_1
v_fma_mix_f32 v159, v136, v136, 0 op_sel:[0,0,0] op_sel_hi:[1,1,0]
s_waitcnt lgkmcnt(8)
v_fma_mix_f32 v159, v137, v137, v159 op_sel:[1,1,0] op_sel_hi:[1,1,0]
v_rcp_f16_sdwa v151, v150 dst_sel:WORD_1 dst_unused:UNUSED_PRESERVE src0_sel:WORD_1
v_fma_mix_f32 v159, v138, v138, v159 op_sel:[0,0,0] op_sel_hi:[1,1,0]
ds_read_b128 v[216:219], v248 offset:49152
v_mfma_f32_32x32x16_bf16 v[120:135], v[68:71], v[220:223], v[120:135]
v_rcp_f16_sdwa v148, v147 dst_sel:WORD_1 dst_unused:UNUSED_PRESERVE src0_sel:WORD_1
v_fma_mix_f32 v159, v139, v139, v159 op_sel:[1,1,0] op_sel_hi:[1,1,0]
s_cmp_eq_u32 s40, 7
s_cbranch_scc1 Lrdy8
s_waitcnt vmcnt(0)
Lrdy8:
s_mov_b64 exec, 1
ds_add_u32 v253, v254 offset:12
s_mov_b64 exec, -1
v_pk_mul_f16 v155, v155, v154
s_waitcnt lgkmcnt(6)
v_fma_mix_f32 v159, v140, v140, v159 op_sel:[0,0,0] op_sel_hi:[1,1,0]
v_pk_mul_f16 v152, v152, v151
v_fma_mix_f32 v159, v141, v141, v159 op_sel:[1,1,0] op_sel_hi:[1,1,0]
v_pk_mul_f16 v149, v149, v148
v_fma_mix_f32 v159, v155, v155, v159 op_sel:[0,0,0] op_sel_hi:[1,1,0]
v_fma_mix_f32 v159, v142, v142, v159 op_sel:[0,0,0] op_sel_hi:[1,1,0]
v_fma_mix_f32 v159, v155, v155, v159 op_sel:[1,1,0] op_sel_hi:[1,1,0]
s_waitcnt lgkmcnt(2)
v_fma_mix_f32 v159, v143, v143, v159 op_sel:[1,1,0] op_sel_hi:[1,1,0]
v_fma_mix_f32 v159, v152, v152, v159 op_sel:[0,0,0] op_sel_hi:[1,1,0]
v_fma_mix_f32 v159, v152, v152, v159 op_sel:[1,1,0] op_sel_hi:[1,1,0]
v_fma_mix_f32 v159, v144, v144, v159 op_sel:[0,0,0] op_sel_hi:[1,1,0]
v_fma_mix_f32 v159, v149, v149, v159 op_sel:[0,0,0] op_sel_hi:[1,1,0]
v_fma_mix_f32 v159, v145, v145, v159 op_sel:[1,1,0] op_sel_hi:[1,1,0]
v_fma_mix_f32 v159, v149, v149, v159 op_sel:[1,1,0] op_sel_hi:[1,1,0]
v_cvt_pkrtz_f16_f32 v137, v120, v121
v_cvt_pkrtz_f16_f32 v139, v122, v123
v_cvt_pkrtz_f16_f32 v141, v124, v125
v_cvt_pkrtz_f16_f32 v143, v126, v127
v_cvt_pkrtz_f16_f32 v145, v128, v129
v_cvt_pk_f16_f32 v155, v130, v131
v_cvt_pk_f16_f32 v152, v132, v133
v_cvt_pk_f16_f32 v149, v134, v135
s_setprio 0
ds_read_b128 v[220:223], v248 offset:52224
v_mfma_f32_32x32x16_bf16 v[120:135], v[48:51], v[224:227], 0
v_pk_fma_f16 v154, v155, v155, s48
v_and_b32_e64 v137, s49, v137
v_pk_fma_f16 v151, v152, v152, s48
v_and_b32_e64 v139, s49, v139
v_pk_fma_f16 v148, v149, v149, s48
v_pk_mul_f16 v154, v155, v154
v_bfe_u32 v136, v137, 2, 14
v_pk_mul_f16 v151, v152, v151
v_pk_mul_f16 v148, v149, v148
v_bfe_u32 v138, v139, 2, 14
ds_read_b128 v[224:227], v250 offset:65520
ds_read_u16_d16 v136, v136
ds_read_u16_d16 v138, v138
v_mfma_f32_32x32x16_bf16 v[120:135], v[52:55], v[228:231], v[120:135]
v_exp_f16 v153, v154
v_lshrrev_b32 v137, 18, v137
v_exp_f16 v150, v151
v_lshrrev_b32 v139, 18, v139
v_exp_f16 v147, v148
v_and_b32 v141, s49, v141
v_and_b32_e64 v143, s49, v143
ds_read_b128 v[228:231], v248 offset:53248
ds_read_u16_d16_hi v137, v137
ds_read_b32 v247, v253 offset:12
ds_read_u16_d16_hi v139, v139
v_mfma_f32_32x32x16_bf16 v[120:135], v[56:59], v[232:235], v[120:135]
v_exp_f16_sdwa v153, v154 dst_sel:WORD_1 dst_unused:UNUSED_PRESERVE src0_sel:WORD_1
v_bfe_u32 v140, v141, 2, 14
v_exp_f16_sdwa v150, v151 dst_sel:WORD_1 dst_unused:UNUSED_PRESERVE src0_sel:WORD_1
v_bfe_u32 v142, v143, 2, 14
v_exp_f16_sdwa v147, v148 dst_sel:WORD_1 dst_unused:UNUSED_PRESERVE src0_sel:WORD_1
v_lshrrev_b32_e64 v141, 18, v141
v_pk_add_f16 v153, v153, 1.0 op_sel_hi:[1,0]
ds_read_b128 v[232:235], v248 offset:56320
ds_read_u16_d16 v140, v140
ds_read_u16_d16 v142, v142
ds_read_u16_d16_hi v141, v141
v_mfma_f32_32x32x16_bf16 v[120:135], v[60:63], v[236:239], v[120:135]
v_lshrrev_b32_e64 v143, 18, v143
v_pk_add_f16 v150, v150, 1.0 op_sel_hi:[1,0]
v_pk_add_f16 v147, v147, 1.0 op_sel_hi:[1,0]
v_and_b32 v145, s49, v145
v_rcp_f16 v154, v153
v_bfe_u32 v144, v145, 2, 14
ds_read_u16_d16_hi v143, v143
ds_read_u16_d16 v144, v144
s_waitcnt lgkmcnt(7)
v_readfirstlane_b32 s43, v247
s_nop 1
s_cmp_ge_u32 s43, 16
s_cbranch_scc1 Lev3
Lev3w:
s_sleep 1
ds_read_b32 v247, v253 offset:12
s_waitcnt lgkmcnt(0)
v_readfirstlane_b32 s43, v247
s_cmp_eq_u32 s76, 0
s_cbranch_scc1 Lev3
s_sub_u32 s76, s76, 1
s_cmp_lt_u32 s43, 16
s_cbranch_scc1 Lev3w
Lev3:
v_rcp_f16 v151, v150
v_lshrrev_b32_e64 v145, 18, v145
ds_read_b128 v[236:239], v245 offset:6528
ds_read_b128 v[192:195], v244 offset:128
ds_read_b128 v[196:199], v244 offset:64
ds_read_u16_d16_hi v145, v145
v_mfma_f32_32x32x16_bf16 v[120:135], v[64:67], v[216:219], v[120:135]
v_rcp_f16 v148, v147
v_rcp_f16_sdwa v154, v153 dst_sel:WORD_1 dst_unused:UNUSED_PRESERVE src0_sel:WORD_1
v_fma_mix_f32 v160, v136, v136, 0 op_sel:[0,0,0] op_sel_hi:[1,1,0]
v_fma_mix_f32 v160, v137, v137, v160 op_sel:[1,1,0] op_sel_hi:[1,1,0]
v_rcp_f16_sdwa v151, v150 dst_sel:WORD_1 dst_unused:UNUSED_PRESERVE src0_sel:WORD_1
v_fma_mix_f32 v160, v138, v138, v160 op_sel:[0,0,0] op_sel_hi:[1,1,0]
ds_read_b128 v[216:219], v248 offset:54272
v_mfma_f32_32x32x16_bf16 v[120:135], v[68:71], v[220:223], v[120:135]
v_rcp_f16_sdwa v148, v147 dst_sel:WORD_1 dst_unused:UNUSED_PRESERVE src0_sel:WORD_1
s_waitcnt lgkmcnt(5)
v_fma_mix_f32 v160, v139, v139, v160 op_sel:[1,1,0] op_sel_hi:[1,1,0]
v_pk_mul_f16 v155, v155, v154
v_fma_mix_f32 v160, v140, v140, v160 op_sel:[0,0,0] op_sel_hi:[1,1,0]
v_pk_mul_f16 v152, v152, v151
v_fma_mix_f32 v160, v141, v141, v160 op_sel:[1,1,0] op_sel_hi:[1,1,0]
v_pk_mul_f16 v149, v149, v148
v_fma_mix_f32 v160, v155, v155, v160 op_sel:[0,0,0] op_sel_hi:[1,1,0]
v_fma_mix_f32 v160, v142, v142, v160 op_sel:[0,0,0] op_sel_hi:[1,1,0]
v_fma_mix_f32 v160, v155, v155, v160 op_sel:[1,1,0] op_sel_hi:[1,1,0]
v_fma_mix_f32 v160, v143, v143, v160 op_sel:[1,1,0] op_sel_hi:[1,1,0]
v_fma_mix_f32 v160, v152, v152, v160 op_sel:[0,0,0] op_sel_hi:[1,1,0]
v_fma_mix_f32 v160, v152, v152, v160 op_sel:[1,1,0] op_sel_hi:[1,1,0]
v_fma_mix_f32 v160, v144, v144, v160 op_sel:[0,0,0] op_sel_hi:[1,1,0]
v_fma_mix_f32 v160, v149, v149, v160 op_sel:[0,0,0] op_sel_hi:[1,1,0]
s_waitcnt lgkmcnt(1)
v_fma_mix_f32 v160, v145, v145, v160 op_sel:[1,1,0] op_sel_hi:[1,1,0]
v_fma_mix_f32 v160, v149, v149, v160 op_sel:[1,1,0] op_sel_hi:[1,1,0]
s_setprio 2
v_mfma_f32_32x32x16_bf16 v[0:15], v[224:227], v[224:227], 0
ds_read_b128 v[220:223], v245 offset:6144
ds_read_b128 v[200:203], v244
ds_read_b128 v[204:207], v243 offset:128
v_cvt_pkrtz_f16_f32 v137, v120, v121
v_cvt_pkrtz_f16_f32 v139, v122, v123
v_cvt_pkrtz_f16_f32 v141, v124, v125
v_mfma_f32_32x32x16_bf16 v[16:31], v[224:227], v[224:227], 0
v_cvt_pkrtz_f16_f32 v143, v126, v127
v_cvt_pkrtz_f16_f32 v145, v128, v129
v_cvt_pk_f16_f32 v155, v130, v131
v_mfma_f32_32x32x16_bf16 v[32:47], v[224:227], v[224:227], 0
v_cvt_pk_f16_f32 v152, v132, v133
v_cvt_pk_f16_f32 v149, v134, v135
v_pk_fma_f16 v154, v155, v155, s48
v_mfma_f32_32x32x16_bf16 v[120:135], v[48:51], v[228:231], 0
ds_read_b128 v[224:227], v248 offset:57344
v_and_b32_e64 v137, s49, v137
v_pk_fma_f16 v151, v152, v152, s48
v_and_b32_e64 v139, s49, v139
v_pk_fma_f16 v148, v149, v149, s48
v_pk_mul_f16 v154, v155, v154
v_bfe_u32 v136, v137, 2, 14
v_mfma_f32_32x32x16_bf16 v[120:135], v[52:55], v[232:235], v[120:135]
ds_read_b128 v[228:231], v245 offset:5760
ds_read_b128 v[208:211], v243 offset:64
ds_read_b128 v[212:215], v243
ds_read_u16_d16 v136, v136
v_pk_mul_f16 v151, v152, v151
v_pk_mul_f16 v148, v149, v148
v_bfe_u32 v138, v139, 2, 14
v_exp_f16 v153, v154
v_lshrrev_b32 v137, 18, v137
v_smfmac_f32_16x16x32_bf16 v[40:43], v[238:239], v[192:195], v246
ds_read_b128 v[232:235], v248 offset:55296
ds_read_u16_d16 v138, v138
ds_read_u16_d16_hi v137, v137
v_exp_f16 v150, v151
v_lshrrev_b32 v139, 18, v139
v_smfmac_f32_16x16x32_bf16 v[24:27], v[236:237], v[196:199], v246
v_exp_f16_e64 v147, v148
v_and_b32 v141, s49, v141
s_waitcnt lgkmcnt(7)
v_mfma_f32_32x32x16_bf16 v[120:135], v[56:59], v[216:219], v[120:135]
ds_read_b128 v[236:239], v245 offset:5376
ds_read_b128 v[192:195], v242 offset:128
ds_read_b128 v[196:199], v242 offset:64
ds_read_u16_d16_hi v139, v139
v_and_b32_e64 v143, s49, v143
v_exp_f16_sdwa v153, v154 dst_sel:WORD_1 dst_unused:UNUSED_PRESERVE src0_sel:WORD_1
v_bfe_u32 v140, v141, 2, 14
v_exp_f16_sdwa v150, v151 dst_sel:WORD_1 dst_unused:UNUSED_PRESERVE src0_sel:WORD_1
v_smfmac_f32_16x16x32_bf16 v[8:11], v[222:223], v[200:203], v246
ds_read_b128 v[216:219], v248 offset:58368
ds_read_u16_d16 v140, v140
v_bfe_u32 v142, v143, 2, 14
v_exp_f16_sdwa v147, v148 dst_sel:WORD_1 dst_unused:UNUSED_PRESERVE src0_sel:WORD_1
v_smfmac_f32_16x16x32_bf16 v[40:43], v[220:221], v[204:207], v246
v_lshrrev_b32_e64 v141, 18, v141
v_pk_add_f16 v153, v153, 1.0 op_sel_hi:[1,0]
v_lshrrev_b32 v143, 18, v143
v_mfma_f32_32x32x16_bf16 v[120:135], v[60:63], v[224:227], v[120:135]
ds_read_b128 v[220:223], v245 offset:4992
ds_read_b128 v[200:203], v242
v_xor_b32 v244, 16, v244
ds_read_b128 v[204:207], v244 offset:128
ds_read_u16_d16 v142, v142
ds_read_u16_d16_hi v141, v141
ds_read_u16_d16_hi v143, v143
v_pk_add_f16 v150, v150, 1.0 op_sel_hi:[1,0]
v_pk_add_f16 v147, v147, 1.0 op_sel_hi:[1,0]
v_and_b32_e64 v145, s49, v145
v_rcp_f16 v154, v153
v_bfe_u32 v144, v145, 2, 14
s_waitcnt lgkmcnt(8)
v_smfmac_f32_16x16x32_bf16 v[24:27], v[230:231], v[208:211], v246
ds_read_b128 v[224:227], v245 offset:4608
ds_read_u16_d16 v144, v144
v_rcp_f16 v151, v150
v_lshrrev_b32 v145, 18, v145
v_smfmac_f32_16x16x32_bf16 v[8:11], v[228:229], v[212:215], v246
v_rcp_f16_e64 v148, v147
v_mfma_f32_32x32x16_bf16 v[120:135], v[64:67], v[232:235], v[120:135]
ds_read_b128 v[208:211], v244 offset:64
ds_read_b128 v[212:215], v244
ds_read_b128 v[228:231], v248 offset:59392
ds_read_u16_d16_hi v145, v145
v_rcp_f16_sdwa v154, v153 dst_sel:WORD_1 dst_unused:UNUSED_PRESERVE src0_sel:WORD_1
v_fma_mix_f32 v161, v136, v136, 0 op_sel:[0,0,0] op_sel_hi:[1,1,0]
v_fma_mix_f32 v161, v137, v137, v161 op_sel:[1,1,0] op_sel_hi:[1,1,0]
v_rcp_f16_sdwa v151, v150 dst_sel:WORD_1 dst_unused:UNUSED_PRESERVE src0_sel:WORD_1
v_fma_mix_f32 v161, v138, v138, v161 op_sel:[0,0,0] op_sel_hi:[1,1,0]
v_smfmac_f32_16x16x32_bf16 v[40:43], v[238:239], v[192:195], v246
ds_read_b128 v[232:235], v248 offset:62464
v_rcp_f16_sdwa v148, v147 dst_sel:WORD_1 dst_unused:UNUSED_PRESERVE src0_sel:WORD_1
v_fma_mix_f32 v161, v139, v139, v161 op_sel:[1,1,0] op_sel_hi:[1,1,0]
v_smfmac_f32_16x16x32_bf16 v[24:27], v[236:237], v[196:199], v246
v_pk_mul_f16 v155, v155, v154
s_waitcnt lgkmcnt(7)
v_fma_mix_f32 v161, v140, v140, v161 op_sel:[0,0,0] op_sel_hi:[1,1,0]
v_pk_mul_f16 v152, v152, v151
v_mfma_f32_32x32x16_bf16 v[120:135], v[68:71], v[216:219], v[120:135]
ds_read_b128 v[236:239], v248 offset:60416
v_fma_mix_f32 v161, v141, v141, v161 op_sel:[1,1,0] op_sel_hi:[1,1,0]
v_pk_mul_f16 v149, v149, v148
v_fma_mix_f32 v161, v155, v155, v161 op_sel:[0,0,0] op_sel_hi:[1,1,0]
v_fma_mix_f32 v161, v142, v142, v161 op_sel:[0,0,0] op_sel_hi:[1,1,0]
v_fma_mix_f32 v161, v155, v155, v161 op_sel:[1,1,0] op_sel_hi:[1,1,0]
v_fma_mix_f32 v161, v143, v143, v161 op_sel:[1,1,0] op_sel_hi:[1,1,0]
v_smfmac_f32_16x16x32_bf16 v[8:11], v[222:223], v[200:203], v246
ds_read_b128 v[216:219], v245 offset:4224
v_xor_b32 v243, 16, v243
ds_read_b128 v[192:195], v243 offset:128
ds_read_b128 v[196:199], v243 offset:64
v_fma_mix_f32 v161, v152, v152, v161 op_sel:[0,0,0] op_sel_hi:[1,1,0]
v_fma_mix_f32 v161, v152, v152, v161 op_sel:[1,1,0] op_sel_hi:[1,1,0]
s_waitcnt lgkmcnt(5)
v_fma_mix_f32 v161, v144, v144, v161 op_sel:[0,0,0] op_sel_hi:[1,1,0]
v_smfmac_f32_16x16x32_bf16 v[44:47], v[220:221], v[204:207], v246
v_fma_mix_f32 v161, v149, v149, v161 op_sel:[0,0,0] op_sel_hi:[1,1,0]
v_fma_mix_f32 v161, v145, v145, v161 op_sel:[1,1,0] op_sel_hi:[1,1,0]
v_fma_mix_f32 v161, v149, v149, v161 op_sel:[1,1,0] op_sel_hi:[1,1,0]
s_cmp_lg_u32 s40, 7
s_cbranch_scc1 Lnosent
v_mov_b32 v180, -1
v_mov_b32 v181, -1
v_mov_b32 v182, -1
v_mov_b32 v183, -1
v_lshlrev_b32 v176, 12, v251
v_add_u32 v177, 262144, v176
v_cmp_gt_u32 vcc, 32, v251
v_mov_b32 v178, 2147483648
s_nop 0
v_cndmask_b32 v177, v178, v177, vcc
s_lshl_b32 s43, s2, 4
buffer_store_dwordx4 v[180:183], v176, s[32:35], s43 offen sc1
buffer_store_dwordx4 v[180:183], v177, s[32:35], s43 offen sc1
s_add_u32 s43, s43, 393216
s_cmp_lt_u32 s2, 96
s_cselect_b32 s43, s43, 1073741824
v_lshlrev_b32_e64 v178, 11, v251
s_mov_b64 exec, 0xff
buffer_store_dwordx4 v[180:183], v178, s[32:35], s43 offen sc1
s_mov_b64 exec, -1
s_sub_u32 s43, s2, 96
s_cmp_lt_u32 s43, 96
s_cbranch_scc0 Lnobias
s_lshl_b32 s44, s43, 1
v_mul_u32_u24 v176, 192, v251
v_lshlrev_b32 v177, 1, v251
s_add_u32 s45, s44, 0
buffer_load_ushort v178, v176, s[16:19], s45 offen
buffer_load_ushort v184, v177, s[28:31], 0 offen offset:0
s_add_u32 s45, s44, 12288
buffer_load_ushort v179, v176, s[16:19], s45 offen
buffer_load_ushort v185, v177, s[28:31], 0 offen offset:128
s_add_u32 s45, s44, 24576
buffer_load_ushort v180, v176, s[16:19], s45 offen
buffer_load_ushort v186, v177, s[28:31], 0 offen offset:256
s_add_u32 s45, s44, 36864
buffer_load_ushort v181, v176, s[16:19], s45 offen
buffer_load_ushort v187, v177, s[28:31], 0 offen offset:384
s_add_u32 s45, s44, 49152
buffer_load_ushort v182, v176, s[16:19], s45 offen
buffer_load_ushort v188, v177, s[28:31], 0 offen offset:512
s_add_u32 s45, s44, 61440
buffer_load_ushort v183, v176, s[16:19], s45 offen
buffer_load_ushort v189, v177, s[28:31], 0 offen offset:640
Lnobias:
s_nop 1
Lnosent:
s_setprio 1
v_smfmac_f32_16x16x32_bf16 v[28:31], v[226:227], v[208:211], v246
ds_read_b128 v[220:223], v248 offset:63488
v_cvt_pkrtz_f16_f32 v137, v120, v121
v_cvt_pkrtz_f16_f32 v139, v122, v123
v_cvt_pkrtz_f16_f32 v141, v124, v125
v_cvt_pkrtz_f16_f32 v143, v126, v127
v_smfmac_f32_16x16x32_bf16 v[12:15], v[224:225], v[212:215], v246
v_cvt_pk_f16_f32 v155, v128, v129
v_cvt_pk_f16_f32 v152, v130, v131
v_cvt_pk_f16_f32 v149, v132, v133
v_cvt_pk_f16_f32 v146, v134, v135
v_mfma_f32_32x32x16_bf16 v[120:135], v[48:51], v[228:231], 0
ds_read_b128 v[224:227], v248 offset:61440
v_pk_fma_f16 v154, v155, v155, s48
v_and_b32_e64 v137, s49, v137
v_pk_fma_f16 v151, v152, v152, s48
v_pk_fma_f16 v148, v149, v149, s48
v_and_b32_e64 v139, s49, v139
v_pk_fma_f16 v145, v146, v146, s48
v_pk_mul_f16 v154, v155, v154
v_bfe_u32 v136, v137, 2, 14
s_waitcnt lgkmcnt(2)
v_mfma_f32_32x32x16_bf16 v[120:135], v[52:55], v[232:235], v[120:135]
ds_read_b128 v[228:231], v245 offset:3840
ds_read_b128 v[200:203], v243
v_xor_b32 v242, 16, v242
ds_read_b128 v[204:207], v242 offset:128
ds_read_u16_d16 v136, v136
v_pk_mul_f16 v151, v152, v151
v_pk_mul_f16 v148, v149, v148
v_bfe_u32 v138, v139, 2, 14
v_pk_mul_f16 v145, v146, v145
v_exp_f16 v153, v154
v_lshrrev_b32 v137, 18, v137
v_exp_f16_e64 v150, v151
v_mfma_f32_32x32x16_bf16 v[120:135], v[56:59], v[236:239], v[120:135]
ds_read_b128 v[232:235], v248 offset:64512
ds_read_u16_d16 v138, v138
ds_read_u16_d16_hi v137, v137
v_lshrrev_b32 v139, 18, v139
v_exp_f16 v147, v148
v_and_b32 v141, s49, v141
v_exp_f16 v144, v145
v_and_b32_e64 v143, s49, v143
v_smfmac_f32_16x16x32_bf16 v[44:47], v[218:219], v[192:195], v246
ds_read_b128 v[236:239], v245 offset:3456
ds_read_b128 v[208:211], v242 offset:64
ds_read_b128 v[212:215], v242
ds_read_u16_d16_hi v139, v139
v_exp_f16_sdwa v153, v154 dst_sel:WORD_1 dst_unused:UNUSED_PRESERVE src0_sel:WORD_1
v_bfe_u32 v140, v141, 2, 14
v_exp_f16_sdwa v150, v151 dst_sel:WORD_1 dst_unused:UNUSED_PRESERVE src0_sel:WORD_1
v_smfmac_f32_16x16x32_bf16 v[28:31], v[216:217], v[196:199], v246
v_bfe_u32 v142, v143, 2, 14
v_exp_f16_sdwa v147, v148 dst_sel:WORD_1 dst_unused:UNUSED_PRESERVE src0_sel:WORD_1
v_lshrrev_b32_e64 v141, 18, v141
s_waitcnt lgkmcnt(7)
v_mfma_f32_32x32x16_bf16 v[120:135], v[60:63], v[220:223], v[120:135]
ds_read_b128 v[216:219], v245 offset:3072
v_xor_b32 v244, 32, v244
ds_read_b128 v[192:195], v244 offset:128
ds_read_b128 v[196:199], v244 offset:64
ds_read_u16_d16 v140, v140
ds_read_u16_d16 v142, v142
ds_read_u16_d16_hi v141, v141
v_exp_f16_sdwa v144, v145 dst_sel:WORD_1 dst_unused:UNUSED_PRESERVE src0_sel:WORD_1
v_lshrrev_b32_e64 v143, 18, v143
v_pk_add_f16 v153, v153, 1.0 op_sel_hi:[1,0]
v_pk_add_f16 v150, v150, 1.0 op_sel_hi:[1,0]
v_pk_add_f16 v147, v147, 1.0 op_sel_hi:[1,0]
v_pk_add_f16 v144, v144, 1.0 op_sel_hi:[1,0]
v_rcp_f16_e64 v154, v153
v_mfma_f32_32x32x16_bf16 v[120:135], v[64:67], v[224:227], v[120:135]
ds_read_b128 v[220:223], v249
ds_read_u16_d16_hi v143, v143
v_rcp_f16 v151, v150
v_rcp_f16 v148, v147
v_rcp_f16_e64 v145, v144
v_rcp_f16_sdwa v154, v153 dst_sel:WORD_1 dst_unused:UNUSED_PRESERVE src0_sel:WORD_1
v_smfmac_f32_16x16x32_bf16 v[12:15], v[230:231], v[200:203], v246
ds_read_b128 v[224:227], v249 offset:3072
v_rcp_f16_sdwa v151, v150 dst_sel:WORD_1 dst_unused:UNUSED_PRESERVE src0_sel:WORD_1
s_setprio 0
v_rcp_f16_sdwa v148, v147 dst_sel:WORD_1 dst_unused:UNUSED_PRESERVE src0_sel:WORD_1
v_fma_mix_f32 v162, v136, v136, 0 op_sel:[0,0,0] op_sel_hi:[1,1,0]
v_smfmac_f32_16x16x32_bf16 v[44:47], v[228:229], v[204:207], v246
v_rcp_f16_sdwa v145, v144 dst_sel:WORD_1 dst_unused:UNUSED_PRESERVE src0_sel:WORD_1
s_waitcnt lgkmcnt(5)
v_fma_mix_f32 v162, v137, v137, v162 op_sel:[1,1,0] op_sel_hi:[1,1,0]
v_pk_mul_f16 v155, v155, v154
v_mfma_f32_32x32x16_bf16 v[120:135], v[68:71], v[232:235], v[120:135]
ds_read_b128 v[228:231], v245 offset:2688
ds_read_b128 v[200:203], v244
v_xor_b32 v243, 32, v243
ds_read_b128 v[204:207], v243 offset:128
v_fma_mix_f32 v162, v138, v138, v162 op_sel:[0,0,0] op_sel_hi:[1,1,0]
v_pk_mul_f16 v152, v152, v151
v_pk_mul_f16 v149, v149, v148
v_fma_mix_f32 v162, v139, v139, v162 op_sel:[1,1,0] op_sel_hi:[1,1,0]
v_pk_mul_f16 v146, v146, v145
v_fma_mix_f32 v162, v155, v155, v162 op_sel:[0,0,0] op_sel_hi:[1,1,0]
v_fma_mix_f32 v162, v140, v140, v162 op_sel:[0,0,0] op_sel_hi:[1,1,0]
v_fma_mix_f32 v162, v155, v155, v162 op_sel:[1,1,0] op_sel_hi:[1,1,0]
v_smfmac_f32_16x16x32_bf16 v[28:31], v[238:239], v[208:211], v246
ds_read_b128 v[232:235], v249 offset:1024
v_fma_mix_f32 v162, v152, v152, v162 op_sel:[0,0,0] op_sel_hi:[1,1,0]
s_waitcnt lgkmcnt(4)
v_fma_mix_f32 v162, v141, v141, v162 op_sel:[1,1,0] op_sel_hi:[1,1,0]
v_fma_mix_f32 v162, v152, v152, v162 op_sel:[1,1,0] op_sel_hi:[1,1,0]
v_fma_mix_f32 v162, v149, v149, v162 op_sel:[0,0,0] op_sel_hi:[1,1,0]
v_smfmac_f32_16x16x32_bf16 v[12:15], v[236:237], v[212:215], v246
v_fma_mix_f32 v162, v142, v142, v162 op_sel:[0,0,0] op_sel_hi:[1,1,0]
v_fma_mix_f32 v162, v149, v149, v162 op_sel:[1,1,0] op_sel_hi:[1,1,0]
v_fma_mix_f32 v162, v146, v146, v162 op_sel:[0,0,0] op_sel_hi:[1,1,0]
v_fma_mix_f32 v162, v143, v143, v162 op_sel:[1,1,0] op_sel_hi:[1,1,0]
v_fma_mix_f32 v162, v146, v146, v162 op_sel:[1,1,0] op_sel_hi:[1,1,0]
v_lshlrev_b32_e64 v252, 7, v251
s_add_u32 s46, s47, 1572864
s_mov_b32 exec_lo, 131071
s_mov_b32 exec_hi, 0
s_mov_b32 m0, 16288
s_nop 0
buffer_load_dword v252, s[4:7], s46 offen lds
s_mov_b64 exec, -1
s_setprio 2
v_smfmac_f32_16x16x32_bf16 v[36:39], v[218:219], v[192:195], v246
ds_read_b128 v[236:239], v249 offset:4096
v_cvt_pkrtz_f16_f32 v137, v120, v121
v_cvt_pkrtz_f16_f32 v139, v122, v123
v_cvt_pkrtz_f16_f32 v141, v124, v125
v_smfmac_f32_16x16x32_bf16 v[20:23], v[216:217], v[196:199], v246
v_cvt_pkrtz_f16_f32 v143, v126, v127
v_cvt_pkrtz_f16_f32 v145, v128, v129
v_cvt_pk_f16_f32 v155, v130, v131
v_cvt_pk_f16_f32 v152, v132, v133
v_cvt_pk_f16_f32 v149, v134, v135
v_mfma_f32_32x32x16_bf16 v[120:135], v[48:51], v[220:223], 0
ds_read_b128 v[216:219], v245 offset:2304
ds_read_b128 v[208:211], v243 offset:64
ds_read_b128 v[212:215], v243
v_pk_fma_f16 v154, v155, v155, s48
v_and_b32_e64 v137, s49, v137
v_pk_fma_f16 v151, v152, v152, s48
v_and_b32_e64 v139, s49, v139
v_pk_fma_f16 v148, v149, v149, s48
v_mfma_f32_32x32x16_bf16 v[120:135], v[52:55], v[224:227], v[120:135]
ds_read_b128 v[220:223], v249 offset:2048
v_pk_mul_f16 v154, v155, v154
v_bfe_u32 v136, v137, 2, 14
v_pk_mul_f16 v151, v152, v151
v_pk_mul_f16 v148, v149, v148
v_bfe_u32 v138, v139, 2, 14
v_exp_f16_e64 v153, v154
s_waitcnt lgkmcnt(4)
v_smfmac_f32_16x16x32_bf16 v[4:7], v[230:231], v[200:203], v246
ds_read_b128 v[224:227], v245 offset:1920
v_xor_b32 v242, 32, v242
ds_read_b128 v[192:195], v242 offset:128
ds_read_b128 v[196:199], v242 offset:64
ds_read_u16_d16 v136, v136
ds_read_u16_d16 v138, v138
v_lshrrev_b32 v137, 18, v137
v_exp_f16 v150, v151
v_smfmac_f32_16x16x32_bf16 v[36:39], v[228:229], v[204:207], v246
v_lshrrev_b32 v139, 18, v139
v_exp_f16 v147, v148
v_and_b32_e64 v141, s49, v141
v_mfma_f32_32x32x16_bf16 v[120:135], v[56:59], v[232:235], v[120:135]
ds_read_b128 v[228:231], v249 offset:5120
ds_read_u16_d16_hi v137, v137
ds_read_u16_d16_hi v139, v139
v_and_b32_e64 v143, s49, v143
v_exp_f16_sdwa v153, v154 dst_sel:WORD_1 dst_unused:UNUSED_PRESERVE src0_sel:WORD_1
v_bfe_u32 v140, v141, 2, 14
v_exp_f16_sdwa v150, v151 dst_sel:WORD_1 dst_unused:UNUSED_PRESERVE src0_sel:WORD_1
v_bfe_u32 v142, v143, 2, 14
v_mfma_f32_32x32x16_bf16 v[120:135], v[60:63], v[236:239], v[120:135]
ds_read_b128 v[232:235], v245 offset:1536
ds_read_b128 v[200:203], v242
v_xor_b32 v244, 16, v244
ds_read_b128 v[204:207], v244 offset:128
ds_read_u16_d16 v140, v140
ds_read_u16_d16 v142, v142
v_exp_f16_sdwa v147, v148 dst_sel:WORD_1 dst_unused:UNUSED_PRESERVE src0_sel:WORD_1
v_lshrrev_b32 v141, 18, v141
v_pk_add_f16 v153, v153, 1.0 op_sel_hi:[1,0]
v_lshrrev_b32 v143, 18, v143
v_pk_add_f16 v150, v150, 1.0 op_sel_hi:[1,0]
s_waitcnt lgkmcnt(8)
v_smfmac_f32_16x16x32_bf16 v[20:23], v[218:219], v[208:211], v246
ds_read_b128 v[236:239], v245 offset:1152
ds_read_u16_d16_hi v141, v141
ds_read_u16_d16_hi v143, v143
v_pk_add_f16 v147, v147, 1.0 op_sel_hi:[1,0]
v_and_b32 v145, s49, v145
v_rcp_f16 v154, v153
v_smfmac_f32_16x16x32_bf16 v[4:7], v[216:217], v[212:215], v246
v_bfe_u32 v144, v145, 2, 14
v_rcp_f16_e64 v151, v150
v_mfma_f32_32x32x16_bf16 v[120:135], v[64:67], v[220:223], v[120:135]
ds_read_b128 v[208:211], v244 offset:64
ds_read_b128 v[212:215], v244
ds_read_b128 v[216:219], v249 offset:6144
ds_read_u16_d16 v144, v144
v_lshrrev_b32_e64 v145, 18, v145
v_rcp_f16 v148, v147
v_rcp_f16_sdwa v154, v153 dst_sel:WORD_1 dst_unused:UNUSED_PRESERVE src0_sel:WORD_1
ds_read_u16_d16_hi v145, v145
v_fma_mix_f32 v163, v136, v136, 0 op_sel:[0,0,0] op_sel_hi:[1,1,0]
s_waitcnt lgkmcnt(8)
v_fma_mix_f32 v163, v137, v137, v163 op_sel:[1,1,0] op_sel_hi:[1,1,0]
v_smfmac_f32_16x16x32_bf16 v[36:39], v[226:227], v[192:195], v246
ds_read_b128 v[220:223], v249 offset:9216
v_rcp_f16_sdwa v151, v150 dst_sel:WORD_1 dst_unused:UNUSED_PRESERVE src0_sel:WORD_1
v_fma_mix_f32 v163, v138, v138, v163 op_sel:[0,0,0] op_sel_hi:[1,1,0]
v_smfmac_f32_16x16x32_bf16 v[20:23], v[224:225], v[196:199], v246
v_rcp_f16_sdwa v148, v147 dst_sel:WORD_1 dst_unused:UNUSED_PRESERVE src0_sel:WORD_1
v_fma_mix_f32 v163, v139, v139, v163 op_sel:[1,1,0] op_sel_hi:[1,1,0]
v_pk_mul_f16 v155, v155, v154
v_mfma_f32_32x32x16_bf16 v[120:135], v[68:71], v[228:231], v[120:135]
ds_read_b128 v[224:227], v249 offset:7168
v_fma_mix_f32 v163, v140, v140, v163 op_sel:[0,0,0] op_sel_hi:[1,1,0]
v_pk_mul_f16 v152, v152, v151
s_waitcnt lgkmcnt(7)
v_fma_mix_f32 v163, v141, v141, v163 op_sel:[1,1,0] op_sel_hi:[1,1,0]
v_pk_mul_f16 v149, v149, v148
v_fma_mix_f32 v163, v155, v155, v163 op_sel:[0,0,0] op_sel_hi:[1,1,0]
v_fma_mix_f32 v163, v142, v142, v163 op_sel:[0,0,0] op_sel_hi:[1,1,0]
v_fma_mix_f32 v163, v155, v155, v163 op_sel:[1,1,0] op_sel_hi:[1,1,0]
v_smfmac_f32_16x16x32_bf16 v[4:7], v[234:235], v[200:203], v246
ds_read_b128 v[228:231], v245 offset:768
v_xor_b32 v243, 16, v243
ds_read_b128 v[192:195], v243 offset:128
ds_read_b128 v[196:199], v243 offset:64
v_fma_mix_f32 v163, v143, v143, v163 op_sel:[1,1,0] op_sel_hi:[1,1,0]
v_fma_mix_f32 v163, v152, v152, v163 op_sel:[0,0,0] op_sel_hi:[1,1,0]
v_fma_mix_f32 v163, v152, v152, v163 op_sel:[1,1,0] op_sel_hi:[1,1,0]
v_smfmac_f32_16x16x32_bf16 v[32:35], v[232:233], v[204:207], v246
s_waitcnt lgkmcnt(4)
v_fma_mix_f32 v163, v144, v144, v163 op_sel:[0,0,0] op_sel_hi:[1,1,0]
v_fma_mix_f32 v163, v149, v149, v163 op_sel:[0,0,0] op_sel_hi:[1,1,0]
v_fma_mix_f32 v163, v145, v145, v163 op_sel:[1,1,0] op_sel_hi:[1,1,0]
v_fma_mix_f32 v163, v149, v149, v163 op_sel:[1,1,0] op_sel_hi:[1,1,0]
v_lshlrev_b32 v252, 7, v251
s_add_u32 s46, s47, 1572864
s_mov_b32 exec_lo, 4294836224
s_mov_b32 exec_hi, 3
s_mov_b32 m0, 16220
s_nop 0
buffer_load_dword v252, s[4:7], s46 offen lds
s_mov_b64 exec, -1
s_setprio 1
v_smfmac_f32_16x16x32_bf16 v[16:19], v[238:239], v[208:211], v246
ds_read_b128 v[232:235], v249 offset:10240
v_cvt_pkrtz_f16_f32 v137, v120, v121
v_cvt_pkrtz_f16_f32 v139, v122, v123
v_cvt_pkrtz_f16_f32 v141, v124, v125
v_smfmac_f32_16x16x32_bf16 v[0:3], v[236:237], v[212:215], v246
v_cvt_pkrtz_f16_f32 v143, v126, v127
v_cvt_pk_f16_f32 v155, v128, v129
v_cvt_pk_f16_f32 v152, v130, v131
v_cvt_pk_f16_f32 v149, v132, v133
v_cvt_pk_f16_f32 v146, v134, v135
v_mfma_f32_32x32x16_bf16 v[120:135], v[48:51], v[216:219], 0
ds_read_b128 v[236:239], v249 offset:8192
v_pk_fma_f16 v154, v155, v155, s48
v_and_b32_e64 v137, s49, v137
v_pk_fma_f16 v151, v152, v152, s48
v_pk_fma_f16 v148, v149, v149, s48
v_and_b32 v139, s49, v139
v_pk_fma_f16 v145, v146, v146, s48
v_pk_mul_f16 v154, v155, v154
v_mfma_f32_32x32x16_bf16 v[120:135], v[52:55], v[220:223], v[120:135]
ds_read_b128 v[216:219], v245 offset:384
ds_read_b128 v[200:203], v243
v_xor_b32 v242, 16, v242
ds_read_b128 v[204:207], v242 offset:128
v_bfe_u32 v136, v137, 2, 14
v_pk_mul_f16 v151, v152, v151
v_pk_mul_f16 v148, v149, v148
v_bfe_u32 v138, v139, 2, 14
v_pk_mul_f16 v145, v146, v145
v_exp_f16 v153, v154
s_waitcnt lgkmcnt(4)
v_mfma_f32_32x32x16_bf16 v[120:135], v[56:59], v[224:227], v[120:135]
ds_read_b128 v[220:223], v249 offset:11264
ds_read_u16_d16 v136, v136
ds_read_u16_d16 v138, v138
v_lshrrev_b32 v137, 18, v137
v_exp_f16 v150, v151
v_lshrrev_b32 v139, 18, v139
v_exp_f16 v147, v148
v_and_b32_e64 v141, s49, v141
v_smfmac_f32_16x16x32_bf16 v[32:35], v[230:231], v[192:195], v246
ds_read_b128 v[224:227], v245
ds_read_b128 v[208:211], v242 offset:64
ds_read_b128 v[212:215], v242
ds_read_u16_d16_hi v137, v137
ds_read_u16_d16_hi v139, v139
v_exp_f16 v144, v145
v_and_b32 v143, s49, v143
v_exp_f16_sdwa v153, v154 dst_sel:WORD_1 dst_unused:UNUSED_PRESERVE src0_sel:WORD_1
v_smfmac_f32_16x16x32_bf16 v[16:19], v[228:229], v[196:199], v246
v_bfe_u32 v140, v141, 2, 14
v_exp_f16_sdwa v150, v151 dst_sel:WORD_1 dst_unused:UNUSED_PRESERVE src0_sel:WORD_1
v_mfma_f32_32x32x16_bf16 v[120:135], v[60:63], v[232:235], v[120:135]
ds_read_b128 v[228:231], v249 offset:12288
ds_read_u16_d16 v140, v140
v_bfe_u32 v142, v143, 2, 14
v_exp_f16_sdwa v147, v148 dst_sel:WORD_1 dst_unused:UNUSED_PRESERVE src0_sel:WORD_1
v_lshrrev_b32_e64 v141, 18, v141
v_exp_f16_sdwa v144, v145 dst_sel:WORD_1 dst_unused:UNUSED_PRESERVE src0_sel:WORD_1
v_lshrrev_b32 v143, 18, v143
v_pk_add_f16 v153, v153, 1.0 op_sel_hi:[1,0]
s_waitcnt lgkmcnt(7)
v_mfma_f32_32x32x16_bf16 v[120:135], v[64:67], v[236:239], v[120:135]
ds_read_b128 v[232:235], v249 offset:15360
ds_read_u16_d16 v142, v142
ds_read_u16_d16_hi v141, v141
ds_read_u16_d16_hi v143, v143
v_pk_add_f16 v150, v150, 1.0 op_sel_hi:[1,0]
v_pk_add_f16 v147, v147, 1.0 op_sel_hi:[1,0]
v_pk_add_f16 v144, v144, 1.0 op_sel_hi:[1,0]
v_rcp_f16 v154, v153
v_rcp_f16 v151, v150
v_smfmac_f32_16x16x32_bf16 v[0:3], v[218:219], v[200:203], v246
ds_read_b128 v[236:239], v249 offset:13312
v_rcp_f16 v148, v147
v_rcp_f16 v145, v144
v_smfmac_f32_16x16x32_bf16 v[32:35], v[216:217], v[204:207], v246
v_rcp_f16_sdwa v154, v153 dst_sel:WORD_1 dst_unused:UNUSED_PRESERVE src0_sel:WORD_1
v_rcp_f16_sdwa v151, v150 dst_sel:WORD_1 dst_unused:UNUSED_PRESERVE src0_sel:WORD_1
s_setprio 0
v_mfma_f32_32x32x16_bf16 v[120:135], v[68:71], v[220:223], v[120:135]
ds_read_b128 v[216:219], v249 offset:16384
v_rcp_f16_sdwa v148, v147 dst_sel:WORD_1 dst_unused:UNUSED_PRESERVE src0_sel:WORD_1
v_fma_mix_f32 v164, v136, v136, 0 op_sel:[0,0,0] op_sel_hi:[1,1,0]
v_rcp_f16_sdwa v145, v144 dst_sel:WORD_1 dst_unused:UNUSED_PRESERVE src0_sel:WORD_1
s_waitcnt lgkmcnt(6)
v_fma_mix_f32 v164, v137, v137, v164 op_sel:[1,1,0] op_sel_hi:[1,1,0]
v_pk_mul_f16 v155, v155, v154
v_fma_mix_f32 v164, v138, v138, v164 op_sel:[0,0,0] op_sel_hi:[1,1,0]
v_smfmac_f32_16x16x32_bf16 v[16:19], v[226:227], v[208:211], v246
ds_read_b128 v[220:223], v249 offset:14336
v_pk_mul_f16 v152, v152, v151
v_pk_mul_f16 v149, v149, v148
v_fma_mix_f32 v164, v139, v139, v164 op_sel:[1,1,0] op_sel_hi:[1,1,0]
v_pk_mul_f16 v146, v146, v145
v_smfmac_f32_16x16x32_bf16 v[0:3], v[224:225], v[212:215], v246
s_mov_b64 exec, 1
ds_add_u32 v253, v254 offset:16
s_mov_b64 exec, -1
v_fma_mix_f32 v164, v155, v155, v164 op_sel:[0,0,0] op_sel_hi:[1,1,0]
v_fma_mix_f32 v164, v140, v140, v164 op_sel:[0,0,0] op_sel_hi:[1,1,0]
v_fma_mix_f32 v164, v155, v155, v164 op_sel:[1,1,0] op_sel_hi:[1,1,0]
v_fma_mix_f32 v164, v152, v152, v164 op_sel:[0,0,0] op_sel_hi:[1,1,0]
s_waitcnt lgkmcnt(3)
v_fma_mix_f32 v164, v141, v141, v164 op_sel:[1,1,0] op_sel_hi:[1,1,0]
v_fma_mix_f32 v164, v152, v152, v164 op_sel:[1,1,0] op_sel_hi:[1,1,0]
v_fma_mix_f32 v164, v149, v149, v164 op_sel:[0,0,0] op_sel_hi:[1,1,0]
v_fma_mix_f32 v164, v142, v142, v164 op_sel:[0,0,0] op_sel_hi:[1,1,0]
v_fma_mix_f32 v164, v149, v149, v164 op_sel:[1,1,0] op_sel_hi:[1,1,0]
v_fma_mix_f32 v164, v146, v146, v164 op_sel:[0,0,0] op_sel_hi:[1,1,0]
v_fma_mix_f32 v164, v143, v143, v164 op_sel:[1,1,0] op_sel_hi:[1,1,0]
v_fma_mix_f32 v164, v146, v146, v164 op_sel:[1,1,0] op_sel_hi:[1,1,0]
s_setprio 3
v_pk_add_f32 v[168:169], v[0:1], v[2:3]
v_pk_mul_f32 v[170:171], v[0:1], v[0:1]
v_pk_fma_f32 v[170:171], v[2:3], v[2:3], v[170:171]
v_pk_add_f32 v[168:169], v[168:169], v[4:5]
v_pk_fma_f32 v[170:171], v[4:5], v[4:5], v[170:171]
v_pk_add_f32 v[168:169], v[168:169], v[6:7]
v_pk_fma_f32 v[170:171], v[6:7], v[6:7], v[170:171]
v_pk_add_f32 v[168:169], v[168:169], v[8:9]
v_pk_fma_f32 v[170:171], v[8:9], v[8:9], v[170:171]
v_pk_add_f32 v[168:169], v[168:169], v[10:11]
v_pk_fma_f32 v[170:171], v[10:11], v[10:11], v[170:171]
v_pk_add_f32 v[168:169], v[168:169], v[12:13]
v_pk_fma_f32 v[170:171], v[12:13], v[12:13], v[170:171]
v_pk_add_f32 v[168:169], v[168:169], v[14:15]
v_pk_fma_f32 v[170:171], v[14:15], v[14:15], v[170:171]
v_pk_add_f32 v[168:169], v[168:169], v[16:17]
v_pk_fma_f32 v[170:171], v[16:17], v[16:17], v[170:171]
v_pk_add_f32 v[168:169], v[168:169], v[18:19]
v_pk_fma_f32 v[170:171], v[18:19], v[18:19], v[170:171]
v_pk_add_f32 v[168:169], v[168:169], v[20:21]
v_pk_fma_f32 v[170:171], v[20:21], v[20:21], v[170:171]
v_pk_add_f32 v[168:169], v[168:169], v[22:23]
v_pk_fma_f32 v[170:171], v[22:23], v[22:23], v[170:171]
v_pk_add_f32 v[168:169], v[168:169], v[24:25]
v_pk_fma_f32 v[170:171], v[24:25], v[24:25], v[170:171]
v_pk_add_f32 v[168:169], v[168:169], v[26:27]
v_pk_fma_f32 v[170:171], v[26:27], v[26:27], v[170:171]
v_pk_add_f32 v[168:169], v[168:169], v[28:29]
v_pk_fma_f32 v[170:171], v[28:29], v[28:29], v[170:171]
v_pk_add_f32 v[168:169], v[168:169], v[30:31]
v_pk_fma_f32 v[170:171], v[30:31], v[30:31], v[170:171]
v_pk_add_f32 v[168:169], v[168:169], v[32:33]
v_pk_fma_f32 v[170:171], v[32:33], v[32:33], v[170:171]
v_pk_add_f32 v[168:169], v[168:169], v[34:35]
v_pk_fma_f32 v[170:171], v[34:35], v[34:35], v[170:171]
v_pk_add_f32 v[168:169], v[168:169], v[36:37]
v_pk_fma_f32 v[170:171], v[36:37], v[36:37], v[170:171]
v_pk_add_f32 v[168:169], v[168:169], v[38:39]
v_pk_fma_f32 v[170:171], v[38:39], v[38:39], v[170:171]
v_pk_add_f32 v[168:169], v[168:169], v[40:41]
v_pk_fma_f32 v[170:171], v[40:41], v[40:41], v[170:171]
v_pk_add_f32 v[168:169], v[168:169], v[42:43]
v_pk_fma_f32 v[170:171], v[42:43], v[42:43], v[170:171]
v_pk_add_f32 v[168:169], v[168:169], v[44:45]
v_pk_fma_f32 v[170:171], v[44:45], v[44:45], v[170:171]
v_pk_add_f32 v[168:169], v[168:169], v[46:47]
v_pk_fma_f32 v[170:171], v[46:47], v[46:47], v[170:171]
s_setprio 0
v_add_u32 v174, -36864, v242
v_subrev_u32 v175, 66560, v174
v_min_u32 v174, v174, v175
v_add_u32 v174, 90112, v174
v_sub_u32 v175, v174, v242
v_add_u32 v242, v175, v242
v_add_u32 v243, v175, v243
v_add_u32 v244, v175, v244
v_lshlrev_b32_e64 v252, 7, v251
s_add_u32 s46, s47, 1572864
s_mov_b32 exec_lo, 0
s_mov_b32 exec_hi, 1048572
s_mov_b32 m0, 16152
s_nop 0
buffer_load_dword v252, s[4:7], s46 offen lds
s_mov_b64 exec, -1
s_setprio 2
v_cvt_pkrtz_f16_f32 v137, v120, v121
v_cvt_pkrtz_f16_f32 v139, v122, v123
v_cvt_pkrtz_f16_f32 v141, v124, v125
v_cvt_pkrtz_f16_f32 v143, v126, v127
v_cvt_pkrtz_f16_f32 v145, v128, v129
v_cvt_pk_f16_f32 v155, v130, v131
v_cvt_pk_f16_f32 v152, v132, v133
v_cvt_pk_f16_f32 v149, v134, v135
ds_read_b128 v[224:227], v249 offset:17408
v_mfma_f32_32x32x16_bf16 v[120:135], v[48:51], v[228:231], 0
v_pk_fma_f16 v154, v155, v155, s48
v_add_f32 v168, v168, v169
v_and_b32 v137, s49, v137
v_pk_fma_f16 v151, v152, v152, s48
v_and_b32_e64 v139, s49, v139
v_pk_fma_f16 v148, v149, v149, s48
v_add_f32_e64 v170, v170, v171
v_pk_mul_f16 v154, v155, v154
v_bfe_u32 v136, v137, 2, 14
v_pk_mul_f16 v151, v152, v151
v_pk_mul_f16 v148, v149, v148
v_bfe_u32 v138, v139, 2, 14
ds_read_b128 v[228:231], v249 offset:18432
ds_read_u16_d16 v136, v136
ds_read_u16_d16 v138, v138
v_mfma_f32_32x32x16_bf16 v[120:135], v[52:55], v[232:235], v[120:135]
v_permlane32_swap_b32 v168, v170
v_exp_f16 v153, v154
v_lshrrev_b32 v137, 18, v137
v_exp_f16 v150, v151
v_add_f32 v168, v168, v170
v_lshrrev_b32 v139, 18, v139
v_exp_f16 v147, v148
v_and_b32 v141, s49, v141
v_and_b32_e64 v143, s49, v143
v_mul_f32 v168, 1009429163, v168
ds_read_b128 v[232:235], v249 offset:21504
ds_read_u16_d16_hi v137, v137
ds_read_u16_d16_hi v139, v139
v_mfma_f32_32x32x16_bf16 v[120:135], v[56:59], v[236:239], v[120:135]
v_exp_f16_sdwa v153, v154 dst_sel:WORD_1 dst_unused:UNUSED_PRESERVE src0_sel:WORD_1
v_bfe_u32 v140, v141, 2, 14
v_exp_f16_sdwa v150, v151 dst_sel:WORD_1 dst_unused:UNUSED_PRESERVE src0_sel:WORD_1
v_mov_b32_e64 v170, v168
v_bfe_u32 v142, v143, 2, 14
v_exp_f16_sdwa v147, v148 dst_sel:WORD_1 dst_unused:UNUSED_PRESERVE src0_sel:WORD_1
v_lshrrev_b32_e64 v141, 18, v141
v_permlane32_swap_b32 v168, v170
v_pk_add_f16 v153, v153, 1.0 op_sel_hi:[1,0]
s_waitcnt lgkmcnt(8)
ds_read_b128 v[236:239], v249 offset:19456
ds_read_u16_d16 v140, v140
ds_read_u16_d16 v142, v142
ds_read_u16_d16_hi v141, v141
v_mfma_f32_32x32x16_bf16 v[120:135], v[60:63], v[216:219], v[120:135]
v_lshrrev_b32_e64 v143, 18, v143
v_pk_add_f16 v150, v150, 1.0 op_sel_hi:[1,0]
v_pk_add_f16 v147, v147, 1.0 op_sel_hi:[1,0]
v_and_b32_e64 v145, s49, v145
v_fma_f32 v170, -v168, v168, v170
v_rcp_f16_e64 v154, v153
v_bfe_u32 v144, v145, 2, 14
v_rcp_f16 v151, v150
v_max_f32 v170, 0, v170
v_lshrrev_b32_e64 v145, 18, v145
ds_read_b128 v[216:219], v249 offset:22528
ds_read_u16_d16_hi v143, v143
ds_read_u16_d16 v144, v144
ds_read_u16_d16_hi v145, v145
v_mfma_f32_32x32x16_bf16 v[120:135], v[64:67], v[220:223], v[120:135]
v_rcp_f16 v148, v147
v_rcp_f16_sdwa v154, v153 dst_sel:WORD_1 dst_unused:UNUSED_PRESERVE src0_sel:WORD_1
v_add_f32 v170, 925353388, v170
s_waitcnt lgkmcnt(8)
v_fma_mix_f32 v165, v136, v136, 0 op_sel:[0,0,0] op_sel_hi:[1,1,0]
ds_read_b32 v247, v253 offset:16
v_fma_mix_f32 v165, v137, v137, v165 op_sel:[1,1,0] op_sel_hi:[1,1,0]
v_rcp_f16_sdwa v151, v150 dst_sel:WORD_1 dst_unused:UNUSED_PRESERVE src0_sel:WORD_1
v_rsq_f32_e64 v170, v170
v_fma_mix_f32 v165, v138, v138, v165 op_sel:[0,0,0] op_sel_hi:[1,1,0]
ds_read_b128 v[220:223], v249 offset:20480
v_mfma_f32_32x32x16_bf16 v[120:135], v[68:71], v[224:227], v[120:135]
v_rcp_f16_sdwa v148, v147 dst_sel:WORD_1 dst_unused:UNUSED_PRESERVE src0_sel:WORD_1
v_fma_mix_f32 v165, v139, v139, v165 op_sel:[1,1,0] op_sel_hi:[1,1,0]
v_pk_mul_f16 v155, v155, v154
s_waitcnt lgkmcnt(6)
v_fma_mix_f32 v165, v140, v140, v165 op_sel:[0,0,0] op_sel_hi:[1,1,0]
v_pk_mul_f16 v152, v152, v151
v_fma_mix_f32 v165, v141, v141, v165 op_sel:[1,1,0] op_sel_hi:[1,1,0]
v_pk_mul_f16 v149, v149, v148
v_fma_mix_f32 v165, v155, v155, v165 op_sel:[0,0,0] op_sel_hi:[1,1,0]
v_mul_f32 v172, 3203391086, v170
v_fma_mix_f32 v165, v142, v142, v165 op_sel:[0,0,0] op_sel_hi:[1,1,0]
v_fma_mix_f32 v165, v155, v155, v165 op_sel:[1,1,0] op_sel_hi:[1,1,0]
s_waitcnt lgkmcnt(2)
v_fma_mix_f32 v165, v143, v143, v165 op_sel:[1,1,0] op_sel_hi:[1,1,0]
v_fma_mix_f32 v165, v152, v152, v165 op_sel:[0,0,0] op_sel_hi:[1,1,0]
v_fma_mix_f32 v165, v152, v152, v165 op_sel:[1,1,0] op_sel_hi:[1,1,0]
v_mul_f32 v173, v168, v172
v_fma_mix_f32 v165, v144, v144, v165 op_sel:[0,0,0] op_sel_hi:[1,1,0]
v_fma_mix_f32 v165, v149, v149, v165 op_sel:[0,0,0] op_sel_hi:[1,1,0]
v_fma_mix_f32 v165, v145, v145, v165 op_sel:[1,1,0] op_sel_hi:[1,1,0]
v_fma_mix_f32 v165, v149, v149, v165 op_sel:[1,1,0] op_sel_hi:[1,1,0]
s_setprio 3
v_pk_fma_f32 v[0:1], v[0:1], v[172:173], v[172:173] op_sel:[0,0,1] op_sel_hi:[1,0,1] neg_lo:[0,0,1] neg_hi:[0,0,1]
v_pk_fma_f32 v[2:3], v[2:3], v[172:173], v[172:173] op_sel:[0,0,1] op_sel_hi:[1,0,1] neg_lo:[0,0,1] neg_hi:[0,0,1]
v_pk_fma_f32 v[4:5], v[4:5], v[172:173], v[172:173] op_sel:[0,0,1] op_sel_hi:[1,0,1] neg_lo:[0,0,1] neg_hi:[0,0,1]
v_pk_fma_f32 v[6:7], v[6:7], v[172:173], v[172:173] op_sel:[0,0,1] op_sel_hi:[1,0,1] neg_lo:[0,0,1] neg_hi:[0,0,1]
v_pk_fma_f32 v[8:9], v[8:9], v[172:173], v[172:173] op_sel:[0,0,1] op_sel_hi:[1,0,1] neg_lo:[0,0,1] neg_hi:[0,0,1]
v_pk_fma_f32 v[10:11], v[10:11], v[172:173], v[172:173] op_sel:[0,0,1] op_sel_hi:[1,0,1] neg_lo:[0,0,1] neg_hi:[0,0,1]
v_pk_fma_f32 v[12:13], v[12:13], v[172:173], v[172:173] op_sel:[0,0,1] op_sel_hi:[1,0,1] neg_lo:[0,0,1] neg_hi:[0,0,1]
v_pk_fma_f32 v[14:15], v[14:15], v[172:173], v[172:173] op_sel:[0,0,1] op_sel_hi:[1,0,1] neg_lo:[0,0,1] neg_hi:[0,0,1]
v_pk_fma_f32 v[16:17], v[16:17], v[172:173], v[172:173] op_sel:[0,0,1] op_sel_hi:[1,0,1] neg_lo:[0,0,1] neg_hi:[0,0,1]
v_pk_fma_f32 v[18:19], v[18:19], v[172:173], v[172:173] op_sel:[0,0,1] op_sel_hi:[1,0,1] neg_lo:[0,0,1] neg_hi:[0,0,1]
v_pk_fma_f32 v[20:21], v[20:21], v[172:173], v[172:173] op_sel:[0,0,1] op_sel_hi:[1,0,1] neg_lo:[0,0,1] neg_hi:[0,0,1]
v_pk_fma_f32 v[22:23], v[22:23], v[172:173], v[172:173] op_sel:[0,0,1] op_sel_hi:[1,0,1] neg_lo:[0,0,1] neg_hi:[0,0,1]
v_pk_fma_f32 v[24:25], v[24:25], v[172:173], v[172:173] op_sel:[0,0,1] op_sel_hi:[1,0,1] neg_lo:[0,0,1] neg_hi:[0,0,1]
v_pk_fma_f32 v[26:27], v[26:27], v[172:173], v[172:173] op_sel:[0,0,1] op_sel_hi:[1,0,1] neg_lo:[0,0,1] neg_hi:[0,0,1]
v_pk_fma_f32 v[28:29], v[28:29], v[172:173], v[172:173] op_sel:[0,0,1] op_sel_hi:[1,0,1] neg_lo:[0,0,1] neg_hi:[0,0,1]
v_pk_fma_f32 v[30:31], v[30:31], v[172:173], v[172:173] op_sel:[0,0,1] op_sel_hi:[1,0,1] neg_lo:[0,0,1] neg_hi:[0,0,1]
v_pk_fma_f32 v[32:33], v[32:33], v[172:173], v[172:173] op_sel:[0,0,1] op_sel_hi:[1,0,1] neg_lo:[0,0,1] neg_hi:[0,0,1]
v_pk_fma_f32 v[34:35], v[34:35], v[172:173], v[172:173] op_sel:[0,0,1] op_sel_hi:[1,0,1] neg_lo:[0,0,1] neg_hi:[0,0,1]
v_pk_fma_f32 v[36:37], v[36:37], v[172:173], v[172:173] op_sel:[0,0,1] op_sel_hi:[1,0,1] neg_lo:[0,0,1] neg_hi:[0,0,1]
v_pk_fma_f32 v[38:39], v[38:39], v[172:173], v[172:173] op_sel:[0,0,1] op_sel_hi:[1,0,1] neg_lo:[0,0,1] neg_hi:[0,0,1]
v_pk_fma_f32 v[40:41], v[40:41], v[172:173], v[172:173] op_sel:[0,0,1] op_sel_hi:[1,0,1] neg_lo:[0,0,1] neg_hi:[0,0,1]
v_pk_fma_f32 v[42:43], v[42:43], v[172:173], v[172:173] op_sel:[0,0,1] op_sel_hi:[1,0,1] neg_lo:[0,0,1] neg_hi:[0,0,1]
v_pk_fma_f32 v[44:45], v[44:45], v[172:173], v[172:173] op_sel:[0,0,1] op_sel_hi:[1,0,1] neg_lo:[0,0,1] neg_hi:[0,0,1]
v_pk_fma_f32 v[46:47], v[46:47], v[172:173], v[172:173] op_sel:[0,0,1] op_sel_hi:[1,0,1] neg_lo:[0,0,1] neg_hi:[0,0,1]
s_setprio 2
s_waitcnt lgkmcnt(0)
v_readfirstlane_b32 s43, v247
s_nop 1
s_cmp_ge_u32 s43, 16
s_cbranch_scc1 Lev4
Lev4w:
s_sleep 1
ds_read_b32 v247, v253 offset:16
s_waitcnt lgkmcnt(0)
v_readfirstlane_b32 s43, v247
s_cmp_eq_u32 s76, 0
s_cbranch_scc1 Lev4
s_sub_u32 s76, s76, 1
s_cmp_lt_u32 s43, 16
s_cbranch_scc1 Lev4w
Lev4:
s_setprio 1
v_cvt_pkrtz_f16_f32 v137, v120, v121
v_cvt_pkrtz_f16_f32 v139, v122, v123
v_cvt_pkrtz_f16_f32 v141, v124, v125
v_cvt_pkrtz_f16_f32 v143, v126, v127
v_cvt_pkrtz_f16_f32 v145, v128, v129
v_cvt_pk_f16_f32 v155, v130, v131
v_cvt_pk_f16_f32 v152, v132, v133
v_cvt_pk_f16_f32 v149, v134, v135
s_add_u32 m0, s67, 53248
s_add_u32 s66, s66, 98304
buffer_load_dwordx4 v240, s[4:7], s66 offen lds
ds_read_b128 v[224:227], v249 offset:23552
v_mfma_f32_32x32x16_bf16 v[120:135], v[48:51], v[228:231], 0
v_pk_fma_f16 v154, v155, v155, s48
v_cvt_pk_bf16_f32 v72, v0, v1
v_and_b32 v137, s49, v137
v_pk_fma_f16 v151, v152, v152, s48
v_cvt_pk_bf16_f32 v73, v2, v3
v_and_b32_e64 v139, s49, v139
v_pk_fma_f16 v148, v149, v149, s48
v_pk_mul_f16 v154, v155, v154
v_cvt_pk_bf16_f32 v74, v4, v5
v_bfe_u32 v136, v137, 2, 14
v_pk_mul_f16 v151, v152, v151
v_pk_mul_f16 v148, v149, v148
v_cvt_pk_bf16_f32 v75, v6, v7
v_bfe_u32 v138, v139, 2, 14
s_add_u32 m0, s67, 59904
s_add_u32 s66, s66, 98304
buffer_load_dwordx4 v240, s[4:7], s66 offen lds
ds_read_b128 v[228:231], v248 offset:16384
ds_read_u16_d16 v136, v136
ds_read_u16_d16 v138, v138
v_mfma_f32_32x32x16_bf16 v[120:135], v[52:55], v[232:235], v[120:135]
v_exp_f16_e64 v153, v154
v_cvt_pk_bf16_f32 v76, v8, v9
v_lshrrev_b32 v137, 18, v137
v_exp_f16 v150, v151
v_cvt_pk_bf16_f32 v77, v10, v11
v_lshrrev_b32 v139, 18, v139
v_exp_f16 v147, v148
v_cvt_pk_bf16_f32 v78, v12, v13
v_and_b32_e64 v141, s49, v141
v_and_b32 v143, s49, v143
v_cvt_pk_bf16_f32 v79, v14, v15
s_add_u32 m0, s67, 0
s_add_u32 s66, s66, 98304
buffer_load_dwordx4 v240, s[4:7], s66 offen lds
ds_read_b128 v[232:235], v248 offset:19456
ds_read_u16_d16_hi v137, v137
ds_read_u16_d16_hi v139, v139
v_mfma_f32_32x32x16_bf16 v[120:135], v[56:59], v[236:239], v[120:135]
v_exp_f16_sdwa v153, v154 dst_sel:WORD_1 dst_unused:UNUSED_PRESERVE src0_sel:WORD_1
v_bfe_u32 v140, v141, 2, 14
v_cvt_pk_bf16_f32 v80, v16, v17
v_exp_f16_sdwa v150, v151 dst_sel:WORD_1 dst_unused:UNUSED_PRESERVE src0_sel:WORD_1
v_bfe_u32 v142, v143, 2, 14
v_cvt_pk_bf16_f32 v81, v18, v19
v_exp_f16_sdwa v147, v148 dst_sel:WORD_1 dst_unused:UNUSED_PRESERVE src0_sel:WORD_1
v_cvt_pk_bf16_f32 v82, v20, v21
v_lshrrev_b32_e64 v141, 18, v141
v_pk_add_f16 v153, v153, 1.0 op_sel_hi:[1,0]
v_lshrrev_b32_e64 v143, 18, v143
s_add_u32 m0, s67, 6656
s_add_u32 s66, s66, 98304
buffer_load_dwordx4 v240, s[4:7], s66 offen lds
s_add_u32 m0, s67, 13312
s_add_u32 s66, s66, 98304
buffer_load_dwordx4 v240, s[4:7], s66 offen lds
ds_read_b128 v[236:239], v248 offset:17408
ds_read_u16_d16 v140, v140
ds_read_u16_d16 v142, v142
ds_read_u16_d16_hi v141, v141
ds_read_u16_d16_hi v143, v143
v_mfma_f32_32x32x16_bf16 v[120:135], v[60:63], v[216:219], v[120:135]
v_cvt_pk_bf16_f32 v83, v22, v23
v_pk_add_f16 v150, v150, 1.0 op_sel_hi:[1,0]
v_pk_add_f16 v147, v147, 1.0 op_sel_hi:[1,0]
v_and_b32_e64 v145, s49, v145
v_cvt_pk_bf16_f32 v84, v24, v25
v_rcp_f16_e64 v154, v153
v_bfe_u32 v144, v145, 2, 14
v_cvt_pk_bf16_f32 v85, v26, v27
v_rcp_f16 v151, v150
v_lshrrev_b32 v145, 18, v145
v_cvt_pk_bf16_f32 v86, v28, v29
s_add_u32 m0, s67, 19968
s_add_u32 s66, s66, 98304
buffer_load_dwordx4 v240, s[4:7], s66 offen lds
ds_read_b128 v[216:219], v248 offset:20480
ds_read_u16_d16 v144, v144
ds_read_u16_d16_hi v145, v145
v_mfma_f32_32x32x16_bf16 v[120:135], v[64:67], v[220:223], v[120:135]
v_rcp_f16_e64 v148, v147
v_cvt_pk_bf16_f32 v87, v30, v31
v_rcp_f16_sdwa v154, v153 dst_sel:WORD_1 dst_unused:UNUSED_PRESERVE src0_sel:WORD_1
s_waitcnt lgkmcnt(5)
v_fma_mix_f32 v166, v136, v136, 0 op_sel:[0,0,0] op_sel_hi:[1,1,0]
v_cvt_pk_bf16_f32 v88, v32, v33
s_setprio 0
v_fma_mix_f32 v166, v137, v137, v166 op_sel:[1,1,0] op_sel_hi:[1,1,0]
v_rcp_f16_sdwa v151, v150 dst_sel:WORD_1 dst_unused:UNUSED_PRESERVE src0_sel:WORD_1
v_cvt_pk_bf16_f32 v89, v34, v35
v_fma_mix_f32 v166, v138, v138, v166 op_sel:[0,0,0] op_sel_hi:[1,1,0]
v_rcp_f16_sdwa v148, v147 dst_sel:WORD_1 dst_unused:UNUSED_PRESERVE src0_sel:WORD_1
v_cvt_pk_bf16_f32 v90, v36, v37
s_add_u32 m0, s67, 26624
s_add_u32 s66, s66, 98304
buffer_load_dwordx4 v240, s[4:7], s66 offen lds
ds_read_b128 v[220:223], v248 offset:18432
v_mfma_f32_32x32x16_bf16 v[120:135], v[68:71], v[224:227], v[120:135]
v_fma_mix_f32 v166, v139, v139, v166 op_sel:[1,1,0] op_sel_hi:[1,1,0]
v_pk_mul_f16 v155, v155, v154
v_fma_mix_f32 v166, v140, v140, v166 op_sel:[0,0,0] op_sel_hi:[1,1,0]
v_cvt_pk_bf16_f32 v91, v38, v39
v_pk_mul_f16 v152, v152, v151
s_waitcnt lgkmcnt(1)
v_fma_mix_f32 v166, v141, v141, v166 op_sel:[1,1,0] op_sel_hi:[1,1,0]
v_cvt_pk_bf16_f32 v92, v40, v41
v_pk_mul_f16 v149, v149, v148
v_fma_mix_f32 v166, v155, v155, v166 op_sel:[0,0,0] op_sel_hi:[1,1,0]
v_fma_mix_f32 v166, v142, v142, v166 op_sel:[0,0,0] op_sel_hi:[1,1,0]
v_cvt_pk_bf16_f32 v93, v42, v43
v_fma_mix_f32 v166, v155, v155, v166 op_sel:[1,1,0] op_sel_hi:[1,1,0]
v_fma_mix_f32 v166, v143, v143, v166 op_sel:[1,1,0] op_sel_hi:[1,1,0]
v_fma_mix_f32 v166, v152, v152, v166 op_sel:[0,0,0] op_sel_hi:[1,1,0]
s_add_u32 m0, s67, 33280
s_add_u32 s66, s66, 98304
buffer_load_dwordx4 v240, s[4:7], s66 offen lds
v_cvt_pk_bf16_f32 v94, v44, v45
v_fma_mix_f32 v166, v152, v152, v166 op_sel:[1,1,0] op_sel_hi:[1,1,0]
v_fma_mix_f32 v166, v144, v144, v166 op_sel:[0,0,0] op_sel_hi:[1,1,0]
v_fma_mix_f32 v166, v149, v149, v166 op_sel:[0,0,0] op_sel_hi:[1,1,0]
v_cvt_pk_bf16_f32 v95, v46, v47
v_fma_mix_f32 v166, v145, v145, v166 op_sel:[1,1,0] op_sel_hi:[1,1,0]
v_fma_mix_f32 v166, v149, v149, v166 op_sel:[1,1,0] op_sel_hi:[1,1,0]
s_setprio 2
v_cvt_pkrtz_f16_f32 v137, v120, v121
v_cvt_pkrtz_f16_f32 v139, v122, v123
v_cvt_pkrtz_f16_f32 v141, v124, v125
v_cvt_pkrtz_f16_f32 v143, v126, v127
v_cvt_pkrtz_f16_f32 v145, v128, v129
v_cvt_pk_f16_f32 v155, v130, v131
v_cvt_pk_f16_f32 v152, v132, v133
v_cvt_pk_f16_f32 v149, v134, v135
buffer_store_dwordx4 v[48:51], v241, s[32:35], s80 offen sc1
ds_read_b128 v[224:227], v248 offset:21504
v_mfma_f32_32x32x16_bf16 v[120:135], v[72:75], v[228:231], 0
v_pk_fma_f16 v154, v155, v155, s48
v_and_b32_e64 v137, s49, v137
v_pk_fma_f16 v151, v152, v152, s48
v_and_b32_e64 v139, s49, v139
v_pk_fma_f16 v148, v149, v149, s48
v_pk_mul_f16 v154, v155, v154
v_bfe_u32 v136, v137, 2, 14
v_pk_mul_f16 v151, v152, v151
v_pk_mul_f16 v148, v149, v148
v_bfe_u32 v138, v139, 2, 14
ds_read_b128 v[228:231], v248 offset:22528
ds_read_u16_d16 v136, v136
ds_read_u16_d16 v138, v138
v_mfma_f32_32x32x16_bf16 v[120:135], v[76:79], v[232:235], v[120:135]
v_exp_f16 v153, v154
v_lshrrev_b32 v137, 18, v137
v_exp_f16 v150, v151
v_lshrrev_b32 v139, 18, v139
v_exp_f16 v147, v148
v_and_b32 v141, s49, v141
v_and_b32_e64 v143, s49, v143
ds_read_b128 v[232:235], v248 offset:25600
ds_read_u16_d16_hi v137, v137
ds_read_u16_d16_hi v139, v139
v_mfma_f32_32x32x16_bf16 v[120:135], v[80:83], v[236:239], v[120:135]
v_exp_f16_sdwa v153, v154 dst_sel:WORD_1 dst_unused:UNUSED_PRESERVE src0_sel:WORD_1
v_bfe_u32 v140, v141, 2, 14
v_exp_f16_sdwa v150, v151 dst_sel:WORD_1 dst_unused:UNUSED_PRESERVE src0_sel:WORD_1
v_bfe_u32 v142, v143, 2, 14
v_exp_f16_sdwa v147, v148 dst_sel:WORD_1 dst_unused:UNUSED_PRESERVE src0_sel:WORD_1
v_lshrrev_b32_e64 v141, 18, v141
v_pk_add_f16 v153, v153, 1.0 op_sel_hi:[1,0]
ds_read_b128 v[236:239], v248 offset:23552
ds_read_u16_d16 v140, v140
ds_read_u16_d16 v142, v142
ds_read_u16_d16_hi v141, v141
v_mfma_f32_32x32x16_bf16 v[120:135], v[84:87], v[216:219], v[120:135]
v_lshrrev_b32_e64 v143, 18, v143
v_pk_add_f16 v150, v150, 1.0 op_sel_hi:[1,0]
v_pk_add_f16 v147, v147, 1.0 op_sel_hi:[1,0]
v_and_b32 v145, s49, v145
v_rcp_f16 v154, v153
v_bfe_u32 v144, v145, 2, 14
v_rcp_f16_e64 v151, v150
v_lshrrev_b32 v145, 18, v145
s_waitcnt lgkmcnt(7)
ds_read_b128 v[216:219], v248 offset:26624
ds_read_u16_d16_hi v143, v143
ds_read_u16_d16 v144, v144
ds_read_u16_d16_hi v145, v145
v_mfma_f32_32x32x16_bf16 v[120:135], v[88:91], v[220:223], v[120:135]
v_rcp_f16 v148, v147
v_rcp_f16_sdwa v154, v153 dst_sel:WORD_1 dst_unused:UNUSED_PRESERVE src0_sel:WORD_1
v_fma_mix_f32 v167, v136, v136, 0 op_sel:[0,0,0] op_sel_hi:[1,1,0]
s_waitcnt lgkmcnt(8)
v_fma_mix_f32 v167, v137, v137, v167 op_sel:[1,1,0] op_sel_hi:[1,1,0]
v_rcp_f16_sdwa v151, v150 dst_sel:WORD_1 dst_unused:UNUSED_PRESERVE src0_sel:WORD_1
v_fma_mix_f32 v167, v138, v138, v167 op_sel:[0,0,0] op_sel_hi:[1,1,0]
ds_read_b128 v[220:223], v248 offset:24576
v_mfma_f32_32x32x16_bf16 v[120:135], v[92:95], v[224:227], v[120:135]
v_rcp_f16_sdwa v148, v147 dst_sel:WORD_1 dst_unused:UNUSED_PRESERVE src0_sel:WORD_1
v_fma_mix_f32 v167, v139, v139, v167 op_sel:[1,1,0] op_sel_hi:[1,1,0]
v_pk_mul_f16 v155, v155, v154
s_waitcnt lgkmcnt(5)
v_fma_mix_f32 v167, v140, v140, v167 op_sel:[0,0,0] op_sel_hi:[1,1,0]
v_pk_mul_f16 v152, v152, v151
v_fma_mix_f32 v167, v141, v141, v167 op_sel:[1,1,0] op_sel_hi:[1,1,0]
v_pk_mul_f16 v149, v149, v148
v_fma_mix_f32 v167, v155, v155, v167 op_sel:[0,0,0] op_sel_hi:[1,1,0]
v_fma_mix_f32 v167, v142, v142, v167 op_sel:[0,0,0] op_sel_hi:[1,1,0]
v_fma_mix_f32 v167, v155, v155, v167 op_sel:[1,1,0] op_sel_hi:[1,1,0]
s_waitcnt lgkmcnt(3)
v_fma_mix_f32 v167, v143, v143, v167 op_sel:[1,1,0] op_sel_hi:[1,1,0]
v_fma_mix_f32 v167, v152, v152, v167 op_sel:[0,0,0] op_sel_hi:[1,1,0]
v_fma_mix_f32 v167, v152, v152, v167 op_sel:[1,1,0] op_sel_hi:[1,1,0]
s_waitcnt lgkmcnt(1)
v_fma_mix_f32 v167, v144, v144, v167 op_sel:[0,0,0] op_sel_hi:[1,1,0]
v_fma_mix_f32 v167, v149, v149, v167 op_sel:[0,0,0] op_sel_hi:[1,1,0]
v_fma_mix_f32 v167, v145, v145, v167 op_sel:[1,1,0] op_sel_hi:[1,1,0]
v_fma_mix_f32 v167, v149, v149, v167 op_sel:[1,1,0] op_sel_hi:[1,1,0]
s_setprio 1
v_cvt_pkrtz_f16_f32 v137, v120, v121
v_cvt_pkrtz_f16_f32 v139, v122, v123
v_cvt_pkrtz_f16_f32 v141, v124, v125
v_cvt_pkrtz_f16_f32 v143, v126, v127
v_cvt_pkrtz_f16_f32 v145, v128, v129
v_cvt_pk_f16_f32 v155, v130, v131
v_cvt_pk_f16_f32 v152, v132, v133
v_cvt_pk_f16_f32 v149, v134, v135
s_add_u32 s46, s80, 2097152
buffer_store_dwordx4 v[52:55], v241, s[32:35], s46 offen sc1
ds_read_b128 v[224:227], v248 offset:27648
v_mfma_f32_32x32x16_bf16 v[120:135], v[72:75], v[228:231], 0
v_pk_fma_f16 v154, v155, v155, s48
v_and_b32_e64 v137, s49, v137
v_pk_fma_f16 v151, v152, v152, s48
v_and_b32_e64 v139, s49, v139
v_pk_fma_f16 v148, v149, v149, s48
v_pk_mul_f16 v154, v155, v154
v_bfe_u32 v136, v137, 2, 14
v_pk_mul_f16 v151, v152, v151
v_pk_mul_f16 v148, v149, v148
v_bfe_u32 v138, v139, 2, 14
ds_read_b128 v[228:231], v248 offset:28672
ds_read_u16_d16 v136, v136
ds_read_u16_d16 v138, v138
v_mfma_f32_32x32x16_bf16 v[120:135], v[76:79], v[232:235], v[120:135]
v_exp_f16 v153, v154
v_lshrrev_b32 v137, 18, v137
v_exp_f16 v150, v151
v_lshrrev_b32 v139, 18, v139
v_exp_f16 v147, v148
v_and_b32 v141, s49, v141
v_and_b32_e64 v143, s49, v143
ds_read_b128 v[232:235], v248 offset:31744
ds_read_u16_d16_hi v137, v137
ds_read_u16_d16_hi v139, v139
v_mfma_f32_32x32x16_bf16 v[120:135], v[80:83], v[236:239], v[120:135]
v_exp_f16_sdwa v153, v154 dst_sel:WORD_1 dst_unused:UNUSED_PRESERVE src0_sel:WORD_1
v_bfe_u32 v140, v141, 2, 14
v_exp_f16_sdwa v150, v151 dst_sel:WORD_1 dst_unused:UNUSED_PRESERVE src0_sel:WORD_1
v_bfe_u32 v142, v143, 2, 14
v_exp_f16_sdwa v147, v148 dst_sel:WORD_1 dst_unused:UNUSED_PRESERVE src0_sel:WORD_1
v_lshrrev_b32_e64 v141, 18, v141
v_pk_add_f16 v153, v153, 1.0 op_sel_hi:[1,0]
ds_read_b128 v[236:239], v248 offset:29696
ds_read_u16_d16 v140, v140
ds_read_u16_d16 v142, v142
ds_read_u16_d16_hi v141, v141
v_mfma_f32_32x32x16_bf16 v[120:135], v[84:87], v[216:219], v[120:135]
v_lshrrev_b32_e64 v143, 18, v143
v_pk_add_f16 v150, v150, 1.0 op_sel_hi:[1,0]
v_pk_add_f16 v147, v147, 1.0 op_sel_hi:[1,0]
v_and_b32 v145, s49, v145
v_rcp_f16 v154, v153
v_bfe_u32 v144, v145, 2, 14
v_rcp_f16_e64 v151, v150
v_lshrrev_b32 v145, 18, v145
s_waitcnt lgkmcnt(7)
ds_read_b128 v[216:219], v248 offset:32768
ds_read_u16_d16_hi v143, v143
ds_read_u16_d16 v144, v144
ds_read_u16_d16_hi v145, v145
v_mfma_f32_32x32x16_bf16 v[120:135], v[88:91], v[220:223], v[120:135]
v_rcp_f16_e64 v148, v147
v_rcp_f16_sdwa v154, v153 dst_sel:WORD_1 dst_unused:UNUSED_PRESERVE src0_sel:WORD_1
v_fma_mix_f32 v156, v136, v136, v156 op_sel:[0,0,0] op_sel_hi:[1,1,0]
s_setprio 0
s_waitcnt lgkmcnt(8)
v_fma_mix_f32 v156, v137, v137, v156 op_sel:[1,1,0] op_sel_hi:[1,1,0]
v_rcp_f16_sdwa v151, v150 dst_sel:WORD_1 dst_unused:UNUSED_PRESERVE src0_sel:WORD_1
v_fma_mix_f32 v156, v138, v138, v156 op_sel:[0,0,0] op_sel_hi:[1,1,0]
ds_read_b128 v[220:223], v248 offset:30720
v_mfma_f32_32x32x16_bf16 v[120:135], v[92:95], v[224:227], v[120:135]
v_rcp_f16_sdwa v148, v147 dst_sel:WORD_1 dst_unused:UNUSED_PRESERVE src0_sel:WORD_1
v_fma_mix_f32 v156, v139, v139, v156 op_sel:[1,1,0] op_sel_hi:[1,1,0]
v_pk_mul_f16 v155, v155, v154
s_cmp_eq_u32 s40, 7
s_cbranch_scc1 Lrdy16
s_waitcnt vmcnt(2)
Lrdy16:
s_mov_b64 exec, 1
ds_add_u32 v253, v254 offset:12
s_mov_b64 exec, -1
s_waitcnt lgkmcnt(6)
v_fma_mix_f32 v156, v140, v140, v156 op_sel:[0,0,0] op_sel_hi:[1,1,0]
v_pk_mul_f16 v152, v152, v151
v_fma_mix_f32 v156, v141, v141, v156 op_sel:[1,1,0] op_sel_hi:[1,1,0]
v_pk_mul_f16 v149, v149, v148
v_fma_mix_f32 v156, v155, v155, v156 op_sel:[0,0,0] op_sel_hi:[1,1,0]
v_fma_mix_f32 v156, v142, v142, v156 op_sel:[0,0,0] op_sel_hi:[1,1,0]
v_fma_mix_f32 v156, v155, v155, v156 op_sel:[1,1,0] op_sel_hi:[1,1,0]
s_waitcnt lgkmcnt(2)
v_fma_mix_f32 v156, v143, v143, v156 op_sel:[1,1,0] op_sel_hi:[1,1,0]
v_fma_mix_f32 v156, v152, v152, v156 op_sel:[0,0,0] op_sel_hi:[1,1,0]
v_fma_mix_f32 v156, v152, v152, v156 op_sel:[1,1,0] op_sel_hi:[1,1,0]
v_fma_mix_f32 v156, v144, v144, v156 op_sel:[0,0,0] op_sel_hi:[1,1,0]
v_fma_mix_f32 v156, v149, v149, v156 op_sel:[0,0,0] op_sel_hi:[1,1,0]
v_fma_mix_f32 v156, v145, v145, v156 op_sel:[1,1,0] op_sel_hi:[1,1,0]
v_fma_mix_f32 v156, v149, v149, v156 op_sel:[1,1,0] op_sel_hi:[1,1,0]
s_setprio 2
v_cvt_pkrtz_f16_f32 v137, v120, v121
v_cvt_pkrtz_f16_f32 v139, v122, v123
v_cvt_pkrtz_f16_f32 v141, v124, v125
v_cvt_pkrtz_f16_f32 v143, v126, v127
v_cvt_pkrtz_f16_f32 v145, v128, v129
v_cvt_pk_f16_f32 v155, v130, v131
v_cvt_pk_f16_f32 v152, v132, v133
v_cvt_pk_f16_f32 v149, v134, v135
s_add_u32 s46, s80, 4194304
buffer_store_dwordx4 v[56:59], v241, s[32:35], s46 offen sc1
ds_read_b128 v[224:227], v248 offset:33792
v_mfma_f32_32x32x16_bf16 v[120:135], v[72:75], v[228:231], 0
v_pk_fma_f16 v154, v155, v155, s48
v_and_b32_e64 v137, s49, v137
v_pk_fma_f16 v151, v152, v152, s48
v_and_b32_e64 v139, s49, v139
v_pk_fma_f16 v148, v149, v149, s48
v_pk_mul_f16 v154, v155, v154
v_bfe_u32 v136, v137, 2, 14
v_pk_mul_f16 v151, v152, v151
v_pk_mul_f16 v148, v149, v148
v_bfe_u32 v138, v139, 2, 14
ds_read_b128 v[228:231], v250 offset:65520
ds_read_u16_d16 v136, v136
ds_read_u16_d16 v138, v138
v_mfma_f32_32x32x16_bf16 v[120:135], v[76:79], v[232:235], v[120:135]
v_exp_f16 v153, v154
v_lshrrev_b32 v137, 18, v137
v_exp_f16 v150, v151
v_lshrrev_b32 v139, 18, v139
v_exp_f16 v147, v148
v_and_b32 v141, s49, v141
v_and_b32_e64 v143, s49, v143
ds_read_b128 v[232:235], v248 offset:34816
ds_read_u16_d16_hi v137, v137
ds_read_b32 v247, v253 offset:12
ds_read_u16_d16_hi v139, v139
v_mfma_f32_32x32x16_bf16 v[120:135], v[80:83], v[236:239], v[120:135]
v_exp_f16_sdwa v153, v154 dst_sel:WORD_1 dst_unused:UNUSED_PRESERVE src0_sel:WORD_1
v_bfe_u32 v140, v141, 2, 14
v_exp_f16_sdwa v150, v151 dst_sel:WORD_1 dst_unused:UNUSED_PRESERVE src0_sel:WORD_1
v_bfe_u32 v142, v143, 2, 14
v_exp_f16_sdwa v147, v148 dst_sel:WORD_1 dst_unused:UNUSED_PRESERVE src0_sel:WORD_1
v_lshrrev_b32_e64 v141, 18, v141
v_pk_add_f16 v153, v153, 1.0 op_sel_hi:[1,0]
ds_read_b128 v[236:239], v248 offset:37888
ds_read_u16_d16 v140, v140
ds_read_u16_d16 v142, v142
ds_read_u16_d16_hi v141, v141
v_mfma_f32_32x32x16_bf16 v[120:135], v[84:87], v[216:219], v[120:135]
v_lshrrev_b32_e64 v143, 18, v143
v_pk_add_f16 v150, v150, 1.0 op_sel_hi:[1,0]
v_pk_add_f16 v147, v147, 1.0 op_sel_hi:[1,0]
v_and_b32 v145, s49, v145
v_rcp_f16 v154, v153
v_bfe_u32 v144, v145, 2, 14
ds_read_u16_d16_hi v143, v143
ds_read_u16_d16 v144, v144
s_waitcnt lgkmcnt(7)
v_readfirstlane_b32 s43, v247
s_nop 1
s_cmp_ge_u32 s43, 24
s_cbranch_scc1 Lev5
Lev5w:
s_sleep 1
ds_read_b32 v247, v253 offset:12
s_waitcnt lgkmcnt(0)
v_readfirstlane_b32 s43, v247
s_cmp_eq_u32 s76, 0
s_cbranch_scc1 Lev5
s_sub_u32 s76, s76, 1
s_cmp_lt_u32 s43, 24
s_cbranch_scc1 Lev5w
Lev5:
v_rcp_f16 v151, v150
v_lshrrev_b32_e64 v145, 18, v145
ds_read_b128 v[216:219], v248 offset:35840
ds_read_u16_d16_hi v145, v145
v_mfma_f32_32x32x16_bf16 v[120:135], v[88:91], v[220:223], v[120:135]
v_rcp_f16 v148, v147
v_rcp_f16_sdwa v154, v153 dst_sel:WORD_1 dst_unused:UNUSED_PRESERVE src0_sel:WORD_1
v_fma_mix_f32 v157, v136, v136, v157 op_sel:[0,0,0] op_sel_hi:[1,1,0]
v_fma_mix_f32 v157, v137, v137, v157 op_sel:[1,1,0] op_sel_hi:[1,1,0]
v_rcp_f16_sdwa v151, v150 dst_sel:WORD_1 dst_unused:UNUSED_PRESERVE src0_sel:WORD_1
v_fma_mix_f32 v157, v138, v138, v157 op_sel:[0,0,0] op_sel_hi:[1,1,0]
ds_read_b128 v[220:223], v245
ds_read_b128 v[192:195], v242
ds_read_b128 v[196:199], v242 offset:64
v_mfma_f32_32x32x16_bf16 v[120:135], v[92:95], v[224:227], v[120:135]
v_rcp_f16_sdwa v148, v147 dst_sel:WORD_1 dst_unused:UNUSED_PRESERVE src0_sel:WORD_1
s_waitcnt lgkmcnt(5)
v_fma_mix_f32 v157, v139, v139, v157 op_sel:[1,1,0] op_sel_hi:[1,1,0]
v_pk_mul_f16 v155, v155, v154
v_fma_mix_f32 v157, v140, v140, v157 op_sel:[0,0,0] op_sel_hi:[1,1,0]
v_pk_mul_f16 v152, v152, v151
v_fma_mix_f32 v157, v141, v141, v157 op_sel:[1,1,0] op_sel_hi:[1,1,0]
v_pk_mul_f16 v149, v149, v148
v_fma_mix_f32 v157, v155, v155, v157 op_sel:[0,0,0] op_sel_hi:[1,1,0]
v_fma_mix_f32 v157, v142, v142, v157 op_sel:[0,0,0] op_sel_hi:[1,1,0]
v_fma_mix_f32 v157, v155, v155, v157 op_sel:[1,1,0] op_sel_hi:[1,1,0]
v_fma_mix_f32 v157, v143, v143, v157 op_sel:[1,1,0] op_sel_hi:[1,1,0]
v_fma_mix_f32 v157, v152, v152, v157 op_sel:[0,0,0] op_sel_hi:[1,1,0]
v_fma_mix_f32 v157, v152, v152, v157 op_sel:[1,1,0] op_sel_hi:[1,1,0]
v_fma_mix_f32 v157, v144, v144, v157 op_sel:[0,0,0] op_sel_hi:[1,1,0]
v_fma_mix_f32 v157, v149, v149, v157 op_sel:[0,0,0] op_sel_hi:[1,1,0]
s_waitcnt lgkmcnt(3)
v_fma_mix_f32 v157, v145, v145, v157 op_sel:[1,1,0] op_sel_hi:[1,1,0]
v_fma_mix_f32 v157, v149, v149, v157 op_sel:[1,1,0] op_sel_hi:[1,1,0]
s_setprio 1
v_mfma_f32_32x32x16_bf16 v[0:15], v[228:231], v[228:231], 0
s_add_u32 s46, s80, 6291456
buffer_store_dwordx4 v[60:63], v241, s[32:35], s46 offen sc1
ds_read_b128 v[224:227], v248 offset:38912
v_cvt_pkrtz_f16_f32 v137, v120, v121
v_cvt_pkrtz_f16_f32 v139, v122, v123
v_cvt_pkrtz_f16_f32 v141, v124, v125
v_cvt_pkrtz_f16_f32 v143, v126, v127
v_mfma_f32_32x32x16_bf16 v[16:31], v[228:231], v[228:231], 0
v_cvt_pk_f16_f32 v155, v128, v129
v_cvt_pk_f16_f32 v152, v130, v131
v_cvt_pk_f16_f32 v149, v132, v133
v_cvt_pk_f16_f32 v146, v134, v135
v_mfma_f32_32x32x16_bf16 v[32:47], v[228:231], v[228:231], 0
v_pk_fma_f16 v154, v155, v155, s48
v_and_b32_e64 v137, s49, v137
v_pk_fma_f16 v151, v152, v152, s48
v_pk_fma_f16 v148, v149, v149, s48
v_mfma_f32_32x32x16_bf16 v[120:135], v[72:75], v[232:235], 0
ds_read_b128 v[228:231], v248 offset:36864
v_and_b32_e64 v139, s49, v139
v_pk_fma_f16 v145, v146, v146, s48
v_pk_mul_f16 v154, v155, v154
v_bfe_u32 v136, v137, 2, 14
v_pk_mul_f16 v151, v152, v151
v_pk_mul_f16 v148, v149, v148
v_bfe_u32 v138, v139, 2, 14
v_pk_mul_f16 v145, v146, v145
v_mfma_f32_32x32x16_bf16 v[120:135], v[76:79], v[236:239], v[120:135]
ds_read_b128 v[232:235], v245 offset:384
ds_read_b128 v[200:203], v242 offset:128
ds_read_b128 v[204:207], v243
ds_read_u16_d16 v136, v136
ds_read_u16_d16 v138, v138
v_exp_f16 v153, v154
v_lshrrev_b32 v137, 18, v137
v_exp_f16 v150, v151
v_lshrrev_b32 v139, 18, v139
v_exp_f16_e64 v147, v148
v_mfma_f32_32x32x16_bf16 v[120:135], v[80:83], v[216:219], v[120:135]
ds_read_b128 v[236:239], v248 offset:39936
ds_read_u16_d16_hi v137, v137
ds_read_u16_d16_hi v139, v139
v_and_b32 v141, s49, v141
v_exp_f16 v144, v145
v_and_b32 v143, s49, v143
v_exp_f16_sdwa v153, v154 dst_sel:WORD_1 dst_unused:UNUSED_PRESERVE src0_sel:WORD_1
v_bfe_u32 v140, v141, 2, 14
s_waitcnt lgkmcnt(8)
v_smfmac_f32_16x16x32_bf16 v[0:3], v[220:221], v[192:195], v246
ds_read_b128 v[216:219], v245 offset:768
ds_read_b128 v[208:211], v243 offset:64
ds_read_b128 v[212:215], v243 offset:128
ds_read_u16_d16 v140, v140
v_exp_f16_sdwa v150, v151 dst_sel:WORD_1 dst_unused:UNUSED_PRESERVE src0_sel:WORD_1
v_bfe_u32 v142, v143, 2, 14
v_exp_f16_sdwa v147, v148 dst_sel:WORD_1 dst_unused:UNUSED_PRESERVE src0_sel:WORD_1
v_smfmac_f32_16x16x32_bf16 v[16:19], v[222:223], v[196:199], v246
v_lshrrev_b32_e64 v141, 18, v141
v_exp_f16_sdwa v144, v145 dst_sel:WORD_1 dst_unused:UNUSED_PRESERVE src0_sel:WORD_1
v_lshrrev_b32_e64 v143, 18, v143
v_mfma_f32_32x32x16_bf16 v[120:135], v[84:87], v[224:227], v[120:135]
ds_read_b128 v[220:223], v245 offset:1152
ds_read_b128 v[192:195], v244
ds_read_b128 v[196:199], v244 offset:64
ds_read_u16_d16 v142, v142
ds_read_u16_d16_hi v141, v141
ds_read_u16_d16_hi v143, v143
v_pk_add_f16 v153, v153, 1.0 op_sel_hi:[1,0]
v_pk_add_f16 v150, v150, 1.0 op_sel_hi:[1,0]
v_pk_add_f16 v147, v147, 1.0 op_sel_hi:[1,0]
v_pk_add_f16 v144, v144, 1.0 op_sel_hi:[1,0]
v_rcp_f16 v154, v153
v_rcp_f16 v151, v150
v_mfma_f32_32x32x16_bf16 v[120:135], v[88:91], v[228:231], v[120:135]
ds_read_b128 v[224:227], v248 offset:40960
v_rcp_f16 v148, v147
v_rcp_f16 v145, v144
v_rcp_f16_sdwa v154, v153 dst_sel:WORD_1 dst_unused:UNUSED_PRESERVE src0_sel:WORD_1
v_rcp_f16_sdwa v151, v150 dst_sel:WORD_1 dst_unused:UNUSED_PRESERVE src0_sel:WORD_1
s_setprio 0
s_waitcnt lgkmcnt(7)
v_smfmac_f32_16x16x32_bf16 v[32:35], v[232:233], v[200:203], v246
ds_read_b128 v[228:231], v248 offset:44032
v_rcp_f16_sdwa v148, v147 dst_sel:WORD_1 dst_unused:UNUSED_PRESERVE src0_sel:WORD_1
v_fma_mix_f32 v158, v136, v136, v158 op_sel:[0,0,0] op_sel_hi:[1,1,0]
v_smfmac_f32_16x16x32_bf16 v[0:3], v[234:235], v[204:207], v246
v_rcp_f16_sdwa v145, v144 dst_sel:WORD_1 dst_unused:UNUSED_PRESERVE src0_sel:WORD_1
v_fma_mix_f32 v158, v137, v137, v158 op_sel:[1,1,0] op_sel_hi:[1,1,0]
v_pk_mul_f16 v155, v155, v154
v_fma_mix_f32 v158, v138, v138, v158 op_sel:[0,0,0] op_sel_hi:[1,1,0]
v_mfma_f32_32x32x16_bf16 v[120:135], v[92:95], v[236:239], v[120:135]
ds_read_b128 v[232:235], v248 offset:41984
v_pk_mul_f16 v152, v152, v151
v_pk_mul_f16 v149, v149, v148
v_fma_mix_f32 v158, v139, v139, v158 op_sel:[1,1,0] op_sel_hi:[1,1,0]
v_pk_mul_f16 v146, v146, v145
v_fma_mix_f32 v158, v155, v155, v158 op_sel:[0,0,0] op_sel_hi:[1,1,0]
v_fma_mix_f32 v158, v140, v140, v158 op_sel:[0,0,0] op_sel_hi:[1,1,0]
v_fma_mix_f32 v158, v155, v155, v158 op_sel:[1,1,0] op_sel_hi:[1,1,0]
v_fma_mix_f32 v158, v152, v152, v158 op_sel:[0,0,0] op_sel_hi:[1,1,0]
v_smfmac_f32_16x16x32_bf16 v[16:19], v[216:217], v[208:211], v246
ds_read_b128 v[236:239], v248 offset:45056
s_waitcnt lgkmcnt(3)
v_fma_mix_f32 v158, v141, v141, v158 op_sel:[1,1,0] op_sel_hi:[1,1,0]
v_fma_mix_f32 v158, v152, v152, v158 op_sel:[1,1,0] op_sel_hi:[1,1,0]
v_fma_mix_f32 v158, v149, v149, v158 op_sel:[0,0,0] op_sel_hi:[1,1,0]
v_fma_mix_f32 v158, v142, v142, v158 op_sel:[0,0,0] op_sel_hi:[1,1,0]
v_smfmac_f32_16x16x32_bf16 v[32:35], v[218:219], v[212:215], v246
v_fma_mix_f32 v158, v149, v149, v158 op_sel:[1,1,0] op_sel_hi:[1,1,0]
v_fma_mix_f32 v158, v146, v146, v158 op_sel:[0,0,0] op_sel_hi:[1,1,0]
v_fma_mix_f32 v158, v143, v143, v158 op_sel:[1,1,0] op_sel_hi:[1,1,0]
v_fma_mix_f32 v158, v146, v146, v158 op_sel:[1,1,0] op_sel_hi:[1,1,0]
s_setprio 2
v_smfmac_f32_16x16x32_bf16 v[0:3], v[220:221], v[192:195], v246
s_add_u32 s46, s80, 8388608
buffer_store_dwordx4 v[64:67], v241, s[32:35], s46 offen sc1
ds_read_b128 v[216:219], v248 offset:43008
v_cvt_pkrtz_f16_f32 v137, v120, v121
v_cvt_pkrtz_f16_f32 v139, v122, v123
v_cvt_pkrtz_f16_f32 v141, v124, v125
v_cvt_pkrtz_f16_f32 v143, v126, v127
v_smfmac_f32_16x16x32_bf16 v[16:19], v[222:223], v[196:199], v246
v_cvt_pkrtz_f16_f32 v145, v128, v129
v_cvt_pk_f16_f32 v155, v130, v131
v_cvt_pk_f16_f32 v152, v132, v133
v_cvt_pk_f16_f32 v149, v134, v135
v_mfma_f32_32x32x16_bf16 v[120:135], v[72:75], v[224:227], 0
ds_read_b128 v[220:223], v245 offset:1536
ds_read_b128 v[200:203], v244 offset:128
v_xor_b32 v242, 16, v242
ds_read_b128 v[204:207], v242
v_pk_fma_f16 v154, v155, v155, s48
v_and_b32 v137, s49, v137
v_pk_fma_f16 v151, v152, v152, s48
v_and_b32 v139, s49, v139
v_pk_fma_f16 v148, v149, v149, s48
v_pk_mul_f16 v154, v155, v154
v_bfe_u32 v136, v137, 2, 14
v_pk_mul_f16 v151, v152, v151
s_waitcnt lgkmcnt(4)
v_mfma_f32_32x32x16_bf16 v[120:135], v[76:79], v[228:231], v[120:135]
ds_read_b128 v[224:227], v248 offset:46080
ds_read_u16_d16 v136, v136
v_pk_mul_f16 v148, v149, v148
v_bfe_u32 v138, v139, 2, 14
v_exp_f16 v153, v154
v_lshrrev_b32 v137, 18, v137
v_exp_f16 v150, v151
v_lshrrev_b32 v139, 18, v139
v_mfma_f32_32x32x16_bf16 v[120:135], v[80:83], v[232:235], v[120:135]
ds_read_b128 v[228:231], v245 offset:1920
ds_read_b128 v[208:211], v242 offset:64
ds_read_b128 v[212:215], v242 offset:128
ds_read_u16_d16 v138, v138
ds_read_u16_d16_hi v137, v137
ds_read_u16_d16_hi v139, v139
v_exp_f16 v147, v148
v_and_b32 v141, s49, v141
v_and_b32 v143, s49, v143
v_exp_f16_sdwa v153, v154 dst_sel:WORD_1 dst_unused:UNUSED_PRESERVE src0_sel:WORD_1
v_bfe_u32 v140, v141, 2, 14
v_exp_f16_sdwa v150, v151 dst_sel:WORD_1 dst_unused:UNUSED_PRESERVE src0_sel:WORD_1
v_mfma_f32_32x32x16_bf16 v[120:135], v[84:87], v[236:239], v[120:135]
ds_read_b128 v[232:235], v245 offset:2304
v_xor_b32 v243, 16, v243
ds_read_b128 v[192:195], v243
ds_read_b128 v[196:199], v243 offset:64
ds_read_u16_d16 v140, v140
v_bfe_u32 v142, v143, 2, 14
v_exp_f16_sdwa v147, v148 dst_sel:WORD_1 dst_unused:UNUSED_PRESERVE src0_sel:WORD_1
v_lshrrev_b32_e64 v141, 18, v141
v_pk_add_f16 v153, v153, 1.0 op_sel_hi:[1,0]
v_lshrrev_b32 v143, 18, v143
v_pk_add_f16 v150, v150, 1.0 op_sel_hi:[1,0]
v_pk_add_f16 v147, v147, 1.0 op_sel_hi:[1,0]
s_waitcnt lgkmcnt(9)
v_mfma_f32_32x32x16_bf16 v[120:135], v[88:91], v[216:219], v[120:135]
ds_read_b128 v[236:239], v248 offset:47104
ds_read_u16_d16 v142, v142
ds_read_u16_d16_hi v141, v141
ds_read_u16_d16_hi v143, v143
v_and_b32 v145, s49, v145
v_rcp_f16 v154, v153
v_bfe_u32 v144, v145, 2, 14
v_rcp_f16 v151, v150
v_lshrrev_b32 v145, 18, v145
v_rcp_f16_e64 v148, v147
v_smfmac_f32_16x16x32_bf16 v[32:35], v[220:221], v[200:203], v246
ds_read_b128 v[216:219], v248 offset:50176
ds_read_u16_d16 v144, v144
ds_read_u16_d16_hi v145, v145
v_rcp_f16_sdwa v154, v153 dst_sel:WORD_1 dst_unused:UNUSED_PRESERVE src0_sel:WORD_1
v_fma_mix_f32 v159, v136, v136, v159 op_sel:[0,0,0] op_sel_hi:[1,1,0]
s_waitcnt lgkmcnt(7)
v_fma_mix_f32 v159, v137, v137, v159 op_sel:[1,1,0] op_sel_hi:[1,1,0]
v_smfmac_f32_16x16x32_bf16 v[4:7], v[222:223], v[204:207], v246
v_rcp_f16_sdwa v151, v150 dst_sel:WORD_1 dst_unused:UNUSED_PRESERVE src0_sel:WORD_1
v_fma_mix_f32 v159, v138, v138, v159 op_sel:[0,0,0] op_sel_hi:[1,1,0]
v_mfma_f32_32x32x16_bf16 v[120:135], v[92:95], v[224:227], v[120:135]
ds_read_b128 v[220:223], v248 offset:48128
v_rcp_f16_sdwa v148, v147 dst_sel:WORD_1 dst_unused:UNUSED_PRESERVE src0_sel:WORD_1
v_fma_mix_f32 v159, v139, v139, v159 op_sel:[1,1,0] op_sel_hi:[1,1,0]
v_pk_mul_f16 v155, v155, v154
v_fma_mix_f32 v159, v140, v140, v159 op_sel:[0,0,0] op_sel_hi:[1,1,0]
v_pk_mul_f16 v152, v152, v151
s_waitcnt lgkmcnt(4)
v_fma_mix_f32 v159, v141, v141, v159 op_sel:[1,1,0] op_sel_hi:[1,1,0]
v_pk_mul_f16 v149, v149, v148
v_fma_mix_f32 v159, v155, v155, v159 op_sel:[0,0,0] op_sel_hi:[1,1,0]
v_smfmac_f32_16x16x32_bf16 v[20:23], v[228:229], v[208:211], v246
ds_read_b128 v[224:227], v248 offset:51200
v_fma_mix_f32 v159, v142, v142, v159 op_sel:[0,0,0] op_sel_hi:[1,1,0]
v_fma_mix_f32 v159, v155, v155, v159 op_sel:[1,1,0] op_sel_hi:[1,1,0]
v_fma_mix_f32 v159, v143, v143, v159 op_sel:[1,1,0] op_sel_hi:[1,1,0]
v_fma_mix_f32 v159, v152, v152, v159 op_sel:[0,0,0] op_sel_hi:[1,1,0]
v_smfmac_f32_16x16x32_bf16 v[36:39], v[230:231], v[212:215], v246
v_fma_mix_f32 v159, v152, v152, v159 op_sel:[1,1,0] op_sel_hi:[1,1,0]
s_waitcnt lgkmcnt(2)
v_fma_mix_f32 v159, v144, v144, v159 op_sel:[0,0,0] op_sel_hi:[1,1,0]
v_fma_mix_f32 v159, v149, v149, v159 op_sel:[0,0,0] op_sel_hi:[1,1,0]
v_fma_mix_f32 v159, v145, v145, v159 op_sel:[1,1,0] op_sel_hi:[1,1,0]
v_fma_mix_f32 v159, v149, v149, v159 op_sel:[1,1,0] op_sel_hi:[1,1,0]
s_setprio 1
v_smfmac_f32_16x16x32_bf16 v[4:7], v[232:233], v[192:195], v246
s_add_u32 s46, s80, 10485760
buffer_store_dwordx4 v[68:71], v241, s[32:35], s46 offen sc1
ds_read_b128 v[228:231], v248 offset:49152
v_cvt_pkrtz_f16_f32 v137, v120, v121
v_cvt_pkrtz_f16_f32 v139, v122, v123
v_cvt_pkrtz_f16_f32 v141, v124, v125
v_cvt_pkrtz_f16_f32 v143, v126, v127
v_cvt_pk_f16_f32 v155, v128, v129
v_smfmac_f32_16x16x32_bf16 v[20:23], v[234:235], v[196:199], v246
v_cvt_pk_f16_f32 v152, v130, v131
v_cvt_pk_f16_f32 v149, v132, v133
v_cvt_pk_f16_f32 v146, v134, v135
v_pk_fma_f16 v154, v155, v155, s48
v_and_b32_e64 v137, s49, v137
v_mfma_f32_32x32x16_bf16 v[120:135], v[72:75], v[236:239], 0
ds_read_b128 v[232:235], v248 offset:52224
v_pk_fma_f16 v151, v152, v152, s48
v_pk_fma_f16 v148, v149, v149, s48
v_and_b32_e64 v139, s49, v139
v_pk_fma_f16 v145, v146, v146, s48
v_pk_mul_f16 v154, v155, v154
v_bfe_u32 v136, v137, 2, 14
v_pk_mul_f16 v151, v152, v151
v_pk_mul_f16 v148, v149, v148
v_bfe_u32 v138, v139, 2, 14
v_pk_mul_f16 v145, v146, v145
v_mfma_f32_32x32x16_bf16 v[120:135], v[76:79], v[216:219], v[120:135]
ds_read_b128 v[236:239], v245 offset:2688
ds_read_b128 v[200:203], v243 offset:128
v_xor_b32 v244, 16, v244
ds_read_b128 v[204:207], v244
ds_read_u16_d16 v136, v136
ds_read_u16_d16 v138, v138
v_exp_f16 v153, v154
v_lshrrev_b32 v137, 18, v137
v_exp_f16 v150, v151
v_lshrrev_b32 v139, 18, v139
v_exp_f16 v147, v148
v_and_b32_e64 v141, s49, v141
v_exp_f16 v144, v145
s_waitcnt lgkmcnt(5)
v_mfma_f32_32x32x16_bf16 v[120:135], v[80:83], v[220:223], v[120:135]
ds_read_b128 v[216:219], v245 offset:3072
ds_read_b128 v[208:211], v244 offset:64
ds_read_b128 v[212:215], v244 offset:128
ds_read_u16_d16_hi v137, v137
ds_read_u16_d16_hi v139, v139
v_and_b32_e64 v143, s49, v143
v_exp_f16_sdwa v153, v154 dst_sel:WORD_1 dst_unused:UNUSED_PRESERVE src0_sel:WORD_1
v_bfe_u32 v140, v141, 2, 14
v_exp_f16_sdwa v150, v151 dst_sel:WORD_1 dst_unused:UNUSED_PRESERVE src0_sel:WORD_1
v_bfe_u32 v142, v143, 2, 14
v_exp_f16_sdwa v147, v148 dst_sel:WORD_1 dst_unused:UNUSED_PRESERVE src0_sel:WORD_1
v_lshrrev_b32_e64 v141, 18, v141
v_mfma_f32_32x32x16_bf16 v[120:135], v[84:87], v[224:227], v[120:135]
ds_read_b128 v[220:223], v248 offset:53248
ds_read_u16_d16 v140, v140
ds_read_u16_d16 v142, v142
ds_read_u16_d16_hi v141, v141
v_exp_f16_sdwa v144, v145 dst_sel:WORD_1 dst_unused:UNUSED_PRESERVE src0_sel:WORD_1
v_lshrrev_b32_e64 v143, 18, v143
v_pk_add_f16 v153, v153, 1.0 op_sel_hi:[1,0]
v_pk_add_f16 v150, v150, 1.0 op_sel_hi:[1,0]
v_pk_add_f16 v147, v147, 1.0 op_sel_hi:[1,0]
v_pk_add_f16 v144, v144, 1.0 op_sel_hi:[1,0]
v_rcp_f16 v154, v153
v_rcp_f16 v151, v150
v_mfma_f32_32x32x16_bf16 v[120:135], v[88:91], v[228:231], v[120:135]
ds_read_b128 v[224:227], v248 offset:56320
ds_read_u16_d16_hi v143, v143
v_rcp_f16 v148, v147
v_rcp_f16 v145, v144
v_rcp_f16_sdwa v154, v153 dst_sel:WORD_1 dst_unused:UNUSED_PRESERVE src0_sel:WORD_1
v_rcp_f16_sdwa v151, v150 dst_sel:WORD_1 dst_unused:UNUSED_PRESERVE src0_sel:WORD_1
s_setprio 0
v_rcp_f16_sdwa v148, v147 dst_sel:WORD_1 dst_unused:UNUSED_PRESERVE src0_sel:WORD_1
s_waitcnt lgkmcnt(6)
v_fma_mix_f32 v160, v136, v136, v160 op_sel:[0,0,0] op_sel_hi:[1,1,0]
v_mfma_f32_32x32x16_bf16 v[120:135], v[92:95], v[232:235], v[120:135]
ds_read_b128 v[228:231], v248 offset:54272
v_rcp_f16_sdwa v145, v144 dst_sel:WORD_1 dst_unused:UNUSED_PRESERVE src0_sel:WORD_1
v_fma_mix_f32 v160, v137, v137, v160 op_sel:[1,1,0] op_sel_hi:[1,1,0]
v_pk_mul_f16 v155, v155, v154
v_fma_mix_f32 v160, v138, v138, v160 op_sel:[0,0,0] op_sel_hi:[1,1,0]
v_pk_mul_f16 v152, v152, v151
v_pk_mul_f16 v149, v149, v148
v_fma_mix_f32 v160, v139, v139, v160 op_sel:[1,1,0] op_sel_hi:[1,1,0]
v_pk_mul_f16 v146, v146, v145
v_fma_mix_f32 v160, v155, v155, v160 op_sel:[0,0,0] op_sel_hi:[1,1,0]
v_smfmac_f32_16x16x32_bf16 v[36:39], v[236:237], v[200:203], v246
ds_read_b128 v[232:235], v248 offset:57344
s_waitcnt lgkmcnt(4)
v_fma_mix_f32 v160, v140, v140, v160 op_sel:[0,0,0] op_sel_hi:[1,1,0]
v_fma_mix_f32 v160, v155, v155, v160 op_sel:[1,1,0] op_sel_hi:[1,1,0]
v_fma_mix_f32 v160, v152, v152, v160 op_sel:[0,0,0] op_sel_hi:[1,1,0]
v_fma_mix_f32 v160, v141, v141, v160 op_sel:[1,1,0] op_sel_hi:[1,1,0]
v_fma_mix_f32 v160, v152, v152, v160 op_sel:[1,1,0] op_sel_hi:[1,1,0]
v_smfmac_f32_16x16x32_bf16 v[4:7], v[238:239], v[204:207], v246
v_fma_mix_f32 v160, v149, v149, v160 op_sel:[0,0,0] op_sel_hi:[1,1,0]
v_fma_mix_f32 v160, v142, v142, v160 op_sel:[0,0,0] op_sel_hi:[1,1,0]
v_fma_mix_f32 v160, v149, v149, v160 op_sel:[1,1,0] op_sel_hi:[1,1,0]
v_fma_mix_f32 v160, v146, v146, v160 op_sel:[0,0,0] op_sel_hi:[1,1,0]
s_waitcnt lgkmcnt(2)
v_fma_mix_f32 v160, v143, v143, v160 op_sel:[1,1,0] op_sel_hi:[1,1,0]
v_fma_mix_f32 v160, v146, v146, v160 op_sel:[1,1,0] op_sel_hi:[1,1,0]
s_cmp_lg_u32 s40, 7
s_cbranch_scc1 Lnobias2
s_sub_u32 s43, s2, 96
s_cmp_lt_u32 s43, 96
s_cbranch_scc0 Lnobias2
s_waitcnt vmcnt(17)
v_lshlrev_b32 v178, 16, v178
v_lshlrev_b32 v179, 16, v179
v_lshlrev_b32 v180, 16, v180
v_lshlrev_b32 v181, 16, v181
v_lshlrev_b32 v182, 16, v182
v_lshlrev_b32 v183, 16, v183
v_lshlrev_b32 v184, 16, v184
v_lshlrev_b32 v185, 16, v185
v_lshlrev_b32 v186, 16, v186
v_lshlrev_b32 v187, 16, v187
v_lshlrev_b32 v188, 16, v188
v_lshlrev_b32 v189, 16, v189
v_mul_f32 v176, v178, v184
v_fmac_f32 v176, v179, v185
v_fmac_f32 v176, v180, v186
v_fmac_f32 v176, v181, v187
v_fmac_f32 v176, v182, v188
v_fmac_f32 v176, v183, v189
s_nop 1
v_add_f32_dpp v176, v176, v176 row_ror:8 row_mask:0xf bank_mask:0xf
s_nop 1
v_add_f32_dpp v176, v176, v176 row_ror:4 row_mask:0xf bank_mask:0xf
s_nop 1
v_add_f32_dpp v176, v176, v176 row_ror:2 row_mask:0xf bank_mask:0xf
s_nop 1
v_add_f32_dpp v176, v176, v176 row_ror:1 row_mask:0xf bank_mask:0xf
v_mov_b32 v177, v176
s_nop 1
v_permlane16_swap_b32 v176, v177
v_add_f32 v176, v176, v177
v_mov_b32_e64 v177, v176
s_nop 1
v_permlane32_swap_b32 v176, v177
v_add_f32 v176, v176, v177
s_lshl_b32 s44, s43, 2
s_add_u32 s44, s44, 394752
v_lshlrev_b32_e64 v191, 11, v251
s_mov_b64 exec, 0xff
buffer_store_dword v176, v191, s[32:35], s44 offen sc1
s_mov_b64 exec, -1
Lnobias2:
s_setprio 2
v_smfmac_f32_16x16x32_bf16 v[20:23], v[216:217], v[208:211], v246
ds_read_b128 v[236:239], v248 offset:55296
v_cvt_pkrtz_f16_f32 v137, v120, v121
v_cvt_pkrtz_f16_f32 v139, v122, v123
v_cvt_pkrtz_f16_f32 v141, v124, v125
v_cvt_pkrtz_f16_f32 v143, v126, v127
v_smfmac_f32_16x16x32_bf16 v[36:39], v[218:219], v[212:215], v246
v_cvt_pkrtz_f16_f32 v145, v128, v129
v_cvt_pk_f16_f32 v155, v130, v131
v_cvt_pk_f16_f32 v152, v132, v133
v_cvt_pk_f16_f32 v149, v134, v135
v_mfma_f32_32x32x16_bf16 v[120:135], v[72:75], v[220:223], 0
ds_read_b128 v[216:219], v245 offset:3456
v_xor_b32 v242, 32, v242
ds_read_b128 v[192:195], v242
ds_read_b128 v[196:199], v242 offset:64
v_pk_fma_f16 v154, v155, v155, s48
v_and_b32 v137, s49, v137
v_pk_fma_f16 v151, v152, v152, s48
v_and_b32_e64 v139, s49, v139
v_pk_fma_f16 v148, v149, v149, s48
v_pk_mul_f16 v154, v155, v154
v_bfe_u32 v136, v137, 2, 14
v_pk_mul_f16 v151, v152, v151
v_mfma_f32_32x32x16_bf16 v[120:135], v[76:79], v[224:227], v[120:135]
ds_read_b128 v[220:223], v248 offset:58368
ds_read_u16_d16 v136, v136
v_pk_mul_f16 v148, v149, v148
v_bfe_u32 v138, v139, 2, 14
v_exp_f16 v153, v154
v_lshrrev_b32 v137, 18, v137
v_exp_f16 v150, v151
v_lshrrev_b32 v139, 18, v139
s_waitcnt lgkmcnt(5)
v_mfma_f32_32x32x16_bf16 v[120:135], v[80:83], v[228:231], v[120:135]
ds_read_b128 v[224:227], v245 offset:3840
ds_read_b128 v[200:203], v242 offset:128
v_xor_b32 v243, 32, v243
ds_read_b128 v[204:207], v243
ds_read_u16_d16 v138, v138
ds_read_u16_d16_hi v137, v137
ds_read_u16_d16_hi v139, v139
v_exp_f16 v147, v148
v_and_b32 v141, s49, v141
v_and_b32_e64 v143, s49, v143
v_exp_f16_sdwa v153, v154 dst_sel:WORD_1 dst_unused:UNUSED_PRESERVE src0_sel:WORD_1
v_bfe_u32 v140, v141, 2, 14
v_exp_f16_sdwa v150, v151 dst_sel:WORD_1 dst_unused:UNUSED_PRESERVE src0_sel:WORD_1
v_mfma_f32_32x32x16_bf16 v[120:135], v[84:87], v[232:235], v[120:135]
ds_read_b128 v[228:231], v245 offset:4224
ds_read_b128 v[208:211], v243 offset:64
ds_read_b128 v[212:215], v243 offset:128
ds_read_u16_d16 v140, v140
v_bfe_u32 v142, v143, 2, 14
v_exp_f16_sdwa v147, v148 dst_sel:WORD_1 dst_unused:UNUSED_PRESERVE src0_sel:WORD_1
v_lshrrev_b32_e64 v141, 18, v141
v_pk_add_f16 v153, v153, 1.0 op_sel_hi:[1,0]
v_lshrrev_b32_e64 v143, 18, v143
v_pk_add_f16 v150, v150, 1.0 op_sel_hi:[1,0]
v_pk_add_f16 v147, v147, 1.0 op_sel_hi:[1,0]
v_mfma_f32_32x32x16_bf16 v[120:135], v[88:91], v[236:239], v[120:135]
ds_read_b128 v[232:235], v248 offset:59392
ds_read_u16_d16 v142, v142
ds_read_u16_d16_hi v141, v141
ds_read_u16_d16_hi v143, v143
v_and_b32 v145, s49, v145
v_rcp_f16 v154, v153
v_bfe_u32 v144, v145, 2, 14
v_rcp_f16 v151, v150
v_lshrrev_b32 v145, 18, v145
v_rcp_f16 v148, v147
s_waitcnt lgkmcnt(8)
v_smfmac_f32_16x16x32_bf16 v[12:15], v[216:217], v[192:195], v246
ds_read_b128 v[236:239], v248 offset:62464
ds_read_u16_d16 v144, v144
ds_read_u16_d16_hi v145, v145
v_rcp_f16_sdwa v154, v153 dst_sel:WORD_1 dst_unused:UNUSED_PRESERVE src0_sel:WORD_1
v_fma_mix_f32 v161, v136, v136, v161 op_sel:[0,0,0] op_sel_hi:[1,1,0]
v_fma_mix_f32 v161, v137, v137, v161 op_sel:[1,1,0] op_sel_hi:[1,1,0]
v_smfmac_f32_16x16x32_bf16 v[28:31], v[218:219], v[196:199], v246
v_rcp_f16_sdwa v151, v150 dst_sel:WORD_1 dst_unused:UNUSED_PRESERVE src0_sel:WORD_1
v_fma_mix_f32 v161, v138, v138, v161 op_sel:[0,0,0] op_sel_hi:[1,1,0]
v_mfma_f32_32x32x16_bf16 v[120:135], v[92:95], v[220:223], v[120:135]
ds_read_b128 v[216:219], v248 offset:60416
v_rcp_f16_sdwa v148, v147 dst_sel:WORD_1 dst_unused:UNUSED_PRESERVE src0_sel:WORD_1
v_fma_mix_f32 v161, v139, v139, v161 op_sel:[1,1,0] op_sel_hi:[1,1,0]
v_pk_mul_f16 v155, v155, v154
s_waitcnt lgkmcnt(6)
v_fma_mix_f32 v161, v140, v140, v161 op_sel:[0,0,0] op_sel_hi:[1,1,0]
v_pk_mul_f16 v152, v152, v151
s_waitcnt lgkmcnt(4)
v_fma_mix_f32 v161, v141, v141, v161 op_sel:[1,1,0] op_sel_hi:[1,1,0]
v_pk_mul_f16 v149, v149, v148
v_fma_mix_f32 v161, v155, v155, v161 op_sel:[0,0,0] op_sel_hi:[1,1,0]
v_smfmac_f32_16x16x32_bf16 v[44:47], v[224:225], v[200:203], v246
ds_read_b128 v[220:223], v248 offset:63488
v_fma_mix_f32 v161, v142, v142, v161 op_sel:[0,0,0] op_sel_hi:[1,1,0]
v_fma_mix_f32 v161, v155, v155, v161 op_sel:[1,1,0] op_sel_hi:[1,1,0]
v_fma_mix_f32 v161, v143, v143, v161 op_sel:[1,1,0] op_sel_hi:[1,1,0]
v_fma_mix_f32 v161, v152, v152, v161 op_sel:[0,0,0] op_sel_hi:[1,1,0]
v_smfmac_f32_16x16x32_bf16 v[12:15], v[226:227], v[204:207], v246
v_fma_mix_f32 v161, v152, v152, v161 op_sel:[1,1,0] op_sel_hi:[1,1,0]
s_waitcnt lgkmcnt(2)
v_fma_mix_f32 v161, v144, v144, v161 op_sel:[0,0,0] op_sel_hi:[1,1,0]
v_fma_mix_f32 v161, v149, v149, v161 op_sel:[0,0,0] op_sel_hi:[1,1,0]
v_fma_mix_f32 v161, v145, v145, v161 op_sel:[1,1,0] op_sel_hi:[1,1,0]
v_fma_mix_f32 v161, v149, v149, v161 op_sel:[1,1,0] op_sel_hi:[1,1,0]
v_lshlrev_b32 v252, 7, v251
s_add_u32 s46, s47, 2359296
s_mov_b32 exec_lo, 131071
s_mov_b32 exec_hi, 0
s_mov_b32 m0, 16288
s_nop 0
buffer_load_dword v252, s[4:7], s46 offen lds
s_mov_b64 exec, -1
s_setprio 1
v_smfmac_f32_16x16x32_bf16 v[28:31], v[228:229], v[208:211], v246
ds_read_b128 v[224:227], v248 offset:61440
v_cvt_pkrtz_f16_f32 v137, v120, v121
v_cvt_pkrtz_f16_f32 v139, v122, v123
v_cvt_pkrtz_f16_f32 v141, v124, v125
v_cvt_pkrtz_f16_f32 v143, v126, v127
v_cvt_pk_f16_f32 v155, v128, v129
v_smfmac_f32_16x16x32_bf16 v[44:47], v[230:231], v[212:215], v246
v_cvt_pk_f16_f32 v152, v130, v131
v_cvt_pk_f16_f32 v149, v132, v133
v_cvt_pk_f16_f32 v146, v134, v135
v_pk_fma_f16 v154, v155, v155, s48
v_and_b32_e64 v137, s49, v137
v_mfma_f32_32x32x16_bf16 v[120:135], v[72:75], v[232:235], 0
ds_read_b128 v[228:231], v248 offset:64512
v_pk_fma_f16 v151, v152, v152, s48
v_pk_fma_f16 v148, v149, v149, s48
v_and_b32_e64 v139, s49, v139
v_pk_fma_f16 v145, v146, v146, s48
v_pk_mul_f16 v154, v155, v154
v_bfe_u32 v136, v137, 2, 14
v_pk_mul_f16 v151, v152, v151
v_pk_mul_f16 v148, v149, v148
v_bfe_u32 v138, v139, 2, 14
v_pk_mul_f16 v145, v146, v145
v_mfma_f32_32x32x16_bf16 v[120:135], v[76:79], v[236:239], v[120:135]
ds_read_b128 v[232:235], v245 offset:4608
v_xor_b32 v244, 32, v244
ds_read_b128 v[192:195], v244
ds_read_b128 v[196:199], v244 offset:64
ds_read_u16_d16 v136, v136
ds_read_u16_d16 v138, v138
v_exp_f16 v153, v154
v_lshrrev_b32 v137, 18, v137
v_exp_f16 v150, v151
v_lshrrev_b32 v139, 18, v139
v_exp_f16 v147, v148
v_and_b32 v141, s49, v141
v_exp_f16 v144, v145
s_waitcnt lgkmcnt(5)
v_mfma_f32_32x32x16_bf16 v[120:135], v[80:83], v[216:219], v[120:135]
ds_read_b128 v[236:239], v245 offset:4992
ds_read_b128 v[200:203], v244 offset:128
v_xor_b32 v242, 16, v242
ds_read_b128 v[204:207], v242
ds_read_u16_d16_hi v137, v137
ds_read_u16_d16_hi v139, v139
v_and_b32_e64 v143, s49, v143
v_exp_f16_sdwa v153, v154 dst_sel:WORD_1 dst_unused:UNUSED_PRESERVE src0_sel:WORD_1
v_bfe_u32 v140, v141, 2, 14
v_exp_f16_sdwa v150, v151 dst_sel:WORD_1 dst_unused:UNUSED_PRESERVE src0_sel:WORD_1
v_bfe_u32 v142, v143, 2, 14
v_exp_f16_sdwa v147, v148 dst_sel:WORD_1 dst_unused:UNUSED_PRESERVE src0_sel:WORD_1
v_lshrrev_b32_e64 v141, 18, v141
v_mfma_f32_32x32x16_bf16 v[120:135], v[84:87], v[220:223], v[120:135]
ds_read_b128 v[216:219], v249
ds_read_u16_d16 v140, v140
ds_read_u16_d16 v142, v142
ds_read_u16_d16_hi v141, v141
v_exp_f16_sdwa v144, v145 dst_sel:WORD_1 dst_unused:UNUSED_PRESERVE src0_sel:WORD_1
v_lshrrev_b32_e64 v143, 18, v143
v_pk_add_f16 v153, v153, 1.0 op_sel_hi:[1,0]
v_pk_add_f16 v150, v150, 1.0 op_sel_hi:[1,0]
v_pk_add_f16 v147, v147, 1.0 op_sel_hi:[1,0]
v_pk_add_f16 v144, v144, 1.0 op_sel_hi:[1,0]
v_rcp_f16 v154, v153
v_rcp_f16 v151, v150
v_mfma_f32_32x32x16_bf16 v[120:135], v[88:91], v[224:227], v[120:135]
ds_read_b128 v[220:223], v249 offset:3072
ds_read_u16_d16_hi v143, v143
v_rcp_f16 v148, v147
v_rcp_f16 v145, v144
v_rcp_f16_sdwa v154, v153 dst_sel:WORD_1 dst_unused:UNUSED_PRESERVE src0_sel:WORD_1
v_rcp_f16_sdwa v151, v150 dst_sel:WORD_1 dst_unused:UNUSED_PRESERVE src0_sel:WORD_1
s_setprio 0
v_rcp_f16_sdwa v148, v147 dst_sel:WORD_1 dst_unused:UNUSED_PRESERVE src0_sel:WORD_1
s_waitcnt lgkmcnt(6)
v_fma_mix_f32 v162, v136, v136, v162 op_sel:[0,0,0] op_sel_hi:[1,1,0]
v_mfma_f32_32x32x16_bf16 v[120:135], v[92:95], v[228:231], v[120:135]
ds_read_b128 v[224:227], v249 offset:1024
v_rcp_f16_sdwa v145, v144 dst_sel:WORD_1 dst_unused:UNUSED_PRESERVE src0_sel:WORD_1
v_fma_mix_f32 v162, v137, v137, v162 op_sel:[1,1,0] op_sel_hi:[1,1,0]
v_pk_mul_f16 v155, v155, v154
v_fma_mix_f32 v162, v138, v138, v162 op_sel:[0,0,0] op_sel_hi:[1,1,0]
v_pk_mul_f16 v152, v152, v151
v_pk_mul_f16 v149, v149, v148
v_fma_mix_f32 v162, v139, v139, v162 op_sel:[1,1,0] op_sel_hi:[1,1,0]
v_pk_mul_f16 v146, v146, v145
v_fma_mix_f32 v162, v155, v155, v162 op_sel:[0,0,0] op_sel_hi:[1,1,0]
v_smfmac_f32_16x16x32_bf16 v[12:15], v[232:233], v[192:195], v246
ds_read_b128 v[228:231], v249 offset:4096
s_waitcnt lgkmcnt(4)
v_fma_mix_f32 v162, v140, v140, v162 op_sel:[0,0,0] op_sel_hi:[1,1,0]
v_fma_mix_f32 v162, v155, v155, v162 op_sel:[1,1,0] op_sel_hi:[1,1,0]
v_fma_mix_f32 v162, v152, v152, v162 op_sel:[0,0,0] op_sel_hi:[1,1,0]
v_fma_mix_f32 v162, v141, v141, v162 op_sel:[1,1,0] op_sel_hi:[1,1,0]
v_fma_mix_f32 v162, v152, v152, v162 op_sel:[1,1,0] op_sel_hi:[1,1,0]
v_smfmac_f32_16x16x32_bf16 v[28:31], v[234:235], v[196:199], v246
v_fma_mix_f32 v162, v149, v149, v162 op_sel:[0,0,0] op_sel_hi:[1,1,0]
v_fma_mix_f32 v162, v142, v142, v162 op_sel:[0,0,0] op_sel_hi:[1,1,0]
v_fma_mix_f32 v162, v149, v149, v162 op_sel:[1,1,0] op_sel_hi:[1,1,0]
v_fma_mix_f32 v162, v146, v146, v162 op_sel:[0,0,0] op_sel_hi:[1,1,0]
s_waitcnt lgkmcnt(2)
v_fma_mix_f32 v162, v143, v143, v162 op_sel:[1,1,0] op_sel_hi:[1,1,0]
v_fma_mix_f32 v162, v146, v146, v162 op_sel:[1,1,0] op_sel_hi:[1,1,0]
v_lshlrev_b32_e64 v252, 7, v251
s_add_u32 s46, s47, 2359296
s_mov_b32 exec_lo, 4294836224
s_mov_b32 exec_hi, 3
s_mov_b32 m0, 16220
s_nop 0
buffer_load_dword v252, s[4:7], s46 offen lds
s_mov_b64 exec, -1
s_setprio 2
v_smfmac_f32_16x16x32_bf16 v[44:47], v[236:237], v[200:203], v246
ds_read_b128 v[232:235], v249 offset:2048
v_cvt_pkrtz_f16_f32 v137, v120, v121
v_cvt_pkrtz_f16_f32 v139, v122, v123
v_cvt_pkrtz_f16_f32 v141, v124, v125
v_cvt_pkrtz_f16_f32 v143, v126, v127
v_smfmac_f32_16x16x32_bf16 v[8:11], v[238:239], v[204:207], v246
v_cvt_pkrtz_f16_f32 v145, v128, v129
v_cvt_pk_f16_f32 v155, v130, v131
v_cvt_pk_f16_f32 v152, v132, v133
v_cvt_pk_f16_f32 v149, v134, v135
v_mfma_f32_32x32x16_bf16 v[120:135], v[72:75], v[216:219], 0
ds_read_b128 v[236:239], v245 offset:5376
ds_read_b128 v[208:211], v242 offset:64
ds_read_b128 v[212:215], v242 offset:128
v_pk_fma_f16 v154, v155, v155, s48
v_and_b32_e64 v137, s49, v137
v_pk_fma_f16 v151, v152, v152, s48
v_and_b32_e64 v139, s49, v139
v_pk_fma_f16 v148, v149, v149, s48
v_pk_mul_f16 v154, v155, v154
v_bfe_u32 v136, v137, 2, 14
v_pk_mul_f16 v151, v152, v151
v_mfma_f32_32x32x16_bf16 v[120:135], v[76:79], v[220:223], v[120:135]
ds_read_b128 v[216:219], v249 offset:5120
ds_read_u16_d16 v136, v136
v_pk_mul_f16 v148, v149, v148
v_bfe_u32 v138, v139, 2, 14
v_exp_f16 v153, v154
v_lshrrev_b32 v137, 18, v137
v_exp_f16 v150, v151
v_lshrrev_b32 v139, 18, v139
s_waitcnt lgkmcnt(5)
v_mfma_f32_32x32x16_bf16 v[120:135], v[80:83], v[224:227], v[120:135]
ds_read_b128 v[220:223], v245 offset:5760
v_xor_b32 v243, 16, v243
ds_read_b128 v[192:195], v243
ds_read_b128 v[196:199], v243 offset:64
ds_read_u16_d16 v138, v138
ds_read_u16_d16_hi v137, v137
ds_read_u16_d16_hi v139, v139
v_exp_f16 v147, v148
v_and_b32 v141, s49, v141
v_and_b32_e64 v143, s49, v143
v_exp_f16_sdwa v153, v154 dst_sel:WORD_1 dst_unused:UNUSED_PRESERVE src0_sel:WORD_1
v_bfe_u32 v140, v141, 2, 14
v_exp_f16_sdwa v150, v151 dst_sel:WORD_1 dst_unused:UNUSED_PRESERVE src0_sel:WORD_1
v_mfma_f32_32x32x16_bf16 v[120:135], v[84:87], v[228:231], v[120:135]
ds_read_b128 v[224:227], v245 offset:6144
ds_read_b128 v[200:203], v243 offset:128
v_xor_b32 v244, 16, v244
ds_read_b128 v[204:207], v244
ds_read_u16_d16 v140, v140
v_bfe_u32 v142, v143, 2, 14
v_exp_f16_sdwa v147, v148 dst_sel:WORD_1 dst_unused:UNUSED_PRESERVE src0_sel:WORD_1
v_lshrrev_b32 v141, 18, v141
v_pk_add_f16 v153, v153, 1.0 op_sel_hi:[1,0]
v_lshrrev_b32_e64 v143, 18, v143
v_pk_add_f16 v150, v150, 1.0 op_sel_hi:[1,0]
v_pk_add_f16 v147, v147, 1.0 op_sel_hi:[1,0]
v_mfma_f32_32x32x16_bf16 v[120:135], v[88:91], v[232:235], v[120:135]
ds_read_b128 v[228:231], v249 offset:6144
ds_read_u16_d16 v142, v142
ds_read_u16_d16_hi v141, v141
ds_read_u16_d16_hi v143, v143
v_and_b32 v145, s49, v145
v_rcp_f16 v154, v153
v_bfe_u32 v144, v145, 2, 14
v_rcp_f16 v151, v150
v_lshrrev_b32 v145, 18, v145
v_rcp_f16 v148, v147
s_waitcnt lgkmcnt(8)
v_smfmac_f32_16x16x32_bf16 v[24:27], v[236:237], v[208:211], v246
ds_read_b128 v[232:235], v249 offset:9216
ds_read_u16_d16 v144, v144
ds_read_u16_d16_hi v145, v145
v_rcp_f16_sdwa v154, v153 dst_sel:WORD_1 dst_unused:UNUSED_PRESERVE src0_sel:WORD_1
v_fma_mix_f32 v163, v136, v136, v163 op_sel:[0,0,0] op_sel_hi:[1,1,0]
v_fma_mix_f32 v163, v137, v137, v163 op_sel:[1,1,0] op_sel_hi:[1,1,0]
v_smfmac_f32_16x16x32_bf16 v[40:43], v[238:239], v[212:215], v246
v_rcp_f16_sdwa v151, v150 dst_sel:WORD_1 dst_unused:UNUSED_PRESERVE src0_sel:WORD_1
v_fma_mix_f32 v163, v138, v138, v163 op_sel:[0,0,0] op_sel_hi:[1,1,0]
v_mfma_f32_32x32x16_bf16 v[120:135], v[92:95], v[216:219], v[120:135]
ds_read_b128 v[236:239], v249 offset:7168
v_rcp_f16_sdwa v148, v147 dst_sel:WORD_1 dst_unused:UNUSED_PRESERVE src0_sel:WORD_1
v_fma_mix_f32 v163, v139, v139, v163 op_sel:[1,1,0] op_sel_hi:[1,1,0]
v_pk_mul_f16 v155, v155, v154
s_waitcnt lgkmcnt(6)
v_fma_mix_f32 v163, v140, v140, v163 op_sel:[0,0,0] op_sel_hi:[1,1,0]
v_pk_mul_f16 v152, v152, v151
s_waitcnt lgkmcnt(4)
v_fma_mix_f32 v163, v141, v141, v163 op_sel:[1,1,0] op_sel_hi:[1,1,0]
v_pk_mul_f16 v149, v149, v148
v_fma_mix_f32 v163, v155, v155, v163 op_sel:[0,0,0] op_sel_hi:[1,1,0]
v_smfmac_f32_16x16x32_bf16 v[8:11], v[220:221], v[192:195], v246
ds_read_b128 v[216:219], v249 offset:10240
v_fma_mix_f32 v163, v142, v142, v163 op_sel:[0,0,0] op_sel_hi:[1,1,0]
v_fma_mix_f32 v163, v155, v155, v163 op_sel:[1,1,0] op_sel_hi:[1,1,0]
v_fma_mix_f32 v163, v143, v143, v163 op_sel:[1,1,0] op_sel_hi:[1,1,0]
v_fma_mix_f32 v163, v152, v152, v163 op_sel:[0,0,0] op_sel_hi:[1,1,0]
v_smfmac_f32_16x16x32_bf16 v[24:27], v[222:223], v[196:199], v246
v_fma_mix_f32 v163, v152, v152, v163 op_sel:[1,1,0] op_sel_hi:[1,1,0]
s_waitcnt lgkmcnt(2)
v_fma_mix_f32 v163, v144, v144, v163 op_sel:[0,0,0] op_sel_hi:[1,1,0]
v_fma_mix_f32 v163, v149, v149, v163 op_sel:[0,0,0] op_sel_hi:[1,1,0]
v_fma_mix_f32 v163, v145, v145, v163 op_sel:[1,1,0] op_sel_hi:[1,1,0]
v_fma_mix_f32 v163, v149, v149, v163 op_sel:[1,1,0] op_sel_hi:[1,1,0]
v_lshlrev_b32 v252, 7, v251
s_add_u32 s46, s47, 2359296
s_mov_b32 exec_lo, 0
s_mov_b32 exec_hi, 1048572
s_mov_b32 m0, 16152
s_nop 0
buffer_load_dword v252, s[4:7], s46 offen lds
s_mov_b64 exec, -1
s_setprio 1
v_smfmac_f32_16x16x32_bf16 v[40:43], v[224:225], v[200:203], v246
ds_read_b128 v[220:223], v249 offset:8192
v_cvt_pkrtz_f16_f32 v137, v120, v121
v_cvt_pkrtz_f16_f32 v139, v122, v123
v_cvt_pkrtz_f16_f32 v141, v124, v125
v_cvt_pkrtz_f16_f32 v143, v126, v127
v_smfmac_f32_16x16x32_bf16 v[8:11], v[226:227], v[204:207], v246
v_cvt_pk_f16_f32 v155, v128, v129
v_cvt_pk_f16_f32 v152, v130, v131
v_cvt_pk_f16_f32 v149, v132, v133
v_cvt_pk_f16_f32 v146, v134, v135
v_pk_fma_f16 v154, v155, v155, s48
v_mfma_f32_32x32x16_bf16 v[120:135], v[72:75], v[228:231], 0
ds_read_b128 v[224:227], v249 offset:11264
v_and_b32_e64 v137, s49, v137
v_pk_fma_f16 v151, v152, v152, s48
v_pk_fma_f16 v148, v149, v149, s48
v_and_b32_e64 v139, s49, v139
v_pk_fma_f16 v145, v146, v146, s48
v_pk_mul_f16 v154, v155, v154
v_bfe_u32 v136, v137, 2, 14
v_pk_mul_f16 v151, v152, v151
v_pk_mul_f16 v148, v149, v148
v_bfe_u32 v138, v139, 2, 14
v_mfma_f32_32x32x16_bf16 v[120:135], v[76:79], v[232:235], v[120:135]
ds_read_b128 v[228:231], v245 offset:6528
ds_read_b128 v[208:211], v244 offset:64
ds_read_b128 v[212:215], v244 offset:128
ds_read_u16_d16 v136, v136
ds_read_u16_d16 v138, v138
v_pk_mul_f16 v145, v146, v145
v_exp_f16 v153, v154
v_lshrrev_b32 v137, 18, v137
v_exp_f16 v150, v151
v_lshrrev_b32 v139, 18, v139
v_exp_f16 v147, v148
s_waitcnt lgkmcnt(6)
v_mfma_f32_32x32x16_bf16 v[120:135], v[80:83], v[236:239], v[120:135]
ds_read_b128 v[232:235], v249 offset:12288
ds_read_u16_d16_hi v137, v137
ds_read_u16_d16_hi v139, v139
v_and_b32 v141, s49, v141
v_exp_f16 v144, v145
v_and_b32_e64 v143, s49, v143
v_exp_f16_sdwa v153, v154 dst_sel:WORD_1 dst_unused:UNUSED_PRESERVE src0_sel:WORD_1
v_bfe_u32 v140, v141, 2, 14
v_exp_f16_sdwa v150, v151 dst_sel:WORD_1 dst_unused:UNUSED_PRESERVE src0_sel:WORD_1
v_bfe_u32 v142, v143, 2, 14
v_mfma_f32_32x32x16_bf16 v[120:135], v[84:87], v[216:219], v[120:135]
ds_read_b128 v[236:239], v249 offset:15360
ds_read_u16_d16 v140, v140
ds_read_u16_d16 v142, v142
v_exp_f16_sdwa v147, v148 dst_sel:WORD_1 dst_unused:UNUSED_PRESERVE src0_sel:WORD_1
v_lshrrev_b32_e64 v141, 18, v141
v_exp_f16_sdwa v144, v145 dst_sel:WORD_1 dst_unused:UNUSED_PRESERVE src0_sel:WORD_1
v_lshrrev_b32_e64 v143, 18, v143
v_pk_add_f16 v153, v153, 1.0 op_sel_hi:[1,0]
v_pk_add_f16 v150, v150, 1.0 op_sel_hi:[1,0]
v_pk_add_f16 v147, v147, 1.0 op_sel_hi:[1,0]
v_mfma_f32_32x32x16_bf16 v[120:135], v[88:91], v[220:223], v[120:135]
ds_read_b128 v[216:219], v249 offset:13312
ds_read_u16_d16_hi v141, v141
ds_read_u16_d16_hi v143, v143
v_pk_add_f16 v144, v144, 1.0 op_sel_hi:[1,0]
v_rcp_f16 v154, v153
v_rcp_f16 v151, v150
v_rcp_f16 v148, v147
v_rcp_f16 v145, v144
s_waitcnt lgkmcnt(6)
v_mfma_f32_32x32x16_bf16 v[120:135], v[92:95], v[224:227], v[120:135]
ds_read_b128 v[220:223], v249 offset:16384
v_rcp_f16_sdwa v154, v153 dst_sel:WORD_1 dst_unused:UNUSED_PRESERVE src0_sel:WORD_1
v_rcp_f16_sdwa v151, v150 dst_sel:WORD_1 dst_unused:UNUSED_PRESERVE src0_sel:WORD_1
s_setprio 0
v_rcp_f16_sdwa v148, v147 dst_sel:WORD_1 dst_unused:UNUSED_PRESERVE src0_sel:WORD_1
v_fma_mix_f32 v164, v136, v136, v164 op_sel:[0,0,0] op_sel_hi:[1,1,0]
v_rcp_f16_sdwa v145, v144 dst_sel:WORD_1 dst_unused:UNUSED_PRESERVE src0_sel:WORD_1
v_fma_mix_f32 v164, v137, v137, v164 op_sel:[1,1,0] op_sel_hi:[1,1,0]
v_smfmac_f32_16x16x32_bf16 v[24:27], v[228:229], v[208:211], v246
ds_read_b128 v[224:227], v249 offset:14336
v_pk_mul_f16 v155, v155, v154
v_fma_mix_f32 v164, v138, v138, v164 op_sel:[0,0,0] op_sel_hi:[1,1,0]
v_pk_mul_f16 v152, v152, v151
v_pk_mul_f16 v149, v149, v148
v_fma_mix_f32 v164, v139, v139, v164 op_sel:[1,1,0] op_sel_hi:[1,1,0]
v_smfmac_f32_16x16x32_bf16 v[40:43], v[230:231], v[212:215], v246
s_mov_b64 exec, 1
ds_add_u32 v253, v254 offset:16
s_mov_b64 exec, -1
v_pk_mul_f16 v146, v146, v145
v_fma_mix_f32 v164, v155, v155, v164 op_sel:[0,0,0] op_sel_hi:[1,1,0]
s_waitcnt lgkmcnt(3)
v_fma_mix_f32 v164, v140, v140, v164 op_sel:[0,0,0] op_sel_hi:[1,1,0]
v_fma_mix_f32 v164, v155, v155, v164 op_sel:[1,1,0] op_sel_hi:[1,1,0]
v_fma_mix_f32 v164, v152, v152, v164 op_sel:[0,0,0] op_sel_hi:[1,1,0]
v_fma_mix_f32 v164, v141, v141, v164 op_sel:[1,1,0] op_sel_hi:[1,1,0]
v_fma_mix_f32 v164, v152, v152, v164 op_sel:[1,1,0] op_sel_hi:[1,1,0]
v_fma_mix_f32 v164, v149, v149, v164 op_sel:[0,0,0] op_sel_hi:[1,1,0]
v_fma_mix_f32 v164, v142, v142, v164 op_sel:[0,0,0] op_sel_hi:[1,1,0]
v_fma_mix_f32 v164, v149, v149, v164 op_sel:[1,1,0] op_sel_hi:[1,1,0]
v_fma_mix_f32 v164, v146, v146, v164 op_sel:[0,0,0] op_sel_hi:[1,1,0]
v_fma_mix_f32 v164, v143, v143, v164 op_sel:[1,1,0] op_sel_hi:[1,1,0]
v_fma_mix_f32 v164, v146, v146, v164 op_sel:[1,1,0] op_sel_hi:[1,1,0]
s_setprio 3
v_pk_add_f32 v[168:169], v[0:1], v[2:3]
v_pk_mul_f32 v[170:171], v[0:1], v[0:1]
v_pk_fma_f32 v[170:171], v[2:3], v[2:3], v[170:171]
v_pk_add_f32 v[168:169], v[168:169], v[4:5]
v_pk_fma_f32 v[170:171], v[4:5], v[4:5], v[170:171]
v_pk_add_f32 v[168:169], v[168:169], v[6:7]
v_pk_fma_f32 v[170:171], v[6:7], v[6:7], v[170:171]
v_pk_add_f32 v[168:169], v[168:169], v[8:9]
v_pk_fma_f32 v[170:171], v[8:9], v[8:9], v[170:171]
v_pk_add_f32 v[168:169], v[168:169], v[10:11]
v_pk_fma_f32 v[170:171], v[10:11], v[10:11], v[170:171]
v_pk_add_f32 v[168:169], v[168:169], v[12:13]
v_pk_fma_f32 v[170:171], v[12:13], v[12:13], v[170:171]
v_pk_add_f32 v[168:169], v[168:169], v[14:15]
v_pk_fma_f32 v[170:171], v[14:15], v[14:15], v[170:171]
v_pk_add_f32 v[168:169], v[168:169], v[16:17]
v_pk_fma_f32 v[170:171], v[16:17], v[16:17], v[170:171]
v_pk_add_f32 v[168:169], v[168:169], v[18:19]
v_pk_fma_f32 v[170:171], v[18:19], v[18:19], v[170:171]
v_pk_add_f32 v[168:169], v[168:169], v[20:21]
v_pk_fma_f32 v[170:171], v[20:21], v[20:21], v[170:171]
v_pk_add_f32 v[168:169], v[168:169], v[22:23]
v_pk_fma_f32 v[170:171], v[22:23], v[22:23], v[170:171]
v_pk_add_f32 v[168:169], v[168:169], v[24:25]
v_pk_fma_f32 v[170:171], v[24:25], v[24:25], v[170:171]
v_pk_add_f32 v[168:169], v[168:169], v[26:27]
v_pk_fma_f32 v[170:171], v[26:27], v[26:27], v[170:171]
v_pk_add_f32 v[168:169], v[168:169], v[28:29]
v_pk_fma_f32 v[170:171], v[28:29], v[28:29], v[170:171]
v_pk_add_f32 v[168:169], v[168:169], v[30:31]
v_pk_fma_f32 v[170:171], v[30:31], v[30:31], v[170:171]
v_pk_add_f32 v[168:169], v[168:169], v[32:33]
v_pk_fma_f32 v[170:171], v[32:33], v[32:33], v[170:171]
v_pk_add_f32 v[168:169], v[168:169], v[34:35]
v_pk_fma_f32 v[170:171], v[34:35], v[34:35], v[170:171]
v_pk_add_f32 v[168:169], v[168:169], v[36:37]
v_pk_fma_f32 v[170:171], v[36:37], v[36:37], v[170:171]
v_pk_add_f32 v[168:169], v[168:169], v[38:39]
v_pk_fma_f32 v[170:171], v[38:39], v[38:39], v[170:171]
v_pk_add_f32 v[168:169], v[168:169], v[40:41]
v_pk_fma_f32 v[170:171], v[40:41], v[40:41], v[170:171]
v_pk_add_f32 v[168:169], v[168:169], v[42:43]
v_pk_fma_f32 v[170:171], v[42:43], v[42:43], v[170:171]
v_pk_add_f32 v[168:169], v[168:169], v[44:45]
v_pk_fma_f32 v[170:171], v[44:45], v[44:45], v[170:171]
v_pk_add_f32 v[168:169], v[168:169], v[46:47]
v_pk_fma_f32 v[170:171], v[46:47], v[46:47], v[170:171]
s_setprio 0
v_add_u32 v174, -36864, v242
v_subrev_u32 v175, 66560, v174
v_min_u32 v174, v174, v175
v_add_u32 v174, 90112, v174
v_sub_u32 v175, v174, v242
v_add_u32 v242, v175, v242
v_add_u32_e64 v243, v175, v243
v_add_u32 v244, v175, v244
s_setprio 2
v_cvt_pkrtz_f16_f32 v137, v120, v121
v_cvt_pkrtz_f16_f32 v139, v122, v123
v_cvt_pkrtz_f16_f32 v141, v124, v125
v_cvt_pkrtz_f16_f32 v143, v126, v127
v_cvt_pkrtz_f16_f32 v145, v128, v129
v_cvt_pk_f16_f32 v155, v130, v131
v_cvt_pk_f16_f32 v152, v132, v133
v_cvt_pk_f16_f32 v149, v134, v135
ds_read_b128 v[228:231], v249 offset:17408
v_mfma_f32_32x32x16_bf16 v[120:135], v[72:75], v[232:235], 0
v_pk_fma_f16 v154, v155, v155, s48
v_add_f32 v168, v168, v169
v_and_b32 v137, s49, v137
v_pk_fma_f16 v151, v152, v152, s48
v_and_b32_e64 v139, s49, v139
v_pk_fma_f16 v148, v149, v149, s48
v_add_f32_e64 v170, v170, v171
v_pk_mul_f16 v154, v155, v154
v_bfe_u32 v136, v137, 2, 14
v_pk_mul_f16 v151, v152, v151
v_pk_mul_f16 v148, v149, v148
v_bfe_u32 v138, v139, 2, 14
ds_read_b128 v[232:235], v249 offset:18432
ds_read_u16_d16 v136, v136
ds_read_u16_d16 v138, v138
v_mfma_f32_32x32x16_bf16 v[120:135], v[76:79], v[236:239], v[120:135]
v_permlane32_swap_b32 v168, v170
v_exp_f16 v153, v154
v_lshrrev_b32 v137, 18, v137
v_exp_f16 v150, v151
v_add_f32 v168, v168, v170
v_lshrrev_b32 v139, 18, v139
v_exp_f16 v147, v148
v_and_b32 v141, s49, v141
v_and_b32_e64 v143, s49, v143
v_mul_f32 v168, 1009429163, v168
ds_read_b128 v[236:239], v249 offset:21504
ds_read_u16_d16_hi v137, v137
ds_read_u16_d16_hi v139, v139
v_mfma_f32_32x32x16_bf16 v[120:135], v[80:83], v[216:219], v[120:135]
v_exp_f16_sdwa v153, v154 dst_sel:WORD_1 dst_unused:UNUSED_PRESERVE src0_sel:WORD_1
v_bfe_u32 v140, v141, 2, 14
v_exp_f16_sdwa v150, v151 dst_sel:WORD_1 dst_unused:UNUSED_PRESERVE src0_sel:WORD_1
v_mov_b32_e64 v170, v168
v_bfe_u32 v142, v143, 2, 14
v_exp_f16_sdwa v147, v148 dst_sel:WORD_1 dst_unused:UNUSED_PRESERVE src0_sel:WORD_1
v_lshrrev_b32_e64 v141, 18, v141
v_permlane32_swap_b32 v168, v170
v_pk_add_f16 v153, v153, 1.0 op_sel_hi:[1,0]
s_waitcnt lgkmcnt(8)
ds_read_b128 v[216:219], v249 offset:19456
ds_read_u16_d16 v140, v140
ds_read_u16_d16 v142, v142
ds_read_u16_d16_hi v141, v141
v_mfma_f32_32x32x16_bf16 v[120:135], v[84:87], v[220:223], v[120:135]
v_lshrrev_b32_e64 v143, 18, v143
v_pk_add_f16 v150, v150, 1.0 op_sel_hi:[1,0]
v_pk_add_f16 v147, v147, 1.0 op_sel_hi:[1,0]
v_and_b32_e64 v145, s49, v145
v_fma_f32 v170, -v168, v168, v170
v_rcp_f16_e64 v154, v153
v_bfe_u32 v144, v145, 2, 14
v_rcp_f16 v151, v150
v_max_f32 v170, 0, v170
v_lshrrev_b32_e64 v145, 18, v145
ds_read_b128 v[220:223], v249 offset:22528
ds_read_u16_d16_hi v143, v143
ds_read_u16_d16 v144, v144
ds_read_u16_d16_hi v145, v145
v_mfma_f32_32x32x16_bf16 v[120:135], v[88:91], v[224:227], v[120:135]
v_rcp_f16 v148, v147
v_rcp_f16_sdwa v154, v153 dst_sel:WORD_1 dst_unused:UNUSED_PRESERVE src0_sel:WORD_1
v_add_f32 v170, 925353388, v170
s_waitcnt lgkmcnt(8)
v_fma_mix_f32 v165, v136, v136, v165 op_sel:[0,0,0] op_sel_hi:[1,1,0]
ds_read_b32 v247, v253 offset:16
v_fma_mix_f32 v165, v137, v137, v165 op_sel:[1,1,0] op_sel_hi:[1,1,0]
v_rcp_f16_sdwa v151, v150 dst_sel:WORD_1 dst_unused:UNUSED_PRESERVE src0_sel:WORD_1
v_rsq_f32_e64 v170, v170
v_fma_mix_f32 v165, v138, v138, v165 op_sel:[0,0,0] op_sel_hi:[1,1,0]
ds_read_b128 v[224:227], v249 offset:20480
v_mfma_f32_32x32x16_bf16 v[120:135], v[92:95], v[228:231], v[120:135]
v_rcp_f16_sdwa v148, v147 dst_sel:WORD_1 dst_unused:UNUSED_PRESERVE src0_sel:WORD_1
v_fma_mix_f32 v165, v139, v139, v165 op_sel:[1,1,0] op_sel_hi:[1,1,0]
v_pk_mul_f16 v155, v155, v154
s_waitcnt lgkmcnt(6)
v_fma_mix_f32 v165, v140, v140, v165 op_sel:[0,0,0] op_sel_hi:[1,1,0]
v_pk_mul_f16 v152, v152, v151
v_fma_mix_f32 v165, v141, v141, v165 op_sel:[1,1,0] op_sel_hi:[1,1,0]
v_pk_mul_f16 v149, v149, v148
v_fma_mix_f32 v165, v155, v155, v165 op_sel:[0,0,0] op_sel_hi:[1,1,0]
v_mul_f32 v172, 3203391086, v170
v_fma_mix_f32 v165, v142, v142, v165 op_sel:[0,0,0] op_sel_hi:[1,1,0]
v_fma_mix_f32 v165, v155, v155, v165 op_sel:[1,1,0] op_sel_hi:[1,1,0]
s_waitcnt lgkmcnt(2)
v_fma_mix_f32 v165, v143, v143, v165 op_sel:[1,1,0] op_sel_hi:[1,1,0]
v_fma_mix_f32 v165, v152, v152, v165 op_sel:[0,0,0] op_sel_hi:[1,1,0]
v_fma_mix_f32 v165, v152, v152, v165 op_sel:[1,1,0] op_sel_hi:[1,1,0]
v_mul_f32 v173, v168, v172
v_fma_mix_f32 v165, v144, v144, v165 op_sel:[0,0,0] op_sel_hi:[1,1,0]
v_fma_mix_f32 v165, v149, v149, v165 op_sel:[0,0,0] op_sel_hi:[1,1,0]
v_fma_mix_f32 v165, v145, v145, v165 op_sel:[1,1,0] op_sel_hi:[1,1,0]
v_fma_mix_f32 v165, v149, v149, v165 op_sel:[1,1,0] op_sel_hi:[1,1,0]
s_setprio 3
v_pk_fma_f32 v[0:1], v[0:1], v[172:173], v[172:173] op_sel:[0,0,1] op_sel_hi:[1,0,1] neg_lo:[0,0,1] neg_hi:[0,0,1]
v_pk_fma_f32 v[2:3], v[2:3], v[172:173], v[172:173] op_sel:[0,0,1] op_sel_hi:[1,0,1] neg_lo:[0,0,1] neg_hi:[0,0,1]
v_pk_fma_f32 v[4:5], v[4:5], v[172:173], v[172:173] op_sel:[0,0,1] op_sel_hi:[1,0,1] neg_lo:[0,0,1] neg_hi:[0,0,1]
v_pk_fma_f32 v[6:7], v[6:7], v[172:173], v[172:173] op_sel:[0,0,1] op_sel_hi:[1,0,1] neg_lo:[0,0,1] neg_hi:[0,0,1]
v_pk_fma_f32 v[8:9], v[8:9], v[172:173], v[172:173] op_sel:[0,0,1] op_sel_hi:[1,0,1] neg_lo:[0,0,1] neg_hi:[0,0,1]
v_pk_fma_f32 v[10:11], v[10:11], v[172:173], v[172:173] op_sel:[0,0,1] op_sel_hi:[1,0,1] neg_lo:[0,0,1] neg_hi:[0,0,1]
v_pk_fma_f32 v[12:13], v[12:13], v[172:173], v[172:173] op_sel:[0,0,1] op_sel_hi:[1,0,1] neg_lo:[0,0,1] neg_hi:[0,0,1]
v_pk_fma_f32 v[14:15], v[14:15], v[172:173], v[172:173] op_sel:[0,0,1] op_sel_hi:[1,0,1] neg_lo:[0,0,1] neg_hi:[0,0,1]
v_pk_fma_f32 v[16:17], v[16:17], v[172:173], v[172:173] op_sel:[0,0,1] op_sel_hi:[1,0,1] neg_lo:[0,0,1] neg_hi:[0,0,1]
v_pk_fma_f32 v[18:19], v[18:19], v[172:173], v[172:173] op_sel:[0,0,1] op_sel_hi:[1,0,1] neg_lo:[0,0,1] neg_hi:[0,0,1]
v_pk_fma_f32 v[20:21], v[20:21], v[172:173], v[172:173] op_sel:[0,0,1] op_sel_hi:[1,0,1] neg_lo:[0,0,1] neg_hi:[0,0,1]
v_pk_fma_f32 v[22:23], v[22:23], v[172:173], v[172:173] op_sel:[0,0,1] op_sel_hi:[1,0,1] neg_lo:[0,0,1] neg_hi:[0,0,1]
v_pk_fma_f32 v[24:25], v[24:25], v[172:173], v[172:173] op_sel:[0,0,1] op_sel_hi:[1,0,1] neg_lo:[0,0,1] neg_hi:[0,0,1]
v_pk_fma_f32 v[26:27], v[26:27], v[172:173], v[172:173] op_sel:[0,0,1] op_sel_hi:[1,0,1] neg_lo:[0,0,1] neg_hi:[0,0,1]
v_pk_fma_f32 v[28:29], v[28:29], v[172:173], v[172:173] op_sel:[0,0,1] op_sel_hi:[1,0,1] neg_lo:[0,0,1] neg_hi:[0,0,1]
v_pk_fma_f32 v[30:31], v[30:31], v[172:173], v[172:173] op_sel:[0,0,1] op_sel_hi:[1,0,1] neg_lo:[0,0,1] neg_hi:[0,0,1]
v_pk_fma_f32 v[32:33], v[32:33], v[172:173], v[172:173] op_sel:[0,0,1] op_sel_hi:[1,0,1] neg_lo:[0,0,1] neg_hi:[0,0,1]
v_pk_fma_f32 v[34:35], v[34:35], v[172:173], v[172:173] op_sel:[0,0,1] op_sel_hi:[1,0,1] neg_lo:[0,0,1] neg_hi:[0,0,1]
v_pk_fma_f32 v[36:37], v[36:37], v[172:173], v[172:173] op_sel:[0,0,1] op_sel_hi:[1,0,1] neg_lo:[0,0,1] neg_hi:[0,0,1]
v_pk_fma_f32 v[38:39], v[38:39], v[172:173], v[172:173] op_sel:[0,0,1] op_sel_hi:[1,0,1] neg_lo:[0,0,1] neg_hi:[0,0,1]
v_pk_fma_f32 v[40:41], v[40:41], v[172:173], v[172:173] op_sel:[0,0,1] op_sel_hi:[1,0,1] neg_lo:[0,0,1] neg_hi:[0,0,1]
v_pk_fma_f32 v[42:43], v[42:43], v[172:173], v[172:173] op_sel:[0,0,1] op_sel_hi:[1,0,1] neg_lo:[0,0,1] neg_hi:[0,0,1]
v_pk_fma_f32 v[44:45], v[44:45], v[172:173], v[172:173] op_sel:[0,0,1] op_sel_hi:[1,0,1] neg_lo:[0,0,1] neg_hi:[0,0,1]
v_pk_fma_f32 v[46:47], v[46:47], v[172:173], v[172:173] op_sel:[0,0,1] op_sel_hi:[1,0,1] neg_lo:[0,0,1] neg_hi:[0,0,1]
s_setprio 2
s_waitcnt lgkmcnt(0)
v_readfirstlane_b32 s43, v247
s_nop 1
s_cmp_ge_u32 s43, 24
s_cbranch_scc1 Lev6
Lev6w:
s_sleep 1
ds_read_b32 v247, v253 offset:16
s_waitcnt lgkmcnt(0)
v_readfirstlane_b32 s43, v247
s_cmp_eq_u32 s76, 0
s_cbranch_scc1 Lev6
s_sub_u32 s76, s76, 1
s_cmp_lt_u32 s43, 24
s_cbranch_scc1 Lev6w
Lev6:
s_setprio 1
v_cvt_pkrtz_f16_f32 v137, v120, v121
v_cvt_pkrtz_f16_f32 v139, v122, v123
v_cvt_pkrtz_f16_f32 v141, v124, v125
v_cvt_pkrtz_f16_f32 v143, v126, v127
v_cvt_pkrtz_f16_f32 v145, v128, v129
v_cvt_pk_f16_f32 v155, v130, v131
v_cvt_pk_f16_f32 v152, v132, v133
v_cvt_pk_f16_f32 v149, v134, v135
s_add_u32 m0, s67, 39936
s_add_u32 s66, s66, 98304
buffer_load_dwordx4 v240, s[4:7], s66 offen lds
ds_read_b128 v[228:231], v249 offset:23552
v_mfma_f32_32x32x16_bf16 v[120:135], v[72:75], v[232:235], 0
v_pk_fma_f16 v154, v155, v155, s48
v_cvt_pk_bf16_f32 v96, v0, v1
v_and_b32 v137, s49, v137
v_pk_fma_f16 v151, v152, v152, s48
v_cvt_pk_bf16_f32 v97, v2, v3
v_and_b32_e64 v139, s49, v139
v_pk_fma_f16 v148, v149, v149, s48
v_pk_mul_f16 v154, v155, v154
v_cvt_pk_bf16_f32 v98, v4, v5
v_bfe_u32 v136, v137, 2, 14
v_pk_mul_f16 v151, v152, v151
v_pk_mul_f16 v148, v149, v148
v_cvt_pk_bf16_f32 v99, v6, v7
v_bfe_u32 v138, v139, 2, 14
s_add_u32 m0, s67, 46592
s_add_u32 s66, s66, 98304
buffer_load_dwordx4 v240, s[4:7], s66 offen lds
ds_read_b128 v[232:235], v248 offset:16384
ds_read_u16_d16 v136, v136
ds_read_u16_d16 v138, v138
v_mfma_f32_32x32x16_bf16 v[120:135], v[76:79], v[236:239], v[120:135]
v_exp_f16_e64 v153, v154
v_cvt_pk_bf16_f32 v100, v8, v9
v_lshrrev_b32 v137, 18, v137
v_exp_f16 v150, v151
v_cvt_pk_bf16_f32 v101, v10, v11
v_lshrrev_b32 v139, 18, v139
v_exp_f16 v147, v148
v_cvt_pk_bf16_f32 v102, v12, v13
v_and_b32 v141, s49, v141
v_and_b32 v143, s49, v143
v_cvt_pk_bf16_f32 v103, v14, v15
s_add_u32 m0, s67, 53248
s_add_u32 s66, s66, 98304
buffer_load_dwordx4 v240, s[4:7], s66 offen lds
ds_read_b128 v[236:239], v248 offset:19456
ds_read_u16_d16_hi v137, v137
ds_read_u16_d16_hi v139, v139
v_mfma_f32_32x32x16_bf16 v[120:135], v[80:83], v[216:219], v[120:135]
v_exp_f16_sdwa v153, v154 dst_sel:WORD_1 dst_unused:UNUSED_PRESERVE src0_sel:WORD_1
v_bfe_u32 v140, v141, 2, 14
v_cvt_pk_bf16_f32 v104, v16, v17
v_exp_f16_sdwa v150, v151 dst_sel:WORD_1 dst_unused:UNUSED_PRESERVE src0_sel:WORD_1
v_bfe_u32 v142, v143, 2, 14
v_cvt_pk_bf16_f32 v105, v18, v19
v_exp_f16_sdwa v147, v148 dst_sel:WORD_1 dst_unused:UNUSED_PRESERVE src0_sel:WORD_1
v_cvt_pk_bf16_f32 v106, v20, v21
v_lshrrev_b32_e64 v141, 18, v141
v_pk_add_f16 v153, v153, 1.0 op_sel_hi:[1,0]
v_lshrrev_b32 v143, 18, v143
s_add_u32 m0, s67, 59904
s_add_u32 s66, s66, 98304
buffer_load_dwordx4 v240, s[4:7], s66 offen lds
s_add_u32 m0, s67, 0
s_add_u32 s66, s66, 98304
buffer_load_dwordx4 v240, s[4:7], s66 offen lds
ds_read_b128 v[216:219], v248 offset:17408
ds_read_u16_d16 v140, v140
ds_read_u16_d16 v142, v142
ds_read_u16_d16_hi v141, v141
ds_read_u16_d16_hi v143, v143
v_mfma_f32_32x32x16_bf16 v[120:135], v[84:87], v[220:223], v[120:135]
v_cvt_pk_bf16_f32 v107, v22, v23
v_pk_add_f16 v150, v150, 1.0 op_sel_hi:[1,0]
v_pk_add_f16 v147, v147, 1.0 op_sel_hi:[1,0]
v_and_b32_e64 v145, s49, v145
v_cvt_pk_bf16_f32 v108, v24, v25
v_rcp_f16_e64 v154, v153
v_bfe_u32 v144, v145, 2, 14
v_cvt_pk_bf16_f32 v109, v26, v27
v_rcp_f16 v151, v150
v_lshrrev_b32 v145, 18, v145
v_cvt_pk_bf16_f32 v110, v28, v29
s_add_u32 m0, s67, 6656
s_add_u32 s66, s66, 98304
buffer_load_dwordx4 v240, s[4:7], s66 offen lds
ds_read_b128 v[220:223], v248 offset:20480
ds_read_u16_d16 v144, v144
ds_read_u16_d16_hi v145, v145
v_mfma_f32_32x32x16_bf16 v[120:135], v[88:91], v[224:227], v[120:135]
v_rcp_f16_e64 v148, v147
v_cvt_pk_bf16_f32 v111, v30, v31
v_rcp_f16_sdwa v154, v153 dst_sel:WORD_1 dst_unused:UNUSED_PRESERVE src0_sel:WORD_1
s_waitcnt lgkmcnt(5)
v_fma_mix_f32 v166, v136, v136, v166 op_sel:[0,0,0] op_sel_hi:[1,1,0]
v_cvt_pk_bf16_f32 v112, v32, v33
s_setprio 0
v_fma_mix_f32 v166, v137, v137, v166 op_sel:[1,1,0] op_sel_hi:[1,1,0]
v_rcp_f16_sdwa v151, v150 dst_sel:WORD_1 dst_unused:UNUSED_PRESERVE src0_sel:WORD_1
v_cvt_pk_bf16_f32 v113, v34, v35
v_fma_mix_f32 v166, v138, v138, v166 op_sel:[0,0,0] op_sel_hi:[1,1,0]
v_rcp_f16_sdwa v148, v147 dst_sel:WORD_1 dst_unused:UNUSED_PRESERVE src0_sel:WORD_1
v_cvt_pk_bf16_f32 v114, v36, v37
s_add_u32 m0, s67, 13312
s_add_u32 s66, s66, 98304
buffer_load_dwordx4 v240, s[4:7], s66 offen lds
ds_read_b128 v[224:227], v248 offset:18432
v_mfma_f32_32x32x16_bf16 v[120:135], v[92:95], v[228:231], v[120:135]
v_fma_mix_f32 v166, v139, v139, v166 op_sel:[1,1,0] op_sel_hi:[1,1,0]
v_pk_mul_f16 v155, v155, v154
v_fma_mix_f32 v166, v140, v140, v166 op_sel:[0,0,0] op_sel_hi:[1,1,0]
v_cvt_pk_bf16_f32 v115, v38, v39
v_pk_mul_f16 v152, v152, v151
s_waitcnt lgkmcnt(1)
v_fma_mix_f32 v166, v141, v141, v166 op_sel:[1,1,0] op_sel_hi:[1,1,0]
v_cvt_pk_bf16_f32 v116, v40, v41
v_pk_mul_f16 v149, v149, v148
v_fma_mix_f32 v166, v155, v155, v166 op_sel:[0,0,0] op_sel_hi:[1,1,0]
v_fma_mix_f32 v166, v142, v142, v166 op_sel:[0,0,0] op_sel_hi:[1,1,0]
v_cvt_pk_bf16_f32 v117, v42, v43
v_fma_mix_f32 v166, v155, v155, v166 op_sel:[1,1,0] op_sel_hi:[1,1,0]
v_fma_mix_f32 v166, v143, v143, v166 op_sel:[1,1,0] op_sel_hi:[1,1,0]
v_fma_mix_f32 v166, v152, v152, v166 op_sel:[0,0,0] op_sel_hi:[1,1,0]
s_add_u32 m0, s67, 19968
s_add_u32 s66, s66, 98304
buffer_load_dwordx4 v240, s[4:7], s66 offen lds
v_cvt_pk_bf16_f32 v118, v44, v45
v_fma_mix_f32 v166, v152, v152, v166 op_sel:[1,1,0] op_sel_hi:[1,1,0]
v_fma_mix_f32 v166, v144, v144, v166 op_sel:[0,0,0] op_sel_hi:[1,1,0]
v_fma_mix_f32 v166, v149, v149, v166 op_sel:[0,0,0] op_sel_hi:[1,1,0]
v_cvt_pk_bf16_f32 v119, v46, v47
v_fma_mix_f32 v166, v145, v145, v166 op_sel:[1,1,0] op_sel_hi:[1,1,0]
v_fma_mix_f32 v166, v149, v149, v166 op_sel:[1,1,0] op_sel_hi:[1,1,0]
s_setprio 2
v_cvt_pkrtz_f16_f32 v137, v120, v121
v_cvt_pkrtz_f16_f32 v139, v122, v123
v_cvt_pkrtz_f16_f32 v141, v124, v125
v_cvt_pkrtz_f16_f32 v143, v126, v127
v_cvt_pkrtz_f16_f32 v145, v128, v129
v_cvt_pk_f16_f32 v155, v130, v131
v_cvt_pk_f16_f32 v152, v132, v133
v_cvt_pk_f16_f32 v149, v134, v135
s_add_u32 s46, s80, 12582912
buffer_store_dwordx4 v[72:75], v241, s[32:35], s46 offen sc1
ds_read_b128 v[228:231], v248 offset:21504
v_mfma_f32_32x32x16_bf16 v[120:135], v[96:99], v[232:235], 0
v_pk_fma_f16 v154, v155, v155, s48
v_and_b32_e64 v137, s49, v137
v_pk_fma_f16 v151, v152, v152, s48
v_and_b32_e64 v139, s49, v139
v_pk_fma_f16 v148, v149, v149, s48
v_pk_mul_f16 v154, v155, v154
v_bfe_u32 v136, v137, 2, 14
v_pk_mul_f16 v151, v152, v151
v_pk_mul_f16 v148, v149, v148
v_bfe_u32 v138, v139, 2, 14
ds_read_b128 v[232:235], v248 offset:22528
ds_read_u16_d16 v136, v136
ds_read_u16_d16 v138, v138
v_mfma_f32_32x32x16_bf16 v[120:135], v[100:103], v[236:239], v[120:135]
v_exp_f16 v153, v154
v_lshrrev_b32 v137, 18, v137
v_exp_f16 v150, v151
v_lshrrev_b32 v139, 18, v139
v_exp_f16 v147, v148
v_and_b32 v141, s49, v141
v_and_b32_e64 v143, s49, v143
ds_read_b128 v[236:239], v248 offset:25600
ds_read_u16_d16_hi v137, v137
ds_read_u16_d16_hi v139, v139
v_mfma_f32_32x32x16_bf16 v[120:135], v[104:107], v[216:219], v[120:135]
v_exp_f16_sdwa v153, v154 dst_sel:WORD_1 dst_unused:UNUSED_PRESERVE src0_sel:WORD_1
v_bfe_u32 v140, v141, 2, 14
v_exp_f16_sdwa v150, v151 dst_sel:WORD_1 dst_unused:UNUSED_PRESERVE src0_sel:WORD_1
v_bfe_u32 v142, v143, 2, 14
v_exp_f16_sdwa v147, v148 dst_sel:WORD_1 dst_unused:UNUSED_PRESERVE src0_sel:WORD_1
v_lshrrev_b32_e64 v141, 18, v141
v_pk_add_f16 v153, v153, 1.0 op_sel_hi:[1,0]
ds_read_b128 v[216:219], v248 offset:23552
ds_read_u16_d16 v140, v140
ds_read_u16_d16 v142, v142
ds_read_u16_d16_hi v141, v141
v_mfma_f32_32x32x16_bf16 v[120:135], v[108:111], v[220:223], v[120:135]
v_lshrrev_b32_e64 v143, 18, v143
v_pk_add_f16 v150, v150, 1.0 op_sel_hi:[1,0]
v_pk_add_f16 v147, v147, 1.0 op_sel_hi:[1,0]
v_and_b32 v145, s49, v145
v_rcp_f16 v154, v153
v_bfe_u32 v144, v145, 2, 14
v_rcp_f16_e64 v151, v150
v_lshrrev_b32 v145, 18, v145
s_waitcnt lgkmcnt(7)
ds_read_b128 v[220:223], v248 offset:26624
ds_read_u16_d16_hi v143, v143
ds_read_u16_d16 v144, v144
ds_read_u16_d16_hi v145, v145
v_mfma_f32_32x32x16_bf16 v[120:135], v[112:115], v[224:227], v[120:135]
v_rcp_f16_e64 v148, v147
v_rcp_f16_sdwa v154, v153 dst_sel:WORD_1 dst_unused:UNUSED_PRESERVE src0_sel:WORD_1
v_fma_mix_f32 v167, v136, v136, v167 op_sel:[0,0,0] op_sel_hi:[1,1,0]
s_waitcnt lgkmcnt(8)
v_fma_mix_f32 v167, v137, v137, v167 op_sel:[1,1,0] op_sel_hi:[1,1,0]
v_rcp_f16_sdwa v151, v150 dst_sel:WORD_1 dst_unused:UNUSED_PRESERVE src0_sel:WORD_1
v_fma_mix_f32 v167, v138, v138, v167 op_sel:[0,0,0] op_sel_hi:[1,1,0]
ds_read_b128 v[224:227], v248 offset:24576
v_mfma_f32_32x32x16_bf16 v[120:135], v[116:119], v[228:231], v[120:135]
v_rcp_f16_sdwa v148, v147 dst_sel:WORD_1 dst_unused:UNUSED_PRESERVE src0_sel:WORD_1
v_fma_mix_f32 v167, v139, v139, v167 op_sel:[1,1,0] op_sel_hi:[1,1,0]
v_pk_mul_f16 v155, v155, v154
s_waitcnt lgkmcnt(5)
v_fma_mix_f32 v167, v140, v140, v167 op_sel:[0,0,0] op_sel_hi:[1,1,0]
v_pk_mul_f16 v152, v152, v151
v_fma_mix_f32 v167, v141, v141, v167 op_sel:[1,1,0] op_sel_hi:[1,1,0]
v_pk_mul_f16 v149, v149, v148
v_fma_mix_f32 v167, v155, v155, v167 op_sel:[0,0,0] op_sel_hi:[1,1,0]
v_fma_mix_f32 v167, v142, v142, v167 op_sel:[0,0,0] op_sel_hi:[1,1,0]
v_fma_mix_f32 v167, v155, v155, v167 op_sel:[1,1,0] op_sel_hi:[1,1,0]
s_waitcnt lgkmcnt(3)
v_fma_mix_f32 v167, v143, v143, v167 op_sel:[1,1,0] op_sel_hi:[1,1,0]
v_fma_mix_f32 v167, v152, v152, v167 op_sel:[0,0,0] op_sel_hi:[1,1,0]
v_fma_mix_f32 v167, v152, v152, v167 op_sel:[1,1,0] op_sel_hi:[1,1,0]
s_waitcnt lgkmcnt(1)
v_fma_mix_f32 v167, v144, v144, v167 op_sel:[0,0,0] op_sel_hi:[1,1,0]
v_fma_mix_f32 v167, v149, v149, v167 op_sel:[0,0,0] op_sel_hi:[1,1,0]
v_fma_mix_f32 v167, v145, v145, v167 op_sel:[1,1,0] op_sel_hi:[1,1,0]
v_fma_mix_f32 v167, v149, v149, v167 op_sel:[1,1,0] op_sel_hi:[1,1,0]
s_cmp_lg_u32 s40, 7
s_cbranch_scc1 Lnoinit
s_waitcnt vmcnt(12)
v_mov_b32_e64 v255, 1
s_mov_b64 exec, 1
buffer_atomic_add v255, v241, s[36:39], 0 offen
s_mov_b64 exec, -1
Lnoinit:
s_setprio 1
v_cvt_pkrtz_f16_f32 v137, v120, v121
v_cvt_pkrtz_f16_f32 v139, v122, v123
v_cvt_pkrtz_f16_f32 v141, v124, v125
v_cvt_pkrtz_f16_f32 v143, v126, v127
v_cvt_pkrtz_f16_f32 v145, v128, v129
v_cvt_pk_f16_f32 v155, v130, v131
v_cvt_pk_f16_f32 v152, v132, v133
v_cvt_pk_f16_f32 v149, v134, v135
s_add_u32 s46, s80, 14680064
buffer_store_dwordx4 v[76:79], v241, s[32:35], s46 offen sc1
ds_read_b128 v[228:231], v248 offset:27648
v_mfma_f32_32x32x16_bf16 v[120:135], v[96:99], v[232:235], 0
v_pk_fma_f16 v154, v155, v155, s48
v_and_b32_e64 v137, s49, v137
v_pk_fma_f16 v151, v152, v152, s48
v_and_b32_e64 v139, s49, v139
v_pk_fma_f16 v148, v149, v149, s48
v_pk_mul_f16 v154, v155, v154
v_bfe_u32 v136, v137, 2, 14
v_pk_mul_f16 v151, v152, v151
v_pk_mul_f16 v148, v149, v148
v_bfe_u32 v138, v139, 2, 14
ds_read_b128 v[232:235], v248 offset:28672
ds_read_u16_d16 v136, v136
ds_read_u16_d16 v138, v138
v_mfma_f32_32x32x16_bf16 v[120:135], v[100:103], v[236:239], v[120:135]
v_exp_f16 v153, v154
v_lshrrev_b32 v137, 18, v137
v_exp_f16 v150, v151
v_lshrrev_b32 v139, 18, v139
v_exp_f16 v147, v148
v_and_b32 v141, s49, v141
v_and_b32_e64 v143, s49, v143
ds_read_b128 v[236:239], v248 offset:31744
ds_read_u16_d16_hi v137, v137
ds_read_u16_d16_hi v139, v139
v_mfma_f32_32x32x16_bf16 v[120:135], v[104:107], v[216:219], v[120:135]
v_exp_f16_sdwa v153, v154 dst_sel:WORD_1 dst_unused:UNUSED_PRESERVE src0_sel:WORD_1
v_bfe_u32 v140, v141, 2, 14
v_exp_f16_sdwa v150, v151 dst_sel:WORD_1 dst_unused:UNUSED_PRESERVE src0_sel:WORD_1
v_bfe_u32 v142, v143, 2, 14
v_exp_f16_sdwa v147, v148 dst_sel:WORD_1 dst_unused:UNUSED_PRESERVE src0_sel:WORD_1
v_lshrrev_b32_e64 v141, 18, v141
v_pk_add_f16 v153, v153, 1.0 op_sel_hi:[1,0]
ds_read_b128 v[216:219], v248 offset:29696
ds_read_u16_d16 v140, v140
ds_read_u16_d16 v142, v142
ds_read_u16_d16_hi v141, v141
v_mfma_f32_32x32x16_bf16 v[120:135], v[108:111], v[220:223], v[120:135]
v_lshrrev_b32_e64 v143, 18, v143
v_pk_add_f16 v150, v150, 1.0 op_sel_hi:[1,0]
v_pk_add_f16 v147, v147, 1.0 op_sel_hi:[1,0]
v_and_b32 v145, s49, v145
v_rcp_f16 v154, v153
v_bfe_u32 v144, v145, 2, 14
v_rcp_f16_e64 v151, v150
v_lshrrev_b32 v145, 18, v145
s_waitcnt lgkmcnt(7)
ds_read_b128 v[220:223], v248 offset:32768
ds_read_u16_d16_hi v143, v143
ds_read_u16_d16 v144, v144
ds_read_u16_d16_hi v145, v145
v_mfma_f32_32x32x16_bf16 v[120:135], v[112:115], v[224:227], v[120:135]
v_rcp_f16_e64 v148, v147
v_rcp_f16_sdwa v154, v153 dst_sel:WORD_1 dst_unused:UNUSED_PRESERVE src0_sel:WORD_1
v_fma_mix_f32 v156, v136, v136, v156 op_sel:[0,0,0] op_sel_hi:[1,1,0]
s_setprio 0
s_waitcnt lgkmcnt(8)
v_fma_mix_f32 v156, v137, v137, v156 op_sel:[1,1,0] op_sel_hi:[1,1,0]
v_rcp_f16_sdwa v151, v150 dst_sel:WORD_1 dst_unused:UNUSED_PRESERVE src0_sel:WORD_1
v_fma_mix_f32 v156, v138, v138, v156 op_sel:[0,0,0] op_sel_hi:[1,1,0]
ds_read_b128 v[224:227], v248 offset:30720
v_mfma_f32_32x32x16_bf16 v[120:135], v[116:119], v[228:231], v[120:135]
v_rcp_f16_sdwa v148, v147 dst_sel:WORD_1 dst_unused:UNUSED_PRESERVE src0_sel:WORD_1
v_fma_mix_f32 v156, v139, v139, v156 op_sel:[1,1,0] op_sel_hi:[1,1,0]
v_pk_mul_f16 v155, v155, v154
s_cmp_eq_u32 s40, 7
s_cbranch_scc1 Lrdy24
s_waitcnt vmcnt(2)
Lrdy24:
s_mov_b64 exec, 1
ds_add_u32 v253, v254 offset:12
s_mov_b64 exec, -1
s_waitcnt lgkmcnt(6)
v_fma_mix_f32 v156, v140, v140, v156 op_sel:[0,0,0] op_sel_hi:[1,1,0]
v_pk_mul_f16 v152, v152, v151
v_fma_mix_f32 v156, v141, v141, v156 op_sel:[1,1,0] op_sel_hi:[1,1,0]
v_pk_mul_f16 v149, v149, v148
v_fma_mix_f32 v156, v155, v155, v156 op_sel:[0,0,0] op_sel_hi:[1,1,0]
v_fma_mix_f32 v156, v142, v142, v156 op_sel:[0,0,0] op_sel_hi:[1,1,0]
v_fma_mix_f32 v156, v155, v155, v156 op_sel:[1,1,0] op_sel_hi:[1,1,0]
s_waitcnt lgkmcnt(2)
v_fma_mix_f32 v156, v143, v143, v156 op_sel:[1,1,0] op_sel_hi:[1,1,0]
v_fma_mix_f32 v156, v152, v152, v156 op_sel:[0,0,0] op_sel_hi:[1,1,0]
v_fma_mix_f32 v156, v152, v152, v156 op_sel:[1,1,0] op_sel_hi:[1,1,0]
v_fma_mix_f32 v156, v144, v144, v156 op_sel:[0,0,0] op_sel_hi:[1,1,0]
v_fma_mix_f32 v156, v149, v149, v156 op_sel:[0,0,0] op_sel_hi:[1,1,0]
v_fma_mix_f32 v156, v145, v145, v156 op_sel:[1,1,0] op_sel_hi:[1,1,0]
v_fma_mix_f32 v156, v149, v149, v156 op_sel:[1,1,0] op_sel_hi:[1,1,0]
s_setprio 2
v_cvt_pkrtz_f16_f32 v137, v120, v121
v_cvt_pkrtz_f16_f32 v139, v122, v123
v_cvt_pkrtz_f16_f32 v141, v124, v125
v_cvt_pkrtz_f16_f32 v143, v126, v127
v_cvt_pkrtz_f16_f32 v145, v128, v129
v_cvt_pk_f16_f32 v155, v130, v131
v_cvt_pk_f16_f32 v152, v132, v133
v_cvt_pk_f16_f32 v149, v134, v135
s_add_u32 s46, s80, 16777216
buffer_store_dwordx4 v[80:83], v241, s[32:35], s46 offen sc1
ds_read_b128 v[228:231], v248 offset:33792
v_mfma_f32_32x32x16_bf16 v[120:135], v[96:99], v[232:235], 0
v_pk_fma_f16 v154, v155, v155, s48
v_and_b32_e64 v137, s49, v137
v_pk_fma_f16 v151, v152, v152, s48
v_and_b32_e64 v139, s49, v139
v_pk_fma_f16 v148, v149, v149, s48
v_pk_mul_f16 v154, v155, v154
v_bfe_u32 v136, v137, 2, 14
v_pk_mul_f16 v151, v152, v151
v_pk_mul_f16 v148, v149, v148
v_bfe_u32 v138, v139, 2, 14
ds_read_b128 v[232:235], v250 offset:65520
ds_read_u16_d16 v136, v136
ds_read_u16_d16 v138, v138
v_mfma_f32_32x32x16_bf16 v[120:135], v[100:103], v[236:239], v[120:135]
v_exp_f16 v153, v154
v_lshrrev_b32 v137, 18, v137
v_exp_f16 v150, v151
v_lshrrev_b32 v139, 18, v139
v_exp_f16 v147, v148
v_and_b32 v141, s49, v141
v_and_b32_e64 v143, s49, v143
ds_read_b128 v[236:239], v248 offset:34816
ds_read_u16_d16_hi v137, v137
ds_read_b32 v247, v253 offset:12
ds_read_u16_d16_hi v139, v139
v_mfma_f32_32x32x16_bf16 v[120:135], v[104:107], v[216:219], v[120:135]
v_exp_f16_sdwa v153, v154 dst_sel:WORD_1 dst_unused:UNUSED_PRESERVE src0_sel:WORD_1
v_bfe_u32 v140, v141, 2, 14
v_exp_f16_sdwa v150, v151 dst_sel:WORD_1 dst_unused:UNUSED_PRESERVE src0_sel:WORD_1
v_bfe_u32 v142, v143, 2, 14
v_exp_f16_sdwa v147, v148 dst_sel:WORD_1 dst_unused:UNUSED_PRESERVE src0_sel:WORD_1
v_lshrrev_b32_e64 v141, 18, v141
v_pk_add_f16 v153, v153, 1.0 op_sel_hi:[1,0]
ds_read_b128 v[216:219], v248 offset:37888
ds_read_u16_d16 v140, v140
ds_read_u16_d16 v142, v142
ds_read_u16_d16_hi v141, v141
v_mfma_f32_32x32x16_bf16 v[120:135], v[108:111], v[220:223], v[120:135]
v_lshrrev_b32_e64 v143, 18, v143
v_pk_add_f16 v150, v150, 1.0 op_sel_hi:[1,0]
v_pk_add_f16 v147, v147, 1.0 op_sel_hi:[1,0]
v_and_b32 v145, s49, v145
v_rcp_f16 v154, v153
v_bfe_u32 v144, v145, 2, 14
v_rcp_f16_e64 v151, v150
ds_read_u16_d16_hi v143, v143
ds_read_u16_d16 v144, v144
s_waitcnt lgkmcnt(7)
v_readfirstlane_b32 s43, v247
s_nop 1
s_cmp_ge_u32 s43, 32
s_cbranch_scc1 Lev7
Lev7w:
s_sleep 1
ds_read_b32 v247, v253 offset:12
s_waitcnt lgkmcnt(0)
v_readfirstlane_b32 s43, v247
s_cmp_eq_u32 s76, 0
s_cbranch_scc1 Lev7
s_sub_u32 s76, s76, 1
s_cmp_lt_u32 s43, 32
s_cbranch_scc1 Lev7w
Lev7:
v_lshrrev_b32 v145, 18, v145
ds_read_b128 v[220:223], v248 offset:35840
ds_read_u16_d16_hi v145, v145
v_mfma_f32_32x32x16_bf16 v[120:135], v[112:115], v[224:227], v[120:135]
v_rcp_f16 v148, v147
v_rcp_f16_sdwa v154, v153 dst_sel:WORD_1 dst_unused:UNUSED_PRESERVE src0_sel:WORD_1
v_fma_mix_f32 v157, v136, v136, v157 op_sel:[0,0,0] op_sel_hi:[1,1,0]
v_fma_mix_f32 v157, v137, v137, v157 op_sel:[1,1,0] op_sel_hi:[1,1,0]
v_rcp_f16_sdwa v151, v150 dst_sel:WORD_1 dst_unused:UNUSED_PRESERVE src0_sel:WORD_1
v_fma_mix_f32 v157, v138, v138, v157 op_sel:[0,0,0] op_sel_hi:[1,1,0]
ds_read_b128 v[224:227], v245 offset:6528
ds_read_b128 v[192:195], v244 offset:128
ds_read_b128 v[196:199], v244 offset:64
v_mfma_f32_32x32x16_bf16 v[120:135], v[116:119], v[228:231], v[120:135]
v_rcp_f16_sdwa v148, v147 dst_sel:WORD_1 dst_unused:UNUSED_PRESERVE src0_sel:WORD_1
s_waitcnt lgkmcnt(5)
v_fma_mix_f32 v157, v139, v139, v157 op_sel:[1,1,0] op_sel_hi:[1,1,0]
v_pk_mul_f16 v155, v155, v154
v_fma_mix_f32 v157, v140, v140, v157 op_sel:[0,0,0] op_sel_hi:[1,1,0]
v_pk_mul_f16 v152, v152, v151
v_fma_mix_f32 v157, v141, v141, v157 op_sel:[1,1,0] op_sel_hi:[1,1,0]
v_pk_mul_f16 v149, v149, v148
v_fma_mix_f32 v157, v155, v155, v157 op_sel:[0,0,0] op_sel_hi:[1,1,0]
v_fma_mix_f32 v157, v142, v142, v157 op_sel:[0,0,0] op_sel_hi:[1,1,0]
v_fma_mix_f32 v157, v155, v155, v157 op_sel:[1,1,0] op_sel_hi:[1,1,0]
v_fma_mix_f32 v157, v143, v143, v157 op_sel:[1,1,0] op_sel_hi:[1,1,0]
v_fma_mix_f32 v157, v152, v152, v157 op_sel:[0,0,0] op_sel_hi:[1,1,0]
v_fma_mix_f32 v157, v152, v152, v157 op_sel:[1,1,0] op_sel_hi:[1,1,0]
v_fma_mix_f32 v157, v144, v144, v157 op_sel:[0,0,0] op_sel_hi:[1,1,0]
v_fma_mix_f32 v157, v149, v149, v157 op_sel:[0,0,0] op_sel_hi:[1,1,0]
s_waitcnt lgkmcnt(3)
v_fma_mix_f32 v157, v145, v145, v157 op_sel:[1,1,0] op_sel_hi:[1,1,0]
v_fma_mix_f32 v157, v149, v149, v157 op_sel:[1,1,0] op_sel_hi:[1,1,0]
s_setprio 1
v_mfma_f32_32x32x16_bf16 v[0:15], v[232:235], v[232:235], 0
s_add_u32 s46, s80, 18874368
buffer_store_dwordx4 v[84:87], v241, s[32:35], s46 offen sc1
ds_read_b128 v[228:231], v248 offset:38912
v_cvt_pkrtz_f16_f32 v137, v120, v121
v_cvt_pkrtz_f16_f32 v139, v122, v123
v_cvt_pkrtz_f16_f32 v141, v124, v125
v_cvt_pkrtz_f16_f32 v143, v126, v127
v_mfma_f32_32x32x16_bf16 v[16:31], v[232:235], v[232:235], 0
v_cvt_pk_f16_f32 v155, v128, v129
v_cvt_pk_f16_f32 v152, v130, v131
v_cvt_pk_f16_f32 v149, v132, v133
v_cvt_pk_f16_f32 v146, v134, v135
v_mfma_f32_32x32x16_bf16 v[32:47], v[232:235], v[232:235], 0
v_pk_fma_f16 v154, v155, v155, s48
v_and_b32_e64 v137, s49, v137
v_pk_fma_f16 v151, v152, v152, s48
v_pk_fma_f16 v148, v149, v149, s48
v_mfma_f32_32x32x16_bf16 v[120:135], v[96:99], v[236:239], 0
ds_read_b128 v[232:235], v248 offset:36864
v_and_b32_e64 v139, s49, v139
v_pk_fma_f16 v145, v146, v146, s48
v_pk_mul_f16 v154, v155, v154
v_bfe_u32 v136, v137, 2, 14
v_pk_mul_f16 v151, v152, v151
v_pk_mul_f16 v148, v149, v148
v_bfe_u32 v138, v139, 2, 14
v_pk_mul_f16 v145, v146, v145
v_mfma_f32_32x32x16_bf16 v[120:135], v[100:103], v[216:219], v[120:135]
ds_read_b128 v[236:239], v245 offset:6144
ds_read_b128 v[200:203], v244
ds_read_b128 v[204:207], v243 offset:128
ds_read_u16_d16 v136, v136
ds_read_u16_d16 v138, v138
v_exp_f16 v153, v154
v_lshrrev_b32 v137, 18, v137
v_exp_f16 v150, v151
v_lshrrev_b32 v139, 18, v139
v_exp_f16_e64 v147, v148
v_mfma_f32_32x32x16_bf16 v[120:135], v[104:107], v[220:223], v[120:135]
ds_read_b128 v[216:219], v248 offset:39936
ds_read_u16_d16_hi v137, v137
ds_read_u16_d16_hi v139, v139
v_and_b32 v141, s49, v141
v_exp_f16 v144, v145
v_and_b32 v143, s49, v143
v_exp_f16_sdwa v153, v154 dst_sel:WORD_1 dst_unused:UNUSED_PRESERVE src0_sel:WORD_1
v_bfe_u32 v140, v141, 2, 14
s_waitcnt lgkmcnt(8)
v_smfmac_f32_16x16x32_bf16 v[40:43], v[226:227], v[192:195], v246
ds_read_b128 v[220:223], v245 offset:5760
ds_read_b128 v[208:211], v243 offset:64
ds_read_b128 v[212:215], v243
ds_read_u16_d16 v140, v140
v_exp_f16_sdwa v150, v151 dst_sel:WORD_1 dst_unused:UNUSED_PRESERVE src0_sel:WORD_1
v_bfe_u32 v142, v143, 2, 14
v_exp_f16_sdwa v147, v148 dst_sel:WORD_1 dst_unused:UNUSED_PRESERVE src0_sel:WORD_1
v_smfmac_f32_16x16x32_bf16 v[24:27], v[224:225], v[196:199], v246
v_lshrrev_b32_e64 v141, 18, v141
v_exp_f16_sdwa v144, v145 dst_sel:WORD_1 dst_unused:UNUSED_PRESERVE src0_sel:WORD_1
v_lshrrev_b32_e64 v143, 18, v143
v_mfma_f32_32x32x16_bf16 v[120:135], v[108:111], v[228:231], v[120:135]
ds_read_b128 v[224:227], v245 offset:5376
ds_read_b128 v[192:195], v242 offset:128
ds_read_b128 v[196:199], v242 offset:64
ds_read_u16_d16 v142, v142
ds_read_u16_d16_hi v141, v141
ds_read_u16_d16_hi v143, v143
v_pk_add_f16 v153, v153, 1.0 op_sel_hi:[1,0]
v_pk_add_f16 v150, v150, 1.0 op_sel_hi:[1,0]
v_pk_add_f16 v147, v147, 1.0 op_sel_hi:[1,0]
v_pk_add_f16 v144, v144, 1.0 op_sel_hi:[1,0]
v_rcp_f16 v154, v153
v_rcp_f16 v151, v150
v_mfma_f32_32x32x16_bf16 v[120:135], v[112:115], v[232:235], v[120:135]
ds_read_b128 v[228:231], v248 offset:40960
v_rcp_f16 v148, v147
v_rcp_f16 v145, v144
v_rcp_f16_sdwa v154, v153 dst_sel:WORD_1 dst_unused:UNUSED_PRESERVE src0_sel:WORD_1
v_rcp_f16_sdwa v151, v150 dst_sel:WORD_1 dst_unused:UNUSED_PRESERVE src0_sel:WORD_1
s_setprio 0
s_waitcnt lgkmcnt(7)
v_smfmac_f32_16x16x32_bf16 v[8:11], v[238:239], v[200:203], v246
ds_read_b128 v[232:235], v248 offset:44032
v_rcp_f16_sdwa v148, v147 dst_sel:WORD_1 dst_unused:UNUSED_PRESERVE src0_sel:WORD_1
v_fma_mix_f32 v158, v136, v136, v158 op_sel:[0,0,0] op_sel_hi:[1,1,0]
v_smfmac_f32_16x16x32_bf16 v[40:43], v[236:237], v[204:207], v246
v_rcp_f16_sdwa v145, v144 dst_sel:WORD_1 dst_unused:UNUSED_PRESERVE src0_sel:WORD_1
v_fma_mix_f32 v158, v137, v137, v158 op_sel:[1,1,0] op_sel_hi:[1,1,0]
v_pk_mul_f16 v155, v155, v154
v_fma_mix_f32 v158, v138, v138, v158 op_sel:[0,0,0] op_sel_hi:[1,1,0]
v_mfma_f32_32x32x16_bf16 v[120:135], v[116:119], v[216:219], v[120:135]
ds_read_b128 v[236:239], v248 offset:41984
v_pk_mul_f16 v152, v152, v151
v_pk_mul_f16 v149, v149, v148
v_fma_mix_f32 v158, v139, v139, v158 op_sel:[1,1,0] op_sel_hi:[1,1,0]
v_pk_mul_f16 v146, v146, v145
v_fma_mix_f32 v158, v155, v155, v158 op_sel:[0,0,0] op_sel_hi:[1,1,0]
v_fma_mix_f32 v158, v140, v140, v158 op_sel:[0,0,0] op_sel_hi:[1,1,0]
v_fma_mix_f32 v158, v155, v155, v158 op_sel:[1,1,0] op_sel_hi:[1,1,0]
v_fma_mix_f32 v158, v152, v152, v158 op_sel:[0,0,0] op_sel_hi:[1,1,0]
v_smfmac_f32_16x16x32_bf16 v[24:27], v[222:223], v[208:211], v246
ds_read_b128 v[216:219], v248 offset:45056
s_waitcnt lgkmcnt(3)
v_fma_mix_f32 v158, v141, v141, v158 op_sel:[1,1,0] op_sel_hi:[1,1,0]
v_fma_mix_f32 v158, v152, v152, v158 op_sel:[1,1,0] op_sel_hi:[1,1,0]
v_fma_mix_f32 v158, v149, v149, v158 op_sel:[0,0,0] op_sel_hi:[1,1,0]
v_fma_mix_f32 v158, v142, v142, v158 op_sel:[0,0,0] op_sel_hi:[1,1,0]
v_smfmac_f32_16x16x32_bf16 v[8:11], v[220:221], v[212:215], v246
v_fma_mix_f32 v158, v149, v149, v158 op_sel:[1,1,0] op_sel_hi:[1,1,0]
v_fma_mix_f32 v158, v146, v146, v158 op_sel:[0,0,0] op_sel_hi:[1,1,0]
v_fma_mix_f32 v158, v143, v143, v158 op_sel:[1,1,0] op_sel_hi:[1,1,0]
v_fma_mix_f32 v158, v146, v146, v158 op_sel:[1,1,0] op_sel_hi:[1,1,0]
s_setprio 2
v_smfmac_f32_16x16x32_bf16 v[40:43], v[226:227], v[192:195], v246
s_add_u32 s46, s80, 20971520
buffer_store_dwordx4 v[88:91], v241, s[32:35], s46 offen sc1
ds_read_b128 v[220:223], v248 offset:43008
v_cvt_pkrtz_f16_f32 v137, v120, v121
v_cvt_pkrtz_f16_f32 v139, v122, v123
v_cvt_pkrtz_f16_f32 v141, v124, v125
v_cvt_pkrtz_f16_f32 v143, v126, v127
v_smfmac_f32_16x16x32_bf16 v[24:27], v[224:225], v[196:199], v246
v_cvt_pkrtz_f16_f32 v145, v128, v129
v_cvt_pk_f16_f32 v155, v130, v131
v_cvt_pk_f16_f32 v152, v132, v133
v_cvt_pk_f16_f32 v149, v134, v135
v_mfma_f32_32x32x16_bf16 v[120:135], v[96:99], v[228:231], 0
ds_read_b128 v[224:227], v245 offset:4992
ds_read_b128 v[200:203], v242
v_xor_b32 v244, 16, v244
ds_read_b128 v[204:207], v244 offset:128
v_pk_fma_f16 v154, v155, v155, s48
v_and_b32 v137, s49, v137
v_pk_fma_f16 v151, v152, v152, s48
v_and_b32 v139, s49, v139
v_pk_fma_f16 v148, v149, v149, s48
v_pk_mul_f16 v154, v155, v154
v_bfe_u32 v136, v137, 2, 14
v_pk_mul_f16 v151, v152, v151
s_waitcnt lgkmcnt(4)
v_mfma_f32_32x32x16_bf16 v[120:135], v[100:103], v[232:235], v[120:135]
ds_read_b128 v[228:231], v248 offset:46080
ds_read_u16_d16 v136, v136
v_pk_mul_f16 v148, v149, v148
v_bfe_u32 v138, v139, 2, 14
v_exp_f16 v153, v154
v_lshrrev_b32 v137, 18, v137
v_exp_f16 v150, v151
v_lshrrev_b32 v139, 18, v139
v_mfma_f32_32x32x16_bf16 v[120:135], v[104:107], v[236:239], v[120:135]
ds_read_b128 v[232:235], v245 offset:4608
ds_read_b128 v[208:211], v244 offset:64
ds_read_b128 v[212:215], v244
ds_read_u16_d16 v138, v138
ds_read_u16_d16_hi v137, v137
ds_read_u16_d16_hi v139, v139
v_exp_f16 v147, v148
v_and_b32 v141, s49, v141
v_and_b32 v143, s49, v143
v_exp_f16_sdwa v153, v154 dst_sel:WORD_1 dst_unused:UNUSED_PRESERVE src0_sel:WORD_1
v_bfe_u32 v140, v141, 2, 14
v_exp_f16_sdwa v150, v151 dst_sel:WORD_1 dst_unused:UNUSED_PRESERVE src0_sel:WORD_1
v_mfma_f32_32x32x16_bf16 v[120:135], v[108:111], v[216:219], v[120:135]
ds_read_b128 v[236:239], v245 offset:4224
v_xor_b32 v243, 16, v243
ds_read_b128 v[192:195], v243 offset:128
ds_read_b128 v[196:199], v243 offset:64
ds_read_u16_d16 v140, v140
v_bfe_u32 v142, v143, 2, 14
v_exp_f16_sdwa v147, v148 dst_sel:WORD_1 dst_unused:UNUSED_PRESERVE src0_sel:WORD_1
v_lshrrev_b32_e64 v141, 18, v141
v_pk_add_f16 v153, v153, 1.0 op_sel_hi:[1,0]
v_lshrrev_b32 v143, 18, v143
v_pk_add_f16 v150, v150, 1.0 op_sel_hi:[1,0]
v_pk_add_f16 v147, v147, 1.0 op_sel_hi:[1,0]
s_waitcnt lgkmcnt(9)
v_mfma_f32_32x32x16_bf16 v[120:135], v[112:115], v[220:223], v[120:135]
ds_read_b128 v[216:219], v248 offset:47104
ds_read_u16_d16 v142, v142
ds_read_u16_d16_hi v141, v141
ds_read_u16_d16_hi v143, v143
v_and_b32 v145, s49, v145
v_rcp_f16 v154, v153
v_bfe_u32 v144, v145, 2, 14
v_rcp_f16 v151, v150
v_lshrrev_b32 v145, 18, v145
v_rcp_f16_e64 v148, v147
v_smfmac_f32_16x16x32_bf16 v[8:11], v[226:227], v[200:203], v246
ds_read_b128 v[220:223], v248 offset:50176
ds_read_u16_d16 v144, v144
ds_read_u16_d16_hi v145, v145
v_rcp_f16_sdwa v154, v153 dst_sel:WORD_1 dst_unused:UNUSED_PRESERVE src0_sel:WORD_1
v_fma_mix_f32 v159, v136, v136, v159 op_sel:[0,0,0] op_sel_hi:[1,1,0]
s_waitcnt lgkmcnt(7)
v_fma_mix_f32 v159, v137, v137, v159 op_sel:[1,1,0] op_sel_hi:[1,1,0]
v_smfmac_f32_16x16x32_bf16 v[44:47], v[224:225], v[204:207], v246
v_rcp_f16_sdwa v151, v150 dst_sel:WORD_1 dst_unused:UNUSED_PRESERVE src0_sel:WORD_1
v_fma_mix_f32 v159, v138, v138, v159 op_sel:[0,0,0] op_sel_hi:[1,1,0]
v_mfma_f32_32x32x16_bf16 v[120:135], v[116:119], v[228:231], v[120:135]
ds_read_b128 v[224:227], v248 offset:48128
v_rcp_f16_sdwa v148, v147 dst_sel:WORD_1 dst_unused:UNUSED_PRESERVE src0_sel:WORD_1
v_fma_mix_f32 v159, v139, v139, v159 op_sel:[1,1,0] op_sel_hi:[1,1,0]
v_pk_mul_f16 v155, v155, v154
v_fma_mix_f32 v159, v140, v140, v159 op_sel:[0,0,0] op_sel_hi:[1,1,0]
v_pk_mul_f16 v152, v152, v151
s_waitcnt lgkmcnt(4)
v_fma_mix_f32 v159, v141, v141, v159 op_sel:[1,1,0] op_sel_hi:[1,1,0]
v_pk_mul_f16 v149, v149, v148
v_fma_mix_f32 v159, v155, v155, v159 op_sel:[0,0,0] op_sel_hi:[1,1,0]
v_smfmac_f32_16x16x32_bf16 v[28:31], v[234:235], v[208:211], v246
ds_read_b128 v[228:231], v248 offset:51200
v_fma_mix_f32 v159, v142, v142, v159 op_sel:[0,0,0] op_sel_hi:[1,1,0]
v_fma_mix_f32 v159, v155, v155, v159 op_sel:[1,1,0] op_sel_hi:[1,1,0]
v_fma_mix_f32 v159, v143, v143, v159 op_sel:[1,1,0] op_sel_hi:[1,1,0]
v_fma_mix_f32 v159, v152, v152, v159 op_sel:[0,0,0] op_sel_hi:[1,1,0]
v_smfmac_f32_16x16x32_bf16 v[12:15], v[232:233], v[212:215], v246
v_fma_mix_f32 v159, v152, v152, v159 op_sel:[1,1,0] op_sel_hi:[1,1,0]
s_waitcnt lgkmcnt(2)
v_fma_mix_f32 v159, v144, v144, v159 op_sel:[0,0,0] op_sel_hi:[1,1,0]
v_fma_mix_f32 v159, v149, v149, v159 op_sel:[0,0,0] op_sel_hi:[1,1,0]
v_fma_mix_f32 v159, v145, v145, v159 op_sel:[1,1,0] op_sel_hi:[1,1,0]
v_fma_mix_f32 v159, v149, v149, v159 op_sel:[1,1,0] op_sel_hi:[1,1,0]
s_setprio 1
v_smfmac_f32_16x16x32_bf16 v[44:47], v[238:239], v[192:195], v246
s_add_u32 s46, s80, 23068672
buffer_store_dwordx4 v[92:95], v241, s[32:35], s46 offen sc1
ds_read_b128 v[232:235], v248 offset:49152
v_cvt_pkrtz_f16_f32 v137, v120, v121
v_cvt_pkrtz_f16_f32 v139, v122, v123
v_cvt_pkrtz_f16_f32 v141, v124, v125
v_cvt_pkrtz_f16_f32 v143, v126, v127
v_cvt_pk_f16_f32 v155, v128, v129
v_smfmac_f32_16x16x32_bf16 v[28:31], v[236:237], v[196:199], v246
v_cvt_pk_f16_f32 v152, v130, v131
v_cvt_pk_f16_f32 v149, v132, v133
v_cvt_pk_f16_f32 v146, v134, v135
v_pk_fma_f16 v154, v155, v155, s48
v_and_b32_e64 v137, s49, v137
v_mfma_f32_32x32x16_bf16 v[120:135], v[96:99], v[216:219], 0
ds_read_b128 v[236:239], v248 offset:52224
v_pk_fma_f16 v151, v152, v152, s48
v_pk_fma_f16 v148, v149, v149, s48
v_and_b32_e64 v139, s49, v139
v_pk_fma_f16 v145, v146, v146, s48
v_pk_mul_f16 v154, v155, v154
v_bfe_u32 v136, v137, 2, 14
v_pk_mul_f16 v151, v152, v151
v_pk_mul_f16 v148, v149, v148
v_bfe_u32 v138, v139, 2, 14
v_pk_mul_f16 v145, v146, v145
v_mfma_f32_32x32x16_bf16 v[120:135], v[100:103], v[220:223], v[120:135]
ds_read_b128 v[216:219], v245 offset:3840
ds_read_b128 v[200:203], v243
v_xor_b32 v242, 16, v242
ds_read_b128 v[204:207], v242 offset:128
ds_read_u16_d16 v136, v136
ds_read_u16_d16 v138, v138
v_exp_f16 v153, v154
v_lshrrev_b32 v137, 18, v137
v_exp_f16 v150, v151
v_lshrrev_b32 v139, 18, v139
v_exp_f16 v147, v148
v_and_b32_e64 v141, s49, v141
v_exp_f16 v144, v145
s_waitcnt lgkmcnt(5)
v_mfma_f32_32x32x16_bf16 v[120:135], v[104:107], v[224:227], v[120:135]
ds_read_b128 v[220:223], v245 offset:3456
ds_read_b128 v[208:211], v242 offset:64
ds_read_b128 v[212:215], v242
ds_read_u16_d16_hi v137, v137
ds_read_u16_d16_hi v139, v139
v_and_b32_e64 v143, s49, v143
v_exp_f16_sdwa v153, v154 dst_sel:WORD_1 dst_unused:UNUSED_PRESERVE src0_sel:WORD_1
v_bfe_u32 v140, v141, 2, 14
v_exp_f16_sdwa v150, v151 dst_sel:WORD_1 dst_unused:UNUSED_PRESERVE src0_sel:WORD_1
v_bfe_u32 v142, v143, 2, 14
v_exp_f16_sdwa v147, v148 dst_sel:WORD_1 dst_unused:UNUSED_PRESERVE src0_sel:WORD_1
v_lshrrev_b32_e64 v141, 18, v141
v_mfma_f32_32x32x16_bf16 v[120:135], v[108:111], v[228:231], v[120:135]
ds_read_b128 v[224:227], v248 offset:53248
ds_read_u16_d16 v140, v140
ds_read_u16_d16 v142, v142
ds_read_u16_d16_hi v141, v141
v_exp_f16_sdwa v144, v145 dst_sel:WORD_1 dst_unused:UNUSED_PRESERVE src0_sel:WORD_1
v_lshrrev_b32_e64 v143, 18, v143
v_pk_add_f16 v153, v153, 1.0 op_sel_hi:[1,0]
v_pk_add_f16 v150, v150, 1.0 op_sel_hi:[1,0]
v_pk_add_f16 v147, v147, 1.0 op_sel_hi:[1,0]
v_pk_add_f16 v144, v144, 1.0 op_sel_hi:[1,0]
v_rcp_f16 v154, v153
v_rcp_f16 v151, v150
v_mfma_f32_32x32x16_bf16 v[120:135], v[112:115], v[232:235], v[120:135]
ds_read_b128 v[228:231], v248 offset:56320
ds_read_u16_d16_hi v143, v143
v_rcp_f16_e64 v148, v147
v_rcp_f16 v145, v144
v_rcp_f16_sdwa v154, v153 dst_sel:WORD_1 dst_unused:UNUSED_PRESERVE src0_sel:WORD_1
v_rcp_f16_sdwa v151, v150 dst_sel:WORD_1 dst_unused:UNUSED_PRESERVE src0_sel:WORD_1
s_setprio 0
v_rcp_f16_sdwa v148, v147 dst_sel:WORD_1 dst_unused:UNUSED_PRESERVE src0_sel:WORD_1
s_waitcnt lgkmcnt(6)
v_fma_mix_f32 v160, v136, v136, v160 op_sel:[0,0,0] op_sel_hi:[1,1,0]
v_mfma_f32_32x32x16_bf16 v[120:135], v[116:119], v[236:239], v[120:135]
ds_read_b128 v[232:235], v248 offset:54272
v_rcp_f16_sdwa v145, v144 dst_sel:WORD_1 dst_unused:UNUSED_PRESERVE src0_sel:WORD_1
v_fma_mix_f32 v160, v137, v137, v160 op_sel:[1,1,0] op_sel_hi:[1,1,0]
v_pk_mul_f16 v155, v155, v154
v_fma_mix_f32 v160, v138, v138, v160 op_sel:[0,0,0] op_sel_hi:[1,1,0]
v_pk_mul_f16 v152, v152, v151
v_pk_mul_f16 v149, v149, v148
v_fma_mix_f32 v160, v139, v139, v160 op_sel:[1,1,0] op_sel_hi:[1,1,0]
v_pk_mul_f16 v146, v146, v145
v_fma_mix_f32 v160, v155, v155, v160 op_sel:[0,0,0] op_sel_hi:[1,1,0]
v_smfmac_f32_16x16x32_bf16 v[12:15], v[218:219], v[200:203], v246
ds_read_b128 v[236:239], v248 offset:57344
s_waitcnt lgkmcnt(4)
v_fma_mix_f32 v160, v140, v140, v160 op_sel:[0,0,0] op_sel_hi:[1,1,0]
v_fma_mix_f32 v160, v155, v155, v160 op_sel:[1,1,0] op_sel_hi:[1,1,0]
v_fma_mix_f32 v160, v152, v152, v160 op_sel:[0,0,0] op_sel_hi:[1,1,0]
v_fma_mix_f32 v160, v141, v141, v160 op_sel:[1,1,0] op_sel_hi:[1,1,0]
v_fma_mix_f32 v160, v152, v152, v160 op_sel:[1,1,0] op_sel_hi:[1,1,0]
v_smfmac_f32_16x16x32_bf16 v[44:47], v[216:217], v[204:207], v246
v_fma_mix_f32 v160, v149, v149, v160 op_sel:[0,0,0] op_sel_hi:[1,1,0]
v_fma_mix_f32 v160, v142, v142, v160 op_sel:[0,0,0] op_sel_hi:[1,1,0]
v_fma_mix_f32 v160, v149, v149, v160 op_sel:[1,1,0] op_sel_hi:[1,1,0]
v_fma_mix_f32 v160, v146, v146, v160 op_sel:[0,0,0] op_sel_hi:[1,1,0]
s_waitcnt lgkmcnt(2)
v_fma_mix_f32 v160, v143, v143, v160 op_sel:[1,1,0] op_sel_hi:[1,1,0]
v_fma_mix_f32 v160, v146, v146, v160 op_sel:[1,1,0] op_sel_hi:[1,1,0]
s_setprio 2
v_smfmac_f32_16x16x32_bf16 v[28:31], v[222:223], v[208:211], v246
ds_read_b128 v[216:219], v248 offset:55296
v_cvt_pkrtz_f16_f32 v137, v120, v121
v_cvt_pkrtz_f16_f32 v139, v122, v123
v_cvt_pkrtz_f16_f32 v141, v124, v125
v_cvt_pkrtz_f16_f32 v143, v126, v127
v_smfmac_f32_16x16x32_bf16 v[12:15], v[220:221], v[212:215], v246
v_cvt_pkrtz_f16_f32 v145, v128, v129
v_cvt_pk_f16_f32 v155, v130, v131
v_cvt_pk_f16_f32 v152, v132, v133
v_cvt_pk_f16_f32 v149, v134, v135
v_mfma_f32_32x32x16_bf16 v[120:135], v[96:99], v[224:227], 0
ds_read_b128 v[220:223], v245 offset:3072
v_xor_b32 v244, 32, v244
ds_read_b128 v[192:195], v244 offset:128
ds_read_b128 v[196:199], v244 offset:64
v_pk_fma_f16 v154, v155, v155, s48
v_and_b32 v137, s49, v137
v_pk_fma_f16 v151, v152, v152, s48
v_and_b32_e64 v139, s49, v139
v_pk_fma_f16 v148, v149, v149, s48
v_pk_mul_f16 v154, v155, v154
v_bfe_u32 v136, v137, 2, 14
v_pk_mul_f16 v151, v152, v151
v_mfma_f32_32x32x16_bf16 v[120:135], v[100:103], v[228:231], v[120:135]
ds_read_b128 v[224:227], v248 offset:58368
ds_read_u16_d16 v136, v136
v_pk_mul_f16 v148, v149, v148
v_bfe_u32 v138, v139, 2, 14
v_exp_f16 v153, v154
v_lshrrev_b32 v137, 18, v137
v_exp_f16 v150, v151
v_lshrrev_b32 v139, 18, v139
s_waitcnt lgkmcnt(5)
v_mfma_f32_32x32x16_bf16 v[120:135], v[104:107], v[232:235], v[120:135]
ds_read_b128 v[228:231], v245 offset:2688
ds_read_b128 v[200:203], v244
v_xor_b32 v243, 32, v243
ds_read_b128 v[204:207], v243 offset:128
ds_read_u16_d16 v138, v138
ds_read_u16_d16_hi v137, v137
ds_read_u16_d16_hi v139, v139
v_exp_f16 v147, v148
v_and_b32 v141, s49, v141
v_and_b32_e64 v143, s49, v143
v_exp_f16_sdwa v153, v154 dst_sel:WORD_1 dst_unused:UNUSED_PRESERVE src0_sel:WORD_1
v_bfe_u32 v140, v141, 2, 14
v_exp_f16_sdwa v150, v151 dst_sel:WORD_1 dst_unused:UNUSED_PRESERVE src0_sel:WORD_1
v_mfma_f32_32x32x16_bf16 v[120:135], v[108:111], v[236:239], v[120:135]
ds_read_b128 v[232:235], v245 offset:2304
ds_read_b128 v[208:211], v243 offset:64
ds_read_b128 v[212:215], v243
ds_read_u16_d16 v140, v140
v_bfe_u32 v142, v143, 2, 14
v_exp_f16_sdwa v147, v148 dst_sel:WORD_1 dst_unused:UNUSED_PRESERVE src0_sel:WORD_1
v_lshrrev_b32_e64 v141, 18, v141
v_pk_add_f16 v153, v153, 1.0 op_sel_hi:[1,0]
v_lshrrev_b32_e64 v143, 18, v143
v_pk_add_f16 v150, v150, 1.0 op_sel_hi:[1,0]
v_pk_add_f16 v147, v147, 1.0 op_sel_hi:[1,0]
v_mfma_f32_32x32x16_bf16 v[120:135], v[112:115], v[216:219], v[120:135]
ds_read_b128 v[236:239], v248 offset:59392
ds_read_u16_d16 v142, v142
ds_read_u16_d16_hi v141, v141
ds_read_u16_d16_hi v143, v143
v_and_b32 v145, s49, v145
v_rcp_f16 v154, v153
v_bfe_u32 v144, v145, 2, 14
v_rcp_f16 v151, v150
v_lshrrev_b32 v145, 18, v145
v_rcp_f16 v148, v147
s_waitcnt lgkmcnt(8)
v_smfmac_f32_16x16x32_bf16 v[36:39], v[222:223], v[192:195], v246
ds_read_b128 v[216:219], v248 offset:62464
ds_read_u16_d16 v144, v144
ds_read_u16_d16_hi v145, v145
v_rcp_f16_sdwa v154, v153 dst_sel:WORD_1 dst_unused:UNUSED_PRESERVE src0_sel:WORD_1
v_fma_mix_f32 v161, v136, v136, v161 op_sel:[0,0,0] op_sel_hi:[1,1,0]
v_fma_mix_f32 v161, v137, v137, v161 op_sel:[1,1,0] op_sel_hi:[1,1,0]
v_smfmac_f32_16x16x32_bf16 v[20:23], v[220:221], v[196:199], v246
v_rcp_f16_sdwa v151, v150 dst_sel:WORD_1 dst_unused:UNUSED_PRESERVE src0_sel:WORD_1
v_fma_mix_f32 v161, v138, v138, v161 op_sel:[0,0,0] op_sel_hi:[1,1,0]
v_mfma_f32_32x32x16_bf16 v[120:135], v[116:119], v[224:227], v[120:135]
ds_read_b128 v[220:223], v248 offset:60416
v_rcp_f16_sdwa v148, v147 dst_sel:WORD_1 dst_unused:UNUSED_PRESERVE src0_sel:WORD_1
v_fma_mix_f32 v161, v139, v139, v161 op_sel:[1,1,0] op_sel_hi:[1,1,0]
v_pk_mul_f16 v155, v155, v154
s_waitcnt lgkmcnt(6)
v_fma_mix_f32 v161, v140, v140, v161 op_sel:[0,0,0] op_sel_hi:[1,1,0]
v_pk_mul_f16 v152, v152, v151
s_waitcnt lgkmcnt(4)
v_fma_mix_f32 v161, v141, v141, v161 op_sel:[1,1,0] op_sel_hi:[1,1,0]
v_pk_mul_f16 v149, v149, v148
v_fma_mix_f32 v161, v155, v155, v161 op_sel:[0,0,0] op_sel_hi:[1,1,0]
v_smfmac_f32_16x16x32_bf16 v[4:7], v[230:231], v[200:203], v246
ds_read_b128 v[224:227], v248 offset:63488
v_fma_mix_f32 v161, v142, v142, v161 op_sel:[0,0,0] op_sel_hi:[1,1,0]
v_fma_mix_f32 v161, v155, v155, v161 op_sel:[1,1,0] op_sel_hi:[1,1,0]
v_fma_mix_f32 v161, v143, v143, v161 op_sel:[1,1,0] op_sel_hi:[1,1,0]
v_fma_mix_f32 v161, v152, v152, v161 op_sel:[0,0,0] op_sel_hi:[1,1,0]
v_smfmac_f32_16x16x32_bf16 v[36:39], v[228:229], v[204:207], v246
v_fma_mix_f32 v161, v152, v152, v161 op_sel:[1,1,0] op_sel_hi:[1,1,0]
s_waitcnt lgkmcnt(2)
v_fma_mix_f32 v161, v144, v144, v161 op_sel:[0,0,0] op_sel_hi:[1,1,0]
v_fma_mix_f32 v161, v149, v149, v161 op_sel:[0,0,0] op_sel_hi:[1,1,0]
v_fma_mix_f32 v161, v145, v145, v161 op_sel:[1,1,0] op_sel_hi:[1,1,0]
v_fma_mix_f32 v161, v149, v149, v161 op_sel:[1,1,0] op_sel_hi:[1,1,0]
s_setprio 1
v_smfmac_f32_16x16x32_bf16 v[20:23], v[234:235], v[208:211], v246
ds_read_b128 v[228:231], v248 offset:61440
v_cvt_pkrtz_f16_f32 v137, v120, v121
v_cvt_pkrtz_f16_f32 v139, v122, v123
v_cvt_pkrtz_f16_f32 v141, v124, v125
v_cvt_pkrtz_f16_f32 v143, v126, v127
v_cvt_pk_f16_f32 v155, v128, v129
v_smfmac_f32_16x16x32_bf16 v[4:7], v[232:233], v[212:215], v246
v_cvt_pk_f16_f32 v152, v130, v131
v_cvt_pk_f16_f32 v149, v132, v133
v_cvt_pk_f16_f32 v146, v134, v135
v_pk_fma_f16 v154, v155, v155, s48
v_and_b32_e64 v137, s49, v137
v_mfma_f32_32x32x16_bf16 v[120:135], v[96:99], v[236:239], 0
ds_read_b128 v[232:235], v248 offset:64512
v_pk_fma_f16 v151, v152, v152, s48
v_pk_fma_f16 v148, v149, v149, s48
v_and_b32_e64 v139, s49, v139
v_pk_fma_f16 v145, v146, v146, s48
v_pk_mul_f16 v154, v155, v154
v_bfe_u32 v136, v137, 2, 14
v_pk_mul_f16 v151, v152, v151
v_pk_mul_f16 v148, v149, v148
v_bfe_u32 v138, v139, 2, 14
v_pk_mul_f16 v145, v146, v145
v_mfma_f32_32x32x16_bf16 v[120:135], v[100:103], v[216:219], v[120:135]
ds_read_b128 v[236:239], v245 offset:1920
v_xor_b32 v242, 32, v242
ds_read_b128 v[192:195], v242 offset:128
ds_read_b128 v[196:199], v242 offset:64
ds_read_u16_d16 v136, v136
ds_read_u16_d16 v138, v138
v_exp_f16 v153, v154
v_lshrrev_b32 v137, 18, v137
v_exp_f16 v150, v151
v_lshrrev_b32 v139, 18, v139
v_exp_f16 v147, v148
v_and_b32 v141, s49, v141
v_exp_f16 v144, v145
s_waitcnt lgkmcnt(5)
v_mfma_f32_32x32x16_bf16 v[120:135], v[104:107], v[220:223], v[120:135]
ds_read_b128 v[216:219], v245 offset:1536
ds_read_b128 v[200:203], v242
v_xor_b32 v244, 16, v244
ds_read_b128 v[204:207], v244 offset:128
ds_read_u16_d16_hi v137, v137
ds_read_u16_d16_hi v139, v139
v_and_b32_e64 v143, s49, v143
v_exp_f16_sdwa v153, v154 dst_sel:WORD_1 dst_unused:UNUSED_PRESERVE src0_sel:WORD_1
v_bfe_u32 v140, v141, 2, 14
v_exp_f16_sdwa v150, v151 dst_sel:WORD_1 dst_unused:UNUSED_PRESERVE src0_sel:WORD_1
v_bfe_u32 v142, v143, 2, 14
v_exp_f16_sdwa v147, v148 dst_sel:WORD_1 dst_unused:UNUSED_PRESERVE src0_sel:WORD_1
v_lshrrev_b32_e64 v141, 18, v141
v_mfma_f32_32x32x16_bf16 v[120:135], v[108:111], v[224:227], v[120:135]
ds_read_b128 v[220:223], v249
ds_read_u16_d16 v140, v140
ds_read_u16_d16 v142, v142
ds_read_u16_d16_hi v141, v141
v_exp_f16_sdwa v144, v145 dst_sel:WORD_1 dst_unused:UNUSED_PRESERVE src0_sel:WORD_1
v_lshrrev_b32_e64 v143, 18, v143
v_pk_add_f16 v153, v153, 1.0 op_sel_hi:[1,0]
v_pk_add_f16 v150, v150, 1.0 op_sel_hi:[1,0]
v_pk_add_f16 v147, v147, 1.0 op_sel_hi:[1,0]
v_pk_add_f16 v144, v144, 1.0 op_sel_hi:[1,0]
v_rcp_f16 v154, v153
v_rcp_f16 v151, v150
v_mfma_f32_32x32x16_bf16 v[120:135], v[112:115], v[228:231], v[120:135]
ds_read_b128 v[224:227], v249 offset:3072
ds_read_u16_d16_hi v143, v143
v_rcp_f16_e64 v148, v147
v_rcp_f16 v145, v144
v_rcp_f16_sdwa v154, v153 dst_sel:WORD_1 dst_unused:UNUSED_PRESERVE src0_sel:WORD_1
v_rcp_f16_sdwa v151, v150 dst_sel:WORD_1 dst_unused:UNUSED_PRESERVE src0_sel:WORD_1
s_setprio 0
v_rcp_f16_sdwa v148, v147 dst_sel:WORD_1 dst_unused:UNUSED_PRESERVE src0_sel:WORD_1
s_waitcnt lgkmcnt(6)
v_fma_mix_f32 v162, v136, v136, v162 op_sel:[0,0,0] op_sel_hi:[1,1,0]
v_mfma_f32_32x32x16_bf16 v[120:135], v[116:119], v[232:235], v[120:135]
ds_read_b128 v[228:231], v249 offset:1024
v_rcp_f16_sdwa v145, v144 dst_sel:WORD_1 dst_unused:UNUSED_PRESERVE src0_sel:WORD_1
v_fma_mix_f32 v162, v137, v137, v162 op_sel:[1,1,0] op_sel_hi:[1,1,0]
v_pk_mul_f16 v155, v155, v154
v_fma_mix_f32 v162, v138, v138, v162 op_sel:[0,0,0] op_sel_hi:[1,1,0]
v_pk_mul_f16 v152, v152, v151
v_pk_mul_f16 v149, v149, v148
v_fma_mix_f32 v162, v139, v139, v162 op_sel:[1,1,0] op_sel_hi:[1,1,0]
v_pk_mul_f16 v146, v146, v145
v_fma_mix_f32 v162, v155, v155, v162 op_sel:[0,0,0] op_sel_hi:[1,1,0]
v_smfmac_f32_16x16x32_bf16 v[36:39], v[238:239], v[192:195], v246
ds_read_b128 v[232:235], v249 offset:4096
s_waitcnt lgkmcnt(4)
v_fma_mix_f32 v162, v140, v140, v162 op_sel:[0,0,0] op_sel_hi:[1,1,0]
v_fma_mix_f32 v162, v155, v155, v162 op_sel:[1,1,0] op_sel_hi:[1,1,0]
v_fma_mix_f32 v162, v152, v152, v162 op_sel:[0,0,0] op_sel_hi:[1,1,0]
v_fma_mix_f32 v162, v141, v141, v162 op_sel:[1,1,0] op_sel_hi:[1,1,0]
v_fma_mix_f32 v162, v152, v152, v162 op_sel:[1,1,0] op_sel_hi:[1,1,0]
v_smfmac_f32_16x16x32_bf16 v[20:23], v[236:237], v[196:199], v246
v_fma_mix_f32 v162, v149, v149, v162 op_sel:[0,0,0] op_sel_hi:[1,1,0]
v_fma_mix_f32 v162, v142, v142, v162 op_sel:[0,0,0] op_sel_hi:[1,1,0]
v_fma_mix_f32 v162, v149, v149, v162 op_sel:[1,1,0] op_sel_hi:[1,1,0]
v_fma_mix_f32 v162, v146, v146, v162 op_sel:[0,0,0] op_sel_hi:[1,1,0]
s_waitcnt lgkmcnt(2)
v_fma_mix_f32 v162, v143, v143, v162 op_sel:[1,1,0] op_sel_hi:[1,1,0]
v_fma_mix_f32 v162, v146, v146, v162 op_sel:[1,1,0] op_sel_hi:[1,1,0]
s_setprio 2
v_smfmac_f32_16x16x32_bf16 v[4:7], v[218:219], v[200:203], v246
ds_read_b128 v[236:239], v249 offset:2048
v_cvt_pkrtz_f16_f32 v137, v120, v121
v_cvt_pkrtz_f16_f32 v139, v122, v123
v_cvt_pkrtz_f16_f32 v141, v124, v125
v_cvt_pkrtz_f16_f32 v143, v126, v127
v_smfmac_f32_16x16x32_bf16 v[32:35], v[216:217], v[204:207], v246
v_cvt_pkrtz_f16_f32 v145, v128, v129
v_cvt_pk_f16_f32 v155, v130, v131
v_cvt_pk_f16_f32 v152, v132, v133
v_cvt_pk_f16_f32 v149, v134, v135
v_mfma_f32_32x32x16_bf16 v[120:135], v[96:99], v[220:223], 0
ds_read_b128 v[216:219], v245 offset:1152
ds_read_b128 v[208:211], v244 offset:64
ds_read_b128 v[212:215], v244
v_pk_fma_f16 v154, v155, v155, s48
v_and_b32_e64 v137, s49, v137
v_pk_fma_f16 v151, v152, v152, s48
v_and_b32_e64 v139, s49, v139
v_pk_fma_f16 v148, v149, v149, s48
v_pk_mul_f16 v154, v155, v154
v_bfe_u32 v136, v137, 2, 14
v_pk_mul_f16 v151, v152, v151
v_mfma_f32_32x32x16_bf16 v[120:135], v[100:103], v[224:227], v[120:135]
ds_read_b128 v[220:223], v249 offset:5120
ds_read_u16_d16 v136, v136
v_pk_mul_f16 v148, v149, v148
v_bfe_u32 v138, v139, 2, 14
v_exp_f16 v153, v154
v_lshrrev_b32 v137, 18, v137
v_exp_f16 v150, v151
v_lshrrev_b32 v139, 18, v139
s_waitcnt lgkmcnt(5)
v_mfma_f32_32x32x16_bf16 v[120:135], v[104:107], v[228:231], v[120:135]
ds_read_b128 v[224:227], v245 offset:768
v_xor_b32 v243, 16, v243
ds_read_b128 v[192:195], v243 offset:128
ds_read_b128 v[196:199], v243 offset:64
ds_read_u16_d16 v138, v138
ds_read_u16_d16_hi v137, v137
ds_read_u16_d16_hi v139, v139
v_exp_f16 v147, v148
v_and_b32 v141, s49, v141
v_and_b32_e64 v143, s49, v143
v_exp_f16_sdwa v153, v154 dst_sel:WORD_1 dst_unused:UNUSED_PRESERVE src0_sel:WORD_1
v_bfe_u32 v140, v141, 2, 14
v_exp_f16_sdwa v150, v151 dst_sel:WORD_1 dst_unused:UNUSED_PRESERVE src0_sel:WORD_1
v_mfma_f32_32x32x16_bf16 v[120:135], v[108:111], v[232:235], v[120:135]
ds_read_b128 v[228:231], v245 offset:384
ds_read_b128 v[200:203], v243
v_xor_b32 v242, 16, v242
ds_read_b128 v[204:207], v242 offset:128
ds_read_u16_d16 v140, v140
v_bfe_u32 v142, v143, 2, 14
v_exp_f16_sdwa v147, v148 dst_sel:WORD_1 dst_unused:UNUSED_PRESERVE src0_sel:WORD_1
v_lshrrev_b32 v141, 18, v141
v_pk_add_f16 v153, v153, 1.0 op_sel_hi:[1,0]
v_lshrrev_b32_e64 v143, 18, v143
v_pk_add_f16 v150, v150, 1.0 op_sel_hi:[1,0]
v_pk_add_f16 v147, v147, 1.0 op_sel_hi:[1,0]
v_mfma_f32_32x32x16_bf16 v[120:135], v[112:115], v[236:239], v[120:135]
ds_read_b128 v[232:235], v249 offset:6144
ds_read_u16_d16 v142, v142
ds_read_u16_d16_hi v141, v141
ds_read_u16_d16_hi v143, v143
v_and_b32 v145, s49, v145
v_rcp_f16 v154, v153
v_bfe_u32 v144, v145, 2, 14
v_rcp_f16 v151, v150
v_lshrrev_b32 v145, 18, v145
v_rcp_f16 v148, v147
s_waitcnt lgkmcnt(8)
v_smfmac_f32_16x16x32_bf16 v[16:19], v[218:219], v[208:211], v246
ds_read_b128 v[236:239], v249 offset:9216
ds_read_u16_d16 v144, v144
ds_read_u16_d16_hi v145, v145
v_rcp_f16_sdwa v154, v153 dst_sel:WORD_1 dst_unused:UNUSED_PRESERVE src0_sel:WORD_1
v_fma_mix_f32 v163, v136, v136, v163 op_sel:[0,0,0] op_sel_hi:[1,1,0]
v_fma_mix_f32 v163, v137, v137, v163 op_sel:[1,1,0] op_sel_hi:[1,1,0]
v_smfmac_f32_16x16x32_bf16 v[0:3], v[216:217], v[212:215], v246
v_rcp_f16_sdwa v151, v150 dst_sel:WORD_1 dst_unused:UNUSED_PRESERVE src0_sel:WORD_1
v_fma_mix_f32 v163, v138, v138, v163 op_sel:[0,0,0] op_sel_hi:[1,1,0]
v_mfma_f32_32x32x16_bf16 v[120:135], v[116:119], v[220:223], v[120:135]
ds_read_b128 v[216:219], v249 offset:7168
v_rcp_f16_sdwa v148, v147 dst_sel:WORD_1 dst_unused:UNUSED_PRESERVE src0_sel:WORD_1
v_fma_mix_f32 v163, v139, v139, v163 op_sel:[1,1,0] op_sel_hi:[1,1,0]
v_pk_mul_f16 v155, v155, v154
s_waitcnt lgkmcnt(6)
v_fma_mix_f32 v163, v140, v140, v163 op_sel:[0,0,0] op_sel_hi:[1,1,0]
v_pk_mul_f16 v152, v152, v151
s_waitcnt lgkmcnt(4)
v_fma_mix_f32 v163, v141, v141, v163 op_sel:[1,1,0] op_sel_hi:[1,1,0]
v_pk_mul_f16 v149, v149, v148
v_fma_mix_f32 v163, v155, v155, v163 op_sel:[0,0,0] op_sel_hi:[1,1,0]
v_smfmac_f32_16x16x32_bf16 v[32:35], v[226:227], v[192:195], v246
ds_read_b128 v[220:223], v249 offset:10240
v_fma_mix_f32 v163, v142, v142, v163 op_sel:[0,0,0] op_sel_hi:[1,1,0]
v_fma_mix_f32 v163, v155, v155, v163 op_sel:[1,1,0] op_sel_hi:[1,1,0]
v_fma_mix_f32 v163, v143, v143, v163 op_sel:[1,1,0] op_sel_hi:[1,1,0]
v_fma_mix_f32 v163, v152, v152, v163 op_sel:[0,0,0] op_sel_hi:[1,1,0]
v_smfmac_f32_16x16x32_bf16 v[16:19], v[224:225], v[196:199], v246
v_fma_mix_f32 v163, v152, v152, v163 op_sel:[1,1,0] op_sel_hi:[1,1,0]
s_waitcnt lgkmcnt(2)
v_fma_mix_f32 v163, v144, v144, v163 op_sel:[0,0,0] op_sel_hi:[1,1,0]
v_fma_mix_f32 v163, v149, v149, v163 op_sel:[0,0,0] op_sel_hi:[1,1,0]
v_fma_mix_f32 v163, v145, v145, v163 op_sel:[1,1,0] op_sel_hi:[1,1,0]
v_fma_mix_f32 v163, v149, v149, v163 op_sel:[1,1,0] op_sel_hi:[1,1,0]
s_setprio 1
v_smfmac_f32_16x16x32_bf16 v[0:3], v[230:231], v[200:203], v246
ds_read_b128 v[224:227], v249 offset:8192
v_cvt_pkrtz_f16_f32 v137, v120, v121
v_cvt_pkrtz_f16_f32 v139, v122, v123
v_cvt_pkrtz_f16_f32 v141, v124, v125
v_cvt_pkrtz_f16_f32 v143, v126, v127
v_smfmac_f32_16x16x32_bf16 v[32:35], v[228:229], v[204:207], v246
v_cvt_pk_f16_f32 v155, v128, v129
v_cvt_pk_f16_f32 v152, v130, v131
v_cvt_pk_f16_f32 v149, v132, v133
v_cvt_pk_f16_f32 v146, v134, v135
v_pk_fma_f16 v154, v155, v155, s48
v_mfma_f32_32x32x16_bf16 v[120:135], v[96:99], v[232:235], 0
ds_read_b128 v[228:231], v249 offset:11264
v_and_b32_e64 v137, s49, v137
v_pk_fma_f16 v151, v152, v152, s48
v_pk_fma_f16 v148, v149, v149, s48
v_and_b32_e64 v139, s49, v139
v_pk_fma_f16 v145, v146, v146, s48
v_pk_mul_f16 v154, v155, v154
v_bfe_u32 v136, v137, 2, 14
v_pk_mul_f16 v151, v152, v151
v_pk_mul_f16 v148, v149, v148
v_bfe_u32 v138, v139, 2, 14
v_mfma_f32_32x32x16_bf16 v[120:135], v[100:103], v[236:239], v[120:135]
ds_read_b128 v[232:235], v245
ds_read_b128 v[208:211], v242 offset:64
ds_read_b128 v[212:215], v242
ds_read_u16_d16 v136, v136
ds_read_u16_d16 v138, v138
v_pk_mul_f16 v145, v146, v145
v_exp_f16 v153, v154
v_lshrrev_b32 v137, 18, v137
v_exp_f16 v150, v151
v_lshrrev_b32 v139, 18, v139
v_exp_f16 v147, v148
s_waitcnt lgkmcnt(6)
v_mfma_f32_32x32x16_bf16 v[120:135], v[104:107], v[216:219], v[120:135]
ds_read_b128 v[236:239], v249 offset:12288
ds_read_u16_d16_hi v137, v137
ds_read_u16_d16_hi v139, v139
v_and_b32 v141, s49, v141
v_exp_f16 v144, v145
v_and_b32_e64 v143, s49, v143
v_exp_f16_sdwa v153, v154 dst_sel:WORD_1 dst_unused:UNUSED_PRESERVE src0_sel:WORD_1
v_bfe_u32 v140, v141, 2, 14
v_exp_f16_sdwa v150, v151 dst_sel:WORD_1 dst_unused:UNUSED_PRESERVE src0_sel:WORD_1
v_bfe_u32 v142, v143, 2, 14
v_mfma_f32_32x32x16_bf16 v[120:135], v[108:111], v[220:223], v[120:135]
ds_read_b128 v[216:219], v249 offset:15360
ds_read_u16_d16 v140, v140
ds_read_u16_d16 v142, v142
v_exp_f16_sdwa v147, v148 dst_sel:WORD_1 dst_unused:UNUSED_PRESERVE src0_sel:WORD_1
v_lshrrev_b32_e64 v141, 18, v141
v_exp_f16_sdwa v144, v145 dst_sel:WORD_1 dst_unused:UNUSED_PRESERVE src0_sel:WORD_1
v_lshrrev_b32_e64 v143, 18, v143
v_pk_add_f16 v153, v153, 1.0 op_sel_hi:[1,0]
v_pk_add_f16 v150, v150, 1.0 op_sel_hi:[1,0]
v_pk_add_f16 v147, v147, 1.0 op_sel_hi:[1,0]
v_mfma_f32_32x32x16_bf16 v[120:135], v[112:115], v[224:227], v[120:135]
ds_read_b128 v[220:223], v249 offset:13312
ds_read_u16_d16_hi v141, v141
ds_read_u16_d16_hi v143, v143
v_pk_add_f16 v144, v144, 1.0 op_sel_hi:[1,0]
v_rcp_f16 v154, v153
v_rcp_f16 v151, v150
v_rcp_f16 v148, v147
v_rcp_f16 v145, v144
s_waitcnt lgkmcnt(6)
v_mfma_f32_32x32x16_bf16 v[120:135], v[116:119], v[228:231], v[120:135]
ds_read_b128 v[224:227], v249 offset:16384
v_rcp_f16_sdwa v154, v153 dst_sel:WORD_1 dst_unused:UNUSED_PRESERVE src0_sel:WORD_1
v_rcp_f16_sdwa v151, v150 dst_sel:WORD_1 dst_unused:UNUSED_PRESERVE src0_sel:WORD_1
s_setprio 0
v_rcp_f16_sdwa v148, v147 dst_sel:WORD_1 dst_unused:UNUSED_PRESERVE src0_sel:WORD_1
v_fma_mix_f32 v164, v136, v136, v164 op_sel:[0,0,0] op_sel_hi:[1,1,0]
v_rcp_f16_sdwa v145, v144 dst_sel:WORD_1 dst_unused:UNUSED_PRESERVE src0_sel:WORD_1
v_fma_mix_f32 v164, v137, v137, v164 op_sel:[1,1,0] op_sel_hi:[1,1,0]
v_smfmac_f32_16x16x32_bf16 v[16:19], v[234:235], v[208:211], v246
ds_read_b128 v[228:231], v249 offset:14336
v_pk_mul_f16 v155, v155, v154
v_fma_mix_f32 v164, v138, v138, v164 op_sel:[0,0,0] op_sel_hi:[1,1,0]
v_pk_mul_f16 v152, v152, v151
v_pk_mul_f16 v149, v149, v148
v_fma_mix_f32 v164, v139, v139, v164 op_sel:[1,1,0] op_sel_hi:[1,1,0]
v_smfmac_f32_16x16x32_bf16 v[0:3], v[232:233], v[212:215], v246
s_mov_b64 exec, 1
ds_add_u32 v253, v254 offset:16
s_mov_b64 exec, -1
v_pk_mul_f16 v146, v146, v145
v_fma_mix_f32 v164, v155, v155, v164 op_sel:[0,0,0] op_sel_hi:[1,1,0]
s_waitcnt lgkmcnt(3)
v_fma_mix_f32 v164, v140, v140, v164 op_sel:[0,0,0] op_sel_hi:[1,1,0]
v_fma_mix_f32 v164, v155, v155, v164 op_sel:[1,1,0] op_sel_hi:[1,1,0]
v_fma_mix_f32 v164, v152, v152, v164 op_sel:[0,0,0] op_sel_hi:[1,1,0]
v_fma_mix_f32 v164, v141, v141, v164 op_sel:[1,1,0] op_sel_hi:[1,1,0]
v_fma_mix_f32 v164, v152, v152, v164 op_sel:[1,1,0] op_sel_hi:[1,1,0]
v_fma_mix_f32 v164, v149, v149, v164 op_sel:[0,0,0] op_sel_hi:[1,1,0]
v_fma_mix_f32 v164, v142, v142, v164 op_sel:[0,0,0] op_sel_hi:[1,1,0]
v_fma_mix_f32 v164, v149, v149, v164 op_sel:[1,1,0] op_sel_hi:[1,1,0]
v_fma_mix_f32 v164, v146, v146, v164 op_sel:[0,0,0] op_sel_hi:[1,1,0]
v_fma_mix_f32 v164, v143, v143, v164 op_sel:[1,1,0] op_sel_hi:[1,1,0]
v_fma_mix_f32 v164, v146, v146, v164 op_sel:[1,1,0] op_sel_hi:[1,1,0]
s_setprio 3
v_pk_add_f32 v[168:169], v[0:1], v[2:3]
v_pk_mul_f32 v[170:171], v[0:1], v[0:1]
v_pk_fma_f32 v[170:171], v[2:3], v[2:3], v[170:171]
v_pk_add_f32 v[168:169], v[168:169], v[4:5]
v_pk_fma_f32 v[170:171], v[4:5], v[4:5], v[170:171]
v_pk_add_f32 v[168:169], v[168:169], v[6:7]
v_pk_fma_f32 v[170:171], v[6:7], v[6:7], v[170:171]
v_pk_add_f32 v[168:169], v[168:169], v[8:9]
v_pk_fma_f32 v[170:171], v[8:9], v[8:9], v[170:171]
v_pk_add_f32 v[168:169], v[168:169], v[10:11]
v_pk_fma_f32 v[170:171], v[10:11], v[10:11], v[170:171]
v_pk_add_f32 v[168:169], v[168:169], v[12:13]
v_pk_fma_f32 v[170:171], v[12:13], v[12:13], v[170:171]
v_pk_add_f32 v[168:169], v[168:169], v[14:15]
v_pk_fma_f32 v[170:171], v[14:15], v[14:15], v[170:171]
v_pk_add_f32 v[168:169], v[168:169], v[16:17]
v_pk_fma_f32 v[170:171], v[16:17], v[16:17], v[170:171]
v_pk_add_f32 v[168:169], v[168:169], v[18:19]
v_pk_fma_f32 v[170:171], v[18:19], v[18:19], v[170:171]
v_pk_add_f32 v[168:169], v[168:169], v[20:21]
v_pk_fma_f32 v[170:171], v[20:21], v[20:21], v[170:171]
v_pk_add_f32 v[168:169], v[168:169], v[22:23]
v_pk_fma_f32 v[170:171], v[22:23], v[22:23], v[170:171]
v_pk_add_f32 v[168:169], v[168:169], v[24:25]
v_pk_fma_f32 v[170:171], v[24:25], v[24:25], v[170:171]
v_pk_add_f32 v[168:169], v[168:169], v[26:27]
v_pk_fma_f32 v[170:171], v[26:27], v[26:27], v[170:171]
v_pk_add_f32 v[168:169], v[168:169], v[28:29]
v_pk_fma_f32 v[170:171], v[28:29], v[28:29], v[170:171]
v_pk_add_f32 v[168:169], v[168:169], v[30:31]
v_pk_fma_f32 v[170:171], v[30:31], v[30:31], v[170:171]
v_pk_add_f32 v[168:169], v[168:169], v[32:33]
v_pk_fma_f32 v[170:171], v[32:33], v[32:33], v[170:171]
v_pk_add_f32 v[168:169], v[168:169], v[34:35]
v_pk_fma_f32 v[170:171], v[34:35], v[34:35], v[170:171]
v_pk_add_f32 v[168:169], v[168:169], v[36:37]
v_pk_fma_f32 v[170:171], v[36:37], v[36:37], v[170:171]
v_pk_add_f32 v[168:169], v[168:169], v[38:39]
v_pk_fma_f32 v[170:171], v[38:39], v[38:39], v[170:171]
v_pk_add_f32 v[168:169], v[168:169], v[40:41]
v_pk_fma_f32 v[170:171], v[40:41], v[40:41], v[170:171]
v_pk_add_f32 v[168:169], v[168:169], v[42:43]
v_pk_fma_f32 v[170:171], v[42:43], v[42:43], v[170:171]
v_pk_add_f32 v[168:169], v[168:169], v[44:45]
v_pk_fma_f32 v[170:171], v[44:45], v[44:45], v[170:171]
v_pk_add_f32 v[168:169], v[168:169], v[46:47]
v_pk_fma_f32 v[170:171], v[46:47], v[46:47], v[170:171]
s_setprio 0
v_lshrrev_b32 v240, 2, v251
v_mul_u32_u24 v240, 192, v240
v_and_b32 v252, 3, v251
v_lshl_add_u32 v240, v252, 4, v240
s_setprio 2
v_cvt_pkrtz_f16_f32 v137, v120, v121
v_cvt_pkrtz_f16_f32 v139, v122, v123
v_cvt_pkrtz_f16_f32 v141, v124, v125
v_cvt_pkrtz_f16_f32 v143, v126, v127
v_cvt_pkrtz_f16_f32 v145, v128, v129
v_cvt_pk_f16_f32 v155, v130, v131
v_cvt_pk_f16_f32 v152, v132, v133
v_cvt_pk_f16_f32 v149, v134, v135
ds_read_b128 v[232:235], v249 offset:17408
v_mfma_f32_32x32x16_bf16 v[120:135], v[96:99], v[236:239], 0
v_pk_fma_f16 v154, v155, v155, s48
v_add_f32 v168, v168, v169
v_and_b32 v137, s49, v137
v_pk_fma_f16 v151, v152, v152, s48
v_and_b32_e64 v139, s49, v139
v_pk_fma_f16 v148, v149, v149, s48
v_add_f32_e64 v170, v170, v171
v_pk_mul_f16 v154, v155, v154
v_bfe_u32 v136, v137, 2, 14
v_pk_mul_f16 v151, v152, v151
v_pk_mul_f16 v148, v149, v148
v_bfe_u32 v138, v139, 2, 14
ds_read_b128 v[236:239], v249 offset:18432
ds_read_u16_d16 v136, v136
ds_read_u16_d16 v138, v138
v_mfma_f32_32x32x16_bf16 v[120:135], v[100:103], v[216:219], v[120:135]
v_permlane32_swap_b32 v168, v170
v_exp_f16 v153, v154
v_lshrrev_b32 v137, 18, v137
v_exp_f16 v150, v151
v_add_f32 v168, v168, v170
v_lshrrev_b32 v139, 18, v139
v_exp_f16 v147, v148
v_and_b32 v141, s49, v141
v_and_b32_e64 v143, s49, v143
v_mul_f32 v168, 1009429163, v168
ds_read_b128 v[216:219], v249 offset:21504
ds_read_u16_d16_hi v137, v137
ds_read_u16_d16_hi v139, v139
v_mfma_f32_32x32x16_bf16 v[120:135], v[104:107], v[220:223], v[120:135]
v_exp_f16_sdwa v153, v154 dst_sel:WORD_1 dst_unused:UNUSED_PRESERVE src0_sel:WORD_1
v_bfe_u32 v140, v141, 2, 14
v_exp_f16_sdwa v150, v151 dst_sel:WORD_1 dst_unused:UNUSED_PRESERVE src0_sel:WORD_1
v_mov_b32_e64 v170, v168
v_bfe_u32 v142, v143, 2, 14
v_exp_f16_sdwa v147, v148 dst_sel:WORD_1 dst_unused:UNUSED_PRESERVE src0_sel:WORD_1
v_lshrrev_b32_e64 v141, 18, v141
v_permlane32_swap_b32 v168, v170
v_pk_add_f16 v153, v153, 1.0 op_sel_hi:[1,0]
s_waitcnt lgkmcnt(8)
ds_read_b128 v[220:223], v249 offset:19456
ds_read_u16_d16 v140, v140
ds_read_u16_d16 v142, v142
ds_read_u16_d16_hi v141, v141
v_mfma_f32_32x32x16_bf16 v[120:135], v[108:111], v[224:227], v[120:135]
v_lshrrev_b32_e64 v143, 18, v143
v_pk_add_f16 v150, v150, 1.0 op_sel_hi:[1,0]
v_pk_add_f16 v147, v147, 1.0 op_sel_hi:[1,0]
v_and_b32_e64 v145, s49, v145
v_fma_f32 v170, -v168, v168, v170
v_rcp_f16_e64 v154, v153
v_bfe_u32 v144, v145, 2, 14
v_rcp_f16 v151, v150
v_max_f32 v170, 0, v170
v_lshrrev_b32_e64 v145, 18, v145
ds_read_b128 v[224:227], v249 offset:22528
ds_read_u16_d16_hi v143, v143
ds_read_u16_d16 v144, v144
ds_read_u16_d16_hi v145, v145
v_mfma_f32_32x32x16_bf16 v[120:135], v[112:115], v[228:231], v[120:135]
v_rcp_f16 v148, v147
v_rcp_f16_sdwa v154, v153 dst_sel:WORD_1 dst_unused:UNUSED_PRESERVE src0_sel:WORD_1
v_add_f32 v170, 925353388, v170
s_waitcnt lgkmcnt(8)
v_fma_mix_f32 v165, v136, v136, v165 op_sel:[0,0,0] op_sel_hi:[1,1,0]
ds_read_b32 v247, v253 offset:16
v_fma_mix_f32 v165, v137, v137, v165 op_sel:[1,1,0] op_sel_hi:[1,1,0]
v_rcp_f16_sdwa v151, v150 dst_sel:WORD_1 dst_unused:UNUSED_PRESERVE src0_sel:WORD_1
v_rsq_f32_e64 v170, v170
v_fma_mix_f32 v165, v138, v138, v165 op_sel:[0,0,0] op_sel_hi:[1,1,0]
ds_read_b128 v[228:231], v249 offset:20480
v_mfma_f32_32x32x16_bf16 v[120:135], v[116:119], v[232:235], v[120:135]
v_rcp_f16_sdwa v148, v147 dst_sel:WORD_1 dst_unused:UNUSED_PRESERVE src0_sel:WORD_1
v_fma_mix_f32 v165, v139, v139, v165 op_sel:[1,1,0] op_sel_hi:[1,1,0]
v_pk_mul_f16 v155, v155, v154
s_waitcnt lgkmcnt(6)
v_fma_mix_f32 v165, v140, v140, v165 op_sel:[0,0,0] op_sel_hi:[1,1,0]
v_pk_mul_f16 v152, v152, v151
v_fma_mix_f32 v165, v141, v141, v165 op_sel:[1,1,0] op_sel_hi:[1,1,0]
v_pk_mul_f16 v149, v149, v148
v_fma_mix_f32 v165, v155, v155, v165 op_sel:[0,0,0] op_sel_hi:[1,1,0]
v_mul_f32 v172, 3203391086, v170
v_fma_mix_f32 v165, v142, v142, v165 op_sel:[0,0,0] op_sel_hi:[1,1,0]
v_fma_mix_f32 v165, v155, v155, v165 op_sel:[1,1,0] op_sel_hi:[1,1,0]
s_waitcnt lgkmcnt(2)
v_fma_mix_f32 v165, v143, v143, v165 op_sel:[1,1,0] op_sel_hi:[1,1,0]
v_fma_mix_f32 v165, v152, v152, v165 op_sel:[0,0,0] op_sel_hi:[1,1,0]
v_fma_mix_f32 v165, v152, v152, v165 op_sel:[1,1,0] op_sel_hi:[1,1,0]
v_mul_f32 v173, v168, v172
v_fma_mix_f32 v165, v144, v144, v165 op_sel:[0,0,0] op_sel_hi:[1,1,0]
v_fma_mix_f32 v165, v149, v149, v165 op_sel:[0,0,0] op_sel_hi:[1,1,0]
v_fma_mix_f32 v165, v145, v145, v165 op_sel:[1,1,0] op_sel_hi:[1,1,0]
v_fma_mix_f32 v165, v149, v149, v165 op_sel:[1,1,0] op_sel_hi:[1,1,0]
s_setprio 3
v_pk_fma_f32 v[0:1], v[0:1], v[172:173], v[172:173] op_sel:[0,0,1] op_sel_hi:[1,0,1] neg_lo:[0,0,1] neg_hi:[0,0,1]
v_pk_fma_f32 v[2:3], v[2:3], v[172:173], v[172:173] op_sel:[0,0,1] op_sel_hi:[1,0,1] neg_lo:[0,0,1] neg_hi:[0,0,1]
v_pk_fma_f32 v[4:5], v[4:5], v[172:173], v[172:173] op_sel:[0,0,1] op_sel_hi:[1,0,1] neg_lo:[0,0,1] neg_hi:[0,0,1]
v_pk_fma_f32 v[6:7], v[6:7], v[172:173], v[172:173] op_sel:[0,0,1] op_sel_hi:[1,0,1] neg_lo:[0,0,1] neg_hi:[0,0,1]
v_pk_fma_f32 v[8:9], v[8:9], v[172:173], v[172:173] op_sel:[0,0,1] op_sel_hi:[1,0,1] neg_lo:[0,0,1] neg_hi:[0,0,1]
v_pk_fma_f32 v[10:11], v[10:11], v[172:173], v[172:173] op_sel:[0,0,1] op_sel_hi:[1,0,1] neg_lo:[0,0,1] neg_hi:[0,0,1]
v_pk_fma_f32 v[12:13], v[12:13], v[172:173], v[172:173] op_sel:[0,0,1] op_sel_hi:[1,0,1] neg_lo:[0,0,1] neg_hi:[0,0,1]
v_pk_fma_f32 v[14:15], v[14:15], v[172:173], v[172:173] op_sel:[0,0,1] op_sel_hi:[1,0,1] neg_lo:[0,0,1] neg_hi:[0,0,1]
v_pk_fma_f32 v[16:17], v[16:17], v[172:173], v[172:173] op_sel:[0,0,1] op_sel_hi:[1,0,1] neg_lo:[0,0,1] neg_hi:[0,0,1]
v_pk_fma_f32 v[18:19], v[18:19], v[172:173], v[172:173] op_sel:[0,0,1] op_sel_hi:[1,0,1] neg_lo:[0,0,1] neg_hi:[0,0,1]
v_pk_fma_f32 v[20:21], v[20:21], v[172:173], v[172:173] op_sel:[0,0,1] op_sel_hi:[1,0,1] neg_lo:[0,0,1] neg_hi:[0,0,1]
v_pk_fma_f32 v[22:23], v[22:23], v[172:173], v[172:173] op_sel:[0,0,1] op_sel_hi:[1,0,1] neg_lo:[0,0,1] neg_hi:[0,0,1]
v_pk_fma_f32 v[24:25], v[24:25], v[172:173], v[172:173] op_sel:[0,0,1] op_sel_hi:[1,0,1] neg_lo:[0,0,1] neg_hi:[0,0,1]
v_pk_fma_f32 v[26:27], v[26:27], v[172:173], v[172:173] op_sel:[0,0,1] op_sel_hi:[1,0,1] neg_lo:[0,0,1] neg_hi:[0,0,1]
v_pk_fma_f32 v[28:29], v[28:29], v[172:173], v[172:173] op_sel:[0,0,1] op_sel_hi:[1,0,1] neg_lo:[0,0,1] neg_hi:[0,0,1]
v_pk_fma_f32 v[30:31], v[30:31], v[172:173], v[172:173] op_sel:[0,0,1] op_sel_hi:[1,0,1] neg_lo:[0,0,1] neg_hi:[0,0,1]
v_pk_fma_f32 v[32:33], v[32:33], v[172:173], v[172:173] op_sel:[0,0,1] op_sel_hi:[1,0,1] neg_lo:[0,0,1] neg_hi:[0,0,1]
v_pk_fma_f32 v[34:35], v[34:35], v[172:173], v[172:173] op_sel:[0,0,1] op_sel_hi:[1,0,1] neg_lo:[0,0,1] neg_hi:[0,0,1]
v_pk_fma_f32 v[36:37], v[36:37], v[172:173], v[172:173] op_sel:[0,0,1] op_sel_hi:[1,0,1] neg_lo:[0,0,1] neg_hi:[0,0,1]
v_pk_fma_f32 v[38:39], v[38:39], v[172:173], v[172:173] op_sel:[0,0,1] op_sel_hi:[1,0,1] neg_lo:[0,0,1] neg_hi:[0,0,1]
v_pk_fma_f32 v[40:41], v[40:41], v[172:173], v[172:173] op_sel:[0,0,1] op_sel_hi:[1,0,1] neg_lo:[0,0,1] neg_hi:[0,0,1]
v_pk_fma_f32 v[42:43], v[42:43], v[172:173], v[172:173] op_sel:[0,0,1] op_sel_hi:[1,0,1] neg_lo:[0,0,1] neg_hi:[0,0,1]
v_pk_fma_f32 v[44:45], v[44:45], v[172:173], v[172:173] op_sel:[0,0,1] op_sel_hi:[1,0,1] neg_lo:[0,0,1] neg_hi:[0,0,1]
v_pk_fma_f32 v[46:47], v[46:47], v[172:173], v[172:173] op_sel:[0,0,1] op_sel_hi:[1,0,1] neg_lo:[0,0,1] neg_hi:[0,0,1]
s_setprio 2
s_waitcnt lgkmcnt(0)
v_readfirstlane_b32 s43, v247
s_nop 1
s_cmp_ge_u32 s43, 32
s_cbranch_scc1 Lev8
Lev8w:
s_sleep 1
ds_read_b32 v247, v253 offset:16
s_waitcnt lgkmcnt(0)
v_readfirstlane_b32 s43, v247
s_cmp_eq_u32 s76, 0
s_cbranch_scc1 Lev8
s_sub_u32 s76, s76, 1
s_cmp_lt_u32 s43, 32
s_cbranch_scc1 Lev8w
Lev8:
s_setprio 1
v_cvt_pkrtz_f16_f32 v137, v120, v121
v_cvt_pkrtz_f16_f32 v139, v122, v123
v_cvt_pkrtz_f16_f32 v141, v124, v125
v_cvt_pkrtz_f16_f32 v143, v126, v127
v_cvt_pkrtz_f16_f32 v145, v128, v129
v_cvt_pk_f16_f32 v155, v130, v131
v_cvt_pk_f16_f32 v152, v132, v133
v_cvt_pk_f16_f32 v149, v134, v135
s_add_u32 m0, s72, 0
s_add_u32 s43, s82, 0
buffer_load_dwordx4 v240, s[16:19], s43 offen lds
ds_read_b128 v[232:235], v249 offset:23552
v_mfma_f32_32x32x16_bf16 v[120:135], v[96:99], v[236:239], 0
v_pk_fma_f16 v154, v155, v155, s48
v_cvt_pk_bf16_f32 v168, v0, v1
v_and_b32 v137, s49, v137
v_pk_fma_f16 v151, v152, v152, s48
v_cvt_pk_bf16_f32 v169, v2, v3
v_and_b32_e64 v139, s49, v139
v_pk_fma_f16 v148, v149, v149, s48
v_pk_mul_f16 v154, v155, v154
v_cvt_pk_bf16_f32 v170, v4, v5
v_bfe_u32 v136, v137, 2, 14
v_pk_mul_f16 v151, v152, v151
v_pk_mul_f16 v148, v149, v148
v_cvt_pk_bf16_f32 v171, v6, v7
v_bfe_u32 v138, v139, 2, 14
ds_read_b128 v[236:239], v248 offset:16384
ds_read_u16_d16 v136, v136
ds_read_u16_d16 v138, v138
v_mfma_f32_32x32x16_bf16 v[120:135], v[100:103], v[216:219], v[120:135]
v_exp_f16_e64 v153, v154
v_cvt_pk_bf16_f32 v172, v8, v9
v_lshrrev_b32 v137, 18, v137
v_exp_f16 v150, v151
v_cvt_pk_bf16_f32 v173, v10, v11
v_lshrrev_b32 v139, 18, v139
v_exp_f16 v147, v148
v_cvt_pk_bf16_f32 v174, v12, v13
v_and_b32_e64 v141, s49, v141
v_and_b32 v143, s49, v143
v_cvt_pk_bf16_f32 v175, v14, v15
s_add_u32 m0, s72, 1024
s_add_u32 s43, s82, 64
buffer_load_dwordx4 v240, s[16:19], s43 offen lds
ds_read_b128 v[216:219], v248 offset:19456
ds_read_u16_d16_hi v137, v137
ds_read_u16_d16_hi v139, v139
v_mfma_f32_32x32x16_bf16 v[120:135], v[104:107], v[220:223], v[120:135]
v_exp_f16_sdwa v153, v154 dst_sel:WORD_1 dst_unused:UNUSED_PRESERVE src0_sel:WORD_1
v_bfe_u32 v140, v141, 2, 14
v_cvt_pk_bf16_f32 v176, v16, v17
v_exp_f16_sdwa v150, v151 dst_sel:WORD_1 dst_unused:UNUSED_PRESERVE src0_sel:WORD_1
v_bfe_u32 v142, v143, 2, 14
v_cvt_pk_bf16_f32 v177, v18, v19
v_exp_f16_sdwa v147, v148 dst_sel:WORD_1 dst_unused:UNUSED_PRESERVE src0_sel:WORD_1
v_cvt_pk_bf16_f32 v178, v20, v21
v_lshrrev_b32_e64 v141, 18, v141
v_pk_add_f16 v153, v153, 1.0 op_sel_hi:[1,0]
v_lshrrev_b32_e64 v143, 18, v143
ds_read_b128 v[220:223], v248 offset:17408
ds_read_u16_d16 v140, v140
ds_read_u16_d16 v142, v142
ds_read_u16_d16_hi v141, v141
ds_read_u16_d16_hi v143, v143
v_mfma_f32_32x32x16_bf16 v[120:135], v[108:111], v[224:227], v[120:135]
v_cvt_pk_bf16_f32 v179, v22, v23
v_pk_add_f16 v150, v150, 1.0 op_sel_hi:[1,0]
v_pk_add_f16 v147, v147, 1.0 op_sel_hi:[1,0]
v_and_b32_e64 v145, s49, v145
v_cvt_pk_bf16_f32 v180, v24, v25
v_rcp_f16_e64 v154, v153
v_bfe_u32 v144, v145, 2, 14
v_cvt_pk_bf16_f32 v181, v26, v27
v_rcp_f16 v151, v150
v_lshrrev_b32 v145, 18, v145
v_cvt_pk_bf16_f32 v182, v28, v29
s_add_u32 m0, s72, 2048
s_add_u32 s43, s82, 128
buffer_load_dwordx4 v240, s[16:19], s43 offen lds
ds_read_b128 v[224:227], v248 offset:20480
ds_read_u16_d16 v144, v144
ds_read_u16_d16_hi v145, v145
v_mfma_f32_32x32x16_bf16 v[120:135], v[112:115], v[228:231], v[120:135]
v_rcp_f16 v148, v147
v_cvt_pk_bf16_f32 v183, v30, v31
v_rcp_f16_sdwa v154, v153 dst_sel:WORD_1 dst_unused:UNUSED_PRESERVE src0_sel:WORD_1
s_waitcnt lgkmcnt(5)
v_fma_mix_f32 v166, v136, v136, v166 op_sel:[0,0,0] op_sel_hi:[1,1,0]
v_cvt_pk_bf16_f32 v184, v32, v33
s_setprio 0
v_fma_mix_f32 v166, v137, v137, v166 op_sel:[1,1,0] op_sel_hi:[1,1,0]
v_rcp_f16_sdwa v151, v150 dst_sel:WORD_1 dst_unused:UNUSED_PRESERVE src0_sel:WORD_1
v_cvt_pk_bf16_f32 v185, v34, v35
v_fma_mix_f32 v166, v138, v138, v166 op_sel:[0,0,0] op_sel_hi:[1,1,0]
v_rcp_f16_sdwa v148, v147 dst_sel:WORD_1 dst_unused:UNUSED_PRESERVE src0_sel:WORD_1
v_cvt_pk_bf16_f32 v186, v36, v37
ds_read_b128 v[228:231], v248 offset:18432
v_mfma_f32_32x32x16_bf16 v[120:135], v[116:119], v[232:235], v[120:135]
v_fma_mix_f32 v166, v139, v139, v166 op_sel:[1,1,0] op_sel_hi:[1,1,0]
v_pk_mul_f16 v155, v155, v154
v_fma_mix_f32 v166, v140, v140, v166 op_sel:[0,0,0] op_sel_hi:[1,1,0]
v_cvt_pk_bf16_f32 v187, v38, v39
v_pk_mul_f16 v152, v152, v151
s_waitcnt lgkmcnt(4)
v_fma_mix_f32 v166, v141, v141, v166 op_sel:[1,1,0] op_sel_hi:[1,1,0]
v_cvt_pk_bf16_f32 v188, v40, v41
v_pk_mul_f16 v149, v149, v148
v_fma_mix_f32 v166, v155, v155, v166 op_sel:[0,0,0] op_sel_hi:[1,1,0]
v_fma_mix_f32 v166, v142, v142, v166 op_sel:[0,0,0] op_sel_hi:[1,1,0]
v_cvt_pk_bf16_f32 v189, v42, v43
v_fma_mix_f32 v166, v155, v155, v166 op_sel:[1,1,0] op_sel_hi:[1,1,0]
v_fma_mix_f32 v166, v143, v143, v166 op_sel:[1,1,0] op_sel_hi:[1,1,0]
v_fma_mix_f32 v166, v152, v152, v166 op_sel:[0,0,0] op_sel_hi:[1,1,0]
v_cvt_pk_bf16_f32 v190, v44, v45
v_fma_mix_f32 v166, v152, v152, v166 op_sel:[1,1,0] op_sel_hi:[1,1,0]
s_waitcnt lgkmcnt(1)
v_fma_mix_f32 v166, v144, v144, v166 op_sel:[0,0,0] op_sel_hi:[1,1,0]
v_fma_mix_f32 v166, v149, v149, v166 op_sel:[0,0,0] op_sel_hi:[1,1,0]
v_cvt_pk_bf16_f32 v191, v46, v47
v_fma_mix_f32 v166, v145, v145, v166 op_sel:[1,1,0] op_sel_hi:[1,1,0]
v_fma_mix_f32 v166, v149, v149, v166 op_sel:[1,1,0] op_sel_hi:[1,1,0]
s_setprio 2
v_cvt_pkrtz_f16_f32 v137, v120, v121
v_cvt_pkrtz_f16_f32 v139, v122, v123
v_cvt_pkrtz_f16_f32 v141, v124, v125
v_cvt_pkrtz_f16_f32 v143, v126, v127
v_cvt_pkrtz_f16_f32 v145, v128, v129
v_cvt_pk_f16_f32 v155, v130, v131
v_cvt_pk_f16_f32 v152, v132, v133
v_cvt_pk_f16_f32 v149, v134, v135
s_add_u32 m0, s72, 3072
s_add_u32 s43, s82, 3072
buffer_load_dwordx4 v240, s[16:19], s43 offen lds
ds_read_b128 v[232:235], v248 offset:21504
v_mfma_f32_32x32x16_bf16 v[120:135], v[236:239], v[168:171], 0
v_pk_fma_f16 v154, v155, v155, s48
v_and_b32 v247, 1, v251
v_and_b32 v137, s49, v137
v_pk_fma_f16 v151, v152, v152, s48
v_and_b32 v139, s49, v139
v_lshlrev_b32 v247, 4, v247
v_pk_fma_f16 v148, v149, v149, s48
v_pk_mul_f16 v154, v155, v154
v_bfe_u32 v136, v137, 2, 14
v_mov_b32 v252, 15360
v_pk_mul_f16 v151, v152, v151
v_pk_mul_f16 v148, v149, v148
v_bfe_u32 v138, v139, 2, 14
ds_read_b128 v[236:239], v248 offset:22528
ds_read_u16_d16 v136, v136
ds_read_u16_d16 v138, v138
v_mfma_f32_32x32x16_bf16 v[120:135], v[216:219], v[172:175], v[120:135]
v_exp_f16 v153, v154
v_lshlrev_b32 v247, v247, v252
v_lshrrev_b32 v137, 18, v137
v_exp_f16 v150, v151
v_lshrrev_b32 v252, 3, v251
v_lshrrev_b32 v139, 18, v139
v_exp_f16 v147, v148
v_xor_b32 v252, v252, v251
v_and_b32 v141, s49, v141
v_and_b32 v143, s49, v143
s_add_u32 m0, s72, 4096
s_add_u32 s43, s82, 3136
buffer_load_dwordx4 v240, s[16:19], s43 offen lds
ds_read_b128 v[216:219], v248 offset:25600
ds_read_u16_d16_hi v137, v137
ds_read_u16_d16_hi v139, v139
v_mfma_f32_32x32x16_bf16 v[120:135], v[220:223], v[176:179], v[120:135]
v_exp_f16_sdwa v153, v154 dst_sel:WORD_1 dst_unused:UNUSED_PRESERVE src0_sel:WORD_1
v_and_b32_e64 v252, 4, v252
v_bfe_u32 v140, v141, 2, 14
v_exp_f16_sdwa v150, v151 dst_sel:WORD_1 dst_unused:UNUSED_PRESERVE src0_sel:WORD_1
v_bfe_u32 v253, v251, 3, 2
v_bfe_u32 v142, v143, 2, 14
v_exp_f16_sdwa v147, v148 dst_sel:WORD_1 dst_unused:UNUSED_PRESERVE src0_sel:WORD_1
v_lshl_add_u32 v252, v252, 1, 0
v_lshrrev_b32_e64 v141, 18, v141
v_pk_add_f16 v153, v153, 1.0 op_sel_hi:[1,0]
v_lshrrev_b32_e64 v143, 18, v143
ds_read_b128 v[220:223], v248 offset:23552
ds_read_u16_d16 v140, v140
ds_read_u16_d16 v142, v142
ds_read_u16_d16_hi v141, v141
ds_read_u16_d16_hi v143, v143
v_mfma_f32_32x32x16_bf16 v[120:135], v[224:227], v[180:183], v[120:135]
v_lshl_add_u32 v252, v253, 1, v252
v_pk_add_f16 v150, v150, 1.0 op_sel_hi:[1,0]
v_pk_add_f16 v147, v147, 1.0 op_sel_hi:[1,0]
v_and_b32_e64 v145, s49, v145
v_bfe_u32 v253, v251, 1, 1
v_rcp_f16_e64 v154, v153
v_bfe_u32 v144, v145, 2, 14
v_add_u32 v252, v252, v253
v_rcp_f16 v151, v150
v_lshrrev_b32_e64 v145, 18, v145
v_rcp_f16 v148, v147
s_waitcnt lgkmcnt(5)
s_add_u32 m0, s72, 5120
s_add_u32 s43, s82, 3200
buffer_load_dwordx4 v240, s[16:19], s43 offen lds
ds_read_b128 v[224:227], v248 offset:26624
ds_read_u16_d16 v144, v144
ds_read_u16_d16_hi v145, v145
v_mfma_f32_32x32x16_bf16 v[120:135], v[228:231], v[184:187], v[120:135]
v_cmp_eq_u32 vcc, 0, v252
s_nop 1
v_cndmask_b32 v208, 0, v247, vcc
v_rcp_f16_sdwa v154, v153 dst_sel:WORD_1 dst_unused:UNUSED_PRESERVE src0_sel:WORD_1
v_cmp_eq_u32 vcc, 1, v252
s_nop 1
v_cndmask_b32 v209, 0, v247, vcc
v_fma_mix_f32 v167, v136, v136, v167 op_sel:[0,0,0] op_sel_hi:[1,1,0]
v_fma_mix_f32 v167, v137, v137, v167 op_sel:[1,1,0] op_sel_hi:[1,1,0]
v_rcp_f16_sdwa v151, v150 dst_sel:WORD_1 dst_unused:UNUSED_PRESERVE src0_sel:WORD_1
v_cmp_eq_u32 vcc, 2, v252
s_nop 1
v_cndmask_b32 v210, 0, v247, vcc
v_fma_mix_f32 v167, v138, v138, v167 op_sel:[0,0,0] op_sel_hi:[1,1,0]
v_rcp_f16_sdwa v148, v147 dst_sel:WORD_1 dst_unused:UNUSED_PRESERVE src0_sel:WORD_1
v_cmp_eq_u32 vcc, 3, v252
s_nop 1
v_cndmask_b32 v211, 0, v247, vcc
ds_read_b128 v[228:231], v248 offset:24576
v_mfma_f32_32x32x16_bf16 v[120:135], v[232:235], v[188:191], v[120:135]
v_fma_mix_f32 v167, v139, v139, v167 op_sel:[1,1,0] op_sel_hi:[1,1,0]
v_pk_mul_f16 v155, v155, v154
s_waitcnt lgkmcnt(1)
v_fma_mix_f32 v167, v140, v140, v167 op_sel:[0,0,0] op_sel_hi:[1,1,0]
v_cmp_eq_u32 vcc, 4, v252
s_nop 1
v_cndmask_b32 v212, 0, v247, vcc
v_pk_mul_f16 v152, v152, v151
v_fma_mix_f32 v167, v141, v141, v167 op_sel:[1,1,0] op_sel_hi:[1,1,0]
v_pk_mul_f16 v149, v149, v148
v_cmp_eq_u32 vcc, 5, v252
s_nop 1
v_cndmask_b32 v213, 0, v247, vcc
v_fma_mix_f32 v167, v155, v155, v167 op_sel:[0,0,0] op_sel_hi:[1,1,0]
v_fma_mix_f32 v167, v142, v142, v167 op_sel:[0,0,0] op_sel_hi:[1,1,0]
v_fma_mix_f32 v167, v155, v155, v167 op_sel:[1,1,0] op_sel_hi:[1,1,0]
v_fma_mix_f32 v167, v143, v143, v167 op_sel:[1,1,0] op_sel_hi:[1,1,0]
v_cmp_eq_u32 vcc, 6, v252
s_nop 1
v_cndmask_b32 v214, 0, v247, vcc
v_fma_mix_f32 v167, v152, v152, v167 op_sel:[0,0,0] op_sel_hi:[1,1,0]
v_fma_mix_f32 v167, v152, v152, v167 op_sel:[1,1,0] op_sel_hi:[1,1,0]
v_fma_mix_f32 v167, v144, v144, v167 op_sel:[0,0,0] op_sel_hi:[1,1,0]
v_cmp_eq_u32 vcc, 7, v252
s_nop 1
v_cndmask_b32 v215, 0, v247, vcc
v_fma_mix_f32 v167, v149, v149, v167 op_sel:[0,0,0] op_sel_hi:[1,1,0]
v_fma_mix_f32 v167, v145, v145, v167 op_sel:[1,1,0] op_sel_hi:[1,1,0]
v_fma_mix_f32 v167, v149, v149, v167 op_sel:[1,1,0] op_sel_hi:[1,1,0]
s_setprio 1
v_cvt_pkrtz_f16_f32 v137, v120, v121
v_cvt_pkrtz_f16_f32 v139, v122, v123
v_cvt_pkrtz_f16_f32 v141, v124, v125
v_cvt_pkrtz_f16_f32 v143, v126, v127
v_cvt_pkrtz_f16_f32 v145, v128, v129
v_cvt_pk_f16_f32 v155, v130, v131
v_cvt_pk_f16_f32 v152, v132, v133
v_cvt_pk_f16_f32 v149, v134, v135
s_add_u32 m0, s72, 6144
s_add_u32 s43, s82, 6144
buffer_load_dwordx4 v240, s[16:19], s43 offen lds
ds_read_b128 v[232:235], v248 offset:27648
v_mfma_f32_32x32x16_bf16 v[120:135], v[236:239], v[168:171], 0
v_pk_fma_f16 v154, v155, v155, s48
v_and_b32_e64 v137, s49, v137
v_pk_fma_f16 v151, v152, v152, s48
v_and_b32_e64 v139, s49, v139
v_pk_fma_f16 v148, v149, v149, s48
v_pk_mul_f16 v154, v155, v154
v_bfe_u32 v136, v137, 2, 14
v_pk_mul_f16 v151, v152, v151
ds_read_b128 v[236:239], v248 offset:28672
ds_read_u16_d16 v136, v136
v_mfma_f32_32x32x16_bf16 v[120:135], v[216:219], v[172:175], v[120:135]
v_pk_mul_f16 v148, v149, v148
v_bfe_u32 v138, v139, 2, 14
v_exp_f16 v153, v154
v_lshrrev_b32 v137, 18, v137
v_exp_f16 v150, v151
v_lshrrev_b32 v139, 18, v139
ds_read_b128 v[216:219], v248 offset:31744
ds_read_u16_d16 v138, v138
ds_read_u16_d16_hi v137, v137
ds_read_u16_d16_hi v139, v139
v_mfma_f32_32x32x16_bf16 v[120:135], v[220:223], v[176:179], v[120:135]
v_exp_f16 v147, v148
v_and_b32 v141, s49, v141
v_and_b32_e64 v143, s49, v143
v_exp_f16_sdwa v153, v154 dst_sel:WORD_1 dst_unused:UNUSED_PRESERVE src0_sel:WORD_1
v_bfe_u32 v140, v141, 2, 14
v_exp_f16_sdwa v150, v151 dst_sel:WORD_1 dst_unused:UNUSED_PRESERVE src0_sel:WORD_1
ds_read_b128 v[220:223], v248 offset:29696
ds_read_u16_d16 v140, v140
v_mfma_f32_32x32x16_bf16 v[120:135], v[224:227], v[180:183], v[120:135]
v_bfe_u32 v142, v143, 2, 14
v_exp_f16_sdwa v147, v148 dst_sel:WORD_1 dst_unused:UNUSED_PRESERVE src0_sel:WORD_1
v_lshrrev_b32_e64 v141, 18, v141
v_pk_add_f16 v153, v153, 1.0 op_sel_hi:[1,0]
v_lshrrev_b32 v143, 18, v143
v_pk_add_f16 v150, v150, 1.0 op_sel_hi:[1,0]
v_pk_add_f16 v147, v147, 1.0 op_sel_hi:[1,0]
s_waitcnt lgkmcnt(6)
ds_read_b128 v[224:227], v248 offset:32768
ds_read_u16_d16 v142, v142
ds_read_u16_d16_hi v141, v141
ds_read_u16_d16_hi v143, v143
v_mfma_f32_32x32x16_bf16 v[120:135], v[228:231], v[184:187], v[120:135]
v_and_b32 v145, s49, v145
v_rcp_f16 v154, v153
v_bfe_u32 v144, v145, 2, 14
s_setprio 0
v_rcp_f16 v151, v150
v_lshrrev_b32_e64 v145, 18, v145
ds_read_b128 v[228:231], v248 offset:30720
ds_read_u16_d16 v144, v144
ds_read_u16_d16_hi v145, v145
v_mfma_f32_32x32x16_bf16 v[120:135], v[232:235], v[188:191], v[120:135]
v_rcp_f16 v148, v147
s_waitcnt lgkmcnt(7)
v_or_b32 v0, v136, v137
v_or_b32 v1, v138, v139
v_rcp_f16_sdwa v154, v153 dst_sel:WORD_1 dst_unused:UNUSED_PRESERVE src0_sel:WORD_1
s_waitcnt lgkmcnt(4)
v_or_b32 v2, v140, v141
v_rcp_f16_sdwa v151, v150 dst_sel:WORD_1 dst_unused:UNUSED_PRESERVE src0_sel:WORD_1
s_waitcnt lgkmcnt(3)
v_or_b32 v3, v142, v143
v_rcp_f16_sdwa v148, v147 dst_sel:WORD_1 dst_unused:UNUSED_PRESERVE src0_sel:WORD_1
s_waitcnt lgkmcnt(0)
v_or_b32_e64 v4, v144, v145
v_pk_mul_f16 v5, v155, v154
v_pk_mul_f16 v6, v152, v151
v_pk_mul_f16 v7, v149, v148
s_setprio 2
ds_read_b128 v[232:235], v248 offset:33792
v_mfma_f32_32x32x16_f16 v[192:207], v[0:3], v[208:211], 0
v_cvt_pkrtz_f16_f32 v137, v120, v121
v_cvt_pkrtz_f16_f32 v139, v122, v123
v_cvt_pkrtz_f16_f32 v141, v124, v125
v_cvt_pkrtz_f16_f32 v143, v126, v127
v_cvt_pkrtz_f16_f32 v145, v128, v129
v_mfma_f32_32x32x16_f16 v[192:207], v[4:7], v[212:215], v[192:207]
v_cvt_pk_f16_f32 v155, v130, v131
v_cvt_pk_f16_f32 v152, v132, v133
v_cvt_pk_f16_f32 v149, v134, v135
v_pk_fma_f16 v154, v155, v155, s48
v_and_b32_e64 v137, s49, v137
v_pk_fma_f16 v151, v152, v152, s48
v_mfma_f32_32x32x16_bf16 v[120:135], v[236:239], v[168:171], 0
v_and_b32 v139, s49, v139
v_pk_fma_f16 v148, v149, v149, s48
v_permlane16_swap_b32 v0, v4
v_pk_mul_f16 v154, v155, v154
v_bfe_u32 v136, v137, 2, 14
v_permlane16_swap_b32 v1, v5
v_pk_mul_f16 v151, v152, v151
v_pk_mul_f16 v148, v149, v148
v_bfe_u32 v138, v139, 2, 14
v_permlane16_swap_b32 v2, v6
ds_read_b128 v[236:239], v248 offset:34816
ds_read_u16_d16 v136, v136
ds_read_u16_d16 v138, v138
v_mfma_f32_32x32x16_bf16 v[120:135], v[216:219], v[172:175], v[120:135]
v_exp_f16 v153, v154
v_permlane16_swap_b32 v3, v7
v_lshrrev_b32 v137, 18, v137
v_exp_f16 v150, v151
v_fmac_f32 v156, v192, v192
v_lshrrev_b32 v139, 18, v139
v_exp_f16 v147, v148
v_fmac_f32 v156, v193, v193
v_and_b32_e64 v141, s49, v141
ds_read_b128 v[216:219], v248 offset:37888
ds_read_u16_d16_hi v137, v137
ds_read_u16_d16_hi v139, v139
v_mfma_f32_32x32x16_bf16 v[120:135], v[220:223], v[176:179], v[120:135]
v_and_b32 v143, s49, v143
v_fmac_f32 v156, v194, v194
v_exp_f16_sdwa v153, v154 dst_sel:WORD_1 dst_unused:UNUSED_PRESERVE src0_sel:WORD_1
v_bfe_u32 v140, v141, 2, 14
v_fmac_f32_e64 v156, v195, v195
v_exp_f16_sdwa v150, v151 dst_sel:WORD_1 dst_unused:UNUSED_PRESERVE src0_sel:WORD_1
v_fmac_f32_e64 v156, v196, v196
v_bfe_u32 v142, v143, 2, 14
ds_read_b128 v[220:223], v248 offset:35840
ds_read_u16_d16 v140, v140
ds_read_u16_d16 v142, v142
v_mfma_f32_32x32x16_bf16 v[120:135], v[224:227], v[180:183], v[120:135]
v_exp_f16_sdwa v147, v148 dst_sel:WORD_1 dst_unused:UNUSED_PRESERVE src0_sel:WORD_1
v_fmac_f32 v156, v197, v197
v_lshrrev_b32 v141, 18, v141
v_pk_add_f16 v153, v153, 1.0 op_sel_hi:[1,0]
v_lshrrev_b32 v143, 18, v143
v_fmac_f32 v156, v198, v198
v_pk_add_f16 v150, v150, 1.0 op_sel_hi:[1,0]
v_pk_add_f16 v147, v147, 1.0 op_sel_hi:[1,0]
v_fmac_f32 v156, v199, v199
v_and_b32 v145, s49, v145
ds_read_b128 v[224:227], v248 offset:38912
ds_read_u16_d16_hi v141, v141
ds_read_u16_d16_hi v143, v143
v_mfma_f32_32x32x16_bf16 v[120:135], v[228:231], v[184:187], v[120:135]
v_rcp_f16 v154, v153
v_fmac_f32 v156, v200, v200
v_bfe_u32 v144, v145, 2, 14
v_rcp_f16 v151, v150
v_fmac_f32 v156, v201, v201
v_lshrrev_b32 v145, 18, v145
v_rcp_f16 v148, v147
v_fmac_f32_e64 v156, v202, v202
ds_read_u16_d16 v144, v144
ds_read_u16_d16_hi v145, v145
s_waitcnt lgkmcnt(5)
v_or_b32 v8, v136, v137
ds_read_b128 v[228:231], v248 offset:36864
v_mfma_f32_32x32x16_bf16 v[120:135], v[232:235], v[188:191], v[120:135]
v_or_b32 v9, v138, v139
v_fmac_f32 v156, v203, v203
v_rcp_f16_sdwa v154, v153 dst_sel:WORD_1 dst_unused:UNUSED_PRESERVE src0_sel:WORD_1
v_fmac_f32 v156, v204, v204
s_waitcnt lgkmcnt(4)
v_or_b32_e64 v10, v140, v141
v_rcp_f16_sdwa v151, v150 dst_sel:WORD_1 dst_unused:UNUSED_PRESERVE src0_sel:WORD_1
v_fmac_f32 v156, v205, v205
s_waitcnt lgkmcnt(3)
v_or_b32_e64 v11, v142, v143
v_rcp_f16_sdwa v148, v147 dst_sel:WORD_1 dst_unused:UNUSED_PRESERVE src0_sel:WORD_1
v_fmac_f32 v156, v206, v206
s_waitcnt lgkmcnt(1)
v_or_b32_e64 v12, v144, v145
v_pk_mul_f16 v13, v155, v154
v_fmac_f32_e64 v156, v207, v207
v_pk_mul_f16 v14, v152, v151
v_pk_mul_f16 v15, v149, v148
s_cmp_lg_u32 s40, 0
s_cbranch_scc1 Lrs0
v_lshlrev_b32_e64 v89, 2, v251
v_mov_b32 v90, 0
buffer_load_dword v244, v89, s[24:27], 0 offen offset:0
buffer_load_dword v245, v89, s[24:27], 0 offen offset:256
buffer_load_dword v246, v89, s[24:27], 0 offen offset:512
buffer_load_dword v91, v90, s[36:39], 0 offen sc1
Lrs0:
s_setprio 1
ds_read_b128 v[232:235], v248 offset:39936
v_mfma_f32_32x32x16_f16 v[192:207], v[8:11], v[208:211], 0
v_cvt_pkrtz_f16_f32 v137, v120, v121
v_cvt_pkrtz_f16_f32 v139, v122, v123
v_cvt_pkrtz_f16_f32 v141, v124, v125
v_cvt_pkrtz_f16_f32 v143, v126, v127
v_cvt_pkrtz_f16_f32 v145, v128, v129
v_mfma_f32_32x32x16_f16 v[192:207], v[12:15], v[212:215], v[192:207]
v_cvt_pk_f16_f32 v155, v130, v131
v_cvt_pk_f16_f32 v152, v132, v133
v_cvt_pk_f16_f32 v149, v134, v135
v_pk_fma_f16 v154, v155, v155, s48
v_and_b32_e64 v137, s49, v137
v_pk_fma_f16 v151, v152, v152, s48
v_mfma_f32_32x32x16_bf16 v[120:135], v[236:239], v[168:171], 0
v_and_b32 v139, s49, v139
v_pk_fma_f16 v148, v149, v149, s48
v_permlane16_swap_b32 v8, v12
v_pk_mul_f16 v154, v155, v154
v_bfe_u32 v136, v137, 2, 14
v_permlane16_swap_b32 v9, v13
v_pk_mul_f16 v151, v152, v151
v_pk_mul_f16 v148, v149, v148
v_bfe_u32 v138, v139, 2, 14
v_permlane16_swap_b32 v10, v14
ds_read_b128 v[236:239], v248 offset:40960
ds_read_u16_d16 v136, v136
ds_read_u16_d16 v138, v138
v_mfma_f32_32x32x16_bf16 v[120:135], v[216:219], v[172:175], v[120:135]
v_exp_f16 v153, v154
v_permlane16_swap_b32 v11, v15
v_lshrrev_b32 v137, 18, v137
v_exp_f16 v150, v151
v_fmac_f32 v157, v192, v192
v_lshrrev_b32 v139, 18, v139
v_exp_f16 v147, v148
v_fmac_f32 v157, v193, v193
v_and_b32_e64 v141, s49, v141
ds_read_b128 v[216:219], v248 offset:44032
ds_read_u16_d16_hi v137, v137
ds_read_u16_d16_hi v139, v139
v_mfma_f32_32x32x16_bf16 v[120:135], v[220:223], v[176:179], v[120:135]
v_and_b32 v143, s49, v143
v_fmac_f32 v157, v194, v194
v_exp_f16_sdwa v153, v154 dst_sel:WORD_1 dst_unused:UNUSED_PRESERVE src0_sel:WORD_1
v_bfe_u32 v140, v141, 2, 14
v_fmac_f32_e64 v157, v195, v195
v_exp_f16_sdwa v150, v151 dst_sel:WORD_1 dst_unused:UNUSED_PRESERVE src0_sel:WORD_1
v_fmac_f32_e64 v157, v196, v196
v_bfe_u32 v142, v143, 2, 14
ds_read_b128 v[220:223], v248 offset:41984
ds_read_u16_d16 v140, v140
ds_read_u16_d16 v142, v142
v_mfma_f32_32x32x16_bf16 v[120:135], v[224:227], v[180:183], v[120:135]
v_exp_f16_sdwa v147, v148 dst_sel:WORD_1 dst_unused:UNUSED_PRESERVE src0_sel:WORD_1
v_fmac_f32 v157, v197, v197
v_lshrrev_b32 v141, 18, v141
v_pk_add_f16 v153, v153, 1.0 op_sel_hi:[1,0]
v_lshrrev_b32 v143, 18, v143
v_fmac_f32 v157, v198, v198
v_pk_add_f16 v150, v150, 1.0 op_sel_hi:[1,0]
v_pk_add_f16 v147, v147, 1.0 op_sel_hi:[1,0]
v_fmac_f32_e64 v157, v199, v199
v_and_b32 v145, s49, v145
s_waitcnt lgkmcnt(4)
ds_read_b128 v[224:227], v248 offset:45056
ds_read_u16_d16_hi v141, v141
ds_read_u16_d16_hi v143, v143
v_mfma_f32_32x32x16_bf16 v[120:135], v[228:231], v[184:187], v[120:135]
v_rcp_f16 v154, v153
v_fmac_f32 v157, v200, v200
v_bfe_u32 v144, v145, 2, 14
v_rcp_f16 v151, v150
s_setprio 0
v_fmac_f32 v157, v201, v201
v_lshrrev_b32 v145, 18, v145
v_rcp_f16 v148, v147
v_fmac_f32 v157, v202, v202
ds_read_u16_d16 v144, v144
ds_read_u16_d16_hi v145, v145
v_or_b32_e64 v16, v136, v137
ds_read_b128 v[228:231], v248 offset:43008
v_mfma_f32_32x32x16_bf16 v[120:135], v[232:235], v[188:191], v[120:135]
s_waitcnt lgkmcnt(6)
v_or_b32 v17, v138, v139
v_fmac_f32_e64 v157, v203, v203
v_rcp_f16_sdwa v154, v153 dst_sel:WORD_1 dst_unused:UNUSED_PRESERVE src0_sel:WORD_1
v_fmac_f32 v157, v204, v204
s_waitcnt lgkmcnt(4)
v_or_b32_e64 v18, v140, v141
v_rcp_f16_sdwa v151, v150 dst_sel:WORD_1 dst_unused:UNUSED_PRESERVE src0_sel:WORD_1
v_fmac_f32 v157, v205, v205
s_waitcnt lgkmcnt(3)
v_or_b32_e64 v19, v142, v143
v_rcp_f16_sdwa v148, v147 dst_sel:WORD_1 dst_unused:UNUSED_PRESERVE src0_sel:WORD_1
v_fmac_f32 v157, v206, v206
s_waitcnt lgkmcnt(1)
v_or_b32_e64 v20, v144, v145
v_pk_mul_f16 v21, v155, v154
v_fmac_f32 v157, v207, v207
v_pk_mul_f16 v22, v152, v151
v_pk_mul_f16 v23, v149, v148
s_setprio 2
ds_read_b128 v[232:235], v248 offset:46080
v_mfma_f32_32x32x16_f16 v[192:207], v[16:19], v[208:211], 0
v_cvt_pkrtz_f16_f32 v137, v120, v121
v_cvt_pkrtz_f16_f32 v139, v122, v123
v_cvt_pkrtz_f16_f32 v141, v124, v125
v_cvt_pkrtz_f16_f32 v143, v126, v127
v_cvt_pkrtz_f16_f32 v145, v128, v129
v_mfma_f32_32x32x16_f16 v[192:207], v[20:23], v[212:215], v[192:207]
v_cvt_pk_f16_f32 v155, v130, v131
v_cvt_pk_f16_f32 v152, v132, v133
v_cvt_pk_f16_f32 v149, v134, v135
v_pk_fma_f16 v154, v155, v155, s48
v_and_b32_e64 v137, s49, v137
v_pk_fma_f16 v151, v152, v152, s48
v_mfma_f32_32x32x16_bf16 v[120:135], v[236:239], v[168:171], 0
v_and_b32 v139, s49, v139
v_pk_fma_f16 v148, v149, v149, s48
v_permlane16_swap_b32 v16, v20
v_pk_mul_f16 v154, v155, v154
v_bfe_u32 v136, v137, 2, 14
v_permlane16_swap_b32 v17, v21
v_pk_mul_f16 v151, v152, v151
v_pk_mul_f16 v148, v149, v148
v_bfe_u32 v138, v139, 2, 14
v_permlane16_swap_b32 v18, v22
ds_read_b128 v[236:239], v248 offset:47104
ds_read_u16_d16 v136, v136
ds_read_u16_d16 v138, v138
v_mfma_f32_32x32x16_bf16 v[120:135], v[216:219], v[172:175], v[120:135]
v_exp_f16 v153, v154
v_permlane16_swap_b32 v19, v23
v_lshrrev_b32 v137, 18, v137
v_exp_f16 v150, v151
v_fmac_f32 v158, v192, v192
v_lshrrev_b32 v139, 18, v139
v_exp_f16 v147, v148
v_fmac_f32 v158, v193, v193
v_and_b32_e64 v141, s49, v141
ds_read_b128 v[216:219], v248 offset:50176
ds_read_u16_d16_hi v137, v137
ds_read_u16_d16_hi v139, v139
v_mfma_f32_32x32x16_bf16 v[120:135], v[220:223], v[176:179], v[120:135]
v_and_b32 v143, s49, v143
v_fmac_f32 v158, v194, v194
v_exp_f16_sdwa v153, v154 dst_sel:WORD_1 dst_unused:UNUSED_PRESERVE src0_sel:WORD_1
v_bfe_u32 v140, v141, 2, 14
v_fmac_f32_e64 v158, v195, v195
v_exp_f16_sdwa v150, v151 dst_sel:WORD_1 dst_unused:UNUSED_PRESERVE src0_sel:WORD_1
v_fmac_f32_e64 v158, v196, v196
v_bfe_u32 v142, v143, 2, 14
ds_read_b128 v[220:223], v248 offset:48128
ds_read_u16_d16 v140, v140
ds_read_u16_d16 v142, v142
v_mfma_f32_32x32x16_bf16 v[120:135], v[224:227], v[180:183], v[120:135]
v_exp_f16_sdwa v147, v148 dst_sel:WORD_1 dst_unused:UNUSED_PRESERVE src0_sel:WORD_1
v_fmac_f32 v158, v197, v197
v_lshrrev_b32 v141, 18, v141
v_pk_add_f16 v153, v153, 1.0 op_sel_hi:[1,0]
v_lshrrev_b32 v143, 18, v143
v_fmac_f32 v158, v198, v198
v_pk_add_f16 v150, v150, 1.0 op_sel_hi:[1,0]
v_pk_add_f16 v147, v147, 1.0 op_sel_hi:[1,0]
v_fmac_f32_e64 v158, v199, v199
v_and_b32 v145, s49, v145
s_waitcnt lgkmcnt(4)
ds_read_b128 v[224:227], v248 offset:51200
ds_read_u16_d16_hi v141, v141
ds_read_u16_d16_hi v143, v143
v_mfma_f32_32x32x16_bf16 v[120:135], v[228:231], v[184:187], v[120:135]
v_rcp_f16 v154, v153
v_fmac_f32 v158, v200, v200
v_bfe_u32 v144, v145, 2, 14
v_rcp_f16 v151, v150
v_fmac_f32 v158, v201, v201
v_lshrrev_b32 v145, 18, v145
v_rcp_f16 v148, v147
v_fmac_f32_e64 v158, v202, v202
ds_read_u16_d16 v144, v144
ds_read_u16_d16_hi v145, v145
v_or_b32_e64 v24, v136, v137
ds_read_b128 v[228:231], v248 offset:49152
v_mfma_f32_32x32x16_bf16 v[120:135], v[232:235], v[188:191], v[120:135]
s_waitcnt lgkmcnt(6)
v_or_b32 v25, v138, v139
v_fmac_f32_e64 v158, v203, v203
v_rcp_f16_sdwa v154, v153 dst_sel:WORD_1 dst_unused:UNUSED_PRESERVE src0_sel:WORD_1
v_fmac_f32 v158, v204, v204
s_waitcnt lgkmcnt(4)
v_or_b32_e64 v26, v140, v141
v_rcp_f16_sdwa v151, v150 dst_sel:WORD_1 dst_unused:UNUSED_PRESERVE src0_sel:WORD_1
v_fmac_f32 v158, v205, v205
s_waitcnt lgkmcnt(3)
v_or_b32_e64 v27, v142, v143
v_rcp_f16_sdwa v148, v147 dst_sel:WORD_1 dst_unused:UNUSED_PRESERVE src0_sel:WORD_1
v_fmac_f32 v158, v206, v206
s_waitcnt lgkmcnt(1)
v_or_b32_e64 v28, v144, v145
v_pk_mul_f16 v29, v155, v154
v_fmac_f32 v158, v207, v207
v_pk_mul_f16 v30, v152, v151
v_pk_mul_f16 v31, v149, v148
s_setprio 1
ds_read_b128 v[232:235], v248 offset:52224
v_mfma_f32_32x32x16_f16 v[192:207], v[24:27], v[208:211], 0
v_cvt_pkrtz_f16_f32 v137, v120, v121
v_cvt_pkrtz_f16_f32 v139, v122, v123
v_cvt_pkrtz_f16_f32 v141, v124, v125
v_cvt_pkrtz_f16_f32 v143, v126, v127
v_cvt_pkrtz_f16_f32 v145, v128, v129
v_mfma_f32_32x32x16_f16 v[192:207], v[28:31], v[212:215], v[192:207]
v_cvt_pk_f16_f32 v155, v130, v131
v_cvt_pk_f16_f32 v152, v132, v133
v_cvt_pk_f16_f32 v149, v134, v135
v_pk_fma_f16 v154, v155, v155, s48
v_and_b32_e64 v137, s49, v137
v_pk_fma_f16 v151, v152, v152, s48
v_mfma_f32_32x32x16_bf16 v[120:135], v[236:239], v[168:171], 0
v_and_b32 v139, s49, v139
v_pk_fma_f16 v148, v149, v149, s48
v_permlane16_swap_b32 v24, v28
v_pk_mul_f16 v154, v155, v154
v_bfe_u32 v136, v137, 2, 14
v_permlane16_swap_b32 v25, v29
v_pk_mul_f16 v151, v152, v151
v_pk_mul_f16 v148, v149, v148
v_bfe_u32 v138, v139, 2, 14
v_permlane16_swap_b32 v26, v30
ds_read_b128 v[236:239], v248 offset:53248
ds_read_u16_d16 v136, v136
ds_read_u16_d16 v138, v138
v_mfma_f32_32x32x16_bf16 v[120:135], v[216:219], v[172:175], v[120:135]
v_exp_f16 v153, v154
v_permlane16_swap_b32 v27, v31
v_lshrrev_b32 v137, 18, v137
v_exp_f16 v150, v151
v_fmac_f32 v159, v192, v192
v_lshrrev_b32 v139, 18, v139
v_exp_f16 v147, v148
v_fmac_f32 v159, v193, v193
v_and_b32_e64 v141, s49, v141
ds_read_b128 v[216:219], v248 offset:56320
ds_read_u16_d16_hi v137, v137
ds_read_u16_d16_hi v139, v139
v_mfma_f32_32x32x16_bf16 v[120:135], v[220:223], v[176:179], v[120:135]
v_and_b32 v143, s49, v143
v_fmac_f32 v159, v194, v194
v_exp_f16_sdwa v153, v154 dst_sel:WORD_1 dst_unused:UNUSED_PRESERVE src0_sel:WORD_1
v_bfe_u32 v140, v141, 2, 14
v_fmac_f32_e64 v159, v195, v195
v_exp_f16_sdwa v150, v151 dst_sel:WORD_1 dst_unused:UNUSED_PRESERVE src0_sel:WORD_1
v_fmac_f32_e64 v159, v196, v196
v_bfe_u32 v142, v143, 2, 14
ds_read_b128 v[220:223], v248 offset:54272
ds_read_u16_d16 v140, v140
ds_read_u16_d16 v142, v142
v_mfma_f32_32x32x16_bf16 v[120:135], v[224:227], v[180:183], v[120:135]
v_exp_f16_sdwa v147, v148 dst_sel:WORD_1 dst_unused:UNUSED_PRESERVE src0_sel:WORD_1
v_fmac_f32 v159, v197, v197
v_lshrrev_b32 v141, 18, v141
v_pk_add_f16 v153, v153, 1.0 op_sel_hi:[1,0]
v_lshrrev_b32 v143, 18, v143
v_fmac_f32 v159, v198, v198
v_pk_add_f16 v150, v150, 1.0 op_sel_hi:[1,0]
v_pk_add_f16 v147, v147, 1.0 op_sel_hi:[1,0]
v_fmac_f32_e64 v159, v199, v199
v_and_b32 v145, s49, v145
s_waitcnt lgkmcnt(4)
ds_read_b128 v[224:227], v248 offset:57344
ds_read_u16_d16_hi v141, v141
ds_read_u16_d16_hi v143, v143
v_mfma_f32_32x32x16_bf16 v[120:135], v[228:231], v[184:187], v[120:135]
v_rcp_f16 v154, v153
v_fmac_f32 v159, v200, v200
v_bfe_u32 v144, v145, 2, 14
v_rcp_f16 v151, v150
s_setprio 0
v_fmac_f32 v159, v201, v201
v_lshrrev_b32 v145, 18, v145
v_rcp_f16 v148, v147
v_fmac_f32 v159, v202, v202
ds_read_u16_d16 v144, v144
ds_read_u16_d16_hi v145, v145
v_or_b32_e64 v32, v136, v137
ds_read_b128 v[228:231], v248 offset:55296
v_mfma_f32_32x32x16_bf16 v[120:135], v[232:235], v[188:191], v[120:135]
s_waitcnt lgkmcnt(6)
v_or_b32 v33, v138, v139
v_fmac_f32_e64 v159, v203, v203
v_rcp_f16_sdwa v154, v153 dst_sel:WORD_1 dst_unused:UNUSED_PRESERVE src0_sel:WORD_1
v_fmac_f32 v159, v204, v204
s_waitcnt lgkmcnt(4)
v_or_b32_e64 v34, v140, v141
v_rcp_f16_sdwa v151, v150 dst_sel:WORD_1 dst_unused:UNUSED_PRESERVE src0_sel:WORD_1
v_fmac_f32 v159, v205, v205
s_waitcnt lgkmcnt(3)
v_or_b32_e64 v35, v142, v143
v_rcp_f16_sdwa v148, v147 dst_sel:WORD_1 dst_unused:UNUSED_PRESERVE src0_sel:WORD_1
v_fmac_f32 v159, v206, v206
s_waitcnt lgkmcnt(1)
v_or_b32_e64 v36, v144, v145
v_pk_mul_f16 v37, v155, v154
v_fmac_f32 v159, v207, v207
v_pk_mul_f16 v38, v152, v151
v_pk_mul_f16 v39, v149, v148
s_setprio 2
ds_read_b128 v[232:235], v248 offset:58368
v_mfma_f32_32x32x16_f16 v[192:207], v[32:35], v[208:211], 0
v_cvt_pkrtz_f16_f32 v137, v120, v121
v_cvt_pkrtz_f16_f32 v139, v122, v123
v_cvt_pkrtz_f16_f32 v141, v124, v125
v_cvt_pkrtz_f16_f32 v143, v126, v127
v_cvt_pkrtz_f16_f32 v145, v128, v129
v_mfma_f32_32x32x16_f16 v[192:207], v[36:39], v[212:215], v[192:207]
v_cvt_pk_f16_f32 v155, v130, v131
v_cvt_pk_f16_f32 v152, v132, v133
v_cvt_pk_f16_f32 v149, v134, v135
v_pk_fma_f16 v154, v155, v155, s48
v_and_b32_e64 v137, s49, v137
v_pk_fma_f16 v151, v152, v152, s48
v_mfma_f32_32x32x16_bf16 v[120:135], v[236:239], v[168:171], 0
v_and_b32 v139, s49, v139
v_pk_fma_f16 v148, v149, v149, s48
v_permlane16_swap_b32 v32, v36
v_pk_mul_f16 v154, v155, v154
v_bfe_u32 v136, v137, 2, 14
v_permlane16_swap_b32 v33, v37
v_pk_mul_f16 v151, v152, v151
v_pk_mul_f16 v148, v149, v148
v_bfe_u32 v138, v139, 2, 14
v_permlane16_swap_b32 v34, v38
ds_read_b128 v[236:239], v248 offset:59392
ds_read_u16_d16 v136, v136
ds_read_u16_d16 v138, v138
v_mfma_f32_32x32x16_bf16 v[120:135], v[216:219], v[172:175], v[120:135]
v_exp_f16 v153, v154
v_permlane16_swap_b32 v35, v39
v_lshrrev_b32 v137, 18, v137
v_exp_f16 v150, v151
v_fmac_f32 v160, v192, v192
v_lshrrev_b32 v139, 18, v139
v_exp_f16 v147, v148
v_fmac_f32 v160, v193, v193
v_and_b32_e64 v141, s49, v141
ds_read_b128 v[216:219], v248 offset:62464
ds_read_u16_d16_hi v137, v137
ds_read_u16_d16_hi v139, v139
v_mfma_f32_32x32x16_bf16 v[120:135], v[220:223], v[176:179], v[120:135]
v_and_b32 v143, s49, v143
v_fmac_f32 v160, v194, v194
v_exp_f16_sdwa v153, v154 dst_sel:WORD_1 dst_unused:UNUSED_PRESERVE src0_sel:WORD_1
v_bfe_u32 v140, v141, 2, 14
v_fmac_f32_e64 v160, v195, v195
v_exp_f16_sdwa v150, v151 dst_sel:WORD_1 dst_unused:UNUSED_PRESERVE src0_sel:WORD_1
v_fmac_f32_e64 v160, v196, v196
v_bfe_u32 v142, v143, 2, 14
ds_read_b128 v[220:223], v248 offset:60416
ds_read_u16_d16 v140, v140
ds_read_u16_d16 v142, v142
v_mfma_f32_32x32x16_bf16 v[120:135], v[224:227], v[180:183], v[120:135]
v_exp_f16_sdwa v147, v148 dst_sel:WORD_1 dst_unused:UNUSED_PRESERVE src0_sel:WORD_1
v_fmac_f32 v160, v197, v197
v_lshrrev_b32 v141, 18, v141
v_pk_add_f16 v153, v153, 1.0 op_sel_hi:[1,0]
v_lshrrev_b32 v143, 18, v143
v_fmac_f32 v160, v198, v198
v_pk_add_f16 v150, v150, 1.0 op_sel_hi:[1,0]
v_pk_add_f16 v147, v147, 1.0 op_sel_hi:[1,0]
v_fmac_f32_e64 v160, v199, v199
v_and_b32 v145, s49, v145
s_waitcnt lgkmcnt(4)
ds_read_b128 v[224:227], v248 offset:63488
ds_read_u16_d16_hi v141, v141
ds_read_u16_d16_hi v143, v143
v_mfma_f32_32x32x16_bf16 v[120:135], v[228:231], v[184:187], v[120:135]
v_rcp_f16 v154, v153
v_fmac_f32 v160, v200, v200
v_bfe_u32 v144, v145, 2, 14
v_rcp_f16 v151, v150
v_fmac_f32 v160, v201, v201
v_lshrrev_b32 v145, 18, v145
v_rcp_f16 v148, v147
v_fmac_f32_e64 v160, v202, v202
ds_read_u16_d16 v144, v144
ds_read_u16_d16_hi v145, v145
v_or_b32_e64 v40, v136, v137
ds_read_b128 v[228:231], v248 offset:61440
v_mfma_f32_32x32x16_bf16 v[120:135], v[232:235], v[188:191], v[120:135]
s_waitcnt lgkmcnt(6)
v_or_b32 v41, v138, v139
v_fmac_f32_e64 v160, v203, v203
v_rcp_f16_sdwa v154, v153 dst_sel:WORD_1 dst_unused:UNUSED_PRESERVE src0_sel:WORD_1
v_fmac_f32 v160, v204, v204
s_waitcnt lgkmcnt(4)
v_or_b32_e64 v42, v140, v141
v_rcp_f16_sdwa v151, v150 dst_sel:WORD_1 dst_unused:UNUSED_PRESERVE src0_sel:WORD_1
v_fmac_f32 v160, v205, v205
s_waitcnt lgkmcnt(3)
v_or_b32_e64 v43, v142, v143
v_rcp_f16_sdwa v148, v147 dst_sel:WORD_1 dst_unused:UNUSED_PRESERVE src0_sel:WORD_1
v_fmac_f32 v160, v206, v206
s_waitcnt lgkmcnt(1)
v_or_b32_e64 v44, v144, v145
v_pk_mul_f16 v45, v155, v154
v_fmac_f32_e64 v160, v207, v207
v_pk_mul_f16 v46, v152, v151
v_pk_mul_f16 v47, v149, v148
s_cmp_lg_u32 s40, 0
s_cbranch_scc1 Lrs1
v_mov_b32 v90, 0
Lpi:
s_waitcnt vmcnt(0)
v_readfirstlane_b32 s43, v91
s_cmp_eq_u32 s76, 0
s_cbranch_scc1 Lpix
s_sub_u32 s76, s76, 1
s_cmp_ge_u32 s43, 256
s_cbranch_scc1 Lpix
buffer_load_dword v91, v90, s[36:39], 0 offen sc1
s_branch Lpi
Lpix:
v_min_u32_e64 v88, 47, v251
v_lshlrev_b32 v88, 3, v88
s_and_b32 s44, s2, 7
s_lshl_b32 s44, s44, 11
s_add_u32 s44, s44, 394752
buffer_load_dwordx2 v[92:93], v88, s[32:35], s44 offen sc1
Lrs1:
s_setprio 1
ds_read_b128 v[232:235], v248 offset:64512
v_mfma_f32_32x32x16_f16 v[192:207], v[40:43], v[208:211], 0
v_cvt_pkrtz_f16_f32 v137, v120, v121
v_cvt_pkrtz_f16_f32 v139, v122, v123
v_cvt_pkrtz_f16_f32 v141, v124, v125
v_cvt_pkrtz_f16_f32 v143, v126, v127
v_cvt_pkrtz_f16_f32 v145, v128, v129
v_mfma_f32_32x32x16_f16 v[192:207], v[44:47], v[212:215], v[192:207]
v_cvt_pk_f16_f32 v155, v130, v131
v_cvt_pk_f16_f32 v152, v132, v133
v_cvt_pk_f16_f32 v149, v134, v135
v_pk_fma_f16 v154, v155, v155, s48
v_and_b32_e64 v137, s49, v137
v_pk_fma_f16 v151, v152, v152, s48
v_mfma_f32_32x32x16_bf16 v[120:135], v[236:239], v[168:171], 0
v_and_b32 v139, s49, v139
v_pk_fma_f16 v148, v149, v149, s48
v_permlane16_swap_b32 v40, v44
v_pk_mul_f16 v154, v155, v154
v_bfe_u32 v136, v137, 2, 14
v_permlane16_swap_b32 v41, v45
v_pk_mul_f16 v151, v152, v151
v_pk_mul_f16 v148, v149, v148
v_bfe_u32 v138, v139, 2, 14
v_permlane16_swap_b32 v42, v46
ds_read_b128 v[236:239], v249
ds_read_u16_d16 v136, v136
ds_read_u16_d16 v138, v138
v_mfma_f32_32x32x16_bf16 v[120:135], v[216:219], v[172:175], v[120:135]
v_exp_f16 v153, v154
v_permlane16_swap_b32 v43, v47
v_lshrrev_b32 v137, 18, v137
v_exp_f16 v150, v151
v_fmac_f32 v161, v192, v192
v_lshrrev_b32 v139, 18, v139
v_exp_f16 v147, v148
v_fmac_f32 v161, v193, v193
v_and_b32_e64 v141, s49, v141
ds_read_b128 v[216:219], v249 offset:3072
ds_read_u16_d16_hi v137, v137
ds_read_u16_d16_hi v139, v139
v_mfma_f32_32x32x16_bf16 v[120:135], v[220:223], v[176:179], v[120:135]
v_and_b32 v143, s49, v143
v_fmac_f32 v161, v194, v194
v_exp_f16_sdwa v153, v154 dst_sel:WORD_1 dst_unused:UNUSED_PRESERVE src0_sel:WORD_1
v_bfe_u32 v140, v141, 2, 14
v_fmac_f32_e64 v161, v195, v195
v_exp_f16_sdwa v150, v151 dst_sel:WORD_1 dst_unused:UNUSED_PRESERVE src0_sel:WORD_1
v_fmac_f32_e64 v161, v196, v196
v_bfe_u32 v142, v143, 2, 14
ds_read_b128 v[220:223], v249 offset:1024
ds_read_u16_d16 v140, v140
ds_read_u16_d16 v142, v142
v_mfma_f32_32x32x16_bf16 v[120:135], v[224:227], v[180:183], v[120:135]
v_exp_f16_sdwa v147, v148 dst_sel:WORD_1 dst_unused:UNUSED_PRESERVE src0_sel:WORD_1
v_fmac_f32 v161, v197, v197
v_lshrrev_b32 v141, 18, v141
v_pk_add_f16 v153, v153, 1.0 op_sel_hi:[1,0]
v_lshrrev_b32 v143, 18, v143
v_fmac_f32 v161, v198, v198
v_pk_add_f16 v150, v150, 1.0 op_sel_hi:[1,0]
v_pk_add_f16 v147, v147, 1.0 op_sel_hi:[1,0]
v_fmac_f32_e64 v161, v199, v199
v_and_b32 v145, s49, v145
s_waitcnt lgkmcnt(4)
ds_read_b128 v[224:227], v249 offset:4096
ds_read_u16_d16_hi v141, v141
ds_read_u16_d16_hi v143, v143
v_mfma_f32_32x32x16_bf16 v[120:135], v[228:231], v[184:187], v[120:135]
v_rcp_f16 v154, v153
v_fmac_f32 v161, v200, v200
v_bfe_u32 v144, v145, 2, 14
v_rcp_f16 v151, v150
s_setprio 0
v_fmac_f32 v161, v201, v201
v_lshrrev_b32 v145, 18, v145
v_rcp_f16 v148, v147
v_fmac_f32 v161, v202, v202
ds_read_u16_d16 v144, v144
ds_read_u16_d16_hi v145, v145
v_or_b32_e64 v48, v136, v137
ds_read_b128 v[228:231], v249 offset:2048
v_mfma_f32_32x32x16_bf16 v[120:135], v[232:235], v[188:191], v[120:135]
s_waitcnt lgkmcnt(6)
v_or_b32 v49, v138, v139
v_fmac_f32_e64 v161, v203, v203
v_rcp_f16_sdwa v154, v153 dst_sel:WORD_1 dst_unused:UNUSED_PRESERVE src0_sel:WORD_1
v_fmac_f32 v161, v204, v204
s_waitcnt lgkmcnt(4)
v_or_b32_e64 v50, v140, v141
v_rcp_f16_sdwa v151, v150 dst_sel:WORD_1 dst_unused:UNUSED_PRESERVE src0_sel:WORD_1
v_fmac_f32 v161, v205, v205
s_waitcnt lgkmcnt(3)
v_or_b32_e64 v51, v142, v143
v_rcp_f16_sdwa v148, v147 dst_sel:WORD_1 dst_unused:UNUSED_PRESERVE src0_sel:WORD_1
v_fmac_f32 v161, v206, v206
s_waitcnt lgkmcnt(1)
v_or_b32_e64 v52, v144, v145
v_pk_mul_f16 v53, v155, v154
v_fmac_f32 v161, v207, v207
v_pk_mul_f16 v54, v152, v151
v_pk_mul_f16 v55, v149, v148
s_setprio 2
ds_read_b128 v[232:235], v249 offset:5120
v_mfma_f32_32x32x16_f16 v[192:207], v[48:51], v[208:211], 0
v_cvt_pkrtz_f16_f32 v137, v120, v121
v_cvt_pkrtz_f16_f32 v139, v122, v123
v_cvt_pkrtz_f16_f32 v141, v124, v125
v_cvt_pkrtz_f16_f32 v143, v126, v127
v_cvt_pkrtz_f16_f32 v145, v128, v129
v_mfma_f32_32x32x16_f16 v[192:207], v[52:55], v[212:215], v[192:207]
v_cvt_pk_f16_f32 v155, v130, v131
v_cvt_pk_f16_f32 v152, v132, v133
v_cvt_pk_f16_f32 v149, v134, v135
v_pk_fma_f16 v154, v155, v155, s48
v_and_b32_e64 v137, s49, v137
v_pk_fma_f16 v151, v152, v152, s48
v_mfma_f32_32x32x16_bf16 v[120:135], v[236:239], v[168:171], 0
v_and_b32 v139, s49, v139
v_pk_fma_f16 v148, v149, v149, s48
v_permlane16_swap_b32 v48, v52
v_pk_mul_f16 v154, v155, v154
v_bfe_u32 v136, v137, 2, 14
v_permlane16_swap_b32 v49, v53
v_pk_mul_f16 v151, v152, v151
v_pk_mul_f16 v148, v149, v148
v_bfe_u32 v138, v139, 2, 14
v_permlane16_swap_b32 v50, v54
ds_read_b128 v[236:239], v249 offset:6144
ds_read_u16_d16 v136, v136
ds_read_u16_d16 v138, v138
v_mfma_f32_32x32x16_bf16 v[120:135], v[216:219], v[172:175], v[120:135]
v_exp_f16 v153, v154
v_permlane16_swap_b32 v51, v55
v_lshrrev_b32 v137, 18, v137
v_exp_f16 v150, v151
v_fmac_f32 v162, v192, v192
v_lshrrev_b32 v139, 18, v139
v_exp_f16 v147, v148
v_fmac_f32 v162, v193, v193
v_and_b32_e64 v141, s49, v141
ds_read_b128 v[216:219], v249 offset:9216
ds_read_u16_d16_hi v137, v137
ds_read_u16_d16_hi v139, v139
v_mfma_f32_32x32x16_bf16 v[120:135], v[220:223], v[176:179], v[120:135]
v_and_b32 v143, s49, v143
v_fmac_f32 v162, v194, v194
v_exp_f16_sdwa v153, v154 dst_sel:WORD_1 dst_unused:UNUSED_PRESERVE src0_sel:WORD_1
v_bfe_u32 v140, v141, 2, 14
v_fmac_f32_e64 v162, v195, v195
v_exp_f16_sdwa v150, v151 dst_sel:WORD_1 dst_unused:UNUSED_PRESERVE src0_sel:WORD_1
v_fmac_f32_e64 v162, v196, v196
v_bfe_u32 v142, v143, 2, 14
ds_read_b128 v[220:223], v249 offset:7168
ds_read_u16_d16 v140, v140
ds_read_u16_d16 v142, v142
v_mfma_f32_32x32x16_bf16 v[120:135], v[224:227], v[180:183], v[120:135]
v_exp_f16_sdwa v147, v148 dst_sel:WORD_1 dst_unused:UNUSED_PRESERVE src0_sel:WORD_1
v_fmac_f32 v162, v197, v197
v_lshrrev_b32 v141, 18, v141
v_pk_add_f16 v153, v153, 1.0 op_sel_hi:[1,0]
v_lshrrev_b32 v143, 18, v143
v_fmac_f32 v162, v198, v198
v_pk_add_f16 v150, v150, 1.0 op_sel_hi:[1,0]
v_pk_add_f16 v147, v147, 1.0 op_sel_hi:[1,0]
v_fmac_f32_e64 v162, v199, v199
v_and_b32 v145, s49, v145
s_waitcnt lgkmcnt(4)
ds_read_b128 v[224:227], v249 offset:10240
ds_read_u16_d16_hi v141, v141
ds_read_u16_d16_hi v143, v143
v_mfma_f32_32x32x16_bf16 v[120:135], v[228:231], v[184:187], v[120:135]
v_rcp_f16 v154, v153
v_fmac_f32 v162, v200, v200
v_bfe_u32 v144, v145, 2, 14
v_rcp_f16 v151, v150
v_fmac_f32 v162, v201, v201
v_lshrrev_b32 v145, 18, v145
v_rcp_f16 v148, v147
v_fmac_f32_e64 v162, v202, v202
ds_read_u16_d16 v144, v144
ds_read_u16_d16_hi v145, v145
v_or_b32_e64 v56, v136, v137
ds_read_b128 v[228:231], v249 offset:8192
v_mfma_f32_32x32x16_bf16 v[120:135], v[232:235], v[188:191], v[120:135]
s_waitcnt lgkmcnt(6)
v_or_b32 v57, v138, v139
v_fmac_f32_e64 v162, v203, v203
v_rcp_f16_sdwa v154, v153 dst_sel:WORD_1 dst_unused:UNUSED_PRESERVE src0_sel:WORD_1
v_fmac_f32 v162, v204, v204
s_waitcnt lgkmcnt(4)
v_or_b32_e64 v58, v140, v141
v_rcp_f16_sdwa v151, v150 dst_sel:WORD_1 dst_unused:UNUSED_PRESERVE src0_sel:WORD_1
v_fmac_f32 v162, v205, v205
s_waitcnt lgkmcnt(3)
v_or_b32_e64 v59, v142, v143
v_rcp_f16_sdwa v148, v147 dst_sel:WORD_1 dst_unused:UNUSED_PRESERVE src0_sel:WORD_1
v_fmac_f32 v162, v206, v206
s_waitcnt lgkmcnt(1)
v_or_b32_e64 v60, v144, v145
v_pk_mul_f16 v61, v155, v154
v_fmac_f32 v162, v207, v207
v_pk_mul_f16 v62, v152, v151
v_pk_mul_f16 v63, v149, v148
s_setprio 1
ds_read_b128 v[232:235], v249 offset:11264
v_mfma_f32_32x32x16_f16 v[192:207], v[56:59], v[208:211], 0
v_cvt_pkrtz_f16_f32 v137, v120, v121
v_cvt_pkrtz_f16_f32 v139, v122, v123
v_cvt_pkrtz_f16_f32 v141, v124, v125
v_cvt_pkrtz_f16_f32 v143, v126, v127
v_cvt_pkrtz_f16_f32 v145, v128, v129
v_mfma_f32_32x32x16_f16 v[192:207], v[60:63], v[212:215], v[192:207]
v_cvt_pk_f16_f32 v155, v130, v131
v_cvt_pk_f16_f32 v152, v132, v133
v_cvt_pk_f16_f32 v149, v134, v135
v_pk_fma_f16 v154, v155, v155, s48
v_and_b32_e64 v137, s49, v137
v_pk_fma_f16 v151, v152, v152, s48
v_mfma_f32_32x32x16_bf16 v[120:135], v[236:239], v[168:171], 0
v_and_b32 v139, s49, v139
v_pk_fma_f16 v148, v149, v149, s48
v_permlane16_swap_b32 v56, v60
v_pk_mul_f16 v154, v155, v154
v_bfe_u32 v136, v137, 2, 14
v_permlane16_swap_b32 v57, v61
v_pk_mul_f16 v151, v152, v151
v_pk_mul_f16 v148, v149, v148
v_bfe_u32 v138, v139, 2, 14
v_permlane16_swap_b32 v58, v62
ds_read_b128 v[236:239], v249 offset:12288
ds_read_u16_d16 v136, v136
ds_read_u16_d16 v138, v138
v_mfma_f32_32x32x16_bf16 v[120:135], v[216:219], v[172:175], v[120:135]
v_exp_f16 v153, v154
v_permlane16_swap_b32 v59, v63
v_lshrrev_b32 v137, 18, v137
v_exp_f16 v150, v151
v_fmac_f32 v163, v192, v192
v_lshrrev_b32 v139, 18, v139
v_exp_f16 v147, v148
v_fmac_f32 v163, v193, v193
v_and_b32_e64 v141, s49, v141
ds_read_b128 v[216:219], v249 offset:15360
ds_read_u16_d16_hi v137, v137
ds_read_u16_d16_hi v139, v139
v_mfma_f32_32x32x16_bf16 v[120:135], v[220:223], v[176:179], v[120:135]
v_and_b32 v143, s49, v143
v_fmac_f32 v163, v194, v194
v_exp_f16_sdwa v153, v154 dst_sel:WORD_1 dst_unused:UNUSED_PRESERVE src0_sel:WORD_1
v_bfe_u32 v140, v141, 2, 14
v_fmac_f32_e64 v163, v195, v195
v_exp_f16_sdwa v150, v151 dst_sel:WORD_1 dst_unused:UNUSED_PRESERVE src0_sel:WORD_1
v_fmac_f32_e64 v163, v196, v196
v_bfe_u32 v142, v143, 2, 14
ds_read_b128 v[220:223], v249 offset:13312
ds_read_u16_d16 v140, v140
ds_read_u16_d16 v142, v142
v_mfma_f32_32x32x16_bf16 v[120:135], v[224:227], v[180:183], v[120:135]
v_exp_f16_sdwa v147, v148 dst_sel:WORD_1 dst_unused:UNUSED_PRESERVE src0_sel:WORD_1
v_fmac_f32 v163, v197, v197
v_lshrrev_b32 v141, 18, v141
v_pk_add_f16 v153, v153, 1.0 op_sel_hi:[1,0]
v_lshrrev_b32 v143, 18, v143
v_fmac_f32 v163, v198, v198
v_pk_add_f16 v150, v150, 1.0 op_sel_hi:[1,0]
v_pk_add_f16 v147, v147, 1.0 op_sel_hi:[1,0]
v_fmac_f32_e64 v163, v199, v199
v_and_b32 v145, s49, v145
s_waitcnt lgkmcnt(4)
ds_read_b128 v[224:227], v249 offset:16384
ds_read_u16_d16_hi v141, v141
ds_read_u16_d16_hi v143, v143
v_mfma_f32_32x32x16_bf16 v[120:135], v[228:231], v[184:187], v[120:135]
v_rcp_f16 v154, v153
v_fmac_f32 v163, v200, v200
v_bfe_u32 v144, v145, 2, 14
v_rcp_f16 v151, v150
s_setprio 0
v_fmac_f32 v163, v201, v201
v_lshrrev_b32 v145, 18, v145
v_rcp_f16 v148, v147
v_fmac_f32 v163, v202, v202
ds_read_u16_d16 v144, v144
ds_read_u16_d16_hi v145, v145
v_or_b32_e64 v64, v136, v137
ds_read_b128 v[228:231], v249 offset:14336
v_mfma_f32_32x32x16_bf16 v[120:135], v[232:235], v[188:191], v[120:135]
s_waitcnt lgkmcnt(6)
v_or_b32 v65, v138, v139
v_fmac_f32_e64 v163, v203, v203
v_rcp_f16_sdwa v154, v153 dst_sel:WORD_1 dst_unused:UNUSED_PRESERVE src0_sel:WORD_1
v_fmac_f32 v163, v204, v204
s_waitcnt lgkmcnt(4)
v_or_b32_e64 v66, v140, v141
v_rcp_f16_sdwa v151, v150 dst_sel:WORD_1 dst_unused:UNUSED_PRESERVE src0_sel:WORD_1
v_fmac_f32 v163, v205, v205
s_waitcnt lgkmcnt(3)
v_or_b32_e64 v67, v142, v143
v_rcp_f16_sdwa v148, v147 dst_sel:WORD_1 dst_unused:UNUSED_PRESERVE src0_sel:WORD_1
v_fmac_f32 v163, v206, v206
s_waitcnt lgkmcnt(1)
v_or_b32_e64 v68, v144, v145
v_pk_mul_f16 v69, v155, v154
v_fmac_f32 v163, v207, v207
v_pk_mul_f16 v70, v152, v151
v_pk_mul_f16 v71, v149, v148
s_setprio 2
ds_read_b128 v[232:235], v249 offset:17408
v_mfma_f32_32x32x16_f16 v[192:207], v[64:67], v[208:211], 0
v_cvt_pkrtz_f16_f32 v137, v120, v121
v_cvt_pkrtz_f16_f32 v139, v122, v123
v_cvt_pkrtz_f16_f32 v141, v124, v125
v_cvt_pkrtz_f16_f32 v143, v126, v127
v_cvt_pkrtz_f16_f32 v145, v128, v129
v_mfma_f32_32x32x16_f16 v[192:207], v[68:71], v[212:215], v[192:207]
v_cvt_pk_f16_f32 v155, v130, v131
v_cvt_pk_f16_f32 v152, v132, v133
v_cvt_pk_f16_f32 v149, v134, v135
v_pk_fma_f16 v154, v155, v155, s48
v_and_b32_e64 v137, s49, v137
v_pk_fma_f16 v151, v152, v152, s48
v_mfma_f32_32x32x16_bf16 v[120:135], v[236:239], v[168:171], 0
v_and_b32 v139, s49, v139
v_pk_fma_f16 v148, v149, v149, s48
v_permlane16_swap_b32 v64, v68
v_pk_mul_f16 v154, v155, v154
v_bfe_u32 v136, v137, 2, 14
v_permlane16_swap_b32 v65, v69
v_pk_mul_f16 v151, v152, v151
v_pk_mul_f16 v148, v149, v148
v_bfe_u32 v138, v139, 2, 14
v_permlane16_swap_b32 v66, v70
ds_read_b128 v[236:239], v249 offset:18432
ds_read_u16_d16 v136, v136
ds_read_u16_d16 v138, v138
v_mfma_f32_32x32x16_bf16 v[120:135], v[216:219], v[172:175], v[120:135]
v_exp_f16 v153, v154
v_permlane16_swap_b32 v67, v71
v_lshrrev_b32 v137, 18, v137
v_exp_f16 v150, v151
v_fmac_f32 v164, v192, v192
v_lshrrev_b32 v139, 18, v139
v_exp_f16 v147, v148
v_fmac_f32 v164, v193, v193
v_and_b32_e64 v141, s49, v141
ds_read_b128 v[216:219], v249 offset:21504
ds_read_u16_d16_hi v137, v137
ds_read_u16_d16_hi v139, v139
v_mfma_f32_32x32x16_bf16 v[120:135], v[220:223], v[176:179], v[120:135]
v_and_b32 v143, s49, v143
v_fmac_f32 v164, v194, v194
v_exp_f16_sdwa v153, v154 dst_sel:WORD_1 dst_unused:UNUSED_PRESERVE src0_sel:WORD_1
v_bfe_u32 v140, v141, 2, 14
v_fmac_f32_e64 v164, v195, v195
v_exp_f16_sdwa v150, v151 dst_sel:WORD_1 dst_unused:UNUSED_PRESERVE src0_sel:WORD_1
v_fmac_f32_e64 v164, v196, v196
v_bfe_u32 v142, v143, 2, 14
ds_read_b128 v[220:223], v249 offset:19456
ds_read_u16_d16 v140, v140
ds_read_u16_d16 v142, v142
v_mfma_f32_32x32x16_bf16 v[120:135], v[224:227], v[180:183], v[120:135]
v_exp_f16_sdwa v147, v148 dst_sel:WORD_1 dst_unused:UNUSED_PRESERVE src0_sel:WORD_1
v_fmac_f32 v164, v197, v197
v_lshrrev_b32 v141, 18, v141
v_pk_add_f16 v153, v153, 1.0 op_sel_hi:[1,0]
v_lshrrev_b32 v143, 18, v143
v_fmac_f32 v164, v198, v198
v_pk_add_f16 v150, v150, 1.0 op_sel_hi:[1,0]
v_pk_add_f16 v147, v147, 1.0 op_sel_hi:[1,0]
v_fmac_f32_e64 v164, v199, v199
v_and_b32 v145, s49, v145
s_waitcnt lgkmcnt(4)
ds_read_b128 v[224:227], v249 offset:22528
ds_read_u16_d16_hi v141, v141
ds_read_u16_d16_hi v143, v143
v_mfma_f32_32x32x16_bf16 v[120:135], v[228:231], v[184:187], v[120:135]
v_rcp_f16 v154, v153
v_fmac_f32 v164, v200, v200
v_bfe_u32 v144, v145, 2, 14
v_rcp_f16 v151, v150
v_fmac_f32 v164, v201, v201
v_lshrrev_b32 v145, 18, v145
v_rcp_f16 v148, v147
v_fmac_f32_e64 v164, v202, v202
ds_read_u16_d16 v144, v144
ds_read_u16_d16_hi v145, v145
v_or_b32_e64 v72, v136, v137
ds_read_b128 v[228:231], v249 offset:20480
v_mfma_f32_32x32x16_bf16 v[120:135], v[232:235], v[188:191], v[120:135]
s_waitcnt lgkmcnt(6)
v_or_b32 v73, v138, v139
v_fmac_f32_e64 v164, v203, v203
v_rcp_f16_sdwa v154, v153 dst_sel:WORD_1 dst_unused:UNUSED_PRESERVE src0_sel:WORD_1
v_fmac_f32 v164, v204, v204
s_waitcnt lgkmcnt(4)
v_or_b32_e64 v74, v140, v141
v_rcp_f16_sdwa v151, v150 dst_sel:WORD_1 dst_unused:UNUSED_PRESERVE src0_sel:WORD_1
v_fmac_f32 v164, v205, v205
s_waitcnt lgkmcnt(3)
v_or_b32_e64 v75, v142, v143
v_rcp_f16_sdwa v148, v147 dst_sel:WORD_1 dst_unused:UNUSED_PRESERVE src0_sel:WORD_1
v_fmac_f32 v164, v206, v206
s_waitcnt lgkmcnt(1)
v_or_b32_e64 v76, v144, v145
v_pk_mul_f16 v77, v155, v154
v_fmac_f32_e64 v164, v207, v207
v_pk_mul_f16 v78, v152, v151
v_pk_mul_f16 v79, v149, v148
s_cmp_lg_u32 s40, 0
s_cbranch_scc1 Lrs2
v_min_u32_e64 v88, 47, v251
v_lshlrev_b32 v88, 3, v88
v_add_u32 v89, 7936, v88
v_add_u32 v88, 15872, v88
v_cmp_gt_u32 vcc, 32, v251
s_nop 1
v_cndmask_b32 v88, v88, v89, vcc
s_waitcnt vmcnt(0)
ds_write_b64 v88, v[92:93]
Lrs2:
s_setprio 1
ds_read_b128 v[232:235], v249 offset:23552
v_mfma_f32_32x32x16_f16 v[192:207], v[72:75], v[208:211], 0
v_cvt_pkrtz_f16_f32 v137, v120, v121
v_cvt_pkrtz_f16_f32 v139, v122, v123
v_cvt_pkrtz_f16_f32 v141, v124, v125
v_cvt_pkrtz_f16_f32 v143, v126, v127
v_cvt_pkrtz_f16_f32 v145, v128, v129
v_mfma_f32_32x32x16_f16 v[192:207], v[76:79], v[212:215], v[192:207]
v_cvt_pk_f16_f32 v155, v130, v131
v_cvt_pk_f16_f32 v152, v132, v133
v_cvt_pk_f16_f32 v149, v134, v135
v_pk_fma_f16 v154, v155, v155, s48
v_and_b32_e64 v137, s49, v137
v_pk_fma_f16 v151, v152, v152, s48
v_mfma_f32_32x32x16_bf16 v[120:135], v[236:239], v[168:171], 0
v_and_b32 v139, s49, v139
v_pk_fma_f16 v148, v149, v149, s48
v_permlane16_swap_b32 v72, v76
v_pk_mul_f16 v154, v155, v154
v_bfe_u32 v136, v137, 2, 14
v_permlane16_swap_b32 v73, v77
v_pk_mul_f16 v151, v152, v151
v_pk_mul_f16 v148, v149, v148
v_bfe_u32 v138, v139, 2, 14
v_permlane16_swap_b32 v74, v78
ds_read_u16_d16 v136, v136
ds_read_u16_d16 v138, v138
v_mfma_f32_32x32x16_bf16 v[120:135], v[216:219], v[172:175], v[120:135]
v_exp_f16 v153, v154
v_permlane16_swap_b32 v75, v79
v_lshrrev_b32 v137, 18, v137
v_exp_f16 v150, v151
v_fmac_f32 v165, v192, v192
v_lshrrev_b32 v139, 18, v139
v_exp_f16 v147, v148
v_fmac_f32 v165, v193, v193
v_and_b32_e64 v141, s49, v141
ds_read_u16_d16_hi v137, v137
ds_read_u16_d16_hi v139, v139
v_mfma_f32_32x32x16_bf16 v[120:135], v[220:223], v[176:179], v[120:135]
v_and_b32 v143, s49, v143
v_fmac_f32 v165, v194, v194
v_exp_f16_sdwa v153, v154 dst_sel:WORD_1 dst_unused:UNUSED_PRESERVE src0_sel:WORD_1
v_bfe_u32 v140, v141, 2, 14
v_fmac_f32_e64 v165, v195, v195
v_exp_f16_sdwa v150, v151 dst_sel:WORD_1 dst_unused:UNUSED_PRESERVE src0_sel:WORD_1
v_fmac_f32_e64 v165, v196, v196
v_bfe_u32 v142, v143, 2, 14
ds_read_u16_d16 v140, v140
ds_read_u16_d16 v142, v142
v_mfma_f32_32x32x16_bf16 v[120:135], v[224:227], v[180:183], v[120:135]
v_exp_f16_sdwa v147, v148 dst_sel:WORD_1 dst_unused:UNUSED_PRESERVE src0_sel:WORD_1
v_fmac_f32 v165, v197, v197
v_lshrrev_b32 v141, 18, v141
v_pk_add_f16 v153, v153, 1.0 op_sel_hi:[1,0]
v_lshrrev_b32 v143, 18, v143
v_fmac_f32 v165, v198, v198
v_pk_add_f16 v150, v150, 1.0 op_sel_hi:[1,0]
v_pk_add_f16 v147, v147, 1.0 op_sel_hi:[1,0]
v_fmac_f32_e64 v165, v199, v199
v_and_b32 v145, s49, v145
s_waitcnt lgkmcnt(4)
ds_read_u16_d16_hi v141, v141
ds_read_u16_d16_hi v143, v143
v_mfma_f32_32x32x16_bf16 v[120:135], v[228:231], v[184:187], v[120:135]
v_rcp_f16 v154, v153
v_fmac_f32 v165, v200, v200
v_bfe_u32 v144, v145, 2, 14
v_rcp_f16 v151, v150
s_setprio 0
v_fmac_f32 v165, v201, v201
v_lshrrev_b32 v145, 18, v145
v_rcp_f16 v148, v147
v_fmac_f32 v165, v202, v202
ds_read_u16_d16 v144, v144
ds_read_u16_d16_hi v145, v145
s_waitcnt lgkmcnt(4)
v_or_b32 v80, v136, v137
v_mfma_f32_32x32x16_bf16 v[120:135], v[232:235], v[188:191], v[120:135]
v_or_b32 v81, v138, v139
v_fmac_f32 v165, v203, v203
v_rcp_f16_sdwa v154, v153 dst_sel:WORD_1 dst_unused:UNUSED_PRESERVE src0_sel:WORD_1
v_fmac_f32 v165, v204, v204
s_waitcnt lgkmcnt(3)
v_or_b32_e64 v82, v140, v141
v_rcp_f16_sdwa v151, v150 dst_sel:WORD_1 dst_unused:UNUSED_PRESERVE src0_sel:WORD_1
v_fmac_f32 v165, v205, v205
s_waitcnt lgkmcnt(2)
v_or_b32_e64 v83, v142, v143
v_rcp_f16_sdwa v148, v147 dst_sel:WORD_1 dst_unused:UNUSED_PRESERVE src0_sel:WORD_1
v_fmac_f32 v165, v206, v206
s_waitcnt lgkmcnt(0)
v_or_b32_e64 v84, v144, v145
v_pk_mul_f16 v85, v155, v154
v_fmac_f32 v165, v207, v207
v_pk_mul_f16 v86, v152, v151
v_pk_mul_f16 v87, v149, v148
s_setprio 2
v_mfma_f32_32x32x16_f16 v[192:207], v[80:83], v[208:211], 0
v_mfma_f32_32x32x16_f16 v[192:207], v[84:87], v[212:215], v[192:207]
v_cvt_pkrtz_f16_f32 v137, v120, v121
v_cvt_pkrtz_f16_f32 v139, v122, v123
v_cvt_pkrtz_f16_f32 v141, v124, v125
v_cvt_pkrtz_f16_f32 v143, v126, v127
v_cvt_pkrtz_f16_f32 v145, v128, v129
v_cvt_pk_f16_f32 v155, v130, v131
v_cvt_pk_f16_f32 v152, v132, v133
v_cvt_pk_f16_f32 v149, v134, v135
v_pk_fma_f16 v154, v155, v155, s48
v_and_b32_e64 v137, s49, v137
v_pk_fma_f16 v151, v152, v152, s48
v_and_b32_e64 v139, s49, v139
v_pk_fma_f16 v148, v149, v149, s48
v_permlane16_swap_b32 v80, v84
v_pk_mul_f16 v154, v155, v154
v_bfe_u32 v136, v137, 2, 14
v_permlane16_swap_b32 v81, v85
v_pk_mul_f16 v151, v152, v151
v_pk_mul_f16 v148, v149, v148
v_bfe_u32 v138, v139, 2, 14
v_permlane16_swap_b32 v82, v86
v_exp_f16 v153, v154
v_permlane16_swap_b32 v83, v87
v_lshrrev_b32 v137, 18, v137
v_exp_f16 v150, v151
v_fmac_f32 v166, v192, v192
v_lshrrev_b32 v139, 18, v139
v_exp_f16 v147, v148
v_fmac_f32 v166, v193, v193
v_and_b32 v141, s49, v141
v_and_b32_e64 v143, s49, v143
ds_read_u16_d16 v136, v136
ds_read_u16_d16 v138, v138
ds_read_u16_d16_hi v137, v137
ds_read_u16_d16_hi v139, v139
v_fmac_f32_e64 v166, v194, v194
v_exp_f16_sdwa v153, v154 dst_sel:WORD_1 dst_unused:UNUSED_PRESERVE src0_sel:WORD_1
v_bfe_u32 v140, v141, 2, 14
v_fmac_f32_e64 v166, v195, v195
v_exp_f16_sdwa v150, v151 dst_sel:WORD_1 dst_unused:UNUSED_PRESERVE src0_sel:WORD_1
v_fmac_f32_e64 v166, v196, v196
v_bfe_u32 v142, v143, 2, 14
v_exp_f16_sdwa v147, v148 dst_sel:WORD_1 dst_unused:UNUSED_PRESERVE src0_sel:WORD_1
v_fmac_f32 v166, v197, v197
v_lshrrev_b32 v141, 18, v141
v_pk_add_f16 v153, v153, 1.0 op_sel_hi:[1,0]
v_lshrrev_b32 v143, 18, v143
v_fmac_f32 v166, v198, v198
v_pk_add_f16 v150, v150, 1.0 op_sel_hi:[1,0]
v_pk_add_f16 v147, v147, 1.0 op_sel_hi:[1,0]
v_fmac_f32 v166, v199, v199
v_and_b32 v145, s49, v145
v_rcp_f16 v154, v153
v_fmac_f32 v166, v200, v200
v_bfe_u32 v144, v145, 2, 14
v_rcp_f16 v151, v150
v_fmac_f32 v166, v201, v201
v_lshrrev_b32_e64 v145, 18, v145
ds_read_u16_d16 v140, v140
ds_read_u16_d16 v142, v142
ds_read_u16_d16_hi v141, v141
ds_read_u16_d16_hi v143, v143
ds_read_u16_d16 v144, v144
ds_read_u16_d16_hi v145, v145
v_rcp_f16 v148, v147
v_fmac_f32 v166, v202, v202
s_waitcnt lgkmcnt(6)
v_or_b32 v88, v136, v137
v_or_b32 v89, v138, v139
v_fmac_f32 v166, v203, v203
v_rcp_f16_sdwa v154, v153 dst_sel:WORD_1 dst_unused:UNUSED_PRESERVE src0_sel:WORD_1
v_fmac_f32 v166, v204, v204
s_waitcnt lgkmcnt(3)
v_or_b32_e64 v90, v140, v141
v_rcp_f16_sdwa v151, v150 dst_sel:WORD_1 dst_unused:UNUSED_PRESERVE src0_sel:WORD_1
v_fmac_f32 v166, v205, v205
s_waitcnt lgkmcnt(2)
v_or_b32_e64 v91, v142, v143
v_rcp_f16_sdwa v148, v147 dst_sel:WORD_1 dst_unused:UNUSED_PRESERVE src0_sel:WORD_1
v_fmac_f32 v166, v206, v206
s_waitcnt lgkmcnt(0)
v_or_b32_e64 v92, v144, v145
v_pk_mul_f16 v93, v155, v154
v_fmac_f32 v166, v207, v207
v_pk_mul_f16 v94, v152, v151
v_pk_mul_f16 v95, v149, v148
s_setprio 1
v_mfma_f32_32x32x16_f16 v[192:207], v[88:91], v[208:211], 0
v_mfma_f32_32x32x16_f16 v[192:207], v[92:95], v[212:215], v[192:207]
v_permlane16_swap_b32 v88, v92
v_permlane16_swap_b32 v89, v93
v_permlane16_swap_b32 v90, v94
v_permlane16_swap_b32 v91, v95
s_nop 7
v_fmac_f32 v167, v192, v192
v_fmac_f32 v167, v193, v193
v_fmac_f32 v167, v194, v194
v_fmac_f32 v167, v195, v195
v_fmac_f32 v167, v196, v196
v_fmac_f32 v167, v197, v197
v_fmac_f32 v167, v198, v198
v_fmac_f32 v167, v199, v199
v_fmac_f32 v167, v200, v200
v_fmac_f32 v167, v201, v201
v_fmac_f32 v167, v202, v202
s_setprio 0
v_fmac_f32 v167, v203, v203
v_fmac_f32 v167, v204, v204
v_fmac_f32 v167, v205, v205
v_fmac_f32 v167, v206, v206
v_fmac_f32 v167, v207, v207
s_setprio 3
v_and_b32 v136, 51, v251
v_bfe_u32 v137, v251, 2, 1
v_lshl_add_u32 v136, v137, 3, v136
v_bfe_u32 v137, v251, 3, 1
v_lshl_add_u32 v136, v137, 2, v136
v_lshl_add_u32 v136, v136, 2, s72
v_permlane32_swap_b32 v156, v157
v_add_f32 v156, v156, v157
ds_write_b32 v136, v156 offset:7168
v_permlane32_swap_b32 v158, v159
v_add_f32 v158, v158, v159
ds_write_b32 v136, v158 offset:7424
v_permlane32_swap_b32 v160, v161
v_add_f32 v160, v160, v161
ds_write_b32 v136, v160 offset:7680
v_permlane32_swap_b32 v162, v163
v_add_f32 v162, v162, v163
ds_write_b32 v136, v162 offset:7936
v_permlane32_swap_b32 v164, v165
v_add_f32 v164, v164, v165
ds_write_b32 v136, v164 offset:8192
v_permlane32_swap_b32 v166, v167
v_add_f32 v166, v166, v167
ds_write_b32 v136, v166 offset:8448
v_mov_b32 v128, 16256
v_mov_b32_e64 v129, 1
s_waitcnt lgkmcnt(0)
s_mov_b64 exec, 1
ds_add_rtn_u32 v130, v128, v129
s_mov_b64 exec, -1
s_waitcnt lgkmcnt(0)
v_readfirstlane_b32 s43, v130
s_nop 1
s_cmp_lg_u32 s43, 7
s_cbranch_scc1 Lnopub
v_min_u32 v131, 47, v251
v_lshlrev_b32 v132, 5, v131
v_add_u32 v132, 97280, v132
ds_read_b128 v[168:171], v132
ds_read_b128 v[172:175], v132 offset:16
ds_read_b128 v[176:179], v132 offset:9216
ds_read_b128 v[180:183], v132 offset:9232
ds_read_b128 v[184:187], v132 offset:18432
ds_read_b128 v[188:191], v132 offset:18448
ds_read_b128 v[192:195], v132 offset:27648
ds_read_b128 v[196:199], v132 offset:27664
ds_read_b128 v[200:203], v132 offset:36864
ds_read_b128 v[204:207], v132 offset:36880
ds_read_b128 v[208:211], v132 offset:46080
ds_read_b128 v[212:215], v132 offset:46096
ds_read_b128 v[216:219], v132 offset:55296
ds_read_b128 v[220:223], v132 offset:55312
ds_read_b128 v[120:123], v132 offset:64512
ds_read_b128 v[124:127], v132 offset:64528
v_lshlrev_b32_e64 v134, 13, v131
v_add_u32 v135, 4096, v134
s_waitcnt lgkmcnt(13)
v_add_f32 v168, v168, v176
v_add_f32 v169, v169, v177
v_add_f32 v170, v170, v178
v_add_f32 v171, v171, v179
s_waitcnt lgkmcnt(12)
v_add_f32 v172, v172, v180
v_add_f32 v173, v173, v181
v_add_f32 v174, v174, v182
v_add_f32 v175, v175, v183
s_waitcnt lgkmcnt(9)
v_add_f32 v184, v184, v192
v_add_f32 v185, v185, v193
v_add_f32 v186, v186, v194
v_add_f32 v187, v187, v195
s_waitcnt lgkmcnt(8)
v_add_f32 v188, v188, v196
v_add_f32 v189, v189, v197
v_add_f32 v190, v190, v198
v_add_f32 v191, v191, v199
s_waitcnt lgkmcnt(5)
v_add_f32 v200, v200, v208
v_add_f32 v201, v201, v209
v_add_f32 v202, v202, v210
v_add_f32 v203, v203, v211
s_waitcnt lgkmcnt(4)
v_add_f32 v204, v204, v212
v_add_f32 v205, v205, v213
v_add_f32 v206, v206, v214
v_add_f32 v207, v207, v215
s_waitcnt lgkmcnt(1)
v_add_f32 v216, v216, v120
v_add_f32 v217, v217, v121
v_add_f32 v218, v218, v122
v_add_f32 v219, v219, v123
s_waitcnt lgkmcnt(0)
v_add_f32 v220, v220, v124
v_add_f32 v221, v221, v125
v_add_f32 v222, v222, v126
v_add_f32 v223, v223, v127
v_add_f32 v168, v168, v184
v_add_f32 v169, v169, v185
v_add_f32 v170, v170, v186
v_add_f32 v171, v171, v187
v_add_f32 v172, v172, v188
v_add_f32 v173, v173, v189
v_add_f32 v174, v174, v190
v_add_f32 v175, v175, v191
v_add_f32 v200, v200, v216
v_add_f32 v201, v201, v217
v_add_f32 v202, v202, v218
v_add_f32 v203, v203, v219
v_add_f32 v204, v204, v220
v_add_f32 v205, v205, v221
v_add_f32 v206, v206, v222
v_add_f32 v207, v207, v223
v_add_f32 v168, v168, v200
v_add_f32 v169, v169, v201
v_add_f32 v170, v170, v202
v_add_f32 v171, v171, v203
v_add_f32 v172, v172, v204
v_add_f32 v173, v173, v205
v_add_f32 v174, v174, v206
v_add_f32 v175, v175, v207
v_min_u32 v176, -2, v168
v_min_u32 v177, -2, v169
v_min_u32 v178, -2, v170
v_min_u32 v179, -2, v171
v_min_u32 v180, -2, v172
v_min_u32 v181, -2, v173
v_min_u32_e64 v182, -2, v174
v_min_u32 v183, -2, v175
s_lshl_b32 s43, s2, 4
buffer_store_dwordx4 v[176:179], v134, s[32:35], s43 offen sc1
buffer_store_dwordx4 v[180:183], v135, s[32:35], s43 offen sc1
ds_write_b32 v128, v129 offset:4
s_waitcnt lgkmcnt(0)
s_nop 1
Lnopub:
v_mov_b32 v252, v240
s_mov_b32 s77, 0
s_cmp_lg_u32 s40, 0
s_cbranch_scc1 Lnorole
s_cmp_lt_u32 s2, 96
s_cselect_b32 s77, 1, 2
v_mov_b32 v156, -1
v_mov_b32 v157, -1
v_mov_b32 v158, -1
v_mov_b32 v159, -1
v_mov_b32 v160, -1
v_mov_b32 v161, -1
v_mov_b32 v162, -1
v_mov_b32 v163, -1
v_mov_b32 v164, -1
v_mov_b32 v165, -1
v_mov_b32 v166, -1
v_mov_b32 v167, -1
v_mov_b32 v240, -1
v_mov_b32 v241, -1
v_mov_b32 v242, -1
v_mov_b32 v243, -1
s_call_b64 s[78:79], Lpoll
Lnorole:
s_setprio 0
ds_read_b128 v[224:227], v248 offset:47104
ds_read_b128 v[228:231], v248 offset:50176
ds_read_b128 v[232:235], v248 offset:48128
ds_read_b128 v[236:239], v248 offset:51200
s_setprio 2
s_waitcnt lgkmcnt(3)
v_mfma_f32_32x32x16_bf16 v[120:135], v[224:227], v[96:99], 0
s_waitcnt lgkmcnt(2)
ds_read_b128 v[224:227], v248 offset:49152
v_mfma_f32_32x32x16_bf16 v[120:135], v[228:231], v[100:103], v[120:135]
s_waitcnt lgkmcnt(2)
ds_read_b128 v[228:231], v248 offset:52224
v_mfma_f32_32x32x16_bf16 v[120:135], v[232:235], v[104:107], v[120:135]
s_waitcnt lgkmcnt(2)
ds_read_b128 v[232:235], v248 offset:53248
v_mfma_f32_32x32x16_bf16 v[120:135], v[236:239], v[108:111], v[120:135]
s_waitcnt lgkmcnt(2)
ds_read_b128 v[236:239], v248 offset:56320
v_mfma_f32_32x32x16_bf16 v[120:135], v[224:227], v[112:115], v[120:135]
s_waitcnt lgkmcnt(2)
ds_read_b128 v[224:227], v248 offset:54272
v_mfma_f32_32x32x16_bf16 v[120:135], v[228:231], v[116:119], v[120:135]
s_cmp_eq_u32 s77, 0
s_cbranch_scc1 Lpp0
s_getreg_b32 s43, hwreg(HW_REG_IB_STS, 0, 4)
s_cmp_lg_u32 s43, 0
s_cbranch_scc1 Lpp0
s_call_b64 s[78:79], Lpoll
s_setprio 2
Lpp0:
s_nop 9
v_cvt_pkrtz_f16_f32 v137, v120, v121
v_cvt_pkrtz_f16_f32 v139, v122, v123
v_cvt_pkrtz_f16_f32 v141, v124, v125
v_cvt_pkrtz_f16_f32 v143, v126, v127
v_cvt_pkrtz_f16_f32 v145, v128, v129
v_cvt_pk_f16_f32 v155, v130, v131
v_cvt_pk_f16_f32 v152, v132, v133
v_cvt_pk_f16_f32 v149, v134, v135
s_waitcnt lgkmcnt(0)
ds_read_b128 v[228:231], v248 offset:57344
v_mfma_f32_32x32x16_bf16 v[120:135], v[232:235], v[96:99], 0
v_pk_fma_f16 v154, v155, v155, s48
v_and_b32 v137, s49, v137
v_pk_fma_f16 v151, v152, v152, s48
v_and_b32_e64 v139, s49, v139
v_pk_fma_f16 v148, v149, v149, s48
v_pk_mul_f16 v154, v155, v154
v_bfe_u32 v136, v137, 2, 14
v_pk_mul_f16 v151, v152, v151
ds_read_b128 v[232:235], v248 offset:55296
ds_read_u16_d16 v136, v136
v_mfma_f32_32x32x16_bf16 v[120:135], v[236:239], v[100:103], v[120:135]
v_pk_mul_f16 v148, v149, v148
v_bfe_u32 v138, v139, 2, 14
v_exp_f16 v153, v154
v_lshrrev_b32 v137, 18, v137
v_exp_f16 v150, v151
s_setprio 1
v_lshrrev_b32_e64 v139, 18, v139
ds_read_b128 v[236:239], v248 offset:58368
ds_read_u16_d16 v138, v138
ds_read_u16_d16_hi v137, v137
ds_read_u16_d16_hi v139, v139
v_mfma_f32_32x32x16_bf16 v[120:135], v[224:227], v[104:107], v[120:135]
v_exp_f16 v147, v148
v_and_b32 v141, s49, v141
v_and_b32 v143, s49, v143
v_exp_f16_sdwa v153, v154 dst_sel:WORD_1 dst_unused:UNUSED_PRESERVE src0_sel:WORD_1
v_bfe_u32 v140, v141, 2, 14
v_exp_f16_sdwa v150, v151 dst_sel:WORD_1 dst_unused:UNUSED_PRESERVE src0_sel:WORD_1
s_waitcnt lgkmcnt(6)
ds_read_b128 v[224:227], v248 offset:59392
ds_read_u16_d16 v140, v140
v_mfma_f32_32x32x16_bf16 v[120:135], v[228:231], v[108:111], v[120:135]
v_bfe_u32 v142, v143, 2, 14
v_exp_f16_sdwa v147, v148 dst_sel:WORD_1 dst_unused:UNUSED_PRESERVE src0_sel:WORD_1
v_lshrrev_b32_e64 v141, 18, v141
v_pk_add_f16 v153, v153, 1.0 op_sel_hi:[1,0]
v_lshrrev_b32 v143, 18, v143
v_pk_add_f16 v150, v150, 1.0 op_sel_hi:[1,0]
v_pk_add_f16 v147, v147, 1.0 op_sel_hi:[1,0]
s_waitcnt lgkmcnt(6)
ds_read_b128 v[228:231], v248 offset:62464
ds_read_u16_d16 v142, v142
ds_read_u16_d16_hi v141, v141
ds_read_u16_d16_hi v143, v143
v_mfma_f32_32x32x16_bf16 v[120:135], v[232:235], v[112:115], v[120:135]
v_and_b32 v145, s49, v145
v_rcp_f16 v154, v153
v_bfe_u32 v144, v145, 2, 14
v_rcp_f16_e64 v151, v150
v_lshrrev_b32 v145, 18, v145
s_waitcnt lgkmcnt(6)
ds_read_b128 v[232:235], v248 offset:60416
ds_read_u16_d16 v144, v144
ds_read_u16_d16_hi v145, v145
v_mfma_f32_32x32x16_bf16 v[120:135], v[236:239], v[116:119], v[120:135]
v_rcp_f16 v148, v147
v_or_b32 v168, v136, v137
v_or_b32_e64 v169, v138, v139
v_rcp_f16_sdwa v154, v153 dst_sel:WORD_1 dst_unused:UNUSED_PRESERVE src0_sel:WORD_1
s_waitcnt lgkmcnt(4)
v_or_b32 v170, v140, v141
v_rcp_f16_sdwa v151, v150 dst_sel:WORD_1 dst_unused:UNUSED_PRESERVE src0_sel:WORD_1
s_waitcnt lgkmcnt(3)
v_or_b32 v171, v142, v143
v_rcp_f16_sdwa v148, v147 dst_sel:WORD_1 dst_unused:UNUSED_PRESERVE src0_sel:WORD_1
s_waitcnt lgkmcnt(0)
v_or_b32_e64 v172, v144, v145
v_pk_mul_f16 v173, v155, v154
v_pk_mul_f16 v174, v152, v151
v_pk_mul_f16 v175, v149, v148
s_cmp_eq_u32 s77, 0
s_cbranch_scc1 Lpp1
s_getreg_b32 s43, hwreg(HW_REG_IB_STS, 0, 4)
s_cmp_lg_u32 s43, 0
s_cbranch_scc1 Lpp1
s_call_b64 s[78:79], Lpoll
s_setprio 1
Lpp1:
v_cvt_pkrtz_f16_f32 v137, v120, v121
v_cvt_pkrtz_f16_f32 v139, v122, v123
v_cvt_pkrtz_f16_f32 v141, v124, v125
v_cvt_pkrtz_f16_f32 v143, v126, v127
v_cvt_pkrtz_f16_f32 v145, v128, v129
v_cvt_pk_f16_f32 v155, v130, v131
v_cvt_pk_f16_f32 v152, v132, v133
v_cvt_pk_f16_f32 v149, v134, v135
ds_read_b128 v[236:239], v248 offset:63488
v_mfma_f32_32x32x16_bf16 v[120:135], v[224:227], v[96:99], 0
v_pk_fma_f16 v154, v155, v155, s48
v_permlane16_swap_b32 v168, v172
v_and_b32 v137, s49, v137
v_pk_fma_f16 v151, v152, v152, s48
v_and_b32_e64 v139, s49, v139
v_pk_fma_f16 v148, v149, v149, s48
v_pk_mul_f16 v154, v155, v154
v_bfe_u32 v136, v137, 2, 14
v_pk_mul_f16 v151, v152, v151
ds_read_b128 v[224:227], v248 offset:61440
ds_read_u16_d16 v136, v136
v_mfma_f32_32x32x16_bf16 v[120:135], v[228:231], v[100:103], v[120:135]
v_pk_mul_f16 v148, v149, v148
v_bfe_u32 v138, v139, 2, 14
v_exp_f16 v153, v154
v_lshrrev_b32 v137, 18, v137
v_exp_f16 v150, v151
v_permlane16_swap_b32 v169, v173
v_lshrrev_b32_e64 v139, 18, v139
ds_read_b128 v[228:231], v248 offset:64512
ds_read_u16_d16 v138, v138
ds_read_u16_d16_hi v137, v137
ds_read_u16_d16_hi v139, v139
v_mfma_f32_32x32x16_bf16 v[120:135], v[232:235], v[104:107], v[120:135]
v_exp_f16 v147, v148
s_setprio 0
v_and_b32_e64 v141, s49, v141
v_and_b32 v143, s49, v143
v_exp_f16_sdwa v153, v154 dst_sel:WORD_1 dst_unused:UNUSED_PRESERVE src0_sel:WORD_1
v_bfe_u32 v140, v141, 2, 14
v_exp_f16_sdwa v150, v151 dst_sel:WORD_1 dst_unused:UNUSED_PRESERVE src0_sel:WORD_1
s_waitcnt lgkmcnt(6)
ds_read_b128 v[232:235], v249
ds_read_u16_d16 v140, v140
v_mfma_f32_32x32x16_bf16 v[120:135], v[236:239], v[108:111], v[120:135]
v_bfe_u32 v142, v143, 2, 14
v_exp_f16_sdwa v147, v148 dst_sel:WORD_1 dst_unused:UNUSED_PRESERVE src0_sel:WORD_1
v_lshrrev_b32 v141, 18, v141
v_permlane16_swap_b32 v170, v174
v_pk_add_f16 v153, v153, 1.0 op_sel_hi:[1,0]
v_lshrrev_b32 v143, 18, v143
v_pk_add_f16 v150, v150, 1.0 op_sel_hi:[1,0]
v_pk_add_f16 v147, v147, 1.0 op_sel_hi:[1,0]
s_waitcnt lgkmcnt(6)
ds_read_b128 v[236:239], v249 offset:3072
ds_read_u16_d16 v142, v142
ds_read_u16_d16_hi v141, v141
ds_read_u16_d16_hi v143, v143
v_mfma_f32_32x32x16_bf16 v[120:135], v[224:227], v[112:115], v[120:135]
v_and_b32 v145, s49, v145
v_rcp_f16 v154, v153
v_bfe_u32 v144, v145, 2, 14
v_rcp_f16 v151, v150
v_lshrrev_b32 v145, 18, v145
v_rcp_f16 v148, v147
s_waitcnt lgkmcnt(6)
ds_read_b128 v[224:227], v249 offset:1024
ds_read_u16_d16 v144, v144
ds_read_u16_d16_hi v145, v145
v_mfma_f32_32x32x16_bf16 v[120:135], v[228:231], v[116:119], v[120:135]
v_or_b32 v176, v136, v137
v_permlane16_swap_b32 v171, v175
v_or_b32_e64 v177, v138, v139
v_rcp_f16_sdwa v154, v153 dst_sel:WORD_1 dst_unused:UNUSED_PRESERVE src0_sel:WORD_1
s_waitcnt lgkmcnt(4)
v_or_b32 v178, v140, v141
v_rcp_f16_sdwa v151, v150 dst_sel:WORD_1 dst_unused:UNUSED_PRESERVE src0_sel:WORD_1
s_waitcnt lgkmcnt(3)
v_or_b32 v179, v142, v143
v_rcp_f16_sdwa v148, v147 dst_sel:WORD_1 dst_unused:UNUSED_PRESERVE src0_sel:WORD_1
s_waitcnt lgkmcnt(0)
v_or_b32 v180, v144, v145
v_pk_mul_f16 v181, v155, v154
v_pk_mul_f16 v182, v152, v151
v_pk_mul_f16 v183, v149, v148
s_cmp_eq_u32 s77, 0
s_cbranch_scc1 Lpp2
s_getreg_b32 s43, hwreg(HW_REG_IB_STS, 0, 4)
s_cmp_lg_u32 s43, 0
s_cbranch_scc1 Lpp2
s_call_b64 s[78:79], Lpoll
s_setprio 0
Lpp2:
s_setprio 2
v_cvt_pkrtz_f16_f32 v137, v120, v121
v_cvt_pkrtz_f16_f32 v139, v122, v123
v_cvt_pkrtz_f16_f32 v141, v124, v125
v_cvt_pkrtz_f16_f32 v143, v126, v127
v_cvt_pkrtz_f16_f32 v145, v128, v129
v_cvt_pk_f16_f32 v155, v130, v131
v_cvt_pk_f16_f32 v152, v132, v133
v_cvt_pk_f16_f32 v149, v134, v135
ds_read_b128 v[228:231], v249 offset:4096
v_mfma_f32_32x32x16_bf16 v[120:135], v[232:235], v[96:99], 0
v_pk_fma_f16 v154, v155, v155, s48
v_permlane16_swap_b32 v176, v180
v_and_b32 v137, s49, v137
v_pk_fma_f16 v151, v152, v152, s48
v_and_b32_e64 v139, s49, v139
v_pk_fma_f16 v148, v149, v149, s48
v_pk_mul_f16 v154, v155, v154
v_bfe_u32 v136, v137, 2, 14
v_pk_mul_f16 v151, v152, v151
ds_read_b128 v[232:235], v249 offset:2048
ds_read_u16_d16 v136, v136
v_mfma_f32_32x32x16_bf16 v[120:135], v[236:239], v[100:103], v[120:135]
v_pk_mul_f16 v148, v149, v148
v_bfe_u32 v138, v139, 2, 14
v_exp_f16 v153, v154
v_lshrrev_b32 v137, 18, v137
v_exp_f16 v150, v151
v_permlane16_swap_b32 v177, v181
v_lshrrev_b32_e64 v139, 18, v139
ds_read_b128 v[236:239], v249 offset:5120
ds_read_u16_d16 v138, v138
ds_read_u16_d16_hi v137, v137
ds_read_u16_d16_hi v139, v139
v_mfma_f32_32x32x16_bf16 v[120:135], v[224:227], v[104:107], v[120:135]
v_exp_f16 v147, v148
v_and_b32 v141, s49, v141
v_and_b32 v143, s49, v143
v_exp_f16_sdwa v153, v154 dst_sel:WORD_1 dst_unused:UNUSED_PRESERVE src0_sel:WORD_1
v_bfe_u32 v140, v141, 2, 14
v_exp_f16_sdwa v150, v151 dst_sel:WORD_1 dst_unused:UNUSED_PRESERVE src0_sel:WORD_1
s_waitcnt lgkmcnt(6)
ds_read_b128 v[224:227], v249 offset:6144
ds_read_u16_d16 v140, v140
v_mfma_f32_32x32x16_bf16 v[120:135], v[228:231], v[108:111], v[120:135]
v_bfe_u32 v142, v143, 2, 14
v_exp_f16_sdwa v147, v148 dst_sel:WORD_1 dst_unused:UNUSED_PRESERVE src0_sel:WORD_1
v_lshrrev_b32 v141, 18, v141
v_permlane16_swap_b32 v178, v182
v_pk_add_f16 v153, v153, 1.0 op_sel_hi:[1,0]
v_lshrrev_b32 v143, 18, v143
v_pk_add_f16 v150, v150, 1.0 op_sel_hi:[1,0]
v_pk_add_f16 v147, v147, 1.0 op_sel_hi:[1,0]
s_waitcnt lgkmcnt(6)
ds_read_b128 v[228:231], v249 offset:9216
ds_read_u16_d16 v142, v142
ds_read_u16_d16_hi v141, v141
ds_read_u16_d16_hi v143, v143
v_mfma_f32_32x32x16_bf16 v[120:135], v[232:235], v[112:115], v[120:135]
v_and_b32 v145, s49, v145
v_rcp_f16 v154, v153
v_bfe_u32 v144, v145, 2, 14
v_rcp_f16 v151, v150
v_lshrrev_b32 v145, 18, v145
v_rcp_f16 v148, v147
s_waitcnt lgkmcnt(6)
ds_read_b128 v[232:235], v249 offset:7168
ds_read_u16_d16 v144, v144
ds_read_u16_d16_hi v145, v145
v_mfma_f32_32x32x16_bf16 v[120:135], v[236:239], v[116:119], v[120:135]
v_or_b32 v184, v136, v137
v_permlane16_swap_b32 v179, v183
v_or_b32_e64 v185, v138, v139
v_rcp_f16_sdwa v154, v153 dst_sel:WORD_1 dst_unused:UNUSED_PRESERVE src0_sel:WORD_1
s_waitcnt lgkmcnt(4)
v_or_b32 v186, v140, v141
v_rcp_f16_sdwa v151, v150 dst_sel:WORD_1 dst_unused:UNUSED_PRESERVE src0_sel:WORD_1
s_waitcnt lgkmcnt(3)
v_or_b32 v187, v142, v143
v_rcp_f16_sdwa v148, v147 dst_sel:WORD_1 dst_unused:UNUSED_PRESERVE src0_sel:WORD_1
s_waitcnt lgkmcnt(0)
v_or_b32_e64 v188, v144, v145
v_pk_mul_f16 v189, v155, v154
v_pk_mul_f16 v190, v152, v151
v_pk_mul_f16 v191, v149, v148
s_cmp_eq_u32 s77, 0
s_cbranch_scc1 Lpp3
s_getreg_b32 s43, hwreg(HW_REG_IB_STS, 0, 4)
s_cmp_lg_u32 s43, 0
s_cbranch_scc1 Lpp3
s_call_b64 s[78:79], Lpoll
s_setprio 2
Lpp3:
v_cvt_pkrtz_f16_f32 v137, v120, v121
v_cvt_pkrtz_f16_f32 v139, v122, v123
v_cvt_pkrtz_f16_f32 v141, v124, v125
v_cvt_pkrtz_f16_f32 v143, v126, v127
v_cvt_pkrtz_f16_f32 v145, v128, v129
v_cvt_pk_f16_f32 v155, v130, v131
v_cvt_pk_f16_f32 v152, v132, v133
v_cvt_pk_f16_f32 v149, v134, v135
ds_read_b128 v[236:239], v249 offset:10240
v_mfma_f32_32x32x16_bf16 v[120:135], v[224:227], v[96:99], 0
v_pk_fma_f16 v154, v155, v155, s48
v_permlane16_swap_b32 v184, v188
v_and_b32 v137, s49, v137
v_pk_fma_f16 v151, v152, v152, s48
v_and_b32_e64 v139, s49, v139
v_pk_fma_f16 v148, v149, v149, s48
v_pk_mul_f16 v154, v155, v154
v_bfe_u32 v136, v137, 2, 14
v_pk_mul_f16 v151, v152, v151
ds_read_b128 v[224:227], v249 offset:8192
ds_read_u16_d16 v136, v136
v_mfma_f32_32x32x16_bf16 v[120:135], v[228:231], v[100:103], v[120:135]
v_pk_mul_f16 v148, v149, v148
v_bfe_u32 v138, v139, 2, 14
v_exp_f16 v153, v154
v_lshrrev_b32 v137, 18, v137
v_exp_f16 v150, v151
s_setprio 1
v_permlane16_swap_b32 v185, v189
v_lshrrev_b32 v139, 18, v139
ds_read_b128 v[228:231], v249 offset:11264
ds_read_u16_d16 v138, v138
ds_read_u16_d16_hi v137, v137
ds_read_u16_d16_hi v139, v139
v_mfma_f32_32x32x16_bf16 v[120:135], v[232:235], v[104:107], v[120:135]
v_exp_f16 v147, v148
v_and_b32 v141, s49, v141
v_and_b32 v143, s49, v143
v_exp_f16_sdwa v153, v154 dst_sel:WORD_1 dst_unused:UNUSED_PRESERVE src0_sel:WORD_1
v_bfe_u32 v140, v141, 2, 14
v_exp_f16_sdwa v150, v151 dst_sel:WORD_1 dst_unused:UNUSED_PRESERVE src0_sel:WORD_1
s_waitcnt lgkmcnt(6)
ds_read_b128 v[232:235], v249 offset:12288
ds_read_u16_d16 v140, v140
v_mfma_f32_32x32x16_bf16 v[120:135], v[236:239], v[108:111], v[120:135]
v_bfe_u32 v142, v143, 2, 14
v_exp_f16_sdwa v147, v148 dst_sel:WORD_1 dst_unused:UNUSED_PRESERVE src0_sel:WORD_1
v_lshrrev_b32 v141, 18, v141
v_permlane16_swap_b32 v186, v190
v_pk_add_f16 v153, v153, 1.0 op_sel_hi:[1,0]
v_lshrrev_b32 v143, 18, v143
v_pk_add_f16 v150, v150, 1.0 op_sel_hi:[1,0]
v_pk_add_f16 v147, v147, 1.0 op_sel_hi:[1,0]
s_waitcnt lgkmcnt(6)
ds_read_b128 v[236:239], v249 offset:15360
ds_read_u16_d16 v142, v142
ds_read_u16_d16_hi v141, v141
ds_read_u16_d16_hi v143, v143
v_mfma_f32_32x32x16_bf16 v[120:135], v[224:227], v[112:115], v[120:135]
v_and_b32 v145, s49, v145
v_rcp_f16 v154, v153
v_bfe_u32 v144, v145, 2, 14
v_rcp_f16 v151, v150
v_lshrrev_b32 v145, 18, v145
v_rcp_f16 v148, v147
s_waitcnt lgkmcnt(6)
ds_read_b128 v[224:227], v249 offset:13312
ds_read_u16_d16 v144, v144
ds_read_u16_d16_hi v145, v145
v_mfma_f32_32x32x16_bf16 v[120:135], v[228:231], v[116:119], v[120:135]
v_or_b32 v192, v136, v137
v_permlane16_swap_b32 v187, v191
v_or_b32_e64 v193, v138, v139
v_rcp_f16_sdwa v154, v153 dst_sel:WORD_1 dst_unused:UNUSED_PRESERVE src0_sel:WORD_1
s_waitcnt lgkmcnt(4)
v_or_b32 v194, v140, v141
v_rcp_f16_sdwa v151, v150 dst_sel:WORD_1 dst_unused:UNUSED_PRESERVE src0_sel:WORD_1
s_waitcnt lgkmcnt(3)
v_or_b32 v195, v142, v143
v_rcp_f16_sdwa v148, v147 dst_sel:WORD_1 dst_unused:UNUSED_PRESERVE src0_sel:WORD_1
s_waitcnt lgkmcnt(0)
v_or_b32 v196, v144, v145
v_pk_mul_f16 v197, v155, v154
v_pk_mul_f16 v198, v152, v151
v_pk_mul_f16 v199, v149, v148
s_cmp_eq_u32 s77, 0
s_cbranch_scc1 Lpp4
s_getreg_b32 s43, hwreg(HW_REG_IB_STS, 0, 4)
s_cmp_lg_u32 s43, 0
s_cbranch_scc1 Lpp4
s_call_b64 s[78:79], Lpoll
s_setprio 1
Lpp4:
v_mov_b32 v253, 16256
Lw2w:
ds_read_b32 v254, v253 offset:4
s_waitcnt lgkmcnt(0)
v_readfirstlane_b32 s43, v254
s_cmp_eq_u32 s76, 0
s_cbranch_scc1 Lw2x
s_sub_u32 s76, s76, 1
s_cmp_lt_u32 s43, 1
s_cbranch_scc0 Lw2x
s_sleep 2
s_branch Lw2w
Lw2x:
s_add_u32 m0, s72, 7168
s_add_u32 s43, s82, 6208
buffer_load_dwordx4 v252, s[16:19], s43 offen lds
s_add_u32 m0, s72, 8192
s_add_u32 s43, s82, 6272
buffer_load_dwordx4 v252, s[16:19], s43 offen lds
v_cvt_pkrtz_f16_f32 v137, v120, v121
v_cvt_pkrtz_f16_f32 v139, v122, v123
v_cvt_pkrtz_f16_f32 v141, v124, v125
v_cvt_pkrtz_f16_f32 v143, v126, v127
v_cvt_pkrtz_f16_f32 v145, v128, v129
v_cvt_pk_f16_f32 v155, v130, v131
v_cvt_pk_f16_f32 v152, v132, v133
v_cvt_pk_f16_f32 v149, v134, v135
ds_read_b128 v[228:231], v249 offset:16384
v_mfma_f32_32x32x16_bf16 v[120:135], v[232:235], v[96:99], 0
v_pk_fma_f16 v154, v155, v155, s48
v_permlane16_swap_b32 v192, v196
v_and_b32 v137, s49, v137
v_pk_fma_f16 v151, v152, v152, s48
v_and_b32_e64 v139, s49, v139
v_pk_fma_f16 v148, v149, v149, s48
v_pk_mul_f16 v154, v155, v154
v_bfe_u32 v136, v137, 2, 14
v_pk_mul_f16 v151, v152, v151
ds_read_b128 v[232:235], v249 offset:14336
ds_read_u16_d16 v136, v136
v_mfma_f32_32x32x16_bf16 v[120:135], v[236:239], v[100:103], v[120:135]
v_pk_mul_f16 v148, v149, v148
v_bfe_u32 v138, v139, 2, 14
v_exp_f16 v153, v154
v_lshrrev_b32 v137, 18, v137
v_exp_f16 v150, v151
v_permlane16_swap_b32 v193, v197
v_lshrrev_b32_e64 v139, 18, v139
ds_read_b128 v[236:239], v249 offset:17408
ds_read_u16_d16 v138, v138
ds_read_u16_d16_hi v137, v137
ds_read_u16_d16_hi v139, v139
v_mfma_f32_32x32x16_bf16 v[120:135], v[224:227], v[104:107], v[120:135]
v_exp_f16 v147, v148
s_setprio 0
v_and_b32_e64 v141, s49, v141
v_and_b32 v143, s49, v143
v_exp_f16_sdwa v153, v154 dst_sel:WORD_1 dst_unused:UNUSED_PRESERVE src0_sel:WORD_1
v_bfe_u32 v140, v141, 2, 14
v_exp_f16_sdwa v150, v151 dst_sel:WORD_1 dst_unused:UNUSED_PRESERVE src0_sel:WORD_1
s_waitcnt lgkmcnt(6)
ds_read_b128 v[224:227], v249 offset:18432
ds_read_u16_d16 v140, v140
v_mfma_f32_32x32x16_bf16 v[120:135], v[228:231], v[108:111], v[120:135]
v_bfe_u32 v142, v143, 2, 14
v_exp_f16_sdwa v147, v148 dst_sel:WORD_1 dst_unused:UNUSED_PRESERVE src0_sel:WORD_1
v_lshrrev_b32 v141, 18, v141
v_permlane16_swap_b32 v194, v198
v_pk_add_f16 v153, v153, 1.0 op_sel_hi:[1,0]
v_lshrrev_b32 v143, 18, v143
v_pk_add_f16 v150, v150, 1.0 op_sel_hi:[1,0]
v_pk_add_f16 v147, v147, 1.0 op_sel_hi:[1,0]
s_waitcnt lgkmcnt(6)
ds_read_b128 v[228:231], v249 offset:21504
ds_read_u16_d16 v142, v142
ds_read_u16_d16_hi v141, v141
ds_read_u16_d16_hi v143, v143
v_mfma_f32_32x32x16_bf16 v[120:135], v[232:235], v[112:115], v[120:135]
v_and_b32 v145, s49, v145
v_rcp_f16 v154, v153
v_bfe_u32 v144, v145, 2, 14
v_rcp_f16 v151, v150
v_lshrrev_b32 v145, 18, v145
v_rcp_f16 v148, v147
s_waitcnt lgkmcnt(6)
ds_read_b128 v[232:235], v249 offset:19456
ds_read_u16_d16 v144, v144
ds_read_u16_d16_hi v145, v145
v_mfma_f32_32x32x16_bf16 v[120:135], v[236:239], v[116:119], v[120:135]
v_or_b32 v200, v136, v137
v_permlane16_swap_b32 v195, v199
v_or_b32_e64 v201, v138, v139
v_rcp_f16_sdwa v154, v153 dst_sel:WORD_1 dst_unused:UNUSED_PRESERVE src0_sel:WORD_1
s_waitcnt lgkmcnt(4)
v_or_b32 v202, v140, v141
v_rcp_f16_sdwa v151, v150 dst_sel:WORD_1 dst_unused:UNUSED_PRESERVE src0_sel:WORD_1
s_waitcnt lgkmcnt(3)
v_or_b32 v203, v142, v143
v_rcp_f16_sdwa v148, v147 dst_sel:WORD_1 dst_unused:UNUSED_PRESERVE src0_sel:WORD_1
s_waitcnt lgkmcnt(0)
v_or_b32 v204, v144, v145
v_pk_mul_f16 v205, v155, v154
v_pk_mul_f16 v206, v152, v151
v_pk_mul_f16 v207, v149, v148
s_cmp_eq_u32 s77, 0
s_cbranch_scc1 Lpp5
s_getreg_b32 s43, hwreg(HW_REG_IB_STS, 0, 4)
s_cmp_lg_u32 s43, 0
s_cbranch_scc1 Lpp5
s_call_b64 s[78:79], Lpoll
s_setprio 0
Lpp5:
s_setprio 2
v_cvt_pkrtz_f16_f32 v137, v120, v121
v_cvt_pkrtz_f16_f32 v139, v122, v123
v_cvt_pkrtz_f16_f32 v141, v124, v125
v_cvt_pkrtz_f16_f32 v143, v126, v127
v_cvt_pkrtz_f16_f32 v145, v128, v129
v_cvt_pk_f16_f32 v155, v130, v131
v_cvt_pk_f16_f32 v152, v132, v133
v_cvt_pk_f16_f32 v149, v134, v135
ds_read_b128 v[236:239], v249 offset:22528
v_mfma_f32_32x32x16_bf16 v[120:135], v[224:227], v[96:99], 0
v_pk_fma_f16 v154, v155, v155, s48
v_permlane16_swap_b32 v200, v204
v_and_b32 v137, s49, v137
v_pk_fma_f16 v151, v152, v152, s48
v_and_b32_e64 v139, s49, v139
v_pk_fma_f16 v148, v149, v149, s48
v_pk_mul_f16 v154, v155, v154
v_bfe_u32 v136, v137, 2, 14
v_pk_mul_f16 v151, v152, v151
ds_read_b128 v[224:227], v249 offset:20480
ds_read_u16_d16 v136, v136
v_mfma_f32_32x32x16_bf16 v[120:135], v[228:231], v[100:103], v[120:135]
v_pk_mul_f16 v148, v149, v148
v_bfe_u32 v138, v139, 2, 14
v_exp_f16 v153, v154
v_lshrrev_b32 v137, 18, v137
v_exp_f16 v150, v151
v_permlane16_swap_b32 v201, v205
v_lshrrev_b32_e64 v139, 18, v139
ds_read_b128 v[228:231], v249 offset:23552
ds_read_u16_d16 v138, v138
ds_read_u16_d16_hi v137, v137
ds_read_u16_d16_hi v139, v139
v_mfma_f32_32x32x16_bf16 v[120:135], v[232:235], v[104:107], v[120:135]
v_exp_f16 v147, v148
v_and_b32 v141, s49, v141
v_and_b32 v143, s49, v143
v_exp_f16_sdwa v153, v154 dst_sel:WORD_1 dst_unused:UNUSED_PRESERVE src0_sel:WORD_1
v_bfe_u32 v140, v141, 2, 14
v_exp_f16_sdwa v150, v151 dst_sel:WORD_1 dst_unused:UNUSED_PRESERVE src0_sel:WORD_1
s_waitcnt lgkmcnt(6)
ds_read_u16_d16 v140, v140
v_mfma_f32_32x32x16_bf16 v[120:135], v[236:239], v[108:111], v[120:135]
v_bfe_u32 v142, v143, 2, 14
v_exp_f16_sdwa v147, v148 dst_sel:WORD_1 dst_unused:UNUSED_PRESERVE src0_sel:WORD_1
v_lshrrev_b32 v141, 18, v141
v_permlane16_swap_b32 v202, v206
v_pk_add_f16 v153, v153, 1.0 op_sel_hi:[1,0]
v_lshrrev_b32 v143, 18, v143
v_pk_add_f16 v150, v150, 1.0 op_sel_hi:[1,0]
v_pk_add_f16 v147, v147, 1.0 op_sel_hi:[1,0]
s_waitcnt lgkmcnt(5)
ds_read_u16_d16 v142, v142
ds_read_u16_d16_hi v141, v141
ds_read_u16_d16_hi v143, v143
v_mfma_f32_32x32x16_bf16 v[120:135], v[224:227], v[112:115], v[120:135]
v_and_b32 v145, s49, v145
v_rcp_f16 v154, v153
v_bfe_u32 v144, v145, 2, 14
v_rcp_f16 v151, v150
v_lshrrev_b32 v145, 18, v145
v_rcp_f16 v148, v147
s_waitcnt lgkmcnt(4)
ds_read_u16_d16 v144, v144
ds_read_u16_d16_hi v145, v145
v_mfma_f32_32x32x16_bf16 v[120:135], v[228:231], v[116:119], v[120:135]
v_or_b32 v208, v136, v137
v_permlane16_swap_b32 v203, v207
v_or_b32_e64 v209, v138, v139
v_rcp_f16_sdwa v154, v153 dst_sel:WORD_1 dst_unused:UNUSED_PRESERVE src0_sel:WORD_1
s_waitcnt lgkmcnt(3)
v_or_b32 v210, v140, v141
v_rcp_f16_sdwa v151, v150 dst_sel:WORD_1 dst_unused:UNUSED_PRESERVE src0_sel:WORD_1
s_waitcnt lgkmcnt(2)
v_or_b32 v211, v142, v143
v_rcp_f16_sdwa v148, v147 dst_sel:WORD_1 dst_unused:UNUSED_PRESERVE src0_sel:WORD_1
s_waitcnt lgkmcnt(0)
v_or_b32_e64 v212, v144, v145
v_pk_mul_f16 v213, v155, v154
v_pk_mul_f16 v214, v152, v151
v_pk_mul_f16 v215, v149, v148
s_cmp_eq_u32 s77, 0
s_cbranch_scc1 Lpp6
s_getreg_b32 s43, hwreg(HW_REG_IB_STS, 0, 4)
s_cmp_lg_u32 s43, 0
s_cbranch_scc1 Lpp6
s_call_b64 s[78:79], Lpoll
s_setprio 2
Lpp6:
v_cvt_pkrtz_f16_f32 v137, v120, v121
v_cvt_pkrtz_f16_f32 v139, v122, v123
v_cvt_pkrtz_f16_f32 v141, v124, v125
v_cvt_pkrtz_f16_f32 v143, v126, v127
v_cvt_pkrtz_f16_f32 v145, v128, v129
v_cvt_pk_f16_f32 v155, v130, v131
v_cvt_pk_f16_f32 v152, v132, v133
v_cvt_pk_f16_f32 v149, v134, v135
v_pk_fma_f16 v154, v155, v155, s48
v_permlane16_swap_b32 v96, v100
v_permlane16_swap_b32 v208, v212
v_and_b32_e64 v137, s49, v137
v_pk_fma_f16 v151, v152, v152, s48
v_and_b32 v139, s49, v139
v_pk_fma_f16 v148, v149, v149, s48
v_permlane16_swap_b32 v97, v101
v_pk_mul_f16 v154, v155, v154
v_bfe_u32 v136, v137, 2, 14
v_pk_mul_f16 v151, v152, v151
v_pk_mul_f16 v148, v149, v148
v_bfe_u32 v138, v139, 2, 14
v_permlane16_swap_b32 v98, v102
v_exp_f16 v153, v154
v_lshrrev_b32 v137, 18, v137
v_exp_f16 v150, v151
v_permlane16_swap_b32 v99, v103
s_setprio 1
v_permlane16_swap_b32 v209, v213
v_lshrrev_b32 v139, 18, v139
v_exp_f16 v147, v148
v_and_b32 v141, s49, v141
v_permlane16_swap_b32 v104, v108
v_and_b32 v143, s49, v143
ds_read_u16_d16 v136, v136
ds_read_u16_d16 v138, v138
ds_read_u16_d16_hi v137, v137
ds_read_u16_d16_hi v139, v139
v_exp_f16_sdwa v153, v154 dst_sel:WORD_1 dst_unused:UNUSED_PRESERVE src0_sel:WORD_1
v_bfe_u32 v140, v141, 2, 14
v_exp_f16_sdwa v150, v151 dst_sel:WORD_1 dst_unused:UNUSED_PRESERVE src0_sel:WORD_1
v_permlane16_swap_b32 v105, v109
v_bfe_u32 v142, v143, 2, 14
v_exp_f16_sdwa v147, v148 dst_sel:WORD_1 dst_unused:UNUSED_PRESERVE src0_sel:WORD_1
v_lshrrev_b32 v141, 18, v141
v_permlane16_swap_b32 v106, v110
v_permlane16_swap_b32 v210, v214
v_pk_add_f16 v153, v153, 1.0 op_sel_hi:[1,0]
v_lshrrev_b32_e64 v143, 18, v143
v_pk_add_f16 v150, v150, 1.0 op_sel_hi:[1,0]
v_pk_add_f16 v147, v147, 1.0 op_sel_hi:[1,0]
v_permlane16_swap_b32 v107, v111
v_and_b32 v145, s49, v145
v_rcp_f16_e64 v154, v153
v_bfe_u32 v144, v145, 2, 14
v_rcp_f16 v151, v150
v_permlane16_swap_b32 v112, v116
v_lshrrev_b32_e64 v145, 18, v145
ds_read_u16_d16 v140, v140
ds_read_u16_d16 v142, v142
ds_read_u16_d16_hi v141, v141
ds_read_u16_d16_hi v143, v143
ds_read_u16_d16 v144, v144
ds_read_u16_d16_hi v145, v145
v_rcp_f16 v148, v147
s_waitcnt lgkmcnt(6)
v_or_b32 v216, v136, v137
v_permlane16_swap_b32 v113, v117
v_permlane16_swap_b32 v211, v215
v_or_b32 v217, v138, v139
v_rcp_f16_sdwa v154, v153 dst_sel:WORD_1 dst_unused:UNUSED_PRESERVE src0_sel:WORD_1
s_waitcnt lgkmcnt(3)
v_or_b32 v218, v140, v141
v_permlane16_swap_b32 v114, v118
v_rcp_f16_sdwa v151, v150 dst_sel:WORD_1 dst_unused:UNUSED_PRESERVE src0_sel:WORD_1
s_waitcnt lgkmcnt(2)
v_or_b32_e64 v219, v142, v143
v_rcp_f16_sdwa v148, v147 dst_sel:WORD_1 dst_unused:UNUSED_PRESERVE src0_sel:WORD_1
v_permlane16_swap_b32 v115, v119
s_waitcnt lgkmcnt(0)
v_or_b32_e64 v220, v144, v145
v_pk_mul_f16 v221, v155, v154
v_pk_mul_f16 v222, v152, v151
v_pk_mul_f16 v223, v149, v148
s_cmp_eq_u32 s77, 0
s_cbranch_scc1 Lpp7
s_getreg_b32 s43, hwreg(HW_REG_IB_STS, 0, 4)
s_cmp_lg_u32 s43, 0
s_cbranch_scc1 Lpp7
s_call_b64 s[78:79], Lpoll
s_setprio 1
Lpp7:
v_permlane16_swap_b32 v216, v220
v_permlane16_swap_b32 v217, v221
s_setprio 0
v_permlane16_swap_b32 v218, v222
v_permlane16_swap_b32 v219, v223
s_cmp_eq_u32 s77, 0
s_cbranch_scc1 Lpp8
s_getreg_b32 s43, hwreg(HW_REG_IB_STS, 0, 4)
s_cmp_lg_u32 s43, 0
s_cbranch_scc1 Lpp8
s_call_b64 s[78:79], Lpoll
s_setprio 0
Lpp8:
s_setprio 2
v_lshrrev_b32_e64 v225, 5, v251
v_lshl_add_u32 v224, v225, 9, s72
v_lshl_add_u32 v226, v225, 4, s72
v_and_b32 v225, 15, v251
v_lshl_add_u32 v224, v225, 4, v224
v_bfe_u32 v225, v251, 4, 1
v_lshl_add_u32 v224, v225, 3, v224
s_waitcnt vmcnt(0)
ds_read_b64_tr_b16 v[120:121], v224
ds_read_b64_tr_b16 v[122:123], v224 offset:256
ds_read_b64_tr_b16 v[124:125], v224 offset:1024
ds_read_b64_tr_b16 v[126:127], v224 offset:1280
ds_read_b64_tr_b16 v[128:129], v224 offset:2048
ds_read_b64_tr_b16 v[130:131], v224 offset:2304
ds_read_b64_tr_b16 v[132:133], v224 offset:3072
ds_read_b64_tr_b16 v[134:135], v224 offset:3328
ds_read_b64_tr_b16 v[136:137], v224 offset:4096
ds_read_b64_tr_b16 v[138:139], v224 offset:4352
ds_read_b64_tr_b16 v[140:141], v224 offset:5120
ds_read_b64_tr_b16 v[142:143], v224 offset:5376
ds_read_b64_tr_b16 v[144:145], v224 offset:6144
ds_read_b64_tr_b16 v[146:147], v224 offset:6400
ds_read_b64_tr_b16 v[148:149], v224 offset:7168
ds_read_b64_tr_b16 v[150:151], v224 offset:7424
ds_read_b64_tr_b16 v[152:153], v224 offset:8192
ds_read_b64_tr_b16 v[154:155], v224 offset:8448
v_lshrrev_b32 v225, 4, v251
v_and_b32 v227, 15, v251
v_mul_u32_u24 v252, 192, v227
v_lshl_add_u32 v252, v225, 4, v252
v_lshlrev_b32 v254, 5, v225
v_and_b32 v253, 47, v251
v_lshlrev_b32 v253, 4, v253
v_and_b32 v225, 1, v225
v_mul_u32_u24 v227, 3072, v225
v_add_u32_e64 v248, v227, v253
v_add_u32 v249, 65536, v248
v_add_u32 v250, 131072, v248
v_lshl_add_u32 v253, v225, 21, v253
v_mov_b32 v225, 16256
v_mov_b32_e64 v227, 1
s_waitcnt lgkmcnt(0)
s_mov_b64 exec, 1
ds_add_u32 v225, v227 offset:8
s_mov_b64 exec, -1
v_lshlrev_b32 v228, 16, v120
v_and_b32 v229, 4294901760, v120
v_cvt_pk_f16_f32 v120, v228, v229
v_lshlrev_b32_e64 v230, 16, v121
v_and_b32 v231, 4294901760, v121
v_cvt_pk_f16_f32 v121, v230, v231
v_lshlrev_b32_e64 v228, 16, v122
v_and_b32 v229, 4294901760, v122
v_cvt_pk_f16_f32 v122, v228, v229
v_lshlrev_b32_e64 v230, 16, v123
v_and_b32 v231, 4294901760, v123
v_cvt_pk_f16_f32 v123, v230, v231
v_lshlrev_b32_e64 v228, 16, v124
v_and_b32 v229, 4294901760, v124
v_cvt_pk_f16_f32 v124, v228, v229
v_lshlrev_b32_e64 v230, 16, v125
v_and_b32 v231, 4294901760, v125
v_cvt_pk_f16_f32 v125, v230, v231
v_lshlrev_b32_e64 v228, 16, v126
v_and_b32 v229, 4294901760, v126
v_cvt_pk_f16_f32 v126, v228, v229
v_lshlrev_b32_e64 v230, 16, v127
v_and_b32 v231, 4294901760, v127
v_cvt_pk_f16_f32 v127, v230, v231
v_lshlrev_b32_e64 v228, 16, v128
v_and_b32 v229, 4294901760, v128
v_cvt_pk_f16_f32 v128, v228, v229
v_lshlrev_b32_e64 v230, 16, v129
v_and_b32 v231, 4294901760, v129
v_cvt_pk_f16_f32 v129, v230, v231
v_lshlrev_b32_e64 v228, 16, v130
v_and_b32 v229, 4294901760, v130
v_cvt_pk_f16_f32 v130, v228, v229
v_lshlrev_b32_e64 v230, 16, v131
v_and_b32 v231, 4294901760, v131
v_cvt_pk_f16_f32 v131, v230, v231
s_cmp_eq_u32 s77, 0
s_cbranch_scc1 Lpp911
s_getreg_b32 s43, hwreg(HW_REG_IB_STS, 0, 4)
s_cmp_lg_u32 s43, 0
s_cbranch_scc1 Lpp911
s_call_b64 s[78:79], Lpoll
s_setprio 2
Lpp911:
v_lshlrev_b32 v228, 16, v132
v_and_b32 v229, 4294901760, v132
v_cvt_pk_f16_f32 v132, v228, v229
v_lshlrev_b32_e64 v230, 16, v133
v_and_b32 v231, 4294901760, v133
v_cvt_pk_f16_f32 v133, v230, v231
v_lshlrev_b32_e64 v228, 16, v134
v_and_b32 v229, 4294901760, v134
v_cvt_pk_f16_f32 v134, v228, v229
v_lshlrev_b32_e64 v230, 16, v135
v_and_b32 v231, 4294901760, v135
v_cvt_pk_f16_f32 v135, v230, v231
v_lshlrev_b32_e64 v228, 16, v136
v_and_b32 v229, 4294901760, v136
v_cvt_pk_f16_f32 v136, v228, v229
v_lshlrev_b32_e64 v230, 16, v137
v_and_b32 v231, 4294901760, v137
v_cvt_pk_f16_f32 v137, v230, v231
v_lshlrev_b32_e64 v228, 16, v138
v_and_b32 v229, 4294901760, v138
v_cvt_pk_f16_f32 v138, v228, v229
v_lshlrev_b32_e64 v230, 16, v139
v_and_b32 v231, 4294901760, v139
v_cvt_pk_f16_f32 v139, v230, v231
v_lshlrev_b32_e64 v228, 16, v140
v_and_b32 v229, 4294901760, v140
v_cvt_pk_f16_f32 v140, v228, v229
v_lshlrev_b32_e64 v230, 16, v141
v_and_b32 v231, 4294901760, v141
v_cvt_pk_f16_f32 v141, v230, v231
v_lshlrev_b32_e64 v228, 16, v142
v_and_b32 v229, 4294901760, v142
v_cvt_pk_f16_f32 v142, v228, v229
v_lshlrev_b32_e64 v230, 16, v143
v_and_b32 v231, 4294901760, v143
v_cvt_pk_f16_f32 v143, v230, v231
s_cmp_eq_u32 s77, 0
s_cbranch_scc1 Lpp923
s_getreg_b32 s43, hwreg(HW_REG_IB_STS, 0, 4)
s_cmp_lg_u32 s43, 0
s_cbranch_scc1 Lpp923
s_call_b64 s[78:79], Lpoll
s_setprio 2
Lpp923:
v_lshlrev_b32 v228, 16, v144
v_and_b32 v229, 4294901760, v144
v_cvt_pk_f16_f32 v144, v228, v229
v_lshlrev_b32_e64 v230, 16, v145
v_and_b32 v231, 4294901760, v145
v_cvt_pk_f16_f32 v145, v230, v231
v_lshlrev_b32_e64 v228, 16, v146
v_and_b32 v229, 4294901760, v146
v_cvt_pk_f16_f32 v146, v228, v229
v_lshlrev_b32_e64 v230, 16, v147
v_and_b32 v231, 4294901760, v147
v_cvt_pk_f16_f32 v147, v230, v231
v_lshlrev_b32_e64 v228, 16, v148
v_and_b32 v229, 4294901760, v148
v_cvt_pk_f16_f32 v148, v228, v229
v_lshlrev_b32_e64 v230, 16, v149
v_and_b32 v231, 4294901760, v149
v_cvt_pk_f16_f32 v149, v230, v231
v_lshlrev_b32_e64 v228, 16, v150
v_and_b32 v229, 4294901760, v150
v_cvt_pk_f16_f32 v150, v228, v229
v_lshlrev_b32_e64 v230, 16, v151
v_and_b32 v231, 4294901760, v151
v_cvt_pk_f16_f32 v151, v230, v231
v_lshlrev_b32_e64 v228, 16, v152
v_and_b32 v229, 4294901760, v152
v_cvt_pk_f16_f32 v152, v228, v229
v_lshlrev_b32_e64 v230, 16, v153
v_and_b32 v231, 4294901760, v153
v_cvt_pk_f16_f32 v153, v230, v231
v_lshlrev_b32_e64 v228, 16, v154
v_and_b32 v229, 4294901760, v154
v_cvt_pk_f16_f32 v154, v228, v229
v_lshlrev_b32_e64 v230, 16, v155
v_and_b32 v231, 4294901760, v155
v_cvt_pk_f16_f32 v155, v230, v231
s_cmp_eq_u32 s77, 0
s_cbranch_scc1 Lpp935
s_getreg_b32 s43, hwreg(HW_REG_IB_STS, 0, 4)
s_cmp_lg_u32 s43, 0
s_cbranch_scc1 Lpp935
s_call_b64 s[78:79], Lpoll
s_setprio 2
Lpp935:
v_lshl_add_u32 v224, v251, 4, s72
s_cmp_lg_u32 s40, 0
s_cbranch_scc1 Lnofin
Lspin:
s_cmp_eq_u32 s77, 0
s_cbranch_scc1 Lspinx
s_cmp_eq_u32 s76, 0
s_cbranch_scc1 Lspinx
s_sub_u32 s76, s76, 1
s_call_b64 s[78:79], Lpoll
s_branch Lspin
Lspinx:
v_add_u32_e64 v162, 0, v251
v_mul_u32_u24 v165, 2731, v162
v_lshrrev_b32_e64 v165, 16, v165
v_mul_u32_u24 v165, 9120, v165
v_lshl_add_u32 v162, v162, 2, v165
v_add_u32 v162, 90112, v162
v_add_u32_e64 v163, 64, v251
v_mul_u32_u24 v165, 2731, v163
v_lshrrev_b32_e64 v165, 16, v165
v_mul_u32_u24 v165, 9120, v165
v_lshl_add_u32 v163, v163, 2, v165
v_add_u32 v163, 90112, v163
v_add_u32 v164, 128, v251
v_mul_u32_u24 v165, 2731, v164
v_lshrrev_b32_e64 v165, 16, v165
v_mul_u32_u24 v165, 9120, v165
v_lshl_add_u32 v164, v164, 2, v165
v_add_u32 v164, 90112, v164
v_mov_b32 v165, 16256
Lrrw:
ds_read_b32 v166, v165 offset:8
s_waitcnt lgkmcnt(0)
v_readfirstlane_b32 s43, v166
s_cmp_eq_u32 s76, 0
s_cbranch_scc1 Lrrx
s_sub_u32 s76, s76, 1
s_cmp_lt_u32 s43, 8
s_cbranch_scc0 Lrrx
s_sleep 2
s_branch Lrrw
Lrrx:
ds_write_b32 v162, v244
ds_write_b32 v163, v245
ds_write_b32 v164, v246
Lnofin:
s_waitcnt lgkmcnt(0)
s_barrier
ds_read_b128 v[228:231], v226
ds_read_b128 v[232:235], v226 offset:32
ds_read_b128 v[236:239], v226 offset:64
buffer_load_dwordx4 v[240:243], v252, s[4:7], s71 offen
buffer_load_dwordx4 v[244:247], v252, s[4:7], s71 offen offset:64
s_waitcnt lgkmcnt(0)
v_pk_mul_f16 v120, v120, v228
v_pk_mul_f16 v121, v121, v229
v_pk_mul_f16 v122, v122, v230
v_pk_mul_f16 v123, v123, v231
ds_write_b128 v224, v[120:123]
v_pk_mul_f16 v124, v124, v228
v_pk_mul_f16 v125, v125, v229
v_pk_mul_f16 v126, v126, v230
v_pk_mul_f16 v127, v127, v231
ds_write_b128 v224, v[124:127] offset:1024
v_pk_mul_f16 v128, v128, v228
v_pk_mul_f16 v129, v129, v229
v_pk_mul_f16 v130, v130, v230
v_pk_mul_f16 v131, v131, v231
ds_write_b128 v224, v[128:131] offset:2048
v_pk_mul_f16 v132, v132, v232
v_pk_mul_f16 v133, v133, v233
v_pk_mul_f16 v134, v134, v234
v_pk_mul_f16 v135, v135, v235
ds_write_b128 v224, v[132:135] offset:3072
v_pk_mul_f16 v136, v136, v232
v_pk_mul_f16 v137, v137, v233
v_pk_mul_f16 v138, v138, v234
v_pk_mul_f16 v139, v139, v235
ds_write_b128 v224, v[136:139] offset:4096
v_pk_mul_f16 v140, v140, v232
v_pk_mul_f16 v141, v141, v233
v_pk_mul_f16 v142, v142, v234
v_pk_mul_f16 v143, v143, v235
ds_write_b128 v224, v[140:143] offset:5120
v_pk_mul_f16 v144, v144, v236
v_pk_mul_f16 v145, v145, v237
v_pk_mul_f16 v146, v146, v238
v_pk_mul_f16 v147, v147, v239
ds_write_b128 v224, v[144:147] offset:6144
v_pk_mul_f16 v148, v148, v236
v_pk_mul_f16 v149, v149, v237
v_pk_mul_f16 v150, v150, v238
v_pk_mul_f16 v151, v151, v239
ds_write_b128 v224, v[148:151] offset:7168
v_pk_mul_f16 v152, v152, v236
v_pk_mul_f16 v153, v153, v237
v_pk_mul_f16 v154, v154, v238
v_pk_mul_f16 v155, v155, v239
ds_write_b128 v224, v[152:155] offset:8192
s_waitcnt lgkmcnt(0)
s_barrier
s_setprio 3
ds_read_b128 v[224:227], v249 offset:24576
ds_read_b128 v[228:231], v254 offset:7936
ds_read_b128 v[232:235], v249 offset:24832
ds_read_b128 v[236:239], v254 offset:7952
s_waitcnt lgkmcnt(2)
v_mfma_f32_16x16x32_f16 v[120:123], v[224:227], v[0:3], v[228:231]
v_mfma_f32_16x16x32_f16 v[128:131], v[224:227], v[4:7], v[228:231]
s_waitcnt lgkmcnt(0)
v_mfma_f32_16x16x32_f16 v[124:127], v[232:235], v[0:3], v[236:239]
ds_read_b128 v[224:227], v249 offset:25600
ds_read_b128 v[228:231], v254 offset:8064
v_mfma_f32_16x16x32_f16 v[132:135], v[232:235], v[4:7], v[236:239]
s_waitcnt lgkmcnt(0)
v_mfma_f32_16x16x32_f16 v[136:139], v[224:227], v[0:3], v[228:231]
ds_read_b128 v[232:235], v249 offset:25856
ds_read_b128 v[236:239], v254 offset:8080
v_mfma_f32_16x16x32_f16 v[144:147], v[224:227], v[4:7], v[228:231]
s_waitcnt lgkmcnt(0)
v_mfma_f32_16x16x32_f16 v[140:143], v[232:235], v[0:3], v[236:239]
ds_read_b128 v[224:227], v249 offset:26624
ds_read_b128 v[228:231], v254 offset:16128
v_mfma_f32_16x16x32_f16 v[148:151], v[232:235], v[4:7], v[236:239]
s_waitcnt lgkmcnt(0)
v_mfma_f32_16x16x32_f16 v[152:155], v[224:227], v[0:3], v[228:231]
ds_read_b128 v[232:235], v249 offset:26880
ds_read_b128 v[236:239], v254 offset:16144
v_mfma_f32_16x16x32_f16 v[160:163], v[224:227], v[4:7], v[228:231]
s_waitcnt lgkmcnt(0)
v_mfma_f32_16x16x32_f16 v[156:159], v[232:235], v[0:3], v[236:239]
ds_read_b128 v[224:227], v249 offset:30720
ds_read_b128 v[228:231], v249 offset:30976
v_mfma_f32_16x16x32_f16 v[164:167], v[232:235], v[4:7], v[236:239]
s_waitcnt lgkmcnt(1)
v_mfma_f32_16x16x32_f16 v[120:123], v[224:227], v[8:11], v[120:123]
ds_read_b128 v[232:235], v249 offset:31744
ds_read_b128 v[236:239], v249 offset:32000
v_mfma_f32_16x16x32_f16 v[128:131], v[224:227], v[12:15], v[128:131]
s_waitcnt lgkmcnt(2)
v_mfma_f32_16x16x32_f16 v[124:127], v[228:231], v[8:11], v[124:127]
ds_read_b128 v[224:227], v249 offset:32768
v_mfma_f32_16x16x32_f16 v[132:135], v[228:231], v[12:15], v[132:135]
s_waitcnt lgkmcnt(2)
v_mfma_f32_16x16x32_f16 v[136:139], v[232:235], v[8:11], v[136:139]
ds_read_b128 v[228:231], v249 offset:33024
v_mfma_f32_16x16x32_f16 v[144:147], v[232:235], v[12:15], v[144:147]
s_waitcnt lgkmcnt(2)
v_mfma_f32_16x16x32_f16 v[140:143], v[236:239], v[8:11], v[140:143]
ds_read_b128 v[232:235], v249 offset:36864
v_mfma_f32_16x16x32_f16 v[148:151], v[236:239], v[12:15], v[148:151]
s_waitcnt lgkmcnt(2)
v_mfma_f32_16x16x32_f16 v[152:155], v[224:227], v[8:11], v[152:155]
ds_read_b128 v[236:239], v249 offset:37120
v_mfma_f32_16x16x32_f16 v[160:163], v[224:227], v[12:15], v[160:163]
s_waitcnt lgkmcnt(2)
v_mfma_f32_16x16x32_f16 v[156:159], v[228:231], v[8:11], v[156:159]
ds_read_b128 v[224:227], v249 offset:37888
v_mfma_f32_16x16x32_f16 v[164:167], v[228:231], v[12:15], v[164:167]
s_waitcnt lgkmcnt(2)
v_mfma_f32_16x16x32_f16 v[120:123], v[232:235], v[16:19], v[120:123]
buffer_load_dwordx4 v[12:15], v252, s[4:7], s71 offen offset:128
ds_read_b128 v[228:231], v249 offset:38144
v_mfma_f32_16x16x32_f16 v[128:131], v[232:235], v[20:23], v[128:131]
s_waitcnt lgkmcnt(2)
v_mfma_f32_16x16x32_f16 v[124:127], v[236:239], v[16:19], v[124:127]
ds_read_b128 v[232:235], v249 offset:38912
v_mfma_f32_16x16x32_f16 v[132:135], v[236:239], v[20:23], v[132:135]
s_waitcnt lgkmcnt(2)
v_mfma_f32_16x16x32_f16 v[136:139], v[224:227], v[16:19], v[136:139]
ds_read_b128 v[236:239], v249 offset:39168
v_mfma_f32_16x16x32_f16 v[144:147], v[224:227], v[20:23], v[144:147]
s_waitcnt lgkmcnt(2)
v_mfma_f32_16x16x32_f16 v[140:143], v[228:231], v[16:19], v[140:143]
s_add_u32 s46, s71, 98304
buffer_load_dwordx4 v[8:11], v252, s[4:7], s46 offen
ds_read_b128 v[224:227], v249 offset:43008
v_mfma_f32_16x16x32_f16 v[148:151], v[228:231], v[20:23], v[148:151]
s_waitcnt lgkmcnt(2)
v_mfma_f32_16x16x32_f16 v[152:155], v[232:235], v[16:19], v[152:155]
ds_read_b128 v[228:231], v249 offset:43264
v_mfma_f32_16x16x32_f16 v[160:163], v[232:235], v[20:23], v[160:163]
s_waitcnt lgkmcnt(2)
v_mfma_f32_16x16x32_f16 v[156:159], v[236:239], v[16:19], v[156:159]
ds_read_b128 v[232:235], v249 offset:44032
v_mfma_f32_16x16x32_f16 v[164:167], v[236:239], v[20:23], v[164:167]
s_waitcnt lgkmcnt(2)
v_mfma_f32_16x16x32_f16 v[120:123], v[224:227], v[24:27], v[120:123]
s_add_u32 s46, s71, 98304
buffer_load_dwordx4 v[4:7], v252, s[4:7], s46 offen offset:64
ds_read_b128 v[236:239], v249 offset:44288
v_mfma_f32_16x16x32_f16 v[128:131], v[224:227], v[28:31], v[128:131]
s_waitcnt lgkmcnt(2)
v_mfma_f32_16x16x32_f16 v[124:127], v[228:231], v[24:27], v[124:127]
ds_read_b128 v[224:227], v249 offset:45056
v_mfma_f32_16x16x32_f16 v[132:135], v[228:231], v[28:31], v[132:135]
s_waitcnt lgkmcnt(2)
v_mfma_f32_16x16x32_f16 v[136:139], v[232:235], v[24:27], v[136:139]
ds_read_b128 v[228:231], v249 offset:45312
v_mfma_f32_16x16x32_f16 v[144:147], v[232:235], v[28:31], v[144:147]
s_waitcnt lgkmcnt(2)
v_mfma_f32_16x16x32_f16 v[140:143], v[236:239], v[24:27], v[140:143]
s_add_u32 s46, s71, 98304
buffer_load_dwordx4 v[0:3], v252, s[4:7], s46 offen offset:128
ds_read_b128 v[232:235], v249 offset:49152
v_mfma_f32_16x16x32_f16 v[148:151], v[236:239], v[28:31], v[148:151]
s_waitcnt lgkmcnt(2)
v_mfma_f32_16x16x32_f16 v[152:155], v[224:227], v[24:27], v[152:155]
ds_read_b128 v[236:239], v249 offset:49408
v_mfma_f32_16x16x32_f16 v[160:163], v[224:227], v[28:31], v[160:163]
s_waitcnt lgkmcnt(2)
v_mfma_f32_16x16x32_f16 v[156:159], v[228:231], v[24:27], v[156:159]
ds_read_b128 v[224:227], v249 offset:50176
v_mfma_f32_16x16x32_f16 v[164:167], v[228:231], v[28:31], v[164:167]
s_waitcnt lgkmcnt(2)
v_mfma_f32_16x16x32_f16 v[120:123], v[232:235], v[32:35], v[120:123]
buffer_load_dwordx4 v[24:27], v253, s[32:35], s80 offen nt
ds_read_b128 v[228:231], v249 offset:50432
v_mfma_f32_16x16x32_f16 v[128:131], v[232:235], v[36:39], v[128:131]
v_and_b32 v16, 1, v251
s_waitcnt lgkmcnt(2)
v_mfma_f32_16x16x32_f16 v[124:127], v[236:239], v[32:35], v[124:127]
ds_read_b128 v[232:235], v249 offset:51200
v_mfma_f32_16x16x32_f16 v[132:135], v[236:239], v[36:39], v[132:135]
v_lshlrev_b32 v16, 4, v16
s_waitcnt lgkmcnt(2)
v_mfma_f32_16x16x32_f16 v[136:139], v[224:227], v[32:35], v[136:139]
ds_read_b128 v[236:239], v249 offset:51456
v_mov_b32 v17, 16256
v_mfma_f32_16x16x32_f16 v[144:147], v[224:227], v[36:39], v[144:147]
s_waitcnt lgkmcnt(2)
v_mfma_f32_16x16x32_f16 v[140:143], v[228:231], v[32:35], v[140:143]
ds_read_b128 v[224:227], v249 offset:55296
v_lshlrev_b32 v16, v16, v17
v_mfma_f32_16x16x32_f16 v[148:151], v[228:231], v[36:39], v[148:151]
v_lshrrev_b32 v17, 2, v251
s_waitcnt lgkmcnt(2)
v_mfma_f32_16x16x32_f16 v[152:155], v[232:235], v[32:35], v[152:155]
ds_read_b128 v[228:231], v249 offset:55552
v_mfma_f32_16x16x32_f16 v[160:163], v[232:235], v[36:39], v[160:163]
v_xor_b32 v17, v17, v251
s_waitcnt lgkmcnt(2)
v_mfma_f32_16x16x32_f16 v[156:159], v[236:239], v[32:35], v[156:159]
ds_read_b128 v[232:235], v249 offset:56320
v_mfma_f32_16x16x32_f16 v[164:167], v[236:239], v[36:39], v[164:167]
v_and_b32 v17, 12, v17
s_waitcnt lgkmcnt(2)
v_mfma_f32_16x16x32_f16 v[120:123], v[224:227], v[40:43], v[120:123]
buffer_load_dwordx4 v[28:31], v253, s[32:35], s80 offen offset:256 nt
ds_read_b128 v[236:239], v249 offset:56576
v_and_b32 v20, 2, v251
v_mfma_f32_16x16x32_f16 v[128:131], v[224:227], v[44:47], v[128:131]
s_waitcnt lgkmcnt(2)
v_mfma_f32_16x16x32_f16 v[124:127], v[228:231], v[40:43], v[124:127]
ds_read_b128 v[224:227], v249 offset:57344
v_or_b32_e64 v17, v17, v20
v_mfma_f32_16x16x32_f16 v[132:135], v[228:231], v[44:47], v[132:135]
v_cmp_eq_u32 vcc, 0, v17
s_nop 1
v_cndmask_b32 v18, 0, v16, vcc
s_waitcnt lgkmcnt(2)
v_mfma_f32_16x16x32_f16 v[136:139], v[232:235], v[40:43], v[136:139]
ds_read_b128 v[228:231], v249 offset:57600
v_mfma_f32_16x16x32_f16 v[144:147], v[232:235], v[44:47], v[144:147]
v_cmp_eq_u32 vcc, 2, v17
s_nop 1
v_cndmask_b32 v19, 0, v16, vcc
s_waitcnt lgkmcnt(2)
v_mfma_f32_16x16x32_f16 v[140:143], v[236:239], v[40:43], v[140:143]
ds_read_b128 v[232:235], v249 offset:61440
v_mfma_f32_16x16x32_f16 v[148:151], v[236:239], v[44:47], v[148:151]
v_mov_b32 v16, 0
s_waitcnt lgkmcnt(2)
v_mfma_f32_16x16x32_f16 v[152:155], v[224:227], v[40:43], v[152:155]
ds_read_b128 v[236:239], v249 offset:61696
v_mov_b32 v17, 0
v_mfma_f32_16x16x32_f16 v[160:163], v[224:227], v[44:47], v[160:163]
s_waitcnt lgkmcnt(2)
v_mfma_f32_16x16x32_f16 v[156:159], v[228:231], v[40:43], v[156:159]
ds_read_b128 v[224:227], v249 offset:62464
v_mov_b32_e64 v20, 0
v_mfma_f32_16x16x32_f16 v[164:167], v[228:231], v[44:47], v[164:167]
v_mov_b32 v21, 0
s_waitcnt lgkmcnt(2)
v_mfma_f32_16x16x32_f16 v[120:123], v[232:235], v[48:51], v[120:123]
s_add_u32 s46, s80, 4194304
buffer_load_dwordx4 v[32:35], v253, s[32:35], s46 offen nt
ds_read_b128 v[228:231], v249 offset:62720
v_mfma_f32_16x16x32_f16 v[128:131], v[232:235], v[52:55], v[128:131]
s_waitcnt lgkmcnt(2)
v_mfma_f32_16x16x32_f16 v[124:127], v[236:239], v[48:51], v[124:127]
ds_read_b128 v[232:235], v249 offset:63488
v_mfma_f32_16x16x32_f16 v[132:135], v[236:239], v[52:55], v[132:135]
s_waitcnt lgkmcnt(2)
v_mfma_f32_16x16x32_f16 v[136:139], v[224:227], v[48:51], v[136:139]
ds_read_b128 v[236:239], v249 offset:63744
v_mfma_f32_16x16x32_f16 v[144:147], v[224:227], v[52:55], v[144:147]
s_waitcnt lgkmcnt(2)
v_mfma_f32_16x16x32_f16 v[140:143], v[228:231], v[48:51], v[140:143]
ds_read_b128 v[224:227], v250 offset:2048
v_mfma_f32_16x16x32_f16 v[148:151], v[228:231], v[52:55], v[148:151]
s_waitcnt lgkmcnt(2)
v_mfma_f32_16x16x32_f16 v[152:155], v[232:235], v[48:51], v[152:155]
ds_read_b128 v[228:231], v250 offset:2304
v_mfma_f32_16x16x32_f16 v[160:163], v[232:235], v[52:55], v[160:163]
s_waitcnt lgkmcnt(2)
v_mfma_f32_16x16x32_f16 v[156:159], v[236:239], v[48:51], v[156:159]
ds_read_b128 v[232:235], v250 offset:3072
v_mfma_f32_16x16x32_f16 v[164:167], v[236:239], v[52:55], v[164:167]
s_waitcnt lgkmcnt(2)
v_mfma_f32_16x16x32_f16 v[120:123], v[224:227], v[56:59], v[120:123]
ds_read_b128 v[236:239], v250 offset:3328
v_mfma_f32_16x16x32_f16 v[128:131], v[224:227], v[60:63], v[128:131]
s_waitcnt lgkmcnt(2)
v_mfma_f32_16x16x32_f16 v[124:127], v[228:231], v[56:59], v[124:127]
s_add_u32 s46, s80, 4194304
buffer_load_dwordx4 v[36:39], v253, s[32:35], s46 offen offset:256 nt
ds_read_b128 v[224:227], v250 offset:4096
v_mfma_f32_16x16x32_f16 v[132:135], v[228:231], v[60:63], v[132:135]
s_waitcnt lgkmcnt(2)
v_mfma_f32_16x16x32_f16 v[136:139], v[232:235], v[56:59], v[136:139]
ds_read_b128 v[228:231], v250 offset:4352
v_mfma_f32_16x16x32_f16 v[144:147], v[232:235], v[60:63], v[144:147]
s_waitcnt lgkmcnt(2)
v_mfma_f32_16x16x32_f16 v[140:143], v[236:239], v[56:59], v[140:143]
ds_read_b128 v[232:235], v250 offset:8192
v_mfma_f32_16x16x32_f16 v[148:151], v[236:239], v[60:63], v[148:151]
s_waitcnt lgkmcnt(2)
v_mfma_f32_16x16x32_f16 v[152:155], v[224:227], v[56:59], v[152:155]
ds_read_b128 v[236:239], v250 offset:8448
v_mfma_f32_16x16x32_f16 v[160:163], v[224:227], v[60:63], v[160:163]
s_waitcnt lgkmcnt(2)
v_mfma_f32_16x16x32_f16 v[156:159], v[228:231], v[56:59], v[156:159]
ds_read_b128 v[224:227], v250 offset:9216
v_mfma_f32_16x16x32_f16 v[164:167], v[228:231], v[60:63], v[164:167]
s_waitcnt vmcnt(9)
v_mfma_f32_16x16x32_bf16 v[120:123], v[18:21], v[240:243], v[120:123]
ds_read_b128 v[228:231], v250 offset:9472
v_mfma_f32_16x16x32_bf16 v[124:127], v[16:19], v[240:243], v[124:127]
s_waitcnt vmcnt(8)
v_mfma_f32_16x16x32_bf16 v[136:139], v[18:21], v[244:247], v[136:139]
v_mfma_f32_16x16x32_bf16 v[140:143], v[16:19], v[244:247], v[140:143]
s_waitcnt lgkmcnt(3)
v_mfma_f32_16x16x32_f16 v[120:123], v[232:235], v[64:67], v[120:123]
s_add_u32 s46, s80, 8388608
buffer_load_dwordx4 v[40:43], v253, s[32:35], s46 offen nt
v_mfma_f32_16x16x32_f16 v[128:131], v[232:235], v[68:71], v[128:131]
s_waitcnt lgkmcnt(2)
v_mfma_f32_16x16x32_f16 v[124:127], v[236:239], v[64:67], v[124:127]
ds_read_b128 v[232:235], v250 offset:10240
v_mfma_f32_16x16x32_f16 v[132:135], v[236:239], v[68:71], v[132:135]
s_waitcnt lgkmcnt(2)
v_mfma_f32_16x16x32_f16 v[136:139], v[224:227], v[64:67], v[136:139]
ds_read_b128 v[236:239], v250 offset:10496
v_mfma_f32_16x16x32_f16 v[144:147], v[224:227], v[68:71], v[144:147]
s_waitcnt lgkmcnt(2)
v_mfma_f32_16x16x32_f16 v[140:143], v[228:231], v[64:67], v[140:143]
ds_read_b128 v[224:227], v250 offset:14336
v_mfma_f32_16x16x32_f16 v[148:151], v[228:231], v[68:71], v[148:151]
s_waitcnt lgkmcnt(2)
v_mfma_f32_16x16x32_f16 v[152:155], v[232:235], v[64:67], v[152:155]
ds_read_b128 v[228:231], v250 offset:14592
v_mfma_f32_16x16x32_f16 v[160:163], v[232:235], v[68:71], v[160:163]
s_waitcnt lgkmcnt(2)
v_mfma_f32_16x16x32_f16 v[156:159], v[236:239], v[64:67], v[156:159]
ds_read_b128 v[232:235], v250 offset:15360
v_mfma_f32_16x16x32_f16 v[164:167], v[236:239], v[68:71], v[164:167]
s_waitcnt lgkmcnt(2)
v_mfma_f32_16x16x32_f16 v[120:123], v[224:227], v[72:75], v[120:123]
ds_read_b128 v[236:239], v250 offset:15616
v_mfma_f32_16x16x32_f16 v[128:131], v[224:227], v[76:79], v[128:131]
s_waitcnt lgkmcnt(2)
v_mfma_f32_16x16x32_f16 v[124:127], v[228:231], v[72:75], v[124:127]
s_add_u32 s46, s80, 8388608
buffer_load_dwordx4 v[44:47], v253, s[32:35], s46 offen offset:256 nt
ds_read_b128 v[224:227], v250 offset:16384
v_mfma_f32_16x16x32_f16 v[132:135], v[228:231], v[76:79], v[132:135]
s_waitcnt lgkmcnt(2)
v_mfma_f32_16x16x32_f16 v[136:139], v[232:235], v[72:75], v[136:139]
ds_read_b128 v[228:231], v250 offset:16640
v_mfma_f32_16x16x32_f16 v[144:147], v[232:235], v[76:79], v[144:147]
s_waitcnt lgkmcnt(2)
v_mfma_f32_16x16x32_f16 v[140:143], v[236:239], v[72:75], v[140:143]
ds_read_b128 v[232:235], v250 offset:20480
v_mfma_f32_16x16x32_f16 v[148:151], v[236:239], v[76:79], v[148:151]
s_waitcnt lgkmcnt(2)
v_mfma_f32_16x16x32_f16 v[152:155], v[224:227], v[72:75], v[152:155]
ds_read_b128 v[236:239], v250 offset:20736
v_mfma_f32_16x16x32_f16 v[160:163], v[224:227], v[76:79], v[160:163]
s_waitcnt lgkmcnt(2)
v_mfma_f32_16x16x32_f16 v[156:159], v[228:231], v[72:75], v[156:159]
ds_read_b128 v[224:227], v250 offset:21504
v_mfma_f32_16x16x32_f16 v[164:167], v[228:231], v[76:79], v[164:167]
s_waitcnt vmcnt(9)
v_mfma_f32_16x16x32_bf16 v[152:155], v[18:21], v[12:15], v[152:155]
ds_read_b128 v[228:231], v250 offset:21760
v_mfma_f32_16x16x32_bf16 v[156:159], v[16:19], v[12:15], v[156:159]
s_waitcnt vmcnt(8)
v_mfma_f32_16x16x32_bf16 v[128:131], v[18:21], v[8:11], v[128:131]
v_mfma_f32_16x16x32_bf16 v[132:135], v[16:19], v[8:11], v[132:135]
v_and_b32 v255, 1, v251
v_lshlrev_b32 v255, 7, v255
v_sub_u32 v255, v252, v255
s_mov_b32 s74, 1431655765
s_mov_b32 s75, 1431655765
s_waitcnt lgkmcnt(3)
v_mfma_f32_16x16x32_f16 v[120:123], v[232:235], v[80:83], v[120:123]
buffer_load_dwordx4 v[12:15], v252, s[4:7], s70 offen
v_mfma_f32_16x16x32_f16 v[128:131], v[232:235], v[84:87], v[128:131]
s_waitcnt lgkmcnt(2)
v_mfma_f32_16x16x32_f16 v[124:127], v[236:239], v[80:83], v[124:127]
ds_read_b128 v[232:235], v250 offset:22528
v_mfma_f32_16x16x32_f16 v[132:135], v[236:239], v[84:87], v[132:135]
s_waitcnt lgkmcnt(2)
v_mfma_f32_16x16x32_f16 v[136:139], v[224:227], v[80:83], v[136:139]
ds_read_b128 v[236:239], v250 offset:22784
v_mfma_f32_16x16x32_f16 v[144:147], v[224:227], v[84:87], v[144:147]
s_waitcnt lgkmcnt(2)
v_mfma_f32_16x16x32_f16 v[140:143], v[228:231], v[80:83], v[140:143]
ds_read_b128 v[224:227], v250 offset:26624
v_mfma_f32_16x16x32_f16 v[148:151], v[228:231], v[84:87], v[148:151]
s_waitcnt lgkmcnt(2)
v_mfma_f32_16x16x32_f16 v[152:155], v[232:235], v[80:83], v[152:155]
ds_read_b128 v[228:231], v250 offset:26880
v_mfma_f32_16x16x32_f16 v[160:163], v[232:235], v[84:87], v[160:163]
s_waitcnt lgkmcnt(2)
v_mfma_f32_16x16x32_f16 v[156:159], v[236:239], v[80:83], v[156:159]
ds_read_b128 v[232:235], v250 offset:27648
v_mfma_f32_16x16x32_f16 v[164:167], v[236:239], v[84:87], v[164:167]
s_waitcnt lgkmcnt(2)
v_mfma_f32_16x16x32_f16 v[120:123], v[224:227], v[88:91], v[120:123]
ds_read_b128 v[236:239], v250 offset:27904
v_mfma_f32_16x16x32_f16 v[128:131], v[224:227], v[92:95], v[128:131]
s_waitcnt lgkmcnt(2)
v_mfma_f32_16x16x32_f16 v[124:127], v[228:231], v[88:91], v[124:127]
buffer_load_dwordx4 v[8:11], v252, s[4:7], s70 offen offset:64
ds_read_b128 v[224:227], v250 offset:28672
v_mfma_f32_16x16x32_f16 v[132:135], v[228:231], v[92:95], v[132:135]
s_waitcnt lgkmcnt(2)
v_mfma_f32_16x16x32_f16 v[136:139], v[232:235], v[88:91], v[136:139]
ds_read_b128 v[228:231], v250 offset:28928
v_mfma_f32_16x16x32_f16 v[144:147], v[232:235], v[92:95], v[144:147]
s_waitcnt lgkmcnt(2)
v_mfma_f32_16x16x32_f16 v[140:143], v[236:239], v[88:91], v[140:143]
ds_read_b128 v[232:235], v249 offset:55296
v_mfma_f32_16x16x32_f16 v[148:151], v[236:239], v[92:95], v[148:151]
s_waitcnt lgkmcnt(2)
v_mfma_f32_16x16x32_f16 v[152:155], v[224:227], v[88:91], v[152:155]
ds_read_b128 v[236:239], v254 offset:7936
v_mfma_f32_16x16x32_f16 v[160:163], v[224:227], v[92:95], v[160:163]
s_waitcnt lgkmcnt(2)
v_mfma_f32_16x16x32_f16 v[156:159], v[228:231], v[88:91], v[156:159]
ds_read_b128 v[224:227], v249 offset:55552
v_mfma_f32_16x16x32_f16 v[164:167], v[228:231], v[92:95], v[164:167]
s_waitcnt vmcnt(9)
v_mfma_f32_16x16x32_bf16 v[144:147], v[18:21], v[4:7], v[144:147]
ds_read_b128 v[228:231], v254 offset:7952
v_mfma_f32_16x16x32_bf16 v[148:151], v[16:19], v[4:7], v[148:151]
s_waitcnt vmcnt(8)
v_mfma_f32_16x16x32_bf16 v[160:163], v[18:21], v[0:3], v[160:163]
v_mfma_f32_16x16x32_bf16 v[164:167], v[16:19], v[0:3], v[164:167]
s_waitcnt lgkmcnt(2)
v_mfma_f32_16x16x32_f16 v[48:51], v[232:235], v[168:171], v[236:239]
buffer_load_dwordx4 v[4:7], v252, s[4:7], s70 offen offset:128
v_mfma_f32_16x16x32_f16 v[56:59], v[232:235], v[172:175], v[236:239]
s_waitcnt lgkmcnt(0)
v_mfma_f32_16x16x32_f16 v[52:55], v[224:227], v[168:171], v[228:231]
ds_read_b128 v[232:235], v249 offset:56320
ds_read_b128 v[236:239], v254 offset:8064
v_mfma_f32_16x16x32_f16 v[60:63], v[224:227], v[172:175], v[228:231]
s_waitcnt lgkmcnt(0)
v_mfma_f32_16x16x32_f16 v[64:67], v[232:235], v[168:171], v[236:239]
ds_read_b128 v[224:227], v249 offset:56576
ds_read_b128 v[228:231], v254 offset:8080
v_mfma_f32_16x16x32_f16 v[72:75], v[232:235], v[172:175], v[236:239]
v_cvt_pk_bf16_f32 v136, v136, v137
s_waitcnt lgkmcnt(0)
v_mfma_f32_16x16x32_f16 v[68:71], v[224:227], v[168:171], v[228:231]
ds_read_b128 v[232:235], v249 offset:57344
ds_read_b128 v[236:239], v254 offset:16128
v_cvt_pk_bf16_f32 v137, v138, v139
v_mfma_f32_16x16x32_f16 v[76:79], v[224:227], v[172:175], v[228:231]
v_cvt_pk_bf16_f32 v138, v140, v141
v_cvt_pk_bf16_f32 v139, v142, v143
s_waitcnt lgkmcnt(0)
v_mfma_f32_16x16x32_f16 v[80:83], v[232:235], v[168:171], v[236:239]
ds_read_b128 v[224:227], v249 offset:57600
ds_read_b128 v[228:231], v254 offset:16144
v_cvt_pk_bf16_f32 v120, v120, v121
v_mfma_f32_16x16x32_f16 v[88:91], v[232:235], v[172:175], v[236:239]
v_cvt_pk_bf16_f32 v121, v122, v123
s_waitcnt lgkmcnt(0)
v_mfma_f32_16x16x32_f16 v[84:87], v[224:227], v[168:171], v[228:231]
ds_read_b128 v[232:235], v249 offset:61440
ds_read_b128 v[236:239], v249 offset:61696
v_cvt_pk_bf16_f32 v122, v124, v125
v_mfma_f32_16x16x32_f16 v[92:95], v[224:227], v[172:175], v[228:231]
v_cvt_pk_bf16_f32 v123, v126, v127
v_cvt_pk_bf16_f32 v152, v152, v153
s_waitcnt lgkmcnt(1)
v_mfma_f32_16x16x32_f16 v[48:51], v[232:235], v[176:179], v[48:51]
ds_read_b128 v[224:227], v249 offset:62464
ds_read_b128 v[228:231], v249 offset:62720
v_cvt_pk_bf16_f32 v153, v154, v155
v_mfma_f32_16x16x32_f16 v[56:59], v[232:235], v[180:183], v[56:59]
v_cvt_pk_bf16_f32 v154, v156, v157
s_waitcnt lgkmcnt(2)
v_mfma_f32_16x16x32_f16 v[52:55], v[236:239], v[176:179], v[52:55]
ds_read_b128 v[232:235], v249 offset:63488
v_cvt_pk_bf16_f32 v155, v158, v159
s_mov_b64 vcc, s[74:75]
v_mfma_f32_16x16x32_f16 v[60:63], v[236:239], v[180:183], v[60:63]
v_cndmask_b32 v140, v120, v152, vcc
v_cndmask_b32 v141, v121, v153, vcc
s_waitcnt lgkmcnt(2)
v_mfma_f32_16x16x32_f16 v[64:67], v[224:227], v[176:179], v[64:67]
ds_read_b128 v[236:239], v249 offset:63744
v_cndmask_b32 v142, v122, v154, vcc
v_mfma_f32_16x16x32_f16 v[72:75], v[224:227], v[180:183], v[72:75]
v_cndmask_b32 v143, v123, v155, vcc
s_waitcnt lgkmcnt(2)
v_mfma_f32_16x16x32_f16 v[68:71], v[228:231], v[176:179], v[68:71]
ds_read_b128 v[224:227], v250 offset:2048
v_cndmask_b32_dpp v120, v136, v120, vcc quad_perm:[1,0,3,2] row_mask:0xf bank_mask:0xf
v_mfma_f32_16x16x32_f16 v[76:79], v[228:231], v[180:183], v[76:79]
v_cndmask_b32_dpp v121, v137, v121, vcc quad_perm:[1,0,3,2] row_mask:0xf bank_mask:0xf
v_cndmask_b32_dpp v122, v138, v122, vcc quad_perm:[1,0,3,2] row_mask:0xf bank_mask:0xf
s_waitcnt lgkmcnt(2)
v_mfma_f32_16x16x32_f16 v[80:83], v[232:235], v[176:179], v[80:83]
ds_read_b128 v[228:231], v250 offset:2304
v_cndmask_b32_dpp v123, v139, v123, vcc quad_perm:[1,0,3,2] row_mask:0xf bank_mask:0xf
s_not_b64 vcc, s[74:75]
v_mfma_f32_16x16x32_f16 v[88:91], v[232:235], v[180:183], v[88:91]
v_cndmask_b32_dpp v152, v136, v152, vcc quad_perm:[1,0,3,2] row_mask:0xf bank_mask:0xf
s_waitcnt lgkmcnt(2)
v_mfma_f32_16x16x32_f16 v[84:87], v[236:239], v[176:179], v[84:87]
ds_read_b128 v[232:235], v248 offset:16384
v_cndmask_b32_dpp v153, v137, v153, vcc quad_perm:[1,0,3,2] row_mask:0xf bank_mask:0xf
v_mfma_f32_16x16x32_f16 v[92:95], v[236:239], v[180:183], v[92:95]
v_cndmask_b32_dpp v154, v138, v154, vcc quad_perm:[1,0,3,2] row_mask:0xf bank_mask:0xf
v_cndmask_b32_dpp v155, v139, v155, vcc quad_perm:[1,0,3,2] row_mask:0xf bank_mask:0xf
s_waitcnt lgkmcnt(2)
v_mfma_f32_16x16x32_f16 v[48:51], v[224:227], v[184:187], v[48:51]
s_add_u32 s46, s70, 98304
buffer_load_dwordx4 v[0:3], v252, s[4:7], s46 offen
ds_read_b128 v[236:239], v250 offset:3072
buffer_store_dwordx4 v[120:123], v255, s[8:11], s71 offen sc1
v_mfma_f32_16x16x32_f16 v[56:59], v[224:227], v[188:191], v[56:59]
s_waitcnt lgkmcnt(2)
v_mfma_f32_16x16x32_f16 v[52:55], v[228:231], v[184:187], v[52:55]
ds_read_b128 v[224:227], v250 offset:3328
v_mfma_f32_16x16x32_f16 v[60:63], v[228:231], v[188:191], v[60:63]
s_waitcnt lgkmcnt(2)
v_mfma_f32_16x16x32_bf16 v[168:171], v[232:235], v[96:99], 0
ds_read_b128 v[228:231], v250 offset:4096
v_mfma_f32_16x16x32_bf16 v[176:179], v[232:235], v[100:103], 0
s_waitcnt lgkmcnt(2)
v_mfma_f32_16x16x32_f16 v[64:67], v[236:239], v[184:187], v[64:67]
ds_read_b128 v[232:235], v250 offset:4352
v_mfma_f32_16x16x32_f16 v[72:75], v[236:239], v[188:191], v[72:75]
s_waitcnt lgkmcnt(2)
v_mfma_f32_16x16x32_f16 v[68:71], v[224:227], v[184:187], v[68:71]
ds_read_b128 v[236:239], v248 offset:16640
v_mfma_f32_16x16x32_f16 v[76:79], v[224:227], v[188:191], v[76:79]
s_waitcnt lgkmcnt(2)
v_mfma_f32_16x16x32_f16 v[80:83], v[228:231], v[184:187], v[80:83]
ds_read_b128 v[224:227], v250 offset:8192
v_mfma_f32_16x16x32_f16 v[88:91], v[228:231], v[188:191], v[88:91]
s_waitcnt lgkmcnt(2)
v_mfma_f32_16x16x32_f16 v[84:87], v[232:235], v[184:187], v[84:87]
ds_read_b128 v[228:231], v250 offset:8448
v_mfma_f32_16x16x32_f16 v[92:95], v[232:235], v[188:191], v[92:95]
s_waitcnt lgkmcnt(2)
v_mfma_f32_16x16x32_bf16 v[172:175], v[236:239], v[96:99], 0
ds_read_b128 v[232:235], v250 offset:9216
v_mfma_f32_16x16x32_bf16 v[180:183], v[236:239], v[100:103], 0
s_waitcnt lgkmcnt(2)
v_mfma_f32_16x16x32_f16 v[48:51], v[224:227], v[192:195], v[48:51]
buffer_store_dwordx4 v[140:143], v255, s[8:11], s71 offen offset:128 sc1
ds_read_b128 v[236:239], v250 offset:9472
v_mfma_f32_16x16x32_f16 v[56:59], v[224:227], v[196:199], v[56:59]
s_waitcnt lgkmcnt(2)
v_mfma_f32_16x16x32_f16 v[52:55], v[228:231], v[192:195], v[52:55]
ds_read_b128 v[224:227], v248 offset:17408
v_mfma_f32_16x16x32_f16 v[60:63], v[228:231], v[196:199], v[60:63]
s_waitcnt lgkmcnt(2)
v_mfma_f32_16x16x32_f16 v[64:67], v[232:235], v[192:195], v[64:67]
ds_read_b128 v[228:231], v250 offset:10240
v_mfma_f32_16x16x32_f16 v[72:75], v[232:235], v[196:199], v[72:75]
s_waitcnt lgkmcnt(2)
v_mfma_f32_16x16x32_f16 v[68:71], v[236:239], v[192:195], v[68:71]
ds_read_b128 v[232:235], v250 offset:10496
v_mfma_f32_16x16x32_f16 v[76:79], v[236:239], v[196:199], v[76:79]
s_waitcnt lgkmcnt(2)
v_mfma_f32_16x16x32_bf16 v[168:171], v[224:227], v[104:107], v[168:171]
ds_read_b128 v[236:239], v250 offset:14336
v_mfma_f32_16x16x32_bf16 v[176:179], v[224:227], v[108:111], v[176:179]
s_waitcnt lgkmcnt(2)
v_mfma_f32_16x16x32_f16 v[80:83], v[228:231], v[192:195], v[80:83]
ds_read_b128 v[224:227], v250 offset:14592
v_mfma_f32_16x16x32_f16 v[88:91], v[228:231], v[196:199], v[88:91]
s_waitcnt lgkmcnt(2)
v_mfma_f32_16x16x32_f16 v[84:87], v[232:235], v[192:195], v[84:87]
ds_read_b128 v[228:231], v248 offset:17664
v_mfma_f32_16x16x32_f16 v[92:95], v[232:235], v[196:199], v[92:95]
s_waitcnt lgkmcnt(2)
v_mfma_f32_16x16x32_f16 v[48:51], v[236:239], v[200:203], v[48:51]
s_add_u32 s46, s70, 98304
buffer_load_dwordx4 v[244:247], v252, s[4:7], s46 offen offset:64
ds_read_b128 v[232:235], v250 offset:15360
v_mfma_f32_16x16x32_f16 v[56:59], v[236:239], v[204:207], v[56:59]
s_waitcnt lgkmcnt(2)
v_mfma_f32_16x16x32_f16 v[52:55], v[224:227], v[200:203], v[52:55]
ds_read_b128 v[236:239], v250 offset:15616
v_mfma_f32_16x16x32_f16 v[60:63], v[224:227], v[204:207], v[60:63]
s_waitcnt lgkmcnt(2)
v_mfma_f32_16x16x32_bf16 v[172:175], v[228:231], v[104:107], v[172:175]
ds_read_b128 v[224:227], v250 offset:16384
v_mfma_f32_16x16x32_bf16 v[180:183], v[228:231], v[108:111], v[180:183]
s_waitcnt lgkmcnt(2)
v_mfma_f32_16x16x32_f16 v[64:67], v[232:235], v[200:203], v[64:67]
ds_read_b128 v[228:231], v250 offset:16640
v_mfma_f32_16x16x32_f16 v[72:75], v[232:235], v[204:207], v[72:75]
s_waitcnt lgkmcnt(2)
v_mfma_f32_16x16x32_f16 v[68:71], v[236:239], v[200:203], v[68:71]
ds_read_b128 v[232:235], v248 offset:18432
v_mfma_f32_16x16x32_f16 v[76:79], v[236:239], v[204:207], v[76:79]
s_waitcnt lgkmcnt(2)
v_mfma_f32_16x16x32_f16 v[80:83], v[224:227], v[200:203], v[80:83]
ds_read_b128 v[236:239], v250 offset:20480
v_mfma_f32_16x16x32_f16 v[88:91], v[224:227], v[204:207], v[88:91]
s_waitcnt lgkmcnt(2)
v_mfma_f32_16x16x32_f16 v[84:87], v[228:231], v[200:203], v[84:87]
ds_read_b128 v[224:227], v250 offset:20736
v_mfma_f32_16x16x32_f16 v[92:95], v[228:231], v[204:207], v[92:95]
s_waitcnt lgkmcnt(2)
v_mfma_f32_16x16x32_bf16 v[168:171], v[232:235], v[112:115], v[168:171]
ds_read_b128 v[228:231], v250 offset:21504
v_mfma_f32_16x16x32_bf16 v[176:179], v[232:235], v[116:119], v[176:179]
s_waitcnt lgkmcnt(2)
v_mfma_f32_16x16x32_f16 v[48:51], v[236:239], v[208:211], v[48:51]
ds_read_b128 v[232:235], v250 offset:21760
v_mfma_f32_16x16x32_f16 v[56:59], v[236:239], v[212:215], v[56:59]
s_waitcnt lgkmcnt(2)
v_mfma_f32_16x16x32_f16 v[52:55], v[224:227], v[208:211], v[52:55]
ds_read_b128 v[236:239], v248 offset:18688
v_mfma_f32_16x16x32_f16 v[60:63], v[224:227], v[212:215], v[60:63]
s_waitcnt lgkmcnt(2)
v_mfma_f32_16x16x32_f16 v[64:67], v[228:231], v[208:211], v[64:67]
ds_read_b128 v[224:227], v250 offset:22528
v_mfma_f32_16x16x32_f16 v[72:75], v[228:231], v[212:215], v[72:75]
s_waitcnt lgkmcnt(2)
v_mfma_f32_16x16x32_f16 v[68:71], v[232:235], v[208:211], v[68:71]
ds_read_b128 v[228:231], v250 offset:22784
v_mfma_f32_16x16x32_f16 v[76:79], v[232:235], v[212:215], v[76:79]
s_waitcnt lgkmcnt(2)
v_mfma_f32_16x16x32_bf16 v[172:175], v[236:239], v[112:115], v[172:175]
ds_read_b128 v[232:235], v250 offset:26624
v_mfma_f32_16x16x32_bf16 v[180:183], v[236:239], v[116:119], v[180:183]
s_waitcnt lgkmcnt(2)
v_mfma_f32_16x16x32_f16 v[80:83], v[224:227], v[208:211], v[80:83]
ds_read_b128 v[236:239], v250 offset:26880
v_mfma_f32_16x16x32_f16 v[88:91], v[224:227], v[212:215], v[88:91]
s_waitcnt lgkmcnt(2)
v_mfma_f32_16x16x32_f16 v[84:87], v[228:231], v[208:211], v[84:87]
ds_read_b128 v[224:227], v248 offset:22528
v_mfma_f32_16x16x32_f16 v[92:95], v[228:231], v[212:215], v[92:95]
s_setprio 3
s_waitcnt lgkmcnt(2)
v_mfma_f32_16x16x32_f16 v[48:51], v[232:235], v[216:219], v[48:51]
s_add_u32 s46, s70, 98304
buffer_load_dwordx4 v[204:207], v252, s[4:7], s46 offen offset:128
ds_read_b128 v[228:231], v250 offset:27648
v_cvt_pkrtz_f16_f32 v185, v168, v169
v_cvt_pkrtz_f16_f32 v187, v170, v171
v_mfma_f32_16x16x32_f16 v[56:59], v[232:235], v[220:223], v[56:59]
v_cvt_pkrtz_f16_f32 v189, v172, v173
v_cvt_pkrtz_f16_f32 v191, v174, v175
s_waitcnt lgkmcnt(2)
v_mfma_f32_16x16x32_f16 v[52:55], v[236:239], v[216:219], v[52:55]
ds_read_b128 v[232:235], v248 offset:22784
v_cvt_pkrtz_f16_f32 v193, v176, v177
v_cvt_pk_f16_f32 v203, v178, v179
v_cvt_pk_f16_f32 v200, v180, v181
v_mfma_f32_16x16x32_f16 v[60:63], v[236:239], v[220:223], v[60:63]
v_cvt_pk_f16_f32 v197, v182, v183
v_pk_fma_f16 v202, v203, v203, s48
s_waitcnt lgkmcnt(2)
v_mfma_f32_16x16x32_bf16 v[168:171], v[224:227], v[96:99], 0
ds_read_b128 v[236:239], v250 offset:27904
v_and_b32_e64 v185, s49, v185
v_pk_fma_f16 v199, v200, v200, s48
v_mfma_f32_16x16x32_bf16 v[176:179], v[224:227], v[100:103], 0
v_and_b32 v187, s49, v187
v_pk_fma_f16 v196, v197, v197, s48
v_bfe_u32 v184, v185, 2, 14
s_waitcnt lgkmcnt(2)
v_mfma_f32_16x16x32_f16 v[64:67], v[228:231], v[216:219], v[64:67]
ds_read_b128 v[224:227], v248 offset:23552
ds_read_u16_d16 v184, v184
v_pk_mul_f16 v202, v203, v202
v_bfe_u32 v186, v187, 2, 14
v_mfma_f32_16x16x32_f16 v[72:75], v[228:231], v[220:223], v[72:75]
v_pk_mul_f16 v199, v200, v199
v_lshrrev_b32 v185, 18, v185
s_waitcnt lgkmcnt(3)
v_mfma_f32_16x16x32_bf16 v[172:175], v[232:235], v[96:99], 0
ds_read_b128 v[228:231], v250 offset:28672
ds_read_u16_d16 v186, v186
ds_read_u16_d16_hi v185, v185
v_pk_mul_f16 v196, v197, v196
v_lshrrev_b32_e64 v187, 18, v187
v_mfma_f32_16x16x32_bf16 v[180:183], v[232:235], v[100:103], 0
v_exp_f16_e64 v201, v202
v_and_b32 v189, s49, v189
s_waitcnt lgkmcnt(5)
v_mfma_f32_16x16x32_f16 v[68:71], v[236:239], v[216:219], v[68:71]
ds_read_b128 v[232:235], v250 offset:28928
ds_read_u16_d16_hi v187, v187
v_and_b32_e64 v191, s49, v191
v_mfma_f32_16x16x32_f16 v[76:79], v[236:239], v[220:223], v[76:79]
v_exp_f16 v198, v199
v_bfe_u32 v188, v189, 2, 14
v_bfe_u32 v190, v191, 2, 14
s_waitcnt lgkmcnt(5)
v_mfma_f32_16x16x32_bf16 v[168:171], v[224:227], v[104:107], v[168:171]
buffer_store_dwordx4 v[152:155], v255, s[8:11], s71 offen offset:256 sc1
ds_read_b128 v[236:239], v248 offset:23808
ds_read_u16_d16 v188, v188
ds_read_u16_d16 v190, v190
v_exp_f16_e64 v195, v196
v_mfma_f32_16x16x32_bf16 v[176:179], v[224:227], v[108:111], v[176:179]
v_lshrrev_b32_e64 v189, 18, v189
v_lshrrev_b32 v191, 18, v191
s_waitcnt lgkmcnt(5)
v_mfma_f32_16x16x32_f16 v[80:83], v[228:231], v[216:219], v[80:83]
ds_read_b128 v[224:227], v248 offset:24576
ds_read_u16_d16_hi v189, v189
ds_read_u16_d16_hi v191, v191
v_exp_f16_sdwa v201, v202 dst_sel:WORD_1 dst_unused:UNUSED_PRESERVE src0_sel:WORD_1
v_and_b32 v193, s49, v193
v_mfma_f32_16x16x32_f16 v[88:91], v[228:231], v[220:223], v[88:91]
v_bfe_u32 v192, v193, 2, 14
s_waitcnt lgkmcnt(6)
v_mfma_f32_16x16x32_f16 v[84:87], v[232:235], v[216:219], v[84:87]
ds_read_b128 v[228:231], v248 offset:24832
ds_read_u16_d16 v192, v192
v_exp_f16_sdwa v198, v199 dst_sel:WORD_1 dst_unused:UNUSED_PRESERVE src0_sel:WORD_1
v_lshrrev_b32 v193, 18, v193
v_mfma_f32_16x16x32_f16 v[92:95], v[232:235], v[220:223], v[92:95]
v_exp_f16_sdwa v195, v196 dst_sel:WORD_1 dst_unused:UNUSED_PRESERVE src0_sel:WORD_1
v_pk_add_f16 v201, v201, 1.0 op_sel_hi:[1,0]
s_waitcnt lgkmcnt(7)
v_mfma_f32_16x16x32_bf16 v[172:175], v[236:239], v[104:107], v[172:175]
ds_read_u16_d16_hi v193, v193
v_pk_add_f16 v198, v198, 1.0 op_sel_hi:[1,0]
v_pk_add_f16 v195, v195, 1.0 op_sel_hi:[1,0]
v_mfma_f32_16x16x32_bf16 v[180:183], v[236:239], v[108:111], v[180:183]
v_rcp_f16 v202, v201
s_waitcnt lgkmcnt(5)
v_mfma_f32_16x16x32_bf16 v[168:171], v[224:227], v[112:115], v[168:171]
v_rcp_f16_e64 v199, v198
v_mfma_f32_16x16x32_bf16 v[176:179], v[224:227], v[116:119], v[176:179]
v_rcp_f16 v196, v195
s_waitcnt lgkmcnt(2)
v_mfma_f32_16x16x32_bf16 v[172:175], v[228:231], v[112:115], v[172:175]
ds_read_b128 v[224:227], v249 offset:24576
v_rcp_f16_sdwa v202, v201 dst_sel:WORD_1 dst_unused:UNUSED_PRESERVE src0_sel:WORD_1
v_mfma_f32_16x16x32_bf16 v[180:183], v[228:231], v[116:119], v[180:183]
v_rcp_f16_sdwa v199, v198 dst_sel:WORD_1 dst_unused:UNUSED_PRESERVE src0_sel:WORD_1
v_or_b32 v208, v184, v185
v_or_b32 v209, v186, v187
v_or_b32_e64 v210, v188, v189
v_rcp_f16_sdwa v196, v195 dst_sel:WORD_1 dst_unused:UNUSED_PRESERVE src0_sel:WORD_1
v_or_b32 v211, v190, v191
s_waitcnt lgkmcnt(1)
v_or_b32 v212, v192, v193
v_pk_mul_f16 v213, v203, v202
v_pk_mul_f16 v214, v200, v199
v_pk_mul_f16 v215, v197, v196
s_waitcnt lgkmcnt(0)
v_mfma_f32_16x16x32_f16 v[48:51], v[224:227], v[208:211], v[48:51]
ds_read_b128 v[228:231], v249 offset:24832
ds_read_b128 v[232:235], v248 offset:28672
ds_read_b128 v[236:239], v249 offset:25600
ds_read_b128 v[216:219], v248 offset:28928
ds_read_b128 v[220:223], v249 offset:25856
v_cvt_pkrtz_f16_f32 v185, v168, v169
v_cvt_pkrtz_f16_f32 v187, v170, v171
v_cvt_pkrtz_f16_f32 v189, v172, v173
v_mfma_f32_16x16x32_f16 v[56:59], v[224:227], v[212:215], v[56:59]
v_cvt_pkrtz_f16_f32 v191, v174, v175
v_cvt_pkrtz_f16_f32 v193, v176, v177
v_cvt_pk_f16_f32 v203, v178, v179
s_waitcnt lgkmcnt(4)
v_mfma_f32_16x16x32_f16 v[52:55], v[228:231], v[208:211], v[52:55]
ds_read_b128 v[224:227], v248 offset:29696
v_cvt_pk_f16_f32 v200, v180, v181
v_cvt_pk_f16_f32 v197, v182, v183
v_pk_fma_f16 v202, v203, v203, s48
v_cvt_pk_bf16_f32 v144, v144, v145
v_mfma_f32_16x16x32_f16 v[60:63], v[228:231], v[212:215], v[60:63]
v_and_b32 v185, s49, v185
v_cvt_pk_bf16_f32 v145, v146, v147
v_pk_fma_f16 v199, v200, v200, s48
s_waitcnt lgkmcnt(4)
v_mfma_f32_16x16x32_bf16 v[168:171], v[232:235], v[96:99], 0
ds_read_b128 v[228:231], v249 offset:26624
v_and_b32 v187, s49, v187
v_cvt_pk_bf16_f32 v146, v148, v149
v_pk_fma_f16 v196, v197, v197, s48
v_mfma_f32_16x16x32_bf16 v[176:179], v[232:235], v[100:103], 0
v_cvt_pk_bf16_f32 v147, v150, v151
v_bfe_u32 v184, v185, 2, 14
s_setprio 2
v_pk_mul_f16 v202, v203, v202
v_cvt_pk_bf16_f32 v128, v128, v129
s_waitcnt lgkmcnt(2)
v_mfma_f32_16x16x32_f16 v[64:67], v[236:239], v[208:211], v[64:67]
ds_read_b128 v[232:235], v249 offset:26880
ds_read_u16_d16 v184, v184
v_bfe_u32 v186, v187, 2, 14
v_cvt_pk_bf16_f32 v129, v130, v131
v_pk_mul_f16 v199, v200, v199
v_mfma_f32_16x16x32_f16 v[72:75], v[236:239], v[212:215], v[72:75]
v_lshrrev_b32_e64 v185, 18, v185
v_cvt_pk_bf16_f32 v130, v132, v133
v_pk_mul_f16 v196, v197, v196
v_mfma_f32_16x16x32_bf16 v[172:175], v[216:219], v[96:99], 0
ds_read_b128 v[236:239], v248 offset:29952
ds_read_u16_d16 v186, v186
ds_read_u16_d16_hi v185, v185
v_lshrrev_b32_e64 v187, 18, v187
v_cvt_pk_bf16_f32 v131, v134, v135
v_exp_f16_e64 v201, v202
v_mfma_f32_16x16x32_bf16 v[180:183], v[216:219], v[100:103], 0
v_cvt_pk_bf16_f32 v160, v160, v161
v_and_b32_e64 v189, s49, v189
v_cvt_pk_bf16_f32 v161, v162, v163
v_mfma_f32_16x16x32_f16 v[68:71], v[220:223], v[208:211], v[68:71]
ds_read_b128 v[216:219], v248 offset:30720
ds_read_u16_d16_hi v187, v187
v_and_b32_e64 v191, s49, v191
v_cvt_pk_bf16_f32 v162, v164, v165
v_mfma_f32_16x16x32_f16 v[76:79], v[220:223], v[212:215], v[76:79]
v_exp_f16_e64 v198, v199
v_cvt_pk_bf16_f32 v163, v166, v167
s_mov_b64 vcc, s[74:75]
v_bfe_u32 v188, v189, 2, 14
v_bfe_u32 v190, v191, 2, 14
s_waitcnt lgkmcnt(5)
v_mfma_f32_16x16x32_bf16 v[168:171], v[224:227], v[104:107], v[168:171]
ds_read_b128 v[220:223], v248 offset:30976
ds_read_u16_d16 v188, v188
ds_read_u16_d16 v190, v190
v_cndmask_b32 v148, v128, v160, vcc
v_exp_f16 v195, v196
v_mfma_f32_16x16x32_bf16 v[176:179], v[224:227], v[108:111], v[176:179]
v_cndmask_b32 v149, v129, v161, vcc
v_lshrrev_b32_e64 v189, 18, v189
v_cndmask_b32 v150, v130, v162, vcc
v_mfma_f32_16x16x32_f16 v[80:83], v[228:231], v[208:211], v[80:83]
ds_read_b128 v[224:227], v249 offset:30720
ds_read_u16_d16_hi v189, v189
v_lshrrev_b32 v191, 18, v191
v_cndmask_b32 v151, v131, v163, vcc
v_exp_f16_sdwa v201, v202 dst_sel:WORD_1 dst_unused:UNUSED_PRESERVE src0_sel:WORD_1
v_mfma_f32_16x16x32_f16 v[88:91], v[228:231], v[212:215], v[88:91]
v_cndmask_b32_dpp v128, v144, v128, vcc quad_perm:[1,0,3,2] row_mask:0xf bank_mask:0xf
v_and_b32_e64 v193, s49, v193
v_cndmask_b32_dpp v129, v145, v129, vcc quad_perm:[1,0,3,2] row_mask:0xf bank_mask:0xf
v_mfma_f32_16x16x32_f16 v[84:87], v[232:235], v[208:211], v[84:87]
ds_read_b128 v[228:231], v249 offset:30976
ds_read_u16_d16_hi v191, v191
v_bfe_u32 v192, v193, 2, 14
v_exp_f16_sdwa v198, v199 dst_sel:WORD_1 dst_unused:UNUSED_PRESERVE src0_sel:WORD_1
v_mfma_f32_16x16x32_f16 v[92:95], v[232:235], v[212:215], v[92:95]
v_cndmask_b32_dpp v130, v146, v130, vcc quad_perm:[1,0,3,2] row_mask:0xf bank_mask:0xf
v_lshrrev_b32_e64 v193, 18, v193
v_cndmask_b32_dpp v131, v147, v131, vcc quad_perm:[1,0,3,2] row_mask:0xf bank_mask:0xf
s_not_b64 vcc, s[74:75]
s_waitcnt lgkmcnt(4)
v_mfma_f32_16x16x32_bf16 v[172:175], v[236:239], v[104:107], v[172:175]
ds_read_b128 v[232:235], v248 offset:34816
ds_read_u16_d16 v192, v192
ds_read_u16_d16_hi v193, v193
v_exp_f16_sdwa v195, v196 dst_sel:WORD_1 dst_unused:UNUSED_PRESERVE src0_sel:WORD_1
v_cndmask_b32_dpp v160, v144, v160, vcc quad_perm:[1,0,3,2] row_mask:0xf bank_mask:0xf
v_pk_add_f16 v201, v201, 1.0 op_sel_hi:[1,0]
v_mfma_f32_16x16x32_bf16 v[180:183], v[236:239], v[108:111], v[180:183]
v_cndmask_b32_dpp v161, v145, v161, vcc quad_perm:[1,0,3,2] row_mask:0xf bank_mask:0xf
v_pk_add_f16 v198, v198, 1.0 op_sel_hi:[1,0]
v_cndmask_b32_dpp v162, v146, v162, vcc quad_perm:[1,0,3,2] row_mask:0xf bank_mask:0xf
v_mfma_f32_16x16x32_bf16 v[168:171], v[216:219], v[112:115], v[168:171]
ds_read_b128 v[236:239], v249 offset:31744
v_pk_add_f16 v195, v195, 1.0 op_sel_hi:[1,0]
v_rcp_f16_e64 v202, v201
v_cndmask_b32_dpp v163, v147, v163, vcc quad_perm:[1,0,3,2] row_mask:0xf bank_mask:0xf
v_mfma_f32_16x16x32_bf16 v[176:179], v[216:219], v[116:119], v[176:179]
v_rcp_f16_e64 v199, v198
v_mfma_f32_16x16x32_bf16 v[172:175], v[220:223], v[112:115], v[172:175]
ds_read_b128 v[216:219], v248 offset:35072
s_add_u32 s46, s71, 98304
buffer_store_dwordx4 v[128:131], v255, s[8:11], s46 offen sc1
v_rcp_f16_e64 v196, v195
v_rcp_f16_sdwa v202, v201 dst_sel:WORD_1 dst_unused:UNUSED_PRESERVE src0_sel:WORD_1
v_mfma_f32_16x16x32_bf16 v[180:183], v[220:223], v[116:119], v[180:183]
v_rcp_f16_sdwa v199, v198 dst_sel:WORD_1 dst_unused:UNUSED_PRESERVE src0_sel:WORD_1
v_or_b32 v208, v184, v185
v_or_b32 v209, v186, v187
s_waitcnt lgkmcnt(2)
v_or_b32 v210, v188, v189
v_rcp_f16_sdwa v196, v195 dst_sel:WORD_1 dst_unused:UNUSED_PRESERVE src0_sel:WORD_1
v_or_b32 v211, v190, v191
v_or_b32 v212, v192, v193
v_pk_mul_f16 v213, v203, v202
v_pk_mul_f16 v214, v200, v199
v_pk_mul_f16 v215, v197, v196
v_mfma_f32_16x16x32_f16 v[48:51], v[224:227], v[208:211], v[48:51]
ds_read_b128 v[220:223], v249 offset:32000
v_cvt_pkrtz_f16_f32 v185, v168, v169
v_cvt_pkrtz_f16_f32 v187, v170, v171
v_mfma_f32_16x16x32_f16 v[56:59], v[224:227], v[212:215], v[56:59]
v_cvt_pkrtz_f16_f32 v189, v172, v173
v_cvt_pkrtz_f16_f32 v191, v174, v175
v_mfma_f32_16x16x32_f16 v[52:55], v[228:231], v[208:211], v[52:55]
ds_read_b128 v[224:227], v248 offset:35840
v_cvt_pkrtz_f16_f32 v193, v176, v177
v_cvt_pk_f16_f32 v203, v178, v179
v_mfma_f32_16x16x32_f16 v[60:63], v[228:231], v[212:215], v[60:63]
v_cvt_pk_f16_f32 v200, v180, v181
v_cvt_pk_f16_f32 v197, v182, v183
s_setprio 1
v_mfma_f32_16x16x32_bf16 v[168:171], v[232:235], v[96:99], 0
ds_read_b128 v[228:231], v249 offset:32768
v_pk_fma_f16 v202, v203, v203, s48
v_and_b32 v185, s49, v185
v_mfma_f32_16x16x32_bf16 v[176:179], v[232:235], v[100:103], 0
v_pk_fma_f16 v199, v200, v200, s48
v_and_b32 v187, s49, v187
s_waitcnt lgkmcnt(3)
v_mfma_f32_16x16x32_f16 v[64:67], v[236:239], v[208:211], v[64:67]
ds_read_b128 v[232:235], v249 offset:33024
v_pk_fma_f16 v196, v197, v197, s48
v_bfe_u32 v184, v185, 2, 14
v_pk_mul_f16 v202, v203, v202
v_mfma_f32_16x16x32_f16 v[72:75], v[236:239], v[212:215], v[72:75]
v_bfe_u32 v186, v187, 2, 14
v_pk_mul_f16 v199, v200, v199
s_waitcnt vmcnt(9)
v_mfma_f32_16x16x32_bf16 v[48:51], v[18:21], v[12:15], v[48:51]
ds_read_b128 v[236:239], v248 offset:36096
ds_read_u16_d16 v184, v184
ds_read_u16_d16 v186, v186
v_lshrrev_b32 v185, 18, v185
v_pk_mul_f16 v196, v197, v196
v_mfma_f32_16x16x32_bf16 v[52:55], v[16:19], v[12:15], v[52:55]
v_lshrrev_b32_e64 v187, 18, v187
v_mfma_f32_16x16x32_bf16 v[172:175], v[216:219], v[96:99], 0
ds_read_u16_d16_hi v185, v185
ds_read_u16_d16_hi v187, v187
v_exp_f16 v201, v202
v_and_b32 v189, s49, v189
v_mfma_f32_16x16x32_bf16 v[180:183], v[216:219], v[100:103], 0
v_and_b32 v191, s49, v191
s_waitcnt lgkmcnt(6)
v_mfma_f32_16x16x32_f16 v[68:71], v[220:223], v[208:211], v[68:71]
ds_read_b128 v[216:219], v248 offset:36864
v_exp_f16_e64 v198, v199
v_bfe_u32 v188, v189, 2, 14
v_mfma_f32_16x16x32_f16 v[76:79], v[220:223], v[212:215], v[76:79]
v_bfe_u32 v190, v191, 2, 14
v_exp_f16_e64 v195, v196
v_mfma_f32_16x16x32_bf16 v[168:171], v[224:227], v[104:107], v[168:171]
ds_read_b128 v[220:223], v248 offset:37120
ds_read_u16_d16 v188, v188
ds_read_u16_d16 v190, v190
v_lshrrev_b32 v189, 18, v189
v_lshrrev_b32 v191, 18, v191
v_mfma_f32_16x16x32_bf16 v[176:179], v[224:227], v[108:111], v[176:179]
v_exp_f16_sdwa v201, v202 dst_sel:WORD_1 dst_unused:UNUSED_PRESERVE src0_sel:WORD_1
v_mfma_f32_16x16x32_f16 v[80:83], v[228:231], v[208:211], v[80:83]
ds_read_b128 v[224:227], v249 offset:36864
ds_read_u16_d16_hi v189, v189
ds_read_u16_d16_hi v191, v191
v_and_b32 v193, s49, v193
v_bfe_u32 v192, v193, 2, 14
v_mfma_f32_16x16x32_f16 v[88:91], v[228:231], v[212:215], v[88:91]
v_exp_f16_sdwa v198, v199 dst_sel:WORD_1 dst_unused:UNUSED_PRESERVE src0_sel:WORD_1
s_waitcnt lgkmcnt(7)
v_mfma_f32_16x16x32_f16 v[84:87], v[232:235], v[208:211], v[84:87]
ds_read_b128 v[228:231], v249 offset:37120
ds_read_u16_d16 v192, v192
v_lshrrev_b32_e64 v193, 18, v193
v_mfma_f32_16x16x32_f16 v[92:95], v[232:235], v[212:215], v[92:95]
v_exp_f16_sdwa v195, v196 dst_sel:WORD_1 dst_unused:UNUSED_PRESERVE src0_sel:WORD_1
v_pk_add_f16 v201, v201, 1.0 op_sel_hi:[1,0]
v_pk_add_f16 v198, v198, 1.0 op_sel_hi:[1,0]
v_mfma_f32_16x16x32_bf16 v[172:175], v[236:239], v[104:107], v[172:175]
ds_read_b128 v[232:235], v248 offset:40960
ds_read_u16_d16_hi v193, v193
v_pk_add_f16 v195, v195, 1.0 op_sel_hi:[1,0]
v_mfma_f32_16x16x32_bf16 v[180:183], v[236:239], v[108:111], v[180:183]
v_rcp_f16_e64 v202, v201
s_setprio 0
s_waitcnt lgkmcnt(7)
v_mfma_f32_16x16x32_bf16 v[168:171], v[216:219], v[112:115], v[168:171]
ds_read_b128 v[236:239], v249 offset:37888
v_rcp_f16_e64 v199, v198
v_mfma_f32_16x16x32_bf16 v[176:179], v[216:219], v[116:119], v[176:179]
v_rcp_f16_e64 v196, v195
v_mfma_f32_16x16x32_bf16 v[172:175], v[220:223], v[112:115], v[172:175]
ds_read_b128 v[216:219], v248 offset:41216
v_rcp_f16_sdwa v202, v201 dst_sel:WORD_1 dst_unused:UNUSED_PRESERVE src0_sel:WORD_1
v_mfma_f32_16x16x32_bf16 v[180:183], v[220:223], v[116:119], v[180:183]
v_rcp_f16_sdwa v199, v198 dst_sel:WORD_1 dst_unused:UNUSED_PRESERVE src0_sel:WORD_1
v_or_b32 v208, v184, v185
v_or_b32 v209, v186, v187
s_waitcnt lgkmcnt(4)
v_or_b32 v210, v188, v189
v_rcp_f16_sdwa v196, v195 dst_sel:WORD_1 dst_unused:UNUSED_PRESERVE src0_sel:WORD_1
v_or_b32 v211, v190, v191
s_waitcnt lgkmcnt(2)
v_or_b32 v212, v192, v193
v_pk_mul_f16 v213, v203, v202
v_pk_mul_f16 v214, v200, v199
v_pk_mul_f16 v215, v197, v196
s_setprio 3
v_mfma_f32_16x16x32_f16 v[48:51], v[224:227], v[208:211], v[48:51]
s_add_u32 s46, s71, 98304
buffer_store_dwordx4 v[148:151], v255, s[8:11], s46 offen offset:128 sc1
ds_read_b128 v[220:223], v249 offset:38144
v_cvt_pkrtz_f16_f32 v185, v168, v169
v_cvt_pkrtz_f16_f32 v187, v170, v171
v_mfma_f32_16x16x32_f16 v[56:59], v[224:227], v[212:215], v[56:59]
v_cvt_pkrtz_f16_f32 v189, v172, v173
v_cvt_pkrtz_f16_f32 v191, v174, v175
v_mfma_f32_16x16x32_f16 v[52:55], v[228:231], v[208:211], v[52:55]
ds_read_b128 v[224:227], v248 offset:41984
v_cvt_pkrtz_f16_f32 v193, v176, v177
v_cvt_pk_f16_f32 v203, v178, v179
v_mfma_f32_16x16x32_f16 v[60:63], v[228:231], v[212:215], v[60:63]
v_cvt_pk_f16_f32 v200, v180, v181
v_cvt_pk_f16_f32 v197, v182, v183
v_mfma_f32_16x16x32_bf16 v[168:171], v[232:235], v[96:99], 0
ds_read_b128 v[228:231], v249 offset:38912
v_pk_fma_f16 v202, v203, v203, s48
v_and_b32_e64 v185, s49, v185
v_mfma_f32_16x16x32_bf16 v[176:179], v[232:235], v[100:103], 0
v_pk_fma_f16 v199, v200, v200, s48
v_and_b32 v187, s49, v187
s_waitcnt lgkmcnt(3)
v_mfma_f32_16x16x32_f16 v[64:67], v[236:239], v[208:211], v[64:67]
ds_read_b128 v[232:235], v249 offset:39168
v_pk_fma_f16 v196, v197, v197, s48
v_bfe_u32 v184, v185, 2, 14
v_pk_mul_f16 v202, v203, v202
v_mfma_f32_16x16x32_f16 v[72:75], v[236:239], v[212:215], v[72:75]
v_bfe_u32 v186, v187, 2, 14
v_pk_mul_f16 v199, v200, v199
s_waitcnt vmcnt(9)
v_mfma_f32_16x16x32_bf16 v[64:67], v[18:21], v[8:11], v[64:67]
ds_read_b128 v[236:239], v248 offset:42240
ds_read_u16_d16 v184, v184
ds_read_u16_d16 v186, v186
v_lshrrev_b32 v185, 18, v185
v_pk_mul_f16 v196, v197, v196
v_mfma_f32_16x16x32_bf16 v[68:71], v[16:19], v[8:11], v[68:71]
v_lshrrev_b32_e64 v187, 18, v187
v_mfma_f32_16x16x32_bf16 v[172:175], v[216:219], v[96:99], 0
ds_read_u16_d16_hi v185, v185
ds_read_u16_d16_hi v187, v187
v_exp_f16 v201, v202
v_and_b32 v189, s49, v189
v_mfma_f32_16x16x32_bf16 v[180:183], v[216:219], v[100:103], 0
v_and_b32 v191, s49, v191
s_waitcnt lgkmcnt(6)
v_mfma_f32_16x16x32_f16 v[68:71], v[220:223], v[208:211], v[68:71]
ds_read_b128 v[216:219], v248 offset:43008
v_exp_f16_e64 v198, v199
v_bfe_u32 v188, v189, 2, 14
v_mfma_f32_16x16x32_f16 v[76:79], v[220:223], v[212:215], v[76:79]
v_bfe_u32 v190, v191, 2, 14
v_exp_f16_e64 v195, v196
v_mfma_f32_16x16x32_bf16 v[168:171], v[224:227], v[104:107], v[168:171]
ds_read_b128 v[220:223], v248 offset:43264
ds_read_u16_d16 v188, v188
ds_read_u16_d16 v190, v190
v_lshrrev_b32 v189, 18, v189
v_lshrrev_b32 v191, 18, v191
v_mfma_f32_16x16x32_bf16 v[176:179], v[224:227], v[108:111], v[176:179]
v_exp_f16_sdwa v201, v202 dst_sel:WORD_1 dst_unused:UNUSED_PRESERVE src0_sel:WORD_1
v_mfma_f32_16x16x32_f16 v[80:83], v[228:231], v[208:211], v[80:83]
ds_read_b128 v[224:227], v249 offset:43008
ds_read_u16_d16_hi v189, v189
ds_read_u16_d16_hi v191, v191
v_and_b32 v193, s49, v193
v_bfe_u32 v192, v193, 2, 14
v_mfma_f32_16x16x32_f16 v[88:91], v[228:231], v[212:215], v[88:91]
v_exp_f16_sdwa v198, v199 dst_sel:WORD_1 dst_unused:UNUSED_PRESERVE src0_sel:WORD_1
s_waitcnt lgkmcnt(7)
v_mfma_f32_16x16x32_f16 v[84:87], v[232:235], v[208:211], v[84:87]
ds_read_b128 v[228:231], v249 offset:43264
ds_read_u16_d16 v192, v192
v_lshrrev_b32_e64 v193, 18, v193
v_mfma_f32_16x16x32_f16 v[92:95], v[232:235], v[212:215], v[92:95]
v_exp_f16_sdwa v195, v196 dst_sel:WORD_1 dst_unused:UNUSED_PRESERVE src0_sel:WORD_1
v_pk_add_f16 v201, v201, 1.0 op_sel_hi:[1,0]
v_pk_add_f16 v198, v198, 1.0 op_sel_hi:[1,0]
v_mfma_f32_16x16x32_bf16 v[172:175], v[236:239], v[104:107], v[172:175]
ds_read_b128 v[232:235], v248 offset:16384
ds_read_u16_d16_hi v193, v193
v_pk_add_f16 v195, v195, 1.0 op_sel_hi:[1,0]
v_mfma_f32_16x16x32_bf16 v[180:183], v[236:239], v[108:111], v[180:183]
v_rcp_f16 v202, v201
s_waitcnt lgkmcnt(7)
v_mfma_f32_16x16x32_bf16 v[168:171], v[216:219], v[112:115], v[168:171]
ds_read_b128 v[236:239], v249 offset:44032
v_rcp_f16_e64 v199, v198
v_mfma_f32_16x16x32_bf16 v[176:179], v[216:219], v[116:119], v[176:179]
v_rcp_f16_e64 v196, v195
v_mfma_f32_16x16x32_bf16 v[172:175], v[220:223], v[112:115], v[172:175]
ds_read_b128 v[216:219], v248 offset:16640
v_rcp_f16_sdwa v202, v201 dst_sel:WORD_1 dst_unused:UNUSED_PRESERVE src0_sel:WORD_1
v_mfma_f32_16x16x32_bf16 v[180:183], v[220:223], v[116:119], v[180:183]
v_rcp_f16_sdwa v199, v198 dst_sel:WORD_1 dst_unused:UNUSED_PRESERVE src0_sel:WORD_1
v_or_b32 v208, v184, v185
v_or_b32 v209, v186, v187
s_waitcnt lgkmcnt(4)
v_or_b32 v210, v188, v189
v_rcp_f16_sdwa v196, v195 dst_sel:WORD_1 dst_unused:UNUSED_PRESERVE src0_sel:WORD_1
v_or_b32 v211, v190, v191
s_waitcnt lgkmcnt(2)
v_or_b32_e64 v212, v192, v193
v_pk_mul_f16 v213, v203, v202
v_pk_mul_f16 v214, v200, v199
v_pk_mul_f16 v215, v197, v196
v_mfma_f32_16x16x32_f16 v[48:51], v[224:227], v[208:211], v[48:51]
s_add_u32 s46, s71, 98304
buffer_store_dwordx4 v[160:163], v255, s[8:11], s46 offen offset:256 sc1
ds_read_b128 v[220:223], v249 offset:44288
v_cvt_pkrtz_f16_f32 v185, v168, v169
v_cvt_pkrtz_f16_f32 v187, v170, v171
v_mfma_f32_16x16x32_f16 v[56:59], v[224:227], v[212:215], v[56:59]
v_cvt_pkrtz_f16_f32 v189, v172, v173
v_cvt_pkrtz_f16_f32 v191, v174, v175
v_mfma_f32_16x16x32_f16 v[52:55], v[228:231], v[208:211], v[52:55]
ds_read_b128 v[224:227], v248 offset:17408
v_cvt_pkrtz_f16_f32 v193, v176, v177
v_cvt_pk_f16_f32 v203, v178, v179
v_mfma_f32_16x16x32_f16 v[60:63], v[228:231], v[212:215], v[60:63]
v_cvt_pk_f16_f32 v200, v180, v181
v_cvt_pk_f16_f32 v197, v182, v183
v_mfma_f32_16x16x32_bf16 v[168:171], v[232:235], v[24:27], 0
ds_read_b128 v[228:231], v249 offset:45056
v_pk_fma_f16 v202, v203, v203, s48
v_and_b32_e64 v185, s49, v185
v_mfma_f32_16x16x32_bf16 v[176:179], v[232:235], v[28:31], 0
v_pk_fma_f16 v199, v200, v200, s48
v_and_b32 v187, s49, v187
s_waitcnt lgkmcnt(3)
v_mfma_f32_16x16x32_f16 v[64:67], v[236:239], v[208:211], v[64:67]
ds_read_b128 v[232:235], v249 offset:45312
v_pk_fma_f16 v196, v197, v197, s48
s_setprio 2
v_bfe_u32 v184, v185, 2, 14
v_pk_mul_f16 v202, v203, v202
v_mfma_f32_16x16x32_f16 v[72:75], v[236:239], v[212:215], v[72:75]
v_bfe_u32 v186, v187, 2, 14
v_pk_mul_f16 v199, v200, v199
s_waitcnt vmcnt(9)
v_mfma_f32_16x16x32_bf16 v[80:83], v[18:21], v[4:7], v[80:83]
ds_read_b128 v[236:239], v248 offset:17664
ds_read_u16_d16 v184, v184
ds_read_u16_d16 v186, v186
v_lshrrev_b32_e64 v185, 18, v185
v_pk_mul_f16 v196, v197, v196
v_mfma_f32_16x16x32_bf16 v[84:87], v[16:19], v[4:7], v[84:87]
v_lshrrev_b32_e64 v187, 18, v187
v_mfma_f32_16x16x32_bf16 v[172:175], v[216:219], v[24:27], 0
ds_read_u16_d16_hi v185, v185
ds_read_u16_d16_hi v187, v187
v_exp_f16 v201, v202
v_and_b32 v189, s49, v189
v_mfma_f32_16x16x32_bf16 v[180:183], v[216:219], v[28:31], 0
v_and_b32 v191, s49, v191
s_waitcnt lgkmcnt(6)
v_mfma_f32_16x16x32_f16 v[68:71], v[220:223], v[208:211], v[68:71]
ds_read_b128 v[216:219], v248 offset:18432
v_exp_f16_e64 v198, v199
v_bfe_u32 v188, v189, 2, 14
v_mfma_f32_16x16x32_f16 v[76:79], v[220:223], v[212:215], v[76:79]
v_bfe_u32 v190, v191, 2, 14
v_exp_f16_e64 v195, v196
v_mfma_f32_16x16x32_bf16 v[168:171], v[224:227], v[32:35], v[168:171]
s_add_u32 s46, s80, 12582912
buffer_load_dwordx4 v[96:99], v253, s[32:35], s46 offen nt
ds_read_b128 v[220:223], v248 offset:18688
ds_read_u16_d16 v188, v188
ds_read_u16_d16 v190, v190
v_lshrrev_b32 v189, 18, v189
v_lshrrev_b32 v191, 18, v191
v_mfma_f32_16x16x32_bf16 v[176:179], v[224:227], v[36:39], v[176:179]
v_exp_f16_sdwa v201, v202 dst_sel:WORD_1 dst_unused:UNUSED_PRESERVE src0_sel:WORD_1
v_mfma_f32_16x16x32_f16 v[80:83], v[228:231], v[208:211], v[80:83]
ds_read_b128 v[224:227], v249 offset:49152
ds_read_u16_d16_hi v189, v189
ds_read_u16_d16_hi v191, v191
v_and_b32 v193, s49, v193
v_bfe_u32 v192, v193, 2, 14
v_mfma_f32_16x16x32_f16 v[88:91], v[228:231], v[212:215], v[88:91]
v_exp_f16_sdwa v198, v199 dst_sel:WORD_1 dst_unused:UNUSED_PRESERVE src0_sel:WORD_1
s_waitcnt lgkmcnt(7)
v_mfma_f32_16x16x32_f16 v[84:87], v[232:235], v[208:211], v[84:87]
ds_read_b128 v[228:231], v249 offset:49408
ds_read_u16_d16 v192, v192
v_lshrrev_b32_e64 v193, 18, v193
v_mfma_f32_16x16x32_f16 v[92:95], v[232:235], v[212:215], v[92:95]
v_exp_f16_sdwa v195, v196 dst_sel:WORD_1 dst_unused:UNUSED_PRESERVE src0_sel:WORD_1
v_pk_add_f16 v201, v201, 1.0 op_sel_hi:[1,0]
v_pk_add_f16 v198, v198, 1.0 op_sel_hi:[1,0]
v_mfma_f32_16x16x32_bf16 v[172:175], v[236:239], v[32:35], v[172:175]
ds_read_b128 v[232:235], v248 offset:22528
ds_read_u16_d16_hi v193, v193
v_pk_add_f16 v195, v195, 1.0 op_sel_hi:[1,0]
v_mfma_f32_16x16x32_bf16 v[180:183], v[236:239], v[36:39], v[180:183]
v_rcp_f16 v202, v201
s_waitcnt lgkmcnt(7)
v_mfma_f32_16x16x32_bf16 v[168:171], v[216:219], v[40:43], v[168:171]
ds_read_b128 v[236:239], v249 offset:50176
v_rcp_f16_e64 v199, v198
v_mfma_f32_16x16x32_bf16 v[176:179], v[216:219], v[44:47], v[176:179]
v_rcp_f16_e64 v196, v195
v_mfma_f32_16x16x32_bf16 v[172:175], v[220:223], v[40:43], v[172:175]
ds_read_b128 v[216:219], v248 offset:22784
v_rcp_f16_sdwa v202, v201 dst_sel:WORD_1 dst_unused:UNUSED_PRESERVE src0_sel:WORD_1
v_mfma_f32_16x16x32_bf16 v[180:183], v[220:223], v[44:47], v[180:183]
v_rcp_f16_sdwa v199, v198 dst_sel:WORD_1 dst_unused:UNUSED_PRESERVE src0_sel:WORD_1
v_or_b32 v208, v184, v185
v_or_b32 v209, v186, v187
s_waitcnt lgkmcnt(4)
v_or_b32 v210, v188, v189
v_rcp_f16_sdwa v196, v195 dst_sel:WORD_1 dst_unused:UNUSED_PRESERVE src0_sel:WORD_1
v_or_b32 v211, v190, v191
s_waitcnt lgkmcnt(2)
v_or_b32_e64 v212, v192, v193
v_pk_mul_f16 v213, v203, v202
v_pk_mul_f16 v214, v200, v199
v_pk_mul_f16 v215, v197, v196
v_mfma_f32_16x16x32_f16 v[48:51], v[224:227], v[208:211], v[48:51]
s_add_u32 s46, s80, 12582912
buffer_load_dwordx4 v[100:103], v253, s[32:35], s46 offen offset:256 nt
ds_read_b128 v[220:223], v249 offset:50432
v_cvt_pkrtz_f16_f32 v185, v168, v169
v_cvt_pkrtz_f16_f32 v187, v170, v171
v_mfma_f32_16x16x32_f16 v[56:59], v[224:227], v[212:215], v[56:59]
v_cvt_pkrtz_f16_f32 v189, v172, v173
v_cvt_pkrtz_f16_f32 v191, v174, v175
v_mfma_f32_16x16x32_f16 v[52:55], v[228:231], v[208:211], v[52:55]
ds_read_b128 v[224:227], v248 offset:23552
v_cvt_pkrtz_f16_f32 v193, v176, v177
v_cvt_pk_f16_f32 v203, v178, v179
v_mfma_f32_16x16x32_f16 v[60:63], v[228:231], v[212:215], v[60:63]
v_cvt_pk_f16_f32 v200, v180, v181
v_cvt_pk_f16_f32 v197, v182, v183
s_setprio 1
v_mfma_f32_16x16x32_bf16 v[168:171], v[232:235], v[24:27], 0
ds_read_b128 v[228:231], v249 offset:51200
v_pk_fma_f16 v202, v203, v203, s48
v_and_b32 v185, s49, v185
v_mfma_f32_16x16x32_bf16 v[176:179], v[232:235], v[28:31], 0
v_pk_fma_f16 v199, v200, v200, s48
v_and_b32 v187, s49, v187
s_waitcnt lgkmcnt(3)
v_mfma_f32_16x16x32_f16 v[64:67], v[236:239], v[208:211], v[64:67]
ds_read_b128 v[232:235], v249 offset:51456
v_pk_fma_f16 v196, v197, v197, s48
v_bfe_u32 v184, v185, 2, 14
v_pk_mul_f16 v202, v203, v202
v_mfma_f32_16x16x32_f16 v[72:75], v[236:239], v[212:215], v[72:75]
v_bfe_u32 v186, v187, 2, 14
v_pk_mul_f16 v199, v200, v199
s_waitcnt vmcnt(10)
v_mfma_f32_16x16x32_bf16 v[56:59], v[18:21], v[0:3], v[56:59]
ds_read_b128 v[236:239], v248 offset:23808
ds_read_u16_d16 v184, v184
ds_read_u16_d16 v186, v186
v_lshrrev_b32 v185, 18, v185
v_pk_mul_f16 v196, v197, v196
v_mfma_f32_16x16x32_bf16 v[60:63], v[16:19], v[0:3], v[60:63]
v_lshrrev_b32_e64 v187, 18, v187
v_mfma_f32_16x16x32_bf16 v[172:175], v[216:219], v[24:27], 0
ds_read_u16_d16_hi v185, v185
ds_read_u16_d16_hi v187, v187
v_exp_f16 v201, v202
v_and_b32 v189, s49, v189
v_mfma_f32_16x16x32_bf16 v[180:183], v[216:219], v[28:31], 0
v_and_b32 v191, s49, v191
s_waitcnt lgkmcnt(6)
v_mfma_f32_16x16x32_f16 v[68:71], v[220:223], v[208:211], v[68:71]
ds_read_b128 v[216:219], v248 offset:24576
v_exp_f16_e64 v198, v199
v_bfe_u32 v188, v189, 2, 14
v_mfma_f32_16x16x32_f16 v[76:79], v[220:223], v[212:215], v[76:79]
v_bfe_u32 v190, v191, 2, 14
v_exp_f16_e64 v195, v196
v_mfma_f32_16x16x32_bf16 v[168:171], v[224:227], v[32:35], v[168:171]
ds_read_b128 v[220:223], v248 offset:24832
ds_read_u16_d16 v188, v188
ds_read_u16_d16 v190, v190
v_lshrrev_b32 v189, 18, v189
v_lshrrev_b32 v191, 18, v191
v_mfma_f32_16x16x32_bf16 v[176:179], v[224:227], v[36:39], v[176:179]
v_exp_f16_sdwa v201, v202 dst_sel:WORD_1 dst_unused:UNUSED_PRESERVE src0_sel:WORD_1
v_mfma_f32_16x16x32_f16 v[80:83], v[228:231], v[208:211], v[80:83]
ds_read_b128 v[224:227], v249 offset:24576
ds_read_u16_d16_hi v189, v189
ds_read_u16_d16_hi v191, v191
v_and_b32 v193, s49, v193
v_bfe_u32 v192, v193, 2, 14
v_mfma_f32_16x16x32_f16 v[88:91], v[228:231], v[212:215], v[88:91]
v_exp_f16_sdwa v198, v199 dst_sel:WORD_1 dst_unused:UNUSED_PRESERVE src0_sel:WORD_1
s_waitcnt lgkmcnt(7)
v_mfma_f32_16x16x32_f16 v[84:87], v[232:235], v[208:211], v[84:87]
ds_read_b128 v[228:231], v254 offset:7936
ds_read_u16_d16 v192, v192
v_lshrrev_b32_e64 v193, 18, v193
v_mfma_f32_16x16x32_f16 v[92:95], v[232:235], v[212:215], v[92:95]
v_exp_f16_sdwa v195, v196 dst_sel:WORD_1 dst_unused:UNUSED_PRESERVE src0_sel:WORD_1
v_pk_add_f16 v201, v201, 1.0 op_sel_hi:[1,0]
v_pk_add_f16 v198, v198, 1.0 op_sel_hi:[1,0]
v_mfma_f32_16x16x32_bf16 v[172:175], v[236:239], v[32:35], v[172:175]
ds_read_b128 v[232:235], v249 offset:24832
ds_read_u16_d16_hi v193, v193
v_pk_add_f16 v195, v195, 1.0 op_sel_hi:[1,0]
v_mfma_f32_16x16x32_bf16 v[180:183], v[236:239], v[36:39], v[180:183]
v_rcp_f16_e64 v202, v201
s_setprio 0
s_waitcnt lgkmcnt(7)
v_mfma_f32_16x16x32_bf16 v[168:171], v[216:219], v[40:43], v[168:171]
ds_read_b128 v[236:239], v254 offset:7952
v_rcp_f16_e64 v199, v198
v_mfma_f32_16x16x32_bf16 v[176:179], v[216:219], v[44:47], v[176:179]
v_rcp_f16_e64 v196, v195
v_mfma_f32_16x16x32_bf16 v[172:175], v[220:223], v[40:43], v[172:175]
ds_read_b128 v[216:219], v248 offset:28672
v_rcp_f16_sdwa v202, v201 dst_sel:WORD_1 dst_unused:UNUSED_PRESERVE src0_sel:WORD_1
v_mfma_f32_16x16x32_bf16 v[180:183], v[220:223], v[44:47], v[180:183]
v_rcp_f16_sdwa v199, v198 dst_sel:WORD_1 dst_unused:UNUSED_PRESERVE src0_sel:WORD_1
v_or_b32 v208, v184, v185
v_or_b32 v209, v186, v187
s_waitcnt lgkmcnt(4)
v_or_b32 v210, v188, v189
v_rcp_f16_sdwa v196, v195 dst_sel:WORD_1 dst_unused:UNUSED_PRESERVE src0_sel:WORD_1
v_or_b32 v211, v190, v191
s_waitcnt lgkmcnt(2)
v_or_b32_e64 v212, v192, v193
v_pk_mul_f16 v213, v203, v202
v_pk_mul_f16 v214, v200, v199
v_pk_mul_f16 v215, v197, v196
s_setprio 3
v_mfma_f32_16x16x32_f16 v[120:123], v[224:227], v[208:211], v[228:231]
s_add_u32 s46, s80, 16777216
buffer_load_dwordx4 v[104:107], v253, s[32:35], s46 offen nt
ds_read_b128 v[220:223], v249 offset:25600
v_cvt_pkrtz_f16_f32 v185, v168, v169
v_cvt_pkrtz_f16_f32 v187, v170, v171
v_mfma_f32_16x16x32_f16 v[128:131], v[224:227], v[212:215], v[228:231]
v_cvt_pkrtz_f16_f32 v189, v172, v173
v_cvt_pkrtz_f16_f32 v191, v174, v175
s_waitcnt lgkmcnt(1)
v_mfma_f32_16x16x32_f16 v[124:127], v[232:235], v[208:211], v[236:239]
ds_read_b128 v[224:227], v254 offset:8064
ds_read_b128 v[228:231], v248 offset:28928
v_cvt_pkrtz_f16_f32 v193, v176, v177
v_cvt_pk_f16_f32 v203, v178, v179
v_mfma_f32_16x16x32_f16 v[132:135], v[232:235], v[212:215], v[236:239]
v_cvt_pk_f16_f32 v200, v180, v181
v_cvt_pk_f16_f32 v197, v182, v183
v_mfma_f32_16x16x32_bf16 v[168:171], v[216:219], v[24:27], 0
ds_read_b128 v[232:235], v249 offset:25856
ds_read_b128 v[236:239], v254 offset:8080
v_pk_fma_f16 v202, v203, v203, s48
v_and_b32_e64 v185, s49, v185
v_mfma_f32_16x16x32_bf16 v[176:179], v[216:219], v[28:31], 0
v_pk_fma_f16 v199, v200, v200, s48
v_and_b32 v187, s49, v187
s_waitcnt lgkmcnt(3)
v_mfma_f32_16x16x32_f16 v[136:139], v[220:223], v[208:211], v[224:227]
ds_read_b128 v[216:219], v248 offset:29696
v_pk_fma_f16 v196, v197, v197, s48
v_bfe_u32 v184, v185, 2, 14
v_pk_mul_f16 v202, v203, v202
v_mfma_f32_16x16x32_f16 v[144:147], v[220:223], v[212:215], v[224:227]
v_bfe_u32 v186, v187, 2, 14
v_pk_mul_f16 v199, v200, v199
s_waitcnt vmcnt(8)
v_mfma_f32_16x16x32_bf16 v[72:75], v[18:21], v[244:247], v[72:75]
ds_read_b128 v[220:223], v249 offset:26624
ds_read_b128 v[224:227], v254 offset:16128
ds_read_u16_d16 v184, v184
ds_read_u16_d16 v186, v186
v_lshrrev_b32 v185, 18, v185
v_pk_mul_f16 v196, v197, v196
v_mfma_f32_16x16x32_bf16 v[76:79], v[16:19], v[244:247], v[76:79]
v_lshrrev_b32 v187, 18, v187
s_waitcnt lgkmcnt(5)
v_mfma_f32_16x16x32_bf16 v[172:175], v[228:231], v[24:27], 0
ds_read_u16_d16_hi v185, v185
ds_read_u16_d16_hi v187, v187
v_exp_f16 v201, v202
v_and_b32 v189, s49, v189
v_mfma_f32_16x16x32_bf16 v[180:183], v[228:231], v[28:31], 0
v_and_b32_e64 v191, s49, v191
v_mfma_f32_16x16x32_f16 v[140:143], v[232:235], v[208:211], v[236:239]
ds_read_b128 v[228:231], v249 offset:26880
v_exp_f16_e64 v198, v199
v_bfe_u32 v188, v189, 2, 14
v_mfma_f32_16x16x32_f16 v[148:151], v[232:235], v[212:215], v[236:239]
v_bfe_u32 v190, v191, 2, 14
v_exp_f16 v195, v196
s_waitcnt lgkmcnt(7)
v_mfma_f32_16x16x32_bf16 v[168:171], v[216:219], v[32:35], v[168:171]
ds_read_b128 v[232:235], v254 offset:16144
ds_read_b128 v[236:239], v248 offset:29952
ds_read_u16_d16 v188, v188
ds_read_u16_d16 v190, v190
v_lshrrev_b32_e64 v189, 18, v189
v_lshrrev_b32 v191, 18, v191
v_mfma_f32_16x16x32_bf16 v[176:179], v[216:219], v[36:39], v[176:179]
v_exp_f16_sdwa v201, v202 dst_sel:WORD_1 dst_unused:UNUSED_PRESERVE src0_sel:WORD_1
s_waitcnt lgkmcnt(7)
v_mfma_f32_16x16x32_f16 v[152:155], v[220:223], v[208:211], v[224:227]
ds_read_b128 v[216:219], v248 offset:30720
ds_read_u16_d16_hi v189, v189
ds_read_u16_d16_hi v191, v191
v_and_b32 v193, s49, v193
v_bfe_u32 v192, v193, 2, 14
v_mfma_f32_16x16x32_f16 v[160:163], v[220:223], v[212:215], v[224:227]
v_exp_f16_sdwa v198, v199 dst_sel:WORD_1 dst_unused:UNUSED_PRESERVE src0_sel:WORD_1
s_waitcnt lgkmcnt(6)
v_mfma_f32_16x16x32_f16 v[156:159], v[228:231], v[208:211], v[232:235]
ds_read_b128 v[220:223], v248 offset:30976
ds_read_b128 v[224:227], v249 offset:30720
ds_read_u16_d16 v192, v192
v_lshrrev_b32 v193, 18, v193
v_mfma_f32_16x16x32_f16 v[164:167], v[228:231], v[212:215], v[232:235]
v_exp_f16_sdwa v195, v196 dst_sel:WORD_1 dst_unused:UNUSED_PRESERVE src0_sel:WORD_1
v_pk_add_f16 v201, v201, 1.0 op_sel_hi:[1,0]
v_pk_add_f16 v198, v198, 1.0 op_sel_hi:[1,0]
s_waitcnt lgkmcnt(7)
v_mfma_f32_16x16x32_bf16 v[172:175], v[236:239], v[32:35], v[172:175]
ds_read_b128 v[228:231], v249 offset:30976
ds_read_b128 v[232:235], v248 offset:34816
ds_read_u16_d16_hi v193, v193
v_pk_add_f16 v195, v195, 1.0 op_sel_hi:[1,0]
v_mfma_f32_16x16x32_bf16 v[180:183], v[236:239], v[36:39], v[180:183]
v_rcp_f16 v202, v201
s_waitcnt lgkmcnt(8)
v_mfma_f32_16x16x32_bf16 v[168:171], v[216:219], v[40:43], v[168:171]
ds_read_b128 v[236:239], v249 offset:31744
v_rcp_f16_e64 v199, v198
v_mfma_f32_16x16x32_bf16 v[176:179], v[216:219], v[44:47], v[176:179]
v_rcp_f16 v196, v195
s_waitcnt lgkmcnt(6)
v_mfma_f32_16x16x32_bf16 v[172:175], v[220:223], v[40:43], v[172:175]
ds_read_b128 v[216:219], v248 offset:35072
v_rcp_f16_sdwa v202, v201 dst_sel:WORD_1 dst_unused:UNUSED_PRESERVE src0_sel:WORD_1
v_mfma_f32_16x16x32_bf16 v[180:183], v[220:223], v[44:47], v[180:183]
v_rcp_f16_sdwa v199, v198 dst_sel:WORD_1 dst_unused:UNUSED_PRESERVE src0_sel:WORD_1
v_or_b32 v208, v184, v185
v_or_b32 v209, v186, v187
v_or_b32_e64 v210, v188, v189
v_rcp_f16_sdwa v196, v195 dst_sel:WORD_1 dst_unused:UNUSED_PRESERVE src0_sel:WORD_1
v_or_b32 v211, v190, v191
s_waitcnt lgkmcnt(2)
v_or_b32_e64 v212, v192, v193
v_pk_mul_f16 v213, v203, v202
v_pk_mul_f16 v214, v200, v199
v_pk_mul_f16 v215, v197, v196
v_mfma_f32_16x16x32_f16 v[120:123], v[224:227], v[208:211], v[120:123]
s_add_u32 s46, s80, 16777216
buffer_load_dwordx4 v[108:111], v253, s[32:35], s46 offen offset:256 nt
ds_read_b128 v[220:223], v249 offset:32000
v_cvt_pkrtz_f16_f32 v185, v168, v169
v_cvt_pkrtz_f16_f32 v187, v170, v171
v_mfma_f32_16x16x32_f16 v[128:131], v[224:227], v[212:215], v[128:131]
v_cvt_pkrtz_f16_f32 v189, v172, v173
v_cvt_pkrtz_f16_f32 v191, v174, v175
v_mfma_f32_16x16x32_f16 v[124:127], v[228:231], v[208:211], v[124:127]
ds_read_b128 v[224:227], v248 offset:35840
v_cvt_pkrtz_f16_f32 v193, v176, v177
v_cvt_pk_f16_f32 v203, v178, v179
v_mfma_f32_16x16x32_f16 v[132:135], v[228:231], v[212:215], v[132:135]
v_cvt_pk_f16_f32 v200, v180, v181
v_cvt_pk_f16_f32 v197, v182, v183
v_mfma_f32_16x16x32_bf16 v[168:171], v[232:235], v[24:27], 0
ds_read_b128 v[228:231], v249 offset:32768
v_pk_fma_f16 v202, v203, v203, s48
v_and_b32_e64 v185, s49, v185
v_mfma_f32_16x16x32_bf16 v[176:179], v[232:235], v[28:31], 0
v_pk_fma_f16 v199, v200, v200, s48
v_and_b32 v187, s49, v187
s_waitcnt lgkmcnt(3)
v_mfma_f32_16x16x32_f16 v[136:139], v[236:239], v[208:211], v[136:139]
ds_read_b128 v[232:235], v249 offset:33024
v_pk_fma_f16 v196, v197, v197, s48
s_setprio 2
v_bfe_u32 v184, v185, 2, 14
v_pk_mul_f16 v202, v203, v202
v_mfma_f32_16x16x32_f16 v[144:147], v[236:239], v[212:215], v[144:147]
v_bfe_u32 v186, v187, 2, 14
v_pk_mul_f16 v199, v200, v199
s_waitcnt vmcnt(8)
v_mfma_f32_16x16x32_bf16 v[88:91], v[18:21], v[204:207], v[88:91]
ds_read_b128 v[236:239], v248 offset:36096
ds_read_u16_d16 v184, v184
ds_read_u16_d16 v186, v186
v_lshrrev_b32_e64 v185, 18, v185
v_pk_mul_f16 v196, v197, v196
v_mfma_f32_16x16x32_bf16 v[92:95], v[16:19], v[204:207], v[92:95]
v_lshrrev_b32_e64 v187, 18, v187
v_mfma_f32_16x16x32_bf16 v[172:175], v[216:219], v[24:27], 0
ds_read_u16_d16_hi v185, v185
ds_read_u16_d16_hi v187, v187
v_exp_f16 v201, v202
v_and_b32 v189, s49, v189
v_mfma_f32_16x16x32_bf16 v[180:183], v[216:219], v[28:31], 0
v_and_b32 v191, s49, v191
s_waitcnt lgkmcnt(6)
v_mfma_f32_16x16x32_f16 v[140:143], v[220:223], v[208:211], v[140:143]
ds_read_b128 v[216:219], v248 offset:36864
v_exp_f16_e64 v198, v199
v_bfe_u32 v188, v189, 2, 14
v_mfma_f32_16x16x32_f16 v[148:151], v[220:223], v[212:215], v[148:151]
v_bfe_u32 v190, v191, 2, 14
v_exp_f16_e64 v195, v196
v_mfma_f32_16x16x32_bf16 v[168:171], v[224:227], v[32:35], v[168:171]
ds_read_b128 v[220:223], v248 offset:37120
ds_read_u16_d16 v188, v188
ds_read_u16_d16 v190, v190
v_lshrrev_b32 v189, 18, v189
v_lshrrev_b32 v191, 18, v191
v_mfma_f32_16x16x32_bf16 v[176:179], v[224:227], v[36:39], v[176:179]
v_exp_f16_sdwa v201, v202 dst_sel:WORD_1 dst_unused:UNUSED_PRESERVE src0_sel:WORD_1
v_mfma_f32_16x16x32_f16 v[152:155], v[228:231], v[208:211], v[152:155]
ds_read_b128 v[224:227], v249 offset:36864
ds_read_u16_d16_hi v189, v189
ds_read_u16_d16_hi v191, v191
v_and_b32 v193, s49, v193
v_bfe_u32 v192, v193, 2, 14
v_mfma_f32_16x16x32_f16 v[160:163], v[228:231], v[212:215], v[160:163]
v_exp_f16_sdwa v198, v199 dst_sel:WORD_1 dst_unused:UNUSED_PRESERVE src0_sel:WORD_1
s_waitcnt lgkmcnt(7)
v_mfma_f32_16x16x32_f16 v[156:159], v[232:235], v[208:211], v[156:159]
ds_read_b128 v[228:231], v249 offset:37120
ds_read_u16_d16 v192, v192
v_lshrrev_b32_e64 v193, 18, v193
v_mfma_f32_16x16x32_f16 v[164:167], v[232:235], v[212:215], v[164:167]
v_exp_f16_sdwa v195, v196 dst_sel:WORD_1 dst_unused:UNUSED_PRESERVE src0_sel:WORD_1
v_pk_add_f16 v201, v201, 1.0 op_sel_hi:[1,0]
v_pk_add_f16 v198, v198, 1.0 op_sel_hi:[1,0]
v_mfma_f32_16x16x32_bf16 v[172:175], v[236:239], v[32:35], v[172:175]
ds_read_b128 v[232:235], v248 offset:40960
ds_read_u16_d16_hi v193, v193
v_pk_add_f16 v195, v195, 1.0 op_sel_hi:[1,0]
v_mfma_f32_16x16x32_bf16 v[180:183], v[236:239], v[36:39], v[180:183]
v_rcp_f16 v202, v201
s_waitcnt lgkmcnt(7)
v_mfma_f32_16x16x32_bf16 v[168:171], v[216:219], v[40:43], v[168:171]
ds_read_b128 v[236:239], v249 offset:37888
v_rcp_f16_e64 v199, v198
v_mfma_f32_16x16x32_bf16 v[176:179], v[216:219], v[44:47], v[176:179]
v_rcp_f16_e64 v196, v195
v_mfma_f32_16x16x32_bf16 v[172:175], v[220:223], v[40:43], v[172:175]
ds_read_b128 v[216:219], v248 offset:41216
v_rcp_f16_sdwa v202, v201 dst_sel:WORD_1 dst_unused:UNUSED_PRESERVE src0_sel:WORD_1
v_mfma_f32_16x16x32_bf16 v[180:183], v[220:223], v[44:47], v[180:183]
v_rcp_f16_sdwa v199, v198 dst_sel:WORD_1 dst_unused:UNUSED_PRESERVE src0_sel:WORD_1
v_or_b32 v208, v184, v185
v_or_b32 v209, v186, v187
s_waitcnt lgkmcnt(4)
v_or_b32 v210, v188, v189
v_rcp_f16_sdwa v196, v195 dst_sel:WORD_1 dst_unused:UNUSED_PRESERVE src0_sel:WORD_1
v_or_b32 v211, v190, v191
s_waitcnt lgkmcnt(2)
v_or_b32_e64 v212, v192, v193
v_pk_mul_f16 v213, v203, v202
v_pk_mul_f16 v214, v200, v199
v_pk_mul_f16 v215, v197, v196
v_mfma_f32_16x16x32_f16 v[120:123], v[224:227], v[208:211], v[120:123]
s_add_u32 s46, s80, 20971520
buffer_load_dwordx4 v[112:115], v253, s[32:35], s46 offen nt
ds_read_b128 v[220:223], v249 offset:38144
v_cvt_pkrtz_f16_f32 v185, v168, v169
v_cvt_pkrtz_f16_f32 v187, v170, v171
v_cvt_pkrtz_f16_f32 v189, v172, v173
v_mfma_f32_16x16x32_f16 v[128:131], v[224:227], v[212:215], v[128:131]
v_cvt_pkrtz_f16_f32 v191, v174, v175
v_cvt_pkrtz_f16_f32 v193, v176, v177
v_cvt_pk_f16_f32 v203, v178, v179
v_mfma_f32_16x16x32_f16 v[124:127], v[228:231], v[208:211], v[124:127]
ds_read_b128 v[224:227], v248 offset:41984
v_cvt_pk_f16_f32 v200, v180, v181
v_cvt_pk_f16_f32 v197, v182, v183
v_pk_fma_f16 v202, v203, v203, s48
s_setprio 1
v_cvt_pk_bf16_f32 v64, v64, v65
v_mfma_f32_16x16x32_f16 v[132:135], v[228:231], v[212:215], v[132:135]
v_and_b32 v185, s49, v185
v_cvt_pk_bf16_f32 v65, v66, v67
v_pk_fma_f16 v199, v200, v200, s48
v_mfma_f32_16x16x32_bf16 v[168:171], v[232:235], v[24:27], 0
ds_read_b128 v[228:231], v249 offset:38912
v_and_b32 v187, s49, v187
v_cvt_pk_bf16_f32 v66, v68, v69
v_pk_fma_f16 v196, v197, v197, s48
v_mfma_f32_16x16x32_bf16 v[176:179], v[232:235], v[28:31], 0
v_cvt_pk_bf16_f32 v67, v70, v71
v_bfe_u32 v184, v185, 2, 14
v_pk_mul_f16 v202, v203, v202
v_cvt_pk_bf16_f32 v48, v48, v49
s_waitcnt lgkmcnt(2)
v_mfma_f32_16x16x32_f16 v[136:139], v[236:239], v[208:211], v[136:139]
ds_read_b128 v[232:235], v249 offset:39168
ds_read_u16_d16 v184, v184
v_bfe_u32 v186, v187, 2, 14
v_cvt_pk_bf16_f32 v49, v50, v51
v_pk_mul_f16 v199, v200, v199
v_mfma_f32_16x16x32_f16 v[144:147], v[236:239], v[212:215], v[144:147]
v_lshrrev_b32_e64 v185, 18, v185
v_cvt_pk_bf16_f32 v50, v52, v53
v_pk_mul_f16 v196, v197, v196
v_mfma_f32_16x16x32_bf16 v[172:175], v[216:219], v[24:27], 0
ds_read_b128 v[236:239], v248 offset:42240
ds_read_u16_d16 v186, v186
ds_read_u16_d16_hi v185, v185
v_lshrrev_b32_e64 v187, 18, v187
v_cvt_pk_bf16_f32 v51, v54, v55
v_exp_f16_e64 v201, v202
v_mfma_f32_16x16x32_bf16 v[180:183], v[216:219], v[28:31], 0
v_cvt_pk_bf16_f32 v80, v80, v81
v_and_b32_e64 v189, s49, v189
v_cvt_pk_bf16_f32 v81, v82, v83
v_mfma_f32_16x16x32_f16 v[140:143], v[220:223], v[208:211], v[140:143]
ds_read_b128 v[216:219], v248 offset:43008
ds_read_u16_d16_hi v187, v187
v_and_b32_e64 v191, s49, v191
v_cvt_pk_bf16_f32 v82, v84, v85
v_mfma_f32_16x16x32_f16 v[148:151], v[220:223], v[212:215], v[148:151]
v_exp_f16_e64 v198, v199
v_cvt_pk_bf16_f32 v83, v86, v87
s_mov_b64 vcc, s[74:75]
v_bfe_u32 v188, v189, 2, 14
v_bfe_u32 v190, v191, 2, 14
s_waitcnt lgkmcnt(5)
v_mfma_f32_16x16x32_bf16 v[168:171], v[224:227], v[32:35], v[168:171]
ds_read_b128 v[220:223], v248 offset:43264
ds_read_u16_d16 v188, v188
ds_read_u16_d16 v190, v190
v_cndmask_b32 v68, v48, v80, vcc
v_exp_f16 v195, v196
v_mfma_f32_16x16x32_bf16 v[176:179], v[224:227], v[36:39], v[176:179]
v_cndmask_b32 v69, v49, v81, vcc
v_lshrrev_b32_e64 v189, 18, v189
v_cndmask_b32 v70, v50, v82, vcc
v_mfma_f32_16x16x32_f16 v[152:155], v[228:231], v[208:211], v[152:155]
ds_read_b128 v[224:227], v249 offset:43008
ds_read_u16_d16_hi v189, v189
v_lshrrev_b32 v191, 18, v191
v_cndmask_b32 v71, v51, v83, vcc
v_exp_f16_sdwa v201, v202 dst_sel:WORD_1 dst_unused:UNUSED_PRESERVE src0_sel:WORD_1
v_mfma_f32_16x16x32_f16 v[160:163], v[228:231], v[212:215], v[160:163]
v_cndmask_b32_dpp v48, v64, v48, vcc quad_perm:[1,0,3,2] row_mask:0xf bank_mask:0xf
v_and_b32_e64 v193, s49, v193
v_cndmask_b32_dpp v49, v65, v49, vcc quad_perm:[1,0,3,2] row_mask:0xf bank_mask:0xf
v_mfma_f32_16x16x32_f16 v[156:159], v[232:235], v[208:211], v[156:159]
ds_read_b128 v[228:231], v249 offset:43264
ds_read_u16_d16_hi v191, v191
v_bfe_u32 v192, v193, 2, 14
v_exp_f16_sdwa v198, v199 dst_sel:WORD_1 dst_unused:UNUSED_PRESERVE src0_sel:WORD_1
v_mfma_f32_16x16x32_f16 v[164:167], v[232:235], v[212:215], v[164:167]
v_cndmask_b32_dpp v50, v66, v50, vcc quad_perm:[1,0,3,2] row_mask:0xf bank_mask:0xf
v_lshrrev_b32 v193, 18, v193
v_cndmask_b32_dpp v51, v67, v51, vcc quad_perm:[1,0,3,2] row_mask:0xf bank_mask:0xf
s_not_b64 vcc, s[74:75]
s_waitcnt lgkmcnt(4)
v_mfma_f32_16x16x32_bf16 v[172:175], v[236:239], v[32:35], v[172:175]
ds_read_b128 v[232:235], v248 offset:47104
ds_read_u16_d16 v192, v192
ds_read_u16_d16_hi v193, v193
v_exp_f16_sdwa v195, v196 dst_sel:WORD_1 dst_unused:UNUSED_PRESERVE src0_sel:WORD_1
v_cndmask_b32_dpp v80, v64, v80, vcc quad_perm:[1,0,3,2] row_mask:0xf bank_mask:0xf
s_setprio 0
v_pk_add_f16 v201, v201, 1.0 op_sel_hi:[1,0]
v_mfma_f32_16x16x32_bf16 v[180:183], v[236:239], v[36:39], v[180:183]
v_cndmask_b32_dpp v81, v65, v81, vcc quad_perm:[1,0,3,2] row_mask:0xf bank_mask:0xf
v_pk_add_f16 v198, v198, 1.0 op_sel_hi:[1,0]
v_cndmask_b32_dpp v82, v66, v82, vcc quad_perm:[1,0,3,2] row_mask:0xf bank_mask:0xf
v_mfma_f32_16x16x32_bf16 v[168:171], v[216:219], v[40:43], v[168:171]
ds_read_b128 v[236:239], v249 offset:44032
v_pk_add_f16 v195, v195, 1.0 op_sel_hi:[1,0]
v_rcp_f16_e64 v202, v201
v_cndmask_b32_dpp v83, v67, v83, vcc quad_perm:[1,0,3,2] row_mask:0xf bank_mask:0xf
v_mfma_f32_16x16x32_bf16 v[176:179], v[216:219], v[44:47], v[176:179]
v_rcp_f16_e64 v199, v198
v_mfma_f32_16x16x32_bf16 v[172:175], v[220:223], v[40:43], v[172:175]
ds_read_b128 v[216:219], v248 offset:47360
buffer_store_dwordx4 v[48:51], v255, s[8:11], s70 offen sc1
v_rcp_f16_e64 v196, v195
v_rcp_f16_sdwa v202, v201 dst_sel:WORD_1 dst_unused:UNUSED_PRESERVE src0_sel:WORD_1
v_mfma_f32_16x16x32_bf16 v[180:183], v[220:223], v[44:47], v[180:183]
v_rcp_f16_sdwa v199, v198 dst_sel:WORD_1 dst_unused:UNUSED_PRESERVE src0_sel:WORD_1
v_or_b32 v208, v184, v185
v_or_b32 v209, v186, v187
s_waitcnt lgkmcnt(2)
v_or_b32 v210, v188, v189
v_rcp_f16_sdwa v196, v195 dst_sel:WORD_1 dst_unused:UNUSED_PRESERVE src0_sel:WORD_1
v_or_b32_e64 v211, v190, v191
v_or_b32 v212, v192, v193
v_pk_mul_f16 v213, v203, v202
v_pk_mul_f16 v214, v200, v199
v_pk_mul_f16 v215, v197, v196
s_setprio 3
v_mfma_f32_16x16x32_f16 v[120:123], v[224:227], v[208:211], v[120:123]
buffer_store_dwordx4 v[68:71], v255, s[8:11], s70 offen offset:128 sc1
ds_read_b128 v[220:223], v249 offset:44288
v_cvt_pkrtz_f16_f32 v185, v168, v169
v_cvt_pkrtz_f16_f32 v187, v170, v171
v_mfma_f32_16x16x32_f16 v[128:131], v[224:227], v[212:215], v[128:131]
v_cvt_pkrtz_f16_f32 v189, v172, v173
v_cvt_pkrtz_f16_f32 v191, v174, v175
v_mfma_f32_16x16x32_f16 v[124:127], v[228:231], v[208:211], v[124:127]
ds_read_b128 v[224:227], v248 offset:48128
v_cvt_pkrtz_f16_f32 v193, v176, v177
v_cvt_pk_f16_f32 v203, v178, v179
v_cvt_pk_f16_f32 v200, v180, v181
v_mfma_f32_16x16x32_f16 v[132:135], v[228:231], v[212:215], v[132:135]
v_cvt_pk_f16_f32 v197, v182, v183
v_pk_fma_f16 v202, v203, v203, s48
v_mfma_f32_16x16x32_bf16 v[168:171], v[232:235], v[24:27], 0
ds_read_b128 v[228:231], v249 offset:45056
v_and_b32_e64 v185, s49, v185
v_pk_fma_f16 v199, v200, v200, s48
v_mfma_f32_16x16x32_bf16 v[176:179], v[232:235], v[28:31], 0
v_and_b32 v187, s49, v187
v_pk_fma_f16 v196, v197, v197, s48
v_bfe_u32 v184, v185, 2, 14
s_waitcnt lgkmcnt(3)
v_mfma_f32_16x16x32_f16 v[136:139], v[236:239], v[208:211], v[136:139]
ds_read_b128 v[232:235], v249 offset:45312
ds_read_u16_d16 v184, v184
v_pk_mul_f16 v202, v203, v202
v_bfe_u32 v186, v187, 2, 14
v_mfma_f32_16x16x32_f16 v[144:147], v[236:239], v[212:215], v[144:147]
v_pk_mul_f16 v199, v200, v199
v_lshrrev_b32_e64 v185, 18, v185
v_mfma_f32_16x16x32_bf16 v[172:175], v[216:219], v[24:27], 0
ds_read_b128 v[236:239], v248 offset:48384
ds_read_u16_d16 v186, v186
ds_read_u16_d16_hi v185, v185
v_pk_mul_f16 v196, v197, v196
v_lshrrev_b32_e64 v187, 18, v187
v_mfma_f32_16x16x32_bf16 v[180:183], v[216:219], v[28:31], 0
v_exp_f16_e64 v201, v202
v_and_b32 v189, s49, v189
s_waitcnt lgkmcnt(5)
v_mfma_f32_16x16x32_f16 v[140:143], v[220:223], v[208:211], v[140:143]
ds_read_b128 v[216:219], v248 offset:49152
ds_read_u16_d16_hi v187, v187
v_and_b32_e64 v191, s49, v191
v_mfma_f32_16x16x32_f16 v[148:151], v[220:223], v[212:215], v[148:151]
v_exp_f16_e64 v198, v199
v_bfe_u32 v188, v189, 2, 14
v_bfe_u32 v190, v191, 2, 14
v_mfma_f32_16x16x32_bf16 v[168:171], v[224:227], v[32:35], v[168:171]
s_add_u32 s46, s80, 20971520
buffer_load_dwordx4 v[116:119], v253, s[32:35], s46 offen offset:256 nt
ds_read_b128 v[220:223], v248 offset:49408
ds_read_u16_d16 v188, v188
ds_read_u16_d16 v190, v190
v_exp_f16_e64 v195, v196
v_mfma_f32_16x16x32_bf16 v[176:179], v[224:227], v[36:39], v[176:179]
v_lshrrev_b32 v189, 18, v189
v_lshrrev_b32 v191, 18, v191
v_mfma_f32_16x16x32_f16 v[152:155], v[228:231], v[208:211], v[152:155]
ds_read_b128 v[224:227], v249 offset:49152
ds_read_u16_d16_hi v189, v189
ds_read_u16_d16_hi v191, v191
v_exp_f16_sdwa v201, v202 dst_sel:WORD_1 dst_unused:UNUSED_PRESERVE src0_sel:WORD_1
v_and_b32 v193, s49, v193
v_mfma_f32_16x16x32_f16 v[160:163], v[228:231], v[212:215], v[160:163]
v_bfe_u32 v192, v193, 2, 14
s_waitcnt lgkmcnt(7)
v_mfma_f32_16x16x32_f16 v[156:159], v[232:235], v[208:211], v[156:159]
ds_read_b128 v[228:231], v249 offset:49408
ds_read_u16_d16 v192, v192
v_exp_f16_sdwa v198, v199 dst_sel:WORD_1 dst_unused:UNUSED_PRESERVE src0_sel:WORD_1
v_lshrrev_b32_e64 v193, 18, v193
v_mfma_f32_16x16x32_f16 v[164:167], v[232:235], v[212:215], v[164:167]
v_exp_f16_sdwa v195, v196 dst_sel:WORD_1 dst_unused:UNUSED_PRESERVE src0_sel:WORD_1
v_pk_add_f16 v201, v201, 1.0 op_sel_hi:[1,0]
v_mfma_f32_16x16x32_bf16 v[172:175], v[236:239], v[32:35], v[172:175]
ds_read_b128 v[232:235], v248 offset:53248
ds_read_u16_d16_hi v193, v193
v_pk_add_f16 v198, v198, 1.0 op_sel_hi:[1,0]
v_pk_add_f16 v195, v195, 1.0 op_sel_hi:[1,0]
v_mfma_f32_16x16x32_bf16 v[180:183], v[236:239], v[36:39], v[180:183]
v_rcp_f16_e64 v202, v201
v_mfma_f32_16x16x32_bf16 v[168:171], v[216:219], v[40:43], v[168:171]
ds_read_b128 v[236:239], v249 offset:50176
v_rcp_f16_e64 v199, v198
v_mfma_f32_16x16x32_bf16 v[176:179], v[216:219], v[44:47], v[176:179]
v_rcp_f16 v196, v195
s_waitcnt lgkmcnt(5)
v_mfma_f32_16x16x32_bf16 v[172:175], v[220:223], v[40:43], v[172:175]
ds_read_b128 v[216:219], v248 offset:53504
v_rcp_f16_sdwa v202, v201 dst_sel:WORD_1 dst_unused:UNUSED_PRESERVE src0_sel:WORD_1
v_mfma_f32_16x16x32_bf16 v[180:183], v[220:223], v[44:47], v[180:183]
v_rcp_f16_sdwa v199, v198 dst_sel:WORD_1 dst_unused:UNUSED_PRESERVE src0_sel:WORD_1
v_or_b32 v208, v184, v185
v_or_b32 v209, v186, v187
v_or_b32_e64 v210, v188, v189
v_rcp_f16_sdwa v196, v195 dst_sel:WORD_1 dst_unused:UNUSED_PRESERVE src0_sel:WORD_1
v_or_b32 v211, v190, v191
s_waitcnt lgkmcnt(2)
v_or_b32_e64 v212, v192, v193
v_pk_mul_f16 v213, v203, v202
v_pk_mul_f16 v214, v200, v199
v_pk_mul_f16 v215, v197, v196
v_mfma_f32_16x16x32_f16 v[120:123], v[224:227], v[208:211], v[120:123]
ds_read_b128 v[220:223], v249 offset:50432
v_cvt_pkrtz_f16_f32 v185, v168, v169
v_cvt_pkrtz_f16_f32 v187, v170, v171
v_mfma_f32_16x16x32_f16 v[128:131], v[224:227], v[212:215], v[128:131]
v_cvt_pkrtz_f16_f32 v189, v172, v173
v_cvt_pkrtz_f16_f32 v191, v174, v175
v_mfma_f32_16x16x32_f16 v[124:127], v[228:231], v[208:211], v[124:127]
ds_read_b128 v[224:227], v248 offset:54272
v_cvt_pkrtz_f16_f32 v193, v176, v177
v_cvt_pk_f16_f32 v203, v178, v179
v_cvt_pk_f16_f32 v200, v180, v181
v_mfma_f32_16x16x32_f16 v[132:135], v[228:231], v[212:215], v[132:135]
v_cvt_pk_f16_f32 v197, v182, v183
v_pk_fma_f16 v202, v203, v203, s48
v_mfma_f32_16x16x32_bf16 v[168:171], v[232:235], v[24:27], 0
ds_read_b128 v[228:231], v249 offset:51200
v_and_b32_e64 v185, s49, v185
v_pk_fma_f16 v199, v200, v200, s48
v_mfma_f32_16x16x32_bf16 v[176:179], v[232:235], v[28:31], 0
v_and_b32_e64 v187, s49, v187
v_pk_fma_f16 v196, v197, v197, s48
s_setprio 2
v_bfe_u32 v184, v185, 2, 14
s_waitcnt lgkmcnt(3)
v_mfma_f32_16x16x32_f16 v[136:139], v[236:239], v[208:211], v[136:139]
ds_read_b128 v[232:235], v249 offset:51456
ds_read_u16_d16 v184, v184
v_pk_mul_f16 v202, v203, v202
v_bfe_u32 v186, v187, 2, 14
v_mfma_f32_16x16x32_f16 v[144:147], v[236:239], v[212:215], v[144:147]
v_pk_mul_f16 v199, v200, v199
v_lshrrev_b32_e64 v185, 18, v185
v_mfma_f32_16x16x32_bf16 v[172:175], v[216:219], v[24:27], 0
ds_read_b128 v[236:239], v248 offset:54528
ds_read_u16_d16 v186, v186
ds_read_u16_d16_hi v185, v185
v_pk_mul_f16 v196, v197, v196
v_lshrrev_b32_e64 v187, 18, v187
v_mfma_f32_16x16x32_bf16 v[180:183], v[216:219], v[28:31], 0
v_exp_f16_e64 v201, v202
v_and_b32 v189, s49, v189
s_waitcnt lgkmcnt(5)
v_mfma_f32_16x16x32_f16 v[140:143], v[220:223], v[208:211], v[140:143]
ds_read_b128 v[216:219], v248 offset:55296
ds_read_u16_d16_hi v187, v187
v_and_b32_e64 v191, s49, v191
v_mfma_f32_16x16x32_f16 v[148:151], v[220:223], v[212:215], v[148:151]
v_exp_f16_e64 v198, v199
v_bfe_u32 v188, v189, 2, 14
v_bfe_u32 v190, v191, 2, 14
v_mfma_f32_16x16x32_bf16 v[168:171], v[224:227], v[32:35], v[168:171]
ds_read_b128 v[220:223], v248 offset:55552
ds_read_u16_d16 v188, v188
ds_read_u16_d16 v190, v190
v_exp_f16_e64 v195, v196
v_mfma_f32_16x16x32_bf16 v[176:179], v[224:227], v[36:39], v[176:179]
v_lshrrev_b32 v189, 18, v189
v_lshrrev_b32 v191, 18, v191
v_mfma_f32_16x16x32_f16 v[152:155], v[228:231], v[208:211], v[152:155]
ds_read_b128 v[224:227], v249 offset:55296
ds_read_u16_d16_hi v189, v189
ds_read_u16_d16_hi v191, v191
v_exp_f16_sdwa v201, v202 dst_sel:WORD_1 dst_unused:UNUSED_PRESERVE src0_sel:WORD_1
v_and_b32 v193, s49, v193
v_mfma_f32_16x16x32_f16 v[160:163], v[228:231], v[212:215], v[160:163]
v_bfe_u32 v192, v193, 2, 14
s_waitcnt lgkmcnt(8)
v_mfma_f32_16x16x32_f16 v[156:159], v[232:235], v[208:211], v[156:159]
ds_read_b128 v[228:231], v249 offset:55552
ds_read_u16_d16 v192, v192
v_exp_f16_sdwa v198, v199 dst_sel:WORD_1 dst_unused:UNUSED_PRESERVE src0_sel:WORD_1
v_lshrrev_b32_e64 v193, 18, v193
v_mfma_f32_16x16x32_f16 v[164:167], v[232:235], v[212:215], v[164:167]
v_exp_f16_sdwa v195, v196 dst_sel:WORD_1 dst_unused:UNUSED_PRESERVE src0_sel:WORD_1
v_pk_add_f16 v201, v201, 1.0 op_sel_hi:[1,0]
v_mfma_f32_16x16x32_bf16 v[172:175], v[236:239], v[32:35], v[172:175]
ds_read_b128 v[232:235], v248 offset:59392
ds_read_u16_d16_hi v193, v193
v_pk_add_f16 v198, v198, 1.0 op_sel_hi:[1,0]
v_pk_add_f16 v195, v195, 1.0 op_sel_hi:[1,0]
v_mfma_f32_16x16x32_bf16 v[180:183], v[236:239], v[36:39], v[180:183]
v_rcp_f16 v202, v201
s_waitcnt lgkmcnt(7)
v_mfma_f32_16x16x32_bf16 v[168:171], v[216:219], v[40:43], v[168:171]
ds_read_b128 v[236:239], v249 offset:56320
v_rcp_f16_e64 v199, v198
v_mfma_f32_16x16x32_bf16 v[176:179], v[216:219], v[44:47], v[176:179]
v_rcp_f16_e64 v196, v195
v_mfma_f32_16x16x32_bf16 v[172:175], v[220:223], v[40:43], v[172:175]
ds_read_b128 v[216:219], v248 offset:59648
v_rcp_f16_sdwa v202, v201 dst_sel:WORD_1 dst_unused:UNUSED_PRESERVE src0_sel:WORD_1
v_mfma_f32_16x16x32_bf16 v[180:183], v[220:223], v[44:47], v[180:183]
v_rcp_f16_sdwa v199, v198 dst_sel:WORD_1 dst_unused:UNUSED_PRESERVE src0_sel:WORD_1
v_or_b32 v208, v184, v185
v_or_b32 v209, v186, v187
s_waitcnt lgkmcnt(4)
v_or_b32 v210, v188, v189
v_rcp_f16_sdwa v196, v195 dst_sel:WORD_1 dst_unused:UNUSED_PRESERVE src0_sel:WORD_1
v_or_b32 v211, v190, v191
s_waitcnt lgkmcnt(2)
v_or_b32_e64 v212, v192, v193
v_pk_mul_f16 v213, v203, v202
v_pk_mul_f16 v214, v200, v199
v_pk_mul_f16 v215, v197, v196
v_mfma_f32_16x16x32_f16 v[120:123], v[224:227], v[208:211], v[120:123]
buffer_load_dwordx4 v[204:207], v252, s[4:7], s68 offen
ds_read_b128 v[220:223], v249 offset:56576
v_cvt_pkrtz_f16_f32 v185, v168, v169
v_cvt_pkrtz_f16_f32 v187, v170, v171
v_mfma_f32_16x16x32_f16 v[128:131], v[224:227], v[212:215], v[128:131]
v_cvt_pkrtz_f16_f32 v189, v172, v173
v_cvt_pkrtz_f16_f32 v191, v174, v175
v_mfma_f32_16x16x32_f16 v[124:127], v[228:231], v[208:211], v[124:127]
ds_read_b128 v[224:227], v248 offset:60416
v_cvt_pkrtz_f16_f32 v193, v176, v177
v_cvt_pk_f16_f32 v203, v178, v179
v_cvt_pk_f16_f32 v200, v180, v181
v_mfma_f32_16x16x32_f16 v[132:135], v[228:231], v[212:215], v[132:135]
v_cvt_pk_f16_f32 v197, v182, v183
s_setprio 1
v_pk_fma_f16 v202, v203, v203, s48
v_mfma_f32_16x16x32_bf16 v[168:171], v[232:235], v[24:27], 0
ds_read_b128 v[228:231], v249 offset:57344
v_and_b32 v185, s49, v185
v_pk_fma_f16 v199, v200, v200, s48
v_mfma_f32_16x16x32_bf16 v[176:179], v[232:235], v[28:31], 0
v_and_b32 v187, s49, v187
v_pk_fma_f16 v196, v197, v197, s48
v_bfe_u32 v184, v185, 2, 14
s_waitcnt lgkmcnt(3)
v_mfma_f32_16x16x32_f16 v[136:139], v[236:239], v[208:211], v[136:139]
ds_read_b128 v[232:235], v249 offset:57600
ds_read_u16_d16 v184, v184
v_pk_mul_f16 v202, v203, v202
v_bfe_u32 v186, v187, 2, 14
v_mfma_f32_16x16x32_f16 v[144:147], v[236:239], v[212:215], v[144:147]
v_pk_mul_f16 v199, v200, v199
v_lshrrev_b32_e64 v185, 18, v185
v_mfma_f32_16x16x32_bf16 v[172:175], v[216:219], v[24:27], 0
ds_read_b128 v[236:239], v248 offset:60672
ds_read_u16_d16 v186, v186
ds_read_u16_d16_hi v185, v185
v_pk_mul_f16 v196, v197, v196
v_lshrrev_b32_e64 v187, 18, v187
v_mfma_f32_16x16x32_bf16 v[180:183], v[216:219], v[28:31], 0
v_exp_f16_e64 v201, v202
v_and_b32 v189, s49, v189
s_waitcnt lgkmcnt(5)
v_mfma_f32_16x16x32_f16 v[140:143], v[220:223], v[208:211], v[140:143]
ds_read_b128 v[216:219], v248 offset:61440
ds_read_u16_d16_hi v187, v187
v_and_b32_e64 v191, s49, v191
v_mfma_f32_16x16x32_f16 v[148:151], v[220:223], v[212:215], v[148:151]
v_exp_f16_e64 v198, v199
v_bfe_u32 v188, v189, 2, 14
v_bfe_u32 v190, v191, 2, 14
v_mfma_f32_16x16x32_bf16 v[168:171], v[224:227], v[32:35], v[168:171]
buffer_store_dwordx4 v[80:83], v255, s[8:11], s70 offen offset:256 sc1
ds_read_b128 v[220:223], v248 offset:61696
ds_read_u16_d16 v188, v188
ds_read_u16_d16 v190, v190
v_exp_f16_e64 v195, v196
v_mfma_f32_16x16x32_bf16 v[176:179], v[224:227], v[36:39], v[176:179]
v_lshrrev_b32 v189, 18, v189
v_lshrrev_b32 v191, 18, v191
v_mfma_f32_16x16x32_f16 v[152:155], v[228:231], v[208:211], v[152:155]
ds_read_b128 v[224:227], v249 offset:61440
ds_read_u16_d16_hi v189, v189
ds_read_u16_d16_hi v191, v191
v_exp_f16_sdwa v201, v202 dst_sel:WORD_1 dst_unused:UNUSED_PRESERVE src0_sel:WORD_1
v_and_b32 v193, s49, v193
v_mfma_f32_16x16x32_f16 v[160:163], v[228:231], v[212:215], v[160:163]
v_bfe_u32 v192, v193, 2, 14
s_waitcnt lgkmcnt(8)
v_mfma_f32_16x16x32_f16 v[156:159], v[232:235], v[208:211], v[156:159]
ds_read_b128 v[228:231], v249 offset:61696
ds_read_u16_d16 v192, v192
v_exp_f16_sdwa v198, v199 dst_sel:WORD_1 dst_unused:UNUSED_PRESERVE src0_sel:WORD_1
v_lshrrev_b32_e64 v193, 18, v193
v_mfma_f32_16x16x32_f16 v[164:167], v[232:235], v[212:215], v[164:167]
v_exp_f16_sdwa v195, v196 dst_sel:WORD_1 dst_unused:UNUSED_PRESERVE src0_sel:WORD_1
v_pk_add_f16 v201, v201, 1.0 op_sel_hi:[1,0]
v_mfma_f32_16x16x32_bf16 v[172:175], v[236:239], v[32:35], v[172:175]
ds_read_b128 v[232:235], v249
ds_read_u16_d16_hi v193, v193
v_pk_add_f16 v198, v198, 1.0 op_sel_hi:[1,0]
v_pk_add_f16 v195, v195, 1.0 op_sel_hi:[1,0]
v_mfma_f32_16x16x32_bf16 v[180:183], v[236:239], v[36:39], v[180:183]
v_rcp_f16_e64 v202, v201
s_setprio 0
s_waitcnt lgkmcnt(7)
v_mfma_f32_16x16x32_bf16 v[168:171], v[216:219], v[40:43], v[168:171]
ds_read_b128 v[236:239], v249 offset:62464
v_rcp_f16_e64 v199, v198
v_mfma_f32_16x16x32_bf16 v[176:179], v[216:219], v[44:47], v[176:179]
v_rcp_f16_e64 v196, v195
v_mfma_f32_16x16x32_bf16 v[172:175], v[220:223], v[40:43], v[172:175]
ds_read_b128 v[216:219], v249 offset:256
v_rcp_f16_sdwa v202, v201 dst_sel:WORD_1 dst_unused:UNUSED_PRESERVE src0_sel:WORD_1
v_mfma_f32_16x16x32_bf16 v[180:183], v[220:223], v[44:47], v[180:183]
v_rcp_f16_sdwa v199, v198 dst_sel:WORD_1 dst_unused:UNUSED_PRESERVE src0_sel:WORD_1
v_or_b32 v208, v184, v185
v_or_b32 v209, v186, v187
s_waitcnt lgkmcnt(4)
v_or_b32 v210, v188, v189
v_rcp_f16_sdwa v196, v195 dst_sel:WORD_1 dst_unused:UNUSED_PRESERVE src0_sel:WORD_1
v_or_b32 v211, v190, v191
s_waitcnt lgkmcnt(2)
v_or_b32 v212, v192, v193
v_pk_mul_f16 v213, v203, v202
v_pk_mul_f16 v214, v200, v199
v_pk_mul_f16 v215, v197, v196
s_setprio 3
v_mfma_f32_16x16x32_f16 v[120:123], v[224:227], v[208:211], v[120:123]
buffer_load_dwordx4 v[244:247], v252, s[4:7], s68 offen offset:64
ds_read_b128 v[220:223], v249 offset:62720
v_cvt_pkrtz_f16_f32 v185, v168, v169
v_cvt_pkrtz_f16_f32 v187, v170, v171
v_mfma_f32_16x16x32_f16 v[128:131], v[224:227], v[212:215], v[128:131]
v_cvt_pkrtz_f16_f32 v189, v172, v173
v_cvt_pkrtz_f16_f32 v191, v174, v175
v_mfma_f32_16x16x32_f16 v[124:127], v[228:231], v[208:211], v[124:127]
ds_read_b128 v[224:227], v249 offset:1024
v_cvt_pkrtz_f16_f32 v193, v176, v177
v_cvt_pk_f16_f32 v203, v178, v179
v_cvt_pk_f16_f32 v200, v180, v181
v_mfma_f32_16x16x32_f16 v[132:135], v[228:231], v[212:215], v[132:135]
v_cvt_pk_f16_f32 v197, v182, v183
v_pk_fma_f16 v202, v203, v203, s48
v_mfma_f32_16x16x32_bf16 v[168:171], v[232:235], v[24:27], 0
ds_read_b128 v[228:231], v249 offset:63488
v_and_b32_e64 v185, s49, v185
v_pk_fma_f16 v199, v200, v200, s48
v_mfma_f32_16x16x32_bf16 v[176:179], v[232:235], v[28:31], 0
v_and_b32 v187, s49, v187
v_pk_fma_f16 v196, v197, v197, s48
v_bfe_u32 v184, v185, 2, 14
s_waitcnt lgkmcnt(3)
v_mfma_f32_16x16x32_f16 v[136:139], v[236:239], v[208:211], v[136:139]
ds_read_b128 v[232:235], v249 offset:63744
ds_read_u16_d16 v184, v184
v_pk_mul_f16 v202, v203, v202
v_bfe_u32 v186, v187, 2, 14
v_mfma_f32_16x16x32_f16 v[144:147], v[236:239], v[212:215], v[144:147]
v_pk_mul_f16 v199, v200, v199
v_lshrrev_b32_e64 v185, 18, v185
v_mfma_f32_16x16x32_bf16 v[172:175], v[216:219], v[24:27], 0
ds_read_b128 v[236:239], v249 offset:1280
ds_read_u16_d16 v186, v186
ds_read_u16_d16_hi v185, v185
v_pk_mul_f16 v196, v197, v196
v_lshrrev_b32_e64 v187, 18, v187
v_mfma_f32_16x16x32_bf16 v[180:183], v[216:219], v[28:31], 0
v_exp_f16_e64 v201, v202
v_and_b32 v189, s49, v189
s_waitcnt lgkmcnt(5)
v_mfma_f32_16x16x32_f16 v[140:143], v[220:223], v[208:211], v[140:143]
ds_read_b128 v[216:219], v249 offset:2048
ds_read_u16_d16_hi v187, v187
v_and_b32_e64 v191, s49, v191
v_mfma_f32_16x16x32_f16 v[148:151], v[220:223], v[212:215], v[148:151]
v_exp_f16_e64 v198, v199
v_bfe_u32 v188, v189, 2, 14
v_bfe_u32 v190, v191, 2, 14
v_mfma_f32_16x16x32_bf16 v[168:171], v[224:227], v[32:35], v[168:171]
ds_read_b128 v[220:223], v249 offset:2304
ds_read_u16_d16 v188, v188
ds_read_u16_d16 v190, v190
v_exp_f16_e64 v195, v196
v_mfma_f32_16x16x32_bf16 v[176:179], v[224:227], v[36:39], v[176:179]
v_lshrrev_b32 v189, 18, v189
v_lshrrev_b32 v191, 18, v191
v_mfma_f32_16x16x32_f16 v[152:155], v[228:231], v[208:211], v[152:155]
ds_read_b128 v[224:227], v250 offset:2048
ds_read_u16_d16_hi v189, v189
ds_read_u16_d16_hi v191, v191
v_exp_f16_sdwa v201, v202 dst_sel:WORD_1 dst_unused:UNUSED_PRESERVE src0_sel:WORD_1
v_and_b32 v193, s49, v193
v_mfma_f32_16x16x32_f16 v[160:163], v[228:231], v[212:215], v[160:163]
v_bfe_u32 v192, v193, 2, 14
s_waitcnt lgkmcnt(8)
v_mfma_f32_16x16x32_f16 v[156:159], v[232:235], v[208:211], v[156:159]
ds_read_b128 v[228:231], v250 offset:2304
ds_read_u16_d16 v192, v192
v_exp_f16_sdwa v198, v199 dst_sel:WORD_1 dst_unused:UNUSED_PRESERVE src0_sel:WORD_1
v_lshrrev_b32_e64 v193, 18, v193
v_mfma_f32_16x16x32_f16 v[164:167], v[232:235], v[212:215], v[164:167]
v_exp_f16_sdwa v195, v196 dst_sel:WORD_1 dst_unused:UNUSED_PRESERVE src0_sel:WORD_1
v_pk_add_f16 v201, v201, 1.0 op_sel_hi:[1,0]
v_mfma_f32_16x16x32_bf16 v[172:175], v[236:239], v[32:35], v[172:175]
ds_read_b128 v[232:235], v249 offset:6144
ds_read_u16_d16_hi v193, v193
v_pk_add_f16 v198, v198, 1.0 op_sel_hi:[1,0]
v_pk_add_f16 v195, v195, 1.0 op_sel_hi:[1,0]
v_mfma_f32_16x16x32_bf16 v[180:183], v[236:239], v[36:39], v[180:183]
v_rcp_f16 v202, v201
s_waitcnt lgkmcnt(7)
v_mfma_f32_16x16x32_bf16 v[168:171], v[216:219], v[40:43], v[168:171]
ds_read_b128 v[236:239], v250 offset:3072
v_rcp_f16_e64 v199, v198
v_mfma_f32_16x16x32_bf16 v[176:179], v[216:219], v[44:47], v[176:179]
v_rcp_f16_e64 v196, v195
v_mfma_f32_16x16x32_bf16 v[172:175], v[220:223], v[40:43], v[172:175]
ds_read_b128 v[216:219], v249 offset:6400
v_rcp_f16_sdwa v202, v201 dst_sel:WORD_1 dst_unused:UNUSED_PRESERVE src0_sel:WORD_1
v_mfma_f32_16x16x32_bf16 v[180:183], v[220:223], v[44:47], v[180:183]
v_rcp_f16_sdwa v199, v198 dst_sel:WORD_1 dst_unused:UNUSED_PRESERVE src0_sel:WORD_1
v_or_b32 v208, v184, v185
v_or_b32 v209, v186, v187
s_waitcnt lgkmcnt(4)
v_or_b32 v210, v188, v189
v_rcp_f16_sdwa v196, v195 dst_sel:WORD_1 dst_unused:UNUSED_PRESERVE src0_sel:WORD_1
v_or_b32 v211, v190, v191
s_waitcnt lgkmcnt(2)
v_or_b32_e64 v212, v192, v193
v_pk_mul_f16 v213, v203, v202
v_pk_mul_f16 v214, v200, v199
v_pk_mul_f16 v215, v197, v196
v_mfma_f32_16x16x32_f16 v[120:123], v[224:227], v[208:211], v[120:123]
ds_read_b128 v[220:223], v250 offset:3328
v_cvt_pkrtz_f16_f32 v185, v168, v169
v_cvt_pkrtz_f16_f32 v187, v170, v171
v_cvt_pkrtz_f16_f32 v189, v172, v173
v_mfma_f32_16x16x32_f16 v[128:131], v[224:227], v[212:215], v[128:131]
v_cvt_pkrtz_f16_f32 v191, v174, v175
v_cvt_pkrtz_f16_f32 v193, v176, v177
v_cvt_pk_f16_f32 v203, v178, v179
v_mfma_f32_16x16x32_f16 v[124:127], v[228:231], v[208:211], v[124:127]
ds_read_b128 v[224:227], v249 offset:7168
v_cvt_pk_f16_f32 v200, v180, v181
v_cvt_pk_f16_f32 v197, v182, v183
v_pk_fma_f16 v202, v203, v203, s48
v_cvt_pk_bf16_f32 v72, v72, v73
v_mfma_f32_16x16x32_f16 v[132:135], v[228:231], v[212:215], v[132:135]
v_and_b32_e64 v185, s49, v185
v_cvt_pk_bf16_f32 v73, v74, v75
v_pk_fma_f16 v199, v200, v200, s48
v_mfma_f32_16x16x32_bf16 v[168:171], v[232:235], v[24:27], 0
ds_read_b128 v[228:231], v250 offset:4096
v_and_b32_e64 v187, s49, v187
v_cvt_pk_bf16_f32 v74, v76, v77
v_pk_fma_f16 v196, v197, v197, s48
v_mfma_f32_16x16x32_bf16 v[176:179], v[232:235], v[28:31], 0
v_cvt_pk_bf16_f32 v75, v78, v79
v_bfe_u32 v184, v185, 2, 14
s_setprio 2
v_pk_mul_f16 v202, v203, v202
v_cvt_pk_bf16_f32 v56, v56, v57
s_waitcnt lgkmcnt(2)
v_mfma_f32_16x16x32_f16 v[136:139], v[236:239], v[208:211], v[136:139]
ds_read_b128 v[232:235], v250 offset:4352
ds_read_u16_d16 v184, v184
v_bfe_u32 v186, v187, 2, 14
v_cvt_pk_bf16_f32 v57, v58, v59
v_pk_mul_f16 v199, v200, v199
v_mfma_f32_16x16x32_f16 v[144:147], v[236:239], v[212:215], v[144:147]
v_lshrrev_b32_e64 v185, 18, v185
v_cvt_pk_bf16_f32 v58, v60, v61
v_pk_mul_f16 v196, v197, v196
v_mfma_f32_16x16x32_bf16 v[172:175], v[216:219], v[24:27], 0
ds_read_b128 v[236:239], v249 offset:7424
ds_read_u16_d16 v186, v186
ds_read_u16_d16_hi v185, v185
v_lshrrev_b32_e64 v187, 18, v187
v_cvt_pk_bf16_f32 v59, v62, v63
v_exp_f16_e64 v201, v202
v_mfma_f32_16x16x32_bf16 v[180:183], v[216:219], v[28:31], 0
v_cvt_pk_bf16_f32 v88, v88, v89
v_and_b32_e64 v189, s49, v189
v_cvt_pk_bf16_f32 v89, v90, v91
v_mfma_f32_16x16x32_f16 v[140:143], v[220:223], v[208:211], v[140:143]
ds_read_b128 v[216:219], v249 offset:8192
ds_read_u16_d16_hi v187, v187
v_and_b32_e64 v191, s49, v191
v_cvt_pk_bf16_f32 v90, v92, v93
v_mfma_f32_16x16x32_f16 v[148:151], v[220:223], v[212:215], v[148:151]
v_exp_f16_e64 v198, v199
v_cvt_pk_bf16_f32 v91, v94, v95
s_mov_b64 vcc, s[74:75]
v_bfe_u32 v188, v189, 2, 14
v_bfe_u32 v190, v191, 2, 14
s_waitcnt lgkmcnt(5)
v_mfma_f32_16x16x32_bf16 v[168:171], v[224:227], v[32:35], v[168:171]
ds_read_b128 v[220:223], v249 offset:8448
ds_read_u16_d16 v188, v188
ds_read_u16_d16 v190, v190
v_cndmask_b32 v76, v56, v88, vcc
v_exp_f16 v195, v196
v_mfma_f32_16x16x32_bf16 v[176:179], v[224:227], v[36:39], v[176:179]
v_cndmask_b32 v77, v57, v89, vcc
v_lshrrev_b32_e64 v189, 18, v189
v_cndmask_b32 v78, v58, v90, vcc
v_mfma_f32_16x16x32_f16 v[152:155], v[228:231], v[208:211], v[152:155]
ds_read_b128 v[224:227], v250 offset:8192
ds_read_u16_d16_hi v189, v189
v_lshrrev_b32 v191, 18, v191
v_cndmask_b32 v79, v59, v91, vcc
v_exp_f16_sdwa v201, v202 dst_sel:WORD_1 dst_unused:UNUSED_PRESERVE src0_sel:WORD_1
v_mfma_f32_16x16x32_f16 v[160:163], v[228:231], v[212:215], v[160:163]
v_cndmask_b32_dpp v56, v72, v56, vcc quad_perm:[1,0,3,2] row_mask:0xf bank_mask:0xf
v_and_b32_e64 v193, s49, v193
v_cndmask_b32_dpp v57, v73, v57, vcc quad_perm:[1,0,3,2] row_mask:0xf bank_mask:0xf
v_mfma_f32_16x16x32_f16 v[156:159], v[232:235], v[208:211], v[156:159]
ds_read_b128 v[228:231], v250 offset:8448
ds_read_u16_d16_hi v191, v191
v_bfe_u32 v192, v193, 2, 14
v_exp_f16_sdwa v198, v199 dst_sel:WORD_1 dst_unused:UNUSED_PRESERVE src0_sel:WORD_1
v_mfma_f32_16x16x32_f16 v[164:167], v[232:235], v[212:215], v[164:167]
v_cndmask_b32_dpp v58, v74, v58, vcc quad_perm:[1,0,3,2] row_mask:0xf bank_mask:0xf
v_lshrrev_b32_e64 v193, 18, v193
v_cndmask_b32_dpp v59, v75, v59, vcc quad_perm:[1,0,3,2] row_mask:0xf bank_mask:0xf
s_not_b64 vcc, s[74:75]
s_waitcnt lgkmcnt(4)
v_mfma_f32_16x16x32_bf16 v[172:175], v[236:239], v[32:35], v[172:175]
ds_read_b128 v[232:235], v249 offset:12288
ds_read_u16_d16 v192, v192
ds_read_u16_d16_hi v193, v193
v_exp_f16_sdwa v195, v196 dst_sel:WORD_1 dst_unused:UNUSED_PRESERVE src0_sel:WORD_1
v_cndmask_b32_dpp v88, v72, v88, vcc quad_perm:[1,0,3,2] row_mask:0xf bank_mask:0xf
v_pk_add_f16 v201, v201, 1.0 op_sel_hi:[1,0]
v_mfma_f32_16x16x32_bf16 v[180:183], v[236:239], v[36:39], v[180:183]
v_cndmask_b32_dpp v89, v73, v89, vcc quad_perm:[1,0,3,2] row_mask:0xf bank_mask:0xf
v_pk_add_f16 v198, v198, 1.0 op_sel_hi:[1,0]
v_cndmask_b32_dpp v90, v74, v90, vcc quad_perm:[1,0,3,2] row_mask:0xf bank_mask:0xf
v_mfma_f32_16x16x32_bf16 v[168:171], v[216:219], v[40:43], v[168:171]
ds_read_b128 v[236:239], v250 offset:9216
v_pk_add_f16 v195, v195, 1.0 op_sel_hi:[1,0]
v_rcp_f16_e64 v202, v201
v_cndmask_b32_dpp v91, v75, v91, vcc quad_perm:[1,0,3,2] row_mask:0xf bank_mask:0xf
v_mfma_f32_16x16x32_bf16 v[176:179], v[216:219], v[44:47], v[176:179]
v_rcp_f16_e64 v199, v198
v_mfma_f32_16x16x32_bf16 v[172:175], v[220:223], v[40:43], v[172:175]
ds_read_b128 v[216:219], v249 offset:12544
s_add_u32 s46, s70, 98304
buffer_store_dwordx4 v[56:59], v255, s[8:11], s46 offen sc1
v_rcp_f16_e64 v196, v195
v_rcp_f16_sdwa v202, v201 dst_sel:WORD_1 dst_unused:UNUSED_PRESERVE src0_sel:WORD_1
v_mfma_f32_16x16x32_bf16 v[180:183], v[220:223], v[44:47], v[180:183]
v_rcp_f16_sdwa v199, v198 dst_sel:WORD_1 dst_unused:UNUSED_PRESERVE src0_sel:WORD_1
v_or_b32 v208, v184, v185
v_or_b32 v209, v186, v187
s_waitcnt lgkmcnt(2)
v_or_b32 v210, v188, v189
v_rcp_f16_sdwa v196, v195 dst_sel:WORD_1 dst_unused:UNUSED_PRESERVE src0_sel:WORD_1
v_or_b32 v211, v190, v191
v_or_b32 v212, v192, v193
v_pk_mul_f16 v213, v203, v202
v_pk_mul_f16 v214, v200, v199
v_pk_mul_f16 v215, v197, v196
v_mfma_f32_16x16x32_f16 v[120:123], v[224:227], v[208:211], v[120:123]
buffer_load_dwordx4 v[0:3], v252, s[4:7], s68 offen offset:128
ds_read_b128 v[220:223], v250 offset:9472
v_cvt_pkrtz_f16_f32 v185, v168, v169
v_cvt_pkrtz_f16_f32 v187, v170, v171
v_mfma_f32_16x16x32_f16 v[128:131], v[224:227], v[212:215], v[128:131]
v_cvt_pkrtz_f16_f32 v189, v172, v173
v_cvt_pkrtz_f16_f32 v191, v174, v175
v_mfma_f32_16x16x32_f16 v[124:127], v[228:231], v[208:211], v[124:127]
ds_read_b128 v[224:227], v249 offset:13312
v_cvt_pkrtz_f16_f32 v193, v176, v177
v_cvt_pk_f16_f32 v203, v178, v179
v_cvt_pk_f16_f32 v200, v180, v181
v_mfma_f32_16x16x32_f16 v[132:135], v[228:231], v[212:215], v[132:135]
v_cvt_pk_f16_f32 v197, v182, v183
s_setprio 1
v_pk_fma_f16 v202, v203, v203, s48
v_mfma_f32_16x16x32_bf16 v[168:171], v[232:235], v[24:27], 0
ds_read_b128 v[228:231], v250 offset:10240
v_and_b32 v185, s49, v185
v_pk_fma_f16 v199, v200, v200, s48
v_mfma_f32_16x16x32_bf16 v[176:179], v[232:235], v[28:31], 0
v_and_b32 v187, s49, v187
v_pk_fma_f16 v196, v197, v197, s48
v_bfe_u32 v184, v185, 2, 14
s_waitcnt lgkmcnt(3)
v_mfma_f32_16x16x32_f16 v[136:139], v[236:239], v[208:211], v[136:139]
ds_read_b128 v[232:235], v250 offset:10496
ds_read_u16_d16 v184, v184
v_pk_mul_f16 v202, v203, v202
v_bfe_u32 v186, v187, 2, 14
v_mfma_f32_16x16x32_f16 v[144:147], v[236:239], v[212:215], v[144:147]
v_pk_mul_f16 v199, v200, v199
v_lshrrev_b32_e64 v185, 18, v185
v_mfma_f32_16x16x32_bf16 v[172:175], v[216:219], v[24:27], 0
ds_read_b128 v[236:239], v249 offset:13568
ds_read_u16_d16 v186, v186
ds_read_u16_d16_hi v185, v185
v_pk_mul_f16 v196, v197, v196
v_lshrrev_b32_e64 v187, 18, v187
v_mfma_f32_16x16x32_bf16 v[180:183], v[216:219], v[28:31], 0
v_exp_f16_e64 v201, v202
v_and_b32 v189, s49, v189
s_waitcnt lgkmcnt(5)
v_mfma_f32_16x16x32_f16 v[140:143], v[220:223], v[208:211], v[140:143]
ds_read_b128 v[216:219], v249 offset:14336
ds_read_u16_d16_hi v187, v187
v_and_b32_e64 v191, s49, v191
v_mfma_f32_16x16x32_f16 v[148:151], v[220:223], v[212:215], v[148:151]
v_exp_f16_e64 v198, v199
v_bfe_u32 v188, v189, 2, 14
v_bfe_u32 v190, v191, 2, 14
v_mfma_f32_16x16x32_bf16 v[168:171], v[224:227], v[32:35], v[168:171]
ds_read_b128 v[220:223], v249 offset:14592
ds_read_u16_d16 v188, v188
ds_read_u16_d16 v190, v190
v_exp_f16_e64 v195, v196
v_mfma_f32_16x16x32_bf16 v[176:179], v[224:227], v[36:39], v[176:179]
v_lshrrev_b32 v189, 18, v189
v_lshrrev_b32 v191, 18, v191
v_mfma_f32_16x16x32_f16 v[152:155], v[228:231], v[208:211], v[152:155]
ds_read_b128 v[224:227], v250 offset:14336
ds_read_u16_d16_hi v189, v189
ds_read_u16_d16_hi v191, v191
v_exp_f16_sdwa v201, v202 dst_sel:WORD_1 dst_unused:UNUSED_PRESERVE src0_sel:WORD_1
v_and_b32 v193, s49, v193
v_mfma_f32_16x16x32_f16 v[160:163], v[228:231], v[212:215], v[160:163]
v_bfe_u32 v192, v193, 2, 14
s_waitcnt lgkmcnt(8)
v_mfma_f32_16x16x32_f16 v[156:159], v[232:235], v[208:211], v[156:159]
ds_read_b128 v[228:231], v250 offset:14592
ds_read_u16_d16 v192, v192
v_exp_f16_sdwa v198, v199 dst_sel:WORD_1 dst_unused:UNUSED_PRESERVE src0_sel:WORD_1
v_lshrrev_b32_e64 v193, 18, v193
v_mfma_f32_16x16x32_f16 v[164:167], v[232:235], v[212:215], v[164:167]
v_exp_f16_sdwa v195, v196 dst_sel:WORD_1 dst_unused:UNUSED_PRESERVE src0_sel:WORD_1
v_pk_add_f16 v201, v201, 1.0 op_sel_hi:[1,0]
v_mfma_f32_16x16x32_bf16 v[172:175], v[236:239], v[32:35], v[172:175]
ds_read_b128 v[232:235], v249 offset:18432
ds_read_u16_d16_hi v193, v193
v_pk_add_f16 v198, v198, 1.0 op_sel_hi:[1,0]
v_pk_add_f16 v195, v195, 1.0 op_sel_hi:[1,0]
v_mfma_f32_16x16x32_bf16 v[180:183], v[236:239], v[36:39], v[180:183]
v_rcp_f16_e64 v202, v201
s_setprio 0
s_waitcnt lgkmcnt(7)
v_mfma_f32_16x16x32_bf16 v[168:171], v[216:219], v[40:43], v[168:171]
ds_read_b128 v[236:239], v250 offset:15360
v_rcp_f16_e64 v199, v198
v_mfma_f32_16x16x32_bf16 v[176:179], v[216:219], v[44:47], v[176:179]
v_rcp_f16_e64 v196, v195
v_mfma_f32_16x16x32_bf16 v[172:175], v[220:223], v[40:43], v[172:175]
ds_read_b128 v[216:219], v249 offset:18688
v_rcp_f16_sdwa v202, v201 dst_sel:WORD_1 dst_unused:UNUSED_PRESERVE src0_sel:WORD_1
v_mfma_f32_16x16x32_bf16 v[180:183], v[220:223], v[44:47], v[180:183]
v_rcp_f16_sdwa v199, v198 dst_sel:WORD_1 dst_unused:UNUSED_PRESERVE src0_sel:WORD_1
v_or_b32 v208, v184, v185
v_or_b32 v209, v186, v187
s_waitcnt lgkmcnt(4)
v_or_b32 v210, v188, v189
v_rcp_f16_sdwa v196, v195 dst_sel:WORD_1 dst_unused:UNUSED_PRESERVE src0_sel:WORD_1
v_or_b32 v211, v190, v191
s_waitcnt lgkmcnt(2)
v_or_b32 v212, v192, v193
v_pk_mul_f16 v213, v203, v202
v_pk_mul_f16 v214, v200, v199
v_pk_mul_f16 v215, v197, v196
s_setprio 3
v_mfma_f32_16x16x32_f16 v[120:123], v[224:227], v[208:211], v[120:123]
s_add_u32 s46, s68, 98304
buffer_load_dwordx4 v[4:7], v252, s[4:7], s46 offen
ds_read_b128 v[220:223], v250 offset:15616
v_cvt_pkrtz_f16_f32 v185, v168, v169
v_cvt_pkrtz_f16_f32 v187, v170, v171
v_mfma_f32_16x16x32_f16 v[128:131], v[224:227], v[212:215], v[128:131]
v_cvt_pkrtz_f16_f32 v189, v172, v173
v_cvt_pkrtz_f16_f32 v191, v174, v175
v_mfma_f32_16x16x32_f16 v[124:127], v[228:231], v[208:211], v[124:127]
ds_read_b128 v[224:227], v249 offset:19456
v_cvt_pkrtz_f16_f32 v193, v176, v177
v_cvt_pk_f16_f32 v203, v178, v179
v_cvt_pk_f16_f32 v200, v180, v181
v_mfma_f32_16x16x32_f16 v[132:135], v[228:231], v[212:215], v[132:135]
v_cvt_pk_f16_f32 v197, v182, v183
v_pk_fma_f16 v202, v203, v203, s48
v_mfma_f32_16x16x32_bf16 v[168:171], v[232:235], v[24:27], 0
ds_read_b128 v[228:231], v250 offset:16384
v_and_b32_e64 v185, s49, v185
v_pk_fma_f16 v199, v200, v200, s48
v_mfma_f32_16x16x32_bf16 v[176:179], v[232:235], v[28:31], 0
v_and_b32 v187, s49, v187
v_pk_fma_f16 v196, v197, v197, s48
v_bfe_u32 v184, v185, 2, 14
s_waitcnt lgkmcnt(3)
v_mfma_f32_16x16x32_f16 v[136:139], v[236:239], v[208:211], v[136:139]
ds_read_b128 v[232:235], v250 offset:16640
ds_read_u16_d16 v184, v184
v_pk_mul_f16 v202, v203, v202
v_bfe_u32 v186, v187, 2, 14
v_mfma_f32_16x16x32_f16 v[144:147], v[236:239], v[212:215], v[144:147]
v_pk_mul_f16 v199, v200, v199
v_lshrrev_b32_e64 v185, 18, v185
v_mfma_f32_16x16x32_bf16 v[172:175], v[216:219], v[24:27], 0
ds_read_b128 v[236:239], v249 offset:19712
ds_read_u16_d16 v186, v186
ds_read_u16_d16_hi v185, v185
v_pk_mul_f16 v196, v197, v196
v_lshrrev_b32_e64 v187, 18, v187
v_mfma_f32_16x16x32_bf16 v[180:183], v[216:219], v[28:31], 0
v_exp_f16_e64 v201, v202
v_and_b32 v189, s49, v189
s_waitcnt lgkmcnt(5)
v_mfma_f32_16x16x32_f16 v[140:143], v[220:223], v[208:211], v[140:143]
ds_read_b128 v[216:219], v249 offset:20480
ds_read_u16_d16_hi v187, v187
v_and_b32_e64 v191, s49, v191
v_mfma_f32_16x16x32_f16 v[148:151], v[220:223], v[212:215], v[148:151]
v_exp_f16_e64 v198, v199
v_bfe_u32 v188, v189, 2, 14
v_bfe_u32 v190, v191, 2, 14
v_mfma_f32_16x16x32_bf16 v[168:171], v[224:227], v[32:35], v[168:171]
s_add_u32 s46, s70, 98304
buffer_store_dwordx4 v[76:79], v255, s[8:11], s46 offen offset:128 sc1
ds_read_b128 v[220:223], v249 offset:20736
ds_read_u16_d16 v188, v188
ds_read_u16_d16 v190, v190
v_exp_f16_e64 v195, v196
v_mfma_f32_16x16x32_bf16 v[176:179], v[224:227], v[36:39], v[176:179]
v_lshrrev_b32 v189, 18, v189
v_lshrrev_b32 v191, 18, v191
v_mfma_f32_16x16x32_f16 v[152:155], v[228:231], v[208:211], v[152:155]
ds_read_b128 v[224:227], v250 offset:20480
ds_read_u16_d16_hi v189, v189
ds_read_u16_d16_hi v191, v191
v_exp_f16_sdwa v201, v202 dst_sel:WORD_1 dst_unused:UNUSED_PRESERVE src0_sel:WORD_1
v_and_b32 v193, s49, v193
v_mfma_f32_16x16x32_f16 v[160:163], v[228:231], v[212:215], v[160:163]
v_bfe_u32 v192, v193, 2, 14
s_waitcnt lgkmcnt(7)
v_mfma_f32_16x16x32_f16 v[156:159], v[232:235], v[208:211], v[156:159]
ds_read_b128 v[228:231], v250 offset:20736
ds_read_u16_d16 v192, v192
v_exp_f16_sdwa v198, v199 dst_sel:WORD_1 dst_unused:UNUSED_PRESERVE src0_sel:WORD_1
v_lshrrev_b32_e64 v193, 18, v193
v_mfma_f32_16x16x32_f16 v[164:167], v[232:235], v[212:215], v[164:167]
v_exp_f16_sdwa v195, v196 dst_sel:WORD_1 dst_unused:UNUSED_PRESERVE src0_sel:WORD_1
v_pk_add_f16 v201, v201, 1.0 op_sel_hi:[1,0]
v_mfma_f32_16x16x32_bf16 v[172:175], v[236:239], v[32:35], v[172:175]
ds_read_b128 v[232:235], v248 offset:16384
ds_read_u16_d16_hi v193, v193
v_pk_add_f16 v198, v198, 1.0 op_sel_hi:[1,0]
v_pk_add_f16 v195, v195, 1.0 op_sel_hi:[1,0]
v_mfma_f32_16x16x32_bf16 v[180:183], v[236:239], v[36:39], v[180:183]
v_rcp_f16_e64 v202, v201
v_mfma_f32_16x16x32_bf16 v[168:171], v[216:219], v[40:43], v[168:171]
ds_read_b128 v[236:239], v250 offset:21504
v_rcp_f16_e64 v199, v198
v_mfma_f32_16x16x32_bf16 v[176:179], v[216:219], v[44:47], v[176:179]
v_rcp_f16 v196, v195
s_waitcnt lgkmcnt(5)
v_mfma_f32_16x16x32_bf16 v[172:175], v[220:223], v[40:43], v[172:175]
ds_read_b128 v[216:219], v248 offset:16640
v_rcp_f16_sdwa v202, v201 dst_sel:WORD_1 dst_unused:UNUSED_PRESERVE src0_sel:WORD_1
v_mfma_f32_16x16x32_bf16 v[180:183], v[220:223], v[44:47], v[180:183]
v_rcp_f16_sdwa v199, v198 dst_sel:WORD_1 dst_unused:UNUSED_PRESERVE src0_sel:WORD_1
v_or_b32 v208, v184, v185
v_or_b32 v209, v186, v187
v_or_b32_e64 v210, v188, v189
v_rcp_f16_sdwa v196, v195 dst_sel:WORD_1 dst_unused:UNUSED_PRESERVE src0_sel:WORD_1
v_or_b32 v211, v190, v191
s_waitcnt lgkmcnt(2)
v_or_b32_e64 v212, v192, v193
v_pk_mul_f16 v213, v203, v202
v_pk_mul_f16 v214, v200, v199
v_pk_mul_f16 v215, v197, v196
v_mfma_f32_16x16x32_f16 v[120:123], v[224:227], v[208:211], v[120:123]
ds_read_b128 v[220:223], v250 offset:21760
v_cvt_pkrtz_f16_f32 v185, v168, v169
v_cvt_pkrtz_f16_f32 v187, v170, v171
v_mfma_f32_16x16x32_f16 v[128:131], v[224:227], v[212:215], v[128:131]
v_cvt_pkrtz_f16_f32 v189, v172, v173
v_cvt_pkrtz_f16_f32 v191, v174, v175
v_mfma_f32_16x16x32_f16 v[124:127], v[228:231], v[208:211], v[124:127]
ds_read_b128 v[224:227], v248 offset:17408
v_cvt_pkrtz_f16_f32 v193, v176, v177
v_cvt_pk_f16_f32 v203, v178, v179
v_cvt_pk_f16_f32 v200, v180, v181
v_mfma_f32_16x16x32_f16 v[132:135], v[228:231], v[212:215], v[132:135]
v_cvt_pk_f16_f32 v197, v182, v183
v_pk_fma_f16 v202, v203, v203, s48
s_waitcnt vmcnt(14)
v_mfma_f32_16x16x32_bf16 v[168:171], v[232:235], v[96:99], 0
ds_read_b128 v[228:231], v250 offset:22528
v_and_b32 v185, s49, v185
v_pk_fma_f16 v199, v200, v200, s48
s_waitcnt vmcnt(13)
v_mfma_f32_16x16x32_bf16 v[176:179], v[232:235], v[100:103], 0
v_and_b32 v187, s49, v187
v_pk_fma_f16 v196, v197, v197, s48
s_setprio 2
v_bfe_u32 v184, v185, 2, 14
s_waitcnt lgkmcnt(2)
v_mfma_f32_16x16x32_f16 v[136:139], v[236:239], v[208:211], v[136:139]
ds_read_b128 v[232:235], v250 offset:22784
ds_read_u16_d16 v184, v184
v_pk_mul_f16 v202, v203, v202
v_bfe_u32 v186, v187, 2, 14
v_mfma_f32_16x16x32_f16 v[144:147], v[236:239], v[212:215], v[144:147]
v_pk_mul_f16 v199, v200, v199
v_lshrrev_b32_e64 v185, 18, v185
v_mfma_f32_16x16x32_bf16 v[172:175], v[216:219], v[96:99], 0
ds_read_b128 v[236:239], v248 offset:17664
ds_read_u16_d16 v186, v186
ds_read_u16_d16_hi v185, v185
v_pk_mul_f16 v196, v197, v196
v_lshrrev_b32_e64 v187, 18, v187
v_mfma_f32_16x16x32_bf16 v[180:183], v[216:219], v[100:103], 0
v_exp_f16 v201, v202
v_and_b32 v189, s49, v189
v_mfma_f32_16x16x32_f16 v[140:143], v[220:223], v[208:211], v[140:143]
ds_read_b128 v[216:219], v248 offset:18432
ds_read_u16_d16_hi v187, v187
v_and_b32_e64 v191, s49, v191
v_mfma_f32_16x16x32_f16 v[148:151], v[220:223], v[212:215], v[148:151]
v_exp_f16 v198, v199
v_bfe_u32 v188, v189, 2, 14
v_bfe_u32 v190, v191, 2, 14
s_waitcnt vmcnt(12) lgkmcnt(7)
v_mfma_f32_16x16x32_bf16 v[168:171], v[224:227], v[104:107], v[168:171]
ds_read_b128 v[220:223], v248 offset:18688
ds_read_u16_d16 v188, v188
ds_read_u16_d16 v190, v190
v_exp_f16 v195, v196
s_waitcnt vmcnt(11)
v_mfma_f32_16x16x32_bf16 v[176:179], v[224:227], v[108:111], v[176:179]
v_lshrrev_b32 v189, 18, v189
v_lshrrev_b32 v191, 18, v191
v_mfma_f32_16x16x32_f16 v[152:155], v[228:231], v[208:211], v[152:155]
ds_read_b128 v[224:227], v250 offset:26624
ds_read_u16_d16_hi v189, v189
ds_read_u16_d16_hi v191, v191
v_exp_f16_sdwa v201, v202 dst_sel:WORD_1 dst_unused:UNUSED_PRESERVE src0_sel:WORD_1
v_and_b32 v193, s49, v193
v_mfma_f32_16x16x32_f16 v[160:163], v[228:231], v[212:215], v[160:163]
v_bfe_u32 v192, v193, 2, 14
s_waitcnt lgkmcnt(7)
v_mfma_f32_16x16x32_f16 v[156:159], v[232:235], v[208:211], v[156:159]
ds_read_b128 v[228:231], v250 offset:26880
ds_read_u16_d16 v192, v192
v_exp_f16_sdwa v198, v199 dst_sel:WORD_1 dst_unused:UNUSED_PRESERVE src0_sel:WORD_1
v_lshrrev_b32_e64 v193, 18, v193
v_mfma_f32_16x16x32_f16 v[164:167], v[232:235], v[212:215], v[164:167]
v_exp_f16_sdwa v195, v196 dst_sel:WORD_1 dst_unused:UNUSED_PRESERVE src0_sel:WORD_1
v_pk_add_f16 v201, v201, 1.0 op_sel_hi:[1,0]
v_mfma_f32_16x16x32_bf16 v[172:175], v[236:239], v[104:107], v[172:175]
ds_read_b128 v[232:235], v248 offset:22528
ds_read_u16_d16_hi v193, v193
v_pk_add_f16 v198, v198, 1.0 op_sel_hi:[1,0]
v_pk_add_f16 v195, v195, 1.0 op_sel_hi:[1,0]
v_mfma_f32_16x16x32_bf16 v[180:183], v[236:239], v[108:111], v[180:183]
v_rcp_f16 v202, v201
s_waitcnt vmcnt(10)
v_mfma_f32_16x16x32_bf16 v[168:171], v[216:219], v[112:115], v[168:171]
ds_read_b128 v[236:239], v250 offset:27648
v_rcp_f16 v199, v198
s_waitcnt vmcnt(7)
v_mfma_f32_16x16x32_bf16 v[176:179], v[216:219], v[116:119], v[176:179]
v_rcp_f16 v196, v195
s_waitcnt lgkmcnt(5)
v_mfma_f32_16x16x32_bf16 v[172:175], v[220:223], v[112:115], v[172:175]
ds_read_b128 v[216:219], v248 offset:22784
v_rcp_f16_sdwa v202, v201 dst_sel:WORD_1 dst_unused:UNUSED_PRESERVE src0_sel:WORD_1
v_mfma_f32_16x16x32_bf16 v[180:183], v[220:223], v[116:119], v[180:183]
v_rcp_f16_sdwa v199, v198 dst_sel:WORD_1 dst_unused:UNUSED_PRESERVE src0_sel:WORD_1
v_or_b32 v208, v184, v185
v_or_b32 v209, v186, v187
v_or_b32_e64 v210, v188, v189
v_rcp_f16_sdwa v196, v195 dst_sel:WORD_1 dst_unused:UNUSED_PRESERVE src0_sel:WORD_1
v_or_b32 v211, v190, v191
s_waitcnt lgkmcnt(2)
v_or_b32_e64 v212, v192, v193
v_pk_mul_f16 v213, v203, v202
v_pk_mul_f16 v214, v200, v199
v_pk_mul_f16 v215, v197, v196
v_mfma_f32_16x16x32_f16 v[120:123], v[224:227], v[208:211], v[120:123]
s_add_u32 s46, s68, 98304
buffer_load_dwordx4 v[44:47], v252, s[4:7], s46 offen offset:64
ds_read_b128 v[220:223], v250 offset:27904
v_cvt_pkrtz_f16_f32 v185, v168, v169
v_cvt_pkrtz_f16_f32 v187, v170, v171
v_mfma_f32_16x16x32_f16 v[128:131], v[224:227], v[212:215], v[128:131]
v_cvt_pkrtz_f16_f32 v189, v172, v173
v_cvt_pkrtz_f16_f32 v191, v174, v175
v_mfma_f32_16x16x32_f16 v[124:127], v[228:231], v[208:211], v[124:127]
ds_read_b128 v[224:227], v248 offset:23552
v_cvt_pkrtz_f16_f32 v193, v176, v177
v_cvt_pk_f16_f32 v203, v178, v179
v_mfma_f32_16x16x32_f16 v[132:135], v[228:231], v[212:215], v[132:135]
v_cvt_pk_f16_f32 v200, v180, v181
v_cvt_pk_f16_f32 v197, v182, v183
s_setprio 1
v_mfma_f32_16x16x32_bf16 v[168:171], v[232:235], v[96:99], 0
ds_read_b128 v[228:231], v250 offset:28672
v_pk_fma_f16 v202, v203, v203, s48
v_and_b32 v185, s49, v185
v_mfma_f32_16x16x32_bf16 v[176:179], v[232:235], v[100:103], 0
v_pk_fma_f16 v199, v200, v200, s48
v_and_b32 v187, s49, v187
s_waitcnt lgkmcnt(3)
v_mfma_f32_16x16x32_f16 v[136:139], v[236:239], v[208:211], v[136:139]
ds_read_b128 v[232:235], v250 offset:28928
v_pk_fma_f16 v196, v197, v197, s48
v_bfe_u32 v184, v185, 2, 14
v_pk_mul_f16 v202, v203, v202
v_mfma_f32_16x16x32_f16 v[144:147], v[236:239], v[212:215], v[144:147]
v_bfe_u32 v186, v187, 2, 14
v_pk_mul_f16 v199, v200, v199
s_waitcnt vmcnt(7)
v_mfma_f32_16x16x32_bf16 v[120:123], v[18:21], v[204:207], v[120:123]
ds_read_b128 v[236:239], v248 offset:23808
ds_read_u16_d16 v184, v184
ds_read_u16_d16 v186, v186
v_lshrrev_b32 v185, 18, v185
v_pk_mul_f16 v196, v197, v196
v_mfma_f32_16x16x32_bf16 v[124:127], v[16:19], v[204:207], v[124:127]
v_lshrrev_b32_e64 v187, 18, v187
v_mfma_f32_16x16x32_bf16 v[172:175], v[216:219], v[96:99], 0
ds_read_u16_d16_hi v185, v185
ds_read_u16_d16_hi v187, v187
v_exp_f16 v201, v202
v_and_b32 v189, s49, v189
v_mfma_f32_16x16x32_bf16 v[180:183], v[216:219], v[100:103], 0
v_and_b32 v191, s49, v191
s_waitcnt lgkmcnt(6)
v_mfma_f32_16x16x32_f16 v[140:143], v[220:223], v[208:211], v[140:143]
ds_read_b128 v[216:219], v248 offset:24576
v_exp_f16_e64 v198, v199
v_bfe_u32 v188, v189, 2, 14
v_mfma_f32_16x16x32_f16 v[148:151], v[220:223], v[212:215], v[148:151]
v_bfe_u32 v190, v191, 2, 14
v_exp_f16_e64 v195, v196
v_mfma_f32_16x16x32_bf16 v[168:171], v[224:227], v[104:107], v[168:171]
s_add_u32 s46, s70, 98304
buffer_store_dwordx4 v[88:91], v255, s[8:11], s46 offen offset:256 sc1
ds_read_b128 v[220:223], v248 offset:24832
ds_read_u16_d16 v188, v188
ds_read_u16_d16 v190, v190
v_lshrrev_b32 v189, 18, v189
v_lshrrev_b32 v191, 18, v191
v_mfma_f32_16x16x32_bf16 v[176:179], v[224:227], v[108:111], v[176:179]
v_exp_f16_sdwa v201, v202 dst_sel:WORD_1 dst_unused:UNUSED_PRESERVE src0_sel:WORD_1
v_mfma_f32_16x16x32_f16 v[152:155], v[228:231], v[208:211], v[152:155]
ds_read_b128 v[224:227], v249 offset:24576
ds_read_u16_d16_hi v189, v189
ds_read_u16_d16_hi v191, v191
v_and_b32 v193, s49, v193
v_bfe_u32 v192, v193, 2, 14
v_mfma_f32_16x16x32_f16 v[160:163], v[228:231], v[212:215], v[160:163]
v_exp_f16_sdwa v198, v199 dst_sel:WORD_1 dst_unused:UNUSED_PRESERVE src0_sel:WORD_1
s_waitcnt lgkmcnt(7)
v_mfma_f32_16x16x32_f16 v[156:159], v[232:235], v[208:211], v[156:159]
ds_read_b128 v[228:231], v254 offset:7936
ds_read_u16_d16 v192, v192
v_lshrrev_b32_e64 v193, 18, v193
v_mfma_f32_16x16x32_f16 v[164:167], v[232:235], v[212:215], v[164:167]
v_exp_f16_sdwa v195, v196 dst_sel:WORD_1 dst_unused:UNUSED_PRESERVE src0_sel:WORD_1
v_pk_add_f16 v201, v201, 1.0 op_sel_hi:[1,0]
v_pk_add_f16 v198, v198, 1.0 op_sel_hi:[1,0]
v_mfma_f32_16x16x32_bf16 v[172:175], v[236:239], v[104:107], v[172:175]
ds_read_b128 v[232:235], v249 offset:24832
ds_read_u16_d16_hi v193, v193
v_pk_add_f16 v195, v195, 1.0 op_sel_hi:[1,0]
v_mfma_f32_16x16x32_bf16 v[180:183], v[236:239], v[108:111], v[180:183]
v_rcp_f16_e64 v202, v201
s_setprio 0
s_waitcnt lgkmcnt(7)
v_mfma_f32_16x16x32_bf16 v[168:171], v[216:219], v[112:115], v[168:171]
ds_read_b128 v[236:239], v254 offset:7952
v_rcp_f16_e64 v199, v198
v_mfma_f32_16x16x32_bf16 v[176:179], v[216:219], v[116:119], v[176:179]
v_rcp_f16_e64 v196, v195
v_mfma_f32_16x16x32_bf16 v[172:175], v[220:223], v[112:115], v[172:175]
ds_read_b128 v[216:219], v248 offset:28672
v_rcp_f16_sdwa v202, v201 dst_sel:WORD_1 dst_unused:UNUSED_PRESERVE src0_sel:WORD_1
v_mfma_f32_16x16x32_bf16 v[180:183], v[220:223], v[116:119], v[180:183]
v_rcp_f16_sdwa v199, v198 dst_sel:WORD_1 dst_unused:UNUSED_PRESERVE src0_sel:WORD_1
v_or_b32 v208, v184, v185
v_or_b32 v209, v186, v187
s_waitcnt lgkmcnt(4)
v_or_b32 v210, v188, v189
v_rcp_f16_sdwa v196, v195 dst_sel:WORD_1 dst_unused:UNUSED_PRESERVE src0_sel:WORD_1
v_or_b32 v211, v190, v191
s_waitcnt lgkmcnt(2)
v_or_b32 v212, v192, v193
v_pk_mul_f16 v213, v203, v202
v_pk_mul_f16 v214, v200, v199
v_pk_mul_f16 v215, v197, v196
s_setprio 3
v_mfma_f32_16x16x32_f16 v[48:51], v[224:227], v[208:211], v[228:231]
ds_read_b128 v[220:223], v249 offset:25600
v_cvt_pkrtz_f16_f32 v185, v168, v169
v_cvt_pkrtz_f16_f32 v187, v170, v171
v_mfma_f32_16x16x32_f16 v[56:59], v[224:227], v[212:215], v[228:231]
v_cvt_pkrtz_f16_f32 v189, v172, v173
v_cvt_pkrtz_f16_f32 v191, v174, v175
s_waitcnt lgkmcnt(2)
v_mfma_f32_16x16x32_f16 v[52:55], v[232:235], v[208:211], v[236:239]
ds_read_b128 v[224:227], v254 offset:8064
ds_read_b128 v[228:231], v248 offset:28928
v_cvt_pkrtz_f16_f32 v193, v176, v177
v_cvt_pk_f16_f32 v203, v178, v179
v_mfma_f32_16x16x32_f16 v[60:63], v[232:235], v[212:215], v[236:239]
v_cvt_pk_f16_f32 v200, v180, v181
v_cvt_pk_f16_f32 v197, v182, v183
s_waitcnt lgkmcnt(3)
v_mfma_f32_16x16x32_bf16 v[168:171], v[216:219], v[96:99], 0
ds_read_b128 v[232:235], v249 offset:25856
ds_read_b128 v[236:239], v254 offset:8080
v_pk_fma_f16 v202, v203, v203, s48
v_and_b32_e64 v185, s49, v185
v_mfma_f32_16x16x32_bf16 v[176:179], v[216:219], v[100:103], 0
v_pk_fma_f16 v199, v200, v200, s48
v_and_b32 v187, s49, v187
s_waitcnt lgkmcnt(3)
v_mfma_f32_16x16x32_f16 v[64:67], v[220:223], v[208:211], v[224:227]
ds_read_b128 v[216:219], v248 offset:29696
v_pk_fma_f16 v196, v197, v197, s48
v_bfe_u32 v184, v185, 2, 14
v_pk_mul_f16 v202, v203, v202
v_mfma_f32_16x16x32_f16 v[72:75], v[220:223], v[212:215], v[224:227]
v_bfe_u32 v186, v187, 2, 14
v_pk_mul_f16 v199, v200, v199
s_waitcnt vmcnt(6)
v_mfma_f32_16x16x32_bf16 v[136:139], v[18:21], v[244:247], v[136:139]
ds_read_b128 v[220:223], v249 offset:26624
ds_read_b128 v[224:227], v254 offset:16128
ds_read_u16_d16 v184, v184
ds_read_u16_d16 v186, v186
v_lshrrev_b32 v185, 18, v185
v_pk_mul_f16 v196, v197, v196
v_mfma_f32_16x16x32_bf16 v[140:143], v[16:19], v[244:247], v[140:143]
v_lshrrev_b32 v187, 18, v187
s_waitcnt lgkmcnt(5)
v_mfma_f32_16x16x32_bf16 v[172:175], v[228:231], v[96:99], 0
ds_read_u16_d16_hi v185, v185
ds_read_u16_d16_hi v187, v187
v_exp_f16 v201, v202
v_and_b32 v189, s49, v189
v_mfma_f32_16x16x32_bf16 v[180:183], v[228:231], v[100:103], 0
v_and_b32_e64 v191, s49, v191
v_mfma_f32_16x16x32_f16 v[68:71], v[232:235], v[208:211], v[236:239]
ds_read_b128 v[228:231], v249 offset:26880
v_exp_f16_e64 v198, v199
v_bfe_u32 v188, v189, 2, 14
v_mfma_f32_16x16x32_f16 v[76:79], v[232:235], v[212:215], v[236:239]
v_bfe_u32 v190, v191, 2, 14
v_exp_f16 v195, v196
s_waitcnt lgkmcnt(7)
v_mfma_f32_16x16x32_bf16 v[168:171], v[216:219], v[104:107], v[168:171]
ds_read_b128 v[232:235], v254 offset:16144
ds_read_b128 v[236:239], v248 offset:29952
ds_read_u16_d16 v188, v188
ds_read_u16_d16 v190, v190
v_lshrrev_b32_e64 v189, 18, v189
v_lshrrev_b32 v191, 18, v191
v_mfma_f32_16x16x32_bf16 v[176:179], v[216:219], v[108:111], v[176:179]
v_exp_f16_sdwa v201, v202 dst_sel:WORD_1 dst_unused:UNUSED_PRESERVE src0_sel:WORD_1
s_waitcnt lgkmcnt(7)
v_mfma_f32_16x16x32_f16 v[80:83], v[220:223], v[208:211], v[224:227]
ds_read_b128 v[216:219], v248 offset:30720
ds_read_u16_d16_hi v189, v189
ds_read_u16_d16_hi v191, v191
v_and_b32 v193, s49, v193
v_bfe_u32 v192, v193, 2, 14
v_mfma_f32_16x16x32_f16 v[88:91], v[220:223], v[212:215], v[224:227]
v_exp_f16_sdwa v198, v199 dst_sel:WORD_1 dst_unused:UNUSED_PRESERVE src0_sel:WORD_1
s_waitcnt lgkmcnt(6)
v_mfma_f32_16x16x32_f16 v[84:87], v[228:231], v[208:211], v[232:235]
ds_read_b128 v[220:223], v248 offset:30976
ds_read_b128 v[224:227], v249 offset:30720
ds_read_u16_d16 v192, v192
v_lshrrev_b32 v193, 18, v193
v_mfma_f32_16x16x32_f16 v[92:95], v[228:231], v[212:215], v[232:235]
v_exp_f16_sdwa v195, v196 dst_sel:WORD_1 dst_unused:UNUSED_PRESERVE src0_sel:WORD_1
v_pk_add_f16 v201, v201, 1.0 op_sel_hi:[1,0]
v_pk_add_f16 v198, v198, 1.0 op_sel_hi:[1,0]
s_waitcnt lgkmcnt(7)
v_mfma_f32_16x16x32_bf16 v[172:175], v[236:239], v[104:107], v[172:175]
ds_read_b128 v[228:231], v249 offset:30976
ds_read_b128 v[232:235], v248 offset:34816
ds_read_u16_d16_hi v193, v193
v_pk_add_f16 v195, v195, 1.0 op_sel_hi:[1,0]
v_mfma_f32_16x16x32_bf16 v[180:183], v[236:239], v[108:111], v[180:183]
v_rcp_f16 v202, v201
s_waitcnt lgkmcnt(8)
v_mfma_f32_16x16x32_bf16 v[168:171], v[216:219], v[112:115], v[168:171]
ds_read_b128 v[236:239], v249 offset:31744
v_rcp_f16_e64 v199, v198
v_mfma_f32_16x16x32_bf16 v[176:179], v[216:219], v[116:119], v[176:179]
v_rcp_f16 v196, v195
s_waitcnt lgkmcnt(6)
v_mfma_f32_16x16x32_bf16 v[172:175], v[220:223], v[112:115], v[172:175]
ds_read_b128 v[216:219], v248 offset:35072
v_rcp_f16_sdwa v202, v201 dst_sel:WORD_1 dst_unused:UNUSED_PRESERVE src0_sel:WORD_1
v_mfma_f32_16x16x32_bf16 v[180:183], v[220:223], v[116:119], v[180:183]
v_rcp_f16_sdwa v199, v198 dst_sel:WORD_1 dst_unused:UNUSED_PRESERVE src0_sel:WORD_1
v_or_b32 v208, v184, v185
v_or_b32 v209, v186, v187
v_or_b32_e64 v210, v188, v189
v_rcp_f16_sdwa v196, v195 dst_sel:WORD_1 dst_unused:UNUSED_PRESERVE src0_sel:WORD_1
v_or_b32 v211, v190, v191
s_waitcnt lgkmcnt(2)
v_or_b32_e64 v212, v192, v193
v_pk_mul_f16 v213, v203, v202
v_pk_mul_f16 v214, v200, v199
v_pk_mul_f16 v215, v197, v196
v_mfma_f32_16x16x32_f16 v[48:51], v[224:227], v[208:211], v[48:51]
s_add_u32 s46, s68, 98304
buffer_load_dwordx4 v[244:247], v252, s[4:7], s46 offen offset:128
ds_read_b128 v[220:223], v249 offset:32000
v_cvt_pkrtz_f16_f32 v185, v168, v169
v_cvt_pkrtz_f16_f32 v187, v170, v171
v_mfma_f32_16x16x32_f16 v[56:59], v[224:227], v[212:215], v[56:59]
v_cvt_pkrtz_f16_f32 v189, v172, v173
v_cvt_pkrtz_f16_f32 v191, v174, v175
v_mfma_f32_16x16x32_f16 v[52:55], v[228:231], v[208:211], v[52:55]
ds_read_b128 v[224:227], v248 offset:35840
v_cvt_pkrtz_f16_f32 v193, v176, v177
v_cvt_pk_f16_f32 v203, v178, v179
v_mfma_f32_16x16x32_f16 v[60:63], v[228:231], v[212:215], v[60:63]
v_cvt_pk_f16_f32 v200, v180, v181
v_cvt_pk_f16_f32 v197, v182, v183
v_mfma_f32_16x16x32_bf16 v[168:171], v[232:235], v[96:99], 0
ds_read_b128 v[228:231], v249 offset:32768
v_pk_fma_f16 v202, v203, v203, s48
v_and_b32_e64 v185, s49, v185
v_mfma_f32_16x16x32_bf16 v[176:179], v[232:235], v[100:103], 0
v_pk_fma_f16 v199, v200, v200, s48
v_and_b32 v187, s49, v187
s_waitcnt lgkmcnt(3)
v_mfma_f32_16x16x32_f16 v[64:67], v[236:239], v[208:211], v[64:67]
ds_read_b128 v[232:235], v249 offset:33024
v_pk_fma_f16 v196, v197, v197, s48
s_setprio 2
v_bfe_u32 v184, v185, 2, 14
v_pk_mul_f16 v202, v203, v202
v_mfma_f32_16x16x32_f16 v[72:75], v[236:239], v[212:215], v[72:75]
v_bfe_u32 v186, v187, 2, 14
v_pk_mul_f16 v199, v200, v199
s_waitcnt vmcnt(5)
v_mfma_f32_16x16x32_bf16 v[152:155], v[18:21], v[0:3], v[152:155]
ds_read_b128 v[236:239], v248 offset:36096
ds_read_u16_d16 v184, v184
ds_read_u16_d16 v186, v186
v_lshrrev_b32_e64 v185, 18, v185
v_pk_mul_f16 v196, v197, v196
v_mfma_f32_16x16x32_bf16 v[156:159], v[16:19], v[0:3], v[156:159]
v_lshrrev_b32_e64 v187, 18, v187
v_mfma_f32_16x16x32_bf16 v[172:175], v[216:219], v[96:99], 0
ds_read_u16_d16_hi v185, v185
ds_read_u16_d16_hi v187, v187
v_exp_f16 v201, v202
v_and_b32 v189, s49, v189
v_mfma_f32_16x16x32_bf16 v[180:183], v[216:219], v[100:103], 0
v_and_b32 v191, s49, v191
s_waitcnt lgkmcnt(6)
v_mfma_f32_16x16x32_f16 v[68:71], v[220:223], v[208:211], v[68:71]
ds_read_b128 v[216:219], v248 offset:36864
v_exp_f16_e64 v198, v199
v_bfe_u32 v188, v189, 2, 14
v_mfma_f32_16x16x32_f16 v[76:79], v[220:223], v[212:215], v[76:79]
v_bfe_u32 v190, v191, 2, 14
v_exp_f16_e64 v195, v196
v_mfma_f32_16x16x32_bf16 v[168:171], v[224:227], v[104:107], v[168:171]
ds_read_b128 v[220:223], v248 offset:37120
ds_read_u16_d16 v188, v188
ds_read_u16_d16 v190, v190
v_lshrrev_b32 v189, 18, v189
v_lshrrev_b32 v191, 18, v191
v_mfma_f32_16x16x32_bf16 v[176:179], v[224:227], v[108:111], v[176:179]
v_exp_f16_sdwa v201, v202 dst_sel:WORD_1 dst_unused:UNUSED_PRESERVE src0_sel:WORD_1
v_mfma_f32_16x16x32_f16 v[80:83], v[228:231], v[208:211], v[80:83]
ds_read_b128 v[224:227], v249 offset:36864
ds_read_u16_d16_hi v189, v189
ds_read_u16_d16_hi v191, v191
v_and_b32 v193, s49, v193
v_bfe_u32 v192, v193, 2, 14
v_mfma_f32_16x16x32_f16 v[88:91], v[228:231], v[212:215], v[88:91]
v_exp_f16_sdwa v198, v199 dst_sel:WORD_1 dst_unused:UNUSED_PRESERVE src0_sel:WORD_1
s_waitcnt lgkmcnt(7)
v_mfma_f32_16x16x32_f16 v[84:87], v[232:235], v[208:211], v[84:87]
ds_read_b128 v[228:231], v249 offset:37120
ds_read_u16_d16 v192, v192
v_lshrrev_b32_e64 v193, 18, v193
v_mfma_f32_16x16x32_f16 v[92:95], v[232:235], v[212:215], v[92:95]
v_exp_f16_sdwa v195, v196 dst_sel:WORD_1 dst_unused:UNUSED_PRESERVE src0_sel:WORD_1
v_pk_add_f16 v201, v201, 1.0 op_sel_hi:[1,0]
v_pk_add_f16 v198, v198, 1.0 op_sel_hi:[1,0]
v_mfma_f32_16x16x32_bf16 v[172:175], v[236:239], v[104:107], v[172:175]
ds_read_b128 v[232:235], v248 offset:40960
ds_read_u16_d16_hi v193, v193
v_pk_add_f16 v195, v195, 1.0 op_sel_hi:[1,0]
v_mfma_f32_16x16x32_bf16 v[180:183], v[236:239], v[108:111], v[180:183]
v_rcp_f16 v202, v201
s_waitcnt lgkmcnt(7)
v_mfma_f32_16x16x32_bf16 v[168:171], v[216:219], v[112:115], v[168:171]
ds_read_b128 v[236:239], v249 offset:37888
v_rcp_f16_e64 v199, v198
v_mfma_f32_16x16x32_bf16 v[176:179], v[216:219], v[116:119], v[176:179]
v_rcp_f16_e64 v196, v195
v_mfma_f32_16x16x32_bf16 v[172:175], v[220:223], v[112:115], v[172:175]
ds_read_b128 v[216:219], v248 offset:41216
v_rcp_f16_sdwa v202, v201 dst_sel:WORD_1 dst_unused:UNUSED_PRESERVE src0_sel:WORD_1
v_mfma_f32_16x16x32_bf16 v[180:183], v[220:223], v[116:119], v[180:183]
v_rcp_f16_sdwa v199, v198 dst_sel:WORD_1 dst_unused:UNUSED_PRESERVE src0_sel:WORD_1
v_or_b32 v208, v184, v185
v_or_b32 v209, v186, v187
s_waitcnt lgkmcnt(4)
v_or_b32 v210, v188, v189
v_rcp_f16_sdwa v196, v195 dst_sel:WORD_1 dst_unused:UNUSED_PRESERVE src0_sel:WORD_1
v_or_b32 v211, v190, v191
s_waitcnt lgkmcnt(2)
v_or_b32_e64 v212, v192, v193
v_pk_mul_f16 v213, v203, v202
v_pk_mul_f16 v214, v200, v199
v_pk_mul_f16 v215, v197, v196
v_mfma_f32_16x16x32_f16 v[48:51], v[224:227], v[208:211], v[48:51]
buffer_load_dwordx4 v[0:3], v252, s[4:7], s69 offen
ds_read_b128 v[220:223], v249 offset:38144
v_cvt_pkrtz_f16_f32 v185, v168, v169
v_cvt_pkrtz_f16_f32 v187, v170, v171
v_cvt_pkrtz_f16_f32 v189, v172, v173
v_mfma_f32_16x16x32_f16 v[56:59], v[224:227], v[212:215], v[56:59]
v_cvt_pkrtz_f16_f32 v191, v174, v175
v_cvt_pkrtz_f16_f32 v193, v176, v177
v_cvt_pk_f16_f32 v203, v178, v179
v_mfma_f32_16x16x32_f16 v[52:55], v[228:231], v[208:211], v[52:55]
ds_read_b128 v[224:227], v248 offset:41984
v_cvt_pk_f16_f32 v200, v180, v181
v_cvt_pk_f16_f32 v197, v182, v183
v_pk_fma_f16 v202, v203, v203, s48
s_setprio 1
v_cvt_pk_bf16_f32 v136, v136, v137
v_mfma_f32_16x16x32_f16 v[60:63], v[228:231], v[212:215], v[60:63]
v_and_b32 v185, s49, v185
v_cvt_pk_bf16_f32 v137, v138, v139
v_pk_fma_f16 v199, v200, v200, s48
v_mfma_f32_16x16x32_bf16 v[168:171], v[232:235], v[96:99], 0
ds_read_b128 v[228:231], v249 offset:38912
v_and_b32 v187, s49, v187
v_cvt_pk_bf16_f32 v138, v140, v141
v_pk_fma_f16 v196, v197, v197, s48
v_mfma_f32_16x16x32_bf16 v[176:179], v[232:235], v[100:103], 0
v_cvt_pk_bf16_f32 v139, v142, v143
v_bfe_u32 v184, v185, 2, 14
v_pk_mul_f16 v202, v203, v202
v_cvt_pk_bf16_f32 v120, v120, v121
s_waitcnt lgkmcnt(2)
v_mfma_f32_16x16x32_f16 v[64:67], v[236:239], v[208:211], v[64:67]
ds_read_b128 v[232:235], v249 offset:39168
ds_read_u16_d16 v184, v184
v_bfe_u32 v186, v187, 2, 14
v_cvt_pk_bf16_f32 v121, v122, v123
v_pk_mul_f16 v199, v200, v199
v_mfma_f32_16x16x32_f16 v[72:75], v[236:239], v[212:215], v[72:75]
v_lshrrev_b32_e64 v185, 18, v185
v_cvt_pk_bf16_f32 v122, v124, v125
v_pk_mul_f16 v196, v197, v196
v_mfma_f32_16x16x32_bf16 v[172:175], v[216:219], v[96:99], 0
ds_read_b128 v[236:239], v248 offset:42240
ds_read_u16_d16 v186, v186
ds_read_u16_d16_hi v185, v185
v_lshrrev_b32_e64 v187, 18, v187
v_cvt_pk_bf16_f32 v123, v126, v127
v_exp_f16_e64 v201, v202
v_mfma_f32_16x16x32_bf16 v[180:183], v[216:219], v[100:103], 0
v_cvt_pk_bf16_f32 v152, v152, v153
v_and_b32_e64 v189, s49, v189
v_cvt_pk_bf16_f32 v153, v154, v155
v_mfma_f32_16x16x32_f16 v[68:71], v[220:223], v[208:211], v[68:71]
ds_read_b128 v[216:219], v248 offset:43008
ds_read_u16_d16_hi v187, v187
v_and_b32_e64 v191, s49, v191
v_cvt_pk_bf16_f32 v154, v156, v157
v_mfma_f32_16x16x32_f16 v[76:79], v[220:223], v[212:215], v[76:79]
v_exp_f16_e64 v198, v199
v_cvt_pk_bf16_f32 v155, v158, v159
s_mov_b64 vcc, s[74:75]
v_bfe_u32 v188, v189, 2, 14
v_bfe_u32 v190, v191, 2, 14
s_waitcnt lgkmcnt(5)
v_mfma_f32_16x16x32_bf16 v[168:171], v[224:227], v[104:107], v[168:171]
ds_read_b128 v[220:223], v248 offset:43264
ds_read_u16_d16 v188, v188
ds_read_u16_d16 v190, v190
v_cndmask_b32 v140, v120, v152, vcc
v_exp_f16 v195, v196
v_mfma_f32_16x16x32_bf16 v[176:179], v[224:227], v[108:111], v[176:179]
v_cndmask_b32 v141, v121, v153, vcc
v_lshrrev_b32_e64 v189, 18, v189
v_cndmask_b32 v142, v122, v154, vcc
v_mfma_f32_16x16x32_f16 v[80:83], v[228:231], v[208:211], v[80:83]
ds_read_b128 v[224:227], v249 offset:43008
ds_read_u16_d16_hi v189, v189
v_lshrrev_b32 v191, 18, v191
v_cndmask_b32 v143, v123, v155, vcc
v_exp_f16_sdwa v201, v202 dst_sel:WORD_1 dst_unused:UNUSED_PRESERVE src0_sel:WORD_1
v_mfma_f32_16x16x32_f16 v[88:91], v[228:231], v[212:215], v[88:91]
v_cndmask_b32_dpp v120, v136, v120, vcc quad_perm:[1,0,3,2] row_mask:0xf bank_mask:0xf
v_and_b32_e64 v193, s49, v193
v_cndmask_b32_dpp v121, v137, v121, vcc quad_perm:[1,0,3,2] row_mask:0xf bank_mask:0xf
v_mfma_f32_16x16x32_f16 v[84:87], v[232:235], v[208:211], v[84:87]
ds_read_b128 v[228:231], v249 offset:43264
ds_read_u16_d16_hi v191, v191
v_bfe_u32 v192, v193, 2, 14
v_exp_f16_sdwa v198, v199 dst_sel:WORD_1 dst_unused:UNUSED_PRESERVE src0_sel:WORD_1
v_mfma_f32_16x16x32_f16 v[92:95], v[232:235], v[212:215], v[92:95]
v_cndmask_b32_dpp v122, v138, v122, vcc quad_perm:[1,0,3,2] row_mask:0xf bank_mask:0xf
v_lshrrev_b32 v193, 18, v193
v_cndmask_b32_dpp v123, v139, v123, vcc quad_perm:[1,0,3,2] row_mask:0xf bank_mask:0xf
s_not_b64 vcc, s[74:75]
s_waitcnt lgkmcnt(4)
v_mfma_f32_16x16x32_bf16 v[172:175], v[236:239], v[104:107], v[172:175]
ds_read_b128 v[232:235], v248 offset:47104
ds_read_u16_d16 v192, v192
ds_read_u16_d16_hi v193, v193
v_exp_f16_sdwa v195, v196 dst_sel:WORD_1 dst_unused:UNUSED_PRESERVE src0_sel:WORD_1
v_cndmask_b32_dpp v152, v136, v152, vcc quad_perm:[1,0,3,2] row_mask:0xf bank_mask:0xf
s_setprio 0
v_pk_add_f16 v201, v201, 1.0 op_sel_hi:[1,0]
v_mfma_f32_16x16x32_bf16 v[180:183], v[236:239], v[108:111], v[180:183]
v_cndmask_b32_dpp v153, v137, v153, vcc quad_perm:[1,0,3,2] row_mask:0xf bank_mask:0xf
v_pk_add_f16 v198, v198, 1.0 op_sel_hi:[1,0]
v_cndmask_b32_dpp v154, v138, v154, vcc quad_perm:[1,0,3,2] row_mask:0xf bank_mask:0xf
v_mfma_f32_16x16x32_bf16 v[168:171], v[216:219], v[112:115], v[168:171]
ds_read_b128 v[236:239], v249 offset:44032
v_pk_add_f16 v195, v195, 1.0 op_sel_hi:[1,0]
v_rcp_f16_e64 v202, v201
v_cndmask_b32_dpp v155, v139, v155, vcc quad_perm:[1,0,3,2] row_mask:0xf bank_mask:0xf
v_mfma_f32_16x16x32_bf16 v[176:179], v[216:219], v[116:119], v[176:179]
v_rcp_f16_e64 v199, v198
v_mfma_f32_16x16x32_bf16 v[172:175], v[220:223], v[112:115], v[172:175]
ds_read_b128 v[216:219], v248 offset:47360
buffer_store_dwordx4 v[120:123], v255, s[8:11], s68 offen sc1
v_rcp_f16_e64 v196, v195
v_rcp_f16_sdwa v202, v201 dst_sel:WORD_1 dst_unused:UNUSED_PRESERVE src0_sel:WORD_1
v_mfma_f32_16x16x32_bf16 v[180:183], v[220:223], v[116:119], v[180:183]
v_rcp_f16_sdwa v199, v198 dst_sel:WORD_1 dst_unused:UNUSED_PRESERVE src0_sel:WORD_1
v_or_b32 v208, v184, v185
v_or_b32 v209, v186, v187
s_waitcnt lgkmcnt(2)
v_or_b32 v210, v188, v189
v_rcp_f16_sdwa v196, v195 dst_sel:WORD_1 dst_unused:UNUSED_PRESERVE src0_sel:WORD_1
v_or_b32_e64 v211, v190, v191
v_or_b32 v212, v192, v193
v_pk_mul_f16 v213, v203, v202
v_pk_mul_f16 v214, v200, v199
v_pk_mul_f16 v215, v197, v196
s_setprio 3
v_mfma_f32_16x16x32_f16 v[48:51], v[224:227], v[208:211], v[48:51]
buffer_load_dwordx4 v[204:207], v252, s[4:7], s69 offen offset:64
ds_read_b128 v[220:223], v249 offset:44288
v_cvt_pkrtz_f16_f32 v185, v168, v169
v_cvt_pkrtz_f16_f32 v187, v170, v171
v_mfma_f32_16x16x32_f16 v[56:59], v[224:227], v[212:215], v[56:59]
v_cvt_pkrtz_f16_f32 v189, v172, v173
v_cvt_pkrtz_f16_f32 v191, v174, v175
v_mfma_f32_16x16x32_f16 v[52:55], v[228:231], v[208:211], v[52:55]
ds_read_b128 v[224:227], v248 offset:48128
v_cvt_pkrtz_f16_f32 v193, v176, v177
v_cvt_pk_f16_f32 v203, v178, v179
v_mfma_f32_16x16x32_f16 v[60:63], v[228:231], v[212:215], v[60:63]
v_cvt_pk_f16_f32 v200, v180, v181
v_cvt_pk_f16_f32 v197, v182, v183
v_mfma_f32_16x16x32_bf16 v[168:171], v[232:235], v[96:99], 0
ds_read_b128 v[228:231], v249 offset:45056
v_pk_fma_f16 v202, v203, v203, s48
v_and_b32_e64 v185, s49, v185
v_mfma_f32_16x16x32_bf16 v[176:179], v[232:235], v[100:103], 0
v_pk_fma_f16 v199, v200, v200, s48
v_and_b32 v187, s49, v187
s_waitcnt lgkmcnt(3)
v_mfma_f32_16x16x32_f16 v[64:67], v[236:239], v[208:211], v[64:67]
ds_read_b128 v[232:235], v249 offset:45312
v_pk_fma_f16 v196, v197, v197, s48
v_bfe_u32 v184, v185, 2, 14
v_pk_mul_f16 v202, v203, v202
v_mfma_f32_16x16x32_f16 v[72:75], v[236:239], v[212:215], v[72:75]
v_bfe_u32 v186, v187, 2, 14
v_pk_mul_f16 v199, v200, v199
s_waitcnt vmcnt(7)
v_mfma_f32_16x16x32_bf16 v[128:131], v[18:21], v[4:7], v[128:131]
ds_read_b128 v[236:239], v248 offset:48384
ds_read_u16_d16 v184, v184
ds_read_u16_d16 v186, v186
v_lshrrev_b32 v185, 18, v185
v_pk_mul_f16 v196, v197, v196
v_mfma_f32_16x16x32_bf16 v[132:135], v[16:19], v[4:7], v[132:135]
v_lshrrev_b32_e64 v187, 18, v187
v_mfma_f32_16x16x32_bf16 v[172:175], v[216:219], v[96:99], 0
ds_read_u16_d16_hi v185, v185
ds_read_u16_d16_hi v187, v187
v_exp_f16 v201, v202
v_and_b32 v189, s49, v189
v_mfma_f32_16x16x32_bf16 v[180:183], v[216:219], v[100:103], 0
v_and_b32 v191, s49, v191
s_waitcnt lgkmcnt(6)
v_mfma_f32_16x16x32_f16 v[68:71], v[220:223], v[208:211], v[68:71]
ds_read_b128 v[216:219], v248 offset:49152
v_exp_f16_e64 v198, v199
v_bfe_u32 v188, v189, 2, 14
v_mfma_f32_16x16x32_f16 v[76:79], v[220:223], v[212:215], v[76:79]
v_bfe_u32 v190, v191, 2, 14
v_exp_f16_e64 v195, v196
v_mfma_f32_16x16x32_bf16 v[168:171], v[224:227], v[104:107], v[168:171]
buffer_store_dwordx4 v[140:143], v255, s[8:11], s68 offen offset:128 sc1
ds_read_b128 v[220:223], v248 offset:49408
ds_read_u16_d16 v188, v188
ds_read_u16_d16 v190, v190
v_lshrrev_b32 v189, 18, v189
v_lshrrev_b32 v191, 18, v191
v_mfma_f32_16x16x32_bf16 v[176:179], v[224:227], v[108:111], v[176:179]
v_exp_f16_sdwa v201, v202 dst_sel:WORD_1 dst_unused:UNUSED_PRESERVE src0_sel:WORD_1
v_mfma_f32_16x16x32_f16 v[80:83], v[228:231], v[208:211], v[80:83]
ds_read_b128 v[224:227], v249 offset:49152
ds_read_u16_d16_hi v189, v189
ds_read_u16_d16_hi v191, v191
v_and_b32 v193, s49, v193
v_bfe_u32 v192, v193, 2, 14
v_mfma_f32_16x16x32_f16 v[88:91], v[228:231], v[212:215], v[88:91]
v_exp_f16_sdwa v198, v199 dst_sel:WORD_1 dst_unused:UNUSED_PRESERVE src0_sel:WORD_1
s_waitcnt lgkmcnt(7)
v_mfma_f32_16x16x32_f16 v[84:87], v[232:235], v[208:211], v[84:87]
ds_read_b128 v[228:231], v249 offset:49408
ds_read_u16_d16 v192, v192
v_lshrrev_b32_e64 v193, 18, v193
v_mfma_f32_16x16x32_f16 v[92:95], v[232:235], v[212:215], v[92:95]
v_exp_f16_sdwa v195, v196 dst_sel:WORD_1 dst_unused:UNUSED_PRESERVE src0_sel:WORD_1
v_pk_add_f16 v201, v201, 1.0 op_sel_hi:[1,0]
v_pk_add_f16 v198, v198, 1.0 op_sel_hi:[1,0]
v_mfma_f32_16x16x32_bf16 v[172:175], v[236:239], v[104:107], v[172:175]
ds_read_b128 v[232:235], v248 offset:53248
ds_read_u16_d16_hi v193, v193
v_pk_add_f16 v195, v195, 1.0 op_sel_hi:[1,0]
v_mfma_f32_16x16x32_bf16 v[180:183], v[236:239], v[108:111], v[180:183]
v_rcp_f16 v202, v201
s_waitcnt lgkmcnt(7)
v_mfma_f32_16x16x32_bf16 v[168:171], v[216:219], v[112:115], v[168:171]
ds_read_b128 v[236:239], v249 offset:50176
v_rcp_f16_e64 v199, v198
v_mfma_f32_16x16x32_bf16 v[176:179], v[216:219], v[116:119], v[176:179]
v_rcp_f16_e64 v196, v195
v_mfma_f32_16x16x32_bf16 v[172:175], v[220:223], v[112:115], v[172:175]
ds_read_b128 v[216:219], v248 offset:53504
v_rcp_f16_sdwa v202, v201 dst_sel:WORD_1 dst_unused:UNUSED_PRESERVE src0_sel:WORD_1
v_mfma_f32_16x16x32_bf16 v[180:183], v[220:223], v[116:119], v[180:183]
v_rcp_f16_sdwa v199, v198 dst_sel:WORD_1 dst_unused:UNUSED_PRESERVE src0_sel:WORD_1
v_or_b32 v208, v184, v185
v_or_b32 v209, v186, v187
s_waitcnt lgkmcnt(4)
v_or_b32 v210, v188, v189
v_rcp_f16_sdwa v196, v195 dst_sel:WORD_1 dst_unused:UNUSED_PRESERVE src0_sel:WORD_1
v_or_b32 v211, v190, v191
s_waitcnt lgkmcnt(2)
v_or_b32_e64 v212, v192, v193
v_pk_mul_f16 v213, v203, v202
v_pk_mul_f16 v214, v200, v199
v_pk_mul_f16 v215, v197, v196
v_mfma_f32_16x16x32_f16 v[48:51], v[224:227], v[208:211], v[48:51]
buffer_load_dwordx4 v[4:7], v252, s[4:7], s69 offen offset:128
ds_read_b128 v[220:223], v249 offset:50432
v_cvt_pkrtz_f16_f32 v185, v168, v169
v_cvt_pkrtz_f16_f32 v187, v170, v171
v_mfma_f32_16x16x32_f16 v[56:59], v[224:227], v[212:215], v[56:59]
v_cvt_pkrtz_f16_f32 v189, v172, v173
v_cvt_pkrtz_f16_f32 v191, v174, v175
v_mfma_f32_16x16x32_f16 v[52:55], v[228:231], v[208:211], v[52:55]
ds_read_b128 v[224:227], v248 offset:54272
v_cvt_pkrtz_f16_f32 v193, v176, v177
v_cvt_pk_f16_f32 v203, v178, v179
v_mfma_f32_16x16x32_f16 v[60:63], v[228:231], v[212:215], v[60:63]
v_cvt_pk_f16_f32 v200, v180, v181
v_cvt_pk_f16_f32 v197, v182, v183
v_mfma_f32_16x16x32_bf16 v[168:171], v[232:235], v[96:99], 0
ds_read_b128 v[228:231], v249 offset:51200
v_pk_fma_f16 v202, v203, v203, s48
v_and_b32_e64 v185, s49, v185
v_mfma_f32_16x16x32_bf16 v[176:179], v[232:235], v[100:103], 0
v_pk_fma_f16 v199, v200, v200, s48
v_and_b32 v187, s49, v187
s_waitcnt lgkmcnt(3)
v_mfma_f32_16x16x32_f16 v[64:67], v[236:239], v[208:211], v[64:67]
ds_read_b128 v[232:235], v249 offset:51456
v_pk_fma_f16 v196, v197, v197, s48
s_setprio 2
v_bfe_u32 v184, v185, 2, 14
v_pk_mul_f16 v202, v203, v202
v_mfma_f32_16x16x32_f16 v[72:75], v[236:239], v[212:215], v[72:75]
v_bfe_u32 v186, v187, 2, 14
v_pk_mul_f16 v199, v200, v199
s_waitcnt vmcnt(7)
v_mfma_f32_16x16x32_bf16 v[144:147], v[18:21], v[44:47], v[144:147]
ds_read_b128 v[236:239], v248 offset:54528
ds_read_u16_d16 v184, v184
ds_read_u16_d16 v186, v186
v_lshrrev_b32_e64 v185, 18, v185
v_pk_mul_f16 v196, v197, v196
v_mfma_f32_16x16x32_bf16 v[148:151], v[16:19], v[44:47], v[148:151]
v_lshrrev_b32_e64 v187, 18, v187
v_mfma_f32_16x16x32_bf16 v[172:175], v[216:219], v[96:99], 0
ds_read_u16_d16_hi v185, v185
ds_read_u16_d16_hi v187, v187
v_exp_f16 v201, v202
v_and_b32 v189, s49, v189
v_mfma_f32_16x16x32_bf16 v[180:183], v[216:219], v[100:103], 0
v_and_b32 v191, s49, v191
s_waitcnt lgkmcnt(6)
v_mfma_f32_16x16x32_f16 v[68:71], v[220:223], v[208:211], v[68:71]
ds_read_b128 v[216:219], v248 offset:55296
v_exp_f16_e64 v198, v199
v_bfe_u32 v188, v189, 2, 14
v_mfma_f32_16x16x32_f16 v[76:79], v[220:223], v[212:215], v[76:79]
v_bfe_u32 v190, v191, 2, 14
v_exp_f16_e64 v195, v196
v_mfma_f32_16x16x32_bf16 v[168:171], v[224:227], v[104:107], v[168:171]
ds_read_b128 v[220:223], v248 offset:55552
ds_read_u16_d16 v188, v188
ds_read_u16_d16 v190, v190
v_lshrrev_b32 v189, 18, v189
v_lshrrev_b32 v191, 18, v191
v_mfma_f32_16x16x32_bf16 v[176:179], v[224:227], v[108:111], v[176:179]
v_exp_f16_sdwa v201, v202 dst_sel:WORD_1 dst_unused:UNUSED_PRESERVE src0_sel:WORD_1
v_mfma_f32_16x16x32_f16 v[80:83], v[228:231], v[208:211], v[80:83]
ds_read_b128 v[224:227], v249 offset:55296
ds_read_u16_d16_hi v189, v189
ds_read_u16_d16_hi v191, v191
v_and_b32 v193, s49, v193
v_bfe_u32 v192, v193, 2, 14
v_mfma_f32_16x16x32_f16 v[88:91], v[228:231], v[212:215], v[88:91]
v_exp_f16_sdwa v198, v199 dst_sel:WORD_1 dst_unused:UNUSED_PRESERVE src0_sel:WORD_1
s_waitcnt lgkmcnt(7)
v_mfma_f32_16x16x32_f16 v[84:87], v[232:235], v[208:211], v[84:87]
ds_read_b128 v[228:231], v249 offset:55552
ds_read_u16_d16 v192, v192
v_lshrrev_b32_e64 v193, 18, v193
v_mfma_f32_16x16x32_f16 v[92:95], v[232:235], v[212:215], v[92:95]
v_exp_f16_sdwa v195, v196 dst_sel:WORD_1 dst_unused:UNUSED_PRESERVE src0_sel:WORD_1
v_pk_add_f16 v201, v201, 1.0 op_sel_hi:[1,0]
v_pk_add_f16 v198, v198, 1.0 op_sel_hi:[1,0]
v_mfma_f32_16x16x32_bf16 v[172:175], v[236:239], v[104:107], v[172:175]
ds_read_b128 v[232:235], v248 offset:59392
ds_read_u16_d16_hi v193, v193
v_pk_add_f16 v195, v195, 1.0 op_sel_hi:[1,0]
v_mfma_f32_16x16x32_bf16 v[180:183], v[236:239], v[108:111], v[180:183]
v_rcp_f16 v202, v201
s_waitcnt lgkmcnt(7)
v_mfma_f32_16x16x32_bf16 v[168:171], v[216:219], v[112:115], v[168:171]
ds_read_b128 v[236:239], v249 offset:56320
v_rcp_f16_e64 v199, v198
v_mfma_f32_16x16x32_bf16 v[176:179], v[216:219], v[116:119], v[176:179]
v_rcp_f16_e64 v196, v195
v_mfma_f32_16x16x32_bf16 v[172:175], v[220:223], v[112:115], v[172:175]
ds_read_b128 v[216:219], v248 offset:59648
v_rcp_f16_sdwa v202, v201 dst_sel:WORD_1 dst_unused:UNUSED_PRESERVE src0_sel:WORD_1
v_mfma_f32_16x16x32_bf16 v[180:183], v[220:223], v[116:119], v[180:183]
v_rcp_f16_sdwa v199, v198 dst_sel:WORD_1 dst_unused:UNUSED_PRESERVE src0_sel:WORD_1
v_or_b32 v208, v184, v185
v_or_b32 v209, v186, v187
s_waitcnt lgkmcnt(4)
v_or_b32 v210, v188, v189
v_rcp_f16_sdwa v196, v195 dst_sel:WORD_1 dst_unused:UNUSED_PRESERVE src0_sel:WORD_1
v_or_b32 v211, v190, v191
s_waitcnt lgkmcnt(2)
v_or_b32_e64 v212, v192, v193
v_pk_mul_f16 v213, v203, v202
v_pk_mul_f16 v214, v200, v199
v_pk_mul_f16 v215, v197, v196
v_mfma_f32_16x16x32_f16 v[48:51], v[224:227], v[208:211], v[48:51]
s_add_u32 s46, s69, 98304
buffer_load_dwordx4 v[44:47], v252, s[4:7], s46 offen
ds_read_b128 v[220:223], v249 offset:56576
v_cvt_pkrtz_f16_f32 v185, v168, v169
v_cvt_pkrtz_f16_f32 v187, v170, v171
v_mfma_f32_16x16x32_f16 v[56:59], v[224:227], v[212:215], v[56:59]
v_cvt_pkrtz_f16_f32 v189, v172, v173
v_cvt_pkrtz_f16_f32 v191, v174, v175
v_mfma_f32_16x16x32_f16 v[52:55], v[228:231], v[208:211], v[52:55]
ds_read_b128 v[224:227], v248 offset:60416
v_cvt_pkrtz_f16_f32 v193, v176, v177
v_cvt_pk_f16_f32 v203, v178, v179
v_cvt_pk_f16_f32 v200, v180, v181
v_mfma_f32_16x16x32_f16 v[60:63], v[228:231], v[212:215], v[60:63]
v_cvt_pk_f16_f32 v197, v182, v183
s_setprio 1
v_pk_fma_f16 v202, v203, v203, s48
v_mfma_f32_16x16x32_bf16 v[168:171], v[232:235], v[96:99], 0
ds_read_b128 v[228:231], v249 offset:57344
v_and_b32 v185, s49, v185
v_pk_fma_f16 v199, v200, v200, s48
v_mfma_f32_16x16x32_bf16 v[176:179], v[232:235], v[100:103], 0
v_and_b32 v187, s49, v187
v_pk_fma_f16 v196, v197, v197, s48
v_bfe_u32 v184, v185, 2, 14
s_waitcnt lgkmcnt(3)
v_mfma_f32_16x16x32_f16 v[64:67], v[236:239], v[208:211], v[64:67]
ds_read_b128 v[232:235], v249 offset:57600
ds_read_u16_d16 v184, v184
v_pk_mul_f16 v202, v203, v202
v_bfe_u32 v186, v187, 2, 14
v_mfma_f32_16x16x32_f16 v[72:75], v[236:239], v[212:215], v[72:75]
v_pk_mul_f16 v199, v200, v199
v_lshrrev_b32_e64 v185, 18, v185
v_mfma_f32_16x16x32_bf16 v[172:175], v[216:219], v[96:99], 0
ds_read_b128 v[236:239], v248 offset:60672
ds_read_u16_d16 v186, v186
ds_read_u16_d16_hi v185, v185
v_pk_mul_f16 v196, v197, v196
v_lshrrev_b32_e64 v187, 18, v187
v_mfma_f32_16x16x32_bf16 v[180:183], v[216:219], v[100:103], 0
v_exp_f16_e64 v201, v202
v_and_b32 v189, s49, v189
s_waitcnt lgkmcnt(5)
v_mfma_f32_16x16x32_f16 v[68:71], v[220:223], v[208:211], v[68:71]
ds_read_b128 v[216:219], v248 offset:61440
ds_read_u16_d16_hi v187, v187
v_and_b32_e64 v191, s49, v191
v_mfma_f32_16x16x32_f16 v[76:79], v[220:223], v[212:215], v[76:79]
v_exp_f16_e64 v198, v199
v_bfe_u32 v188, v189, 2, 14
v_bfe_u32 v190, v191, 2, 14
v_mfma_f32_16x16x32_bf16 v[168:171], v[224:227], v[104:107], v[168:171]
buffer_store_dwordx4 v[152:155], v255, s[8:11], s68 offen offset:256 sc1
ds_read_b128 v[220:223], v248 offset:61696
ds_read_u16_d16 v188, v188
ds_read_u16_d16 v190, v190
v_exp_f16_e64 v195, v196
v_mfma_f32_16x16x32_bf16 v[176:179], v[224:227], v[108:111], v[176:179]
v_lshrrev_b32 v189, 18, v189
v_lshrrev_b32 v191, 18, v191
v_mfma_f32_16x16x32_f16 v[80:83], v[228:231], v[208:211], v[80:83]
ds_read_b128 v[224:227], v249 offset:61440
ds_read_u16_d16_hi v189, v189
ds_read_u16_d16_hi v191, v191
v_exp_f16_sdwa v201, v202 dst_sel:WORD_1 dst_unused:UNUSED_PRESERVE src0_sel:WORD_1
v_and_b32 v193, s49, v193
v_mfma_f32_16x16x32_f16 v[88:91], v[228:231], v[212:215], v[88:91]
v_bfe_u32 v192, v193, 2, 14
s_waitcnt lgkmcnt(8)
v_mfma_f32_16x16x32_f16 v[84:87], v[232:235], v[208:211], v[84:87]
ds_read_b128 v[228:231], v249 offset:61696
ds_read_u16_d16 v192, v192
v_exp_f16_sdwa v198, v199 dst_sel:WORD_1 dst_unused:UNUSED_PRESERVE src0_sel:WORD_1
v_lshrrev_b32_e64 v193, 18, v193
v_mfma_f32_16x16x32_f16 v[92:95], v[232:235], v[212:215], v[92:95]
v_exp_f16_sdwa v195, v196 dst_sel:WORD_1 dst_unused:UNUSED_PRESERVE src0_sel:WORD_1
v_pk_add_f16 v201, v201, 1.0 op_sel_hi:[1,0]
v_mfma_f32_16x16x32_bf16 v[172:175], v[236:239], v[104:107], v[172:175]
ds_read_b128 v[232:235], v249
ds_read_u16_d16_hi v193, v193
v_pk_add_f16 v198, v198, 1.0 op_sel_hi:[1,0]
v_pk_add_f16 v195, v195, 1.0 op_sel_hi:[1,0]
v_mfma_f32_16x16x32_bf16 v[180:183], v[236:239], v[108:111], v[180:183]
v_rcp_f16_e64 v202, v201
s_setprio 0
s_waitcnt lgkmcnt(7)
v_mfma_f32_16x16x32_bf16 v[168:171], v[216:219], v[112:115], v[168:171]
ds_read_b128 v[236:239], v249 offset:62464
v_rcp_f16_e64 v199, v198
v_mfma_f32_16x16x32_bf16 v[176:179], v[216:219], v[116:119], v[176:179]
v_rcp_f16_e64 v196, v195
v_mfma_f32_16x16x32_bf16 v[172:175], v[220:223], v[112:115], v[172:175]
ds_read_b128 v[216:219], v249 offset:256
v_rcp_f16_sdwa v202, v201 dst_sel:WORD_1 dst_unused:UNUSED_PRESERVE src0_sel:WORD_1
v_mfma_f32_16x16x32_bf16 v[180:183], v[220:223], v[116:119], v[180:183]
v_rcp_f16_sdwa v199, v198 dst_sel:WORD_1 dst_unused:UNUSED_PRESERVE src0_sel:WORD_1
v_or_b32 v208, v184, v185
v_or_b32 v209, v186, v187
s_waitcnt lgkmcnt(4)
v_or_b32 v210, v188, v189
v_rcp_f16_sdwa v196, v195 dst_sel:WORD_1 dst_unused:UNUSED_PRESERVE src0_sel:WORD_1
v_or_b32 v211, v190, v191
s_waitcnt lgkmcnt(2)
v_or_b32_e64 v212, v192, v193
v_pk_mul_f16 v213, v203, v202
v_pk_mul_f16 v214, v200, v199
v_pk_mul_f16 v215, v197, v196
v_mfma_f32_16x16x32_f16 v[48:51], v[224:227], v[208:211], v[48:51]
s_add_u32 s46, s69, 98304
buffer_load_dwordx4 v[40:43], v252, s[4:7], s46 offen offset:64
ds_read_b128 v[220:223], v249 offset:62720
v_cvt_pkrtz_f16_f32 v185, v168, v169
v_cvt_pkrtz_f16_f32 v187, v170, v171
v_mfma_f32_16x16x32_f16 v[56:59], v[224:227], v[212:215], v[56:59]
v_cvt_pkrtz_f16_f32 v189, v172, v173
v_cvt_pkrtz_f16_f32 v191, v174, v175
v_mfma_f32_16x16x32_f16 v[52:55], v[228:231], v[208:211], v[52:55]
ds_read_b128 v[224:227], v249 offset:1024
v_cvt_pkrtz_f16_f32 v193, v176, v177
v_cvt_pk_f16_f32 v203, v178, v179
v_mfma_f32_16x16x32_f16 v[60:63], v[228:231], v[212:215], v[60:63]
v_cvt_pk_f16_f32 v200, v180, v181
v_cvt_pk_f16_f32 v197, v182, v183
v_mfma_f32_16x16x32_bf16 v[168:171], v[232:235], v[96:99], 0
ds_read_b128 v[228:231], v249 offset:63488
v_pk_fma_f16 v202, v203, v203, s48
v_and_b32_e64 v185, s49, v185
v_mfma_f32_16x16x32_bf16 v[176:179], v[232:235], v[100:103], 0
v_pk_fma_f16 v199, v200, v200, s48
v_and_b32 v187, s49, v187
s_waitcnt lgkmcnt(3)
v_mfma_f32_16x16x32_f16 v[64:67], v[236:239], v[208:211], v[64:67]
ds_read_b128 v[232:235], v249 offset:63744
v_pk_fma_f16 v196, v197, v197, s48
v_bfe_u32 v184, v185, 2, 14
v_mfma_f32_16x16x32_f16 v[72:75], v[236:239], v[212:215], v[72:75]
v_pk_mul_f16 v202, v203, v202
v_bfe_u32 v186, v187, 2, 14
s_waitcnt vmcnt(8)
v_mfma_f32_16x16x32_bf16 v[160:163], v[18:21], v[244:247], v[160:163]
ds_read_b128 v[236:239], v249 offset:1280
ds_read_u16_d16 v184, v184
ds_read_u16_d16 v186, v186
v_pk_mul_f16 v199, v200, v199
v_lshrrev_b32 v185, 18, v185
v_mfma_f32_16x16x32_bf16 v[164:167], v[16:19], v[244:247], v[164:167]
v_pk_mul_f16 v196, v197, v196
v_lshrrev_b32_e64 v187, 18, v187
v_mfma_f32_16x16x32_bf16 v[172:175], v[216:219], v[96:99], 0
ds_read_u16_d16_hi v185, v185
ds_read_u16_d16_hi v187, v187
v_exp_f16_e64 v201, v202
v_mfma_f32_16x16x32_bf16 v[180:183], v[216:219], v[100:103], 0
v_and_b32_e64 v189, s49, v189
v_and_b32 v191, s49, v191
s_waitcnt lgkmcnt(6)
v_mfma_f32_16x16x32_f16 v[68:71], v[220:223], v[208:211], v[68:71]
ds_read_b128 v[216:219], v249 offset:2048
v_exp_f16_e64 v198, v199
v_mfma_f32_16x16x32_f16 v[76:79], v[220:223], v[212:215], v[76:79]
v_bfe_u32 v188, v189, 2, 14
v_bfe_u32 v190, v191, 2, 14
v_mfma_f32_16x16x32_bf16 v[168:171], v[224:227], v[104:107], v[168:171]
ds_read_b128 v[220:223], v249 offset:2304
ds_read_u16_d16 v188, v188
ds_read_u16_d16 v190, v190
v_exp_f16_e64 v195, v196
v_mfma_f32_16x16x32_bf16 v[176:179], v[224:227], v[108:111], v[176:179]
v_lshrrev_b32 v189, 18, v189
v_lshrrev_b32 v191, 18, v191
v_mfma_f32_16x16x32_f16 v[80:83], v[228:231], v[208:211], v[80:83]
ds_read_b128 v[224:227], v250 offset:2048
ds_read_u16_d16_hi v189, v189
ds_read_u16_d16_hi v191, v191
v_exp_f16_sdwa v201, v202 dst_sel:WORD_1 dst_unused:UNUSED_PRESERVE src0_sel:WORD_1
v_mfma_f32_16x16x32_f16 v[88:91], v[228:231], v[212:215], v[88:91]
v_and_b32 v193, s49, v193
v_bfe_u32 v192, v193, 2, 14
s_waitcnt lgkmcnt(7)
v_mfma_f32_16x16x32_f16 v[84:87], v[232:235], v[208:211], v[84:87]
ds_read_b128 v[228:231], v250 offset:2304
ds_read_u16_d16 v192, v192
v_exp_f16_sdwa v198, v199 dst_sel:WORD_1 dst_unused:UNUSED_PRESERVE src0_sel:WORD_1
v_mfma_f32_16x16x32_f16 v[92:95], v[232:235], v[212:215], v[92:95]
v_lshrrev_b32 v193, 18, v193
s_waitcnt vmcnt(7)
v_mfma_f32_16x16x32_bf16 v[48:51], v[18:21], v[0:3], v[48:51]
ds_read_b128 v[232:235], v249 offset:6144
ds_read_u16_d16_hi v193, v193
v_exp_f16_sdwa v195, v196 dst_sel:WORD_1 dst_unused:UNUSED_PRESERVE src0_sel:WORD_1
v_pk_add_f16 v201, v201, 1.0 op_sel_hi:[1,0]
v_mfma_f32_16x16x32_bf16 v[52:55], v[16:19], v[0:3], v[52:55]
v_pk_add_f16 v198, v198, 1.0 op_sel_hi:[1,0]
v_pk_add_f16 v195, v195, 1.0 op_sel_hi:[1,0]
v_mfma_f32_16x16x32_bf16 v[172:175], v[236:239], v[104:107], v[172:175]
v_rcp_f16_e64 v202, v201
v_mfma_f32_16x16x32_bf16 v[180:183], v[236:239], v[108:111], v[180:183]
v_rcp_f16 v199, v198
s_waitcnt lgkmcnt(4)
v_mfma_f32_16x16x32_bf16 v[168:171], v[216:219], v[112:115], v[168:171]
ds_read_b128 v[236:239], v250 offset:3072
v_rcp_f16_e64 v196, v195
v_mfma_f32_16x16x32_bf16 v[176:179], v[216:219], v[116:119], v[176:179]
v_rcp_f16_sdwa v202, v201 dst_sel:WORD_1 dst_unused:UNUSED_PRESERVE src0_sel:WORD_1
v_mfma_f32_16x16x32_bf16 v[172:175], v[220:223], v[112:115], v[172:175]
ds_read_b128 v[216:219], v249 offset:6400
v_rcp_f16_sdwa v199, v198 dst_sel:WORD_1 dst_unused:UNUSED_PRESERVE src0_sel:WORD_1
v_mfma_f32_16x16x32_bf16 v[180:183], v[220:223], v[116:119], v[180:183]
v_or_b32 v208, v184, v185
v_or_b32 v209, v186, v187
v_or_b32_e64 v210, v188, v189
v_rcp_f16_sdwa v196, v195 dst_sel:WORD_1 dst_unused:UNUSED_PRESERVE src0_sel:WORD_1
v_or_b32 v211, v190, v191
s_waitcnt lgkmcnt(2)
v_or_b32_e64 v212, v192, v193
v_pk_mul_f16 v213, v203, v202
v_pk_mul_f16 v214, v200, v199
v_pk_mul_f16 v215, v197, v196
v_mfma_f32_16x16x32_f16 v[48:51], v[224:227], v[208:211], v[48:51]
s_add_u32 s46, s69, 98304
buffer_load_dwordx4 v[0:3], v252, s[4:7], s46 offen offset:128
ds_read_b128 v[220:223], v250 offset:3328
v_cvt_pkrtz_f16_f32 v185, v168, v169
v_cvt_pkrtz_f16_f32 v187, v170, v171
v_cvt_pkrtz_f16_f32 v189, v172, v173
v_mfma_f32_16x16x32_f16 v[56:59], v[224:227], v[212:215], v[56:59]
v_cvt_pkrtz_f16_f32 v191, v174, v175
v_cvt_pkrtz_f16_f32 v193, v176, v177
v_cvt_pk_f16_f32 v203, v178, v179
v_mfma_f32_16x16x32_f16 v[52:55], v[228:231], v[208:211], v[52:55]
ds_read_b128 v[224:227], v249 offset:7168
v_cvt_pk_f16_f32 v200, v180, v181
v_cvt_pk_f16_f32 v197, v182, v183
v_pk_fma_f16 v202, v203, v203, s48
v_mfma_f32_16x16x32_f16 v[60:63], v[228:231], v[212:215], v[60:63]
v_cvt_pk_bf16_f32 v144, v144, v145
v_and_b32_e64 v185, s49, v185
v_cvt_pk_bf16_f32 v145, v146, v147
v_mfma_f32_16x16x32_bf16 v[168:171], v[232:235], v[96:99], 0
ds_read_b128 v[228:231], v250 offset:4096
v_pk_fma_f16 v199, v200, v200, s48
v_and_b32 v187, s49, v187
v_cvt_pk_bf16_f32 v146, v148, v149
v_mfma_f32_16x16x32_bf16 v[176:179], v[232:235], v[100:103], 0
v_pk_fma_f16 v196, v197, v197, s48
v_cvt_pk_bf16_f32 v147, v150, v151
v_bfe_u32 v184, v185, 2, 14
s_waitcnt lgkmcnt(2)
v_mfma_f32_16x16x32_f16 v[64:67], v[236:239], v[208:211], v[64:67]
ds_read_b128 v[232:235], v250 offset:4352
ds_read_u16_d16 v184, v184
v_pk_mul_f16 v202, v203, v202
v_cvt_pk_bf16_f32 v128, v128, v129
v_bfe_u32 v186, v187, 2, 14
v_mfma_f32_16x16x32_f16 v[72:75], v[236:239], v[212:215], v[72:75]
v_cvt_pk_bf16_f32 v129, v130, v131
v_pk_mul_f16 v199, v200, v199
v_lshrrev_b32 v185, 18, v185
s_waitcnt vmcnt(6)
v_mfma_f32_16x16x32_bf16 v[64:67], v[18:21], v[204:207], v[64:67]
ds_read_b128 v[236:239], v249 offset:7424
ds_read_u16_d16 v186, v186
ds_read_u16_d16_hi v185, v185
v_cvt_pk_bf16_f32 v130, v132, v133
v_pk_mul_f16 v196, v197, v196
v_lshrrev_b32_e64 v187, 18, v187
v_mfma_f32_16x16x32_bf16 v[68:71], v[16:19], v[204:207], v[68:71]
v_cvt_pk_bf16_f32 v131, v134, v135
v_exp_f16_e64 v201, v202
v_mfma_f32_16x16x32_bf16 v[172:175], v[216:219], v[96:99], 0
ds_read_u16_d16_hi v187, v187
v_cvt_pk_bf16_f32 v160, v160, v161
v_and_b32_e64 v189, s49, v189
v_cvt_pk_bf16_f32 v161, v162, v163
v_mfma_f32_16x16x32_bf16 v[180:183], v[216:219], v[100:103], 0
v_and_b32_e64 v191, s49, v191
v_cvt_pk_bf16_f32 v162, v164, v165
v_mfma_f32_16x16x32_f16 v[68:71], v[220:223], v[208:211], v[68:71]
ds_read_b128 v[216:219], v249 offset:8192
v_exp_f16 v198, v199
v_cvt_pk_bf16_f32 v163, v166, v167
s_mov_b64 vcc, s[74:75]
v_bfe_u32 v188, v189, 2, 14
v_bfe_u32 v190, v191, 2, 14
v_mfma_f32_16x16x32_f16 v[76:79], v[220:223], v[212:215], v[76:79]
v_cndmask_b32 v148, v128, v160, vcc
v_exp_f16_e64 v195, v196
s_waitcnt lgkmcnt(2)
v_mfma_f32_16x16x32_bf16 v[168:171], v[224:227], v[104:107], v[168:171]
ds_read_b128 v[220:223], v249 offset:8448
ds_read_u16_d16 v188, v188
ds_read_u16_d16 v190, v190
v_cndmask_b32 v149, v129, v161, vcc
v_lshrrev_b32_e64 v189, 18, v189
v_cndmask_b32 v150, v130, v162, vcc
v_mfma_f32_16x16x32_bf16 v[176:179], v[224:227], v[108:111], v[176:179]
v_lshrrev_b32 v191, 18, v191
v_cndmask_b32 v151, v131, v163, vcc
v_mfma_f32_16x16x32_f16 v[80:83], v[228:231], v[208:211], v[80:83]
ds_read_b128 v[224:227], v250 offset:8192
ds_read_u16_d16_hi v189, v189
ds_read_u16_d16_hi v191, v191
v_exp_f16_sdwa v201, v202 dst_sel:WORD_1 dst_unused:UNUSED_PRESERVE src0_sel:WORD_1
v_cndmask_b32_dpp v128, v144, v128, vcc quad_perm:[1,0,3,2] row_mask:0xf bank_mask:0xf
v_and_b32_e64 v193, s49, v193
v_mfma_f32_16x16x32_f16 v[88:91], v[228:231], v[212:215], v[88:91]
v_cndmask_b32_dpp v129, v145, v129, vcc quad_perm:[1,0,3,2] row_mask:0xf bank_mask:0xf
v_bfe_u32 v192, v193, 2, 14
v_mfma_f32_16x16x32_f16 v[84:87], v[232:235], v[208:211], v[84:87]
ds_read_b128 v[228:231], v250 offset:8448
ds_read_u16_d16 v192, v192
v_exp_f16_sdwa v198, v199 dst_sel:WORD_1 dst_unused:UNUSED_PRESERVE src0_sel:WORD_1
v_cndmask_b32_dpp v130, v146, v130, vcc quad_perm:[1,0,3,2] row_mask:0xf bank_mask:0xf
v_lshrrev_b32 v193, 18, v193
v_mfma_f32_16x16x32_f16 v[92:95], v[232:235], v[212:215], v[92:95]
v_cndmask_b32_dpp v131, v147, v131, vcc quad_perm:[1,0,3,2] row_mask:0xf bank_mask:0xf
s_not_b64 vcc, s[74:75]
v_exp_f16_sdwa v195, v196 dst_sel:WORD_1 dst_unused:UNUSED_PRESERVE src0_sel:WORD_1
v_mfma_f32_16x16x32_bf16 v[172:175], v[236:239], v[104:107], v[172:175]
ds_read_b128 v[232:235], v249 offset:12288
ds_read_u16_d16_hi v193, v193
v_cndmask_b32_dpp v160, v144, v160, vcc quad_perm:[1,0,3,2] row_mask:0xf bank_mask:0xf
v_pk_add_f16 v201, v201, 1.0 op_sel_hi:[1,0]
v_cndmask_b32_dpp v161, v145, v161, vcc quad_perm:[1,0,3,2] row_mask:0xf bank_mask:0xf
v_mfma_f32_16x16x32_bf16 v[180:183], v[236:239], v[108:111], v[180:183]
v_pk_add_f16 v198, v198, 1.0 op_sel_hi:[1,0]
v_cndmask_b32_dpp v162, v146, v162, vcc quad_perm:[1,0,3,2] row_mask:0xf bank_mask:0xf
v_pk_add_f16 v195, v195, 1.0 op_sel_hi:[1,0]
s_waitcnt lgkmcnt(4)
v_mfma_f32_16x16x32_bf16 v[168:171], v[216:219], v[112:115], v[168:171]
ds_read_b128 v[236:239], v250 offset:9216
v_rcp_f16 v202, v201
v_cndmask_b32_dpp v163, v147, v163, vcc quad_perm:[1,0,3,2] row_mask:0xf bank_mask:0xf
v_mfma_f32_16x16x32_bf16 v[176:179], v[216:219], v[116:119], v[176:179]
v_rcp_f16_e64 v199, v198
v_mfma_f32_16x16x32_bf16 v[172:175], v[220:223], v[112:115], v[172:175]
ds_read_b128 v[216:219], v249 offset:12544
s_add_u32 s46, s68, 98304
buffer_store_dwordx4 v[128:131], v255, s[8:11], s46 offen sc1
v_rcp_f16_e64 v196, v195
v_rcp_f16_sdwa v202, v201 dst_sel:WORD_1 dst_unused:UNUSED_PRESERVE src0_sel:WORD_1
v_mfma_f32_16x16x32_bf16 v[180:183], v[220:223], v[116:119], v[180:183]
v_rcp_f16_sdwa v199, v198 dst_sel:WORD_1 dst_unused:UNUSED_PRESERVE src0_sel:WORD_1
v_or_b32 v208, v184, v185
v_or_b32 v209, v186, v187
v_or_b32_e64 v210, v188, v189
v_rcp_f16_sdwa v196, v195 dst_sel:WORD_1 dst_unused:UNUSED_PRESERVE src0_sel:WORD_1
v_or_b32 v211, v190, v191
s_waitcnt lgkmcnt(2)
v_or_b32_e64 v212, v192, v193
v_pk_mul_f16 v213, v203, v202
v_pk_mul_f16 v214, v200, v199
v_pk_mul_f16 v215, v197, v196
v_mfma_f32_16x16x32_f16 v[48:51], v[224:227], v[208:211], v[48:51]
s_add_u32 s46, s68, 98304
buffer_store_dwordx4 v[148:151], v255, s[8:11], s46 offen offset:128 sc1
ds_read_b128 v[220:223], v250 offset:9472
v_cvt_pkrtz_f16_f32 v185, v168, v169
v_cvt_pkrtz_f16_f32 v187, v170, v171
v_mfma_f32_16x16x32_f16 v[56:59], v[224:227], v[212:215], v[56:59]
v_cvt_pkrtz_f16_f32 v189, v172, v173
v_cvt_pkrtz_f16_f32 v191, v174, v175
v_mfma_f32_16x16x32_f16 v[52:55], v[228:231], v[208:211], v[52:55]
ds_read_b128 v[224:227], v249 offset:13312
v_cvt_pkrtz_f16_f32 v193, v176, v177
v_cvt_pk_f16_f32 v203, v178, v179
v_mfma_f32_16x16x32_f16 v[60:63], v[228:231], v[212:215], v[60:63]
v_cvt_pk_f16_f32 v200, v180, v181
v_cvt_pk_f16_f32 v197, v182, v183
v_mfma_f32_16x16x32_bf16 v[168:171], v[232:235], v[96:99], 0
ds_read_b128 v[228:231], v250 offset:10240
v_pk_fma_f16 v202, v203, v203, s48
v_and_b32_e64 v185, s49, v185
v_mfma_f32_16x16x32_bf16 v[176:179], v[232:235], v[100:103], 0
v_pk_fma_f16 v199, v200, v200, s48
v_and_b32 v187, s49, v187
s_waitcnt lgkmcnt(3)
v_mfma_f32_16x16x32_f16 v[64:67], v[236:239], v[208:211], v[64:67]
ds_read_b128 v[232:235], v250 offset:10496
v_pk_fma_f16 v196, v197, v197, s48
v_bfe_u32 v184, v185, 2, 14
v_pk_mul_f16 v202, v203, v202
v_mfma_f32_16x16x32_f16 v[72:75], v[236:239], v[212:215], v[72:75]
v_bfe_u32 v186, v187, 2, 14
v_pk_mul_f16 v199, v200, v199
s_waitcnt vmcnt(6)
v_mfma_f32_16x16x32_bf16 v[80:83], v[18:21], v[4:7], v[80:83]
ds_read_b128 v[236:239], v249 offset:13568
ds_read_u16_d16 v184, v184
ds_read_u16_d16 v186, v186
v_lshrrev_b32 v185, 18, v185
v_pk_mul_f16 v196, v197, v196
v_mfma_f32_16x16x32_bf16 v[84:87], v[16:19], v[4:7], v[84:87]
v_lshrrev_b32_e64 v187, 18, v187
v_mfma_f32_16x16x32_bf16 v[172:175], v[216:219], v[96:99], 0
ds_read_u16_d16_hi v185, v185
ds_read_u16_d16_hi v187, v187
v_exp_f16 v201, v202
v_and_b32 v189, s49, v189
v_mfma_f32_16x16x32_bf16 v[180:183], v[216:219], v[100:103], 0
v_and_b32 v191, s49, v191
s_waitcnt lgkmcnt(6)
v_mfma_f32_16x16x32_f16 v[68:71], v[220:223], v[208:211], v[68:71]
ds_read_b128 v[216:219], v249 offset:14336
v_exp_f16_e64 v198, v199
v_bfe_u32 v188, v189, 2, 14
v_mfma_f32_16x16x32_f16 v[76:79], v[220:223], v[212:215], v[76:79]
v_bfe_u32 v190, v191, 2, 14
v_exp_f16_e64 v195, v196
v_mfma_f32_16x16x32_bf16 v[168:171], v[224:227], v[104:107], v[168:171]
ds_read_b128 v[220:223], v249 offset:14592
ds_read_u16_d16 v188, v188
ds_read_u16_d16 v190, v190
v_lshrrev_b32 v189, 18, v189
v_lshrrev_b32 v191, 18, v191
v_mfma_f32_16x16x32_bf16 v[176:179], v[224:227], v[108:111], v[176:179]
v_exp_f16_sdwa v201, v202 dst_sel:WORD_1 dst_unused:UNUSED_PRESERVE src0_sel:WORD_1
v_mfma_f32_16x16x32_f16 v[80:83], v[228:231], v[208:211], v[80:83]
ds_read_b128 v[224:227], v250 offset:14336
ds_read_u16_d16_hi v189, v189
ds_read_u16_d16_hi v191, v191
v_and_b32 v193, s49, v193
v_bfe_u32 v192, v193, 2, 14
v_mfma_f32_16x16x32_f16 v[88:91], v[228:231], v[212:215], v[88:91]
v_exp_f16_sdwa v198, v199 dst_sel:WORD_1 dst_unused:UNUSED_PRESERVE src0_sel:WORD_1
s_waitcnt lgkmcnt(7)
v_mfma_f32_16x16x32_f16 v[84:87], v[232:235], v[208:211], v[84:87]
ds_read_b128 v[228:231], v250 offset:14592
ds_read_u16_d16 v192, v192
v_lshrrev_b32_e64 v193, 18, v193
v_mfma_f32_16x16x32_f16 v[92:95], v[232:235], v[212:215], v[92:95]
v_exp_f16_sdwa v195, v196 dst_sel:WORD_1 dst_unused:UNUSED_PRESERVE src0_sel:WORD_1
v_pk_add_f16 v201, v201, 1.0 op_sel_hi:[1,0]
v_pk_add_f16 v198, v198, 1.0 op_sel_hi:[1,0]
v_mfma_f32_16x16x32_bf16 v[172:175], v[236:239], v[104:107], v[172:175]
ds_read_b128 v[232:235], v249 offset:18432
ds_read_u16_d16_hi v193, v193
v_pk_add_f16 v195, v195, 1.0 op_sel_hi:[1,0]
v_mfma_f32_16x16x32_bf16 v[180:183], v[236:239], v[108:111], v[180:183]
v_rcp_f16 v202, v201
s_waitcnt lgkmcnt(7)
v_mfma_f32_16x16x32_bf16 v[168:171], v[216:219], v[112:115], v[168:171]
ds_read_b128 v[236:239], v250 offset:15360
v_rcp_f16_e64 v199, v198
v_mfma_f32_16x16x32_bf16 v[176:179], v[216:219], v[116:119], v[176:179]
v_rcp_f16_e64 v196, v195
v_mfma_f32_16x16x32_bf16 v[172:175], v[220:223], v[112:115], v[172:175]
ds_read_b128 v[216:219], v249 offset:18688
v_rcp_f16_sdwa v202, v201 dst_sel:WORD_1 dst_unused:UNUSED_PRESERVE src0_sel:WORD_1
v_mfma_f32_16x16x32_bf16 v[180:183], v[220:223], v[116:119], v[180:183]
v_rcp_f16_sdwa v199, v198 dst_sel:WORD_1 dst_unused:UNUSED_PRESERVE src0_sel:WORD_1
v_or_b32 v208, v184, v185
v_or_b32 v209, v186, v187
s_waitcnt lgkmcnt(4)
v_or_b32 v210, v188, v189
v_rcp_f16_sdwa v196, v195 dst_sel:WORD_1 dst_unused:UNUSED_PRESERVE src0_sel:WORD_1
v_or_b32 v211, v190, v191
s_waitcnt lgkmcnt(2)
v_or_b32_e64 v212, v192, v193
v_pk_mul_f16 v213, v203, v202
v_pk_mul_f16 v214, v200, v199
v_pk_mul_f16 v215, v197, v196
v_mfma_f32_16x16x32_f16 v[48:51], v[224:227], v[208:211], v[48:51]
ds_read_b128 v[220:223], v250 offset:15616
v_cvt_pkrtz_f16_f32 v185, v168, v169
v_cvt_pkrtz_f16_f32 v187, v170, v171
v_mfma_f32_16x16x32_f16 v[56:59], v[224:227], v[212:215], v[56:59]
v_cvt_pkrtz_f16_f32 v189, v172, v173
v_cvt_pkrtz_f16_f32 v191, v174, v175
v_mfma_f32_16x16x32_f16 v[52:55], v[228:231], v[208:211], v[52:55]
ds_read_b128 v[224:227], v249 offset:19456
v_cvt_pkrtz_f16_f32 v193, v176, v177
v_cvt_pk_f16_f32 v203, v178, v179
v_mfma_f32_16x16x32_f16 v[60:63], v[228:231], v[212:215], v[60:63]
v_cvt_pk_f16_f32 v200, v180, v181
v_cvt_pk_f16_f32 v197, v182, v183
v_mfma_f32_16x16x32_bf16 v[168:171], v[232:235], v[96:99], 0
ds_read_b128 v[228:231], v250 offset:16384
v_pk_fma_f16 v202, v203, v203, s48
v_and_b32_e64 v185, s49, v185
v_mfma_f32_16x16x32_bf16 v[176:179], v[232:235], v[100:103], 0
v_pk_fma_f16 v199, v200, v200, s48
v_and_b32 v187, s49, v187
s_waitcnt lgkmcnt(3)
v_mfma_f32_16x16x32_f16 v[64:67], v[236:239], v[208:211], v[64:67]
ds_read_b128 v[232:235], v250 offset:16640
v_pk_fma_f16 v196, v197, v197, s48
v_bfe_u32 v184, v185, 2, 14
v_pk_mul_f16 v202, v203, v202
v_mfma_f32_16x16x32_f16 v[72:75], v[236:239], v[212:215], v[72:75]
v_bfe_u32 v186, v187, 2, 14
v_pk_mul_f16 v199, v200, v199
s_waitcnt vmcnt(5)
v_mfma_f32_16x16x32_bf16 v[56:59], v[18:21], v[44:47], v[56:59]
ds_read_b128 v[236:239], v249 offset:19712
ds_read_u16_d16 v184, v184
ds_read_u16_d16 v186, v186
v_lshrrev_b32 v185, 18, v185
v_pk_mul_f16 v196, v197, v196
v_mfma_f32_16x16x32_bf16 v[60:63], v[16:19], v[44:47], v[60:63]
v_lshrrev_b32_e64 v187, 18, v187
v_mfma_f32_16x16x32_bf16 v[172:175], v[216:219], v[96:99], 0
ds_read_u16_d16_hi v185, v185
ds_read_u16_d16_hi v187, v187
v_exp_f16 v201, v202
v_and_b32 v189, s49, v189
v_mfma_f32_16x16x32_bf16 v[180:183], v[216:219], v[100:103], 0
v_and_b32 v191, s49, v191
s_waitcnt lgkmcnt(6)
v_mfma_f32_16x16x32_f16 v[68:71], v[220:223], v[208:211], v[68:71]
ds_read_b128 v[216:219], v249 offset:20480
v_exp_f16_e64 v198, v199
v_bfe_u32 v188, v189, 2, 14
v_mfma_f32_16x16x32_f16 v[76:79], v[220:223], v[212:215], v[76:79]
v_bfe_u32 v190, v191, 2, 14
v_exp_f16_e64 v195, v196
v_mfma_f32_16x16x32_bf16 v[168:171], v[224:227], v[104:107], v[168:171]
ds_read_b128 v[220:223], v249 offset:20736
ds_read_u16_d16 v188, v188
ds_read_u16_d16 v190, v190
v_lshrrev_b32 v189, 18, v189
v_lshrrev_b32 v191, 18, v191
v_mfma_f32_16x16x32_bf16 v[176:179], v[224:227], v[108:111], v[176:179]
v_exp_f16_sdwa v201, v202 dst_sel:WORD_1 dst_unused:UNUSED_PRESERVE src0_sel:WORD_1
v_mfma_f32_16x16x32_f16 v[80:83], v[228:231], v[208:211], v[80:83]
ds_read_b128 v[224:227], v250 offset:20480
ds_read_u16_d16_hi v189, v189
ds_read_u16_d16_hi v191, v191
v_and_b32 v193, s49, v193
v_bfe_u32 v192, v193, 2, 14
v_mfma_f32_16x16x32_f16 v[88:91], v[228:231], v[212:215], v[88:91]
v_exp_f16_sdwa v198, v199 dst_sel:WORD_1 dst_unused:UNUSED_PRESERVE src0_sel:WORD_1
s_waitcnt lgkmcnt(7)
v_mfma_f32_16x16x32_f16 v[84:87], v[232:235], v[208:211], v[84:87]
ds_read_b128 v[228:231], v250 offset:20736
ds_read_u16_d16 v192, v192
v_lshrrev_b32_e64 v193, 18, v193
v_mfma_f32_16x16x32_f16 v[92:95], v[232:235], v[212:215], v[92:95]
v_exp_f16_sdwa v195, v196 dst_sel:WORD_1 dst_unused:UNUSED_PRESERVE src0_sel:WORD_1
v_pk_add_f16 v201, v201, 1.0 op_sel_hi:[1,0]
v_pk_add_f16 v198, v198, 1.0 op_sel_hi:[1,0]
v_mfma_f32_16x16x32_bf16 v[172:175], v[236:239], v[104:107], v[172:175]
ds_read_b128 v[232:235], v250 offset:21504
ds_read_u16_d16_hi v193, v193
v_pk_add_f16 v195, v195, 1.0 op_sel_hi:[1,0]
v_mfma_f32_16x16x32_bf16 v[180:183], v[236:239], v[108:111], v[180:183]
v_rcp_f16 v202, v201
s_waitcnt lgkmcnt(7)
v_mfma_f32_16x16x32_bf16 v[168:171], v[216:219], v[112:115], v[168:171]
ds_read_b128 v[236:239], v250 offset:21760
v_rcp_f16_e64 v199, v198
v_mfma_f32_16x16x32_bf16 v[176:179], v[216:219], v[116:119], v[176:179]
v_rcp_f16_e64 v196, v195
v_mfma_f32_16x16x32_bf16 v[172:175], v[220:223], v[112:115], v[172:175]
ds_read_b128 v[216:219], v250 offset:22528
v_rcp_f16_sdwa v202, v201 dst_sel:WORD_1 dst_unused:UNUSED_PRESERVE src0_sel:WORD_1
v_mfma_f32_16x16x32_bf16 v[180:183], v[220:223], v[116:119], v[180:183]
v_rcp_f16_sdwa v199, v198 dst_sel:WORD_1 dst_unused:UNUSED_PRESERVE src0_sel:WORD_1
v_or_b32 v208, v184, v185
v_or_b32 v209, v186, v187
s_waitcnt lgkmcnt(4)
v_or_b32 v210, v188, v189
v_rcp_f16_sdwa v196, v195 dst_sel:WORD_1 dst_unused:UNUSED_PRESERVE src0_sel:WORD_1
v_or_b32 v211, v190, v191
s_waitcnt lgkmcnt(2)
v_or_b32_e64 v212, v192, v193
v_pk_mul_f16 v213, v203, v202
v_pk_mul_f16 v214, v200, v199
v_pk_mul_f16 v215, v197, v196
v_mfma_f32_16x16x32_f16 v[48:51], v[224:227], v[208:211], v[48:51]
s_add_u32 s46, s68, 98304
buffer_store_dwordx4 v[160:163], v255, s[8:11], s46 offen offset:256 sc1
ds_read_b128 v[220:223], v250 offset:22784
v_cvt_pkrtz_f16_f32 v185, v168, v169
v_cvt_pkrtz_f16_f32 v187, v170, v171
v_cvt_pkrtz_f16_f32 v189, v172, v173
v_cvt_pkrtz_f16_f32 v191, v174, v175
v_mfma_f32_16x16x32_f16 v[56:59], v[224:227], v[212:215], v[56:59]
v_cvt_pkrtz_f16_f32 v193, v176, v177
v_cvt_pk_f16_f32 v203, v178, v179
v_cvt_pk_f16_f32 v200, v180, v181
v_cvt_pk_f16_f32 v197, v182, v183
v_mfma_f32_16x16x32_f16 v[52:55], v[228:231], v[208:211], v[52:55]
ds_read_b128 v[224:227], v250 offset:26624
v_pk_fma_f16 v202, v203, v203, s48
v_and_b32_e64 v185, s49, v185
v_pk_fma_f16 v199, v200, v200, s48
v_and_b32_e64 v187, s49, v187
v_mfma_f32_16x16x32_f16 v[60:63], v[228:231], v[212:215], v[60:63]
v_pk_fma_f16 v196, v197, v197, s48
v_bfe_u32 v184, v185, 2, 14
v_pk_mul_f16 v202, v203, v202
v_bfe_u32 v186, v187, 2, 14
v_mfma_f32_16x16x32_f16 v[64:67], v[232:235], v[208:211], v[64:67]
ds_read_b128 v[228:231], v250 offset:26880
ds_read_u16_d16 v184, v184
ds_read_u16_d16 v186, v186
v_pk_mul_f16 v199, v200, v199
v_lshrrev_b32_e64 v185, 18, v185
v_pk_mul_f16 v196, v197, v196
v_lshrrev_b32_e64 v187, 18, v187
v_mfma_f32_16x16x32_f16 v[72:75], v[232:235], v[212:215], v[72:75]
v_exp_f16 v201, v202
v_and_b32 v189, s49, v189
v_and_b32 v191, s49, v191
s_waitcnt vmcnt(4)
v_mfma_f32_16x16x32_bf16 v[72:75], v[18:21], v[40:43], v[72:75]
ds_read_b128 v[232:235], v250 offset:27648
ds_read_u16_d16_hi v185, v185
ds_read_u16_d16_hi v187, v187
v_exp_f16_e64 v198, v199
v_bfe_u32 v188, v189, 2, 14
v_bfe_u32 v190, v191, 2, 14
v_mfma_f32_16x16x32_bf16 v[76:79], v[16:19], v[40:43], v[76:79]
v_exp_f16 v195, v196
v_lshrrev_b32 v189, 18, v189
v_lshrrev_b32 v191, 18, v191
s_waitcnt lgkmcnt(6)
v_mfma_f32_16x16x32_f16 v[68:71], v[236:239], v[208:211], v[68:71]
ds_read_u16_d16 v188, v188
ds_read_u16_d16 v190, v190
ds_read_u16_d16_hi v189, v189
ds_read_u16_d16_hi v191, v191
v_exp_f16_sdwa v201, v202 dst_sel:WORD_1 dst_unused:UNUSED_PRESERVE src0_sel:WORD_1
v_and_b32_e64 v193, s49, v193
v_bfe_u32 v192, v193, 2, 14
v_mfma_f32_16x16x32_f16 v[76:79], v[236:239], v[212:215], v[76:79]
v_exp_f16_sdwa v198, v199 dst_sel:WORD_1 dst_unused:UNUSED_PRESERVE src0_sel:WORD_1
v_lshrrev_b32_e64 v193, 18, v193
v_mfma_f32_16x16x32_f16 v[80:83], v[216:219], v[208:211], v[80:83]
ds_read_b128 v[236:239], v250 offset:27904
ds_read_u16_d16 v192, v192
ds_read_u16_d16_hi v193, v193
v_exp_f16_sdwa v195, v196 dst_sel:WORD_1 dst_unused:UNUSED_PRESERVE src0_sel:WORD_1
v_pk_add_f16 v201, v201, 1.0 op_sel_hi:[1,0]
v_pk_add_f16 v198, v198, 1.0 op_sel_hi:[1,0]
v_pk_add_f16 v195, v195, 1.0 op_sel_hi:[1,0]
v_mfma_f32_16x16x32_f16 v[88:91], v[216:219], v[212:215], v[88:91]
v_rcp_f16 v202, v201
v_rcp_f16 v199, v198
v_mfma_f32_16x16x32_f16 v[84:87], v[220:223], v[208:211], v[84:87]
ds_read_b128 v[216:219], v250 offset:28672
v_rcp_f16_e64 v196, v195
v_rcp_f16_sdwa v202, v201 dst_sel:WORD_1 dst_unused:UNUSED_PRESERVE src0_sel:WORD_1
v_mfma_f32_16x16x32_f16 v[92:95], v[220:223], v[212:215], v[92:95]
v_rcp_f16_sdwa v199, v198 dst_sel:WORD_1 dst_unused:UNUSED_PRESERVE src0_sel:WORD_1
s_waitcnt lgkmcnt(5)
v_or_b32 v208, v184, v185
v_or_b32_e64 v209, v186, v187
v_or_b32 v210, v188, v189
v_rcp_f16_sdwa v196, v195 dst_sel:WORD_1 dst_unused:UNUSED_PRESERVE src0_sel:WORD_1
s_waitcnt lgkmcnt(4)
v_or_b32 v211, v190, v191
s_waitcnt lgkmcnt(1)
v_or_b32 v212, v192, v193
v_pk_mul_f16 v213, v203, v202
v_pk_mul_f16 v214, v200, v199
v_pk_mul_f16 v215, v197, v196
v_mfma_f32_16x16x32_f16 v[48:51], v[224:227], v[208:211], v[48:51]
ds_read_b128 v[220:223], v250 offset:28928
v_mfma_f32_16x16x32_f16 v[56:59], v[224:227], v[212:215], v[56:59]
v_mfma_f32_16x16x32_f16 v[52:55], v[228:231], v[208:211], v[52:55]
v_mfma_f32_16x16x32_f16 v[60:63], v[228:231], v[212:215], v[60:63]
v_mfma_f32_16x16x32_f16 v[64:67], v[232:235], v[208:211], v[64:67]
v_mfma_f32_16x16x32_f16 v[72:75], v[232:235], v[212:215], v[72:75]
s_waitcnt vmcnt(3)
v_mfma_f32_16x16x32_bf16 v[88:91], v[18:21], v[0:3], v[88:91]
v_mfma_f32_16x16x32_bf16 v[92:95], v[16:19], v[0:3], v[92:95]
v_mfma_f32_16x16x32_f16 v[68:71], v[236:239], v[208:211], v[68:71]
v_mfma_f32_16x16x32_f16 v[76:79], v[236:239], v[212:215], v[76:79]
s_waitcnt lgkmcnt(1)
v_mfma_f32_16x16x32_f16 v[80:83], v[216:219], v[208:211], v[80:83]
v_mfma_f32_16x16x32_f16 v[88:91], v[216:219], v[212:215], v[88:91]
s_waitcnt lgkmcnt(0)
v_mfma_f32_16x16x32_f16 v[84:87], v[220:223], v[208:211], v[84:87]
v_mfma_f32_16x16x32_f16 v[92:95], v[220:223], v[212:215], v[92:95]
v_cvt_pk_bf16_f32 v64, v64, v65
v_cvt_pk_bf16_f32 v65, v66, v67
v_cvt_pk_bf16_f32 v66, v68, v69
v_cvt_pk_bf16_f32 v67, v70, v71
v_cvt_pk_bf16_f32 v48, v48, v49
v_cvt_pk_bf16_f32 v49, v50, v51
v_cvt_pk_bf16_f32 v50, v52, v53
v_cvt_pk_bf16_f32 v51, v54, v55
v_cvt_pk_bf16_f32 v80, v80, v81
v_cvt_pk_bf16_f32 v81, v82, v83
v_cvt_pk_bf16_f32 v82, v84, v85
v_cvt_pk_bf16_f32 v83, v86, v87
s_mov_b64 vcc, s[74:75]
v_cndmask_b32 v68, v48, v80, vcc
v_cndmask_b32 v69, v49, v81, vcc
v_cndmask_b32 v70, v50, v82, vcc
v_cndmask_b32 v71, v51, v83, vcc
v_cndmask_b32_dpp v48, v64, v48, vcc quad_perm:[1,0,3,2] row_mask:0xf bank_mask:0xf
v_cndmask_b32_dpp v49, v65, v49, vcc quad_perm:[1,0,3,2] row_mask:0xf bank_mask:0xf
v_cndmask_b32_dpp v50, v66, v50, vcc quad_perm:[1,0,3,2] row_mask:0xf bank_mask:0xf
v_cndmask_b32_dpp v51, v67, v51, vcc quad_perm:[1,0,3,2] row_mask:0xf bank_mask:0xf
s_not_b64 vcc, s[74:75]
v_cndmask_b32_dpp v80, v64, v80, vcc quad_perm:[1,0,3,2] row_mask:0xf bank_mask:0xf
v_cndmask_b32_dpp v81, v65, v81, vcc quad_perm:[1,0,3,2] row_mask:0xf bank_mask:0xf
v_cndmask_b32_dpp v82, v66, v82, vcc quad_perm:[1,0,3,2] row_mask:0xf bank_mask:0xf
v_cndmask_b32_dpp v83, v67, v83, vcc quad_perm:[1,0,3,2] row_mask:0xf bank_mask:0xf
buffer_store_dwordx4 v[48:51], v255, s[8:11], s69 offen sc1
buffer_store_dwordx4 v[68:71], v255, s[8:11], s69 offen offset:128 sc1
buffer_store_dwordx4 v[80:83], v255, s[8:11], s69 offen offset:256 sc1
v_cvt_pk_bf16_f32 v72, v72, v73
v_cvt_pk_bf16_f32 v73, v74, v75
v_cvt_pk_bf16_f32 v74, v76, v77
v_cvt_pk_bf16_f32 v75, v78, v79
v_cvt_pk_bf16_f32 v56, v56, v57
v_cvt_pk_bf16_f32 v57, v58, v59
v_cvt_pk_bf16_f32 v58, v60, v61
v_cvt_pk_bf16_f32 v59, v62, v63
v_cvt_pk_bf16_f32 v88, v88, v89
v_cvt_pk_bf16_f32 v89, v90, v91
v_cvt_pk_bf16_f32 v90, v92, v93
v_cvt_pk_bf16_f32 v91, v94, v95
s_mov_b64 vcc, s[74:75]
v_cndmask_b32 v76, v56, v88, vcc
v_cndmask_b32 v77, v57, v89, vcc
v_cndmask_b32 v78, v58, v90, vcc
v_cndmask_b32 v79, v59, v91, vcc
v_cndmask_b32_dpp v56, v72, v56, vcc quad_perm:[1,0,3,2] row_mask:0xf bank_mask:0xf
v_cndmask_b32_dpp v57, v73, v57, vcc quad_perm:[1,0,3,2] row_mask:0xf bank_mask:0xf
v_cndmask_b32_dpp v58, v74, v58, vcc quad_perm:[1,0,3,2] row_mask:0xf bank_mask:0xf
v_cndmask_b32_dpp v59, v75, v59, vcc quad_perm:[1,0,3,2] row_mask:0xf bank_mask:0xf
s_not_b64 vcc, s[74:75]
v_cndmask_b32_dpp v88, v72, v88, vcc quad_perm:[1,0,3,2] row_mask:0xf bank_mask:0xf
v_cndmask_b32_dpp v89, v73, v89, vcc quad_perm:[1,0,3,2] row_mask:0xf bank_mask:0xf
v_cndmask_b32_dpp v90, v74, v90, vcc quad_perm:[1,0,3,2] row_mask:0xf bank_mask:0xf
v_cndmask_b32_dpp v91, v75, v91, vcc quad_perm:[1,0,3,2] row_mask:0xf bank_mask:0xf
s_add_u32 s46, s69, 98304
buffer_store_dwordx4 v[56:59], v255, s[8:11], s46 offen sc1
s_add_u32 s46, s69, 98304
buffer_store_dwordx4 v[76:79], v255, s[8:11], s46 offen offset:128 sc1
s_add_u32 s46, s69, 98304
buffer_store_dwordx4 v[88:91], v255, s[8:11], s46 offen offset:256 sc1
s_endpgm
Lpoll:
s_waitcnt vmcnt(0)
s_cmp_eq_u32 s77, 2
s_cbranch_scc1 LpollC
v_max_u32 v255, v156, v157
v_max3_u32 v255, v255, v158, v159
v_max3_u32 v255, v255, v160, v161
v_max3_u32 v255, v255, v162, v163
v_max3_u32 v255, v255, v164, v165
v_max3_u32 v255, v255, v166, v167
v_max3_u32 v255, v255, v240, v241
v_max3_u32 v255, v255, v242, v243
v_cmp_eq_u32 vcc, -1, v255
s_nop 4
s_cbranch_vccz LpollR
v_lshlrev_b32 v247, 4, v251
s_lshl_b32 s44, s2, 12
buffer_load_dwordx4 v[156:159], v247, s[32:35], s44 offen sc1
buffer_load_dwordx4 v[160:163], v247, s[32:35], s44 offen offset:1024 sc1
buffer_load_dwordx4 v[164:167], v247, s[32:35], s44 offen offset:2048 sc1
buffer_load_dwordx4 v[240:243], v247, s[32:35], s44 offen offset:3072 sc1
s_setpc_b64 s[78:79]
LpollR:
s_setprio 3
v_add_f32 v156, v156, v160
v_add_f32 v240, v164, v240
v_add_f32 v240, v156, v240
v_add_f32 v157, v157, v161
v_add_f32 v241, v165, v241
v_add_f32 v241, v157, v241
v_add_f32 v158, v158, v162
v_add_f32 v242, v166, v242
v_add_f32 v242, v158, v242
v_add_f32 v159, v159, v163
v_add_f32 v243, v167, v243
v_add_f32 v243, v159, v243
v_add_f32_dpp v240, v240, v240 row_ror:8 row_mask:0xf bank_mask:0xf
s_nop 1
v_add_f32_dpp v240, v240, v240 row_ror:4 row_mask:0xf bank_mask:0xf
s_nop 1
v_add_f32_dpp v240, v240, v240 row_ror:2 row_mask:0xf bank_mask:0xf
s_nop 1
v_add_f32_dpp v240, v240, v240 row_ror:1 row_mask:0xf bank_mask:0xf
v_mov_b32 v255, v240
s_nop 1
v_permlane16_swap_b32 v240, v255
v_add_f32 v240, v240, v255
v_mov_b32 v255, v240
s_nop 1
v_permlane32_swap_b32 v240, v255
v_add_f32 v240, v240, v255
v_min_u32 v240, -2, v240
v_add_f32_dpp v241, v241, v241 row_ror:8 row_mask:0xf bank_mask:0xf
s_nop 1
v_add_f32_dpp v241, v241, v241 row_ror:4 row_mask:0xf bank_mask:0xf
s_nop 1
v_add_f32_dpp v241, v241, v241 row_ror:2 row_mask:0xf bank_mask:0xf
s_nop 1
v_add_f32_dpp v241, v241, v241 row_ror:1 row_mask:0xf bank_mask:0xf
v_mov_b32 v255, v241
s_nop 1
v_permlane16_swap_b32 v241, v255
v_add_f32 v241, v241, v255
v_mov_b32 v255, v241
s_nop 1
v_permlane32_swap_b32 v241, v255
v_add_f32 v241, v241, v255
v_min_u32 v241, -2, v241
v_add_f32_dpp v242, v242, v242 row_ror:8 row_mask:0xf bank_mask:0xf
s_nop 1
v_add_f32_dpp v242, v242, v242 row_ror:4 row_mask:0xf bank_mask:0xf
s_nop 1
v_add_f32_dpp v242, v242, v242 row_ror:2 row_mask:0xf bank_mask:0xf
s_nop 1
v_add_f32_dpp v242, v242, v242 row_ror:1 row_mask:0xf bank_mask:0xf
v_mov_b32 v255, v242
s_nop 1
v_permlane16_swap_b32 v242, v255
v_add_f32 v242, v242, v255
v_mov_b32 v255, v242
s_nop 1
v_permlane32_swap_b32 v242, v255
v_add_f32 v242, v242, v255
v_min_u32 v242, -2, v242
v_add_f32_dpp v243, v243, v243 row_ror:8 row_mask:0xf bank_mask:0xf
s_nop 1
v_add_f32_dpp v243, v243, v243 row_ror:4 row_mask:0xf bank_mask:0xf
s_nop 1
v_add_f32_dpp v243, v243, v243 row_ror:2 row_mask:0xf bank_mask:0xf
s_nop 1
v_add_f32_dpp v243, v243, v243 row_ror:1 row_mask:0xf bank_mask:0xf
v_mov_b32 v255, v243
s_nop 1
v_permlane16_swap_b32 v243, v255
v_add_f32 v243, v243, v255
v_mov_b32 v255, v243
s_nop 1
v_permlane32_swap_b32 v243, v255
v_add_f32_e64 v243, v243, v255
v_min_u32 v243, -2, v243
s_lshl_b32 s44, s2, 4
s_add_u32 s44, s44, 393216
v_lshlrev_b32_e64 v255, 11, v251
s_mov_b64 exec, 0xff
buffer_store_dwordx4 v[240:243], v255, s[32:35], s44 offen sc1
s_mov_b64 exec, -1
s_mov_b32 s77, 2
v_lshlrev_b32_e64 v247, 3, v251
s_and_b32 s44, s2, 7
s_lshl_b32 s44, s44, 11
s_add_u32 s44, s44, 393216
buffer_load_dwordx2 v[156:157], v247, s[32:35], s44 offen sc1
buffer_load_dwordx2 v[158:159], v247, s[32:35], s44 offen offset:512 sc1
buffer_load_dwordx2 v[160:161], v247, s[32:35], s44 offen offset:1024 sc1
s_setpc_b64 s[78:79]
LpollC:
v_max3_u32 v255, v156, v157, v158
v_max3_u32 v255, v255, v159, v160
v_max_u32 v255, v255, v161
v_cmp_eq_u32 vcc, -1, v255
s_nop 4
s_cbranch_vccz LpollS
v_lshlrev_b32 v247, 3, v251
s_and_b32 s44, s2, 7
s_lshl_b32 s44, s44, 11
s_add_u32 s44, s44, 393216
buffer_load_dwordx2 v[156:157], v247, s[32:35], s44 offen sc1
buffer_load_dwordx2 v[158:159], v247, s[32:35], s44 offen offset:512 sc1
buffer_load_dwordx2 v[160:161], v247, s[32:35], s44 offen offset:1024 sc1
s_setpc_b64 s[78:79]
LpollS:
s_setprio 3
s_mov_b32 s43, 1083296634
v_mov_b32 v162, 897988541
v_fma_f32 v156, v156, s43, v162
v_fma_f32 v157, v157, s43, v162
v_fma_f32 v158, v158, s43, v162
v_fma_f32 v159, v159, s43, v162
v_fma_f32 v160, v160, s43, v162
v_fma_f32 v161, v161, s43, v162
v_sqrt_f32 v156, v156
v_sqrt_f32 v157, v157
v_sqrt_f32 v158, v158
v_sqrt_f32 v159, v159
v_sqrt_f32 v160, v160
v_sqrt_f32 v161, v161
v_add_f32 v163, v156, v157
v_add_f32 v163, v163, v158
v_add_f32 v163, v163, v159
v_add_f32 v163, v163, v160
v_add_f32 v163, v163, v161
s_nop 1
v_add_f32_dpp v163, v163, v163 row_ror:8 row_mask:0xf bank_mask:0xf
s_nop 1
v_add_f32_dpp v163, v163, v163 row_ror:4 row_mask:0xf bank_mask:0xf
s_nop 1
v_add_f32_dpp v163, v163, v163 row_ror:2 row_mask:0xf bank_mask:0xf
s_nop 1
v_add_f32_dpp v163, v163, v163 row_ror:1 row_mask:0xf bank_mask:0xf
v_mov_b32 v255, v163
s_nop 1
v_permlane16_swap_b32 v163, v255
v_add_f32 v163, v163, v255
v_mov_b32 v255, v163
s_nop 1
v_permlane32_swap_b32 v163, v255
v_add_f32_e64 v163, v163, v255
s_mov_b32 s43, 992651947
v_fma_f32 v163, v163, s43, v162
v_rcp_f32_e64 v163, v163
v_mov_b32 v162, 3221789604
v_mul_f32 v163, v163, v162
v_lshlrev_b32 v164, 16, v244
v_and_b32 v165, 4294901760, v244
v_mul_f32 v156, v156, v163
v_mul_f32 v157, v157, v163
v_fma_f32 v164, v164, v156, v162
v_fma_f32 v165, v165, v157, v162
v_cvt_pk_f16_f32 v244, v164, v165
v_lshlrev_b32_e64 v164, 16, v245
v_and_b32 v165, 4294901760, v245
v_mul_f32 v158, v158, v163
v_mul_f32 v159, v159, v163
v_fma_f32 v164, v164, v158, v162
v_fma_f32 v165, v165, v159, v162
v_cvt_pk_f16_f32 v245, v164, v165
v_lshlrev_b32_e64 v164, 16, v246
v_and_b32 v165, 4294901760, v246
v_mul_f32 v160, v160, v163
v_mul_f32 v161, v161, v163
v_fma_f32 v164, v164, v160, v162
v_fma_f32 v165, v165, v161, v162
v_cvt_pk_f16_f32 v246, v164, v165
s_mov_b32 s77, 0
s_setpc_b64 s[78:79]
Lend:
s_endpgm

.section .rodata,"a"
.p2align 6
.amdhsa_kernel standalone__modern_conv_block_convnext_v2__vision_kernel
  .amdhsa_next_free_vgpr 256
  .amdhsa_next_free_sgpr 102
  .amdhsa_accum_offset 256
  .amdhsa_group_segment_fixed_size 0
  .amdhsa_kernarg_size 72
  .amdhsa_user_sgpr_count 2
  .amdhsa_user_sgpr_kernarg_segment_ptr 1
  .amdhsa_system_sgpr_workgroup_id_x 1
.end_amdhsa_kernel
```

```asm
; @launch grid=(256,1,1) block=(512,1,1) lds=163840
.amdgcn_target "amdgcn-amd-amdhsa--gfx950"
.text
.globl standalone__modern_conv_block_convnext_v2__vision_kernel
.p2align 8
.type standalone__modern_conv_block_convnext_v2__vision_kernel,@function
standalone__modern_conv_block_convnext_v2__vision_kernel:
Lmain:
s_cmp_ge_u32 s2, 256
s_cbranch_scc1 Lend
s_load_dwordx16 s[80:95], s[0:1], 0
s_load_dwordx2 s[96:97], s[0:1], 64
s_getpc_b64 s[74:75]
Lpc0:
s_sub_u32 s74, s74, Lpc0-Lmain
s_subb_u32 s75, s75, 0
v_lshlrev_b32 v159, 7, v0
s_movk_i32 s43, 64
v_cmp_gt_u32 vcc, s43, v0
s_and_saveexec_b64 s[78:79], vcc
s_cbranch_execz Lpf0x
global_load_dword v255, v159, s[74:75]
Lpf0x:
s_mov_b64 exec, s[78:79]
v_mov_b32 v199, v0
v_and_b32 v251, 63, v0
v_lshrrev_b32 v120, 6, v0
s_nop 0
v_readfirstlane_b32 s40, v120
s_and_b32 s43, s2, 7
s_lshr_b32 s44, s2, 3
s_and_b32 s41, s43, 3
s_lshl_b32 s41, s41, 2
s_and_b32 s45, s44, 3
s_add_u32 s41, s41, s45
s_lshr_b32 s42, s43, 2
s_lshl_b32 s42, s42, 3
s_lshr_b32 s45, s44, 2
s_add_u32 s42, s42, s45
s_lshl_b32 s41, s41, 5
s_lshl_b32 s42, s42, 5
s_lshl_b32 s67, s40, 6
s_cmp_eq_u32 s40, 6
s_cselect_b32 s67, 352, s67
v_add_u32_e64 v125, s67, v251
v_mul_u32_u24 v121, 5462, v125
v_lshrrev_b32 v121, 16, v121
v_mul_u32_u24 v122, 12, v121
v_sub_u32 v122, v125, v122
v_bfe_u32 v123, v121, 2, 2
v_xor_b32 v122, v122, v123
v_add_u32 v123, s41, v121
v_subrev_u32 v123, 1, v123
v_mul_u32_u24 v124, 192, v123
v_lshl_add_u32 v124, v122, 4, v124
v_mov_b32 v240, 2147483648
s_movk_i32 s43, 512
v_cmp_gt_u32 vcc, s43, v123
s_nop 1
v_cndmask_b32 v124, v240, v124, vcc
v_cmp_gt_u32 vcc, 34, v121
s_nop 1
v_cndmask_b32 v240, v240, v124, vcc
s_add_i32 s43, s42, -1
s_mul_i32 s44, s43, 98304
s_cmp_lt_u32 s43, 512
s_cselect_b32 s46, s44, 1073741824
s_mul_i32 s66, s42, 98304
s_mov_b32 s6, 50331648
s_mov_b32 s7, 131072
s_lshl_b32 s67, s67, 4
s_add_u32 s67, s67, 90112
s_cmp_eq_u32 s40, 7
s_cselect_b32 s67, 163840, s67
v_lshlrev_b32 v130, 1, v199
v_add_u32 v155, 768, v199
v_min_u32 v155, 863, v155
v_lshlrev_b32_e64 v131, 1, v155
s_waitcnt lgkmcnt(0)
s_mov_b32 s4, s80
s_and_b32 s5, s81, 65535
s_cmp_ge_u32 s40, 4
s_cbranch_scc1 Lnodw
s_mov_b32 s20, s82
s_and_b32 s21, s83, 65535
s_mov_b32 s22, 1728
s_mov_b32 s23, 131072
buffer_load_ushort v126, v130, s[20:23], 0 offen offset:0
buffer_load_ushort v127, v130, s[20:23], 0 offen offset:512
buffer_load_ushort v128, v130, s[20:23], 0 offen offset:1024
buffer_load_ushort v129, v131, s[20:23], 0 offen offset:0
Lnodw:
s_cmp_eq_u32 s40, 7
s_cbranch_scc1 Lskipx0
s_add_u32 m0, s67, 0
s_nop 0
buffer_load_dwordx4 v240, s[4:7], s46 offen nt lds
s_add_u32 m0, s67, 6656
s_nop 0
buffer_load_dwordx4 v240, s[4:7], s66 offen nt lds
s_add_u32 m0, s67, 13312
s_add_u32 s45, s66, 98304
buffer_load_dwordx4 v240, s[4:7], s45 offen nt lds
s_add_u32 m0, s67, 19968
s_add_u32 s45, s66, 196608
buffer_load_dwordx4 v240, s[4:7], s45 offen nt lds
s_add_u32 m0, s67, 26624
s_add_u32 s45, s66, 294912
buffer_load_dwordx4 v240, s[4:7], s45 offen nt lds
s_add_u32 m0, s67, 33280
s_add_u32 s45, s66, 393216
buffer_load_dwordx4 v240, s[4:7], s45 offen nt lds
Lskipx0:
s_mov_b32 s12, s84
s_and_b32 s13, s85, 65535
s_mov_b32 s14, 73728
s_mov_b32 s15, 131072
v_lshrrev_b32 v189, 2, v251
v_mul_u32_u24 v189, 768, v189
v_and_b32_e64 v125, 3, v251
v_lshl_add_u32 v189, v125, 4, v189
s_and_b32 s43, s40, 3
s_lshl_b32 s3, s43, 6
s_mul_i32 s77, s43, 6144
s_add_u32 s77, s77, 16384
v_mov_b32 v253, 16256
v_mov_b32 v254, 1
s_add_u32 s43, s42, s40
s_add_u32 s43, s43, 1
s_lshl_b32 s43, s43, 9
s_add_u32 s43, s43, s41
s_mul_i32 s47, s43, 192
s_sub_u32 s47, s47, 256
s_and_b32 s43, s40, 1
s_lshl_b32 s46, s43, 4
s_add_u32 s41, s41, s46
s_and_b32 s43, s40, 6
s_add_u32 s42, s42, s43
s_mul_i32 s45, s43, 6656
s_add_u32 s45, s45, 90112
v_and_b32 v131, 15, v251
v_lshrrev_b32 v132, 4, v251
v_mul_u32_u24 v122, 6656, v132
v_add_u32 v122, s45, v122
v_add_u32 v121, s46, v131
v_mul_u32_u24 v123, 192, v121
v_bfe_u32 v124, v121, 2, 2
v_lshl_add_u32 v123, v124, 4, v123
v_add_u32 v242, v122, v123
v_add_u32 v121, 1, v121
v_mul_u32_u24 v123, 192, v121
v_bfe_u32 v124, v121, 2, 2
v_lshl_add_u32 v123, v124, 4, v123
v_add_u32 v243, v122, v123
v_add_u32 v121, 1, v121
v_mul_u32_u24 v123, 192, v121
v_bfe_u32 v124, v121, 2, 2
v_lshl_add_u32 v123, v124, 4, v123
v_add_u32_e64 v244, v122, v123
s_mul_i32 s72, s40, 9216
s_add_u32 s72, s72, 90112
v_bfe_u32 v133, v131, 2, 1
v_sub_u32 v133, v132, v133
v_lshrrev_b32 v134, 3, v131
v_and_b32_e64 v135, 3, v131
v_lshl_add_u32 v135, v134, 2, v135
v_lshlrev_b32_e64 v136, 7, v133
v_lshl_add_u32 v136, v135, 4, v136
v_add_u32 v136, 156672, v136
v_mov_b32 v135, 163840
v_cmp_gt_u32 vcc, 3, v133
s_nop 1
v_cndmask_b32 v245, v135, v136, vcc
v_and_b32 v135, 3, v131
v_mul_u32_u24 v246, 85, v135
s_mov_b32 s16, s86
s_and_b32 s17, s87, 65535
s_mov_b32 s18, 73728
s_mov_b32 s19, 131072
s_mov_b32 s24, s88
s_and_b32 s25, s89, 65535
s_mov_b32 s26, 768
s_mov_b32 s27, 131072
s_mov_b32 s28, s90
s_and_b32 s29, s91, 65535
s_mov_b32 s30, 768
s_mov_b32 s31, 131072
s_mov_b32 s8, s92
s_and_b32 s9, s93, 65535
s_mov_b32 s10, 50331648
s_mov_b32 s11, 131072
s_mov_b32 s36, s94
s_and_b32 s37, s95, 65535
s_mov_b32 s38, 256
s_mov_b32 s39, 131072
s_mov_b32 s32, s96
s_and_b32 s33, s97, 65535
s_mov_b32 s34, 83886080
s_mov_b32 s35, 131072
v_lshlrev_b32 v241, 4, v251
v_and_b32 v133, 35, v251
v_bfe_u32 v134, v251, 2, 2
v_lshl_add_u32 v133, v134, 3, v133
v_bfe_u32 v134, v251, 4, 1
v_lshl_add_u32 v133, v134, 2, v133
v_lshlrev_b32_e64 v248, 4, v133
v_add_u32 v249, 65536, v248
v_add_u32 v250, 131072, v248
s_lshl_b32 s73, s2, 3
s_add_u32 s73, s73, s40
s_lshl_b32 s80, s73, 10
s_add_u32 s80, s80, 4194304
s_mul_i32 s73, s73, 16
s_add_u32 s73, s73, 1048576
s_mul_i32 s46, s41, 192
s_add_u32 s43, s42, 0
s_mul_i32 s43, s43, 98304
s_add_u32 s68, s43, s46
s_add_u32 s43, s42, 8
s_mul_i32 s43, s43, 98304
s_add_u32 s69, s43, s46
s_add_u32 s43, s42, 16
s_mul_i32 s43, s43, 98304
s_add_u32 s70, s43, s46
s_add_u32 s43, s42, 24
s_mul_i32 s43, s43, 98304
s_add_u32 s71, s43, s46
s_mul_i32 s82, s40, 9216
s_mov_b32 s48, 1156203754
s_mov_b32 s49, 4294508536
s_mov_b32 s76, 400000
v_lshrrev_b32 v148, 5, v251
v_lshlrev_b32 v190, 8, v148
v_bfe_u32 v148, v251, 2, 2
v_lshl_add_u32 v190, v148, 6, v190
v_bfe_u32 v148, v251, 4, 1
v_lshl_add_u32 v190, v148, 5, v190
v_bfe_u32 v148, v251, 0, 1
v_lshl_add_u32 v190, v148, 4, v190
v_bfe_u32 v148, v251, 1, 1
v_lshl_add_u32 v190, v148, 3, v190
v_add_u32 v190, s77, v190
v_add_u32 v191, s77, v248
s_cmp_lt_u32 s40, 4
s_cbranch_scc1 Lnoy
v_lshlrev_b32_e64 v24, 6, v199
s_mov_b32 s43, 1065362610
v_mov_b32 v25, 1084047360
v_add_u32 v0, 32772, v24
v_add_u32 v1, 32780, v24
v_add_u32 v2, 32788, v24
v_add_u32 v3, 32796, v24
v_add_u32 v4, 32804, v24
v_add_u32 v5, 32812, v24
v_add_u32 v6, 32820, v24
v_add_u32 v7, 32828, v24
v_cvt_f32_f16 v0, v0
v_cvt_f32_f16 v1, v1
v_cvt_f32_f16 v2, v2
v_cvt_f32_f16 v3, v3
v_cvt_f32_f16 v4, v4
v_cvt_f32_f16 v5, v5
v_cvt_f32_f16 v6, v6
v_cvt_f32_f16 v7, v7
v_mul_f32 v8, v0, v0
v_mul_f32 v9, v1, v1
v_mul_f32 v10, v2, v2
v_mul_f32 v11, v3, v3
v_mul_f32 v12, v4, v4
v_mul_f32 v13, v5, v5
v_mul_f32 v14, v6, v6
v_mul_f32 v15, v7, v7
v_fma_f32 v8, v8, s43, v25
v_fma_f32 v9, v9, s43, v25
v_fma_f32 v10, v10, s43, v25
v_fma_f32 v11, v11, s43, v25
v_fma_f32 v12, v12, s43, v25
v_fma_f32 v13, v13, s43, v25
v_fma_f32 v14, v14, s43, v25
v_fma_f32 v15, v15, s43, v25
v_mul_f32 v8, v0, v8
v_mul_f32 v9, v1, v9
v_mul_f32 v10, v2, v10
v_mul_f32 v11, v3, v11
v_mul_f32 v12, v4, v12
v_mul_f32 v13, v5, v13
v_mul_f32 v14, v6, v14
v_mul_f32 v15, v7, v15
v_exp_f32 v8, v8
v_exp_f32 v9, v9
v_exp_f32 v10, v10
v_exp_f32 v11, v11
v_exp_f32 v12, v12
v_exp_f32 v13, v13
v_exp_f32 v14, v14
v_exp_f32 v15, v15
v_add_f32 v16, 1.0, v8
v_add_f32 v17, 1.0, v9
v_add_f32 v18, 1.0, v10
v_add_f32 v19, 1.0, v11
v_add_f32 v20, 1.0, v12
v_add_f32 v21, 1.0, v13
v_add_f32 v22, 1.0, v14
v_add_f32 v23, 1.0, v15
v_rcp_f32 v16, v16
v_rcp_f32 v17, v17
v_rcp_f32 v18, v18
v_rcp_f32 v19, v19
v_rcp_f32 v20, v20
v_rcp_f32 v21, v21
v_rcp_f32 v22, v22
v_rcp_f32 v23, v23
v_mul_f32 v0, v0, v16
v_mul_f32 v1, v1, v17
v_mul_f32 v2, v2, v18
v_mul_f32 v3, v3, v19
v_mul_f32 v4, v4, v20
v_mul_f32 v5, v5, v21
v_mul_f32 v6, v6, v22
v_mul_f32 v7, v7, v23
v_mul_f32 v8, v8, v0
v_mul_f32 v9, v9, v1
v_mul_f32 v10, v10, v2
v_mul_f32 v11, v11, v3
v_mul_f32 v12, v12, v4
v_mul_f32 v13, v13, v5
v_mul_f32 v14, v14, v6
v_mul_f32 v15, v15, v7
v_cvt_pk_f16_f32 v28, v0, v1
v_cvt_pk_f16_f32 v32, -v8, -v9
v_cvt_pk_f16_f32 v29, v2, v3
v_cvt_pk_f16_f32 v33, -v10, -v11
v_cvt_pk_f16_f32 v30, v4, v5
v_cvt_pk_f16_f32 v34, -v12, -v13
v_cvt_pk_f16_f32 v31, v6, v7
v_cvt_pk_f16_f32 v35, -v14, -v15
v_lshlrev_b32_e64 v24, 4, v199
v_mov_b32 v25, 163840
s_movk_i32 s43, 496
v_cmp_gt_u32 vcc, s43, v199
s_nop 1
v_cndmask_b32 v24, v25, v24, vcc
ds_write_b128 v24, v[32:35]
ds_write_b128 v24, v[28:31] offset:8192
Lnoy:
s_cmp_ge_u32 s40, 4
s_cbranch_scc1 Lnoo
v_add_u32_e64 v152, 0, v199
v_mul_u32_u24 v140, 683, v152
v_lshrrev_b32 v140, 16, v140
v_mul_u32_u24 v142, 11, v140
v_lshrrev_b32 v142, 5, v142
v_lshrrev_b32 v143, 5, v152
v_bfe_u32 v141, v152, 3, 2
v_bfe_u32 v144, v152, 4, 1
v_xor_b32 v141, v141, v144
v_sub_u32 v141, v141, v142
v_mul_i32_i24 v141, 9, v141
v_add_u32 v143, v143, v141
v_lshrrev_b32_e64 v141, 1, v143
v_mul_u32_u24 v141, 368, v141
v_lshl_add_u32 v143, v143, 3, v141
v_lshl_add_u32 v143, v142, 7, v143
v_and_b32_e64 v144, 7, v152
v_lshl_add_u32 v143, v144, 4, v143
v_add_u32 v156, 156672, v143
v_add_u32 v153, 256, v199
v_mul_u32_u24 v140, 683, v153
v_lshrrev_b32 v140, 16, v140
v_mul_u32_u24 v142, 11, v140
v_lshrrev_b32 v142, 5, v142
v_lshrrev_b32 v143, 5, v153
v_bfe_u32 v141, v153, 3, 2
v_bfe_u32 v144, v153, 4, 1
v_xor_b32 v141, v141, v144
v_sub_u32 v141, v141, v142
v_mul_i32_i24 v141, 9, v141
v_add_u32 v143, v143, v141
v_lshrrev_b32_e64 v141, 1, v143
v_mul_u32_u24 v141, 368, v141
v_lshl_add_u32 v143, v143, 3, v141
v_lshl_add_u32 v143, v142, 7, v143
v_and_b32_e64 v144, 7, v153
v_lshl_add_u32 v143, v144, 4, v143
v_add_u32 v157, 156672, v143
v_add_u32 v154, 512, v199
v_mul_u32_u24 v140, 683, v154
v_lshrrev_b32 v140, 16, v140
v_mul_u32_u24 v142, 11, v140
v_lshrrev_b32 v142, 5, v142
v_lshrrev_b32 v143, 5, v154
v_bfe_u32 v141, v154, 3, 2
v_bfe_u32 v144, v154, 4, 1
v_xor_b32 v141, v141, v144
v_sub_u32 v141, v141, v142
v_mul_i32_i24 v141, 9, v141
v_add_u32 v143, v143, v141
v_lshrrev_b32_e64 v141, 1, v143
v_mul_u32_u24 v141, 368, v141
v_lshl_add_u32 v143, v143, 3, v141
v_lshl_add_u32 v143, v142, 7, v143
v_and_b32_e64 v144, 7, v154
v_lshl_add_u32 v143, v144, 4, v143
v_add_u32 v158, 156672, v143
v_mul_u32_u24 v140, 683, v155
v_lshrrev_b32 v140, 16, v140
v_mul_u32_u24 v142, 11, v140
v_lshrrev_b32 v142, 5, v142
v_lshrrev_b32 v143, 5, v155
v_bfe_u32 v141, v155, 3, 2
v_bfe_u32 v144, v155, 4, 1
v_xor_b32 v141, v141, v144
v_sub_u32 v141, v141, v142
v_mul_i32_i24 v141, 9, v141
v_add_u32 v143, v143, v141
v_lshrrev_b32_e64 v141, 1, v143
v_mul_u32_u24 v141, 368, v141
v_lshl_add_u32 v143, v143, 3, v141
v_lshl_add_u32 v143, v142, 7, v143
v_and_b32_e64 v144, 7, v155
v_lshl_add_u32 v143, v144, 4, v143
v_add_u32 v159, 156672, v143
v_mov_b32 v160, 0
v_mov_b32 v161, 0
v_mov_b32_e64 v162, 0
v_mov_b32 v163, 0
s_mov_b64 exec, 1
ds_write_b128 v253, v[160:163]
ds_write_b128 v253, v[160:163] offset:16
s_mov_b64 exec, -1
s_waitcnt vmcnt(6)
v_and_b32_e64 v130, 4, v152
v_cmp_eq_u32 vcc, 0, v130
s_nop 1
v_cndmask_b32 v164, 0, v126, vcc
v_sub_u32 v165, v126, v164
ds_write_b64 v156, v[164:165]
v_and_b32_e64 v130, 4, v153
v_cmp_eq_u32 vcc, 0, v130
s_nop 1
v_cndmask_b32 v166, 0, v127, vcc
v_sub_u32 v167, v127, v166
ds_write_b64 v157, v[166:167]
v_and_b32_e64 v130, 4, v154
v_cmp_eq_u32 vcc, 0, v130
s_nop 1
v_cndmask_b32 v168, 0, v128, vcc
v_sub_u32 v169, v128, v168
ds_write_b64 v158, v[168:169]
v_and_b32_e64 v130, 4, v155
v_cmp_eq_u32 vcc, 0, v130
s_nop 1
v_cndmask_b32 v170, 0, v129, vcc
v_sub_u32 v171, v129, v170
ds_write_b64 v159, v[170:171]
s_waitcnt lgkmcnt(0)
Lnoo:
s_barrier
s_cmp_lt_u32 s40, 4
s_cbranch_scc1 Lnoy2
v_subrev_u32 v199, 256, v199
v_lshlrev_b32_e64 v24, 6, v199
s_mov_b32 s43, 1065362610
v_mov_b32 v25, 1084047360
v_add_u32 v0, 32772, v24
v_add_u32 v1, 32780, v24
v_add_u32 v2, 32788, v24
v_add_u32 v3, 32796, v24
v_add_u32 v4, 32804, v24
v_add_u32 v5, 32812, v24
v_add_u32 v6, 32820, v24
v_add_u32 v7, 32828, v24
v_cvt_f32_f16 v0, v0
v_cvt_f32_f16 v1, v1
v_cvt_f32_f16 v2, v2
v_cvt_f32_f16 v3, v3
v_cvt_f32_f16 v4, v4
v_cvt_f32_f16 v5, v5
v_cvt_f32_f16 v6, v6
v_cvt_f32_f16 v7, v7
v_mul_f32 v8, v0, v0
v_mul_f32 v9, v1, v1
v_mul_f32 v10, v2, v2
v_mul_f32 v11, v3, v3
v_mul_f32 v12, v4, v4
v_mul_f32 v13, v5, v5
v_mul_f32 v14, v6, v6
v_mul_f32 v15, v7, v7
v_fma_f32 v8, v8, s43, v25
v_fma_f32 v9, v9, s43, v25
v_fma_f32 v10, v10, s43, v25
v_fma_f32 v11, v11, s43, v25
v_fma_f32 v12, v12, s43, v25
v_fma_f32 v13, v13, s43, v25
v_fma_f32 v14, v14, s43, v25
v_fma_f32 v15, v15, s43, v25
v_mul_f32 v8, v0, v8
v_mul_f32 v9, v1, v9
v_mul_f32 v10, v2, v10
v_mul_f32 v11, v3, v11
v_mul_f32 v12, v4, v12
v_mul_f32 v13, v5, v13
v_mul_f32 v14, v6, v14
v_mul_f32 v15, v7, v15
v_exp_f32 v8, v8
v_exp_f32 v9, v9
v_exp_f32 v10, v10
v_exp_f32 v11, v11
v_exp_f32 v12, v12
v_exp_f32 v13, v13
v_exp_f32 v14, v14
v_exp_f32 v15, v15
v_add_f32 v16, 1.0, v8
v_add_f32 v17, 1.0, v9
v_add_f32 v18, 1.0, v10
v_add_f32 v19, 1.0, v11
v_add_f32 v20, 1.0, v12
v_add_f32 v21, 1.0, v13
v_add_f32 v22, 1.0, v14
v_add_f32 v23, 1.0, v15
v_rcp_f32 v16, v16
v_rcp_f32 v17, v17
v_rcp_f32 v18, v18
v_rcp_f32 v19, v19
v_rcp_f32 v20, v20
v_rcp_f32 v21, v21
v_rcp_f32 v22, v22
v_rcp_f32 v23, v23
v_mul_f32 v0, v0, v16
v_mul_f32 v1, v1, v17
v_mul_f32 v2, v2, v18
v_mul_f32 v3, v3, v19
v_mul_f32 v4, v4, v20
v_mul_f32 v5, v5, v21
v_mul_f32 v6, v6, v22
v_mul_f32 v7, v7, v23
v_mul_f32 v8, v8, v0
v_mul_f32 v9, v9, v1
v_mul_f32 v10, v10, v2
v_mul_f32 v11, v11, v3
v_mul_f32 v12, v12, v4
v_mul_f32 v13, v13, v5
v_mul_f32 v14, v14, v6
v_mul_f32 v15, v15, v7
v_cvt_pk_f16_f32 v28, v0, v1
v_cvt_pk_f16_f32 v32, -v8, -v9
v_cvt_pk_f16_f32 v29, v2, v3
v_cvt_pk_f16_f32 v33, -v10, -v11
v_cvt_pk_f16_f32 v30, v4, v5
v_cvt_pk_f16_f32 v34, -v12, -v13
v_cvt_pk_f16_f32 v31, v6, v7
v_cvt_pk_f16_f32 v35, -v14, -v15
v_lshlrev_b32_e64 v24, 4, v199
v_mov_b32 v25, 163840
s_movk_i32 s43, 496
v_cmp_gt_u32 vcc, s43, v199
s_nop 1
v_cndmask_b32 v24, v25, v24, vcc
ds_write_b128 v24, v[32:35]
ds_write_b128 v24, v[28:31] offset:8192
Lnoy2:
s_setprio 2
s_cmp_lt_u32 s40, 4
s_cbranch_scc0 Lsu0
s_call_b64 s[78:79], Lpre
s_call_b64 s[78:79], Lrb
s_waitcnt vmcnt(4)
s_mov_b64 exec, 1
ds_add_u32 v253, v254 offset:28
s_mov_b64 exec, -1
v_mov_b32 v253, 16256
Lsw288w:
ds_read_b32 v247, v253 offset:28
s_waitcnt lgkmcnt(0)
v_readfirstlane_b32 s43, v247
s_cmp_eq_u32 s76, 0
s_cbranch_scc1 Lsw288x
s_sub_u32 s76, s76, 1
s_cmp_lt_u32 s43, 8
s_cbranch_scc0 Lsw288x
s_sleep 2
s_branch Lsw288w
Lsw288x:
s_call_b64 s[78:79], Lconv0
s_mov_b64 exec, 1
ds_add_u32 v253, v254 offset:16
s_mov_b64 exec, -1
s_call_b64 s[78:79], Lln0
s_waitcnt vmcnt(0)
s_mov_b64 exec, 1
ds_add_u32 v253, v254 offset:12
s_mov_b64 exec, -1
s_call_b64 s[78:79], Lw1i
Lsu0:
s_cmp_ge_u32 s40, 4
s_cbranch_scc0 Lsu2
s_setprio 3
s_call_b64 s[78:79], Lw1f
s_waitcnt vmcnt(6)
s_mov_b64 exec, 1
ds_add_u32 v253, v254 offset:28
s_mov_b64 exec, -1
s_call_b64 s[78:79], Lrb
s_waitcnt vmcnt(4)
s_call_b64 s[78:79], Lw1a
s_mov_b64 exec, 1
ds_add_u32 v253, v254 offset:20
s_mov_b64 exec, -1
s_call_b64 s[78:79], Lpre
s_waitcnt vmcnt(0)
s_mov_b64 exec, 1
ds_add_u32 v253, v254 offset:12
s_mov_b64 exec, -1
v_mov_b32 v253, 16256
Lsw128w:
ds_read_b32 v247, v253 offset:12
s_waitcnt lgkmcnt(0)
v_readfirstlane_b32 s43, v247
s_cmp_eq_u32 s76, 0
s_cbranch_scc1 Lsw128x
s_sub_u32 s76, s76, 1
s_cmp_lt_u32 s43, 8
s_cbranch_scc0 Lsw128x
s_sleep 2
s_branch Lsw128w
Lsw128x:
s_call_b64 s[78:79], Lconv0
s_mov_b64 exec, 1
ds_add_u32 v253, v254 offset:16
s_mov_b64 exec, -1
s_call_b64 s[78:79], Lln0
Lsu2:
s_branch Lgo
Lconv0:
ds_read_b128 v[192:195], v242
ds_read_b128 v[196:199], v242 offset:64
ds_read_b128 v[200:203], v242 offset:128
ds_read_b128 v[204:207], v243
ds_read_b128 v[208:211], v243 offset:64
ds_read_b128 v[212:215], v243 offset:128
ds_read_b128 v[224:227], v244
ds_read_b128 v[228:231], v244 offset:64
ds_read_b128 v[232:235], v244 offset:128
v_xor_b32 v242, 16, v242
ds_read_b128 v[236:239], v242
ds_read_b128 v[216:219], v242 offset:64
ds_read_b128 v[220:223], v242 offset:128
s_waitcnt lgkmcnt(11)
v_smfmac_f32_16x16x32_bf16 v[0:3], v[48:49], v[192:195], v246
s_waitcnt lgkmcnt(10)
v_smfmac_f32_16x16x32_bf16 v[16:19], v[50:51], v[196:199], v246
s_waitcnt lgkmcnt(9)
v_smfmac_f32_16x16x32_bf16 v[32:35], v[52:53], v[200:203], v246
s_waitcnt lgkmcnt(8)
v_xor_b32 v243, 16, v243
ds_read_b128 v[192:195], v243
ds_read_b128 v[196:199], v243 offset:64
v_smfmac_f32_16x16x32_bf16 v[0:3], v[54:55], v[204:207], v246
s_waitcnt lgkmcnt(9)
v_smfmac_f32_16x16x32_bf16 v[16:19], v[56:57], v[208:211], v246
s_waitcnt lgkmcnt(8)
ds_read_b128 v[200:203], v243 offset:128
v_xor_b32 v244, 16, v244
ds_read_b128 v[204:207], v244
v_smfmac_f32_16x16x32_bf16 v[32:35], v[58:59], v[212:215], v246
s_waitcnt lgkmcnt(9)
v_smfmac_f32_16x16x32_bf16 v[0:3], v[60:61], v[224:227], v246
s_waitcnt lgkmcnt(8)
ds_read_b128 v[208:211], v244 offset:64
ds_read_b128 v[212:215], v244 offset:128
v_smfmac_f32_16x16x32_bf16 v[16:19], v[62:63], v[228:231], v246
s_waitcnt lgkmcnt(9)
v_smfmac_f32_16x16x32_bf16 v[32:35], v[64:65], v[232:235], v246
s_waitcnt lgkmcnt(8)
v_xor_b32 v242, 32, v242
ds_read_b128 v[224:227], v242
ds_read_b128 v[228:231], v242 offset:64
v_smfmac_f32_16x16x32_bf16 v[4:7], v[66:67], v[236:239], v246
s_waitcnt lgkmcnt(9)
v_smfmac_f32_16x16x32_bf16 v[20:23], v[68:69], v[216:219], v246
s_waitcnt lgkmcnt(8)
ds_read_b128 v[232:235], v242 offset:128
v_xor_b32 v243, 32, v243
ds_read_b128 v[236:239], v243
v_smfmac_f32_16x16x32_bf16 v[36:39], v[70:71], v[220:223], v246
s_waitcnt lgkmcnt(9)
v_smfmac_f32_16x16x32_bf16 v[4:7], v[72:73], v[192:195], v246
s_waitcnt lgkmcnt(8)
ds_read_b128 v[216:219], v243 offset:64
ds_read_b128 v[220:223], v243 offset:128
v_smfmac_f32_16x16x32_bf16 v[20:23], v[74:75], v[196:199], v246
s_waitcnt lgkmcnt(9)
v_smfmac_f32_16x16x32_bf16 v[36:39], v[76:77], v[200:203], v246
s_waitcnt lgkmcnt(8)
v_xor_b32 v244, 32, v244
ds_read_b128 v[192:195], v244
ds_read_b128 v[196:199], v244 offset:64
v_smfmac_f32_16x16x32_bf16 v[4:7], v[78:79], v[204:207], v246
s_waitcnt lgkmcnt(9)
v_smfmac_f32_16x16x32_bf16 v[20:23], v[80:81], v[208:211], v246
s_waitcnt lgkmcnt(8)
ds_read_b128 v[200:203], v244 offset:128
v_xor_b32 v242, 16, v242
ds_read_b128 v[204:207], v242
v_smfmac_f32_16x16x32_bf16 v[36:39], v[82:83], v[212:215], v246
s_waitcnt lgkmcnt(9)
v_smfmac_f32_16x16x32_bf16 v[12:15], v[84:85], v[224:227], v246
s_waitcnt lgkmcnt(8)
ds_read_b128 v[208:211], v242 offset:64
ds_read_b128 v[212:215], v242 offset:128
v_smfmac_f32_16x16x32_bf16 v[28:31], v[86:87], v[228:231], v246
s_waitcnt lgkmcnt(9)
v_smfmac_f32_16x16x32_bf16 v[44:47], v[88:89], v[232:235], v246
s_waitcnt lgkmcnt(8)
v_xor_b32 v243, 16, v243
ds_read_b128 v[224:227], v243
ds_read_b128 v[228:231], v243 offset:64
v_smfmac_f32_16x16x32_bf16 v[12:15], v[90:91], v[236:239], v246
s_waitcnt lgkmcnt(9)
v_smfmac_f32_16x16x32_bf16 v[28:31], v[92:93], v[216:219], v246
s_waitcnt lgkmcnt(8)
ds_read_b128 v[232:235], v243 offset:128
v_xor_b32 v244, 16, v244
ds_read_b128 v[236:239], v244
v_smfmac_f32_16x16x32_bf16 v[44:47], v[94:95], v[220:223], v246
s_waitcnt lgkmcnt(9)
v_smfmac_f32_16x16x32_bf16 v[12:15], v[96:97], v[192:195], v246
s_waitcnt lgkmcnt(8)
ds_read_b128 v[216:219], v244 offset:64
ds_read_b128 v[220:223], v244 offset:128
v_smfmac_f32_16x16x32_bf16 v[28:31], v[98:99], v[196:199], v246
s_waitcnt lgkmcnt(9)
v_smfmac_f32_16x16x32_bf16 v[44:47], v[100:101], v[200:203], v246
s_waitcnt lgkmcnt(8)
v_smfmac_f32_16x16x32_bf16 v[8:11], v[102:103], v[204:207], v246
s_waitcnt lgkmcnt(7)
v_smfmac_f32_16x16x32_bf16 v[24:27], v[104:105], v[208:211], v246
s_waitcnt lgkmcnt(6)
v_smfmac_f32_16x16x32_bf16 v[40:43], v[106:107], v[212:215], v246
s_waitcnt lgkmcnt(5)
v_smfmac_f32_16x16x32_bf16 v[8:11], v[108:109], v[224:227], v246
s_waitcnt lgkmcnt(4)
v_smfmac_f32_16x16x32_bf16 v[24:27], v[110:111], v[228:231], v246
s_waitcnt lgkmcnt(3)
v_smfmac_f32_16x16x32_bf16 v[40:43], v[112:113], v[232:235], v246
s_waitcnt lgkmcnt(2)
v_smfmac_f32_16x16x32_bf16 v[8:11], v[114:115], v[236:239], v246
s_waitcnt lgkmcnt(1)
v_smfmac_f32_16x16x32_bf16 v[24:27], v[116:117], v[216:219], v246
s_waitcnt lgkmcnt(0)
v_smfmac_f32_16x16x32_bf16 v[40:43], v[118:119], v[220:223], v246
s_nop 11
s_setpc_b64 s[78:79]
Lln0:
v_pk_add_f32 v[168:169], v[0:1], v[2:3]
v_pk_mul_f32 v[170:171], v[0:1], v[0:1]
v_pk_fma_f32 v[170:171], v[2:3], v[2:3], v[170:171]
v_pk_add_f32 v[168:169], v[168:169], v[4:5]
v_pk_fma_f32 v[170:171], v[4:5], v[4:5], v[170:171]
v_pk_add_f32 v[168:169], v[168:169], v[6:7]
v_pk_fma_f32 v[170:171], v[6:7], v[6:7], v[170:171]
v_pk_add_f32 v[168:169], v[168:169], v[8:9]
v_pk_fma_f32 v[170:171], v[8:9], v[8:9], v[170:171]
v_pk_add_f32 v[168:169], v[168:169], v[10:11]
v_pk_fma_f32 v[170:171], v[10:11], v[10:11], v[170:171]
v_pk_add_f32 v[168:169], v[168:169], v[12:13]
v_pk_fma_f32 v[170:171], v[12:13], v[12:13], v[170:171]
v_pk_add_f32 v[168:169], v[168:169], v[14:15]
v_pk_fma_f32 v[170:171], v[14:15], v[14:15], v[170:171]
v_pk_add_f32 v[168:169], v[168:169], v[16:17]
v_pk_fma_f32 v[170:171], v[16:17], v[16:17], v[170:171]
v_pk_add_f32 v[168:169], v[168:169], v[18:19]
v_pk_fma_f32 v[170:171], v[18:19], v[18:19], v[170:171]
v_pk_add_f32 v[168:169], v[168:169], v[20:21]
v_pk_fma_f32 v[170:171], v[20:21], v[20:21], v[170:171]
v_pk_add_f32 v[168:169], v[168:169], v[22:23]
v_pk_fma_f32 v[170:171], v[22:23], v[22:23], v[170:171]
v_pk_add_f32 v[168:169], v[168:169], v[24:25]
v_pk_fma_f32 v[170:171], v[24:25], v[24:25], v[170:171]
v_pk_add_f32 v[168:169], v[168:169], v[26:27]
v_pk_fma_f32 v[170:171], v[26:27], v[26:27], v[170:171]
v_pk_add_f32 v[168:169], v[168:169], v[28:29]
v_pk_fma_f32 v[170:171], v[28:29], v[28:29], v[170:171]
v_pk_add_f32 v[168:169], v[168:169], v[30:31]
v_pk_fma_f32 v[170:171], v[30:31], v[30:31], v[170:171]
v_pk_add_f32 v[168:169], v[168:169], v[32:33]
v_pk_fma_f32 v[170:171], v[32:33], v[32:33], v[170:171]
v_pk_add_f32 v[168:169], v[168:169], v[34:35]
v_pk_fma_f32 v[170:171], v[34:35], v[34:35], v[170:171]
v_pk_add_f32 v[168:169], v[168:169], v[36:37]
v_pk_fma_f32 v[170:171], v[36:37], v[36:37], v[170:171]
v_pk_add_f32 v[168:169], v[168:169], v[38:39]
v_pk_fma_f32 v[170:171], v[38:39], v[38:39], v[170:171]
v_pk_add_f32 v[168:169], v[168:169], v[40:41]
v_pk_fma_f32 v[170:171], v[40:41], v[40:41], v[170:171]
v_pk_add_f32 v[168:169], v[168:169], v[42:43]
v_pk_fma_f32 v[170:171], v[42:43], v[42:43], v[170:171]
v_pk_add_f32 v[168:169], v[168:169], v[44:45]
v_pk_fma_f32 v[170:171], v[44:45], v[44:45], v[170:171]
v_pk_add_f32 v[168:169], v[168:169], v[46:47]
v_pk_fma_f32 v[170:171], v[46:47], v[46:47], v[170:171]
v_add_f32 v168, v168, v169
v_add_f32 v170, v170, v171
s_nop 1
v_permlane32_swap_b32 v168, v170
v_add_f32_e64 v168, v168, v170
v_mul_f32 v168, 1009429163, v168
v_mov_b32_e64 v170, v168
s_nop 1
v_permlane32_swap_b32 v168, v170
v_fma_f32 v170, -v168, v168, v170
v_max_f32_e64 v170, 0, v170
v_add_f32 v170, 925353388, v170
v_rsq_f32 v170, v170
s_nop 0
v_mul_f32 v172, 3203391086, v170
v_mul_f32_e64 v173, v168, v172
v_pk_fma_f32 v[0:1], v[0:1], v[172:173], v[172:173] op_sel:[0,0,1] op_sel_hi:[1,0,1] neg_lo:[0,0,1] neg_hi:[0,0,1]
v_pk_fma_f32 v[2:3], v[2:3], v[172:173], v[172:173] op_sel:[0,0,1] op_sel_hi:[1,0,1] neg_lo:[0,0,1] neg_hi:[0,0,1]
v_pk_fma_f32 v[4:5], v[4:5], v[172:173], v[172:173] op_sel:[0,0,1] op_sel_hi:[1,0,1] neg_lo:[0,0,1] neg_hi:[0,0,1]
v_pk_fma_f32 v[6:7], v[6:7], v[172:173], v[172:173] op_sel:[0,0,1] op_sel_hi:[1,0,1] neg_lo:[0,0,1] neg_hi:[0,0,1]
v_pk_fma_f32 v[8:9], v[8:9], v[172:173], v[172:173] op_sel:[0,0,1] op_sel_hi:[1,0,1] neg_lo:[0,0,1] neg_hi:[0,0,1]
v_pk_fma_f32 v[10:11], v[10:11], v[172:173], v[172:173] op_sel:[0,0,1] op_sel_hi:[1,0,1] neg_lo:[0,0,1] neg_hi:[0,0,1]
v_pk_fma_f32 v[12:13], v[12:13], v[172:173], v[172:173] op_sel:[0,0,1] op_sel_hi:[1,0,1] neg_lo:[0,0,1] neg_hi:[0,0,1]
v_pk_fma_f32 v[14:15], v[14:15], v[172:173], v[172:173] op_sel:[0,0,1] op_sel_hi:[1,0,1] neg_lo:[0,0,1] neg_hi:[0,0,1]
v_pk_fma_f32 v[16:17], v[16:17], v[172:173], v[172:173] op_sel:[0,0,1] op_sel_hi:[1,0,1] neg_lo:[0,0,1] neg_hi:[0,0,1]
v_pk_fma_f32 v[18:19], v[18:19], v[172:173], v[172:173] op_sel:[0,0,1] op_sel_hi:[1,0,1] neg_lo:[0,0,1] neg_hi:[0,0,1]
v_pk_fma_f32 v[20:21], v[20:21], v[172:173], v[172:173] op_sel:[0,0,1] op_sel_hi:[1,0,1] neg_lo:[0,0,1] neg_hi:[0,0,1]
v_pk_fma_f32 v[22:23], v[22:23], v[172:173], v[172:173] op_sel:[0,0,1] op_sel_hi:[1,0,1] neg_lo:[0,0,1] neg_hi:[0,0,1]
v_pk_fma_f32 v[24:25], v[24:25], v[172:173], v[172:173] op_sel:[0,0,1] op_sel_hi:[1,0,1] neg_lo:[0,0,1] neg_hi:[0,0,1]
v_pk_fma_f32 v[26:27], v[26:27], v[172:173], v[172:173] op_sel:[0,0,1] op_sel_hi:[1,0,1] neg_lo:[0,0,1] neg_hi:[0,0,1]
v_pk_fma_f32 v[28:29], v[28:29], v[172:173], v[172:173] op_sel:[0,0,1] op_sel_hi:[1,0,1] neg_lo:[0,0,1] neg_hi:[0,0,1]
v_pk_fma_f32 v[30:31], v[30:31], v[172:173], v[172:173] op_sel:[0,0,1] op_sel_hi:[1,0,1] neg_lo:[0,0,1] neg_hi:[0,0,1]
v_pk_fma_f32 v[32:33], v[32:33], v[172:173], v[172:173] op_sel:[0,0,1] op_sel_hi:[1,0,1] neg_lo:[0,0,1] neg_hi:[0,0,1]
v_pk_fma_f32 v[34:35], v[34:35], v[172:173], v[172:173] op_sel:[0,0,1] op_sel_hi:[1,0,1] neg_lo:[0,0,1] neg_hi:[0,0,1]
v_pk_fma_f32 v[36:37], v[36:37], v[172:173], v[172:173] op_sel:[0,0,1] op_sel_hi:[1,0,1] neg_lo:[0,0,1] neg_hi:[0,0,1]
v_pk_fma_f32 v[38:39], v[38:39], v[172:173], v[172:173] op_sel:[0,0,1] op_sel_hi:[1,0,1] neg_lo:[0,0,1] neg_hi:[0,0,1]
v_pk_fma_f32 v[40:41], v[40:41], v[172:173], v[172:173] op_sel:[0,0,1] op_sel_hi:[1,0,1] neg_lo:[0,0,1] neg_hi:[0,0,1]
v_pk_fma_f32 v[42:43], v[42:43], v[172:173], v[172:173] op_sel:[0,0,1] op_sel_hi:[1,0,1] neg_lo:[0,0,1] neg_hi:[0,0,1]
v_pk_fma_f32 v[44:45], v[44:45], v[172:173], v[172:173] op_sel:[0,0,1] op_sel_hi:[1,0,1] neg_lo:[0,0,1] neg_hi:[0,0,1]
v_pk_fma_f32 v[46:47], v[46:47], v[172:173], v[172:173] op_sel:[0,0,1] op_sel_hi:[1,0,1] neg_lo:[0,0,1] neg_hi:[0,0,1]
v_cvt_pk_bf16_f32 v48, v0, v1
v_cvt_pk_bf16_f32 v49, v2, v3
v_cvt_pk_bf16_f32 v50, v4, v5
v_cvt_pk_bf16_f32 v51, v6, v7
v_cvt_pk_bf16_f32 v52, v8, v9
v_cvt_pk_bf16_f32 v53, v10, v11
v_cvt_pk_bf16_f32 v54, v12, v13
v_cvt_pk_bf16_f32 v55, v14, v15
v_cvt_pk_bf16_f32 v56, v16, v17
v_cvt_pk_bf16_f32 v57, v18, v19
v_cvt_pk_bf16_f32 v58, v20, v21
v_cvt_pk_bf16_f32 v59, v22, v23
v_cvt_pk_bf16_f32 v60, v24, v25
v_cvt_pk_bf16_f32 v61, v26, v27
v_cvt_pk_bf16_f32 v62, v28, v29
v_cvt_pk_bf16_f32 v63, v30, v31
v_cvt_pk_bf16_f32 v64, v32, v33
v_cvt_pk_bf16_f32 v65, v34, v35
v_cvt_pk_bf16_f32 v66, v36, v37
v_cvt_pk_bf16_f32 v67, v38, v39
v_cvt_pk_bf16_f32 v68, v40, v41
v_cvt_pk_bf16_f32 v69, v42, v43
v_cvt_pk_bf16_f32 v70, v44, v45
v_cvt_pk_bf16_f32 v71, v46, v47
s_nop 1
s_setpc_b64 s[78:79]
Lw1a:
ds_read_b64_tr_b16 v[148:149], v190
ds_read_b64_tr_b16 v[150:151], v190 offset:512
ds_read_b64_tr_b16 v[152:153], v190 offset:1024
ds_read_b64_tr_b16 v[154:155], v190 offset:1536
ds_read_b64_tr_b16 v[156:157], v190 offset:2048
ds_read_b64_tr_b16 v[158:159], v190 offset:2560
ds_read_b64_tr_b16 v[160:161], v190 offset:3072
ds_read_b64_tr_b16 v[162:163], v190 offset:3584
ds_read_b64_tr_b16 v[164:165], v190 offset:4096
ds_read_b64_tr_b16 v[166:167], v190 offset:4608
ds_read_b64_tr_b16 v[168:169], v190 offset:5120
ds_read_b64_tr_b16 v[170:171], v190 offset:5632
s_waitcnt lgkmcnt(10)
ds_write_b128 v191, v[148:151]
s_waitcnt lgkmcnt(9)
ds_write_b128 v191, v[152:155] offset:1024
s_waitcnt lgkmcnt(8)
ds_write_b128 v191, v[156:159] offset:2048
s_waitcnt lgkmcnt(7)
ds_write_b128 v191, v[160:163] offset:3072
s_waitcnt lgkmcnt(6)
ds_write_b128 v191, v[164:167] offset:4096
s_waitcnt lgkmcnt(5)
ds_write_b128 v191, v[168:171] offset:5120
s_waitcnt lgkmcnt(0)
s_setpc_b64 s[78:79]
Lw1i:
s_add_u32 m0, s77, 24576
s_add_u32 s43, s3, 256
buffer_load_dwordx4 v189, s[12:15], s43 offen lds
s_add_u32 m0, s77, 25600
s_add_u32 s43, s3, 24832
buffer_load_dwordx4 v189, s[12:15], s43 offen lds
s_add_u32 m0, s77, 26624
s_add_u32 s43, s3, 49408
buffer_load_dwordx4 v189, s[12:15], s43 offen lds
s_add_u32 m0, s77, 27648
s_add_u32 s43, s3, 12544
buffer_load_dwordx4 v189, s[12:15], s43 offen lds
s_add_u32 m0, s77, 28672
s_add_u32 s43, s3, 37120
buffer_load_dwordx4 v189, s[12:15], s43 offen lds
s_add_u32 m0, s77, 29696
s_add_u32 s43, s3, 61696
buffer_load_dwordx4 v189, s[12:15], s43 offen lds
s_add_u32 m0, s77, 49152
s_add_u32 s43, s3, 512
buffer_load_dwordx4 v189, s[12:15], s43 offen lds
s_add_u32 m0, s77, 50176
s_add_u32 s43, s3, 25088
buffer_load_dwordx4 v189, s[12:15], s43 offen lds
s_add_u32 m0, s77, 51200
s_add_u32 s43, s3, 49664
buffer_load_dwordx4 v189, s[12:15], s43 offen lds
s_add_u32 m0, s77, 52224
s_add_u32 s43, s3, 12800
buffer_load_dwordx4 v189, s[12:15], s43 offen lds
s_add_u32 m0, s77, 53248
s_add_u32 s43, s3, 37376
buffer_load_dwordx4 v189, s[12:15], s43 offen lds
s_add_u32 m0, s77, 54272
s_add_u32 s43, s3, 61952
buffer_load_dwordx4 v189, s[12:15], s43 offen lds
s_setpc_b64 s[78:79]
Lw1b:
s_waitcnt vmcnt(0)
ds_read_b64_tr_b16 v[72:73], v190 offset:24576
ds_read_b64_tr_b16 v[74:75], v190 offset:25088
ds_read_b64_tr_b16 v[76:77], v190 offset:25600
ds_read_b64_tr_b16 v[78:79], v190 offset:26112
ds_read_b64_tr_b16 v[80:81], v190 offset:26624
ds_read_b64_tr_b16 v[82:83], v190 offset:27136
ds_read_b64_tr_b16 v[84:85], v190 offset:27648
ds_read_b64_tr_b16 v[86:87], v190 offset:28160
ds_read_b64_tr_b16 v[88:89], v190 offset:28672
ds_read_b64_tr_b16 v[90:91], v190 offset:29184
ds_read_b64_tr_b16 v[92:93], v190 offset:29696
ds_read_b64_tr_b16 v[94:95], v190 offset:30208
ds_read_b64_tr_b16 v[96:97], v190 offset:49152
ds_read_b64_tr_b16 v[98:99], v190 offset:49664
ds_read_b64_tr_b16 v[100:101], v190 offset:50176
ds_read_b64_tr_b16 v[102:103], v190 offset:50688
ds_read_b64_tr_b16 v[104:105], v190 offset:51200
ds_read_b64_tr_b16 v[106:107], v190 offset:51712
ds_read_b64_tr_b16 v[108:109], v190 offset:52224
ds_read_b64_tr_b16 v[110:111], v190 offset:52736
ds_read_b64_tr_b16 v[112:113], v190 offset:53248
ds_read_b64_tr_b16 v[114:115], v190 offset:53760
ds_read_b64_tr_b16 v[116:117], v190 offset:54272
ds_read_b64_tr_b16 v[118:119], v190 offset:54784
s_waitcnt lgkmcnt(15)
ds_write_b128 v191, v[72:75] offset:24576
ds_write_b128 v191, v[76:79] offset:25600
ds_write_b128 v191, v[80:83] offset:26624
ds_write_b128 v191, v[84:87] offset:27648
s_waitcnt lgkmcnt(15)
ds_write_b128 v191, v[88:91] offset:28672
ds_write_b128 v191, v[92:95] offset:29696
s_waitcnt lgkmcnt(15)
ds_write_b128 v191, v[96:99] offset:49152
s_waitcnt lgkmcnt(15)
ds_write_b128 v191, v[100:103] offset:50176
s_waitcnt lgkmcnt(14)
ds_write_b128 v191, v[104:107] offset:51200
s_waitcnt lgkmcnt(13)
ds_write_b128 v191, v[108:111] offset:52224
s_waitcnt lgkmcnt(12)
ds_write_b128 v191, v[112:115] offset:53248
s_waitcnt lgkmcnt(11)
ds_write_b128 v191, v[116:119] offset:54272
s_waitcnt lgkmcnt(0)
s_setpc_b64 s[78:79]
Lpre:
ds_read_b128 v[48:51], v245
ds_read_b128 v[52:55], v245 offset:384
ds_read_b128 v[56:59], v245 offset:768
ds_read_b128 v[60:63], v245 offset:1152
ds_read_b128 v[64:67], v245 offset:1536
ds_read_b128 v[68:71], v245 offset:1920
ds_read_b128 v[72:75], v245 offset:2304
ds_read_b128 v[76:79], v245 offset:2688
ds_read_b128 v[80:83], v245 offset:3072
ds_read_b128 v[84:87], v245 offset:3456
ds_read_b128 v[88:91], v245 offset:3840
ds_read_b128 v[92:95], v245 offset:4224
ds_read_b128 v[96:99], v245 offset:4608
ds_read_b128 v[100:103], v245 offset:4992
ds_read_b128 v[104:107], v245 offset:5376
ds_read_b128 v[108:111], v245 offset:5760
ds_read_b128 v[112:115], v245 offset:6144
ds_read_b128 v[116:119], v245 offset:6528
v_mov_b32 v0, 0
v_mov_b32 v1, 0
v_mov_b32 v2, 0
v_mov_b32 v3, 0
v_mov_b32 v4, 0
v_mov_b32 v5, 0
v_mov_b32 v6, 0
v_mov_b32 v7, 0
v_mov_b32 v8, 0
v_mov_b32 v9, 0
v_mov_b32 v10, 0
v_mov_b32 v11, 0
v_mov_b32 v12, 0
v_mov_b32 v13, 0
v_mov_b32 v14, 0
v_mov_b32 v15, 0
v_mov_b32 v16, 0
v_mov_b32 v17, 0
v_mov_b32 v18, 0
v_mov_b32 v19, 0
v_mov_b32 v20, 0
v_mov_b32 v21, 0
v_mov_b32 v22, 0
v_mov_b32 v23, 0
v_mov_b32 v24, 0
v_mov_b32 v25, 0
v_mov_b32 v26, 0
v_mov_b32 v27, 0
v_mov_b32 v28, 0
v_mov_b32 v29, 0
v_mov_b32 v30, 0
v_mov_b32 v31, 0
v_mov_b32 v32, 0
v_mov_b32 v33, 0
v_mov_b32 v34, 0
v_mov_b32 v35, 0
v_mov_b32 v36, 0
v_mov_b32 v37, 0
v_mov_b32 v38, 0
v_mov_b32 v39, 0
v_mov_b32 v40, 0
v_mov_b32 v41, 0
v_mov_b32 v42, 0
v_mov_b32 v43, 0
v_mov_b32 v44, 0
v_mov_b32 v45, 0
v_mov_b32_e64 v46, 0
v_mov_b32 v47, 0
s_waitcnt lgkmcnt(0)
s_setpc_b64 s[78:79]
Lrb:
s_add_u32 m0, s67, 39936
s_add_u32 s45, s66, 491520
buffer_load_dwordx4 v240, s[4:7], s45 offen nt lds
s_add_u32 m0, s67, 46592
s_add_u32 s45, s66, 589824
buffer_load_dwordx4 v240, s[4:7], s45 offen nt lds
s_add_u32 m0, s67, 53248
s_add_u32 s45, s66, 688128
buffer_load_dwordx4 v240, s[4:7], s45 offen nt lds
s_add_u32 m0, s67, 59904
s_add_u32 s45, s66, 786432
buffer_load_dwordx4 v240, s[4:7], s45 offen nt lds
s_setpc_b64 s[78:79]
Lw1f:
s_add_u32 m0, s77, 0
s_add_u32 s43, s3, 0
buffer_load_dwordx4 v189, s[12:15], s43 offen lds
s_add_u32 m0, s77, 1024
s_add_u32 s43, s3, 24576
buffer_load_dwordx4 v189, s[12:15], s43 offen lds
s_add_u32 m0, s77, 2048
s_add_u32 s43, s3, 49152
buffer_load_dwordx4 v189, s[12:15], s43 offen lds
s_add_u32 m0, s77, 3072
s_add_u32 s43, s3, 12288
buffer_load_dwordx4 v189, s[12:15], s43 offen lds
s_add_u32 m0, s77, 4096
s_add_u32 s43, s3, 36864
buffer_load_dwordx4 v189, s[12:15], s43 offen lds
s_add_u32 m0, s77, 5120
s_add_u32 s43, s3, 61440
buffer_load_dwordx4 v189, s[12:15], s43 offen lds
s_setpc_b64 s[78:79]
Lgo:
v_mov_b32 v253, 16256
Lsw204w:
ds_read_b32 v247, v253 offset:20
s_waitcnt lgkmcnt(0)
v_readfirstlane_b32 s43, v247
s_cmp_eq_u32 s76, 0
s_cbranch_scc1 Lsw204x
s_sub_u32 s76, s76, 1
s_cmp_lt_u32 s43, 4
s_cbranch_scc0 Lsw204x
s_sleep 2
s_branch Lsw204w
Lsw204x:
s_cmp_lg_u32 s40, 7
s_cbranch_scc1 Lnopf
s_getpc_b64 s[74:75]
Lpc:
s_lshr_b32 s43, s2, 3
s_and_b32 s43, s43, 15
s_lshl_b32 s43, s43, 13
v_lshlrev_b32 v178, 7, v251
v_add_u32 v178, s43, v178
v_min_u32 v178, Lend-Lpc, v178
global_load_dword v255, v178, s[74:75]
Lnopf:
s_add_u32 s66, s66, 786432
ds_read_b128 v[224:227], v248 offset:16384
ds_read_b128 v[228:231], v248 offset:19456
ds_read_b128 v[232:235], v248 offset:17408
ds_read_b128 v[236:239], v248 offset:20480
ds_read_b128 v[216:219], v248 offset:18432
ds_read_b128 v[220:223], v248 offset:21504
s_setprio 2
s_waitcnt lgkmcnt(5)
v_mfma_f32_32x32x16_bf16 v[120:135], v[48:51], v[224:227], 0
s_waitcnt lgkmcnt(4)
ds_read_b128 v[224:227], v248 offset:22528
v_mfma_f32_32x32x16_bf16 v[120:135], v[52:55], v[228:231], v[120:135]
s_waitcnt lgkmcnt(4)
ds_read_b128 v[228:231], v248 offset:25600
v_mfma_f32_32x32x16_bf16 v[120:135], v[56:59], v[232:235], v[120:135]
s_waitcnt lgkmcnt(4)
ds_read_b128 v[232:235], v248 offset:23552
v_mfma_f32_32x32x16_bf16 v[120:135], v[60:63], v[236:239], v[120:135]
s_waitcnt lgkmcnt(4)
ds_read_b128 v[236:239], v248 offset:26624
v_mfma_f32_32x32x16_bf16 v[120:135], v[64:67], v[216:219], v[120:135]
s_waitcnt lgkmcnt(4)
ds_read_b128 v[216:219], v248 offset:24576
v_mfma_f32_32x32x16_bf16 v[120:135], v[68:71], v[220:223], v[120:135]
v_add_u32 v174, -36864, v242
v_subrev_u32 v175, 66560, v174
v_min_u32 v174, v174, v175
v_add_u32 v174, 90112, v174
v_sub_u32 v175, v174, v242
v_add_u32 v242, v175, v242
v_add_u32_e64 v243, v175, v243
v_add_u32 v244, v175, v244
s_nop 3
v_cvt_pkrtz_f16_f32 v137, v120, v121
v_cvt_pkrtz_f16_f32 v139, v122, v123
v_cvt_pkrtz_f16_f32 v141, v124, v125
v_cvt_pkrtz_f16_f32 v143, v126, v127
v_cvt_pkrtz_f16_f32 v145, v128, v129
v_cvt_pk_f16_f32 v155, v130, v131
v_cvt_pk_f16_f32 v152, v132, v133
v_cvt_pk_f16_f32 v149, v134, v135
s_waitcnt lgkmcnt(1)
ds_read_b128 v[220:223], v248 offset:27648
v_mfma_f32_32x32x16_bf16 v[120:135], v[48:51], v[224:227], 0
v_pk_fma_f16 v154, v155, v155, s48
v_and_b32 v137, s49, v137
v_pk_fma_f16 v151, v152, v152, s48
v_and_b32_e64 v139, s49, v139
v_pk_fma_f16 v148, v149, v149, s48
v_pk_mul_f16 v154, v155, v154
v_bfe_u32 v136, v137, 2, 14
v_pk_mul_f16 v151, v152, v151
v_pk_mul_f16 v148, v149, v148
v_bfe_u32 v138, v139, 2, 14
ds_read_b128 v[224:227], v248 offset:28672
ds_read_u16_d16 v136, v136
ds_read_u16_d16 v138, v138
v_mfma_f32_32x32x16_bf16 v[120:135], v[52:55], v[228:231], v[120:135]
v_exp_f16 v153, v154
v_lshrrev_b32 v137, 18, v137
v_exp_f16 v150, v151
v_lshrrev_b32 v139, 18, v139
v_exp_f16 v147, v148
v_and_b32 v141, s49, v141
v_and_b32_e64 v143, s49, v143
ds_read_b128 v[228:231], v248 offset:31744
ds_read_u16_d16_hi v137, v137
ds_read_u16_d16_hi v139, v139
v_mfma_f32_32x32x16_bf16 v[120:135], v[56:59], v[232:235], v[120:135]
v_exp_f16_sdwa v153, v154 dst_sel:WORD_1 dst_unused:UNUSED_PRESERVE src0_sel:WORD_1
v_bfe_u32 v140, v141, 2, 14
v_exp_f16_sdwa v150, v151 dst_sel:WORD_1 dst_unused:UNUSED_PRESERVE src0_sel:WORD_1
v_bfe_u32 v142, v143, 2, 14
v_exp_f16_sdwa v147, v148 dst_sel:WORD_1 dst_unused:UNUSED_PRESERVE src0_sel:WORD_1
v_lshrrev_b32_e64 v141, 18, v141
v_pk_add_f16 v153, v153, 1.0 op_sel_hi:[1,0]
ds_read_b128 v[232:235], v248 offset:29696
ds_read_u16_d16 v140, v140
ds_read_u16_d16 v142, v142
ds_read_u16_d16_hi v141, v141
v_mfma_f32_32x32x16_bf16 v[120:135], v[60:63], v[236:239], v[120:135]
v_lshrrev_b32_e64 v143, 18, v143
v_pk_add_f16 v150, v150, 1.0 op_sel_hi:[1,0]
v_pk_add_f16 v147, v147, 1.0 op_sel_hi:[1,0]
v_and_b32 v145, s49, v145
v_rcp_f16 v154, v153
v_bfe_u32 v144, v145, 2, 14
v_rcp_f16_e64 v151, v150
v_lshrrev_b32 v145, 18, v145
s_waitcnt lgkmcnt(7)
ds_read_b128 v[236:239], v248 offset:32768
ds_read_u16_d16_hi v143, v143
ds_read_u16_d16 v144, v144
ds_read_u16_d16_hi v145, v145
v_mfma_f32_32x32x16_bf16 v[120:135], v[64:67], v[216:219], v[120:135]
v_rcp_f16_e64 v148, v147
v_rcp_f16_sdwa v154, v153 dst_sel:WORD_1 dst_unused:UNUSED_PRESERVE src0_sel:WORD_1
v_fma_mix_f32 v156, v136, v136, 0 op_sel:[0,0,0] op_sel_hi:[1,1,0]
ds_read_b32 v247, v253 offset:16
s_waitcnt lgkmcnt(9)
v_fma_mix_f32 v156, v137, v137, v156 op_sel:[1,1,0] op_sel_hi:[1,1,0]
v_rcp_f16_sdwa v151, v150 dst_sel:WORD_1 dst_unused:UNUSED_PRESERVE src0_sel:WORD_1
v_fma_mix_f32 v156, v138, v138, v156 op_sel:[0,0,0] op_sel_hi:[1,1,0]
ds_read_b128 v[216:219], v248 offset:30720
v_mfma_f32_32x32x16_bf16 v[120:135], v[68:71], v[220:223], v[120:135]
v_rcp_f16_sdwa v148, v147 dst_sel:WORD_1 dst_unused:UNUSED_PRESERVE src0_sel:WORD_1
v_fma_mix_f32 v156, v139, v139, v156 op_sel:[1,1,0] op_sel_hi:[1,1,0]
v_pk_mul_f16 v155, v155, v154
s_waitcnt lgkmcnt(6)
v_fma_mix_f32 v156, v140, v140, v156 op_sel:[0,0,0] op_sel_hi:[1,1,0]
v_pk_mul_f16 v152, v152, v151
v_fma_mix_f32 v156, v141, v141, v156 op_sel:[1,1,0] op_sel_hi:[1,1,0]
v_pk_mul_f16 v149, v149, v148
v_fma_mix_f32 v156, v155, v155, v156 op_sel:[0,0,0] op_sel_hi:[1,1,0]
v_fma_mix_f32 v156, v142, v142, v156 op_sel:[0,0,0] op_sel_hi:[1,1,0]
v_fma_mix_f32 v156, v155, v155, v156 op_sel:[1,1,0] op_sel_hi:[1,1,0]
s_waitcnt lgkmcnt(4)
v_fma_mix_f32 v156, v143, v143, v156 op_sel:[1,1,0] op_sel_hi:[1,1,0]
v_fma_mix_f32 v156, v152, v152, v156 op_sel:[0,0,0] op_sel_hi:[1,1,0]
v_fma_mix_f32 v156, v152, v152, v156 op_sel:[1,1,0] op_sel_hi:[1,1,0]
s_waitcnt lgkmcnt(2)
v_fma_mix_f32 v156, v144, v144, v156 op_sel:[0,0,0] op_sel_hi:[1,1,0]
v_fma_mix_f32 v156, v149, v149, v156 op_sel:[0,0,0] op_sel_hi:[1,1,0]
v_fma_mix_f32 v156, v145, v145, v156 op_sel:[1,1,0] op_sel_hi:[1,1,0]
v_fma_mix_f32 v156, v149, v149, v156 op_sel:[1,1,0] op_sel_hi:[1,1,0]
s_cmp_lt_u32 s40, 4
s_cbranch_scc0 Lsu5
s_call_b64 s[78:79], Lw1b
s_mov_b64 exec, 1
ds_add_u32 v253, v254 offset:24
s_mov_b64 exec, -1
Lsu5:
s_waitcnt lgkmcnt(0)
v_readfirstlane_b32 s43, v247
s_nop 1
s_cmp_ge_u32 s43, 8
s_cbranch_scc1 Lev1
Lev1w:
s_sleep 1
ds_read_b32 v247, v253 offset:16
s_waitcnt lgkmcnt(0)
v_readfirstlane_b32 s43, v247
s_cmp_eq_u32 s76, 0
s_cbranch_scc1 Lev1
s_sub_u32 s76, s76, 1
s_cmp_lt_u32 s43, 8
s_cbranch_scc1 Lev1w
Lev1:
v_cvt_pkrtz_f16_f32 v137, v120, v121
v_cvt_pkrtz_f16_f32 v139, v122, v123
v_cvt_pkrtz_f16_f32 v141, v124, v125
v_cvt_pkrtz_f16_f32 v143, v126, v127
v_cvt_pkrtz_f16_f32 v145, v128, v129
v_cvt_pk_f16_f32 v155, v130, v131
v_cvt_pk_f16_f32 v152, v132, v133
v_cvt_pk_f16_f32 v149, v134, v135
s_add_u32 m0, s67, 0
s_add_u32 s66, s66, 98304
buffer_load_dwordx4 v240, s[4:7], s66 offen lds
ds_read_b128 v[220:223], v248 offset:33792
v_mfma_f32_32x32x16_bf16 v[120:135], v[48:51], v[224:227], 0
v_pk_fma_f16 v154, v155, v155, s48
v_and_b32 v137, s49, v137
v_pk_fma_f16 v151, v152, v152, s48
v_and_b32_e64 v139, s49, v139
v_pk_fma_f16 v148, v149, v149, s48
v_pk_mul_f16 v154, v155, v154
v_bfe_u32 v136, v137, 2, 14
v_pk_mul_f16 v151, v152, v151
v_pk_mul_f16 v148, v149, v148
v_bfe_u32 v138, v139, 2, 14
s_add_u32 m0, s67, 6656
s_add_u32 s66, s66, 98304
buffer_load_dwordx4 v240, s[4:7], s66 offen lds
ds_read_b128 v[224:227], v248 offset:34816
ds_read_u16_d16 v136, v136
ds_read_u16_d16 v138, v138
v_mfma_f32_32x32x16_bf16 v[120:135], v[52:55], v[228:231], v[120:135]
v_exp_f16 v153, v154
v_lshrrev_b32 v137, 18, v137
v_exp_f16 v150, v151
v_lshrrev_b32 v139, 18, v139
v_exp_f16 v147, v148
v_and_b32 v141, s49, v141
v_and_b32_e64 v143, s49, v143
s_add_u32 m0, s67, 13312
s_add_u32 s66, s66, 98304
buffer_load_dwordx4 v240, s[4:7], s66 offen lds
ds_read_b128 v[228:231], v248 offset:37888
ds_read_u16_d16_hi v137, v137
ds_read_u16_d16_hi v139, v139
v_mfma_f32_32x32x16_bf16 v[120:135], v[56:59], v[232:235], v[120:135]
v_exp_f16_sdwa v153, v154 dst_sel:WORD_1 dst_unused:UNUSED_PRESERVE src0_sel:WORD_1
v_bfe_u32 v140, v141, 2, 14
v_exp_f16_sdwa v150, v151 dst_sel:WORD_1 dst_unused:UNUSED_PRESERVE src0_sel:WORD_1
v_bfe_u32 v142, v143, 2, 14
v_exp_f16_sdwa v147, v148 dst_sel:WORD_1 dst_unused:UNUSED_PRESERVE src0_sel:WORD_1
v_lshrrev_b32_e64 v141, 18, v141
v_pk_add_f16 v153, v153, 1.0 op_sel_hi:[1,0]
s_add_u32 m0, s67, 19968
s_add_u32 s66, s66, 98304
buffer_load_dwordx4 v240, s[4:7], s66 offen lds
s_add_u32 m0, s67, 26624
s_add_u32 s66, s66, 98304
buffer_load_dwordx4 v240, s[4:7], s66 offen lds
ds_read_b128 v[232:235], v248 offset:35840
ds_read_u16_d16 v140, v140
ds_read_u16_d16 v142, v142
ds_read_u16_d16_hi v141, v141
v_mfma_f32_32x32x16_bf16 v[120:135], v[60:63], v[236:239], v[120:135]
v_lshrrev_b32_e64 v143, 18, v143
v_pk_add_f16 v150, v150, 1.0 op_sel_hi:[1,0]
v_pk_add_f16 v147, v147, 1.0 op_sel_hi:[1,0]
v_and_b32 v145, s49, v145
v_rcp_f16 v154, v153
v_bfe_u32 v144, v145, 2, 14
v_rcp_f16 v151, v150
v_lshrrev_b32 v145, 18, v145
s_add_u32 m0, s67, 33280
s_add_u32 s66, s66, 98304
buffer_load_dwordx4 v240, s[4:7], s66 offen lds
ds_read_b128 v[236:239], v248 offset:38912
ds_read_u16_d16_hi v143, v143
ds_read_u16_d16 v144, v144
ds_read_u16_d16_hi v145, v145
v_mfma_f32_32x32x16_bf16 v[120:135], v[64:67], v[216:219], v[120:135]
v_rcp_f16_e64 v148, v147
v_rcp_f16_sdwa v154, v153 dst_sel:WORD_1 dst_unused:UNUSED_PRESERVE src0_sel:WORD_1
s_waitcnt lgkmcnt(8)
v_fma_mix_f32 v157, v136, v136, 0 op_sel:[0,0,0] op_sel_hi:[1,1,0]
v_fma_mix_f32 v157, v137, v137, v157 op_sel:[1,1,0] op_sel_hi:[1,1,0]
v_rcp_f16_sdwa v151, v150 dst_sel:WORD_1 dst_unused:UNUSED_PRESERVE src0_sel:WORD_1
v_fma_mix_f32 v157, v138, v138, v157 op_sel:[0,0,0] op_sel_hi:[1,1,0]
s_add_u32 m0, s67, 39936
s_add_u32 s66, s66, 98304
buffer_load_dwordx4 v240, s[4:7], s66 offen lds
ds_read_b128 v[216:219], v248 offset:36864
v_mfma_f32_32x32x16_bf16 v[120:135], v[68:71], v[220:223], v[120:135]
v_rcp_f16_sdwa v148, v147 dst_sel:WORD_1 dst_unused:UNUSED_PRESERVE src0_sel:WORD_1
v_fma_mix_f32 v157, v139, v139, v157 op_sel:[1,1,0] op_sel_hi:[1,1,0]
v_pk_mul_f16 v155, v155, v154
s_waitcnt lgkmcnt(5)
v_fma_mix_f32 v157, v140, v140, v157 op_sel:[0,0,0] op_sel_hi:[1,1,0]
v_pk_mul_f16 v152, v152, v151
v_fma_mix_f32 v157, v141, v141, v157 op_sel:[1,1,0] op_sel_hi:[1,1,0]
v_pk_mul_f16 v149, v149, v148
v_fma_mix_f32 v157, v155, v155, v157 op_sel:[0,0,0] op_sel_hi:[1,1,0]
v_fma_mix_f32 v157, v142, v142, v157 op_sel:[0,0,0] op_sel_hi:[1,1,0]
v_fma_mix_f32 v157, v155, v155, v157 op_sel:[1,1,0] op_sel_hi:[1,1,0]
s_add_u32 m0, s67, 46592
s_add_u32 s66, s66, 98304
buffer_load_dwordx4 v240, s[4:7], s66 offen lds
s_waitcnt lgkmcnt(1)
v_fma_mix_f32 v157, v143, v143, v157 op_sel:[1,1,0] op_sel_hi:[1,1,0]
v_fma_mix_f32 v157, v152, v152, v157 op_sel:[0,0,0] op_sel_hi:[1,1,0]
v_fma_mix_f32 v157, v152, v152, v157 op_sel:[1,1,0] op_sel_hi:[1,1,0]
v_fma_mix_f32 v157, v144, v144, v157 op_sel:[0,0,0] op_sel_hi:[1,1,0]
v_fma_mix_f32 v157, v149, v149, v157 op_sel:[0,0,0] op_sel_hi:[1,1,0]
v_fma_mix_f32 v157, v145, v145, v157 op_sel:[1,1,0] op_sel_hi:[1,1,0]
v_fma_mix_f32 v157, v149, v149, v157 op_sel:[1,1,0] op_sel_hi:[1,1,0]
s_setprio 1
v_cvt_pkrtz_f16_f32 v137, v120, v121
v_cvt_pkrtz_f16_f32 v139, v122, v123
v_cvt_pkrtz_f16_f32 v141, v124, v125
v_cvt_pkrtz_f16_f32 v143, v126, v127
v_cvt_pkrtz_f16_f32 v145, v128, v129
v_cvt_pk_f16_f32 v155, v130, v131
v_cvt_pk_f16_f32 v152, v132, v133
v_cvt_pk_f16_f32 v149, v134, v135
ds_read_b128 v[220:223], v248 offset:39936
v_mfma_f32_32x32x16_bf16 v[120:135], v[48:51], v[224:227], 0
v_pk_fma_f16 v154, v155, v155, s48
v_and_b32_e64 v137, s49, v137
v_pk_fma_f16 v151, v152, v152, s48
v_and_b32_e64 v139, s49, v139
v_pk_fma_f16 v148, v149, v149, s48
v_pk_mul_f16 v154, v155, v154
v_bfe_u32 v136, v137, 2, 14
v_pk_mul_f16 v151, v152, v151
v_pk_mul_f16 v148, v149, v148
v_bfe_u32 v138, v139, 2, 14
ds_read_u16_d16 v136, v136
ds_read_b32 v247, v253 offset:24
ds_read_u16_d16 v138, v138
v_mfma_f32_32x32x16_bf16 v[120:135], v[52:55], v[228:231], v[120:135]
v_exp_f16 v153, v154
v_lshrrev_b32 v137, 18, v137
v_exp_f16 v150, v151
v_lshrrev_b32 v139, 18, v139
v_exp_f16 v147, v148
v_and_b32 v141, s49, v141
v_and_b32_e64 v143, s49, v143
ds_read_u16_d16_hi v137, v137
ds_read_u16_d16_hi v139, v139
v_mfma_f32_32x32x16_bf16 v[120:135], v[56:59], v[232:235], v[120:135]
v_exp_f16_sdwa v153, v154 dst_sel:WORD_1 dst_unused:UNUSED_PRESERVE src0_sel:WORD_1
v_bfe_u32 v140, v141, 2, 14
v_exp_f16_sdwa v150, v151 dst_sel:WORD_1 dst_unused:UNUSED_PRESERVE src0_sel:WORD_1
v_bfe_u32 v142, v143, 2, 14
v_exp_f16_sdwa v147, v148 dst_sel:WORD_1 dst_unused:UNUSED_PRESERVE src0_sel:WORD_1
v_lshrrev_b32_e64 v141, 18, v141
v_pk_add_f16 v153, v153, 1.0 op_sel_hi:[1,0]
ds_read_u16_d16 v140, v140
ds_read_u16_d16 v142, v142
ds_read_u16_d16_hi v141, v141
s_waitcnt lgkmcnt(6)
v_readfirstlane_b32 s43, v247
s_nop 1
s_cmp_ge_u32 s43, 4
s_cbranch_scc1 Lev2
Lev2w:
s_sleep 1
ds_read_b32 v247, v253 offset:24
s_waitcnt lgkmcnt(0)
v_readfirstlane_b32 s43, v247
s_cmp_eq_u32 s76, 0
s_cbranch_scc1 Lev2
s_sub_u32 s76, s76, 1
s_cmp_lt_u32 s43, 4
s_cbranch_scc1 Lev2w
Lev2:
ds_read_b128 v[224:227], v248 offset:40960
ds_read_b128 v[228:231], v248 offset:44032
ds_read_b128 v[232:235], v248 offset:41984
v_mfma_f32_32x32x16_bf16 v[120:135], v[60:63], v[236:239], v[120:135]
v_lshrrev_b32 v143, 18, v143
v_pk_add_f16 v150, v150, 1.0 op_sel_hi:[1,0]
v_pk_add_f16 v147, v147, 1.0 op_sel_hi:[1,0]
v_and_b32 v145, s49, v145
v_rcp_f16 v154, v153
v_bfe_u32 v144, v145, 2, 14
v_rcp_f16 v151, v150
v_lshrrev_b32 v145, 18, v145
ds_read_b128 v[236:239], v248 offset:45056
ds_read_u16_d16_hi v143, v143
ds_read_u16_d16 v144, v144
ds_read_u16_d16_hi v145, v145
v_mfma_f32_32x32x16_bf16 v[120:135], v[64:67], v[216:219], v[120:135]
v_rcp_f16 v148, v147
v_rcp_f16_sdwa v154, v153 dst_sel:WORD_1 dst_unused:UNUSED_PRESERVE src0_sel:WORD_1
v_fma_mix_f32 v158, v136, v136, 0 op_sel:[0,0,0] op_sel_hi:[1,1,0]
s_waitcnt lgkmcnt(7)
v_fma_mix_f32 v158, v137, v137, v158 op_sel:[1,1,0] op_sel_hi:[1,1,0]
v_rcp_f16_sdwa v151, v150 dst_sel:WORD_1 dst_unused:UNUSED_PRESERVE src0_sel:WORD_1
v_fma_mix_f32 v158, v138, v138, v158 op_sel:[0,0,0] op_sel_hi:[1,1,0]
ds_read_b128 v[216:219], v248 offset:43008
v_mfma_f32_32x32x16_bf16 v[120:135], v[68:71], v[220:223], v[120:135]
v_rcp_f16_sdwa v148, v147 dst_sel:WORD_1 dst_unused:UNUSED_PRESERVE src0_sel:WORD_1
v_fma_mix_f32 v158, v139, v139, v158 op_sel:[1,1,0] op_sel_hi:[1,1,0]
v_pk_mul_f16 v155, v155, v154
v_fma_mix_f32 v158, v140, v140, v158 op_sel:[0,0,0] op_sel_hi:[1,1,0]
v_pk_mul_f16 v152, v152, v151
v_fma_mix_f32 v158, v141, v141, v158 op_sel:[1,1,0] op_sel_hi:[1,1,0]
v_pk_mul_f16 v149, v149, v148
v_fma_mix_f32 v158, v155, v155, v158 op_sel:[0,0,0] op_sel_hi:[1,1,0]
v_fma_mix_f32 v158, v142, v142, v158 op_sel:[0,0,0] op_sel_hi:[1,1,0]
v_fma_mix_f32 v158, v155, v155, v158 op_sel:[1,1,0] op_sel_hi:[1,1,0]
s_waitcnt lgkmcnt(3)
v_fma_mix_f32 v158, v143, v143, v158 op_sel:[1,1,0] op_sel_hi:[1,1,0]
v_fma_mix_f32 v158, v152, v152, v158 op_sel:[0,0,0] op_sel_hi:[1,1,0]
v_fma_mix_f32 v158, v152, v152, v158 op_sel:[1,1,0] op_sel_hi:[1,1,0]
s_waitcnt lgkmcnt(1)
v_fma_mix_f32 v158, v144, v144, v158 op_sel:[0,0,0] op_sel_hi:[1,1,0]
v_fma_mix_f32 v158, v149, v149, v158 op_sel:[0,0,0] op_sel_hi:[1,1,0]
v_fma_mix_f32 v158, v145, v145, v158 op_sel:[1,1,0] op_sel_hi:[1,1,0]
v_fma_mix_f32 v158, v149, v149, v158 op_sel:[1,1,0] op_sel_hi:[1,1,0]
v_cvt_pkrtz_f16_f32 v137, v120, v121
v_cvt_pkrtz_f16_f32 v139, v122, v123
v_cvt_pkrtz_f16_f32 v141, v124, v125
v_cvt_pkrtz_f16_f32 v143, v126, v127
v_cvt_pkrtz_f16_f32 v145, v128, v129
v_cvt_pk_f16_f32 v155, v130, v131
v_cvt_pk_f16_f32 v152, v132, v133
v_cvt_pk_f16_f32 v149, v134, v135
ds_read_b128 v[220:223], v248 offset:46080
v_mfma_f32_32x32x16_bf16 v[120:135], v[48:51], v[224:227], 0
v_pk_fma_f16 v154, v155, v155, s48
v_and_b32_e64 v137, s49, v137
v_pk_fma_f16 v151, v152, v152, s48
v_and_b32_e64 v139, s49, v139
v_pk_fma_f16 v148, v149, v149, s48
v_pk_mul_f16 v154, v155, v154
v_bfe_u32 v136, v137, 2, 14
v_pk_mul_f16 v151, v152, v151
v_pk_mul_f16 v148, v149, v148
v_bfe_u32 v138, v139, 2, 14
ds_read_b128 v[224:227], v248 offset:47104
ds_read_u16_d16 v136, v136
ds_read_u16_d16 v138, v138
v_mfma_f32_32x32x16_bf16 v[120:135], v[52:55], v[228:231], v[120:135]
v_exp_f16 v153, v154
v_lshrrev_b32 v137, 18, v137
v_exp_f16 v150, v151
v_lshrrev_b32 v139, 18, v139
v_exp_f16 v147, v148
v_and_b32 v141, s49, v141
v_and_b32_e64 v143, s49, v143
ds_read_b128 v[228:231], v248 offset:50176
ds_read_u16_d16_hi v137, v137
ds_read_u16_d16_hi v139, v139
v_mfma_f32_32x32x16_bf16 v[120:135], v[56:59], v[232:235], v[120:135]
v_exp_f16_sdwa v153, v154 dst_sel:WORD_1 dst_unused:UNUSED_PRESERVE src0_sel:WORD_1
v_bfe_u32 v140, v141, 2, 14
v_exp_f16_sdwa v150, v151 dst_sel:WORD_1 dst_unused:UNUSED_PRESERVE src0_sel:WORD_1
v_bfe_u32 v142, v143, 2, 14
v_exp_f16_sdwa v147, v148 dst_sel:WORD_1 dst_unused:UNUSED_PRESERVE src0_sel:WORD_1
v_lshrrev_b32_e64 v141, 18, v141
v_pk_add_f16 v153, v153, 1.0 op_sel_hi:[1,0]
ds_read_b128 v[232:235], v248 offset:48128
ds_read_u16_d16 v140, v140
ds_read_u16_d16 v142, v142
ds_read_u16_d16_hi v141, v141
v_mfma_f32_32x32x16_bf16 v[120:135], v[60:63], v[236:239], v[120:135]
v_lshrrev_b32_e64 v143, 18, v143
v_pk_add_f16 v150, v150, 1.0 op_sel_hi:[1,0]
v_pk_add_f16 v147, v147, 1.0 op_sel_hi:[1,0]
v_and_b32 v145, s49, v145
v_rcp_f16 v154, v153
v_bfe_u32 v144, v145, 2, 14
v_rcp_f16_e64 v151, v150
v_lshrrev_b32 v145, 18, v145
s_waitcnt lgkmcnt(7)
ds_read_b128 v[236:239], v248 offset:51200
ds_read_u16_d16_hi v143, v143
ds_read_u16_d16 v144, v144
ds_read_u16_d16_hi v145, v145
v_mfma_f32_32x32x16_bf16 v[120:135], v[64:67], v[216:219], v[120:135]
v_rcp_f16 v148, v147
v_rcp_f16_sdwa v154, v153 dst_sel:WORD_1 dst_unused:UNUSED_PRESERVE src0_sel:WORD_1
v_fma_mix_f32 v159, v136, v136, 0 op_sel:[0,0,0] op_sel_hi:[1,1,0]
s_waitcnt lgkmcnt(8)
v_fma_mix_f32 v159, v137, v137, v159 op_sel:[1,1,0] op_sel_hi:[1,1,0]
v_rcp_f16_sdwa v151, v150 dst_sel:WORD_1 dst_unused:UNUSED_PRESERVE src0_sel:WORD_1
v_fma_mix_f32 v159, v138, v138, v159 op_sel:[0,0,0] op_sel_hi:[1,1,0]
ds_read_b128 v[216:219], v248 offset:49152
v_mfma_f32_32x32x16_bf16 v[120:135], v[68:71], v[220:223], v[120:135]
v_rcp_f16_sdwa v148, v147 dst_sel:WORD_1 dst_unused:UNUSED_PRESERVE src0_sel:WORD_1
v_fma_mix_f32 v159, v139, v139, v159 op_sel:[1,1,0] op_sel_hi:[1,1,0]
s_cmp_eq_u32 s40, 7
s_cbranch_scc1 Lrdy8
s_waitcnt vmcnt(0)
Lrdy8:
s_mov_b64 exec, 1
ds_add_u32 v253, v254 offset:12
s_mov_b64 exec, -1
v_pk_mul_f16 v155, v155, v154
s_waitcnt lgkmcnt(6)
v_fma_mix_f32 v159, v140, v140, v159 op_sel:[0,0,0] op_sel_hi:[1,1,0]
v_pk_mul_f16 v152, v152, v151
v_fma_mix_f32 v159, v141, v141, v159 op_sel:[1,1,0] op_sel_hi:[1,1,0]
v_pk_mul_f16 v149, v149, v148
v_fma_mix_f32 v159, v155, v155, v159 op_sel:[0,0,0] op_sel_hi:[1,1,0]
v_fma_mix_f32 v159, v142, v142, v159 op_sel:[0,0,0] op_sel_hi:[1,1,0]
v_fma_mix_f32 v159, v155, v155, v159 op_sel:[1,1,0] op_sel_hi:[1,1,0]
s_waitcnt lgkmcnt(2)
v_fma_mix_f32 v159, v143, v143, v159 op_sel:[1,1,0] op_sel_hi:[1,1,0]
v_fma_mix_f32 v159, v152, v152, v159 op_sel:[0,0,0] op_sel_hi:[1,1,0]
v_fma_mix_f32 v159, v152, v152, v159 op_sel:[1,1,0] op_sel_hi:[1,1,0]
v_fma_mix_f32 v159, v144, v144, v159 op_sel:[0,0,0] op_sel_hi:[1,1,0]
v_fma_mix_f32 v159, v149, v149, v159 op_sel:[0,0,0] op_sel_hi:[1,1,0]
v_fma_mix_f32 v159, v145, v145, v159 op_sel:[1,1,0] op_sel_hi:[1,1,0]
v_fma_mix_f32 v159, v149, v149, v159 op_sel:[1,1,0] op_sel_hi:[1,1,0]
v_cvt_pkrtz_f16_f32 v137, v120, v121
v_cvt_pkrtz_f16_f32 v139, v122, v123
v_cvt_pkrtz_f16_f32 v141, v124, v125
v_cvt_pkrtz_f16_f32 v143, v126, v127
v_cvt_pkrtz_f16_f32 v145, v128, v129
v_cvt_pk_f16_f32 v155, v130, v131
v_cvt_pk_f16_f32 v152, v132, v133
v_cvt_pk_f16_f32 v149, v134, v135
s_setprio 0
ds_read_b128 v[220:223], v248 offset:52224
v_mfma_f32_32x32x16_bf16 v[120:135], v[48:51], v[224:227], 0
v_pk_fma_f16 v154, v155, v155, s48
v_and_b32_e64 v137, s49, v137
v_pk_fma_f16 v151, v152, v152, s48
v_and_b32_e64 v139, s49, v139
v_pk_fma_f16 v148, v149, v149, s48
v_pk_mul_f16 v154, v155, v154
v_bfe_u32 v136, v137, 2, 14
v_pk_mul_f16 v151, v152, v151
v_pk_mul_f16 v148, v149, v148
v_bfe_u32 v138, v139, 2, 14
ds_read_b128 v[224:227], v250 offset:65520
ds_read_u16_d16 v136, v136
ds_read_u16_d16 v138, v138
v_mfma_f32_32x32x16_bf16 v[120:135], v[52:55], v[228:231], v[120:135]
v_exp_f16 v153, v154
v_lshrrev_b32 v137, 18, v137
v_exp_f16 v150, v151
v_lshrrev_b32 v139, 18, v139
v_exp_f16 v147, v148
v_and_b32 v141, s49, v141
v_and_b32_e64 v143, s49, v143
ds_read_b128 v[228:231], v248 offset:53248
ds_read_u16_d16_hi v137, v137
ds_read_b32 v247, v253 offset:12
ds_read_u16_d16_hi v139, v139
v_mfma_f32_32x32x16_bf16 v[120:135], v[56:59], v[232:235], v[120:135]
v_exp_f16_sdwa v153, v154 dst_sel:WORD_1 dst_unused:UNUSED_PRESERVE src0_sel:WORD_1
v_bfe_u32 v140, v141, 2, 14
v_exp_f16_sdwa v150, v151 dst_sel:WORD_1 dst_unused:UNUSED_PRESERVE src0_sel:WORD_1
v_bfe_u32 v142, v143, 2, 14
v_exp_f16_sdwa v147, v148 dst_sel:WORD_1 dst_unused:UNUSED_PRESERVE src0_sel:WORD_1
v_lshrrev_b32_e64 v141, 18, v141
v_pk_add_f16 v153, v153, 1.0 op_sel_hi:[1,0]
ds_read_b128 v[232:235], v248 offset:56320
ds_read_u16_d16 v140, v140
ds_read_u16_d16 v142, v142
ds_read_u16_d16_hi v141, v141
v_mfma_f32_32x32x16_bf16 v[120:135], v[60:63], v[236:239], v[120:135]
v_lshrrev_b32_e64 v143, 18, v143
v_pk_add_f16 v150, v150, 1.0 op_sel_hi:[1,0]
v_pk_add_f16 v147, v147, 1.0 op_sel_hi:[1,0]
v_and_b32 v145, s49, v145
v_rcp_f16 v154, v153
v_bfe_u32 v144, v145, 2, 14
ds_read_u16_d16_hi v143, v143
ds_read_u16_d16 v144, v144
s_waitcnt lgkmcnt(7)
v_readfirstlane_b32 s43, v247
s_nop 1
s_cmp_ge_u32 s43, 16
s_cbranch_scc1 Lev3
Lev3w:
s_sleep 1
ds_read_b32 v247, v253 offset:12
s_waitcnt lgkmcnt(0)
v_readfirstlane_b32 s43, v247
s_cmp_eq_u32 s76, 0
s_cbranch_scc1 Lev3
s_sub_u32 s76, s76, 1
s_cmp_lt_u32 s43, 16
s_cbranch_scc1 Lev3w
Lev3:
v_rcp_f16 v151, v150
v_lshrrev_b32_e64 v145, 18, v145
ds_read_b128 v[236:239], v245 offset:6528
ds_read_b128 v[192:195], v244 offset:128
ds_read_b128 v[196:199], v244 offset:64
ds_read_u16_d16_hi v145, v145
v_mfma_f32_32x32x16_bf16 v[120:135], v[64:67], v[216:219], v[120:135]
v_rcp_f16 v148, v147
v_rcp_f16_sdwa v154, v153 dst_sel:WORD_1 dst_unused:UNUSED_PRESERVE src0_sel:WORD_1
v_fma_mix_f32 v160, v136, v136, 0 op_sel:[0,0,0] op_sel_hi:[1,1,0]
v_fma_mix_f32 v160, v137, v137, v160 op_sel:[1,1,0] op_sel_hi:[1,1,0]
v_rcp_f16_sdwa v151, v150 dst_sel:WORD_1 dst_unused:UNUSED_PRESERVE src0_sel:WORD_1
v_fma_mix_f32 v160, v138, v138, v160 op_sel:[0,0,0] op_sel_hi:[1,1,0]
ds_read_b128 v[216:219], v248 offset:54272
v_mfma_f32_32x32x16_bf16 v[120:135], v[68:71], v[220:223], v[120:135]
v_rcp_f16_sdwa v148, v147 dst_sel:WORD_1 dst_unused:UNUSED_PRESERVE src0_sel:WORD_1
s_waitcnt lgkmcnt(5)
v_fma_mix_f32 v160, v139, v139, v160 op_sel:[1,1,0] op_sel_hi:[1,1,0]
v_pk_mul_f16 v155, v155, v154
v_fma_mix_f32 v160, v140, v140, v160 op_sel:[0,0,0] op_sel_hi:[1,1,0]
v_pk_mul_f16 v152, v152, v151
v_fma_mix_f32 v160, v141, v141, v160 op_sel:[1,1,0] op_sel_hi:[1,1,0]
v_pk_mul_f16 v149, v149, v148
v_fma_mix_f32 v160, v155, v155, v160 op_sel:[0,0,0] op_sel_hi:[1,1,0]
v_fma_mix_f32 v160, v142, v142, v160 op_sel:[0,0,0] op_sel_hi:[1,1,0]
v_fma_mix_f32 v160, v155, v155, v160 op_sel:[1,1,0] op_sel_hi:[1,1,0]
v_fma_mix_f32 v160, v143, v143, v160 op_sel:[1,1,0] op_sel_hi:[1,1,0]
v_fma_mix_f32 v160, v152, v152, v160 op_sel:[0,0,0] op_sel_hi:[1,1,0]
v_fma_mix_f32 v160, v152, v152, v160 op_sel:[1,1,0] op_sel_hi:[1,1,0]
v_fma_mix_f32 v160, v144, v144, v160 op_sel:[0,0,0] op_sel_hi:[1,1,0]
v_fma_mix_f32 v160, v149, v149, v160 op_sel:[0,0,0] op_sel_hi:[1,1,0]
s_waitcnt lgkmcnt(1)
v_fma_mix_f32 v160, v145, v145, v160 op_sel:[1,1,0] op_sel_hi:[1,1,0]
v_fma_mix_f32 v160, v149, v149, v160 op_sel:[1,1,0] op_sel_hi:[1,1,0]
s_setprio 2
v_mfma_f32_32x32x16_bf16 v[0:15], v[224:227], v[224:227], 0
ds_read_b128 v[220:223], v245 offset:6144
ds_read_b128 v[200:203], v244
ds_read_b128 v[204:207], v243 offset:128
v_cvt_pkrtz_f16_f32 v137, v120, v121
v_cvt_pkrtz_f16_f32 v139, v122, v123
v_cvt_pkrtz_f16_f32 v141, v124, v125
v_mfma_f32_32x32x16_bf16 v[16:31], v[224:227], v[224:227], 0
v_cvt_pkrtz_f16_f32 v143, v126, v127
v_cvt_pkrtz_f16_f32 v145, v128, v129
v_cvt_pk_f16_f32 v155, v130, v131
v_mfma_f32_32x32x16_bf16 v[32:47], v[224:227], v[224:227], 0
v_cvt_pk_f16_f32 v152, v132, v133
v_cvt_pk_f16_f32 v149, v134, v135
v_pk_fma_f16 v154, v155, v155, s48
v_mfma_f32_32x32x16_bf16 v[120:135], v[48:51], v[228:231], 0
ds_read_b128 v[224:227], v248 offset:57344
v_and_b32_e64 v137, s49, v137
v_pk_fma_f16 v151, v152, v152, s48
v_and_b32_e64 v139, s49, v139
v_pk_fma_f16 v148, v149, v149, s48
v_pk_mul_f16 v154, v155, v154
v_bfe_u32 v136, v137, 2, 14
v_mfma_f32_32x32x16_bf16 v[120:135], v[52:55], v[232:235], v[120:135]
ds_read_b128 v[228:231], v245 offset:5760
ds_read_b128 v[208:211], v243 offset:64
ds_read_b128 v[212:215], v243
ds_read_u16_d16 v136, v136
v_pk_mul_f16 v151, v152, v151
v_pk_mul_f16 v148, v149, v148
v_bfe_u32 v138, v139, 2, 14
v_exp_f16 v153, v154
v_lshrrev_b32 v137, 18, v137
v_smfmac_f32_16x16x32_bf16 v[40:43], v[238:239], v[192:195], v246
ds_read_b128 v[232:235], v248 offset:55296
ds_read_u16_d16 v138, v138
ds_read_u16_d16_hi v137, v137
v_exp_f16 v150, v151
v_lshrrev_b32 v139, 18, v139
v_smfmac_f32_16x16x32_bf16 v[24:27], v[236:237], v[196:199], v246
v_exp_f16_e64 v147, v148
v_and_b32 v141, s49, v141
s_waitcnt lgkmcnt(7)
v_mfma_f32_32x32x16_bf16 v[120:135], v[56:59], v[216:219], v[120:135]
ds_read_b128 v[236:239], v245 offset:5376
ds_read_b128 v[192:195], v242 offset:128
ds_read_b128 v[196:199], v242 offset:64
ds_read_u16_d16_hi v139, v139
v_and_b32_e64 v143, s49, v143
v_exp_f16_sdwa v153, v154 dst_sel:WORD_1 dst_unused:UNUSED_PRESERVE src0_sel:WORD_1
v_bfe_u32 v140, v141, 2, 14
v_exp_f16_sdwa v150, v151 dst_sel:WORD_1 dst_unused:UNUSED_PRESERVE src0_sel:WORD_1
v_smfmac_f32_16x16x32_bf16 v[8:11], v[222:223], v[200:203], v246
ds_read_b128 v[216:219], v248 offset:58368
ds_read_u16_d16 v140, v140
v_bfe_u32 v142, v143, 2, 14
v_exp_f16_sdwa v147, v148 dst_sel:WORD_1 dst_unused:UNUSED_PRESERVE src0_sel:WORD_1
v_smfmac_f32_16x16x32_bf16 v[40:43], v[220:221], v[204:207], v246
v_lshrrev_b32_e64 v141, 18, v141
v_pk_add_f16 v153, v153, 1.0 op_sel_hi:[1,0]
v_lshrrev_b32 v143, 18, v143
v_mfma_f32_32x32x16_bf16 v[120:135], v[60:63], v[224:227], v[120:135]
ds_read_b128 v[220:223], v245 offset:4992
ds_read_b128 v[200:203], v242
v_xor_b32 v244, 16, v244
ds_read_b128 v[204:207], v244 offset:128
ds_read_u16_d16 v142, v142
ds_read_u16_d16_hi v141, v141
ds_read_u16_d16_hi v143, v143
v_pk_add_f16 v150, v150, 1.0 op_sel_hi:[1,0]
v_pk_add_f16 v147, v147, 1.0 op_sel_hi:[1,0]
v_and_b32_e64 v145, s49, v145
v_rcp_f16 v154, v153
v_bfe_u32 v144, v145, 2, 14
s_waitcnt lgkmcnt(8)
v_smfmac_f32_16x16x32_bf16 v[24:27], v[230:231], v[208:211], v246
ds_read_b128 v[224:227], v245 offset:4608
ds_read_u16_d16 v144, v144
v_rcp_f16 v151, v150
v_lshrrev_b32 v145, 18, v145
v_smfmac_f32_16x16x32_bf16 v[8:11], v[228:229], v[212:215], v246
v_rcp_f16_e64 v148, v147
v_mfma_f32_32x32x16_bf16 v[120:135], v[64:67], v[232:235], v[120:135]
ds_read_b128 v[208:211], v244 offset:64
ds_read_b128 v[212:215], v244
ds_read_b128 v[228:231], v248 offset:59392
ds_read_u16_d16_hi v145, v145
v_rcp_f16_sdwa v154, v153 dst_sel:WORD_1 dst_unused:UNUSED_PRESERVE src0_sel:WORD_1
v_fma_mix_f32 v161, v136, v136, 0 op_sel:[0,0,0] op_sel_hi:[1,1,0]
v_fma_mix_f32 v161, v137, v137, v161 op_sel:[1,1,0] op_sel_hi:[1,1,0]
v_rcp_f16_sdwa v151, v150 dst_sel:WORD_1 dst_unused:UNUSED_PRESERVE src0_sel:WORD_1
v_fma_mix_f32 v161, v138, v138, v161 op_sel:[0,0,0] op_sel_hi:[1,1,0]
v_smfmac_f32_16x16x32_bf16 v[40:43], v[238:239], v[192:195], v246
ds_read_b128 v[232:235], v248 offset:62464
v_rcp_f16_sdwa v148, v147 dst_sel:WORD_1 dst_unused:UNUSED_PRESERVE src0_sel:WORD_1
v_fma_mix_f32 v161, v139, v139, v161 op_sel:[1,1,0] op_sel_hi:[1,1,0]
v_smfmac_f32_16x16x32_bf16 v[24:27], v[236:237], v[196:199], v246
v_pk_mul_f16 v155, v155, v154
s_waitcnt lgkmcnt(7)
v_fma_mix_f32 v161, v140, v140, v161 op_sel:[0,0,0] op_sel_hi:[1,1,0]
v_pk_mul_f16 v152, v152, v151
v_mfma_f32_32x32x16_bf16 v[120:135], v[68:71], v[216:219], v[120:135]
ds_read_b128 v[236:239], v248 offset:60416
v_fma_mix_f32 v161, v141, v141, v161 op_sel:[1,1,0] op_sel_hi:[1,1,0]
v_pk_mul_f16 v149, v149, v148
v_fma_mix_f32 v161, v155, v155, v161 op_sel:[0,0,0] op_sel_hi:[1,1,0]
v_fma_mix_f32 v161, v142, v142, v161 op_sel:[0,0,0] op_sel_hi:[1,1,0]
v_fma_mix_f32 v161, v155, v155, v161 op_sel:[1,1,0] op_sel_hi:[1,1,0]
v_fma_mix_f32 v161, v143, v143, v161 op_sel:[1,1,0] op_sel_hi:[1,1,0]
v_smfmac_f32_16x16x32_bf16 v[8:11], v[222:223], v[200:203], v246
ds_read_b128 v[216:219], v245 offset:4224
v_xor_b32 v243, 16, v243
ds_read_b128 v[192:195], v243 offset:128
ds_read_b128 v[196:199], v243 offset:64
v_fma_mix_f32 v161, v152, v152, v161 op_sel:[0,0,0] op_sel_hi:[1,1,0]
v_fma_mix_f32 v161, v152, v152, v161 op_sel:[1,1,0] op_sel_hi:[1,1,0]
s_waitcnt lgkmcnt(5)
v_fma_mix_f32 v161, v144, v144, v161 op_sel:[0,0,0] op_sel_hi:[1,1,0]
v_smfmac_f32_16x16x32_bf16 v[44:47], v[220:221], v[204:207], v246
v_fma_mix_f32 v161, v149, v149, v161 op_sel:[0,0,0] op_sel_hi:[1,1,0]
v_fma_mix_f32 v161, v145, v145, v161 op_sel:[1,1,0] op_sel_hi:[1,1,0]
v_fma_mix_f32 v161, v149, v149, v161 op_sel:[1,1,0] op_sel_hi:[1,1,0]
s_cmp_lg_u32 s40, 7
s_cbranch_scc1 Lnosent
v_mov_b32 v180, -1
v_mov_b32 v181, -1
v_mov_b32 v182, -1
v_mov_b32 v183, -1
v_lshlrev_b32 v176, 12, v251
v_add_u32 v177, 262144, v176
v_cmp_gt_u32 vcc, 32, v251
v_mov_b32 v178, 2147483648
s_nop 0
v_cndmask_b32 v177, v178, v177, vcc
s_lshl_b32 s43, s2, 4
buffer_store_dwordx4 v[180:183], v176, s[32:35], s43 offen sc1
buffer_store_dwordx4 v[180:183], v177, s[32:35], s43 offen sc1
s_add_u32 s43, s43, 393216
s_cmp_lt_u32 s2, 96
s_cselect_b32 s43, s43, 1073741824
v_lshlrev_b32_e64 v178, 11, v251
s_mov_b64 exec, 0xff
buffer_store_dwordx4 v[180:183], v178, s[32:35], s43 offen sc1
s_mov_b64 exec, -1
s_sub_u32 s43, s2, 96
s_cmp_lt_u32 s43, 96
s_cbranch_scc0 Lnobias
s_lshl_b32 s44, s43, 1
v_mul_u32_u24 v176, 192, v251
v_lshlrev_b32 v177, 1, v251
s_add_u32 s45, s44, 0
buffer_load_ushort v178, v176, s[16:19], s45 offen
buffer_load_ushort v184, v177, s[28:31], 0 offen offset:0
s_add_u32 s45, s44, 12288
buffer_load_ushort v179, v176, s[16:19], s45 offen
buffer_load_ushort v185, v177, s[28:31], 0 offen offset:128
s_add_u32 s45, s44, 24576
buffer_load_ushort v180, v176, s[16:19], s45 offen
buffer_load_ushort v186, v177, s[28:31], 0 offen offset:256
s_add_u32 s45, s44, 36864
buffer_load_ushort v181, v176, s[16:19], s45 offen
buffer_load_ushort v187, v177, s[28:31], 0 offen offset:384
s_add_u32 s45, s44, 49152
buffer_load_ushort v182, v176, s[16:19], s45 offen
buffer_load_ushort v188, v177, s[28:31], 0 offen offset:512
s_add_u32 s45, s44, 61440
buffer_load_ushort v183, v176, s[16:19], s45 offen
buffer_load_ushort v189, v177, s[28:31], 0 offen offset:640
Lnobias:
s_nop 1
Lnosent:
s_setprio 1
v_smfmac_f32_16x16x32_bf16 v[28:31], v[226:227], v[208:211], v246
ds_read_b128 v[220:223], v248 offset:63488
v_cvt_pkrtz_f16_f32 v137, v120, v121
v_cvt_pkrtz_f16_f32 v139, v122, v123
v_cvt_pkrtz_f16_f32 v141, v124, v125
v_cvt_pkrtz_f16_f32 v143, v126, v127
v_smfmac_f32_16x16x32_bf16 v[12:15], v[224:225], v[212:215], v246
v_cvt_pk_f16_f32 v155, v128, v129
v_cvt_pk_f16_f32 v152, v130, v131
v_cvt_pk_f16_f32 v149, v132, v133
v_cvt_pk_f16_f32 v146, v134, v135
v_mfma_f32_32x32x16_bf16 v[120:135], v[48:51], v[228:231], 0
ds_read_b128 v[224:227], v248 offset:61440
v_pk_fma_f16 v154, v155, v155, s48
v_and_b32_e64 v137, s49, v137
v_pk_fma_f16 v151, v152, v152, s48
v_pk_fma_f16 v148, v149, v149, s48
v_and_b32_e64 v139, s49, v139
v_pk_fma_f16 v145, v146, v146, s48
v_pk_mul_f16 v154, v155, v154
v_bfe_u32 v136, v137, 2, 14
s_waitcnt lgkmcnt(2)
v_mfma_f32_32x32x16_bf16 v[120:135], v[52:55], v[232:235], v[120:135]
ds_read_b128 v[228:231], v245 offset:3840
ds_read_b128 v[200:203], v243
v_xor_b32 v242, 16, v242
ds_read_b128 v[204:207], v242 offset:128
ds_read_u16_d16 v136, v136
v_pk_mul_f16 v151, v152, v151
v_pk_mul_f16 v148, v149, v148
v_bfe_u32 v138, v139, 2, 14
v_pk_mul_f16 v145, v146, v145
v_exp_f16 v153, v154
v_lshrrev_b32 v137, 18, v137
v_exp_f16_e64 v150, v151
v_mfma_f32_32x32x16_bf16 v[120:135], v[56:59], v[236:239], v[120:135]
ds_read_b128 v[232:235], v248 offset:64512
ds_read_u16_d16 v138, v138
ds_read_u16_d16_hi v137, v137
v_lshrrev_b32 v139, 18, v139
v_exp_f16 v147, v148
v_and_b32 v141, s49, v141
v_exp_f16 v144, v145
v_and_b32_e64 v143, s49, v143
v_smfmac_f32_16x16x32_bf16 v[44:47], v[218:219], v[192:195], v246
ds_read_b128 v[236:239], v245 offset:3456
ds_read_b128 v[208:211], v242 offset:64
ds_read_b128 v[212:215], v242
ds_read_u16_d16_hi v139, v139
v_exp_f16_sdwa v153, v154 dst_sel:WORD_1 dst_unused:UNUSED_PRESERVE src0_sel:WORD_1
v_bfe_u32 v140, v141, 2, 14
v_exp_f16_sdwa v150, v151 dst_sel:WORD_1 dst_unused:UNUSED_PRESERVE src0_sel:WORD_1
v_smfmac_f32_16x16x32_bf16 v[28:31], v[216:217], v[196:199], v246
v_bfe_u32 v142, v143, 2, 14
v_exp_f16_sdwa v147, v148 dst_sel:WORD_1 dst_unused:UNUSED_PRESERVE src0_sel:WORD_1
v_lshrrev_b32_e64 v141, 18, v141
s_waitcnt lgkmcnt(7)
v_mfma_f32_32x32x16_bf16 v[120:135], v[60:63], v[220:223], v[120:135]
ds_read_b128 v[216:219], v245 offset:3072
v_xor_b32 v244, 32, v244
ds_read_b128 v[192:195], v244 offset:128
ds_read_b128 v[196:199], v244 offset:64
ds_read_u16_d16 v140, v140
ds_read_u16_d16 v142, v142
ds_read_u16_d16_hi v141, v141
v_exp_f16_sdwa v144, v145 dst_sel:WORD_1 dst_unused:UNUSED_PRESERVE src0_sel:WORD_1
v_lshrrev_b32_e64 v143, 18, v143
v_pk_add_f16 v153, v153, 1.0 op_sel_hi:[1,0]
v_pk_add_f16 v150, v150, 1.0 op_sel_hi:[1,0]
v_pk_add_f16 v147, v147, 1.0 op_sel_hi:[1,0]
v_pk_add_f16 v144, v144, 1.0 op_sel_hi:[1,0]
v_rcp_f16_e64 v154, v153
v_mfma_f32_32x32x16_bf16 v[120:135], v[64:67], v[224:227], v[120:135]
ds_read_b128 v[220:223], v249
ds_read_u16_d16_hi v143, v143
v_rcp_f16 v151, v150
v_rcp_f16 v148, v147
v_rcp_f16_e64 v145, v144
v_rcp_f16_sdwa v154, v153 dst_sel:WORD_1 dst_unused:UNUSED_PRESERVE src0_sel:WORD_1
v_smfmac_f32_16x16x32_bf16 v[12:15], v[230:231], v[200:203], v246
ds_read_b128 v[224:227], v249 offset:3072
v_rcp_f16_sdwa v151, v150 dst_sel:WORD_1 dst_unused:UNUSED_PRESERVE src0_sel:WORD_1
s_setprio 0
v_rcp_f16_sdwa v148, v147 dst_sel:WORD_1 dst_unused:UNUSED_PRESERVE src0_sel:WORD_1
v_fma_mix_f32 v162, v136, v136, 0 op_sel:[0,0,0] op_sel_hi:[1,1,0]
v_smfmac_f32_16x16x32_bf16 v[44:47], v[228:229], v[204:207], v246
v_rcp_f16_sdwa v145, v144 dst_sel:WORD_1 dst_unused:UNUSED_PRESERVE src0_sel:WORD_1
s_waitcnt lgkmcnt(5)
v_fma_mix_f32 v162, v137, v137, v162 op_sel:[1,1,0] op_sel_hi:[1,1,0]
v_pk_mul_f16 v155, v155, v154
v_mfma_f32_32x32x16_bf16 v[120:135], v[68:71], v[232:235], v[120:135]
ds_read_b128 v[228:231], v245 offset:2688
ds_read_b128 v[200:203], v244
v_xor_b32 v243, 32, v243
ds_read_b128 v[204:207], v243 offset:128
v_fma_mix_f32 v162, v138, v138, v162 op_sel:[0,0,0] op_sel_hi:[1,1,0]
v_pk_mul_f16 v152, v152, v151
v_pk_mul_f16 v149, v149, v148
v_fma_mix_f32 v162, v139, v139, v162 op_sel:[1,1,0] op_sel_hi:[1,1,0]
v_pk_mul_f16 v146, v146, v145
v_fma_mix_f32 v162, v155, v155, v162 op_sel:[0,0,0] op_sel_hi:[1,1,0]
v_fma_mix_f32 v162, v140, v140, v162 op_sel:[0,0,0] op_sel_hi:[1,1,0]
v_fma_mix_f32 v162, v155, v155, v162 op_sel:[1,1,0] op_sel_hi:[1,1,0]
v_smfmac_f32_16x16x32_bf16 v[28:31], v[238:239], v[208:211], v246
ds_read_b128 v[232:235], v249 offset:1024
v_fma_mix_f32 v162, v152, v152, v162 op_sel:[0,0,0] op_sel_hi:[1,1,0]
s_waitcnt lgkmcnt(4)
v_fma_mix_f32 v162, v141, v141, v162 op_sel:[1,1,0] op_sel_hi:[1,1,0]
v_fma_mix_f32 v162, v152, v152, v162 op_sel:[1,1,0] op_sel_hi:[1,1,0]
v_fma_mix_f32 v162, v149, v149, v162 op_sel:[0,0,0] op_sel_hi:[1,1,0]
v_smfmac_f32_16x16x32_bf16 v[12:15], v[236:237], v[212:215], v246
v_fma_mix_f32 v162, v142, v142, v162 op_sel:[0,0,0] op_sel_hi:[1,1,0]
v_fma_mix_f32 v162, v149, v149, v162 op_sel:[1,1,0] op_sel_hi:[1,1,0]
v_fma_mix_f32 v162, v146, v146, v162 op_sel:[0,0,0] op_sel_hi:[1,1,0]
v_fma_mix_f32 v162, v143, v143, v162 op_sel:[1,1,0] op_sel_hi:[1,1,0]
v_fma_mix_f32 v162, v146, v146, v162 op_sel:[1,1,0] op_sel_hi:[1,1,0]
v_lshlrev_b32_e64 v252, 7, v251
s_add_u32 s46, s47, 1572864
s_mov_b32 exec_lo, 131071
s_mov_b32 exec_hi, 0
s_mov_b32 m0, 16288
s_nop 0
buffer_load_dword v252, s[4:7], s46 offen lds
s_mov_b64 exec, -1
s_setprio 2
v_smfmac_f32_16x16x32_bf16 v[36:39], v[218:219], v[192:195], v246
ds_read_b128 v[236:239], v249 offset:4096
v_cvt_pkrtz_f16_f32 v137, v120, v121
v_cvt_pkrtz_f16_f32 v139, v122, v123
v_cvt_pkrtz_f16_f32 v141, v124, v125
v_smfmac_f32_16x16x32_bf16 v[20:23], v[216:217], v[196:199], v246
v_cvt_pkrtz_f16_f32 v143, v126, v127
v_cvt_pkrtz_f16_f32 v145, v128, v129
v_cvt_pk_f16_f32 v155, v130, v131
v_cvt_pk_f16_f32 v152, v132, v133
v_cvt_pk_f16_f32 v149, v134, v135
v_mfma_f32_32x32x16_bf16 v[120:135], v[48:51], v[220:223], 0
ds_read_b128 v[216:219], v245 offset:2304
ds_read_b128 v[208:211], v243 offset:64
ds_read_b128 v[212:215], v243
v_pk_fma_f16 v154, v155, v155, s48
v_and_b32_e64 v137, s49, v137
v_pk_fma_f16 v151, v152, v152, s48
v_and_b32_e64 v139, s49, v139
v_pk_fma_f16 v148, v149, v149, s48
v_mfma_f32_32x32x16_bf16 v[120:135], v[52:55], v[224:227], v[120:135]
ds_read_b128 v[220:223], v249 offset:2048
v_pk_mul_f16 v154, v155, v154
v_bfe_u32 v136, v137, 2, 14
v_pk_mul_f16 v151, v152, v151
v_pk_mul_f16 v148, v149, v148
v_bfe_u32 v138, v139, 2, 14
v_exp_f16_e64 v153, v154
s_waitcnt lgkmcnt(4)
v_smfmac_f32_16x16x32_bf16 v[4:7], v[230:231], v[200:203], v246
ds_read_b128 v[224:227], v245 offset:1920
v_xor_b32 v242, 32, v242
ds_read_b128 v[192:195], v242 offset:128
ds_read_b128 v[196:199], v242 offset:64
ds_read_u16_d16 v136, v136
ds_read_u16_d16 v138, v138
v_lshrrev_b32 v137, 18, v137
v_exp_f16 v150, v151
v_smfmac_f32_16x16x32_bf16 v[36:39], v[228:229], v[204:207], v246
v_lshrrev_b32 v139, 18, v139
v_exp_f16 v147, v148
v_and_b32_e64 v141, s49, v141
v_mfma_f32_32x32x16_bf16 v[120:135], v[56:59], v[232:235], v[120:135]
ds_read_b128 v[228:231], v249 offset:5120
ds_read_u16_d16_hi v137, v137
ds_read_u16_d16_hi v139, v139
v_and_b32_e64 v143, s49, v143
v_exp_f16_sdwa v153, v154 dst_sel:WORD_1 dst_unused:UNUSED_PRESERVE src0_sel:WORD_1
v_bfe_u32 v140, v141, 2, 14
v_exp_f16_sdwa v150, v151 dst_sel:WORD_1 dst_unused:UNUSED_PRESERVE src0_sel:WORD_1
v_bfe_u32 v142, v143, 2, 14
v_mfma_f32_32x32x16_bf16 v[120:135], v[60:63], v[236:239], v[120:135]
ds_read_b128 v[232:235], v245 offset:1536
ds_read_b128 v[200:203], v242
v_xor_b32 v244, 16, v244
ds_read_b128 v[204:207], v244 offset:128
ds_read_u16_d16 v140, v140
ds_read_u16_d16 v142, v142
v_exp_f16_sdwa v147, v148 dst_sel:WORD_1 dst_unused:UNUSED_PRESERVE src0_sel:WORD_1
v_lshrrev_b32 v141, 18, v141
v_pk_add_f16 v153, v153, 1.0 op_sel_hi:[1,0]
v_lshrrev_b32 v143, 18, v143
v_pk_add_f16 v150, v150, 1.0 op_sel_hi:[1,0]
s_waitcnt lgkmcnt(8)
v_smfmac_f32_16x16x32_bf16 v[20:23], v[218:219], v[208:211], v246
ds_read_b128 v[236:239], v245 offset:1152
ds_read_u16_d16_hi v141, v141
ds_read_u16_d16_hi v143, v143
v_pk_add_f16 v147, v147, 1.0 op_sel_hi:[1,0]
v_and_b32 v145, s49, v145
v_rcp_f16 v154, v153
v_smfmac_f32_16x16x32_bf16 v[4:7], v[216:217], v[212:215], v246
v_bfe_u32 v144, v145, 2, 14
v_rcp_f16_e64 v151, v150
v_mfma_f32_32x32x16_bf16 v[120:135], v[64:67], v[220:223], v[120:135]
ds_read_b128 v[208:211], v244 offset:64
ds_read_b128 v[212:215], v244
ds_read_b128 v[216:219], v249 offset:6144
ds_read_u16_d16 v144, v144
v_lshrrev_b32_e64 v145, 18, v145
v_rcp_f16 v148, v147
v_rcp_f16_sdwa v154, v153 dst_sel:WORD_1 dst_unused:UNUSED_PRESERVE src0_sel:WORD_1
ds_read_u16_d16_hi v145, v145
v_fma_mix_f32 v163, v136, v136, 0 op_sel:[0,0,0] op_sel_hi:[1,1,0]
s_waitcnt lgkmcnt(8)
v_fma_mix_f32 v163, v137, v137, v163 op_sel:[1,1,0] op_sel_hi:[1,1,0]
v_smfmac_f32_16x16x32_bf16 v[36:39], v[226:227], v[192:195], v246
ds_read_b128 v[220:223], v249 offset:9216
v_rcp_f16_sdwa v151, v150 dst_sel:WORD_1 dst_unused:UNUSED_PRESERVE src0_sel:WORD_1
v_fma_mix_f32 v163, v138, v138, v163 op_sel:[0,0,0] op_sel_hi:[1,1,0]
v_smfmac_f32_16x16x32_bf16 v[20:23], v[224:225], v[196:199], v246
v_rcp_f16_sdwa v148, v147 dst_sel:WORD_1 dst_unused:UNUSED_PRESERVE src0_sel:WORD_1
v_fma_mix_f32 v163, v139, v139, v163 op_sel:[1,1,0] op_sel_hi:[1,1,0]
v_pk_mul_f16 v155, v155, v154
v_mfma_f32_32x32x16_bf16 v[120:135], v[68:71], v[228:231], v[120:135]
ds_read_b128 v[224:227], v249 offset:7168
v_fma_mix_f32 v163, v140, v140, v163 op_sel:[0,0,0] op_sel_hi:[1,1,0]
v_pk_mul_f16 v152, v152, v151
s_waitcnt lgkmcnt(7)
v_fma_mix_f32 v163, v141, v141, v163 op_sel:[1,1,0] op_sel_hi:[1,1,0]
v_pk_mul_f16 v149, v149, v148
v_fma_mix_f32 v163, v155, v155, v163 op_sel:[0,0,0] op_sel_hi:[1,1,0]
v_fma_mix_f32 v163, v142, v142, v163 op_sel:[0,0,0] op_sel_hi:[1,1,0]
v_fma_mix_f32 v163, v155, v155, v163 op_sel:[1,1,0] op_sel_hi:[1,1,0]
v_smfmac_f32_16x16x32_bf16 v[4:7], v[234:235], v[200:203], v246
ds_read_b128 v[228:231], v245 offset:768
v_xor_b32 v243, 16, v243
ds_read_b128 v[192:195], v243 offset:128
ds_read_b128 v[196:199], v243 offset:64
v_fma_mix_f32 v163, v143, v143, v163 op_sel:[1,1,0] op_sel_hi:[1,1,0]
v_fma_mix_f32 v163, v152, v152, v163 op_sel:[0,0,0] op_sel_hi:[1,1,0]
v_fma_mix_f32 v163, v152, v152, v163 op_sel:[1,1,0] op_sel_hi:[1,1,0]
v_smfmac_f32_16x16x32_bf16 v[32:35], v[232:233], v[204:207], v246
s_waitcnt lgkmcnt(4)
v_fma_mix_f32 v163, v144, v144, v163 op_sel:[0,0,0] op_sel_hi:[1,1,0]
v_fma_mix_f32 v163, v149, v149, v163 op_sel:[0,0,0] op_sel_hi:[1,1,0]
v_fma_mix_f32 v163, v145, v145, v163 op_sel:[1,1,0] op_sel_hi:[1,1,0]
v_fma_mix_f32 v163, v149, v149, v163 op_sel:[1,1,0] op_sel_hi:[1,1,0]
v_lshlrev_b32 v252, 7, v251
s_add_u32 s46, s47, 1572864
s_mov_b32 exec_lo, 4294836224
s_mov_b32 exec_hi, 3
s_mov_b32 m0, 16220
s_nop 0
buffer_load_dword v252, s[4:7], s46 offen lds
s_mov_b64 exec, -1
s_setprio 1
v_smfmac_f32_16x16x32_bf16 v[16:19], v[238:239], v[208:211], v246
ds_read_b128 v[232:235], v249 offset:10240
v_cvt_pkrtz_f16_f32 v137, v120, v121
v_cvt_pkrtz_f16_f32 v139, v122, v123
v_cvt_pkrtz_f16_f32 v141, v124, v125
v_smfmac_f32_16x16x32_bf16 v[0:3], v[236:237], v[212:215], v246
v_cvt_pkrtz_f16_f32 v143, v126, v127
v_cvt_pk_f16_f32 v155, v128, v129
v_cvt_pk_f16_f32 v152, v130, v131
v_cvt_pk_f16_f32 v149, v132, v133
v_cvt_pk_f16_f32 v146, v134, v135
v_mfma_f32_32x32x16_bf16 v[120:135], v[48:51], v[216:219], 0
ds_read_b128 v[236:239], v249 offset:8192
v_pk_fma_f16 v154, v155, v155, s48
v_and_b32_e64 v137, s49, v137
v_pk_fma_f16 v151, v152, v152, s48
v_pk_fma_f16 v148, v149, v149, s48
v_and_b32 v139, s49, v139
v_pk_fma_f16 v145, v146, v146, s48
v_pk_mul_f16 v154, v155, v154
v_mfma_f32_32x32x16_bf16 v[120:135], v[52:55], v[220:223], v[120:135]
ds_read_b128 v[216:219], v245 offset:384
ds_read_b128 v[200:203], v243
v_xor_b32 v242, 16, v242
ds_read_b128 v[204:207], v242 offset:128
v_bfe_u32 v136, v137, 2, 14
v_pk_mul_f16 v151, v152, v151
v_pk_mul_f16 v148, v149, v148
v_bfe_u32 v138, v139, 2, 14
v_pk_mul_f16 v145, v146, v145
v_exp_f16 v153, v154
s_waitcnt lgkmcnt(4)
v_mfma_f32_32x32x16_bf16 v[120:135], v[56:59], v[224:227], v[120:135]
ds_read_b128 v[220:223], v249 offset:11264
ds_read_u16_d16 v136, v136
ds_read_u16_d16 v138, v138
v_lshrrev_b32 v137, 18, v137
v_exp_f16 v150, v151
v_lshrrev_b32 v139, 18, v139
v_exp_f16 v147, v148
v_and_b32_e64 v141, s49, v141
v_smfmac_f32_16x16x32_bf16 v[32:35], v[230:231], v[192:195], v246
ds_read_b128 v[224:227], v245
ds_read_b128 v[208:211], v242 offset:64
ds_read_b128 v[212:215], v242
ds_read_u16_d16_hi v137, v137
ds_read_u16_d16_hi v139, v139
v_exp_f16 v144, v145
v_and_b32 v143, s49, v143
v_exp_f16_sdwa v153, v154 dst_sel:WORD_1 dst_unused:UNUSED_PRESERVE src0_sel:WORD_1
v_smfmac_f32_16x16x32_bf16 v[16:19], v[228:229], v[196:199], v246
v_bfe_u32 v140, v141, 2, 14
v_exp_f16_sdwa v150, v151 dst_sel:WORD_1 dst_unused:UNUSED_PRESERVE src0_sel:WORD_1
v_mfma_f32_32x32x16_bf16 v[120:135], v[60:63], v[232:235], v[120:135]
ds_read_b128 v[228:231], v249 offset:12288
ds_read_u16_d16 v140, v140
v_bfe_u32 v142, v143, 2, 14
v_exp_f16_sdwa v147, v148 dst_sel:WORD_1 dst_unused:UNUSED_PRESERVE src0_sel:WORD_1
v_lshrrev_b32_e64 v141, 18, v141
v_exp_f16_sdwa v144, v145 dst_sel:WORD_1 dst_unused:UNUSED_PRESERVE src0_sel:WORD_1
v_lshrrev_b32 v143, 18, v143
v_pk_add_f16 v153, v153, 1.0 op_sel_hi:[1,0]
s_waitcnt lgkmcnt(7)
v_mfma_f32_32x32x16_bf16 v[120:135], v[64:67], v[236:239], v[120:135]
ds_read_b128 v[232:235], v249 offset:15360
ds_read_u16_d16 v142, v142
ds_read_u16_d16_hi v141, v141
ds_read_u16_d16_hi v143, v143
v_pk_add_f16 v150, v150, 1.0 op_sel_hi:[1,0]
v_pk_add_f16 v147, v147, 1.0 op_sel_hi:[1,0]
v_pk_add_f16 v144, v144, 1.0 op_sel_hi:[1,0]
v_rcp_f16 v154, v153
v_rcp_f16 v151, v150
v_smfmac_f32_16x16x32_bf16 v[0:3], v[218:219], v[200:203], v246
ds_read_b128 v[236:239], v249 offset:13312
v_rcp_f16 v148, v147
v_rcp_f16 v145, v144
v_smfmac_f32_16x16x32_bf16 v[32:35], v[216:217], v[204:207], v246
v_rcp_f16_sdwa v154, v153 dst_sel:WORD_1 dst_unused:UNUSED_PRESERVE src0_sel:WORD_1
v_rcp_f16_sdwa v151, v150 dst_sel:WORD_1 dst_unused:UNUSED_PRESERVE src0_sel:WORD_1
s_setprio 0
v_mfma_f32_32x32x16_bf16 v[120:135], v[68:71], v[220:223], v[120:135]
ds_read_b128 v[216:219], v249 offset:16384
v_rcp_f16_sdwa v148, v147 dst_sel:WORD_1 dst_unused:UNUSED_PRESERVE src0_sel:WORD_1
v_fma_mix_f32 v164, v136, v136, 0 op_sel:[0,0,0] op_sel_hi:[1,1,0]
v_rcp_f16_sdwa v145, v144 dst_sel:WORD_1 dst_unused:UNUSED_PRESERVE src0_sel:WORD_1
s_waitcnt lgkmcnt(6)
v_fma_mix_f32 v164, v137, v137, v164 op_sel:[1,1,0] op_sel_hi:[1,1,0]
v_pk_mul_f16 v155, v155, v154
v_fma_mix_f32 v164, v138, v138, v164 op_sel:[0,0,0] op_sel_hi:[1,1,0]
v_smfmac_f32_16x16x32_bf16 v[16:19], v[226:227], v[208:211], v246
ds_read_b128 v[220:223], v249 offset:14336
v_pk_mul_f16 v152, v152, v151
v_pk_mul_f16 v149, v149, v148
v_fma_mix_f32 v164, v139, v139, v164 op_sel:[1,1,0] op_sel_hi:[1,1,0]
v_pk_mul_f16 v146, v146, v145
v_smfmac_f32_16x16x32_bf16 v[0:3], v[224:225], v[212:215], v246
s_mov_b64 exec, 1
ds_add_u32 v253, v254 offset:16
s_mov_b64 exec, -1
v_fma_mix_f32 v164, v155, v155, v164 op_sel:[0,0,0] op_sel_hi:[1,1,0]
v_fma_mix_f32 v164, v140, v140, v164 op_sel:[0,0,0] op_sel_hi:[1,1,0]
v_fma_mix_f32 v164, v155, v155, v164 op_sel:[1,1,0] op_sel_hi:[1,1,0]
v_fma_mix_f32 v164, v152, v152, v164 op_sel:[0,0,0] op_sel_hi:[1,1,0]
s_waitcnt lgkmcnt(3)
v_fma_mix_f32 v164, v141, v141, v164 op_sel:[1,1,0] op_sel_hi:[1,1,0]
v_fma_mix_f32 v164, v152, v152, v164 op_sel:[1,1,0] op_sel_hi:[1,1,0]
v_fma_mix_f32 v164, v149, v149, v164 op_sel:[0,0,0] op_sel_hi:[1,1,0]
v_fma_mix_f32 v164, v142, v142, v164 op_sel:[0,0,0] op_sel_hi:[1,1,0]
v_fma_mix_f32 v164, v149, v149, v164 op_sel:[1,1,0] op_sel_hi:[1,1,0]
v_fma_mix_f32 v164, v146, v146, v164 op_sel:[0,0,0] op_sel_hi:[1,1,0]
v_fma_mix_f32 v164, v143, v143, v164 op_sel:[1,1,0] op_sel_hi:[1,1,0]
v_fma_mix_f32 v164, v146, v146, v164 op_sel:[1,1,0] op_sel_hi:[1,1,0]
s_setprio 3
v_pk_add_f32 v[168:169], v[0:1], v[2:3]
v_pk_mul_f32 v[170:171], v[0:1], v[0:1]
v_pk_fma_f32 v[170:171], v[2:3], v[2:3], v[170:171]
v_pk_add_f32 v[168:169], v[168:169], v[4:5]
v_pk_fma_f32 v[170:171], v[4:5], v[4:5], v[170:171]
v_pk_add_f32 v[168:169], v[168:169], v[6:7]
v_pk_fma_f32 v[170:171], v[6:7], v[6:7], v[170:171]
v_pk_add_f32 v[168:169], v[168:169], v[8:9]
v_pk_fma_f32 v[170:171], v[8:9], v[8:9], v[170:171]
v_pk_add_f32 v[168:169], v[168:169], v[10:11]
v_pk_fma_f32 v[170:171], v[10:11], v[10:11], v[170:171]
v_pk_add_f32 v[168:169], v[168:169], v[12:13]
v_pk_fma_f32 v[170:171], v[12:13], v[12:13], v[170:171]
v_pk_add_f32 v[168:169], v[168:169], v[14:15]
v_pk_fma_f32 v[170:171], v[14:15], v[14:15], v[170:171]
v_pk_add_f32 v[168:169], v[168:169], v[16:17]
v_pk_fma_f32 v[170:171], v[16:17], v[16:17], v[170:171]
v_pk_add_f32 v[168:169], v[168:169], v[18:19]
v_pk_fma_f32 v[170:171], v[18:19], v[18:19], v[170:171]
v_pk_add_f32 v[168:169], v[168:169], v[20:21]
v_pk_fma_f32 v[170:171], v[20:21], v[20:21], v[170:171]
v_pk_add_f32 v[168:169], v[168:169], v[22:23]
v_pk_fma_f32 v[170:171], v[22:23], v[22:23], v[170:171]
v_pk_add_f32 v[168:169], v[168:169], v[24:25]
v_pk_fma_f32 v[170:171], v[24:25], v[24:25], v[170:171]
v_pk_add_f32 v[168:169], v[168:169], v[26:27]
v_pk_fma_f32 v[170:171], v[26:27], v[26:27], v[170:171]
v_pk_add_f32 v[168:169], v[168:169], v[28:29]
v_pk_fma_f32 v[170:171], v[28:29], v[28:29], v[170:171]
v_pk_add_f32 v[168:169], v[168:169], v[30:31]
v_pk_fma_f32 v[170:171], v[30:31], v[30:31], v[170:171]
v_pk_add_f32 v[168:169], v[168:169], v[32:33]
v_pk_fma_f32 v[170:171], v[32:33], v[32:33], v[170:171]
v_pk_add_f32 v[168:169], v[168:169], v[34:35]
v_pk_fma_f32 v[170:171], v[34:35], v[34:35], v[170:171]
v_pk_add_f32 v[168:169], v[168:169], v[36:37]
v_pk_fma_f32 v[170:171], v[36:37], v[36:37], v[170:171]
v_pk_add_f32 v[168:169], v[168:169], v[38:39]
v_pk_fma_f32 v[170:171], v[38:39], v[38:39], v[170:171]
v_pk_add_f32 v[168:169], v[168:169], v[40:41]
v_pk_fma_f32 v[170:171], v[40:41], v[40:41], v[170:171]
v_pk_add_f32 v[168:169], v[168:169], v[42:43]
v_pk_fma_f32 v[170:171], v[42:43], v[42:43], v[170:171]
v_pk_add_f32 v[168:169], v[168:169], v[44:45]
v_pk_fma_f32 v[170:171], v[44:45], v[44:45], v[170:171]
v_pk_add_f32 v[168:169], v[168:169], v[46:47]
v_pk_fma_f32 v[170:171], v[46:47], v[46:47], v[170:171]
s_setprio 0
v_add_u32 v174, -36864, v242
v_subrev_u32 v175, 66560, v174
v_min_u32 v174, v174, v175
v_add_u32 v174, 90112, v174
v_sub_u32 v175, v174, v242
v_add_u32 v242, v175, v242
v_add_u32 v243, v175, v243
v_add_u32 v244, v175, v244
v_lshlrev_b32_e64 v252, 7, v251
s_add_u32 s46, s47, 1572864
s_mov_b32 exec_lo, 0
s_mov_b32 exec_hi, 1048572
s_mov_b32 m0, 16152
s_nop 0
buffer_load_dword v252, s[4:7], s46 offen lds
s_mov_b64 exec, -1
s_setprio 2
v_cvt_pkrtz_f16_f32 v137, v120, v121
v_cvt_pkrtz_f16_f32 v139, v122, v123
v_cvt_pkrtz_f16_f32 v141, v124, v125
v_cvt_pkrtz_f16_f32 v143, v126, v127
v_cvt_pkrtz_f16_f32 v145, v128, v129
v_cvt_pk_f16_f32 v155, v130, v131
v_cvt_pk_f16_f32 v152, v132, v133
v_cvt_pk_f16_f32 v149, v134, v135
ds_read_b128 v[224:227], v249 offset:17408
v_mfma_f32_32x32x16_bf16 v[120:135], v[48:51], v[228:231], 0
v_pk_fma_f16 v154, v155, v155, s48
v_add_f32 v168, v168, v169
v_and_b32 v137, s49, v137
v_pk_fma_f16 v151, v152, v152, s48
v_and_b32_e64 v139, s49, v139
v_pk_fma_f16 v148, v149, v149, s48
v_add_f32_e64 v170, v170, v171
v_pk_mul_f16 v154, v155, v154
v_bfe_u32 v136, v137, 2, 14
v_pk_mul_f16 v151, v152, v151
v_pk_mul_f16 v148, v149, v148
v_bfe_u32 v138, v139, 2, 14
ds_read_b128 v[228:231], v249 offset:18432
ds_read_u16_d16 v136, v136
ds_read_u16_d16 v138, v138
v_mfma_f32_32x32x16_bf16 v[120:135], v[52:55], v[232:235], v[120:135]
v_permlane32_swap_b32 v168, v170
v_exp_f16 v153, v154
v_lshrrev_b32 v137, 18, v137
v_exp_f16 v150, v151
v_add_f32 v168, v168, v170
v_lshrrev_b32 v139, 18, v139
v_exp_f16 v147, v148
v_and_b32 v141, s49, v141
v_and_b32_e64 v143, s49, v143
v_mul_f32 v168, 1009429163, v168
ds_read_b128 v[232:235], v249 offset:21504
ds_read_u16_d16_hi v137, v137
ds_read_u16_d16_hi v139, v139
v_mfma_f32_32x32x16_bf16 v[120:135], v[56:59], v[236:239], v[120:135]
v_exp_f16_sdwa v153, v154 dst_sel:WORD_1 dst_unused:UNUSED_PRESERVE src0_sel:WORD_1
v_bfe_u32 v140, v141, 2, 14
v_exp_f16_sdwa v150, v151 dst_sel:WORD_1 dst_unused:UNUSED_PRESERVE src0_sel:WORD_1
v_mov_b32_e64 v170, v168
v_bfe_u32 v142, v143, 2, 14
v_exp_f16_sdwa v147, v148 dst_sel:WORD_1 dst_unused:UNUSED_PRESERVE src0_sel:WORD_1
v_lshrrev_b32_e64 v141, 18, v141
v_permlane32_swap_b32 v168, v170
v_pk_add_f16 v153, v153, 1.0 op_sel_hi:[1,0]
s_waitcnt lgkmcnt(8)
ds_read_b128 v[236:239], v249 offset:19456
ds_read_u16_d16 v140, v140
ds_read_u16_d16 v142, v142
ds_read_u16_d16_hi v141, v141
v_mfma_f32_32x32x16_bf16 v[120:135], v[60:63], v[216:219], v[120:135]
v_lshrrev_b32_e64 v143, 18, v143
v_pk_add_f16 v150, v150, 1.0 op_sel_hi:[1,0]
v_pk_add_f16 v147, v147, 1.0 op_sel_hi:[1,0]
v_and_b32_e64 v145, s49, v145
v_fma_f32 v170, -v168, v168, v170
v_rcp_f16_e64 v154, v153
v_bfe_u32 v144, v145, 2, 14
v_rcp_f16 v151, v150
v_max_f32 v170, 0, v170
v_lshrrev_b32_e64 v145, 18, v145
ds_read_b128 v[216:219], v249 offset:22528
ds_read_u16_d16_hi v143, v143
ds_read_u16_d16 v144, v144
ds_read_u16_d16_hi v145, v145
v_mfma_f32_32x32x16_bf16 v[120:135], v[64:67], v[220:223], v[120:135]
v_rcp_f16 v148, v147
v_rcp_f16_sdwa v154, v153 dst_sel:WORD_1 dst_unused:UNUSED_PRESERVE src0_sel:WORD_1
v_add_f32 v170, 925353388, v170
s_waitcnt lgkmcnt(8)
v_fma_mix_f32 v165, v136, v136, 0 op_sel:[0,0,0] op_sel_hi:[1,1,0]
ds_read_b32 v247, v253 offset:16
v_fma_mix_f32 v165, v137, v137, v165 op_sel:[1,1,0] op_sel_hi:[1,1,0]
v_rcp_f16_sdwa v151, v150 dst_sel:WORD_1 dst_unused:UNUSED_PRESERVE src0_sel:WORD_1
v_rsq_f32_e64 v170, v170
v_fma_mix_f32 v165, v138, v138, v165 op_sel:[0,0,0] op_sel_hi:[1,1,0]
ds_read_b128 v[220:223], v249 offset:20480
v_mfma_f32_32x32x16_bf16 v[120:135], v[68:71], v[224:227], v[120:135]
v_rcp_f16_sdwa v148, v147 dst_sel:WORD_1 dst_unused:UNUSED_PRESERVE src0_sel:WORD_1
v_fma_mix_f32 v165, v139, v139, v165 op_sel:[1,1,0] op_sel_hi:[1,1,0]
v_pk_mul_f16 v155, v155, v154
s_waitcnt lgkmcnt(6)
v_fma_mix_f32 v165, v140, v140, v165 op_sel:[0,0,0] op_sel_hi:[1,1,0]
v_pk_mul_f16 v152, v152, v151
v_fma_mix_f32 v165, v141, v141, v165 op_sel:[1,1,0] op_sel_hi:[1,1,0]
v_pk_mul_f16 v149, v149, v148
v_fma_mix_f32 v165, v155, v155, v165 op_sel:[0,0,0] op_sel_hi:[1,1,0]
v_mul_f32 v172, 3203391086, v170
v_fma_mix_f32 v165, v142, v142, v165 op_sel:[0,0,0] op_sel_hi:[1,1,0]
v_fma_mix_f32 v165, v155, v155, v165 op_sel:[1,1,0] op_sel_hi:[1,1,0]
s_waitcnt lgkmcnt(2)
v_fma_mix_f32 v165, v143, v143, v165 op_sel:[1,1,0] op_sel_hi:[1,1,0]
v_fma_mix_f32 v165, v152, v152, v165 op_sel:[0,0,0] op_sel_hi:[1,1,0]
v_fma_mix_f32 v165, v152, v152, v165 op_sel:[1,1,0] op_sel_hi:[1,1,0]
v_mul_f32 v173, v168, v172
v_fma_mix_f32 v165, v144, v144, v165 op_sel:[0,0,0] op_sel_hi:[1,1,0]
v_fma_mix_f32 v165, v149, v149, v165 op_sel:[0,0,0] op_sel_hi:[1,1,0]
v_fma_mix_f32 v165, v145, v145, v165 op_sel:[1,1,0] op_sel_hi:[1,1,0]
v_fma_mix_f32 v165, v149, v149, v165 op_sel:[1,1,0] op_sel_hi:[1,1,0]
s_setprio 3
v_pk_fma_f32 v[0:1], v[0:1], v[172:173], v[172:173] op_sel:[0,0,1] op_sel_hi:[1,0,1] neg_lo:[0,0,1] neg_hi:[0,0,1]
v_pk_fma_f32 v[2:3], v[2:3], v[172:173], v[172:173] op_sel:[0,0,1] op_sel_hi:[1,0,1] neg_lo:[0,0,1] neg_hi:[0,0,1]
v_pk_fma_f32 v[4:5], v[4:5], v[172:173], v[172:173] op_sel:[0,0,1] op_sel_hi:[1,0,1] neg_lo:[0,0,1] neg_hi:[0,0,1]
v_pk_fma_f32 v[6:7], v[6:7], v[172:173], v[172:173] op_sel:[0,0,1] op_sel_hi:[1,0,1] neg_lo:[0,0,1] neg_hi:[0,0,1]
v_pk_fma_f32 v[8:9], v[8:9], v[172:173], v[172:173] op_sel:[0,0,1] op_sel_hi:[1,0,1] neg_lo:[0,0,1] neg_hi:[0,0,1]
v_pk_fma_f32 v[10:11], v[10:11], v[172:173], v[172:173] op_sel:[0,0,1] op_sel_hi:[1,0,1] neg_lo:[0,0,1] neg_hi:[0,0,1]
v_pk_fma_f32 v[12:13], v[12:13], v[172:173], v[172:173] op_sel:[0,0,1] op_sel_hi:[1,0,1] neg_lo:[0,0,1] neg_hi:[0,0,1]
v_pk_fma_f32 v[14:15], v[14:15], v[172:173], v[172:173] op_sel:[0,0,1] op_sel_hi:[1,0,1] neg_lo:[0,0,1] neg_hi:[0,0,1]
v_pk_fma_f32 v[16:17], v[16:17], v[172:173], v[172:173] op_sel:[0,0,1] op_sel_hi:[1,0,1] neg_lo:[0,0,1] neg_hi:[0,0,1]
v_pk_fma_f32 v[18:19], v[18:19], v[172:173], v[172:173] op_sel:[0,0,1] op_sel_hi:[1,0,1] neg_lo:[0,0,1] neg_hi:[0,0,1]
v_pk_fma_f32 v[20:21], v[20:21], v[172:173], v[172:173] op_sel:[0,0,1] op_sel_hi:[1,0,1] neg_lo:[0,0,1] neg_hi:[0,0,1]
v_pk_fma_f32 v[22:23], v[22:23], v[172:173], v[172:173] op_sel:[0,0,1] op_sel_hi:[1,0,1] neg_lo:[0,0,1] neg_hi:[0,0,1]
v_pk_fma_f32 v[24:25], v[24:25], v[172:173], v[172:173] op_sel:[0,0,1] op_sel_hi:[1,0,1] neg_lo:[0,0,1] neg_hi:[0,0,1]
v_pk_fma_f32 v[26:27], v[26:27], v[172:173], v[172:173] op_sel:[0,0,1] op_sel_hi:[1,0,1] neg_lo:[0,0,1] neg_hi:[0,0,1]
v_pk_fma_f32 v[28:29], v[28:29], v[172:173], v[172:173] op_sel:[0,0,1] op_sel_hi:[1,0,1] neg_lo:[0,0,1] neg_hi:[0,0,1]
v_pk_fma_f32 v[30:31], v[30:31], v[172:173], v[172:173] op_sel:[0,0,1] op_sel_hi:[1,0,1] neg_lo:[0,0,1] neg_hi:[0,0,1]
v_pk_fma_f32 v[32:33], v[32:33], v[172:173], v[172:173] op_sel:[0,0,1] op_sel_hi:[1,0,1] neg_lo:[0,0,1] neg_hi:[0,0,1]
v_pk_fma_f32 v[34:35], v[34:35], v[172:173], v[172:173] op_sel:[0,0,1] op_sel_hi:[1,0,1] neg_lo:[0,0,1] neg_hi:[0,0,1]
v_pk_fma_f32 v[36:37], v[36:37], v[172:173], v[172:173] op_sel:[0,0,1] op_sel_hi:[1,0,1] neg_lo:[0,0,1] neg_hi:[0,0,1]
v_pk_fma_f32 v[38:39], v[38:39], v[172:173], v[172:173] op_sel:[0,0,1] op_sel_hi:[1,0,1] neg_lo:[0,0,1] neg_hi:[0,0,1]
v_pk_fma_f32 v[40:41], v[40:41], v[172:173], v[172:173] op_sel:[0,0,1] op_sel_hi:[1,0,1] neg_lo:[0,0,1] neg_hi:[0,0,1]
v_pk_fma_f32 v[42:43], v[42:43], v[172:173], v[172:173] op_sel:[0,0,1] op_sel_hi:[1,0,1] neg_lo:[0,0,1] neg_hi:[0,0,1]
v_pk_fma_f32 v[44:45], v[44:45], v[172:173], v[172:173] op_sel:[0,0,1] op_sel_hi:[1,0,1] neg_lo:[0,0,1] neg_hi:[0,0,1]
v_pk_fma_f32 v[46:47], v[46:47], v[172:173], v[172:173] op_sel:[0,0,1] op_sel_hi:[1,0,1] neg_lo:[0,0,1] neg_hi:[0,0,1]
s_setprio 2
s_waitcnt lgkmcnt(0)
v_readfirstlane_b32 s43, v247
s_nop 1
s_cmp_ge_u32 s43, 16
s_cbranch_scc1 Lev4
Lev4w:
s_sleep 1
ds_read_b32 v247, v253 offset:16
s_waitcnt lgkmcnt(0)
v_readfirstlane_b32 s43, v247
s_cmp_eq_u32 s76, 0
s_cbranch_scc1 Lev4
s_sub_u32 s76, s76, 1
s_cmp_lt_u32 s43, 16
s_cbranch_scc1 Lev4w
Lev4:
s_setprio 1
v_cvt_pkrtz_f16_f32 v137, v120, v121
v_cvt_pkrtz_f16_f32 v139, v122, v123
v_cvt_pkrtz_f16_f32 v141, v124, v125
v_cvt_pkrtz_f16_f32 v143, v126, v127
v_cvt_pkrtz_f16_f32 v145, v128, v129
v_cvt_pk_f16_f32 v155, v130, v131
v_cvt_pk_f16_f32 v152, v132, v133
v_cvt_pk_f16_f32 v149, v134, v135
s_add_u32 m0, s67, 53248
s_add_u32 s66, s66, 98304
buffer_load_dwordx4 v240, s[4:7], s66 offen lds
ds_read_b128 v[224:227], v249 offset:23552
v_mfma_f32_32x32x16_bf16 v[120:135], v[48:51], v[228:231], 0
v_pk_fma_f16 v154, v155, v155, s48
v_cvt_pk_bf16_f32 v72, v0, v1
v_and_b32 v137, s49, v137
v_pk_fma_f16 v151, v152, v152, s48
v_cvt_pk_bf16_f32 v73, v2, v3
v_and_b32_e64 v139, s49, v139
v_pk_fma_f16 v148, v149, v149, s48
v_pk_mul_f16 v154, v155, v154
v_cvt_pk_bf16_f32 v74, v4, v5
v_bfe_u32 v136, v137, 2, 14
v_pk_mul_f16 v151, v152, v151
v_pk_mul_f16 v148, v149, v148
v_cvt_pk_bf16_f32 v75, v6, v7
v_bfe_u32 v138, v139, 2, 14
s_add_u32 m0, s67, 59904
s_add_u32 s66, s66, 98304
buffer_load_dwordx4 v240, s[4:7], s66 offen lds
ds_read_b128 v[228:231], v248 offset:16384
ds_read_u16_d16 v136, v136
ds_read_u16_d16 v138, v138
v_mfma_f32_32x32x16_bf16 v[120:135], v[52:55], v[232:235], v[120:135]
v_exp_f16_e64 v153, v154
v_cvt_pk_bf16_f32 v76, v8, v9
v_lshrrev_b32 v137, 18, v137
v_exp_f16 v150, v151
v_cvt_pk_bf16_f32 v77, v10, v11
v_lshrrev_b32 v139, 18, v139
v_exp_f16 v147, v148
v_cvt_pk_bf16_f32 v78, v12, v13
v_and_b32_e64 v141, s49, v141
v_and_b32 v143, s49, v143
v_cvt_pk_bf16_f32 v79, v14, v15
s_add_u32 m0, s67, 0
s_add_u32 s66, s66, 98304
buffer_load_dwordx4 v240, s[4:7], s66 offen lds
ds_read_b128 v[232:235], v248 offset:19456
ds_read_u16_d16_hi v137, v137
ds_read_u16_d16_hi v139, v139
v_mfma_f32_32x32x16_bf16 v[120:135], v[56:59], v[236:239], v[120:135]
v_exp_f16_sdwa v153, v154 dst_sel:WORD_1 dst_unused:UNUSED_PRESERVE src0_sel:WORD_1
v_bfe_u32 v140, v141, 2, 14
v_cvt_pk_bf16_f32 v80, v16, v17
v_exp_f16_sdwa v150, v151 dst_sel:WORD_1 dst_unused:UNUSED_PRESERVE src0_sel:WORD_1
v_bfe_u32 v142, v143, 2, 14
v_cvt_pk_bf16_f32 v81, v18, v19
v_exp_f16_sdwa v147, v148 dst_sel:WORD_1 dst_unused:UNUSED_PRESERVE src0_sel:WORD_1
v_cvt_pk_bf16_f32 v82, v20, v21
v_lshrrev_b32_e64 v141, 18, v141
v_pk_add_f16 v153, v153, 1.0 op_sel_hi:[1,0]
v_lshrrev_b32_e64 v143, 18, v143
s_add_u32 m0, s67, 6656
s_add_u32 s66, s66, 98304
buffer_load_dwordx4 v240, s[4:7], s66 offen lds
s_add_u32 m0, s67, 13312
s_add_u32 s66, s66, 98304
buffer_load_dwordx4 v240, s[4:7], s66 offen lds
ds_read_b128 v[236:239], v248 offset:17408
ds_read_u16_d16 v140, v140
ds_read_u16_d16 v142, v142
ds_read_u16_d16_hi v141, v141
ds_read_u16_d16_hi v143, v143
v_mfma_f32_32x32x16_bf16 v[120:135], v[60:63], v[216:219], v[120:135]
v_cvt_pk_bf16_f32 v83, v22, v23
v_pk_add_f16 v150, v150, 1.0 op_sel_hi:[1,0]
v_pk_add_f16 v147, v147, 1.0 op_sel_hi:[1,0]
v_and_b32_e64 v145, s49, v145
v_cvt_pk_bf16_f32 v84, v24, v25
v_rcp_f16_e64 v154, v153
v_bfe_u32 v144, v145, 2, 14
v_cvt_pk_bf16_f32 v85, v26, v27
v_rcp_f16 v151, v150
v_lshrrev_b32 v145, 18, v145
v_cvt_pk_bf16_f32 v86, v28, v29
s_add_u32 m0, s67, 19968
s_add_u32 s66, s66, 98304
buffer_load_dwordx4 v240, s[4:7], s66 offen lds
ds_read_b128 v[216:219], v248 offset:20480
ds_read_u16_d16 v144, v144
ds_read_u16_d16_hi v145, v145
v_mfma_f32_32x32x16_bf16 v[120:135], v[64:67], v[220:223], v[120:135]
v_rcp_f16_e64 v148, v147
v_cvt_pk_bf16_f32 v87, v30, v31
v_rcp_f16_sdwa v154, v153 dst_sel:WORD_1 dst_unused:UNUSED_PRESERVE src0_sel:WORD_1
s_waitcnt lgkmcnt(5)
v_fma_mix_f32 v166, v136, v136, 0 op_sel:[0,0,0] op_sel_hi:[1,1,0]
v_cvt_pk_bf16_f32 v88, v32, v33
s_setprio 0
v_fma_mix_f32 v166, v137, v137, v166 op_sel:[1,1,0] op_sel_hi:[1,1,0]
v_rcp_f16_sdwa v151, v150 dst_sel:WORD_1 dst_unused:UNUSED_PRESERVE src0_sel:WORD_1
v_cvt_pk_bf16_f32 v89, v34, v35
v_fma_mix_f32 v166, v138, v138, v166 op_sel:[0,0,0] op_sel_hi:[1,1,0]
v_rcp_f16_sdwa v148, v147 dst_sel:WORD_1 dst_unused:UNUSED_PRESERVE src0_sel:WORD_1
v_cvt_pk_bf16_f32 v90, v36, v37
s_add_u32 m0, s67, 26624
s_add_u32 s66, s66, 98304
buffer_load_dwordx4 v240, s[4:7], s66 offen lds
ds_read_b128 v[220:223], v248 offset:18432
v_mfma_f32_32x32x16_bf16 v[120:135], v[68:71], v[224:227], v[120:135]
v_fma_mix_f32 v166, v139, v139, v166 op_sel:[1,1,0] op_sel_hi:[1,1,0]
v_pk_mul_f16 v155, v155, v154
v_fma_mix_f32 v166, v140, v140, v166 op_sel:[0,0,0] op_sel_hi:[1,1,0]
v_cvt_pk_bf16_f32 v91, v38, v39
v_pk_mul_f16 v152, v152, v151
s_waitcnt lgkmcnt(1)
v_fma_mix_f32 v166, v141, v141, v166 op_sel:[1,1,0] op_sel_hi:[1,1,0]
v_cvt_pk_bf16_f32 v92, v40, v41
v_pk_mul_f16 v149, v149, v148
v_fma_mix_f32 v166, v155, v155, v166 op_sel:[0,0,0] op_sel_hi:[1,1,0]
v_fma_mix_f32 v166, v142, v142, v166 op_sel:[0,0,0] op_sel_hi:[1,1,0]
v_cvt_pk_bf16_f32 v93, v42, v43
v_fma_mix_f32 v166, v155, v155, v166 op_sel:[1,1,0] op_sel_hi:[1,1,0]
v_fma_mix_f32 v166, v143, v143, v166 op_sel:[1,1,0] op_sel_hi:[1,1,0]
v_fma_mix_f32 v166, v152, v152, v166 op_sel:[0,0,0] op_sel_hi:[1,1,0]
s_add_u32 m0, s67, 33280
s_add_u32 s66, s66, 98304
buffer_load_dwordx4 v240, s[4:7], s66 offen lds
v_cvt_pk_bf16_f32 v94, v44, v45
v_fma_mix_f32 v166, v152, v152, v166 op_sel:[1,1,0] op_sel_hi:[1,1,0]
v_fma_mix_f32 v166, v144, v144, v166 op_sel:[0,0,0] op_sel_hi:[1,1,0]
v_fma_mix_f32 v166, v149, v149, v166 op_sel:[0,0,0] op_sel_hi:[1,1,0]
v_cvt_pk_bf16_f32 v95, v46, v47
v_fma_mix_f32 v166, v145, v145, v166 op_sel:[1,1,0] op_sel_hi:[1,1,0]
v_fma_mix_f32 v166, v149, v149, v166 op_sel:[1,1,0] op_sel_hi:[1,1,0]
s_setprio 2
v_cvt_pkrtz_f16_f32 v137, v120, v121
v_cvt_pkrtz_f16_f32 v139, v122, v123
v_cvt_pkrtz_f16_f32 v141, v124, v125
v_cvt_pkrtz_f16_f32 v143, v126, v127
v_cvt_pkrtz_f16_f32 v145, v128, v129
v_cvt_pk_f16_f32 v155, v130, v131
v_cvt_pk_f16_f32 v152, v132, v133
v_cvt_pk_f16_f32 v149, v134, v135
buffer_store_dwordx4 v[48:51], v241, s[32:35], s80 offen sc1
ds_read_b128 v[224:227], v248 offset:21504
v_mfma_f32_32x32x16_bf16 v[120:135], v[72:75], v[228:231], 0
v_pk_fma_f16 v154, v155, v155, s48
v_and_b32_e64 v137, s49, v137
v_pk_fma_f16 v151, v152, v152, s48
v_and_b32_e64 v139, s49, v139
v_pk_fma_f16 v148, v149, v149, s48
v_pk_mul_f16 v154, v155, v154
v_bfe_u32 v136, v137, 2, 14
v_pk_mul_f16 v151, v152, v151
v_pk_mul_f16 v148, v149, v148
v_bfe_u32 v138, v139, 2, 14
ds_read_b128 v[228:231], v248 offset:22528
ds_read_u16_d16 v136, v136
ds_read_u16_d16 v138, v138
v_mfma_f32_32x32x16_bf16 v[120:135], v[76:79], v[232:235], v[120:135]
v_exp_f16 v153, v154
v_lshrrev_b32 v137, 18, v137
v_exp_f16 v150, v151
v_lshrrev_b32 v139, 18, v139
v_exp_f16 v147, v148
v_and_b32 v141, s49, v141
v_and_b32_e64 v143, s49, v143
ds_read_b128 v[232:235], v248 offset:25600
ds_read_u16_d16_hi v137, v137
ds_read_u16_d16_hi v139, v139
v_mfma_f32_32x32x16_bf16 v[120:135], v[80:83], v[236:239], v[120:135]
v_exp_f16_sdwa v153, v154 dst_sel:WORD_1 dst_unused:UNUSED_PRESERVE src0_sel:WORD_1
v_bfe_u32 v140, v141, 2, 14
v_exp_f16_sdwa v150, v151 dst_sel:WORD_1 dst_unused:UNUSED_PRESERVE src0_sel:WORD_1
v_bfe_u32 v142, v143, 2, 14
v_exp_f16_sdwa v147, v148 dst_sel:WORD_1 dst_unused:UNUSED_PRESERVE src0_sel:WORD_1
v_lshrrev_b32_e64 v141, 18, v141
v_pk_add_f16 v153, v153, 1.0 op_sel_hi:[1,0]
ds_read_b128 v[236:239], v248 offset:23552
ds_read_u16_d16 v140, v140
ds_read_u16_d16 v142, v142
ds_read_u16_d16_hi v141, v141
v_mfma_f32_32x32x16_bf16 v[120:135], v[84:87], v[216:219], v[120:135]
v_lshrrev_b32_e64 v143, 18, v143
v_pk_add_f16 v150, v150, 1.0 op_sel_hi:[1,0]
v_pk_add_f16 v147, v147, 1.0 op_sel_hi:[1,0]
v_and_b32 v145, s49, v145
v_rcp_f16 v154, v153
v_bfe_u32 v144, v145, 2, 14
v_rcp_f16_e64 v151, v150
v_lshrrev_b32 v145, 18, v145
s_waitcnt lgkmcnt(7)
ds_read_b128 v[216:219], v248 offset:26624
ds_read_u16_d16_hi v143, v143
ds_read_u16_d16 v144, v144
ds_read_u16_d16_hi v145, v145
v_mfma_f32_32x32x16_bf16 v[120:135], v[88:91], v[220:223], v[120:135]
v_rcp_f16 v148, v147
v_rcp_f16_sdwa v154, v153 dst_sel:WORD_1 dst_unused:UNUSED_PRESERVE src0_sel:WORD_1
v_fma_mix_f32 v167, v136, v136, 0 op_sel:[0,0,0] op_sel_hi:[1,1,0]
s_waitcnt lgkmcnt(8)
v_fma_mix_f32 v167, v137, v137, v167 op_sel:[1,1,0] op_sel_hi:[1,1,0]
v_rcp_f16_sdwa v151, v150 dst_sel:WORD_1 dst_unused:UNUSED_PRESERVE src0_sel:WORD_1
v_fma_mix_f32 v167, v138, v138, v167 op_sel:[0,0,0] op_sel_hi:[1,1,0]
ds_read_b128 v[220:223], v248 offset:24576
v_mfma_f32_32x32x16_bf16 v[120:135], v[92:95], v[224:227], v[120:135]
v_rcp_f16_sdwa v148, v147 dst_sel:WORD_1 dst_unused:UNUSED_PRESERVE src0_sel:WORD_1
v_fma_mix_f32 v167, v139, v139, v167 op_sel:[1,1,0] op_sel_hi:[1,1,0]
v_pk_mul_f16 v155, v155, v154
s_waitcnt lgkmcnt(5)
v_fma_mix_f32 v167, v140, v140, v167 op_sel:[0,0,0] op_sel_hi:[1,1,0]
v_pk_mul_f16 v152, v152, v151
v_fma_mix_f32 v167, v141, v141, v167 op_sel:[1,1,0] op_sel_hi:[1,1,0]
v_pk_mul_f16 v149, v149, v148
v_fma_mix_f32 v167, v155, v155, v167 op_sel:[0,0,0] op_sel_hi:[1,1,0]
v_fma_mix_f32 v167, v142, v142, v167 op_sel:[0,0,0] op_sel_hi:[1,1,0]
v_fma_mix_f32 v167, v155, v155, v167 op_sel:[1,1,0] op_sel_hi:[1,1,0]
s_waitcnt lgkmcnt(3)
v_fma_mix_f32 v167, v143, v143, v167 op_sel:[1,1,0] op_sel_hi:[1,1,0]
v_fma_mix_f32 v167, v152, v152, v167 op_sel:[0,0,0] op_sel_hi:[1,1,0]
v_fma_mix_f32 v167, v152, v152, v167 op_sel:[1,1,0] op_sel_hi:[1,1,0]
s_waitcnt lgkmcnt(1)
v_fma_mix_f32 v167, v144, v144, v167 op_sel:[0,0,0] op_sel_hi:[1,1,0]
v_fma_mix_f32 v167, v149, v149, v167 op_sel:[0,0,0] op_sel_hi:[1,1,0]
v_fma_mix_f32 v167, v145, v145, v167 op_sel:[1,1,0] op_sel_hi:[1,1,0]
v_fma_mix_f32 v167, v149, v149, v167 op_sel:[1,1,0] op_sel_hi:[1,1,0]
s_setprio 1
v_cvt_pkrtz_f16_f32 v137, v120, v121
v_cvt_pkrtz_f16_f32 v139, v122, v123
v_cvt_pkrtz_f16_f32 v141, v124, v125
v_cvt_pkrtz_f16_f32 v143, v126, v127
v_cvt_pkrtz_f16_f32 v145, v128, v129
v_cvt_pk_f16_f32 v155, v130, v131
v_cvt_pk_f16_f32 v152, v132, v133
v_cvt_pk_f16_f32 v149, v134, v135
s_add_u32 s46, s80, 2097152
buffer_store_dwordx4 v[52:55], v241, s[32:35], s46 offen sc1
ds_read_b128 v[224:227], v248 offset:27648
v_mfma_f32_32x32x16_bf16 v[120:135], v[72:75], v[228:231], 0
v_pk_fma_f16 v154, v155, v155, s48
v_and_b32_e64 v137, s49, v137
v_pk_fma_f16 v151, v152, v152, s48
v_and_b32_e64 v139, s49, v139
v_pk_fma_f16 v148, v149, v149, s48
v_pk_mul_f16 v154, v155, v154
v_bfe_u32 v136, v137, 2, 14
v_pk_mul_f16 v151, v152, v151
v_pk_mul_f16 v148, v149, v148
v_bfe_u32 v138, v139, 2, 14
ds_read_b128 v[228:231], v248 offset:28672
ds_read_u16_d16 v136, v136
ds_read_u16_d16 v138, v138
v_mfma_f32_32x32x16_bf16 v[120:135], v[76:79], v[232:235], v[120:135]
v_exp_f16 v153, v154
v_lshrrev_b32 v137, 18, v137
v_exp_f16 v150, v151
v_lshrrev_b32 v139, 18, v139
v_exp_f16 v147, v148
v_and_b32 v141, s49, v141
v_and_b32_e64 v143, s49, v143
ds_read_b128 v[232:235], v248 offset:31744
ds_read_u16_d16_hi v137, v137
ds_read_u16_d16_hi v139, v139
v_mfma_f32_32x32x16_bf16 v[120:135], v[80:83], v[236:239], v[120:135]
v_exp_f16_sdwa v153, v154 dst_sel:WORD_1 dst_unused:UNUSED_PRESERVE src0_sel:WORD_1
v_bfe_u32 v140, v141, 2, 14
v_exp_f16_sdwa v150, v151 dst_sel:WORD_1 dst_unused:UNUSED_PRESERVE src0_sel:WORD_1
v_bfe_u32 v142, v143, 2, 14
v_exp_f16_sdwa v147, v148 dst_sel:WORD_1 dst_unused:UNUSED_PRESERVE src0_sel:WORD_1
v_lshrrev_b32_e64 v141, 18, v141
v_pk_add_f16 v153, v153, 1.0 op_sel_hi:[1,0]
ds_read_b128 v[236:239], v248 offset:29696
ds_read_u16_d16 v140, v140
ds_read_u16_d16 v142, v142
ds_read_u16_d16_hi v141, v141
v_mfma_f32_32x32x16_bf16 v[120:135], v[84:87], v[216:219], v[120:135]
v_lshrrev_b32_e64 v143, 18, v143
v_pk_add_f16 v150, v150, 1.0 op_sel_hi:[1,0]
v_pk_add_f16 v147, v147, 1.0 op_sel_hi:[1,0]
v_and_b32 v145, s49, v145
v_rcp_f16 v154, v153
v_bfe_u32 v144, v145, 2, 14
v_rcp_f16_e64 v151, v150
v_lshrrev_b32 v145, 18, v145
s_waitcnt lgkmcnt(7)
ds_read_b128 v[216:219], v248 offset:32768
ds_read_u16_d16_hi v143, v143
ds_read_u16_d16 v144, v144
ds_read_u16_d16_hi v145, v145
v_mfma_f32_32x32x16_bf16 v[120:135], v[88:91], v[220:223], v[120:135]
v_rcp_f16_e64 v148, v147
v_rcp_f16_sdwa v154, v153 dst_sel:WORD_1 dst_unused:UNUSED_PRESERVE src0_sel:WORD_1
v_fma_mix_f32 v156, v136, v136, v156 op_sel:[0,0,0] op_sel_hi:[1,1,0]
s_setprio 0
s_waitcnt lgkmcnt(8)
v_fma_mix_f32 v156, v137, v137, v156 op_sel:[1,1,0] op_sel_hi:[1,1,0]
v_rcp_f16_sdwa v151, v150 dst_sel:WORD_1 dst_unused:UNUSED_PRESERVE src0_sel:WORD_1
v_fma_mix_f32 v156, v138, v138, v156 op_sel:[0,0,0] op_sel_hi:[1,1,0]
ds_read_b128 v[220:223], v248 offset:30720
v_mfma_f32_32x32x16_bf16 v[120:135], v[92:95], v[224:227], v[120:135]
v_rcp_f16_sdwa v148, v147 dst_sel:WORD_1 dst_unused:UNUSED_PRESERVE src0_sel:WORD_1
v_fma_mix_f32 v156, v139, v139, v156 op_sel:[1,1,0] op_sel_hi:[1,1,0]
v_pk_mul_f16 v155, v155, v154
s_cmp_eq_u32 s40, 7
s_cbranch_scc1 Lrdy16
s_waitcnt vmcnt(2)
Lrdy16:
s_mov_b64 exec, 1
ds_add_u32 v253, v254 offset:12
s_mov_b64 exec, -1
s_waitcnt lgkmcnt(6)
v_fma_mix_f32 v156, v140, v140, v156 op_sel:[0,0,0] op_sel_hi:[1,1,0]
v_pk_mul_f16 v152, v152, v151
v_fma_mix_f32 v156, v141, v141, v156 op_sel:[1,1,0] op_sel_hi:[1,1,0]
v_pk_mul_f16 v149, v149, v148
v_fma_mix_f32 v156, v155, v155, v156 op_sel:[0,0,0] op_sel_hi:[1,1,0]
v_fma_mix_f32 v156, v142, v142, v156 op_sel:[0,0,0] op_sel_hi:[1,1,0]
v_fma_mix_f32 v156, v155, v155, v156 op_sel:[1,1,0] op_sel_hi:[1,1,0]
s_waitcnt lgkmcnt(2)
v_fma_mix_f32 v156, v143, v143, v156 op_sel:[1,1,0] op_sel_hi:[1,1,0]
v_fma_mix_f32 v156, v152, v152, v156 op_sel:[0,0,0] op_sel_hi:[1,1,0]
v_fma_mix_f32 v156, v152, v152, v156 op_sel:[1,1,0] op_sel_hi:[1,1,0]
v_fma_mix_f32 v156, v144, v144, v156 op_sel:[0,0,0] op_sel_hi:[1,1,0]
v_fma_mix_f32 v156, v149, v149, v156 op_sel:[0,0,0] op_sel_hi:[1,1,0]
v_fma_mix_f32 v156, v145, v145, v156 op_sel:[1,1,0] op_sel_hi:[1,1,0]
v_fma_mix_f32 v156, v149, v149, v156 op_sel:[1,1,0] op_sel_hi:[1,1,0]
s_setprio 2
v_cvt_pkrtz_f16_f32 v137, v120, v121
v_cvt_pkrtz_f16_f32 v139, v122, v123
v_cvt_pkrtz_f16_f32 v141, v124, v125
v_cvt_pkrtz_f16_f32 v143, v126, v127
v_cvt_pkrtz_f16_f32 v145, v128, v129
v_cvt_pk_f16_f32 v155, v130, v131
v_cvt_pk_f16_f32 v152, v132, v133
v_cvt_pk_f16_f32 v149, v134, v135
s_add_u32 s46, s80, 4194304
buffer_store_dwordx4 v[56:59], v241, s[32:35], s46 offen sc1
ds_read_b128 v[224:227], v248 offset:33792
v_mfma_f32_32x32x16_bf16 v[120:135], v[72:75], v[228:231], 0
v_pk_fma_f16 v154, v155, v155, s48
v_and_b32_e64 v137, s49, v137
v_pk_fma_f16 v151, v152, v152, s48
v_and_b32_e64 v139, s49, v139
v_pk_fma_f16 v148, v149, v149, s48
v_pk_mul_f16 v154, v155, v154
v_bfe_u32 v136, v137, 2, 14
v_pk_mul_f16 v151, v152, v151
v_pk_mul_f16 v148, v149, v148
v_bfe_u32 v138, v139, 2, 14
ds_read_b128 v[228:231], v250 offset:65520
ds_read_u16_d16 v136, v136
ds_read_u16_d16 v138, v138
v_mfma_f32_32x32x16_bf16 v[120:135], v[76:79], v[232:235], v[120:135]
v_exp_f16 v153, v154
v_lshrrev_b32 v137, 18, v137
v_exp_f16 v150, v151
v_lshrrev_b32 v139, 18, v139
v_exp_f16 v147, v148
v_and_b32 v141, s49, v141
v_and_b32_e64 v143, s49, v143
ds_read_b128 v[232:235], v248 offset:34816
ds_read_u16_d16_hi v137, v137
ds_read_b32 v247, v253 offset:12
ds_read_u16_d16_hi v139, v139
v_mfma_f32_32x32x16_bf16 v[120:135], v[80:83], v[236:239], v[120:135]
v_exp_f16_sdwa v153, v154 dst_sel:WORD_1 dst_unused:UNUSED_PRESERVE src0_sel:WORD_1
v_bfe_u32 v140, v141, 2, 14
v_exp_f16_sdwa v150, v151 dst_sel:WORD_1 dst_unused:UNUSED_PRESERVE src0_sel:WORD_1
v_bfe_u32 v142, v143, 2, 14
v_exp_f16_sdwa v147, v148 dst_sel:WORD_1 dst_unused:UNUSED_PRESERVE src0_sel:WORD_1
v_lshrrev_b32_e64 v141, 18, v141
v_pk_add_f16 v153, v153, 1.0 op_sel_hi:[1,0]
ds_read_b128 v[236:239], v248 offset:37888
ds_read_u16_d16 v140, v140
ds_read_u16_d16 v142, v142
ds_read_u16_d16_hi v141, v141
v_mfma_f32_32x32x16_bf16 v[120:135], v[84:87], v[216:219], v[120:135]
v_lshrrev_b32_e64 v143, 18, v143
v_pk_add_f16 v150, v150, 1.0 op_sel_hi:[1,0]
v_pk_add_f16 v147, v147, 1.0 op_sel_hi:[1,0]
v_and_b32 v145, s49, v145
v_rcp_f16 v154, v153
v_bfe_u32 v144, v145, 2, 14
ds_read_u16_d16_hi v143, v143
ds_read_u16_d16 v144, v144
s_waitcnt lgkmcnt(7)
v_readfirstlane_b32 s43, v247
s_nop 1
s_cmp_ge_u32 s43, 24
s_cbranch_scc1 Lev5
Lev5w:
s_sleep 1
ds_read_b32 v247, v253 offset:12
s_waitcnt lgkmcnt(0)
v_readfirstlane_b32 s43, v247
s_cmp_eq_u32 s76, 0
s_cbranch_scc1 Lev5
s_sub_u32 s76, s76, 1
s_cmp_lt_u32 s43, 24
s_cbranch_scc1 Lev5w
Lev5:
v_rcp_f16 v151, v150
v_lshrrev_b32_e64 v145, 18, v145
ds_read_b128 v[216:219], v248 offset:35840
ds_read_u16_d16_hi v145, v145
v_mfma_f32_32x32x16_bf16 v[120:135], v[88:91], v[220:223], v[120:135]
v_rcp_f16 v148, v147
v_rcp_f16_sdwa v154, v153 dst_sel:WORD_1 dst_unused:UNUSED_PRESERVE src0_sel:WORD_1
v_fma_mix_f32 v157, v136, v136, v157 op_sel:[0,0,0] op_sel_hi:[1,1,0]
v_fma_mix_f32 v157, v137, v137, v157 op_sel:[1,1,0] op_sel_hi:[1,1,0]
v_rcp_f16_sdwa v151, v150 dst_sel:WORD_1 dst_unused:UNUSED_PRESERVE src0_sel:WORD_1
v_fma_mix_f32 v157, v138, v138, v157 op_sel:[0,0,0] op_sel_hi:[1,1,0]
ds_read_b128 v[220:223], v245
ds_read_b128 v[192:195], v242
ds_read_b128 v[196:199], v242 offset:64
v_mfma_f32_32x32x16_bf16 v[120:135], v[92:95], v[224:227], v[120:135]
v_rcp_f16_sdwa v148, v147 dst_sel:WORD_1 dst_unused:UNUSED_PRESERVE src0_sel:WORD_1
s_waitcnt lgkmcnt(5)
v_fma_mix_f32 v157, v139, v139, v157 op_sel:[1,1,0] op_sel_hi:[1,1,0]
v_pk_mul_f16 v155, v155, v154
v_fma_mix_f32 v157, v140, v140, v157 op_sel:[0,0,0] op_sel_hi:[1,1,0]
v_pk_mul_f16 v152, v152, v151
v_fma_mix_f32 v157, v141, v141, v157 op_sel:[1,1,0] op_sel_hi:[1,1,0]
v_pk_mul_f16 v149, v149, v148
v_fma_mix_f32 v157, v155, v155, v157 op_sel:[0,0,0] op_sel_hi:[1,1,0]
v_fma_mix_f32 v157, v142, v142, v157 op_sel:[0,0,0] op_sel_hi:[1,1,0]
v_fma_mix_f32 v157, v155, v155, v157 op_sel:[1,1,0] op_sel_hi:[1,1,0]
v_fma_mix_f32 v157, v143, v143, v157 op_sel:[1,1,0] op_sel_hi:[1,1,0]
v_fma_mix_f32 v157, v152, v152, v157 op_sel:[0,0,0] op_sel_hi:[1,1,0]
v_fma_mix_f32 v157, v152, v152, v157 op_sel:[1,1,0] op_sel_hi:[1,1,0]
v_fma_mix_f32 v157, v144, v144, v157 op_sel:[0,0,0] op_sel_hi:[1,1,0]
v_fma_mix_f32 v157, v149, v149, v157 op_sel:[0,0,0] op_sel_hi:[1,1,0]
s_waitcnt lgkmcnt(3)
v_fma_mix_f32 v157, v145, v145, v157 op_sel:[1,1,0] op_sel_hi:[1,1,0]
v_fma_mix_f32 v157, v149, v149, v157 op_sel:[1,1,0] op_sel_hi:[1,1,0]
s_setprio 1
v_mfma_f32_32x32x16_bf16 v[0:15], v[228:231], v[228:231], 0
s_add_u32 s46, s80, 6291456
buffer_store_dwordx4 v[60:63], v241, s[32:35], s46 offen sc1
ds_read_b128 v[224:227], v248 offset:38912
v_cvt_pkrtz_f16_f32 v137, v120, v121
v_cvt_pkrtz_f16_f32 v139, v122, v123
v_cvt_pkrtz_f16_f32 v141, v124, v125
v_cvt_pkrtz_f16_f32 v143, v126, v127
v_mfma_f32_32x32x16_bf16 v[16:31], v[228:231], v[228:231], 0
v_cvt_pk_f16_f32 v155, v128, v129
v_cvt_pk_f16_f32 v152, v130, v131
v_cvt_pk_f16_f32 v149, v132, v133
v_cvt_pk_f16_f32 v146, v134, v135
v_mfma_f32_32x32x16_bf16 v[32:47], v[228:231], v[228:231], 0
v_pk_fma_f16 v154, v155, v155, s48
v_and_b32_e64 v137, s49, v137
v_pk_fma_f16 v151, v152, v152, s48
v_pk_fma_f16 v148, v149, v149, s48
v_mfma_f32_32x32x16_bf16 v[120:135], v[72:75], v[232:235], 0
ds_read_b128 v[228:231], v248 offset:36864
v_and_b32_e64 v139, s49, v139
v_pk_fma_f16 v145, v146, v146, s48
v_pk_mul_f16 v154, v155, v154
v_bfe_u32 v136, v137, 2, 14
v_pk_mul_f16 v151, v152, v151
v_pk_mul_f16 v148, v149, v148
v_bfe_u32 v138, v139, 2, 14
v_pk_mul_f16 v145, v146, v145
v_mfma_f32_32x32x16_bf16 v[120:135], v[76:79], v[236:239], v[120:135]
ds_read_b128 v[232:235], v245 offset:384
ds_read_b128 v[200:203], v242 offset:128
ds_read_b128 v[204:207], v243
ds_read_u16_d16 v136, v136
ds_read_u16_d16 v138, v138
v_exp_f16 v153, v154
v_lshrrev_b32 v137, 18, v137
v_exp_f16 v150, v151
v_lshrrev_b32 v139, 18, v139
v_exp_f16_e64 v147, v148
v_mfma_f32_32x32x16_bf16 v[120:135], v[80:83], v[216:219], v[120:135]
ds_read_b128 v[236:239], v248 offset:39936
ds_read_u16_d16_hi v137, v137
ds_read_u16_d16_hi v139, v139
v_and_b32 v141, s49, v141
v_exp_f16 v144, v145
v_and_b32 v143, s49, v143
v_exp_f16_sdwa v153, v154 dst_sel:WORD_1 dst_unused:UNUSED_PRESERVE src0_sel:WORD_1
v_bfe_u32 v140, v141, 2, 14
s_waitcnt lgkmcnt(8)
v_smfmac_f32_16x16x32_bf16 v[0:3], v[220:221], v[192:195], v246
ds_read_b128 v[216:219], v245 offset:768
ds_read_b128 v[208:211], v243 offset:64
ds_read_b128 v[212:215], v243 offset:128
ds_read_u16_d16 v140, v140
v_exp_f16_sdwa v150, v151 dst_sel:WORD_1 dst_unused:UNUSED_PRESERVE src0_sel:WORD_1
v_bfe_u32 v142, v143, 2, 14
v_exp_f16_sdwa v147, v148 dst_sel:WORD_1 dst_unused:UNUSED_PRESERVE src0_sel:WORD_1
v_smfmac_f32_16x16x32_bf16 v[16:19], v[222:223], v[196:199], v246
v_lshrrev_b32_e64 v141, 18, v141
v_exp_f16_sdwa v144, v145 dst_sel:WORD_1 dst_unused:UNUSED_PRESERVE src0_sel:WORD_1
v_lshrrev_b32_e64 v143, 18, v143
v_mfma_f32_32x32x16_bf16 v[120:135], v[84:87], v[224:227], v[120:135]
ds_read_b128 v[220:223], v245 offset:1152
ds_read_b128 v[192:195], v244
ds_read_b128 v[196:199], v244 offset:64
ds_read_u16_d16 v142, v142
ds_read_u16_d16_hi v141, v141
ds_read_u16_d16_hi v143, v143
v_pk_add_f16 v153, v153, 1.0 op_sel_hi:[1,0]
v_pk_add_f16 v150, v150, 1.0 op_sel_hi:[1,0]
v_pk_add_f16 v147, v147, 1.0 op_sel_hi:[1,0]
v_pk_add_f16 v144, v144, 1.0 op_sel_hi:[1,0]
v_rcp_f16 v154, v153
v_rcp_f16 v151, v150
v_mfma_f32_32x32x16_bf16 v[120:135], v[88:91], v[228:231], v[120:135]
ds_read_b128 v[224:227], v248 offset:40960
v_rcp_f16 v148, v147
v_rcp_f16 v145, v144
v_rcp_f16_sdwa v154, v153 dst_sel:WORD_1 dst_unused:UNUSED_PRESERVE src0_sel:WORD_1
v_rcp_f16_sdwa v151, v150 dst_sel:WORD_1 dst_unused:UNUSED_PRESERVE src0_sel:WORD_1
s_setprio 0
s_waitcnt lgkmcnt(7)
v_smfmac_f32_16x16x32_bf16 v[32:35], v[232:233], v[200:203], v246
ds_read_b128 v[228:231], v248 offset:44032
v_rcp_f16_sdwa v148, v147 dst_sel:WORD_1 dst_unused:UNUSED_PRESERVE src0_sel:WORD_1
v_fma_mix_f32 v158, v136, v136, v158 op_sel:[0,0,0] op_sel_hi:[1,1,0]
v_smfmac_f32_16x16x32_bf16 v[0:3], v[234:235], v[204:207], v246
v_rcp_f16_sdwa v145, v144 dst_sel:WORD_1 dst_unused:UNUSED_PRESERVE src0_sel:WORD_1
v_fma_mix_f32 v158, v137, v137, v158 op_sel:[1,1,0] op_sel_hi:[1,1,0]
v_pk_mul_f16 v155, v155, v154
v_fma_mix_f32 v158, v138, v138, v158 op_sel:[0,0,0] op_sel_hi:[1,1,0]
v_mfma_f32_32x32x16_bf16 v[120:135], v[92:95], v[236:239], v[120:135]
ds_read_b128 v[232:235], v248 offset:41984
v_pk_mul_f16 v152, v152, v151
v_pk_mul_f16 v149, v149, v148
v_fma_mix_f32 v158, v139, v139, v158 op_sel:[1,1,0] op_sel_hi:[1,1,0]
v_pk_mul_f16 v146, v146, v145
v_fma_mix_f32 v158, v155, v155, v158 op_sel:[0,0,0] op_sel_hi:[1,1,0]
v_fma_mix_f32 v158, v140, v140, v158 op_sel:[0,0,0] op_sel_hi:[1,1,0]
v_fma_mix_f32 v158, v155, v155, v158 op_sel:[1,1,0] op_sel_hi:[1,1,0]
v_fma_mix_f32 v158, v152, v152, v158 op_sel:[0,0,0] op_sel_hi:[1,1,0]
v_smfmac_f32_16x16x32_bf16 v[16:19], v[216:217], v[208:211], v246
ds_read_b128 v[236:239], v248 offset:45056
s_waitcnt lgkmcnt(3)
v_fma_mix_f32 v158, v141, v141, v158 op_sel:[1,1,0] op_sel_hi:[1,1,0]
v_fma_mix_f32 v158, v152, v152, v158 op_sel:[1,1,0] op_sel_hi:[1,1,0]
v_fma_mix_f32 v158, v149, v149, v158 op_sel:[0,0,0] op_sel_hi:[1,1,0]
v_fma_mix_f32 v158, v142, v142, v158 op_sel:[0,0,0] op_sel_hi:[1,1,0]
v_smfmac_f32_16x16x32_bf16 v[32:35], v[218:219], v[212:215], v246
v_fma_mix_f32 v158, v149, v149, v158 op_sel:[1,1,0] op_sel_hi:[1,1,0]
v_fma_mix_f32 v158, v146, v146, v158 op_sel:[0,0,0] op_sel_hi:[1,1,0]
v_fma_mix_f32 v158, v143, v143, v158 op_sel:[1,1,0] op_sel_hi:[1,1,0]
v_fma_mix_f32 v158, v146, v146, v158 op_sel:[1,1,0] op_sel_hi:[1,1,0]
s_setprio 2
v_smfmac_f32_16x16x32_bf16 v[0:3], v[220:221], v[192:195], v246
s_add_u32 s46, s80, 8388608
buffer_store_dwordx4 v[64:67], v241, s[32:35], s46 offen sc1
ds_read_b128 v[216:219], v248 offset:43008
v_cvt_pkrtz_f16_f32 v137, v120, v121
v_cvt_pkrtz_f16_f32 v139, v122, v123
v_cvt_pkrtz_f16_f32 v141, v124, v125
v_cvt_pkrtz_f16_f32 v143, v126, v127
v_smfmac_f32_16x16x32_bf16 v[16:19], v[222:223], v[196:199], v246
v_cvt_pkrtz_f16_f32 v145, v128, v129
v_cvt_pk_f16_f32 v155, v130, v131
v_cvt_pk_f16_f32 v152, v132, v133
v_cvt_pk_f16_f32 v149, v134, v135
v_mfma_f32_32x32x16_bf16 v[120:135], v[72:75], v[224:227], 0
ds_read_b128 v[220:223], v245 offset:1536
ds_read_b128 v[200:203], v244 offset:128
v_xor_b32 v242, 16, v242
ds_read_b128 v[204:207], v242
v_pk_fma_f16 v154, v155, v155, s48
v_and_b32 v137, s49, v137
v_pk_fma_f16 v151, v152, v152, s48
v_and_b32 v139, s49, v139
v_pk_fma_f16 v148, v149, v149, s48
v_pk_mul_f16 v154, v155, v154
v_bfe_u32 v136, v137, 2, 14
v_pk_mul_f16 v151, v152, v151
s_waitcnt lgkmcnt(4)
v_mfma_f32_32x32x16_bf16 v[120:135], v[76:79], v[228:231], v[120:135]
ds_read_b128 v[224:227], v248 offset:46080
ds_read_u16_d16 v136, v136
v_pk_mul_f16 v148, v149, v148
v_bfe_u32 v138, v139, 2, 14
v_exp_f16 v153, v154
v_lshrrev_b32 v137, 18, v137
v_exp_f16 v150, v151
v_lshrrev_b32 v139, 18, v139
v_mfma_f32_32x32x16_bf16 v[120:135], v[80:83], v[232:235], v[120:135]
ds_read_b128 v[228:231], v245 offset:1920
ds_read_b128 v[208:211], v242 offset:64
ds_read_b128 v[212:215], v242 offset:128
ds_read_u16_d16 v138, v138
ds_read_u16_d16_hi v137, v137
ds_read_u16_d16_hi v139, v139
v_exp_f16 v147, v148
v_and_b32 v141, s49, v141
v_and_b32 v143, s49, v143
v_exp_f16_sdwa v153, v154 dst_sel:WORD_1 dst_unused:UNUSED_PRESERVE src0_sel:WORD_1
v_bfe_u32 v140, v141, 2, 14
v_exp_f16_sdwa v150, v151 dst_sel:WORD_1 dst_unused:UNUSED_PRESERVE src0_sel:WORD_1
v_mfma_f32_32x32x16_bf16 v[120:135], v[84:87], v[236:239], v[120:135]
ds_read_b128 v[232:235], v245 offset:2304
v_xor_b32 v243, 16, v243
ds_read_b128 v[192:195], v243
ds_read_b128 v[196:199], v243 offset:64
ds_read_u16_d16 v140, v140
v_bfe_u32 v142, v143, 2, 14
v_exp_f16_sdwa v147, v148 dst_sel:WORD_1 dst_unused:UNUSED_PRESERVE src0_sel:WORD_1
v_lshrrev_b32_e64 v141, 18, v141
v_pk_add_f16 v153, v153, 1.0 op_sel_hi:[1,0]
v_lshrrev_b32 v143, 18, v143
v_pk_add_f16 v150, v150, 1.0 op_sel_hi:[1,0]
v_pk_add_f16 v147, v147, 1.0 op_sel_hi:[1,0]
s_waitcnt lgkmcnt(9)
v_mfma_f32_32x32x16_bf16 v[120:135], v[88:91], v[216:219], v[120:135]
ds_read_b128 v[236:239], v248 offset:47104
ds_read_u16_d16 v142, v142
ds_read_u16_d16_hi v141, v141
ds_read_u16_d16_hi v143, v143
v_and_b32 v145, s49, v145
v_rcp_f16 v154, v153
v_bfe_u32 v144, v145, 2, 14
v_rcp_f16 v151, v150
v_lshrrev_b32 v145, 18, v145
v_rcp_f16_e64 v148, v147
v_smfmac_f32_16x16x32_bf16 v[32:35], v[220:221], v[200:203], v246
ds_read_b128 v[216:219], v248 offset:50176
ds_read_u16_d16 v144, v144
ds_read_u16_d16_hi v145, v145
v_rcp_f16_sdwa v154, v153 dst_sel:WORD_1 dst_unused:UNUSED_PRESERVE src0_sel:WORD_1
v_fma_mix_f32 v159, v136, v136, v159 op_sel:[0,0,0] op_sel_hi:[1,1,0]
s_waitcnt lgkmcnt(7)
v_fma_mix_f32 v159, v137, v137, v159 op_sel:[1,1,0] op_sel_hi:[1,1,0]
v_smfmac_f32_16x16x32_bf16 v[4:7], v[222:223], v[204:207], v246
v_rcp_f16_sdwa v151, v150 dst_sel:WORD_1 dst_unused:UNUSED_PRESERVE src0_sel:WORD_1
v_fma_mix_f32 v159, v138, v138, v159 op_sel:[0,0,0] op_sel_hi:[1,1,0]
v_mfma_f32_32x32x16_bf16 v[120:135], v[92:95], v[224:227], v[120:135]
ds_read_b128 v[220:223], v248 offset:48128
v_rcp_f16_sdwa v148, v147 dst_sel:WORD_1 dst_unused:UNUSED_PRESERVE src0_sel:WORD_1
v_fma_mix_f32 v159, v139, v139, v159 op_sel:[1,1,0] op_sel_hi:[1,1,0]
v_pk_mul_f16 v155, v155, v154
v_fma_mix_f32 v159, v140, v140, v159 op_sel:[0,0,0] op_sel_hi:[1,1,0]
v_pk_mul_f16 v152, v152, v151
s_waitcnt lgkmcnt(4)
v_fma_mix_f32 v159, v141, v141, v159 op_sel:[1,1,0] op_sel_hi:[1,1,0]
v_pk_mul_f16 v149, v149, v148
v_fma_mix_f32 v159, v155, v155, v159 op_sel:[0,0,0] op_sel_hi:[1,1,0]
v_smfmac_f32_16x16x32_bf16 v[20:23], v[228:229], v[208:211], v246
ds_read_b128 v[224:227], v248 offset:51200
v_fma_mix_f32 v159, v142, v142, v159 op_sel:[0,0,0] op_sel_hi:[1,1,0]
v_fma_mix_f32 v159, v155, v155, v159 op_sel:[1,1,0] op_sel_hi:[1,1,0]
v_fma_mix_f32 v159, v143, v143, v159 op_sel:[1,1,0] op_sel_hi:[1,1,0]
v_fma_mix_f32 v159, v152, v152, v159 op_sel:[0,0,0] op_sel_hi:[1,1,0]
v_smfmac_f32_16x16x32_bf16 v[36:39], v[230:231], v[212:215], v246
v_fma_mix_f32 v159, v152, v152, v159 op_sel:[1,1,0] op_sel_hi:[1,1,0]
s_waitcnt lgkmcnt(2)
v_fma_mix_f32 v159, v144, v144, v159 op_sel:[0,0,0] op_sel_hi:[1,1,0]
v_fma_mix_f32 v159, v149, v149, v159 op_sel:[0,0,0] op_sel_hi:[1,1,0]
v_fma_mix_f32 v159, v145, v145, v159 op_sel:[1,1,0] op_sel_hi:[1,1,0]
v_fma_mix_f32 v159, v149, v149, v159 op_sel:[1,1,0] op_sel_hi:[1,1,0]
s_setprio 1
v_smfmac_f32_16x16x32_bf16 v[4:7], v[232:233], v[192:195], v246
s_add_u32 s46, s80, 10485760
buffer_store_dwordx4 v[68:71], v241, s[32:35], s46 offen sc1
ds_read_b128 v[228:231], v248 offset:49152
v_cvt_pkrtz_f16_f32 v137, v120, v121
v_cvt_pkrtz_f16_f32 v139, v122, v123
v_cvt_pkrtz_f16_f32 v141, v124, v125
v_cvt_pkrtz_f16_f32 v143, v126, v127
v_cvt_pk_f16_f32 v155, v128, v129
v_smfmac_f32_16x16x32_bf16 v[20:23], v[234:235], v[196:199], v246
v_cvt_pk_f16_f32 v152, v130, v131
v_cvt_pk_f16_f32 v149, v132, v133
v_cvt_pk_f16_f32 v146, v134, v135
v_pk_fma_f16 v154, v155, v155, s48
v_and_b32_e64 v137, s49, v137
v_mfma_f32_32x32x16_bf16 v[120:135], v[72:75], v[236:239], 0
ds_read_b128 v[232:235], v248 offset:52224
v_pk_fma_f16 v151, v152, v152, s48
v_pk_fma_f16 v148, v149, v149, s48
v_and_b32_e64 v139, s49, v139
v_pk_fma_f16 v145, v146, v146, s48
v_pk_mul_f16 v154, v155, v154
v_bfe_u32 v136, v137, 2, 14
v_pk_mul_f16 v151, v152, v151
v_pk_mul_f16 v148, v149, v148
v_bfe_u32 v138, v139, 2, 14
v_pk_mul_f16 v145, v146, v145
v_mfma_f32_32x32x16_bf16 v[120:135], v[76:79], v[216:219], v[120:135]
ds_read_b128 v[236:239], v245 offset:2688
ds_read_b128 v[200:203], v243 offset:128
v_xor_b32 v244, 16, v244
ds_read_b128 v[204:207], v244
ds_read_u16_d16 v136, v136
ds_read_u16_d16 v138, v138
v_exp_f16 v153, v154
v_lshrrev_b32 v137, 18, v137
v_exp_f16 v150, v151
v_lshrrev_b32 v139, 18, v139
v_exp_f16 v147, v148
v_and_b32_e64 v141, s49, v141
v_exp_f16 v144, v145
s_waitcnt lgkmcnt(5)
v_mfma_f32_32x32x16_bf16 v[120:135], v[80:83], v[220:223], v[120:135]
ds_read_b128 v[216:219], v245 offset:3072
ds_read_b128 v[208:211], v244 offset:64
ds_read_b128 v[212:215], v244 offset:128
ds_read_u16_d16_hi v137, v137
ds_read_u16_d16_hi v139, v139
v_and_b32_e64 v143, s49, v143
v_exp_f16_sdwa v153, v154 dst_sel:WORD_1 dst_unused:UNUSED_PRESERVE src0_sel:WORD_1
v_bfe_u32 v140, v141, 2, 14
v_exp_f16_sdwa v150, v151 dst_sel:WORD_1 dst_unused:UNUSED_PRESERVE src0_sel:WORD_1
v_bfe_u32 v142, v143, 2, 14
v_exp_f16_sdwa v147, v148 dst_sel:WORD_1 dst_unused:UNUSED_PRESERVE src0_sel:WORD_1
v_lshrrev_b32_e64 v141, 18, v141
v_mfma_f32_32x32x16_bf16 v[120:135], v[84:87], v[224:227], v[120:135]
ds_read_b128 v[220:223], v248 offset:53248
ds_read_u16_d16 v140, v140
ds_read_u16_d16 v142, v142
ds_read_u16_d16_hi v141, v141
v_exp_f16_sdwa v144, v145 dst_sel:WORD_1 dst_unused:UNUSED_PRESERVE src0_sel:WORD_1
v_lshrrev_b32_e64 v143, 18, v143
v_pk_add_f16 v153, v153, 1.0 op_sel_hi:[1,0]
v_pk_add_f16 v150, v150, 1.0 op_sel_hi:[1,0]
v_pk_add_f16 v147, v147, 1.0 op_sel_hi:[1,0]
v_pk_add_f16 v144, v144, 1.0 op_sel_hi:[1,0]
v_rcp_f16 v154, v153
v_rcp_f16 v151, v150
v_mfma_f32_32x32x16_bf16 v[120:135], v[88:91], v[228:231], v[120:135]
ds_read_b128 v[224:227], v248 offset:56320
ds_read_u16_d16_hi v143, v143
v_rcp_f16 v148, v147
v_rcp_f16 v145, v144
v_rcp_f16_sdwa v154, v153 dst_sel:WORD_1 dst_unused:UNUSED_PRESERVE src0_sel:WORD_1
v_rcp_f16_sdwa v151, v150 dst_sel:WORD_1 dst_unused:UNUSED_PRESERVE src0_sel:WORD_1
s_setprio 0
v_rcp_f16_sdwa v148, v147 dst_sel:WORD_1 dst_unused:UNUSED_PRESERVE src0_sel:WORD_1
s_waitcnt lgkmcnt(6)
v_fma_mix_f32 v160, v136, v136, v160 op_sel:[0,0,0] op_sel_hi:[1,1,0]
v_mfma_f32_32x32x16_bf16 v[120:135], v[92:95], v[232:235], v[120:135]
ds_read_b128 v[228:231], v248 offset:54272
v_rcp_f16_sdwa v145, v144 dst_sel:WORD_1 dst_unused:UNUSED_PRESERVE src0_sel:WORD_1
v_fma_mix_f32 v160, v137, v137, v160 op_sel:[1,1,0] op_sel_hi:[1,1,0]
v_pk_mul_f16 v155, v155, v154
v_fma_mix_f32 v160, v138, v138, v160 op_sel:[0,0,0] op_sel_hi:[1,1,0]
v_pk_mul_f16 v152, v152, v151
v_pk_mul_f16 v149, v149, v148
v_fma_mix_f32 v160, v139, v139, v160 op_sel:[1,1,0] op_sel_hi:[1,1,0]
v_pk_mul_f16 v146, v146, v145
v_fma_mix_f32 v160, v155, v155, v160 op_sel:[0,0,0] op_sel_hi:[1,1,0]
v_smfmac_f32_16x16x32_bf16 v[36:39], v[236:237], v[200:203], v246
ds_read_b128 v[232:235], v248 offset:57344
s_waitcnt lgkmcnt(4)
v_fma_mix_f32 v160, v140, v140, v160 op_sel:[0,0,0] op_sel_hi:[1,1,0]
v_fma_mix_f32 v160, v155, v155, v160 op_sel:[1,1,0] op_sel_hi:[1,1,0]
v_fma_mix_f32 v160, v152, v152, v160 op_sel:[0,0,0] op_sel_hi:[1,1,0]
v_fma_mix_f32 v160, v141, v141, v160 op_sel:[1,1,0] op_sel_hi:[1,1,0]
v_fma_mix_f32 v160, v152, v152, v160 op_sel:[1,1,0] op_sel_hi:[1,1,0]
v_smfmac_f32_16x16x32_bf16 v[4:7], v[238:239], v[204:207], v246
v_fma_mix_f32 v160, v149, v149, v160 op_sel:[0,0,0] op_sel_hi:[1,1,0]
v_fma_mix_f32 v160, v142, v142, v160 op_sel:[0,0,0] op_sel_hi:[1,1,0]
v_fma_mix_f32 v160, v149, v149, v160 op_sel:[1,1,0] op_sel_hi:[1,1,0]
v_fma_mix_f32 v160, v146, v146, v160 op_sel:[0,0,0] op_sel_hi:[1,1,0]
s_waitcnt lgkmcnt(2)
v_fma_mix_f32 v160, v143, v143, v160 op_sel:[1,1,0] op_sel_hi:[1,1,0]
v_fma_mix_f32 v160, v146, v146, v160 op_sel:[1,1,0] op_sel_hi:[1,1,0]
s_cmp_lg_u32 s40, 7
s_cbranch_scc1 Lnobias2
s_sub_u32 s43, s2, 96
s_cmp_lt_u32 s43, 96
s_cbranch_scc0 Lnobias2
s_waitcnt vmcnt(17)
v_lshlrev_b32 v178, 16, v178
v_lshlrev_b32 v179, 16, v179
v_lshlrev_b32 v180, 16, v180
v_lshlrev_b32 v181, 16, v181
v_lshlrev_b32 v182, 16, v182
v_lshlrev_b32 v183, 16, v183
v_lshlrev_b32 v184, 16, v184
v_lshlrev_b32 v185, 16, v185
v_lshlrev_b32 v186, 16, v186
v_lshlrev_b32 v187, 16, v187
v_lshlrev_b32 v188, 16, v188
v_lshlrev_b32 v189, 16, v189
v_mul_f32 v176, v178, v184
v_fmac_f32 v176, v179, v185
v_fmac_f32 v176, v180, v186
v_fmac_f32 v176, v181, v187
v_fmac_f32 v176, v182, v188
v_fmac_f32 v176, v183, v189
s_nop 1
v_add_f32_dpp v176, v176, v176 row_ror:8 row_mask:0xf bank_mask:0xf
s_nop 1
v_add_f32_dpp v176, v176, v176 row_ror:4 row_mask:0xf bank_mask:0xf
s_nop 1
v_add_f32_dpp v176, v176, v176 row_ror:2 row_mask:0xf bank_mask:0xf
s_nop 1
v_add_f32_dpp v176, v176, v176 row_ror:1 row_mask:0xf bank_mask:0xf
v_mov_b32 v177, v176
s_nop 1
v_permlane16_swap_b32 v176, v177
v_add_f32 v176, v176, v177
v_mov_b32_e64 v177, v176
s_nop 1
v_permlane32_swap_b32 v176, v177
v_add_f32 v176, v176, v177
s_lshl_b32 s44, s43, 2
s_add_u32 s44, s44, 394752
v_lshlrev_b32_e64 v191, 11, v251
s_mov_b64 exec, 0xff
buffer_store_dword v176, v191, s[32:35], s44 offen sc1
s_mov_b64 exec, -1
Lnobias2:
s_setprio 2
v_smfmac_f32_16x16x32_bf16 v[20:23], v[216:217], v[208:211], v246
ds_read_b128 v[236:239], v248 offset:55296
v_cvt_pkrtz_f16_f32 v137, v120, v121
v_cvt_pkrtz_f16_f32 v139, v122, v123
v_cvt_pkrtz_f16_f32 v141, v124, v125
v_cvt_pkrtz_f16_f32 v143, v126, v127
v_smfmac_f32_16x16x32_bf16 v[36:39], v[218:219], v[212:215], v246
v_cvt_pkrtz_f16_f32 v145, v128, v129
v_cvt_pk_f16_f32 v155, v130, v131
v_cvt_pk_f16_f32 v152, v132, v133
v_cvt_pk_f16_f32 v149, v134, v135
v_mfma_f32_32x32x16_bf16 v[120:135], v[72:75], v[220:223], 0
ds_read_b128 v[216:219], v245 offset:3456
v_xor_b32 v242, 32, v242
ds_read_b128 v[192:195], v242
ds_read_b128 v[196:199], v242 offset:64
v_pk_fma_f16 v154, v155, v155, s48
v_and_b32 v137, s49, v137
v_pk_fma_f16 v151, v152, v152, s48
v_and_b32_e64 v139, s49, v139
v_pk_fma_f16 v148, v149, v149, s48
v_pk_mul_f16 v154, v155, v154
v_bfe_u32 v136, v137, 2, 14
v_pk_mul_f16 v151, v152, v151
v_mfma_f32_32x32x16_bf16 v[120:135], v[76:79], v[224:227], v[120:135]
ds_read_b128 v[220:223], v248 offset:58368
ds_read_u16_d16 v136, v136
v_pk_mul_f16 v148, v149, v148
v_bfe_u32 v138, v139, 2, 14
v_exp_f16 v153, v154
v_lshrrev_b32 v137, 18, v137
v_exp_f16 v150, v151
v_lshrrev_b32 v139, 18, v139
s_waitcnt lgkmcnt(5)
v_mfma_f32_32x32x16_bf16 v[120:135], v[80:83], v[228:231], v[120:135]
ds_read_b128 v[224:227], v245 offset:3840
ds_read_b128 v[200:203], v242 offset:128
v_xor_b32 v243, 32, v243
ds_read_b128 v[204:207], v243
ds_read_u16_d16 v138, v138
ds_read_u16_d16_hi v137, v137
ds_read_u16_d16_hi v139, v139
v_exp_f16 v147, v148
v_and_b32 v141, s49, v141
v_and_b32_e64 v143, s49, v143
v_exp_f16_sdwa v153, v154 dst_sel:WORD_1 dst_unused:UNUSED_PRESERVE src0_sel:WORD_1
v_bfe_u32 v140, v141, 2, 14
v_exp_f16_sdwa v150, v151 dst_sel:WORD_1 dst_unused:UNUSED_PRESERVE src0_sel:WORD_1
v_mfma_f32_32x32x16_bf16 v[120:135], v[84:87], v[232:235], v[120:135]
ds_read_b128 v[228:231], v245 offset:4224
ds_read_b128 v[208:211], v243 offset:64
ds_read_b128 v[212:215], v243 offset:128
ds_read_u16_d16 v140, v140
v_bfe_u32 v142, v143, 2, 14
v_exp_f16_sdwa v147, v148 dst_sel:WORD_1 dst_unused:UNUSED_PRESERVE src0_sel:WORD_1
v_lshrrev_b32_e64 v141, 18, v141
v_pk_add_f16 v153, v153, 1.0 op_sel_hi:[1,0]
v_lshrrev_b32_e64 v143, 18, v143
v_pk_add_f16 v150, v150, 1.0 op_sel_hi:[1,0]
v_pk_add_f16 v147, v147, 1.0 op_sel_hi:[1,0]
v_mfma_f32_32x32x16_bf16 v[120:135], v[88:91], v[236:239], v[120:135]
ds_read_b128 v[232:235], v248 offset:59392
ds_read_u16_d16 v142, v142
ds_read_u16_d16_hi v141, v141
ds_read_u16_d16_hi v143, v143
v_and_b32 v145, s49, v145
v_rcp_f16 v154, v153
v_bfe_u32 v144, v145, 2, 14
v_rcp_f16 v151, v150
v_lshrrev_b32 v145, 18, v145
v_rcp_f16 v148, v147
s_waitcnt lgkmcnt(8)
v_smfmac_f32_16x16x32_bf16 v[12:15], v[216:217], v[192:195], v246
ds_read_b128 v[236:239], v248 offset:62464
ds_read_u16_d16 v144, v144
ds_read_u16_d16_hi v145, v145
v_rcp_f16_sdwa v154, v153 dst_sel:WORD_1 dst_unused:UNUSED_PRESERVE src0_sel:WORD_1
v_fma_mix_f32 v161, v136, v136, v161 op_sel:[0,0,0] op_sel_hi:[1,1,0]
v_fma_mix_f32 v161, v137, v137, v161 op_sel:[1,1,0] op_sel_hi:[1,1,0]
v_smfmac_f32_16x16x32_bf16 v[28:31], v[218:219], v[196:199], v246
v_rcp_f16_sdwa v151, v150 dst_sel:WORD_1 dst_unused:UNUSED_PRESERVE src0_sel:WORD_1
v_fma_mix_f32 v161, v138, v138, v161 op_sel:[0,0,0] op_sel_hi:[1,1,0]
v_mfma_f32_32x32x16_bf16 v[120:135], v[92:95], v[220:223], v[120:135]
ds_read_b128 v[216:219], v248 offset:60416
v_rcp_f16_sdwa v148, v147 dst_sel:WORD_1 dst_unused:UNUSED_PRESERVE src0_sel:WORD_1
v_fma_mix_f32 v161, v139, v139, v161 op_sel:[1,1,0] op_sel_hi:[1,1,0]
v_pk_mul_f16 v155, v155, v154
s_waitcnt lgkmcnt(6)
v_fma_mix_f32 v161, v140, v140, v161 op_sel:[0,0,0] op_sel_hi:[1,1,0]
v_pk_mul_f16 v152, v152, v151
s_waitcnt lgkmcnt(4)
v_fma_mix_f32 v161, v141, v141, v161 op_sel:[1,1,0] op_sel_hi:[1,1,0]
v_pk_mul_f16 v149, v149, v148
v_fma_mix_f32 v161, v155, v155, v161 op_sel:[0,0,0] op_sel_hi:[1,1,0]
v_smfmac_f32_16x16x32_bf16 v[44:47], v[224:225], v[200:203], v246
ds_read_b128 v[220:223], v248 offset:63488
v_fma_mix_f32 v161, v142, v142, v161 op_sel:[0,0,0] op_sel_hi:[1,1,0]
v_fma_mix_f32 v161, v155, v155, v161 op_sel:[1,1,0] op_sel_hi:[1,1,0]
v_fma_mix_f32 v161, v143, v143, v161 op_sel:[1,1,0] op_sel_hi:[1,1,0]
v_fma_mix_f32 v161, v152, v152, v161 op_sel:[0,0,0] op_sel_hi:[1,1,0]
v_smfmac_f32_16x16x32_bf16 v[12:15], v[226:227], v[204:207], v246
v_fma_mix_f32 v161, v152, v152, v161 op_sel:[1,1,0] op_sel_hi:[1,1,0]
s_waitcnt lgkmcnt(2)
v_fma_mix_f32 v161, v144, v144, v161 op_sel:[0,0,0] op_sel_hi:[1,1,0]
v_fma_mix_f32 v161, v149, v149, v161 op_sel:[0,0,0] op_sel_hi:[1,1,0]
v_fma_mix_f32 v161, v145, v145, v161 op_sel:[1,1,0] op_sel_hi:[1,1,0]
v_fma_mix_f32 v161, v149, v149, v161 op_sel:[1,1,0] op_sel_hi:[1,1,0]
v_lshlrev_b32 v252, 7, v251
s_add_u32 s46, s47, 2359296
s_mov_b32 exec_lo, 131071
s_mov_b32 exec_hi, 0
s_mov_b32 m0, 16288
s_nop 0
buffer_load_dword v252, s[4:7], s46 offen lds
s_mov_b64 exec, -1
s_setprio 1
v_smfmac_f32_16x16x32_bf16 v[28:31], v[228:229], v[208:211], v246
ds_read_b128 v[224:227], v248 offset:61440
v_cvt_pkrtz_f16_f32 v137, v120, v121
v_cvt_pkrtz_f16_f32 v139, v122, v123
v_cvt_pkrtz_f16_f32 v141, v124, v125
v_cvt_pkrtz_f16_f32 v143, v126, v127
v_cvt_pk_f16_f32 v155, v128, v129
v_smfmac_f32_16x16x32_bf16 v[44:47], v[230:231], v[212:215], v246
v_cvt_pk_f16_f32 v152, v130, v131
v_cvt_pk_f16_f32 v149, v132, v133
v_cvt_pk_f16_f32 v146, v134, v135
v_pk_fma_f16 v154, v155, v155, s48
v_and_b32_e64 v137, s49, v137
v_mfma_f32_32x32x16_bf16 v[120:135], v[72:75], v[232:235], 0
ds_read_b128 v[228:231], v248 offset:64512
v_pk_fma_f16 v151, v152, v152, s48
v_pk_fma_f16 v148, v149, v149, s48
v_and_b32_e64 v139, s49, v139
v_pk_fma_f16 v145, v146, v146, s48
v_pk_mul_f16 v154, v155, v154
v_bfe_u32 v136, v137, 2, 14
v_pk_mul_f16 v151, v152, v151
v_pk_mul_f16 v148, v149, v148
v_bfe_u32 v138, v139, 2, 14
v_pk_mul_f16 v145, v146, v145
v_mfma_f32_32x32x16_bf16 v[120:135], v[76:79], v[236:239], v[120:135]
ds_read_b128 v[232:235], v245 offset:4608
v_xor_b32 v244, 32, v244
ds_read_b128 v[192:195], v244
ds_read_b128 v[196:199], v244 offset:64
ds_read_u16_d16 v136, v136
ds_read_u16_d16 v138, v138
v_exp_f16 v153, v154
v_lshrrev_b32 v137, 18, v137
v_exp_f16 v150, v151
v_lshrrev_b32 v139, 18, v139
v_exp_f16 v147, v148
v_and_b32 v141, s49, v141
v_exp_f16 v144, v145
s_waitcnt lgkmcnt(5)
v_mfma_f32_32x32x16_bf16 v[120:135], v[80:83], v[216:219], v[120:135]
ds_read_b128 v[236:239], v245 offset:4992
ds_read_b128 v[200:203], v244 offset:128
v_xor_b32 v242, 16, v242
ds_read_b128 v[204:207], v242
ds_read_u16_d16_hi v137, v137
ds_read_u16_d16_hi v139, v139
v_and_b32_e64 v143, s49, v143
v_exp_f16_sdwa v153, v154 dst_sel:WORD_1 dst_unused:UNUSED_PRESERVE src0_sel:WORD_1
v_bfe_u32 v140, v141, 2, 14
v_exp_f16_sdwa v150, v151 dst_sel:WORD_1 dst_unused:UNUSED_PRESERVE src0_sel:WORD_1
v_bfe_u32 v142, v143, 2, 14
v_exp_f16_sdwa v147, v148 dst_sel:WORD_1 dst_unused:UNUSED_PRESERVE src0_sel:WORD_1
v_lshrrev_b32_e64 v141, 18, v141
v_mfma_f32_32x32x16_bf16 v[120:135], v[84:87], v[220:223], v[120:135]
ds_read_b128 v[216:219], v249
ds_read_u16_d16 v140, v140
ds_read_u16_d16 v142, v142
ds_read_u16_d16_hi v141, v141
v_exp_f16_sdwa v144, v145 dst_sel:WORD_1 dst_unused:UNUSED_PRESERVE src0_sel:WORD_1
v_lshrrev_b32_e64 v143, 18, v143
v_pk_add_f16 v153, v153, 1.0 op_sel_hi:[1,0]
v_pk_add_f16 v150, v150, 1.0 op_sel_hi:[1,0]
v_pk_add_f16 v147, v147, 1.0 op_sel_hi:[1,0]
v_pk_add_f16 v144, v144, 1.0 op_sel_hi:[1,0]
v_rcp_f16 v154, v153
v_rcp_f16 v151, v150
v_mfma_f32_32x32x16_bf16 v[120:135], v[88:91], v[224:227], v[120:135]
ds_read_b128 v[220:223], v249 offset:3072
ds_read_u16_d16_hi v143, v143
v_rcp_f16 v148, v147
v_rcp_f16 v145, v144
v_rcp_f16_sdwa v154, v153 dst_sel:WORD_1 dst_unused:UNUSED_PRESERVE src0_sel:WORD_1
v_rcp_f16_sdwa v151, v150 dst_sel:WORD_1 dst_unused:UNUSED_PRESERVE src0_sel:WORD_1
s_setprio 0
v_rcp_f16_sdwa v148, v147 dst_sel:WORD_1 dst_unused:UNUSED_PRESERVE src0_sel:WORD_1
s_waitcnt lgkmcnt(6)
v_fma_mix_f32 v162, v136, v136, v162 op_sel:[0,0,0] op_sel_hi:[1,1,0]
v_mfma_f32_32x32x16_bf16 v[120:135], v[92:95], v[228:231], v[120:135]
ds_read_b128 v[224:227], v249 offset:1024
v_rcp_f16_sdwa v145, v144 dst_sel:WORD_1 dst_unused:UNUSED_PRESERVE src0_sel:WORD_1
v_fma_mix_f32 v162, v137, v137, v162 op_sel:[1,1,0] op_sel_hi:[1,1,0]
v_pk_mul_f16 v155, v155, v154
v_fma_mix_f32 v162, v138, v138, v162 op_sel:[0,0,0] op_sel_hi:[1,1,0]
v_pk_mul_f16 v152, v152, v151
v_pk_mul_f16 v149, v149, v148
v_fma_mix_f32 v162, v139, v139, v162 op_sel:[1,1,0] op_sel_hi:[1,1,0]
v_pk_mul_f16 v146, v146, v145
v_fma_mix_f32 v162, v155, v155, v162 op_sel:[0,0,0] op_sel_hi:[1,1,0]
v_smfmac_f32_16x16x32_bf16 v[12:15], v[232:233], v[192:195], v246
ds_read_b128 v[228:231], v249 offset:4096
s_waitcnt lgkmcnt(4)
v_fma_mix_f32 v162, v140, v140, v162 op_sel:[0,0,0] op_sel_hi:[1,1,0]
v_fma_mix_f32 v162, v155, v155, v162 op_sel:[1,1,0] op_sel_hi:[1,1,0]
v_fma_mix_f32 v162, v152, v152, v162 op_sel:[0,0,0] op_sel_hi:[1,1,0]
v_fma_mix_f32 v162, v141, v141, v162 op_sel:[1,1,0] op_sel_hi:[1,1,0]
v_fma_mix_f32 v162, v152, v152, v162 op_sel:[1,1,0] op_sel_hi:[1,1,0]
v_smfmac_f32_16x16x32_bf16 v[28:31], v[234:235], v[196:199], v246
v_fma_mix_f32 v162, v149, v149, v162 op_sel:[0,0,0] op_sel_hi:[1,1,0]
v_fma_mix_f32 v162, v142, v142, v162 op_sel:[0,0,0] op_sel_hi:[1,1,0]
v_fma_mix_f32 v162, v149, v149, v162 op_sel:[1,1,0] op_sel_hi:[1,1,0]
v_fma_mix_f32 v162, v146, v146, v162 op_sel:[0,0,0] op_sel_hi:[1,1,0]
s_waitcnt lgkmcnt(2)
v_fma_mix_f32 v162, v143, v143, v162 op_sel:[1,1,0] op_sel_hi:[1,1,0]
v_fma_mix_f32 v162, v146, v146, v162 op_sel:[1,1,0] op_sel_hi:[1,1,0]
v_lshlrev_b32_e64 v252, 7, v251
s_add_u32 s46, s47, 2359296
s_mov_b32 exec_lo, 4294836224
s_mov_b32 exec_hi, 3
s_mov_b32 m0, 16220
s_nop 0
buffer_load_dword v252, s[4:7], s46 offen lds
s_mov_b64 exec, -1
s_setprio 2
v_smfmac_f32_16x16x32_bf16 v[44:47], v[236:237], v[200:203], v246
ds_read_b128 v[232:235], v249 offset:2048
v_cvt_pkrtz_f16_f32 v137, v120, v121
v_cvt_pkrtz_f16_f32 v139, v122, v123
v_cvt_pkrtz_f16_f32 v141, v124, v125
v_cvt_pkrtz_f16_f32 v143, v126, v127
v_smfmac_f32_16x16x32_bf16 v[8:11], v[238:239], v[204:207], v246
v_cvt_pkrtz_f16_f32 v145, v128, v129
v_cvt_pk_f16_f32 v155, v130, v131
v_cvt_pk_f16_f32 v152, v132, v133
v_cvt_pk_f16_f32 v149, v134, v135
v_mfma_f32_32x32x16_bf16 v[120:135], v[72:75], v[216:219], 0
ds_read_b128 v[236:239], v245 offset:5376
ds_read_b128 v[208:211], v242 offset:64
ds_read_b128 v[212:215], v242 offset:128
v_pk_fma_f16 v154, v155, v155, s48
v_and_b32_e64 v137, s49, v137
v_pk_fma_f16 v151, v152, v152, s48
v_and_b32_e64 v139, s49, v139
v_pk_fma_f16 v148, v149, v149, s48
v_pk_mul_f16 v154, v155, v154
v_bfe_u32 v136, v137, 2, 14
v_pk_mul_f16 v151, v152, v151
v_mfma_f32_32x32x16_bf16 v[120:135], v[76:79], v[220:223], v[120:135]
ds_read_b128 v[216:219], v249 offset:5120
ds_read_u16_d16 v136, v136
v_pk_mul_f16 v148, v149, v148
v_bfe_u32 v138, v139, 2, 14
v_exp_f16 v153, v154
v_lshrrev_b32 v137, 18, v137
v_exp_f16 v150, v151
v_lshrrev_b32 v139, 18, v139
s_waitcnt lgkmcnt(5)
v_mfma_f32_32x32x16_bf16 v[120:135], v[80:83], v[224:227], v[120:135]
ds_read_b128 v[220:223], v245 offset:5760
v_xor_b32 v243, 16, v243
ds_read_b128 v[192:195], v243
ds_read_b128 v[196:199], v243 offset:64
ds_read_u16_d16 v138, v138
ds_read_u16_d16_hi v137, v137
ds_read_u16_d16_hi v139, v139
v_exp_f16 v147, v148
v_and_b32 v141, s49, v141
v_and_b32_e64 v143, s49, v143
v_exp_f16_sdwa v153, v154 dst_sel:WORD_1 dst_unused:UNUSED_PRESERVE src0_sel:WORD_1
v_bfe_u32 v140, v141, 2, 14
v_exp_f16_sdwa v150, v151 dst_sel:WORD_1 dst_unused:UNUSED_PRESERVE src0_sel:WORD_1
v_mfma_f32_32x32x16_bf16 v[120:135], v[84:87], v[228:231], v[120:135]
ds_read_b128 v[224:227], v245 offset:6144
ds_read_b128 v[200:203], v243 offset:128
v_xor_b32 v244, 16, v244
ds_read_b128 v[204:207], v244
ds_read_u16_d16 v140, v140
v_bfe_u32 v142, v143, 2, 14
v_exp_f16_sdwa v147, v148 dst_sel:WORD_1 dst_unused:UNUSED_PRESERVE src0_sel:WORD_1
v_lshrrev_b32 v141, 18, v141
v_pk_add_f16 v153, v153, 1.0 op_sel_hi:[1,0]
v_lshrrev_b32_e64 v143, 18, v143
v_pk_add_f16 v150, v150, 1.0 op_sel_hi:[1,0]
v_pk_add_f16 v147, v147, 1.0 op_sel_hi:[1,0]
v_mfma_f32_32x32x16_bf16 v[120:135], v[88:91], v[232:235], v[120:135]
ds_read_b128 v[228:231], v249 offset:6144
ds_read_u16_d16 v142, v142
ds_read_u16_d16_hi v141, v141
ds_read_u16_d16_hi v143, v143
v_and_b32 v145, s49, v145
v_rcp_f16 v154, v153
v_bfe_u32 v144, v145, 2, 14
v_rcp_f16 v151, v150
v_lshrrev_b32 v145, 18, v145
v_rcp_f16 v148, v147
s_waitcnt lgkmcnt(8)
v_smfmac_f32_16x16x32_bf16 v[24:27], v[236:237], v[208:211], v246
ds_read_b128 v[232:235], v249 offset:9216
ds_read_u16_d16 v144, v144
ds_read_u16_d16_hi v145, v145
v_rcp_f16_sdwa v154, v153 dst_sel:WORD_1 dst_unused:UNUSED_PRESERVE src0_sel:WORD_1
v_fma_mix_f32 v163, v136, v136, v163 op_sel:[0,0,0] op_sel_hi:[1,1,0]
v_fma_mix_f32 v163, v137, v137, v163 op_sel:[1,1,0] op_sel_hi:[1,1,0]
v_smfmac_f32_16x16x32_bf16 v[40:43], v[238:239], v[212:215], v246
v_rcp_f16_sdwa v151, v150 dst_sel:WORD_1 dst_unused:UNUSED_PRESERVE src0_sel:WORD_1
v_fma_mix_f32 v163, v138, v138, v163 op_sel:[0,0,0] op_sel_hi:[1,1,0]
v_mfma_f32_32x32x16_bf16 v[120:135], v[92:95], v[216:219], v[120:135]
ds_read_b128 v[236:239], v249 offset:7168
v_rcp_f16_sdwa v148, v147 dst_sel:WORD_1 dst_unused:UNUSED_PRESERVE src0_sel:WORD_1
v_fma_mix_f32 v163, v139, v139, v163 op_sel:[1,1,0] op_sel_hi:[1,1,0]
v_pk_mul_f16 v155, v155, v154
s_waitcnt lgkmcnt(6)
v_fma_mix_f32 v163, v140, v140, v163 op_sel:[0,0,0] op_sel_hi:[1,1,0]
v_pk_mul_f16 v152, v152, v151
s_waitcnt lgkmcnt(4)
v_fma_mix_f32 v163, v141, v141, v163 op_sel:[1,1,0] op_sel_hi:[1,1,0]
v_pk_mul_f16 v149, v149, v148
v_fma_mix_f32 v163, v155, v155, v163 op_sel:[0,0,0] op_sel_hi:[1,1,0]
v_smfmac_f32_16x16x32_bf16 v[8:11], v[220:221], v[192:195], v246
ds_read_b128 v[216:219], v249 offset:10240
v_fma_mix_f32 v163, v142, v142, v163 op_sel:[0,0,0] op_sel_hi:[1,1,0]
v_fma_mix_f32 v163, v155, v155, v163 op_sel:[1,1,0] op_sel_hi:[1,1,0]
v_fma_mix_f32 v163, v143, v143, v163 op_sel:[1,1,0] op_sel_hi:[1,1,0]
v_fma_mix_f32 v163, v152, v152, v163 op_sel:[0,0,0] op_sel_hi:[1,1,0]
v_smfmac_f32_16x16x32_bf16 v[24:27], v[222:223], v[196:199], v246
v_fma_mix_f32 v163, v152, v152, v163 op_sel:[1,1,0] op_sel_hi:[1,1,0]
s_waitcnt lgkmcnt(2)
v_fma_mix_f32 v163, v144, v144, v163 op_sel:[0,0,0] op_sel_hi:[1,1,0]
v_fma_mix_f32 v163, v149, v149, v163 op_sel:[0,0,0] op_sel_hi:[1,1,0]
v_fma_mix_f32 v163, v145, v145, v163 op_sel:[1,1,0] op_sel_hi:[1,1,0]
v_fma_mix_f32 v163, v149, v149, v163 op_sel:[1,1,0] op_sel_hi:[1,1,0]
v_lshlrev_b32 v252, 7, v251
s_add_u32 s46, s47, 2359296
s_mov_b32 exec_lo, 0
s_mov_b32 exec_hi, 1048572
s_mov_b32 m0, 16152
s_nop 0
buffer_load_dword v252, s[4:7], s46 offen lds
s_mov_b64 exec, -1
s_setprio 1
v_smfmac_f32_16x16x32_bf16 v[40:43], v[224:225], v[200:203], v246
ds_read_b128 v[220:223], v249 offset:8192
v_cvt_pkrtz_f16_f32 v137, v120, v121
v_cvt_pkrtz_f16_f32 v139, v122, v123
v_cvt_pkrtz_f16_f32 v141, v124, v125
v_cvt_pkrtz_f16_f32 v143, v126, v127
v_smfmac_f32_16x16x32_bf16 v[8:11], v[226:227], v[204:207], v246
v_cvt_pk_f16_f32 v155, v128, v129
v_cvt_pk_f16_f32 v152, v130, v131
v_cvt_pk_f16_f32 v149, v132, v133
v_cvt_pk_f16_f32 v146, v134, v135
v_pk_fma_f16 v154, v155, v155, s48
v_mfma_f32_32x32x16_bf16 v[120:135], v[72:75], v[228:231], 0
ds_read_b128 v[224:227], v249 offset:11264
v_and_b32_e64 v137, s49, v137
v_pk_fma_f16 v151, v152, v152, s48
v_pk_fma_f16 v148, v149, v149, s48
v_and_b32_e64 v139, s49, v139
v_pk_fma_f16 v145, v146, v146, s48
v_pk_mul_f16 v154, v155, v154
v_bfe_u32 v136, v137, 2, 14
v_pk_mul_f16 v151, v152, v151
v_pk_mul_f16 v148, v149, v148
v_bfe_u32 v138, v139, 2, 14
v_mfma_f32_32x32x16_bf16 v[120:135], v[76:79], v[232:235], v[120:135]
ds_read_b128 v[228:231], v245 offset:6528
ds_read_b128 v[208:211], v244 offset:64
ds_read_b128 v[212:215], v244 offset:128
ds_read_u16_d16 v136, v136
ds_read_u16_d16 v138, v138
v_pk_mul_f16 v145, v146, v145
v_exp_f16 v153, v154
v_lshrrev_b32 v137, 18, v137
v_exp_f16 v150, v151
v_lshrrev_b32 v139, 18, v139
v_exp_f16 v147, v148
s_waitcnt lgkmcnt(6)
v_mfma_f32_32x32x16_bf16 v[120:135], v[80:83], v[236:239], v[120:135]
ds_read_b128 v[232:235], v249 offset:12288
ds_read_u16_d16_hi v137, v137
ds_read_u16_d16_hi v139, v139
v_and_b32 v141, s49, v141
v_exp_f16 v144, v145
v_and_b32_e64 v143, s49, v143
v_exp_f16_sdwa v153, v154 dst_sel:WORD_1 dst_unused:UNUSED_PRESERVE src0_sel:WORD_1
v_bfe_u32 v140, v141, 2, 14
v_exp_f16_sdwa v150, v151 dst_sel:WORD_1 dst_unused:UNUSED_PRESERVE src0_sel:WORD_1
v_bfe_u32 v142, v143, 2, 14
v_mfma_f32_32x32x16_bf16 v[120:135], v[84:87], v[216:219], v[120:135]
ds_read_b128 v[236:239], v249 offset:15360
ds_read_u16_d16 v140, v140
ds_read_u16_d16 v142, v142
v_exp_f16_sdwa v147, v148 dst_sel:WORD_1 dst_unused:UNUSED_PRESERVE src0_sel:WORD_1
v_lshrrev_b32_e64 v141, 18, v141
v_exp_f16_sdwa v144, v145 dst_sel:WORD_1 dst_unused:UNUSED_PRESERVE src0_sel:WORD_1
v_lshrrev_b32_e64 v143, 18, v143
v_pk_add_f16 v153, v153, 1.0 op_sel_hi:[1,0]
v_pk_add_f16 v150, v150, 1.0 op_sel_hi:[1,0]
v_pk_add_f16 v147, v147, 1.0 op_sel_hi:[1,0]
v_mfma_f32_32x32x16_bf16 v[120:135], v[88:91], v[220:223], v[120:135]
ds_read_b128 v[216:219], v249 offset:13312
ds_read_u16_d16_hi v141, v141
ds_read_u16_d16_hi v143, v143
v_pk_add_f16 v144, v144, 1.0 op_sel_hi:[1,0]
v_rcp_f16 v154, v153
v_rcp_f16 v151, v150
v_rcp_f16 v148, v147
v_rcp_f16 v145, v144
s_waitcnt lgkmcnt(6)
v_mfma_f32_32x32x16_bf16 v[120:135], v[92:95], v[224:227], v[120:135]
ds_read_b128 v[220:223], v249 offset:16384
v_rcp_f16_sdwa v154, v153 dst_sel:WORD_1 dst_unused:UNUSED_PRESERVE src0_sel:WORD_1
v_rcp_f16_sdwa v151, v150 dst_sel:WORD_1 dst_unused:UNUSED_PRESERVE src0_sel:WORD_1
s_setprio 0
v_rcp_f16_sdwa v148, v147 dst_sel:WORD_1 dst_unused:UNUSED_PRESERVE src0_sel:WORD_1
v_fma_mix_f32 v164, v136, v136, v164 op_sel:[0,0,0] op_sel_hi:[1,1,0]
v_rcp_f16_sdwa v145, v144 dst_sel:WORD_1 dst_unused:UNUSED_PRESERVE src0_sel:WORD_1
v_fma_mix_f32 v164, v137, v137, v164 op_sel:[1,1,0] op_sel_hi:[1,1,0]
v_smfmac_f32_16x16x32_bf16 v[24:27], v[228:229], v[208:211], v246
ds_read_b128 v[224:227], v249 offset:14336
v_pk_mul_f16 v155, v155, v154
v_fma_mix_f32 v164, v138, v138, v164 op_sel:[0,0,0] op_sel_hi:[1,1,0]
v_pk_mul_f16 v152, v152, v151
v_pk_mul_f16 v149, v149, v148
v_fma_mix_f32 v164, v139, v139, v164 op_sel:[1,1,0] op_sel_hi:[1,1,0]
v_smfmac_f32_16x16x32_bf16 v[40:43], v[230:231], v[212:215], v246
s_mov_b64 exec, 1
ds_add_u32 v253, v254 offset:16
s_mov_b64 exec, -1
v_pk_mul_f16 v146, v146, v145
v_fma_mix_f32 v164, v155, v155, v164 op_sel:[0,0,0] op_sel_hi:[1,1,0]
s_waitcnt lgkmcnt(3)
v_fma_mix_f32 v164, v140, v140, v164 op_sel:[0,0,0] op_sel_hi:[1,1,0]
v_fma_mix_f32 v164, v155, v155, v164 op_sel:[1,1,0] op_sel_hi:[1,1,0]
v_fma_mix_f32 v164, v152, v152, v164 op_sel:[0,0,0] op_sel_hi:[1,1,0]
v_fma_mix_f32 v164, v141, v141, v164 op_sel:[1,1,0] op_sel_hi:[1,1,0]
v_fma_mix_f32 v164, v152, v152, v164 op_sel:[1,1,0] op_sel_hi:[1,1,0]
v_fma_mix_f32 v164, v149, v149, v164 op_sel:[0,0,0] op_sel_hi:[1,1,0]
v_fma_mix_f32 v164, v142, v142, v164 op_sel:[0,0,0] op_sel_hi:[1,1,0]
v_fma_mix_f32 v164, v149, v149, v164 op_sel:[1,1,0] op_sel_hi:[1,1,0]
v_fma_mix_f32 v164, v146, v146, v164 op_sel:[0,0,0] op_sel_hi:[1,1,0]
v_fma_mix_f32 v164, v143, v143, v164 op_sel:[1,1,0] op_sel_hi:[1,1,0]
v_fma_mix_f32 v164, v146, v146, v164 op_sel:[1,1,0] op_sel_hi:[1,1,0]
s_setprio 3
v_pk_add_f32 v[168:169], v[0:1], v[2:3]
v_pk_mul_f32 v[170:171], v[0:1], v[0:1]
v_pk_fma_f32 v[170:171], v[2:3], v[2:3], v[170:171]
v_pk_add_f32 v[168:169], v[168:169], v[4:5]
v_pk_fma_f32 v[170:171], v[4:5], v[4:5], v[170:171]
v_pk_add_f32 v[168:169], v[168:169], v[6:7]
v_pk_fma_f32 v[170:171], v[6:7], v[6:7], v[170:171]
v_pk_add_f32 v[168:169], v[168:169], v[8:9]
v_pk_fma_f32 v[170:171], v[8:9], v[8:9], v[170:171]
v_pk_add_f32 v[168:169], v[168:169], v[10:11]
v_pk_fma_f32 v[170:171], v[10:11], v[10:11], v[170:171]
v_pk_add_f32 v[168:169], v[168:169], v[12:13]
v_pk_fma_f32 v[170:171], v[12:13], v[12:13], v[170:171]
v_pk_add_f32 v[168:169], v[168:169], v[14:15]
v_pk_fma_f32 v[170:171], v[14:15], v[14:15], v[170:171]
v_pk_add_f32 v[168:169], v[168:169], v[16:17]
v_pk_fma_f32 v[170:171], v[16:17], v[16:17], v[170:171]
v_pk_add_f32 v[168:169], v[168:169], v[18:19]
v_pk_fma_f32 v[170:171], v[18:19], v[18:19], v[170:171]
v_pk_add_f32 v[168:169], v[168:169], v[20:21]
v_pk_fma_f32 v[170:171], v[20:21], v[20:21], v[170:171]
v_pk_add_f32 v[168:169], v[168:169], v[22:23]
v_pk_fma_f32 v[170:171], v[22:23], v[22:23], v[170:171]
v_pk_add_f32 v[168:169], v[168:169], v[24:25]
v_pk_fma_f32 v[170:171], v[24:25], v[24:25], v[170:171]
v_pk_add_f32 v[168:169], v[168:169], v[26:27]
v_pk_fma_f32 v[170:171], v[26:27], v[26:27], v[170:171]
v_pk_add_f32 v[168:169], v[168:169], v[28:29]
v_pk_fma_f32 v[170:171], v[28:29], v[28:29], v[170:171]
v_pk_add_f32 v[168:169], v[168:169], v[30:31]
v_pk_fma_f32 v[170:171], v[30:31], v[30:31], v[170:171]
v_pk_add_f32 v[168:169], v[168:169], v[32:33]
v_pk_fma_f32 v[170:171], v[32:33], v[32:33], v[170:171]
v_pk_add_f32 v[168:169], v[168:169], v[34:35]
v_pk_fma_f32 v[170:171], v[34:35], v[34:35], v[170:171]
v_pk_add_f32 v[168:169], v[168:169], v[36:37]
v_pk_fma_f32 v[170:171], v[36:37], v[36:37], v[170:171]
v_pk_add_f32 v[168:169], v[168:169], v[38:39]
v_pk_fma_f32 v[170:171], v[38:39], v[38:39], v[170:171]
v_pk_add_f32 v[168:169], v[168:169], v[40:41]
v_pk_fma_f32 v[170:171], v[40:41], v[40:41], v[170:171]
v_pk_add_f32 v[168:169], v[168:169], v[42:43]
v_pk_fma_f32 v[170:171], v[42:43], v[42:43], v[170:171]
v_pk_add_f32 v[168:169], v[168:169], v[44:45]
v_pk_fma_f32 v[170:171], v[44:45], v[44:45], v[170:171]
v_pk_add_f32 v[168:169], v[168:169], v[46:47]
v_pk_fma_f32 v[170:171], v[46:47], v[46:47], v[170:171]
s_setprio 0
v_add_u32 v174, -36864, v242
v_subrev_u32 v175, 66560, v174
v_min_u32 v174, v174, v175
v_add_u32 v174, 90112, v174
v_sub_u32 v175, v174, v242
v_add_u32 v242, v175, v242
v_add_u32_e64 v243, v175, v243
v_add_u32 v244, v175, v244
s_setprio 2
v_cvt_pkrtz_f16_f32 v137, v120, v121
v_cvt_pkrtz_f16_f32 v139, v122, v123
v_cvt_pkrtz_f16_f32 v141, v124, v125
v_cvt_pkrtz_f16_f32 v143, v126, v127
v_cvt_pkrtz_f16_f32 v145, v128, v129
v_cvt_pk_f16_f32 v155, v130, v131
v_cvt_pk_f16_f32 v152, v132, v133
v_cvt_pk_f16_f32 v149, v134, v135
ds_read_b128 v[228:231], v249 offset:17408
v_mfma_f32_32x32x16_bf16 v[120:135], v[72:75], v[232:235], 0
v_pk_fma_f16 v154, v155, v155, s48
v_add_f32 v168, v168, v169
v_and_b32 v137, s49, v137
v_pk_fma_f16 v151, v152, v152, s48
v_and_b32_e64 v139, s49, v139
v_pk_fma_f16 v148, v149, v149, s48
v_add_f32_e64 v170, v170, v171
v_pk_mul_f16 v154, v155, v154
v_bfe_u32 v136, v137, 2, 14
v_pk_mul_f16 v151, v152, v151
v_pk_mul_f16 v148, v149, v148
v_bfe_u32 v138, v139, 2, 14
ds_read_b128 v[232:235], v249 offset:18432
ds_read_u16_d16 v136, v136
ds_read_u16_d16 v138, v138
v_mfma_f32_32x32x16_bf16 v[120:135], v[76:79], v[236:239], v[120:135]
v_permlane32_swap_b32 v168, v170
v_exp_f16 v153, v154
v_lshrrev_b32 v137, 18, v137
v_exp_f16 v150, v151
v_add_f32 v168, v168, v170
v_lshrrev_b32 v139, 18, v139
v_exp_f16 v147, v148
v_and_b32 v141, s49, v141
v_and_b32_e64 v143, s49, v143
v_mul_f32 v168, 1009429163, v168
ds_read_b128 v[236:239], v249 offset:21504
ds_read_u16_d16_hi v137, v137
ds_read_u16_d16_hi v139, v139
v_mfma_f32_32x32x16_bf16 v[120:135], v[80:83], v[216:219], v[120:135]
v_exp_f16_sdwa v153, v154 dst_sel:WORD_1 dst_unused:UNUSED_PRESERVE src0_sel:WORD_1
v_bfe_u32 v140, v141, 2, 14
v_exp_f16_sdwa v150, v151 dst_sel:WORD_1 dst_unused:UNUSED_PRESERVE src0_sel:WORD_1
v_mov_b32_e64 v170, v168
v_bfe_u32 v142, v143, 2, 14
v_exp_f16_sdwa v147, v148 dst_sel:WORD_1 dst_unused:UNUSED_PRESERVE src0_sel:WORD_1
v_lshrrev_b32_e64 v141, 18, v141
v_permlane32_swap_b32 v168, v170
v_pk_add_f16 v153, v153, 1.0 op_sel_hi:[1,0]
s_waitcnt lgkmcnt(8)
ds_read_b128 v[216:219], v249 offset:19456
ds_read_u16_d16 v140, v140
ds_read_u16_d16 v142, v142
ds_read_u16_d16_hi v141, v141
v_mfma_f32_32x32x16_bf16 v[120:135], v[84:87], v[220:223], v[120:135]
v_lshrrev_b32_e64 v143, 18, v143
v_pk_add_f16 v150, v150, 1.0 op_sel_hi:[1,0]
v_pk_add_f16 v147, v147, 1.0 op_sel_hi:[1,0]
v_and_b32_e64 v145, s49, v145
v_fma_f32 v170, -v168, v168, v170
v_rcp_f16_e64 v154, v153
v_bfe_u32 v144, v145, 2, 14
v_rcp_f16 v151, v150
v_max_f32 v170, 0, v170
v_lshrrev_b32_e64 v145, 18, v145
ds_read_b128 v[220:223], v249 offset:22528
ds_read_u16_d16_hi v143, v143
ds_read_u16_d16 v144, v144
ds_read_u16_d16_hi v145, v145
v_mfma_f32_32x32x16_bf16 v[120:135], v[88:91], v[224:227], v[120:135]
v_rcp_f16 v148, v147
v_rcp_f16_sdwa v154, v153 dst_sel:WORD_1 dst_unused:UNUSED_PRESERVE src0_sel:WORD_1
v_add_f32 v170, 925353388, v170
s_waitcnt lgkmcnt(8)
v_fma_mix_f32 v165, v136, v136, v165 op_sel:[0,0,0] op_sel_hi:[1,1,0]
ds_read_b32 v247, v253 offset:16
v_fma_mix_f32 v165, v137, v137, v165 op_sel:[1,1,0] op_sel_hi:[1,1,0]
v_rcp_f16_sdwa v151, v150 dst_sel:WORD_1 dst_unused:UNUSED_PRESERVE src0_sel:WORD_1
v_rsq_f32_e64 v170, v170
v_fma_mix_f32 v165, v138, v138, v165 op_sel:[0,0,0] op_sel_hi:[1,1,0]
ds_read_b128 v[224:227], v249 offset:20480
v_mfma_f32_32x32x16_bf16 v[120:135], v[92:95], v[228:231], v[120:135]
v_rcp_f16_sdwa v148, v147 dst_sel:WORD_1 dst_unused:UNUSED_PRESERVE src0_sel:WORD_1
v_fma_mix_f32 v165, v139, v139, v165 op_sel:[1,1,0] op_sel_hi:[1,1,0]
v_pk_mul_f16 v155, v155, v154
s_waitcnt lgkmcnt(6)
v_fma_mix_f32 v165, v140, v140, v165 op_sel:[0,0,0] op_sel_hi:[1,1,0]
v_pk_mul_f16 v152, v152, v151
v_fma_mix_f32 v165, v141, v141, v165 op_sel:[1,1,0] op_sel_hi:[1,1,0]
v_pk_mul_f16 v149, v149, v148
v_fma_mix_f32 v165, v155, v155, v165 op_sel:[0,0,0] op_sel_hi:[1,1,0]
v_mul_f32 v172, 3203391086, v170
v_fma_mix_f32 v165, v142, v142, v165 op_sel:[0,0,0] op_sel_hi:[1,1,0]
v_fma_mix_f32 v165, v155, v155, v165 op_sel:[1,1,0] op_sel_hi:[1,1,0]
s_waitcnt lgkmcnt(2)
v_fma_mix_f32 v165, v143, v143, v165 op_sel:[1,1,0] op_sel_hi:[1,1,0]
v_fma_mix_f32 v165, v152, v152, v165 op_sel:[0,0,0] op_sel_hi:[1,1,0]
v_fma_mix_f32 v165, v152, v152, v165 op_sel:[1,1,0] op_sel_hi:[1,1,0]
v_mul_f32 v173, v168, v172
v_fma_mix_f32 v165, v144, v144, v165 op_sel:[0,0,0] op_sel_hi:[1,1,0]
v_fma_mix_f32 v165, v149, v149, v165 op_sel:[0,0,0] op_sel_hi:[1,1,0]
v_fma_mix_f32 v165, v145, v145, v165 op_sel:[1,1,0] op_sel_hi:[1,1,0]
v_fma_mix_f32 v165, v149, v149, v165 op_sel:[1,1,0] op_sel_hi:[1,1,0]
s_setprio 3
v_pk_fma_f32 v[0:1], v[0:1], v[172:173], v[172:173] op_sel:[0,0,1] op_sel_hi:[1,0,1] neg_lo:[0,0,1] neg_hi:[0,0,1]
v_pk_fma_f32 v[2:3], v[2:3], v[172:173], v[172:173] op_sel:[0,0,1] op_sel_hi:[1,0,1] neg_lo:[0,0,1] neg_hi:[0,0,1]
v_pk_fma_f32 v[4:5], v[4:5], v[172:173], v[172:173] op_sel:[0,0,1] op_sel_hi:[1,0,1] neg_lo:[0,0,1] neg_hi:[0,0,1]
v_pk_fma_f32 v[6:7], v[6:7], v[172:173], v[172:173] op_sel:[0,0,1] op_sel_hi:[1,0,1] neg_lo:[0,0,1] neg_hi:[0,0,1]
v_pk_fma_f32 v[8:9], v[8:9], v[172:173], v[172:173] op_sel:[0,0,1] op_sel_hi:[1,0,1] neg_lo:[0,0,1] neg_hi:[0,0,1]
v_pk_fma_f32 v[10:11], v[10:11], v[172:173], v[172:173] op_sel:[0,0,1] op_sel_hi:[1,0,1] neg_lo:[0,0,1] neg_hi:[0,0,1]
v_pk_fma_f32 v[12:13], v[12:13], v[172:173], v[172:173] op_sel:[0,0,1] op_sel_hi:[1,0,1] neg_lo:[0,0,1] neg_hi:[0,0,1]
v_pk_fma_f32 v[14:15], v[14:15], v[172:173], v[172:173] op_sel:[0,0,1] op_sel_hi:[1,0,1] neg_lo:[0,0,1] neg_hi:[0,0,1]
v_pk_fma_f32 v[16:17], v[16:17], v[172:173], v[172:173] op_sel:[0,0,1] op_sel_hi:[1,0,1] neg_lo:[0,0,1] neg_hi:[0,0,1]
v_pk_fma_f32 v[18:19], v[18:19], v[172:173], v[172:173] op_sel:[0,0,1] op_sel_hi:[1,0,1] neg_lo:[0,0,1] neg_hi:[0,0,1]
v_pk_fma_f32 v[20:21], v[20:21], v[172:173], v[172:173] op_sel:[0,0,1] op_sel_hi:[1,0,1] neg_lo:[0,0,1] neg_hi:[0,0,1]
v_pk_fma_f32 v[22:23], v[22:23], v[172:173], v[172:173] op_sel:[0,0,1] op_sel_hi:[1,0,1] neg_lo:[0,0,1] neg_hi:[0,0,1]
v_pk_fma_f32 v[24:25], v[24:25], v[172:173], v[172:173] op_sel:[0,0,1] op_sel_hi:[1,0,1] neg_lo:[0,0,1] neg_hi:[0,0,1]
v_pk_fma_f32 v[26:27], v[26:27], v[172:173], v[172:173] op_sel:[0,0,1] op_sel_hi:[1,0,1] neg_lo:[0,0,1] neg_hi:[0,0,1]
v_pk_fma_f32 v[28:29], v[28:29], v[172:173], v[172:173] op_sel:[0,0,1] op_sel_hi:[1,0,1] neg_lo:[0,0,1] neg_hi:[0,0,1]
v_pk_fma_f32 v[30:31], v[30:31], v[172:173], v[172:173] op_sel:[0,0,1] op_sel_hi:[1,0,1] neg_lo:[0,0,1] neg_hi:[0,0,1]
v_pk_fma_f32 v[32:33], v[32:33], v[172:173], v[172:173] op_sel:[0,0,1] op_sel_hi:[1,0,1] neg_lo:[0,0,1] neg_hi:[0,0,1]
v_pk_fma_f32 v[34:35], v[34:35], v[172:173], v[172:173] op_sel:[0,0,1] op_sel_hi:[1,0,1] neg_lo:[0,0,1] neg_hi:[0,0,1]
v_pk_fma_f32 v[36:37], v[36:37], v[172:173], v[172:173] op_sel:[0,0,1] op_sel_hi:[1,0,1] neg_lo:[0,0,1] neg_hi:[0,0,1]
v_pk_fma_f32 v[38:39], v[38:39], v[172:173], v[172:173] op_sel:[0,0,1] op_sel_hi:[1,0,1] neg_lo:[0,0,1] neg_hi:[0,0,1]
v_pk_fma_f32 v[40:41], v[40:41], v[172:173], v[172:173] op_sel:[0,0,1] op_sel_hi:[1,0,1] neg_lo:[0,0,1] neg_hi:[0,0,1]
v_pk_fma_f32 v[42:43], v[42:43], v[172:173], v[172:173] op_sel:[0,0,1] op_sel_hi:[1,0,1] neg_lo:[0,0,1] neg_hi:[0,0,1]
v_pk_fma_f32 v[44:45], v[44:45], v[172:173], v[172:173] op_sel:[0,0,1] op_sel_hi:[1,0,1] neg_lo:[0,0,1] neg_hi:[0,0,1]
v_pk_fma_f32 v[46:47], v[46:47], v[172:173], v[172:173] op_sel:[0,0,1] op_sel_hi:[1,0,1] neg_lo:[0,0,1] neg_hi:[0,0,1]
s_setprio 2
s_waitcnt lgkmcnt(0)
v_readfirstlane_b32 s43, v247
s_nop 1
s_cmp_ge_u32 s43, 24
s_cbranch_scc1 Lev6
Lev6w:
s_sleep 1
ds_read_b32 v247, v253 offset:16
s_waitcnt lgkmcnt(0)
v_readfirstlane_b32 s43, v247
s_cmp_eq_u32 s76, 0
s_cbranch_scc1 Lev6
s_sub_u32 s76, s76, 1
s_cmp_lt_u32 s43, 24
s_cbranch_scc1 Lev6w
Lev6:
s_setprio 1
v_cvt_pkrtz_f16_f32 v137, v120, v121
v_cvt_pkrtz_f16_f32 v139, v122, v123
v_cvt_pkrtz_f16_f32 v141, v124, v125
v_cvt_pkrtz_f16_f32 v143, v126, v127
v_cvt_pkrtz_f16_f32 v145, v128, v129
v_cvt_pk_f16_f32 v155, v130, v131
v_cvt_pk_f16_f32 v152, v132, v133
v_cvt_pk_f16_f32 v149, v134, v135
s_add_u32 m0, s67, 39936
s_add_u32 s66, s66, 98304
buffer_load_dwordx4 v240, s[4:7], s66 offen lds
ds_read_b128 v[228:231], v249 offset:23552
v_mfma_f32_32x32x16_bf16 v[120:135], v[72:75], v[232:235], 0
v_pk_fma_f16 v154, v155, v155, s48
v_cvt_pk_bf16_f32 v96, v0, v1
v_and_b32 v137, s49, v137
v_pk_fma_f16 v151, v152, v152, s48
v_cvt_pk_bf16_f32 v97, v2, v3
v_and_b32_e64 v139, s49, v139
v_pk_fma_f16 v148, v149, v149, s48
v_pk_mul_f16 v154, v155, v154
v_cvt_pk_bf16_f32 v98, v4, v5
v_bfe_u32 v136, v137, 2, 14
v_pk_mul_f16 v151, v152, v151
v_pk_mul_f16 v148, v149, v148
v_cvt_pk_bf16_f32 v99, v6, v7
v_bfe_u32 v138, v139, 2, 14
s_add_u32 m0, s67, 46592
s_add_u32 s66, s66, 98304
buffer_load_dwordx4 v240, s[4:7], s66 offen lds
ds_read_b128 v[232:235], v248 offset:16384
ds_read_u16_d16 v136, v136
ds_read_u16_d16 v138, v138
v_mfma_f32_32x32x16_bf16 v[120:135], v[76:79], v[236:239], v[120:135]
v_exp_f16_e64 v153, v154
v_cvt_pk_bf16_f32 v100, v8, v9
v_lshrrev_b32 v137, 18, v137
v_exp_f16 v150, v151
v_cvt_pk_bf16_f32 v101, v10, v11
v_lshrrev_b32 v139, 18, v139
v_exp_f16 v147, v148
v_cvt_pk_bf16_f32 v102, v12, v13
v_and_b32 v141, s49, v141
v_and_b32 v143, s49, v143
v_cvt_pk_bf16_f32 v103, v14, v15
s_add_u32 m0, s67, 53248
s_add_u32 s66, s66, 98304
buffer_load_dwordx4 v240, s[4:7], s66 offen lds
ds_read_b128 v[236:239], v248 offset:19456
ds_read_u16_d16_hi v137, v137
ds_read_u16_d16_hi v139, v139
v_mfma_f32_32x32x16_bf16 v[120:135], v[80:83], v[216:219], v[120:135]
v_exp_f16_sdwa v153, v154 dst_sel:WORD_1 dst_unused:UNUSED_PRESERVE src0_sel:WORD_1
v_bfe_u32 v140, v141, 2, 14
v_cvt_pk_bf16_f32 v104, v16, v17
v_exp_f16_sdwa v150, v151 dst_sel:WORD_1 dst_unused:UNUSED_PRESERVE src0_sel:WORD_1
v_bfe_u32 v142, v143, 2, 14
v_cvt_pk_bf16_f32 v105, v18, v19
v_exp_f16_sdwa v147, v148 dst_sel:WORD_1 dst_unused:UNUSED_PRESERVE src0_sel:WORD_1
v_cvt_pk_bf16_f32 v106, v20, v21
v_lshrrev_b32_e64 v141, 18, v141
v_pk_add_f16 v153, v153, 1.0 op_sel_hi:[1,0]
v_lshrrev_b32 v143, 18, v143
s_add_u32 m0, s67, 59904
s_add_u32 s66, s66, 98304
buffer_load_dwordx4 v240, s[4:7], s66 offen lds
s_add_u32 m0, s67, 0
s_add_u32 s66, s66, 98304
buffer_load_dwordx4 v240, s[4:7], s66 offen lds
ds_read_b128 v[216:219], v248 offset:17408
ds_read_u16_d16 v140, v140
ds_read_u16_d16 v142, v142
ds_read_u16_d16_hi v141, v141
ds_read_u16_d16_hi v143, v143
v_mfma_f32_32x32x16_bf16 v[120:135], v[84:87], v[220:223], v[120:135]
v_cvt_pk_bf16_f32 v107, v22, v23
v_pk_add_f16 v150, v150, 1.0 op_sel_hi:[1,0]
v_pk_add_f16 v147, v147, 1.0 op_sel_hi:[1,0]
v_and_b32_e64 v145, s49, v145
v_cvt_pk_bf16_f32 v108, v24, v25
v_rcp_f16_e64 v154, v153
v_bfe_u32 v144, v145, 2, 14
v_cvt_pk_bf16_f32 v109, v26, v27
v_rcp_f16 v151, v150
v_lshrrev_b32 v145, 18, v145
v_cvt_pk_bf16_f32 v110, v28, v29
s_add_u32 m0, s67, 6656
s_add_u32 s66, s66, 98304
buffer_load_dwordx4 v240, s[4:7], s66 offen lds
ds_read_b128 v[220:223], v248 offset:20480
ds_read_u16_d16 v144, v144
ds_read_u16_d16_hi v145, v145
v_mfma_f32_32x32x16_bf16 v[120:135], v[88:91], v[224:227], v[120:135]
v_rcp_f16_e64 v148, v147
v_cvt_pk_bf16_f32 v111, v30, v31
v_rcp_f16_sdwa v154, v153 dst_sel:WORD_1 dst_unused:UNUSED_PRESERVE src0_sel:WORD_1
s_waitcnt lgkmcnt(5)
v_fma_mix_f32 v166, v136, v136, v166 op_sel:[0,0,0] op_sel_hi:[1,1,0]
v_cvt_pk_bf16_f32 v112, v32, v33
s_setprio 0
v_fma_mix_f32 v166, v137, v137, v166 op_sel:[1,1,0] op_sel_hi:[1,1,0]
v_rcp_f16_sdwa v151, v150 dst_sel:WORD_1 dst_unused:UNUSED_PRESERVE src0_sel:WORD_1
v_cvt_pk_bf16_f32 v113, v34, v35
v_fma_mix_f32 v166, v138, v138, v166 op_sel:[0,0,0] op_sel_hi:[1,1,0]
v_rcp_f16_sdwa v148, v147 dst_sel:WORD_1 dst_unused:UNUSED_PRESERVE src0_sel:WORD_1
v_cvt_pk_bf16_f32 v114, v36, v37
s_add_u32 m0, s67, 13312
s_add_u32 s66, s66, 98304
buffer_load_dwordx4 v240, s[4:7], s66 offen lds
ds_read_b128 v[224:227], v248 offset:18432
v_mfma_f32_32x32x16_bf16 v[120:135], v[92:95], v[228:231], v[120:135]
v_fma_mix_f32 v166, v139, v139, v166 op_sel:[1,1,0] op_sel_hi:[1,1,0]
v_pk_mul_f16 v155, v155, v154
v_fma_mix_f32 v166, v140, v140, v166 op_sel:[0,0,0] op_sel_hi:[1,1,0]
v_cvt_pk_bf16_f32 v115, v38, v39
v_pk_mul_f16 v152, v152, v151
s_waitcnt lgkmcnt(1)
v_fma_mix_f32 v166, v141, v141, v166 op_sel:[1,1,0] op_sel_hi:[1,1,0]
v_cvt_pk_bf16_f32 v116, v40, v41
v_pk_mul_f16 v149, v149, v148
v_fma_mix_f32 v166, v155, v155, v166 op_sel:[0,0,0] op_sel_hi:[1,1,0]
v_fma_mix_f32 v166, v142, v142, v166 op_sel:[0,0,0] op_sel_hi:[1,1,0]
v_cvt_pk_bf16_f32 v117, v42, v43
v_fma_mix_f32 v166, v155, v155, v166 op_sel:[1,1,0] op_sel_hi:[1,1,0]
v_fma_mix_f32 v166, v143, v143, v166 op_sel:[1,1,0] op_sel_hi:[1,1,0]
v_fma_mix_f32 v166, v152, v152, v166 op_sel:[0,0,0] op_sel_hi:[1,1,0]
s_add_u32 m0, s67, 19968
s_add_u32 s66, s66, 98304
buffer_load_dwordx4 v240, s[4:7], s66 offen lds
v_cvt_pk_bf16_f32 v118, v44, v45
v_fma_mix_f32 v166, v152, v152, v166 op_sel:[1,1,0] op_sel_hi:[1,1,0]
v_fma_mix_f32 v166, v144, v144, v166 op_sel:[0,0,0] op_sel_hi:[1,1,0]
v_fma_mix_f32 v166, v149, v149, v166 op_sel:[0,0,0] op_sel_hi:[1,1,0]
v_cvt_pk_bf16_f32 v119, v46, v47
v_fma_mix_f32 v166, v145, v145, v166 op_sel:[1,1,0] op_sel_hi:[1,1,0]
v_fma_mix_f32 v166, v149, v149, v166 op_sel:[1,1,0] op_sel_hi:[1,1,0]
s_setprio 2
v_cvt_pkrtz_f16_f32 v137, v120, v121
v_cvt_pkrtz_f16_f32 v139, v122, v123
v_cvt_pkrtz_f16_f32 v141, v124, v125
v_cvt_pkrtz_f16_f32 v143, v126, v127
v_cvt_pkrtz_f16_f32 v145, v128, v129
v_cvt_pk_f16_f32 v155, v130, v131
v_cvt_pk_f16_f32 v152, v132, v133
v_cvt_pk_f16_f32 v149, v134, v135
s_add_u32 s46, s80, 12582912
buffer_store_dwordx4 v[72:75], v241, s[32:35], s46 offen sc1
ds_read_b128 v[228:231], v248 offset:21504
v_mfma_f32_32x32x16_bf16 v[120:135], v[96:99], v[232:235], 0
v_pk_fma_f16 v154, v155, v155, s48
v_and_b32_e64 v137, s49, v137
v_pk_fma_f16 v151, v152, v152, s48
v_and_b32_e64 v139, s49, v139
v_pk_fma_f16 v148, v149, v149, s48
v_pk_mul_f16 v154, v155, v154
v_bfe_u32 v136, v137, 2, 14
v_pk_mul_f16 v151, v152, v151
v_pk_mul_f16 v148, v149, v148
v_bfe_u32 v138, v139, 2, 14
ds_read_b128 v[232:235], v248 offset:22528
ds_read_u16_d16 v136, v136
ds_read_u16_d16 v138, v138
v_mfma_f32_32x32x16_bf16 v[120:135], v[100:103], v[236:239], v[120:135]
v_exp_f16 v153, v154
v_lshrrev_b32 v137, 18, v137
v_exp_f16 v150, v151
v_lshrrev_b32 v139, 18, v139
v_exp_f16 v147, v148
v_and_b32 v141, s49, v141
v_and_b32_e64 v143, s49, v143
ds_read_b128 v[236:239], v248 offset:25600
ds_read_u16_d16_hi v137, v137
ds_read_u16_d16_hi v139, v139
v_mfma_f32_32x32x16_bf16 v[120:135], v[104:107], v[216:219], v[120:135]
v_exp_f16_sdwa v153, v154 dst_sel:WORD_1 dst_unused:UNUSED_PRESERVE src0_sel:WORD_1
v_bfe_u32 v140, v141, 2, 14
v_exp_f16_sdwa v150, v151 dst_sel:WORD_1 dst_unused:UNUSED_PRESERVE src0_sel:WORD_1
v_bfe_u32 v142, v143, 2, 14
v_exp_f16_sdwa v147, v148 dst_sel:WORD_1 dst_unused:UNUSED_PRESERVE src0_sel:WORD_1
v_lshrrev_b32_e64 v141, 18, v141
v_pk_add_f16 v153, v153, 1.0 op_sel_hi:[1,0]
ds_read_b128 v[216:219], v248 offset:23552
ds_read_u16_d16 v140, v140
ds_read_u16_d16 v142, v142
ds_read_u16_d16_hi v141, v141
v_mfma_f32_32x32x16_bf16 v[120:135], v[108:111], v[220:223], v[120:135]
v_lshrrev_b32_e64 v143, 18, v143
v_pk_add_f16 v150, v150, 1.0 op_sel_hi:[1,0]
v_pk_add_f16 v147, v147, 1.0 op_sel_hi:[1,0]
v_and_b32 v145, s49, v145
v_rcp_f16 v154, v153
v_bfe_u32 v144, v145, 2, 14
v_rcp_f16_e64 v151, v150
v_lshrrev_b32 v145, 18, v145
s_waitcnt lgkmcnt(7)
ds_read_b128 v[220:223], v248 offset:26624
ds_read_u16_d16_hi v143, v143
ds_read_u16_d16 v144, v144
ds_read_u16_d16_hi v145, v145
v_mfma_f32_32x32x16_bf16 v[120:135], v[112:115], v[224:227], v[120:135]
v_rcp_f16_e64 v148, v147
v_rcp_f16_sdwa v154, v153 dst_sel:WORD_1 dst_unused:UNUSED_PRESERVE src0_sel:WORD_1
v_fma_mix_f32 v167, v136, v136, v167 op_sel:[0,0,0] op_sel_hi:[1,1,0]
s_waitcnt lgkmcnt(8)
v_fma_mix_f32 v167, v137, v137, v167 op_sel:[1,1,0] op_sel_hi:[1,1,0]
v_rcp_f16_sdwa v151, v150 dst_sel:WORD_1 dst_unused:UNUSED_PRESERVE src0_sel:WORD_1
v_fma_mix_f32 v167, v138, v138, v167 op_sel:[0,0,0] op_sel_hi:[1,1,0]
ds_read_b128 v[224:227], v248 offset:24576
v_mfma_f32_32x32x16_bf16 v[120:135], v[116:119], v[228:231], v[120:135]
v_rcp_f16_sdwa v148, v147 dst_sel:WORD_1 dst_unused:UNUSED_PRESERVE src0_sel:WORD_1
v_fma_mix_f32 v167, v139, v139, v167 op_sel:[1,1,0] op_sel_hi:[1,1,0]
v_pk_mul_f16 v155, v155, v154
s_waitcnt lgkmcnt(5)
v_fma_mix_f32 v167, v140, v140, v167 op_sel:[0,0,0] op_sel_hi:[1,1,0]
v_pk_mul_f16 v152, v152, v151
v_fma_mix_f32 v167, v141, v141, v167 op_sel:[1,1,0] op_sel_hi:[1,1,0]
v_pk_mul_f16 v149, v149, v148
v_fma_mix_f32 v167, v155, v155, v167 op_sel:[0,0,0] op_sel_hi:[1,1,0]
v_fma_mix_f32 v167, v142, v142, v167 op_sel:[0,0,0] op_sel_hi:[1,1,0]
v_fma_mix_f32 v167, v155, v155, v167 op_sel:[1,1,0] op_sel_hi:[1,1,0]
s_waitcnt lgkmcnt(3)
v_fma_mix_f32 v167, v143, v143, v167 op_sel:[1,1,0] op_sel_hi:[1,1,0]
v_fma_mix_f32 v167, v152, v152, v167 op_sel:[0,0,0] op_sel_hi:[1,1,0]
v_fma_mix_f32 v167, v152, v152, v167 op_sel:[1,1,0] op_sel_hi:[1,1,0]
s_waitcnt lgkmcnt(1)
v_fma_mix_f32 v167, v144, v144, v167 op_sel:[0,0,0] op_sel_hi:[1,1,0]
v_fma_mix_f32 v167, v149, v149, v167 op_sel:[0,0,0] op_sel_hi:[1,1,0]
v_fma_mix_f32 v167, v145, v145, v167 op_sel:[1,1,0] op_sel_hi:[1,1,0]
v_fma_mix_f32 v167, v149, v149, v167 op_sel:[1,1,0] op_sel_hi:[1,1,0]
s_cmp_lg_u32 s40, 7
s_cbranch_scc1 Lnoinit
s_waitcnt vmcnt(12)
v_mov_b32_e64 v255, 1
s_mov_b64 exec, 1
buffer_atomic_add v255, v241, s[36:39], 0 offen
s_mov_b64 exec, -1
Lnoinit:
s_setprio 1
v_cvt_pkrtz_f16_f32 v137, v120, v121
v_cvt_pkrtz_f16_f32 v139, v122, v123
v_cvt_pkrtz_f16_f32 v141, v124, v125
v_cvt_pkrtz_f16_f32 v143, v126, v127
v_cvt_pkrtz_f16_f32 v145, v128, v129
v_cvt_pk_f16_f32 v155, v130, v131
v_cvt_pk_f16_f32 v152, v132, v133
v_cvt_pk_f16_f32 v149, v134, v135
s_add_u32 s46, s80, 14680064
buffer_store_dwordx4 v[76:79], v241, s[32:35], s46 offen sc1
ds_read_b128 v[228:231], v248 offset:27648
v_mfma_f32_32x32x16_bf16 v[120:135], v[96:99], v[232:235], 0
v_pk_fma_f16 v154, v155, v155, s48
v_and_b32_e64 v137, s49, v137
v_pk_fma_f16 v151, v152, v152, s48
v_and_b32_e64 v139, s49, v139
v_pk_fma_f16 v148, v149, v149, s48
v_pk_mul_f16 v154, v155, v154
v_bfe_u32 v136, v137, 2, 14
v_pk_mul_f16 v151, v152, v151
v_pk_mul_f16 v148, v149, v148
v_bfe_u32 v138, v139, 2, 14
ds_read_b128 v[232:235], v248 offset:28672
ds_read_u16_d16 v136, v136
ds_read_u16_d16 v138, v138
v_mfma_f32_32x32x16_bf16 v[120:135], v[100:103], v[236:239], v[120:135]
v_exp_f16 v153, v154
v_lshrrev_b32 v137, 18, v137
v_exp_f16 v150, v151
v_lshrrev_b32 v139, 18, v139
v_exp_f16 v147, v148
v_and_b32 v141, s49, v141
v_and_b32_e64 v143, s49, v143
ds_read_b128 v[236:239], v248 offset:31744
ds_read_u16_d16_hi v137, v137
ds_read_u16_d16_hi v139, v139
v_mfma_f32_32x32x16_bf16 v[120:135], v[104:107], v[216:219], v[120:135]
v_exp_f16_sdwa v153, v154 dst_sel:WORD_1 dst_unused:UNUSED_PRESERVE src0_sel:WORD_1
v_bfe_u32 v140, v141, 2, 14
v_exp_f16_sdwa v150, v151 dst_sel:WORD_1 dst_unused:UNUSED_PRESERVE src0_sel:WORD_1
v_bfe_u32 v142, v143, 2, 14
v_exp_f16_sdwa v147, v148 dst_sel:WORD_1 dst_unused:UNUSED_PRESERVE src0_sel:WORD_1
v_lshrrev_b32_e64 v141, 18, v141
v_pk_add_f16 v153, v153, 1.0 op_sel_hi:[1,0]
ds_read_b128 v[216:219], v248 offset:29696
ds_read_u16_d16 v140, v140
ds_read_u16_d16 v142, v142
ds_read_u16_d16_hi v141, v141
v_mfma_f32_32x32x16_bf16 v[120:135], v[108:111], v[220:223], v[120:135]
v_lshrrev_b32_e64 v143, 18, v143
v_pk_add_f16 v150, v150, 1.0 op_sel_hi:[1,0]
v_pk_add_f16 v147, v147, 1.0 op_sel_hi:[1,0]
v_and_b32 v145, s49, v145
v_rcp_f16 v154, v153
v_bfe_u32 v144, v145, 2, 14
v_rcp_f16_e64 v151, v150
v_lshrrev_b32 v145, 18, v145
s_waitcnt lgkmcnt(7)
ds_read_b128 v[220:223], v248 offset:32768
ds_read_u16_d16_hi v143, v143
ds_read_u16_d16 v144, v144
ds_read_u16_d16_hi v145, v145
v_mfma_f32_32x32x16_bf16 v[120:135], v[112:115], v[224:227], v[120:135]
v_rcp_f16_e64 v148, v147
v_rcp_f16_sdwa v154, v153 dst_sel:WORD_1 dst_unused:UNUSED_PRESERVE src0_sel:WORD_1
v_fma_mix_f32 v156, v136, v136, v156 op_sel:[0,0,0] op_sel_hi:[1,1,0]
s_setprio 0
s_waitcnt lgkmcnt(8)
v_fma_mix_f32 v156, v137, v137, v156 op_sel:[1,1,0] op_sel_hi:[1,1,0]
v_rcp_f16_sdwa v151, v150 dst_sel:WORD_1 dst_unused:UNUSED_PRESERVE src0_sel:WORD_1
v_fma_mix_f32 v156, v138, v138, v156 op_sel:[0,0,0] op_sel_hi:[1,1,0]
ds_read_b128 v[224:227], v248 offset:30720
v_mfma_f32_32x32x16_bf16 v[120:135], v[116:119], v[228:231], v[120:135]
v_rcp_f16_sdwa v148, v147 dst_sel:WORD_1 dst_unused:UNUSED_PRESERVE src0_sel:WORD_1
v_fma_mix_f32 v156, v139, v139, v156 op_sel:[1,1,0] op_sel_hi:[1,1,0]
v_pk_mul_f16 v155, v155, v154
s_cmp_eq_u32 s40, 7
s_cbranch_scc1 Lrdy24
s_waitcnt vmcnt(2)
Lrdy24:
s_mov_b64 exec, 1
ds_add_u32 v253, v254 offset:12
s_mov_b64 exec, -1
s_waitcnt lgkmcnt(6)
v_fma_mix_f32 v156, v140, v140, v156 op_sel:[0,0,0] op_sel_hi:[1,1,0]
v_pk_mul_f16 v152, v152, v151
v_fma_mix_f32 v156, v141, v141, v156 op_sel:[1,1,0] op_sel_hi:[1,1,0]
v_pk_mul_f16 v149, v149, v148
v_fma_mix_f32 v156, v155, v155, v156 op_sel:[0,0,0] op_sel_hi:[1,1,0]
v_fma_mix_f32 v156, v142, v142, v156 op_sel:[0,0,0] op_sel_hi:[1,1,0]
v_fma_mix_f32 v156, v155, v155, v156 op_sel:[1,1,0] op_sel_hi:[1,1,0]
s_waitcnt lgkmcnt(2)
v_fma_mix_f32 v156, v143, v143, v156 op_sel:[1,1,0] op_sel_hi:[1,1,0]
v_fma_mix_f32 v156, v152, v152, v156 op_sel:[0,0,0] op_sel_hi:[1,1,0]
v_fma_mix_f32 v156, v152, v152, v156 op_sel:[1,1,0] op_sel_hi:[1,1,0]
v_fma_mix_f32 v156, v144, v144, v156 op_sel:[0,0,0] op_sel_hi:[1,1,0]
v_fma_mix_f32 v156, v149, v149, v156 op_sel:[0,0,0] op_sel_hi:[1,1,0]
v_fma_mix_f32 v156, v145, v145, v156 op_sel:[1,1,0] op_sel_hi:[1,1,0]
v_fma_mix_f32 v156, v149, v149, v156 op_sel:[1,1,0] op_sel_hi:[1,1,0]
s_setprio 2
v_cvt_pkrtz_f16_f32 v137, v120, v121
v_cvt_pkrtz_f16_f32 v139, v122, v123
v_cvt_pkrtz_f16_f32 v141, v124, v125
v_cvt_pkrtz_f16_f32 v143, v126, v127
v_cvt_pkrtz_f16_f32 v145, v128, v129
v_cvt_pk_f16_f32 v155, v130, v131
v_cvt_pk_f16_f32 v152, v132, v133
v_cvt_pk_f16_f32 v149, v134, v135
s_add_u32 s46, s80, 16777216
buffer_store_dwordx4 v[80:83], v241, s[32:35], s46 offen sc1
ds_read_b128 v[228:231], v248 offset:33792
v_mfma_f32_32x32x16_bf16 v[120:135], v[96:99], v[232:235], 0
v_pk_fma_f16 v154, v155, v155, s48
v_and_b32_e64 v137, s49, v137
v_pk_fma_f16 v151, v152, v152, s48
v_and_b32_e64 v139, s49, v139
v_pk_fma_f16 v148, v149, v149, s48
v_pk_mul_f16 v154, v155, v154
v_bfe_u32 v136, v137, 2, 14
v_pk_mul_f16 v151, v152, v151
v_pk_mul_f16 v148, v149, v148
v_bfe_u32 v138, v139, 2, 14
ds_read_b128 v[232:235], v250 offset:65520
ds_read_u16_d16 v136, v136
ds_read_u16_d16 v138, v138
v_mfma_f32_32x32x16_bf16 v[120:135], v[100:103], v[236:239], v[120:135]
v_exp_f16 v153, v154
v_lshrrev_b32 v137, 18, v137
v_exp_f16 v150, v151
v_lshrrev_b32 v139, 18, v139
v_exp_f16 v147, v148
v_and_b32 v141, s49, v141
v_and_b32_e64 v143, s49, v143
ds_read_b128 v[236:239], v248 offset:34816
ds_read_u16_d16_hi v137, v137
ds_read_b32 v247, v253 offset:12
ds_read_u16_d16_hi v139, v139
v_mfma_f32_32x32x16_bf16 v[120:135], v[104:107], v[216:219], v[120:135]
v_exp_f16_sdwa v153, v154 dst_sel:WORD_1 dst_unused:UNUSED_PRESERVE src0_sel:WORD_1
v_bfe_u32 v140, v141, 2, 14
v_exp_f16_sdwa v150, v151 dst_sel:WORD_1 dst_unused:UNUSED_PRESERVE src0_sel:WORD_1
v_bfe_u32 v142, v143, 2, 14
v_exp_f16_sdwa v147, v148 dst_sel:WORD_1 dst_unused:UNUSED_PRESERVE src0_sel:WORD_1
v_lshrrev_b32_e64 v141, 18, v141
v_pk_add_f16 v153, v153, 1.0 op_sel_hi:[1,0]
ds_read_b128 v[216:219], v248 offset:37888
ds_read_u16_d16 v140, v140
ds_read_u16_d16 v142, v142
ds_read_u16_d16_hi v141, v141
v_mfma_f32_32x32x16_bf16 v[120:135], v[108:111], v[220:223], v[120:135]
v_lshrrev_b32_e64 v143, 18, v143
v_pk_add_f16 v150, v150, 1.0 op_sel_hi:[1,0]
v_pk_add_f16 v147, v147, 1.0 op_sel_hi:[1,0]
v_and_b32 v145, s49, v145
v_rcp_f16 v154, v153
v_bfe_u32 v144, v145, 2, 14
v_rcp_f16_e64 v151, v150
ds_read_u16_d16_hi v143, v143
ds_read_u16_d16 v144, v144
s_waitcnt lgkmcnt(7)
v_readfirstlane_b32 s43, v247
s_nop 1
s_cmp_ge_u32 s43, 32
s_cbranch_scc1 Lev7
Lev7w:
s_sleep 1
ds_read_b32 v247, v253 offset:12
s_waitcnt lgkmcnt(0)
v_readfirstlane_b32 s43, v247
s_cmp_eq_u32 s76, 0
s_cbranch_scc1 Lev7
s_sub_u32 s76, s76, 1
s_cmp_lt_u32 s43, 32
s_cbranch_scc1 Lev7w
Lev7:
v_lshrrev_b32 v145, 18, v145
ds_read_b128 v[220:223], v248 offset:35840
ds_read_u16_d16_hi v145, v145
v_mfma_f32_32x32x16_bf16 v[120:135], v[112:115], v[224:227], v[120:135]
v_rcp_f16 v148, v147
v_rcp_f16_sdwa v154, v153 dst_sel:WORD_1 dst_unused:UNUSED_PRESERVE src0_sel:WORD_1
v_fma_mix_f32 v157, v136, v136, v157 op_sel:[0,0,0] op_sel_hi:[1,1,0]
v_fma_mix_f32 v157, v137, v137, v157 op_sel:[1,1,0] op_sel_hi:[1,1,0]
v_rcp_f16_sdwa v151, v150 dst_sel:WORD_1 dst_unused:UNUSED_PRESERVE src0_sel:WORD_1
v_fma_mix_f32 v157, v138, v138, v157 op_sel:[0,0,0] op_sel_hi:[1,1,0]
ds_read_b128 v[224:227], v245 offset:6528
ds_read_b128 v[192:195], v244 offset:128
ds_read_b128 v[196:199], v244 offset:64
v_mfma_f32_32x32x16_bf16 v[120:135], v[116:119], v[228:231], v[120:135]
v_rcp_f16_sdwa v148, v147 dst_sel:WORD_1 dst_unused:UNUSED_PRESERVE src0_sel:WORD_1
s_waitcnt lgkmcnt(5)
v_fma_mix_f32 v157, v139, v139, v157 op_sel:[1,1,0] op_sel_hi:[1,1,0]
v_pk_mul_f16 v155, v155, v154
v_fma_mix_f32 v157, v140, v140, v157 op_sel:[0,0,0] op_sel_hi:[1,1,0]
v_pk_mul_f16 v152, v152, v151
v_fma_mix_f32 v157, v141, v141, v157 op_sel:[1,1,0] op_sel_hi:[1,1,0]
v_pk_mul_f16 v149, v149, v148
v_fma_mix_f32 v157, v155, v155, v157 op_sel:[0,0,0] op_sel_hi:[1,1,0]
v_fma_mix_f32 v157, v142, v142, v157 op_sel:[0,0,0] op_sel_hi:[1,1,0]
v_fma_mix_f32 v157, v155, v155, v157 op_sel:[1,1,0] op_sel_hi:[1,1,0]
v_fma_mix_f32 v157, v143, v143, v157 op_sel:[1,1,0] op_sel_hi:[1,1,0]
v_fma_mix_f32 v157, v152, v152, v157 op_sel:[0,0,0] op_sel_hi:[1,1,0]
v_fma_mix_f32 v157, v152, v152, v157 op_sel:[1,1,0] op_sel_hi:[1,1,0]
v_fma_mix_f32 v157, v144, v144, v157 op_sel:[0,0,0] op_sel_hi:[1,1,0]
v_fma_mix_f32 v157, v149, v149, v157 op_sel:[0,0,0] op_sel_hi:[1,1,0]
s_waitcnt lgkmcnt(3)
v_fma_mix_f32 v157, v145, v145, v157 op_sel:[1,1,0] op_sel_hi:[1,1,0]
v_fma_mix_f32 v157, v149, v149, v157 op_sel:[1,1,0] op_sel_hi:[1,1,0]
s_setprio 1
v_mfma_f32_32x32x16_bf16 v[0:15], v[232:235], v[232:235], 0
s_add_u32 s46, s80, 18874368
buffer_store_dwordx4 v[84:87], v241, s[32:35], s46 offen sc1
ds_read_b128 v[228:231], v248 offset:38912
v_cvt_pkrtz_f16_f32 v137, v120, v121
v_cvt_pkrtz_f16_f32 v139, v122, v123
v_cvt_pkrtz_f16_f32 v141, v124, v125
v_cvt_pkrtz_f16_f32 v143, v126, v127
v_mfma_f32_32x32x16_bf16 v[16:31], v[232:235], v[232:235], 0
v_cvt_pk_f16_f32 v155, v128, v129
v_cvt_pk_f16_f32 v152, v130, v131
v_cvt_pk_f16_f32 v149, v132, v133
v_cvt_pk_f16_f32 v146, v134, v135
v_mfma_f32_32x32x16_bf16 v[32:47], v[232:235], v[232:235], 0
v_pk_fma_f16 v154, v155, v155, s48
v_and_b32_e64 v137, s49, v137
v_pk_fma_f16 v151, v152, v152, s48
v_pk_fma_f16 v148, v149, v149, s48
v_mfma_f32_32x32x16_bf16 v[120:135], v[96:99], v[236:239], 0
ds_read_b128 v[232:235], v248 offset:36864
v_and_b32_e64 v139, s49, v139
v_pk_fma_f16 v145, v146, v146, s48
v_pk_mul_f16 v154, v155, v154
v_bfe_u32 v136, v137, 2, 14
v_pk_mul_f16 v151, v152, v151
v_pk_mul_f16 v148, v149, v148
v_bfe_u32 v138, v139, 2, 14
v_pk_mul_f16 v145, v146, v145
v_mfma_f32_32x32x16_bf16 v[120:135], v[100:103], v[216:219], v[120:135]
ds_read_b128 v[236:239], v245 offset:6144
ds_read_b128 v[200:203], v244
ds_read_b128 v[204:207], v243 offset:128
ds_read_u16_d16 v136, v136
ds_read_u16_d16 v138, v138
v_exp_f16 v153, v154
v_lshrrev_b32 v137, 18, v137
v_exp_f16 v150, v151
v_lshrrev_b32 v139, 18, v139
v_exp_f16_e64 v147, v148
v_mfma_f32_32x32x16_bf16 v[120:135], v[104:107], v[220:223], v[120:135]
ds_read_b128 v[216:219], v248 offset:39936
ds_read_u16_d16_hi v137, v137
ds_read_u16_d16_hi v139, v139
v_and_b32 v141, s49, v141
v_exp_f16 v144, v145
v_and_b32 v143, s49, v143
v_exp_f16_sdwa v153, v154 dst_sel:WORD_1 dst_unused:UNUSED_PRESERVE src0_sel:WORD_1
v_bfe_u32 v140, v141, 2, 14
s_waitcnt lgkmcnt(8)
v_smfmac_f32_16x16x32_bf16 v[40:43], v[226:227], v[192:195], v246
ds_read_b128 v[220:223], v245 offset:5760
ds_read_b128 v[208:211], v243 offset:64
ds_read_b128 v[212:215], v243
ds_read_u16_d16 v140, v140
v_exp_f16_sdwa v150, v151 dst_sel:WORD_1 dst_unused:UNUSED_PRESERVE src0_sel:WORD_1
v_bfe_u32 v142, v143, 2, 14
v_exp_f16_sdwa v147, v148 dst_sel:WORD_1 dst_unused:UNUSED_PRESERVE src0_sel:WORD_1
v_smfmac_f32_16x16x32_bf16 v[24:27], v[224:225], v[196:199], v246
v_lshrrev_b32_e64 v141, 18, v141
v_exp_f16_sdwa v144, v145 dst_sel:WORD_1 dst_unused:UNUSED_PRESERVE src0_sel:WORD_1
v_lshrrev_b32_e64 v143, 18, v143
v_mfma_f32_32x32x16_bf16 v[120:135], v[108:111], v[228:231], v[120:135]
ds_read_b128 v[224:227], v245 offset:5376
ds_read_b128 v[192:195], v242 offset:128
ds_read_b128 v[196:199], v242 offset:64
ds_read_u16_d16 v142, v142
ds_read_u16_d16_hi v141, v141
ds_read_u16_d16_hi v143, v143
v_pk_add_f16 v153, v153, 1.0 op_sel_hi:[1,0]
v_pk_add_f16 v150, v150, 1.0 op_sel_hi:[1,0]
v_pk_add_f16 v147, v147, 1.0 op_sel_hi:[1,0]
v_pk_add_f16 v144, v144, 1.0 op_sel_hi:[1,0]
v_rcp_f16 v154, v153
v_rcp_f16 v151, v150
v_mfma_f32_32x32x16_bf16 v[120:135], v[112:115], v[232:235], v[120:135]
ds_read_b128 v[228:231], v248 offset:40960
v_rcp_f16 v148, v147
v_rcp_f16 v145, v144
v_rcp_f16_sdwa v154, v153 dst_sel:WORD_1 dst_unused:UNUSED_PRESERVE src0_sel:WORD_1
v_rcp_f16_sdwa v151, v150 dst_sel:WORD_1 dst_unused:UNUSED_PRESERVE src0_sel:WORD_1
s_setprio 0
s_waitcnt lgkmcnt(7)
v_smfmac_f32_16x16x32_bf16 v[8:11], v[238:239], v[200:203], v246
ds_read_b128 v[232:235], v248 offset:44032
v_rcp_f16_sdwa v148, v147 dst_sel:WORD_1 dst_unused:UNUSED_PRESERVE src0_sel:WORD_1
v_fma_mix_f32 v158, v136, v136, v158 op_sel:[0,0,0] op_sel_hi:[1,1,0]
v_smfmac_f32_16x16x32_bf16 v[40:43], v[236:237], v[204:207], v246
v_rcp_f16_sdwa v145, v144 dst_sel:WORD_1 dst_unused:UNUSED_PRESERVE src0_sel:WORD_1
v_fma_mix_f32 v158, v137, v137, v158 op_sel:[1,1,0] op_sel_hi:[1,1,0]
v_pk_mul_f16 v155, v155, v154
v_fma_mix_f32 v158, v138, v138, v158 op_sel:[0,0,0] op_sel_hi:[1,1,0]
v_mfma_f32_32x32x16_bf16 v[120:135], v[116:119], v[216:219], v[120:135]
ds_read_b128 v[236:239], v248 offset:41984
v_pk_mul_f16 v152, v152, v151
v_pk_mul_f16 v149, v149, v148
v_fma_mix_f32 v158, v139, v139, v158 op_sel:[1,1,0] op_sel_hi:[1,1,0]
v_pk_mul_f16 v146, v146, v145
v_fma_mix_f32 v158, v155, v155, v158 op_sel:[0,0,0] op_sel_hi:[1,1,0]
v_fma_mix_f32 v158, v140, v140, v158 op_sel:[0,0,0] op_sel_hi:[1,1,0]
v_fma_mix_f32 v158, v155, v155, v158 op_sel:[1,1,0] op_sel_hi:[1,1,0]
v_fma_mix_f32 v158, v152, v152, v158 op_sel:[0,0,0] op_sel_hi:[1,1,0]
v_smfmac_f32_16x16x32_bf16 v[24:27], v[222:223], v[208:211], v246
ds_read_b128 v[216:219], v248 offset:45056
s_waitcnt lgkmcnt(3)
v_fma_mix_f32 v158, v141, v141, v158 op_sel:[1,1,0] op_sel_hi:[1,1,0]
v_fma_mix_f32 v158, v152, v152, v158 op_sel:[1,1,0] op_sel_hi:[1,1,0]
v_fma_mix_f32 v158, v149, v149, v158 op_sel:[0,0,0] op_sel_hi:[1,1,0]
v_fma_mix_f32 v158, v142, v142, v158 op_sel:[0,0,0] op_sel_hi:[1,1,0]
v_smfmac_f32_16x16x32_bf16 v[8:11], v[220:221], v[212:215], v246
v_fma_mix_f32 v158, v149, v149, v158 op_sel:[1,1,0] op_sel_hi:[1,1,0]
v_fma_mix_f32 v158, v146, v146, v158 op_sel:[0,0,0] op_sel_hi:[1,1,0]
v_fma_mix_f32 v158, v143, v143, v158 op_sel:[1,1,0] op_sel_hi:[1,1,0]
v_fma_mix_f32 v158, v146, v146, v158 op_sel:[1,1,0] op_sel_hi:[1,1,0]
s_setprio 2
v_smfmac_f32_16x16x32_bf16 v[40:43], v[226:227], v[192:195], v246
s_add_u32 s46, s80, 20971520
buffer_store_dwordx4 v[88:91], v241, s[32:35], s46 offen sc1
ds_read_b128 v[220:223], v248 offset:43008
v_cvt_pkrtz_f16_f32 v137, v120, v121
v_cvt_pkrtz_f16_f32 v139, v122, v123
v_cvt_pkrtz_f16_f32 v141, v124, v125
v_cvt_pkrtz_f16_f32 v143, v126, v127
v_smfmac_f32_16x16x32_bf16 v[24:27], v[224:225], v[196:199], v246
v_cvt_pkrtz_f16_f32 v145, v128, v129
v_cvt_pk_f16_f32 v155, v130, v131
v_cvt_pk_f16_f32 v152, v132, v133
v_cvt_pk_f16_f32 v149, v134, v135
v_mfma_f32_32x32x16_bf16 v[120:135], v[96:99], v[228:231], 0
ds_read_b128 v[224:227], v245 offset:4992
ds_read_b128 v[200:203], v242
v_xor_b32 v244, 16, v244
ds_read_b128 v[204:207], v244 offset:128
v_pk_fma_f16 v154, v155, v155, s48
v_and_b32 v137, s49, v137
v_pk_fma_f16 v151, v152, v152, s48
v_and_b32 v139, s49, v139
v_pk_fma_f16 v148, v149, v149, s48
v_pk_mul_f16 v154, v155, v154
v_bfe_u32 v136, v137, 2, 14
v_pk_mul_f16 v151, v152, v151
s_waitcnt lgkmcnt(4)
v_mfma_f32_32x32x16_bf16 v[120:135], v[100:103], v[232:235], v[120:135]
ds_read_b128 v[228:231], v248 offset:46080
ds_read_u16_d16 v136, v136
v_pk_mul_f16 v148, v149, v148
v_bfe_u32 v138, v139, 2, 14
v_exp_f16 v153, v154
v_lshrrev_b32 v137, 18, v137
v_exp_f16 v150, v151
v_lshrrev_b32 v139, 18, v139
v_mfma_f32_32x32x16_bf16 v[120:135], v[104:107], v[236:239], v[120:135]
ds_read_b128 v[232:235], v245 offset:4608
ds_read_b128 v[208:211], v244 offset:64
ds_read_b128 v[212:215], v244
ds_read_u16_d16 v138, v138
ds_read_u16_d16_hi v137, v137
ds_read_u16_d16_hi v139, v139
v_exp_f16 v147, v148
v_and_b32 v141, s49, v141
v_and_b32 v143, s49, v143
v_exp_f16_sdwa v153, v154 dst_sel:WORD_1 dst_unused:UNUSED_PRESERVE src0_sel:WORD_1
v_bfe_u32 v140, v141, 2, 14
v_exp_f16_sdwa v150, v151 dst_sel:WORD_1 dst_unused:UNUSED_PRESERVE src0_sel:WORD_1
v_mfma_f32_32x32x16_bf16 v[120:135], v[108:111], v[216:219], v[120:135]
ds_read_b128 v[236:239], v245 offset:4224
v_xor_b32 v243, 16, v243
ds_read_b128 v[192:195], v243 offset:128
ds_read_b128 v[196:199], v243 offset:64
ds_read_u16_d16 v140, v140
v_bfe_u32 v142, v143, 2, 14
v_exp_f16_sdwa v147, v148 dst_sel:WORD_1 dst_unused:UNUSED_PRESERVE src0_sel:WORD_1
v_lshrrev_b32_e64 v141, 18, v141
v_pk_add_f16 v153, v153, 1.0 op_sel_hi:[1,0]
v_lshrrev_b32 v143, 18, v143
v_pk_add_f16 v150, v150, 1.0 op_sel_hi:[1,0]
v_pk_add_f16 v147, v147, 1.0 op_sel_hi:[1,0]
s_waitcnt lgkmcnt(9)
v_mfma_f32_32x32x16_bf16 v[120:135], v[112:115], v[220:223], v[120:135]
ds_read_b128 v[216:219], v248 offset:47104
ds_read_u16_d16 v142, v142
ds_read_u16_d16_hi v141, v141
ds_read_u16_d16_hi v143, v143
v_and_b32 v145, s49, v145
v_rcp_f16 v154, v153
v_bfe_u32 v144, v145, 2, 14
v_rcp_f16 v151, v150
v_lshrrev_b32 v145, 18, v145
v_rcp_f16_e64 v148, v147
v_smfmac_f32_16x16x32_bf16 v[8:11], v[226:227], v[200:203], v246
ds_read_b128 v[220:223], v248 offset:50176
ds_read_u16_d16 v144, v144
ds_read_u16_d16_hi v145, v145
v_rcp_f16_sdwa v154, v153 dst_sel:WORD_1 dst_unused:UNUSED_PRESERVE src0_sel:WORD_1
v_fma_mix_f32 v159, v136, v136, v159 op_sel:[0,0,0] op_sel_hi:[1,1,0]
s_waitcnt lgkmcnt(7)
v_fma_mix_f32 v159, v137, v137, v159 op_sel:[1,1,0] op_sel_hi:[1,1,0]
v_smfmac_f32_16x16x32_bf16 v[44:47], v[224:225], v[204:207], v246
v_rcp_f16_sdwa v151, v150 dst_sel:WORD_1 dst_unused:UNUSED_PRESERVE src0_sel:WORD_1
v_fma_mix_f32 v159, v138, v138, v159 op_sel:[0,0,0] op_sel_hi:[1,1,0]
v_mfma_f32_32x32x16_bf16 v[120:135], v[116:119], v[228:231], v[120:135]
ds_read_b128 v[224:227], v248 offset:48128
v_rcp_f16_sdwa v148, v147 dst_sel:WORD_1 dst_unused:UNUSED_PRESERVE src0_sel:WORD_1
v_fma_mix_f32 v159, v139, v139, v159 op_sel:[1,1,0] op_sel_hi:[1,1,0]
v_pk_mul_f16 v155, v155, v154
v_fma_mix_f32 v159, v140, v140, v159 op_sel:[0,0,0] op_sel_hi:[1,1,0]
v_pk_mul_f16 v152, v152, v151
s_waitcnt lgkmcnt(4)
v_fma_mix_f32 v159, v141, v141, v159 op_sel:[1,1,0] op_sel_hi:[1,1,0]
v_pk_mul_f16 v149, v149, v148
v_fma_mix_f32 v159, v155, v155, v159 op_sel:[0,0,0] op_sel_hi:[1,1,0]
v_smfmac_f32_16x16x32_bf16 v[28:31], v[234:235], v[208:211], v246
ds_read_b128 v[228:231], v248 offset:51200
v_fma_mix_f32 v159, v142, v142, v159 op_sel:[0,0,0] op_sel_hi:[1,1,0]
v_fma_mix_f32 v159, v155, v155, v159 op_sel:[1,1,0] op_sel_hi:[1,1,0]
v_fma_mix_f32 v159, v143, v143, v159 op_sel:[1,1,0] op_sel_hi:[1,1,0]
v_fma_mix_f32 v159, v152, v152, v159 op_sel:[0,0,0] op_sel_hi:[1,1,0]
v_smfmac_f32_16x16x32_bf16 v[12:15], v[232:233], v[212:215], v246
v_fma_mix_f32 v159, v152, v152, v159 op_sel:[1,1,0] op_sel_hi:[1,1,0]
s_waitcnt lgkmcnt(2)
v_fma_mix_f32 v159, v144, v144, v159 op_sel:[0,0,0] op_sel_hi:[1,1,0]
v_fma_mix_f32 v159, v149, v149, v159 op_sel:[0,0,0] op_sel_hi:[1,1,0]
v_fma_mix_f32 v159, v145, v145, v159 op_sel:[1,1,0] op_sel_hi:[1,1,0]
v_fma_mix_f32 v159, v149, v149, v159 op_sel:[1,1,0] op_sel_hi:[1,1,0]
s_setprio 1
v_smfmac_f32_16x16x32_bf16 v[44:47], v[238:239], v[192:195], v246
s_add_u32 s46, s80, 23068672
buffer_store_dwordx4 v[92:95], v241, s[32:35], s46 offen sc1
ds_read_b128 v[232:235], v248 offset:49152
v_cvt_pkrtz_f16_f32 v137, v120, v121
v_cvt_pkrtz_f16_f32 v139, v122, v123
v_cvt_pkrtz_f16_f32 v141, v124, v125
v_cvt_pkrtz_f16_f32 v143, v126, v127
v_cvt_pk_f16_f32 v155, v128, v129
v_smfmac_f32_16x16x32_bf16 v[28:31], v[236:237], v[196:199], v246
v_cvt_pk_f16_f32 v152, v130, v131
v_cvt_pk_f16_f32 v149, v132, v133
v_cvt_pk_f16_f32 v146, v134, v135
v_pk_fma_f16 v154, v155, v155, s48
v_and_b32_e64 v137, s49, v137
v_mfma_f32_32x32x16_bf16 v[120:135], v[96:99], v[216:219], 0
ds_read_b128 v[236:239], v248 offset:52224
v_pk_fma_f16 v151, v152, v152, s48
v_pk_fma_f16 v148, v149, v149, s48
v_and_b32_e64 v139, s49, v139
v_pk_fma_f16 v145, v146, v146, s48
v_pk_mul_f16 v154, v155, v154
v_bfe_u32 v136, v137, 2, 14
v_pk_mul_f16 v151, v152, v151
v_pk_mul_f16 v148, v149, v148
v_bfe_u32 v138, v139, 2, 14
v_pk_mul_f16 v145, v146, v145
v_mfma_f32_32x32x16_bf16 v[120:135], v[100:103], v[220:223], v[120:135]
ds_read_b128 v[216:219], v245 offset:3840
ds_read_b128 v[200:203], v243
v_xor_b32 v242, 16, v242
ds_read_b128 v[204:207], v242 offset:128
ds_read_u16_d16 v136, v136
ds_read_u16_d16 v138, v138
v_exp_f16 v153, v154
v_lshrrev_b32 v137, 18, v137
v_exp_f16 v150, v151
v_lshrrev_b32 v139, 18, v139
v_exp_f16 v147, v148
v_and_b32_e64 v141, s49, v141
v_exp_f16 v144, v145
s_waitcnt lgkmcnt(5)
v_mfma_f32_32x32x16_bf16 v[120:135], v[104:107], v[224:227], v[120:135]
ds_read_b128 v[220:223], v245 offset:3456
ds_read_b128 v[208:211], v242 offset:64
ds_read_b128 v[212:215], v242
ds_read_u16_d16_hi v137, v137
ds_read_u16_d16_hi v139, v139
v_and_b32_e64 v143, s49, v143
v_exp_f16_sdwa v153, v154 dst_sel:WORD_1 dst_unused:UNUSED_PRESERVE src0_sel:WORD_1
v_bfe_u32 v140, v141, 2, 14
v_exp_f16_sdwa v150, v151 dst_sel:WORD_1 dst_unused:UNUSED_PRESERVE src0_sel:WORD_1
v_bfe_u32 v142, v143, 2, 14
v_exp_f16_sdwa v147, v148 dst_sel:WORD_1 dst_unused:UNUSED_PRESERVE src0_sel:WORD_1
v_lshrrev_b32_e64 v141, 18, v141
v_mfma_f32_32x32x16_bf16 v[120:135], v[108:111], v[228:231], v[120:135]
ds_read_b128 v[224:227], v248 offset:53248
ds_read_u16_d16 v140, v140
ds_read_u16_d16 v142, v142
ds_read_u16_d16_hi v141, v141
v_exp_f16_sdwa v144, v145 dst_sel:WORD_1 dst_unused:UNUSED_PRESERVE src0_sel:WORD_1
v_lshrrev_b32_e64 v143, 18, v143
v_pk_add_f16 v153, v153, 1.0 op_sel_hi:[1,0]
v_pk_add_f16 v150, v150, 1.0 op_sel_hi:[1,0]
v_pk_add_f16 v147, v147, 1.0 op_sel_hi:[1,0]
v_pk_add_f16 v144, v144, 1.0 op_sel_hi:[1,0]
v_rcp_f16 v154, v153
v_rcp_f16 v151, v150
v_mfma_f32_32x32x16_bf16 v[120:135], v[112:115], v[232:235], v[120:135]
ds_read_b128 v[228:231], v248 offset:56320
ds_read_u16_d16_hi v143, v143
v_rcp_f16_e64 v148, v147
v_rcp_f16 v145, v144
v_rcp_f16_sdwa v154, v153 dst_sel:WORD_1 dst_unused:UNUSED_PRESERVE src0_sel:WORD_1
v_rcp_f16_sdwa v151, v150 dst_sel:WORD_1 dst_unused:UNUSED_PRESERVE src0_sel:WORD_1
s_setprio 0
v_rcp_f16_sdwa v148, v147 dst_sel:WORD_1 dst_unused:UNUSED_PRESERVE src0_sel:WORD_1
s_waitcnt lgkmcnt(6)
v_fma_mix_f32 v160, v136, v136, v160 op_sel:[0,0,0] op_sel_hi:[1,1,0]
v_mfma_f32_32x32x16_bf16 v[120:135], v[116:119], v[236:239], v[120:135]
ds_read_b128 v[232:235], v248 offset:54272
v_rcp_f16_sdwa v145, v144 dst_sel:WORD_1 dst_unused:UNUSED_PRESERVE src0_sel:WORD_1
v_fma_mix_f32 v160, v137, v137, v160 op_sel:[1,1,0] op_sel_hi:[1,1,0]
v_pk_mul_f16 v155, v155, v154
v_fma_mix_f32 v160, v138, v138, v160 op_sel:[0,0,0] op_sel_hi:[1,1,0]
v_pk_mul_f16 v152, v152, v151
v_pk_mul_f16 v149, v149, v148
v_fma_mix_f32 v160, v139, v139, v160 op_sel:[1,1,0] op_sel_hi:[1,1,0]
v_pk_mul_f16 v146, v146, v145
v_fma_mix_f32 v160, v155, v155, v160 op_sel:[0,0,0] op_sel_hi:[1,1,0]
v_smfmac_f32_16x16x32_bf16 v[12:15], v[218:219], v[200:203], v246
ds_read_b128 v[236:239], v248 offset:57344
s_waitcnt lgkmcnt(4)
v_fma_mix_f32 v160, v140, v140, v160 op_sel:[0,0,0] op_sel_hi:[1,1,0]
v_fma_mix_f32 v160, v155, v155, v160 op_sel:[1,1,0] op_sel_hi:[1,1,0]
v_fma_mix_f32 v160, v152, v152, v160 op_sel:[0,0,0] op_sel_hi:[1,1,0]
v_fma_mix_f32 v160, v141, v141, v160 op_sel:[1,1,0] op_sel_hi:[1,1,0]
v_fma_mix_f32 v160, v152, v152, v160 op_sel:[1,1,0] op_sel_hi:[1,1,0]
v_smfmac_f32_16x16x32_bf16 v[44:47], v[216:217], v[204:207], v246
v_fma_mix_f32 v160, v149, v149, v160 op_sel:[0,0,0] op_sel_hi:[1,1,0]
v_fma_mix_f32 v160, v142, v142, v160 op_sel:[0,0,0] op_sel_hi:[1,1,0]
v_fma_mix_f32 v160, v149, v149, v160 op_sel:[1,1,0] op_sel_hi:[1,1,0]
v_fma_mix_f32 v160, v146, v146, v160 op_sel:[0,0,0] op_sel_hi:[1,1,0]
s_waitcnt lgkmcnt(2)
v_fma_mix_f32 v160, v143, v143, v160 op_sel:[1,1,0] op_sel_hi:[1,1,0]
v_fma_mix_f32 v160, v146, v146, v160 op_sel:[1,1,0] op_sel_hi:[1,1,0]
s_setprio 2
v_smfmac_f32_16x16x32_bf16 v[28:31], v[222:223], v[208:211], v246
ds_read_b128 v[216:219], v248 offset:55296
v_cvt_pkrtz_f16_f32 v137, v120, v121
v_cvt_pkrtz_f16_f32 v139, v122, v123
v_cvt_pkrtz_f16_f32 v141, v124, v125
v_cvt_pkrtz_f16_f32 v143, v126, v127
v_smfmac_f32_16x16x32_bf16 v[12:15], v[220:221], v[212:215], v246
v_cvt_pkrtz_f16_f32 v145, v128, v129
v_cvt_pk_f16_f32 v155, v130, v131
v_cvt_pk_f16_f32 v152, v132, v133
v_cvt_pk_f16_f32 v149, v134, v135
v_mfma_f32_32x32x16_bf16 v[120:135], v[96:99], v[224:227], 0
ds_read_b128 v[220:223], v245 offset:3072
v_xor_b32 v244, 32, v244
ds_read_b128 v[192:195], v244 offset:128
ds_read_b128 v[196:199], v244 offset:64
v_pk_fma_f16 v154, v155, v155, s48
v_and_b32 v137, s49, v137
v_pk_fma_f16 v151, v152, v152, s48
v_and_b32_e64 v139, s49, v139
v_pk_fma_f16 v148, v149, v149, s48
v_pk_mul_f16 v154, v155, v154
v_bfe_u32 v136, v137, 2, 14
v_pk_mul_f16 v151, v152, v151
v_mfma_f32_32x32x16_bf16 v[120:135], v[100:103], v[228:231], v[120:135]
ds_read_b128 v[224:227], v248 offset:58368
ds_read_u16_d16 v136, v136
v_pk_mul_f16 v148, v149, v148
v_bfe_u32 v138, v139, 2, 14
v_exp_f16 v153, v154
v_lshrrev_b32 v137, 18, v137
v_exp_f16 v150, v151
v_lshrrev_b32 v139, 18, v139
s_waitcnt lgkmcnt(5)
v_mfma_f32_32x32x16_bf16 v[120:135], v[104:107], v[232:235], v[120:135]
ds_read_b128 v[228:231], v245 offset:2688
ds_read_b128 v[200:203], v244
v_xor_b32 v243, 32, v243
ds_read_b128 v[204:207], v243 offset:128
ds_read_u16_d16 v138, v138
ds_read_u16_d16_hi v137, v137
ds_read_u16_d16_hi v139, v139
v_exp_f16 v147, v148
v_and_b32 v141, s49, v141
v_and_b32_e64 v143, s49, v143
v_exp_f16_sdwa v153, v154 dst_sel:WORD_1 dst_unused:UNUSED_PRESERVE src0_sel:WORD_1
v_bfe_u32 v140, v141, 2, 14
v_exp_f16_sdwa v150, v151 dst_sel:WORD_1 dst_unused:UNUSED_PRESERVE src0_sel:WORD_1
v_mfma_f32_32x32x16_bf16 v[120:135], v[108:111], v[236:239], v[120:135]
ds_read_b128 v[232:235], v245 offset:2304
ds_read_b128 v[208:211], v243 offset:64
ds_read_b128 v[212:215], v243
ds_read_u16_d16 v140, v140
v_bfe_u32 v142, v143, 2, 14
v_exp_f16_sdwa v147, v148 dst_sel:WORD_1 dst_unused:UNUSED_PRESERVE src0_sel:WORD_1
v_lshrrev_b32_e64 v141, 18, v141
v_pk_add_f16 v153, v153, 1.0 op_sel_hi:[1,0]
v_lshrrev_b32_e64 v143, 18, v143
v_pk_add_f16 v150, v150, 1.0 op_sel_hi:[1,0]
v_pk_add_f16 v147, v147, 1.0 op_sel_hi:[1,0]
v_mfma_f32_32x32x16_bf16 v[120:135], v[112:115], v[216:219], v[120:135]
ds_read_b128 v[236:239], v248 offset:59392
ds_read_u16_d16 v142, v142
ds_read_u16_d16_hi v141, v141
ds_read_u16_d16_hi v143, v143
v_and_b32 v145, s49, v145
v_rcp_f16 v154, v153
v_bfe_u32 v144, v145, 2, 14
v_rcp_f16 v151, v150
v_lshrrev_b32 v145, 18, v145
v_rcp_f16 v148, v147
s_waitcnt lgkmcnt(8)
v_smfmac_f32_16x16x32_bf16 v[36:39], v[222:223], v[192:195], v246
ds_read_b128 v[216:219], v248 offset:62464
ds_read_u16_d16 v144, v144
ds_read_u16_d16_hi v145, v145
v_rcp_f16_sdwa v154, v153 dst_sel:WORD_1 dst_unused:UNUSED_PRESERVE src0_sel:WORD_1
v_fma_mix_f32 v161, v136, v136, v161 op_sel:[0,0,0] op_sel_hi:[1,1,0]
v_fma_mix_f32 v161, v137, v137, v161 op_sel:[1,1,0] op_sel_hi:[1,1,0]
v_smfmac_f32_16x16x32_bf16 v[20:23], v[220:221], v[196:199], v246
v_rcp_f16_sdwa v151, v150 dst_sel:WORD_1 dst_unused:UNUSED_PRESERVE src0_sel:WORD_1
v_fma_mix_f32 v161, v138, v138, v161 op_sel:[0,0,0] op_sel_hi:[1,1,0]
v_mfma_f32_32x32x16_bf16 v[120:135], v[116:119], v[224:227], v[120:135]
ds_read_b128 v[220:223], v248 offset:60416
v_rcp_f16_sdwa v148, v147 dst_sel:WORD_1 dst_unused:UNUSED_PRESERVE src0_sel:WORD_1
v_fma_mix_f32 v161, v139, v139, v161 op_sel:[1,1,0] op_sel_hi:[1,1,0]
v_pk_mul_f16 v155, v155, v154
s_waitcnt lgkmcnt(6)
v_fma_mix_f32 v161, v140, v140, v161 op_sel:[0,0,0] op_sel_hi:[1,1,0]
v_pk_mul_f16 v152, v152, v151
s_waitcnt lgkmcnt(4)
v_fma_mix_f32 v161, v141, v141, v161 op_sel:[1,1,0] op_sel_hi:[1,1,0]
v_pk_mul_f16 v149, v149, v148
v_fma_mix_f32 v161, v155, v155, v161 op_sel:[0,0,0] op_sel_hi:[1,1,0]
v_smfmac_f32_16x16x32_bf16 v[4:7], v[230:231], v[200:203], v246
ds_read_b128 v[224:227], v248 offset:63488
v_fma_mix_f32 v161, v142, v142, v161 op_sel:[0,0,0] op_sel_hi:[1,1,0]
v_fma_mix_f32 v161, v155, v155, v161 op_sel:[1,1,0] op_sel_hi:[1,1,0]
v_fma_mix_f32 v161, v143, v143, v161 op_sel:[1,1,0] op_sel_hi:[1,1,0]
v_fma_mix_f32 v161, v152, v152, v161 op_sel:[0,0,0] op_sel_hi:[1,1,0]
v_smfmac_f32_16x16x32_bf16 v[36:39], v[228:229], v[204:207], v246
v_fma_mix_f32 v161, v152, v152, v161 op_sel:[1,1,0] op_sel_hi:[1,1,0]
s_waitcnt lgkmcnt(2)
v_fma_mix_f32 v161, v144, v144, v161 op_sel:[0,0,0] op_sel_hi:[1,1,0]
v_fma_mix_f32 v161, v149, v149, v161 op_sel:[0,0,0] op_sel_hi:[1,1,0]
v_fma_mix_f32 v161, v145, v145, v161 op_sel:[1,1,0] op_sel_hi:[1,1,0]
v_fma_mix_f32 v161, v149, v149, v161 op_sel:[1,1,0] op_sel_hi:[1,1,0]
s_setprio 1
v_smfmac_f32_16x16x32_bf16 v[20:23], v[234:235], v[208:211], v246
ds_read_b128 v[228:231], v248 offset:61440
v_cvt_pkrtz_f16_f32 v137, v120, v121
v_cvt_pkrtz_f16_f32 v139, v122, v123
v_cvt_pkrtz_f16_f32 v141, v124, v125
v_cvt_pkrtz_f16_f32 v143, v126, v127
v_cvt_pk_f16_f32 v155, v128, v129
v_smfmac_f32_16x16x32_bf16 v[4:7], v[232:233], v[212:215], v246
v_cvt_pk_f16_f32 v152, v130, v131
v_cvt_pk_f16_f32 v149, v132, v133
v_cvt_pk_f16_f32 v146, v134, v135
v_pk_fma_f16 v154, v155, v155, s48
v_and_b32_e64 v137, s49, v137
v_mfma_f32_32x32x16_bf16 v[120:135], v[96:99], v[236:239], 0
ds_read_b128 v[232:235], v248 offset:64512
v_pk_fma_f16 v151, v152, v152, s48
v_pk_fma_f16 v148, v149, v149, s48
v_and_b32_e64 v139, s49, v139
v_pk_fma_f16 v145, v146, v146, s48
v_pk_mul_f16 v154, v155, v154
v_bfe_u32 v136, v137, 2, 14
v_pk_mul_f16 v151, v152, v151
v_pk_mul_f16 v148, v149, v148
v_bfe_u32 v138, v139, 2, 14
v_pk_mul_f16 v145, v146, v145
v_mfma_f32_32x32x16_bf16 v[120:135], v[100:103], v[216:219], v[120:135]
ds_read_b128 v[236:239], v245 offset:1920
v_xor_b32 v242, 32, v242
ds_read_b128 v[192:195], v242 offset:128
ds_read_b128 v[196:199], v242 offset:64
ds_read_u16_d16 v136, v136
ds_read_u16_d16 v138, v138
v_exp_f16 v153, v154
v_lshrrev_b32 v137, 18, v137
v_exp_f16 v150, v151
v_lshrrev_b32 v139, 18, v139
v_exp_f16 v147, v148
v_and_b32 v141, s49, v141
v_exp_f16 v144, v145
s_waitcnt lgkmcnt(5)
v_mfma_f32_32x32x16_bf16 v[120:135], v[104:107], v[220:223], v[120:135]
ds_read_b128 v[216:219], v245 offset:1536
ds_read_b128 v[200:203], v242
v_xor_b32 v244, 16, v244
ds_read_b128 v[204:207], v244 offset:128
ds_read_u16_d16_hi v137, v137
ds_read_u16_d16_hi v139, v139
v_and_b32_e64 v143, s49, v143
v_exp_f16_sdwa v153, v154 dst_sel:WORD_1 dst_unused:UNUSED_PRESERVE src0_sel:WORD_1
v_bfe_u32 v140, v141, 2, 14
v_exp_f16_sdwa v150, v151 dst_sel:WORD_1 dst_unused:UNUSED_PRESERVE src0_sel:WORD_1
v_bfe_u32 v142, v143, 2, 14
v_exp_f16_sdwa v147, v148 dst_sel:WORD_1 dst_unused:UNUSED_PRESERVE src0_sel:WORD_1
v_lshrrev_b32_e64 v141, 18, v141
v_mfma_f32_32x32x16_bf16 v[120:135], v[108:111], v[224:227], v[120:135]
ds_read_b128 v[220:223], v249
ds_read_u16_d16 v140, v140
ds_read_u16_d16 v142, v142
ds_read_u16_d16_hi v141, v141
v_exp_f16_sdwa v144, v145 dst_sel:WORD_1 dst_unused:UNUSED_PRESERVE src0_sel:WORD_1
v_lshrrev_b32_e64 v143, 18, v143
v_pk_add_f16 v153, v153, 1.0 op_sel_hi:[1,0]
v_pk_add_f16 v150, v150, 1.0 op_sel_hi:[1,0]
v_pk_add_f16 v147, v147, 1.0 op_sel_hi:[1,0]
v_pk_add_f16 v144, v144, 1.0 op_sel_hi:[1,0]
v_rcp_f16 v154, v153
v_rcp_f16 v151, v150
v_mfma_f32_32x32x16_bf16 v[120:135], v[112:115], v[228:231], v[120:135]
ds_read_b128 v[224:227], v249 offset:3072
ds_read_u16_d16_hi v143, v143
v_rcp_f16_e64 v148, v147
v_rcp_f16 v145, v144
v_rcp_f16_sdwa v154, v153 dst_sel:WORD_1 dst_unused:UNUSED_PRESERVE src0_sel:WORD_1
v_rcp_f16_sdwa v151, v150 dst_sel:WORD_1 dst_unused:UNUSED_PRESERVE src0_sel:WORD_1
s_setprio 0
v_rcp_f16_sdwa v148, v147 dst_sel:WORD_1 dst_unused:UNUSED_PRESERVE src0_sel:WORD_1
s_waitcnt lgkmcnt(6)
v_fma_mix_f32 v162, v136, v136, v162 op_sel:[0,0,0] op_sel_hi:[1,1,0]
v_mfma_f32_32x32x16_bf16 v[120:135], v[116:119], v[232:235], v[120:135]
ds_read_b128 v[228:231], v249 offset:1024
v_rcp_f16_sdwa v145, v144 dst_sel:WORD_1 dst_unused:UNUSED_PRESERVE src0_sel:WORD_1
v_fma_mix_f32 v162, v137, v137, v162 op_sel:[1,1,0] op_sel_hi:[1,1,0]
v_pk_mul_f16 v155, v155, v154
v_fma_mix_f32 v162, v138, v138, v162 op_sel:[0,0,0] op_sel_hi:[1,1,0]
v_pk_mul_f16 v152, v152, v151
v_pk_mul_f16 v149, v149, v148
v_fma_mix_f32 v162, v139, v139, v162 op_sel:[1,1,0] op_sel_hi:[1,1,0]
v_pk_mul_f16 v146, v146, v145
v_fma_mix_f32 v162, v155, v155, v162 op_sel:[0,0,0] op_sel_hi:[1,1,0]
v_smfmac_f32_16x16x32_bf16 v[36:39], v[238:239], v[192:195], v246
ds_read_b128 v[232:235], v249 offset:4096
s_waitcnt lgkmcnt(4)
v_fma_mix_f32 v162, v140, v140, v162 op_sel:[0,0,0] op_sel_hi:[1,1,0]
v_fma_mix_f32 v162, v155, v155, v162 op_sel:[1,1,0] op_sel_hi:[1,1,0]
v_fma_mix_f32 v162, v152, v152, v162 op_sel:[0,0,0] op_sel_hi:[1,1,0]
v_fma_mix_f32 v162, v141, v141, v162 op_sel:[1,1,0] op_sel_hi:[1,1,0]
v_fma_mix_f32 v162, v152, v152, v162 op_sel:[1,1,0] op_sel_hi:[1,1,0]
v_smfmac_f32_16x16x32_bf16 v[20:23], v[236:237], v[196:199], v246
v_fma_mix_f32 v162, v149, v149, v162 op_sel:[0,0,0] op_sel_hi:[1,1,0]
v_fma_mix_f32 v162, v142, v142, v162 op_sel:[0,0,0] op_sel_hi:[1,1,0]
v_fma_mix_f32 v162, v149, v149, v162 op_sel:[1,1,0] op_sel_hi:[1,1,0]
v_fma_mix_f32 v162, v146, v146, v162 op_sel:[0,0,0] op_sel_hi:[1,1,0]
s_waitcnt lgkmcnt(2)
v_fma_mix_f32 v162, v143, v143, v162 op_sel:[1,1,0] op_sel_hi:[1,1,0]
v_fma_mix_f32 v162, v146, v146, v162 op_sel:[1,1,0] op_sel_hi:[1,1,0]
s_setprio 2
v_smfmac_f32_16x16x32_bf16 v[4:7], v[218:219], v[200:203], v246
ds_read_b128 v[236:239], v249 offset:2048
v_cvt_pkrtz_f16_f32 v137, v120, v121
v_cvt_pkrtz_f16_f32 v139, v122, v123
v_cvt_pkrtz_f16_f32 v141, v124, v125
v_cvt_pkrtz_f16_f32 v143, v126, v127
v_smfmac_f32_16x16x32_bf16 v[32:35], v[216:217], v[204:207], v246
v_cvt_pkrtz_f16_f32 v145, v128, v129
v_cvt_pk_f16_f32 v155, v130, v131
v_cvt_pk_f16_f32 v152, v132, v133
v_cvt_pk_f16_f32 v149, v134, v135
v_mfma_f32_32x32x16_bf16 v[120:135], v[96:99], v[220:223], 0
ds_read_b128 v[216:219], v245 offset:1152
ds_read_b128 v[208:211], v244 offset:64
ds_read_b128 v[212:215], v244
v_pk_fma_f16 v154, v155, v155, s48
v_and_b32_e64 v137, s49, v137
v_pk_fma_f16 v151, v152, v152, s48
v_and_b32_e64 v139, s49, v139
v_pk_fma_f16 v148, v149, v149, s48
v_pk_mul_f16 v154, v155, v154
v_bfe_u32 v136, v137, 2, 14
v_pk_mul_f16 v151, v152, v151
v_mfma_f32_32x32x16_bf16 v[120:135], v[100:103], v[224:227], v[120:135]
ds_read_b128 v[220:223], v249 offset:5120
ds_read_u16_d16 v136, v136
v_pk_mul_f16 v148, v149, v148
v_bfe_u32 v138, v139, 2, 14
v_exp_f16 v153, v154
v_lshrrev_b32 v137, 18, v137
v_exp_f16 v150, v151
v_lshrrev_b32 v139, 18, v139
s_waitcnt lgkmcnt(5)
v_mfma_f32_32x32x16_bf16 v[120:135], v[104:107], v[228:231], v[120:135]
ds_read_b128 v[224:227], v245 offset:768
v_xor_b32 v243, 16, v243
ds_read_b128 v[192:195], v243 offset:128
ds_read_b128 v[196:199], v243 offset:64
ds_read_u16_d16 v138, v138
ds_read_u16_d16_hi v137, v137
ds_read_u16_d16_hi v139, v139
v_exp_f16 v147, v148
v_and_b32 v141, s49, v141
v_and_b32_e64 v143, s49, v143
v_exp_f16_sdwa v153, v154 dst_sel:WORD_1 dst_unused:UNUSED_PRESERVE src0_sel:WORD_1
v_bfe_u32 v140, v141, 2, 14
v_exp_f16_sdwa v150, v151 dst_sel:WORD_1 dst_unused:UNUSED_PRESERVE src0_sel:WORD_1
v_mfma_f32_32x32x16_bf16 v[120:135], v[108:111], v[232:235], v[120:135]
ds_read_b128 v[228:231], v245 offset:384
ds_read_b128 v[200:203], v243
v_xor_b32 v242, 16, v242
ds_read_b128 v[204:207], v242 offset:128
ds_read_u16_d16 v140, v140
v_bfe_u32 v142, v143, 2, 14
v_exp_f16_sdwa v147, v148 dst_sel:WORD_1 dst_unused:UNUSED_PRESERVE src0_sel:WORD_1
v_lshrrev_b32 v141, 18, v141
v_pk_add_f16 v153, v153, 1.0 op_sel_hi:[1,0]
v_lshrrev_b32_e64 v143, 18, v143
v_pk_add_f16 v150, v150, 1.0 op_sel_hi:[1,0]
v_pk_add_f16 v147, v147, 1.0 op_sel_hi:[1,0]
v_mfma_f32_32x32x16_bf16 v[120:135], v[112:115], v[236:239], v[120:135]
ds_read_b128 v[232:235], v249 offset:6144
ds_read_u16_d16 v142, v142
ds_read_u16_d16_hi v141, v141
ds_read_u16_d16_hi v143, v143
v_and_b32 v145, s49, v145
v_rcp_f16 v154, v153
v_bfe_u32 v144, v145, 2, 14
v_rcp_f16 v151, v150
v_lshrrev_b32 v145, 18, v145
v_rcp_f16 v148, v147
s_waitcnt lgkmcnt(8)
v_smfmac_f32_16x16x32_bf16 v[16:19], v[218:219], v[208:211], v246
ds_read_b128 v[236:239], v249 offset:9216
ds_read_u16_d16 v144, v144
ds_read_u16_d16_hi v145, v145
v_rcp_f16_sdwa v154, v153 dst_sel:WORD_1 dst_unused:UNUSED_PRESERVE src0_sel:WORD_1
v_fma_mix_f32 v163, v136, v136, v163 op_sel:[0,0,0] op_sel_hi:[1,1,0]
v_fma_mix_f32 v163, v137, v137, v163 op_sel:[1,1,0] op_sel_hi:[1,1,0]
v_smfmac_f32_16x16x32_bf16 v[0:3], v[216:217], v[212:215], v246
v_rcp_f16_sdwa v151, v150 dst_sel:WORD_1 dst_unused:UNUSED_PRESERVE src0_sel:WORD_1
v_fma_mix_f32 v163, v138, v138, v163 op_sel:[0,0,0] op_sel_hi:[1,1,0]
v_mfma_f32_32x32x16_bf16 v[120:135], v[116:119], v[220:223], v[120:135]
ds_read_b128 v[216:219], v249 offset:7168
v_rcp_f16_sdwa v148, v147 dst_sel:WORD_1 dst_unused:UNUSED_PRESERVE src0_sel:WORD_1
v_fma_mix_f32 v163, v139, v139, v163 op_sel:[1,1,0] op_sel_hi:[1,1,0]
v_pk_mul_f16 v155, v155, v154
s_waitcnt lgkmcnt(6)
v_fma_mix_f32 v163, v140, v140, v163 op_sel:[0,0,0] op_sel_hi:[1,1,0]
v_pk_mul_f16 v152, v152, v151
s_waitcnt lgkmcnt(4)
v_fma_mix_f32 v163, v141, v141, v163 op_sel:[1,1,0] op_sel_hi:[1,1,0]
v_pk_mul_f16 v149, v149, v148
v_fma_mix_f32 v163, v155, v155, v163 op_sel:[0,0,0] op_sel_hi:[1,1,0]
v_smfmac_f32_16x16x32_bf16 v[32:35], v[226:227], v[192:195], v246
ds_read_b128 v[220:223], v249 offset:10240
v_fma_mix_f32 v163, v142, v142, v163 op_sel:[0,0,0] op_sel_hi:[1,1,0]
v_fma_mix_f32 v163, v155, v155, v163 op_sel:[1,1,0] op_sel_hi:[1,1,0]
v_fma_mix_f32 v163, v143, v143, v163 op_sel:[1,1,0] op_sel_hi:[1,1,0]
v_fma_mix_f32 v163, v152, v152, v163 op_sel:[0,0,0] op_sel_hi:[1,1,0]
v_smfmac_f32_16x16x32_bf16 v[16:19], v[224:225], v[196:199], v246
v_fma_mix_f32 v163, v152, v152, v163 op_sel:[1,1,0] op_sel_hi:[1,1,0]
s_waitcnt lgkmcnt(2)
v_fma_mix_f32 v163, v144, v144, v163 op_sel:[0,0,0] op_sel_hi:[1,1,0]
v_fma_mix_f32 v163, v149, v149, v163 op_sel:[0,0,0] op_sel_hi:[1,1,0]
v_fma_mix_f32 v163, v145, v145, v163 op_sel:[1,1,0] op_sel_hi:[1,1,0]
v_fma_mix_f32 v163, v149, v149, v163 op_sel:[1,1,0] op_sel_hi:[1,1,0]
s_setprio 1
v_smfmac_f32_16x16x32_bf16 v[0:3], v[230:231], v[200:203], v246
ds_read_b128 v[224:227], v249 offset:8192
v_cvt_pkrtz_f16_f32 v137, v120, v121
v_cvt_pkrtz_f16_f32 v139, v122, v123
v_cvt_pkrtz_f16_f32 v141, v124, v125
v_cvt_pkrtz_f16_f32 v143, v126, v127
v_smfmac_f32_16x16x32_bf16 v[32:35], v[228:229], v[204:207], v246
v_cvt_pk_f16_f32 v155, v128, v129
v_cvt_pk_f16_f32 v152, v130, v131
v_cvt_pk_f16_f32 v149, v132, v133
v_cvt_pk_f16_f32 v146, v134, v135
v_pk_fma_f16 v154, v155, v155, s48
v_mfma_f32_32x32x16_bf16 v[120:135], v[96:99], v[232:235], 0
ds_read_b128 v[228:231], v249 offset:11264
v_and_b32_e64 v137, s49, v137
v_pk_fma_f16 v151, v152, v152, s48
v_pk_fma_f16 v148, v149, v149, s48
v_and_b32_e64 v139, s49, v139
v_pk_fma_f16 v145, v146, v146, s48
v_pk_mul_f16 v154, v155, v154
v_bfe_u32 v136, v137, 2, 14
v_pk_mul_f16 v151, v152, v151
v_pk_mul_f16 v148, v149, v148
v_bfe_u32 v138, v139, 2, 14
v_mfma_f32_32x32x16_bf16 v[120:135], v[100:103], v[236:239], v[120:135]
ds_read_b128 v[232:235], v245
ds_read_b128 v[208:211], v242 offset:64
ds_read_b128 v[212:215], v242
ds_read_u16_d16 v136, v136
ds_read_u16_d16 v138, v138
v_pk_mul_f16 v145, v146, v145
v_exp_f16 v153, v154
v_lshrrev_b32 v137, 18, v137
v_exp_f16 v150, v151
v_lshrrev_b32 v139, 18, v139
v_exp_f16 v147, v148
s_waitcnt lgkmcnt(6)
v_mfma_f32_32x32x16_bf16 v[120:135], v[104:107], v[216:219], v[120:135]
ds_read_b128 v[236:239], v249 offset:12288
ds_read_u16_d16_hi v137, v137
ds_read_u16_d16_hi v139, v139
v_and_b32 v141, s49, v141
v_exp_f16 v144, v145
v_and_b32_e64 v143, s49, v143
v_exp_f16_sdwa v153, v154 dst_sel:WORD_1 dst_unused:UNUSED_PRESERVE src0_sel:WORD_1
v_bfe_u32 v140, v141, 2, 14
v_exp_f16_sdwa v150, v151 dst_sel:WORD_1 dst_unused:UNUSED_PRESERVE src0_sel:WORD_1
v_bfe_u32 v142, v143, 2, 14
v_mfma_f32_32x32x16_bf16 v[120:135], v[108:111], v[220:223], v[120:135]
ds_read_b128 v[216:219], v249 offset:15360
ds_read_u16_d16 v140, v140
ds_read_u16_d16 v142, v142
v_exp_f16_sdwa v147, v148 dst_sel:WORD_1 dst_unused:UNUSED_PRESERVE src0_sel:WORD_1
v_lshrrev_b32_e64 v141, 18, v141
v_exp_f16_sdwa v144, v145 dst_sel:WORD_1 dst_unused:UNUSED_PRESERVE src0_sel:WORD_1
v_lshrrev_b32_e64 v143, 18, v143
v_pk_add_f16 v153, v153, 1.0 op_sel_hi:[1,0]
v_pk_add_f16 v150, v150, 1.0 op_sel_hi:[1,0]
v_pk_add_f16 v147, v147, 1.0 op_sel_hi:[1,0]
v_mfma_f32_32x32x16_bf16 v[120:135], v[112:115], v[224:227], v[120:135]
ds_read_b128 v[220:223], v249 offset:13312
ds_read_u16_d16_hi v141, v141
ds_read_u16_d16_hi v143, v143
v_pk_add_f16 v144, v144, 1.0 op_sel_hi:[1,0]
v_rcp_f16 v154, v153
v_rcp_f16 v151, v150
v_rcp_f16 v148, v147
v_rcp_f16 v145, v144
s_waitcnt lgkmcnt(6)
v_mfma_f32_32x32x16_bf16 v[120:135], v[116:119], v[228:231], v[120:135]
ds_read_b128 v[224:227], v249 offset:16384
v_rcp_f16_sdwa v154, v153 dst_sel:WORD_1 dst_unused:UNUSED_PRESERVE src0_sel:WORD_1
v_rcp_f16_sdwa v151, v150 dst_sel:WORD_1 dst_unused:UNUSED_PRESERVE src0_sel:WORD_1
s_setprio 0
v_rcp_f16_sdwa v148, v147 dst_sel:WORD_1 dst_unused:UNUSED_PRESERVE src0_sel:WORD_1
v_fma_mix_f32 v164, v136, v136, v164 op_sel:[0,0,0] op_sel_hi:[1,1,0]
v_rcp_f16_sdwa v145, v144 dst_sel:WORD_1 dst_unused:UNUSED_PRESERVE src0_sel:WORD_1
v_fma_mix_f32 v164, v137, v137, v164 op_sel:[1,1,0] op_sel_hi:[1,1,0]
v_smfmac_f32_16x16x32_bf16 v[16:19], v[234:235], v[208:211], v246
ds_read_b128 v[228:231], v249 offset:14336
v_pk_mul_f16 v155, v155, v154
v_fma_mix_f32 v164, v138, v138, v164 op_sel:[0,0,0] op_sel_hi:[1,1,0]
v_pk_mul_f16 v152, v152, v151
v_pk_mul_f16 v149, v149, v148
v_fma_mix_f32 v164, v139, v139, v164 op_sel:[1,1,0] op_sel_hi:[1,1,0]
v_smfmac_f32_16x16x32_bf16 v[0:3], v[232:233], v[212:215], v246
s_mov_b64 exec, 1
ds_add_u32 v253, v254 offset:16
s_mov_b64 exec, -1
v_pk_mul_f16 v146, v146, v145
v_fma_mix_f32 v164, v155, v155, v164 op_sel:[0,0,0] op_sel_hi:[1,1,0]
s_waitcnt lgkmcnt(3)
v_fma_mix_f32 v164, v140, v140, v164 op_sel:[0,0,0] op_sel_hi:[1,1,0]
v_fma_mix_f32 v164, v155, v155, v164 op_sel:[1,1,0] op_sel_hi:[1,1,0]
v_fma_mix_f32 v164, v152, v152, v164 op_sel:[0,0,0] op_sel_hi:[1,1,0]
v_fma_mix_f32 v164, v141, v141, v164 op_sel:[1,1,0] op_sel_hi:[1,1,0]
v_fma_mix_f32 v164, v152, v152, v164 op_sel:[1,1,0] op_sel_hi:[1,1,0]
v_fma_mix_f32 v164, v149, v149, v164 op_sel:[0,0,0] op_sel_hi:[1,1,0]
v_fma_mix_f32 v164, v142, v142, v164 op_sel:[0,0,0] op_sel_hi:[1,1,0]
v_fma_mix_f32 v164, v149, v149, v164 op_sel:[1,1,0] op_sel_hi:[1,1,0]
v_fma_mix_f32 v164, v146, v146, v164 op_sel:[0,0,0] op_sel_hi:[1,1,0]
v_fma_mix_f32 v164, v143, v143, v164 op_sel:[1,1,0] op_sel_hi:[1,1,0]
v_fma_mix_f32 v164, v146, v146, v164 op_sel:[1,1,0] op_sel_hi:[1,1,0]
s_setprio 3
v_pk_add_f32 v[168:169], v[0:1], v[2:3]
v_pk_mul_f32 v[170:171], v[0:1], v[0:1]
v_pk_fma_f32 v[170:171], v[2:3], v[2:3], v[170:171]
v_pk_add_f32 v[168:169], v[168:169], v[4:5]
v_pk_fma_f32 v[170:171], v[4:5], v[4:5], v[170:171]
v_pk_add_f32 v[168:169], v[168:169], v[6:7]
v_pk_fma_f32 v[170:171], v[6:7], v[6:7], v[170:171]
v_pk_add_f32 v[168:169], v[168:169], v[8:9]
v_pk_fma_f32 v[170:171], v[8:9], v[8:9], v[170:171]
v_pk_add_f32 v[168:169], v[168:169], v[10:11]
v_pk_fma_f32 v[170:171], v[10:11], v[10:11], v[170:171]
v_pk_add_f32 v[168:169], v[168:169], v[12:13]
v_pk_fma_f32 v[170:171], v[12:13], v[12:13], v[170:171]
v_pk_add_f32 v[168:169], v[168:169], v[14:15]
v_pk_fma_f32 v[170:171], v[14:15], v[14:15], v[170:171]
v_pk_add_f32 v[168:169], v[168:169], v[16:17]
v_pk_fma_f32 v[170:171], v[16:17], v[16:17], v[170:171]
v_pk_add_f32 v[168:169], v[168:169], v[18:19]
v_pk_fma_f32 v[170:171], v[18:19], v[18:19], v[170:171]
v_pk_add_f32 v[168:169], v[168:169], v[20:21]
v_pk_fma_f32 v[170:171], v[20:21], v[20:21], v[170:171]
v_pk_add_f32 v[168:169], v[168:169], v[22:23]
v_pk_fma_f32 v[170:171], v[22:23], v[22:23], v[170:171]
v_pk_add_f32 v[168:169], v[168:169], v[24:25]
v_pk_fma_f32 v[170:171], v[24:25], v[24:25], v[170:171]
v_pk_add_f32 v[168:169], v[168:169], v[26:27]
v_pk_fma_f32 v[170:171], v[26:27], v[26:27], v[170:171]
v_pk_add_f32 v[168:169], v[168:169], v[28:29]
v_pk_fma_f32 v[170:171], v[28:29], v[28:29], v[170:171]
v_pk_add_f32 v[168:169], v[168:169], v[30:31]
v_pk_fma_f32 v[170:171], v[30:31], v[30:31], v[170:171]
v_pk_add_f32 v[168:169], v[168:169], v[32:33]
v_pk_fma_f32 v[170:171], v[32:33], v[32:33], v[170:171]
v_pk_add_f32 v[168:169], v[168:169], v[34:35]
v_pk_fma_f32 v[170:171], v[34:35], v[34:35], v[170:171]
v_pk_add_f32 v[168:169], v[168:169], v[36:37]
v_pk_fma_f32 v[170:171], v[36:37], v[36:37], v[170:171]
v_pk_add_f32 v[168:169], v[168:169], v[38:39]
v_pk_fma_f32 v[170:171], v[38:39], v[38:39], v[170:171]
v_pk_add_f32 v[168:169], v[168:169], v[40:41]
v_pk_fma_f32 v[170:171], v[40:41], v[40:41], v[170:171]
v_pk_add_f32 v[168:169], v[168:169], v[42:43]
v_pk_fma_f32 v[170:171], v[42:43], v[42:43], v[170:171]
v_pk_add_f32 v[168:169], v[168:169], v[44:45]
v_pk_fma_f32 v[170:171], v[44:45], v[44:45], v[170:171]
v_pk_add_f32 v[168:169], v[168:169], v[46:47]
v_pk_fma_f32 v[170:171], v[46:47], v[46:47], v[170:171]
s_setprio 0
v_lshrrev_b32 v240, 2, v251
v_mul_u32_u24 v240, 192, v240
v_and_b32 v252, 3, v251
v_lshl_add_u32 v240, v252, 4, v240
s_setprio 2
v_cvt_pkrtz_f16_f32 v137, v120, v121
v_cvt_pkrtz_f16_f32 v139, v122, v123
v_cvt_pkrtz_f16_f32 v141, v124, v125
v_cvt_pkrtz_f16_f32 v143, v126, v127
v_cvt_pkrtz_f16_f32 v145, v128, v129
v_cvt_pk_f16_f32 v155, v130, v131
v_cvt_pk_f16_f32 v152, v132, v133
v_cvt_pk_f16_f32 v149, v134, v135
ds_read_b128 v[232:235], v249 offset:17408
v_mfma_f32_32x32x16_bf16 v[120:135], v[96:99], v[236:239], 0
v_pk_fma_f16 v154, v155, v155, s48
v_add_f32 v168, v168, v169
v_and_b32 v137, s49, v137
v_pk_fma_f16 v151, v152, v152, s48
v_and_b32_e64 v139, s49, v139
v_pk_fma_f16 v148, v149, v149, s48
v_add_f32_e64 v170, v170, v171
v_pk_mul_f16 v154, v155, v154
v_bfe_u32 v136, v137, 2, 14
v_pk_mul_f16 v151, v152, v151
v_pk_mul_f16 v148, v149, v148
v_bfe_u32 v138, v139, 2, 14
ds_read_b128 v[236:239], v249 offset:18432
ds_read_u16_d16 v136, v136
ds_read_u16_d16 v138, v138
v_mfma_f32_32x32x16_bf16 v[120:135], v[100:103], v[216:219], v[120:135]
v_permlane32_swap_b32 v168, v170
v_exp_f16 v153, v154
v_lshrrev_b32 v137, 18, v137
v_exp_f16 v150, v151
v_add_f32 v168, v168, v170
v_lshrrev_b32 v139, 18, v139
v_exp_f16 v147, v148
v_and_b32 v141, s49, v141
v_and_b32_e64 v143, s49, v143
v_mul_f32 v168, 1009429163, v168
ds_read_b128 v[216:219], v249 offset:21504
ds_read_u16_d16_hi v137, v137
ds_read_u16_d16_hi v139, v139
v_mfma_f32_32x32x16_bf16 v[120:135], v[104:107], v[220:223], v[120:135]
v_exp_f16_sdwa v153, v154 dst_sel:WORD_1 dst_unused:UNUSED_PRESERVE src0_sel:WORD_1
v_bfe_u32 v140, v141, 2, 14
v_exp_f16_sdwa v150, v151 dst_sel:WORD_1 dst_unused:UNUSED_PRESERVE src0_sel:WORD_1
v_mov_b32_e64 v170, v168
v_bfe_u32 v142, v143, 2, 14
v_exp_f16_sdwa v147, v148 dst_sel:WORD_1 dst_unused:UNUSED_PRESERVE src0_sel:WORD_1
v_lshrrev_b32_e64 v141, 18, v141
v_permlane32_swap_b32 v168, v170
v_pk_add_f16 v153, v153, 1.0 op_sel_hi:[1,0]
s_waitcnt lgkmcnt(8)
ds_read_b128 v[220:223], v249 offset:19456
ds_read_u16_d16 v140, v140
ds_read_u16_d16 v142, v142
ds_read_u16_d16_hi v141, v141
v_mfma_f32_32x32x16_bf16 v[120:135], v[108:111], v[224:227], v[120:135]
v_lshrrev_b32_e64 v143, 18, v143
v_pk_add_f16 v150, v150, 1.0 op_sel_hi:[1,0]
v_pk_add_f16 v147, v147, 1.0 op_sel_hi:[1,0]
v_and_b32_e64 v145, s49, v145
v_fma_f32 v170, -v168, v168, v170
v_rcp_f16_e64 v154, v153
v_bfe_u32 v144, v145, 2, 14
v_rcp_f16 v151, v150
v_max_f32 v170, 0, v170
v_lshrrev_b32_e64 v145, 18, v145
ds_read_b128 v[224:227], v249 offset:22528
ds_read_u16_d16_hi v143, v143
ds_read_u16_d16 v144, v144
ds_read_u16_d16_hi v145, v145
v_mfma_f32_32x32x16_bf16 v[120:135], v[112:115], v[228:231], v[120:135]
v_rcp_f16 v148, v147
v_rcp_f16_sdwa v154, v153 dst_sel:WORD_1 dst_unused:UNUSED_PRESERVE src0_sel:WORD_1
v_add_f32 v170, 925353388, v170
s_waitcnt lgkmcnt(8)
v_fma_mix_f32 v165, v136, v136, v165 op_sel:[0,0,0] op_sel_hi:[1,1,0]
ds_read_b32 v247, v253 offset:16
v_fma_mix_f32 v165, v137, v137, v165 op_sel:[1,1,0] op_sel_hi:[1,1,0]
v_rcp_f16_sdwa v151, v150 dst_sel:WORD_1 dst_unused:UNUSED_PRESERVE src0_sel:WORD_1
v_rsq_f32_e64 v170, v170
v_fma_mix_f32 v165, v138, v138, v165 op_sel:[0,0,0] op_sel_hi:[1,1,0]
ds_read_b128 v[228:231], v249 offset:20480
v_mfma_f32_32x32x16_bf16 v[120:135], v[116:119], v[232:235], v[120:135]
v_rcp_f16_sdwa v148, v147 dst_sel:WORD_1 dst_unused:UNUSED_PRESERVE src0_sel:WORD_1
v_fma_mix_f32 v165, v139, v139, v165 op_sel:[1,1,0] op_sel_hi:[1,1,0]
v_pk_mul_f16 v155, v155, v154
s_waitcnt lgkmcnt(6)
v_fma_mix_f32 v165, v140, v140, v165 op_sel:[0,0,0] op_sel_hi:[1,1,0]
v_pk_mul_f16 v152, v152, v151
v_fma_mix_f32 v165, v141, v141, v165 op_sel:[1,1,0] op_sel_hi:[1,1,0]
v_pk_mul_f16 v149, v149, v148
v_fma_mix_f32 v165, v155, v155, v165 op_sel:[0,0,0] op_sel_hi:[1,1,0]
v_mul_f32 v172, 3203391086, v170
v_fma_mix_f32 v165, v142, v142, v165 op_sel:[0,0,0] op_sel_hi:[1,1,0]
v_fma_mix_f32 v165, v155, v155, v165 op_sel:[1,1,0] op_sel_hi:[1,1,0]
s_waitcnt lgkmcnt(2)
v_fma_mix_f32 v165, v143, v143, v165 op_sel:[1,1,0] op_sel_hi:[1,1,0]
v_fma_mix_f32 v165, v152, v152, v165 op_sel:[0,0,0] op_sel_hi:[1,1,0]
v_fma_mix_f32 v165, v152, v152, v165 op_sel:[1,1,0] op_sel_hi:[1,1,0]
v_mul_f32 v173, v168, v172
v_fma_mix_f32 v165, v144, v144, v165 op_sel:[0,0,0] op_sel_hi:[1,1,0]
v_fma_mix_f32 v165, v149, v149, v165 op_sel:[0,0,0] op_sel_hi:[1,1,0]
v_fma_mix_f32 v165, v145, v145, v165 op_sel:[1,1,0] op_sel_hi:[1,1,0]
v_fma_mix_f32 v165, v149, v149, v165 op_sel:[1,1,0] op_sel_hi:[1,1,0]
s_setprio 3
v_pk_fma_f32 v[0:1], v[0:1], v[172:173], v[172:173] op_sel:[0,0,1] op_sel_hi:[1,0,1] neg_lo:[0,0,1] neg_hi:[0,0,1]
v_pk_fma_f32 v[2:3], v[2:3], v[172:173], v[172:173] op_sel:[0,0,1] op_sel_hi:[1,0,1] neg_lo:[0,0,1] neg_hi:[0,0,1]
v_pk_fma_f32 v[4:5], v[4:5], v[172:173], v[172:173] op_sel:[0,0,1] op_sel_hi:[1,0,1] neg_lo:[0,0,1] neg_hi:[0,0,1]
v_pk_fma_f32 v[6:7], v[6:7], v[172:173], v[172:173] op_sel:[0,0,1] op_sel_hi:[1,0,1] neg_lo:[0,0,1] neg_hi:[0,0,1]
v_pk_fma_f32 v[8:9], v[8:9], v[172:173], v[172:173] op_sel:[0,0,1] op_sel_hi:[1,0,1] neg_lo:[0,0,1] neg_hi:[0,0,1]
v_pk_fma_f32 v[10:11], v[10:11], v[172:173], v[172:173] op_sel:[0,0,1] op_sel_hi:[1,0,1] neg_lo:[0,0,1] neg_hi:[0,0,1]
v_pk_fma_f32 v[12:13], v[12:13], v[172:173], v[172:173] op_sel:[0,0,1] op_sel_hi:[1,0,1] neg_lo:[0,0,1] neg_hi:[0,0,1]
v_pk_fma_f32 v[14:15], v[14:15], v[172:173], v[172:173] op_sel:[0,0,1] op_sel_hi:[1,0,1] neg_lo:[0,0,1] neg_hi:[0,0,1]
v_pk_fma_f32 v[16:17], v[16:17], v[172:173], v[172:173] op_sel:[0,0,1] op_sel_hi:[1,0,1] neg_lo:[0,0,1] neg_hi:[0,0,1]
v_pk_fma_f32 v[18:19], v[18:19], v[172:173], v[172:173] op_sel:[0,0,1] op_sel_hi:[1,0,1] neg_lo:[0,0,1] neg_hi:[0,0,1]
v_pk_fma_f32 v[20:21], v[20:21], v[172:173], v[172:173] op_sel:[0,0,1] op_sel_hi:[1,0,1] neg_lo:[0,0,1] neg_hi:[0,0,1]
v_pk_fma_f32 v[22:23], v[22:23], v[172:173], v[172:173] op_sel:[0,0,1] op_sel_hi:[1,0,1] neg_lo:[0,0,1] neg_hi:[0,0,1]
v_pk_fma_f32 v[24:25], v[24:25], v[172:173], v[172:173] op_sel:[0,0,1] op_sel_hi:[1,0,1] neg_lo:[0,0,1] neg_hi:[0,0,1]
v_pk_fma_f32 v[26:27], v[26:27], v[172:173], v[172:173] op_sel:[0,0,1] op_sel_hi:[1,0,1] neg_lo:[0,0,1] neg_hi:[0,0,1]
v_pk_fma_f32 v[28:29], v[28:29], v[172:173], v[172:173] op_sel:[0,0,1] op_sel_hi:[1,0,1] neg_lo:[0,0,1] neg_hi:[0,0,1]
v_pk_fma_f32 v[30:31], v[30:31], v[172:173], v[172:173] op_sel:[0,0,1] op_sel_hi:[1,0,1] neg_lo:[0,0,1] neg_hi:[0,0,1]
v_pk_fma_f32 v[32:33], v[32:33], v[172:173], v[172:173] op_sel:[0,0,1] op_sel_hi:[1,0,1] neg_lo:[0,0,1] neg_hi:[0,0,1]
v_pk_fma_f32 v[34:35], v[34:35], v[172:173], v[172:173] op_sel:[0,0,1] op_sel_hi:[1,0,1] neg_lo:[0,0,1] neg_hi:[0,0,1]
v_pk_fma_f32 v[36:37], v[36:37], v[172:173], v[172:173] op_sel:[0,0,1] op_sel_hi:[1,0,1] neg_lo:[0,0,1] neg_hi:[0,0,1]
v_pk_fma_f32 v[38:39], v[38:39], v[172:173], v[172:173] op_sel:[0,0,1] op_sel_hi:[1,0,1] neg_lo:[0,0,1] neg_hi:[0,0,1]
v_pk_fma_f32 v[40:41], v[40:41], v[172:173], v[172:173] op_sel:[0,0,1] op_sel_hi:[1,0,1] neg_lo:[0,0,1] neg_hi:[0,0,1]
v_pk_fma_f32 v[42:43], v[42:43], v[172:173], v[172:173] op_sel:[0,0,1] op_sel_hi:[1,0,1] neg_lo:[0,0,1] neg_hi:[0,0,1]
v_pk_fma_f32 v[44:45], v[44:45], v[172:173], v[172:173] op_sel:[0,0,1] op_sel_hi:[1,0,1] neg_lo:[0,0,1] neg_hi:[0,0,1]
v_pk_fma_f32 v[46:47], v[46:47], v[172:173], v[172:173] op_sel:[0,0,1] op_sel_hi:[1,0,1] neg_lo:[0,0,1] neg_hi:[0,0,1]
s_setprio 2
s_waitcnt lgkmcnt(0)
v_readfirstlane_b32 s43, v247
s_nop 1
s_cmp_ge_u32 s43, 32
s_cbranch_scc1 Lev8
Lev8w:
s_sleep 1
ds_read_b32 v247, v253 offset:16
s_waitcnt lgkmcnt(0)
v_readfirstlane_b32 s43, v247
s_cmp_eq_u32 s76, 0
s_cbranch_scc1 Lev8
s_sub_u32 s76, s76, 1
s_cmp_lt_u32 s43, 32
s_cbranch_scc1 Lev8w
Lev8:
s_setprio 1
v_cvt_pkrtz_f16_f32 v137, v120, v121
v_cvt_pkrtz_f16_f32 v139, v122, v123
v_cvt_pkrtz_f16_f32 v141, v124, v125
v_cvt_pkrtz_f16_f32 v143, v126, v127
v_cvt_pkrtz_f16_f32 v145, v128, v129
v_cvt_pk_f16_f32 v155, v130, v131
v_cvt_pk_f16_f32 v152, v132, v133
v_cvt_pk_f16_f32 v149, v134, v135
s_add_u32 m0, s72, 0
s_add_u32 s43, s82, 0
buffer_load_dwordx4 v240, s[16:19], s43 offen lds
ds_read_b128 v[232:235], v249 offset:23552
v_mfma_f32_32x32x16_bf16 v[120:135], v[96:99], v[236:239], 0
v_pk_fma_f16 v154, v155, v155, s48
v_cvt_pk_bf16_f32 v168, v0, v1
v_and_b32 v137, s49, v137
v_pk_fma_f16 v151, v152, v152, s48
v_cvt_pk_bf16_f32 v169, v2, v3
v_and_b32_e64 v139, s49, v139
v_pk_fma_f16 v148, v149, v149, s48
v_pk_mul_f16 v154, v155, v154
v_cvt_pk_bf16_f32 v170, v4, v5
v_bfe_u32 v136, v137, 2, 14
v_pk_mul_f16 v151, v152, v151
v_pk_mul_f16 v148, v149, v148
v_cvt_pk_bf16_f32 v171, v6, v7
v_bfe_u32 v138, v139, 2, 14
ds_read_b128 v[236:239], v248 offset:16384
ds_read_u16_d16 v136, v136
ds_read_u16_d16 v138, v138
v_mfma_f32_32x32x16_bf16 v[120:135], v[100:103], v[216:219], v[120:135]
v_exp_f16_e64 v153, v154
v_cvt_pk_bf16_f32 v172, v8, v9
v_lshrrev_b32 v137, 18, v137
v_exp_f16 v150, v151
v_cvt_pk_bf16_f32 v173, v10, v11
v_lshrrev_b32 v139, 18, v139
v_exp_f16 v147, v148
v_cvt_pk_bf16_f32 v174, v12, v13
v_and_b32_e64 v141, s49, v141
v_and_b32 v143, s49, v143
v_cvt_pk_bf16_f32 v175, v14, v15
s_add_u32 m0, s72, 1024
s_add_u32 s43, s82, 64
buffer_load_dwordx4 v240, s[16:19], s43 offen lds
ds_read_b128 v[216:219], v248 offset:19456
ds_read_u16_d16_hi v137, v137
ds_read_u16_d16_hi v139, v139
v_mfma_f32_32x32x16_bf16 v[120:135], v[104:107], v[220:223], v[120:135]
v_exp_f16_sdwa v153, v154 dst_sel:WORD_1 dst_unused:UNUSED_PRESERVE src0_sel:WORD_1
v_bfe_u32 v140, v141, 2, 14
v_cvt_pk_bf16_f32 v176, v16, v17
v_exp_f16_sdwa v150, v151 dst_sel:WORD_1 dst_unused:UNUSED_PRESERVE src0_sel:WORD_1
v_bfe_u32 v142, v143, 2, 14
v_cvt_pk_bf16_f32 v177, v18, v19
v_exp_f16_sdwa v147, v148 dst_sel:WORD_1 dst_unused:UNUSED_PRESERVE src0_sel:WORD_1
v_cvt_pk_bf16_f32 v178, v20, v21
v_lshrrev_b32_e64 v141, 18, v141
v_pk_add_f16 v153, v153, 1.0 op_sel_hi:[1,0]
v_lshrrev_b32_e64 v143, 18, v143
ds_read_b128 v[220:223], v248 offset:17408
ds_read_u16_d16 v140, v140
ds_read_u16_d16 v142, v142
ds_read_u16_d16_hi v141, v141
ds_read_u16_d16_hi v143, v143
v_mfma_f32_32x32x16_bf16 v[120:135], v[108:111], v[224:227], v[120:135]
v_cvt_pk_bf16_f32 v179, v22, v23
v_pk_add_f16 v150, v150, 1.0 op_sel_hi:[1,0]
v_pk_add_f16 v147, v147, 1.0 op_sel_hi:[1,0]
v_and_b32_e64 v145, s49, v145
v_cvt_pk_bf16_f32 v180, v24, v25
v_rcp_f16_e64 v154, v153
v_bfe_u32 v144, v145, 2, 14
v_cvt_pk_bf16_f32 v181, v26, v27
v_rcp_f16 v151, v150
v_lshrrev_b32 v145, 18, v145
v_cvt_pk_bf16_f32 v182, v28, v29
s_add_u32 m0, s72, 2048
s_add_u32 s43, s82, 128
buffer_load_dwordx4 v240, s[16:19], s43 offen lds
ds_read_b128 v[224:227], v248 offset:20480
ds_read_u16_d16 v144, v144
ds_read_u16_d16_hi v145, v145
v_mfma_f32_32x32x16_bf16 v[120:135], v[112:115], v[228:231], v[120:135]
v_rcp_f16 v148, v147
v_cvt_pk_bf16_f32 v183, v30, v31
v_rcp_f16_sdwa v154, v153 dst_sel:WORD_1 dst_unused:UNUSED_PRESERVE src0_sel:WORD_1
s_waitcnt lgkmcnt(5)
v_fma_mix_f32 v166, v136, v136, v166 op_sel:[0,0,0] op_sel_hi:[1,1,0]
v_cvt_pk_bf16_f32 v184, v32, v33
s_setprio 0
v_fma_mix_f32 v166, v137, v137, v166 op_sel:[1,1,0] op_sel_hi:[1,1,0]
v_rcp_f16_sdwa v151, v150 dst_sel:WORD_1 dst_unused:UNUSED_PRESERVE src0_sel:WORD_1
v_cvt_pk_bf16_f32 v185, v34, v35
v_fma_mix_f32 v166, v138, v138, v166 op_sel:[0,0,0] op_sel_hi:[1,1,0]
v_rcp_f16_sdwa v148, v147 dst_sel:WORD_1 dst_unused:UNUSED_PRESERVE src0_sel:WORD_1
v_cvt_pk_bf16_f32 v186, v36, v37
ds_read_b128 v[228:231], v248 offset:18432
v_mfma_f32_32x32x16_bf16 v[120:135], v[116:119], v[232:235], v[120:135]
v_fma_mix_f32 v166, v139, v139, v166 op_sel:[1,1,0] op_sel_hi:[1,1,0]
v_pk_mul_f16 v155, v155, v154
v_fma_mix_f32 v166, v140, v140, v166 op_sel:[0,0,0] op_sel_hi:[1,1,0]
v_cvt_pk_bf16_f32 v187, v38, v39
v_pk_mul_f16 v152, v152, v151
s_waitcnt lgkmcnt(4)
v_fma_mix_f32 v166, v141, v141, v166 op_sel:[1,1,0] op_sel_hi:[1,1,0]
v_cvt_pk_bf16_f32 v188, v40, v41
v_pk_mul_f16 v149, v149, v148
v_fma_mix_f32 v166, v155, v155, v166 op_sel:[0,0,0] op_sel_hi:[1,1,0]
v_fma_mix_f32 v166, v142, v142, v166 op_sel:[0,0,0] op_sel_hi:[1,1,0]
v_cvt_pk_bf16_f32 v189, v42, v43
v_fma_mix_f32 v166, v155, v155, v166 op_sel:[1,1,0] op_sel_hi:[1,1,0]
v_fma_mix_f32 v166, v143, v143, v166 op_sel:[1,1,0] op_sel_hi:[1,1,0]
v_fma_mix_f32 v166, v152, v152, v166 op_sel:[0,0,0] op_sel_hi:[1,1,0]
v_cvt_pk_bf16_f32 v190, v44, v45
v_fma_mix_f32 v166, v152, v152, v166 op_sel:[1,1,0] op_sel_hi:[1,1,0]
s_waitcnt lgkmcnt(1)
v_fma_mix_f32 v166, v144, v144, v166 op_sel:[0,0,0] op_sel_hi:[1,1,0]
v_fma_mix_f32 v166, v149, v149, v166 op_sel:[0,0,0] op_sel_hi:[1,1,0]
v_cvt_pk_bf16_f32 v191, v46, v47
v_fma_mix_f32 v166, v145, v145, v166 op_sel:[1,1,0] op_sel_hi:[1,1,0]
v_fma_mix_f32 v166, v149, v149, v166 op_sel:[1,1,0] op_sel_hi:[1,1,0]
s_setprio 2
v_cvt_pkrtz_f16_f32 v137, v120, v121
v_cvt_pkrtz_f16_f32 v139, v122, v123
v_cvt_pkrtz_f16_f32 v141, v124, v125
v_cvt_pkrtz_f16_f32 v143, v126, v127
v_cvt_pkrtz_f16_f32 v145, v128, v129
v_cvt_pk_f16_f32 v155, v130, v131
v_cvt_pk_f16_f32 v152, v132, v133
v_cvt_pk_f16_f32 v149, v134, v135
s_add_u32 m0, s72, 3072
s_add_u32 s43, s82, 3072
buffer_load_dwordx4 v240, s[16:19], s43 offen lds
ds_read_b128 v[232:235], v248 offset:21504
v_mfma_f32_32x32x16_bf16 v[120:135], v[236:239], v[168:171], 0
v_pk_fma_f16 v154, v155, v155, s48
v_and_b32 v247, 1, v251
v_and_b32 v137, s49, v137
v_pk_fma_f16 v151, v152, v152, s48
v_and_b32 v139, s49, v139
v_lshlrev_b32 v247, 4, v247
v_pk_fma_f16 v148, v149, v149, s48
v_pk_mul_f16 v154, v155, v154
v_bfe_u32 v136, v137, 2, 14
v_mov_b32 v252, 15360
v_pk_mul_f16 v151, v152, v151
v_pk_mul_f16 v148, v149, v148
v_bfe_u32 v138, v139, 2, 14
ds_read_b128 v[236:239], v248 offset:22528
ds_read_u16_d16 v136, v136
ds_read_u16_d16 v138, v138
v_mfma_f32_32x32x16_bf16 v[120:135], v[216:219], v[172:175], v[120:135]
v_exp_f16 v153, v154
v_lshlrev_b32 v247, v247, v252
v_lshrrev_b32 v137, 18, v137
v_exp_f16 v150, v151
v_lshrrev_b32 v252, 3, v251
v_lshrrev_b32 v139, 18, v139
v_exp_f16 v147, v148
v_xor_b32 v252, v252, v251
v_and_b32 v141, s49, v141
v_and_b32 v143, s49, v143
s_add_u32 m0, s72, 4096
s_add_u32 s43, s82, 3136
buffer_load_dwordx4 v240, s[16:19], s43 offen lds
ds_read_b128 v[216:219], v248 offset:25600
ds_read_u16_d16_hi v137, v137
ds_read_u16_d16_hi v139, v139
v_mfma_f32_32x32x16_bf16 v[120:135], v[220:223], v[176:179], v[120:135]
v_exp_f16_sdwa v153, v154 dst_sel:WORD_1 dst_unused:UNUSED_PRESERVE src0_sel:WORD_1
v_and_b32_e64 v252, 4, v252
v_bfe_u32 v140, v141, 2, 14
v_exp_f16_sdwa v150, v151 dst_sel:WORD_1 dst_unused:UNUSED_PRESERVE src0_sel:WORD_1
v_bfe_u32 v253, v251, 3, 2
v_bfe_u32 v142, v143, 2, 14
v_exp_f16_sdwa v147, v148 dst_sel:WORD_1 dst_unused:UNUSED_PRESERVE src0_sel:WORD_1
v_lshl_add_u32 v252, v252, 1, 0
v_lshrrev_b32_e64 v141, 18, v141
v_pk_add_f16 v153, v153, 1.0 op_sel_hi:[1,0]
v_lshrrev_b32_e64 v143, 18, v143
ds_read_b128 v[220:223], v248 offset:23552
ds_read_u16_d16 v140, v140
ds_read_u16_d16 v142, v142
ds_read_u16_d16_hi v141, v141
ds_read_u16_d16_hi v143, v143
v_mfma_f32_32x32x16_bf16 v[120:135], v[224:227], v[180:183], v[120:135]
v_lshl_add_u32 v252, v253, 1, v252
v_pk_add_f16 v150, v150, 1.0 op_sel_hi:[1,0]
v_pk_add_f16 v147, v147, 1.0 op_sel_hi:[1,0]
v_and_b32_e64 v145, s49, v145
v_bfe_u32 v253, v251, 1, 1
v_rcp_f16_e64 v154, v153
v_bfe_u32 v144, v145, 2, 14
v_add_u32 v252, v252, v253
v_rcp_f16 v151, v150
v_lshrrev_b32_e64 v145, 18, v145
v_rcp_f16 v148, v147
s_waitcnt lgkmcnt(5)
s_add_u32 m0, s72, 5120
s_add_u32 s43, s82, 3200
buffer_load_dwordx4 v240, s[16:19], s43 offen lds
ds_read_b128 v[224:227], v248 offset:26624
ds_read_u16_d16 v144, v144
ds_read_u16_d16_hi v145, v145
v_mfma_f32_32x32x16_bf16 v[120:135], v[228:231], v[184:187], v[120:135]
v_cmp_eq_u32 vcc, 0, v252
s_nop 1
v_cndmask_b32 v208, 0, v247, vcc
v_rcp_f16_sdwa v154, v153 dst_sel:WORD_1 dst_unused:UNUSED_PRESERVE src0_sel:WORD_1
v_cmp_eq_u32 vcc, 1, v252
s_nop 1
v_cndmask_b32 v209, 0, v247, vcc
v_fma_mix_f32 v167, v136, v136, v167 op_sel:[0,0,0] op_sel_hi:[1,1,0]
v_fma_mix_f32 v167, v137, v137, v167 op_sel:[1,1,0] op_sel_hi:[1,1,0]
v_rcp_f16_sdwa v151, v150 dst_sel:WORD_1 dst_unused:UNUSED_PRESERVE src0_sel:WORD_1
v_cmp_eq_u32 vcc, 2, v252
s_nop 1
v_cndmask_b32 v210, 0, v247, vcc
v_fma_mix_f32 v167, v138, v138, v167 op_sel:[0,0,0] op_sel_hi:[1,1,0]
v_rcp_f16_sdwa v148, v147 dst_sel:WORD_1 dst_unused:UNUSED_PRESERVE src0_sel:WORD_1
v_cmp_eq_u32 vcc, 3, v252
s_nop 1
v_cndmask_b32 v211, 0, v247, vcc
ds_read_b128 v[228:231], v248 offset:24576
v_mfma_f32_32x32x16_bf16 v[120:135], v[232:235], v[188:191], v[120:135]
v_fma_mix_f32 v167, v139, v139, v167 op_sel:[1,1,0] op_sel_hi:[1,1,0]
v_pk_mul_f16 v155, v155, v154
s_waitcnt lgkmcnt(1)
v_fma_mix_f32 v167, v140, v140, v167 op_sel:[0,0,0] op_sel_hi:[1,1,0]
v_cmp_eq_u32 vcc, 4, v252
s_nop 1
v_cndmask_b32 v212, 0, v247, vcc
v_pk_mul_f16 v152, v152, v151
v_fma_mix_f32 v167, v141, v141, v167 op_sel:[1,1,0] op_sel_hi:[1,1,0]
v_pk_mul_f16 v149, v149, v148
v_cmp_eq_u32 vcc, 5, v252
s_nop 1
v_cndmask_b32 v213, 0, v247, vcc
v_fma_mix_f32 v167, v155, v155, v167 op_sel:[0,0,0] op_sel_hi:[1,1,0]
v_fma_mix_f32 v167, v142, v142, v167 op_sel:[0,0,0] op_sel_hi:[1,1,0]
v_fma_mix_f32 v167, v155, v155, v167 op_sel:[1,1,0] op_sel_hi:[1,1,0]
v_fma_mix_f32 v167, v143, v143, v167 op_sel:[1,1,0] op_sel_hi:[1,1,0]
v_cmp_eq_u32 vcc, 6, v252
s_nop 1
v_cndmask_b32 v214, 0, v247, vcc
v_fma_mix_f32 v167, v152, v152, v167 op_sel:[0,0,0] op_sel_hi:[1,1,0]
v_fma_mix_f32 v167, v152, v152, v167 op_sel:[1,1,0] op_sel_hi:[1,1,0]
v_fma_mix_f32 v167, v144, v144, v167 op_sel:[0,0,0] op_sel_hi:[1,1,0]
v_cmp_eq_u32 vcc, 7, v252
s_nop 1
v_cndmask_b32 v215, 0, v247, vcc
v_fma_mix_f32 v167, v149, v149, v167 op_sel:[0,0,0] op_sel_hi:[1,1,0]
v_fma_mix_f32 v167, v145, v145, v167 op_sel:[1,1,0] op_sel_hi:[1,1,0]
v_fma_mix_f32 v167, v149, v149, v167 op_sel:[1,1,0] op_sel_hi:[1,1,0]
s_setprio 1
v_cvt_pkrtz_f16_f32 v137, v120, v121
v_cvt_pkrtz_f16_f32 v139, v122, v123
v_cvt_pkrtz_f16_f32 v141, v124, v125
v_cvt_pkrtz_f16_f32 v143, v126, v127
v_cvt_pkrtz_f16_f32 v145, v128, v129
v_cvt_pk_f16_f32 v155, v130, v131
v_cvt_pk_f16_f32 v152, v132, v133
v_cvt_pk_f16_f32 v149, v134, v135
s_add_u32 m0, s72, 6144
s_add_u32 s43, s82, 6144
buffer_load_dwordx4 v240, s[16:19], s43 offen lds
ds_read_b128 v[232:235], v248 offset:27648
v_mfma_f32_32x32x16_bf16 v[120:135], v[236:239], v[168:171], 0
v_pk_fma_f16 v154, v155, v155, s48
v_and_b32_e64 v137, s49, v137
v_pk_fma_f16 v151, v152, v152, s48
v_and_b32_e64 v139, s49, v139
v_pk_fma_f16 v148, v149, v149, s48
v_pk_mul_f16 v154, v155, v154
v_bfe_u32 v136, v137, 2, 14
v_pk_mul_f16 v151, v152, v151
ds_read_b128 v[236:239], v248 offset:28672
ds_read_u16_d16 v136, v136
v_mfma_f32_32x32x16_bf16 v[120:135], v[216:219], v[172:175], v[120:135]
v_pk_mul_f16 v148, v149, v148
v_bfe_u32 v138, v139, 2, 14
v_exp_f16 v153, v154
v_lshrrev_b32 v137, 18, v137
v_exp_f16 v150, v151
v_lshrrev_b32 v139, 18, v139
ds_read_b128 v[216:219], v248 offset:31744
ds_read_u16_d16 v138, v138
ds_read_u16_d16_hi v137, v137
ds_read_u16_d16_hi v139, v139
v_mfma_f32_32x32x16_bf16 v[120:135], v[220:223], v[176:179], v[120:135]
v_exp_f16 v147, v148
v_and_b32 v141, s49, v141
v_and_b32_e64 v143, s49, v143
v_exp_f16_sdwa v153, v154 dst_sel:WORD_1 dst_unused:UNUSED_PRESERVE src0_sel:WORD_1
v_bfe_u32 v140, v141, 2, 14
v_exp_f16_sdwa v150, v151 dst_sel:WORD_1 dst_unused:UNUSED_PRESERVE src0_sel:WORD_1
ds_read_b128 v[220:223], v248 offset:29696
ds_read_u16_d16 v140, v140
v_mfma_f32_32x32x16_bf16 v[120:135], v[224:227], v[180:183], v[120:135]
v_bfe_u32 v142, v143, 2, 14
v_exp_f16_sdwa v147, v148 dst_sel:WORD_1 dst_unused:UNUSED_PRESERVE src0_sel:WORD_1
v_lshrrev_b32_e64 v141, 18, v141
v_pk_add_f16 v153, v153, 1.0 op_sel_hi:[1,0]
v_lshrrev_b32 v143, 18, v143
v_pk_add_f16 v150, v150, 1.0 op_sel_hi:[1,0]
v_pk_add_f16 v147, v147, 1.0 op_sel_hi:[1,0]
s_waitcnt lgkmcnt(6)
ds_read_b128 v[224:227], v248 offset:32768
ds_read_u16_d16 v142, v142
ds_read_u16_d16_hi v141, v141
ds_read_u16_d16_hi v143, v143
v_mfma_f32_32x32x16_bf16 v[120:135], v[228:231], v[184:187], v[120:135]
v_and_b32 v145, s49, v145
v_rcp_f16 v154, v153
v_bfe_u32 v144, v145, 2, 14
s_setprio 0
v_rcp_f16 v151, v150
v_lshrrev_b32_e64 v145, 18, v145
ds_read_b128 v[228:231], v248 offset:30720
ds_read_u16_d16 v144, v144
ds_read_u16_d16_hi v145, v145
v_mfma_f32_32x32x16_bf16 v[120:135], v[232:235], v[188:191], v[120:135]
v_rcp_f16 v148, v147
s_waitcnt lgkmcnt(7)
v_or_b32 v0, v136, v137
v_or_b32 v1, v138, v139
v_rcp_f16_sdwa v154, v153 dst_sel:WORD_1 dst_unused:UNUSED_PRESERVE src0_sel:WORD_1
s_waitcnt lgkmcnt(4)
v_or_b32 v2, v140, v141
v_rcp_f16_sdwa v151, v150 dst_sel:WORD_1 dst_unused:UNUSED_PRESERVE src0_sel:WORD_1
s_waitcnt lgkmcnt(3)
v_or_b32 v3, v142, v143
v_rcp_f16_sdwa v148, v147 dst_sel:WORD_1 dst_unused:UNUSED_PRESERVE src0_sel:WORD_1
s_waitcnt lgkmcnt(0)
v_or_b32_e64 v4, v144, v145
v_pk_mul_f16 v5, v155, v154
v_pk_mul_f16 v6, v152, v151
v_pk_mul_f16 v7, v149, v148
s_setprio 2
ds_read_b128 v[232:235], v248 offset:33792
v_mfma_f32_32x32x16_f16 v[192:207], v[0:3], v[208:211], 0
v_cvt_pkrtz_f16_f32 v137, v120, v121
v_cvt_pkrtz_f16_f32 v139, v122, v123
v_cvt_pkrtz_f16_f32 v141, v124, v125
v_cvt_pkrtz_f16_f32 v143, v126, v127
v_cvt_pkrtz_f16_f32 v145, v128, v129
v_mfma_f32_32x32x16_f16 v[192:207], v[4:7], v[212:215], v[192:207]
v_cvt_pk_f16_f32 v155, v130, v131
v_cvt_pk_f16_f32 v152, v132, v133
v_cvt_pk_f16_f32 v149, v134, v135
v_pk_fma_f16 v154, v155, v155, s48
v_and_b32_e64 v137, s49, v137
v_pk_fma_f16 v151, v152, v152, s48
v_mfma_f32_32x32x16_bf16 v[120:135], v[236:239], v[168:171], 0
v_and_b32 v139, s49, v139
v_pk_fma_f16 v148, v149, v149, s48
v_permlane16_swap_b32 v0, v4
v_pk_mul_f16 v154, v155, v154
v_bfe_u32 v136, v137, 2, 14
v_permlane16_swap_b32 v1, v5
v_pk_mul_f16 v151, v152, v151
v_pk_mul_f16 v148, v149, v148
v_bfe_u32 v138, v139, 2, 14
v_permlane16_swap_b32 v2, v6
ds_read_b128 v[236:239], v248 offset:34816
ds_read_u16_d16 v136, v136
ds_read_u16_d16 v138, v138
v_mfma_f32_32x32x16_bf16 v[120:135], v[216:219], v[172:175], v[120:135]
v_exp_f16 v153, v154
v_permlane16_swap_b32 v3, v7
v_lshrrev_b32 v137, 18, v137
v_exp_f16 v150, v151
v_fmac_f32 v156, v192, v192
v_lshrrev_b32 v139, 18, v139
v_exp_f16 v147, v148
v_fmac_f32 v156, v193, v193
v_and_b32_e64 v141, s49, v141
ds_read_b128 v[216:219], v248 offset:37888
ds_read_u16_d16_hi v137, v137
ds_read_u16_d16_hi v139, v139
v_mfma_f32_32x32x16_bf16 v[120:135], v[220:223], v[176:179], v[120:135]
v_and_b32 v143, s49, v143
v_fmac_f32 v156, v194, v194
v_exp_f16_sdwa v153, v154 dst_sel:WORD_1 dst_unused:UNUSED_PRESERVE src0_sel:WORD_1
v_bfe_u32 v140, v141, 2, 14
v_fmac_f32_e64 v156, v195, v195
v_exp_f16_sdwa v150, v151 dst_sel:WORD_1 dst_unused:UNUSED_PRESERVE src0_sel:WORD_1
v_fmac_f32_e64 v156, v196, v196
v_bfe_u32 v142, v143, 2, 14
ds_read_b128 v[220:223], v248 offset:35840
ds_read_u16_d16 v140, v140
ds_read_u16_d16 v142, v142
v_mfma_f32_32x32x16_bf16 v[120:135], v[224:227], v[180:183], v[120:135]
v_exp_f16_sdwa v147, v148 dst_sel:WORD_1 dst_unused:UNUSED_PRESERVE src0_sel:WORD_1
v_fmac_f32 v156, v197, v197
v_lshrrev_b32 v141, 18, v141
v_pk_add_f16 v153, v153, 1.0 op_sel_hi:[1,0]
v_lshrrev_b32 v143, 18, v143
v_fmac_f32 v156, v198, v198
v_pk_add_f16 v150, v150, 1.0 op_sel_hi:[1,0]
v_pk_add_f16 v147, v147, 1.0 op_sel_hi:[1,0]
v_fmac_f32 v156, v199, v199
v_and_b32 v145, s49, v145
ds_read_b128 v[224:227], v248 offset:38912
ds_read_u16_d16_hi v141, v141
ds_read_u16_d16_hi v143, v143
v_mfma_f32_32x32x16_bf16 v[120:135], v[228:231], v[184:187], v[120:135]
v_rcp_f16 v154, v153
v_fmac_f32 v156, v200, v200
v_bfe_u32 v144, v145, 2, 14
v_rcp_f16 v151, v150
v_fmac_f32 v156, v201, v201
v_lshrrev_b32 v145, 18, v145
v_rcp_f16 v148, v147
v_fmac_f32_e64 v156, v202, v202
ds_read_u16_d16 v144, v144
ds_read_u16_d16_hi v145, v145
s_waitcnt lgkmcnt(5)
v_or_b32 v8, v136, v137
ds_read_b128 v[228:231], v248 offset:36864
v_mfma_f32_32x32x16_bf16 v[120:135], v[232:235], v[188:191], v[120:135]
v_or_b32 v9, v138, v139
v_fmac_f32 v156, v203, v203
v_rcp_f16_sdwa v154, v153 dst_sel:WORD_1 dst_unused:UNUSED_PRESERVE src0_sel:WORD_1
v_fmac_f32 v156, v204, v204
s_waitcnt lgkmcnt(4)
v_or_b32_e64 v10, v140, v141
v_rcp_f16_sdwa v151, v150 dst_sel:WORD_1 dst_unused:UNUSED_PRESERVE src0_sel:WORD_1
v_fmac_f32 v156, v205, v205
s_waitcnt lgkmcnt(3)
v_or_b32_e64 v11, v142, v143
v_rcp_f16_sdwa v148, v147 dst_sel:WORD_1 dst_unused:UNUSED_PRESERVE src0_sel:WORD_1
v_fmac_f32 v156, v206, v206
s_waitcnt lgkmcnt(1)
v_or_b32_e64 v12, v144, v145
v_pk_mul_f16 v13, v155, v154
v_fmac_f32_e64 v156, v207, v207
v_pk_mul_f16 v14, v152, v151
v_pk_mul_f16 v15, v149, v148
s_cmp_lg_u32 s40, 0
s_cbranch_scc1 Lrs0
v_lshlrev_b32_e64 v89, 2, v251
v_mov_b32 v90, 0
buffer_load_dword v244, v89, s[24:27], 0 offen offset:0
buffer_load_dword v245, v89, s[24:27], 0 offen offset:256
buffer_load_dword v246, v89, s[24:27], 0 offen offset:512
buffer_load_dword v91, v90, s[36:39], 0 offen sc1
Lrs0:
s_setprio 1
ds_read_b128 v[232:235], v248 offset:39936
v_mfma_f32_32x32x16_f16 v[192:207], v[8:11], v[208:211], 0
v_cvt_pkrtz_f16_f32 v137, v120, v121
v_cvt_pkrtz_f16_f32 v139, v122, v123
v_cvt_pkrtz_f16_f32 v141, v124, v125
v_cvt_pkrtz_f16_f32 v143, v126, v127
v_cvt_pkrtz_f16_f32 v145, v128, v129
v_mfma_f32_32x32x16_f16 v[192:207], v[12:15], v[212:215], v[192:207]
v_cvt_pk_f16_f32 v155, v130, v131
v_cvt_pk_f16_f32 v152, v132, v133
v_cvt_pk_f16_f32 v149, v134, v135
v_pk_fma_f16 v154, v155, v155, s48
v_and_b32_e64 v137, s49, v137
v_pk_fma_f16 v151, v152, v152, s48
v_mfma_f32_32x32x16_bf16 v[120:135], v[236:239], v[168:171], 0
v_and_b32 v139, s49, v139
v_pk_fma_f16 v148, v149, v149, s48
v_permlane16_swap_b32 v8, v12
v_pk_mul_f16 v154, v155, v154
v_bfe_u32 v136, v137, 2, 14
v_permlane16_swap_b32 v9, v13
v_pk_mul_f16 v151, v152, v151
v_pk_mul_f16 v148, v149, v148
v_bfe_u32 v138, v139, 2, 14
v_permlane16_swap_b32 v10, v14
ds_read_b128 v[236:239], v248 offset:40960
ds_read_u16_d16 v136, v136
ds_read_u16_d16 v138, v138
v_mfma_f32_32x32x16_bf16 v[120:135], v[216:219], v[172:175], v[120:135]
v_exp_f16 v153, v154
v_permlane16_swap_b32 v11, v15
v_lshrrev_b32 v137, 18, v137
v_exp_f16 v150, v151
v_fmac_f32 v157, v192, v192
v_lshrrev_b32 v139, 18, v139
v_exp_f16 v147, v148
v_fmac_f32 v157, v193, v193
v_and_b32_e64 v141, s49, v141
ds_read_b128 v[216:219], v248 offset:44032
ds_read_u16_d16_hi v137, v137
ds_read_u16_d16_hi v139, v139
v_mfma_f32_32x32x16_bf16 v[120:135], v[220:223], v[176:179], v[120:135]
v_and_b32 v143, s49, v143
v_fmac_f32 v157, v194, v194
v_exp_f16_sdwa v153, v154 dst_sel:WORD_1 dst_unused:UNUSED_PRESERVE src0_sel:WORD_1
v_bfe_u32 v140, v141, 2, 14
v_fmac_f32_e64 v157, v195, v195
v_exp_f16_sdwa v150, v151 dst_sel:WORD_1 dst_unused:UNUSED_PRESERVE src0_sel:WORD_1
v_fmac_f32_e64 v157, v196, v196
v_bfe_u32 v142, v143, 2, 14
ds_read_b128 v[220:223], v248 offset:41984
ds_read_u16_d16 v140, v140
ds_read_u16_d16 v142, v142
v_mfma_f32_32x32x16_bf16 v[120:135], v[224:227], v[180:183], v[120:135]
v_exp_f16_sdwa v147, v148 dst_sel:WORD_1 dst_unused:UNUSED_PRESERVE src0_sel:WORD_1
v_fmac_f32 v157, v197, v197
v_lshrrev_b32 v141, 18, v141
v_pk_add_f16 v153, v153, 1.0 op_sel_hi:[1,0]
v_lshrrev_b32 v143, 18, v143
v_fmac_f32 v157, v198, v198
v_pk_add_f16 v150, v150, 1.0 op_sel_hi:[1,0]
v_pk_add_f16 v147, v147, 1.0 op_sel_hi:[1,0]
v_fmac_f32_e64 v157, v199, v199
v_and_b32 v145, s49, v145
s_waitcnt lgkmcnt(4)
ds_read_b128 v[224:227], v248 offset:45056
ds_read_u16_d16_hi v141, v141
ds_read_u16_d16_hi v143, v143
v_mfma_f32_32x32x16_bf16 v[120:135], v[228:231], v[184:187], v[120:135]
v_rcp_f16 v154, v153
v_fmac_f32 v157, v200, v200
v_bfe_u32 v144, v145, 2, 14
v_rcp_f16 v151, v150
s_setprio 0
v_fmac_f32 v157, v201, v201
v_lshrrev_b32 v145, 18, v145
v_rcp_f16 v148, v147
v_fmac_f32 v157, v202, v202
ds_read_u16_d16 v144, v144
ds_read_u16_d16_hi v145, v145
v_or_b32_e64 v16, v136, v137
ds_read_b128 v[228:231], v248 offset:43008
v_mfma_f32_32x32x16_bf16 v[120:135], v[232:235], v[188:191], v[120:135]
s_waitcnt lgkmcnt(6)
v_or_b32 v17, v138, v139
v_fmac_f32_e64 v157, v203, v203
v_rcp_f16_sdwa v154, v153 dst_sel:WORD_1 dst_unused:UNUSED_PRESERVE src0_sel:WORD_1
v_fmac_f32 v157, v204, v204
s_waitcnt lgkmcnt(4)
v_or_b32_e64 v18, v140, v141
v_rcp_f16_sdwa v151, v150 dst_sel:WORD_1 dst_unused:UNUSED_PRESERVE src0_sel:WORD_1
v_fmac_f32 v157, v205, v205
s_waitcnt lgkmcnt(3)
v_or_b32_e64 v19, v142, v143
v_rcp_f16_sdwa v148, v147 dst_sel:WORD_1 dst_unused:UNUSED_PRESERVE src0_sel:WORD_1
v_fmac_f32 v157, v206, v206
s_waitcnt lgkmcnt(1)
v_or_b32_e64 v20, v144, v145
v_pk_mul_f16 v21, v155, v154
v_fmac_f32 v157, v207, v207
v_pk_mul_f16 v22, v152, v151
v_pk_mul_f16 v23, v149, v148
s_setprio 2
ds_read_b128 v[232:235], v248 offset:46080
v_mfma_f32_32x32x16_f16 v[192:207], v[16:19], v[208:211], 0
v_cvt_pkrtz_f16_f32 v137, v120, v121
v_cvt_pkrtz_f16_f32 v139, v122, v123
v_cvt_pkrtz_f16_f32 v141, v124, v125
v_cvt_pkrtz_f16_f32 v143, v126, v127
v_cvt_pkrtz_f16_f32 v145, v128, v129
v_mfma_f32_32x32x16_f16 v[192:207], v[20:23], v[212:215], v[192:207]
v_cvt_pk_f16_f32 v155, v130, v131
v_cvt_pk_f16_f32 v152, v132, v133
v_cvt_pk_f16_f32 v149, v134, v135
v_pk_fma_f16 v154, v155, v155, s48
v_and_b32_e64 v137, s49, v137
v_pk_fma_f16 v151, v152, v152, s48
v_mfma_f32_32x32x16_bf16 v[120:135], v[236:239], v[168:171], 0
v_and_b32 v139, s49, v139
v_pk_fma_f16 v148, v149, v149, s48
v_permlane16_swap_b32 v16, v20
v_pk_mul_f16 v154, v155, v154
v_bfe_u32 v136, v137, 2, 14
v_permlane16_swap_b32 v17, v21
v_pk_mul_f16 v151, v152, v151
v_pk_mul_f16 v148, v149, v148
v_bfe_u32 v138, v139, 2, 14
v_permlane16_swap_b32 v18, v22
ds_read_b128 v[236:239], v248 offset:47104
ds_read_u16_d16 v136, v136
ds_read_u16_d16 v138, v138
v_mfma_f32_32x32x16_bf16 v[120:135], v[216:219], v[172:175], v[120:135]
v_exp_f16 v153, v154
v_permlane16_swap_b32 v19, v23
v_lshrrev_b32 v137, 18, v137
v_exp_f16 v150, v151
v_fmac_f32 v158, v192, v192
v_lshrrev_b32 v139, 18, v139
v_exp_f16 v147, v148
v_fmac_f32 v158, v193, v193
v_and_b32_e64 v141, s49, v141
ds_read_b128 v[216:219], v248 offset:50176
ds_read_u16_d16_hi v137, v137
ds_read_u16_d16_hi v139, v139
v_mfma_f32_32x32x16_bf16 v[120:135], v[220:223], v[176:179], v[120:135]
v_and_b32 v143, s49, v143
v_fmac_f32 v158, v194, v194
v_exp_f16_sdwa v153, v154 dst_sel:WORD_1 dst_unused:UNUSED_PRESERVE src0_sel:WORD_1
v_bfe_u32 v140, v141, 2, 14
v_fmac_f32_e64 v158, v195, v195
v_exp_f16_sdwa v150, v151 dst_sel:WORD_1 dst_unused:UNUSED_PRESERVE src0_sel:WORD_1
v_fmac_f32_e64 v158, v196, v196
v_bfe_u32 v142, v143, 2, 14
ds_read_b128 v[220:223], v248 offset:48128
ds_read_u16_d16 v140, v140
ds_read_u16_d16 v142, v142
v_mfma_f32_32x32x16_bf16 v[120:135], v[224:227], v[180:183], v[120:135]
v_exp_f16_sdwa v147, v148 dst_sel:WORD_1 dst_unused:UNUSED_PRESERVE src0_sel:WORD_1
v_fmac_f32 v158, v197, v197
v_lshrrev_b32 v141, 18, v141
v_pk_add_f16 v153, v153, 1.0 op_sel_hi:[1,0]
v_lshrrev_b32 v143, 18, v143
v_fmac_f32 v158, v198, v198
v_pk_add_f16 v150, v150, 1.0 op_sel_hi:[1,0]
v_pk_add_f16 v147, v147, 1.0 op_sel_hi:[1,0]
v_fmac_f32_e64 v158, v199, v199
v_and_b32 v145, s49, v145
s_waitcnt lgkmcnt(4)
ds_read_b128 v[224:227], v248 offset:51200
ds_read_u16_d16_hi v141, v141
ds_read_u16_d16_hi v143, v143
v_mfma_f32_32x32x16_bf16 v[120:135], v[228:231], v[184:187], v[120:135]
v_rcp_f16 v154, v153
v_fmac_f32 v158, v200, v200
v_bfe_u32 v144, v145, 2, 14
v_rcp_f16 v151, v150
v_fmac_f32 v158, v201, v201
v_lshrrev_b32 v145, 18, v145
v_rcp_f16 v148, v147
v_fmac_f32_e64 v158, v202, v202
ds_read_u16_d16 v144, v144
ds_read_u16_d16_hi v145, v145
v_or_b32_e64 v24, v136, v137
ds_read_b128 v[228:231], v248 offset:49152
v_mfma_f32_32x32x16_bf16 v[120:135], v[232:235], v[188:191], v[120:135]
s_waitcnt lgkmcnt(6)
v_or_b32 v25, v138, v139
v_fmac_f32_e64 v158, v203, v203
v_rcp_f16_sdwa v154, v153 dst_sel:WORD_1 dst_unused:UNUSED_PRESERVE src0_sel:WORD_1
v_fmac_f32 v158, v204, v204
s_waitcnt lgkmcnt(4)
v_or_b32_e64 v26, v140, v141
v_rcp_f16_sdwa v151, v150 dst_sel:WORD_1 dst_unused:UNUSED_PRESERVE src0_sel:WORD_1
v_fmac_f32 v158, v205, v205
s_waitcnt lgkmcnt(3)
v_or_b32_e64 v27, v142, v143
v_rcp_f16_sdwa v148, v147 dst_sel:WORD_1 dst_unused:UNUSED_PRESERVE src0_sel:WORD_1
v_fmac_f32 v158, v206, v206
s_waitcnt lgkmcnt(1)
v_or_b32_e64 v28, v144, v145
v_pk_mul_f16 v29, v155, v154
v_fmac_f32 v158, v207, v207
v_pk_mul_f16 v30, v152, v151
v_pk_mul_f16 v31, v149, v148
s_setprio 1
ds_read_b128 v[232:235], v248 offset:52224
v_mfma_f32_32x32x16_f16 v[192:207], v[24:27], v[208:211], 0
v_cvt_pkrtz_f16_f32 v137, v120, v121
v_cvt_pkrtz_f16_f32 v139, v122, v123
v_cvt_pkrtz_f16_f32 v141, v124, v125
v_cvt_pkrtz_f16_f32 v143, v126, v127
v_cvt_pkrtz_f16_f32 v145, v128, v129
v_mfma_f32_32x32x16_f16 v[192:207], v[28:31], v[212:215], v[192:207]
v_cvt_pk_f16_f32 v155, v130, v131
v_cvt_pk_f16_f32 v152, v132, v133
v_cvt_pk_f16_f32 v149, v134, v135
v_pk_fma_f16 v154, v155, v155, s48
v_and_b32_e64 v137, s49, v137
v_pk_fma_f16 v151, v152, v152, s48
v_mfma_f32_32x32x16_bf16 v[120:135], v[236:239], v[168:171], 0
v_and_b32 v139, s49, v139
v_pk_fma_f16 v148, v149, v149, s48
v_permlane16_swap_b32 v24, v28
v_pk_mul_f16 v154, v155, v154
v_bfe_u32 v136, v137, 2, 14
v_permlane16_swap_b32 v25, v29
v_pk_mul_f16 v151, v152, v151
v_pk_mul_f16 v148, v149, v148
v_bfe_u32 v138, v139, 2, 14
v_permlane16_swap_b32 v26, v30
ds_read_b128 v[236:239], v248 offset:53248
ds_read_u16_d16 v136, v136
ds_read_u16_d16 v138, v138
v_mfma_f32_32x32x16_bf16 v[120:135], v[216:219], v[172:175], v[120:135]
v_exp_f16 v153, v154
v_permlane16_swap_b32 v27, v31
v_lshrrev_b32 v137, 18, v137
v_exp_f16 v150, v151
v_fmac_f32 v159, v192, v192
v_lshrrev_b32 v139, 18, v139
v_exp_f16 v147, v148
v_fmac_f32 v159, v193, v193
v_and_b32_e64 v141, s49, v141
ds_read_b128 v[216:219], v248 offset:56320
ds_read_u16_d16_hi v137, v137
ds_read_u16_d16_hi v139, v139
v_mfma_f32_32x32x16_bf16 v[120:135], v[220:223], v[176:179], v[120:135]
v_and_b32 v143, s49, v143
v_fmac_f32 v159, v194, v194
v_exp_f16_sdwa v153, v154 dst_sel:WORD_1 dst_unused:UNUSED_PRESERVE src0_sel:WORD_1
v_bfe_u32 v140, v141, 2, 14
v_fmac_f32_e64 v159, v195, v195
v_exp_f16_sdwa v150, v151 dst_sel:WORD_1 dst_unused:UNUSED_PRESERVE src0_sel:WORD_1
v_fmac_f32_e64 v159, v196, v196
v_bfe_u32 v142, v143, 2, 14
ds_read_b128 v[220:223], v248 offset:54272
ds_read_u16_d16 v140, v140
ds_read_u16_d16 v142, v142
v_mfma_f32_32x32x16_bf16 v[120:135], v[224:227], v[180:183], v[120:135]
v_exp_f16_sdwa v147, v148 dst_sel:WORD_1 dst_unused:UNUSED_PRESERVE src0_sel:WORD_1
v_fmac_f32 v159, v197, v197
v_lshrrev_b32 v141, 18, v141
v_pk_add_f16 v153, v153, 1.0 op_sel_hi:[1,0]
v_lshrrev_b32 v143, 18, v143
v_fmac_f32 v159, v198, v198
v_pk_add_f16 v150, v150, 1.0 op_sel_hi:[1,0]
v_pk_add_f16 v147, v147, 1.0 op_sel_hi:[1,0]
v_fmac_f32_e64 v159, v199, v199
v_and_b32 v145, s49, v145
s_waitcnt lgkmcnt(4)
ds_read_b128 v[224:227], v248 offset:57344
ds_read_u16_d16_hi v141, v141
ds_read_u16_d16_hi v143, v143
v_mfma_f32_32x32x16_bf16 v[120:135], v[228:231], v[184:187], v[120:135]
v_rcp_f16 v154, v153
v_fmac_f32 v159, v200, v200
v_bfe_u32 v144, v145, 2, 14
v_rcp_f16 v151, v150
s_setprio 0
v_fmac_f32 v159, v201, v201
v_lshrrev_b32 v145, 18, v145
v_rcp_f16 v148, v147
v_fmac_f32 v159, v202, v202
ds_read_u16_d16 v144, v144
ds_read_u16_d16_hi v145, v145
v_or_b32_e64 v32, v136, v137
ds_read_b128 v[228:231], v248 offset:55296
v_mfma_f32_32x32x16_bf16 v[120:135], v[232:235], v[188:191], v[120:135]
s_waitcnt lgkmcnt(6)
v_or_b32 v33, v138, v139
v_fmac_f32_e64 v159, v203, v203
v_rcp_f16_sdwa v154, v153 dst_sel:WORD_1 dst_unused:UNUSED_PRESERVE src0_sel:WORD_1
v_fmac_f32 v159, v204, v204
s_waitcnt lgkmcnt(4)
v_or_b32_e64 v34, v140, v141
v_rcp_f16_sdwa v151, v150 dst_sel:WORD_1 dst_unused:UNUSED_PRESERVE src0_sel:WORD_1
v_fmac_f32 v159, v205, v205
s_waitcnt lgkmcnt(3)
v_or_b32_e64 v35, v142, v143
v_rcp_f16_sdwa v148, v147 dst_sel:WORD_1 dst_unused:UNUSED_PRESERVE src0_sel:WORD_1
v_fmac_f32 v159, v206, v206
s_waitcnt lgkmcnt(1)
v_or_b32_e64 v36, v144, v145
v_pk_mul_f16 v37, v155, v154
v_fmac_f32 v159, v207, v207
v_pk_mul_f16 v38, v152, v151
v_pk_mul_f16 v39, v149, v148
s_setprio 2
ds_read_b128 v[232:235], v248 offset:58368
v_mfma_f32_32x32x16_f16 v[192:207], v[32:35], v[208:211], 0
v_cvt_pkrtz_f16_f32 v137, v120, v121
v_cvt_pkrtz_f16_f32 v139, v122, v123
v_cvt_pkrtz_f16_f32 v141, v124, v125
v_cvt_pkrtz_f16_f32 v143, v126, v127
v_cvt_pkrtz_f16_f32 v145, v128, v129
v_mfma_f32_32x32x16_f16 v[192:207], v[36:39], v[212:215], v[192:207]
v_cvt_pk_f16_f32 v155, v130, v131
v_cvt_pk_f16_f32 v152, v132, v133
v_cvt_pk_f16_f32 v149, v134, v135
v_pk_fma_f16 v154, v155, v155, s48
v_and_b32_e64 v137, s49, v137
v_pk_fma_f16 v151, v152, v152, s48
v_mfma_f32_32x32x16_bf16 v[120:135], v[236:239], v[168:171], 0
v_and_b32 v139, s49, v139
v_pk_fma_f16 v148, v149, v149, s48
v_permlane16_swap_b32 v32, v36
v_pk_mul_f16 v154, v155, v154
v_bfe_u32 v136, v137, 2, 14
v_permlane16_swap_b32 v33, v37
v_pk_mul_f16 v151, v152, v151
v_pk_mul_f16 v148, v149, v148
v_bfe_u32 v138, v139, 2, 14
v_permlane16_swap_b32 v34, v38
ds_read_b128 v[236:239], v248 offset:59392
ds_read_u16_d16 v136, v136
ds_read_u16_d16 v138, v138
v_mfma_f32_32x32x16_bf16 v[120:135], v[216:219], v[172:175], v[120:135]
v_exp_f16 v153, v154
v_permlane16_swap_b32 v35, v39
v_lshrrev_b32 v137, 18, v137
v_exp_f16 v150, v151
v_fmac_f32 v160, v192, v192
v_lshrrev_b32 v139, 18, v139
v_exp_f16 v147, v148
v_fmac_f32 v160, v193, v193
v_and_b32_e64 v141, s49, v141
ds_read_b128 v[216:219], v248 offset:62464
ds_read_u16_d16_hi v137, v137
ds_read_u16_d16_hi v139, v139
v_mfma_f32_32x32x16_bf16 v[120:135], v[220:223], v[176:179], v[120:135]
v_and_b32 v143, s49, v143
v_fmac_f32 v160, v194, v194
v_exp_f16_sdwa v153, v154 dst_sel:WORD_1 dst_unused:UNUSED_PRESERVE src0_sel:WORD_1
v_bfe_u32 v140, v141, 2, 14
v_fmac_f32_e64 v160, v195, v195
v_exp_f16_sdwa v150, v151 dst_sel:WORD_1 dst_unused:UNUSED_PRESERVE src0_sel:WORD_1
v_fmac_f32_e64 v160, v196, v196
v_bfe_u32 v142, v143, 2, 14
ds_read_b128 v[220:223], v248 offset:60416
ds_read_u16_d16 v140, v140
ds_read_u16_d16 v142, v142
v_mfma_f32_32x32x16_bf16 v[120:135], v[224:227], v[180:183], v[120:135]
v_exp_f16_sdwa v147, v148 dst_sel:WORD_1 dst_unused:UNUSED_PRESERVE src0_sel:WORD_1
v_fmac_f32 v160, v197, v197
v_lshrrev_b32 v141, 18, v141
v_pk_add_f16 v153, v153, 1.0 op_sel_hi:[1,0]
v_lshrrev_b32 v143, 18, v143
v_fmac_f32 v160, v198, v198
v_pk_add_f16 v150, v150, 1.0 op_sel_hi:[1,0]
v_pk_add_f16 v147, v147, 1.0 op_sel_hi:[1,0]
v_fmac_f32_e64 v160, v199, v199
v_and_b32 v145, s49, v145
s_waitcnt lgkmcnt(4)
ds_read_b128 v[224:227], v248 offset:63488
ds_read_u16_d16_hi v141, v141
ds_read_u16_d16_hi v143, v143
v_mfma_f32_32x32x16_bf16 v[120:135], v[228:231], v[184:187], v[120:135]
v_rcp_f16 v154, v153
v_fmac_f32 v160, v200, v200
v_bfe_u32 v144, v145, 2, 14
v_rcp_f16 v151, v150
v_fmac_f32 v160, v201, v201
v_lshrrev_b32 v145, 18, v145
v_rcp_f16 v148, v147
v_fmac_f32_e64 v160, v202, v202
ds_read_u16_d16 v144, v144
ds_read_u16_d16_hi v145, v145
v_or_b32_e64 v40, v136, v137
ds_read_b128 v[228:231], v248 offset:61440
v_mfma_f32_32x32x16_bf16 v[120:135], v[232:235], v[188:191], v[120:135]
s_waitcnt lgkmcnt(6)
v_or_b32 v41, v138, v139
v_fmac_f32_e64 v160, v203, v203
v_rcp_f16_sdwa v154, v153 dst_sel:WORD_1 dst_unused:UNUSED_PRESERVE src0_sel:WORD_1
v_fmac_f32 v160, v204, v204
s_waitcnt lgkmcnt(4)
v_or_b32_e64 v42, v140, v141
v_rcp_f16_sdwa v151, v150 dst_sel:WORD_1 dst_unused:UNUSED_PRESERVE src0_sel:WORD_1
v_fmac_f32 v160, v205, v205
s_waitcnt lgkmcnt(3)
v_or_b32_e64 v43, v142, v143
v_rcp_f16_sdwa v148, v147 dst_sel:WORD_1 dst_unused:UNUSED_PRESERVE src0_sel:WORD_1
v_fmac_f32 v160, v206, v206
s_waitcnt lgkmcnt(1)
v_or_b32_e64 v44, v144, v145
v_pk_mul_f16 v45, v155, v154
v_fmac_f32_e64 v160, v207, v207
v_pk_mul_f16 v46, v152, v151
v_pk_mul_f16 v47, v149, v148
s_cmp_lg_u32 s40, 0
s_cbranch_scc1 Lrs1
v_mov_b32 v90, 0
Lpi:
s_waitcnt vmcnt(0)
v_readfirstlane_b32 s43, v91
s_cmp_eq_u32 s76, 0
s_cbranch_scc1 Lpix
s_sub_u32 s76, s76, 1
s_cmp_ge_u32 s43, 256
s_cbranch_scc1 Lpix
buffer_load_dword v91, v90, s[36:39], 0 offen sc1
s_branch Lpi
Lpix:
v_min_u32_e64 v88, 47, v251
v_lshlrev_b32 v88, 3, v88
s_and_b32 s44, s2, 7
s_lshl_b32 s44, s44, 11
s_add_u32 s44, s44, 394752
buffer_load_dwordx2 v[92:93], v88, s[32:35], s44 offen sc1
Lrs1:
s_setprio 1
ds_read_b128 v[232:235], v248 offset:64512
v_mfma_f32_32x32x16_f16 v[192:207], v[40:43], v[208:211], 0
v_cvt_pkrtz_f16_f32 v137, v120, v121
v_cvt_pkrtz_f16_f32 v139, v122, v123
v_cvt_pkrtz_f16_f32 v141, v124, v125
v_cvt_pkrtz_f16_f32 v143, v126, v127
v_cvt_pkrtz_f16_f32 v145, v128, v129
v_mfma_f32_32x32x16_f16 v[192:207], v[44:47], v[212:215], v[192:207]
v_cvt_pk_f16_f32 v155, v130, v131
v_cvt_pk_f16_f32 v152, v132, v133
v_cvt_pk_f16_f32 v149, v134, v135
v_pk_fma_f16 v154, v155, v155, s48
v_and_b32_e64 v137, s49, v137
v_pk_fma_f16 v151, v152, v152, s48
v_mfma_f32_32x32x16_bf16 v[120:135], v[236:239], v[168:171], 0
v_and_b32 v139, s49, v139
v_pk_fma_f16 v148, v149, v149, s48
v_permlane16_swap_b32 v40, v44
v_pk_mul_f16 v154, v155, v154
v_bfe_u32 v136, v137, 2, 14
v_permlane16_swap_b32 v41, v45
v_pk_mul_f16 v151, v152, v151
v_pk_mul_f16 v148, v149, v148
v_bfe_u32 v138, v139, 2, 14
v_permlane16_swap_b32 v42, v46
ds_read_b128 v[236:239], v249
ds_read_u16_d16 v136, v136
ds_read_u16_d16 v138, v138
v_mfma_f32_32x32x16_bf16 v[120:135], v[216:219], v[172:175], v[120:135]
v_exp_f16 v153, v154
v_permlane16_swap_b32 v43, v47
v_lshrrev_b32 v137, 18, v137
v_exp_f16 v150, v151
v_fmac_f32 v161, v192, v192
v_lshrrev_b32 v139, 18, v139
v_exp_f16 v147, v148
v_fmac_f32 v161, v193, v193
v_and_b32_e64 v141, s49, v141
ds_read_b128 v[216:219], v249 offset:3072
ds_read_u16_d16_hi v137, v137
ds_read_u16_d16_hi v139, v139
v_mfma_f32_32x32x16_bf16 v[120:135], v[220:223], v[176:179], v[120:135]
v_and_b32 v143, s49, v143
v_fmac_f32 v161, v194, v194
v_exp_f16_sdwa v153, v154 dst_sel:WORD_1 dst_unused:UNUSED_PRESERVE src0_sel:WORD_1
v_bfe_u32 v140, v141, 2, 14
v_fmac_f32_e64 v161, v195, v195
v_exp_f16_sdwa v150, v151 dst_sel:WORD_1 dst_unused:UNUSED_PRESERVE src0_sel:WORD_1
v_fmac_f32_e64 v161, v196, v196
v_bfe_u32 v142, v143, 2, 14
ds_read_b128 v[220:223], v249 offset:1024
ds_read_u16_d16 v140, v140
ds_read_u16_d16 v142, v142
v_mfma_f32_32x32x16_bf16 v[120:135], v[224:227], v[180:183], v[120:135]
v_exp_f16_sdwa v147, v148 dst_sel:WORD_1 dst_unused:UNUSED_PRESERVE src0_sel:WORD_1
v_fmac_f32 v161, v197, v197
v_lshrrev_b32 v141, 18, v141
v_pk_add_f16 v153, v153, 1.0 op_sel_hi:[1,0]
v_lshrrev_b32 v143, 18, v143
v_fmac_f32 v161, v198, v198
v_pk_add_f16 v150, v150, 1.0 op_sel_hi:[1,0]
v_pk_add_f16 v147, v147, 1.0 op_sel_hi:[1,0]
v_fmac_f32_e64 v161, v199, v199
v_and_b32 v145, s49, v145
s_waitcnt lgkmcnt(4)
ds_read_b128 v[224:227], v249 offset:4096
ds_read_u16_d16_hi v141, v141
ds_read_u16_d16_hi v143, v143
v_mfma_f32_32x32x16_bf16 v[120:135], v[228:231], v[184:187], v[120:135]
v_rcp_f16 v154, v153
v_fmac_f32 v161, v200, v200
v_bfe_u32 v144, v145, 2, 14
v_rcp_f16 v151, v150
s_setprio 0
v_fmac_f32 v161, v201, v201
v_lshrrev_b32 v145, 18, v145
v_rcp_f16 v148, v147
v_fmac_f32 v161, v202, v202
ds_read_u16_d16 v144, v144
ds_read_u16_d16_hi v145, v145
v_or_b32_e64 v48, v136, v137
ds_read_b128 v[228:231], v249 offset:2048
v_mfma_f32_32x32x16_bf16 v[120:135], v[232:235], v[188:191], v[120:135]
s_waitcnt lgkmcnt(6)
v_or_b32 v49, v138, v139
v_fmac_f32_e64 v161, v203, v203
v_rcp_f16_sdwa v154, v153 dst_sel:WORD_1 dst_unused:UNUSED_PRESERVE src0_sel:WORD_1
v_fmac_f32 v161, v204, v204
s_waitcnt lgkmcnt(4)
v_or_b32_e64 v50, v140, v141
v_rcp_f16_sdwa v151, v150 dst_sel:WORD_1 dst_unused:UNUSED_PRESERVE src0_sel:WORD_1
v_fmac_f32 v161, v205, v205
s_waitcnt lgkmcnt(3)
v_or_b32_e64 v51, v142, v143
v_rcp_f16_sdwa v148, v147 dst_sel:WORD_1 dst_unused:UNUSED_PRESERVE src0_sel:WORD_1
v_fmac_f32 v161, v206, v206
s_waitcnt lgkmcnt(1)
v_or_b32_e64 v52, v144, v145
v_pk_mul_f16 v53, v155, v154
v_fmac_f32 v161, v207, v207
v_pk_mul_f16 v54, v152, v151
v_pk_mul_f16 v55, v149, v148
s_setprio 2
ds_read_b128 v[232:235], v249 offset:5120
v_mfma_f32_32x32x16_f16 v[192:207], v[48:51], v[208:211], 0
v_cvt_pkrtz_f16_f32 v137, v120, v121
v_cvt_pkrtz_f16_f32 v139, v122, v123
v_cvt_pkrtz_f16_f32 v141, v124, v125
v_cvt_pkrtz_f16_f32 v143, v126, v127
v_cvt_pkrtz_f16_f32 v145, v128, v129
v_mfma_f32_32x32x16_f16 v[192:207], v[52:55], v[212:215], v[192:207]
v_cvt_pk_f16_f32 v155, v130, v131
v_cvt_pk_f16_f32 v152, v132, v133
v_cvt_pk_f16_f32 v149, v134, v135
v_pk_fma_f16 v154, v155, v155, s48
v_and_b32_e64 v137, s49, v137
v_pk_fma_f16 v151, v152, v152, s48
v_mfma_f32_32x32x16_bf16 v[120:135], v[236:239], v[168:171], 0
v_and_b32 v139, s49, v139
v_pk_fma_f16 v148, v149, v149, s48
v_permlane16_swap_b32 v48, v52
v_pk_mul_f16 v154, v155, v154
v_bfe_u32 v136, v137, 2, 14
v_permlane16_swap_b32 v49, v53
v_pk_mul_f16 v151, v152, v151
v_pk_mul_f16 v148, v149, v148
v_bfe_u32 v138, v139, 2, 14
v_permlane16_swap_b32 v50, v54
ds_read_b128 v[236:239], v249 offset:6144
ds_read_u16_d16 v136, v136
ds_read_u16_d16 v138, v138
v_mfma_f32_32x32x16_bf16 v[120:135], v[216:219], v[172:175], v[120:135]
v_exp_f16 v153, v154
v_permlane16_swap_b32 v51, v55
v_lshrrev_b32 v137, 18, v137
v_exp_f16 v150, v151
v_fmac_f32 v162, v192, v192
v_lshrrev_b32 v139, 18, v139
v_exp_f16 v147, v148
v_fmac_f32 v162, v193, v193
v_and_b32_e64 v141, s49, v141
ds_read_b128 v[216:219], v249 offset:9216
ds_read_u16_d16_hi v137, v137
ds_read_u16_d16_hi v139, v139
v_mfma_f32_32x32x16_bf16 v[120:135], v[220:223], v[176:179], v[120:135]
v_and_b32 v143, s49, v143
v_fmac_f32 v162, v194, v194
v_exp_f16_sdwa v153, v154 dst_sel:WORD_1 dst_unused:UNUSED_PRESERVE src0_sel:WORD_1
v_bfe_u32 v140, v141, 2, 14
v_fmac_f32_e64 v162, v195, v195
v_exp_f16_sdwa v150, v151 dst_sel:WORD_1 dst_unused:UNUSED_PRESERVE src0_sel:WORD_1
v_fmac_f32_e64 v162, v196, v196
v_bfe_u32 v142, v143, 2, 14
ds_read_b128 v[220:223], v249 offset:7168
ds_read_u16_d16 v140, v140
ds_read_u16_d16 v142, v142
v_mfma_f32_32x32x16_bf16 v[120:135], v[224:227], v[180:183], v[120:135]
v_exp_f16_sdwa v147, v148 dst_sel:WORD_1 dst_unused:UNUSED_PRESERVE src0_sel:WORD_1
v_fmac_f32 v162, v197, v197
v_lshrrev_b32 v141, 18, v141
v_pk_add_f16 v153, v153, 1.0 op_sel_hi:[1,0]
v_lshrrev_b32 v143, 18, v143
v_fmac_f32 v162, v198, v198
v_pk_add_f16 v150, v150, 1.0 op_sel_hi:[1,0]
v_pk_add_f16 v147, v147, 1.0 op_sel_hi:[1,0]
v_fmac_f32_e64 v162, v199, v199
v_and_b32 v145, s49, v145
s_waitcnt lgkmcnt(4)
ds_read_b128 v[224:227], v249 offset:10240
ds_read_u16_d16_hi v141, v141
ds_read_u16_d16_hi v143, v143
v_mfma_f32_32x32x16_bf16 v[120:135], v[228:231], v[184:187], v[120:135]
v_rcp_f16 v154, v153
v_fmac_f32 v162, v200, v200
v_bfe_u32 v144, v145, 2, 14
v_rcp_f16 v151, v150
v_fmac_f32 v162, v201, v201
v_lshrrev_b32 v145, 18, v145
v_rcp_f16 v148, v147
v_fmac_f32_e64 v162, v202, v202
ds_read_u16_d16 v144, v144
ds_read_u16_d16_hi v145, v145
v_or_b32_e64 v56, v136, v137
ds_read_b128 v[228:231], v249 offset:8192
v_mfma_f32_32x32x16_bf16 v[120:135], v[232:235], v[188:191], v[120:135]
s_waitcnt lgkmcnt(6)
v_or_b32 v57, v138, v139
v_fmac_f32_e64 v162, v203, v203
v_rcp_f16_sdwa v154, v153 dst_sel:WORD_1 dst_unused:UNUSED_PRESERVE src0_sel:WORD_1
v_fmac_f32 v162, v204, v204
s_waitcnt lgkmcnt(4)
v_or_b32_e64 v58, v140, v141
v_rcp_f16_sdwa v151, v150 dst_sel:WORD_1 dst_unused:UNUSED_PRESERVE src0_sel:WORD_1
v_fmac_f32 v162, v205, v205
s_waitcnt lgkmcnt(3)
v_or_b32_e64 v59, v142, v143
v_rcp_f16_sdwa v148, v147 dst_sel:WORD_1 dst_unused:UNUSED_PRESERVE src0_sel:WORD_1
v_fmac_f32 v162, v206, v206
s_waitcnt lgkmcnt(1)
v_or_b32_e64 v60, v144, v145
v_pk_mul_f16 v61, v155, v154
v_fmac_f32 v162, v207, v207
v_pk_mul_f16 v62, v152, v151
v_pk_mul_f16 v63, v149, v148
s_setprio 1
ds_read_b128 v[232:235], v249 offset:11264
v_mfma_f32_32x32x16_f16 v[192:207], v[56:59], v[208:211], 0
v_cvt_pkrtz_f16_f32 v137, v120, v121
v_cvt_pkrtz_f16_f32 v139, v122, v123
v_cvt_pkrtz_f16_f32 v141, v124, v125
v_cvt_pkrtz_f16_f32 v143, v126, v127
v_cvt_pkrtz_f16_f32 v145, v128, v129
v_mfma_f32_32x32x16_f16 v[192:207], v[60:63], v[212:215], v[192:207]
v_cvt_pk_f16_f32 v155, v130, v131
v_cvt_pk_f16_f32 v152, v132, v133
v_cvt_pk_f16_f32 v149, v134, v135
v_pk_fma_f16 v154, v155, v155, s48
v_and_b32_e64 v137, s49, v137
v_pk_fma_f16 v151, v152, v152, s48
v_mfma_f32_32x32x16_bf16 v[120:135], v[236:239], v[168:171], 0
v_and_b32 v139, s49, v139
v_pk_fma_f16 v148, v149, v149, s48
v_permlane16_swap_b32 v56, v60
v_pk_mul_f16 v154, v155, v154
v_bfe_u32 v136, v137, 2, 14
v_permlane16_swap_b32 v57, v61
v_pk_mul_f16 v151, v152, v151
v_pk_mul_f16 v148, v149, v148
v_bfe_u32 v138, v139, 2, 14
v_permlane16_swap_b32 v58, v62
ds_read_b128 v[236:239], v249 offset:12288
ds_read_u16_d16 v136, v136
ds_read_u16_d16 v138, v138
v_mfma_f32_32x32x16_bf16 v[120:135], v[216:219], v[172:175], v[120:135]
v_exp_f16 v153, v154
v_permlane16_swap_b32 v59, v63
v_lshrrev_b32 v137, 18, v137
v_exp_f16 v150, v151
v_fmac_f32 v163, v192, v192
v_lshrrev_b32 v139, 18, v139
v_exp_f16 v147, v148
v_fmac_f32 v163, v193, v193
v_and_b32_e64 v141, s49, v141
ds_read_b128 v[216:219], v249 offset:15360
ds_read_u16_d16_hi v137, v137
ds_read_u16_d16_hi v139, v139
v_mfma_f32_32x32x16_bf16 v[120:135], v[220:223], v[176:179], v[120:135]
v_and_b32 v143, s49, v143
v_fmac_f32 v163, v194, v194
v_exp_f16_sdwa v153, v154 dst_sel:WORD_1 dst_unused:UNUSED_PRESERVE src0_sel:WORD_1
v_bfe_u32 v140, v141, 2, 14
v_fmac_f32_e64 v163, v195, v195
v_exp_f16_sdwa v150, v151 dst_sel:WORD_1 dst_unused:UNUSED_PRESERVE src0_sel:WORD_1
v_fmac_f32_e64 v163, v196, v196
v_bfe_u32 v142, v143, 2, 14
ds_read_b128 v[220:223], v249 offset:13312
ds_read_u16_d16 v140, v140
ds_read_u16_d16 v142, v142
v_mfma_f32_32x32x16_bf16 v[120:135], v[224:227], v[180:183], v[120:135]
v_exp_f16_sdwa v147, v148 dst_sel:WORD_1 dst_unused:UNUSED_PRESERVE src0_sel:WORD_1
v_fmac_f32 v163, v197, v197
v_lshrrev_b32 v141, 18, v141
v_pk_add_f16 v153, v153, 1.0 op_sel_hi:[1,0]
v_lshrrev_b32 v143, 18, v143
v_fmac_f32 v163, v198, v198
v_pk_add_f16 v150, v150, 1.0 op_sel_hi:[1,0]
v_pk_add_f16 v147, v147, 1.0 op_sel_hi:[1,0]
v_fmac_f32_e64 v163, v199, v199
v_and_b32 v145, s49, v145
s_waitcnt lgkmcnt(4)
ds_read_b128 v[224:227], v249 offset:16384
ds_read_u16_d16_hi v141, v141
ds_read_u16_d16_hi v143, v143
v_mfma_f32_32x32x16_bf16 v[120:135], v[228:231], v[184:187], v[120:135]
v_rcp_f16 v154, v153
v_fmac_f32 v163, v200, v200
v_bfe_u32 v144, v145, 2, 14
v_rcp_f16 v151, v150
s_setprio 0
v_fmac_f32 v163, v201, v201
v_lshrrev_b32 v145, 18, v145
v_rcp_f16 v148, v147
v_fmac_f32 v163, v202, v202
ds_read_u16_d16 v144, v144
ds_read_u16_d16_hi v145, v145
v_or_b32_e64 v64, v136, v137
ds_read_b128 v[228:231], v249 offset:14336
v_mfma_f32_32x32x16_bf16 v[120:135], v[232:235], v[188:191], v[120:135]
s_waitcnt lgkmcnt(6)
v_or_b32 v65, v138, v139
v_fmac_f32_e64 v163, v203, v203
v_rcp_f16_sdwa v154, v153 dst_sel:WORD_1 dst_unused:UNUSED_PRESERVE src0_sel:WORD_1
v_fmac_f32 v163, v204, v204
s_waitcnt lgkmcnt(4)
v_or_b32_e64 v66, v140, v141
v_rcp_f16_sdwa v151, v150 dst_sel:WORD_1 dst_unused:UNUSED_PRESERVE src0_sel:WORD_1
v_fmac_f32 v163, v205, v205
s_waitcnt lgkmcnt(3)
v_or_b32_e64 v67, v142, v143
v_rcp_f16_sdwa v148, v147 dst_sel:WORD_1 dst_unused:UNUSED_PRESERVE src0_sel:WORD_1
v_fmac_f32 v163, v206, v206
s_waitcnt lgkmcnt(1)
v_or_b32_e64 v68, v144, v145
v_pk_mul_f16 v69, v155, v154
v_fmac_f32 v163, v207, v207
v_pk_mul_f16 v70, v152, v151
v_pk_mul_f16 v71, v149, v148
s_setprio 2
ds_read_b128 v[232:235], v249 offset:17408
v_mfma_f32_32x32x16_f16 v[192:207], v[64:67], v[208:211], 0
v_cvt_pkrtz_f16_f32 v137, v120, v121
v_cvt_pkrtz_f16_f32 v139, v122, v123
v_cvt_pkrtz_f16_f32 v141, v124, v125
v_cvt_pkrtz_f16_f32 v143, v126, v127
v_cvt_pkrtz_f16_f32 v145, v128, v129
v_mfma_f32_32x32x16_f16 v[192:207], v[68:71], v[212:215], v[192:207]
v_cvt_pk_f16_f32 v155, v130, v131
v_cvt_pk_f16_f32 v152, v132, v133
v_cvt_pk_f16_f32 v149, v134, v135
v_pk_fma_f16 v154, v155, v155, s48
v_and_b32_e64 v137, s49, v137
v_pk_fma_f16 v151, v152, v152, s48
v_mfma_f32_32x32x16_bf16 v[120:135], v[236:239], v[168:171], 0
v_and_b32 v139, s49, v139
v_pk_fma_f16 v148, v149, v149, s48
v_permlane16_swap_b32 v64, v68
v_pk_mul_f16 v154, v155, v154
v_bfe_u32 v136, v137, 2, 14
v_permlane16_swap_b32 v65, v69
v_pk_mul_f16 v151, v152, v151
v_pk_mul_f16 v148, v149, v148
v_bfe_u32 v138, v139, 2, 14
v_permlane16_swap_b32 v66, v70
ds_read_b128 v[236:239], v249 offset:18432
ds_read_u16_d16 v136, v136
ds_read_u16_d16 v138, v138
v_mfma_f32_32x32x16_bf16 v[120:135], v[216:219], v[172:175], v[120:135]
v_exp_f16 v153, v154
v_permlane16_swap_b32 v67, v71
v_lshrrev_b32 v137, 18, v137
v_exp_f16 v150, v151
v_fmac_f32 v164, v192, v192
v_lshrrev_b32 v139, 18, v139
v_exp_f16 v147, v148
v_fmac_f32 v164, v193, v193
v_and_b32_e64 v141, s49, v141
ds_read_b128 v[216:219], v249 offset:21504
ds_read_u16_d16_hi v137, v137
ds_read_u16_d16_hi v139, v139
v_mfma_f32_32x32x16_bf16 v[120:135], v[220:223], v[176:179], v[120:135]
v_and_b32 v143, s49, v143
v_fmac_f32 v164, v194, v194
v_exp_f16_sdwa v153, v154 dst_sel:WORD_1 dst_unused:UNUSED_PRESERVE src0_sel:WORD_1
v_bfe_u32 v140, v141, 2, 14
v_fmac_f32_e64 v164, v195, v195
v_exp_f16_sdwa v150, v151 dst_sel:WORD_1 dst_unused:UNUSED_PRESERVE src0_sel:WORD_1
v_fmac_f32_e64 v164, v196, v196
v_bfe_u32 v142, v143, 2, 14
ds_read_b128 v[220:223], v249 offset:19456
ds_read_u16_d16 v140, v140
ds_read_u16_d16 v142, v142
v_mfma_f32_32x32x16_bf16 v[120:135], v[224:227], v[180:183], v[120:135]
v_exp_f16_sdwa v147, v148 dst_sel:WORD_1 dst_unused:UNUSED_PRESERVE src0_sel:WORD_1
v_fmac_f32 v164, v197, v197
v_lshrrev_b32 v141, 18, v141
v_pk_add_f16 v153, v153, 1.0 op_sel_hi:[1,0]
v_lshrrev_b32 v143, 18, v143
v_fmac_f32 v164, v198, v198
v_pk_add_f16 v150, v150, 1.0 op_sel_hi:[1,0]
v_pk_add_f16 v147, v147, 1.0 op_sel_hi:[1,0]
v_fmac_f32_e64 v164, v199, v199
v_and_b32 v145, s49, v145
s_waitcnt lgkmcnt(4)
ds_read_b128 v[224:227], v249 offset:22528
ds_read_u16_d16_hi v141, v141
ds_read_u16_d16_hi v143, v143
v_mfma_f32_32x32x16_bf16 v[120:135], v[228:231], v[184:187], v[120:135]
v_rcp_f16 v154, v153
v_fmac_f32 v164, v200, v200
v_bfe_u32 v144, v145, 2, 14
v_rcp_f16 v151, v150
v_fmac_f32 v164, v201, v201
v_lshrrev_b32 v145, 18, v145
v_rcp_f16 v148, v147
v_fmac_f32_e64 v164, v202, v202
ds_read_u16_d16 v144, v144
ds_read_u16_d16_hi v145, v145
v_or_b32_e64 v72, v136, v137
ds_read_b128 v[228:231], v249 offset:20480
v_mfma_f32_32x32x16_bf16 v[120:135], v[232:235], v[188:191], v[120:135]
s_waitcnt lgkmcnt(6)
v_or_b32 v73, v138, v139
v_fmac_f32_e64 v164, v203, v203
v_rcp_f16_sdwa v154, v153 dst_sel:WORD_1 dst_unused:UNUSED_PRESERVE src0_sel:WORD_1
v_fmac_f32 v164, v204, v204
s_waitcnt lgkmcnt(4)
v_or_b32_e64 v74, v140, v141
v_rcp_f16_sdwa v151, v150 dst_sel:WORD_1 dst_unused:UNUSED_PRESERVE src0_sel:WORD_1
v_fmac_f32 v164, v205, v205
s_waitcnt lgkmcnt(3)
v_or_b32_e64 v75, v142, v143
v_rcp_f16_sdwa v148, v147 dst_sel:WORD_1 dst_unused:UNUSED_PRESERVE src0_sel:WORD_1
v_fmac_f32 v164, v206, v206
s_waitcnt lgkmcnt(1)
v_or_b32_e64 v76, v144, v145
v_pk_mul_f16 v77, v155, v154
v_fmac_f32_e64 v164, v207, v207
v_pk_mul_f16 v78, v152, v151
v_pk_mul_f16 v79, v149, v148
s_cmp_lg_u32 s40, 0
s_cbranch_scc1 Lrs2
v_min_u32_e64 v88, 47, v251
v_lshlrev_b32 v88, 3, v88
v_add_u32 v89, 7936, v88
v_add_u32 v88, 15872, v88
v_cmp_gt_u32 vcc, 32, v251
s_nop 1
v_cndmask_b32 v88, v88, v89, vcc
s_waitcnt vmcnt(0)
ds_write_b64 v88, v[92:93]
Lrs2:
s_setprio 1
ds_read_b128 v[232:235], v249 offset:23552
v_mfma_f32_32x32x16_f16 v[192:207], v[72:75], v[208:211], 0
v_cvt_pkrtz_f16_f32 v137, v120, v121
v_cvt_pkrtz_f16_f32 v139, v122, v123
v_cvt_pkrtz_f16_f32 v141, v124, v125
v_cvt_pkrtz_f16_f32 v143, v126, v127
v_cvt_pkrtz_f16_f32 v145, v128, v129
v_mfma_f32_32x32x16_f16 v[192:207], v[76:79], v[212:215], v[192:207]
v_cvt_pk_f16_f32 v155, v130, v131
v_cvt_pk_f16_f32 v152, v132, v133
v_cvt_pk_f16_f32 v149, v134, v135
v_pk_fma_f16 v154, v155, v155, s48
v_and_b32_e64 v137, s49, v137
v_pk_fma_f16 v151, v152, v152, s48
v_mfma_f32_32x32x16_bf16 v[120:135], v[236:239], v[168:171], 0
v_and_b32 v139, s49, v139
v_pk_fma_f16 v148, v149, v149, s48
v_permlane16_swap_b32 v72, v76
v_pk_mul_f16 v154, v155, v154
v_bfe_u32 v136, v137, 2, 14
v_permlane16_swap_b32 v73, v77
v_pk_mul_f16 v151, v152, v151
v_pk_mul_f16 v148, v149, v148
v_bfe_u32 v138, v139, 2, 14
v_permlane16_swap_b32 v74, v78
ds_read_u16_d16 v136, v136
ds_read_u16_d16 v138, v138
v_mfma_f32_32x32x16_bf16 v[120:135], v[216:219], v[172:175], v[120:135]
v_exp_f16 v153, v154
v_permlane16_swap_b32 v75, v79
v_lshrrev_b32 v137, 18, v137
v_exp_f16 v150, v151
v_fmac_f32 v165, v192, v192
v_lshrrev_b32 v139, 18, v139
v_exp_f16 v147, v148
v_fmac_f32 v165, v193, v193
v_and_b32_e64 v141, s49, v141
ds_read_u16_d16_hi v137, v137
ds_read_u16_d16_hi v139, v139
v_mfma_f32_32x32x16_bf16 v[120:135], v[220:223], v[176:179], v[120:135]
v_and_b32 v143, s49, v143
v_fmac_f32 v165, v194, v194
v_exp_f16_sdwa v153, v154 dst_sel:WORD_1 dst_unused:UNUSED_PRESERVE src0_sel:WORD_1
v_bfe_u32 v140, v141, 2, 14
v_fmac_f32_e64 v165, v195, v195
v_exp_f16_sdwa v150, v151 dst_sel:WORD_1 dst_unused:UNUSED_PRESERVE src0_sel:WORD_1
v_fmac_f32_e64 v165, v196, v196
v_bfe_u32 v142, v143, 2, 14
ds_read_u16_d16 v140, v140
ds_read_u16_d16 v142, v142
v_mfma_f32_32x32x16_bf16 v[120:135], v[224:227], v[180:183], v[120:135]
v_exp_f16_sdwa v147, v148 dst_sel:WORD_1 dst_unused:UNUSED_PRESERVE src0_sel:WORD_1
v_fmac_f32 v165, v197, v197
v_lshrrev_b32 v141, 18, v141
v_pk_add_f16 v153, v153, 1.0 op_sel_hi:[1,0]
v_lshrrev_b32 v143, 18, v143
v_fmac_f32 v165, v198, v198
v_pk_add_f16 v150, v150, 1.0 op_sel_hi:[1,0]
v_pk_add_f16 v147, v147, 1.0 op_sel_hi:[1,0]
v_fmac_f32_e64 v165, v199, v199
v_and_b32 v145, s49, v145
s_waitcnt lgkmcnt(4)
ds_read_u16_d16_hi v141, v141
ds_read_u16_d16_hi v143, v143
v_mfma_f32_32x32x16_bf16 v[120:135], v[228:231], v[184:187], v[120:135]
v_rcp_f16 v154, v153
v_fmac_f32 v165, v200, v200
v_bfe_u32 v144, v145, 2, 14
v_rcp_f16 v151, v150
s_setprio 0
v_fmac_f32 v165, v201, v201
v_lshrrev_b32 v145, 18, v145
v_rcp_f16 v148, v147
v_fmac_f32 v165, v202, v202
ds_read_u16_d16 v144, v144
ds_read_u16_d16_hi v145, v145
s_waitcnt lgkmcnt(4)
v_or_b32 v80, v136, v137
v_mfma_f32_32x32x16_bf16 v[120:135], v[232:235], v[188:191], v[120:135]
v_or_b32 v81, v138, v139
v_fmac_f32 v165, v203, v203
v_rcp_f16_sdwa v154, v153 dst_sel:WORD_1 dst_unused:UNUSED_PRESERVE src0_sel:WORD_1
v_fmac_f32 v165, v204, v204
s_waitcnt lgkmcnt(3)
v_or_b32_e64 v82, v140, v141
v_rcp_f16_sdwa v151, v150 dst_sel:WORD_1 dst_unused:UNUSED_PRESERVE src0_sel:WORD_1
v_fmac_f32 v165, v205, v205
s_waitcnt lgkmcnt(2)
v_or_b32_e64 v83, v142, v143
v_rcp_f16_sdwa v148, v147 dst_sel:WORD_1 dst_unused:UNUSED_PRESERVE src0_sel:WORD_1
v_fmac_f32 v165, v206, v206
s_waitcnt lgkmcnt(0)
v_or_b32_e64 v84, v144, v145
v_pk_mul_f16 v85, v155, v154
v_fmac_f32 v165, v207, v207
v_pk_mul_f16 v86, v152, v151
v_pk_mul_f16 v87, v149, v148
s_setprio 2
v_mfma_f32_32x32x16_f16 v[192:207], v[80:83], v[208:211], 0
v_mfma_f32_32x32x16_f16 v[192:207], v[84:87], v[212:215], v[192:207]
v_cvt_pkrtz_f16_f32 v137, v120, v121
v_cvt_pkrtz_f16_f32 v139, v122, v123
v_cvt_pkrtz_f16_f32 v141, v124, v125
v_cvt_pkrtz_f16_f32 v143, v126, v127
v_cvt_pkrtz_f16_f32 v145, v128, v129
v_cvt_pk_f16_f32 v155, v130, v131
v_cvt_pk_f16_f32 v152, v132, v133
v_cvt_pk_f16_f32 v149, v134, v135
v_pk_fma_f16 v154, v155, v155, s48
v_and_b32_e64 v137, s49, v137
v_pk_fma_f16 v151, v152, v152, s48
v_and_b32_e64 v139, s49, v139
v_pk_fma_f16 v148, v149, v149, s48
v_permlane16_swap_b32 v80, v84
v_pk_mul_f16 v154, v155, v154
v_bfe_u32 v136, v137, 2, 14
v_permlane16_swap_b32 v81, v85
v_pk_mul_f16 v151, v152, v151
v_pk_mul_f16 v148, v149, v148
v_bfe_u32 v138, v139, 2, 14
v_permlane16_swap_b32 v82, v86
v_exp_f16 v153, v154
v_permlane16_swap_b32 v83, v87
v_lshrrev_b32 v137, 18, v137
v_exp_f16 v150, v151
v_fmac_f32 v166, v192, v192
v_lshrrev_b32 v139, 18, v139
v_exp_f16 v147, v148
v_fmac_f32 v166, v193, v193
v_and_b32 v141, s49, v141
v_and_b32_e64 v143, s49, v143
ds_read_u16_d16 v136, v136
ds_read_u16_d16 v138, v138
ds_read_u16_d16_hi v137, v137
ds_read_u16_d16_hi v139, v139
v_fmac_f32_e64 v166, v194, v194
v_exp_f16_sdwa v153, v154 dst_sel:WORD_1 dst_unused:UNUSED_PRESERVE src0_sel:WORD_1
v_bfe_u32 v140, v141, 2, 14
v_fmac_f32_e64 v166, v195, v195
v_exp_f16_sdwa v150, v151 dst_sel:WORD_1 dst_unused:UNUSED_PRESERVE src0_sel:WORD_1
v_fmac_f32_e64 v166, v196, v196
v_bfe_u32 v142, v143, 2, 14
v_exp_f16_sdwa v147, v148 dst_sel:WORD_1 dst_unused:UNUSED_PRESERVE src0_sel:WORD_1
v_fmac_f32 v166, v197, v197
v_lshrrev_b32 v141, 18, v141
v_pk_add_f16 v153, v153, 1.0 op_sel_hi:[1,0]
v_lshrrev_b32 v143, 18, v143
v_fmac_f32 v166, v198, v198
v_pk_add_f16 v150, v150, 1.0 op_sel_hi:[1,0]
v_pk_add_f16 v147, v147, 1.0 op_sel_hi:[1,0]
v_fmac_f32 v166, v199, v199
v_and_b32 v145, s49, v145
v_rcp_f16 v154, v153
v_fmac_f32 v166, v200, v200
v_bfe_u32 v144, v145, 2, 14
v_rcp_f16 v151, v150
v_fmac_f32 v166, v201, v201
v_lshrrev_b32_e64 v145, 18, v145
ds_read_u16_d16 v140, v140
ds_read_u16_d16 v142, v142
ds_read_u16_d16_hi v141, v141
ds_read_u16_d16_hi v143, v143
ds_read_u16_d16 v144, v144
ds_read_u16_d16_hi v145, v145
v_rcp_f16 v148, v147
v_fmac_f32 v166, v202, v202
s_waitcnt lgkmcnt(6)
v_or_b32 v88, v136, v137
v_or_b32 v89, v138, v139
v_fmac_f32 v166, v203, v203
v_rcp_f16_sdwa v154, v153 dst_sel:WORD_1 dst_unused:UNUSED_PRESERVE src0_sel:WORD_1
v_fmac_f32 v166, v204, v204
s_waitcnt lgkmcnt(3)
v_or_b32_e64 v90, v140, v141
v_rcp_f16_sdwa v151, v150 dst_sel:WORD_1 dst_unused:UNUSED_PRESERVE src0_sel:WORD_1
v_fmac_f32 v166, v205, v205
s_waitcnt lgkmcnt(2)
v_or_b32_e64 v91, v142, v143
v_rcp_f16_sdwa v148, v147 dst_sel:WORD_1 dst_unused:UNUSED_PRESERVE src0_sel:WORD_1
v_fmac_f32 v166, v206, v206
s_waitcnt lgkmcnt(0)
v_or_b32_e64 v92, v144, v145
v_pk_mul_f16 v93, v155, v154
v_fmac_f32 v166, v207, v207
v_pk_mul_f16 v94, v152, v151
v_pk_mul_f16 v95, v149, v148
s_setprio 1
v_mfma_f32_32x32x16_f16 v[192:207], v[88:91], v[208:211], 0
v_mfma_f32_32x32x16_f16 v[192:207], v[92:95], v[212:215], v[192:207]
v_permlane16_swap_b32 v88, v92
v_permlane16_swap_b32 v89, v93
v_permlane16_swap_b32 v90, v94
v_permlane16_swap_b32 v91, v95
s_nop 7
v_fmac_f32 v167, v192, v192
v_fmac_f32 v167, v193, v193
v_fmac_f32 v167, v194, v194
v_fmac_f32 v167, v195, v195
v_fmac_f32 v167, v196, v196
v_fmac_f32 v167, v197, v197
v_fmac_f32 v167, v198, v198
v_fmac_f32 v167, v199, v199
v_fmac_f32 v167, v200, v200
v_fmac_f32 v167, v201, v201
v_fmac_f32 v167, v202, v202
s_setprio 0
v_fmac_f32 v167, v203, v203
v_fmac_f32 v167, v204, v204
v_fmac_f32 v167, v205, v205
v_fmac_f32 v167, v206, v206
v_fmac_f32 v167, v207, v207
s_setprio 3
v_and_b32 v136, 51, v251
v_bfe_u32 v137, v251, 2, 1
v_lshl_add_u32 v136, v137, 3, v136
v_bfe_u32 v137, v251, 3, 1
v_lshl_add_u32 v136, v137, 2, v136
v_lshl_add_u32 v136, v136, 2, s72
v_permlane32_swap_b32 v156, v157
v_add_f32 v156, v156, v157
ds_write_b32 v136, v156 offset:7168
v_permlane32_swap_b32 v158, v159
v_add_f32 v158, v158, v159
ds_write_b32 v136, v158 offset:7424
v_permlane32_swap_b32 v160, v161
v_add_f32 v160, v160, v161
ds_write_b32 v136, v160 offset:7680
v_permlane32_swap_b32 v162, v163
v_add_f32 v162, v162, v163
ds_write_b32 v136, v162 offset:7936
v_permlane32_swap_b32 v164, v165
v_add_f32 v164, v164, v165
ds_write_b32 v136, v164 offset:8192
v_permlane32_swap_b32 v166, v167
v_add_f32 v166, v166, v167
ds_write_b32 v136, v166 offset:8448
v_mov_b32 v128, 16256
v_mov_b32_e64 v129, 1
s_waitcnt lgkmcnt(0)
s_mov_b64 exec, 1
ds_add_rtn_u32 v130, v128, v129
s_mov_b64 exec, -1
s_waitcnt lgkmcnt(0)
v_readfirstlane_b32 s43, v130
s_nop 1
s_cmp_lg_u32 s43, 7
s_cbranch_scc1 Lnopub
v_min_u32 v131, 47, v251
v_lshlrev_b32 v132, 5, v131
v_add_u32 v132, 97280, v132
ds_read_b128 v[168:171], v132
ds_read_b128 v[172:175], v132 offset:16
ds_read_b128 v[176:179], v132 offset:9216
ds_read_b128 v[180:183], v132 offset:9232
ds_read_b128 v[184:187], v132 offset:18432
ds_read_b128 v[188:191], v132 offset:18448
ds_read_b128 v[192:195], v132 offset:27648
ds_read_b128 v[196:199], v132 offset:27664
ds_read_b128 v[200:203], v132 offset:36864
ds_read_b128 v[204:207], v132 offset:36880
ds_read_b128 v[208:211], v132 offset:46080
ds_read_b128 v[212:215], v132 offset:46096
ds_read_b128 v[216:219], v132 offset:55296
ds_read_b128 v[220:223], v132 offset:55312
ds_read_b128 v[120:123], v132 offset:64512
ds_read_b128 v[124:127], v132 offset:64528
v_lshlrev_b32_e64 v134, 13, v131
v_add_u32 v135, 4096, v134
s_waitcnt lgkmcnt(13)
v_add_f32 v168, v168, v176
v_add_f32 v169, v169, v177
v_add_f32 v170, v170, v178
v_add_f32 v171, v171, v179
s_waitcnt lgkmcnt(12)
v_add_f32 v172, v172, v180
v_add_f32 v173, v173, v181
v_add_f32 v174, v174, v182
v_add_f32 v175, v175, v183
s_waitcnt lgkmcnt(9)
v_add_f32 v184, v184, v192
v_add_f32 v185, v185, v193
v_add_f32 v186, v186, v194
v_add_f32 v187, v187, v195
s_waitcnt lgkmcnt(8)
v_add_f32 v188, v188, v196
v_add_f32 v189, v189, v197
v_add_f32 v190, v190, v198
v_add_f32 v191, v191, v199
s_waitcnt lgkmcnt(5)
v_add_f32 v200, v200, v208
v_add_f32 v201, v201, v209
v_add_f32 v202, v202, v210
v_add_f32 v203, v203, v211
s_waitcnt lgkmcnt(4)
v_add_f32 v204, v204, v212
v_add_f32 v205, v205, v213
v_add_f32 v206, v206, v214
v_add_f32 v207, v207, v215
s_waitcnt lgkmcnt(1)
v_add_f32 v216, v216, v120
v_add_f32 v217, v217, v121
v_add_f32 v218, v218, v122
v_add_f32 v219, v219, v123
s_waitcnt lgkmcnt(0)
v_add_f32 v220, v220, v124
v_add_f32 v221, v221, v125
v_add_f32 v222, v222, v126
v_add_f32 v223, v223, v127
v_add_f32 v168, v168, v184
v_add_f32 v169, v169, v185
v_add_f32 v170, v170, v186
v_add_f32 v171, v171, v187
v_add_f32 v172, v172, v188
v_add_f32 v173, v173, v189
v_add_f32 v174, v174, v190
v_add_f32 v175, v175, v191
v_add_f32 v200, v200, v216
v_add_f32 v201, v201, v217
v_add_f32 v202, v202, v218
v_add_f32 v203, v203, v219
v_add_f32 v204, v204, v220
v_add_f32 v205, v205, v221
v_add_f32 v206, v206, v222
v_add_f32 v207, v207, v223
v_add_f32 v168, v168, v200
v_add_f32 v169, v169, v201
v_add_f32 v170, v170, v202
v_add_f32 v171, v171, v203
v_add_f32 v172, v172, v204
v_add_f32 v173, v173, v205
v_add_f32 v174, v174, v206
v_add_f32 v175, v175, v207
v_min_u32 v176, -2, v168
v_min_u32 v177, -2, v169
v_min_u32 v178, -2, v170
v_min_u32 v179, -2, v171
v_min_u32 v180, -2, v172
v_min_u32 v181, -2, v173
v_min_u32_e64 v182, -2, v174
v_min_u32 v183, -2, v175
s_lshl_b32 s43, s2, 4
buffer_store_dwordx4 v[176:179], v134, s[32:35], s43 offen sc1
buffer_store_dwordx4 v[180:183], v135, s[32:35], s43 offen sc1
ds_write_b32 v128, v129 offset:4
s_waitcnt lgkmcnt(0)
s_nop 1
Lnopub:
v_mov_b32 v252, v240
s_mov_b32 s77, 0
s_cmp_lg_u32 s40, 0
s_cbranch_scc1 Lnorole
s_cmp_lt_u32 s2, 96
s_cselect_b32 s77, 1, 2
v_mov_b32 v156, -1
v_mov_b32 v157, -1
v_mov_b32 v158, -1
v_mov_b32 v159, -1
v_mov_b32 v160, -1
v_mov_b32 v161, -1
v_mov_b32 v162, -1
v_mov_b32 v163, -1
v_mov_b32 v164, -1
v_mov_b32 v165, -1
v_mov_b32 v166, -1
v_mov_b32 v167, -1
v_mov_b32 v240, -1
v_mov_b32 v241, -1
v_mov_b32 v242, -1
v_mov_b32 v243, -1
s_call_b64 s[78:79], Lpoll
Lnorole:
s_setprio 0
ds_read_b128 v[224:227], v248 offset:47104
ds_read_b128 v[228:231], v248 offset:50176
ds_read_b128 v[232:235], v248 offset:48128
ds_read_b128 v[236:239], v248 offset:51200
s_setprio 2
s_waitcnt lgkmcnt(3)
v_mfma_f32_32x32x16_bf16 v[120:135], v[224:227], v[96:99], 0
s_waitcnt lgkmcnt(2)
ds_read_b128 v[224:227], v248 offset:49152
v_mfma_f32_32x32x16_bf16 v[120:135], v[228:231], v[100:103], v[120:135]
s_waitcnt lgkmcnt(2)
ds_read_b128 v[228:231], v248 offset:52224
v_mfma_f32_32x32x16_bf16 v[120:135], v[232:235], v[104:107], v[120:135]
s_waitcnt lgkmcnt(2)
ds_read_b128 v[232:235], v248 offset:53248
v_mfma_f32_32x32x16_bf16 v[120:135], v[236:239], v[108:111], v[120:135]
s_waitcnt lgkmcnt(2)
ds_read_b128 v[236:239], v248 offset:56320
v_mfma_f32_32x32x16_bf16 v[120:135], v[224:227], v[112:115], v[120:135]
s_waitcnt lgkmcnt(2)
ds_read_b128 v[224:227], v248 offset:54272
v_mfma_f32_32x32x16_bf16 v[120:135], v[228:231], v[116:119], v[120:135]
s_cmp_eq_u32 s77, 0
s_cbranch_scc1 Lpp0
s_getreg_b32 s43, hwreg(HW_REG_IB_STS, 0, 4)
s_cmp_lg_u32 s43, 0
s_cbranch_scc1 Lpp0
s_call_b64 s[78:79], Lpoll
s_setprio 2
Lpp0:
s_nop 9
v_cvt_pkrtz_f16_f32 v137, v120, v121
v_cvt_pkrtz_f16_f32 v139, v122, v123
v_cvt_pkrtz_f16_f32 v141, v124, v125
v_cvt_pkrtz_f16_f32 v143, v126, v127
v_cvt_pkrtz_f16_f32 v145, v128, v129
v_cvt_pk_f16_f32 v155, v130, v131
v_cvt_pk_f16_f32 v152, v132, v133
v_cvt_pk_f16_f32 v149, v134, v135
s_waitcnt lgkmcnt(0)
ds_read_b128 v[228:231], v248 offset:57344
v_mfma_f32_32x32x16_bf16 v[120:135], v[232:235], v[96:99], 0
v_pk_fma_f16 v154, v155, v155, s48
v_and_b32 v137, s49, v137
v_pk_fma_f16 v151, v152, v152, s48
v_and_b32_e64 v139, s49, v139
v_pk_fma_f16 v148, v149, v149, s48
v_pk_mul_f16 v154, v155, v154
v_bfe_u32 v136, v137, 2, 14
v_pk_mul_f16 v151, v152, v151
ds_read_b128 v[232:235], v248 offset:55296
ds_read_u16_d16 v136, v136
v_mfma_f32_32x32x16_bf16 v[120:135], v[236:239], v[100:103], v[120:135]
v_pk_mul_f16 v148, v149, v148
v_bfe_u32 v138, v139, 2, 14
v_exp_f16 v153, v154
v_lshrrev_b32 v137, 18, v137
v_exp_f16 v150, v151
s_setprio 1
v_lshrrev_b32_e64 v139, 18, v139
ds_read_b128 v[236:239], v248 offset:58368
ds_read_u16_d16 v138, v138
ds_read_u16_d16_hi v137, v137
ds_read_u16_d16_hi v139, v139
v_mfma_f32_32x32x16_bf16 v[120:135], v[224:227], v[104:107], v[120:135]
v_exp_f16 v147, v148
v_and_b32 v141, s49, v141
v_and_b32 v143, s49, v143
v_exp_f16_sdwa v153, v154 dst_sel:WORD_1 dst_unused:UNUSED_PRESERVE src0_sel:WORD_1
v_bfe_u32 v140, v141, 2, 14
v_exp_f16_sdwa v150, v151 dst_sel:WORD_1 dst_unused:UNUSED_PRESERVE src0_sel:WORD_1
s_waitcnt lgkmcnt(6)
ds_read_b128 v[224:227], v248 offset:59392
ds_read_u16_d16 v140, v140
v_mfma_f32_32x32x16_bf16 v[120:135], v[228:231], v[108:111], v[120:135]
v_bfe_u32 v142, v143, 2, 14
v_exp_f16_sdwa v147, v148 dst_sel:WORD_1 dst_unused:UNUSED_PRESERVE src0_sel:WORD_1
v_lshrrev_b32_e64 v141, 18, v141
v_pk_add_f16 v153, v153, 1.0 op_sel_hi:[1,0]
v_lshrrev_b32 v143, 18, v143
v_pk_add_f16 v150, v150, 1.0 op_sel_hi:[1,0]
v_pk_add_f16 v147, v147, 1.0 op_sel_hi:[1,0]
s_waitcnt lgkmcnt(6)
ds_read_b128 v[228:231], v248 offset:62464
ds_read_u16_d16 v142, v142
ds_read_u16_d16_hi v141, v141
ds_read_u16_d16_hi v143, v143
v_mfma_f32_32x32x16_bf16 v[120:135], v[232:235], v[112:115], v[120:135]
v_and_b32 v145, s49, v145
v_rcp_f16 v154, v153
v_bfe_u32 v144, v145, 2, 14
v_rcp_f16_e64 v151, v150
v_lshrrev_b32 v145, 18, v145
s_waitcnt lgkmcnt(6)
ds_read_b128 v[232:235], v248 offset:60416
ds_read_u16_d16 v144, v144
ds_read_u16_d16_hi v145, v145
v_mfma_f32_32x32x16_bf16 v[120:135], v[236:239], v[116:119], v[120:135]
v_rcp_f16 v148, v147
v_or_b32 v168, v136, v137
v_or_b32_e64 v169, v138, v139
v_rcp_f16_sdwa v154, v153 dst_sel:WORD_1 dst_unused:UNUSED_PRESERVE src0_sel:WORD_1
s_waitcnt lgkmcnt(4)
v_or_b32 v170, v140, v141
v_rcp_f16_sdwa v151, v150 dst_sel:WORD_1 dst_unused:UNUSED_PRESERVE src0_sel:WORD_1
s_waitcnt lgkmcnt(3)
v_or_b32 v171, v142, v143
v_rcp_f16_sdwa v148, v147 dst_sel:WORD_1 dst_unused:UNUSED_PRESERVE src0_sel:WORD_1
s_waitcnt lgkmcnt(0)
v_or_b32_e64 v172, v144, v145
v_pk_mul_f16 v173, v155, v154
v_pk_mul_f16 v174, v152, v151
v_pk_mul_f16 v175, v149, v148
s_cmp_eq_u32 s77, 0
s_cbranch_scc1 Lpp1
s_getreg_b32 s43, hwreg(HW_REG_IB_STS, 0, 4)
s_cmp_lg_u32 s43, 0
s_cbranch_scc1 Lpp1
s_call_b64 s[78:79], Lpoll
s_setprio 1
Lpp1:
v_cvt_pkrtz_f16_f32 v137, v120, v121
v_cvt_pkrtz_f16_f32 v139, v122, v123
v_cvt_pkrtz_f16_f32 v141, v124, v125
v_cvt_pkrtz_f16_f32 v143, v126, v127
v_cvt_pkrtz_f16_f32 v145, v128, v129
v_cvt_pk_f16_f32 v155, v130, v131
v_cvt_pk_f16_f32 v152, v132, v133
v_cvt_pk_f16_f32 v149, v134, v135
ds_read_b128 v[236:239], v248 offset:63488
v_mfma_f32_32x32x16_bf16 v[120:135], v[224:227], v[96:99], 0
v_pk_fma_f16 v154, v155, v155, s48
v_permlane16_swap_b32 v168, v172
v_and_b32 v137, s49, v137
v_pk_fma_f16 v151, v152, v152, s48
v_and_b32_e64 v139, s49, v139
v_pk_fma_f16 v148, v149, v149, s48
v_pk_mul_f16 v154, v155, v154
v_bfe_u32 v136, v137, 2, 14
v_pk_mul_f16 v151, v152, v151
ds_read_b128 v[224:227], v248 offset:61440
ds_read_u16_d16 v136, v136
v_mfma_f32_32x32x16_bf16 v[120:135], v[228:231], v[100:103], v[120:135]
v_pk_mul_f16 v148, v149, v148
v_bfe_u32 v138, v139, 2, 14
v_exp_f16 v153, v154
v_lshrrev_b32 v137, 18, v137
v_exp_f16 v150, v151
v_permlane16_swap_b32 v169, v173
v_lshrrev_b32_e64 v139, 18, v139
ds_read_b128 v[228:231], v248 offset:64512
ds_read_u16_d16 v138, v138
ds_read_u16_d16_hi v137, v137
ds_read_u16_d16_hi v139, v139
v_mfma_f32_32x32x16_bf16 v[120:135], v[232:235], v[104:107], v[120:135]
v_exp_f16 v147, v148
s_setprio 0
v_and_b32_e64 v141, s49, v141
v_and_b32 v143, s49, v143
v_exp_f16_sdwa v153, v154 dst_sel:WORD_1 dst_unused:UNUSED_PRESERVE src0_sel:WORD_1
v_bfe_u32 v140, v141, 2, 14
v_exp_f16_sdwa v150, v151 dst_sel:WORD_1 dst_unused:UNUSED_PRESERVE src0_sel:WORD_1
s_waitcnt lgkmcnt(6)
ds_read_b128 v[232:235], v249
ds_read_u16_d16 v140, v140
v_mfma_f32_32x32x16_bf16 v[120:135], v[236:239], v[108:111], v[120:135]
v_bfe_u32 v142, v143, 2, 14
v_exp_f16_sdwa v147, v148 dst_sel:WORD_1 dst_unused:UNUSED_PRESERVE src0_sel:WORD_1
v_lshrrev_b32 v141, 18, v141
v_permlane16_swap_b32 v170, v174
v_pk_add_f16 v153, v153, 1.0 op_sel_hi:[1,0]
v_lshrrev_b32 v143, 18, v143
v_pk_add_f16 v150, v150, 1.0 op_sel_hi:[1,0]
v_pk_add_f16 v147, v147, 1.0 op_sel_hi:[1,0]
s_waitcnt lgkmcnt(6)
ds_read_b128 v[236:239], v249 offset:3072
ds_read_u16_d16 v142, v142
ds_read_u16_d16_hi v141, v141
ds_read_u16_d16_hi v143, v143
v_mfma_f32_32x32x16_bf16 v[120:135], v[224:227], v[112:115], v[120:135]
v_and_b32 v145, s49, v145
v_rcp_f16 v154, v153
v_bfe_u32 v144, v145, 2, 14
v_rcp_f16 v151, v150
v_lshrrev_b32 v145, 18, v145
v_rcp_f16 v148, v147
s_waitcnt lgkmcnt(6)
ds_read_b128 v[224:227], v249 offset:1024
ds_read_u16_d16 v144, v144
ds_read_u16_d16_hi v145, v145
v_mfma_f32_32x32x16_bf16 v[120:135], v[228:231], v[116:119], v[120:135]
v_or_b32 v176, v136, v137
v_permlane16_swap_b32 v171, v175
v_or_b32_e64 v177, v138, v139
v_rcp_f16_sdwa v154, v153 dst_sel:WORD_1 dst_unused:UNUSED_PRESERVE src0_sel:WORD_1
s_waitcnt lgkmcnt(4)
v_or_b32 v178, v140, v141
v_rcp_f16_sdwa v151, v150 dst_sel:WORD_1 dst_unused:UNUSED_PRESERVE src0_sel:WORD_1
s_waitcnt lgkmcnt(3)
v_or_b32 v179, v142, v143
v_rcp_f16_sdwa v148, v147 dst_sel:WORD_1 dst_unused:UNUSED_PRESERVE src0_sel:WORD_1
s_waitcnt lgkmcnt(0)
v_or_b32 v180, v144, v145
v_pk_mul_f16 v181, v155, v154
v_pk_mul_f16 v182, v152, v151
v_pk_mul_f16 v183, v149, v148
s_cmp_eq_u32 s77, 0
s_cbranch_scc1 Lpp2
s_getreg_b32 s43, hwreg(HW_REG_IB_STS, 0, 4)
s_cmp_lg_u32 s43, 0
s_cbranch_scc1 Lpp2
s_call_b64 s[78:79], Lpoll
s_setprio 0
Lpp2:
s_setprio 2
v_cvt_pkrtz_f16_f32 v137, v120, v121
v_cvt_pkrtz_f16_f32 v139, v122, v123
v_cvt_pkrtz_f16_f32 v141, v124, v125
v_cvt_pkrtz_f16_f32 v143, v126, v127
v_cvt_pkrtz_f16_f32 v145, v128, v129
v_cvt_pk_f16_f32 v155, v130, v131
v_cvt_pk_f16_f32 v152, v132, v133
v_cvt_pk_f16_f32 v149, v134, v135
ds_read_b128 v[228:231], v249 offset:4096
v_mfma_f32_32x32x16_bf16 v[120:135], v[232:235], v[96:99], 0
v_pk_fma_f16 v154, v155, v155, s48
v_permlane16_swap_b32 v176, v180
v_and_b32 v137, s49, v137
v_pk_fma_f16 v151, v152, v152, s48
v_and_b32_e64 v139, s49, v139
v_pk_fma_f16 v148, v149, v149, s48
v_pk_mul_f16 v154, v155, v154
v_bfe_u32 v136, v137, 2, 14
v_pk_mul_f16 v151, v152, v151
ds_read_b128 v[232:235], v249 offset:2048
ds_read_u16_d16 v136, v136
v_mfma_f32_32x32x16_bf16 v[120:135], v[236:239], v[100:103], v[120:135]
v_pk_mul_f16 v148, v149, v148
v_bfe_u32 v138, v139, 2, 14
v_exp_f16 v153, v154
v_lshrrev_b32 v137, 18, v137
v_exp_f16 v150, v151
v_permlane16_swap_b32 v177, v181
v_lshrrev_b32_e64 v139, 18, v139
ds_read_b128 v[236:239], v249 offset:5120
ds_read_u16_d16 v138, v138
ds_read_u16_d16_hi v137, v137
ds_read_u16_d16_hi v139, v139
v_mfma_f32_32x32x16_bf16 v[120:135], v[224:227], v[104:107], v[120:135]
v_exp_f16 v147, v148
v_and_b32 v141, s49, v141
v_and_b32 v143, s49, v143
v_exp_f16_sdwa v153, v154 dst_sel:WORD_1 dst_unused:UNUSED_PRESERVE src0_sel:WORD_1
v_bfe_u32 v140, v141, 2, 14
v_exp_f16_sdwa v150, v151 dst_sel:WORD_1 dst_unused:UNUSED_PRESERVE src0_sel:WORD_1
s_waitcnt lgkmcnt(6)
ds_read_b128 v[224:227], v249 offset:6144
ds_read_u16_d16 v140, v140
v_mfma_f32_32x32x16_bf16 v[120:135], v[228:231], v[108:111], v[120:135]
v_bfe_u32 v142, v143, 2, 14
v_exp_f16_sdwa v147, v148 dst_sel:WORD_1 dst_unused:UNUSED_PRESERVE src0_sel:WORD_1
v_lshrrev_b32 v141, 18, v141
v_permlane16_swap_b32 v178, v182
v_pk_add_f16 v153, v153, 1.0 op_sel_hi:[1,0]
v_lshrrev_b32 v143, 18, v143
v_pk_add_f16 v150, v150, 1.0 op_sel_hi:[1,0]
v_pk_add_f16 v147, v147, 1.0 op_sel_hi:[1,0]
s_waitcnt lgkmcnt(6)
ds_read_b128 v[228:231], v249 offset:9216
ds_read_u16_d16 v142, v142
ds_read_u16_d16_hi v141, v141
ds_read_u16_d16_hi v143, v143
v_mfma_f32_32x32x16_bf16 v[120:135], v[232:235], v[112:115], v[120:135]
v_and_b32 v145, s49, v145
v_rcp_f16 v154, v153
v_bfe_u32 v144, v145, 2, 14
v_rcp_f16 v151, v150
v_lshrrev_b32 v145, 18, v145
v_rcp_f16 v148, v147
s_waitcnt lgkmcnt(6)
ds_read_b128 v[232:235], v249 offset:7168
ds_read_u16_d16 v144, v144
ds_read_u16_d16_hi v145, v145
v_mfma_f32_32x32x16_bf16 v[120:135], v[236:239], v[116:119], v[120:135]
v_or_b32 v184, v136, v137
v_permlane16_swap_b32 v179, v183
v_or_b32_e64 v185, v138, v139
v_rcp_f16_sdwa v154, v153 dst_sel:WORD_1 dst_unused:UNUSED_PRESERVE src0_sel:WORD_1
s_waitcnt lgkmcnt(4)
v_or_b32 v186, v140, v141
v_rcp_f16_sdwa v151, v150 dst_sel:WORD_1 dst_unused:UNUSED_PRESERVE src0_sel:WORD_1
s_waitcnt lgkmcnt(3)
v_or_b32 v187, v142, v143
v_rcp_f16_sdwa v148, v147 dst_sel:WORD_1 dst_unused:UNUSED_PRESERVE src0_sel:WORD_1
s_waitcnt lgkmcnt(0)
v_or_b32_e64 v188, v144, v145
v_pk_mul_f16 v189, v155, v154
v_pk_mul_f16 v190, v152, v151
v_pk_mul_f16 v191, v149, v148
s_cmp_eq_u32 s77, 0
s_cbranch_scc1 Lpp3
s_getreg_b32 s43, hwreg(HW_REG_IB_STS, 0, 4)
s_cmp_lg_u32 s43, 0
s_cbranch_scc1 Lpp3
s_call_b64 s[78:79], Lpoll
s_setprio 2
Lpp3:
v_cvt_pkrtz_f16_f32 v137, v120, v121
v_cvt_pkrtz_f16_f32 v139, v122, v123
v_cvt_pkrtz_f16_f32 v141, v124, v125
v_cvt_pkrtz_f16_f32 v143, v126, v127
v_cvt_pkrtz_f16_f32 v145, v128, v129
v_cvt_pk_f16_f32 v155, v130, v131
v_cvt_pk_f16_f32 v152, v132, v133
v_cvt_pk_f16_f32 v149, v134, v135
ds_read_b128 v[236:239], v249 offset:10240
v_mfma_f32_32x32x16_bf16 v[120:135], v[224:227], v[96:99], 0
v_pk_fma_f16 v154, v155, v155, s48
v_permlane16_swap_b32 v184, v188
v_and_b32 v137, s49, v137
v_pk_fma_f16 v151, v152, v152, s48
v_and_b32_e64 v139, s49, v139
v_pk_fma_f16 v148, v149, v149, s48
v_pk_mul_f16 v154, v155, v154
v_bfe_u32 v136, v137, 2, 14
v_pk_mul_f16 v151, v152, v151
ds_read_b128 v[224:227], v249 offset:8192
ds_read_u16_d16 v136, v136
v_mfma_f32_32x32x16_bf16 v[120:135], v[228:231], v[100:103], v[120:135]
v_pk_mul_f16 v148, v149, v148
v_bfe_u32 v138, v139, 2, 14
v_exp_f16 v153, v154
v_lshrrev_b32 v137, 18, v137
v_exp_f16 v150, v151
s_setprio 1
v_permlane16_swap_b32 v185, v189
v_lshrrev_b32 v139, 18, v139
ds_read_b128 v[228:231], v249 offset:11264
ds_read_u16_d16 v138, v138
ds_read_u16_d16_hi v137, v137
ds_read_u16_d16_hi v139, v139
v_mfma_f32_32x32x16_bf16 v[120:135], v[232:235], v[104:107], v[120:135]
v_exp_f16 v147, v148
v_and_b32 v141, s49, v141
v_and_b32 v143, s49, v143
v_exp_f16_sdwa v153, v154 dst_sel:WORD_1 dst_unused:UNUSED_PRESERVE src0_sel:WORD_1
v_bfe_u32 v140, v141, 2, 14
v_exp_f16_sdwa v150, v151 dst_sel:WORD_1 dst_unused:UNUSED_PRESERVE src0_sel:WORD_1
s_waitcnt lgkmcnt(6)
ds_read_b128 v[232:235], v249 offset:12288
ds_read_u16_d16 v140, v140
v_mfma_f32_32x32x16_bf16 v[120:135], v[236:239], v[108:111], v[120:135]
v_bfe_u32 v142, v143, 2, 14
v_exp_f16_sdwa v147, v148 dst_sel:WORD_1 dst_unused:UNUSED_PRESERVE src0_sel:WORD_1
v_lshrrev_b32 v141, 18, v141
v_permlane16_swap_b32 v186, v190
v_pk_add_f16 v153, v153, 1.0 op_sel_hi:[1,0]
v_lshrrev_b32 v143, 18, v143
v_pk_add_f16 v150, v150, 1.0 op_sel_hi:[1,0]
v_pk_add_f16 v147, v147, 1.0 op_sel_hi:[1,0]
s_waitcnt lgkmcnt(6)
ds_read_b128 v[236:239], v249 offset:15360
ds_read_u16_d16 v142, v142
ds_read_u16_d16_hi v141, v141
ds_read_u16_d16_hi v143, v143
v_mfma_f32_32x32x16_bf16 v[120:135], v[224:227], v[112:115], v[120:135]
v_and_b32 v145, s49, v145
v_rcp_f16 v154, v153
v_bfe_u32 v144, v145, 2, 14
v_rcp_f16 v151, v150
v_lshrrev_b32 v145, 18, v145
v_rcp_f16 v148, v147
s_waitcnt lgkmcnt(6)
ds_read_b128 v[224:227], v249 offset:13312
ds_read_u16_d16 v144, v144
ds_read_u16_d16_hi v145, v145
v_mfma_f32_32x32x16_bf16 v[120:135], v[228:231], v[116:119], v[120:135]
v_or_b32 v192, v136, v137
v_permlane16_swap_b32 v187, v191
v_or_b32_e64 v193, v138, v139
v_rcp_f16_sdwa v154, v153 dst_sel:WORD_1 dst_unused:UNUSED_PRESERVE src0_sel:WORD_1
s_waitcnt lgkmcnt(4)
v_or_b32 v194, v140, v141
v_rcp_f16_sdwa v151, v150 dst_sel:WORD_1 dst_unused:UNUSED_PRESERVE src0_sel:WORD_1
s_waitcnt lgkmcnt(3)
v_or_b32 v195, v142, v143
v_rcp_f16_sdwa v148, v147 dst_sel:WORD_1 dst_unused:UNUSED_PRESERVE src0_sel:WORD_1
s_waitcnt lgkmcnt(0)
v_or_b32 v196, v144, v145
v_pk_mul_f16 v197, v155, v154
v_pk_mul_f16 v198, v152, v151
v_pk_mul_f16 v199, v149, v148
s_cmp_eq_u32 s77, 0
s_cbranch_scc1 Lpp4
s_getreg_b32 s43, hwreg(HW_REG_IB_STS, 0, 4)
s_cmp_lg_u32 s43, 0
s_cbranch_scc1 Lpp4
s_call_b64 s[78:79], Lpoll
s_setprio 1
Lpp4:
v_mov_b32 v253, 16256
Lw2w:
ds_read_b32 v254, v253 offset:4
s_waitcnt lgkmcnt(0)
v_readfirstlane_b32 s43, v254
s_cmp_eq_u32 s76, 0
s_cbranch_scc1 Lw2x
s_sub_u32 s76, s76, 1
s_cmp_lt_u32 s43, 1
s_cbranch_scc0 Lw2x
s_sleep 2
s_branch Lw2w
Lw2x:
s_add_u32 m0, s72, 7168
s_add_u32 s43, s82, 6208
buffer_load_dwordx4 v252, s[16:19], s43 offen lds
s_add_u32 m0, s72, 8192
s_add_u32 s43, s82, 6272
buffer_load_dwordx4 v252, s[16:19], s43 offen lds
v_cvt_pkrtz_f16_f32 v137, v120, v121
v_cvt_pkrtz_f16_f32 v139, v122, v123
v_cvt_pkrtz_f16_f32 v141, v124, v125
v_cvt_pkrtz_f16_f32 v143, v126, v127
v_cvt_pkrtz_f16_f32 v145, v128, v129
v_cvt_pk_f16_f32 v155, v130, v131
v_cvt_pk_f16_f32 v152, v132, v133
v_cvt_pk_f16_f32 v149, v134, v135
ds_read_b128 v[228:231], v249 offset:16384
v_mfma_f32_32x32x16_bf16 v[120:135], v[232:235], v[96:99], 0
v_pk_fma_f16 v154, v155, v155, s48
v_permlane16_swap_b32 v192, v196
v_and_b32 v137, s49, v137
v_pk_fma_f16 v151, v152, v152, s48
v_and_b32_e64 v139, s49, v139
v_pk_fma_f16 v148, v149, v149, s48
v_pk_mul_f16 v154, v155, v154
v_bfe_u32 v136, v137, 2, 14
v_pk_mul_f16 v151, v152, v151
ds_read_b128 v[232:235], v249 offset:14336
ds_read_u16_d16 v136, v136
v_mfma_f32_32x32x16_bf16 v[120:135], v[236:239], v[100:103], v[120:135]
v_pk_mul_f16 v148, v149, v148
v_bfe_u32 v138, v139, 2, 14
v_exp_f16 v153, v154
v_lshrrev_b32 v137, 18, v137
v_exp_f16 v150, v151
v_permlane16_swap_b32 v193, v197
v_lshrrev_b32_e64 v139, 18, v139
ds_read_b128 v[236:239], v249 offset:17408
ds_read_u16_d16 v138, v138
ds_read_u16_d16_hi v137, v137
ds_read_u16_d16_hi v139, v139
v_mfma_f32_32x32x16_bf16 v[120:135], v[224:227], v[104:107], v[120:135]
v_exp_f16 v147, v148
s_setprio 0
v_and_b32_e64 v141, s49, v141
v_and_b32 v143, s49, v143
v_exp_f16_sdwa v153, v154 dst_sel:WORD_1 dst_unused:UNUSED_PRESERVE src0_sel:WORD_1
v_bfe_u32 v140, v141, 2, 14
v_exp_f16_sdwa v150, v151 dst_sel:WORD_1 dst_unused:UNUSED_PRESERVE src0_sel:WORD_1
s_waitcnt lgkmcnt(6)
ds_read_b128 v[224:227], v249 offset:18432
ds_read_u16_d16 v140, v140
v_mfma_f32_32x32x16_bf16 v[120:135], v[228:231], v[108:111], v[120:135]
v_bfe_u32 v142, v143, 2, 14
v_exp_f16_sdwa v147, v148 dst_sel:WORD_1 dst_unused:UNUSED_PRESERVE src0_sel:WORD_1
v_lshrrev_b32 v141, 18, v141
v_permlane16_swap_b32 v194, v198
v_pk_add_f16 v153, v153, 1.0 op_sel_hi:[1,0]
v_lshrrev_b32 v143, 18, v143
v_pk_add_f16 v150, v150, 1.0 op_sel_hi:[1,0]
v_pk_add_f16 v147, v147, 1.0 op_sel_hi:[1,0]
s_waitcnt lgkmcnt(6)
ds_read_b128 v[228:231], v249 offset:21504
ds_read_u16_d16 v142, v142
ds_read_u16_d16_hi v141, v141
ds_read_u16_d16_hi v143, v143
v_mfma_f32_32x32x16_bf16 v[120:135], v[232:235], v[112:115], v[120:135]
v_and_b32 v145, s49, v145
v_rcp_f16 v154, v153
v_bfe_u32 v144, v145, 2, 14
v_rcp_f16 v151, v150
v_lshrrev_b32 v145, 18, v145
v_rcp_f16 v148, v147
s_waitcnt lgkmcnt(6)
ds_read_b128 v[232:235], v249 offset:19456
ds_read_u16_d16 v144, v144
ds_read_u16_d16_hi v145, v145
v_mfma_f32_32x32x16_bf16 v[120:135], v[236:239], v[116:119], v[120:135]
v_or_b32 v200, v136, v137
v_permlane16_swap_b32 v195, v199
v_or_b32_e64 v201, v138, v139
v_rcp_f16_sdwa v154, v153 dst_sel:WORD_1 dst_unused:UNUSED_PRESERVE src0_sel:WORD_1
s_waitcnt lgkmcnt(4)
v_or_b32 v202, v140, v141
v_rcp_f16_sdwa v151, v150 dst_sel:WORD_1 dst_unused:UNUSED_PRESERVE src0_sel:WORD_1
s_waitcnt lgkmcnt(3)
v_or_b32 v203, v142, v143
v_rcp_f16_sdwa v148, v147 dst_sel:WORD_1 dst_unused:UNUSED_PRESERVE src0_sel:WORD_1
s_waitcnt lgkmcnt(0)
v_or_b32 v204, v144, v145
v_pk_mul_f16 v205, v155, v154
v_pk_mul_f16 v206, v152, v151
v_pk_mul_f16 v207, v149, v148
s_cmp_eq_u32 s77, 0
s_cbranch_scc1 Lpp5
s_getreg_b32 s43, hwreg(HW_REG_IB_STS, 0, 4)
s_cmp_lg_u32 s43, 0
s_cbranch_scc1 Lpp5
s_call_b64 s[78:79], Lpoll
s_setprio 0
Lpp5:
s_setprio 2
v_cvt_pkrtz_f16_f32 v137, v120, v121
v_cvt_pkrtz_f16_f32 v139, v122, v123
v_cvt_pkrtz_f16_f32 v141, v124, v125
v_cvt_pkrtz_f16_f32 v143, v126, v127
v_cvt_pkrtz_f16_f32 v145, v128, v129
v_cvt_pk_f16_f32 v155, v130, v131
v_cvt_pk_f16_f32 v152, v132, v133
v_cvt_pk_f16_f32 v149, v134, v135
ds_read_b128 v[236:239], v249 offset:22528
v_mfma_f32_32x32x16_bf16 v[120:135], v[224:227], v[96:99], 0
v_pk_fma_f16 v154, v155, v155, s48
v_permlane16_swap_b32 v200, v204
v_and_b32 v137, s49, v137
v_pk_fma_f16 v151, v152, v152, s48
v_and_b32_e64 v139, s49, v139
v_pk_fma_f16 v148, v149, v149, s48
v_pk_mul_f16 v154, v155, v154
v_bfe_u32 v136, v137, 2, 14
v_pk_mul_f16 v151, v152, v151
ds_read_b128 v[224:227], v249 offset:20480
ds_read_u16_d16 v136, v136
v_mfma_f32_32x32x16_bf16 v[120:135], v[228:231], v[100:103], v[120:135]
v_pk_mul_f16 v148, v149, v148
v_bfe_u32 v138, v139, 2, 14
v_exp_f16 v153, v154
v_lshrrev_b32 v137, 18, v137
v_exp_f16 v150, v151
v_permlane16_swap_b32 v201, v205
v_lshrrev_b32_e64 v139, 18, v139
ds_read_b128 v[228:231], v249 offset:23552
ds_read_u16_d16 v138, v138
ds_read_u16_d16_hi v137, v137
ds_read_u16_d16_hi v139, v139
v_mfma_f32_32x32x16_bf16 v[120:135], v[232:235], v[104:107], v[120:135]
v_exp_f16 v147, v148
v_and_b32 v141, s49, v141
v_and_b32 v143, s49, v143
v_exp_f16_sdwa v153, v154 dst_sel:WORD_1 dst_unused:UNUSED_PRESERVE src0_sel:WORD_1
v_bfe_u32 v140, v141, 2, 14
v_exp_f16_sdwa v150, v151 dst_sel:WORD_1 dst_unused:UNUSED_PRESERVE src0_sel:WORD_1
s_waitcnt lgkmcnt(6)
ds_read_u16_d16 v140, v140
v_mfma_f32_32x32x16_bf16 v[120:135], v[236:239], v[108:111], v[120:135]
v_bfe_u32 v142, v143, 2, 14
v_exp_f16_sdwa v147, v148 dst_sel:WORD_1 dst_unused:UNUSED_PRESERVE src0_sel:WORD_1
v_lshrrev_b32 v141, 18, v141
v_permlane16_swap_b32 v202, v206
v_pk_add_f16 v153, v153, 1.0 op_sel_hi:[1,0]
v_lshrrev_b32 v143, 18, v143
v_pk_add_f16 v150, v150, 1.0 op_sel_hi:[1,0]
v_pk_add_f16 v147, v147, 1.0 op_sel_hi:[1,0]
s_waitcnt lgkmcnt(5)
ds_read_u16_d16 v142, v142
ds_read_u16_d16_hi v141, v141
ds_read_u16_d16_hi v143, v143
v_mfma_f32_32x32x16_bf16 v[120:135], v[224:227], v[112:115], v[120:135]
v_and_b32 v145, s49, v145
v_rcp_f16 v154, v153
v_bfe_u32 v144, v145, 2, 14
v_rcp_f16 v151, v150
v_lshrrev_b32 v145, 18, v145
v_rcp_f16 v148, v147
s_waitcnt lgkmcnt(4)
ds_read_u16_d16 v144, v144
ds_read_u16_d16_hi v145, v145
v_mfma_f32_32x32x16_bf16 v[120:135], v[228:231], v[116:119], v[120:135]
v_or_b32 v208, v136, v137
v_permlane16_swap_b32 v203, v207
v_or_b32_e64 v209, v138, v139
v_rcp_f16_sdwa v154, v153 dst_sel:WORD_1 dst_unused:UNUSED_PRESERVE src0_sel:WORD_1
s_waitcnt lgkmcnt(3)
v_or_b32 v210, v140, v141
v_rcp_f16_sdwa v151, v150 dst_sel:WORD_1 dst_unused:UNUSED_PRESERVE src0_sel:WORD_1
s_waitcnt lgkmcnt(2)
v_or_b32 v211, v142, v143
v_rcp_f16_sdwa v148, v147 dst_sel:WORD_1 dst_unused:UNUSED_PRESERVE src0_sel:WORD_1
s_waitcnt lgkmcnt(0)
v_or_b32_e64 v212, v144, v145
v_pk_mul_f16 v213, v155, v154
v_pk_mul_f16 v214, v152, v151
v_pk_mul_f16 v215, v149, v148
s_cmp_eq_u32 s77, 0
s_cbranch_scc1 Lpp6
s_getreg_b32 s43, hwreg(HW_REG_IB_STS, 0, 4)
s_cmp_lg_u32 s43, 0
s_cbranch_scc1 Lpp6
s_call_b64 s[78:79], Lpoll
s_setprio 2
Lpp6:
v_cvt_pkrtz_f16_f32 v137, v120, v121
v_cvt_pkrtz_f16_f32 v139, v122, v123
v_cvt_pkrtz_f16_f32 v141, v124, v125
v_cvt_pkrtz_f16_f32 v143, v126, v127
v_cvt_pkrtz_f16_f32 v145, v128, v129
v_cvt_pk_f16_f32 v155, v130, v131
v_cvt_pk_f16_f32 v152, v132, v133
v_cvt_pk_f16_f32 v149, v134, v135
v_pk_fma_f16 v154, v155, v155, s48
v_permlane16_swap_b32 v96, v100
v_permlane16_swap_b32 v208, v212
v_and_b32_e64 v137, s49, v137
v_pk_fma_f16 v151, v152, v152, s48
v_and_b32 v139, s49, v139
v_pk_fma_f16 v148, v149, v149, s48
v_permlane16_swap_b32 v97, v101
v_pk_mul_f16 v154, v155, v154
v_bfe_u32 v136, v137, 2, 14
v_pk_mul_f16 v151, v152, v151
v_pk_mul_f16 v148, v149, v148
v_bfe_u32 v138, v139, 2, 14
v_permlane16_swap_b32 v98, v102
v_exp_f16 v153, v154
v_lshrrev_b32 v137, 18, v137
v_exp_f16 v150, v151
v_permlane16_swap_b32 v99, v103
s_setprio 1
v_permlane16_swap_b32 v209, v213
v_lshrrev_b32 v139, 18, v139
v_exp_f16 v147, v148
v_and_b32 v141, s49, v141
v_permlane16_swap_b32 v104, v108
v_and_b32 v143, s49, v143
ds_read_u16_d16 v136, v136
ds_read_u16_d16 v138, v138
ds_read_u16_d16_hi v137, v137
ds_read_u16_d16_hi v139, v139
v_exp_f16_sdwa v153, v154 dst_sel:WORD_1 dst_unused:UNUSED_PRESERVE src0_sel:WORD_1
v_bfe_u32 v140, v141, 2, 14
v_exp_f16_sdwa v150, v151 dst_sel:WORD_1 dst_unused:UNUSED_PRESERVE src0_sel:WORD_1
v_permlane16_swap_b32 v105, v109
v_bfe_u32 v142, v143, 2, 14
v_exp_f16_sdwa v147, v148 dst_sel:WORD_1 dst_unused:UNUSED_PRESERVE src0_sel:WORD_1
v_lshrrev_b32 v141, 18, v141
v_permlane16_swap_b32 v106, v110
v_permlane16_swap_b32 v210, v214
v_pk_add_f16 v153, v153, 1.0 op_sel_hi:[1,0]
v_lshrrev_b32_e64 v143, 18, v143
v_pk_add_f16 v150, v150, 1.0 op_sel_hi:[1,0]
v_pk_add_f16 v147, v147, 1.0 op_sel_hi:[1,0]
v_permlane16_swap_b32 v107, v111
v_and_b32 v145, s49, v145
v_rcp_f16_e64 v154, v153
v_bfe_u32 v144, v145, 2, 14
v_rcp_f16 v151, v150
v_permlane16_swap_b32 v112, v116
v_lshrrev_b32_e64 v145, 18, v145
ds_read_u16_d16 v140, v140
ds_read_u16_d16 v142, v142
ds_read_u16_d16_hi v141, v141
ds_read_u16_d16_hi v143, v143
ds_read_u16_d16 v144, v144
ds_read_u16_d16_hi v145, v145
v_rcp_f16 v148, v147
s_waitcnt lgkmcnt(6)
v_or_b32 v216, v136, v137
v_permlane16_swap_b32 v113, v117
v_permlane16_swap_b32 v211, v215
v_or_b32 v217, v138, v139
v_rcp_f16_sdwa v154, v153 dst_sel:WORD_1 dst_unused:UNUSED_PRESERVE src0_sel:WORD_1
s_waitcnt lgkmcnt(3)
v_or_b32 v218, v140, v141
v_permlane16_swap_b32 v114, v118
v_rcp_f16_sdwa v151, v150 dst_sel:WORD_1 dst_unused:UNUSED_PRESERVE src0_sel:WORD_1
s_waitcnt lgkmcnt(2)
v_or_b32_e64 v219, v142, v143
v_rcp_f16_sdwa v148, v147 dst_sel:WORD_1 dst_unused:UNUSED_PRESERVE src0_sel:WORD_1
v_permlane16_swap_b32 v115, v119
s_waitcnt lgkmcnt(0)
v_or_b32_e64 v220, v144, v145
v_pk_mul_f16 v221, v155, v154
v_pk_mul_f16 v222, v152, v151
v_pk_mul_f16 v223, v149, v148
s_cmp_eq_u32 s77, 0
s_cbranch_scc1 Lpp7
s_getreg_b32 s43, hwreg(HW_REG_IB_STS, 0, 4)
s_cmp_lg_u32 s43, 0
s_cbranch_scc1 Lpp7
s_call_b64 s[78:79], Lpoll
s_setprio 1
Lpp7:
v_permlane16_swap_b32 v216, v220
v_permlane16_swap_b32 v217, v221
s_setprio 0
v_permlane16_swap_b32 v218, v222
v_permlane16_swap_b32 v219, v223
s_cmp_eq_u32 s77, 0
s_cbranch_scc1 Lpp8
s_getreg_b32 s43, hwreg(HW_REG_IB_STS, 0, 4)
s_cmp_lg_u32 s43, 0
s_cbranch_scc1 Lpp8
s_call_b64 s[78:79], Lpoll
s_setprio 0
Lpp8:
s_setprio 2
v_lshrrev_b32_e64 v225, 5, v251
v_lshl_add_u32 v224, v225, 9, s72
v_lshl_add_u32 v226, v225, 4, s72
v_and_b32 v225, 15, v251
v_lshl_add_u32 v224, v225, 4, v224
v_bfe_u32 v225, v251, 4, 1
v_lshl_add_u32 v224, v225, 3, v224
s_waitcnt vmcnt(0)
ds_read_b64_tr_b16 v[120:121], v224
ds_read_b64_tr_b16 v[122:123], v224 offset:256
ds_read_b64_tr_b16 v[124:125], v224 offset:1024
ds_read_b64_tr_b16 v[126:127], v224 offset:1280
ds_read_b64_tr_b16 v[128:129], v224 offset:2048
ds_read_b64_tr_b16 v[130:131], v224 offset:2304
ds_read_b64_tr_b16 v[132:133], v224 offset:3072
ds_read_b64_tr_b16 v[134:135], v224 offset:3328
ds_read_b64_tr_b16 v[136:137], v224 offset:4096
ds_read_b64_tr_b16 v[138:139], v224 offset:4352
ds_read_b64_tr_b16 v[140:141], v224 offset:5120
ds_read_b64_tr_b16 v[142:143], v224 offset:5376
ds_read_b64_tr_b16 v[144:145], v224 offset:6144
ds_read_b64_tr_b16 v[146:147], v224 offset:6400
ds_read_b64_tr_b16 v[148:149], v224 offset:7168
ds_read_b64_tr_b16 v[150:151], v224 offset:7424
ds_read_b64_tr_b16 v[152:153], v224 offset:8192
ds_read_b64_tr_b16 v[154:155], v224 offset:8448
v_lshrrev_b32 v225, 4, v251
v_and_b32 v227, 15, v251
v_mul_u32_u24 v252, 192, v227
v_lshl_add_u32 v252, v225, 4, v252
v_lshlrev_b32 v254, 5, v225
v_and_b32 v253, 47, v251
v_lshlrev_b32 v253, 4, v253
v_and_b32 v225, 1, v225
v_mul_u32_u24 v227, 3072, v225
v_add_u32_e64 v248, v227, v253
v_add_u32 v249, 65536, v248
v_add_u32 v250, 131072, v248
v_lshl_add_u32 v253, v225, 21, v253
v_mov_b32 v225, 16256
v_mov_b32_e64 v227, 1
s_waitcnt lgkmcnt(0)
s_mov_b64 exec, 1
ds_add_u32 v225, v227 offset:8
s_mov_b64 exec, -1
v_lshlrev_b32 v228, 16, v120
v_and_b32 v229, 4294901760, v120
v_cvt_pk_f16_f32 v120, v228, v229
v_lshlrev_b32_e64 v230, 16, v121
v_and_b32 v231, 4294901760, v121
v_cvt_pk_f16_f32 v121, v230, v231
v_lshlrev_b32_e64 v228, 16, v122
v_and_b32 v229, 4294901760, v122
v_cvt_pk_f16_f32 v122, v228, v229
v_lshlrev_b32_e64 v230, 16, v123
v_and_b32 v231, 4294901760, v123
v_cvt_pk_f16_f32 v123, v230, v231
v_lshlrev_b32_e64 v228, 16, v124
v_and_b32 v229, 4294901760, v124
v_cvt_pk_f16_f32 v124, v228, v229
v_lshlrev_b32_e64 v230, 16, v125
v_and_b32 v231, 4294901760, v125
v_cvt_pk_f16_f32 v125, v230, v231
v_lshlrev_b32_e64 v228, 16, v126
v_and_b32 v229, 4294901760, v126
v_cvt_pk_f16_f32 v126, v228, v229
v_lshlrev_b32_e64 v230, 16, v127
v_and_b32 v231, 4294901760, v127
v_cvt_pk_f16_f32 v127, v230, v231
v_lshlrev_b32_e64 v228, 16, v128
v_and_b32 v229, 4294901760, v128
v_cvt_pk_f16_f32 v128, v228, v229
v_lshlrev_b32_e64 v230, 16, v129
v_and_b32 v231, 4294901760, v129
v_cvt_pk_f16_f32 v129, v230, v231
v_lshlrev_b32_e64 v228, 16, v130
v_and_b32 v229, 4294901760, v130
v_cvt_pk_f16_f32 v130, v228, v229
v_lshlrev_b32_e64 v230, 16, v131
v_and_b32 v231, 4294901760, v131
v_cvt_pk_f16_f32 v131, v230, v231
s_cmp_eq_u32 s77, 0
s_cbranch_scc1 Lpp911
s_getreg_b32 s43, hwreg(HW_REG_IB_STS, 0, 4)
s_cmp_lg_u32 s43, 0
s_cbranch_scc1 Lpp911
s_call_b64 s[78:79], Lpoll
s_setprio 2
Lpp911:
v_lshlrev_b32 v228, 16, v132
v_and_b32 v229, 4294901760, v132
v_cvt_pk_f16_f32 v132, v228, v229
v_lshlrev_b32_e64 v230, 16, v133
v_and_b32 v231, 4294901760, v133
v_cvt_pk_f16_f32 v133, v230, v231
v_lshlrev_b32_e64 v228, 16, v134
v_and_b32 v229, 4294901760, v134
v_cvt_pk_f16_f32 v134, v228, v229
v_lshlrev_b32_e64 v230, 16, v135
v_and_b32 v231, 4294901760, v135
v_cvt_pk_f16_f32 v135, v230, v231
v_lshlrev_b32_e64 v228, 16, v136
v_and_b32 v229, 4294901760, v136
v_cvt_pk_f16_f32 v136, v228, v229
v_lshlrev_b32_e64 v230, 16, v137
v_and_b32 v231, 4294901760, v137
v_cvt_pk_f16_f32 v137, v230, v231
v_lshlrev_b32_e64 v228, 16, v138
v_and_b32 v229, 4294901760, v138
v_cvt_pk_f16_f32 v138, v228, v229
v_lshlrev_b32_e64 v230, 16, v139
v_and_b32 v231, 4294901760, v139
v_cvt_pk_f16_f32 v139, v230, v231
v_lshlrev_b32_e64 v228, 16, v140
v_and_b32 v229, 4294901760, v140
v_cvt_pk_f16_f32 v140, v228, v229
v_lshlrev_b32_e64 v230, 16, v141
v_and_b32 v231, 4294901760, v141
v_cvt_pk_f16_f32 v141, v230, v231
v_lshlrev_b32_e64 v228, 16, v142
v_and_b32 v229, 4294901760, v142
v_cvt_pk_f16_f32 v142, v228, v229
v_lshlrev_b32_e64 v230, 16, v143
v_and_b32 v231, 4294901760, v143
v_cvt_pk_f16_f32 v143, v230, v231
s_cmp_eq_u32 s77, 0
s_cbranch_scc1 Lpp923
s_getreg_b32 s43, hwreg(HW_REG_IB_STS, 0, 4)
s_cmp_lg_u32 s43, 0
s_cbranch_scc1 Lpp923
s_call_b64 s[78:79], Lpoll
s_setprio 2
Lpp923:
v_lshlrev_b32 v228, 16, v144
v_and_b32 v229, 4294901760, v144
v_cvt_pk_f16_f32 v144, v228, v229
v_lshlrev_b32_e64 v230, 16, v145
v_and_b32 v231, 4294901760, v145
v_cvt_pk_f16_f32 v145, v230, v231
v_lshlrev_b32_e64 v228, 16, v146
v_and_b32 v229, 4294901760, v146
v_cvt_pk_f16_f32 v146, v228, v229
v_lshlrev_b32_e64 v230, 16, v147
v_and_b32 v231, 4294901760, v147
v_cvt_pk_f16_f32 v147, v230, v231
v_lshlrev_b32_e64 v228, 16, v148
v_and_b32 v229, 4294901760, v148
v_cvt_pk_f16_f32 v148, v228, v229
v_lshlrev_b32_e64 v230, 16, v149
v_and_b32 v231, 4294901760, v149
v_cvt_pk_f16_f32 v149, v230, v231
v_lshlrev_b32_e64 v228, 16, v150
v_and_b32 v229, 4294901760, v150
v_cvt_pk_f16_f32 v150, v228, v229
v_lshlrev_b32_e64 v230, 16, v151
v_and_b32 v231, 4294901760, v151
v_cvt_pk_f16_f32 v151, v230, v231
v_lshlrev_b32_e64 v228, 16, v152
v_and_b32 v229, 4294901760, v152
v_cvt_pk_f16_f32 v152, v228, v229
v_lshlrev_b32_e64 v230, 16, v153
v_and_b32 v231, 4294901760, v153
v_cvt_pk_f16_f32 v153, v230, v231
v_lshlrev_b32_e64 v228, 16, v154
v_and_b32 v229, 4294901760, v154
v_cvt_pk_f16_f32 v154, v228, v229
v_lshlrev_b32_e64 v230, 16, v155
v_and_b32 v231, 4294901760, v155
v_cvt_pk_f16_f32 v155, v230, v231
s_cmp_eq_u32 s77, 0
s_cbranch_scc1 Lpp935
s_getreg_b32 s43, hwreg(HW_REG_IB_STS, 0, 4)
s_cmp_lg_u32 s43, 0
s_cbranch_scc1 Lpp935
s_call_b64 s[78:79], Lpoll
s_setprio 2
Lpp935:
v_lshl_add_u32 v224, v251, 4, s72
s_cmp_lg_u32 s40, 0
s_cbranch_scc1 Lnofin
Lspin:
s_cmp_eq_u32 s77, 0
s_cbranch_scc1 Lspinx
s_cmp_eq_u32 s76, 0
s_cbranch_scc1 Lspinx
s_sub_u32 s76, s76, 1
s_call_b64 s[78:79], Lpoll
s_branch Lspin
Lspinx:
v_add_u32_e64 v162, 0, v251
v_mul_u32_u24 v165, 2731, v162
v_lshrrev_b32_e64 v165, 16, v165
v_mul_u32_u24 v165, 9120, v165
v_lshl_add_u32 v162, v162, 2, v165
v_add_u32 v162, 90112, v162
v_add_u32_e64 v163, 64, v251
v_mul_u32_u24 v165, 2731, v163
v_lshrrev_b32_e64 v165, 16, v165
v_mul_u32_u24 v165, 9120, v165
v_lshl_add_u32 v163, v163, 2, v165
v_add_u32 v163, 90112, v163
v_add_u32 v164, 128, v251
v_mul_u32_u24 v165, 2731, v164
v_lshrrev_b32_e64 v165, 16, v165
v_mul_u32_u24 v165, 9120, v165
v_lshl_add_u32 v164, v164, 2, v165
v_add_u32 v164, 90112, v164
v_mov_b32 v165, 16256
Lrrw:
ds_read_b32 v166, v165 offset:8
s_waitcnt lgkmcnt(0)
v_readfirstlane_b32 s43, v166
s_cmp_eq_u32 s76, 0
s_cbranch_scc1 Lrrx
s_sub_u32 s76, s76, 1
s_cmp_lt_u32 s43, 8
s_cbranch_scc0 Lrrx
s_sleep 2
s_branch Lrrw
Lrrx:
ds_write_b32 v162, v244
ds_write_b32 v163, v245
ds_write_b32 v164, v246
Lnofin:
s_waitcnt lgkmcnt(0)
s_barrier
ds_read_b128 v[228:231], v226
ds_read_b128 v[232:235], v226 offset:32
ds_read_b128 v[236:239], v226 offset:64
buffer_load_dwordx4 v[240:243], v252, s[4:7], s71 offen
buffer_load_dwordx4 v[244:247], v252, s[4:7], s71 offen offset:64
s_waitcnt lgkmcnt(0)
v_pk_mul_f16 v120, v120, v228
v_pk_mul_f16 v121, v121, v229
v_pk_mul_f16 v122, v122, v230
v_pk_mul_f16 v123, v123, v231
ds_write_b128 v224, v[120:123]
v_pk_mul_f16 v124, v124, v228
v_pk_mul_f16 v125, v125, v229
v_pk_mul_f16 v126, v126, v230
v_pk_mul_f16 v127, v127, v231
ds_write_b128 v224, v[124:127] offset:1024
v_pk_mul_f16 v128, v128, v228
v_pk_mul_f16 v129, v129, v229
v_pk_mul_f16 v130, v130, v230
v_pk_mul_f16 v131, v131, v231
ds_write_b128 v224, v[128:131] offset:2048
v_pk_mul_f16 v132, v132, v232
v_pk_mul_f16 v133, v133, v233
v_pk_mul_f16 v134, v134, v234
v_pk_mul_f16 v135, v135, v235
ds_write_b128 v224, v[132:135] offset:3072
v_pk_mul_f16 v136, v136, v232
v_pk_mul_f16 v137, v137, v233
v_pk_mul_f16 v138, v138, v234
v_pk_mul_f16 v139, v139, v235
ds_write_b128 v224, v[136:139] offset:4096
v_pk_mul_f16 v140, v140, v232
v_pk_mul_f16 v141, v141, v233
v_pk_mul_f16 v142, v142, v234
v_pk_mul_f16 v143, v143, v235
ds_write_b128 v224, v[140:143] offset:5120
v_pk_mul_f16 v144, v144, v236
v_pk_mul_f16 v145, v145, v237
v_pk_mul_f16 v146, v146, v238
v_pk_mul_f16 v147, v147, v239
ds_write_b128 v224, v[144:147] offset:6144
v_pk_mul_f16 v148, v148, v236
v_pk_mul_f16 v149, v149, v237
v_pk_mul_f16 v150, v150, v238
v_pk_mul_f16 v151, v151, v239
ds_write_b128 v224, v[148:151] offset:7168
v_pk_mul_f16 v152, v152, v236
v_pk_mul_f16 v153, v153, v237
v_pk_mul_f16 v154, v154, v238
v_pk_mul_f16 v155, v155, v239
ds_write_b128 v224, v[152:155] offset:8192
s_waitcnt lgkmcnt(0)
s_barrier
s_setprio 3
ds_read_b128 v[224:227], v249 offset:24576
ds_read_b128 v[228:231], v254 offset:7936
ds_read_b128 v[232:235], v249 offset:24832
ds_read_b128 v[236:239], v254 offset:7952
s_waitcnt lgkmcnt(2)
v_mfma_f32_16x16x32_f16 v[120:123], v[224:227], v[0:3], v[228:231]
v_mfma_f32_16x16x32_f16 v[128:131], v[224:227], v[4:7], v[228:231]
s_waitcnt lgkmcnt(0)
v_mfma_f32_16x16x32_f16 v[124:127], v[232:235], v[0:3], v[236:239]
ds_read_b128 v[224:227], v249 offset:25600
ds_read_b128 v[228:231], v254 offset:8064
v_mfma_f32_16x16x32_f16 v[132:135], v[232:235], v[4:7], v[236:239]
s_waitcnt lgkmcnt(0)
v_mfma_f32_16x16x32_f16 v[136:139], v[224:227], v[0:3], v[228:231]
ds_read_b128 v[232:235], v249 offset:25856
ds_read_b128 v[236:239], v254 offset:8080
v_mfma_f32_16x16x32_f16 v[144:147], v[224:227], v[4:7], v[228:231]
s_waitcnt lgkmcnt(0)
v_mfma_f32_16x16x32_f16 v[140:143], v[232:235], v[0:3], v[236:239]
ds_read_b128 v[224:227], v249 offset:26624
ds_read_b128 v[228:231], v254 offset:16128
v_mfma_f32_16x16x32_f16 v[148:151], v[232:235], v[4:7], v[236:239]
s_waitcnt lgkmcnt(0)
v_mfma_f32_16x16x32_f16 v[152:155], v[224:227], v[0:3], v[228:231]
ds_read_b128 v[232:235], v249 offset:26880
ds_read_b128 v[236:239], v254 offset:16144
v_mfma_f32_16x16x32_f16 v[160:163], v[224:227], v[4:7], v[228:231]
s_waitcnt lgkmcnt(0)
v_mfma_f32_16x16x32_f16 v[156:159], v[232:235], v[0:3], v[236:239]
ds_read_b128 v[224:227], v249 offset:30720
ds_read_b128 v[228:231], v249 offset:30976
v_mfma_f32_16x16x32_f16 v[164:167], v[232:235], v[4:7], v[236:239]
s_waitcnt lgkmcnt(1)
v_mfma_f32_16x16x32_f16 v[120:123], v[224:227], v[8:11], v[120:123]
ds_read_b128 v[232:235], v249 offset:31744
ds_read_b128 v[236:239], v249 offset:32000
v_mfma_f32_16x16x32_f16 v[128:131], v[224:227], v[12:15], v[128:131]
s_waitcnt lgkmcnt(2)
v_mfma_f32_16x16x32_f16 v[124:127], v[228:231], v[8:11], v[124:127]
ds_read_b128 v[224:227], v249 offset:32768
v_mfma_f32_16x16x32_f16 v[132:135], v[228:231], v[12:15], v[132:135]
s_waitcnt lgkmcnt(2)
v_mfma_f32_16x16x32_f16 v[136:139], v[232:235], v[8:11], v[136:139]
ds_read_b128 v[228:231], v249 offset:33024
v_mfma_f32_16x16x32_f16 v[144:147], v[232:235], v[12:15], v[144:147]
s_waitcnt lgkmcnt(2)
v_mfma_f32_16x16x32_f16 v[140:143], v[236:239], v[8:11], v[140:143]
ds_read_b128 v[232:235], v249 offset:36864
v_mfma_f32_16x16x32_f16 v[148:151], v[236:239], v[12:15], v[148:151]
s_waitcnt lgkmcnt(2)
v_mfma_f32_16x16x32_f16 v[152:155], v[224:227], v[8:11], v[152:155]
ds_read_b128 v[236:239], v249 offset:37120
v_mfma_f32_16x16x32_f16 v[160:163], v[224:227], v[12:15], v[160:163]
s_waitcnt lgkmcnt(2)
v_mfma_f32_16x16x32_f16 v[156:159], v[228:231], v[8:11], v[156:159]
ds_read_b128 v[224:227], v249 offset:37888
v_mfma_f32_16x16x32_f16 v[164:167], v[228:231], v[12:15], v[164:167]
s_waitcnt lgkmcnt(2)
v_mfma_f32_16x16x32_f16 v[120:123], v[232:235], v[16:19], v[120:123]
buffer_load_dwordx4 v[12:15], v252, s[4:7], s71 offen offset:128
ds_read_b128 v[228:231], v249 offset:38144
v_mfma_f32_16x16x32_f16 v[128:131], v[232:235], v[20:23], v[128:131]
s_waitcnt lgkmcnt(2)
v_mfma_f32_16x16x32_f16 v[124:127], v[236:239], v[16:19], v[124:127]
ds_read_b128 v[232:235], v249 offset:38912
v_mfma_f32_16x16x32_f16 v[132:135], v[236:239], v[20:23], v[132:135]
s_waitcnt lgkmcnt(2)
v_mfma_f32_16x16x32_f16 v[136:139], v[224:227], v[16:19], v[136:139]
ds_read_b128 v[236:239], v249 offset:39168
v_mfma_f32_16x16x32_f16 v[144:147], v[224:227], v[20:23], v[144:147]
s_waitcnt lgkmcnt(2)
v_mfma_f32_16x16x32_f16 v[140:143], v[228:231], v[16:19], v[140:143]
s_add_u32 s46, s71, 98304
buffer_load_dwordx4 v[8:11], v252, s[4:7], s46 offen
ds_read_b128 v[224:227], v249 offset:43008
v_mfma_f32_16x16x32_f16 v[148:151], v[228:231], v[20:23], v[148:151]
s_waitcnt lgkmcnt(2)
v_mfma_f32_16x16x32_f16 v[152:155], v[232:235], v[16:19], v[152:155]
ds_read_b128 v[228:231], v249 offset:43264
v_mfma_f32_16x16x32_f16 v[160:163], v[232:235], v[20:23], v[160:163]
s_waitcnt lgkmcnt(2)
v_mfma_f32_16x16x32_f16 v[156:159], v[236:239], v[16:19], v[156:159]
ds_read_b128 v[232:235], v249 offset:44032
v_mfma_f32_16x16x32_f16 v[164:167], v[236:239], v[20:23], v[164:167]
s_waitcnt lgkmcnt(2)
v_mfma_f32_16x16x32_f16 v[120:123], v[224:227], v[24:27], v[120:123]
s_add_u32 s46, s71, 98304
buffer_load_dwordx4 v[4:7], v252, s[4:7], s46 offen offset:64
ds_read_b128 v[236:239], v249 offset:44288
v_mfma_f32_16x16x32_f16 v[128:131], v[224:227], v[28:31], v[128:131]
s_waitcnt lgkmcnt(2)
v_mfma_f32_16x16x32_f16 v[124:127], v[228:231], v[24:27], v[124:127]
ds_read_b128 v[224:227], v249 offset:45056
v_mfma_f32_16x16x32_f16 v[132:135], v[228:231], v[28:31], v[132:135]
s_waitcnt lgkmcnt(2)
v_mfma_f32_16x16x32_f16 v[136:139], v[232:235], v[24:27], v[136:139]
ds_read_b128 v[228:231], v249 offset:45312
v_mfma_f32_16x16x32_f16 v[144:147], v[232:235], v[28:31], v[144:147]
s_waitcnt lgkmcnt(2)
v_mfma_f32_16x16x32_f16 v[140:143], v[236:239], v[24:27], v[140:143]
s_add_u32 s46, s71, 98304
buffer_load_dwordx4 v[0:3], v252, s[4:7], s46 offen offset:128
ds_read_b128 v[232:235], v249 offset:49152
v_mfma_f32_16x16x32_f16 v[148:151], v[236:239], v[28:31], v[148:151]
s_waitcnt lgkmcnt(2)
v_mfma_f32_16x16x32_f16 v[152:155], v[224:227], v[24:27], v[152:155]
ds_read_b128 v[236:239], v249 offset:49408
v_mfma_f32_16x16x32_f16 v[160:163], v[224:227], v[28:31], v[160:163]
s_waitcnt lgkmcnt(2)
v_mfma_f32_16x16x32_f16 v[156:159], v[228:231], v[24:27], v[156:159]
ds_read_b128 v[224:227], v249 offset:50176
v_mfma_f32_16x16x32_f16 v[164:167], v[228:231], v[28:31], v[164:167]
s_waitcnt lgkmcnt(2)
v_mfma_f32_16x16x32_f16 v[120:123], v[232:235], v[32:35], v[120:123]
buffer_load_dwordx4 v[24:27], v253, s[32:35], s80 offen nt
ds_read_b128 v[228:231], v249 offset:50432
v_mfma_f32_16x16x32_f16 v[128:131], v[232:235], v[36:39], v[128:131]
v_and_b32 v16, 1, v251
s_waitcnt lgkmcnt(2)
v_mfma_f32_16x16x32_f16 v[124:127], v[236:239], v[32:35], v[124:127]
ds_read_b128 v[232:235], v249 offset:51200
v_mfma_f32_16x16x32_f16 v[132:135], v[236:239], v[36:39], v[132:135]
v_lshlrev_b32 v16, 4, v16
s_waitcnt lgkmcnt(2)
v_mfma_f32_16x16x32_f16 v[136:139], v[224:227], v[32:35], v[136:139]
ds_read_b128 v[236:239], v249 offset:51456
v_mov_b32 v17, 16256
v_mfma_f32_16x16x32_f16 v[144:147], v[224:227], v[36:39], v[144:147]
s_waitcnt lgkmcnt(2)
v_mfma_f32_16x16x32_f16 v[140:143], v[228:231], v[32:35], v[140:143]
ds_read_b128 v[224:227], v249 offset:55296
v_lshlrev_b32 v16, v16, v17
v_mfma_f32_16x16x32_f16 v[148:151], v[228:231], v[36:39], v[148:151]
v_lshrrev_b32 v17, 2, v251
s_waitcnt lgkmcnt(2)
v_mfma_f32_16x16x32_f16 v[152:155], v[232:235], v[32:35], v[152:155]
ds_read_b128 v[228:231], v249 offset:55552
v_mfma_f32_16x16x32_f16 v[160:163], v[232:235], v[36:39], v[160:163]
v_xor_b32 v17, v17, v251
s_waitcnt lgkmcnt(2)
v_mfma_f32_16x16x32_f16 v[156:159], v[236:239], v[32:35], v[156:159]
ds_read_b128 v[232:235], v249 offset:56320
v_mfma_f32_16x16x32_f16 v[164:167], v[236:239], v[36:39], v[164:167]
v_and_b32 v17, 12, v17
s_waitcnt lgkmcnt(2)
v_mfma_f32_16x16x32_f16 v[120:123], v[224:227], v[40:43], v[120:123]
buffer_load_dwordx4 v[28:31], v253, s[32:35], s80 offen offset:256 nt
ds_read_b128 v[236:239], v249 offset:56576
v_and_b32 v20, 2, v251
v_mfma_f32_16x16x32_f16 v[128:131], v[224:227], v[44:47], v[128:131]
s_waitcnt lgkmcnt(2)
v_mfma_f32_16x16x32_f16 v[124:127], v[228:231], v[40:43], v[124:127]
ds_read_b128 v[224:227], v249 offset:57344
v_or_b32_e64 v17, v17, v20
v_mfma_f32_16x16x32_f16 v[132:135], v[228:231], v[44:47], v[132:135]
v_cmp_eq_u32 vcc, 0, v17
s_nop 1
v_cndmask_b32 v18, 0, v16, vcc
s_waitcnt lgkmcnt(2)
v_mfma_f32_16x16x32_f16 v[136:139], v[232:235], v[40:43], v[136:139]
ds_read_b128 v[228:231], v249 offset:57600
v_mfma_f32_16x16x32_f16 v[144:147], v[232:235], v[44:47], v[144:147]
v_cmp_eq_u32 vcc, 2, v17
s_nop 1
v_cndmask_b32 v19, 0, v16, vcc
s_waitcnt lgkmcnt(2)
v_mfma_f32_16x16x32_f16 v[140:143], v[236:239], v[40:43], v[140:143]
ds_read_b128 v[232:235], v249 offset:61440
v_mfma_f32_16x16x32_f16 v[148:151], v[236:239], v[44:47], v[148:151]
v_mov_b32 v16, 0
s_waitcnt lgkmcnt(2)
v_mfma_f32_16x16x32_f16 v[152:155], v[224:227], v[40:43], v[152:155]
ds_read_b128 v[236:239], v249 offset:61696
v_mov_b32 v17, 0
v_mfma_f32_16x16x32_f16 v[160:163], v[224:227], v[44:47], v[160:163]
s_waitcnt lgkmcnt(2)
v_mfma_f32_16x16x32_f16 v[156:159], v[228:231], v[40:43], v[156:159]
ds_read_b128 v[224:227], v249 offset:62464
v_mov_b32_e64 v20, 0
v_mfma_f32_16x16x32_f16 v[164:167], v[228:231], v[44:47], v[164:167]
v_mov_b32 v21, 0
s_waitcnt lgkmcnt(2)
v_mfma_f32_16x16x32_f16 v[120:123], v[232:235], v[48:51], v[120:123]
s_add_u32 s46, s80, 4194304
buffer_load_dwordx4 v[32:35], v253, s[32:35], s46 offen nt
ds_read_b128 v[228:231], v249 offset:62720
v_mfma_f32_16x16x32_f16 v[128:131], v[232:235], v[52:55], v[128:131]
s_waitcnt lgkmcnt(2)
v_mfma_f32_16x16x32_f16 v[124:127], v[236:239], v[48:51], v[124:127]
ds_read_b128 v[232:235], v249 offset:63488
v_mfma_f32_16x16x32_f16 v[132:135], v[236:239], v[52:55], v[132:135]
s_waitcnt lgkmcnt(2)
v_mfma_f32_16x16x32_f16 v[136:139], v[224:227], v[48:51], v[136:139]
ds_read_b128 v[236:239], v249 offset:63744
v_mfma_f32_16x16x32_f16 v[144:147], v[224:227], v[52:55], v[144:147]
s_waitcnt lgkmcnt(2)
v_mfma_f32_16x16x32_f16 v[140:143], v[228:231], v[48:51], v[140:143]
ds_read_b128 v[224:227], v250 offset:2048
v_mfma_f32_16x16x32_f16 v[148:151], v[228:231], v[52:55], v[148:151]
s_waitcnt lgkmcnt(2)
v_mfma_f32_16x16x32_f16 v[152:155], v[232:235], v[48:51], v[152:155]
ds_read_b128 v[228:231], v250 offset:2304
v_mfma_f32_16x16x32_f16 v[160:163], v[232:235], v[52:55], v[160:163]
s_waitcnt lgkmcnt(2)
v_mfma_f32_16x16x32_f16 v[156:159], v[236:239], v[48:51], v[156:159]
ds_read_b128 v[232:235], v250 offset:3072
v_mfma_f32_16x16x32_f16 v[164:167], v[236:239], v[52:55], v[164:167]
s_waitcnt lgkmcnt(2)
v_mfma_f32_16x16x32_f16 v[120:123], v[224:227], v[56:59], v[120:123]
ds_read_b128 v[236:239], v250 offset:3328
v_mfma_f32_16x16x32_f16 v[128:131], v[224:227], v[60:63], v[128:131]
s_waitcnt lgkmcnt(2)
v_mfma_f32_16x16x32_f16 v[124:127], v[228:231], v[56:59], v[124:127]
s_add_u32 s46, s80, 4194304
buffer_load_dwordx4 v[36:39], v253, s[32:35], s46 offen offset:256 nt
ds_read_b128 v[224:227], v250 offset:4096
v_mfma_f32_16x16x32_f16 v[132:135], v[228:231], v[60:63], v[132:135]
s_waitcnt lgkmcnt(2)
v_mfma_f32_16x16x32_f16 v[136:139], v[232:235], v[56:59], v[136:139]
ds_read_b128 v[228:231], v250 offset:4352
v_mfma_f32_16x16x32_f16 v[144:147], v[232:235], v[60:63], v[144:147]
s_waitcnt lgkmcnt(2)
v_mfma_f32_16x16x32_f16 v[140:143], v[236:239], v[56:59], v[140:143]
ds_read_b128 v[232:235], v250 offset:8192
v_mfma_f32_16x16x32_f16 v[148:151], v[236:239], v[60:63], v[148:151]
s_waitcnt lgkmcnt(2)
v_mfma_f32_16x16x32_f16 v[152:155], v[224:227], v[56:59], v[152:155]
ds_read_b128 v[236:239], v250 offset:8448
v_mfma_f32_16x16x32_f16 v[160:163], v[224:227], v[60:63], v[160:163]
s_waitcnt lgkmcnt(2)
v_mfma_f32_16x16x32_f16 v[156:159], v[228:231], v[56:59], v[156:159]
ds_read_b128 v[224:227], v250 offset:9216
v_mfma_f32_16x16x32_f16 v[164:167], v[228:231], v[60:63], v[164:167]
s_waitcnt vmcnt(9)
v_mfma_f32_16x16x32_bf16 v[120:123], v[18:21], v[240:243], v[120:123]
ds_read_b128 v[228:231], v250 offset:9472
v_mfma_f32_16x16x32_bf16 v[124:127], v[16:19], v[240:243], v[124:127]
s_waitcnt vmcnt(8)
v_mfma_f32_16x16x32_bf16 v[136:139], v[18:21], v[244:247], v[136:139]
v_mfma_f32_16x16x32_bf16 v[140:143], v[16:19], v[244:247], v[140:143]
s_waitcnt lgkmcnt(3)
v_mfma_f32_16x16x32_f16 v[120:123], v[232:235], v[64:67], v[120:123]
s_add_u32 s46, s80, 8388608
buffer_load_dwordx4 v[40:43], v253, s[32:35], s46 offen nt
v_mfma_f32_16x16x32_f16 v[128:131], v[232:235], v[68:71], v[128:131]
s_waitcnt lgkmcnt(2)
v_mfma_f32_16x16x32_f16 v[124:127], v[236:239], v[64:67], v[124:127]
ds_read_b128 v[232:235], v250 offset:10240
v_mfma_f32_16x16x32_f16 v[132:135], v[236:239], v[68:71], v[132:135]
s_waitcnt lgkmcnt(2)
v_mfma_f32_16x16x32_f16 v[136:139], v[224:227], v[64:67], v[136:139]
ds_read_b128 v[236:239], v250 offset:10496
v_mfma_f32_16x16x32_f16 v[144:147], v[224:227], v[68:71], v[144:147]
s_waitcnt lgkmcnt(2)
v_mfma_f32_16x16x32_f16 v[140:143], v[228:231], v[64:67], v[140:143]
ds_read_b128 v[224:227], v250 offset:14336
v_mfma_f32_16x16x32_f16 v[148:151], v[228:231], v[68:71], v[148:151]
s_waitcnt lgkmcnt(2)
v_mfma_f32_16x16x32_f16 v[152:155], v[232:235], v[64:67], v[152:155]
ds_read_b128 v[228:231], v250 offset:14592
v_mfma_f32_16x16x32_f16 v[160:163], v[232:235], v[68:71], v[160:163]
s_waitcnt lgkmcnt(2)
v_mfma_f32_16x16x32_f16 v[156:159], v[236:239], v[64:67], v[156:159]
ds_read_b128 v[232:235], v250 offset:15360
v_mfma_f32_16x16x32_f16 v[164:167], v[236:239], v[68:71], v[164:167]
s_waitcnt lgkmcnt(2)
v_mfma_f32_16x16x32_f16 v[120:123], v[224:227], v[72:75], v[120:123]
ds_read_b128 v[236:239], v250 offset:15616
v_mfma_f32_16x16x32_f16 v[128:131], v[224:227], v[76:79], v[128:131]
s_waitcnt lgkmcnt(2)
v_mfma_f32_16x16x32_f16 v[124:127], v[228:231], v[72:75], v[124:127]
s_add_u32 s46, s80, 8388608
buffer_load_dwordx4 v[44:47], v253, s[32:35], s46 offen offset:256 nt
ds_read_b128 v[224:227], v250 offset:16384
v_mfma_f32_16x16x32_f16 v[132:135], v[228:231], v[76:79], v[132:135]
s_waitcnt lgkmcnt(2)
v_mfma_f32_16x16x32_f16 v[136:139], v[232:235], v[72:75], v[136:139]
ds_read_b128 v[228:231], v250 offset:16640
v_mfma_f32_16x16x32_f16 v[144:147], v[232:235], v[76:79], v[144:147]
s_waitcnt lgkmcnt(2)
v_mfma_f32_16x16x32_f16 v[140:143], v[236:239], v[72:75], v[140:143]
ds_read_b128 v[232:235], v250 offset:20480
v_mfma_f32_16x16x32_f16 v[148:151], v[236:239], v[76:79], v[148:151]
s_waitcnt lgkmcnt(2)
v_mfma_f32_16x16x32_f16 v[152:155], v[224:227], v[72:75], v[152:155]
ds_read_b128 v[236:239], v250 offset:20736
v_mfma_f32_16x16x32_f16 v[160:163], v[224:227], v[76:79], v[160:163]
s_waitcnt lgkmcnt(2)
v_mfma_f32_16x16x32_f16 v[156:159], v[228:231], v[72:75], v[156:159]
ds_read_b128 v[224:227], v250 offset:21504
v_mfma_f32_16x16x32_f16 v[164:167], v[228:231], v[76:79], v[164:167]
s_waitcnt vmcnt(9)
v_mfma_f32_16x16x32_bf16 v[152:155], v[18:21], v[12:15], v[152:155]
ds_read_b128 v[228:231], v250 offset:21760
v_mfma_f32_16x16x32_bf16 v[156:159], v[16:19], v[12:15], v[156:159]
s_waitcnt vmcnt(8)
v_mfma_f32_16x16x32_bf16 v[128:131], v[18:21], v[8:11], v[128:131]
v_mfma_f32_16x16x32_bf16 v[132:135], v[16:19], v[8:11], v[132:135]
v_and_b32 v255, 1, v251
v_lshlrev_b32 v255, 7, v255
v_sub_u32 v255, v252, v255
s_mov_b32 s74, 1431655765
s_mov_b32 s75, 1431655765
s_waitcnt lgkmcnt(3)
v_mfma_f32_16x16x32_f16 v[120:123], v[232:235], v[80:83], v[120:123]
buffer_load_dwordx4 v[12:15], v252, s[4:7], s70 offen
v_mfma_f32_16x16x32_f16 v[128:131], v[232:235], v[84:87], v[128:131]
s_waitcnt lgkmcnt(2)
v_mfma_f32_16x16x32_f16 v[124:127], v[236:239], v[80:83], v[124:127]
ds_read_b128 v[232:235], v250 offset:22528
v_mfma_f32_16x16x32_f16 v[132:135], v[236:239], v[84:87], v[132:135]
s_waitcnt lgkmcnt(2)
v_mfma_f32_16x16x32_f16 v[136:139], v[224:227], v[80:83], v[136:139]
ds_read_b128 v[236:239], v250 offset:22784
v_mfma_f32_16x16x32_f16 v[144:147], v[224:227], v[84:87], v[144:147]
s_waitcnt lgkmcnt(2)
v_mfma_f32_16x16x32_f16 v[140:143], v[228:231], v[80:83], v[140:143]
ds_read_b128 v[224:227], v250 offset:26624
v_mfma_f32_16x16x32_f16 v[148:151], v[228:231], v[84:87], v[148:151]
s_waitcnt lgkmcnt(2)
v_mfma_f32_16x16x32_f16 v[152:155], v[232:235], v[80:83], v[152:155]
ds_read_b128 v[228:231], v250 offset:26880
v_mfma_f32_16x16x32_f16 v[160:163], v[232:235], v[84:87], v[160:163]
s_waitcnt lgkmcnt(2)
v_mfma_f32_16x16x32_f16 v[156:159], v[236:239], v[80:83], v[156:159]
ds_read_b128 v[232:235], v250 offset:27648
v_mfma_f32_16x16x32_f16 v[164:167], v[236:239], v[84:87], v[164:167]
s_waitcnt lgkmcnt(2)
v_mfma_f32_16x16x32_f16 v[120:123], v[224:227], v[88:91], v[120:123]
ds_read_b128 v[236:239], v250 offset:27904
v_mfma_f32_16x16x32_f16 v[128:131], v[224:227], v[92:95], v[128:131]
s_waitcnt lgkmcnt(2)
v_mfma_f32_16x16x32_f16 v[124:127], v[228:231], v[88:91], v[124:127]
buffer_load_dwordx4 v[8:11], v252, s[4:7], s70 offen offset:64
ds_read_b128 v[224:227], v250 offset:28672
v_mfma_f32_16x16x32_f16 v[132:135], v[228:231], v[92:95], v[132:135]
s_waitcnt lgkmcnt(2)
v_mfma_f32_16x16x32_f16 v[136:139], v[232:235], v[88:91], v[136:139]
ds_read_b128 v[228:231], v250 offset:28928
v_mfma_f32_16x16x32_f16 v[144:147], v[232:235], v[92:95], v[144:147]
s_waitcnt lgkmcnt(2)
v_mfma_f32_16x16x32_f16 v[140:143], v[236:239], v[88:91], v[140:143]
ds_read_b128 v[232:235], v249 offset:55296
v_mfma_f32_16x16x32_f16 v[148:151], v[236:239], v[92:95], v[148:151]
s_waitcnt lgkmcnt(2)
v_mfma_f32_16x16x32_f16 v[152:155], v[224:227], v[88:91], v[152:155]
ds_read_b128 v[236:239], v254 offset:7936
v_mfma_f32_16x16x32_f16 v[160:163], v[224:227], v[92:95], v[160:163]
s_waitcnt lgkmcnt(2)
v_mfma_f32_16x16x32_f16 v[156:159], v[228:231], v[88:91], v[156:159]
ds_read_b128 v[224:227], v249 offset:55552
v_mfma_f32_16x16x32_f16 v[164:167], v[228:231], v[92:95], v[164:167]
s_waitcnt vmcnt(9)
v_mfma_f32_16x16x32_bf16 v[144:147], v[18:21], v[4:7], v[144:147]
ds_read_b128 v[228:231], v254 offset:7952
v_mfma_f32_16x16x32_bf16 v[148:151], v[16:19], v[4:7], v[148:151]
s_waitcnt vmcnt(8)
v_mfma_f32_16x16x32_bf16 v[160:163], v[18:21], v[0:3], v[160:163]
v_mfma_f32_16x16x32_bf16 v[164:167], v[16:19], v[0:3], v[164:167]
s_waitcnt lgkmcnt(2)
v_mfma_f32_16x16x32_f16 v[48:51], v[232:235], v[168:171], v[236:239]
buffer_load_dwordx4 v[4:7], v252, s[4:7], s70 offen offset:128
v_mfma_f32_16x16x32_f16 v[56:59], v[232:235], v[172:175], v[236:239]
s_waitcnt lgkmcnt(0)
v_mfma_f32_16x16x32_f16 v[52:55], v[224:227], v[168:171], v[228:231]
ds_read_b128 v[232:235], v249 offset:56320
ds_read_b128 v[236:239], v254 offset:8064
v_mfma_f32_16x16x32_f16 v[60:63], v[224:227], v[172:175], v[228:231]
s_waitcnt lgkmcnt(0)
v_mfma_f32_16x16x32_f16 v[64:67], v[232:235], v[168:171], v[236:239]
ds_read_b128 v[224:227], v249 offset:56576
ds_read_b128 v[228:231], v254 offset:8080
v_mfma_f32_16x16x32_f16 v[72:75], v[232:235], v[172:175], v[236:239]
v_cvt_pk_bf16_f32 v136, v136, v137
s_waitcnt lgkmcnt(0)
v_mfma_f32_16x16x32_f16 v[68:71], v[224:227], v[168:171], v[228:231]
ds_read_b128 v[232:235], v249 offset:57344
ds_read_b128 v[236:239], v254 offset:16128
v_cvt_pk_bf16_f32 v137, v138, v139
v_mfma_f32_16x16x32_f16 v[76:79], v[224:227], v[172:175], v[228:231]
v_cvt_pk_bf16_f32 v138, v140, v141
v_cvt_pk_bf16_f32 v139, v142, v143
s_waitcnt lgkmcnt(0)
v_mfma_f32_16x16x32_f16 v[80:83], v[232:235], v[168:171], v[236:239]
ds_read_b128 v[224:227], v249 offset:57600
ds_read_b128 v[228:231], v254 offset:16144
v_cvt_pk_bf16_f32 v120, v120, v121
v_mfma_f32_16x16x32_f16 v[88:91], v[232:235], v[172:175], v[236:239]
v_cvt_pk_bf16_f32 v121, v122, v123
s_waitcnt lgkmcnt(0)
v_mfma_f32_16x16x32_f16 v[84:87], v[224:227], v[168:171], v[228:231]
ds_read_b128 v[232:235], v249 offset:61440
ds_read_b128 v[236:239], v249 offset:61696
v_cvt_pk_bf16_f32 v122, v124, v125
v_mfma_f32_16x16x32_f16 v[92:95], v[224:227], v[172:175], v[228:231]
v_cvt_pk_bf16_f32 v123, v126, v127
v_cvt_pk_bf16_f32 v152, v152, v153
s_waitcnt lgkmcnt(1)
v_mfma_f32_16x16x32_f16 v[48:51], v[232:235], v[176:179], v[48:51]
ds_read_b128 v[224:227], v249 offset:62464
ds_read_b128 v[228:231], v249 offset:62720
v_cvt_pk_bf16_f32 v153, v154, v155
v_mfma_f32_16x16x32_f16 v[56:59], v[232:235], v[180:183], v[56:59]
v_cvt_pk_bf16_f32 v154, v156, v157
s_waitcnt lgkmcnt(2)
v_mfma_f32_16x16x32_f16 v[52:55], v[236:239], v[176:179], v[52:55]
ds_read_b128 v[232:235], v249 offset:63488
v_cvt_pk_bf16_f32 v155, v158, v159
s_mov_b64 vcc, s[74:75]
v_mfma_f32_16x16x32_f16 v[60:63], v[236:239], v[180:183], v[60:63]
v_cndmask_b32 v140, v120, v152, vcc
v_cndmask_b32 v141, v121, v153, vcc
s_waitcnt lgkmcnt(2)
v_mfma_f32_16x16x32_f16 v[64:67], v[224:227], v[176:179], v[64:67]
ds_read_b128 v[236:239], v249 offset:63744
v_cndmask_b32 v142, v122, v154, vcc
v_mfma_f32_16x16x32_f16 v[72:75], v[224:227], v[180:183], v[72:75]
v_cndmask_b32 v143, v123, v155, vcc
s_waitcnt lgkmcnt(2)
v_mfma_f32_16x16x32_f16 v[68:71], v[228:231], v[176:179], v[68:71]
ds_read_b128 v[224:227], v250 offset:2048
v_cndmask_b32_dpp v120, v136, v120, vcc quad_perm:[1,0,3,2] row_mask:0xf bank_mask:0xf
v_mfma_f32_16x16x32_f16 v[76:79], v[228:231], v[180:183], v[76:79]
v_cndmask_b32_dpp v121, v137, v121, vcc quad_perm:[1,0,3,2] row_mask:0xf bank_mask:0xf
v_cndmask_b32_dpp v122, v138, v122, vcc quad_perm:[1,0,3,2] row_mask:0xf bank_mask:0xf
s_waitcnt lgkmcnt(2)
v_mfma_f32_16x16x32_f16 v[80:83], v[232:235], v[176:179], v[80:83]
ds_read_b128 v[228:231], v250 offset:2304
v_cndmask_b32_dpp v123, v139, v123, vcc quad_perm:[1,0,3,2] row_mask:0xf bank_mask:0xf
s_not_b64 vcc, s[74:75]
v_mfma_f32_16x16x32_f16 v[88:91], v[232:235], v[180:183], v[88:91]
v_cndmask_b32_dpp v152, v136, v152, vcc quad_perm:[1,0,3,2] row_mask:0xf bank_mask:0xf
s_waitcnt lgkmcnt(2)
v_mfma_f32_16x16x32_f16 v[84:87], v[236:239], v[176:179], v[84:87]
ds_read_b128 v[232:235], v248 offset:16384
v_cndmask_b32_dpp v153, v137, v153, vcc quad_perm:[1,0,3,2] row_mask:0xf bank_mask:0xf
v_mfma_f32_16x16x32_f16 v[92:95], v[236:239], v[180:183], v[92:95]
v_cndmask_b32_dpp v154, v138, v154, vcc quad_perm:[1,0,3,2] row_mask:0xf bank_mask:0xf
v_cndmask_b32_dpp v155, v139, v155, vcc quad_perm:[1,0,3,2] row_mask:0xf bank_mask:0xf
s_waitcnt lgkmcnt(2)
v_mfma_f32_16x16x32_f16 v[48:51], v[224:227], v[184:187], v[48:51]
s_add_u32 s46, s70, 98304
buffer_load_dwordx4 v[0:3], v252, s[4:7], s46 offen
ds_read_b128 v[236:239], v250 offset:3072
buffer_store_dwordx4 v[120:123], v255, s[8:11], s71 offen sc1
v_mfma_f32_16x16x32_f16 v[56:59], v[224:227], v[188:191], v[56:59]
s_waitcnt lgkmcnt(2)
v_mfma_f32_16x16x32_f16 v[52:55], v[228:231], v[184:187], v[52:55]
ds_read_b128 v[224:227], v250 offset:3328
v_mfma_f32_16x16x32_f16 v[60:63], v[228:231], v[188:191], v[60:63]
s_waitcnt lgkmcnt(2)
v_mfma_f32_16x16x32_bf16 v[168:171], v[232:235], v[96:99], 0
ds_read_b128 v[228:231], v250 offset:4096
v_mfma_f32_16x16x32_bf16 v[176:179], v[232:235], v[100:103], 0
s_waitcnt lgkmcnt(2)
v_mfma_f32_16x16x32_f16 v[64:67], v[236:239], v[184:187], v[64:67]
ds_read_b128 v[232:235], v250 offset:4352
v_mfma_f32_16x16x32_f16 v[72:75], v[236:239], v[188:191], v[72:75]
s_waitcnt lgkmcnt(2)
v_mfma_f32_16x16x32_f16 v[68:71], v[224:227], v[184:187], v[68:71]
ds_read_b128 v[236:239], v248 offset:16640
v_mfma_f32_16x16x32_f16 v[76:79], v[224:227], v[188:191], v[76:79]
s_waitcnt lgkmcnt(2)
v_mfma_f32_16x16x32_f16 v[80:83], v[228:231], v[184:187], v[80:83]
ds_read_b128 v[224:227], v250 offset:8192
v_mfma_f32_16x16x32_f16 v[88:91], v[228:231], v[188:191], v[88:91]
s_waitcnt lgkmcnt(2)
v_mfma_f32_16x16x32_f16 v[84:87], v[232:235], v[184:187], v[84:87]
ds_read_b128 v[228:231], v250 offset:8448
v_mfma_f32_16x16x32_f16 v[92:95], v[232:235], v[188:191], v[92:95]
s_waitcnt lgkmcnt(2)
v_mfma_f32_16x16x32_bf16 v[172:175], v[236:239], v[96:99], 0
ds_read_b128 v[232:235], v250 offset:9216
v_mfma_f32_16x16x32_bf16 v[180:183], v[236:239], v[100:103], 0
s_waitcnt lgkmcnt(2)
v_mfma_f32_16x16x32_f16 v[48:51], v[224:227], v[192:195], v[48:51]
buffer_store_dwordx4 v[140:143], v255, s[8:11], s71 offen offset:128 sc1
ds_read_b128 v[236:239], v250 offset:9472
v_mfma_f32_16x16x32_f16 v[56:59], v[224:227], v[196:199], v[56:59]
s_waitcnt lgkmcnt(2)
v_mfma_f32_16x16x32_f16 v[52:55], v[228:231], v[192:195], v[52:55]
ds_read_b128 v[224:227], v248 offset:17408
v_mfma_f32_16x16x32_f16 v[60:63], v[228:231], v[196:199], v[60:63]
s_waitcnt lgkmcnt(2)
v_mfma_f32_16x16x32_f16 v[64:67], v[232:235], v[192:195], v[64:67]
ds_read_b128 v[228:231], v250 offset:10240
v_mfma_f32_16x16x32_f16 v[72:75], v[232:235], v[196:199], v[72:75]
s_waitcnt lgkmcnt(2)
v_mfma_f32_16x16x32_f16 v[68:71], v[236:239], v[192:195], v[68:71]
ds_read_b128 v[232:235], v250 offset:10496
v_mfma_f32_16x16x32_f16 v[76:79], v[236:239], v[196:199], v[76:79]
s_waitcnt lgkmcnt(2)
v_mfma_f32_16x16x32_bf16 v[168:171], v[224:227], v[104:107], v[168:171]
ds_read_b128 v[236:239], v250 offset:14336
v_mfma_f32_16x16x32_bf16 v[176:179], v[224:227], v[108:111], v[176:179]
s_waitcnt lgkmcnt(2)
v_mfma_f32_16x16x32_f16 v[80:83], v[228:231], v[192:195], v[80:83]
ds_read_b128 v[224:227], v250 offset:14592
v_mfma_f32_16x16x32_f16 v[88:91], v[228:231], v[196:199], v[88:91]
s_waitcnt lgkmcnt(2)
v_mfma_f32_16x16x32_f16 v[84:87], v[232:235], v[192:195], v[84:87]
ds_read_b128 v[228:231], v248 offset:17664
v_mfma_f32_16x16x32_f16 v[92:95], v[232:235], v[196:199], v[92:95]
s_waitcnt lgkmcnt(2)
v_mfma_f32_16x16x32_f16 v[48:51], v[236:239], v[200:203], v[48:51]
s_add_u32 s46, s70, 98304
buffer_load_dwordx4 v[244:247], v252, s[4:7], s46 offen offset:64
ds_read_b128 v[232:235], v250 offset:15360
v_mfma_f32_16x16x32_f16 v[56:59], v[236:239], v[204:207], v[56:59]
s_waitcnt lgkmcnt(2)
v_mfma_f32_16x16x32_f16 v[52:55], v[224:227], v[200:203], v[52:55]
ds_read_b128 v[236:239], v250 offset:15616
v_mfma_f32_16x16x32_f16 v[60:63], v[224:227], v[204:207], v[60:63]
s_waitcnt lgkmcnt(2)
v_mfma_f32_16x16x32_bf16 v[172:175], v[228:231], v[104:107], v[172:175]
ds_read_b128 v[224:227], v250 offset:16384
v_mfma_f32_16x16x32_bf16 v[180:183], v[228:231], v[108:111], v[180:183]
s_waitcnt lgkmcnt(2)
v_mfma_f32_16x16x32_f16 v[64:67], v[232:235], v[200:203], v[64:67]
ds_read_b128 v[228:231], v250 offset:16640
v_mfma_f32_16x16x32_f16 v[72:75], v[232:235], v[204:207], v[72:75]
s_waitcnt lgkmcnt(2)
v_mfma_f32_16x16x32_f16 v[68:71], v[236:239], v[200:203], v[68:71]
ds_read_b128 v[232:235], v248 offset:18432
v_mfma_f32_16x16x32_f16 v[76:79], v[236:239], v[204:207], v[76:79]
s_waitcnt lgkmcnt(2)
v_mfma_f32_16x16x32_f16 v[80:83], v[224:227], v[200:203], v[80:83]
ds_read_b128 v[236:239], v250 offset:20480
v_mfma_f32_16x16x32_f16 v[88:91], v[224:227], v[204:207], v[88:91]
s_waitcnt lgkmcnt(2)
v_mfma_f32_16x16x32_f16 v[84:87], v[228:231], v[200:203], v[84:87]
ds_read_b128 v[224:227], v250 offset:20736
v_mfma_f32_16x16x32_f16 v[92:95], v[228:231], v[204:207], v[92:95]
s_waitcnt lgkmcnt(2)
v_mfma_f32_16x16x32_bf16 v[168:171], v[232:235], v[112:115], v[168:171]
ds_read_b128 v[228:231], v250 offset:21504
v_mfma_f32_16x16x32_bf16 v[176:179], v[232:235], v[116:119], v[176:179]
s_waitcnt lgkmcnt(2)
v_mfma_f32_16x16x32_f16 v[48:51], v[236:239], v[208:211], v[48:51]
ds_read_b128 v[232:235], v250 offset:21760
v_mfma_f32_16x16x32_f16 v[56:59], v[236:239], v[212:215], v[56:59]
s_waitcnt lgkmcnt(2)
v_mfma_f32_16x16x32_f16 v[52:55], v[224:227], v[208:211], v[52:55]
ds_read_b128 v[236:239], v248 offset:18688
v_mfma_f32_16x16x32_f16 v[60:63], v[224:227], v[212:215], v[60:63]
s_waitcnt lgkmcnt(2)
v_mfma_f32_16x16x32_f16 v[64:67], v[228:231], v[208:211], v[64:67]
ds_read_b128 v[224:227], v250 offset:22528
v_mfma_f32_16x16x32_f16 v[72:75], v[228:231], v[212:215], v[72:75]
s_waitcnt lgkmcnt(2)
v_mfma_f32_16x16x32_f16 v[68:71], v[232:235], v[208:211], v[68:71]
ds_read_b128 v[228:231], v250 offset:22784
v_mfma_f32_16x16x32_f16 v[76:79], v[232:235], v[212:215], v[76:79]
s_waitcnt lgkmcnt(2)
v_mfma_f32_16x16x32_bf16 v[172:175], v[236:239], v[112:115], v[172:175]
ds_read_b128 v[232:235], v250 offset:26624
v_mfma_f32_16x16x32_bf16 v[180:183], v[236:239], v[116:119], v[180:183]
s_waitcnt lgkmcnt(2)
v_mfma_f32_16x16x32_f16 v[80:83], v[224:227], v[208:211], v[80:83]
ds_read_b128 v[236:239], v250 offset:26880
v_mfma_f32_16x16x32_f16 v[88:91], v[224:227], v[212:215], v[88:91]
s_waitcnt lgkmcnt(2)
v_mfma_f32_16x16x32_f16 v[84:87], v[228:231], v[208:211], v[84:87]
ds_read_b128 v[224:227], v248 offset:22528
v_mfma_f32_16x16x32_f16 v[92:95], v[228:231], v[212:215], v[92:95]
s_setprio 3
s_waitcnt lgkmcnt(2)
v_mfma_f32_16x16x32_f16 v[48:51], v[232:235], v[216:219], v[48:51]
s_add_u32 s46, s70, 98304
buffer_load_dwordx4 v[204:207], v252, s[4:7], s46 offen offset:128
ds_read_b128 v[228:231], v250 offset:27648
v_cvt_pkrtz_f16_f32 v185, v168, v169
v_cvt_pkrtz_f16_f32 v187, v170, v171
v_mfma_f32_16x16x32_f16 v[56:59], v[232:235], v[220:223], v[56:59]
v_cvt_pkrtz_f16_f32 v189, v172, v173
v_cvt_pkrtz_f16_f32 v191, v174, v175
s_waitcnt lgkmcnt(2)
v_mfma_f32_16x16x32_f16 v[52:55], v[236:239], v[216:219], v[52:55]
ds_read_b128 v[232:235], v248 offset:22784
v_cvt_pkrtz_f16_f32 v193, v176, v177
v_cvt_pk_f16_f32 v203, v178, v179
v_cvt_pk_f16_f32 v200, v180, v181
v_mfma_f32_16x16x32_f16 v[60:63], v[236:239], v[220:223], v[60:63]
v_cvt_pk_f16_f32 v197, v182, v183
v_pk_fma_f16 v202, v203, v203, s48
s_waitcnt lgkmcnt(2)
v_mfma_f32_16x16x32_bf16 v[168:171], v[224:227], v[96:99], 0
ds_read_b128 v[236:239], v250 offset:27904
v_and_b32_e64 v185, s49, v185
v_pk_fma_f16 v199, v200, v200, s48
v_mfma_f32_16x16x32_bf16 v[176:179], v[224:227], v[100:103], 0
v_and_b32 v187, s49, v187
v_pk_fma_f16 v196, v197, v197, s48
v_bfe_u32 v184, v185, 2, 14
s_waitcnt lgkmcnt(2)
v_mfma_f32_16x16x32_f16 v[64:67], v[228:231], v[216:219], v[64:67]
ds_read_b128 v[224:227], v248 offset:23552
ds_read_u16_d16 v184, v184
v_pk_mul_f16 v202, v203, v202
v_bfe_u32 v186, v187, 2, 14
v_mfma_f32_16x16x32_f16 v[72:75], v[228:231], v[220:223], v[72:75]
v_pk_mul_f16 v199, v200, v199
v_lshrrev_b32 v185, 18, v185
s_waitcnt lgkmcnt(3)
v_mfma_f32_16x16x32_bf16 v[172:175], v[232:235], v[96:99], 0
ds_read_b128 v[228:231], v250 offset:28672
ds_read_u16_d16 v186, v186
ds_read_u16_d16_hi v185, v185
v_pk_mul_f16 v196, v197, v196
v_lshrrev_b32_e64 v187, 18, v187
v_mfma_f32_16x16x32_bf16 v[180:183], v[232:235], v[100:103], 0
v_exp_f16_e64 v201, v202
v_and_b32 v189, s49, v189
s_waitcnt lgkmcnt(5)
v_mfma_f32_16x16x32_f16 v[68:71], v[236:239], v[216:219], v[68:71]
ds_read_b128 v[232:235], v250 offset:28928
ds_read_u16_d16_hi v187, v187
v_and_b32_e64 v191, s49, v191
v_mfma_f32_16x16x32_f16 v[76:79], v[236:239], v[220:223], v[76:79]
v_exp_f16 v198, v199
v_bfe_u32 v188, v189, 2, 14
v_bfe_u32 v190, v191, 2, 14
s_waitcnt lgkmcnt(5)
v_mfma_f32_16x16x32_bf16 v[168:171], v[224:227], v[104:107], v[168:171]
buffer_store_dwordx4 v[152:155], v255, s[8:11], s71 offen offset:256 sc1
ds_read_b128 v[236:239], v248 offset:23808
ds_read_u16_d16 v188, v188
ds_read_u16_d16 v190, v190
v_exp_f16_e64 v195, v196
v_mfma_f32_16x16x32_bf16 v[176:179], v[224:227], v[108:111], v[176:179]
v_lshrrev_b32_e64 v189, 18, v189
v_lshrrev_b32 v191, 18, v191
s_waitcnt lgkmcnt(5)
v_mfma_f32_16x16x32_f16 v[80:83], v[228:231], v[216:219], v[80:83]
ds_read_b128 v[224:227], v248 offset:24576
ds_read_u16_d16_hi v189, v189
ds_read_u16_d16_hi v191, v191
v_exp_f16_sdwa v201, v202 dst_sel:WORD_1 dst_unused:UNUSED_PRESERVE src0_sel:WORD_1
v_and_b32 v193, s49, v193
v_mfma_f32_16x16x32_f16 v[88:91], v[228:231], v[220:223], v[88:91]
v_bfe_u32 v192, v193, 2, 14
s_waitcnt lgkmcnt(6)
v_mfma_f32_16x16x32_f16 v[84:87], v[232:235], v[216:219], v[84:87]
ds_read_b128 v[228:231], v248 offset:24832
ds_read_u16_d16 v192, v192
v_exp_f16_sdwa v198, v199 dst_sel:WORD_1 dst_unused:UNUSED_PRESERVE src0_sel:WORD_1
v_lshrrev_b32 v193, 18, v193
v_mfma_f32_16x16x32_f16 v[92:95], v[232:235], v[220:223], v[92:95]
v_exp_f16_sdwa v195, v196 dst_sel:WORD_1 dst_unused:UNUSED_PRESERVE src0_sel:WORD_1
v_pk_add_f16 v201, v201, 1.0 op_sel_hi:[1,0]
s_waitcnt lgkmcnt(7)
v_mfma_f32_16x16x32_bf16 v[172:175], v[236:239], v[104:107], v[172:175]
ds_read_u16_d16_hi v193, v193
v_pk_add_f16 v198, v198, 1.0 op_sel_hi:[1,0]
v_pk_add_f16 v195, v195, 1.0 op_sel_hi:[1,0]
v_mfma_f32_16x16x32_bf16 v[180:183], v[236:239], v[108:111], v[180:183]
v_rcp_f16 v202, v201
s_waitcnt lgkmcnt(5)
v_mfma_f32_16x16x32_bf16 v[168:171], v[224:227], v[112:115], v[168:171]
v_rcp_f16_e64 v199, v198
v_mfma_f32_16x16x32_bf16 v[176:179], v[224:227], v[116:119], v[176:179]
v_rcp_f16 v196, v195
s_waitcnt lgkmcnt(2)
v_mfma_f32_16x16x32_bf16 v[172:175], v[228:231], v[112:115], v[172:175]
ds_read_b128 v[224:227], v249 offset:24576
v_rcp_f16_sdwa v202, v201 dst_sel:WORD_1 dst_unused:UNUSED_PRESERVE src0_sel:WORD_1
v_mfma_f32_16x16x32_bf16 v[180:183], v[228:231], v[116:119], v[180:183]
v_rcp_f16_sdwa v199, v198 dst_sel:WORD_1 dst_unused:UNUSED_PRESERVE src0_sel:WORD_1
v_or_b32 v208, v184, v185
v_or_b32 v209, v186, v187
v_or_b32_e64 v210, v188, v189
v_rcp_f16_sdwa v196, v195 dst_sel:WORD_1 dst_unused:UNUSED_PRESERVE src0_sel:WORD_1
v_or_b32 v211, v190, v191
s_waitcnt lgkmcnt(1)
v_or_b32 v212, v192, v193
v_pk_mul_f16 v213, v203, v202
v_pk_mul_f16 v214, v200, v199
v_pk_mul_f16 v215, v197, v196
s_waitcnt lgkmcnt(0)
v_mfma_f32_16x16x32_f16 v[48:51], v[224:227], v[208:211], v[48:51]
ds_read_b128 v[228:231], v249 offset:24832
ds_read_b128 v[232:235], v248 offset:28672
ds_read_b128 v[236:239], v249 offset:25600
ds_read_b128 v[216:219], v248 offset:28928
ds_read_b128 v[220:223], v249 offset:25856
v_cvt_pkrtz_f16_f32 v185, v168, v169
v_cvt_pkrtz_f16_f32 v187, v170, v171
v_cvt_pkrtz_f16_f32 v189, v172, v173
v_mfma_f32_16x16x32_f16 v[56:59], v[224:227], v[212:215], v[56:59]
v_cvt_pkrtz_f16_f32 v191, v174, v175
v_cvt_pkrtz_f16_f32 v193, v176, v177
v_cvt_pk_f16_f32 v203, v178, v179
s_waitcnt lgkmcnt(4)
v_mfma_f32_16x16x32_f16 v[52:55], v[228:231], v[208:211], v[52:55]
ds_read_b128 v[224:227], v248 offset:29696
v_cvt_pk_f16_f32 v200, v180, v181
v_cvt_pk_f16_f32 v197, v182, v183
v_pk_fma_f16 v202, v203, v203, s48
v_cvt_pk_bf16_f32 v144, v144, v145
v_mfma_f32_16x16x32_f16 v[60:63], v[228:231], v[212:215], v[60:63]
v_and_b32 v185, s49, v185
v_cvt_pk_bf16_f32 v145, v146, v147
v_pk_fma_f16 v199, v200, v200, s48
s_waitcnt lgkmcnt(4)
v_mfma_f32_16x16x32_bf16 v[168:171], v[232:235], v[96:99], 0
ds_read_b128 v[228:231], v249 offset:26624
v_and_b32 v187, s49, v187
v_cvt_pk_bf16_f32 v146, v148, v149
v_pk_fma_f16 v196, v197, v197, s48
v_mfma_f32_16x16x32_bf16 v[176:179], v[232:235], v[100:103], 0
v_cvt_pk_bf16_f32 v147, v150, v151
v_bfe_u32 v184, v185, 2, 14
s_setprio 2
v_pk_mul_f16 v202, v203, v202
v_cvt_pk_bf16_f32 v128, v128, v129
s_waitcnt lgkmcnt(2)
v_mfma_f32_16x16x32_f16 v[64:67], v[236:239], v[208:211], v[64:67]
ds_read_b128 v[232:235], v249 offset:26880
ds_read_u16_d16 v184, v184
v_bfe_u32 v186, v187, 2, 14
v_cvt_pk_bf16_f32 v129, v130, v131
v_pk_mul_f16 v199, v200, v199
v_mfma_f32_16x16x32_f16 v[72:75], v[236:239], v[212:215], v[72:75]
v_lshrrev_b32_e64 v185, 18, v185
v_cvt_pk_bf16_f32 v130, v132, v133
v_pk_mul_f16 v196, v197, v196
v_mfma_f32_16x16x32_bf16 v[172:175], v[216:219], v[96:99], 0
ds_read_b128 v[236:239], v248 offset:29952
ds_read_u16_d16 v186, v186
ds_read_u16_d16_hi v185, v185
v_lshrrev_b32_e64 v187, 18, v187
v_cvt_pk_bf16_f32 v131, v134, v135
v_exp_f16_e64 v201, v202
v_mfma_f32_16x16x32_bf16 v[180:183], v[216:219], v[100:103], 0
v_cvt_pk_bf16_f32 v160, v160, v161
v_and_b32_e64 v189, s49, v189
v_cvt_pk_bf16_f32 v161, v162, v163
v_mfma_f32_16x16x32_f16 v[68:71], v[220:223], v[208:211], v[68:71]
ds_read_b128 v[216:219], v248 offset:30720
ds_read_u16_d16_hi v187, v187
v_and_b32_e64 v191, s49, v191
v_cvt_pk_bf16_f32 v162, v164, v165
v_mfma_f32_16x16x32_f16 v[76:79], v[220:223], v[212:215], v[76:79]
v_exp_f16_e64 v198, v199
v_cvt_pk_bf16_f32 v163, v166, v167
s_mov_b64 vcc, s[74:75]
v_bfe_u32 v188, v189, 2, 14
v_bfe_u32 v190, v191, 2, 14
s_waitcnt lgkmcnt(5)
v_mfma_f32_16x16x32_bf16 v[168:171], v[224:227], v[104:107], v[168:171]
ds_read_b128 v[220:223], v248 offset:30976
ds_read_u16_d16 v188, v188
ds_read_u16_d16 v190, v190
v_cndmask_b32 v148, v128, v160, vcc
v_exp_f16 v195, v196
v_mfma_f32_16x16x32_bf16 v[176:179], v[224:227], v[108:111], v[176:179]
v_cndmask_b32 v149, v129, v161, vcc
v_lshrrev_b32_e64 v189, 18, v189
v_cndmask_b32 v150, v130, v162, vcc
v_mfma_f32_16x16x32_f16 v[80:83], v[228:231], v[208:211], v[80:83]
ds_read_b128 v[224:227], v249 offset:30720
ds_read_u16_d16_hi v189, v189
v_lshrrev_b32 v191, 18, v191
v_cndmask_b32 v151, v131, v163, vcc
v_exp_f16_sdwa v201, v202 dst_sel:WORD_1 dst_unused:UNUSED_PRESERVE src0_sel:WORD_1
v_mfma_f32_16x16x32_f16 v[88:91], v[228:231], v[212:215], v[88:91]
v_cndmask_b32_dpp v128, v144, v128, vcc quad_perm:[1,0,3,2] row_mask:0xf bank_mask:0xf
v_and_b32_e64 v193, s49, v193
v_cndmask_b32_dpp v129, v145, v129, vcc quad_perm:[1,0,3,2] row_mask:0xf bank_mask:0xf
v_mfma_f32_16x16x32_f16 v[84:87], v[232:235], v[208:211], v[84:87]
ds_read_b128 v[228:231], v249 offset:30976
ds_read_u16_d16_hi v191, v191
v_bfe_u32 v192, v193, 2, 14
v_exp_f16_sdwa v198, v199 dst_sel:WORD_1 dst_unused:UNUSED_PRESERVE src0_sel:WORD_1
v_mfma_f32_16x16x32_f16 v[92:95], v[232:235], v[212:215], v[92:95]
v_cndmask_b32_dpp v130, v146, v130, vcc quad_perm:[1,0,3,2] row_mask:0xf bank_mask:0xf
v_lshrrev_b32_e64 v193, 18, v193
v_cndmask_b32_dpp v131, v147, v131, vcc quad_perm:[1,0,3,2] row_mask:0xf bank_mask:0xf
s_not_b64 vcc, s[74:75]
s_waitcnt lgkmcnt(4)
v_mfma_f32_16x16x32_bf16 v[172:175], v[236:239], v[104:107], v[172:175]
ds_read_b128 v[232:235], v248 offset:34816
ds_read_u16_d16 v192, v192
ds_read_u16_d16_hi v193, v193
v_exp_f16_sdwa v195, v196 dst_sel:WORD_1 dst_unused:UNUSED_PRESERVE src0_sel:WORD_1
v_cndmask_b32_dpp v160, v144, v160, vcc quad_perm:[1,0,3,2] row_mask:0xf bank_mask:0xf
v_pk_add_f16 v201, v201, 1.0 op_sel_hi:[1,0]
v_mfma_f32_16x16x32_bf16 v[180:183], v[236:239], v[108:111], v[180:183]
v_cndmask_b32_dpp v161, v145, v161, vcc quad_perm:[1,0,3,2] row_mask:0xf bank_mask:0xf
v_pk_add_f16 v198, v198, 1.0 op_sel_hi:[1,0]
v_cndmask_b32_dpp v162, v146, v162, vcc quad_perm:[1,0,3,2] row_mask:0xf bank_mask:0xf
v_mfma_f32_16x16x32_bf16 v[168:171], v[216:219], v[112:115], v[168:171]
ds_read_b128 v[236:239], v249 offset:31744
v_pk_add_f16 v195, v195, 1.0 op_sel_hi:[1,0]
v_rcp_f16_e64 v202, v201
v_cndmask_b32_dpp v163, v147, v163, vcc quad_perm:[1,0,3,2] row_mask:0xf bank_mask:0xf
v_mfma_f32_16x16x32_bf16 v[176:179], v[216:219], v[116:119], v[176:179]
v_rcp_f16_e64 v199, v198
v_mfma_f32_16x16x32_bf16 v[172:175], v[220:223], v[112:115], v[172:175]
ds_read_b128 v[216:219], v248 offset:35072
s_add_u32 s46, s71, 98304
buffer_store_dwordx4 v[128:131], v255, s[8:11], s46 offen sc1
v_rcp_f16_e64 v196, v195
v_rcp_f16_sdwa v202, v201 dst_sel:WORD_1 dst_unused:UNUSED_PRESERVE src0_sel:WORD_1
v_mfma_f32_16x16x32_bf16 v[180:183], v[220:223], v[116:119], v[180:183]
v_rcp_f16_sdwa v199, v198 dst_sel:WORD_1 dst_unused:UNUSED_PRESERVE src0_sel:WORD_1
v_or_b32 v208, v184, v185
v_or_b32 v209, v186, v187
s_waitcnt lgkmcnt(2)
v_or_b32 v210, v188, v189
v_rcp_f16_sdwa v196, v195 dst_sel:WORD_1 dst_unused:UNUSED_PRESERVE src0_sel:WORD_1
v_or_b32 v211, v190, v191
v_or_b32 v212, v192, v193
v_pk_mul_f16 v213, v203, v202
v_pk_mul_f16 v214, v200, v199
v_pk_mul_f16 v215, v197, v196
v_mfma_f32_16x16x32_f16 v[48:51], v[224:227], v[208:211], v[48:51]
ds_read_b128 v[220:223], v249 offset:32000
v_cvt_pkrtz_f16_f32 v185, v168, v169
v_cvt_pkrtz_f16_f32 v187, v170, v171
v_mfma_f32_16x16x32_f16 v[56:59], v[224:227], v[212:215], v[56:59]
v_cvt_pkrtz_f16_f32 v189, v172, v173
v_cvt_pkrtz_f16_f32 v191, v174, v175
v_mfma_f32_16x16x32_f16 v[52:55], v[228:231], v[208:211], v[52:55]
ds_read_b128 v[224:227], v248 offset:35840
v_cvt_pkrtz_f16_f32 v193, v176, v177
v_cvt_pk_f16_f32 v203, v178, v179
v_mfma_f32_16x16x32_f16 v[60:63], v[228:231], v[212:215], v[60:63]
v_cvt_pk_f16_f32 v200, v180, v181
v_cvt_pk_f16_f32 v197, v182, v183
s_setprio 1
v_mfma_f32_16x16x32_bf16 v[168:171], v[232:235], v[96:99], 0
ds_read_b128 v[228:231], v249 offset:32768
v_pk_fma_f16 v202, v203, v203, s48
v_and_b32 v185, s49, v185
v_mfma_f32_16x16x32_bf16 v[176:179], v[232:235], v[100:103], 0
v_pk_fma_f16 v199, v200, v200, s48
v_and_b32 v187, s49, v187
s_waitcnt lgkmcnt(3)
v_mfma_f32_16x16x32_f16 v[64:67], v[236:239], v[208:211], v[64:67]
ds_read_b128 v[232:235], v249 offset:33024
v_pk_fma_f16 v196, v197, v197, s48
v_bfe_u32 v184, v185, 2, 14
v_pk_mul_f16 v202, v203, v202
v_mfma_f32_16x16x32_f16 v[72:75], v[236:239], v[212:215], v[72:75]
v_bfe_u32 v186, v187, 2, 14
v_pk_mul_f16 v199, v200, v199
s_waitcnt vmcnt(9)
v_mfma_f32_16x16x32_bf16 v[48:51], v[18:21], v[12:15], v[48:51]
ds_read_b128 v[236:239], v248 offset:36096
ds_read_u16_d16 v184, v184
ds_read_u16_d16 v186, v186
v_lshrrev_b32 v185, 18, v185
v_pk_mul_f16 v196, v197, v196
v_mfma_f32_16x16x32_bf16 v[52:55], v[16:19], v[12:15], v[52:55]
v_lshrrev_b32_e64 v187, 18, v187
v_mfma_f32_16x16x32_bf16 v[172:175], v[216:219], v[96:99], 0
ds_read_u16_d16_hi v185, v185
ds_read_u16_d16_hi v187, v187
v_exp_f16 v201, v202
v_and_b32 v189, s49, v189
v_mfma_f32_16x16x32_bf16 v[180:183], v[216:219], v[100:103], 0
v_and_b32 v191, s49, v191
s_waitcnt lgkmcnt(6)
v_mfma_f32_16x16x32_f16 v[68:71], v[220:223], v[208:211], v[68:71]
ds_read_b128 v[216:219], v248 offset:36864
v_exp_f16_e64 v198, v199
v_bfe_u32 v188, v189, 2, 14
v_mfma_f32_16x16x32_f16 v[76:79], v[220:223], v[212:215], v[76:79]
v_bfe_u32 v190, v191, 2, 14
v_exp_f16_e64 v195, v196
v_mfma_f32_16x16x32_bf16 v[168:171], v[224:227], v[104:107], v[168:171]
ds_read_b128 v[220:223], v248 offset:37120
ds_read_u16_d16 v188, v188
ds_read_u16_d16 v190, v190
v_lshrrev_b32 v189, 18, v189
v_lshrrev_b32 v191, 18, v191
v_mfma_f32_16x16x32_bf16 v[176:179], v[224:227], v[108:111], v[176:179]
v_exp_f16_sdwa v201, v202 dst_sel:WORD_1 dst_unused:UNUSED_PRESERVE src0_sel:WORD_1
v_mfma_f32_16x16x32_f16 v[80:83], v[228:231], v[208:211], v[80:83]
ds_read_b128 v[224:227], v249 offset:36864
ds_read_u16_d16_hi v189, v189
ds_read_u16_d16_hi v191, v191
v_and_b32 v193, s49, v193
v_bfe_u32 v192, v193, 2, 14
v_mfma_f32_16x16x32_f16 v[88:91], v[228:231], v[212:215], v[88:91]
v_exp_f16_sdwa v198, v199 dst_sel:WORD_1 dst_unused:UNUSED_PRESERVE src0_sel:WORD_1
s_waitcnt lgkmcnt(7)
v_mfma_f32_16x16x32_f16 v[84:87], v[232:235], v[208:211], v[84:87]
ds_read_b128 v[228:231], v249 offset:37120
ds_read_u16_d16 v192, v192
v_lshrrev_b32_e64 v193, 18, v193
v_mfma_f32_16x16x32_f16 v[92:95], v[232:235], v[212:215], v[92:95]
v_exp_f16_sdwa v195, v196 dst_sel:WORD_1 dst_unused:UNUSED_PRESERVE src0_sel:WORD_1
v_pk_add_f16 v201, v201, 1.0 op_sel_hi:[1,0]
v_pk_add_f16 v198, v198, 1.0 op_sel_hi:[1,0]
v_mfma_f32_16x16x32_bf16 v[172:175], v[236:239], v[104:107], v[172:175]
ds_read_b128 v[232:235], v248 offset:40960
ds_read_u16_d16_hi v193, v193
v_pk_add_f16 v195, v195, 1.0 op_sel_hi:[1,0]
v_mfma_f32_16x16x32_bf16 v[180:183], v[236:239], v[108:111], v[180:183]
v_rcp_f16_e64 v202, v201
s_setprio 0
s_waitcnt lgkmcnt(7)
v_mfma_f32_16x16x32_bf16 v[168:171], v[216:219], v[112:115], v[168:171]
ds_read_b128 v[236:239], v249 offset:37888
v_rcp_f16_e64 v199, v198
v_mfma_f32_16x16x32_bf16 v[176:179], v[216:219], v[116:119], v[176:179]
v_rcp_f16_e64 v196, v195
v_mfma_f32_16x16x32_bf16 v[172:175], v[220:223], v[112:115], v[172:175]
ds_read_b128 v[216:219], v248 offset:41216
v_rcp_f16_sdwa v202, v201 dst_sel:WORD_1 dst_unused:UNUSED_PRESERVE src0_sel:WORD_1
v_mfma_f32_16x16x32_bf16 v[180:183], v[220:223], v[116:119], v[180:183]
v_rcp_f16_sdwa v199, v198 dst_sel:WORD_1 dst_unused:UNUSED_PRESERVE src0_sel:WORD_1
v_or_b32 v208, v184, v185
v_or_b32 v209, v186, v187
s_waitcnt lgkmcnt(4)
v_or_b32 v210, v188, v189
v_rcp_f16_sdwa v196, v195 dst_sel:WORD_1 dst_unused:UNUSED_PRESERVE src0_sel:WORD_1
v_or_b32 v211, v190, v191
s_waitcnt lgkmcnt(2)
v_or_b32 v212, v192, v193
v_pk_mul_f16 v213, v203, v202
v_pk_mul_f16 v214, v200, v199
v_pk_mul_f16 v215, v197, v196
s_setprio 3
v_mfma_f32_16x16x32_f16 v[48:51], v[224:227], v[208:211], v[48:51]
s_add_u32 s46, s71, 98304
buffer_store_dwordx4 v[148:151], v255, s[8:11], s46 offen offset:128 sc1
ds_read_b128 v[220:223], v249 offset:38144
v_cvt_pkrtz_f16_f32 v185, v168, v169
v_cvt_pkrtz_f16_f32 v187, v170, v171
v_mfma_f32_16x16x32_f16 v[56:59], v[224:227], v[212:215], v[56:59]
v_cvt_pkrtz_f16_f32 v189, v172, v173
v_cvt_pkrtz_f16_f32 v191, v174, v175
v_mfma_f32_16x16x32_f16 v[52:55], v[228:231], v[208:211], v[52:55]
ds_read_b128 v[224:227], v248 offset:41984
v_cvt_pkrtz_f16_f32 v193, v176, v177
v_cvt_pk_f16_f32 v203, v178, v179
v_mfma_f32_16x16x32_f16 v[60:63], v[228:231], v[212:215], v[60:63]
v_cvt_pk_f16_f32 v200, v180, v181
v_cvt_pk_f16_f32 v197, v182, v183
v_mfma_f32_16x16x32_bf16 v[168:171], v[232:235], v[96:99], 0
ds_read_b128 v[228:231], v249 offset:38912
v_pk_fma_f16 v202, v203, v203, s48
v_and_b32_e64 v185, s49, v185
v_mfma_f32_16x16x32_bf16 v[176:179], v[232:235], v[100:103], 0
v_pk_fma_f16 v199, v200, v200, s48
v_and_b32 v187, s49, v187
s_waitcnt lgkmcnt(3)
v_mfma_f32_16x16x32_f16 v[64:67], v[236:239], v[208:211], v[64:67]
ds_read_b128 v[232:235], v249 offset:39168
v_pk_fma_f16 v196, v197, v197, s48
v_bfe_u32 v184, v185, 2, 14
v_pk_mul_f16 v202, v203, v202
v_mfma_f32_16x16x32_f16 v[72:75], v[236:239], v[212:215], v[72:75]
v_bfe_u32 v186, v187, 2, 14
v_pk_mul_f16 v199, v200, v199
s_waitcnt vmcnt(9)
v_mfma_f32_16x16x32_bf16 v[64:67], v[18:21], v[8:11], v[64:67]
ds_read_b128 v[236:239], v248 offset:42240
ds_read_u16_d16 v184, v184
ds_read_u16_d16 v186, v186
v_lshrrev_b32 v185, 18, v185
v_pk_mul_f16 v196, v197, v196
v_mfma_f32_16x16x32_bf16 v[68:71], v[16:19], v[8:11], v[68:71]
v_lshrrev_b32_e64 v187, 18, v187
v_mfma_f32_16x16x32_bf16 v[172:175], v[216:219], v[96:99], 0
ds_read_u16_d16_hi v185, v185
ds_read_u16_d16_hi v187, v187
v_exp_f16 v201, v202
v_and_b32 v189, s49, v189
v_mfma_f32_16x16x32_bf16 v[180:183], v[216:219], v[100:103], 0
v_and_b32 v191, s49, v191
s_waitcnt lgkmcnt(6)
v_mfma_f32_16x16x32_f16 v[68:71], v[220:223], v[208:211], v[68:71]
ds_read_b128 v[216:219], v248 offset:43008
v_exp_f16_e64 v198, v199
v_bfe_u32 v188, v189, 2, 14
v_mfma_f32_16x16x32_f16 v[76:79], v[220:223], v[212:215], v[76:79]
v_bfe_u32 v190, v191, 2, 14
v_exp_f16_e64 v195, v196
v_mfma_f32_16x16x32_bf16 v[168:171], v[224:227], v[104:107], v[168:171]
ds_read_b128 v[220:223], v248 offset:43264
ds_read_u16_d16 v188, v188
ds_read_u16_d16 v190, v190
v_lshrrev_b32 v189, 18, v189
v_lshrrev_b32 v191, 18, v191
v_mfma_f32_16x16x32_bf16 v[176:179], v[224:227], v[108:111], v[176:179]
v_exp_f16_sdwa v201, v202 dst_sel:WORD_1 dst_unused:UNUSED_PRESERVE src0_sel:WORD_1
v_mfma_f32_16x16x32_f16 v[80:83], v[228:231], v[208:211], v[80:83]
ds_read_b128 v[224:227], v249 offset:43008
ds_read_u16_d16_hi v189, v189
ds_read_u16_d16_hi v191, v191
v_and_b32 v193, s49, v193
v_bfe_u32 v192, v193, 2, 14
v_mfma_f32_16x16x32_f16 v[88:91], v[228:231], v[212:215], v[88:91]
v_exp_f16_sdwa v198, v199 dst_sel:WORD_1 dst_unused:UNUSED_PRESERVE src0_sel:WORD_1
s_waitcnt lgkmcnt(7)
v_mfma_f32_16x16x32_f16 v[84:87], v[232:235], v[208:211], v[84:87]
ds_read_b128 v[228:231], v249 offset:43264
ds_read_u16_d16 v192, v192
v_lshrrev_b32_e64 v193, 18, v193
v_mfma_f32_16x16x32_f16 v[92:95], v[232:235], v[212:215], v[92:95]
v_exp_f16_sdwa v195, v196 dst_sel:WORD_1 dst_unused:UNUSED_PRESERVE src0_sel:WORD_1
v_pk_add_f16 v201, v201, 1.0 op_sel_hi:[1,0]
v_pk_add_f16 v198, v198, 1.0 op_sel_hi:[1,0]
v_mfma_f32_16x16x32_bf16 v[172:175], v[236:239], v[104:107], v[172:175]
ds_read_b128 v[232:235], v248 offset:16384
ds_read_u16_d16_hi v193, v193
v_pk_add_f16 v195, v195, 1.0 op_sel_hi:[1,0]
v_mfma_f32_16x16x32_bf16 v[180:183], v[236:239], v[108:111], v[180:183]
v_rcp_f16 v202, v201
s_waitcnt lgkmcnt(7)
v_mfma_f32_16x16x32_bf16 v[168:171], v[216:219], v[112:115], v[168:171]
ds_read_b128 v[236:239], v249 offset:44032
v_rcp_f16_e64 v199, v198
v_mfma_f32_16x16x32_bf16 v[176:179], v[216:219], v[116:119], v[176:179]
v_rcp_f16_e64 v196, v195
v_mfma_f32_16x16x32_bf16 v[172:175], v[220:223], v[112:115], v[172:175]
ds_read_b128 v[216:219], v248 offset:16640
v_rcp_f16_sdwa v202, v201 dst_sel:WORD_1 dst_unused:UNUSED_PRESERVE src0_sel:WORD_1
v_mfma_f32_16x16x32_bf16 v[180:183], v[220:223], v[116:119], v[180:183]
v_rcp_f16_sdwa v199, v198 dst_sel:WORD_1 dst_unused:UNUSED_PRESERVE src0_sel:WORD_1
v_or_b32 v208, v184, v185
v_or_b32 v209, v186, v187
s_waitcnt lgkmcnt(4)
v_or_b32 v210, v188, v189
v_rcp_f16_sdwa v196, v195 dst_sel:WORD_1 dst_unused:UNUSED_PRESERVE src0_sel:WORD_1
v_or_b32 v211, v190, v191
s_waitcnt lgkmcnt(2)
v_or_b32_e64 v212, v192, v193
v_pk_mul_f16 v213, v203, v202
v_pk_mul_f16 v214, v200, v199
v_pk_mul_f16 v215, v197, v196
v_mfma_f32_16x16x32_f16 v[48:51], v[224:227], v[208:211], v[48:51]
s_add_u32 s46, s71, 98304
buffer_store_dwordx4 v[160:163], v255, s[8:11], s46 offen offset:256 sc1
ds_read_b128 v[220:223], v249 offset:44288
v_cvt_pkrtz_f16_f32 v185, v168, v169
v_cvt_pkrtz_f16_f32 v187, v170, v171
v_mfma_f32_16x16x32_f16 v[56:59], v[224:227], v[212:215], v[56:59]
v_cvt_pkrtz_f16_f32 v189, v172, v173
v_cvt_pkrtz_f16_f32 v191, v174, v175
v_mfma_f32_16x16x32_f16 v[52:55], v[228:231], v[208:211], v[52:55]
ds_read_b128 v[224:227], v248 offset:17408
v_cvt_pkrtz_f16_f32 v193, v176, v177
v_cvt_pk_f16_f32 v203, v178, v179
v_mfma_f32_16x16x32_f16 v[60:63], v[228:231], v[212:215], v[60:63]
v_cvt_pk_f16_f32 v200, v180, v181
v_cvt_pk_f16_f32 v197, v182, v183
v_mfma_f32_16x16x32_bf16 v[168:171], v[232:235], v[24:27], 0
ds_read_b128 v[228:231], v249 offset:45056
v_pk_fma_f16 v202, v203, v203, s48
v_and_b32_e64 v185, s49, v185
v_mfma_f32_16x16x32_bf16 v[176:179], v[232:235], v[28:31], 0
v_pk_fma_f16 v199, v200, v200, s48
v_and_b32 v187, s49, v187
s_waitcnt lgkmcnt(3)
v_mfma_f32_16x16x32_f16 v[64:67], v[236:239], v[208:211], v[64:67]
ds_read_b128 v[232:235], v249 offset:45312
v_pk_fma_f16 v196, v197, v197, s48
s_setprio 2
v_bfe_u32 v184, v185, 2, 14
v_pk_mul_f16 v202, v203, v202
v_mfma_f32_16x16x32_f16 v[72:75], v[236:239], v[212:215], v[72:75]
v_bfe_u32 v186, v187, 2, 14
v_pk_mul_f16 v199, v200, v199
s_waitcnt vmcnt(9)
v_mfma_f32_16x16x32_bf16 v[80:83], v[18:21], v[4:7], v[80:83]
ds_read_b128 v[236:239], v248 offset:17664
ds_read_u16_d16 v184, v184
ds_read_u16_d16 v186, v186
v_lshrrev_b32_e64 v185, 18, v185
v_pk_mul_f16 v196, v197, v196
v_mfma_f32_16x16x32_bf16 v[84:87], v[16:19], v[4:7], v[84:87]
v_lshrrev_b32_e64 v187, 18, v187
v_mfma_f32_16x16x32_bf16 v[172:175], v[216:219], v[24:27], 0
ds_read_u16_d16_hi v185, v185
ds_read_u16_d16_hi v187, v187
v_exp_f16 v201, v202
v_and_b32 v189, s49, v189
v_mfma_f32_16x16x32_bf16 v[180:183], v[216:219], v[28:31], 0
v_and_b32 v191, s49, v191
s_waitcnt lgkmcnt(6)
v_mfma_f32_16x16x32_f16 v[68:71], v[220:223], v[208:211], v[68:71]
ds_read_b128 v[216:219], v248 offset:18432
v_exp_f16_e64 v198, v199
v_bfe_u32 v188, v189, 2, 14
v_mfma_f32_16x16x32_f16 v[76:79], v[220:223], v[212:215], v[76:79]
v_bfe_u32 v190, v191, 2, 14
v_exp_f16_e64 v195, v196
v_mfma_f32_16x16x32_bf16 v[168:171], v[224:227], v[32:35], v[168:171]
s_add_u32 s46, s80, 12582912
buffer_load_dwordx4 v[96:99], v253, s[32:35], s46 offen nt
ds_read_b128 v[220:223], v248 offset:18688
ds_read_u16_d16 v188, v188
ds_read_u16_d16 v190, v190
v_lshrrev_b32 v189, 18, v189
v_lshrrev_b32 v191, 18, v191
v_mfma_f32_16x16x32_bf16 v[176:179], v[224:227], v[36:39], v[176:179]
v_exp_f16_sdwa v201, v202 dst_sel:WORD_1 dst_unused:UNUSED_PRESERVE src0_sel:WORD_1
v_mfma_f32_16x16x32_f16 v[80:83], v[228:231], v[208:211], v[80:83]
ds_read_b128 v[224:227], v249 offset:49152
ds_read_u16_d16_hi v189, v189
ds_read_u16_d16_hi v191, v191
v_and_b32 v193, s49, v193
v_bfe_u32 v192, v193, 2, 14
v_mfma_f32_16x16x32_f16 v[88:91], v[228:231], v[212:215], v[88:91]
v_exp_f16_sdwa v198, v199 dst_sel:WORD_1 dst_unused:UNUSED_PRESERVE src0_sel:WORD_1
s_waitcnt lgkmcnt(7)
v_mfma_f32_16x16x32_f16 v[84:87], v[232:235], v[208:211], v[84:87]
ds_read_b128 v[228:231], v249 offset:49408
ds_read_u16_d16 v192, v192
v_lshrrev_b32_e64 v193, 18, v193
v_mfma_f32_16x16x32_f16 v[92:95], v[232:235], v[212:215], v[92:95]
v_exp_f16_sdwa v195, v196 dst_sel:WORD_1 dst_unused:UNUSED_PRESERVE src0_sel:WORD_1
v_pk_add_f16 v201, v201, 1.0 op_sel_hi:[1,0]
v_pk_add_f16 v198, v198, 1.0 op_sel_hi:[1,0]
v_mfma_f32_16x16x32_bf16 v[172:175], v[236:239], v[32:35], v[172:175]
ds_read_b128 v[232:235], v248 offset:22528
ds_read_u16_d16_hi v193, v193
v_pk_add_f16 v195, v195, 1.0 op_sel_hi:[1,0]
v_mfma_f32_16x16x32_bf16 v[180:183], v[236:239], v[36:39], v[180:183]
v_rcp_f16 v202, v201
s_waitcnt lgkmcnt(7)
v_mfma_f32_16x16x32_bf16 v[168:171], v[216:219], v[40:43], v[168:171]
ds_read_b128 v[236:239], v249 offset:50176
v_rcp_f16_e64 v199, v198
v_mfma_f32_16x16x32_bf16 v[176:179], v[216:219], v[44:47], v[176:179]
v_rcp_f16_e64 v196, v195
v_mfma_f32_16x16x32_bf16 v[172:175], v[220:223], v[40:43], v[172:175]
ds_read_b128 v[216:219], v248 offset:22784
v_rcp_f16_sdwa v202, v201 dst_sel:WORD_1 dst_unused:UNUSED_PRESERVE src0_sel:WORD_1
v_mfma_f32_16x16x32_bf16 v[180:183], v[220:223], v[44:47], v[180:183]
v_rcp_f16_sdwa v199, v198 dst_sel:WORD_1 dst_unused:UNUSED_PRESERVE src0_sel:WORD_1
v_or_b32 v208, v184, v185
v_or_b32 v209, v186, v187
s_waitcnt lgkmcnt(4)
v_or_b32 v210, v188, v189
v_rcp_f16_sdwa v196, v195 dst_sel:WORD_1 dst_unused:UNUSED_PRESERVE src0_sel:WORD_1
v_or_b32 v211, v190, v191
s_waitcnt lgkmcnt(2)
v_or_b32_e64 v212, v192, v193
v_pk_mul_f16 v213, v203, v202
v_pk_mul_f16 v214, v200, v199
v_pk_mul_f16 v215, v197, v196
v_mfma_f32_16x16x32_f16 v[48:51], v[224:227], v[208:211], v[48:51]
s_add_u32 s46, s80, 12582912
buffer_load_dwordx4 v[100:103], v253, s[32:35], s46 offen offset:256 nt
ds_read_b128 v[220:223], v249 offset:50432
v_cvt_pkrtz_f16_f32 v185, v168, v169
v_cvt_pkrtz_f16_f32 v187, v170, v171
v_mfma_f32_16x16x32_f16 v[56:59], v[224:227], v[212:215], v[56:59]
v_cvt_pkrtz_f16_f32 v189, v172, v173
v_cvt_pkrtz_f16_f32 v191, v174, v175
v_mfma_f32_16x16x32_f16 v[52:55], v[228:231], v[208:211], v[52:55]
ds_read_b128 v[224:227], v248 offset:23552
v_cvt_pkrtz_f16_f32 v193, v176, v177
v_cvt_pk_f16_f32 v203, v178, v179
v_mfma_f32_16x16x32_f16 v[60:63], v[228:231], v[212:215], v[60:63]
v_cvt_pk_f16_f32 v200, v180, v181
v_cvt_pk_f16_f32 v197, v182, v183
s_setprio 1
v_mfma_f32_16x16x32_bf16 v[168:171], v[232:235], v[24:27], 0
ds_read_b128 v[228:231], v249 offset:51200
v_pk_fma_f16 v202, v203, v203, s48
v_and_b32 v185, s49, v185
v_mfma_f32_16x16x32_bf16 v[176:179], v[232:235], v[28:31], 0
v_pk_fma_f16 v199, v200, v200, s48
v_and_b32 v187, s49, v187
s_waitcnt lgkmcnt(3)
v_mfma_f32_16x16x32_f16 v[64:67], v[236:239], v[208:211], v[64:67]
ds_read_b128 v[232:235], v249 offset:51456
v_pk_fma_f16 v196, v197, v197, s48
v_bfe_u32 v184, v185, 2, 14
v_pk_mul_f16 v202, v203, v202
v_mfma_f32_16x16x32_f16 v[72:75], v[236:239], v[212:215], v[72:75]
v_bfe_u32 v186, v187, 2, 14
v_pk_mul_f16 v199, v200, v199
s_waitcnt vmcnt(10)
v_mfma_f32_16x16x32_bf16 v[56:59], v[18:21], v[0:3], v[56:59]
ds_read_b128 v[236:239], v248 offset:23808
ds_read_u16_d16 v184, v184
ds_read_u16_d16 v186, v186
v_lshrrev_b32 v185, 18, v185
v_pk_mul_f16 v196, v197, v196
v_mfma_f32_16x16x32_bf16 v[60:63], v[16:19], v[0:3], v[60:63]
v_lshrrev_b32_e64 v187, 18, v187
v_mfma_f32_16x16x32_bf16 v[172:175], v[216:219], v[24:27], 0
ds_read_u16_d16_hi v185, v185
ds_read_u16_d16_hi v187, v187
v_exp_f16 v201, v202
v_and_b32 v189, s49, v189
v_mfma_f32_16x16x32_bf16 v[180:183], v[216:219], v[28:31], 0
v_and_b32 v191, s49, v191
s_waitcnt lgkmcnt(6)
v_mfma_f32_16x16x32_f16 v[68:71], v[220:223], v[208:211], v[68:71]
ds_read_b128 v[216:219], v248 offset:24576
v_exp_f16_e64 v198, v199
v_bfe_u32 v188, v189, 2, 14
v_mfma_f32_16x16x32_f16 v[76:79], v[220:223], v[212:215], v[76:79]
v_bfe_u32 v190, v191, 2, 14
v_exp_f16_e64 v195, v196
v_mfma_f32_16x16x32_bf16 v[168:171], v[224:227], v[32:35], v[168:171]
ds_read_b128 v[220:223], v248 offset:24832
ds_read_u16_d16 v188, v188
ds_read_u16_d16 v190, v190
v_lshrrev_b32 v189, 18, v189
v_lshrrev_b32 v191, 18, v191
v_mfma_f32_16x16x32_bf16 v[176:179], v[224:227], v[36:39], v[176:179]
v_exp_f16_sdwa v201, v202 dst_sel:WORD_1 dst_unused:UNUSED_PRESERVE src0_sel:WORD_1
v_mfma_f32_16x16x32_f16 v[80:83], v[228:231], v[208:211], v[80:83]
ds_read_b128 v[224:227], v249 offset:24576
ds_read_u16_d16_hi v189, v189
ds_read_u16_d16_hi v191, v191
v_and_b32 v193, s49, v193
v_bfe_u32 v192, v193, 2, 14
v_mfma_f32_16x16x32_f16 v[88:91], v[228:231], v[212:215], v[88:91]
v_exp_f16_sdwa v198, v199 dst_sel:WORD_1 dst_unused:UNUSED_PRESERVE src0_sel:WORD_1
s_waitcnt lgkmcnt(7)
v_mfma_f32_16x16x32_f16 v[84:87], v[232:235], v[208:211], v[84:87]
ds_read_b128 v[228:231], v254 offset:7936
ds_read_u16_d16 v192, v192
v_lshrrev_b32_e64 v193, 18, v193
v_mfma_f32_16x16x32_f16 v[92:95], v[232:235], v[212:215], v[92:95]
v_exp_f16_sdwa v195, v196 dst_sel:WORD_1 dst_unused:UNUSED_PRESERVE src0_sel:WORD_1
v_pk_add_f16 v201, v201, 1.0 op_sel_hi:[1,0]
v_pk_add_f16 v198, v198, 1.0 op_sel_hi:[1,0]
v_mfma_f32_16x16x32_bf16 v[172:175], v[236:239], v[32:35], v[172:175]
ds_read_b128 v[232:235], v249 offset:24832
ds_read_u16_d16_hi v193, v193
v_pk_add_f16 v195, v195, 1.0 op_sel_hi:[1,0]
v_mfma_f32_16x16x32_bf16 v[180:183], v[236:239], v[36:39], v[180:183]
v_rcp_f16_e64 v202, v201
s_setprio 0
s_waitcnt lgkmcnt(7)
v_mfma_f32_16x16x32_bf16 v[168:171], v[216:219], v[40:43], v[168:171]
ds_read_b128 v[236:239], v254 offset:7952
v_rcp_f16_e64 v199, v198
v_mfma_f32_16x16x32_bf16 v[176:179], v[216:219], v[44:47], v[176:179]
v_rcp_f16_e64 v196, v195
v_mfma_f32_16x16x32_bf16 v[172:175], v[220:223], v[40:43], v[172:175]
ds_read_b128 v[216:219], v248 offset:28672
v_rcp_f16_sdwa v202, v201 dst_sel:WORD_1 dst_unused:UNUSED_PRESERVE src0_sel:WORD_1
v_mfma_f32_16x16x32_bf16 v[180:183], v[220:223], v[44:47], v[180:183]
v_rcp_f16_sdwa v199, v198 dst_sel:WORD_1 dst_unused:UNUSED_PRESERVE src0_sel:WORD_1
v_or_b32 v208, v184, v185
v_or_b32 v209, v186, v187
s_waitcnt lgkmcnt(4)
v_or_b32 v210, v188, v189
v_rcp_f16_sdwa v196, v195 dst_sel:WORD_1 dst_unused:UNUSED_PRESERVE src0_sel:WORD_1
v_or_b32 v211, v190, v191
s_waitcnt lgkmcnt(2)
v_or_b32_e64 v212, v192, v193
v_pk_mul_f16 v213, v203, v202
v_pk_mul_f16 v214, v200, v199
v_pk_mul_f16 v215, v197, v196
s_setprio 3
v_mfma_f32_16x16x32_f16 v[120:123], v[224:227], v[208:211], v[228:231]
s_add_u32 s46, s80, 16777216
buffer_load_dwordx4 v[104:107], v253, s[32:35], s46 offen nt
ds_read_b128 v[220:223], v249 offset:25600
v_cvt_pkrtz_f16_f32 v185, v168, v169
v_cvt_pkrtz_f16_f32 v187, v170, v171
v_mfma_f32_16x16x32_f16 v[128:131], v[224:227], v[212:215], v[228:231]
v_cvt_pkrtz_f16_f32 v189, v172, v173
v_cvt_pkrtz_f16_f32 v191, v174, v175
s_waitcnt lgkmcnt(1)
v_mfma_f32_16x16x32_f16 v[124:127], v[232:235], v[208:211], v[236:239]
ds_read_b128 v[224:227], v254 offset:8064
ds_read_b128 v[228:231], v248 offset:28928
v_cvt_pkrtz_f16_f32 v193, v176, v177
v_cvt_pk_f16_f32 v203, v178, v179
v_mfma_f32_16x16x32_f16 v[132:135], v[232:235], v[212:215], v[236:239]
v_cvt_pk_f16_f32 v200, v180, v181
v_cvt_pk_f16_f32 v197, v182, v183
v_mfma_f32_16x16x32_bf16 v[168:171], v[216:219], v[24:27], 0
ds_read_b128 v[232:235], v249 offset:25856
ds_read_b128 v[236:239], v254 offset:8080
v_pk_fma_f16 v202, v203, v203, s48
v_and_b32_e64 v185, s49, v185
v_mfma_f32_16x16x32_bf16 v[176:179], v[216:219], v[28:31], 0
v_pk_fma_f16 v199, v200, v200, s48
v_and_b32 v187, s49, v187
s_waitcnt lgkmcnt(3)
v_mfma_f32_16x16x32_f16 v[136:139], v[220:223], v[208:211], v[224:227]
ds_read_b128 v[216:219], v248 offset:29696
v_pk_fma_f16 v196, v197, v197, s48
v_bfe_u32 v184, v185, 2, 14
v_pk_mul_f16 v202, v203, v202
v_mfma_f32_16x16x32_f16 v[144:147], v[220:223], v[212:215], v[224:227]
v_bfe_u32 v186, v187, 2, 14
v_pk_mul_f16 v199, v200, v199
s_waitcnt vmcnt(8)
v_mfma_f32_16x16x32_bf16 v[72:75], v[18:21], v[244:247], v[72:75]
ds_read_b128 v[220:223], v249 offset:26624
ds_read_b128 v[224:227], v254 offset:16128
ds_read_u16_d16 v184, v184
ds_read_u16_d16 v186, v186
v_lshrrev_b32 v185, 18, v185
v_pk_mul_f16 v196, v197, v196
v_mfma_f32_16x16x32_bf16 v[76:79], v[16:19], v[244:247], v[76:79]
v_lshrrev_b32 v187, 18, v187
s_waitcnt lgkmcnt(5)
v_mfma_f32_16x16x32_bf16 v[172:175], v[228:231], v[24:27], 0
ds_read_u16_d16_hi v185, v185
ds_read_u16_d16_hi v187, v187
v_exp_f16 v201, v202
v_and_b32 v189, s49, v189
v_mfma_f32_16x16x32_bf16 v[180:183], v[228:231], v[28:31], 0
v_and_b32_e64 v191, s49, v191
v_mfma_f32_16x16x32_f16 v[140:143], v[232:235], v[208:211], v[236:239]
ds_read_b128 v[228:231], v249 offset:26880
v_exp_f16_e64 v198, v199
v_bfe_u32 v188, v189, 2, 14
v_mfma_f32_16x16x32_f16 v[148:151], v[232:235], v[212:215], v[236:239]
v_bfe_u32 v190, v191, 2, 14
v_exp_f16 v195, v196
s_waitcnt lgkmcnt(7)
v_mfma_f32_16x16x32_bf16 v[168:171], v[216:219], v[32:35], v[168:171]
ds_read_b128 v[232:235], v254 offset:16144
ds_read_b128 v[236:239], v248 offset:29952
ds_read_u16_d16 v188, v188
ds_read_u16_d16 v190, v190
v_lshrrev_b32_e64 v189, 18, v189
v_lshrrev_b32 v191, 18, v191
v_mfma_f32_16x16x32_bf16 v[176:179], v[216:219], v[36:39], v[176:179]
v_exp_f16_sdwa v201, v202 dst_sel:WORD_1 dst_unused:UNUSED_PRESERVE src0_sel:WORD_1
s_waitcnt lgkmcnt(7)
v_mfma_f32_16x16x32_f16 v[152:155], v[220:223], v[208:211], v[224:227]
ds_read_b128 v[216:219], v248 offset:30720
ds_read_u16_d16_hi v189, v189
ds_read_u16_d16_hi v191, v191
v_and_b32 v193, s49, v193
v_bfe_u32 v192, v193, 2, 14
v_mfma_f32_16x16x32_f16 v[160:163], v[220:223], v[212:215], v[224:227]
v_exp_f16_sdwa v198, v199 dst_sel:WORD_1 dst_unused:UNUSED_PRESERVE src0_sel:WORD_1
s_waitcnt lgkmcnt(6)
v_mfma_f32_16x16x32_f16 v[156:159], v[228:231], v[208:211], v[232:235]
ds_read_b128 v[220:223], v248 offset:30976
ds_read_b128 v[224:227], v249 offset:30720
ds_read_u16_d16 v192, v192
v_lshrrev_b32 v193, 18, v193
v_mfma_f32_16x16x32_f16 v[164:167], v[228:231], v[212:215], v[232:235]
v_exp_f16_sdwa v195, v196 dst_sel:WORD_1 dst_unused:UNUSED_PRESERVE src0_sel:WORD_1
v_pk_add_f16 v201, v201, 1.0 op_sel_hi:[1,0]
v_pk_add_f16 v198, v198, 1.0 op_sel_hi:[1,0]
s_waitcnt lgkmcnt(7)
v_mfma_f32_16x16x32_bf16 v[172:175], v[236:239], v[32:35], v[172:175]
ds_read_b128 v[228:231], v249 offset:30976
ds_read_b128 v[232:235], v248 offset:34816
ds_read_u16_d16_hi v193, v193
v_pk_add_f16 v195, v195, 1.0 op_sel_hi:[1,0]
v_mfma_f32_16x16x32_bf16 v[180:183], v[236:239], v[36:39], v[180:183]
v_rcp_f16 v202, v201
s_waitcnt lgkmcnt(8)
v_mfma_f32_16x16x32_bf16 v[168:171], v[216:219], v[40:43], v[168:171]
ds_read_b128 v[236:239], v249 offset:31744
v_rcp_f16_e64 v199, v198
v_mfma_f32_16x16x32_bf16 v[176:179], v[216:219], v[44:47], v[176:179]
v_rcp_f16 v196, v195
s_waitcnt lgkmcnt(6)
v_mfma_f32_16x16x32_bf16 v[172:175], v[220:223], v[40:43], v[172:175]
ds_read_b128 v[216:219], v248 offset:35072
v_rcp_f16_sdwa v202, v201 dst_sel:WORD_1 dst_unused:UNUSED_PRESERVE src0_sel:WORD_1
v_mfma_f32_16x16x32_bf16 v[180:183], v[220:223], v[44:47], v[180:183]
v_rcp_f16_sdwa v199, v198 dst_sel:WORD_1 dst_unused:UNUSED_PRESERVE src0_sel:WORD_1
v_or_b32 v208, v184, v185
v_or_b32 v209, v186, v187
v_or_b32_e64 v210, v188, v189
v_rcp_f16_sdwa v196, v195 dst_sel:WORD_1 dst_unused:UNUSED_PRESERVE src0_sel:WORD_1
v_or_b32 v211, v190, v191
s_waitcnt lgkmcnt(2)
v_or_b32_e64 v212, v192, v193
v_pk_mul_f16 v213, v203, v202
v_pk_mul_f16 v214, v200, v199
v_pk_mul_f16 v215, v197, v196
v_mfma_f32_16x16x32_f16 v[120:123], v[224:227], v[208:211], v[120:123]
s_add_u32 s46, s80, 16777216
buffer_load_dwordx4 v[108:111], v253, s[32:35], s46 offen offset:256 nt
ds_read_b128 v[220:223], v249 offset:32000
v_cvt_pkrtz_f16_f32 v185, v168, v169
v_cvt_pkrtz_f16_f32 v187, v170, v171
v_mfma_f32_16x16x32_f16 v[128:131], v[224:227], v[212:215], v[128:131]
v_cvt_pkrtz_f16_f32 v189, v172, v173
v_cvt_pkrtz_f16_f32 v191, v174, v175
v_mfma_f32_16x16x32_f16 v[124:127], v[228:231], v[208:211], v[124:127]
ds_read_b128 v[224:227], v248 offset:35840
v_cvt_pkrtz_f16_f32 v193, v176, v177
v_cvt_pk_f16_f32 v203, v178, v179
v_mfma_f32_16x16x32_f16 v[132:135], v[228:231], v[212:215], v[132:135]
v_cvt_pk_f16_f32 v200, v180, v181
v_cvt_pk_f16_f32 v197, v182, v183
v_mfma_f32_16x16x32_bf16 v[168:171], v[232:235], v[24:27], 0
ds_read_b128 v[228:231], v249 offset:32768
v_pk_fma_f16 v202, v203, v203, s48
v_and_b32_e64 v185, s49, v185
v_mfma_f32_16x16x32_bf16 v[176:179], v[232:235], v[28:31], 0
v_pk_fma_f16 v199, v200, v200, s48
v_and_b32 v187, s49, v187
s_waitcnt lgkmcnt(3)
v_mfma_f32_16x16x32_f16 v[136:139], v[236:239], v[208:211], v[136:139]
ds_read_b128 v[232:235], v249 offset:33024
v_pk_fma_f16 v196, v197, v197, s48
s_setprio 2
v_bfe_u32 v184, v185, 2, 14
v_pk_mul_f16 v202, v203, v202
v_mfma_f32_16x16x32_f16 v[144:147], v[236:239], v[212:215], v[144:147]
v_bfe_u32 v186, v187, 2, 14
v_pk_mul_f16 v199, v200, v199
s_waitcnt vmcnt(8)
v_mfma_f32_16x16x32_bf16 v[88:91], v[18:21], v[204:207], v[88:91]
ds_read_b128 v[236:239], v248 offset:36096
ds_read_u16_d16 v184, v184
ds_read_u16_d16 v186, v186
v_lshrrev_b32_e64 v185, 18, v185
v_pk_mul_f16 v196, v197, v196
v_mfma_f32_16x16x32_bf16 v[92:95], v[16:19], v[204:207], v[92:95]
v_lshrrev_b32_e64 v187, 18, v187
v_mfma_f32_16x16x32_bf16 v[172:175], v[216:219], v[24:27], 0
ds_read_u16_d16_hi v185, v185
ds_read_u16_d16_hi v187, v187
v_exp_f16 v201, v202
v_and_b32 v189, s49, v189
v_mfma_f32_16x16x32_bf16 v[180:183], v[216:219], v[28:31], 0
v_and_b32 v191, s49, v191
s_waitcnt lgkmcnt(6)
v_mfma_f32_16x16x32_f16 v[140:143], v[220:223], v[208:211], v[140:143]
ds_read_b128 v[216:219], v248 offset:36864
v_exp_f16_e64 v198, v199
v_bfe_u32 v188, v189, 2, 14
v_mfma_f32_16x16x32_f16 v[148:151], v[220:223], v[212:215], v[148:151]
v_bfe_u32 v190, v191, 2, 14
v_exp_f16_e64 v195, v196
v_mfma_f32_16x16x32_bf16 v[168:171], v[224:227], v[32:35], v[168:171]
ds_read_b128 v[220:223], v248 offset:37120
ds_read_u16_d16 v188, v188
ds_read_u16_d16 v190, v190
v_lshrrev_b32 v189, 18, v189
v_lshrrev_b32 v191, 18, v191
v_mfma_f32_16x16x32_bf16 v[176:179], v[224:227], v[36:39], v[176:179]
v_exp_f16_sdwa v201, v202 dst_sel:WORD_1 dst_unused:UNUSED_PRESERVE src0_sel:WORD_1
v_mfma_f32_16x16x32_f16 v[152:155], v[228:231], v[208:211], v[152:155]
ds_read_b128 v[224:227], v249 offset:36864
ds_read_u16_d16_hi v189, v189
ds_read_u16_d16_hi v191, v191
v_and_b32 v193, s49, v193
v_bfe_u32 v192, v193, 2, 14
v_mfma_f32_16x16x32_f16 v[160:163], v[228:231], v[212:215], v[160:163]
v_exp_f16_sdwa v198, v199 dst_sel:WORD_1 dst_unused:UNUSED_PRESERVE src0_sel:WORD_1
s_waitcnt lgkmcnt(7)
v_mfma_f32_16x16x32_f16 v[156:159], v[232:235], v[208:211], v[156:159]
ds_read_b128 v[228:231], v249 offset:37120
ds_read_u16_d16 v192, v192
v_lshrrev_b32_e64 v193, 18, v193
v_mfma_f32_16x16x32_f16 v[164:167], v[232:235], v[212:215], v[164:167]
v_exp_f16_sdwa v195, v196 dst_sel:WORD_1 dst_unused:UNUSED_PRESERVE src0_sel:WORD_1
v_pk_add_f16 v201, v201, 1.0 op_sel_hi:[1,0]
v_pk_add_f16 v198, v198, 1.0 op_sel_hi:[1,0]
v_mfma_f32_16x16x32_bf16 v[172:175], v[236:239], v[32:35], v[172:175]
ds_read_b128 v[232:235], v248 offset:40960
ds_read_u16_d16_hi v193, v193
v_pk_add_f16 v195, v195, 1.0 op_sel_hi:[1,0]
v_mfma_f32_16x16x32_bf16 v[180:183], v[236:239], v[36:39], v[180:183]
v_rcp_f16 v202, v201
s_waitcnt lgkmcnt(7)
v_mfma_f32_16x16x32_bf16 v[168:171], v[216:219], v[40:43], v[168:171]
ds_read_b128 v[236:239], v249 offset:37888
v_rcp_f16_e64 v199, v198
v_mfma_f32_16x16x32_bf16 v[176:179], v[216:219], v[44:47], v[176:179]
v_rcp_f16_e64 v196, v195
v_mfma_f32_16x16x32_bf16 v[172:175], v[220:223], v[40:43], v[172:175]
ds_read_b128 v[216:219], v248 offset:41216
v_rcp_f16_sdwa v202, v201 dst_sel:WORD_1 dst_unused:UNUSED_PRESERVE src0_sel:WORD_1
v_mfma_f32_16x16x32_bf16 v[180:183], v[220:223], v[44:47], v[180:183]
v_rcp_f16_sdwa v199, v198 dst_sel:WORD_1 dst_unused:UNUSED_PRESERVE src0_sel:WORD_1
v_or_b32 v208, v184, v185
v_or_b32 v209, v186, v187
s_waitcnt lgkmcnt(4)
v_or_b32 v210, v188, v189
v_rcp_f16_sdwa v196, v195 dst_sel:WORD_1 dst_unused:UNUSED_PRESERVE src0_sel:WORD_1
v_or_b32 v211, v190, v191
s_waitcnt lgkmcnt(2)
v_or_b32_e64 v212, v192, v193
v_pk_mul_f16 v213, v203, v202
v_pk_mul_f16 v214, v200, v199
v_pk_mul_f16 v215, v197, v196
v_mfma_f32_16x16x32_f16 v[120:123], v[224:227], v[208:211], v[120:123]
s_add_u32 s46, s80, 20971520
buffer_load_dwordx4 v[112:115], v253, s[32:35], s46 offen nt
ds_read_b128 v[220:223], v249 offset:38144
v_cvt_pkrtz_f16_f32 v185, v168, v169
v_cvt_pkrtz_f16_f32 v187, v170, v171
v_cvt_pkrtz_f16_f32 v189, v172, v173
v_mfma_f32_16x16x32_f16 v[128:131], v[224:227], v[212:215], v[128:131]
v_cvt_pkrtz_f16_f32 v191, v174, v175
v_cvt_pkrtz_f16_f32 v193, v176, v177
v_cvt_pk_f16_f32 v203, v178, v179
v_mfma_f32_16x16x32_f16 v[124:127], v[228:231], v[208:211], v[124:127]
ds_read_b128 v[224:227], v248 offset:41984
v_cvt_pk_f16_f32 v200, v180, v181
v_cvt_pk_f16_f32 v197, v182, v183
v_pk_fma_f16 v202, v203, v203, s48
s_setprio 1
v_cvt_pk_bf16_f32 v64, v64, v65
v_mfma_f32_16x16x32_f16 v[132:135], v[228:231], v[212:215], v[132:135]
v_and_b32 v185, s49, v185
v_cvt_pk_bf16_f32 v65, v66, v67
v_pk_fma_f16 v199, v200, v200, s48
v_mfma_f32_16x16x32_bf16 v[168:171], v[232:235], v[24:27], 0
ds_read_b128 v[228:231], v249 offset:38912
v_and_b32 v187, s49, v187
v_cvt_pk_bf16_f32 v66, v68, v69
v_pk_fma_f16 v196, v197, v197, s48
v_mfma_f32_16x16x32_bf16 v[176:179], v[232:235], v[28:31], 0
v_cvt_pk_bf16_f32 v67, v70, v71
v_bfe_u32 v184, v185, 2, 14
v_pk_mul_f16 v202, v203, v202
v_cvt_pk_bf16_f32 v48, v48, v49
s_waitcnt lgkmcnt(2)
v_mfma_f32_16x16x32_f16 v[136:139], v[236:239], v[208:211], v[136:139]
ds_read_b128 v[232:235], v249 offset:39168
ds_read_u16_d16 v184, v184
v_bfe_u32 v186, v187, 2, 14
v_cvt_pk_bf16_f32 v49, v50, v51
v_pk_mul_f16 v199, v200, v199
v_mfma_f32_16x16x32_f16 v[144:147], v[236:239], v[212:215], v[144:147]
v_lshrrev_b32_e64 v185, 18, v185
v_cvt_pk_bf16_f32 v50, v52, v53
v_pk_mul_f16 v196, v197, v196
v_mfma_f32_16x16x32_bf16 v[172:175], v[216:219], v[24:27], 0
ds_read_b128 v[236:239], v248 offset:42240
ds_read_u16_d16 v186, v186
ds_read_u16_d16_hi v185, v185
v_lshrrev_b32_e64 v187, 18, v187
v_cvt_pk_bf16_f32 v51, v54, v55
v_exp_f16_e64 v201, v202
v_mfma_f32_16x16x32_bf16 v[180:183], v[216:219], v[28:31], 0
v_cvt_pk_bf16_f32 v80, v80, v81
v_and_b32_e64 v189, s49, v189
v_cvt_pk_bf16_f32 v81, v82, v83
v_mfma_f32_16x16x32_f16 v[140:143], v[220:223], v[208:211], v[140:143]
ds_read_b128 v[216:219], v248 offset:43008
ds_read_u16_d16_hi v187, v187
v_and_b32_e64 v191, s49, v191
v_cvt_pk_bf16_f32 v82, v84, v85
v_mfma_f32_16x16x32_f16 v[148:151], v[220:223], v[212:215], v[148:151]
v_exp_f16_e64 v198, v199
v_cvt_pk_bf16_f32 v83, v86, v87
s_mov_b64 vcc, s[74:75]
v_bfe_u32 v188, v189, 2, 14
v_bfe_u32 v190, v191, 2, 14
s_waitcnt lgkmcnt(5)
v_mfma_f32_16x16x32_bf16 v[168:171], v[224:227], v[32:35], v[168:171]
ds_read_b128 v[220:223], v248 offset:43264
ds_read_u16_d16 v188, v188
ds_read_u16_d16 v190, v190
v_cndmask_b32 v68, v48, v80, vcc
v_exp_f16 v195, v196
v_mfma_f32_16x16x32_bf16 v[176:179], v[224:227], v[36:39], v[176:179]
v_cndmask_b32 v69, v49, v81, vcc
v_lshrrev_b32_e64 v189, 18, v189
v_cndmask_b32 v70, v50, v82, vcc
v_mfma_f32_16x16x32_f16 v[152:155], v[228:231], v[208:211], v[152:155]
ds_read_b128 v[224:227], v249 offset:43008
ds_read_u16_d16_hi v189, v189
v_lshrrev_b32 v191, 18, v191
v_cndmask_b32 v71, v51, v83, vcc
v_exp_f16_sdwa v201, v202 dst_sel:WORD_1 dst_unused:UNUSED_PRESERVE src0_sel:WORD_1
v_mfma_f32_16x16x32_f16 v[160:163], v[228:231], v[212:215], v[160:163]
v_cndmask_b32_dpp v48, v64, v48, vcc quad_perm:[1,0,3,2] row_mask:0xf bank_mask:0xf
v_and_b32_e64 v193, s49, v193
v_cndmask_b32_dpp v49, v65, v49, vcc quad_perm:[1,0,3,2] row_mask:0xf bank_mask:0xf
v_mfma_f32_16x16x32_f16 v[156:159], v[232:235], v[208:211], v[156:159]
ds_read_b128 v[228:231], v249 offset:43264
ds_read_u16_d16_hi v191, v191
v_bfe_u32 v192, v193, 2, 14
v_exp_f16_sdwa v198, v199 dst_sel:WORD_1 dst_unused:UNUSED_PRESERVE src0_sel:WORD_1
v_mfma_f32_16x16x32_f16 v[164:167], v[232:235], v[212:215], v[164:167]
v_cndmask_b32_dpp v50, v66, v50, vcc quad_perm:[1,0,3,2] row_mask:0xf bank_mask:0xf
v_lshrrev_b32 v193, 18, v193
v_cndmask_b32_dpp v51, v67, v51, vcc quad_perm:[1,0,3,2] row_mask:0xf bank_mask:0xf
s_not_b64 vcc, s[74:75]
s_waitcnt lgkmcnt(4)
v_mfma_f32_16x16x32_bf16 v[172:175], v[236:239], v[32:35], v[172:175]
ds_read_b128 v[232:235], v248 offset:47104
ds_read_u16_d16 v192, v192
ds_read_u16_d16_hi v193, v193
v_exp_f16_sdwa v195, v196 dst_sel:WORD_1 dst_unused:UNUSED_PRESERVE src0_sel:WORD_1
v_cndmask_b32_dpp v80, v64, v80, vcc quad_perm:[1,0,3,2] row_mask:0xf bank_mask:0xf
s_setprio 0
v_pk_add_f16 v201, v201, 1.0 op_sel_hi:[1,0]
v_mfma_f32_16x16x32_bf16 v[180:183], v[236:239], v[36:39], v[180:183]
v_cndmask_b32_dpp v81, v65, v81, vcc quad_perm:[1,0,3,2] row_mask:0xf bank_mask:0xf
v_pk_add_f16 v198, v198, 1.0 op_sel_hi:[1,0]
v_cndmask_b32_dpp v82, v66, v82, vcc quad_perm:[1,0,3,2] row_mask:0xf bank_mask:0xf
v_mfma_f32_16x16x32_bf16 v[168:171], v[216:219], v[40:43], v[168:171]
ds_read_b128 v[236:239], v249 offset:44032
v_pk_add_f16 v195, v195, 1.0 op_sel_hi:[1,0]
v_rcp_f16_e64 v202, v201
v_cndmask_b32_dpp v83, v67, v83, vcc quad_perm:[1,0,3,2] row_mask:0xf bank_mask:0xf
v_mfma_f32_16x16x32_bf16 v[176:179], v[216:219], v[44:47], v[176:179]
v_rcp_f16_e64 v199, v198
v_mfma_f32_16x16x32_bf16 v[172:175], v[220:223], v[40:43], v[172:175]
ds_read_b128 v[216:219], v248 offset:47360
buffer_store_dwordx4 v[48:51], v255, s[8:11], s70 offen sc1
v_rcp_f16_e64 v196, v195
v_rcp_f16_sdwa v202, v201 dst_sel:WORD_1 dst_unused:UNUSED_PRESERVE src0_sel:WORD_1
v_mfma_f32_16x16x32_bf16 v[180:183], v[220:223], v[44:47], v[180:183]
v_rcp_f16_sdwa v199, v198 dst_sel:WORD_1 dst_unused:UNUSED_PRESERVE src0_sel:WORD_1
v_or_b32 v208, v184, v185
v_or_b32 v209, v186, v187
s_waitcnt lgkmcnt(2)
v_or_b32 v210, v188, v189
v_rcp_f16_sdwa v196, v195 dst_sel:WORD_1 dst_unused:UNUSED_PRESERVE src0_sel:WORD_1
v_or_b32_e64 v211, v190, v191
v_or_b32 v212, v192, v193
v_pk_mul_f16 v213, v203, v202
v_pk_mul_f16 v214, v200, v199
v_pk_mul_f16 v215, v197, v196
s_setprio 3
v_mfma_f32_16x16x32_f16 v[120:123], v[224:227], v[208:211], v[120:123]
buffer_store_dwordx4 v[68:71], v255, s[8:11], s70 offen offset:128 sc1
ds_read_b128 v[220:223], v249 offset:44288
v_cvt_pkrtz_f16_f32 v185, v168, v169
v_cvt_pkrtz_f16_f32 v187, v170, v171
v_mfma_f32_16x16x32_f16 v[128:131], v[224:227], v[212:215], v[128:131]
v_cvt_pkrtz_f16_f32 v189, v172, v173
v_cvt_pkrtz_f16_f32 v191, v174, v175
v_mfma_f32_16x16x32_f16 v[124:127], v[228:231], v[208:211], v[124:127]
ds_read_b128 v[224:227], v248 offset:48128
v_cvt_pkrtz_f16_f32 v193, v176, v177
v_cvt_pk_f16_f32 v203, v178, v179
v_cvt_pk_f16_f32 v200, v180, v181
v_mfma_f32_16x16x32_f16 v[132:135], v[228:231], v[212:215], v[132:135]
v_cvt_pk_f16_f32 v197, v182, v183
v_pk_fma_f16 v202, v203, v203, s48
v_mfma_f32_16x16x32_bf16 v[168:171], v[232:235], v[24:27], 0
ds_read_b128 v[228:231], v249 offset:45056
v_and_b32_e64 v185, s49, v185
v_pk_fma_f16 v199, v200, v200, s48
v_mfma_f32_16x16x32_bf16 v[176:179], v[232:235], v[28:31], 0
v_and_b32 v187, s49, v187
v_pk_fma_f16 v196, v197, v197, s48
v_bfe_u32 v184, v185, 2, 14
s_waitcnt lgkmcnt(3)
v_mfma_f32_16x16x32_f16 v[136:139], v[236:239], v[208:211], v[136:139]
ds_read_b128 v[232:235], v249 offset:45312
ds_read_u16_d16 v184, v184
v_pk_mul_f16 v202, v203, v202
v_bfe_u32 v186, v187, 2, 14
v_mfma_f32_16x16x32_f16 v[144:147], v[236:239], v[212:215], v[144:147]
v_pk_mul_f16 v199, v200, v199
v_lshrrev_b32_e64 v185, 18, v185
v_mfma_f32_16x16x32_bf16 v[172:175], v[216:219], v[24:27], 0
ds_read_b128 v[236:239], v248 offset:48384
ds_read_u16_d16 v186, v186
ds_read_u16_d16_hi v185, v185
v_pk_mul_f16 v196, v197, v196
v_lshrrev_b32_e64 v187, 18, v187
v_mfma_f32_16x16x32_bf16 v[180:183], v[216:219], v[28:31], 0
v_exp_f16_e64 v201, v202
v_and_b32 v189, s49, v189
s_waitcnt lgkmcnt(5)
v_mfma_f32_16x16x32_f16 v[140:143], v[220:223], v[208:211], v[140:143]
ds_read_b128 v[216:219], v248 offset:49152
ds_read_u16_d16_hi v187, v187
v_and_b32_e64 v191, s49, v191
v_mfma_f32_16x16x32_f16 v[148:151], v[220:223], v[212:215], v[148:151]
v_exp_f16_e64 v198, v199
v_bfe_u32 v188, v189, 2, 14
v_bfe_u32 v190, v191, 2, 14
v_mfma_f32_16x16x32_bf16 v[168:171], v[224:227], v[32:35], v[168:171]
s_add_u32 s46, s80, 20971520
buffer_load_dwordx4 v[116:119], v253, s[32:35], s46 offen offset:256 nt
ds_read_b128 v[220:223], v248 offset:49408
ds_read_u16_d16 v188, v188
ds_read_u16_d16 v190, v190
v_exp_f16_e64 v195, v196
v_mfma_f32_16x16x32_bf16 v[176:179], v[224:227], v[36:39], v[176:179]
v_lshrrev_b32 v189, 18, v189
v_lshrrev_b32 v191, 18, v191
v_mfma_f32_16x16x32_f16 v[152:155], v[228:231], v[208:211], v[152:155]
ds_read_b128 v[224:227], v249 offset:49152
ds_read_u16_d16_hi v189, v189
ds_read_u16_d16_hi v191, v191
v_exp_f16_sdwa v201, v202 dst_sel:WORD_1 dst_unused:UNUSED_PRESERVE src0_sel:WORD_1
v_and_b32 v193, s49, v193
v_mfma_f32_16x16x32_f16 v[160:163], v[228:231], v[212:215], v[160:163]
v_bfe_u32 v192, v193, 2, 14
s_waitcnt lgkmcnt(7)
v_mfma_f32_16x16x32_f16 v[156:159], v[232:235], v[208:211], v[156:159]
ds_read_b128 v[228:231], v249 offset:49408
ds_read_u16_d16 v192, v192
v_exp_f16_sdwa v198, v199 dst_sel:WORD_1 dst_unused:UNUSED_PRESERVE src0_sel:WORD_1
v_lshrrev_b32_e64 v193, 18, v193
v_mfma_f32_16x16x32_f16 v[164:167], v[232:235], v[212:215], v[164:167]
v_exp_f16_sdwa v195, v196 dst_sel:WORD_1 dst_unused:UNUSED_PRESERVE src0_sel:WORD_1
v_pk_add_f16 v201, v201, 1.0 op_sel_hi:[1,0]
v_mfma_f32_16x16x32_bf16 v[172:175], v[236:239], v[32:35], v[172:175]
ds_read_b128 v[232:235], v248 offset:53248
ds_read_u16_d16_hi v193, v193
v_pk_add_f16 v198, v198, 1.0 op_sel_hi:[1,0]
v_pk_add_f16 v195, v195, 1.0 op_sel_hi:[1,0]
v_mfma_f32_16x16x32_bf16 v[180:183], v[236:239], v[36:39], v[180:183]
v_rcp_f16_e64 v202, v201
v_mfma_f32_16x16x32_bf16 v[168:171], v[216:219], v[40:43], v[168:171]
ds_read_b128 v[236:239], v249 offset:50176
v_rcp_f16_e64 v199, v198
v_mfma_f32_16x16x32_bf16 v[176:179], v[216:219], v[44:47], v[176:179]
v_rcp_f16 v196, v195
s_waitcnt lgkmcnt(5)
v_mfma_f32_16x16x32_bf16 v[172:175], v[220:223], v[40:43], v[172:175]
ds_read_b128 v[216:219], v248 offset:53504
v_rcp_f16_sdwa v202, v201 dst_sel:WORD_1 dst_unused:UNUSED_PRESERVE src0_sel:WORD_1
v_mfma_f32_16x16x32_bf16 v[180:183], v[220:223], v[44:47], v[180:183]
v_rcp_f16_sdwa v199, v198 dst_sel:WORD_1 dst_unused:UNUSED_PRESERVE src0_sel:WORD_1
v_or_b32 v208, v184, v185
v_or_b32 v209, v186, v187
v_or_b32_e64 v210, v188, v189
v_rcp_f16_sdwa v196, v195 dst_sel:WORD_1 dst_unused:UNUSED_PRESERVE src0_sel:WORD_1
v_or_b32 v211, v190, v191
s_waitcnt lgkmcnt(2)
v_or_b32_e64 v212, v192, v193
v_pk_mul_f16 v213, v203, v202
v_pk_mul_f16 v214, v200, v199
v_pk_mul_f16 v215, v197, v196
v_mfma_f32_16x16x32_f16 v[120:123], v[224:227], v[208:211], v[120:123]
ds_read_b128 v[220:223], v249 offset:50432
v_cvt_pkrtz_f16_f32 v185, v168, v169
v_cvt_pkrtz_f16_f32 v187, v170, v171
v_mfma_f32_16x16x32_f16 v[128:131], v[224:227], v[212:215], v[128:131]
v_cvt_pkrtz_f16_f32 v189, v172, v173
v_cvt_pkrtz_f16_f32 v191, v174, v175
v_mfma_f32_16x16x32_f16 v[124:127], v[228:231], v[208:211], v[124:127]
ds_read_b128 v[224:227], v248 offset:54272
v_cvt_pkrtz_f16_f32 v193, v176, v177
v_cvt_pk_f16_f32 v203, v178, v179
v_cvt_pk_f16_f32 v200, v180, v181
v_mfma_f32_16x16x32_f16 v[132:135], v[228:231], v[212:215], v[132:135]
v_cvt_pk_f16_f32 v197, v182, v183
v_pk_fma_f16 v202, v203, v203, s48
v_mfma_f32_16x16x32_bf16 v[168:171], v[232:235], v[24:27], 0
ds_read_b128 v[228:231], v249 offset:51200
v_and_b32_e64 v185, s49, v185
v_pk_fma_f16 v199, v200, v200, s48
v_mfma_f32_16x16x32_bf16 v[176:179], v[232:235], v[28:31], 0
v_and_b32_e64 v187, s49, v187
v_pk_fma_f16 v196, v197, v197, s48
s_setprio 2
v_bfe_u32 v184, v185, 2, 14
s_waitcnt lgkmcnt(3)
v_mfma_f32_16x16x32_f16 v[136:139], v[236:239], v[208:211], v[136:139]
ds_read_b128 v[232:235], v249 offset:51456
ds_read_u16_d16 v184, v184
v_pk_mul_f16 v202, v203, v202
v_bfe_u32 v186, v187, 2, 14
v_mfma_f32_16x16x32_f16 v[144:147], v[236:239], v[212:215], v[144:147]
v_pk_mul_f16 v199, v200, v199
v_lshrrev_b32_e64 v185, 18, v185
v_mfma_f32_16x16x32_bf16 v[172:175], v[216:219], v[24:27], 0
ds_read_b128 v[236:239], v248 offset:54528
ds_read_u16_d16 v186, v186
ds_read_u16_d16_hi v185, v185
v_pk_mul_f16 v196, v197, v196
v_lshrrev_b32_e64 v187, 18, v187
v_mfma_f32_16x16x32_bf16 v[180:183], v[216:219], v[28:31], 0
v_exp_f16_e64 v201, v202
v_and_b32 v189, s49, v189
s_waitcnt lgkmcnt(5)
v_mfma_f32_16x16x32_f16 v[140:143], v[220:223], v[208:211], v[140:143]
ds_read_b128 v[216:219], v248 offset:55296
ds_read_u16_d16_hi v187, v187
v_and_b32_e64 v191, s49, v191
v_mfma_f32_16x16x32_f16 v[148:151], v[220:223], v[212:215], v[148:151]
v_exp_f16_e64 v198, v199
v_bfe_u32 v188, v189, 2, 14
v_bfe_u32 v190, v191, 2, 14
v_mfma_f32_16x16x32_bf16 v[168:171], v[224:227], v[32:35], v[168:171]
ds_read_b128 v[220:223], v248 offset:55552
ds_read_u16_d16 v188, v188
ds_read_u16_d16 v190, v190
v_exp_f16_e64 v195, v196
v_mfma_f32_16x16x32_bf16 v[176:179], v[224:227], v[36:39], v[176:179]
v_lshrrev_b32 v189, 18, v189
v_lshrrev_b32 v191, 18, v191
v_mfma_f32_16x16x32_f16 v[152:155], v[228:231], v[208:211], v[152:155]
ds_read_b128 v[224:227], v249 offset:55296
ds_read_u16_d16_hi v189, v189
ds_read_u16_d16_hi v191, v191
v_exp_f16_sdwa v201, v202 dst_sel:WORD_1 dst_unused:UNUSED_PRESERVE src0_sel:WORD_1
v_and_b32 v193, s49, v193
v_mfma_f32_16x16x32_f16 v[160:163], v[228:231], v[212:215], v[160:163]
v_bfe_u32 v192, v193, 2, 14
s_waitcnt lgkmcnt(8)
v_mfma_f32_16x16x32_f16 v[156:159], v[232:235], v[208:211], v[156:159]
ds_read_b128 v[228:231], v249 offset:55552
ds_read_u16_d16 v192, v192
v_exp_f16_sdwa v198, v199 dst_sel:WORD_1 dst_unused:UNUSED_PRESERVE src0_sel:WORD_1
v_lshrrev_b32_e64 v193, 18, v193
v_mfma_f32_16x16x32_f16 v[164:167], v[232:235], v[212:215], v[164:167]
v_exp_f16_sdwa v195, v196 dst_sel:WORD_1 dst_unused:UNUSED_PRESERVE src0_sel:WORD_1
v_pk_add_f16 v201, v201, 1.0 op_sel_hi:[1,0]
v_mfma_f32_16x16x32_bf16 v[172:175], v[236:239], v[32:35], v[172:175]
ds_read_b128 v[232:235], v248 offset:59392
ds_read_u16_d16_hi v193, v193
v_pk_add_f16 v198, v198, 1.0 op_sel_hi:[1,0]
v_pk_add_f16 v195, v195, 1.0 op_sel_hi:[1,0]
v_mfma_f32_16x16x32_bf16 v[180:183], v[236:239], v[36:39], v[180:183]
v_rcp_f16 v202, v201
s_waitcnt lgkmcnt(7)
v_mfma_f32_16x16x32_bf16 v[168:171], v[216:219], v[40:43], v[168:171]
ds_read_b128 v[236:239], v249 offset:56320
v_rcp_f16_e64 v199, v198
v_mfma_f32_16x16x32_bf16 v[176:179], v[216:219], v[44:47], v[176:179]
v_rcp_f16_e64 v196, v195
v_mfma_f32_16x16x32_bf16 v[172:175], v[220:223], v[40:43], v[172:175]
ds_read_b128 v[216:219], v248 offset:59648
v_rcp_f16_sdwa v202, v201 dst_sel:WORD_1 dst_unused:UNUSED_PRESERVE src0_sel:WORD_1
v_mfma_f32_16x16x32_bf16 v[180:183], v[220:223], v[44:47], v[180:183]
v_rcp_f16_sdwa v199, v198 dst_sel:WORD_1 dst_unused:UNUSED_PRESERVE src0_sel:WORD_1
v_or_b32 v208, v184, v185
v_or_b32 v209, v186, v187
s_waitcnt lgkmcnt(4)
v_or_b32 v210, v188, v189
v_rcp_f16_sdwa v196, v195 dst_sel:WORD_1 dst_unused:UNUSED_PRESERVE src0_sel:WORD_1
v_or_b32 v211, v190, v191
s_waitcnt lgkmcnt(2)
v_or_b32_e64 v212, v192, v193
v_pk_mul_f16 v213, v203, v202
v_pk_mul_f16 v214, v200, v199
v_pk_mul_f16 v215, v197, v196
v_mfma_f32_16x16x32_f16 v[120:123], v[224:227], v[208:211], v[120:123]
buffer_load_dwordx4 v[204:207], v252, s[4:7], s68 offen
ds_read_b128 v[220:223], v249 offset:56576
v_cvt_pkrtz_f16_f32 v185, v168, v169
v_cvt_pkrtz_f16_f32 v187, v170, v171
v_mfma_f32_16x16x32_f16 v[128:131], v[224:227], v[212:215], v[128:131]
v_cvt_pkrtz_f16_f32 v189, v172, v173
v_cvt_pkrtz_f16_f32 v191, v174, v175
v_mfma_f32_16x16x32_f16 v[124:127], v[228:231], v[208:211], v[124:127]
ds_read_b128 v[224:227], v248 offset:60416
v_cvt_pkrtz_f16_f32 v193, v176, v177
v_cvt_pk_f16_f32 v203, v178, v179
v_cvt_pk_f16_f32 v200, v180, v181
v_mfma_f32_16x16x32_f16 v[132:135], v[228:231], v[212:215], v[132:135]
v_cvt_pk_f16_f32 v197, v182, v183
s_setprio 1
v_pk_fma_f16 v202, v203, v203, s48
v_mfma_f32_16x16x32_bf16 v[168:171], v[232:235], v[24:27], 0
ds_read_b128 v[228:231], v249 offset:57344
v_and_b32 v185, s49, v185
v_pk_fma_f16 v199, v200, v200, s48
v_mfma_f32_16x16x32_bf16 v[176:179], v[232:235], v[28:31], 0
v_and_b32 v187, s49, v187
v_pk_fma_f16 v196, v197, v197, s48
v_bfe_u32 v184, v185, 2, 14
s_waitcnt lgkmcnt(3)
v_mfma_f32_16x16x32_f16 v[136:139], v[236:239], v[208:211], v[136:139]
ds_read_b128 v[232:235], v249 offset:57600
ds_read_u16_d16 v184, v184
v_pk_mul_f16 v202, v203, v202
v_bfe_u32 v186, v187, 2, 14
v_mfma_f32_16x16x32_f16 v[144:147], v[236:239], v[212:215], v[144:147]
v_pk_mul_f16 v199, v200, v199
v_lshrrev_b32_e64 v185, 18, v185
v_mfma_f32_16x16x32_bf16 v[172:175], v[216:219], v[24:27], 0
ds_read_b128 v[236:239], v248 offset:60672
ds_read_u16_d16 v186, v186
ds_read_u16_d16_hi v185, v185
v_pk_mul_f16 v196, v197, v196
v_lshrrev_b32_e64 v187, 18, v187
v_mfma_f32_16x16x32_bf16 v[180:183], v[216:219], v[28:31], 0
v_exp_f16_e64 v201, v202
v_and_b32 v189, s49, v189
s_waitcnt lgkmcnt(5)
v_mfma_f32_16x16x32_f16 v[140:143], v[220:223], v[208:211], v[140:143]
ds_read_b128 v[216:219], v248 offset:61440
ds_read_u16_d16_hi v187, v187
v_and_b32_e64 v191, s49, v191
v_mfma_f32_16x16x32_f16 v[148:151], v[220:223], v[212:215], v[148:151]
v_exp_f16_e64 v198, v199
v_bfe_u32 v188, v189, 2, 14
v_bfe_u32 v190, v191, 2, 14
v_mfma_f32_16x16x32_bf16 v[168:171], v[224:227], v[32:35], v[168:171]
buffer_store_dwordx4 v[80:83], v255, s[8:11], s70 offen offset:256 sc1
ds_read_b128 v[220:223], v248 offset:61696
ds_read_u16_d16 v188, v188
ds_read_u16_d16 v190, v190
v_exp_f16_e64 v195, v196
v_mfma_f32_16x16x32_bf16 v[176:179], v[224:227], v[36:39], v[176:179]
v_lshrrev_b32 v189, 18, v189
v_lshrrev_b32 v191, 18, v191
v_mfma_f32_16x16x32_f16 v[152:155], v[228:231], v[208:211], v[152:155]
ds_read_b128 v[224:227], v249 offset:61440
ds_read_u16_d16_hi v189, v189
ds_read_u16_d16_hi v191, v191
v_exp_f16_sdwa v201, v202 dst_sel:WORD_1 dst_unused:UNUSED_PRESERVE src0_sel:WORD_1
v_and_b32 v193, s49, v193
v_mfma_f32_16x16x32_f16 v[160:163], v[228:231], v[212:215], v[160:163]
v_bfe_u32 v192, v193, 2, 14
s_waitcnt lgkmcnt(8)
v_mfma_f32_16x16x32_f16 v[156:159], v[232:235], v[208:211], v[156:159]
ds_read_b128 v[228:231], v249 offset:61696
ds_read_u16_d16 v192, v192
v_exp_f16_sdwa v198, v199 dst_sel:WORD_1 dst_unused:UNUSED_PRESERVE src0_sel:WORD_1
v_lshrrev_b32_e64 v193, 18, v193
v_mfma_f32_16x16x32_f16 v[164:167], v[232:235], v[212:215], v[164:167]
v_exp_f16_sdwa v195, v196 dst_sel:WORD_1 dst_unused:UNUSED_PRESERVE src0_sel:WORD_1
v_pk_add_f16 v201, v201, 1.0 op_sel_hi:[1,0]
v_mfma_f32_16x16x32_bf16 v[172:175], v[236:239], v[32:35], v[172:175]
ds_read_b128 v[232:235], v249
ds_read_u16_d16_hi v193, v193
v_pk_add_f16 v198, v198, 1.0 op_sel_hi:[1,0]
v_pk_add_f16 v195, v195, 1.0 op_sel_hi:[1,0]
v_mfma_f32_16x16x32_bf16 v[180:183], v[236:239], v[36:39], v[180:183]
v_rcp_f16_e64 v202, v201
s_setprio 0
s_waitcnt lgkmcnt(7)
v_mfma_f32_16x16x32_bf16 v[168:171], v[216:219], v[40:43], v[168:171]
ds_read_b128 v[236:239], v249 offset:62464
v_rcp_f16_e64 v199, v198
v_mfma_f32_16x16x32_bf16 v[176:179], v[216:219], v[44:47], v[176:179]
v_rcp_f16_e64 v196, v195
v_mfma_f32_16x16x32_bf16 v[172:175], v[220:223], v[40:43], v[172:175]
ds_read_b128 v[216:219], v249 offset:256
v_rcp_f16_sdwa v202, v201 dst_sel:WORD_1 dst_unused:UNUSED_PRESERVE src0_sel:WORD_1
v_mfma_f32_16x16x32_bf16 v[180:183], v[220:223], v[44:47], v[180:183]
v_rcp_f16_sdwa v199, v198 dst_sel:WORD_1 dst_unused:UNUSED_PRESERVE src0_sel:WORD_1
v_or_b32 v208, v184, v185
v_or_b32 v209, v186, v187
s_waitcnt lgkmcnt(4)
v_or_b32 v210, v188, v189
v_rcp_f16_sdwa v196, v195 dst_sel:WORD_1 dst_unused:UNUSED_PRESERVE src0_sel:WORD_1
v_or_b32 v211, v190, v191
s_waitcnt lgkmcnt(2)
v_or_b32 v212, v192, v193
v_pk_mul_f16 v213, v203, v202
v_pk_mul_f16 v214, v200, v199
v_pk_mul_f16 v215, v197, v196
s_setprio 3
v_mfma_f32_16x16x32_f16 v[120:123], v[224:227], v[208:211], v[120:123]
buffer_load_dwordx4 v[244:247], v252, s[4:7], s68 offen offset:64
ds_read_b128 v[220:223], v249 offset:62720
v_cvt_pkrtz_f16_f32 v185, v168, v169
v_cvt_pkrtz_f16_f32 v187, v170, v171
v_mfma_f32_16x16x32_f16 v[128:131], v[224:227], v[212:215], v[128:131]
v_cvt_pkrtz_f16_f32 v189, v172, v173
v_cvt_pkrtz_f16_f32 v191, v174, v175
v_mfma_f32_16x16x32_f16 v[124:127], v[228:231], v[208:211], v[124:127]
ds_read_b128 v[224:227], v249 offset:1024
v_cvt_pkrtz_f16_f32 v193, v176, v177
v_cvt_pk_f16_f32 v203, v178, v179
v_cvt_pk_f16_f32 v200, v180, v181
v_mfma_f32_16x16x32_f16 v[132:135], v[228:231], v[212:215], v[132:135]
v_cvt_pk_f16_f32 v197, v182, v183
v_pk_fma_f16 v202, v203, v203, s48
v_mfma_f32_16x16x32_bf16 v[168:171], v[232:235], v[24:27], 0
ds_read_b128 v[228:231], v249 offset:63488
v_and_b32_e64 v185, s49, v185
v_pk_fma_f16 v199, v200, v200, s48
v_mfma_f32_16x16x32_bf16 v[176:179], v[232:235], v[28:31], 0
v_and_b32 v187, s49, v187
v_pk_fma_f16 v196, v197, v197, s48
v_bfe_u32 v184, v185, 2, 14
s_waitcnt lgkmcnt(3)
v_mfma_f32_16x16x32_f16 v[136:139], v[236:239], v[208:211], v[136:139]
ds_read_b128 v[232:235], v249 offset:63744
ds_read_u16_d16 v184, v184
v_pk_mul_f16 v202, v203, v202
v_bfe_u32 v186, v187, 2, 14
v_mfma_f32_16x16x32_f16 v[144:147], v[236:239], v[212:215], v[144:147]
v_pk_mul_f16 v199, v200, v199
v_lshrrev_b32_e64 v185, 18, v185
v_mfma_f32_16x16x32_bf16 v[172:175], v[216:219], v[24:27], 0
ds_read_b128 v[236:239], v249 offset:1280
ds_read_u16_d16 v186, v186
ds_read_u16_d16_hi v185, v185
v_pk_mul_f16 v196, v197, v196
v_lshrrev_b32_e64 v187, 18, v187
v_mfma_f32_16x16x32_bf16 v[180:183], v[216:219], v[28:31], 0
v_exp_f16_e64 v201, v202
v_and_b32 v189, s49, v189
s_waitcnt lgkmcnt(5)
v_mfma_f32_16x16x32_f16 v[140:143], v[220:223], v[208:211], v[140:143]
ds_read_b128 v[216:219], v249 offset:2048
ds_read_u16_d16_hi v187, v187
v_and_b32_e64 v191, s49, v191
v_mfma_f32_16x16x32_f16 v[148:151], v[220:223], v[212:215], v[148:151]
v_exp_f16_e64 v198, v199
v_bfe_u32 v188, v189, 2, 14
v_bfe_u32 v190, v191, 2, 14
v_mfma_f32_16x16x32_bf16 v[168:171], v[224:227], v[32:35], v[168:171]
ds_read_b128 v[220:223], v249 offset:2304
ds_read_u16_d16 v188, v188
ds_read_u16_d16 v190, v190
v_exp_f16_e64 v195, v196
v_mfma_f32_16x16x32_bf16 v[176:179], v[224:227], v[36:39], v[176:179]
v_lshrrev_b32 v189, 18, v189
v_lshrrev_b32 v191, 18, v191
v_mfma_f32_16x16x32_f16 v[152:155], v[228:231], v[208:211], v[152:155]
ds_read_b128 v[224:227], v250 offset:2048
ds_read_u16_d16_hi v189, v189
ds_read_u16_d16_hi v191, v191
v_exp_f16_sdwa v201, v202 dst_sel:WORD_1 dst_unused:UNUSED_PRESERVE src0_sel:WORD_1
v_and_b32 v193, s49, v193
v_mfma_f32_16x16x32_f16 v[160:163], v[228:231], v[212:215], v[160:163]
v_bfe_u32 v192, v193, 2, 14
s_waitcnt lgkmcnt(8)
v_mfma_f32_16x16x32_f16 v[156:159], v[232:235], v[208:211], v[156:159]
ds_read_b128 v[228:231], v250 offset:2304
ds_read_u16_d16 v192, v192
v_exp_f16_sdwa v198, v199 dst_sel:WORD_1 dst_unused:UNUSED_PRESERVE src0_sel:WORD_1
v_lshrrev_b32_e64 v193, 18, v193
v_mfma_f32_16x16x32_f16 v[164:167], v[232:235], v[212:215], v[164:167]
v_exp_f16_sdwa v195, v196 dst_sel:WORD_1 dst_unused:UNUSED_PRESERVE src0_sel:WORD_1
v_pk_add_f16 v201, v201, 1.0 op_sel_hi:[1,0]
v_mfma_f32_16x16x32_bf16 v[172:175], v[236:239], v[32:35], v[172:175]
ds_read_b128 v[232:235], v249 offset:6144
ds_read_u16_d16_hi v193, v193
v_pk_add_f16 v198, v198, 1.0 op_sel_hi:[1,0]
v_pk_add_f16 v195, v195, 1.0 op_sel_hi:[1,0]
v_mfma_f32_16x16x32_bf16 v[180:183], v[236:239], v[36:39], v[180:183]
v_rcp_f16 v202, v201
s_waitcnt lgkmcnt(7)
v_mfma_f32_16x16x32_bf16 v[168:171], v[216:219], v[40:43], v[168:171]
ds_read_b128 v[236:239], v250 offset:3072
v_rcp_f16_e64 v199, v198
v_mfma_f32_16x16x32_bf16 v[176:179], v[216:219], v[44:47], v[176:179]
v_rcp_f16_e64 v196, v195
v_mfma_f32_16x16x32_bf16 v[172:175], v[220:223], v[40:43], v[172:175]
ds_read_b128 v[216:219], v249 offset:6400
v_rcp_f16_sdwa v202, v201 dst_sel:WORD_1 dst_unused:UNUSED_PRESERVE src0_sel:WORD_1
v_mfma_f32_16x16x32_bf16 v[180:183], v[220:223], v[44:47], v[180:183]
v_rcp_f16_sdwa v199, v198 dst_sel:WORD_1 dst_unused:UNUSED_PRESERVE src0_sel:WORD_1
v_or_b32 v208, v184, v185
v_or_b32 v209, v186, v187
s_waitcnt lgkmcnt(4)
v_or_b32 v210, v188, v189
v_rcp_f16_sdwa v196, v195 dst_sel:WORD_1 dst_unused:UNUSED_PRESERVE src0_sel:WORD_1
v_or_b32 v211, v190, v191
s_waitcnt lgkmcnt(2)
v_or_b32_e64 v212, v192, v193
v_pk_mul_f16 v213, v203, v202
v_pk_mul_f16 v214, v200, v199
v_pk_mul_f16 v215, v197, v196
v_mfma_f32_16x16x32_f16 v[120:123], v[224:227], v[208:211], v[120:123]
ds_read_b128 v[220:223], v250 offset:3328
v_cvt_pkrtz_f16_f32 v185, v168, v169
v_cvt_pkrtz_f16_f32 v187, v170, v171
v_cvt_pkrtz_f16_f32 v189, v172, v173
v_mfma_f32_16x16x32_f16 v[128:131], v[224:227], v[212:215], v[128:131]
v_cvt_pkrtz_f16_f32 v191, v174, v175
v_cvt_pkrtz_f16_f32 v193, v176, v177
v_cvt_pk_f16_f32 v203, v178, v179
v_mfma_f32_16x16x32_f16 v[124:127], v[228:231], v[208:211], v[124:127]
ds_read_b128 v[224:227], v249 offset:7168
v_cvt_pk_f16_f32 v200, v180, v181
v_cvt_pk_f16_f32 v197, v182, v183
v_pk_fma_f16 v202, v203, v203, s48
v_cvt_pk_bf16_f32 v72, v72, v73
v_mfma_f32_16x16x32_f16 v[132:135], v[228:231], v[212:215], v[132:135]
v_and_b32_e64 v185, s49, v185
v_cvt_pk_bf16_f32 v73, v74, v75
v_pk_fma_f16 v199, v200, v200, s48
v_mfma_f32_16x16x32_bf16 v[168:171], v[232:235], v[24:27], 0
ds_read_b128 v[228:231], v250 offset:4096
v_and_b32_e64 v187, s49, v187
v_cvt_pk_bf16_f32 v74, v76, v77
v_pk_fma_f16 v196, v197, v197, s48
v_mfma_f32_16x16x32_bf16 v[176:179], v[232:235], v[28:31], 0
v_cvt_pk_bf16_f32 v75, v78, v79
v_bfe_u32 v184, v185, 2, 14
s_setprio 2
v_pk_mul_f16 v202, v203, v202
v_cvt_pk_bf16_f32 v56, v56, v57
s_waitcnt lgkmcnt(2)
v_mfma_f32_16x16x32_f16 v[136:139], v[236:239], v[208:211], v[136:139]
ds_read_b128 v[232:235], v250 offset:4352
ds_read_u16_d16 v184, v184
v_bfe_u32 v186, v187, 2, 14
v_cvt_pk_bf16_f32 v57, v58, v59
v_pk_mul_f16 v199, v200, v199
v_mfma_f32_16x16x32_f16 v[144:147], v[236:239], v[212:215], v[144:147]
v_lshrrev_b32_e64 v185, 18, v185
v_cvt_pk_bf16_f32 v58, v60, v61
v_pk_mul_f16 v196, v197, v196
v_mfma_f32_16x16x32_bf16 v[172:175], v[216:219], v[24:27], 0
ds_read_b128 v[236:239], v249 offset:7424
ds_read_u16_d16 v186, v186
ds_read_u16_d16_hi v185, v185
v_lshrrev_b32_e64 v187, 18, v187
v_cvt_pk_bf16_f32 v59, v62, v63
v_exp_f16_e64 v201, v202
v_mfma_f32_16x16x32_bf16 v[180:183], v[216:219], v[28:31], 0
v_cvt_pk_bf16_f32 v88, v88, v89
v_and_b32_e64 v189, s49, v189
v_cvt_pk_bf16_f32 v89, v90, v91
v_mfma_f32_16x16x32_f16 v[140:143], v[220:223], v[208:211], v[140:143]
ds_read_b128 v[216:219], v249 offset:8192
ds_read_u16_d16_hi v187, v187
v_and_b32_e64 v191, s49, v191
v_cvt_pk_bf16_f32 v90, v92, v93
v_mfma_f32_16x16x32_f16 v[148:151], v[220:223], v[212:215], v[148:151]
v_exp_f16_e64 v198, v199
v_cvt_pk_bf16_f32 v91, v94, v95
s_mov_b64 vcc, s[74:75]
v_bfe_u32 v188, v189, 2, 14
v_bfe_u32 v190, v191, 2, 14
s_waitcnt lgkmcnt(5)
v_mfma_f32_16x16x32_bf16 v[168:171], v[224:227], v[32:35], v[168:171]
ds_read_b128 v[220:223], v249 offset:8448
ds_read_u16_d16 v188, v188
ds_read_u16_d16 v190, v190
v_cndmask_b32 v76, v56, v88, vcc
v_exp_f16 v195, v196
v_mfma_f32_16x16x32_bf16 v[176:179], v[224:227], v[36:39], v[176:179]
v_cndmask_b32 v77, v57, v89, vcc
v_lshrrev_b32_e64 v189, 18, v189
v_cndmask_b32 v78, v58, v90, vcc
v_mfma_f32_16x16x32_f16 v[152:155], v[228:231], v[208:211], v[152:155]
ds_read_b128 v[224:227], v250 offset:8192
ds_read_u16_d16_hi v189, v189
v_lshrrev_b32 v191, 18, v191
v_cndmask_b32 v79, v59, v91, vcc
v_exp_f16_sdwa v201, v202 dst_sel:WORD_1 dst_unused:UNUSED_PRESERVE src0_sel:WORD_1
v_mfma_f32_16x16x32_f16 v[160:163], v[228:231], v[212:215], v[160:163]
v_cndmask_b32_dpp v56, v72, v56, vcc quad_perm:[1,0,3,2] row_mask:0xf bank_mask:0xf
v_and_b32_e64 v193, s49, v193
v_cndmask_b32_dpp v57, v73, v57, vcc quad_perm:[1,0,3,2] row_mask:0xf bank_mask:0xf
v_mfma_f32_16x16x32_f16 v[156:159], v[232:235], v[208:211], v[156:159]
ds_read_b128 v[228:231], v250 offset:8448
ds_read_u16_d16_hi v191, v191
v_bfe_u32 v192, v193, 2, 14
v_exp_f16_sdwa v198, v199 dst_sel:WORD_1 dst_unused:UNUSED_PRESERVE src0_sel:WORD_1
v_mfma_f32_16x16x32_f16 v[164:167], v[232:235], v[212:215], v[164:167]
v_cndmask_b32_dpp v58, v74, v58, vcc quad_perm:[1,0,3,2] row_mask:0xf bank_mask:0xf
v_lshrrev_b32_e64 v193, 18, v193
v_cndmask_b32_dpp v59, v75, v59, vcc quad_perm:[1,0,3,2] row_mask:0xf bank_mask:0xf
s_not_b64 vcc, s[74:75]
s_waitcnt lgkmcnt(4)
v_mfma_f32_16x16x32_bf16 v[172:175], v[236:239], v[32:35], v[172:175]
ds_read_b128 v[232:235], v249 offset:12288
ds_read_u16_d16 v192, v192
ds_read_u16_d16_hi v193, v193
v_exp_f16_sdwa v195, v196 dst_sel:WORD_1 dst_unused:UNUSED_PRESERVE src0_sel:WORD_1
v_cndmask_b32_dpp v88, v72, v88, vcc quad_perm:[1,0,3,2] row_mask:0xf bank_mask:0xf
v_pk_add_f16 v201, v201, 1.0 op_sel_hi:[1,0]
v_mfma_f32_16x16x32_bf16 v[180:183], v[236:239], v[36:39], v[180:183]
v_cndmask_b32_dpp v89, v73, v89, vcc quad_perm:[1,0,3,2] row_mask:0xf bank_mask:0xf
v_pk_add_f16 v198, v198, 1.0 op_sel_hi:[1,0]
v_cndmask_b32_dpp v90, v74, v90, vcc quad_perm:[1,0,3,2] row_mask:0xf bank_mask:0xf
v_mfma_f32_16x16x32_bf16 v[168:171], v[216:219], v[40:43], v[168:171]
ds_read_b128 v[236:239], v250 offset:9216
v_pk_add_f16 v195, v195, 1.0 op_sel_hi:[1,0]
v_rcp_f16_e64 v202, v201
v_cndmask_b32_dpp v91, v75, v91, vcc quad_perm:[1,0,3,2] row_mask:0xf bank_mask:0xf
v_mfma_f32_16x16x32_bf16 v[176:179], v[216:219], v[44:47], v[176:179]
v_rcp_f16_e64 v199, v198
v_mfma_f32_16x16x32_bf16 v[172:175], v[220:223], v[40:43], v[172:175]
ds_read_b128 v[216:219], v249 offset:12544
s_add_u32 s46, s70, 98304
buffer_store_dwordx4 v[56:59], v255, s[8:11], s46 offen sc1
v_rcp_f16_e64 v196, v195
v_rcp_f16_sdwa v202, v201 dst_sel:WORD_1 dst_unused:UNUSED_PRESERVE src0_sel:WORD_1
v_mfma_f32_16x16x32_bf16 v[180:183], v[220:223], v[44:47], v[180:183]
v_rcp_f16_sdwa v199, v198 dst_sel:WORD_1 dst_unused:UNUSED_PRESERVE src0_sel:WORD_1
v_or_b32 v208, v184, v185
v_or_b32 v209, v186, v187
s_waitcnt lgkmcnt(2)
v_or_b32 v210, v188, v189
v_rcp_f16_sdwa v196, v195 dst_sel:WORD_1 dst_unused:UNUSED_PRESERVE src0_sel:WORD_1
v_or_b32 v211, v190, v191
v_or_b32 v212, v192, v193
v_pk_mul_f16 v213, v203, v202
v_pk_mul_f16 v214, v200, v199
v_pk_mul_f16 v215, v197, v196
v_mfma_f32_16x16x32_f16 v[120:123], v[224:227], v[208:211], v[120:123]
buffer_load_dwordx4 v[0:3], v252, s[4:7], s68 offen offset:128
ds_read_b128 v[220:223], v250 offset:9472
v_cvt_pkrtz_f16_f32 v185, v168, v169
v_cvt_pkrtz_f16_f32 v187, v170, v171
v_mfma_f32_16x16x32_f16 v[128:131], v[224:227], v[212:215], v[128:131]
v_cvt_pkrtz_f16_f32 v189, v172, v173
v_cvt_pkrtz_f16_f32 v191, v174, v175
v_mfma_f32_16x16x32_f16 v[124:127], v[228:231], v[208:211], v[124:127]
ds_read_b128 v[224:227], v249 offset:13312
v_cvt_pkrtz_f16_f32 v193, v176, v177
v_cvt_pk_f16_f32 v203, v178, v179
v_cvt_pk_f16_f32 v200, v180, v181
v_mfma_f32_16x16x32_f16 v[132:135], v[228:231], v[212:215], v[132:135]
v_cvt_pk_f16_f32 v197, v182, v183
s_setprio 1
v_pk_fma_f16 v202, v203, v203, s48
v_mfma_f32_16x16x32_bf16 v[168:171], v[232:235], v[24:27], 0
ds_read_b128 v[228:231], v250 offset:10240
v_and_b32 v185, s49, v185
v_pk_fma_f16 v199, v200, v200, s48
v_mfma_f32_16x16x32_bf16 v[176:179], v[232:235], v[28:31], 0
v_and_b32 v187, s49, v187
v_pk_fma_f16 v196, v197, v197, s48
v_bfe_u32 v184, v185, 2, 14
s_waitcnt lgkmcnt(3)
v_mfma_f32_16x16x32_f16 v[136:139], v[236:239], v[208:211], v[136:139]
ds_read_b128 v[232:235], v250 offset:10496
ds_read_u16_d16 v184, v184
v_pk_mul_f16 v202, v203, v202
v_bfe_u32 v186, v187, 2, 14
v_mfma_f32_16x16x32_f16 v[144:147], v[236:239], v[212:215], v[144:147]
v_pk_mul_f16 v199, v200, v199
v_lshrrev_b32_e64 v185, 18, v185
v_mfma_f32_16x16x32_bf16 v[172:175], v[216:219], v[24:27], 0
ds_read_b128 v[236:239], v249 offset:13568
ds_read_u16_d16 v186, v186
ds_read_u16_d16_hi v185, v185
v_pk_mul_f16 v196, v197, v196
v_lshrrev_b32_e64 v187, 18, v187
v_mfma_f32_16x16x32_bf16 v[180:183], v[216:219], v[28:31], 0
v_exp_f16_e64 v201, v202
v_and_b32 v189, s49, v189
s_waitcnt lgkmcnt(5)
v_mfma_f32_16x16x32_f16 v[140:143], v[220:223], v[208:211], v[140:143]
ds_read_b128 v[216:219], v249 offset:14336
ds_read_u16_d16_hi v187, v187
v_and_b32_e64 v191, s49, v191
v_mfma_f32_16x16x32_f16 v[148:151], v[220:223], v[212:215], v[148:151]
v_exp_f16_e64 v198, v199
v_bfe_u32 v188, v189, 2, 14
v_bfe_u32 v190, v191, 2, 14
v_mfma_f32_16x16x32_bf16 v[168:171], v[224:227], v[32:35], v[168:171]
ds_read_b128 v[220:223], v249 offset:14592
ds_read_u16_d16 v188, v188
ds_read_u16_d16 v190, v190
v_exp_f16_e64 v195, v196
v_mfma_f32_16x16x32_bf16 v[176:179], v[224:227], v[36:39], v[176:179]
v_lshrrev_b32 v189, 18, v189
v_lshrrev_b32 v191, 18, v191
v_mfma_f32_16x16x32_f16 v[152:155], v[228:231], v[208:211], v[152:155]
ds_read_b128 v[224:227], v250 offset:14336
ds_read_u16_d16_hi v189, v189
ds_read_u16_d16_hi v191, v191
v_exp_f16_sdwa v201, v202 dst_sel:WORD_1 dst_unused:UNUSED_PRESERVE src0_sel:WORD_1
v_and_b32 v193, s49, v193
v_mfma_f32_16x16x32_f16 v[160:163], v[228:231], v[212:215], v[160:163]
v_bfe_u32 v192, v193, 2, 14
s_waitcnt lgkmcnt(8)
v_mfma_f32_16x16x32_f16 v[156:159], v[232:235], v[208:211], v[156:159]
ds_read_b128 v[228:231], v250 offset:14592
ds_read_u16_d16 v192, v192
v_exp_f16_sdwa v198, v199 dst_sel:WORD_1 dst_unused:UNUSED_PRESERVE src0_sel:WORD_1
v_lshrrev_b32_e64 v193, 18, v193
v_mfma_f32_16x16x32_f16 v[164:167], v[232:235], v[212:215], v[164:167]
v_exp_f16_sdwa v195, v196 dst_sel:WORD_1 dst_unused:UNUSED_PRESERVE src0_sel:WORD_1
v_pk_add_f16 v201, v201, 1.0 op_sel_hi:[1,0]
v_mfma_f32_16x16x32_bf16 v[172:175], v[236:239], v[32:35], v[172:175]
ds_read_b128 v[232:235], v249 offset:18432
ds_read_u16_d16_hi v193, v193
v_pk_add_f16 v198, v198, 1.0 op_sel_hi:[1,0]
v_pk_add_f16 v195, v195, 1.0 op_sel_hi:[1,0]
v_mfma_f32_16x16x32_bf16 v[180:183], v[236:239], v[36:39], v[180:183]
v_rcp_f16_e64 v202, v201
s_setprio 0
s_waitcnt lgkmcnt(7)
v_mfma_f32_16x16x32_bf16 v[168:171], v[216:219], v[40:43], v[168:171]
ds_read_b128 v[236:239], v250 offset:15360
v_rcp_f16_e64 v199, v198
v_mfma_f32_16x16x32_bf16 v[176:179], v[216:219], v[44:47], v[176:179]
v_rcp_f16_e64 v196, v195
v_mfma_f32_16x16x32_bf16 v[172:175], v[220:223], v[40:43], v[172:175]
ds_read_b128 v[216:219], v249 offset:18688
v_rcp_f16_sdwa v202, v201 dst_sel:WORD_1 dst_unused:UNUSED_PRESERVE src0_sel:WORD_1
v_mfma_f32_16x16x32_bf16 v[180:183], v[220:223], v[44:47], v[180:183]
v_rcp_f16_sdwa v199, v198 dst_sel:WORD_1 dst_unused:UNUSED_PRESERVE src0_sel:WORD_1
v_or_b32 v208, v184, v185
v_or_b32 v209, v186, v187
s_waitcnt lgkmcnt(4)
v_or_b32 v210, v188, v189
v_rcp_f16_sdwa v196, v195 dst_sel:WORD_1 dst_unused:UNUSED_PRESERVE src0_sel:WORD_1
v_or_b32 v211, v190, v191
s_waitcnt lgkmcnt(2)
v_or_b32 v212, v192, v193
v_pk_mul_f16 v213, v203, v202
v_pk_mul_f16 v214, v200, v199
v_pk_mul_f16 v215, v197, v196
s_setprio 3
v_mfma_f32_16x16x32_f16 v[120:123], v[224:227], v[208:211], v[120:123]
s_add_u32 s46, s68, 98304
buffer_load_dwordx4 v[4:7], v252, s[4:7], s46 offen
ds_read_b128 v[220:223], v250 offset:15616
v_cvt_pkrtz_f16_f32 v185, v168, v169
v_cvt_pkrtz_f16_f32 v187, v170, v171
v_mfma_f32_16x16x32_f16 v[128:131], v[224:227], v[212:215], v[128:131]
v_cvt_pkrtz_f16_f32 v189, v172, v173
v_cvt_pkrtz_f16_f32 v191, v174, v175
v_mfma_f32_16x16x32_f16 v[124:127], v[228:231], v[208:211], v[124:127]
ds_read_b128 v[224:227], v249 offset:19456
v_cvt_pkrtz_f16_f32 v193, v176, v177
v_cvt_pk_f16_f32 v203, v178, v179
v_cvt_pk_f16_f32 v200, v180, v181
v_mfma_f32_16x16x32_f16 v[132:135], v[228:231], v[212:215], v[132:135]
v_cvt_pk_f16_f32 v197, v182, v183
v_pk_fma_f16 v202, v203, v203, s48
v_mfma_f32_16x16x32_bf16 v[168:171], v[232:235], v[24:27], 0
ds_read_b128 v[228:231], v250 offset:16384
v_and_b32_e64 v185, s49, v185
v_pk_fma_f16 v199, v200, v200, s48
v_mfma_f32_16x16x32_bf16 v[176:179], v[232:235], v[28:31], 0
v_and_b32 v187, s49, v187
v_pk_fma_f16 v196, v197, v197, s48
v_bfe_u32 v184, v185, 2, 14
s_waitcnt lgkmcnt(3)
v_mfma_f32_16x16x32_f16 v[136:139], v[236:239], v[208:211], v[136:139]
ds_read_b128 v[232:235], v250 offset:16640
ds_read_u16_d16 v184, v184
v_pk_mul_f16 v202, v203, v202
v_bfe_u32 v186, v187, 2, 14
v_mfma_f32_16x16x32_f16 v[144:147], v[236:239], v[212:215], v[144:147]
v_pk_mul_f16 v199, v200, v199
v_lshrrev_b32_e64 v185, 18, v185
v_mfma_f32_16x16x32_bf16 v[172:175], v[216:219], v[24:27], 0
ds_read_b128 v[236:239], v249 offset:19712
ds_read_u16_d16 v186, v186
ds_read_u16_d16_hi v185, v185
v_pk_mul_f16 v196, v197, v196
v_lshrrev_b32_e64 v187, 18, v187
v_mfma_f32_16x16x32_bf16 v[180:183], v[216:219], v[28:31], 0
v_exp_f16_e64 v201, v202
v_and_b32 v189, s49, v189
s_waitcnt lgkmcnt(5)
v_mfma_f32_16x16x32_f16 v[140:143], v[220:223], v[208:211], v[140:143]
ds_read_b128 v[216:219], v249 offset:20480
ds_read_u16_d16_hi v187, v187
v_and_b32_e64 v191, s49, v191
v_mfma_f32_16x16x32_f16 v[148:151], v[220:223], v[212:215], v[148:151]
v_exp_f16_e64 v198, v199
v_bfe_u32 v188, v189, 2, 14
v_bfe_u32 v190, v191, 2, 14
v_mfma_f32_16x16x32_bf16 v[168:171], v[224:227], v[32:35], v[168:171]
s_add_u32 s46, s70, 98304
buffer_store_dwordx4 v[76:79], v255, s[8:11], s46 offen offset:128 sc1
ds_read_b128 v[220:223], v249 offset:20736
ds_read_u16_d16 v188, v188
ds_read_u16_d16 v190, v190
v_exp_f16_e64 v195, v196
v_mfma_f32_16x16x32_bf16 v[176:179], v[224:227], v[36:39], v[176:179]
v_lshrrev_b32 v189, 18, v189
v_lshrrev_b32 v191, 18, v191
v_mfma_f32_16x16x32_f16 v[152:155], v[228:231], v[208:211], v[152:155]
ds_read_b128 v[224:227], v250 offset:20480
ds_read_u16_d16_hi v189, v189
ds_read_u16_d16_hi v191, v191
v_exp_f16_sdwa v201, v202 dst_sel:WORD_1 dst_unused:UNUSED_PRESERVE src0_sel:WORD_1
v_and_b32 v193, s49, v193
v_mfma_f32_16x16x32_f16 v[160:163], v[228:231], v[212:215], v[160:163]
v_bfe_u32 v192, v193, 2, 14
s_waitcnt lgkmcnt(7)
v_mfma_f32_16x16x32_f16 v[156:159], v[232:235], v[208:211], v[156:159]
ds_read_b128 v[228:231], v250 offset:20736
ds_read_u16_d16 v192, v192
v_exp_f16_sdwa v198, v199 dst_sel:WORD_1 dst_unused:UNUSED_PRESERVE src0_sel:WORD_1
v_lshrrev_b32_e64 v193, 18, v193
v_mfma_f32_16x16x32_f16 v[164:167], v[232:235], v[212:215], v[164:167]
v_exp_f16_sdwa v195, v196 dst_sel:WORD_1 dst_unused:UNUSED_PRESERVE src0_sel:WORD_1
v_pk_add_f16 v201, v201, 1.0 op_sel_hi:[1,0]
v_mfma_f32_16x16x32_bf16 v[172:175], v[236:239], v[32:35], v[172:175]
ds_read_b128 v[232:235], v248 offset:16384
ds_read_u16_d16_hi v193, v193
v_pk_add_f16 v198, v198, 1.0 op_sel_hi:[1,0]
v_pk_add_f16 v195, v195, 1.0 op_sel_hi:[1,0]
v_mfma_f32_16x16x32_bf16 v[180:183], v[236:239], v[36:39], v[180:183]
v_rcp_f16_e64 v202, v201
v_mfma_f32_16x16x32_bf16 v[168:171], v[216:219], v[40:43], v[168:171]
ds_read_b128 v[236:239], v250 offset:21504
v_rcp_f16_e64 v199, v198
v_mfma_f32_16x16x32_bf16 v[176:179], v[216:219], v[44:47], v[176:179]
v_rcp_f16 v196, v195
s_waitcnt lgkmcnt(5)
v_mfma_f32_16x16x32_bf16 v[172:175], v[220:223], v[40:43], v[172:175]
ds_read_b128 v[216:219], v248 offset:16640
v_rcp_f16_sdwa v202, v201 dst_sel:WORD_1 dst_unused:UNUSED_PRESERVE src0_sel:WORD_1
v_mfma_f32_16x16x32_bf16 v[180:183], v[220:223], v[44:47], v[180:183]
v_rcp_f16_sdwa v199, v198 dst_sel:WORD_1 dst_unused:UNUSED_PRESERVE src0_sel:WORD_1
v_or_b32 v208, v184, v185
v_or_b32 v209, v186, v187
v_or_b32_e64 v210, v188, v189
v_rcp_f16_sdwa v196, v195 dst_sel:WORD_1 dst_unused:UNUSED_PRESERVE src0_sel:WORD_1
v_or_b32 v211, v190, v191
s_waitcnt lgkmcnt(2)
v_or_b32_e64 v212, v192, v193
v_pk_mul_f16 v213, v203, v202
v_pk_mul_f16 v214, v200, v199
v_pk_mul_f16 v215, v197, v196
v_mfma_f32_16x16x32_f16 v[120:123], v[224:227], v[208:211], v[120:123]
ds_read_b128 v[220:223], v250 offset:21760
v_cvt_pkrtz_f16_f32 v185, v168, v169
v_cvt_pkrtz_f16_f32 v187, v170, v171
v_mfma_f32_16x16x32_f16 v[128:131], v[224:227], v[212:215], v[128:131]
v_cvt_pkrtz_f16_f32 v189, v172, v173
v_cvt_pkrtz_f16_f32 v191, v174, v175
v_mfma_f32_16x16x32_f16 v[124:127], v[228:231], v[208:211], v[124:127]
ds_read_b128 v[224:227], v248 offset:17408
v_cvt_pkrtz_f16_f32 v193, v176, v177
v_cvt_pk_f16_f32 v203, v178, v179
v_cvt_pk_f16_f32 v200, v180, v181
v_mfma_f32_16x16x32_f16 v[132:135], v[228:231], v[212:215], v[132:135]
v_cvt_pk_f16_f32 v197, v182, v183
v_pk_fma_f16 v202, v203, v203, s48
s_waitcnt vmcnt(14)
v_mfma_f32_16x16x32_bf16 v[168:171], v[232:235], v[96:99], 0
ds_read_b128 v[228:231], v250 offset:22528
v_and_b32 v185, s49, v185
v_pk_fma_f16 v199, v200, v200, s48
s_waitcnt vmcnt(13)
v_mfma_f32_16x16x32_bf16 v[176:179], v[232:235], v[100:103], 0
v_and_b32 v187, s49, v187
v_pk_fma_f16 v196, v197, v197, s48
s_setprio 2
v_bfe_u32 v184, v185, 2, 14
s_waitcnt lgkmcnt(2)
v_mfma_f32_16x16x32_f16 v[136:139], v[236:239], v[208:211], v[136:139]
ds_read_b128 v[232:235], v250 offset:22784
ds_read_u16_d16 v184, v184
v_pk_mul_f16 v202, v203, v202
v_bfe_u32 v186, v187, 2, 14
v_mfma_f32_16x16x32_f16 v[144:147], v[236:239], v[212:215], v[144:147]
v_pk_mul_f16 v199, v200, v199
v_lshrrev_b32_e64 v185, 18, v185
v_mfma_f32_16x16x32_bf16 v[172:175], v[216:219], v[96:99], 0
ds_read_b128 v[236:239], v248 offset:17664
ds_read_u16_d16 v186, v186
ds_read_u16_d16_hi v185, v185
v_pk_mul_f16 v196, v197, v196
v_lshrrev_b32_e64 v187, 18, v187
v_mfma_f32_16x16x32_bf16 v[180:183], v[216:219], v[100:103], 0
v_exp_f16 v201, v202
v_and_b32 v189, s49, v189
v_mfma_f32_16x16x32_f16 v[140:143], v[220:223], v[208:211], v[140:143]
ds_read_b128 v[216:219], v248 offset:18432
ds_read_u16_d16_hi v187, v187
v_and_b32_e64 v191, s49, v191
v_mfma_f32_16x16x32_f16 v[148:151], v[220:223], v[212:215], v[148:151]
v_exp_f16 v198, v199
v_bfe_u32 v188, v189, 2, 14
v_bfe_u32 v190, v191, 2, 14
s_waitcnt vmcnt(12) lgkmcnt(7)
v_mfma_f32_16x16x32_bf16 v[168:171], v[224:227], v[104:107], v[168:171]
ds_read_b128 v[220:223], v248 offset:18688
ds_read_u16_d16 v188, v188
ds_read_u16_d16 v190, v190
v_exp_f16 v195, v196
s_waitcnt vmcnt(11)
v_mfma_f32_16x16x32_bf16 v[176:179], v[224:227], v[108:111], v[176:179]
v_lshrrev_b32 v189, 18, v189
v_lshrrev_b32 v191, 18, v191
v_mfma_f32_16x16x32_f16 v[152:155], v[228:231], v[208:211], v[152:155]
ds_read_b128 v[224:227], v250 offset:26624
ds_read_u16_d16_hi v189, v189
ds_read_u16_d16_hi v191, v191
v_exp_f16_sdwa v201, v202 dst_sel:WORD_1 dst_unused:UNUSED_PRESERVE src0_sel:WORD_1
v_and_b32 v193, s49, v193
v_mfma_f32_16x16x32_f16 v[160:163], v[228:231], v[212:215], v[160:163]
v_bfe_u32 v192, v193, 2, 14
s_waitcnt lgkmcnt(7)
v_mfma_f32_16x16x32_f16 v[156:159], v[232:235], v[208:211], v[156:159]
ds_read_b128 v[228:231], v250 offset:26880
ds_read_u16_d16 v192, v192
v_exp_f16_sdwa v198, v199 dst_sel:WORD_1 dst_unused:UNUSED_PRESERVE src0_sel:WORD_1
v_lshrrev_b32_e64 v193, 18, v193
v_mfma_f32_16x16x32_f16 v[164:167], v[232:235], v[212:215], v[164:167]
v_exp_f16_sdwa v195, v196 dst_sel:WORD_1 dst_unused:UNUSED_PRESERVE src0_sel:WORD_1
v_pk_add_f16 v201, v201, 1.0 op_sel_hi:[1,0]
v_mfma_f32_16x16x32_bf16 v[172:175], v[236:239], v[104:107], v[172:175]
ds_read_b128 v[232:235], v248 offset:22528
ds_read_u16_d16_hi v193, v193
v_pk_add_f16 v198, v198, 1.0 op_sel_hi:[1,0]
v_pk_add_f16 v195, v195, 1.0 op_sel_hi:[1,0]
v_mfma_f32_16x16x32_bf16 v[180:183], v[236:239], v[108:111], v[180:183]
v_rcp_f16 v202, v201
s_waitcnt vmcnt(10)
v_mfma_f32_16x16x32_bf16 v[168:171], v[216:219], v[112:115], v[168:171]
ds_read_b128 v[236:239], v250 offset:27648
v_rcp_f16 v199, v198
s_waitcnt vmcnt(7)
v_mfma_f32_16x16x32_bf16 v[176:179], v[216:219], v[116:119], v[176:179]
v_rcp_f16 v196, v195
s_waitcnt lgkmcnt(5)
v_mfma_f32_16x16x32_bf16 v[172:175], v[220:223], v[112:115], v[172:175]
ds_read_b128 v[216:219], v248 offset:22784
v_rcp_f16_sdwa v202, v201 dst_sel:WORD_1 dst_unused:UNUSED_PRESERVE src0_sel:WORD_1
v_mfma_f32_16x16x32_bf16 v[180:183], v[220:223], v[116:119], v[180:183]
v_rcp_f16_sdwa v199, v198 dst_sel:WORD_1 dst_unused:UNUSED_PRESERVE src0_sel:WORD_1
v_or_b32 v208, v184, v185
v_or_b32 v209, v186, v187
v_or_b32_e64 v210, v188, v189
v_rcp_f16_sdwa v196, v195 dst_sel:WORD_1 dst_unused:UNUSED_PRESERVE src0_sel:WORD_1
v_or_b32 v211, v190, v191
s_waitcnt lgkmcnt(2)
v_or_b32_e64 v212, v192, v193
v_pk_mul_f16 v213, v203, v202
v_pk_mul_f16 v214, v200, v199
v_pk_mul_f16 v215, v197, v196
v_mfma_f32_16x16x32_f16 v[120:123], v[224:227], v[208:211], v[120:123]
s_add_u32 s46, s68, 98304
buffer_load_dwordx4 v[44:47], v252, s[4:7], s46 offen offset:64
ds_read_b128 v[220:223], v250 offset:27904
v_cvt_pkrtz_f16_f32 v185, v168, v169
v_cvt_pkrtz_f16_f32 v187, v170, v171
v_mfma_f32_16x16x32_f16 v[128:131], v[224:227], v[212:215], v[128:131]
v_cvt_pkrtz_f16_f32 v189, v172, v173
v_cvt_pkrtz_f16_f32 v191, v174, v175
v_mfma_f32_16x16x32_f16 v[124:127], v[228:231], v[208:211], v[124:127]
ds_read_b128 v[224:227], v248 offset:23552
v_cvt_pkrtz_f16_f32 v193, v176, v177
v_cvt_pk_f16_f32 v203, v178, v179
v_mfma_f32_16x16x32_f16 v[132:135], v[228:231], v[212:215], v[132:135]
v_cvt_pk_f16_f32 v200, v180, v181
v_cvt_pk_f16_f32 v197, v182, v183
s_setprio 1
v_mfma_f32_16x16x32_bf16 v[168:171], v[232:235], v[96:99], 0
ds_read_b128 v[228:231], v250 offset:28672
v_pk_fma_f16 v202, v203, v203, s48
v_and_b32 v185, s49, v185
v_mfma_f32_16x16x32_bf16 v[176:179], v[232:235], v[100:103], 0
v_pk_fma_f16 v199, v200, v200, s48
v_and_b32 v187, s49, v187
s_waitcnt lgkmcnt(3)
v_mfma_f32_16x16x32_f16 v[136:139], v[236:239], v[208:211], v[136:139]
ds_read_b128 v[232:235], v250 offset:28928
v_pk_fma_f16 v196, v197, v197, s48
v_bfe_u32 v184, v185, 2, 14
v_pk_mul_f16 v202, v203, v202
v_mfma_f32_16x16x32_f16 v[144:147], v[236:239], v[212:215], v[144:147]
v_bfe_u32 v186, v187, 2, 14
v_pk_mul_f16 v199, v200, v199
s_waitcnt vmcnt(7)
v_mfma_f32_16x16x32_bf16 v[120:123], v[18:21], v[204:207], v[120:123]
ds_read_b128 v[236:239], v248 offset:23808
ds_read_u16_d16 v184, v184
ds_read_u16_d16 v186, v186
v_lshrrev_b32 v185, 18, v185
v_pk_mul_f16 v196, v197, v196
v_mfma_f32_16x16x32_bf16 v[124:127], v[16:19], v[204:207], v[124:127]
v_lshrrev_b32_e64 v187, 18, v187
v_mfma_f32_16x16x32_bf16 v[172:175], v[216:219], v[96:99], 0
ds_read_u16_d16_hi v185, v185
ds_read_u16_d16_hi v187, v187
v_exp_f16 v201, v202
v_and_b32 v189, s49, v189
v_mfma_f32_16x16x32_bf16 v[180:183], v[216:219], v[100:103], 0
v_and_b32 v191, s49, v191
s_waitcnt lgkmcnt(6)
v_mfma_f32_16x16x32_f16 v[140:143], v[220:223], v[208:211], v[140:143]
ds_read_b128 v[216:219], v248 offset:24576
v_exp_f16_e64 v198, v199
v_bfe_u32 v188, v189, 2, 14
v_mfma_f32_16x16x32_f16 v[148:151], v[220:223], v[212:215], v[148:151]
v_bfe_u32 v190, v191, 2, 14
v_exp_f16_e64 v195, v196
v_mfma_f32_16x16x32_bf16 v[168:171], v[224:227], v[104:107], v[168:171]
s_add_u32 s46, s70, 98304
buffer_store_dwordx4 v[88:91], v255, s[8:11], s46 offen offset:256 sc1
ds_read_b128 v[220:223], v248 offset:24832
ds_read_u16_d16 v188, v188
ds_read_u16_d16 v190, v190
v_lshrrev_b32 v189, 18, v189
v_lshrrev_b32 v191, 18, v191
v_mfma_f32_16x16x32_bf16 v[176:179], v[224:227], v[108:111], v[176:179]
v_exp_f16_sdwa v201, v202 dst_sel:WORD_1 dst_unused:UNUSED_PRESERVE src0_sel:WORD_1
v_mfma_f32_16x16x32_f16 v[152:155], v[228:231], v[208:211], v[152:155]
ds_read_b128 v[224:227], v249 offset:24576
ds_read_u16_d16_hi v189, v189
ds_read_u16_d16_hi v191, v191
v_and_b32 v193, s49, v193
v_bfe_u32 v192, v193, 2, 14
v_mfma_f32_16x16x32_f16 v[160:163], v[228:231], v[212:215], v[160:163]
v_exp_f16_sdwa v198, v199 dst_sel:WORD_1 dst_unused:UNUSED_PRESERVE src0_sel:WORD_1
s_waitcnt lgkmcnt(7)
v_mfma_f32_16x16x32_f16 v[156:159], v[232:235], v[208:211], v[156:159]
ds_read_b128 v[228:231], v254 offset:7936
ds_read_u16_d16 v192, v192
v_lshrrev_b32_e64 v193, 18, v193
v_mfma_f32_16x16x32_f16 v[164:167], v[232:235], v[212:215], v[164:167]
v_exp_f16_sdwa v195, v196 dst_sel:WORD_1 dst_unused:UNUSED_PRESERVE src0_sel:WORD_1
v_pk_add_f16 v201, v201, 1.0 op_sel_hi:[1,0]
v_pk_add_f16 v198, v198, 1.0 op_sel_hi:[1,0]
v_mfma_f32_16x16x32_bf16 v[172:175], v[236:239], v[104:107], v[172:175]
ds_read_b128 v[232:235], v249 offset:24832
ds_read_u16_d16_hi v193, v193
v_pk_add_f16 v195, v195, 1.0 op_sel_hi:[1,0]
v_mfma_f32_16x16x32_bf16 v[180:183], v[236:239], v[108:111], v[180:183]
v_rcp_f16_e64 v202, v201
s_setprio 0
s_waitcnt lgkmcnt(7)
v_mfma_f32_16x16x32_bf16 v[168:171], v[216:219], v[112:115], v[168:171]
ds_read_b128 v[236:239], v254 offset:7952
v_rcp_f16_e64 v199, v198
v_mfma_f32_16x16x32_bf16 v[176:179], v[216:219], v[116:119], v[176:179]
v_rcp_f16_e64 v196, v195
v_mfma_f32_16x16x32_bf16 v[172:175], v[220:223], v[112:115], v[172:175]
ds_read_b128 v[216:219], v248 offset:28672
v_rcp_f16_sdwa v202, v201 dst_sel:WORD_1 dst_unused:UNUSED_PRESERVE src0_sel:WORD_1
v_mfma_f32_16x16x32_bf16 v[180:183], v[220:223], v[116:119], v[180:183]
v_rcp_f16_sdwa v199, v198 dst_sel:WORD_1 dst_unused:UNUSED_PRESERVE src0_sel:WORD_1
v_or_b32 v208, v184, v185
v_or_b32 v209, v186, v187
s_waitcnt lgkmcnt(4)
v_or_b32 v210, v188, v189
v_rcp_f16_sdwa v196, v195 dst_sel:WORD_1 dst_unused:UNUSED_PRESERVE src0_sel:WORD_1
v_or_b32 v211, v190, v191
s_waitcnt lgkmcnt(2)
v_or_b32 v212, v192, v193
v_pk_mul_f16 v213, v203, v202
v_pk_mul_f16 v214, v200, v199
v_pk_mul_f16 v215, v197, v196
s_setprio 3
v_mfma_f32_16x16x32_f16 v[48:51], v[224:227], v[208:211], v[228:231]
ds_read_b128 v[220:223], v249 offset:25600
v_cvt_pkrtz_f16_f32 v185, v168, v169
v_cvt_pkrtz_f16_f32 v187, v170, v171
v_mfma_f32_16x16x32_f16 v[56:59], v[224:227], v[212:215], v[228:231]
v_cvt_pkrtz_f16_f32 v189, v172, v173
v_cvt_pkrtz_f16_f32 v191, v174, v175
s_waitcnt lgkmcnt(2)
v_mfma_f32_16x16x32_f16 v[52:55], v[232:235], v[208:211], v[236:239]
ds_read_b128 v[224:227], v254 offset:8064
ds_read_b128 v[228:231], v248 offset:28928
v_cvt_pkrtz_f16_f32 v193, v176, v177
v_cvt_pk_f16_f32 v203, v178, v179
v_mfma_f32_16x16x32_f16 v[60:63], v[232:235], v[212:215], v[236:239]
v_cvt_pk_f16_f32 v200, v180, v181
v_cvt_pk_f16_f32 v197, v182, v183
s_waitcnt lgkmcnt(3)
v_mfma_f32_16x16x32_bf16 v[168:171], v[216:219], v[96:99], 0
ds_read_b128 v[232:235], v249 offset:25856
ds_read_b128 v[236:239], v254 offset:8080
v_pk_fma_f16 v202, v203, v203, s48
v_and_b32_e64 v185, s49, v185
v_mfma_f32_16x16x32_bf16 v[176:179], v[216:219], v[100:103], 0
v_pk_fma_f16 v199, v200, v200, s48
v_and_b32 v187, s49, v187
s_waitcnt lgkmcnt(3)
v_mfma_f32_16x16x32_f16 v[64:67], v[220:223], v[208:211], v[224:227]
ds_read_b128 v[216:219], v248 offset:29696
v_pk_fma_f16 v196, v197, v197, s48
v_bfe_u32 v184, v185, 2, 14
v_pk_mul_f16 v202, v203, v202
v_mfma_f32_16x16x32_f16 v[72:75], v[220:223], v[212:215], v[224:227]
v_bfe_u32 v186, v187, 2, 14
v_pk_mul_f16 v199, v200, v199
s_waitcnt vmcnt(6)
v_mfma_f32_16x16x32_bf16 v[136:139], v[18:21], v[244:247], v[136:139]
ds_read_b128 v[220:223], v249 offset:26624
ds_read_b128 v[224:227], v254 offset:16128
ds_read_u16_d16 v184, v184
ds_read_u16_d16 v186, v186
v_lshrrev_b32 v185, 18, v185
v_pk_mul_f16 v196, v197, v196
v_mfma_f32_16x16x32_bf16 v[140:143], v[16:19], v[244:247], v[140:143]
v_lshrrev_b32 v187, 18, v187
s_waitcnt lgkmcnt(5)
v_mfma_f32_16x16x32_bf16 v[172:175], v[228:231], v[96:99], 0
ds_read_u16_d16_hi v185, v185
ds_read_u16_d16_hi v187, v187
v_exp_f16 v201, v202
v_and_b32 v189, s49, v189
v_mfma_f32_16x16x32_bf16 v[180:183], v[228:231], v[100:103], 0
v_and_b32_e64 v191, s49, v191
v_mfma_f32_16x16x32_f16 v[68:71], v[232:235], v[208:211], v[236:239]
ds_read_b128 v[228:231], v249 offset:26880
v_exp_f16_e64 v198, v199
v_bfe_u32 v188, v189, 2, 14
v_mfma_f32_16x16x32_f16 v[76:79], v[232:235], v[212:215], v[236:239]
v_bfe_u32 v190, v191, 2, 14
v_exp_f16 v195, v196
s_waitcnt lgkmcnt(7)
v_mfma_f32_16x16x32_bf16 v[168:171], v[216:219], v[104:107], v[168:171]
ds_read_b128 v[232:235], v254 offset:16144
ds_read_b128 v[236:239], v248 offset:29952
ds_read_u16_d16 v188, v188
ds_read_u16_d16 v190, v190
v_lshrrev_b32_e64 v189, 18, v189
v_lshrrev_b32 v191, 18, v191
v_mfma_f32_16x16x32_bf16 v[176:179], v[216:219], v[108:111], v[176:179]
v_exp_f16_sdwa v201, v202 dst_sel:WORD_1 dst_unused:UNUSED_PRESERVE src0_sel:WORD_1
s_waitcnt lgkmcnt(7)
v_mfma_f32_16x16x32_f16 v[80:83], v[220:223], v[208:211], v[224:227]
ds_read_b128 v[216:219], v248 offset:30720
ds_read_u16_d16_hi v189, v189
ds_read_u16_d16_hi v191, v191
v_and_b32 v193, s49, v193
v_bfe_u32 v192, v193, 2, 14
v_mfma_f32_16x16x32_f16 v[88:91], v[220:223], v[212:215], v[224:227]
v_exp_f16_sdwa v198, v199 dst_sel:WORD_1 dst_unused:UNUSED_PRESERVE src0_sel:WORD_1
s_waitcnt lgkmcnt(6)
v_mfma_f32_16x16x32_f16 v[84:87], v[228:231], v[208:211], v[232:235]
ds_read_b128 v[220:223], v248 offset:30976
ds_read_b128 v[224:227], v249 offset:30720
ds_read_u16_d16 v192, v192
v_lshrrev_b32 v193, 18, v193
v_mfma_f32_16x16x32_f16 v[92:95], v[228:231], v[212:215], v[232:235]
v_exp_f16_sdwa v195, v196 dst_sel:WORD_1 dst_unused:UNUSED_PRESERVE src0_sel:WORD_1
v_pk_add_f16 v201, v201, 1.0 op_sel_hi:[1,0]
v_pk_add_f16 v198, v198, 1.0 op_sel_hi:[1,0]
s_waitcnt lgkmcnt(7)
v_mfma_f32_16x16x32_bf16 v[172:175], v[236:239], v[104:107], v[172:175]
ds_read_b128 v[228:231], v249 offset:30976
ds_read_b128 v[232:235], v248 offset:34816
ds_read_u16_d16_hi v193, v193
v_pk_add_f16 v195, v195, 1.0 op_sel_hi:[1,0]
v_mfma_f32_16x16x32_bf16 v[180:183], v[236:239], v[108:111], v[180:183]
v_rcp_f16 v202, v201
s_waitcnt lgkmcnt(8)
v_mfma_f32_16x16x32_bf16 v[168:171], v[216:219], v[112:115], v[168:171]
ds_read_b128 v[236:239], v249 offset:31744
v_rcp_f16_e64 v199, v198
v_mfma_f32_16x16x32_bf16 v[176:179], v[216:219], v[116:119], v[176:179]
v_rcp_f16 v196, v195
s_waitcnt lgkmcnt(6)
v_mfma_f32_16x16x32_bf16 v[172:175], v[220:223], v[112:115], v[172:175]
ds_read_b128 v[216:219], v248 offset:35072
v_rcp_f16_sdwa v202, v201 dst_sel:WORD_1 dst_unused:UNUSED_PRESERVE src0_sel:WORD_1
v_mfma_f32_16x16x32_bf16 v[180:183], v[220:223], v[116:119], v[180:183]
v_rcp_f16_sdwa v199, v198 dst_sel:WORD_1 dst_unused:UNUSED_PRESERVE src0_sel:WORD_1
v_or_b32 v208, v184, v185
v_or_b32 v209, v186, v187
v_or_b32_e64 v210, v188, v189
v_rcp_f16_sdwa v196, v195 dst_sel:WORD_1 dst_unused:UNUSED_PRESERVE src0_sel:WORD_1
v_or_b32 v211, v190, v191
s_waitcnt lgkmcnt(2)
v_or_b32_e64 v212, v192, v193
v_pk_mul_f16 v213, v203, v202
v_pk_mul_f16 v214, v200, v199
v_pk_mul_f16 v215, v197, v196
v_mfma_f32_16x16x32_f16 v[48:51], v[224:227], v[208:211], v[48:51]
s_add_u32 s46, s68, 98304
buffer_load_dwordx4 v[244:247], v252, s[4:7], s46 offen offset:128
ds_read_b128 v[220:223], v249 offset:32000
v_cvt_pkrtz_f16_f32 v185, v168, v169
v_cvt_pkrtz_f16_f32 v187, v170, v171
v_mfma_f32_16x16x32_f16 v[56:59], v[224:227], v[212:215], v[56:59]
v_cvt_pkrtz_f16_f32 v189, v172, v173
v_cvt_pkrtz_f16_f32 v191, v174, v175
v_mfma_f32_16x16x32_f16 v[52:55], v[228:231], v[208:211], v[52:55]
ds_read_b128 v[224:227], v248 offset:35840
v_cvt_pkrtz_f16_f32 v193, v176, v177
v_cvt_pk_f16_f32 v203, v178, v179
v_mfma_f32_16x16x32_f16 v[60:63], v[228:231], v[212:215], v[60:63]
v_cvt_pk_f16_f32 v200, v180, v181
v_cvt_pk_f16_f32 v197, v182, v183
v_mfma_f32_16x16x32_bf16 v[168:171], v[232:235], v[96:99], 0
ds_read_b128 v[228:231], v249 offset:32768
v_pk_fma_f16 v202, v203, v203, s48
v_and_b32_e64 v185, s49, v185
v_mfma_f32_16x16x32_bf16 v[176:179], v[232:235], v[100:103], 0
v_pk_fma_f16 v199, v200, v200, s48
v_and_b32 v187, s49, v187
s_waitcnt lgkmcnt(3)
v_mfma_f32_16x16x32_f16 v[64:67], v[236:239], v[208:211], v[64:67]
ds_read_b128 v[232:235], v249 offset:33024
v_pk_fma_f16 v196, v197, v197, s48
s_setprio 2
v_bfe_u32 v184, v185, 2, 14
v_pk_mul_f16 v202, v203, v202
v_mfma_f32_16x16x32_f16 v[72:75], v[236:239], v[212:215], v[72:75]
v_bfe_u32 v186, v187, 2, 14
v_pk_mul_f16 v199, v200, v199
s_waitcnt vmcnt(5)
v_mfma_f32_16x16x32_bf16 v[152:155], v[18:21], v[0:3], v[152:155]
ds_read_b128 v[236:239], v248 offset:36096
ds_read_u16_d16 v184, v184
ds_read_u16_d16 v186, v186
v_lshrrev_b32_e64 v185, 18, v185
v_pk_mul_f16 v196, v197, v196
v_mfma_f32_16x16x32_bf16 v[156:159], v[16:19], v[0:3], v[156:159]
v_lshrrev_b32_e64 v187, 18, v187
v_mfma_f32_16x16x32_bf16 v[172:175], v[216:219], v[96:99], 0
ds_read_u16_d16_hi v185, v185
ds_read_u16_d16_hi v187, v187
v_exp_f16 v201, v202
v_and_b32 v189, s49, v189
v_mfma_f32_16x16x32_bf16 v[180:183], v[216:219], v[100:103], 0
v_and_b32 v191, s49, v191
s_waitcnt lgkmcnt(6)
v_mfma_f32_16x16x32_f16 v[68:71], v[220:223], v[208:211], v[68:71]
ds_read_b128 v[216:219], v248 offset:36864
v_exp_f16_e64 v198, v199
v_bfe_u32 v188, v189, 2, 14
v_mfma_f32_16x16x32_f16 v[76:79], v[220:223], v[212:215], v[76:79]
v_bfe_u32 v190, v191, 2, 14
v_exp_f16_e64 v195, v196
v_mfma_f32_16x16x32_bf16 v[168:171], v[224:227], v[104:107], v[168:171]
ds_read_b128 v[220:223], v248 offset:37120
ds_read_u16_d16 v188, v188
ds_read_u16_d16 v190, v190
v_lshrrev_b32 v189, 18, v189
v_lshrrev_b32 v191, 18, v191
v_mfma_f32_16x16x32_bf16 v[176:179], v[224:227], v[108:111], v[176:179]
v_exp_f16_sdwa v201, v202 dst_sel:WORD_1 dst_unused:UNUSED_PRESERVE src0_sel:WORD_1
v_mfma_f32_16x16x32_f16 v[80:83], v[228:231], v[208:211], v[80:83]
ds_read_b128 v[224:227], v249 offset:36864
ds_read_u16_d16_hi v189, v189
ds_read_u16_d16_hi v191, v191
v_and_b32 v193, s49, v193
v_bfe_u32 v192, v193, 2, 14
v_mfma_f32_16x16x32_f16 v[88:91], v[228:231], v[212:215], v[88:91]
v_exp_f16_sdwa v198, v199 dst_sel:WORD_1 dst_unused:UNUSED_PRESERVE src0_sel:WORD_1
s_waitcnt lgkmcnt(7)
v_mfma_f32_16x16x32_f16 v[84:87], v[232:235], v[208:211], v[84:87]
ds_read_b128 v[228:231], v249 offset:37120
ds_read_u16_d16 v192, v192
v_lshrrev_b32_e64 v193, 18, v193
v_mfma_f32_16x16x32_f16 v[92:95], v[232:235], v[212:215], v[92:95]
v_exp_f16_sdwa v195, v196 dst_sel:WORD_1 dst_unused:UNUSED_PRESERVE src0_sel:WORD_1
v_pk_add_f16 v201, v201, 1.0 op_sel_hi:[1,0]
v_pk_add_f16 v198, v198, 1.0 op_sel_hi:[1,0]
v_mfma_f32_16x16x32_bf16 v[172:175], v[236:239], v[104:107], v[172:175]
ds_read_b128 v[232:235], v248 offset:40960
ds_read_u16_d16_hi v193, v193
v_pk_add_f16 v195, v195, 1.0 op_sel_hi:[1,0]
v_mfma_f32_16x16x32_bf16 v[180:183], v[236:239], v[108:111], v[180:183]
v_rcp_f16 v202, v201
s_waitcnt lgkmcnt(7)
v_mfma_f32_16x16x32_bf16 v[168:171], v[216:219], v[112:115], v[168:171]
ds_read_b128 v[236:239], v249 offset:37888
v_rcp_f16_e64 v199, v198
v_mfma_f32_16x16x32_bf16 v[176:179], v[216:219], v[116:119], v[176:179]
v_rcp_f16_e64 v196, v195
v_mfma_f32_16x16x32_bf16 v[172:175], v[220:223], v[112:115], v[172:175]
ds_read_b128 v[216:219], v248 offset:41216
v_rcp_f16_sdwa v202, v201 dst_sel:WORD_1 dst_unused:UNUSED_PRESERVE src0_sel:WORD_1
v_mfma_f32_16x16x32_bf16 v[180:183], v[220:223], v[116:119], v[180:183]
v_rcp_f16_sdwa v199, v198 dst_sel:WORD_1 dst_unused:UNUSED_PRESERVE src0_sel:WORD_1
v_or_b32 v208, v184, v185
v_or_b32 v209, v186, v187
s_waitcnt lgkmcnt(4)
v_or_b32 v210, v188, v189
v_rcp_f16_sdwa v196, v195 dst_sel:WORD_1 dst_unused:UNUSED_PRESERVE src0_sel:WORD_1
v_or_b32 v211, v190, v191
s_waitcnt lgkmcnt(2)
v_or_b32_e64 v212, v192, v193
v_pk_mul_f16 v213, v203, v202
v_pk_mul_f16 v214, v200, v199
v_pk_mul_f16 v215, v197, v196
v_mfma_f32_16x16x32_f16 v[48:51], v[224:227], v[208:211], v[48:51]
buffer_load_dwordx4 v[0:3], v252, s[4:7], s69 offen
ds_read_b128 v[220:223], v249 offset:38144
v_cvt_pkrtz_f16_f32 v185, v168, v169
v_cvt_pkrtz_f16_f32 v187, v170, v171
v_cvt_pkrtz_f16_f32 v189, v172, v173
v_mfma_f32_16x16x32_f16 v[56:59], v[224:227], v[212:215], v[56:59]
v_cvt_pkrtz_f16_f32 v191, v174, v175
v_cvt_pkrtz_f16_f32 v193, v176, v177
v_cvt_pk_f16_f32 v203, v178, v179
v_mfma_f32_16x16x32_f16 v[52:55], v[228:231], v[208:211], v[52:55]
ds_read_b128 v[224:227], v248 offset:41984
v_cvt_pk_f16_f32 v200, v180, v181
v_cvt_pk_f16_f32 v197, v182, v183
v_pk_fma_f16 v202, v203, v203, s48
s_setprio 1
v_cvt_pk_bf16_f32 v136, v136, v137
v_mfma_f32_16x16x32_f16 v[60:63], v[228:231], v[212:215], v[60:63]
v_and_b32 v185, s49, v185
v_cvt_pk_bf16_f32 v137, v138, v139
v_pk_fma_f16 v199, v200, v200, s48
v_mfma_f32_16x16x32_bf16 v[168:171], v[232:235], v[96:99], 0
ds_read_b128 v[228:231], v249 offset:38912
v_and_b32 v187, s49, v187
v_cvt_pk_bf16_f32 v138, v140, v141
v_pk_fma_f16 v196, v197, v197, s48
v_mfma_f32_16x16x32_bf16 v[176:179], v[232:235], v[100:103], 0
v_cvt_pk_bf16_f32 v139, v142, v143
v_bfe_u32 v184, v185, 2, 14
v_pk_mul_f16 v202, v203, v202
v_cvt_pk_bf16_f32 v120, v120, v121
s_waitcnt lgkmcnt(2)
v_mfma_f32_16x16x32_f16 v[64:67], v[236:239], v[208:211], v[64:67]
ds_read_b128 v[232:235], v249 offset:39168
ds_read_u16_d16 v184, v184
v_bfe_u32 v186, v187, 2, 14
v_cvt_pk_bf16_f32 v121, v122, v123
v_pk_mul_f16 v199, v200, v199
v_mfma_f32_16x16x32_f16 v[72:75], v[236:239], v[212:215], v[72:75]
v_lshrrev_b32_e64 v185, 18, v185
v_cvt_pk_bf16_f32 v122, v124, v125
v_pk_mul_f16 v196, v197, v196
v_mfma_f32_16x16x32_bf16 v[172:175], v[216:219], v[96:99], 0
ds_read_b128 v[236:239], v248 offset:42240
ds_read_u16_d16 v186, v186
ds_read_u16_d16_hi v185, v185
v_lshrrev_b32_e64 v187, 18, v187
v_cvt_pk_bf16_f32 v123, v126, v127
v_exp_f16_e64 v201, v202
v_mfma_f32_16x16x32_bf16 v[180:183], v[216:219], v[100:103], 0
v_cvt_pk_bf16_f32 v152, v152, v153
v_and_b32_e64 v189, s49, v189
v_cvt_pk_bf16_f32 v153, v154, v155
v_mfma_f32_16x16x32_f16 v[68:71], v[220:223], v[208:211], v[68:71]
ds_read_b128 v[216:219], v248 offset:43008
ds_read_u16_d16_hi v187, v187
v_and_b32_e64 v191, s49, v191
v_cvt_pk_bf16_f32 v154, v156, v157
v_mfma_f32_16x16x32_f16 v[76:79], v[220:223], v[212:215], v[76:79]
v_exp_f16_e64 v198, v199
v_cvt_pk_bf16_f32 v155, v158, v159
s_mov_b64 vcc, s[74:75]
v_bfe_u32 v188, v189, 2, 14
v_bfe_u32 v190, v191, 2, 14
s_waitcnt lgkmcnt(5)
v_mfma_f32_16x16x32_bf16 v[168:171], v[224:227], v[104:107], v[168:171]
ds_read_b128 v[220:223], v248 offset:43264
ds_read_u16_d16 v188, v188
ds_read_u16_d16 v190, v190
v_cndmask_b32 v140, v120, v152, vcc
v_exp_f16 v195, v196
v_mfma_f32_16x16x32_bf16 v[176:179], v[224:227], v[108:111], v[176:179]
v_cndmask_b32 v141, v121, v153, vcc
v_lshrrev_b32_e64 v189, 18, v189
v_cndmask_b32 v142, v122, v154, vcc
v_mfma_f32_16x16x32_f16 v[80:83], v[228:231], v[208:211], v[80:83]
ds_read_b128 v[224:227], v249 offset:43008
ds_read_u16_d16_hi v189, v189
v_lshrrev_b32 v191, 18, v191
v_cndmask_b32 v143, v123, v155, vcc
v_exp_f16_sdwa v201, v202 dst_sel:WORD_1 dst_unused:UNUSED_PRESERVE src0_sel:WORD_1
v_mfma_f32_16x16x32_f16 v[88:91], v[228:231], v[212:215], v[88:91]
v_cndmask_b32_dpp v120, v136, v120, vcc quad_perm:[1,0,3,2] row_mask:0xf bank_mask:0xf
v_and_b32_e64 v193, s49, v193
v_cndmask_b32_dpp v121, v137, v121, vcc quad_perm:[1,0,3,2] row_mask:0xf bank_mask:0xf
v_mfma_f32_16x16x32_f16 v[84:87], v[232:235], v[208:211], v[84:87]
ds_read_b128 v[228:231], v249 offset:43264
ds_read_u16_d16_hi v191, v191
v_bfe_u32 v192, v193, 2, 14
v_exp_f16_sdwa v198, v199 dst_sel:WORD_1 dst_unused:UNUSED_PRESERVE src0_sel:WORD_1
v_mfma_f32_16x16x32_f16 v[92:95], v[232:235], v[212:215], v[92:95]
v_cndmask_b32_dpp v122, v138, v122, vcc quad_perm:[1,0,3,2] row_mask:0xf bank_mask:0xf
v_lshrrev_b32 v193, 18, v193
v_cndmask_b32_dpp v123, v139, v123, vcc quad_perm:[1,0,3,2] row_mask:0xf bank_mask:0xf
s_not_b64 vcc, s[74:75]
s_waitcnt lgkmcnt(4)
v_mfma_f32_16x16x32_bf16 v[172:175], v[236:239], v[104:107], v[172:175]
ds_read_b128 v[232:235], v248 offset:47104
ds_read_u16_d16 v192, v192
ds_read_u16_d16_hi v193, v193
v_exp_f16_sdwa v195, v196 dst_sel:WORD_1 dst_unused:UNUSED_PRESERVE src0_sel:WORD_1
v_cndmask_b32_dpp v152, v136, v152, vcc quad_perm:[1,0,3,2] row_mask:0xf bank_mask:0xf
s_setprio 0
v_pk_add_f16 v201, v201, 1.0 op_sel_hi:[1,0]
v_mfma_f32_16x16x32_bf16 v[180:183], v[236:239], v[108:111], v[180:183]
v_cndmask_b32_dpp v153, v137, v153, vcc quad_perm:[1,0,3,2] row_mask:0xf bank_mask:0xf
v_pk_add_f16 v198, v198, 1.0 op_sel_hi:[1,0]
v_cndmask_b32_dpp v154, v138, v154, vcc quad_perm:[1,0,3,2] row_mask:0xf bank_mask:0xf
v_mfma_f32_16x16x32_bf16 v[168:171], v[216:219], v[112:115], v[168:171]
ds_read_b128 v[236:239], v249 offset:44032
v_pk_add_f16 v195, v195, 1.0 op_sel_hi:[1,0]
v_rcp_f16_e64 v202, v201
v_cndmask_b32_dpp v155, v139, v155, vcc quad_perm:[1,0,3,2] row_mask:0xf bank_mask:0xf
v_mfma_f32_16x16x32_bf16 v[176:179], v[216:219], v[116:119], v[176:179]
v_rcp_f16_e64 v199, v198
v_mfma_f32_16x16x32_bf16 v[172:175], v[220:223], v[112:115], v[172:175]
ds_read_b128 v[216:219], v248 offset:47360
buffer_store_dwordx4 v[120:123], v255, s[8:11], s68 offen sc1
v_rcp_f16_e64 v196, v195
v_rcp_f16_sdwa v202, v201 dst_sel:WORD_1 dst_unused:UNUSED_PRESERVE src0_sel:WORD_1
v_mfma_f32_16x16x32_bf16 v[180:183], v[220:223], v[116:119], v[180:183]
v_rcp_f16_sdwa v199, v198 dst_sel:WORD_1 dst_unused:UNUSED_PRESERVE src0_sel:WORD_1
v_or_b32 v208, v184, v185
v_or_b32 v209, v186, v187
s_waitcnt lgkmcnt(2)
v_or_b32 v210, v188, v189
v_rcp_f16_sdwa v196, v195 dst_sel:WORD_1 dst_unused:UNUSED_PRESERVE src0_sel:WORD_1
v_or_b32_e64 v211, v190, v191
v_or_b32 v212, v192, v193
v_pk_mul_f16 v213, v203, v202
v_pk_mul_f16 v214, v200, v199
v_pk_mul_f16 v215, v197, v196
s_setprio 3
v_mfma_f32_16x16x32_f16 v[48:51], v[224:227], v[208:211], v[48:51]
buffer_load_dwordx4 v[204:207], v252, s[4:7], s69 offen offset:64
ds_read_b128 v[220:223], v249 offset:44288
v_cvt_pkrtz_f16_f32 v185, v168, v169
v_cvt_pkrtz_f16_f32 v187, v170, v171
v_mfma_f32_16x16x32_f16 v[56:59], v[224:227], v[212:215], v[56:59]
v_cvt_pkrtz_f16_f32 v189, v172, v173
v_cvt_pkrtz_f16_f32 v191, v174, v175
v_mfma_f32_16x16x32_f16 v[52:55], v[228:231], v[208:211], v[52:55]
ds_read_b128 v[224:227], v248 offset:48128
v_cvt_pkrtz_f16_f32 v193, v176, v177
v_cvt_pk_f16_f32 v203, v178, v179
v_mfma_f32_16x16x32_f16 v[60:63], v[228:231], v[212:215], v[60:63]
v_cvt_pk_f16_f32 v200, v180, v181
v_cvt_pk_f16_f32 v197, v182, v183
v_mfma_f32_16x16x32_bf16 v[168:171], v[232:235], v[96:99], 0
ds_read_b128 v[228:231], v249 offset:45056
v_pk_fma_f16 v202, v203, v203, s48
v_and_b32_e64 v185, s49, v185
v_mfma_f32_16x16x32_bf16 v[176:179], v[232:235], v[100:103], 0
v_pk_fma_f16 v199, v200, v200, s48
v_and_b32 v187, s49, v187
s_waitcnt lgkmcnt(3)
v_mfma_f32_16x16x32_f16 v[64:67], v[236:239], v[208:211], v[64:67]
ds_read_b128 v[232:235], v249 offset:45312
v_pk_fma_f16 v196, v197, v197, s48
v_bfe_u32 v184, v185, 2, 14
v_pk_mul_f16 v202, v203, v202
v_mfma_f32_16x16x32_f16 v[72:75], v[236:239], v[212:215], v[72:75]
v_bfe_u32 v186, v187, 2, 14
v_pk_mul_f16 v199, v200, v199
s_waitcnt vmcnt(7)
v_mfma_f32_16x16x32_bf16 v[128:131], v[18:21], v[4:7], v[128:131]
ds_read_b128 v[236:239], v248 offset:48384
ds_read_u16_d16 v184, v184
ds_read_u16_d16 v186, v186
v_lshrrev_b32 v185, 18, v185
v_pk_mul_f16 v196, v197, v196
v_mfma_f32_16x16x32_bf16 v[132:135], v[16:19], v[4:7], v[132:135]
v_lshrrev_b32_e64 v187, 18, v187
v_mfma_f32_16x16x32_bf16 v[172:175], v[216:219], v[96:99], 0
ds_read_u16_d16_hi v185, v185
ds_read_u16_d16_hi v187, v187
v_exp_f16 v201, v202
v_and_b32 v189, s49, v189
v_mfma_f32_16x16x32_bf16 v[180:183], v[216:219], v[100:103], 0
v_and_b32 v191, s49, v191
s_waitcnt lgkmcnt(6)
v_mfma_f32_16x16x32_f16 v[68:71], v[220:223], v[208:211], v[68:71]
ds_read_b128 v[216:219], v248 offset:49152
v_exp_f16_e64 v198, v199
v_bfe_u32 v188, v189, 2, 14
v_mfma_f32_16x16x32_f16 v[76:79], v[220:223], v[212:215], v[76:79]
v_bfe_u32 v190, v191, 2, 14
v_exp_f16_e64 v195, v196
v_mfma_f32_16x16x32_bf16 v[168:171], v[224:227], v[104:107], v[168:171]
buffer_store_dwordx4 v[140:143], v255, s[8:11], s68 offen offset:128 sc1
ds_read_b128 v[220:223], v248 offset:49408
ds_read_u16_d16 v188, v188
ds_read_u16_d16 v190, v190
v_lshrrev_b32 v189, 18, v189
v_lshrrev_b32 v191, 18, v191
v_mfma_f32_16x16x32_bf16 v[176:179], v[224:227], v[108:111], v[176:179]
v_exp_f16_sdwa v201, v202 dst_sel:WORD_1 dst_unused:UNUSED_PRESERVE src0_sel:WORD_1
v_mfma_f32_16x16x32_f16 v[80:83], v[228:231], v[208:211], v[80:83]
ds_read_b128 v[224:227], v249 offset:49152
ds_read_u16_d16_hi v189, v189
ds_read_u16_d16_hi v191, v191
v_and_b32 v193, s49, v193
v_bfe_u32 v192, v193, 2, 14
v_mfma_f32_16x16x32_f16 v[88:91], v[228:231], v[212:215], v[88:91]
v_exp_f16_sdwa v198, v199 dst_sel:WORD_1 dst_unused:UNUSED_PRESERVE src0_sel:WORD_1
s_waitcnt lgkmcnt(7)
v_mfma_f32_16x16x32_f16 v[84:87], v[232:235], v[208:211], v[84:87]
ds_read_b128 v[228:231], v249 offset:49408
ds_read_u16_d16 v192, v192
v_lshrrev_b32_e64 v193, 18, v193
v_mfma_f32_16x16x32_f16 v[92:95], v[232:235], v[212:215], v[92:95]
v_exp_f16_sdwa v195, v196 dst_sel:WORD_1 dst_unused:UNUSED_PRESERVE src0_sel:WORD_1
v_pk_add_f16 v201, v201, 1.0 op_sel_hi:[1,0]
v_pk_add_f16 v198, v198, 1.0 op_sel_hi:[1,0]
v_mfma_f32_16x16x32_bf16 v[172:175], v[236:239], v[104:107], v[172:175]
ds_read_b128 v[232:235], v248 offset:53248
ds_read_u16_d16_hi v193, v193
v_pk_add_f16 v195, v195, 1.0 op_sel_hi:[1,0]
v_mfma_f32_16x16x32_bf16 v[180:183], v[236:239], v[108:111], v[180:183]
v_rcp_f16 v202, v201
s_waitcnt lgkmcnt(7)
v_mfma_f32_16x16x32_bf16 v[168:171], v[216:219], v[112:115], v[168:171]
ds_read_b128 v[236:239], v249 offset:50176
v_rcp_f16_e64 v199, v198
v_mfma_f32_16x16x32_bf16 v[176:179], v[216:219], v[116:119], v[176:179]
v_rcp_f16_e64 v196, v195
v_mfma_f32_16x16x32_bf16 v[172:175], v[220:223], v[112:115], v[172:175]
ds_read_b128 v[216:219], v248 offset:53504
v_rcp_f16_sdwa v202, v201 dst_sel:WORD_1 dst_unused:UNUSED_PRESERVE src0_sel:WORD_1
v_mfma_f32_16x16x32_bf16 v[180:183], v[220:223], v[116:119], v[180:183]
v_rcp_f16_sdwa v199, v198 dst_sel:WORD_1 dst_unused:UNUSED_PRESERVE src0_sel:WORD_1
v_or_b32 v208, v184, v185
v_or_b32 v209, v186, v187
s_waitcnt lgkmcnt(4)
v_or_b32 v210, v188, v189
v_rcp_f16_sdwa v196, v195 dst_sel:WORD_1 dst_unused:UNUSED_PRESERVE src0_sel:WORD_1
v_or_b32 v211, v190, v191
s_waitcnt lgkmcnt(2)
v_or_b32_e64 v212, v192, v193
v_pk_mul_f16 v213, v203, v202
v_pk_mul_f16 v214, v200, v199
v_pk_mul_f16 v215, v197, v196
v_mfma_f32_16x16x32_f16 v[48:51], v[224:227], v[208:211], v[48:51]
buffer_load_dwordx4 v[4:7], v252, s[4:7], s69 offen offset:128
ds_read_b128 v[220:223], v249 offset:50432
v_cvt_pkrtz_f16_f32 v185, v168, v169
v_cvt_pkrtz_f16_f32 v187, v170, v171
v_mfma_f32_16x16x32_f16 v[56:59], v[224:227], v[212:215], v[56:59]
v_cvt_pkrtz_f16_f32 v189, v172, v173
v_cvt_pkrtz_f16_f32 v191, v174, v175
v_mfma_f32_16x16x32_f16 v[52:55], v[228:231], v[208:211], v[52:55]
ds_read_b128 v[224:227], v248 offset:54272
v_cvt_pkrtz_f16_f32 v193, v176, v177
v_cvt_pk_f16_f32 v203, v178, v179
v_mfma_f32_16x16x32_f16 v[60:63], v[228:231], v[212:215], v[60:63]
v_cvt_pk_f16_f32 v200, v180, v181
v_cvt_pk_f16_f32 v197, v182, v183
v_mfma_f32_16x16x32_bf16 v[168:171], v[232:235], v[96:99], 0
ds_read_b128 v[228:231], v249 offset:51200
v_pk_fma_f16 v202, v203, v203, s48
v_and_b32_e64 v185, s49, v185
v_mfma_f32_16x16x32_bf16 v[176:179], v[232:235], v[100:103], 0
v_pk_fma_f16 v199, v200, v200, s48
v_and_b32 v187, s49, v187
s_waitcnt lgkmcnt(3)
v_mfma_f32_16x16x32_f16 v[64:67], v[236:239], v[208:211], v[64:67]
ds_read_b128 v[232:235], v249 offset:51456
v_pk_fma_f16 v196, v197, v197, s48
s_setprio 2
v_bfe_u32 v184, v185, 2, 14
v_pk_mul_f16 v202, v203, v202
v_mfma_f32_16x16x32_f16 v[72:75], v[236:239], v[212:215], v[72:75]
v_bfe_u32 v186, v187, 2, 14
v_pk_mul_f16 v199, v200, v199
s_waitcnt vmcnt(7)
v_mfma_f32_16x16x32_bf16 v[144:147], v[18:21], v[44:47], v[144:147]
ds_read_b128 v[236:239], v248 offset:54528
ds_read_u16_d16 v184, v184
ds_read_u16_d16 v186, v186
v_lshrrev_b32_e64 v185, 18, v185
v_pk_mul_f16 v196, v197, v196
v_mfma_f32_16x16x32_bf16 v[148:151], v[16:19], v[44:47], v[148:151]
v_lshrrev_b32_e64 v187, 18, v187
v_mfma_f32_16x16x32_bf16 v[172:175], v[216:219], v[96:99], 0
ds_read_u16_d16_hi v185, v185
ds_read_u16_d16_hi v187, v187
v_exp_f16 v201, v202
v_and_b32 v189, s49, v189
v_mfma_f32_16x16x32_bf16 v[180:183], v[216:219], v[100:103], 0
v_and_b32 v191, s49, v191
s_waitcnt lgkmcnt(6)
v_mfma_f32_16x16x32_f16 v[68:71], v[220:223], v[208:211], v[68:71]
ds_read_b128 v[216:219], v248 offset:55296
v_exp_f16_e64 v198, v199
v_bfe_u32 v188, v189, 2, 14
v_mfma_f32_16x16x32_f16 v[76:79], v[220:223], v[212:215], v[76:79]
v_bfe_u32 v190, v191, 2, 14
v_exp_f16_e64 v195, v196
v_mfma_f32_16x16x32_bf16 v[168:171], v[224:227], v[104:107], v[168:171]
ds_read_b128 v[220:223], v248 offset:55552
ds_read_u16_d16 v188, v188
ds_read_u16_d16 v190, v190
v_lshrrev_b32 v189, 18, v189
v_lshrrev_b32 v191, 18, v191
v_mfma_f32_16x16x32_bf16 v[176:179], v[224:227], v[108:111], v[176:179]
v_exp_f16_sdwa v201, v202 dst_sel:WORD_1 dst_unused:UNUSED_PRESERVE src0_sel:WORD_1
v_mfma_f32_16x16x32_f16 v[80:83], v[228:231], v[208:211], v[80:83]
ds_read_b128 v[224:227], v249 offset:55296
ds_read_u16_d16_hi v189, v189
ds_read_u16_d16_hi v191, v191
v_and_b32 v193, s49, v193
v_bfe_u32 v192, v193, 2, 14
v_mfma_f32_16x16x32_f16 v[88:91], v[228:231], v[212:215], v[88:91]
v_exp_f16_sdwa v198, v199 dst_sel:WORD_1 dst_unused:UNUSED_PRESERVE src0_sel:WORD_1
s_waitcnt lgkmcnt(7)
v_mfma_f32_16x16x32_f16 v[84:87], v[232:235], v[208:211], v[84:87]
ds_read_b128 v[228:231], v249 offset:55552
ds_read_u16_d16 v192, v192
v_lshrrev_b32_e64 v193, 18, v193
v_mfma_f32_16x16x32_f16 v[92:95], v[232:235], v[212:215], v[92:95]
v_exp_f16_sdwa v195, v196 dst_sel:WORD_1 dst_unused:UNUSED_PRESERVE src0_sel:WORD_1
v_pk_add_f16 v201, v201, 1.0 op_sel_hi:[1,0]
v_pk_add_f16 v198, v198, 1.0 op_sel_hi:[1,0]
v_mfma_f32_16x16x32_bf16 v[172:175], v[236:239], v[104:107], v[172:175]
ds_read_b128 v[232:235], v248 offset:59392
ds_read_u16_d16_hi v193, v193
v_pk_add_f16 v195, v195, 1.0 op_sel_hi:[1,0]
v_mfma_f32_16x16x32_bf16 v[180:183], v[236:239], v[108:111], v[180:183]
v_rcp_f16 v202, v201
s_waitcnt lgkmcnt(7)
v_mfma_f32_16x16x32_bf16 v[168:171], v[216:219], v[112:115], v[168:171]
ds_read_b128 v[236:239], v249 offset:56320
v_rcp_f16_e64 v199, v198
v_mfma_f32_16x16x32_bf16 v[176:179], v[216:219], v[116:119], v[176:179]
v_rcp_f16_e64 v196, v195
v_mfma_f32_16x16x32_bf16 v[172:175], v[220:223], v[112:115], v[172:175]
ds_read_b128 v[216:219], v248 offset:59648
v_rcp_f16_sdwa v202, v201 dst_sel:WORD_1 dst_unused:UNUSED_PRESERVE src0_sel:WORD_1
v_mfma_f32_16x16x32_bf16 v[180:183], v[220:223], v[116:119], v[180:183]
v_rcp_f16_sdwa v199, v198 dst_sel:WORD_1 dst_unused:UNUSED_PRESERVE src0_sel:WORD_1
v_or_b32 v208, v184, v185
v_or_b32 v209, v186, v187
s_waitcnt lgkmcnt(4)
v_or_b32 v210, v188, v189
v_rcp_f16_sdwa v196, v195 dst_sel:WORD_1 dst_unused:UNUSED_PRESERVE src0_sel:WORD_1
v_or_b32 v211, v190, v191
s_waitcnt lgkmcnt(2)
v_or_b32_e64 v212, v192, v193
v_pk_mul_f16 v213, v203, v202
v_pk_mul_f16 v214, v200, v199
v_pk_mul_f16 v215, v197, v196
v_mfma_f32_16x16x32_f16 v[48:51], v[224:227], v[208:211], v[48:51]
s_add_u32 s46, s69, 98304
buffer_load_dwordx4 v[44:47], v252, s[4:7], s46 offen
ds_read_b128 v[220:223], v249 offset:56576
v_cvt_pkrtz_f16_f32 v185, v168, v169
v_cvt_pkrtz_f16_f32 v187, v170, v171
v_mfma_f32_16x16x32_f16 v[56:59], v[224:227], v[212:215], v[56:59]
v_cvt_pkrtz_f16_f32 v189, v172, v173
v_cvt_pkrtz_f16_f32 v191, v174, v175
v_mfma_f32_16x16x32_f16 v[52:55], v[228:231], v[208:211], v[52:55]
ds_read_b128 v[224:227], v248 offset:60416
v_cvt_pkrtz_f16_f32 v193, v176, v177
v_cvt_pk_f16_f32 v203, v178, v179
v_cvt_pk_f16_f32 v200, v180, v181
v_mfma_f32_16x16x32_f16 v[60:63], v[228:231], v[212:215], v[60:63]
v_cvt_pk_f16_f32 v197, v182, v183
s_setprio 1
v_pk_fma_f16 v202, v203, v203, s48
v_mfma_f32_16x16x32_bf16 v[168:171], v[232:235], v[96:99], 0
ds_read_b128 v[228:231], v249 offset:57344
v_and_b32 v185, s49, v185
v_pk_fma_f16 v199, v200, v200, s48
v_mfma_f32_16x16x32_bf16 v[176:179], v[232:235], v[100:103], 0
v_and_b32 v187, s49, v187
v_pk_fma_f16 v196, v197, v197, s48
v_bfe_u32 v184, v185, 2, 14
s_waitcnt lgkmcnt(3)
v_mfma_f32_16x16x32_f16 v[64:67], v[236:239], v[208:211], v[64:67]
ds_read_b128 v[232:235], v249 offset:57600
ds_read_u16_d16 v184, v184
v_pk_mul_f16 v202, v203, v202
v_bfe_u32 v186, v187, 2, 14
v_mfma_f32_16x16x32_f16 v[72:75], v[236:239], v[212:215], v[72:75]
v_pk_mul_f16 v199, v200, v199
v_lshrrev_b32_e64 v185, 18, v185
v_mfma_f32_16x16x32_bf16 v[172:175], v[216:219], v[96:99], 0
ds_read_b128 v[236:239], v248 offset:60672
ds_read_u16_d16 v186, v186
ds_read_u16_d16_hi v185, v185
v_pk_mul_f16 v196, v197, v196
v_lshrrev_b32_e64 v187, 18, v187
v_mfma_f32_16x16x32_bf16 v[180:183], v[216:219], v[100:103], 0
v_exp_f16_e64 v201, v202
v_and_b32 v189, s49, v189
s_waitcnt lgkmcnt(5)
v_mfma_f32_16x16x32_f16 v[68:71], v[220:223], v[208:211], v[68:71]
ds_read_b128 v[216:219], v248 offset:61440
ds_read_u16_d16_hi v187, v187
v_and_b32_e64 v191, s49, v191
v_mfma_f32_16x16x32_f16 v[76:79], v[220:223], v[212:215], v[76:79]
v_exp_f16_e64 v198, v199
v_bfe_u32 v188, v189, 2, 14
v_bfe_u32 v190, v191, 2, 14
v_mfma_f32_16x16x32_bf16 v[168:171], v[224:227], v[104:107], v[168:171]
buffer_store_dwordx4 v[152:155], v255, s[8:11], s68 offen offset:256 sc1
ds_read_b128 v[220:223], v248 offset:61696
ds_read_u16_d16 v188, v188
ds_read_u16_d16 v190, v190
v_exp_f16_e64 v195, v196
v_mfma_f32_16x16x32_bf16 v[176:179], v[224:227], v[108:111], v[176:179]
v_lshrrev_b32 v189, 18, v189
v_lshrrev_b32 v191, 18, v191
v_mfma_f32_16x16x32_f16 v[80:83], v[228:231], v[208:211], v[80:83]
ds_read_b128 v[224:227], v249 offset:61440
ds_read_u16_d16_hi v189, v189
ds_read_u16_d16_hi v191, v191
v_exp_f16_sdwa v201, v202 dst_sel:WORD_1 dst_unused:UNUSED_PRESERVE src0_sel:WORD_1
v_and_b32 v193, s49, v193
v_mfma_f32_16x16x32_f16 v[88:91], v[228:231], v[212:215], v[88:91]
v_bfe_u32 v192, v193, 2, 14
s_waitcnt lgkmcnt(8)
v_mfma_f32_16x16x32_f16 v[84:87], v[232:235], v[208:211], v[84:87]
ds_read_b128 v[228:231], v249 offset:61696
ds_read_u16_d16 v192, v192
v_exp_f16_sdwa v198, v199 dst_sel:WORD_1 dst_unused:UNUSED_PRESERVE src0_sel:WORD_1
v_lshrrev_b32_e64 v193, 18, v193
v_mfma_f32_16x16x32_f16 v[92:95], v[232:235], v[212:215], v[92:95]
v_exp_f16_sdwa v195, v196 dst_sel:WORD_1 dst_unused:UNUSED_PRESERVE src0_sel:WORD_1
v_pk_add_f16 v201, v201, 1.0 op_sel_hi:[1,0]
v_mfma_f32_16x16x32_bf16 v[172:175], v[236:239], v[104:107], v[172:175]
ds_read_b128 v[232:235], v249
ds_read_u16_d16_hi v193, v193
v_pk_add_f16 v198, v198, 1.0 op_sel_hi:[1,0]
v_pk_add_f16 v195, v195, 1.0 op_sel_hi:[1,0]
v_mfma_f32_16x16x32_bf16 v[180:183], v[236:239], v[108:111], v[180:183]
v_rcp_f16_e64 v202, v201
s_setprio 0
s_waitcnt lgkmcnt(7)
v_mfma_f32_16x16x32_bf16 v[168:171], v[216:219], v[112:115], v[168:171]
ds_read_b128 v[236:239], v249 offset:62464
v_rcp_f16_e64 v199, v198
v_mfma_f32_16x16x32_bf16 v[176:179], v[216:219], v[116:119], v[176:179]
v_rcp_f16_e64 v196, v195
v_mfma_f32_16x16x32_bf16 v[172:175], v[220:223], v[112:115], v[172:175]
ds_read_b128 v[216:219], v249 offset:256
v_rcp_f16_sdwa v202, v201 dst_sel:WORD_1 dst_unused:UNUSED_PRESERVE src0_sel:WORD_1
v_mfma_f32_16x16x32_bf16 v[180:183], v[220:223], v[116:119], v[180:183]
v_rcp_f16_sdwa v199, v198 dst_sel:WORD_1 dst_unused:UNUSED_PRESERVE src0_sel:WORD_1
v_or_b32 v208, v184, v185
v_or_b32 v209, v186, v187
s_waitcnt lgkmcnt(4)
v_or_b32 v210, v188, v189
v_rcp_f16_sdwa v196, v195 dst_sel:WORD_1 dst_unused:UNUSED_PRESERVE src0_sel:WORD_1
v_or_b32 v211, v190, v191
s_waitcnt lgkmcnt(2)
v_or_b32_e64 v212, v192, v193
v_pk_mul_f16 v213, v203, v202
v_pk_mul_f16 v214, v200, v199
v_pk_mul_f16 v215, v197, v196
v_mfma_f32_16x16x32_f16 v[48:51], v[224:227], v[208:211], v[48:51]
s_add_u32 s46, s69, 98304
buffer_load_dwordx4 v[40:43], v252, s[4:7], s46 offen offset:64
ds_read_b128 v[220:223], v249 offset:62720
v_cvt_pkrtz_f16_f32 v185, v168, v169
v_cvt_pkrtz_f16_f32 v187, v170, v171
v_mfma_f32_16x16x32_f16 v[56:59], v[224:227], v[212:215], v[56:59]
v_cvt_pkrtz_f16_f32 v189, v172, v173
v_cvt_pkrtz_f16_f32 v191, v174, v175
v_mfma_f32_16x16x32_f16 v[52:55], v[228:231], v[208:211], v[52:55]
ds_read_b128 v[224:227], v249 offset:1024
v_cvt_pkrtz_f16_f32 v193, v176, v177
v_cvt_pk_f16_f32 v203, v178, v179
v_mfma_f32_16x16x32_f16 v[60:63], v[228:231], v[212:215], v[60:63]
v_cvt_pk_f16_f32 v200, v180, v181
v_cvt_pk_f16_f32 v197, v182, v183
v_mfma_f32_16x16x32_bf16 v[168:171], v[232:235], v[96:99], 0
ds_read_b128 v[228:231], v249 offset:63488
v_pk_fma_f16 v202, v203, v203, s48
v_and_b32_e64 v185, s49, v185
v_mfma_f32_16x16x32_bf16 v[176:179], v[232:235], v[100:103], 0
v_pk_fma_f16 v199, v200, v200, s48
v_and_b32 v187, s49, v187
s_waitcnt lgkmcnt(3)
v_mfma_f32_16x16x32_f16 v[64:67], v[236:239], v[208:211], v[64:67]
ds_read_b128 v[232:235], v249 offset:63744
v_pk_fma_f16 v196, v197, v197, s48
v_bfe_u32 v184, v185, 2, 14
v_mfma_f32_16x16x32_f16 v[72:75], v[236:239], v[212:215], v[72:75]
v_pk_mul_f16 v202, v203, v202
v_bfe_u32 v186, v187, 2, 14
s_waitcnt vmcnt(8)
v_mfma_f32_16x16x32_bf16 v[160:163], v[18:21], v[244:247], v[160:163]
ds_read_b128 v[236:239], v249 offset:1280
ds_read_u16_d16 v184, v184
ds_read_u16_d16 v186, v186
v_pk_mul_f16 v199, v200, v199
v_lshrrev_b32 v185, 18, v185
v_mfma_f32_16x16x32_bf16 v[164:167], v[16:19], v[244:247], v[164:167]
v_pk_mul_f16 v196, v197, v196
v_lshrrev_b32_e64 v187, 18, v187
v_mfma_f32_16x16x32_bf16 v[172:175], v[216:219], v[96:99], 0
ds_read_u16_d16_hi v185, v185
ds_read_u16_d16_hi v187, v187
v_exp_f16_e64 v201, v202
v_mfma_f32_16x16x32_bf16 v[180:183], v[216:219], v[100:103], 0
v_and_b32_e64 v189, s49, v189
v_and_b32 v191, s49, v191
s_waitcnt lgkmcnt(6)
v_mfma_f32_16x16x32_f16 v[68:71], v[220:223], v[208:211], v[68:71]
ds_read_b128 v[216:219], v249 offset:2048
v_exp_f16_e64 v198, v199
v_mfma_f32_16x16x32_f16 v[76:79], v[220:223], v[212:215], v[76:79]
v_bfe_u32 v188, v189, 2, 14
v_bfe_u32 v190, v191, 2, 14
v_mfma_f32_16x16x32_bf16 v[168:171], v[224:227], v[104:107], v[168:171]
ds_read_b128 v[220:223], v249 offset:2304
ds_read_u16_d16 v188, v188
ds_read_u16_d16 v190, v190
v_exp_f16_e64 v195, v196
v_mfma_f32_16x16x32_bf16 v[176:179], v[224:227], v[108:111], v[176:179]
v_lshrrev_b32 v189, 18, v189
v_lshrrev_b32 v191, 18, v191
v_mfma_f32_16x16x32_f16 v[80:83], v[228:231], v[208:211], v[80:83]
ds_read_b128 v[224:227], v250 offset:2048
ds_read_u16_d16_hi v189, v189
ds_read_u16_d16_hi v191, v191
v_exp_f16_sdwa v201, v202 dst_sel:WORD_1 dst_unused:UNUSED_PRESERVE src0_sel:WORD_1
v_mfma_f32_16x16x32_f16 v[88:91], v[228:231], v[212:215], v[88:91]
v_and_b32 v193, s49, v193
v_bfe_u32 v192, v193, 2, 14
s_waitcnt lgkmcnt(7)
v_mfma_f32_16x16x32_f16 v[84:87], v[232:235], v[208:211], v[84:87]
ds_read_b128 v[228:231], v250 offset:2304
ds_read_u16_d16 v192, v192
v_exp_f16_sdwa v198, v199 dst_sel:WORD_1 dst_unused:UNUSED_PRESERVE src0_sel:WORD_1
v_mfma_f32_16x16x32_f16 v[92:95], v[232:235], v[212:215], v[92:95]
v_lshrrev_b32 v193, 18, v193
s_waitcnt vmcnt(7)
v_mfma_f32_16x16x32_bf16 v[48:51], v[18:21], v[0:3], v[48:51]
ds_read_b128 v[232:235], v249 offset:6144
ds_read_u16_d16_hi v193, v193
v_exp_f16_sdwa v195, v196 dst_sel:WORD_1 dst_unused:UNUSED_PRESERVE src0_sel:WORD_1
v_pk_add_f16 v201, v201, 1.0 op_sel_hi:[1,0]
v_mfma_f32_16x16x32_bf16 v[52:55], v[16:19], v[0:3], v[52:55]
v_pk_add_f16 v198, v198, 1.0 op_sel_hi:[1,0]
v_pk_add_f16 v195, v195, 1.0 op_sel_hi:[1,0]
v_mfma_f32_16x16x32_bf16 v[172:175], v[236:239], v[104:107], v[172:175]
v_rcp_f16_e64 v202, v201
v_mfma_f32_16x16x32_bf16 v[180:183], v[236:239], v[108:111], v[180:183]
v_rcp_f16 v199, v198
s_waitcnt lgkmcnt(4)
v_mfma_f32_16x16x32_bf16 v[168:171], v[216:219], v[112:115], v[168:171]
ds_read_b128 v[236:239], v250 offset:3072
v_rcp_f16_e64 v196, v195
v_mfma_f32_16x16x32_bf16 v[176:179], v[216:219], v[116:119], v[176:179]
v_rcp_f16_sdwa v202, v201 dst_sel:WORD_1 dst_unused:UNUSED_PRESERVE src0_sel:WORD_1
v_mfma_f32_16x16x32_bf16 v[172:175], v[220:223], v[112:115], v[172:175]
ds_read_b128 v[216:219], v249 offset:6400
v_rcp_f16_sdwa v199, v198 dst_sel:WORD_1 dst_unused:UNUSED_PRESERVE src0_sel:WORD_1
v_mfma_f32_16x16x32_bf16 v[180:183], v[220:223], v[116:119], v[180:183]
v_or_b32 v208, v184, v185
v_or_b32 v209, v186, v187
v_or_b32_e64 v210, v188, v189
v_rcp_f16_sdwa v196, v195 dst_sel:WORD_1 dst_unused:UNUSED_PRESERVE src0_sel:WORD_1
v_or_b32 v211, v190, v191
s_waitcnt lgkmcnt(2)
v_or_b32_e64 v212, v192, v193
v_pk_mul_f16 v213, v203, v202
v_pk_mul_f16 v214, v200, v199
v_pk_mul_f16 v215, v197, v196
v_mfma_f32_16x16x32_f16 v[48:51], v[224:227], v[208:211], v[48:51]
s_add_u32 s46, s69, 98304
buffer_load_dwordx4 v[0:3], v252, s[4:7], s46 offen offset:128
ds_read_b128 v[220:223], v250 offset:3328
v_cvt_pkrtz_f16_f32 v185, v168, v169
v_cvt_pkrtz_f16_f32 v187, v170, v171
v_cvt_pkrtz_f16_f32 v189, v172, v173
v_mfma_f32_16x16x32_f16 v[56:59], v[224:227], v[212:215], v[56:59]
v_cvt_pkrtz_f16_f32 v191, v174, v175
v_cvt_pkrtz_f16_f32 v193, v176, v177
v_cvt_pk_f16_f32 v203, v178, v179
v_mfma_f32_16x16x32_f16 v[52:55], v[228:231], v[208:211], v[52:55]
ds_read_b128 v[224:227], v249 offset:7168
v_cvt_pk_f16_f32 v200, v180, v181
v_cvt_pk_f16_f32 v197, v182, v183
v_pk_fma_f16 v202, v203, v203, s48
v_mfma_f32_16x16x32_f16 v[60:63], v[228:231], v[212:215], v[60:63]
v_cvt_pk_bf16_f32 v144, v144, v145
v_and_b32_e64 v185, s49, v185
v_cvt_pk_bf16_f32 v145, v146, v147
v_mfma_f32_16x16x32_bf16 v[168:171], v[232:235], v[96:99], 0
ds_read_b128 v[228:231], v250 offset:4096
v_pk_fma_f16 v199, v200, v200, s48
v_and_b32 v187, s49, v187
v_cvt_pk_bf16_f32 v146, v148, v149
v_mfma_f32_16x16x32_bf16 v[176:179], v[232:235], v[100:103], 0
v_pk_fma_f16 v196, v197, v197, s48
v_cvt_pk_bf16_f32 v147, v150, v151
v_bfe_u32 v184, v185, 2, 14
s_waitcnt lgkmcnt(2)
v_mfma_f32_16x16x32_f16 v[64:67], v[236:239], v[208:211], v[64:67]
ds_read_b128 v[232:235], v250 offset:4352
ds_read_u16_d16 v184, v184
v_pk_mul_f16 v202, v203, v202
v_cvt_pk_bf16_f32 v128, v128, v129
v_bfe_u32 v186, v187, 2, 14
v_mfma_f32_16x16x32_f16 v[72:75], v[236:239], v[212:215], v[72:75]
v_cvt_pk_bf16_f32 v129, v130, v131
v_pk_mul_f16 v199, v200, v199
v_lshrrev_b32 v185, 18, v185
s_waitcnt vmcnt(6)
v_mfma_f32_16x16x32_bf16 v[64:67], v[18:21], v[204:207], v[64:67]
ds_read_b128 v[236:239], v249 offset:7424
ds_read_u16_d16 v186, v186
ds_read_u16_d16_hi v185, v185
v_cvt_pk_bf16_f32 v130, v132, v133
v_pk_mul_f16 v196, v197, v196
v_lshrrev_b32_e64 v187, 18, v187
v_mfma_f32_16x16x32_bf16 v[68:71], v[16:19], v[204:207], v[68:71]
v_cvt_pk_bf16_f32 v131, v134, v135
v_exp_f16_e64 v201, v202
v_mfma_f32_16x16x32_bf16 v[172:175], v[216:219], v[96:99], 0
ds_read_u16_d16_hi v187, v187
v_cvt_pk_bf16_f32 v160, v160, v161
v_and_b32_e64 v189, s49, v189
v_cvt_pk_bf16_f32 v161, v162, v163
v_mfma_f32_16x16x32_bf16 v[180:183], v[216:219], v[100:103], 0
v_and_b32_e64 v191, s49, v191
v_cvt_pk_bf16_f32 v162, v164, v165
v_mfma_f32_16x16x32_f16 v[68:71], v[220:223], v[208:211], v[68:71]
ds_read_b128 v[216:219], v249 offset:8192
v_exp_f16 v198, v199
v_cvt_pk_bf16_f32 v163, v166, v167
s_mov_b64 vcc, s[74:75]
v_bfe_u32 v188, v189, 2, 14
v_bfe_u32 v190, v191, 2, 14
v_mfma_f32_16x16x32_f16 v[76:79], v[220:223], v[212:215], v[76:79]
v_cndmask_b32 v148, v128, v160, vcc
v_exp_f16_e64 v195, v196
s_waitcnt lgkmcnt(2)
v_mfma_f32_16x16x32_bf16 v[168:171], v[224:227], v[104:107], v[168:171]
ds_read_b128 v[220:223], v249 offset:8448
ds_read_u16_d16 v188, v188
ds_read_u16_d16 v190, v190
v_cndmask_b32 v149, v129, v161, vcc
v_lshrrev_b32_e64 v189, 18, v189
v_cndmask_b32 v150, v130, v162, vcc
v_mfma_f32_16x16x32_bf16 v[176:179], v[224:227], v[108:111], v[176:179]
v_lshrrev_b32 v191, 18, v191
v_cndmask_b32 v151, v131, v163, vcc
v_mfma_f32_16x16x32_f16 v[80:83], v[228:231], v[208:211], v[80:83]
ds_read_b128 v[224:227], v250 offset:8192
ds_read_u16_d16_hi v189, v189
ds_read_u16_d16_hi v191, v191
v_exp_f16_sdwa v201, v202 dst_sel:WORD_1 dst_unused:UNUSED_PRESERVE src0_sel:WORD_1
v_cndmask_b32_dpp v128, v144, v128, vcc quad_perm:[1,0,3,2] row_mask:0xf bank_mask:0xf
v_and_b32_e64 v193, s49, v193
v_mfma_f32_16x16x32_f16 v[88:91], v[228:231], v[212:215], v[88:91]
v_cndmask_b32_dpp v129, v145, v129, vcc quad_perm:[1,0,3,2] row_mask:0xf bank_mask:0xf
v_bfe_u32 v192, v193, 2, 14
v_mfma_f32_16x16x32_f16 v[84:87], v[232:235], v[208:211], v[84:87]
ds_read_b128 v[228:231], v250 offset:8448
ds_read_u16_d16 v192, v192
v_exp_f16_sdwa v198, v199 dst_sel:WORD_1 dst_unused:UNUSED_PRESERVE src0_sel:WORD_1
v_cndmask_b32_dpp v130, v146, v130, vcc quad_perm:[1,0,3,2] row_mask:0xf bank_mask:0xf
v_lshrrev_b32 v193, 18, v193
v_mfma_f32_16x16x32_f16 v[92:95], v[232:235], v[212:215], v[92:95]
v_cndmask_b32_dpp v131, v147, v131, vcc quad_perm:[1,0,3,2] row_mask:0xf bank_mask:0xf
s_not_b64 vcc, s[74:75]
v_exp_f16_sdwa v195, v196 dst_sel:WORD_1 dst_unused:UNUSED_PRESERVE src0_sel:WORD_1
v_mfma_f32_16x16x32_bf16 v[172:175], v[236:239], v[104:107], v[172:175]
ds_read_b128 v[232:235], v249 offset:12288
ds_read_u16_d16_hi v193, v193
v_cndmask_b32_dpp v160, v144, v160, vcc quad_perm:[1,0,3,2] row_mask:0xf bank_mask:0xf
v_pk_add_f16 v201, v201, 1.0 op_sel_hi:[1,0]
v_cndmask_b32_dpp v161, v145, v161, vcc quad_perm:[1,0,3,2] row_mask:0xf bank_mask:0xf
v_mfma_f32_16x16x32_bf16 v[180:183], v[236:239], v[108:111], v[180:183]
v_pk_add_f16 v198, v198, 1.0 op_sel_hi:[1,0]
v_cndmask_b32_dpp v162, v146, v162, vcc quad_perm:[1,0,3,2] row_mask:0xf bank_mask:0xf
v_pk_add_f16 v195, v195, 1.0 op_sel_hi:[1,0]
s_waitcnt lgkmcnt(4)
v_mfma_f32_16x16x32_bf16 v[168:171], v[216:219], v[112:115], v[168:171]
ds_read_b128 v[236:239], v250 offset:9216
v_rcp_f16 v202, v201
v_cndmask_b32_dpp v163, v147, v163, vcc quad_perm:[1,0,3,2] row_mask:0xf bank_mask:0xf
v_mfma_f32_16x16x32_bf16 v[176:179], v[216:219], v[116:119], v[176:179]
v_rcp_f16_e64 v199, v198
v_mfma_f32_16x16x32_bf16 v[172:175], v[220:223], v[112:115], v[172:175]
ds_read_b128 v[216:219], v249 offset:12544
s_add_u32 s46, s68, 98304
buffer_store_dwordx4 v[128:131], v255, s[8:11], s46 offen sc1
v_rcp_f16_e64 v196, v195
v_rcp_f16_sdwa v202, v201 dst_sel:WORD_1 dst_unused:UNUSED_PRESERVE src0_sel:WORD_1
v_mfma_f32_16x16x32_bf16 v[180:183], v[220:223], v[116:119], v[180:183]
v_rcp_f16_sdwa v199, v198 dst_sel:WORD_1 dst_unused:UNUSED_PRESERVE src0_sel:WORD_1
v_or_b32 v208, v184, v185
v_or_b32 v209, v186, v187
v_or_b32_e64 v210, v188, v189
v_rcp_f16_sdwa v196, v195 dst_sel:WORD_1 dst_unused:UNUSED_PRESERVE src0_sel:WORD_1
v_or_b32 v211, v190, v191
s_waitcnt lgkmcnt(2)
v_or_b32_e64 v212, v192, v193
v_pk_mul_f16 v213, v203, v202
v_pk_mul_f16 v214, v200, v199
v_pk_mul_f16 v215, v197, v196
v_mfma_f32_16x16x32_f16 v[48:51], v[224:227], v[208:211], v[48:51]
s_add_u32 s46, s68, 98304
buffer_store_dwordx4 v[148:151], v255, s[8:11], s46 offen offset:128 sc1
ds_read_b128 v[220:223], v250 offset:9472
v_cvt_pkrtz_f16_f32 v185, v168, v169
v_cvt_pkrtz_f16_f32 v187, v170, v171
v_mfma_f32_16x16x32_f16 v[56:59], v[224:227], v[212:215], v[56:59]
v_cvt_pkrtz_f16_f32 v189, v172, v173
v_cvt_pkrtz_f16_f32 v191, v174, v175
v_mfma_f32_16x16x32_f16 v[52:55], v[228:231], v[208:211], v[52:55]
ds_read_b128 v[224:227], v249 offset:13312
v_cvt_pkrtz_f16_f32 v193, v176, v177
v_cvt_pk_f16_f32 v203, v178, v179
v_mfma_f32_16x16x32_f16 v[60:63], v[228:231], v[212:215], v[60:63]
v_cvt_pk_f16_f32 v200, v180, v181
v_cvt_pk_f16_f32 v197, v182, v183
v_mfma_f32_16x16x32_bf16 v[168:171], v[232:235], v[96:99], 0
ds_read_b128 v[228:231], v250 offset:10240
v_pk_fma_f16 v202, v203, v203, s48
v_and_b32_e64 v185, s49, v185
v_mfma_f32_16x16x32_bf16 v[176:179], v[232:235], v[100:103], 0
v_pk_fma_f16 v199, v200, v200, s48
v_and_b32 v187, s49, v187
s_waitcnt lgkmcnt(3)
v_mfma_f32_16x16x32_f16 v[64:67], v[236:239], v[208:211], v[64:67]
ds_read_b128 v[232:235], v250 offset:10496
v_pk_fma_f16 v196, v197, v197, s48
v_bfe_u32 v184, v185, 2, 14
v_pk_mul_f16 v202, v203, v202
v_mfma_f32_16x16x32_f16 v[72:75], v[236:239], v[212:215], v[72:75]
v_bfe_u32 v186, v187, 2, 14
v_pk_mul_f16 v199, v200, v199
s_waitcnt vmcnt(6)
v_mfma_f32_16x16x32_bf16 v[80:83], v[18:21], v[4:7], v[80:83]
ds_read_b128 v[236:239], v249 offset:13568
ds_read_u16_d16 v184, v184
ds_read_u16_d16 v186, v186
v_lshrrev_b32 v185, 18, v185
v_pk_mul_f16 v196, v197, v196
v_mfma_f32_16x16x32_bf16 v[84:87], v[16:19], v[4:7], v[84:87]
v_lshrrev_b32_e64 v187, 18, v187
v_mfma_f32_16x16x32_bf16 v[172:175], v[216:219], v[96:99], 0
ds_read_u16_d16_hi v185, v185
ds_read_u16_d16_hi v187, v187
v_exp_f16 v201, v202
v_and_b32 v189, s49, v189
v_mfma_f32_16x16x32_bf16 v[180:183], v[216:219], v[100:103], 0
v_and_b32 v191, s49, v191
s_waitcnt lgkmcnt(6)
v_mfma_f32_16x16x32_f16 v[68:71], v[220:223], v[208:211], v[68:71]
ds_read_b128 v[216:219], v249 offset:14336
v_exp_f16_e64 v198, v199
v_bfe_u32 v188, v189, 2, 14
v_mfma_f32_16x16x32_f16 v[76:79], v[220:223], v[212:215], v[76:79]
v_bfe_u32 v190, v191, 2, 14
v_exp_f16_e64 v195, v196
v_mfma_f32_16x16x32_bf16 v[168:171], v[224:227], v[104:107], v[168:171]
ds_read_b128 v[220:223], v249 offset:14592
ds_read_u16_d16 v188, v188
ds_read_u16_d16 v190, v190
v_lshrrev_b32 v189, 18, v189
v_lshrrev_b32 v191, 18, v191
v_mfma_f32_16x16x32_bf16 v[176:179], v[224:227], v[108:111], v[176:179]
v_exp_f16_sdwa v201, v202 dst_sel:WORD_1 dst_unused:UNUSED_PRESERVE src0_sel:WORD_1
v_mfma_f32_16x16x32_f16 v[80:83], v[228:231], v[208:211], v[80:83]
ds_read_b128 v[224:227], v250 offset:14336
ds_read_u16_d16_hi v189, v189
ds_read_u16_d16_hi v191, v191
v_and_b32 v193, s49, v193
v_bfe_u32 v192, v193, 2, 14
v_mfma_f32_16x16x32_f16 v[88:91], v[228:231], v[212:215], v[88:91]
v_exp_f16_sdwa v198, v199 dst_sel:WORD_1 dst_unused:UNUSED_PRESERVE src0_sel:WORD_1
s_waitcnt lgkmcnt(7)
v_mfma_f32_16x16x32_f16 v[84:87], v[232:235], v[208:211], v[84:87]
ds_read_b128 v[228:231], v250 offset:14592
ds_read_u16_d16 v192, v192
v_lshrrev_b32_e64 v193, 18, v193
v_mfma_f32_16x16x32_f16 v[92:95], v[232:235], v[212:215], v[92:95]
v_exp_f16_sdwa v195, v196 dst_sel:WORD_1 dst_unused:UNUSED_PRESERVE src0_sel:WORD_1
v_pk_add_f16 v201, v201, 1.0 op_sel_hi:[1,0]
v_pk_add_f16 v198, v198, 1.0 op_sel_hi:[1,0]
v_mfma_f32_16x16x32_bf16 v[172:175], v[236:239], v[104:107], v[172:175]
ds_read_b128 v[232:235], v249 offset:18432
ds_read_u16_d16_hi v193, v193
v_pk_add_f16 v195, v195, 1.0 op_sel_hi:[1,0]
v_mfma_f32_16x16x32_bf16 v[180:183], v[236:239], v[108:111], v[180:183]
v_rcp_f16 v202, v201
s_waitcnt lgkmcnt(7)
v_mfma_f32_16x16x32_bf16 v[168:171], v[216:219], v[112:115], v[168:171]
ds_read_b128 v[236:239], v250 offset:15360
v_rcp_f16_e64 v199, v198
v_mfma_f32_16x16x32_bf16 v[176:179], v[216:219], v[116:119], v[176:179]
v_rcp_f16_e64 v196, v195
v_mfma_f32_16x16x32_bf16 v[172:175], v[220:223], v[112:115], v[172:175]
ds_read_b128 v[216:219], v249 offset:18688
v_rcp_f16_sdwa v202, v201 dst_sel:WORD_1 dst_unused:UNUSED_PRESERVE src0_sel:WORD_1
v_mfma_f32_16x16x32_bf16 v[180:183], v[220:223], v[116:119], v[180:183]
v_rcp_f16_sdwa v199, v198 dst_sel:WORD_1 dst_unused:UNUSED_PRESERVE src0_sel:WORD_1
v_or_b32 v208, v184, v185
v_or_b32 v209, v186, v187
s_waitcnt lgkmcnt(4)
v_or_b32 v210, v188, v189
v_rcp_f16_sdwa v196, v195 dst_sel:WORD_1 dst_unused:UNUSED_PRESERVE src0_sel:WORD_1
v_or_b32 v211, v190, v191
s_waitcnt lgkmcnt(2)
v_or_b32_e64 v212, v192, v193
v_pk_mul_f16 v213, v203, v202
v_pk_mul_f16 v214, v200, v199
v_pk_mul_f16 v215, v197, v196
v_mfma_f32_16x16x32_f16 v[48:51], v[224:227], v[208:211], v[48:51]
ds_read_b128 v[220:223], v250 offset:15616
v_cvt_pkrtz_f16_f32 v185, v168, v169
v_cvt_pkrtz_f16_f32 v187, v170, v171
v_mfma_f32_16x16x32_f16 v[56:59], v[224:227], v[212:215], v[56:59]
v_cvt_pkrtz_f16_f32 v189, v172, v173
v_cvt_pkrtz_f16_f32 v191, v174, v175
v_mfma_f32_16x16x32_f16 v[52:55], v[228:231], v[208:211], v[52:55]
ds_read_b128 v[224:227], v249 offset:19456
v_cvt_pkrtz_f16_f32 v193, v176, v177
v_cvt_pk_f16_f32 v203, v178, v179
v_mfma_f32_16x16x32_f16 v[60:63], v[228:231], v[212:215], v[60:63]
v_cvt_pk_f16_f32 v200, v180, v181
v_cvt_pk_f16_f32 v197, v182, v183
v_mfma_f32_16x16x32_bf16 v[168:171], v[232:235], v[96:99], 0
ds_read_b128 v[228:231], v250 offset:16384
v_pk_fma_f16 v202, v203, v203, s48
v_and_b32_e64 v185, s49, v185
v_mfma_f32_16x16x32_bf16 v[176:179], v[232:235], v[100:103], 0
v_pk_fma_f16 v199, v200, v200, s48
v_and_b32 v187, s49, v187
s_waitcnt lgkmcnt(3)
v_mfma_f32_16x16x32_f16 v[64:67], v[236:239], v[208:211], v[64:67]
ds_read_b128 v[232:235], v250 offset:16640
v_pk_fma_f16 v196, v197, v197, s48
v_bfe_u32 v184, v185, 2, 14
v_pk_mul_f16 v202, v203, v202
v_mfma_f32_16x16x32_f16 v[72:75], v[236:239], v[212:215], v[72:75]
v_bfe_u32 v186, v187, 2, 14
v_pk_mul_f16 v199, v200, v199
s_waitcnt vmcnt(5)
v_mfma_f32_16x16x32_bf16 v[56:59], v[18:21], v[44:47], v[56:59]
ds_read_b128 v[236:239], v249 offset:19712
ds_read_u16_d16 v184, v184
ds_read_u16_d16 v186, v186
v_lshrrev_b32 v185, 18, v185
v_pk_mul_f16 v196, v197, v196
v_mfma_f32_16x16x32_bf16 v[60:63], v[16:19], v[44:47], v[60:63]
v_lshrrev_b32_e64 v187, 18, v187
v_mfma_f32_16x16x32_bf16 v[172:175], v[216:219], v[96:99], 0
ds_read_u16_d16_hi v185, v185
ds_read_u16_d16_hi v187, v187
v_exp_f16 v201, v202
v_and_b32 v189, s49, v189
v_mfma_f32_16x16x32_bf16 v[180:183], v[216:219], v[100:103], 0
v_and_b32 v191, s49, v191
s_waitcnt lgkmcnt(6)
v_mfma_f32_16x16x32_f16 v[68:71], v[220:223], v[208:211], v[68:71]
ds_read_b128 v[216:219], v249 offset:20480
v_exp_f16_e64 v198, v199
v_bfe_u32 v188, v189, 2, 14
v_mfma_f32_16x16x32_f16 v[76:79], v[220:223], v[212:215], v[76:79]
v_bfe_u32 v190, v191, 2, 14
v_exp_f16_e64 v195, v196
v_mfma_f32_16x16x32_bf16 v[168:171], v[224:227], v[104:107], v[168:171]
ds_read_b128 v[220:223], v249 offset:20736
ds_read_u16_d16 v188, v188
ds_read_u16_d16 v190, v190
v_lshrrev_b32 v189, 18, v189
v_lshrrev_b32 v191, 18, v191
v_mfma_f32_16x16x32_bf16 v[176:179], v[224:227], v[108:111], v[176:179]
v_exp_f16_sdwa v201, v202 dst_sel:WORD_1 dst_unused:UNUSED_PRESERVE src0_sel:WORD_1
v_mfma_f32_16x16x32_f16 v[80:83], v[228:231], v[208:211], v[80:83]
ds_read_b128 v[224:227], v250 offset:20480
ds_read_u16_d16_hi v189, v189
ds_read_u16_d16_hi v191, v191
v_and_b32 v193, s49, v193
v_bfe_u32 v192, v193, 2, 14
v_mfma_f32_16x16x32_f16 v[88:91], v[228:231], v[212:215], v[88:91]
v_exp_f16_sdwa v198, v199 dst_sel:WORD_1 dst_unused:UNUSED_PRESERVE src0_sel:WORD_1
s_waitcnt lgkmcnt(7)
v_mfma_f32_16x16x32_f16 v[84:87], v[232:235], v[208:211], v[84:87]
ds_read_b128 v[228:231], v250 offset:20736
ds_read_u16_d16 v192, v192
v_lshrrev_b32_e64 v193, 18, v193
v_mfma_f32_16x16x32_f16 v[92:95], v[232:235], v[212:215], v[92:95]
v_exp_f16_sdwa v195, v196 dst_sel:WORD_1 dst_unused:UNUSED_PRESERVE src0_sel:WORD_1
v_pk_add_f16 v201, v201, 1.0 op_sel_hi:[1,0]
v_pk_add_f16 v198, v198, 1.0 op_sel_hi:[1,0]
v_mfma_f32_16x16x32_bf16 v[172:175], v[236:239], v[104:107], v[172:175]
ds_read_b128 v[232:235], v250 offset:21504
ds_read_u16_d16_hi v193, v193
v_pk_add_f16 v195, v195, 1.0 op_sel_hi:[1,0]
v_mfma_f32_16x16x32_bf16 v[180:183], v[236:239], v[108:111], v[180:183]
v_rcp_f16 v202, v201
s_waitcnt lgkmcnt(7)
v_mfma_f32_16x16x32_bf16 v[168:171], v[216:219], v[112:115], v[168:171]
ds_read_b128 v[236:239], v250 offset:21760
v_rcp_f16_e64 v199, v198
v_mfma_f32_16x16x32_bf16 v[176:179], v[216:219], v[116:119], v[176:179]
v_rcp_f16_e64 v196, v195
v_mfma_f32_16x16x32_bf16 v[172:175], v[220:223], v[112:115], v[172:175]
ds_read_b128 v[216:219], v250 offset:22528
v_rcp_f16_sdwa v202, v201 dst_sel:WORD_1 dst_unused:UNUSED_PRESERVE src0_sel:WORD_1
v_mfma_f32_16x16x32_bf16 v[180:183], v[220:223], v[116:119], v[180:183]
v_rcp_f16_sdwa v199, v198 dst_sel:WORD_1 dst_unused:UNUSED_PRESERVE src0_sel:WORD_1
v_or_b32 v208, v184, v185
v_or_b32 v209, v186, v187
s_waitcnt lgkmcnt(4)
v_or_b32 v210, v188, v189
v_rcp_f16_sdwa v196, v195 dst_sel:WORD_1 dst_unused:UNUSED_PRESERVE src0_sel:WORD_1
v_or_b32 v211, v190, v191
s_waitcnt lgkmcnt(2)
v_or_b32_e64 v212, v192, v193
v_pk_mul_f16 v213, v203, v202
v_pk_mul_f16 v214, v200, v199
v_pk_mul_f16 v215, v197, v196
v_mfma_f32_16x16x32_f16 v[48:51], v[224:227], v[208:211], v[48:51]
s_add_u32 s46, s68, 98304
buffer_store_dwordx4 v[160:163], v255, s[8:11], s46 offen offset:256 sc1
ds_read_b128 v[220:223], v250 offset:22784
v_cvt_pkrtz_f16_f32 v185, v168, v169
v_cvt_pkrtz_f16_f32 v187, v170, v171
v_cvt_pkrtz_f16_f32 v189, v172, v173
v_cvt_pkrtz_f16_f32 v191, v174, v175
v_mfma_f32_16x16x32_f16 v[56:59], v[224:227], v[212:215], v[56:59]
v_cvt_pkrtz_f16_f32 v193, v176, v177
v_cvt_pk_f16_f32 v203, v178, v179
v_cvt_pk_f16_f32 v200, v180, v181
v_cvt_pk_f16_f32 v197, v182, v183
v_mfma_f32_16x16x32_f16 v[52:55], v[228:231], v[208:211], v[52:55]
ds_read_b128 v[224:227], v250 offset:26624
v_pk_fma_f16 v202, v203, v203, s48
v_and_b32_e64 v185, s49, v185
v_pk_fma_f16 v199, v200, v200, s48
v_and_b32_e64 v187, s49, v187
v_mfma_f32_16x16x32_f16 v[60:63], v[228:231], v[212:215], v[60:63]
v_pk_fma_f16 v196, v197, v197, s48
v_bfe_u32 v184, v185, 2, 14
v_pk_mul_f16 v202, v203, v202
v_bfe_u32 v186, v187, 2, 14
v_mfma_f32_16x16x32_f16 v[64:67], v[232:235], v[208:211], v[64:67]
ds_read_b128 v[228:231], v250 offset:26880
ds_read_u16_d16 v184, v184
ds_read_u16_d16 v186, v186
v_pk_mul_f16 v199, v200, v199
v_lshrrev_b32_e64 v185, 18, v185
v_pk_mul_f16 v196, v197, v196
v_lshrrev_b32_e64 v187, 18, v187
v_mfma_f32_16x16x32_f16 v[72:75], v[232:235], v[212:215], v[72:75]
v_exp_f16 v201, v202
v_and_b32 v189, s49, v189
v_and_b32 v191, s49, v191
s_waitcnt vmcnt(4)
v_mfma_f32_16x16x32_bf16 v[72:75], v[18:21], v[40:43], v[72:75]
ds_read_b128 v[232:235], v250 offset:27648
ds_read_u16_d16_hi v185, v185
ds_read_u16_d16_hi v187, v187
v_exp_f16_e64 v198, v199
v_bfe_u32 v188, v189, 2, 14
v_bfe_u32 v190, v191, 2, 14
v_mfma_f32_16x16x32_bf16 v[76:79], v[16:19], v[40:43], v[76:79]
v_exp_f16 v195, v196
v_lshrrev_b32 v189, 18, v189
v_lshrrev_b32 v191, 18, v191
s_waitcnt lgkmcnt(6)
v_mfma_f32_16x16x32_f16 v[68:71], v[236:239], v[208:211], v[68:71]
ds_read_u16_d16 v188, v188
ds_read_u16_d16 v190, v190
ds_read_u16_d16_hi v189, v189
ds_read_u16_d16_hi v191, v191
v_exp_f16_sdwa v201, v202 dst_sel:WORD_1 dst_unused:UNUSED_PRESERVE src0_sel:WORD_1
v_and_b32_e64 v193, s49, v193
v_bfe_u32 v192, v193, 2, 14
v_mfma_f32_16x16x32_f16 v[76:79], v[236:239], v[212:215], v[76:79]
v_exp_f16_sdwa v198, v199 dst_sel:WORD_1 dst_unused:UNUSED_PRESERVE src0_sel:WORD_1
v_lshrrev_b32_e64 v193, 18, v193
v_mfma_f32_16x16x32_f16 v[80:83], v[216:219], v[208:211], v[80:83]
ds_read_b128 v[236:239], v250 offset:27904
ds_read_u16_d16 v192, v192
ds_read_u16_d16_hi v193, v193
v_exp_f16_sdwa v195, v196 dst_sel:WORD_1 dst_unused:UNUSED_PRESERVE src0_sel:WORD_1
v_pk_add_f16 v201, v201, 1.0 op_sel_hi:[1,0]
v_pk_add_f16 v198, v198, 1.0 op_sel_hi:[1,0]
v_pk_add_f16 v195, v195, 1.0 op_sel_hi:[1,0]
v_mfma_f32_16x16x32_f16 v[88:91], v[216:219], v[212:215], v[88:91]
v_rcp_f16 v202, v201
v_rcp_f16 v199, v198
v_mfma_f32_16x16x32_f16 v[84:87], v[220:223], v[208:211], v[84:87]
ds_read_b128 v[216:219], v250 offset:28672
v_rcp_f16_e64 v196, v195
v_rcp_f16_sdwa v202, v201 dst_sel:WORD_1 dst_unused:UNUSED_PRESERVE src0_sel:WORD_1
v_mfma_f32_16x16x32_f16 v[92:95], v[220:223], v[212:215], v[92:95]
v_rcp_f16_sdwa v199, v198 dst_sel:WORD_1 dst_unused:UNUSED_PRESERVE src0_sel:WORD_1
s_waitcnt lgkmcnt(5)
v_or_b32 v208, v184, v185
v_or_b32_e64 v209, v186, v187
v_or_b32 v210, v188, v189
v_rcp_f16_sdwa v196, v195 dst_sel:WORD_1 dst_unused:UNUSED_PRESERVE src0_sel:WORD_1
s_waitcnt lgkmcnt(4)
v_or_b32 v211, v190, v191
s_waitcnt lgkmcnt(1)
v_or_b32 v212, v192, v193
v_pk_mul_f16 v213, v203, v202
v_pk_mul_f16 v214, v200, v199
v_pk_mul_f16 v215, v197, v196
v_mfma_f32_16x16x32_f16 v[48:51], v[224:227], v[208:211], v[48:51]
ds_read_b128 v[220:223], v250 offset:28928
v_mfma_f32_16x16x32_f16 v[56:59], v[224:227], v[212:215], v[56:59]
v_mfma_f32_16x16x32_f16 v[52:55], v[228:231], v[208:211], v[52:55]
v_mfma_f32_16x16x32_f16 v[60:63], v[228:231], v[212:215], v[60:63]
v_mfma_f32_16x16x32_f16 v[64:67], v[232:235], v[208:211], v[64:67]
v_mfma_f32_16x16x32_f16 v[72:75], v[232:235], v[212:215], v[72:75]
s_waitcnt vmcnt(3)
v_mfma_f32_16x16x32_bf16 v[88:91], v[18:21], v[0:3], v[88:91]
v_mfma_f32_16x16x32_bf16 v[92:95], v[16:19], v[0:3], v[92:95]
v_mfma_f32_16x16x32_f16 v[68:71], v[236:239], v[208:211], v[68:71]
v_mfma_f32_16x16x32_f16 v[76:79], v[236:239], v[212:215], v[76:79]
s_waitcnt lgkmcnt(1)
v_mfma_f32_16x16x32_f16 v[80:83], v[216:219], v[208:211], v[80:83]
v_mfma_f32_16x16x32_f16 v[88:91], v[216:219], v[212:215], v[88:91]
s_waitcnt lgkmcnt(0)
v_mfma_f32_16x16x32_f16 v[84:87], v[220:223], v[208:211], v[84:87]
v_mfma_f32_16x16x32_f16 v[92:95], v[220:223], v[212:215], v[92:95]
v_cvt_pk_bf16_f32 v64, v64, v65
v_cvt_pk_bf16_f32 v65, v66, v67
v_cvt_pk_bf16_f32 v66, v68, v69
v_cvt_pk_bf16_f32 v67, v70, v71
v_cvt_pk_bf16_f32 v48, v48, v49
v_cvt_pk_bf16_f32 v49, v50, v51
v_cvt_pk_bf16_f32 v50, v52, v53
v_cvt_pk_bf16_f32 v51, v54, v55
v_cvt_pk_bf16_f32 v80, v80, v81
v_cvt_pk_bf16_f32 v81, v82, v83
v_cvt_pk_bf16_f32 v82, v84, v85
v_cvt_pk_bf16_f32 v83, v86, v87
s_mov_b64 vcc, s[74:75]
v_cndmask_b32 v68, v48, v80, vcc
v_cndmask_b32 v69, v49, v81, vcc
v_cndmask_b32 v70, v50, v82, vcc
v_cndmask_b32 v71, v51, v83, vcc
v_cndmask_b32_dpp v48, v64, v48, vcc quad_perm:[1,0,3,2] row_mask:0xf bank_mask:0xf
v_cndmask_b32_dpp v49, v65, v49, vcc quad_perm:[1,0,3,2] row_mask:0xf bank_mask:0xf
v_cndmask_b32_dpp v50, v66, v50, vcc quad_perm:[1,0,3,2] row_mask:0xf bank_mask:0xf
v_cndmask_b32_dpp v51, v67, v51, vcc quad_perm:[1,0,3,2] row_mask:0xf bank_mask:0xf
s_not_b64 vcc, s[74:75]
v_cndmask_b32_dpp v80, v64, v80, vcc quad_perm:[1,0,3,2] row_mask:0xf bank_mask:0xf
v_cndmask_b32_dpp v81, v65, v81, vcc quad_perm:[1,0,3,2] row_mask:0xf bank_mask:0xf
v_cndmask_b32_dpp v82, v66, v82, vcc quad_perm:[1,0,3,2] row_mask:0xf bank_mask:0xf
v_cndmask_b32_dpp v83, v67, v83, vcc quad_perm:[1,0,3,2] row_mask:0xf bank_mask:0xf
buffer_store_dwordx4 v[48:51], v255, s[8:11], s69 offen sc1
buffer_store_dwordx4 v[68:71], v255, s[8:11], s69 offen offset:128 sc1
buffer_store_dwordx4 v[80:83], v255, s[8:11], s69 offen offset:256 sc1
v_cvt_pk_bf16_f32 v72, v72, v73
v_cvt_pk_bf16_f32 v73, v74, v75
v_cvt_pk_bf16_f32 v74, v76, v77
v_cvt_pk_bf16_f32 v75, v78, v79
v_cvt_pk_bf16_f32 v56, v56, v57
v_cvt_pk_bf16_f32 v57, v58, v59
v_cvt_pk_bf16_f32 v58, v60, v61
v_cvt_pk_bf16_f32 v59, v62, v63
v_cvt_pk_bf16_f32 v88, v88, v89
v_cvt_pk_bf16_f32 v89, v90, v91
v_cvt_pk_bf16_f32 v90, v92, v93
v_cvt_pk_bf16_f32 v91, v94, v95
s_mov_b64 vcc, s[74:75]
v_cndmask_b32 v76, v56, v88, vcc
v_cndmask_b32 v77, v57, v89, vcc
v_cndmask_b32 v78, v58, v90, vcc
v_cndmask_b32 v79, v59, v91, vcc
v_cndmask_b32_dpp v56, v72, v56, vcc quad_perm:[1,0,3,2] row_mask:0xf bank_mask:0xf
v_cndmask_b32_dpp v57, v73, v57, vcc quad_perm:[1,0,3,2] row_mask:0xf bank_mask:0xf
v_cndmask_b32_dpp v58, v74, v58, vcc quad_perm:[1,0,3,2] row_mask:0xf bank_mask:0xf
v_cndmask_b32_dpp v59, v75, v59, vcc quad_perm:[1,0,3,2] row_mask:0xf bank_mask:0xf
s_not_b64 vcc, s[74:75]
v_cndmask_b32_dpp v88, v72, v88, vcc quad_perm:[1,0,3,2] row_mask:0xf bank_mask:0xf
v_cndmask_b32_dpp v89, v73, v89, vcc quad_perm:[1,0,3,2] row_mask:0xf bank_mask:0xf
v_cndmask_b32_dpp v90, v74, v90, vcc quad_perm:[1,0,3,2] row_mask:0xf bank_mask:0xf
v_cndmask_b32_dpp v91, v75, v91, vcc quad_perm:[1,0,3,2] row_mask:0xf bank_mask:0xf
s_add_u32 s46, s69, 98304
buffer_store_dwordx4 v[56:59], v255, s[8:11], s46 offen sc1
s_add_u32 s46, s69, 98304
buffer_store_dwordx4 v[76:79], v255, s[8:11], s46 offen offset:128 sc1
s_add_u32 s46, s69, 98304
buffer_store_dwordx4 v[88:91], v255, s[8:11], s46 offen offset:256 sc1
s_endpgm
Lpoll:
s_waitcnt vmcnt(0)
s_cmp_eq_u32 s77, 2
s_cbranch_scc1 LpollC
v_max_u32 v255, v156, v157
v_max3_u32 v255, v255, v158, v159
v_max3_u32 v255, v255, v160, v161
v_max3_u32 v255, v255, v162, v163
v_max3_u32 v255, v255, v164, v165
v_max3_u32 v255, v255, v166, v167
v_max3_u32 v255, v255, v240, v241
v_max3_u32 v255, v255, v242, v243
v_cmp_eq_u32 vcc, -1, v255
s_nop 4
s_cbranch_vccz LpollR
v_lshlrev_b32 v247, 4, v251
s_lshl_b32 s44, s2, 12
buffer_load_dwordx4 v[156:159], v247, s[32:35], s44 offen sc1
buffer_load_dwordx4 v[160:163], v247, s[32:35], s44 offen offset:1024 sc1
buffer_load_dwordx4 v[164:167], v247, s[32:35], s44 offen offset:2048 sc1
buffer_load_dwordx4 v[240:243], v247, s[32:35], s44 offen offset:3072 sc1
s_setpc_b64 s[78:79]
LpollR:
s_setprio 3
v_add_f32 v156, v156, v160
v_add_f32 v240, v164, v240
v_add_f32 v240, v156, v240
v_add_f32 v157, v157, v161
v_add_f32 v241, v165, v241
v_add_f32 v241, v157, v241
v_add_f32 v158, v158, v162
v_add_f32 v242, v166, v242
v_add_f32 v242, v158, v242
v_add_f32 v159, v159, v163
v_add_f32 v243, v167, v243
v_add_f32 v243, v159, v243
v_add_f32_dpp v240, v240, v240 row_ror:8 row_mask:0xf bank_mask:0xf
s_nop 1
v_add_f32_dpp v240, v240, v240 row_ror:4 row_mask:0xf bank_mask:0xf
s_nop 1
v_add_f32_dpp v240, v240, v240 row_ror:2 row_mask:0xf bank_mask:0xf
s_nop 1
v_add_f32_dpp v240, v240, v240 row_ror:1 row_mask:0xf bank_mask:0xf
v_mov_b32 v255, v240
s_nop 1
v_permlane16_swap_b32 v240, v255
v_add_f32 v240, v240, v255
v_mov_b32 v255, v240
s_nop 1
v_permlane32_swap_b32 v240, v255
v_add_f32 v240, v240, v255
v_min_u32 v240, -2, v240
v_add_f32_dpp v241, v241, v241 row_ror:8 row_mask:0xf bank_mask:0xf
s_nop 1
v_add_f32_dpp v241, v241, v241 row_ror:4 row_mask:0xf bank_mask:0xf
s_nop 1
v_add_f32_dpp v241, v241, v241 row_ror:2 row_mask:0xf bank_mask:0xf
s_nop 1
v_add_f32_dpp v241, v241, v241 row_ror:1 row_mask:0xf bank_mask:0xf
v_mov_b32 v255, v241
s_nop 1
v_permlane16_swap_b32 v241, v255
v_add_f32 v241, v241, v255
v_mov_b32 v255, v241
s_nop 1
v_permlane32_swap_b32 v241, v255
v_add_f32 v241, v241, v255
v_min_u32 v241, -2, v241
v_add_f32_dpp v242, v242, v242 row_ror:8 row_mask:0xf bank_mask:0xf
s_nop 1
v_add_f32_dpp v242, v242, v242 row_ror:4 row_mask:0xf bank_mask:0xf
s_nop 1
v_add_f32_dpp v242, v242, v242 row_ror:2 row_mask:0xf bank_mask:0xf
s_nop 1
v_add_f32_dpp v242, v242, v242 row_ror:1 row_mask:0xf bank_mask:0xf
v_mov_b32 v255, v242
s_nop 1
v_permlane16_swap_b32 v242, v255
v_add_f32 v242, v242, v255
v_mov_b32 v255, v242
s_nop 1
v_permlane32_swap_b32 v242, v255
v_add_f32 v242, v242, v255
v_min_u32 v242, -2, v242
v_add_f32_dpp v243, v243, v243 row_ror:8 row_mask:0xf bank_mask:0xf
s_nop 1
v_add_f32_dpp v243, v243, v243 row_ror:4 row_mask:0xf bank_mask:0xf
s_nop 1
v_add_f32_dpp v243, v243, v243 row_ror:2 row_mask:0xf bank_mask:0xf
s_nop 1
v_add_f32_dpp v243, v243, v243 row_ror:1 row_mask:0xf bank_mask:0xf
v_mov_b32 v255, v243
s_nop 1
v_permlane16_swap_b32 v243, v255
v_add_f32 v243, v243, v255
v_mov_b32 v255, v243
s_nop 1
v_permlane32_swap_b32 v243, v255
v_add_f32_e64 v243, v243, v255
v_min_u32 v243, -2, v243
s_lshl_b32 s44, s2, 4
s_add_u32 s44, s44, 393216
v_lshlrev_b32_e64 v255, 11, v251
s_mov_b64 exec, 0xff
buffer_store_dwordx4 v[240:243], v255, s[32:35], s44 offen sc1
s_mov_b64 exec, -1
s_mov_b32 s77, 2
v_lshlrev_b32_e64 v247, 3, v251
s_and_b32 s44, s2, 7
s_lshl_b32 s44, s44, 11
s_add_u32 s44, s44, 393216
buffer_load_dwordx2 v[156:157], v247, s[32:35], s44 offen sc1
buffer_load_dwordx2 v[158:159], v247, s[32:35], s44 offen offset:512 sc1
buffer_load_dwordx2 v[160:161], v247, s[32:35], s44 offen offset:1024 sc1
s_setpc_b64 s[78:79]
LpollC:
v_max3_u32 v255, v156, v157, v158
v_max3_u32 v255, v255, v159, v160
v_max_u32 v255, v255, v161
v_cmp_eq_u32 vcc, -1, v255
s_nop 4
s_cbranch_vccz LpollS
v_lshlrev_b32 v247, 3, v251
s_and_b32 s44, s2, 7
s_lshl_b32 s44, s44, 11
s_add_u32 s44, s44, 393216
buffer_load_dwordx2 v[156:157], v247, s[32:35], s44 offen sc1
buffer_load_dwordx2 v[158:159], v247, s[32:35], s44 offen offset:512 sc1
buffer_load_dwordx2 v[160:161], v247, s[32:35], s44 offen offset:1024 sc1
s_setpc_b64 s[78:79]
LpollS:
s_setprio 3
s_mov_b32 s43, 1083296634
v_mov_b32 v162, 897988541
v_fma_f32 v156, v156, s43, v162
v_fma_f32 v157, v157, s43, v162
v_fma_f32 v158, v158, s43, v162
v_fma_f32 v159, v159, s43, v162
v_fma_f32 v160, v160, s43, v162
v_fma_f32 v161, v161, s43, v162
v_sqrt_f32 v156, v156
v_sqrt_f32 v157, v157
v_sqrt_f32 v158, v158
v_sqrt_f32 v159, v159
v_sqrt_f32 v160, v160
v_sqrt_f32 v161, v161
v_add_f32 v163, v156, v157
v_add_f32 v163, v163, v158
v_add_f32 v163, v163, v159
v_add_f32 v163, v163, v160
v_add_f32 v163, v163, v161
s_nop 1
v_add_f32_dpp v163, v163, v163 row_ror:8 row_mask:0xf bank_mask:0xf
s_nop 1
v_add_f32_dpp v163, v163, v163 row_ror:4 row_mask:0xf bank_mask:0xf
s_nop 1
v_add_f32_dpp v163, v163, v163 row_ror:2 row_mask:0xf bank_mask:0xf
s_nop 1
v_add_f32_dpp v163, v163, v163 row_ror:1 row_mask:0xf bank_mask:0xf
v_mov_b32 v255, v163
s_nop 1
v_permlane16_swap_b32 v163, v255
v_add_f32 v163, v163, v255
v_mov_b32 v255, v163
s_nop 1
v_permlane32_swap_b32 v163, v255
v_add_f32_e64 v163, v163, v255
s_mov_b32 s43, 992651947
v_fma_f32 v163, v163, s43, v162
v_rcp_f32_e64 v163, v163
v_mov_b32 v162, 3221789604
v_mul_f32 v163, v163, v162
v_lshlrev_b32 v164, 16, v244
v_and_b32 v165, 4294901760, v244
v_mul_f32 v156, v156, v163
v_mul_f32 v157, v157, v163
v_fma_f32 v164, v164, v156, v162
v_fma_f32 v165, v165, v157, v162
v_cvt_pk_f16_f32 v244, v164, v165
v_lshlrev_b32_e64 v164, 16, v245
v_and_b32 v165, 4294901760, v245
v_mul_f32 v158, v158, v163
v_mul_f32 v159, v159, v163
v_fma_f32 v164, v164, v158, v162
v_fma_f32 v165, v165, v159, v162
v_cvt_pk_f16_f32 v245, v164, v165
v_lshlrev_b32_e64 v164, 16, v246
v_and_b32 v165, 4294901760, v246
v_mul_f32 v160, v160, v163
v_mul_f32 v161, v161, v163
v_fma_f32 v164, v164, v160, v162
v_fma_f32 v165, v165, v161, v162
v_cvt_pk_f16_f32 v246, v164, v165
s_mov_b32 s77, 0
s_setpc_b64 s[78:79]
Lend:
s_endpgm

.section .rodata,"a"
.p2align 6
.amdhsa_kernel standalone__modern_conv_block_convnext_v2__vision_kernel
  .amdhsa_next_free_vgpr 256
  .amdhsa_next_free_sgpr 102
  .amdhsa_accum_offset 256
  .amdhsa_group_segment_fixed_size 0
  .amdhsa_kernarg_size 72
  .amdhsa_user_sgpr_count 2
  .amdhsa_user_sgpr_kernarg_segment_ptr 1
  .amdhsa_system_sgpr_workgroup_id_x 1
.end_amdhsa_kernel
```

```asm
; @launch grid=(256,1,1) block=(512,1,1) lds=163840
.amdgcn_target "amdgcn-amd-amdhsa--gfx950"
.text
.globl standalone__modern_conv_block_convnext_v2__vision_kernel
.p2align 8
.type standalone__modern_conv_block_convnext_v2__vision_kernel,@function
standalone__modern_conv_block_convnext_v2__vision_kernel:
Lmain:
s_cmp_ge_u32 s2, 256
s_cbranch_scc1 Lend
s_load_dwordx16 s[80:95], s[0:1], 0
s_load_dwordx2 s[96:97], s[0:1], 64
s_getpc_b64 s[74:75]
Lpc0:
s_sub_u32 s74, s74, Lpc0-Lmain
s_subb_u32 s75, s75, 0
v_lshlrev_b32 v159, 7, v0
s_movk_i32 s43, 64
v_cmp_gt_u32 vcc, s43, v0
s_and_saveexec_b64 s[78:79], vcc
s_cbranch_execz Lpf0x
global_load_dword v255, v159, s[74:75]
Lpf0x:
s_mov_b64 exec, s[78:79]
v_mov_b32 v199, v0
v_and_b32 v251, 63, v0
v_lshrrev_b32 v120, 6, v0
s_nop 0
v_readfirstlane_b32 s40, v120
s_and_b32 s43, s2, 7
s_lshr_b32 s44, s2, 3
s_and_b32 s41, s43, 0
s_lshl_b32 s41, s41, 4
s_and_b32 s45, s44, 15
s_add_u32 s41, s41, s45
s_lshr_b32 s42, s43, 0
s_lshl_b32 s42, s42, 1
s_lshr_b32 s45, s44, 4
s_add_u32 s42, s42, s45
s_lshl_b32 s41, s41, 5
s_lshl_b32 s42, s42, 5
s_lshl_b32 s67, s40, 6
s_cmp_eq_u32 s40, 6
s_cselect_b32 s67, 352, s67
v_add_u32_e64 v125, s67, v251
v_mul_u32_u24 v121, 5462, v125
v_lshrrev_b32 v121, 16, v121
v_mul_u32_u24 v122, 12, v121
v_sub_u32 v122, v125, v122
v_bfe_u32 v123, v121, 2, 2
v_xor_b32 v122, v122, v123
v_add_u32 v123, s41, v121
v_subrev_u32 v123, 1, v123
v_mul_u32_u24 v124, 192, v123
v_lshl_add_u32 v124, v122, 4, v124
v_mov_b32 v240, 2147483648
s_movk_i32 s43, 512
v_cmp_gt_u32 vcc, s43, v123
s_nop 1
v_cndmask_b32 v124, v240, v124, vcc
v_cmp_gt_u32 vcc, 34, v121
s_nop 1
v_cndmask_b32 v240, v240, v124, vcc
s_add_i32 s43, s42, -1
s_mul_i32 s44, s43, 98304
s_cmp_lt_u32 s43, 512
s_cselect_b32 s46, s44, 1073741824
s_mul_i32 s66, s42, 98304
s_mov_b32 s6, 50331648
s_mov_b32 s7, 131072
s_lshl_b32 s67, s67, 4
s_add_u32 s67, s67, 90112
s_cmp_eq_u32 s40, 7
s_cselect_b32 s67, 163840, s67
v_lshlrev_b32 v130, 1, v199
v_add_u32 v155, 768, v199
v_min_u32 v155, 863, v155
v_lshlrev_b32_e64 v131, 1, v155
s_waitcnt lgkmcnt(0)
s_mov_b32 s4, s80
s_and_b32 s5, s81, 65535
s_cmp_ge_u32 s40, 4
s_cbranch_scc1 Lnodw
s_mov_b32 s20, s82
s_and_b32 s21, s83, 65535
s_mov_b32 s22, 1728
s_mov_b32 s23, 131072
buffer_load_ushort v126, v130, s[20:23], 0 offen offset:0
buffer_load_ushort v127, v130, s[20:23], 0 offen offset:512
buffer_load_ushort v128, v130, s[20:23], 0 offen offset:1024
buffer_load_ushort v129, v131, s[20:23], 0 offen offset:0
Lnodw:
s_cmp_eq_u32 s40, 7
s_cbranch_scc1 Lskipx0
s_add_u32 m0, s67, 0
s_nop 0
buffer_load_dwordx4 v240, s[4:7], s46 offen nt lds
s_add_u32 m0, s67, 6656
s_nop 0
buffer_load_dwordx4 v240, s[4:7], s66 offen nt lds
s_add_u32 m0, s67, 13312
s_add_u32 s45, s66, 98304
buffer_load_dwordx4 v240, s[4:7], s45 offen nt lds
s_add_u32 m0, s67, 19968
s_add_u32 s45, s66, 196608
buffer_load_dwordx4 v240, s[4:7], s45 offen nt lds
s_add_u32 m0, s67, 26624
s_add_u32 s45, s66, 294912
buffer_load_dwordx4 v240, s[4:7], s45 offen nt lds
s_add_u32 m0, s67, 33280
s_add_u32 s45, s66, 393216
buffer_load_dwordx4 v240, s[4:7], s45 offen nt lds
Lskipx0:
s_mov_b32 s12, s84
s_and_b32 s13, s85, 65535
s_mov_b32 s14, 73728
s_mov_b32 s15, 131072
v_lshrrev_b32 v189, 2, v251
v_mul_u32_u24 v189, 768, v189
v_and_b32_e64 v125, 3, v251
v_lshl_add_u32 v189, v125, 4, v189
s_and_b32 s43, s40, 3
s_lshl_b32 s3, s43, 6
s_mul_i32 s77, s43, 6144
s_add_u32 s77, s77, 16384
v_mov_b32 v253, 16256
v_mov_b32 v254, 1
s_add_u32 s43, s42, s40
s_add_u32 s43, s43, 1
s_lshl_b32 s43, s43, 9
s_add_u32 s43, s43, s41
s_mul_i32 s47, s43, 192
s_sub_u32 s47, s47, 256
s_and_b32 s43, s40, 1
s_lshl_b32 s46, s43, 4
s_add_u32 s41, s41, s46
s_and_b32 s43, s40, 6
s_add_u32 s42, s42, s43
s_mul_i32 s45, s43, 6656
s_add_u32 s45, s45, 90112
v_and_b32 v131, 15, v251
v_lshrrev_b32 v132, 4, v251
v_mul_u32_u24 v122, 6656, v132
v_add_u32 v122, s45, v122
v_add_u32 v121, s46, v131
v_mul_u32_u24 v123, 192, v121
v_bfe_u32 v124, v121, 2, 2
v_lshl_add_u32 v123, v124, 4, v123
v_add_u32 v242, v122, v123
v_add_u32 v121, 1, v121
v_mul_u32_u24 v123, 192, v121
v_bfe_u32 v124, v121, 2, 2
v_lshl_add_u32 v123, v124, 4, v123
v_add_u32 v243, v122, v123
v_add_u32 v121, 1, v121
v_mul_u32_u24 v123, 192, v121
v_bfe_u32 v124, v121, 2, 2
v_lshl_add_u32 v123, v124, 4, v123
v_add_u32_e64 v244, v122, v123
s_mul_i32 s72, s40, 9216
s_add_u32 s72, s72, 90112
v_bfe_u32 v133, v131, 2, 1
v_sub_u32 v133, v132, v133
v_lshrrev_b32 v134, 3, v131
v_and_b32_e64 v135, 3, v131
v_lshl_add_u32 v135, v134, 2, v135
v_lshlrev_b32_e64 v136, 7, v133
v_lshl_add_u32 v136, v135, 4, v136
v_add_u32 v136, 156672, v136
v_mov_b32 v135, 163840
v_cmp_gt_u32 vcc, 3, v133
s_nop 1
v_cndmask_b32 v245, v135, v136, vcc
v_and_b32 v135, 3, v131
v_mul_u32_u24 v246, 85, v135
s_mov_b32 s16, s86
s_and_b32 s17, s87, 65535
s_mov_b32 s18, 73728
s_mov_b32 s19, 131072
s_mov_b32 s24, s88
s_and_b32 s25, s89, 65535
s_mov_b32 s26, 768
s_mov_b32 s27, 131072
s_mov_b32 s28, s90
s_and_b32 s29, s91, 65535
s_mov_b32 s30, 768
s_mov_b32 s31, 131072
s_mov_b32 s8, s92
s_and_b32 s9, s93, 65535
s_mov_b32 s10, 50331648
s_mov_b32 s11, 131072
s_mov_b32 s36, s94
s_and_b32 s37, s95, 65535
s_mov_b32 s38, 256
s_mov_b32 s39, 131072
s_mov_b32 s32, s96
s_and_b32 s33, s97, 65535
s_mov_b32 s34, 83886080
s_mov_b32 s35, 131072
v_lshlrev_b32 v241, 4, v251
v_and_b32 v133, 35, v251
v_bfe_u32 v134, v251, 2, 2
v_lshl_add_u32 v133, v134, 3, v133
v_bfe_u32 v134, v251, 4, 1
v_lshl_add_u32 v133, v134, 2, v133
v_lshlrev_b32_e64 v248, 4, v133
v_add_u32 v249, 65536, v248
v_add_u32 v250, 131072, v248
s_lshl_b32 s73, s2, 3
s_add_u32 s73, s73, s40
s_lshl_b32 s80, s73, 10
s_add_u32 s80, s80, 4194304
s_mul_i32 s73, s73, 16
s_add_u32 s73, s73, 1048576
s_mul_i32 s46, s41, 192
s_add_u32 s43, s42, 0
s_mul_i32 s43, s43, 98304
s_add_u32 s68, s43, s46
s_add_u32 s43, s42, 8
s_mul_i32 s43, s43, 98304
s_add_u32 s69, s43, s46
s_add_u32 s43, s42, 16
s_mul_i32 s43, s43, 98304
s_add_u32 s70, s43, s46
s_add_u32 s43, s42, 24
s_mul_i32 s43, s43, 98304
s_add_u32 s71, s43, s46
s_mul_i32 s82, s40, 9216
s_mov_b32 s48, 1156203754
s_mov_b32 s49, 4294508536
s_mov_b32 s76, 400000
v_lshrrev_b32 v148, 5, v251
v_lshlrev_b32 v190, 8, v148
v_bfe_u32 v148, v251, 2, 2
v_lshl_add_u32 v190, v148, 6, v190
v_bfe_u32 v148, v251, 4, 1
v_lshl_add_u32 v190, v148, 5, v190
v_bfe_u32 v148, v251, 0, 1
v_lshl_add_u32 v190, v148, 4, v190
v_bfe_u32 v148, v251, 1, 1
v_lshl_add_u32 v190, v148, 3, v190
v_add_u32 v190, s77, v190
v_add_u32 v191, s77, v248
s_cmp_lt_u32 s40, 4
s_cbranch_scc1 Lnoy
v_lshlrev_b32_e64 v24, 6, v199
s_mov_b32 s43, 1065362610
v_mov_b32 v25, 1084047360
v_add_u32 v0, 32772, v24
v_add_u32 v1, 32780, v24
v_add_u32 v2, 32788, v24
v_add_u32 v3, 32796, v24
v_add_u32 v4, 32804, v24
v_add_u32 v5, 32812, v24
v_add_u32 v6, 32820, v24
v_add_u32 v7, 32828, v24
v_cvt_f32_f16 v0, v0
v_cvt_f32_f16 v1, v1
v_cvt_f32_f16 v2, v2
v_cvt_f32_f16 v3, v3
v_cvt_f32_f16 v4, v4
v_cvt_f32_f16 v5, v5
v_cvt_f32_f16 v6, v6
v_cvt_f32_f16 v7, v7
v_mul_f32 v8, v0, v0
v_mul_f32 v9, v1, v1
v_mul_f32 v10, v2, v2
v_mul_f32 v11, v3, v3
v_mul_f32 v12, v4, v4
v_mul_f32 v13, v5, v5
v_mul_f32 v14, v6, v6
v_mul_f32 v15, v7, v7
v_fma_f32 v8, v8, s43, v25
v_fma_f32 v9, v9, s43, v25
v_fma_f32 v10, v10, s43, v25
v_fma_f32 v11, v11, s43, v25
v_fma_f32 v12, v12, s43, v25
v_fma_f32 v13, v13, s43, v25
v_fma_f32 v14, v14, s43, v25
v_fma_f32 v15, v15, s43, v25
v_mul_f32 v8, v0, v8
v_mul_f32 v9, v1, v9
v_mul_f32 v10, v2, v10
v_mul_f32 v11, v3, v11
v_mul_f32 v12, v4, v12
v_mul_f32 v13, v5, v13
v_mul_f32 v14, v6, v14
v_mul_f32 v15, v7, v15
v_exp_f32 v8, v8
v_exp_f32 v9, v9
v_exp_f32 v10, v10
v_exp_f32 v11, v11
v_exp_f32 v12, v12
v_exp_f32 v13, v13
v_exp_f32 v14, v14
v_exp_f32 v15, v15
v_add_f32 v16, 1.0, v8
v_add_f32 v17, 1.0, v9
v_add_f32 v18, 1.0, v10
v_add_f32 v19, 1.0, v11
v_add_f32 v20, 1.0, v12
v_add_f32 v21, 1.0, v13
v_add_f32 v22, 1.0, v14
v_add_f32 v23, 1.0, v15
v_rcp_f32 v16, v16
v_rcp_f32 v17, v17
v_rcp_f32 v18, v18
v_rcp_f32 v19, v19
v_rcp_f32 v20, v20
v_rcp_f32 v21, v21
v_rcp_f32 v22, v22
v_rcp_f32 v23, v23
v_mul_f32 v0, v0, v16
v_mul_f32 v1, v1, v17
v_mul_f32 v2, v2, v18
v_mul_f32 v3, v3, v19
v_mul_f32 v4, v4, v20
v_mul_f32 v5, v5, v21
v_mul_f32 v6, v6, v22
v_mul_f32 v7, v7, v23
v_mul_f32 v8, v8, v0
v_mul_f32 v9, v9, v1
v_mul_f32 v10, v10, v2
v_mul_f32 v11, v11, v3
v_mul_f32 v12, v12, v4
v_mul_f32 v13, v13, v5
v_mul_f32 v14, v14, v6
v_mul_f32 v15, v15, v7
v_cvt_pk_f16_f32 v28, v0, v1
v_cvt_pk_f16_f32 v32, -v8, -v9
v_cvt_pk_f16_f32 v29, v2, v3
v_cvt_pk_f16_f32 v33, -v10, -v11
v_cvt_pk_f16_f32 v30, v4, v5
v_cvt_pk_f16_f32 v34, -v12, -v13
v_cvt_pk_f16_f32 v31, v6, v7
v_cvt_pk_f16_f32 v35, -v14, -v15
v_lshlrev_b32_e64 v24, 4, v199
v_mov_b32 v25, 163840
s_movk_i32 s43, 496
v_cmp_gt_u32 vcc, s43, v199
s_nop 1
v_cndmask_b32 v24, v25, v24, vcc
ds_write_b128 v24, v[32:35]
ds_write_b128 v24, v[28:31] offset:8192
Lnoy:
s_cmp_ge_u32 s40, 4
s_cbranch_scc1 Lnoo
v_add_u32_e64 v152, 0, v199
v_mul_u32_u24 v140, 683, v152
v_lshrrev_b32 v140, 16, v140
v_mul_u32_u24 v142, 11, v140
v_lshrrev_b32 v142, 5, v142
v_lshrrev_b32 v143, 5, v152
v_bfe_u32 v141, v152, 3, 2
v_bfe_u32 v144, v152, 4, 1
v_xor_b32 v141, v141, v144
v_sub_u32 v141, v141, v142
v_mul_i32_i24 v141, 9, v141
v_add_u32 v143, v143, v141
v_lshrrev_b32_e64 v141, 1, v143
v_mul_u32_u24 v141, 368, v141
v_lshl_add_u32 v143, v143, 3, v141
v_lshl_add_u32 v143, v142, 7, v143
v_and_b32_e64 v144, 7, v152
v_lshl_add_u32 v143, v144, 4, v143
v_add_u32 v156, 156672, v143
v_add_u32 v153, 256, v199
v_mul_u32_u24 v140, 683, v153
v_lshrrev_b32 v140, 16, v140
v_mul_u32_u24 v142, 11, v140
v_lshrrev_b32 v142, 5, v142
v_lshrrev_b32 v143, 5, v153
v_bfe_u32 v141, v153, 3, 2
v_bfe_u32 v144, v153, 4, 1
v_xor_b32 v141, v141, v144
v_sub_u32 v141, v141, v142
v_mul_i32_i24 v141, 9, v141
v_add_u32 v143, v143, v141
v_lshrrev_b32_e64 v141, 1, v143
v_mul_u32_u24 v141, 368, v141
v_lshl_add_u32 v143, v143, 3, v141
v_lshl_add_u32 v143, v142, 7, v143
v_and_b32_e64 v144, 7, v153
v_lshl_add_u32 v143, v144, 4, v143
v_add_u32 v157, 156672, v143
v_add_u32 v154, 512, v199
v_mul_u32_u24 v140, 683, v154
v_lshrrev_b32 v140, 16, v140
v_mul_u32_u24 v142, 11, v140
v_lshrrev_b32 v142, 5, v142
v_lshrrev_b32 v143, 5, v154
v_bfe_u32 v141, v154, 3, 2
v_bfe_u32 v144, v154, 4, 1
v_xor_b32 v141, v141, v144
v_sub_u32 v141, v141, v142
v_mul_i32_i24 v141, 9, v141
v_add_u32 v143, v143, v141
v_lshrrev_b32_e64 v141, 1, v143
v_mul_u32_u24 v141, 368, v141
v_lshl_add_u32 v143, v143, 3, v141
v_lshl_add_u32 v143, v142, 7, v143
v_and_b32_e64 v144, 7, v154
v_lshl_add_u32 v143, v144, 4, v143
v_add_u32 v158, 156672, v143
v_mul_u32_u24 v140, 683, v155
v_lshrrev_b32 v140, 16, v140
v_mul_u32_u24 v142, 11, v140
v_lshrrev_b32 v142, 5, v142
v_lshrrev_b32 v143, 5, v155
v_bfe_u32 v141, v155, 3, 2
v_bfe_u32 v144, v155, 4, 1
v_xor_b32 v141, v141, v144
v_sub_u32 v141, v141, v142
v_mul_i32_i24 v141, 9, v141
v_add_u32 v143, v143, v141
v_lshrrev_b32_e64 v141, 1, v143
v_mul_u32_u24 v141, 368, v141
v_lshl_add_u32 v143, v143, 3, v141
v_lshl_add_u32 v143, v142, 7, v143
v_and_b32_e64 v144, 7, v155
v_lshl_add_u32 v143, v144, 4, v143
v_add_u32 v159, 156672, v143
v_mov_b32 v160, 0
v_mov_b32 v161, 0
v_mov_b32_e64 v162, 0
v_mov_b32 v163, 0
s_mov_b64 exec, 1
ds_write_b128 v253, v[160:163]
ds_write_b128 v253, v[160:163] offset:16
s_mov_b64 exec, -1
s_waitcnt vmcnt(6)
v_and_b32_e64 v130, 4, v152
v_cmp_eq_u32 vcc, 0, v130
s_nop 1
v_cndmask_b32 v164, 0, v126, vcc
v_sub_u32 v165, v126, v164
ds_write_b64 v156, v[164:165]
v_and_b32_e64 v130, 4, v153
v_cmp_eq_u32 vcc, 0, v130
s_nop 1
v_cndmask_b32 v166, 0, v127, vcc
v_sub_u32 v167, v127, v166
ds_write_b64 v157, v[166:167]
v_and_b32_e64 v130, 4, v154
v_cmp_eq_u32 vcc, 0, v130
s_nop 1
v_cndmask_b32 v168, 0, v128, vcc
v_sub_u32 v169, v128, v168
ds_write_b64 v158, v[168:169]
v_and_b32_e64 v130, 4, v155
v_cmp_eq_u32 vcc, 0, v130
s_nop 1
v_cndmask_b32 v170, 0, v129, vcc
v_sub_u32 v171, v129, v170
ds_write_b64 v159, v[170:171]
s_waitcnt lgkmcnt(0)
Lnoo:
s_barrier
s_cmp_lt_u32 s40, 4
s_cbranch_scc1 Lnoy2
v_subrev_u32 v199, 256, v199
v_lshlrev_b32_e64 v24, 6, v199
s_mov_b32 s43, 1065362610
v_mov_b32 v25, 1084047360
v_add_u32 v0, 32772, v24
v_add_u32 v1, 32780, v24
v_add_u32 v2, 32788, v24
v_add_u32 v3, 32796, v24
v_add_u32 v4, 32804, v24
v_add_u32 v5, 32812, v24
v_add_u32 v6, 32820, v24
v_add_u32 v7, 32828, v24
v_cvt_f32_f16 v0, v0
v_cvt_f32_f16 v1, v1
v_cvt_f32_f16 v2, v2
v_cvt_f32_f16 v3, v3
v_cvt_f32_f16 v4, v4
v_cvt_f32_f16 v5, v5
v_cvt_f32_f16 v6, v6
v_cvt_f32_f16 v7, v7
v_mul_f32 v8, v0, v0
v_mul_f32 v9, v1, v1
v_mul_f32 v10, v2, v2
v_mul_f32 v11, v3, v3
v_mul_f32 v12, v4, v4
v_mul_f32 v13, v5, v5
v_mul_f32 v14, v6, v6
v_mul_f32 v15, v7, v7
v_fma_f32 v8, v8, s43, v25
v_fma_f32 v9, v9, s43, v25
v_fma_f32 v10, v10, s43, v25
v_fma_f32 v11, v11, s43, v25
v_fma_f32 v12, v12, s43, v25
v_fma_f32 v13, v13, s43, v25
v_fma_f32 v14, v14, s43, v25
v_fma_f32 v15, v15, s43, v25
v_mul_f32 v8, v0, v8
v_mul_f32 v9, v1, v9
v_mul_f32 v10, v2, v10
v_mul_f32 v11, v3, v11
v_mul_f32 v12, v4, v12
v_mul_f32 v13, v5, v13
v_mul_f32 v14, v6, v14
v_mul_f32 v15, v7, v15
v_exp_f32 v8, v8
v_exp_f32 v9, v9
v_exp_f32 v10, v10
v_exp_f32 v11, v11
v_exp_f32 v12, v12
v_exp_f32 v13, v13
v_exp_f32 v14, v14
v_exp_f32 v15, v15
v_add_f32 v16, 1.0, v8
v_add_f32 v17, 1.0, v9
v_add_f32 v18, 1.0, v10
v_add_f32 v19, 1.0, v11
v_add_f32 v20, 1.0, v12
v_add_f32 v21, 1.0, v13
v_add_f32 v22, 1.0, v14
v_add_f32 v23, 1.0, v15
v_rcp_f32 v16, v16
v_rcp_f32 v17, v17
v_rcp_f32 v18, v18
v_rcp_f32 v19, v19
v_rcp_f32 v20, v20
v_rcp_f32 v21, v21
v_rcp_f32 v22, v22
v_rcp_f32 v23, v23
v_mul_f32 v0, v0, v16
v_mul_f32 v1, v1, v17
v_mul_f32 v2, v2, v18
v_mul_f32 v3, v3, v19
v_mul_f32 v4, v4, v20
v_mul_f32 v5, v5, v21
v_mul_f32 v6, v6, v22
v_mul_f32 v7, v7, v23
v_mul_f32 v8, v8, v0
v_mul_f32 v9, v9, v1
v_mul_f32 v10, v10, v2
v_mul_f32 v11, v11, v3
v_mul_f32 v12, v12, v4
v_mul_f32 v13, v13, v5
v_mul_f32 v14, v14, v6
v_mul_f32 v15, v15, v7
v_cvt_pk_f16_f32 v28, v0, v1
v_cvt_pk_f16_f32 v32, -v8, -v9
v_cvt_pk_f16_f32 v29, v2, v3
v_cvt_pk_f16_f32 v33, -v10, -v11
v_cvt_pk_f16_f32 v30, v4, v5
v_cvt_pk_f16_f32 v34, -v12, -v13
v_cvt_pk_f16_f32 v31, v6, v7
v_cvt_pk_f16_f32 v35, -v14, -v15
v_lshlrev_b32_e64 v24, 4, v199
v_mov_b32 v25, 163840
s_movk_i32 s43, 496
v_cmp_gt_u32 vcc, s43, v199
s_nop 1
v_cndmask_b32 v24, v25, v24, vcc
ds_write_b128 v24, v[32:35]
ds_write_b128 v24, v[28:31] offset:8192
Lnoy2:
s_setprio 2
s_cmp_lt_u32 s40, 4
s_cbranch_scc0 Lsu0
s_call_b64 s[78:79], Lpre
s_call_b64 s[78:79], Lrb
s_waitcnt vmcnt(4)
s_mov_b64 exec, 1
ds_add_u32 v253, v254 offset:28
s_mov_b64 exec, -1
v_mov_b32 v253, 16256
Lsw288w:
ds_read_b32 v247, v253 offset:28
s_waitcnt lgkmcnt(0)
v_readfirstlane_b32 s43, v247
s_cmp_eq_u32 s76, 0
s_cbranch_scc1 Lsw288x
s_sub_u32 s76, s76, 1
s_cmp_lt_u32 s43, 8
s_cbranch_scc0 Lsw288x
s_sleep 2
s_branch Lsw288w
Lsw288x:
s_call_b64 s[78:79], Lconv0
s_mov_b64 exec, 1
ds_add_u32 v253, v254 offset:16
s_mov_b64 exec, -1
s_call_b64 s[78:79], Lln0
s_waitcnt vmcnt(0)
s_mov_b64 exec, 1
ds_add_u32 v253, v254 offset:12
s_mov_b64 exec, -1
s_call_b64 s[78:79], Lw1i
Lsu0:
s_cmp_ge_u32 s40, 4
s_cbranch_scc0 Lsu2
s_setprio 3
s_call_b64 s[78:79], Lw1f
s_waitcnt vmcnt(6)
s_mov_b64 exec, 1
ds_add_u32 v253, v254 offset:28
s_mov_b64 exec, -1
s_call_b64 s[78:79], Lrb
s_waitcnt vmcnt(4)
s_call_b64 s[78:79], Lw1a
s_mov_b64 exec, 1
ds_add_u32 v253, v254 offset:20
s_mov_b64 exec, -1
s_call_b64 s[78:79], Lpre
s_waitcnt vmcnt(0)
s_mov_b64 exec, 1
ds_add_u32 v253, v254 offset:12
s_mov_b64 exec, -1
v_mov_b32 v253, 16256
Lsw128w:
ds_read_b32 v247, v253 offset:12
s_waitcnt lgkmcnt(0)
v_readfirstlane_b32 s43, v247
s_cmp_eq_u32 s76, 0
s_cbranch_scc1 Lsw128x
s_sub_u32 s76, s76, 1
s_cmp_lt_u32 s43, 8
s_cbranch_scc0 Lsw128x
s_sleep 2
s_branch Lsw128w
Lsw128x:
s_call_b64 s[78:79], Lconv0
s_mov_b64 exec, 1
ds_add_u32 v253, v254 offset:16
s_mov_b64 exec, -1
s_call_b64 s[78:79], Lln0
Lsu2:
s_branch Lgo
Lconv0:
ds_read_b128 v[192:195], v242
ds_read_b128 v[196:199], v242 offset:64
ds_read_b128 v[200:203], v242 offset:128
ds_read_b128 v[204:207], v243
ds_read_b128 v[208:211], v243 offset:64
ds_read_b128 v[212:215], v243 offset:128
ds_read_b128 v[224:227], v244
ds_read_b128 v[228:231], v244 offset:64
ds_read_b128 v[232:235], v244 offset:128
v_xor_b32 v242, 16, v242
ds_read_b128 v[236:239], v242
ds_read_b128 v[216:219], v242 offset:64
ds_read_b128 v[220:223], v242 offset:128
s_waitcnt lgkmcnt(11)
v_smfmac_f32_16x16x32_bf16 v[0:3], v[48:49], v[192:195], v246
s_waitcnt lgkmcnt(10)
v_smfmac_f32_16x16x32_bf16 v[16:19], v[50:51], v[196:199], v246
s_waitcnt lgkmcnt(9)
v_smfmac_f32_16x16x32_bf16 v[32:35], v[52:53], v[200:203], v246
s_waitcnt lgkmcnt(8)
v_xor_b32 v243, 16, v243
ds_read_b128 v[192:195], v243
ds_read_b128 v[196:199], v243 offset:64
v_smfmac_f32_16x16x32_bf16 v[0:3], v[54:55], v[204:207], v246
s_waitcnt lgkmcnt(9)
v_smfmac_f32_16x16x32_bf16 v[16:19], v[56:57], v[208:211], v246
s_waitcnt lgkmcnt(8)
ds_read_b128 v[200:203], v243 offset:128
v_xor_b32 v244, 16, v244
ds_read_b128 v[204:207], v244
v_smfmac_f32_16x16x32_bf16 v[32:35], v[58:59], v[212:215], v246
s_waitcnt lgkmcnt(9)
v_smfmac_f32_16x16x32_bf16 v[0:3], v[60:61], v[224:227], v246
s_waitcnt lgkmcnt(8)
ds_read_b128 v[208:211], v244 offset:64
ds_read_b128 v[212:215], v244 offset:128
v_smfmac_f32_16x16x32_bf16 v[16:19], v[62:63], v[228:231], v246
s_waitcnt lgkmcnt(9)
v_smfmac_f32_16x16x32_bf16 v[32:35], v[64:65], v[232:235], v246
s_waitcnt lgkmcnt(8)
v_xor_b32 v242, 32, v242
ds_read_b128 v[224:227], v242
ds_read_b128 v[228:231], v242 offset:64
v_smfmac_f32_16x16x32_bf16 v[4:7], v[66:67], v[236:239], v246
s_waitcnt lgkmcnt(9)
v_smfmac_f32_16x16x32_bf16 v[20:23], v[68:69], v[216:219], v246
s_waitcnt lgkmcnt(8)
ds_read_b128 v[232:235], v242 offset:128
v_xor_b32 v243, 32, v243
ds_read_b128 v[236:239], v243
v_smfmac_f32_16x16x32_bf16 v[36:39], v[70:71], v[220:223], v246
s_waitcnt lgkmcnt(9)
v_smfmac_f32_16x16x32_bf16 v[4:7], v[72:73], v[192:195], v246
s_waitcnt lgkmcnt(8)
ds_read_b128 v[216:219], v243 offset:64
ds_read_b128 v[220:223], v243 offset:128
v_smfmac_f32_16x16x32_bf16 v[20:23], v[74:75], v[196:199], v246
s_waitcnt lgkmcnt(9)
v_smfmac_f32_16x16x32_bf16 v[36:39], v[76:77], v[200:203], v246
s_waitcnt lgkmcnt(8)
v_xor_b32 v244, 32, v244
ds_read_b128 v[192:195], v244
ds_read_b128 v[196:199], v244 offset:64
v_smfmac_f32_16x16x32_bf16 v[4:7], v[78:79], v[204:207], v246
s_waitcnt lgkmcnt(9)
v_smfmac_f32_16x16x32_bf16 v[20:23], v[80:81], v[208:211], v246
s_waitcnt lgkmcnt(8)
ds_read_b128 v[200:203], v244 offset:128
v_xor_b32 v242, 16, v242
ds_read_b128 v[204:207], v242
v_smfmac_f32_16x16x32_bf16 v[36:39], v[82:83], v[212:215], v246
s_waitcnt lgkmcnt(9)
v_smfmac_f32_16x16x32_bf16 v[12:15], v[84:85], v[224:227], v246
s_waitcnt lgkmcnt(8)
ds_read_b128 v[208:211], v242 offset:64
ds_read_b128 v[212:215], v242 offset:128
v_smfmac_f32_16x16x32_bf16 v[28:31], v[86:87], v[228:231], v246
s_waitcnt lgkmcnt(9)
v_smfmac_f32_16x16x32_bf16 v[44:47], v[88:89], v[232:235], v246
s_waitcnt lgkmcnt(8)
v_xor_b32 v243, 16, v243
ds_read_b128 v[224:227], v243
ds_read_b128 v[228:231], v243 offset:64
v_smfmac_f32_16x16x32_bf16 v[12:15], v[90:91], v[236:239], v246
s_waitcnt lgkmcnt(9)
v_smfmac_f32_16x16x32_bf16 v[28:31], v[92:93], v[216:219], v246
s_waitcnt lgkmcnt(8)
ds_read_b128 v[232:235], v243 offset:128
v_xor_b32 v244, 16, v244
ds_read_b128 v[236:239], v244
v_smfmac_f32_16x16x32_bf16 v[44:47], v[94:95], v[220:223], v246
s_waitcnt lgkmcnt(9)
v_smfmac_f32_16x16x32_bf16 v[12:15], v[96:97], v[192:195], v246
s_waitcnt lgkmcnt(8)
ds_read_b128 v[216:219], v244 offset:64
ds_read_b128 v[220:223], v244 offset:128
v_smfmac_f32_16x16x32_bf16 v[28:31], v[98:99], v[196:199], v246
s_waitcnt lgkmcnt(9)
v_smfmac_f32_16x16x32_bf16 v[44:47], v[100:101], v[200:203], v246
s_waitcnt lgkmcnt(8)
v_smfmac_f32_16x16x32_bf16 v[8:11], v[102:103], v[204:207], v246
s_waitcnt lgkmcnt(7)
v_smfmac_f32_16x16x32_bf16 v[24:27], v[104:105], v[208:211], v246
s_waitcnt lgkmcnt(6)
v_smfmac_f32_16x16x32_bf16 v[40:43], v[106:107], v[212:215], v246
s_waitcnt lgkmcnt(5)
v_smfmac_f32_16x16x32_bf16 v[8:11], v[108:109], v[224:227], v246
s_waitcnt lgkmcnt(4)
v_smfmac_f32_16x16x32_bf16 v[24:27], v[110:111], v[228:231], v246
s_waitcnt lgkmcnt(3)
v_smfmac_f32_16x16x32_bf16 v[40:43], v[112:113], v[232:235], v246
s_waitcnt lgkmcnt(2)
v_smfmac_f32_16x16x32_bf16 v[8:11], v[114:115], v[236:239], v246
s_waitcnt lgkmcnt(1)
v_smfmac_f32_16x16x32_bf16 v[24:27], v[116:117], v[216:219], v246
s_waitcnt lgkmcnt(0)
v_smfmac_f32_16x16x32_bf16 v[40:43], v[118:119], v[220:223], v246
s_nop 11
s_setpc_b64 s[78:79]
Lln0:
v_pk_add_f32 v[168:169], v[0:1], v[2:3]
v_pk_mul_f32 v[170:171], v[0:1], v[0:1]
v_pk_fma_f32 v[170:171], v[2:3], v[2:3], v[170:171]
v_pk_add_f32 v[168:169], v[168:169], v[4:5]
v_pk_fma_f32 v[170:171], v[4:5], v[4:5], v[170:171]
v_pk_add_f32 v[168:169], v[168:169], v[6:7]
v_pk_fma_f32 v[170:171], v[6:7], v[6:7], v[170:171]
v_pk_add_f32 v[168:169], v[168:169], v[8:9]
v_pk_fma_f32 v[170:171], v[8:9], v[8:9], v[170:171]
v_pk_add_f32 v[168:169], v[168:169], v[10:11]
v_pk_fma_f32 v[170:171], v[10:11], v[10:11], v[170:171]
v_pk_add_f32 v[168:169], v[168:169], v[12:13]
v_pk_fma_f32 v[170:171], v[12:13], v[12:13], v[170:171]
v_pk_add_f32 v[168:169], v[168:169], v[14:15]
v_pk_fma_f32 v[170:171], v[14:15], v[14:15], v[170:171]
v_pk_add_f32 v[168:169], v[168:169], v[16:17]
v_pk_fma_f32 v[170:171], v[16:17], v[16:17], v[170:171]
v_pk_add_f32 v[168:169], v[168:169], v[18:19]
v_pk_fma_f32 v[170:171], v[18:19], v[18:19], v[170:171]
v_pk_add_f32 v[168:169], v[168:169], v[20:21]
v_pk_fma_f32 v[170:171], v[20:21], v[20:21], v[170:171]
v_pk_add_f32 v[168:169], v[168:169], v[22:23]
v_pk_fma_f32 v[170:171], v[22:23], v[22:23], v[170:171]
v_pk_add_f32 v[168:169], v[168:169], v[24:25]
v_pk_fma_f32 v[170:171], v[24:25], v[24:25], v[170:171]
v_pk_add_f32 v[168:169], v[168:169], v[26:27]
v_pk_fma_f32 v[170:171], v[26:27], v[26:27], v[170:171]
v_pk_add_f32 v[168:169], v[168:169], v[28:29]
v_pk_fma_f32 v[170:171], v[28:29], v[28:29], v[170:171]
v_pk_add_f32 v[168:169], v[168:169], v[30:31]
v_pk_fma_f32 v[170:171], v[30:31], v[30:31], v[170:171]
v_pk_add_f32 v[168:169], v[168:169], v[32:33]
v_pk_fma_f32 v[170:171], v[32:33], v[32:33], v[170:171]
v_pk_add_f32 v[168:169], v[168:169], v[34:35]
v_pk_fma_f32 v[170:171], v[34:35], v[34:35], v[170:171]
v_pk_add_f32 v[168:169], v[168:169], v[36:37]
v_pk_fma_f32 v[170:171], v[36:37], v[36:37], v[170:171]
v_pk_add_f32 v[168:169], v[168:169], v[38:39]
v_pk_fma_f32 v[170:171], v[38:39], v[38:39], v[170:171]
v_pk_add_f32 v[168:169], v[168:169], v[40:41]
v_pk_fma_f32 v[170:171], v[40:41], v[40:41], v[170:171]
v_pk_add_f32 v[168:169], v[168:169], v[42:43]
v_pk_fma_f32 v[170:171], v[42:43], v[42:43], v[170:171]
v_pk_add_f32 v[168:169], v[168:169], v[44:45]
v_pk_fma_f32 v[170:171], v[44:45], v[44:45], v[170:171]
v_pk_add_f32 v[168:169], v[168:169], v[46:47]
v_pk_fma_f32 v[170:171], v[46:47], v[46:47], v[170:171]
v_add_f32 v168, v168, v169
v_add_f32 v170, v170, v171
s_nop 1
v_permlane32_swap_b32 v168, v170
v_add_f32_e64 v168, v168, v170
v_mul_f32 v168, 1009429163, v168
v_mov_b32_e64 v170, v168
s_nop 1
v_permlane32_swap_b32 v168, v170
v_fma_f32 v170, -v168, v168, v170
v_max_f32_e64 v170, 0, v170
v_add_f32 v170, 925353388, v170
v_rsq_f32 v170, v170
s_nop 0
v_mul_f32 v172, 3203391086, v170
v_mul_f32_e64 v173, v168, v172
v_pk_fma_f32 v[0:1], v[0:1], v[172:173], v[172:173] op_sel:[0,0,1] op_sel_hi:[1,0,1] neg_lo:[0,0,1] neg_hi:[0,0,1]
v_pk_fma_f32 v[2:3], v[2:3], v[172:173], v[172:173] op_sel:[0,0,1] op_sel_hi:[1,0,1] neg_lo:[0,0,1] neg_hi:[0,0,1]
v_pk_fma_f32 v[4:5], v[4:5], v[172:173], v[172:173] op_sel:[0,0,1] op_sel_hi:[1,0,1] neg_lo:[0,0,1] neg_hi:[0,0,1]
v_pk_fma_f32 v[6:7], v[6:7], v[172:173], v[172:173] op_sel:[0,0,1] op_sel_hi:[1,0,1] neg_lo:[0,0,1] neg_hi:[0,0,1]
v_pk_fma_f32 v[8:9], v[8:9], v[172:173], v[172:173] op_sel:[0,0,1] op_sel_hi:[1,0,1] neg_lo:[0,0,1] neg_hi:[0,0,1]
v_pk_fma_f32 v[10:11], v[10:11], v[172:173], v[172:173] op_sel:[0,0,1] op_sel_hi:[1,0,1] neg_lo:[0,0,1] neg_hi:[0,0,1]
v_pk_fma_f32 v[12:13], v[12:13], v[172:173], v[172:173] op_sel:[0,0,1] op_sel_hi:[1,0,1] neg_lo:[0,0,1] neg_hi:[0,0,1]
v_pk_fma_f32 v[14:15], v[14:15], v[172:173], v[172:173] op_sel:[0,0,1] op_sel_hi:[1,0,1] neg_lo:[0,0,1] neg_hi:[0,0,1]
v_pk_fma_f32 v[16:17], v[16:17], v[172:173], v[172:173] op_sel:[0,0,1] op_sel_hi:[1,0,1] neg_lo:[0,0,1] neg_hi:[0,0,1]
v_pk_fma_f32 v[18:19], v[18:19], v[172:173], v[172:173] op_sel:[0,0,1] op_sel_hi:[1,0,1] neg_lo:[0,0,1] neg_hi:[0,0,1]
v_pk_fma_f32 v[20:21], v[20:21], v[172:173], v[172:173] op_sel:[0,0,1] op_sel_hi:[1,0,1] neg_lo:[0,0,1] neg_hi:[0,0,1]
v_pk_fma_f32 v[22:23], v[22:23], v[172:173], v[172:173] op_sel:[0,0,1] op_sel_hi:[1,0,1] neg_lo:[0,0,1] neg_hi:[0,0,1]
v_pk_fma_f32 v[24:25], v[24:25], v[172:173], v[172:173] op_sel:[0,0,1] op_sel_hi:[1,0,1] neg_lo:[0,0,1] neg_hi:[0,0,1]
v_pk_fma_f32 v[26:27], v[26:27], v[172:173], v[172:173] op_sel:[0,0,1] op_sel_hi:[1,0,1] neg_lo:[0,0,1] neg_hi:[0,0,1]
v_pk_fma_f32 v[28:29], v[28:29], v[172:173], v[172:173] op_sel:[0,0,1] op_sel_hi:[1,0,1] neg_lo:[0,0,1] neg_hi:[0,0,1]
v_pk_fma_f32 v[30:31], v[30:31], v[172:173], v[172:173] op_sel:[0,0,1] op_sel_hi:[1,0,1] neg_lo:[0,0,1] neg_hi:[0,0,1]
v_pk_fma_f32 v[32:33], v[32:33], v[172:173], v[172:173] op_sel:[0,0,1] op_sel_hi:[1,0,1] neg_lo:[0,0,1] neg_hi:[0,0,1]
v_pk_fma_f32 v[34:35], v[34:35], v[172:173], v[172:173] op_sel:[0,0,1] op_sel_hi:[1,0,1] neg_lo:[0,0,1] neg_hi:[0,0,1]
v_pk_fma_f32 v[36:37], v[36:37], v[172:173], v[172:173] op_sel:[0,0,1] op_sel_hi:[1,0,1] neg_lo:[0,0,1] neg_hi:[0,0,1]
v_pk_fma_f32 v[38:39], v[38:39], v[172:173], v[172:173] op_sel:[0,0,1] op_sel_hi:[1,0,1] neg_lo:[0,0,1] neg_hi:[0,0,1]
v_pk_fma_f32 v[40:41], v[40:41], v[172:173], v[172:173] op_sel:[0,0,1] op_sel_hi:[1,0,1] neg_lo:[0,0,1] neg_hi:[0,0,1]
v_pk_fma_f32 v[42:43], v[42:43], v[172:173], v[172:173] op_sel:[0,0,1] op_sel_hi:[1,0,1] neg_lo:[0,0,1] neg_hi:[0,0,1]
v_pk_fma_f32 v[44:45], v[44:45], v[172:173], v[172:173] op_sel:[0,0,1] op_sel_hi:[1,0,1] neg_lo:[0,0,1] neg_hi:[0,0,1]
v_pk_fma_f32 v[46:47], v[46:47], v[172:173], v[172:173] op_sel:[0,0,1] op_sel_hi:[1,0,1] neg_lo:[0,0,1] neg_hi:[0,0,1]
v_cvt_pk_bf16_f32 v48, v0, v1
v_cvt_pk_bf16_f32 v49, v2, v3
v_cvt_pk_bf16_f32 v50, v4, v5
v_cvt_pk_bf16_f32 v51, v6, v7
v_cvt_pk_bf16_f32 v52, v8, v9
v_cvt_pk_bf16_f32 v53, v10, v11
v_cvt_pk_bf16_f32 v54, v12, v13
v_cvt_pk_bf16_f32 v55, v14, v15
v_cvt_pk_bf16_f32 v56, v16, v17
v_cvt_pk_bf16_f32 v57, v18, v19
v_cvt_pk_bf16_f32 v58, v20, v21
v_cvt_pk_bf16_f32 v59, v22, v23
v_cvt_pk_bf16_f32 v60, v24, v25
v_cvt_pk_bf16_f32 v61, v26, v27
v_cvt_pk_bf16_f32 v62, v28, v29
v_cvt_pk_bf16_f32 v63, v30, v31
v_cvt_pk_bf16_f32 v64, v32, v33
v_cvt_pk_bf16_f32 v65, v34, v35
v_cvt_pk_bf16_f32 v66, v36, v37
v_cvt_pk_bf16_f32 v67, v38, v39
v_cvt_pk_bf16_f32 v68, v40, v41
v_cvt_pk_bf16_f32 v69, v42, v43
v_cvt_pk_bf16_f32 v70, v44, v45
v_cvt_pk_bf16_f32 v71, v46, v47
s_nop 1
s_setpc_b64 s[78:79]
Lw1a:
ds_read_b64_tr_b16 v[148:149], v190
ds_read_b64_tr_b16 v[150:151], v190 offset:512
ds_read_b64_tr_b16 v[152:153], v190 offset:1024
ds_read_b64_tr_b16 v[154:155], v190 offset:1536
ds_read_b64_tr_b16 v[156:157], v190 offset:2048
ds_read_b64_tr_b16 v[158:159], v190 offset:2560
ds_read_b64_tr_b16 v[160:161], v190 offset:3072
ds_read_b64_tr_b16 v[162:163], v190 offset:3584
ds_read_b64_tr_b16 v[164:165], v190 offset:4096
ds_read_b64_tr_b16 v[166:167], v190 offset:4608
ds_read_b64_tr_b16 v[168:169], v190 offset:5120
ds_read_b64_tr_b16 v[170:171], v190 offset:5632
s_waitcnt lgkmcnt(10)
ds_write_b128 v191, v[148:151]
s_waitcnt lgkmcnt(9)
ds_write_b128 v191, v[152:155] offset:1024
s_waitcnt lgkmcnt(8)
ds_write_b128 v191, v[156:159] offset:2048
s_waitcnt lgkmcnt(7)
ds_write_b128 v191, v[160:163] offset:3072
s_waitcnt lgkmcnt(6)
ds_write_b128 v191, v[164:167] offset:4096
s_waitcnt lgkmcnt(5)
ds_write_b128 v191, v[168:171] offset:5120
s_waitcnt lgkmcnt(0)
s_setpc_b64 s[78:79]
Lw1i:
s_add_u32 m0, s77, 24576
s_add_u32 s43, s3, 256
buffer_load_dwordx4 v189, s[12:15], s43 offen lds
s_add_u32 m0, s77, 25600
s_add_u32 s43, s3, 24832
buffer_load_dwordx4 v189, s[12:15], s43 offen lds
s_add_u32 m0, s77, 26624
s_add_u32 s43, s3, 49408
buffer_load_dwordx4 v189, s[12:15], s43 offen lds
s_add_u32 m0, s77, 27648
s_add_u32 s43, s3, 12544
buffer_load_dwordx4 v189, s[12:15], s43 offen lds
s_add_u32 m0, s77, 28672
s_add_u32 s43, s3, 37120
buffer_load_dwordx4 v189, s[12:15], s43 offen lds
s_add_u32 m0, s77, 29696
s_add_u32 s43, s3, 61696
buffer_load_dwordx4 v189, s[12:15], s43 offen lds
s_add_u32 m0, s77, 49152
s_add_u32 s43, s3, 512
buffer_load_dwordx4 v189, s[12:15], s43 offen lds
s_add_u32 m0, s77, 50176
s_add_u32 s43, s3, 25088
buffer_load_dwordx4 v189, s[12:15], s43 offen lds
s_add_u32 m0, s77, 51200
s_add_u32 s43, s3, 49664
buffer_load_dwordx4 v189, s[12:15], s43 offen lds
s_add_u32 m0, s77, 52224
s_add_u32 s43, s3, 12800
buffer_load_dwordx4 v189, s[12:15], s43 offen lds
s_add_u32 m0, s77, 53248
s_add_u32 s43, s3, 37376
buffer_load_dwordx4 v189, s[12:15], s43 offen lds
s_add_u32 m0, s77, 54272
s_add_u32 s43, s3, 61952
buffer_load_dwordx4 v189, s[12:15], s43 offen lds
s_setpc_b64 s[78:79]
Lw1b:
s_waitcnt vmcnt(0)
ds_read_b64_tr_b16 v[72:73], v190 offset:24576
ds_read_b64_tr_b16 v[74:75], v190 offset:25088
ds_read_b64_tr_b16 v[76:77], v190 offset:25600
ds_read_b64_tr_b16 v[78:79], v190 offset:26112
ds_read_b64_tr_b16 v[80:81], v190 offset:26624
ds_read_b64_tr_b16 v[82:83], v190 offset:27136
ds_read_b64_tr_b16 v[84:85], v190 offset:27648
ds_read_b64_tr_b16 v[86:87], v190 offset:28160
ds_read_b64_tr_b16 v[88:89], v190 offset:28672
ds_read_b64_tr_b16 v[90:91], v190 offset:29184
ds_read_b64_tr_b16 v[92:93], v190 offset:29696
ds_read_b64_tr_b16 v[94:95], v190 offset:30208
ds_read_b64_tr_b16 v[96:97], v190 offset:49152
ds_read_b64_tr_b16 v[98:99], v190 offset:49664
ds_read_b64_tr_b16 v[100:101], v190 offset:50176
ds_read_b64_tr_b16 v[102:103], v190 offset:50688
ds_read_b64_tr_b16 v[104:105], v190 offset:51200
ds_read_b64_tr_b16 v[106:107], v190 offset:51712
ds_read_b64_tr_b16 v[108:109], v190 offset:52224
ds_read_b64_tr_b16 v[110:111], v190 offset:52736
ds_read_b64_tr_b16 v[112:113], v190 offset:53248
ds_read_b64_tr_b16 v[114:115], v190 offset:53760
ds_read_b64_tr_b16 v[116:117], v190 offset:54272
ds_read_b64_tr_b16 v[118:119], v190 offset:54784
s_waitcnt lgkmcnt(15)
ds_write_b128 v191, v[72:75] offset:24576
ds_write_b128 v191, v[76:79] offset:25600
ds_write_b128 v191, v[80:83] offset:26624
ds_write_b128 v191, v[84:87] offset:27648
s_waitcnt lgkmcnt(15)
ds_write_b128 v191, v[88:91] offset:28672
ds_write_b128 v191, v[92:95] offset:29696
s_waitcnt lgkmcnt(15)
ds_write_b128 v191, v[96:99] offset:49152
s_waitcnt lgkmcnt(15)
ds_write_b128 v191, v[100:103] offset:50176
s_waitcnt lgkmcnt(14)
ds_write_b128 v191, v[104:107] offset:51200
s_waitcnt lgkmcnt(13)
ds_write_b128 v191, v[108:111] offset:52224
s_waitcnt lgkmcnt(12)
ds_write_b128 v191, v[112:115] offset:53248
s_waitcnt lgkmcnt(11)
ds_write_b128 v191, v[116:119] offset:54272
s_waitcnt lgkmcnt(0)
s_setpc_b64 s[78:79]
Lpre:
ds_read_b128 v[48:51], v245
ds_read_b128 v[52:55], v245 offset:384
ds_read_b128 v[56:59], v245 offset:768
ds_read_b128 v[60:63], v245 offset:1152
ds_read_b128 v[64:67], v245 offset:1536
ds_read_b128 v[68:71], v245 offset:1920
ds_read_b128 v[72:75], v245 offset:2304
ds_read_b128 v[76:79], v245 offset:2688
ds_read_b128 v[80:83], v245 offset:3072
ds_read_b128 v[84:87], v245 offset:3456
ds_read_b128 v[88:91], v245 offset:3840
ds_read_b128 v[92:95], v245 offset:4224
ds_read_b128 v[96:99], v245 offset:4608
ds_read_b128 v[100:103], v245 offset:4992
ds_read_b128 v[104:107], v245 offset:5376
ds_read_b128 v[108:111], v245 offset:5760
ds_read_b128 v[112:115], v245 offset:6144
ds_read_b128 v[116:119], v245 offset:6528
v_mov_b32 v0, 0
v_mov_b32 v1, 0
v_mov_b32 v2, 0
v_mov_b32 v3, 0
v_mov_b32 v4, 0
v_mov_b32 v5, 0
v_mov_b32 v6, 0
v_mov_b32 v7, 0
v_mov_b32 v8, 0
v_mov_b32 v9, 0
v_mov_b32 v10, 0
v_mov_b32 v11, 0
v_mov_b32 v12, 0
v_mov_b32 v13, 0
v_mov_b32 v14, 0
v_mov_b32 v15, 0
v_mov_b32 v16, 0
v_mov_b32 v17, 0
v_mov_b32 v18, 0
v_mov_b32 v19, 0
v_mov_b32 v20, 0
v_mov_b32 v21, 0
v_mov_b32 v22, 0
v_mov_b32 v23, 0
v_mov_b32 v24, 0
v_mov_b32 v25, 0
v_mov_b32 v26, 0
v_mov_b32 v27, 0
v_mov_b32 v28, 0
v_mov_b32 v29, 0
v_mov_b32 v30, 0
v_mov_b32 v31, 0
v_mov_b32 v32, 0
v_mov_b32 v33, 0
v_mov_b32 v34, 0
v_mov_b32 v35, 0
v_mov_b32 v36, 0
v_mov_b32 v37, 0
v_mov_b32 v38, 0
v_mov_b32 v39, 0
v_mov_b32 v40, 0
v_mov_b32 v41, 0
v_mov_b32 v42, 0
v_mov_b32 v43, 0
v_mov_b32 v44, 0
v_mov_b32 v45, 0
v_mov_b32_e64 v46, 0
v_mov_b32 v47, 0
s_waitcnt lgkmcnt(0)
s_setpc_b64 s[78:79]
Lrb:
s_add_u32 m0, s67, 39936
s_add_u32 s45, s66, 491520
buffer_load_dwordx4 v240, s[4:7], s45 offen nt lds
s_add_u32 m0, s67, 46592
s_add_u32 s45, s66, 589824
buffer_load_dwordx4 v240, s[4:7], s45 offen nt lds
s_add_u32 m0, s67, 53248
s_add_u32 s45, s66, 688128
buffer_load_dwordx4 v240, s[4:7], s45 offen nt lds
s_add_u32 m0, s67, 59904
s_add_u32 s45, s66, 786432
buffer_load_dwordx4 v240, s[4:7], s45 offen nt lds
s_setpc_b64 s[78:79]
Lw1f:
s_add_u32 m0, s77, 0
s_add_u32 s43, s3, 0
buffer_load_dwordx4 v189, s[12:15], s43 offen lds
s_add_u32 m0, s77, 1024
s_add_u32 s43, s3, 24576
buffer_load_dwordx4 v189, s[12:15], s43 offen lds
s_add_u32 m0, s77, 2048
s_add_u32 s43, s3, 49152
buffer_load_dwordx4 v189, s[12:15], s43 offen lds
s_add_u32 m0, s77, 3072
s_add_u32 s43, s3, 12288
buffer_load_dwordx4 v189, s[12:15], s43 offen lds
s_add_u32 m0, s77, 4096
s_add_u32 s43, s3, 36864
buffer_load_dwordx4 v189, s[12:15], s43 offen lds
s_add_u32 m0, s77, 5120
s_add_u32 s43, s3, 61440
buffer_load_dwordx4 v189, s[12:15], s43 offen lds
s_setpc_b64 s[78:79]
Lgo:
v_mov_b32 v253, 16256
Lsw204w:
ds_read_b32 v247, v253 offset:20
s_waitcnt lgkmcnt(0)
v_readfirstlane_b32 s43, v247
s_cmp_eq_u32 s76, 0
s_cbranch_scc1 Lsw204x
s_sub_u32 s76, s76, 1
s_cmp_lt_u32 s43, 4
s_cbranch_scc0 Lsw204x
s_sleep 2
s_branch Lsw204w
Lsw204x:
s_cmp_lg_u32 s40, 7
s_cbranch_scc1 Lnopf
s_getpc_b64 s[74:75]
Lpc:
s_lshr_b32 s43, s2, 3
s_and_b32 s43, s43, 15
s_lshl_b32 s43, s43, 13
v_lshlrev_b32 v178, 7, v251
v_add_u32 v178, s43, v178
v_min_u32 v178, Lend-Lpc, v178
global_load_dword v255, v178, s[74:75]
Lnopf:
s_add_u32 s66, s66, 786432
ds_read_b128 v[224:227], v248 offset:16384
ds_read_b128 v[228:231], v248 offset:19456
ds_read_b128 v[232:235], v248 offset:17408
ds_read_b128 v[236:239], v248 offset:20480
ds_read_b128 v[216:219], v248 offset:18432
ds_read_b128 v[220:223], v248 offset:21504
s_setprio 2
s_waitcnt lgkmcnt(5)
v_mfma_f32_32x32x16_bf16 v[120:135], v[48:51], v[224:227], 0
s_waitcnt lgkmcnt(4)
ds_read_b128 v[224:227], v248 offset:22528
v_mfma_f32_32x32x16_bf16 v[120:135], v[52:55], v[228:231], v[120:135]
s_waitcnt lgkmcnt(4)
ds_read_b128 v[228:231], v248 offset:25600
v_mfma_f32_32x32x16_bf16 v[120:135], v[56:59], v[232:235], v[120:135]
s_waitcnt lgkmcnt(4)
ds_read_b128 v[232:235], v248 offset:23552
v_mfma_f32_32x32x16_bf16 v[120:135], v[60:63], v[236:239], v[120:135]
s_waitcnt lgkmcnt(4)
ds_read_b128 v[236:239], v248 offset:26624
v_mfma_f32_32x32x16_bf16 v[120:135], v[64:67], v[216:219], v[120:135]
s_waitcnt lgkmcnt(4)
ds_read_b128 v[216:219], v248 offset:24576
v_mfma_f32_32x32x16_bf16 v[120:135], v[68:71], v[220:223], v[120:135]
v_add_u32 v174, -36864, v242
v_subrev_u32 v175, 66560, v174
v_min_u32 v174, v174, v175
v_add_u32 v174, 90112, v174
v_sub_u32 v175, v174, v242
v_add_u32 v242, v175, v242
v_add_u32_e64 v243, v175, v243
v_add_u32 v244, v175, v244
s_nop 3
v_cvt_pkrtz_f16_f32 v137, v120, v121
v_cvt_pkrtz_f16_f32 v139, v122, v123
v_cvt_pkrtz_f16_f32 v141, v124, v125
v_cvt_pkrtz_f16_f32 v143, v126, v127
v_cvt_pkrtz_f16_f32 v145, v128, v129
v_cvt_pk_f16_f32 v155, v130, v131
v_cvt_pk_f16_f32 v152, v132, v133
v_cvt_pk_f16_f32 v149, v134, v135
s_waitcnt lgkmcnt(1)
ds_read_b128 v[220:223], v248 offset:27648
v_mfma_f32_32x32x16_bf16 v[120:135], v[48:51], v[224:227], 0
v_pk_fma_f16 v154, v155, v155, s48
v_and_b32 v137, s49, v137
v_pk_fma_f16 v151, v152, v152, s48
v_and_b32_e64 v139, s49, v139
v_pk_fma_f16 v148, v149, v149, s48
v_pk_mul_f16 v154, v155, v154
v_bfe_u32 v136, v137, 2, 14
v_pk_mul_f16 v151, v152, v151
v_pk_mul_f16 v148, v149, v148
v_bfe_u32 v138, v139, 2, 14
ds_read_b128 v[224:227], v248 offset:28672
ds_read_u16_d16 v136, v136
ds_read_u16_d16 v138, v138
v_mfma_f32_32x32x16_bf16 v[120:135], v[52:55], v[228:231], v[120:135]
v_exp_f16 v153, v154
v_lshrrev_b32 v137, 18, v137
v_exp_f16 v150, v151
v_lshrrev_b32 v139, 18, v139
v_exp_f16 v147, v148
v_and_b32 v141, s49, v141
v_and_b32_e64 v143, s49, v143
ds_read_b128 v[228:231], v248 offset:31744
ds_read_u16_d16_hi v137, v137
ds_read_u16_d16_hi v139, v139
v_mfma_f32_32x32x16_bf16 v[120:135], v[56:59], v[232:235], v[120:135]
v_exp_f16_sdwa v153, v154 dst_sel:WORD_1 dst_unused:UNUSED_PRESERVE src0_sel:WORD_1
v_bfe_u32 v140, v141, 2, 14
v_exp_f16_sdwa v150, v151 dst_sel:WORD_1 dst_unused:UNUSED_PRESERVE src0_sel:WORD_1
v_bfe_u32 v142, v143, 2, 14
v_exp_f16_sdwa v147, v148 dst_sel:WORD_1 dst_unused:UNUSED_PRESERVE src0_sel:WORD_1
v_lshrrev_b32_e64 v141, 18, v141
v_pk_add_f16 v153, v153, 1.0 op_sel_hi:[1,0]
ds_read_b128 v[232:235], v248 offset:29696
ds_read_u16_d16 v140, v140
ds_read_u16_d16 v142, v142
ds_read_u16_d16_hi v141, v141
v_mfma_f32_32x32x16_bf16 v[120:135], v[60:63], v[236:239], v[120:135]
v_lshrrev_b32_e64 v143, 18, v143
v_pk_add_f16 v150, v150, 1.0 op_sel_hi:[1,0]
v_pk_add_f16 v147, v147, 1.0 op_sel_hi:[1,0]
v_and_b32 v145, s49, v145
v_rcp_f16 v154, v153
v_bfe_u32 v144, v145, 2, 14
v_rcp_f16_e64 v151, v150
v_lshrrev_b32 v145, 18, v145
s_waitcnt lgkmcnt(7)
ds_read_b128 v[236:239], v248 offset:32768
ds_read_u16_d16_hi v143, v143
ds_read_u16_d16 v144, v144
ds_read_u16_d16_hi v145, v145
v_mfma_f32_32x32x16_bf16 v[120:135], v[64:67], v[216:219], v[120:135]
v_rcp_f16_e64 v148, v147
v_rcp_f16_sdwa v154, v153 dst_sel:WORD_1 dst_unused:UNUSED_PRESERVE src0_sel:WORD_1
v_fma_mix_f32 v156, v136, v136, 0 op_sel:[0,0,0] op_sel_hi:[1,1,0]
ds_read_b32 v247, v253 offset:16
s_waitcnt lgkmcnt(9)
v_fma_mix_f32 v156, v137, v137, v156 op_sel:[1,1,0] op_sel_hi:[1,1,0]
v_rcp_f16_sdwa v151, v150 dst_sel:WORD_1 dst_unused:UNUSED_PRESERVE src0_sel:WORD_1
v_fma_mix_f32 v156, v138, v138, v156 op_sel:[0,0,0] op_sel_hi:[1,1,0]
ds_read_b128 v[216:219], v248 offset:30720
v_mfma_f32_32x32x16_bf16 v[120:135], v[68:71], v[220:223], v[120:135]
v_rcp_f16_sdwa v148, v147 dst_sel:WORD_1 dst_unused:UNUSED_PRESERVE src0_sel:WORD_1
v_fma_mix_f32 v156, v139, v139, v156 op_sel:[1,1,0] op_sel_hi:[1,1,0]
v_pk_mul_f16 v155, v155, v154
s_waitcnt lgkmcnt(6)
v_fma_mix_f32 v156, v140, v140, v156 op_sel:[0,0,0] op_sel_hi:[1,1,0]
v_pk_mul_f16 v152, v152, v151
v_fma_mix_f32 v156, v141, v141, v156 op_sel:[1,1,0] op_sel_hi:[1,1,0]
v_pk_mul_f16 v149, v149, v148
v_fma_mix_f32 v156, v155, v155, v156 op_sel:[0,0,0] op_sel_hi:[1,1,0]
v_fma_mix_f32 v156, v142, v142, v156 op_sel:[0,0,0] op_sel_hi:[1,1,0]
v_fma_mix_f32 v156, v155, v155, v156 op_sel:[1,1,0] op_sel_hi:[1,1,0]
s_waitcnt lgkmcnt(4)
v_fma_mix_f32 v156, v143, v143, v156 op_sel:[1,1,0] op_sel_hi:[1,1,0]
v_fma_mix_f32 v156, v152, v152, v156 op_sel:[0,0,0] op_sel_hi:[1,1,0]
v_fma_mix_f32 v156, v152, v152, v156 op_sel:[1,1,0] op_sel_hi:[1,1,0]
s_waitcnt lgkmcnt(2)
v_fma_mix_f32 v156, v144, v144, v156 op_sel:[0,0,0] op_sel_hi:[1,1,0]
v_fma_mix_f32 v156, v149, v149, v156 op_sel:[0,0,0] op_sel_hi:[1,1,0]
v_fma_mix_f32 v156, v145, v145, v156 op_sel:[1,1,0] op_sel_hi:[1,1,0]
v_fma_mix_f32 v156, v149, v149, v156 op_sel:[1,1,0] op_sel_hi:[1,1,0]
s_cmp_lt_u32 s40, 4
s_cbranch_scc0 Lsu5
s_call_b64 s[78:79], Lw1b
s_mov_b64 exec, 1
ds_add_u32 v253, v254 offset:24
s_mov_b64 exec, -1
Lsu5:
s_waitcnt lgkmcnt(0)
v_readfirstlane_b32 s43, v247
s_nop 1
s_cmp_ge_u32 s43, 8
s_cbranch_scc1 Lev1
Lev1w:
s_sleep 1
ds_read_b32 v247, v253 offset:16
s_waitcnt lgkmcnt(0)
v_readfirstlane_b32 s43, v247
s_cmp_eq_u32 s76, 0
s_cbranch_scc1 Lev1
s_sub_u32 s76, s76, 1
s_cmp_lt_u32 s43, 8
s_cbranch_scc1 Lev1w
Lev1:
v_cvt_pkrtz_f16_f32 v137, v120, v121
v_cvt_pkrtz_f16_f32 v139, v122, v123
v_cvt_pkrtz_f16_f32 v141, v124, v125
v_cvt_pkrtz_f16_f32 v143, v126, v127
v_cvt_pkrtz_f16_f32 v145, v128, v129
v_cvt_pk_f16_f32 v155, v130, v131
v_cvt_pk_f16_f32 v152, v132, v133
v_cvt_pk_f16_f32 v149, v134, v135
s_add_u32 m0, s67, 0
s_add_u32 s66, s66, 98304
buffer_load_dwordx4 v240, s[4:7], s66 offen lds
ds_read_b128 v[220:223], v248 offset:33792
v_mfma_f32_32x32x16_bf16 v[120:135], v[48:51], v[224:227], 0
v_pk_fma_f16 v154, v155, v155, s48
v_and_b32 v137, s49, v137
v_pk_fma_f16 v151, v152, v152, s48
v_and_b32_e64 v139, s49, v139
v_pk_fma_f16 v148, v149, v149, s48
v_pk_mul_f16 v154, v155, v154
v_bfe_u32 v136, v137, 2, 14
v_pk_mul_f16 v151, v152, v151
v_pk_mul_f16 v148, v149, v148
v_bfe_u32 v138, v139, 2, 14
s_add_u32 m0, s67, 6656
s_add_u32 s66, s66, 98304
buffer_load_dwordx4 v240, s[4:7], s66 offen lds
ds_read_b128 v[224:227], v248 offset:34816
ds_read_u16_d16 v136, v136
ds_read_u16_d16 v138, v138
v_mfma_f32_32x32x16_bf16 v[120:135], v[52:55], v[228:231], v[120:135]
v_exp_f16 v153, v154
v_lshrrev_b32 v137, 18, v137
v_exp_f16 v150, v151
v_lshrrev_b32 v139, 18, v139
v_exp_f16 v147, v148
v_and_b32 v141, s49, v141
v_and_b32_e64 v143, s49, v143
s_add_u32 m0, s67, 13312
s_add_u32 s66, s66, 98304
buffer_load_dwordx4 v240, s[4:7], s66 offen lds
ds_read_b128 v[228:231], v248 offset:37888
ds_read_u16_d16_hi v137, v137
ds_read_u16_d16_hi v139, v139
v_mfma_f32_32x32x16_bf16 v[120:135], v[56:59], v[232:235], v[120:135]
v_exp_f16_sdwa v153, v154 dst_sel:WORD_1 dst_unused:UNUSED_PRESERVE src0_sel:WORD_1
v_bfe_u32 v140, v141, 2, 14
v_exp_f16_sdwa v150, v151 dst_sel:WORD_1 dst_unused:UNUSED_PRESERVE src0_sel:WORD_1
v_bfe_u32 v142, v143, 2, 14
v_exp_f16_sdwa v147, v148 dst_sel:WORD_1 dst_unused:UNUSED_PRESERVE src0_sel:WORD_1
v_lshrrev_b32_e64 v141, 18, v141
v_pk_add_f16 v153, v153, 1.0 op_sel_hi:[1,0]
s_add_u32 m0, s67, 19968
s_add_u32 s66, s66, 98304
buffer_load_dwordx4 v240, s[4:7], s66 offen lds
s_add_u32 m0, s67, 26624
s_add_u32 s66, s66, 98304
buffer_load_dwordx4 v240, s[4:7], s66 offen lds
ds_read_b128 v[232:235], v248 offset:35840
ds_read_u16_d16 v140, v140
ds_read_u16_d16 v142, v142
ds_read_u16_d16_hi v141, v141
v_mfma_f32_32x32x16_bf16 v[120:135], v[60:63], v[236:239], v[120:135]
v_lshrrev_b32_e64 v143, 18, v143
v_pk_add_f16 v150, v150, 1.0 op_sel_hi:[1,0]
v_pk_add_f16 v147, v147, 1.0 op_sel_hi:[1,0]
v_and_b32 v145, s49, v145
v_rcp_f16 v154, v153
v_bfe_u32 v144, v145, 2, 14
v_rcp_f16 v151, v150
v_lshrrev_b32 v145, 18, v145
s_add_u32 m0, s67, 33280
s_add_u32 s66, s66, 98304
buffer_load_dwordx4 v240, s[4:7], s66 offen lds
ds_read_b128 v[236:239], v248 offset:38912
ds_read_u16_d16_hi v143, v143
ds_read_u16_d16 v144, v144
ds_read_u16_d16_hi v145, v145
v_mfma_f32_32x32x16_bf16 v[120:135], v[64:67], v[216:219], v[120:135]
v_rcp_f16_e64 v148, v147
v_rcp_f16_sdwa v154, v153 dst_sel:WORD_1 dst_unused:UNUSED_PRESERVE src0_sel:WORD_1
s_waitcnt lgkmcnt(8)
v_fma_mix_f32 v157, v136, v136, 0 op_sel:[0,0,0] op_sel_hi:[1,1,0]
v_fma_mix_f32 v157, v137, v137, v157 op_sel:[1,1,0] op_sel_hi:[1,1,0]
v_rcp_f16_sdwa v151, v150 dst_sel:WORD_1 dst_unused:UNUSED_PRESERVE src0_sel:WORD_1
v_fma_mix_f32 v157, v138, v138, v157 op_sel:[0,0,0] op_sel_hi:[1,1,0]
s_add_u32 m0, s67, 39936
s_add_u32 s66, s66, 98304
buffer_load_dwordx4 v240, s[4:7], s66 offen lds
ds_read_b128 v[216:219], v248 offset:36864
v_mfma_f32_32x32x16_bf16 v[120:135], v[68:71], v[220:223], v[120:135]
v_rcp_f16_sdwa v148, v147 dst_sel:WORD_1 dst_unused:UNUSED_PRESERVE src0_sel:WORD_1
v_fma_mix_f32 v157, v139, v139, v157 op_sel:[1,1,0] op_sel_hi:[1,1,0]
v_pk_mul_f16 v155, v155, v154
s_waitcnt lgkmcnt(5)
v_fma_mix_f32 v157, v140, v140, v157 op_sel:[0,0,0] op_sel_hi:[1,1,0]
v_pk_mul_f16 v152, v152, v151
v_fma_mix_f32 v157, v141, v141, v157 op_sel:[1,1,0] op_sel_hi:[1,1,0]
v_pk_mul_f16 v149, v149, v148
v_fma_mix_f32 v157, v155, v155, v157 op_sel:[0,0,0] op_sel_hi:[1,1,0]
v_fma_mix_f32 v157, v142, v142, v157 op_sel:[0,0,0] op_sel_hi:[1,1,0]
v_fma_mix_f32 v157, v155, v155, v157 op_sel:[1,1,0] op_sel_hi:[1,1,0]
s_add_u32 m0, s67, 46592
s_add_u32 s66, s66, 98304
buffer_load_dwordx4 v240, s[4:7], s66 offen lds
s_waitcnt lgkmcnt(1)
v_fma_mix_f32 v157, v143, v143, v157 op_sel:[1,1,0] op_sel_hi:[1,1,0]
v_fma_mix_f32 v157, v152, v152, v157 op_sel:[0,0,0] op_sel_hi:[1,1,0]
v_fma_mix_f32 v157, v152, v152, v157 op_sel:[1,1,0] op_sel_hi:[1,1,0]
v_fma_mix_f32 v157, v144, v144, v157 op_sel:[0,0,0] op_sel_hi:[1,1,0]
v_fma_mix_f32 v157, v149, v149, v157 op_sel:[0,0,0] op_sel_hi:[1,1,0]
v_fma_mix_f32 v157, v145, v145, v157 op_sel:[1,1,0] op_sel_hi:[1,1,0]
v_fma_mix_f32 v157, v149, v149, v157 op_sel:[1,1,0] op_sel_hi:[1,1,0]
s_setprio 1
v_cvt_pkrtz_f16_f32 v137, v120, v121
v_cvt_pkrtz_f16_f32 v139, v122, v123
v_cvt_pkrtz_f16_f32 v141, v124, v125
v_cvt_pkrtz_f16_f32 v143, v126, v127
v_cvt_pkrtz_f16_f32 v145, v128, v129
v_cvt_pk_f16_f32 v155, v130, v131
v_cvt_pk_f16_f32 v152, v132, v133
v_cvt_pk_f16_f32 v149, v134, v135
ds_read_b128 v[220:223], v248 offset:39936
v_mfma_f32_32x32x16_bf16 v[120:135], v[48:51], v[224:227], 0
v_pk_fma_f16 v154, v155, v155, s48
v_and_b32_e64 v137, s49, v137
v_pk_fma_f16 v151, v152, v152, s48
v_and_b32_e64 v139, s49, v139
v_pk_fma_f16 v148, v149, v149, s48
v_pk_mul_f16 v154, v155, v154
v_bfe_u32 v136, v137, 2, 14
v_pk_mul_f16 v151, v152, v151
v_pk_mul_f16 v148, v149, v148
v_bfe_u32 v138, v139, 2, 14
ds_read_u16_d16 v136, v136
ds_read_b32 v247, v253 offset:24
ds_read_u16_d16 v138, v138
v_mfma_f32_32x32x16_bf16 v[120:135], v[52:55], v[228:231], v[120:135]
v_exp_f16 v153, v154
v_lshrrev_b32 v137, 18, v137
v_exp_f16 v150, v151
v_lshrrev_b32 v139, 18, v139
v_exp_f16 v147, v148
v_and_b32 v141, s49, v141
v_and_b32_e64 v143, s49, v143
ds_read_u16_d16_hi v137, v137
ds_read_u16_d16_hi v139, v139
v_mfma_f32_32x32x16_bf16 v[120:135], v[56:59], v[232:235], v[120:135]
v_exp_f16_sdwa v153, v154 dst_sel:WORD_1 dst_unused:UNUSED_PRESERVE src0_sel:WORD_1
v_bfe_u32 v140, v141, 2, 14
v_exp_f16_sdwa v150, v151 dst_sel:WORD_1 dst_unused:UNUSED_PRESERVE src0_sel:WORD_1
v_bfe_u32 v142, v143, 2, 14
v_exp_f16_sdwa v147, v148 dst_sel:WORD_1 dst_unused:UNUSED_PRESERVE src0_sel:WORD_1
v_lshrrev_b32_e64 v141, 18, v141
v_pk_add_f16 v153, v153, 1.0 op_sel_hi:[1,0]
ds_read_u16_d16 v140, v140
ds_read_u16_d16 v142, v142
ds_read_u16_d16_hi v141, v141
s_waitcnt lgkmcnt(6)
v_readfirstlane_b32 s43, v247
s_nop 1
s_cmp_ge_u32 s43, 4
s_cbranch_scc1 Lev2
Lev2w:
s_sleep 1
ds_read_b32 v247, v253 offset:24
s_waitcnt lgkmcnt(0)
v_readfirstlane_b32 s43, v247
s_cmp_eq_u32 s76, 0
s_cbranch_scc1 Lev2
s_sub_u32 s76, s76, 1
s_cmp_lt_u32 s43, 4
s_cbranch_scc1 Lev2w
Lev2:
ds_read_b128 v[224:227], v248 offset:40960
ds_read_b128 v[228:231], v248 offset:44032
ds_read_b128 v[232:235], v248 offset:41984
v_mfma_f32_32x32x16_bf16 v[120:135], v[60:63], v[236:239], v[120:135]
v_lshrrev_b32 v143, 18, v143
v_pk_add_f16 v150, v150, 1.0 op_sel_hi:[1,0]
v_pk_add_f16 v147, v147, 1.0 op_sel_hi:[1,0]
v_and_b32 v145, s49, v145
v_rcp_f16 v154, v153
v_bfe_u32 v144, v145, 2, 14
v_rcp_f16 v151, v150
v_lshrrev_b32 v145, 18, v145
ds_read_b128 v[236:239], v248 offset:45056
ds_read_u16_d16_hi v143, v143
ds_read_u16_d16 v144, v144
ds_read_u16_d16_hi v145, v145
v_mfma_f32_32x32x16_bf16 v[120:135], v[64:67], v[216:219], v[120:135]
v_rcp_f16 v148, v147
v_rcp_f16_sdwa v154, v153 dst_sel:WORD_1 dst_unused:UNUSED_PRESERVE src0_sel:WORD_1
v_fma_mix_f32 v158, v136, v136, 0 op_sel:[0,0,0] op_sel_hi:[1,1,0]
s_waitcnt lgkmcnt(7)
v_fma_mix_f32 v158, v137, v137, v158 op_sel:[1,1,0] op_sel_hi:[1,1,0]
v_rcp_f16_sdwa v151, v150 dst_sel:WORD_1 dst_unused:UNUSED_PRESERVE src0_sel:WORD_1
v_fma_mix_f32 v158, v138, v138, v158 op_sel:[0,0,0] op_sel_hi:[1,1,0]
ds_read_b128 v[216:219], v248 offset:43008
v_mfma_f32_32x32x16_bf16 v[120:135], v[68:71], v[220:223], v[120:135]
v_rcp_f16_sdwa v148, v147 dst_sel:WORD_1 dst_unused:UNUSED_PRESERVE src0_sel:WORD_1
v_fma_mix_f32 v158, v139, v139, v158 op_sel:[1,1,0] op_sel_hi:[1,1,0]
v_pk_mul_f16 v155, v155, v154
v_fma_mix_f32 v158, v140, v140, v158 op_sel:[0,0,0] op_sel_hi:[1,1,0]
v_pk_mul_f16 v152, v152, v151
v_fma_mix_f32 v158, v141, v141, v158 op_sel:[1,1,0] op_sel_hi:[1,1,0]
v_pk_mul_f16 v149, v149, v148
v_fma_mix_f32 v158, v155, v155, v158 op_sel:[0,0,0] op_sel_hi:[1,1,0]
v_fma_mix_f32 v158, v142, v142, v158 op_sel:[0,0,0] op_sel_hi:[1,1,0]
v_fma_mix_f32 v158, v155, v155, v158 op_sel:[1,1,0] op_sel_hi:[1,1,0]
s_waitcnt lgkmcnt(3)
v_fma_mix_f32 v158, v143, v143, v158 op_sel:[1,1,0] op_sel_hi:[1,1,0]
v_fma_mix_f32 v158, v152, v152, v158 op_sel:[0,0,0] op_sel_hi:[1,1,0]
v_fma_mix_f32 v158, v152, v152, v158 op_sel:[1,1,0] op_sel_hi:[1,1,0]
s_waitcnt lgkmcnt(1)
v_fma_mix_f32 v158, v144, v144, v158 op_sel:[0,0,0] op_sel_hi:[1,1,0]
v_fma_mix_f32 v158, v149, v149, v158 op_sel:[0,0,0] op_sel_hi:[1,1,0]
v_fma_mix_f32 v158, v145, v145, v158 op_sel:[1,1,0] op_sel_hi:[1,1,0]
v_fma_mix_f32 v158, v149, v149, v158 op_sel:[1,1,0] op_sel_hi:[1,1,0]
v_cvt_pkrtz_f16_f32 v137, v120, v121
v_cvt_pkrtz_f16_f32 v139, v122, v123
v_cvt_pkrtz_f16_f32 v141, v124, v125
v_cvt_pkrtz_f16_f32 v143, v126, v127
v_cvt_pkrtz_f16_f32 v145, v128, v129
v_cvt_pk_f16_f32 v155, v130, v131
v_cvt_pk_f16_f32 v152, v132, v133
v_cvt_pk_f16_f32 v149, v134, v135
ds_read_b128 v[220:223], v248 offset:46080
v_mfma_f32_32x32x16_bf16 v[120:135], v[48:51], v[224:227], 0
v_pk_fma_f16 v154, v155, v155, s48
v_and_b32_e64 v137, s49, v137
v_pk_fma_f16 v151, v152, v152, s48
v_and_b32_e64 v139, s49, v139
v_pk_fma_f16 v148, v149, v149, s48
v_pk_mul_f16 v154, v155, v154
v_bfe_u32 v136, v137, 2, 14
v_pk_mul_f16 v151, v152, v151
v_pk_mul_f16 v148, v149, v148
v_bfe_u32 v138, v139, 2, 14
ds_read_b128 v[224:227], v248 offset:47104
ds_read_u16_d16 v136, v136
ds_read_u16_d16 v138, v138
v_mfma_f32_32x32x16_bf16 v[120:135], v[52:55], v[228:231], v[120:135]
v_exp_f16 v153, v154
v_lshrrev_b32 v137, 18, v137
v_exp_f16 v150, v151
v_lshrrev_b32 v139, 18, v139
v_exp_f16 v147, v148
v_and_b32 v141, s49, v141
v_and_b32_e64 v143, s49, v143
ds_read_b128 v[228:231], v248 offset:50176
ds_read_u16_d16_hi v137, v137
ds_read_u16_d16_hi v139, v139
v_mfma_f32_32x32x16_bf16 v[120:135], v[56:59], v[232:235], v[120:135]
v_exp_f16_sdwa v153, v154 dst_sel:WORD_1 dst_unused:UNUSED_PRESERVE src0_sel:WORD_1
v_bfe_u32 v140, v141, 2, 14
v_exp_f16_sdwa v150, v151 dst_sel:WORD_1 dst_unused:UNUSED_PRESERVE src0_sel:WORD_1
v_bfe_u32 v142, v143, 2, 14
v_exp_f16_sdwa v147, v148 dst_sel:WORD_1 dst_unused:UNUSED_PRESERVE src0_sel:WORD_1
v_lshrrev_b32_e64 v141, 18, v141
v_pk_add_f16 v153, v153, 1.0 op_sel_hi:[1,0]
ds_read_b128 v[232:235], v248 offset:48128
ds_read_u16_d16 v140, v140
ds_read_u16_d16 v142, v142
ds_read_u16_d16_hi v141, v141
v_mfma_f32_32x32x16_bf16 v[120:135], v[60:63], v[236:239], v[120:135]
v_lshrrev_b32_e64 v143, 18, v143
v_pk_add_f16 v150, v150, 1.0 op_sel_hi:[1,0]
v_pk_add_f16 v147, v147, 1.0 op_sel_hi:[1,0]
v_and_b32 v145, s49, v145
v_rcp_f16 v154, v153
v_bfe_u32 v144, v145, 2, 14
v_rcp_f16_e64 v151, v150
v_lshrrev_b32 v145, 18, v145
s_waitcnt lgkmcnt(7)
ds_read_b128 v[236:239], v248 offset:51200
ds_read_u16_d16_hi v143, v143
ds_read_u16_d16 v144, v144
ds_read_u16_d16_hi v145, v145
v_mfma_f32_32x32x16_bf16 v[120:135], v[64:67], v[216:219], v[120:135]
v_rcp_f16 v148, v147
v_rcp_f16_sdwa v154, v153 dst_sel:WORD_1 dst_unused:UNUSED_PRESERVE src0_sel:WORD_1
v_fma_mix_f32 v159, v136, v136, 0 op_sel:[0,0,0] op_sel_hi:[1,1,0]
s_waitcnt lgkmcnt(8)
v_fma_mix_f32 v159, v137, v137, v159 op_sel:[1,1,0] op_sel_hi:[1,1,0]
v_rcp_f16_sdwa v151, v150 dst_sel:WORD_1 dst_unused:UNUSED_PRESERVE src0_sel:WORD_1
v_fma_mix_f32 v159, v138, v138, v159 op_sel:[0,0,0] op_sel_hi:[1,1,0]
ds_read_b128 v[216:219], v248 offset:49152
v_mfma_f32_32x32x16_bf16 v[120:135], v[68:71], v[220:223], v[120:135]
v_rcp_f16_sdwa v148, v147 dst_sel:WORD_1 dst_unused:UNUSED_PRESERVE src0_sel:WORD_1
v_fma_mix_f32 v159, v139, v139, v159 op_sel:[1,1,0] op_sel_hi:[1,1,0]
s_cmp_eq_u32 s40, 7
s_cbranch_scc1 Lrdy8
s_waitcnt vmcnt(0)
Lrdy8:
s_mov_b64 exec, 1
ds_add_u32 v253, v254 offset:12
s_mov_b64 exec, -1
v_pk_mul_f16 v155, v155, v154
s_waitcnt lgkmcnt(6)
v_fma_mix_f32 v159, v140, v140, v159 op_sel:[0,0,0] op_sel_hi:[1,1,0]
v_pk_mul_f16 v152, v152, v151
v_fma_mix_f32 v159, v141, v141, v159 op_sel:[1,1,0] op_sel_hi:[1,1,0]
v_pk_mul_f16 v149, v149, v148
v_fma_mix_f32 v159, v155, v155, v159 op_sel:[0,0,0] op_sel_hi:[1,1,0]
v_fma_mix_f32 v159, v142, v142, v159 op_sel:[0,0,0] op_sel_hi:[1,1,0]
v_fma_mix_f32 v159, v155, v155, v159 op_sel:[1,1,0] op_sel_hi:[1,1,0]
s_waitcnt lgkmcnt(2)
v_fma_mix_f32 v159, v143, v143, v159 op_sel:[1,1,0] op_sel_hi:[1,1,0]
v_fma_mix_f32 v159, v152, v152, v159 op_sel:[0,0,0] op_sel_hi:[1,1,0]
v_fma_mix_f32 v159, v152, v152, v159 op_sel:[1,1,0] op_sel_hi:[1,1,0]
v_fma_mix_f32 v159, v144, v144, v159 op_sel:[0,0,0] op_sel_hi:[1,1,0]
v_fma_mix_f32 v159, v149, v149, v159 op_sel:[0,0,0] op_sel_hi:[1,1,0]
v_fma_mix_f32 v159, v145, v145, v159 op_sel:[1,1,0] op_sel_hi:[1,1,0]
v_fma_mix_f32 v159, v149, v149, v159 op_sel:[1,1,0] op_sel_hi:[1,1,0]
v_cvt_pkrtz_f16_f32 v137, v120, v121
v_cvt_pkrtz_f16_f32 v139, v122, v123
v_cvt_pkrtz_f16_f32 v141, v124, v125
v_cvt_pkrtz_f16_f32 v143, v126, v127
v_cvt_pkrtz_f16_f32 v145, v128, v129
v_cvt_pk_f16_f32 v155, v130, v131
v_cvt_pk_f16_f32 v152, v132, v133
v_cvt_pk_f16_f32 v149, v134, v135
s_setprio 0
ds_read_b128 v[220:223], v248 offset:52224
v_mfma_f32_32x32x16_bf16 v[120:135], v[48:51], v[224:227], 0
v_pk_fma_f16 v154, v155, v155, s48
v_and_b32_e64 v137, s49, v137
v_pk_fma_f16 v151, v152, v152, s48
v_and_b32_e64 v139, s49, v139
v_pk_fma_f16 v148, v149, v149, s48
v_pk_mul_f16 v154, v155, v154
v_bfe_u32 v136, v137, 2, 14
v_pk_mul_f16 v151, v152, v151
v_pk_mul_f16 v148, v149, v148
v_bfe_u32 v138, v139, 2, 14
ds_read_b128 v[224:227], v250 offset:65520
ds_read_u16_d16 v136, v136
ds_read_u16_d16 v138, v138
v_mfma_f32_32x32x16_bf16 v[120:135], v[52:55], v[228:231], v[120:135]
v_exp_f16 v153, v154
v_lshrrev_b32 v137, 18, v137
v_exp_f16 v150, v151
v_lshrrev_b32 v139, 18, v139
v_exp_f16 v147, v148
v_and_b32 v141, s49, v141
v_and_b32_e64 v143, s49, v143
ds_read_b128 v[228:231], v248 offset:53248
ds_read_u16_d16_hi v137, v137
ds_read_b32 v247, v253 offset:12
ds_read_u16_d16_hi v139, v139
v_mfma_f32_32x32x16_bf16 v[120:135], v[56:59], v[232:235], v[120:135]
v_exp_f16_sdwa v153, v154 dst_sel:WORD_1 dst_unused:UNUSED_PRESERVE src0_sel:WORD_1
v_bfe_u32 v140, v141, 2, 14
v_exp_f16_sdwa v150, v151 dst_sel:WORD_1 dst_unused:UNUSED_PRESERVE src0_sel:WORD_1
v_bfe_u32 v142, v143, 2, 14
v_exp_f16_sdwa v147, v148 dst_sel:WORD_1 dst_unused:UNUSED_PRESERVE src0_sel:WORD_1
v_lshrrev_b32_e64 v141, 18, v141
v_pk_add_f16 v153, v153, 1.0 op_sel_hi:[1,0]
ds_read_b128 v[232:235], v248 offset:56320
ds_read_u16_d16 v140, v140
ds_read_u16_d16 v142, v142
ds_read_u16_d16_hi v141, v141
v_mfma_f32_32x32x16_bf16 v[120:135], v[60:63], v[236:239], v[120:135]
v_lshrrev_b32_e64 v143, 18, v143
v_pk_add_f16 v150, v150, 1.0 op_sel_hi:[1,0]
v_pk_add_f16 v147, v147, 1.0 op_sel_hi:[1,0]
v_and_b32 v145, s49, v145
v_rcp_f16 v154, v153
v_bfe_u32 v144, v145, 2, 14
ds_read_u16_d16_hi v143, v143
ds_read_u16_d16 v144, v144
s_waitcnt lgkmcnt(7)
v_readfirstlane_b32 s43, v247
s_nop 1
s_cmp_ge_u32 s43, 16
s_cbranch_scc1 Lev3
Lev3w:
s_sleep 1
ds_read_b32 v247, v253 offset:12
s_waitcnt lgkmcnt(0)
v_readfirstlane_b32 s43, v247
s_cmp_eq_u32 s76, 0
s_cbranch_scc1 Lev3
s_sub_u32 s76, s76, 1
s_cmp_lt_u32 s43, 16
s_cbranch_scc1 Lev3w
Lev3:
v_rcp_f16 v151, v150
v_lshrrev_b32_e64 v145, 18, v145
ds_read_b128 v[236:239], v245 offset:6528
ds_read_b128 v[192:195], v244 offset:128
ds_read_b128 v[196:199], v244 offset:64
ds_read_u16_d16_hi v145, v145
v_mfma_f32_32x32x16_bf16 v[120:135], v[64:67], v[216:219], v[120:135]
v_rcp_f16 v148, v147
v_rcp_f16_sdwa v154, v153 dst_sel:WORD_1 dst_unused:UNUSED_PRESERVE src0_sel:WORD_1
v_fma_mix_f32 v160, v136, v136, 0 op_sel:[0,0,0] op_sel_hi:[1,1,0]
v_fma_mix_f32 v160, v137, v137, v160 op_sel:[1,1,0] op_sel_hi:[1,1,0]
v_rcp_f16_sdwa v151, v150 dst_sel:WORD_1 dst_unused:UNUSED_PRESERVE src0_sel:WORD_1
v_fma_mix_f32 v160, v138, v138, v160 op_sel:[0,0,0] op_sel_hi:[1,1,0]
ds_read_b128 v[216:219], v248 offset:54272
v_mfma_f32_32x32x16_bf16 v[120:135], v[68:71], v[220:223], v[120:135]
v_rcp_f16_sdwa v148, v147 dst_sel:WORD_1 dst_unused:UNUSED_PRESERVE src0_sel:WORD_1
s_waitcnt lgkmcnt(5)
v_fma_mix_f32 v160, v139, v139, v160 op_sel:[1,1,0] op_sel_hi:[1,1,0]
v_pk_mul_f16 v155, v155, v154
v_fma_mix_f32 v160, v140, v140, v160 op_sel:[0,0,0] op_sel_hi:[1,1,0]
v_pk_mul_f16 v152, v152, v151
v_fma_mix_f32 v160, v141, v141, v160 op_sel:[1,1,0] op_sel_hi:[1,1,0]
v_pk_mul_f16 v149, v149, v148
v_fma_mix_f32 v160, v155, v155, v160 op_sel:[0,0,0] op_sel_hi:[1,1,0]
v_fma_mix_f32 v160, v142, v142, v160 op_sel:[0,0,0] op_sel_hi:[1,1,0]
v_fma_mix_f32 v160, v155, v155, v160 op_sel:[1,1,0] op_sel_hi:[1,1,0]
v_fma_mix_f32 v160, v143, v143, v160 op_sel:[1,1,0] op_sel_hi:[1,1,0]
v_fma_mix_f32 v160, v152, v152, v160 op_sel:[0,0,0] op_sel_hi:[1,1,0]
v_fma_mix_f32 v160, v152, v152, v160 op_sel:[1,1,0] op_sel_hi:[1,1,0]
v_fma_mix_f32 v160, v144, v144, v160 op_sel:[0,0,0] op_sel_hi:[1,1,0]
v_fma_mix_f32 v160, v149, v149, v160 op_sel:[0,0,0] op_sel_hi:[1,1,0]
s_waitcnt lgkmcnt(1)
v_fma_mix_f32 v160, v145, v145, v160 op_sel:[1,1,0] op_sel_hi:[1,1,0]
v_fma_mix_f32 v160, v149, v149, v160 op_sel:[1,1,0] op_sel_hi:[1,1,0]
s_setprio 2
v_mfma_f32_32x32x16_bf16 v[0:15], v[224:227], v[224:227], 0
ds_read_b128 v[220:223], v245 offset:6144
ds_read_b128 v[200:203], v244
ds_read_b128 v[204:207], v243 offset:128
v_cvt_pkrtz_f16_f32 v137, v120, v121
v_cvt_pkrtz_f16_f32 v139, v122, v123
v_cvt_pkrtz_f16_f32 v141, v124, v125
v_mfma_f32_32x32x16_bf16 v[16:31], v[224:227], v[224:227], 0
v_cvt_pkrtz_f16_f32 v143, v126, v127
v_cvt_pkrtz_f16_f32 v145, v128, v129
v_cvt_pk_f16_f32 v155, v130, v131
v_mfma_f32_32x32x16_bf16 v[32:47], v[224:227], v[224:227], 0
v_cvt_pk_f16_f32 v152, v132, v133
v_cvt_pk_f16_f32 v149, v134, v135
v_pk_fma_f16 v154, v155, v155, s48
v_mfma_f32_32x32x16_bf16 v[120:135], v[48:51], v[228:231], 0
ds_read_b128 v[224:227], v248 offset:57344
v_and_b32_e64 v137, s49, v137
v_pk_fma_f16 v151, v152, v152, s48
v_and_b32_e64 v139, s49, v139
v_pk_fma_f16 v148, v149, v149, s48
v_pk_mul_f16 v154, v155, v154
v_bfe_u32 v136, v137, 2, 14
v_mfma_f32_32x32x16_bf16 v[120:135], v[52:55], v[232:235], v[120:135]
ds_read_b128 v[228:231], v245 offset:5760
ds_read_b128 v[208:211], v243 offset:64
ds_read_b128 v[212:215], v243
ds_read_u16_d16 v136, v136
v_pk_mul_f16 v151, v152, v151
v_pk_mul_f16 v148, v149, v148
v_bfe_u32 v138, v139, 2, 14
v_exp_f16 v153, v154
v_lshrrev_b32 v137, 18, v137
v_smfmac_f32_16x16x32_bf16 v[40:43], v[238:239], v[192:195], v246
ds_read_b128 v[232:235], v248 offset:55296
ds_read_u16_d16 v138, v138
ds_read_u16_d16_hi v137, v137
v_exp_f16 v150, v151
v_lshrrev_b32 v139, 18, v139
v_smfmac_f32_16x16x32_bf16 v[24:27], v[236:237], v[196:199], v246
v_exp_f16_e64 v147, v148
v_and_b32 v141, s49, v141
s_waitcnt lgkmcnt(7)
v_mfma_f32_32x32x16_bf16 v[120:135], v[56:59], v[216:219], v[120:135]
ds_read_b128 v[236:239], v245 offset:5376
ds_read_b128 v[192:195], v242 offset:128
ds_read_b128 v[196:199], v242 offset:64
ds_read_u16_d16_hi v139, v139
v_and_b32_e64 v143, s49, v143
v_exp_f16_sdwa v153, v154 dst_sel:WORD_1 dst_unused:UNUSED_PRESERVE src0_sel:WORD_1
v_bfe_u32 v140, v141, 2, 14
v_exp_f16_sdwa v150, v151 dst_sel:WORD_1 dst_unused:UNUSED_PRESERVE src0_sel:WORD_1
v_smfmac_f32_16x16x32_bf16 v[8:11], v[222:223], v[200:203], v246
ds_read_b128 v[216:219], v248 offset:58368
ds_read_u16_d16 v140, v140
v_bfe_u32 v142, v143, 2, 14
v_exp_f16_sdwa v147, v148 dst_sel:WORD_1 dst_unused:UNUSED_PRESERVE src0_sel:WORD_1
v_smfmac_f32_16x16x32_bf16 v[40:43], v[220:221], v[204:207], v246
v_lshrrev_b32_e64 v141, 18, v141
v_pk_add_f16 v153, v153, 1.0 op_sel_hi:[1,0]
v_lshrrev_b32 v143, 18, v143
v_mfma_f32_32x32x16_bf16 v[120:135], v[60:63], v[224:227], v[120:135]
ds_read_b128 v[220:223], v245 offset:4992
ds_read_b128 v[200:203], v242
v_xor_b32 v244, 16, v244
ds_read_b128 v[204:207], v244 offset:128
ds_read_u16_d16 v142, v142
ds_read_u16_d16_hi v141, v141
ds_read_u16_d16_hi v143, v143
v_pk_add_f16 v150, v150, 1.0 op_sel_hi:[1,0]
v_pk_add_f16 v147, v147, 1.0 op_sel_hi:[1,0]
v_and_b32_e64 v145, s49, v145
v_rcp_f16 v154, v153
v_bfe_u32 v144, v145, 2, 14
s_waitcnt lgkmcnt(8)
v_smfmac_f32_16x16x32_bf16 v[24:27], v[230:231], v[208:211], v246
ds_read_b128 v[224:227], v245 offset:4608
ds_read_u16_d16 v144, v144
v_rcp_f16 v151, v150
v_lshrrev_b32 v145, 18, v145
v_smfmac_f32_16x16x32_bf16 v[8:11], v[228:229], v[212:215], v246
v_rcp_f16_e64 v148, v147
v_mfma_f32_32x32x16_bf16 v[120:135], v[64:67], v[232:235], v[120:135]
ds_read_b128 v[208:211], v244 offset:64
ds_read_b128 v[212:215], v244
ds_read_b128 v[228:231], v248 offset:59392
ds_read_u16_d16_hi v145, v145
v_rcp_f16_sdwa v154, v153 dst_sel:WORD_1 dst_unused:UNUSED_PRESERVE src0_sel:WORD_1
v_fma_mix_f32 v161, v136, v136, 0 op_sel:[0,0,0] op_sel_hi:[1,1,0]
v_fma_mix_f32 v161, v137, v137, v161 op_sel:[1,1,0] op_sel_hi:[1,1,0]
v_rcp_f16_sdwa v151, v150 dst_sel:WORD_1 dst_unused:UNUSED_PRESERVE src0_sel:WORD_1
v_fma_mix_f32 v161, v138, v138, v161 op_sel:[0,0,0] op_sel_hi:[1,1,0]
v_smfmac_f32_16x16x32_bf16 v[40:43], v[238:239], v[192:195], v246
ds_read_b128 v[232:235], v248 offset:62464
v_rcp_f16_sdwa v148, v147 dst_sel:WORD_1 dst_unused:UNUSED_PRESERVE src0_sel:WORD_1
v_fma_mix_f32 v161, v139, v139, v161 op_sel:[1,1,0] op_sel_hi:[1,1,0]
v_smfmac_f32_16x16x32_bf16 v[24:27], v[236:237], v[196:199], v246
v_pk_mul_f16 v155, v155, v154
s_waitcnt lgkmcnt(7)
v_fma_mix_f32 v161, v140, v140, v161 op_sel:[0,0,0] op_sel_hi:[1,1,0]
v_pk_mul_f16 v152, v152, v151
v_mfma_f32_32x32x16_bf16 v[120:135], v[68:71], v[216:219], v[120:135]
ds_read_b128 v[236:239], v248 offset:60416
v_fma_mix_f32 v161, v141, v141, v161 op_sel:[1,1,0] op_sel_hi:[1,1,0]
v_pk_mul_f16 v149, v149, v148
v_fma_mix_f32 v161, v155, v155, v161 op_sel:[0,0,0] op_sel_hi:[1,1,0]
v_fma_mix_f32 v161, v142, v142, v161 op_sel:[0,0,0] op_sel_hi:[1,1,0]
v_fma_mix_f32 v161, v155, v155, v161 op_sel:[1,1,0] op_sel_hi:[1,1,0]
v_fma_mix_f32 v161, v143, v143, v161 op_sel:[1,1,0] op_sel_hi:[1,1,0]
v_smfmac_f32_16x16x32_bf16 v[8:11], v[222:223], v[200:203], v246
ds_read_b128 v[216:219], v245 offset:4224
v_xor_b32 v243, 16, v243
ds_read_b128 v[192:195], v243 offset:128
ds_read_b128 v[196:199], v243 offset:64
v_fma_mix_f32 v161, v152, v152, v161 op_sel:[0,0,0] op_sel_hi:[1,1,0]
v_fma_mix_f32 v161, v152, v152, v161 op_sel:[1,1,0] op_sel_hi:[1,1,0]
s_waitcnt lgkmcnt(5)
v_fma_mix_f32 v161, v144, v144, v161 op_sel:[0,0,0] op_sel_hi:[1,1,0]
v_smfmac_f32_16x16x32_bf16 v[44:47], v[220:221], v[204:207], v246
v_fma_mix_f32 v161, v149, v149, v161 op_sel:[0,0,0] op_sel_hi:[1,1,0]
v_fma_mix_f32 v161, v145, v145, v161 op_sel:[1,1,0] op_sel_hi:[1,1,0]
v_fma_mix_f32 v161, v149, v149, v161 op_sel:[1,1,0] op_sel_hi:[1,1,0]
s_cmp_lg_u32 s40, 7
s_cbranch_scc1 Lnosent
v_mov_b32 v180, -1
v_mov_b32 v181, -1
v_mov_b32 v182, -1
v_mov_b32 v183, -1
v_lshlrev_b32 v176, 12, v251
v_add_u32 v177, 262144, v176
v_cmp_gt_u32 vcc, 32, v251
v_mov_b32 v178, 2147483648
s_nop 0
v_cndmask_b32 v177, v178, v177, vcc
s_lshl_b32 s43, s2, 4
buffer_store_dwordx4 v[180:183], v176, s[32:35], s43 offen sc1
buffer_store_dwordx4 v[180:183], v177, s[32:35], s43 offen sc1
s_add_u32 s43, s43, 393216
s_cmp_lt_u32 s2, 96
s_cselect_b32 s43, s43, 1073741824
v_lshlrev_b32_e64 v178, 11, v251
s_mov_b64 exec, 0xff
buffer_store_dwordx4 v[180:183], v178, s[32:35], s43 offen sc1
s_mov_b64 exec, -1
s_sub_u32 s43, s2, 96
s_cmp_lt_u32 s43, 96
s_cbranch_scc0 Lnobias
s_lshl_b32 s44, s43, 1
v_mul_u32_u24 v176, 192, v251
v_lshlrev_b32 v177, 1, v251
s_add_u32 s45, s44, 0
buffer_load_ushort v178, v176, s[16:19], s45 offen
buffer_load_ushort v184, v177, s[28:31], 0 offen offset:0
s_add_u32 s45, s44, 12288
buffer_load_ushort v179, v176, s[16:19], s45 offen
buffer_load_ushort v185, v177, s[28:31], 0 offen offset:128
s_add_u32 s45, s44, 24576
buffer_load_ushort v180, v176, s[16:19], s45 offen
buffer_load_ushort v186, v177, s[28:31], 0 offen offset:256
s_add_u32 s45, s44, 36864
buffer_load_ushort v181, v176, s[16:19], s45 offen
buffer_load_ushort v187, v177, s[28:31], 0 offen offset:384
s_add_u32 s45, s44, 49152
buffer_load_ushort v182, v176, s[16:19], s45 offen
buffer_load_ushort v188, v177, s[28:31], 0 offen offset:512
s_add_u32 s45, s44, 61440
buffer_load_ushort v183, v176, s[16:19], s45 offen
buffer_load_ushort v189, v177, s[28:31], 0 offen offset:640
Lnobias:
s_nop 1
Lnosent:
s_setprio 1
v_smfmac_f32_16x16x32_bf16 v[28:31], v[226:227], v[208:211], v246
ds_read_b128 v[220:223], v248 offset:63488
v_cvt_pkrtz_f16_f32 v137, v120, v121
v_cvt_pkrtz_f16_f32 v139, v122, v123
v_cvt_pkrtz_f16_f32 v141, v124, v125
v_cvt_pkrtz_f16_f32 v143, v126, v127
v_smfmac_f32_16x16x32_bf16 v[12:15], v[224:225], v[212:215], v246
v_cvt_pk_f16_f32 v155, v128, v129
v_cvt_pk_f16_f32 v152, v130, v131
v_cvt_pk_f16_f32 v149, v132, v133
v_cvt_pk_f16_f32 v146, v134, v135
v_mfma_f32_32x32x16_bf16 v[120:135], v[48:51], v[228:231], 0
ds_read_b128 v[224:227], v248 offset:61440
v_pk_fma_f16 v154, v155, v155, s48
v_and_b32_e64 v137, s49, v137
v_pk_fma_f16 v151, v152, v152, s48
v_pk_fma_f16 v148, v149, v149, s48
v_and_b32_e64 v139, s49, v139
v_pk_fma_f16 v145, v146, v146, s48
v_pk_mul_f16 v154, v155, v154
v_bfe_u32 v136, v137, 2, 14
s_waitcnt lgkmcnt(2)
v_mfma_f32_32x32x16_bf16 v[120:135], v[52:55], v[232:235], v[120:135]
ds_read_b128 v[228:231], v245 offset:3840
ds_read_b128 v[200:203], v243
v_xor_b32 v242, 16, v242
ds_read_b128 v[204:207], v242 offset:128
ds_read_u16_d16 v136, v136
v_pk_mul_f16 v151, v152, v151
v_pk_mul_f16 v148, v149, v148
v_bfe_u32 v138, v139, 2, 14
v_pk_mul_f16 v145, v146, v145
v_exp_f16 v153, v154
v_lshrrev_b32 v137, 18, v137
v_exp_f16_e64 v150, v151
v_mfma_f32_32x32x16_bf16 v[120:135], v[56:59], v[236:239], v[120:135]
ds_read_b128 v[232:235], v248 offset:64512
ds_read_u16_d16 v138, v138
ds_read_u16_d16_hi v137, v137
v_lshrrev_b32 v139, 18, v139
v_exp_f16 v147, v148
v_and_b32 v141, s49, v141
v_exp_f16 v144, v145
v_and_b32_e64 v143, s49, v143
v_smfmac_f32_16x16x32_bf16 v[44:47], v[218:219], v[192:195], v246
ds_read_b128 v[236:239], v245 offset:3456
ds_read_b128 v[208:211], v242 offset:64
ds_read_b128 v[212:215], v242
ds_read_u16_d16_hi v139, v139
v_exp_f16_sdwa v153, v154 dst_sel:WORD_1 dst_unused:UNUSED_PRESERVE src0_sel:WORD_1
v_bfe_u32 v140, v141, 2, 14
v_exp_f16_sdwa v150, v151 dst_sel:WORD_1 dst_unused:UNUSED_PRESERVE src0_sel:WORD_1
v_smfmac_f32_16x16x32_bf16 v[28:31], v[216:217], v[196:199], v246
v_bfe_u32 v142, v143, 2, 14
v_exp_f16_sdwa v147, v148 dst_sel:WORD_1 dst_unused:UNUSED_PRESERVE src0_sel:WORD_1
v_lshrrev_b32_e64 v141, 18, v141
s_waitcnt lgkmcnt(7)
v_mfma_f32_32x32x16_bf16 v[120:135], v[60:63], v[220:223], v[120:135]
ds_read_b128 v[216:219], v245 offset:3072
v_xor_b32 v244, 32, v244
ds_read_b128 v[192:195], v244 offset:128
ds_read_b128 v[196:199], v244 offset:64
ds_read_u16_d16 v140, v140
ds_read_u16_d16 v142, v142
ds_read_u16_d16_hi v141, v141
v_exp_f16_sdwa v144, v145 dst_sel:WORD_1 dst_unused:UNUSED_PRESERVE src0_sel:WORD_1
v_lshrrev_b32_e64 v143, 18, v143
v_pk_add_f16 v153, v153, 1.0 op_sel_hi:[1,0]
v_pk_add_f16 v150, v150, 1.0 op_sel_hi:[1,0]
v_pk_add_f16 v147, v147, 1.0 op_sel_hi:[1,0]
v_pk_add_f16 v144, v144, 1.0 op_sel_hi:[1,0]
v_rcp_f16_e64 v154, v153
v_mfma_f32_32x32x16_bf16 v[120:135], v[64:67], v[224:227], v[120:135]
ds_read_b128 v[220:223], v249
ds_read_u16_d16_hi v143, v143
v_rcp_f16 v151, v150
v_rcp_f16 v148, v147
v_rcp_f16_e64 v145, v144
v_rcp_f16_sdwa v154, v153 dst_sel:WORD_1 dst_unused:UNUSED_PRESERVE src0_sel:WORD_1
v_smfmac_f32_16x16x32_bf16 v[12:15], v[230:231], v[200:203], v246
ds_read_b128 v[224:227], v249 offset:3072
v_rcp_f16_sdwa v151, v150 dst_sel:WORD_1 dst_unused:UNUSED_PRESERVE src0_sel:WORD_1
s_setprio 0
v_rcp_f16_sdwa v148, v147 dst_sel:WORD_1 dst_unused:UNUSED_PRESERVE src0_sel:WORD_1
v_fma_mix_f32 v162, v136, v136, 0 op_sel:[0,0,0] op_sel_hi:[1,1,0]
v_smfmac_f32_16x16x32_bf16 v[44:47], v[228:229], v[204:207], v246
v_rcp_f16_sdwa v145, v144 dst_sel:WORD_1 dst_unused:UNUSED_PRESERVE src0_sel:WORD_1
s_waitcnt lgkmcnt(5)
v_fma_mix_f32 v162, v137, v137, v162 op_sel:[1,1,0] op_sel_hi:[1,1,0]
v_pk_mul_f16 v155, v155, v154
v_mfma_f32_32x32x16_bf16 v[120:135], v[68:71], v[232:235], v[120:135]
ds_read_b128 v[228:231], v245 offset:2688
ds_read_b128 v[200:203], v244
v_xor_b32 v243, 32, v243
ds_read_b128 v[204:207], v243 offset:128
v_fma_mix_f32 v162, v138, v138, v162 op_sel:[0,0,0] op_sel_hi:[1,1,0]
v_pk_mul_f16 v152, v152, v151
v_pk_mul_f16 v149, v149, v148
v_fma_mix_f32 v162, v139, v139, v162 op_sel:[1,1,0] op_sel_hi:[1,1,0]
v_pk_mul_f16 v146, v146, v145
v_fma_mix_f32 v162, v155, v155, v162 op_sel:[0,0,0] op_sel_hi:[1,1,0]
v_fma_mix_f32 v162, v140, v140, v162 op_sel:[0,0,0] op_sel_hi:[1,1,0]
v_fma_mix_f32 v162, v155, v155, v162 op_sel:[1,1,0] op_sel_hi:[1,1,0]
v_smfmac_f32_16x16x32_bf16 v[28:31], v[238:239], v[208:211], v246
ds_read_b128 v[232:235], v249 offset:1024
v_fma_mix_f32 v162, v152, v152, v162 op_sel:[0,0,0] op_sel_hi:[1,1,0]
s_waitcnt lgkmcnt(4)
v_fma_mix_f32 v162, v141, v141, v162 op_sel:[1,1,0] op_sel_hi:[1,1,0]
v_fma_mix_f32 v162, v152, v152, v162 op_sel:[1,1,0] op_sel_hi:[1,1,0]
v_fma_mix_f32 v162, v149, v149, v162 op_sel:[0,0,0] op_sel_hi:[1,1,0]
v_smfmac_f32_16x16x32_bf16 v[12:15], v[236:237], v[212:215], v246
v_fma_mix_f32 v162, v142, v142, v162 op_sel:[0,0,0] op_sel_hi:[1,1,0]
v_fma_mix_f32 v162, v149, v149, v162 op_sel:[1,1,0] op_sel_hi:[1,1,0]
v_fma_mix_f32 v162, v146, v146, v162 op_sel:[0,0,0] op_sel_hi:[1,1,0]
v_fma_mix_f32 v162, v143, v143, v162 op_sel:[1,1,0] op_sel_hi:[1,1,0]
v_fma_mix_f32 v162, v146, v146, v162 op_sel:[1,1,0] op_sel_hi:[1,1,0]
v_lshlrev_b32_e64 v252, 7, v251
s_add_u32 s46, s47, 1572864
s_mov_b32 exec_lo, 131071
s_mov_b32 exec_hi, 0
s_mov_b32 m0, 16288
s_nop 0
buffer_load_dword v252, s[4:7], s46 offen lds
s_mov_b64 exec, -1
s_setprio 2
v_smfmac_f32_16x16x32_bf16 v[36:39], v[218:219], v[192:195], v246
ds_read_b128 v[236:239], v249 offset:4096
v_cvt_pkrtz_f16_f32 v137, v120, v121
v_cvt_pkrtz_f16_f32 v139, v122, v123
v_cvt_pkrtz_f16_f32 v141, v124, v125
v_smfmac_f32_16x16x32_bf16 v[20:23], v[216:217], v[196:199], v246
v_cvt_pkrtz_f16_f32 v143, v126, v127
v_cvt_pkrtz_f16_f32 v145, v128, v129
v_cvt_pk_f16_f32 v155, v130, v131
v_cvt_pk_f16_f32 v152, v132, v133
v_cvt_pk_f16_f32 v149, v134, v135
v_mfma_f32_32x32x16_bf16 v[120:135], v[48:51], v[220:223], 0
ds_read_b128 v[216:219], v245 offset:2304
ds_read_b128 v[208:211], v243 offset:64
ds_read_b128 v[212:215], v243
v_pk_fma_f16 v154, v155, v155, s48
v_and_b32_e64 v137, s49, v137
v_pk_fma_f16 v151, v152, v152, s48
v_and_b32_e64 v139, s49, v139
v_pk_fma_f16 v148, v149, v149, s48
v_mfma_f32_32x32x16_bf16 v[120:135], v[52:55], v[224:227], v[120:135]
ds_read_b128 v[220:223], v249 offset:2048
v_pk_mul_f16 v154, v155, v154
v_bfe_u32 v136, v137, 2, 14
v_pk_mul_f16 v151, v152, v151
v_pk_mul_f16 v148, v149, v148
v_bfe_u32 v138, v139, 2, 14
v_exp_f16_e64 v153, v154
s_waitcnt lgkmcnt(4)
v_smfmac_f32_16x16x32_bf16 v[4:7], v[230:231], v[200:203], v246
ds_read_b128 v[224:227], v245 offset:1920
v_xor_b32 v242, 32, v242
ds_read_b128 v[192:195], v242 offset:128
ds_read_b128 v[196:199], v242 offset:64
ds_read_u16_d16 v136, v136
ds_read_u16_d16 v138, v138
v_lshrrev_b32 v137, 18, v137
v_exp_f16 v150, v151
v_smfmac_f32_16x16x32_bf16 v[36:39], v[228:229], v[204:207], v246
v_lshrrev_b32 v139, 18, v139
v_exp_f16 v147, v148
v_and_b32_e64 v141, s49, v141
v_mfma_f32_32x32x16_bf16 v[120:135], v[56:59], v[232:235], v[120:135]
ds_read_b128 v[228:231], v249 offset:5120
ds_read_u16_d16_hi v137, v137
ds_read_u16_d16_hi v139, v139
v_and_b32_e64 v143, s49, v143
v_exp_f16_sdwa v153, v154 dst_sel:WORD_1 dst_unused:UNUSED_PRESERVE src0_sel:WORD_1
v_bfe_u32 v140, v141, 2, 14
v_exp_f16_sdwa v150, v151 dst_sel:WORD_1 dst_unused:UNUSED_PRESERVE src0_sel:WORD_1
v_bfe_u32 v142, v143, 2, 14
v_mfma_f32_32x32x16_bf16 v[120:135], v[60:63], v[236:239], v[120:135]
ds_read_b128 v[232:235], v245 offset:1536
ds_read_b128 v[200:203], v242
v_xor_b32 v244, 16, v244
ds_read_b128 v[204:207], v244 offset:128
ds_read_u16_d16 v140, v140
ds_read_u16_d16 v142, v142
v_exp_f16_sdwa v147, v148 dst_sel:WORD_1 dst_unused:UNUSED_PRESERVE src0_sel:WORD_1
v_lshrrev_b32 v141, 18, v141
v_pk_add_f16 v153, v153, 1.0 op_sel_hi:[1,0]
v_lshrrev_b32 v143, 18, v143
v_pk_add_f16 v150, v150, 1.0 op_sel_hi:[1,0]
s_waitcnt lgkmcnt(8)
v_smfmac_f32_16x16x32_bf16 v[20:23], v[218:219], v[208:211], v246
ds_read_b128 v[236:239], v245 offset:1152
ds_read_u16_d16_hi v141, v141
ds_read_u16_d16_hi v143, v143
v_pk_add_f16 v147, v147, 1.0 op_sel_hi:[1,0]
v_and_b32 v145, s49, v145
v_rcp_f16 v154, v153
v_smfmac_f32_16x16x32_bf16 v[4:7], v[216:217], v[212:215], v246
v_bfe_u32 v144, v145, 2, 14
v_rcp_f16_e64 v151, v150
v_mfma_f32_32x32x16_bf16 v[120:135], v[64:67], v[220:223], v[120:135]
ds_read_b128 v[208:211], v244 offset:64
ds_read_b128 v[212:215], v244
ds_read_b128 v[216:219], v249 offset:6144
ds_read_u16_d16 v144, v144
v_lshrrev_b32_e64 v145, 18, v145
v_rcp_f16 v148, v147
v_rcp_f16_sdwa v154, v153 dst_sel:WORD_1 dst_unused:UNUSED_PRESERVE src0_sel:WORD_1
ds_read_u16_d16_hi v145, v145
v_fma_mix_f32 v163, v136, v136, 0 op_sel:[0,0,0] op_sel_hi:[1,1,0]
s_waitcnt lgkmcnt(8)
v_fma_mix_f32 v163, v137, v137, v163 op_sel:[1,1,0] op_sel_hi:[1,1,0]
v_smfmac_f32_16x16x32_bf16 v[36:39], v[226:227], v[192:195], v246
ds_read_b128 v[220:223], v249 offset:9216
v_rcp_f16_sdwa v151, v150 dst_sel:WORD_1 dst_unused:UNUSED_PRESERVE src0_sel:WORD_1
v_fma_mix_f32 v163, v138, v138, v163 op_sel:[0,0,0] op_sel_hi:[1,1,0]
v_smfmac_f32_16x16x32_bf16 v[20:23], v[224:225], v[196:199], v246
v_rcp_f16_sdwa v148, v147 dst_sel:WORD_1 dst_unused:UNUSED_PRESERVE src0_sel:WORD_1
v_fma_mix_f32 v163, v139, v139, v163 op_sel:[1,1,0] op_sel_hi:[1,1,0]
v_pk_mul_f16 v155, v155, v154
v_mfma_f32_32x32x16_bf16 v[120:135], v[68:71], v[228:231], v[120:135]
ds_read_b128 v[224:227], v249 offset:7168
v_fma_mix_f32 v163, v140, v140, v163 op_sel:[0,0,0] op_sel_hi:[1,1,0]
v_pk_mul_f16 v152, v152, v151
s_waitcnt lgkmcnt(7)
v_fma_mix_f32 v163, v141, v141, v163 op_sel:[1,1,0] op_sel_hi:[1,1,0]
v_pk_mul_f16 v149, v149, v148
v_fma_mix_f32 v163, v155, v155, v163 op_sel:[0,0,0] op_sel_hi:[1,1,0]
v_fma_mix_f32 v163, v142, v142, v163 op_sel:[0,0,0] op_sel_hi:[1,1,0]
v_fma_mix_f32 v163, v155, v155, v163 op_sel:[1,1,0] op_sel_hi:[1,1,0]
v_smfmac_f32_16x16x32_bf16 v[4:7], v[234:235], v[200:203], v246
ds_read_b128 v[228:231], v245 offset:768
v_xor_b32 v243, 16, v243
ds_read_b128 v[192:195], v243 offset:128
ds_read_b128 v[196:199], v243 offset:64
v_fma_mix_f32 v163, v143, v143, v163 op_sel:[1,1,0] op_sel_hi:[1,1,0]
v_fma_mix_f32 v163, v152, v152, v163 op_sel:[0,0,0] op_sel_hi:[1,1,0]
v_fma_mix_f32 v163, v152, v152, v163 op_sel:[1,1,0] op_sel_hi:[1,1,0]
v_smfmac_f32_16x16x32_bf16 v[32:35], v[232:233], v[204:207], v246
s_waitcnt lgkmcnt(4)
v_fma_mix_f32 v163, v144, v144, v163 op_sel:[0,0,0] op_sel_hi:[1,1,0]
v_fma_mix_f32 v163, v149, v149, v163 op_sel:[0,0,0] op_sel_hi:[1,1,0]
v_fma_mix_f32 v163, v145, v145, v163 op_sel:[1,1,0] op_sel_hi:[1,1,0]
v_fma_mix_f32 v163, v149, v149, v163 op_sel:[1,1,0] op_sel_hi:[1,1,0]
v_lshlrev_b32 v252, 7, v251
s_add_u32 s46, s47, 1572864
s_mov_b32 exec_lo, 4294836224
s_mov_b32 exec_hi, 3
s_mov_b32 m0, 16220
s_nop 0
buffer_load_dword v252, s[4:7], s46 offen lds
s_mov_b64 exec, -1
s_setprio 1
v_smfmac_f32_16x16x32_bf16 v[16:19], v[238:239], v[208:211], v246
ds_read_b128 v[232:235], v249 offset:10240
v_cvt_pkrtz_f16_f32 v137, v120, v121
v_cvt_pkrtz_f16_f32 v139, v122, v123
v_cvt_pkrtz_f16_f32 v141, v124, v125
v_smfmac_f32_16x16x32_bf16 v[0:3], v[236:237], v[212:215], v246
v_cvt_pkrtz_f16_f32 v143, v126, v127
v_cvt_pk_f16_f32 v155, v128, v129
v_cvt_pk_f16_f32 v152, v130, v131
v_cvt_pk_f16_f32 v149, v132, v133
v_cvt_pk_f16_f32 v146, v134, v135
v_mfma_f32_32x32x16_bf16 v[120:135], v[48:51], v[216:219], 0
ds_read_b128 v[236:239], v249 offset:8192
v_pk_fma_f16 v154, v155, v155, s48
v_and_b32_e64 v137, s49, v137
v_pk_fma_f16 v151, v152, v152, s48
v_pk_fma_f16 v148, v149, v149, s48
v_and_b32 v139, s49, v139
v_pk_fma_f16 v145, v146, v146, s48
v_pk_mul_f16 v154, v155, v154
v_mfma_f32_32x32x16_bf16 v[120:135], v[52:55], v[220:223], v[120:135]
ds_read_b128 v[216:219], v245 offset:384
ds_read_b128 v[200:203], v243
v_xor_b32 v242, 16, v242
ds_read_b128 v[204:207], v242 offset:128
v_bfe_u32 v136, v137, 2, 14
v_pk_mul_f16 v151, v152, v151
v_pk_mul_f16 v148, v149, v148
v_bfe_u32 v138, v139, 2, 14
v_pk_mul_f16 v145, v146, v145
v_exp_f16 v153, v154
s_waitcnt lgkmcnt(4)
v_mfma_f32_32x32x16_bf16 v[120:135], v[56:59], v[224:227], v[120:135]
ds_read_b128 v[220:223], v249 offset:11264
ds_read_u16_d16 v136, v136
ds_read_u16_d16 v138, v138
v_lshrrev_b32 v137, 18, v137
v_exp_f16 v150, v151
v_lshrrev_b32 v139, 18, v139
v_exp_f16 v147, v148
v_and_b32_e64 v141, s49, v141
v_smfmac_f32_16x16x32_bf16 v[32:35], v[230:231], v[192:195], v246
ds_read_b128 v[224:227], v245
ds_read_b128 v[208:211], v242 offset:64
ds_read_b128 v[212:215], v242
ds_read_u16_d16_hi v137, v137
ds_read_u16_d16_hi v139, v139
v_exp_f16 v144, v145
v_and_b32 v143, s49, v143
v_exp_f16_sdwa v153, v154 dst_sel:WORD_1 dst_unused:UNUSED_PRESERVE src0_sel:WORD_1
v_smfmac_f32_16x16x32_bf16 v[16:19], v[228:229], v[196:199], v246
v_bfe_u32 v140, v141, 2, 14
v_exp_f16_sdwa v150, v151 dst_sel:WORD_1 dst_unused:UNUSED_PRESERVE src0_sel:WORD_1
v_mfma_f32_32x32x16_bf16 v[120:135], v[60:63], v[232:235], v[120:135]
ds_read_b128 v[228:231], v249 offset:12288
ds_read_u16_d16 v140, v140
v_bfe_u32 v142, v143, 2, 14
v_exp_f16_sdwa v147, v148 dst_sel:WORD_1 dst_unused:UNUSED_PRESERVE src0_sel:WORD_1
v_lshrrev_b32_e64 v141, 18, v141
v_exp_f16_sdwa v144, v145 dst_sel:WORD_1 dst_unused:UNUSED_PRESERVE src0_sel:WORD_1
v_lshrrev_b32 v143, 18, v143
v_pk_add_f16 v153, v153, 1.0 op_sel_hi:[1,0]
s_waitcnt lgkmcnt(7)
v_mfma_f32_32x32x16_bf16 v[120:135], v[64:67], v[236:239], v[120:135]
ds_read_b128 v[232:235], v249 offset:15360
ds_read_u16_d16 v142, v142
ds_read_u16_d16_hi v141, v141
ds_read_u16_d16_hi v143, v143
v_pk_add_f16 v150, v150, 1.0 op_sel_hi:[1,0]
v_pk_add_f16 v147, v147, 1.0 op_sel_hi:[1,0]
v_pk_add_f16 v144, v144, 1.0 op_sel_hi:[1,0]
v_rcp_f16 v154, v153
v_rcp_f16 v151, v150
v_smfmac_f32_16x16x32_bf16 v[0:3], v[218:219], v[200:203], v246
ds_read_b128 v[236:239], v249 offset:13312
v_rcp_f16 v148, v147
v_rcp_f16 v145, v144
v_smfmac_f32_16x16x32_bf16 v[32:35], v[216:217], v[204:207], v246
v_rcp_f16_sdwa v154, v153 dst_sel:WORD_1 dst_unused:UNUSED_PRESERVE src0_sel:WORD_1
v_rcp_f16_sdwa v151, v150 dst_sel:WORD_1 dst_unused:UNUSED_PRESERVE src0_sel:WORD_1
s_setprio 0
v_mfma_f32_32x32x16_bf16 v[120:135], v[68:71], v[220:223], v[120:135]
ds_read_b128 v[216:219], v249 offset:16384
v_rcp_f16_sdwa v148, v147 dst_sel:WORD_1 dst_unused:UNUSED_PRESERVE src0_sel:WORD_1
v_fma_mix_f32 v164, v136, v136, 0 op_sel:[0,0,0] op_sel_hi:[1,1,0]
v_rcp_f16_sdwa v145, v144 dst_sel:WORD_1 dst_unused:UNUSED_PRESERVE src0_sel:WORD_1
s_waitcnt lgkmcnt(6)
v_fma_mix_f32 v164, v137, v137, v164 op_sel:[1,1,0] op_sel_hi:[1,1,0]
v_pk_mul_f16 v155, v155, v154
v_fma_mix_f32 v164, v138, v138, v164 op_sel:[0,0,0] op_sel_hi:[1,1,0]
v_smfmac_f32_16x16x32_bf16 v[16:19], v[226:227], v[208:211], v246
ds_read_b128 v[220:223], v249 offset:14336
v_pk_mul_f16 v152, v152, v151
v_pk_mul_f16 v149, v149, v148
v_fma_mix_f32 v164, v139, v139, v164 op_sel:[1,1,0] op_sel_hi:[1,1,0]
v_pk_mul_f16 v146, v146, v145
v_smfmac_f32_16x16x32_bf16 v[0:3], v[224:225], v[212:215], v246
s_mov_b64 exec, 1
ds_add_u32 v253, v254 offset:16
s_mov_b64 exec, -1
v_fma_mix_f32 v164, v155, v155, v164 op_sel:[0,0,0] op_sel_hi:[1,1,0]
v_fma_mix_f32 v164, v140, v140, v164 op_sel:[0,0,0] op_sel_hi:[1,1,0]
v_fma_mix_f32 v164, v155, v155, v164 op_sel:[1,1,0] op_sel_hi:[1,1,0]
v_fma_mix_f32 v164, v152, v152, v164 op_sel:[0,0,0] op_sel_hi:[1,1,0]
s_waitcnt lgkmcnt(3)
v_fma_mix_f32 v164, v141, v141, v164 op_sel:[1,1,0] op_sel_hi:[1,1,0]
v_fma_mix_f32 v164, v152, v152, v164 op_sel:[1,1,0] op_sel_hi:[1,1,0]
v_fma_mix_f32 v164, v149, v149, v164 op_sel:[0,0,0] op_sel_hi:[1,1,0]
v_fma_mix_f32 v164, v142, v142, v164 op_sel:[0,0,0] op_sel_hi:[1,1,0]
v_fma_mix_f32 v164, v149, v149, v164 op_sel:[1,1,0] op_sel_hi:[1,1,0]
v_fma_mix_f32 v164, v146, v146, v164 op_sel:[0,0,0] op_sel_hi:[1,1,0]
v_fma_mix_f32 v164, v143, v143, v164 op_sel:[1,1,0] op_sel_hi:[1,1,0]
v_fma_mix_f32 v164, v146, v146, v164 op_sel:[1,1,0] op_sel_hi:[1,1,0]
s_setprio 3
v_pk_add_f32 v[168:169], v[0:1], v[2:3]
v_pk_mul_f32 v[170:171], v[0:1], v[0:1]
v_pk_fma_f32 v[170:171], v[2:3], v[2:3], v[170:171]
v_pk_add_f32 v[168:169], v[168:169], v[4:5]
v_pk_fma_f32 v[170:171], v[4:5], v[4:5], v[170:171]
v_pk_add_f32 v[168:169], v[168:169], v[6:7]
v_pk_fma_f32 v[170:171], v[6:7], v[6:7], v[170:171]
v_pk_add_f32 v[168:169], v[168:169], v[8:9]
v_pk_fma_f32 v[170:171], v[8:9], v[8:9], v[170:171]
v_pk_add_f32 v[168:169], v[168:169], v[10:11]
v_pk_fma_f32 v[170:171], v[10:11], v[10:11], v[170:171]
v_pk_add_f32 v[168:169], v[168:169], v[12:13]
v_pk_fma_f32 v[170:171], v[12:13], v[12:13], v[170:171]
v_pk_add_f32 v[168:169], v[168:169], v[14:15]
v_pk_fma_f32 v[170:171], v[14:15], v[14:15], v[170:171]
v_pk_add_f32 v[168:169], v[168:169], v[16:17]
v_pk_fma_f32 v[170:171], v[16:17], v[16:17], v[170:171]
v_pk_add_f32 v[168:169], v[168:169], v[18:19]
v_pk_fma_f32 v[170:171], v[18:19], v[18:19], v[170:171]
v_pk_add_f32 v[168:169], v[168:169], v[20:21]
v_pk_fma_f32 v[170:171], v[20:21], v[20:21], v[170:171]
v_pk_add_f32 v[168:169], v[168:169], v[22:23]
v_pk_fma_f32 v[170:171], v[22:23], v[22:23], v[170:171]
v_pk_add_f32 v[168:169], v[168:169], v[24:25]
v_pk_fma_f32 v[170:171], v[24:25], v[24:25], v[170:171]
v_pk_add_f32 v[168:169], v[168:169], v[26:27]
v_pk_fma_f32 v[170:171], v[26:27], v[26:27], v[170:171]
v_pk_add_f32 v[168:169], v[168:169], v[28:29]
v_pk_fma_f32 v[170:171], v[28:29], v[28:29], v[170:171]
v_pk_add_f32 v[168:169], v[168:169], v[30:31]
v_pk_fma_f32 v[170:171], v[30:31], v[30:31], v[170:171]
v_pk_add_f32 v[168:169], v[168:169], v[32:33]
v_pk_fma_f32 v[170:171], v[32:33], v[32:33], v[170:171]
v_pk_add_f32 v[168:169], v[168:169], v[34:35]
v_pk_fma_f32 v[170:171], v[34:35], v[34:35], v[170:171]
v_pk_add_f32 v[168:169], v[168:169], v[36:37]
v_pk_fma_f32 v[170:171], v[36:37], v[36:37], v[170:171]
v_pk_add_f32 v[168:169], v[168:169], v[38:39]
v_pk_fma_f32 v[170:171], v[38:39], v[38:39], v[170:171]
v_pk_add_f32 v[168:169], v[168:169], v[40:41]
v_pk_fma_f32 v[170:171], v[40:41], v[40:41], v[170:171]
v_pk_add_f32 v[168:169], v[168:169], v[42:43]
v_pk_fma_f32 v[170:171], v[42:43], v[42:43], v[170:171]
v_pk_add_f32 v[168:169], v[168:169], v[44:45]
v_pk_fma_f32 v[170:171], v[44:45], v[44:45], v[170:171]
v_pk_add_f32 v[168:169], v[168:169], v[46:47]
v_pk_fma_f32 v[170:171], v[46:47], v[46:47], v[170:171]
s_setprio 0
v_add_u32 v174, -36864, v242
v_subrev_u32 v175, 66560, v174
v_min_u32 v174, v174, v175
v_add_u32 v174, 90112, v174
v_sub_u32 v175, v174, v242
v_add_u32 v242, v175, v242
v_add_u32 v243, v175, v243
v_add_u32 v244, v175, v244
v_lshlrev_b32_e64 v252, 7, v251
s_add_u32 s46, s47, 1572864
s_mov_b32 exec_lo, 0
s_mov_b32 exec_hi, 1048572
s_mov_b32 m0, 16152
s_nop 0
buffer_load_dword v252, s[4:7], s46 offen lds
s_mov_b64 exec, -1
s_setprio 2
v_cvt_pkrtz_f16_f32 v137, v120, v121
v_cvt_pkrtz_f16_f32 v139, v122, v123
v_cvt_pkrtz_f16_f32 v141, v124, v125
v_cvt_pkrtz_f16_f32 v143, v126, v127
v_cvt_pkrtz_f16_f32 v145, v128, v129
v_cvt_pk_f16_f32 v155, v130, v131
v_cvt_pk_f16_f32 v152, v132, v133
v_cvt_pk_f16_f32 v149, v134, v135
ds_read_b128 v[224:227], v249 offset:17408
v_mfma_f32_32x32x16_bf16 v[120:135], v[48:51], v[228:231], 0
v_pk_fma_f16 v154, v155, v155, s48
v_add_f32 v168, v168, v169
v_and_b32 v137, s49, v137
v_pk_fma_f16 v151, v152, v152, s48
v_and_b32_e64 v139, s49, v139
v_pk_fma_f16 v148, v149, v149, s48
v_add_f32_e64 v170, v170, v171
v_pk_mul_f16 v154, v155, v154
v_bfe_u32 v136, v137, 2, 14
v_pk_mul_f16 v151, v152, v151
v_pk_mul_f16 v148, v149, v148
v_bfe_u32 v138, v139, 2, 14
ds_read_b128 v[228:231], v249 offset:18432
ds_read_u16_d16 v136, v136
ds_read_u16_d16 v138, v138
v_mfma_f32_32x32x16_bf16 v[120:135], v[52:55], v[232:235], v[120:135]
v_permlane32_swap_b32 v168, v170
v_exp_f16 v153, v154
v_lshrrev_b32 v137, 18, v137
v_exp_f16 v150, v151
v_add_f32 v168, v168, v170
v_lshrrev_b32 v139, 18, v139
v_exp_f16 v147, v148
v_and_b32 v141, s49, v141
v_and_b32_e64 v143, s49, v143
v_mul_f32 v168, 1009429163, v168
ds_read_b128 v[232:235], v249 offset:21504
ds_read_u16_d16_hi v137, v137
ds_read_u16_d16_hi v139, v139
v_mfma_f32_32x32x16_bf16 v[120:135], v[56:59], v[236:239], v[120:135]
v_exp_f16_sdwa v153, v154 dst_sel:WORD_1 dst_unused:UNUSED_PRESERVE src0_sel:WORD_1
v_bfe_u32 v140, v141, 2, 14
v_exp_f16_sdwa v150, v151 dst_sel:WORD_1 dst_unused:UNUSED_PRESERVE src0_sel:WORD_1
v_mov_b32_e64 v170, v168
v_bfe_u32 v142, v143, 2, 14
v_exp_f16_sdwa v147, v148 dst_sel:WORD_1 dst_unused:UNUSED_PRESERVE src0_sel:WORD_1
v_lshrrev_b32_e64 v141, 18, v141
v_permlane32_swap_b32 v168, v170
v_pk_add_f16 v153, v153, 1.0 op_sel_hi:[1,0]
s_waitcnt lgkmcnt(8)
ds_read_b128 v[236:239], v249 offset:19456
ds_read_u16_d16 v140, v140
ds_read_u16_d16 v142, v142
ds_read_u16_d16_hi v141, v141
v_mfma_f32_32x32x16_bf16 v[120:135], v[60:63], v[216:219], v[120:135]
v_lshrrev_b32_e64 v143, 18, v143
v_pk_add_f16 v150, v150, 1.0 op_sel_hi:[1,0]
v_pk_add_f16 v147, v147, 1.0 op_sel_hi:[1,0]
v_and_b32_e64 v145, s49, v145
v_fma_f32 v170, -v168, v168, v170
v_rcp_f16_e64 v154, v153
v_bfe_u32 v144, v145, 2, 14
v_rcp_f16 v151, v150
v_max_f32 v170, 0, v170
v_lshrrev_b32_e64 v145, 18, v145
ds_read_b128 v[216:219], v249 offset:22528
ds_read_u16_d16_hi v143, v143
ds_read_u16_d16 v144, v144
ds_read_u16_d16_hi v145, v145
v_mfma_f32_32x32x16_bf16 v[120:135], v[64:67], v[220:223], v[120:135]
v_rcp_f16 v148, v147
v_rcp_f16_sdwa v154, v153 dst_sel:WORD_1 dst_unused:UNUSED_PRESERVE src0_sel:WORD_1
v_add_f32 v170, 925353388, v170
s_waitcnt lgkmcnt(8)
v_fma_mix_f32 v165, v136, v136, 0 op_sel:[0,0,0] op_sel_hi:[1,1,0]
ds_read_b32 v247, v253 offset:16
v_fma_mix_f32 v165, v137, v137, v165 op_sel:[1,1,0] op_sel_hi:[1,1,0]
v_rcp_f16_sdwa v151, v150 dst_sel:WORD_1 dst_unused:UNUSED_PRESERVE src0_sel:WORD_1
v_rsq_f32_e64 v170, v170
v_fma_mix_f32 v165, v138, v138, v165 op_sel:[0,0,0] op_sel_hi:[1,1,0]
ds_read_b128 v[220:223], v249 offset:20480
v_mfma_f32_32x32x16_bf16 v[120:135], v[68:71], v[224:227], v[120:135]
v_rcp_f16_sdwa v148, v147 dst_sel:WORD_1 dst_unused:UNUSED_PRESERVE src0_sel:WORD_1
v_fma_mix_f32 v165, v139, v139, v165 op_sel:[1,1,0] op_sel_hi:[1,1,0]
v_pk_mul_f16 v155, v155, v154
s_waitcnt lgkmcnt(6)
v_fma_mix_f32 v165, v140, v140, v165 op_sel:[0,0,0] op_sel_hi:[1,1,0]
v_pk_mul_f16 v152, v152, v151
v_fma_mix_f32 v165, v141, v141, v165 op_sel:[1,1,0] op_sel_hi:[1,1,0]
v_pk_mul_f16 v149, v149, v148
v_fma_mix_f32 v165, v155, v155, v165 op_sel:[0,0,0] op_sel_hi:[1,1,0]
v_mul_f32 v172, 3203391086, v170
v_fma_mix_f32 v165, v142, v142, v165 op_sel:[0,0,0] op_sel_hi:[1,1,0]
v_fma_mix_f32 v165, v155, v155, v165 op_sel:[1,1,0] op_sel_hi:[1,1,0]
s_waitcnt lgkmcnt(2)
v_fma_mix_f32 v165, v143, v143, v165 op_sel:[1,1,0] op_sel_hi:[1,1,0]
v_fma_mix_f32 v165, v152, v152, v165 op_sel:[0,0,0] op_sel_hi:[1,1,0]
v_fma_mix_f32 v165, v152, v152, v165 op_sel:[1,1,0] op_sel_hi:[1,1,0]
v_mul_f32 v173, v168, v172
v_fma_mix_f32 v165, v144, v144, v165 op_sel:[0,0,0] op_sel_hi:[1,1,0]
v_fma_mix_f32 v165, v149, v149, v165 op_sel:[0,0,0] op_sel_hi:[1,1,0]
v_fma_mix_f32 v165, v145, v145, v165 op_sel:[1,1,0] op_sel_hi:[1,1,0]
v_fma_mix_f32 v165, v149, v149, v165 op_sel:[1,1,0] op_sel_hi:[1,1,0]
s_setprio 3
v_pk_fma_f32 v[0:1], v[0:1], v[172:173], v[172:173] op_sel:[0,0,1] op_sel_hi:[1,0,1] neg_lo:[0,0,1] neg_hi:[0,0,1]
v_pk_fma_f32 v[2:3], v[2:3], v[172:173], v[172:173] op_sel:[0,0,1] op_sel_hi:[1,0,1] neg_lo:[0,0,1] neg_hi:[0,0,1]
v_pk_fma_f32 v[4:5], v[4:5], v[172:173], v[172:173] op_sel:[0,0,1] op_sel_hi:[1,0,1] neg_lo:[0,0,1] neg_hi:[0,0,1]
v_pk_fma_f32 v[6:7], v[6:7], v[172:173], v[172:173] op_sel:[0,0,1] op_sel_hi:[1,0,1] neg_lo:[0,0,1] neg_hi:[0,0,1]
v_pk_fma_f32 v[8:9], v[8:9], v[172:173], v[172:173] op_sel:[0,0,1] op_sel_hi:[1,0,1] neg_lo:[0,0,1] neg_hi:[0,0,1]
v_pk_fma_f32 v[10:11], v[10:11], v[172:173], v[172:173] op_sel:[0,0,1] op_sel_hi:[1,0,1] neg_lo:[0,0,1] neg_hi:[0,0,1]
v_pk_fma_f32 v[12:13], v[12:13], v[172:173], v[172:173] op_sel:[0,0,1] op_sel_hi:[1,0,1] neg_lo:[0,0,1] neg_hi:[0,0,1]
v_pk_fma_f32 v[14:15], v[14:15], v[172:173], v[172:173] op_sel:[0,0,1] op_sel_hi:[1,0,1] neg_lo:[0,0,1] neg_hi:[0,0,1]
v_pk_fma_f32 v[16:17], v[16:17], v[172:173], v[172:173] op_sel:[0,0,1] op_sel_hi:[1,0,1] neg_lo:[0,0,1] neg_hi:[0,0,1]
v_pk_fma_f32 v[18:19], v[18:19], v[172:173], v[172:173] op_sel:[0,0,1] op_sel_hi:[1,0,1] neg_lo:[0,0,1] neg_hi:[0,0,1]
v_pk_fma_f32 v[20:21], v[20:21], v[172:173], v[172:173] op_sel:[0,0,1] op_sel_hi:[1,0,1] neg_lo:[0,0,1] neg_hi:[0,0,1]
v_pk_fma_f32 v[22:23], v[22:23], v[172:173], v[172:173] op_sel:[0,0,1] op_sel_hi:[1,0,1] neg_lo:[0,0,1] neg_hi:[0,0,1]
v_pk_fma_f32 v[24:25], v[24:25], v[172:173], v[172:173] op_sel:[0,0,1] op_sel_hi:[1,0,1] neg_lo:[0,0,1] neg_hi:[0,0,1]
v_pk_fma_f32 v[26:27], v[26:27], v[172:173], v[172:173] op_sel:[0,0,1] op_sel_hi:[1,0,1] neg_lo:[0,0,1] neg_hi:[0,0,1]
v_pk_fma_f32 v[28:29], v[28:29], v[172:173], v[172:173] op_sel:[0,0,1] op_sel_hi:[1,0,1] neg_lo:[0,0,1] neg_hi:[0,0,1]
v_pk_fma_f32 v[30:31], v[30:31], v[172:173], v[172:173] op_sel:[0,0,1] op_sel_hi:[1,0,1] neg_lo:[0,0,1] neg_hi:[0,0,1]
v_pk_fma_f32 v[32:33], v[32:33], v[172:173], v[172:173] op_sel:[0,0,1] op_sel_hi:[1,0,1] neg_lo:[0,0,1] neg_hi:[0,0,1]
v_pk_fma_f32 v[34:35], v[34:35], v[172:173], v[172:173] op_sel:[0,0,1] op_sel_hi:[1,0,1] neg_lo:[0,0,1] neg_hi:[0,0,1]
v_pk_fma_f32 v[36:37], v[36:37], v[172:173], v[172:173] op_sel:[0,0,1] op_sel_hi:[1,0,1] neg_lo:[0,0,1] neg_hi:[0,0,1]
v_pk_fma_f32 v[38:39], v[38:39], v[172:173], v[172:173] op_sel:[0,0,1] op_sel_hi:[1,0,1] neg_lo:[0,0,1] neg_hi:[0,0,1]
v_pk_fma_f32 v[40:41], v[40:41], v[172:173], v[172:173] op_sel:[0,0,1] op_sel_hi:[1,0,1] neg_lo:[0,0,1] neg_hi:[0,0,1]
v_pk_fma_f32 v[42:43], v[42:43], v[172:173], v[172:173] op_sel:[0,0,1] op_sel_hi:[1,0,1] neg_lo:[0,0,1] neg_hi:[0,0,1]
v_pk_fma_f32 v[44:45], v[44:45], v[172:173], v[172:173] op_sel:[0,0,1] op_sel_hi:[1,0,1] neg_lo:[0,0,1] neg_hi:[0,0,1]
v_pk_fma_f32 v[46:47], v[46:47], v[172:173], v[172:173] op_sel:[0,0,1] op_sel_hi:[1,0,1] neg_lo:[0,0,1] neg_hi:[0,0,1]
s_setprio 2
s_waitcnt lgkmcnt(0)
v_readfirstlane_b32 s43, v247
s_nop 1
s_cmp_ge_u32 s43, 16
s_cbranch_scc1 Lev4
Lev4w:
s_sleep 1
ds_read_b32 v247, v253 offset:16
s_waitcnt lgkmcnt(0)
v_readfirstlane_b32 s43, v247
s_cmp_eq_u32 s76, 0
s_cbranch_scc1 Lev4
s_sub_u32 s76, s76, 1
s_cmp_lt_u32 s43, 16
s_cbranch_scc1 Lev4w
Lev4:
s_setprio 1
v_cvt_pkrtz_f16_f32 v137, v120, v121
v_cvt_pkrtz_f16_f32 v139, v122, v123
v_cvt_pkrtz_f16_f32 v141, v124, v125
v_cvt_pkrtz_f16_f32 v143, v126, v127
v_cvt_pkrtz_f16_f32 v145, v128, v129
v_cvt_pk_f16_f32 v155, v130, v131
v_cvt_pk_f16_f32 v152, v132, v133
v_cvt_pk_f16_f32 v149, v134, v135
s_add_u32 m0, s67, 53248
s_add_u32 s66, s66, 98304
buffer_load_dwordx4 v240, s[4:7], s66 offen lds
ds_read_b128 v[224:227], v249 offset:23552
v_mfma_f32_32x32x16_bf16 v[120:135], v[48:51], v[228:231], 0
v_pk_fma_f16 v154, v155, v155, s48
v_cvt_pk_bf16_f32 v72, v0, v1
v_and_b32 v137, s49, v137
v_pk_fma_f16 v151, v152, v152, s48
v_cvt_pk_bf16_f32 v73, v2, v3
v_and_b32_e64 v139, s49, v139
v_pk_fma_f16 v148, v149, v149, s48
v_pk_mul_f16 v154, v155, v154
v_cvt_pk_bf16_f32 v74, v4, v5
v_bfe_u32 v136, v137, 2, 14
v_pk_mul_f16 v151, v152, v151
v_pk_mul_f16 v148, v149, v148
v_cvt_pk_bf16_f32 v75, v6, v7
v_bfe_u32 v138, v139, 2, 14
s_add_u32 m0, s67, 59904
s_add_u32 s66, s66, 98304
buffer_load_dwordx4 v240, s[4:7], s66 offen lds
ds_read_b128 v[228:231], v248 offset:16384
ds_read_u16_d16 v136, v136
ds_read_u16_d16 v138, v138
v_mfma_f32_32x32x16_bf16 v[120:135], v[52:55], v[232:235], v[120:135]
v_exp_f16_e64 v153, v154
v_cvt_pk_bf16_f32 v76, v8, v9
v_lshrrev_b32 v137, 18, v137
v_exp_f16 v150, v151
v_cvt_pk_bf16_f32 v77, v10, v11
v_lshrrev_b32 v139, 18, v139
v_exp_f16 v147, v148
v_cvt_pk_bf16_f32 v78, v12, v13
v_and_b32_e64 v141, s49, v141
v_and_b32 v143, s49, v143
v_cvt_pk_bf16_f32 v79, v14, v15
s_add_u32 m0, s67, 0
s_add_u32 s66, s66, 98304
buffer_load_dwordx4 v240, s[4:7], s66 offen lds
ds_read_b128 v[232:235], v248 offset:19456
ds_read_u16_d16_hi v137, v137
ds_read_u16_d16_hi v139, v139
v_mfma_f32_32x32x16_bf16 v[120:135], v[56:59], v[236:239], v[120:135]
v_exp_f16_sdwa v153, v154 dst_sel:WORD_1 dst_unused:UNUSED_PRESERVE src0_sel:WORD_1
v_bfe_u32 v140, v141, 2, 14
v_cvt_pk_bf16_f32 v80, v16, v17
v_exp_f16_sdwa v150, v151 dst_sel:WORD_1 dst_unused:UNUSED_PRESERVE src0_sel:WORD_1
v_bfe_u32 v142, v143, 2, 14
v_cvt_pk_bf16_f32 v81, v18, v19
v_exp_f16_sdwa v147, v148 dst_sel:WORD_1 dst_unused:UNUSED_PRESERVE src0_sel:WORD_1
v_cvt_pk_bf16_f32 v82, v20, v21
v_lshrrev_b32_e64 v141, 18, v141
v_pk_add_f16 v153, v153, 1.0 op_sel_hi:[1,0]
v_lshrrev_b32_e64 v143, 18, v143
s_add_u32 m0, s67, 6656
s_add_u32 s66, s66, 98304
buffer_load_dwordx4 v240, s[4:7], s66 offen lds
s_add_u32 m0, s67, 13312
s_add_u32 s66, s66, 98304
buffer_load_dwordx4 v240, s[4:7], s66 offen lds
ds_read_b128 v[236:239], v248 offset:17408
ds_read_u16_d16 v140, v140
ds_read_u16_d16 v142, v142
ds_read_u16_d16_hi v141, v141
ds_read_u16_d16_hi v143, v143
v_mfma_f32_32x32x16_bf16 v[120:135], v[60:63], v[216:219], v[120:135]
v_cvt_pk_bf16_f32 v83, v22, v23
v_pk_add_f16 v150, v150, 1.0 op_sel_hi:[1,0]
v_pk_add_f16 v147, v147, 1.0 op_sel_hi:[1,0]
v_and_b32_e64 v145, s49, v145
v_cvt_pk_bf16_f32 v84, v24, v25
v_rcp_f16_e64 v154, v153
v_bfe_u32 v144, v145, 2, 14
v_cvt_pk_bf16_f32 v85, v26, v27
v_rcp_f16 v151, v150
v_lshrrev_b32 v145, 18, v145
v_cvt_pk_bf16_f32 v86, v28, v29
s_add_u32 m0, s67, 19968
s_add_u32 s66, s66, 98304
buffer_load_dwordx4 v240, s[4:7], s66 offen lds
ds_read_b128 v[216:219], v248 offset:20480
ds_read_u16_d16 v144, v144
ds_read_u16_d16_hi v145, v145
v_mfma_f32_32x32x16_bf16 v[120:135], v[64:67], v[220:223], v[120:135]
v_rcp_f16_e64 v148, v147
v_cvt_pk_bf16_f32 v87, v30, v31
v_rcp_f16_sdwa v154, v153 dst_sel:WORD_1 dst_unused:UNUSED_PRESERVE src0_sel:WORD_1
s_waitcnt lgkmcnt(5)
v_fma_mix_f32 v166, v136, v136, 0 op_sel:[0,0,0] op_sel_hi:[1,1,0]
v_cvt_pk_bf16_f32 v88, v32, v33
s_setprio 0
v_fma_mix_f32 v166, v137, v137, v166 op_sel:[1,1,0] op_sel_hi:[1,1,0]
v_rcp_f16_sdwa v151, v150 dst_sel:WORD_1 dst_unused:UNUSED_PRESERVE src0_sel:WORD_1
v_cvt_pk_bf16_f32 v89, v34, v35
v_fma_mix_f32 v166, v138, v138, v166 op_sel:[0,0,0] op_sel_hi:[1,1,0]
v_rcp_f16_sdwa v148, v147 dst_sel:WORD_1 dst_unused:UNUSED_PRESERVE src0_sel:WORD_1
v_cvt_pk_bf16_f32 v90, v36, v37
s_add_u32 m0, s67, 26624
s_add_u32 s66, s66, 98304
buffer_load_dwordx4 v240, s[4:7], s66 offen lds
ds_read_b128 v[220:223], v248 offset:18432
v_mfma_f32_32x32x16_bf16 v[120:135], v[68:71], v[224:227], v[120:135]
v_fma_mix_f32 v166, v139, v139, v166 op_sel:[1,1,0] op_sel_hi:[1,1,0]
v_pk_mul_f16 v155, v155, v154
v_fma_mix_f32 v166, v140, v140, v166 op_sel:[0,0,0] op_sel_hi:[1,1,0]
v_cvt_pk_bf16_f32 v91, v38, v39
v_pk_mul_f16 v152, v152, v151
s_waitcnt lgkmcnt(1)
v_fma_mix_f32 v166, v141, v141, v166 op_sel:[1,1,0] op_sel_hi:[1,1,0]
v_cvt_pk_bf16_f32 v92, v40, v41
v_pk_mul_f16 v149, v149, v148
v_fma_mix_f32 v166, v155, v155, v166 op_sel:[0,0,0] op_sel_hi:[1,1,0]
v_fma_mix_f32 v166, v142, v142, v166 op_sel:[0,0,0] op_sel_hi:[1,1,0]
v_cvt_pk_bf16_f32 v93, v42, v43
v_fma_mix_f32 v166, v155, v155, v166 op_sel:[1,1,0] op_sel_hi:[1,1,0]
v_fma_mix_f32 v166, v143, v143, v166 op_sel:[1,1,0] op_sel_hi:[1,1,0]
v_fma_mix_f32 v166, v152, v152, v166 op_sel:[0,0,0] op_sel_hi:[1,1,0]
s_add_u32 m0, s67, 33280
s_add_u32 s66, s66, 98304
buffer_load_dwordx4 v240, s[4:7], s66 offen lds
v_cvt_pk_bf16_f32 v94, v44, v45
v_fma_mix_f32 v166, v152, v152, v166 op_sel:[1,1,0] op_sel_hi:[1,1,0]
v_fma_mix_f32 v166, v144, v144, v166 op_sel:[0,0,0] op_sel_hi:[1,1,0]
v_fma_mix_f32 v166, v149, v149, v166 op_sel:[0,0,0] op_sel_hi:[1,1,0]
v_cvt_pk_bf16_f32 v95, v46, v47
v_fma_mix_f32 v166, v145, v145, v166 op_sel:[1,1,0] op_sel_hi:[1,1,0]
v_fma_mix_f32 v166, v149, v149, v166 op_sel:[1,1,0] op_sel_hi:[1,1,0]
s_setprio 2
v_cvt_pkrtz_f16_f32 v137, v120, v121
v_cvt_pkrtz_f16_f32 v139, v122, v123
v_cvt_pkrtz_f16_f32 v141, v124, v125
v_cvt_pkrtz_f16_f32 v143, v126, v127
v_cvt_pkrtz_f16_f32 v145, v128, v129
v_cvt_pk_f16_f32 v155, v130, v131
v_cvt_pk_f16_f32 v152, v132, v133
v_cvt_pk_f16_f32 v149, v134, v135
buffer_store_dwordx4 v[48:51], v241, s[32:35], s80 offen sc1
ds_read_b128 v[224:227], v248 offset:21504
v_mfma_f32_32x32x16_bf16 v[120:135], v[72:75], v[228:231], 0
v_pk_fma_f16 v154, v155, v155, s48
v_and_b32_e64 v137, s49, v137
v_pk_fma_f16 v151, v152, v152, s48
v_and_b32_e64 v139, s49, v139
v_pk_fma_f16 v148, v149, v149, s48
v_pk_mul_f16 v154, v155, v154
v_bfe_u32 v136, v137, 2, 14
v_pk_mul_f16 v151, v152, v151
v_pk_mul_f16 v148, v149, v148
v_bfe_u32 v138, v139, 2, 14
ds_read_b128 v[228:231], v248 offset:22528
ds_read_u16_d16 v136, v136
ds_read_u16_d16 v138, v138
v_mfma_f32_32x32x16_bf16 v[120:135], v[76:79], v[232:235], v[120:135]
v_exp_f16 v153, v154
v_lshrrev_b32 v137, 18, v137
v_exp_f16 v150, v151
v_lshrrev_b32 v139, 18, v139
v_exp_f16 v147, v148
v_and_b32 v141, s49, v141
v_and_b32_e64 v143, s49, v143
ds_read_b128 v[232:235], v248 offset:25600
ds_read_u16_d16_hi v137, v137
ds_read_u16_d16_hi v139, v139
v_mfma_f32_32x32x16_bf16 v[120:135], v[80:83], v[236:239], v[120:135]
v_exp_f16_sdwa v153, v154 dst_sel:WORD_1 dst_unused:UNUSED_PRESERVE src0_sel:WORD_1
v_bfe_u32 v140, v141, 2, 14
v_exp_f16_sdwa v150, v151 dst_sel:WORD_1 dst_unused:UNUSED_PRESERVE src0_sel:WORD_1
v_bfe_u32 v142, v143, 2, 14
v_exp_f16_sdwa v147, v148 dst_sel:WORD_1 dst_unused:UNUSED_PRESERVE src0_sel:WORD_1
v_lshrrev_b32_e64 v141, 18, v141
v_pk_add_f16 v153, v153, 1.0 op_sel_hi:[1,0]
ds_read_b128 v[236:239], v248 offset:23552
ds_read_u16_d16 v140, v140
ds_read_u16_d16 v142, v142
ds_read_u16_d16_hi v141, v141
v_mfma_f32_32x32x16_bf16 v[120:135], v[84:87], v[216:219], v[120:135]
v_lshrrev_b32_e64 v143, 18, v143
v_pk_add_f16 v150, v150, 1.0 op_sel_hi:[1,0]
v_pk_add_f16 v147, v147, 1.0 op_sel_hi:[1,0]
v_and_b32 v145, s49, v145
v_rcp_f16 v154, v153
v_bfe_u32 v144, v145, 2, 14
v_rcp_f16_e64 v151, v150
v_lshrrev_b32 v145, 18, v145
s_waitcnt lgkmcnt(7)
ds_read_b128 v[216:219], v248 offset:26624
ds_read_u16_d16_hi v143, v143
ds_read_u16_d16 v144, v144
ds_read_u16_d16_hi v145, v145
v_mfma_f32_32x32x16_bf16 v[120:135], v[88:91], v[220:223], v[120:135]
v_rcp_f16 v148, v147
v_rcp_f16_sdwa v154, v153 dst_sel:WORD_1 dst_unused:UNUSED_PRESERVE src0_sel:WORD_1
v_fma_mix_f32 v167, v136, v136, 0 op_sel:[0,0,0] op_sel_hi:[1,1,0]
s_waitcnt lgkmcnt(8)
v_fma_mix_f32 v167, v137, v137, v167 op_sel:[1,1,0] op_sel_hi:[1,1,0]
v_rcp_f16_sdwa v151, v150 dst_sel:WORD_1 dst_unused:UNUSED_PRESERVE src0_sel:WORD_1
v_fma_mix_f32 v167, v138, v138, v167 op_sel:[0,0,0] op_sel_hi:[1,1,0]
ds_read_b128 v[220:223], v248 offset:24576
v_mfma_f32_32x32x16_bf16 v[120:135], v[92:95], v[224:227], v[120:135]
v_rcp_f16_sdwa v148, v147 dst_sel:WORD_1 dst_unused:UNUSED_PRESERVE src0_sel:WORD_1
v_fma_mix_f32 v167, v139, v139, v167 op_sel:[1,1,0] op_sel_hi:[1,1,0]
v_pk_mul_f16 v155, v155, v154
s_waitcnt lgkmcnt(5)
v_fma_mix_f32 v167, v140, v140, v167 op_sel:[0,0,0] op_sel_hi:[1,1,0]
v_pk_mul_f16 v152, v152, v151
v_fma_mix_f32 v167, v141, v141, v167 op_sel:[1,1,0] op_sel_hi:[1,1,0]
v_pk_mul_f16 v149, v149, v148
v_fma_mix_f32 v167, v155, v155, v167 op_sel:[0,0,0] op_sel_hi:[1,1,0]
v_fma_mix_f32 v167, v142, v142, v167 op_sel:[0,0,0] op_sel_hi:[1,1,0]
v_fma_mix_f32 v167, v155, v155, v167 op_sel:[1,1,0] op_sel_hi:[1,1,0]
s_waitcnt lgkmcnt(3)
v_fma_mix_f32 v167, v143, v143, v167 op_sel:[1,1,0] op_sel_hi:[1,1,0]
v_fma_mix_f32 v167, v152, v152, v167 op_sel:[0,0,0] op_sel_hi:[1,1,0]
v_fma_mix_f32 v167, v152, v152, v167 op_sel:[1,1,0] op_sel_hi:[1,1,0]
s_waitcnt lgkmcnt(1)
v_fma_mix_f32 v167, v144, v144, v167 op_sel:[0,0,0] op_sel_hi:[1,1,0]
v_fma_mix_f32 v167, v149, v149, v167 op_sel:[0,0,0] op_sel_hi:[1,1,0]
v_fma_mix_f32 v167, v145, v145, v167 op_sel:[1,1,0] op_sel_hi:[1,1,0]
v_fma_mix_f32 v167, v149, v149, v167 op_sel:[1,1,0] op_sel_hi:[1,1,0]
s_setprio 1
v_cvt_pkrtz_f16_f32 v137, v120, v121
v_cvt_pkrtz_f16_f32 v139, v122, v123
v_cvt_pkrtz_f16_f32 v141, v124, v125
v_cvt_pkrtz_f16_f32 v143, v126, v127
v_cvt_pkrtz_f16_f32 v145, v128, v129
v_cvt_pk_f16_f32 v155, v130, v131
v_cvt_pk_f16_f32 v152, v132, v133
v_cvt_pk_f16_f32 v149, v134, v135
s_add_u32 s46, s80, 2097152
buffer_store_dwordx4 v[52:55], v241, s[32:35], s46 offen sc1
ds_read_b128 v[224:227], v248 offset:27648
v_mfma_f32_32x32x16_bf16 v[120:135], v[72:75], v[228:231], 0
v_pk_fma_f16 v154, v155, v155, s48
v_and_b32_e64 v137, s49, v137
v_pk_fma_f16 v151, v152, v152, s48
v_and_b32_e64 v139, s49, v139
v_pk_fma_f16 v148, v149, v149, s48
v_pk_mul_f16 v154, v155, v154
v_bfe_u32 v136, v137, 2, 14
v_pk_mul_f16 v151, v152, v151
v_pk_mul_f16 v148, v149, v148
v_bfe_u32 v138, v139, 2, 14
ds_read_b128 v[228:231], v248 offset:28672
ds_read_u16_d16 v136, v136
ds_read_u16_d16 v138, v138
v_mfma_f32_32x32x16_bf16 v[120:135], v[76:79], v[232:235], v[120:135]
v_exp_f16 v153, v154
v_lshrrev_b32 v137, 18, v137
v_exp_f16 v150, v151
v_lshrrev_b32 v139, 18, v139
v_exp_f16 v147, v148
v_and_b32 v141, s49, v141
v_and_b32_e64 v143, s49, v143
ds_read_b128 v[232:235], v248 offset:31744
ds_read_u16_d16_hi v137, v137
ds_read_u16_d16_hi v139, v139
v_mfma_f32_32x32x16_bf16 v[120:135], v[80:83], v[236:239], v[120:135]
v_exp_f16_sdwa v153, v154 dst_sel:WORD_1 dst_unused:UNUSED_PRESERVE src0_sel:WORD_1
v_bfe_u32 v140, v141, 2, 14
v_exp_f16_sdwa v150, v151 dst_sel:WORD_1 dst_unused:UNUSED_PRESERVE src0_sel:WORD_1
v_bfe_u32 v142, v143, 2, 14
v_exp_f16_sdwa v147, v148 dst_sel:WORD_1 dst_unused:UNUSED_PRESERVE src0_sel:WORD_1
v_lshrrev_b32_e64 v141, 18, v141
v_pk_add_f16 v153, v153, 1.0 op_sel_hi:[1,0]
ds_read_b128 v[236:239], v248 offset:29696
ds_read_u16_d16 v140, v140
ds_read_u16_d16 v142, v142
ds_read_u16_d16_hi v141, v141
v_mfma_f32_32x32x16_bf16 v[120:135], v[84:87], v[216:219], v[120:135]
v_lshrrev_b32_e64 v143, 18, v143
v_pk_add_f16 v150, v150, 1.0 op_sel_hi:[1,0]
v_pk_add_f16 v147, v147, 1.0 op_sel_hi:[1,0]
v_and_b32 v145, s49, v145
v_rcp_f16 v154, v153
v_bfe_u32 v144, v145, 2, 14
v_rcp_f16_e64 v151, v150
v_lshrrev_b32 v145, 18, v145
s_waitcnt lgkmcnt(7)
ds_read_b128 v[216:219], v248 offset:32768
ds_read_u16_d16_hi v143, v143
ds_read_u16_d16 v144, v144
ds_read_u16_d16_hi v145, v145
v_mfma_f32_32x32x16_bf16 v[120:135], v[88:91], v[220:223], v[120:135]
v_rcp_f16_e64 v148, v147
v_rcp_f16_sdwa v154, v153 dst_sel:WORD_1 dst_unused:UNUSED_PRESERVE src0_sel:WORD_1
v_fma_mix_f32 v156, v136, v136, v156 op_sel:[0,0,0] op_sel_hi:[1,1,0]
s_setprio 0
s_waitcnt lgkmcnt(8)
v_fma_mix_f32 v156, v137, v137, v156 op_sel:[1,1,0] op_sel_hi:[1,1,0]
v_rcp_f16_sdwa v151, v150 dst_sel:WORD_1 dst_unused:UNUSED_PRESERVE src0_sel:WORD_1
v_fma_mix_f32 v156, v138, v138, v156 op_sel:[0,0,0] op_sel_hi:[1,1,0]
ds_read_b128 v[220:223], v248 offset:30720
v_mfma_f32_32x32x16_bf16 v[120:135], v[92:95], v[224:227], v[120:135]
v_rcp_f16_sdwa v148, v147 dst_sel:WORD_1 dst_unused:UNUSED_PRESERVE src0_sel:WORD_1
v_fma_mix_f32 v156, v139, v139, v156 op_sel:[1,1,0] op_sel_hi:[1,1,0]
v_pk_mul_f16 v155, v155, v154
s_cmp_eq_u32 s40, 7
s_cbranch_scc1 Lrdy16
s_waitcnt vmcnt(2)
Lrdy16:
s_mov_b64 exec, 1
ds_add_u32 v253, v254 offset:12
s_mov_b64 exec, -1
s_waitcnt lgkmcnt(6)
v_fma_mix_f32 v156, v140, v140, v156 op_sel:[0,0,0] op_sel_hi:[1,1,0]
v_pk_mul_f16 v152, v152, v151
v_fma_mix_f32 v156, v141, v141, v156 op_sel:[1,1,0] op_sel_hi:[1,1,0]
v_pk_mul_f16 v149, v149, v148
v_fma_mix_f32 v156, v155, v155, v156 op_sel:[0,0,0] op_sel_hi:[1,1,0]
v_fma_mix_f32 v156, v142, v142, v156 op_sel:[0,0,0] op_sel_hi:[1,1,0]
v_fma_mix_f32 v156, v155, v155, v156 op_sel:[1,1,0] op_sel_hi:[1,1,0]
s_waitcnt lgkmcnt(2)
v_fma_mix_f32 v156, v143, v143, v156 op_sel:[1,1,0] op_sel_hi:[1,1,0]
v_fma_mix_f32 v156, v152, v152, v156 op_sel:[0,0,0] op_sel_hi:[1,1,0]
v_fma_mix_f32 v156, v152, v152, v156 op_sel:[1,1,0] op_sel_hi:[1,1,0]
v_fma_mix_f32 v156, v144, v144, v156 op_sel:[0,0,0] op_sel_hi:[1,1,0]
v_fma_mix_f32 v156, v149, v149, v156 op_sel:[0,0,0] op_sel_hi:[1,1,0]
v_fma_mix_f32 v156, v145, v145, v156 op_sel:[1,1,0] op_sel_hi:[1,1,0]
v_fma_mix_f32 v156, v149, v149, v156 op_sel:[1,1,0] op_sel_hi:[1,1,0]
s_setprio 2
v_cvt_pkrtz_f16_f32 v137, v120, v121
v_cvt_pkrtz_f16_f32 v139, v122, v123
v_cvt_pkrtz_f16_f32 v141, v124, v125
v_cvt_pkrtz_f16_f32 v143, v126, v127
v_cvt_pkrtz_f16_f32 v145, v128, v129
v_cvt_pk_f16_f32 v155, v130, v131
v_cvt_pk_f16_f32 v152, v132, v133
v_cvt_pk_f16_f32 v149, v134, v135
s_add_u32 s46, s80, 4194304
buffer_store_dwordx4 v[56:59], v241, s[32:35], s46 offen sc1
ds_read_b128 v[224:227], v248 offset:33792
v_mfma_f32_32x32x16_bf16 v[120:135], v[72:75], v[228:231], 0
v_pk_fma_f16 v154, v155, v155, s48
v_and_b32_e64 v137, s49, v137
v_pk_fma_f16 v151, v152, v152, s48
v_and_b32_e64 v139, s49, v139
v_pk_fma_f16 v148, v149, v149, s48
v_pk_mul_f16 v154, v155, v154
v_bfe_u32 v136, v137, 2, 14
v_pk_mul_f16 v151, v152, v151
v_pk_mul_f16 v148, v149, v148
v_bfe_u32 v138, v139, 2, 14
ds_read_b128 v[228:231], v250 offset:65520
ds_read_u16_d16 v136, v136
ds_read_u16_d16 v138, v138
v_mfma_f32_32x32x16_bf16 v[120:135], v[76:79], v[232:235], v[120:135]
v_exp_f16 v153, v154
v_lshrrev_b32 v137, 18, v137
v_exp_f16 v150, v151
v_lshrrev_b32 v139, 18, v139
v_exp_f16 v147, v148
v_and_b32 v141, s49, v141
v_and_b32_e64 v143, s49, v143
ds_read_b128 v[232:235], v248 offset:34816
ds_read_u16_d16_hi v137, v137
ds_read_b32 v247, v253 offset:12
ds_read_u16_d16_hi v139, v139
v_mfma_f32_32x32x16_bf16 v[120:135], v[80:83], v[236:239], v[120:135]
v_exp_f16_sdwa v153, v154 dst_sel:WORD_1 dst_unused:UNUSED_PRESERVE src0_sel:WORD_1
v_bfe_u32 v140, v141, 2, 14
v_exp_f16_sdwa v150, v151 dst_sel:WORD_1 dst_unused:UNUSED_PRESERVE src0_sel:WORD_1
v_bfe_u32 v142, v143, 2, 14
v_exp_f16_sdwa v147, v148 dst_sel:WORD_1 dst_unused:UNUSED_PRESERVE src0_sel:WORD_1
v_lshrrev_b32_e64 v141, 18, v141
v_pk_add_f16 v153, v153, 1.0 op_sel_hi:[1,0]
ds_read_b128 v[236:239], v248 offset:37888
ds_read_u16_d16 v140, v140
ds_read_u16_d16 v142, v142
ds_read_u16_d16_hi v141, v141
v_mfma_f32_32x32x16_bf16 v[120:135], v[84:87], v[216:219], v[120:135]
v_lshrrev_b32_e64 v143, 18, v143
v_pk_add_f16 v150, v150, 1.0 op_sel_hi:[1,0]
v_pk_add_f16 v147, v147, 1.0 op_sel_hi:[1,0]
v_and_b32 v145, s49, v145
v_rcp_f16 v154, v153
v_bfe_u32 v144, v145, 2, 14
ds_read_u16_d16_hi v143, v143
ds_read_u16_d16 v144, v144
s_waitcnt lgkmcnt(7)
v_readfirstlane_b32 s43, v247
s_nop 1
s_cmp_ge_u32 s43, 24
s_cbranch_scc1 Lev5
Lev5w:
s_sleep 1
ds_read_b32 v247, v253 offset:12
s_waitcnt lgkmcnt(0)
v_readfirstlane_b32 s43, v247
s_cmp_eq_u32 s76, 0
s_cbranch_scc1 Lev5
s_sub_u32 s76, s76, 1
s_cmp_lt_u32 s43, 24
s_cbranch_scc1 Lev5w
Lev5:
v_rcp_f16 v151, v150
v_lshrrev_b32_e64 v145, 18, v145
ds_read_b128 v[216:219], v248 offset:35840
ds_read_u16_d16_hi v145, v145
v_mfma_f32_32x32x16_bf16 v[120:135], v[88:91], v[220:223], v[120:135]
v_rcp_f16 v148, v147
v_rcp_f16_sdwa v154, v153 dst_sel:WORD_1 dst_unused:UNUSED_PRESERVE src0_sel:WORD_1
v_fma_mix_f32 v157, v136, v136, v157 op_sel:[0,0,0] op_sel_hi:[1,1,0]
v_fma_mix_f32 v157, v137, v137, v157 op_sel:[1,1,0] op_sel_hi:[1,1,0]
v_rcp_f16_sdwa v151, v150 dst_sel:WORD_1 dst_unused:UNUSED_PRESERVE src0_sel:WORD_1
v_fma_mix_f32 v157, v138, v138, v157 op_sel:[0,0,0] op_sel_hi:[1,1,0]
ds_read_b128 v[220:223], v245
ds_read_b128 v[192:195], v242
ds_read_b128 v[196:199], v242 offset:64
v_mfma_f32_32x32x16_bf16 v[120:135], v[92:95], v[224:227], v[120:135]
v_rcp_f16_sdwa v148, v147 dst_sel:WORD_1 dst_unused:UNUSED_PRESERVE src0_sel:WORD_1
s_waitcnt lgkmcnt(5)
v_fma_mix_f32 v157, v139, v139, v157 op_sel:[1,1,0] op_sel_hi:[1,1,0]
v_pk_mul_f16 v155, v155, v154
v_fma_mix_f32 v157, v140, v140, v157 op_sel:[0,0,0] op_sel_hi:[1,1,0]
v_pk_mul_f16 v152, v152, v151
v_fma_mix_f32 v157, v141, v141, v157 op_sel:[1,1,0] op_sel_hi:[1,1,0]
v_pk_mul_f16 v149, v149, v148
v_fma_mix_f32 v157, v155, v155, v157 op_sel:[0,0,0] op_sel_hi:[1,1,0]
v_fma_mix_f32 v157, v142, v142, v157 op_sel:[0,0,0] op_sel_hi:[1,1,0]
v_fma_mix_f32 v157, v155, v155, v157 op_sel:[1,1,0] op_sel_hi:[1,1,0]
v_fma_mix_f32 v157, v143, v143, v157 op_sel:[1,1,0] op_sel_hi:[1,1,0]
v_fma_mix_f32 v157, v152, v152, v157 op_sel:[0,0,0] op_sel_hi:[1,1,0]
v_fma_mix_f32 v157, v152, v152, v157 op_sel:[1,1,0] op_sel_hi:[1,1,0]
v_fma_mix_f32 v157, v144, v144, v157 op_sel:[0,0,0] op_sel_hi:[1,1,0]
v_fma_mix_f32 v157, v149, v149, v157 op_sel:[0,0,0] op_sel_hi:[1,1,0]
s_waitcnt lgkmcnt(3)
v_fma_mix_f32 v157, v145, v145, v157 op_sel:[1,1,0] op_sel_hi:[1,1,0]
v_fma_mix_f32 v157, v149, v149, v157 op_sel:[1,1,0] op_sel_hi:[1,1,0]
s_setprio 1
v_mfma_f32_32x32x16_bf16 v[0:15], v[228:231], v[228:231], 0
s_add_u32 s46, s80, 6291456
buffer_store_dwordx4 v[60:63], v241, s[32:35], s46 offen sc1
ds_read_b128 v[224:227], v248 offset:38912
v_cvt_pkrtz_f16_f32 v137, v120, v121
v_cvt_pkrtz_f16_f32 v139, v122, v123
v_cvt_pkrtz_f16_f32 v141, v124, v125
v_cvt_pkrtz_f16_f32 v143, v126, v127
v_mfma_f32_32x32x16_bf16 v[16:31], v[228:231], v[228:231], 0
v_cvt_pk_f16_f32 v155, v128, v129
v_cvt_pk_f16_f32 v152, v130, v131
v_cvt_pk_f16_f32 v149, v132, v133
v_cvt_pk_f16_f32 v146, v134, v135
v_mfma_f32_32x32x16_bf16 v[32:47], v[228:231], v[228:231], 0
v_pk_fma_f16 v154, v155, v155, s48
v_and_b32_e64 v137, s49, v137
v_pk_fma_f16 v151, v152, v152, s48
v_pk_fma_f16 v148, v149, v149, s48
v_mfma_f32_32x32x16_bf16 v[120:135], v[72:75], v[232:235], 0
ds_read_b128 v[228:231], v248 offset:36864
v_and_b32_e64 v139, s49, v139
v_pk_fma_f16 v145, v146, v146, s48
v_pk_mul_f16 v154, v155, v154
v_bfe_u32 v136, v137, 2, 14
v_pk_mul_f16 v151, v152, v151
v_pk_mul_f16 v148, v149, v148
v_bfe_u32 v138, v139, 2, 14
v_pk_mul_f16 v145, v146, v145
v_mfma_f32_32x32x16_bf16 v[120:135], v[76:79], v[236:239], v[120:135]
ds_read_b128 v[232:235], v245 offset:384
ds_read_b128 v[200:203], v242 offset:128
ds_read_b128 v[204:207], v243
ds_read_u16_d16 v136, v136
ds_read_u16_d16 v138, v138
v_exp_f16 v153, v154
v_lshrrev_b32 v137, 18, v137
v_exp_f16 v150, v151
v_lshrrev_b32 v139, 18, v139
v_exp_f16_e64 v147, v148
v_mfma_f32_32x32x16_bf16 v[120:135], v[80:83], v[216:219], v[120:135]
ds_read_b128 v[236:239], v248 offset:39936
ds_read_u16_d16_hi v137, v137
ds_read_u16_d16_hi v139, v139
v_and_b32 v141, s49, v141
v_exp_f16 v144, v145
v_and_b32 v143, s49, v143
v_exp_f16_sdwa v153, v154 dst_sel:WORD_1 dst_unused:UNUSED_PRESERVE src0_sel:WORD_1
v_bfe_u32 v140, v141, 2, 14
s_waitcnt lgkmcnt(8)
v_smfmac_f32_16x16x32_bf16 v[0:3], v[220:221], v[192:195], v246
ds_read_b128 v[216:219], v245 offset:768
ds_read_b128 v[208:211], v243 offset:64
ds_read_b128 v[212:215], v243 offset:128
ds_read_u16_d16 v140, v140
v_exp_f16_sdwa v150, v151 dst_sel:WORD_1 dst_unused:UNUSED_PRESERVE src0_sel:WORD_1
v_bfe_u32 v142, v143, 2, 14
v_exp_f16_sdwa v147, v148 dst_sel:WORD_1 dst_unused:UNUSED_PRESERVE src0_sel:WORD_1
v_smfmac_f32_16x16x32_bf16 v[16:19], v[222:223], v[196:199], v246
v_lshrrev_b32_e64 v141, 18, v141
v_exp_f16_sdwa v144, v145 dst_sel:WORD_1 dst_unused:UNUSED_PRESERVE src0_sel:WORD_1
v_lshrrev_b32_e64 v143, 18, v143
v_mfma_f32_32x32x16_bf16 v[120:135], v[84:87], v[224:227], v[120:135]
ds_read_b128 v[220:223], v245 offset:1152
ds_read_b128 v[192:195], v244
ds_read_b128 v[196:199], v244 offset:64
ds_read_u16_d16 v142, v142
ds_read_u16_d16_hi v141, v141
ds_read_u16_d16_hi v143, v143
v_pk_add_f16 v153, v153, 1.0 op_sel_hi:[1,0]
v_pk_add_f16 v150, v150, 1.0 op_sel_hi:[1,0]
v_pk_add_f16 v147, v147, 1.0 op_sel_hi:[1,0]
v_pk_add_f16 v144, v144, 1.0 op_sel_hi:[1,0]
v_rcp_f16 v154, v153
v_rcp_f16 v151, v150
v_mfma_f32_32x32x16_bf16 v[120:135], v[88:91], v[228:231], v[120:135]
ds_read_b128 v[224:227], v248 offset:40960
v_rcp_f16 v148, v147
v_rcp_f16 v145, v144
v_rcp_f16_sdwa v154, v153 dst_sel:WORD_1 dst_unused:UNUSED_PRESERVE src0_sel:WORD_1
v_rcp_f16_sdwa v151, v150 dst_sel:WORD_1 dst_unused:UNUSED_PRESERVE src0_sel:WORD_1
s_setprio 0
s_waitcnt lgkmcnt(7)
v_smfmac_f32_16x16x32_bf16 v[32:35], v[232:233], v[200:203], v246
ds_read_b128 v[228:231], v248 offset:44032
v_rcp_f16_sdwa v148, v147 dst_sel:WORD_1 dst_unused:UNUSED_PRESERVE src0_sel:WORD_1
v_fma_mix_f32 v158, v136, v136, v158 op_sel:[0,0,0] op_sel_hi:[1,1,0]
v_smfmac_f32_16x16x32_bf16 v[0:3], v[234:235], v[204:207], v246
v_rcp_f16_sdwa v145, v144 dst_sel:WORD_1 dst_unused:UNUSED_PRESERVE src0_sel:WORD_1
v_fma_mix_f32 v158, v137, v137, v158 op_sel:[1,1,0] op_sel_hi:[1,1,0]
v_pk_mul_f16 v155, v155, v154
v_fma_mix_f32 v158, v138, v138, v158 op_sel:[0,0,0] op_sel_hi:[1,1,0]
v_mfma_f32_32x32x16_bf16 v[120:135], v[92:95], v[236:239], v[120:135]
ds_read_b128 v[232:235], v248 offset:41984
v_pk_mul_f16 v152, v152, v151
v_pk_mul_f16 v149, v149, v148
v_fma_mix_f32 v158, v139, v139, v158 op_sel:[1,1,0] op_sel_hi:[1,1,0]
v_pk_mul_f16 v146, v146, v145
v_fma_mix_f32 v158, v155, v155, v158 op_sel:[0,0,0] op_sel_hi:[1,1,0]
v_fma_mix_f32 v158, v140, v140, v158 op_sel:[0,0,0] op_sel_hi:[1,1,0]
v_fma_mix_f32 v158, v155, v155, v158 op_sel:[1,1,0] op_sel_hi:[1,1,0]
v_fma_mix_f32 v158, v152, v152, v158 op_sel:[0,0,0] op_sel_hi:[1,1,0]
v_smfmac_f32_16x16x32_bf16 v[16:19], v[216:217], v[208:211], v246
ds_read_b128 v[236:239], v248 offset:45056
s_waitcnt lgkmcnt(3)
v_fma_mix_f32 v158, v141, v141, v158 op_sel:[1,1,0] op_sel_hi:[1,1,0]
v_fma_mix_f32 v158, v152, v152, v158 op_sel:[1,1,0] op_sel_hi:[1,1,0]
v_fma_mix_f32 v158, v149, v149, v158 op_sel:[0,0,0] op_sel_hi:[1,1,0]
v_fma_mix_f32 v158, v142, v142, v158 op_sel:[0,0,0] op_sel_hi:[1,1,0]
v_smfmac_f32_16x16x32_bf16 v[32:35], v[218:219], v[212:215], v246
v_fma_mix_f32 v158, v149, v149, v158 op_sel:[1,1,0] op_sel_hi:[1,1,0]
v_fma_mix_f32 v158, v146, v146, v158 op_sel:[0,0,0] op_sel_hi:[1,1,0]
v_fma_mix_f32 v158, v143, v143, v158 op_sel:[1,1,0] op_sel_hi:[1,1,0]
v_fma_mix_f32 v158, v146, v146, v158 op_sel:[1,1,0] op_sel_hi:[1,1,0]
s_setprio 2
v_smfmac_f32_16x16x32_bf16 v[0:3], v[220:221], v[192:195], v246
s_add_u32 s46, s80, 8388608
buffer_store_dwordx4 v[64:67], v241, s[32:35], s46 offen sc1
ds_read_b128 v[216:219], v248 offset:43008
v_cvt_pkrtz_f16_f32 v137, v120, v121
v_cvt_pkrtz_f16_f32 v139, v122, v123
v_cvt_pkrtz_f16_f32 v141, v124, v125
v_cvt_pkrtz_f16_f32 v143, v126, v127
v_smfmac_f32_16x16x32_bf16 v[16:19], v[222:223], v[196:199], v246
v_cvt_pkrtz_f16_f32 v145, v128, v129
v_cvt_pk_f16_f32 v155, v130, v131
v_cvt_pk_f16_f32 v152, v132, v133
v_cvt_pk_f16_f32 v149, v134, v135
v_mfma_f32_32x32x16_bf16 v[120:135], v[72:75], v[224:227], 0
ds_read_b128 v[220:223], v245 offset:1536
ds_read_b128 v[200:203], v244 offset:128
v_xor_b32 v242, 16, v242
ds_read_b128 v[204:207], v242
v_pk_fma_f16 v154, v155, v155, s48
v_and_b32 v137, s49, v137
v_pk_fma_f16 v151, v152, v152, s48
v_and_b32 v139, s49, v139
v_pk_fma_f16 v148, v149, v149, s48
v_pk_mul_f16 v154, v155, v154
v_bfe_u32 v136, v137, 2, 14
v_pk_mul_f16 v151, v152, v151
s_waitcnt lgkmcnt(4)
v_mfma_f32_32x32x16_bf16 v[120:135], v[76:79], v[228:231], v[120:135]
ds_read_b128 v[224:227], v248 offset:46080
ds_read_u16_d16 v136, v136
v_pk_mul_f16 v148, v149, v148
v_bfe_u32 v138, v139, 2, 14
v_exp_f16 v153, v154
v_lshrrev_b32 v137, 18, v137
v_exp_f16 v150, v151
v_lshrrev_b32 v139, 18, v139
v_mfma_f32_32x32x16_bf16 v[120:135], v[80:83], v[232:235], v[120:135]
ds_read_b128 v[228:231], v245 offset:1920
ds_read_b128 v[208:211], v242 offset:64
ds_read_b128 v[212:215], v242 offset:128
ds_read_u16_d16 v138, v138
ds_read_u16_d16_hi v137, v137
ds_read_u16_d16_hi v139, v139
v_exp_f16 v147, v148
v_and_b32 v141, s49, v141
v_and_b32 v143, s49, v143
v_exp_f16_sdwa v153, v154 dst_sel:WORD_1 dst_unused:UNUSED_PRESERVE src0_sel:WORD_1
v_bfe_u32 v140, v141, 2, 14
v_exp_f16_sdwa v150, v151 dst_sel:WORD_1 dst_unused:UNUSED_PRESERVE src0_sel:WORD_1
v_mfma_f32_32x32x16_bf16 v[120:135], v[84:87], v[236:239], v[120:135]
ds_read_b128 v[232:235], v245 offset:2304
v_xor_b32 v243, 16, v243
ds_read_b128 v[192:195], v243
ds_read_b128 v[196:199], v243 offset:64
ds_read_u16_d16 v140, v140
v_bfe_u32 v142, v143, 2, 14
v_exp_f16_sdwa v147, v148 dst_sel:WORD_1 dst_unused:UNUSED_PRESERVE src0_sel:WORD_1
v_lshrrev_b32_e64 v141, 18, v141
v_pk_add_f16 v153, v153, 1.0 op_sel_hi:[1,0]
v_lshrrev_b32 v143, 18, v143
v_pk_add_f16 v150, v150, 1.0 op_sel_hi:[1,0]
v_pk_add_f16 v147, v147, 1.0 op_sel_hi:[1,0]
s_waitcnt lgkmcnt(9)
v_mfma_f32_32x32x16_bf16 v[120:135], v[88:91], v[216:219], v[120:135]
ds_read_b128 v[236:239], v248 offset:47104
ds_read_u16_d16 v142, v142
ds_read_u16_d16_hi v141, v141
ds_read_u16_d16_hi v143, v143
v_and_b32 v145, s49, v145
v_rcp_f16 v154, v153
v_bfe_u32 v144, v145, 2, 14
v_rcp_f16 v151, v150
v_lshrrev_b32 v145, 18, v145
v_rcp_f16_e64 v148, v147
v_smfmac_f32_16x16x32_bf16 v[32:35], v[220:221], v[200:203], v246
ds_read_b128 v[216:219], v248 offset:50176
ds_read_u16_d16 v144, v144
ds_read_u16_d16_hi v145, v145
v_rcp_f16_sdwa v154, v153 dst_sel:WORD_1 dst_unused:UNUSED_PRESERVE src0_sel:WORD_1
v_fma_mix_f32 v159, v136, v136, v159 op_sel:[0,0,0] op_sel_hi:[1,1,0]
s_waitcnt lgkmcnt(7)
v_fma_mix_f32 v159, v137, v137, v159 op_sel:[1,1,0] op_sel_hi:[1,1,0]
v_smfmac_f32_16x16x32_bf16 v[4:7], v[222:223], v[204:207], v246
v_rcp_f16_sdwa v151, v150 dst_sel:WORD_1 dst_unused:UNUSED_PRESERVE src0_sel:WORD_1
v_fma_mix_f32 v159, v138, v138, v159 op_sel:[0,0,0] op_sel_hi:[1,1,0]
v_mfma_f32_32x32x16_bf16 v[120:135], v[92:95], v[224:227], v[120:135]
ds_read_b128 v[220:223], v248 offset:48128
v_rcp_f16_sdwa v148, v147 dst_sel:WORD_1 dst_unused:UNUSED_PRESERVE src0_sel:WORD_1
v_fma_mix_f32 v159, v139, v139, v159 op_sel:[1,1,0] op_sel_hi:[1,1,0]
v_pk_mul_f16 v155, v155, v154
v_fma_mix_f32 v159, v140, v140, v159 op_sel:[0,0,0] op_sel_hi:[1,1,0]
v_pk_mul_f16 v152, v152, v151
s_waitcnt lgkmcnt(4)
v_fma_mix_f32 v159, v141, v141, v159 op_sel:[1,1,0] op_sel_hi:[1,1,0]
v_pk_mul_f16 v149, v149, v148
v_fma_mix_f32 v159, v155, v155, v159 op_sel:[0,0,0] op_sel_hi:[1,1,0]
v_smfmac_f32_16x16x32_bf16 v[20:23], v[228:229], v[208:211], v246
ds_read_b128 v[224:227], v248 offset:51200
v_fma_mix_f32 v159, v142, v142, v159 op_sel:[0,0,0] op_sel_hi:[1,1,0]
v_fma_mix_f32 v159, v155, v155, v159 op_sel:[1,1,0] op_sel_hi:[1,1,0]
v_fma_mix_f32 v159, v143, v143, v159 op_sel:[1,1,0] op_sel_hi:[1,1,0]
v_fma_mix_f32 v159, v152, v152, v159 op_sel:[0,0,0] op_sel_hi:[1,1,0]
v_smfmac_f32_16x16x32_bf16 v[36:39], v[230:231], v[212:215], v246
v_fma_mix_f32 v159, v152, v152, v159 op_sel:[1,1,0] op_sel_hi:[1,1,0]
s_waitcnt lgkmcnt(2)
v_fma_mix_f32 v159, v144, v144, v159 op_sel:[0,0,0] op_sel_hi:[1,1,0]
v_fma_mix_f32 v159, v149, v149, v159 op_sel:[0,0,0] op_sel_hi:[1,1,0]
v_fma_mix_f32 v159, v145, v145, v159 op_sel:[1,1,0] op_sel_hi:[1,1,0]
v_fma_mix_f32 v159, v149, v149, v159 op_sel:[1,1,0] op_sel_hi:[1,1,0]
s_setprio 1
v_smfmac_f32_16x16x32_bf16 v[4:7], v[232:233], v[192:195], v246
s_add_u32 s46, s80, 10485760
buffer_store_dwordx4 v[68:71], v241, s[32:35], s46 offen sc1
ds_read_b128 v[228:231], v248 offset:49152
v_cvt_pkrtz_f16_f32 v137, v120, v121
v_cvt_pkrtz_f16_f32 v139, v122, v123
v_cvt_pkrtz_f16_f32 v141, v124, v125
v_cvt_pkrtz_f16_f32 v143, v126, v127
v_cvt_pk_f16_f32 v155, v128, v129
v_smfmac_f32_16x16x32_bf16 v[20:23], v[234:235], v[196:199], v246
v_cvt_pk_f16_f32 v152, v130, v131
v_cvt_pk_f16_f32 v149, v132, v133
v_cvt_pk_f16_f32 v146, v134, v135
v_pk_fma_f16 v154, v155, v155, s48
v_and_b32_e64 v137, s49, v137
v_mfma_f32_32x32x16_bf16 v[120:135], v[72:75], v[236:239], 0
ds_read_b128 v[232:235], v248 offset:52224
v_pk_fma_f16 v151, v152, v152, s48
v_pk_fma_f16 v148, v149, v149, s48
v_and_b32_e64 v139, s49, v139
v_pk_fma_f16 v145, v146, v146, s48
v_pk_mul_f16 v154, v155, v154
v_bfe_u32 v136, v137, 2, 14
v_pk_mul_f16 v151, v152, v151
v_pk_mul_f16 v148, v149, v148
v_bfe_u32 v138, v139, 2, 14
v_pk_mul_f16 v145, v146, v145
v_mfma_f32_32x32x16_bf16 v[120:135], v[76:79], v[216:219], v[120:135]
ds_read_b128 v[236:239], v245 offset:2688
ds_read_b128 v[200:203], v243 offset:128
v_xor_b32 v244, 16, v244
ds_read_b128 v[204:207], v244
ds_read_u16_d16 v136, v136
ds_read_u16_d16 v138, v138
v_exp_f16 v153, v154
v_lshrrev_b32 v137, 18, v137
v_exp_f16 v150, v151
v_lshrrev_b32 v139, 18, v139
v_exp_f16 v147, v148
v_and_b32_e64 v141, s49, v141
v_exp_f16 v144, v145
s_waitcnt lgkmcnt(5)
v_mfma_f32_32x32x16_bf16 v[120:135], v[80:83], v[220:223], v[120:135]
ds_read_b128 v[216:219], v245 offset:3072
ds_read_b128 v[208:211], v244 offset:64
ds_read_b128 v[212:215], v244 offset:128
ds_read_u16_d16_hi v137, v137
ds_read_u16_d16_hi v139, v139
v_and_b32_e64 v143, s49, v143
v_exp_f16_sdwa v153, v154 dst_sel:WORD_1 dst_unused:UNUSED_PRESERVE src0_sel:WORD_1
v_bfe_u32 v140, v141, 2, 14
v_exp_f16_sdwa v150, v151 dst_sel:WORD_1 dst_unused:UNUSED_PRESERVE src0_sel:WORD_1
v_bfe_u32 v142, v143, 2, 14
v_exp_f16_sdwa v147, v148 dst_sel:WORD_1 dst_unused:UNUSED_PRESERVE src0_sel:WORD_1
v_lshrrev_b32_e64 v141, 18, v141
v_mfma_f32_32x32x16_bf16 v[120:135], v[84:87], v[224:227], v[120:135]
ds_read_b128 v[220:223], v248 offset:53248
ds_read_u16_d16 v140, v140
ds_read_u16_d16 v142, v142
ds_read_u16_d16_hi v141, v141
v_exp_f16_sdwa v144, v145 dst_sel:WORD_1 dst_unused:UNUSED_PRESERVE src0_sel:WORD_1
v_lshrrev_b32_e64 v143, 18, v143
v_pk_add_f16 v153, v153, 1.0 op_sel_hi:[1,0]
v_pk_add_f16 v150, v150, 1.0 op_sel_hi:[1,0]
v_pk_add_f16 v147, v147, 1.0 op_sel_hi:[1,0]
v_pk_add_f16 v144, v144, 1.0 op_sel_hi:[1,0]
v_rcp_f16 v154, v153
v_rcp_f16 v151, v150
v_mfma_f32_32x32x16_bf16 v[120:135], v[88:91], v[228:231], v[120:135]
ds_read_b128 v[224:227], v248 offset:56320
ds_read_u16_d16_hi v143, v143
v_rcp_f16 v148, v147
v_rcp_f16 v145, v144
v_rcp_f16_sdwa v154, v153 dst_sel:WORD_1 dst_unused:UNUSED_PRESERVE src0_sel:WORD_1
v_rcp_f16_sdwa v151, v150 dst_sel:WORD_1 dst_unused:UNUSED_PRESERVE src0_sel:WORD_1
s_setprio 0
v_rcp_f16_sdwa v148, v147 dst_sel:WORD_1 dst_unused:UNUSED_PRESERVE src0_sel:WORD_1
s_waitcnt lgkmcnt(6)
v_fma_mix_f32 v160, v136, v136, v160 op_sel:[0,0,0] op_sel_hi:[1,1,0]
v_mfma_f32_32x32x16_bf16 v[120:135], v[92:95], v[232:235], v[120:135]
ds_read_b128 v[228:231], v248 offset:54272
v_rcp_f16_sdwa v145, v144 dst_sel:WORD_1 dst_unused:UNUSED_PRESERVE src0_sel:WORD_1
v_fma_mix_f32 v160, v137, v137, v160 op_sel:[1,1,0] op_sel_hi:[1,1,0]
v_pk_mul_f16 v155, v155, v154
v_fma_mix_f32 v160, v138, v138, v160 op_sel:[0,0,0] op_sel_hi:[1,1,0]
v_pk_mul_f16 v152, v152, v151
v_pk_mul_f16 v149, v149, v148
v_fma_mix_f32 v160, v139, v139, v160 op_sel:[1,1,0] op_sel_hi:[1,1,0]
v_pk_mul_f16 v146, v146, v145
v_fma_mix_f32 v160, v155, v155, v160 op_sel:[0,0,0] op_sel_hi:[1,1,0]
v_smfmac_f32_16x16x32_bf16 v[36:39], v[236:237], v[200:203], v246
ds_read_b128 v[232:235], v248 offset:57344
s_waitcnt lgkmcnt(4)
v_fma_mix_f32 v160, v140, v140, v160 op_sel:[0,0,0] op_sel_hi:[1,1,0]
v_fma_mix_f32 v160, v155, v155, v160 op_sel:[1,1,0] op_sel_hi:[1,1,0]
v_fma_mix_f32 v160, v152, v152, v160 op_sel:[0,0,0] op_sel_hi:[1,1,0]
v_fma_mix_f32 v160, v141, v141, v160 op_sel:[1,1,0] op_sel_hi:[1,1,0]
v_fma_mix_f32 v160, v152, v152, v160 op_sel:[1,1,0] op_sel_hi:[1,1,0]
v_smfmac_f32_16x16x32_bf16 v[4:7], v[238:239], v[204:207], v246
v_fma_mix_f32 v160, v149, v149, v160 op_sel:[0,0,0] op_sel_hi:[1,1,0]
v_fma_mix_f32 v160, v142, v142, v160 op_sel:[0,0,0] op_sel_hi:[1,1,0]
v_fma_mix_f32 v160, v149, v149, v160 op_sel:[1,1,0] op_sel_hi:[1,1,0]
v_fma_mix_f32 v160, v146, v146, v160 op_sel:[0,0,0] op_sel_hi:[1,1,0]
s_waitcnt lgkmcnt(2)
v_fma_mix_f32 v160, v143, v143, v160 op_sel:[1,1,0] op_sel_hi:[1,1,0]
v_fma_mix_f32 v160, v146, v146, v160 op_sel:[1,1,0] op_sel_hi:[1,1,0]
s_cmp_lg_u32 s40, 7
s_cbranch_scc1 Lnobias2
s_sub_u32 s43, s2, 96
s_cmp_lt_u32 s43, 96
s_cbranch_scc0 Lnobias2
s_waitcnt vmcnt(17)
v_lshlrev_b32 v178, 16, v178
v_lshlrev_b32 v179, 16, v179
v_lshlrev_b32 v180, 16, v180
v_lshlrev_b32 v181, 16, v181
v_lshlrev_b32 v182, 16, v182
v_lshlrev_b32 v183, 16, v183
v_lshlrev_b32 v184, 16, v184
v_lshlrev_b32 v185, 16, v185
v_lshlrev_b32 v186, 16, v186
v_lshlrev_b32 v187, 16, v187
v_lshlrev_b32 v188, 16, v188
v_lshlrev_b32 v189, 16, v189
v_mul_f32 v176, v178, v184
v_fmac_f32 v176, v179, v185
v_fmac_f32 v176, v180, v186
v_fmac_f32 v176, v181, v187
v_fmac_f32 v176, v182, v188
v_fmac_f32 v176, v183, v189
s_nop 1
v_add_f32_dpp v176, v176, v176 row_ror:8 row_mask:0xf bank_mask:0xf
s_nop 1
v_add_f32_dpp v176, v176, v176 row_ror:4 row_mask:0xf bank_mask:0xf
s_nop 1
v_add_f32_dpp v176, v176, v176 row_ror:2 row_mask:0xf bank_mask:0xf
s_nop 1
v_add_f32_dpp v176, v176, v176 row_ror:1 row_mask:0xf bank_mask:0xf
v_mov_b32 v177, v176
s_nop 1
v_permlane16_swap_b32 v176, v177
v_add_f32 v176, v176, v177
v_mov_b32_e64 v177, v176
s_nop 1
v_permlane32_swap_b32 v176, v177
v_add_f32 v176, v176, v177
s_lshl_b32 s44, s43, 2
s_add_u32 s44, s44, 394752
v_lshlrev_b32_e64 v191, 11, v251
s_mov_b64 exec, 0xff
buffer_store_dword v176, v191, s[32:35], s44 offen sc1
s_mov_b64 exec, -1
Lnobias2:
s_setprio 2
v_smfmac_f32_16x16x32_bf16 v[20:23], v[216:217], v[208:211], v246
ds_read_b128 v[236:239], v248 offset:55296
v_cvt_pkrtz_f16_f32 v137, v120, v121
v_cvt_pkrtz_f16_f32 v139, v122, v123
v_cvt_pkrtz_f16_f32 v141, v124, v125
v_cvt_pkrtz_f16_f32 v143, v126, v127
v_smfmac_f32_16x16x32_bf16 v[36:39], v[218:219], v[212:215], v246
v_cvt_pkrtz_f16_f32 v145, v128, v129
v_cvt_pk_f16_f32 v155, v130, v131
v_cvt_pk_f16_f32 v152, v132, v133
v_cvt_pk_f16_f32 v149, v134, v135
v_mfma_f32_32x32x16_bf16 v[120:135], v[72:75], v[220:223], 0
ds_read_b128 v[216:219], v245 offset:3456
v_xor_b32 v242, 32, v242
ds_read_b128 v[192:195], v242
ds_read_b128 v[196:199], v242 offset:64
v_pk_fma_f16 v154, v155, v155, s48
v_and_b32 v137, s49, v137
v_pk_fma_f16 v151, v152, v152, s48
v_and_b32_e64 v139, s49, v139
v_pk_fma_f16 v148, v149, v149, s48
v_pk_mul_f16 v154, v155, v154
v_bfe_u32 v136, v137, 2, 14
v_pk_mul_f16 v151, v152, v151
v_mfma_f32_32x32x16_bf16 v[120:135], v[76:79], v[224:227], v[120:135]
ds_read_b128 v[220:223], v248 offset:58368
ds_read_u16_d16 v136, v136
v_pk_mul_f16 v148, v149, v148
v_bfe_u32 v138, v139, 2, 14
v_exp_f16 v153, v154
v_lshrrev_b32 v137, 18, v137
v_exp_f16 v150, v151
v_lshrrev_b32 v139, 18, v139
s_waitcnt lgkmcnt(5)
v_mfma_f32_32x32x16_bf16 v[120:135], v[80:83], v[228:231], v[120:135]
ds_read_b128 v[224:227], v245 offset:3840
ds_read_b128 v[200:203], v242 offset:128
v_xor_b32 v243, 32, v243
ds_read_b128 v[204:207], v243
ds_read_u16_d16 v138, v138
ds_read_u16_d16_hi v137, v137
ds_read_u16_d16_hi v139, v139
v_exp_f16 v147, v148
v_and_b32 v141, s49, v141
v_and_b32_e64 v143, s49, v143
v_exp_f16_sdwa v153, v154 dst_sel:WORD_1 dst_unused:UNUSED_PRESERVE src0_sel:WORD_1
v_bfe_u32 v140, v141, 2, 14
v_exp_f16_sdwa v150, v151 dst_sel:WORD_1 dst_unused:UNUSED_PRESERVE src0_sel:WORD_1
v_mfma_f32_32x32x16_bf16 v[120:135], v[84:87], v[232:235], v[120:135]
ds_read_b128 v[228:231], v245 offset:4224
ds_read_b128 v[208:211], v243 offset:64
ds_read_b128 v[212:215], v243 offset:128
ds_read_u16_d16 v140, v140
v_bfe_u32 v142, v143, 2, 14
v_exp_f16_sdwa v147, v148 dst_sel:WORD_1 dst_unused:UNUSED_PRESERVE src0_sel:WORD_1
v_lshrrev_b32_e64 v141, 18, v141
v_pk_add_f16 v153, v153, 1.0 op_sel_hi:[1,0]
v_lshrrev_b32_e64 v143, 18, v143
v_pk_add_f16 v150, v150, 1.0 op_sel_hi:[1,0]
v_pk_add_f16 v147, v147, 1.0 op_sel_hi:[1,0]
v_mfma_f32_32x32x16_bf16 v[120:135], v[88:91], v[236:239], v[120:135]
ds_read_b128 v[232:235], v248 offset:59392
ds_read_u16_d16 v142, v142
ds_read_u16_d16_hi v141, v141
ds_read_u16_d16_hi v143, v143
v_and_b32 v145, s49, v145
v_rcp_f16 v154, v153
v_bfe_u32 v144, v145, 2, 14
v_rcp_f16 v151, v150
v_lshrrev_b32 v145, 18, v145
v_rcp_f16 v148, v147
s_waitcnt lgkmcnt(8)
v_smfmac_f32_16x16x32_bf16 v[12:15], v[216:217], v[192:195], v246
ds_read_b128 v[236:239], v248 offset:62464
ds_read_u16_d16 v144, v144
ds_read_u16_d16_hi v145, v145
v_rcp_f16_sdwa v154, v153 dst_sel:WORD_1 dst_unused:UNUSED_PRESERVE src0_sel:WORD_1
v_fma_mix_f32 v161, v136, v136, v161 op_sel:[0,0,0] op_sel_hi:[1,1,0]
v_fma_mix_f32 v161, v137, v137, v161 op_sel:[1,1,0] op_sel_hi:[1,1,0]
v_smfmac_f32_16x16x32_bf16 v[28:31], v[218:219], v[196:199], v246
v_rcp_f16_sdwa v151, v150 dst_sel:WORD_1 dst_unused:UNUSED_PRESERVE src0_sel:WORD_1
v_fma_mix_f32 v161, v138, v138, v161 op_sel:[0,0,0] op_sel_hi:[1,1,0]
v_mfma_f32_32x32x16_bf16 v[120:135], v[92:95], v[220:223], v[120:135]
ds_read_b128 v[216:219], v248 offset:60416
v_rcp_f16_sdwa v148, v147 dst_sel:WORD_1 dst_unused:UNUSED_PRESERVE src0_sel:WORD_1
v_fma_mix_f32 v161, v139, v139, v161 op_sel:[1,1,0] op_sel_hi:[1,1,0]
v_pk_mul_f16 v155, v155, v154
s_waitcnt lgkmcnt(6)
v_fma_mix_f32 v161, v140, v140, v161 op_sel:[0,0,0] op_sel_hi:[1,1,0]
v_pk_mul_f16 v152, v152, v151
s_waitcnt lgkmcnt(4)
v_fma_mix_f32 v161, v141, v141, v161 op_sel:[1,1,0] op_sel_hi:[1,1,0]
v_pk_mul_f16 v149, v149, v148
v_fma_mix_f32 v161, v155, v155, v161 op_sel:[0,0,0] op_sel_hi:[1,1,0]
v_smfmac_f32_16x16x32_bf16 v[44:47], v[224:225], v[200:203], v246
ds_read_b128 v[220:223], v248 offset:63488
v_fma_mix_f32 v161, v142, v142, v161 op_sel:[0,0,0] op_sel_hi:[1,1,0]
v_fma_mix_f32 v161, v155, v155, v161 op_sel:[1,1,0] op_sel_hi:[1,1,0]
v_fma_mix_f32 v161, v143, v143, v161 op_sel:[1,1,0] op_sel_hi:[1,1,0]
v_fma_mix_f32 v161, v152, v152, v161 op_sel:[0,0,0] op_sel_hi:[1,1,0]
v_smfmac_f32_16x16x32_bf16 v[12:15], v[226:227], v[204:207], v246
v_fma_mix_f32 v161, v152, v152, v161 op_sel:[1,1,0] op_sel_hi:[1,1,0]
s_waitcnt lgkmcnt(2)
v_fma_mix_f32 v161, v144, v144, v161 op_sel:[0,0,0] op_sel_hi:[1,1,0]
v_fma_mix_f32 v161, v149, v149, v161 op_sel:[0,0,0] op_sel_hi:[1,1,0]
v_fma_mix_f32 v161, v145, v145, v161 op_sel:[1,1,0] op_sel_hi:[1,1,0]
v_fma_mix_f32 v161, v149, v149, v161 op_sel:[1,1,0] op_sel_hi:[1,1,0]
v_lshlrev_b32 v252, 7, v251
s_add_u32 s46, s47, 2359296
s_mov_b32 exec_lo, 131071
s_mov_b32 exec_hi, 0
s_mov_b32 m0, 16288
s_nop 0
buffer_load_dword v252, s[4:7], s46 offen lds
s_mov_b64 exec, -1
s_setprio 1
v_smfmac_f32_16x16x32_bf16 v[28:31], v[228:229], v[208:211], v246
ds_read_b128 v[224:227], v248 offset:61440
v_cvt_pkrtz_f16_f32 v137, v120, v121
v_cvt_pkrtz_f16_f32 v139, v122, v123
v_cvt_pkrtz_f16_f32 v141, v124, v125
v_cvt_pkrtz_f16_f32 v143, v126, v127
v_cvt_pk_f16_f32 v155, v128, v129
v_smfmac_f32_16x16x32_bf16 v[44:47], v[230:231], v[212:215], v246
v_cvt_pk_f16_f32 v152, v130, v131
v_cvt_pk_f16_f32 v149, v132, v133
v_cvt_pk_f16_f32 v146, v134, v135
v_pk_fma_f16 v154, v155, v155, s48
v_and_b32_e64 v137, s49, v137
v_mfma_f32_32x32x16_bf16 v[120:135], v[72:75], v[232:235], 0
ds_read_b128 v[228:231], v248 offset:64512
v_pk_fma_f16 v151, v152, v152, s48
v_pk_fma_f16 v148, v149, v149, s48
v_and_b32_e64 v139, s49, v139
v_pk_fma_f16 v145, v146, v146, s48
v_pk_mul_f16 v154, v155, v154
v_bfe_u32 v136, v137, 2, 14
v_pk_mul_f16 v151, v152, v151
v_pk_mul_f16 v148, v149, v148
v_bfe_u32 v138, v139, 2, 14
v_pk_mul_f16 v145, v146, v145
v_mfma_f32_32x32x16_bf16 v[120:135], v[76:79], v[236:239], v[120:135]
ds_read_b128 v[232:235], v245 offset:4608
v_xor_b32 v244, 32, v244
ds_read_b128 v[192:195], v244
ds_read_b128 v[196:199], v244 offset:64
ds_read_u16_d16 v136, v136
ds_read_u16_d16 v138, v138
v_exp_f16 v153, v154
v_lshrrev_b32 v137, 18, v137
v_exp_f16 v150, v151
v_lshrrev_b32 v139, 18, v139
v_exp_f16 v147, v148
v_and_b32 v141, s49, v141
v_exp_f16 v144, v145
s_waitcnt lgkmcnt(5)
v_mfma_f32_32x32x16_bf16 v[120:135], v[80:83], v[216:219], v[120:135]
ds_read_b128 v[236:239], v245 offset:4992
ds_read_b128 v[200:203], v244 offset:128
v_xor_b32 v242, 16, v242
ds_read_b128 v[204:207], v242
ds_read_u16_d16_hi v137, v137
ds_read_u16_d16_hi v139, v139
v_and_b32_e64 v143, s49, v143
v_exp_f16_sdwa v153, v154 dst_sel:WORD_1 dst_unused:UNUSED_PRESERVE src0_sel:WORD_1
v_bfe_u32 v140, v141, 2, 14
v_exp_f16_sdwa v150, v151 dst_sel:WORD_1 dst_unused:UNUSED_PRESERVE src0_sel:WORD_1
v_bfe_u32 v142, v143, 2, 14
v_exp_f16_sdwa v147, v148 dst_sel:WORD_1 dst_unused:UNUSED_PRESERVE src0_sel:WORD_1
v_lshrrev_b32_e64 v141, 18, v141
v_mfma_f32_32x32x16_bf16 v[120:135], v[84:87], v[220:223], v[120:135]
ds_read_b128 v[216:219], v249
ds_read_u16_d16 v140, v140
ds_read_u16_d16 v142, v142
ds_read_u16_d16_hi v141, v141
v_exp_f16_sdwa v144, v145 dst_sel:WORD_1 dst_unused:UNUSED_PRESERVE src0_sel:WORD_1
v_lshrrev_b32_e64 v143, 18, v143
v_pk_add_f16 v153, v153, 1.0 op_sel_hi:[1,0]
v_pk_add_f16 v150, v150, 1.0 op_sel_hi:[1,0]
v_pk_add_f16 v147, v147, 1.0 op_sel_hi:[1,0]
v_pk_add_f16 v144, v144, 1.0 op_sel_hi:[1,0]
v_rcp_f16 v154, v153
v_rcp_f16 v151, v150
v_mfma_f32_32x32x16_bf16 v[120:135], v[88:91], v[224:227], v[120:135]
ds_read_b128 v[220:223], v249 offset:3072
ds_read_u16_d16_hi v143, v143
v_rcp_f16 v148, v147
v_rcp_f16 v145, v144
v_rcp_f16_sdwa v154, v153 dst_sel:WORD_1 dst_unused:UNUSED_PRESERVE src0_sel:WORD_1
v_rcp_f16_sdwa v151, v150 dst_sel:WORD_1 dst_unused:UNUSED_PRESERVE src0_sel:WORD_1
s_setprio 0
v_rcp_f16_sdwa v148, v147 dst_sel:WORD_1 dst_unused:UNUSED_PRESERVE src0_sel:WORD_1
s_waitcnt lgkmcnt(6)
v_fma_mix_f32 v162, v136, v136, v162 op_sel:[0,0,0] op_sel_hi:[1,1,0]
v_mfma_f32_32x32x16_bf16 v[120:135], v[92:95], v[228:231], v[120:135]
ds_read_b128 v[224:227], v249 offset:1024
v_rcp_f16_sdwa v145, v144 dst_sel:WORD_1 dst_unused:UNUSED_PRESERVE src0_sel:WORD_1
v_fma_mix_f32 v162, v137, v137, v162 op_sel:[1,1,0] op_sel_hi:[1,1,0]
v_pk_mul_f16 v155, v155, v154
v_fma_mix_f32 v162, v138, v138, v162 op_sel:[0,0,0] op_sel_hi:[1,1,0]
v_pk_mul_f16 v152, v152, v151
v_pk_mul_f16 v149, v149, v148
v_fma_mix_f32 v162, v139, v139, v162 op_sel:[1,1,0] op_sel_hi:[1,1,0]
v_pk_mul_f16 v146, v146, v145
v_fma_mix_f32 v162, v155, v155, v162 op_sel:[0,0,0] op_sel_hi:[1,1,0]
v_smfmac_f32_16x16x32_bf16 v[12:15], v[232:233], v[192:195], v246
ds_read_b128 v[228:231], v249 offset:4096
s_waitcnt lgkmcnt(4)
v_fma_mix_f32 v162, v140, v140, v162 op_sel:[0,0,0] op_sel_hi:[1,1,0]
v_fma_mix_f32 v162, v155, v155, v162 op_sel:[1,1,0] op_sel_hi:[1,1,0]
v_fma_mix_f32 v162, v152, v152, v162 op_sel:[0,0,0] op_sel_hi:[1,1,0]
v_fma_mix_f32 v162, v141, v141, v162 op_sel:[1,1,0] op_sel_hi:[1,1,0]
v_fma_mix_f32 v162, v152, v152, v162 op_sel:[1,1,0] op_sel_hi:[1,1,0]
v_smfmac_f32_16x16x32_bf16 v[28:31], v[234:235], v[196:199], v246
v_fma_mix_f32 v162, v149, v149, v162 op_sel:[0,0,0] op_sel_hi:[1,1,0]
v_fma_mix_f32 v162, v142, v142, v162 op_sel:[0,0,0] op_sel_hi:[1,1,0]
v_fma_mix_f32 v162, v149, v149, v162 op_sel:[1,1,0] op_sel_hi:[1,1,0]
v_fma_mix_f32 v162, v146, v146, v162 op_sel:[0,0,0] op_sel_hi:[1,1,0]
s_waitcnt lgkmcnt(2)
v_fma_mix_f32 v162, v143, v143, v162 op_sel:[1,1,0] op_sel_hi:[1,1,0]
v_fma_mix_f32 v162, v146, v146, v162 op_sel:[1,1,0] op_sel_hi:[1,1,0]
v_lshlrev_b32_e64 v252, 7, v251
s_add_u32 s46, s47, 2359296
s_mov_b32 exec_lo, 4294836224
s_mov_b32 exec_hi, 3
s_mov_b32 m0, 16220
s_nop 0
buffer_load_dword v252, s[4:7], s46 offen lds
s_mov_b64 exec, -1
s_setprio 2
v_smfmac_f32_16x16x32_bf16 v[44:47], v[236:237], v[200:203], v246
ds_read_b128 v[232:235], v249 offset:2048
v_cvt_pkrtz_f16_f32 v137, v120, v121
v_cvt_pkrtz_f16_f32 v139, v122, v123
v_cvt_pkrtz_f16_f32 v141, v124, v125
v_cvt_pkrtz_f16_f32 v143, v126, v127
v_smfmac_f32_16x16x32_bf16 v[8:11], v[238:239], v[204:207], v246
v_cvt_pkrtz_f16_f32 v145, v128, v129
v_cvt_pk_f16_f32 v155, v130, v131
v_cvt_pk_f16_f32 v152, v132, v133
v_cvt_pk_f16_f32 v149, v134, v135
v_mfma_f32_32x32x16_bf16 v[120:135], v[72:75], v[216:219], 0
ds_read_b128 v[236:239], v245 offset:5376
ds_read_b128 v[208:211], v242 offset:64
ds_read_b128 v[212:215], v242 offset:128
v_pk_fma_f16 v154, v155, v155, s48
v_and_b32_e64 v137, s49, v137
v_pk_fma_f16 v151, v152, v152, s48
v_and_b32_e64 v139, s49, v139
v_pk_fma_f16 v148, v149, v149, s48
v_pk_mul_f16 v154, v155, v154
v_bfe_u32 v136, v137, 2, 14
v_pk_mul_f16 v151, v152, v151
v_mfma_f32_32x32x16_bf16 v[120:135], v[76:79], v[220:223], v[120:135]
ds_read_b128 v[216:219], v249 offset:5120
ds_read_u16_d16 v136, v136
v_pk_mul_f16 v148, v149, v148
v_bfe_u32 v138, v139, 2, 14
v_exp_f16 v153, v154
v_lshrrev_b32 v137, 18, v137
v_exp_f16 v150, v151
v_lshrrev_b32 v139, 18, v139
s_waitcnt lgkmcnt(5)
v_mfma_f32_32x32x16_bf16 v[120:135], v[80:83], v[224:227], v[120:135]
ds_read_b128 v[220:223], v245 offset:5760
v_xor_b32 v243, 16, v243
ds_read_b128 v[192:195], v243
ds_read_b128 v[196:199], v243 offset:64
ds_read_u16_d16 v138, v138
ds_read_u16_d16_hi v137, v137
ds_read_u16_d16_hi v139, v139
v_exp_f16 v147, v148
v_and_b32 v141, s49, v141
v_and_b32_e64 v143, s49, v143
v_exp_f16_sdwa v153, v154 dst_sel:WORD_1 dst_unused:UNUSED_PRESERVE src0_sel:WORD_1
v_bfe_u32 v140, v141, 2, 14
v_exp_f16_sdwa v150, v151 dst_sel:WORD_1 dst_unused:UNUSED_PRESERVE src0_sel:WORD_1
v_mfma_f32_32x32x16_bf16 v[120:135], v[84:87], v[228:231], v[120:135]
ds_read_b128 v[224:227], v245 offset:6144
ds_read_b128 v[200:203], v243 offset:128
v_xor_b32 v244, 16, v244
ds_read_b128 v[204:207], v244
ds_read_u16_d16 v140, v140
v_bfe_u32 v142, v143, 2, 14
v_exp_f16_sdwa v147, v148 dst_sel:WORD_1 dst_unused:UNUSED_PRESERVE src0_sel:WORD_1
v_lshrrev_b32 v141, 18, v141
v_pk_add_f16 v153, v153, 1.0 op_sel_hi:[1,0]
v_lshrrev_b32_e64 v143, 18, v143
v_pk_add_f16 v150, v150, 1.0 op_sel_hi:[1,0]
v_pk_add_f16 v147, v147, 1.0 op_sel_hi:[1,0]
v_mfma_f32_32x32x16_bf16 v[120:135], v[88:91], v[232:235], v[120:135]
ds_read_b128 v[228:231], v249 offset:6144
ds_read_u16_d16 v142, v142
ds_read_u16_d16_hi v141, v141
ds_read_u16_d16_hi v143, v143
v_and_b32 v145, s49, v145
v_rcp_f16 v154, v153
v_bfe_u32 v144, v145, 2, 14
v_rcp_f16 v151, v150
v_lshrrev_b32 v145, 18, v145
v_rcp_f16 v148, v147
s_waitcnt lgkmcnt(8)
v_smfmac_f32_16x16x32_bf16 v[24:27], v[236:237], v[208:211], v246
ds_read_b128 v[232:235], v249 offset:9216
ds_read_u16_d16 v144, v144
ds_read_u16_d16_hi v145, v145
v_rcp_f16_sdwa v154, v153 dst_sel:WORD_1 dst_unused:UNUSED_PRESERVE src0_sel:WORD_1
v_fma_mix_f32 v163, v136, v136, v163 op_sel:[0,0,0] op_sel_hi:[1,1,0]
v_fma_mix_f32 v163, v137, v137, v163 op_sel:[1,1,0] op_sel_hi:[1,1,0]
v_smfmac_f32_16x16x32_bf16 v[40:43], v[238:239], v[212:215], v246
v_rcp_f16_sdwa v151, v150 dst_sel:WORD_1 dst_unused:UNUSED_PRESERVE src0_sel:WORD_1
v_fma_mix_f32 v163, v138, v138, v163 op_sel:[0,0,0] op_sel_hi:[1,1,0]
v_mfma_f32_32x32x16_bf16 v[120:135], v[92:95], v[216:219], v[120:135]
ds_read_b128 v[236:239], v249 offset:7168
v_rcp_f16_sdwa v148, v147 dst_sel:WORD_1 dst_unused:UNUSED_PRESERVE src0_sel:WORD_1
v_fma_mix_f32 v163, v139, v139, v163 op_sel:[1,1,0] op_sel_hi:[1,1,0]
v_pk_mul_f16 v155, v155, v154
s_waitcnt lgkmcnt(6)
v_fma_mix_f32 v163, v140, v140, v163 op_sel:[0,0,0] op_sel_hi:[1,1,0]
v_pk_mul_f16 v152, v152, v151
s_waitcnt lgkmcnt(4)
v_fma_mix_f32 v163, v141, v141, v163 op_sel:[1,1,0] op_sel_hi:[1,1,0]
v_pk_mul_f16 v149, v149, v148
v_fma_mix_f32 v163, v155, v155, v163 op_sel:[0,0,0] op_sel_hi:[1,1,0]
v_smfmac_f32_16x16x32_bf16 v[8:11], v[220:221], v[192:195], v246
ds_read_b128 v[216:219], v249 offset:10240
v_fma_mix_f32 v163, v142, v142, v163 op_sel:[0,0,0] op_sel_hi:[1,1,0]
v_fma_mix_f32 v163, v155, v155, v163 op_sel:[1,1,0] op_sel_hi:[1,1,0]
v_fma_mix_f32 v163, v143, v143, v163 op_sel:[1,1,0] op_sel_hi:[1,1,0]
v_fma_mix_f32 v163, v152, v152, v163 op_sel:[0,0,0] op_sel_hi:[1,1,0]
v_smfmac_f32_16x16x32_bf16 v[24:27], v[222:223], v[196:199], v246
v_fma_mix_f32 v163, v152, v152, v163 op_sel:[1,1,0] op_sel_hi:[1,1,0]
s_waitcnt lgkmcnt(2)
v_fma_mix_f32 v163, v144, v144, v163 op_sel:[0,0,0] op_sel_hi:[1,1,0]
v_fma_mix_f32 v163, v149, v149, v163 op_sel:[0,0,0] op_sel_hi:[1,1,0]
v_fma_mix_f32 v163, v145, v145, v163 op_sel:[1,1,0] op_sel_hi:[1,1,0]
v_fma_mix_f32 v163, v149, v149, v163 op_sel:[1,1,0] op_sel_hi:[1,1,0]
v_lshlrev_b32 v252, 7, v251
s_add_u32 s46, s47, 2359296
s_mov_b32 exec_lo, 0
s_mov_b32 exec_hi, 1048572
s_mov_b32 m0, 16152
s_nop 0
buffer_load_dword v252, s[4:7], s46 offen lds
s_mov_b64 exec, -1
s_setprio 1
v_smfmac_f32_16x16x32_bf16 v[40:43], v[224:225], v[200:203], v246
ds_read_b128 v[220:223], v249 offset:8192
v_cvt_pkrtz_f16_f32 v137, v120, v121
v_cvt_pkrtz_f16_f32 v139, v122, v123
v_cvt_pkrtz_f16_f32 v141, v124, v125
v_cvt_pkrtz_f16_f32 v143, v126, v127
v_smfmac_f32_16x16x32_bf16 v[8:11], v[226:227], v[204:207], v246
v_cvt_pk_f16_f32 v155, v128, v129
v_cvt_pk_f16_f32 v152, v130, v131
v_cvt_pk_f16_f32 v149, v132, v133
v_cvt_pk_f16_f32 v146, v134, v135
v_pk_fma_f16 v154, v155, v155, s48
v_mfma_f32_32x32x16_bf16 v[120:135], v[72:75], v[228:231], 0
ds_read_b128 v[224:227], v249 offset:11264
v_and_b32_e64 v137, s49, v137
v_pk_fma_f16 v151, v152, v152, s48
v_pk_fma_f16 v148, v149, v149, s48
v_and_b32_e64 v139, s49, v139
v_pk_fma_f16 v145, v146, v146, s48
v_pk_mul_f16 v154, v155, v154
v_bfe_u32 v136, v137, 2, 14
v_pk_mul_f16 v151, v152, v151
v_pk_mul_f16 v148, v149, v148
v_bfe_u32 v138, v139, 2, 14
v_mfma_f32_32x32x16_bf16 v[120:135], v[76:79], v[232:235], v[120:135]
ds_read_b128 v[228:231], v245 offset:6528
ds_read_b128 v[208:211], v244 offset:64
ds_read_b128 v[212:215], v244 offset:128
ds_read_u16_d16 v136, v136
ds_read_u16_d16 v138, v138
v_pk_mul_f16 v145, v146, v145
v_exp_f16 v153, v154
v_lshrrev_b32 v137, 18, v137
v_exp_f16 v150, v151
v_lshrrev_b32 v139, 18, v139
v_exp_f16 v147, v148
s_waitcnt lgkmcnt(6)
v_mfma_f32_32x32x16_bf16 v[120:135], v[80:83], v[236:239], v[120:135]
ds_read_b128 v[232:235], v249 offset:12288
ds_read_u16_d16_hi v137, v137
ds_read_u16_d16_hi v139, v139
v_and_b32 v141, s49, v141
v_exp_f16 v144, v145
v_and_b32_e64 v143, s49, v143
v_exp_f16_sdwa v153, v154 dst_sel:WORD_1 dst_unused:UNUSED_PRESERVE src0_sel:WORD_1
v_bfe_u32 v140, v141, 2, 14
v_exp_f16_sdwa v150, v151 dst_sel:WORD_1 dst_unused:UNUSED_PRESERVE src0_sel:WORD_1
v_bfe_u32 v142, v143, 2, 14
v_mfma_f32_32x32x16_bf16 v[120:135], v[84:87], v[216:219], v[120:135]
ds_read_b128 v[236:239], v249 offset:15360
ds_read_u16_d16 v140, v140
ds_read_u16_d16 v142, v142
v_exp_f16_sdwa v147, v148 dst_sel:WORD_1 dst_unused:UNUSED_PRESERVE src0_sel:WORD_1
v_lshrrev_b32_e64 v141, 18, v141
v_exp_f16_sdwa v144, v145 dst_sel:WORD_1 dst_unused:UNUSED_PRESERVE src0_sel:WORD_1
v_lshrrev_b32_e64 v143, 18, v143
v_pk_add_f16 v153, v153, 1.0 op_sel_hi:[1,0]
v_pk_add_f16 v150, v150, 1.0 op_sel_hi:[1,0]
v_pk_add_f16 v147, v147, 1.0 op_sel_hi:[1,0]
v_mfma_f32_32x32x16_bf16 v[120:135], v[88:91], v[220:223], v[120:135]
ds_read_b128 v[216:219], v249 offset:13312
ds_read_u16_d16_hi v141, v141
ds_read_u16_d16_hi v143, v143
v_pk_add_f16 v144, v144, 1.0 op_sel_hi:[1,0]
v_rcp_f16 v154, v153
v_rcp_f16 v151, v150
v_rcp_f16 v148, v147
v_rcp_f16 v145, v144
s_waitcnt lgkmcnt(6)
v_mfma_f32_32x32x16_bf16 v[120:135], v[92:95], v[224:227], v[120:135]
ds_read_b128 v[220:223], v249 offset:16384
v_rcp_f16_sdwa v154, v153 dst_sel:WORD_1 dst_unused:UNUSED_PRESERVE src0_sel:WORD_1
v_rcp_f16_sdwa v151, v150 dst_sel:WORD_1 dst_unused:UNUSED_PRESERVE src0_sel:WORD_1
s_setprio 0
v_rcp_f16_sdwa v148, v147 dst_sel:WORD_1 dst_unused:UNUSED_PRESERVE src0_sel:WORD_1
v_fma_mix_f32 v164, v136, v136, v164 op_sel:[0,0,0] op_sel_hi:[1,1,0]
v_rcp_f16_sdwa v145, v144 dst_sel:WORD_1 dst_unused:UNUSED_PRESERVE src0_sel:WORD_1
v_fma_mix_f32 v164, v137, v137, v164 op_sel:[1,1,0] op_sel_hi:[1,1,0]
v_smfmac_f32_16x16x32_bf16 v[24:27], v[228:229], v[208:211], v246
ds_read_b128 v[224:227], v249 offset:14336
v_pk_mul_f16 v155, v155, v154
v_fma_mix_f32 v164, v138, v138, v164 op_sel:[0,0,0] op_sel_hi:[1,1,0]
v_pk_mul_f16 v152, v152, v151
v_pk_mul_f16 v149, v149, v148
v_fma_mix_f32 v164, v139, v139, v164 op_sel:[1,1,0] op_sel_hi:[1,1,0]
v_smfmac_f32_16x16x32_bf16 v[40:43], v[230:231], v[212:215], v246
s_mov_b64 exec, 1
ds_add_u32 v253, v254 offset:16
s_mov_b64 exec, -1
v_pk_mul_f16 v146, v146, v145
v_fma_mix_f32 v164, v155, v155, v164 op_sel:[0,0,0] op_sel_hi:[1,1,0]
s_waitcnt lgkmcnt(3)
v_fma_mix_f32 v164, v140, v140, v164 op_sel:[0,0,0] op_sel_hi:[1,1,0]
v_fma_mix_f32 v164, v155, v155, v164 op_sel:[1,1,0] op_sel_hi:[1,1,0]
v_fma_mix_f32 v164, v152, v152, v164 op_sel:[0,0,0] op_sel_hi:[1,1,0]
v_fma_mix_f32 v164, v141, v141, v164 op_sel:[1,1,0] op_sel_hi:[1,1,0]
v_fma_mix_f32 v164, v152, v152, v164 op_sel:[1,1,0] op_sel_hi:[1,1,0]
v_fma_mix_f32 v164, v149, v149, v164 op_sel:[0,0,0] op_sel_hi:[1,1,0]
v_fma_mix_f32 v164, v142, v142, v164 op_sel:[0,0,0] op_sel_hi:[1,1,0]
v_fma_mix_f32 v164, v149, v149, v164 op_sel:[1,1,0] op_sel_hi:[1,1,0]
v_fma_mix_f32 v164, v146, v146, v164 op_sel:[0,0,0] op_sel_hi:[1,1,0]
v_fma_mix_f32 v164, v143, v143, v164 op_sel:[1,1,0] op_sel_hi:[1,1,0]
v_fma_mix_f32 v164, v146, v146, v164 op_sel:[1,1,0] op_sel_hi:[1,1,0]
s_setprio 3
v_pk_add_f32 v[168:169], v[0:1], v[2:3]
v_pk_mul_f32 v[170:171], v[0:1], v[0:1]
v_pk_fma_f32 v[170:171], v[2:3], v[2:3], v[170:171]
v_pk_add_f32 v[168:169], v[168:169], v[4:5]
v_pk_fma_f32 v[170:171], v[4:5], v[4:5], v[170:171]
v_pk_add_f32 v[168:169], v[168:169], v[6:7]
v_pk_fma_f32 v[170:171], v[6:7], v[6:7], v[170:171]
v_pk_add_f32 v[168:169], v[168:169], v[8:9]
v_pk_fma_f32 v[170:171], v[8:9], v[8:9], v[170:171]
v_pk_add_f32 v[168:169], v[168:169], v[10:11]
v_pk_fma_f32 v[170:171], v[10:11], v[10:11], v[170:171]
v_pk_add_f32 v[168:169], v[168:169], v[12:13]
v_pk_fma_f32 v[170:171], v[12:13], v[12:13], v[170:171]
v_pk_add_f32 v[168:169], v[168:169], v[14:15]
v_pk_fma_f32 v[170:171], v[14:15], v[14:15], v[170:171]
v_pk_add_f32 v[168:169], v[168:169], v[16:17]
v_pk_fma_f32 v[170:171], v[16:17], v[16:17], v[170:171]
v_pk_add_f32 v[168:169], v[168:169], v[18:19]
v_pk_fma_f32 v[170:171], v[18:19], v[18:19], v[170:171]
v_pk_add_f32 v[168:169], v[168:169], v[20:21]
v_pk_fma_f32 v[170:171], v[20:21], v[20:21], v[170:171]
v_pk_add_f32 v[168:169], v[168:169], v[22:23]
v_pk_fma_f32 v[170:171], v[22:23], v[22:23], v[170:171]
v_pk_add_f32 v[168:169], v[168:169], v[24:25]
v_pk_fma_f32 v[170:171], v[24:25], v[24:25], v[170:171]
v_pk_add_f32 v[168:169], v[168:169], v[26:27]
v_pk_fma_f32 v[170:171], v[26:27], v[26:27], v[170:171]
v_pk_add_f32 v[168:169], v[168:169], v[28:29]
v_pk_fma_f32 v[170:171], v[28:29], v[28:29], v[170:171]
v_pk_add_f32 v[168:169], v[168:169], v[30:31]
v_pk_fma_f32 v[170:171], v[30:31], v[30:31], v[170:171]
v_pk_add_f32 v[168:169], v[168:169], v[32:33]
v_pk_fma_f32 v[170:171], v[32:33], v[32:33], v[170:171]
v_pk_add_f32 v[168:169], v[168:169], v[34:35]
v_pk_fma_f32 v[170:171], v[34:35], v[34:35], v[170:171]
v_pk_add_f32 v[168:169], v[168:169], v[36:37]
v_pk_fma_f32 v[170:171], v[36:37], v[36:37], v[170:171]
v_pk_add_f32 v[168:169], v[168:169], v[38:39]
v_pk_fma_f32 v[170:171], v[38:39], v[38:39], v[170:171]
v_pk_add_f32 v[168:169], v[168:169], v[40:41]
v_pk_fma_f32 v[170:171], v[40:41], v[40:41], v[170:171]
v_pk_add_f32 v[168:169], v[168:169], v[42:43]
v_pk_fma_f32 v[170:171], v[42:43], v[42:43], v[170:171]
v_pk_add_f32 v[168:169], v[168:169], v[44:45]
v_pk_fma_f32 v[170:171], v[44:45], v[44:45], v[170:171]
v_pk_add_f32 v[168:169], v[168:169], v[46:47]
v_pk_fma_f32 v[170:171], v[46:47], v[46:47], v[170:171]
s_setprio 0
v_add_u32 v174, -36864, v242
v_subrev_u32 v175, 66560, v174
v_min_u32 v174, v174, v175
v_add_u32 v174, 90112, v174
v_sub_u32 v175, v174, v242
v_add_u32 v242, v175, v242
v_add_u32_e64 v243, v175, v243
v_add_u32 v244, v175, v244
s_setprio 2
v_cvt_pkrtz_f16_f32 v137, v120, v121
v_cvt_pkrtz_f16_f32 v139, v122, v123
v_cvt_pkrtz_f16_f32 v141, v124, v125
v_cvt_pkrtz_f16_f32 v143, v126, v127
v_cvt_pkrtz_f16_f32 v145, v128, v129
v_cvt_pk_f16_f32 v155, v130, v131
v_cvt_pk_f16_f32 v152, v132, v133
v_cvt_pk_f16_f32 v149, v134, v135
ds_read_b128 v[228:231], v249 offset:17408
v_mfma_f32_32x32x16_bf16 v[120:135], v[72:75], v[232:235], 0
v_pk_fma_f16 v154, v155, v155, s48
v_add_f32 v168, v168, v169
v_and_b32 v137, s49, v137
v_pk_fma_f16 v151, v152, v152, s48
v_and_b32_e64 v139, s49, v139
v_pk_fma_f16 v148, v149, v149, s48
v_add_f32_e64 v170, v170, v171
v_pk_mul_f16 v154, v155, v154
v_bfe_u32 v136, v137, 2, 14
v_pk_mul_f16 v151, v152, v151
v_pk_mul_f16 v148, v149, v148
v_bfe_u32 v138, v139, 2, 14
ds_read_b128 v[232:235], v249 offset:18432
ds_read_u16_d16 v136, v136
ds_read_u16_d16 v138, v138
v_mfma_f32_32x32x16_bf16 v[120:135], v[76:79], v[236:239], v[120:135]
v_permlane32_swap_b32 v168, v170
v_exp_f16 v153, v154
v_lshrrev_b32 v137, 18, v137
v_exp_f16 v150, v151
v_add_f32 v168, v168, v170
v_lshrrev_b32 v139, 18, v139
v_exp_f16 v147, v148
v_and_b32 v141, s49, v141
v_and_b32_e64 v143, s49, v143
v_mul_f32 v168, 1009429163, v168
ds_read_b128 v[236:239], v249 offset:21504
ds_read_u16_d16_hi v137, v137
ds_read_u16_d16_hi v139, v139
v_mfma_f32_32x32x16_bf16 v[120:135], v[80:83], v[216:219], v[120:135]
v_exp_f16_sdwa v153, v154 dst_sel:WORD_1 dst_unused:UNUSED_PRESERVE src0_sel:WORD_1
v_bfe_u32 v140, v141, 2, 14
v_exp_f16_sdwa v150, v151 dst_sel:WORD_1 dst_unused:UNUSED_PRESERVE src0_sel:WORD_1
v_mov_b32_e64 v170, v168
v_bfe_u32 v142, v143, 2, 14
v_exp_f16_sdwa v147, v148 dst_sel:WORD_1 dst_unused:UNUSED_PRESERVE src0_sel:WORD_1
v_lshrrev_b32_e64 v141, 18, v141
v_permlane32_swap_b32 v168, v170
v_pk_add_f16 v153, v153, 1.0 op_sel_hi:[1,0]
s_waitcnt lgkmcnt(8)
ds_read_b128 v[216:219], v249 offset:19456
ds_read_u16_d16 v140, v140
ds_read_u16_d16 v142, v142
ds_read_u16_d16_hi v141, v141
v_mfma_f32_32x32x16_bf16 v[120:135], v[84:87], v[220:223], v[120:135]
v_lshrrev_b32_e64 v143, 18, v143
v_pk_add_f16 v150, v150, 1.0 op_sel_hi:[1,0]
v_pk_add_f16 v147, v147, 1.0 op_sel_hi:[1,0]
v_and_b32_e64 v145, s49, v145
v_fma_f32 v170, -v168, v168, v170
v_rcp_f16_e64 v154, v153
v_bfe_u32 v144, v145, 2, 14
v_rcp_f16 v151, v150
v_max_f32 v170, 0, v170
v_lshrrev_b32_e64 v145, 18, v145
ds_read_b128 v[220:223], v249 offset:22528
ds_read_u16_d16_hi v143, v143
ds_read_u16_d16 v144, v144
ds_read_u16_d16_hi v145, v145
v_mfma_f32_32x32x16_bf16 v[120:135], v[88:91], v[224:227], v[120:135]
v_rcp_f16 v148, v147
v_rcp_f16_sdwa v154, v153 dst_sel:WORD_1 dst_unused:UNUSED_PRESERVE src0_sel:WORD_1
v_add_f32 v170, 925353388, v170
s_waitcnt lgkmcnt(8)
v_fma_mix_f32 v165, v136, v136, v165 op_sel:[0,0,0] op_sel_hi:[1,1,0]
ds_read_b32 v247, v253 offset:16
v_fma_mix_f32 v165, v137, v137, v165 op_sel:[1,1,0] op_sel_hi:[1,1,0]
v_rcp_f16_sdwa v151, v150 dst_sel:WORD_1 dst_unused:UNUSED_PRESERVE src0_sel:WORD_1
v_rsq_f32_e64 v170, v170
v_fma_mix_f32 v165, v138, v138, v165 op_sel:[0,0,0] op_sel_hi:[1,1,0]
ds_read_b128 v[224:227], v249 offset:20480
v_mfma_f32_32x32x16_bf16 v[120:135], v[92:95], v[228:231], v[120:135]
v_rcp_f16_sdwa v148, v147 dst_sel:WORD_1 dst_unused:UNUSED_PRESERVE src0_sel:WORD_1
v_fma_mix_f32 v165, v139, v139, v165 op_sel:[1,1,0] op_sel_hi:[1,1,0]
v_pk_mul_f16 v155, v155, v154
s_waitcnt lgkmcnt(6)
v_fma_mix_f32 v165, v140, v140, v165 op_sel:[0,0,0] op_sel_hi:[1,1,0]
v_pk_mul_f16 v152, v152, v151
v_fma_mix_f32 v165, v141, v141, v165 op_sel:[1,1,0] op_sel_hi:[1,1,0]
v_pk_mul_f16 v149, v149, v148
v_fma_mix_f32 v165, v155, v155, v165 op_sel:[0,0,0] op_sel_hi:[1,1,0]
v_mul_f32 v172, 3203391086, v170
v_fma_mix_f32 v165, v142, v142, v165 op_sel:[0,0,0] op_sel_hi:[1,1,0]
v_fma_mix_f32 v165, v155, v155, v165 op_sel:[1,1,0] op_sel_hi:[1,1,0]
s_waitcnt lgkmcnt(2)
v_fma_mix_f32 v165, v143, v143, v165 op_sel:[1,1,0] op_sel_hi:[1,1,0]
v_fma_mix_f32 v165, v152, v152, v165 op_sel:[0,0,0] op_sel_hi:[1,1,0]
v_fma_mix_f32 v165, v152, v152, v165 op_sel:[1,1,0] op_sel_hi:[1,1,0]
v_mul_f32 v173, v168, v172
v_fma_mix_f32 v165, v144, v144, v165 op_sel:[0,0,0] op_sel_hi:[1,1,0]
v_fma_mix_f32 v165, v149, v149, v165 op_sel:[0,0,0] op_sel_hi:[1,1,0]
v_fma_mix_f32 v165, v145, v145, v165 op_sel:[1,1,0] op_sel_hi:[1,1,0]
v_fma_mix_f32 v165, v149, v149, v165 op_sel:[1,1,0] op_sel_hi:[1,1,0]
s_setprio 3
v_pk_fma_f32 v[0:1], v[0:1], v[172:173], v[172:173] op_sel:[0,0,1] op_sel_hi:[1,0,1] neg_lo:[0,0,1] neg_hi:[0,0,1]
v_pk_fma_f32 v[2:3], v[2:3], v[172:173], v[172:173] op_sel:[0,0,1] op_sel_hi:[1,0,1] neg_lo:[0,0,1] neg_hi:[0,0,1]
v_pk_fma_f32 v[4:5], v[4:5], v[172:173], v[172:173] op_sel:[0,0,1] op_sel_hi:[1,0,1] neg_lo:[0,0,1] neg_hi:[0,0,1]
v_pk_fma_f32 v[6:7], v[6:7], v[172:173], v[172:173] op_sel:[0,0,1] op_sel_hi:[1,0,1] neg_lo:[0,0,1] neg_hi:[0,0,1]
v_pk_fma_f32 v[8:9], v[8:9], v[172:173], v[172:173] op_sel:[0,0,1] op_sel_hi:[1,0,1] neg_lo:[0,0,1] neg_hi:[0,0,1]
v_pk_fma_f32 v[10:11], v[10:11], v[172:173], v[172:173] op_sel:[0,0,1] op_sel_hi:[1,0,1] neg_lo:[0,0,1] neg_hi:[0,0,1]
v_pk_fma_f32 v[12:13], v[12:13], v[172:173], v[172:173] op_sel:[0,0,1] op_sel_hi:[1,0,1] neg_lo:[0,0,1] neg_hi:[0,0,1]
v_pk_fma_f32 v[14:15], v[14:15], v[172:173], v[172:173] op_sel:[0,0,1] op_sel_hi:[1,0,1] neg_lo:[0,0,1] neg_hi:[0,0,1]
v_pk_fma_f32 v[16:17], v[16:17], v[172:173], v[172:173] op_sel:[0,0,1] op_sel_hi:[1,0,1] neg_lo:[0,0,1] neg_hi:[0,0,1]
v_pk_fma_f32 v[18:19], v[18:19], v[172:173], v[172:173] op_sel:[0,0,1] op_sel_hi:[1,0,1] neg_lo:[0,0,1] neg_hi:[0,0,1]
v_pk_fma_f32 v[20:21], v[20:21], v[172:173], v[172:173] op_sel:[0,0,1] op_sel_hi:[1,0,1] neg_lo:[0,0,1] neg_hi:[0,0,1]
v_pk_fma_f32 v[22:23], v[22:23], v[172:173], v[172:173] op_sel:[0,0,1] op_sel_hi:[1,0,1] neg_lo:[0,0,1] neg_hi:[0,0,1]
v_pk_fma_f32 v[24:25], v[24:25], v[172:173], v[172:173] op_sel:[0,0,1] op_sel_hi:[1,0,1] neg_lo:[0,0,1] neg_hi:[0,0,1]
v_pk_fma_f32 v[26:27], v[26:27], v[172:173], v[172:173] op_sel:[0,0,1] op_sel_hi:[1,0,1] neg_lo:[0,0,1] neg_hi:[0,0,1]
v_pk_fma_f32 v[28:29], v[28:29], v[172:173], v[172:173] op_sel:[0,0,1] op_sel_hi:[1,0,1] neg_lo:[0,0,1] neg_hi:[0,0,1]
v_pk_fma_f32 v[30:31], v[30:31], v[172:173], v[172:173] op_sel:[0,0,1] op_sel_hi:[1,0,1] neg_lo:[0,0,1] neg_hi:[0,0,1]
v_pk_fma_f32 v[32:33], v[32:33], v[172:173], v[172:173] op_sel:[0,0,1] op_sel_hi:[1,0,1] neg_lo:[0,0,1] neg_hi:[0,0,1]
v_pk_fma_f32 v[34:35], v[34:35], v[172:173], v[172:173] op_sel:[0,0,1] op_sel_hi:[1,0,1] neg_lo:[0,0,1] neg_hi:[0,0,1]
v_pk_fma_f32 v[36:37], v[36:37], v[172:173], v[172:173] op_sel:[0,0,1] op_sel_hi:[1,0,1] neg_lo:[0,0,1] neg_hi:[0,0,1]
v_pk_fma_f32 v[38:39], v[38:39], v[172:173], v[172:173] op_sel:[0,0,1] op_sel_hi:[1,0,1] neg_lo:[0,0,1] neg_hi:[0,0,1]
v_pk_fma_f32 v[40:41], v[40:41], v[172:173], v[172:173] op_sel:[0,0,1] op_sel_hi:[1,0,1] neg_lo:[0,0,1] neg_hi:[0,0,1]
v_pk_fma_f32 v[42:43], v[42:43], v[172:173], v[172:173] op_sel:[0,0,1] op_sel_hi:[1,0,1] neg_lo:[0,0,1] neg_hi:[0,0,1]
v_pk_fma_f32 v[44:45], v[44:45], v[172:173], v[172:173] op_sel:[0,0,1] op_sel_hi:[1,0,1] neg_lo:[0,0,1] neg_hi:[0,0,1]
v_pk_fma_f32 v[46:47], v[46:47], v[172:173], v[172:173] op_sel:[0,0,1] op_sel_hi:[1,0,1] neg_lo:[0,0,1] neg_hi:[0,0,1]
s_setprio 2
s_waitcnt lgkmcnt(0)
v_readfirstlane_b32 s43, v247
s_nop 1
s_cmp_ge_u32 s43, 24
s_cbranch_scc1 Lev6
Lev6w:
s_sleep 1
ds_read_b32 v247, v253 offset:16
s_waitcnt lgkmcnt(0)
v_readfirstlane_b32 s43, v247
s_cmp_eq_u32 s76, 0
s_cbranch_scc1 Lev6
s_sub_u32 s76, s76, 1
s_cmp_lt_u32 s43, 24
s_cbranch_scc1 Lev6w
Lev6:
s_setprio 1
v_cvt_pkrtz_f16_f32 v137, v120, v121
v_cvt_pkrtz_f16_f32 v139, v122, v123
v_cvt_pkrtz_f16_f32 v141, v124, v125
v_cvt_pkrtz_f16_f32 v143, v126, v127
v_cvt_pkrtz_f16_f32 v145, v128, v129
v_cvt_pk_f16_f32 v155, v130, v131
v_cvt_pk_f16_f32 v152, v132, v133
v_cvt_pk_f16_f32 v149, v134, v135
s_add_u32 m0, s67, 39936
s_add_u32 s66, s66, 98304
buffer_load_dwordx4 v240, s[4:7], s66 offen lds
ds_read_b128 v[228:231], v249 offset:23552
v_mfma_f32_32x32x16_bf16 v[120:135], v[72:75], v[232:235], 0
v_pk_fma_f16 v154, v155, v155, s48
v_cvt_pk_bf16_f32 v96, v0, v1
v_and_b32 v137, s49, v137
v_pk_fma_f16 v151, v152, v152, s48
v_cvt_pk_bf16_f32 v97, v2, v3
v_and_b32_e64 v139, s49, v139
v_pk_fma_f16 v148, v149, v149, s48
v_pk_mul_f16 v154, v155, v154
v_cvt_pk_bf16_f32 v98, v4, v5
v_bfe_u32 v136, v137, 2, 14
v_pk_mul_f16 v151, v152, v151
v_pk_mul_f16 v148, v149, v148
v_cvt_pk_bf16_f32 v99, v6, v7
v_bfe_u32 v138, v139, 2, 14
s_add_u32 m0, s67, 46592
s_add_u32 s66, s66, 98304
buffer_load_dwordx4 v240, s[4:7], s66 offen lds
ds_read_b128 v[232:235], v248 offset:16384
ds_read_u16_d16 v136, v136
ds_read_u16_d16 v138, v138
v_mfma_f32_32x32x16_bf16 v[120:135], v[76:79], v[236:239], v[120:135]
v_exp_f16_e64 v153, v154
v_cvt_pk_bf16_f32 v100, v8, v9
v_lshrrev_b32 v137, 18, v137
v_exp_f16 v150, v151
v_cvt_pk_bf16_f32 v101, v10, v11
v_lshrrev_b32 v139, 18, v139
v_exp_f16 v147, v148
v_cvt_pk_bf16_f32 v102, v12, v13
v_and_b32 v141, s49, v141
v_and_b32 v143, s49, v143
v_cvt_pk_bf16_f32 v103, v14, v15
s_add_u32 m0, s67, 53248
s_add_u32 s66, s66, 98304
buffer_load_dwordx4 v240, s[4:7], s66 offen lds
ds_read_b128 v[236:239], v248 offset:19456
ds_read_u16_d16_hi v137, v137
ds_read_u16_d16_hi v139, v139
v_mfma_f32_32x32x16_bf16 v[120:135], v[80:83], v[216:219], v[120:135]
v_exp_f16_sdwa v153, v154 dst_sel:WORD_1 dst_unused:UNUSED_PRESERVE src0_sel:WORD_1
v_bfe_u32 v140, v141, 2, 14
v_cvt_pk_bf16_f32 v104, v16, v17
v_exp_f16_sdwa v150, v151 dst_sel:WORD_1 dst_unused:UNUSED_PRESERVE src0_sel:WORD_1
v_bfe_u32 v142, v143, 2, 14
v_cvt_pk_bf16_f32 v105, v18, v19
v_exp_f16_sdwa v147, v148 dst_sel:WORD_1 dst_unused:UNUSED_PRESERVE src0_sel:WORD_1
v_cvt_pk_bf16_f32 v106, v20, v21
v_lshrrev_b32_e64 v141, 18, v141
v_pk_add_f16 v153, v153, 1.0 op_sel_hi:[1,0]
v_lshrrev_b32 v143, 18, v143
s_add_u32 m0, s67, 59904
s_add_u32 s66, s66, 98304
buffer_load_dwordx4 v240, s[4:7], s66 offen lds
s_add_u32 m0, s67, 0
s_add_u32 s66, s66, 98304
buffer_load_dwordx4 v240, s[4:7], s66 offen lds
ds_read_b128 v[216:219], v248 offset:17408
ds_read_u16_d16 v140, v140
ds_read_u16_d16 v142, v142
ds_read_u16_d16_hi v141, v141
ds_read_u16_d16_hi v143, v143
v_mfma_f32_32x32x16_bf16 v[120:135], v[84:87], v[220:223], v[120:135]
v_cvt_pk_bf16_f32 v107, v22, v23
v_pk_add_f16 v150, v150, 1.0 op_sel_hi:[1,0]
v_pk_add_f16 v147, v147, 1.0 op_sel_hi:[1,0]
v_and_b32_e64 v145, s49, v145
v_cvt_pk_bf16_f32 v108, v24, v25
v_rcp_f16_e64 v154, v153
v_bfe_u32 v144, v145, 2, 14
v_cvt_pk_bf16_f32 v109, v26, v27
v_rcp_f16 v151, v150
v_lshrrev_b32 v145, 18, v145
v_cvt_pk_bf16_f32 v110, v28, v29
s_add_u32 m0, s67, 6656
s_add_u32 s66, s66, 98304
buffer_load_dwordx4 v240, s[4:7], s66 offen lds
ds_read_b128 v[220:223], v248 offset:20480
ds_read_u16_d16 v144, v144
ds_read_u16_d16_hi v145, v145
v_mfma_f32_32x32x16_bf16 v[120:135], v[88:91], v[224:227], v[120:135]
v_rcp_f16_e64 v148, v147
v_cvt_pk_bf16_f32 v111, v30, v31
v_rcp_f16_sdwa v154, v153 dst_sel:WORD_1 dst_unused:UNUSED_PRESERVE src0_sel:WORD_1
s_waitcnt lgkmcnt(5)
v_fma_mix_f32 v166, v136, v136, v166 op_sel:[0,0,0] op_sel_hi:[1,1,0]
v_cvt_pk_bf16_f32 v112, v32, v33
s_setprio 0
v_fma_mix_f32 v166, v137, v137, v166 op_sel:[1,1,0] op_sel_hi:[1,1,0]
v_rcp_f16_sdwa v151, v150 dst_sel:WORD_1 dst_unused:UNUSED_PRESERVE src0_sel:WORD_1
v_cvt_pk_bf16_f32 v113, v34, v35
v_fma_mix_f32 v166, v138, v138, v166 op_sel:[0,0,0] op_sel_hi:[1,1,0]
v_rcp_f16_sdwa v148, v147 dst_sel:WORD_1 dst_unused:UNUSED_PRESERVE src0_sel:WORD_1
v_cvt_pk_bf16_f32 v114, v36, v37
s_add_u32 m0, s67, 13312
s_add_u32 s66, s66, 98304
buffer_load_dwordx4 v240, s[4:7], s66 offen lds
ds_read_b128 v[224:227], v248 offset:18432
v_mfma_f32_32x32x16_bf16 v[120:135], v[92:95], v[228:231], v[120:135]
v_fma_mix_f32 v166, v139, v139, v166 op_sel:[1,1,0] op_sel_hi:[1,1,0]
v_pk_mul_f16 v155, v155, v154
v_fma_mix_f32 v166, v140, v140, v166 op_sel:[0,0,0] op_sel_hi:[1,1,0]
v_cvt_pk_bf16_f32 v115, v38, v39
v_pk_mul_f16 v152, v152, v151
s_waitcnt lgkmcnt(1)
v_fma_mix_f32 v166, v141, v141, v166 op_sel:[1,1,0] op_sel_hi:[1,1,0]
v_cvt_pk_bf16_f32 v116, v40, v41
v_pk_mul_f16 v149, v149, v148
v_fma_mix_f32 v166, v155, v155, v166 op_sel:[0,0,0] op_sel_hi:[1,1,0]
v_fma_mix_f32 v166, v142, v142, v166 op_sel:[0,0,0] op_sel_hi:[1,1,0]
v_cvt_pk_bf16_f32 v117, v42, v43
v_fma_mix_f32 v166, v155, v155, v166 op_sel:[1,1,0] op_sel_hi:[1,1,0]
v_fma_mix_f32 v166, v143, v143, v166 op_sel:[1,1,0] op_sel_hi:[1,1,0]
v_fma_mix_f32 v166, v152, v152, v166 op_sel:[0,0,0] op_sel_hi:[1,1,0]
s_add_u32 m0, s67, 19968
s_add_u32 s66, s66, 98304
buffer_load_dwordx4 v240, s[4:7], s66 offen lds
v_cvt_pk_bf16_f32 v118, v44, v45
v_fma_mix_f32 v166, v152, v152, v166 op_sel:[1,1,0] op_sel_hi:[1,1,0]
v_fma_mix_f32 v166, v144, v144, v166 op_sel:[0,0,0] op_sel_hi:[1,1,0]
v_fma_mix_f32 v166, v149, v149, v166 op_sel:[0,0,0] op_sel_hi:[1,1,0]
v_cvt_pk_bf16_f32 v119, v46, v47
v_fma_mix_f32 v166, v145, v145, v166 op_sel:[1,1,0] op_sel_hi:[1,1,0]
v_fma_mix_f32 v166, v149, v149, v166 op_sel:[1,1,0] op_sel_hi:[1,1,0]
s_setprio 2
v_cvt_pkrtz_f16_f32 v137, v120, v121
v_cvt_pkrtz_f16_f32 v139, v122, v123
v_cvt_pkrtz_f16_f32 v141, v124, v125
v_cvt_pkrtz_f16_f32 v143, v126, v127
v_cvt_pkrtz_f16_f32 v145, v128, v129
v_cvt_pk_f16_f32 v155, v130, v131
v_cvt_pk_f16_f32 v152, v132, v133
v_cvt_pk_f16_f32 v149, v134, v135
s_add_u32 s46, s80, 12582912
buffer_store_dwordx4 v[72:75], v241, s[32:35], s46 offen sc1
ds_read_b128 v[228:231], v248 offset:21504
v_mfma_f32_32x32x16_bf16 v[120:135], v[96:99], v[232:235], 0
v_pk_fma_f16 v154, v155, v155, s48
v_and_b32_e64 v137, s49, v137
v_pk_fma_f16 v151, v152, v152, s48
v_and_b32_e64 v139, s49, v139
v_pk_fma_f16 v148, v149, v149, s48
v_pk_mul_f16 v154, v155, v154
v_bfe_u32 v136, v137, 2, 14
v_pk_mul_f16 v151, v152, v151
v_pk_mul_f16 v148, v149, v148
v_bfe_u32 v138, v139, 2, 14
ds_read_b128 v[232:235], v248 offset:22528
ds_read_u16_d16 v136, v136
ds_read_u16_d16 v138, v138
v_mfma_f32_32x32x16_bf16 v[120:135], v[100:103], v[236:239], v[120:135]
v_exp_f16 v153, v154
v_lshrrev_b32 v137, 18, v137
v_exp_f16 v150, v151
v_lshrrev_b32 v139, 18, v139
v_exp_f16 v147, v148
v_and_b32 v141, s49, v141
v_and_b32_e64 v143, s49, v143
ds_read_b128 v[236:239], v248 offset:25600
ds_read_u16_d16_hi v137, v137
ds_read_u16_d16_hi v139, v139
v_mfma_f32_32x32x16_bf16 v[120:135], v[104:107], v[216:219], v[120:135]
v_exp_f16_sdwa v153, v154 dst_sel:WORD_1 dst_unused:UNUSED_PRESERVE src0_sel:WORD_1
v_bfe_u32 v140, v141, 2, 14
v_exp_f16_sdwa v150, v151 dst_sel:WORD_1 dst_unused:UNUSED_PRESERVE src0_sel:WORD_1
v_bfe_u32 v142, v143, 2, 14
v_exp_f16_sdwa v147, v148 dst_sel:WORD_1 dst_unused:UNUSED_PRESERVE src0_sel:WORD_1
v_lshrrev_b32_e64 v141, 18, v141
v_pk_add_f16 v153, v153, 1.0 op_sel_hi:[1,0]
ds_read_b128 v[216:219], v248 offset:23552
ds_read_u16_d16 v140, v140
ds_read_u16_d16 v142, v142
ds_read_u16_d16_hi v141, v141
v_mfma_f32_32x32x16_bf16 v[120:135], v[108:111], v[220:223], v[120:135]
v_lshrrev_b32_e64 v143, 18, v143
v_pk_add_f16 v150, v150, 1.0 op_sel_hi:[1,0]
v_pk_add_f16 v147, v147, 1.0 op_sel_hi:[1,0]
v_and_b32 v145, s49, v145
v_rcp_f16 v154, v153
v_bfe_u32 v144, v145, 2, 14
v_rcp_f16_e64 v151, v150
v_lshrrev_b32 v145, 18, v145
s_waitcnt lgkmcnt(7)
ds_read_b128 v[220:223], v248 offset:26624
ds_read_u16_d16_hi v143, v143
ds_read_u16_d16 v144, v144
ds_read_u16_d16_hi v145, v145
v_mfma_f32_32x32x16_bf16 v[120:135], v[112:115], v[224:227], v[120:135]
v_rcp_f16_e64 v148, v147
v_rcp_f16_sdwa v154, v153 dst_sel:WORD_1 dst_unused:UNUSED_PRESERVE src0_sel:WORD_1
v_fma_mix_f32 v167, v136, v136, v167 op_sel:[0,0,0] op_sel_hi:[1,1,0]
s_waitcnt lgkmcnt(8)
v_fma_mix_f32 v167, v137, v137, v167 op_sel:[1,1,0] op_sel_hi:[1,1,0]
v_rcp_f16_sdwa v151, v150 dst_sel:WORD_1 dst_unused:UNUSED_PRESERVE src0_sel:WORD_1
v_fma_mix_f32 v167, v138, v138, v167 op_sel:[0,0,0] op_sel_hi:[1,1,0]
ds_read_b128 v[224:227], v248 offset:24576
v_mfma_f32_32x32x16_bf16 v[120:135], v[116:119], v[228:231], v[120:135]
v_rcp_f16_sdwa v148, v147 dst_sel:WORD_1 dst_unused:UNUSED_PRESERVE src0_sel:WORD_1
v_fma_mix_f32 v167, v139, v139, v167 op_sel:[1,1,0] op_sel_hi:[1,1,0]
v_pk_mul_f16 v155, v155, v154
s_waitcnt lgkmcnt(5)
v_fma_mix_f32 v167, v140, v140, v167 op_sel:[0,0,0] op_sel_hi:[1,1,0]
v_pk_mul_f16 v152, v152, v151
v_fma_mix_f32 v167, v141, v141, v167 op_sel:[1,1,0] op_sel_hi:[1,1,0]
v_pk_mul_f16 v149, v149, v148
v_fma_mix_f32 v167, v155, v155, v167 op_sel:[0,0,0] op_sel_hi:[1,1,0]
v_fma_mix_f32 v167, v142, v142, v167 op_sel:[0,0,0] op_sel_hi:[1,1,0]
v_fma_mix_f32 v167, v155, v155, v167 op_sel:[1,1,0] op_sel_hi:[1,1,0]
s_waitcnt lgkmcnt(3)
v_fma_mix_f32 v167, v143, v143, v167 op_sel:[1,1,0] op_sel_hi:[1,1,0]
v_fma_mix_f32 v167, v152, v152, v167 op_sel:[0,0,0] op_sel_hi:[1,1,0]
v_fma_mix_f32 v167, v152, v152, v167 op_sel:[1,1,0] op_sel_hi:[1,1,0]
s_waitcnt lgkmcnt(1)
v_fma_mix_f32 v167, v144, v144, v167 op_sel:[0,0,0] op_sel_hi:[1,1,0]
v_fma_mix_f32 v167, v149, v149, v167 op_sel:[0,0,0] op_sel_hi:[1,1,0]
v_fma_mix_f32 v167, v145, v145, v167 op_sel:[1,1,0] op_sel_hi:[1,1,0]
v_fma_mix_f32 v167, v149, v149, v167 op_sel:[1,1,0] op_sel_hi:[1,1,0]
s_cmp_lg_u32 s40, 7
s_cbranch_scc1 Lnoinit
s_waitcnt vmcnt(12)
v_mov_b32_e64 v255, 1
s_mov_b64 exec, 1
buffer_atomic_add v255, v241, s[36:39], 0 offen
s_mov_b64 exec, -1
Lnoinit:
s_setprio 1
v_cvt_pkrtz_f16_f32 v137, v120, v121
v_cvt_pkrtz_f16_f32 v139, v122, v123
v_cvt_pkrtz_f16_f32 v141, v124, v125
v_cvt_pkrtz_f16_f32 v143, v126, v127
v_cvt_pkrtz_f16_f32 v145, v128, v129
v_cvt_pk_f16_f32 v155, v130, v131
v_cvt_pk_f16_f32 v152, v132, v133
v_cvt_pk_f16_f32 v149, v134, v135
s_add_u32 s46, s80, 14680064
buffer_store_dwordx4 v[76:79], v241, s[32:35], s46 offen sc1
ds_read_b128 v[228:231], v248 offset:27648
v_mfma_f32_32x32x16_bf16 v[120:135], v[96:99], v[232:235], 0
v_pk_fma_f16 v154, v155, v155, s48
v_and_b32_e64 v137, s49, v137
v_pk_fma_f16 v151, v152, v152, s48
v_and_b32_e64 v139, s49, v139
v_pk_fma_f16 v148, v149, v149, s48
v_pk_mul_f16 v154, v155, v154
v_bfe_u32 v136, v137, 2, 14
v_pk_mul_f16 v151, v152, v151
v_pk_mul_f16 v148, v149, v148
v_bfe_u32 v138, v139, 2, 14
ds_read_b128 v[232:235], v248 offset:28672
ds_read_u16_d16 v136, v136
ds_read_u16_d16 v138, v138
v_mfma_f32_32x32x16_bf16 v[120:135], v[100:103], v[236:239], v[120:135]
v_exp_f16 v153, v154
v_lshrrev_b32 v137, 18, v137
v_exp_f16 v150, v151
v_lshrrev_b32 v139, 18, v139
v_exp_f16 v147, v148
v_and_b32 v141, s49, v141
v_and_b32_e64 v143, s49, v143
ds_read_b128 v[236:239], v248 offset:31744
ds_read_u16_d16_hi v137, v137
ds_read_u16_d16_hi v139, v139
v_mfma_f32_32x32x16_bf16 v[120:135], v[104:107], v[216:219], v[120:135]
v_exp_f16_sdwa v153, v154 dst_sel:WORD_1 dst_unused:UNUSED_PRESERVE src0_sel:WORD_1
v_bfe_u32 v140, v141, 2, 14
v_exp_f16_sdwa v150, v151 dst_sel:WORD_1 dst_unused:UNUSED_PRESERVE src0_sel:WORD_1
v_bfe_u32 v142, v143, 2, 14
v_exp_f16_sdwa v147, v148 dst_sel:WORD_1 dst_unused:UNUSED_PRESERVE src0_sel:WORD_1
v_lshrrev_b32_e64 v141, 18, v141
v_pk_add_f16 v153, v153, 1.0 op_sel_hi:[1,0]
ds_read_b128 v[216:219], v248 offset:29696
ds_read_u16_d16 v140, v140
ds_read_u16_d16 v142, v142
ds_read_u16_d16_hi v141, v141
v_mfma_f32_32x32x16_bf16 v[120:135], v[108:111], v[220:223], v[120:135]
v_lshrrev_b32_e64 v143, 18, v143
v_pk_add_f16 v150, v150, 1.0 op_sel_hi:[1,0]
v_pk_add_f16 v147, v147, 1.0 op_sel_hi:[1,0]
v_and_b32 v145, s49, v145
v_rcp_f16 v154, v153
v_bfe_u32 v144, v145, 2, 14
v_rcp_f16_e64 v151, v150
v_lshrrev_b32 v145, 18, v145
s_waitcnt lgkmcnt(7)
ds_read_b128 v[220:223], v248 offset:32768
ds_read_u16_d16_hi v143, v143
ds_read_u16_d16 v144, v144
ds_read_u16_d16_hi v145, v145
v_mfma_f32_32x32x16_bf16 v[120:135], v[112:115], v[224:227], v[120:135]
v_rcp_f16_e64 v148, v147
v_rcp_f16_sdwa v154, v153 dst_sel:WORD_1 dst_unused:UNUSED_PRESERVE src0_sel:WORD_1
v_fma_mix_f32 v156, v136, v136, v156 op_sel:[0,0,0] op_sel_hi:[1,1,0]
s_setprio 0
s_waitcnt lgkmcnt(8)
v_fma_mix_f32 v156, v137, v137, v156 op_sel:[1,1,0] op_sel_hi:[1,1,0]
v_rcp_f16_sdwa v151, v150 dst_sel:WORD_1 dst_unused:UNUSED_PRESERVE src0_sel:WORD_1
v_fma_mix_f32 v156, v138, v138, v156 op_sel:[0,0,0] op_sel_hi:[1,1,0]
ds_read_b128 v[224:227], v248 offset:30720
v_mfma_f32_32x32x16_bf16 v[120:135], v[116:119], v[228:231], v[120:135]
v_rcp_f16_sdwa v148, v147 dst_sel:WORD_1 dst_unused:UNUSED_PRESERVE src0_sel:WORD_1
v_fma_mix_f32 v156, v139, v139, v156 op_sel:[1,1,0] op_sel_hi:[1,1,0]
v_pk_mul_f16 v155, v155, v154
s_cmp_eq_u32 s40, 7
s_cbranch_scc1 Lrdy24
s_waitcnt vmcnt(2)
Lrdy24:
s_mov_b64 exec, 1
ds_add_u32 v253, v254 offset:12
s_mov_b64 exec, -1
s_waitcnt lgkmcnt(6)
v_fma_mix_f32 v156, v140, v140, v156 op_sel:[0,0,0] op_sel_hi:[1,1,0]
v_pk_mul_f16 v152, v152, v151
v_fma_mix_f32 v156, v141, v141, v156 op_sel:[1,1,0] op_sel_hi:[1,1,0]
v_pk_mul_f16 v149, v149, v148
v_fma_mix_f32 v156, v155, v155, v156 op_sel:[0,0,0] op_sel_hi:[1,1,0]
v_fma_mix_f32 v156, v142, v142, v156 op_sel:[0,0,0] op_sel_hi:[1,1,0]
v_fma_mix_f32 v156, v155, v155, v156 op_sel:[1,1,0] op_sel_hi:[1,1,0]
s_waitcnt lgkmcnt(2)
v_fma_mix_f32 v156, v143, v143, v156 op_sel:[1,1,0] op_sel_hi:[1,1,0]
v_fma_mix_f32 v156, v152, v152, v156 op_sel:[0,0,0] op_sel_hi:[1,1,0]
v_fma_mix_f32 v156, v152, v152, v156 op_sel:[1,1,0] op_sel_hi:[1,1,0]
v_fma_mix_f32 v156, v144, v144, v156 op_sel:[0,0,0] op_sel_hi:[1,1,0]
v_fma_mix_f32 v156, v149, v149, v156 op_sel:[0,0,0] op_sel_hi:[1,1,0]
v_fma_mix_f32 v156, v145, v145, v156 op_sel:[1,1,0] op_sel_hi:[1,1,0]
v_fma_mix_f32 v156, v149, v149, v156 op_sel:[1,1,0] op_sel_hi:[1,1,0]
s_setprio 2
v_cvt_pkrtz_f16_f32 v137, v120, v121
v_cvt_pkrtz_f16_f32 v139, v122, v123
v_cvt_pkrtz_f16_f32 v141, v124, v125
v_cvt_pkrtz_f16_f32 v143, v126, v127
v_cvt_pkrtz_f16_f32 v145, v128, v129
v_cvt_pk_f16_f32 v155, v130, v131
v_cvt_pk_f16_f32 v152, v132, v133
v_cvt_pk_f16_f32 v149, v134, v135
s_add_u32 s46, s80, 16777216
buffer_store_dwordx4 v[80:83], v241, s[32:35], s46 offen sc1
ds_read_b128 v[228:231], v248 offset:33792
v_mfma_f32_32x32x16_bf16 v[120:135], v[96:99], v[232:235], 0
v_pk_fma_f16 v154, v155, v155, s48
v_and_b32_e64 v137, s49, v137
v_pk_fma_f16 v151, v152, v152, s48
v_and_b32_e64 v139, s49, v139
v_pk_fma_f16 v148, v149, v149, s48
v_pk_mul_f16 v154, v155, v154
v_bfe_u32 v136, v137, 2, 14
v_pk_mul_f16 v151, v152, v151
v_pk_mul_f16 v148, v149, v148
v_bfe_u32 v138, v139, 2, 14
ds_read_b128 v[232:235], v250 offset:65520
ds_read_u16_d16 v136, v136
ds_read_u16_d16 v138, v138
v_mfma_f32_32x32x16_bf16 v[120:135], v[100:103], v[236:239], v[120:135]
v_exp_f16 v153, v154
v_lshrrev_b32 v137, 18, v137
v_exp_f16 v150, v151
v_lshrrev_b32 v139, 18, v139
v_exp_f16 v147, v148
v_and_b32 v141, s49, v141
v_and_b32_e64 v143, s49, v143
ds_read_b128 v[236:239], v248 offset:34816
ds_read_u16_d16_hi v137, v137
ds_read_b32 v247, v253 offset:12
ds_read_u16_d16_hi v139, v139
v_mfma_f32_32x32x16_bf16 v[120:135], v[104:107], v[216:219], v[120:135]
v_exp_f16_sdwa v153, v154 dst_sel:WORD_1 dst_unused:UNUSED_PRESERVE src0_sel:WORD_1
v_bfe_u32 v140, v141, 2, 14
v_exp_f16_sdwa v150, v151 dst_sel:WORD_1 dst_unused:UNUSED_PRESERVE src0_sel:WORD_1
v_bfe_u32 v142, v143, 2, 14
v_exp_f16_sdwa v147, v148 dst_sel:WORD_1 dst_unused:UNUSED_PRESERVE src0_sel:WORD_1
v_lshrrev_b32_e64 v141, 18, v141
v_pk_add_f16 v153, v153, 1.0 op_sel_hi:[1,0]
ds_read_b128 v[216:219], v248 offset:37888
ds_read_u16_d16 v140, v140
ds_read_u16_d16 v142, v142
ds_read_u16_d16_hi v141, v141
v_mfma_f32_32x32x16_bf16 v[120:135], v[108:111], v[220:223], v[120:135]
v_lshrrev_b32_e64 v143, 18, v143
v_pk_add_f16 v150, v150, 1.0 op_sel_hi:[1,0]
v_pk_add_f16 v147, v147, 1.0 op_sel_hi:[1,0]
v_and_b32 v145, s49, v145
v_rcp_f16 v154, v153
v_bfe_u32 v144, v145, 2, 14
v_rcp_f16_e64 v151, v150
ds_read_u16_d16_hi v143, v143
ds_read_u16_d16 v144, v144
s_waitcnt lgkmcnt(7)
v_readfirstlane_b32 s43, v247
s_nop 1
s_cmp_ge_u32 s43, 32
s_cbranch_scc1 Lev7
Lev7w:
s_sleep 1
ds_read_b32 v247, v253 offset:12
s_waitcnt lgkmcnt(0)
v_readfirstlane_b32 s43, v247
s_cmp_eq_u32 s76, 0
s_cbranch_scc1 Lev7
s_sub_u32 s76, s76, 1
s_cmp_lt_u32 s43, 32
s_cbranch_scc1 Lev7w
Lev7:
v_lshrrev_b32 v145, 18, v145
ds_read_b128 v[220:223], v248 offset:35840
ds_read_u16_d16_hi v145, v145
v_mfma_f32_32x32x16_bf16 v[120:135], v[112:115], v[224:227], v[120:135]
v_rcp_f16 v148, v147
v_rcp_f16_sdwa v154, v153 dst_sel:WORD_1 dst_unused:UNUSED_PRESERVE src0_sel:WORD_1
v_fma_mix_f32 v157, v136, v136, v157 op_sel:[0,0,0] op_sel_hi:[1,1,0]
v_fma_mix_f32 v157, v137, v137, v157 op_sel:[1,1,0] op_sel_hi:[1,1,0]
v_rcp_f16_sdwa v151, v150 dst_sel:WORD_1 dst_unused:UNUSED_PRESERVE src0_sel:WORD_1
v_fma_mix_f32 v157, v138, v138, v157 op_sel:[0,0,0] op_sel_hi:[1,1,0]
ds_read_b128 v[224:227], v245 offset:6528
ds_read_b128 v[192:195], v244 offset:128
ds_read_b128 v[196:199], v244 offset:64
v_mfma_f32_32x32x16_bf16 v[120:135], v[116:119], v[228:231], v[120:135]
v_rcp_f16_sdwa v148, v147 dst_sel:WORD_1 dst_unused:UNUSED_PRESERVE src0_sel:WORD_1
s_waitcnt lgkmcnt(5)
v_fma_mix_f32 v157, v139, v139, v157 op_sel:[1,1,0] op_sel_hi:[1,1,0]
v_pk_mul_f16 v155, v155, v154
v_fma_mix_f32 v157, v140, v140, v157 op_sel:[0,0,0] op_sel_hi:[1,1,0]
v_pk_mul_f16 v152, v152, v151
v_fma_mix_f32 v157, v141, v141, v157 op_sel:[1,1,0] op_sel_hi:[1,1,0]
v_pk_mul_f16 v149, v149, v148
v_fma_mix_f32 v157, v155, v155, v157 op_sel:[0,0,0] op_sel_hi:[1,1,0]
v_fma_mix_f32 v157, v142, v142, v157 op_sel:[0,0,0] op_sel_hi:[1,1,0]
v_fma_mix_f32 v157, v155, v155, v157 op_sel:[1,1,0] op_sel_hi:[1,1,0]
v_fma_mix_f32 v157, v143, v143, v157 op_sel:[1,1,0] op_sel_hi:[1,1,0]
v_fma_mix_f32 v157, v152, v152, v157 op_sel:[0,0,0] op_sel_hi:[1,1,0]
v_fma_mix_f32 v157, v152, v152, v157 op_sel:[1,1,0] op_sel_hi:[1,1,0]
v_fma_mix_f32 v157, v144, v144, v157 op_sel:[0,0,0] op_sel_hi:[1,1,0]
v_fma_mix_f32 v157, v149, v149, v157 op_sel:[0,0,0] op_sel_hi:[1,1,0]
s_waitcnt lgkmcnt(3)
v_fma_mix_f32 v157, v145, v145, v157 op_sel:[1,1,0] op_sel_hi:[1,1,0]
v_fma_mix_f32 v157, v149, v149, v157 op_sel:[1,1,0] op_sel_hi:[1,1,0]
s_setprio 1
v_mfma_f32_32x32x16_bf16 v[0:15], v[232:235], v[232:235], 0
s_add_u32 s46, s80, 18874368
buffer_store_dwordx4 v[84:87], v241, s[32:35], s46 offen sc1
ds_read_b128 v[228:231], v248 offset:38912
v_cvt_pkrtz_f16_f32 v137, v120, v121
v_cvt_pkrtz_f16_f32 v139, v122, v123
v_cvt_pkrtz_f16_f32 v141, v124, v125
v_cvt_pkrtz_f16_f32 v143, v126, v127
v_mfma_f32_32x32x16_bf16 v[16:31], v[232:235], v[232:235], 0
v_cvt_pk_f16_f32 v155, v128, v129
v_cvt_pk_f16_f32 v152, v130, v131
v_cvt_pk_f16_f32 v149, v132, v133
v_cvt_pk_f16_f32 v146, v134, v135
v_mfma_f32_32x32x16_bf16 v[32:47], v[232:235], v[232:235], 0
v_pk_fma_f16 v154, v155, v155, s48
v_and_b32_e64 v137, s49, v137
v_pk_fma_f16 v151, v152, v152, s48
v_pk_fma_f16 v148, v149, v149, s48
v_mfma_f32_32x32x16_bf16 v[120:135], v[96:99], v[236:239], 0
ds_read_b128 v[232:235], v248 offset:36864
v_and_b32_e64 v139, s49, v139
v_pk_fma_f16 v145, v146, v146, s48
v_pk_mul_f16 v154, v155, v154
v_bfe_u32 v136, v137, 2, 14
v_pk_mul_f16 v151, v152, v151
v_pk_mul_f16 v148, v149, v148
v_bfe_u32 v138, v139, 2, 14
v_pk_mul_f16 v145, v146, v145
v_mfma_f32_32x32x16_bf16 v[120:135], v[100:103], v[216:219], v[120:135]
ds_read_b128 v[236:239], v245 offset:6144
ds_read_b128 v[200:203], v244
ds_read_b128 v[204:207], v243 offset:128
ds_read_u16_d16 v136, v136
ds_read_u16_d16 v138, v138
v_exp_f16 v153, v154
v_lshrrev_b32 v137, 18, v137
v_exp_f16 v150, v151
v_lshrrev_b32 v139, 18, v139
v_exp_f16_e64 v147, v148
v_mfma_f32_32x32x16_bf16 v[120:135], v[104:107], v[220:223], v[120:135]
ds_read_b128 v[216:219], v248 offset:39936
ds_read_u16_d16_hi v137, v137
ds_read_u16_d16_hi v139, v139
v_and_b32 v141, s49, v141
v_exp_f16 v144, v145
v_and_b32 v143, s49, v143
v_exp_f16_sdwa v153, v154 dst_sel:WORD_1 dst_unused:UNUSED_PRESERVE src0_sel:WORD_1
v_bfe_u32 v140, v141, 2, 14
s_waitcnt lgkmcnt(8)
v_smfmac_f32_16x16x32_bf16 v[40:43], v[226:227], v[192:195], v246
ds_read_b128 v[220:223], v245 offset:5760
ds_read_b128 v[208:211], v243 offset:64
ds_read_b128 v[212:215], v243
ds_read_u16_d16 v140, v140
v_exp_f16_sdwa v150, v151 dst_sel:WORD_1 dst_unused:UNUSED_PRESERVE src0_sel:WORD_1
v_bfe_u32 v142, v143, 2, 14
v_exp_f16_sdwa v147, v148 dst_sel:WORD_1 dst_unused:UNUSED_PRESERVE src0_sel:WORD_1
v_smfmac_f32_16x16x32_bf16 v[24:27], v[224:225], v[196:199], v246
v_lshrrev_b32_e64 v141, 18, v141
v_exp_f16_sdwa v144, v145 dst_sel:WORD_1 dst_unused:UNUSED_PRESERVE src0_sel:WORD_1
v_lshrrev_b32_e64 v143, 18, v143
v_mfma_f32_32x32x16_bf16 v[120:135], v[108:111], v[228:231], v[120:135]
ds_read_b128 v[224:227], v245 offset:5376
ds_read_b128 v[192:195], v242 offset:128
ds_read_b128 v[196:199], v242 offset:64
ds_read_u16_d16 v142, v142
ds_read_u16_d16_hi v141, v141
ds_read_u16_d16_hi v143, v143
v_pk_add_f16 v153, v153, 1.0 op_sel_hi:[1,0]
v_pk_add_f16 v150, v150, 1.0 op_sel_hi:[1,0]
v_pk_add_f16 v147, v147, 1.0 op_sel_hi:[1,0]
v_pk_add_f16 v144, v144, 1.0 op_sel_hi:[1,0]
v_rcp_f16 v154, v153
v_rcp_f16 v151, v150
v_mfma_f32_32x32x16_bf16 v[120:135], v[112:115], v[232:235], v[120:135]
ds_read_b128 v[228:231], v248 offset:40960
v_rcp_f16 v148, v147
v_rcp_f16 v145, v144
v_rcp_f16_sdwa v154, v153 dst_sel:WORD_1 dst_unused:UNUSED_PRESERVE src0_sel:WORD_1
v_rcp_f16_sdwa v151, v150 dst_sel:WORD_1 dst_unused:UNUSED_PRESERVE src0_sel:WORD_1
s_setprio 0
s_waitcnt lgkmcnt(7)
v_smfmac_f32_16x16x32_bf16 v[8:11], v[238:239], v[200:203], v246
ds_read_b128 v[232:235], v248 offset:44032
v_rcp_f16_sdwa v148, v147 dst_sel:WORD_1 dst_unused:UNUSED_PRESERVE src0_sel:WORD_1
v_fma_mix_f32 v158, v136, v136, v158 op_sel:[0,0,0] op_sel_hi:[1,1,0]
v_smfmac_f32_16x16x32_bf16 v[40:43], v[236:237], v[204:207], v246
v_rcp_f16_sdwa v145, v144 dst_sel:WORD_1 dst_unused:UNUSED_PRESERVE src0_sel:WORD_1
v_fma_mix_f32 v158, v137, v137, v158 op_sel:[1,1,0] op_sel_hi:[1,1,0]
v_pk_mul_f16 v155, v155, v154
v_fma_mix_f32 v158, v138, v138, v158 op_sel:[0,0,0] op_sel_hi:[1,1,0]
v_mfma_f32_32x32x16_bf16 v[120:135], v[116:119], v[216:219], v[120:135]
ds_read_b128 v[236:239], v248 offset:41984
v_pk_mul_f16 v152, v152, v151
v_pk_mul_f16 v149, v149, v148
v_fma_mix_f32 v158, v139, v139, v158 op_sel:[1,1,0] op_sel_hi:[1,1,0]
v_pk_mul_f16 v146, v146, v145
v_fma_mix_f32 v158, v155, v155, v158 op_sel:[0,0,0] op_sel_hi:[1,1,0]
v_fma_mix_f32 v158, v140, v140, v158 op_sel:[0,0,0] op_sel_hi:[1,1,0]
v_fma_mix_f32 v158, v155, v155, v158 op_sel:[1,1,0] op_sel_hi:[1,1,0]
v_fma_mix_f32 v158, v152, v152, v158 op_sel:[0,0,0] op_sel_hi:[1,1,0]
v_smfmac_f32_16x16x32_bf16 v[24:27], v[222:223], v[208:211], v246
ds_read_b128 v[216:219], v248 offset:45056
s_waitcnt lgkmcnt(3)
v_fma_mix_f32 v158, v141, v141, v158 op_sel:[1,1,0] op_sel_hi:[1,1,0]
v_fma_mix_f32 v158, v152, v152, v158 op_sel:[1,1,0] op_sel_hi:[1,1,0]
v_fma_mix_f32 v158, v149, v149, v158 op_sel:[0,0,0] op_sel_hi:[1,1,0]
v_fma_mix_f32 v158, v142, v142, v158 op_sel:[0,0,0] op_sel_hi:[1,1,0]
v_smfmac_f32_16x16x32_bf16 v[8:11], v[220:221], v[212:215], v246
v_fma_mix_f32 v158, v149, v149, v158 op_sel:[1,1,0] op_sel_hi:[1,1,0]
v_fma_mix_f32 v158, v146, v146, v158 op_sel:[0,0,0] op_sel_hi:[1,1,0]
v_fma_mix_f32 v158, v143, v143, v158 op_sel:[1,1,0] op_sel_hi:[1,1,0]
v_fma_mix_f32 v158, v146, v146, v158 op_sel:[1,1,0] op_sel_hi:[1,1,0]
s_setprio 2
v_smfmac_f32_16x16x32_bf16 v[40:43], v[226:227], v[192:195], v246
s_add_u32 s46, s80, 20971520
buffer_store_dwordx4 v[88:91], v241, s[32:35], s46 offen sc1
ds_read_b128 v[220:223], v248 offset:43008
v_cvt_pkrtz_f16_f32 v137, v120, v121
v_cvt_pkrtz_f16_f32 v139, v122, v123
v_cvt_pkrtz_f16_f32 v141, v124, v125
v_cvt_pkrtz_f16_f32 v143, v126, v127
v_smfmac_f32_16x16x32_bf16 v[24:27], v[224:225], v[196:199], v246
v_cvt_pkrtz_f16_f32 v145, v128, v129
v_cvt_pk_f16_f32 v155, v130, v131
v_cvt_pk_f16_f32 v152, v132, v133
v_cvt_pk_f16_f32 v149, v134, v135
v_mfma_f32_32x32x16_bf16 v[120:135], v[96:99], v[228:231], 0
ds_read_b128 v[224:227], v245 offset:4992
ds_read_b128 v[200:203], v242
v_xor_b32 v244, 16, v244
ds_read_b128 v[204:207], v244 offset:128
v_pk_fma_f16 v154, v155, v155, s48
v_and_b32 v137, s49, v137
v_pk_fma_f16 v151, v152, v152, s48
v_and_b32 v139, s49, v139
v_pk_fma_f16 v148, v149, v149, s48
v_pk_mul_f16 v154, v155, v154
v_bfe_u32 v136, v137, 2, 14
v_pk_mul_f16 v151, v152, v151
s_waitcnt lgkmcnt(4)
v_mfma_f32_32x32x16_bf16 v[120:135], v[100:103], v[232:235], v[120:135]
ds_read_b128 v[228:231], v248 offset:46080
ds_read_u16_d16 v136, v136
v_pk_mul_f16 v148, v149, v148
v_bfe_u32 v138, v139, 2, 14
v_exp_f16 v153, v154
v_lshrrev_b32 v137, 18, v137
v_exp_f16 v150, v151
v_lshrrev_b32 v139, 18, v139
v_mfma_f32_32x32x16_bf16 v[120:135], v[104:107], v[236:239], v[120:135]
ds_read_b128 v[232:235], v245 offset:4608
ds_read_b128 v[208:211], v244 offset:64
ds_read_b128 v[212:215], v244
ds_read_u16_d16 v138, v138
ds_read_u16_d16_hi v137, v137
ds_read_u16_d16_hi v139, v139
v_exp_f16 v147, v148
v_and_b32 v141, s49, v141
v_and_b32 v143, s49, v143
v_exp_f16_sdwa v153, v154 dst_sel:WORD_1 dst_unused:UNUSED_PRESERVE src0_sel:WORD_1
v_bfe_u32 v140, v141, 2, 14
v_exp_f16_sdwa v150, v151 dst_sel:WORD_1 dst_unused:UNUSED_PRESERVE src0_sel:WORD_1
v_mfma_f32_32x32x16_bf16 v[120:135], v[108:111], v[216:219], v[120:135]
ds_read_b128 v[236:239], v245 offset:4224
v_xor_b32 v243, 16, v243
ds_read_b128 v[192:195], v243 offset:128
ds_read_b128 v[196:199], v243 offset:64
ds_read_u16_d16 v140, v140
v_bfe_u32 v142, v143, 2, 14
v_exp_f16_sdwa v147, v148 dst_sel:WORD_1 dst_unused:UNUSED_PRESERVE src0_sel:WORD_1
v_lshrrev_b32_e64 v141, 18, v141
v_pk_add_f16 v153, v153, 1.0 op_sel_hi:[1,0]
v_lshrrev_b32 v143, 18, v143
v_pk_add_f16 v150, v150, 1.0 op_sel_hi:[1,0]
v_pk_add_f16 v147, v147, 1.0 op_sel_hi:[1,0]
s_waitcnt lgkmcnt(9)
v_mfma_f32_32x32x16_bf16 v[120:135], v[112:115], v[220:223], v[120:135]
ds_read_b128 v[216:219], v248 offset:47104
ds_read_u16_d16 v142, v142
ds_read_u16_d16_hi v141, v141
ds_read_u16_d16_hi v143, v143
v_and_b32 v145, s49, v145
v_rcp_f16 v154, v153
v_bfe_u32 v144, v145, 2, 14
v_rcp_f16 v151, v150
v_lshrrev_b32 v145, 18, v145
v_rcp_f16_e64 v148, v147
v_smfmac_f32_16x16x32_bf16 v[8:11], v[226:227], v[200:203], v246
ds_read_b128 v[220:223], v248 offset:50176
ds_read_u16_d16 v144, v144
ds_read_u16_d16_hi v145, v145
v_rcp_f16_sdwa v154, v153 dst_sel:WORD_1 dst_unused:UNUSED_PRESERVE src0_sel:WORD_1
v_fma_mix_f32 v159, v136, v136, v159 op_sel:[0,0,0] op_sel_hi:[1,1,0]
s_waitcnt lgkmcnt(7)
v_fma_mix_f32 v159, v137, v137, v159 op_sel:[1,1,0] op_sel_hi:[1,1,0]
v_smfmac_f32_16x16x32_bf16 v[44:47], v[224:225], v[204:207], v246
v_rcp_f16_sdwa v151, v150 dst_sel:WORD_1 dst_unused:UNUSED_PRESERVE src0_sel:WORD_1
v_fma_mix_f32 v159, v138, v138, v159 op_sel:[0,0,0] op_sel_hi:[1,1,0]
v_mfma_f32_32x32x16_bf16 v[120:135], v[116:119], v[228:231], v[120:135]
ds_read_b128 v[224:227], v248 offset:48128
v_rcp_f16_sdwa v148, v147 dst_sel:WORD_1 dst_unused:UNUSED_PRESERVE src0_sel:WORD_1
v_fma_mix_f32 v159, v139, v139, v159 op_sel:[1,1,0] op_sel_hi:[1,1,0]
v_pk_mul_f16 v155, v155, v154
v_fma_mix_f32 v159, v140, v140, v159 op_sel:[0,0,0] op_sel_hi:[1,1,0]
v_pk_mul_f16 v152, v152, v151
s_waitcnt lgkmcnt(4)
v_fma_mix_f32 v159, v141, v141, v159 op_sel:[1,1,0] op_sel_hi:[1,1,0]
v_pk_mul_f16 v149, v149, v148
v_fma_mix_f32 v159, v155, v155, v159 op_sel:[0,0,0] op_sel_hi:[1,1,0]
v_smfmac_f32_16x16x32_bf16 v[28:31], v[234:235], v[208:211], v246
ds_read_b128 v[228:231], v248 offset:51200
v_fma_mix_f32 v159, v142, v142, v159 op_sel:[0,0,0] op_sel_hi:[1,1,0]
v_fma_mix_f32 v159, v155, v155, v159 op_sel:[1,1,0] op_sel_hi:[1,1,0]
v_fma_mix_f32 v159, v143, v143, v159 op_sel:[1,1,0] op_sel_hi:[1,1,0]
v_fma_mix_f32 v159, v152, v152, v159 op_sel:[0,0,0] op_sel_hi:[1,1,0]
v_smfmac_f32_16x16x32_bf16 v[12:15], v[232:233], v[212:215], v246
v_fma_mix_f32 v159, v152, v152, v159 op_sel:[1,1,0] op_sel_hi:[1,1,0]
s_waitcnt lgkmcnt(2)
v_fma_mix_f32 v159, v144, v144, v159 op_sel:[0,0,0] op_sel_hi:[1,1,0]
v_fma_mix_f32 v159, v149, v149, v159 op_sel:[0,0,0] op_sel_hi:[1,1,0]
v_fma_mix_f32 v159, v145, v145, v159 op_sel:[1,1,0] op_sel_hi:[1,1,0]
v_fma_mix_f32 v159, v149, v149, v159 op_sel:[1,1,0] op_sel_hi:[1,1,0]
s_setprio 1
v_smfmac_f32_16x16x32_bf16 v[44:47], v[238:239], v[192:195], v246
s_add_u32 s46, s80, 23068672
buffer_store_dwordx4 v[92:95], v241, s[32:35], s46 offen sc1
ds_read_b128 v[232:235], v248 offset:49152
v_cvt_pkrtz_f16_f32 v137, v120, v121
v_cvt_pkrtz_f16_f32 v139, v122, v123
v_cvt_pkrtz_f16_f32 v141, v124, v125
v_cvt_pkrtz_f16_f32 v143, v126, v127
v_cvt_pk_f16_f32 v155, v128, v129
v_smfmac_f32_16x16x32_bf16 v[28:31], v[236:237], v[196:199], v246
v_cvt_pk_f16_f32 v152, v130, v131
v_cvt_pk_f16_f32 v149, v132, v133
v_cvt_pk_f16_f32 v146, v134, v135
v_pk_fma_f16 v154, v155, v155, s48
v_and_b32_e64 v137, s49, v137
v_mfma_f32_32x32x16_bf16 v[120:135], v[96:99], v[216:219], 0
ds_read_b128 v[236:239], v248 offset:52224
v_pk_fma_f16 v151, v152, v152, s48
v_pk_fma_f16 v148, v149, v149, s48
v_and_b32_e64 v139, s49, v139
v_pk_fma_f16 v145, v146, v146, s48
v_pk_mul_f16 v154, v155, v154
v_bfe_u32 v136, v137, 2, 14
v_pk_mul_f16 v151, v152, v151
v_pk_mul_f16 v148, v149, v148
v_bfe_u32 v138, v139, 2, 14
v_pk_mul_f16 v145, v146, v145
v_mfma_f32_32x32x16_bf16 v[120:135], v[100:103], v[220:223], v[120:135]
ds_read_b128 v[216:219], v245 offset:3840
ds_read_b128 v[200:203], v243
v_xor_b32 v242, 16, v242
ds_read_b128 v[204:207], v242 offset:128
ds_read_u16_d16 v136, v136
ds_read_u16_d16 v138, v138
v_exp_f16 v153, v154
v_lshrrev_b32 v137, 18, v137
v_exp_f16 v150, v151
v_lshrrev_b32 v139, 18, v139
v_exp_f16 v147, v148
v_and_b32_e64 v141, s49, v141
v_exp_f16 v144, v145
s_waitcnt lgkmcnt(5)
v_mfma_f32_32x32x16_bf16 v[120:135], v[104:107], v[224:227], v[120:135]
ds_read_b128 v[220:223], v245 offset:3456
ds_read_b128 v[208:211], v242 offset:64
ds_read_b128 v[212:215], v242
ds_read_u16_d16_hi v137, v137
ds_read_u16_d16_hi v139, v139
v_and_b32_e64 v143, s49, v143
v_exp_f16_sdwa v153, v154 dst_sel:WORD_1 dst_unused:UNUSED_PRESERVE src0_sel:WORD_1
v_bfe_u32 v140, v141, 2, 14
v_exp_f16_sdwa v150, v151 dst_sel:WORD_1 dst_unused:UNUSED_PRESERVE src0_sel:WORD_1
v_bfe_u32 v142, v143, 2, 14
v_exp_f16_sdwa v147, v148 dst_sel:WORD_1 dst_unused:UNUSED_PRESERVE src0_sel:WORD_1
v_lshrrev_b32_e64 v141, 18, v141
v_mfma_f32_32x32x16_bf16 v[120:135], v[108:111], v[228:231], v[120:135]
ds_read_b128 v[224:227], v248 offset:53248
ds_read_u16_d16 v140, v140
ds_read_u16_d16 v142, v142
ds_read_u16_d16_hi v141, v141
v_exp_f16_sdwa v144, v145 dst_sel:WORD_1 dst_unused:UNUSED_PRESERVE src0_sel:WORD_1
v_lshrrev_b32_e64 v143, 18, v143
v_pk_add_f16 v153, v153, 1.0 op_sel_hi:[1,0]
v_pk_add_f16 v150, v150, 1.0 op_sel_hi:[1,0]
v_pk_add_f16 v147, v147, 1.0 op_sel_hi:[1,0]
v_pk_add_f16 v144, v144, 1.0 op_sel_hi:[1,0]
v_rcp_f16 v154, v153
v_rcp_f16 v151, v150
v_mfma_f32_32x32x16_bf16 v[120:135], v[112:115], v[232:235], v[120:135]
ds_read_b128 v[228:231], v248 offset:56320
ds_read_u16_d16_hi v143, v143
v_rcp_f16_e64 v148, v147
v_rcp_f16 v145, v144
v_rcp_f16_sdwa v154, v153 dst_sel:WORD_1 dst_unused:UNUSED_PRESERVE src0_sel:WORD_1
v_rcp_f16_sdwa v151, v150 dst_sel:WORD_1 dst_unused:UNUSED_PRESERVE src0_sel:WORD_1
s_setprio 0
v_rcp_f16_sdwa v148, v147 dst_sel:WORD_1 dst_unused:UNUSED_PRESERVE src0_sel:WORD_1
s_waitcnt lgkmcnt(6)
v_fma_mix_f32 v160, v136, v136, v160 op_sel:[0,0,0] op_sel_hi:[1,1,0]
v_mfma_f32_32x32x16_bf16 v[120:135], v[116:119], v[236:239], v[120:135]
ds_read_b128 v[232:235], v248 offset:54272
v_rcp_f16_sdwa v145, v144 dst_sel:WORD_1 dst_unused:UNUSED_PRESERVE src0_sel:WORD_1
v_fma_mix_f32 v160, v137, v137, v160 op_sel:[1,1,0] op_sel_hi:[1,1,0]
v_pk_mul_f16 v155, v155, v154
v_fma_mix_f32 v160, v138, v138, v160 op_sel:[0,0,0] op_sel_hi:[1,1,0]
v_pk_mul_f16 v152, v152, v151
v_pk_mul_f16 v149, v149, v148
v_fma_mix_f32 v160, v139, v139, v160 op_sel:[1,1,0] op_sel_hi:[1,1,0]
v_pk_mul_f16 v146, v146, v145
v_fma_mix_f32 v160, v155, v155, v160 op_sel:[0,0,0] op_sel_hi:[1,1,0]
v_smfmac_f32_16x16x32_bf16 v[12:15], v[218:219], v[200:203], v246
ds_read_b128 v[236:239], v248 offset:57344
s_waitcnt lgkmcnt(4)
v_fma_mix_f32 v160, v140, v140, v160 op_sel:[0,0,0] op_sel_hi:[1,1,0]
v_fma_mix_f32 v160, v155, v155, v160 op_sel:[1,1,0] op_sel_hi:[1,1,0]
v_fma_mix_f32 v160, v152, v152, v160 op_sel:[0,0,0] op_sel_hi:[1,1,0]
v_fma_mix_f32 v160, v141, v141, v160 op_sel:[1,1,0] op_sel_hi:[1,1,0]
v_fma_mix_f32 v160, v152, v152, v160 op_sel:[1,1,0] op_sel_hi:[1,1,0]
v_smfmac_f32_16x16x32_bf16 v[44:47], v[216:217], v[204:207], v246
v_fma_mix_f32 v160, v149, v149, v160 op_sel:[0,0,0] op_sel_hi:[1,1,0]
v_fma_mix_f32 v160, v142, v142, v160 op_sel:[0,0,0] op_sel_hi:[1,1,0]
v_fma_mix_f32 v160, v149, v149, v160 op_sel:[1,1,0] op_sel_hi:[1,1,0]
v_fma_mix_f32 v160, v146, v146, v160 op_sel:[0,0,0] op_sel_hi:[1,1,0]
s_waitcnt lgkmcnt(2)
v_fma_mix_f32 v160, v143, v143, v160 op_sel:[1,1,0] op_sel_hi:[1,1,0]
v_fma_mix_f32 v160, v146, v146, v160 op_sel:[1,1,0] op_sel_hi:[1,1,0]
s_setprio 2
v_smfmac_f32_16x16x32_bf16 v[28:31], v[222:223], v[208:211], v246
ds_read_b128 v[216:219], v248 offset:55296
v_cvt_pkrtz_f16_f32 v137, v120, v121
v_cvt_pkrtz_f16_f32 v139, v122, v123
v_cvt_pkrtz_f16_f32 v141, v124, v125
v_cvt_pkrtz_f16_f32 v143, v126, v127
v_smfmac_f32_16x16x32_bf16 v[12:15], v[220:221], v[212:215], v246
v_cvt_pkrtz_f16_f32 v145, v128, v129
v_cvt_pk_f16_f32 v155, v130, v131
v_cvt_pk_f16_f32 v152, v132, v133
v_cvt_pk_f16_f32 v149, v134, v135
v_mfma_f32_32x32x16_bf16 v[120:135], v[96:99], v[224:227], 0
ds_read_b128 v[220:223], v245 offset:3072
v_xor_b32 v244, 32, v244
ds_read_b128 v[192:195], v244 offset:128
ds_read_b128 v[196:199], v244 offset:64
v_pk_fma_f16 v154, v155, v155, s48
v_and_b32 v137, s49, v137
v_pk_fma_f16 v151, v152, v152, s48
v_and_b32_e64 v139, s49, v139
v_pk_fma_f16 v148, v149, v149, s48
v_pk_mul_f16 v154, v155, v154
v_bfe_u32 v136, v137, 2, 14
v_pk_mul_f16 v151, v152, v151
v_mfma_f32_32x32x16_bf16 v[120:135], v[100:103], v[228:231], v[120:135]
ds_read_b128 v[224:227], v248 offset:58368
ds_read_u16_d16 v136, v136
v_pk_mul_f16 v148, v149, v148
v_bfe_u32 v138, v139, 2, 14
v_exp_f16 v153, v154
v_lshrrev_b32 v137, 18, v137
v_exp_f16 v150, v151
v_lshrrev_b32 v139, 18, v139
s_waitcnt lgkmcnt(5)
v_mfma_f32_32x32x16_bf16 v[120:135], v[104:107], v[232:235], v[120:135]
ds_read_b128 v[228:231], v245 offset:2688
ds_read_b128 v[200:203], v244
v_xor_b32 v243, 32, v243
ds_read_b128 v[204:207], v243 offset:128
ds_read_u16_d16 v138, v138
ds_read_u16_d16_hi v137, v137
ds_read_u16_d16_hi v139, v139
v_exp_f16 v147, v148
v_and_b32 v141, s49, v141
v_and_b32_e64 v143, s49, v143
v_exp_f16_sdwa v153, v154 dst_sel:WORD_1 dst_unused:UNUSED_PRESERVE src0_sel:WORD_1
v_bfe_u32 v140, v141, 2, 14
v_exp_f16_sdwa v150, v151 dst_sel:WORD_1 dst_unused:UNUSED_PRESERVE src0_sel:WORD_1
v_mfma_f32_32x32x16_bf16 v[120:135], v[108:111], v[236:239], v[120:135]
ds_read_b128 v[232:235], v245 offset:2304
ds_read_b128 v[208:211], v243 offset:64
ds_read_b128 v[212:215], v243
ds_read_u16_d16 v140, v140
v_bfe_u32 v142, v143, 2, 14
v_exp_f16_sdwa v147, v148 dst_sel:WORD_1 dst_unused:UNUSED_PRESERVE src0_sel:WORD_1
v_lshrrev_b32_e64 v141, 18, v141
v_pk_add_f16 v153, v153, 1.0 op_sel_hi:[1,0]
v_lshrrev_b32_e64 v143, 18, v143
v_pk_add_f16 v150, v150, 1.0 op_sel_hi:[1,0]
v_pk_add_f16 v147, v147, 1.0 op_sel_hi:[1,0]
v_mfma_f32_32x32x16_bf16 v[120:135], v[112:115], v[216:219], v[120:135]
ds_read_b128 v[236:239], v248 offset:59392
ds_read_u16_d16 v142, v142
ds_read_u16_d16_hi v141, v141
ds_read_u16_d16_hi v143, v143
v_and_b32 v145, s49, v145
v_rcp_f16 v154, v153
v_bfe_u32 v144, v145, 2, 14
v_rcp_f16 v151, v150
v_lshrrev_b32 v145, 18, v145
v_rcp_f16 v148, v147
s_waitcnt lgkmcnt(8)
v_smfmac_f32_16x16x32_bf16 v[36:39], v[222:223], v[192:195], v246
ds_read_b128 v[216:219], v248 offset:62464
ds_read_u16_d16 v144, v144
ds_read_u16_d16_hi v145, v145
v_rcp_f16_sdwa v154, v153 dst_sel:WORD_1 dst_unused:UNUSED_PRESERVE src0_sel:WORD_1
v_fma_mix_f32 v161, v136, v136, v161 op_sel:[0,0,0] op_sel_hi:[1,1,0]
v_fma_mix_f32 v161, v137, v137, v161 op_sel:[1,1,0] op_sel_hi:[1,1,0]
v_smfmac_f32_16x16x32_bf16 v[20:23], v[220:221], v[196:199], v246
v_rcp_f16_sdwa v151, v150 dst_sel:WORD_1 dst_unused:UNUSED_PRESERVE src0_sel:WORD_1
v_fma_mix_f32 v161, v138, v138, v161 op_sel:[0,0,0] op_sel_hi:[1,1,0]
v_mfma_f32_32x32x16_bf16 v[120:135], v[116:119], v[224:227], v[120:135]
ds_read_b128 v[220:223], v248 offset:60416
v_rcp_f16_sdwa v148, v147 dst_sel:WORD_1 dst_unused:UNUSED_PRESERVE src0_sel:WORD_1
v_fma_mix_f32 v161, v139, v139, v161 op_sel:[1,1,0] op_sel_hi:[1,1,0]
v_pk_mul_f16 v155, v155, v154
s_waitcnt lgkmcnt(6)
v_fma_mix_f32 v161, v140, v140, v161 op_sel:[0,0,0] op_sel_hi:[1,1,0]
v_pk_mul_f16 v152, v152, v151
s_waitcnt lgkmcnt(4)
v_fma_mix_f32 v161, v141, v141, v161 op_sel:[1,1,0] op_sel_hi:[1,1,0]
v_pk_mul_f16 v149, v149, v148
v_fma_mix_f32 v161, v155, v155, v161 op_sel:[0,0,0] op_sel_hi:[1,1,0]
v_smfmac_f32_16x16x32_bf16 v[4:7], v[230:231], v[200:203], v246
ds_read_b128 v[224:227], v248 offset:63488
v_fma_mix_f32 v161, v142, v142, v161 op_sel:[0,0,0] op_sel_hi:[1,1,0]
v_fma_mix_f32 v161, v155, v155, v161 op_sel:[1,1,0] op_sel_hi:[1,1,0]
v_fma_mix_f32 v161, v143, v143, v161 op_sel:[1,1,0] op_sel_hi:[1,1,0]
v_fma_mix_f32 v161, v152, v152, v161 op_sel:[0,0,0] op_sel_hi:[1,1,0]
v_smfmac_f32_16x16x32_bf16 v[36:39], v[228:229], v[204:207], v246
v_fma_mix_f32 v161, v152, v152, v161 op_sel:[1,1,0] op_sel_hi:[1,1,0]
s_waitcnt lgkmcnt(2)
v_fma_mix_f32 v161, v144, v144, v161 op_sel:[0,0,0] op_sel_hi:[1,1,0]
v_fma_mix_f32 v161, v149, v149, v161 op_sel:[0,0,0] op_sel_hi:[1,1,0]
v_fma_mix_f32 v161, v145, v145, v161 op_sel:[1,1,0] op_sel_hi:[1,1,0]
v_fma_mix_f32 v161, v149, v149, v161 op_sel:[1,1,0] op_sel_hi:[1,1,0]
s_setprio 1
v_smfmac_f32_16x16x32_bf16 v[20:23], v[234:235], v[208:211], v246
ds_read_b128 v[228:231], v248 offset:61440
v_cvt_pkrtz_f16_f32 v137, v120, v121
v_cvt_pkrtz_f16_f32 v139, v122, v123
v_cvt_pkrtz_f16_f32 v141, v124, v125
v_cvt_pkrtz_f16_f32 v143, v126, v127
v_cvt_pk_f16_f32 v155, v128, v129
v_smfmac_f32_16x16x32_bf16 v[4:7], v[232:233], v[212:215], v246
v_cvt_pk_f16_f32 v152, v130, v131
v_cvt_pk_f16_f32 v149, v132, v133
v_cvt_pk_f16_f32 v146, v134, v135
v_pk_fma_f16 v154, v155, v155, s48
v_and_b32_e64 v137, s49, v137
v_mfma_f32_32x32x16_bf16 v[120:135], v[96:99], v[236:239], 0
ds_read_b128 v[232:235], v248 offset:64512
v_pk_fma_f16 v151, v152, v152, s48
v_pk_fma_f16 v148, v149, v149, s48
v_and_b32_e64 v139, s49, v139
v_pk_fma_f16 v145, v146, v146, s48
v_pk_mul_f16 v154, v155, v154
v_bfe_u32 v136, v137, 2, 14
v_pk_mul_f16 v151, v152, v151
v_pk_mul_f16 v148, v149, v148
v_bfe_u32 v138, v139, 2, 14
v_pk_mul_f16 v145, v146, v145
v_mfma_f32_32x32x16_bf16 v[120:135], v[100:103], v[216:219], v[120:135]
ds_read_b128 v[236:239], v245 offset:1920
v_xor_b32 v242, 32, v242
ds_read_b128 v[192:195], v242 offset:128
ds_read_b128 v[196:199], v242 offset:64
ds_read_u16_d16 v136, v136
ds_read_u16_d16 v138, v138
v_exp_f16 v153, v154
v_lshrrev_b32 v137, 18, v137
v_exp_f16 v150, v151
v_lshrrev_b32 v139, 18, v139
v_exp_f16 v147, v148
v_and_b32 v141, s49, v141
v_exp_f16 v144, v145
s_waitcnt lgkmcnt(5)
v_mfma_f32_32x32x16_bf16 v[120:135], v[104:107], v[220:223], v[120:135]
ds_read_b128 v[216:219], v245 offset:1536
ds_read_b128 v[200:203], v242
v_xor_b32 v244, 16, v244
ds_read_b128 v[204:207], v244 offset:128
ds_read_u16_d16_hi v137, v137
ds_read_u16_d16_hi v139, v139
v_and_b32_e64 v143, s49, v143
v_exp_f16_sdwa v153, v154 dst_sel:WORD_1 dst_unused:UNUSED_PRESERVE src0_sel:WORD_1
v_bfe_u32 v140, v141, 2, 14
v_exp_f16_sdwa v150, v151 dst_sel:WORD_1 dst_unused:UNUSED_PRESERVE src0_sel:WORD_1
v_bfe_u32 v142, v143, 2, 14
v_exp_f16_sdwa v147, v148 dst_sel:WORD_1 dst_unused:UNUSED_PRESERVE src0_sel:WORD_1
v_lshrrev_b32_e64 v141, 18, v141
v_mfma_f32_32x32x16_bf16 v[120:135], v[108:111], v[224:227], v[120:135]
ds_read_b128 v[220:223], v249
ds_read_u16_d16 v140, v140
ds_read_u16_d16 v142, v142
ds_read_u16_d16_hi v141, v141
v_exp_f16_sdwa v144, v145 dst_sel:WORD_1 dst_unused:UNUSED_PRESERVE src0_sel:WORD_1
v_lshrrev_b32_e64 v143, 18, v143
v_pk_add_f16 v153, v153, 1.0 op_sel_hi:[1,0]
v_pk_add_f16 v150, v150, 1.0 op_sel_hi:[1,0]
v_pk_add_f16 v147, v147, 1.0 op_sel_hi:[1,0]
v_pk_add_f16 v144, v144, 1.0 op_sel_hi:[1,0]
v_rcp_f16 v154, v153
v_rcp_f16 v151, v150
v_mfma_f32_32x32x16_bf16 v[120:135], v[112:115], v[228:231], v[120:135]
ds_read_b128 v[224:227], v249 offset:3072
ds_read_u16_d16_hi v143, v143
v_rcp_f16_e64 v148, v147
v_rcp_f16 v145, v144
v_rcp_f16_sdwa v154, v153 dst_sel:WORD_1 dst_unused:UNUSED_PRESERVE src0_sel:WORD_1
v_rcp_f16_sdwa v151, v150 dst_sel:WORD_1 dst_unused:UNUSED_PRESERVE src0_sel:WORD_1
s_setprio 0
v_rcp_f16_sdwa v148, v147 dst_sel:WORD_1 dst_unused:UNUSED_PRESERVE src0_sel:WORD_1
s_waitcnt lgkmcnt(6)
v_fma_mix_f32 v162, v136, v136, v162 op_sel:[0,0,0] op_sel_hi:[1,1,0]
v_mfma_f32_32x32x16_bf16 v[120:135], v[116:119], v[232:235], v[120:135]
ds_read_b128 v[228:231], v249 offset:1024
v_rcp_f16_sdwa v145, v144 dst_sel:WORD_1 dst_unused:UNUSED_PRESERVE src0_sel:WORD_1
v_fma_mix_f32 v162, v137, v137, v162 op_sel:[1,1,0] op_sel_hi:[1,1,0]
v_pk_mul_f16 v155, v155, v154
v_fma_mix_f32 v162, v138, v138, v162 op_sel:[0,0,0] op_sel_hi:[1,1,0]
v_pk_mul_f16 v152, v152, v151
v_pk_mul_f16 v149, v149, v148
v_fma_mix_f32 v162, v139, v139, v162 op_sel:[1,1,0] op_sel_hi:[1,1,0]
v_pk_mul_f16 v146, v146, v145
v_fma_mix_f32 v162, v155, v155, v162 op_sel:[0,0,0] op_sel_hi:[1,1,0]
v_smfmac_f32_16x16x32_bf16 v[36:39], v[238:239], v[192:195], v246
ds_read_b128 v[232:235], v249 offset:4096
s_waitcnt lgkmcnt(4)
v_fma_mix_f32 v162, v140, v140, v162 op_sel:[0,0,0] op_sel_hi:[1,1,0]
v_fma_mix_f32 v162, v155, v155, v162 op_sel:[1,1,0] op_sel_hi:[1,1,0]
v_fma_mix_f32 v162, v152, v152, v162 op_sel:[0,0,0] op_sel_hi:[1,1,0]
v_fma_mix_f32 v162, v141, v141, v162 op_sel:[1,1,0] op_sel_hi:[1,1,0]
v_fma_mix_f32 v162, v152, v152, v162 op_sel:[1,1,0] op_sel_hi:[1,1,0]
v_smfmac_f32_16x16x32_bf16 v[20:23], v[236:237], v[196:199], v246
v_fma_mix_f32 v162, v149, v149, v162 op_sel:[0,0,0] op_sel_hi:[1,1,0]
v_fma_mix_f32 v162, v142, v142, v162 op_sel:[0,0,0] op_sel_hi:[1,1,0]
v_fma_mix_f32 v162, v149, v149, v162 op_sel:[1,1,0] op_sel_hi:[1,1,0]
v_fma_mix_f32 v162, v146, v146, v162 op_sel:[0,0,0] op_sel_hi:[1,1,0]
s_waitcnt lgkmcnt(2)
v_fma_mix_f32 v162, v143, v143, v162 op_sel:[1,1,0] op_sel_hi:[1,1,0]
v_fma_mix_f32 v162, v146, v146, v162 op_sel:[1,1,0] op_sel_hi:[1,1,0]
s_setprio 2
v_smfmac_f32_16x16x32_bf16 v[4:7], v[218:219], v[200:203], v246
ds_read_b128 v[236:239], v249 offset:2048
v_cvt_pkrtz_f16_f32 v137, v120, v121
v_cvt_pkrtz_f16_f32 v139, v122, v123
v_cvt_pkrtz_f16_f32 v141, v124, v125
v_cvt_pkrtz_f16_f32 v143, v126, v127
v_smfmac_f32_16x16x32_bf16 v[32:35], v[216:217], v[204:207], v246
v_cvt_pkrtz_f16_f32 v145, v128, v129
v_cvt_pk_f16_f32 v155, v130, v131
v_cvt_pk_f16_f32 v152, v132, v133
v_cvt_pk_f16_f32 v149, v134, v135
v_mfma_f32_32x32x16_bf16 v[120:135], v[96:99], v[220:223], 0
ds_read_b128 v[216:219], v245 offset:1152
ds_read_b128 v[208:211], v244 offset:64
ds_read_b128 v[212:215], v244
v_pk_fma_f16 v154, v155, v155, s48
v_and_b32_e64 v137, s49, v137
v_pk_fma_f16 v151, v152, v152, s48
v_and_b32_e64 v139, s49, v139
v_pk_fma_f16 v148, v149, v149, s48
v_pk_mul_f16 v154, v155, v154
v_bfe_u32 v136, v137, 2, 14
v_pk_mul_f16 v151, v152, v151
v_mfma_f32_32x32x16_bf16 v[120:135], v[100:103], v[224:227], v[120:135]
ds_read_b128 v[220:223], v249 offset:5120
ds_read_u16_d16 v136, v136
v_pk_mul_f16 v148, v149, v148
v_bfe_u32 v138, v139, 2, 14
v_exp_f16 v153, v154
v_lshrrev_b32 v137, 18, v137
v_exp_f16 v150, v151
v_lshrrev_b32 v139, 18, v139
s_waitcnt lgkmcnt(5)
v_mfma_f32_32x32x16_bf16 v[120:135], v[104:107], v[228:231], v[120:135]
ds_read_b128 v[224:227], v245 offset:768
v_xor_b32 v243, 16, v243
ds_read_b128 v[192:195], v243 offset:128
ds_read_b128 v[196:199], v243 offset:64
ds_read_u16_d16 v138, v138
ds_read_u16_d16_hi v137, v137
ds_read_u16_d16_hi v139, v139
v_exp_f16 v147, v148
v_and_b32 v141, s49, v141
v_and_b32_e64 v143, s49, v143
v_exp_f16_sdwa v153, v154 dst_sel:WORD_1 dst_unused:UNUSED_PRESERVE src0_sel:WORD_1
v_bfe_u32 v140, v141, 2, 14
v_exp_f16_sdwa v150, v151 dst_sel:WORD_1 dst_unused:UNUSED_PRESERVE src0_sel:WORD_1
v_mfma_f32_32x32x16_bf16 v[120:135], v[108:111], v[232:235], v[120:135]
ds_read_b128 v[228:231], v245 offset:384
ds_read_b128 v[200:203], v243
v_xor_b32 v242, 16, v242
ds_read_b128 v[204:207], v242 offset:128
ds_read_u16_d16 v140, v140
v_bfe_u32 v142, v143, 2, 14
v_exp_f16_sdwa v147, v148 dst_sel:WORD_1 dst_unused:UNUSED_PRESERVE src0_sel:WORD_1
v_lshrrev_b32 v141, 18, v141
v_pk_add_f16 v153, v153, 1.0 op_sel_hi:[1,0]
v_lshrrev_b32_e64 v143, 18, v143
v_pk_add_f16 v150, v150, 1.0 op_sel_hi:[1,0]
v_pk_add_f16 v147, v147, 1.0 op_sel_hi:[1,0]
v_mfma_f32_32x32x16_bf16 v[120:135], v[112:115], v[236:239], v[120:135]
ds_read_b128 v[232:235], v249 offset:6144
ds_read_u16_d16 v142, v142
ds_read_u16_d16_hi v141, v141
ds_read_u16_d16_hi v143, v143
v_and_b32 v145, s49, v145
v_rcp_f16 v154, v153
v_bfe_u32 v144, v145, 2, 14
v_rcp_f16 v151, v150
v_lshrrev_b32 v145, 18, v145
v_rcp_f16 v148, v147
s_waitcnt lgkmcnt(8)
v_smfmac_f32_16x16x32_bf16 v[16:19], v[218:219], v[208:211], v246
ds_read_b128 v[236:239], v249 offset:9216
ds_read_u16_d16 v144, v144
ds_read_u16_d16_hi v145, v145
v_rcp_f16_sdwa v154, v153 dst_sel:WORD_1 dst_unused:UNUSED_PRESERVE src0_sel:WORD_1
v_fma_mix_f32 v163, v136, v136, v163 op_sel:[0,0,0] op_sel_hi:[1,1,0]
v_fma_mix_f32 v163, v137, v137, v163 op_sel:[1,1,0] op_sel_hi:[1,1,0]
v_smfmac_f32_16x16x32_bf16 v[0:3], v[216:217], v[212:215], v246
v_rcp_f16_sdwa v151, v150 dst_sel:WORD_1 dst_unused:UNUSED_PRESERVE src0_sel:WORD_1
v_fma_mix_f32 v163, v138, v138, v163 op_sel:[0,0,0] op_sel_hi:[1,1,0]
v_mfma_f32_32x32x16_bf16 v[120:135], v[116:119], v[220:223], v[120:135]
ds_read_b128 v[216:219], v249 offset:7168
v_rcp_f16_sdwa v148, v147 dst_sel:WORD_1 dst_unused:UNUSED_PRESERVE src0_sel:WORD_1
v_fma_mix_f32 v163, v139, v139, v163 op_sel:[1,1,0] op_sel_hi:[1,1,0]
v_pk_mul_f16 v155, v155, v154
s_waitcnt lgkmcnt(6)
v_fma_mix_f32 v163, v140, v140, v163 op_sel:[0,0,0] op_sel_hi:[1,1,0]
v_pk_mul_f16 v152, v152, v151
s_waitcnt lgkmcnt(4)
v_fma_mix_f32 v163, v141, v141, v163 op_sel:[1,1,0] op_sel_hi:[1,1,0]
v_pk_mul_f16 v149, v149, v148
v_fma_mix_f32 v163, v155, v155, v163 op_sel:[0,0,0] op_sel_hi:[1,1,0]
v_smfmac_f32_16x16x32_bf16 v[32:35], v[226:227], v[192:195], v246
ds_read_b128 v[220:223], v249 offset:10240
v_fma_mix_f32 v163, v142, v142, v163 op_sel:[0,0,0] op_sel_hi:[1,1,0]
v_fma_mix_f32 v163, v155, v155, v163 op_sel:[1,1,0] op_sel_hi:[1,1,0]
v_fma_mix_f32 v163, v143, v143, v163 op_sel:[1,1,0] op_sel_hi:[1,1,0]
v_fma_mix_f32 v163, v152, v152, v163 op_sel:[0,0,0] op_sel_hi:[1,1,0]
v_smfmac_f32_16x16x32_bf16 v[16:19], v[224:225], v[196:199], v246
v_fma_mix_f32 v163, v152, v152, v163 op_sel:[1,1,0] op_sel_hi:[1,1,0]
s_waitcnt lgkmcnt(2)
v_fma_mix_f32 v163, v144, v144, v163 op_sel:[0,0,0] op_sel_hi:[1,1,0]
v_fma_mix_f32 v163, v149, v149, v163 op_sel:[0,0,0] op_sel_hi:[1,1,0]
v_fma_mix_f32 v163, v145, v145, v163 op_sel:[1,1,0] op_sel_hi:[1,1,0]
v_fma_mix_f32 v163, v149, v149, v163 op_sel:[1,1,0] op_sel_hi:[1,1,0]
s_setprio 1
v_smfmac_f32_16x16x32_bf16 v[0:3], v[230:231], v[200:203], v246
ds_read_b128 v[224:227], v249 offset:8192
v_cvt_pkrtz_f16_f32 v137, v120, v121
v_cvt_pkrtz_f16_f32 v139, v122, v123
v_cvt_pkrtz_f16_f32 v141, v124, v125
v_cvt_pkrtz_f16_f32 v143, v126, v127
v_smfmac_f32_16x16x32_bf16 v[32:35], v[228:229], v[204:207], v246
v_cvt_pk_f16_f32 v155, v128, v129
v_cvt_pk_f16_f32 v152, v130, v131
v_cvt_pk_f16_f32 v149, v132, v133
v_cvt_pk_f16_f32 v146, v134, v135
v_pk_fma_f16 v154, v155, v155, s48
v_mfma_f32_32x32x16_bf16 v[120:135], v[96:99], v[232:235], 0
ds_read_b128 v[228:231], v249 offset:11264
v_and_b32_e64 v137, s49, v137
v_pk_fma_f16 v151, v152, v152, s48
v_pk_fma_f16 v148, v149, v149, s48
v_and_b32_e64 v139, s49, v139
v_pk_fma_f16 v145, v146, v146, s48
v_pk_mul_f16 v154, v155, v154
v_bfe_u32 v136, v137, 2, 14
v_pk_mul_f16 v151, v152, v151
v_pk_mul_f16 v148, v149, v148
v_bfe_u32 v138, v139, 2, 14
v_mfma_f32_32x32x16_bf16 v[120:135], v[100:103], v[236:239], v[120:135]
ds_read_b128 v[232:235], v245
ds_read_b128 v[208:211], v242 offset:64
ds_read_b128 v[212:215], v242
ds_read_u16_d16 v136, v136
ds_read_u16_d16 v138, v138
v_pk_mul_f16 v145, v146, v145
v_exp_f16 v153, v154
v_lshrrev_b32 v137, 18, v137
v_exp_f16 v150, v151
v_lshrrev_b32 v139, 18, v139
v_exp_f16 v147, v148
s_waitcnt lgkmcnt(6)
v_mfma_f32_32x32x16_bf16 v[120:135], v[104:107], v[216:219], v[120:135]
ds_read_b128 v[236:239], v249 offset:12288
ds_read_u16_d16_hi v137, v137
ds_read_u16_d16_hi v139, v139
v_and_b32 v141, s49, v141
v_exp_f16 v144, v145
v_and_b32_e64 v143, s49, v143
v_exp_f16_sdwa v153, v154 dst_sel:WORD_1 dst_unused:UNUSED_PRESERVE src0_sel:WORD_1
v_bfe_u32 v140, v141, 2, 14
v_exp_f16_sdwa v150, v151 dst_sel:WORD_1 dst_unused:UNUSED_PRESERVE src0_sel:WORD_1
v_bfe_u32 v142, v143, 2, 14
v_mfma_f32_32x32x16_bf16 v[120:135], v[108:111], v[220:223], v[120:135]
ds_read_b128 v[216:219], v249 offset:15360
ds_read_u16_d16 v140, v140
ds_read_u16_d16 v142, v142
v_exp_f16_sdwa v147, v148 dst_sel:WORD_1 dst_unused:UNUSED_PRESERVE src0_sel:WORD_1
v_lshrrev_b32_e64 v141, 18, v141
v_exp_f16_sdwa v144, v145 dst_sel:WORD_1 dst_unused:UNUSED_PRESERVE src0_sel:WORD_1
v_lshrrev_b32_e64 v143, 18, v143
v_pk_add_f16 v153, v153, 1.0 op_sel_hi:[1,0]
v_pk_add_f16 v150, v150, 1.0 op_sel_hi:[1,0]
v_pk_add_f16 v147, v147, 1.0 op_sel_hi:[1,0]
v_mfma_f32_32x32x16_bf16 v[120:135], v[112:115], v[224:227], v[120:135]
ds_read_b128 v[220:223], v249 offset:13312
ds_read_u16_d16_hi v141, v141
ds_read_u16_d16_hi v143, v143
v_pk_add_f16 v144, v144, 1.0 op_sel_hi:[1,0]
v_rcp_f16 v154, v153
v_rcp_f16 v151, v150
v_rcp_f16 v148, v147
v_rcp_f16 v145, v144
s_waitcnt lgkmcnt(6)
v_mfma_f32_32x32x16_bf16 v[120:135], v[116:119], v[228:231], v[120:135]
ds_read_b128 v[224:227], v249 offset:16384
v_rcp_f16_sdwa v154, v153 dst_sel:WORD_1 dst_unused:UNUSED_PRESERVE src0_sel:WORD_1
v_rcp_f16_sdwa v151, v150 dst_sel:WORD_1 dst_unused:UNUSED_PRESERVE src0_sel:WORD_1
s_setprio 0
v_rcp_f16_sdwa v148, v147 dst_sel:WORD_1 dst_unused:UNUSED_PRESERVE src0_sel:WORD_1
v_fma_mix_f32 v164, v136, v136, v164 op_sel:[0,0,0] op_sel_hi:[1,1,0]
v_rcp_f16_sdwa v145, v144 dst_sel:WORD_1 dst_unused:UNUSED_PRESERVE src0_sel:WORD_1
v_fma_mix_f32 v164, v137, v137, v164 op_sel:[1,1,0] op_sel_hi:[1,1,0]
v_smfmac_f32_16x16x32_bf16 v[16:19], v[234:235], v[208:211], v246
ds_read_b128 v[228:231], v249 offset:14336
v_pk_mul_f16 v155, v155, v154
v_fma_mix_f32 v164, v138, v138, v164 op_sel:[0,0,0] op_sel_hi:[1,1,0]
v_pk_mul_f16 v152, v152, v151
v_pk_mul_f16 v149, v149, v148
v_fma_mix_f32 v164, v139, v139, v164 op_sel:[1,1,0] op_sel_hi:[1,1,0]
v_smfmac_f32_16x16x32_bf16 v[0:3], v[232:233], v[212:215], v246
s_mov_b64 exec, 1
ds_add_u32 v253, v254 offset:16
s_mov_b64 exec, -1
v_pk_mul_f16 v146, v146, v145
v_fma_mix_f32 v164, v155, v155, v164 op_sel:[0,0,0] op_sel_hi:[1,1,0]
s_waitcnt lgkmcnt(3)
v_fma_mix_f32 v164, v140, v140, v164 op_sel:[0,0,0] op_sel_hi:[1,1,0]
v_fma_mix_f32 v164, v155, v155, v164 op_sel:[1,1,0] op_sel_hi:[1,1,0]
v_fma_mix_f32 v164, v152, v152, v164 op_sel:[0,0,0] op_sel_hi:[1,1,0]
v_fma_mix_f32 v164, v141, v141, v164 op_sel:[1,1,0] op_sel_hi:[1,1,0]
v_fma_mix_f32 v164, v152, v152, v164 op_sel:[1,1,0] op_sel_hi:[1,1,0]
v_fma_mix_f32 v164, v149, v149, v164 op_sel:[0,0,0] op_sel_hi:[1,1,0]
v_fma_mix_f32 v164, v142, v142, v164 op_sel:[0,0,0] op_sel_hi:[1,1,0]
v_fma_mix_f32 v164, v149, v149, v164 op_sel:[1,1,0] op_sel_hi:[1,1,0]
v_fma_mix_f32 v164, v146, v146, v164 op_sel:[0,0,0] op_sel_hi:[1,1,0]
v_fma_mix_f32 v164, v143, v143, v164 op_sel:[1,1,0] op_sel_hi:[1,1,0]
v_fma_mix_f32 v164, v146, v146, v164 op_sel:[1,1,0] op_sel_hi:[1,1,0]
s_setprio 3
v_pk_add_f32 v[168:169], v[0:1], v[2:3]
v_pk_mul_f32 v[170:171], v[0:1], v[0:1]
v_pk_fma_f32 v[170:171], v[2:3], v[2:3], v[170:171]
v_pk_add_f32 v[168:169], v[168:169], v[4:5]
v_pk_fma_f32 v[170:171], v[4:5], v[4:5], v[170:171]
v_pk_add_f32 v[168:169], v[168:169], v[6:7]
v_pk_fma_f32 v[170:171], v[6:7], v[6:7], v[170:171]
v_pk_add_f32 v[168:169], v[168:169], v[8:9]
v_pk_fma_f32 v[170:171], v[8:9], v[8:9], v[170:171]
v_pk_add_f32 v[168:169], v[168:169], v[10:11]
v_pk_fma_f32 v[170:171], v[10:11], v[10:11], v[170:171]
v_pk_add_f32 v[168:169], v[168:169], v[12:13]
v_pk_fma_f32 v[170:171], v[12:13], v[12:13], v[170:171]
v_pk_add_f32 v[168:169], v[168:169], v[14:15]
v_pk_fma_f32 v[170:171], v[14:15], v[14:15], v[170:171]
v_pk_add_f32 v[168:169], v[168:169], v[16:17]
v_pk_fma_f32 v[170:171], v[16:17], v[16:17], v[170:171]
v_pk_add_f32 v[168:169], v[168:169], v[18:19]
v_pk_fma_f32 v[170:171], v[18:19], v[18:19], v[170:171]
v_pk_add_f32 v[168:169], v[168:169], v[20:21]
v_pk_fma_f32 v[170:171], v[20:21], v[20:21], v[170:171]
v_pk_add_f32 v[168:169], v[168:169], v[22:23]
v_pk_fma_f32 v[170:171], v[22:23], v[22:23], v[170:171]
v_pk_add_f32 v[168:169], v[168:169], v[24:25]
v_pk_fma_f32 v[170:171], v[24:25], v[24:25], v[170:171]
v_pk_add_f32 v[168:169], v[168:169], v[26:27]
v_pk_fma_f32 v[170:171], v[26:27], v[26:27], v[170:171]
v_pk_add_f32 v[168:169], v[168:169], v[28:29]
v_pk_fma_f32 v[170:171], v[28:29], v[28:29], v[170:171]
v_pk_add_f32 v[168:169], v[168:169], v[30:31]
v_pk_fma_f32 v[170:171], v[30:31], v[30:31], v[170:171]
v_pk_add_f32 v[168:169], v[168:169], v[32:33]
v_pk_fma_f32 v[170:171], v[32:33], v[32:33], v[170:171]
v_pk_add_f32 v[168:169], v[168:169], v[34:35]
v_pk_fma_f32 v[170:171], v[34:35], v[34:35], v[170:171]
v_pk_add_f32 v[168:169], v[168:169], v[36:37]
v_pk_fma_f32 v[170:171], v[36:37], v[36:37], v[170:171]
v_pk_add_f32 v[168:169], v[168:169], v[38:39]
v_pk_fma_f32 v[170:171], v[38:39], v[38:39], v[170:171]
v_pk_add_f32 v[168:169], v[168:169], v[40:41]
v_pk_fma_f32 v[170:171], v[40:41], v[40:41], v[170:171]
v_pk_add_f32 v[168:169], v[168:169], v[42:43]
v_pk_fma_f32 v[170:171], v[42:43], v[42:43], v[170:171]
v_pk_add_f32 v[168:169], v[168:169], v[44:45]
v_pk_fma_f32 v[170:171], v[44:45], v[44:45], v[170:171]
v_pk_add_f32 v[168:169], v[168:169], v[46:47]
v_pk_fma_f32 v[170:171], v[46:47], v[46:47], v[170:171]
s_setprio 0
v_lshrrev_b32 v252, 2, v251
v_mul_u32_u24 v252, 192, v252
v_and_b32 v240, 3, v251
v_lshl_add_u32 v252, v240, 4, v252
s_setprio 2
v_cvt_pkrtz_f16_f32 v137, v120, v121
v_cvt_pkrtz_f16_f32 v139, v122, v123
v_cvt_pkrtz_f16_f32 v141, v124, v125
v_cvt_pkrtz_f16_f32 v143, v126, v127
v_cvt_pkrtz_f16_f32 v145, v128, v129
v_cvt_pk_f16_f32 v155, v130, v131
v_cvt_pk_f16_f32 v152, v132, v133
v_cvt_pk_f16_f32 v149, v134, v135
ds_read_b128 v[232:235], v249 offset:17408
v_mfma_f32_32x32x16_bf16 v[120:135], v[236:239], v[96:99], 0
v_pk_fma_f16 v154, v155, v155, s48
v_add_f32 v168, v168, v169
v_and_b32 v137, s49, v137
v_pk_fma_f16 v151, v152, v152, s48
v_and_b32_e64 v139, s49, v139
v_pk_fma_f16 v148, v149, v149, s48
v_add_f32_e64 v170, v170, v171
v_pk_mul_f16 v154, v155, v154
v_bfe_u32 v136, v137, 2, 14
v_pk_mul_f16 v151, v152, v151
v_pk_mul_f16 v148, v149, v148
v_bfe_u32 v138, v139, 2, 14
ds_read_u16_d16 v136, v136
ds_read_u16_d16 v138, v138
v_mfma_f32_32x32x16_bf16 v[120:135], v[216:219], v[100:103], v[120:135]
v_permlane32_swap_b32 v168, v170
v_exp_f16 v153, v154
v_lshrrev_b32 v137, 18, v137
v_exp_f16 v150, v151
v_add_f32 v168, v168, v170
v_lshrrev_b32 v139, 18, v139
v_exp_f16 v147, v148
v_and_b32 v141, s49, v141
v_and_b32_e64 v143, s49, v143
v_mul_f32 v168, 1009429163, v168
ds_read_u16_d16_hi v137, v137
ds_read_u16_d16_hi v139, v139
v_mfma_f32_32x32x16_bf16 v[120:135], v[220:223], v[104:107], v[120:135]
v_exp_f16_sdwa v153, v154 dst_sel:WORD_1 dst_unused:UNUSED_PRESERVE src0_sel:WORD_1
v_bfe_u32 v140, v141, 2, 14
v_exp_f16_sdwa v150, v151 dst_sel:WORD_1 dst_unused:UNUSED_PRESERVE src0_sel:WORD_1
v_mov_b32_e64 v170, v168
v_bfe_u32 v142, v143, 2, 14
v_exp_f16_sdwa v147, v148 dst_sel:WORD_1 dst_unused:UNUSED_PRESERVE src0_sel:WORD_1
v_lshrrev_b32_e64 v141, 18, v141
v_permlane32_swap_b32 v168, v170
v_pk_add_f16 v153, v153, 1.0 op_sel_hi:[1,0]
s_waitcnt lgkmcnt(6)
ds_read_u16_d16 v140, v140
ds_read_u16_d16 v142, v142
ds_read_u16_d16_hi v141, v141
v_mfma_f32_32x32x16_bf16 v[120:135], v[224:227], v[108:111], v[120:135]
v_lshrrev_b32_e64 v143, 18, v143
v_pk_add_f16 v150, v150, 1.0 op_sel_hi:[1,0]
v_pk_add_f16 v147, v147, 1.0 op_sel_hi:[1,0]
v_and_b32_e64 v145, s49, v145
v_fma_f32 v170, -v168, v168, v170
v_rcp_f16_e64 v154, v153
v_bfe_u32 v144, v145, 2, 14
v_rcp_f16 v151, v150
v_max_f32 v170, 0, v170
v_lshrrev_b32_e64 v145, 18, v145
ds_read_b128 v[224:227], v249 offset:18432
ds_read_u16_d16_hi v143, v143
ds_read_u16_d16 v144, v144
ds_read_u16_d16_hi v145, v145
v_mfma_f32_32x32x16_bf16 v[120:135], v[228:231], v[112:115], v[120:135]
v_rcp_f16 v148, v147
v_rcp_f16_sdwa v154, v153 dst_sel:WORD_1 dst_unused:UNUSED_PRESERVE src0_sel:WORD_1
v_add_f32 v170, 925353388, v170
s_waitcnt lgkmcnt(7)
v_fma_mix_f32 v165, v136, v136, v165 op_sel:[0,0,0] op_sel_hi:[1,1,0]
ds_read_b32 v247, v253 offset:16
v_fma_mix_f32 v165, v137, v137, v165 op_sel:[1,1,0] op_sel_hi:[1,1,0]
v_rcp_f16_sdwa v151, v150 dst_sel:WORD_1 dst_unused:UNUSED_PRESERVE src0_sel:WORD_1
v_rsq_f32_e64 v170, v170
v_fma_mix_f32 v165, v138, v138, v165 op_sel:[0,0,0] op_sel_hi:[1,1,0]
ds_read_b128 v[228:231], v249 offset:21504
v_mfma_f32_32x32x16_bf16 v[120:135], v[232:235], v[116:119], v[120:135]
v_rcp_f16_sdwa v148, v147 dst_sel:WORD_1 dst_unused:UNUSED_PRESERVE src0_sel:WORD_1
v_fma_mix_f32 v165, v139, v139, v165 op_sel:[1,1,0] op_sel_hi:[1,1,0]
v_pk_mul_f16 v155, v155, v154
s_waitcnt lgkmcnt(6)
v_fma_mix_f32 v165, v140, v140, v165 op_sel:[0,0,0] op_sel_hi:[1,1,0]
v_pk_mul_f16 v152, v152, v151
v_fma_mix_f32 v165, v141, v141, v165 op_sel:[1,1,0] op_sel_hi:[1,1,0]
v_pk_mul_f16 v149, v149, v148
v_fma_mix_f32 v165, v155, v155, v165 op_sel:[0,0,0] op_sel_hi:[1,1,0]
v_mul_f32 v172, 3203391086, v170
v_fma_mix_f32 v165, v142, v142, v165 op_sel:[0,0,0] op_sel_hi:[1,1,0]
v_fma_mix_f32 v165, v155, v155, v165 op_sel:[1,1,0] op_sel_hi:[1,1,0]
s_waitcnt lgkmcnt(2)
v_fma_mix_f32 v165, v143, v143, v165 op_sel:[1,1,0] op_sel_hi:[1,1,0]
v_fma_mix_f32 v165, v152, v152, v165 op_sel:[0,0,0] op_sel_hi:[1,1,0]
v_fma_mix_f32 v165, v152, v152, v165 op_sel:[1,1,0] op_sel_hi:[1,1,0]
v_mul_f32 v173, v168, v172
v_fma_mix_f32 v165, v144, v144, v165 op_sel:[0,0,0] op_sel_hi:[1,1,0]
v_fma_mix_f32 v165, v149, v149, v165 op_sel:[0,0,0] op_sel_hi:[1,1,0]
v_fma_mix_f32 v165, v145, v145, v165 op_sel:[1,1,0] op_sel_hi:[1,1,0]
v_fma_mix_f32 v165, v149, v149, v165 op_sel:[1,1,0] op_sel_hi:[1,1,0]
s_setprio 3
v_pk_fma_f32 v[0:1], v[0:1], v[172:173], v[172:173] op_sel:[0,0,1] op_sel_hi:[1,0,1] neg_lo:[0,0,1] neg_hi:[0,0,1]
v_pk_fma_f32 v[2:3], v[2:3], v[172:173], v[172:173] op_sel:[0,0,1] op_sel_hi:[1,0,1] neg_lo:[0,0,1] neg_hi:[0,0,1]
v_pk_fma_f32 v[4:5], v[4:5], v[172:173], v[172:173] op_sel:[0,0,1] op_sel_hi:[1,0,1] neg_lo:[0,0,1] neg_hi:[0,0,1]
v_pk_fma_f32 v[6:7], v[6:7], v[172:173], v[172:173] op_sel:[0,0,1] op_sel_hi:[1,0,1] neg_lo:[0,0,1] neg_hi:[0,0,1]
v_pk_fma_f32 v[8:9], v[8:9], v[172:173], v[172:173] op_sel:[0,0,1] op_sel_hi:[1,0,1] neg_lo:[0,0,1] neg_hi:[0,0,1]
v_pk_fma_f32 v[10:11], v[10:11], v[172:173], v[172:173] op_sel:[0,0,1] op_sel_hi:[1,0,1] neg_lo:[0,0,1] neg_hi:[0,0,1]
v_pk_fma_f32 v[12:13], v[12:13], v[172:173], v[172:173] op_sel:[0,0,1] op_sel_hi:[1,0,1] neg_lo:[0,0,1] neg_hi:[0,0,1]
v_pk_fma_f32 v[14:15], v[14:15], v[172:173], v[172:173] op_sel:[0,0,1] op_sel_hi:[1,0,1] neg_lo:[0,0,1] neg_hi:[0,0,1]
v_pk_fma_f32 v[16:17], v[16:17], v[172:173], v[172:173] op_sel:[0,0,1] op_sel_hi:[1,0,1] neg_lo:[0,0,1] neg_hi:[0,0,1]
v_pk_fma_f32 v[18:19], v[18:19], v[172:173], v[172:173] op_sel:[0,0,1] op_sel_hi:[1,0,1] neg_lo:[0,0,1] neg_hi:[0,0,1]
v_pk_fma_f32 v[20:21], v[20:21], v[172:173], v[172:173] op_sel:[0,0,1] op_sel_hi:[1,0,1] neg_lo:[0,0,1] neg_hi:[0,0,1]
v_pk_fma_f32 v[22:23], v[22:23], v[172:173], v[172:173] op_sel:[0,0,1] op_sel_hi:[1,0,1] neg_lo:[0,0,1] neg_hi:[0,0,1]
v_pk_fma_f32 v[24:25], v[24:25], v[172:173], v[172:173] op_sel:[0,0,1] op_sel_hi:[1,0,1] neg_lo:[0,0,1] neg_hi:[0,0,1]
v_pk_fma_f32 v[26:27], v[26:27], v[172:173], v[172:173] op_sel:[0,0,1] op_sel_hi:[1,0,1] neg_lo:[0,0,1] neg_hi:[0,0,1]
v_pk_fma_f32 v[28:29], v[28:29], v[172:173], v[172:173] op_sel:[0,0,1] op_sel_hi:[1,0,1] neg_lo:[0,0,1] neg_hi:[0,0,1]
v_pk_fma_f32 v[30:31], v[30:31], v[172:173], v[172:173] op_sel:[0,0,1] op_sel_hi:[1,0,1] neg_lo:[0,0,1] neg_hi:[0,0,1]
v_pk_fma_f32 v[32:33], v[32:33], v[172:173], v[172:173] op_sel:[0,0,1] op_sel_hi:[1,0,1] neg_lo:[0,0,1] neg_hi:[0,0,1]
v_pk_fma_f32 v[34:35], v[34:35], v[172:173], v[172:173] op_sel:[0,0,1] op_sel_hi:[1,0,1] neg_lo:[0,0,1] neg_hi:[0,0,1]
v_pk_fma_f32 v[36:37], v[36:37], v[172:173], v[172:173] op_sel:[0,0,1] op_sel_hi:[1,0,1] neg_lo:[0,0,1] neg_hi:[0,0,1]
v_pk_fma_f32 v[38:39], v[38:39], v[172:173], v[172:173] op_sel:[0,0,1] op_sel_hi:[1,0,1] neg_lo:[0,0,1] neg_hi:[0,0,1]
v_pk_fma_f32 v[40:41], v[40:41], v[172:173], v[172:173] op_sel:[0,0,1] op_sel_hi:[1,0,1] neg_lo:[0,0,1] neg_hi:[0,0,1]
v_pk_fma_f32 v[42:43], v[42:43], v[172:173], v[172:173] op_sel:[0,0,1] op_sel_hi:[1,0,1] neg_lo:[0,0,1] neg_hi:[0,0,1]
v_pk_fma_f32 v[44:45], v[44:45], v[172:173], v[172:173] op_sel:[0,0,1] op_sel_hi:[1,0,1] neg_lo:[0,0,1] neg_hi:[0,0,1]
v_pk_fma_f32 v[46:47], v[46:47], v[172:173], v[172:173] op_sel:[0,0,1] op_sel_hi:[1,0,1] neg_lo:[0,0,1] neg_hi:[0,0,1]
s_setprio 2
s_waitcnt lgkmcnt(0)
v_readfirstlane_b32 s43, v247
s_nop 1
s_cmp_ge_u32 s43, 32
s_cbranch_scc1 Lev8
Lev8w:
s_sleep 1
ds_read_b32 v247, v253 offset:16
s_waitcnt lgkmcnt(0)
v_readfirstlane_b32 s43, v247
s_cmp_eq_u32 s76, 0
s_cbranch_scc1 Lev8
s_sub_u32 s76, s76, 1
s_cmp_lt_u32 s43, 32
s_cbranch_scc1 Lev8w
Lev8:
s_setprio 1
v_cvt_pkrtz_f16_f32 v137, v120, v121
v_cvt_pkrtz_f16_f32 v139, v122, v123
v_cvt_pkrtz_f16_f32 v141, v124, v125
v_cvt_pkrtz_f16_f32 v143, v126, v127
v_cvt_pkrtz_f16_f32 v145, v128, v129
v_cvt_pk_f16_f32 v155, v130, v131
v_cvt_pk_f16_f32 v152, v132, v133
v_cvt_pk_f16_f32 v149, v134, v135
s_add_u32 m0, s72, 0
s_add_u32 s43, s82, 0
buffer_load_dwordx4 v252, s[16:19], s43 offen lds
ds_read_b128 v[232:235], v249 offset:19456
ds_read_b128 v[236:239], v249 offset:22528
v_mfma_f32_32x32x16_bf16 v[120:135], v[224:227], v[96:99], 0
v_pk_fma_f16 v154, v155, v155, s48
v_and_b32 v192, 1, v251
v_cvt_pk_bf16_f32 v168, v0, v1
v_and_b32_e64 v137, s49, v137
v_pk_fma_f16 v151, v152, v152, s48
v_cvt_pk_bf16_f32 v169, v2, v3
v_lshlrev_b32 v192, 4, v192
v_and_b32 v139, s49, v139
v_pk_fma_f16 v148, v149, v149, s48
v_cvt_pk_bf16_f32 v170, v4, v5
v_pk_mul_f16 v154, v155, v154
v_mov_b32 v193, 15360
v_bfe_u32 v136, v137, 2, 14
v_pk_mul_f16 v151, v152, v151
v_cvt_pk_bf16_f32 v171, v6, v7
ds_read_b128 v[224:227], v249 offset:20480
ds_read_u16_d16 v136, v136
v_mfma_f32_32x32x16_bf16 v[120:135], v[228:231], v[100:103], v[120:135]
v_pk_mul_f16 v148, v149, v148
v_lshlrev_b32_e64 v192, v192, v193
v_bfe_u32 v138, v139, 2, 14
v_cvt_pk_bf16_f32 v172, v8, v9
v_exp_f16 v153, v154
v_lshrrev_b32 v193, 3, v251
v_cvt_pk_bf16_f32 v173, v10, v11
v_lshrrev_b32_e64 v137, 18, v137
v_exp_f16 v150, v151
v_xor_b32 v193, v193, v251
v_cvt_pk_bf16_f32 v174, v12, v13
v_lshrrev_b32 v139, 18, v139
v_exp_f16 v147, v148
s_waitcnt lgkmcnt(2)
s_add_u32 m0, s72, 1024
s_add_u32 s43, s82, 64
buffer_load_dwordx4 v252, s[16:19], s43 offen lds
ds_read_b128 v[228:231], v249 offset:23552
ds_read_u16_d16 v138, v138
ds_read_u16_d16_hi v137, v137
ds_read_u16_d16_hi v139, v139
v_mfma_f32_32x32x16_bf16 v[120:135], v[232:235], v[104:107], v[120:135]
v_and_b32_e64 v193, 4, v193
v_cvt_pk_bf16_f32 v175, v14, v15
v_and_b32_e64 v141, s49, v141
v_cvt_pk_bf16_f32 v176, v16, v17
v_and_b32_e64 v143, s49, v143
v_bfe_u32 v194, v251, 3, 2
v_exp_f16_sdwa v153, v154 dst_sel:WORD_1 dst_unused:UNUSED_PRESERVE src0_sel:WORD_1
v_cvt_pk_bf16_f32 v177, v18, v19
v_bfe_u32 v140, v141, 2, 14
v_lshl_add_u32 v193, v193, 1, 0
v_exp_f16_sdwa v150, v151 dst_sel:WORD_1 dst_unused:UNUSED_PRESERVE src0_sel:WORD_1
v_cvt_pk_bf16_f32 v178, v20, v21
v_bfe_u32 v142, v143, 2, 14
ds_read_b128 v[232:235], v248 offset:16384
ds_read_u16_d16 v140, v140
ds_read_u16_d16 v142, v142
v_mfma_f32_32x32x16_bf16 v[120:135], v[236:239], v[108:111], v[120:135]
v_lshl_add_u32 v193, v194, 1, v193
v_cvt_pk_bf16_f32 v179, v22, v23
v_exp_f16_sdwa v147, v148 dst_sel:WORD_1 dst_unused:UNUSED_PRESERVE src0_sel:WORD_1
v_lshrrev_b32_e64 v141, 18, v141
v_bfe_u32 v194, v251, 1, 1
v_cvt_pk_bf16_f32 v180, v24, v25
v_pk_add_f16 v153, v153, 1.0 op_sel_hi:[1,0]
v_lshrrev_b32_e64 v143, 18, v143
v_cvt_pk_bf16_f32 v181, v26, v27
v_add_u32_e64 v193, v193, v194
v_pk_add_f16 v150, v150, 1.0 op_sel_hi:[1,0]
v_pk_add_f16 v147, v147, 1.0 op_sel_hi:[1,0]
v_cvt_pk_bf16_f32 v182, v28, v29
v_and_b32_e64 v145, s49, v145
v_cmp_eq_u32 vcc, 0, v193
s_nop 1
v_cndmask_b32 v240, 0, v192, vcc
s_waitcnt lgkmcnt(3)
s_add_u32 m0, s72, 2048
s_add_u32 s43, s82, 128
buffer_load_dwordx4 v252, s[16:19], s43 offen lds
ds_read_b128 v[236:239], v248 offset:19456
ds_read_u16_d16_hi v141, v141
ds_read_u16_d16_hi v143, v143
v_mfma_f32_32x32x16_bf16 v[120:135], v[224:227], v[112:115], v[120:135]
v_rcp_f16_e64 v154, v153
v_cvt_pk_bf16_f32 v183, v30, v31
v_bfe_u32 v144, v145, 2, 14
v_cmp_eq_u32 vcc, 1, v193
s_nop 1
v_cndmask_b32 v241, 0, v192, vcc
v_rcp_f16_e64 v151, v150
s_setprio 0
v_cvt_pk_bf16_f32 v184, v32, v33
v_lshrrev_b32 v145, 18, v145
v_cmp_eq_u32 vcc, 2, v193
s_nop 1
v_cndmask_b32 v242, 0, v192, vcc
v_cvt_pk_bf16_f32 v185, v34, v35
v_rcp_f16_e64 v148, v147
ds_read_u16_d16 v144, v144
ds_read_u16_d16_hi v145, v145
v_or_b32 v208, v136, v137
v_cmp_eq_u32 vcc, 3, v193
s_nop 1
v_cndmask_b32 v243, 0, v192, vcc
v_cvt_pk_bf16_f32 v186, v36, v37
ds_read_b128 v[224:227], v248 offset:17408
v_mfma_f32_32x32x16_bf16 v[120:135], v[228:231], v[116:119], v[120:135]
v_or_b32 v209, v138, v139
v_rcp_f16_sdwa v154, v153 dst_sel:WORD_1 dst_unused:UNUSED_PRESERVE src0_sel:WORD_1
v_cmp_eq_u32 vcc, 4, v193
s_nop 1
v_cndmask_b32 v244, 0, v192, vcc
v_cvt_pk_bf16_f32 v187, v38, v39
s_waitcnt lgkmcnt(3)
v_or_b32 v210, v140, v141
v_cvt_pk_bf16_f32 v188, v40, v41
v_rcp_f16_sdwa v151, v150 dst_sel:WORD_1 dst_unused:UNUSED_PRESERVE src0_sel:WORD_1
v_cmp_eq_u32 vcc, 5, v193
s_nop 1
v_cndmask_b32 v245, 0, v192, vcc
v_or_b32 v211, v142, v143
v_cvt_pk_bf16_f32 v189, v42, v43
v_rcp_f16_sdwa v148, v147 dst_sel:WORD_1 dst_unused:UNUSED_PRESERVE src0_sel:WORD_1
v_cmp_eq_u32 vcc, 6, v193
s_nop 1
v_cndmask_b32 v246, 0, v192, vcc
v_cvt_pk_bf16_f32 v190, v44, v45
s_waitcnt lgkmcnt(0)
v_or_b32_e64 v212, v144, v145
v_pk_mul_f16 v213, v155, v154
v_cmp_eq_u32 vcc, 7, v193
s_nop 1
v_cndmask_b32 v247, 0, v192, vcc
v_cvt_pk_bf16_f32 v191, v46, v47
v_pk_mul_f16 v214, v152, v151
v_pk_mul_f16 v215, v149, v148
s_setprio 2
s_add_u32 m0, s72, 3072
s_add_u32 s43, s82, 3072
buffer_load_dwordx4 v252, s[16:19], s43 offen lds
ds_read_b128 v[228:231], v248 offset:20480
v_mfma_f32_32x32x16_f16 v[192:207], v[208:211], v[240:243], 0
v_cvt_pkrtz_f16_f32 v137, v120, v121
v_cvt_pkrtz_f16_f32 v139, v122, v123
v_cvt_pkrtz_f16_f32 v141, v124, v125
v_cvt_pkrtz_f16_f32 v143, v126, v127
v_cvt_pkrtz_f16_f32 v145, v128, v129
v_mfma_f32_32x32x16_f16 v[192:207], v[212:215], v[244:247], v[192:207]
v_cvt_pk_f16_f32 v155, v130, v131
v_cvt_pk_f16_f32 v152, v132, v133
v_cvt_pk_f16_f32 v149, v134, v135
v_pk_fma_f16 v154, v155, v155, s48
v_and_b32_e64 v137, s49, v137
v_pk_fma_f16 v151, v152, v152, s48
v_mfma_f32_32x32x16_bf16 v[120:135], v[232:235], v[168:171], 0
v_and_b32 v139, s49, v139
v_pk_fma_f16 v148, v149, v149, s48
v_permlane16_swap_b32 v208, v212
v_pk_mul_f16 v154, v155, v154
v_bfe_u32 v136, v137, 2, 14
v_permlane16_swap_b32 v209, v213
v_pk_mul_f16 v151, v152, v151
v_pk_mul_f16 v148, v149, v148
v_bfe_u32 v138, v139, 2, 14
v_permlane16_swap_b32 v210, v214
s_add_u32 m0, s72, 4096
s_add_u32 s43, s82, 3136
buffer_load_dwordx4 v252, s[16:19], s43 offen lds
ds_read_b128 v[232:235], v248 offset:18432
ds_read_u16_d16 v136, v136
ds_read_u16_d16 v138, v138
v_mfma_f32_32x32x16_bf16 v[120:135], v[236:239], v[172:175], v[120:135]
v_exp_f16 v153, v154
v_permlane16_swap_b32 v211, v215
v_lshrrev_b32 v137, 18, v137
v_exp_f16 v150, v151
v_fmac_f32 v166, v192, v192
v_lshrrev_b32 v139, 18, v139
v_exp_f16 v147, v148
v_fmac_f32 v166, v193, v193
v_and_b32_e64 v141, s49, v141
ds_read_b128 v[236:239], v248 offset:21504
ds_read_u16_d16_hi v137, v137
ds_read_u16_d16_hi v139, v139
v_mfma_f32_32x32x16_bf16 v[120:135], v[224:227], v[176:179], v[120:135]
v_and_b32 v143, s49, v143
v_fmac_f32 v166, v194, v194
v_exp_f16_sdwa v153, v154 dst_sel:WORD_1 dst_unused:UNUSED_PRESERVE src0_sel:WORD_1
v_bfe_u32 v140, v141, 2, 14
v_fmac_f32_e64 v166, v195, v195
v_exp_f16_sdwa v150, v151 dst_sel:WORD_1 dst_unused:UNUSED_PRESERVE src0_sel:WORD_1
v_fmac_f32 v166, v196, v196
v_bfe_u32 v142, v143, 2, 14
s_waitcnt lgkmcnt(5)
ds_read_b128 v[224:227], v248 offset:22528
ds_read_u16_d16 v140, v140
ds_read_u16_d16 v142, v142
v_mfma_f32_32x32x16_bf16 v[120:135], v[228:231], v[180:183], v[120:135]
v_exp_f16_sdwa v147, v148 dst_sel:WORD_1 dst_unused:UNUSED_PRESERVE src0_sel:WORD_1
v_fmac_f32 v166, v197, v197
v_lshrrev_b32 v141, 18, v141
v_pk_add_f16 v153, v153, 1.0 op_sel_hi:[1,0]
v_lshrrev_b32 v143, 18, v143
v_fmac_f32 v166, v198, v198
v_pk_add_f16 v150, v150, 1.0 op_sel_hi:[1,0]
v_pk_add_f16 v147, v147, 1.0 op_sel_hi:[1,0]
v_fmac_f32 v166, v199, v199
v_and_b32 v145, s49, v145
s_add_u32 m0, s72, 5120
s_add_u32 s43, s82, 3200
buffer_load_dwordx4 v252, s[16:19], s43 offen lds
ds_read_b128 v[228:231], v248 offset:25600
ds_read_u16_d16_hi v141, v141
ds_read_u16_d16_hi v143, v143
v_mfma_f32_32x32x16_bf16 v[120:135], v[232:235], v[184:187], v[120:135]
v_rcp_f16 v154, v153
v_fmac_f32 v166, v200, v200
v_bfe_u32 v144, v145, 2, 14
v_rcp_f16 v151, v150
v_fmac_f32 v166, v201, v201
v_lshrrev_b32 v145, 18, v145
v_rcp_f16 v148, v147
v_fmac_f32_e64 v166, v202, v202
ds_read_u16_d16 v144, v144
ds_read_u16_d16_hi v145, v145
s_waitcnt lgkmcnt(5)
v_or_b32 v216, v136, v137
ds_read_b128 v[232:235], v248 offset:23552
v_mfma_f32_32x32x16_bf16 v[120:135], v[236:239], v[188:191], v[120:135]
v_or_b32 v217, v138, v139
v_fmac_f32 v166, v203, v203
v_rcp_f16_sdwa v154, v153 dst_sel:WORD_1 dst_unused:UNUSED_PRESERVE src0_sel:WORD_1
v_fmac_f32 v166, v204, v204
s_waitcnt lgkmcnt(4)
v_or_b32_e64 v218, v140, v141
v_rcp_f16_sdwa v151, v150 dst_sel:WORD_1 dst_unused:UNUSED_PRESERVE src0_sel:WORD_1
v_fmac_f32 v166, v205, v205
s_waitcnt lgkmcnt(3)
v_or_b32_e64 v219, v142, v143
v_rcp_f16_sdwa v148, v147 dst_sel:WORD_1 dst_unused:UNUSED_PRESERVE src0_sel:WORD_1
v_fmac_f32 v166, v206, v206
s_waitcnt lgkmcnt(1)
v_or_b32_e64 v220, v144, v145
v_pk_mul_f16 v221, v155, v154
v_fmac_f32 v166, v207, v207
v_pk_mul_f16 v222, v152, v151
v_pk_mul_f16 v223, v149, v148
s_setprio 1
s_add_u32 m0, s72, 6144
s_add_u32 s43, s82, 6144
buffer_load_dwordx4 v252, s[16:19], s43 offen lds
ds_read_b128 v[236:239], v248 offset:26624
v_mfma_f32_32x32x16_f16 v[192:207], v[216:219], v[240:243], 0
v_cvt_pkrtz_f16_f32 v137, v120, v121
v_cvt_pkrtz_f16_f32 v139, v122, v123
v_cvt_pkrtz_f16_f32 v141, v124, v125
v_cvt_pkrtz_f16_f32 v143, v126, v127
v_cvt_pkrtz_f16_f32 v145, v128, v129
v_cvt_pk_f16_f32 v155, v130, v131
v_mfma_f32_32x32x16_f16 v[192:207], v[220:223], v[244:247], v[192:207]
v_cvt_pk_f16_f32 v152, v132, v133
v_cvt_pk_f16_f32 v149, v134, v135
v_pk_fma_f16 v154, v155, v155, s48
v_and_b32 v255, 51, v251
v_and_b32 v137, s49, v137
v_pk_fma_f16 v151, v152, v152, s48
v_mfma_f32_32x32x16_bf16 v[120:135], v[224:227], v[168:171], 0
v_and_b32 v139, s49, v139
v_pk_fma_f16 v148, v149, v149, s48
v_permlane16_swap_b32 v216, v220
v_pk_mul_f16 v154, v155, v154
v_bfe_u32 v136, v137, 2, 14
v_permlane16_swap_b32 v217, v221
v_pk_mul_f16 v151, v152, v151
v_pk_mul_f16 v148, v149, v148
v_bfe_u32 v138, v139, 2, 14
v_permlane16_swap_b32 v218, v222
v_bfe_u32 v95, v251, 2, 1
ds_read_b128 v[224:227], v248 offset:24576
ds_read_u16_d16 v136, v136
ds_read_u16_d16 v138, v138
v_mfma_f32_32x32x16_bf16 v[120:135], v[228:231], v[172:175], v[120:135]
v_exp_f16 v153, v154
v_permlane16_swap_b32 v219, v223
v_lshrrev_b32 v137, 18, v137
v_exp_f16 v150, v151
v_fmac_f32 v167, v192, v192
v_lshrrev_b32 v139, 18, v139
v_exp_f16 v147, v148
v_fmac_f32 v167, v193, v193
v_and_b32_e64 v141, s49, v141
v_and_b32 v143, s49, v143
s_waitcnt lgkmcnt(3)
ds_read_b128 v[228:231], v248 offset:27648
ds_read_u16_d16_hi v137, v137
ds_read_u16_d16_hi v139, v139
v_mfma_f32_32x32x16_bf16 v[120:135], v[232:235], v[176:179], v[120:135]
v_lshl_add_u32 v255, v95, 3, v255
v_fmac_f32_e64 v167, v194, v194
v_exp_f16_sdwa v153, v154 dst_sel:WORD_1 dst_unused:UNUSED_PRESERVE src0_sel:WORD_1
v_bfe_u32 v140, v141, 2, 14
v_fmac_f32_e64 v167, v195, v195
v_exp_f16_sdwa v150, v151 dst_sel:WORD_1 dst_unused:UNUSED_PRESERVE src0_sel:WORD_1
v_fmac_f32_e64 v167, v196, v196
v_bfe_u32 v142, v143, 2, 14
v_exp_f16_sdwa v147, v148 dst_sel:WORD_1 dst_unused:UNUSED_PRESERVE src0_sel:WORD_1
ds_read_b128 v[232:235], v248 offset:28672
ds_read_u16_d16 v140, v140
ds_read_u16_d16 v142, v142
v_mfma_f32_32x32x16_bf16 v[120:135], v[236:239], v[180:183], v[120:135]
v_fmac_f32 v167, v197, v197
v_lshrrev_b32 v141, 18, v141
v_bfe_u32 v95, v251, 3, 1
v_pk_add_f16 v153, v153, 1.0 op_sel_hi:[1,0]
v_lshrrev_b32 v143, 18, v143
v_fmac_f32 v167, v198, v198
v_pk_add_f16 v150, v150, 1.0 op_sel_hi:[1,0]
v_pk_add_f16 v147, v147, 1.0 op_sel_hi:[1,0]
v_fmac_f32 v167, v199, v199
v_and_b32 v145, s49, v145
v_rcp_f16 v154, v153
s_waitcnt lgkmcnt(3)
ds_read_b128 v[236:239], v248 offset:31744
ds_read_u16_d16_hi v141, v141
ds_read_u16_d16_hi v143, v143
v_mfma_f32_32x32x16_bf16 v[120:135], v[224:227], v[184:187], v[120:135]
v_fmac_f32_e64 v167, v200, v200
v_bfe_u32 v144, v145, 2, 14
v_rcp_f16 v151, v150
s_setprio 0
v_lshl_add_u32 v255, v95, 2, v255
v_fmac_f32 v167, v201, v201
v_lshrrev_b32 v145, 18, v145
v_rcp_f16 v148, v147
v_fmac_f32 v167, v202, v202
ds_read_u16_d16 v144, v144
ds_read_u16_d16_hi v145, v145
v_or_b32 v0, v136, v137
v_or_b32 v1, v138, v139
ds_read_b128 v[224:227], v248 offset:29696
v_mfma_f32_32x32x16_bf16 v[120:135], v[228:231], v[188:191], v[120:135]
v_fmac_f32_e64 v167, v203, v203
v_rcp_f16_sdwa v154, v153 dst_sel:WORD_1 dst_unused:UNUSED_PRESERVE src0_sel:WORD_1
v_fmac_f32 v167, v204, v204
s_waitcnt lgkmcnt(4)
v_or_b32_e64 v2, v140, v141
v_lshl_add_u32 v255, v255, 2, s72
v_rcp_f16_sdwa v151, v150 dst_sel:WORD_1 dst_unused:UNUSED_PRESERVE src0_sel:WORD_1
v_fmac_f32 v167, v205, v205
s_waitcnt lgkmcnt(3)
v_or_b32_e64 v3, v142, v143
v_rcp_f16_sdwa v148, v147 dst_sel:WORD_1 dst_unused:UNUSED_PRESERVE src0_sel:WORD_1
v_fmac_f32 v167, v206, v206
s_waitcnt lgkmcnt(1)
v_or_b32_e64 v4, v144, v145
v_pk_mul_f16 v5, v155, v154
v_fmac_f32 v167, v207, v207
v_pk_mul_f16 v6, v152, v151
v_pk_mul_f16 v7, v149, v148
s_setprio 2
ds_read_b128 v[228:231], v248 offset:32768
v_mfma_f32_32x32x16_f16 v[192:207], v[0:3], v[240:243], 0
v_cvt_pkrtz_f16_f32 v137, v120, v121
v_cvt_pkrtz_f16_f32 v139, v122, v123
v_cvt_pkrtz_f16_f32 v141, v124, v125
v_cvt_pkrtz_f16_f32 v143, v126, v127
v_cvt_pkrtz_f16_f32 v145, v128, v129
v_mfma_f32_32x32x16_f16 v[192:207], v[4:7], v[244:247], v[192:207]
v_cvt_pk_f16_f32 v155, v130, v131
v_cvt_pk_f16_f32 v152, v132, v133
v_cvt_pk_f16_f32 v149, v134, v135
v_pk_fma_f16 v154, v155, v155, s48
v_and_b32_e64 v137, s49, v137
v_pk_fma_f16 v151, v152, v152, s48
v_mfma_f32_32x32x16_bf16 v[120:135], v[232:235], v[168:171], 0
v_and_b32 v139, s49, v139
v_pk_fma_f16 v148, v149, v149, s48
v_permlane16_swap_b32 v0, v4
v_pk_mul_f16 v154, v155, v154
v_bfe_u32 v136, v137, 2, 14
v_permlane16_swap_b32 v1, v5
v_pk_mul_f16 v151, v152, v151
v_pk_mul_f16 v148, v149, v148
v_bfe_u32 v138, v139, 2, 14
v_permlane16_swap_b32 v2, v6
ds_read_b128 v[232:235], v248 offset:30720
ds_read_u16_d16 v136, v136
ds_read_u16_d16 v138, v138
v_mfma_f32_32x32x16_bf16 v[120:135], v[236:239], v[172:175], v[120:135]
v_exp_f16 v153, v154
v_permlane16_swap_b32 v3, v7
v_lshrrev_b32 v137, 18, v137
v_exp_f16 v150, v151
v_fmac_f32 v156, v192, v192
v_lshrrev_b32 v139, 18, v139
v_exp_f16 v147, v148
v_fmac_f32 v156, v193, v193
v_and_b32 v141, s49, v141
s_waitcnt lgkmcnt(3)
ds_read_b128 v[236:239], v248 offset:33792
ds_read_u16_d16_hi v137, v137
ds_read_u16_d16_hi v139, v139
v_mfma_f32_32x32x16_bf16 v[120:135], v[224:227], v[176:179], v[120:135]
v_and_b32 v143, s49, v143
v_fmac_f32 v156, v194, v194
v_exp_f16_sdwa v153, v154 dst_sel:WORD_1 dst_unused:UNUSED_PRESERVE src0_sel:WORD_1
v_bfe_u32 v140, v141, 2, 14
v_fmac_f32_e64 v156, v195, v195
v_exp_f16_sdwa v150, v151 dst_sel:WORD_1 dst_unused:UNUSED_PRESERVE src0_sel:WORD_1
v_fmac_f32_e64 v156, v196, v196
v_bfe_u32 v142, v143, 2, 14
ds_read_b128 v[224:227], v248 offset:34816
ds_read_u16_d16 v140, v140
ds_read_u16_d16 v142, v142
v_mfma_f32_32x32x16_bf16 v[120:135], v[228:231], v[180:183], v[120:135]
v_exp_f16_sdwa v147, v148 dst_sel:WORD_1 dst_unused:UNUSED_PRESERVE src0_sel:WORD_1
v_fmac_f32 v156, v197, v197
v_lshrrev_b32 v141, 18, v141
v_pk_add_f16 v153, v153, 1.0 op_sel_hi:[1,0]
v_lshrrev_b32 v143, 18, v143
v_fmac_f32 v156, v198, v198
v_pk_add_f16 v150, v150, 1.0 op_sel_hi:[1,0]
v_pk_add_f16 v147, v147, 1.0 op_sel_hi:[1,0]
v_fmac_f32_e64 v156, v199, v199
v_and_b32 v145, s49, v145
s_waitcnt lgkmcnt(4)
ds_read_b128 v[228:231], v248 offset:37888
ds_read_u16_d16_hi v141, v141
ds_read_u16_d16_hi v143, v143
v_mfma_f32_32x32x16_bf16 v[120:135], v[232:235], v[184:187], v[120:135]
v_rcp_f16 v154, v153
v_fmac_f32 v156, v200, v200
v_bfe_u32 v144, v145, 2, 14
v_rcp_f16 v151, v150
v_fmac_f32 v156, v201, v201
v_lshrrev_b32 v145, 18, v145
v_rcp_f16 v148, v147
v_fmac_f32_e64 v156, v202, v202
ds_read_u16_d16 v144, v144
ds_read_u16_d16_hi v145, v145
v_or_b32_e64 v8, v136, v137
ds_read_b128 v[232:235], v248 offset:35840
v_mfma_f32_32x32x16_bf16 v[120:135], v[236:239], v[188:191], v[120:135]
s_waitcnt lgkmcnt(6)
v_or_b32 v9, v138, v139
v_fmac_f32_e64 v156, v203, v203
v_rcp_f16_sdwa v154, v153 dst_sel:WORD_1 dst_unused:UNUSED_PRESERVE src0_sel:WORD_1
v_fmac_f32 v156, v204, v204
s_waitcnt lgkmcnt(4)
v_or_b32_e64 v10, v140, v141
v_rcp_f16_sdwa v151, v150 dst_sel:WORD_1 dst_unused:UNUSED_PRESERVE src0_sel:WORD_1
v_fmac_f32 v156, v205, v205
s_waitcnt lgkmcnt(3)
v_or_b32_e64 v11, v142, v143
v_rcp_f16_sdwa v148, v147 dst_sel:WORD_1 dst_unused:UNUSED_PRESERVE src0_sel:WORD_1
v_fmac_f32 v156, v206, v206
s_waitcnt lgkmcnt(1)
v_or_b32_e64 v12, v144, v145
v_pk_mul_f16 v13, v155, v154
v_fmac_f32_e64 v156, v207, v207
v_pk_mul_f16 v14, v152, v151
v_pk_mul_f16 v15, v149, v148
s_cmp_lg_u32 s40, 0
s_cbranch_scc1 Lrs0
v_mov_b32 v90, 0
buffer_load_dword v91, v90, s[36:39], 0 offen sc1
Lrs0:
s_setprio 1
ds_read_b128 v[236:239], v248 offset:38912
v_mfma_f32_32x32x16_f16 v[192:207], v[8:11], v[240:243], 0
v_cvt_pkrtz_f16_f32 v137, v120, v121
v_cvt_pkrtz_f16_f32 v139, v122, v123
v_cvt_pkrtz_f16_f32 v141, v124, v125
v_cvt_pkrtz_f16_f32 v143, v126, v127
v_cvt_pkrtz_f16_f32 v145, v128, v129
v_mfma_f32_32x32x16_f16 v[192:207], v[12:15], v[244:247], v[192:207]
v_cvt_pk_f16_f32 v155, v130, v131
v_cvt_pk_f16_f32 v152, v132, v133
v_cvt_pk_f16_f32 v149, v134, v135
v_pk_fma_f16 v154, v155, v155, s48
v_and_b32_e64 v137, s49, v137
v_pk_fma_f16 v151, v152, v152, s48
v_mfma_f32_32x32x16_bf16 v[120:135], v[224:227], v[168:171], 0
v_and_b32 v139, s49, v139
v_pk_fma_f16 v148, v149, v149, s48
v_permlane16_swap_b32 v8, v12
v_pk_mul_f16 v154, v155, v154
v_bfe_u32 v136, v137, 2, 14
v_permlane16_swap_b32 v9, v13
v_pk_mul_f16 v151, v152, v151
v_pk_mul_f16 v148, v149, v148
v_permlane16_swap_b32 v10, v14
v_bfe_u32 v138, v139, 2, 14
ds_read_b128 v[224:227], v248 offset:36864
ds_read_u16_d16 v136, v136
ds_read_u16_d16 v138, v138
v_mfma_f32_32x32x16_bf16 v[120:135], v[228:231], v[172:175], v[120:135]
v_exp_f16 v153, v154
v_permlane16_swap_b32 v11, v15
v_lshrrev_b32 v137, 18, v137
v_exp_f16 v150, v151
v_fmac_f32 v157, v192, v192
v_lshrrev_b32 v139, 18, v139
v_fmac_f32 v157, v193, v193
v_exp_f16 v147, v148
v_and_b32_e64 v141, s49, v141
v_fmac_f32 v157, v194, v194
s_waitcnt lgkmcnt(3)
ds_read_b128 v[228:231], v248 offset:39936
ds_read_u16_d16_hi v137, v137
ds_read_u16_d16_hi v139, v139
v_mfma_f32_32x32x16_bf16 v[120:135], v[232:235], v[176:179], v[120:135]
v_and_b32_e64 v143, s49, v143
v_exp_f16_sdwa v153, v154 dst_sel:WORD_1 dst_unused:UNUSED_PRESERVE src0_sel:WORD_1
v_fmac_f32_e64 v157, v195, v195
v_bfe_u32 v140, v141, 2, 14
v_fmac_f32_e64 v157, v196, v196
v_exp_f16_sdwa v150, v151 dst_sel:WORD_1 dst_unused:UNUSED_PRESERVE src0_sel:WORD_1
v_bfe_u32 v142, v143, 2, 14
v_fmac_f32_e64 v157, v197, v197
ds_read_b128 v[232:235], v248 offset:40960
ds_read_u16_d16 v140, v140
ds_read_u16_d16 v142, v142
v_mfma_f32_32x32x16_bf16 v[120:135], v[236:239], v[180:183], v[120:135]
v_exp_f16_sdwa v147, v148 dst_sel:WORD_1 dst_unused:UNUSED_PRESERVE src0_sel:WORD_1
v_fmac_f32 v157, v198, v198
v_lshrrev_b32 v141, 18, v141
v_pk_add_f16 v153, v153, 1.0 op_sel_hi:[1,0]
v_lshrrev_b32 v143, 18, v143
v_fmac_f32 v157, v199, v199
v_pk_add_f16 v150, v150, 1.0 op_sel_hi:[1,0]
v_pk_add_f16 v147, v147, 1.0 op_sel_hi:[1,0]
v_fmac_f32 v157, v200, v200
v_and_b32 v145, s49, v145
v_rcp_f16 v154, v153
s_waitcnt lgkmcnt(3)
ds_read_b128 v[236:239], v248 offset:44032
ds_read_u16_d16_hi v141, v141
ds_read_u16_d16_hi v143, v143
v_mfma_f32_32x32x16_bf16 v[120:135], v[224:227], v[184:187], v[120:135]
v_fmac_f32_e64 v157, v201, v201
v_bfe_u32 v144, v145, 2, 14
v_rcp_f16 v151, v150
s_setprio 0
v_fmac_f32 v157, v202, v202
v_lshrrev_b32 v145, 18, v145
v_fmac_f32 v157, v203, v203
v_rcp_f16 v148, v147
v_fmac_f32_e64 v157, v204, v204
ds_read_u16_d16 v144, v144
ds_read_u16_d16_hi v145, v145
v_or_b32_e64 v16, v136, v137
ds_read_b128 v[224:227], v248 offset:41984
v_mfma_f32_32x32x16_bf16 v[120:135], v[228:231], v[188:191], v[120:135]
v_or_b32_e64 v17, v138, v139
v_rcp_f16_sdwa v154, v153 dst_sel:WORD_1 dst_unused:UNUSED_PRESERVE src0_sel:WORD_1
v_fmac_f32 v157, v205, v205
s_waitcnt lgkmcnt(4)
v_or_b32 v18, v140, v141
v_fmac_f32 v157, v206, v206
v_rcp_f16_sdwa v151, v150 dst_sel:WORD_1 dst_unused:UNUSED_PRESERVE src0_sel:WORD_1
v_fmac_f32 v157, v207, v207
s_waitcnt lgkmcnt(3)
v_or_b32_e64 v19, v142, v143
v_rcp_f16_sdwa v148, v147 dst_sel:WORD_1 dst_unused:UNUSED_PRESERVE src0_sel:WORD_1
v_permlane32_swap_b32 v156, v157
s_waitcnt lgkmcnt(1)
v_or_b32_e64 v20, v144, v145
v_pk_mul_f16 v21, v155, v154
v_add_f32 v156, v156, v157
ds_write_b32 v255, v156 offset:7168
v_pk_mul_f16 v22, v152, v151
v_pk_mul_f16 v23, v149, v148
s_setprio 2
ds_read_b128 v[228:231], v248 offset:45056
v_mfma_f32_32x32x16_f16 v[192:207], v[16:19], v[240:243], 0
v_cvt_pkrtz_f16_f32 v137, v120, v121
v_cvt_pkrtz_f16_f32 v139, v122, v123
v_cvt_pkrtz_f16_f32 v141, v124, v125
v_cvt_pkrtz_f16_f32 v143, v126, v127
v_cvt_pkrtz_f16_f32 v145, v128, v129
v_mfma_f32_32x32x16_f16 v[192:207], v[20:23], v[244:247], v[192:207]
v_cvt_pk_f16_f32 v155, v130, v131
v_cvt_pk_f16_f32 v152, v132, v133
v_cvt_pk_f16_f32 v149, v134, v135
v_pk_fma_f16 v154, v155, v155, s48
v_and_b32_e64 v137, s49, v137
v_pk_fma_f16 v151, v152, v152, s48
v_mfma_f32_32x32x16_bf16 v[120:135], v[232:235], v[168:171], 0
v_and_b32 v139, s49, v139
v_pk_fma_f16 v148, v149, v149, s48
v_permlane16_swap_b32 v16, v20
v_pk_mul_f16 v154, v155, v154
v_bfe_u32 v136, v137, 2, 14
v_permlane16_swap_b32 v17, v21
v_pk_mul_f16 v151, v152, v151
v_pk_mul_f16 v148, v149, v148
v_bfe_u32 v138, v139, 2, 14
v_permlane16_swap_b32 v18, v22
ds_read_b128 v[232:235], v248 offset:43008
ds_read_u16_d16 v136, v136
ds_read_u16_d16 v138, v138
v_mfma_f32_32x32x16_bf16 v[120:135], v[236:239], v[172:175], v[120:135]
v_exp_f16 v153, v154
v_permlane16_swap_b32 v19, v23
v_lshrrev_b32 v137, 18, v137
v_exp_f16 v150, v151
v_fmac_f32 v158, v192, v192
v_lshrrev_b32 v139, 18, v139
v_exp_f16 v147, v148
v_fmac_f32 v158, v193, v193
v_and_b32 v141, s49, v141
s_waitcnt lgkmcnt(5)
ds_read_b128 v[236:239], v248 offset:46080
ds_read_u16_d16_hi v137, v137
ds_read_u16_d16_hi v139, v139
v_mfma_f32_32x32x16_bf16 v[120:135], v[224:227], v[176:179], v[120:135]
v_and_b32 v143, s49, v143
v_fmac_f32 v158, v194, v194
v_exp_f16_sdwa v153, v154 dst_sel:WORD_1 dst_unused:UNUSED_PRESERVE src0_sel:WORD_1
v_bfe_u32 v140, v141, 2, 14
v_fmac_f32_e64 v158, v195, v195
v_exp_f16_sdwa v150, v151 dst_sel:WORD_1 dst_unused:UNUSED_PRESERVE src0_sel:WORD_1
v_fmac_f32 v158, v196, v196
v_bfe_u32 v142, v143, 2, 14
s_waitcnt lgkmcnt(4)
ds_read_b128 v[224:227], v248 offset:47104
ds_read_u16_d16 v140, v140
ds_read_u16_d16 v142, v142
v_mfma_f32_32x32x16_bf16 v[120:135], v[228:231], v[180:183], v[120:135]
v_exp_f16_sdwa v147, v148 dst_sel:WORD_1 dst_unused:UNUSED_PRESERVE src0_sel:WORD_1
v_fmac_f32 v158, v197, v197
v_lshrrev_b32 v141, 18, v141
v_pk_add_f16 v153, v153, 1.0 op_sel_hi:[1,0]
v_lshrrev_b32 v143, 18, v143
v_fmac_f32 v158, v198, v198
v_pk_add_f16 v150, v150, 1.0 op_sel_hi:[1,0]
v_pk_add_f16 v147, v147, 1.0 op_sel_hi:[1,0]
v_fmac_f32 v158, v199, v199
v_and_b32 v145, s49, v145
ds_read_b128 v[228:231], v248 offset:50176
ds_read_u16_d16_hi v141, v141
ds_read_u16_d16_hi v143, v143
v_mfma_f32_32x32x16_bf16 v[120:135], v[232:235], v[184:187], v[120:135]
v_rcp_f16 v154, v153
v_fmac_f32 v158, v200, v200
v_bfe_u32 v144, v145, 2, 14
v_rcp_f16 v151, v150
v_fmac_f32 v158, v201, v201
v_lshrrev_b32 v145, 18, v145
v_rcp_f16 v148, v147
v_fmac_f32_e64 v158, v202, v202
ds_read_u16_d16 v144, v144
ds_read_u16_d16_hi v145, v145
s_waitcnt lgkmcnt(5)
v_or_b32 v24, v136, v137
ds_read_b128 v[232:235], v248 offset:48128
v_mfma_f32_32x32x16_bf16 v[120:135], v[236:239], v[188:191], v[120:135]
v_or_b32 v25, v138, v139
v_fmac_f32 v158, v203, v203
v_rcp_f16_sdwa v154, v153 dst_sel:WORD_1 dst_unused:UNUSED_PRESERVE src0_sel:WORD_1
v_fmac_f32 v158, v204, v204
s_waitcnt lgkmcnt(4)
v_or_b32_e64 v26, v140, v141
v_rcp_f16_sdwa v151, v150 dst_sel:WORD_1 dst_unused:UNUSED_PRESERVE src0_sel:WORD_1
v_fmac_f32 v158, v205, v205
s_waitcnt lgkmcnt(3)
v_or_b32_e64 v27, v142, v143
v_rcp_f16_sdwa v148, v147 dst_sel:WORD_1 dst_unused:UNUSED_PRESERVE src0_sel:WORD_1
v_fmac_f32 v158, v206, v206
s_waitcnt lgkmcnt(1)
v_or_b32_e64 v28, v144, v145
v_pk_mul_f16 v29, v155, v154
v_fmac_f32 v158, v207, v207
v_pk_mul_f16 v30, v152, v151
v_pk_mul_f16 v31, v149, v148
s_setprio 1
ds_read_b128 v[236:239], v248 offset:51200
v_mfma_f32_32x32x16_f16 v[192:207], v[24:27], v[240:243], 0
v_cvt_pkrtz_f16_f32 v137, v120, v121
v_cvt_pkrtz_f16_f32 v139, v122, v123
v_cvt_pkrtz_f16_f32 v141, v124, v125
v_cvt_pkrtz_f16_f32 v143, v126, v127
v_cvt_pkrtz_f16_f32 v145, v128, v129
v_mfma_f32_32x32x16_f16 v[192:207], v[28:31], v[244:247], v[192:207]
v_cvt_pk_f16_f32 v155, v130, v131
v_cvt_pk_f16_f32 v152, v132, v133
v_cvt_pk_f16_f32 v149, v134, v135
v_pk_fma_f16 v154, v155, v155, s48
v_and_b32_e64 v137, s49, v137
v_pk_fma_f16 v151, v152, v152, s48
v_mfma_f32_32x32x16_bf16 v[120:135], v[224:227], v[168:171], 0
v_and_b32 v139, s49, v139
v_pk_fma_f16 v148, v149, v149, s48
v_permlane16_swap_b32 v24, v28
v_pk_mul_f16 v154, v155, v154
v_bfe_u32 v136, v137, 2, 14
v_permlane16_swap_b32 v25, v29
v_pk_mul_f16 v151, v152, v151
v_pk_mul_f16 v148, v149, v148
v_permlane16_swap_b32 v26, v30
v_bfe_u32 v138, v139, 2, 14
ds_read_b128 v[224:227], v248 offset:49152
ds_read_u16_d16 v136, v136
ds_read_u16_d16 v138, v138
v_mfma_f32_32x32x16_bf16 v[120:135], v[228:231], v[172:175], v[120:135]
v_exp_f16 v153, v154
v_permlane16_swap_b32 v27, v31
v_lshrrev_b32 v137, 18, v137
v_exp_f16 v150, v151
v_fmac_f32 v159, v192, v192
v_lshrrev_b32 v139, 18, v139
v_fmac_f32 v159, v193, v193
v_exp_f16 v147, v148
v_and_b32_e64 v141, s49, v141
v_fmac_f32 v159, v194, v194
s_waitcnt lgkmcnt(3)
ds_read_b128 v[228:231], v248 offset:52224
ds_read_u16_d16_hi v137, v137
ds_read_u16_d16_hi v139, v139
v_mfma_f32_32x32x16_bf16 v[120:135], v[232:235], v[176:179], v[120:135]
v_and_b32_e64 v143, s49, v143
v_exp_f16_sdwa v153, v154 dst_sel:WORD_1 dst_unused:UNUSED_PRESERVE src0_sel:WORD_1
v_fmac_f32_e64 v159, v195, v195
v_bfe_u32 v140, v141, 2, 14
v_fmac_f32_e64 v159, v196, v196
v_exp_f16_sdwa v150, v151 dst_sel:WORD_1 dst_unused:UNUSED_PRESERVE src0_sel:WORD_1
v_bfe_u32 v142, v143, 2, 14
v_fmac_f32_e64 v159, v197, v197
ds_read_b128 v[232:235], v248 offset:53248
ds_read_u16_d16 v140, v140
ds_read_u16_d16 v142, v142
v_mfma_f32_32x32x16_bf16 v[120:135], v[236:239], v[180:183], v[120:135]
v_exp_f16_sdwa v147, v148 dst_sel:WORD_1 dst_unused:UNUSED_PRESERVE src0_sel:WORD_1
v_fmac_f32 v159, v198, v198
v_lshrrev_b32 v141, 18, v141
v_pk_add_f16 v153, v153, 1.0 op_sel_hi:[1,0]
v_lshrrev_b32 v143, 18, v143
v_fmac_f32 v159, v199, v199
v_pk_add_f16 v150, v150, 1.0 op_sel_hi:[1,0]
v_pk_add_f16 v147, v147, 1.0 op_sel_hi:[1,0]
v_fmac_f32 v159, v200, v200
v_and_b32 v145, s49, v145
v_rcp_f16 v154, v153
s_waitcnt lgkmcnt(3)
ds_read_b128 v[236:239], v248 offset:56320
ds_read_u16_d16_hi v141, v141
ds_read_u16_d16_hi v143, v143
v_mfma_f32_32x32x16_bf16 v[120:135], v[224:227], v[184:187], v[120:135]
v_fmac_f32_e64 v159, v201, v201
v_bfe_u32 v144, v145, 2, 14
v_rcp_f16 v151, v150
s_setprio 0
v_fmac_f32 v159, v202, v202
v_lshrrev_b32 v145, 18, v145
v_fmac_f32 v159, v203, v203
v_rcp_f16 v148, v147
v_fmac_f32_e64 v159, v204, v204
ds_read_u16_d16 v144, v144
ds_read_u16_d16_hi v145, v145
v_or_b32_e64 v32, v136, v137
ds_read_b128 v[224:227], v248 offset:54272
v_mfma_f32_32x32x16_bf16 v[120:135], v[228:231], v[188:191], v[120:135]
v_or_b32_e64 v33, v138, v139
v_rcp_f16_sdwa v154, v153 dst_sel:WORD_1 dst_unused:UNUSED_PRESERVE src0_sel:WORD_1
v_fmac_f32 v159, v205, v205
s_waitcnt lgkmcnt(4)
v_or_b32 v34, v140, v141
v_fmac_f32 v159, v206, v206
v_rcp_f16_sdwa v151, v150 dst_sel:WORD_1 dst_unused:UNUSED_PRESERVE src0_sel:WORD_1
v_fmac_f32 v159, v207, v207
s_waitcnt lgkmcnt(3)
v_or_b32_e64 v35, v142, v143
v_rcp_f16_sdwa v148, v147 dst_sel:WORD_1 dst_unused:UNUSED_PRESERVE src0_sel:WORD_1
v_permlane32_swap_b32 v158, v159
s_waitcnt lgkmcnt(1)
v_or_b32_e64 v36, v144, v145
v_pk_mul_f16 v37, v155, v154
v_add_f32 v158, v158, v159
ds_write_b32 v255, v158 offset:7424
v_pk_mul_f16 v38, v152, v151
v_pk_mul_f16 v39, v149, v148
s_setprio 2
ds_read_b128 v[228:231], v248 offset:57344
v_mfma_f32_32x32x16_f16 v[192:207], v[32:35], v[240:243], 0
v_cvt_pkrtz_f16_f32 v137, v120, v121
v_cvt_pkrtz_f16_f32 v139, v122, v123
v_cvt_pkrtz_f16_f32 v141, v124, v125
v_cvt_pkrtz_f16_f32 v143, v126, v127
v_cvt_pkrtz_f16_f32 v145, v128, v129
v_mfma_f32_32x32x16_f16 v[192:207], v[36:39], v[244:247], v[192:207]
v_cvt_pk_f16_f32 v155, v130, v131
v_cvt_pk_f16_f32 v152, v132, v133
v_cvt_pk_f16_f32 v149, v134, v135
v_pk_fma_f16 v154, v155, v155, s48
v_and_b32_e64 v137, s49, v137
v_pk_fma_f16 v151, v152, v152, s48
v_mfma_f32_32x32x16_bf16 v[120:135], v[232:235], v[168:171], 0
v_and_b32 v139, s49, v139
v_pk_fma_f16 v148, v149, v149, s48
v_permlane16_swap_b32 v32, v36
v_pk_mul_f16 v154, v155, v154
v_bfe_u32 v136, v137, 2, 14
v_permlane16_swap_b32 v33, v37
v_pk_mul_f16 v151, v152, v151
v_pk_mul_f16 v148, v149, v148
v_bfe_u32 v138, v139, 2, 14
v_permlane16_swap_b32 v34, v38
ds_read_b128 v[232:235], v248 offset:55296
ds_read_u16_d16 v136, v136
ds_read_u16_d16 v138, v138
v_mfma_f32_32x32x16_bf16 v[120:135], v[236:239], v[172:175], v[120:135]
v_exp_f16 v153, v154
v_permlane16_swap_b32 v35, v39
v_lshrrev_b32 v137, 18, v137
v_exp_f16 v150, v151
v_fmac_f32 v160, v192, v192
v_lshrrev_b32 v139, 18, v139
v_exp_f16 v147, v148
v_fmac_f32 v160, v193, v193
v_and_b32 v141, s49, v141
s_waitcnt lgkmcnt(5)
ds_read_b128 v[236:239], v248 offset:58368
ds_read_u16_d16_hi v137, v137
ds_read_u16_d16_hi v139, v139
v_mfma_f32_32x32x16_bf16 v[120:135], v[224:227], v[176:179], v[120:135]
v_and_b32 v143, s49, v143
v_fmac_f32 v160, v194, v194
v_exp_f16_sdwa v153, v154 dst_sel:WORD_1 dst_unused:UNUSED_PRESERVE src0_sel:WORD_1
v_bfe_u32 v140, v141, 2, 14
v_fmac_f32_e64 v160, v195, v195
v_exp_f16_sdwa v150, v151 dst_sel:WORD_1 dst_unused:UNUSED_PRESERVE src0_sel:WORD_1
v_fmac_f32 v160, v196, v196
v_bfe_u32 v142, v143, 2, 14
s_waitcnt lgkmcnt(4)
ds_read_b128 v[224:227], v248 offset:59392
ds_read_u16_d16 v140, v140
ds_read_u16_d16 v142, v142
v_mfma_f32_32x32x16_bf16 v[120:135], v[228:231], v[180:183], v[120:135]
v_exp_f16_sdwa v147, v148 dst_sel:WORD_1 dst_unused:UNUSED_PRESERVE src0_sel:WORD_1
v_fmac_f32 v160, v197, v197
v_lshrrev_b32 v141, 18, v141
v_pk_add_f16 v153, v153, 1.0 op_sel_hi:[1,0]
v_lshrrev_b32 v143, 18, v143
v_fmac_f32 v160, v198, v198
v_pk_add_f16 v150, v150, 1.0 op_sel_hi:[1,0]
v_pk_add_f16 v147, v147, 1.0 op_sel_hi:[1,0]
v_fmac_f32 v160, v199, v199
v_and_b32 v145, s49, v145
ds_read_b128 v[228:231], v248 offset:62464
ds_read_u16_d16_hi v141, v141
ds_read_u16_d16_hi v143, v143
v_mfma_f32_32x32x16_bf16 v[120:135], v[232:235], v[184:187], v[120:135]
v_rcp_f16 v154, v153
v_fmac_f32 v160, v200, v200
v_bfe_u32 v144, v145, 2, 14
v_rcp_f16 v151, v150
v_fmac_f32 v160, v201, v201
v_lshrrev_b32 v145, 18, v145
v_rcp_f16 v148, v147
v_fmac_f32_e64 v160, v202, v202
ds_read_u16_d16 v144, v144
ds_read_u16_d16_hi v145, v145
s_waitcnt lgkmcnt(5)
v_or_b32 v40, v136, v137
ds_read_b128 v[232:235], v248 offset:60416
v_mfma_f32_32x32x16_bf16 v[120:135], v[236:239], v[188:191], v[120:135]
v_or_b32 v41, v138, v139
v_fmac_f32 v160, v203, v203
v_rcp_f16_sdwa v154, v153 dst_sel:WORD_1 dst_unused:UNUSED_PRESERVE src0_sel:WORD_1
v_fmac_f32 v160, v204, v204
s_waitcnt lgkmcnt(4)
v_or_b32_e64 v42, v140, v141
v_rcp_f16_sdwa v151, v150 dst_sel:WORD_1 dst_unused:UNUSED_PRESERVE src0_sel:WORD_1
v_fmac_f32 v160, v205, v205
s_waitcnt lgkmcnt(3)
v_or_b32_e64 v43, v142, v143
v_rcp_f16_sdwa v148, v147 dst_sel:WORD_1 dst_unused:UNUSED_PRESERVE src0_sel:WORD_1
v_fmac_f32 v160, v206, v206
s_waitcnt lgkmcnt(1)
v_or_b32_e64 v44, v144, v145
v_pk_mul_f16 v45, v155, v154
v_fmac_f32_e64 v160, v207, v207
v_pk_mul_f16 v46, v152, v151
v_pk_mul_f16 v47, v149, v148
s_cmp_lg_u32 s40, 0
s_cbranch_scc1 Lrs1
v_mov_b32 v90, 0
Lpi:
s_waitcnt vmcnt(0)
v_readfirstlane_b32 s43, v91
s_cmp_eq_u32 s76, 0
s_cbranch_scc1 Lpix
s_sub_u32 s76, s76, 1
s_cmp_ge_u32 s43, 256
s_cbranch_scc1 Lpix
buffer_load_dword v91, v90, s[36:39], 0 offen sc1
s_branch Lpi
Lpix:
v_min_u32_e64 v88, 47, v251
v_lshlrev_b32 v88, 3, v88
s_and_b32 s44, s2, 7
s_lshl_b32 s44, s44, 11
s_add_u32 s44, s44, 394752
buffer_load_dwordx2 v[92:93], v88, s[32:35], s44 offen sc1
Lrs1:
s_setprio 1
ds_read_b128 v[236:239], v248 offset:63488
v_mfma_f32_32x32x16_f16 v[192:207], v[40:43], v[240:243], 0
v_cvt_pkrtz_f16_f32 v137, v120, v121
v_cvt_pkrtz_f16_f32 v139, v122, v123
v_cvt_pkrtz_f16_f32 v141, v124, v125
v_cvt_pkrtz_f16_f32 v143, v126, v127
v_cvt_pkrtz_f16_f32 v145, v128, v129
v_mfma_f32_32x32x16_f16 v[192:207], v[44:47], v[244:247], v[192:207]
v_cvt_pk_f16_f32 v155, v130, v131
v_cvt_pk_f16_f32 v152, v132, v133
v_cvt_pk_f16_f32 v149, v134, v135
v_pk_fma_f16 v154, v155, v155, s48
v_and_b32_e64 v137, s49, v137
v_pk_fma_f16 v151, v152, v152, s48
v_mfma_f32_32x32x16_bf16 v[120:135], v[224:227], v[168:171], 0
v_and_b32 v139, s49, v139
v_pk_fma_f16 v148, v149, v149, s48
v_permlane16_swap_b32 v40, v44
v_pk_mul_f16 v154, v155, v154
v_bfe_u32 v136, v137, 2, 14
v_permlane16_swap_b32 v41, v45
v_pk_mul_f16 v151, v152, v151
v_pk_mul_f16 v148, v149, v148
v_permlane16_swap_b32 v42, v46
v_bfe_u32 v138, v139, 2, 14
ds_read_b128 v[224:227], v248 offset:61440
ds_read_u16_d16 v136, v136
ds_read_u16_d16 v138, v138
v_mfma_f32_32x32x16_bf16 v[120:135], v[228:231], v[172:175], v[120:135]
v_exp_f16 v153, v154
v_permlane16_swap_b32 v43, v47
v_lshrrev_b32 v137, 18, v137
v_exp_f16 v150, v151
v_fmac_f32 v161, v192, v192
v_lshrrev_b32 v139, 18, v139
v_fmac_f32 v161, v193, v193
v_exp_f16 v147, v148
v_and_b32_e64 v141, s49, v141
v_fmac_f32 v161, v194, v194
s_waitcnt lgkmcnt(3)
ds_read_b128 v[228:231], v248 offset:64512
ds_read_u16_d16_hi v137, v137
ds_read_u16_d16_hi v139, v139
v_mfma_f32_32x32x16_bf16 v[120:135], v[232:235], v[176:179], v[120:135]
v_and_b32_e64 v143, s49, v143
v_exp_f16_sdwa v153, v154 dst_sel:WORD_1 dst_unused:UNUSED_PRESERVE src0_sel:WORD_1
v_fmac_f32_e64 v161, v195, v195
v_bfe_u32 v140, v141, 2, 14
v_fmac_f32_e64 v161, v196, v196
v_exp_f16_sdwa v150, v151 dst_sel:WORD_1 dst_unused:UNUSED_PRESERVE src0_sel:WORD_1
v_bfe_u32 v142, v143, 2, 14
v_fmac_f32_e64 v161, v197, v197
ds_read_b128 v[232:235], v249
ds_read_u16_d16 v140, v140
ds_read_u16_d16 v142, v142
v_mfma_f32_32x32x16_bf16 v[120:135], v[236:239], v[180:183], v[120:135]
v_exp_f16_sdwa v147, v148 dst_sel:WORD_1 dst_unused:UNUSED_PRESERVE src0_sel:WORD_1
v_fmac_f32 v161, v198, v198
v_lshrrev_b32 v141, 18, v141
v_pk_add_f16 v153, v153, 1.0 op_sel_hi:[1,0]
v_lshrrev_b32 v143, 18, v143
v_fmac_f32 v161, v199, v199
v_pk_add_f16 v150, v150, 1.0 op_sel_hi:[1,0]
v_pk_add_f16 v147, v147, 1.0 op_sel_hi:[1,0]
v_fmac_f32 v161, v200, v200
v_and_b32 v145, s49, v145
v_rcp_f16 v154, v153
s_waitcnt lgkmcnt(3)
ds_read_b128 v[236:239], v249 offset:3072
ds_read_u16_d16_hi v141, v141
ds_read_u16_d16_hi v143, v143
v_mfma_f32_32x32x16_bf16 v[120:135], v[224:227], v[184:187], v[120:135]
v_fmac_f32_e64 v161, v201, v201
v_bfe_u32 v144, v145, 2, 14
v_rcp_f16 v151, v150
s_setprio 0
v_fmac_f32 v161, v202, v202
v_lshrrev_b32 v145, 18, v145
v_fmac_f32 v161, v203, v203
v_rcp_f16 v148, v147
v_fmac_f32_e64 v161, v204, v204
ds_read_u16_d16 v144, v144
ds_read_u16_d16_hi v145, v145
v_or_b32_e64 v48, v136, v137
ds_read_b128 v[224:227], v249 offset:1024
v_mfma_f32_32x32x16_bf16 v[120:135], v[228:231], v[188:191], v[120:135]
v_or_b32_e64 v49, v138, v139
v_rcp_f16_sdwa v154, v153 dst_sel:WORD_1 dst_unused:UNUSED_PRESERVE src0_sel:WORD_1
v_fmac_f32 v161, v205, v205
s_waitcnt lgkmcnt(4)
v_or_b32 v50, v140, v141
v_fmac_f32 v161, v206, v206
v_rcp_f16_sdwa v151, v150 dst_sel:WORD_1 dst_unused:UNUSED_PRESERVE src0_sel:WORD_1
v_fmac_f32 v161, v207, v207
s_waitcnt lgkmcnt(3)
v_or_b32_e64 v51, v142, v143
v_rcp_f16_sdwa v148, v147 dst_sel:WORD_1 dst_unused:UNUSED_PRESERVE src0_sel:WORD_1
v_permlane32_swap_b32 v160, v161
s_waitcnt lgkmcnt(1)
v_or_b32_e64 v52, v144, v145
v_pk_mul_f16 v53, v155, v154
v_add_f32 v160, v160, v161
ds_write_b32 v255, v160 offset:7680
v_pk_mul_f16 v54, v152, v151
v_pk_mul_f16 v55, v149, v148
s_setprio 2
ds_read_b128 v[228:231], v249 offset:4096
v_mfma_f32_32x32x16_f16 v[192:207], v[48:51], v[240:243], 0
v_cvt_pkrtz_f16_f32 v137, v120, v121
v_cvt_pkrtz_f16_f32 v139, v122, v123
v_cvt_pkrtz_f16_f32 v141, v124, v125
v_cvt_pkrtz_f16_f32 v143, v126, v127
v_cvt_pkrtz_f16_f32 v145, v128, v129
v_mfma_f32_32x32x16_f16 v[192:207], v[52:55], v[244:247], v[192:207]
v_cvt_pk_f16_f32 v155, v130, v131
v_cvt_pk_f16_f32 v152, v132, v133
v_cvt_pk_f16_f32 v149, v134, v135
v_pk_fma_f16 v154, v155, v155, s48
v_and_b32_e64 v137, s49, v137
v_pk_fma_f16 v151, v152, v152, s48
v_mfma_f32_32x32x16_bf16 v[120:135], v[232:235], v[168:171], 0
v_and_b32 v139, s49, v139
v_pk_fma_f16 v148, v149, v149, s48
v_permlane16_swap_b32 v48, v52
v_pk_mul_f16 v154, v155, v154
v_bfe_u32 v136, v137, 2, 14
v_permlane16_swap_b32 v49, v53
v_pk_mul_f16 v151, v152, v151
v_pk_mul_f16 v148, v149, v148
v_bfe_u32 v138, v139, 2, 14
v_permlane16_swap_b32 v50, v54
ds_read_b128 v[232:235], v249 offset:2048
ds_read_u16_d16 v136, v136
ds_read_u16_d16 v138, v138
v_mfma_f32_32x32x16_bf16 v[120:135], v[236:239], v[172:175], v[120:135]
v_exp_f16 v153, v154
v_permlane16_swap_b32 v51, v55
v_lshrrev_b32 v137, 18, v137
v_exp_f16 v150, v151
v_fmac_f32 v162, v192, v192
v_lshrrev_b32 v139, 18, v139
v_exp_f16 v147, v148
v_fmac_f32 v162, v193, v193
v_and_b32 v141, s49, v141
s_waitcnt lgkmcnt(5)
ds_read_b128 v[236:239], v249 offset:5120
ds_read_u16_d16_hi v137, v137
ds_read_u16_d16_hi v139, v139
v_mfma_f32_32x32x16_bf16 v[120:135], v[224:227], v[176:179], v[120:135]
v_and_b32 v143, s49, v143
v_fmac_f32 v162, v194, v194
v_exp_f16_sdwa v153, v154 dst_sel:WORD_1 dst_unused:UNUSED_PRESERVE src0_sel:WORD_1
v_bfe_u32 v140, v141, 2, 14
v_fmac_f32_e64 v162, v195, v195
v_exp_f16_sdwa v150, v151 dst_sel:WORD_1 dst_unused:UNUSED_PRESERVE src0_sel:WORD_1
v_fmac_f32 v162, v196, v196
v_bfe_u32 v142, v143, 2, 14
s_waitcnt lgkmcnt(4)
ds_read_b128 v[224:227], v249 offset:6144
ds_read_u16_d16 v140, v140
ds_read_u16_d16 v142, v142
v_mfma_f32_32x32x16_bf16 v[120:135], v[228:231], v[180:183], v[120:135]
v_exp_f16_sdwa v147, v148 dst_sel:WORD_1 dst_unused:UNUSED_PRESERVE src0_sel:WORD_1
v_fmac_f32 v162, v197, v197
v_lshrrev_b32 v141, 18, v141
v_pk_add_f16 v153, v153, 1.0 op_sel_hi:[1,0]
v_lshrrev_b32 v143, 18, v143
v_fmac_f32 v162, v198, v198
v_pk_add_f16 v150, v150, 1.0 op_sel_hi:[1,0]
v_pk_add_f16 v147, v147, 1.0 op_sel_hi:[1,0]
v_fmac_f32 v162, v199, v199
v_and_b32 v145, s49, v145
ds_read_b128 v[228:231], v249 offset:9216
ds_read_u16_d16_hi v141, v141
ds_read_u16_d16_hi v143, v143
v_mfma_f32_32x32x16_bf16 v[120:135], v[232:235], v[184:187], v[120:135]
v_rcp_f16 v154, v153
v_fmac_f32 v162, v200, v200
v_bfe_u32 v144, v145, 2, 14
v_rcp_f16 v151, v150
v_fmac_f32 v162, v201, v201
v_lshrrev_b32 v145, 18, v145
v_rcp_f16 v148, v147
v_fmac_f32_e64 v162, v202, v202
ds_read_u16_d16 v144, v144
ds_read_u16_d16_hi v145, v145
s_waitcnt lgkmcnt(5)
v_or_b32 v56, v136, v137
ds_read_b128 v[232:235], v249 offset:7168
v_mfma_f32_32x32x16_bf16 v[120:135], v[236:239], v[188:191], v[120:135]
v_or_b32 v57, v138, v139
v_fmac_f32 v162, v203, v203
v_rcp_f16_sdwa v154, v153 dst_sel:WORD_1 dst_unused:UNUSED_PRESERVE src0_sel:WORD_1
v_fmac_f32 v162, v204, v204
s_waitcnt lgkmcnt(4)
v_or_b32_e64 v58, v140, v141
v_rcp_f16_sdwa v151, v150 dst_sel:WORD_1 dst_unused:UNUSED_PRESERVE src0_sel:WORD_1
v_fmac_f32 v162, v205, v205
s_waitcnt lgkmcnt(3)
v_or_b32_e64 v59, v142, v143
v_rcp_f16_sdwa v148, v147 dst_sel:WORD_1 dst_unused:UNUSED_PRESERVE src0_sel:WORD_1
v_fmac_f32 v162, v206, v206
s_waitcnt lgkmcnt(1)
v_or_b32_e64 v60, v144, v145
v_pk_mul_f16 v61, v155, v154
v_fmac_f32 v162, v207, v207
v_pk_mul_f16 v62, v152, v151
v_pk_mul_f16 v63, v149, v148
s_setprio 1
ds_read_b128 v[236:239], v249 offset:10240
v_mfma_f32_32x32x16_f16 v[192:207], v[56:59], v[240:243], 0
v_cvt_pkrtz_f16_f32 v137, v120, v121
v_cvt_pkrtz_f16_f32 v139, v122, v123
v_cvt_pkrtz_f16_f32 v141, v124, v125
v_cvt_pkrtz_f16_f32 v143, v126, v127
v_cvt_pkrtz_f16_f32 v145, v128, v129
v_mfma_f32_32x32x16_f16 v[192:207], v[60:63], v[244:247], v[192:207]
v_cvt_pk_f16_f32 v155, v130, v131
v_cvt_pk_f16_f32 v152, v132, v133
v_cvt_pk_f16_f32 v149, v134, v135
v_pk_fma_f16 v154, v155, v155, s48
v_and_b32_e64 v137, s49, v137
v_pk_fma_f16 v151, v152, v152, s48
v_mfma_f32_32x32x16_bf16 v[120:135], v[224:227], v[168:171], 0
v_and_b32 v139, s49, v139
v_pk_fma_f16 v148, v149, v149, s48
v_permlane16_swap_b32 v56, v60
v_pk_mul_f16 v154, v155, v154
v_bfe_u32 v136, v137, 2, 14
v_permlane16_swap_b32 v57, v61
v_pk_mul_f16 v151, v152, v151
v_pk_mul_f16 v148, v149, v148
v_permlane16_swap_b32 v58, v62
v_bfe_u32 v138, v139, 2, 14
ds_read_b128 v[224:227], v249 offset:8192
ds_read_u16_d16 v136, v136
ds_read_u16_d16 v138, v138
v_mfma_f32_32x32x16_bf16 v[120:135], v[228:231], v[172:175], v[120:135]
v_exp_f16 v153, v154
v_permlane16_swap_b32 v59, v63
v_lshrrev_b32 v137, 18, v137
v_exp_f16 v150, v151
v_fmac_f32 v163, v192, v192
v_lshrrev_b32 v139, 18, v139
v_fmac_f32 v163, v193, v193
v_exp_f16 v147, v148
v_and_b32_e64 v141, s49, v141
v_fmac_f32 v163, v194, v194
s_waitcnt lgkmcnt(3)
ds_read_b128 v[228:231], v249 offset:11264
ds_read_u16_d16_hi v137, v137
ds_read_u16_d16_hi v139, v139
v_mfma_f32_32x32x16_bf16 v[120:135], v[232:235], v[176:179], v[120:135]
v_and_b32_e64 v143, s49, v143
v_exp_f16_sdwa v153, v154 dst_sel:WORD_1 dst_unused:UNUSED_PRESERVE src0_sel:WORD_1
v_fmac_f32_e64 v163, v195, v195
v_bfe_u32 v140, v141, 2, 14
v_fmac_f32_e64 v163, v196, v196
v_exp_f16_sdwa v150, v151 dst_sel:WORD_1 dst_unused:UNUSED_PRESERVE src0_sel:WORD_1
v_bfe_u32 v142, v143, 2, 14
v_fmac_f32_e64 v163, v197, v197
ds_read_b128 v[232:235], v249 offset:12288
ds_read_u16_d16 v140, v140
ds_read_u16_d16 v142, v142
v_mfma_f32_32x32x16_bf16 v[120:135], v[236:239], v[180:183], v[120:135]
v_exp_f16_sdwa v147, v148 dst_sel:WORD_1 dst_unused:UNUSED_PRESERVE src0_sel:WORD_1
v_fmac_f32 v163, v198, v198
v_lshrrev_b32 v141, 18, v141
v_pk_add_f16 v153, v153, 1.0 op_sel_hi:[1,0]
v_lshrrev_b32 v143, 18, v143
v_fmac_f32 v163, v199, v199
v_pk_add_f16 v150, v150, 1.0 op_sel_hi:[1,0]
v_pk_add_f16 v147, v147, 1.0 op_sel_hi:[1,0]
v_fmac_f32 v163, v200, v200
v_and_b32 v145, s49, v145
v_rcp_f16 v154, v153
s_waitcnt lgkmcnt(3)
ds_read_b128 v[236:239], v249 offset:15360
ds_read_u16_d16_hi v141, v141
ds_read_u16_d16_hi v143, v143
v_mfma_f32_32x32x16_bf16 v[120:135], v[224:227], v[184:187], v[120:135]
v_fmac_f32_e64 v163, v201, v201
v_bfe_u32 v144, v145, 2, 14
v_rcp_f16 v151, v150
s_setprio 0
v_fmac_f32 v163, v202, v202
v_lshrrev_b32 v145, 18, v145
v_fmac_f32 v163, v203, v203
v_rcp_f16 v148, v147
v_fmac_f32_e64 v163, v204, v204
ds_read_u16_d16 v144, v144
ds_read_u16_d16_hi v145, v145
v_or_b32_e64 v64, v136, v137
ds_read_b128 v[224:227], v249 offset:13312
v_mfma_f32_32x32x16_bf16 v[120:135], v[228:231], v[188:191], v[120:135]
v_or_b32_e64 v65, v138, v139
v_rcp_f16_sdwa v154, v153 dst_sel:WORD_1 dst_unused:UNUSED_PRESERVE src0_sel:WORD_1
v_fmac_f32 v163, v205, v205
s_waitcnt lgkmcnt(4)
v_or_b32 v66, v140, v141
v_fmac_f32 v163, v206, v206
v_rcp_f16_sdwa v151, v150 dst_sel:WORD_1 dst_unused:UNUSED_PRESERVE src0_sel:WORD_1
v_fmac_f32 v163, v207, v207
s_waitcnt lgkmcnt(3)
v_or_b32_e64 v67, v142, v143
v_rcp_f16_sdwa v148, v147 dst_sel:WORD_1 dst_unused:UNUSED_PRESERVE src0_sel:WORD_1
v_permlane32_swap_b32 v162, v163
s_waitcnt lgkmcnt(1)
v_or_b32_e64 v68, v144, v145
v_pk_mul_f16 v69, v155, v154
v_add_f32 v162, v162, v163
ds_write_b32 v255, v162 offset:7936
v_pk_mul_f16 v70, v152, v151
v_pk_mul_f16 v71, v149, v148
s_setprio 2
ds_read_b128 v[228:231], v249 offset:16384
v_mfma_f32_32x32x16_f16 v[192:207], v[64:67], v[240:243], 0
v_cvt_pkrtz_f16_f32 v137, v120, v121
v_cvt_pkrtz_f16_f32 v139, v122, v123
v_cvt_pkrtz_f16_f32 v141, v124, v125
v_cvt_pkrtz_f16_f32 v143, v126, v127
v_cvt_pkrtz_f16_f32 v145, v128, v129
v_mfma_f32_32x32x16_f16 v[192:207], v[68:71], v[244:247], v[192:207]
v_cvt_pk_f16_f32 v155, v130, v131
v_cvt_pk_f16_f32 v152, v132, v133
v_cvt_pk_f16_f32 v149, v134, v135
v_pk_fma_f16 v154, v155, v155, s48
v_and_b32_e64 v137, s49, v137
v_pk_fma_f16 v151, v152, v152, s48
v_mfma_f32_32x32x16_bf16 v[120:135], v[232:235], v[168:171], 0
v_and_b32 v139, s49, v139
v_pk_fma_f16 v148, v149, v149, s48
v_permlane16_swap_b32 v64, v68
v_pk_mul_f16 v154, v155, v154
v_bfe_u32 v136, v137, 2, 14
v_permlane16_swap_b32 v65, v69
v_pk_mul_f16 v151, v152, v151
v_pk_mul_f16 v148, v149, v148
v_bfe_u32 v138, v139, 2, 14
v_permlane16_swap_b32 v66, v70
ds_read_b128 v[232:235], v249 offset:14336
ds_read_u16_d16 v136, v136
ds_read_u16_d16 v138, v138
v_mfma_f32_32x32x16_bf16 v[120:135], v[236:239], v[172:175], v[120:135]
v_exp_f16 v153, v154
v_permlane16_swap_b32 v67, v71
v_lshrrev_b32 v137, 18, v137
v_exp_f16 v150, v151
v_fmac_f32 v164, v192, v192
v_lshrrev_b32 v139, 18, v139
v_exp_f16 v147, v148
v_fmac_f32 v164, v193, v193
v_and_b32 v141, s49, v141
s_waitcnt lgkmcnt(5)
ds_read_b128 v[236:239], v249 offset:17408
ds_read_u16_d16_hi v137, v137
ds_read_u16_d16_hi v139, v139
v_mfma_f32_32x32x16_bf16 v[120:135], v[224:227], v[176:179], v[120:135]
v_and_b32 v143, s49, v143
v_fmac_f32 v164, v194, v194
v_exp_f16_sdwa v153, v154 dst_sel:WORD_1 dst_unused:UNUSED_PRESERVE src0_sel:WORD_1
v_bfe_u32 v140, v141, 2, 14
v_fmac_f32_e64 v164, v195, v195
v_exp_f16_sdwa v150, v151 dst_sel:WORD_1 dst_unused:UNUSED_PRESERVE src0_sel:WORD_1
v_fmac_f32 v164, v196, v196
v_bfe_u32 v142, v143, 2, 14
s_waitcnt lgkmcnt(4)
ds_read_b128 v[224:227], v249 offset:18432
ds_read_u16_d16 v140, v140
ds_read_u16_d16 v142, v142
v_mfma_f32_32x32x16_bf16 v[120:135], v[228:231], v[180:183], v[120:135]
v_exp_f16_sdwa v147, v148 dst_sel:WORD_1 dst_unused:UNUSED_PRESERVE src0_sel:WORD_1
v_fmac_f32 v164, v197, v197
v_lshrrev_b32 v141, 18, v141
v_pk_add_f16 v153, v153, 1.0 op_sel_hi:[1,0]
v_lshrrev_b32 v143, 18, v143
v_fmac_f32 v164, v198, v198
v_pk_add_f16 v150, v150, 1.0 op_sel_hi:[1,0]
v_pk_add_f16 v147, v147, 1.0 op_sel_hi:[1,0]
v_fmac_f32 v164, v199, v199
v_and_b32 v145, s49, v145
ds_read_b128 v[228:231], v249 offset:21504
ds_read_u16_d16_hi v141, v141
ds_read_u16_d16_hi v143, v143
v_mfma_f32_32x32x16_bf16 v[120:135], v[232:235], v[184:187], v[120:135]
v_rcp_f16 v154, v153
v_fmac_f32 v164, v200, v200
v_bfe_u32 v144, v145, 2, 14
v_rcp_f16 v151, v150
v_fmac_f32 v164, v201, v201
v_lshrrev_b32 v145, 18, v145
v_rcp_f16 v148, v147
v_fmac_f32_e64 v164, v202, v202
ds_read_u16_d16 v144, v144
ds_read_u16_d16_hi v145, v145
s_waitcnt lgkmcnt(5)
v_or_b32 v72, v136, v137
ds_read_b128 v[232:235], v249 offset:19456
v_mfma_f32_32x32x16_bf16 v[120:135], v[236:239], v[188:191], v[120:135]
v_or_b32 v73, v138, v139
v_fmac_f32 v164, v203, v203
v_rcp_f16_sdwa v154, v153 dst_sel:WORD_1 dst_unused:UNUSED_PRESERVE src0_sel:WORD_1
v_fmac_f32 v164, v204, v204
s_waitcnt lgkmcnt(4)
v_or_b32_e64 v74, v140, v141
v_rcp_f16_sdwa v151, v150 dst_sel:WORD_1 dst_unused:UNUSED_PRESERVE src0_sel:WORD_1
v_fmac_f32 v164, v205, v205
s_waitcnt lgkmcnt(3)
v_or_b32_e64 v75, v142, v143
v_rcp_f16_sdwa v148, v147 dst_sel:WORD_1 dst_unused:UNUSED_PRESERVE src0_sel:WORD_1
v_fmac_f32 v164, v206, v206
s_waitcnt lgkmcnt(1)
v_or_b32_e64 v76, v144, v145
v_pk_mul_f16 v77, v155, v154
v_fmac_f32_e64 v164, v207, v207
v_pk_mul_f16 v78, v152, v151
v_pk_mul_f16 v79, v149, v148
s_cmp_lg_u32 s40, 0
s_cbranch_scc1 Lrs2
v_min_u32_e64 v88, 47, v251
v_lshlrev_b32 v88, 3, v88
v_add_u32 v89, 7936, v88
v_add_u32 v88, 15872, v88
v_cmp_gt_u32 vcc, 32, v251
s_nop 1
v_cndmask_b32 v88, v88, v89, vcc
s_waitcnt vmcnt(0)
ds_write_b64 v88, v[92:93]
Lrs2:
s_setprio 1
ds_read_b128 v[236:239], v249 offset:22528
v_mfma_f32_32x32x16_f16 v[192:207], v[72:75], v[240:243], 0
v_cvt_pkrtz_f16_f32 v137, v120, v121
v_cvt_pkrtz_f16_f32 v139, v122, v123
v_cvt_pkrtz_f16_f32 v141, v124, v125
v_cvt_pkrtz_f16_f32 v143, v126, v127
v_cvt_pkrtz_f16_f32 v145, v128, v129
v_mfma_f32_32x32x16_f16 v[192:207], v[76:79], v[244:247], v[192:207]
v_cvt_pk_f16_f32 v155, v130, v131
v_cvt_pk_f16_f32 v152, v132, v133
v_cvt_pk_f16_f32 v149, v134, v135
v_pk_fma_f16 v154, v155, v155, s48
v_and_b32_e64 v137, s49, v137
v_pk_fma_f16 v151, v152, v152, s48
v_mfma_f32_32x32x16_bf16 v[120:135], v[224:227], v[168:171], 0
v_and_b32 v139, s49, v139
v_pk_fma_f16 v148, v149, v149, s48
v_permlane16_swap_b32 v72, v76
v_pk_mul_f16 v154, v155, v154
v_bfe_u32 v136, v137, 2, 14
v_permlane16_swap_b32 v73, v77
v_pk_mul_f16 v151, v152, v151
v_pk_mul_f16 v148, v149, v148
v_permlane16_swap_b32 v74, v78
v_bfe_u32 v138, v139, 2, 14
ds_read_b128 v[224:227], v249 offset:20480
ds_read_u16_d16 v136, v136
ds_read_u16_d16 v138, v138
v_mfma_f32_32x32x16_bf16 v[120:135], v[228:231], v[172:175], v[120:135]
v_exp_f16 v153, v154
v_permlane16_swap_b32 v75, v79
v_lshrrev_b32 v137, 18, v137
v_exp_f16 v150, v151
v_fmac_f32 v165, v192, v192
v_lshrrev_b32 v139, 18, v139
v_fmac_f32 v165, v193, v193
v_exp_f16 v147, v148
v_and_b32_e64 v141, s49, v141
v_fmac_f32 v165, v194, v194
s_waitcnt lgkmcnt(3)
ds_read_b128 v[228:231], v249 offset:23552
ds_read_u16_d16_hi v137, v137
ds_read_u16_d16_hi v139, v139
v_mfma_f32_32x32x16_bf16 v[120:135], v[232:235], v[176:179], v[120:135]
v_and_b32_e64 v143, s49, v143
v_exp_f16_sdwa v153, v154 dst_sel:WORD_1 dst_unused:UNUSED_PRESERVE src0_sel:WORD_1
v_fmac_f32_e64 v165, v195, v195
v_bfe_u32 v140, v141, 2, 14
v_fmac_f32_e64 v165, v196, v196
v_exp_f16_sdwa v150, v151 dst_sel:WORD_1 dst_unused:UNUSED_PRESERVE src0_sel:WORD_1
v_bfe_u32 v142, v143, 2, 14
v_fmac_f32_e64 v165, v197, v197
ds_read_b128 v[232:235], v248 offset:40960
ds_read_u16_d16 v140, v140
ds_read_u16_d16 v142, v142
v_mfma_f32_32x32x16_bf16 v[120:135], v[236:239], v[180:183], v[120:135]
v_exp_f16_sdwa v147, v148 dst_sel:WORD_1 dst_unused:UNUSED_PRESERVE src0_sel:WORD_1
v_fmac_f32 v165, v198, v198
v_lshrrev_b32 v141, 18, v141
v_pk_add_f16 v153, v153, 1.0 op_sel_hi:[1,0]
v_lshrrev_b32 v143, 18, v143
v_fmac_f32 v165, v199, v199
v_pk_add_f16 v150, v150, 1.0 op_sel_hi:[1,0]
v_pk_add_f16 v147, v147, 1.0 op_sel_hi:[1,0]
v_fmac_f32 v165, v200, v200
v_and_b32 v145, s49, v145
v_rcp_f16 v154, v153
s_waitcnt lgkmcnt(3)
ds_read_b128 v[236:239], v248 offset:44032
ds_read_u16_d16_hi v141, v141
ds_read_u16_d16_hi v143, v143
v_mfma_f32_32x32x16_bf16 v[120:135], v[224:227], v[184:187], v[120:135]
v_fmac_f32_e64 v165, v201, v201
v_bfe_u32 v144, v145, 2, 14
v_rcp_f16 v151, v150
s_setprio 0
v_fmac_f32 v165, v202, v202
v_lshrrev_b32 v145, 18, v145
v_fmac_f32 v165, v203, v203
v_rcp_f16 v148, v147
v_fmac_f32_e64 v165, v204, v204
ds_read_u16_d16 v144, v144
ds_read_u16_d16_hi v145, v145
v_or_b32_e64 v80, v136, v137
ds_read_b128 v[224:227], v248 offset:41984
v_mfma_f32_32x32x16_bf16 v[120:135], v[228:231], v[188:191], v[120:135]
v_or_b32_e64 v81, v138, v139
v_rcp_f16_sdwa v154, v153 dst_sel:WORD_1 dst_unused:UNUSED_PRESERVE src0_sel:WORD_1
v_fmac_f32 v165, v205, v205
s_waitcnt lgkmcnt(4)
v_or_b32 v82, v140, v141
v_fmac_f32 v165, v206, v206
v_rcp_f16_sdwa v151, v150 dst_sel:WORD_1 dst_unused:UNUSED_PRESERVE src0_sel:WORD_1
v_fmac_f32 v165, v207, v207
s_waitcnt lgkmcnt(3)
v_or_b32_e64 v83, v142, v143
v_rcp_f16_sdwa v148, v147 dst_sel:WORD_1 dst_unused:UNUSED_PRESERVE src0_sel:WORD_1
v_permlane32_swap_b32 v164, v165
s_waitcnt lgkmcnt(1)
v_or_b32_e64 v84, v144, v145
v_pk_mul_f16 v85, v155, v154
v_add_f32 v164, v164, v165
ds_write_b32 v255, v164 offset:8192
v_pk_mul_f16 v86, v152, v151
v_pk_mul_f16 v87, v149, v148
s_setprio 2
ds_read_b128 v[228:231], v248 offset:45056
v_mfma_f32_32x32x16_f16 v[192:207], v[80:83], v[240:243], 0
v_cvt_pkrtz_f16_f32 v137, v120, v121
v_cvt_pkrtz_f16_f32 v139, v122, v123
v_cvt_pkrtz_f16_f32 v141, v124, v125
v_cvt_pkrtz_f16_f32 v143, v126, v127
v_cvt_pkrtz_f16_f32 v145, v128, v129
v_mfma_f32_32x32x16_f16 v[192:207], v[84:87], v[244:247], v[192:207]
v_cvt_pk_f16_f32 v155, v130, v131
v_cvt_pk_f16_f32 v152, v132, v133
v_cvt_pk_f16_f32 v149, v134, v135
v_pk_fma_f16 v154, v155, v155, s48
v_and_b32_e64 v137, s49, v137
v_pk_fma_f16 v151, v152, v152, s48
v_mfma_f32_32x32x16_bf16 v[120:135], v[232:235], v[96:99], 0
v_and_b32 v139, s49, v139
v_pk_fma_f16 v148, v149, v149, s48
v_permlane16_swap_b32 v80, v84
v_pk_mul_f16 v154, v155, v154
v_bfe_u32 v136, v137, 2, 14
v_permlane16_swap_b32 v81, v85
v_pk_mul_f16 v151, v152, v151
v_pk_mul_f16 v148, v149, v148
v_bfe_u32 v138, v139, 2, 14
v_permlane16_swap_b32 v82, v86
ds_read_b128 v[232:235], v248 offset:43008
ds_read_u16_d16 v136, v136
ds_read_u16_d16 v138, v138
v_mfma_f32_32x32x16_bf16 v[120:135], v[236:239], v[100:103], v[120:135]
v_exp_f16 v153, v154
v_permlane16_swap_b32 v83, v87
v_lshrrev_b32 v137, 18, v137
v_exp_f16 v150, v151
v_fmac_f32 v166, v192, v192
v_lshrrev_b32 v139, 18, v139
v_exp_f16 v147, v148
v_fmac_f32 v166, v193, v193
v_and_b32 v141, s49, v141
s_waitcnt lgkmcnt(5)
ds_read_b128 v[236:239], v248 offset:46080
ds_read_u16_d16_hi v137, v137
ds_read_u16_d16_hi v139, v139
v_mfma_f32_32x32x16_bf16 v[120:135], v[224:227], v[104:107], v[120:135]
v_and_b32 v143, s49, v143
v_fmac_f32 v166, v194, v194
v_exp_f16_sdwa v153, v154 dst_sel:WORD_1 dst_unused:UNUSED_PRESERVE src0_sel:WORD_1
v_bfe_u32 v140, v141, 2, 14
v_fmac_f32_e64 v166, v195, v195
v_exp_f16_sdwa v150, v151 dst_sel:WORD_1 dst_unused:UNUSED_PRESERVE src0_sel:WORD_1
v_fmac_f32 v166, v196, v196
v_bfe_u32 v142, v143, 2, 14
s_waitcnt lgkmcnt(4)
ds_read_b128 v[224:227], v248 offset:47104
ds_read_u16_d16 v140, v140
ds_read_u16_d16 v142, v142
v_mfma_f32_32x32x16_bf16 v[120:135], v[228:231], v[108:111], v[120:135]
v_exp_f16_sdwa v147, v148 dst_sel:WORD_1 dst_unused:UNUSED_PRESERVE src0_sel:WORD_1
v_fmac_f32 v166, v197, v197
v_lshrrev_b32 v141, 18, v141
v_pk_add_f16 v153, v153, 1.0 op_sel_hi:[1,0]
v_lshrrev_b32 v143, 18, v143
v_fmac_f32 v166, v198, v198
v_pk_add_f16 v150, v150, 1.0 op_sel_hi:[1,0]
v_pk_add_f16 v147, v147, 1.0 op_sel_hi:[1,0]
v_fmac_f32 v166, v199, v199
v_and_b32 v145, s49, v145
ds_read_b128 v[228:231], v248 offset:50176
ds_read_u16_d16_hi v141, v141
ds_read_u16_d16_hi v143, v143
v_mfma_f32_32x32x16_bf16 v[120:135], v[232:235], v[112:115], v[120:135]
v_rcp_f16 v154, v153
v_fmac_f32 v166, v200, v200
v_bfe_u32 v144, v145, 2, 14
v_rcp_f16 v151, v150
v_fmac_f32 v166, v201, v201
v_lshrrev_b32 v145, 18, v145
v_rcp_f16 v148, v147
v_fmac_f32_e64 v166, v202, v202
ds_read_u16_d16 v144, v144
ds_read_u16_d16_hi v145, v145
s_waitcnt lgkmcnt(5)
v_or_b32 v88, v136, v137
ds_read_b128 v[232:235], v248 offset:48128
v_mfma_f32_32x32x16_bf16 v[120:135], v[236:239], v[116:119], v[120:135]
v_or_b32 v89, v138, v139
v_fmac_f32 v166, v203, v203
v_rcp_f16_sdwa v154, v153 dst_sel:WORD_1 dst_unused:UNUSED_PRESERVE src0_sel:WORD_1
v_fmac_f32 v166, v204, v204
s_waitcnt lgkmcnt(4)
v_or_b32_e64 v90, v140, v141
v_rcp_f16_sdwa v151, v150 dst_sel:WORD_1 dst_unused:UNUSED_PRESERVE src0_sel:WORD_1
v_fmac_f32 v166, v205, v205
s_waitcnt lgkmcnt(3)
v_or_b32_e64 v91, v142, v143
v_rcp_f16_sdwa v148, v147 dst_sel:WORD_1 dst_unused:UNUSED_PRESERVE src0_sel:WORD_1
v_fmac_f32 v166, v206, v206
s_waitcnt lgkmcnt(1)
v_or_b32_e64 v92, v144, v145
v_pk_mul_f16 v93, v155, v154
v_fmac_f32 v166, v207, v207
v_pk_mul_f16 v94, v152, v151
v_pk_mul_f16 v95, v149, v148
s_setprio 1
ds_read_b128 v[236:239], v248 offset:51200
v_mfma_f32_32x32x16_f16 v[192:207], v[88:91], v[240:243], 0
v_cvt_pkrtz_f16_f32 v137, v120, v121
v_cvt_pkrtz_f16_f32 v139, v122, v123
v_cvt_pkrtz_f16_f32 v141, v124, v125
v_cvt_pkrtz_f16_f32 v143, v126, v127
v_cvt_pkrtz_f16_f32 v145, v128, v129
v_mfma_f32_32x32x16_f16 v[192:207], v[92:95], v[244:247], v[192:207]
v_cvt_pk_f16_f32 v155, v130, v131
v_cvt_pk_f16_f32 v152, v132, v133
v_cvt_pk_f16_f32 v149, v134, v135
v_pk_fma_f16 v154, v155, v155, s48
v_and_b32_e64 v137, s49, v137
v_pk_fma_f16 v151, v152, v152, s48
v_mfma_f32_32x32x16_bf16 v[120:135], v[224:227], v[96:99], 0
v_and_b32 v139, s49, v139
v_permlane16_swap_b32 v88, v92
v_permlane16_swap_b32 v89, v93
v_permlane16_swap_b32 v90, v94
v_permlane16_swap_b32 v91, v95
v_fmac_f32 v167, v192, v192
v_fmac_f32 v167, v193, v193
v_fmac_f32 v167, v194, v194
v_fmac_f32 v167, v195, v195
v_fmac_f32 v167, v196, v196
v_fmac_f32_e64 v167, v197, v197
ds_read_b128 v[224:227], v248 offset:49152
v_mfma_f32_32x32x16_bf16 v[120:135], v[228:231], v[100:103], v[120:135]
v_fmac_f32 v167, v198, v198
v_fmac_f32 v167, v199, v199
v_fmac_f32 v167, v200, v200
v_fmac_f32 v167, v201, v201
v_fmac_f32 v167, v202, v202
v_fmac_f32 v167, v203, v203
v_fmac_f32 v167, v204, v204
v_fmac_f32 v167, v205, v205
v_fmac_f32 v167, v206, v206
v_fmac_f32 v167, v207, v207
s_nop 1
v_permlane32_swap_b32 v166, v167
v_add_f32_e64 v166, v166, v167
ds_write_b32 v255, v166 offset:8448
s_setprio 3
s_mov_b64 exec, 1
ds_add_rtn_u32 v242, v253, v254
s_mov_b64 exec, -1
s_waitcnt lgkmcnt(0)
v_readfirstlane_b32 s43, v242
s_nop 1
s_cmp_lg_u32 s43, 7
s_cbranch_scc1 Lnopub
v_min_u32 v243, 47, v251
v_lshlrev_b32 v244, 5, v243
v_add_u32 v244, 97280, v244
ds_read_b128 v[168:171], v244
ds_read_b128 v[172:175], v244 offset:16
ds_read_b128 v[176:179], v244 offset:9216
ds_read_b128 v[180:183], v244 offset:9232
ds_read_b128 v[184:187], v244 offset:18432
ds_read_b128 v[188:191], v244 offset:18448
ds_read_b128 v[192:195], v244 offset:27648
ds_read_b128 v[196:199], v244 offset:27664
ds_read_b128 v[200:203], v244 offset:36864
ds_read_b128 v[204:207], v244 offset:36880
ds_read_b128 v[156:159], v244 offset:46080
ds_read_b128 v[160:163], v244 offset:46096
v_lshlrev_b32_e64 v246, 13, v243
v_add_u32 v247, 4096, v246
s_waitcnt lgkmcnt(9)
v_add_f32 v168, v168, v176
v_add_f32 v169, v169, v177
v_add_f32 v170, v170, v178
v_add_f32 v171, v171, v179
s_waitcnt lgkmcnt(8)
v_add_f32 v172, v172, v180
v_add_f32 v173, v173, v181
v_add_f32 v174, v174, v182
v_add_f32 v175, v175, v183
ds_read_b128 v[176:179], v244 offset:55296
ds_read_b128 v[180:183], v244 offset:55312
s_waitcnt lgkmcnt(7)
v_add_f32 v184, v184, v192
v_add_f32 v185, v185, v193
v_add_f32 v186, v186, v194
v_add_f32 v187, v187, v195
s_waitcnt lgkmcnt(6)
v_add_f32 v188, v188, v196
v_add_f32 v189, v189, v197
v_add_f32 v190, v190, v198
v_add_f32 v191, v191, v199
ds_read_b128 v[192:195], v244 offset:64512
ds_read_b128 v[196:199], v244 offset:64528
s_waitcnt lgkmcnt(5)
v_add_f32 v200, v200, v156
v_add_f32 v201, v201, v157
v_add_f32 v202, v202, v158
v_add_f32 v203, v203, v159
s_waitcnt lgkmcnt(4)
v_add_f32 v204, v204, v160
v_add_f32 v205, v205, v161
v_add_f32 v206, v206, v162
v_add_f32 v207, v207, v163
v_add_f32 v168, v168, v184
v_add_f32 v169, v169, v185
v_add_f32 v170, v170, v186
v_add_f32 v171, v171, v187
v_add_f32 v172, v172, v188
v_add_f32 v173, v173, v189
v_add_f32 v174, v174, v190
v_add_f32 v175, v175, v191
s_waitcnt lgkmcnt(1)
v_add_f32 v176, v176, v192
v_add_f32 v177, v177, v193
v_add_f32 v178, v178, v194
v_add_f32 v179, v179, v195
s_waitcnt lgkmcnt(0)
v_add_f32 v180, v180, v196
v_add_f32 v181, v181, v197
v_add_f32 v182, v182, v198
v_add_f32 v183, v183, v199
v_add_f32 v200, v200, v176
v_add_f32 v201, v201, v177
v_add_f32 v202, v202, v178
v_add_f32 v203, v203, v179
v_add_f32 v204, v204, v180
v_add_f32 v205, v205, v181
v_add_f32 v206, v206, v182
v_add_f32 v207, v207, v183
v_add_f32 v168, v168, v200
v_add_f32 v169, v169, v201
v_add_f32 v170, v170, v202
v_add_f32 v171, v171, v203
v_add_f32 v172, v172, v204
v_add_f32 v173, v173, v205
v_add_f32 v174, v174, v206
v_add_f32 v175, v175, v207
v_min_u32 v176, -2, v168
v_min_u32 v177, -2, v169
v_min_u32 v178, -2, v170
v_min_u32 v179, -2, v171
v_min_u32 v180, -2, v172
v_min_u32 v181, -2, v173
v_min_u32_e64 v182, -2, v174
v_min_u32 v183, -2, v175
s_lshl_b32 s43, s2, 4
buffer_store_dwordx4 v[176:179], v246, s[32:35], s43 offen sc1
buffer_store_dwordx4 v[180:183], v247, s[32:35], s43 offen sc1
ds_write_b32 v253, v254 offset:4
s_nop 1
Lnopub:
s_mov_b32 s77, 0
s_cmp_lg_u32 s40, 0
s_cbranch_scc1 Lnorole
v_lshlrev_b32_e64 v247, 2, v251
buffer_load_dword v244, v247, s[24:27], 0 offen offset:0
buffer_load_dword v245, v247, s[24:27], 0 offen offset:256
buffer_load_dword v246, v247, s[24:27], 0 offen offset:512
s_cmp_lt_u32 s2, 96
s_cselect_b32 s77, 1, 2
s_waitcnt lgkmcnt(0)
v_mov_b32 v156, -1
v_mov_b32 v157, -1
v_mov_b32 v158, -1
v_mov_b32 v159, -1
v_mov_b32 v160, -1
v_mov_b32 v161, -1
v_mov_b32 v162, -1
v_mov_b32 v163, -1
v_mov_b32 v164, -1
v_mov_b32 v165, -1
v_mov_b32 v166, -1
v_mov_b32 v167, -1
v_mov_b32 v240, -1
v_mov_b32 v241, -1
v_mov_b32 v242, -1
v_mov_b32 v243, -1
s_call_b64 s[78:79], Lpoll1
Lnorole:
s_setprio 1
ds_read_b128 v[228:231], v248 offset:52224
v_mfma_f32_32x32x16_bf16 v[120:135], v[232:235], v[104:107], v[120:135]
v_pk_fma_f16 v148, v149, v149, s48
v_pk_mul_f16 v154, v155, v154
v_bfe_u32 v136, v137, 2, 14
v_pk_mul_f16 v151, v152, v151
v_pk_mul_f16 v148, v149, v148
v_bfe_u32 v138, v139, 2, 14
v_exp_f16 v153, v154
v_lshrrev_b32 v137, 18, v137
v_exp_f16_e64 v150, v151
ds_read_b128 v[232:235], v248 offset:53248
ds_read_u16_d16 v136, v136
ds_read_u16_d16 v138, v138
ds_read_u16_d16_hi v137, v137
v_mfma_f32_32x32x16_bf16 v[120:135], v[236:239], v[108:111], v[120:135]
v_lshrrev_b32 v139, 18, v139
v_exp_f16 v147, v148
v_and_b32 v141, s49, v141
v_and_b32 v143, s49, v143
v_exp_f16_sdwa v153, v154 dst_sel:WORD_1 dst_unused:UNUSED_PRESERVE src0_sel:WORD_1
v_bfe_u32 v140, v141, 2, 14
v_exp_f16_sdwa v150, v151 dst_sel:WORD_1 dst_unused:UNUSED_PRESERVE src0_sel:WORD_1
v_bfe_u32 v142, v143, 2, 14
ds_read_b128 v[236:239], v248 offset:56320
ds_read_u16_d16_hi v139, v139
ds_read_u16_d16 v140, v140
ds_read_u16_d16 v142, v142
v_mfma_f32_32x32x16_bf16 v[120:135], v[224:227], v[112:115], v[120:135]
v_exp_f16_sdwa v147, v148 dst_sel:WORD_1 dst_unused:UNUSED_PRESERVE src0_sel:WORD_1
v_lshrrev_b32_e64 v141, 18, v141
v_pk_add_f16 v153, v153, 1.0 op_sel_hi:[1,0]
v_lshrrev_b32 v143, 18, v143
s_setprio 0
v_pk_add_f16 v150, v150, 1.0 op_sel_hi:[1,0]
v_pk_add_f16 v147, v147, 1.0 op_sel_hi:[1,0]
v_and_b32_e64 v145, s49, v145
v_rcp_f16 v154, v153
v_bfe_u32 v144, v145, 2, 14
s_waitcnt lgkmcnt(4)
ds_read_b128 v[224:227], v248 offset:54272
ds_read_u16_d16_hi v141, v141
ds_read_u16_d16_hi v143, v143
ds_read_u16_d16 v144, v144
v_mfma_f32_32x32x16_bf16 v[120:135], v[228:231], v[116:119], v[120:135]
v_rcp_f16 v151, v150
v_lshrrev_b32 v145, 18, v145
v_rcp_f16_e64 v148, v147
ds_read_u16_d16_hi v145, v145
v_or_b32 v168, v136, v137
s_waitcnt lgkmcnt(7)
v_or_b32_e64 v169, v138, v139
v_rcp_f16_sdwa v154, v153 dst_sel:WORD_1 dst_unused:UNUSED_PRESERVE src0_sel:WORD_1
s_waitcnt lgkmcnt(3)
v_or_b32 v170, v140, v141
v_rcp_f16_sdwa v151, v150 dst_sel:WORD_1 dst_unused:UNUSED_PRESERVE src0_sel:WORD_1
s_waitcnt lgkmcnt(2)
v_or_b32 v171, v142, v143
v_rcp_f16_sdwa v148, v147 dst_sel:WORD_1 dst_unused:UNUSED_PRESERVE src0_sel:WORD_1
s_waitcnt lgkmcnt(0)
v_or_b32 v172, v144, v145
v_pk_mul_f16 v173, v155, v154
v_pk_mul_f16 v174, v152, v151
v_pk_mul_f16 v175, v149, v148
s_cmp_eq_u32 s77, 0
s_cbranch_scc1 Lpp49
s_getreg_b32 s43, hwreg(HW_REG_IB_STS, 0, 4)
s_cmp_lg_u32 s43, 0
s_cbranch_scc1 Lpp49
s_call_b64 s[78:79], Lpoll
s_setprio 0
Lpp49:
s_setprio 2
v_cvt_pkrtz_f16_f32 v137, v120, v121
v_cvt_pkrtz_f16_f32 v139, v122, v123
v_cvt_pkrtz_f16_f32 v141, v124, v125
v_cvt_pkrtz_f16_f32 v143, v126, v127
v_cvt_pkrtz_f16_f32 v145, v128, v129
v_cvt_pk_f16_f32 v155, v130, v131
v_cvt_pk_f16_f32 v152, v132, v133
v_cvt_pk_f16_f32 v149, v134, v135
ds_read_b128 v[228:231], v248 offset:57344
v_mfma_f32_32x32x16_bf16 v[120:135], v[232:235], v[96:99], 0
v_pk_fma_f16 v154, v155, v155, s48
v_permlane16_swap_b32 v168, v172
v_and_b32 v137, s49, v137
v_pk_fma_f16 v151, v152, v152, s48
v_and_b32_e64 v139, s49, v139
v_pk_fma_f16 v148, v149, v149, s48
v_pk_mul_f16 v154, v155, v154
v_bfe_u32 v136, v137, 2, 14
v_pk_mul_f16 v151, v152, v151
ds_read_b128 v[232:235], v248 offset:55296
ds_read_u16_d16 v136, v136
v_mfma_f32_32x32x16_bf16 v[120:135], v[236:239], v[100:103], v[120:135]
v_pk_mul_f16 v148, v149, v148
v_bfe_u32 v138, v139, 2, 14
v_exp_f16 v153, v154
v_lshrrev_b32 v137, 18, v137
v_exp_f16 v150, v151
v_permlane16_swap_b32 v169, v173
v_lshrrev_b32_e64 v139, 18, v139
ds_read_b128 v[236:239], v248 offset:58368
ds_read_u16_d16 v138, v138
ds_read_u16_d16_hi v137, v137
ds_read_u16_d16_hi v139, v139
v_mfma_f32_32x32x16_bf16 v[120:135], v[224:227], v[104:107], v[120:135]
v_exp_f16 v147, v148
v_and_b32 v141, s49, v141
v_and_b32 v143, s49, v143
v_exp_f16_sdwa v153, v154 dst_sel:WORD_1 dst_unused:UNUSED_PRESERVE src0_sel:WORD_1
v_bfe_u32 v140, v141, 2, 14
v_exp_f16_sdwa v150, v151 dst_sel:WORD_1 dst_unused:UNUSED_PRESERVE src0_sel:WORD_1
s_waitcnt lgkmcnt(6)
ds_read_b128 v[224:227], v248 offset:59392
ds_read_u16_d16 v140, v140
v_mfma_f32_32x32x16_bf16 v[120:135], v[228:231], v[108:111], v[120:135]
v_bfe_u32 v142, v143, 2, 14
v_exp_f16_sdwa v147, v148 dst_sel:WORD_1 dst_unused:UNUSED_PRESERVE src0_sel:WORD_1
v_lshrrev_b32 v141, 18, v141
v_permlane16_swap_b32 v170, v174
v_pk_add_f16 v153, v153, 1.0 op_sel_hi:[1,0]
v_lshrrev_b32 v143, 18, v143
v_pk_add_f16 v150, v150, 1.0 op_sel_hi:[1,0]
v_pk_add_f16 v147, v147, 1.0 op_sel_hi:[1,0]
s_waitcnt lgkmcnt(6)
ds_read_b128 v[228:231], v248 offset:62464
ds_read_u16_d16 v142, v142
ds_read_u16_d16_hi v141, v141
ds_read_u16_d16_hi v143, v143
v_mfma_f32_32x32x16_bf16 v[120:135], v[232:235], v[112:115], v[120:135]
v_and_b32 v145, s49, v145
v_rcp_f16 v154, v153
v_bfe_u32 v144, v145, 2, 14
v_rcp_f16 v151, v150
v_lshrrev_b32 v145, 18, v145
v_rcp_f16 v148, v147
s_waitcnt lgkmcnt(6)
ds_read_b128 v[232:235], v248 offset:60416
ds_read_u16_d16 v144, v144
ds_read_u16_d16_hi v145, v145
v_mfma_f32_32x32x16_bf16 v[120:135], v[236:239], v[116:119], v[120:135]
v_or_b32 v176, v136, v137
v_permlane16_swap_b32 v171, v175
v_or_b32_e64 v177, v138, v139
v_rcp_f16_sdwa v154, v153 dst_sel:WORD_1 dst_unused:UNUSED_PRESERVE src0_sel:WORD_1
s_waitcnt lgkmcnt(4)
v_or_b32 v178, v140, v141
v_rcp_f16_sdwa v151, v150 dst_sel:WORD_1 dst_unused:UNUSED_PRESERVE src0_sel:WORD_1
s_waitcnt lgkmcnt(3)
v_or_b32 v179, v142, v143
v_rcp_f16_sdwa v148, v147 dst_sel:WORD_1 dst_unused:UNUSED_PRESERVE src0_sel:WORD_1
s_waitcnt lgkmcnt(0)
v_or_b32 v180, v144, v145
v_pk_mul_f16 v181, v155, v154
v_pk_mul_f16 v182, v152, v151
v_pk_mul_f16 v183, v149, v148
s_cmp_eq_u32 s77, 0
s_cbranch_scc1 Lpp50
s_getreg_b32 s43, hwreg(HW_REG_IB_STS, 0, 4)
s_cmp_lg_u32 s43, 0
s_cbranch_scc1 Lpp50
s_call_b64 s[78:79], Lpoll
s_setprio 2
Lpp50:
s_setprio 1
v_cvt_pkrtz_f16_f32 v137, v120, v121
v_cvt_pkrtz_f16_f32 v139, v122, v123
v_cvt_pkrtz_f16_f32 v141, v124, v125
v_cvt_pkrtz_f16_f32 v143, v126, v127
v_cvt_pkrtz_f16_f32 v145, v128, v129
v_cvt_pk_f16_f32 v155, v130, v131
v_cvt_pk_f16_f32 v152, v132, v133
v_cvt_pk_f16_f32 v149, v134, v135
ds_read_b128 v[236:239], v248 offset:63488
v_mfma_f32_32x32x16_bf16 v[120:135], v[224:227], v[96:99], 0
v_pk_fma_f16 v154, v155, v155, s48
v_permlane16_swap_b32 v176, v180
v_and_b32 v137, s49, v137
v_pk_fma_f16 v151, v152, v152, s48
v_and_b32_e64 v139, s49, v139
v_pk_fma_f16 v148, v149, v149, s48
v_pk_mul_f16 v154, v155, v154
v_bfe_u32 v136, v137, 2, 14
v_pk_mul_f16 v151, v152, v151
ds_read_b128 v[224:227], v248 offset:61440
ds_read_u16_d16 v136, v136
v_mfma_f32_32x32x16_bf16 v[120:135], v[228:231], v[100:103], v[120:135]
v_pk_mul_f16 v148, v149, v148
v_bfe_u32 v138, v139, 2, 14
v_exp_f16 v153, v154
v_lshrrev_b32 v137, 18, v137
v_exp_f16 v150, v151
v_permlane16_swap_b32 v177, v181
v_lshrrev_b32_e64 v139, 18, v139
ds_read_b128 v[228:231], v248 offset:64512
ds_read_u16_d16 v138, v138
ds_read_u16_d16_hi v137, v137
ds_read_u16_d16_hi v139, v139
v_mfma_f32_32x32x16_bf16 v[120:135], v[232:235], v[104:107], v[120:135]
v_exp_f16 v147, v148
v_and_b32 v141, s49, v141
v_and_b32 v143, s49, v143
v_exp_f16_sdwa v153, v154 dst_sel:WORD_1 dst_unused:UNUSED_PRESERVE src0_sel:WORD_1
v_bfe_u32 v140, v141, 2, 14
v_exp_f16_sdwa v150, v151 dst_sel:WORD_1 dst_unused:UNUSED_PRESERVE src0_sel:WORD_1
s_waitcnt lgkmcnt(6)
ds_read_b128 v[232:235], v249
ds_read_u16_d16 v140, v140
v_mfma_f32_32x32x16_bf16 v[120:135], v[236:239], v[108:111], v[120:135]
v_bfe_u32 v142, v143, 2, 14
v_exp_f16_sdwa v147, v148 dst_sel:WORD_1 dst_unused:UNUSED_PRESERVE src0_sel:WORD_1
v_lshrrev_b32 v141, 18, v141
v_permlane16_swap_b32 v178, v182
v_pk_add_f16 v153, v153, 1.0 op_sel_hi:[1,0]
v_lshrrev_b32 v143, 18, v143
v_pk_add_f16 v150, v150, 1.0 op_sel_hi:[1,0]
v_pk_add_f16 v147, v147, 1.0 op_sel_hi:[1,0]
s_waitcnt lgkmcnt(6)
ds_read_b128 v[236:239], v249 offset:3072
ds_read_u16_d16 v142, v142
ds_read_u16_d16_hi v141, v141
ds_read_u16_d16_hi v143, v143
v_mfma_f32_32x32x16_bf16 v[120:135], v[224:227], v[112:115], v[120:135]
v_and_b32 v145, s49, v145
v_rcp_f16 v154, v153
v_bfe_u32 v144, v145, 2, 14
s_setprio 0
v_rcp_f16 v151, v150
v_lshrrev_b32_e64 v145, 18, v145
v_rcp_f16 v148, v147
s_waitcnt lgkmcnt(6)
ds_read_b128 v[224:227], v249 offset:1024
ds_read_u16_d16 v144, v144
ds_read_u16_d16_hi v145, v145
v_mfma_f32_32x32x16_bf16 v[120:135], v[228:231], v[116:119], v[120:135]
v_or_b32 v184, v136, v137
v_permlane16_swap_b32 v179, v183
v_or_b32_e64 v185, v138, v139
v_rcp_f16_sdwa v154, v153 dst_sel:WORD_1 dst_unused:UNUSED_PRESERVE src0_sel:WORD_1
s_waitcnt lgkmcnt(4)
v_or_b32 v186, v140, v141
v_rcp_f16_sdwa v151, v150 dst_sel:WORD_1 dst_unused:UNUSED_PRESERVE src0_sel:WORD_1
s_waitcnt lgkmcnt(3)
v_or_b32 v187, v142, v143
v_rcp_f16_sdwa v148, v147 dst_sel:WORD_1 dst_unused:UNUSED_PRESERVE src0_sel:WORD_1
s_waitcnt lgkmcnt(0)
v_or_b32_e64 v188, v144, v145
v_pk_mul_f16 v189, v155, v154
v_pk_mul_f16 v190, v152, v151
v_pk_mul_f16 v191, v149, v148
s_cmp_eq_u32 s77, 0
s_cbranch_scc1 Lpp51
s_getreg_b32 s43, hwreg(HW_REG_IB_STS, 0, 4)
s_cmp_lg_u32 s43, 0
s_cbranch_scc1 Lpp51
s_call_b64 s[78:79], Lpoll
s_setprio 0
Lpp51:
v_mov_b32 v253, 16256
Lw2w:
ds_read_b32 v254, v253 offset:4
s_waitcnt lgkmcnt(0)
v_readfirstlane_b32 s43, v254
s_cmp_eq_u32 s76, 0
s_cbranch_scc1 Lw2x
s_sub_u32 s76, s76, 1
s_cmp_lt_u32 s43, 1
s_cbranch_scc0 Lw2x
s_sleep 2
s_branch Lw2w
Lw2x:
s_add_u32 m0, s72, 7168
s_add_u32 s43, s82, 6208
buffer_load_dwordx4 v252, s[16:19], s43 offen lds
s_add_u32 m0, s72, 8192
s_add_u32 s43, s82, 6272
buffer_load_dwordx4 v252, s[16:19], s43 offen lds
s_setprio 2
v_cvt_pkrtz_f16_f32 v137, v120, v121
v_cvt_pkrtz_f16_f32 v139, v122, v123
v_cvt_pkrtz_f16_f32 v141, v124, v125
v_cvt_pkrtz_f16_f32 v143, v126, v127
v_cvt_pkrtz_f16_f32 v145, v128, v129
v_cvt_pk_f16_f32 v155, v130, v131
v_cvt_pk_f16_f32 v152, v132, v133
v_cvt_pk_f16_f32 v149, v134, v135
ds_read_b128 v[228:231], v249 offset:4096
v_mfma_f32_32x32x16_bf16 v[120:135], v[232:235], v[96:99], 0
v_pk_fma_f16 v154, v155, v155, s48
v_permlane16_swap_b32 v184, v188
v_and_b32 v137, s49, v137
v_pk_fma_f16 v151, v152, v152, s48
v_and_b32_e64 v139, s49, v139
v_pk_fma_f16 v148, v149, v149, s48
v_pk_mul_f16 v154, v155, v154
v_bfe_u32 v136, v137, 2, 14
v_pk_mul_f16 v151, v152, v151
ds_read_b128 v[232:235], v249 offset:2048
ds_read_u16_d16 v136, v136
v_mfma_f32_32x32x16_bf16 v[120:135], v[236:239], v[100:103], v[120:135]
v_pk_mul_f16 v148, v149, v148
v_bfe_u32 v138, v139, 2, 14
v_exp_f16 v153, v154
v_lshrrev_b32 v137, 18, v137
v_exp_f16 v150, v151
v_permlane16_swap_b32 v185, v189
v_lshrrev_b32_e64 v139, 18, v139
ds_read_b128 v[236:239], v249 offset:5120
ds_read_u16_d16 v138, v138
ds_read_u16_d16_hi v137, v137
ds_read_u16_d16_hi v139, v139
v_mfma_f32_32x32x16_bf16 v[120:135], v[224:227], v[104:107], v[120:135]
v_exp_f16 v147, v148
v_and_b32 v141, s49, v141
v_and_b32 v143, s49, v143
v_exp_f16_sdwa v153, v154 dst_sel:WORD_1 dst_unused:UNUSED_PRESERVE src0_sel:WORD_1
v_bfe_u32 v140, v141, 2, 14
v_exp_f16_sdwa v150, v151 dst_sel:WORD_1 dst_unused:UNUSED_PRESERVE src0_sel:WORD_1
s_waitcnt lgkmcnt(6)
ds_read_b128 v[224:227], v249 offset:6144
ds_read_u16_d16 v140, v140
v_mfma_f32_32x32x16_bf16 v[120:135], v[228:231], v[108:111], v[120:135]
v_bfe_u32 v142, v143, 2, 14
v_exp_f16_sdwa v147, v148 dst_sel:WORD_1 dst_unused:UNUSED_PRESERVE src0_sel:WORD_1
v_lshrrev_b32 v141, 18, v141
v_permlane16_swap_b32 v186, v190
v_pk_add_f16 v153, v153, 1.0 op_sel_hi:[1,0]
v_lshrrev_b32 v143, 18, v143
v_pk_add_f16 v150, v150, 1.0 op_sel_hi:[1,0]
v_pk_add_f16 v147, v147, 1.0 op_sel_hi:[1,0]
s_waitcnt lgkmcnt(6)
ds_read_b128 v[228:231], v249 offset:9216
ds_read_u16_d16 v142, v142
ds_read_u16_d16_hi v141, v141
ds_read_u16_d16_hi v143, v143
v_mfma_f32_32x32x16_bf16 v[120:135], v[232:235], v[112:115], v[120:135]
v_and_b32 v145, s49, v145
v_rcp_f16 v154, v153
v_bfe_u32 v144, v145, 2, 14
v_rcp_f16 v151, v150
v_lshrrev_b32 v145, 18, v145
v_rcp_f16 v148, v147
s_waitcnt lgkmcnt(6)
ds_read_b128 v[232:235], v249 offset:7168
ds_read_u16_d16 v144, v144
ds_read_u16_d16_hi v145, v145
v_mfma_f32_32x32x16_bf16 v[120:135], v[236:239], v[116:119], v[120:135]
v_or_b32 v192, v136, v137
v_permlane16_swap_b32 v187, v191
v_or_b32_e64 v193, v138, v139
v_rcp_f16_sdwa v154, v153 dst_sel:WORD_1 dst_unused:UNUSED_PRESERVE src0_sel:WORD_1
s_waitcnt lgkmcnt(4)
v_or_b32 v194, v140, v141
v_rcp_f16_sdwa v151, v150 dst_sel:WORD_1 dst_unused:UNUSED_PRESERVE src0_sel:WORD_1
s_waitcnt lgkmcnt(3)
v_or_b32 v195, v142, v143
v_rcp_f16_sdwa v148, v147 dst_sel:WORD_1 dst_unused:UNUSED_PRESERVE src0_sel:WORD_1
s_waitcnt lgkmcnt(0)
v_or_b32 v196, v144, v145
v_pk_mul_f16 v197, v155, v154
v_pk_mul_f16 v198, v152, v151
v_pk_mul_f16 v199, v149, v148
s_cmp_eq_u32 s77, 0
s_cbranch_scc1 Lpp52
s_getreg_b32 s43, hwreg(HW_REG_IB_STS, 0, 4)
s_cmp_lg_u32 s43, 0
s_cbranch_scc1 Lpp52
s_call_b64 s[78:79], Lpoll
s_setprio 2
Lpp52:
s_setprio 1
v_cvt_pkrtz_f16_f32 v137, v120, v121
v_cvt_pkrtz_f16_f32 v139, v122, v123
v_cvt_pkrtz_f16_f32 v141, v124, v125
v_cvt_pkrtz_f16_f32 v143, v126, v127
v_cvt_pkrtz_f16_f32 v145, v128, v129
v_cvt_pk_f16_f32 v155, v130, v131
v_cvt_pk_f16_f32 v152, v132, v133
v_cvt_pk_f16_f32 v149, v134, v135
ds_read_b128 v[236:239], v249 offset:10240
v_mfma_f32_32x32x16_bf16 v[120:135], v[224:227], v[96:99], 0
v_pk_fma_f16 v154, v155, v155, s48
v_permlane16_swap_b32 v192, v196
v_and_b32 v137, s49, v137
v_pk_fma_f16 v151, v152, v152, s48
v_and_b32_e64 v139, s49, v139
v_pk_fma_f16 v148, v149, v149, s48
v_pk_mul_f16 v154, v155, v154
v_bfe_u32 v136, v137, 2, 14
v_pk_mul_f16 v151, v152, v151
ds_read_b128 v[224:227], v249 offset:8192
ds_read_u16_d16 v136, v136
v_mfma_f32_32x32x16_bf16 v[120:135], v[228:231], v[100:103], v[120:135]
v_pk_mul_f16 v148, v149, v148
v_bfe_u32 v138, v139, 2, 14
v_exp_f16 v153, v154
v_lshrrev_b32 v137, 18, v137
v_exp_f16 v150, v151
v_permlane16_swap_b32 v193, v197
v_lshrrev_b32_e64 v139, 18, v139
ds_read_b128 v[228:231], v249 offset:11264
ds_read_u16_d16 v138, v138
ds_read_u16_d16_hi v137, v137
ds_read_u16_d16_hi v139, v139
v_mfma_f32_32x32x16_bf16 v[120:135], v[232:235], v[104:107], v[120:135]
v_exp_f16 v147, v148
v_and_b32 v141, s49, v141
v_and_b32 v143, s49, v143
v_exp_f16_sdwa v153, v154 dst_sel:WORD_1 dst_unused:UNUSED_PRESERVE src0_sel:WORD_1
v_bfe_u32 v140, v141, 2, 14
v_exp_f16_sdwa v150, v151 dst_sel:WORD_1 dst_unused:UNUSED_PRESERVE src0_sel:WORD_1
s_waitcnt lgkmcnt(6)
ds_read_u16_d16 v140, v140
v_mfma_f32_32x32x16_bf16 v[120:135], v[236:239], v[108:111], v[120:135]
v_bfe_u32 v142, v143, 2, 14
v_exp_f16_sdwa v147, v148 dst_sel:WORD_1 dst_unused:UNUSED_PRESERVE src0_sel:WORD_1
v_lshrrev_b32 v141, 18, v141
v_permlane16_swap_b32 v194, v198
v_pk_add_f16 v153, v153, 1.0 op_sel_hi:[1,0]
v_lshrrev_b32 v143, 18, v143
v_pk_add_f16 v150, v150, 1.0 op_sel_hi:[1,0]
v_pk_add_f16 v147, v147, 1.0 op_sel_hi:[1,0]
s_waitcnt lgkmcnt(5)
ds_read_u16_d16 v142, v142
ds_read_u16_d16_hi v141, v141
ds_read_u16_d16_hi v143, v143
v_mfma_f32_32x32x16_bf16 v[120:135], v[224:227], v[112:115], v[120:135]
v_and_b32 v145, s49, v145
v_rcp_f16 v154, v153
v_bfe_u32 v144, v145, 2, 14
s_setprio 0
v_rcp_f16 v151, v150
v_lshrrev_b32_e64 v145, 18, v145
v_rcp_f16 v148, v147
s_waitcnt lgkmcnt(4)
ds_read_u16_d16 v144, v144
ds_read_u16_d16_hi v145, v145
v_mfma_f32_32x32x16_bf16 v[120:135], v[228:231], v[116:119], v[120:135]
v_or_b32 v200, v136, v137
v_permlane16_swap_b32 v195, v199
v_or_b32_e64 v201, v138, v139
v_rcp_f16_sdwa v154, v153 dst_sel:WORD_1 dst_unused:UNUSED_PRESERVE src0_sel:WORD_1
s_waitcnt lgkmcnt(3)
v_or_b32 v202, v140, v141
v_rcp_f16_sdwa v151, v150 dst_sel:WORD_1 dst_unused:UNUSED_PRESERVE src0_sel:WORD_1
s_waitcnt lgkmcnt(2)
v_or_b32 v203, v142, v143
v_rcp_f16_sdwa v148, v147 dst_sel:WORD_1 dst_unused:UNUSED_PRESERVE src0_sel:WORD_1
s_waitcnt lgkmcnt(0)
v_or_b32 v204, v144, v145
v_pk_mul_f16 v205, v155, v154
v_pk_mul_f16 v206, v152, v151
v_pk_mul_f16 v207, v149, v148
s_cmp_eq_u32 s77, 0
s_cbranch_scc1 Lpp53
s_getreg_b32 s43, hwreg(HW_REG_IB_STS, 0, 4)
s_cmp_lg_u32 s43, 0
s_cbranch_scc1 Lpp53
s_call_b64 s[78:79], Lpoll
s_setprio 0
Lpp53:
s_setprio 2
v_cvt_pkrtz_f16_f32 v137, v120, v121
v_cvt_pkrtz_f16_f32 v139, v122, v123
v_cvt_pkrtz_f16_f32 v141, v124, v125
v_cvt_pkrtz_f16_f32 v143, v126, v127
v_cvt_pkrtz_f16_f32 v145, v128, v129
v_cvt_pk_f16_f32 v155, v130, v131
v_cvt_pk_f16_f32 v152, v132, v133
v_cvt_pk_f16_f32 v149, v134, v135
v_pk_fma_f16 v154, v155, v155, s48
v_permlane16_swap_b32 v96, v100
v_permlane16_swap_b32 v200, v204
v_and_b32_e64 v137, s49, v137
v_pk_fma_f16 v151, v152, v152, s48
v_and_b32 v139, s49, v139
v_pk_fma_f16 v148, v149, v149, s48
v_permlane16_swap_b32 v97, v101
v_pk_mul_f16 v154, v155, v154
v_bfe_u32 v136, v137, 2, 14
v_pk_mul_f16 v151, v152, v151
v_pk_mul_f16 v148, v149, v148
v_bfe_u32 v138, v139, 2, 14
v_permlane16_swap_b32 v98, v102
v_exp_f16 v153, v154
v_lshrrev_b32 v137, 18, v137
v_exp_f16 v150, v151
v_permlane16_swap_b32 v99, v103
v_permlane16_swap_b32 v201, v205
v_lshrrev_b32 v139, 18, v139
v_exp_f16 v147, v148
v_and_b32 v141, s49, v141
v_permlane16_swap_b32 v104, v108
v_and_b32_e64 v143, s49, v143
ds_read_u16_d16 v136, v136
ds_read_u16_d16 v138, v138
ds_read_u16_d16_hi v137, v137
ds_read_u16_d16_hi v139, v139
v_exp_f16_sdwa v153, v154 dst_sel:WORD_1 dst_unused:UNUSED_PRESERVE src0_sel:WORD_1
v_bfe_u32 v140, v141, 2, 14
v_exp_f16_sdwa v150, v151 dst_sel:WORD_1 dst_unused:UNUSED_PRESERVE src0_sel:WORD_1
v_permlane16_swap_b32 v105, v109
v_bfe_u32 v142, v143, 2, 14
v_exp_f16_sdwa v147, v148 dst_sel:WORD_1 dst_unused:UNUSED_PRESERVE src0_sel:WORD_1
v_lshrrev_b32 v141, 18, v141
v_permlane16_swap_b32 v106, v110
v_permlane16_swap_b32 v202, v206
v_pk_add_f16 v153, v153, 1.0 op_sel_hi:[1,0]
v_lshrrev_b32_e64 v143, 18, v143
v_pk_add_f16 v150, v150, 1.0 op_sel_hi:[1,0]
v_pk_add_f16 v147, v147, 1.0 op_sel_hi:[1,0]
v_permlane16_swap_b32 v107, v111
v_and_b32 v145, s49, v145
v_rcp_f16_e64 v154, v153
v_bfe_u32 v144, v145, 2, 14
v_rcp_f16 v151, v150
v_permlane16_swap_b32 v112, v116
v_lshrrev_b32_e64 v145, 18, v145
ds_read_u16_d16 v140, v140
ds_read_u16_d16 v142, v142
ds_read_u16_d16_hi v141, v141
ds_read_u16_d16_hi v143, v143
ds_read_u16_d16 v144, v144
ds_read_u16_d16_hi v145, v145
v_rcp_f16 v148, v147
s_waitcnt lgkmcnt(6)
v_or_b32 v232, v136, v137
v_permlane16_swap_b32 v113, v117
v_permlane16_swap_b32 v203, v207
v_or_b32 v233, v138, v139
v_rcp_f16_sdwa v154, v153 dst_sel:WORD_1 dst_unused:UNUSED_PRESERVE src0_sel:WORD_1
s_waitcnt lgkmcnt(3)
v_or_b32 v234, v140, v141
v_permlane16_swap_b32 v114, v118
v_rcp_f16_sdwa v151, v150 dst_sel:WORD_1 dst_unused:UNUSED_PRESERVE src0_sel:WORD_1
s_waitcnt lgkmcnt(2)
v_or_b32_e64 v235, v142, v143
v_rcp_f16_sdwa v148, v147 dst_sel:WORD_1 dst_unused:UNUSED_PRESERVE src0_sel:WORD_1
v_permlane16_swap_b32 v115, v119
s_waitcnt lgkmcnt(0)
v_or_b32_e64 v236, v144, v145
v_pk_mul_f16 v237, v155, v154
v_pk_mul_f16 v238, v152, v151
v_pk_mul_f16 v239, v149, v148
s_cmp_eq_u32 s77, 0
s_cbranch_scc1 Lpp54
s_getreg_b32 s43, hwreg(HW_REG_IB_STS, 0, 4)
s_cmp_lg_u32 s43, 0
s_cbranch_scc1 Lpp54
s_call_b64 s[78:79], Lpoll
s_setprio 2
Lpp54:
s_setprio 1
v_permlane16_swap_b32 v232, v236
v_permlane16_swap_b32 v233, v237
v_permlane16_swap_b32 v234, v238
s_setprio 0
v_permlane16_swap_b32 v235, v239
s_cmp_eq_u32 s77, 0
s_cbranch_scc1 Lpp55
s_getreg_b32 s43, hwreg(HW_REG_IB_STS, 0, 4)
s_cmp_lg_u32 s43, 0
s_cbranch_scc1 Lpp55
s_call_b64 s[78:79], Lpoll
s_setprio 0
Lpp55:
s_setprio 2
v_lshrrev_b32 v225, 5, v251
v_lshl_add_u32 v224, v225, 9, s72
v_lshl_add_u32 v226, v225, 4, s72
v_and_b32 v225, 15, v251
v_lshl_add_u32 v224, v225, 4, v224
v_bfe_u32 v225, v251, 4, 1
v_lshl_add_u32 v224, v225, 3, v224
s_waitcnt vmcnt(0)
ds_read_b64_tr_b16 v[120:121], v224
ds_read_b64_tr_b16 v[122:123], v224 offset:256
ds_read_b64_tr_b16 v[124:125], v224 offset:1024
ds_read_b64_tr_b16 v[126:127], v224 offset:1280
ds_read_b64_tr_b16 v[128:129], v224 offset:2048
ds_read_b64_tr_b16 v[130:131], v224 offset:2304
ds_read_b64_tr_b16 v[132:133], v224 offset:3072
ds_read_b64_tr_b16 v[134:135], v224 offset:3328
ds_read_b64_tr_b16 v[136:137], v224 offset:4096
ds_read_b64_tr_b16 v[138:139], v224 offset:4352
ds_read_b64_tr_b16 v[140:141], v224 offset:5120
ds_read_b64_tr_b16 v[142:143], v224 offset:5376
ds_read_b64_tr_b16 v[144:145], v224 offset:6144
ds_read_b64_tr_b16 v[146:147], v224 offset:6400
ds_read_b64_tr_b16 v[148:149], v224 offset:7168
ds_read_b64_tr_b16 v[150:151], v224 offset:7424
ds_read_b64_tr_b16 v[152:153], v224 offset:8192
ds_read_b64_tr_b16 v[154:155], v224 offset:8448
v_lshrrev_b32 v225, 4, v251
v_and_b32 v227, 15, v251
v_mul_u32_u24 v252, 192, v227
v_lshl_add_u32 v252, v225, 4, v252
v_lshlrev_b32 v254, 5, v225
v_and_b32 v253, 47, v251
v_lshlrev_b32 v253, 4, v253
v_and_b32 v225, 1, v225
v_mul_u32_u24 v227, 3072, v225
v_add_u32_e64 v248, v227, v253
v_add_u32 v249, 65536, v248
v_add_u32 v250, 131072, v248
v_lshl_add_u32 v253, v225, 21, v253
v_mov_b32 v225, 16256
v_mov_b32_e64 v227, 1
s_waitcnt lgkmcnt(0)
s_mov_b64 exec, 1
ds_add_u32 v225, v227 offset:8
s_mov_b64 exec, -1
v_lshlrev_b32 v228, 16, v120
v_and_b32 v229, 4294901760, v120
v_cvt_pk_f16_f32 v120, v228, v229
v_lshlrev_b32_e64 v230, 16, v121
v_and_b32 v231, 4294901760, v121
v_cvt_pk_f16_f32 v121, v230, v231
v_lshlrev_b32_e64 v228, 16, v122
v_and_b32 v229, 4294901760, v122
v_cvt_pk_f16_f32 v122, v228, v229
v_lshlrev_b32_e64 v230, 16, v123
v_and_b32 v231, 4294901760, v123
v_cvt_pk_f16_f32 v123, v230, v231
v_lshlrev_b32_e64 v228, 16, v124
v_and_b32 v229, 4294901760, v124
v_cvt_pk_f16_f32 v124, v228, v229
v_lshlrev_b32_e64 v230, 16, v125
v_and_b32 v231, 4294901760, v125
v_cvt_pk_f16_f32 v125, v230, v231
v_lshlrev_b32_e64 v228, 16, v126
v_and_b32 v229, 4294901760, v126
v_cvt_pk_f16_f32 v126, v228, v229
v_lshlrev_b32_e64 v230, 16, v127
v_and_b32 v231, 4294901760, v127
v_cvt_pk_f16_f32 v127, v230, v231
v_lshlrev_b32_e64 v228, 16, v128
v_and_b32 v229, 4294901760, v128
v_cvt_pk_f16_f32 v128, v228, v229
v_lshlrev_b32_e64 v230, 16, v129
v_and_b32 v231, 4294901760, v129
v_cvt_pk_f16_f32 v129, v230, v231
v_lshlrev_b32_e64 v228, 16, v130
v_and_b32 v229, 4294901760, v130
v_cvt_pk_f16_f32 v130, v228, v229
v_lshlrev_b32_e64 v230, 16, v131
v_and_b32 v231, 4294901760, v131
v_cvt_pk_f16_f32 v131, v230, v231
s_cmp_eq_u32 s77, 0
s_cbranch_scc1 Lpp911
s_getreg_b32 s43, hwreg(HW_REG_IB_STS, 0, 4)
s_cmp_lg_u32 s43, 0
s_cbranch_scc1 Lpp911
s_call_b64 s[78:79], Lpoll
s_setprio 2
Lpp911:
v_lshlrev_b32 v228, 16, v132
v_and_b32 v229, 4294901760, v132
v_cvt_pk_f16_f32 v132, v228, v229
v_lshlrev_b32_e64 v230, 16, v133
v_and_b32 v231, 4294901760, v133
v_cvt_pk_f16_f32 v133, v230, v231
v_lshlrev_b32_e64 v228, 16, v134
v_and_b32 v229, 4294901760, v134
v_cvt_pk_f16_f32 v134, v228, v229
v_lshlrev_b32_e64 v230, 16, v135
v_and_b32 v231, 4294901760, v135
v_cvt_pk_f16_f32 v135, v230, v231
v_lshlrev_b32_e64 v228, 16, v136
v_and_b32 v229, 4294901760, v136
v_cvt_pk_f16_f32 v136, v228, v229
v_lshlrev_b32_e64 v230, 16, v137
v_and_b32 v231, 4294901760, v137
v_cvt_pk_f16_f32 v137, v230, v231
v_lshlrev_b32_e64 v228, 16, v138
v_and_b32 v229, 4294901760, v138
v_cvt_pk_f16_f32 v138, v228, v229
v_lshlrev_b32_e64 v230, 16, v139
v_and_b32 v231, 4294901760, v139
v_cvt_pk_f16_f32 v139, v230, v231
v_lshlrev_b32_e64 v228, 16, v140
v_and_b32 v229, 4294901760, v140
v_cvt_pk_f16_f32 v140, v228, v229
v_lshlrev_b32_e64 v230, 16, v141
v_and_b32 v231, 4294901760, v141
v_cvt_pk_f16_f32 v141, v230, v231
v_lshlrev_b32_e64 v228, 16, v142
v_and_b32 v229, 4294901760, v142
v_cvt_pk_f16_f32 v142, v228, v229
v_lshlrev_b32_e64 v230, 16, v143
v_and_b32 v231, 4294901760, v143
v_cvt_pk_f16_f32 v143, v230, v231
s_cmp_eq_u32 s77, 0
s_cbranch_scc1 Lpp923
s_getreg_b32 s43, hwreg(HW_REG_IB_STS, 0, 4)
s_cmp_lg_u32 s43, 0
s_cbranch_scc1 Lpp923
s_call_b64 s[78:79], Lpoll
s_setprio 2
Lpp923:
v_lshlrev_b32 v228, 16, v144
v_and_b32 v229, 4294901760, v144
v_cvt_pk_f16_f32 v144, v228, v229
v_lshlrev_b32_e64 v230, 16, v145
v_and_b32 v231, 4294901760, v145
v_cvt_pk_f16_f32 v145, v230, v231
v_lshlrev_b32_e64 v228, 16, v146
v_and_b32 v229, 4294901760, v146
v_cvt_pk_f16_f32 v146, v228, v229
v_lshlrev_b32_e64 v230, 16, v147
v_and_b32 v231, 4294901760, v147
v_cvt_pk_f16_f32 v147, v230, v231
v_lshlrev_b32_e64 v228, 16, v148
v_and_b32 v229, 4294901760, v148
v_cvt_pk_f16_f32 v148, v228, v229
v_lshlrev_b32_e64 v230, 16, v149
v_and_b32 v231, 4294901760, v149
v_cvt_pk_f16_f32 v149, v230, v231
v_lshlrev_b32_e64 v228, 16, v150
v_and_b32 v229, 4294901760, v150
v_cvt_pk_f16_f32 v150, v228, v229
v_lshlrev_b32_e64 v230, 16, v151
v_and_b32 v231, 4294901760, v151
v_cvt_pk_f16_f32 v151, v230, v231
v_lshlrev_b32_e64 v228, 16, v152
v_and_b32 v229, 4294901760, v152
v_cvt_pk_f16_f32 v152, v228, v229
v_lshlrev_b32_e64 v230, 16, v153
v_and_b32 v231, 4294901760, v153
v_cvt_pk_f16_f32 v153, v230, v231
v_lshlrev_b32_e64 v228, 16, v154
v_and_b32 v229, 4294901760, v154
v_cvt_pk_f16_f32 v154, v228, v229
v_lshlrev_b32_e64 v230, 16, v155
v_and_b32 v231, 4294901760, v155
v_cvt_pk_f16_f32 v155, v230, v231
s_cmp_eq_u32 s77, 0
s_cbranch_scc1 Lpp935
s_getreg_b32 s43, hwreg(HW_REG_IB_STS, 0, 4)
s_cmp_lg_u32 s43, 0
s_cbranch_scc1 Lpp935
s_call_b64 s[78:79], Lpoll
s_setprio 2
Lpp935:
v_lshl_add_u32 v224, v251, 4, s72
s_cmp_lg_u32 s40, 0
s_cbranch_scc1 Lnofin
Lspin:
s_cmp_eq_u32 s77, 0
s_cbranch_scc1 Lspinx
s_cmp_eq_u32 s76, 0
s_cbranch_scc1 Lspinx
s_sub_u32 s76, s76, 1
s_call_b64 s[78:79], Lpoll
s_branch Lspin
Lspinx:
v_add_u32_e64 v162, 0, v251
v_mul_u32_u24 v165, 2731, v162
v_lshrrev_b32_e64 v165, 16, v165
v_mul_u32_u24 v165, 9120, v165
v_lshl_add_u32 v162, v162, 2, v165
v_add_u32 v162, 90112, v162
v_add_u32_e64 v163, 64, v251
v_mul_u32_u24 v165, 2731, v163
v_lshrrev_b32_e64 v165, 16, v165
v_mul_u32_u24 v165, 9120, v165
v_lshl_add_u32 v163, v163, 2, v165
v_add_u32 v163, 90112, v163
v_add_u32 v164, 128, v251
v_mul_u32_u24 v165, 2731, v164
v_lshrrev_b32_e64 v165, 16, v165
v_mul_u32_u24 v165, 9120, v165
v_lshl_add_u32 v164, v164, 2, v165
v_add_u32 v164, 90112, v164
v_mov_b32 v165, 16256
Lrrw:
ds_read_b32 v166, v165 offset:8
s_waitcnt lgkmcnt(0)
v_readfirstlane_b32 s43, v166
s_cmp_eq_u32 s76, 0
s_cbranch_scc1 Lrrx
s_sub_u32 s76, s76, 1
s_cmp_lt_u32 s43, 8
s_cbranch_scc0 Lrrx
s_sleep 2
s_branch Lrrw
Lrrx:
ds_write_b32 v162, v244
ds_write_b32 v163, v245
ds_write_b32 v164, v246
Lnofin:
s_waitcnt lgkmcnt(0)
s_barrier
ds_read_b128 v[156:159], v226
ds_read_b128 v[160:163], v226 offset:32
ds_read_b128 v[164:167], v226 offset:64
s_waitcnt lgkmcnt(0)
v_pk_mul_f16 v120, v120, v156
v_pk_mul_f16 v121, v121, v157
v_pk_mul_f16 v122, v122, v158
v_pk_mul_f16 v123, v123, v159
ds_write_b128 v224, v[120:123]
v_pk_mul_f16 v124, v124, v156
v_pk_mul_f16 v125, v125, v157
v_pk_mul_f16 v126, v126, v158
v_pk_mul_f16 v127, v127, v159
ds_write_b128 v224, v[124:127] offset:1024
v_pk_mul_f16 v128, v128, v156
v_pk_mul_f16 v129, v129, v157
v_pk_mul_f16 v130, v130, v158
v_pk_mul_f16 v131, v131, v159
ds_write_b128 v224, v[128:131] offset:2048
v_pk_mul_f16 v132, v132, v160
v_pk_mul_f16 v133, v133, v161
v_pk_mul_f16 v134, v134, v162
v_pk_mul_f16 v135, v135, v163
ds_write_b128 v224, v[132:135] offset:3072
v_pk_mul_f16 v136, v136, v160
v_pk_mul_f16 v137, v137, v161
v_pk_mul_f16 v138, v138, v162
v_pk_mul_f16 v139, v139, v163
ds_write_b128 v224, v[136:139] offset:4096
v_pk_mul_f16 v140, v140, v160
v_pk_mul_f16 v141, v141, v161
v_pk_mul_f16 v142, v142, v162
v_pk_mul_f16 v143, v143, v163
ds_write_b128 v224, v[140:143] offset:5120
v_pk_mul_f16 v144, v144, v164
v_pk_mul_f16 v145, v145, v165
v_pk_mul_f16 v146, v146, v166
v_pk_mul_f16 v147, v147, v167
ds_write_b128 v224, v[144:147] offset:6144
v_pk_mul_f16 v148, v148, v164
v_pk_mul_f16 v149, v149, v165
v_pk_mul_f16 v150, v150, v166
v_pk_mul_f16 v151, v151, v167
ds_write_b128 v224, v[148:151] offset:7168
v_pk_mul_f16 v152, v152, v164
v_pk_mul_f16 v153, v153, v165
v_pk_mul_f16 v154, v154, v166
v_pk_mul_f16 v155, v155, v167
ds_write_b128 v224, v[152:155] offset:8192
s_waitcnt lgkmcnt(0)
s_barrier
s_setprio 3
ds_read_b128 v[224:227], v249 offset:24576
ds_read_b128 v[228:231], v254 offset:7936
ds_read_b128 v[240:243], v249 offset:24832
ds_read_b128 v[244:247], v254 offset:7952
s_waitcnt lgkmcnt(2)
v_mfma_f32_16x16x32_f16 v[120:123], v[224:227], v[0:3], v[228:231]
v_mfma_f32_16x16x32_f16 v[128:131], v[224:227], v[4:7], v[228:231]
s_waitcnt lgkmcnt(0)
v_mfma_f32_16x16x32_f16 v[124:127], v[240:243], v[0:3], v[244:247]
ds_read_b128 v[224:227], v249 offset:25600
ds_read_b128 v[228:231], v254 offset:8064
v_mfma_f32_16x16x32_f16 v[132:135], v[240:243], v[4:7], v[244:247]
s_waitcnt lgkmcnt(0)
v_mfma_f32_16x16x32_f16 v[136:139], v[224:227], v[0:3], v[228:231]
ds_read_b128 v[240:243], v249 offset:25856
ds_read_b128 v[244:247], v254 offset:8080
v_mfma_f32_16x16x32_f16 v[144:147], v[224:227], v[4:7], v[228:231]
s_waitcnt lgkmcnt(0)
v_mfma_f32_16x16x32_f16 v[140:143], v[240:243], v[0:3], v[244:247]
ds_read_b128 v[224:227], v249 offset:26624
ds_read_b128 v[228:231], v254 offset:16128
v_mfma_f32_16x16x32_f16 v[148:151], v[240:243], v[4:7], v[244:247]
s_waitcnt lgkmcnt(0)
v_mfma_f32_16x16x32_f16 v[152:155], v[224:227], v[0:3], v[228:231]
ds_read_b128 v[240:243], v249 offset:26880
ds_read_b128 v[244:247], v254 offset:16144
v_mfma_f32_16x16x32_f16 v[160:163], v[224:227], v[4:7], v[228:231]
s_waitcnt lgkmcnt(0)
v_mfma_f32_16x16x32_f16 v[156:159], v[240:243], v[0:3], v[244:247]
ds_read_b128 v[224:227], v249 offset:30720
ds_read_b128 v[228:231], v249 offset:30976
v_mfma_f32_16x16x32_f16 v[164:167], v[240:243], v[4:7], v[244:247]
s_waitcnt lgkmcnt(1)
v_mfma_f32_16x16x32_f16 v[120:123], v[224:227], v[8:11], v[120:123]
ds_read_b128 v[240:243], v249 offset:31744
ds_read_b128 v[244:247], v249 offset:32000
v_mfma_f32_16x16x32_f16 v[128:131], v[224:227], v[12:15], v[128:131]
s_waitcnt lgkmcnt(2)
v_mfma_f32_16x16x32_f16 v[124:127], v[228:231], v[8:11], v[124:127]
ds_read_b128 v[224:227], v249 offset:32768
v_mfma_f32_16x16x32_f16 v[132:135], v[228:231], v[12:15], v[132:135]
s_waitcnt lgkmcnt(2)
v_mfma_f32_16x16x32_f16 v[136:139], v[240:243], v[8:11], v[136:139]
ds_read_b128 v[228:231], v249 offset:33024
v_mfma_f32_16x16x32_f16 v[144:147], v[240:243], v[12:15], v[144:147]
s_waitcnt lgkmcnt(2)
v_mfma_f32_16x16x32_f16 v[140:143], v[244:247], v[8:11], v[140:143]
ds_read_b128 v[240:243], v249 offset:36864
v_mfma_f32_16x16x32_f16 v[148:151], v[244:247], v[12:15], v[148:151]
s_waitcnt lgkmcnt(2)
v_mfma_f32_16x16x32_f16 v[152:155], v[224:227], v[8:11], v[152:155]
ds_read_b128 v[244:247], v249 offset:37120
v_mfma_f32_16x16x32_f16 v[160:163], v[224:227], v[12:15], v[160:163]
s_waitcnt lgkmcnt(2)
v_mfma_f32_16x16x32_f16 v[156:159], v[228:231], v[8:11], v[156:159]
ds_read_b128 v[224:227], v249 offset:37888
v_mfma_f32_16x16x32_f16 v[164:167], v[228:231], v[12:15], v[164:167]
s_waitcnt lgkmcnt(2)
v_mfma_f32_16x16x32_f16 v[120:123], v[240:243], v[16:19], v[120:123]
buffer_load_dwordx4 v[12:15], v252, s[4:7], s71 offen
ds_read_b128 v[228:231], v249 offset:38144
v_mfma_f32_16x16x32_f16 v[128:131], v[240:243], v[20:23], v[128:131]
s_waitcnt lgkmcnt(2)
v_mfma_f32_16x16x32_f16 v[124:127], v[244:247], v[16:19], v[124:127]
ds_read_b128 v[240:243], v249 offset:38912
v_mfma_f32_16x16x32_f16 v[132:135], v[244:247], v[20:23], v[132:135]
s_waitcnt lgkmcnt(2)
v_mfma_f32_16x16x32_f16 v[136:139], v[224:227], v[16:19], v[136:139]
ds_read_b128 v[244:247], v249 offset:39168
v_mfma_f32_16x16x32_f16 v[144:147], v[224:227], v[20:23], v[144:147]
s_waitcnt lgkmcnt(2)
v_mfma_f32_16x16x32_f16 v[140:143], v[228:231], v[16:19], v[140:143]
buffer_load_dwordx4 v[8:11], v252, s[4:7], s71 offen offset:64
ds_read_b128 v[224:227], v249 offset:43008
v_mfma_f32_16x16x32_f16 v[148:151], v[228:231], v[20:23], v[148:151]
s_waitcnt lgkmcnt(2)
v_mfma_f32_16x16x32_f16 v[152:155], v[240:243], v[16:19], v[152:155]
ds_read_b128 v[228:231], v249 offset:43264
v_mfma_f32_16x16x32_f16 v[160:163], v[240:243], v[20:23], v[160:163]
s_waitcnt lgkmcnt(2)
v_mfma_f32_16x16x32_f16 v[156:159], v[244:247], v[16:19], v[156:159]
ds_read_b128 v[240:243], v249 offset:44032
v_mfma_f32_16x16x32_f16 v[164:167], v[244:247], v[20:23], v[164:167]
s_waitcnt lgkmcnt(2)
v_mfma_f32_16x16x32_f16 v[120:123], v[224:227], v[24:27], v[120:123]
buffer_load_dwordx4 v[4:7], v252, s[4:7], s71 offen offset:128
ds_read_b128 v[244:247], v249 offset:44288
v_mfma_f32_16x16x32_f16 v[128:131], v[224:227], v[28:31], v[128:131]
s_waitcnt lgkmcnt(2)
v_mfma_f32_16x16x32_f16 v[124:127], v[228:231], v[24:27], v[124:127]
ds_read_b128 v[224:227], v249 offset:45056
v_mfma_f32_16x16x32_f16 v[132:135], v[228:231], v[28:31], v[132:135]
s_waitcnt lgkmcnt(2)
v_mfma_f32_16x16x32_f16 v[136:139], v[240:243], v[24:27], v[136:139]
ds_read_b128 v[228:231], v249 offset:45312
v_mfma_f32_16x16x32_f16 v[144:147], v[240:243], v[28:31], v[144:147]
s_waitcnt lgkmcnt(2)
v_mfma_f32_16x16x32_f16 v[140:143], v[244:247], v[24:27], v[140:143]
s_add_u32 s46, s71, 98304
buffer_load_dwordx4 v[0:3], v252, s[4:7], s46 offen
ds_read_b128 v[240:243], v249 offset:49152
v_mfma_f32_16x16x32_f16 v[148:151], v[244:247], v[28:31], v[148:151]
s_waitcnt lgkmcnt(2)
v_mfma_f32_16x16x32_f16 v[152:155], v[224:227], v[24:27], v[152:155]
ds_read_b128 v[244:247], v249 offset:49408
v_mfma_f32_16x16x32_f16 v[160:163], v[224:227], v[28:31], v[160:163]
s_waitcnt lgkmcnt(2)
v_mfma_f32_16x16x32_f16 v[156:159], v[228:231], v[24:27], v[156:159]
ds_read_b128 v[224:227], v249 offset:50176
v_mfma_f32_16x16x32_f16 v[164:167], v[228:231], v[28:31], v[164:167]
s_waitcnt lgkmcnt(2)
v_mfma_f32_16x16x32_f16 v[120:123], v[240:243], v[32:35], v[120:123]
buffer_load_dwordx4 v[24:27], v253, s[32:35], s80 offen nt
ds_read_b128 v[228:231], v249 offset:50432
v_mfma_f32_16x16x32_f16 v[128:131], v[240:243], v[36:39], v[128:131]
v_and_b32 v16, 1, v251
s_waitcnt lgkmcnt(2)
v_mfma_f32_16x16x32_f16 v[124:127], v[244:247], v[32:35], v[124:127]
ds_read_b128 v[240:243], v249 offset:51200
v_mfma_f32_16x16x32_f16 v[132:135], v[244:247], v[36:39], v[132:135]
v_lshlrev_b32 v16, 4, v16
s_waitcnt lgkmcnt(2)
v_mfma_f32_16x16x32_f16 v[136:139], v[224:227], v[32:35], v[136:139]
ds_read_b128 v[244:247], v249 offset:51456
v_mov_b32 v17, 16256
v_mfma_f32_16x16x32_f16 v[144:147], v[224:227], v[36:39], v[144:147]
s_waitcnt lgkmcnt(2)
v_mfma_f32_16x16x32_f16 v[140:143], v[228:231], v[32:35], v[140:143]
ds_read_b128 v[224:227], v249 offset:55296
v_lshlrev_b32 v16, v16, v17
v_mfma_f32_16x16x32_f16 v[148:151], v[228:231], v[36:39], v[148:151]
v_lshrrev_b32 v17, 2, v251
s_waitcnt lgkmcnt(2)
v_mfma_f32_16x16x32_f16 v[152:155], v[240:243], v[32:35], v[152:155]
ds_read_b128 v[228:231], v249 offset:55552
v_mfma_f32_16x16x32_f16 v[160:163], v[240:243], v[36:39], v[160:163]
v_xor_b32 v17, v17, v251
s_waitcnt lgkmcnt(2)
v_mfma_f32_16x16x32_f16 v[156:159], v[244:247], v[32:35], v[156:159]
ds_read_b128 v[240:243], v249 offset:56320
v_mfma_f32_16x16x32_f16 v[164:167], v[244:247], v[36:39], v[164:167]
v_and_b32 v17, 12, v17
s_waitcnt lgkmcnt(2)
v_mfma_f32_16x16x32_f16 v[120:123], v[224:227], v[40:43], v[120:123]
buffer_load_dwordx4 v[28:31], v253, s[32:35], s80 offen offset:256 nt
ds_read_b128 v[244:247], v249 offset:56576
v_and_b32 v20, 2, v251
v_mfma_f32_16x16x32_f16 v[128:131], v[224:227], v[44:47], v[128:131]
s_waitcnt lgkmcnt(2)
v_mfma_f32_16x16x32_f16 v[124:127], v[228:231], v[40:43], v[124:127]
ds_read_b128 v[224:227], v249 offset:57344
v_or_b32_e64 v17, v17, v20
v_mfma_f32_16x16x32_f16 v[132:135], v[228:231], v[44:47], v[132:135]
v_cmp_eq_u32 vcc, 0, v17
s_nop 1
v_cndmask_b32 v18, 0, v16, vcc
s_waitcnt lgkmcnt(2)
v_mfma_f32_16x16x32_f16 v[136:139], v[240:243], v[40:43], v[136:139]
ds_read_b128 v[228:231], v249 offset:57600
v_mfma_f32_16x16x32_f16 v[144:147], v[240:243], v[44:47], v[144:147]
v_cmp_eq_u32 vcc, 2, v17
s_nop 1
v_cndmask_b32 v19, 0, v16, vcc
s_waitcnt lgkmcnt(2)
v_mfma_f32_16x16x32_f16 v[140:143], v[244:247], v[40:43], v[140:143]
ds_read_b128 v[240:243], v249 offset:61440
v_mfma_f32_16x16x32_f16 v[148:151], v[244:247], v[44:47], v[148:151]
v_mov_b32 v16, 0
s_waitcnt lgkmcnt(2)
v_mfma_f32_16x16x32_f16 v[152:155], v[224:227], v[40:43], v[152:155]
ds_read_b128 v[244:247], v249 offset:61696
v_mov_b32 v17, 0
v_mfma_f32_16x16x32_f16 v[160:163], v[224:227], v[44:47], v[160:163]
s_waitcnt lgkmcnt(2)
v_mfma_f32_16x16x32_f16 v[156:159], v[228:231], v[40:43], v[156:159]
ds_read_b128 v[224:227], v249 offset:62464
v_mov_b32_e64 v20, 0
v_mfma_f32_16x16x32_f16 v[164:167], v[228:231], v[44:47], v[164:167]
v_mov_b32 v21, 0
s_waitcnt lgkmcnt(2)
v_mfma_f32_16x16x32_f16 v[120:123], v[240:243], v[48:51], v[120:123]
s_add_u32 s46, s80, 4194304
buffer_load_dwordx4 v[32:35], v253, s[32:35], s46 offen nt
ds_read_b128 v[228:231], v249 offset:62720
v_mfma_f32_16x16x32_f16 v[128:131], v[240:243], v[52:55], v[128:131]
s_waitcnt lgkmcnt(2)
v_mfma_f32_16x16x32_f16 v[124:127], v[244:247], v[48:51], v[124:127]
ds_read_b128 v[240:243], v249 offset:63488
v_mfma_f32_16x16x32_f16 v[132:135], v[244:247], v[52:55], v[132:135]
s_waitcnt lgkmcnt(2)
v_mfma_f32_16x16x32_f16 v[136:139], v[224:227], v[48:51], v[136:139]
ds_read_b128 v[244:247], v249 offset:63744
v_mfma_f32_16x16x32_f16 v[144:147], v[224:227], v[52:55], v[144:147]
s_waitcnt lgkmcnt(2)
v_mfma_f32_16x16x32_f16 v[140:143], v[228:231], v[48:51], v[140:143]
ds_read_b128 v[224:227], v250 offset:2048
v_mfma_f32_16x16x32_f16 v[148:151], v[228:231], v[52:55], v[148:151]
s_waitcnt lgkmcnt(2)
v_mfma_f32_16x16x32_f16 v[152:155], v[240:243], v[48:51], v[152:155]
ds_read_b128 v[228:231], v250 offset:2304
v_mfma_f32_16x16x32_f16 v[160:163], v[240:243], v[52:55], v[160:163]
s_waitcnt lgkmcnt(2)
v_mfma_f32_16x16x32_f16 v[156:159], v[244:247], v[48:51], v[156:159]
ds_read_b128 v[240:243], v250 offset:3072
v_mfma_f32_16x16x32_f16 v[164:167], v[244:247], v[52:55], v[164:167]
s_waitcnt lgkmcnt(2)
v_mfma_f32_16x16x32_f16 v[120:123], v[224:227], v[56:59], v[120:123]
ds_read_b128 v[244:247], v250 offset:3328
v_mfma_f32_16x16x32_f16 v[128:131], v[224:227], v[60:63], v[128:131]
s_waitcnt lgkmcnt(2)
v_mfma_f32_16x16x32_f16 v[124:127], v[228:231], v[56:59], v[124:127]
s_add_u32 s46, s80, 4194304
buffer_load_dwordx4 v[36:39], v253, s[32:35], s46 offen offset:256 nt
ds_read_b128 v[224:227], v250 offset:4096
v_mfma_f32_16x16x32_f16 v[132:135], v[228:231], v[60:63], v[132:135]
s_waitcnt lgkmcnt(2)
v_mfma_f32_16x16x32_f16 v[136:139], v[240:243], v[56:59], v[136:139]
ds_read_b128 v[228:231], v250 offset:4352
v_mfma_f32_16x16x32_f16 v[144:147], v[240:243], v[60:63], v[144:147]
s_waitcnt lgkmcnt(2)
v_mfma_f32_16x16x32_f16 v[140:143], v[244:247], v[56:59], v[140:143]
ds_read_b128 v[240:243], v250 offset:8192
v_mfma_f32_16x16x32_f16 v[148:151], v[244:247], v[60:63], v[148:151]
s_waitcnt lgkmcnt(2)
v_mfma_f32_16x16x32_f16 v[152:155], v[224:227], v[56:59], v[152:155]
ds_read_b128 v[244:247], v250 offset:8448
v_mfma_f32_16x16x32_f16 v[160:163], v[224:227], v[60:63], v[160:163]
s_waitcnt lgkmcnt(2)
v_mfma_f32_16x16x32_f16 v[156:159], v[228:231], v[56:59], v[156:159]
ds_read_b128 v[224:227], v250 offset:9216
v_mfma_f32_16x16x32_f16 v[164:167], v[228:231], v[60:63], v[164:167]
s_waitcnt vmcnt(7)
v_mfma_f32_16x16x32_bf16 v[120:123], v[18:21], v[12:15], v[120:123]
ds_read_b128 v[228:231], v250 offset:9472
v_mfma_f32_16x16x32_bf16 v[124:127], v[16:19], v[12:15], v[124:127]
s_waitcnt vmcnt(6)
v_mfma_f32_16x16x32_bf16 v[136:139], v[18:21], v[8:11], v[136:139]
v_mfma_f32_16x16x32_bf16 v[140:143], v[16:19], v[8:11], v[140:143]
s_waitcnt lgkmcnt(3)
v_mfma_f32_16x16x32_f16 v[120:123], v[240:243], v[64:67], v[120:123]
s_add_u32 s46, s80, 8388608
buffer_load_dwordx4 v[40:43], v253, s[32:35], s46 offen nt
v_mfma_f32_16x16x32_f16 v[128:131], v[240:243], v[68:71], v[128:131]
s_waitcnt lgkmcnt(2)
v_mfma_f32_16x16x32_f16 v[124:127], v[244:247], v[64:67], v[124:127]
ds_read_b128 v[240:243], v250 offset:10240
v_mfma_f32_16x16x32_f16 v[132:135], v[244:247], v[68:71], v[132:135]
s_waitcnt lgkmcnt(2)
v_mfma_f32_16x16x32_f16 v[136:139], v[224:227], v[64:67], v[136:139]
ds_read_b128 v[244:247], v250 offset:10496
v_mfma_f32_16x16x32_f16 v[144:147], v[224:227], v[68:71], v[144:147]
s_waitcnt lgkmcnt(2)
v_mfma_f32_16x16x32_f16 v[140:143], v[228:231], v[64:67], v[140:143]
ds_read_b128 v[224:227], v250 offset:14336
v_mfma_f32_16x16x32_f16 v[148:151], v[228:231], v[68:71], v[148:151]
s_waitcnt lgkmcnt(2)
v_mfma_f32_16x16x32_f16 v[152:155], v[240:243], v[64:67], v[152:155]
s_add_u32 s46, s80, 8388608
buffer_load_dwordx4 v[44:47], v253, s[32:35], s46 offen offset:256 nt
ds_read_b128 v[228:231], v250 offset:14592
v_mfma_f32_16x16x32_f16 v[160:163], v[240:243], v[68:71], v[160:163]
s_waitcnt lgkmcnt(2)
v_mfma_f32_16x16x32_f16 v[156:159], v[244:247], v[64:67], v[156:159]
ds_read_b128 v[240:243], v250 offset:15360
v_mfma_f32_16x16x32_f16 v[164:167], v[244:247], v[68:71], v[164:167]
s_waitcnt lgkmcnt(2)
v_mfma_f32_16x16x32_f16 v[120:123], v[224:227], v[72:75], v[120:123]
ds_read_b128 v[244:247], v250 offset:15616
v_mfma_f32_16x16x32_f16 v[128:131], v[224:227], v[76:79], v[128:131]
s_waitcnt lgkmcnt(2)
v_mfma_f32_16x16x32_f16 v[124:127], v[228:231], v[72:75], v[124:127]
s_add_u32 s46, s71, 98304
buffer_load_dwordx4 v[8:11], v252, s[4:7], s46 offen offset:64
ds_read_b128 v[224:227], v250 offset:16384
v_mfma_f32_16x16x32_f16 v[132:135], v[228:231], v[76:79], v[132:135]
s_waitcnt lgkmcnt(2)
v_mfma_f32_16x16x32_f16 v[136:139], v[240:243], v[72:75], v[136:139]
ds_read_b128 v[228:231], v250 offset:16640
v_mfma_f32_16x16x32_f16 v[144:147], v[240:243], v[76:79], v[144:147]
s_waitcnt lgkmcnt(2)
v_mfma_f32_16x16x32_f16 v[140:143], v[244:247], v[72:75], v[140:143]
ds_read_b128 v[240:243], v250 offset:20480
v_mfma_f32_16x16x32_f16 v[148:151], v[244:247], v[76:79], v[148:151]
s_waitcnt lgkmcnt(2)
v_mfma_f32_16x16x32_f16 v[152:155], v[224:227], v[72:75], v[152:155]
ds_read_b128 v[244:247], v250 offset:20736
v_mfma_f32_16x16x32_f16 v[160:163], v[224:227], v[76:79], v[160:163]
s_waitcnt lgkmcnt(2)
v_mfma_f32_16x16x32_f16 v[156:159], v[228:231], v[72:75], v[156:159]
s_add_u32 s46, s71, 98304
buffer_load_dwordx4 v[12:15], v252, s[4:7], s46 offen offset:128
ds_read_b128 v[224:227], v250 offset:21504
v_mfma_f32_16x16x32_f16 v[164:167], v[228:231], v[76:79], v[164:167]
s_waitcnt vmcnt(9)
v_mfma_f32_16x16x32_bf16 v[152:155], v[18:21], v[4:7], v[152:155]
ds_read_b128 v[228:231], v250 offset:21760
v_mfma_f32_16x16x32_bf16 v[156:159], v[16:19], v[4:7], v[156:159]
s_waitcnt vmcnt(8)
v_mfma_f32_16x16x32_bf16 v[128:131], v[18:21], v[0:3], v[128:131]
v_mfma_f32_16x16x32_bf16 v[132:135], v[16:19], v[0:3], v[132:135]
v_and_b32 v255, 1, v251
v_lshlrev_b32 v255, 7, v255
v_sub_u32 v255, v252, v255
s_mov_b32 s74, 1431655765
s_mov_b32 s75, 1431655765
s_waitcnt lgkmcnt(3)
v_mfma_f32_16x16x32_f16 v[120:123], v[240:243], v[80:83], v[120:123]
buffer_load_dwordx4 v[4:7], v252, s[4:7], s70 offen
v_mfma_f32_16x16x32_f16 v[128:131], v[240:243], v[84:87], v[128:131]
s_waitcnt lgkmcnt(2)
v_mfma_f32_16x16x32_f16 v[124:127], v[244:247], v[80:83], v[124:127]
ds_read_b128 v[240:243], v250 offset:22528
v_mfma_f32_16x16x32_f16 v[132:135], v[244:247], v[84:87], v[132:135]
s_waitcnt lgkmcnt(2)
v_mfma_f32_16x16x32_f16 v[136:139], v[224:227], v[80:83], v[136:139]
ds_read_b128 v[244:247], v250 offset:22784
v_mfma_f32_16x16x32_f16 v[144:147], v[224:227], v[84:87], v[144:147]
s_waitcnt lgkmcnt(2)
v_mfma_f32_16x16x32_f16 v[140:143], v[228:231], v[80:83], v[140:143]
ds_read_b128 v[224:227], v250 offset:26624
v_mfma_f32_16x16x32_f16 v[148:151], v[228:231], v[84:87], v[148:151]
s_waitcnt lgkmcnt(2)
v_mfma_f32_16x16x32_f16 v[152:155], v[240:243], v[80:83], v[152:155]
ds_read_b128 v[228:231], v250 offset:26880
v_mfma_f32_16x16x32_f16 v[160:163], v[240:243], v[84:87], v[160:163]
s_waitcnt lgkmcnt(2)
v_mfma_f32_16x16x32_f16 v[156:159], v[244:247], v[80:83], v[156:159]
ds_read_b128 v[240:243], v250 offset:27648
v_mfma_f32_16x16x32_f16 v[164:167], v[244:247], v[84:87], v[164:167]
s_waitcnt lgkmcnt(2)
v_mfma_f32_16x16x32_f16 v[120:123], v[224:227], v[88:91], v[120:123]
buffer_load_dwordx4 v[0:3], v252, s[4:7], s70 offen offset:64
ds_read_b128 v[244:247], v250 offset:27904
v_mfma_f32_16x16x32_f16 v[128:131], v[224:227], v[92:95], v[128:131]
s_waitcnt lgkmcnt(2)
v_mfma_f32_16x16x32_f16 v[124:127], v[228:231], v[88:91], v[124:127]
ds_read_b128 v[224:227], v250 offset:28672
v_mfma_f32_16x16x32_f16 v[132:135], v[228:231], v[92:95], v[132:135]
s_waitcnt lgkmcnt(2)
v_mfma_f32_16x16x32_f16 v[136:139], v[240:243], v[88:91], v[136:139]
ds_read_b128 v[228:231], v250 offset:28928
v_mfma_f32_16x16x32_f16 v[144:147], v[240:243], v[92:95], v[144:147]
s_waitcnt lgkmcnt(2)
v_mfma_f32_16x16x32_f16 v[140:143], v[244:247], v[88:91], v[140:143]
ds_read_b128 v[240:243], v249 offset:49152
v_mfma_f32_16x16x32_f16 v[148:151], v[244:247], v[92:95], v[148:151]
s_waitcnt lgkmcnt(2)
v_mfma_f32_16x16x32_f16 v[152:155], v[224:227], v[88:91], v[152:155]
ds_read_b128 v[244:247], v254 offset:7936
v_mfma_f32_16x16x32_f16 v[160:163], v[224:227], v[92:95], v[160:163]
s_waitcnt lgkmcnt(2)
v_mfma_f32_16x16x32_f16 v[156:159], v[228:231], v[88:91], v[156:159]
ds_read_b128 v[224:227], v249 offset:49408
v_mfma_f32_16x16x32_f16 v[164:167], v[228:231], v[92:95], v[164:167]
s_waitcnt lgkmcnt(1)
v_mfma_f32_16x16x32_f16 v[48:51], v[240:243], v[168:171], v[244:247]
ds_read_b128 v[228:231], v254 offset:7952
v_mfma_f32_16x16x32_f16 v[56:59], v[240:243], v[172:175], v[244:247]
s_waitcnt lgkmcnt(0)
v_mfma_f32_16x16x32_f16 v[52:55], v[224:227], v[168:171], v[228:231]
ds_read_b128 v[240:243], v249 offset:50176
ds_read_b128 v[244:247], v254 offset:8064
v_mfma_f32_16x16x32_f16 v[60:63], v[224:227], v[172:175], v[228:231]
s_waitcnt lgkmcnt(0)
v_mfma_f32_16x16x32_f16 v[64:67], v[240:243], v[168:171], v[244:247]
ds_read_b128 v[224:227], v249 offset:50432
ds_read_b128 v[228:231], v254 offset:8080
v_mfma_f32_16x16x32_f16 v[72:75], v[240:243], v[172:175], v[244:247]
s_waitcnt lgkmcnt(0)
v_mfma_f32_16x16x32_f16 v[68:71], v[224:227], v[168:171], v[228:231]
ds_read_b128 v[240:243], v249 offset:51200
ds_read_b128 v[244:247], v254 offset:16128
v_cvt_pk_bf16_f32 v136, v136, v137
v_mfma_f32_16x16x32_f16 v[76:79], v[224:227], v[172:175], v[228:231]
v_cvt_pk_bf16_f32 v137, v138, v139
s_waitcnt lgkmcnt(0)
v_mfma_f32_16x16x32_f16 v[80:83], v[240:243], v[168:171], v[244:247]
ds_read_b128 v[224:227], v249 offset:51456
ds_read_b128 v[228:231], v254 offset:16144
v_cvt_pk_bf16_f32 v138, v140, v141
v_mfma_f32_16x16x32_f16 v[88:91], v[240:243], v[172:175], v[244:247]
v_cvt_pk_bf16_f32 v139, v142, v143
s_waitcnt lgkmcnt(0)
v_mfma_f32_16x16x32_f16 v[84:87], v[224:227], v[168:171], v[228:231]
ds_read_b128 v[240:243], v249 offset:55296
ds_read_b128 v[244:247], v249 offset:55552
v_cvt_pk_bf16_f32 v120, v120, v121
v_mfma_f32_16x16x32_f16 v[92:95], v[224:227], v[172:175], v[228:231]
v_cvt_pk_bf16_f32 v121, v122, v123
s_waitcnt lgkmcnt(1)
v_mfma_f32_16x16x32_f16 v[48:51], v[240:243], v[176:179], v[48:51]
ds_read_b128 v[224:227], v249 offset:56320
ds_read_b128 v[228:231], v249 offset:56576
v_cvt_pk_bf16_f32 v122, v124, v125
v_mfma_f32_16x16x32_f16 v[56:59], v[240:243], v[180:183], v[56:59]
v_cvt_pk_bf16_f32 v123, v126, v127
s_waitcnt lgkmcnt(2)
v_mfma_f32_16x16x32_f16 v[52:55], v[244:247], v[176:179], v[52:55]
ds_read_b128 v[240:243], v249 offset:57344
v_cvt_pk_bf16_f32 v152, v152, v153
v_cvt_pk_bf16_f32 v153, v154, v155
v_mfma_f32_16x16x32_f16 v[60:63], v[244:247], v[180:183], v[60:63]
v_cvt_pk_bf16_f32 v154, v156, v157
s_waitcnt lgkmcnt(2)
v_mfma_f32_16x16x32_f16 v[64:67], v[224:227], v[176:179], v[64:67]
ds_read_b128 v[244:247], v249 offset:57600
v_cvt_pk_bf16_f32 v155, v158, v159
s_mov_b64 vcc, s[74:75]
v_mfma_f32_16x16x32_f16 v[72:75], v[224:227], v[180:183], v[72:75]
v_cndmask_b32 v140, v120, v152, vcc
s_waitcnt lgkmcnt(2)
v_mfma_f32_16x16x32_f16 v[68:71], v[228:231], v[176:179], v[68:71]
ds_read_b128 v[224:227], v249 offset:61440
v_cndmask_b32 v141, v121, v153, vcc
v_mfma_f32_16x16x32_f16 v[76:79], v[228:231], v[180:183], v[76:79]
v_cndmask_b32 v142, v122, v154, vcc
s_waitcnt lgkmcnt(2)
v_mfma_f32_16x16x32_f16 v[80:83], v[240:243], v[176:179], v[80:83]
ds_read_b128 v[228:231], v249 offset:61696
v_cndmask_b32 v143, v123, v155, vcc
v_mfma_f32_16x16x32_f16 v[88:91], v[240:243], v[180:183], v[88:91]
v_cndmask_b32_dpp v120, v136, v120, vcc quad_perm:[1,0,3,2] row_mask:0xf bank_mask:0xf
s_waitcnt lgkmcnt(2)
v_mfma_f32_16x16x32_f16 v[84:87], v[244:247], v[176:179], v[84:87]
ds_read_b128 v[240:243], v248 offset:16384
v_cndmask_b32_dpp v121, v137, v121, vcc quad_perm:[1,0,3,2] row_mask:0xf bank_mask:0xf
v_mfma_f32_16x16x32_f16 v[92:95], v[244:247], v[180:183], v[92:95]
v_cndmask_b32_dpp v122, v138, v122, vcc quad_perm:[1,0,3,2] row_mask:0xf bank_mask:0xf
s_waitcnt vmcnt(3)
v_mfma_f32_16x16x32_bf16 v[144:147], v[18:21], v[8:11], v[144:147]
ds_read_b128 v[244:247], v249 offset:62464
v_cndmask_b32_dpp v123, v139, v123, vcc quad_perm:[1,0,3,2] row_mask:0xf bank_mask:0xf
s_not_b64 vcc, s[74:75]
v_mfma_f32_16x16x32_bf16 v[148:151], v[16:19], v[8:11], v[148:151]
v_cndmask_b32_dpp v152, v136, v152, vcc quad_perm:[1,0,3,2] row_mask:0xf bank_mask:0xf
s_waitcnt vmcnt(2)
v_mfma_f32_16x16x32_bf16 v[160:163], v[18:21], v[12:15], v[160:163]
v_cndmask_b32_dpp v153, v137, v153, vcc quad_perm:[1,0,3,2] row_mask:0xf bank_mask:0xf
v_mfma_f32_16x16x32_bf16 v[164:167], v[16:19], v[12:15], v[164:167]
v_cndmask_b32_dpp v154, v138, v154, vcc quad_perm:[1,0,3,2] row_mask:0xf bank_mask:0xf
v_cndmask_b32_dpp v155, v139, v155, vcc quad_perm:[1,0,3,2] row_mask:0xf bank_mask:0xf
s_waitcnt lgkmcnt(3)
v_mfma_f32_16x16x32_f16 v[48:51], v[224:227], v[184:187], v[48:51]
buffer_load_dwordx4 v[8:11], v252, s[4:7], s70 offen offset:128
buffer_store_dwordx4 v[120:123], v255, s[8:11], s71 offen sc1
v_mfma_f32_16x16x32_f16 v[56:59], v[224:227], v[188:191], v[56:59]
s_waitcnt lgkmcnt(2)
v_mfma_f32_16x16x32_f16 v[52:55], v[228:231], v[184:187], v[52:55]
ds_read_b128 v[224:227], v249 offset:62720
v_mfma_f32_16x16x32_f16 v[60:63], v[228:231], v[188:191], v[60:63]
s_waitcnt lgkmcnt(2)
v_mfma_f32_16x16x32_bf16 v[168:171], v[240:243], v[96:99], 0
ds_read_b128 v[228:231], v249 offset:63488
v_mfma_f32_16x16x32_bf16 v[176:179], v[240:243], v[100:103], 0
s_waitcnt lgkmcnt(2)
v_mfma_f32_16x16x32_f16 v[64:67], v[244:247], v[184:187], v[64:67]
ds_read_b128 v[240:243], v249 offset:63744
v_mfma_f32_16x16x32_f16 v[72:75], v[244:247], v[188:191], v[72:75]
s_waitcnt lgkmcnt(2)
v_mfma_f32_16x16x32_f16 v[68:71], v[224:227], v[184:187], v[68:71]
ds_read_b128 v[244:247], v248 offset:16640
v_mfma_f32_16x16x32_f16 v[76:79], v[224:227], v[188:191], v[76:79]
s_waitcnt lgkmcnt(2)
v_mfma_f32_16x16x32_f16 v[80:83], v[228:231], v[184:187], v[80:83]
s_add_u32 s46, s70, 98304
buffer_load_dwordx4 v[12:15], v252, s[4:7], s46 offen
ds_read_b128 v[224:227], v250 offset:2048
v_mfma_f32_16x16x32_f16 v[88:91], v[228:231], v[188:191], v[88:91]
s_waitcnt lgkmcnt(2)
v_mfma_f32_16x16x32_f16 v[84:87], v[240:243], v[184:187], v[84:87]
ds_read_b128 v[228:231], v250 offset:2304
v_mfma_f32_16x16x32_f16 v[92:95], v[240:243], v[188:191], v[92:95]
s_waitcnt lgkmcnt(2)
v_mfma_f32_16x16x32_bf16 v[172:175], v[244:247], v[96:99], 0
ds_read_b128 v[240:243], v250 offset:3072
v_mfma_f32_16x16x32_bf16 v[180:183], v[244:247], v[100:103], 0
s_waitcnt lgkmcnt(2)
v_mfma_f32_16x16x32_f16 v[48:51], v[224:227], v[192:195], v[48:51]
ds_read_b128 v[244:247], v250 offset:3328
v_mfma_f32_16x16x32_f16 v[56:59], v[224:227], v[196:199], v[56:59]
s_waitcnt lgkmcnt(2)
v_mfma_f32_16x16x32_f16 v[52:55], v[228:231], v[192:195], v[52:55]
ds_read_b128 v[224:227], v248 offset:17408
v_mfma_f32_16x16x32_f16 v[60:63], v[228:231], v[196:199], v[60:63]
s_waitcnt lgkmcnt(2)
v_mfma_f32_16x16x32_f16 v[64:67], v[240:243], v[192:195], v[64:67]
buffer_store_dwordx4 v[140:143], v255, s[8:11], s71 offen offset:128 sc1
ds_read_b128 v[228:231], v250 offset:4096
v_mfma_f32_16x16x32_f16 v[72:75], v[240:243], v[196:199], v[72:75]
s_waitcnt lgkmcnt(2)
v_mfma_f32_16x16x32_f16 v[68:71], v[244:247], v[192:195], v[68:71]
ds_read_b128 v[240:243], v250 offset:4352
v_mfma_f32_16x16x32_f16 v[76:79], v[244:247], v[196:199], v[76:79]
s_waitcnt lgkmcnt(2)
v_mfma_f32_16x16x32_bf16 v[168:171], v[224:227], v[104:107], v[168:171]
ds_read_b128 v[244:247], v250 offset:8192
v_mfma_f32_16x16x32_bf16 v[176:179], v[224:227], v[108:111], v[176:179]
s_waitcnt lgkmcnt(2)
v_mfma_f32_16x16x32_f16 v[80:83], v[228:231], v[192:195], v[80:83]
ds_read_b128 v[224:227], v250 offset:8448
v_mfma_f32_16x16x32_f16 v[88:91], v[228:231], v[196:199], v[88:91]
s_waitcnt lgkmcnt(2)
v_mfma_f32_16x16x32_f16 v[84:87], v[240:243], v[192:195], v[84:87]
ds_read_b128 v[228:231], v248 offset:17664
v_mfma_f32_16x16x32_f16 v[92:95], v[240:243], v[196:199], v[92:95]
s_waitcnt lgkmcnt(2)
v_mfma_f32_16x16x32_f16 v[48:51], v[244:247], v[200:203], v[48:51]
buffer_store_dwordx4 v[152:155], v255, s[8:11], s71 offen offset:256 sc1
ds_read_b128 v[240:243], v250 offset:9216
v_mfma_f32_16x16x32_f16 v[56:59], v[244:247], v[204:207], v[56:59]
s_waitcnt lgkmcnt(2)
v_mfma_f32_16x16x32_f16 v[52:55], v[224:227], v[200:203], v[52:55]
ds_read_b128 v[244:247], v250 offset:9472
v_mfma_f32_16x16x32_f16 v[60:63], v[224:227], v[204:207], v[60:63]
s_waitcnt lgkmcnt(2)
v_mfma_f32_16x16x32_bf16 v[172:175], v[228:231], v[104:107], v[172:175]
ds_read_b128 v[224:227], v250 offset:10240
v_mfma_f32_16x16x32_bf16 v[180:183], v[228:231], v[108:111], v[180:183]
s_waitcnt lgkmcnt(2)
v_mfma_f32_16x16x32_f16 v[64:67], v[240:243], v[200:203], v[64:67]
ds_read_b128 v[228:231], v250 offset:10496
v_mfma_f32_16x16x32_f16 v[72:75], v[240:243], v[204:207], v[72:75]
s_waitcnt lgkmcnt(2)
v_mfma_f32_16x16x32_f16 v[68:71], v[244:247], v[200:203], v[68:71]
ds_read_b128 v[240:243], v248 offset:18432
v_mfma_f32_16x16x32_f16 v[76:79], v[244:247], v[204:207], v[76:79]
s_waitcnt lgkmcnt(2)
v_mfma_f32_16x16x32_f16 v[80:83], v[224:227], v[200:203], v[80:83]
ds_read_b128 v[244:247], v250 offset:14336
v_mfma_f32_16x16x32_f16 v[88:91], v[224:227], v[204:207], v[88:91]
s_waitcnt lgkmcnt(2)
v_mfma_f32_16x16x32_f16 v[84:87], v[228:231], v[200:203], v[84:87]
ds_read_b128 v[224:227], v250 offset:14592
v_mfma_f32_16x16x32_f16 v[92:95], v[228:231], v[204:207], v[92:95]
s_waitcnt lgkmcnt(2)
v_mfma_f32_16x16x32_bf16 v[168:171], v[240:243], v[112:115], v[168:171]
ds_read_b128 v[228:231], v250 offset:15360
v_mfma_f32_16x16x32_bf16 v[176:179], v[240:243], v[116:119], v[176:179]
s_waitcnt lgkmcnt(2)
v_mfma_f32_16x16x32_f16 v[48:51], v[244:247], v[232:235], v[48:51]
ds_read_b128 v[240:243], v250 offset:15616
v_mfma_f32_16x16x32_f16 v[56:59], v[244:247], v[236:239], v[56:59]
s_waitcnt lgkmcnt(2)
v_mfma_f32_16x16x32_f16 v[52:55], v[224:227], v[232:235], v[52:55]
ds_read_b128 v[244:247], v248 offset:18688
v_mfma_f32_16x16x32_f16 v[60:63], v[224:227], v[236:239], v[60:63]
s_waitcnt lgkmcnt(2)
v_mfma_f32_16x16x32_f16 v[64:67], v[228:231], v[232:235], v[64:67]
ds_read_b128 v[224:227], v250 offset:16384
v_mfma_f32_16x16x32_f16 v[72:75], v[228:231], v[236:239], v[72:75]
s_waitcnt lgkmcnt(2)
v_mfma_f32_16x16x32_f16 v[68:71], v[240:243], v[232:235], v[68:71]
ds_read_b128 v[228:231], v250 offset:16640
v_mfma_f32_16x16x32_f16 v[76:79], v[240:243], v[236:239], v[76:79]
s_waitcnt lgkmcnt(2)
v_mfma_f32_16x16x32_bf16 v[172:175], v[244:247], v[112:115], v[172:175]
ds_read_b128 v[240:243], v250 offset:20480
v_mfma_f32_16x16x32_bf16 v[180:183], v[244:247], v[116:119], v[180:183]
s_waitcnt lgkmcnt(2)
v_mfma_f32_16x16x32_f16 v[80:83], v[224:227], v[232:235], v[80:83]
ds_read_b128 v[244:247], v250 offset:20736
v_mfma_f32_16x16x32_f16 v[88:91], v[224:227], v[236:239], v[88:91]
s_waitcnt lgkmcnt(2)
v_mfma_f32_16x16x32_f16 v[84:87], v[228:231], v[232:235], v[84:87]
ds_read_b128 v[224:227], v250 offset:21504
v_mfma_f32_16x16x32_f16 v[92:95], v[228:231], v[236:239], v[92:95]
s_waitcnt lgkmcnt(2)
v_mfma_f32_16x16x32_f16 v[48:51], v[240:243], v[208:211], v[48:51]
ds_read_b128 v[228:231], v250 offset:21760
v_mfma_f32_16x16x32_f16 v[56:59], v[240:243], v[212:215], v[56:59]
s_waitcnt lgkmcnt(2)
v_mfma_f32_16x16x32_f16 v[52:55], v[244:247], v[208:211], v[52:55]
ds_read_b128 v[240:243], v250 offset:22528
v_mfma_f32_16x16x32_f16 v[60:63], v[244:247], v[212:215], v[60:63]
s_waitcnt lgkmcnt(2)
v_mfma_f32_16x16x32_f16 v[64:67], v[224:227], v[208:211], v[64:67]
ds_read_b128 v[244:247], v250 offset:22784
v_mfma_f32_16x16x32_f16 v[72:75], v[224:227], v[212:215], v[72:75]
s_waitcnt lgkmcnt(2)
v_mfma_f32_16x16x32_f16 v[68:71], v[228:231], v[208:211], v[68:71]
ds_read_b128 v[224:227], v250 offset:26624
v_mfma_f32_16x16x32_f16 v[76:79], v[228:231], v[212:215], v[76:79]
s_waitcnt lgkmcnt(2)
v_mfma_f32_16x16x32_f16 v[80:83], v[240:243], v[208:211], v[80:83]
ds_read_b128 v[228:231], v250 offset:26880
v_mfma_f32_16x16x32_f16 v[88:91], v[240:243], v[212:215], v[88:91]
s_waitcnt lgkmcnt(2)
v_mfma_f32_16x16x32_f16 v[84:87], v[244:247], v[208:211], v[84:87]
ds_read_b128 v[240:243], v248 offset:22528
v_mfma_f32_16x16x32_f16 v[92:95], v[244:247], v[212:215], v[92:95]
s_setprio 3
s_waitcnt lgkmcnt(2)
v_mfma_f32_16x16x32_f16 v[48:51], v[224:227], v[216:219], v[48:51]
s_add_u32 s46, s70, 98304
buffer_load_dwordx4 v[208:211], v252, s[4:7], s46 offen offset:64
ds_read_b128 v[244:247], v250 offset:27648
v_cvt_pkrtz_f16_f32 v185, v168, v169
v_cvt_pkrtz_f16_f32 v187, v170, v171
v_mfma_f32_16x16x32_f16 v[56:59], v[224:227], v[220:223], v[56:59]
v_cvt_pkrtz_f16_f32 v189, v172, v173
v_cvt_pkrtz_f16_f32 v191, v174, v175
s_waitcnt lgkmcnt(2)
v_mfma_f32_16x16x32_f16 v[52:55], v[228:231], v[216:219], v[52:55]
ds_read_b128 v[224:227], v248 offset:22784
v_cvt_pkrtz_f16_f32 v193, v176, v177
v_cvt_pk_f16_f32 v203, v178, v179
v_cvt_pk_f16_f32 v200, v180, v181
v_mfma_f32_16x16x32_f16 v[60:63], v[228:231], v[220:223], v[60:63]
v_cvt_pk_f16_f32 v197, v182, v183
v_pk_fma_f16 v202, v203, v203, s48
s_waitcnt lgkmcnt(2)
v_mfma_f32_16x16x32_bf16 v[168:171], v[240:243], v[96:99], 0
ds_read_b128 v[228:231], v250 offset:27904
v_and_b32_e64 v185, s49, v185
v_pk_fma_f16 v199, v200, v200, s48
v_mfma_f32_16x16x32_bf16 v[176:179], v[240:243], v[100:103], 0
v_and_b32 v187, s49, v187
v_pk_fma_f16 v196, v197, v197, s48
v_bfe_u32 v184, v185, 2, 14
s_waitcnt lgkmcnt(2)
v_mfma_f32_16x16x32_f16 v[64:67], v[244:247], v[216:219], v[64:67]
ds_read_b128 v[240:243], v248 offset:23552
ds_read_u16_d16 v184, v184
v_pk_mul_f16 v202, v203, v202
v_bfe_u32 v186, v187, 2, 14
v_mfma_f32_16x16x32_f16 v[72:75], v[244:247], v[220:223], v[72:75]
v_pk_mul_f16 v199, v200, v199
v_lshrrev_b32 v185, 18, v185
s_waitcnt lgkmcnt(3)
v_mfma_f32_16x16x32_bf16 v[172:175], v[224:227], v[96:99], 0
ds_read_b128 v[244:247], v250 offset:28672
ds_read_u16_d16 v186, v186
ds_read_u16_d16_hi v185, v185
v_pk_mul_f16 v196, v197, v196
v_lshrrev_b32_e64 v187, 18, v187
v_mfma_f32_16x16x32_bf16 v[180:183], v[224:227], v[100:103], 0
v_exp_f16_e64 v201, v202
v_and_b32 v189, s49, v189
s_waitcnt lgkmcnt(5)
v_mfma_f32_16x16x32_f16 v[68:71], v[228:231], v[216:219], v[68:71]
ds_read_b128 v[224:227], v250 offset:28928
ds_read_u16_d16_hi v187, v187
v_and_b32_e64 v191, s49, v191
v_mfma_f32_16x16x32_f16 v[76:79], v[228:231], v[220:223], v[76:79]
v_exp_f16 v198, v199
v_bfe_u32 v188, v189, 2, 14
v_bfe_u32 v190, v191, 2, 14
s_waitcnt lgkmcnt(5)
v_mfma_f32_16x16x32_bf16 v[168:171], v[240:243], v[104:107], v[168:171]
s_add_u32 s46, s70, 98304
buffer_load_dwordx4 v[204:207], v252, s[4:7], s46 offen offset:128
ds_read_b128 v[228:231], v248 offset:23808
ds_read_u16_d16 v188, v188
ds_read_u16_d16 v190, v190
v_exp_f16_e64 v195, v196
v_mfma_f32_16x16x32_bf16 v[176:179], v[240:243], v[108:111], v[176:179]
v_lshrrev_b32_e64 v189, 18, v189
v_lshrrev_b32 v191, 18, v191
s_waitcnt lgkmcnt(5)
v_mfma_f32_16x16x32_f16 v[80:83], v[244:247], v[216:219], v[80:83]
ds_read_b128 v[240:243], v248 offset:24576
ds_read_u16_d16_hi v189, v189
ds_read_u16_d16_hi v191, v191
v_exp_f16_sdwa v201, v202 dst_sel:WORD_1 dst_unused:UNUSED_PRESERVE src0_sel:WORD_1
v_and_b32 v193, s49, v193
v_mfma_f32_16x16x32_f16 v[88:91], v[244:247], v[220:223], v[88:91]
v_bfe_u32 v192, v193, 2, 14
s_waitcnt lgkmcnt(6)
v_mfma_f32_16x16x32_f16 v[84:87], v[224:227], v[216:219], v[84:87]
ds_read_b128 v[244:247], v248 offset:24832
ds_read_u16_d16 v192, v192
v_exp_f16_sdwa v198, v199 dst_sel:WORD_1 dst_unused:UNUSED_PRESERVE src0_sel:WORD_1
v_lshrrev_b32 v193, 18, v193
v_mfma_f32_16x16x32_f16 v[92:95], v[224:227], v[220:223], v[92:95]
v_exp_f16_sdwa v195, v196 dst_sel:WORD_1 dst_unused:UNUSED_PRESERVE src0_sel:WORD_1
v_pk_add_f16 v201, v201, 1.0 op_sel_hi:[1,0]
s_waitcnt lgkmcnt(7)
v_mfma_f32_16x16x32_bf16 v[172:175], v[228:231], v[104:107], v[172:175]
ds_read_b128 v[224:227], v249 offset:24576
ds_read_u16_d16_hi v193, v193
v_pk_add_f16 v198, v198, 1.0 op_sel_hi:[1,0]
v_pk_add_f16 v195, v195, 1.0 op_sel_hi:[1,0]
v_mfma_f32_16x16x32_bf16 v[180:183], v[228:231], v[108:111], v[180:183]
v_rcp_f16 v202, v201
s_waitcnt lgkmcnt(6)
v_mfma_f32_16x16x32_bf16 v[168:171], v[240:243], v[112:115], v[168:171]
ds_read_b128 v[228:231], v249 offset:24832
v_rcp_f16_e64 v199, v198
v_mfma_f32_16x16x32_bf16 v[176:179], v[240:243], v[116:119], v[176:179]
v_rcp_f16 v196, v195
s_waitcnt lgkmcnt(4)
v_mfma_f32_16x16x32_bf16 v[172:175], v[244:247], v[112:115], v[172:175]
ds_read_b128 v[240:243], v248 offset:28672
v_rcp_f16_sdwa v202, v201 dst_sel:WORD_1 dst_unused:UNUSED_PRESERVE src0_sel:WORD_1
v_mfma_f32_16x16x32_bf16 v[180:183], v[244:247], v[116:119], v[180:183]
v_rcp_f16_sdwa v199, v198 dst_sel:WORD_1 dst_unused:UNUSED_PRESERVE src0_sel:WORD_1
v_or_b32 v232, v184, v185
v_or_b32 v233, v186, v187
v_or_b32_e64 v234, v188, v189
v_rcp_f16_sdwa v196, v195 dst_sel:WORD_1 dst_unused:UNUSED_PRESERVE src0_sel:WORD_1
v_or_b32 v235, v190, v191
s_waitcnt lgkmcnt(2)
v_or_b32_e64 v236, v192, v193
v_pk_mul_f16 v237, v203, v202
v_pk_mul_f16 v238, v200, v199
v_pk_mul_f16 v239, v197, v196
v_mfma_f32_16x16x32_f16 v[48:51], v[224:227], v[232:235], v[48:51]
ds_read_b128 v[244:247], v249 offset:25600
ds_read_b128 v[216:219], v248 offset:28928
ds_read_b128 v[220:223], v249 offset:25856
v_cvt_pkrtz_f16_f32 v185, v168, v169
v_cvt_pkrtz_f16_f32 v187, v170, v171
v_cvt_pkrtz_f16_f32 v189, v172, v173
v_mfma_f32_16x16x32_f16 v[56:59], v[224:227], v[236:239], v[56:59]
v_cvt_pkrtz_f16_f32 v191, v174, v175
v_cvt_pkrtz_f16_f32 v193, v176, v177
v_cvt_pk_f16_f32 v203, v178, v179
s_waitcnt lgkmcnt(3)
v_mfma_f32_16x16x32_f16 v[52:55], v[228:231], v[232:235], v[52:55]
ds_read_b128 v[224:227], v248 offset:29696
v_cvt_pk_f16_f32 v200, v180, v181
v_cvt_pk_f16_f32 v197, v182, v183
v_pk_fma_f16 v202, v203, v203, s48
v_mfma_f32_16x16x32_f16 v[60:63], v[228:231], v[236:239], v[60:63]
v_cvt_pk_bf16_f32 v144, v144, v145
v_and_b32 v185, s49, v185
v_cvt_pk_bf16_f32 v145, v146, v147
v_mfma_f32_16x16x32_bf16 v[168:171], v[240:243], v[96:99], 0
ds_read_b128 v[228:231], v249 offset:26624
v_pk_fma_f16 v199, v200, v200, s48
v_and_b32_e64 v187, s49, v187
v_cvt_pk_bf16_f32 v146, v148, v149
v_mfma_f32_16x16x32_bf16 v[176:179], v[240:243], v[100:103], 0
v_pk_fma_f16 v196, v197, v197, s48
v_cvt_pk_bf16_f32 v147, v150, v151
v_bfe_u32 v184, v185, 2, 14
s_setprio 2
s_waitcnt lgkmcnt(2)
v_mfma_f32_16x16x32_f16 v[64:67], v[244:247], v[232:235], v[64:67]
ds_read_b128 v[240:243], v249 offset:26880
ds_read_u16_d16 v184, v184
v_pk_mul_f16 v202, v203, v202
v_cvt_pk_bf16_f32 v128, v128, v129
v_bfe_u32 v186, v187, 2, 14
v_mfma_f32_16x16x32_f16 v[72:75], v[244:247], v[236:239], v[72:75]
v_cvt_pk_bf16_f32 v129, v130, v131
v_pk_mul_f16 v199, v200, v199
v_lshrrev_b32 v185, 18, v185
s_waitcnt vmcnt(8)
v_mfma_f32_16x16x32_bf16 v[48:51], v[18:21], v[4:7], v[48:51]
ds_read_b128 v[244:247], v248 offset:29952
ds_read_u16_d16 v186, v186
ds_read_u16_d16_hi v185, v185
v_cvt_pk_bf16_f32 v130, v132, v133
v_pk_mul_f16 v196, v197, v196
v_lshrrev_b32_e64 v187, 18, v187
v_mfma_f32_16x16x32_bf16 v[52:55], v[16:19], v[4:7], v[52:55]
v_cvt_pk_bf16_f32 v131, v134, v135
v_exp_f16_e64 v201, v202
v_mfma_f32_16x16x32_bf16 v[172:175], v[216:219], v[96:99], 0
ds_read_u16_d16_hi v187, v187
v_cvt_pk_bf16_f32 v160, v160, v161
v_and_b32_e64 v189, s49, v189
v_cvt_pk_bf16_f32 v161, v162, v163
v_mfma_f32_16x16x32_bf16 v[180:183], v[216:219], v[100:103], 0
v_and_b32_e64 v191, s49, v191
v_cvt_pk_bf16_f32 v162, v164, v165
v_mfma_f32_16x16x32_f16 v[68:71], v[220:223], v[232:235], v[68:71]
ds_read_b128 v[216:219], v248 offset:30720
v_exp_f16 v198, v199
v_cvt_pk_bf16_f32 v163, v166, v167
s_mov_b64 vcc, s[74:75]
v_bfe_u32 v188, v189, 2, 14
v_bfe_u32 v190, v191, 2, 14
v_mfma_f32_16x16x32_f16 v[76:79], v[220:223], v[236:239], v[76:79]
v_cndmask_b32 v148, v128, v160, vcc
v_exp_f16_e64 v195, v196
s_waitcnt lgkmcnt(2)
v_mfma_f32_16x16x32_bf16 v[168:171], v[224:227], v[104:107], v[168:171]
ds_read_b128 v[220:223], v248 offset:30976
ds_read_u16_d16 v188, v188
ds_read_u16_d16 v190, v190
v_cndmask_b32 v149, v129, v161, vcc
v_lshrrev_b32_e64 v189, 18, v189
v_cndmask_b32 v150, v130, v162, vcc
v_mfma_f32_16x16x32_bf16 v[176:179], v[224:227], v[108:111], v[176:179]
v_lshrrev_b32 v191, 18, v191
v_cndmask_b32 v151, v131, v163, vcc
v_mfma_f32_16x16x32_f16 v[80:83], v[228:231], v[232:235], v[80:83]
ds_read_b128 v[224:227], v249 offset:30720
ds_read_u16_d16_hi v189, v189
ds_read_u16_d16_hi v191, v191
v_exp_f16_sdwa v201, v202 dst_sel:WORD_1 dst_unused:UNUSED_PRESERVE src0_sel:WORD_1
v_cndmask_b32_dpp v128, v144, v128, vcc quad_perm:[1,0,3,2] row_mask:0xf bank_mask:0xf
v_and_b32_e64 v193, s49, v193
v_mfma_f32_16x16x32_f16 v[88:91], v[228:231], v[236:239], v[88:91]
v_cndmask_b32_dpp v129, v145, v129, vcc quad_perm:[1,0,3,2] row_mask:0xf bank_mask:0xf
v_bfe_u32 v192, v193, 2, 14
v_mfma_f32_16x16x32_f16 v[84:87], v[240:243], v[232:235], v[84:87]
ds_read_b128 v[228:231], v249 offset:30976
ds_read_u16_d16 v192, v192
v_exp_f16_sdwa v198, v199 dst_sel:WORD_1 dst_unused:UNUSED_PRESERVE src0_sel:WORD_1
v_cndmask_b32_dpp v130, v146, v130, vcc quad_perm:[1,0,3,2] row_mask:0xf bank_mask:0xf
v_lshrrev_b32 v193, 18, v193
v_mfma_f32_16x16x32_f16 v[92:95], v[240:243], v[236:239], v[92:95]
v_cndmask_b32_dpp v131, v147, v131, vcc quad_perm:[1,0,3,2] row_mask:0xf bank_mask:0xf
s_not_b64 vcc, s[74:75]
v_exp_f16_sdwa v195, v196 dst_sel:WORD_1 dst_unused:UNUSED_PRESERVE src0_sel:WORD_1
v_mfma_f32_16x16x32_bf16 v[172:175], v[244:247], v[104:107], v[172:175]
ds_read_b128 v[240:243], v248 offset:34816
ds_read_u16_d16_hi v193, v193
v_cndmask_b32_dpp v160, v144, v160, vcc quad_perm:[1,0,3,2] row_mask:0xf bank_mask:0xf
v_pk_add_f16 v201, v201, 1.0 op_sel_hi:[1,0]
v_cndmask_b32_dpp v161, v145, v161, vcc quad_perm:[1,0,3,2] row_mask:0xf bank_mask:0xf
v_mfma_f32_16x16x32_bf16 v[180:183], v[244:247], v[108:111], v[180:183]
v_pk_add_f16 v198, v198, 1.0 op_sel_hi:[1,0]
v_cndmask_b32_dpp v162, v146, v162, vcc quad_perm:[1,0,3,2] row_mask:0xf bank_mask:0xf
v_pk_add_f16 v195, v195, 1.0 op_sel_hi:[1,0]
s_waitcnt lgkmcnt(4)
v_mfma_f32_16x16x32_bf16 v[168:171], v[216:219], v[112:115], v[168:171]
ds_read_b128 v[244:247], v249 offset:31744
v_rcp_f16 v202, v201
v_cndmask_b32_dpp v163, v147, v163, vcc quad_perm:[1,0,3,2] row_mask:0xf bank_mask:0xf
v_mfma_f32_16x16x32_bf16 v[176:179], v[216:219], v[116:119], v[176:179]
v_rcp_f16_e64 v199, v198
v_mfma_f32_16x16x32_bf16 v[172:175], v[220:223], v[112:115], v[172:175]
ds_read_b128 v[216:219], v248 offset:35072
s_add_u32 s46, s71, 98304
buffer_store_dwordx4 v[128:131], v255, s[8:11], s46 offen sc1
v_rcp_f16_e64 v196, v195
v_rcp_f16_sdwa v202, v201 dst_sel:WORD_1 dst_unused:UNUSED_PRESERVE src0_sel:WORD_1
v_mfma_f32_16x16x32_bf16 v[180:183], v[220:223], v[116:119], v[180:183]
v_rcp_f16_sdwa v199, v198 dst_sel:WORD_1 dst_unused:UNUSED_PRESERVE src0_sel:WORD_1
v_or_b32 v232, v184, v185
v_or_b32 v233, v186, v187
v_or_b32_e64 v234, v188, v189
v_rcp_f16_sdwa v196, v195 dst_sel:WORD_1 dst_unused:UNUSED_PRESERVE src0_sel:WORD_1
v_or_b32 v235, v190, v191
s_waitcnt lgkmcnt(2)
v_or_b32_e64 v236, v192, v193
v_pk_mul_f16 v237, v203, v202
v_pk_mul_f16 v238, v200, v199
v_pk_mul_f16 v239, v197, v196
v_mfma_f32_16x16x32_f16 v[48:51], v[224:227], v[232:235], v[48:51]
s_add_u32 s46, s71, 98304
buffer_store_dwordx4 v[148:151], v255, s[8:11], s46 offen offset:128 sc1
ds_read_b128 v[220:223], v249 offset:32000
v_cvt_pkrtz_f16_f32 v185, v168, v169
v_cvt_pkrtz_f16_f32 v187, v170, v171
v_mfma_f32_16x16x32_f16 v[56:59], v[224:227], v[236:239], v[56:59]
v_cvt_pkrtz_f16_f32 v189, v172, v173
v_cvt_pkrtz_f16_f32 v191, v174, v175
v_mfma_f32_16x16x32_f16 v[52:55], v[228:231], v[232:235], v[52:55]
ds_read_b128 v[224:227], v248 offset:35840
v_cvt_pkrtz_f16_f32 v193, v176, v177
v_cvt_pk_f16_f32 v203, v178, v179
v_mfma_f32_16x16x32_f16 v[60:63], v[228:231], v[236:239], v[60:63]
v_cvt_pk_f16_f32 v200, v180, v181
v_cvt_pk_f16_f32 v197, v182, v183
s_setprio 1
v_mfma_f32_16x16x32_bf16 v[168:171], v[240:243], v[96:99], 0
ds_read_b128 v[228:231], v249 offset:32768
v_pk_fma_f16 v202, v203, v203, s48
v_and_b32 v185, s49, v185
v_mfma_f32_16x16x32_bf16 v[176:179], v[240:243], v[100:103], 0
v_pk_fma_f16 v199, v200, v200, s48
v_and_b32 v187, s49, v187
s_waitcnt lgkmcnt(3)
v_mfma_f32_16x16x32_f16 v[64:67], v[244:247], v[232:235], v[64:67]
ds_read_b128 v[240:243], v249 offset:33024
v_pk_fma_f16 v196, v197, v197, s48
v_bfe_u32 v184, v185, 2, 14
v_pk_mul_f16 v202, v203, v202
v_mfma_f32_16x16x32_f16 v[72:75], v[244:247], v[236:239], v[72:75]
v_bfe_u32 v186, v187, 2, 14
v_pk_mul_f16 v199, v200, v199
s_waitcnt vmcnt(9)
v_mfma_f32_16x16x32_bf16 v[64:67], v[18:21], v[0:3], v[64:67]
ds_read_b128 v[244:247], v248 offset:36096
ds_read_u16_d16 v184, v184
ds_read_u16_d16 v186, v186
v_lshrrev_b32 v185, 18, v185
v_pk_mul_f16 v196, v197, v196
v_mfma_f32_16x16x32_bf16 v[68:71], v[16:19], v[0:3], v[68:71]
v_lshrrev_b32_e64 v187, 18, v187
v_mfma_f32_16x16x32_bf16 v[172:175], v[216:219], v[96:99], 0
ds_read_u16_d16_hi v185, v185
ds_read_u16_d16_hi v187, v187
v_exp_f16 v201, v202
v_and_b32 v189, s49, v189
v_mfma_f32_16x16x32_bf16 v[180:183], v[216:219], v[100:103], 0
v_and_b32 v191, s49, v191
s_waitcnt lgkmcnt(6)
v_mfma_f32_16x16x32_f16 v[68:71], v[220:223], v[232:235], v[68:71]
ds_read_b128 v[216:219], v248 offset:36864
v_exp_f16_e64 v198, v199
v_bfe_u32 v188, v189, 2, 14
v_mfma_f32_16x16x32_f16 v[76:79], v[220:223], v[236:239], v[76:79]
v_bfe_u32 v190, v191, 2, 14
v_exp_f16_e64 v195, v196
v_mfma_f32_16x16x32_bf16 v[168:171], v[224:227], v[104:107], v[168:171]
ds_read_b128 v[220:223], v248 offset:37120
ds_read_u16_d16 v188, v188
ds_read_u16_d16 v190, v190
v_lshrrev_b32 v189, 18, v189
v_lshrrev_b32 v191, 18, v191
v_mfma_f32_16x16x32_bf16 v[176:179], v[224:227], v[108:111], v[176:179]
v_exp_f16_sdwa v201, v202 dst_sel:WORD_1 dst_unused:UNUSED_PRESERVE src0_sel:WORD_1
v_mfma_f32_16x16x32_f16 v[80:83], v[228:231], v[232:235], v[80:83]
ds_read_b128 v[224:227], v249 offset:36864
ds_read_u16_d16_hi v189, v189
ds_read_u16_d16_hi v191, v191
v_and_b32 v193, s49, v193
v_bfe_u32 v192, v193, 2, 14
v_mfma_f32_16x16x32_f16 v[88:91], v[228:231], v[236:239], v[88:91]
v_exp_f16_sdwa v198, v199 dst_sel:WORD_1 dst_unused:UNUSED_PRESERVE src0_sel:WORD_1
s_waitcnt lgkmcnt(7)
v_mfma_f32_16x16x32_f16 v[84:87], v[240:243], v[232:235], v[84:87]
ds_read_b128 v[228:231], v249 offset:37120
ds_read_u16_d16 v192, v192
v_lshrrev_b32_e64 v193, 18, v193
v_mfma_f32_16x16x32_f16 v[92:95], v[240:243], v[236:239], v[92:95]
v_exp_f16_sdwa v195, v196 dst_sel:WORD_1 dst_unused:UNUSED_PRESERVE src0_sel:WORD_1
v_pk_add_f16 v201, v201, 1.0 op_sel_hi:[1,0]
v_pk_add_f16 v198, v198, 1.0 op_sel_hi:[1,0]
v_mfma_f32_16x16x32_bf16 v[172:175], v[244:247], v[104:107], v[172:175]
ds_read_b128 v[240:243], v248 offset:16384
ds_read_u16_d16_hi v193, v193
v_pk_add_f16 v195, v195, 1.0 op_sel_hi:[1,0]
v_mfma_f32_16x16x32_bf16 v[180:183], v[244:247], v[108:111], v[180:183]
v_rcp_f16_e64 v202, v201
s_setprio 0
s_waitcnt lgkmcnt(7)
v_mfma_f32_16x16x32_bf16 v[168:171], v[216:219], v[112:115], v[168:171]
ds_read_b128 v[244:247], v249 offset:37888
v_rcp_f16_e64 v199, v198
v_mfma_f32_16x16x32_bf16 v[176:179], v[216:219], v[116:119], v[176:179]
v_rcp_f16_e64 v196, v195
v_mfma_f32_16x16x32_bf16 v[172:175], v[220:223], v[112:115], v[172:175]
ds_read_b128 v[216:219], v248 offset:16640
v_rcp_f16_sdwa v202, v201 dst_sel:WORD_1 dst_unused:UNUSED_PRESERVE src0_sel:WORD_1
v_mfma_f32_16x16x32_bf16 v[180:183], v[220:223], v[116:119], v[180:183]
v_rcp_f16_sdwa v199, v198 dst_sel:WORD_1 dst_unused:UNUSED_PRESERVE src0_sel:WORD_1
v_or_b32 v232, v184, v185
v_or_b32 v233, v186, v187
s_waitcnt lgkmcnt(4)
v_or_b32 v234, v188, v189
v_rcp_f16_sdwa v196, v195 dst_sel:WORD_1 dst_unused:UNUSED_PRESERVE src0_sel:WORD_1
v_or_b32 v235, v190, v191
s_waitcnt lgkmcnt(2)
v_or_b32 v236, v192, v193
v_pk_mul_f16 v237, v203, v202
v_pk_mul_f16 v238, v200, v199
v_pk_mul_f16 v239, v197, v196
s_setprio 3
v_mfma_f32_16x16x32_f16 v[48:51], v[224:227], v[232:235], v[48:51]
s_add_u32 s46, s80, 12582912
buffer_load_dwordx4 v[96:99], v253, s[32:35], s46 offen nt
ds_read_b128 v[220:223], v249 offset:38144
v_cvt_pkrtz_f16_f32 v185, v168, v169
v_cvt_pkrtz_f16_f32 v187, v170, v171
v_mfma_f32_16x16x32_f16 v[56:59], v[224:227], v[236:239], v[56:59]
v_cvt_pkrtz_f16_f32 v189, v172, v173
v_cvt_pkrtz_f16_f32 v191, v174, v175
v_mfma_f32_16x16x32_f16 v[52:55], v[228:231], v[232:235], v[52:55]
ds_read_b128 v[224:227], v248 offset:17408
v_cvt_pkrtz_f16_f32 v193, v176, v177
v_cvt_pk_f16_f32 v203, v178, v179
v_mfma_f32_16x16x32_f16 v[60:63], v[228:231], v[236:239], v[60:63]
v_cvt_pk_f16_f32 v200, v180, v181
v_cvt_pk_f16_f32 v197, v182, v183
v_mfma_f32_16x16x32_bf16 v[168:171], v[240:243], v[24:27], 0
ds_read_b128 v[228:231], v249 offset:38912
v_pk_fma_f16 v202, v203, v203, s48
v_and_b32_e64 v185, s49, v185
v_mfma_f32_16x16x32_bf16 v[176:179], v[240:243], v[28:31], 0
v_pk_fma_f16 v199, v200, v200, s48
v_and_b32 v187, s49, v187
s_waitcnt lgkmcnt(3)
v_mfma_f32_16x16x32_f16 v[64:67], v[244:247], v[232:235], v[64:67]
ds_read_b128 v[240:243], v249 offset:39168
v_pk_fma_f16 v196, v197, v197, s48
v_bfe_u32 v184, v185, 2, 14
v_pk_mul_f16 v202, v203, v202
v_mfma_f32_16x16x32_f16 v[72:75], v[244:247], v[236:239], v[72:75]
v_bfe_u32 v186, v187, 2, 14
v_pk_mul_f16 v199, v200, v199
s_waitcnt vmcnt(9)
v_mfma_f32_16x16x32_bf16 v[80:83], v[18:21], v[8:11], v[80:83]
ds_read_b128 v[244:247], v248 offset:17664
ds_read_u16_d16 v184, v184
ds_read_u16_d16 v186, v186
v_lshrrev_b32 v185, 18, v185
v_pk_mul_f16 v196, v197, v196
v_mfma_f32_16x16x32_bf16 v[84:87], v[16:19], v[8:11], v[84:87]
v_lshrrev_b32_e64 v187, 18, v187
v_mfma_f32_16x16x32_bf16 v[172:175], v[216:219], v[24:27], 0
ds_read_u16_d16_hi v185, v185
ds_read_u16_d16_hi v187, v187
v_exp_f16 v201, v202
v_and_b32 v189, s49, v189
v_mfma_f32_16x16x32_bf16 v[180:183], v[216:219], v[28:31], 0
v_and_b32 v191, s49, v191
s_waitcnt lgkmcnt(6)
v_mfma_f32_16x16x32_f16 v[68:71], v[220:223], v[232:235], v[68:71]
ds_read_b128 v[216:219], v248 offset:18432
v_exp_f16_e64 v198, v199
v_bfe_u32 v188, v189, 2, 14
v_mfma_f32_16x16x32_f16 v[76:79], v[220:223], v[236:239], v[76:79]
v_bfe_u32 v190, v191, 2, 14
v_exp_f16_e64 v195, v196
v_mfma_f32_16x16x32_bf16 v[168:171], v[224:227], v[32:35], v[168:171]
ds_read_b128 v[220:223], v248 offset:18688
ds_read_u16_d16 v188, v188
ds_read_u16_d16 v190, v190
v_lshrrev_b32 v189, 18, v189
v_lshrrev_b32 v191, 18, v191
v_mfma_f32_16x16x32_bf16 v[176:179], v[224:227], v[36:39], v[176:179]
v_exp_f16_sdwa v201, v202 dst_sel:WORD_1 dst_unused:UNUSED_PRESERVE src0_sel:WORD_1
v_mfma_f32_16x16x32_f16 v[80:83], v[228:231], v[232:235], v[80:83]
ds_read_b128 v[224:227], v249 offset:43008
ds_read_u16_d16_hi v189, v189
ds_read_u16_d16_hi v191, v191
v_and_b32 v193, s49, v193
v_bfe_u32 v192, v193, 2, 14
v_mfma_f32_16x16x32_f16 v[88:91], v[228:231], v[236:239], v[88:91]
v_exp_f16_sdwa v198, v199 dst_sel:WORD_1 dst_unused:UNUSED_PRESERVE src0_sel:WORD_1
s_waitcnt lgkmcnt(7)
v_mfma_f32_16x16x32_f16 v[84:87], v[240:243], v[232:235], v[84:87]
ds_read_b128 v[228:231], v249 offset:43264
ds_read_u16_d16 v192, v192
v_lshrrev_b32_e64 v193, 18, v193
v_mfma_f32_16x16x32_f16 v[92:95], v[240:243], v[236:239], v[92:95]
v_exp_f16_sdwa v195, v196 dst_sel:WORD_1 dst_unused:UNUSED_PRESERVE src0_sel:WORD_1
v_pk_add_f16 v201, v201, 1.0 op_sel_hi:[1,0]
v_pk_add_f16 v198, v198, 1.0 op_sel_hi:[1,0]
v_mfma_f32_16x16x32_bf16 v[172:175], v[244:247], v[32:35], v[172:175]
ds_read_b128 v[240:243], v248 offset:22528
ds_read_u16_d16_hi v193, v193
v_pk_add_f16 v195, v195, 1.0 op_sel_hi:[1,0]
v_mfma_f32_16x16x32_bf16 v[180:183], v[244:247], v[36:39], v[180:183]
v_rcp_f16 v202, v201
s_waitcnt lgkmcnt(7)
v_mfma_f32_16x16x32_bf16 v[168:171], v[216:219], v[40:43], v[168:171]
ds_read_b128 v[244:247], v249 offset:44032
v_rcp_f16_e64 v199, v198
v_mfma_f32_16x16x32_bf16 v[176:179], v[216:219], v[44:47], v[176:179]
v_rcp_f16_e64 v196, v195
v_mfma_f32_16x16x32_bf16 v[172:175], v[220:223], v[40:43], v[172:175]
ds_read_b128 v[216:219], v248 offset:22784
v_rcp_f16_sdwa v202, v201 dst_sel:WORD_1 dst_unused:UNUSED_PRESERVE src0_sel:WORD_1
v_mfma_f32_16x16x32_bf16 v[180:183], v[220:223], v[44:47], v[180:183]
v_rcp_f16_sdwa v199, v198 dst_sel:WORD_1 dst_unused:UNUSED_PRESERVE src0_sel:WORD_1
v_or_b32 v232, v184, v185
v_or_b32 v233, v186, v187
s_waitcnt lgkmcnt(4)
v_or_b32 v234, v188, v189
v_rcp_f16_sdwa v196, v195 dst_sel:WORD_1 dst_unused:UNUSED_PRESERVE src0_sel:WORD_1
v_or_b32 v235, v190, v191
s_waitcnt lgkmcnt(2)
v_or_b32_e64 v236, v192, v193
v_pk_mul_f16 v237, v203, v202
v_pk_mul_f16 v238, v200, v199
v_pk_mul_f16 v239, v197, v196
v_mfma_f32_16x16x32_f16 v[48:51], v[224:227], v[232:235], v[48:51]
s_add_u32 s46, s71, 98304
buffer_store_dwordx4 v[160:163], v255, s[8:11], s46 offen offset:256 sc1
ds_read_b128 v[220:223], v249 offset:44288
v_cvt_pkrtz_f16_f32 v185, v168, v169
v_cvt_pkrtz_f16_f32 v187, v170, v171
v_mfma_f32_16x16x32_f16 v[56:59], v[224:227], v[236:239], v[56:59]
v_cvt_pkrtz_f16_f32 v189, v172, v173
v_cvt_pkrtz_f16_f32 v191, v174, v175
v_mfma_f32_16x16x32_f16 v[52:55], v[228:231], v[232:235], v[52:55]
ds_read_b128 v[224:227], v248 offset:23552
v_cvt_pkrtz_f16_f32 v193, v176, v177
v_cvt_pk_f16_f32 v203, v178, v179
v_mfma_f32_16x16x32_f16 v[60:63], v[228:231], v[236:239], v[60:63]
v_cvt_pk_f16_f32 v200, v180, v181
v_cvt_pk_f16_f32 v197, v182, v183
v_mfma_f32_16x16x32_bf16 v[168:171], v[240:243], v[24:27], 0
ds_read_b128 v[228:231], v249 offset:45056
v_pk_fma_f16 v202, v203, v203, s48
v_and_b32_e64 v185, s49, v185
v_mfma_f32_16x16x32_bf16 v[176:179], v[240:243], v[28:31], 0
v_pk_fma_f16 v199, v200, v200, s48
v_and_b32 v187, s49, v187
s_waitcnt lgkmcnt(3)
v_mfma_f32_16x16x32_f16 v[64:67], v[244:247], v[232:235], v[64:67]
ds_read_b128 v[240:243], v249 offset:45312
v_pk_fma_f16 v196, v197, v197, s48
s_setprio 2
v_bfe_u32 v184, v185, 2, 14
v_pk_mul_f16 v202, v203, v202
v_mfma_f32_16x16x32_f16 v[72:75], v[244:247], v[236:239], v[72:75]
v_bfe_u32 v186, v187, 2, 14
v_pk_mul_f16 v199, v200, v199
s_waitcnt vmcnt(8)
v_mfma_f32_16x16x32_bf16 v[56:59], v[18:21], v[12:15], v[56:59]
ds_read_b128 v[244:247], v248 offset:23808
ds_read_u16_d16 v184, v184
ds_read_u16_d16 v186, v186
v_lshrrev_b32_e64 v185, 18, v185
v_pk_mul_f16 v196, v197, v196
v_mfma_f32_16x16x32_bf16 v[60:63], v[16:19], v[12:15], v[60:63]
v_lshrrev_b32_e64 v187, 18, v187
v_mfma_f32_16x16x32_bf16 v[172:175], v[216:219], v[24:27], 0
ds_read_u16_d16_hi v185, v185
ds_read_u16_d16_hi v187, v187
v_exp_f16 v201, v202
v_and_b32 v189, s49, v189
v_mfma_f32_16x16x32_bf16 v[180:183], v[216:219], v[28:31], 0
v_and_b32 v191, s49, v191
s_waitcnt lgkmcnt(6)
v_mfma_f32_16x16x32_f16 v[68:71], v[220:223], v[232:235], v[68:71]
ds_read_b128 v[216:219], v248 offset:24576
v_exp_f16_e64 v198, v199
v_bfe_u32 v188, v189, 2, 14
v_mfma_f32_16x16x32_f16 v[76:79], v[220:223], v[236:239], v[76:79]
v_bfe_u32 v190, v191, 2, 14
v_exp_f16_e64 v195, v196
v_mfma_f32_16x16x32_bf16 v[168:171], v[224:227], v[32:35], v[168:171]
s_add_u32 s46, s80, 12582912
buffer_load_dwordx4 v[100:103], v253, s[32:35], s46 offen offset:256 nt
ds_read_b128 v[220:223], v248 offset:24832
ds_read_u16_d16 v188, v188
ds_read_u16_d16 v190, v190
v_lshrrev_b32 v189, 18, v189
v_lshrrev_b32 v191, 18, v191
v_mfma_f32_16x16x32_bf16 v[176:179], v[224:227], v[36:39], v[176:179]
v_exp_f16_sdwa v201, v202 dst_sel:WORD_1 dst_unused:UNUSED_PRESERVE src0_sel:WORD_1
v_mfma_f32_16x16x32_f16 v[80:83], v[228:231], v[232:235], v[80:83]
ds_read_b128 v[224:227], v249 offset:24576
ds_read_u16_d16_hi v189, v189
ds_read_u16_d16_hi v191, v191
v_and_b32 v193, s49, v193
v_bfe_u32 v192, v193, 2, 14
v_mfma_f32_16x16x32_f16 v[88:91], v[228:231], v[236:239], v[88:91]
v_exp_f16_sdwa v198, v199 dst_sel:WORD_1 dst_unused:UNUSED_PRESERVE src0_sel:WORD_1
s_waitcnt lgkmcnt(7)
v_mfma_f32_16x16x32_f16 v[84:87], v[240:243], v[232:235], v[84:87]
ds_read_b128 v[228:231], v254 offset:7936
ds_read_u16_d16 v192, v192
v_lshrrev_b32_e64 v193, 18, v193
v_mfma_f32_16x16x32_f16 v[92:95], v[240:243], v[236:239], v[92:95]
v_exp_f16_sdwa v195, v196 dst_sel:WORD_1 dst_unused:UNUSED_PRESERVE src0_sel:WORD_1
v_pk_add_f16 v201, v201, 1.0 op_sel_hi:[1,0]
v_pk_add_f16 v198, v198, 1.0 op_sel_hi:[1,0]
v_mfma_f32_16x16x32_bf16 v[172:175], v[244:247], v[32:35], v[172:175]
ds_read_b128 v[240:243], v249 offset:24832
ds_read_u16_d16_hi v193, v193
v_pk_add_f16 v195, v195, 1.0 op_sel_hi:[1,0]
v_mfma_f32_16x16x32_bf16 v[180:183], v[244:247], v[36:39], v[180:183]
v_rcp_f16 v202, v201
s_waitcnt lgkmcnt(7)
v_mfma_f32_16x16x32_bf16 v[168:171], v[216:219], v[40:43], v[168:171]
ds_read_b128 v[244:247], v254 offset:7952
v_rcp_f16_e64 v199, v198
v_mfma_f32_16x16x32_bf16 v[176:179], v[216:219], v[44:47], v[176:179]
v_rcp_f16_e64 v196, v195
v_mfma_f32_16x16x32_bf16 v[172:175], v[220:223], v[40:43], v[172:175]
ds_read_b128 v[216:219], v248 offset:28672
v_rcp_f16_sdwa v202, v201 dst_sel:WORD_1 dst_unused:UNUSED_PRESERVE src0_sel:WORD_1
v_mfma_f32_16x16x32_bf16 v[180:183], v[220:223], v[44:47], v[180:183]
v_rcp_f16_sdwa v199, v198 dst_sel:WORD_1 dst_unused:UNUSED_PRESERVE src0_sel:WORD_1
v_or_b32 v232, v184, v185
v_or_b32 v233, v186, v187
s_waitcnt lgkmcnt(4)
v_or_b32 v234, v188, v189
v_rcp_f16_sdwa v196, v195 dst_sel:WORD_1 dst_unused:UNUSED_PRESERVE src0_sel:WORD_1
v_or_b32 v235, v190, v191
s_waitcnt lgkmcnt(2)
v_or_b32 v236, v192, v193
v_pk_mul_f16 v237, v203, v202
v_pk_mul_f16 v238, v200, v199
v_pk_mul_f16 v239, v197, v196
v_mfma_f32_16x16x32_f16 v[120:123], v[224:227], v[232:235], v[228:231]
s_add_u32 s46, s80, 16777216
buffer_load_dwordx4 v[104:107], v253, s[32:35], s46 offen nt
ds_read_b128 v[220:223], v249 offset:25600
v_cvt_pkrtz_f16_f32 v185, v168, v169
v_cvt_pkrtz_f16_f32 v187, v170, v171
v_mfma_f32_16x16x32_f16 v[128:131], v[224:227], v[236:239], v[228:231]
v_cvt_pkrtz_f16_f32 v189, v172, v173
v_cvt_pkrtz_f16_f32 v191, v174, v175
s_waitcnt lgkmcnt(2)
v_mfma_f32_16x16x32_f16 v[124:127], v[240:243], v[232:235], v[244:247]
ds_read_b128 v[224:227], v254 offset:8064
ds_read_b128 v[228:231], v248 offset:28928
v_cvt_pkrtz_f16_f32 v193, v176, v177
v_cvt_pk_f16_f32 v203, v178, v179
v_mfma_f32_16x16x32_f16 v[132:135], v[240:243], v[236:239], v[244:247]
v_cvt_pk_f16_f32 v200, v180, v181
v_cvt_pk_f16_f32 v197, v182, v183
s_setprio 1
s_waitcnt lgkmcnt(3)
v_mfma_f32_16x16x32_bf16 v[168:171], v[216:219], v[24:27], 0
ds_read_b128 v[240:243], v249 offset:25856
ds_read_b128 v[244:247], v254 offset:8080
v_pk_fma_f16 v202, v203, v203, s48
v_and_b32_e64 v185, s49, v185
v_mfma_f32_16x16x32_bf16 v[176:179], v[216:219], v[28:31], 0
v_pk_fma_f16 v199, v200, v200, s48
v_and_b32 v187, s49, v187
s_waitcnt lgkmcnt(3)
v_mfma_f32_16x16x32_f16 v[136:139], v[220:223], v[232:235], v[224:227]
ds_read_b128 v[216:219], v248 offset:29696
v_pk_fma_f16 v196, v197, v197, s48
v_bfe_u32 v184, v185, 2, 14
v_pk_mul_f16 v202, v203, v202
v_mfma_f32_16x16x32_f16 v[144:147], v[220:223], v[236:239], v[224:227]
v_bfe_u32 v186, v187, 2, 14
v_pk_mul_f16 v199, v200, v199
s_waitcnt vmcnt(7)
v_mfma_f32_16x16x32_bf16 v[72:75], v[18:21], v[208:211], v[72:75]
ds_read_b128 v[220:223], v249 offset:26624
ds_read_b128 v[224:227], v254 offset:16128
ds_read_u16_d16 v184, v184
ds_read_u16_d16 v186, v186
v_lshrrev_b32 v185, 18, v185
v_pk_mul_f16 v196, v197, v196
v_mfma_f32_16x16x32_bf16 v[76:79], v[16:19], v[208:211], v[76:79]
v_lshrrev_b32 v187, 18, v187
s_waitcnt lgkmcnt(5)
v_mfma_f32_16x16x32_bf16 v[172:175], v[228:231], v[24:27], 0
ds_read_u16_d16_hi v185, v185
ds_read_u16_d16_hi v187, v187
v_exp_f16 v201, v202
v_and_b32 v189, s49, v189
v_mfma_f32_16x16x32_bf16 v[180:183], v[228:231], v[28:31], 0
v_and_b32_e64 v191, s49, v191
v_mfma_f32_16x16x32_f16 v[140:143], v[240:243], v[232:235], v[244:247]
ds_read_b128 v[228:231], v249 offset:26880
v_exp_f16_e64 v198, v199
v_bfe_u32 v188, v189, 2, 14
v_mfma_f32_16x16x32_f16 v[148:151], v[240:243], v[236:239], v[244:247]
v_bfe_u32 v190, v191, 2, 14
v_exp_f16 v195, v196
s_waitcnt lgkmcnt(7)
v_mfma_f32_16x16x32_bf16 v[168:171], v[216:219], v[32:35], v[168:171]
ds_read_b128 v[240:243], v254 offset:16144
ds_read_b128 v[244:247], v248 offset:29952
ds_read_u16_d16 v188, v188
ds_read_u16_d16 v190, v190
v_lshrrev_b32_e64 v189, 18, v189
v_lshrrev_b32 v191, 18, v191
v_mfma_f32_16x16x32_bf16 v[176:179], v[216:219], v[36:39], v[176:179]
v_exp_f16_sdwa v201, v202 dst_sel:WORD_1 dst_unused:UNUSED_PRESERVE src0_sel:WORD_1
s_waitcnt lgkmcnt(7)
v_mfma_f32_16x16x32_f16 v[152:155], v[220:223], v[232:235], v[224:227]
ds_read_b128 v[216:219], v248 offset:30720
ds_read_u16_d16_hi v189, v189
ds_read_u16_d16_hi v191, v191
v_and_b32 v193, s49, v193
v_bfe_u32 v192, v193, 2, 14
v_mfma_f32_16x16x32_f16 v[160:163], v[220:223], v[236:239], v[224:227]
v_exp_f16_sdwa v198, v199 dst_sel:WORD_1 dst_unused:UNUSED_PRESERVE src0_sel:WORD_1
s_waitcnt lgkmcnt(6)
v_mfma_f32_16x16x32_f16 v[156:159], v[228:231], v[232:235], v[240:243]
ds_read_b128 v[220:223], v248 offset:30976
ds_read_b128 v[224:227], v249 offset:30720
ds_read_u16_d16 v192, v192
v_lshrrev_b32 v193, 18, v193
v_mfma_f32_16x16x32_f16 v[164:167], v[228:231], v[236:239], v[240:243]
v_exp_f16_sdwa v195, v196 dst_sel:WORD_1 dst_unused:UNUSED_PRESERVE src0_sel:WORD_1
v_pk_add_f16 v201, v201, 1.0 op_sel_hi:[1,0]
v_pk_add_f16 v198, v198, 1.0 op_sel_hi:[1,0]
s_waitcnt lgkmcnt(7)
v_mfma_f32_16x16x32_bf16 v[172:175], v[244:247], v[32:35], v[172:175]
ds_read_b128 v[228:231], v249 offset:30976
ds_read_b128 v[240:243], v248 offset:34816
ds_read_u16_d16_hi v193, v193
v_pk_add_f16 v195, v195, 1.0 op_sel_hi:[1,0]
v_mfma_f32_16x16x32_bf16 v[180:183], v[244:247], v[36:39], v[180:183]
v_rcp_f16_e64 v202, v201
s_setprio 0
s_waitcnt lgkmcnt(7)
v_mfma_f32_16x16x32_bf16 v[168:171], v[216:219], v[40:43], v[168:171]
ds_read_b128 v[244:247], v249 offset:31744
v_rcp_f16_e64 v199, v198
v_mfma_f32_16x16x32_bf16 v[176:179], v[216:219], v[44:47], v[176:179]
v_rcp_f16 v196, v195
s_waitcnt lgkmcnt(6)
v_mfma_f32_16x16x32_bf16 v[172:175], v[220:223], v[40:43], v[172:175]
ds_read_b128 v[216:219], v248 offset:35072
v_rcp_f16_sdwa v202, v201 dst_sel:WORD_1 dst_unused:UNUSED_PRESERVE src0_sel:WORD_1
v_mfma_f32_16x16x32_bf16 v[180:183], v[220:223], v[44:47], v[180:183]
v_rcp_f16_sdwa v199, v198 dst_sel:WORD_1 dst_unused:UNUSED_PRESERVE src0_sel:WORD_1
v_or_b32 v232, v184, v185
v_or_b32 v233, v186, v187
v_or_b32_e64 v234, v188, v189
v_rcp_f16_sdwa v196, v195 dst_sel:WORD_1 dst_unused:UNUSED_PRESERVE src0_sel:WORD_1
v_or_b32 v235, v190, v191
s_waitcnt lgkmcnt(2)
v_or_b32 v236, v192, v193
v_pk_mul_f16 v237, v203, v202
v_pk_mul_f16 v238, v200, v199
v_pk_mul_f16 v239, v197, v196
s_setprio 3
v_mfma_f32_16x16x32_f16 v[120:123], v[224:227], v[232:235], v[120:123]
s_add_u32 s46, s80, 16777216
buffer_load_dwordx4 v[108:111], v253, s[32:35], s46 offen offset:256 nt
ds_read_b128 v[220:223], v249 offset:32000
v_cvt_pkrtz_f16_f32 v185, v168, v169
v_cvt_pkrtz_f16_f32 v187, v170, v171
v_mfma_f32_16x16x32_f16 v[128:131], v[224:227], v[236:239], v[128:131]
v_cvt_pkrtz_f16_f32 v189, v172, v173
v_cvt_pkrtz_f16_f32 v191, v174, v175
v_mfma_f32_16x16x32_f16 v[124:127], v[228:231], v[232:235], v[124:127]
ds_read_b128 v[224:227], v248 offset:35840
v_cvt_pkrtz_f16_f32 v193, v176, v177
v_cvt_pk_f16_f32 v203, v178, v179
v_mfma_f32_16x16x32_f16 v[132:135], v[228:231], v[236:239], v[132:135]
v_cvt_pk_f16_f32 v200, v180, v181
v_cvt_pk_f16_f32 v197, v182, v183
v_mfma_f32_16x16x32_bf16 v[168:171], v[240:243], v[24:27], 0
ds_read_b128 v[228:231], v249 offset:32768
v_pk_fma_f16 v202, v203, v203, s48
v_and_b32_e64 v185, s49, v185
v_mfma_f32_16x16x32_bf16 v[176:179], v[240:243], v[28:31], 0
v_pk_fma_f16 v199, v200, v200, s48
v_and_b32 v187, s49, v187
s_waitcnt lgkmcnt(3)
v_mfma_f32_16x16x32_f16 v[136:139], v[244:247], v[232:235], v[136:139]
ds_read_b128 v[240:243], v249 offset:33024
v_pk_fma_f16 v196, v197, v197, s48
v_bfe_u32 v184, v185, 2, 14
v_pk_mul_f16 v202, v203, v202
v_mfma_f32_16x16x32_f16 v[144:147], v[244:247], v[236:239], v[144:147]
v_bfe_u32 v186, v187, 2, 14
v_pk_mul_f16 v199, v200, v199
s_waitcnt vmcnt(7)
v_mfma_f32_16x16x32_bf16 v[88:91], v[18:21], v[204:207], v[88:91]
ds_read_b128 v[244:247], v248 offset:36096
ds_read_u16_d16 v184, v184
ds_read_u16_d16 v186, v186
v_lshrrev_b32 v185, 18, v185
v_pk_mul_f16 v196, v197, v196
v_mfma_f32_16x16x32_bf16 v[92:95], v[16:19], v[204:207], v[92:95]
v_lshrrev_b32_e64 v187, 18, v187
v_mfma_f32_16x16x32_bf16 v[172:175], v[216:219], v[24:27], 0
ds_read_u16_d16_hi v185, v185
ds_read_u16_d16_hi v187, v187
v_exp_f16 v201, v202
v_and_b32 v189, s49, v189
v_mfma_f32_16x16x32_bf16 v[180:183], v[216:219], v[28:31], 0
v_and_b32 v191, s49, v191
s_waitcnt lgkmcnt(6)
v_mfma_f32_16x16x32_f16 v[140:143], v[220:223], v[232:235], v[140:143]
ds_read_b128 v[216:219], v248 offset:36864
v_exp_f16_e64 v198, v199
v_bfe_u32 v188, v189, 2, 14
v_mfma_f32_16x16x32_f16 v[148:151], v[220:223], v[236:239], v[148:151]
v_bfe_u32 v190, v191, 2, 14
v_exp_f16_e64 v195, v196
v_mfma_f32_16x16x32_bf16 v[168:171], v[224:227], v[32:35], v[168:171]
ds_read_b128 v[220:223], v248 offset:37120
ds_read_u16_d16 v188, v188
ds_read_u16_d16 v190, v190
v_lshrrev_b32 v189, 18, v189
v_lshrrev_b32 v191, 18, v191
v_mfma_f32_16x16x32_bf16 v[176:179], v[224:227], v[36:39], v[176:179]
v_exp_f16_sdwa v201, v202 dst_sel:WORD_1 dst_unused:UNUSED_PRESERVE src0_sel:WORD_1
v_mfma_f32_16x16x32_f16 v[152:155], v[228:231], v[232:235], v[152:155]
ds_read_b128 v[224:227], v249 offset:36864
ds_read_u16_d16_hi v189, v189
ds_read_u16_d16_hi v191, v191
v_and_b32 v193, s49, v193
v_bfe_u32 v192, v193, 2, 14
v_mfma_f32_16x16x32_f16 v[160:163], v[228:231], v[236:239], v[160:163]
v_exp_f16_sdwa v198, v199 dst_sel:WORD_1 dst_unused:UNUSED_PRESERVE src0_sel:WORD_1
s_waitcnt lgkmcnt(7)
v_mfma_f32_16x16x32_f16 v[156:159], v[240:243], v[232:235], v[156:159]
ds_read_b128 v[228:231], v249 offset:37120
ds_read_u16_d16 v192, v192
v_lshrrev_b32_e64 v193, 18, v193
v_mfma_f32_16x16x32_f16 v[164:167], v[240:243], v[236:239], v[164:167]
v_exp_f16_sdwa v195, v196 dst_sel:WORD_1 dst_unused:UNUSED_PRESERVE src0_sel:WORD_1
v_pk_add_f16 v201, v201, 1.0 op_sel_hi:[1,0]
v_pk_add_f16 v198, v198, 1.0 op_sel_hi:[1,0]
v_mfma_f32_16x16x32_bf16 v[172:175], v[244:247], v[32:35], v[172:175]
ds_read_b128 v[240:243], v248 offset:40960
ds_read_u16_d16_hi v193, v193
v_pk_add_f16 v195, v195, 1.0 op_sel_hi:[1,0]
v_mfma_f32_16x16x32_bf16 v[180:183], v[244:247], v[36:39], v[180:183]
v_rcp_f16 v202, v201
s_waitcnt lgkmcnt(7)
v_mfma_f32_16x16x32_bf16 v[168:171], v[216:219], v[40:43], v[168:171]
ds_read_b128 v[244:247], v249 offset:37888
v_rcp_f16_e64 v199, v198
v_mfma_f32_16x16x32_bf16 v[176:179], v[216:219], v[44:47], v[176:179]
v_rcp_f16_e64 v196, v195
v_mfma_f32_16x16x32_bf16 v[172:175], v[220:223], v[40:43], v[172:175]
ds_read_b128 v[216:219], v248 offset:41216
v_rcp_f16_sdwa v202, v201 dst_sel:WORD_1 dst_unused:UNUSED_PRESERVE src0_sel:WORD_1
v_mfma_f32_16x16x32_bf16 v[180:183], v[220:223], v[44:47], v[180:183]
v_rcp_f16_sdwa v199, v198 dst_sel:WORD_1 dst_unused:UNUSED_PRESERVE src0_sel:WORD_1
v_or_b32 v232, v184, v185
v_or_b32 v233, v186, v187
s_waitcnt lgkmcnt(4)
v_or_b32 v234, v188, v189
v_rcp_f16_sdwa v196, v195 dst_sel:WORD_1 dst_unused:UNUSED_PRESERVE src0_sel:WORD_1
v_or_b32 v235, v190, v191
s_waitcnt lgkmcnt(2)
v_or_b32_e64 v236, v192, v193
v_pk_mul_f16 v237, v203, v202
v_pk_mul_f16 v238, v200, v199
v_pk_mul_f16 v239, v197, v196
v_mfma_f32_16x16x32_f16 v[120:123], v[224:227], v[232:235], v[120:123]
s_add_u32 s46, s80, 20971520
buffer_load_dwordx4 v[112:115], v253, s[32:35], s46 offen nt
ds_read_b128 v[220:223], v249 offset:38144
v_cvt_pkrtz_f16_f32 v185, v168, v169
v_cvt_pkrtz_f16_f32 v187, v170, v171
v_cvt_pkrtz_f16_f32 v189, v172, v173
v_mfma_f32_16x16x32_f16 v[128:131], v[224:227], v[236:239], v[128:131]
v_cvt_pkrtz_f16_f32 v191, v174, v175
v_cvt_pkrtz_f16_f32 v193, v176, v177
v_cvt_pk_f16_f32 v203, v178, v179
v_mfma_f32_16x16x32_f16 v[124:127], v[228:231], v[232:235], v[124:127]
ds_read_b128 v[224:227], v248 offset:41984
v_cvt_pk_f16_f32 v200, v180, v181
v_cvt_pk_f16_f32 v197, v182, v183
v_pk_fma_f16 v202, v203, v203, s48
v_cvt_pk_bf16_f32 v64, v64, v65
v_mfma_f32_16x16x32_f16 v[132:135], v[228:231], v[236:239], v[132:135]
v_and_b32_e64 v185, s49, v185
v_cvt_pk_bf16_f32 v65, v66, v67
v_pk_fma_f16 v199, v200, v200, s48
v_mfma_f32_16x16x32_bf16 v[168:171], v[240:243], v[24:27], 0
ds_read_b128 v[228:231], v249 offset:38912
v_and_b32_e64 v187, s49, v187
v_cvt_pk_bf16_f32 v66, v68, v69
v_pk_fma_f16 v196, v197, v197, s48
v_mfma_f32_16x16x32_bf16 v[176:179], v[240:243], v[28:31], 0
v_cvt_pk_bf16_f32 v67, v70, v71
v_bfe_u32 v184, v185, 2, 14
s_setprio 2
v_pk_mul_f16 v202, v203, v202
v_cvt_pk_bf16_f32 v48, v48, v49
s_waitcnt lgkmcnt(2)
v_mfma_f32_16x16x32_f16 v[136:139], v[244:247], v[232:235], v[136:139]
ds_read_b128 v[240:243], v249 offset:39168
ds_read_u16_d16 v184, v184
v_bfe_u32 v186, v187, 2, 14
v_cvt_pk_bf16_f32 v49, v50, v51
v_pk_mul_f16 v199, v200, v199
v_mfma_f32_16x16x32_f16 v[144:147], v[244:247], v[236:239], v[144:147]
v_lshrrev_b32_e64 v185, 18, v185
v_cvt_pk_bf16_f32 v50, v52, v53
v_pk_mul_f16 v196, v197, v196
v_mfma_f32_16x16x32_bf16 v[172:175], v[216:219], v[24:27], 0
ds_read_b128 v[244:247], v248 offset:42240
ds_read_u16_d16 v186, v186
ds_read_u16_d16_hi v185, v185
v_lshrrev_b32_e64 v187, 18, v187
v_cvt_pk_bf16_f32 v51, v54, v55
v_exp_f16_e64 v201, v202
v_mfma_f32_16x16x32_bf16 v[180:183], v[216:219], v[28:31], 0
v_cvt_pk_bf16_f32 v80, v80, v81
v_and_b32_e64 v189, s49, v189
v_cvt_pk_bf16_f32 v81, v82, v83
v_mfma_f32_16x16x32_f16 v[140:143], v[220:223], v[232:235], v[140:143]
ds_read_b128 v[216:219], v248 offset:43008
ds_read_u16_d16_hi v187, v187
v_and_b32_e64 v191, s49, v191
v_cvt_pk_bf16_f32 v82, v84, v85
v_mfma_f32_16x16x32_f16 v[148:151], v[220:223], v[236:239], v[148:151]
v_exp_f16_e64 v198, v199
v_cvt_pk_bf16_f32 v83, v86, v87
s_mov_b64 vcc, s[74:75]
v_bfe_u32 v188, v189, 2, 14
v_bfe_u32 v190, v191, 2, 14
s_waitcnt lgkmcnt(5)
v_mfma_f32_16x16x32_bf16 v[168:171], v[224:227], v[32:35], v[168:171]
ds_read_b128 v[220:223], v248 offset:43264
ds_read_u16_d16 v188, v188
ds_read_u16_d16 v190, v190
v_cndmask_b32 v68, v48, v80, vcc
v_exp_f16 v195, v196
v_mfma_f32_16x16x32_bf16 v[176:179], v[224:227], v[36:39], v[176:179]
v_cndmask_b32 v69, v49, v81, vcc
v_lshrrev_b32_e64 v189, 18, v189
v_cndmask_b32 v70, v50, v82, vcc
v_mfma_f32_16x16x32_f16 v[152:155], v[228:231], v[232:235], v[152:155]
ds_read_b128 v[224:227], v249 offset:43008
ds_read_u16_d16_hi v189, v189
v_lshrrev_b32 v191, 18, v191
v_cndmask_b32 v71, v51, v83, vcc
v_exp_f16_sdwa v201, v202 dst_sel:WORD_1 dst_unused:UNUSED_PRESERVE src0_sel:WORD_1
v_mfma_f32_16x16x32_f16 v[160:163], v[228:231], v[236:239], v[160:163]
v_cndmask_b32_dpp v48, v64, v48, vcc quad_perm:[1,0,3,2] row_mask:0xf bank_mask:0xf
v_and_b32_e64 v193, s49, v193
v_cndmask_b32_dpp v49, v65, v49, vcc quad_perm:[1,0,3,2] row_mask:0xf bank_mask:0xf
v_mfma_f32_16x16x32_f16 v[156:159], v[240:243], v[232:235], v[156:159]
ds_read_b128 v[228:231], v249 offset:43264
ds_read_u16_d16_hi v191, v191
v_bfe_u32 v192, v193, 2, 14
v_exp_f16_sdwa v198, v199 dst_sel:WORD_1 dst_unused:UNUSED_PRESERVE src0_sel:WORD_1
v_mfma_f32_16x16x32_f16 v[164:167], v[240:243], v[236:239], v[164:167]
v_cndmask_b32_dpp v50, v66, v50, vcc quad_perm:[1,0,3,2] row_mask:0xf bank_mask:0xf
v_lshrrev_b32_e64 v193, 18, v193
v_cndmask_b32_dpp v51, v67, v51, vcc quad_perm:[1,0,3,2] row_mask:0xf bank_mask:0xf
s_not_b64 vcc, s[74:75]
s_waitcnt lgkmcnt(4)
v_mfma_f32_16x16x32_bf16 v[172:175], v[244:247], v[32:35], v[172:175]
ds_read_b128 v[240:243], v248 offset:47104
ds_read_u16_d16 v192, v192
ds_read_u16_d16_hi v193, v193
v_exp_f16_sdwa v195, v196 dst_sel:WORD_1 dst_unused:UNUSED_PRESERVE src0_sel:WORD_1
v_cndmask_b32_dpp v80, v64, v80, vcc quad_perm:[1,0,3,2] row_mask:0xf bank_mask:0xf
v_pk_add_f16 v201, v201, 1.0 op_sel_hi:[1,0]
v_mfma_f32_16x16x32_bf16 v[180:183], v[244:247], v[36:39], v[180:183]
v_cndmask_b32_dpp v81, v65, v81, vcc quad_perm:[1,0,3,2] row_mask:0xf bank_mask:0xf
v_pk_add_f16 v198, v198, 1.0 op_sel_hi:[1,0]
v_cndmask_b32_dpp v82, v66, v82, vcc quad_perm:[1,0,3,2] row_mask:0xf bank_mask:0xf
v_mfma_f32_16x16x32_bf16 v[168:171], v[216:219], v[40:43], v[168:171]
ds_read_b128 v[244:247], v249 offset:44032
v_pk_add_f16 v195, v195, 1.0 op_sel_hi:[1,0]
v_rcp_f16_e64 v202, v201
v_cndmask_b32_dpp v83, v67, v83, vcc quad_perm:[1,0,3,2] row_mask:0xf bank_mask:0xf
v_mfma_f32_16x16x32_bf16 v[176:179], v[216:219], v[44:47], v[176:179]
v_rcp_f16_e64 v199, v198
v_mfma_f32_16x16x32_bf16 v[172:175], v[220:223], v[40:43], v[172:175]
ds_read_b128 v[216:219], v248 offset:47360
buffer_store_dwordx4 v[48:51], v255, s[8:11], s70 offen sc1
v_rcp_f16_e64 v196, v195
v_rcp_f16_sdwa v202, v201 dst_sel:WORD_1 dst_unused:UNUSED_PRESERVE src0_sel:WORD_1
v_mfma_f32_16x16x32_bf16 v[180:183], v[220:223], v[44:47], v[180:183]
v_rcp_f16_sdwa v199, v198 dst_sel:WORD_1 dst_unused:UNUSED_PRESERVE src0_sel:WORD_1
v_or_b32 v232, v184, v185
v_or_b32 v233, v186, v187
s_waitcnt lgkmcnt(3)
v_or_b32 v234, v188, v189
v_rcp_f16_sdwa v196, v195 dst_sel:WORD_1 dst_unused:UNUSED_PRESERVE src0_sel:WORD_1
v_or_b32 v235, v190, v191
s_waitcnt lgkmcnt(2)
v_or_b32_e64 v236, v192, v193
v_pk_mul_f16 v237, v203, v202
v_pk_mul_f16 v238, v200, v199
v_pk_mul_f16 v239, v197, v196
v_mfma_f32_16x16x32_f16 v[120:123], v[224:227], v[232:235], v[120:123]
buffer_store_dwordx4 v[68:71], v255, s[8:11], s70 offen offset:128 sc1
ds_read_b128 v[220:223], v249 offset:44288
v_cvt_pkrtz_f16_f32 v185, v168, v169
v_cvt_pkrtz_f16_f32 v187, v170, v171
v_mfma_f32_16x16x32_f16 v[128:131], v[224:227], v[236:239], v[128:131]
v_cvt_pkrtz_f16_f32 v189, v172, v173
v_cvt_pkrtz_f16_f32 v191, v174, v175
v_mfma_f32_16x16x32_f16 v[124:127], v[228:231], v[232:235], v[124:127]
ds_read_b128 v[224:227], v248 offset:48128
v_cvt_pkrtz_f16_f32 v193, v176, v177
v_cvt_pk_f16_f32 v203, v178, v179
v_cvt_pk_f16_f32 v200, v180, v181
v_mfma_f32_16x16x32_f16 v[132:135], v[228:231], v[236:239], v[132:135]
v_cvt_pk_f16_f32 v197, v182, v183
s_setprio 1
v_pk_fma_f16 v202, v203, v203, s48
v_mfma_f32_16x16x32_bf16 v[168:171], v[240:243], v[24:27], 0
ds_read_b128 v[228:231], v249 offset:45056
v_and_b32 v185, s49, v185
v_pk_fma_f16 v199, v200, v200, s48
v_mfma_f32_16x16x32_bf16 v[176:179], v[240:243], v[28:31], 0
v_and_b32 v187, s49, v187
v_pk_fma_f16 v196, v197, v197, s48
v_bfe_u32 v184, v185, 2, 14
s_waitcnt lgkmcnt(3)
v_mfma_f32_16x16x32_f16 v[136:139], v[244:247], v[232:235], v[136:139]
ds_read_b128 v[240:243], v249 offset:45312
ds_read_u16_d16 v184, v184
v_pk_mul_f16 v202, v203, v202
v_bfe_u32 v186, v187, 2, 14
v_mfma_f32_16x16x32_f16 v[144:147], v[244:247], v[236:239], v[144:147]
v_pk_mul_f16 v199, v200, v199
v_lshrrev_b32_e64 v185, 18, v185
v_mfma_f32_16x16x32_bf16 v[172:175], v[216:219], v[24:27], 0
ds_read_b128 v[244:247], v248 offset:48384
ds_read_u16_d16 v186, v186
ds_read_u16_d16_hi v185, v185
v_pk_mul_f16 v196, v197, v196
v_lshrrev_b32_e64 v187, 18, v187
v_mfma_f32_16x16x32_bf16 v[180:183], v[216:219], v[28:31], 0
v_exp_f16_e64 v201, v202
v_and_b32 v189, s49, v189
s_waitcnt lgkmcnt(5)
v_mfma_f32_16x16x32_f16 v[140:143], v[220:223], v[232:235], v[140:143]
ds_read_b128 v[216:219], v248 offset:49152
ds_read_u16_d16_hi v187, v187
v_and_b32_e64 v191, s49, v191
v_mfma_f32_16x16x32_f16 v[148:151], v[220:223], v[236:239], v[148:151]
v_exp_f16_e64 v198, v199
v_bfe_u32 v188, v189, 2, 14
v_bfe_u32 v190, v191, 2, 14
v_mfma_f32_16x16x32_bf16 v[168:171], v[224:227], v[32:35], v[168:171]
s_add_u32 s46, s80, 20971520
buffer_load_dwordx4 v[116:119], v253, s[32:35], s46 offen offset:256 nt
ds_read_b128 v[220:223], v248 offset:49408
ds_read_u16_d16 v188, v188
ds_read_u16_d16 v190, v190
v_exp_f16_e64 v195, v196
v_mfma_f32_16x16x32_bf16 v[176:179], v[224:227], v[36:39], v[176:179]
v_lshrrev_b32 v189, 18, v189
v_lshrrev_b32 v191, 18, v191
v_mfma_f32_16x16x32_f16 v[152:155], v[228:231], v[232:235], v[152:155]
ds_read_b128 v[224:227], v249 offset:49152
ds_read_u16_d16_hi v189, v189
ds_read_u16_d16_hi v191, v191
v_exp_f16_sdwa v201, v202 dst_sel:WORD_1 dst_unused:UNUSED_PRESERVE src0_sel:WORD_1
v_and_b32 v193, s49, v193
v_mfma_f32_16x16x32_f16 v[160:163], v[228:231], v[236:239], v[160:163]
v_bfe_u32 v192, v193, 2, 14
s_waitcnt lgkmcnt(7)
v_mfma_f32_16x16x32_f16 v[156:159], v[240:243], v[232:235], v[156:159]
ds_read_b128 v[228:231], v249 offset:49408
ds_read_u16_d16 v192, v192
v_exp_f16_sdwa v198, v199 dst_sel:WORD_1 dst_unused:UNUSED_PRESERVE src0_sel:WORD_1
v_lshrrev_b32_e64 v193, 18, v193
v_mfma_f32_16x16x32_f16 v[164:167], v[240:243], v[236:239], v[164:167]
v_exp_f16_sdwa v195, v196 dst_sel:WORD_1 dst_unused:UNUSED_PRESERVE src0_sel:WORD_1
v_pk_add_f16 v201, v201, 1.0 op_sel_hi:[1,0]
v_mfma_f32_16x16x32_bf16 v[172:175], v[244:247], v[32:35], v[172:175]
ds_read_b128 v[240:243], v248 offset:53248
ds_read_u16_d16_hi v193, v193
v_pk_add_f16 v198, v198, 1.0 op_sel_hi:[1,0]
v_pk_add_f16 v195, v195, 1.0 op_sel_hi:[1,0]
v_mfma_f32_16x16x32_bf16 v[180:183], v[244:247], v[36:39], v[180:183]
v_rcp_f16 v202, v201
s_setprio 0
v_mfma_f32_16x16x32_bf16 v[168:171], v[216:219], v[40:43], v[168:171]
ds_read_b128 v[244:247], v249 offset:50176
v_rcp_f16_e64 v199, v198
v_mfma_f32_16x16x32_bf16 v[176:179], v[216:219], v[44:47], v[176:179]
v_rcp_f16 v196, v195
s_waitcnt lgkmcnt(5)
v_mfma_f32_16x16x32_bf16 v[172:175], v[220:223], v[40:43], v[172:175]
ds_read_b128 v[216:219], v248 offset:53504
v_rcp_f16_sdwa v202, v201 dst_sel:WORD_1 dst_unused:UNUSED_PRESERVE src0_sel:WORD_1
v_mfma_f32_16x16x32_bf16 v[180:183], v[220:223], v[44:47], v[180:183]
v_rcp_f16_sdwa v199, v198 dst_sel:WORD_1 dst_unused:UNUSED_PRESERVE src0_sel:WORD_1
v_or_b32 v232, v184, v185
v_or_b32 v233, v186, v187
v_or_b32_e64 v234, v188, v189
v_rcp_f16_sdwa v196, v195 dst_sel:WORD_1 dst_unused:UNUSED_PRESERVE src0_sel:WORD_1
v_or_b32 v235, v190, v191
s_waitcnt lgkmcnt(2)
v_or_b32 v236, v192, v193
v_pk_mul_f16 v237, v203, v202
v_pk_mul_f16 v238, v200, v199
v_pk_mul_f16 v239, v197, v196
s_setprio 3
v_mfma_f32_16x16x32_f16 v[120:123], v[224:227], v[232:235], v[120:123]
ds_read_b128 v[220:223], v249 offset:50432
v_cvt_pkrtz_f16_f32 v185, v168, v169
v_cvt_pkrtz_f16_f32 v187, v170, v171
v_mfma_f32_16x16x32_f16 v[128:131], v[224:227], v[236:239], v[128:131]
v_cvt_pkrtz_f16_f32 v189, v172, v173
v_cvt_pkrtz_f16_f32 v191, v174, v175
v_mfma_f32_16x16x32_f16 v[124:127], v[228:231], v[232:235], v[124:127]
ds_read_b128 v[224:227], v248 offset:54272
v_cvt_pkrtz_f16_f32 v193, v176, v177
v_cvt_pk_f16_f32 v203, v178, v179
v_cvt_pk_f16_f32 v200, v180, v181
v_mfma_f32_16x16x32_f16 v[132:135], v[228:231], v[236:239], v[132:135]
v_cvt_pk_f16_f32 v197, v182, v183
v_pk_fma_f16 v202, v203, v203, s48
v_mfma_f32_16x16x32_bf16 v[168:171], v[240:243], v[24:27], 0
ds_read_b128 v[228:231], v249 offset:51200
v_and_b32_e64 v185, s49, v185
v_pk_fma_f16 v199, v200, v200, s48
v_mfma_f32_16x16x32_bf16 v[176:179], v[240:243], v[28:31], 0
v_and_b32 v187, s49, v187
v_pk_fma_f16 v196, v197, v197, s48
v_bfe_u32 v184, v185, 2, 14
s_waitcnt lgkmcnt(3)
v_mfma_f32_16x16x32_f16 v[136:139], v[244:247], v[232:235], v[136:139]
ds_read_b128 v[240:243], v249 offset:51456
ds_read_u16_d16 v184, v184
v_pk_mul_f16 v202, v203, v202
v_bfe_u32 v186, v187, 2, 14
v_mfma_f32_16x16x32_f16 v[144:147], v[244:247], v[236:239], v[144:147]
v_pk_mul_f16 v199, v200, v199
v_lshrrev_b32_e64 v185, 18, v185
v_mfma_f32_16x16x32_bf16 v[172:175], v[216:219], v[24:27], 0
ds_read_b128 v[244:247], v248 offset:54528
ds_read_u16_d16 v186, v186
ds_read_u16_d16_hi v185, v185
v_pk_mul_f16 v196, v197, v196
v_lshrrev_b32_e64 v187, 18, v187
v_mfma_f32_16x16x32_bf16 v[180:183], v[216:219], v[28:31], 0
v_exp_f16_e64 v201, v202
v_and_b32 v189, s49, v189
s_waitcnt lgkmcnt(5)
v_mfma_f32_16x16x32_f16 v[140:143], v[220:223], v[232:235], v[140:143]
ds_read_b128 v[216:219], v248 offset:55296
ds_read_u16_d16_hi v187, v187
v_and_b32_e64 v191, s49, v191
v_mfma_f32_16x16x32_f16 v[148:151], v[220:223], v[236:239], v[148:151]
v_exp_f16_e64 v198, v199
v_bfe_u32 v188, v189, 2, 14
v_bfe_u32 v190, v191, 2, 14
v_mfma_f32_16x16x32_bf16 v[168:171], v[224:227], v[32:35], v[168:171]
ds_read_b128 v[220:223], v248 offset:55552
ds_read_u16_d16 v188, v188
ds_read_u16_d16 v190, v190
v_exp_f16_e64 v195, v196
v_mfma_f32_16x16x32_bf16 v[176:179], v[224:227], v[36:39], v[176:179]
v_lshrrev_b32 v189, 18, v189
v_lshrrev_b32 v191, 18, v191
v_mfma_f32_16x16x32_f16 v[152:155], v[228:231], v[232:235], v[152:155]
ds_read_b128 v[224:227], v249 offset:55296
ds_read_u16_d16_hi v189, v189
ds_read_u16_d16_hi v191, v191
v_exp_f16_sdwa v201, v202 dst_sel:WORD_1 dst_unused:UNUSED_PRESERVE src0_sel:WORD_1
v_and_b32 v193, s49, v193
v_mfma_f32_16x16x32_f16 v[160:163], v[228:231], v[236:239], v[160:163]
v_bfe_u32 v192, v193, 2, 14
s_waitcnt lgkmcnt(8)
v_mfma_f32_16x16x32_f16 v[156:159], v[240:243], v[232:235], v[156:159]
ds_read_b128 v[228:231], v249 offset:55552
ds_read_u16_d16 v192, v192
v_exp_f16_sdwa v198, v199 dst_sel:WORD_1 dst_unused:UNUSED_PRESERVE src0_sel:WORD_1
v_lshrrev_b32_e64 v193, 18, v193
v_mfma_f32_16x16x32_f16 v[164:167], v[240:243], v[236:239], v[164:167]
v_exp_f16_sdwa v195, v196 dst_sel:WORD_1 dst_unused:UNUSED_PRESERVE src0_sel:WORD_1
v_pk_add_f16 v201, v201, 1.0 op_sel_hi:[1,0]
v_mfma_f32_16x16x32_bf16 v[172:175], v[244:247], v[32:35], v[172:175]
ds_read_b128 v[240:243], v248 offset:59392
ds_read_u16_d16_hi v193, v193
v_pk_add_f16 v198, v198, 1.0 op_sel_hi:[1,0]
v_pk_add_f16 v195, v195, 1.0 op_sel_hi:[1,0]
v_mfma_f32_16x16x32_bf16 v[180:183], v[244:247], v[36:39], v[180:183]
v_rcp_f16 v202, v201
s_waitcnt lgkmcnt(7)
v_mfma_f32_16x16x32_bf16 v[168:171], v[216:219], v[40:43], v[168:171]
ds_read_b128 v[244:247], v249 offset:56320
v_rcp_f16_e64 v199, v198
v_mfma_f32_16x16x32_bf16 v[176:179], v[216:219], v[44:47], v[176:179]
v_rcp_f16_e64 v196, v195
v_mfma_f32_16x16x32_bf16 v[172:175], v[220:223], v[40:43], v[172:175]
ds_read_b128 v[216:219], v248 offset:59648
v_rcp_f16_sdwa v202, v201 dst_sel:WORD_1 dst_unused:UNUSED_PRESERVE src0_sel:WORD_1
v_mfma_f32_16x16x32_bf16 v[180:183], v[220:223], v[44:47], v[180:183]
v_rcp_f16_sdwa v199, v198 dst_sel:WORD_1 dst_unused:UNUSED_PRESERVE src0_sel:WORD_1
v_or_b32 v232, v184, v185
v_or_b32 v233, v186, v187
s_waitcnt lgkmcnt(4)
v_or_b32 v234, v188, v189
v_rcp_f16_sdwa v196, v195 dst_sel:WORD_1 dst_unused:UNUSED_PRESERVE src0_sel:WORD_1
v_or_b32 v235, v190, v191
s_waitcnt lgkmcnt(2)
v_or_b32_e64 v236, v192, v193
v_pk_mul_f16 v237, v203, v202
v_pk_mul_f16 v238, v200, v199
v_pk_mul_f16 v239, v197, v196
v_mfma_f32_16x16x32_f16 v[120:123], v[224:227], v[232:235], v[120:123]
buffer_load_dwordx4 v[204:207], v252, s[4:7], s68 offen
ds_read_b128 v[220:223], v249 offset:56576
v_cvt_pkrtz_f16_f32 v185, v168, v169
v_cvt_pkrtz_f16_f32 v187, v170, v171
v_mfma_f32_16x16x32_f16 v[128:131], v[224:227], v[236:239], v[128:131]
v_cvt_pkrtz_f16_f32 v189, v172, v173
v_cvt_pkrtz_f16_f32 v191, v174, v175
v_mfma_f32_16x16x32_f16 v[124:127], v[228:231], v[232:235], v[124:127]
ds_read_b128 v[224:227], v248 offset:60416
v_cvt_pkrtz_f16_f32 v193, v176, v177
v_cvt_pk_f16_f32 v203, v178, v179
v_cvt_pk_f16_f32 v200, v180, v181
v_mfma_f32_16x16x32_f16 v[132:135], v[228:231], v[236:239], v[132:135]
v_cvt_pk_f16_f32 v197, v182, v183
v_pk_fma_f16 v202, v203, v203, s48
v_mfma_f32_16x16x32_bf16 v[168:171], v[240:243], v[24:27], 0
ds_read_b128 v[228:231], v249 offset:57344
v_and_b32_e64 v185, s49, v185
v_pk_fma_f16 v199, v200, v200, s48
v_mfma_f32_16x16x32_bf16 v[176:179], v[240:243], v[28:31], 0
v_and_b32_e64 v187, s49, v187
v_pk_fma_f16 v196, v197, v197, s48
s_setprio 2
v_bfe_u32 v184, v185, 2, 14
s_waitcnt lgkmcnt(3)
v_mfma_f32_16x16x32_f16 v[136:139], v[244:247], v[232:235], v[136:139]
ds_read_b128 v[240:243], v249 offset:57600
ds_read_u16_d16 v184, v184
v_pk_mul_f16 v202, v203, v202
v_bfe_u32 v186, v187, 2, 14
v_mfma_f32_16x16x32_f16 v[144:147], v[244:247], v[236:239], v[144:147]
v_pk_mul_f16 v199, v200, v199
v_lshrrev_b32_e64 v185, 18, v185
v_mfma_f32_16x16x32_bf16 v[172:175], v[216:219], v[24:27], 0
ds_read_b128 v[244:247], v248 offset:60672
ds_read_u16_d16 v186, v186
ds_read_u16_d16_hi v185, v185
v_pk_mul_f16 v196, v197, v196
v_lshrrev_b32_e64 v187, 18, v187
v_mfma_f32_16x16x32_bf16 v[180:183], v[216:219], v[28:31], 0
v_exp_f16_e64 v201, v202
v_and_b32 v189, s49, v189
s_waitcnt lgkmcnt(5)
v_mfma_f32_16x16x32_f16 v[140:143], v[220:223], v[232:235], v[140:143]
ds_read_b128 v[216:219], v248 offset:61440
ds_read_u16_d16_hi v187, v187
v_and_b32_e64 v191, s49, v191
v_mfma_f32_16x16x32_f16 v[148:151], v[220:223], v[236:239], v[148:151]
v_exp_f16_e64 v198, v199
v_bfe_u32 v188, v189, 2, 14
v_bfe_u32 v190, v191, 2, 14
v_mfma_f32_16x16x32_bf16 v[168:171], v[224:227], v[32:35], v[168:171]
buffer_store_dwordx4 v[80:83], v255, s[8:11], s70 offen offset:256 sc1
ds_read_b128 v[220:223], v248 offset:61696
ds_read_u16_d16 v188, v188
ds_read_u16_d16 v190, v190
v_exp_f16_e64 v195, v196
v_mfma_f32_16x16x32_bf16 v[176:179], v[224:227], v[36:39], v[176:179]
v_lshrrev_b32 v189, 18, v189
v_lshrrev_b32 v191, 18, v191
v_mfma_f32_16x16x32_f16 v[152:155], v[228:231], v[232:235], v[152:155]
ds_read_b128 v[224:227], v249 offset:61440
ds_read_u16_d16_hi v189, v189
ds_read_u16_d16_hi v191, v191
v_exp_f16_sdwa v201, v202 dst_sel:WORD_1 dst_unused:UNUSED_PRESERVE src0_sel:WORD_1
v_and_b32 v193, s49, v193
v_mfma_f32_16x16x32_f16 v[160:163], v[228:231], v[236:239], v[160:163]
v_bfe_u32 v192, v193, 2, 14
s_waitcnt lgkmcnt(8)
v_mfma_f32_16x16x32_f16 v[156:159], v[240:243], v[232:235], v[156:159]
ds_read_b128 v[228:231], v249 offset:61696
ds_read_u16_d16 v192, v192
v_exp_f16_sdwa v198, v199 dst_sel:WORD_1 dst_unused:UNUSED_PRESERVE src0_sel:WORD_1
v_lshrrev_b32_e64 v193, 18, v193
v_mfma_f32_16x16x32_f16 v[164:167], v[240:243], v[236:239], v[164:167]
v_exp_f16_sdwa v195, v196 dst_sel:WORD_1 dst_unused:UNUSED_PRESERVE src0_sel:WORD_1
v_pk_add_f16 v201, v201, 1.0 op_sel_hi:[1,0]
v_mfma_f32_16x16x32_bf16 v[172:175], v[244:247], v[32:35], v[172:175]
ds_read_b128 v[240:243], v249
ds_read_u16_d16_hi v193, v193
v_pk_add_f16 v198, v198, 1.0 op_sel_hi:[1,0]
v_pk_add_f16 v195, v195, 1.0 op_sel_hi:[1,0]
v_mfma_f32_16x16x32_bf16 v[180:183], v[244:247], v[36:39], v[180:183]
v_rcp_f16 v202, v201
s_waitcnt lgkmcnt(7)
v_mfma_f32_16x16x32_bf16 v[168:171], v[216:219], v[40:43], v[168:171]
ds_read_b128 v[244:247], v249 offset:62464
v_rcp_f16_e64 v199, v198
v_mfma_f32_16x16x32_bf16 v[176:179], v[216:219], v[44:47], v[176:179]
v_rcp_f16_e64 v196, v195
v_mfma_f32_16x16x32_bf16 v[172:175], v[220:223], v[40:43], v[172:175]
ds_read_b128 v[216:219], v249 offset:256
v_rcp_f16_sdwa v202, v201 dst_sel:WORD_1 dst_unused:UNUSED_PRESERVE src0_sel:WORD_1
v_mfma_f32_16x16x32_bf16 v[180:183], v[220:223], v[44:47], v[180:183]
v_rcp_f16_sdwa v199, v198 dst_sel:WORD_1 dst_unused:UNUSED_PRESERVE src0_sel:WORD_1
v_or_b32 v232, v184, v185
v_or_b32 v233, v186, v187
s_waitcnt lgkmcnt(4)
v_or_b32 v234, v188, v189
v_rcp_f16_sdwa v196, v195 dst_sel:WORD_1 dst_unused:UNUSED_PRESERVE src0_sel:WORD_1
v_or_b32 v235, v190, v191
s_waitcnt lgkmcnt(2)
v_or_b32_e64 v236, v192, v193
v_pk_mul_f16 v237, v203, v202
v_pk_mul_f16 v238, v200, v199
v_pk_mul_f16 v239, v197, v196
v_mfma_f32_16x16x32_f16 v[120:123], v[224:227], v[232:235], v[120:123]
buffer_load_dwordx4 v[208:211], v252, s[4:7], s68 offen offset:64
ds_read_b128 v[220:223], v249 offset:62720
v_cvt_pkrtz_f16_f32 v185, v168, v169
v_cvt_pkrtz_f16_f32 v187, v170, v171
v_mfma_f32_16x16x32_f16 v[128:131], v[224:227], v[236:239], v[128:131]
v_cvt_pkrtz_f16_f32 v189, v172, v173
v_cvt_pkrtz_f16_f32 v191, v174, v175
v_mfma_f32_16x16x32_f16 v[124:127], v[228:231], v[232:235], v[124:127]
ds_read_b128 v[224:227], v249 offset:1024
v_cvt_pkrtz_f16_f32 v193, v176, v177
v_cvt_pk_f16_f32 v203, v178, v179
v_cvt_pk_f16_f32 v200, v180, v181
v_mfma_f32_16x16x32_f16 v[132:135], v[228:231], v[236:239], v[132:135]
v_cvt_pk_f16_f32 v197, v182, v183
s_setprio 1
v_pk_fma_f16 v202, v203, v203, s48
v_mfma_f32_16x16x32_bf16 v[168:171], v[240:243], v[24:27], 0
ds_read_b128 v[228:231], v249 offset:63488
v_and_b32 v185, s49, v185
v_pk_fma_f16 v199, v200, v200, s48
v_mfma_f32_16x16x32_bf16 v[176:179], v[240:243], v[28:31], 0
v_and_b32 v187, s49, v187
v_pk_fma_f16 v196, v197, v197, s48
v_bfe_u32 v184, v185, 2, 14
s_waitcnt lgkmcnt(3)
v_mfma_f32_16x16x32_f16 v[136:139], v[244:247], v[232:235], v[136:139]
ds_read_b128 v[240:243], v249 offset:63744
ds_read_u16_d16 v184, v184
v_pk_mul_f16 v202, v203, v202
v_bfe_u32 v186, v187, 2, 14
v_mfma_f32_16x16x32_f16 v[144:147], v[244:247], v[236:239], v[144:147]
v_pk_mul_f16 v199, v200, v199
v_lshrrev_b32_e64 v185, 18, v185
v_mfma_f32_16x16x32_bf16 v[172:175], v[216:219], v[24:27], 0
ds_read_b128 v[244:247], v249 offset:1280
ds_read_u16_d16 v186, v186
ds_read_u16_d16_hi v185, v185
v_pk_mul_f16 v196, v197, v196
v_lshrrev_b32_e64 v187, 18, v187
v_mfma_f32_16x16x32_bf16 v[180:183], v[216:219], v[28:31], 0
v_exp_f16_e64 v201, v202
v_and_b32 v189, s49, v189
s_waitcnt lgkmcnt(5)
v_mfma_f32_16x16x32_f16 v[140:143], v[220:223], v[232:235], v[140:143]
ds_read_b128 v[216:219], v249 offset:2048
ds_read_u16_d16_hi v187, v187
v_and_b32_e64 v191, s49, v191
v_mfma_f32_16x16x32_f16 v[148:151], v[220:223], v[236:239], v[148:151]
v_exp_f16_e64 v198, v199
v_bfe_u32 v188, v189, 2, 14
v_bfe_u32 v190, v191, 2, 14
v_mfma_f32_16x16x32_bf16 v[168:171], v[224:227], v[32:35], v[168:171]
ds_read_b128 v[220:223], v249 offset:2304
ds_read_u16_d16 v188, v188
ds_read_u16_d16 v190, v190
v_exp_f16_e64 v195, v196
v_mfma_f32_16x16x32_bf16 v[176:179], v[224:227], v[36:39], v[176:179]
v_lshrrev_b32 v189, 18, v189
v_lshrrev_b32 v191, 18, v191
v_mfma_f32_16x16x32_f16 v[152:155], v[228:231], v[232:235], v[152:155]
ds_read_b128 v[224:227], v250 offset:2048
ds_read_u16_d16_hi v189, v189
ds_read_u16_d16_hi v191, v191
v_exp_f16_sdwa v201, v202 dst_sel:WORD_1 dst_unused:UNUSED_PRESERVE src0_sel:WORD_1
v_and_b32 v193, s49, v193
v_mfma_f32_16x16x32_f16 v[160:163], v[228:231], v[236:239], v[160:163]
v_bfe_u32 v192, v193, 2, 14
s_waitcnt lgkmcnt(8)
v_mfma_f32_16x16x32_f16 v[156:159], v[240:243], v[232:235], v[156:159]
ds_read_b128 v[228:231], v250 offset:2304
ds_read_u16_d16 v192, v192
v_exp_f16_sdwa v198, v199 dst_sel:WORD_1 dst_unused:UNUSED_PRESERVE src0_sel:WORD_1
v_lshrrev_b32_e64 v193, 18, v193
v_mfma_f32_16x16x32_f16 v[164:167], v[240:243], v[236:239], v[164:167]
v_exp_f16_sdwa v195, v196 dst_sel:WORD_1 dst_unused:UNUSED_PRESERVE src0_sel:WORD_1
v_pk_add_f16 v201, v201, 1.0 op_sel_hi:[1,0]
v_mfma_f32_16x16x32_bf16 v[172:175], v[244:247], v[32:35], v[172:175]
ds_read_b128 v[240:243], v249 offset:6144
ds_read_u16_d16_hi v193, v193
v_pk_add_f16 v198, v198, 1.0 op_sel_hi:[1,0]
v_pk_add_f16 v195, v195, 1.0 op_sel_hi:[1,0]
v_mfma_f32_16x16x32_bf16 v[180:183], v[244:247], v[36:39], v[180:183]
v_rcp_f16_e64 v202, v201
s_setprio 0
s_waitcnt lgkmcnt(7)
v_mfma_f32_16x16x32_bf16 v[168:171], v[216:219], v[40:43], v[168:171]
ds_read_b128 v[244:247], v250 offset:3072
v_rcp_f16_e64 v199, v198
v_mfma_f32_16x16x32_bf16 v[176:179], v[216:219], v[44:47], v[176:179]
v_rcp_f16_e64 v196, v195
v_mfma_f32_16x16x32_bf16 v[172:175], v[220:223], v[40:43], v[172:175]
ds_read_b128 v[216:219], v249 offset:6400
v_rcp_f16_sdwa v202, v201 dst_sel:WORD_1 dst_unused:UNUSED_PRESERVE src0_sel:WORD_1
v_mfma_f32_16x16x32_bf16 v[180:183], v[220:223], v[44:47], v[180:183]
v_rcp_f16_sdwa v199, v198 dst_sel:WORD_1 dst_unused:UNUSED_PRESERVE src0_sel:WORD_1
v_or_b32 v232, v184, v185
v_or_b32 v233, v186, v187
s_waitcnt lgkmcnt(4)
v_or_b32 v234, v188, v189
v_rcp_f16_sdwa v196, v195 dst_sel:WORD_1 dst_unused:UNUSED_PRESERVE src0_sel:WORD_1
v_or_b32 v235, v190, v191
s_waitcnt lgkmcnt(2)
v_or_b32 v236, v192, v193
v_pk_mul_f16 v237, v203, v202
v_pk_mul_f16 v238, v200, v199
v_pk_mul_f16 v239, v197, v196
s_setprio 3
v_mfma_f32_16x16x32_f16 v[120:123], v[224:227], v[232:235], v[120:123]
ds_read_b128 v[220:223], v250 offset:3328
v_cvt_pkrtz_f16_f32 v185, v168, v169
v_cvt_pkrtz_f16_f32 v187, v170, v171
v_cvt_pkrtz_f16_f32 v189, v172, v173
v_mfma_f32_16x16x32_f16 v[128:131], v[224:227], v[236:239], v[128:131]
v_cvt_pkrtz_f16_f32 v191, v174, v175
v_cvt_pkrtz_f16_f32 v193, v176, v177
v_cvt_pk_f16_f32 v203, v178, v179
v_mfma_f32_16x16x32_f16 v[124:127], v[228:231], v[232:235], v[124:127]
ds_read_b128 v[224:227], v249 offset:7168
v_cvt_pk_f16_f32 v200, v180, v181
v_cvt_pk_f16_f32 v197, v182, v183
v_pk_fma_f16 v202, v203, v203, s48
v_cvt_pk_bf16_f32 v72, v72, v73
v_mfma_f32_16x16x32_f16 v[132:135], v[228:231], v[236:239], v[132:135]
v_and_b32_e64 v185, s49, v185
v_cvt_pk_bf16_f32 v73, v74, v75
v_pk_fma_f16 v199, v200, v200, s48
v_mfma_f32_16x16x32_bf16 v[168:171], v[240:243], v[24:27], 0
ds_read_b128 v[228:231], v250 offset:4096
v_and_b32 v187, s49, v187
v_cvt_pk_bf16_f32 v74, v76, v77
v_pk_fma_f16 v196, v197, v197, s48
v_mfma_f32_16x16x32_bf16 v[176:179], v[240:243], v[28:31], 0
v_cvt_pk_bf16_f32 v75, v78, v79
v_bfe_u32 v184, v185, 2, 14
v_pk_mul_f16 v202, v203, v202
v_cvt_pk_bf16_f32 v56, v56, v57
s_waitcnt lgkmcnt(2)
v_mfma_f32_16x16x32_f16 v[136:139], v[244:247], v[232:235], v[136:139]
ds_read_b128 v[240:243], v250 offset:4352
ds_read_u16_d16 v184, v184
v_bfe_u32 v186, v187, 2, 14
v_cvt_pk_bf16_f32 v57, v58, v59
v_pk_mul_f16 v199, v200, v199
v_mfma_f32_16x16x32_f16 v[144:147], v[244:247], v[236:239], v[144:147]
v_lshrrev_b32_e64 v185, 18, v185
v_cvt_pk_bf16_f32 v58, v60, v61
v_pk_mul_f16 v196, v197, v196
v_mfma_f32_16x16x32_bf16 v[172:175], v[216:219], v[24:27], 0
ds_read_b128 v[244:247], v249 offset:7424
ds_read_u16_d16 v186, v186
ds_read_u16_d16_hi v185, v185
v_lshrrev_b32_e64 v187, 18, v187
v_cvt_pk_bf16_f32 v59, v62, v63
v_exp_f16_e64 v201, v202
v_mfma_f32_16x16x32_bf16 v[180:183], v[216:219], v[28:31], 0
v_cvt_pk_bf16_f32 v88, v88, v89
v_and_b32_e64 v189, s49, v189
v_cvt_pk_bf16_f32 v89, v90, v91
v_mfma_f32_16x16x32_f16 v[140:143], v[220:223], v[232:235], v[140:143]
ds_read_b128 v[216:219], v249 offset:8192
ds_read_u16_d16_hi v187, v187
v_and_b32_e64 v191, s49, v191
v_cvt_pk_bf16_f32 v90, v92, v93
v_mfma_f32_16x16x32_f16 v[148:151], v[220:223], v[236:239], v[148:151]
v_exp_f16_e64 v198, v199
v_cvt_pk_bf16_f32 v91, v94, v95
s_mov_b64 vcc, s[74:75]
v_bfe_u32 v188, v189, 2, 14
v_bfe_u32 v190, v191, 2, 14
s_waitcnt lgkmcnt(5)
v_mfma_f32_16x16x32_bf16 v[168:171], v[224:227], v[32:35], v[168:171]
ds_read_b128 v[220:223], v249 offset:8448
ds_read_u16_d16 v188, v188
ds_read_u16_d16 v190, v190
v_cndmask_b32 v76, v56, v88, vcc
v_exp_f16 v195, v196
v_mfma_f32_16x16x32_bf16 v[176:179], v[224:227], v[36:39], v[176:179]
v_cndmask_b32 v77, v57, v89, vcc
v_lshrrev_b32_e64 v189, 18, v189
v_cndmask_b32 v78, v58, v90, vcc
v_mfma_f32_16x16x32_f16 v[152:155], v[228:231], v[232:235], v[152:155]
ds_read_b128 v[224:227], v250 offset:8192
ds_read_u16_d16_hi v189, v189
v_lshrrev_b32 v191, 18, v191
v_cndmask_b32 v79, v59, v91, vcc
v_exp_f16_sdwa v201, v202 dst_sel:WORD_1 dst_unused:UNUSED_PRESERVE src0_sel:WORD_1
v_mfma_f32_16x16x32_f16 v[160:163], v[228:231], v[236:239], v[160:163]
v_cndmask_b32_dpp v56, v72, v56, vcc quad_perm:[1,0,3,2] row_mask:0xf bank_mask:0xf
v_and_b32_e64 v193, s49, v193
v_cndmask_b32_dpp v57, v73, v57, vcc quad_perm:[1,0,3,2] row_mask:0xf bank_mask:0xf
v_mfma_f32_16x16x32_f16 v[156:159], v[240:243], v[232:235], v[156:159]
ds_read_b128 v[228:231], v250 offset:8448
ds_read_u16_d16_hi v191, v191
v_bfe_u32 v192, v193, 2, 14
v_exp_f16_sdwa v198, v199 dst_sel:WORD_1 dst_unused:UNUSED_PRESERVE src0_sel:WORD_1
v_mfma_f32_16x16x32_f16 v[164:167], v[240:243], v[236:239], v[164:167]
v_cndmask_b32_dpp v58, v74, v58, vcc quad_perm:[1,0,3,2] row_mask:0xf bank_mask:0xf
v_lshrrev_b32_e64 v193, 18, v193
v_cndmask_b32_dpp v59, v75, v59, vcc quad_perm:[1,0,3,2] row_mask:0xf bank_mask:0xf
s_not_b64 vcc, s[74:75]
s_waitcnt lgkmcnt(4)
v_mfma_f32_16x16x32_bf16 v[172:175], v[244:247], v[32:35], v[172:175]
ds_read_b128 v[240:243], v249 offset:12288
ds_read_u16_d16 v192, v192
ds_read_u16_d16_hi v193, v193
v_exp_f16_sdwa v195, v196 dst_sel:WORD_1 dst_unused:UNUSED_PRESERVE src0_sel:WORD_1
v_cndmask_b32_dpp v88, v72, v88, vcc quad_perm:[1,0,3,2] row_mask:0xf bank_mask:0xf
v_pk_add_f16 v201, v201, 1.0 op_sel_hi:[1,0]
v_mfma_f32_16x16x32_bf16 v[180:183], v[244:247], v[36:39], v[180:183]
v_cndmask_b32_dpp v89, v73, v89, vcc quad_perm:[1,0,3,2] row_mask:0xf bank_mask:0xf
v_pk_add_f16 v198, v198, 1.0 op_sel_hi:[1,0]
v_cndmask_b32_dpp v90, v74, v90, vcc quad_perm:[1,0,3,2] row_mask:0xf bank_mask:0xf
v_mfma_f32_16x16x32_bf16 v[168:171], v[216:219], v[40:43], v[168:171]
ds_read_b128 v[244:247], v250 offset:9216
v_pk_add_f16 v195, v195, 1.0 op_sel_hi:[1,0]
v_rcp_f16_e64 v202, v201
v_cndmask_b32_dpp v91, v75, v91, vcc quad_perm:[1,0,3,2] row_mask:0xf bank_mask:0xf
v_mfma_f32_16x16x32_bf16 v[176:179], v[216:219], v[44:47], v[176:179]
v_rcp_f16_e64 v199, v198
v_mfma_f32_16x16x32_bf16 v[172:175], v[220:223], v[40:43], v[172:175]
ds_read_b128 v[216:219], v249 offset:12544
s_add_u32 s46, s70, 98304
buffer_store_dwordx4 v[56:59], v255, s[8:11], s46 offen sc1
v_rcp_f16_e64 v196, v195
v_rcp_f16_sdwa v202, v201 dst_sel:WORD_1 dst_unused:UNUSED_PRESERVE src0_sel:WORD_1
v_mfma_f32_16x16x32_bf16 v[180:183], v[220:223], v[44:47], v[180:183]
v_rcp_f16_sdwa v199, v198 dst_sel:WORD_1 dst_unused:UNUSED_PRESERVE src0_sel:WORD_1
v_or_b32 v232, v184, v185
v_or_b32 v233, v186, v187
s_waitcnt lgkmcnt(2)
v_or_b32 v234, v188, v189
v_rcp_f16_sdwa v196, v195 dst_sel:WORD_1 dst_unused:UNUSED_PRESERVE src0_sel:WORD_1
v_or_b32 v235, v190, v191
v_or_b32 v236, v192, v193
v_pk_mul_f16 v237, v203, v202
v_pk_mul_f16 v238, v200, v199
v_pk_mul_f16 v239, v197, v196
v_mfma_f32_16x16x32_f16 v[120:123], v[224:227], v[232:235], v[120:123]
buffer_load_dwordx4 v[12:15], v252, s[4:7], s68 offen offset:128
ds_read_b128 v[220:223], v250 offset:9472
v_cvt_pkrtz_f16_f32 v185, v168, v169
v_cvt_pkrtz_f16_f32 v187, v170, v171
v_mfma_f32_16x16x32_f16 v[128:131], v[224:227], v[236:239], v[128:131]
v_cvt_pkrtz_f16_f32 v189, v172, v173
v_cvt_pkrtz_f16_f32 v191, v174, v175
v_mfma_f32_16x16x32_f16 v[124:127], v[228:231], v[232:235], v[124:127]
ds_read_b128 v[224:227], v249 offset:13312
v_cvt_pkrtz_f16_f32 v193, v176, v177
v_cvt_pk_f16_f32 v203, v178, v179
v_cvt_pk_f16_f32 v200, v180, v181
v_mfma_f32_16x16x32_f16 v[132:135], v[228:231], v[236:239], v[132:135]
v_cvt_pk_f16_f32 v197, v182, v183
v_pk_fma_f16 v202, v203, v203, s48
v_mfma_f32_16x16x32_bf16 v[168:171], v[240:243], v[24:27], 0
ds_read_b128 v[228:231], v250 offset:10240
v_and_b32_e64 v185, s49, v185
v_pk_fma_f16 v199, v200, v200, s48
v_mfma_f32_16x16x32_bf16 v[176:179], v[240:243], v[28:31], 0
v_and_b32_e64 v187, s49, v187
v_pk_fma_f16 v196, v197, v197, s48
s_setprio 2
v_bfe_u32 v184, v185, 2, 14
s_waitcnt lgkmcnt(3)
v_mfma_f32_16x16x32_f16 v[136:139], v[244:247], v[232:235], v[136:139]
ds_read_b128 v[240:243], v250 offset:10496
ds_read_u16_d16 v184, v184
v_pk_mul_f16 v202, v203, v202
v_bfe_u32 v186, v187, 2, 14
v_mfma_f32_16x16x32_f16 v[144:147], v[244:247], v[236:239], v[144:147]
v_pk_mul_f16 v199, v200, v199
v_lshrrev_b32_e64 v185, 18, v185
v_mfma_f32_16x16x32_bf16 v[172:175], v[216:219], v[24:27], 0
ds_read_b128 v[244:247], v249 offset:13568
ds_read_u16_d16 v186, v186
ds_read_u16_d16_hi v185, v185
v_pk_mul_f16 v196, v197, v196
v_lshrrev_b32_e64 v187, 18, v187
v_mfma_f32_16x16x32_bf16 v[180:183], v[216:219], v[28:31], 0
v_exp_f16_e64 v201, v202
v_and_b32 v189, s49, v189
s_waitcnt lgkmcnt(5)
v_mfma_f32_16x16x32_f16 v[140:143], v[220:223], v[232:235], v[140:143]
ds_read_b128 v[216:219], v249 offset:14336
ds_read_u16_d16_hi v187, v187
v_and_b32_e64 v191, s49, v191
v_mfma_f32_16x16x32_f16 v[148:151], v[220:223], v[236:239], v[148:151]
v_exp_f16_e64 v198, v199
v_bfe_u32 v188, v189, 2, 14
v_bfe_u32 v190, v191, 2, 14
v_mfma_f32_16x16x32_bf16 v[168:171], v[224:227], v[32:35], v[168:171]
ds_read_b128 v[220:223], v249 offset:14592
ds_read_u16_d16 v188, v188
ds_read_u16_d16 v190, v190
v_exp_f16_e64 v195, v196
v_mfma_f32_16x16x32_bf16 v[176:179], v[224:227], v[36:39], v[176:179]
v_lshrrev_b32 v189, 18, v189
v_lshrrev_b32 v191, 18, v191
v_mfma_f32_16x16x32_f16 v[152:155], v[228:231], v[232:235], v[152:155]
ds_read_b128 v[224:227], v250 offset:14336
ds_read_u16_d16_hi v189, v189
ds_read_u16_d16_hi v191, v191
v_exp_f16_sdwa v201, v202 dst_sel:WORD_1 dst_unused:UNUSED_PRESERVE src0_sel:WORD_1
v_and_b32 v193, s49, v193
v_mfma_f32_16x16x32_f16 v[160:163], v[228:231], v[236:239], v[160:163]
v_bfe_u32 v192, v193, 2, 14
s_waitcnt lgkmcnt(8)
v_mfma_f32_16x16x32_f16 v[156:159], v[240:243], v[232:235], v[156:159]
ds_read_b128 v[228:231], v250 offset:14592
ds_read_u16_d16 v192, v192
v_exp_f16_sdwa v198, v199 dst_sel:WORD_1 dst_unused:UNUSED_PRESERVE src0_sel:WORD_1
v_lshrrev_b32_e64 v193, 18, v193
v_mfma_f32_16x16x32_f16 v[164:167], v[240:243], v[236:239], v[164:167]
v_exp_f16_sdwa v195, v196 dst_sel:WORD_1 dst_unused:UNUSED_PRESERVE src0_sel:WORD_1
v_pk_add_f16 v201, v201, 1.0 op_sel_hi:[1,0]
v_mfma_f32_16x16x32_bf16 v[172:175], v[244:247], v[32:35], v[172:175]
ds_read_b128 v[240:243], v249 offset:18432
ds_read_u16_d16_hi v193, v193
v_pk_add_f16 v198, v198, 1.0 op_sel_hi:[1,0]
v_pk_add_f16 v195, v195, 1.0 op_sel_hi:[1,0]
v_mfma_f32_16x16x32_bf16 v[180:183], v[244:247], v[36:39], v[180:183]
v_rcp_f16 v202, v201
s_waitcnt lgkmcnt(7)
v_mfma_f32_16x16x32_bf16 v[168:171], v[216:219], v[40:43], v[168:171]
ds_read_b128 v[244:247], v250 offset:15360
v_rcp_f16_e64 v199, v198
v_mfma_f32_16x16x32_bf16 v[176:179], v[216:219], v[44:47], v[176:179]
v_rcp_f16_e64 v196, v195
v_mfma_f32_16x16x32_bf16 v[172:175], v[220:223], v[40:43], v[172:175]
ds_read_b128 v[216:219], v249 offset:18688
v_rcp_f16_sdwa v202, v201 dst_sel:WORD_1 dst_unused:UNUSED_PRESERVE src0_sel:WORD_1
v_mfma_f32_16x16x32_bf16 v[180:183], v[220:223], v[44:47], v[180:183]
v_rcp_f16_sdwa v199, v198 dst_sel:WORD_1 dst_unused:UNUSED_PRESERVE src0_sel:WORD_1
v_or_b32 v232, v184, v185
v_or_b32 v233, v186, v187
s_waitcnt lgkmcnt(4)
v_or_b32 v234, v188, v189
v_rcp_f16_sdwa v196, v195 dst_sel:WORD_1 dst_unused:UNUSED_PRESERVE src0_sel:WORD_1
v_or_b32 v235, v190, v191
s_waitcnt lgkmcnt(2)
v_or_b32_e64 v236, v192, v193
v_pk_mul_f16 v237, v203, v202
v_pk_mul_f16 v238, v200, v199
v_pk_mul_f16 v239, v197, v196
v_mfma_f32_16x16x32_f16 v[120:123], v[224:227], v[232:235], v[120:123]
s_add_u32 s46, s68, 98304
buffer_load_dwordx4 v[8:11], v252, s[4:7], s46 offen
ds_read_b128 v[220:223], v250 offset:15616
v_cvt_pkrtz_f16_f32 v185, v168, v169
v_cvt_pkrtz_f16_f32 v187, v170, v171
v_mfma_f32_16x16x32_f16 v[128:131], v[224:227], v[236:239], v[128:131]
v_cvt_pkrtz_f16_f32 v189, v172, v173
v_cvt_pkrtz_f16_f32 v191, v174, v175
v_mfma_f32_16x16x32_f16 v[124:127], v[228:231], v[232:235], v[124:127]
ds_read_b128 v[224:227], v249 offset:19456
v_cvt_pkrtz_f16_f32 v193, v176, v177
v_cvt_pk_f16_f32 v203, v178, v179
v_cvt_pk_f16_f32 v200, v180, v181
v_mfma_f32_16x16x32_f16 v[132:135], v[228:231], v[236:239], v[132:135]
v_cvt_pk_f16_f32 v197, v182, v183
s_setprio 1
v_pk_fma_f16 v202, v203, v203, s48
v_mfma_f32_16x16x32_bf16 v[168:171], v[240:243], v[24:27], 0
ds_read_b128 v[228:231], v250 offset:16384
v_and_b32 v185, s49, v185
v_pk_fma_f16 v199, v200, v200, s48
v_mfma_f32_16x16x32_bf16 v[176:179], v[240:243], v[28:31], 0
v_and_b32 v187, s49, v187
v_pk_fma_f16 v196, v197, v197, s48
v_bfe_u32 v184, v185, 2, 14
s_waitcnt lgkmcnt(3)
v_mfma_f32_16x16x32_f16 v[136:139], v[244:247], v[232:235], v[136:139]
ds_read_b128 v[240:243], v250 offset:16640
ds_read_u16_d16 v184, v184
v_pk_mul_f16 v202, v203, v202
v_bfe_u32 v186, v187, 2, 14
v_mfma_f32_16x16x32_f16 v[144:147], v[244:247], v[236:239], v[144:147]
v_pk_mul_f16 v199, v200, v199
v_lshrrev_b32_e64 v185, 18, v185
v_mfma_f32_16x16x32_bf16 v[172:175], v[216:219], v[24:27], 0
ds_read_b128 v[244:247], v249 offset:19712
ds_read_u16_d16 v186, v186
ds_read_u16_d16_hi v185, v185
v_pk_mul_f16 v196, v197, v196
v_lshrrev_b32_e64 v187, 18, v187
v_mfma_f32_16x16x32_bf16 v[180:183], v[216:219], v[28:31], 0
v_exp_f16_e64 v201, v202
v_and_b32 v189, s49, v189
s_waitcnt lgkmcnt(5)
v_mfma_f32_16x16x32_f16 v[140:143], v[220:223], v[232:235], v[140:143]
ds_read_b128 v[216:219], v249 offset:20480
ds_read_u16_d16_hi v187, v187
v_and_b32_e64 v191, s49, v191
v_mfma_f32_16x16x32_f16 v[148:151], v[220:223], v[236:239], v[148:151]
v_exp_f16_e64 v198, v199
v_bfe_u32 v188, v189, 2, 14
v_bfe_u32 v190, v191, 2, 14
v_mfma_f32_16x16x32_bf16 v[168:171], v[224:227], v[32:35], v[168:171]
s_add_u32 s46, s70, 98304
buffer_store_dwordx4 v[76:79], v255, s[8:11], s46 offen offset:128 sc1
ds_read_b128 v[220:223], v249 offset:20736
ds_read_u16_d16 v188, v188
ds_read_u16_d16 v190, v190
v_exp_f16_e64 v195, v196
v_mfma_f32_16x16x32_bf16 v[176:179], v[224:227], v[36:39], v[176:179]
v_lshrrev_b32 v189, 18, v189
v_lshrrev_b32 v191, 18, v191
v_mfma_f32_16x16x32_f16 v[152:155], v[228:231], v[232:235], v[152:155]
ds_read_b128 v[224:227], v250 offset:20480
ds_read_u16_d16_hi v189, v189
ds_read_u16_d16_hi v191, v191
v_exp_f16_sdwa v201, v202 dst_sel:WORD_1 dst_unused:UNUSED_PRESERVE src0_sel:WORD_1
v_and_b32 v193, s49, v193
v_mfma_f32_16x16x32_f16 v[160:163], v[228:231], v[236:239], v[160:163]
v_bfe_u32 v192, v193, 2, 14
s_waitcnt lgkmcnt(7)
v_mfma_f32_16x16x32_f16 v[156:159], v[240:243], v[232:235], v[156:159]
ds_read_b128 v[228:231], v250 offset:20736
ds_read_u16_d16 v192, v192
v_exp_f16_sdwa v198, v199 dst_sel:WORD_1 dst_unused:UNUSED_PRESERVE src0_sel:WORD_1
v_lshrrev_b32_e64 v193, 18, v193
v_mfma_f32_16x16x32_f16 v[164:167], v[240:243], v[236:239], v[164:167]
v_exp_f16_sdwa v195, v196 dst_sel:WORD_1 dst_unused:UNUSED_PRESERVE src0_sel:WORD_1
v_pk_add_f16 v201, v201, 1.0 op_sel_hi:[1,0]
v_mfma_f32_16x16x32_bf16 v[172:175], v[244:247], v[32:35], v[172:175]
ds_read_b128 v[240:243], v248 offset:16384
ds_read_u16_d16_hi v193, v193
v_pk_add_f16 v198, v198, 1.0 op_sel_hi:[1,0]
v_pk_add_f16 v195, v195, 1.0 op_sel_hi:[1,0]
v_mfma_f32_16x16x32_bf16 v[180:183], v[244:247], v[36:39], v[180:183]
v_rcp_f16 v202, v201
s_setprio 0
v_mfma_f32_16x16x32_bf16 v[168:171], v[216:219], v[40:43], v[168:171]
ds_read_b128 v[244:247], v250 offset:21504
v_rcp_f16_e64 v199, v198
v_mfma_f32_16x16x32_bf16 v[176:179], v[216:219], v[44:47], v[176:179]
v_rcp_f16 v196, v195
s_waitcnt lgkmcnt(5)
v_mfma_f32_16x16x32_bf16 v[172:175], v[220:223], v[40:43], v[172:175]
ds_read_b128 v[216:219], v248 offset:16640
v_rcp_f16_sdwa v202, v201 dst_sel:WORD_1 dst_unused:UNUSED_PRESERVE src0_sel:WORD_1
v_mfma_f32_16x16x32_bf16 v[180:183], v[220:223], v[44:47], v[180:183]
v_rcp_f16_sdwa v199, v198 dst_sel:WORD_1 dst_unused:UNUSED_PRESERVE src0_sel:WORD_1
v_or_b32 v232, v184, v185
v_or_b32 v233, v186, v187
v_or_b32_e64 v234, v188, v189
v_rcp_f16_sdwa v196, v195 dst_sel:WORD_1 dst_unused:UNUSED_PRESERVE src0_sel:WORD_1
v_or_b32 v235, v190, v191
s_waitcnt lgkmcnt(2)
v_or_b32 v236, v192, v193
v_pk_mul_f16 v237, v203, v202
v_pk_mul_f16 v238, v200, v199
v_pk_mul_f16 v239, v197, v196
s_setprio 3
v_mfma_f32_16x16x32_f16 v[120:123], v[224:227], v[232:235], v[120:123]
ds_read_b128 v[220:223], v250 offset:21760
v_cvt_pkrtz_f16_f32 v185, v168, v169
v_cvt_pkrtz_f16_f32 v187, v170, v171
v_mfma_f32_16x16x32_f16 v[128:131], v[224:227], v[236:239], v[128:131]
v_cvt_pkrtz_f16_f32 v189, v172, v173
v_cvt_pkrtz_f16_f32 v191, v174, v175
v_mfma_f32_16x16x32_f16 v[124:127], v[228:231], v[232:235], v[124:127]
ds_read_b128 v[224:227], v248 offset:17408
v_cvt_pkrtz_f16_f32 v193, v176, v177
v_cvt_pk_f16_f32 v203, v178, v179
v_cvt_pk_f16_f32 v200, v180, v181
v_mfma_f32_16x16x32_f16 v[132:135], v[228:231], v[236:239], v[132:135]
v_cvt_pk_f16_f32 v197, v182, v183
v_pk_fma_f16 v202, v203, v203, s48
s_waitcnt vmcnt(15)
v_mfma_f32_16x16x32_bf16 v[168:171], v[240:243], v[96:99], 0
ds_read_b128 v[228:231], v250 offset:22528
v_and_b32_e64 v185, s49, v185
v_pk_fma_f16 v199, v200, v200, s48
s_waitcnt vmcnt(13)
v_mfma_f32_16x16x32_bf16 v[176:179], v[240:243], v[100:103], 0
v_and_b32 v187, s49, v187
v_pk_fma_f16 v196, v197, v197, s48
v_bfe_u32 v184, v185, 2, 14
s_waitcnt lgkmcnt(3)
v_mfma_f32_16x16x32_f16 v[136:139], v[244:247], v[232:235], v[136:139]
ds_read_b128 v[240:243], v250 offset:22784
ds_read_u16_d16 v184, v184
v_pk_mul_f16 v202, v203, v202
v_bfe_u32 v186, v187, 2, 14
v_mfma_f32_16x16x32_f16 v[144:147], v[244:247], v[236:239], v[144:147]
v_pk_mul_f16 v199, v200, v199
v_lshrrev_b32_e64 v185, 18, v185
v_mfma_f32_16x16x32_bf16 v[172:175], v[216:219], v[96:99], 0
ds_read_b128 v[244:247], v248 offset:17664
ds_read_u16_d16 v186, v186
ds_read_u16_d16_hi v185, v185
v_pk_mul_f16 v196, v197, v196
v_lshrrev_b32_e64 v187, 18, v187
v_mfma_f32_16x16x32_bf16 v[180:183], v[216:219], v[100:103], 0
v_exp_f16_e64 v201, v202
v_and_b32 v189, s49, v189
s_waitcnt lgkmcnt(5)
v_mfma_f32_16x16x32_f16 v[140:143], v[220:223], v[232:235], v[140:143]
ds_read_b128 v[216:219], v248 offset:18432
ds_read_u16_d16_hi v187, v187
v_and_b32_e64 v191, s49, v191
v_mfma_f32_16x16x32_f16 v[148:151], v[220:223], v[236:239], v[148:151]
v_exp_f16 v198, v199
v_bfe_u32 v188, v189, 2, 14
v_bfe_u32 v190, v191, 2, 14
s_waitcnt vmcnt(12)
v_mfma_f32_16x16x32_bf16 v[168:171], v[224:227], v[104:107], v[168:171]
ds_read_b128 v[220:223], v248 offset:18688
ds_read_u16_d16 v188, v188
ds_read_u16_d16 v190, v190
v_exp_f16 v195, v196
s_waitcnt vmcnt(11)
v_mfma_f32_16x16x32_bf16 v[176:179], v[224:227], v[108:111], v[176:179]
v_lshrrev_b32 v189, 18, v189
v_lshrrev_b32 v191, 18, v191
v_mfma_f32_16x16x32_f16 v[152:155], v[228:231], v[232:235], v[152:155]
ds_read_b128 v[224:227], v250 offset:26624
ds_read_u16_d16_hi v189, v189
ds_read_u16_d16_hi v191, v191
v_exp_f16_sdwa v201, v202 dst_sel:WORD_1 dst_unused:UNUSED_PRESERVE src0_sel:WORD_1
v_and_b32 v193, s49, v193
v_mfma_f32_16x16x32_f16 v[160:163], v[228:231], v[236:239], v[160:163]
v_bfe_u32 v192, v193, 2, 14
s_waitcnt lgkmcnt(7)
v_mfma_f32_16x16x32_f16 v[156:159], v[240:243], v[232:235], v[156:159]
ds_read_b128 v[228:231], v250 offset:26880
ds_read_u16_d16 v192, v192
v_exp_f16_sdwa v198, v199 dst_sel:WORD_1 dst_unused:UNUSED_PRESERVE src0_sel:WORD_1
v_lshrrev_b32_e64 v193, 18, v193
v_mfma_f32_16x16x32_f16 v[164:167], v[240:243], v[236:239], v[164:167]
v_exp_f16_sdwa v195, v196 dst_sel:WORD_1 dst_unused:UNUSED_PRESERVE src0_sel:WORD_1
v_pk_add_f16 v201, v201, 1.0 op_sel_hi:[1,0]
v_mfma_f32_16x16x32_bf16 v[172:175], v[244:247], v[104:107], v[172:175]
ds_read_b128 v[240:243], v248 offset:22528
ds_read_u16_d16_hi v193, v193
v_pk_add_f16 v198, v198, 1.0 op_sel_hi:[1,0]
v_pk_add_f16 v195, v195, 1.0 op_sel_hi:[1,0]
v_mfma_f32_16x16x32_bf16 v[180:183], v[244:247], v[108:111], v[180:183]
v_rcp_f16 v202, v201
s_waitcnt vmcnt(10)
v_mfma_f32_16x16x32_bf16 v[168:171], v[216:219], v[112:115], v[168:171]
ds_read_b128 v[244:247], v250 offset:27648
v_rcp_f16 v199, v198
s_waitcnt vmcnt(7)
v_mfma_f32_16x16x32_bf16 v[176:179], v[216:219], v[116:119], v[176:179]
v_rcp_f16 v196, v195
s_waitcnt lgkmcnt(5)
v_mfma_f32_16x16x32_bf16 v[172:175], v[220:223], v[112:115], v[172:175]
ds_read_b128 v[216:219], v248 offset:22784
v_rcp_f16_sdwa v202, v201 dst_sel:WORD_1 dst_unused:UNUSED_PRESERVE src0_sel:WORD_1
v_mfma_f32_16x16x32_bf16 v[180:183], v[220:223], v[116:119], v[180:183]
v_rcp_f16_sdwa v199, v198 dst_sel:WORD_1 dst_unused:UNUSED_PRESERVE src0_sel:WORD_1
v_or_b32 v232, v184, v185
v_or_b32 v233, v186, v187
v_or_b32_e64 v234, v188, v189
v_rcp_f16_sdwa v196, v195 dst_sel:WORD_1 dst_unused:UNUSED_PRESERVE src0_sel:WORD_1
v_or_b32 v235, v190, v191
s_waitcnt lgkmcnt(2)
v_or_b32_e64 v236, v192, v193
v_pk_mul_f16 v237, v203, v202
v_pk_mul_f16 v238, v200, v199
v_pk_mul_f16 v239, v197, v196
v_mfma_f32_16x16x32_f16 v[120:123], v[224:227], v[232:235], v[120:123]
s_add_u32 s46, s68, 98304
buffer_load_dwordx4 v[44:47], v252, s[4:7], s46 offen offset:64
ds_read_b128 v[220:223], v250 offset:27904
v_cvt_pkrtz_f16_f32 v185, v168, v169
v_cvt_pkrtz_f16_f32 v187, v170, v171
v_mfma_f32_16x16x32_f16 v[128:131], v[224:227], v[236:239], v[128:131]
v_cvt_pkrtz_f16_f32 v189, v172, v173
v_cvt_pkrtz_f16_f32 v191, v174, v175
v_mfma_f32_16x16x32_f16 v[124:127], v[228:231], v[232:235], v[124:127]
ds_read_b128 v[224:227], v248 offset:23552
v_cvt_pkrtz_f16_f32 v193, v176, v177
v_cvt_pk_f16_f32 v203, v178, v179
v_mfma_f32_16x16x32_f16 v[132:135], v[228:231], v[236:239], v[132:135]
v_cvt_pk_f16_f32 v200, v180, v181
v_cvt_pk_f16_f32 v197, v182, v183
v_mfma_f32_16x16x32_bf16 v[168:171], v[240:243], v[96:99], 0
ds_read_b128 v[228:231], v250 offset:28672
v_pk_fma_f16 v202, v203, v203, s48
v_and_b32_e64 v185, s49, v185
v_mfma_f32_16x16x32_bf16 v[176:179], v[240:243], v[100:103], 0
v_pk_fma_f16 v199, v200, v200, s48
v_and_b32 v187, s49, v187
s_waitcnt lgkmcnt(3)
v_mfma_f32_16x16x32_f16 v[136:139], v[244:247], v[232:235], v[136:139]
ds_read_b128 v[240:243], v250 offset:28928
v_pk_fma_f16 v196, v197, v197, s48
s_setprio 2
v_bfe_u32 v184, v185, 2, 14
v_pk_mul_f16 v202, v203, v202
v_mfma_f32_16x16x32_f16 v[144:147], v[244:247], v[236:239], v[144:147]
v_bfe_u32 v186, v187, 2, 14
v_pk_mul_f16 v199, v200, v199
s_waitcnt vmcnt(7)
v_mfma_f32_16x16x32_bf16 v[120:123], v[18:21], v[204:207], v[120:123]
ds_read_b128 v[244:247], v248 offset:23808
ds_read_u16_d16 v184, v184
ds_read_u16_d16 v186, v186
v_lshrrev_b32_e64 v185, 18, v185
v_pk_mul_f16 v196, v197, v196
v_mfma_f32_16x16x32_bf16 v[124:127], v[16:19], v[204:207], v[124:127]
v_lshrrev_b32_e64 v187, 18, v187
v_mfma_f32_16x16x32_bf16 v[172:175], v[216:219], v[96:99], 0
ds_read_u16_d16_hi v185, v185
ds_read_u16_d16_hi v187, v187
v_exp_f16 v201, v202
v_and_b32 v189, s49, v189
v_mfma_f32_16x16x32_bf16 v[180:183], v[216:219], v[100:103], 0
v_and_b32 v191, s49, v191
s_waitcnt lgkmcnt(6)
v_mfma_f32_16x16x32_f16 v[140:143], v[220:223], v[232:235], v[140:143]
ds_read_b128 v[216:219], v248 offset:24576
v_exp_f16_e64 v198, v199
v_bfe_u32 v188, v189, 2, 14
v_mfma_f32_16x16x32_f16 v[148:151], v[220:223], v[236:239], v[148:151]
v_bfe_u32 v190, v191, 2, 14
v_exp_f16_e64 v195, v196
v_mfma_f32_16x16x32_bf16 v[168:171], v[224:227], v[104:107], v[168:171]
s_add_u32 s46, s70, 98304
buffer_store_dwordx4 v[88:91], v255, s[8:11], s46 offen offset:256 sc1
ds_read_b128 v[220:223], v248 offset:24832
ds_read_u16_d16 v188, v188
ds_read_u16_d16 v190, v190
v_lshrrev_b32 v189, 18, v189
v_lshrrev_b32 v191, 18, v191
v_mfma_f32_16x16x32_bf16 v[176:179], v[224:227], v[108:111], v[176:179]
v_exp_f16_sdwa v201, v202 dst_sel:WORD_1 dst_unused:UNUSED_PRESERVE src0_sel:WORD_1
v_mfma_f32_16x16x32_f16 v[152:155], v[228:231], v[232:235], v[152:155]
ds_read_b128 v[224:227], v249 offset:24576
ds_read_u16_d16_hi v189, v189
ds_read_u16_d16_hi v191, v191
v_and_b32 v193, s49, v193
v_bfe_u32 v192, v193, 2, 14
v_mfma_f32_16x16x32_f16 v[160:163], v[228:231], v[236:239], v[160:163]
v_exp_f16_sdwa v198, v199 dst_sel:WORD_1 dst_unused:UNUSED_PRESERVE src0_sel:WORD_1
s_waitcnt lgkmcnt(7)
v_mfma_f32_16x16x32_f16 v[156:159], v[240:243], v[232:235], v[156:159]
ds_read_b128 v[228:231], v254 offset:7936
ds_read_u16_d16 v192, v192
v_lshrrev_b32_e64 v193, 18, v193
v_mfma_f32_16x16x32_f16 v[164:167], v[240:243], v[236:239], v[164:167]
v_exp_f16_sdwa v195, v196 dst_sel:WORD_1 dst_unused:UNUSED_PRESERVE src0_sel:WORD_1
v_pk_add_f16 v201, v201, 1.0 op_sel_hi:[1,0]
v_pk_add_f16 v198, v198, 1.0 op_sel_hi:[1,0]
v_mfma_f32_16x16x32_bf16 v[172:175], v[244:247], v[104:107], v[172:175]
ds_read_b128 v[240:243], v249 offset:24832
ds_read_u16_d16_hi v193, v193
v_pk_add_f16 v195, v195, 1.0 op_sel_hi:[1,0]
v_mfma_f32_16x16x32_bf16 v[180:183], v[244:247], v[108:111], v[180:183]
v_rcp_f16 v202, v201
s_waitcnt lgkmcnt(7)
v_mfma_f32_16x16x32_bf16 v[168:171], v[216:219], v[112:115], v[168:171]
ds_read_b128 v[244:247], v254 offset:7952
v_rcp_f16_e64 v199, v198
v_mfma_f32_16x16x32_bf16 v[176:179], v[216:219], v[116:119], v[176:179]
v_rcp_f16_e64 v196, v195
v_mfma_f32_16x16x32_bf16 v[172:175], v[220:223], v[112:115], v[172:175]
ds_read_b128 v[216:219], v248 offset:28672
v_rcp_f16_sdwa v202, v201 dst_sel:WORD_1 dst_unused:UNUSED_PRESERVE src0_sel:WORD_1
v_mfma_f32_16x16x32_bf16 v[180:183], v[220:223], v[116:119], v[180:183]
v_rcp_f16_sdwa v199, v198 dst_sel:WORD_1 dst_unused:UNUSED_PRESERVE src0_sel:WORD_1
v_or_b32 v232, v184, v185
v_or_b32 v233, v186, v187
s_waitcnt lgkmcnt(4)
v_or_b32 v234, v188, v189
v_rcp_f16_sdwa v196, v195 dst_sel:WORD_1 dst_unused:UNUSED_PRESERVE src0_sel:WORD_1
v_or_b32 v235, v190, v191
s_waitcnt lgkmcnt(2)
v_or_b32 v236, v192, v193
v_pk_mul_f16 v237, v203, v202
v_pk_mul_f16 v238, v200, v199
v_pk_mul_f16 v239, v197, v196
v_mfma_f32_16x16x32_f16 v[48:51], v[224:227], v[232:235], v[228:231]
ds_read_b128 v[220:223], v249 offset:25600
v_cvt_pkrtz_f16_f32 v185, v168, v169
v_cvt_pkrtz_f16_f32 v187, v170, v171
v_mfma_f32_16x16x32_f16 v[56:59], v[224:227], v[236:239], v[228:231]
v_cvt_pkrtz_f16_f32 v189, v172, v173
v_cvt_pkrtz_f16_f32 v191, v174, v175
s_waitcnt lgkmcnt(2)
v_mfma_f32_16x16x32_f16 v[52:55], v[240:243], v[232:235], v[244:247]
ds_read_b128 v[224:227], v254 offset:8064
ds_read_b128 v[228:231], v248 offset:28928
v_cvt_pkrtz_f16_f32 v193, v176, v177
v_cvt_pk_f16_f32 v203, v178, v179
v_mfma_f32_16x16x32_f16 v[60:63], v[240:243], v[236:239], v[244:247]
v_cvt_pk_f16_f32 v200, v180, v181
v_cvt_pk_f16_f32 v197, v182, v183
s_setprio 1
s_waitcnt lgkmcnt(3)
v_mfma_f32_16x16x32_bf16 v[168:171], v[216:219], v[96:99], 0
ds_read_b128 v[240:243], v249 offset:25856
ds_read_b128 v[244:247], v254 offset:8080
v_pk_fma_f16 v202, v203, v203, s48
v_and_b32_e64 v185, s49, v185
v_mfma_f32_16x16x32_bf16 v[176:179], v[216:219], v[100:103], 0
v_pk_fma_f16 v199, v200, v200, s48
v_and_b32 v187, s49, v187
s_waitcnt lgkmcnt(3)
v_mfma_f32_16x16x32_f16 v[64:67], v[220:223], v[232:235], v[224:227]
ds_read_b128 v[216:219], v248 offset:29696
v_pk_fma_f16 v196, v197, v197, s48
v_bfe_u32 v184, v185, 2, 14
v_pk_mul_f16 v202, v203, v202
v_mfma_f32_16x16x32_f16 v[72:75], v[220:223], v[236:239], v[224:227]
v_bfe_u32 v186, v187, 2, 14
v_pk_mul_f16 v199, v200, v199
s_waitcnt vmcnt(6)
v_mfma_f32_16x16x32_bf16 v[136:139], v[18:21], v[208:211], v[136:139]
ds_read_b128 v[220:223], v249 offset:26624
ds_read_b128 v[224:227], v254 offset:16128
ds_read_u16_d16 v184, v184
ds_read_u16_d16 v186, v186
v_lshrrev_b32 v185, 18, v185
v_pk_mul_f16 v196, v197, v196
v_mfma_f32_16x16x32_bf16 v[140:143], v[16:19], v[208:211], v[140:143]
v_lshrrev_b32 v187, 18, v187
s_waitcnt lgkmcnt(5)
v_mfma_f32_16x16x32_bf16 v[172:175], v[228:231], v[96:99], 0
ds_read_u16_d16_hi v185, v185
ds_read_u16_d16_hi v187, v187
v_exp_f16 v201, v202
v_and_b32 v189, s49, v189
v_mfma_f32_16x16x32_bf16 v[180:183], v[228:231], v[100:103], 0
v_and_b32_e64 v191, s49, v191
v_mfma_f32_16x16x32_f16 v[68:71], v[240:243], v[232:235], v[244:247]
ds_read_b128 v[228:231], v249 offset:26880
v_exp_f16_e64 v198, v199
v_bfe_u32 v188, v189, 2, 14
v_mfma_f32_16x16x32_f16 v[76:79], v[240:243], v[236:239], v[244:247]
v_bfe_u32 v190, v191, 2, 14
v_exp_f16 v195, v196
s_waitcnt lgkmcnt(7)
v_mfma_f32_16x16x32_bf16 v[168:171], v[216:219], v[104:107], v[168:171]
ds_read_b128 v[240:243], v254 offset:16144
ds_read_b128 v[244:247], v248 offset:29952
ds_read_u16_d16 v188, v188
ds_read_u16_d16 v190, v190
v_lshrrev_b32_e64 v189, 18, v189
v_lshrrev_b32 v191, 18, v191
v_mfma_f32_16x16x32_bf16 v[176:179], v[216:219], v[108:111], v[176:179]
v_exp_f16_sdwa v201, v202 dst_sel:WORD_1 dst_unused:UNUSED_PRESERVE src0_sel:WORD_1
s_waitcnt lgkmcnt(7)
v_mfma_f32_16x16x32_f16 v[80:83], v[220:223], v[232:235], v[224:227]
ds_read_b128 v[216:219], v248 offset:30720
ds_read_u16_d16_hi v189, v189
ds_read_u16_d16_hi v191, v191
v_and_b32 v193, s49, v193
v_bfe_u32 v192, v193, 2, 14
v_mfma_f32_16x16x32_f16 v[88:91], v[220:223], v[236:239], v[224:227]
v_exp_f16_sdwa v198, v199 dst_sel:WORD_1 dst_unused:UNUSED_PRESERVE src0_sel:WORD_1
s_waitcnt lgkmcnt(6)
v_mfma_f32_16x16x32_f16 v[84:87], v[228:231], v[232:235], v[240:243]
ds_read_b128 v[220:223], v248 offset:30976
ds_read_b128 v[224:227], v249 offset:30720
ds_read_u16_d16 v192, v192
v_lshrrev_b32 v193, 18, v193
v_mfma_f32_16x16x32_f16 v[92:95], v[228:231], v[236:239], v[240:243]
v_exp_f16_sdwa v195, v196 dst_sel:WORD_1 dst_unused:UNUSED_PRESERVE src0_sel:WORD_1
v_pk_add_f16 v201, v201, 1.0 op_sel_hi:[1,0]
v_pk_add_f16 v198, v198, 1.0 op_sel_hi:[1,0]
s_waitcnt lgkmcnt(7)
v_mfma_f32_16x16x32_bf16 v[172:175], v[244:247], v[104:107], v[172:175]
ds_read_b128 v[228:231], v249 offset:30976
ds_read_b128 v[240:243], v248 offset:34816
ds_read_u16_d16_hi v193, v193
v_pk_add_f16 v195, v195, 1.0 op_sel_hi:[1,0]
v_mfma_f32_16x16x32_bf16 v[180:183], v[244:247], v[108:111], v[180:183]
v_rcp_f16_e64 v202, v201
s_setprio 0
s_waitcnt lgkmcnt(7)
v_mfma_f32_16x16x32_bf16 v[168:171], v[216:219], v[112:115], v[168:171]
ds_read_b128 v[244:247], v249 offset:31744
v_rcp_f16_e64 v199, v198
v_mfma_f32_16x16x32_bf16 v[176:179], v[216:219], v[116:119], v[176:179]
v_rcp_f16 v196, v195
s_waitcnt lgkmcnt(6)
v_mfma_f32_16x16x32_bf16 v[172:175], v[220:223], v[112:115], v[172:175]
ds_read_b128 v[216:219], v248 offset:35072
v_rcp_f16_sdwa v202, v201 dst_sel:WORD_1 dst_unused:UNUSED_PRESERVE src0_sel:WORD_1
v_mfma_f32_16x16x32_bf16 v[180:183], v[220:223], v[116:119], v[180:183]
v_rcp_f16_sdwa v199, v198 dst_sel:WORD_1 dst_unused:UNUSED_PRESERVE src0_sel:WORD_1
v_or_b32 v232, v184, v185
v_or_b32 v233, v186, v187
v_or_b32_e64 v234, v188, v189
v_rcp_f16_sdwa v196, v195 dst_sel:WORD_1 dst_unused:UNUSED_PRESERVE src0_sel:WORD_1
v_or_b32 v235, v190, v191
s_waitcnt lgkmcnt(2)
v_or_b32 v236, v192, v193
v_pk_mul_f16 v237, v203, v202
v_pk_mul_f16 v238, v200, v199
v_pk_mul_f16 v239, v197, v196
s_setprio 3
v_mfma_f32_16x16x32_f16 v[48:51], v[224:227], v[232:235], v[48:51]
s_add_u32 s46, s68, 98304
buffer_load_dwordx4 v[208:211], v252, s[4:7], s46 offen offset:128
ds_read_b128 v[220:223], v249 offset:32000
v_cvt_pkrtz_f16_f32 v185, v168, v169
v_cvt_pkrtz_f16_f32 v187, v170, v171
v_mfma_f32_16x16x32_f16 v[56:59], v[224:227], v[236:239], v[56:59]
v_cvt_pkrtz_f16_f32 v189, v172, v173
v_cvt_pkrtz_f16_f32 v191, v174, v175
v_mfma_f32_16x16x32_f16 v[52:55], v[228:231], v[232:235], v[52:55]
ds_read_b128 v[224:227], v248 offset:35840
v_cvt_pkrtz_f16_f32 v193, v176, v177
v_cvt_pk_f16_f32 v203, v178, v179
v_mfma_f32_16x16x32_f16 v[60:63], v[228:231], v[236:239], v[60:63]
v_cvt_pk_f16_f32 v200, v180, v181
v_cvt_pk_f16_f32 v197, v182, v183
v_mfma_f32_16x16x32_bf16 v[168:171], v[240:243], v[96:99], 0
ds_read_b128 v[228:231], v249 offset:32768
v_pk_fma_f16 v202, v203, v203, s48
v_and_b32_e64 v185, s49, v185
v_mfma_f32_16x16x32_bf16 v[176:179], v[240:243], v[100:103], 0
v_pk_fma_f16 v199, v200, v200, s48
v_and_b32 v187, s49, v187
s_waitcnt lgkmcnt(3)
v_mfma_f32_16x16x32_f16 v[64:67], v[244:247], v[232:235], v[64:67]
ds_read_b128 v[240:243], v249 offset:33024
v_pk_fma_f16 v196, v197, v197, s48
v_bfe_u32 v184, v185, 2, 14
v_pk_mul_f16 v202, v203, v202
v_mfma_f32_16x16x32_f16 v[72:75], v[244:247], v[236:239], v[72:75]
v_bfe_u32 v186, v187, 2, 14
v_pk_mul_f16 v199, v200, v199
s_waitcnt vmcnt(5)
v_mfma_f32_16x16x32_bf16 v[152:155], v[18:21], v[12:15], v[152:155]
ds_read_b128 v[244:247], v248 offset:36096
ds_read_u16_d16 v184, v184
ds_read_u16_d16 v186, v186
v_lshrrev_b32 v185, 18, v185
v_pk_mul_f16 v196, v197, v196
v_mfma_f32_16x16x32_bf16 v[156:159], v[16:19], v[12:15], v[156:159]
v_lshrrev_b32_e64 v187, 18, v187
v_mfma_f32_16x16x32_bf16 v[172:175], v[216:219], v[96:99], 0
ds_read_u16_d16_hi v185, v185
ds_read_u16_d16_hi v187, v187
v_exp_f16 v201, v202
v_and_b32 v189, s49, v189
v_mfma_f32_16x16x32_bf16 v[180:183], v[216:219], v[100:103], 0
v_and_b32 v191, s49, v191
s_waitcnt lgkmcnt(6)
v_mfma_f32_16x16x32_f16 v[68:71], v[220:223], v[232:235], v[68:71]
ds_read_b128 v[216:219], v248 offset:36864
v_exp_f16_e64 v198, v199
v_bfe_u32 v188, v189, 2, 14
v_mfma_f32_16x16x32_f16 v[76:79], v[220:223], v[236:239], v[76:79]
v_bfe_u32 v190, v191, 2, 14
v_exp_f16_e64 v195, v196
v_mfma_f32_16x16x32_bf16 v[168:171], v[224:227], v[104:107], v[168:171]
ds_read_b128 v[220:223], v248 offset:37120
ds_read_u16_d16 v188, v188
ds_read_u16_d16 v190, v190
v_lshrrev_b32 v189, 18, v189
v_lshrrev_b32 v191, 18, v191
v_mfma_f32_16x16x32_bf16 v[176:179], v[224:227], v[108:111], v[176:179]
v_exp_f16_sdwa v201, v202 dst_sel:WORD_1 dst_unused:UNUSED_PRESERVE src0_sel:WORD_1
v_mfma_f32_16x16x32_f16 v[80:83], v[228:231], v[232:235], v[80:83]
ds_read_b128 v[224:227], v249 offset:36864
ds_read_u16_d16_hi v189, v189
ds_read_u16_d16_hi v191, v191
v_and_b32 v193, s49, v193
v_bfe_u32 v192, v193, 2, 14
v_mfma_f32_16x16x32_f16 v[88:91], v[228:231], v[236:239], v[88:91]
v_exp_f16_sdwa v198, v199 dst_sel:WORD_1 dst_unused:UNUSED_PRESERVE src0_sel:WORD_1
s_waitcnt lgkmcnt(7)
v_mfma_f32_16x16x32_f16 v[84:87], v[240:243], v[232:235], v[84:87]
ds_read_b128 v[228:231], v249 offset:37120
ds_read_u16_d16 v192, v192
v_lshrrev_b32_e64 v193, 18, v193
v_mfma_f32_16x16x32_f16 v[92:95], v[240:243], v[236:239], v[92:95]
v_exp_f16_sdwa v195, v196 dst_sel:WORD_1 dst_unused:UNUSED_PRESERVE src0_sel:WORD_1
v_pk_add_f16 v201, v201, 1.0 op_sel_hi:[1,0]
v_pk_add_f16 v198, v198, 1.0 op_sel_hi:[1,0]
v_mfma_f32_16x16x32_bf16 v[172:175], v[244:247], v[104:107], v[172:175]
ds_read_b128 v[240:243], v248 offset:40960
ds_read_u16_d16_hi v193, v193
v_pk_add_f16 v195, v195, 1.0 op_sel_hi:[1,0]
v_mfma_f32_16x16x32_bf16 v[180:183], v[244:247], v[108:111], v[180:183]
v_rcp_f16 v202, v201
s_waitcnt lgkmcnt(7)
v_mfma_f32_16x16x32_bf16 v[168:171], v[216:219], v[112:115], v[168:171]
ds_read_b128 v[244:247], v249 offset:37888
v_rcp_f16_e64 v199, v198
v_mfma_f32_16x16x32_bf16 v[176:179], v[216:219], v[116:119], v[176:179]
v_rcp_f16_e64 v196, v195
v_mfma_f32_16x16x32_bf16 v[172:175], v[220:223], v[112:115], v[172:175]
ds_read_b128 v[216:219], v248 offset:41216
v_rcp_f16_sdwa v202, v201 dst_sel:WORD_1 dst_unused:UNUSED_PRESERVE src0_sel:WORD_1
v_mfma_f32_16x16x32_bf16 v[180:183], v[220:223], v[116:119], v[180:183]
v_rcp_f16_sdwa v199, v198 dst_sel:WORD_1 dst_unused:UNUSED_PRESERVE src0_sel:WORD_1
v_or_b32 v232, v184, v185
v_or_b32 v233, v186, v187
s_waitcnt lgkmcnt(4)
v_or_b32 v234, v188, v189
v_rcp_f16_sdwa v196, v195 dst_sel:WORD_1 dst_unused:UNUSED_PRESERVE src0_sel:WORD_1
v_or_b32 v235, v190, v191
s_waitcnt lgkmcnt(2)
v_or_b32_e64 v236, v192, v193
v_pk_mul_f16 v237, v203, v202
v_pk_mul_f16 v238, v200, v199
v_pk_mul_f16 v239, v197, v196
v_mfma_f32_16x16x32_f16 v[48:51], v[224:227], v[232:235], v[48:51]
buffer_load_dwordx4 v[12:15], v252, s[4:7], s69 offen
ds_read_b128 v[220:223], v249 offset:38144
v_cvt_pkrtz_f16_f32 v185, v168, v169
v_cvt_pkrtz_f16_f32 v187, v170, v171
v_cvt_pkrtz_f16_f32 v189, v172, v173
v_mfma_f32_16x16x32_f16 v[56:59], v[224:227], v[236:239], v[56:59]
v_cvt_pkrtz_f16_f32 v191, v174, v175
v_cvt_pkrtz_f16_f32 v193, v176, v177
v_cvt_pk_f16_f32 v203, v178, v179
v_mfma_f32_16x16x32_f16 v[52:55], v[228:231], v[232:235], v[52:55]
ds_read_b128 v[224:227], v248 offset:41984
v_cvt_pk_f16_f32 v200, v180, v181
v_cvt_pk_f16_f32 v197, v182, v183
v_pk_fma_f16 v202, v203, v203, s48
v_cvt_pk_bf16_f32 v136, v136, v137
v_mfma_f32_16x16x32_f16 v[60:63], v[228:231], v[236:239], v[60:63]
v_and_b32_e64 v185, s49, v185
v_cvt_pk_bf16_f32 v137, v138, v139
v_pk_fma_f16 v199, v200, v200, s48
v_mfma_f32_16x16x32_bf16 v[168:171], v[240:243], v[96:99], 0
ds_read_b128 v[228:231], v249 offset:38912
v_and_b32_e64 v187, s49, v187
v_cvt_pk_bf16_f32 v138, v140, v141
v_pk_fma_f16 v196, v197, v197, s48
v_mfma_f32_16x16x32_bf16 v[176:179], v[240:243], v[100:103], 0
v_cvt_pk_bf16_f32 v139, v142, v143
v_bfe_u32 v184, v185, 2, 14
s_setprio 2
v_pk_mul_f16 v202, v203, v202
v_cvt_pk_bf16_f32 v120, v120, v121
s_waitcnt lgkmcnt(2)
v_mfma_f32_16x16x32_f16 v[64:67], v[244:247], v[232:235], v[64:67]
ds_read_b128 v[240:243], v249 offset:39168
ds_read_u16_d16 v184, v184
v_bfe_u32 v186, v187, 2, 14
v_cvt_pk_bf16_f32 v121, v122, v123
v_pk_mul_f16 v199, v200, v199
v_mfma_f32_16x16x32_f16 v[72:75], v[244:247], v[236:239], v[72:75]
v_lshrrev_b32_e64 v185, 18, v185
v_cvt_pk_bf16_f32 v122, v124, v125
v_pk_mul_f16 v196, v197, v196
v_mfma_f32_16x16x32_bf16 v[172:175], v[216:219], v[96:99], 0
ds_read_b128 v[244:247], v248 offset:42240
ds_read_u16_d16 v186, v186
ds_read_u16_d16_hi v185, v185
v_lshrrev_b32_e64 v187, 18, v187
v_cvt_pk_bf16_f32 v123, v126, v127
v_exp_f16_e64 v201, v202
v_mfma_f32_16x16x32_bf16 v[180:183], v[216:219], v[100:103], 0
v_cvt_pk_bf16_f32 v152, v152, v153
v_and_b32_e64 v189, s49, v189
v_cvt_pk_bf16_f32 v153, v154, v155
v_mfma_f32_16x16x32_f16 v[68:71], v[220:223], v[232:235], v[68:71]
ds_read_b128 v[216:219], v248 offset:43008
ds_read_u16_d16_hi v187, v187
v_and_b32_e64 v191, s49, v191
v_cvt_pk_bf16_f32 v154, v156, v157
v_mfma_f32_16x16x32_f16 v[76:79], v[220:223], v[236:239], v[76:79]
v_exp_f16_e64 v198, v199
v_cvt_pk_bf16_f32 v155, v158, v159
s_mov_b64 vcc, s[74:75]
v_bfe_u32 v188, v189, 2, 14
v_bfe_u32 v190, v191, 2, 14
s_waitcnt lgkmcnt(5)
v_mfma_f32_16x16x32_bf16 v[168:171], v[224:227], v[104:107], v[168:171]
ds_read_b128 v[220:223], v248 offset:43264
ds_read_u16_d16 v188, v188
ds_read_u16_d16 v190, v190
v_cndmask_b32 v140, v120, v152, vcc
v_exp_f16 v195, v196
v_mfma_f32_16x16x32_bf16 v[176:179], v[224:227], v[108:111], v[176:179]
v_cndmask_b32 v141, v121, v153, vcc
v_lshrrev_b32_e64 v189, 18, v189
v_cndmask_b32 v142, v122, v154, vcc
v_mfma_f32_16x16x32_f16 v[80:83], v[228:231], v[232:235], v[80:83]
ds_read_b128 v[224:227], v249 offset:43008
ds_read_u16_d16_hi v189, v189
v_lshrrev_b32 v191, 18, v191
v_cndmask_b32 v143, v123, v155, vcc
v_exp_f16_sdwa v201, v202 dst_sel:WORD_1 dst_unused:UNUSED_PRESERVE src0_sel:WORD_1
v_mfma_f32_16x16x32_f16 v[88:91], v[228:231], v[236:239], v[88:91]
v_cndmask_b32_dpp v120, v136, v120, vcc quad_perm:[1,0,3,2] row_mask:0xf bank_mask:0xf
v_and_b32_e64 v193, s49, v193
v_cndmask_b32_dpp v121, v137, v121, vcc quad_perm:[1,0,3,2] row_mask:0xf bank_mask:0xf
v_mfma_f32_16x16x32_f16 v[84:87], v[240:243], v[232:235], v[84:87]
ds_read_b128 v[228:231], v249 offset:43264
ds_read_u16_d16_hi v191, v191
v_bfe_u32 v192, v193, 2, 14
v_exp_f16_sdwa v198, v199 dst_sel:WORD_1 dst_unused:UNUSED_PRESERVE src0_sel:WORD_1
v_mfma_f32_16x16x32_f16 v[92:95], v[240:243], v[236:239], v[92:95]
v_cndmask_b32_dpp v122, v138, v122, vcc quad_perm:[1,0,3,2] row_mask:0xf bank_mask:0xf
v_lshrrev_b32_e64 v193, 18, v193
v_cndmask_b32_dpp v123, v139, v123, vcc quad_perm:[1,0,3,2] row_mask:0xf bank_mask:0xf
s_not_b64 vcc, s[74:75]
s_waitcnt lgkmcnt(4)
v_mfma_f32_16x16x32_bf16 v[172:175], v[244:247], v[104:107], v[172:175]
ds_read_b128 v[240:243], v248 offset:47104
ds_read_u16_d16 v192, v192
ds_read_u16_d16_hi v193, v193
v_exp_f16_sdwa v195, v196 dst_sel:WORD_1 dst_unused:UNUSED_PRESERVE src0_sel:WORD_1
v_cndmask_b32_dpp v152, v136, v152, vcc quad_perm:[1,0,3,2] row_mask:0xf bank_mask:0xf
v_pk_add_f16 v201, v201, 1.0 op_sel_hi:[1,0]
v_mfma_f32_16x16x32_bf16 v[180:183], v[244:247], v[108:111], v[180:183]
v_cndmask_b32_dpp v153, v137, v153, vcc quad_perm:[1,0,3,2] row_mask:0xf bank_mask:0xf
v_pk_add_f16 v198, v198, 1.0 op_sel_hi:[1,0]
v_cndmask_b32_dpp v154, v138, v154, vcc quad_perm:[1,0,3,2] row_mask:0xf bank_mask:0xf
v_mfma_f32_16x16x32_bf16 v[168:171], v[216:219], v[112:115], v[168:171]
ds_read_b128 v[244:247], v249 offset:44032
v_pk_add_f16 v195, v195, 1.0 op_sel_hi:[1,0]
v_rcp_f16_e64 v202, v201
v_cndmask_b32_dpp v155, v139, v155, vcc quad_perm:[1,0,3,2] row_mask:0xf bank_mask:0xf
v_mfma_f32_16x16x32_bf16 v[176:179], v[216:219], v[116:119], v[176:179]
v_rcp_f16_e64 v199, v198
v_mfma_f32_16x16x32_bf16 v[172:175], v[220:223], v[112:115], v[172:175]
ds_read_b128 v[216:219], v248 offset:47360
buffer_store_dwordx4 v[120:123], v255, s[8:11], s68 offen sc1
v_rcp_f16_e64 v196, v195
v_rcp_f16_sdwa v202, v201 dst_sel:WORD_1 dst_unused:UNUSED_PRESERVE src0_sel:WORD_1
v_mfma_f32_16x16x32_bf16 v[180:183], v[220:223], v[116:119], v[180:183]
v_rcp_f16_sdwa v199, v198 dst_sel:WORD_1 dst_unused:UNUSED_PRESERVE src0_sel:WORD_1
v_or_b32 v232, v184, v185
v_or_b32 v233, v186, v187
s_waitcnt lgkmcnt(3)
v_or_b32 v234, v188, v189
v_rcp_f16_sdwa v196, v195 dst_sel:WORD_1 dst_unused:UNUSED_PRESERVE src0_sel:WORD_1
v_or_b32 v235, v190, v191
s_waitcnt lgkmcnt(2)
v_or_b32_e64 v236, v192, v193
v_pk_mul_f16 v237, v203, v202
v_pk_mul_f16 v238, v200, v199
v_pk_mul_f16 v239, v197, v196
v_mfma_f32_16x16x32_f16 v[48:51], v[224:227], v[232:235], v[48:51]
buffer_load_dwordx4 v[204:207], v252, s[4:7], s69 offen offset:64
ds_read_b128 v[220:223], v249 offset:44288
v_cvt_pkrtz_f16_f32 v185, v168, v169
v_cvt_pkrtz_f16_f32 v187, v170, v171
v_mfma_f32_16x16x32_f16 v[56:59], v[224:227], v[236:239], v[56:59]
v_cvt_pkrtz_f16_f32 v189, v172, v173
v_cvt_pkrtz_f16_f32 v191, v174, v175
v_mfma_f32_16x16x32_f16 v[52:55], v[228:231], v[232:235], v[52:55]
ds_read_b128 v[224:227], v248 offset:48128
v_cvt_pkrtz_f16_f32 v193, v176, v177
v_cvt_pk_f16_f32 v203, v178, v179
v_mfma_f32_16x16x32_f16 v[60:63], v[228:231], v[236:239], v[60:63]
v_cvt_pk_f16_f32 v200, v180, v181
v_cvt_pk_f16_f32 v197, v182, v183
s_setprio 1
v_mfma_f32_16x16x32_bf16 v[168:171], v[240:243], v[96:99], 0
ds_read_b128 v[228:231], v249 offset:45056
v_pk_fma_f16 v202, v203, v203, s48
v_and_b32 v185, s49, v185
v_mfma_f32_16x16x32_bf16 v[176:179], v[240:243], v[100:103], 0
v_pk_fma_f16 v199, v200, v200, s48
v_and_b32 v187, s49, v187
s_waitcnt lgkmcnt(3)
v_mfma_f32_16x16x32_f16 v[64:67], v[244:247], v[232:235], v[64:67]
ds_read_b128 v[240:243], v249 offset:45312
v_pk_fma_f16 v196, v197, v197, s48
v_bfe_u32 v184, v185, 2, 14
v_pk_mul_f16 v202, v203, v202
v_mfma_f32_16x16x32_f16 v[72:75], v[244:247], v[236:239], v[72:75]
v_bfe_u32 v186, v187, 2, 14
v_pk_mul_f16 v199, v200, v199
s_waitcnt vmcnt(7)
v_mfma_f32_16x16x32_bf16 v[128:131], v[18:21], v[8:11], v[128:131]
ds_read_b128 v[244:247], v248 offset:48384
ds_read_u16_d16 v184, v184
ds_read_u16_d16 v186, v186
v_lshrrev_b32 v185, 18, v185
v_pk_mul_f16 v196, v197, v196
v_mfma_f32_16x16x32_bf16 v[132:135], v[16:19], v[8:11], v[132:135]
v_lshrrev_b32_e64 v187, 18, v187
v_mfma_f32_16x16x32_bf16 v[172:175], v[216:219], v[96:99], 0
ds_read_u16_d16_hi v185, v185
ds_read_u16_d16_hi v187, v187
v_exp_f16 v201, v202
v_and_b32 v189, s49, v189
v_mfma_f32_16x16x32_bf16 v[180:183], v[216:219], v[100:103], 0
v_and_b32 v191, s49, v191
s_waitcnt lgkmcnt(6)
v_mfma_f32_16x16x32_f16 v[68:71], v[220:223], v[232:235], v[68:71]
ds_read_b128 v[216:219], v248 offset:49152
v_exp_f16_e64 v198, v199
v_bfe_u32 v188, v189, 2, 14
v_mfma_f32_16x16x32_f16 v[76:79], v[220:223], v[236:239], v[76:79]
v_bfe_u32 v190, v191, 2, 14
v_exp_f16_e64 v195, v196
v_mfma_f32_16x16x32_bf16 v[168:171], v[224:227], v[104:107], v[168:171]
buffer_store_dwordx4 v[140:143], v255, s[8:11], s68 offen offset:128 sc1
ds_read_b128 v[220:223], v248 offset:49408
ds_read_u16_d16 v188, v188
ds_read_u16_d16 v190, v190
v_lshrrev_b32 v189, 18, v189
v_lshrrev_b32 v191, 18, v191
v_mfma_f32_16x16x32_bf16 v[176:179], v[224:227], v[108:111], v[176:179]
v_exp_f16_sdwa v201, v202 dst_sel:WORD_1 dst_unused:UNUSED_PRESERVE src0_sel:WORD_1
v_mfma_f32_16x16x32_f16 v[80:83], v[228:231], v[232:235], v[80:83]
ds_read_b128 v[224:227], v249 offset:49152
ds_read_u16_d16_hi v189, v189
ds_read_u16_d16_hi v191, v191
v_and_b32 v193, s49, v193
v_bfe_u32 v192, v193, 2, 14
v_mfma_f32_16x16x32_f16 v[88:91], v[228:231], v[236:239], v[88:91]
v_exp_f16_sdwa v198, v199 dst_sel:WORD_1 dst_unused:UNUSED_PRESERVE src0_sel:WORD_1
s_waitcnt lgkmcnt(7)
v_mfma_f32_16x16x32_f16 v[84:87], v[240:243], v[232:235], v[84:87]
ds_read_b128 v[228:231], v249 offset:49408
ds_read_u16_d16 v192, v192
v_lshrrev_b32_e64 v193, 18, v193
v_mfma_f32_16x16x32_f16 v[92:95], v[240:243], v[236:239], v[92:95]
v_exp_f16_sdwa v195, v196 dst_sel:WORD_1 dst_unused:UNUSED_PRESERVE src0_sel:WORD_1
v_pk_add_f16 v201, v201, 1.0 op_sel_hi:[1,0]
v_pk_add_f16 v198, v198, 1.0 op_sel_hi:[1,0]
v_mfma_f32_16x16x32_bf16 v[172:175], v[244:247], v[104:107], v[172:175]
ds_read_b128 v[240:243], v248 offset:53248
ds_read_u16_d16_hi v193, v193
v_pk_add_f16 v195, v195, 1.0 op_sel_hi:[1,0]
v_mfma_f32_16x16x32_bf16 v[180:183], v[244:247], v[108:111], v[180:183]
v_rcp_f16_e64 v202, v201
s_setprio 0
s_waitcnt lgkmcnt(7)
v_mfma_f32_16x16x32_bf16 v[168:171], v[216:219], v[112:115], v[168:171]
ds_read_b128 v[244:247], v249 offset:50176
v_rcp_f16_e64 v199, v198
v_mfma_f32_16x16x32_bf16 v[176:179], v[216:219], v[116:119], v[176:179]
v_rcp_f16_e64 v196, v195
v_mfma_f32_16x16x32_bf16 v[172:175], v[220:223], v[112:115], v[172:175]
ds_read_b128 v[216:219], v248 offset:53504
v_rcp_f16_sdwa v202, v201 dst_sel:WORD_1 dst_unused:UNUSED_PRESERVE src0_sel:WORD_1
v_mfma_f32_16x16x32_bf16 v[180:183], v[220:223], v[116:119], v[180:183]
v_rcp_f16_sdwa v199, v198 dst_sel:WORD_1 dst_unused:UNUSED_PRESERVE src0_sel:WORD_1
v_or_b32 v232, v184, v185
v_or_b32 v233, v186, v187
s_waitcnt lgkmcnt(4)
v_or_b32 v234, v188, v189
v_rcp_f16_sdwa v196, v195 dst_sel:WORD_1 dst_unused:UNUSED_PRESERVE src0_sel:WORD_1
v_or_b32 v235, v190, v191
s_waitcnt lgkmcnt(2)
v_or_b32 v236, v192, v193
v_pk_mul_f16 v237, v203, v202
v_pk_mul_f16 v238, v200, v199
v_pk_mul_f16 v239, v197, v196
s_setprio 3
v_mfma_f32_16x16x32_f16 v[48:51], v[224:227], v[232:235], v[48:51]
buffer_load_dwordx4 v[8:11], v252, s[4:7], s69 offen offset:128
ds_read_b128 v[220:223], v249 offset:50432
v_cvt_pkrtz_f16_f32 v185, v168, v169
v_cvt_pkrtz_f16_f32 v187, v170, v171
v_mfma_f32_16x16x32_f16 v[56:59], v[224:227], v[236:239], v[56:59]
v_cvt_pkrtz_f16_f32 v189, v172, v173
v_cvt_pkrtz_f16_f32 v191, v174, v175
v_mfma_f32_16x16x32_f16 v[52:55], v[228:231], v[232:235], v[52:55]
ds_read_b128 v[224:227], v248 offset:54272
v_cvt_pkrtz_f16_f32 v193, v176, v177
v_cvt_pk_f16_f32 v203, v178, v179
v_mfma_f32_16x16x32_f16 v[60:63], v[228:231], v[236:239], v[60:63]
v_cvt_pk_f16_f32 v200, v180, v181
v_cvt_pk_f16_f32 v197, v182, v183
v_mfma_f32_16x16x32_bf16 v[168:171], v[240:243], v[96:99], 0
ds_read_b128 v[228:231], v249 offset:51200
v_pk_fma_f16 v202, v203, v203, s48
v_and_b32_e64 v185, s49, v185
v_mfma_f32_16x16x32_bf16 v[176:179], v[240:243], v[100:103], 0
v_pk_fma_f16 v199, v200, v200, s48
v_and_b32 v187, s49, v187
s_waitcnt lgkmcnt(3)
v_mfma_f32_16x16x32_f16 v[64:67], v[244:247], v[232:235], v[64:67]
ds_read_b128 v[240:243], v249 offset:51456
v_pk_fma_f16 v196, v197, v197, s48
v_bfe_u32 v184, v185, 2, 14
v_pk_mul_f16 v202, v203, v202
v_mfma_f32_16x16x32_f16 v[72:75], v[244:247], v[236:239], v[72:75]
v_bfe_u32 v186, v187, 2, 14
v_pk_mul_f16 v199, v200, v199
s_waitcnt vmcnt(7)
v_mfma_f32_16x16x32_bf16 v[144:147], v[18:21], v[44:47], v[144:147]
ds_read_b128 v[244:247], v248 offset:54528
ds_read_u16_d16 v184, v184
ds_read_u16_d16 v186, v186
v_lshrrev_b32 v185, 18, v185
v_pk_mul_f16 v196, v197, v196
v_mfma_f32_16x16x32_bf16 v[148:151], v[16:19], v[44:47], v[148:151]
v_lshrrev_b32_e64 v187, 18, v187
v_mfma_f32_16x16x32_bf16 v[172:175], v[216:219], v[96:99], 0
ds_read_u16_d16_hi v185, v185
ds_read_u16_d16_hi v187, v187
v_exp_f16 v201, v202
v_and_b32 v189, s49, v189
v_mfma_f32_16x16x32_bf16 v[180:183], v[216:219], v[100:103], 0
v_and_b32 v191, s49, v191
s_waitcnt lgkmcnt(6)
v_mfma_f32_16x16x32_f16 v[68:71], v[220:223], v[232:235], v[68:71]
ds_read_b128 v[216:219], v248 offset:55296
v_exp_f16_e64 v198, v199
v_bfe_u32 v188, v189, 2, 14
v_mfma_f32_16x16x32_f16 v[76:79], v[220:223], v[236:239], v[76:79]
v_bfe_u32 v190, v191, 2, 14
v_exp_f16_e64 v195, v196
v_mfma_f32_16x16x32_bf16 v[168:171], v[224:227], v[104:107], v[168:171]
ds_read_b128 v[220:223], v248 offset:55552
ds_read_u16_d16 v188, v188
ds_read_u16_d16 v190, v190
v_lshrrev_b32 v189, 18, v189
v_lshrrev_b32 v191, 18, v191
v_mfma_f32_16x16x32_bf16 v[176:179], v[224:227], v[108:111], v[176:179]
v_exp_f16_sdwa v201, v202 dst_sel:WORD_1 dst_unused:UNUSED_PRESERVE src0_sel:WORD_1
v_mfma_f32_16x16x32_f16 v[80:83], v[228:231], v[232:235], v[80:83]
ds_read_b128 v[224:227], v249 offset:55296
ds_read_u16_d16_hi v189, v189
ds_read_u16_d16_hi v191, v191
v_and_b32 v193, s49, v193
v_bfe_u32 v192, v193, 2, 14
v_mfma_f32_16x16x32_f16 v[88:91], v[228:231], v[236:239], v[88:91]
v_exp_f16_sdwa v198, v199 dst_sel:WORD_1 dst_unused:UNUSED_PRESERVE src0_sel:WORD_1
s_waitcnt lgkmcnt(7)
v_mfma_f32_16x16x32_f16 v[84:87], v[240:243], v[232:235], v[84:87]
ds_read_b128 v[228:231], v249 offset:55552
ds_read_u16_d16 v192, v192
v_lshrrev_b32_e64 v193, 18, v193
v_mfma_f32_16x16x32_f16 v[92:95], v[240:243], v[236:239], v[92:95]
v_exp_f16_sdwa v195, v196 dst_sel:WORD_1 dst_unused:UNUSED_PRESERVE src0_sel:WORD_1
v_pk_add_f16 v201, v201, 1.0 op_sel_hi:[1,0]
v_pk_add_f16 v198, v198, 1.0 op_sel_hi:[1,0]
v_mfma_f32_16x16x32_bf16 v[172:175], v[244:247], v[104:107], v[172:175]
ds_read_b128 v[240:243], v248 offset:59392
ds_read_u16_d16_hi v193, v193
v_pk_add_f16 v195, v195, 1.0 op_sel_hi:[1,0]
v_mfma_f32_16x16x32_bf16 v[180:183], v[244:247], v[108:111], v[180:183]
v_rcp_f16 v202, v201
s_waitcnt lgkmcnt(7)
v_mfma_f32_16x16x32_bf16 v[168:171], v[216:219], v[112:115], v[168:171]
ds_read_b128 v[244:247], v249 offset:56320
v_rcp_f16_e64 v199, v198
v_mfma_f32_16x16x32_bf16 v[176:179], v[216:219], v[116:119], v[176:179]
v_rcp_f16_e64 v196, v195
v_mfma_f32_16x16x32_bf16 v[172:175], v[220:223], v[112:115], v[172:175]
ds_read_b128 v[216:219], v248 offset:59648
v_rcp_f16_sdwa v202, v201 dst_sel:WORD_1 dst_unused:UNUSED_PRESERVE src0_sel:WORD_1
v_mfma_f32_16x16x32_bf16 v[180:183], v[220:223], v[116:119], v[180:183]
v_rcp_f16_sdwa v199, v198 dst_sel:WORD_1 dst_unused:UNUSED_PRESERVE src0_sel:WORD_1
v_or_b32 v232, v184, v185
v_or_b32 v233, v186, v187
s_waitcnt lgkmcnt(4)
v_or_b32 v234, v188, v189
v_rcp_f16_sdwa v196, v195 dst_sel:WORD_1 dst_unused:UNUSED_PRESERVE src0_sel:WORD_1
v_or_b32 v235, v190, v191
s_waitcnt lgkmcnt(2)
v_or_b32_e64 v236, v192, v193
v_pk_mul_f16 v237, v203, v202
v_pk_mul_f16 v238, v200, v199
v_pk_mul_f16 v239, v197, v196
v_mfma_f32_16x16x32_f16 v[48:51], v[224:227], v[232:235], v[48:51]
s_add_u32 s46, s69, 98304
buffer_load_dwordx4 v[44:47], v252, s[4:7], s46 offen
ds_read_b128 v[220:223], v249 offset:56576
v_cvt_pkrtz_f16_f32 v185, v168, v169
v_cvt_pkrtz_f16_f32 v187, v170, v171
v_mfma_f32_16x16x32_f16 v[56:59], v[224:227], v[236:239], v[56:59]
v_cvt_pkrtz_f16_f32 v189, v172, v173
v_cvt_pkrtz_f16_f32 v191, v174, v175
v_mfma_f32_16x16x32_f16 v[52:55], v[228:231], v[232:235], v[52:55]
ds_read_b128 v[224:227], v248 offset:60416
v_cvt_pkrtz_f16_f32 v193, v176, v177
v_cvt_pk_f16_f32 v203, v178, v179
v_cvt_pk_f16_f32 v200, v180, v181
v_mfma_f32_16x16x32_f16 v[60:63], v[228:231], v[236:239], v[60:63]
v_cvt_pk_f16_f32 v197, v182, v183
v_pk_fma_f16 v202, v203, v203, s48
v_mfma_f32_16x16x32_bf16 v[168:171], v[240:243], v[96:99], 0
ds_read_b128 v[228:231], v249 offset:57344
v_and_b32_e64 v185, s49, v185
v_pk_fma_f16 v199, v200, v200, s48
v_mfma_f32_16x16x32_bf16 v[176:179], v[240:243], v[100:103], 0
v_and_b32_e64 v187, s49, v187
v_pk_fma_f16 v196, v197, v197, s48
s_setprio 2
v_bfe_u32 v184, v185, 2, 14
s_waitcnt lgkmcnt(3)
v_mfma_f32_16x16x32_f16 v[64:67], v[244:247], v[232:235], v[64:67]
ds_read_b128 v[240:243], v249 offset:57600
ds_read_u16_d16 v184, v184
v_pk_mul_f16 v202, v203, v202
v_bfe_u32 v186, v187, 2, 14
v_mfma_f32_16x16x32_f16 v[72:75], v[244:247], v[236:239], v[72:75]
v_pk_mul_f16 v199, v200, v199
v_lshrrev_b32_e64 v185, 18, v185
v_mfma_f32_16x16x32_bf16 v[172:175], v[216:219], v[96:99], 0
ds_read_b128 v[244:247], v248 offset:60672
ds_read_u16_d16 v186, v186
ds_read_u16_d16_hi v185, v185
v_pk_mul_f16 v196, v197, v196
v_lshrrev_b32_e64 v187, 18, v187
v_mfma_f32_16x16x32_bf16 v[180:183], v[216:219], v[100:103], 0
v_exp_f16_e64 v201, v202
v_and_b32 v189, s49, v189
s_waitcnt lgkmcnt(5)
v_mfma_f32_16x16x32_f16 v[68:71], v[220:223], v[232:235], v[68:71]
ds_read_b128 v[216:219], v248 offset:61440
ds_read_u16_d16_hi v187, v187
v_and_b32_e64 v191, s49, v191
v_mfma_f32_16x16x32_f16 v[76:79], v[220:223], v[236:239], v[76:79]
v_exp_f16_e64 v198, v199
v_bfe_u32 v188, v189, 2, 14
v_bfe_u32 v190, v191, 2, 14
v_mfma_f32_16x16x32_bf16 v[168:171], v[224:227], v[104:107], v[168:171]
buffer_store_dwordx4 v[152:155], v255, s[8:11], s68 offen offset:256 sc1
ds_read_b128 v[220:223], v248 offset:61696
ds_read_u16_d16 v188, v188
ds_read_u16_d16 v190, v190
v_exp_f16_e64 v195, v196
v_mfma_f32_16x16x32_bf16 v[176:179], v[224:227], v[108:111], v[176:179]
v_lshrrev_b32 v189, 18, v189
v_lshrrev_b32 v191, 18, v191
v_mfma_f32_16x16x32_f16 v[80:83], v[228:231], v[232:235], v[80:83]
ds_read_b128 v[224:227], v249 offset:61440
ds_read_u16_d16_hi v189, v189
ds_read_u16_d16_hi v191, v191
v_exp_f16_sdwa v201, v202 dst_sel:WORD_1 dst_unused:UNUSED_PRESERVE src0_sel:WORD_1
v_and_b32 v193, s49, v193
v_mfma_f32_16x16x32_f16 v[88:91], v[228:231], v[236:239], v[88:91]
v_bfe_u32 v192, v193, 2, 14
s_waitcnt lgkmcnt(8)
v_mfma_f32_16x16x32_f16 v[84:87], v[240:243], v[232:235], v[84:87]
ds_read_b128 v[228:231], v249 offset:61696
ds_read_u16_d16 v192, v192
v_exp_f16_sdwa v198, v199 dst_sel:WORD_1 dst_unused:UNUSED_PRESERVE src0_sel:WORD_1
v_lshrrev_b32_e64 v193, 18, v193
v_mfma_f32_16x16x32_f16 v[92:95], v[240:243], v[236:239], v[92:95]
v_exp_f16_sdwa v195, v196 dst_sel:WORD_1 dst_unused:UNUSED_PRESERVE src0_sel:WORD_1
v_pk_add_f16 v201, v201, 1.0 op_sel_hi:[1,0]
v_mfma_f32_16x16x32_bf16 v[172:175], v[244:247], v[104:107], v[172:175]
ds_read_b128 v[240:243], v249
ds_read_u16_d16_hi v193, v193
v_pk_add_f16 v198, v198, 1.0 op_sel_hi:[1,0]
v_pk_add_f16 v195, v195, 1.0 op_sel_hi:[1,0]
v_mfma_f32_16x16x32_bf16 v[180:183], v[244:247], v[108:111], v[180:183]
v_rcp_f16 v202, v201
s_waitcnt lgkmcnt(7)
v_mfma_f32_16x16x32_bf16 v[168:171], v[216:219], v[112:115], v[168:171]
ds_read_b128 v[244:247], v249 offset:62464
v_rcp_f16_e64 v199, v198
v_mfma_f32_16x16x32_bf16 v[176:179], v[216:219], v[116:119], v[176:179]
v_rcp_f16_e64 v196, v195
v_mfma_f32_16x16x32_bf16 v[172:175], v[220:223], v[112:115], v[172:175]
ds_read_b128 v[216:219], v249 offset:256
v_rcp_f16_sdwa v202, v201 dst_sel:WORD_1 dst_unused:UNUSED_PRESERVE src0_sel:WORD_1
v_mfma_f32_16x16x32_bf16 v[180:183], v[220:223], v[116:119], v[180:183]
v_rcp_f16_sdwa v199, v198 dst_sel:WORD_1 dst_unused:UNUSED_PRESERVE src0_sel:WORD_1
v_or_b32 v232, v184, v185
v_or_b32 v233, v186, v187
s_waitcnt lgkmcnt(4)
v_or_b32 v234, v188, v189
v_rcp_f16_sdwa v196, v195 dst_sel:WORD_1 dst_unused:UNUSED_PRESERVE src0_sel:WORD_1
v_or_b32 v235, v190, v191
s_waitcnt lgkmcnt(2)
v_or_b32_e64 v236, v192, v193
v_pk_mul_f16 v237, v203, v202
v_pk_mul_f16 v238, v200, v199
v_pk_mul_f16 v239, v197, v196
v_mfma_f32_16x16x32_f16 v[48:51], v[224:227], v[232:235], v[48:51]
s_add_u32 s46, s69, 98304
buffer_load_dwordx4 v[40:43], v252, s[4:7], s46 offen offset:64
ds_read_b128 v[220:223], v249 offset:62720
v_cvt_pkrtz_f16_f32 v185, v168, v169
v_cvt_pkrtz_f16_f32 v187, v170, v171
v_mfma_f32_16x16x32_f16 v[56:59], v[224:227], v[236:239], v[56:59]
v_cvt_pkrtz_f16_f32 v189, v172, v173
v_cvt_pkrtz_f16_f32 v191, v174, v175
v_mfma_f32_16x16x32_f16 v[52:55], v[228:231], v[232:235], v[52:55]
ds_read_b128 v[224:227], v249 offset:1024
v_cvt_pkrtz_f16_f32 v193, v176, v177
v_cvt_pk_f16_f32 v203, v178, v179
v_mfma_f32_16x16x32_f16 v[60:63], v[228:231], v[236:239], v[60:63]
v_cvt_pk_f16_f32 v200, v180, v181
v_cvt_pk_f16_f32 v197, v182, v183
s_setprio 1
v_mfma_f32_16x16x32_bf16 v[168:171], v[240:243], v[96:99], 0
ds_read_b128 v[228:231], v249 offset:63488
v_pk_fma_f16 v202, v203, v203, s48
v_and_b32 v185, s49, v185
v_mfma_f32_16x16x32_bf16 v[176:179], v[240:243], v[100:103], 0
v_pk_fma_f16 v199, v200, v200, s48
v_and_b32 v187, s49, v187
s_waitcnt lgkmcnt(3)
v_mfma_f32_16x16x32_f16 v[64:67], v[244:247], v[232:235], v[64:67]
ds_read_b128 v[240:243], v249 offset:63744
v_pk_fma_f16 v196, v197, v197, s48
v_bfe_u32 v184, v185, 2, 14
v_mfma_f32_16x16x32_f16 v[72:75], v[244:247], v[236:239], v[72:75]
v_pk_mul_f16 v202, v203, v202
v_bfe_u32 v186, v187, 2, 14
s_waitcnt vmcnt(8)
v_mfma_f32_16x16x32_bf16 v[160:163], v[18:21], v[208:211], v[160:163]
ds_read_b128 v[244:247], v249 offset:1280
ds_read_u16_d16 v184, v184
ds_read_u16_d16 v186, v186
v_pk_mul_f16 v199, v200, v199
v_lshrrev_b32 v185, 18, v185
v_mfma_f32_16x16x32_bf16 v[164:167], v[16:19], v[208:211], v[164:167]
v_pk_mul_f16 v196, v197, v196
v_lshrrev_b32_e64 v187, 18, v187
v_mfma_f32_16x16x32_bf16 v[172:175], v[216:219], v[96:99], 0
ds_read_u16_d16_hi v185, v185
ds_read_u16_d16_hi v187, v187
v_exp_f16_e64 v201, v202
v_mfma_f32_16x16x32_bf16 v[180:183], v[216:219], v[100:103], 0
v_and_b32_e64 v189, s49, v189
v_and_b32 v191, s49, v191
s_waitcnt lgkmcnt(6)
v_mfma_f32_16x16x32_f16 v[68:71], v[220:223], v[232:235], v[68:71]
ds_read_b128 v[216:219], v249 offset:2048
v_exp_f16_e64 v198, v199
v_mfma_f32_16x16x32_f16 v[76:79], v[220:223], v[236:239], v[76:79]
v_bfe_u32 v188, v189, 2, 14
v_bfe_u32 v190, v191, 2, 14
v_mfma_f32_16x16x32_bf16 v[168:171], v[224:227], v[104:107], v[168:171]
ds_read_b128 v[220:223], v249 offset:2304
ds_read_u16_d16 v188, v188
ds_read_u16_d16 v190, v190
v_exp_f16_e64 v195, v196
v_mfma_f32_16x16x32_bf16 v[176:179], v[224:227], v[108:111], v[176:179]
v_lshrrev_b32 v189, 18, v189
v_lshrrev_b32 v191, 18, v191
v_mfma_f32_16x16x32_f16 v[80:83], v[228:231], v[232:235], v[80:83]
ds_read_b128 v[224:227], v250 offset:2048
ds_read_u16_d16_hi v189, v189
ds_read_u16_d16_hi v191, v191
v_exp_f16_sdwa v201, v202 dst_sel:WORD_1 dst_unused:UNUSED_PRESERVE src0_sel:WORD_1
v_mfma_f32_16x16x32_f16 v[88:91], v[228:231], v[236:239], v[88:91]
v_and_b32 v193, s49, v193
v_bfe_u32 v192, v193, 2, 14
s_waitcnt lgkmcnt(7)
v_mfma_f32_16x16x32_f16 v[84:87], v[240:243], v[232:235], v[84:87]
ds_read_b128 v[228:231], v250 offset:2304
ds_read_u16_d16 v192, v192
v_exp_f16_sdwa v198, v199 dst_sel:WORD_1 dst_unused:UNUSED_PRESERVE src0_sel:WORD_1
v_mfma_f32_16x16x32_f16 v[92:95], v[240:243], v[236:239], v[92:95]
v_lshrrev_b32 v193, 18, v193
s_waitcnt vmcnt(7)
v_mfma_f32_16x16x32_bf16 v[48:51], v[18:21], v[12:15], v[48:51]
ds_read_b128 v[240:243], v249 offset:6144
ds_read_u16_d16_hi v193, v193
v_exp_f16_sdwa v195, v196 dst_sel:WORD_1 dst_unused:UNUSED_PRESERVE src0_sel:WORD_1
v_pk_add_f16 v201, v201, 1.0 op_sel_hi:[1,0]
v_mfma_f32_16x16x32_bf16 v[52:55], v[16:19], v[12:15], v[52:55]
v_pk_add_f16 v198, v198, 1.0 op_sel_hi:[1,0]
v_pk_add_f16 v195, v195, 1.0 op_sel_hi:[1,0]
v_mfma_f32_16x16x32_bf16 v[172:175], v[244:247], v[104:107], v[172:175]
v_rcp_f16 v202, v201
s_setprio 0
v_mfma_f32_16x16x32_bf16 v[180:183], v[244:247], v[108:111], v[180:183]
v_rcp_f16 v199, v198
s_waitcnt lgkmcnt(4)
v_mfma_f32_16x16x32_bf16 v[168:171], v[216:219], v[112:115], v[168:171]
ds_read_b128 v[244:247], v250 offset:3072
v_rcp_f16_e64 v196, v195
v_mfma_f32_16x16x32_bf16 v[176:179], v[216:219], v[116:119], v[176:179]
v_rcp_f16_sdwa v202, v201 dst_sel:WORD_1 dst_unused:UNUSED_PRESERVE src0_sel:WORD_1
v_mfma_f32_16x16x32_bf16 v[172:175], v[220:223], v[112:115], v[172:175]
ds_read_b128 v[216:219], v249 offset:6400
v_rcp_f16_sdwa v199, v198 dst_sel:WORD_1 dst_unused:UNUSED_PRESERVE src0_sel:WORD_1
v_mfma_f32_16x16x32_bf16 v[180:183], v[220:223], v[116:119], v[180:183]
v_or_b32 v232, v184, v185
v_or_b32 v233, v186, v187
v_or_b32_e64 v234, v188, v189
v_rcp_f16_sdwa v196, v195 dst_sel:WORD_1 dst_unused:UNUSED_PRESERVE src0_sel:WORD_1
v_or_b32 v235, v190, v191
s_waitcnt lgkmcnt(2)
v_or_b32_e64 v236, v192, v193
v_pk_mul_f16 v237, v203, v202
v_pk_mul_f16 v238, v200, v199
v_pk_mul_f16 v239, v197, v196
v_mfma_f32_16x16x32_f16 v[48:51], v[224:227], v[232:235], v[48:51]
s_add_u32 s46, s69, 98304
buffer_load_dwordx4 v[208:211], v252, s[4:7], s46 offen offset:128
ds_read_b128 v[220:223], v250 offset:3328
v_cvt_pkrtz_f16_f32 v185, v168, v169
v_cvt_pkrtz_f16_f32 v187, v170, v171
v_cvt_pkrtz_f16_f32 v189, v172, v173
v_mfma_f32_16x16x32_f16 v[56:59], v[224:227], v[236:239], v[56:59]
v_cvt_pkrtz_f16_f32 v191, v174, v175
v_cvt_pkrtz_f16_f32 v193, v176, v177
v_cvt_pk_f16_f32 v203, v178, v179
v_mfma_f32_16x16x32_f16 v[52:55], v[228:231], v[232:235], v[52:55]
ds_read_b128 v[224:227], v249 offset:7168
v_cvt_pk_f16_f32 v200, v180, v181
v_cvt_pk_f16_f32 v197, v182, v183
v_pk_fma_f16 v202, v203, v203, s48
v_mfma_f32_16x16x32_f16 v[60:63], v[228:231], v[236:239], v[60:63]
v_cvt_pk_bf16_f32 v144, v144, v145
v_and_b32_e64 v185, s49, v185
v_cvt_pk_bf16_f32 v145, v146, v147
v_mfma_f32_16x16x32_bf16 v[168:171], v[240:243], v[96:99], 0
ds_read_b128 v[228:231], v250 offset:4096
v_pk_fma_f16 v199, v200, v200, s48
v_and_b32 v187, s49, v187
v_cvt_pk_bf16_f32 v146, v148, v149
v_mfma_f32_16x16x32_bf16 v[176:179], v[240:243], v[100:103], 0
v_pk_fma_f16 v196, v197, v197, s48
v_cvt_pk_bf16_f32 v147, v150, v151
v_bfe_u32 v184, v185, 2, 14
s_waitcnt lgkmcnt(2)
v_mfma_f32_16x16x32_f16 v[64:67], v[244:247], v[232:235], v[64:67]
ds_read_b128 v[240:243], v250 offset:4352
ds_read_u16_d16 v184, v184
v_pk_mul_f16 v202, v203, v202
v_cvt_pk_bf16_f32 v128, v128, v129
v_bfe_u32 v186, v187, 2, 14
v_mfma_f32_16x16x32_f16 v[72:75], v[244:247], v[236:239], v[72:75]
v_cvt_pk_bf16_f32 v129, v130, v131
v_pk_mul_f16 v199, v200, v199
v_lshrrev_b32 v185, 18, v185
s_waitcnt vmcnt(6)
v_mfma_f32_16x16x32_bf16 v[64:67], v[18:21], v[204:207], v[64:67]
ds_read_b128 v[244:247], v249 offset:7424
ds_read_u16_d16 v186, v186
ds_read_u16_d16_hi v185, v185
v_cvt_pk_bf16_f32 v130, v132, v133
v_pk_mul_f16 v196, v197, v196
v_lshrrev_b32_e64 v187, 18, v187
v_mfma_f32_16x16x32_bf16 v[68:71], v[16:19], v[204:207], v[68:71]
v_cvt_pk_bf16_f32 v131, v134, v135
v_exp_f16_e64 v201, v202
v_mfma_f32_16x16x32_bf16 v[172:175], v[216:219], v[96:99], 0
ds_read_u16_d16_hi v187, v187
v_cvt_pk_bf16_f32 v160, v160, v161
v_and_b32_e64 v189, s49, v189
v_cvt_pk_bf16_f32 v161, v162, v163
v_mfma_f32_16x16x32_bf16 v[180:183], v[216:219], v[100:103], 0
v_and_b32_e64 v191, s49, v191
v_cvt_pk_bf16_f32 v162, v164, v165
v_mfma_f32_16x16x32_f16 v[68:71], v[220:223], v[232:235], v[68:71]
ds_read_b128 v[216:219], v249 offset:8192
v_exp_f16 v198, v199
v_cvt_pk_bf16_f32 v163, v166, v167
s_mov_b64 vcc, s[74:75]
v_bfe_u32 v188, v189, 2, 14
v_bfe_u32 v190, v191, 2, 14
v_mfma_f32_16x16x32_f16 v[76:79], v[220:223], v[236:239], v[76:79]
v_cndmask_b32 v148, v128, v160, vcc
v_exp_f16_e64 v195, v196
s_waitcnt lgkmcnt(2)
v_mfma_f32_16x16x32_bf16 v[168:171], v[224:227], v[104:107], v[168:171]
ds_read_b128 v[220:223], v249 offset:8448
ds_read_u16_d16 v188, v188
ds_read_u16_d16 v190, v190
v_cndmask_b32 v149, v129, v161, vcc
v_lshrrev_b32_e64 v189, 18, v189
v_cndmask_b32 v150, v130, v162, vcc
v_mfma_f32_16x16x32_bf16 v[176:179], v[224:227], v[108:111], v[176:179]
v_lshrrev_b32 v191, 18, v191
v_cndmask_b32 v151, v131, v163, vcc
v_mfma_f32_16x16x32_f16 v[80:83], v[228:231], v[232:235], v[80:83]
ds_read_b128 v[224:227], v250 offset:8192
ds_read_u16_d16_hi v189, v189
ds_read_u16_d16_hi v191, v191
v_exp_f16_sdwa v201, v202 dst_sel:WORD_1 dst_unused:UNUSED_PRESERVE src0_sel:WORD_1
v_cndmask_b32_dpp v128, v144, v128, vcc quad_perm:[1,0,3,2] row_mask:0xf bank_mask:0xf
v_and_b32_e64 v193, s49, v193
v_mfma_f32_16x16x32_f16 v[88:91], v[228:231], v[236:239], v[88:91]
v_cndmask_b32_dpp v129, v145, v129, vcc quad_perm:[1,0,3,2] row_mask:0xf bank_mask:0xf
v_bfe_u32 v192, v193, 2, 14
v_mfma_f32_16x16x32_f16 v[84:87], v[240:243], v[232:235], v[84:87]
ds_read_b128 v[228:231], v250 offset:8448
ds_read_u16_d16 v192, v192
v_exp_f16_sdwa v198, v199 dst_sel:WORD_1 dst_unused:UNUSED_PRESERVE src0_sel:WORD_1
v_cndmask_b32_dpp v130, v146, v130, vcc quad_perm:[1,0,3,2] row_mask:0xf bank_mask:0xf
v_lshrrev_b32 v193, 18, v193
v_mfma_f32_16x16x32_f16 v[92:95], v[240:243], v[236:239], v[92:95]
v_cndmask_b32_dpp v131, v147, v131, vcc quad_perm:[1,0,3,2] row_mask:0xf bank_mask:0xf
s_not_b64 vcc, s[74:75]
v_exp_f16_sdwa v195, v196 dst_sel:WORD_1 dst_unused:UNUSED_PRESERVE src0_sel:WORD_1
v_mfma_f32_16x16x32_bf16 v[172:175], v[244:247], v[104:107], v[172:175]
ds_read_b128 v[240:243], v249 offset:12288
ds_read_u16_d16_hi v193, v193
v_cndmask_b32_dpp v160, v144, v160, vcc quad_perm:[1,0,3,2] row_mask:0xf bank_mask:0xf
v_pk_add_f16 v201, v201, 1.0 op_sel_hi:[1,0]
v_cndmask_b32_dpp v161, v145, v161, vcc quad_perm:[1,0,3,2] row_mask:0xf bank_mask:0xf
v_mfma_f32_16x16x32_bf16 v[180:183], v[244:247], v[108:111], v[180:183]
v_pk_add_f16 v198, v198, 1.0 op_sel_hi:[1,0]
v_cndmask_b32_dpp v162, v146, v162, vcc quad_perm:[1,0,3,2] row_mask:0xf bank_mask:0xf
v_pk_add_f16 v195, v195, 1.0 op_sel_hi:[1,0]
s_waitcnt lgkmcnt(4)
v_mfma_f32_16x16x32_bf16 v[168:171], v[216:219], v[112:115], v[168:171]
ds_read_b128 v[244:247], v250 offset:9216
v_rcp_f16 v202, v201
v_cndmask_b32_dpp v163, v147, v163, vcc quad_perm:[1,0,3,2] row_mask:0xf bank_mask:0xf
v_mfma_f32_16x16x32_bf16 v[176:179], v[216:219], v[116:119], v[176:179]
v_rcp_f16_e64 v199, v198
v_mfma_f32_16x16x32_bf16 v[172:175], v[220:223], v[112:115], v[172:175]
ds_read_b128 v[216:219], v249 offset:12544
s_add_u32 s46, s68, 98304
buffer_store_dwordx4 v[128:131], v255, s[8:11], s46 offen sc1
v_rcp_f16_e64 v196, v195
v_rcp_f16_sdwa v202, v201 dst_sel:WORD_1 dst_unused:UNUSED_PRESERVE src0_sel:WORD_1
v_mfma_f32_16x16x32_bf16 v[180:183], v[220:223], v[116:119], v[180:183]
v_rcp_f16_sdwa v199, v198 dst_sel:WORD_1 dst_unused:UNUSED_PRESERVE src0_sel:WORD_1
v_or_b32 v232, v184, v185
v_or_b32 v233, v186, v187
v_or_b32_e64 v234, v188, v189
v_rcp_f16_sdwa v196, v195 dst_sel:WORD_1 dst_unused:UNUSED_PRESERVE src0_sel:WORD_1
v_or_b32 v235, v190, v191
s_waitcnt lgkmcnt(2)
v_or_b32_e64 v236, v192, v193
v_pk_mul_f16 v237, v203, v202
v_pk_mul_f16 v238, v200, v199
v_pk_mul_f16 v239, v197, v196
v_mfma_f32_16x16x32_f16 v[48:51], v[224:227], v[232:235], v[48:51]
s_add_u32 s46, s68, 98304
buffer_store_dwordx4 v[148:151], v255, s[8:11], s46 offen offset:128 sc1
ds_read_b128 v[220:223], v250 offset:9472
v_cvt_pkrtz_f16_f32 v185, v168, v169
v_cvt_pkrtz_f16_f32 v187, v170, v171
v_mfma_f32_16x16x32_f16 v[56:59], v[224:227], v[236:239], v[56:59]
v_cvt_pkrtz_f16_f32 v189, v172, v173
v_cvt_pkrtz_f16_f32 v191, v174, v175
v_mfma_f32_16x16x32_f16 v[52:55], v[228:231], v[232:235], v[52:55]
ds_read_b128 v[224:227], v249 offset:13312
v_cvt_pkrtz_f16_f32 v193, v176, v177
v_cvt_pk_f16_f32 v203, v178, v179
v_mfma_f32_16x16x32_f16 v[60:63], v[228:231], v[236:239], v[60:63]
v_cvt_pk_f16_f32 v200, v180, v181
v_cvt_pk_f16_f32 v197, v182, v183
v_mfma_f32_16x16x32_bf16 v[168:171], v[240:243], v[96:99], 0
ds_read_b128 v[228:231], v250 offset:10240
v_pk_fma_f16 v202, v203, v203, s48
v_and_b32_e64 v185, s49, v185
v_mfma_f32_16x16x32_bf16 v[176:179], v[240:243], v[100:103], 0
v_pk_fma_f16 v199, v200, v200, s48
v_and_b32 v187, s49, v187
s_waitcnt lgkmcnt(3)
v_mfma_f32_16x16x32_f16 v[64:67], v[244:247], v[232:235], v[64:67]
ds_read_b128 v[240:243], v250 offset:10496
v_pk_fma_f16 v196, v197, v197, s48
v_bfe_u32 v184, v185, 2, 14
v_pk_mul_f16 v202, v203, v202
v_mfma_f32_16x16x32_f16 v[72:75], v[244:247], v[236:239], v[72:75]
v_bfe_u32 v186, v187, 2, 14
v_pk_mul_f16 v199, v200, v199
s_waitcnt vmcnt(6)
v_mfma_f32_16x16x32_bf16 v[80:83], v[18:21], v[8:11], v[80:83]
ds_read_b128 v[244:247], v249 offset:13568
ds_read_u16_d16 v184, v184
ds_read_u16_d16 v186, v186
v_lshrrev_b32 v185, 18, v185
v_pk_mul_f16 v196, v197, v196
v_mfma_f32_16x16x32_bf16 v[84:87], v[16:19], v[8:11], v[84:87]
v_lshrrev_b32_e64 v187, 18, v187
v_mfma_f32_16x16x32_bf16 v[172:175], v[216:219], v[96:99], 0
ds_read_u16_d16_hi v185, v185
ds_read_u16_d16_hi v187, v187
v_exp_f16 v201, v202
v_and_b32 v189, s49, v189
v_mfma_f32_16x16x32_bf16 v[180:183], v[216:219], v[100:103], 0
v_and_b32 v191, s49, v191
s_waitcnt lgkmcnt(6)
v_mfma_f32_16x16x32_f16 v[68:71], v[220:223], v[232:235], v[68:71]
ds_read_b128 v[216:219], v249 offset:14336
v_exp_f16_e64 v198, v199
v_bfe_u32 v188, v189, 2, 14
v_mfma_f32_16x16x32_f16 v[76:79], v[220:223], v[236:239], v[76:79]
v_bfe_u32 v190, v191, 2, 14
v_exp_f16_e64 v195, v196
v_mfma_f32_16x16x32_bf16 v[168:171], v[224:227], v[104:107], v[168:171]
ds_read_b128 v[220:223], v249 offset:14592
ds_read_u16_d16 v188, v188
ds_read_u16_d16 v190, v190
v_lshrrev_b32 v189, 18, v189
v_lshrrev_b32 v191, 18, v191
v_mfma_f32_16x16x32_bf16 v[176:179], v[224:227], v[108:111], v[176:179]
v_exp_f16_sdwa v201, v202 dst_sel:WORD_1 dst_unused:UNUSED_PRESERVE src0_sel:WORD_1
v_mfma_f32_16x16x32_f16 v[80:83], v[228:231], v[232:235], v[80:83]
ds_read_b128 v[224:227], v250 offset:14336
ds_read_u16_d16_hi v189, v189
ds_read_u16_d16_hi v191, v191
v_and_b32 v193, s49, v193
v_bfe_u32 v192, v193, 2, 14
v_mfma_f32_16x16x32_f16 v[88:91], v[228:231], v[236:239], v[88:91]
v_exp_f16_sdwa v198, v199 dst_sel:WORD_1 dst_unused:UNUSED_PRESERVE src0_sel:WORD_1
s_waitcnt lgkmcnt(7)
v_mfma_f32_16x16x32_f16 v[84:87], v[240:243], v[232:235], v[84:87]
ds_read_b128 v[228:231], v250 offset:14592
ds_read_u16_d16 v192, v192
v_lshrrev_b32_e64 v193, 18, v193
v_mfma_f32_16x16x32_f16 v[92:95], v[240:243], v[236:239], v[92:95]
v_exp_f16_sdwa v195, v196 dst_sel:WORD_1 dst_unused:UNUSED_PRESERVE src0_sel:WORD_1
v_pk_add_f16 v201, v201, 1.0 op_sel_hi:[1,0]
v_pk_add_f16 v198, v198, 1.0 op_sel_hi:[1,0]
v_mfma_f32_16x16x32_bf16 v[172:175], v[244:247], v[104:107], v[172:175]
ds_read_b128 v[240:243], v249 offset:18432
ds_read_u16_d16_hi v193, v193
v_pk_add_f16 v195, v195, 1.0 op_sel_hi:[1,0]
v_mfma_f32_16x16x32_bf16 v[180:183], v[244:247], v[108:111], v[180:183]
v_rcp_f16 v202, v201
s_waitcnt lgkmcnt(7)
v_mfma_f32_16x16x32_bf16 v[168:171], v[216:219], v[112:115], v[168:171]
ds_read_b128 v[244:247], v250 offset:15360
v_rcp_f16_e64 v199, v198
v_mfma_f32_16x16x32_bf16 v[176:179], v[216:219], v[116:119], v[176:179]
v_rcp_f16_e64 v196, v195
v_mfma_f32_16x16x32_bf16 v[172:175], v[220:223], v[112:115], v[172:175]
ds_read_b128 v[216:219], v249 offset:18688
v_rcp_f16_sdwa v202, v201 dst_sel:WORD_1 dst_unused:UNUSED_PRESERVE src0_sel:WORD_1
v_mfma_f32_16x16x32_bf16 v[180:183], v[220:223], v[116:119], v[180:183]
v_rcp_f16_sdwa v199, v198 dst_sel:WORD_1 dst_unused:UNUSED_PRESERVE src0_sel:WORD_1
v_or_b32 v232, v184, v185
v_or_b32 v233, v186, v187
s_waitcnt lgkmcnt(4)
v_or_b32 v234, v188, v189
v_rcp_f16_sdwa v196, v195 dst_sel:WORD_1 dst_unused:UNUSED_PRESERVE src0_sel:WORD_1
v_or_b32 v235, v190, v191
s_waitcnt lgkmcnt(2)
v_or_b32_e64 v236, v192, v193
v_pk_mul_f16 v237, v203, v202
v_pk_mul_f16 v238, v200, v199
v_pk_mul_f16 v239, v197, v196
v_mfma_f32_16x16x32_f16 v[48:51], v[224:227], v[232:235], v[48:51]
ds_read_b128 v[220:223], v250 offset:15616
v_cvt_pkrtz_f16_f32 v185, v168, v169
v_cvt_pkrtz_f16_f32 v187, v170, v171
v_mfma_f32_16x16x32_f16 v[56:59], v[224:227], v[236:239], v[56:59]
v_cvt_pkrtz_f16_f32 v189, v172, v173
v_cvt_pkrtz_f16_f32 v191, v174, v175
v_mfma_f32_16x16x32_f16 v[52:55], v[228:231], v[232:235], v[52:55]
ds_read_b128 v[224:227], v249 offset:19456
v_cvt_pkrtz_f16_f32 v193, v176, v177
v_cvt_pk_f16_f32 v203, v178, v179
v_mfma_f32_16x16x32_f16 v[60:63], v[228:231], v[236:239], v[60:63]
v_cvt_pk_f16_f32 v200, v180, v181
v_cvt_pk_f16_f32 v197, v182, v183
v_mfma_f32_16x16x32_bf16 v[168:171], v[240:243], v[96:99], 0
ds_read_b128 v[228:231], v250 offset:16384
v_pk_fma_f16 v202, v203, v203, s48
v_and_b32_e64 v185, s49, v185
v_mfma_f32_16x16x32_bf16 v[176:179], v[240:243], v[100:103], 0
v_pk_fma_f16 v199, v200, v200, s48
v_and_b32 v187, s49, v187
s_waitcnt lgkmcnt(3)
v_mfma_f32_16x16x32_f16 v[64:67], v[244:247], v[232:235], v[64:67]
ds_read_b128 v[240:243], v250 offset:16640
v_pk_fma_f16 v196, v197, v197, s48
v_bfe_u32 v184, v185, 2, 14
v_pk_mul_f16 v202, v203, v202
v_mfma_f32_16x16x32_f16 v[72:75], v[244:247], v[236:239], v[72:75]
v_bfe_u32 v186, v187, 2, 14
v_pk_mul_f16 v199, v200, v199
s_waitcnt vmcnt(5)
v_mfma_f32_16x16x32_bf16 v[56:59], v[18:21], v[44:47], v[56:59]
ds_read_b128 v[244:247], v249 offset:19712
ds_read_u16_d16 v184, v184
ds_read_u16_d16 v186, v186
v_lshrrev_b32 v185, 18, v185
v_pk_mul_f16 v196, v197, v196
v_mfma_f32_16x16x32_bf16 v[60:63], v[16:19], v[44:47], v[60:63]
v_lshrrev_b32_e64 v187, 18, v187
v_mfma_f32_16x16x32_bf16 v[172:175], v[216:219], v[96:99], 0
ds_read_u16_d16_hi v185, v185
ds_read_u16_d16_hi v187, v187
v_exp_f16 v201, v202
v_and_b32 v189, s49, v189
v_mfma_f32_16x16x32_bf16 v[180:183], v[216:219], v[100:103], 0
v_and_b32 v191, s49, v191
s_waitcnt lgkmcnt(6)
v_mfma_f32_16x16x32_f16 v[68:71], v[220:223], v[232:235], v[68:71]
ds_read_b128 v[216:219], v249 offset:20480
v_exp_f16_e64 v198, v199
v_bfe_u32 v188, v189, 2, 14
v_mfma_f32_16x16x32_f16 v[76:79], v[220:223], v[236:239], v[76:79]
v_bfe_u32 v190, v191, 2, 14
v_exp_f16_e64 v195, v196
v_mfma_f32_16x16x32_bf16 v[168:171], v[224:227], v[104:107], v[168:171]
ds_read_b128 v[220:223], v249 offset:20736
ds_read_u16_d16 v188, v188
ds_read_u16_d16 v190, v190
v_lshrrev_b32 v189, 18, v189
v_lshrrev_b32 v191, 18, v191
v_mfma_f32_16x16x32_bf16 v[176:179], v[224:227], v[108:111], v[176:179]
v_exp_f16_sdwa v201, v202 dst_sel:WORD_1 dst_unused:UNUSED_PRESERVE src0_sel:WORD_1
v_mfma_f32_16x16x32_f16 v[80:83], v[228:231], v[232:235], v[80:83]
ds_read_b128 v[224:227], v250 offset:20480
ds_read_u16_d16_hi v189, v189
ds_read_u16_d16_hi v191, v191
v_and_b32 v193, s49, v193
v_bfe_u32 v192, v193, 2, 14
v_mfma_f32_16x16x32_f16 v[88:91], v[228:231], v[236:239], v[88:91]
v_exp_f16_sdwa v198, v199 dst_sel:WORD_1 dst_unused:UNUSED_PRESERVE src0_sel:WORD_1
s_waitcnt lgkmcnt(7)
v_mfma_f32_16x16x32_f16 v[84:87], v[240:243], v[232:235], v[84:87]
ds_read_b128 v[228:231], v250 offset:20736
ds_read_u16_d16 v192, v192
v_lshrrev_b32_e64 v193, 18, v193
v_mfma_f32_16x16x32_f16 v[92:95], v[240:243], v[236:239], v[92:95]
v_exp_f16_sdwa v195, v196 dst_sel:WORD_1 dst_unused:UNUSED_PRESERVE src0_sel:WORD_1
v_pk_add_f16 v201, v201, 1.0 op_sel_hi:[1,0]
v_pk_add_f16 v198, v198, 1.0 op_sel_hi:[1,0]
v_mfma_f32_16x16x32_bf16 v[172:175], v[244:247], v[104:107], v[172:175]
ds_read_b128 v[240:243], v250 offset:21504
ds_read_u16_d16_hi v193, v193
v_pk_add_f16 v195, v195, 1.0 op_sel_hi:[1,0]
v_mfma_f32_16x16x32_bf16 v[180:183], v[244:247], v[108:111], v[180:183]
v_rcp_f16 v202, v201
s_waitcnt lgkmcnt(7)
v_mfma_f32_16x16x32_bf16 v[168:171], v[216:219], v[112:115], v[168:171]
ds_read_b128 v[244:247], v250 offset:21760
v_rcp_f16_e64 v199, v198
v_mfma_f32_16x16x32_bf16 v[176:179], v[216:219], v[116:119], v[176:179]
v_rcp_f16_e64 v196, v195
v_mfma_f32_16x16x32_bf16 v[172:175], v[220:223], v[112:115], v[172:175]
ds_read_b128 v[216:219], v250 offset:22528
v_rcp_f16_sdwa v202, v201 dst_sel:WORD_1 dst_unused:UNUSED_PRESERVE src0_sel:WORD_1
v_mfma_f32_16x16x32_bf16 v[180:183], v[220:223], v[116:119], v[180:183]
v_rcp_f16_sdwa v199, v198 dst_sel:WORD_1 dst_unused:UNUSED_PRESERVE src0_sel:WORD_1
v_or_b32 v232, v184, v185
v_or_b32 v233, v186, v187
s_waitcnt lgkmcnt(4)
v_or_b32 v234, v188, v189
v_rcp_f16_sdwa v196, v195 dst_sel:WORD_1 dst_unused:UNUSED_PRESERVE src0_sel:WORD_1
v_or_b32 v235, v190, v191
s_waitcnt lgkmcnt(2)
v_or_b32_e64 v236, v192, v193
v_pk_mul_f16 v237, v203, v202
v_pk_mul_f16 v238, v200, v199
v_pk_mul_f16 v239, v197, v196
v_mfma_f32_16x16x32_f16 v[48:51], v[224:227], v[232:235], v[48:51]
s_add_u32 s46, s68, 98304
buffer_store_dwordx4 v[160:163], v255, s[8:11], s46 offen offset:256 sc1
ds_read_b128 v[220:223], v250 offset:22784
v_cvt_pkrtz_f16_f32 v185, v168, v169
v_cvt_pkrtz_f16_f32 v187, v170, v171
v_cvt_pkrtz_f16_f32 v189, v172, v173
v_cvt_pkrtz_f16_f32 v191, v174, v175
v_mfma_f32_16x16x32_f16 v[56:59], v[224:227], v[236:239], v[56:59]
v_cvt_pkrtz_f16_f32 v193, v176, v177
v_cvt_pk_f16_f32 v203, v178, v179
v_cvt_pk_f16_f32 v200, v180, v181
v_cvt_pk_f16_f32 v197, v182, v183
v_mfma_f32_16x16x32_f16 v[52:55], v[228:231], v[232:235], v[52:55]
ds_read_b128 v[224:227], v250 offset:26624
v_pk_fma_f16 v202, v203, v203, s48
v_and_b32_e64 v185, s49, v185
v_pk_fma_f16 v199, v200, v200, s48
v_and_b32_e64 v187, s49, v187
v_mfma_f32_16x16x32_f16 v[60:63], v[228:231], v[236:239], v[60:63]
v_pk_fma_f16 v196, v197, v197, s48
v_bfe_u32 v184, v185, 2, 14
v_pk_mul_f16 v202, v203, v202
v_bfe_u32 v186, v187, 2, 14
v_mfma_f32_16x16x32_f16 v[64:67], v[240:243], v[232:235], v[64:67]
ds_read_b128 v[228:231], v250 offset:26880
ds_read_u16_d16 v184, v184
ds_read_u16_d16 v186, v186
v_pk_mul_f16 v199, v200, v199
v_lshrrev_b32_e64 v185, 18, v185
v_pk_mul_f16 v196, v197, v196
v_lshrrev_b32_e64 v187, 18, v187
v_mfma_f32_16x16x32_f16 v[72:75], v[240:243], v[236:239], v[72:75]
v_exp_f16 v201, v202
v_and_b32 v189, s49, v189
v_and_b32 v191, s49, v191
s_waitcnt vmcnt(4)
v_mfma_f32_16x16x32_bf16 v[72:75], v[18:21], v[40:43], v[72:75]
ds_read_b128 v[240:243], v250 offset:27648
ds_read_u16_d16_hi v185, v185
ds_read_u16_d16_hi v187, v187
v_exp_f16_e64 v198, v199
v_bfe_u32 v188, v189, 2, 14
v_bfe_u32 v190, v191, 2, 14
v_mfma_f32_16x16x32_bf16 v[76:79], v[16:19], v[40:43], v[76:79]
v_exp_f16 v195, v196
v_lshrrev_b32 v189, 18, v189
v_lshrrev_b32 v191, 18, v191
s_waitcnt lgkmcnt(6)
v_mfma_f32_16x16x32_f16 v[68:71], v[244:247], v[232:235], v[68:71]
ds_read_u16_d16 v188, v188
ds_read_u16_d16 v190, v190
ds_read_u16_d16_hi v189, v189
ds_read_u16_d16_hi v191, v191
v_exp_f16_sdwa v201, v202 dst_sel:WORD_1 dst_unused:UNUSED_PRESERVE src0_sel:WORD_1
v_and_b32_e64 v193, s49, v193
v_bfe_u32 v192, v193, 2, 14
v_mfma_f32_16x16x32_f16 v[76:79], v[244:247], v[236:239], v[76:79]
v_exp_f16_sdwa v198, v199 dst_sel:WORD_1 dst_unused:UNUSED_PRESERVE src0_sel:WORD_1
v_lshrrev_b32_e64 v193, 18, v193
v_mfma_f32_16x16x32_f16 v[80:83], v[216:219], v[232:235], v[80:83]
ds_read_b128 v[244:247], v250 offset:27904
ds_read_u16_d16 v192, v192
ds_read_u16_d16_hi v193, v193
v_exp_f16_sdwa v195, v196 dst_sel:WORD_1 dst_unused:UNUSED_PRESERVE src0_sel:WORD_1
v_pk_add_f16 v201, v201, 1.0 op_sel_hi:[1,0]
v_pk_add_f16 v198, v198, 1.0 op_sel_hi:[1,0]
v_pk_add_f16 v195, v195, 1.0 op_sel_hi:[1,0]
v_mfma_f32_16x16x32_f16 v[88:91], v[216:219], v[236:239], v[88:91]
v_rcp_f16 v202, v201
v_rcp_f16 v199, v198
v_mfma_f32_16x16x32_f16 v[84:87], v[220:223], v[232:235], v[84:87]
ds_read_b128 v[216:219], v250 offset:28672
v_rcp_f16_e64 v196, v195
v_rcp_f16_sdwa v202, v201 dst_sel:WORD_1 dst_unused:UNUSED_PRESERVE src0_sel:WORD_1
v_mfma_f32_16x16x32_f16 v[92:95], v[220:223], v[236:239], v[92:95]
v_rcp_f16_sdwa v199, v198 dst_sel:WORD_1 dst_unused:UNUSED_PRESERVE src0_sel:WORD_1
s_waitcnt lgkmcnt(5)
v_or_b32 v232, v184, v185
v_or_b32_e64 v233, v186, v187
v_or_b32 v234, v188, v189
v_rcp_f16_sdwa v196, v195 dst_sel:WORD_1 dst_unused:UNUSED_PRESERVE src0_sel:WORD_1
s_waitcnt lgkmcnt(4)
v_or_b32 v235, v190, v191
s_waitcnt lgkmcnt(1)
v_or_b32 v236, v192, v193
v_pk_mul_f16 v237, v203, v202
v_pk_mul_f16 v238, v200, v199
v_pk_mul_f16 v239, v197, v196
v_mfma_f32_16x16x32_f16 v[48:51], v[224:227], v[232:235], v[48:51]
ds_read_b128 v[220:223], v250 offset:28928
v_mfma_f32_16x16x32_f16 v[56:59], v[224:227], v[236:239], v[56:59]
v_mfma_f32_16x16x32_f16 v[52:55], v[228:231], v[232:235], v[52:55]
v_mfma_f32_16x16x32_f16 v[60:63], v[228:231], v[236:239], v[60:63]
v_mfma_f32_16x16x32_f16 v[64:67], v[240:243], v[232:235], v[64:67]
v_mfma_f32_16x16x32_f16 v[72:75], v[240:243], v[236:239], v[72:75]
s_waitcnt vmcnt(3)
v_mfma_f32_16x16x32_bf16 v[88:91], v[18:21], v[208:211], v[88:91]
v_mfma_f32_16x16x32_bf16 v[92:95], v[16:19], v[208:211], v[92:95]
v_mfma_f32_16x16x32_f16 v[68:71], v[244:247], v[232:235], v[68:71]
v_mfma_f32_16x16x32_f16 v[76:79], v[244:247], v[236:239], v[76:79]
s_waitcnt lgkmcnt(1)
v_mfma_f32_16x16x32_f16 v[80:83], v[216:219], v[232:235], v[80:83]
v_mfma_f32_16x16x32_f16 v[88:91], v[216:219], v[236:239], v[88:91]
s_waitcnt lgkmcnt(0)
v_mfma_f32_16x16x32_f16 v[84:87], v[220:223], v[232:235], v[84:87]
v_mfma_f32_16x16x32_f16 v[92:95], v[220:223], v[236:239], v[92:95]
v_cvt_pk_bf16_f32 v64, v64, v65
v_cvt_pk_bf16_f32 v65, v66, v67
v_cvt_pk_bf16_f32 v66, v68, v69
v_cvt_pk_bf16_f32 v67, v70, v71
v_cvt_pk_bf16_f32 v48, v48, v49
v_cvt_pk_bf16_f32 v49, v50, v51
v_cvt_pk_bf16_f32 v50, v52, v53
v_cvt_pk_bf16_f32 v51, v54, v55
v_cvt_pk_bf16_f32 v80, v80, v81
v_cvt_pk_bf16_f32 v81, v82, v83
v_cvt_pk_bf16_f32 v82, v84, v85
v_cvt_pk_bf16_f32 v83, v86, v87
s_mov_b64 vcc, s[74:75]
v_cndmask_b32 v68, v48, v80, vcc
v_cndmask_b32 v69, v49, v81, vcc
v_cndmask_b32 v70, v50, v82, vcc
v_cndmask_b32 v71, v51, v83, vcc
v_cndmask_b32_dpp v48, v64, v48, vcc quad_perm:[1,0,3,2] row_mask:0xf bank_mask:0xf
v_cndmask_b32_dpp v49, v65, v49, vcc quad_perm:[1,0,3,2] row_mask:0xf bank_mask:0xf
v_cndmask_b32_dpp v50, v66, v50, vcc quad_perm:[1,0,3,2] row_mask:0xf bank_mask:0xf
v_cndmask_b32_dpp v51, v67, v51, vcc quad_perm:[1,0,3,2] row_mask:0xf bank_mask:0xf
s_not_b64 vcc, s[74:75]
v_cndmask_b32_dpp v80, v64, v80, vcc quad_perm:[1,0,3,2] row_mask:0xf bank_mask:0xf
v_cndmask_b32_dpp v81, v65, v81, vcc quad_perm:[1,0,3,2] row_mask:0xf bank_mask:0xf
v_cndmask_b32_dpp v82, v66, v82, vcc quad_perm:[1,0,3,2] row_mask:0xf bank_mask:0xf
v_cndmask_b32_dpp v83, v67, v83, vcc quad_perm:[1,0,3,2] row_mask:0xf bank_mask:0xf
buffer_store_dwordx4 v[48:51], v255, s[8:11], s69 offen sc1
buffer_store_dwordx4 v[68:71], v255, s[8:11], s69 offen offset:128 sc1
buffer_store_dwordx4 v[80:83], v255, s[8:11], s69 offen offset:256 sc1
v_cvt_pk_bf16_f32 v72, v72, v73
v_cvt_pk_bf16_f32 v73, v74, v75
v_cvt_pk_bf16_f32 v74, v76, v77
v_cvt_pk_bf16_f32 v75, v78, v79
v_cvt_pk_bf16_f32 v56, v56, v57
v_cvt_pk_bf16_f32 v57, v58, v59
v_cvt_pk_bf16_f32 v58, v60, v61
v_cvt_pk_bf16_f32 v59, v62, v63
v_cvt_pk_bf16_f32 v88, v88, v89
v_cvt_pk_bf16_f32 v89, v90, v91
v_cvt_pk_bf16_f32 v90, v92, v93
v_cvt_pk_bf16_f32 v91, v94, v95
s_mov_b64 vcc, s[74:75]
v_cndmask_b32 v76, v56, v88, vcc
v_cndmask_b32 v77, v57, v89, vcc
v_cndmask_b32 v78, v58, v90, vcc
v_cndmask_b32 v79, v59, v91, vcc
v_cndmask_b32_dpp v56, v72, v56, vcc quad_perm:[1,0,3,2] row_mask:0xf bank_mask:0xf
v_cndmask_b32_dpp v57, v73, v57, vcc quad_perm:[1,0,3,2] row_mask:0xf bank_mask:0xf
v_cndmask_b32_dpp v58, v74, v58, vcc quad_perm:[1,0,3,2] row_mask:0xf bank_mask:0xf
v_cndmask_b32_dpp v59, v75, v59, vcc quad_perm:[1,0,3,2] row_mask:0xf bank_mask:0xf
s_not_b64 vcc, s[74:75]
v_cndmask_b32_dpp v88, v72, v88, vcc quad_perm:[1,0,3,2] row_mask:0xf bank_mask:0xf
v_cndmask_b32_dpp v89, v73, v89, vcc quad_perm:[1,0,3,2] row_mask:0xf bank_mask:0xf
v_cndmask_b32_dpp v90, v74, v90, vcc quad_perm:[1,0,3,2] row_mask:0xf bank_mask:0xf
v_cndmask_b32_dpp v91, v75, v91, vcc quad_perm:[1,0,3,2] row_mask:0xf bank_mask:0xf
s_add_u32 s46, s69, 98304
buffer_store_dwordx4 v[56:59], v255, s[8:11], s46 offen sc1
s_add_u32 s46, s69, 98304
buffer_store_dwordx4 v[76:79], v255, s[8:11], s46 offen offset:128 sc1
s_add_u32 s46, s69, 98304
buffer_store_dwordx4 v[88:91], v255, s[8:11], s46 offen offset:256 sc1
s_endpgm
Lpoll:
s_waitcnt vmcnt(0)
Lpoll1:
s_cmp_eq_u32 s77, 2
s_cbranch_scc1 LpollC
v_max_u32 v255, v156, v157
v_max3_u32 v255, v255, v158, v159
v_max3_u32 v255, v255, v160, v161
v_max3_u32 v255, v255, v162, v163
v_max3_u32 v255, v255, v164, v165
v_max3_u32 v255, v255, v166, v167
v_max3_u32 v255, v255, v240, v241
v_max3_u32 v255, v255, v242, v243
v_cmp_eq_u32 vcc, -1, v255
s_nop 4
s_cbranch_vccz LpollR
v_lshlrev_b32 v247, 4, v251
s_lshl_b32 s44, s2, 12
buffer_load_dwordx4 v[156:159], v247, s[32:35], s44 offen sc1
buffer_load_dwordx4 v[160:163], v247, s[32:35], s44 offen offset:1024 sc1
buffer_load_dwordx4 v[164:167], v247, s[32:35], s44 offen offset:2048 sc1
buffer_load_dwordx4 v[240:243], v247, s[32:35], s44 offen offset:3072 sc1
s_setpc_b64 s[78:79]
LpollR:
s_setprio 3
v_add_f32 v156, v156, v160
v_add_f32 v240, v164, v240
v_add_f32 v240, v156, v240
v_add_f32 v157, v157, v161
v_add_f32 v241, v165, v241
v_add_f32 v241, v157, v241
v_add_f32 v158, v158, v162
v_add_f32 v242, v166, v242
v_add_f32 v242, v158, v242
v_add_f32 v159, v159, v163
v_add_f32 v243, v167, v243
v_add_f32 v243, v159, v243
v_add_f32_dpp v240, v240, v240 row_ror:8 row_mask:0xf bank_mask:0xf
s_nop 1
v_add_f32_dpp v240, v240, v240 row_ror:4 row_mask:0xf bank_mask:0xf
s_nop 1
v_add_f32_dpp v240, v240, v240 row_ror:2 row_mask:0xf bank_mask:0xf
s_nop 1
v_add_f32_dpp v240, v240, v240 row_ror:1 row_mask:0xf bank_mask:0xf
v_mov_b32 v255, v240
s_nop 1
v_permlane16_swap_b32 v240, v255
v_add_f32 v240, v240, v255
v_mov_b32 v255, v240
s_nop 1
v_permlane32_swap_b32 v240, v255
v_add_f32 v240, v240, v255
v_min_u32 v240, -2, v240
v_add_f32_dpp v241, v241, v241 row_ror:8 row_mask:0xf bank_mask:0xf
s_nop 1
v_add_f32_dpp v241, v241, v241 row_ror:4 row_mask:0xf bank_mask:0xf
s_nop 1
v_add_f32_dpp v241, v241, v241 row_ror:2 row_mask:0xf bank_mask:0xf
s_nop 1
v_add_f32_dpp v241, v241, v241 row_ror:1 row_mask:0xf bank_mask:0xf
v_mov_b32 v255, v241
s_nop 1
v_permlane16_swap_b32 v241, v255
v_add_f32 v241, v241, v255
v_mov_b32 v255, v241
s_nop 1
v_permlane32_swap_b32 v241, v255
v_add_f32 v241, v241, v255
v_min_u32 v241, -2, v241
v_add_f32_dpp v242, v242, v242 row_ror:8 row_mask:0xf bank_mask:0xf
s_nop 1
v_add_f32_dpp v242, v242, v242 row_ror:4 row_mask:0xf bank_mask:0xf
s_nop 1
v_add_f32_dpp v242, v242, v242 row_ror:2 row_mask:0xf bank_mask:0xf
s_nop 1
v_add_f32_dpp v242, v242, v242 row_ror:1 row_mask:0xf bank_mask:0xf
v_mov_b32 v255, v242
s_nop 1
v_permlane16_swap_b32 v242, v255
v_add_f32 v242, v242, v255
v_mov_b32 v255, v242
s_nop 1
v_permlane32_swap_b32 v242, v255
v_add_f32 v242, v242, v255
v_min_u32 v242, -2, v242
v_add_f32_dpp v243, v243, v243 row_ror:8 row_mask:0xf bank_mask:0xf
s_nop 1
v_add_f32_dpp v243, v243, v243 row_ror:4 row_mask:0xf bank_mask:0xf
s_nop 1
v_add_f32_dpp v243, v243, v243 row_ror:2 row_mask:0xf bank_mask:0xf
s_nop 1
v_add_f32_dpp v243, v243, v243 row_ror:1 row_mask:0xf bank_mask:0xf
v_mov_b32 v255, v243
s_nop 1
v_permlane16_swap_b32 v243, v255
v_add_f32 v243, v243, v255
v_mov_b32 v255, v243
s_nop 1
v_permlane32_swap_b32 v243, v255
v_add_f32_e64 v243, v243, v255
v_min_u32 v243, -2, v243
s_lshl_b32 s44, s2, 4
s_add_u32 s44, s44, 393216
v_lshlrev_b32_e64 v255, 11, v251
s_mov_b64 exec, 0xff
buffer_store_dwordx4 v[240:243], v255, s[32:35], s44 offen sc1
s_mov_b64 exec, -1
s_mov_b32 s77, 2
v_lshlrev_b32_e64 v247, 3, v251
s_and_b32 s44, s2, 7
s_lshl_b32 s44, s44, 11
s_add_u32 s44, s44, 393216
buffer_load_dwordx2 v[156:157], v247, s[32:35], s44 offen sc1
buffer_load_dwordx2 v[158:159], v247, s[32:35], s44 offen offset:512 sc1
buffer_load_dwordx2 v[160:161], v247, s[32:35], s44 offen offset:1024 sc1
s_setpc_b64 s[78:79]
LpollC:
v_max3_u32 v255, v156, v157, v158
v_max3_u32 v255, v255, v159, v160
v_max_u32 v255, v255, v161
v_cmp_eq_u32 vcc, -1, v255
s_nop 4
s_cbranch_vccz LpollS
v_lshlrev_b32 v247, 3, v251
s_and_b32 s44, s2, 7
s_lshl_b32 s44, s44, 11
s_add_u32 s44, s44, 393216
buffer_load_dwordx2 v[156:157], v247, s[32:35], s44 offen sc1
buffer_load_dwordx2 v[158:159], v247, s[32:35], s44 offen offset:512 sc1
buffer_load_dwordx2 v[160:161], v247, s[32:35], s44 offen offset:1024 sc1
s_setpc_b64 s[78:79]
LpollS:
s_setprio 3
s_mov_b32 s43, 1083296634
v_mov_b32 v162, 897988541
v_fma_f32 v156, v156, s43, v162
v_fma_f32 v157, v157, s43, v162
v_fma_f32 v158, v158, s43, v162
v_fma_f32 v159, v159, s43, v162
v_fma_f32 v160, v160, s43, v162
v_fma_f32 v161, v161, s43, v162
v_sqrt_f32 v156, v156
v_sqrt_f32 v157, v157
v_sqrt_f32 v158, v158
v_sqrt_f32 v159, v159
v_sqrt_f32 v160, v160
v_sqrt_f32 v161, v161
v_add_f32 v163, v156, v157
v_add_f32 v163, v163, v158
v_add_f32 v163, v163, v159
v_add_f32 v163, v163, v160
v_add_f32 v163, v163, v161
s_nop 1
v_add_f32_dpp v163, v163, v163 row_ror:8 row_mask:0xf bank_mask:0xf
s_nop 1
v_add_f32_dpp v163, v163, v163 row_ror:4 row_mask:0xf bank_mask:0xf
s_nop 1
v_add_f32_dpp v163, v163, v163 row_ror:2 row_mask:0xf bank_mask:0xf
s_nop 1
v_add_f32_dpp v163, v163, v163 row_ror:1 row_mask:0xf bank_mask:0xf
v_mov_b32 v255, v163
s_nop 1
v_permlane16_swap_b32 v163, v255
v_add_f32 v163, v163, v255
v_mov_b32 v255, v163
s_nop 1
v_permlane32_swap_b32 v163, v255
v_add_f32_e64 v163, v163, v255
s_mov_b32 s43, 992651947
v_fma_f32 v163, v163, s43, v162
v_rcp_f32_e64 v163, v163
v_mov_b32 v162, 3221789604
v_mul_f32 v163, v163, v162
v_lshlrev_b32 v164, 16, v244
v_and_b32 v165, 4294901760, v244
v_mul_f32 v156, v156, v163
v_mul_f32 v157, v157, v163
v_fma_f32 v164, v164, v156, v162
v_fma_f32 v165, v165, v157, v162
v_cvt_pk_f16_f32 v244, v164, v165
v_lshlrev_b32_e64 v164, 16, v245
v_and_b32 v165, 4294901760, v245
v_mul_f32 v158, v158, v163
v_mul_f32 v159, v159, v163
v_fma_f32 v164, v164, v158, v162
v_fma_f32 v165, v165, v159, v162
v_cvt_pk_f16_f32 v245, v164, v165
v_lshlrev_b32_e64 v164, 16, v246
v_and_b32 v165, 4294901760, v246
v_mul_f32 v160, v160, v163
v_mul_f32 v161, v161, v163
v_fma_f32 v164, v164, v160, v162
v_fma_f32 v165, v165, v161, v162
v_cvt_pk_f16_f32 v246, v164, v165
s_mov_b32 s77, 0
s_setpc_b64 s[78:79]
Lend:
s_endpgm

.section .rodata,"a"
.p2align 6
.amdhsa_kernel standalone__modern_conv_block_convnext_v2__vision_kernel
  .amdhsa_next_free_vgpr 256
  .amdhsa_next_free_sgpr 102
  .amdhsa_accum_offset 256
  .amdhsa_group_segment_fixed_size 0
  .amdhsa_kernarg_size 72
  .amdhsa_user_sgpr_count 2
  .amdhsa_user_sgpr_kernarg_segment_ptr 1
  .amdhsa_system_sgpr_workgroup_id_x 1
.end_amdhsa_kernel
```

```asm
; @launch grid=(256,1,1) block=(512,1,1) lds=163840
.amdgcn_target "amdgcn-amd-amdhsa--gfx950"
.text
.globl standalone__modern_conv_block_convnext_v2__vision_kernel
.p2align 8
.type standalone__modern_conv_block_convnext_v2__vision_kernel,@function
standalone__modern_conv_block_convnext_v2__vision_kernel:
Lmain:
s_cmp_ge_u32 s2, 256
s_cbranch_scc1 Lend
s_load_dwordx16 s[80:95], s[0:1], 0
s_load_dwordx2 s[96:97], s[0:1], 64
s_getpc_b64 s[74:75]
Lpc0:
s_sub_u32 s74, s74, Lpc0-Lmain
s_subb_u32 s75, s75, 0
v_lshlrev_b32 v159, 7, v0
s_movk_i32 s43, 64
v_cmp_gt_u32 vcc, s43, v0
s_and_saveexec_b64 s[78:79], vcc
s_cbranch_execz Lpf0x
global_load_dword v255, v159, s[74:75]
Lpf0x:
s_mov_b64 exec, s[78:79]
v_mov_b32 v199, v0
v_and_b32 v251, 63, v0
v_lshrrev_b32 v120, 6, v0
s_nop 0
v_readfirstlane_b32 s40, v120
s_and_b32 s43, s2, 7
s_lshr_b32 s44, s2, 3
s_and_b32 s41, s43, 0
s_lshl_b32 s41, s41, 4
s_and_b32 s45, s44, 15
s_add_u32 s41, s41, s45
s_lshr_b32 s42, s43, 0
s_lshl_b32 s42, s42, 1
s_lshr_b32 s45, s44, 4
s_add_u32 s42, s42, s45
s_lshl_b32 s41, s41, 5
s_lshl_b32 s42, s42, 5
s_lshl_b32 s67, s40, 6
s_cmp_eq_u32 s40, 6
s_cselect_b32 s67, 352, s67
v_add_u32_e64 v125, s67, v251
v_mul_u32_u24 v121, 5462, v125
v_lshrrev_b32 v121, 16, v121
v_mul_u32_u24 v122, 12, v121
v_sub_u32 v122, v125, v122
v_bfe_u32 v123, v121, 2, 2
v_xor_b32 v122, v122, v123
v_add_u32 v123, s41, v121
v_subrev_u32 v123, 1, v123
v_mul_u32_u24 v124, 192, v123
v_lshl_add_u32 v124, v122, 4, v124
v_mov_b32 v240, 2147483648
s_movk_i32 s43, 512
v_cmp_gt_u32 vcc, s43, v123
s_nop 1
v_cndmask_b32 v124, v240, v124, vcc
v_cmp_gt_u32 vcc, 34, v121
s_nop 1
v_cndmask_b32 v240, v240, v124, vcc
s_add_i32 s43, s42, -1
s_mul_i32 s44, s43, 98304
s_cmp_lt_u32 s43, 512
s_cselect_b32 s46, s44, 1073741824
s_mul_i32 s66, s42, 98304
s_mov_b32 s6, 50331648
s_mov_b32 s7, 131072
s_lshl_b32 s67, s67, 4
s_add_u32 s67, s67, 90112
s_cmp_eq_u32 s40, 7
s_cselect_b32 s67, 163840, s67
v_lshlrev_b32 v130, 1, v199
v_add_u32 v155, 768, v199
v_min_u32 v155, 863, v155
v_lshlrev_b32_e64 v131, 1, v155
s_waitcnt lgkmcnt(0)
s_mov_b32 s4, s80
s_and_b32 s5, s81, 65535
s_cmp_ge_u32 s40, 4
s_cbranch_scc1 Lnodw
s_mov_b32 s20, s82
s_and_b32 s21, s83, 65535
s_mov_b32 s22, 1728
s_mov_b32 s23, 131072
buffer_load_ushort v126, v130, s[20:23], 0 offen offset:0
buffer_load_ushort v127, v130, s[20:23], 0 offen offset:512
buffer_load_ushort v128, v130, s[20:23], 0 offen offset:1024
buffer_load_ushort v129, v131, s[20:23], 0 offen offset:0
Lnodw:
s_cmp_eq_u32 s40, 7
s_cbranch_scc1 Lskipx0
s_add_u32 m0, s67, 0
s_nop 0
buffer_load_dwordx4 v240, s[4:7], s46 offen nt lds
s_add_u32 m0, s67, 6656
s_nop 0
buffer_load_dwordx4 v240, s[4:7], s66 offen nt lds
s_add_u32 m0, s67, 13312
s_add_u32 s45, s66, 98304
buffer_load_dwordx4 v240, s[4:7], s45 offen nt lds
s_add_u32 m0, s67, 19968
s_add_u32 s45, s66, 196608
buffer_load_dwordx4 v240, s[4:7], s45 offen nt lds
s_add_u32 m0, s67, 26624
s_add_u32 s45, s66, 294912
buffer_load_dwordx4 v240, s[4:7], s45 offen nt lds
s_add_u32 m0, s67, 33280
s_add_u32 s45, s66, 393216
buffer_load_dwordx4 v240, s[4:7], s45 offen nt lds
Lskipx0:
s_mov_b32 s12, s84
s_and_b32 s13, s85, 65535
s_mov_b32 s14, 73728
s_mov_b32 s15, 131072
v_lshrrev_b32 v189, 2, v251
v_mul_u32_u24 v189, 768, v189
v_and_b32_e64 v125, 3, v251
v_lshl_add_u32 v189, v125, 4, v189
s_and_b32 s43, s40, 3
s_lshl_b32 s3, s43, 6
s_mul_i32 s77, s43, 6144
s_add_u32 s77, s77, 16384
v_mov_b32 v253, 16256
v_mov_b32 v254, 1
s_add_u32 s43, s42, s40
s_add_u32 s43, s43, 1
s_lshl_b32 s43, s43, 9
s_add_u32 s43, s43, s41
s_mul_i32 s47, s43, 192
s_sub_u32 s47, s47, 256
s_and_b32 s43, s40, 1
s_lshl_b32 s46, s43, 4
s_add_u32 s41, s41, s46
s_and_b32 s43, s40, 6
s_add_u32 s42, s42, s43
s_mul_i32 s45, s43, 6656
s_add_u32 s45, s45, 90112
v_and_b32 v131, 15, v251
v_lshrrev_b32 v132, 4, v251
v_mul_u32_u24 v122, 6656, v132
v_add_u32 v122, s45, v122
v_add_u32 v121, s46, v131
v_mul_u32_u24 v123, 192, v121
v_bfe_u32 v124, v121, 2, 2
v_lshl_add_u32 v123, v124, 4, v123
v_add_u32 v242, v122, v123
v_add_u32 v121, 1, v121
v_mul_u32_u24 v123, 192, v121
v_bfe_u32 v124, v121, 2, 2
v_lshl_add_u32 v123, v124, 4, v123
v_add_u32 v243, v122, v123
v_add_u32 v121, 1, v121
v_mul_u32_u24 v123, 192, v121
v_bfe_u32 v124, v121, 2, 2
v_lshl_add_u32 v123, v124, 4, v123
v_add_u32_e64 v244, v122, v123
s_mul_i32 s72, s40, 9216
s_add_u32 s72, s72, 90112
v_bfe_u32 v133, v131, 2, 1
v_sub_u32 v133, v132, v133
v_lshrrev_b32 v134, 3, v131
v_and_b32_e64 v135, 3, v131
v_lshl_add_u32 v135, v134, 2, v135
v_lshlrev_b32_e64 v136, 7, v133
v_lshl_add_u32 v136, v135, 4, v136
v_add_u32 v136, 156672, v136
v_mov_b32 v135, 163840
v_cmp_gt_u32 vcc, 3, v133
s_nop 1
v_cndmask_b32 v245, v135, v136, vcc
v_and_b32 v135, 3, v131
v_mul_u32_u24 v246, 85, v135
s_mov_b32 s16, s86
s_and_b32 s17, s87, 65535
s_mov_b32 s18, 73728
s_mov_b32 s19, 131072
s_mov_b32 s24, s88
s_and_b32 s25, s89, 65535
s_mov_b32 s26, 768
s_mov_b32 s27, 131072
s_mov_b32 s28, s90
s_and_b32 s29, s91, 65535
s_mov_b32 s30, 768
s_mov_b32 s31, 131072
s_mov_b32 s8, s92
s_and_b32 s9, s93, 65535
s_mov_b32 s10, 50331648
s_mov_b32 s11, 131072
s_mov_b32 s36, s94
s_and_b32 s37, s95, 65535
s_mov_b32 s38, 256
s_mov_b32 s39, 131072
s_mov_b32 s32, s96
s_and_b32 s33, s97, 65535
s_mov_b32 s34, 83886080
s_mov_b32 s35, 131072
v_lshlrev_b32 v241, 4, v251
v_and_b32 v133, 35, v251
v_bfe_u32 v134, v251, 2, 2
v_lshl_add_u32 v133, v134, 3, v133
v_bfe_u32 v134, v251, 4, 1
v_lshl_add_u32 v133, v134, 2, v133
v_lshlrev_b32_e64 v248, 4, v133
v_add_u32 v249, 65536, v248
v_add_u32 v250, 131072, v248
s_lshl_b32 s73, s2, 3
s_add_u32 s73, s73, s40
s_lshl_b32 s80, s73, 10
s_add_u32 s80, s80, 4194304
s_mul_i32 s73, s73, 16
s_add_u32 s73, s73, 1048576
s_mul_i32 s46, s41, 192
s_add_u32 s43, s42, 0
s_mul_i32 s43, s43, 98304
s_add_u32 s68, s43, s46
s_add_u32 s43, s42, 8
s_mul_i32 s43, s43, 98304
s_add_u32 s69, s43, s46
s_add_u32 s43, s42, 16
s_mul_i32 s43, s43, 98304
s_add_u32 s70, s43, s46
s_add_u32 s43, s42, 24
s_mul_i32 s43, s43, 98304
s_add_u32 s71, s43, s46
s_mul_i32 s82, s40, 9216
s_mov_b32 s48, 1156203754
s_mov_b32 s49, 4294508536
s_mov_b32 s76, 400000
v_lshrrev_b32 v148, 5, v251
v_lshlrev_b32 v190, 8, v148
v_bfe_u32 v148, v251, 2, 2
v_lshl_add_u32 v190, v148, 6, v190
v_bfe_u32 v148, v251, 4, 1
v_lshl_add_u32 v190, v148, 5, v190
v_bfe_u32 v148, v251, 0, 1
v_lshl_add_u32 v190, v148, 4, v190
v_bfe_u32 v148, v251, 1, 1
v_lshl_add_u32 v190, v148, 3, v190
v_add_u32 v190, s77, v190
v_add_u32 v191, s77, v248
s_cmp_lt_u32 s40, 4
s_cbranch_scc1 Lnoy
v_lshlrev_b32_e64 v24, 6, v199
s_mov_b32 s43, 1065362610
v_mov_b32 v25, 1084047360
v_add_u32 v0, 32772, v24
v_add_u32 v1, 32780, v24
v_add_u32 v2, 32788, v24
v_add_u32 v3, 32796, v24
v_add_u32 v4, 32804, v24
v_add_u32 v5, 32812, v24
v_add_u32 v6, 32820, v24
v_add_u32 v7, 32828, v24
v_cvt_f32_f16 v0, v0
v_cvt_f32_f16 v1, v1
v_cvt_f32_f16 v2, v2
v_cvt_f32_f16 v3, v3
v_cvt_f32_f16 v4, v4
v_cvt_f32_f16 v5, v5
v_cvt_f32_f16 v6, v6
v_cvt_f32_f16 v7, v7
v_mul_f32 v8, v0, v0
v_mul_f32 v9, v1, v1
v_mul_f32 v10, v2, v2
v_mul_f32 v11, v3, v3
v_mul_f32 v12, v4, v4
v_mul_f32 v13, v5, v5
v_mul_f32 v14, v6, v6
v_mul_f32 v15, v7, v7
v_fma_f32 v8, v8, s43, v25
v_fma_f32 v9, v9, s43, v25
v_fma_f32 v10, v10, s43, v25
v_fma_f32 v11, v11, s43, v25
v_fma_f32 v12, v12, s43, v25
v_fma_f32 v13, v13, s43, v25
v_fma_f32 v14, v14, s43, v25
v_fma_f32 v15, v15, s43, v25
v_mul_f32 v8, v0, v8
v_mul_f32 v9, v1, v9
v_mul_f32 v10, v2, v10
v_mul_f32 v11, v3, v11
v_mul_f32 v12, v4, v12
v_mul_f32 v13, v5, v13
v_mul_f32 v14, v6, v14
v_mul_f32 v15, v7, v15
v_exp_f32 v8, v8
v_exp_f32 v9, v9
v_exp_f32 v10, v10
v_exp_f32 v11, v11
v_exp_f32 v12, v12
v_exp_f32 v13, v13
v_exp_f32 v14, v14
v_exp_f32 v15, v15
v_add_f32 v16, 1.0, v8
v_add_f32 v17, 1.0, v9
v_add_f32 v18, 1.0, v10
v_add_f32 v19, 1.0, v11
v_add_f32 v20, 1.0, v12
v_add_f32 v21, 1.0, v13
v_add_f32 v22, 1.0, v14
v_add_f32 v23, 1.0, v15
v_rcp_f32 v16, v16
v_rcp_f32 v17, v17
v_rcp_f32 v18, v18
v_rcp_f32 v19, v19
v_rcp_f32 v20, v20
v_rcp_f32 v21, v21
v_rcp_f32 v22, v22
v_rcp_f32 v23, v23
v_mul_f32 v0, v0, v16
v_mul_f32 v1, v1, v17
v_mul_f32 v2, v2, v18
v_mul_f32 v3, v3, v19
v_mul_f32 v4, v4, v20
v_mul_f32 v5, v5, v21
v_mul_f32 v6, v6, v22
v_mul_f32 v7, v7, v23
v_mul_f32 v8, v8, v0
v_mul_f32 v9, v9, v1
v_mul_f32 v10, v10, v2
v_mul_f32 v11, v11, v3
v_mul_f32 v12, v12, v4
v_mul_f32 v13, v13, v5
v_mul_f32 v14, v14, v6
v_mul_f32 v15, v15, v7
v_cvt_pk_f16_f32 v28, v0, v1
v_cvt_pk_f16_f32 v32, -v8, -v9
v_cvt_pk_f16_f32 v29, v2, v3
v_cvt_pk_f16_f32 v33, -v10, -v11
v_cvt_pk_f16_f32 v30, v4, v5
v_cvt_pk_f16_f32 v34, -v12, -v13
v_cvt_pk_f16_f32 v31, v6, v7
v_cvt_pk_f16_f32 v35, -v14, -v15
v_lshlrev_b32_e64 v24, 4, v199
v_mov_b32 v25, 163840
s_movk_i32 s43, 496
v_cmp_gt_u32 vcc, s43, v199
s_nop 1
v_cndmask_b32 v24, v25, v24, vcc
ds_write_b128 v24, v[32:35]
ds_write_b128 v24, v[28:31] offset:8192
Lnoy:
s_cmp_ge_u32 s40, 4
s_cbranch_scc1 Lnoo
v_add_u32_e64 v152, 0, v199
v_mul_u32_u24 v140, 683, v152
v_lshrrev_b32 v140, 16, v140
v_mul_u32_u24 v142, 11, v140
v_lshrrev_b32 v142, 5, v142
v_lshrrev_b32 v143, 5, v152
v_bfe_u32 v141, v152, 3, 2
v_bfe_u32 v144, v152, 4, 1
v_xor_b32 v141, v141, v144
v_sub_u32 v141, v141, v142
v_mul_i32_i24 v141, 9, v141
v_add_u32 v143, v143, v141
v_lshrrev_b32_e64 v141, 1, v143
v_mul_u32_u24 v141, 368, v141
v_lshl_add_u32 v143, v143, 3, v141
v_lshl_add_u32 v143, v142, 7, v143
v_and_b32_e64 v144, 7, v152
v_lshl_add_u32 v143, v144, 4, v143
v_add_u32 v156, 156672, v143
v_add_u32 v153, 256, v199
v_mul_u32_u24 v140, 683, v153
v_lshrrev_b32 v140, 16, v140
v_mul_u32_u24 v142, 11, v140
v_lshrrev_b32 v142, 5, v142
v_lshrrev_b32 v143, 5, v153
v_bfe_u32 v141, v153, 3, 2
v_bfe_u32 v144, v153, 4, 1
v_xor_b32 v141, v141, v144
v_sub_u32 v141, v141, v142
v_mul_i32_i24 v141, 9, v141
v_add_u32 v143, v143, v141
v_lshrrev_b32_e64 v141, 1, v143
v_mul_u32_u24 v141, 368, v141
v_lshl_add_u32 v143, v143, 3, v141
v_lshl_add_u32 v143, v142, 7, v143
v_and_b32_e64 v144, 7, v153
v_lshl_add_u32 v143, v144, 4, v143
v_add_u32 v157, 156672, v143
v_add_u32 v154, 512, v199
v_mul_u32_u24 v140, 683, v154
v_lshrrev_b32 v140, 16, v140
v_mul_u32_u24 v142, 11, v140
v_lshrrev_b32 v142, 5, v142
v_lshrrev_b32 v143, 5, v154
v_bfe_u32 v141, v154, 3, 2
v_bfe_u32 v144, v154, 4, 1
v_xor_b32 v141, v141, v144
v_sub_u32 v141, v141, v142
v_mul_i32_i24 v141, 9, v141
v_add_u32 v143, v143, v141
v_lshrrev_b32_e64 v141, 1, v143
v_mul_u32_u24 v141, 368, v141
v_lshl_add_u32 v143, v143, 3, v141
v_lshl_add_u32 v143, v142, 7, v143
v_and_b32_e64 v144, 7, v154
v_lshl_add_u32 v143, v144, 4, v143
v_add_u32 v158, 156672, v143
v_mul_u32_u24 v140, 683, v155
v_lshrrev_b32 v140, 16, v140
v_mul_u32_u24 v142, 11, v140
v_lshrrev_b32 v142, 5, v142
v_lshrrev_b32 v143, 5, v155
v_bfe_u32 v141, v155, 3, 2
v_bfe_u32 v144, v155, 4, 1
v_xor_b32 v141, v141, v144
v_sub_u32 v141, v141, v142
v_mul_i32_i24 v141, 9, v141
v_add_u32 v143, v143, v141
v_lshrrev_b32_e64 v141, 1, v143
v_mul_u32_u24 v141, 368, v141
v_lshl_add_u32 v143, v143, 3, v141
v_lshl_add_u32 v143, v142, 7, v143
v_and_b32_e64 v144, 7, v155
v_lshl_add_u32 v143, v144, 4, v143
v_add_u32 v159, 156672, v143
v_mov_b32 v160, 0
v_mov_b32 v161, 0
v_mov_b32_e64 v162, 0
v_mov_b32 v163, 0
s_mov_b64 exec, 1
ds_write_b128 v253, v[160:163]
ds_write_b128 v253, v[160:163] offset:16
s_mov_b64 exec, -1
s_waitcnt vmcnt(6)
v_and_b32_e64 v130, 4, v152
v_cmp_eq_u32 vcc, 0, v130
s_nop 1
v_cndmask_b32 v164, 0, v126, vcc
v_sub_u32 v165, v126, v164
ds_write_b64 v156, v[164:165]
v_and_b32_e64 v130, 4, v153
v_cmp_eq_u32 vcc, 0, v130
s_nop 1
v_cndmask_b32 v166, 0, v127, vcc
v_sub_u32 v167, v127, v166
ds_write_b64 v157, v[166:167]
v_and_b32_e64 v130, 4, v154
v_cmp_eq_u32 vcc, 0, v130
s_nop 1
v_cndmask_b32 v168, 0, v128, vcc
v_sub_u32 v169, v128, v168
ds_write_b64 v158, v[168:169]
v_and_b32_e64 v130, 4, v155
v_cmp_eq_u32 vcc, 0, v130
s_nop 1
v_cndmask_b32 v170, 0, v129, vcc
v_sub_u32 v171, v129, v170
ds_write_b64 v159, v[170:171]
s_waitcnt lgkmcnt(0)
Lnoo:
s_barrier
s_cmp_lt_u32 s40, 4
s_cbranch_scc1 Lnoy2
v_subrev_u32 v199, 256, v199
v_lshlrev_b32_e64 v24, 6, v199
s_mov_b32 s43, 1065362610
v_mov_b32 v25, 1084047360
v_add_u32 v0, 32772, v24
v_add_u32 v1, 32780, v24
v_add_u32 v2, 32788, v24
v_add_u32 v3, 32796, v24
v_add_u32 v4, 32804, v24
v_add_u32 v5, 32812, v24
v_add_u32 v6, 32820, v24
v_add_u32 v7, 32828, v24
v_cvt_f32_f16 v0, v0
v_cvt_f32_f16 v1, v1
v_cvt_f32_f16 v2, v2
v_cvt_f32_f16 v3, v3
v_cvt_f32_f16 v4, v4
v_cvt_f32_f16 v5, v5
v_cvt_f32_f16 v6, v6
v_cvt_f32_f16 v7, v7
v_mul_f32 v8, v0, v0
v_mul_f32 v9, v1, v1
v_mul_f32 v10, v2, v2
v_mul_f32 v11, v3, v3
v_mul_f32 v12, v4, v4
v_mul_f32 v13, v5, v5
v_mul_f32 v14, v6, v6
v_mul_f32 v15, v7, v7
v_fma_f32 v8, v8, s43, v25
v_fma_f32 v9, v9, s43, v25
v_fma_f32 v10, v10, s43, v25
v_fma_f32 v11, v11, s43, v25
v_fma_f32 v12, v12, s43, v25
v_fma_f32 v13, v13, s43, v25
v_fma_f32 v14, v14, s43, v25
v_fma_f32 v15, v15, s43, v25
v_mul_f32 v8, v0, v8
v_mul_f32 v9, v1, v9
v_mul_f32 v10, v2, v10
v_mul_f32 v11, v3, v11
v_mul_f32 v12, v4, v12
v_mul_f32 v13, v5, v13
v_mul_f32 v14, v6, v14
v_mul_f32 v15, v7, v15
v_exp_f32 v8, v8
v_exp_f32 v9, v9
v_exp_f32 v10, v10
v_exp_f32 v11, v11
v_exp_f32 v12, v12
v_exp_f32 v13, v13
v_exp_f32 v14, v14
v_exp_f32 v15, v15
v_add_f32 v16, 1.0, v8
v_add_f32 v17, 1.0, v9
v_add_f32 v18, 1.0, v10
v_add_f32 v19, 1.0, v11
v_add_f32 v20, 1.0, v12
v_add_f32 v21, 1.0, v13
v_add_f32 v22, 1.0, v14
v_add_f32 v23, 1.0, v15
v_rcp_f32 v16, v16
v_rcp_f32 v17, v17
v_rcp_f32 v18, v18
v_rcp_f32 v19, v19
v_rcp_f32 v20, v20
v_rcp_f32 v21, v21
v_rcp_f32 v22, v22
v_rcp_f32 v23, v23
v_mul_f32 v0, v0, v16
v_mul_f32 v1, v1, v17
v_mul_f32 v2, v2, v18
v_mul_f32 v3, v3, v19
v_mul_f32 v4, v4, v20
v_mul_f32 v5, v5, v21
v_mul_f32 v6, v6, v22
v_mul_f32 v7, v7, v23
v_mul_f32 v8, v8, v0
v_mul_f32 v9, v9, v1
v_mul_f32 v10, v10, v2
v_mul_f32 v11, v11, v3
v_mul_f32 v12, v12, v4
v_mul_f32 v13, v13, v5
v_mul_f32 v14, v14, v6
v_mul_f32 v15, v15, v7
v_cvt_pk_f16_f32 v28, v0, v1
v_cvt_pk_f16_f32 v32, -v8, -v9
v_cvt_pk_f16_f32 v29, v2, v3
v_cvt_pk_f16_f32 v33, -v10, -v11
v_cvt_pk_f16_f32 v30, v4, v5
v_cvt_pk_f16_f32 v34, -v12, -v13
v_cvt_pk_f16_f32 v31, v6, v7
v_cvt_pk_f16_f32 v35, -v14, -v15
v_lshlrev_b32_e64 v24, 4, v199
v_mov_b32 v25, 163840
s_movk_i32 s43, 496
v_cmp_gt_u32 vcc, s43, v199
s_nop 1
v_cndmask_b32 v24, v25, v24, vcc
ds_write_b128 v24, v[32:35]
ds_write_b128 v24, v[28:31] offset:8192
Lnoy2:
s_setprio 2
s_cmp_lt_u32 s40, 4
s_cbranch_scc0 Lsu0
s_call_b64 s[78:79], Lpre
s_call_b64 s[78:79], Lrb
s_waitcnt vmcnt(4)
s_mov_b64 exec, 1
ds_add_u32 v253, v254 offset:28
s_mov_b64 exec, -1
v_mov_b32 v253, 16256
Lsw288w:
ds_read_b32 v247, v253 offset:28
s_waitcnt lgkmcnt(0)
v_readfirstlane_b32 s43, v247
s_cmp_eq_u32 s76, 0
s_cbranch_scc1 Lsw288x
s_sub_u32 s76, s76, 1
s_cmp_lt_u32 s43, 8
s_cbranch_scc0 Lsw288x
s_sleep 2
s_branch Lsw288w
Lsw288x:
s_call_b64 s[78:79], Lconv0
s_mov_b64 exec, 1
ds_add_u32 v253, v254 offset:16
s_mov_b64 exec, -1
s_call_b64 s[78:79], Lln0
s_waitcnt vmcnt(0)
s_mov_b64 exec, 1
ds_add_u32 v253, v254 offset:12
s_mov_b64 exec, -1
s_call_b64 s[78:79], Lw1i
Lsu0:
s_cmp_ge_u32 s40, 4
s_cbranch_scc0 Lsu2
s_setprio 3
s_call_b64 s[78:79], Lw1f
s_waitcnt vmcnt(6)
s_mov_b64 exec, 1
ds_add_u32 v253, v254 offset:28
s_mov_b64 exec, -1
s_call_b64 s[78:79], Lrb
s_waitcnt vmcnt(4)
s_call_b64 s[78:79], Lw1a
s_mov_b64 exec, 1
ds_add_u32 v253, v254 offset:20
s_mov_b64 exec, -1
s_call_b64 s[78:79], Lpre
s_waitcnt vmcnt(0)
s_mov_b64 exec, 1
ds_add_u32 v253, v254 offset:12
s_mov_b64 exec, -1
v_mov_b32 v253, 16256
Lsw128w:
ds_read_b32 v247, v253 offset:12
s_waitcnt lgkmcnt(0)
v_readfirstlane_b32 s43, v247
s_cmp_eq_u32 s76, 0
s_cbranch_scc1 Lsw128x
s_sub_u32 s76, s76, 1
s_cmp_lt_u32 s43, 8
s_cbranch_scc0 Lsw128x
s_sleep 2
s_branch Lsw128w
Lsw128x:
s_call_b64 s[78:79], Lconv0
s_mov_b64 exec, 1
ds_add_u32 v253, v254 offset:16
s_mov_b64 exec, -1
s_call_b64 s[78:79], Lln0
Lsu2:
s_branch Lgo
Lconv0:
ds_read_b128 v[192:195], v242
ds_read_b128 v[196:199], v242 offset:64
ds_read_b128 v[200:203], v242 offset:128
ds_read_b128 v[204:207], v243
ds_read_b128 v[208:211], v243 offset:64
ds_read_b128 v[212:215], v243 offset:128
ds_read_b128 v[224:227], v244
ds_read_b128 v[228:231], v244 offset:64
ds_read_b128 v[232:235], v244 offset:128
v_xor_b32 v242, 16, v242
ds_read_b128 v[236:239], v242
ds_read_b128 v[216:219], v242 offset:64
ds_read_b128 v[220:223], v242 offset:128
s_waitcnt lgkmcnt(11)
v_smfmac_f32_16x16x32_bf16 v[0:3], v[48:49], v[192:195], v246
s_waitcnt lgkmcnt(10)
v_smfmac_f32_16x16x32_bf16 v[16:19], v[50:51], v[196:199], v246
s_waitcnt lgkmcnt(9)
v_smfmac_f32_16x16x32_bf16 v[32:35], v[52:53], v[200:203], v246
s_waitcnt lgkmcnt(8)
v_xor_b32 v243, 16, v243
ds_read_b128 v[192:195], v243
ds_read_b128 v[196:199], v243 offset:64
v_smfmac_f32_16x16x32_bf16 v[0:3], v[54:55], v[204:207], v246
s_waitcnt lgkmcnt(9)
v_smfmac_f32_16x16x32_bf16 v[16:19], v[56:57], v[208:211], v246
s_waitcnt lgkmcnt(8)
ds_read_b128 v[200:203], v243 offset:128
v_xor_b32 v244, 16, v244
ds_read_b128 v[204:207], v244
v_smfmac_f32_16x16x32_bf16 v[32:35], v[58:59], v[212:215], v246
s_waitcnt lgkmcnt(9)
v_smfmac_f32_16x16x32_bf16 v[0:3], v[60:61], v[224:227], v246
s_waitcnt lgkmcnt(8)
ds_read_b128 v[208:211], v244 offset:64
ds_read_b128 v[212:215], v244 offset:128
v_smfmac_f32_16x16x32_bf16 v[16:19], v[62:63], v[228:231], v246
s_waitcnt lgkmcnt(9)
v_smfmac_f32_16x16x32_bf16 v[32:35], v[64:65], v[232:235], v246
s_waitcnt lgkmcnt(8)
v_xor_b32 v242, 32, v242
ds_read_b128 v[224:227], v242
ds_read_b128 v[228:231], v242 offset:64
v_smfmac_f32_16x16x32_bf16 v[4:7], v[66:67], v[236:239], v246
s_waitcnt lgkmcnt(9)
v_smfmac_f32_16x16x32_bf16 v[20:23], v[68:69], v[216:219], v246
s_waitcnt lgkmcnt(8)
ds_read_b128 v[232:235], v242 offset:128
v_xor_b32 v243, 32, v243
ds_read_b128 v[236:239], v243
v_smfmac_f32_16x16x32_bf16 v[36:39], v[70:71], v[220:223], v246
s_waitcnt lgkmcnt(9)
v_smfmac_f32_16x16x32_bf16 v[4:7], v[72:73], v[192:195], v246
s_waitcnt lgkmcnt(8)
ds_read_b128 v[216:219], v243 offset:64
ds_read_b128 v[220:223], v243 offset:128
v_smfmac_f32_16x16x32_bf16 v[20:23], v[74:75], v[196:199], v246
s_waitcnt lgkmcnt(9)
v_smfmac_f32_16x16x32_bf16 v[36:39], v[76:77], v[200:203], v246
s_waitcnt lgkmcnt(8)
v_xor_b32 v244, 32, v244
ds_read_b128 v[192:195], v244
ds_read_b128 v[196:199], v244 offset:64
v_smfmac_f32_16x16x32_bf16 v[4:7], v[78:79], v[204:207], v246
s_waitcnt lgkmcnt(9)
v_smfmac_f32_16x16x32_bf16 v[20:23], v[80:81], v[208:211], v246
s_waitcnt lgkmcnt(8)
ds_read_b128 v[200:203], v244 offset:128
v_xor_b32 v242, 16, v242
ds_read_b128 v[204:207], v242
v_smfmac_f32_16x16x32_bf16 v[36:39], v[82:83], v[212:215], v246
s_waitcnt lgkmcnt(9)
v_smfmac_f32_16x16x32_bf16 v[12:15], v[84:85], v[224:227], v246
s_waitcnt lgkmcnt(8)
ds_read_b128 v[208:211], v242 offset:64
ds_read_b128 v[212:215], v242 offset:128
v_smfmac_f32_16x16x32_bf16 v[28:31], v[86:87], v[228:231], v246
s_waitcnt lgkmcnt(9)
v_smfmac_f32_16x16x32_bf16 v[44:47], v[88:89], v[232:235], v246
s_waitcnt lgkmcnt(8)
v_xor_b32 v243, 16, v243
ds_read_b128 v[224:227], v243
ds_read_b128 v[228:231], v243 offset:64
v_smfmac_f32_16x16x32_bf16 v[12:15], v[90:91], v[236:239], v246
s_waitcnt lgkmcnt(9)
v_smfmac_f32_16x16x32_bf16 v[28:31], v[92:93], v[216:219], v246
s_waitcnt lgkmcnt(8)
ds_read_b128 v[232:235], v243 offset:128
v_xor_b32 v244, 16, v244
ds_read_b128 v[236:239], v244
v_smfmac_f32_16x16x32_bf16 v[44:47], v[94:95], v[220:223], v246
s_waitcnt lgkmcnt(9)
v_smfmac_f32_16x16x32_bf16 v[12:15], v[96:97], v[192:195], v246
s_waitcnt lgkmcnt(8)
ds_read_b128 v[216:219], v244 offset:64
ds_read_b128 v[220:223], v244 offset:128
v_smfmac_f32_16x16x32_bf16 v[28:31], v[98:99], v[196:199], v246
s_waitcnt lgkmcnt(9)
v_smfmac_f32_16x16x32_bf16 v[44:47], v[100:101], v[200:203], v246
s_waitcnt lgkmcnt(8)
v_smfmac_f32_16x16x32_bf16 v[8:11], v[102:103], v[204:207], v246
s_waitcnt lgkmcnt(7)
v_smfmac_f32_16x16x32_bf16 v[24:27], v[104:105], v[208:211], v246
s_waitcnt lgkmcnt(6)
v_smfmac_f32_16x16x32_bf16 v[40:43], v[106:107], v[212:215], v246
s_waitcnt lgkmcnt(5)
v_smfmac_f32_16x16x32_bf16 v[8:11], v[108:109], v[224:227], v246
s_waitcnt lgkmcnt(4)
v_smfmac_f32_16x16x32_bf16 v[24:27], v[110:111], v[228:231], v246
s_waitcnt lgkmcnt(3)
v_smfmac_f32_16x16x32_bf16 v[40:43], v[112:113], v[232:235], v246
s_waitcnt lgkmcnt(2)
v_smfmac_f32_16x16x32_bf16 v[8:11], v[114:115], v[236:239], v246
s_waitcnt lgkmcnt(1)
v_smfmac_f32_16x16x32_bf16 v[24:27], v[116:117], v[216:219], v246
s_waitcnt lgkmcnt(0)
v_smfmac_f32_16x16x32_bf16 v[40:43], v[118:119], v[220:223], v246
s_nop 11
s_setpc_b64 s[78:79]
Lln0:
v_pk_add_f32 v[168:169], v[0:1], v[2:3]
v_pk_mul_f32 v[170:171], v[0:1], v[0:1]
v_pk_fma_f32 v[170:171], v[2:3], v[2:3], v[170:171]
v_pk_add_f32 v[168:169], v[168:169], v[4:5]
v_pk_fma_f32 v[170:171], v[4:5], v[4:5], v[170:171]
v_pk_add_f32 v[168:169], v[168:169], v[6:7]
v_pk_fma_f32 v[170:171], v[6:7], v[6:7], v[170:171]
v_pk_add_f32 v[168:169], v[168:169], v[8:9]
v_pk_fma_f32 v[170:171], v[8:9], v[8:9], v[170:171]
v_pk_add_f32 v[168:169], v[168:169], v[10:11]
v_pk_fma_f32 v[170:171], v[10:11], v[10:11], v[170:171]
v_pk_add_f32 v[168:169], v[168:169], v[12:13]
v_pk_fma_f32 v[170:171], v[12:13], v[12:13], v[170:171]
v_pk_add_f32 v[168:169], v[168:169], v[14:15]
v_pk_fma_f32 v[170:171], v[14:15], v[14:15], v[170:171]
v_pk_add_f32 v[168:169], v[168:169], v[16:17]
v_pk_fma_f32 v[170:171], v[16:17], v[16:17], v[170:171]
v_pk_add_f32 v[168:169], v[168:169], v[18:19]
v_pk_fma_f32 v[170:171], v[18:19], v[18:19], v[170:171]
v_pk_add_f32 v[168:169], v[168:169], v[20:21]
v_pk_fma_f32 v[170:171], v[20:21], v[20:21], v[170:171]
v_pk_add_f32 v[168:169], v[168:169], v[22:23]
v_pk_fma_f32 v[170:171], v[22:23], v[22:23], v[170:171]
v_pk_add_f32 v[168:169], v[168:169], v[24:25]
v_pk_fma_f32 v[170:171], v[24:25], v[24:25], v[170:171]
v_pk_add_f32 v[168:169], v[168:169], v[26:27]
v_pk_fma_f32 v[170:171], v[26:27], v[26:27], v[170:171]
v_pk_add_f32 v[168:169], v[168:169], v[28:29]
v_pk_fma_f32 v[170:171], v[28:29], v[28:29], v[170:171]
v_pk_add_f32 v[168:169], v[168:169], v[30:31]
v_pk_fma_f32 v[170:171], v[30:31], v[30:31], v[170:171]
v_pk_add_f32 v[168:169], v[168:169], v[32:33]
v_pk_fma_f32 v[170:171], v[32:33], v[32:33], v[170:171]
v_pk_add_f32 v[168:169], v[168:169], v[34:35]
v_pk_fma_f32 v[170:171], v[34:35], v[34:35], v[170:171]
v_pk_add_f32 v[168:169], v[168:169], v[36:37]
v_pk_fma_f32 v[170:171], v[36:37], v[36:37], v[170:171]
v_pk_add_f32 v[168:169], v[168:169], v[38:39]
v_pk_fma_f32 v[170:171], v[38:39], v[38:39], v[170:171]
v_pk_add_f32 v[168:169], v[168:169], v[40:41]
v_pk_fma_f32 v[170:171], v[40:41], v[40:41], v[170:171]
v_pk_add_f32 v[168:169], v[168:169], v[42:43]
v_pk_fma_f32 v[170:171], v[42:43], v[42:43], v[170:171]
v_pk_add_f32 v[168:169], v[168:169], v[44:45]
v_pk_fma_f32 v[170:171], v[44:45], v[44:45], v[170:171]
v_pk_add_f32 v[168:169], v[168:169], v[46:47]
v_pk_fma_f32 v[170:171], v[46:47], v[46:47], v[170:171]
v_add_f32 v168, v168, v169
v_add_f32 v170, v170, v171
s_nop 1
v_permlane32_swap_b32 v168, v170
v_add_f32_e64 v168, v168, v170
v_mul_f32 v168, 1009429163, v168
v_mov_b32_e64 v170, v168
s_nop 1
v_permlane32_swap_b32 v168, v170
v_fma_f32 v170, -v168, v168, v170
v_max_f32_e64 v170, 0, v170
v_add_f32 v170, 925353388, v170
v_rsq_f32 v170, v170
s_nop 0
v_mul_f32 v172, 3203391086, v170
v_mul_f32_e64 v173, v168, v172
v_pk_fma_f32 v[0:1], v[0:1], v[172:173], v[172:173] op_sel:[0,0,1] op_sel_hi:[1,0,1] neg_lo:[0,0,1] neg_hi:[0,0,1]
v_pk_fma_f32 v[2:3], v[2:3], v[172:173], v[172:173] op_sel:[0,0,1] op_sel_hi:[1,0,1] neg_lo:[0,0,1] neg_hi:[0,0,1]
v_pk_fma_f32 v[4:5], v[4:5], v[172:173], v[172:173] op_sel:[0,0,1] op_sel_hi:[1,0,1] neg_lo:[0,0,1] neg_hi:[0,0,1]
v_pk_fma_f32 v[6:7], v[6:7], v[172:173], v[172:173] op_sel:[0,0,1] op_sel_hi:[1,0,1] neg_lo:[0,0,1] neg_hi:[0,0,1]
v_pk_fma_f32 v[8:9], v[8:9], v[172:173], v[172:173] op_sel:[0,0,1] op_sel_hi:[1,0,1] neg_lo:[0,0,1] neg_hi:[0,0,1]
v_pk_fma_f32 v[10:11], v[10:11], v[172:173], v[172:173] op_sel:[0,0,1] op_sel_hi:[1,0,1] neg_lo:[0,0,1] neg_hi:[0,0,1]
v_pk_fma_f32 v[12:13], v[12:13], v[172:173], v[172:173] op_sel:[0,0,1] op_sel_hi:[1,0,1] neg_lo:[0,0,1] neg_hi:[0,0,1]
v_pk_fma_f32 v[14:15], v[14:15], v[172:173], v[172:173] op_sel:[0,0,1] op_sel_hi:[1,0,1] neg_lo:[0,0,1] neg_hi:[0,0,1]
v_pk_fma_f32 v[16:17], v[16:17], v[172:173], v[172:173] op_sel:[0,0,1] op_sel_hi:[1,0,1] neg_lo:[0,0,1] neg_hi:[0,0,1]
v_pk_fma_f32 v[18:19], v[18:19], v[172:173], v[172:173] op_sel:[0,0,1] op_sel_hi:[1,0,1] neg_lo:[0,0,1] neg_hi:[0,0,1]
v_pk_fma_f32 v[20:21], v[20:21], v[172:173], v[172:173] op_sel:[0,0,1] op_sel_hi:[1,0,1] neg_lo:[0,0,1] neg_hi:[0,0,1]
v_pk_fma_f32 v[22:23], v[22:23], v[172:173], v[172:173] op_sel:[0,0,1] op_sel_hi:[1,0,1] neg_lo:[0,0,1] neg_hi:[0,0,1]
v_pk_fma_f32 v[24:25], v[24:25], v[172:173], v[172:173] op_sel:[0,0,1] op_sel_hi:[1,0,1] neg_lo:[0,0,1] neg_hi:[0,0,1]
v_pk_fma_f32 v[26:27], v[26:27], v[172:173], v[172:173] op_sel:[0,0,1] op_sel_hi:[1,0,1] neg_lo:[0,0,1] neg_hi:[0,0,1]
v_pk_fma_f32 v[28:29], v[28:29], v[172:173], v[172:173] op_sel:[0,0,1] op_sel_hi:[1,0,1] neg_lo:[0,0,1] neg_hi:[0,0,1]
v_pk_fma_f32 v[30:31], v[30:31], v[172:173], v[172:173] op_sel:[0,0,1] op_sel_hi:[1,0,1] neg_lo:[0,0,1] neg_hi:[0,0,1]
v_pk_fma_f32 v[32:33], v[32:33], v[172:173], v[172:173] op_sel:[0,0,1] op_sel_hi:[1,0,1] neg_lo:[0,0,1] neg_hi:[0,0,1]
v_pk_fma_f32 v[34:35], v[34:35], v[172:173], v[172:173] op_sel:[0,0,1] op_sel_hi:[1,0,1] neg_lo:[0,0,1] neg_hi:[0,0,1]
v_pk_fma_f32 v[36:37], v[36:37], v[172:173], v[172:173] op_sel:[0,0,1] op_sel_hi:[1,0,1] neg_lo:[0,0,1] neg_hi:[0,0,1]
v_pk_fma_f32 v[38:39], v[38:39], v[172:173], v[172:173] op_sel:[0,0,1] op_sel_hi:[1,0,1] neg_lo:[0,0,1] neg_hi:[0,0,1]
v_pk_fma_f32 v[40:41], v[40:41], v[172:173], v[172:173] op_sel:[0,0,1] op_sel_hi:[1,0,1] neg_lo:[0,0,1] neg_hi:[0,0,1]
v_pk_fma_f32 v[42:43], v[42:43], v[172:173], v[172:173] op_sel:[0,0,1] op_sel_hi:[1,0,1] neg_lo:[0,0,1] neg_hi:[0,0,1]
v_pk_fma_f32 v[44:45], v[44:45], v[172:173], v[172:173] op_sel:[0,0,1] op_sel_hi:[1,0,1] neg_lo:[0,0,1] neg_hi:[0,0,1]
v_pk_fma_f32 v[46:47], v[46:47], v[172:173], v[172:173] op_sel:[0,0,1] op_sel_hi:[1,0,1] neg_lo:[0,0,1] neg_hi:[0,0,1]
v_cvt_pk_bf16_f32 v48, v0, v1
v_cvt_pk_bf16_f32 v49, v2, v3
v_cvt_pk_bf16_f32 v50, v4, v5
v_cvt_pk_bf16_f32 v51, v6, v7
v_cvt_pk_bf16_f32 v52, v8, v9
v_cvt_pk_bf16_f32 v53, v10, v11
v_cvt_pk_bf16_f32 v54, v12, v13
v_cvt_pk_bf16_f32 v55, v14, v15
v_cvt_pk_bf16_f32 v56, v16, v17
v_cvt_pk_bf16_f32 v57, v18, v19
v_cvt_pk_bf16_f32 v58, v20, v21
v_cvt_pk_bf16_f32 v59, v22, v23
v_cvt_pk_bf16_f32 v60, v24, v25
v_cvt_pk_bf16_f32 v61, v26, v27
v_cvt_pk_bf16_f32 v62, v28, v29
v_cvt_pk_bf16_f32 v63, v30, v31
v_cvt_pk_bf16_f32 v64, v32, v33
v_cvt_pk_bf16_f32 v65, v34, v35
v_cvt_pk_bf16_f32 v66, v36, v37
v_cvt_pk_bf16_f32 v67, v38, v39
v_cvt_pk_bf16_f32 v68, v40, v41
v_cvt_pk_bf16_f32 v69, v42, v43
v_cvt_pk_bf16_f32 v70, v44, v45
v_cvt_pk_bf16_f32 v71, v46, v47
s_nop 1
s_setpc_b64 s[78:79]
Lw1a:
ds_read_b64_tr_b16 v[148:149], v190
ds_read_b64_tr_b16 v[150:151], v190 offset:512
ds_read_b64_tr_b16 v[152:153], v190 offset:1024
ds_read_b64_tr_b16 v[154:155], v190 offset:1536
ds_read_b64_tr_b16 v[156:157], v190 offset:2048
ds_read_b64_tr_b16 v[158:159], v190 offset:2560
ds_read_b64_tr_b16 v[160:161], v190 offset:3072
ds_read_b64_tr_b16 v[162:163], v190 offset:3584
ds_read_b64_tr_b16 v[164:165], v190 offset:4096
ds_read_b64_tr_b16 v[166:167], v190 offset:4608
ds_read_b64_tr_b16 v[168:169], v190 offset:5120
ds_read_b64_tr_b16 v[170:171], v190 offset:5632
s_waitcnt lgkmcnt(10)
ds_write_b128 v191, v[148:151]
s_waitcnt lgkmcnt(9)
ds_write_b128 v191, v[152:155] offset:1024
s_waitcnt lgkmcnt(8)
ds_write_b128 v191, v[156:159] offset:2048
s_waitcnt lgkmcnt(7)
ds_write_b128 v191, v[160:163] offset:3072
s_waitcnt lgkmcnt(6)
ds_write_b128 v191, v[164:167] offset:4096
s_waitcnt lgkmcnt(5)
ds_write_b128 v191, v[168:171] offset:5120
s_waitcnt lgkmcnt(0)
s_setpc_b64 s[78:79]
Lw1i:
s_add_u32 m0, s77, 24576
s_add_u32 s43, s3, 256
buffer_load_dwordx4 v189, s[12:15], s43 offen lds
s_add_u32 m0, s77, 25600
s_add_u32 s43, s3, 24832
buffer_load_dwordx4 v189, s[12:15], s43 offen lds
s_add_u32 m0, s77, 26624
s_add_u32 s43, s3, 49408
buffer_load_dwordx4 v189, s[12:15], s43 offen lds
s_add_u32 m0, s77, 27648
s_add_u32 s43, s3, 12544
buffer_load_dwordx4 v189, s[12:15], s43 offen lds
s_add_u32 m0, s77, 28672
s_add_u32 s43, s3, 37120
buffer_load_dwordx4 v189, s[12:15], s43 offen lds
s_add_u32 m0, s77, 29696
s_add_u32 s43, s3, 61696
buffer_load_dwordx4 v189, s[12:15], s43 offen lds
s_add_u32 m0, s77, 49152
s_add_u32 s43, s3, 512
buffer_load_dwordx4 v189, s[12:15], s43 offen lds
s_add_u32 m0, s77, 50176
s_add_u32 s43, s3, 25088
buffer_load_dwordx4 v189, s[12:15], s43 offen lds
s_add_u32 m0, s77, 51200
s_add_u32 s43, s3, 49664
buffer_load_dwordx4 v189, s[12:15], s43 offen lds
s_add_u32 m0, s77, 52224
s_add_u32 s43, s3, 12800
buffer_load_dwordx4 v189, s[12:15], s43 offen lds
s_add_u32 m0, s77, 53248
s_add_u32 s43, s3, 37376
buffer_load_dwordx4 v189, s[12:15], s43 offen lds
s_add_u32 m0, s77, 54272
s_add_u32 s43, s3, 61952
buffer_load_dwordx4 v189, s[12:15], s43 offen lds
s_setpc_b64 s[78:79]
Lw1b:
s_waitcnt vmcnt(0)
ds_read_b64_tr_b16 v[72:73], v190 offset:24576
ds_read_b64_tr_b16 v[74:75], v190 offset:25088
ds_read_b64_tr_b16 v[76:77], v190 offset:25600
ds_read_b64_tr_b16 v[78:79], v190 offset:26112
ds_read_b64_tr_b16 v[80:81], v190 offset:26624
ds_read_b64_tr_b16 v[82:83], v190 offset:27136
ds_read_b64_tr_b16 v[84:85], v190 offset:27648
ds_read_b64_tr_b16 v[86:87], v190 offset:28160
ds_read_b64_tr_b16 v[88:89], v190 offset:28672
ds_read_b64_tr_b16 v[90:91], v190 offset:29184
ds_read_b64_tr_b16 v[92:93], v190 offset:29696
ds_read_b64_tr_b16 v[94:95], v190 offset:30208
ds_read_b64_tr_b16 v[96:97], v190 offset:49152
ds_read_b64_tr_b16 v[98:99], v190 offset:49664
ds_read_b64_tr_b16 v[100:101], v190 offset:50176
ds_read_b64_tr_b16 v[102:103], v190 offset:50688
ds_read_b64_tr_b16 v[104:105], v190 offset:51200
ds_read_b64_tr_b16 v[106:107], v190 offset:51712
ds_read_b64_tr_b16 v[108:109], v190 offset:52224
ds_read_b64_tr_b16 v[110:111], v190 offset:52736
ds_read_b64_tr_b16 v[112:113], v190 offset:53248
ds_read_b64_tr_b16 v[114:115], v190 offset:53760
ds_read_b64_tr_b16 v[116:117], v190 offset:54272
ds_read_b64_tr_b16 v[118:119], v190 offset:54784
s_waitcnt lgkmcnt(15)
ds_write_b128 v191, v[72:75] offset:24576
ds_write_b128 v191, v[76:79] offset:25600
ds_write_b128 v191, v[80:83] offset:26624
ds_write_b128 v191, v[84:87] offset:27648
s_waitcnt lgkmcnt(15)
ds_write_b128 v191, v[88:91] offset:28672
ds_write_b128 v191, v[92:95] offset:29696
s_waitcnt lgkmcnt(15)
ds_write_b128 v191, v[96:99] offset:49152
s_waitcnt lgkmcnt(15)
ds_write_b128 v191, v[100:103] offset:50176
s_waitcnt lgkmcnt(14)
ds_write_b128 v191, v[104:107] offset:51200
s_waitcnt lgkmcnt(13)
ds_write_b128 v191, v[108:111] offset:52224
s_waitcnt lgkmcnt(12)
ds_write_b128 v191, v[112:115] offset:53248
s_waitcnt lgkmcnt(11)
ds_write_b128 v191, v[116:119] offset:54272
s_waitcnt lgkmcnt(0)
s_setpc_b64 s[78:79]
Lpre:
ds_read_b128 v[48:51], v245
ds_read_b128 v[52:55], v245 offset:384
ds_read_b128 v[56:59], v245 offset:768
ds_read_b128 v[60:63], v245 offset:1152
ds_read_b128 v[64:67], v245 offset:1536
ds_read_b128 v[68:71], v245 offset:1920
ds_read_b128 v[72:75], v245 offset:2304
ds_read_b128 v[76:79], v245 offset:2688
ds_read_b128 v[80:83], v245 offset:3072
ds_read_b128 v[84:87], v245 offset:3456
ds_read_b128 v[88:91], v245 offset:3840
ds_read_b128 v[92:95], v245 offset:4224
ds_read_b128 v[96:99], v245 offset:4608
ds_read_b128 v[100:103], v245 offset:4992
ds_read_b128 v[104:107], v245 offset:5376
ds_read_b128 v[108:111], v245 offset:5760
ds_read_b128 v[112:115], v245 offset:6144
ds_read_b128 v[116:119], v245 offset:6528
v_mov_b32 v0, 0
v_mov_b32 v1, 0
v_mov_b32 v2, 0
v_mov_b32 v3, 0
v_mov_b32 v4, 0
v_mov_b32 v5, 0
v_mov_b32 v6, 0
v_mov_b32 v7, 0
v_mov_b32 v8, 0
v_mov_b32 v9, 0
v_mov_b32 v10, 0
v_mov_b32 v11, 0
v_mov_b32 v12, 0
v_mov_b32 v13, 0
v_mov_b32 v14, 0
v_mov_b32 v15, 0
v_mov_b32 v16, 0
v_mov_b32 v17, 0
v_mov_b32 v18, 0
v_mov_b32 v19, 0
v_mov_b32 v20, 0
v_mov_b32 v21, 0
v_mov_b32 v22, 0
v_mov_b32 v23, 0
v_mov_b32 v24, 0
v_mov_b32 v25, 0
v_mov_b32 v26, 0
v_mov_b32 v27, 0
v_mov_b32 v28, 0
v_mov_b32 v29, 0
v_mov_b32 v30, 0
v_mov_b32 v31, 0
v_mov_b32 v32, 0
v_mov_b32 v33, 0
v_mov_b32 v34, 0
v_mov_b32 v35, 0
v_mov_b32 v36, 0
v_mov_b32 v37, 0
v_mov_b32 v38, 0
v_mov_b32 v39, 0
v_mov_b32 v40, 0
v_mov_b32 v41, 0
v_mov_b32 v42, 0
v_mov_b32 v43, 0
v_mov_b32 v44, 0
v_mov_b32 v45, 0
v_mov_b32_e64 v46, 0
v_mov_b32 v47, 0
s_waitcnt lgkmcnt(0)
s_setpc_b64 s[78:79]
Lrb:
s_add_u32 m0, s67, 39936
s_add_u32 s45, s66, 491520
buffer_load_dwordx4 v240, s[4:7], s45 offen nt lds
s_add_u32 m0, s67, 46592
s_add_u32 s45, s66, 589824
buffer_load_dwordx4 v240, s[4:7], s45 offen nt lds
s_add_u32 m0, s67, 53248
s_add_u32 s45, s66, 688128
buffer_load_dwordx4 v240, s[4:7], s45 offen nt lds
s_add_u32 m0, s67, 59904
s_add_u32 s45, s66, 786432
buffer_load_dwordx4 v240, s[4:7], s45 offen nt lds
s_setpc_b64 s[78:79]
Lw1f:
s_add_u32 m0, s77, 0
s_add_u32 s43, s3, 0
buffer_load_dwordx4 v189, s[12:15], s43 offen lds
s_add_u32 m0, s77, 1024
s_add_u32 s43, s3, 24576
buffer_load_dwordx4 v189, s[12:15], s43 offen lds
s_add_u32 m0, s77, 2048
s_add_u32 s43, s3, 49152
buffer_load_dwordx4 v189, s[12:15], s43 offen lds
s_add_u32 m0, s77, 3072
s_add_u32 s43, s3, 12288
buffer_load_dwordx4 v189, s[12:15], s43 offen lds
s_add_u32 m0, s77, 4096
s_add_u32 s43, s3, 36864
buffer_load_dwordx4 v189, s[12:15], s43 offen lds
s_add_u32 m0, s77, 5120
s_add_u32 s43, s3, 61440
buffer_load_dwordx4 v189, s[12:15], s43 offen lds
s_setpc_b64 s[78:79]
Lgo:
v_mov_b32 v253, 16256
Lsw204w:
ds_read_b32 v247, v253 offset:20
s_waitcnt lgkmcnt(0)
v_readfirstlane_b32 s43, v247
s_cmp_eq_u32 s76, 0
s_cbranch_scc1 Lsw204x
s_sub_u32 s76, s76, 1
s_cmp_lt_u32 s43, 4
s_cbranch_scc0 Lsw204x
s_sleep 2
s_branch Lsw204w
Lsw204x:
s_cmp_lg_u32 s40, 7
s_cbranch_scc1 Lnopf
s_getpc_b64 s[74:75]
Lpc:
s_lshr_b32 s43, s2, 3
s_and_b32 s43, s43, 15
s_lshl_b32 s43, s43, 13
v_lshlrev_b32 v178, 7, v251
v_add_u32 v178, s43, v178
v_min_u32 v178, Lend-Lpc, v178
global_load_dword v255, v178, s[74:75]
Lnopf:
s_add_u32 s66, s66, 786432
ds_read_b128 v[224:227], v248 offset:16384
ds_read_b128 v[228:231], v248 offset:19456
ds_read_b128 v[232:235], v248 offset:17408
ds_read_b128 v[236:239], v248 offset:20480
ds_read_b128 v[216:219], v248 offset:18432
ds_read_b128 v[220:223], v248 offset:21504
s_setprio 2
s_waitcnt lgkmcnt(5)
v_mfma_f32_32x32x16_bf16 v[120:135], v[48:51], v[224:227], 0
s_waitcnt lgkmcnt(4)
ds_read_b128 v[224:227], v248 offset:22528
v_mfma_f32_32x32x16_bf16 v[120:135], v[52:55], v[228:231], v[120:135]
s_waitcnt lgkmcnt(4)
ds_read_b128 v[228:231], v248 offset:25600
v_mfma_f32_32x32x16_bf16 v[120:135], v[56:59], v[232:235], v[120:135]
s_waitcnt lgkmcnt(4)
ds_read_b128 v[232:235], v248 offset:23552
v_mfma_f32_32x32x16_bf16 v[120:135], v[60:63], v[236:239], v[120:135]
s_waitcnt lgkmcnt(4)
ds_read_b128 v[236:239], v248 offset:26624
v_mfma_f32_32x32x16_bf16 v[120:135], v[64:67], v[216:219], v[120:135]
s_waitcnt lgkmcnt(4)
ds_read_b128 v[216:219], v248 offset:24576
v_mfma_f32_32x32x16_bf16 v[120:135], v[68:71], v[220:223], v[120:135]
v_add_u32 v174, -36864, v242
v_subrev_u32 v175, 66560, v174
v_min_u32 v174, v174, v175
v_add_u32 v174, 90112, v174
v_sub_u32 v175, v174, v242
v_add_u32 v242, v175, v242
v_add_u32_e64 v243, v175, v243
v_add_u32 v244, v175, v244
s_nop 3
v_cvt_pkrtz_f16_f32 v137, v120, v121
v_cvt_pkrtz_f16_f32 v139, v122, v123
v_cvt_pkrtz_f16_f32 v141, v124, v125
v_cvt_pkrtz_f16_f32 v143, v126, v127
v_cvt_pkrtz_f16_f32 v145, v128, v129
v_cvt_pk_f16_f32 v155, v130, v131
v_cvt_pk_f16_f32 v152, v132, v133
v_cvt_pk_f16_f32 v149, v134, v135
s_waitcnt lgkmcnt(1)
ds_read_b128 v[220:223], v248 offset:27648
v_mfma_f32_32x32x16_bf16 v[120:135], v[48:51], v[224:227], 0
v_pk_fma_f16 v154, v155, v155, s48
v_and_b32 v137, s49, v137
v_pk_fma_f16 v151, v152, v152, s48
v_and_b32_e64 v139, s49, v139
v_pk_fma_f16 v148, v149, v149, s48
v_pk_mul_f16 v154, v155, v154
v_bfe_u32 v136, v137, 2, 14
v_pk_mul_f16 v151, v152, v151
v_pk_mul_f16 v148, v149, v148
v_bfe_u32 v138, v139, 2, 14
ds_read_b128 v[224:227], v248 offset:28672
ds_read_u16_d16 v136, v136
ds_read_u16_d16 v138, v138
v_mfma_f32_32x32x16_bf16 v[120:135], v[52:55], v[228:231], v[120:135]
v_exp_f16 v153, v154
v_lshrrev_b32 v137, 18, v137
v_exp_f16 v150, v151
v_lshrrev_b32 v139, 18, v139
v_exp_f16 v147, v148
v_and_b32 v141, s49, v141
v_and_b32_e64 v143, s49, v143
ds_read_b128 v[228:231], v248 offset:31744
ds_read_u16_d16_hi v137, v137
ds_read_u16_d16_hi v139, v139
v_mfma_f32_32x32x16_bf16 v[120:135], v[56:59], v[232:235], v[120:135]
v_exp_f16_sdwa v153, v154 dst_sel:WORD_1 dst_unused:UNUSED_PRESERVE src0_sel:WORD_1
v_bfe_u32 v140, v141, 2, 14
v_exp_f16_sdwa v150, v151 dst_sel:WORD_1 dst_unused:UNUSED_PRESERVE src0_sel:WORD_1
v_bfe_u32 v142, v143, 2, 14
v_exp_f16_sdwa v147, v148 dst_sel:WORD_1 dst_unused:UNUSED_PRESERVE src0_sel:WORD_1
v_lshrrev_b32_e64 v141, 18, v141
v_pk_add_f16 v153, v153, 1.0 op_sel_hi:[1,0]
ds_read_b128 v[232:235], v248 offset:29696
ds_read_u16_d16 v140, v140
ds_read_u16_d16 v142, v142
ds_read_u16_d16_hi v141, v141
v_mfma_f32_32x32x16_bf16 v[120:135], v[60:63], v[236:239], v[120:135]
v_lshrrev_b32_e64 v143, 18, v143
v_pk_add_f16 v150, v150, 1.0 op_sel_hi:[1,0]
v_pk_add_f16 v147, v147, 1.0 op_sel_hi:[1,0]
v_and_b32 v145, s49, v145
v_rcp_f16 v154, v153
v_bfe_u32 v144, v145, 2, 14
v_rcp_f16_e64 v151, v150
v_lshrrev_b32 v145, 18, v145
s_waitcnt lgkmcnt(7)
ds_read_b128 v[236:239], v248 offset:32768
ds_read_u16_d16_hi v143, v143
ds_read_u16_d16 v144, v144
ds_read_u16_d16_hi v145, v145
v_mfma_f32_32x32x16_bf16 v[120:135], v[64:67], v[216:219], v[120:135]
v_rcp_f16_e64 v148, v147
v_rcp_f16_sdwa v154, v153 dst_sel:WORD_1 dst_unused:UNUSED_PRESERVE src0_sel:WORD_1
v_fma_mix_f32 v156, v136, v136, 0 op_sel:[0,0,0] op_sel_hi:[1,1,0]
ds_read_b32 v247, v253 offset:16
s_waitcnt lgkmcnt(9)
v_fma_mix_f32 v156, v137, v137, v156 op_sel:[1,1,0] op_sel_hi:[1,1,0]
v_rcp_f16_sdwa v151, v150 dst_sel:WORD_1 dst_unused:UNUSED_PRESERVE src0_sel:WORD_1
v_fma_mix_f32 v156, v138, v138, v156 op_sel:[0,0,0] op_sel_hi:[1,1,0]
ds_read_b128 v[216:219], v248 offset:30720
v_mfma_f32_32x32x16_bf16 v[120:135], v[68:71], v[220:223], v[120:135]
v_rcp_f16_sdwa v148, v147 dst_sel:WORD_1 dst_unused:UNUSED_PRESERVE src0_sel:WORD_1
v_fma_mix_f32 v156, v139, v139, v156 op_sel:[1,1,0] op_sel_hi:[1,1,0]
v_pk_mul_f16 v155, v155, v154
s_waitcnt lgkmcnt(6)
v_fma_mix_f32 v156, v140, v140, v156 op_sel:[0,0,0] op_sel_hi:[1,1,0]
v_pk_mul_f16 v152, v152, v151
v_fma_mix_f32 v156, v141, v141, v156 op_sel:[1,1,0] op_sel_hi:[1,1,0]
v_pk_mul_f16 v149, v149, v148
v_fma_mix_f32 v156, v155, v155, v156 op_sel:[0,0,0] op_sel_hi:[1,1,0]
v_fma_mix_f32 v156, v142, v142, v156 op_sel:[0,0,0] op_sel_hi:[1,1,0]
v_fma_mix_f32 v156, v155, v155, v156 op_sel:[1,1,0] op_sel_hi:[1,1,0]
s_waitcnt lgkmcnt(4)
v_fma_mix_f32 v156, v143, v143, v156 op_sel:[1,1,0] op_sel_hi:[1,1,0]
v_fma_mix_f32 v156, v152, v152, v156 op_sel:[0,0,0] op_sel_hi:[1,1,0]
v_fma_mix_f32 v156, v152, v152, v156 op_sel:[1,1,0] op_sel_hi:[1,1,0]
s_waitcnt lgkmcnt(2)
v_fma_mix_f32 v156, v144, v144, v156 op_sel:[0,0,0] op_sel_hi:[1,1,0]
v_fma_mix_f32 v156, v149, v149, v156 op_sel:[0,0,0] op_sel_hi:[1,1,0]
v_fma_mix_f32 v156, v145, v145, v156 op_sel:[1,1,0] op_sel_hi:[1,1,0]
v_fma_mix_f32 v156, v149, v149, v156 op_sel:[1,1,0] op_sel_hi:[1,1,0]
s_cmp_lt_u32 s40, 4
s_cbranch_scc0 Lsu5
s_call_b64 s[78:79], Lw1b
s_mov_b64 exec, 1
ds_add_u32 v253, v254 offset:24
s_mov_b64 exec, -1
Lsu5:
s_waitcnt lgkmcnt(0)
v_readfirstlane_b32 s43, v247
s_nop 1
s_cmp_ge_u32 s43, 8
s_cbranch_scc1 Lev1
Lev1w:
s_sleep 1
ds_read_b32 v247, v253 offset:16
s_waitcnt lgkmcnt(0)
v_readfirstlane_b32 s43, v247
s_cmp_eq_u32 s76, 0
s_cbranch_scc1 Lev1
s_sub_u32 s76, s76, 1
s_cmp_lt_u32 s43, 8
s_cbranch_scc1 Lev1w
Lev1:
v_cvt_pkrtz_f16_f32 v137, v120, v121
v_cvt_pkrtz_f16_f32 v139, v122, v123
v_cvt_pkrtz_f16_f32 v141, v124, v125
v_cvt_pkrtz_f16_f32 v143, v126, v127
v_cvt_pkrtz_f16_f32 v145, v128, v129
v_cvt_pk_f16_f32 v155, v130, v131
v_cvt_pk_f16_f32 v152, v132, v133
v_cvt_pk_f16_f32 v149, v134, v135
s_add_u32 m0, s67, 0
s_add_u32 s66, s66, 98304
buffer_load_dwordx4 v240, s[4:7], s66 offen lds
ds_read_b128 v[220:223], v248 offset:33792
v_mfma_f32_32x32x16_bf16 v[120:135], v[48:51], v[224:227], 0
v_pk_fma_f16 v154, v155, v155, s48
v_and_b32 v137, s49, v137
v_pk_fma_f16 v151, v152, v152, s48
v_and_b32_e64 v139, s49, v139
v_pk_fma_f16 v148, v149, v149, s48
v_pk_mul_f16 v154, v155, v154
v_bfe_u32 v136, v137, 2, 14
v_pk_mul_f16 v151, v152, v151
v_pk_mul_f16 v148, v149, v148
v_bfe_u32 v138, v139, 2, 14
s_add_u32 m0, s67, 6656
s_add_u32 s66, s66, 98304
buffer_load_dwordx4 v240, s[4:7], s66 offen lds
ds_read_b128 v[224:227], v248 offset:34816
ds_read_u16_d16 v136, v136
ds_read_u16_d16 v138, v138
v_mfma_f32_32x32x16_bf16 v[120:135], v[52:55], v[228:231], v[120:135]
v_exp_f16 v153, v154
v_lshrrev_b32 v137, 18, v137
v_exp_f16 v150, v151
v_lshrrev_b32 v139, 18, v139
v_exp_f16 v147, v148
v_and_b32 v141, s49, v141
v_and_b32_e64 v143, s49, v143
s_add_u32 m0, s67, 13312
s_add_u32 s66, s66, 98304
buffer_load_dwordx4 v240, s[4:7], s66 offen lds
ds_read_b128 v[228:231], v248 offset:37888
ds_read_u16_d16_hi v137, v137
ds_read_u16_d16_hi v139, v139
v_mfma_f32_32x32x16_bf16 v[120:135], v[56:59], v[232:235], v[120:135]
v_exp_f16_sdwa v153, v154 dst_sel:WORD_1 dst_unused:UNUSED_PRESERVE src0_sel:WORD_1
v_bfe_u32 v140, v141, 2, 14
v_exp_f16_sdwa v150, v151 dst_sel:WORD_1 dst_unused:UNUSED_PRESERVE src0_sel:WORD_1
v_bfe_u32 v142, v143, 2, 14
v_exp_f16_sdwa v147, v148 dst_sel:WORD_1 dst_unused:UNUSED_PRESERVE src0_sel:WORD_1
v_lshrrev_b32_e64 v141, 18, v141
v_pk_add_f16 v153, v153, 1.0 op_sel_hi:[1,0]
s_add_u32 m0, s67, 19968
s_add_u32 s66, s66, 98304
buffer_load_dwordx4 v240, s[4:7], s66 offen lds
s_add_u32 m0, s67, 26624
s_add_u32 s66, s66, 98304
buffer_load_dwordx4 v240, s[4:7], s66 offen lds
ds_read_b128 v[232:235], v248 offset:35840
ds_read_u16_d16 v140, v140
ds_read_u16_d16 v142, v142
ds_read_u16_d16_hi v141, v141
v_mfma_f32_32x32x16_bf16 v[120:135], v[60:63], v[236:239], v[120:135]
v_lshrrev_b32_e64 v143, 18, v143
v_pk_add_f16 v150, v150, 1.0 op_sel_hi:[1,0]
v_pk_add_f16 v147, v147, 1.0 op_sel_hi:[1,0]
v_and_b32 v145, s49, v145
v_rcp_f16 v154, v153
v_bfe_u32 v144, v145, 2, 14
v_rcp_f16 v151, v150
v_lshrrev_b32 v145, 18, v145
s_add_u32 m0, s67, 33280
s_add_u32 s66, s66, 98304
buffer_load_dwordx4 v240, s[4:7], s66 offen lds
ds_read_b128 v[236:239], v248 offset:38912
ds_read_u16_d16_hi v143, v143
ds_read_u16_d16 v144, v144
ds_read_u16_d16_hi v145, v145
v_mfma_f32_32x32x16_bf16 v[120:135], v[64:67], v[216:219], v[120:135]
v_rcp_f16_e64 v148, v147
v_rcp_f16_sdwa v154, v153 dst_sel:WORD_1 dst_unused:UNUSED_PRESERVE src0_sel:WORD_1
s_waitcnt lgkmcnt(8)
v_fma_mix_f32 v157, v136, v136, 0 op_sel:[0,0,0] op_sel_hi:[1,1,0]
v_fma_mix_f32 v157, v137, v137, v157 op_sel:[1,1,0] op_sel_hi:[1,1,0]
v_rcp_f16_sdwa v151, v150 dst_sel:WORD_1 dst_unused:UNUSED_PRESERVE src0_sel:WORD_1
v_fma_mix_f32 v157, v138, v138, v157 op_sel:[0,0,0] op_sel_hi:[1,1,0]
s_add_u32 m0, s67, 39936
s_add_u32 s66, s66, 98304
buffer_load_dwordx4 v240, s[4:7], s66 offen lds
ds_read_b128 v[216:219], v248 offset:36864
v_mfma_f32_32x32x16_bf16 v[120:135], v[68:71], v[220:223], v[120:135]
v_rcp_f16_sdwa v148, v147 dst_sel:WORD_1 dst_unused:UNUSED_PRESERVE src0_sel:WORD_1
v_fma_mix_f32 v157, v139, v139, v157 op_sel:[1,1,0] op_sel_hi:[1,1,0]
v_pk_mul_f16 v155, v155, v154
s_waitcnt lgkmcnt(5)
v_fma_mix_f32 v157, v140, v140, v157 op_sel:[0,0,0] op_sel_hi:[1,1,0]
v_pk_mul_f16 v152, v152, v151
v_fma_mix_f32 v157, v141, v141, v157 op_sel:[1,1,0] op_sel_hi:[1,1,0]
v_pk_mul_f16 v149, v149, v148
v_fma_mix_f32 v157, v155, v155, v157 op_sel:[0,0,0] op_sel_hi:[1,1,0]
v_fma_mix_f32 v157, v142, v142, v157 op_sel:[0,0,0] op_sel_hi:[1,1,0]
v_fma_mix_f32 v157, v155, v155, v157 op_sel:[1,1,0] op_sel_hi:[1,1,0]
s_add_u32 m0, s67, 46592
s_add_u32 s66, s66, 98304
buffer_load_dwordx4 v240, s[4:7], s66 offen lds
s_waitcnt lgkmcnt(1)
v_fma_mix_f32 v157, v143, v143, v157 op_sel:[1,1,0] op_sel_hi:[1,1,0]
v_fma_mix_f32 v157, v152, v152, v157 op_sel:[0,0,0] op_sel_hi:[1,1,0]
v_fma_mix_f32 v157, v152, v152, v157 op_sel:[1,1,0] op_sel_hi:[1,1,0]
v_fma_mix_f32 v157, v144, v144, v157 op_sel:[0,0,0] op_sel_hi:[1,1,0]
v_fma_mix_f32 v157, v149, v149, v157 op_sel:[0,0,0] op_sel_hi:[1,1,0]
v_fma_mix_f32 v157, v145, v145, v157 op_sel:[1,1,0] op_sel_hi:[1,1,0]
v_fma_mix_f32 v157, v149, v149, v157 op_sel:[1,1,0] op_sel_hi:[1,1,0]
s_setprio 1
v_cvt_pkrtz_f16_f32 v137, v120, v121
v_cvt_pkrtz_f16_f32 v139, v122, v123
v_cvt_pkrtz_f16_f32 v141, v124, v125
v_cvt_pkrtz_f16_f32 v143, v126, v127
v_cvt_pkrtz_f16_f32 v145, v128, v129
v_cvt_pk_f16_f32 v155, v130, v131
v_cvt_pk_f16_f32 v152, v132, v133
v_cvt_pk_f16_f32 v149, v134, v135
ds_read_b128 v[220:223], v248 offset:39936
v_mfma_f32_32x32x16_bf16 v[120:135], v[48:51], v[224:227], 0
v_pk_fma_f16 v154, v155, v155, s48
v_and_b32_e64 v137, s49, v137
v_pk_fma_f16 v151, v152, v152, s48
v_and_b32_e64 v139, s49, v139
v_pk_fma_f16 v148, v149, v149, s48
v_pk_mul_f16 v154, v155, v154
v_bfe_u32 v136, v137, 2, 14
v_pk_mul_f16 v151, v152, v151
v_pk_mul_f16 v148, v149, v148
v_bfe_u32 v138, v139, 2, 14
ds_read_u16_d16 v136, v136
ds_read_b32 v247, v253 offset:24
ds_read_u16_d16 v138, v138
v_mfma_f32_32x32x16_bf16 v[120:135], v[52:55], v[228:231], v[120:135]
v_exp_f16 v153, v154
v_lshrrev_b32 v137, 18, v137
v_exp_f16 v150, v151
v_lshrrev_b32 v139, 18, v139
v_exp_f16 v147, v148
v_and_b32 v141, s49, v141
v_and_b32_e64 v143, s49, v143
ds_read_u16_d16_hi v137, v137
ds_read_u16_d16_hi v139, v139
v_mfma_f32_32x32x16_bf16 v[120:135], v[56:59], v[232:235], v[120:135]
v_exp_f16_sdwa v153, v154 dst_sel:WORD_1 dst_unused:UNUSED_PRESERVE src0_sel:WORD_1
v_bfe_u32 v140, v141, 2, 14
v_exp_f16_sdwa v150, v151 dst_sel:WORD_1 dst_unused:UNUSED_PRESERVE src0_sel:WORD_1
v_bfe_u32 v142, v143, 2, 14
v_exp_f16_sdwa v147, v148 dst_sel:WORD_1 dst_unused:UNUSED_PRESERVE src0_sel:WORD_1
v_lshrrev_b32_e64 v141, 18, v141
v_pk_add_f16 v153, v153, 1.0 op_sel_hi:[1,0]
ds_read_u16_d16 v140, v140
ds_read_u16_d16 v142, v142
ds_read_u16_d16_hi v141, v141
s_waitcnt lgkmcnt(6)
v_readfirstlane_b32 s43, v247
s_nop 1
s_cmp_ge_u32 s43, 4
s_cbranch_scc1 Lev2
Lev2w:
s_sleep 1
ds_read_b32 v247, v253 offset:24
s_waitcnt lgkmcnt(0)
v_readfirstlane_b32 s43, v247
s_cmp_eq_u32 s76, 0
s_cbranch_scc1 Lev2
s_sub_u32 s76, s76, 1
s_cmp_lt_u32 s43, 4
s_cbranch_scc1 Lev2w
Lev2:
ds_read_b128 v[224:227], v248 offset:40960
ds_read_b128 v[228:231], v248 offset:44032
ds_read_b128 v[232:235], v248 offset:41984
v_mfma_f32_32x32x16_bf16 v[120:135], v[60:63], v[236:239], v[120:135]
v_lshrrev_b32 v143, 18, v143
v_pk_add_f16 v150, v150, 1.0 op_sel_hi:[1,0]
v_pk_add_f16 v147, v147, 1.0 op_sel_hi:[1,0]
v_and_b32 v145, s49, v145
v_rcp_f16 v154, v153
v_bfe_u32 v144, v145, 2, 14
v_rcp_f16 v151, v150
v_lshrrev_b32 v145, 18, v145
ds_read_b128 v[236:239], v248 offset:45056
ds_read_u16_d16_hi v143, v143
ds_read_u16_d16 v144, v144
ds_read_u16_d16_hi v145, v145
v_mfma_f32_32x32x16_bf16 v[120:135], v[64:67], v[216:219], v[120:135]
v_rcp_f16 v148, v147
v_rcp_f16_sdwa v154, v153 dst_sel:WORD_1 dst_unused:UNUSED_PRESERVE src0_sel:WORD_1
v_fma_mix_f32 v158, v136, v136, 0 op_sel:[0,0,0] op_sel_hi:[1,1,0]
s_waitcnt lgkmcnt(7)
v_fma_mix_f32 v158, v137, v137, v158 op_sel:[1,1,0] op_sel_hi:[1,1,0]
v_rcp_f16_sdwa v151, v150 dst_sel:WORD_1 dst_unused:UNUSED_PRESERVE src0_sel:WORD_1
v_fma_mix_f32 v158, v138, v138, v158 op_sel:[0,0,0] op_sel_hi:[1,1,0]
ds_read_b128 v[216:219], v248 offset:43008
v_mfma_f32_32x32x16_bf16 v[120:135], v[68:71], v[220:223], v[120:135]
v_rcp_f16_sdwa v148, v147 dst_sel:WORD_1 dst_unused:UNUSED_PRESERVE src0_sel:WORD_1
v_fma_mix_f32 v158, v139, v139, v158 op_sel:[1,1,0] op_sel_hi:[1,1,0]
v_pk_mul_f16 v155, v155, v154
v_fma_mix_f32 v158, v140, v140, v158 op_sel:[0,0,0] op_sel_hi:[1,1,0]
v_pk_mul_f16 v152, v152, v151
v_fma_mix_f32 v158, v141, v141, v158 op_sel:[1,1,0] op_sel_hi:[1,1,0]
v_pk_mul_f16 v149, v149, v148
v_fma_mix_f32 v158, v155, v155, v158 op_sel:[0,0,0] op_sel_hi:[1,1,0]
v_fma_mix_f32 v158, v142, v142, v158 op_sel:[0,0,0] op_sel_hi:[1,1,0]
v_fma_mix_f32 v158, v155, v155, v158 op_sel:[1,1,0] op_sel_hi:[1,1,0]
s_waitcnt lgkmcnt(3)
v_fma_mix_f32 v158, v143, v143, v158 op_sel:[1,1,0] op_sel_hi:[1,1,0]
v_fma_mix_f32 v158, v152, v152, v158 op_sel:[0,0,0] op_sel_hi:[1,1,0]
v_fma_mix_f32 v158, v152, v152, v158 op_sel:[1,1,0] op_sel_hi:[1,1,0]
s_waitcnt lgkmcnt(1)
v_fma_mix_f32 v158, v144, v144, v158 op_sel:[0,0,0] op_sel_hi:[1,1,0]
v_fma_mix_f32 v158, v149, v149, v158 op_sel:[0,0,0] op_sel_hi:[1,1,0]
v_fma_mix_f32 v158, v145, v145, v158 op_sel:[1,1,0] op_sel_hi:[1,1,0]
v_fma_mix_f32 v158, v149, v149, v158 op_sel:[1,1,0] op_sel_hi:[1,1,0]
v_cvt_pkrtz_f16_f32 v137, v120, v121
v_cvt_pkrtz_f16_f32 v139, v122, v123
v_cvt_pkrtz_f16_f32 v141, v124, v125
v_cvt_pkrtz_f16_f32 v143, v126, v127
v_cvt_pkrtz_f16_f32 v145, v128, v129
v_cvt_pk_f16_f32 v155, v130, v131
v_cvt_pk_f16_f32 v152, v132, v133
v_cvt_pk_f16_f32 v149, v134, v135
ds_read_b128 v[220:223], v248 offset:46080
v_mfma_f32_32x32x16_bf16 v[120:135], v[48:51], v[224:227], 0
v_pk_fma_f16 v154, v155, v155, s48
v_and_b32_e64 v137, s49, v137
v_pk_fma_f16 v151, v152, v152, s48
v_and_b32_e64 v139, s49, v139
v_pk_fma_f16 v148, v149, v149, s48
v_pk_mul_f16 v154, v155, v154
v_bfe_u32 v136, v137, 2, 14
v_pk_mul_f16 v151, v152, v151
v_pk_mul_f16 v148, v149, v148
v_bfe_u32 v138, v139, 2, 14
ds_read_b128 v[224:227], v248 offset:47104
ds_read_u16_d16 v136, v136
ds_read_u16_d16 v138, v138
v_mfma_f32_32x32x16_bf16 v[120:135], v[52:55], v[228:231], v[120:135]
v_exp_f16 v153, v154
v_lshrrev_b32 v137, 18, v137
v_exp_f16 v150, v151
v_lshrrev_b32 v139, 18, v139
v_exp_f16 v147, v148
v_and_b32 v141, s49, v141
v_and_b32_e64 v143, s49, v143
ds_read_b128 v[228:231], v248 offset:50176
ds_read_u16_d16_hi v137, v137
ds_read_u16_d16_hi v139, v139
v_mfma_f32_32x32x16_bf16 v[120:135], v[56:59], v[232:235], v[120:135]
v_exp_f16_sdwa v153, v154 dst_sel:WORD_1 dst_unused:UNUSED_PRESERVE src0_sel:WORD_1
v_bfe_u32 v140, v141, 2, 14
v_exp_f16_sdwa v150, v151 dst_sel:WORD_1 dst_unused:UNUSED_PRESERVE src0_sel:WORD_1
v_bfe_u32 v142, v143, 2, 14
v_exp_f16_sdwa v147, v148 dst_sel:WORD_1 dst_unused:UNUSED_PRESERVE src0_sel:WORD_1
v_lshrrev_b32_e64 v141, 18, v141
v_pk_add_f16 v153, v153, 1.0 op_sel_hi:[1,0]
ds_read_b128 v[232:235], v248 offset:48128
ds_read_u16_d16 v140, v140
ds_read_u16_d16 v142, v142
ds_read_u16_d16_hi v141, v141
v_mfma_f32_32x32x16_bf16 v[120:135], v[60:63], v[236:239], v[120:135]
v_lshrrev_b32_e64 v143, 18, v143
v_pk_add_f16 v150, v150, 1.0 op_sel_hi:[1,0]
v_pk_add_f16 v147, v147, 1.0 op_sel_hi:[1,0]
v_and_b32 v145, s49, v145
v_rcp_f16 v154, v153
v_bfe_u32 v144, v145, 2, 14
v_rcp_f16_e64 v151, v150
v_lshrrev_b32 v145, 18, v145
s_waitcnt lgkmcnt(7)
ds_read_b128 v[236:239], v248 offset:51200
ds_read_u16_d16_hi v143, v143
ds_read_u16_d16 v144, v144
ds_read_u16_d16_hi v145, v145
v_mfma_f32_32x32x16_bf16 v[120:135], v[64:67], v[216:219], v[120:135]
v_rcp_f16 v148, v147
v_rcp_f16_sdwa v154, v153 dst_sel:WORD_1 dst_unused:UNUSED_PRESERVE src0_sel:WORD_1
v_fma_mix_f32 v159, v136, v136, 0 op_sel:[0,0,0] op_sel_hi:[1,1,0]
s_waitcnt lgkmcnt(8)
v_fma_mix_f32 v159, v137, v137, v159 op_sel:[1,1,0] op_sel_hi:[1,1,0]
v_rcp_f16_sdwa v151, v150 dst_sel:WORD_1 dst_unused:UNUSED_PRESERVE src0_sel:WORD_1
v_fma_mix_f32 v159, v138, v138, v159 op_sel:[0,0,0] op_sel_hi:[1,1,0]
ds_read_b128 v[216:219], v248 offset:49152
v_mfma_f32_32x32x16_bf16 v[120:135], v[68:71], v[220:223], v[120:135]
v_rcp_f16_sdwa v148, v147 dst_sel:WORD_1 dst_unused:UNUSED_PRESERVE src0_sel:WORD_1
v_fma_mix_f32 v159, v139, v139, v159 op_sel:[1,1,0] op_sel_hi:[1,1,0]
s_cmp_eq_u32 s40, 7
s_cbranch_scc1 Lrdy8
s_waitcnt vmcnt(0)
Lrdy8:
s_mov_b64 exec, 1
ds_add_u32 v253, v254 offset:12
s_mov_b64 exec, -1
v_pk_mul_f16 v155, v155, v154
s_waitcnt lgkmcnt(6)
v_fma_mix_f32 v159, v140, v140, v159 op_sel:[0,0,0] op_sel_hi:[1,1,0]
v_pk_mul_f16 v152, v152, v151
v_fma_mix_f32 v159, v141, v141, v159 op_sel:[1,1,0] op_sel_hi:[1,1,0]
v_pk_mul_f16 v149, v149, v148
v_fma_mix_f32 v159, v155, v155, v159 op_sel:[0,0,0] op_sel_hi:[1,1,0]
v_fma_mix_f32 v159, v142, v142, v159 op_sel:[0,0,0] op_sel_hi:[1,1,0]
v_fma_mix_f32 v159, v155, v155, v159 op_sel:[1,1,0] op_sel_hi:[1,1,0]
s_waitcnt lgkmcnt(2)
v_fma_mix_f32 v159, v143, v143, v159 op_sel:[1,1,0] op_sel_hi:[1,1,0]
v_fma_mix_f32 v159, v152, v152, v159 op_sel:[0,0,0] op_sel_hi:[1,1,0]
v_fma_mix_f32 v159, v152, v152, v159 op_sel:[1,1,0] op_sel_hi:[1,1,0]
v_fma_mix_f32 v159, v144, v144, v159 op_sel:[0,0,0] op_sel_hi:[1,1,0]
v_fma_mix_f32 v159, v149, v149, v159 op_sel:[0,0,0] op_sel_hi:[1,1,0]
v_fma_mix_f32 v159, v145, v145, v159 op_sel:[1,1,0] op_sel_hi:[1,1,0]
v_fma_mix_f32 v159, v149, v149, v159 op_sel:[1,1,0] op_sel_hi:[1,1,0]
v_cvt_pkrtz_f16_f32 v137, v120, v121
v_cvt_pkrtz_f16_f32 v139, v122, v123
v_cvt_pkrtz_f16_f32 v141, v124, v125
v_cvt_pkrtz_f16_f32 v143, v126, v127
v_cvt_pkrtz_f16_f32 v145, v128, v129
v_cvt_pk_f16_f32 v155, v130, v131
v_cvt_pk_f16_f32 v152, v132, v133
v_cvt_pk_f16_f32 v149, v134, v135
s_setprio 0
ds_read_b128 v[220:223], v248 offset:52224
v_mfma_f32_32x32x16_bf16 v[120:135], v[48:51], v[224:227], 0
v_pk_fma_f16 v154, v155, v155, s48
v_and_b32_e64 v137, s49, v137
v_pk_fma_f16 v151, v152, v152, s48
v_and_b32_e64 v139, s49, v139
v_pk_fma_f16 v148, v149, v149, s48
v_pk_mul_f16 v154, v155, v154
v_bfe_u32 v136, v137, 2, 14
v_pk_mul_f16 v151, v152, v151
v_pk_mul_f16 v148, v149, v148
v_bfe_u32 v138, v139, 2, 14
ds_read_b128 v[224:227], v250 offset:65520
ds_read_u16_d16 v136, v136
ds_read_u16_d16 v138, v138
v_mfma_f32_32x32x16_bf16 v[120:135], v[52:55], v[228:231], v[120:135]
v_exp_f16 v153, v154
v_lshrrev_b32 v137, 18, v137
v_exp_f16 v150, v151
v_lshrrev_b32 v139, 18, v139
v_exp_f16 v147, v148
v_and_b32 v141, s49, v141
v_and_b32_e64 v143, s49, v143
ds_read_b128 v[228:231], v248 offset:53248
ds_read_u16_d16_hi v137, v137
ds_read_b32 v247, v253 offset:12
ds_read_u16_d16_hi v139, v139
v_mfma_f32_32x32x16_bf16 v[120:135], v[56:59], v[232:235], v[120:135]
v_exp_f16_sdwa v153, v154 dst_sel:WORD_1 dst_unused:UNUSED_PRESERVE src0_sel:WORD_1
v_bfe_u32 v140, v141, 2, 14
v_exp_f16_sdwa v150, v151 dst_sel:WORD_1 dst_unused:UNUSED_PRESERVE src0_sel:WORD_1
v_bfe_u32 v142, v143, 2, 14
v_exp_f16_sdwa v147, v148 dst_sel:WORD_1 dst_unused:UNUSED_PRESERVE src0_sel:WORD_1
v_lshrrev_b32_e64 v141, 18, v141
v_pk_add_f16 v153, v153, 1.0 op_sel_hi:[1,0]
ds_read_b128 v[232:235], v248 offset:56320
ds_read_u16_d16 v140, v140
ds_read_u16_d16 v142, v142
ds_read_u16_d16_hi v141, v141
v_mfma_f32_32x32x16_bf16 v[120:135], v[60:63], v[236:239], v[120:135]
v_lshrrev_b32_e64 v143, 18, v143
v_pk_add_f16 v150, v150, 1.0 op_sel_hi:[1,0]
v_pk_add_f16 v147, v147, 1.0 op_sel_hi:[1,0]
v_and_b32 v145, s49, v145
v_rcp_f16 v154, v153
v_bfe_u32 v144, v145, 2, 14
ds_read_u16_d16_hi v143, v143
ds_read_u16_d16 v144, v144
s_waitcnt lgkmcnt(7)
v_readfirstlane_b32 s43, v247
s_nop 1
s_cmp_ge_u32 s43, 16
s_cbranch_scc1 Lev3
Lev3w:
s_sleep 1
ds_read_b32 v247, v253 offset:12
s_waitcnt lgkmcnt(0)
v_readfirstlane_b32 s43, v247
s_cmp_eq_u32 s76, 0
s_cbranch_scc1 Lev3
s_sub_u32 s76, s76, 1
s_cmp_lt_u32 s43, 16
s_cbranch_scc1 Lev3w
Lev3:
v_rcp_f16 v151, v150
v_lshrrev_b32_e64 v145, 18, v145
ds_read_b128 v[236:239], v245 offset:6528
ds_read_b128 v[192:195], v244 offset:128
ds_read_b128 v[196:199], v244 offset:64
ds_read_u16_d16_hi v145, v145
v_mfma_f32_32x32x16_bf16 v[120:135], v[64:67], v[216:219], v[120:135]
v_rcp_f16 v148, v147
v_rcp_f16_sdwa v154, v153 dst_sel:WORD_1 dst_unused:UNUSED_PRESERVE src0_sel:WORD_1
v_fma_mix_f32 v160, v136, v136, 0 op_sel:[0,0,0] op_sel_hi:[1,1,0]
v_fma_mix_f32 v160, v137, v137, v160 op_sel:[1,1,0] op_sel_hi:[1,1,0]
v_rcp_f16_sdwa v151, v150 dst_sel:WORD_1 dst_unused:UNUSED_PRESERVE src0_sel:WORD_1
v_fma_mix_f32 v160, v138, v138, v160 op_sel:[0,0,0] op_sel_hi:[1,1,0]
ds_read_b128 v[216:219], v248 offset:54272
v_mfma_f32_32x32x16_bf16 v[120:135], v[68:71], v[220:223], v[120:135]
v_rcp_f16_sdwa v148, v147 dst_sel:WORD_1 dst_unused:UNUSED_PRESERVE src0_sel:WORD_1
s_waitcnt lgkmcnt(5)
v_fma_mix_f32 v160, v139, v139, v160 op_sel:[1,1,0] op_sel_hi:[1,1,0]
v_pk_mul_f16 v155, v155, v154
v_fma_mix_f32 v160, v140, v140, v160 op_sel:[0,0,0] op_sel_hi:[1,1,0]
v_pk_mul_f16 v152, v152, v151
v_fma_mix_f32 v160, v141, v141, v160 op_sel:[1,1,0] op_sel_hi:[1,1,0]
v_pk_mul_f16 v149, v149, v148
v_fma_mix_f32 v160, v155, v155, v160 op_sel:[0,0,0] op_sel_hi:[1,1,0]
v_fma_mix_f32 v160, v142, v142, v160 op_sel:[0,0,0] op_sel_hi:[1,1,0]
v_fma_mix_f32 v160, v155, v155, v160 op_sel:[1,1,0] op_sel_hi:[1,1,0]
v_fma_mix_f32 v160, v143, v143, v160 op_sel:[1,1,0] op_sel_hi:[1,1,0]
v_fma_mix_f32 v160, v152, v152, v160 op_sel:[0,0,0] op_sel_hi:[1,1,0]
v_fma_mix_f32 v160, v152, v152, v160 op_sel:[1,1,0] op_sel_hi:[1,1,0]
v_fma_mix_f32 v160, v144, v144, v160 op_sel:[0,0,0] op_sel_hi:[1,1,0]
v_fma_mix_f32 v160, v149, v149, v160 op_sel:[0,0,0] op_sel_hi:[1,1,0]
s_waitcnt lgkmcnt(1)
v_fma_mix_f32 v160, v145, v145, v160 op_sel:[1,1,0] op_sel_hi:[1,1,0]
v_fma_mix_f32 v160, v149, v149, v160 op_sel:[1,1,0] op_sel_hi:[1,1,0]
s_setprio 2
v_mfma_f32_32x32x16_bf16 v[0:15], v[224:227], v[224:227], 0
ds_read_b128 v[220:223], v245 offset:6144
ds_read_b128 v[200:203], v244
ds_read_b128 v[204:207], v243 offset:128
v_cvt_pkrtz_f16_f32 v137, v120, v121
v_cvt_pkrtz_f16_f32 v139, v122, v123
v_cvt_pkrtz_f16_f32 v141, v124, v125
v_mfma_f32_32x32x16_bf16 v[16:31], v[224:227], v[224:227], 0
v_cvt_pkrtz_f16_f32 v143, v126, v127
v_cvt_pkrtz_f16_f32 v145, v128, v129
v_cvt_pk_f16_f32 v155, v130, v131
v_mfma_f32_32x32x16_bf16 v[32:47], v[224:227], v[224:227], 0
v_cvt_pk_f16_f32 v152, v132, v133
v_cvt_pk_f16_f32 v149, v134, v135
v_pk_fma_f16 v154, v155, v155, s48
v_mfma_f32_32x32x16_bf16 v[120:135], v[48:51], v[228:231], 0
ds_read_b128 v[224:227], v248 offset:57344
v_and_b32_e64 v137, s49, v137
v_pk_fma_f16 v151, v152, v152, s48
v_and_b32_e64 v139, s49, v139
v_pk_fma_f16 v148, v149, v149, s48
v_pk_mul_f16 v154, v155, v154
v_bfe_u32 v136, v137, 2, 14
v_mfma_f32_32x32x16_bf16 v[120:135], v[52:55], v[232:235], v[120:135]
ds_read_b128 v[228:231], v245 offset:5760
ds_read_b128 v[208:211], v243 offset:64
ds_read_b128 v[212:215], v243
ds_read_u16_d16 v136, v136
v_pk_mul_f16 v151, v152, v151
v_pk_mul_f16 v148, v149, v148
v_bfe_u32 v138, v139, 2, 14
v_exp_f16 v153, v154
v_lshrrev_b32 v137, 18, v137
v_smfmac_f32_16x16x32_bf16 v[40:43], v[238:239], v[192:195], v246
ds_read_b128 v[232:235], v248 offset:55296
ds_read_u16_d16 v138, v138
ds_read_u16_d16_hi v137, v137
v_exp_f16 v150, v151
v_lshrrev_b32 v139, 18, v139
v_smfmac_f32_16x16x32_bf16 v[24:27], v[236:237], v[196:199], v246
v_exp_f16_e64 v147, v148
v_and_b32 v141, s49, v141
s_waitcnt lgkmcnt(7)
v_mfma_f32_32x32x16_bf16 v[120:135], v[56:59], v[216:219], v[120:135]
ds_read_b128 v[236:239], v245 offset:5376
ds_read_b128 v[192:195], v242 offset:128
ds_read_b128 v[196:199], v242 offset:64
ds_read_u16_d16_hi v139, v139
v_and_b32_e64 v143, s49, v143
v_exp_f16_sdwa v153, v154 dst_sel:WORD_1 dst_unused:UNUSED_PRESERVE src0_sel:WORD_1
v_bfe_u32 v140, v141, 2, 14
v_exp_f16_sdwa v150, v151 dst_sel:WORD_1 dst_unused:UNUSED_PRESERVE src0_sel:WORD_1
v_smfmac_f32_16x16x32_bf16 v[8:11], v[222:223], v[200:203], v246
ds_read_b128 v[216:219], v248 offset:58368
ds_read_u16_d16 v140, v140
v_bfe_u32 v142, v143, 2, 14
v_exp_f16_sdwa v147, v148 dst_sel:WORD_1 dst_unused:UNUSED_PRESERVE src0_sel:WORD_1
v_smfmac_f32_16x16x32_bf16 v[40:43], v[220:221], v[204:207], v246
v_lshrrev_b32_e64 v141, 18, v141
v_pk_add_f16 v153, v153, 1.0 op_sel_hi:[1,0]
v_lshrrev_b32 v143, 18, v143
v_mfma_f32_32x32x16_bf16 v[120:135], v[60:63], v[224:227], v[120:135]
ds_read_b128 v[220:223], v245 offset:4992
ds_read_b128 v[200:203], v242
v_xor_b32 v244, 16, v244
ds_read_b128 v[204:207], v244 offset:128
ds_read_u16_d16 v142, v142
ds_read_u16_d16_hi v141, v141
ds_read_u16_d16_hi v143, v143
v_pk_add_f16 v150, v150, 1.0 op_sel_hi:[1,0]
v_pk_add_f16 v147, v147, 1.0 op_sel_hi:[1,0]
v_and_b32_e64 v145, s49, v145
v_rcp_f16 v154, v153
v_bfe_u32 v144, v145, 2, 14
s_waitcnt lgkmcnt(8)
v_smfmac_f32_16x16x32_bf16 v[24:27], v[230:231], v[208:211], v246
ds_read_b128 v[224:227], v245 offset:4608
ds_read_u16_d16 v144, v144
v_rcp_f16 v151, v150
v_lshrrev_b32 v145, 18, v145
v_smfmac_f32_16x16x32_bf16 v[8:11], v[228:229], v[212:215], v246
v_rcp_f16_e64 v148, v147
v_mfma_f32_32x32x16_bf16 v[120:135], v[64:67], v[232:235], v[120:135]
ds_read_b128 v[208:211], v244 offset:64
ds_read_b128 v[212:215], v244
ds_read_b128 v[228:231], v248 offset:59392
ds_read_u16_d16_hi v145, v145
v_rcp_f16_sdwa v154, v153 dst_sel:WORD_1 dst_unused:UNUSED_PRESERVE src0_sel:WORD_1
v_fma_mix_f32 v161, v136, v136, 0 op_sel:[0,0,0] op_sel_hi:[1,1,0]
v_fma_mix_f32 v161, v137, v137, v161 op_sel:[1,1,0] op_sel_hi:[1,1,0]
v_rcp_f16_sdwa v151, v150 dst_sel:WORD_1 dst_unused:UNUSED_PRESERVE src0_sel:WORD_1
v_fma_mix_f32 v161, v138, v138, v161 op_sel:[0,0,0] op_sel_hi:[1,1,0]
v_smfmac_f32_16x16x32_bf16 v[40:43], v[238:239], v[192:195], v246
ds_read_b128 v[232:235], v248 offset:62464
v_rcp_f16_sdwa v148, v147 dst_sel:WORD_1 dst_unused:UNUSED_PRESERVE src0_sel:WORD_1
v_fma_mix_f32 v161, v139, v139, v161 op_sel:[1,1,0] op_sel_hi:[1,1,0]
v_smfmac_f32_16x16x32_bf16 v[24:27], v[236:237], v[196:199], v246
v_pk_mul_f16 v155, v155, v154
s_waitcnt lgkmcnt(7)
v_fma_mix_f32 v161, v140, v140, v161 op_sel:[0,0,0] op_sel_hi:[1,1,0]
v_pk_mul_f16 v152, v152, v151
v_mfma_f32_32x32x16_bf16 v[120:135], v[68:71], v[216:219], v[120:135]
ds_read_b128 v[236:239], v248 offset:60416
v_fma_mix_f32 v161, v141, v141, v161 op_sel:[1,1,0] op_sel_hi:[1,1,0]
v_pk_mul_f16 v149, v149, v148
v_fma_mix_f32 v161, v155, v155, v161 op_sel:[0,0,0] op_sel_hi:[1,1,0]
v_fma_mix_f32 v161, v142, v142, v161 op_sel:[0,0,0] op_sel_hi:[1,1,0]
v_fma_mix_f32 v161, v155, v155, v161 op_sel:[1,1,0] op_sel_hi:[1,1,0]
v_fma_mix_f32 v161, v143, v143, v161 op_sel:[1,1,0] op_sel_hi:[1,1,0]
v_smfmac_f32_16x16x32_bf16 v[8:11], v[222:223], v[200:203], v246
ds_read_b128 v[216:219], v245 offset:4224
v_xor_b32 v243, 16, v243
ds_read_b128 v[192:195], v243 offset:128
ds_read_b128 v[196:199], v243 offset:64
v_fma_mix_f32 v161, v152, v152, v161 op_sel:[0,0,0] op_sel_hi:[1,1,0]
v_fma_mix_f32 v161, v152, v152, v161 op_sel:[1,1,0] op_sel_hi:[1,1,0]
s_waitcnt lgkmcnt(5)
v_fma_mix_f32 v161, v144, v144, v161 op_sel:[0,0,0] op_sel_hi:[1,1,0]
v_smfmac_f32_16x16x32_bf16 v[44:47], v[220:221], v[204:207], v246
v_fma_mix_f32 v161, v149, v149, v161 op_sel:[0,0,0] op_sel_hi:[1,1,0]
v_fma_mix_f32 v161, v145, v145, v161 op_sel:[1,1,0] op_sel_hi:[1,1,0]
v_fma_mix_f32 v161, v149, v149, v161 op_sel:[1,1,0] op_sel_hi:[1,1,0]
s_cmp_lg_u32 s40, 7
s_cbranch_scc1 Lnosent
v_mov_b32 v180, -1
v_mov_b32 v181, -1
v_mov_b32 v182, -1
v_mov_b32 v183, -1
v_lshlrev_b32 v176, 12, v251
v_add_u32 v177, 262144, v176
v_cmp_gt_u32 vcc, 32, v251
v_mov_b32 v178, 2147483648
s_nop 0
v_cndmask_b32 v177, v178, v177, vcc
s_lshl_b32 s43, s2, 4
buffer_store_dwordx4 v[180:183], v176, s[32:35], s43 offen sc1
buffer_store_dwordx4 v[180:183], v177, s[32:35], s43 offen sc1
s_add_u32 s43, s43, 393216
s_cmp_lt_u32 s2, 96
s_cselect_b32 s43, s43, 1073741824
v_lshlrev_b32_e64 v178, 11, v251
s_mov_b64 exec, 0xff
buffer_store_dwordx4 v[180:183], v178, s[32:35], s43 offen sc1
s_mov_b64 exec, -1
s_sub_u32 s43, s2, 96
s_cmp_lt_u32 s43, 96
s_cbranch_scc0 Lnobias
s_lshl_b32 s44, s43, 1
v_mul_u32_u24 v176, 192, v251
v_lshlrev_b32 v177, 1, v251
s_add_u32 s45, s44, 0
buffer_load_ushort v178, v176, s[16:19], s45 offen
buffer_load_ushort v184, v177, s[28:31], 0 offen offset:0
s_add_u32 s45, s44, 12288
buffer_load_ushort v179, v176, s[16:19], s45 offen
buffer_load_ushort v185, v177, s[28:31], 0 offen offset:128
s_add_u32 s45, s44, 24576
buffer_load_ushort v180, v176, s[16:19], s45 offen
buffer_load_ushort v186, v177, s[28:31], 0 offen offset:256
s_add_u32 s45, s44, 36864
buffer_load_ushort v181, v176, s[16:19], s45 offen
buffer_load_ushort v187, v177, s[28:31], 0 offen offset:384
s_add_u32 s45, s44, 49152
buffer_load_ushort v182, v176, s[16:19], s45 offen
buffer_load_ushort v188, v177, s[28:31], 0 offen offset:512
s_add_u32 s45, s44, 61440
buffer_load_ushort v183, v176, s[16:19], s45 offen
buffer_load_ushort v189, v177, s[28:31], 0 offen offset:640
Lnobias:
s_nop 1
Lnosent:
s_setprio 1
v_smfmac_f32_16x16x32_bf16 v[28:31], v[226:227], v[208:211], v246
ds_read_b128 v[220:223], v248 offset:63488
v_cvt_pkrtz_f16_f32 v137, v120, v121
v_cvt_pkrtz_f16_f32 v139, v122, v123
v_cvt_pkrtz_f16_f32 v141, v124, v125
v_cvt_pkrtz_f16_f32 v143, v126, v127
v_smfmac_f32_16x16x32_bf16 v[12:15], v[224:225], v[212:215], v246
v_cvt_pk_f16_f32 v155, v128, v129
v_cvt_pk_f16_f32 v152, v130, v131
v_cvt_pk_f16_f32 v149, v132, v133
v_cvt_pk_f16_f32 v146, v134, v135
v_mfma_f32_32x32x16_bf16 v[120:135], v[48:51], v[228:231], 0
ds_read_b128 v[224:227], v248 offset:61440
v_pk_fma_f16 v154, v155, v155, s48
v_and_b32_e64 v137, s49, v137
v_pk_fma_f16 v151, v152, v152, s48
v_pk_fma_f16 v148, v149, v149, s48
v_and_b32_e64 v139, s49, v139
v_pk_fma_f16 v145, v146, v146, s48
v_pk_mul_f16 v154, v155, v154
v_bfe_u32 v136, v137, 2, 14
s_waitcnt lgkmcnt(2)
v_mfma_f32_32x32x16_bf16 v[120:135], v[52:55], v[232:235], v[120:135]
ds_read_b128 v[228:231], v245 offset:3840
ds_read_b128 v[200:203], v243
v_xor_b32 v242, 16, v242
ds_read_b128 v[204:207], v242 offset:128
ds_read_u16_d16 v136, v136
v_pk_mul_f16 v151, v152, v151
v_pk_mul_f16 v148, v149, v148
v_bfe_u32 v138, v139, 2, 14
v_pk_mul_f16 v145, v146, v145
v_exp_f16 v153, v154
v_lshrrev_b32 v137, 18, v137
v_exp_f16_e64 v150, v151
v_mfma_f32_32x32x16_bf16 v[120:135], v[56:59], v[236:239], v[120:135]
ds_read_b128 v[232:235], v248 offset:64512
ds_read_u16_d16 v138, v138
ds_read_u16_d16_hi v137, v137
v_lshrrev_b32 v139, 18, v139
v_exp_f16 v147, v148
v_and_b32 v141, s49, v141
v_exp_f16 v144, v145
v_and_b32_e64 v143, s49, v143
v_smfmac_f32_16x16x32_bf16 v[44:47], v[218:219], v[192:195], v246
ds_read_b128 v[236:239], v245 offset:3456
ds_read_b128 v[208:211], v242 offset:64
ds_read_b128 v[212:215], v242
ds_read_u16_d16_hi v139, v139
v_exp_f16_sdwa v153, v154 dst_sel:WORD_1 dst_unused:UNUSED_PRESERVE src0_sel:WORD_1
v_bfe_u32 v140, v141, 2, 14
v_exp_f16_sdwa v150, v151 dst_sel:WORD_1 dst_unused:UNUSED_PRESERVE src0_sel:WORD_1
v_smfmac_f32_16x16x32_bf16 v[28:31], v[216:217], v[196:199], v246
v_bfe_u32 v142, v143, 2, 14
v_exp_f16_sdwa v147, v148 dst_sel:WORD_1 dst_unused:UNUSED_PRESERVE src0_sel:WORD_1
v_lshrrev_b32_e64 v141, 18, v141
s_waitcnt lgkmcnt(7)
v_mfma_f32_32x32x16_bf16 v[120:135], v[60:63], v[220:223], v[120:135]
ds_read_b128 v[216:219], v245 offset:3072
v_xor_b32 v244, 32, v244
ds_read_b128 v[192:195], v244 offset:128
ds_read_b128 v[196:199], v244 offset:64
ds_read_u16_d16 v140, v140
ds_read_u16_d16 v142, v142
ds_read_u16_d16_hi v141, v141
v_exp_f16_sdwa v144, v145 dst_sel:WORD_1 dst_unused:UNUSED_PRESERVE src0_sel:WORD_1
v_lshrrev_b32_e64 v143, 18, v143
v_pk_add_f16 v153, v153, 1.0 op_sel_hi:[1,0]
v_pk_add_f16 v150, v150, 1.0 op_sel_hi:[1,0]
v_pk_add_f16 v147, v147, 1.0 op_sel_hi:[1,0]
v_pk_add_f16 v144, v144, 1.0 op_sel_hi:[1,0]
v_rcp_f16_e64 v154, v153
v_mfma_f32_32x32x16_bf16 v[120:135], v[64:67], v[224:227], v[120:135]
ds_read_b128 v[220:223], v249
ds_read_u16_d16_hi v143, v143
v_rcp_f16 v151, v150
v_rcp_f16 v148, v147
v_rcp_f16_e64 v145, v144
v_rcp_f16_sdwa v154, v153 dst_sel:WORD_1 dst_unused:UNUSED_PRESERVE src0_sel:WORD_1
v_smfmac_f32_16x16x32_bf16 v[12:15], v[230:231], v[200:203], v246
ds_read_b128 v[224:227], v249 offset:3072
v_rcp_f16_sdwa v151, v150 dst_sel:WORD_1 dst_unused:UNUSED_PRESERVE src0_sel:WORD_1
s_setprio 0
v_rcp_f16_sdwa v148, v147 dst_sel:WORD_1 dst_unused:UNUSED_PRESERVE src0_sel:WORD_1
v_fma_mix_f32 v162, v136, v136, 0 op_sel:[0,0,0] op_sel_hi:[1,1,0]
v_smfmac_f32_16x16x32_bf16 v[44:47], v[228:229], v[204:207], v246
v_rcp_f16_sdwa v145, v144 dst_sel:WORD_1 dst_unused:UNUSED_PRESERVE src0_sel:WORD_1
s_waitcnt lgkmcnt(5)
v_fma_mix_f32 v162, v137, v137, v162 op_sel:[1,1,0] op_sel_hi:[1,1,0]
v_pk_mul_f16 v155, v155, v154
v_mfma_f32_32x32x16_bf16 v[120:135], v[68:71], v[232:235], v[120:135]
ds_read_b128 v[228:231], v245 offset:2688
ds_read_b128 v[200:203], v244
v_xor_b32 v243, 32, v243
ds_read_b128 v[204:207], v243 offset:128
v_fma_mix_f32 v162, v138, v138, v162 op_sel:[0,0,0] op_sel_hi:[1,1,0]
v_pk_mul_f16 v152, v152, v151
v_pk_mul_f16 v149, v149, v148
v_fma_mix_f32 v162, v139, v139, v162 op_sel:[1,1,0] op_sel_hi:[1,1,0]
v_pk_mul_f16 v146, v146, v145
v_fma_mix_f32 v162, v155, v155, v162 op_sel:[0,0,0] op_sel_hi:[1,1,0]
v_fma_mix_f32 v162, v140, v140, v162 op_sel:[0,0,0] op_sel_hi:[1,1,0]
v_fma_mix_f32 v162, v155, v155, v162 op_sel:[1,1,0] op_sel_hi:[1,1,0]
v_smfmac_f32_16x16x32_bf16 v[28:31], v[238:239], v[208:211], v246
ds_read_b128 v[232:235], v249 offset:1024
v_fma_mix_f32 v162, v152, v152, v162 op_sel:[0,0,0] op_sel_hi:[1,1,0]
s_waitcnt lgkmcnt(4)
v_fma_mix_f32 v162, v141, v141, v162 op_sel:[1,1,0] op_sel_hi:[1,1,0]
v_fma_mix_f32 v162, v152, v152, v162 op_sel:[1,1,0] op_sel_hi:[1,1,0]
v_fma_mix_f32 v162, v149, v149, v162 op_sel:[0,0,0] op_sel_hi:[1,1,0]
v_smfmac_f32_16x16x32_bf16 v[12:15], v[236:237], v[212:215], v246
v_fma_mix_f32 v162, v142, v142, v162 op_sel:[0,0,0] op_sel_hi:[1,1,0]
v_fma_mix_f32 v162, v149, v149, v162 op_sel:[1,1,0] op_sel_hi:[1,1,0]
v_fma_mix_f32 v162, v146, v146, v162 op_sel:[0,0,0] op_sel_hi:[1,1,0]
v_fma_mix_f32 v162, v143, v143, v162 op_sel:[1,1,0] op_sel_hi:[1,1,0]
v_fma_mix_f32 v162, v146, v146, v162 op_sel:[1,1,0] op_sel_hi:[1,1,0]
v_lshlrev_b32_e64 v252, 7, v251
s_add_u32 s46, s47, 1572864
s_mov_b32 exec_lo, 131071
s_mov_b32 exec_hi, 0
s_mov_b32 m0, 16288
s_nop 0
buffer_load_dword v252, s[4:7], s46 offen lds
s_mov_b64 exec, -1
s_setprio 2
v_smfmac_f32_16x16x32_bf16 v[36:39], v[218:219], v[192:195], v246
ds_read_b128 v[236:239], v249 offset:4096
v_cvt_pkrtz_f16_f32 v137, v120, v121
v_cvt_pkrtz_f16_f32 v139, v122, v123
v_cvt_pkrtz_f16_f32 v141, v124, v125
v_smfmac_f32_16x16x32_bf16 v[20:23], v[216:217], v[196:199], v246
v_cvt_pkrtz_f16_f32 v143, v126, v127
v_cvt_pkrtz_f16_f32 v145, v128, v129
v_cvt_pk_f16_f32 v155, v130, v131
v_cvt_pk_f16_f32 v152, v132, v133
v_cvt_pk_f16_f32 v149, v134, v135
v_mfma_f32_32x32x16_bf16 v[120:135], v[48:51], v[220:223], 0
ds_read_b128 v[216:219], v245 offset:2304
ds_read_b128 v[208:211], v243 offset:64
ds_read_b128 v[212:215], v243
v_pk_fma_f16 v154, v155, v155, s48
v_and_b32_e64 v137, s49, v137
v_pk_fma_f16 v151, v152, v152, s48
v_and_b32_e64 v139, s49, v139
v_pk_fma_f16 v148, v149, v149, s48
v_mfma_f32_32x32x16_bf16 v[120:135], v[52:55], v[224:227], v[120:135]
ds_read_b128 v[220:223], v249 offset:2048
v_pk_mul_f16 v154, v155, v154
v_bfe_u32 v136, v137, 2, 14
v_pk_mul_f16 v151, v152, v151
v_pk_mul_f16 v148, v149, v148
v_bfe_u32 v138, v139, 2, 14
v_exp_f16_e64 v153, v154
s_waitcnt lgkmcnt(4)
v_smfmac_f32_16x16x32_bf16 v[4:7], v[230:231], v[200:203], v246
ds_read_b128 v[224:227], v245 offset:1920
v_xor_b32 v242, 32, v242
ds_read_b128 v[192:195], v242 offset:128
ds_read_b128 v[196:199], v242 offset:64
ds_read_u16_d16 v136, v136
ds_read_u16_d16 v138, v138
v_lshrrev_b32 v137, 18, v137
v_exp_f16 v150, v151
v_smfmac_f32_16x16x32_bf16 v[36:39], v[228:229], v[204:207], v246
v_lshrrev_b32 v139, 18, v139
v_exp_f16 v147, v148
v_and_b32_e64 v141, s49, v141
v_mfma_f32_32x32x16_bf16 v[120:135], v[56:59], v[232:235], v[120:135]
ds_read_b128 v[228:231], v249 offset:5120
ds_read_u16_d16_hi v137, v137
ds_read_u16_d16_hi v139, v139
v_and_b32_e64 v143, s49, v143
v_exp_f16_sdwa v153, v154 dst_sel:WORD_1 dst_unused:UNUSED_PRESERVE src0_sel:WORD_1
v_bfe_u32 v140, v141, 2, 14
v_exp_f16_sdwa v150, v151 dst_sel:WORD_1 dst_unused:UNUSED_PRESERVE src0_sel:WORD_1
v_bfe_u32 v142, v143, 2, 14
v_mfma_f32_32x32x16_bf16 v[120:135], v[60:63], v[236:239], v[120:135]
ds_read_b128 v[232:235], v245 offset:1536
ds_read_b128 v[200:203], v242
v_xor_b32 v244, 16, v244
ds_read_b128 v[204:207], v244 offset:128
ds_read_u16_d16 v140, v140
ds_read_u16_d16 v142, v142
v_exp_f16_sdwa v147, v148 dst_sel:WORD_1 dst_unused:UNUSED_PRESERVE src0_sel:WORD_1
v_lshrrev_b32 v141, 18, v141
v_pk_add_f16 v153, v153, 1.0 op_sel_hi:[1,0]
v_lshrrev_b32 v143, 18, v143
v_pk_add_f16 v150, v150, 1.0 op_sel_hi:[1,0]
s_waitcnt lgkmcnt(8)
v_smfmac_f32_16x16x32_bf16 v[20:23], v[218:219], v[208:211], v246
ds_read_b128 v[236:239], v245 offset:1152
ds_read_u16_d16_hi v141, v141
ds_read_u16_d16_hi v143, v143
v_pk_add_f16 v147, v147, 1.0 op_sel_hi:[1,0]
v_and_b32 v145, s49, v145
v_rcp_f16 v154, v153
v_smfmac_f32_16x16x32_bf16 v[4:7], v[216:217], v[212:215], v246
v_bfe_u32 v144, v145, 2, 14
v_rcp_f16_e64 v151, v150
v_mfma_f32_32x32x16_bf16 v[120:135], v[64:67], v[220:223], v[120:135]
ds_read_b128 v[208:211], v244 offset:64
ds_read_b128 v[212:215], v244
ds_read_b128 v[216:219], v249 offset:6144
ds_read_u16_d16 v144, v144
v_lshrrev_b32_e64 v145, 18, v145
v_rcp_f16 v148, v147
v_rcp_f16_sdwa v154, v153 dst_sel:WORD_1 dst_unused:UNUSED_PRESERVE src0_sel:WORD_1
ds_read_u16_d16_hi v145, v145
v_fma_mix_f32 v163, v136, v136, 0 op_sel:[0,0,0] op_sel_hi:[1,1,0]
s_waitcnt lgkmcnt(8)
v_fma_mix_f32 v163, v137, v137, v163 op_sel:[1,1,0] op_sel_hi:[1,1,0]
v_smfmac_f32_16x16x32_bf16 v[36:39], v[226:227], v[192:195], v246
ds_read_b128 v[220:223], v249 offset:9216
v_rcp_f16_sdwa v151, v150 dst_sel:WORD_1 dst_unused:UNUSED_PRESERVE src0_sel:WORD_1
v_fma_mix_f32 v163, v138, v138, v163 op_sel:[0,0,0] op_sel_hi:[1,1,0]
v_smfmac_f32_16x16x32_bf16 v[20:23], v[224:225], v[196:199], v246
v_rcp_f16_sdwa v148, v147 dst_sel:WORD_1 dst_unused:UNUSED_PRESERVE src0_sel:WORD_1
v_fma_mix_f32 v163, v139, v139, v163 op_sel:[1,1,0] op_sel_hi:[1,1,0]
v_pk_mul_f16 v155, v155, v154
v_mfma_f32_32x32x16_bf16 v[120:135], v[68:71], v[228:231], v[120:135]
ds_read_b128 v[224:227], v249 offset:7168
v_fma_mix_f32 v163, v140, v140, v163 op_sel:[0,0,0] op_sel_hi:[1,1,0]
v_pk_mul_f16 v152, v152, v151
s_waitcnt lgkmcnt(7)
v_fma_mix_f32 v163, v141, v141, v163 op_sel:[1,1,0] op_sel_hi:[1,1,0]
v_pk_mul_f16 v149, v149, v148
v_fma_mix_f32 v163, v155, v155, v163 op_sel:[0,0,0] op_sel_hi:[1,1,0]
v_fma_mix_f32 v163, v142, v142, v163 op_sel:[0,0,0] op_sel_hi:[1,1,0]
v_fma_mix_f32 v163, v155, v155, v163 op_sel:[1,1,0] op_sel_hi:[1,1,0]
v_smfmac_f32_16x16x32_bf16 v[4:7], v[234:235], v[200:203], v246
ds_read_b128 v[228:231], v245 offset:768
v_xor_b32 v243, 16, v243
ds_read_b128 v[192:195], v243 offset:128
ds_read_b128 v[196:199], v243 offset:64
v_fma_mix_f32 v163, v143, v143, v163 op_sel:[1,1,0] op_sel_hi:[1,1,0]
v_fma_mix_f32 v163, v152, v152, v163 op_sel:[0,0,0] op_sel_hi:[1,1,0]
v_fma_mix_f32 v163, v152, v152, v163 op_sel:[1,1,0] op_sel_hi:[1,1,0]
v_smfmac_f32_16x16x32_bf16 v[32:35], v[232:233], v[204:207], v246
s_waitcnt lgkmcnt(4)
v_fma_mix_f32 v163, v144, v144, v163 op_sel:[0,0,0] op_sel_hi:[1,1,0]
v_fma_mix_f32 v163, v149, v149, v163 op_sel:[0,0,0] op_sel_hi:[1,1,0]
v_fma_mix_f32 v163, v145, v145, v163 op_sel:[1,1,0] op_sel_hi:[1,1,0]
v_fma_mix_f32 v163, v149, v149, v163 op_sel:[1,1,0] op_sel_hi:[1,1,0]
v_lshlrev_b32 v252, 7, v251
s_add_u32 s46, s47, 1572864
s_mov_b32 exec_lo, 4294836224
s_mov_b32 exec_hi, 3
s_mov_b32 m0, 16220
s_nop 0
buffer_load_dword v252, s[4:7], s46 offen lds
s_mov_b64 exec, -1
s_setprio 1
v_smfmac_f32_16x16x32_bf16 v[16:19], v[238:239], v[208:211], v246
ds_read_b128 v[232:235], v249 offset:10240
v_cvt_pkrtz_f16_f32 v137, v120, v121
v_cvt_pkrtz_f16_f32 v139, v122, v123
v_cvt_pkrtz_f16_f32 v141, v124, v125
v_smfmac_f32_16x16x32_bf16 v[0:3], v[236:237], v[212:215], v246
v_cvt_pkrtz_f16_f32 v143, v126, v127
v_cvt_pk_f16_f32 v155, v128, v129
v_cvt_pk_f16_f32 v152, v130, v131
v_cvt_pk_f16_f32 v149, v132, v133
v_cvt_pk_f16_f32 v146, v134, v135
v_mfma_f32_32x32x16_bf16 v[120:135], v[48:51], v[216:219], 0
ds_read_b128 v[236:239], v249 offset:8192
v_pk_fma_f16 v154, v155, v155, s48
v_and_b32_e64 v137, s49, v137
v_pk_fma_f16 v151, v152, v152, s48
v_pk_fma_f16 v148, v149, v149, s48
v_and_b32 v139, s49, v139
v_pk_fma_f16 v145, v146, v146, s48
v_pk_mul_f16 v154, v155, v154
v_mfma_f32_32x32x16_bf16 v[120:135], v[52:55], v[220:223], v[120:135]
ds_read_b128 v[216:219], v245 offset:384
ds_read_b128 v[200:203], v243
v_xor_b32 v242, 16, v242
ds_read_b128 v[204:207], v242 offset:128
v_bfe_u32 v136, v137, 2, 14
v_pk_mul_f16 v151, v152, v151
v_pk_mul_f16 v148, v149, v148
v_bfe_u32 v138, v139, 2, 14
v_pk_mul_f16 v145, v146, v145
v_exp_f16 v153, v154
s_waitcnt lgkmcnt(4)
v_mfma_f32_32x32x16_bf16 v[120:135], v[56:59], v[224:227], v[120:135]
ds_read_b128 v[220:223], v249 offset:11264
ds_read_u16_d16 v136, v136
ds_read_u16_d16 v138, v138
v_lshrrev_b32 v137, 18, v137
v_exp_f16 v150, v151
v_lshrrev_b32 v139, 18, v139
v_exp_f16 v147, v148
v_and_b32_e64 v141, s49, v141
v_smfmac_f32_16x16x32_bf16 v[32:35], v[230:231], v[192:195], v246
ds_read_b128 v[224:227], v245
ds_read_b128 v[208:211], v242 offset:64
ds_read_b128 v[212:215], v242
ds_read_u16_d16_hi v137, v137
ds_read_u16_d16_hi v139, v139
v_exp_f16 v144, v145
v_and_b32 v143, s49, v143
v_exp_f16_sdwa v153, v154 dst_sel:WORD_1 dst_unused:UNUSED_PRESERVE src0_sel:WORD_1
v_smfmac_f32_16x16x32_bf16 v[16:19], v[228:229], v[196:199], v246
v_bfe_u32 v140, v141, 2, 14
v_exp_f16_sdwa v150, v151 dst_sel:WORD_1 dst_unused:UNUSED_PRESERVE src0_sel:WORD_1
v_mfma_f32_32x32x16_bf16 v[120:135], v[60:63], v[232:235], v[120:135]
ds_read_b128 v[228:231], v249 offset:12288
ds_read_u16_d16 v140, v140
v_bfe_u32 v142, v143, 2, 14
v_exp_f16_sdwa v147, v148 dst_sel:WORD_1 dst_unused:UNUSED_PRESERVE src0_sel:WORD_1
v_lshrrev_b32_e64 v141, 18, v141
v_exp_f16_sdwa v144, v145 dst_sel:WORD_1 dst_unused:UNUSED_PRESERVE src0_sel:WORD_1
v_lshrrev_b32 v143, 18, v143
v_pk_add_f16 v153, v153, 1.0 op_sel_hi:[1,0]
s_waitcnt lgkmcnt(7)
v_mfma_f32_32x32x16_bf16 v[120:135], v[64:67], v[236:239], v[120:135]
ds_read_b128 v[232:235], v249 offset:15360
ds_read_u16_d16 v142, v142
ds_read_u16_d16_hi v141, v141
ds_read_u16_d16_hi v143, v143
v_pk_add_f16 v150, v150, 1.0 op_sel_hi:[1,0]
v_pk_add_f16 v147, v147, 1.0 op_sel_hi:[1,0]
v_pk_add_f16 v144, v144, 1.0 op_sel_hi:[1,0]
v_rcp_f16 v154, v153
v_rcp_f16 v151, v150
v_smfmac_f32_16x16x32_bf16 v[0:3], v[218:219], v[200:203], v246
ds_read_b128 v[236:239], v249 offset:13312
v_rcp_f16 v148, v147
v_rcp_f16 v145, v144
v_smfmac_f32_16x16x32_bf16 v[32:35], v[216:217], v[204:207], v246
v_rcp_f16_sdwa v154, v153 dst_sel:WORD_1 dst_unused:UNUSED_PRESERVE src0_sel:WORD_1
v_rcp_f16_sdwa v151, v150 dst_sel:WORD_1 dst_unused:UNUSED_PRESERVE src0_sel:WORD_1
s_setprio 0
v_mfma_f32_32x32x16_bf16 v[120:135], v[68:71], v[220:223], v[120:135]
ds_read_b128 v[216:219], v249 offset:16384
v_rcp_f16_sdwa v148, v147 dst_sel:WORD_1 dst_unused:UNUSED_PRESERVE src0_sel:WORD_1
v_fma_mix_f32 v164, v136, v136, 0 op_sel:[0,0,0] op_sel_hi:[1,1,0]
v_rcp_f16_sdwa v145, v144 dst_sel:WORD_1 dst_unused:UNUSED_PRESERVE src0_sel:WORD_1
s_waitcnt lgkmcnt(6)
v_fma_mix_f32 v164, v137, v137, v164 op_sel:[1,1,0] op_sel_hi:[1,1,0]
v_pk_mul_f16 v155, v155, v154
v_fma_mix_f32 v164, v138, v138, v164 op_sel:[0,0,0] op_sel_hi:[1,1,0]
v_smfmac_f32_16x16x32_bf16 v[16:19], v[226:227], v[208:211], v246
ds_read_b128 v[220:223], v249 offset:14336
v_pk_mul_f16 v152, v152, v151
v_pk_mul_f16 v149, v149, v148
v_fma_mix_f32 v164, v139, v139, v164 op_sel:[1,1,0] op_sel_hi:[1,1,0]
v_pk_mul_f16 v146, v146, v145
v_smfmac_f32_16x16x32_bf16 v[0:3], v[224:225], v[212:215], v246
s_mov_b64 exec, 1
ds_add_u32 v253, v254 offset:16
s_mov_b64 exec, -1
v_fma_mix_f32 v164, v155, v155, v164 op_sel:[0,0,0] op_sel_hi:[1,1,0]
v_fma_mix_f32 v164, v140, v140, v164 op_sel:[0,0,0] op_sel_hi:[1,1,0]
v_fma_mix_f32 v164, v155, v155, v164 op_sel:[1,1,0] op_sel_hi:[1,1,0]
v_fma_mix_f32 v164, v152, v152, v164 op_sel:[0,0,0] op_sel_hi:[1,1,0]
s_waitcnt lgkmcnt(3)
v_fma_mix_f32 v164, v141, v141, v164 op_sel:[1,1,0] op_sel_hi:[1,1,0]
v_fma_mix_f32 v164, v152, v152, v164 op_sel:[1,1,0] op_sel_hi:[1,1,0]
v_fma_mix_f32 v164, v149, v149, v164 op_sel:[0,0,0] op_sel_hi:[1,1,0]
v_fma_mix_f32 v164, v142, v142, v164 op_sel:[0,0,0] op_sel_hi:[1,1,0]
v_fma_mix_f32 v164, v149, v149, v164 op_sel:[1,1,0] op_sel_hi:[1,1,0]
v_fma_mix_f32 v164, v146, v146, v164 op_sel:[0,0,0] op_sel_hi:[1,1,0]
v_fma_mix_f32 v164, v143, v143, v164 op_sel:[1,1,0] op_sel_hi:[1,1,0]
v_fma_mix_f32 v164, v146, v146, v164 op_sel:[1,1,0] op_sel_hi:[1,1,0]
s_setprio 3
v_pk_add_f32 v[168:169], v[0:1], v[2:3]
v_pk_mul_f32 v[170:171], v[0:1], v[0:1]
v_pk_fma_f32 v[170:171], v[2:3], v[2:3], v[170:171]
v_pk_add_f32 v[168:169], v[168:169], v[4:5]
v_pk_fma_f32 v[170:171], v[4:5], v[4:5], v[170:171]
v_pk_add_f32 v[168:169], v[168:169], v[6:7]
v_pk_fma_f32 v[170:171], v[6:7], v[6:7], v[170:171]
v_pk_add_f32 v[168:169], v[168:169], v[8:9]
v_pk_fma_f32 v[170:171], v[8:9], v[8:9], v[170:171]
v_pk_add_f32 v[168:169], v[168:169], v[10:11]
v_pk_fma_f32 v[170:171], v[10:11], v[10:11], v[170:171]
v_pk_add_f32 v[168:169], v[168:169], v[12:13]
v_pk_fma_f32 v[170:171], v[12:13], v[12:13], v[170:171]
v_pk_add_f32 v[168:169], v[168:169], v[14:15]
v_pk_fma_f32 v[170:171], v[14:15], v[14:15], v[170:171]
v_pk_add_f32 v[168:169], v[168:169], v[16:17]
v_pk_fma_f32 v[170:171], v[16:17], v[16:17], v[170:171]
v_pk_add_f32 v[168:169], v[168:169], v[18:19]
v_pk_fma_f32 v[170:171], v[18:19], v[18:19], v[170:171]
v_pk_add_f32 v[168:169], v[168:169], v[20:21]
v_pk_fma_f32 v[170:171], v[20:21], v[20:21], v[170:171]
v_pk_add_f32 v[168:169], v[168:169], v[22:23]
v_pk_fma_f32 v[170:171], v[22:23], v[22:23], v[170:171]
v_pk_add_f32 v[168:169], v[168:169], v[24:25]
v_pk_fma_f32 v[170:171], v[24:25], v[24:25], v[170:171]
v_pk_add_f32 v[168:169], v[168:169], v[26:27]
v_pk_fma_f32 v[170:171], v[26:27], v[26:27], v[170:171]
v_pk_add_f32 v[168:169], v[168:169], v[28:29]
v_pk_fma_f32 v[170:171], v[28:29], v[28:29], v[170:171]
v_pk_add_f32 v[168:169], v[168:169], v[30:31]
v_pk_fma_f32 v[170:171], v[30:31], v[30:31], v[170:171]
v_pk_add_f32 v[168:169], v[168:169], v[32:33]
v_pk_fma_f32 v[170:171], v[32:33], v[32:33], v[170:171]
v_pk_add_f32 v[168:169], v[168:169], v[34:35]
v_pk_fma_f32 v[170:171], v[34:35], v[34:35], v[170:171]
v_pk_add_f32 v[168:169], v[168:169], v[36:37]
v_pk_fma_f32 v[170:171], v[36:37], v[36:37], v[170:171]
v_pk_add_f32 v[168:169], v[168:169], v[38:39]
v_pk_fma_f32 v[170:171], v[38:39], v[38:39], v[170:171]
v_pk_add_f32 v[168:169], v[168:169], v[40:41]
v_pk_fma_f32 v[170:171], v[40:41], v[40:41], v[170:171]
v_pk_add_f32 v[168:169], v[168:169], v[42:43]
v_pk_fma_f32 v[170:171], v[42:43], v[42:43], v[170:171]
v_pk_add_f32 v[168:169], v[168:169], v[44:45]
v_pk_fma_f32 v[170:171], v[44:45], v[44:45], v[170:171]
v_pk_add_f32 v[168:169], v[168:169], v[46:47]
v_pk_fma_f32 v[170:171], v[46:47], v[46:47], v[170:171]
s_setprio 0
v_add_u32 v174, -36864, v242
v_subrev_u32 v175, 66560, v174
v_min_u32 v174, v174, v175
v_add_u32 v174, 90112, v174
v_sub_u32 v175, v174, v242
v_add_u32 v242, v175, v242
v_add_u32 v243, v175, v243
v_add_u32 v244, v175, v244
v_lshlrev_b32_e64 v252, 7, v251
s_add_u32 s46, s47, 1572864
s_mov_b32 exec_lo, 0
s_mov_b32 exec_hi, 1048572
s_mov_b32 m0, 16152
s_nop 0
buffer_load_dword v252, s[4:7], s46 offen lds
s_mov_b64 exec, -1
s_setprio 2
v_cvt_pkrtz_f16_f32 v137, v120, v121
v_cvt_pkrtz_f16_f32 v139, v122, v123
v_cvt_pkrtz_f16_f32 v141, v124, v125
v_cvt_pkrtz_f16_f32 v143, v126, v127
v_cvt_pkrtz_f16_f32 v145, v128, v129
v_cvt_pk_f16_f32 v155, v130, v131
v_cvt_pk_f16_f32 v152, v132, v133
v_cvt_pk_f16_f32 v149, v134, v135
ds_read_b128 v[224:227], v249 offset:17408
v_mfma_f32_32x32x16_bf16 v[120:135], v[48:51], v[228:231], 0
v_pk_fma_f16 v154, v155, v155, s48
v_add_f32 v168, v168, v169
v_and_b32 v137, s49, v137
v_pk_fma_f16 v151, v152, v152, s48
v_and_b32_e64 v139, s49, v139
v_pk_fma_f16 v148, v149, v149, s48
v_add_f32_e64 v170, v170, v171
v_pk_mul_f16 v154, v155, v154
v_bfe_u32 v136, v137, 2, 14
v_pk_mul_f16 v151, v152, v151
v_pk_mul_f16 v148, v149, v148
v_bfe_u32 v138, v139, 2, 14
ds_read_b128 v[228:231], v249 offset:18432
ds_read_u16_d16 v136, v136
ds_read_u16_d16 v138, v138
v_mfma_f32_32x32x16_bf16 v[120:135], v[52:55], v[232:235], v[120:135]
v_permlane32_swap_b32 v168, v170
v_exp_f16 v153, v154
v_lshrrev_b32 v137, 18, v137
v_exp_f16 v150, v151
v_add_f32 v168, v168, v170
v_lshrrev_b32 v139, 18, v139
v_exp_f16 v147, v148
v_and_b32 v141, s49, v141
v_and_b32_e64 v143, s49, v143
v_mul_f32 v168, 1009429163, v168
ds_read_b128 v[232:235], v249 offset:21504
ds_read_u16_d16_hi v137, v137
ds_read_u16_d16_hi v139, v139
v_mfma_f32_32x32x16_bf16 v[120:135], v[56:59], v[236:239], v[120:135]
v_exp_f16_sdwa v153, v154 dst_sel:WORD_1 dst_unused:UNUSED_PRESERVE src0_sel:WORD_1
v_bfe_u32 v140, v141, 2, 14
v_exp_f16_sdwa v150, v151 dst_sel:WORD_1 dst_unused:UNUSED_PRESERVE src0_sel:WORD_1
v_mov_b32_e64 v170, v168
v_bfe_u32 v142, v143, 2, 14
v_exp_f16_sdwa v147, v148 dst_sel:WORD_1 dst_unused:UNUSED_PRESERVE src0_sel:WORD_1
v_lshrrev_b32_e64 v141, 18, v141
v_permlane32_swap_b32 v168, v170
v_pk_add_f16 v153, v153, 1.0 op_sel_hi:[1,0]
s_waitcnt lgkmcnt(8)
ds_read_b128 v[236:239], v249 offset:19456
ds_read_u16_d16 v140, v140
ds_read_u16_d16 v142, v142
ds_read_u16_d16_hi v141, v141
v_mfma_f32_32x32x16_bf16 v[120:135], v[60:63], v[216:219], v[120:135]
v_lshrrev_b32_e64 v143, 18, v143
v_pk_add_f16 v150, v150, 1.0 op_sel_hi:[1,0]
v_pk_add_f16 v147, v147, 1.0 op_sel_hi:[1,0]
v_and_b32_e64 v145, s49, v145
v_fma_f32 v170, -v168, v168, v170
v_rcp_f16_e64 v154, v153
v_bfe_u32 v144, v145, 2, 14
v_rcp_f16 v151, v150
v_max_f32 v170, 0, v170
v_lshrrev_b32_e64 v145, 18, v145
ds_read_b128 v[216:219], v249 offset:22528
ds_read_u16_d16_hi v143, v143
ds_read_u16_d16 v144, v144
ds_read_u16_d16_hi v145, v145
v_mfma_f32_32x32x16_bf16 v[120:135], v[64:67], v[220:223], v[120:135]
v_rcp_f16 v148, v147
v_rcp_f16_sdwa v154, v153 dst_sel:WORD_1 dst_unused:UNUSED_PRESERVE src0_sel:WORD_1
v_add_f32 v170, 925353388, v170
s_waitcnt lgkmcnt(8)
v_fma_mix_f32 v165, v136, v136, 0 op_sel:[0,0,0] op_sel_hi:[1,1,0]
ds_read_b32 v247, v253 offset:16
v_fma_mix_f32 v165, v137, v137, v165 op_sel:[1,1,0] op_sel_hi:[1,1,0]
v_rcp_f16_sdwa v151, v150 dst_sel:WORD_1 dst_unused:UNUSED_PRESERVE src0_sel:WORD_1
v_rsq_f32_e64 v170, v170
v_fma_mix_f32 v165, v138, v138, v165 op_sel:[0,0,0] op_sel_hi:[1,1,0]
ds_read_b128 v[220:223], v249 offset:20480
v_mfma_f32_32x32x16_bf16 v[120:135], v[68:71], v[224:227], v[120:135]
v_rcp_f16_sdwa v148, v147 dst_sel:WORD_1 dst_unused:UNUSED_PRESERVE src0_sel:WORD_1
v_fma_mix_f32 v165, v139, v139, v165 op_sel:[1,1,0] op_sel_hi:[1,1,0]
v_pk_mul_f16 v155, v155, v154
s_waitcnt lgkmcnt(6)
v_fma_mix_f32 v165, v140, v140, v165 op_sel:[0,0,0] op_sel_hi:[1,1,0]
v_pk_mul_f16 v152, v152, v151
v_fma_mix_f32 v165, v141, v141, v165 op_sel:[1,1,0] op_sel_hi:[1,1,0]
v_pk_mul_f16 v149, v149, v148
v_fma_mix_f32 v165, v155, v155, v165 op_sel:[0,0,0] op_sel_hi:[1,1,0]
v_mul_f32 v172, 3203391086, v170
v_fma_mix_f32 v165, v142, v142, v165 op_sel:[0,0,0] op_sel_hi:[1,1,0]
v_fma_mix_f32 v165, v155, v155, v165 op_sel:[1,1,0] op_sel_hi:[1,1,0]
s_waitcnt lgkmcnt(2)
v_fma_mix_f32 v165, v143, v143, v165 op_sel:[1,1,0] op_sel_hi:[1,1,0]
v_fma_mix_f32 v165, v152, v152, v165 op_sel:[0,0,0] op_sel_hi:[1,1,0]
v_fma_mix_f32 v165, v152, v152, v165 op_sel:[1,1,0] op_sel_hi:[1,1,0]
v_mul_f32 v173, v168, v172
v_fma_mix_f32 v165, v144, v144, v165 op_sel:[0,0,0] op_sel_hi:[1,1,0]
v_fma_mix_f32 v165, v149, v149, v165 op_sel:[0,0,0] op_sel_hi:[1,1,0]
v_fma_mix_f32 v165, v145, v145, v165 op_sel:[1,1,0] op_sel_hi:[1,1,0]
v_fma_mix_f32 v165, v149, v149, v165 op_sel:[1,1,0] op_sel_hi:[1,1,0]
s_setprio 3
v_pk_fma_f32 v[0:1], v[0:1], v[172:173], v[172:173] op_sel:[0,0,1] op_sel_hi:[1,0,1] neg_lo:[0,0,1] neg_hi:[0,0,1]
v_pk_fma_f32 v[2:3], v[2:3], v[172:173], v[172:173] op_sel:[0,0,1] op_sel_hi:[1,0,1] neg_lo:[0,0,1] neg_hi:[0,0,1]
v_pk_fma_f32 v[4:5], v[4:5], v[172:173], v[172:173] op_sel:[0,0,1] op_sel_hi:[1,0,1] neg_lo:[0,0,1] neg_hi:[0,0,1]
v_pk_fma_f32 v[6:7], v[6:7], v[172:173], v[172:173] op_sel:[0,0,1] op_sel_hi:[1,0,1] neg_lo:[0,0,1] neg_hi:[0,0,1]
v_pk_fma_f32 v[8:9], v[8:9], v[172:173], v[172:173] op_sel:[0,0,1] op_sel_hi:[1,0,1] neg_lo:[0,0,1] neg_hi:[0,0,1]
v_pk_fma_f32 v[10:11], v[10:11], v[172:173], v[172:173] op_sel:[0,0,1] op_sel_hi:[1,0,1] neg_lo:[0,0,1] neg_hi:[0,0,1]
v_pk_fma_f32 v[12:13], v[12:13], v[172:173], v[172:173] op_sel:[0,0,1] op_sel_hi:[1,0,1] neg_lo:[0,0,1] neg_hi:[0,0,1]
v_pk_fma_f32 v[14:15], v[14:15], v[172:173], v[172:173] op_sel:[0,0,1] op_sel_hi:[1,0,1] neg_lo:[0,0,1] neg_hi:[0,0,1]
v_pk_fma_f32 v[16:17], v[16:17], v[172:173], v[172:173] op_sel:[0,0,1] op_sel_hi:[1,0,1] neg_lo:[0,0,1] neg_hi:[0,0,1]
v_pk_fma_f32 v[18:19], v[18:19], v[172:173], v[172:173] op_sel:[0,0,1] op_sel_hi:[1,0,1] neg_lo:[0,0,1] neg_hi:[0,0,1]
v_pk_fma_f32 v[20:21], v[20:21], v[172:173], v[172:173] op_sel:[0,0,1] op_sel_hi:[1,0,1] neg_lo:[0,0,1] neg_hi:[0,0,1]
v_pk_fma_f32 v[22:23], v[22:23], v[172:173], v[172:173] op_sel:[0,0,1] op_sel_hi:[1,0,1] neg_lo:[0,0,1] neg_hi:[0,0,1]
v_pk_fma_f32 v[24:25], v[24:25], v[172:173], v[172:173] op_sel:[0,0,1] op_sel_hi:[1,0,1] neg_lo:[0,0,1] neg_hi:[0,0,1]
v_pk_fma_f32 v[26:27], v[26:27], v[172:173], v[172:173] op_sel:[0,0,1] op_sel_hi:[1,0,1] neg_lo:[0,0,1] neg_hi:[0,0,1]
v_pk_fma_f32 v[28:29], v[28:29], v[172:173], v[172:173] op_sel:[0,0,1] op_sel_hi:[1,0,1] neg_lo:[0,0,1] neg_hi:[0,0,1]
v_pk_fma_f32 v[30:31], v[30:31], v[172:173], v[172:173] op_sel:[0,0,1] op_sel_hi:[1,0,1] neg_lo:[0,0,1] neg_hi:[0,0,1]
v_pk_fma_f32 v[32:33], v[32:33], v[172:173], v[172:173] op_sel:[0,0,1] op_sel_hi:[1,0,1] neg_lo:[0,0,1] neg_hi:[0,0,1]
v_pk_fma_f32 v[34:35], v[34:35], v[172:173], v[172:173] op_sel:[0,0,1] op_sel_hi:[1,0,1] neg_lo:[0,0,1] neg_hi:[0,0,1]
v_pk_fma_f32 v[36:37], v[36:37], v[172:173], v[172:173] op_sel:[0,0,1] op_sel_hi:[1,0,1] neg_lo:[0,0,1] neg_hi:[0,0,1]
v_pk_fma_f32 v[38:39], v[38:39], v[172:173], v[172:173] op_sel:[0,0,1] op_sel_hi:[1,0,1] neg_lo:[0,0,1] neg_hi:[0,0,1]
v_pk_fma_f32 v[40:41], v[40:41], v[172:173], v[172:173] op_sel:[0,0,1] op_sel_hi:[1,0,1] neg_lo:[0,0,1] neg_hi:[0,0,1]
v_pk_fma_f32 v[42:43], v[42:43], v[172:173], v[172:173] op_sel:[0,0,1] op_sel_hi:[1,0,1] neg_lo:[0,0,1] neg_hi:[0,0,1]
v_pk_fma_f32 v[44:45], v[44:45], v[172:173], v[172:173] op_sel:[0,0,1] op_sel_hi:[1,0,1] neg_lo:[0,0,1] neg_hi:[0,0,1]
v_pk_fma_f32 v[46:47], v[46:47], v[172:173], v[172:173] op_sel:[0,0,1] op_sel_hi:[1,0,1] neg_lo:[0,0,1] neg_hi:[0,0,1]
s_setprio 2
s_waitcnt lgkmcnt(0)
v_readfirstlane_b32 s43, v247
s_nop 1
s_cmp_ge_u32 s43, 16
s_cbranch_scc1 Lev4
Lev4w:
s_sleep 1
ds_read_b32 v247, v253 offset:16
s_waitcnt lgkmcnt(0)
v_readfirstlane_b32 s43, v247
s_cmp_eq_u32 s76, 0
s_cbranch_scc1 Lev4
s_sub_u32 s76, s76, 1
s_cmp_lt_u32 s43, 16
s_cbranch_scc1 Lev4w
Lev4:
s_setprio 1
v_cvt_pkrtz_f16_f32 v137, v120, v121
v_cvt_pkrtz_f16_f32 v139, v122, v123
v_cvt_pkrtz_f16_f32 v141, v124, v125
v_cvt_pkrtz_f16_f32 v143, v126, v127
v_cvt_pkrtz_f16_f32 v145, v128, v129
v_cvt_pk_f16_f32 v155, v130, v131
v_cvt_pk_f16_f32 v152, v132, v133
v_cvt_pk_f16_f32 v149, v134, v135
s_add_u32 m0, s67, 53248
s_add_u32 s66, s66, 98304
buffer_load_dwordx4 v240, s[4:7], s66 offen lds
ds_read_b128 v[224:227], v249 offset:23552
v_mfma_f32_32x32x16_bf16 v[120:135], v[48:51], v[228:231], 0
v_pk_fma_f16 v154, v155, v155, s48
v_cvt_pk_bf16_f32 v72, v0, v1
v_and_b32 v137, s49, v137
v_pk_fma_f16 v151, v152, v152, s48
v_cvt_pk_bf16_f32 v73, v2, v3
v_and_b32_e64 v139, s49, v139
v_pk_fma_f16 v148, v149, v149, s48
v_pk_mul_f16 v154, v155, v154
v_cvt_pk_bf16_f32 v74, v4, v5
v_bfe_u32 v136, v137, 2, 14
v_pk_mul_f16 v151, v152, v151
v_pk_mul_f16 v148, v149, v148
v_cvt_pk_bf16_f32 v75, v6, v7
v_bfe_u32 v138, v139, 2, 14
s_add_u32 m0, s67, 59904
s_add_u32 s66, s66, 98304
buffer_load_dwordx4 v240, s[4:7], s66 offen lds
ds_read_b128 v[228:231], v248 offset:16384
ds_read_u16_d16 v136, v136
ds_read_u16_d16 v138, v138
v_mfma_f32_32x32x16_bf16 v[120:135], v[52:55], v[232:235], v[120:135]
v_exp_f16_e64 v153, v154
v_cvt_pk_bf16_f32 v76, v8, v9
v_lshrrev_b32 v137, 18, v137
v_exp_f16 v150, v151
v_cvt_pk_bf16_f32 v77, v10, v11
v_lshrrev_b32 v139, 18, v139
v_exp_f16 v147, v148
v_cvt_pk_bf16_f32 v78, v12, v13
v_and_b32_e64 v141, s49, v141
v_and_b32 v143, s49, v143
v_cvt_pk_bf16_f32 v79, v14, v15
s_add_u32 m0, s67, 0
s_add_u32 s66, s66, 98304
buffer_load_dwordx4 v240, s[4:7], s66 offen lds
ds_read_b128 v[232:235], v248 offset:19456
ds_read_u16_d16_hi v137, v137
ds_read_u16_d16_hi v139, v139
v_mfma_f32_32x32x16_bf16 v[120:135], v[56:59], v[236:239], v[120:135]
v_exp_f16_sdwa v153, v154 dst_sel:WORD_1 dst_unused:UNUSED_PRESERVE src0_sel:WORD_1
v_bfe_u32 v140, v141, 2, 14
v_cvt_pk_bf16_f32 v80, v16, v17
v_exp_f16_sdwa v150, v151 dst_sel:WORD_1 dst_unused:UNUSED_PRESERVE src0_sel:WORD_1
v_bfe_u32 v142, v143, 2, 14
v_cvt_pk_bf16_f32 v81, v18, v19
v_exp_f16_sdwa v147, v148 dst_sel:WORD_1 dst_unused:UNUSED_PRESERVE src0_sel:WORD_1
v_cvt_pk_bf16_f32 v82, v20, v21
v_lshrrev_b32_e64 v141, 18, v141
v_pk_add_f16 v153, v153, 1.0 op_sel_hi:[1,0]
v_lshrrev_b32_e64 v143, 18, v143
s_add_u32 m0, s67, 6656
s_add_u32 s66, s66, 98304
buffer_load_dwordx4 v240, s[4:7], s66 offen lds
s_add_u32 m0, s67, 13312
s_add_u32 s66, s66, 98304
buffer_load_dwordx4 v240, s[4:7], s66 offen lds
ds_read_b128 v[236:239], v248 offset:17408
ds_read_u16_d16 v140, v140
ds_read_u16_d16 v142, v142
ds_read_u16_d16_hi v141, v141
ds_read_u16_d16_hi v143, v143
v_mfma_f32_32x32x16_bf16 v[120:135], v[60:63], v[216:219], v[120:135]
v_cvt_pk_bf16_f32 v83, v22, v23
v_pk_add_f16 v150, v150, 1.0 op_sel_hi:[1,0]
v_pk_add_f16 v147, v147, 1.0 op_sel_hi:[1,0]
v_and_b32_e64 v145, s49, v145
v_cvt_pk_bf16_f32 v84, v24, v25
v_rcp_f16_e64 v154, v153
v_bfe_u32 v144, v145, 2, 14
v_cvt_pk_bf16_f32 v85, v26, v27
v_rcp_f16 v151, v150
v_lshrrev_b32 v145, 18, v145
v_cvt_pk_bf16_f32 v86, v28, v29
s_add_u32 m0, s67, 19968
s_add_u32 s66, s66, 98304
buffer_load_dwordx4 v240, s[4:7], s66 offen lds
ds_read_b128 v[216:219], v248 offset:20480
ds_read_u16_d16 v144, v144
ds_read_u16_d16_hi v145, v145
v_mfma_f32_32x32x16_bf16 v[120:135], v[64:67], v[220:223], v[120:135]
v_rcp_f16_e64 v148, v147
v_cvt_pk_bf16_f32 v87, v30, v31
v_rcp_f16_sdwa v154, v153 dst_sel:WORD_1 dst_unused:UNUSED_PRESERVE src0_sel:WORD_1
s_waitcnt lgkmcnt(5)
v_fma_mix_f32 v166, v136, v136, 0 op_sel:[0,0,0] op_sel_hi:[1,1,0]
v_cvt_pk_bf16_f32 v88, v32, v33
s_setprio 0
v_fma_mix_f32 v166, v137, v137, v166 op_sel:[1,1,0] op_sel_hi:[1,1,0]
v_rcp_f16_sdwa v151, v150 dst_sel:WORD_1 dst_unused:UNUSED_PRESERVE src0_sel:WORD_1
v_cvt_pk_bf16_f32 v89, v34, v35
v_fma_mix_f32 v166, v138, v138, v166 op_sel:[0,0,0] op_sel_hi:[1,1,0]
v_rcp_f16_sdwa v148, v147 dst_sel:WORD_1 dst_unused:UNUSED_PRESERVE src0_sel:WORD_1
v_cvt_pk_bf16_f32 v90, v36, v37
s_add_u32 m0, s67, 26624
s_add_u32 s66, s66, 98304
buffer_load_dwordx4 v240, s[4:7], s66 offen lds
ds_read_b128 v[220:223], v248 offset:18432
v_mfma_f32_32x32x16_bf16 v[120:135], v[68:71], v[224:227], v[120:135]
v_fma_mix_f32 v166, v139, v139, v166 op_sel:[1,1,0] op_sel_hi:[1,1,0]
v_pk_mul_f16 v155, v155, v154
v_fma_mix_f32 v166, v140, v140, v166 op_sel:[0,0,0] op_sel_hi:[1,1,0]
v_cvt_pk_bf16_f32 v91, v38, v39
v_pk_mul_f16 v152, v152, v151
s_waitcnt lgkmcnt(1)
v_fma_mix_f32 v166, v141, v141, v166 op_sel:[1,1,0] op_sel_hi:[1,1,0]
v_cvt_pk_bf16_f32 v92, v40, v41
v_pk_mul_f16 v149, v149, v148
v_fma_mix_f32 v166, v155, v155, v166 op_sel:[0,0,0] op_sel_hi:[1,1,0]
v_fma_mix_f32 v166, v142, v142, v166 op_sel:[0,0,0] op_sel_hi:[1,1,0]
v_cvt_pk_bf16_f32 v93, v42, v43
v_fma_mix_f32 v166, v155, v155, v166 op_sel:[1,1,0] op_sel_hi:[1,1,0]
v_fma_mix_f32 v166, v143, v143, v166 op_sel:[1,1,0] op_sel_hi:[1,1,0]
v_fma_mix_f32 v166, v152, v152, v166 op_sel:[0,0,0] op_sel_hi:[1,1,0]
s_add_u32 m0, s67, 33280
s_add_u32 s66, s66, 98304
buffer_load_dwordx4 v240, s[4:7], s66 offen lds
v_cvt_pk_bf16_f32 v94, v44, v45
v_fma_mix_f32 v166, v152, v152, v166 op_sel:[1,1,0] op_sel_hi:[1,1,0]
v_fma_mix_f32 v166, v144, v144, v166 op_sel:[0,0,0] op_sel_hi:[1,1,0]
v_fma_mix_f32 v166, v149, v149, v166 op_sel:[0,0,0] op_sel_hi:[1,1,0]
v_cvt_pk_bf16_f32 v95, v46, v47
v_fma_mix_f32 v166, v145, v145, v166 op_sel:[1,1,0] op_sel_hi:[1,1,0]
v_fma_mix_f32 v166, v149, v149, v166 op_sel:[1,1,0] op_sel_hi:[1,1,0]
s_setprio 2
v_cvt_pkrtz_f16_f32 v137, v120, v121
v_cvt_pkrtz_f16_f32 v139, v122, v123
v_cvt_pkrtz_f16_f32 v141, v124, v125
v_cvt_pkrtz_f16_f32 v143, v126, v127
v_cvt_pkrtz_f16_f32 v145, v128, v129
v_cvt_pk_f16_f32 v155, v130, v131
v_cvt_pk_f16_f32 v152, v132, v133
v_cvt_pk_f16_f32 v149, v134, v135
buffer_store_dwordx4 v[48:51], v241, s[32:35], s80 offen sc1
ds_read_b128 v[224:227], v248 offset:21504
v_mfma_f32_32x32x16_bf16 v[120:135], v[72:75], v[228:231], 0
v_pk_fma_f16 v154, v155, v155, s48
v_and_b32_e64 v137, s49, v137
v_pk_fma_f16 v151, v152, v152, s48
v_and_b32_e64 v139, s49, v139
v_pk_fma_f16 v148, v149, v149, s48
v_pk_mul_f16 v154, v155, v154
v_bfe_u32 v136, v137, 2, 14
v_pk_mul_f16 v151, v152, v151
v_pk_mul_f16 v148, v149, v148
v_bfe_u32 v138, v139, 2, 14
ds_read_b128 v[228:231], v248 offset:22528
ds_read_u16_d16 v136, v136
ds_read_u16_d16 v138, v138
v_mfma_f32_32x32x16_bf16 v[120:135], v[76:79], v[232:235], v[120:135]
v_exp_f16 v153, v154
v_lshrrev_b32 v137, 18, v137
v_exp_f16 v150, v151
v_lshrrev_b32 v139, 18, v139
v_exp_f16 v147, v148
v_and_b32 v141, s49, v141
v_and_b32_e64 v143, s49, v143
ds_read_b128 v[232:235], v248 offset:25600
ds_read_u16_d16_hi v137, v137
ds_read_u16_d16_hi v139, v139
v_mfma_f32_32x32x16_bf16 v[120:135], v[80:83], v[236:239], v[120:135]
v_exp_f16_sdwa v153, v154 dst_sel:WORD_1 dst_unused:UNUSED_PRESERVE src0_sel:WORD_1
v_bfe_u32 v140, v141, 2, 14
v_exp_f16_sdwa v150, v151 dst_sel:WORD_1 dst_unused:UNUSED_PRESERVE src0_sel:WORD_1
v_bfe_u32 v142, v143, 2, 14
v_exp_f16_sdwa v147, v148 dst_sel:WORD_1 dst_unused:UNUSED_PRESERVE src0_sel:WORD_1
v_lshrrev_b32_e64 v141, 18, v141
v_pk_add_f16 v153, v153, 1.0 op_sel_hi:[1,0]
ds_read_b128 v[236:239], v248 offset:23552
ds_read_u16_d16 v140, v140
ds_read_u16_d16 v142, v142
ds_read_u16_d16_hi v141, v141
v_mfma_f32_32x32x16_bf16 v[120:135], v[84:87], v[216:219], v[120:135]
v_lshrrev_b32_e64 v143, 18, v143
v_pk_add_f16 v150, v150, 1.0 op_sel_hi:[1,0]
v_pk_add_f16 v147, v147, 1.0 op_sel_hi:[1,0]
v_and_b32 v145, s49, v145
v_rcp_f16 v154, v153
v_bfe_u32 v144, v145, 2, 14
v_rcp_f16_e64 v151, v150
v_lshrrev_b32 v145, 18, v145
s_waitcnt lgkmcnt(7)
ds_read_b128 v[216:219], v248 offset:26624
ds_read_u16_d16_hi v143, v143
ds_read_u16_d16 v144, v144
ds_read_u16_d16_hi v145, v145
v_mfma_f32_32x32x16_bf16 v[120:135], v[88:91], v[220:223], v[120:135]
v_rcp_f16 v148, v147
v_rcp_f16_sdwa v154, v153 dst_sel:WORD_1 dst_unused:UNUSED_PRESERVE src0_sel:WORD_1
v_fma_mix_f32 v167, v136, v136, 0 op_sel:[0,0,0] op_sel_hi:[1,1,0]
s_waitcnt lgkmcnt(8)
v_fma_mix_f32 v167, v137, v137, v167 op_sel:[1,1,0] op_sel_hi:[1,1,0]
v_rcp_f16_sdwa v151, v150 dst_sel:WORD_1 dst_unused:UNUSED_PRESERVE src0_sel:WORD_1
v_fma_mix_f32 v167, v138, v138, v167 op_sel:[0,0,0] op_sel_hi:[1,1,0]
ds_read_b128 v[220:223], v248 offset:24576
v_mfma_f32_32x32x16_bf16 v[120:135], v[92:95], v[224:227], v[120:135]
v_rcp_f16_sdwa v148, v147 dst_sel:WORD_1 dst_unused:UNUSED_PRESERVE src0_sel:WORD_1
v_fma_mix_f32 v167, v139, v139, v167 op_sel:[1,1,0] op_sel_hi:[1,1,0]
v_pk_mul_f16 v155, v155, v154
s_waitcnt lgkmcnt(5)
v_fma_mix_f32 v167, v140, v140, v167 op_sel:[0,0,0] op_sel_hi:[1,1,0]
v_pk_mul_f16 v152, v152, v151
v_fma_mix_f32 v167, v141, v141, v167 op_sel:[1,1,0] op_sel_hi:[1,1,0]
v_pk_mul_f16 v149, v149, v148
v_fma_mix_f32 v167, v155, v155, v167 op_sel:[0,0,0] op_sel_hi:[1,1,0]
v_fma_mix_f32 v167, v142, v142, v167 op_sel:[0,0,0] op_sel_hi:[1,1,0]
v_fma_mix_f32 v167, v155, v155, v167 op_sel:[1,1,0] op_sel_hi:[1,1,0]
s_waitcnt lgkmcnt(3)
v_fma_mix_f32 v167, v143, v143, v167 op_sel:[1,1,0] op_sel_hi:[1,1,0]
v_fma_mix_f32 v167, v152, v152, v167 op_sel:[0,0,0] op_sel_hi:[1,1,0]
v_fma_mix_f32 v167, v152, v152, v167 op_sel:[1,1,0] op_sel_hi:[1,1,0]
s_waitcnt lgkmcnt(1)
v_fma_mix_f32 v167, v144, v144, v167 op_sel:[0,0,0] op_sel_hi:[1,1,0]
v_fma_mix_f32 v167, v149, v149, v167 op_sel:[0,0,0] op_sel_hi:[1,1,0]
v_fma_mix_f32 v167, v145, v145, v167 op_sel:[1,1,0] op_sel_hi:[1,1,0]
v_fma_mix_f32 v167, v149, v149, v167 op_sel:[1,1,0] op_sel_hi:[1,1,0]
s_setprio 1
v_cvt_pkrtz_f16_f32 v137, v120, v121
v_cvt_pkrtz_f16_f32 v139, v122, v123
v_cvt_pkrtz_f16_f32 v141, v124, v125
v_cvt_pkrtz_f16_f32 v143, v126, v127
v_cvt_pkrtz_f16_f32 v145, v128, v129
v_cvt_pk_f16_f32 v155, v130, v131
v_cvt_pk_f16_f32 v152, v132, v133
v_cvt_pk_f16_f32 v149, v134, v135
s_add_u32 s46, s80, 2097152
buffer_store_dwordx4 v[52:55], v241, s[32:35], s46 offen sc1
ds_read_b128 v[224:227], v248 offset:27648
v_mfma_f32_32x32x16_bf16 v[120:135], v[72:75], v[228:231], 0
v_pk_fma_f16 v154, v155, v155, s48
v_and_b32_e64 v137, s49, v137
v_pk_fma_f16 v151, v152, v152, s48
v_and_b32_e64 v139, s49, v139
v_pk_fma_f16 v148, v149, v149, s48
v_pk_mul_f16 v154, v155, v154
v_bfe_u32 v136, v137, 2, 14
v_pk_mul_f16 v151, v152, v151
v_pk_mul_f16 v148, v149, v148
v_bfe_u32 v138, v139, 2, 14
ds_read_b128 v[228:231], v248 offset:28672
ds_read_u16_d16 v136, v136
ds_read_u16_d16 v138, v138
v_mfma_f32_32x32x16_bf16 v[120:135], v[76:79], v[232:235], v[120:135]
v_exp_f16 v153, v154
v_lshrrev_b32 v137, 18, v137
v_exp_f16 v150, v151
v_lshrrev_b32 v139, 18, v139
v_exp_f16 v147, v148
v_and_b32 v141, s49, v141
v_and_b32_e64 v143, s49, v143
ds_read_b128 v[232:235], v248 offset:31744
ds_read_u16_d16_hi v137, v137
ds_read_u16_d16_hi v139, v139
v_mfma_f32_32x32x16_bf16 v[120:135], v[80:83], v[236:239], v[120:135]
v_exp_f16_sdwa v153, v154 dst_sel:WORD_1 dst_unused:UNUSED_PRESERVE src0_sel:WORD_1
v_bfe_u32 v140, v141, 2, 14
v_exp_f16_sdwa v150, v151 dst_sel:WORD_1 dst_unused:UNUSED_PRESERVE src0_sel:WORD_1
v_bfe_u32 v142, v143, 2, 14
v_exp_f16_sdwa v147, v148 dst_sel:WORD_1 dst_unused:UNUSED_PRESERVE src0_sel:WORD_1
v_lshrrev_b32_e64 v141, 18, v141
v_pk_add_f16 v153, v153, 1.0 op_sel_hi:[1,0]
ds_read_b128 v[236:239], v248 offset:29696
ds_read_u16_d16 v140, v140
ds_read_u16_d16 v142, v142
ds_read_u16_d16_hi v141, v141
v_mfma_f32_32x32x16_bf16 v[120:135], v[84:87], v[216:219], v[120:135]
v_lshrrev_b32_e64 v143, 18, v143
v_pk_add_f16 v150, v150, 1.0 op_sel_hi:[1,0]
v_pk_add_f16 v147, v147, 1.0 op_sel_hi:[1,0]
v_and_b32 v145, s49, v145
v_rcp_f16 v154, v153
v_bfe_u32 v144, v145, 2, 14
v_rcp_f16_e64 v151, v150
v_lshrrev_b32 v145, 18, v145
s_waitcnt lgkmcnt(7)
ds_read_b128 v[216:219], v248 offset:32768
ds_read_u16_d16_hi v143, v143
ds_read_u16_d16 v144, v144
ds_read_u16_d16_hi v145, v145
v_mfma_f32_32x32x16_bf16 v[120:135], v[88:91], v[220:223], v[120:135]
v_rcp_f16_e64 v148, v147
v_rcp_f16_sdwa v154, v153 dst_sel:WORD_1 dst_unused:UNUSED_PRESERVE src0_sel:WORD_1
v_fma_mix_f32 v156, v136, v136, v156 op_sel:[0,0,0] op_sel_hi:[1,1,0]
s_setprio 0
s_waitcnt lgkmcnt(8)
v_fma_mix_f32 v156, v137, v137, v156 op_sel:[1,1,0] op_sel_hi:[1,1,0]
v_rcp_f16_sdwa v151, v150 dst_sel:WORD_1 dst_unused:UNUSED_PRESERVE src0_sel:WORD_1
v_fma_mix_f32 v156, v138, v138, v156 op_sel:[0,0,0] op_sel_hi:[1,1,0]
ds_read_b128 v[220:223], v248 offset:30720
v_mfma_f32_32x32x16_bf16 v[120:135], v[92:95], v[224:227], v[120:135]
v_rcp_f16_sdwa v148, v147 dst_sel:WORD_1 dst_unused:UNUSED_PRESERVE src0_sel:WORD_1
v_fma_mix_f32 v156, v139, v139, v156 op_sel:[1,1,0] op_sel_hi:[1,1,0]
v_pk_mul_f16 v155, v155, v154
s_cmp_eq_u32 s40, 7
s_cbranch_scc1 Lrdy16
s_waitcnt vmcnt(2)
Lrdy16:
s_mov_b64 exec, 1
ds_add_u32 v253, v254 offset:12
s_mov_b64 exec, -1
s_waitcnt lgkmcnt(6)
v_fma_mix_f32 v156, v140, v140, v156 op_sel:[0,0,0] op_sel_hi:[1,1,0]
v_pk_mul_f16 v152, v152, v151
v_fma_mix_f32 v156, v141, v141, v156 op_sel:[1,1,0] op_sel_hi:[1,1,0]
v_pk_mul_f16 v149, v149, v148
v_fma_mix_f32 v156, v155, v155, v156 op_sel:[0,0,0] op_sel_hi:[1,1,0]
v_fma_mix_f32 v156, v142, v142, v156 op_sel:[0,0,0] op_sel_hi:[1,1,0]
v_fma_mix_f32 v156, v155, v155, v156 op_sel:[1,1,0] op_sel_hi:[1,1,0]
s_waitcnt lgkmcnt(2)
v_fma_mix_f32 v156, v143, v143, v156 op_sel:[1,1,0] op_sel_hi:[1,1,0]
v_fma_mix_f32 v156, v152, v152, v156 op_sel:[0,0,0] op_sel_hi:[1,1,0]
v_fma_mix_f32 v156, v152, v152, v156 op_sel:[1,1,0] op_sel_hi:[1,1,0]
v_fma_mix_f32 v156, v144, v144, v156 op_sel:[0,0,0] op_sel_hi:[1,1,0]
v_fma_mix_f32 v156, v149, v149, v156 op_sel:[0,0,0] op_sel_hi:[1,1,0]
v_fma_mix_f32 v156, v145, v145, v156 op_sel:[1,1,0] op_sel_hi:[1,1,0]
v_fma_mix_f32 v156, v149, v149, v156 op_sel:[1,1,0] op_sel_hi:[1,1,0]
s_setprio 2
v_cvt_pkrtz_f16_f32 v137, v120, v121
v_cvt_pkrtz_f16_f32 v139, v122, v123
v_cvt_pkrtz_f16_f32 v141, v124, v125
v_cvt_pkrtz_f16_f32 v143, v126, v127
v_cvt_pkrtz_f16_f32 v145, v128, v129
v_cvt_pk_f16_f32 v155, v130, v131
v_cvt_pk_f16_f32 v152, v132, v133
v_cvt_pk_f16_f32 v149, v134, v135
s_add_u32 s46, s80, 4194304
buffer_store_dwordx4 v[56:59], v241, s[32:35], s46 offen sc1
ds_read_b128 v[224:227], v248 offset:33792
v_mfma_f32_32x32x16_bf16 v[120:135], v[72:75], v[228:231], 0
v_pk_fma_f16 v154, v155, v155, s48
v_and_b32_e64 v137, s49, v137
v_pk_fma_f16 v151, v152, v152, s48
v_and_b32_e64 v139, s49, v139
v_pk_fma_f16 v148, v149, v149, s48
v_pk_mul_f16 v154, v155, v154
v_bfe_u32 v136, v137, 2, 14
v_pk_mul_f16 v151, v152, v151
v_pk_mul_f16 v148, v149, v148
v_bfe_u32 v138, v139, 2, 14
ds_read_b128 v[228:231], v250 offset:65520
ds_read_u16_d16 v136, v136
ds_read_u16_d16 v138, v138
v_mfma_f32_32x32x16_bf16 v[120:135], v[76:79], v[232:235], v[120:135]
v_exp_f16 v153, v154
v_lshrrev_b32 v137, 18, v137
v_exp_f16 v150, v151
v_lshrrev_b32 v139, 18, v139
v_exp_f16 v147, v148
v_and_b32 v141, s49, v141
v_and_b32_e64 v143, s49, v143
ds_read_b128 v[232:235], v248 offset:34816
ds_read_u16_d16_hi v137, v137
ds_read_b32 v247, v253 offset:12
ds_read_u16_d16_hi v139, v139
v_mfma_f32_32x32x16_bf16 v[120:135], v[80:83], v[236:239], v[120:135]
v_exp_f16_sdwa v153, v154 dst_sel:WORD_1 dst_unused:UNUSED_PRESERVE src0_sel:WORD_1
v_bfe_u32 v140, v141, 2, 14
v_exp_f16_sdwa v150, v151 dst_sel:WORD_1 dst_unused:UNUSED_PRESERVE src0_sel:WORD_1
v_bfe_u32 v142, v143, 2, 14
v_exp_f16_sdwa v147, v148 dst_sel:WORD_1 dst_unused:UNUSED_PRESERVE src0_sel:WORD_1
v_lshrrev_b32_e64 v141, 18, v141
v_pk_add_f16 v153, v153, 1.0 op_sel_hi:[1,0]
ds_read_b128 v[236:239], v248 offset:37888
ds_read_u16_d16 v140, v140
ds_read_u16_d16 v142, v142
ds_read_u16_d16_hi v141, v141
v_mfma_f32_32x32x16_bf16 v[120:135], v[84:87], v[216:219], v[120:135]
v_lshrrev_b32_e64 v143, 18, v143
v_pk_add_f16 v150, v150, 1.0 op_sel_hi:[1,0]
v_pk_add_f16 v147, v147, 1.0 op_sel_hi:[1,0]
v_and_b32 v145, s49, v145
v_rcp_f16 v154, v153
v_bfe_u32 v144, v145, 2, 14
ds_read_u16_d16_hi v143, v143
ds_read_u16_d16 v144, v144
s_waitcnt lgkmcnt(7)
v_readfirstlane_b32 s43, v247
s_nop 1
s_cmp_ge_u32 s43, 24
s_cbranch_scc1 Lev5
Lev5w:
s_sleep 1
ds_read_b32 v247, v253 offset:12
s_waitcnt lgkmcnt(0)
v_readfirstlane_b32 s43, v247
s_cmp_eq_u32 s76, 0
s_cbranch_scc1 Lev5
s_sub_u32 s76, s76, 1
s_cmp_lt_u32 s43, 24
s_cbranch_scc1 Lev5w
Lev5:
v_rcp_f16 v151, v150
v_lshrrev_b32_e64 v145, 18, v145
ds_read_b128 v[216:219], v248 offset:35840
ds_read_u16_d16_hi v145, v145
v_mfma_f32_32x32x16_bf16 v[120:135], v[88:91], v[220:223], v[120:135]
v_rcp_f16 v148, v147
v_rcp_f16_sdwa v154, v153 dst_sel:WORD_1 dst_unused:UNUSED_PRESERVE src0_sel:WORD_1
v_fma_mix_f32 v157, v136, v136, v157 op_sel:[0,0,0] op_sel_hi:[1,1,0]
v_fma_mix_f32 v157, v137, v137, v157 op_sel:[1,1,0] op_sel_hi:[1,1,0]
v_rcp_f16_sdwa v151, v150 dst_sel:WORD_1 dst_unused:UNUSED_PRESERVE src0_sel:WORD_1
v_fma_mix_f32 v157, v138, v138, v157 op_sel:[0,0,0] op_sel_hi:[1,1,0]
ds_read_b128 v[220:223], v245
ds_read_b128 v[192:195], v242
ds_read_b128 v[196:199], v242 offset:64
v_mfma_f32_32x32x16_bf16 v[120:135], v[92:95], v[224:227], v[120:135]
v_rcp_f16_sdwa v148, v147 dst_sel:WORD_1 dst_unused:UNUSED_PRESERVE src0_sel:WORD_1
s_waitcnt lgkmcnt(5)
v_fma_mix_f32 v157, v139, v139, v157 op_sel:[1,1,0] op_sel_hi:[1,1,0]
v_pk_mul_f16 v155, v155, v154
v_fma_mix_f32 v157, v140, v140, v157 op_sel:[0,0,0] op_sel_hi:[1,1,0]
v_pk_mul_f16 v152, v152, v151
v_fma_mix_f32 v157, v141, v141, v157 op_sel:[1,1,0] op_sel_hi:[1,1,0]
v_pk_mul_f16 v149, v149, v148
v_fma_mix_f32 v157, v155, v155, v157 op_sel:[0,0,0] op_sel_hi:[1,1,0]
v_fma_mix_f32 v157, v142, v142, v157 op_sel:[0,0,0] op_sel_hi:[1,1,0]
v_fma_mix_f32 v157, v155, v155, v157 op_sel:[1,1,0] op_sel_hi:[1,1,0]
v_fma_mix_f32 v157, v143, v143, v157 op_sel:[1,1,0] op_sel_hi:[1,1,0]
v_fma_mix_f32 v157, v152, v152, v157 op_sel:[0,0,0] op_sel_hi:[1,1,0]
v_fma_mix_f32 v157, v152, v152, v157 op_sel:[1,1,0] op_sel_hi:[1,1,0]
v_fma_mix_f32 v157, v144, v144, v157 op_sel:[0,0,0] op_sel_hi:[1,1,0]
v_fma_mix_f32 v157, v149, v149, v157 op_sel:[0,0,0] op_sel_hi:[1,1,0]
s_waitcnt lgkmcnt(3)
v_fma_mix_f32 v157, v145, v145, v157 op_sel:[1,1,0] op_sel_hi:[1,1,0]
v_fma_mix_f32 v157, v149, v149, v157 op_sel:[1,1,0] op_sel_hi:[1,1,0]
s_setprio 1
v_mfma_f32_32x32x16_bf16 v[0:15], v[228:231], v[228:231], 0
s_add_u32 s46, s80, 6291456
buffer_store_dwordx4 v[60:63], v241, s[32:35], s46 offen sc1
ds_read_b128 v[224:227], v248 offset:38912
v_cvt_pkrtz_f16_f32 v137, v120, v121
v_cvt_pkrtz_f16_f32 v139, v122, v123
v_cvt_pkrtz_f16_f32 v141, v124, v125
v_cvt_pkrtz_f16_f32 v143, v126, v127
v_mfma_f32_32x32x16_bf16 v[16:31], v[228:231], v[228:231], 0
v_cvt_pk_f16_f32 v155, v128, v129
v_cvt_pk_f16_f32 v152, v130, v131
v_cvt_pk_f16_f32 v149, v132, v133
v_cvt_pk_f16_f32 v146, v134, v135
v_mfma_f32_32x32x16_bf16 v[32:47], v[228:231], v[228:231], 0
v_pk_fma_f16 v154, v155, v155, s48
v_and_b32_e64 v137, s49, v137
v_pk_fma_f16 v151, v152, v152, s48
v_pk_fma_f16 v148, v149, v149, s48
v_mfma_f32_32x32x16_bf16 v[120:135], v[72:75], v[232:235], 0
ds_read_b128 v[228:231], v248 offset:36864
v_and_b32_e64 v139, s49, v139
v_pk_fma_f16 v145, v146, v146, s48
v_pk_mul_f16 v154, v155, v154
v_bfe_u32 v136, v137, 2, 14
v_pk_mul_f16 v151, v152, v151
v_pk_mul_f16 v148, v149, v148
v_bfe_u32 v138, v139, 2, 14
v_pk_mul_f16 v145, v146, v145
v_mfma_f32_32x32x16_bf16 v[120:135], v[76:79], v[236:239], v[120:135]
ds_read_b128 v[232:235], v245 offset:384
ds_read_b128 v[200:203], v242 offset:128
ds_read_b128 v[204:207], v243
ds_read_u16_d16 v136, v136
ds_read_u16_d16 v138, v138
v_exp_f16 v153, v154
v_lshrrev_b32 v137, 18, v137
v_exp_f16 v150, v151
v_lshrrev_b32 v139, 18, v139
v_exp_f16_e64 v147, v148
v_mfma_f32_32x32x16_bf16 v[120:135], v[80:83], v[216:219], v[120:135]
ds_read_b128 v[236:239], v248 offset:39936
ds_read_u16_d16_hi v137, v137
ds_read_u16_d16_hi v139, v139
v_and_b32 v141, s49, v141
v_exp_f16 v144, v145
v_and_b32 v143, s49, v143
v_exp_f16_sdwa v153, v154 dst_sel:WORD_1 dst_unused:UNUSED_PRESERVE src0_sel:WORD_1
v_bfe_u32 v140, v141, 2, 14
s_waitcnt lgkmcnt(8)
v_smfmac_f32_16x16x32_bf16 v[0:3], v[220:221], v[192:195], v246
ds_read_b128 v[216:219], v245 offset:768
ds_read_b128 v[208:211], v243 offset:64
ds_read_b128 v[212:215], v243 offset:128
ds_read_u16_d16 v140, v140
v_exp_f16_sdwa v150, v151 dst_sel:WORD_1 dst_unused:UNUSED_PRESERVE src0_sel:WORD_1
v_bfe_u32 v142, v143, 2, 14
v_exp_f16_sdwa v147, v148 dst_sel:WORD_1 dst_unused:UNUSED_PRESERVE src0_sel:WORD_1
v_smfmac_f32_16x16x32_bf16 v[16:19], v[222:223], v[196:199], v246
v_lshrrev_b32_e64 v141, 18, v141
v_exp_f16_sdwa v144, v145 dst_sel:WORD_1 dst_unused:UNUSED_PRESERVE src0_sel:WORD_1
v_lshrrev_b32_e64 v143, 18, v143
v_mfma_f32_32x32x16_bf16 v[120:135], v[84:87], v[224:227], v[120:135]
ds_read_b128 v[220:223], v245 offset:1152
ds_read_b128 v[192:195], v244
ds_read_b128 v[196:199], v244 offset:64
ds_read_u16_d16 v142, v142
ds_read_u16_d16_hi v141, v141
ds_read_u16_d16_hi v143, v143
v_pk_add_f16 v153, v153, 1.0 op_sel_hi:[1,0]
v_pk_add_f16 v150, v150, 1.0 op_sel_hi:[1,0]
v_pk_add_f16 v147, v147, 1.0 op_sel_hi:[1,0]
v_pk_add_f16 v144, v144, 1.0 op_sel_hi:[1,0]
v_rcp_f16 v154, v153
v_rcp_f16 v151, v150
v_mfma_f32_32x32x16_bf16 v[120:135], v[88:91], v[228:231], v[120:135]
ds_read_b128 v[224:227], v248 offset:40960
v_rcp_f16 v148, v147
v_rcp_f16 v145, v144
v_rcp_f16_sdwa v154, v153 dst_sel:WORD_1 dst_unused:UNUSED_PRESERVE src0_sel:WORD_1
v_rcp_f16_sdwa v151, v150 dst_sel:WORD_1 dst_unused:UNUSED_PRESERVE src0_sel:WORD_1
s_setprio 0
s_waitcnt lgkmcnt(7)
v_smfmac_f32_16x16x32_bf16 v[32:35], v[232:233], v[200:203], v246
ds_read_b128 v[228:231], v248 offset:44032
v_rcp_f16_sdwa v148, v147 dst_sel:WORD_1 dst_unused:UNUSED_PRESERVE src0_sel:WORD_1
v_fma_mix_f32 v158, v136, v136, v158 op_sel:[0,0,0] op_sel_hi:[1,1,0]
v_smfmac_f32_16x16x32_bf16 v[0:3], v[234:235], v[204:207], v246
v_rcp_f16_sdwa v145, v144 dst_sel:WORD_1 dst_unused:UNUSED_PRESERVE src0_sel:WORD_1
v_fma_mix_f32 v158, v137, v137, v158 op_sel:[1,1,0] op_sel_hi:[1,1,0]
v_pk_mul_f16 v155, v155, v154
v_fma_mix_f32 v158, v138, v138, v158 op_sel:[0,0,0] op_sel_hi:[1,1,0]
v_mfma_f32_32x32x16_bf16 v[120:135], v[92:95], v[236:239], v[120:135]
ds_read_b128 v[232:235], v248 offset:41984
v_pk_mul_f16 v152, v152, v151
v_pk_mul_f16 v149, v149, v148
v_fma_mix_f32 v158, v139, v139, v158 op_sel:[1,1,0] op_sel_hi:[1,1,0]
v_pk_mul_f16 v146, v146, v145
v_fma_mix_f32 v158, v155, v155, v158 op_sel:[0,0,0] op_sel_hi:[1,1,0]
v_fma_mix_f32 v158, v140, v140, v158 op_sel:[0,0,0] op_sel_hi:[1,1,0]
v_fma_mix_f32 v158, v155, v155, v158 op_sel:[1,1,0] op_sel_hi:[1,1,0]
v_fma_mix_f32 v158, v152, v152, v158 op_sel:[0,0,0] op_sel_hi:[1,1,0]
v_smfmac_f32_16x16x32_bf16 v[16:19], v[216:217], v[208:211], v246
ds_read_b128 v[236:239], v248 offset:45056
s_waitcnt lgkmcnt(3)
v_fma_mix_f32 v158, v141, v141, v158 op_sel:[1,1,0] op_sel_hi:[1,1,0]
v_fma_mix_f32 v158, v152, v152, v158 op_sel:[1,1,0] op_sel_hi:[1,1,0]
v_fma_mix_f32 v158, v149, v149, v158 op_sel:[0,0,0] op_sel_hi:[1,1,0]
v_fma_mix_f32 v158, v142, v142, v158 op_sel:[0,0,0] op_sel_hi:[1,1,0]
v_smfmac_f32_16x16x32_bf16 v[32:35], v[218:219], v[212:215], v246
v_fma_mix_f32 v158, v149, v149, v158 op_sel:[1,1,0] op_sel_hi:[1,1,0]
v_fma_mix_f32 v158, v146, v146, v158 op_sel:[0,0,0] op_sel_hi:[1,1,0]
v_fma_mix_f32 v158, v143, v143, v158 op_sel:[1,1,0] op_sel_hi:[1,1,0]
v_fma_mix_f32 v158, v146, v146, v158 op_sel:[1,1,0] op_sel_hi:[1,1,0]
s_setprio 2
v_smfmac_f32_16x16x32_bf16 v[0:3], v[220:221], v[192:195], v246
s_add_u32 s46, s80, 8388608
buffer_store_dwordx4 v[64:67], v241, s[32:35], s46 offen sc1
ds_read_b128 v[216:219], v248 offset:43008
v_cvt_pkrtz_f16_f32 v137, v120, v121
v_cvt_pkrtz_f16_f32 v139, v122, v123
v_cvt_pkrtz_f16_f32 v141, v124, v125
v_cvt_pkrtz_f16_f32 v143, v126, v127
v_smfmac_f32_16x16x32_bf16 v[16:19], v[222:223], v[196:199], v246
v_cvt_pkrtz_f16_f32 v145, v128, v129
v_cvt_pk_f16_f32 v155, v130, v131
v_cvt_pk_f16_f32 v152, v132, v133
v_cvt_pk_f16_f32 v149, v134, v135
v_mfma_f32_32x32x16_bf16 v[120:135], v[72:75], v[224:227], 0
ds_read_b128 v[220:223], v245 offset:1536
ds_read_b128 v[200:203], v244 offset:128
v_xor_b32 v242, 16, v242
ds_read_b128 v[204:207], v242
v_pk_fma_f16 v154, v155, v155, s48
v_and_b32 v137, s49, v137
v_pk_fma_f16 v151, v152, v152, s48
v_and_b32 v139, s49, v139
v_pk_fma_f16 v148, v149, v149, s48
v_pk_mul_f16 v154, v155, v154
v_bfe_u32 v136, v137, 2, 14
v_pk_mul_f16 v151, v152, v151
s_waitcnt lgkmcnt(4)
v_mfma_f32_32x32x16_bf16 v[120:135], v[76:79], v[228:231], v[120:135]
ds_read_b128 v[224:227], v248 offset:46080
ds_read_u16_d16 v136, v136
v_pk_mul_f16 v148, v149, v148
v_bfe_u32 v138, v139, 2, 14
v_exp_f16 v153, v154
v_lshrrev_b32 v137, 18, v137
v_exp_f16 v150, v151
v_lshrrev_b32 v139, 18, v139
v_mfma_f32_32x32x16_bf16 v[120:135], v[80:83], v[232:235], v[120:135]
ds_read_b128 v[228:231], v245 offset:1920
ds_read_b128 v[208:211], v242 offset:64
ds_read_b128 v[212:215], v242 offset:128
ds_read_u16_d16 v138, v138
ds_read_u16_d16_hi v137, v137
ds_read_u16_d16_hi v139, v139
v_exp_f16 v147, v148
v_and_b32 v141, s49, v141
v_and_b32 v143, s49, v143
v_exp_f16_sdwa v153, v154 dst_sel:WORD_1 dst_unused:UNUSED_PRESERVE src0_sel:WORD_1
v_bfe_u32 v140, v141, 2, 14
v_exp_f16_sdwa v150, v151 dst_sel:WORD_1 dst_unused:UNUSED_PRESERVE src0_sel:WORD_1
v_mfma_f32_32x32x16_bf16 v[120:135], v[84:87], v[236:239], v[120:135]
ds_read_b128 v[232:235], v245 offset:2304
v_xor_b32 v243, 16, v243
ds_read_b128 v[192:195], v243
ds_read_b128 v[196:199], v243 offset:64
ds_read_u16_d16 v140, v140
v_bfe_u32 v142, v143, 2, 14
v_exp_f16_sdwa v147, v148 dst_sel:WORD_1 dst_unused:UNUSED_PRESERVE src0_sel:WORD_1
v_lshrrev_b32_e64 v141, 18, v141
v_pk_add_f16 v153, v153, 1.0 op_sel_hi:[1,0]
v_lshrrev_b32 v143, 18, v143
v_pk_add_f16 v150, v150, 1.0 op_sel_hi:[1,0]
v_pk_add_f16 v147, v147, 1.0 op_sel_hi:[1,0]
s_waitcnt lgkmcnt(9)
v_mfma_f32_32x32x16_bf16 v[120:135], v[88:91], v[216:219], v[120:135]
ds_read_b128 v[236:239], v248 offset:47104
ds_read_u16_d16 v142, v142
ds_read_u16_d16_hi v141, v141
ds_read_u16_d16_hi v143, v143
v_and_b32 v145, s49, v145
v_rcp_f16 v154, v153
v_bfe_u32 v144, v145, 2, 14
v_rcp_f16 v151, v150
v_lshrrev_b32 v145, 18, v145
v_rcp_f16_e64 v148, v147
v_smfmac_f32_16x16x32_bf16 v[32:35], v[220:221], v[200:203], v246
ds_read_b128 v[216:219], v248 offset:50176
ds_read_u16_d16 v144, v144
ds_read_u16_d16_hi v145, v145
v_rcp_f16_sdwa v154, v153 dst_sel:WORD_1 dst_unused:UNUSED_PRESERVE src0_sel:WORD_1
v_fma_mix_f32 v159, v136, v136, v159 op_sel:[0,0,0] op_sel_hi:[1,1,0]
s_waitcnt lgkmcnt(7)
v_fma_mix_f32 v159, v137, v137, v159 op_sel:[1,1,0] op_sel_hi:[1,1,0]
v_smfmac_f32_16x16x32_bf16 v[4:7], v[222:223], v[204:207], v246
v_rcp_f16_sdwa v151, v150 dst_sel:WORD_1 dst_unused:UNUSED_PRESERVE src0_sel:WORD_1
v_fma_mix_f32 v159, v138, v138, v159 op_sel:[0,0,0] op_sel_hi:[1,1,0]
v_mfma_f32_32x32x16_bf16 v[120:135], v[92:95], v[224:227], v[120:135]
ds_read_b128 v[220:223], v248 offset:48128
v_rcp_f16_sdwa v148, v147 dst_sel:WORD_1 dst_unused:UNUSED_PRESERVE src0_sel:WORD_1
v_fma_mix_f32 v159, v139, v139, v159 op_sel:[1,1,0] op_sel_hi:[1,1,0]
v_pk_mul_f16 v155, v155, v154
v_fma_mix_f32 v159, v140, v140, v159 op_sel:[0,0,0] op_sel_hi:[1,1,0]
v_pk_mul_f16 v152, v152, v151
s_waitcnt lgkmcnt(4)
v_fma_mix_f32 v159, v141, v141, v159 op_sel:[1,1,0] op_sel_hi:[1,1,0]
v_pk_mul_f16 v149, v149, v148
v_fma_mix_f32 v159, v155, v155, v159 op_sel:[0,0,0] op_sel_hi:[1,1,0]
v_smfmac_f32_16x16x32_bf16 v[20:23], v[228:229], v[208:211], v246
ds_read_b128 v[224:227], v248 offset:51200
v_fma_mix_f32 v159, v142, v142, v159 op_sel:[0,0,0] op_sel_hi:[1,1,0]
v_fma_mix_f32 v159, v155, v155, v159 op_sel:[1,1,0] op_sel_hi:[1,1,0]
v_fma_mix_f32 v159, v143, v143, v159 op_sel:[1,1,0] op_sel_hi:[1,1,0]
v_fma_mix_f32 v159, v152, v152, v159 op_sel:[0,0,0] op_sel_hi:[1,1,0]
v_smfmac_f32_16x16x32_bf16 v[36:39], v[230:231], v[212:215], v246
v_fma_mix_f32 v159, v152, v152, v159 op_sel:[1,1,0] op_sel_hi:[1,1,0]
s_waitcnt lgkmcnt(2)
v_fma_mix_f32 v159, v144, v144, v159 op_sel:[0,0,0] op_sel_hi:[1,1,0]
v_fma_mix_f32 v159, v149, v149, v159 op_sel:[0,0,0] op_sel_hi:[1,1,0]
v_fma_mix_f32 v159, v145, v145, v159 op_sel:[1,1,0] op_sel_hi:[1,1,0]
v_fma_mix_f32 v159, v149, v149, v159 op_sel:[1,1,0] op_sel_hi:[1,1,0]
s_setprio 1
v_smfmac_f32_16x16x32_bf16 v[4:7], v[232:233], v[192:195], v246
s_add_u32 s46, s80, 10485760
buffer_store_dwordx4 v[68:71], v241, s[32:35], s46 offen sc1
ds_read_b128 v[228:231], v248 offset:49152
v_cvt_pkrtz_f16_f32 v137, v120, v121
v_cvt_pkrtz_f16_f32 v139, v122, v123
v_cvt_pkrtz_f16_f32 v141, v124, v125
v_cvt_pkrtz_f16_f32 v143, v126, v127
v_cvt_pk_f16_f32 v155, v128, v129
v_smfmac_f32_16x16x32_bf16 v[20:23], v[234:235], v[196:199], v246
v_cvt_pk_f16_f32 v152, v130, v131
v_cvt_pk_f16_f32 v149, v132, v133
v_cvt_pk_f16_f32 v146, v134, v135
v_pk_fma_f16 v154, v155, v155, s48
v_and_b32_e64 v137, s49, v137
v_mfma_f32_32x32x16_bf16 v[120:135], v[72:75], v[236:239], 0
ds_read_b128 v[232:235], v248 offset:52224
v_pk_fma_f16 v151, v152, v152, s48
v_pk_fma_f16 v148, v149, v149, s48
v_and_b32_e64 v139, s49, v139
v_pk_fma_f16 v145, v146, v146, s48
v_pk_mul_f16 v154, v155, v154
v_bfe_u32 v136, v137, 2, 14
v_pk_mul_f16 v151, v152, v151
v_pk_mul_f16 v148, v149, v148
v_bfe_u32 v138, v139, 2, 14
v_pk_mul_f16 v145, v146, v145
v_mfma_f32_32x32x16_bf16 v[120:135], v[76:79], v[216:219], v[120:135]
ds_read_b128 v[236:239], v245 offset:2688
ds_read_b128 v[200:203], v243 offset:128
v_xor_b32 v244, 16, v244
ds_read_b128 v[204:207], v244
ds_read_u16_d16 v136, v136
ds_read_u16_d16 v138, v138
v_exp_f16 v153, v154
v_lshrrev_b32 v137, 18, v137
v_exp_f16 v150, v151
v_lshrrev_b32 v139, 18, v139
v_exp_f16 v147, v148
v_and_b32_e64 v141, s49, v141
v_exp_f16 v144, v145
s_waitcnt lgkmcnt(5)
v_mfma_f32_32x32x16_bf16 v[120:135], v[80:83], v[220:223], v[120:135]
ds_read_b128 v[216:219], v245 offset:3072
ds_read_b128 v[208:211], v244 offset:64
ds_read_b128 v[212:215], v244 offset:128
ds_read_u16_d16_hi v137, v137
ds_read_u16_d16_hi v139, v139
v_and_b32_e64 v143, s49, v143
v_exp_f16_sdwa v153, v154 dst_sel:WORD_1 dst_unused:UNUSED_PRESERVE src0_sel:WORD_1
v_bfe_u32 v140, v141, 2, 14
v_exp_f16_sdwa v150, v151 dst_sel:WORD_1 dst_unused:UNUSED_PRESERVE src0_sel:WORD_1
v_bfe_u32 v142, v143, 2, 14
v_exp_f16_sdwa v147, v148 dst_sel:WORD_1 dst_unused:UNUSED_PRESERVE src0_sel:WORD_1
v_lshrrev_b32_e64 v141, 18, v141
v_mfma_f32_32x32x16_bf16 v[120:135], v[84:87], v[224:227], v[120:135]
ds_read_b128 v[220:223], v248 offset:53248
ds_read_u16_d16 v140, v140
ds_read_u16_d16 v142, v142
ds_read_u16_d16_hi v141, v141
v_exp_f16_sdwa v144, v145 dst_sel:WORD_1 dst_unused:UNUSED_PRESERVE src0_sel:WORD_1
v_lshrrev_b32_e64 v143, 18, v143
v_pk_add_f16 v153, v153, 1.0 op_sel_hi:[1,0]
v_pk_add_f16 v150, v150, 1.0 op_sel_hi:[1,0]
v_pk_add_f16 v147, v147, 1.0 op_sel_hi:[1,0]
v_pk_add_f16 v144, v144, 1.0 op_sel_hi:[1,0]
v_rcp_f16 v154, v153
v_rcp_f16 v151, v150
v_mfma_f32_32x32x16_bf16 v[120:135], v[88:91], v[228:231], v[120:135]
ds_read_b128 v[224:227], v248 offset:56320
ds_read_u16_d16_hi v143, v143
v_rcp_f16 v148, v147
v_rcp_f16 v145, v144
v_rcp_f16_sdwa v154, v153 dst_sel:WORD_1 dst_unused:UNUSED_PRESERVE src0_sel:WORD_1
v_rcp_f16_sdwa v151, v150 dst_sel:WORD_1 dst_unused:UNUSED_PRESERVE src0_sel:WORD_1
s_setprio 0
v_rcp_f16_sdwa v148, v147 dst_sel:WORD_1 dst_unused:UNUSED_PRESERVE src0_sel:WORD_1
s_waitcnt lgkmcnt(6)
v_fma_mix_f32 v160, v136, v136, v160 op_sel:[0,0,0] op_sel_hi:[1,1,0]
v_mfma_f32_32x32x16_bf16 v[120:135], v[92:95], v[232:235], v[120:135]
ds_read_b128 v[228:231], v248 offset:54272
v_rcp_f16_sdwa v145, v144 dst_sel:WORD_1 dst_unused:UNUSED_PRESERVE src0_sel:WORD_1
v_fma_mix_f32 v160, v137, v137, v160 op_sel:[1,1,0] op_sel_hi:[1,1,0]
v_pk_mul_f16 v155, v155, v154
v_fma_mix_f32 v160, v138, v138, v160 op_sel:[0,0,0] op_sel_hi:[1,1,0]
v_pk_mul_f16 v152, v152, v151
v_pk_mul_f16 v149, v149, v148
v_fma_mix_f32 v160, v139, v139, v160 op_sel:[1,1,0] op_sel_hi:[1,1,0]
v_pk_mul_f16 v146, v146, v145
v_fma_mix_f32 v160, v155, v155, v160 op_sel:[0,0,0] op_sel_hi:[1,1,0]
v_smfmac_f32_16x16x32_bf16 v[36:39], v[236:237], v[200:203], v246
ds_read_b128 v[232:235], v248 offset:57344
s_waitcnt lgkmcnt(4)
v_fma_mix_f32 v160, v140, v140, v160 op_sel:[0,0,0] op_sel_hi:[1,1,0]
v_fma_mix_f32 v160, v155, v155, v160 op_sel:[1,1,0] op_sel_hi:[1,1,0]
v_fma_mix_f32 v160, v152, v152, v160 op_sel:[0,0,0] op_sel_hi:[1,1,0]
v_fma_mix_f32 v160, v141, v141, v160 op_sel:[1,1,0] op_sel_hi:[1,1,0]
v_fma_mix_f32 v160, v152, v152, v160 op_sel:[1,1,0] op_sel_hi:[1,1,0]
v_smfmac_f32_16x16x32_bf16 v[4:7], v[238:239], v[204:207], v246
v_fma_mix_f32 v160, v149, v149, v160 op_sel:[0,0,0] op_sel_hi:[1,1,0]
v_fma_mix_f32 v160, v142, v142, v160 op_sel:[0,0,0] op_sel_hi:[1,1,0]
v_fma_mix_f32 v160, v149, v149, v160 op_sel:[1,1,0] op_sel_hi:[1,1,0]
v_fma_mix_f32 v160, v146, v146, v160 op_sel:[0,0,0] op_sel_hi:[1,1,0]
s_waitcnt lgkmcnt(2)
v_fma_mix_f32 v160, v143, v143, v160 op_sel:[1,1,0] op_sel_hi:[1,1,0]
v_fma_mix_f32 v160, v146, v146, v160 op_sel:[1,1,0] op_sel_hi:[1,1,0]
s_cmp_lg_u32 s40, 7
s_cbranch_scc1 Lnobias2
s_sub_u32 s43, s2, 96
s_cmp_lt_u32 s43, 96
s_cbranch_scc0 Lnobias2
s_waitcnt vmcnt(17)
v_lshlrev_b32 v178, 16, v178
v_lshlrev_b32 v179, 16, v179
v_lshlrev_b32 v180, 16, v180
v_lshlrev_b32 v181, 16, v181
v_lshlrev_b32 v182, 16, v182
v_lshlrev_b32 v183, 16, v183
v_lshlrev_b32 v184, 16, v184
v_lshlrev_b32 v185, 16, v185
v_lshlrev_b32 v186, 16, v186
v_lshlrev_b32 v187, 16, v187
v_lshlrev_b32 v188, 16, v188
v_lshlrev_b32 v189, 16, v189
v_mul_f32 v176, v178, v184
v_fmac_f32 v176, v179, v185
v_fmac_f32 v176, v180, v186
v_fmac_f32 v176, v181, v187
v_fmac_f32 v176, v182, v188
v_fmac_f32 v176, v183, v189
s_nop 1
v_add_f32_dpp v176, v176, v176 row_ror:8 row_mask:0xf bank_mask:0xf
s_nop 1
v_add_f32_dpp v176, v176, v176 row_ror:4 row_mask:0xf bank_mask:0xf
s_nop 1
v_add_f32_dpp v176, v176, v176 row_ror:2 row_mask:0xf bank_mask:0xf
s_nop 1
v_add_f32_dpp v176, v176, v176 row_ror:1 row_mask:0xf bank_mask:0xf
v_mov_b32 v177, v176
s_nop 1
v_permlane16_swap_b32 v176, v177
v_add_f32 v176, v176, v177
v_mov_b32_e64 v177, v176
s_nop 1
v_permlane32_swap_b32 v176, v177
v_add_f32 v176, v176, v177
s_lshl_b32 s44, s43, 2
s_add_u32 s44, s44, 394752
v_lshlrev_b32_e64 v191, 11, v251
s_mov_b64 exec, 0xff
buffer_store_dword v176, v191, s[32:35], s44 offen sc1
s_mov_b64 exec, -1
Lnobias2:
s_setprio 2
v_smfmac_f32_16x16x32_bf16 v[20:23], v[216:217], v[208:211], v246
ds_read_b128 v[236:239], v248 offset:55296
v_cvt_pkrtz_f16_f32 v137, v120, v121
v_cvt_pkrtz_f16_f32 v139, v122, v123
v_cvt_pkrtz_f16_f32 v141, v124, v125
v_cvt_pkrtz_f16_f32 v143, v126, v127
v_smfmac_f32_16x16x32_bf16 v[36:39], v[218:219], v[212:215], v246
v_cvt_pkrtz_f16_f32 v145, v128, v129
v_cvt_pk_f16_f32 v155, v130, v131
v_cvt_pk_f16_f32 v152, v132, v133
v_cvt_pk_f16_f32 v149, v134, v135
v_mfma_f32_32x32x16_bf16 v[120:135], v[72:75], v[220:223], 0
ds_read_b128 v[216:219], v245 offset:3456
v_xor_b32 v242, 32, v242
ds_read_b128 v[192:195], v242
ds_read_b128 v[196:199], v242 offset:64
v_pk_fma_f16 v154, v155, v155, s48
v_and_b32 v137, s49, v137
v_pk_fma_f16 v151, v152, v152, s48
v_and_b32_e64 v139, s49, v139
v_pk_fma_f16 v148, v149, v149, s48
v_pk_mul_f16 v154, v155, v154
v_bfe_u32 v136, v137, 2, 14
v_pk_mul_f16 v151, v152, v151
v_mfma_f32_32x32x16_bf16 v[120:135], v[76:79], v[224:227], v[120:135]
ds_read_b128 v[220:223], v248 offset:58368
ds_read_u16_d16 v136, v136
v_pk_mul_f16 v148, v149, v148
v_bfe_u32 v138, v139, 2, 14
v_exp_f16 v153, v154
v_lshrrev_b32 v137, 18, v137
v_exp_f16 v150, v151
v_lshrrev_b32 v139, 18, v139
s_waitcnt lgkmcnt(5)
v_mfma_f32_32x32x16_bf16 v[120:135], v[80:83], v[228:231], v[120:135]
ds_read_b128 v[224:227], v245 offset:3840
ds_read_b128 v[200:203], v242 offset:128
v_xor_b32 v243, 32, v243
ds_read_b128 v[204:207], v243
ds_read_u16_d16 v138, v138
ds_read_u16_d16_hi v137, v137
ds_read_u16_d16_hi v139, v139
v_exp_f16 v147, v148
v_and_b32 v141, s49, v141
v_and_b32_e64 v143, s49, v143
v_exp_f16_sdwa v153, v154 dst_sel:WORD_1 dst_unused:UNUSED_PRESERVE src0_sel:WORD_1
v_bfe_u32 v140, v141, 2, 14
v_exp_f16_sdwa v150, v151 dst_sel:WORD_1 dst_unused:UNUSED_PRESERVE src0_sel:WORD_1
v_mfma_f32_32x32x16_bf16 v[120:135], v[84:87], v[232:235], v[120:135]
ds_read_b128 v[228:231], v245 offset:4224
ds_read_b128 v[208:211], v243 offset:64
ds_read_b128 v[212:215], v243 offset:128
ds_read_u16_d16 v140, v140
v_bfe_u32 v142, v143, 2, 14
v_exp_f16_sdwa v147, v148 dst_sel:WORD_1 dst_unused:UNUSED_PRESERVE src0_sel:WORD_1
v_lshrrev_b32_e64 v141, 18, v141
v_pk_add_f16 v153, v153, 1.0 op_sel_hi:[1,0]
v_lshrrev_b32_e64 v143, 18, v143
v_pk_add_f16 v150, v150, 1.0 op_sel_hi:[1,0]
v_pk_add_f16 v147, v147, 1.0 op_sel_hi:[1,0]
v_mfma_f32_32x32x16_bf16 v[120:135], v[88:91], v[236:239], v[120:135]
ds_read_b128 v[232:235], v248 offset:59392
ds_read_u16_d16 v142, v142
ds_read_u16_d16_hi v141, v141
ds_read_u16_d16_hi v143, v143
v_and_b32 v145, s49, v145
v_rcp_f16 v154, v153
v_bfe_u32 v144, v145, 2, 14
v_rcp_f16 v151, v150
v_lshrrev_b32 v145, 18, v145
v_rcp_f16 v148, v147
s_waitcnt lgkmcnt(8)
v_smfmac_f32_16x16x32_bf16 v[12:15], v[216:217], v[192:195], v246
ds_read_b128 v[236:239], v248 offset:62464
ds_read_u16_d16 v144, v144
ds_read_u16_d16_hi v145, v145
v_rcp_f16_sdwa v154, v153 dst_sel:WORD_1 dst_unused:UNUSED_PRESERVE src0_sel:WORD_1
v_fma_mix_f32 v161, v136, v136, v161 op_sel:[0,0,0] op_sel_hi:[1,1,0]
v_fma_mix_f32 v161, v137, v137, v161 op_sel:[1,1,0] op_sel_hi:[1,1,0]
v_smfmac_f32_16x16x32_bf16 v[28:31], v[218:219], v[196:199], v246
v_rcp_f16_sdwa v151, v150 dst_sel:WORD_1 dst_unused:UNUSED_PRESERVE src0_sel:WORD_1
v_fma_mix_f32 v161, v138, v138, v161 op_sel:[0,0,0] op_sel_hi:[1,1,0]
v_mfma_f32_32x32x16_bf16 v[120:135], v[92:95], v[220:223], v[120:135]
ds_read_b128 v[216:219], v248 offset:60416
v_rcp_f16_sdwa v148, v147 dst_sel:WORD_1 dst_unused:UNUSED_PRESERVE src0_sel:WORD_1
v_fma_mix_f32 v161, v139, v139, v161 op_sel:[1,1,0] op_sel_hi:[1,1,0]
v_pk_mul_f16 v155, v155, v154
s_waitcnt lgkmcnt(6)
v_fma_mix_f32 v161, v140, v140, v161 op_sel:[0,0,0] op_sel_hi:[1,1,0]
v_pk_mul_f16 v152, v152, v151
s_waitcnt lgkmcnt(4)
v_fma_mix_f32 v161, v141, v141, v161 op_sel:[1,1,0] op_sel_hi:[1,1,0]
v_pk_mul_f16 v149, v149, v148
v_fma_mix_f32 v161, v155, v155, v161 op_sel:[0,0,0] op_sel_hi:[1,1,0]
v_smfmac_f32_16x16x32_bf16 v[44:47], v[224:225], v[200:203], v246
ds_read_b128 v[220:223], v248 offset:63488
v_fma_mix_f32 v161, v142, v142, v161 op_sel:[0,0,0] op_sel_hi:[1,1,0]
v_fma_mix_f32 v161, v155, v155, v161 op_sel:[1,1,0] op_sel_hi:[1,1,0]
v_fma_mix_f32 v161, v143, v143, v161 op_sel:[1,1,0] op_sel_hi:[1,1,0]
v_fma_mix_f32 v161, v152, v152, v161 op_sel:[0,0,0] op_sel_hi:[1,1,0]
v_smfmac_f32_16x16x32_bf16 v[12:15], v[226:227], v[204:207], v246
v_fma_mix_f32 v161, v152, v152, v161 op_sel:[1,1,0] op_sel_hi:[1,1,0]
s_waitcnt lgkmcnt(2)
v_fma_mix_f32 v161, v144, v144, v161 op_sel:[0,0,0] op_sel_hi:[1,1,0]
v_fma_mix_f32 v161, v149, v149, v161 op_sel:[0,0,0] op_sel_hi:[1,1,0]
v_fma_mix_f32 v161, v145, v145, v161 op_sel:[1,1,0] op_sel_hi:[1,1,0]
v_fma_mix_f32 v161, v149, v149, v161 op_sel:[1,1,0] op_sel_hi:[1,1,0]
v_lshlrev_b32 v252, 7, v251
s_add_u32 s46, s47, 2359296
s_mov_b32 exec_lo, 131071
s_mov_b32 exec_hi, 0
s_mov_b32 m0, 16288
s_nop 0
buffer_load_dword v252, s[4:7], s46 offen lds
s_mov_b64 exec, -1
s_setprio 1
v_smfmac_f32_16x16x32_bf16 v[28:31], v[228:229], v[208:211], v246
ds_read_b128 v[224:227], v248 offset:61440
v_cvt_pkrtz_f16_f32 v137, v120, v121
v_cvt_pkrtz_f16_f32 v139, v122, v123
v_cvt_pkrtz_f16_f32 v141, v124, v125
v_cvt_pkrtz_f16_f32 v143, v126, v127
v_cvt_pk_f16_f32 v155, v128, v129
v_smfmac_f32_16x16x32_bf16 v[44:47], v[230:231], v[212:215], v246
v_cvt_pk_f16_f32 v152, v130, v131
v_cvt_pk_f16_f32 v149, v132, v133
v_cvt_pk_f16_f32 v146, v134, v135
v_pk_fma_f16 v154, v155, v155, s48
v_and_b32_e64 v137, s49, v137
v_mfma_f32_32x32x16_bf16 v[120:135], v[72:75], v[232:235], 0
ds_read_b128 v[228:231], v248 offset:64512
v_pk_fma_f16 v151, v152, v152, s48
v_pk_fma_f16 v148, v149, v149, s48
v_and_b32_e64 v139, s49, v139
v_pk_fma_f16 v145, v146, v146, s48
v_pk_mul_f16 v154, v155, v154
v_bfe_u32 v136, v137, 2, 14
v_pk_mul_f16 v151, v152, v151
v_pk_mul_f16 v148, v149, v148
v_bfe_u32 v138, v139, 2, 14
v_pk_mul_f16 v145, v146, v145
v_mfma_f32_32x32x16_bf16 v[120:135], v[76:79], v[236:239], v[120:135]
ds_read_b128 v[232:235], v245 offset:4608
v_xor_b32 v244, 32, v244
ds_read_b128 v[192:195], v244
ds_read_b128 v[196:199], v244 offset:64
ds_read_u16_d16 v136, v136
ds_read_u16_d16 v138, v138
v_exp_f16 v153, v154
v_lshrrev_b32 v137, 18, v137
v_exp_f16 v150, v151
v_lshrrev_b32 v139, 18, v139
v_exp_f16 v147, v148
v_and_b32 v141, s49, v141
v_exp_f16 v144, v145
s_waitcnt lgkmcnt(5)
v_mfma_f32_32x32x16_bf16 v[120:135], v[80:83], v[216:219], v[120:135]
ds_read_b128 v[236:239], v245 offset:4992
ds_read_b128 v[200:203], v244 offset:128
v_xor_b32 v242, 16, v242
ds_read_b128 v[204:207], v242
ds_read_u16_d16_hi v137, v137
ds_read_u16_d16_hi v139, v139
v_and_b32_e64 v143, s49, v143
v_exp_f16_sdwa v153, v154 dst_sel:WORD_1 dst_unused:UNUSED_PRESERVE src0_sel:WORD_1
v_bfe_u32 v140, v141, 2, 14
v_exp_f16_sdwa v150, v151 dst_sel:WORD_1 dst_unused:UNUSED_PRESERVE src0_sel:WORD_1
v_bfe_u32 v142, v143, 2, 14
v_exp_f16_sdwa v147, v148 dst_sel:WORD_1 dst_unused:UNUSED_PRESERVE src0_sel:WORD_1
v_lshrrev_b32_e64 v141, 18, v141
v_mfma_f32_32x32x16_bf16 v[120:135], v[84:87], v[220:223], v[120:135]
ds_read_b128 v[216:219], v249
ds_read_u16_d16 v140, v140
ds_read_u16_d16 v142, v142
ds_read_u16_d16_hi v141, v141
v_exp_f16_sdwa v144, v145 dst_sel:WORD_1 dst_unused:UNUSED_PRESERVE src0_sel:WORD_1
v_lshrrev_b32_e64 v143, 18, v143
v_pk_add_f16 v153, v153, 1.0 op_sel_hi:[1,0]
v_pk_add_f16 v150, v150, 1.0 op_sel_hi:[1,0]
v_pk_add_f16 v147, v147, 1.0 op_sel_hi:[1,0]
v_pk_add_f16 v144, v144, 1.0 op_sel_hi:[1,0]
v_rcp_f16 v154, v153
v_rcp_f16 v151, v150
v_mfma_f32_32x32x16_bf16 v[120:135], v[88:91], v[224:227], v[120:135]
ds_read_b128 v[220:223], v249 offset:3072
ds_read_u16_d16_hi v143, v143
v_rcp_f16 v148, v147
v_rcp_f16 v145, v144
v_rcp_f16_sdwa v154, v153 dst_sel:WORD_1 dst_unused:UNUSED_PRESERVE src0_sel:WORD_1
v_rcp_f16_sdwa v151, v150 dst_sel:WORD_1 dst_unused:UNUSED_PRESERVE src0_sel:WORD_1
s_setprio 0
v_rcp_f16_sdwa v148, v147 dst_sel:WORD_1 dst_unused:UNUSED_PRESERVE src0_sel:WORD_1
s_waitcnt lgkmcnt(6)
v_fma_mix_f32 v162, v136, v136, v162 op_sel:[0,0,0] op_sel_hi:[1,1,0]
v_mfma_f32_32x32x16_bf16 v[120:135], v[92:95], v[228:231], v[120:135]
ds_read_b128 v[224:227], v249 offset:1024
v_rcp_f16_sdwa v145, v144 dst_sel:WORD_1 dst_unused:UNUSED_PRESERVE src0_sel:WORD_1
v_fma_mix_f32 v162, v137, v137, v162 op_sel:[1,1,0] op_sel_hi:[1,1,0]
v_pk_mul_f16 v155, v155, v154
v_fma_mix_f32 v162, v138, v138, v162 op_sel:[0,0,0] op_sel_hi:[1,1,0]
v_pk_mul_f16 v152, v152, v151
v_pk_mul_f16 v149, v149, v148
v_fma_mix_f32 v162, v139, v139, v162 op_sel:[1,1,0] op_sel_hi:[1,1,0]
v_pk_mul_f16 v146, v146, v145
v_fma_mix_f32 v162, v155, v155, v162 op_sel:[0,0,0] op_sel_hi:[1,1,0]
v_smfmac_f32_16x16x32_bf16 v[12:15], v[232:233], v[192:195], v246
ds_read_b128 v[228:231], v249 offset:4096
s_waitcnt lgkmcnt(4)
v_fma_mix_f32 v162, v140, v140, v162 op_sel:[0,0,0] op_sel_hi:[1,1,0]
v_fma_mix_f32 v162, v155, v155, v162 op_sel:[1,1,0] op_sel_hi:[1,1,0]
v_fma_mix_f32 v162, v152, v152, v162 op_sel:[0,0,0] op_sel_hi:[1,1,0]
v_fma_mix_f32 v162, v141, v141, v162 op_sel:[1,1,0] op_sel_hi:[1,1,0]
v_fma_mix_f32 v162, v152, v152, v162 op_sel:[1,1,0] op_sel_hi:[1,1,0]
v_smfmac_f32_16x16x32_bf16 v[28:31], v[234:235], v[196:199], v246
v_fma_mix_f32 v162, v149, v149, v162 op_sel:[0,0,0] op_sel_hi:[1,1,0]
v_fma_mix_f32 v162, v142, v142, v162 op_sel:[0,0,0] op_sel_hi:[1,1,0]
v_fma_mix_f32 v162, v149, v149, v162 op_sel:[1,1,0] op_sel_hi:[1,1,0]
v_fma_mix_f32 v162, v146, v146, v162 op_sel:[0,0,0] op_sel_hi:[1,1,0]
s_waitcnt lgkmcnt(2)
v_fma_mix_f32 v162, v143, v143, v162 op_sel:[1,1,0] op_sel_hi:[1,1,0]
v_fma_mix_f32 v162, v146, v146, v162 op_sel:[1,1,0] op_sel_hi:[1,1,0]
v_lshlrev_b32_e64 v252, 7, v251
s_add_u32 s46, s47, 2359296
s_mov_b32 exec_lo, 4294836224
s_mov_b32 exec_hi, 3
s_mov_b32 m0, 16220
s_nop 0
buffer_load_dword v252, s[4:7], s46 offen lds
s_mov_b64 exec, -1
s_setprio 2
v_smfmac_f32_16x16x32_bf16 v[44:47], v[236:237], v[200:203], v246
ds_read_b128 v[232:235], v249 offset:2048
v_cvt_pkrtz_f16_f32 v137, v120, v121
v_cvt_pkrtz_f16_f32 v139, v122, v123
v_cvt_pkrtz_f16_f32 v141, v124, v125
v_cvt_pkrtz_f16_f32 v143, v126, v127
v_smfmac_f32_16x16x32_bf16 v[8:11], v[238:239], v[204:207], v246
v_cvt_pkrtz_f16_f32 v145, v128, v129
v_cvt_pk_f16_f32 v155, v130, v131
v_cvt_pk_f16_f32 v152, v132, v133
v_cvt_pk_f16_f32 v149, v134, v135
v_mfma_f32_32x32x16_bf16 v[120:135], v[72:75], v[216:219], 0
ds_read_b128 v[236:239], v245 offset:5376
ds_read_b128 v[208:211], v242 offset:64
ds_read_b128 v[212:215], v242 offset:128
v_pk_fma_f16 v154, v155, v155, s48
v_and_b32_e64 v137, s49, v137
v_pk_fma_f16 v151, v152, v152, s48
v_and_b32_e64 v139, s49, v139
v_pk_fma_f16 v148, v149, v149, s48
v_pk_mul_f16 v154, v155, v154
v_bfe_u32 v136, v137, 2, 14
v_pk_mul_f16 v151, v152, v151
v_mfma_f32_32x32x16_bf16 v[120:135], v[76:79], v[220:223], v[120:135]
ds_read_b128 v[216:219], v249 offset:5120
ds_read_u16_d16 v136, v136
v_pk_mul_f16 v148, v149, v148
v_bfe_u32 v138, v139, 2, 14
v_exp_f16 v153, v154
v_lshrrev_b32 v137, 18, v137
v_exp_f16 v150, v151
v_lshrrev_b32 v139, 18, v139
s_waitcnt lgkmcnt(5)
v_mfma_f32_32x32x16_bf16 v[120:135], v[80:83], v[224:227], v[120:135]
ds_read_b128 v[220:223], v245 offset:5760
v_xor_b32 v243, 16, v243
ds_read_b128 v[192:195], v243
ds_read_b128 v[196:199], v243 offset:64
ds_read_u16_d16 v138, v138
ds_read_u16_d16_hi v137, v137
ds_read_u16_d16_hi v139, v139
v_exp_f16 v147, v148
v_and_b32 v141, s49, v141
v_and_b32_e64 v143, s49, v143
v_exp_f16_sdwa v153, v154 dst_sel:WORD_1 dst_unused:UNUSED_PRESERVE src0_sel:WORD_1
v_bfe_u32 v140, v141, 2, 14
v_exp_f16_sdwa v150, v151 dst_sel:WORD_1 dst_unused:UNUSED_PRESERVE src0_sel:WORD_1
v_mfma_f32_32x32x16_bf16 v[120:135], v[84:87], v[228:231], v[120:135]
ds_read_b128 v[224:227], v245 offset:6144
ds_read_b128 v[200:203], v243 offset:128
v_xor_b32 v244, 16, v244
ds_read_b128 v[204:207], v244
ds_read_u16_d16 v140, v140
v_bfe_u32 v142, v143, 2, 14
v_exp_f16_sdwa v147, v148 dst_sel:WORD_1 dst_unused:UNUSED_PRESERVE src0_sel:WORD_1
v_lshrrev_b32 v141, 18, v141
v_pk_add_f16 v153, v153, 1.0 op_sel_hi:[1,0]
v_lshrrev_b32_e64 v143, 18, v143
v_pk_add_f16 v150, v150, 1.0 op_sel_hi:[1,0]
v_pk_add_f16 v147, v147, 1.0 op_sel_hi:[1,0]
v_mfma_f32_32x32x16_bf16 v[120:135], v[88:91], v[232:235], v[120:135]
ds_read_b128 v[228:231], v249 offset:6144
ds_read_u16_d16 v142, v142
ds_read_u16_d16_hi v141, v141
ds_read_u16_d16_hi v143, v143
v_and_b32 v145, s49, v145
v_rcp_f16 v154, v153
v_bfe_u32 v144, v145, 2, 14
v_rcp_f16 v151, v150
v_lshrrev_b32 v145, 18, v145
v_rcp_f16 v148, v147
s_waitcnt lgkmcnt(8)
v_smfmac_f32_16x16x32_bf16 v[24:27], v[236:237], v[208:211], v246
ds_read_b128 v[232:235], v249 offset:9216
ds_read_u16_d16 v144, v144
ds_read_u16_d16_hi v145, v145
v_rcp_f16_sdwa v154, v153 dst_sel:WORD_1 dst_unused:UNUSED_PRESERVE src0_sel:WORD_1
v_fma_mix_f32 v163, v136, v136, v163 op_sel:[0,0,0] op_sel_hi:[1,1,0]
v_fma_mix_f32 v163, v137, v137, v163 op_sel:[1,1,0] op_sel_hi:[1,1,0]
v_smfmac_f32_16x16x32_bf16 v[40:43], v[238:239], v[212:215], v246
v_rcp_f16_sdwa v151, v150 dst_sel:WORD_1 dst_unused:UNUSED_PRESERVE src0_sel:WORD_1
v_fma_mix_f32 v163, v138, v138, v163 op_sel:[0,0,0] op_sel_hi:[1,1,0]
v_mfma_f32_32x32x16_bf16 v[120:135], v[92:95], v[216:219], v[120:135]
ds_read_b128 v[236:239], v249 offset:7168
v_rcp_f16_sdwa v148, v147 dst_sel:WORD_1 dst_unused:UNUSED_PRESERVE src0_sel:WORD_1
v_fma_mix_f32 v163, v139, v139, v163 op_sel:[1,1,0] op_sel_hi:[1,1,0]
v_pk_mul_f16 v155, v155, v154
s_waitcnt lgkmcnt(6)
v_fma_mix_f32 v163, v140, v140, v163 op_sel:[0,0,0] op_sel_hi:[1,1,0]
v_pk_mul_f16 v152, v152, v151
s_waitcnt lgkmcnt(4)
v_fma_mix_f32 v163, v141, v141, v163 op_sel:[1,1,0] op_sel_hi:[1,1,0]
v_pk_mul_f16 v149, v149, v148
v_fma_mix_f32 v163, v155, v155, v163 op_sel:[0,0,0] op_sel_hi:[1,1,0]
v_smfmac_f32_16x16x32_bf16 v[8:11], v[220:221], v[192:195], v246
ds_read_b128 v[216:219], v249 offset:10240
v_fma_mix_f32 v163, v142, v142, v163 op_sel:[0,0,0] op_sel_hi:[1,1,0]
v_fma_mix_f32 v163, v155, v155, v163 op_sel:[1,1,0] op_sel_hi:[1,1,0]
v_fma_mix_f32 v163, v143, v143, v163 op_sel:[1,1,0] op_sel_hi:[1,1,0]
v_fma_mix_f32 v163, v152, v152, v163 op_sel:[0,0,0] op_sel_hi:[1,1,0]
v_smfmac_f32_16x16x32_bf16 v[24:27], v[222:223], v[196:199], v246
v_fma_mix_f32 v163, v152, v152, v163 op_sel:[1,1,0] op_sel_hi:[1,1,0]
s_waitcnt lgkmcnt(2)
v_fma_mix_f32 v163, v144, v144, v163 op_sel:[0,0,0] op_sel_hi:[1,1,0]
v_fma_mix_f32 v163, v149, v149, v163 op_sel:[0,0,0] op_sel_hi:[1,1,0]
v_fma_mix_f32 v163, v145, v145, v163 op_sel:[1,1,0] op_sel_hi:[1,1,0]
v_fma_mix_f32 v163, v149, v149, v163 op_sel:[1,1,0] op_sel_hi:[1,1,0]
v_lshlrev_b32 v252, 7, v251
s_add_u32 s46, s47, 2359296
s_mov_b32 exec_lo, 0
s_mov_b32 exec_hi, 1048572
s_mov_b32 m0, 16152
s_nop 0
buffer_load_dword v252, s[4:7], s46 offen lds
s_mov_b64 exec, -1
s_setprio 1
v_smfmac_f32_16x16x32_bf16 v[40:43], v[224:225], v[200:203], v246
ds_read_b128 v[220:223], v249 offset:8192
v_cvt_pkrtz_f16_f32 v137, v120, v121
v_cvt_pkrtz_f16_f32 v139, v122, v123
v_cvt_pkrtz_f16_f32 v141, v124, v125
v_cvt_pkrtz_f16_f32 v143, v126, v127
v_smfmac_f32_16x16x32_bf16 v[8:11], v[226:227], v[204:207], v246
v_cvt_pk_f16_f32 v155, v128, v129
v_cvt_pk_f16_f32 v152, v130, v131
v_cvt_pk_f16_f32 v149, v132, v133
v_cvt_pk_f16_f32 v146, v134, v135
v_pk_fma_f16 v154, v155, v155, s48
v_mfma_f32_32x32x16_bf16 v[120:135], v[72:75], v[228:231], 0
ds_read_b128 v[224:227], v249 offset:11264
v_and_b32_e64 v137, s49, v137
v_pk_fma_f16 v151, v152, v152, s48
v_pk_fma_f16 v148, v149, v149, s48
v_and_b32_e64 v139, s49, v139
v_pk_fma_f16 v145, v146, v146, s48
v_pk_mul_f16 v154, v155, v154
v_bfe_u32 v136, v137, 2, 14
v_pk_mul_f16 v151, v152, v151
v_pk_mul_f16 v148, v149, v148
v_bfe_u32 v138, v139, 2, 14
v_mfma_f32_32x32x16_bf16 v[120:135], v[76:79], v[232:235], v[120:135]
ds_read_b128 v[228:231], v245 offset:6528
ds_read_b128 v[208:211], v244 offset:64
ds_read_b128 v[212:215], v244 offset:128
ds_read_u16_d16 v136, v136
ds_read_u16_d16 v138, v138
v_pk_mul_f16 v145, v146, v145
v_exp_f16 v153, v154
v_lshrrev_b32 v137, 18, v137
v_exp_f16 v150, v151
v_lshrrev_b32 v139, 18, v139
v_exp_f16 v147, v148
s_waitcnt lgkmcnt(6)
v_mfma_f32_32x32x16_bf16 v[120:135], v[80:83], v[236:239], v[120:135]
ds_read_b128 v[232:235], v249 offset:12288
ds_read_u16_d16_hi v137, v137
ds_read_u16_d16_hi v139, v139
v_and_b32 v141, s49, v141
v_exp_f16 v144, v145
v_and_b32_e64 v143, s49, v143
v_exp_f16_sdwa v153, v154 dst_sel:WORD_1 dst_unused:UNUSED_PRESERVE src0_sel:WORD_1
v_bfe_u32 v140, v141, 2, 14
v_exp_f16_sdwa v150, v151 dst_sel:WORD_1 dst_unused:UNUSED_PRESERVE src0_sel:WORD_1
v_bfe_u32 v142, v143, 2, 14
v_mfma_f32_32x32x16_bf16 v[120:135], v[84:87], v[216:219], v[120:135]
ds_read_b128 v[236:239], v249 offset:15360
ds_read_u16_d16 v140, v140
ds_read_u16_d16 v142, v142
v_exp_f16_sdwa v147, v148 dst_sel:WORD_1 dst_unused:UNUSED_PRESERVE src0_sel:WORD_1
v_lshrrev_b32_e64 v141, 18, v141
v_exp_f16_sdwa v144, v145 dst_sel:WORD_1 dst_unused:UNUSED_PRESERVE src0_sel:WORD_1
v_lshrrev_b32_e64 v143, 18, v143
v_pk_add_f16 v153, v153, 1.0 op_sel_hi:[1,0]
v_pk_add_f16 v150, v150, 1.0 op_sel_hi:[1,0]
v_pk_add_f16 v147, v147, 1.0 op_sel_hi:[1,0]
v_mfma_f32_32x32x16_bf16 v[120:135], v[88:91], v[220:223], v[120:135]
ds_read_b128 v[216:219], v249 offset:13312
ds_read_u16_d16_hi v141, v141
ds_read_u16_d16_hi v143, v143
v_pk_add_f16 v144, v144, 1.0 op_sel_hi:[1,0]
v_rcp_f16 v154, v153
v_rcp_f16 v151, v150
v_rcp_f16 v148, v147
v_rcp_f16 v145, v144
s_waitcnt lgkmcnt(6)
v_mfma_f32_32x32x16_bf16 v[120:135], v[92:95], v[224:227], v[120:135]
ds_read_b128 v[220:223], v249 offset:16384
v_rcp_f16_sdwa v154, v153 dst_sel:WORD_1 dst_unused:UNUSED_PRESERVE src0_sel:WORD_1
v_rcp_f16_sdwa v151, v150 dst_sel:WORD_1 dst_unused:UNUSED_PRESERVE src0_sel:WORD_1
s_setprio 0
v_rcp_f16_sdwa v148, v147 dst_sel:WORD_1 dst_unused:UNUSED_PRESERVE src0_sel:WORD_1
v_fma_mix_f32 v164, v136, v136, v164 op_sel:[0,0,0] op_sel_hi:[1,1,0]
v_rcp_f16_sdwa v145, v144 dst_sel:WORD_1 dst_unused:UNUSED_PRESERVE src0_sel:WORD_1
v_fma_mix_f32 v164, v137, v137, v164 op_sel:[1,1,0] op_sel_hi:[1,1,0]
v_smfmac_f32_16x16x32_bf16 v[24:27], v[228:229], v[208:211], v246
ds_read_b128 v[224:227], v249 offset:14336
v_pk_mul_f16 v155, v155, v154
v_fma_mix_f32 v164, v138, v138, v164 op_sel:[0,0,0] op_sel_hi:[1,1,0]
v_pk_mul_f16 v152, v152, v151
v_pk_mul_f16 v149, v149, v148
v_fma_mix_f32 v164, v139, v139, v164 op_sel:[1,1,0] op_sel_hi:[1,1,0]
v_smfmac_f32_16x16x32_bf16 v[40:43], v[230:231], v[212:215], v246
s_mov_b64 exec, 1
ds_add_u32 v253, v254 offset:16
s_mov_b64 exec, -1
v_pk_mul_f16 v146, v146, v145
v_fma_mix_f32 v164, v155, v155, v164 op_sel:[0,0,0] op_sel_hi:[1,1,0]
s_waitcnt lgkmcnt(3)
v_fma_mix_f32 v164, v140, v140, v164 op_sel:[0,0,0] op_sel_hi:[1,1,0]
v_fma_mix_f32 v164, v155, v155, v164 op_sel:[1,1,0] op_sel_hi:[1,1,0]
v_fma_mix_f32 v164, v152, v152, v164 op_sel:[0,0,0] op_sel_hi:[1,1,0]
v_fma_mix_f32 v164, v141, v141, v164 op_sel:[1,1,0] op_sel_hi:[1,1,0]
v_fma_mix_f32 v164, v152, v152, v164 op_sel:[1,1,0] op_sel_hi:[1,1,0]
v_fma_mix_f32 v164, v149, v149, v164 op_sel:[0,0,0] op_sel_hi:[1,1,0]
v_fma_mix_f32 v164, v142, v142, v164 op_sel:[0,0,0] op_sel_hi:[1,1,0]
v_fma_mix_f32 v164, v149, v149, v164 op_sel:[1,1,0] op_sel_hi:[1,1,0]
v_fma_mix_f32 v164, v146, v146, v164 op_sel:[0,0,0] op_sel_hi:[1,1,0]
v_fma_mix_f32 v164, v143, v143, v164 op_sel:[1,1,0] op_sel_hi:[1,1,0]
v_fma_mix_f32 v164, v146, v146, v164 op_sel:[1,1,0] op_sel_hi:[1,1,0]
s_setprio 3
v_pk_add_f32 v[168:169], v[0:1], v[2:3]
v_pk_mul_f32 v[170:171], v[0:1], v[0:1]
v_pk_fma_f32 v[170:171], v[2:3], v[2:3], v[170:171]
v_pk_add_f32 v[168:169], v[168:169], v[4:5]
v_pk_fma_f32 v[170:171], v[4:5], v[4:5], v[170:171]
v_pk_add_f32 v[168:169], v[168:169], v[6:7]
v_pk_fma_f32 v[170:171], v[6:7], v[6:7], v[170:171]
v_pk_add_f32 v[168:169], v[168:169], v[8:9]
v_pk_fma_f32 v[170:171], v[8:9], v[8:9], v[170:171]
v_pk_add_f32 v[168:169], v[168:169], v[10:11]
v_pk_fma_f32 v[170:171], v[10:11], v[10:11], v[170:171]
v_pk_add_f32 v[168:169], v[168:169], v[12:13]
v_pk_fma_f32 v[170:171], v[12:13], v[12:13], v[170:171]
v_pk_add_f32 v[168:169], v[168:169], v[14:15]
v_pk_fma_f32 v[170:171], v[14:15], v[14:15], v[170:171]
v_pk_add_f32 v[168:169], v[168:169], v[16:17]
v_pk_fma_f32 v[170:171], v[16:17], v[16:17], v[170:171]
v_pk_add_f32 v[168:169], v[168:169], v[18:19]
v_pk_fma_f32 v[170:171], v[18:19], v[18:19], v[170:171]
v_pk_add_f32 v[168:169], v[168:169], v[20:21]
v_pk_fma_f32 v[170:171], v[20:21], v[20:21], v[170:171]
v_pk_add_f32 v[168:169], v[168:169], v[22:23]
v_pk_fma_f32 v[170:171], v[22:23], v[22:23], v[170:171]
v_pk_add_f32 v[168:169], v[168:169], v[24:25]
v_pk_fma_f32 v[170:171], v[24:25], v[24:25], v[170:171]
v_pk_add_f32 v[168:169], v[168:169], v[26:27]
v_pk_fma_f32 v[170:171], v[26:27], v[26:27], v[170:171]
v_pk_add_f32 v[168:169], v[168:169], v[28:29]
v_pk_fma_f32 v[170:171], v[28:29], v[28:29], v[170:171]
v_pk_add_f32 v[168:169], v[168:169], v[30:31]
v_pk_fma_f32 v[170:171], v[30:31], v[30:31], v[170:171]
v_pk_add_f32 v[168:169], v[168:169], v[32:33]
v_pk_fma_f32 v[170:171], v[32:33], v[32:33], v[170:171]
v_pk_add_f32 v[168:169], v[168:169], v[34:35]
v_pk_fma_f32 v[170:171], v[34:35], v[34:35], v[170:171]
v_pk_add_f32 v[168:169], v[168:169], v[36:37]
v_pk_fma_f32 v[170:171], v[36:37], v[36:37], v[170:171]
v_pk_add_f32 v[168:169], v[168:169], v[38:39]
v_pk_fma_f32 v[170:171], v[38:39], v[38:39], v[170:171]
v_pk_add_f32 v[168:169], v[168:169], v[40:41]
v_pk_fma_f32 v[170:171], v[40:41], v[40:41], v[170:171]
v_pk_add_f32 v[168:169], v[168:169], v[42:43]
v_pk_fma_f32 v[170:171], v[42:43], v[42:43], v[170:171]
v_pk_add_f32 v[168:169], v[168:169], v[44:45]
v_pk_fma_f32 v[170:171], v[44:45], v[44:45], v[170:171]
v_pk_add_f32 v[168:169], v[168:169], v[46:47]
v_pk_fma_f32 v[170:171], v[46:47], v[46:47], v[170:171]
s_setprio 0
v_add_u32 v174, -36864, v242
v_subrev_u32 v175, 66560, v174
v_min_u32 v174, v174, v175
v_add_u32 v174, 90112, v174
v_sub_u32 v175, v174, v242
v_add_u32 v242, v175, v242
v_add_u32_e64 v243, v175, v243
v_add_u32 v244, v175, v244
s_setprio 2
v_cvt_pkrtz_f16_f32 v137, v120, v121
v_cvt_pkrtz_f16_f32 v139, v122, v123
v_cvt_pkrtz_f16_f32 v141, v124, v125
v_cvt_pkrtz_f16_f32 v143, v126, v127
v_cvt_pkrtz_f16_f32 v145, v128, v129
v_cvt_pk_f16_f32 v155, v130, v131
v_cvt_pk_f16_f32 v152, v132, v133
v_cvt_pk_f16_f32 v149, v134, v135
ds_read_b128 v[228:231], v249 offset:17408
v_mfma_f32_32x32x16_bf16 v[120:135], v[72:75], v[232:235], 0
v_pk_fma_f16 v154, v155, v155, s48
v_add_f32 v168, v168, v169
v_and_b32 v137, s49, v137
v_pk_fma_f16 v151, v152, v152, s48
v_and_b32_e64 v139, s49, v139
v_pk_fma_f16 v148, v149, v149, s48
v_add_f32_e64 v170, v170, v171
v_pk_mul_f16 v154, v155, v154
v_bfe_u32 v136, v137, 2, 14
v_pk_mul_f16 v151, v152, v151
v_pk_mul_f16 v148, v149, v148
v_bfe_u32 v138, v139, 2, 14
ds_read_b128 v[232:235], v249 offset:18432
ds_read_u16_d16 v136, v136
ds_read_u16_d16 v138, v138
v_mfma_f32_32x32x16_bf16 v[120:135], v[76:79], v[236:239], v[120:135]
v_permlane32_swap_b32 v168, v170
v_exp_f16 v153, v154
v_lshrrev_b32 v137, 18, v137
v_exp_f16 v150, v151
v_add_f32 v168, v168, v170
v_lshrrev_b32 v139, 18, v139
v_exp_f16 v147, v148
v_and_b32 v141, s49, v141
v_and_b32_e64 v143, s49, v143
v_mul_f32 v168, 1009429163, v168
ds_read_b128 v[236:239], v249 offset:21504
ds_read_u16_d16_hi v137, v137
ds_read_u16_d16_hi v139, v139
v_mfma_f32_32x32x16_bf16 v[120:135], v[80:83], v[216:219], v[120:135]
v_exp_f16_sdwa v153, v154 dst_sel:WORD_1 dst_unused:UNUSED_PRESERVE src0_sel:WORD_1
v_bfe_u32 v140, v141, 2, 14
v_exp_f16_sdwa v150, v151 dst_sel:WORD_1 dst_unused:UNUSED_PRESERVE src0_sel:WORD_1
v_mov_b32_e64 v170, v168
v_bfe_u32 v142, v143, 2, 14
v_exp_f16_sdwa v147, v148 dst_sel:WORD_1 dst_unused:UNUSED_PRESERVE src0_sel:WORD_1
v_lshrrev_b32_e64 v141, 18, v141
v_permlane32_swap_b32 v168, v170
v_pk_add_f16 v153, v153, 1.0 op_sel_hi:[1,0]
s_waitcnt lgkmcnt(8)
ds_read_b128 v[216:219], v249 offset:19456
ds_read_u16_d16 v140, v140
ds_read_u16_d16 v142, v142
ds_read_u16_d16_hi v141, v141
v_mfma_f32_32x32x16_bf16 v[120:135], v[84:87], v[220:223], v[120:135]
v_lshrrev_b32_e64 v143, 18, v143
v_pk_add_f16 v150, v150, 1.0 op_sel_hi:[1,0]
v_pk_add_f16 v147, v147, 1.0 op_sel_hi:[1,0]
v_and_b32_e64 v145, s49, v145
v_fma_f32 v170, -v168, v168, v170
v_rcp_f16_e64 v154, v153
v_bfe_u32 v144, v145, 2, 14
v_rcp_f16 v151, v150
v_max_f32 v170, 0, v170
v_lshrrev_b32_e64 v145, 18, v145
ds_read_b128 v[220:223], v249 offset:22528
ds_read_u16_d16_hi v143, v143
ds_read_u16_d16 v144, v144
ds_read_u16_d16_hi v145, v145
v_mfma_f32_32x32x16_bf16 v[120:135], v[88:91], v[224:227], v[120:135]
v_rcp_f16 v148, v147
v_rcp_f16_sdwa v154, v153 dst_sel:WORD_1 dst_unused:UNUSED_PRESERVE src0_sel:WORD_1
v_add_f32 v170, 925353388, v170
s_waitcnt lgkmcnt(8)
v_fma_mix_f32 v165, v136, v136, v165 op_sel:[0,0,0] op_sel_hi:[1,1,0]
ds_read_b32 v247, v253 offset:16
v_fma_mix_f32 v165, v137, v137, v165 op_sel:[1,1,0] op_sel_hi:[1,1,0]
v_rcp_f16_sdwa v151, v150 dst_sel:WORD_1 dst_unused:UNUSED_PRESERVE src0_sel:WORD_1
v_rsq_f32_e64 v170, v170
v_fma_mix_f32 v165, v138, v138, v165 op_sel:[0,0,0] op_sel_hi:[1,1,0]
ds_read_b128 v[224:227], v249 offset:20480
v_mfma_f32_32x32x16_bf16 v[120:135], v[92:95], v[228:231], v[120:135]
v_rcp_f16_sdwa v148, v147 dst_sel:WORD_1 dst_unused:UNUSED_PRESERVE src0_sel:WORD_1
v_fma_mix_f32 v165, v139, v139, v165 op_sel:[1,1,0] op_sel_hi:[1,1,0]
v_pk_mul_f16 v155, v155, v154
s_waitcnt lgkmcnt(6)
v_fma_mix_f32 v165, v140, v140, v165 op_sel:[0,0,0] op_sel_hi:[1,1,0]
v_pk_mul_f16 v152, v152, v151
v_fma_mix_f32 v165, v141, v141, v165 op_sel:[1,1,0] op_sel_hi:[1,1,0]
v_pk_mul_f16 v149, v149, v148
v_fma_mix_f32 v165, v155, v155, v165 op_sel:[0,0,0] op_sel_hi:[1,1,0]
v_mul_f32 v172, 3203391086, v170
v_fma_mix_f32 v165, v142, v142, v165 op_sel:[0,0,0] op_sel_hi:[1,1,0]
v_fma_mix_f32 v165, v155, v155, v165 op_sel:[1,1,0] op_sel_hi:[1,1,0]
s_waitcnt lgkmcnt(2)
v_fma_mix_f32 v165, v143, v143, v165 op_sel:[1,1,0] op_sel_hi:[1,1,0]
v_fma_mix_f32 v165, v152, v152, v165 op_sel:[0,0,0] op_sel_hi:[1,1,0]
v_fma_mix_f32 v165, v152, v152, v165 op_sel:[1,1,0] op_sel_hi:[1,1,0]
v_mul_f32 v173, v168, v172
v_fma_mix_f32 v165, v144, v144, v165 op_sel:[0,0,0] op_sel_hi:[1,1,0]
v_fma_mix_f32 v165, v149, v149, v165 op_sel:[0,0,0] op_sel_hi:[1,1,0]
v_fma_mix_f32 v165, v145, v145, v165 op_sel:[1,1,0] op_sel_hi:[1,1,0]
v_fma_mix_f32 v165, v149, v149, v165 op_sel:[1,1,0] op_sel_hi:[1,1,0]
s_setprio 3
v_pk_fma_f32 v[0:1], v[0:1], v[172:173], v[172:173] op_sel:[0,0,1] op_sel_hi:[1,0,1] neg_lo:[0,0,1] neg_hi:[0,0,1]
v_pk_fma_f32 v[2:3], v[2:3], v[172:173], v[172:173] op_sel:[0,0,1] op_sel_hi:[1,0,1] neg_lo:[0,0,1] neg_hi:[0,0,1]
v_pk_fma_f32 v[4:5], v[4:5], v[172:173], v[172:173] op_sel:[0,0,1] op_sel_hi:[1,0,1] neg_lo:[0,0,1] neg_hi:[0,0,1]
v_pk_fma_f32 v[6:7], v[6:7], v[172:173], v[172:173] op_sel:[0,0,1] op_sel_hi:[1,0,1] neg_lo:[0,0,1] neg_hi:[0,0,1]
v_pk_fma_f32 v[8:9], v[8:9], v[172:173], v[172:173] op_sel:[0,0,1] op_sel_hi:[1,0,1] neg_lo:[0,0,1] neg_hi:[0,0,1]
v_pk_fma_f32 v[10:11], v[10:11], v[172:173], v[172:173] op_sel:[0,0,1] op_sel_hi:[1,0,1] neg_lo:[0,0,1] neg_hi:[0,0,1]
v_pk_fma_f32 v[12:13], v[12:13], v[172:173], v[172:173] op_sel:[0,0,1] op_sel_hi:[1,0,1] neg_lo:[0,0,1] neg_hi:[0,0,1]
v_pk_fma_f32 v[14:15], v[14:15], v[172:173], v[172:173] op_sel:[0,0,1] op_sel_hi:[1,0,1] neg_lo:[0,0,1] neg_hi:[0,0,1]
v_pk_fma_f32 v[16:17], v[16:17], v[172:173], v[172:173] op_sel:[0,0,1] op_sel_hi:[1,0,1] neg_lo:[0,0,1] neg_hi:[0,0,1]
v_pk_fma_f32 v[18:19], v[18:19], v[172:173], v[172:173] op_sel:[0,0,1] op_sel_hi:[1,0,1] neg_lo:[0,0,1] neg_hi:[0,0,1]
v_pk_fma_f32 v[20:21], v[20:21], v[172:173], v[172:173] op_sel:[0,0,1] op_sel_hi:[1,0,1] neg_lo:[0,0,1] neg_hi:[0,0,1]
v_pk_fma_f32 v[22:23], v[22:23], v[172:173], v[172:173] op_sel:[0,0,1] op_sel_hi:[1,0,1] neg_lo:[0,0,1] neg_hi:[0,0,1]
v_pk_fma_f32 v[24:25], v[24:25], v[172:173], v[172:173] op_sel:[0,0,1] op_sel_hi:[1,0,1] neg_lo:[0,0,1] neg_hi:[0,0,1]
v_pk_fma_f32 v[26:27], v[26:27], v[172:173], v[172:173] op_sel:[0,0,1] op_sel_hi:[1,0,1] neg_lo:[0,0,1] neg_hi:[0,0,1]
v_pk_fma_f32 v[28:29], v[28:29], v[172:173], v[172:173] op_sel:[0,0,1] op_sel_hi:[1,0,1] neg_lo:[0,0,1] neg_hi:[0,0,1]
v_pk_fma_f32 v[30:31], v[30:31], v[172:173], v[172:173] op_sel:[0,0,1] op_sel_hi:[1,0,1] neg_lo:[0,0,1] neg_hi:[0,0,1]
v_pk_fma_f32 v[32:33], v[32:33], v[172:173], v[172:173] op_sel:[0,0,1] op_sel_hi:[1,0,1] neg_lo:[0,0,1] neg_hi:[0,0,1]
v_pk_fma_f32 v[34:35], v[34:35], v[172:173], v[172:173] op_sel:[0,0,1] op_sel_hi:[1,0,1] neg_lo:[0,0,1] neg_hi:[0,0,1]
v_pk_fma_f32 v[36:37], v[36:37], v[172:173], v[172:173] op_sel:[0,0,1] op_sel_hi:[1,0,1] neg_lo:[0,0,1] neg_hi:[0,0,1]
v_pk_fma_f32 v[38:39], v[38:39], v[172:173], v[172:173] op_sel:[0,0,1] op_sel_hi:[1,0,1] neg_lo:[0,0,1] neg_hi:[0,0,1]
v_pk_fma_f32 v[40:41], v[40:41], v[172:173], v[172:173] op_sel:[0,0,1] op_sel_hi:[1,0,1] neg_lo:[0,0,1] neg_hi:[0,0,1]
v_pk_fma_f32 v[42:43], v[42:43], v[172:173], v[172:173] op_sel:[0,0,1] op_sel_hi:[1,0,1] neg_lo:[0,0,1] neg_hi:[0,0,1]
v_pk_fma_f32 v[44:45], v[44:45], v[172:173], v[172:173] op_sel:[0,0,1] op_sel_hi:[1,0,1] neg_lo:[0,0,1] neg_hi:[0,0,1]
v_pk_fma_f32 v[46:47], v[46:47], v[172:173], v[172:173] op_sel:[0,0,1] op_sel_hi:[1,0,1] neg_lo:[0,0,1] neg_hi:[0,0,1]
s_setprio 2
s_waitcnt lgkmcnt(0)
v_readfirstlane_b32 s43, v247
s_nop 1
s_cmp_ge_u32 s43, 24
s_cbranch_scc1 Lev6
Lev6w:
s_sleep 1
ds_read_b32 v247, v253 offset:16
s_waitcnt lgkmcnt(0)
v_readfirstlane_b32 s43, v247
s_cmp_eq_u32 s76, 0
s_cbranch_scc1 Lev6
s_sub_u32 s76, s76, 1
s_cmp_lt_u32 s43, 24
s_cbranch_scc1 Lev6w
Lev6:
s_setprio 1
v_cvt_pkrtz_f16_f32 v137, v120, v121
v_cvt_pkrtz_f16_f32 v139, v122, v123
v_cvt_pkrtz_f16_f32 v141, v124, v125
v_cvt_pkrtz_f16_f32 v143, v126, v127
v_cvt_pkrtz_f16_f32 v145, v128, v129
v_cvt_pk_f16_f32 v155, v130, v131
v_cvt_pk_f16_f32 v152, v132, v133
v_cvt_pk_f16_f32 v149, v134, v135
s_add_u32 m0, s67, 39936
s_add_u32 s66, s66, 98304
buffer_load_dwordx4 v240, s[4:7], s66 offen lds
ds_read_b128 v[228:231], v249 offset:23552
v_mfma_f32_32x32x16_bf16 v[120:135], v[72:75], v[232:235], 0
v_pk_fma_f16 v154, v155, v155, s48
v_cvt_pk_bf16_f32 v96, v0, v1
v_and_b32 v137, s49, v137
v_pk_fma_f16 v151, v152, v152, s48
v_cvt_pk_bf16_f32 v97, v2, v3
v_and_b32_e64 v139, s49, v139
v_pk_fma_f16 v148, v149, v149, s48
v_pk_mul_f16 v154, v155, v154
v_cvt_pk_bf16_f32 v98, v4, v5
v_bfe_u32 v136, v137, 2, 14
v_pk_mul_f16 v151, v152, v151
v_pk_mul_f16 v148, v149, v148
v_cvt_pk_bf16_f32 v99, v6, v7
v_bfe_u32 v138, v139, 2, 14
s_add_u32 m0, s67, 46592
s_add_u32 s66, s66, 98304
buffer_load_dwordx4 v240, s[4:7], s66 offen lds
ds_read_b128 v[232:235], v248 offset:16384
ds_read_u16_d16 v136, v136
ds_read_u16_d16 v138, v138
v_mfma_f32_32x32x16_bf16 v[120:135], v[76:79], v[236:239], v[120:135]
v_exp_f16_e64 v153, v154
v_cvt_pk_bf16_f32 v100, v8, v9
v_lshrrev_b32 v137, 18, v137
v_exp_f16 v150, v151
v_cvt_pk_bf16_f32 v101, v10, v11
v_lshrrev_b32 v139, 18, v139
v_exp_f16 v147, v148
v_cvt_pk_bf16_f32 v102, v12, v13
v_and_b32 v141, s49, v141
v_and_b32 v143, s49, v143
v_cvt_pk_bf16_f32 v103, v14, v15
s_add_u32 m0, s67, 53248
s_add_u32 s66, s66, 98304
buffer_load_dwordx4 v240, s[4:7], s66 offen lds
ds_read_b128 v[236:239], v248 offset:19456
ds_read_u16_d16_hi v137, v137
ds_read_u16_d16_hi v139, v139
v_mfma_f32_32x32x16_bf16 v[120:135], v[80:83], v[216:219], v[120:135]
v_exp_f16_sdwa v153, v154 dst_sel:WORD_1 dst_unused:UNUSED_PRESERVE src0_sel:WORD_1
v_bfe_u32 v140, v141, 2, 14
v_cvt_pk_bf16_f32 v104, v16, v17
v_exp_f16_sdwa v150, v151 dst_sel:WORD_1 dst_unused:UNUSED_PRESERVE src0_sel:WORD_1
v_bfe_u32 v142, v143, 2, 14
v_cvt_pk_bf16_f32 v105, v18, v19
v_exp_f16_sdwa v147, v148 dst_sel:WORD_1 dst_unused:UNUSED_PRESERVE src0_sel:WORD_1
v_cvt_pk_bf16_f32 v106, v20, v21
v_lshrrev_b32_e64 v141, 18, v141
v_pk_add_f16 v153, v153, 1.0 op_sel_hi:[1,0]
v_lshrrev_b32 v143, 18, v143
s_add_u32 m0, s67, 59904
s_add_u32 s66, s66, 98304
buffer_load_dwordx4 v240, s[4:7], s66 offen lds
s_add_u32 m0, s67, 0
s_add_u32 s66, s66, 98304
buffer_load_dwordx4 v240, s[4:7], s66 offen lds
ds_read_b128 v[216:219], v248 offset:17408
ds_read_u16_d16 v140, v140
ds_read_u16_d16 v142, v142
ds_read_u16_d16_hi v141, v141
ds_read_u16_d16_hi v143, v143
v_mfma_f32_32x32x16_bf16 v[120:135], v[84:87], v[220:223], v[120:135]
v_cvt_pk_bf16_f32 v107, v22, v23
v_pk_add_f16 v150, v150, 1.0 op_sel_hi:[1,0]
v_pk_add_f16 v147, v147, 1.0 op_sel_hi:[1,0]
v_and_b32_e64 v145, s49, v145
v_cvt_pk_bf16_f32 v108, v24, v25
v_rcp_f16_e64 v154, v153
v_bfe_u32 v144, v145, 2, 14
v_cvt_pk_bf16_f32 v109, v26, v27
v_rcp_f16 v151, v150
v_lshrrev_b32 v145, 18, v145
v_cvt_pk_bf16_f32 v110, v28, v29
s_add_u32 m0, s67, 6656
s_add_u32 s66, s66, 98304
buffer_load_dwordx4 v240, s[4:7], s66 offen lds
ds_read_b128 v[220:223], v248 offset:20480
ds_read_u16_d16 v144, v144
ds_read_u16_d16_hi v145, v145
v_mfma_f32_32x32x16_bf16 v[120:135], v[88:91], v[224:227], v[120:135]
v_rcp_f16_e64 v148, v147
v_cvt_pk_bf16_f32 v111, v30, v31
v_rcp_f16_sdwa v154, v153 dst_sel:WORD_1 dst_unused:UNUSED_PRESERVE src0_sel:WORD_1
s_waitcnt lgkmcnt(5)
v_fma_mix_f32 v166, v136, v136, v166 op_sel:[0,0,0] op_sel_hi:[1,1,0]
v_cvt_pk_bf16_f32 v112, v32, v33
s_setprio 0
v_fma_mix_f32 v166, v137, v137, v166 op_sel:[1,1,0] op_sel_hi:[1,1,0]
v_rcp_f16_sdwa v151, v150 dst_sel:WORD_1 dst_unused:UNUSED_PRESERVE src0_sel:WORD_1
v_cvt_pk_bf16_f32 v113, v34, v35
v_fma_mix_f32 v166, v138, v138, v166 op_sel:[0,0,0] op_sel_hi:[1,1,0]
v_rcp_f16_sdwa v148, v147 dst_sel:WORD_1 dst_unused:UNUSED_PRESERVE src0_sel:WORD_1
v_cvt_pk_bf16_f32 v114, v36, v37
s_add_u32 m0, s67, 13312
s_add_u32 s66, s66, 98304
buffer_load_dwordx4 v240, s[4:7], s66 offen lds
ds_read_b128 v[224:227], v248 offset:18432
v_mfma_f32_32x32x16_bf16 v[120:135], v[92:95], v[228:231], v[120:135]
v_fma_mix_f32 v166, v139, v139, v166 op_sel:[1,1,0] op_sel_hi:[1,1,0]
v_pk_mul_f16 v155, v155, v154
v_fma_mix_f32 v166, v140, v140, v166 op_sel:[0,0,0] op_sel_hi:[1,1,0]
v_cvt_pk_bf16_f32 v115, v38, v39
v_pk_mul_f16 v152, v152, v151
s_waitcnt lgkmcnt(1)
v_fma_mix_f32 v166, v141, v141, v166 op_sel:[1,1,0] op_sel_hi:[1,1,0]
v_cvt_pk_bf16_f32 v116, v40, v41
v_pk_mul_f16 v149, v149, v148
v_fma_mix_f32 v166, v155, v155, v166 op_sel:[0,0,0] op_sel_hi:[1,1,0]
v_fma_mix_f32 v166, v142, v142, v166 op_sel:[0,0,0] op_sel_hi:[1,1,0]
v_cvt_pk_bf16_f32 v117, v42, v43
v_fma_mix_f32 v166, v155, v155, v166 op_sel:[1,1,0] op_sel_hi:[1,1,0]
v_fma_mix_f32 v166, v143, v143, v166 op_sel:[1,1,0] op_sel_hi:[1,1,0]
v_fma_mix_f32 v166, v152, v152, v166 op_sel:[0,0,0] op_sel_hi:[1,1,0]
s_add_u32 m0, s67, 19968
s_add_u32 s66, s66, 98304
buffer_load_dwordx4 v240, s[4:7], s66 offen lds
v_cvt_pk_bf16_f32 v118, v44, v45
v_fma_mix_f32 v166, v152, v152, v166 op_sel:[1,1,0] op_sel_hi:[1,1,0]
v_fma_mix_f32 v166, v144, v144, v166 op_sel:[0,0,0] op_sel_hi:[1,1,0]
v_fma_mix_f32 v166, v149, v149, v166 op_sel:[0,0,0] op_sel_hi:[1,1,0]
v_cvt_pk_bf16_f32 v119, v46, v47
v_fma_mix_f32 v166, v145, v145, v166 op_sel:[1,1,0] op_sel_hi:[1,1,0]
v_fma_mix_f32 v166, v149, v149, v166 op_sel:[1,1,0] op_sel_hi:[1,1,0]
s_setprio 2
v_cvt_pkrtz_f16_f32 v137, v120, v121
v_cvt_pkrtz_f16_f32 v139, v122, v123
v_cvt_pkrtz_f16_f32 v141, v124, v125
v_cvt_pkrtz_f16_f32 v143, v126, v127
v_cvt_pkrtz_f16_f32 v145, v128, v129
v_cvt_pk_f16_f32 v155, v130, v131
v_cvt_pk_f16_f32 v152, v132, v133
v_cvt_pk_f16_f32 v149, v134, v135
s_add_u32 s46, s80, 12582912
buffer_store_dwordx4 v[72:75], v241, s[32:35], s46 offen sc1
ds_read_b128 v[228:231], v248 offset:21504
v_mfma_f32_32x32x16_bf16 v[120:135], v[96:99], v[232:235], 0
v_pk_fma_f16 v154, v155, v155, s48
v_and_b32_e64 v137, s49, v137
v_pk_fma_f16 v151, v152, v152, s48
v_and_b32_e64 v139, s49, v139
v_pk_fma_f16 v148, v149, v149, s48
v_pk_mul_f16 v154, v155, v154
v_bfe_u32 v136, v137, 2, 14
v_pk_mul_f16 v151, v152, v151
v_pk_mul_f16 v148, v149, v148
v_bfe_u32 v138, v139, 2, 14
ds_read_b128 v[232:235], v248 offset:22528
ds_read_u16_d16 v136, v136
ds_read_u16_d16 v138, v138
v_mfma_f32_32x32x16_bf16 v[120:135], v[100:103], v[236:239], v[120:135]
v_exp_f16 v153, v154
v_lshrrev_b32 v137, 18, v137
v_exp_f16 v150, v151
v_lshrrev_b32 v139, 18, v139
v_exp_f16 v147, v148
v_and_b32 v141, s49, v141
v_and_b32_e64 v143, s49, v143
ds_read_b128 v[236:239], v248 offset:25600
ds_read_u16_d16_hi v137, v137
ds_read_u16_d16_hi v139, v139
v_mfma_f32_32x32x16_bf16 v[120:135], v[104:107], v[216:219], v[120:135]
v_exp_f16_sdwa v153, v154 dst_sel:WORD_1 dst_unused:UNUSED_PRESERVE src0_sel:WORD_1
v_bfe_u32 v140, v141, 2, 14
v_exp_f16_sdwa v150, v151 dst_sel:WORD_1 dst_unused:UNUSED_PRESERVE src0_sel:WORD_1
v_bfe_u32 v142, v143, 2, 14
v_exp_f16_sdwa v147, v148 dst_sel:WORD_1 dst_unused:UNUSED_PRESERVE src0_sel:WORD_1
v_lshrrev_b32_e64 v141, 18, v141
v_pk_add_f16 v153, v153, 1.0 op_sel_hi:[1,0]
ds_read_b128 v[216:219], v248 offset:23552
ds_read_u16_d16 v140, v140
ds_read_u16_d16 v142, v142
ds_read_u16_d16_hi v141, v141
v_mfma_f32_32x32x16_bf16 v[120:135], v[108:111], v[220:223], v[120:135]
v_lshrrev_b32_e64 v143, 18, v143
v_pk_add_f16 v150, v150, 1.0 op_sel_hi:[1,0]
v_pk_add_f16 v147, v147, 1.0 op_sel_hi:[1,0]
v_and_b32 v145, s49, v145
v_rcp_f16 v154, v153
v_bfe_u32 v144, v145, 2, 14
v_rcp_f16_e64 v151, v150
v_lshrrev_b32 v145, 18, v145
s_waitcnt lgkmcnt(7)
ds_read_b128 v[220:223], v248 offset:26624
ds_read_u16_d16_hi v143, v143
ds_read_u16_d16 v144, v144
ds_read_u16_d16_hi v145, v145
v_mfma_f32_32x32x16_bf16 v[120:135], v[112:115], v[224:227], v[120:135]
v_rcp_f16_e64 v148, v147
v_rcp_f16_sdwa v154, v153 dst_sel:WORD_1 dst_unused:UNUSED_PRESERVE src0_sel:WORD_1
v_fma_mix_f32 v167, v136, v136, v167 op_sel:[0,0,0] op_sel_hi:[1,1,0]
s_waitcnt lgkmcnt(8)
v_fma_mix_f32 v167, v137, v137, v167 op_sel:[1,1,0] op_sel_hi:[1,1,0]
v_rcp_f16_sdwa v151, v150 dst_sel:WORD_1 dst_unused:UNUSED_PRESERVE src0_sel:WORD_1
v_fma_mix_f32 v167, v138, v138, v167 op_sel:[0,0,0] op_sel_hi:[1,1,0]
ds_read_b128 v[224:227], v248 offset:24576
v_mfma_f32_32x32x16_bf16 v[120:135], v[116:119], v[228:231], v[120:135]
v_rcp_f16_sdwa v148, v147 dst_sel:WORD_1 dst_unused:UNUSED_PRESERVE src0_sel:WORD_1
v_fma_mix_f32 v167, v139, v139, v167 op_sel:[1,1,0] op_sel_hi:[1,1,0]
v_pk_mul_f16 v155, v155, v154
s_waitcnt lgkmcnt(5)
v_fma_mix_f32 v167, v140, v140, v167 op_sel:[0,0,0] op_sel_hi:[1,1,0]
v_pk_mul_f16 v152, v152, v151
v_fma_mix_f32 v167, v141, v141, v167 op_sel:[1,1,0] op_sel_hi:[1,1,0]
v_pk_mul_f16 v149, v149, v148
v_fma_mix_f32 v167, v155, v155, v167 op_sel:[0,0,0] op_sel_hi:[1,1,0]
v_fma_mix_f32 v167, v142, v142, v167 op_sel:[0,0,0] op_sel_hi:[1,1,0]
v_fma_mix_f32 v167, v155, v155, v167 op_sel:[1,1,0] op_sel_hi:[1,1,0]
s_waitcnt lgkmcnt(3)
v_fma_mix_f32 v167, v143, v143, v167 op_sel:[1,1,0] op_sel_hi:[1,1,0]
v_fma_mix_f32 v167, v152, v152, v167 op_sel:[0,0,0] op_sel_hi:[1,1,0]
v_fma_mix_f32 v167, v152, v152, v167 op_sel:[1,1,0] op_sel_hi:[1,1,0]
s_waitcnt lgkmcnt(1)
v_fma_mix_f32 v167, v144, v144, v167 op_sel:[0,0,0] op_sel_hi:[1,1,0]
v_fma_mix_f32 v167, v149, v149, v167 op_sel:[0,0,0] op_sel_hi:[1,1,0]
v_fma_mix_f32 v167, v145, v145, v167 op_sel:[1,1,0] op_sel_hi:[1,1,0]
v_fma_mix_f32 v167, v149, v149, v167 op_sel:[1,1,0] op_sel_hi:[1,1,0]
s_cmp_lg_u32 s40, 7
s_cbranch_scc1 Lnoinit
s_waitcnt vmcnt(12)
v_mov_b32_e64 v255, 1
s_mov_b64 exec, 1
buffer_atomic_add v255, v241, s[36:39], 0 offen
s_mov_b64 exec, -1
Lnoinit:
s_setprio 1
v_cvt_pkrtz_f16_f32 v137, v120, v121
v_cvt_pkrtz_f16_f32 v139, v122, v123
v_cvt_pkrtz_f16_f32 v141, v124, v125
v_cvt_pkrtz_f16_f32 v143, v126, v127
v_cvt_pkrtz_f16_f32 v145, v128, v129
v_cvt_pk_f16_f32 v155, v130, v131
v_cvt_pk_f16_f32 v152, v132, v133
v_cvt_pk_f16_f32 v149, v134, v135
s_add_u32 s46, s80, 14680064
buffer_store_dwordx4 v[76:79], v241, s[32:35], s46 offen sc1
ds_read_b128 v[228:231], v248 offset:27648
v_mfma_f32_32x32x16_bf16 v[120:135], v[96:99], v[232:235], 0
v_pk_fma_f16 v154, v155, v155, s48
v_and_b32_e64 v137, s49, v137
v_pk_fma_f16 v151, v152, v152, s48
v_and_b32_e64 v139, s49, v139
v_pk_fma_f16 v148, v149, v149, s48
v_pk_mul_f16 v154, v155, v154
v_bfe_u32 v136, v137, 2, 14
v_pk_mul_f16 v151, v152, v151
v_pk_mul_f16 v148, v149, v148
v_bfe_u32 v138, v139, 2, 14
ds_read_b128 v[232:235], v248 offset:28672
ds_read_u16_d16 v136, v136
ds_read_u16_d16 v138, v138
v_mfma_f32_32x32x16_bf16 v[120:135], v[100:103], v[236:239], v[120:135]
v_exp_f16 v153, v154
v_lshrrev_b32 v137, 18, v137
v_exp_f16 v150, v151
v_lshrrev_b32 v139, 18, v139
v_exp_f16 v147, v148
v_and_b32 v141, s49, v141
v_and_b32_e64 v143, s49, v143
ds_read_b128 v[236:239], v248 offset:31744
ds_read_u16_d16_hi v137, v137
ds_read_u16_d16_hi v139, v139
v_mfma_f32_32x32x16_bf16 v[120:135], v[104:107], v[216:219], v[120:135]
v_exp_f16_sdwa v153, v154 dst_sel:WORD_1 dst_unused:UNUSED_PRESERVE src0_sel:WORD_1
v_bfe_u32 v140, v141, 2, 14
v_exp_f16_sdwa v150, v151 dst_sel:WORD_1 dst_unused:UNUSED_PRESERVE src0_sel:WORD_1
v_bfe_u32 v142, v143, 2, 14
v_exp_f16_sdwa v147, v148 dst_sel:WORD_1 dst_unused:UNUSED_PRESERVE src0_sel:WORD_1
v_lshrrev_b32_e64 v141, 18, v141
v_pk_add_f16 v153, v153, 1.0 op_sel_hi:[1,0]
ds_read_b128 v[216:219], v248 offset:29696
ds_read_u16_d16 v140, v140
ds_read_u16_d16 v142, v142
ds_read_u16_d16_hi v141, v141
v_mfma_f32_32x32x16_bf16 v[120:135], v[108:111], v[220:223], v[120:135]
v_lshrrev_b32_e64 v143, 18, v143
v_pk_add_f16 v150, v150, 1.0 op_sel_hi:[1,0]
v_pk_add_f16 v147, v147, 1.0 op_sel_hi:[1,0]
v_and_b32 v145, s49, v145
v_rcp_f16 v154, v153
v_bfe_u32 v144, v145, 2, 14
v_rcp_f16_e64 v151, v150
v_lshrrev_b32 v145, 18, v145
s_waitcnt lgkmcnt(7)
ds_read_b128 v[220:223], v248 offset:32768
ds_read_u16_d16_hi v143, v143
ds_read_u16_d16 v144, v144
ds_read_u16_d16_hi v145, v145
v_mfma_f32_32x32x16_bf16 v[120:135], v[112:115], v[224:227], v[120:135]
v_rcp_f16_e64 v148, v147
v_rcp_f16_sdwa v154, v153 dst_sel:WORD_1 dst_unused:UNUSED_PRESERVE src0_sel:WORD_1
v_fma_mix_f32 v156, v136, v136, v156 op_sel:[0,0,0] op_sel_hi:[1,1,0]
s_setprio 0
s_waitcnt lgkmcnt(8)
v_fma_mix_f32 v156, v137, v137, v156 op_sel:[1,1,0] op_sel_hi:[1,1,0]
v_rcp_f16_sdwa v151, v150 dst_sel:WORD_1 dst_unused:UNUSED_PRESERVE src0_sel:WORD_1
v_fma_mix_f32 v156, v138, v138, v156 op_sel:[0,0,0] op_sel_hi:[1,1,0]
ds_read_b128 v[224:227], v248 offset:30720
v_mfma_f32_32x32x16_bf16 v[120:135], v[116:119], v[228:231], v[120:135]
v_rcp_f16_sdwa v148, v147 dst_sel:WORD_1 dst_unused:UNUSED_PRESERVE src0_sel:WORD_1
v_fma_mix_f32 v156, v139, v139, v156 op_sel:[1,1,0] op_sel_hi:[1,1,0]
v_pk_mul_f16 v155, v155, v154
s_cmp_eq_u32 s40, 7
s_cbranch_scc1 Lrdy24
s_waitcnt vmcnt(2)
Lrdy24:
s_mov_b64 exec, 1
ds_add_u32 v253, v254 offset:12
s_mov_b64 exec, -1
s_waitcnt lgkmcnt(6)
v_fma_mix_f32 v156, v140, v140, v156 op_sel:[0,0,0] op_sel_hi:[1,1,0]
v_pk_mul_f16 v152, v152, v151
v_fma_mix_f32 v156, v141, v141, v156 op_sel:[1,1,0] op_sel_hi:[1,1,0]
v_pk_mul_f16 v149, v149, v148
v_fma_mix_f32 v156, v155, v155, v156 op_sel:[0,0,0] op_sel_hi:[1,1,0]
v_fma_mix_f32 v156, v142, v142, v156 op_sel:[0,0,0] op_sel_hi:[1,1,0]
v_fma_mix_f32 v156, v155, v155, v156 op_sel:[1,1,0] op_sel_hi:[1,1,0]
s_waitcnt lgkmcnt(2)
v_fma_mix_f32 v156, v143, v143, v156 op_sel:[1,1,0] op_sel_hi:[1,1,0]
v_fma_mix_f32 v156, v152, v152, v156 op_sel:[0,0,0] op_sel_hi:[1,1,0]
v_fma_mix_f32 v156, v152, v152, v156 op_sel:[1,1,0] op_sel_hi:[1,1,0]
v_fma_mix_f32 v156, v144, v144, v156 op_sel:[0,0,0] op_sel_hi:[1,1,0]
v_fma_mix_f32 v156, v149, v149, v156 op_sel:[0,0,0] op_sel_hi:[1,1,0]
v_fma_mix_f32 v156, v145, v145, v156 op_sel:[1,1,0] op_sel_hi:[1,1,0]
v_fma_mix_f32 v156, v149, v149, v156 op_sel:[1,1,0] op_sel_hi:[1,1,0]
s_setprio 2
v_cvt_pkrtz_f16_f32 v137, v120, v121
v_cvt_pkrtz_f16_f32 v139, v122, v123
v_cvt_pkrtz_f16_f32 v141, v124, v125
v_cvt_pkrtz_f16_f32 v143, v126, v127
v_cvt_pkrtz_f16_f32 v145, v128, v129
v_cvt_pk_f16_f32 v155, v130, v131
v_cvt_pk_f16_f32 v152, v132, v133
v_cvt_pk_f16_f32 v149, v134, v135
s_add_u32 s46, s80, 16777216
buffer_store_dwordx4 v[80:83], v241, s[32:35], s46 offen sc1
ds_read_b128 v[228:231], v248 offset:33792
v_mfma_f32_32x32x16_bf16 v[120:135], v[96:99], v[232:235], 0
v_pk_fma_f16 v154, v155, v155, s48
v_and_b32_e64 v137, s49, v137
v_pk_fma_f16 v151, v152, v152, s48
v_and_b32_e64 v139, s49, v139
v_pk_fma_f16 v148, v149, v149, s48
v_pk_mul_f16 v154, v155, v154
v_bfe_u32 v136, v137, 2, 14
v_pk_mul_f16 v151, v152, v151
v_pk_mul_f16 v148, v149, v148
v_bfe_u32 v138, v139, 2, 14
ds_read_b128 v[232:235], v250 offset:65520
ds_read_u16_d16 v136, v136
ds_read_u16_d16 v138, v138
v_mfma_f32_32x32x16_bf16 v[120:135], v[100:103], v[236:239], v[120:135]
v_exp_f16 v153, v154
v_lshrrev_b32 v137, 18, v137
v_exp_f16 v150, v151
v_lshrrev_b32 v139, 18, v139
v_exp_f16 v147, v148
v_and_b32 v141, s49, v141
v_and_b32_e64 v143, s49, v143
ds_read_b128 v[236:239], v248 offset:34816
ds_read_u16_d16_hi v137, v137
ds_read_b32 v247, v253 offset:12
ds_read_u16_d16_hi v139, v139
v_mfma_f32_32x32x16_bf16 v[120:135], v[104:107], v[216:219], v[120:135]
v_exp_f16_sdwa v153, v154 dst_sel:WORD_1 dst_unused:UNUSED_PRESERVE src0_sel:WORD_1
v_bfe_u32 v140, v141, 2, 14
v_exp_f16_sdwa v150, v151 dst_sel:WORD_1 dst_unused:UNUSED_PRESERVE src0_sel:WORD_1
v_bfe_u32 v142, v143, 2, 14
v_exp_f16_sdwa v147, v148 dst_sel:WORD_1 dst_unused:UNUSED_PRESERVE src0_sel:WORD_1
v_lshrrev_b32_e64 v141, 18, v141
v_pk_add_f16 v153, v153, 1.0 op_sel_hi:[1,0]
ds_read_b128 v[216:219], v248 offset:37888
ds_read_u16_d16 v140, v140
ds_read_u16_d16 v142, v142
ds_read_u16_d16_hi v141, v141
v_mfma_f32_32x32x16_bf16 v[120:135], v[108:111], v[220:223], v[120:135]
v_lshrrev_b32_e64 v143, 18, v143
v_pk_add_f16 v150, v150, 1.0 op_sel_hi:[1,0]
v_pk_add_f16 v147, v147, 1.0 op_sel_hi:[1,0]
v_and_b32 v145, s49, v145
v_rcp_f16 v154, v153
v_bfe_u32 v144, v145, 2, 14
v_rcp_f16_e64 v151, v150
ds_read_u16_d16_hi v143, v143
ds_read_u16_d16 v144, v144
s_waitcnt lgkmcnt(7)
v_readfirstlane_b32 s43, v247
s_nop 1
s_cmp_ge_u32 s43, 32
s_cbranch_scc1 Lev7
Lev7w:
s_sleep 1
ds_read_b32 v247, v253 offset:12
s_waitcnt lgkmcnt(0)
v_readfirstlane_b32 s43, v247
s_cmp_eq_u32 s76, 0
s_cbranch_scc1 Lev7
s_sub_u32 s76, s76, 1
s_cmp_lt_u32 s43, 32
s_cbranch_scc1 Lev7w
Lev7:
v_lshrrev_b32 v145, 18, v145
ds_read_b128 v[220:223], v248 offset:35840
ds_read_u16_d16_hi v145, v145
v_mfma_f32_32x32x16_bf16 v[120:135], v[112:115], v[224:227], v[120:135]
v_rcp_f16 v148, v147
v_rcp_f16_sdwa v154, v153 dst_sel:WORD_1 dst_unused:UNUSED_PRESERVE src0_sel:WORD_1
v_fma_mix_f32 v157, v136, v136, v157 op_sel:[0,0,0] op_sel_hi:[1,1,0]
v_fma_mix_f32 v157, v137, v137, v157 op_sel:[1,1,0] op_sel_hi:[1,1,0]
v_rcp_f16_sdwa v151, v150 dst_sel:WORD_1 dst_unused:UNUSED_PRESERVE src0_sel:WORD_1
v_fma_mix_f32 v157, v138, v138, v157 op_sel:[0,0,0] op_sel_hi:[1,1,0]
ds_read_b128 v[224:227], v245 offset:6528
ds_read_b128 v[192:195], v244 offset:128
ds_read_b128 v[196:199], v244 offset:64
v_mfma_f32_32x32x16_bf16 v[120:135], v[116:119], v[228:231], v[120:135]
v_rcp_f16_sdwa v148, v147 dst_sel:WORD_1 dst_unused:UNUSED_PRESERVE src0_sel:WORD_1
s_waitcnt lgkmcnt(5)
v_fma_mix_f32 v157, v139, v139, v157 op_sel:[1,1,0] op_sel_hi:[1,1,0]
v_pk_mul_f16 v155, v155, v154
v_fma_mix_f32 v157, v140, v140, v157 op_sel:[0,0,0] op_sel_hi:[1,1,0]
v_pk_mul_f16 v152, v152, v151
v_fma_mix_f32 v157, v141, v141, v157 op_sel:[1,1,0] op_sel_hi:[1,1,0]
v_pk_mul_f16 v149, v149, v148
v_fma_mix_f32 v157, v155, v155, v157 op_sel:[0,0,0] op_sel_hi:[1,1,0]
v_fma_mix_f32 v157, v142, v142, v157 op_sel:[0,0,0] op_sel_hi:[1,1,0]
v_fma_mix_f32 v157, v155, v155, v157 op_sel:[1,1,0] op_sel_hi:[1,1,0]
v_fma_mix_f32 v157, v143, v143, v157 op_sel:[1,1,0] op_sel_hi:[1,1,0]
v_fma_mix_f32 v157, v152, v152, v157 op_sel:[0,0,0] op_sel_hi:[1,1,0]
v_fma_mix_f32 v157, v152, v152, v157 op_sel:[1,1,0] op_sel_hi:[1,1,0]
v_fma_mix_f32 v157, v144, v144, v157 op_sel:[0,0,0] op_sel_hi:[1,1,0]
v_fma_mix_f32 v157, v149, v149, v157 op_sel:[0,0,0] op_sel_hi:[1,1,0]
s_waitcnt lgkmcnt(3)
v_fma_mix_f32 v157, v145, v145, v157 op_sel:[1,1,0] op_sel_hi:[1,1,0]
v_fma_mix_f32 v157, v149, v149, v157 op_sel:[1,1,0] op_sel_hi:[1,1,0]
s_setprio 1
v_mfma_f32_32x32x16_bf16 v[0:15], v[232:235], v[232:235], 0
s_add_u32 s46, s80, 18874368
buffer_store_dwordx4 v[84:87], v241, s[32:35], s46 offen sc1
ds_read_b128 v[228:231], v248 offset:38912
v_cvt_pkrtz_f16_f32 v137, v120, v121
v_cvt_pkrtz_f16_f32 v139, v122, v123
v_cvt_pkrtz_f16_f32 v141, v124, v125
v_cvt_pkrtz_f16_f32 v143, v126, v127
v_mfma_f32_32x32x16_bf16 v[16:31], v[232:235], v[232:235], 0
v_cvt_pk_f16_f32 v155, v128, v129
v_cvt_pk_f16_f32 v152, v130, v131
v_cvt_pk_f16_f32 v149, v132, v133
v_cvt_pk_f16_f32 v146, v134, v135
v_mfma_f32_32x32x16_bf16 v[32:47], v[232:235], v[232:235], 0
v_pk_fma_f16 v154, v155, v155, s48
v_and_b32_e64 v137, s49, v137
v_pk_fma_f16 v151, v152, v152, s48
v_pk_fma_f16 v148, v149, v149, s48
v_mfma_f32_32x32x16_bf16 v[120:135], v[96:99], v[236:239], 0
ds_read_b128 v[232:235], v248 offset:36864
v_and_b32_e64 v139, s49, v139
v_pk_fma_f16 v145, v146, v146, s48
v_pk_mul_f16 v154, v155, v154
v_bfe_u32 v136, v137, 2, 14
v_pk_mul_f16 v151, v152, v151
v_pk_mul_f16 v148, v149, v148
v_bfe_u32 v138, v139, 2, 14
v_pk_mul_f16 v145, v146, v145
v_mfma_f32_32x32x16_bf16 v[120:135], v[100:103], v[216:219], v[120:135]
ds_read_b128 v[236:239], v245 offset:6144
ds_read_b128 v[200:203], v244
ds_read_b128 v[204:207], v243 offset:128
ds_read_u16_d16 v136, v136
ds_read_u16_d16 v138, v138
v_exp_f16 v153, v154
v_lshrrev_b32 v137, 18, v137
v_exp_f16 v150, v151
v_lshrrev_b32 v139, 18, v139
v_exp_f16_e64 v147, v148
v_mfma_f32_32x32x16_bf16 v[120:135], v[104:107], v[220:223], v[120:135]
ds_read_b128 v[216:219], v248 offset:39936
ds_read_u16_d16_hi v137, v137
ds_read_u16_d16_hi v139, v139
v_and_b32 v141, s49, v141
v_exp_f16 v144, v145
v_and_b32 v143, s49, v143
v_exp_f16_sdwa v153, v154 dst_sel:WORD_1 dst_unused:UNUSED_PRESERVE src0_sel:WORD_1
v_bfe_u32 v140, v141, 2, 14
s_waitcnt lgkmcnt(8)
v_smfmac_f32_16x16x32_bf16 v[40:43], v[226:227], v[192:195], v246
ds_read_b128 v[220:223], v245 offset:5760
ds_read_b128 v[208:211], v243 offset:64
ds_read_b128 v[212:215], v243
ds_read_u16_d16 v140, v140
v_exp_f16_sdwa v150, v151 dst_sel:WORD_1 dst_unused:UNUSED_PRESERVE src0_sel:WORD_1
v_bfe_u32 v142, v143, 2, 14
v_exp_f16_sdwa v147, v148 dst_sel:WORD_1 dst_unused:UNUSED_PRESERVE src0_sel:WORD_1
v_smfmac_f32_16x16x32_bf16 v[24:27], v[224:225], v[196:199], v246
v_lshrrev_b32_e64 v141, 18, v141
v_exp_f16_sdwa v144, v145 dst_sel:WORD_1 dst_unused:UNUSED_PRESERVE src0_sel:WORD_1
v_lshrrev_b32_e64 v143, 18, v143
v_mfma_f32_32x32x16_bf16 v[120:135], v[108:111], v[228:231], v[120:135]
ds_read_b128 v[224:227], v245 offset:5376
ds_read_b128 v[192:195], v242 offset:128
ds_read_b128 v[196:199], v242 offset:64
ds_read_u16_d16 v142, v142
ds_read_u16_d16_hi v141, v141
ds_read_u16_d16_hi v143, v143
v_pk_add_f16 v153, v153, 1.0 op_sel_hi:[1,0]
v_pk_add_f16 v150, v150, 1.0 op_sel_hi:[1,0]
v_pk_add_f16 v147, v147, 1.0 op_sel_hi:[1,0]
v_pk_add_f16 v144, v144, 1.0 op_sel_hi:[1,0]
v_rcp_f16 v154, v153
v_rcp_f16 v151, v150
v_mfma_f32_32x32x16_bf16 v[120:135], v[112:115], v[232:235], v[120:135]
ds_read_b128 v[228:231], v248 offset:40960
v_rcp_f16 v148, v147
v_rcp_f16 v145, v144
v_rcp_f16_sdwa v154, v153 dst_sel:WORD_1 dst_unused:UNUSED_PRESERVE src0_sel:WORD_1
v_rcp_f16_sdwa v151, v150 dst_sel:WORD_1 dst_unused:UNUSED_PRESERVE src0_sel:WORD_1
s_setprio 0
s_waitcnt lgkmcnt(7)
v_smfmac_f32_16x16x32_bf16 v[8:11], v[238:239], v[200:203], v246
ds_read_b128 v[232:235], v248 offset:44032
v_rcp_f16_sdwa v148, v147 dst_sel:WORD_1 dst_unused:UNUSED_PRESERVE src0_sel:WORD_1
v_fma_mix_f32 v158, v136, v136, v158 op_sel:[0,0,0] op_sel_hi:[1,1,0]
v_smfmac_f32_16x16x32_bf16 v[40:43], v[236:237], v[204:207], v246
v_rcp_f16_sdwa v145, v144 dst_sel:WORD_1 dst_unused:UNUSED_PRESERVE src0_sel:WORD_1
v_fma_mix_f32 v158, v137, v137, v158 op_sel:[1,1,0] op_sel_hi:[1,1,0]
v_pk_mul_f16 v155, v155, v154
v_fma_mix_f32 v158, v138, v138, v158 op_sel:[0,0,0] op_sel_hi:[1,1,0]
v_mfma_f32_32x32x16_bf16 v[120:135], v[116:119], v[216:219], v[120:135]
ds_read_b128 v[236:239], v248 offset:41984
v_pk_mul_f16 v152, v152, v151
v_pk_mul_f16 v149, v149, v148
v_fma_mix_f32 v158, v139, v139, v158 op_sel:[1,1,0] op_sel_hi:[1,1,0]
v_pk_mul_f16 v146, v146, v145
v_fma_mix_f32 v158, v155, v155, v158 op_sel:[0,0,0] op_sel_hi:[1,1,0]
v_fma_mix_f32 v158, v140, v140, v158 op_sel:[0,0,0] op_sel_hi:[1,1,0]
v_fma_mix_f32 v158, v155, v155, v158 op_sel:[1,1,0] op_sel_hi:[1,1,0]
v_fma_mix_f32 v158, v152, v152, v158 op_sel:[0,0,0] op_sel_hi:[1,1,0]
v_smfmac_f32_16x16x32_bf16 v[24:27], v[222:223], v[208:211], v246
ds_read_b128 v[216:219], v248 offset:45056
s_waitcnt lgkmcnt(3)
v_fma_mix_f32 v158, v141, v141, v158 op_sel:[1,1,0] op_sel_hi:[1,1,0]
v_fma_mix_f32 v158, v152, v152, v158 op_sel:[1,1,0] op_sel_hi:[1,1,0]
v_fma_mix_f32 v158, v149, v149, v158 op_sel:[0,0,0] op_sel_hi:[1,1,0]
v_fma_mix_f32 v158, v142, v142, v158 op_sel:[0,0,0] op_sel_hi:[1,1,0]
v_smfmac_f32_16x16x32_bf16 v[8:11], v[220:221], v[212:215], v246
v_fma_mix_f32 v158, v149, v149, v158 op_sel:[1,1,0] op_sel_hi:[1,1,0]
v_fma_mix_f32 v158, v146, v146, v158 op_sel:[0,0,0] op_sel_hi:[1,1,0]
v_fma_mix_f32 v158, v143, v143, v158 op_sel:[1,1,0] op_sel_hi:[1,1,0]
v_fma_mix_f32 v158, v146, v146, v158 op_sel:[1,1,0] op_sel_hi:[1,1,0]
s_setprio 2
v_smfmac_f32_16x16x32_bf16 v[40:43], v[226:227], v[192:195], v246
s_add_u32 s46, s80, 20971520
buffer_store_dwordx4 v[88:91], v241, s[32:35], s46 offen sc1
ds_read_b128 v[220:223], v248 offset:43008
v_cvt_pkrtz_f16_f32 v137, v120, v121
v_cvt_pkrtz_f16_f32 v139, v122, v123
v_cvt_pkrtz_f16_f32 v141, v124, v125
v_cvt_pkrtz_f16_f32 v143, v126, v127
v_smfmac_f32_16x16x32_bf16 v[24:27], v[224:225], v[196:199], v246
v_cvt_pkrtz_f16_f32 v145, v128, v129
v_cvt_pk_f16_f32 v155, v130, v131
v_cvt_pk_f16_f32 v152, v132, v133
v_cvt_pk_f16_f32 v149, v134, v135
v_mfma_f32_32x32x16_bf16 v[120:135], v[96:99], v[228:231], 0
ds_read_b128 v[224:227], v245 offset:4992
ds_read_b128 v[200:203], v242
v_xor_b32 v244, 16, v244
ds_read_b128 v[204:207], v244 offset:128
v_pk_fma_f16 v154, v155, v155, s48
v_and_b32 v137, s49, v137
v_pk_fma_f16 v151, v152, v152, s48
v_and_b32 v139, s49, v139
v_pk_fma_f16 v148, v149, v149, s48
v_pk_mul_f16 v154, v155, v154
v_bfe_u32 v136, v137, 2, 14
v_pk_mul_f16 v151, v152, v151
s_waitcnt lgkmcnt(4)
v_mfma_f32_32x32x16_bf16 v[120:135], v[100:103], v[232:235], v[120:135]
ds_read_b128 v[228:231], v248 offset:46080
ds_read_u16_d16 v136, v136
v_pk_mul_f16 v148, v149, v148
v_bfe_u32 v138, v139, 2, 14
v_exp_f16 v153, v154
v_lshrrev_b32 v137, 18, v137
v_exp_f16 v150, v151
v_lshrrev_b32 v139, 18, v139
v_mfma_f32_32x32x16_bf16 v[120:135], v[104:107], v[236:239], v[120:135]
ds_read_b128 v[232:235], v245 offset:4608
ds_read_b128 v[208:211], v244 offset:64
ds_read_b128 v[212:215], v244
ds_read_u16_d16 v138, v138
ds_read_u16_d16_hi v137, v137
ds_read_u16_d16_hi v139, v139
v_exp_f16 v147, v148
v_and_b32 v141, s49, v141
v_and_b32 v143, s49, v143
v_exp_f16_sdwa v153, v154 dst_sel:WORD_1 dst_unused:UNUSED_PRESERVE src0_sel:WORD_1
v_bfe_u32 v140, v141, 2, 14
v_exp_f16_sdwa v150, v151 dst_sel:WORD_1 dst_unused:UNUSED_PRESERVE src0_sel:WORD_1
v_mfma_f32_32x32x16_bf16 v[120:135], v[108:111], v[216:219], v[120:135]
ds_read_b128 v[236:239], v245 offset:4224
v_xor_b32 v243, 16, v243
ds_read_b128 v[192:195], v243 offset:128
ds_read_b128 v[196:199], v243 offset:64
ds_read_u16_d16 v140, v140
v_bfe_u32 v142, v143, 2, 14
v_exp_f16_sdwa v147, v148 dst_sel:WORD_1 dst_unused:UNUSED_PRESERVE src0_sel:WORD_1
v_lshrrev_b32_e64 v141, 18, v141
v_pk_add_f16 v153, v153, 1.0 op_sel_hi:[1,0]
v_lshrrev_b32 v143, 18, v143
v_pk_add_f16 v150, v150, 1.0 op_sel_hi:[1,0]
v_pk_add_f16 v147, v147, 1.0 op_sel_hi:[1,0]
s_waitcnt lgkmcnt(9)
v_mfma_f32_32x32x16_bf16 v[120:135], v[112:115], v[220:223], v[120:135]
ds_read_b128 v[216:219], v248 offset:47104
ds_read_u16_d16 v142, v142
ds_read_u16_d16_hi v141, v141
ds_read_u16_d16_hi v143, v143
v_and_b32 v145, s49, v145
v_rcp_f16 v154, v153
v_bfe_u32 v144, v145, 2, 14
v_rcp_f16 v151, v150
v_lshrrev_b32 v145, 18, v145
v_rcp_f16_e64 v148, v147
v_smfmac_f32_16x16x32_bf16 v[8:11], v[226:227], v[200:203], v246
ds_read_b128 v[220:223], v248 offset:50176
ds_read_u16_d16 v144, v144
ds_read_u16_d16_hi v145, v145
v_rcp_f16_sdwa v154, v153 dst_sel:WORD_1 dst_unused:UNUSED_PRESERVE src0_sel:WORD_1
v_fma_mix_f32 v159, v136, v136, v159 op_sel:[0,0,0] op_sel_hi:[1,1,0]
s_waitcnt lgkmcnt(7)
v_fma_mix_f32 v159, v137, v137, v159 op_sel:[1,1,0] op_sel_hi:[1,1,0]
v_smfmac_f32_16x16x32_bf16 v[44:47], v[224:225], v[204:207], v246
v_rcp_f16_sdwa v151, v150 dst_sel:WORD_1 dst_unused:UNUSED_PRESERVE src0_sel:WORD_1
v_fma_mix_f32 v159, v138, v138, v159 op_sel:[0,0,0] op_sel_hi:[1,1,0]
v_mfma_f32_32x32x16_bf16 v[120:135], v[116:119], v[228:231], v[120:135]
ds_read_b128 v[224:227], v248 offset:48128
v_rcp_f16_sdwa v148, v147 dst_sel:WORD_1 dst_unused:UNUSED_PRESERVE src0_sel:WORD_1
v_fma_mix_f32 v159, v139, v139, v159 op_sel:[1,1,0] op_sel_hi:[1,1,0]
v_pk_mul_f16 v155, v155, v154
v_fma_mix_f32 v159, v140, v140, v159 op_sel:[0,0,0] op_sel_hi:[1,1,0]
v_pk_mul_f16 v152, v152, v151
s_waitcnt lgkmcnt(4)
v_fma_mix_f32 v159, v141, v141, v159 op_sel:[1,1,0] op_sel_hi:[1,1,0]
v_pk_mul_f16 v149, v149, v148
v_fma_mix_f32 v159, v155, v155, v159 op_sel:[0,0,0] op_sel_hi:[1,1,0]
v_smfmac_f32_16x16x32_bf16 v[28:31], v[234:235], v[208:211], v246
ds_read_b128 v[228:231], v248 offset:51200
v_fma_mix_f32 v159, v142, v142, v159 op_sel:[0,0,0] op_sel_hi:[1,1,0]
v_fma_mix_f32 v159, v155, v155, v159 op_sel:[1,1,0] op_sel_hi:[1,1,0]
v_fma_mix_f32 v159, v143, v143, v159 op_sel:[1,1,0] op_sel_hi:[1,1,0]
v_fma_mix_f32 v159, v152, v152, v159 op_sel:[0,0,0] op_sel_hi:[1,1,0]
v_smfmac_f32_16x16x32_bf16 v[12:15], v[232:233], v[212:215], v246
v_fma_mix_f32 v159, v152, v152, v159 op_sel:[1,1,0] op_sel_hi:[1,1,0]
s_waitcnt lgkmcnt(2)
v_fma_mix_f32 v159, v144, v144, v159 op_sel:[0,0,0] op_sel_hi:[1,1,0]
v_fma_mix_f32 v159, v149, v149, v159 op_sel:[0,0,0] op_sel_hi:[1,1,0]
v_fma_mix_f32 v159, v145, v145, v159 op_sel:[1,1,0] op_sel_hi:[1,1,0]
v_fma_mix_f32 v159, v149, v149, v159 op_sel:[1,1,0] op_sel_hi:[1,1,0]
s_setprio 1
v_smfmac_f32_16x16x32_bf16 v[44:47], v[238:239], v[192:195], v246
s_add_u32 s46, s80, 23068672
buffer_store_dwordx4 v[92:95], v241, s[32:35], s46 offen sc1
ds_read_b128 v[232:235], v248 offset:49152
v_cvt_pkrtz_f16_f32 v137, v120, v121
v_cvt_pkrtz_f16_f32 v139, v122, v123
v_cvt_pkrtz_f16_f32 v141, v124, v125
v_cvt_pkrtz_f16_f32 v143, v126, v127
v_cvt_pk_f16_f32 v155, v128, v129
v_smfmac_f32_16x16x32_bf16 v[28:31], v[236:237], v[196:199], v246
v_cvt_pk_f16_f32 v152, v130, v131
v_cvt_pk_f16_f32 v149, v132, v133
v_cvt_pk_f16_f32 v146, v134, v135
v_pk_fma_f16 v154, v155, v155, s48
v_and_b32_e64 v137, s49, v137
v_mfma_f32_32x32x16_bf16 v[120:135], v[96:99], v[216:219], 0
ds_read_b128 v[236:239], v248 offset:52224
v_pk_fma_f16 v151, v152, v152, s48
v_pk_fma_f16 v148, v149, v149, s48
v_and_b32_e64 v139, s49, v139
v_pk_fma_f16 v145, v146, v146, s48
v_pk_mul_f16 v154, v155, v154
v_bfe_u32 v136, v137, 2, 14
v_pk_mul_f16 v151, v152, v151
v_pk_mul_f16 v148, v149, v148
v_bfe_u32 v138, v139, 2, 14
v_pk_mul_f16 v145, v146, v145
v_mfma_f32_32x32x16_bf16 v[120:135], v[100:103], v[220:223], v[120:135]
ds_read_b128 v[216:219], v245 offset:3840
ds_read_b128 v[200:203], v243
v_xor_b32 v242, 16, v242
ds_read_b128 v[204:207], v242 offset:128
ds_read_u16_d16 v136, v136
ds_read_u16_d16 v138, v138
v_exp_f16 v153, v154
v_lshrrev_b32 v137, 18, v137
v_exp_f16 v150, v151
v_lshrrev_b32 v139, 18, v139
v_exp_f16 v147, v148
v_and_b32_e64 v141, s49, v141
v_exp_f16 v144, v145
s_waitcnt lgkmcnt(5)
v_mfma_f32_32x32x16_bf16 v[120:135], v[104:107], v[224:227], v[120:135]
ds_read_b128 v[220:223], v245 offset:3456
ds_read_b128 v[208:211], v242 offset:64
ds_read_b128 v[212:215], v242
ds_read_u16_d16_hi v137, v137
ds_read_u16_d16_hi v139, v139
v_and_b32_e64 v143, s49, v143
v_exp_f16_sdwa v153, v154 dst_sel:WORD_1 dst_unused:UNUSED_PRESERVE src0_sel:WORD_1
v_bfe_u32 v140, v141, 2, 14
v_exp_f16_sdwa v150, v151 dst_sel:WORD_1 dst_unused:UNUSED_PRESERVE src0_sel:WORD_1
v_bfe_u32 v142, v143, 2, 14
v_exp_f16_sdwa v147, v148 dst_sel:WORD_1 dst_unused:UNUSED_PRESERVE src0_sel:WORD_1
v_lshrrev_b32_e64 v141, 18, v141
v_mfma_f32_32x32x16_bf16 v[120:135], v[108:111], v[228:231], v[120:135]
ds_read_b128 v[224:227], v248 offset:53248
ds_read_u16_d16 v140, v140
ds_read_u16_d16 v142, v142
ds_read_u16_d16_hi v141, v141
v_exp_f16_sdwa v144, v145 dst_sel:WORD_1 dst_unused:UNUSED_PRESERVE src0_sel:WORD_1
v_lshrrev_b32_e64 v143, 18, v143
v_pk_add_f16 v153, v153, 1.0 op_sel_hi:[1,0]
v_pk_add_f16 v150, v150, 1.0 op_sel_hi:[1,0]
v_pk_add_f16 v147, v147, 1.0 op_sel_hi:[1,0]
v_pk_add_f16 v144, v144, 1.0 op_sel_hi:[1,0]
v_rcp_f16 v154, v153
v_rcp_f16 v151, v150
v_mfma_f32_32x32x16_bf16 v[120:135], v[112:115], v[232:235], v[120:135]
ds_read_b128 v[228:231], v248 offset:56320
ds_read_u16_d16_hi v143, v143
v_rcp_f16_e64 v148, v147
v_rcp_f16 v145, v144
v_rcp_f16_sdwa v154, v153 dst_sel:WORD_1 dst_unused:UNUSED_PRESERVE src0_sel:WORD_1
v_rcp_f16_sdwa v151, v150 dst_sel:WORD_1 dst_unused:UNUSED_PRESERVE src0_sel:WORD_1
s_setprio 0
v_rcp_f16_sdwa v148, v147 dst_sel:WORD_1 dst_unused:UNUSED_PRESERVE src0_sel:WORD_1
s_waitcnt lgkmcnt(6)
v_fma_mix_f32 v160, v136, v136, v160 op_sel:[0,0,0] op_sel_hi:[1,1,0]
v_mfma_f32_32x32x16_bf16 v[120:135], v[116:119], v[236:239], v[120:135]
ds_read_b128 v[232:235], v248 offset:54272
v_rcp_f16_sdwa v145, v144 dst_sel:WORD_1 dst_unused:UNUSED_PRESERVE src0_sel:WORD_1
v_fma_mix_f32 v160, v137, v137, v160 op_sel:[1,1,0] op_sel_hi:[1,1,0]
v_pk_mul_f16 v155, v155, v154
v_fma_mix_f32 v160, v138, v138, v160 op_sel:[0,0,0] op_sel_hi:[1,1,0]
v_pk_mul_f16 v152, v152, v151
v_pk_mul_f16 v149, v149, v148
v_fma_mix_f32 v160, v139, v139, v160 op_sel:[1,1,0] op_sel_hi:[1,1,0]
v_pk_mul_f16 v146, v146, v145
v_fma_mix_f32 v160, v155, v155, v160 op_sel:[0,0,0] op_sel_hi:[1,1,0]
v_smfmac_f32_16x16x32_bf16 v[12:15], v[218:219], v[200:203], v246
ds_read_b128 v[236:239], v248 offset:57344
s_waitcnt lgkmcnt(4)
v_fma_mix_f32 v160, v140, v140, v160 op_sel:[0,0,0] op_sel_hi:[1,1,0]
v_fma_mix_f32 v160, v155, v155, v160 op_sel:[1,1,0] op_sel_hi:[1,1,0]
v_fma_mix_f32 v160, v152, v152, v160 op_sel:[0,0,0] op_sel_hi:[1,1,0]
v_fma_mix_f32 v160, v141, v141, v160 op_sel:[1,1,0] op_sel_hi:[1,1,0]
v_fma_mix_f32 v160, v152, v152, v160 op_sel:[1,1,0] op_sel_hi:[1,1,0]
v_smfmac_f32_16x16x32_bf16 v[44:47], v[216:217], v[204:207], v246
v_fma_mix_f32 v160, v149, v149, v160 op_sel:[0,0,0] op_sel_hi:[1,1,0]
v_fma_mix_f32 v160, v142, v142, v160 op_sel:[0,0,0] op_sel_hi:[1,1,0]
v_fma_mix_f32 v160, v149, v149, v160 op_sel:[1,1,0] op_sel_hi:[1,1,0]
v_fma_mix_f32 v160, v146, v146, v160 op_sel:[0,0,0] op_sel_hi:[1,1,0]
s_waitcnt lgkmcnt(2)
v_fma_mix_f32 v160, v143, v143, v160 op_sel:[1,1,0] op_sel_hi:[1,1,0]
v_fma_mix_f32 v160, v146, v146, v160 op_sel:[1,1,0] op_sel_hi:[1,1,0]
s_setprio 2
v_smfmac_f32_16x16x32_bf16 v[28:31], v[222:223], v[208:211], v246
ds_read_b128 v[216:219], v248 offset:55296
v_cvt_pkrtz_f16_f32 v137, v120, v121
v_cvt_pkrtz_f16_f32 v139, v122, v123
v_cvt_pkrtz_f16_f32 v141, v124, v125
v_cvt_pkrtz_f16_f32 v143, v126, v127
v_smfmac_f32_16x16x32_bf16 v[12:15], v[220:221], v[212:215], v246
v_cvt_pkrtz_f16_f32 v145, v128, v129
v_cvt_pk_f16_f32 v155, v130, v131
v_cvt_pk_f16_f32 v152, v132, v133
v_cvt_pk_f16_f32 v149, v134, v135
v_mfma_f32_32x32x16_bf16 v[120:135], v[96:99], v[224:227], 0
ds_read_b128 v[220:223], v245 offset:3072
v_xor_b32 v244, 32, v244
ds_read_b128 v[192:195], v244 offset:128
ds_read_b128 v[196:199], v244 offset:64
v_pk_fma_f16 v154, v155, v155, s48
v_and_b32 v137, s49, v137
v_pk_fma_f16 v151, v152, v152, s48
v_and_b32_e64 v139, s49, v139
v_pk_fma_f16 v148, v149, v149, s48
v_pk_mul_f16 v154, v155, v154
v_bfe_u32 v136, v137, 2, 14
v_pk_mul_f16 v151, v152, v151
v_mfma_f32_32x32x16_bf16 v[120:135], v[100:103], v[228:231], v[120:135]
ds_read_b128 v[224:227], v248 offset:58368
ds_read_u16_d16 v136, v136
v_pk_mul_f16 v148, v149, v148
v_bfe_u32 v138, v139, 2, 14
v_exp_f16 v153, v154
v_lshrrev_b32 v137, 18, v137
v_exp_f16 v150, v151
v_lshrrev_b32 v139, 18, v139
s_waitcnt lgkmcnt(5)
v_mfma_f32_32x32x16_bf16 v[120:135], v[104:107], v[232:235], v[120:135]
ds_read_b128 v[228:231], v245 offset:2688
ds_read_b128 v[200:203], v244
v_xor_b32 v243, 32, v243
ds_read_b128 v[204:207], v243 offset:128
ds_read_u16_d16 v138, v138
ds_read_u16_d16_hi v137, v137
ds_read_u16_d16_hi v139, v139
v_exp_f16 v147, v148
v_and_b32 v141, s49, v141
v_and_b32_e64 v143, s49, v143
v_exp_f16_sdwa v153, v154 dst_sel:WORD_1 dst_unused:UNUSED_PRESERVE src0_sel:WORD_1
v_bfe_u32 v140, v141, 2, 14
v_exp_f16_sdwa v150, v151 dst_sel:WORD_1 dst_unused:UNUSED_PRESERVE src0_sel:WORD_1
v_mfma_f32_32x32x16_bf16 v[120:135], v[108:111], v[236:239], v[120:135]
ds_read_b128 v[232:235], v245 offset:2304
ds_read_b128 v[208:211], v243 offset:64
ds_read_b128 v[212:215], v243
ds_read_u16_d16 v140, v140
v_bfe_u32 v142, v143, 2, 14
v_exp_f16_sdwa v147, v148 dst_sel:WORD_1 dst_unused:UNUSED_PRESERVE src0_sel:WORD_1
v_lshrrev_b32_e64 v141, 18, v141
v_pk_add_f16 v153, v153, 1.0 op_sel_hi:[1,0]
v_lshrrev_b32_e64 v143, 18, v143
v_pk_add_f16 v150, v150, 1.0 op_sel_hi:[1,0]
v_pk_add_f16 v147, v147, 1.0 op_sel_hi:[1,0]
v_mfma_f32_32x32x16_bf16 v[120:135], v[112:115], v[216:219], v[120:135]
ds_read_b128 v[236:239], v248 offset:59392
ds_read_u16_d16 v142, v142
ds_read_u16_d16_hi v141, v141
ds_read_u16_d16_hi v143, v143
v_and_b32 v145, s49, v145
v_rcp_f16 v154, v153
v_bfe_u32 v144, v145, 2, 14
v_rcp_f16 v151, v150
v_lshrrev_b32 v145, 18, v145
v_rcp_f16 v148, v147
s_waitcnt lgkmcnt(8)
v_smfmac_f32_16x16x32_bf16 v[36:39], v[222:223], v[192:195], v246
ds_read_b128 v[216:219], v248 offset:62464
ds_read_u16_d16 v144, v144
ds_read_u16_d16_hi v145, v145
v_rcp_f16_sdwa v154, v153 dst_sel:WORD_1 dst_unused:UNUSED_PRESERVE src0_sel:WORD_1
v_fma_mix_f32 v161, v136, v136, v161 op_sel:[0,0,0] op_sel_hi:[1,1,0]
v_fma_mix_f32 v161, v137, v137, v161 op_sel:[1,1,0] op_sel_hi:[1,1,0]
v_smfmac_f32_16x16x32_bf16 v[20:23], v[220:221], v[196:199], v246
v_rcp_f16_sdwa v151, v150 dst_sel:WORD_1 dst_unused:UNUSED_PRESERVE src0_sel:WORD_1
v_fma_mix_f32 v161, v138, v138, v161 op_sel:[0,0,0] op_sel_hi:[1,1,0]
v_mfma_f32_32x32x16_bf16 v[120:135], v[116:119], v[224:227], v[120:135]
ds_read_b128 v[220:223], v248 offset:60416
v_rcp_f16_sdwa v148, v147 dst_sel:WORD_1 dst_unused:UNUSED_PRESERVE src0_sel:WORD_1
v_fma_mix_f32 v161, v139, v139, v161 op_sel:[1,1,0] op_sel_hi:[1,1,0]
v_pk_mul_f16 v155, v155, v154
s_waitcnt lgkmcnt(6)
v_fma_mix_f32 v161, v140, v140, v161 op_sel:[0,0,0] op_sel_hi:[1,1,0]
v_pk_mul_f16 v152, v152, v151
s_waitcnt lgkmcnt(4)
v_fma_mix_f32 v161, v141, v141, v161 op_sel:[1,1,0] op_sel_hi:[1,1,0]
v_pk_mul_f16 v149, v149, v148
v_fma_mix_f32 v161, v155, v155, v161 op_sel:[0,0,0] op_sel_hi:[1,1,0]
v_smfmac_f32_16x16x32_bf16 v[4:7], v[230:231], v[200:203], v246
ds_read_b128 v[224:227], v248 offset:63488
v_fma_mix_f32 v161, v142, v142, v161 op_sel:[0,0,0] op_sel_hi:[1,1,0]
v_fma_mix_f32 v161, v155, v155, v161 op_sel:[1,1,0] op_sel_hi:[1,1,0]
v_fma_mix_f32 v161, v143, v143, v161 op_sel:[1,1,0] op_sel_hi:[1,1,0]
v_fma_mix_f32 v161, v152, v152, v161 op_sel:[0,0,0] op_sel_hi:[1,1,0]
v_smfmac_f32_16x16x32_bf16 v[36:39], v[228:229], v[204:207], v246
v_fma_mix_f32 v161, v152, v152, v161 op_sel:[1,1,0] op_sel_hi:[1,1,0]
s_waitcnt lgkmcnt(2)
v_fma_mix_f32 v161, v144, v144, v161 op_sel:[0,0,0] op_sel_hi:[1,1,0]
v_fma_mix_f32 v161, v149, v149, v161 op_sel:[0,0,0] op_sel_hi:[1,1,0]
v_fma_mix_f32 v161, v145, v145, v161 op_sel:[1,1,0] op_sel_hi:[1,1,0]
v_fma_mix_f32 v161, v149, v149, v161 op_sel:[1,1,0] op_sel_hi:[1,1,0]
s_setprio 1
v_smfmac_f32_16x16x32_bf16 v[20:23], v[234:235], v[208:211], v246
ds_read_b128 v[228:231], v248 offset:61440
v_cvt_pkrtz_f16_f32 v137, v120, v121
v_cvt_pkrtz_f16_f32 v139, v122, v123
v_cvt_pkrtz_f16_f32 v141, v124, v125
v_cvt_pkrtz_f16_f32 v143, v126, v127
v_cvt_pk_f16_f32 v155, v128, v129
v_smfmac_f32_16x16x32_bf16 v[4:7], v[232:233], v[212:215], v246
v_cvt_pk_f16_f32 v152, v130, v131
v_cvt_pk_f16_f32 v149, v132, v133
v_cvt_pk_f16_f32 v146, v134, v135
v_pk_fma_f16 v154, v155, v155, s48
v_and_b32_e64 v137, s49, v137
v_mfma_f32_32x32x16_bf16 v[120:135], v[96:99], v[236:239], 0
ds_read_b128 v[232:235], v248 offset:64512
v_pk_fma_f16 v151, v152, v152, s48
v_pk_fma_f16 v148, v149, v149, s48
v_and_b32_e64 v139, s49, v139
v_pk_fma_f16 v145, v146, v146, s48
v_pk_mul_f16 v154, v155, v154
v_bfe_u32 v136, v137, 2, 14
v_pk_mul_f16 v151, v152, v151
v_pk_mul_f16 v148, v149, v148
v_bfe_u32 v138, v139, 2, 14
v_pk_mul_f16 v145, v146, v145
v_mfma_f32_32x32x16_bf16 v[120:135], v[100:103], v[216:219], v[120:135]
ds_read_b128 v[236:239], v245 offset:1920
v_xor_b32 v242, 32, v242
ds_read_b128 v[192:195], v242 offset:128
ds_read_b128 v[196:199], v242 offset:64
ds_read_u16_d16 v136, v136
ds_read_u16_d16 v138, v138
v_exp_f16 v153, v154
v_lshrrev_b32 v137, 18, v137
v_exp_f16 v150, v151
v_lshrrev_b32 v139, 18, v139
v_exp_f16 v147, v148
v_and_b32 v141, s49, v141
v_exp_f16 v144, v145
s_waitcnt lgkmcnt(5)
v_mfma_f32_32x32x16_bf16 v[120:135], v[104:107], v[220:223], v[120:135]
ds_read_b128 v[216:219], v245 offset:1536
ds_read_b128 v[200:203], v242
v_xor_b32 v244, 16, v244
ds_read_b128 v[204:207], v244 offset:128
ds_read_u16_d16_hi v137, v137
ds_read_u16_d16_hi v139, v139
v_and_b32_e64 v143, s49, v143
v_exp_f16_sdwa v153, v154 dst_sel:WORD_1 dst_unused:UNUSED_PRESERVE src0_sel:WORD_1
v_bfe_u32 v140, v141, 2, 14
v_exp_f16_sdwa v150, v151 dst_sel:WORD_1 dst_unused:UNUSED_PRESERVE src0_sel:WORD_1
v_bfe_u32 v142, v143, 2, 14
v_exp_f16_sdwa v147, v148 dst_sel:WORD_1 dst_unused:UNUSED_PRESERVE src0_sel:WORD_1
v_lshrrev_b32_e64 v141, 18, v141
v_mfma_f32_32x32x16_bf16 v[120:135], v[108:111], v[224:227], v[120:135]
ds_read_b128 v[220:223], v249
ds_read_u16_d16 v140, v140
ds_read_u16_d16 v142, v142
ds_read_u16_d16_hi v141, v141
v_exp_f16_sdwa v144, v145 dst_sel:WORD_1 dst_unused:UNUSED_PRESERVE src0_sel:WORD_1
v_lshrrev_b32_e64 v143, 18, v143
v_pk_add_f16 v153, v153, 1.0 op_sel_hi:[1,0]
v_pk_add_f16 v150, v150, 1.0 op_sel_hi:[1,0]
v_pk_add_f16 v147, v147, 1.0 op_sel_hi:[1,0]
v_pk_add_f16 v144, v144, 1.0 op_sel_hi:[1,0]
v_rcp_f16 v154, v153
v_rcp_f16 v151, v150
v_mfma_f32_32x32x16_bf16 v[120:135], v[112:115], v[228:231], v[120:135]
ds_read_b128 v[224:227], v249 offset:3072
ds_read_u16_d16_hi v143, v143
v_rcp_f16 v148, v147
v_rcp_f16 v145, v144
v_rcp_f16_sdwa v154, v153 dst_sel:WORD_1 dst_unused:UNUSED_PRESERVE src0_sel:WORD_1
v_rcp_f16_sdwa v151, v150 dst_sel:WORD_1 dst_unused:UNUSED_PRESERVE src0_sel:WORD_1
s_setprio 0
v_rcp_f16_sdwa v148, v147 dst_sel:WORD_1 dst_unused:UNUSED_PRESERVE src0_sel:WORD_1
s_waitcnt lgkmcnt(6)
v_fma_mix_f32 v162, v136, v136, v162 op_sel:[0,0,0] op_sel_hi:[1,1,0]
v_mfma_f32_32x32x16_bf16 v[120:135], v[116:119], v[232:235], v[120:135]
ds_read_b128 v[228:231], v249 offset:1024
v_rcp_f16_sdwa v145, v144 dst_sel:WORD_1 dst_unused:UNUSED_PRESERVE src0_sel:WORD_1
v_fma_mix_f32 v162, v137, v137, v162 op_sel:[1,1,0] op_sel_hi:[1,1,0]
v_pk_mul_f16 v155, v155, v154
v_fma_mix_f32 v162, v138, v138, v162 op_sel:[0,0,0] op_sel_hi:[1,1,0]
v_pk_mul_f16 v152, v152, v151
v_pk_mul_f16 v149, v149, v148
v_fma_mix_f32 v162, v139, v139, v162 op_sel:[1,1,0] op_sel_hi:[1,1,0]
v_pk_mul_f16 v146, v146, v145
v_fma_mix_f32 v162, v155, v155, v162 op_sel:[0,0,0] op_sel_hi:[1,1,0]
v_smfmac_f32_16x16x32_bf16 v[36:39], v[238:239], v[192:195], v246
ds_read_b128 v[232:235], v249 offset:4096
s_waitcnt lgkmcnt(4)
v_fma_mix_f32 v162, v140, v140, v162 op_sel:[0,0,0] op_sel_hi:[1,1,0]
v_fma_mix_f32 v162, v155, v155, v162 op_sel:[1,1,0] op_sel_hi:[1,1,0]
v_fma_mix_f32 v162, v152, v152, v162 op_sel:[0,0,0] op_sel_hi:[1,1,0]
v_fma_mix_f32 v162, v141, v141, v162 op_sel:[1,1,0] op_sel_hi:[1,1,0]
v_fma_mix_f32 v162, v152, v152, v162 op_sel:[1,1,0] op_sel_hi:[1,1,0]
v_smfmac_f32_16x16x32_bf16 v[20:23], v[236:237], v[196:199], v246
v_fma_mix_f32 v162, v149, v149, v162 op_sel:[0,0,0] op_sel_hi:[1,1,0]
v_fma_mix_f32 v162, v142, v142, v162 op_sel:[0,0,0] op_sel_hi:[1,1,0]
v_fma_mix_f32 v162, v149, v149, v162 op_sel:[1,1,0] op_sel_hi:[1,1,0]
v_fma_mix_f32 v162, v146, v146, v162 op_sel:[0,0,0] op_sel_hi:[1,1,0]
s_waitcnt lgkmcnt(2)
v_fma_mix_f32 v162, v143, v143, v162 op_sel:[1,1,0] op_sel_hi:[1,1,0]
v_fma_mix_f32 v162, v146, v146, v162 op_sel:[1,1,0] op_sel_hi:[1,1,0]
s_cmp_lg_u32 s40, 0
s_cbranch_scc1 Lrs0
v_mov_b32 v90, 0
buffer_load_dword v91, v90, s[36:39], 0 offen sc1
Lrs0:
s_setprio 2
v_smfmac_f32_16x16x32_bf16 v[4:7], v[218:219], v[200:203], v246
ds_read_b128 v[236:239], v249 offset:2048
v_cvt_pkrtz_f16_f32 v137, v120, v121
v_cvt_pkrtz_f16_f32 v139, v122, v123
v_cvt_pkrtz_f16_f32 v141, v124, v125
v_cvt_pkrtz_f16_f32 v143, v126, v127
v_smfmac_f32_16x16x32_bf16 v[32:35], v[216:217], v[204:207], v246
v_cvt_pkrtz_f16_f32 v145, v128, v129
v_cvt_pk_f16_f32 v155, v130, v131
v_cvt_pk_f16_f32 v152, v132, v133
v_cvt_pk_f16_f32 v149, v134, v135
v_mfma_f32_32x32x16_bf16 v[120:135], v[96:99], v[220:223], 0
ds_read_b128 v[216:219], v245 offset:1152
ds_read_b128 v[208:211], v244 offset:64
ds_read_b128 v[212:215], v244
v_pk_fma_f16 v154, v155, v155, s48
v_and_b32_e64 v137, s49, v137
v_pk_fma_f16 v151, v152, v152, s48
v_and_b32_e64 v139, s49, v139
v_pk_fma_f16 v148, v149, v149, s48
v_pk_mul_f16 v154, v155, v154
v_bfe_u32 v136, v137, 2, 14
v_pk_mul_f16 v151, v152, v151
v_mfma_f32_32x32x16_bf16 v[120:135], v[100:103], v[224:227], v[120:135]
ds_read_b128 v[220:223], v249 offset:5120
ds_read_u16_d16 v136, v136
v_pk_mul_f16 v148, v149, v148
v_bfe_u32 v138, v139, 2, 14
v_exp_f16 v153, v154
v_lshrrev_b32 v137, 18, v137
v_exp_f16 v150, v151
v_lshrrev_b32 v139, 18, v139
s_waitcnt lgkmcnt(5)
v_mfma_f32_32x32x16_bf16 v[120:135], v[104:107], v[228:231], v[120:135]
ds_read_b128 v[224:227], v245 offset:768
v_xor_b32 v243, 16, v243
ds_read_b128 v[192:195], v243 offset:128
ds_read_b128 v[196:199], v243 offset:64
ds_read_u16_d16 v138, v138
ds_read_u16_d16_hi v137, v137
ds_read_u16_d16_hi v139, v139
v_exp_f16 v147, v148
v_and_b32 v141, s49, v141
v_and_b32_e64 v143, s49, v143
v_exp_f16_sdwa v153, v154 dst_sel:WORD_1 dst_unused:UNUSED_PRESERVE src0_sel:WORD_1
v_bfe_u32 v140, v141, 2, 14
v_exp_f16_sdwa v150, v151 dst_sel:WORD_1 dst_unused:UNUSED_PRESERVE src0_sel:WORD_1
v_mfma_f32_32x32x16_bf16 v[120:135], v[108:111], v[232:235], v[120:135]
ds_read_b128 v[228:231], v245 offset:384
ds_read_b128 v[200:203], v243
v_xor_b32 v242, 16, v242
ds_read_b128 v[204:207], v242 offset:128
ds_read_u16_d16 v140, v140
v_bfe_u32 v142, v143, 2, 14
v_exp_f16_sdwa v147, v148 dst_sel:WORD_1 dst_unused:UNUSED_PRESERVE src0_sel:WORD_1
v_lshrrev_b32 v141, 18, v141
v_pk_add_f16 v153, v153, 1.0 op_sel_hi:[1,0]
v_lshrrev_b32_e64 v143, 18, v143
v_pk_add_f16 v150, v150, 1.0 op_sel_hi:[1,0]
v_pk_add_f16 v147, v147, 1.0 op_sel_hi:[1,0]
v_mfma_f32_32x32x16_bf16 v[120:135], v[112:115], v[236:239], v[120:135]
ds_read_b128 v[232:235], v249 offset:6144
ds_read_u16_d16 v142, v142
ds_read_u16_d16_hi v141, v141
ds_read_u16_d16_hi v143, v143
v_and_b32 v145, s49, v145
v_rcp_f16 v154, v153
v_bfe_u32 v144, v145, 2, 14
v_rcp_f16 v151, v150
v_lshrrev_b32 v145, 18, v145
v_rcp_f16 v148, v147
s_waitcnt lgkmcnt(8)
v_smfmac_f32_16x16x32_bf16 v[16:19], v[218:219], v[208:211], v246
ds_read_b128 v[236:239], v249 offset:9216
ds_read_u16_d16 v144, v144
ds_read_u16_d16_hi v145, v145
v_rcp_f16_sdwa v154, v153 dst_sel:WORD_1 dst_unused:UNUSED_PRESERVE src0_sel:WORD_1
v_fma_mix_f32 v163, v136, v136, v163 op_sel:[0,0,0] op_sel_hi:[1,1,0]
v_fma_mix_f32 v163, v137, v137, v163 op_sel:[1,1,0] op_sel_hi:[1,1,0]
v_smfmac_f32_16x16x32_bf16 v[0:3], v[216:217], v[212:215], v246
v_rcp_f16_sdwa v151, v150 dst_sel:WORD_1 dst_unused:UNUSED_PRESERVE src0_sel:WORD_1
v_fma_mix_f32 v163, v138, v138, v163 op_sel:[0,0,0] op_sel_hi:[1,1,0]
v_mfma_f32_32x32x16_bf16 v[120:135], v[116:119], v[220:223], v[120:135]
ds_read_b128 v[216:219], v249 offset:7168
v_rcp_f16_sdwa v148, v147 dst_sel:WORD_1 dst_unused:UNUSED_PRESERVE src0_sel:WORD_1
v_fma_mix_f32 v163, v139, v139, v163 op_sel:[1,1,0] op_sel_hi:[1,1,0]
v_pk_mul_f16 v155, v155, v154
s_waitcnt lgkmcnt(6)
v_fma_mix_f32 v163, v140, v140, v163 op_sel:[0,0,0] op_sel_hi:[1,1,0]
v_pk_mul_f16 v152, v152, v151
s_waitcnt lgkmcnt(4)
v_fma_mix_f32 v163, v141, v141, v163 op_sel:[1,1,0] op_sel_hi:[1,1,0]
v_pk_mul_f16 v149, v149, v148
v_fma_mix_f32 v163, v155, v155, v163 op_sel:[0,0,0] op_sel_hi:[1,1,0]
v_smfmac_f32_16x16x32_bf16 v[32:35], v[226:227], v[192:195], v246
ds_read_b128 v[220:223], v249 offset:10240
v_fma_mix_f32 v163, v142, v142, v163 op_sel:[0,0,0] op_sel_hi:[1,1,0]
v_fma_mix_f32 v163, v155, v155, v163 op_sel:[1,1,0] op_sel_hi:[1,1,0]
v_fma_mix_f32 v163, v143, v143, v163 op_sel:[1,1,0] op_sel_hi:[1,1,0]
v_fma_mix_f32 v163, v152, v152, v163 op_sel:[0,0,0] op_sel_hi:[1,1,0]
v_smfmac_f32_16x16x32_bf16 v[16:19], v[224:225], v[196:199], v246
v_fma_mix_f32 v163, v152, v152, v163 op_sel:[1,1,0] op_sel_hi:[1,1,0]
s_waitcnt lgkmcnt(2)
v_fma_mix_f32 v163, v144, v144, v163 op_sel:[0,0,0] op_sel_hi:[1,1,0]
v_fma_mix_f32 v163, v149, v149, v163 op_sel:[0,0,0] op_sel_hi:[1,1,0]
v_fma_mix_f32 v163, v145, v145, v163 op_sel:[1,1,0] op_sel_hi:[1,1,0]
v_fma_mix_f32 v163, v149, v149, v163 op_sel:[1,1,0] op_sel_hi:[1,1,0]
s_setprio 1
v_smfmac_f32_16x16x32_bf16 v[0:3], v[230:231], v[200:203], v246
ds_read_b128 v[224:227], v249 offset:8192
v_cvt_pkrtz_f16_f32 v137, v120, v121
v_cvt_pkrtz_f16_f32 v139, v122, v123
v_cvt_pkrtz_f16_f32 v141, v124, v125
v_cvt_pkrtz_f16_f32 v143, v126, v127
v_smfmac_f32_16x16x32_bf16 v[32:35], v[228:229], v[204:207], v246
v_cvt_pk_f16_f32 v155, v128, v129
v_cvt_pk_f16_f32 v152, v130, v131
v_cvt_pk_f16_f32 v149, v132, v133
v_cvt_pk_f16_f32 v146, v134, v135
v_pk_fma_f16 v154, v155, v155, s48
v_mfma_f32_32x32x16_bf16 v[120:135], v[96:99], v[232:235], 0
ds_read_b128 v[228:231], v249 offset:11264
v_and_b32_e64 v137, s49, v137
v_pk_fma_f16 v151, v152, v152, s48
v_pk_fma_f16 v148, v149, v149, s48
v_and_b32_e64 v139, s49, v139
v_pk_fma_f16 v145, v146, v146, s48
v_pk_mul_f16 v154, v155, v154
v_bfe_u32 v136, v137, 2, 14
v_pk_mul_f16 v151, v152, v151
v_pk_mul_f16 v148, v149, v148
v_bfe_u32 v138, v139, 2, 14
v_mfma_f32_32x32x16_bf16 v[120:135], v[100:103], v[236:239], v[120:135]
ds_read_b128 v[232:235], v245
ds_read_b128 v[208:211], v242 offset:64
ds_read_b128 v[212:215], v242
ds_read_u16_d16 v136, v136
ds_read_u16_d16 v138, v138
v_pk_mul_f16 v145, v146, v145
v_exp_f16 v153, v154
v_lshrrev_b32 v137, 18, v137
v_exp_f16 v150, v151
v_lshrrev_b32 v139, 18, v139
v_exp_f16 v147, v148
s_waitcnt lgkmcnt(6)
v_mfma_f32_32x32x16_bf16 v[120:135], v[104:107], v[216:219], v[120:135]
ds_read_b128 v[236:239], v249 offset:12288
ds_read_u16_d16_hi v137, v137
ds_read_u16_d16_hi v139, v139
v_and_b32 v141, s49, v141
v_exp_f16 v144, v145
v_and_b32_e64 v143, s49, v143
v_exp_f16_sdwa v153, v154 dst_sel:WORD_1 dst_unused:UNUSED_PRESERVE src0_sel:WORD_1
v_bfe_u32 v140, v141, 2, 14
v_exp_f16_sdwa v150, v151 dst_sel:WORD_1 dst_unused:UNUSED_PRESERVE src0_sel:WORD_1
v_bfe_u32 v142, v143, 2, 14
v_mfma_f32_32x32x16_bf16 v[120:135], v[108:111], v[220:223], v[120:135]
ds_read_b128 v[216:219], v249 offset:15360
ds_read_u16_d16 v140, v140
ds_read_u16_d16 v142, v142
v_exp_f16_sdwa v147, v148 dst_sel:WORD_1 dst_unused:UNUSED_PRESERVE src0_sel:WORD_1
v_lshrrev_b32_e64 v141, 18, v141
v_exp_f16_sdwa v144, v145 dst_sel:WORD_1 dst_unused:UNUSED_PRESERVE src0_sel:WORD_1
v_lshrrev_b32_e64 v143, 18, v143
v_pk_add_f16 v153, v153, 1.0 op_sel_hi:[1,0]
v_pk_add_f16 v150, v150, 1.0 op_sel_hi:[1,0]
v_pk_add_f16 v147, v147, 1.0 op_sel_hi:[1,0]
v_mfma_f32_32x32x16_bf16 v[120:135], v[112:115], v[224:227], v[120:135]
ds_read_b128 v[220:223], v249 offset:13312
ds_read_u16_d16_hi v141, v141
ds_read_u16_d16_hi v143, v143
v_pk_add_f16 v144, v144, 1.0 op_sel_hi:[1,0]
v_rcp_f16 v154, v153
v_rcp_f16 v151, v150
v_rcp_f16 v148, v147
v_rcp_f16 v145, v144
s_waitcnt lgkmcnt(6)
v_mfma_f32_32x32x16_bf16 v[120:135], v[116:119], v[228:231], v[120:135]
ds_read_b128 v[224:227], v249 offset:16384
v_rcp_f16_sdwa v154, v153 dst_sel:WORD_1 dst_unused:UNUSED_PRESERVE src0_sel:WORD_1
v_rcp_f16_sdwa v151, v150 dst_sel:WORD_1 dst_unused:UNUSED_PRESERVE src0_sel:WORD_1
s_setprio 0
v_rcp_f16_sdwa v148, v147 dst_sel:WORD_1 dst_unused:UNUSED_PRESERVE src0_sel:WORD_1
v_fma_mix_f32 v164, v136, v136, v164 op_sel:[0,0,0] op_sel_hi:[1,1,0]
v_rcp_f16_sdwa v145, v144 dst_sel:WORD_1 dst_unused:UNUSED_PRESERVE src0_sel:WORD_1
v_fma_mix_f32 v164, v137, v137, v164 op_sel:[1,1,0] op_sel_hi:[1,1,0]
v_smfmac_f32_16x16x32_bf16 v[16:19], v[234:235], v[208:211], v246
ds_read_b128 v[228:231], v249 offset:14336
v_pk_mul_f16 v155, v155, v154
v_fma_mix_f32 v164, v138, v138, v164 op_sel:[0,0,0] op_sel_hi:[1,1,0]
v_pk_mul_f16 v152, v152, v151
v_pk_mul_f16 v149, v149, v148
v_fma_mix_f32 v164, v139, v139, v164 op_sel:[1,1,0] op_sel_hi:[1,1,0]
v_smfmac_f32_16x16x32_bf16 v[0:3], v[232:233], v[212:215], v246
s_mov_b64 exec, 1
ds_add_u32 v253, v254 offset:16
s_mov_b64 exec, -1
v_pk_mul_f16 v146, v146, v145
v_fma_mix_f32 v164, v155, v155, v164 op_sel:[0,0,0] op_sel_hi:[1,1,0]
s_waitcnt lgkmcnt(3)
v_fma_mix_f32 v164, v140, v140, v164 op_sel:[0,0,0] op_sel_hi:[1,1,0]
v_fma_mix_f32 v164, v155, v155, v164 op_sel:[1,1,0] op_sel_hi:[1,1,0]
v_fma_mix_f32 v164, v152, v152, v164 op_sel:[0,0,0] op_sel_hi:[1,1,0]
v_fma_mix_f32 v164, v141, v141, v164 op_sel:[1,1,0] op_sel_hi:[1,1,0]
v_fma_mix_f32 v164, v152, v152, v164 op_sel:[1,1,0] op_sel_hi:[1,1,0]
v_fma_mix_f32 v164, v149, v149, v164 op_sel:[0,0,0] op_sel_hi:[1,1,0]
v_fma_mix_f32 v164, v142, v142, v164 op_sel:[0,0,0] op_sel_hi:[1,1,0]
v_fma_mix_f32 v164, v149, v149, v164 op_sel:[1,1,0] op_sel_hi:[1,1,0]
v_fma_mix_f32 v164, v146, v146, v164 op_sel:[0,0,0] op_sel_hi:[1,1,0]
v_fma_mix_f32 v164, v143, v143, v164 op_sel:[1,1,0] op_sel_hi:[1,1,0]
v_fma_mix_f32 v164, v146, v146, v164 op_sel:[1,1,0] op_sel_hi:[1,1,0]
s_setprio 3
v_pk_add_f32 v[168:169], v[0:1], v[2:3]
v_pk_mul_f32 v[170:171], v[0:1], v[0:1]
v_pk_fma_f32 v[170:171], v[2:3], v[2:3], v[170:171]
v_pk_add_f32 v[168:169], v[168:169], v[4:5]
v_pk_fma_f32 v[170:171], v[4:5], v[4:5], v[170:171]
v_pk_add_f32 v[168:169], v[168:169], v[6:7]
v_pk_fma_f32 v[170:171], v[6:7], v[6:7], v[170:171]
v_pk_add_f32 v[168:169], v[168:169], v[8:9]
v_pk_fma_f32 v[170:171], v[8:9], v[8:9], v[170:171]
v_pk_add_f32 v[168:169], v[168:169], v[10:11]
v_pk_fma_f32 v[170:171], v[10:11], v[10:11], v[170:171]
v_pk_add_f32 v[168:169], v[168:169], v[12:13]
v_pk_fma_f32 v[170:171], v[12:13], v[12:13], v[170:171]
v_pk_add_f32 v[168:169], v[168:169], v[14:15]
v_pk_fma_f32 v[170:171], v[14:15], v[14:15], v[170:171]
v_pk_add_f32 v[168:169], v[168:169], v[16:17]
v_pk_fma_f32 v[170:171], v[16:17], v[16:17], v[170:171]
v_pk_add_f32 v[168:169], v[168:169], v[18:19]
v_pk_fma_f32 v[170:171], v[18:19], v[18:19], v[170:171]
v_pk_add_f32 v[168:169], v[168:169], v[20:21]
v_pk_fma_f32 v[170:171], v[20:21], v[20:21], v[170:171]
v_pk_add_f32 v[168:169], v[168:169], v[22:23]
v_pk_fma_f32 v[170:171], v[22:23], v[22:23], v[170:171]
v_pk_add_f32 v[168:169], v[168:169], v[24:25]
v_pk_fma_f32 v[170:171], v[24:25], v[24:25], v[170:171]
v_pk_add_f32 v[168:169], v[168:169], v[26:27]
v_pk_fma_f32 v[170:171], v[26:27], v[26:27], v[170:171]
v_pk_add_f32 v[168:169], v[168:169], v[28:29]
v_pk_fma_f32 v[170:171], v[28:29], v[28:29], v[170:171]
v_pk_add_f32 v[168:169], v[168:169], v[30:31]
v_pk_fma_f32 v[170:171], v[30:31], v[30:31], v[170:171]
v_pk_add_f32 v[168:169], v[168:169], v[32:33]
v_pk_fma_f32 v[170:171], v[32:33], v[32:33], v[170:171]
v_pk_add_f32 v[168:169], v[168:169], v[34:35]
v_pk_fma_f32 v[170:171], v[34:35], v[34:35], v[170:171]
v_pk_add_f32 v[168:169], v[168:169], v[36:37]
v_pk_fma_f32 v[170:171], v[36:37], v[36:37], v[170:171]
v_pk_add_f32 v[168:169], v[168:169], v[38:39]
v_pk_fma_f32 v[170:171], v[38:39], v[38:39], v[170:171]
v_pk_add_f32 v[168:169], v[168:169], v[40:41]
v_pk_fma_f32 v[170:171], v[40:41], v[40:41], v[170:171]
v_pk_add_f32 v[168:169], v[168:169], v[42:43]
v_pk_fma_f32 v[170:171], v[42:43], v[42:43], v[170:171]
v_pk_add_f32 v[168:169], v[168:169], v[44:45]
v_pk_fma_f32 v[170:171], v[44:45], v[44:45], v[170:171]
v_pk_add_f32 v[168:169], v[168:169], v[46:47]
v_pk_fma_f32 v[170:171], v[46:47], v[46:47], v[170:171]
s_setprio 0
v_lshrrev_b32 v252, 2, v251
v_mul_u32_u24 v252, 192, v252
v_and_b32 v240, 3, v251
v_lshl_add_u32 v252, v240, 4, v252
s_setprio 2
v_cvt_pkrtz_f16_f32 v137, v120, v121
v_cvt_pkrtz_f16_f32 v139, v122, v123
v_cvt_pkrtz_f16_f32 v141, v124, v125
v_cvt_pkrtz_f16_f32 v143, v126, v127
v_cvt_pkrtz_f16_f32 v145, v128, v129
v_cvt_pk_f16_f32 v155, v130, v131
v_cvt_pk_f16_f32 v152, v132, v133
v_cvt_pk_f16_f32 v149, v134, v135
ds_read_b128 v[232:235], v249 offset:17408
v_mfma_f32_32x32x16_bf16 v[120:135], v[236:239], v[96:99], 0
v_pk_fma_f16 v154, v155, v155, s48
v_add_f32 v168, v168, v169
v_and_b32 v137, s49, v137
v_pk_fma_f16 v151, v152, v152, s48
v_and_b32_e64 v139, s49, v139
v_pk_fma_f16 v148, v149, v149, s48
v_add_f32_e64 v170, v170, v171
v_pk_mul_f16 v154, v155, v154
v_bfe_u32 v136, v137, 2, 14
v_pk_mul_f16 v151, v152, v151
v_pk_mul_f16 v148, v149, v148
v_bfe_u32 v138, v139, 2, 14
ds_read_u16_d16 v136, v136
ds_read_u16_d16 v138, v138
v_mfma_f32_32x32x16_bf16 v[120:135], v[216:219], v[100:103], v[120:135]
v_permlane32_swap_b32 v168, v170
v_exp_f16 v153, v154
v_lshrrev_b32 v137, 18, v137
v_exp_f16 v150, v151
v_add_f32 v168, v168, v170
v_lshrrev_b32 v139, 18, v139
v_exp_f16 v147, v148
v_and_b32 v141, s49, v141
v_and_b32_e64 v143, s49, v143
v_mul_f32 v168, 1009429163, v168
ds_read_u16_d16_hi v137, v137
ds_read_u16_d16_hi v139, v139
v_mfma_f32_32x32x16_bf16 v[120:135], v[220:223], v[104:107], v[120:135]
v_exp_f16_sdwa v153, v154 dst_sel:WORD_1 dst_unused:UNUSED_PRESERVE src0_sel:WORD_1
v_bfe_u32 v140, v141, 2, 14
v_exp_f16_sdwa v150, v151 dst_sel:WORD_1 dst_unused:UNUSED_PRESERVE src0_sel:WORD_1
v_mov_b32_e64 v170, v168
v_bfe_u32 v142, v143, 2, 14
v_exp_f16_sdwa v147, v148 dst_sel:WORD_1 dst_unused:UNUSED_PRESERVE src0_sel:WORD_1
v_lshrrev_b32_e64 v141, 18, v141
v_permlane32_swap_b32 v168, v170
v_pk_add_f16 v153, v153, 1.0 op_sel_hi:[1,0]
s_waitcnt lgkmcnt(6)
ds_read_u16_d16 v140, v140
ds_read_u16_d16 v142, v142
ds_read_u16_d16_hi v141, v141
v_mfma_f32_32x32x16_bf16 v[120:135], v[224:227], v[108:111], v[120:135]
v_lshrrev_b32_e64 v143, 18, v143
v_pk_add_f16 v150, v150, 1.0 op_sel_hi:[1,0]
v_pk_add_f16 v147, v147, 1.0 op_sel_hi:[1,0]
v_and_b32_e64 v145, s49, v145
v_fma_f32 v170, -v168, v168, v170
v_rcp_f16_e64 v154, v153
v_bfe_u32 v144, v145, 2, 14
v_rcp_f16 v151, v150
v_max_f32 v170, 0, v170
v_lshrrev_b32_e64 v145, 18, v145
ds_read_b128 v[224:227], v249 offset:18432
ds_read_u16_d16_hi v143, v143
ds_read_u16_d16 v144, v144
ds_read_u16_d16_hi v145, v145
v_mfma_f32_32x32x16_bf16 v[120:135], v[228:231], v[112:115], v[120:135]
v_rcp_f16 v148, v147
v_rcp_f16_sdwa v154, v153 dst_sel:WORD_1 dst_unused:UNUSED_PRESERVE src0_sel:WORD_1
v_add_f32 v170, 925353388, v170
s_waitcnt lgkmcnt(7)
v_fma_mix_f32 v165, v136, v136, v165 op_sel:[0,0,0] op_sel_hi:[1,1,0]
ds_read_b32 v247, v253 offset:16
v_fma_mix_f32 v165, v137, v137, v165 op_sel:[1,1,0] op_sel_hi:[1,1,0]
v_rcp_f16_sdwa v151, v150 dst_sel:WORD_1 dst_unused:UNUSED_PRESERVE src0_sel:WORD_1
v_rsq_f32_e64 v170, v170
v_fma_mix_f32 v165, v138, v138, v165 op_sel:[0,0,0] op_sel_hi:[1,1,0]
ds_read_b128 v[228:231], v249 offset:21504
v_mfma_f32_32x32x16_bf16 v[120:135], v[232:235], v[116:119], v[120:135]
v_rcp_f16_sdwa v148, v147 dst_sel:WORD_1 dst_unused:UNUSED_PRESERVE src0_sel:WORD_1
v_fma_mix_f32 v165, v139, v139, v165 op_sel:[1,1,0] op_sel_hi:[1,1,0]
v_pk_mul_f16 v155, v155, v154
s_waitcnt lgkmcnt(6)
v_fma_mix_f32 v165, v140, v140, v165 op_sel:[0,0,0] op_sel_hi:[1,1,0]
v_pk_mul_f16 v152, v152, v151
v_fma_mix_f32 v165, v141, v141, v165 op_sel:[1,1,0] op_sel_hi:[1,1,0]
v_pk_mul_f16 v149, v149, v148
v_fma_mix_f32 v165, v155, v155, v165 op_sel:[0,0,0] op_sel_hi:[1,1,0]
v_mul_f32 v172, 3203391086, v170
v_fma_mix_f32 v165, v142, v142, v165 op_sel:[0,0,0] op_sel_hi:[1,1,0]
v_fma_mix_f32 v165, v155, v155, v165 op_sel:[1,1,0] op_sel_hi:[1,1,0]
s_waitcnt lgkmcnt(2)
v_fma_mix_f32 v165, v143, v143, v165 op_sel:[1,1,0] op_sel_hi:[1,1,0]
v_fma_mix_f32 v165, v152, v152, v165 op_sel:[0,0,0] op_sel_hi:[1,1,0]
v_fma_mix_f32 v165, v152, v152, v165 op_sel:[1,1,0] op_sel_hi:[1,1,0]
v_mul_f32 v173, v168, v172
v_fma_mix_f32 v165, v144, v144, v165 op_sel:[0,0,0] op_sel_hi:[1,1,0]
v_fma_mix_f32 v165, v149, v149, v165 op_sel:[0,0,0] op_sel_hi:[1,1,0]
v_fma_mix_f32 v165, v145, v145, v165 op_sel:[1,1,0] op_sel_hi:[1,1,0]
v_fma_mix_f32 v165, v149, v149, v165 op_sel:[1,1,0] op_sel_hi:[1,1,0]
s_setprio 3
v_pk_fma_f32 v[0:1], v[0:1], v[172:173], v[172:173] op_sel:[0,0,1] op_sel_hi:[1,0,1] neg_lo:[0,0,1] neg_hi:[0,0,1]
v_pk_fma_f32 v[2:3], v[2:3], v[172:173], v[172:173] op_sel:[0,0,1] op_sel_hi:[1,0,1] neg_lo:[0,0,1] neg_hi:[0,0,1]
v_pk_fma_f32 v[4:5], v[4:5], v[172:173], v[172:173] op_sel:[0,0,1] op_sel_hi:[1,0,1] neg_lo:[0,0,1] neg_hi:[0,0,1]
v_pk_fma_f32 v[6:7], v[6:7], v[172:173], v[172:173] op_sel:[0,0,1] op_sel_hi:[1,0,1] neg_lo:[0,0,1] neg_hi:[0,0,1]
v_pk_fma_f32 v[8:9], v[8:9], v[172:173], v[172:173] op_sel:[0,0,1] op_sel_hi:[1,0,1] neg_lo:[0,0,1] neg_hi:[0,0,1]
v_pk_fma_f32 v[10:11], v[10:11], v[172:173], v[172:173] op_sel:[0,0,1] op_sel_hi:[1,0,1] neg_lo:[0,0,1] neg_hi:[0,0,1]
v_pk_fma_f32 v[12:13], v[12:13], v[172:173], v[172:173] op_sel:[0,0,1] op_sel_hi:[1,0,1] neg_lo:[0,0,1] neg_hi:[0,0,1]
v_pk_fma_f32 v[14:15], v[14:15], v[172:173], v[172:173] op_sel:[0,0,1] op_sel_hi:[1,0,1] neg_lo:[0,0,1] neg_hi:[0,0,1]
v_pk_fma_f32 v[16:17], v[16:17], v[172:173], v[172:173] op_sel:[0,0,1] op_sel_hi:[1,0,1] neg_lo:[0,0,1] neg_hi:[0,0,1]
v_pk_fma_f32 v[18:19], v[18:19], v[172:173], v[172:173] op_sel:[0,0,1] op_sel_hi:[1,0,1] neg_lo:[0,0,1] neg_hi:[0,0,1]
v_pk_fma_f32 v[20:21], v[20:21], v[172:173], v[172:173] op_sel:[0,0,1] op_sel_hi:[1,0,1] neg_lo:[0,0,1] neg_hi:[0,0,1]
v_pk_fma_f32 v[22:23], v[22:23], v[172:173], v[172:173] op_sel:[0,0,1] op_sel_hi:[1,0,1] neg_lo:[0,0,1] neg_hi:[0,0,1]
v_pk_fma_f32 v[24:25], v[24:25], v[172:173], v[172:173] op_sel:[0,0,1] op_sel_hi:[1,0,1] neg_lo:[0,0,1] neg_hi:[0,0,1]
v_pk_fma_f32 v[26:27], v[26:27], v[172:173], v[172:173] op_sel:[0,0,1] op_sel_hi:[1,0,1] neg_lo:[0,0,1] neg_hi:[0,0,1]
v_pk_fma_f32 v[28:29], v[28:29], v[172:173], v[172:173] op_sel:[0,0,1] op_sel_hi:[1,0,1] neg_lo:[0,0,1] neg_hi:[0,0,1]
v_pk_fma_f32 v[30:31], v[30:31], v[172:173], v[172:173] op_sel:[0,0,1] op_sel_hi:[1,0,1] neg_lo:[0,0,1] neg_hi:[0,0,1]
v_pk_fma_f32 v[32:33], v[32:33], v[172:173], v[172:173] op_sel:[0,0,1] op_sel_hi:[1,0,1] neg_lo:[0,0,1] neg_hi:[0,0,1]
v_pk_fma_f32 v[34:35], v[34:35], v[172:173], v[172:173] op_sel:[0,0,1] op_sel_hi:[1,0,1] neg_lo:[0,0,1] neg_hi:[0,0,1]
v_pk_fma_f32 v[36:37], v[36:37], v[172:173], v[172:173] op_sel:[0,0,1] op_sel_hi:[1,0,1] neg_lo:[0,0,1] neg_hi:[0,0,1]
v_pk_fma_f32 v[38:39], v[38:39], v[172:173], v[172:173] op_sel:[0,0,1] op_sel_hi:[1,0,1] neg_lo:[0,0,1] neg_hi:[0,0,1]
v_pk_fma_f32 v[40:41], v[40:41], v[172:173], v[172:173] op_sel:[0,0,1] op_sel_hi:[1,0,1] neg_lo:[0,0,1] neg_hi:[0,0,1]
v_pk_fma_f32 v[42:43], v[42:43], v[172:173], v[172:173] op_sel:[0,0,1] op_sel_hi:[1,0,1] neg_lo:[0,0,1] neg_hi:[0,0,1]
v_pk_fma_f32 v[44:45], v[44:45], v[172:173], v[172:173] op_sel:[0,0,1] op_sel_hi:[1,0,1] neg_lo:[0,0,1] neg_hi:[0,0,1]
v_pk_fma_f32 v[46:47], v[46:47], v[172:173], v[172:173] op_sel:[0,0,1] op_sel_hi:[1,0,1] neg_lo:[0,0,1] neg_hi:[0,0,1]
s_setprio 2
s_cmp_lg_u32 s40, 0
s_cbranch_scc1 Lrs1
v_mov_b32 v90, 0
Lpi:
s_waitcnt vmcnt(0)
v_readfirstlane_b32 s43, v91
s_cmp_eq_u32 s76, 0
s_cbranch_scc1 Lpix
s_sub_u32 s76, s76, 1
s_cmp_ge_u32 s43, 256
s_cbranch_scc1 Lpix
buffer_load_dword v91, v90, s[36:39], 0 offen sc1
s_branch Lpi
Lpix:
v_min_u32 v88, 47, v251
v_lshlrev_b32_e64 v88, 3, v88
s_and_b32 s44, s2, 7
s_lshl_b32 s44, s44, 11
s_add_u32 s44, s44, 394752
buffer_load_dwordx2 v[92:93], v88, s[32:35], s44 offen sc1
Lrs1:
s_waitcnt lgkmcnt(0)
v_readfirstlane_b32 s43, v247
s_nop 1
s_cmp_ge_u32 s43, 32
s_cbranch_scc1 Lev8
Lev8w:
s_sleep 1
ds_read_b32 v247, v253 offset:16
s_waitcnt lgkmcnt(0)
v_readfirstlane_b32 s43, v247
s_cmp_eq_u32 s76, 0
s_cbranch_scc1 Lev8
s_sub_u32 s76, s76, 1
s_cmp_lt_u32 s43, 32
s_cbranch_scc1 Lev8w
Lev8:
s_setprio 1
v_cvt_pkrtz_f16_f32 v137, v120, v121
v_cvt_pkrtz_f16_f32 v139, v122, v123
v_cvt_pkrtz_f16_f32 v141, v124, v125
v_cvt_pkrtz_f16_f32 v143, v126, v127
v_cvt_pkrtz_f16_f32 v145, v128, v129
v_cvt_pk_f16_f32 v155, v130, v131
v_cvt_pk_f16_f32 v152, v132, v133
v_cvt_pk_f16_f32 v149, v134, v135
s_add_u32 m0, s72, 0
s_add_u32 s43, s82, 0
buffer_load_dwordx4 v252, s[16:19], s43 offen lds
ds_read_b128 v[232:235], v249 offset:19456
ds_read_b128 v[236:239], v249 offset:22528
v_mfma_f32_32x32x16_bf16 v[120:135], v[224:227], v[96:99], 0
v_pk_fma_f16 v154, v155, v155, s48
v_and_b32_e64 v192, 1, v251
v_cvt_pk_bf16_f32 v168, v0, v1
v_and_b32_e64 v137, s49, v137
v_pk_fma_f16 v151, v152, v152, s48
v_cvt_pk_bf16_f32 v169, v2, v3
v_lshlrev_b32 v192, 4, v192
v_and_b32 v139, s49, v139
v_pk_fma_f16 v148, v149, v149, s48
v_cvt_pk_bf16_f32 v170, v4, v5
v_pk_mul_f16 v154, v155, v154
v_mov_b32 v193, 15360
v_bfe_u32 v136, v137, 2, 14
v_pk_mul_f16 v151, v152, v151
v_cvt_pk_bf16_f32 v171, v6, v7
ds_read_b128 v[224:227], v249 offset:20480
ds_read_u16_d16 v136, v136
v_mfma_f32_32x32x16_bf16 v[120:135], v[228:231], v[100:103], v[120:135]
v_pk_mul_f16 v148, v149, v148
v_lshlrev_b32_e64 v192, v192, v193
v_bfe_u32 v138, v139, 2, 14
v_cvt_pk_bf16_f32 v172, v8, v9
v_exp_f16 v153, v154
v_lshrrev_b32 v193, 3, v251
v_cvt_pk_bf16_f32 v173, v10, v11
v_lshrrev_b32_e64 v137, 18, v137
v_exp_f16 v150, v151
v_xor_b32 v193, v193, v251
v_cvt_pk_bf16_f32 v174, v12, v13
v_lshrrev_b32 v139, 18, v139
v_exp_f16 v147, v148
s_waitcnt lgkmcnt(2)
s_add_u32 m0, s72, 1024
s_add_u32 s43, s82, 64
buffer_load_dwordx4 v252, s[16:19], s43 offen lds
ds_read_b128 v[228:231], v249 offset:23552
ds_read_u16_d16 v138, v138
ds_read_u16_d16_hi v137, v137
ds_read_u16_d16_hi v139, v139
v_mfma_f32_32x32x16_bf16 v[120:135], v[232:235], v[104:107], v[120:135]
v_and_b32_e64 v193, 4, v193
v_cvt_pk_bf16_f32 v175, v14, v15
v_and_b32_e64 v141, s49, v141
v_cvt_pk_bf16_f32 v176, v16, v17
v_and_b32_e64 v143, s49, v143
v_bfe_u32 v194, v251, 3, 2
v_exp_f16_sdwa v153, v154 dst_sel:WORD_1 dst_unused:UNUSED_PRESERVE src0_sel:WORD_1
v_cvt_pk_bf16_f32 v177, v18, v19
v_bfe_u32 v140, v141, 2, 14
v_lshl_add_u32 v193, v193, 1, 0
v_exp_f16_sdwa v150, v151 dst_sel:WORD_1 dst_unused:UNUSED_PRESERVE src0_sel:WORD_1
v_cvt_pk_bf16_f32 v178, v20, v21
v_bfe_u32 v142, v143, 2, 14
ds_read_b128 v[232:235], v248 offset:16384
ds_read_u16_d16 v140, v140
ds_read_u16_d16 v142, v142
v_mfma_f32_32x32x16_bf16 v[120:135], v[236:239], v[108:111], v[120:135]
v_lshl_add_u32 v193, v194, 1, v193
v_cvt_pk_bf16_f32 v179, v22, v23
v_exp_f16_sdwa v147, v148 dst_sel:WORD_1 dst_unused:UNUSED_PRESERVE src0_sel:WORD_1
v_lshrrev_b32_e64 v141, 18, v141
v_bfe_u32 v194, v251, 1, 1
v_cvt_pk_bf16_f32 v180, v24, v25
v_pk_add_f16 v153, v153, 1.0 op_sel_hi:[1,0]
v_lshrrev_b32_e64 v143, 18, v143
v_cvt_pk_bf16_f32 v181, v26, v27
v_add_u32_e64 v193, v193, v194
v_pk_add_f16 v150, v150, 1.0 op_sel_hi:[1,0]
v_pk_add_f16 v147, v147, 1.0 op_sel_hi:[1,0]
v_cvt_pk_bf16_f32 v182, v28, v29
v_and_b32_e64 v145, s49, v145
v_cmp_eq_u32 vcc, 0, v193
s_nop 1
v_cndmask_b32 v240, 0, v192, vcc
s_waitcnt lgkmcnt(3)
s_add_u32 m0, s72, 2048
s_add_u32 s43, s82, 128
buffer_load_dwordx4 v252, s[16:19], s43 offen lds
ds_read_b128 v[236:239], v248 offset:19456
ds_read_u16_d16_hi v141, v141
ds_read_u16_d16_hi v143, v143
v_mfma_f32_32x32x16_bf16 v[120:135], v[224:227], v[112:115], v[120:135]
v_rcp_f16_e64 v154, v153
v_cvt_pk_bf16_f32 v183, v30, v31
v_bfe_u32 v144, v145, 2, 14
v_cmp_eq_u32 vcc, 1, v193
s_nop 1
v_cndmask_b32 v241, 0, v192, vcc
v_rcp_f16_e64 v151, v150
s_setprio 0
v_cvt_pk_bf16_f32 v184, v32, v33
v_lshrrev_b32 v145, 18, v145
v_cmp_eq_u32 vcc, 2, v193
s_nop 1
v_cndmask_b32 v242, 0, v192, vcc
v_cvt_pk_bf16_f32 v185, v34, v35
v_rcp_f16_e64 v148, v147
ds_read_u16_d16 v144, v144
ds_read_u16_d16_hi v145, v145
v_or_b32 v208, v136, v137
v_cmp_eq_u32 vcc, 3, v193
s_nop 1
v_cndmask_b32 v243, 0, v192, vcc
v_cvt_pk_bf16_f32 v186, v36, v37
ds_read_b128 v[224:227], v248 offset:17408
v_mfma_f32_32x32x16_bf16 v[120:135], v[228:231], v[116:119], v[120:135]
v_or_b32 v209, v138, v139
v_rcp_f16_sdwa v154, v153 dst_sel:WORD_1 dst_unused:UNUSED_PRESERVE src0_sel:WORD_1
v_cmp_eq_u32 vcc, 4, v193
s_nop 1
v_cndmask_b32 v244, 0, v192, vcc
v_cvt_pk_bf16_f32 v187, v38, v39
s_waitcnt lgkmcnt(3)
v_or_b32 v210, v140, v141
v_cvt_pk_bf16_f32 v188, v40, v41
v_rcp_f16_sdwa v151, v150 dst_sel:WORD_1 dst_unused:UNUSED_PRESERVE src0_sel:WORD_1
v_cmp_eq_u32 vcc, 5, v193
s_nop 1
v_cndmask_b32 v245, 0, v192, vcc
v_or_b32 v211, v142, v143
v_cvt_pk_bf16_f32 v189, v42, v43
v_rcp_f16_sdwa v148, v147 dst_sel:WORD_1 dst_unused:UNUSED_PRESERVE src0_sel:WORD_1
v_cmp_eq_u32 vcc, 6, v193
s_nop 1
v_cndmask_b32 v246, 0, v192, vcc
v_cvt_pk_bf16_f32 v190, v44, v45
s_waitcnt lgkmcnt(0)
v_or_b32_e64 v212, v144, v145
v_pk_mul_f16 v213, v155, v154
v_cmp_eq_u32 vcc, 7, v193
s_nop 1
v_cndmask_b32 v247, 0, v192, vcc
v_cvt_pk_bf16_f32 v191, v46, v47
v_pk_mul_f16 v214, v152, v151
v_pk_mul_f16 v215, v149, v148
s_setprio 2
s_add_u32 m0, s72, 3072
s_add_u32 s43, s82, 3072
buffer_load_dwordx4 v252, s[16:19], s43 offen lds
ds_read_b128 v[228:231], v248 offset:20480
v_mfma_f32_32x32x16_f16 v[192:207], v[208:211], v[240:243], 0
v_cvt_pkrtz_f16_f32 v137, v120, v121
v_cvt_pkrtz_f16_f32 v139, v122, v123
v_cvt_pkrtz_f16_f32 v141, v124, v125
v_cvt_pkrtz_f16_f32 v143, v126, v127
v_cvt_pkrtz_f16_f32 v145, v128, v129
v_mfma_f32_32x32x16_f16 v[192:207], v[212:215], v[244:247], v[192:207]
v_cvt_pk_f16_f32 v155, v130, v131
v_cvt_pk_f16_f32 v152, v132, v133
v_cvt_pk_f16_f32 v149, v134, v135
v_pk_fma_f16 v154, v155, v155, s48
v_and_b32_e64 v137, s49, v137
v_pk_fma_f16 v151, v152, v152, s48
v_mfma_f32_32x32x16_bf16 v[120:135], v[232:235], v[168:171], 0
v_and_b32 v139, s49, v139
v_pk_fma_f16 v148, v149, v149, s48
v_permlane16_swap_b32 v208, v212
v_pk_mul_f16 v154, v155, v154
v_bfe_u32 v136, v137, 2, 14
v_permlane16_swap_b32 v209, v213
v_pk_mul_f16 v151, v152, v151
v_pk_mul_f16 v148, v149, v148
v_bfe_u32 v138, v139, 2, 14
v_permlane16_swap_b32 v210, v214
s_add_u32 m0, s72, 4096
s_add_u32 s43, s82, 3136
buffer_load_dwordx4 v252, s[16:19], s43 offen lds
ds_read_b128 v[232:235], v248 offset:18432
ds_read_u16_d16 v136, v136
ds_read_u16_d16 v138, v138
v_mfma_f32_32x32x16_bf16 v[120:135], v[236:239], v[172:175], v[120:135]
v_exp_f16 v153, v154
v_permlane16_swap_b32 v211, v215
v_lshrrev_b32 v137, 18, v137
v_exp_f16 v150, v151
v_fmac_f32 v166, v192, v192
v_lshrrev_b32 v139, 18, v139
v_exp_f16 v147, v148
v_fmac_f32 v166, v193, v193
v_and_b32_e64 v141, s49, v141
ds_read_b128 v[236:239], v248 offset:21504
ds_read_u16_d16_hi v137, v137
ds_read_u16_d16_hi v139, v139
v_mfma_f32_32x32x16_bf16 v[120:135], v[224:227], v[176:179], v[120:135]
v_and_b32 v143, s49, v143
v_fmac_f32 v166, v194, v194
v_exp_f16_sdwa v153, v154 dst_sel:WORD_1 dst_unused:UNUSED_PRESERVE src0_sel:WORD_1
v_bfe_u32 v140, v141, 2, 14
v_fmac_f32_e64 v166, v195, v195
v_exp_f16_sdwa v150, v151 dst_sel:WORD_1 dst_unused:UNUSED_PRESERVE src0_sel:WORD_1
v_fmac_f32 v166, v196, v196
v_bfe_u32 v142, v143, 2, 14
s_waitcnt lgkmcnt(5)
ds_read_b128 v[224:227], v248 offset:22528
ds_read_u16_d16 v140, v140
ds_read_u16_d16 v142, v142
v_mfma_f32_32x32x16_bf16 v[120:135], v[228:231], v[180:183], v[120:135]
v_exp_f16_sdwa v147, v148 dst_sel:WORD_1 dst_unused:UNUSED_PRESERVE src0_sel:WORD_1
v_fmac_f32 v166, v197, v197
v_lshrrev_b32 v141, 18, v141
v_pk_add_f16 v153, v153, 1.0 op_sel_hi:[1,0]
v_lshrrev_b32 v143, 18, v143
v_fmac_f32 v166, v198, v198
v_pk_add_f16 v150, v150, 1.0 op_sel_hi:[1,0]
v_pk_add_f16 v147, v147, 1.0 op_sel_hi:[1,0]
v_fmac_f32 v166, v199, v199
v_and_b32 v145, s49, v145
s_add_u32 m0, s72, 5120
s_add_u32 s43, s82, 3200
buffer_load_dwordx4 v252, s[16:19], s43 offen lds
ds_read_b128 v[228:231], v248 offset:25600
ds_read_u16_d16_hi v141, v141
ds_read_u16_d16_hi v143, v143
v_mfma_f32_32x32x16_bf16 v[120:135], v[232:235], v[184:187], v[120:135]
v_rcp_f16 v154, v153
v_fmac_f32 v166, v200, v200
v_bfe_u32 v144, v145, 2, 14
v_rcp_f16 v151, v150
v_fmac_f32 v166, v201, v201
v_lshrrev_b32 v145, 18, v145
v_rcp_f16 v148, v147
v_fmac_f32_e64 v166, v202, v202
ds_read_u16_d16 v144, v144
ds_read_u16_d16_hi v145, v145
s_waitcnt lgkmcnt(5)
v_or_b32 v216, v136, v137
ds_read_b128 v[232:235], v248 offset:23552
v_mfma_f32_32x32x16_bf16 v[120:135], v[236:239], v[188:191], v[120:135]
v_or_b32 v217, v138, v139
v_fmac_f32 v166, v203, v203
v_rcp_f16_sdwa v154, v153 dst_sel:WORD_1 dst_unused:UNUSED_PRESERVE src0_sel:WORD_1
v_fmac_f32 v166, v204, v204
s_waitcnt lgkmcnt(4)
v_or_b32_e64 v218, v140, v141
v_rcp_f16_sdwa v151, v150 dst_sel:WORD_1 dst_unused:UNUSED_PRESERVE src0_sel:WORD_1
v_fmac_f32 v166, v205, v205
s_waitcnt lgkmcnt(3)
v_or_b32_e64 v219, v142, v143
v_rcp_f16_sdwa v148, v147 dst_sel:WORD_1 dst_unused:UNUSED_PRESERVE src0_sel:WORD_1
v_fmac_f32 v166, v206, v206
s_waitcnt lgkmcnt(1)
v_or_b32_e64 v220, v144, v145
v_pk_mul_f16 v221, v155, v154
v_fmac_f32 v166, v207, v207
v_pk_mul_f16 v222, v152, v151
v_pk_mul_f16 v223, v149, v148
s_setprio 1
s_add_u32 m0, s72, 6144
s_add_u32 s43, s82, 6144
buffer_load_dwordx4 v252, s[16:19], s43 offen lds
ds_read_b128 v[236:239], v248 offset:26624
v_mfma_f32_32x32x16_f16 v[192:207], v[216:219], v[240:243], 0
v_cvt_pkrtz_f16_f32 v137, v120, v121
v_cvt_pkrtz_f16_f32 v139, v122, v123
v_cvt_pkrtz_f16_f32 v141, v124, v125
v_cvt_pkrtz_f16_f32 v143, v126, v127
v_cvt_pkrtz_f16_f32 v145, v128, v129
v_cvt_pk_f16_f32 v155, v130, v131
v_mfma_f32_32x32x16_f16 v[192:207], v[220:223], v[244:247], v[192:207]
v_cvt_pk_f16_f32 v152, v132, v133
v_cvt_pk_f16_f32 v149, v134, v135
v_pk_fma_f16 v154, v155, v155, s48
v_and_b32 v255, 51, v251
v_and_b32 v137, s49, v137
v_pk_fma_f16 v151, v152, v152, s48
v_mfma_f32_32x32x16_bf16 v[120:135], v[224:227], v[168:171], 0
v_and_b32 v139, s49, v139
v_pk_fma_f16 v148, v149, v149, s48
v_permlane16_swap_b32 v216, v220
v_pk_mul_f16 v154, v155, v154
v_bfe_u32 v136, v137, 2, 14
v_permlane16_swap_b32 v217, v221
v_pk_mul_f16 v151, v152, v151
v_pk_mul_f16 v148, v149, v148
v_bfe_u32 v138, v139, 2, 14
v_permlane16_swap_b32 v218, v222
v_bfe_u32 v95, v251, 2, 1
ds_read_b128 v[224:227], v248 offset:24576
ds_read_u16_d16 v136, v136
ds_read_u16_d16 v138, v138
v_mfma_f32_32x32x16_bf16 v[120:135], v[228:231], v[172:175], v[120:135]
v_exp_f16 v153, v154
v_permlane16_swap_b32 v219, v223
v_lshrrev_b32 v137, 18, v137
v_exp_f16 v150, v151
v_fmac_f32 v167, v192, v192
v_lshrrev_b32 v139, 18, v139
v_exp_f16 v147, v148
v_fmac_f32 v167, v193, v193
v_and_b32_e64 v141, s49, v141
v_and_b32 v143, s49, v143
s_waitcnt lgkmcnt(3)
ds_read_b128 v[228:231], v248 offset:27648
ds_read_u16_d16_hi v137, v137
ds_read_u16_d16_hi v139, v139
v_mfma_f32_32x32x16_bf16 v[120:135], v[232:235], v[176:179], v[120:135]
v_lshl_add_u32 v255, v95, 3, v255
v_fmac_f32_e64 v167, v194, v194
v_exp_f16_sdwa v153, v154 dst_sel:WORD_1 dst_unused:UNUSED_PRESERVE src0_sel:WORD_1
v_bfe_u32 v140, v141, 2, 14
v_fmac_f32_e64 v167, v195, v195
v_exp_f16_sdwa v150, v151 dst_sel:WORD_1 dst_unused:UNUSED_PRESERVE src0_sel:WORD_1
v_fmac_f32_e64 v167, v196, v196
v_bfe_u32 v142, v143, 2, 14
v_exp_f16_sdwa v147, v148 dst_sel:WORD_1 dst_unused:UNUSED_PRESERVE src0_sel:WORD_1
ds_read_b128 v[232:235], v248 offset:28672
ds_read_u16_d16 v140, v140
ds_read_u16_d16 v142, v142
v_mfma_f32_32x32x16_bf16 v[120:135], v[236:239], v[180:183], v[120:135]
v_fmac_f32 v167, v197, v197
v_lshrrev_b32 v141, 18, v141
v_bfe_u32 v95, v251, 3, 1
v_pk_add_f16 v153, v153, 1.0 op_sel_hi:[1,0]
v_lshrrev_b32 v143, 18, v143
v_fmac_f32 v167, v198, v198
v_pk_add_f16 v150, v150, 1.0 op_sel_hi:[1,0]
v_pk_add_f16 v147, v147, 1.0 op_sel_hi:[1,0]
v_fmac_f32 v167, v199, v199
v_and_b32 v145, s49, v145
v_rcp_f16 v154, v153
s_waitcnt lgkmcnt(3)
ds_read_b128 v[236:239], v248 offset:31744
ds_read_u16_d16_hi v141, v141
ds_read_u16_d16_hi v143, v143
v_mfma_f32_32x32x16_bf16 v[120:135], v[224:227], v[184:187], v[120:135]
v_fmac_f32_e64 v167, v200, v200
v_bfe_u32 v144, v145, 2, 14
v_rcp_f16 v151, v150
s_setprio 0
v_lshl_add_u32 v255, v95, 2, v255
v_fmac_f32 v167, v201, v201
v_lshrrev_b32 v145, 18, v145
v_rcp_f16 v148, v147
v_fmac_f32 v167, v202, v202
ds_read_u16_d16 v144, v144
ds_read_u16_d16_hi v145, v145
v_or_b32 v0, v136, v137
v_or_b32 v1, v138, v139
ds_read_b128 v[224:227], v248 offset:29696
v_mfma_f32_32x32x16_bf16 v[120:135], v[228:231], v[188:191], v[120:135]
v_fmac_f32_e64 v167, v203, v203
v_rcp_f16_sdwa v154, v153 dst_sel:WORD_1 dst_unused:UNUSED_PRESERVE src0_sel:WORD_1
v_fmac_f32 v167, v204, v204
s_waitcnt lgkmcnt(4)
v_or_b32_e64 v2, v140, v141
v_lshl_add_u32 v255, v255, 2, s72
v_rcp_f16_sdwa v151, v150 dst_sel:WORD_1 dst_unused:UNUSED_PRESERVE src0_sel:WORD_1
v_fmac_f32 v167, v205, v205
s_waitcnt lgkmcnt(3)
v_or_b32_e64 v3, v142, v143
v_rcp_f16_sdwa v148, v147 dst_sel:WORD_1 dst_unused:UNUSED_PRESERVE src0_sel:WORD_1
v_fmac_f32 v167, v206, v206
s_waitcnt lgkmcnt(1)
v_or_b32_e64 v4, v144, v145
v_pk_mul_f16 v5, v155, v154
v_fmac_f32 v167, v207, v207
v_pk_mul_f16 v6, v152, v151
v_pk_mul_f16 v7, v149, v148
s_setprio 2
ds_read_b128 v[228:231], v248 offset:32768
v_mfma_f32_32x32x16_f16 v[192:207], v[0:3], v[240:243], 0
v_cvt_pkrtz_f16_f32 v137, v120, v121
v_cvt_pkrtz_f16_f32 v139, v122, v123
v_cvt_pkrtz_f16_f32 v141, v124, v125
v_cvt_pkrtz_f16_f32 v143, v126, v127
v_cvt_pkrtz_f16_f32 v145, v128, v129
v_mfma_f32_32x32x16_f16 v[192:207], v[4:7], v[244:247], v[192:207]
v_cvt_pk_f16_f32 v155, v130, v131
v_cvt_pk_f16_f32 v152, v132, v133
v_cvt_pk_f16_f32 v149, v134, v135
v_pk_fma_f16 v154, v155, v155, s48
v_and_b32_e64 v137, s49, v137
v_pk_fma_f16 v151, v152, v152, s48
v_mfma_f32_32x32x16_bf16 v[120:135], v[232:235], v[168:171], 0
v_and_b32 v139, s49, v139
v_pk_fma_f16 v148, v149, v149, s48
v_permlane16_swap_b32 v0, v4
v_pk_mul_f16 v154, v155, v154
v_bfe_u32 v136, v137, 2, 14
v_permlane16_swap_b32 v1, v5
v_pk_mul_f16 v151, v152, v151
v_pk_mul_f16 v148, v149, v148
v_bfe_u32 v138, v139, 2, 14
v_permlane16_swap_b32 v2, v6
ds_read_b128 v[232:235], v248 offset:30720
ds_read_u16_d16 v136, v136
ds_read_u16_d16 v138, v138
v_mfma_f32_32x32x16_bf16 v[120:135], v[236:239], v[172:175], v[120:135]
v_exp_f16 v153, v154
v_permlane16_swap_b32 v3, v7
v_lshrrev_b32 v137, 18, v137
v_exp_f16 v150, v151
v_fmac_f32 v156, v192, v192
v_lshrrev_b32 v139, 18, v139
v_exp_f16 v147, v148
v_fmac_f32 v156, v193, v193
v_and_b32 v141, s49, v141
s_waitcnt lgkmcnt(3)
ds_read_b128 v[236:239], v248 offset:33792
ds_read_u16_d16_hi v137, v137
ds_read_u16_d16_hi v139, v139
v_mfma_f32_32x32x16_bf16 v[120:135], v[224:227], v[176:179], v[120:135]
v_and_b32 v143, s49, v143
v_fmac_f32 v156, v194, v194
v_exp_f16_sdwa v153, v154 dst_sel:WORD_1 dst_unused:UNUSED_PRESERVE src0_sel:WORD_1
v_bfe_u32 v140, v141, 2, 14
v_fmac_f32_e64 v156, v195, v195
v_exp_f16_sdwa v150, v151 dst_sel:WORD_1 dst_unused:UNUSED_PRESERVE src0_sel:WORD_1
v_fmac_f32_e64 v156, v196, v196
v_bfe_u32 v142, v143, 2, 14
ds_read_b128 v[224:227], v248 offset:34816
ds_read_u16_d16 v140, v140
ds_read_u16_d16 v142, v142
v_mfma_f32_32x32x16_bf16 v[120:135], v[228:231], v[180:183], v[120:135]
v_exp_f16_sdwa v147, v148 dst_sel:WORD_1 dst_unused:UNUSED_PRESERVE src0_sel:WORD_1
v_fmac_f32 v156, v197, v197
v_lshrrev_b32 v141, 18, v141
v_pk_add_f16 v153, v153, 1.0 op_sel_hi:[1,0]
v_lshrrev_b32 v143, 18, v143
v_fmac_f32 v156, v198, v198
v_pk_add_f16 v150, v150, 1.0 op_sel_hi:[1,0]
v_pk_add_f16 v147, v147, 1.0 op_sel_hi:[1,0]
v_fmac_f32_e64 v156, v199, v199
v_and_b32 v145, s49, v145
s_waitcnt lgkmcnt(4)
ds_read_b128 v[228:231], v248 offset:37888
ds_read_u16_d16_hi v141, v141
ds_read_u16_d16_hi v143, v143
v_mfma_f32_32x32x16_bf16 v[120:135], v[232:235], v[184:187], v[120:135]
v_rcp_f16 v154, v153
v_fmac_f32 v156, v200, v200
v_bfe_u32 v144, v145, 2, 14
v_rcp_f16 v151, v150
v_fmac_f32 v156, v201, v201
v_lshrrev_b32 v145, 18, v145
v_rcp_f16 v148, v147
v_fmac_f32_e64 v156, v202, v202
ds_read_u16_d16 v144, v144
ds_read_u16_d16_hi v145, v145
v_or_b32_e64 v8, v136, v137
ds_read_b128 v[232:235], v248 offset:35840
v_mfma_f32_32x32x16_bf16 v[120:135], v[236:239], v[188:191], v[120:135]
s_waitcnt lgkmcnt(6)
v_or_b32 v9, v138, v139
v_fmac_f32_e64 v156, v203, v203
v_rcp_f16_sdwa v154, v153 dst_sel:WORD_1 dst_unused:UNUSED_PRESERVE src0_sel:WORD_1
v_fmac_f32 v156, v204, v204
s_waitcnt lgkmcnt(4)
v_or_b32_e64 v10, v140, v141
v_rcp_f16_sdwa v151, v150 dst_sel:WORD_1 dst_unused:UNUSED_PRESERVE src0_sel:WORD_1
v_fmac_f32 v156, v205, v205
s_waitcnt lgkmcnt(3)
v_or_b32_e64 v11, v142, v143
v_rcp_f16_sdwa v148, v147 dst_sel:WORD_1 dst_unused:UNUSED_PRESERVE src0_sel:WORD_1
v_fmac_f32 v156, v206, v206
s_waitcnt lgkmcnt(1)
v_or_b32_e64 v12, v144, v145
v_pk_mul_f16 v13, v155, v154
v_fmac_f32_e64 v156, v207, v207
v_pk_mul_f16 v14, v152, v151
v_pk_mul_f16 v15, v149, v148
s_cmp_lg_u32 s40, 0
s_cbranch_scc1 Lrs2
v_min_u32_e64 v88, 47, v251
v_lshlrev_b32 v88, 3, v88
v_add_u32 v89, 7936, v88
v_add_u32 v88, 15872, v88
v_cmp_gt_u32 vcc, 32, v251
s_nop 1
v_cndmask_b32 v88, v88, v89, vcc
s_waitcnt vmcnt(0)
ds_write_b64 v88, v[92:93]
Lrs2:
s_setprio 1
ds_read_b128 v[236:239], v248 offset:38912
v_mfma_f32_32x32x16_f16 v[192:207], v[8:11], v[240:243], 0
v_cvt_pkrtz_f16_f32 v137, v120, v121
v_cvt_pkrtz_f16_f32 v139, v122, v123
v_cvt_pkrtz_f16_f32 v141, v124, v125
v_cvt_pkrtz_f16_f32 v143, v126, v127
v_cvt_pkrtz_f16_f32 v145, v128, v129
v_mfma_f32_32x32x16_f16 v[192:207], v[12:15], v[244:247], v[192:207]
v_cvt_pk_f16_f32 v155, v130, v131
v_cvt_pk_f16_f32 v152, v132, v133
v_cvt_pk_f16_f32 v149, v134, v135
v_pk_fma_f16 v154, v155, v155, s48
v_and_b32_e64 v137, s49, v137
v_pk_fma_f16 v151, v152, v152, s48
v_mfma_f32_32x32x16_bf16 v[120:135], v[224:227], v[168:171], 0
v_and_b32 v139, s49, v139
v_pk_fma_f16 v148, v149, v149, s48
v_permlane16_swap_b32 v8, v12
v_pk_mul_f16 v154, v155, v154
v_bfe_u32 v136, v137, 2, 14
v_permlane16_swap_b32 v9, v13
v_pk_mul_f16 v151, v152, v151
v_pk_mul_f16 v148, v149, v148
v_permlane16_swap_b32 v10, v14
v_bfe_u32 v138, v139, 2, 14
ds_read_b128 v[224:227], v248 offset:36864
ds_read_u16_d16 v136, v136
ds_read_u16_d16 v138, v138
v_mfma_f32_32x32x16_bf16 v[120:135], v[228:231], v[172:175], v[120:135]
v_exp_f16 v153, v154
v_permlane16_swap_b32 v11, v15
v_lshrrev_b32 v137, 18, v137
v_exp_f16 v150, v151
v_fmac_f32 v157, v192, v192
v_lshrrev_b32 v139, 18, v139
v_fmac_f32 v157, v193, v193
v_exp_f16 v147, v148
v_and_b32_e64 v141, s49, v141
v_fmac_f32 v157, v194, v194
s_waitcnt lgkmcnt(3)
ds_read_b128 v[228:231], v248 offset:39936
ds_read_u16_d16_hi v137, v137
ds_read_u16_d16_hi v139, v139
v_mfma_f32_32x32x16_bf16 v[120:135], v[232:235], v[176:179], v[120:135]
v_and_b32_e64 v143, s49, v143
v_exp_f16_sdwa v153, v154 dst_sel:WORD_1 dst_unused:UNUSED_PRESERVE src0_sel:WORD_1
v_fmac_f32_e64 v157, v195, v195
v_bfe_u32 v140, v141, 2, 14
v_fmac_f32_e64 v157, v196, v196
v_exp_f16_sdwa v150, v151 dst_sel:WORD_1 dst_unused:UNUSED_PRESERVE src0_sel:WORD_1
v_bfe_u32 v142, v143, 2, 14
v_fmac_f32_e64 v157, v197, v197
ds_read_b128 v[232:235], v248 offset:40960
ds_read_u16_d16 v140, v140
ds_read_u16_d16 v142, v142
v_mfma_f32_32x32x16_bf16 v[120:135], v[236:239], v[180:183], v[120:135]
v_exp_f16_sdwa v147, v148 dst_sel:WORD_1 dst_unused:UNUSED_PRESERVE src0_sel:WORD_1
v_fmac_f32 v157, v198, v198
v_lshrrev_b32 v141, 18, v141
v_pk_add_f16 v153, v153, 1.0 op_sel_hi:[1,0]
v_lshrrev_b32 v143, 18, v143
v_fmac_f32 v157, v199, v199
v_pk_add_f16 v150, v150, 1.0 op_sel_hi:[1,0]
v_pk_add_f16 v147, v147, 1.0 op_sel_hi:[1,0]
v_fmac_f32 v157, v200, v200
v_and_b32 v145, s49, v145
v_rcp_f16 v154, v153
s_waitcnt lgkmcnt(3)
ds_read_b128 v[236:239], v248 offset:44032
ds_read_u16_d16_hi v141, v141
ds_read_u16_d16_hi v143, v143
v_mfma_f32_32x32x16_bf16 v[120:135], v[224:227], v[184:187], v[120:135]
v_fmac_f32_e64 v157, v201, v201
v_bfe_u32 v144, v145, 2, 14
v_rcp_f16 v151, v150
s_setprio 0
v_fmac_f32 v157, v202, v202
v_lshrrev_b32 v145, 18, v145
v_fmac_f32 v157, v203, v203
v_rcp_f16 v148, v147
v_fmac_f32_e64 v157, v204, v204
ds_read_u16_d16 v144, v144
ds_read_u16_d16_hi v145, v145
v_or_b32_e64 v16, v136, v137
ds_read_b128 v[224:227], v248 offset:41984
v_mfma_f32_32x32x16_bf16 v[120:135], v[228:231], v[188:191], v[120:135]
v_or_b32_e64 v17, v138, v139
v_rcp_f16_sdwa v154, v153 dst_sel:WORD_1 dst_unused:UNUSED_PRESERVE src0_sel:WORD_1
v_fmac_f32 v157, v205, v205
s_waitcnt lgkmcnt(4)
v_or_b32 v18, v140, v141
v_fmac_f32 v157, v206, v206
v_rcp_f16_sdwa v151, v150 dst_sel:WORD_1 dst_unused:UNUSED_PRESERVE src0_sel:WORD_1
v_fmac_f32 v157, v207, v207
s_waitcnt lgkmcnt(3)
v_or_b32_e64 v19, v142, v143
v_rcp_f16_sdwa v148, v147 dst_sel:WORD_1 dst_unused:UNUSED_PRESERVE src0_sel:WORD_1
v_permlane32_swap_b32 v156, v157
s_waitcnt lgkmcnt(1)
v_or_b32_e64 v20, v144, v145
v_pk_mul_f16 v21, v155, v154
v_add_f32 v156, v156, v157
ds_write_b32 v255, v156 offset:7168
v_pk_mul_f16 v22, v152, v151
v_pk_mul_f16 v23, v149, v148
s_setprio 2
ds_read_b128 v[228:231], v248 offset:45056
v_mfma_f32_32x32x16_f16 v[192:207], v[16:19], v[240:243], 0
v_cvt_pkrtz_f16_f32 v137, v120, v121
v_cvt_pkrtz_f16_f32 v139, v122, v123
v_cvt_pkrtz_f16_f32 v141, v124, v125
v_cvt_pkrtz_f16_f32 v143, v126, v127
v_cvt_pkrtz_f16_f32 v145, v128, v129
v_mfma_f32_32x32x16_f16 v[192:207], v[20:23], v[244:247], v[192:207]
v_cvt_pk_f16_f32 v155, v130, v131
v_cvt_pk_f16_f32 v152, v132, v133
v_cvt_pk_f16_f32 v149, v134, v135
v_pk_fma_f16 v154, v155, v155, s48
v_and_b32_e64 v137, s49, v137
v_pk_fma_f16 v151, v152, v152, s48
v_mfma_f32_32x32x16_bf16 v[120:135], v[232:235], v[168:171], 0
v_and_b32 v139, s49, v139
v_pk_fma_f16 v148, v149, v149, s48
v_permlane16_swap_b32 v16, v20
v_pk_mul_f16 v154, v155, v154
v_bfe_u32 v136, v137, 2, 14
v_permlane16_swap_b32 v17, v21
v_pk_mul_f16 v151, v152, v151
v_pk_mul_f16 v148, v149, v148
v_bfe_u32 v138, v139, 2, 14
v_permlane16_swap_b32 v18, v22
ds_read_b128 v[232:235], v248 offset:43008
ds_read_u16_d16 v136, v136
ds_read_u16_d16 v138, v138
v_mfma_f32_32x32x16_bf16 v[120:135], v[236:239], v[172:175], v[120:135]
v_exp_f16 v153, v154
v_permlane16_swap_b32 v19, v23
v_lshrrev_b32 v137, 18, v137
v_exp_f16 v150, v151
v_fmac_f32 v158, v192, v192
v_lshrrev_b32 v139, 18, v139
v_exp_f16 v147, v148
v_fmac_f32 v158, v193, v193
v_and_b32 v141, s49, v141
s_waitcnt lgkmcnt(5)
ds_read_b128 v[236:239], v248 offset:46080
ds_read_u16_d16_hi v137, v137
ds_read_u16_d16_hi v139, v139
v_mfma_f32_32x32x16_bf16 v[120:135], v[224:227], v[176:179], v[120:135]
v_and_b32 v143, s49, v143
v_fmac_f32 v158, v194, v194
v_exp_f16_sdwa v153, v154 dst_sel:WORD_1 dst_unused:UNUSED_PRESERVE src0_sel:WORD_1
v_bfe_u32 v140, v141, 2, 14
v_fmac_f32_e64 v158, v195, v195
v_exp_f16_sdwa v150, v151 dst_sel:WORD_1 dst_unused:UNUSED_PRESERVE src0_sel:WORD_1
v_fmac_f32 v158, v196, v196
v_bfe_u32 v142, v143, 2, 14
s_waitcnt lgkmcnt(4)
ds_read_b128 v[224:227], v248 offset:47104
ds_read_u16_d16 v140, v140
ds_read_u16_d16 v142, v142
v_mfma_f32_32x32x16_bf16 v[120:135], v[228:231], v[180:183], v[120:135]
v_exp_f16_sdwa v147, v148 dst_sel:WORD_1 dst_unused:UNUSED_PRESERVE src0_sel:WORD_1
v_fmac_f32 v158, v197, v197
v_lshrrev_b32 v141, 18, v141
v_pk_add_f16 v153, v153, 1.0 op_sel_hi:[1,0]
v_lshrrev_b32 v143, 18, v143
v_fmac_f32 v158, v198, v198
v_pk_add_f16 v150, v150, 1.0 op_sel_hi:[1,0]
v_pk_add_f16 v147, v147, 1.0 op_sel_hi:[1,0]
v_fmac_f32 v158, v199, v199
v_and_b32 v145, s49, v145
ds_read_b128 v[228:231], v248 offset:50176
ds_read_u16_d16_hi v141, v141
ds_read_u16_d16_hi v143, v143
v_mfma_f32_32x32x16_bf16 v[120:135], v[232:235], v[184:187], v[120:135]
v_rcp_f16 v154, v153
v_fmac_f32 v158, v200, v200
v_bfe_u32 v144, v145, 2, 14
v_rcp_f16 v151, v150
v_fmac_f32 v158, v201, v201
v_lshrrev_b32 v145, 18, v145
v_rcp_f16 v148, v147
v_fmac_f32_e64 v158, v202, v202
ds_read_u16_d16 v144, v144
ds_read_u16_d16_hi v145, v145
s_waitcnt lgkmcnt(5)
v_or_b32 v24, v136, v137
ds_read_b128 v[232:235], v248 offset:48128
v_mfma_f32_32x32x16_bf16 v[120:135], v[236:239], v[188:191], v[120:135]
v_or_b32 v25, v138, v139
v_fmac_f32 v158, v203, v203
v_rcp_f16_sdwa v154, v153 dst_sel:WORD_1 dst_unused:UNUSED_PRESERVE src0_sel:WORD_1
v_fmac_f32 v158, v204, v204
s_waitcnt lgkmcnt(4)
v_or_b32_e64 v26, v140, v141
v_rcp_f16_sdwa v151, v150 dst_sel:WORD_1 dst_unused:UNUSED_PRESERVE src0_sel:WORD_1
v_fmac_f32 v158, v205, v205
s_waitcnt lgkmcnt(3)
v_or_b32_e64 v27, v142, v143
v_rcp_f16_sdwa v148, v147 dst_sel:WORD_1 dst_unused:UNUSED_PRESERVE src0_sel:WORD_1
v_fmac_f32 v158, v206, v206
s_waitcnt lgkmcnt(1)
v_or_b32_e64 v28, v144, v145
v_pk_mul_f16 v29, v155, v154
v_fmac_f32 v158, v207, v207
v_pk_mul_f16 v30, v152, v151
v_pk_mul_f16 v31, v149, v148
s_setprio 1
ds_read_b128 v[236:239], v248 offset:51200
v_mfma_f32_32x32x16_f16 v[192:207], v[24:27], v[240:243], 0
v_cvt_pkrtz_f16_f32 v137, v120, v121
v_cvt_pkrtz_f16_f32 v139, v122, v123
v_cvt_pkrtz_f16_f32 v141, v124, v125
v_cvt_pkrtz_f16_f32 v143, v126, v127
v_cvt_pkrtz_f16_f32 v145, v128, v129
v_mfma_f32_32x32x16_f16 v[192:207], v[28:31], v[244:247], v[192:207]
v_cvt_pk_f16_f32 v155, v130, v131
v_cvt_pk_f16_f32 v152, v132, v133
v_cvt_pk_f16_f32 v149, v134, v135
v_pk_fma_f16 v154, v155, v155, s48
v_and_b32_e64 v137, s49, v137
v_pk_fma_f16 v151, v152, v152, s48
v_mfma_f32_32x32x16_bf16 v[120:135], v[224:227], v[168:171], 0
v_and_b32 v139, s49, v139
v_pk_fma_f16 v148, v149, v149, s48
v_permlane16_swap_b32 v24, v28
v_pk_mul_f16 v154, v155, v154
v_bfe_u32 v136, v137, 2, 14
v_permlane16_swap_b32 v25, v29
v_pk_mul_f16 v151, v152, v151
v_pk_mul_f16 v148, v149, v148
v_permlane16_swap_b32 v26, v30
v_bfe_u32 v138, v139, 2, 14
ds_read_b128 v[224:227], v248 offset:49152
ds_read_u16_d16 v136, v136
ds_read_u16_d16 v138, v138
v_mfma_f32_32x32x16_bf16 v[120:135], v[228:231], v[172:175], v[120:135]
v_exp_f16 v153, v154
v_permlane16_swap_b32 v27, v31
v_lshrrev_b32 v137, 18, v137
v_exp_f16 v150, v151
v_fmac_f32 v159, v192, v192
v_lshrrev_b32 v139, 18, v139
v_fmac_f32 v159, v193, v193
v_exp_f16 v147, v148
v_and_b32_e64 v141, s49, v141
v_fmac_f32 v159, v194, v194
s_waitcnt lgkmcnt(3)
ds_read_b128 v[228:231], v248 offset:52224
ds_read_u16_d16_hi v137, v137
ds_read_u16_d16_hi v139, v139
v_mfma_f32_32x32x16_bf16 v[120:135], v[232:235], v[176:179], v[120:135]
v_and_b32_e64 v143, s49, v143
v_exp_f16_sdwa v153, v154 dst_sel:WORD_1 dst_unused:UNUSED_PRESERVE src0_sel:WORD_1
v_fmac_f32_e64 v159, v195, v195
v_bfe_u32 v140, v141, 2, 14
v_fmac_f32_e64 v159, v196, v196
v_exp_f16_sdwa v150, v151 dst_sel:WORD_1 dst_unused:UNUSED_PRESERVE src0_sel:WORD_1
v_bfe_u32 v142, v143, 2, 14
v_fmac_f32_e64 v159, v197, v197
ds_read_b128 v[232:235], v248 offset:53248
ds_read_u16_d16 v140, v140
ds_read_u16_d16 v142, v142
v_mfma_f32_32x32x16_bf16 v[120:135], v[236:239], v[180:183], v[120:135]
v_exp_f16_sdwa v147, v148 dst_sel:WORD_1 dst_unused:UNUSED_PRESERVE src0_sel:WORD_1
v_fmac_f32 v159, v198, v198
v_lshrrev_b32 v141, 18, v141
v_pk_add_f16 v153, v153, 1.0 op_sel_hi:[1,0]
v_lshrrev_b32 v143, 18, v143
v_fmac_f32 v159, v199, v199
v_pk_add_f16 v150, v150, 1.0 op_sel_hi:[1,0]
v_pk_add_f16 v147, v147, 1.0 op_sel_hi:[1,0]
v_fmac_f32 v159, v200, v200
v_and_b32 v145, s49, v145
v_rcp_f16 v154, v153
s_waitcnt lgkmcnt(3)
ds_read_b128 v[236:239], v248 offset:56320
ds_read_u16_d16_hi v141, v141
ds_read_u16_d16_hi v143, v143
v_mfma_f32_32x32x16_bf16 v[120:135], v[224:227], v[184:187], v[120:135]
v_fmac_f32_e64 v159, v201, v201
v_bfe_u32 v144, v145, 2, 14
v_rcp_f16 v151, v150
s_setprio 0
v_fmac_f32 v159, v202, v202
v_lshrrev_b32 v145, 18, v145
v_fmac_f32 v159, v203, v203
v_rcp_f16 v148, v147
v_fmac_f32_e64 v159, v204, v204
ds_read_u16_d16 v144, v144
ds_read_u16_d16_hi v145, v145
v_or_b32_e64 v32, v136, v137
ds_read_b128 v[224:227], v248 offset:54272
v_mfma_f32_32x32x16_bf16 v[120:135], v[228:231], v[188:191], v[120:135]
v_or_b32_e64 v33, v138, v139
v_rcp_f16_sdwa v154, v153 dst_sel:WORD_1 dst_unused:UNUSED_PRESERVE src0_sel:WORD_1
v_fmac_f32 v159, v205, v205
s_waitcnt lgkmcnt(4)
v_or_b32 v34, v140, v141
v_fmac_f32 v159, v206, v206
v_rcp_f16_sdwa v151, v150 dst_sel:WORD_1 dst_unused:UNUSED_PRESERVE src0_sel:WORD_1
v_fmac_f32 v159, v207, v207
s_waitcnt lgkmcnt(3)
v_or_b32_e64 v35, v142, v143
v_rcp_f16_sdwa v148, v147 dst_sel:WORD_1 dst_unused:UNUSED_PRESERVE src0_sel:WORD_1
v_permlane32_swap_b32 v158, v159
s_waitcnt lgkmcnt(1)
v_or_b32_e64 v36, v144, v145
v_pk_mul_f16 v37, v155, v154
v_add_f32 v158, v158, v159
ds_write_b32 v255, v158 offset:7424
v_pk_mul_f16 v38, v152, v151
v_pk_mul_f16 v39, v149, v148
s_setprio 2
ds_read_b128 v[228:231], v248 offset:57344
v_mfma_f32_32x32x16_f16 v[192:207], v[32:35], v[240:243], 0
v_cvt_pkrtz_f16_f32 v137, v120, v121
v_cvt_pkrtz_f16_f32 v139, v122, v123
v_cvt_pkrtz_f16_f32 v141, v124, v125
v_cvt_pkrtz_f16_f32 v143, v126, v127
v_cvt_pkrtz_f16_f32 v145, v128, v129
v_mfma_f32_32x32x16_f16 v[192:207], v[36:39], v[244:247], v[192:207]
v_cvt_pk_f16_f32 v155, v130, v131
v_cvt_pk_f16_f32 v152, v132, v133
v_cvt_pk_f16_f32 v149, v134, v135
v_pk_fma_f16 v154, v155, v155, s48
v_and_b32_e64 v137, s49, v137
v_pk_fma_f16 v151, v152, v152, s48
v_mfma_f32_32x32x16_bf16 v[120:135], v[232:235], v[168:171], 0
v_and_b32 v139, s49, v139
v_pk_fma_f16 v148, v149, v149, s48
v_permlane16_swap_b32 v32, v36
v_pk_mul_f16 v154, v155, v154
v_bfe_u32 v136, v137, 2, 14
v_permlane16_swap_b32 v33, v37
v_pk_mul_f16 v151, v152, v151
v_pk_mul_f16 v148, v149, v148
v_bfe_u32 v138, v139, 2, 14
v_permlane16_swap_b32 v34, v38
ds_read_b128 v[232:235], v248 offset:55296
ds_read_u16_d16 v136, v136
ds_read_u16_d16 v138, v138
v_mfma_f32_32x32x16_bf16 v[120:135], v[236:239], v[172:175], v[120:135]
v_exp_f16 v153, v154
v_permlane16_swap_b32 v35, v39
v_lshrrev_b32 v137, 18, v137
v_exp_f16 v150, v151
v_fmac_f32 v160, v192, v192
v_lshrrev_b32 v139, 18, v139
v_exp_f16 v147, v148
v_fmac_f32 v160, v193, v193
v_and_b32 v141, s49, v141
s_waitcnt lgkmcnt(5)
ds_read_b128 v[236:239], v248 offset:58368
ds_read_u16_d16_hi v137, v137
ds_read_u16_d16_hi v139, v139
v_mfma_f32_32x32x16_bf16 v[120:135], v[224:227], v[176:179], v[120:135]
v_and_b32 v143, s49, v143
v_fmac_f32 v160, v194, v194
v_exp_f16_sdwa v153, v154 dst_sel:WORD_1 dst_unused:UNUSED_PRESERVE src0_sel:WORD_1
v_bfe_u32 v140, v141, 2, 14
v_fmac_f32_e64 v160, v195, v195
v_exp_f16_sdwa v150, v151 dst_sel:WORD_1 dst_unused:UNUSED_PRESERVE src0_sel:WORD_1
v_fmac_f32 v160, v196, v196
v_bfe_u32 v142, v143, 2, 14
s_waitcnt lgkmcnt(4)
ds_read_b128 v[224:227], v248 offset:59392
ds_read_u16_d16 v140, v140
ds_read_u16_d16 v142, v142
v_mfma_f32_32x32x16_bf16 v[120:135], v[228:231], v[180:183], v[120:135]
v_exp_f16_sdwa v147, v148 dst_sel:WORD_1 dst_unused:UNUSED_PRESERVE src0_sel:WORD_1
v_fmac_f32 v160, v197, v197
v_lshrrev_b32 v141, 18, v141
v_pk_add_f16 v153, v153, 1.0 op_sel_hi:[1,0]
v_lshrrev_b32 v143, 18, v143
v_fmac_f32 v160, v198, v198
v_pk_add_f16 v150, v150, 1.0 op_sel_hi:[1,0]
v_pk_add_f16 v147, v147, 1.0 op_sel_hi:[1,0]
v_fmac_f32 v160, v199, v199
v_and_b32 v145, s49, v145
ds_read_b128 v[228:231], v248 offset:62464
ds_read_u16_d16_hi v141, v141
ds_read_u16_d16_hi v143, v143
v_mfma_f32_32x32x16_bf16 v[120:135], v[232:235], v[184:187], v[120:135]
v_rcp_f16 v154, v153
v_fmac_f32 v160, v200, v200
v_bfe_u32 v144, v145, 2, 14
v_rcp_f16 v151, v150
v_fmac_f32 v160, v201, v201
v_lshrrev_b32 v145, 18, v145
v_rcp_f16 v148, v147
v_fmac_f32_e64 v160, v202, v202
ds_read_u16_d16 v144, v144
ds_read_u16_d16_hi v145, v145
s_waitcnt lgkmcnt(5)
v_or_b32 v40, v136, v137
ds_read_b128 v[232:235], v248 offset:60416
v_mfma_f32_32x32x16_bf16 v[120:135], v[236:239], v[188:191], v[120:135]
v_or_b32 v41, v138, v139
v_fmac_f32 v160, v203, v203
v_rcp_f16_sdwa v154, v153 dst_sel:WORD_1 dst_unused:UNUSED_PRESERVE src0_sel:WORD_1
v_fmac_f32 v160, v204, v204
s_waitcnt lgkmcnt(4)
v_or_b32_e64 v42, v140, v141
v_rcp_f16_sdwa v151, v150 dst_sel:WORD_1 dst_unused:UNUSED_PRESERVE src0_sel:WORD_1
v_fmac_f32 v160, v205, v205
s_waitcnt lgkmcnt(3)
v_or_b32_e64 v43, v142, v143
v_rcp_f16_sdwa v148, v147 dst_sel:WORD_1 dst_unused:UNUSED_PRESERVE src0_sel:WORD_1
v_fmac_f32 v160, v206, v206
s_waitcnt lgkmcnt(1)
v_or_b32_e64 v44, v144, v145
v_pk_mul_f16 v45, v155, v154
v_fmac_f32 v160, v207, v207
v_pk_mul_f16 v46, v152, v151
v_pk_mul_f16 v47, v149, v148
s_setprio 1
ds_read_b128 v[236:239], v248 offset:63488
v_mfma_f32_32x32x16_f16 v[192:207], v[40:43], v[240:243], 0
v_cvt_pkrtz_f16_f32 v137, v120, v121
v_cvt_pkrtz_f16_f32 v139, v122, v123
v_cvt_pkrtz_f16_f32 v141, v124, v125
v_cvt_pkrtz_f16_f32 v143, v126, v127
v_cvt_pkrtz_f16_f32 v145, v128, v129
v_mfma_f32_32x32x16_f16 v[192:207], v[44:47], v[244:247], v[192:207]
v_cvt_pk_f16_f32 v155, v130, v131
v_cvt_pk_f16_f32 v152, v132, v133
v_cvt_pk_f16_f32 v149, v134, v135
v_pk_fma_f16 v154, v155, v155, s48
v_and_b32_e64 v137, s49, v137
v_pk_fma_f16 v151, v152, v152, s48
v_mfma_f32_32x32x16_bf16 v[120:135], v[224:227], v[168:171], 0
v_and_b32 v139, s49, v139
v_pk_fma_f16 v148, v149, v149, s48
v_permlane16_swap_b32 v40, v44
v_pk_mul_f16 v154, v155, v154
v_bfe_u32 v136, v137, 2, 14
v_permlane16_swap_b32 v41, v45
v_pk_mul_f16 v151, v152, v151
v_pk_mul_f16 v148, v149, v148
v_permlane16_swap_b32 v42, v46
v_bfe_u32 v138, v139, 2, 14
ds_read_b128 v[224:227], v248 offset:61440
ds_read_u16_d16 v136, v136
ds_read_u16_d16 v138, v138
v_mfma_f32_32x32x16_bf16 v[120:135], v[228:231], v[172:175], v[120:135]
v_exp_f16 v153, v154
v_permlane16_swap_b32 v43, v47
v_lshrrev_b32 v137, 18, v137
v_exp_f16 v150, v151
v_fmac_f32 v161, v192, v192
v_lshrrev_b32 v139, 18, v139
v_fmac_f32 v161, v193, v193
v_exp_f16 v147, v148
v_and_b32_e64 v141, s49, v141
v_fmac_f32 v161, v194, v194
s_waitcnt lgkmcnt(3)
ds_read_b128 v[228:231], v248 offset:64512
ds_read_u16_d16_hi v137, v137
ds_read_u16_d16_hi v139, v139
v_mfma_f32_32x32x16_bf16 v[120:135], v[232:235], v[176:179], v[120:135]
v_and_b32_e64 v143, s49, v143
v_exp_f16_sdwa v153, v154 dst_sel:WORD_1 dst_unused:UNUSED_PRESERVE src0_sel:WORD_1
v_fmac_f32_e64 v161, v195, v195
v_bfe_u32 v140, v141, 2, 14
v_fmac_f32_e64 v161, v196, v196
v_exp_f16_sdwa v150, v151 dst_sel:WORD_1 dst_unused:UNUSED_PRESERVE src0_sel:WORD_1
v_bfe_u32 v142, v143, 2, 14
v_fmac_f32_e64 v161, v197, v197
ds_read_b128 v[232:235], v249
ds_read_u16_d16 v140, v140
ds_read_u16_d16 v142, v142
v_mfma_f32_32x32x16_bf16 v[120:135], v[236:239], v[180:183], v[120:135]
v_exp_f16_sdwa v147, v148 dst_sel:WORD_1 dst_unused:UNUSED_PRESERVE src0_sel:WORD_1
v_fmac_f32 v161, v198, v198
v_lshrrev_b32 v141, 18, v141
v_pk_add_f16 v153, v153, 1.0 op_sel_hi:[1,0]
v_lshrrev_b32 v143, 18, v143
v_fmac_f32 v161, v199, v199
v_pk_add_f16 v150, v150, 1.0 op_sel_hi:[1,0]
v_pk_add_f16 v147, v147, 1.0 op_sel_hi:[1,0]
v_fmac_f32 v161, v200, v200
v_and_b32 v145, s49, v145
v_rcp_f16 v154, v153
s_waitcnt lgkmcnt(3)
ds_read_b128 v[236:239], v249 offset:3072
ds_read_u16_d16_hi v141, v141
ds_read_u16_d16_hi v143, v143
v_mfma_f32_32x32x16_bf16 v[120:135], v[224:227], v[184:187], v[120:135]
v_fmac_f32_e64 v161, v201, v201
v_bfe_u32 v144, v145, 2, 14
v_rcp_f16 v151, v150
s_setprio 0
v_fmac_f32 v161, v202, v202
v_lshrrev_b32 v145, 18, v145
v_fmac_f32 v161, v203, v203
v_rcp_f16 v148, v147
v_fmac_f32_e64 v161, v204, v204
ds_read_u16_d16 v144, v144
ds_read_u16_d16_hi v145, v145
v_or_b32_e64 v48, v136, v137
ds_read_b128 v[224:227], v249 offset:1024
v_mfma_f32_32x32x16_bf16 v[120:135], v[228:231], v[188:191], v[120:135]
v_or_b32_e64 v49, v138, v139
v_rcp_f16_sdwa v154, v153 dst_sel:WORD_1 dst_unused:UNUSED_PRESERVE src0_sel:WORD_1
v_fmac_f32 v161, v205, v205
s_waitcnt lgkmcnt(4)
v_or_b32 v50, v140, v141
v_fmac_f32 v161, v206, v206
v_rcp_f16_sdwa v151, v150 dst_sel:WORD_1 dst_unused:UNUSED_PRESERVE src0_sel:WORD_1
v_fmac_f32 v161, v207, v207
s_waitcnt lgkmcnt(3)
v_or_b32_e64 v51, v142, v143
v_rcp_f16_sdwa v148, v147 dst_sel:WORD_1 dst_unused:UNUSED_PRESERVE src0_sel:WORD_1
v_permlane32_swap_b32 v160, v161
s_waitcnt lgkmcnt(1)
v_or_b32_e64 v52, v144, v145
v_pk_mul_f16 v53, v155, v154
v_add_f32 v160, v160, v161
ds_write_b32 v255, v160 offset:7680
v_pk_mul_f16 v54, v152, v151
v_pk_mul_f16 v55, v149, v148
s_setprio 2
ds_read_b128 v[228:231], v249 offset:4096
v_mfma_f32_32x32x16_f16 v[192:207], v[48:51], v[240:243], 0
v_cvt_pkrtz_f16_f32 v137, v120, v121
v_cvt_pkrtz_f16_f32 v139, v122, v123
v_cvt_pkrtz_f16_f32 v141, v124, v125
v_cvt_pkrtz_f16_f32 v143, v126, v127
v_cvt_pkrtz_f16_f32 v145, v128, v129
v_mfma_f32_32x32x16_f16 v[192:207], v[52:55], v[244:247], v[192:207]
v_cvt_pk_f16_f32 v155, v130, v131
v_cvt_pk_f16_f32 v152, v132, v133
v_cvt_pk_f16_f32 v149, v134, v135
v_pk_fma_f16 v154, v155, v155, s48
v_and_b32_e64 v137, s49, v137
v_pk_fma_f16 v151, v152, v152, s48
v_mfma_f32_32x32x16_bf16 v[120:135], v[232:235], v[168:171], 0
v_and_b32 v139, s49, v139
v_pk_fma_f16 v148, v149, v149, s48
v_permlane16_swap_b32 v48, v52
v_pk_mul_f16 v154, v155, v154
v_bfe_u32 v136, v137, 2, 14
v_permlane16_swap_b32 v49, v53
v_pk_mul_f16 v151, v152, v151
v_pk_mul_f16 v148, v149, v148
v_bfe_u32 v138, v139, 2, 14
v_permlane16_swap_b32 v50, v54
ds_read_b128 v[232:235], v249 offset:2048
ds_read_u16_d16 v136, v136
ds_read_u16_d16 v138, v138
v_mfma_f32_32x32x16_bf16 v[120:135], v[236:239], v[172:175], v[120:135]
v_exp_f16 v153, v154
v_permlane16_swap_b32 v51, v55
v_lshrrev_b32 v137, 18, v137
v_exp_f16 v150, v151
v_fmac_f32 v162, v192, v192
v_lshrrev_b32 v139, 18, v139
v_exp_f16 v147, v148
v_fmac_f32 v162, v193, v193
v_and_b32 v141, s49, v141
s_waitcnt lgkmcnt(5)
ds_read_b128 v[236:239], v249 offset:5120
ds_read_u16_d16_hi v137, v137
ds_read_u16_d16_hi v139, v139
v_mfma_f32_32x32x16_bf16 v[120:135], v[224:227], v[176:179], v[120:135]
v_and_b32 v143, s49, v143
v_fmac_f32 v162, v194, v194
v_exp_f16_sdwa v153, v154 dst_sel:WORD_1 dst_unused:UNUSED_PRESERVE src0_sel:WORD_1
v_bfe_u32 v140, v141, 2, 14
v_fmac_f32_e64 v162, v195, v195
v_exp_f16_sdwa v150, v151 dst_sel:WORD_1 dst_unused:UNUSED_PRESERVE src0_sel:WORD_1
v_fmac_f32 v162, v196, v196
v_bfe_u32 v142, v143, 2, 14
s_waitcnt lgkmcnt(4)
ds_read_b128 v[224:227], v249 offset:6144
ds_read_u16_d16 v140, v140
ds_read_u16_d16 v142, v142
v_mfma_f32_32x32x16_bf16 v[120:135], v[228:231], v[180:183], v[120:135]
v_exp_f16_sdwa v147, v148 dst_sel:WORD_1 dst_unused:UNUSED_PRESERVE src0_sel:WORD_1
v_fmac_f32 v162, v197, v197
v_lshrrev_b32 v141, 18, v141
v_pk_add_f16 v153, v153, 1.0 op_sel_hi:[1,0]
v_lshrrev_b32 v143, 18, v143
v_fmac_f32 v162, v198, v198
v_pk_add_f16 v150, v150, 1.0 op_sel_hi:[1,0]
v_pk_add_f16 v147, v147, 1.0 op_sel_hi:[1,0]
v_fmac_f32 v162, v199, v199
v_and_b32 v145, s49, v145
ds_read_b128 v[228:231], v249 offset:9216
ds_read_u16_d16_hi v141, v141
ds_read_u16_d16_hi v143, v143
v_mfma_f32_32x32x16_bf16 v[120:135], v[232:235], v[184:187], v[120:135]
v_rcp_f16 v154, v153
v_fmac_f32 v162, v200, v200
v_bfe_u32 v144, v145, 2, 14
v_rcp_f16 v151, v150
v_fmac_f32 v162, v201, v201
v_lshrrev_b32 v145, 18, v145
v_rcp_f16 v148, v147
v_fmac_f32_e64 v162, v202, v202
ds_read_u16_d16 v144, v144
ds_read_u16_d16_hi v145, v145
s_waitcnt lgkmcnt(5)
v_or_b32 v56, v136, v137
ds_read_b128 v[232:235], v249 offset:7168
v_mfma_f32_32x32x16_bf16 v[120:135], v[236:239], v[188:191], v[120:135]
v_or_b32 v57, v138, v139
v_fmac_f32 v162, v203, v203
v_rcp_f16_sdwa v154, v153 dst_sel:WORD_1 dst_unused:UNUSED_PRESERVE src0_sel:WORD_1
v_fmac_f32 v162, v204, v204
s_waitcnt lgkmcnt(4)
v_or_b32_e64 v58, v140, v141
v_rcp_f16_sdwa v151, v150 dst_sel:WORD_1 dst_unused:UNUSED_PRESERVE src0_sel:WORD_1
v_fmac_f32 v162, v205, v205
s_waitcnt lgkmcnt(3)
v_or_b32_e64 v59, v142, v143
v_rcp_f16_sdwa v148, v147 dst_sel:WORD_1 dst_unused:UNUSED_PRESERVE src0_sel:WORD_1
v_fmac_f32 v162, v206, v206
s_waitcnt lgkmcnt(1)
v_or_b32_e64 v60, v144, v145
v_pk_mul_f16 v61, v155, v154
v_fmac_f32 v162, v207, v207
v_pk_mul_f16 v62, v152, v151
v_pk_mul_f16 v63, v149, v148
s_setprio 1
ds_read_b128 v[236:239], v249 offset:10240
v_mfma_f32_32x32x16_f16 v[192:207], v[56:59], v[240:243], 0
v_cvt_pkrtz_f16_f32 v137, v120, v121
v_cvt_pkrtz_f16_f32 v139, v122, v123
v_cvt_pkrtz_f16_f32 v141, v124, v125
v_cvt_pkrtz_f16_f32 v143, v126, v127
v_cvt_pkrtz_f16_f32 v145, v128, v129
v_mfma_f32_32x32x16_f16 v[192:207], v[60:63], v[244:247], v[192:207]
v_cvt_pk_f16_f32 v155, v130, v131
v_cvt_pk_f16_f32 v152, v132, v133
v_cvt_pk_f16_f32 v149, v134, v135
v_pk_fma_f16 v154, v155, v155, s48
v_and_b32_e64 v137, s49, v137
v_pk_fma_f16 v151, v152, v152, s48
v_mfma_f32_32x32x16_bf16 v[120:135], v[224:227], v[168:171], 0
v_and_b32 v139, s49, v139
v_pk_fma_f16 v148, v149, v149, s48
v_permlane16_swap_b32 v56, v60
v_pk_mul_f16 v154, v155, v154
v_bfe_u32 v136, v137, 2, 14
v_permlane16_swap_b32 v57, v61
v_pk_mul_f16 v151, v152, v151
v_pk_mul_f16 v148, v149, v148
v_permlane16_swap_b32 v58, v62
v_bfe_u32 v138, v139, 2, 14
ds_read_b128 v[224:227], v249 offset:8192
ds_read_u16_d16 v136, v136
ds_read_u16_d16 v138, v138
v_mfma_f32_32x32x16_bf16 v[120:135], v[228:231], v[172:175], v[120:135]
v_exp_f16 v153, v154
v_permlane16_swap_b32 v59, v63
v_lshrrev_b32 v137, 18, v137
v_exp_f16 v150, v151
v_fmac_f32 v163, v192, v192
v_lshrrev_b32 v139, 18, v139
v_fmac_f32 v163, v193, v193
v_exp_f16 v147, v148
v_and_b32_e64 v141, s49, v141
v_fmac_f32 v163, v194, v194
s_waitcnt lgkmcnt(3)
ds_read_b128 v[228:231], v249 offset:11264
ds_read_u16_d16_hi v137, v137
ds_read_u16_d16_hi v139, v139
v_mfma_f32_32x32x16_bf16 v[120:135], v[232:235], v[176:179], v[120:135]
v_and_b32_e64 v143, s49, v143
v_exp_f16_sdwa v153, v154 dst_sel:WORD_1 dst_unused:UNUSED_PRESERVE src0_sel:WORD_1
v_fmac_f32_e64 v163, v195, v195
v_bfe_u32 v140, v141, 2, 14
v_fmac_f32_e64 v163, v196, v196
v_exp_f16_sdwa v150, v151 dst_sel:WORD_1 dst_unused:UNUSED_PRESERVE src0_sel:WORD_1
v_bfe_u32 v142, v143, 2, 14
v_fmac_f32_e64 v163, v197, v197
ds_read_b128 v[232:235], v249 offset:12288
ds_read_u16_d16 v140, v140
ds_read_u16_d16 v142, v142
v_mfma_f32_32x32x16_bf16 v[120:135], v[236:239], v[180:183], v[120:135]
v_exp_f16_sdwa v147, v148 dst_sel:WORD_1 dst_unused:UNUSED_PRESERVE src0_sel:WORD_1
v_fmac_f32 v163, v198, v198
v_lshrrev_b32 v141, 18, v141
v_pk_add_f16 v153, v153, 1.0 op_sel_hi:[1,0]
v_lshrrev_b32 v143, 18, v143
v_fmac_f32 v163, v199, v199
v_pk_add_f16 v150, v150, 1.0 op_sel_hi:[1,0]
v_pk_add_f16 v147, v147, 1.0 op_sel_hi:[1,0]
v_fmac_f32 v163, v200, v200
v_and_b32 v145, s49, v145
v_rcp_f16 v154, v153
s_waitcnt lgkmcnt(3)
ds_read_b128 v[236:239], v249 offset:15360
ds_read_u16_d16_hi v141, v141
ds_read_u16_d16_hi v143, v143
v_mfma_f32_32x32x16_bf16 v[120:135], v[224:227], v[184:187], v[120:135]
v_fmac_f32_e64 v163, v201, v201
v_bfe_u32 v144, v145, 2, 14
v_rcp_f16 v151, v150
s_setprio 0
v_fmac_f32 v163, v202, v202
v_lshrrev_b32 v145, 18, v145
v_fmac_f32 v163, v203, v203
v_rcp_f16 v148, v147
v_fmac_f32_e64 v163, v204, v204
ds_read_u16_d16 v144, v144
ds_read_u16_d16_hi v145, v145
v_or_b32_e64 v64, v136, v137
ds_read_b128 v[224:227], v249 offset:13312
v_mfma_f32_32x32x16_bf16 v[120:135], v[228:231], v[188:191], v[120:135]
v_or_b32_e64 v65, v138, v139
v_rcp_f16_sdwa v154, v153 dst_sel:WORD_1 dst_unused:UNUSED_PRESERVE src0_sel:WORD_1
v_fmac_f32 v163, v205, v205
s_waitcnt lgkmcnt(4)
v_or_b32 v66, v140, v141
v_fmac_f32 v163, v206, v206
v_rcp_f16_sdwa v151, v150 dst_sel:WORD_1 dst_unused:UNUSED_PRESERVE src0_sel:WORD_1
v_fmac_f32 v163, v207, v207
s_waitcnt lgkmcnt(3)
v_or_b32_e64 v67, v142, v143
v_rcp_f16_sdwa v148, v147 dst_sel:WORD_1 dst_unused:UNUSED_PRESERVE src0_sel:WORD_1
v_permlane32_swap_b32 v162, v163
s_waitcnt lgkmcnt(1)
v_or_b32_e64 v68, v144, v145
v_pk_mul_f16 v69, v155, v154
v_add_f32 v162, v162, v163
ds_write_b32 v255, v162 offset:7936
v_pk_mul_f16 v70, v152, v151
v_pk_mul_f16 v71, v149, v148
s_setprio 2
ds_read_b128 v[228:231], v249 offset:16384
v_mfma_f32_32x32x16_f16 v[192:207], v[64:67], v[240:243], 0
v_cvt_pkrtz_f16_f32 v137, v120, v121
v_cvt_pkrtz_f16_f32 v139, v122, v123
v_cvt_pkrtz_f16_f32 v141, v124, v125
v_cvt_pkrtz_f16_f32 v143, v126, v127
v_cvt_pkrtz_f16_f32 v145, v128, v129
v_mfma_f32_32x32x16_f16 v[192:207], v[68:71], v[244:247], v[192:207]
v_cvt_pk_f16_f32 v155, v130, v131
v_cvt_pk_f16_f32 v152, v132, v133
v_cvt_pk_f16_f32 v149, v134, v135
v_pk_fma_f16 v154, v155, v155, s48
v_and_b32_e64 v137, s49, v137
v_pk_fma_f16 v151, v152, v152, s48
v_mfma_f32_32x32x16_bf16 v[120:135], v[232:235], v[168:171], 0
v_and_b32 v139, s49, v139
v_pk_fma_f16 v148, v149, v149, s48
v_permlane16_swap_b32 v64, v68
v_pk_mul_f16 v154, v155, v154
v_bfe_u32 v136, v137, 2, 14
v_permlane16_swap_b32 v65, v69
v_pk_mul_f16 v151, v152, v151
v_pk_mul_f16 v148, v149, v148
v_bfe_u32 v138, v139, 2, 14
v_permlane16_swap_b32 v66, v70
ds_read_b128 v[232:235], v249 offset:14336
ds_read_u16_d16 v136, v136
ds_read_u16_d16 v138, v138
v_mfma_f32_32x32x16_bf16 v[120:135], v[236:239], v[172:175], v[120:135]
v_exp_f16 v153, v154
v_permlane16_swap_b32 v67, v71
v_lshrrev_b32 v137, 18, v137
v_exp_f16 v150, v151
v_fmac_f32 v164, v192, v192
v_lshrrev_b32 v139, 18, v139
v_exp_f16 v147, v148
v_fmac_f32 v164, v193, v193
v_and_b32 v141, s49, v141
s_waitcnt lgkmcnt(5)
ds_read_b128 v[236:239], v249 offset:17408
ds_read_u16_d16_hi v137, v137
ds_read_u16_d16_hi v139, v139
v_mfma_f32_32x32x16_bf16 v[120:135], v[224:227], v[176:179], v[120:135]
v_and_b32 v143, s49, v143
v_fmac_f32 v164, v194, v194
v_exp_f16_sdwa v153, v154 dst_sel:WORD_1 dst_unused:UNUSED_PRESERVE src0_sel:WORD_1
v_bfe_u32 v140, v141, 2, 14
v_fmac_f32_e64 v164, v195, v195
v_exp_f16_sdwa v150, v151 dst_sel:WORD_1 dst_unused:UNUSED_PRESERVE src0_sel:WORD_1
v_fmac_f32 v164, v196, v196
v_bfe_u32 v142, v143, 2, 14
s_waitcnt lgkmcnt(4)
ds_read_b128 v[224:227], v249 offset:18432
ds_read_u16_d16 v140, v140
ds_read_u16_d16 v142, v142
v_mfma_f32_32x32x16_bf16 v[120:135], v[228:231], v[180:183], v[120:135]
v_exp_f16_sdwa v147, v148 dst_sel:WORD_1 dst_unused:UNUSED_PRESERVE src0_sel:WORD_1
v_fmac_f32 v164, v197, v197
v_lshrrev_b32 v141, 18, v141
v_pk_add_f16 v153, v153, 1.0 op_sel_hi:[1,0]
v_lshrrev_b32 v143, 18, v143
v_fmac_f32 v164, v198, v198
v_pk_add_f16 v150, v150, 1.0 op_sel_hi:[1,0]
v_pk_add_f16 v147, v147, 1.0 op_sel_hi:[1,0]
v_fmac_f32 v164, v199, v199
v_and_b32 v145, s49, v145
ds_read_b128 v[228:231], v249 offset:21504
ds_read_u16_d16_hi v141, v141
ds_read_u16_d16_hi v143, v143
v_mfma_f32_32x32x16_bf16 v[120:135], v[232:235], v[184:187], v[120:135]
v_rcp_f16 v154, v153
v_fmac_f32 v164, v200, v200
v_bfe_u32 v144, v145, 2, 14
v_rcp_f16 v151, v150
v_fmac_f32 v164, v201, v201
v_lshrrev_b32 v145, 18, v145
v_rcp_f16 v148, v147
v_fmac_f32_e64 v164, v202, v202
ds_read_u16_d16 v144, v144
ds_read_u16_d16_hi v145, v145
s_waitcnt lgkmcnt(5)
v_or_b32 v72, v136, v137
ds_read_b128 v[232:235], v249 offset:19456
v_mfma_f32_32x32x16_bf16 v[120:135], v[236:239], v[188:191], v[120:135]
v_or_b32 v73, v138, v139
v_fmac_f32 v164, v203, v203
v_rcp_f16_sdwa v154, v153 dst_sel:WORD_1 dst_unused:UNUSED_PRESERVE src0_sel:WORD_1
v_fmac_f32 v164, v204, v204
s_waitcnt lgkmcnt(4)
v_or_b32_e64 v74, v140, v141
v_rcp_f16_sdwa v151, v150 dst_sel:WORD_1 dst_unused:UNUSED_PRESERVE src0_sel:WORD_1
v_fmac_f32 v164, v205, v205
s_waitcnt lgkmcnt(3)
v_or_b32_e64 v75, v142, v143
v_rcp_f16_sdwa v148, v147 dst_sel:WORD_1 dst_unused:UNUSED_PRESERVE src0_sel:WORD_1
v_fmac_f32 v164, v206, v206
s_waitcnt lgkmcnt(1)
v_or_b32_e64 v76, v144, v145
v_pk_mul_f16 v77, v155, v154
v_fmac_f32 v164, v207, v207
v_pk_mul_f16 v78, v152, v151
v_pk_mul_f16 v79, v149, v148
s_setprio 1
ds_read_b128 v[236:239], v249 offset:22528
v_mfma_f32_32x32x16_f16 v[192:207], v[72:75], v[240:243], 0
v_cvt_pkrtz_f16_f32 v137, v120, v121
v_cvt_pkrtz_f16_f32 v139, v122, v123
v_cvt_pkrtz_f16_f32 v141, v124, v125
v_cvt_pkrtz_f16_f32 v143, v126, v127
v_cvt_pkrtz_f16_f32 v145, v128, v129
v_mfma_f32_32x32x16_f16 v[192:207], v[76:79], v[244:247], v[192:207]
v_cvt_pk_f16_f32 v155, v130, v131
v_cvt_pk_f16_f32 v152, v132, v133
v_cvt_pk_f16_f32 v149, v134, v135
v_pk_fma_f16 v154, v155, v155, s48
v_and_b32_e64 v137, s49, v137
v_pk_fma_f16 v151, v152, v152, s48
v_mfma_f32_32x32x16_bf16 v[120:135], v[224:227], v[168:171], 0
v_and_b32 v139, s49, v139
v_pk_fma_f16 v148, v149, v149, s48
v_permlane16_swap_b32 v72, v76
v_pk_mul_f16 v154, v155, v154
v_bfe_u32 v136, v137, 2, 14
v_permlane16_swap_b32 v73, v77
v_pk_mul_f16 v151, v152, v151
v_pk_mul_f16 v148, v149, v148
v_permlane16_swap_b32 v74, v78
v_bfe_u32 v138, v139, 2, 14
ds_read_b128 v[224:227], v249 offset:20480
ds_read_u16_d16 v136, v136
ds_read_u16_d16 v138, v138
v_mfma_f32_32x32x16_bf16 v[120:135], v[228:231], v[172:175], v[120:135]
v_exp_f16 v153, v154
v_permlane16_swap_b32 v75, v79
v_lshrrev_b32 v137, 18, v137
v_exp_f16 v150, v151
v_fmac_f32 v165, v192, v192
v_lshrrev_b32 v139, 18, v139
v_fmac_f32 v165, v193, v193
v_exp_f16 v147, v148
v_and_b32_e64 v141, s49, v141
v_fmac_f32 v165, v194, v194
s_waitcnt lgkmcnt(3)
ds_read_b128 v[228:231], v249 offset:23552
ds_read_u16_d16_hi v137, v137
ds_read_u16_d16_hi v139, v139
v_mfma_f32_32x32x16_bf16 v[120:135], v[232:235], v[176:179], v[120:135]
v_and_b32_e64 v143, s49, v143
v_exp_f16_sdwa v153, v154 dst_sel:WORD_1 dst_unused:UNUSED_PRESERVE src0_sel:WORD_1
v_fmac_f32_e64 v165, v195, v195
v_bfe_u32 v140, v141, 2, 14
v_fmac_f32_e64 v165, v196, v196
v_exp_f16_sdwa v150, v151 dst_sel:WORD_1 dst_unused:UNUSED_PRESERVE src0_sel:WORD_1
v_bfe_u32 v142, v143, 2, 14
v_fmac_f32_e64 v165, v197, v197
ds_read_b128 v[232:235], v248 offset:40960
ds_read_u16_d16 v140, v140
ds_read_u16_d16 v142, v142
v_mfma_f32_32x32x16_bf16 v[120:135], v[236:239], v[180:183], v[120:135]
v_exp_f16_sdwa v147, v148 dst_sel:WORD_1 dst_unused:UNUSED_PRESERVE src0_sel:WORD_1
v_fmac_f32 v165, v198, v198
v_lshrrev_b32 v141, 18, v141
v_pk_add_f16 v153, v153, 1.0 op_sel_hi:[1,0]
v_lshrrev_b32 v143, 18, v143
v_fmac_f32 v165, v199, v199
v_pk_add_f16 v150, v150, 1.0 op_sel_hi:[1,0]
v_pk_add_f16 v147, v147, 1.0 op_sel_hi:[1,0]
v_fmac_f32 v165, v200, v200
v_and_b32 v145, s49, v145
v_rcp_f16 v154, v153
s_waitcnt lgkmcnt(3)
ds_read_b128 v[236:239], v248 offset:44032
ds_read_u16_d16_hi v141, v141
ds_read_u16_d16_hi v143, v143
v_mfma_f32_32x32x16_bf16 v[120:135], v[224:227], v[184:187], v[120:135]
v_fmac_f32_e64 v165, v201, v201
v_bfe_u32 v144, v145, 2, 14
v_rcp_f16 v151, v150
s_setprio 0
v_fmac_f32 v165, v202, v202
v_lshrrev_b32 v145, 18, v145
v_fmac_f32 v165, v203, v203
v_rcp_f16 v148, v147
v_fmac_f32_e64 v165, v204, v204
ds_read_u16_d16 v144, v144
ds_read_u16_d16_hi v145, v145
v_or_b32_e64 v80, v136, v137
ds_read_b128 v[224:227], v248 offset:41984
v_mfma_f32_32x32x16_bf16 v[120:135], v[228:231], v[188:191], v[120:135]
v_or_b32_e64 v81, v138, v139
v_rcp_f16_sdwa v154, v153 dst_sel:WORD_1 dst_unused:UNUSED_PRESERVE src0_sel:WORD_1
v_fmac_f32 v165, v205, v205
s_waitcnt lgkmcnt(4)
v_or_b32 v82, v140, v141
v_fmac_f32 v165, v206, v206
v_rcp_f16_sdwa v151, v150 dst_sel:WORD_1 dst_unused:UNUSED_PRESERVE src0_sel:WORD_1
v_fmac_f32 v165, v207, v207
s_waitcnt lgkmcnt(3)
v_or_b32_e64 v83, v142, v143
v_rcp_f16_sdwa v148, v147 dst_sel:WORD_1 dst_unused:UNUSED_PRESERVE src0_sel:WORD_1
v_permlane32_swap_b32 v164, v165
s_waitcnt lgkmcnt(1)
v_or_b32_e64 v84, v144, v145
v_pk_mul_f16 v85, v155, v154
v_add_f32 v164, v164, v165
ds_write_b32 v255, v164 offset:8192
v_pk_mul_f16 v86, v152, v151
v_pk_mul_f16 v87, v149, v148
s_setprio 2
ds_read_b128 v[228:231], v248 offset:45056
v_mfma_f32_32x32x16_f16 v[192:207], v[80:83], v[240:243], 0
v_cvt_pkrtz_f16_f32 v137, v120, v121
v_cvt_pkrtz_f16_f32 v139, v122, v123
v_cvt_pkrtz_f16_f32 v141, v124, v125
v_cvt_pkrtz_f16_f32 v143, v126, v127
v_cvt_pkrtz_f16_f32 v145, v128, v129
v_mfma_f32_32x32x16_f16 v[192:207], v[84:87], v[244:247], v[192:207]
v_cvt_pk_f16_f32 v155, v130, v131
v_cvt_pk_f16_f32 v152, v132, v133
v_cvt_pk_f16_f32 v149, v134, v135
v_pk_fma_f16 v154, v155, v155, s48
v_and_b32_e64 v137, s49, v137
v_pk_fma_f16 v151, v152, v152, s48
v_mfma_f32_32x32x16_bf16 v[120:135], v[232:235], v[96:99], 0
v_and_b32 v139, s49, v139
v_pk_fma_f16 v148, v149, v149, s48
v_permlane16_swap_b32 v80, v84
v_pk_mul_f16 v154, v155, v154
v_bfe_u32 v136, v137, 2, 14
v_permlane16_swap_b32 v81, v85
v_pk_mul_f16 v151, v152, v151
v_pk_mul_f16 v148, v149, v148
v_bfe_u32 v138, v139, 2, 14
v_permlane16_swap_b32 v82, v86
ds_read_b128 v[232:235], v248 offset:43008
ds_read_u16_d16 v136, v136
ds_read_u16_d16 v138, v138
v_mfma_f32_32x32x16_bf16 v[120:135], v[236:239], v[100:103], v[120:135]
v_exp_f16 v153, v154
v_permlane16_swap_b32 v83, v87
v_lshrrev_b32 v137, 18, v137
v_exp_f16 v150, v151
v_fmac_f32 v166, v192, v192
v_lshrrev_b32 v139, 18, v139
v_exp_f16 v147, v148
v_fmac_f32 v166, v193, v193
v_and_b32 v141, s49, v141
s_waitcnt lgkmcnt(5)
ds_read_b128 v[236:239], v248 offset:46080
ds_read_u16_d16_hi v137, v137
ds_read_u16_d16_hi v139, v139
v_mfma_f32_32x32x16_bf16 v[120:135], v[224:227], v[104:107], v[120:135]
v_and_b32 v143, s49, v143
v_fmac_f32 v166, v194, v194
v_exp_f16_sdwa v153, v154 dst_sel:WORD_1 dst_unused:UNUSED_PRESERVE src0_sel:WORD_1
v_bfe_u32 v140, v141, 2, 14
v_fmac_f32_e64 v166, v195, v195
v_exp_f16_sdwa v150, v151 dst_sel:WORD_1 dst_unused:UNUSED_PRESERVE src0_sel:WORD_1
v_fmac_f32 v166, v196, v196
v_bfe_u32 v142, v143, 2, 14
s_waitcnt lgkmcnt(4)
ds_read_b128 v[224:227], v248 offset:47104
ds_read_u16_d16 v140, v140
ds_read_u16_d16 v142, v142
v_mfma_f32_32x32x16_bf16 v[120:135], v[228:231], v[108:111], v[120:135]
v_exp_f16_sdwa v147, v148 dst_sel:WORD_1 dst_unused:UNUSED_PRESERVE src0_sel:WORD_1
v_fmac_f32 v166, v197, v197
v_lshrrev_b32 v141, 18, v141
v_pk_add_f16 v153, v153, 1.0 op_sel_hi:[1,0]
v_lshrrev_b32 v143, 18, v143
v_fmac_f32 v166, v198, v198
v_pk_add_f16 v150, v150, 1.0 op_sel_hi:[1,0]
v_pk_add_f16 v147, v147, 1.0 op_sel_hi:[1,0]
v_fmac_f32 v166, v199, v199
v_and_b32 v145, s49, v145
ds_read_b128 v[228:231], v248 offset:50176
ds_read_u16_d16_hi v141, v141
ds_read_u16_d16_hi v143, v143
v_mfma_f32_32x32x16_bf16 v[120:135], v[232:235], v[112:115], v[120:135]
v_rcp_f16 v154, v153
v_fmac_f32 v166, v200, v200
v_bfe_u32 v144, v145, 2, 14
v_rcp_f16 v151, v150
v_fmac_f32 v166, v201, v201
v_lshrrev_b32 v145, 18, v145
v_rcp_f16 v148, v147
v_fmac_f32_e64 v166, v202, v202
ds_read_u16_d16 v144, v144
ds_read_u16_d16_hi v145, v145
s_waitcnt lgkmcnt(5)
v_or_b32 v88, v136, v137
ds_read_b128 v[232:235], v248 offset:48128
v_mfma_f32_32x32x16_bf16 v[120:135], v[236:239], v[116:119], v[120:135]
v_or_b32 v89, v138, v139
v_fmac_f32 v166, v203, v203
v_rcp_f16_sdwa v154, v153 dst_sel:WORD_1 dst_unused:UNUSED_PRESERVE src0_sel:WORD_1
v_fmac_f32 v166, v204, v204
s_waitcnt lgkmcnt(4)
v_or_b32_e64 v90, v140, v141
v_rcp_f16_sdwa v151, v150 dst_sel:WORD_1 dst_unused:UNUSED_PRESERVE src0_sel:WORD_1
v_fmac_f32 v166, v205, v205
s_waitcnt lgkmcnt(3)
v_or_b32_e64 v91, v142, v143
v_rcp_f16_sdwa v148, v147 dst_sel:WORD_1 dst_unused:UNUSED_PRESERVE src0_sel:WORD_1
v_fmac_f32 v166, v206, v206
s_waitcnt lgkmcnt(1)
v_or_b32_e64 v92, v144, v145
v_pk_mul_f16 v93, v155, v154
v_fmac_f32 v166, v207, v207
v_pk_mul_f16 v94, v152, v151
v_pk_mul_f16 v95, v149, v148
s_setprio 1
ds_read_b128 v[236:239], v248 offset:51200
v_mfma_f32_32x32x16_f16 v[192:207], v[88:91], v[240:243], 0
v_cvt_pkrtz_f16_f32 v137, v120, v121
v_cvt_pkrtz_f16_f32 v139, v122, v123
v_cvt_pkrtz_f16_f32 v141, v124, v125
v_cvt_pkrtz_f16_f32 v143, v126, v127
v_cvt_pkrtz_f16_f32 v145, v128, v129
v_mfma_f32_32x32x16_f16 v[192:207], v[92:95], v[244:247], v[192:207]
v_cvt_pk_f16_f32 v155, v130, v131
v_cvt_pk_f16_f32 v152, v132, v133
v_cvt_pk_f16_f32 v149, v134, v135
v_pk_fma_f16 v154, v155, v155, s48
v_and_b32_e64 v137, s49, v137
v_pk_fma_f16 v151, v152, v152, s48
v_mfma_f32_32x32x16_bf16 v[120:135], v[224:227], v[96:99], 0
v_and_b32 v139, s49, v139
v_permlane16_swap_b32 v88, v92
v_permlane16_swap_b32 v89, v93
v_permlane16_swap_b32 v90, v94
v_permlane16_swap_b32 v91, v95
v_fmac_f32 v167, v192, v192
v_fmac_f32 v167, v193, v193
v_fmac_f32 v167, v194, v194
v_fmac_f32 v167, v195, v195
v_fmac_f32 v167, v196, v196
v_fmac_f32_e64 v167, v197, v197
ds_read_b128 v[224:227], v248 offset:49152
v_mfma_f32_32x32x16_bf16 v[120:135], v[228:231], v[100:103], v[120:135]
v_fmac_f32 v167, v198, v198
v_fmac_f32 v167, v199, v199
v_fmac_f32 v167, v200, v200
v_fmac_f32 v167, v201, v201
v_fmac_f32 v167, v202, v202
v_fmac_f32 v167, v203, v203
v_fmac_f32 v167, v204, v204
v_fmac_f32 v167, v205, v205
v_fmac_f32 v167, v206, v206
v_fmac_f32 v167, v207, v207
s_nop 1
v_permlane32_swap_b32 v166, v167
v_add_f32_e64 v166, v166, v167
ds_write_b32 v255, v166 offset:8448
s_setprio 3
s_mov_b64 exec, 1
ds_add_rtn_u32 v242, v253, v254
s_mov_b64 exec, -1
s_waitcnt lgkmcnt(0)
v_readfirstlane_b32 s43, v242
s_nop 1
s_cmp_lg_u32 s43, 7
s_cbranch_scc1 Lnopub
v_min_u32 v243, 47, v251
v_lshlrev_b32 v244, 5, v243
v_add_u32 v244, 97280, v244
ds_read_b128 v[168:171], v244
ds_read_b128 v[172:175], v244 offset:16
ds_read_b128 v[176:179], v244 offset:9216
ds_read_b128 v[180:183], v244 offset:9232
ds_read_b128 v[184:187], v244 offset:18432
ds_read_b128 v[188:191], v244 offset:18448
ds_read_b128 v[192:195], v244 offset:27648
ds_read_b128 v[196:199], v244 offset:27664
ds_read_b128 v[200:203], v244 offset:36864
ds_read_b128 v[204:207], v244 offset:36880
ds_read_b128 v[156:159], v244 offset:46080
ds_read_b128 v[160:163], v244 offset:46096
v_lshlrev_b32_e64 v246, 13, v243
v_add_u32 v247, 4096, v246
s_waitcnt lgkmcnt(9)
v_add_f32 v168, v168, v176
v_add_f32 v169, v169, v177
v_add_f32 v170, v170, v178
v_add_f32 v171, v171, v179
s_waitcnt lgkmcnt(8)
v_add_f32 v172, v172, v180
v_add_f32 v173, v173, v181
v_add_f32 v174, v174, v182
v_add_f32 v175, v175, v183
ds_read_b128 v[176:179], v244 offset:55296
ds_read_b128 v[180:183], v244 offset:55312
s_waitcnt lgkmcnt(7)
v_add_f32 v184, v184, v192
v_add_f32 v185, v185, v193
v_add_f32 v186, v186, v194
v_add_f32 v187, v187, v195
s_waitcnt lgkmcnt(6)
v_add_f32 v188, v188, v196
v_add_f32 v189, v189, v197
v_add_f32 v190, v190, v198
v_add_f32 v191, v191, v199
ds_read_b128 v[192:195], v244 offset:64512
ds_read_b128 v[196:199], v244 offset:64528
s_waitcnt lgkmcnt(5)
v_add_f32 v200, v200, v156
v_add_f32 v201, v201, v157
v_add_f32 v202, v202, v158
v_add_f32 v203, v203, v159
s_waitcnt lgkmcnt(4)
v_add_f32 v204, v204, v160
v_add_f32 v205, v205, v161
v_add_f32 v206, v206, v162
v_add_f32 v207, v207, v163
v_add_f32 v168, v168, v184
v_add_f32 v169, v169, v185
v_add_f32 v170, v170, v186
v_add_f32 v171, v171, v187
v_add_f32 v172, v172, v188
v_add_f32 v173, v173, v189
v_add_f32 v174, v174, v190
v_add_f32 v175, v175, v191
s_waitcnt lgkmcnt(1)
v_add_f32 v176, v176, v192
v_add_f32 v177, v177, v193
v_add_f32 v178, v178, v194
v_add_f32 v179, v179, v195
s_waitcnt lgkmcnt(0)
v_add_f32 v180, v180, v196
v_add_f32 v181, v181, v197
v_add_f32 v182, v182, v198
v_add_f32 v183, v183, v199
v_add_f32 v200, v200, v176
v_add_f32 v201, v201, v177
v_add_f32 v202, v202, v178
v_add_f32 v203, v203, v179
v_add_f32 v204, v204, v180
v_add_f32 v205, v205, v181
v_add_f32 v206, v206, v182
v_add_f32 v207, v207, v183
v_add_f32 v168, v168, v200
v_add_f32 v169, v169, v201
v_add_f32 v170, v170, v202
v_add_f32 v171, v171, v203
v_add_f32 v172, v172, v204
v_add_f32 v173, v173, v205
v_add_f32 v174, v174, v206
v_add_f32 v175, v175, v207
v_min_u32 v176, -2, v168
v_min_u32 v177, -2, v169
v_min_u32 v178, -2, v170
v_min_u32 v179, -2, v171
v_min_u32 v180, -2, v172
v_min_u32 v181, -2, v173
v_min_u32_e64 v182, -2, v174
v_min_u32 v183, -2, v175
s_lshl_b32 s43, s2, 4
buffer_store_dwordx4 v[176:179], v246, s[32:35], s43 offen sc1
buffer_store_dwordx4 v[180:183], v247, s[32:35], s43 offen sc1
ds_write_b32 v253, v254 offset:4
s_nop 1
Lnopub:
s_mov_b32 s77, 0
s_cmp_lg_u32 s40, 0
s_cbranch_scc1 Lnorole
v_lshlrev_b32_e64 v247, 2, v251
buffer_load_dword v244, v247, s[24:27], 0 offen offset:0
buffer_load_dword v245, v247, s[24:27], 0 offen offset:256
buffer_load_dword v246, v247, s[24:27], 0 offen offset:512
s_cmp_lt_u32 s2, 96
s_cselect_b32 s77, 1, 2
s_waitcnt lgkmcnt(0)
v_mov_b32 v156, -1
v_mov_b32 v157, -1
v_mov_b32 v158, -1
v_mov_b32 v159, -1
v_mov_b32 v160, -1
v_mov_b32 v161, -1
v_mov_b32 v162, -1
v_mov_b32 v163, -1
v_mov_b32 v164, -1
v_mov_b32 v165, -1
v_mov_b32 v166, -1
v_mov_b32 v167, -1
v_mov_b32 v240, -1
v_mov_b32 v241, -1
v_mov_b32 v242, -1
v_mov_b32 v243, -1
s_call_b64 s[78:79], Lpoll1
Lnorole:
s_setprio 1
ds_read_b128 v[228:231], v248 offset:52224
v_mfma_f32_32x32x16_bf16 v[120:135], v[232:235], v[104:107], v[120:135]
v_pk_fma_f16 v148, v149, v149, s48
v_pk_mul_f16 v154, v155, v154
v_bfe_u32 v136, v137, 2, 14
v_pk_mul_f16 v151, v152, v151
v_pk_mul_f16 v148, v149, v148
v_bfe_u32 v138, v139, 2, 14
v_exp_f16 v153, v154
v_lshrrev_b32 v137, 18, v137
v_exp_f16_e64 v150, v151
ds_read_b128 v[232:235], v248 offset:53248
ds_read_u16_d16 v136, v136
ds_read_u16_d16 v138, v138
ds_read_u16_d16_hi v137, v137
v_mfma_f32_32x32x16_bf16 v[120:135], v[236:239], v[108:111], v[120:135]
v_lshrrev_b32 v139, 18, v139
v_exp_f16 v147, v148
v_and_b32 v141, s49, v141
v_and_b32 v143, s49, v143
v_exp_f16_sdwa v153, v154 dst_sel:WORD_1 dst_unused:UNUSED_PRESERVE src0_sel:WORD_1
v_bfe_u32 v140, v141, 2, 14
v_exp_f16_sdwa v150, v151 dst_sel:WORD_1 dst_unused:UNUSED_PRESERVE src0_sel:WORD_1
v_bfe_u32 v142, v143, 2, 14
ds_read_b128 v[236:239], v248 offset:56320
ds_read_u16_d16_hi v139, v139
ds_read_u16_d16 v140, v140
ds_read_u16_d16 v142, v142
v_mfma_f32_32x32x16_bf16 v[120:135], v[224:227], v[112:115], v[120:135]
v_exp_f16_sdwa v147, v148 dst_sel:WORD_1 dst_unused:UNUSED_PRESERVE src0_sel:WORD_1
v_lshrrev_b32_e64 v141, 18, v141
v_pk_add_f16 v153, v153, 1.0 op_sel_hi:[1,0]
v_lshrrev_b32 v143, 18, v143
s_setprio 0
v_pk_add_f16 v150, v150, 1.0 op_sel_hi:[1,0]
v_pk_add_f16 v147, v147, 1.0 op_sel_hi:[1,0]
v_and_b32_e64 v145, s49, v145
v_rcp_f16 v154, v153
v_bfe_u32 v144, v145, 2, 14
s_waitcnt lgkmcnt(4)
ds_read_b128 v[224:227], v248 offset:54272
ds_read_u16_d16_hi v141, v141
ds_read_u16_d16_hi v143, v143
ds_read_u16_d16 v144, v144
v_mfma_f32_32x32x16_bf16 v[120:135], v[228:231], v[116:119], v[120:135]
v_rcp_f16 v151, v150
v_lshrrev_b32 v145, 18, v145
v_rcp_f16_e64 v148, v147
ds_read_u16_d16_hi v145, v145
v_or_b32 v168, v136, v137
s_waitcnt lgkmcnt(7)
v_or_b32_e64 v169, v138, v139
v_rcp_f16_sdwa v154, v153 dst_sel:WORD_1 dst_unused:UNUSED_PRESERVE src0_sel:WORD_1
s_waitcnt lgkmcnt(3)
v_or_b32 v170, v140, v141
v_rcp_f16_sdwa v151, v150 dst_sel:WORD_1 dst_unused:UNUSED_PRESERVE src0_sel:WORD_1
s_waitcnt lgkmcnt(2)
v_or_b32 v171, v142, v143
v_rcp_f16_sdwa v148, v147 dst_sel:WORD_1 dst_unused:UNUSED_PRESERVE src0_sel:WORD_1
s_waitcnt lgkmcnt(0)
v_or_b32 v172, v144, v145
v_pk_mul_f16 v173, v155, v154
v_pk_mul_f16 v174, v152, v151
v_pk_mul_f16 v175, v149, v148
s_cmp_eq_u32 s77, 0
s_cbranch_scc1 Lpp49
s_getreg_b32 s43, hwreg(HW_REG_IB_STS, 0, 4)
s_cmp_lg_u32 s43, 0
s_cbranch_scc1 Lpp49
s_call_b64 s[78:79], Lpoll
s_setprio 0
Lpp49:
s_setprio 2
v_cvt_pkrtz_f16_f32 v137, v120, v121
v_cvt_pkrtz_f16_f32 v139, v122, v123
v_cvt_pkrtz_f16_f32 v141, v124, v125
v_cvt_pkrtz_f16_f32 v143, v126, v127
v_cvt_pkrtz_f16_f32 v145, v128, v129
v_cvt_pk_f16_f32 v155, v130, v131
v_cvt_pk_f16_f32 v152, v132, v133
v_cvt_pk_f16_f32 v149, v134, v135
ds_read_b128 v[228:231], v248 offset:57344
v_mfma_f32_32x32x16_bf16 v[120:135], v[232:235], v[96:99], 0
v_pk_fma_f16 v154, v155, v155, s48
v_permlane16_swap_b32 v168, v172
v_and_b32 v137, s49, v137
v_pk_fma_f16 v151, v152, v152, s48
v_and_b32_e64 v139, s49, v139
v_pk_fma_f16 v148, v149, v149, s48
v_pk_mul_f16 v154, v155, v154
v_bfe_u32 v136, v137, 2, 14
v_pk_mul_f16 v151, v152, v151
ds_read_b128 v[232:235], v248 offset:55296
ds_read_u16_d16 v136, v136
v_mfma_f32_32x32x16_bf16 v[120:135], v[236:239], v[100:103], v[120:135]
v_pk_mul_f16 v148, v149, v148
v_bfe_u32 v138, v139, 2, 14
v_exp_f16 v153, v154
v_lshrrev_b32 v137, 18, v137
v_exp_f16 v150, v151
v_permlane16_swap_b32 v169, v173
v_lshrrev_b32_e64 v139, 18, v139
ds_read_b128 v[236:239], v248 offset:58368
ds_read_u16_d16 v138, v138
ds_read_u16_d16_hi v137, v137
ds_read_u16_d16_hi v139, v139
v_mfma_f32_32x32x16_bf16 v[120:135], v[224:227], v[104:107], v[120:135]
v_exp_f16 v147, v148
v_and_b32 v141, s49, v141
v_and_b32 v143, s49, v143
v_exp_f16_sdwa v153, v154 dst_sel:WORD_1 dst_unused:UNUSED_PRESERVE src0_sel:WORD_1
v_bfe_u32 v140, v141, 2, 14
v_exp_f16_sdwa v150, v151 dst_sel:WORD_1 dst_unused:UNUSED_PRESERVE src0_sel:WORD_1
s_waitcnt lgkmcnt(6)
ds_read_b128 v[224:227], v248 offset:59392
ds_read_u16_d16 v140, v140
v_mfma_f32_32x32x16_bf16 v[120:135], v[228:231], v[108:111], v[120:135]
v_bfe_u32 v142, v143, 2, 14
v_exp_f16_sdwa v147, v148 dst_sel:WORD_1 dst_unused:UNUSED_PRESERVE src0_sel:WORD_1
v_lshrrev_b32 v141, 18, v141
v_permlane16_swap_b32 v170, v174
v_pk_add_f16 v153, v153, 1.0 op_sel_hi:[1,0]
v_lshrrev_b32 v143, 18, v143
v_pk_add_f16 v150, v150, 1.0 op_sel_hi:[1,0]
v_pk_add_f16 v147, v147, 1.0 op_sel_hi:[1,0]
s_waitcnt lgkmcnt(6)
ds_read_b128 v[228:231], v248 offset:62464
ds_read_u16_d16 v142, v142
ds_read_u16_d16_hi v141, v141
ds_read_u16_d16_hi v143, v143
v_mfma_f32_32x32x16_bf16 v[120:135], v[232:235], v[112:115], v[120:135]
v_and_b32 v145, s49, v145
v_rcp_f16 v154, v153
v_bfe_u32 v144, v145, 2, 14
v_rcp_f16 v151, v150
v_lshrrev_b32 v145, 18, v145
v_rcp_f16 v148, v147
s_waitcnt lgkmcnt(6)
ds_read_b128 v[232:235], v248 offset:60416
ds_read_u16_d16 v144, v144
ds_read_u16_d16_hi v145, v145
v_mfma_f32_32x32x16_bf16 v[120:135], v[236:239], v[116:119], v[120:135]
v_or_b32 v176, v136, v137
v_permlane16_swap_b32 v171, v175
v_or_b32_e64 v177, v138, v139
v_rcp_f16_sdwa v154, v153 dst_sel:WORD_1 dst_unused:UNUSED_PRESERVE src0_sel:WORD_1
s_waitcnt lgkmcnt(4)
v_or_b32 v178, v140, v141
v_rcp_f16_sdwa v151, v150 dst_sel:WORD_1 dst_unused:UNUSED_PRESERVE src0_sel:WORD_1
s_waitcnt lgkmcnt(3)
v_or_b32 v179, v142, v143
v_rcp_f16_sdwa v148, v147 dst_sel:WORD_1 dst_unused:UNUSED_PRESERVE src0_sel:WORD_1
s_waitcnt lgkmcnt(0)
v_or_b32 v180, v144, v145
v_pk_mul_f16 v181, v155, v154
v_pk_mul_f16 v182, v152, v151
v_pk_mul_f16 v183, v149, v148
s_cmp_eq_u32 s77, 0
s_cbranch_scc1 Lpp50
s_getreg_b32 s43, hwreg(HW_REG_IB_STS, 0, 4)
s_cmp_lg_u32 s43, 0
s_cbranch_scc1 Lpp50
s_call_b64 s[78:79], Lpoll
s_setprio 2
Lpp50:
s_setprio 1
v_cvt_pkrtz_f16_f32 v137, v120, v121
v_cvt_pkrtz_f16_f32 v139, v122, v123
v_cvt_pkrtz_f16_f32 v141, v124, v125
v_cvt_pkrtz_f16_f32 v143, v126, v127
v_cvt_pkrtz_f16_f32 v145, v128, v129
v_cvt_pk_f16_f32 v155, v130, v131
v_cvt_pk_f16_f32 v152, v132, v133
v_cvt_pk_f16_f32 v149, v134, v135
ds_read_b128 v[236:239], v248 offset:63488
v_mfma_f32_32x32x16_bf16 v[120:135], v[224:227], v[96:99], 0
v_pk_fma_f16 v154, v155, v155, s48
v_permlane16_swap_b32 v176, v180
v_and_b32 v137, s49, v137
v_pk_fma_f16 v151, v152, v152, s48
v_and_b32_e64 v139, s49, v139
v_pk_fma_f16 v148, v149, v149, s48
v_pk_mul_f16 v154, v155, v154
v_bfe_u32 v136, v137, 2, 14
v_pk_mul_f16 v151, v152, v151
ds_read_b128 v[224:227], v248 offset:61440
ds_read_u16_d16 v136, v136
v_mfma_f32_32x32x16_bf16 v[120:135], v[228:231], v[100:103], v[120:135]
v_pk_mul_f16 v148, v149, v148
v_bfe_u32 v138, v139, 2, 14
v_exp_f16 v153, v154
v_lshrrev_b32 v137, 18, v137
v_exp_f16 v150, v151
v_permlane16_swap_b32 v177, v181
v_lshrrev_b32_e64 v139, 18, v139
ds_read_b128 v[228:231], v248 offset:64512
ds_read_u16_d16 v138, v138
ds_read_u16_d16_hi v137, v137
ds_read_u16_d16_hi v139, v139
v_mfma_f32_32x32x16_bf16 v[120:135], v[232:235], v[104:107], v[120:135]
v_exp_f16 v147, v148
v_and_b32 v141, s49, v141
v_and_b32 v143, s49, v143
v_exp_f16_sdwa v153, v154 dst_sel:WORD_1 dst_unused:UNUSED_PRESERVE src0_sel:WORD_1
v_bfe_u32 v140, v141, 2, 14
v_exp_f16_sdwa v150, v151 dst_sel:WORD_1 dst_unused:UNUSED_PRESERVE src0_sel:WORD_1
s_waitcnt lgkmcnt(6)
ds_read_b128 v[232:235], v249
ds_read_u16_d16 v140, v140
v_mfma_f32_32x32x16_bf16 v[120:135], v[236:239], v[108:111], v[120:135]
v_bfe_u32 v142, v143, 2, 14
v_exp_f16_sdwa v147, v148 dst_sel:WORD_1 dst_unused:UNUSED_PRESERVE src0_sel:WORD_1
v_lshrrev_b32 v141, 18, v141
v_permlane16_swap_b32 v178, v182
v_pk_add_f16 v153, v153, 1.0 op_sel_hi:[1,0]
v_lshrrev_b32 v143, 18, v143
v_pk_add_f16 v150, v150, 1.0 op_sel_hi:[1,0]
v_pk_add_f16 v147, v147, 1.0 op_sel_hi:[1,0]
s_waitcnt lgkmcnt(6)
ds_read_b128 v[236:239], v249 offset:3072
ds_read_u16_d16 v142, v142
ds_read_u16_d16_hi v141, v141
ds_read_u16_d16_hi v143, v143
v_mfma_f32_32x32x16_bf16 v[120:135], v[224:227], v[112:115], v[120:135]
v_and_b32 v145, s49, v145
v_rcp_f16 v154, v153
v_bfe_u32 v144, v145, 2, 14
s_setprio 0
v_rcp_f16 v151, v150
v_lshrrev_b32_e64 v145, 18, v145
v_rcp_f16 v148, v147
s_waitcnt lgkmcnt(6)
ds_read_b128 v[224:227], v249 offset:1024
ds_read_u16_d16 v144, v144
ds_read_u16_d16_hi v145, v145
v_mfma_f32_32x32x16_bf16 v[120:135], v[228:231], v[116:119], v[120:135]
v_or_b32 v184, v136, v137
v_permlane16_swap_b32 v179, v183
v_or_b32_e64 v185, v138, v139
v_rcp_f16_sdwa v154, v153 dst_sel:WORD_1 dst_unused:UNUSED_PRESERVE src0_sel:WORD_1
s_waitcnt lgkmcnt(4)
v_or_b32 v186, v140, v141
v_rcp_f16_sdwa v151, v150 dst_sel:WORD_1 dst_unused:UNUSED_PRESERVE src0_sel:WORD_1
s_waitcnt lgkmcnt(3)
v_or_b32 v187, v142, v143
v_rcp_f16_sdwa v148, v147 dst_sel:WORD_1 dst_unused:UNUSED_PRESERVE src0_sel:WORD_1
s_waitcnt lgkmcnt(0)
v_or_b32_e64 v188, v144, v145
v_pk_mul_f16 v189, v155, v154
v_pk_mul_f16 v190, v152, v151
v_pk_mul_f16 v191, v149, v148
s_cmp_eq_u32 s77, 0
s_cbranch_scc1 Lpp51
s_getreg_b32 s43, hwreg(HW_REG_IB_STS, 0, 4)
s_cmp_lg_u32 s43, 0
s_cbranch_scc1 Lpp51
s_call_b64 s[78:79], Lpoll
s_setprio 0
Lpp51:
v_mov_b32 v253, 16256
Lw2w:
ds_read_b32 v254, v253 offset:4
s_waitcnt lgkmcnt(0)
v_readfirstlane_b32 s43, v254
s_cmp_eq_u32 s76, 0
s_cbranch_scc1 Lw2x
s_sub_u32 s76, s76, 1
s_cmp_lt_u32 s43, 1
s_cbranch_scc0 Lw2x
s_sleep 2
s_branch Lw2w
Lw2x:
s_add_u32 m0, s72, 7168
s_add_u32 s43, s82, 6208
buffer_load_dwordx4 v252, s[16:19], s43 offen lds
s_add_u32 m0, s72, 8192
s_add_u32 s43, s82, 6272
buffer_load_dwordx4 v252, s[16:19], s43 offen lds
s_setprio 2
v_cvt_pkrtz_f16_f32 v137, v120, v121
v_cvt_pkrtz_f16_f32 v139, v122, v123
v_cvt_pkrtz_f16_f32 v141, v124, v125
v_cvt_pkrtz_f16_f32 v143, v126, v127
v_cvt_pkrtz_f16_f32 v145, v128, v129
v_cvt_pk_f16_f32 v155, v130, v131
v_cvt_pk_f16_f32 v152, v132, v133
v_cvt_pk_f16_f32 v149, v134, v135
ds_read_b128 v[228:231], v249 offset:4096
v_mfma_f32_32x32x16_bf16 v[120:135], v[232:235], v[96:99], 0
v_pk_fma_f16 v154, v155, v155, s48
v_permlane16_swap_b32 v184, v188
v_and_b32 v137, s49, v137
v_pk_fma_f16 v151, v152, v152, s48
v_and_b32_e64 v139, s49, v139
v_pk_fma_f16 v148, v149, v149, s48
v_pk_mul_f16 v154, v155, v154
v_bfe_u32 v136, v137, 2, 14
v_pk_mul_f16 v151, v152, v151
ds_read_b128 v[232:235], v249 offset:2048
ds_read_u16_d16 v136, v136
v_mfma_f32_32x32x16_bf16 v[120:135], v[236:239], v[100:103], v[120:135]
v_pk_mul_f16 v148, v149, v148
v_bfe_u32 v138, v139, 2, 14
v_exp_f16 v153, v154
v_lshrrev_b32 v137, 18, v137
v_exp_f16 v150, v151
v_permlane16_swap_b32 v185, v189
v_lshrrev_b32_e64 v139, 18, v139
ds_read_b128 v[236:239], v249 offset:5120
ds_read_u16_d16 v138, v138
ds_read_u16_d16_hi v137, v137
ds_read_u16_d16_hi v139, v139
v_mfma_f32_32x32x16_bf16 v[120:135], v[224:227], v[104:107], v[120:135]
v_exp_f16 v147, v148
v_and_b32 v141, s49, v141
v_and_b32 v143, s49, v143
v_exp_f16_sdwa v153, v154 dst_sel:WORD_1 dst_unused:UNUSED_PRESERVE src0_sel:WORD_1
v_bfe_u32 v140, v141, 2, 14
v_exp_f16_sdwa v150, v151 dst_sel:WORD_1 dst_unused:UNUSED_PRESERVE src0_sel:WORD_1
s_waitcnt lgkmcnt(6)
ds_read_b128 v[224:227], v249 offset:6144
ds_read_u16_d16 v140, v140
v_mfma_f32_32x32x16_bf16 v[120:135], v[228:231], v[108:111], v[120:135]
v_bfe_u32 v142, v143, 2, 14
v_exp_f16_sdwa v147, v148 dst_sel:WORD_1 dst_unused:UNUSED_PRESERVE src0_sel:WORD_1
v_lshrrev_b32 v141, 18, v141
v_permlane16_swap_b32 v186, v190
v_pk_add_f16 v153, v153, 1.0 op_sel_hi:[1,0]
v_lshrrev_b32 v143, 18, v143
v_pk_add_f16 v150, v150, 1.0 op_sel_hi:[1,0]
v_pk_add_f16 v147, v147, 1.0 op_sel_hi:[1,0]
s_waitcnt lgkmcnt(6)
ds_read_b128 v[228:231], v249 offset:9216
ds_read_u16_d16 v142, v142
ds_read_u16_d16_hi v141, v141
ds_read_u16_d16_hi v143, v143
v_mfma_f32_32x32x16_bf16 v[120:135], v[232:235], v[112:115], v[120:135]
v_and_b32 v145, s49, v145
v_rcp_f16 v154, v153
v_bfe_u32 v144, v145, 2, 14
v_rcp_f16 v151, v150
v_lshrrev_b32 v145, 18, v145
v_rcp_f16 v148, v147
s_waitcnt lgkmcnt(6)
ds_read_b128 v[232:235], v249 offset:7168
ds_read_u16_d16 v144, v144
ds_read_u16_d16_hi v145, v145
v_mfma_f32_32x32x16_bf16 v[120:135], v[236:239], v[116:119], v[120:135]
v_or_b32 v192, v136, v137
v_permlane16_swap_b32 v187, v191
v_or_b32_e64 v193, v138, v139
v_rcp_f16_sdwa v154, v153 dst_sel:WORD_1 dst_unused:UNUSED_PRESERVE src0_sel:WORD_1
s_waitcnt lgkmcnt(4)
v_or_b32 v194, v140, v141
v_rcp_f16_sdwa v151, v150 dst_sel:WORD_1 dst_unused:UNUSED_PRESERVE src0_sel:WORD_1
s_waitcnt lgkmcnt(3)
v_or_b32 v195, v142, v143
v_rcp_f16_sdwa v148, v147 dst_sel:WORD_1 dst_unused:UNUSED_PRESERVE src0_sel:WORD_1
s_waitcnt lgkmcnt(0)
v_or_b32 v196, v144, v145
v_pk_mul_f16 v197, v155, v154
v_pk_mul_f16 v198, v152, v151
v_pk_mul_f16 v199, v149, v148
s_cmp_eq_u32 s77, 0
s_cbranch_scc1 Lpp52
s_getreg_b32 s43, hwreg(HW_REG_IB_STS, 0, 4)
s_cmp_lg_u32 s43, 0
s_cbranch_scc1 Lpp52
s_call_b64 s[78:79], Lpoll
s_setprio 2
Lpp52:
s_setprio 1
v_cvt_pkrtz_f16_f32 v137, v120, v121
v_cvt_pkrtz_f16_f32 v139, v122, v123
v_cvt_pkrtz_f16_f32 v141, v124, v125
v_cvt_pkrtz_f16_f32 v143, v126, v127
v_cvt_pkrtz_f16_f32 v145, v128, v129
v_cvt_pk_f16_f32 v155, v130, v131
v_cvt_pk_f16_f32 v152, v132, v133
v_cvt_pk_f16_f32 v149, v134, v135
ds_read_b128 v[236:239], v249 offset:10240
v_mfma_f32_32x32x16_bf16 v[120:135], v[224:227], v[96:99], 0
v_pk_fma_f16 v154, v155, v155, s48
v_permlane16_swap_b32 v192, v196
v_and_b32 v137, s49, v137
v_pk_fma_f16 v151, v152, v152, s48
v_and_b32_e64 v139, s49, v139
v_pk_fma_f16 v148, v149, v149, s48
v_pk_mul_f16 v154, v155, v154
v_bfe_u32 v136, v137, 2, 14
v_pk_mul_f16 v151, v152, v151
ds_read_b128 v[224:227], v249 offset:8192
ds_read_u16_d16 v136, v136
v_mfma_f32_32x32x16_bf16 v[120:135], v[228:231], v[100:103], v[120:135]
v_pk_mul_f16 v148, v149, v148
v_bfe_u32 v138, v139, 2, 14
v_exp_f16 v153, v154
v_lshrrev_b32 v137, 18, v137
v_exp_f16 v150, v151
v_permlane16_swap_b32 v193, v197
v_lshrrev_b32_e64 v139, 18, v139
ds_read_b128 v[228:231], v249 offset:11264
ds_read_u16_d16 v138, v138
ds_read_u16_d16_hi v137, v137
ds_read_u16_d16_hi v139, v139
v_mfma_f32_32x32x16_bf16 v[120:135], v[232:235], v[104:107], v[120:135]
v_exp_f16 v147, v148
v_and_b32 v141, s49, v141
v_and_b32 v143, s49, v143
v_exp_f16_sdwa v153, v154 dst_sel:WORD_1 dst_unused:UNUSED_PRESERVE src0_sel:WORD_1
v_bfe_u32 v140, v141, 2, 14
v_exp_f16_sdwa v150, v151 dst_sel:WORD_1 dst_unused:UNUSED_PRESERVE src0_sel:WORD_1
s_waitcnt lgkmcnt(6)
ds_read_u16_d16 v140, v140
v_mfma_f32_32x32x16_bf16 v[120:135], v[236:239], v[108:111], v[120:135]
v_bfe_u32 v142, v143, 2, 14
v_exp_f16_sdwa v147, v148 dst_sel:WORD_1 dst_unused:UNUSED_PRESERVE src0_sel:WORD_1
v_lshrrev_b32 v141, 18, v141
v_permlane16_swap_b32 v194, v198
v_pk_add_f16 v153, v153, 1.0 op_sel_hi:[1,0]
v_lshrrev_b32 v143, 18, v143
v_pk_add_f16 v150, v150, 1.0 op_sel_hi:[1,0]
v_pk_add_f16 v147, v147, 1.0 op_sel_hi:[1,0]
s_waitcnt lgkmcnt(5)
ds_read_u16_d16 v142, v142
ds_read_u16_d16_hi v141, v141
ds_read_u16_d16_hi v143, v143
v_mfma_f32_32x32x16_bf16 v[120:135], v[224:227], v[112:115], v[120:135]
v_and_b32 v145, s49, v145
v_rcp_f16 v154, v153
v_bfe_u32 v144, v145, 2, 14
s_setprio 0
v_rcp_f16 v151, v150
v_lshrrev_b32_e64 v145, 18, v145
v_rcp_f16 v148, v147
s_waitcnt lgkmcnt(4)
ds_read_u16_d16 v144, v144
ds_read_u16_d16_hi v145, v145
v_mfma_f32_32x32x16_bf16 v[120:135], v[228:231], v[116:119], v[120:135]
v_or_b32 v200, v136, v137
v_permlane16_swap_b32 v195, v199
v_or_b32_e64 v201, v138, v139
v_rcp_f16_sdwa v154, v153 dst_sel:WORD_1 dst_unused:UNUSED_PRESERVE src0_sel:WORD_1
s_waitcnt lgkmcnt(3)
v_or_b32 v202, v140, v141
v_rcp_f16_sdwa v151, v150 dst_sel:WORD_1 dst_unused:UNUSED_PRESERVE src0_sel:WORD_1
s_waitcnt lgkmcnt(2)
v_or_b32 v203, v142, v143
v_rcp_f16_sdwa v148, v147 dst_sel:WORD_1 dst_unused:UNUSED_PRESERVE src0_sel:WORD_1
s_waitcnt lgkmcnt(0)
v_or_b32 v204, v144, v145
v_pk_mul_f16 v205, v155, v154
v_pk_mul_f16 v206, v152, v151
v_pk_mul_f16 v207, v149, v148
s_cmp_eq_u32 s77, 0
s_cbranch_scc1 Lpp53
s_getreg_b32 s43, hwreg(HW_REG_IB_STS, 0, 4)
s_cmp_lg_u32 s43, 0
s_cbranch_scc1 Lpp53
s_call_b64 s[78:79], Lpoll
s_setprio 0
Lpp53:
s_setprio 2
v_cvt_pkrtz_f16_f32 v137, v120, v121
v_cvt_pkrtz_f16_f32 v139, v122, v123
v_cvt_pkrtz_f16_f32 v141, v124, v125
v_cvt_pkrtz_f16_f32 v143, v126, v127
v_cvt_pkrtz_f16_f32 v145, v128, v129
v_cvt_pk_f16_f32 v155, v130, v131
v_cvt_pk_f16_f32 v152, v132, v133
v_cvt_pk_f16_f32 v149, v134, v135
v_pk_fma_f16 v154, v155, v155, s48
v_permlane16_swap_b32 v96, v100
v_permlane16_swap_b32 v200, v204
v_and_b32_e64 v137, s49, v137
v_pk_fma_f16 v151, v152, v152, s48
v_and_b32 v139, s49, v139
v_pk_fma_f16 v148, v149, v149, s48
v_permlane16_swap_b32 v97, v101
v_pk_mul_f16 v154, v155, v154
v_bfe_u32 v136, v137, 2, 14
v_pk_mul_f16 v151, v152, v151
v_pk_mul_f16 v148, v149, v148
v_bfe_u32 v138, v139, 2, 14
v_permlane16_swap_b32 v98, v102
v_exp_f16 v153, v154
v_lshrrev_b32 v137, 18, v137
v_exp_f16 v150, v151
v_permlane16_swap_b32 v99, v103
v_permlane16_swap_b32 v201, v205
v_lshrrev_b32 v139, 18, v139
v_exp_f16 v147, v148
v_and_b32 v141, s49, v141
v_permlane16_swap_b32 v104, v108
v_and_b32_e64 v143, s49, v143
ds_read_u16_d16 v136, v136
ds_read_u16_d16 v138, v138
ds_read_u16_d16_hi v137, v137
ds_read_u16_d16_hi v139, v139
v_exp_f16_sdwa v153, v154 dst_sel:WORD_1 dst_unused:UNUSED_PRESERVE src0_sel:WORD_1
v_bfe_u32 v140, v141, 2, 14
v_exp_f16_sdwa v150, v151 dst_sel:WORD_1 dst_unused:UNUSED_PRESERVE src0_sel:WORD_1
v_permlane16_swap_b32 v105, v109
v_bfe_u32 v142, v143, 2, 14
v_exp_f16_sdwa v147, v148 dst_sel:WORD_1 dst_unused:UNUSED_PRESERVE src0_sel:WORD_1
v_lshrrev_b32 v141, 18, v141
v_permlane16_swap_b32 v106, v110
v_permlane16_swap_b32 v202, v206
v_pk_add_f16 v153, v153, 1.0 op_sel_hi:[1,0]
v_lshrrev_b32_e64 v143, 18, v143
v_pk_add_f16 v150, v150, 1.0 op_sel_hi:[1,0]
v_pk_add_f16 v147, v147, 1.0 op_sel_hi:[1,0]
v_permlane16_swap_b32 v107, v111
v_and_b32 v145, s49, v145
v_rcp_f16_e64 v154, v153
v_bfe_u32 v144, v145, 2, 14
v_rcp_f16 v151, v150
v_permlane16_swap_b32 v112, v116
v_lshrrev_b32_e64 v145, 18, v145
ds_read_u16_d16 v140, v140
ds_read_u16_d16 v142, v142
ds_read_u16_d16_hi v141, v141
ds_read_u16_d16_hi v143, v143
ds_read_u16_d16 v144, v144
ds_read_u16_d16_hi v145, v145
v_rcp_f16 v148, v147
s_waitcnt lgkmcnt(6)
v_or_b32 v232, v136, v137
v_permlane16_swap_b32 v113, v117
v_permlane16_swap_b32 v203, v207
v_or_b32 v233, v138, v139
v_rcp_f16_sdwa v154, v153 dst_sel:WORD_1 dst_unused:UNUSED_PRESERVE src0_sel:WORD_1
s_waitcnt lgkmcnt(3)
v_or_b32 v234, v140, v141
v_permlane16_swap_b32 v114, v118
v_rcp_f16_sdwa v151, v150 dst_sel:WORD_1 dst_unused:UNUSED_PRESERVE src0_sel:WORD_1
s_waitcnt lgkmcnt(2)
v_or_b32_e64 v235, v142, v143
v_rcp_f16_sdwa v148, v147 dst_sel:WORD_1 dst_unused:UNUSED_PRESERVE src0_sel:WORD_1
v_permlane16_swap_b32 v115, v119
s_waitcnt lgkmcnt(0)
v_or_b32_e64 v236, v144, v145
v_pk_mul_f16 v237, v155, v154
v_pk_mul_f16 v238, v152, v151
v_pk_mul_f16 v239, v149, v148
s_cmp_eq_u32 s77, 0
s_cbranch_scc1 Lpp54
s_getreg_b32 s43, hwreg(HW_REG_IB_STS, 0, 4)
s_cmp_lg_u32 s43, 0
s_cbranch_scc1 Lpp54
s_call_b64 s[78:79], Lpoll
s_setprio 2
Lpp54:
s_setprio 1
v_permlane16_swap_b32 v232, v236
v_permlane16_swap_b32 v233, v237
v_permlane16_swap_b32 v234, v238
s_setprio 0
v_permlane16_swap_b32 v235, v239
s_cmp_eq_u32 s77, 0
s_cbranch_scc1 Lpp55
s_getreg_b32 s43, hwreg(HW_REG_IB_STS, 0, 4)
s_cmp_lg_u32 s43, 0
s_cbranch_scc1 Lpp55
s_call_b64 s[78:79], Lpoll
s_setprio 0
Lpp55:
s_setprio 2
v_lshrrev_b32 v225, 5, v251
v_lshl_add_u32 v224, v225, 9, s72
v_lshl_add_u32 v226, v225, 4, s72
v_and_b32 v225, 15, v251
v_lshl_add_u32 v224, v225, 4, v224
v_bfe_u32 v225, v251, 4, 1
v_lshl_add_u32 v224, v225, 3, v224
s_waitcnt vmcnt(0)
ds_read_b64_tr_b16 v[120:121], v224
ds_read_b64_tr_b16 v[122:123], v224 offset:256
ds_read_b64_tr_b16 v[124:125], v224 offset:1024
ds_read_b64_tr_b16 v[126:127], v224 offset:1280
ds_read_b64_tr_b16 v[128:129], v224 offset:2048
ds_read_b64_tr_b16 v[130:131], v224 offset:2304
ds_read_b64_tr_b16 v[132:133], v224 offset:3072
ds_read_b64_tr_b16 v[134:135], v224 offset:3328
ds_read_b64_tr_b16 v[136:137], v224 offset:4096
ds_read_b64_tr_b16 v[138:139], v224 offset:4352
ds_read_b64_tr_b16 v[140:141], v224 offset:5120
ds_read_b64_tr_b16 v[142:143], v224 offset:5376
ds_read_b64_tr_b16 v[144:145], v224 offset:6144
ds_read_b64_tr_b16 v[146:147], v224 offset:6400
ds_read_b64_tr_b16 v[148:149], v224 offset:7168
ds_read_b64_tr_b16 v[150:151], v224 offset:7424
ds_read_b64_tr_b16 v[152:153], v224 offset:8192
ds_read_b64_tr_b16 v[154:155], v224 offset:8448
v_lshrrev_b32 v225, 4, v251
v_and_b32 v227, 15, v251
v_mul_u32_u24 v252, 192, v227
v_lshl_add_u32 v252, v225, 4, v252
v_lshlrev_b32 v254, 5, v225
v_and_b32 v253, 47, v251
v_lshlrev_b32 v253, 4, v253
v_and_b32 v225, 1, v225
v_mul_u32_u24 v227, 3072, v225
v_add_u32_e64 v248, v227, v253
v_add_u32 v249, 65536, v248
v_add_u32 v250, 131072, v248
v_lshl_add_u32 v253, v225, 21, v253
v_mov_b32 v225, 16256
v_mov_b32_e64 v227, 1
s_waitcnt lgkmcnt(0)
s_mov_b64 exec, 1
ds_add_u32 v225, v227 offset:8
s_mov_b64 exec, -1
v_lshlrev_b32 v228, 16, v120
v_and_b32 v229, 4294901760, v120
v_cvt_pk_f16_f32 v120, v228, v229
v_lshlrev_b32_e64 v230, 16, v121
v_and_b32 v231, 4294901760, v121
v_cvt_pk_f16_f32 v121, v230, v231
v_lshlrev_b32_e64 v228, 16, v122
v_and_b32 v229, 4294901760, v122
v_cvt_pk_f16_f32 v122, v228, v229
v_lshlrev_b32_e64 v230, 16, v123
v_and_b32 v231, 4294901760, v123
v_cvt_pk_f16_f32 v123, v230, v231
v_lshlrev_b32_e64 v228, 16, v124
v_and_b32 v229, 4294901760, v124
v_cvt_pk_f16_f32 v124, v228, v229
v_lshlrev_b32_e64 v230, 16, v125
v_and_b32 v231, 4294901760, v125
v_cvt_pk_f16_f32 v125, v230, v231
v_lshlrev_b32_e64 v228, 16, v126
v_and_b32 v229, 4294901760, v126
v_cvt_pk_f16_f32 v126, v228, v229
v_lshlrev_b32_e64 v230, 16, v127
v_and_b32 v231, 4294901760, v127
v_cvt_pk_f16_f32 v127, v230, v231
v_lshlrev_b32_e64 v228, 16, v128
v_and_b32 v229, 4294901760, v128
v_cvt_pk_f16_f32 v128, v228, v229
v_lshlrev_b32_e64 v230, 16, v129
v_and_b32 v231, 4294901760, v129
v_cvt_pk_f16_f32 v129, v230, v231
v_lshlrev_b32_e64 v228, 16, v130
v_and_b32 v229, 4294901760, v130
v_cvt_pk_f16_f32 v130, v228, v229
v_lshlrev_b32_e64 v230, 16, v131
v_and_b32 v231, 4294901760, v131
v_cvt_pk_f16_f32 v131, v230, v231
s_cmp_eq_u32 s77, 0
s_cbranch_scc1 Lpp911
s_getreg_b32 s43, hwreg(HW_REG_IB_STS, 0, 4)
s_cmp_lg_u32 s43, 0
s_cbranch_scc1 Lpp911
s_call_b64 s[78:79], Lpoll
s_setprio 2
Lpp911:
v_lshlrev_b32 v228, 16, v132
v_and_b32 v229, 4294901760, v132
v_cvt_pk_f16_f32 v132, v228, v229
v_lshlrev_b32_e64 v230, 16, v133
v_and_b32 v231, 4294901760, v133
v_cvt_pk_f16_f32 v133, v230, v231
v_lshlrev_b32_e64 v228, 16, v134
v_and_b32 v229, 4294901760, v134
v_cvt_pk_f16_f32 v134, v228, v229
v_lshlrev_b32_e64 v230, 16, v135
v_and_b32 v231, 4294901760, v135
v_cvt_pk_f16_f32 v135, v230, v231
v_lshlrev_b32_e64 v228, 16, v136
v_and_b32 v229, 4294901760, v136
v_cvt_pk_f16_f32 v136, v228, v229
v_lshlrev_b32_e64 v230, 16, v137
v_and_b32 v231, 4294901760, v137
v_cvt_pk_f16_f32 v137, v230, v231
v_lshlrev_b32_e64 v228, 16, v138
v_and_b32 v229, 4294901760, v138
v_cvt_pk_f16_f32 v138, v228, v229
v_lshlrev_b32_e64 v230, 16, v139
v_and_b32 v231, 4294901760, v139
v_cvt_pk_f16_f32 v139, v230, v231
v_lshlrev_b32_e64 v228, 16, v140
v_and_b32 v229, 4294901760, v140
v_cvt_pk_f16_f32 v140, v228, v229
v_lshlrev_b32_e64 v230, 16, v141
v_and_b32 v231, 4294901760, v141
v_cvt_pk_f16_f32 v141, v230, v231
v_lshlrev_b32_e64 v228, 16, v142
v_and_b32 v229, 4294901760, v142
v_cvt_pk_f16_f32 v142, v228, v229
v_lshlrev_b32_e64 v230, 16, v143
v_and_b32 v231, 4294901760, v143
v_cvt_pk_f16_f32 v143, v230, v231
s_cmp_eq_u32 s77, 0
s_cbranch_scc1 Lpp923
s_getreg_b32 s43, hwreg(HW_REG_IB_STS, 0, 4)
s_cmp_lg_u32 s43, 0
s_cbranch_scc1 Lpp923
s_call_b64 s[78:79], Lpoll
s_setprio 2
Lpp923:
v_lshlrev_b32 v228, 16, v144
v_and_b32 v229, 4294901760, v144
v_cvt_pk_f16_f32 v144, v228, v229
v_lshlrev_b32_e64 v230, 16, v145
v_and_b32 v231, 4294901760, v145
v_cvt_pk_f16_f32 v145, v230, v231
v_lshlrev_b32_e64 v228, 16, v146
v_and_b32 v229, 4294901760, v146
v_cvt_pk_f16_f32 v146, v228, v229
v_lshlrev_b32_e64 v230, 16, v147
v_and_b32 v231, 4294901760, v147
v_cvt_pk_f16_f32 v147, v230, v231
v_lshlrev_b32_e64 v228, 16, v148
v_and_b32 v229, 4294901760, v148
v_cvt_pk_f16_f32 v148, v228, v229
v_lshlrev_b32_e64 v230, 16, v149
v_and_b32 v231, 4294901760, v149
v_cvt_pk_f16_f32 v149, v230, v231
v_lshlrev_b32_e64 v228, 16, v150
v_and_b32 v229, 4294901760, v150
v_cvt_pk_f16_f32 v150, v228, v229
v_lshlrev_b32_e64 v230, 16, v151
v_and_b32 v231, 4294901760, v151
v_cvt_pk_f16_f32 v151, v230, v231
v_lshlrev_b32_e64 v228, 16, v152
v_and_b32 v229, 4294901760, v152
v_cvt_pk_f16_f32 v152, v228, v229
v_lshlrev_b32_e64 v230, 16, v153
v_and_b32 v231, 4294901760, v153
v_cvt_pk_f16_f32 v153, v230, v231
v_lshlrev_b32_e64 v228, 16, v154
v_and_b32 v229, 4294901760, v154
v_cvt_pk_f16_f32 v154, v228, v229
v_lshlrev_b32_e64 v230, 16, v155
v_and_b32 v231, 4294901760, v155
v_cvt_pk_f16_f32 v155, v230, v231
s_cmp_eq_u32 s77, 0
s_cbranch_scc1 Lpp935
s_getreg_b32 s43, hwreg(HW_REG_IB_STS, 0, 4)
s_cmp_lg_u32 s43, 0
s_cbranch_scc1 Lpp935
s_call_b64 s[78:79], Lpoll
s_setprio 2
Lpp935:
v_lshl_add_u32 v224, v251, 4, s72
s_cmp_lg_u32 s40, 0
s_cbranch_scc1 Lnofin
Lspin:
s_cmp_eq_u32 s77, 0
s_cbranch_scc1 Lspinx
s_cmp_eq_u32 s76, 0
s_cbranch_scc1 Lspinx
s_sub_u32 s76, s76, 1
s_call_b64 s[78:79], Lpoll
s_branch Lspin
Lspinx:
v_add_u32_e64 v162, 0, v251
v_mul_u32_u24 v165, 2731, v162
v_lshrrev_b32_e64 v165, 16, v165
v_mul_u32_u24 v165, 9120, v165
v_lshl_add_u32 v162, v162, 2, v165
v_add_u32 v162, 90112, v162
v_add_u32_e64 v163, 64, v251
v_mul_u32_u24 v165, 2731, v163
v_lshrrev_b32_e64 v165, 16, v165
v_mul_u32_u24 v165, 9120, v165
v_lshl_add_u32 v163, v163, 2, v165
v_add_u32 v163, 90112, v163
v_add_u32 v164, 128, v251
v_mul_u32_u24 v165, 2731, v164
v_lshrrev_b32_e64 v165, 16, v165
v_mul_u32_u24 v165, 9120, v165
v_lshl_add_u32 v164, v164, 2, v165
v_add_u32 v164, 90112, v164
v_mov_b32 v165, 16256
Lrrw:
ds_read_b32 v166, v165 offset:8
s_waitcnt lgkmcnt(0)
v_readfirstlane_b32 s43, v166
s_cmp_eq_u32 s76, 0
s_cbranch_scc1 Lrrx
s_sub_u32 s76, s76, 1
s_cmp_lt_u32 s43, 8
s_cbranch_scc0 Lrrx
s_sleep 2
s_branch Lrrw
Lrrx:
ds_write_b32 v162, v244
ds_write_b32 v163, v245
ds_write_b32 v164, v246
Lnofin:
s_waitcnt lgkmcnt(0)
s_barrier
ds_read_b128 v[156:159], v226
ds_read_b128 v[160:163], v226 offset:32
ds_read_b128 v[164:167], v226 offset:64
s_waitcnt lgkmcnt(0)
v_pk_mul_f16 v120, v120, v156
v_pk_mul_f16 v121, v121, v157
v_pk_mul_f16 v122, v122, v158
v_pk_mul_f16 v123, v123, v159
ds_write_b128 v224, v[120:123]
v_pk_mul_f16 v124, v124, v156
v_pk_mul_f16 v125, v125, v157
v_pk_mul_f16 v126, v126, v158
v_pk_mul_f16 v127, v127, v159
ds_write_b128 v224, v[124:127] offset:1024
v_pk_mul_f16 v128, v128, v156
v_pk_mul_f16 v129, v129, v157
v_pk_mul_f16 v130, v130, v158
v_pk_mul_f16 v131, v131, v159
ds_write_b128 v224, v[128:131] offset:2048
v_pk_mul_f16 v132, v132, v160
v_pk_mul_f16 v133, v133, v161
v_pk_mul_f16 v134, v134, v162
v_pk_mul_f16 v135, v135, v163
ds_write_b128 v224, v[132:135] offset:3072
v_pk_mul_f16 v136, v136, v160
v_pk_mul_f16 v137, v137, v161
v_pk_mul_f16 v138, v138, v162
v_pk_mul_f16 v139, v139, v163
ds_write_b128 v224, v[136:139] offset:4096
v_pk_mul_f16 v140, v140, v160
v_pk_mul_f16 v141, v141, v161
v_pk_mul_f16 v142, v142, v162
v_pk_mul_f16 v143, v143, v163
ds_write_b128 v224, v[140:143] offset:5120
v_pk_mul_f16 v144, v144, v164
v_pk_mul_f16 v145, v145, v165
v_pk_mul_f16 v146, v146, v166
v_pk_mul_f16 v147, v147, v167
ds_write_b128 v224, v[144:147] offset:6144
v_pk_mul_f16 v148, v148, v164
v_pk_mul_f16 v149, v149, v165
v_pk_mul_f16 v150, v150, v166
v_pk_mul_f16 v151, v151, v167
ds_write_b128 v224, v[148:151] offset:7168
v_pk_mul_f16 v152, v152, v164
v_pk_mul_f16 v153, v153, v165
v_pk_mul_f16 v154, v154, v166
v_pk_mul_f16 v155, v155, v167
ds_write_b128 v224, v[152:155] offset:8192
s_waitcnt lgkmcnt(0)
s_barrier
s_setprio 3
ds_read_b128 v[224:227], v249 offset:24576
ds_read_b128 v[228:231], v254 offset:7936
ds_read_b128 v[240:243], v249 offset:24832
ds_read_b128 v[244:247], v254 offset:7952
s_waitcnt lgkmcnt(2)
v_mfma_f32_16x16x32_f16 v[120:123], v[224:227], v[0:3], v[228:231]
v_mfma_f32_16x16x32_f16 v[128:131], v[224:227], v[4:7], v[228:231]
s_waitcnt lgkmcnt(0)
v_mfma_f32_16x16x32_f16 v[124:127], v[240:243], v[0:3], v[244:247]
ds_read_b128 v[224:227], v249 offset:25600
ds_read_b128 v[228:231], v254 offset:8064
v_mfma_f32_16x16x32_f16 v[132:135], v[240:243], v[4:7], v[244:247]
s_waitcnt lgkmcnt(0)
v_mfma_f32_16x16x32_f16 v[136:139], v[224:227], v[0:3], v[228:231]
ds_read_b128 v[240:243], v249 offset:25856
ds_read_b128 v[244:247], v254 offset:8080
v_mfma_f32_16x16x32_f16 v[144:147], v[224:227], v[4:7], v[228:231]
s_waitcnt lgkmcnt(0)
v_mfma_f32_16x16x32_f16 v[140:143], v[240:243], v[0:3], v[244:247]
ds_read_b128 v[224:227], v249 offset:26624
ds_read_b128 v[228:231], v254 offset:16128
v_mfma_f32_16x16x32_f16 v[148:151], v[240:243], v[4:7], v[244:247]
s_waitcnt lgkmcnt(0)
v_mfma_f32_16x16x32_f16 v[152:155], v[224:227], v[0:3], v[228:231]
ds_read_b128 v[240:243], v249 offset:26880
ds_read_b128 v[244:247], v254 offset:16144
v_mfma_f32_16x16x32_f16 v[160:163], v[224:227], v[4:7], v[228:231]
s_waitcnt lgkmcnt(0)
v_mfma_f32_16x16x32_f16 v[156:159], v[240:243], v[0:3], v[244:247]
ds_read_b128 v[224:227], v249 offset:30720
ds_read_b128 v[228:231], v249 offset:30976
v_mfma_f32_16x16x32_f16 v[164:167], v[240:243], v[4:7], v[244:247]
s_waitcnt lgkmcnt(1)
v_mfma_f32_16x16x32_f16 v[120:123], v[224:227], v[8:11], v[120:123]
ds_read_b128 v[240:243], v249 offset:31744
ds_read_b128 v[244:247], v249 offset:32000
v_mfma_f32_16x16x32_f16 v[128:131], v[224:227], v[12:15], v[128:131]
s_waitcnt lgkmcnt(2)
v_mfma_f32_16x16x32_f16 v[124:127], v[228:231], v[8:11], v[124:127]
ds_read_b128 v[224:227], v249 offset:32768
v_mfma_f32_16x16x32_f16 v[132:135], v[228:231], v[12:15], v[132:135]
s_waitcnt lgkmcnt(2)
v_mfma_f32_16x16x32_f16 v[136:139], v[240:243], v[8:11], v[136:139]
ds_read_b128 v[228:231], v249 offset:33024
v_mfma_f32_16x16x32_f16 v[144:147], v[240:243], v[12:15], v[144:147]
s_waitcnt lgkmcnt(2)
v_mfma_f32_16x16x32_f16 v[140:143], v[244:247], v[8:11], v[140:143]
ds_read_b128 v[240:243], v249 offset:36864
v_mfma_f32_16x16x32_f16 v[148:151], v[244:247], v[12:15], v[148:151]
s_waitcnt lgkmcnt(2)
v_mfma_f32_16x16x32_f16 v[152:155], v[224:227], v[8:11], v[152:155]
ds_read_b128 v[244:247], v249 offset:37120
v_mfma_f32_16x16x32_f16 v[160:163], v[224:227], v[12:15], v[160:163]
s_waitcnt lgkmcnt(2)
v_mfma_f32_16x16x32_f16 v[156:159], v[228:231], v[8:11], v[156:159]
ds_read_b128 v[224:227], v249 offset:37888
v_mfma_f32_16x16x32_f16 v[164:167], v[228:231], v[12:15], v[164:167]
s_waitcnt lgkmcnt(2)
v_mfma_f32_16x16x32_f16 v[120:123], v[240:243], v[16:19], v[120:123]
buffer_load_dwordx4 v[12:15], v252, s[4:7], s71 offen
ds_read_b128 v[228:231], v249 offset:38144
v_mfma_f32_16x16x32_f16 v[128:131], v[240:243], v[20:23], v[128:131]
s_waitcnt lgkmcnt(2)
v_mfma_f32_16x16x32_f16 v[124:127], v[244:247], v[16:19], v[124:127]
ds_read_b128 v[240:243], v249 offset:38912
v_mfma_f32_16x16x32_f16 v[132:135], v[244:247], v[20:23], v[132:135]
s_waitcnt lgkmcnt(2)
v_mfma_f32_16x16x32_f16 v[136:139], v[224:227], v[16:19], v[136:139]
ds_read_b128 v[244:247], v249 offset:39168
v_mfma_f32_16x16x32_f16 v[144:147], v[224:227], v[20:23], v[144:147]
s_waitcnt lgkmcnt(2)
v_mfma_f32_16x16x32_f16 v[140:143], v[228:231], v[16:19], v[140:143]
buffer_load_dwordx4 v[8:11], v252, s[4:7], s71 offen offset:64
ds_read_b128 v[224:227], v249 offset:43008
v_mfma_f32_16x16x32_f16 v[148:151], v[228:231], v[20:23], v[148:151]
s_waitcnt lgkmcnt(2)
v_mfma_f32_16x16x32_f16 v[152:155], v[240:243], v[16:19], v[152:155]
ds_read_b128 v[228:231], v249 offset:43264
v_mfma_f32_16x16x32_f16 v[160:163], v[240:243], v[20:23], v[160:163]
s_waitcnt lgkmcnt(2)
v_mfma_f32_16x16x32_f16 v[156:159], v[244:247], v[16:19], v[156:159]
ds_read_b128 v[240:243], v249 offset:44032
v_mfma_f32_16x16x32_f16 v[164:167], v[244:247], v[20:23], v[164:167]
s_waitcnt lgkmcnt(2)
v_mfma_f32_16x16x32_f16 v[120:123], v[224:227], v[24:27], v[120:123]
buffer_load_dwordx4 v[4:7], v252, s[4:7], s71 offen offset:128
ds_read_b128 v[244:247], v249 offset:44288
v_mfma_f32_16x16x32_f16 v[128:131], v[224:227], v[28:31], v[128:131]
s_waitcnt lgkmcnt(2)
v_mfma_f32_16x16x32_f16 v[124:127], v[228:231], v[24:27], v[124:127]
ds_read_b128 v[224:227], v249 offset:45056
v_mfma_f32_16x16x32_f16 v[132:135], v[228:231], v[28:31], v[132:135]
s_waitcnt lgkmcnt(2)
v_mfma_f32_16x16x32_f16 v[136:139], v[240:243], v[24:27], v[136:139]
ds_read_b128 v[228:231], v249 offset:45312
v_mfma_f32_16x16x32_f16 v[144:147], v[240:243], v[28:31], v[144:147]
s_waitcnt lgkmcnt(2)
v_mfma_f32_16x16x32_f16 v[140:143], v[244:247], v[24:27], v[140:143]
s_add_u32 s46, s71, 98304
buffer_load_dwordx4 v[0:3], v252, s[4:7], s46 offen
ds_read_b128 v[240:243], v249 offset:49152
v_mfma_f32_16x16x32_f16 v[148:151], v[244:247], v[28:31], v[148:151]
s_waitcnt lgkmcnt(2)
v_mfma_f32_16x16x32_f16 v[152:155], v[224:227], v[24:27], v[152:155]
ds_read_b128 v[244:247], v249 offset:49408
v_mfma_f32_16x16x32_f16 v[160:163], v[224:227], v[28:31], v[160:163]
s_waitcnt lgkmcnt(2)
v_mfma_f32_16x16x32_f16 v[156:159], v[228:231], v[24:27], v[156:159]
ds_read_b128 v[224:227], v249 offset:50176
v_mfma_f32_16x16x32_f16 v[164:167], v[228:231], v[28:31], v[164:167]
s_waitcnt lgkmcnt(2)
v_mfma_f32_16x16x32_f16 v[120:123], v[240:243], v[32:35], v[120:123]
buffer_load_dwordx4 v[24:27], v253, s[32:35], s80 offen nt
ds_read_b128 v[228:231], v249 offset:50432
v_mfma_f32_16x16x32_f16 v[128:131], v[240:243], v[36:39], v[128:131]
v_and_b32 v16, 1, v251
s_waitcnt lgkmcnt(2)
v_mfma_f32_16x16x32_f16 v[124:127], v[244:247], v[32:35], v[124:127]
ds_read_b128 v[240:243], v249 offset:51200
v_mfma_f32_16x16x32_f16 v[132:135], v[244:247], v[36:39], v[132:135]
v_lshlrev_b32 v16, 4, v16
s_waitcnt lgkmcnt(2)
v_mfma_f32_16x16x32_f16 v[136:139], v[224:227], v[32:35], v[136:139]
ds_read_b128 v[244:247], v249 offset:51456
v_mov_b32 v17, 16256
v_mfma_f32_16x16x32_f16 v[144:147], v[224:227], v[36:39], v[144:147]
s_waitcnt lgkmcnt(2)
v_mfma_f32_16x16x32_f16 v[140:143], v[228:231], v[32:35], v[140:143]
ds_read_b128 v[224:227], v249 offset:55296
v_lshlrev_b32 v16, v16, v17
v_mfma_f32_16x16x32_f16 v[148:151], v[228:231], v[36:39], v[148:151]
v_lshrrev_b32 v17, 2, v251
s_waitcnt lgkmcnt(2)
v_mfma_f32_16x16x32_f16 v[152:155], v[240:243], v[32:35], v[152:155]
ds_read_b128 v[228:231], v249 offset:55552
v_mfma_f32_16x16x32_f16 v[160:163], v[240:243], v[36:39], v[160:163]
v_xor_b32 v17, v17, v251
s_waitcnt lgkmcnt(2)
v_mfma_f32_16x16x32_f16 v[156:159], v[244:247], v[32:35], v[156:159]
ds_read_b128 v[240:243], v249 offset:56320
v_mfma_f32_16x16x32_f16 v[164:167], v[244:247], v[36:39], v[164:167]
v_and_b32 v17, 12, v17
s_waitcnt lgkmcnt(2)
v_mfma_f32_16x16x32_f16 v[120:123], v[224:227], v[40:43], v[120:123]
buffer_load_dwordx4 v[28:31], v253, s[32:35], s80 offen offset:256 nt
ds_read_b128 v[244:247], v249 offset:56576
v_and_b32 v20, 2, v251
v_mfma_f32_16x16x32_f16 v[128:131], v[224:227], v[44:47], v[128:131]
s_waitcnt lgkmcnt(2)
v_mfma_f32_16x16x32_f16 v[124:127], v[228:231], v[40:43], v[124:127]
ds_read_b128 v[224:227], v249 offset:57344
v_or_b32_e64 v17, v17, v20
v_mfma_f32_16x16x32_f16 v[132:135], v[228:231], v[44:47], v[132:135]
v_cmp_eq_u32 vcc, 0, v17
s_nop 1
v_cndmask_b32 v18, 0, v16, vcc
s_waitcnt lgkmcnt(2)
v_mfma_f32_16x16x32_f16 v[136:139], v[240:243], v[40:43], v[136:139]
ds_read_b128 v[228:231], v249 offset:57600
v_mfma_f32_16x16x32_f16 v[144:147], v[240:243], v[44:47], v[144:147]
v_cmp_eq_u32 vcc, 2, v17
s_nop 1
v_cndmask_b32 v19, 0, v16, vcc
s_waitcnt lgkmcnt(2)
v_mfma_f32_16x16x32_f16 v[140:143], v[244:247], v[40:43], v[140:143]
ds_read_b128 v[240:243], v249 offset:61440
v_mfma_f32_16x16x32_f16 v[148:151], v[244:247], v[44:47], v[148:151]
v_mov_b32 v16, 0
s_waitcnt lgkmcnt(2)
v_mfma_f32_16x16x32_f16 v[152:155], v[224:227], v[40:43], v[152:155]
ds_read_b128 v[244:247], v249 offset:61696
v_mov_b32 v17, 0
v_mfma_f32_16x16x32_f16 v[160:163], v[224:227], v[44:47], v[160:163]
s_waitcnt lgkmcnt(2)
v_mfma_f32_16x16x32_f16 v[156:159], v[228:231], v[40:43], v[156:159]
ds_read_b128 v[224:227], v249 offset:62464
v_mov_b32_e64 v20, 0
v_mfma_f32_16x16x32_f16 v[164:167], v[228:231], v[44:47], v[164:167]
v_mov_b32 v21, 0
s_waitcnt lgkmcnt(2)
v_mfma_f32_16x16x32_f16 v[120:123], v[240:243], v[48:51], v[120:123]
s_add_u32 s46, s80, 4194304
buffer_load_dwordx4 v[32:35], v253, s[32:35], s46 offen nt
ds_read_b128 v[228:231], v249 offset:62720
v_mfma_f32_16x16x32_f16 v[128:131], v[240:243], v[52:55], v[128:131]
s_waitcnt lgkmcnt(2)
v_mfma_f32_16x16x32_f16 v[124:127], v[244:247], v[48:51], v[124:127]
ds_read_b128 v[240:243], v249 offset:63488
v_mfma_f32_16x16x32_f16 v[132:135], v[244:247], v[52:55], v[132:135]
s_waitcnt lgkmcnt(2)
v_mfma_f32_16x16x32_f16 v[136:139], v[224:227], v[48:51], v[136:139]
ds_read_b128 v[244:247], v249 offset:63744
v_mfma_f32_16x16x32_f16 v[144:147], v[224:227], v[52:55], v[144:147]
s_waitcnt lgkmcnt(2)
v_mfma_f32_16x16x32_f16 v[140:143], v[228:231], v[48:51], v[140:143]
ds_read_b128 v[224:227], v250 offset:2048
v_mfma_f32_16x16x32_f16 v[148:151], v[228:231], v[52:55], v[148:151]
s_waitcnt lgkmcnt(2)
v_mfma_f32_16x16x32_f16 v[152:155], v[240:243], v[48:51], v[152:155]
ds_read_b128 v[228:231], v250 offset:2304
v_mfma_f32_16x16x32_f16 v[160:163], v[240:243], v[52:55], v[160:163]
s_waitcnt lgkmcnt(2)
v_mfma_f32_16x16x32_f16 v[156:159], v[244:247], v[48:51], v[156:159]
ds_read_b128 v[240:243], v250 offset:3072
v_mfma_f32_16x16x32_f16 v[164:167], v[244:247], v[52:55], v[164:167]
s_waitcnt lgkmcnt(2)
v_mfma_f32_16x16x32_f16 v[120:123], v[224:227], v[56:59], v[120:123]
ds_read_b128 v[244:247], v250 offset:3328
v_mfma_f32_16x16x32_f16 v[128:131], v[224:227], v[60:63], v[128:131]
s_waitcnt lgkmcnt(2)
v_mfma_f32_16x16x32_f16 v[124:127], v[228:231], v[56:59], v[124:127]
s_add_u32 s46, s80, 4194304
buffer_load_dwordx4 v[36:39], v253, s[32:35], s46 offen offset:256 nt
ds_read_b128 v[224:227], v250 offset:4096
v_mfma_f32_16x16x32_f16 v[132:135], v[228:231], v[60:63], v[132:135]
s_waitcnt lgkmcnt(2)
v_mfma_f32_16x16x32_f16 v[136:139], v[240:243], v[56:59], v[136:139]
ds_read_b128 v[228:231], v250 offset:4352
v_mfma_f32_16x16x32_f16 v[144:147], v[240:243], v[60:63], v[144:147]
s_waitcnt lgkmcnt(2)
v_mfma_f32_16x16x32_f16 v[140:143], v[244:247], v[56:59], v[140:143]
ds_read_b128 v[240:243], v250 offset:8192
v_mfma_f32_16x16x32_f16 v[148:151], v[244:247], v[60:63], v[148:151]
s_waitcnt lgkmcnt(2)
v_mfma_f32_16x16x32_f16 v[152:155], v[224:227], v[56:59], v[152:155]
ds_read_b128 v[244:247], v250 offset:8448
v_mfma_f32_16x16x32_f16 v[160:163], v[224:227], v[60:63], v[160:163]
s_waitcnt lgkmcnt(2)
v_mfma_f32_16x16x32_f16 v[156:159], v[228:231], v[56:59], v[156:159]
ds_read_b128 v[224:227], v250 offset:9216
v_mfma_f32_16x16x32_f16 v[164:167], v[228:231], v[60:63], v[164:167]
s_waitcnt vmcnt(7)
v_mfma_f32_16x16x32_bf16 v[120:123], v[18:21], v[12:15], v[120:123]
ds_read_b128 v[228:231], v250 offset:9472
v_mfma_f32_16x16x32_bf16 v[124:127], v[16:19], v[12:15], v[124:127]
s_waitcnt vmcnt(6)
v_mfma_f32_16x16x32_bf16 v[136:139], v[18:21], v[8:11], v[136:139]
v_mfma_f32_16x16x32_bf16 v[140:143], v[16:19], v[8:11], v[140:143]
s_waitcnt lgkmcnt(3)
v_mfma_f32_16x16x32_f16 v[120:123], v[240:243], v[64:67], v[120:123]
s_add_u32 s46, s80, 8388608
buffer_load_dwordx4 v[40:43], v253, s[32:35], s46 offen nt
v_mfma_f32_16x16x32_f16 v[128:131], v[240:243], v[68:71], v[128:131]
s_waitcnt lgkmcnt(2)
v_mfma_f32_16x16x32_f16 v[124:127], v[244:247], v[64:67], v[124:127]
ds_read_b128 v[240:243], v250 offset:10240
v_mfma_f32_16x16x32_f16 v[132:135], v[244:247], v[68:71], v[132:135]
s_waitcnt lgkmcnt(2)
v_mfma_f32_16x16x32_f16 v[136:139], v[224:227], v[64:67], v[136:139]
ds_read_b128 v[244:247], v250 offset:10496
v_mfma_f32_16x16x32_f16 v[144:147], v[224:227], v[68:71], v[144:147]
s_waitcnt lgkmcnt(2)
v_mfma_f32_16x16x32_f16 v[140:143], v[228:231], v[64:67], v[140:143]
ds_read_b128 v[224:227], v250 offset:14336
v_mfma_f32_16x16x32_f16 v[148:151], v[228:231], v[68:71], v[148:151]
s_waitcnt lgkmcnt(2)
v_mfma_f32_16x16x32_f16 v[152:155], v[240:243], v[64:67], v[152:155]
s_add_u32 s46, s80, 8388608
buffer_load_dwordx4 v[44:47], v253, s[32:35], s46 offen offset:256 nt
ds_read_b128 v[228:231], v250 offset:14592
v_mfma_f32_16x16x32_f16 v[160:163], v[240:243], v[68:71], v[160:163]
s_waitcnt lgkmcnt(2)
v_mfma_f32_16x16x32_f16 v[156:159], v[244:247], v[64:67], v[156:159]
ds_read_b128 v[240:243], v250 offset:15360
v_mfma_f32_16x16x32_f16 v[164:167], v[244:247], v[68:71], v[164:167]
s_waitcnt lgkmcnt(2)
v_mfma_f32_16x16x32_f16 v[120:123], v[224:227], v[72:75], v[120:123]
ds_read_b128 v[244:247], v250 offset:15616
v_mfma_f32_16x16x32_f16 v[128:131], v[224:227], v[76:79], v[128:131]
s_waitcnt lgkmcnt(2)
v_mfma_f32_16x16x32_f16 v[124:127], v[228:231], v[72:75], v[124:127]
s_add_u32 s46, s71, 98304
buffer_load_dwordx4 v[8:11], v252, s[4:7], s46 offen offset:64
ds_read_b128 v[224:227], v250 offset:16384
v_mfma_f32_16x16x32_f16 v[132:135], v[228:231], v[76:79], v[132:135]
s_waitcnt lgkmcnt(2)
v_mfma_f32_16x16x32_f16 v[136:139], v[240:243], v[72:75], v[136:139]
ds_read_b128 v[228:231], v250 offset:16640
v_mfma_f32_16x16x32_f16 v[144:147], v[240:243], v[76:79], v[144:147]
s_waitcnt lgkmcnt(2)
v_mfma_f32_16x16x32_f16 v[140:143], v[244:247], v[72:75], v[140:143]
ds_read_b128 v[240:243], v250 offset:20480
v_mfma_f32_16x16x32_f16 v[148:151], v[244:247], v[76:79], v[148:151]
s_waitcnt lgkmcnt(2)
v_mfma_f32_16x16x32_f16 v[152:155], v[224:227], v[72:75], v[152:155]
ds_read_b128 v[244:247], v250 offset:20736
v_mfma_f32_16x16x32_f16 v[160:163], v[224:227], v[76:79], v[160:163]
s_waitcnt lgkmcnt(2)
v_mfma_f32_16x16x32_f16 v[156:159], v[228:231], v[72:75], v[156:159]
s_add_u32 s46, s71, 98304
buffer_load_dwordx4 v[12:15], v252, s[4:7], s46 offen offset:128
ds_read_b128 v[224:227], v250 offset:21504
v_mfma_f32_16x16x32_f16 v[164:167], v[228:231], v[76:79], v[164:167]
s_waitcnt vmcnt(9)
v_mfma_f32_16x16x32_bf16 v[152:155], v[18:21], v[4:7], v[152:155]
ds_read_b128 v[228:231], v250 offset:21760
v_mfma_f32_16x16x32_bf16 v[156:159], v[16:19], v[4:7], v[156:159]
s_waitcnt vmcnt(8)
v_mfma_f32_16x16x32_bf16 v[128:131], v[18:21], v[0:3], v[128:131]
v_mfma_f32_16x16x32_bf16 v[132:135], v[16:19], v[0:3], v[132:135]
v_and_b32 v255, 1, v251
v_lshlrev_b32 v255, 7, v255
v_sub_u32 v255, v252, v255
s_mov_b32 s74, 1431655765
s_mov_b32 s75, 1431655765
s_waitcnt lgkmcnt(3)
v_mfma_f32_16x16x32_f16 v[120:123], v[240:243], v[80:83], v[120:123]
buffer_load_dwordx4 v[4:7], v252, s[4:7], s70 offen
v_mfma_f32_16x16x32_f16 v[128:131], v[240:243], v[84:87], v[128:131]
s_waitcnt lgkmcnt(2)
v_mfma_f32_16x16x32_f16 v[124:127], v[244:247], v[80:83], v[124:127]
ds_read_b128 v[240:243], v250 offset:22528
v_mfma_f32_16x16x32_f16 v[132:135], v[244:247], v[84:87], v[132:135]
s_waitcnt lgkmcnt(2)
v_mfma_f32_16x16x32_f16 v[136:139], v[224:227], v[80:83], v[136:139]
ds_read_b128 v[244:247], v250 offset:22784
v_mfma_f32_16x16x32_f16 v[144:147], v[224:227], v[84:87], v[144:147]
s_waitcnt lgkmcnt(2)
v_mfma_f32_16x16x32_f16 v[140:143], v[228:231], v[80:83], v[140:143]
ds_read_b128 v[224:227], v250 offset:26624
v_mfma_f32_16x16x32_f16 v[148:151], v[228:231], v[84:87], v[148:151]
s_waitcnt lgkmcnt(2)
v_mfma_f32_16x16x32_f16 v[152:155], v[240:243], v[80:83], v[152:155]
ds_read_b128 v[228:231], v250 offset:26880
v_mfma_f32_16x16x32_f16 v[160:163], v[240:243], v[84:87], v[160:163]
s_waitcnt lgkmcnt(2)
v_mfma_f32_16x16x32_f16 v[156:159], v[244:247], v[80:83], v[156:159]
ds_read_b128 v[240:243], v250 offset:27648
v_mfma_f32_16x16x32_f16 v[164:167], v[244:247], v[84:87], v[164:167]
s_waitcnt lgkmcnt(2)
v_mfma_f32_16x16x32_f16 v[120:123], v[224:227], v[88:91], v[120:123]
buffer_load_dwordx4 v[0:3], v252, s[4:7], s70 offen offset:64
ds_read_b128 v[244:247], v250 offset:27904
v_mfma_f32_16x16x32_f16 v[128:131], v[224:227], v[92:95], v[128:131]
s_waitcnt lgkmcnt(2)
v_mfma_f32_16x16x32_f16 v[124:127], v[228:231], v[88:91], v[124:127]
ds_read_b128 v[224:227], v250 offset:28672
v_mfma_f32_16x16x32_f16 v[132:135], v[228:231], v[92:95], v[132:135]
s_waitcnt lgkmcnt(2)
v_mfma_f32_16x16x32_f16 v[136:139], v[240:243], v[88:91], v[136:139]
ds_read_b128 v[228:231], v250 offset:28928
v_mfma_f32_16x16x32_f16 v[144:147], v[240:243], v[92:95], v[144:147]
s_waitcnt lgkmcnt(2)
v_mfma_f32_16x16x32_f16 v[140:143], v[244:247], v[88:91], v[140:143]
ds_read_b128 v[240:243], v249 offset:49152
v_mfma_f32_16x16x32_f16 v[148:151], v[244:247], v[92:95], v[148:151]
s_waitcnt lgkmcnt(2)
v_mfma_f32_16x16x32_f16 v[152:155], v[224:227], v[88:91], v[152:155]
ds_read_b128 v[244:247], v254 offset:7936
v_mfma_f32_16x16x32_f16 v[160:163], v[224:227], v[92:95], v[160:163]
s_waitcnt lgkmcnt(2)
v_mfma_f32_16x16x32_f16 v[156:159], v[228:231], v[88:91], v[156:159]
ds_read_b128 v[224:227], v249 offset:49408
v_mfma_f32_16x16x32_f16 v[164:167], v[228:231], v[92:95], v[164:167]
s_waitcnt lgkmcnt(1)
v_mfma_f32_16x16x32_f16 v[48:51], v[240:243], v[168:171], v[244:247]
ds_read_b128 v[228:231], v254 offset:7952
v_mfma_f32_16x16x32_f16 v[56:59], v[240:243], v[172:175], v[244:247]
s_waitcnt lgkmcnt(0)
v_mfma_f32_16x16x32_f16 v[52:55], v[224:227], v[168:171], v[228:231]
ds_read_b128 v[240:243], v249 offset:50176
ds_read_b128 v[244:247], v254 offset:8064
v_mfma_f32_16x16x32_f16 v[60:63], v[224:227], v[172:175], v[228:231]
s_waitcnt lgkmcnt(0)
v_mfma_f32_16x16x32_f16 v[64:67], v[240:243], v[168:171], v[244:247]
ds_read_b128 v[224:227], v249 offset:50432
ds_read_b128 v[228:231], v254 offset:8080
v_mfma_f32_16x16x32_f16 v[72:75], v[240:243], v[172:175], v[244:247]
s_waitcnt lgkmcnt(0)
v_mfma_f32_16x16x32_f16 v[68:71], v[224:227], v[168:171], v[228:231]
ds_read_b128 v[240:243], v249 offset:51200
ds_read_b128 v[244:247], v254 offset:16128
v_cvt_pk_bf16_f32 v136, v136, v137
v_mfma_f32_16x16x32_f16 v[76:79], v[224:227], v[172:175], v[228:231]
v_cvt_pk_bf16_f32 v137, v138, v139
s_waitcnt lgkmcnt(0)
v_mfma_f32_16x16x32_f16 v[80:83], v[240:243], v[168:171], v[244:247]
ds_read_b128 v[224:227], v249 offset:51456
ds_read_b128 v[228:231], v254 offset:16144
v_cvt_pk_bf16_f32 v138, v140, v141
v_mfma_f32_16x16x32_f16 v[88:91], v[240:243], v[172:175], v[244:247]
v_cvt_pk_bf16_f32 v139, v142, v143
s_waitcnt lgkmcnt(0)
v_mfma_f32_16x16x32_f16 v[84:87], v[224:227], v[168:171], v[228:231]
ds_read_b128 v[240:243], v249 offset:55296
ds_read_b128 v[244:247], v249 offset:55552
v_cvt_pk_bf16_f32 v120, v120, v121
v_mfma_f32_16x16x32_f16 v[92:95], v[224:227], v[172:175], v[228:231]
v_cvt_pk_bf16_f32 v121, v122, v123
s_waitcnt lgkmcnt(1)
v_mfma_f32_16x16x32_f16 v[48:51], v[240:243], v[176:179], v[48:51]
ds_read_b128 v[224:227], v249 offset:56320
ds_read_b128 v[228:231], v249 offset:56576
v_cvt_pk_bf16_f32 v122, v124, v125
v_mfma_f32_16x16x32_f16 v[56:59], v[240:243], v[180:183], v[56:59]
v_cvt_pk_bf16_f32 v123, v126, v127
s_waitcnt lgkmcnt(2)
v_mfma_f32_16x16x32_f16 v[52:55], v[244:247], v[176:179], v[52:55]
ds_read_b128 v[240:243], v249 offset:57344
v_cvt_pk_bf16_f32 v152, v152, v153
v_cvt_pk_bf16_f32 v153, v154, v155
v_mfma_f32_16x16x32_f16 v[60:63], v[244:247], v[180:183], v[60:63]
v_cvt_pk_bf16_f32 v154, v156, v157
s_waitcnt lgkmcnt(2)
v_mfma_f32_16x16x32_f16 v[64:67], v[224:227], v[176:179], v[64:67]
ds_read_b128 v[244:247], v249 offset:57600
v_cvt_pk_bf16_f32 v155, v158, v159
s_mov_b64 vcc, s[74:75]
v_mfma_f32_16x16x32_f16 v[72:75], v[224:227], v[180:183], v[72:75]
v_cndmask_b32 v140, v120, v152, vcc
s_waitcnt lgkmcnt(2)
v_mfma_f32_16x16x32_f16 v[68:71], v[228:231], v[176:179], v[68:71]
ds_read_b128 v[224:227], v249 offset:61440
v_cndmask_b32 v141, v121, v153, vcc
v_mfma_f32_16x16x32_f16 v[76:79], v[228:231], v[180:183], v[76:79]
v_cndmask_b32 v142, v122, v154, vcc
s_waitcnt lgkmcnt(2)
v_mfma_f32_16x16x32_f16 v[80:83], v[240:243], v[176:179], v[80:83]
ds_read_b128 v[228:231], v249 offset:61696
v_cndmask_b32 v143, v123, v155, vcc
v_mfma_f32_16x16x32_f16 v[88:91], v[240:243], v[180:183], v[88:91]
v_cndmask_b32_dpp v120, v136, v120, vcc quad_perm:[1,0,3,2] row_mask:0xf bank_mask:0xf
s_waitcnt lgkmcnt(2)
v_mfma_f32_16x16x32_f16 v[84:87], v[244:247], v[176:179], v[84:87]
ds_read_b128 v[240:243], v248 offset:16384
v_cndmask_b32_dpp v121, v137, v121, vcc quad_perm:[1,0,3,2] row_mask:0xf bank_mask:0xf
v_mfma_f32_16x16x32_f16 v[92:95], v[244:247], v[180:183], v[92:95]
v_cndmask_b32_dpp v122, v138, v122, vcc quad_perm:[1,0,3,2] row_mask:0xf bank_mask:0xf
s_waitcnt vmcnt(3)
v_mfma_f32_16x16x32_bf16 v[144:147], v[18:21], v[8:11], v[144:147]
ds_read_b128 v[244:247], v249 offset:62464
v_cndmask_b32_dpp v123, v139, v123, vcc quad_perm:[1,0,3,2] row_mask:0xf bank_mask:0xf
s_not_b64 vcc, s[74:75]
v_mfma_f32_16x16x32_bf16 v[148:151], v[16:19], v[8:11], v[148:151]
v_cndmask_b32_dpp v152, v136, v152, vcc quad_perm:[1,0,3,2] row_mask:0xf bank_mask:0xf
s_waitcnt vmcnt(2)
v_mfma_f32_16x16x32_bf16 v[160:163], v[18:21], v[12:15], v[160:163]
v_cndmask_b32_dpp v153, v137, v153, vcc quad_perm:[1,0,3,2] row_mask:0xf bank_mask:0xf
v_mfma_f32_16x16x32_bf16 v[164:167], v[16:19], v[12:15], v[164:167]
v_cndmask_b32_dpp v154, v138, v154, vcc quad_perm:[1,0,3,2] row_mask:0xf bank_mask:0xf
v_cndmask_b32_dpp v155, v139, v155, vcc quad_perm:[1,0,3,2] row_mask:0xf bank_mask:0xf
s_waitcnt lgkmcnt(3)
v_mfma_f32_16x16x32_f16 v[48:51], v[224:227], v[184:187], v[48:51]
buffer_load_dwordx4 v[8:11], v252, s[4:7], s70 offen offset:128
buffer_store_dwordx4 v[120:123], v255, s[8:11], s71 offen sc1
v_mfma_f32_16x16x32_f16 v[56:59], v[224:227], v[188:191], v[56:59]
s_waitcnt lgkmcnt(2)
v_mfma_f32_16x16x32_f16 v[52:55], v[228:231], v[184:187], v[52:55]
ds_read_b128 v[224:227], v249 offset:62720
v_mfma_f32_16x16x32_f16 v[60:63], v[228:231], v[188:191], v[60:63]
s_waitcnt lgkmcnt(2)
v_mfma_f32_16x16x32_bf16 v[168:171], v[240:243], v[96:99], 0
ds_read_b128 v[228:231], v249 offset:63488
v_mfma_f32_16x16x32_bf16 v[176:179], v[240:243], v[100:103], 0
s_waitcnt lgkmcnt(2)
v_mfma_f32_16x16x32_f16 v[64:67], v[244:247], v[184:187], v[64:67]
ds_read_b128 v[240:243], v249 offset:63744
v_mfma_f32_16x16x32_f16 v[72:75], v[244:247], v[188:191], v[72:75]
s_waitcnt lgkmcnt(2)
v_mfma_f32_16x16x32_f16 v[68:71], v[224:227], v[184:187], v[68:71]
ds_read_b128 v[244:247], v248 offset:16640
v_mfma_f32_16x16x32_f16 v[76:79], v[224:227], v[188:191], v[76:79]
s_waitcnt lgkmcnt(2)
v_mfma_f32_16x16x32_f16 v[80:83], v[228:231], v[184:187], v[80:83]
s_add_u32 s46, s70, 98304
buffer_load_dwordx4 v[12:15], v252, s[4:7], s46 offen
ds_read_b128 v[224:227], v250 offset:2048
v_mfma_f32_16x16x32_f16 v[88:91], v[228:231], v[188:191], v[88:91]
s_waitcnt lgkmcnt(2)
v_mfma_f32_16x16x32_f16 v[84:87], v[240:243], v[184:187], v[84:87]
ds_read_b128 v[228:231], v250 offset:2304
v_mfma_f32_16x16x32_f16 v[92:95], v[240:243], v[188:191], v[92:95]
s_waitcnt lgkmcnt(2)
v_mfma_f32_16x16x32_bf16 v[172:175], v[244:247], v[96:99], 0
ds_read_b128 v[240:243], v250 offset:3072
v_mfma_f32_16x16x32_bf16 v[180:183], v[244:247], v[100:103], 0
s_waitcnt lgkmcnt(2)
v_mfma_f32_16x16x32_f16 v[48:51], v[224:227], v[192:195], v[48:51]
ds_read_b128 v[244:247], v250 offset:3328
v_mfma_f32_16x16x32_f16 v[56:59], v[224:227], v[196:199], v[56:59]
s_waitcnt lgkmcnt(2)
v_mfma_f32_16x16x32_f16 v[52:55], v[228:231], v[192:195], v[52:55]
ds_read_b128 v[224:227], v248 offset:17408
v_mfma_f32_16x16x32_f16 v[60:63], v[228:231], v[196:199], v[60:63]
s_waitcnt lgkmcnt(2)
v_mfma_f32_16x16x32_f16 v[64:67], v[240:243], v[192:195], v[64:67]
buffer_store_dwordx4 v[140:143], v255, s[8:11], s71 offen offset:128 sc1
ds_read_b128 v[228:231], v250 offset:4096
v_mfma_f32_16x16x32_f16 v[72:75], v[240:243], v[196:199], v[72:75]
s_waitcnt lgkmcnt(2)
v_mfma_f32_16x16x32_f16 v[68:71], v[244:247], v[192:195], v[68:71]
ds_read_b128 v[240:243], v250 offset:4352
v_mfma_f32_16x16x32_f16 v[76:79], v[244:247], v[196:199], v[76:79]
s_waitcnt lgkmcnt(2)
v_mfma_f32_16x16x32_bf16 v[168:171], v[224:227], v[104:107], v[168:171]
ds_read_b128 v[244:247], v250 offset:8192
v_mfma_f32_16x16x32_bf16 v[176:179], v[224:227], v[108:111], v[176:179]
s_waitcnt lgkmcnt(2)
v_mfma_f32_16x16x32_f16 v[80:83], v[228:231], v[192:195], v[80:83]
ds_read_b128 v[224:227], v250 offset:8448
v_mfma_f32_16x16x32_f16 v[88:91], v[228:231], v[196:199], v[88:91]
s_waitcnt lgkmcnt(2)
v_mfma_f32_16x16x32_f16 v[84:87], v[240:243], v[192:195], v[84:87]
ds_read_b128 v[228:231], v248 offset:17664
v_mfma_f32_16x16x32_f16 v[92:95], v[240:243], v[196:199], v[92:95]
s_waitcnt lgkmcnt(2)
v_mfma_f32_16x16x32_f16 v[48:51], v[244:247], v[200:203], v[48:51]
buffer_store_dwordx4 v[152:155], v255, s[8:11], s71 offen offset:256 sc1
ds_read_b128 v[240:243], v250 offset:9216
v_mfma_f32_16x16x32_f16 v[56:59], v[244:247], v[204:207], v[56:59]
s_waitcnt lgkmcnt(2)
v_mfma_f32_16x16x32_f16 v[52:55], v[224:227], v[200:203], v[52:55]
ds_read_b128 v[244:247], v250 offset:9472
v_mfma_f32_16x16x32_f16 v[60:63], v[224:227], v[204:207], v[60:63]
s_waitcnt lgkmcnt(2)
v_mfma_f32_16x16x32_bf16 v[172:175], v[228:231], v[104:107], v[172:175]
ds_read_b128 v[224:227], v250 offset:10240
v_mfma_f32_16x16x32_bf16 v[180:183], v[228:231], v[108:111], v[180:183]
s_waitcnt lgkmcnt(2)
v_mfma_f32_16x16x32_f16 v[64:67], v[240:243], v[200:203], v[64:67]
ds_read_b128 v[228:231], v250 offset:10496
v_mfma_f32_16x16x32_f16 v[72:75], v[240:243], v[204:207], v[72:75]
s_waitcnt lgkmcnt(2)
v_mfma_f32_16x16x32_f16 v[68:71], v[244:247], v[200:203], v[68:71]
ds_read_b128 v[240:243], v248 offset:18432
v_mfma_f32_16x16x32_f16 v[76:79], v[244:247], v[204:207], v[76:79]
s_waitcnt lgkmcnt(2)
v_mfma_f32_16x16x32_f16 v[80:83], v[224:227], v[200:203], v[80:83]
ds_read_b128 v[244:247], v250 offset:14336
v_mfma_f32_16x16x32_f16 v[88:91], v[224:227], v[204:207], v[88:91]
s_waitcnt lgkmcnt(2)
v_mfma_f32_16x16x32_f16 v[84:87], v[228:231], v[200:203], v[84:87]
ds_read_b128 v[224:227], v250 offset:14592
v_mfma_f32_16x16x32_f16 v[92:95], v[228:231], v[204:207], v[92:95]
s_waitcnt lgkmcnt(2)
v_mfma_f32_16x16x32_bf16 v[168:171], v[240:243], v[112:115], v[168:171]
ds_read_b128 v[228:231], v250 offset:15360
v_mfma_f32_16x16x32_bf16 v[176:179], v[240:243], v[116:119], v[176:179]
s_waitcnt lgkmcnt(2)
v_mfma_f32_16x16x32_f16 v[48:51], v[244:247], v[232:235], v[48:51]
ds_read_b128 v[240:243], v250 offset:15616
v_mfma_f32_16x16x32_f16 v[56:59], v[244:247], v[236:239], v[56:59]
s_waitcnt lgkmcnt(2)
v_mfma_f32_16x16x32_f16 v[52:55], v[224:227], v[232:235], v[52:55]
ds_read_b128 v[244:247], v248 offset:18688
v_mfma_f32_16x16x32_f16 v[60:63], v[224:227], v[236:239], v[60:63]
s_waitcnt lgkmcnt(2)
v_mfma_f32_16x16x32_f16 v[64:67], v[228:231], v[232:235], v[64:67]
ds_read_b128 v[224:227], v250 offset:16384
v_mfma_f32_16x16x32_f16 v[72:75], v[228:231], v[236:239], v[72:75]
s_waitcnt lgkmcnt(2)
v_mfma_f32_16x16x32_f16 v[68:71], v[240:243], v[232:235], v[68:71]
ds_read_b128 v[228:231], v250 offset:16640
v_mfma_f32_16x16x32_f16 v[76:79], v[240:243], v[236:239], v[76:79]
s_waitcnt lgkmcnt(2)
v_mfma_f32_16x16x32_bf16 v[172:175], v[244:247], v[112:115], v[172:175]
ds_read_b128 v[240:243], v250 offset:20480
v_mfma_f32_16x16x32_bf16 v[180:183], v[244:247], v[116:119], v[180:183]
s_waitcnt lgkmcnt(2)
v_mfma_f32_16x16x32_f16 v[80:83], v[224:227], v[232:235], v[80:83]
ds_read_b128 v[244:247], v250 offset:20736
v_mfma_f32_16x16x32_f16 v[88:91], v[224:227], v[236:239], v[88:91]
s_waitcnt lgkmcnt(2)
v_mfma_f32_16x16x32_f16 v[84:87], v[228:231], v[232:235], v[84:87]
ds_read_b128 v[224:227], v250 offset:21504
v_mfma_f32_16x16x32_f16 v[92:95], v[228:231], v[236:239], v[92:95]
s_waitcnt lgkmcnt(2)
v_mfma_f32_16x16x32_f16 v[48:51], v[240:243], v[208:211], v[48:51]
ds_read_b128 v[228:231], v250 offset:21760
v_mfma_f32_16x16x32_f16 v[56:59], v[240:243], v[212:215], v[56:59]
s_waitcnt lgkmcnt(2)
v_mfma_f32_16x16x32_f16 v[52:55], v[244:247], v[208:211], v[52:55]
ds_read_b128 v[240:243], v250 offset:22528
v_mfma_f32_16x16x32_f16 v[60:63], v[244:247], v[212:215], v[60:63]
s_waitcnt lgkmcnt(2)
v_mfma_f32_16x16x32_f16 v[64:67], v[224:227], v[208:211], v[64:67]
ds_read_b128 v[244:247], v250 offset:22784
v_mfma_f32_16x16x32_f16 v[72:75], v[224:227], v[212:215], v[72:75]
s_waitcnt lgkmcnt(2)
v_mfma_f32_16x16x32_f16 v[68:71], v[228:231], v[208:211], v[68:71]
ds_read_b128 v[224:227], v250 offset:26624
v_mfma_f32_16x16x32_f16 v[76:79], v[228:231], v[212:215], v[76:79]
s_waitcnt lgkmcnt(2)
v_mfma_f32_16x16x32_f16 v[80:83], v[240:243], v[208:211], v[80:83]
ds_read_b128 v[228:231], v250 offset:26880
v_mfma_f32_16x16x32_f16 v[88:91], v[240:243], v[212:215], v[88:91]
s_waitcnt lgkmcnt(2)
v_mfma_f32_16x16x32_f16 v[84:87], v[244:247], v[208:211], v[84:87]
ds_read_b128 v[240:243], v248 offset:22528
v_mfma_f32_16x16x32_f16 v[92:95], v[244:247], v[212:215], v[92:95]
s_setprio 3
s_waitcnt lgkmcnt(2)
v_mfma_f32_16x16x32_f16 v[48:51], v[224:227], v[216:219], v[48:51]
s_add_u32 s46, s70, 98304
buffer_load_dwordx4 v[208:211], v252, s[4:7], s46 offen offset:64
ds_read_b128 v[244:247], v250 offset:27648
v_cvt_pkrtz_f16_f32 v185, v168, v169
v_cvt_pkrtz_f16_f32 v187, v170, v171
v_cvt_pkrtz_f16_f32 v189, v172, v173
v_mfma_f32_16x16x32_f16 v[56:59], v[224:227], v[220:223], v[56:59]
v_cvt_pkrtz_f16_f32 v191, v174, v175
v_cvt_pkrtz_f16_f32 v193, v176, v177
v_cvt_pk_f16_f32 v203, v178, v179
s_waitcnt lgkmcnt(2)
v_mfma_f32_16x16x32_f16 v[52:55], v[228:231], v[216:219], v[52:55]
ds_read_b128 v[224:227], v248 offset:22784
v_cvt_pk_f16_f32 v200, v180, v181
v_cvt_pk_f16_f32 v197, v182, v183
v_pk_fma_f16 v202, v203, v203, s48
v_cvt_pk_bf16_f32 v144, v144, v145
v_mfma_f32_16x16x32_f16 v[60:63], v[228:231], v[220:223], v[60:63]
v_and_b32_e64 v185, s49, v185
v_cvt_pk_bf16_f32 v145, v146, v147
v_pk_fma_f16 v199, v200, v200, s48
s_waitcnt lgkmcnt(2)
v_mfma_f32_16x16x32_bf16 v[168:171], v[240:243], v[96:99], 0
ds_read_b128 v[228:231], v250 offset:27904
v_and_b32 v187, s49, v187
v_cvt_pk_bf16_f32 v146, v148, v149
v_pk_fma_f16 v196, v197, v197, s48
v_mfma_f32_16x16x32_bf16 v[176:179], v[240:243], v[100:103], 0
v_bfe_u32 v184, v185, 2, 14
v_cvt_pk_bf16_f32 v147, v150, v151
v_pk_mul_f16 v202, v203, v202
v_cvt_pk_bf16_f32 v128, v128, v129
s_waitcnt lgkmcnt(2)
v_mfma_f32_16x16x32_f16 v[64:67], v[244:247], v[216:219], v[64:67]
ds_read_b128 v[240:243], v248 offset:23552
ds_read_u16_d16 v184, v184
v_bfe_u32 v186, v187, 2, 14
v_pk_mul_f16 v199, v200, v199
v_cvt_pk_bf16_f32 v129, v130, v131
v_mfma_f32_16x16x32_f16 v[72:75], v[244:247], v[220:223], v[72:75]
v_lshrrev_b32 v185, 18, v185
v_pk_mul_f16 v196, v197, v196
v_cvt_pk_bf16_f32 v130, v132, v133
s_waitcnt lgkmcnt(3)
v_mfma_f32_16x16x32_bf16 v[172:175], v[224:227], v[96:99], 0
ds_read_b128 v[244:247], v250 offset:28672
ds_read_u16_d16 v186, v186
ds_read_u16_d16_hi v185, v185
v_lshrrev_b32_e64 v187, 18, v187
v_cvt_pk_bf16_f32 v131, v134, v135
v_exp_f16_e64 v201, v202
v_mfma_f32_16x16x32_bf16 v[180:183], v[224:227], v[100:103], 0
v_cvt_pk_bf16_f32 v160, v160, v161
v_and_b32_e64 v189, s49, v189
v_and_b32 v191, s49, v191
s_waitcnt lgkmcnt(5)
v_mfma_f32_16x16x32_f16 v[68:71], v[228:231], v[216:219], v[68:71]
ds_read_b128 v[224:227], v250 offset:28928
ds_read_u16_d16_hi v187, v187
v_cvt_pk_bf16_f32 v161, v162, v163
v_exp_f16_e64 v198, v199
v_mfma_f32_16x16x32_f16 v[76:79], v[228:231], v[220:223], v[76:79]
v_cvt_pk_bf16_f32 v162, v164, v165
v_bfe_u32 v188, v189, 2, 14
v_cvt_pk_bf16_f32 v163, v166, v167
s_mov_b64 vcc, s[74:75]
v_bfe_u32 v190, v191, 2, 14
s_waitcnt lgkmcnt(5)
v_mfma_f32_16x16x32_bf16 v[168:171], v[240:243], v[104:107], v[168:171]
s_add_u32 s46, s70, 98304
buffer_load_dwordx4 v[204:207], v252, s[4:7], s46 offen offset:128
ds_read_b128 v[228:231], v248 offset:23808
ds_read_u16_d16 v188, v188
ds_read_u16_d16 v190, v190
v_exp_f16 v195, v196
v_cndmask_b32 v148, v128, v160, vcc
v_mfma_f32_16x16x32_bf16 v[176:179], v[240:243], v[108:111], v[176:179]
v_cndmask_b32 v149, v129, v161, vcc
v_lshrrev_b32 v189, 18, v189
v_lshrrev_b32 v191, 18, v191
s_waitcnt lgkmcnt(5)
v_mfma_f32_16x16x32_f16 v[80:83], v[244:247], v[216:219], v[80:83]
ds_read_b128 v[240:243], v248 offset:24576
ds_read_u16_d16_hi v189, v189
ds_read_u16_d16_hi v191, v191
v_cndmask_b32 v150, v130, v162, vcc
v_exp_f16_sdwa v201, v202 dst_sel:WORD_1 dst_unused:UNUSED_PRESERVE src0_sel:WORD_1
v_cndmask_b32 v151, v131, v163, vcc
v_mfma_f32_16x16x32_f16 v[88:91], v[244:247], v[220:223], v[88:91]
v_and_b32 v193, s49, v193
v_cndmask_b32_dpp v128, v144, v128, vcc quad_perm:[1,0,3,2] row_mask:0xf bank_mask:0xf
v_bfe_u32 v192, v193, 2, 14
s_waitcnt lgkmcnt(6)
v_mfma_f32_16x16x32_f16 v[84:87], v[224:227], v[216:219], v[84:87]
ds_read_b128 v[244:247], v248 offset:24832
ds_read_u16_d16 v192, v192
v_exp_f16_sdwa v198, v199 dst_sel:WORD_1 dst_unused:UNUSED_PRESERVE src0_sel:WORD_1
v_cndmask_b32_dpp v129, v145, v129, vcc quad_perm:[1,0,3,2] row_mask:0xf bank_mask:0xf
v_mfma_f32_16x16x32_f16 v[92:95], v[224:227], v[220:223], v[92:95]
v_lshrrev_b32_e64 v193, 18, v193
v_cndmask_b32_dpp v130, v146, v130, vcc quad_perm:[1,0,3,2] row_mask:0xf bank_mask:0xf
v_exp_f16_sdwa v195, v196 dst_sel:WORD_1 dst_unused:UNUSED_PRESERVE src0_sel:WORD_1
s_waitcnt lgkmcnt(5)
v_mfma_f32_16x16x32_bf16 v[172:175], v[228:231], v[104:107], v[172:175]
ds_read_b128 v[224:227], v249 offset:24576
ds_read_u16_d16_hi v193, v193
v_cndmask_b32_dpp v131, v147, v131, vcc quad_perm:[1,0,3,2] row_mask:0xf bank_mask:0xf
s_not_b64 vcc, s[74:75]
v_pk_add_f16 v201, v201, 1.0 op_sel_hi:[1,0]
v_cndmask_b32_dpp v160, v144, v160, vcc quad_perm:[1,0,3,2] row_mask:0xf bank_mask:0xf
v_mfma_f32_16x16x32_bf16 v[180:183], v[228:231], v[108:111], v[180:183]
v_pk_add_f16 v198, v198, 1.0 op_sel_hi:[1,0]
v_pk_add_f16 v195, v195, 1.0 op_sel_hi:[1,0]
v_cndmask_b32_dpp v161, v145, v161, vcc quad_perm:[1,0,3,2] row_mask:0xf bank_mask:0xf
s_waitcnt lgkmcnt(4)
v_mfma_f32_16x16x32_bf16 v[168:171], v[240:243], v[112:115], v[168:171]
ds_read_b128 v[228:231], v249 offset:24832
v_rcp_f16 v202, v201
v_cndmask_b32_dpp v162, v146, v162, vcc quad_perm:[1,0,3,2] row_mask:0xf bank_mask:0xf
v_mfma_f32_16x16x32_bf16 v[176:179], v[240:243], v[116:119], v[176:179]
v_rcp_f16 v199, v198
v_cndmask_b32_dpp v163, v147, v163, vcc quad_perm:[1,0,3,2] row_mask:0xf bank_mask:0xf
s_waitcnt lgkmcnt(3)
v_mfma_f32_16x16x32_bf16 v[172:175], v[244:247], v[112:115], v[172:175]
ds_read_b128 v[240:243], v248 offset:28672
s_add_u32 s46, s71, 98304
buffer_store_dwordx4 v[128:131], v255, s[8:11], s46 offen sc1
v_rcp_f16_e64 v196, v195
v_rcp_f16_sdwa v202, v201 dst_sel:WORD_1 dst_unused:UNUSED_PRESERVE src0_sel:WORD_1
v_mfma_f32_16x16x32_bf16 v[180:183], v[244:247], v[116:119], v[180:183]
v_rcp_f16_sdwa v199, v198 dst_sel:WORD_1 dst_unused:UNUSED_PRESERVE src0_sel:WORD_1
v_or_b32 v232, v184, v185
v_or_b32 v233, v186, v187
v_or_b32_e64 v234, v188, v189
v_rcp_f16_sdwa v196, v195 dst_sel:WORD_1 dst_unused:UNUSED_PRESERVE src0_sel:WORD_1
v_or_b32 v235, v190, v191
s_waitcnt lgkmcnt(2)
v_or_b32_e64 v236, v192, v193
v_pk_mul_f16 v237, v203, v202
v_pk_mul_f16 v238, v200, v199
v_pk_mul_f16 v239, v197, v196
v_mfma_f32_16x16x32_f16 v[48:51], v[224:227], v[232:235], v[48:51]
s_add_u32 s46, s71, 98304
buffer_store_dwordx4 v[148:151], v255, s[8:11], s46 offen offset:128 sc1
ds_read_b128 v[244:247], v249 offset:25600
ds_read_b128 v[216:219], v248 offset:28928
ds_read_b128 v[220:223], v249 offset:25856
v_cvt_pkrtz_f16_f32 v185, v168, v169
v_cvt_pkrtz_f16_f32 v187, v170, v171
v_mfma_f32_16x16x32_f16 v[56:59], v[224:227], v[236:239], v[56:59]
v_cvt_pkrtz_f16_f32 v189, v172, v173
v_cvt_pkrtz_f16_f32 v191, v174, v175
s_waitcnt lgkmcnt(3)
v_mfma_f32_16x16x32_f16 v[52:55], v[228:231], v[232:235], v[52:55]
ds_read_b128 v[224:227], v248 offset:29696
v_cvt_pkrtz_f16_f32 v193, v176, v177
v_cvt_pk_f16_f32 v203, v178, v179
v_mfma_f32_16x16x32_f16 v[60:63], v[228:231], v[236:239], v[60:63]
v_cvt_pk_f16_f32 v200, v180, v181
v_cvt_pk_f16_f32 v197, v182, v183
v_mfma_f32_16x16x32_bf16 v[168:171], v[240:243], v[96:99], 0
ds_read_b128 v[228:231], v249 offset:26624
v_pk_fma_f16 v202, v203, v203, s48
v_and_b32 v185, s49, v185
v_mfma_f32_16x16x32_bf16 v[176:179], v[240:243], v[100:103], 0
v_pk_fma_f16 v199, v200, v200, s48
v_and_b32 v187, s49, v187
s_waitcnt lgkmcnt(4)
v_mfma_f32_16x16x32_f16 v[64:67], v[244:247], v[232:235], v[64:67]
ds_read_b128 v[240:243], v249 offset:26880
v_pk_fma_f16 v196, v197, v197, s48
s_setprio 2
v_bfe_u32 v184, v185, 2, 14
v_pk_mul_f16 v202, v203, v202
v_mfma_f32_16x16x32_f16 v[72:75], v[244:247], v[236:239], v[72:75]
v_bfe_u32 v186, v187, 2, 14
v_pk_mul_f16 v199, v200, v199
s_waitcnt vmcnt(10)
v_mfma_f32_16x16x32_bf16 v[48:51], v[18:21], v[4:7], v[48:51]
ds_read_b128 v[244:247], v248 offset:29952
ds_read_u16_d16 v184, v184
ds_read_u16_d16 v186, v186
v_lshrrev_b32_e64 v185, 18, v185
v_pk_mul_f16 v196, v197, v196
v_mfma_f32_16x16x32_bf16 v[52:55], v[16:19], v[4:7], v[52:55]
v_lshrrev_b32 v187, 18, v187
s_waitcnt lgkmcnt(4)
v_mfma_f32_16x16x32_bf16 v[172:175], v[216:219], v[96:99], 0
ds_read_u16_d16_hi v185, v185
ds_read_u16_d16_hi v187, v187
v_exp_f16 v201, v202
v_and_b32 v189, s49, v189
v_mfma_f32_16x16x32_bf16 v[180:183], v[216:219], v[100:103], 0
v_and_b32_e64 v191, s49, v191
v_mfma_f32_16x16x32_f16 v[68:71], v[220:223], v[232:235], v[68:71]
ds_read_b128 v[216:219], v248 offset:30720
v_exp_f16_e64 v198, v199
v_bfe_u32 v188, v189, 2, 14
v_mfma_f32_16x16x32_f16 v[76:79], v[220:223], v[236:239], v[76:79]
v_bfe_u32 v190, v191, 2, 14
v_exp_f16_e64 v195, v196
v_mfma_f32_16x16x32_bf16 v[168:171], v[224:227], v[104:107], v[168:171]
ds_read_b128 v[220:223], v248 offset:30976
ds_read_u16_d16 v188, v188
ds_read_u16_d16 v190, v190
v_lshrrev_b32 v189, 18, v189
v_lshrrev_b32 v191, 18, v191
v_mfma_f32_16x16x32_bf16 v[176:179], v[224:227], v[108:111], v[176:179]
v_exp_f16_sdwa v201, v202 dst_sel:WORD_1 dst_unused:UNUSED_PRESERVE src0_sel:WORD_1
v_mfma_f32_16x16x32_f16 v[80:83], v[228:231], v[232:235], v[80:83]
ds_read_b128 v[224:227], v249 offset:30720
ds_read_u16_d16_hi v189, v189
ds_read_u16_d16_hi v191, v191
v_and_b32 v193, s49, v193
v_bfe_u32 v192, v193, 2, 14
v_mfma_f32_16x16x32_f16 v[88:91], v[228:231], v[236:239], v[88:91]
v_exp_f16_sdwa v198, v199 dst_sel:WORD_1 dst_unused:UNUSED_PRESERVE src0_sel:WORD_1
s_waitcnt lgkmcnt(7)
v_mfma_f32_16x16x32_f16 v[84:87], v[240:243], v[232:235], v[84:87]
ds_read_b128 v[228:231], v249 offset:30976
ds_read_u16_d16 v192, v192
v_lshrrev_b32_e64 v193, 18, v193
v_mfma_f32_16x16x32_f16 v[92:95], v[240:243], v[236:239], v[92:95]
v_exp_f16_sdwa v195, v196 dst_sel:WORD_1 dst_unused:UNUSED_PRESERVE src0_sel:WORD_1
v_pk_add_f16 v201, v201, 1.0 op_sel_hi:[1,0]
v_pk_add_f16 v198, v198, 1.0 op_sel_hi:[1,0]
v_mfma_f32_16x16x32_bf16 v[172:175], v[244:247], v[104:107], v[172:175]
ds_read_b128 v[240:243], v248 offset:34816
ds_read_u16_d16_hi v193, v193
v_pk_add_f16 v195, v195, 1.0 op_sel_hi:[1,0]
v_mfma_f32_16x16x32_bf16 v[180:183], v[244:247], v[108:111], v[180:183]
v_rcp_f16 v202, v201
s_waitcnt lgkmcnt(7)
v_mfma_f32_16x16x32_bf16 v[168:171], v[216:219], v[112:115], v[168:171]
ds_read_b128 v[244:247], v249 offset:31744
v_rcp_f16_e64 v199, v198
v_mfma_f32_16x16x32_bf16 v[176:179], v[216:219], v[116:119], v[176:179]
v_rcp_f16_e64 v196, v195
v_mfma_f32_16x16x32_bf16 v[172:175], v[220:223], v[112:115], v[172:175]
ds_read_b128 v[216:219], v248 offset:35072
v_rcp_f16_sdwa v202, v201 dst_sel:WORD_1 dst_unused:UNUSED_PRESERVE src0_sel:WORD_1
v_mfma_f32_16x16x32_bf16 v[180:183], v[220:223], v[116:119], v[180:183]
v_rcp_f16_sdwa v199, v198 dst_sel:WORD_1 dst_unused:UNUSED_PRESERVE src0_sel:WORD_1
v_or_b32 v232, v184, v185
v_or_b32 v233, v186, v187
s_waitcnt lgkmcnt(4)
v_or_b32 v234, v188, v189
v_rcp_f16_sdwa v196, v195 dst_sel:WORD_1 dst_unused:UNUSED_PRESERVE src0_sel:WORD_1
v_or_b32 v235, v190, v191
s_waitcnt lgkmcnt(2)
v_or_b32_e64 v236, v192, v193
v_pk_mul_f16 v237, v203, v202
v_pk_mul_f16 v238, v200, v199
v_pk_mul_f16 v239, v197, v196
v_mfma_f32_16x16x32_f16 v[48:51], v[224:227], v[232:235], v[48:51]
s_add_u32 s46, s71, 98304
buffer_store_dwordx4 v[160:163], v255, s[8:11], s46 offen offset:256 sc1
ds_read_b128 v[220:223], v249 offset:32000
v_cvt_pkrtz_f16_f32 v185, v168, v169
v_cvt_pkrtz_f16_f32 v187, v170, v171
v_mfma_f32_16x16x32_f16 v[56:59], v[224:227], v[236:239], v[56:59]
v_cvt_pkrtz_f16_f32 v189, v172, v173
v_cvt_pkrtz_f16_f32 v191, v174, v175
v_mfma_f32_16x16x32_f16 v[52:55], v[228:231], v[232:235], v[52:55]
ds_read_b128 v[224:227], v248 offset:35840
v_cvt_pkrtz_f16_f32 v193, v176, v177
v_cvt_pk_f16_f32 v203, v178, v179
v_mfma_f32_16x16x32_f16 v[60:63], v[228:231], v[236:239], v[60:63]
v_cvt_pk_f16_f32 v200, v180, v181
v_cvt_pk_f16_f32 v197, v182, v183
s_setprio 1
v_mfma_f32_16x16x32_bf16 v[168:171], v[240:243], v[96:99], 0
ds_read_b128 v[228:231], v249 offset:32768
v_pk_fma_f16 v202, v203, v203, s48
v_and_b32 v185, s49, v185
v_mfma_f32_16x16x32_bf16 v[176:179], v[240:243], v[100:103], 0
v_pk_fma_f16 v199, v200, v200, s48
v_and_b32 v187, s49, v187
s_waitcnt lgkmcnt(3)
v_mfma_f32_16x16x32_f16 v[64:67], v[244:247], v[232:235], v[64:67]
ds_read_b128 v[240:243], v249 offset:33024
v_pk_fma_f16 v196, v197, v197, s48
v_bfe_u32 v184, v185, 2, 14
v_pk_mul_f16 v202, v203, v202
v_mfma_f32_16x16x32_f16 v[72:75], v[244:247], v[236:239], v[72:75]
v_bfe_u32 v186, v187, 2, 14
v_pk_mul_f16 v199, v200, v199
s_waitcnt vmcnt(10)
v_mfma_f32_16x16x32_bf16 v[64:67], v[18:21], v[0:3], v[64:67]
ds_read_b128 v[244:247], v248 offset:36096
ds_read_u16_d16 v184, v184
ds_read_u16_d16 v186, v186
v_lshrrev_b32 v185, 18, v185
v_pk_mul_f16 v196, v197, v196
v_mfma_f32_16x16x32_bf16 v[68:71], v[16:19], v[0:3], v[68:71]
v_lshrrev_b32_e64 v187, 18, v187
v_mfma_f32_16x16x32_bf16 v[172:175], v[216:219], v[96:99], 0
ds_read_u16_d16_hi v185, v185
ds_read_u16_d16_hi v187, v187
v_exp_f16 v201, v202
v_and_b32 v189, s49, v189
v_mfma_f32_16x16x32_bf16 v[180:183], v[216:219], v[100:103], 0
v_and_b32 v191, s49, v191
s_waitcnt lgkmcnt(6)
v_mfma_f32_16x16x32_f16 v[68:71], v[220:223], v[232:235], v[68:71]
ds_read_b128 v[216:219], v248 offset:36864
v_exp_f16_e64 v198, v199
v_bfe_u32 v188, v189, 2, 14
v_mfma_f32_16x16x32_f16 v[76:79], v[220:223], v[236:239], v[76:79]
v_bfe_u32 v190, v191, 2, 14
v_exp_f16_e64 v195, v196
v_mfma_f32_16x16x32_bf16 v[168:171], v[224:227], v[104:107], v[168:171]
ds_read_b128 v[220:223], v248 offset:37120
ds_read_u16_d16 v188, v188
ds_read_u16_d16 v190, v190
v_lshrrev_b32 v189, 18, v189
v_lshrrev_b32 v191, 18, v191
v_mfma_f32_16x16x32_bf16 v[176:179], v[224:227], v[108:111], v[176:179]
v_exp_f16_sdwa v201, v202 dst_sel:WORD_1 dst_unused:UNUSED_PRESERVE src0_sel:WORD_1
v_mfma_f32_16x16x32_f16 v[80:83], v[228:231], v[232:235], v[80:83]
ds_read_b128 v[224:227], v249 offset:36864
ds_read_u16_d16_hi v189, v189
ds_read_u16_d16_hi v191, v191
v_and_b32 v193, s49, v193
v_bfe_u32 v192, v193, 2, 14
v_mfma_f32_16x16x32_f16 v[88:91], v[228:231], v[236:239], v[88:91]
v_exp_f16_sdwa v198, v199 dst_sel:WORD_1 dst_unused:UNUSED_PRESERVE src0_sel:WORD_1
s_waitcnt lgkmcnt(7)
v_mfma_f32_16x16x32_f16 v[84:87], v[240:243], v[232:235], v[84:87]
ds_read_b128 v[228:231], v249 offset:37120
ds_read_u16_d16 v192, v192
v_lshrrev_b32_e64 v193, 18, v193
v_mfma_f32_16x16x32_f16 v[92:95], v[240:243], v[236:239], v[92:95]
v_exp_f16_sdwa v195, v196 dst_sel:WORD_1 dst_unused:UNUSED_PRESERVE src0_sel:WORD_1
v_pk_add_f16 v201, v201, 1.0 op_sel_hi:[1,0]
v_pk_add_f16 v198, v198, 1.0 op_sel_hi:[1,0]
v_mfma_f32_16x16x32_bf16 v[172:175], v[244:247], v[104:107], v[172:175]
ds_read_b128 v[240:243], v248 offset:16384
ds_read_u16_d16_hi v193, v193
v_pk_add_f16 v195, v195, 1.0 op_sel_hi:[1,0]
v_mfma_f32_16x16x32_bf16 v[180:183], v[244:247], v[108:111], v[180:183]
v_rcp_f16_e64 v202, v201
s_setprio 0
s_waitcnt lgkmcnt(7)
v_mfma_f32_16x16x32_bf16 v[168:171], v[216:219], v[112:115], v[168:171]
ds_read_b128 v[244:247], v249 offset:37888
v_rcp_f16_e64 v199, v198
v_mfma_f32_16x16x32_bf16 v[176:179], v[216:219], v[116:119], v[176:179]
v_rcp_f16_e64 v196, v195
v_mfma_f32_16x16x32_bf16 v[172:175], v[220:223], v[112:115], v[172:175]
ds_read_b128 v[216:219], v248 offset:16640
v_rcp_f16_sdwa v202, v201 dst_sel:WORD_1 dst_unused:UNUSED_PRESERVE src0_sel:WORD_1
v_mfma_f32_16x16x32_bf16 v[180:183], v[220:223], v[116:119], v[180:183]
v_rcp_f16_sdwa v199, v198 dst_sel:WORD_1 dst_unused:UNUSED_PRESERVE src0_sel:WORD_1
v_or_b32 v232, v184, v185
v_or_b32 v233, v186, v187
s_waitcnt lgkmcnt(4)
v_or_b32 v234, v188, v189
v_rcp_f16_sdwa v196, v195 dst_sel:WORD_1 dst_unused:UNUSED_PRESERVE src0_sel:WORD_1
v_or_b32 v235, v190, v191
s_waitcnt lgkmcnt(2)
v_or_b32 v236, v192, v193
v_pk_mul_f16 v237, v203, v202
v_pk_mul_f16 v238, v200, v199
v_pk_mul_f16 v239, v197, v196
s_setprio 3
v_mfma_f32_16x16x32_f16 v[48:51], v[224:227], v[232:235], v[48:51]
s_add_u32 s46, s80, 12582912
buffer_load_dwordx4 v[96:99], v253, s[32:35], s46 offen nt
ds_read_b128 v[220:223], v249 offset:38144
v_cvt_pkrtz_f16_f32 v185, v168, v169
v_cvt_pkrtz_f16_f32 v187, v170, v171
v_mfma_f32_16x16x32_f16 v[56:59], v[224:227], v[236:239], v[56:59]
v_cvt_pkrtz_f16_f32 v189, v172, v173
v_cvt_pkrtz_f16_f32 v191, v174, v175
v_mfma_f32_16x16x32_f16 v[52:55], v[228:231], v[232:235], v[52:55]
ds_read_b128 v[224:227], v248 offset:17408
v_cvt_pkrtz_f16_f32 v193, v176, v177
v_cvt_pk_f16_f32 v203, v178, v179
v_mfma_f32_16x16x32_f16 v[60:63], v[228:231], v[236:239], v[60:63]
v_cvt_pk_f16_f32 v200, v180, v181
v_cvt_pk_f16_f32 v197, v182, v183
v_mfma_f32_16x16x32_bf16 v[168:171], v[240:243], v[24:27], 0
ds_read_b128 v[228:231], v249 offset:38912
v_pk_fma_f16 v202, v203, v203, s48
v_and_b32_e64 v185, s49, v185
v_mfma_f32_16x16x32_bf16 v[176:179], v[240:243], v[28:31], 0
v_pk_fma_f16 v199, v200, v200, s48
v_and_b32 v187, s49, v187
s_waitcnt lgkmcnt(3)
v_mfma_f32_16x16x32_f16 v[64:67], v[244:247], v[232:235], v[64:67]
ds_read_b128 v[240:243], v249 offset:39168
v_pk_fma_f16 v196, v197, v197, s48
v_bfe_u32 v184, v185, 2, 14
v_pk_mul_f16 v202, v203, v202
v_mfma_f32_16x16x32_f16 v[72:75], v[244:247], v[236:239], v[72:75]
v_bfe_u32 v186, v187, 2, 14
v_pk_mul_f16 v199, v200, v199
s_waitcnt vmcnt(10)
v_mfma_f32_16x16x32_bf16 v[80:83], v[18:21], v[8:11], v[80:83]
ds_read_b128 v[244:247], v248 offset:17664
ds_read_u16_d16 v184, v184
ds_read_u16_d16 v186, v186
v_lshrrev_b32 v185, 18, v185
v_pk_mul_f16 v196, v197, v196
v_mfma_f32_16x16x32_bf16 v[84:87], v[16:19], v[8:11], v[84:87]
v_lshrrev_b32_e64 v187, 18, v187
v_mfma_f32_16x16x32_bf16 v[172:175], v[216:219], v[24:27], 0
ds_read_u16_d16_hi v185, v185
ds_read_u16_d16_hi v187, v187
v_exp_f16 v201, v202
v_and_b32 v189, s49, v189
v_mfma_f32_16x16x32_bf16 v[180:183], v[216:219], v[28:31], 0
v_and_b32 v191, s49, v191
s_waitcnt lgkmcnt(6)
v_mfma_f32_16x16x32_f16 v[68:71], v[220:223], v[232:235], v[68:71]
ds_read_b128 v[216:219], v248 offset:18432
v_exp_f16_e64 v198, v199
v_bfe_u32 v188, v189, 2, 14
v_mfma_f32_16x16x32_f16 v[76:79], v[220:223], v[236:239], v[76:79]
v_bfe_u32 v190, v191, 2, 14
v_exp_f16_e64 v195, v196
v_mfma_f32_16x16x32_bf16 v[168:171], v[224:227], v[32:35], v[168:171]
ds_read_b128 v[220:223], v248 offset:18688
ds_read_u16_d16 v188, v188
ds_read_u16_d16 v190, v190
v_lshrrev_b32 v189, 18, v189
v_lshrrev_b32 v191, 18, v191
v_mfma_f32_16x16x32_bf16 v[176:179], v[224:227], v[36:39], v[176:179]
v_exp_f16_sdwa v201, v202 dst_sel:WORD_1 dst_unused:UNUSED_PRESERVE src0_sel:WORD_1
v_mfma_f32_16x16x32_f16 v[80:83], v[228:231], v[232:235], v[80:83]
ds_read_b128 v[224:227], v249 offset:43008
ds_read_u16_d16_hi v189, v189
ds_read_u16_d16_hi v191, v191
v_and_b32 v193, s49, v193
v_bfe_u32 v192, v193, 2, 14
v_mfma_f32_16x16x32_f16 v[88:91], v[228:231], v[236:239], v[88:91]
v_exp_f16_sdwa v198, v199 dst_sel:WORD_1 dst_unused:UNUSED_PRESERVE src0_sel:WORD_1
s_waitcnt lgkmcnt(7)
v_mfma_f32_16x16x32_f16 v[84:87], v[240:243], v[232:235], v[84:87]
ds_read_b128 v[228:231], v249 offset:43264
ds_read_u16_d16 v192, v192
v_lshrrev_b32_e64 v193, 18, v193
v_mfma_f32_16x16x32_f16 v[92:95], v[240:243], v[236:239], v[92:95]
v_exp_f16_sdwa v195, v196 dst_sel:WORD_1 dst_unused:UNUSED_PRESERVE src0_sel:WORD_1
v_pk_add_f16 v201, v201, 1.0 op_sel_hi:[1,0]
v_pk_add_f16 v198, v198, 1.0 op_sel_hi:[1,0]
v_mfma_f32_16x16x32_bf16 v[172:175], v[244:247], v[32:35], v[172:175]
ds_read_b128 v[240:243], v248 offset:22528
ds_read_u16_d16_hi v193, v193
v_pk_add_f16 v195, v195, 1.0 op_sel_hi:[1,0]
v_mfma_f32_16x16x32_bf16 v[180:183], v[244:247], v[36:39], v[180:183]
v_rcp_f16 v202, v201
s_waitcnt lgkmcnt(7)
v_mfma_f32_16x16x32_bf16 v[168:171], v[216:219], v[40:43], v[168:171]
ds_read_b128 v[244:247], v249 offset:44032
v_rcp_f16_e64 v199, v198
v_mfma_f32_16x16x32_bf16 v[176:179], v[216:219], v[44:47], v[176:179]
v_rcp_f16_e64 v196, v195
v_mfma_f32_16x16x32_bf16 v[172:175], v[220:223], v[40:43], v[172:175]
ds_read_b128 v[216:219], v248 offset:22784
v_rcp_f16_sdwa v202, v201 dst_sel:WORD_1 dst_unused:UNUSED_PRESERVE src0_sel:WORD_1
v_mfma_f32_16x16x32_bf16 v[180:183], v[220:223], v[44:47], v[180:183]
v_rcp_f16_sdwa v199, v198 dst_sel:WORD_1 dst_unused:UNUSED_PRESERVE src0_sel:WORD_1
v_or_b32 v232, v184, v185
v_or_b32 v233, v186, v187
s_waitcnt lgkmcnt(4)
v_or_b32 v234, v188, v189
v_rcp_f16_sdwa v196, v195 dst_sel:WORD_1 dst_unused:UNUSED_PRESERVE src0_sel:WORD_1
v_or_b32 v235, v190, v191
s_waitcnt lgkmcnt(2)
v_or_b32_e64 v236, v192, v193
v_pk_mul_f16 v237, v203, v202
v_pk_mul_f16 v238, v200, v199
v_pk_mul_f16 v239, v197, v196
v_mfma_f32_16x16x32_f16 v[48:51], v[224:227], v[232:235], v[48:51]
s_add_u32 s46, s80, 12582912
buffer_load_dwordx4 v[100:103], v253, s[32:35], s46 offen offset:256 nt
ds_read_b128 v[220:223], v249 offset:44288
v_cvt_pkrtz_f16_f32 v185, v168, v169
v_cvt_pkrtz_f16_f32 v187, v170, v171
v_mfma_f32_16x16x32_f16 v[56:59], v[224:227], v[236:239], v[56:59]
v_cvt_pkrtz_f16_f32 v189, v172, v173
v_cvt_pkrtz_f16_f32 v191, v174, v175
v_mfma_f32_16x16x32_f16 v[52:55], v[228:231], v[232:235], v[52:55]
ds_read_b128 v[224:227], v248 offset:23552
v_cvt_pkrtz_f16_f32 v193, v176, v177
v_cvt_pk_f16_f32 v203, v178, v179
v_mfma_f32_16x16x32_f16 v[60:63], v[228:231], v[236:239], v[60:63]
v_cvt_pk_f16_f32 v200, v180, v181
v_cvt_pk_f16_f32 v197, v182, v183
v_mfma_f32_16x16x32_bf16 v[168:171], v[240:243], v[24:27], 0
ds_read_b128 v[228:231], v249 offset:45056
v_pk_fma_f16 v202, v203, v203, s48
v_and_b32_e64 v185, s49, v185
v_mfma_f32_16x16x32_bf16 v[176:179], v[240:243], v[28:31], 0
v_pk_fma_f16 v199, v200, v200, s48
v_and_b32 v187, s49, v187
s_waitcnt lgkmcnt(3)
v_mfma_f32_16x16x32_f16 v[64:67], v[244:247], v[232:235], v[64:67]
ds_read_b128 v[240:243], v249 offset:45312
v_pk_fma_f16 v196, v197, v197, s48
s_setprio 2
v_bfe_u32 v184, v185, 2, 14
v_pk_mul_f16 v202, v203, v202
v_mfma_f32_16x16x32_f16 v[72:75], v[244:247], v[236:239], v[72:75]
v_bfe_u32 v186, v187, 2, 14
v_pk_mul_f16 v199, v200, v199
s_waitcnt vmcnt(9)
v_mfma_f32_16x16x32_bf16 v[56:59], v[18:21], v[12:15], v[56:59]
ds_read_b128 v[244:247], v248 offset:23808
ds_read_u16_d16 v184, v184
ds_read_u16_d16 v186, v186
v_lshrrev_b32_e64 v185, 18, v185
v_pk_mul_f16 v196, v197, v196
v_mfma_f32_16x16x32_bf16 v[60:63], v[16:19], v[12:15], v[60:63]
v_lshrrev_b32_e64 v187, 18, v187
v_mfma_f32_16x16x32_bf16 v[172:175], v[216:219], v[24:27], 0
ds_read_u16_d16_hi v185, v185
ds_read_u16_d16_hi v187, v187
v_exp_f16 v201, v202
v_and_b32 v189, s49, v189
v_mfma_f32_16x16x32_bf16 v[180:183], v[216:219], v[28:31], 0
v_and_b32 v191, s49, v191
s_waitcnt lgkmcnt(6)
v_mfma_f32_16x16x32_f16 v[68:71], v[220:223], v[232:235], v[68:71]
ds_read_b128 v[216:219], v248 offset:24576
v_exp_f16_e64 v198, v199
v_bfe_u32 v188, v189, 2, 14
v_mfma_f32_16x16x32_f16 v[76:79], v[220:223], v[236:239], v[76:79]
v_bfe_u32 v190, v191, 2, 14
v_exp_f16_e64 v195, v196
v_mfma_f32_16x16x32_bf16 v[168:171], v[224:227], v[32:35], v[168:171]
ds_read_b128 v[220:223], v248 offset:24832
ds_read_u16_d16 v188, v188
ds_read_u16_d16 v190, v190
v_lshrrev_b32 v189, 18, v189
v_lshrrev_b32 v191, 18, v191
v_mfma_f32_16x16x32_bf16 v[176:179], v[224:227], v[36:39], v[176:179]
v_exp_f16_sdwa v201, v202 dst_sel:WORD_1 dst_unused:UNUSED_PRESERVE src0_sel:WORD_1
v_mfma_f32_16x16x32_f16 v[80:83], v[228:231], v[232:235], v[80:83]
ds_read_b128 v[224:227], v249 offset:24576
ds_read_u16_d16_hi v189, v189
ds_read_u16_d16_hi v191, v191
v_and_b32 v193, s49, v193
v_bfe_u32 v192, v193, 2, 14
v_mfma_f32_16x16x32_f16 v[88:91], v[228:231], v[236:239], v[88:91]
v_exp_f16_sdwa v198, v199 dst_sel:WORD_1 dst_unused:UNUSED_PRESERVE src0_sel:WORD_1
s_waitcnt lgkmcnt(7)
v_mfma_f32_16x16x32_f16 v[84:87], v[240:243], v[232:235], v[84:87]
ds_read_b128 v[228:231], v254 offset:7936
ds_read_u16_d16 v192, v192
v_lshrrev_b32_e64 v193, 18, v193
v_mfma_f32_16x16x32_f16 v[92:95], v[240:243], v[236:239], v[92:95]
v_exp_f16_sdwa v195, v196 dst_sel:WORD_1 dst_unused:UNUSED_PRESERVE src0_sel:WORD_1
v_pk_add_f16 v201, v201, 1.0 op_sel_hi:[1,0]
v_pk_add_f16 v198, v198, 1.0 op_sel_hi:[1,0]
v_mfma_f32_16x16x32_bf16 v[172:175], v[244:247], v[32:35], v[172:175]
ds_read_b128 v[240:243], v249 offset:24832
ds_read_u16_d16_hi v193, v193
v_pk_add_f16 v195, v195, 1.0 op_sel_hi:[1,0]
v_mfma_f32_16x16x32_bf16 v[180:183], v[244:247], v[36:39], v[180:183]
v_rcp_f16 v202, v201
s_waitcnt lgkmcnt(7)
v_mfma_f32_16x16x32_bf16 v[168:171], v[216:219], v[40:43], v[168:171]
ds_read_b128 v[244:247], v254 offset:7952
v_rcp_f16_e64 v199, v198
v_mfma_f32_16x16x32_bf16 v[176:179], v[216:219], v[44:47], v[176:179]
v_rcp_f16_e64 v196, v195
v_mfma_f32_16x16x32_bf16 v[172:175], v[220:223], v[40:43], v[172:175]
ds_read_b128 v[216:219], v248 offset:28672
v_rcp_f16_sdwa v202, v201 dst_sel:WORD_1 dst_unused:UNUSED_PRESERVE src0_sel:WORD_1
v_mfma_f32_16x16x32_bf16 v[180:183], v[220:223], v[44:47], v[180:183]
v_rcp_f16_sdwa v199, v198 dst_sel:WORD_1 dst_unused:UNUSED_PRESERVE src0_sel:WORD_1
v_or_b32 v232, v184, v185
v_or_b32 v233, v186, v187
s_waitcnt lgkmcnt(4)
v_or_b32 v234, v188, v189
v_rcp_f16_sdwa v196, v195 dst_sel:WORD_1 dst_unused:UNUSED_PRESERVE src0_sel:WORD_1
v_or_b32 v235, v190, v191
s_waitcnt lgkmcnt(2)
v_or_b32 v236, v192, v193
v_pk_mul_f16 v237, v203, v202
v_pk_mul_f16 v238, v200, v199
v_pk_mul_f16 v239, v197, v196
v_mfma_f32_16x16x32_f16 v[120:123], v[224:227], v[232:235], v[228:231]
s_add_u32 s46, s80, 16777216
buffer_load_dwordx4 v[104:107], v253, s[32:35], s46 offen nt
ds_read_b128 v[220:223], v249 offset:25600
v_cvt_pkrtz_f16_f32 v185, v168, v169
v_cvt_pkrtz_f16_f32 v187, v170, v171
v_mfma_f32_16x16x32_f16 v[128:131], v[224:227], v[236:239], v[228:231]
v_cvt_pkrtz_f16_f32 v189, v172, v173
v_cvt_pkrtz_f16_f32 v191, v174, v175
s_waitcnt lgkmcnt(2)
v_mfma_f32_16x16x32_f16 v[124:127], v[240:243], v[232:235], v[244:247]
ds_read_b128 v[224:227], v254 offset:8064
ds_read_b128 v[228:231], v248 offset:28928
v_cvt_pkrtz_f16_f32 v193, v176, v177
v_cvt_pk_f16_f32 v203, v178, v179
v_mfma_f32_16x16x32_f16 v[132:135], v[240:243], v[236:239], v[244:247]
v_cvt_pk_f16_f32 v200, v180, v181
v_cvt_pk_f16_f32 v197, v182, v183
s_setprio 1
s_waitcnt lgkmcnt(3)
v_mfma_f32_16x16x32_bf16 v[168:171], v[216:219], v[24:27], 0
ds_read_b128 v[240:243], v249 offset:25856
ds_read_b128 v[244:247], v254 offset:8080
v_pk_fma_f16 v202, v203, v203, s48
v_and_b32_e64 v185, s49, v185
v_mfma_f32_16x16x32_bf16 v[176:179], v[216:219], v[28:31], 0
v_pk_fma_f16 v199, v200, v200, s48
v_and_b32 v187, s49, v187
s_waitcnt lgkmcnt(3)
v_mfma_f32_16x16x32_f16 v[136:139], v[220:223], v[232:235], v[224:227]
ds_read_b128 v[216:219], v248 offset:29696
v_pk_fma_f16 v196, v197, v197, s48
v_bfe_u32 v184, v185, 2, 14
v_pk_mul_f16 v202, v203, v202
v_mfma_f32_16x16x32_f16 v[144:147], v[220:223], v[236:239], v[224:227]
v_bfe_u32 v186, v187, 2, 14
v_pk_mul_f16 v199, v200, v199
s_waitcnt vmcnt(7)
v_mfma_f32_16x16x32_bf16 v[72:75], v[18:21], v[208:211], v[72:75]
ds_read_b128 v[220:223], v249 offset:26624
ds_read_b128 v[224:227], v254 offset:16128
ds_read_u16_d16 v184, v184
ds_read_u16_d16 v186, v186
v_lshrrev_b32 v185, 18, v185
v_pk_mul_f16 v196, v197, v196
v_mfma_f32_16x16x32_bf16 v[76:79], v[16:19], v[208:211], v[76:79]
v_lshrrev_b32 v187, 18, v187
s_waitcnt lgkmcnt(5)
v_mfma_f32_16x16x32_bf16 v[172:175], v[228:231], v[24:27], 0
ds_read_u16_d16_hi v185, v185
ds_read_u16_d16_hi v187, v187
v_exp_f16 v201, v202
v_and_b32 v189, s49, v189
v_mfma_f32_16x16x32_bf16 v[180:183], v[228:231], v[28:31], 0
v_and_b32_e64 v191, s49, v191
v_mfma_f32_16x16x32_f16 v[140:143], v[240:243], v[232:235], v[244:247]
ds_read_b128 v[228:231], v249 offset:26880
v_exp_f16_e64 v198, v199
v_bfe_u32 v188, v189, 2, 14
v_mfma_f32_16x16x32_f16 v[148:151], v[240:243], v[236:239], v[244:247]
v_bfe_u32 v190, v191, 2, 14
v_exp_f16 v195, v196
s_waitcnt lgkmcnt(7)
v_mfma_f32_16x16x32_bf16 v[168:171], v[216:219], v[32:35], v[168:171]
ds_read_b128 v[240:243], v254 offset:16144
ds_read_b128 v[244:247], v248 offset:29952
ds_read_u16_d16 v188, v188
ds_read_u16_d16 v190, v190
v_lshrrev_b32_e64 v189, 18, v189
v_lshrrev_b32 v191, 18, v191
v_mfma_f32_16x16x32_bf16 v[176:179], v[216:219], v[36:39], v[176:179]
v_exp_f16_sdwa v201, v202 dst_sel:WORD_1 dst_unused:UNUSED_PRESERVE src0_sel:WORD_1
s_waitcnt lgkmcnt(7)
v_mfma_f32_16x16x32_f16 v[152:155], v[220:223], v[232:235], v[224:227]
ds_read_b128 v[216:219], v248 offset:30720
ds_read_u16_d16_hi v189, v189
ds_read_u16_d16_hi v191, v191
v_and_b32 v193, s49, v193
v_bfe_u32 v192, v193, 2, 14
v_mfma_f32_16x16x32_f16 v[160:163], v[220:223], v[236:239], v[224:227]
v_exp_f16_sdwa v198, v199 dst_sel:WORD_1 dst_unused:UNUSED_PRESERVE src0_sel:WORD_1
s_waitcnt lgkmcnt(6)
v_mfma_f32_16x16x32_f16 v[156:159], v[228:231], v[232:235], v[240:243]
ds_read_b128 v[220:223], v248 offset:30976
ds_read_b128 v[224:227], v249 offset:30720
ds_read_u16_d16 v192, v192
v_lshrrev_b32 v193, 18, v193
v_mfma_f32_16x16x32_f16 v[164:167], v[228:231], v[236:239], v[240:243]
v_exp_f16_sdwa v195, v196 dst_sel:WORD_1 dst_unused:UNUSED_PRESERVE src0_sel:WORD_1
v_pk_add_f16 v201, v201, 1.0 op_sel_hi:[1,0]
v_pk_add_f16 v198, v198, 1.0 op_sel_hi:[1,0]
s_waitcnt lgkmcnt(7)
v_mfma_f32_16x16x32_bf16 v[172:175], v[244:247], v[32:35], v[172:175]
ds_read_b128 v[228:231], v249 offset:30976
ds_read_b128 v[240:243], v248 offset:34816
ds_read_u16_d16_hi v193, v193
v_pk_add_f16 v195, v195, 1.0 op_sel_hi:[1,0]
v_mfma_f32_16x16x32_bf16 v[180:183], v[244:247], v[36:39], v[180:183]
v_rcp_f16_e64 v202, v201
s_setprio 0
s_waitcnt lgkmcnt(7)
v_mfma_f32_16x16x32_bf16 v[168:171], v[216:219], v[40:43], v[168:171]
ds_read_b128 v[244:247], v249 offset:31744
v_rcp_f16_e64 v199, v198
v_mfma_f32_16x16x32_bf16 v[176:179], v[216:219], v[44:47], v[176:179]
v_rcp_f16 v196, v195
s_waitcnt lgkmcnt(6)
v_mfma_f32_16x16x32_bf16 v[172:175], v[220:223], v[40:43], v[172:175]
ds_read_b128 v[216:219], v248 offset:35072
v_rcp_f16_sdwa v202, v201 dst_sel:WORD_1 dst_unused:UNUSED_PRESERVE src0_sel:WORD_1
v_mfma_f32_16x16x32_bf16 v[180:183], v[220:223], v[44:47], v[180:183]
v_rcp_f16_sdwa v199, v198 dst_sel:WORD_1 dst_unused:UNUSED_PRESERVE src0_sel:WORD_1
v_or_b32 v232, v184, v185
v_or_b32 v233, v186, v187
v_or_b32_e64 v234, v188, v189
v_rcp_f16_sdwa v196, v195 dst_sel:WORD_1 dst_unused:UNUSED_PRESERVE src0_sel:WORD_1
v_or_b32 v235, v190, v191
s_waitcnt lgkmcnt(2)
v_or_b32 v236, v192, v193
v_pk_mul_f16 v237, v203, v202
v_pk_mul_f16 v238, v200, v199
v_pk_mul_f16 v239, v197, v196
s_setprio 3
v_mfma_f32_16x16x32_f16 v[120:123], v[224:227], v[232:235], v[120:123]
s_add_u32 s46, s80, 16777216
buffer_load_dwordx4 v[108:111], v253, s[32:35], s46 offen offset:256 nt
ds_read_b128 v[220:223], v249 offset:32000
v_cvt_pkrtz_f16_f32 v185, v168, v169
v_cvt_pkrtz_f16_f32 v187, v170, v171
v_mfma_f32_16x16x32_f16 v[128:131], v[224:227], v[236:239], v[128:131]
v_cvt_pkrtz_f16_f32 v189, v172, v173
v_cvt_pkrtz_f16_f32 v191, v174, v175
v_mfma_f32_16x16x32_f16 v[124:127], v[228:231], v[232:235], v[124:127]
ds_read_b128 v[224:227], v248 offset:35840
v_cvt_pkrtz_f16_f32 v193, v176, v177
v_cvt_pk_f16_f32 v203, v178, v179
v_mfma_f32_16x16x32_f16 v[132:135], v[228:231], v[236:239], v[132:135]
v_cvt_pk_f16_f32 v200, v180, v181
v_cvt_pk_f16_f32 v197, v182, v183
v_mfma_f32_16x16x32_bf16 v[168:171], v[240:243], v[24:27], 0
ds_read_b128 v[228:231], v249 offset:32768
v_pk_fma_f16 v202, v203, v203, s48
v_and_b32_e64 v185, s49, v185
v_mfma_f32_16x16x32_bf16 v[176:179], v[240:243], v[28:31], 0
v_pk_fma_f16 v199, v200, v200, s48
v_and_b32 v187, s49, v187
s_waitcnt lgkmcnt(3)
v_mfma_f32_16x16x32_f16 v[136:139], v[244:247], v[232:235], v[136:139]
ds_read_b128 v[240:243], v249 offset:33024
v_pk_fma_f16 v196, v197, v197, s48
v_bfe_u32 v184, v185, 2, 14
v_pk_mul_f16 v202, v203, v202
v_mfma_f32_16x16x32_f16 v[144:147], v[244:247], v[236:239], v[144:147]
v_bfe_u32 v186, v187, 2, 14
v_pk_mul_f16 v199, v200, v199
s_waitcnt vmcnt(7)
v_mfma_f32_16x16x32_bf16 v[88:91], v[18:21], v[204:207], v[88:91]
ds_read_b128 v[244:247], v248 offset:36096
ds_read_u16_d16 v184, v184
ds_read_u16_d16 v186, v186
v_lshrrev_b32 v185, 18, v185
v_pk_mul_f16 v196, v197, v196
v_mfma_f32_16x16x32_bf16 v[92:95], v[16:19], v[204:207], v[92:95]
v_lshrrev_b32_e64 v187, 18, v187
v_mfma_f32_16x16x32_bf16 v[172:175], v[216:219], v[24:27], 0
ds_read_u16_d16_hi v185, v185
ds_read_u16_d16_hi v187, v187
v_exp_f16 v201, v202
v_and_b32 v189, s49, v189
v_mfma_f32_16x16x32_bf16 v[180:183], v[216:219], v[28:31], 0
v_and_b32 v191, s49, v191
s_waitcnt lgkmcnt(6)
v_mfma_f32_16x16x32_f16 v[140:143], v[220:223], v[232:235], v[140:143]
ds_read_b128 v[216:219], v248 offset:36864
v_exp_f16_e64 v198, v199
v_bfe_u32 v188, v189, 2, 14
v_mfma_f32_16x16x32_f16 v[148:151], v[220:223], v[236:239], v[148:151]
v_bfe_u32 v190, v191, 2, 14
v_exp_f16_e64 v195, v196
v_mfma_f32_16x16x32_bf16 v[168:171], v[224:227], v[32:35], v[168:171]
ds_read_b128 v[220:223], v248 offset:37120
ds_read_u16_d16 v188, v188
ds_read_u16_d16 v190, v190
v_lshrrev_b32 v189, 18, v189
v_lshrrev_b32 v191, 18, v191
v_mfma_f32_16x16x32_bf16 v[176:179], v[224:227], v[36:39], v[176:179]
v_exp_f16_sdwa v201, v202 dst_sel:WORD_1 dst_unused:UNUSED_PRESERVE src0_sel:WORD_1
v_mfma_f32_16x16x32_f16 v[152:155], v[228:231], v[232:235], v[152:155]
ds_read_b128 v[224:227], v249 offset:36864
ds_read_u16_d16_hi v189, v189
ds_read_u16_d16_hi v191, v191
v_and_b32 v193, s49, v193
v_bfe_u32 v192, v193, 2, 14
v_mfma_f32_16x16x32_f16 v[160:163], v[228:231], v[236:239], v[160:163]
v_exp_f16_sdwa v198, v199 dst_sel:WORD_1 dst_unused:UNUSED_PRESERVE src0_sel:WORD_1
s_waitcnt lgkmcnt(7)
v_mfma_f32_16x16x32_f16 v[156:159], v[240:243], v[232:235], v[156:159]
ds_read_b128 v[228:231], v249 offset:37120
ds_read_u16_d16 v192, v192
v_lshrrev_b32_e64 v193, 18, v193
v_mfma_f32_16x16x32_f16 v[164:167], v[240:243], v[236:239], v[164:167]
v_exp_f16_sdwa v195, v196 dst_sel:WORD_1 dst_unused:UNUSED_PRESERVE src0_sel:WORD_1
v_pk_add_f16 v201, v201, 1.0 op_sel_hi:[1,0]
v_pk_add_f16 v198, v198, 1.0 op_sel_hi:[1,0]
v_mfma_f32_16x16x32_bf16 v[172:175], v[244:247], v[32:35], v[172:175]
ds_read_b128 v[240:243], v248 offset:40960
ds_read_u16_d16_hi v193, v193
v_pk_add_f16 v195, v195, 1.0 op_sel_hi:[1,0]
v_mfma_f32_16x16x32_bf16 v[180:183], v[244:247], v[36:39], v[180:183]
v_rcp_f16 v202, v201
s_waitcnt lgkmcnt(7)
v_mfma_f32_16x16x32_bf16 v[168:171], v[216:219], v[40:43], v[168:171]
ds_read_b128 v[244:247], v249 offset:37888
v_rcp_f16_e64 v199, v198
v_mfma_f32_16x16x32_bf16 v[176:179], v[216:219], v[44:47], v[176:179]
v_rcp_f16_e64 v196, v195
v_mfma_f32_16x16x32_bf16 v[172:175], v[220:223], v[40:43], v[172:175]
ds_read_b128 v[216:219], v248 offset:41216
v_rcp_f16_sdwa v202, v201 dst_sel:WORD_1 dst_unused:UNUSED_PRESERVE src0_sel:WORD_1
v_mfma_f32_16x16x32_bf16 v[180:183], v[220:223], v[44:47], v[180:183]
v_rcp_f16_sdwa v199, v198 dst_sel:WORD_1 dst_unused:UNUSED_PRESERVE src0_sel:WORD_1
v_or_b32 v232, v184, v185
v_or_b32 v233, v186, v187
s_waitcnt lgkmcnt(4)
v_or_b32 v234, v188, v189
v_rcp_f16_sdwa v196, v195 dst_sel:WORD_1 dst_unused:UNUSED_PRESERVE src0_sel:WORD_1
v_or_b32 v235, v190, v191
s_waitcnt lgkmcnt(2)
v_or_b32_e64 v236, v192, v193
v_pk_mul_f16 v237, v203, v202
v_pk_mul_f16 v238, v200, v199
v_pk_mul_f16 v239, v197, v196
v_mfma_f32_16x16x32_f16 v[120:123], v[224:227], v[232:235], v[120:123]
s_add_u32 s46, s80, 20971520
buffer_load_dwordx4 v[112:115], v253, s[32:35], s46 offen nt
ds_read_b128 v[220:223], v249 offset:38144
v_cvt_pkrtz_f16_f32 v185, v168, v169
v_cvt_pkrtz_f16_f32 v187, v170, v171
v_cvt_pkrtz_f16_f32 v189, v172, v173
v_mfma_f32_16x16x32_f16 v[128:131], v[224:227], v[236:239], v[128:131]
v_cvt_pkrtz_f16_f32 v191, v174, v175
v_cvt_pkrtz_f16_f32 v193, v176, v177
v_cvt_pk_f16_f32 v203, v178, v179
v_mfma_f32_16x16x32_f16 v[124:127], v[228:231], v[232:235], v[124:127]
ds_read_b128 v[224:227], v248 offset:41984
v_cvt_pk_f16_f32 v200, v180, v181
v_cvt_pk_f16_f32 v197, v182, v183
v_pk_fma_f16 v202, v203, v203, s48
v_cvt_pk_bf16_f32 v64, v64, v65
v_mfma_f32_16x16x32_f16 v[132:135], v[228:231], v[236:239], v[132:135]
v_and_b32_e64 v185, s49, v185
v_cvt_pk_bf16_f32 v65, v66, v67
v_pk_fma_f16 v199, v200, v200, s48
v_mfma_f32_16x16x32_bf16 v[168:171], v[240:243], v[24:27], 0
ds_read_b128 v[228:231], v249 offset:38912
v_and_b32_e64 v187, s49, v187
v_cvt_pk_bf16_f32 v66, v68, v69
v_pk_fma_f16 v196, v197, v197, s48
v_mfma_f32_16x16x32_bf16 v[176:179], v[240:243], v[28:31], 0
v_cvt_pk_bf16_f32 v67, v70, v71
v_bfe_u32 v184, v185, 2, 14
s_setprio 2
v_pk_mul_f16 v202, v203, v202
v_cvt_pk_bf16_f32 v48, v48, v49
s_waitcnt lgkmcnt(2)
v_mfma_f32_16x16x32_f16 v[136:139], v[244:247], v[232:235], v[136:139]
ds_read_b128 v[240:243], v249 offset:39168
ds_read_u16_d16 v184, v184
v_bfe_u32 v186, v187, 2, 14
v_cvt_pk_bf16_f32 v49, v50, v51
v_pk_mul_f16 v199, v200, v199
v_mfma_f32_16x16x32_f16 v[144:147], v[244:247], v[236:239], v[144:147]
v_lshrrev_b32_e64 v185, 18, v185
v_cvt_pk_bf16_f32 v50, v52, v53
v_pk_mul_f16 v196, v197, v196
v_mfma_f32_16x16x32_bf16 v[172:175], v[216:219], v[24:27], 0
ds_read_b128 v[244:247], v248 offset:42240
ds_read_u16_d16 v186, v186
ds_read_u16_d16_hi v185, v185
v_lshrrev_b32_e64 v187, 18, v187
v_cvt_pk_bf16_f32 v51, v54, v55
v_exp_f16_e64 v201, v202
v_mfma_f32_16x16x32_bf16 v[180:183], v[216:219], v[28:31], 0
v_cvt_pk_bf16_f32 v80, v80, v81
v_and_b32_e64 v189, s49, v189
v_cvt_pk_bf16_f32 v81, v82, v83
v_mfma_f32_16x16x32_f16 v[140:143], v[220:223], v[232:235], v[140:143]
ds_read_b128 v[216:219], v248 offset:43008
ds_read_u16_d16_hi v187, v187
v_and_b32_e64 v191, s49, v191
v_cvt_pk_bf16_f32 v82, v84, v85
v_mfma_f32_16x16x32_f16 v[148:151], v[220:223], v[236:239], v[148:151]
v_exp_f16_e64 v198, v199
v_cvt_pk_bf16_f32 v83, v86, v87
s_mov_b64 vcc, s[74:75]
v_bfe_u32 v188, v189, 2, 14
v_bfe_u32 v190, v191, 2, 14
s_waitcnt lgkmcnt(5)
v_mfma_f32_16x16x32_bf16 v[168:171], v[224:227], v[32:35], v[168:171]
ds_read_b128 v[220:223], v248 offset:43264
ds_read_u16_d16 v188, v188
ds_read_u16_d16 v190, v190
v_cndmask_b32 v68, v48, v80, vcc
v_exp_f16 v195, v196
v_mfma_f32_16x16x32_bf16 v[176:179], v[224:227], v[36:39], v[176:179]
v_cndmask_b32 v69, v49, v81, vcc
v_lshrrev_b32_e64 v189, 18, v189
v_cndmask_b32 v70, v50, v82, vcc
v_mfma_f32_16x16x32_f16 v[152:155], v[228:231], v[232:235], v[152:155]
ds_read_b128 v[224:227], v249 offset:43008
ds_read_u16_d16_hi v189, v189
v_lshrrev_b32 v191, 18, v191
v_cndmask_b32 v71, v51, v83, vcc
v_exp_f16_sdwa v201, v202 dst_sel:WORD_1 dst_unused:UNUSED_PRESERVE src0_sel:WORD_1
v_mfma_f32_16x16x32_f16 v[160:163], v[228:231], v[236:239], v[160:163]
v_cndmask_b32_dpp v48, v64, v48, vcc quad_perm:[1,0,3,2] row_mask:0xf bank_mask:0xf
v_and_b32_e64 v193, s49, v193
v_cndmask_b32_dpp v49, v65, v49, vcc quad_perm:[1,0,3,2] row_mask:0xf bank_mask:0xf
v_mfma_f32_16x16x32_f16 v[156:159], v[240:243], v[232:235], v[156:159]
ds_read_b128 v[228:231], v249 offset:43264
ds_read_u16_d16_hi v191, v191
v_bfe_u32 v192, v193, 2, 14
v_exp_f16_sdwa v198, v199 dst_sel:WORD_1 dst_unused:UNUSED_PRESERVE src0_sel:WORD_1
v_mfma_f32_16x16x32_f16 v[164:167], v[240:243], v[236:239], v[164:167]
v_cndmask_b32_dpp v50, v66, v50, vcc quad_perm:[1,0,3,2] row_mask:0xf bank_mask:0xf
v_lshrrev_b32_e64 v193, 18, v193
v_cndmask_b32_dpp v51, v67, v51, vcc quad_perm:[1,0,3,2] row_mask:0xf bank_mask:0xf
s_not_b64 vcc, s[74:75]
s_waitcnt lgkmcnt(4)
v_mfma_f32_16x16x32_bf16 v[172:175], v[244:247], v[32:35], v[172:175]
ds_read_b128 v[240:243], v248 offset:47104
ds_read_u16_d16 v192, v192
ds_read_u16_d16_hi v193, v193
v_exp_f16_sdwa v195, v196 dst_sel:WORD_1 dst_unused:UNUSED_PRESERVE src0_sel:WORD_1
v_cndmask_b32_dpp v80, v64, v80, vcc quad_perm:[1,0,3,2] row_mask:0xf bank_mask:0xf
v_pk_add_f16 v201, v201, 1.0 op_sel_hi:[1,0]
v_mfma_f32_16x16x32_bf16 v[180:183], v[244:247], v[36:39], v[180:183]
v_cndmask_b32_dpp v81, v65, v81, vcc quad_perm:[1,0,3,2] row_mask:0xf bank_mask:0xf
v_pk_add_f16 v198, v198, 1.0 op_sel_hi:[1,0]
v_cndmask_b32_dpp v82, v66, v82, vcc quad_perm:[1,0,3,2] row_mask:0xf bank_mask:0xf
v_mfma_f32_16x16x32_bf16 v[168:171], v[216:219], v[40:43], v[168:171]
ds_read_b128 v[244:247], v249 offset:44032
v_pk_add_f16 v195, v195, 1.0 op_sel_hi:[1,0]
v_rcp_f16_e64 v202, v201
v_cndmask_b32_dpp v83, v67, v83, vcc quad_perm:[1,0,3,2] row_mask:0xf bank_mask:0xf
v_mfma_f32_16x16x32_bf16 v[176:179], v[216:219], v[44:47], v[176:179]
v_rcp_f16_e64 v199, v198
v_mfma_f32_16x16x32_bf16 v[172:175], v[220:223], v[40:43], v[172:175]
ds_read_b128 v[216:219], v248 offset:47360
buffer_store_dwordx4 v[48:51], v255, s[8:11], s70 offen sc1
v_rcp_f16_e64 v196, v195
v_rcp_f16_sdwa v202, v201 dst_sel:WORD_1 dst_unused:UNUSED_PRESERVE src0_sel:WORD_1
v_mfma_f32_16x16x32_bf16 v[180:183], v[220:223], v[44:47], v[180:183]
v_rcp_f16_sdwa v199, v198 dst_sel:WORD_1 dst_unused:UNUSED_PRESERVE src0_sel:WORD_1
v_or_b32 v232, v184, v185
v_or_b32 v233, v186, v187
s_waitcnt lgkmcnt(3)
v_or_b32 v234, v188, v189
v_rcp_f16_sdwa v196, v195 dst_sel:WORD_1 dst_unused:UNUSED_PRESERVE src0_sel:WORD_1
v_or_b32 v235, v190, v191
s_waitcnt lgkmcnt(2)
v_or_b32_e64 v236, v192, v193
v_pk_mul_f16 v237, v203, v202
v_pk_mul_f16 v238, v200, v199
v_pk_mul_f16 v239, v197, v196
v_mfma_f32_16x16x32_f16 v[120:123], v[224:227], v[232:235], v[120:123]
buffer_store_dwordx4 v[68:71], v255, s[8:11], s70 offen offset:128 sc1
ds_read_b128 v[220:223], v249 offset:44288
v_cvt_pkrtz_f16_f32 v185, v168, v169
v_cvt_pkrtz_f16_f32 v187, v170, v171
v_mfma_f32_16x16x32_f16 v[128:131], v[224:227], v[236:239], v[128:131]
v_cvt_pkrtz_f16_f32 v189, v172, v173
v_cvt_pkrtz_f16_f32 v191, v174, v175
v_mfma_f32_16x16x32_f16 v[124:127], v[228:231], v[232:235], v[124:127]
ds_read_b128 v[224:227], v248 offset:48128
v_cvt_pkrtz_f16_f32 v193, v176, v177
v_cvt_pk_f16_f32 v203, v178, v179
v_cvt_pk_f16_f32 v200, v180, v181
v_mfma_f32_16x16x32_f16 v[132:135], v[228:231], v[236:239], v[132:135]
v_cvt_pk_f16_f32 v197, v182, v183
s_setprio 1
v_pk_fma_f16 v202, v203, v203, s48
v_mfma_f32_16x16x32_bf16 v[168:171], v[240:243], v[24:27], 0
ds_read_b128 v[228:231], v249 offset:45056
v_and_b32 v185, s49, v185
v_pk_fma_f16 v199, v200, v200, s48
v_mfma_f32_16x16x32_bf16 v[176:179], v[240:243], v[28:31], 0
v_and_b32 v187, s49, v187
v_pk_fma_f16 v196, v197, v197, s48
v_bfe_u32 v184, v185, 2, 14
s_waitcnt lgkmcnt(3)
v_mfma_f32_16x16x32_f16 v[136:139], v[244:247], v[232:235], v[136:139]
ds_read_b128 v[240:243], v249 offset:45312
ds_read_u16_d16 v184, v184
v_pk_mul_f16 v202, v203, v202
v_bfe_u32 v186, v187, 2, 14
v_mfma_f32_16x16x32_f16 v[144:147], v[244:247], v[236:239], v[144:147]
v_pk_mul_f16 v199, v200, v199
v_lshrrev_b32_e64 v185, 18, v185
v_mfma_f32_16x16x32_bf16 v[172:175], v[216:219], v[24:27], 0
ds_read_b128 v[244:247], v248 offset:48384
ds_read_u16_d16 v186, v186
ds_read_u16_d16_hi v185, v185
v_pk_mul_f16 v196, v197, v196
v_lshrrev_b32_e64 v187, 18, v187
v_mfma_f32_16x16x32_bf16 v[180:183], v[216:219], v[28:31], 0
v_exp_f16_e64 v201, v202
v_and_b32 v189, s49, v189
s_waitcnt lgkmcnt(5)
v_mfma_f32_16x16x32_f16 v[140:143], v[220:223], v[232:235], v[140:143]
ds_read_b128 v[216:219], v248 offset:49152
ds_read_u16_d16_hi v187, v187
v_and_b32_e64 v191, s49, v191
v_mfma_f32_16x16x32_f16 v[148:151], v[220:223], v[236:239], v[148:151]
v_exp_f16_e64 v198, v199
v_bfe_u32 v188, v189, 2, 14
v_bfe_u32 v190, v191, 2, 14
v_mfma_f32_16x16x32_bf16 v[168:171], v[224:227], v[32:35], v[168:171]
s_add_u32 s46, s80, 20971520
buffer_load_dwordx4 v[116:119], v253, s[32:35], s46 offen offset:256 nt
ds_read_b128 v[220:223], v248 offset:49408
ds_read_u16_d16 v188, v188
ds_read_u16_d16 v190, v190
v_exp_f16_e64 v195, v196
v_mfma_f32_16x16x32_bf16 v[176:179], v[224:227], v[36:39], v[176:179]
v_lshrrev_b32 v189, 18, v189
v_lshrrev_b32 v191, 18, v191
v_mfma_f32_16x16x32_f16 v[152:155], v[228:231], v[232:235], v[152:155]
ds_read_b128 v[224:227], v249 offset:49152
ds_read_u16_d16_hi v189, v189
ds_read_u16_d16_hi v191, v191
v_exp_f16_sdwa v201, v202 dst_sel:WORD_1 dst_unused:UNUSED_PRESERVE src0_sel:WORD_1
v_and_b32 v193, s49, v193
v_mfma_f32_16x16x32_f16 v[160:163], v[228:231], v[236:239], v[160:163]
v_bfe_u32 v192, v193, 2, 14
s_waitcnt lgkmcnt(7)
v_mfma_f32_16x16x32_f16 v[156:159], v[240:243], v[232:235], v[156:159]
ds_read_b128 v[228:231], v249 offset:49408
ds_read_u16_d16 v192, v192
v_exp_f16_sdwa v198, v199 dst_sel:WORD_1 dst_unused:UNUSED_PRESERVE src0_sel:WORD_1
v_lshrrev_b32_e64 v193, 18, v193
v_mfma_f32_16x16x32_f16 v[164:167], v[240:243], v[236:239], v[164:167]
v_exp_f16_sdwa v195, v196 dst_sel:WORD_1 dst_unused:UNUSED_PRESERVE src0_sel:WORD_1
v_pk_add_f16 v201, v201, 1.0 op_sel_hi:[1,0]
v_mfma_f32_16x16x32_bf16 v[172:175], v[244:247], v[32:35], v[172:175]
ds_read_b128 v[240:243], v248 offset:53248
ds_read_u16_d16_hi v193, v193
v_pk_add_f16 v198, v198, 1.0 op_sel_hi:[1,0]
v_pk_add_f16 v195, v195, 1.0 op_sel_hi:[1,0]
v_mfma_f32_16x16x32_bf16 v[180:183], v[244:247], v[36:39], v[180:183]
v_rcp_f16 v202, v201
s_setprio 0
v_mfma_f32_16x16x32_bf16 v[168:171], v[216:219], v[40:43], v[168:171]
ds_read_b128 v[244:247], v249 offset:50176
v_rcp_f16_e64 v199, v198
v_mfma_f32_16x16x32_bf16 v[176:179], v[216:219], v[44:47], v[176:179]
v_rcp_f16 v196, v195
s_waitcnt lgkmcnt(5)
v_mfma_f32_16x16x32_bf16 v[172:175], v[220:223], v[40:43], v[172:175]
ds_read_b128 v[216:219], v248 offset:53504
v_rcp_f16_sdwa v202, v201 dst_sel:WORD_1 dst_unused:UNUSED_PRESERVE src0_sel:WORD_1
v_mfma_f32_16x16x32_bf16 v[180:183], v[220:223], v[44:47], v[180:183]
v_rcp_f16_sdwa v199, v198 dst_sel:WORD_1 dst_unused:UNUSED_PRESERVE src0_sel:WORD_1
v_or_b32 v232, v184, v185
v_or_b32 v233, v186, v187
v_or_b32_e64 v234, v188, v189
v_rcp_f16_sdwa v196, v195 dst_sel:WORD_1 dst_unused:UNUSED_PRESERVE src0_sel:WORD_1
v_or_b32 v235, v190, v191
s_waitcnt lgkmcnt(2)
v_or_b32 v236, v192, v193
v_pk_mul_f16 v237, v203, v202
v_pk_mul_f16 v238, v200, v199
v_pk_mul_f16 v239, v197, v196
s_setprio 3
v_mfma_f32_16x16x32_f16 v[120:123], v[224:227], v[232:235], v[120:123]
ds_read_b128 v[220:223], v249 offset:50432
v_cvt_pkrtz_f16_f32 v185, v168, v169
v_cvt_pkrtz_f16_f32 v187, v170, v171
v_mfma_f32_16x16x32_f16 v[128:131], v[224:227], v[236:239], v[128:131]
v_cvt_pkrtz_f16_f32 v189, v172, v173
v_cvt_pkrtz_f16_f32 v191, v174, v175
v_mfma_f32_16x16x32_f16 v[124:127], v[228:231], v[232:235], v[124:127]
ds_read_b128 v[224:227], v248 offset:54272
v_cvt_pkrtz_f16_f32 v193, v176, v177
v_cvt_pk_f16_f32 v203, v178, v179
v_cvt_pk_f16_f32 v200, v180, v181
v_mfma_f32_16x16x32_f16 v[132:135], v[228:231], v[236:239], v[132:135]
v_cvt_pk_f16_f32 v197, v182, v183
v_pk_fma_f16 v202, v203, v203, s48
v_mfma_f32_16x16x32_bf16 v[168:171], v[240:243], v[24:27], 0
ds_read_b128 v[228:231], v249 offset:51200
v_and_b32_e64 v185, s49, v185
v_pk_fma_f16 v199, v200, v200, s48
v_mfma_f32_16x16x32_bf16 v[176:179], v[240:243], v[28:31], 0
v_and_b32 v187, s49, v187
v_pk_fma_f16 v196, v197, v197, s48
v_bfe_u32 v184, v185, 2, 14
s_waitcnt lgkmcnt(3)
v_mfma_f32_16x16x32_f16 v[136:139], v[244:247], v[232:235], v[136:139]
ds_read_b128 v[240:243], v249 offset:51456
ds_read_u16_d16 v184, v184
v_pk_mul_f16 v202, v203, v202
v_bfe_u32 v186, v187, 2, 14
v_mfma_f32_16x16x32_f16 v[144:147], v[244:247], v[236:239], v[144:147]
v_pk_mul_f16 v199, v200, v199
v_lshrrev_b32_e64 v185, 18, v185
v_mfma_f32_16x16x32_bf16 v[172:175], v[216:219], v[24:27], 0
ds_read_b128 v[244:247], v248 offset:54528
ds_read_u16_d16 v186, v186
ds_read_u16_d16_hi v185, v185
v_pk_mul_f16 v196, v197, v196
v_lshrrev_b32_e64 v187, 18, v187
v_mfma_f32_16x16x32_bf16 v[180:183], v[216:219], v[28:31], 0
v_exp_f16_e64 v201, v202
v_and_b32 v189, s49, v189
s_waitcnt lgkmcnt(5)
v_mfma_f32_16x16x32_f16 v[140:143], v[220:223], v[232:235], v[140:143]
ds_read_b128 v[216:219], v248 offset:55296
ds_read_u16_d16_hi v187, v187
v_and_b32_e64 v191, s49, v191
v_mfma_f32_16x16x32_f16 v[148:151], v[220:223], v[236:239], v[148:151]
v_exp_f16_e64 v198, v199
v_bfe_u32 v188, v189, 2, 14
v_bfe_u32 v190, v191, 2, 14
v_mfma_f32_16x16x32_bf16 v[168:171], v[224:227], v[32:35], v[168:171]
ds_read_b128 v[220:223], v248 offset:55552
ds_read_u16_d16 v188, v188
ds_read_u16_d16 v190, v190
v_exp_f16_e64 v195, v196
v_mfma_f32_16x16x32_bf16 v[176:179], v[224:227], v[36:39], v[176:179]
v_lshrrev_b32 v189, 18, v189
v_lshrrev_b32 v191, 18, v191
v_mfma_f32_16x16x32_f16 v[152:155], v[228:231], v[232:235], v[152:155]
ds_read_b128 v[224:227], v249 offset:55296
ds_read_u16_d16_hi v189, v189
ds_read_u16_d16_hi v191, v191
v_exp_f16_sdwa v201, v202 dst_sel:WORD_1 dst_unused:UNUSED_PRESERVE src0_sel:WORD_1
v_and_b32 v193, s49, v193
v_mfma_f32_16x16x32_f16 v[160:163], v[228:231], v[236:239], v[160:163]
v_bfe_u32 v192, v193, 2, 14
s_waitcnt lgkmcnt(8)
v_mfma_f32_16x16x32_f16 v[156:159], v[240:243], v[232:235], v[156:159]
ds_read_b128 v[228:231], v249 offset:55552
ds_read_u16_d16 v192, v192
v_exp_f16_sdwa v198, v199 dst_sel:WORD_1 dst_unused:UNUSED_PRESERVE src0_sel:WORD_1
v_lshrrev_b32_e64 v193, 18, v193
v_mfma_f32_16x16x32_f16 v[164:167], v[240:243], v[236:239], v[164:167]
v_exp_f16_sdwa v195, v196 dst_sel:WORD_1 dst_unused:UNUSED_PRESERVE src0_sel:WORD_1
v_pk_add_f16 v201, v201, 1.0 op_sel_hi:[1,0]
v_mfma_f32_16x16x32_bf16 v[172:175], v[244:247], v[32:35], v[172:175]
ds_read_b128 v[240:243], v248 offset:59392
ds_read_u16_d16_hi v193, v193
v_pk_add_f16 v198, v198, 1.0 op_sel_hi:[1,0]
v_pk_add_f16 v195, v195, 1.0 op_sel_hi:[1,0]
v_mfma_f32_16x16x32_bf16 v[180:183], v[244:247], v[36:39], v[180:183]
v_rcp_f16 v202, v201
s_waitcnt lgkmcnt(7)
v_mfma_f32_16x16x32_bf16 v[168:171], v[216:219], v[40:43], v[168:171]
ds_read_b128 v[244:247], v249 offset:56320
v_rcp_f16_e64 v199, v198
v_mfma_f32_16x16x32_bf16 v[176:179], v[216:219], v[44:47], v[176:179]
v_rcp_f16_e64 v196, v195
v_mfma_f32_16x16x32_bf16 v[172:175], v[220:223], v[40:43], v[172:175]
ds_read_b128 v[216:219], v248 offset:59648
v_rcp_f16_sdwa v202, v201 dst_sel:WORD_1 dst_unused:UNUSED_PRESERVE src0_sel:WORD_1
v_mfma_f32_16x16x32_bf16 v[180:183], v[220:223], v[44:47], v[180:183]
v_rcp_f16_sdwa v199, v198 dst_sel:WORD_1 dst_unused:UNUSED_PRESERVE src0_sel:WORD_1
v_or_b32 v232, v184, v185
v_or_b32 v233, v186, v187
s_waitcnt lgkmcnt(4)
v_or_b32 v234, v188, v189
v_rcp_f16_sdwa v196, v195 dst_sel:WORD_1 dst_unused:UNUSED_PRESERVE src0_sel:WORD_1
v_or_b32 v235, v190, v191
s_waitcnt lgkmcnt(2)
v_or_b32_e64 v236, v192, v193
v_pk_mul_f16 v237, v203, v202
v_pk_mul_f16 v238, v200, v199
v_pk_mul_f16 v239, v197, v196
v_mfma_f32_16x16x32_f16 v[120:123], v[224:227], v[232:235], v[120:123]
buffer_load_dwordx4 v[204:207], v252, s[4:7], s68 offen
ds_read_b128 v[220:223], v249 offset:56576
v_cvt_pkrtz_f16_f32 v185, v168, v169
v_cvt_pkrtz_f16_f32 v187, v170, v171
v_mfma_f32_16x16x32_f16 v[128:131], v[224:227], v[236:239], v[128:131]
v_cvt_pkrtz_f16_f32 v189, v172, v173
v_cvt_pkrtz_f16_f32 v191, v174, v175
v_mfma_f32_16x16x32_f16 v[124:127], v[228:231], v[232:235], v[124:127]
ds_read_b128 v[224:227], v248 offset:60416
v_cvt_pkrtz_f16_f32 v193, v176, v177
v_cvt_pk_f16_f32 v203, v178, v179
v_cvt_pk_f16_f32 v200, v180, v181
v_mfma_f32_16x16x32_f16 v[132:135], v[228:231], v[236:239], v[132:135]
v_cvt_pk_f16_f32 v197, v182, v183
v_pk_fma_f16 v202, v203, v203, s48
v_mfma_f32_16x16x32_bf16 v[168:171], v[240:243], v[24:27], 0
ds_read_b128 v[228:231], v249 offset:57344
v_and_b32_e64 v185, s49, v185
v_pk_fma_f16 v199, v200, v200, s48
v_mfma_f32_16x16x32_bf16 v[176:179], v[240:243], v[28:31], 0
v_and_b32_e64 v187, s49, v187
v_pk_fma_f16 v196, v197, v197, s48
s_setprio 2
v_bfe_u32 v184, v185, 2, 14
s_waitcnt lgkmcnt(3)
v_mfma_f32_16x16x32_f16 v[136:139], v[244:247], v[232:235], v[136:139]
ds_read_b128 v[240:243], v249 offset:57600
ds_read_u16_d16 v184, v184
v_pk_mul_f16 v202, v203, v202
v_bfe_u32 v186, v187, 2, 14
v_mfma_f32_16x16x32_f16 v[144:147], v[244:247], v[236:239], v[144:147]
v_pk_mul_f16 v199, v200, v199
v_lshrrev_b32_e64 v185, 18, v185
v_mfma_f32_16x16x32_bf16 v[172:175], v[216:219], v[24:27], 0
ds_read_b128 v[244:247], v248 offset:60672
ds_read_u16_d16 v186, v186
ds_read_u16_d16_hi v185, v185
v_pk_mul_f16 v196, v197, v196
v_lshrrev_b32_e64 v187, 18, v187
v_mfma_f32_16x16x32_bf16 v[180:183], v[216:219], v[28:31], 0
v_exp_f16_e64 v201, v202
v_and_b32 v189, s49, v189
s_waitcnt lgkmcnt(5)
v_mfma_f32_16x16x32_f16 v[140:143], v[220:223], v[232:235], v[140:143]
ds_read_b128 v[216:219], v248 offset:61440
ds_read_u16_d16_hi v187, v187
v_and_b32_e64 v191, s49, v191
v_mfma_f32_16x16x32_f16 v[148:151], v[220:223], v[236:239], v[148:151]
v_exp_f16_e64 v198, v199
v_bfe_u32 v188, v189, 2, 14
v_bfe_u32 v190, v191, 2, 14
v_mfma_f32_16x16x32_bf16 v[168:171], v[224:227], v[32:35], v[168:171]
buffer_store_dwordx4 v[80:83], v255, s[8:11], s70 offen offset:256 sc1
ds_read_b128 v[220:223], v248 offset:61696
ds_read_u16_d16 v188, v188
ds_read_u16_d16 v190, v190
v_exp_f16_e64 v195, v196
v_mfma_f32_16x16x32_bf16 v[176:179], v[224:227], v[36:39], v[176:179]
v_lshrrev_b32 v189, 18, v189
v_lshrrev_b32 v191, 18, v191
v_mfma_f32_16x16x32_f16 v[152:155], v[228:231], v[232:235], v[152:155]
ds_read_b128 v[224:227], v249 offset:61440
ds_read_u16_d16_hi v189, v189
ds_read_u16_d16_hi v191, v191
v_exp_f16_sdwa v201, v202 dst_sel:WORD_1 dst_unused:UNUSED_PRESERVE src0_sel:WORD_1
v_and_b32 v193, s49, v193
v_mfma_f32_16x16x32_f16 v[160:163], v[228:231], v[236:239], v[160:163]
v_bfe_u32 v192, v193, 2, 14
s_waitcnt lgkmcnt(8)
v_mfma_f32_16x16x32_f16 v[156:159], v[240:243], v[232:235], v[156:159]
ds_read_b128 v[228:231], v249 offset:61696
ds_read_u16_d16 v192, v192
v_exp_f16_sdwa v198, v199 dst_sel:WORD_1 dst_unused:UNUSED_PRESERVE src0_sel:WORD_1
v_lshrrev_b32_e64 v193, 18, v193
v_mfma_f32_16x16x32_f16 v[164:167], v[240:243], v[236:239], v[164:167]
v_exp_f16_sdwa v195, v196 dst_sel:WORD_1 dst_unused:UNUSED_PRESERVE src0_sel:WORD_1
v_pk_add_f16 v201, v201, 1.0 op_sel_hi:[1,0]
v_mfma_f32_16x16x32_bf16 v[172:175], v[244:247], v[32:35], v[172:175]
ds_read_b128 v[240:243], v249
ds_read_u16_d16_hi v193, v193
v_pk_add_f16 v198, v198, 1.0 op_sel_hi:[1,0]
v_pk_add_f16 v195, v195, 1.0 op_sel_hi:[1,0]
v_mfma_f32_16x16x32_bf16 v[180:183], v[244:247], v[36:39], v[180:183]
v_rcp_f16 v202, v201
s_waitcnt lgkmcnt(7)
v_mfma_f32_16x16x32_bf16 v[168:171], v[216:219], v[40:43], v[168:171]
ds_read_b128 v[244:247], v249 offset:62464
v_rcp_f16_e64 v199, v198
v_mfma_f32_16x16x32_bf16 v[176:179], v[216:219], v[44:47], v[176:179]
v_rcp_f16_e64 v196, v195
v_mfma_f32_16x16x32_bf16 v[172:175], v[220:223], v[40:43], v[172:175]
ds_read_b128 v[216:219], v249 offset:256
v_rcp_f16_sdwa v202, v201 dst_sel:WORD_1 dst_unused:UNUSED_PRESERVE src0_sel:WORD_1
v_mfma_f32_16x16x32_bf16 v[180:183], v[220:223], v[44:47], v[180:183]
v_rcp_f16_sdwa v199, v198 dst_sel:WORD_1 dst_unused:UNUSED_PRESERVE src0_sel:WORD_1
v_or_b32 v232, v184, v185
v_or_b32 v233, v186, v187
s_waitcnt lgkmcnt(4)
v_or_b32 v234, v188, v189
v_rcp_f16_sdwa v196, v195 dst_sel:WORD_1 dst_unused:UNUSED_PRESERVE src0_sel:WORD_1
v_or_b32 v235, v190, v191
s_waitcnt lgkmcnt(2)
v_or_b32_e64 v236, v192, v193
v_pk_mul_f16 v237, v203, v202
v_pk_mul_f16 v238, v200, v199
v_pk_mul_f16 v239, v197, v196
v_mfma_f32_16x16x32_f16 v[120:123], v[224:227], v[232:235], v[120:123]
buffer_load_dwordx4 v[208:211], v252, s[4:7], s68 offen offset:64
ds_read_b128 v[220:223], v249 offset:62720
v_cvt_pkrtz_f16_f32 v185, v168, v169
v_cvt_pkrtz_f16_f32 v187, v170, v171
v_mfma_f32_16x16x32_f16 v[128:131], v[224:227], v[236:239], v[128:131]
v_cvt_pkrtz_f16_f32 v189, v172, v173
v_cvt_pkrtz_f16_f32 v191, v174, v175
v_mfma_f32_16x16x32_f16 v[124:127], v[228:231], v[232:235], v[124:127]
ds_read_b128 v[224:227], v249 offset:1024
v_cvt_pkrtz_f16_f32 v193, v176, v177
v_cvt_pk_f16_f32 v203, v178, v179
v_cvt_pk_f16_f32 v200, v180, v181
v_mfma_f32_16x16x32_f16 v[132:135], v[228:231], v[236:239], v[132:135]
v_cvt_pk_f16_f32 v197, v182, v183
s_setprio 1
v_pk_fma_f16 v202, v203, v203, s48
v_mfma_f32_16x16x32_bf16 v[168:171], v[240:243], v[24:27], 0
ds_read_b128 v[228:231], v249 offset:63488
v_and_b32 v185, s49, v185
v_pk_fma_f16 v199, v200, v200, s48
v_mfma_f32_16x16x32_bf16 v[176:179], v[240:243], v[28:31], 0
v_and_b32 v187, s49, v187
v_pk_fma_f16 v196, v197, v197, s48
v_bfe_u32 v184, v185, 2, 14
s_waitcnt lgkmcnt(3)
v_mfma_f32_16x16x32_f16 v[136:139], v[244:247], v[232:235], v[136:139]
ds_read_b128 v[240:243], v249 offset:63744
ds_read_u16_d16 v184, v184
v_pk_mul_f16 v202, v203, v202
v_bfe_u32 v186, v187, 2, 14
v_mfma_f32_16x16x32_f16 v[144:147], v[244:247], v[236:239], v[144:147]
v_pk_mul_f16 v199, v200, v199
v_lshrrev_b32_e64 v185, 18, v185
v_mfma_f32_16x16x32_bf16 v[172:175], v[216:219], v[24:27], 0
ds_read_b128 v[244:247], v249 offset:1280
ds_read_u16_d16 v186, v186
ds_read_u16_d16_hi v185, v185
v_pk_mul_f16 v196, v197, v196
v_lshrrev_b32_e64 v187, 18, v187
v_mfma_f32_16x16x32_bf16 v[180:183], v[216:219], v[28:31], 0
v_exp_f16_e64 v201, v202
v_and_b32 v189, s49, v189
s_waitcnt lgkmcnt(5)
v_mfma_f32_16x16x32_f16 v[140:143], v[220:223], v[232:235], v[140:143]
ds_read_b128 v[216:219], v249 offset:2048
ds_read_u16_d16_hi v187, v187
v_and_b32_e64 v191, s49, v191
v_mfma_f32_16x16x32_f16 v[148:151], v[220:223], v[236:239], v[148:151]
v_exp_f16_e64 v198, v199
v_bfe_u32 v188, v189, 2, 14
v_bfe_u32 v190, v191, 2, 14
v_mfma_f32_16x16x32_bf16 v[168:171], v[224:227], v[32:35], v[168:171]
ds_read_b128 v[220:223], v249 offset:2304
ds_read_u16_d16 v188, v188
ds_read_u16_d16 v190, v190
v_exp_f16_e64 v195, v196
v_mfma_f32_16x16x32_bf16 v[176:179], v[224:227], v[36:39], v[176:179]
v_lshrrev_b32 v189, 18, v189
v_lshrrev_b32 v191, 18, v191
v_mfma_f32_16x16x32_f16 v[152:155], v[228:231], v[232:235], v[152:155]
ds_read_b128 v[224:227], v250 offset:2048
ds_read_u16_d16_hi v189, v189
ds_read_u16_d16_hi v191, v191
v_exp_f16_sdwa v201, v202 dst_sel:WORD_1 dst_unused:UNUSED_PRESERVE src0_sel:WORD_1
v_and_b32 v193, s49, v193
v_mfma_f32_16x16x32_f16 v[160:163], v[228:231], v[236:239], v[160:163]
v_bfe_u32 v192, v193, 2, 14
s_waitcnt lgkmcnt(8)
v_mfma_f32_16x16x32_f16 v[156:159], v[240:243], v[232:235], v[156:159]
ds_read_b128 v[228:231], v250 offset:2304
ds_read_u16_d16 v192, v192
v_exp_f16_sdwa v198, v199 dst_sel:WORD_1 dst_unused:UNUSED_PRESERVE src0_sel:WORD_1
v_lshrrev_b32_e64 v193, 18, v193
v_mfma_f32_16x16x32_f16 v[164:167], v[240:243], v[236:239], v[164:167]
v_exp_f16_sdwa v195, v196 dst_sel:WORD_1 dst_unused:UNUSED_PRESERVE src0_sel:WORD_1
v_pk_add_f16 v201, v201, 1.0 op_sel_hi:[1,0]
v_mfma_f32_16x16x32_bf16 v[172:175], v[244:247], v[32:35], v[172:175]
ds_read_b128 v[240:243], v249 offset:6144
ds_read_u16_d16_hi v193, v193
v_pk_add_f16 v198, v198, 1.0 op_sel_hi:[1,0]
v_pk_add_f16 v195, v195, 1.0 op_sel_hi:[1,0]
v_mfma_f32_16x16x32_bf16 v[180:183], v[244:247], v[36:39], v[180:183]
v_rcp_f16_e64 v202, v201
s_setprio 0
s_waitcnt lgkmcnt(7)
v_mfma_f32_16x16x32_bf16 v[168:171], v[216:219], v[40:43], v[168:171]
ds_read_b128 v[244:247], v250 offset:3072
v_rcp_f16_e64 v199, v198
v_mfma_f32_16x16x32_bf16 v[176:179], v[216:219], v[44:47], v[176:179]
v_rcp_f16_e64 v196, v195
v_mfma_f32_16x16x32_bf16 v[172:175], v[220:223], v[40:43], v[172:175]
ds_read_b128 v[216:219], v249 offset:6400
v_rcp_f16_sdwa v202, v201 dst_sel:WORD_1 dst_unused:UNUSED_PRESERVE src0_sel:WORD_1
v_mfma_f32_16x16x32_bf16 v[180:183], v[220:223], v[44:47], v[180:183]
v_rcp_f16_sdwa v199, v198 dst_sel:WORD_1 dst_unused:UNUSED_PRESERVE src0_sel:WORD_1
v_or_b32 v232, v184, v185
v_or_b32 v233, v186, v187
s_waitcnt lgkmcnt(4)
v_or_b32 v234, v188, v189
v_rcp_f16_sdwa v196, v195 dst_sel:WORD_1 dst_unused:UNUSED_PRESERVE src0_sel:WORD_1
v_or_b32 v235, v190, v191
s_waitcnt lgkmcnt(2)
v_or_b32 v236, v192, v193
v_pk_mul_f16 v237, v203, v202
v_pk_mul_f16 v238, v200, v199
v_pk_mul_f16 v239, v197, v196
s_setprio 3
v_mfma_f32_16x16x32_f16 v[120:123], v[224:227], v[232:235], v[120:123]
ds_read_b128 v[220:223], v250 offset:3328
v_cvt_pkrtz_f16_f32 v185, v168, v169
v_cvt_pkrtz_f16_f32 v187, v170, v171
v_cvt_pkrtz_f16_f32 v189, v172, v173
v_mfma_f32_16x16x32_f16 v[128:131], v[224:227], v[236:239], v[128:131]
v_cvt_pkrtz_f16_f32 v191, v174, v175
v_cvt_pkrtz_f16_f32 v193, v176, v177
v_cvt_pk_f16_f32 v203, v178, v179
v_mfma_f32_16x16x32_f16 v[124:127], v[228:231], v[232:235], v[124:127]
ds_read_b128 v[224:227], v249 offset:7168
v_cvt_pk_f16_f32 v200, v180, v181
v_cvt_pk_f16_f32 v197, v182, v183
v_pk_fma_f16 v202, v203, v203, s48
v_cvt_pk_bf16_f32 v72, v72, v73
v_mfma_f32_16x16x32_f16 v[132:135], v[228:231], v[236:239], v[132:135]
v_and_b32_e64 v185, s49, v185
v_cvt_pk_bf16_f32 v73, v74, v75
v_pk_fma_f16 v199, v200, v200, s48
v_mfma_f32_16x16x32_bf16 v[168:171], v[240:243], v[24:27], 0
ds_read_b128 v[228:231], v250 offset:4096
v_and_b32 v187, s49, v187
v_cvt_pk_bf16_f32 v74, v76, v77
v_pk_fma_f16 v196, v197, v197, s48
v_mfma_f32_16x16x32_bf16 v[176:179], v[240:243], v[28:31], 0
v_cvt_pk_bf16_f32 v75, v78, v79
v_bfe_u32 v184, v185, 2, 14
v_pk_mul_f16 v202, v203, v202
v_cvt_pk_bf16_f32 v56, v56, v57
s_waitcnt lgkmcnt(2)
v_mfma_f32_16x16x32_f16 v[136:139], v[244:247], v[232:235], v[136:139]
ds_read_b128 v[240:243], v250 offset:4352
ds_read_u16_d16 v184, v184
v_bfe_u32 v186, v187, 2, 14
v_cvt_pk_bf16_f32 v57, v58, v59
v_pk_mul_f16 v199, v200, v199
v_mfma_f32_16x16x32_f16 v[144:147], v[244:247], v[236:239], v[144:147]
v_lshrrev_b32_e64 v185, 18, v185
v_cvt_pk_bf16_f32 v58, v60, v61
v_pk_mul_f16 v196, v197, v196
v_mfma_f32_16x16x32_bf16 v[172:175], v[216:219], v[24:27], 0
ds_read_b128 v[244:247], v249 offset:7424
ds_read_u16_d16 v186, v186
ds_read_u16_d16_hi v185, v185
v_lshrrev_b32_e64 v187, 18, v187
v_cvt_pk_bf16_f32 v59, v62, v63
v_exp_f16_e64 v201, v202
v_mfma_f32_16x16x32_bf16 v[180:183], v[216:219], v[28:31], 0
v_cvt_pk_bf16_f32 v88, v88, v89
v_and_b32_e64 v189, s49, v189
v_cvt_pk_bf16_f32 v89, v90, v91
v_mfma_f32_16x16x32_f16 v[140:143], v[220:223], v[232:235], v[140:143]
ds_read_b128 v[216:219], v249 offset:8192
ds_read_u16_d16_hi v187, v187
v_and_b32_e64 v191, s49, v191
v_cvt_pk_bf16_f32 v90, v92, v93
v_mfma_f32_16x16x32_f16 v[148:151], v[220:223], v[236:239], v[148:151]
v_exp_f16_e64 v198, v199
v_cvt_pk_bf16_f32 v91, v94, v95
s_mov_b64 vcc, s[74:75]
v_bfe_u32 v188, v189, 2, 14
v_bfe_u32 v190, v191, 2, 14
s_waitcnt lgkmcnt(5)
v_mfma_f32_16x16x32_bf16 v[168:171], v[224:227], v[32:35], v[168:171]
ds_read_b128 v[220:223], v249 offset:8448
ds_read_u16_d16 v188, v188
ds_read_u16_d16 v190, v190
v_cndmask_b32 v76, v56, v88, vcc
v_exp_f16 v195, v196
v_mfma_f32_16x16x32_bf16 v[176:179], v[224:227], v[36:39], v[176:179]
v_cndmask_b32 v77, v57, v89, vcc
v_lshrrev_b32_e64 v189, 18, v189
v_cndmask_b32 v78, v58, v90, vcc
v_mfma_f32_16x16x32_f16 v[152:155], v[228:231], v[232:235], v[152:155]
ds_read_b128 v[224:227], v250 offset:8192
ds_read_u16_d16_hi v189, v189
v_lshrrev_b32 v191, 18, v191
v_cndmask_b32 v79, v59, v91, vcc
v_exp_f16_sdwa v201, v202 dst_sel:WORD_1 dst_unused:UNUSED_PRESERVE src0_sel:WORD_1
v_mfma_f32_16x16x32_f16 v[160:163], v[228:231], v[236:239], v[160:163]
v_cndmask_b32_dpp v56, v72, v56, vcc quad_perm:[1,0,3,2] row_mask:0xf bank_mask:0xf
v_and_b32_e64 v193, s49, v193
v_cndmask_b32_dpp v57, v73, v57, vcc quad_perm:[1,0,3,2] row_mask:0xf bank_mask:0xf
v_mfma_f32_16x16x32_f16 v[156:159], v[240:243], v[232:235], v[156:159]
ds_read_b128 v[228:231], v250 offset:8448
ds_read_u16_d16_hi v191, v191
v_bfe_u32 v192, v193, 2, 14
v_exp_f16_sdwa v198, v199 dst_sel:WORD_1 dst_unused:UNUSED_PRESERVE src0_sel:WORD_1
v_mfma_f32_16x16x32_f16 v[164:167], v[240:243], v[236:239], v[164:167]
v_cndmask_b32_dpp v58, v74, v58, vcc quad_perm:[1,0,3,2] row_mask:0xf bank_mask:0xf
v_lshrrev_b32_e64 v193, 18, v193
v_cndmask_b32_dpp v59, v75, v59, vcc quad_perm:[1,0,3,2] row_mask:0xf bank_mask:0xf
s_not_b64 vcc, s[74:75]
s_waitcnt lgkmcnt(4)
v_mfma_f32_16x16x32_bf16 v[172:175], v[244:247], v[32:35], v[172:175]
ds_read_b128 v[240:243], v249 offset:12288
ds_read_u16_d16 v192, v192
ds_read_u16_d16_hi v193, v193
v_exp_f16_sdwa v195, v196 dst_sel:WORD_1 dst_unused:UNUSED_PRESERVE src0_sel:WORD_1
v_cndmask_b32_dpp v88, v72, v88, vcc quad_perm:[1,0,3,2] row_mask:0xf bank_mask:0xf
v_pk_add_f16 v201, v201, 1.0 op_sel_hi:[1,0]
v_mfma_f32_16x16x32_bf16 v[180:183], v[244:247], v[36:39], v[180:183]
v_cndmask_b32_dpp v89, v73, v89, vcc quad_perm:[1,0,3,2] row_mask:0xf bank_mask:0xf
v_pk_add_f16 v198, v198, 1.0 op_sel_hi:[1,0]
v_cndmask_b32_dpp v90, v74, v90, vcc quad_perm:[1,0,3,2] row_mask:0xf bank_mask:0xf
v_mfma_f32_16x16x32_bf16 v[168:171], v[216:219], v[40:43], v[168:171]
ds_read_b128 v[244:247], v250 offset:9216
v_pk_add_f16 v195, v195, 1.0 op_sel_hi:[1,0]
v_rcp_f16_e64 v202, v201
v_cndmask_b32_dpp v91, v75, v91, vcc quad_perm:[1,0,3,2] row_mask:0xf bank_mask:0xf
v_mfma_f32_16x16x32_bf16 v[176:179], v[216:219], v[44:47], v[176:179]
v_rcp_f16_e64 v199, v198
v_mfma_f32_16x16x32_bf16 v[172:175], v[220:223], v[40:43], v[172:175]
ds_read_b128 v[216:219], v249 offset:12544
s_add_u32 s46, s70, 98304
buffer_store_dwordx4 v[56:59], v255, s[8:11], s46 offen sc1
v_rcp_f16_e64 v196, v195
v_rcp_f16_sdwa v202, v201 dst_sel:WORD_1 dst_unused:UNUSED_PRESERVE src0_sel:WORD_1
v_mfma_f32_16x16x32_bf16 v[180:183], v[220:223], v[44:47], v[180:183]
v_rcp_f16_sdwa v199, v198 dst_sel:WORD_1 dst_unused:UNUSED_PRESERVE src0_sel:WORD_1
v_or_b32 v232, v184, v185
v_or_b32 v233, v186, v187
s_waitcnt lgkmcnt(2)
v_or_b32 v234, v188, v189
v_rcp_f16_sdwa v196, v195 dst_sel:WORD_1 dst_unused:UNUSED_PRESERVE src0_sel:WORD_1
v_or_b32 v235, v190, v191
v_or_b32 v236, v192, v193
v_pk_mul_f16 v237, v203, v202
v_pk_mul_f16 v238, v200, v199
v_pk_mul_f16 v239, v197, v196
v_mfma_f32_16x16x32_f16 v[120:123], v[224:227], v[232:235], v[120:123]
buffer_load_dwordx4 v[12:15], v252, s[4:7], s68 offen offset:128
ds_read_b128 v[220:223], v250 offset:9472
v_cvt_pkrtz_f16_f32 v185, v168, v169
v_cvt_pkrtz_f16_f32 v187, v170, v171
v_mfma_f32_16x16x32_f16 v[128:131], v[224:227], v[236:239], v[128:131]
v_cvt_pkrtz_f16_f32 v189, v172, v173
v_cvt_pkrtz_f16_f32 v191, v174, v175
v_mfma_f32_16x16x32_f16 v[124:127], v[228:231], v[232:235], v[124:127]
ds_read_b128 v[224:227], v249 offset:13312
v_cvt_pkrtz_f16_f32 v193, v176, v177
v_cvt_pk_f16_f32 v203, v178, v179
v_cvt_pk_f16_f32 v200, v180, v181
v_mfma_f32_16x16x32_f16 v[132:135], v[228:231], v[236:239], v[132:135]
v_cvt_pk_f16_f32 v197, v182, v183
v_pk_fma_f16 v202, v203, v203, s48
v_mfma_f32_16x16x32_bf16 v[168:171], v[240:243], v[24:27], 0
ds_read_b128 v[228:231], v250 offset:10240
v_and_b32_e64 v185, s49, v185
v_pk_fma_f16 v199, v200, v200, s48
v_mfma_f32_16x16x32_bf16 v[176:179], v[240:243], v[28:31], 0
v_and_b32_e64 v187, s49, v187
v_pk_fma_f16 v196, v197, v197, s48
s_setprio 2
v_bfe_u32 v184, v185, 2, 14
s_waitcnt lgkmcnt(3)
v_mfma_f32_16x16x32_f16 v[136:139], v[244:247], v[232:235], v[136:139]
ds_read_b128 v[240:243], v250 offset:10496
ds_read_u16_d16 v184, v184
v_pk_mul_f16 v202, v203, v202
v_bfe_u32 v186, v187, 2, 14
v_mfma_f32_16x16x32_f16 v[144:147], v[244:247], v[236:239], v[144:147]
v_pk_mul_f16 v199, v200, v199
v_lshrrev_b32_e64 v185, 18, v185
v_mfma_f32_16x16x32_bf16 v[172:175], v[216:219], v[24:27], 0
ds_read_b128 v[244:247], v249 offset:13568
ds_read_u16_d16 v186, v186
ds_read_u16_d16_hi v185, v185
v_pk_mul_f16 v196, v197, v196
v_lshrrev_b32_e64 v187, 18, v187
v_mfma_f32_16x16x32_bf16 v[180:183], v[216:219], v[28:31], 0
v_exp_f16_e64 v201, v202
v_and_b32 v189, s49, v189
s_waitcnt lgkmcnt(5)
v_mfma_f32_16x16x32_f16 v[140:143], v[220:223], v[232:235], v[140:143]
ds_read_b128 v[216:219], v249 offset:14336
ds_read_u16_d16_hi v187, v187
v_and_b32_e64 v191, s49, v191
v_mfma_f32_16x16x32_f16 v[148:151], v[220:223], v[236:239], v[148:151]
v_exp_f16_e64 v198, v199
v_bfe_u32 v188, v189, 2, 14
v_bfe_u32 v190, v191, 2, 14
v_mfma_f32_16x16x32_bf16 v[168:171], v[224:227], v[32:35], v[168:171]
ds_read_b128 v[220:223], v249 offset:14592
ds_read_u16_d16 v188, v188
ds_read_u16_d16 v190, v190
v_exp_f16_e64 v195, v196
v_mfma_f32_16x16x32_bf16 v[176:179], v[224:227], v[36:39], v[176:179]
v_lshrrev_b32 v189, 18, v189
v_lshrrev_b32 v191, 18, v191
v_mfma_f32_16x16x32_f16 v[152:155], v[228:231], v[232:235], v[152:155]
ds_read_b128 v[224:227], v250 offset:14336
ds_read_u16_d16_hi v189, v189
ds_read_u16_d16_hi v191, v191
v_exp_f16_sdwa v201, v202 dst_sel:WORD_1 dst_unused:UNUSED_PRESERVE src0_sel:WORD_1
v_and_b32 v193, s49, v193
v_mfma_f32_16x16x32_f16 v[160:163], v[228:231], v[236:239], v[160:163]
v_bfe_u32 v192, v193, 2, 14
s_waitcnt lgkmcnt(8)
v_mfma_f32_16x16x32_f16 v[156:159], v[240:243], v[232:235], v[156:159]
ds_read_b128 v[228:231], v250 offset:14592
ds_read_u16_d16 v192, v192
v_exp_f16_sdwa v198, v199 dst_sel:WORD_1 dst_unused:UNUSED_PRESERVE src0_sel:WORD_1
v_lshrrev_b32_e64 v193, 18, v193
v_mfma_f32_16x16x32_f16 v[164:167], v[240:243], v[236:239], v[164:167]
v_exp_f16_sdwa v195, v196 dst_sel:WORD_1 dst_unused:UNUSED_PRESERVE src0_sel:WORD_1
v_pk_add_f16 v201, v201, 1.0 op_sel_hi:[1,0]
v_mfma_f32_16x16x32_bf16 v[172:175], v[244:247], v[32:35], v[172:175]
ds_read_b128 v[240:243], v249 offset:18432
ds_read_u16_d16_hi v193, v193
v_pk_add_f16 v198, v198, 1.0 op_sel_hi:[1,0]
v_pk_add_f16 v195, v195, 1.0 op_sel_hi:[1,0]
v_mfma_f32_16x16x32_bf16 v[180:183], v[244:247], v[36:39], v[180:183]
v_rcp_f16 v202, v201
s_waitcnt lgkmcnt(7)
v_mfma_f32_16x16x32_bf16 v[168:171], v[216:219], v[40:43], v[168:171]
ds_read_b128 v[244:247], v250 offset:15360
v_rcp_f16_e64 v199, v198
v_mfma_f32_16x16x32_bf16 v[176:179], v[216:219], v[44:47], v[176:179]
v_rcp_f16_e64 v196, v195
v_mfma_f32_16x16x32_bf16 v[172:175], v[220:223], v[40:43], v[172:175]
ds_read_b128 v[216:219], v249 offset:18688
v_rcp_f16_sdwa v202, v201 dst_sel:WORD_1 dst_unused:UNUSED_PRESERVE src0_sel:WORD_1
v_mfma_f32_16x16x32_bf16 v[180:183], v[220:223], v[44:47], v[180:183]
v_rcp_f16_sdwa v199, v198 dst_sel:WORD_1 dst_unused:UNUSED_PRESERVE src0_sel:WORD_1
v_or_b32 v232, v184, v185
v_or_b32 v233, v186, v187
s_waitcnt lgkmcnt(4)
v_or_b32 v234, v188, v189
v_rcp_f16_sdwa v196, v195 dst_sel:WORD_1 dst_unused:UNUSED_PRESERVE src0_sel:WORD_1
v_or_b32 v235, v190, v191
s_waitcnt lgkmcnt(2)
v_or_b32_e64 v236, v192, v193
v_pk_mul_f16 v237, v203, v202
v_pk_mul_f16 v238, v200, v199
v_pk_mul_f16 v239, v197, v196
v_mfma_f32_16x16x32_f16 v[120:123], v[224:227], v[232:235], v[120:123]
s_add_u32 s46, s68, 98304
buffer_load_dwordx4 v[8:11], v252, s[4:7], s46 offen
ds_read_b128 v[220:223], v250 offset:15616
v_cvt_pkrtz_f16_f32 v185, v168, v169
v_cvt_pkrtz_f16_f32 v187, v170, v171
v_mfma_f32_16x16x32_f16 v[128:131], v[224:227], v[236:239], v[128:131]
v_cvt_pkrtz_f16_f32 v189, v172, v173
v_cvt_pkrtz_f16_f32 v191, v174, v175
v_mfma_f32_16x16x32_f16 v[124:127], v[228:231], v[232:235], v[124:127]
ds_read_b128 v[224:227], v249 offset:19456
v_cvt_pkrtz_f16_f32 v193, v176, v177
v_cvt_pk_f16_f32 v203, v178, v179
v_cvt_pk_f16_f32 v200, v180, v181
v_mfma_f32_16x16x32_f16 v[132:135], v[228:231], v[236:239], v[132:135]
v_cvt_pk_f16_f32 v197, v182, v183
s_setprio 1
v_pk_fma_f16 v202, v203, v203, s48
v_mfma_f32_16x16x32_bf16 v[168:171], v[240:243], v[24:27], 0
ds_read_b128 v[228:231], v250 offset:16384
v_and_b32 v185, s49, v185
v_pk_fma_f16 v199, v200, v200, s48
v_mfma_f32_16x16x32_bf16 v[176:179], v[240:243], v[28:31], 0
v_and_b32 v187, s49, v187
v_pk_fma_f16 v196, v197, v197, s48
v_bfe_u32 v184, v185, 2, 14
s_waitcnt lgkmcnt(3)
v_mfma_f32_16x16x32_f16 v[136:139], v[244:247], v[232:235], v[136:139]
ds_read_b128 v[240:243], v250 offset:16640
ds_read_u16_d16 v184, v184
v_pk_mul_f16 v202, v203, v202
v_bfe_u32 v186, v187, 2, 14
v_mfma_f32_16x16x32_f16 v[144:147], v[244:247], v[236:239], v[144:147]
v_pk_mul_f16 v199, v200, v199
v_lshrrev_b32_e64 v185, 18, v185
v_mfma_f32_16x16x32_bf16 v[172:175], v[216:219], v[24:27], 0
ds_read_b128 v[244:247], v249 offset:19712
ds_read_u16_d16 v186, v186
ds_read_u16_d16_hi v185, v185
v_pk_mul_f16 v196, v197, v196
v_lshrrev_b32_e64 v187, 18, v187
v_mfma_f32_16x16x32_bf16 v[180:183], v[216:219], v[28:31], 0
v_exp_f16_e64 v201, v202
v_and_b32 v189, s49, v189
s_waitcnt lgkmcnt(5)
v_mfma_f32_16x16x32_f16 v[140:143], v[220:223], v[232:235], v[140:143]
ds_read_b128 v[216:219], v249 offset:20480
ds_read_u16_d16_hi v187, v187
v_and_b32_e64 v191, s49, v191
v_mfma_f32_16x16x32_f16 v[148:151], v[220:223], v[236:239], v[148:151]
v_exp_f16_e64 v198, v199
v_bfe_u32 v188, v189, 2, 14
v_bfe_u32 v190, v191, 2, 14
v_mfma_f32_16x16x32_bf16 v[168:171], v[224:227], v[32:35], v[168:171]
s_add_u32 s46, s70, 98304
buffer_store_dwordx4 v[76:79], v255, s[8:11], s46 offen offset:128 sc1
ds_read_b128 v[220:223], v249 offset:20736
ds_read_u16_d16 v188, v188
ds_read_u16_d16 v190, v190
v_exp_f16_e64 v195, v196
v_mfma_f32_16x16x32_bf16 v[176:179], v[224:227], v[36:39], v[176:179]
v_lshrrev_b32 v189, 18, v189
v_lshrrev_b32 v191, 18, v191
v_mfma_f32_16x16x32_f16 v[152:155], v[228:231], v[232:235], v[152:155]
ds_read_b128 v[224:227], v250 offset:20480
ds_read_u16_d16_hi v189, v189
ds_read_u16_d16_hi v191, v191
v_exp_f16_sdwa v201, v202 dst_sel:WORD_1 dst_unused:UNUSED_PRESERVE src0_sel:WORD_1
v_and_b32 v193, s49, v193
v_mfma_f32_16x16x32_f16 v[160:163], v[228:231], v[236:239], v[160:163]
v_bfe_u32 v192, v193, 2, 14
s_waitcnt lgkmcnt(7)
v_mfma_f32_16x16x32_f16 v[156:159], v[240:243], v[232:235], v[156:159]
ds_read_b128 v[228:231], v250 offset:20736
ds_read_u16_d16 v192, v192
v_exp_f16_sdwa v198, v199 dst_sel:WORD_1 dst_unused:UNUSED_PRESERVE src0_sel:WORD_1
v_lshrrev_b32_e64 v193, 18, v193
v_mfma_f32_16x16x32_f16 v[164:167], v[240:243], v[236:239], v[164:167]
v_exp_f16_sdwa v195, v196 dst_sel:WORD_1 dst_unused:UNUSED_PRESERVE src0_sel:WORD_1
v_pk_add_f16 v201, v201, 1.0 op_sel_hi:[1,0]
v_mfma_f32_16x16x32_bf16 v[172:175], v[244:247], v[32:35], v[172:175]
ds_read_b128 v[240:243], v248 offset:16384
ds_read_u16_d16_hi v193, v193
v_pk_add_f16 v198, v198, 1.0 op_sel_hi:[1,0]
v_pk_add_f16 v195, v195, 1.0 op_sel_hi:[1,0]
v_mfma_f32_16x16x32_bf16 v[180:183], v[244:247], v[36:39], v[180:183]
v_rcp_f16 v202, v201
s_setprio 0
v_mfma_f32_16x16x32_bf16 v[168:171], v[216:219], v[40:43], v[168:171]
ds_read_b128 v[244:247], v250 offset:21504
v_rcp_f16_e64 v199, v198
v_mfma_f32_16x16x32_bf16 v[176:179], v[216:219], v[44:47], v[176:179]
v_rcp_f16 v196, v195
s_waitcnt lgkmcnt(5)
v_mfma_f32_16x16x32_bf16 v[172:175], v[220:223], v[40:43], v[172:175]
ds_read_b128 v[216:219], v248 offset:16640
v_rcp_f16_sdwa v202, v201 dst_sel:WORD_1 dst_unused:UNUSED_PRESERVE src0_sel:WORD_1
v_mfma_f32_16x16x32_bf16 v[180:183], v[220:223], v[44:47], v[180:183]
v_rcp_f16_sdwa v199, v198 dst_sel:WORD_1 dst_unused:UNUSED_PRESERVE src0_sel:WORD_1
v_or_b32 v232, v184, v185
v_or_b32 v233, v186, v187
v_or_b32_e64 v234, v188, v189
v_rcp_f16_sdwa v196, v195 dst_sel:WORD_1 dst_unused:UNUSED_PRESERVE src0_sel:WORD_1
v_or_b32 v235, v190, v191
s_waitcnt lgkmcnt(2)
v_or_b32 v236, v192, v193
v_pk_mul_f16 v237, v203, v202
v_pk_mul_f16 v238, v200, v199
v_pk_mul_f16 v239, v197, v196
s_setprio 3
v_mfma_f32_16x16x32_f16 v[120:123], v[224:227], v[232:235], v[120:123]
ds_read_b128 v[220:223], v250 offset:21760
v_cvt_pkrtz_f16_f32 v185, v168, v169
v_cvt_pkrtz_f16_f32 v187, v170, v171
v_mfma_f32_16x16x32_f16 v[128:131], v[224:227], v[236:239], v[128:131]
v_cvt_pkrtz_f16_f32 v189, v172, v173
v_cvt_pkrtz_f16_f32 v191, v174, v175
v_mfma_f32_16x16x32_f16 v[124:127], v[228:231], v[232:235], v[124:127]
ds_read_b128 v[224:227], v248 offset:17408
v_cvt_pkrtz_f16_f32 v193, v176, v177
v_cvt_pk_f16_f32 v203, v178, v179
v_cvt_pk_f16_f32 v200, v180, v181
v_mfma_f32_16x16x32_f16 v[132:135], v[228:231], v[236:239], v[132:135]
v_cvt_pk_f16_f32 v197, v182, v183
v_pk_fma_f16 v202, v203, v203, s48
s_waitcnt vmcnt(14)
v_mfma_f32_16x16x32_bf16 v[168:171], v[240:243], v[96:99], 0
ds_read_b128 v[228:231], v250 offset:22528
v_and_b32_e64 v185, s49, v185
v_pk_fma_f16 v199, v200, v200, s48
s_waitcnt vmcnt(13)
v_mfma_f32_16x16x32_bf16 v[176:179], v[240:243], v[100:103], 0
v_and_b32 v187, s49, v187
v_pk_fma_f16 v196, v197, v197, s48
v_bfe_u32 v184, v185, 2, 14
s_waitcnt lgkmcnt(3)
v_mfma_f32_16x16x32_f16 v[136:139], v[244:247], v[232:235], v[136:139]
ds_read_b128 v[240:243], v250 offset:22784
ds_read_u16_d16 v184, v184
v_pk_mul_f16 v202, v203, v202
v_bfe_u32 v186, v187, 2, 14
v_mfma_f32_16x16x32_f16 v[144:147], v[244:247], v[236:239], v[144:147]
v_pk_mul_f16 v199, v200, v199
v_lshrrev_b32_e64 v185, 18, v185
v_mfma_f32_16x16x32_bf16 v[172:175], v[216:219], v[96:99], 0
ds_read_b128 v[244:247], v248 offset:17664
ds_read_u16_d16 v186, v186
ds_read_u16_d16_hi v185, v185
v_pk_mul_f16 v196, v197, v196
v_lshrrev_b32_e64 v187, 18, v187
v_mfma_f32_16x16x32_bf16 v[180:183], v[216:219], v[100:103], 0
v_exp_f16_e64 v201, v202
v_and_b32 v189, s49, v189
s_waitcnt lgkmcnt(5)
v_mfma_f32_16x16x32_f16 v[140:143], v[220:223], v[232:235], v[140:143]
ds_read_b128 v[216:219], v248 offset:18432
ds_read_u16_d16_hi v187, v187
v_and_b32_e64 v191, s49, v191
v_mfma_f32_16x16x32_f16 v[148:151], v[220:223], v[236:239], v[148:151]
v_exp_f16 v198, v199
v_bfe_u32 v188, v189, 2, 14
v_bfe_u32 v190, v191, 2, 14
s_waitcnt vmcnt(12)
v_mfma_f32_16x16x32_bf16 v[168:171], v[224:227], v[104:107], v[168:171]
ds_read_b128 v[220:223], v248 offset:18688
ds_read_u16_d16 v188, v188
ds_read_u16_d16 v190, v190
v_exp_f16 v195, v196
s_waitcnt vmcnt(11)
v_mfma_f32_16x16x32_bf16 v[176:179], v[224:227], v[108:111], v[176:179]
v_lshrrev_b32 v189, 18, v189
v_lshrrev_b32 v191, 18, v191
v_mfma_f32_16x16x32_f16 v[152:155], v[228:231], v[232:235], v[152:155]
ds_read_b128 v[224:227], v250 offset:26624
ds_read_u16_d16_hi v189, v189
ds_read_u16_d16_hi v191, v191
v_exp_f16_sdwa v201, v202 dst_sel:WORD_1 dst_unused:UNUSED_PRESERVE src0_sel:WORD_1
v_and_b32 v193, s49, v193
v_mfma_f32_16x16x32_f16 v[160:163], v[228:231], v[236:239], v[160:163]
v_bfe_u32 v192, v193, 2, 14
s_waitcnt lgkmcnt(7)
v_mfma_f32_16x16x32_f16 v[156:159], v[240:243], v[232:235], v[156:159]
ds_read_b128 v[228:231], v250 offset:26880
ds_read_u16_d16 v192, v192
v_exp_f16_sdwa v198, v199 dst_sel:WORD_1 dst_unused:UNUSED_PRESERVE src0_sel:WORD_1
v_lshrrev_b32_e64 v193, 18, v193
v_mfma_f32_16x16x32_f16 v[164:167], v[240:243], v[236:239], v[164:167]
v_exp_f16_sdwa v195, v196 dst_sel:WORD_1 dst_unused:UNUSED_PRESERVE src0_sel:WORD_1
v_pk_add_f16 v201, v201, 1.0 op_sel_hi:[1,0]
v_mfma_f32_16x16x32_bf16 v[172:175], v[244:247], v[104:107], v[172:175]
ds_read_b128 v[240:243], v248 offset:22528
ds_read_u16_d16_hi v193, v193
v_pk_add_f16 v198, v198, 1.0 op_sel_hi:[1,0]
v_pk_add_f16 v195, v195, 1.0 op_sel_hi:[1,0]
v_mfma_f32_16x16x32_bf16 v[180:183], v[244:247], v[108:111], v[180:183]
v_rcp_f16 v202, v201
s_waitcnt vmcnt(10)
v_mfma_f32_16x16x32_bf16 v[168:171], v[216:219], v[112:115], v[168:171]
ds_read_b128 v[244:247], v250 offset:27648
v_rcp_f16 v199, v198
s_waitcnt vmcnt(7)
v_mfma_f32_16x16x32_bf16 v[176:179], v[216:219], v[116:119], v[176:179]
v_rcp_f16 v196, v195
s_waitcnt lgkmcnt(5)
v_mfma_f32_16x16x32_bf16 v[172:175], v[220:223], v[112:115], v[172:175]
ds_read_b128 v[216:219], v248 offset:22784
v_rcp_f16_sdwa v202, v201 dst_sel:WORD_1 dst_unused:UNUSED_PRESERVE src0_sel:WORD_1
v_mfma_f32_16x16x32_bf16 v[180:183], v[220:223], v[116:119], v[180:183]
v_rcp_f16_sdwa v199, v198 dst_sel:WORD_1 dst_unused:UNUSED_PRESERVE src0_sel:WORD_1
v_or_b32 v232, v184, v185
v_or_b32 v233, v186, v187
v_or_b32_e64 v234, v188, v189
v_rcp_f16_sdwa v196, v195 dst_sel:WORD_1 dst_unused:UNUSED_PRESERVE src0_sel:WORD_1
v_or_b32 v235, v190, v191
s_waitcnt lgkmcnt(2)
v_or_b32_e64 v236, v192, v193
v_pk_mul_f16 v237, v203, v202
v_pk_mul_f16 v238, v200, v199
v_pk_mul_f16 v239, v197, v196
v_mfma_f32_16x16x32_f16 v[120:123], v[224:227], v[232:235], v[120:123]
s_add_u32 s46, s68, 98304
buffer_load_dwordx4 v[44:47], v252, s[4:7], s46 offen offset:64
ds_read_b128 v[220:223], v250 offset:27904
v_cvt_pkrtz_f16_f32 v185, v168, v169
v_cvt_pkrtz_f16_f32 v187, v170, v171
v_mfma_f32_16x16x32_f16 v[128:131], v[224:227], v[236:239], v[128:131]
v_cvt_pkrtz_f16_f32 v189, v172, v173
v_cvt_pkrtz_f16_f32 v191, v174, v175
v_mfma_f32_16x16x32_f16 v[124:127], v[228:231], v[232:235], v[124:127]
ds_read_b128 v[224:227], v248 offset:23552
v_cvt_pkrtz_f16_f32 v193, v176, v177
v_cvt_pk_f16_f32 v203, v178, v179
v_mfma_f32_16x16x32_f16 v[132:135], v[228:231], v[236:239], v[132:135]
v_cvt_pk_f16_f32 v200, v180, v181
v_cvt_pk_f16_f32 v197, v182, v183
v_mfma_f32_16x16x32_bf16 v[168:171], v[240:243], v[96:99], 0
ds_read_b128 v[228:231], v250 offset:28672
v_pk_fma_f16 v202, v203, v203, s48
v_and_b32_e64 v185, s49, v185
v_mfma_f32_16x16x32_bf16 v[176:179], v[240:243], v[100:103], 0
v_pk_fma_f16 v199, v200, v200, s48
v_and_b32 v187, s49, v187
s_waitcnt lgkmcnt(3)
v_mfma_f32_16x16x32_f16 v[136:139], v[244:247], v[232:235], v[136:139]
ds_read_b128 v[240:243], v250 offset:28928
v_pk_fma_f16 v196, v197, v197, s48
s_setprio 2
v_bfe_u32 v184, v185, 2, 14
v_pk_mul_f16 v202, v203, v202
v_mfma_f32_16x16x32_f16 v[144:147], v[244:247], v[236:239], v[144:147]
v_bfe_u32 v186, v187, 2, 14
v_pk_mul_f16 v199, v200, v199
s_waitcnt vmcnt(7)
v_mfma_f32_16x16x32_bf16 v[120:123], v[18:21], v[204:207], v[120:123]
ds_read_b128 v[244:247], v248 offset:23808
ds_read_u16_d16 v184, v184
ds_read_u16_d16 v186, v186
v_lshrrev_b32_e64 v185, 18, v185
v_pk_mul_f16 v196, v197, v196
v_mfma_f32_16x16x32_bf16 v[124:127], v[16:19], v[204:207], v[124:127]
v_lshrrev_b32_e64 v187, 18, v187
v_mfma_f32_16x16x32_bf16 v[172:175], v[216:219], v[96:99], 0
ds_read_u16_d16_hi v185, v185
ds_read_u16_d16_hi v187, v187
v_exp_f16 v201, v202
v_and_b32 v189, s49, v189
v_mfma_f32_16x16x32_bf16 v[180:183], v[216:219], v[100:103], 0
v_and_b32 v191, s49, v191
s_waitcnt lgkmcnt(6)
v_mfma_f32_16x16x32_f16 v[140:143], v[220:223], v[232:235], v[140:143]
ds_read_b128 v[216:219], v248 offset:24576
v_exp_f16_e64 v198, v199
v_bfe_u32 v188, v189, 2, 14
v_mfma_f32_16x16x32_f16 v[148:151], v[220:223], v[236:239], v[148:151]
v_bfe_u32 v190, v191, 2, 14
v_exp_f16_e64 v195, v196
v_mfma_f32_16x16x32_bf16 v[168:171], v[224:227], v[104:107], v[168:171]
s_add_u32 s46, s70, 98304
buffer_store_dwordx4 v[88:91], v255, s[8:11], s46 offen offset:256 sc1
ds_read_b128 v[220:223], v248 offset:24832
ds_read_u16_d16 v188, v188
ds_read_u16_d16 v190, v190
v_lshrrev_b32 v189, 18, v189
v_lshrrev_b32 v191, 18, v191
v_mfma_f32_16x16x32_bf16 v[176:179], v[224:227], v[108:111], v[176:179]
v_exp_f16_sdwa v201, v202 dst_sel:WORD_1 dst_unused:UNUSED_PRESERVE src0_sel:WORD_1
v_mfma_f32_16x16x32_f16 v[152:155], v[228:231], v[232:235], v[152:155]
ds_read_b128 v[224:227], v249 offset:24576
ds_read_u16_d16_hi v189, v189
ds_read_u16_d16_hi v191, v191
v_and_b32 v193, s49, v193
v_bfe_u32 v192, v193, 2, 14
v_mfma_f32_16x16x32_f16 v[160:163], v[228:231], v[236:239], v[160:163]
v_exp_f16_sdwa v198, v199 dst_sel:WORD_1 dst_unused:UNUSED_PRESERVE src0_sel:WORD_1
s_waitcnt lgkmcnt(7)
v_mfma_f32_16x16x32_f16 v[156:159], v[240:243], v[232:235], v[156:159]
ds_read_b128 v[228:231], v254 offset:7936
ds_read_u16_d16 v192, v192
v_lshrrev_b32_e64 v193, 18, v193
v_mfma_f32_16x16x32_f16 v[164:167], v[240:243], v[236:239], v[164:167]
v_exp_f16_sdwa v195, v196 dst_sel:WORD_1 dst_unused:UNUSED_PRESERVE src0_sel:WORD_1
v_pk_add_f16 v201, v201, 1.0 op_sel_hi:[1,0]
v_pk_add_f16 v198, v198, 1.0 op_sel_hi:[1,0]
v_mfma_f32_16x16x32_bf16 v[172:175], v[244:247], v[104:107], v[172:175]
ds_read_b128 v[240:243], v249 offset:24832
ds_read_u16_d16_hi v193, v193
v_pk_add_f16 v195, v195, 1.0 op_sel_hi:[1,0]
v_mfma_f32_16x16x32_bf16 v[180:183], v[244:247], v[108:111], v[180:183]
v_rcp_f16 v202, v201
s_waitcnt lgkmcnt(7)
v_mfma_f32_16x16x32_bf16 v[168:171], v[216:219], v[112:115], v[168:171]
ds_read_b128 v[244:247], v254 offset:7952
v_rcp_f16_e64 v199, v198
v_mfma_f32_16x16x32_bf16 v[176:179], v[216:219], v[116:119], v[176:179]
v_rcp_f16_e64 v196, v195
v_mfma_f32_16x16x32_bf16 v[172:175], v[220:223], v[112:115], v[172:175]
ds_read_b128 v[216:219], v248 offset:28672
v_rcp_f16_sdwa v202, v201 dst_sel:WORD_1 dst_unused:UNUSED_PRESERVE src0_sel:WORD_1
v_mfma_f32_16x16x32_bf16 v[180:183], v[220:223], v[116:119], v[180:183]
v_rcp_f16_sdwa v199, v198 dst_sel:WORD_1 dst_unused:UNUSED_PRESERVE src0_sel:WORD_1
v_or_b32 v232, v184, v185
v_or_b32 v233, v186, v187
s_waitcnt lgkmcnt(4)
v_or_b32 v234, v188, v189
v_rcp_f16_sdwa v196, v195 dst_sel:WORD_1 dst_unused:UNUSED_PRESERVE src0_sel:WORD_1
v_or_b32 v235, v190, v191
s_waitcnt lgkmcnt(2)
v_or_b32 v236, v192, v193
v_pk_mul_f16 v237, v203, v202
v_pk_mul_f16 v238, v200, v199
v_pk_mul_f16 v239, v197, v196
v_mfma_f32_16x16x32_f16 v[48:51], v[224:227], v[232:235], v[228:231]
ds_read_b128 v[220:223], v249 offset:25600
v_cvt_pkrtz_f16_f32 v185, v168, v169
v_cvt_pkrtz_f16_f32 v187, v170, v171
v_mfma_f32_16x16x32_f16 v[56:59], v[224:227], v[236:239], v[228:231]
v_cvt_pkrtz_f16_f32 v189, v172, v173
v_cvt_pkrtz_f16_f32 v191, v174, v175
s_waitcnt lgkmcnt(2)
v_mfma_f32_16x16x32_f16 v[52:55], v[240:243], v[232:235], v[244:247]
ds_read_b128 v[224:227], v254 offset:8064
ds_read_b128 v[228:231], v248 offset:28928
v_cvt_pkrtz_f16_f32 v193, v176, v177
v_cvt_pk_f16_f32 v203, v178, v179
v_mfma_f32_16x16x32_f16 v[60:63], v[240:243], v[236:239], v[244:247]
v_cvt_pk_f16_f32 v200, v180, v181
v_cvt_pk_f16_f32 v197, v182, v183
s_setprio 1
s_waitcnt lgkmcnt(3)
v_mfma_f32_16x16x32_bf16 v[168:171], v[216:219], v[96:99], 0
ds_read_b128 v[240:243], v249 offset:25856
ds_read_b128 v[244:247], v254 offset:8080
v_pk_fma_f16 v202, v203, v203, s48
v_and_b32_e64 v185, s49, v185
v_mfma_f32_16x16x32_bf16 v[176:179], v[216:219], v[100:103], 0
v_pk_fma_f16 v199, v200, v200, s48
v_and_b32 v187, s49, v187
s_waitcnt lgkmcnt(3)
v_mfma_f32_16x16x32_f16 v[64:67], v[220:223], v[232:235], v[224:227]
ds_read_b128 v[216:219], v248 offset:29696
v_pk_fma_f16 v196, v197, v197, s48
v_bfe_u32 v184, v185, 2, 14
v_pk_mul_f16 v202, v203, v202
v_mfma_f32_16x16x32_f16 v[72:75], v[220:223], v[236:239], v[224:227]
v_bfe_u32 v186, v187, 2, 14
v_pk_mul_f16 v199, v200, v199
s_waitcnt vmcnt(6)
v_mfma_f32_16x16x32_bf16 v[136:139], v[18:21], v[208:211], v[136:139]
ds_read_b128 v[220:223], v249 offset:26624
ds_read_b128 v[224:227], v254 offset:16128
ds_read_u16_d16 v184, v184
ds_read_u16_d16 v186, v186
v_lshrrev_b32 v185, 18, v185
v_pk_mul_f16 v196, v197, v196
v_mfma_f32_16x16x32_bf16 v[140:143], v[16:19], v[208:211], v[140:143]
v_lshrrev_b32 v187, 18, v187
s_waitcnt lgkmcnt(5)
v_mfma_f32_16x16x32_bf16 v[172:175], v[228:231], v[96:99], 0
ds_read_u16_d16_hi v185, v185
ds_read_u16_d16_hi v187, v187
v_exp_f16 v201, v202
v_and_b32 v189, s49, v189
v_mfma_f32_16x16x32_bf16 v[180:183], v[228:231], v[100:103], 0
v_and_b32_e64 v191, s49, v191
v_mfma_f32_16x16x32_f16 v[68:71], v[240:243], v[232:235], v[244:247]
ds_read_b128 v[228:231], v249 offset:26880
v_exp_f16_e64 v198, v199
v_bfe_u32 v188, v189, 2, 14
v_mfma_f32_16x16x32_f16 v[76:79], v[240:243], v[236:239], v[244:247]
v_bfe_u32 v190, v191, 2, 14
v_exp_f16 v195, v196
s_waitcnt lgkmcnt(7)
v_mfma_f32_16x16x32_bf16 v[168:171], v[216:219], v[104:107], v[168:171]
ds_read_b128 v[240:243], v254 offset:16144
ds_read_b128 v[244:247], v248 offset:29952
ds_read_u16_d16 v188, v188
ds_read_u16_d16 v190, v190
v_lshrrev_b32_e64 v189, 18, v189
v_lshrrev_b32 v191, 18, v191
v_mfma_f32_16x16x32_bf16 v[176:179], v[216:219], v[108:111], v[176:179]
v_exp_f16_sdwa v201, v202 dst_sel:WORD_1 dst_unused:UNUSED_PRESERVE src0_sel:WORD_1
s_waitcnt lgkmcnt(7)
v_mfma_f32_16x16x32_f16 v[80:83], v[220:223], v[232:235], v[224:227]
ds_read_b128 v[216:219], v248 offset:30720
ds_read_u16_d16_hi v189, v189
ds_read_u16_d16_hi v191, v191
v_and_b32 v193, s49, v193
v_bfe_u32 v192, v193, 2, 14
v_mfma_f32_16x16x32_f16 v[88:91], v[220:223], v[236:239], v[224:227]
v_exp_f16_sdwa v198, v199 dst_sel:WORD_1 dst_unused:UNUSED_PRESERVE src0_sel:WORD_1
s_waitcnt lgkmcnt(6)
v_mfma_f32_16x16x32_f16 v[84:87], v[228:231], v[232:235], v[240:243]
ds_read_b128 v[220:223], v248 offset:30976
ds_read_b128 v[224:227], v249 offset:30720
ds_read_u16_d16 v192, v192
v_lshrrev_b32 v193, 18, v193
v_mfma_f32_16x16x32_f16 v[92:95], v[228:231], v[236:239], v[240:243]
v_exp_f16_sdwa v195, v196 dst_sel:WORD_1 dst_unused:UNUSED_PRESERVE src0_sel:WORD_1
v_pk_add_f16 v201, v201, 1.0 op_sel_hi:[1,0]
v_pk_add_f16 v198, v198, 1.0 op_sel_hi:[1,0]
s_waitcnt lgkmcnt(7)
v_mfma_f32_16x16x32_bf16 v[172:175], v[244:247], v[104:107], v[172:175]
ds_read_b128 v[228:231], v249 offset:30976
ds_read_b128 v[240:243], v248 offset:34816
ds_read_u16_d16_hi v193, v193
v_pk_add_f16 v195, v195, 1.0 op_sel_hi:[1,0]
v_mfma_f32_16x16x32_bf16 v[180:183], v[244:247], v[108:111], v[180:183]
v_rcp_f16_e64 v202, v201
s_setprio 0
s_waitcnt lgkmcnt(7)
v_mfma_f32_16x16x32_bf16 v[168:171], v[216:219], v[112:115], v[168:171]
ds_read_b128 v[244:247], v249 offset:31744
v_rcp_f16_e64 v199, v198
v_mfma_f32_16x16x32_bf16 v[176:179], v[216:219], v[116:119], v[176:179]
v_rcp_f16 v196, v195
s_waitcnt lgkmcnt(6)
v_mfma_f32_16x16x32_bf16 v[172:175], v[220:223], v[112:115], v[172:175]
ds_read_b128 v[216:219], v248 offset:35072
v_rcp_f16_sdwa v202, v201 dst_sel:WORD_1 dst_unused:UNUSED_PRESERVE src0_sel:WORD_1
v_mfma_f32_16x16x32_bf16 v[180:183], v[220:223], v[116:119], v[180:183]
v_rcp_f16_sdwa v199, v198 dst_sel:WORD_1 dst_unused:UNUSED_PRESERVE src0_sel:WORD_1
v_or_b32 v232, v184, v185
v_or_b32 v233, v186, v187
v_or_b32_e64 v234, v188, v189
v_rcp_f16_sdwa v196, v195 dst_sel:WORD_1 dst_unused:UNUSED_PRESERVE src0_sel:WORD_1
v_or_b32 v235, v190, v191
s_waitcnt lgkmcnt(2)
v_or_b32 v236, v192, v193
v_pk_mul_f16 v237, v203, v202
v_pk_mul_f16 v238, v200, v199
v_pk_mul_f16 v239, v197, v196
s_setprio 3
v_mfma_f32_16x16x32_f16 v[48:51], v[224:227], v[232:235], v[48:51]
s_add_u32 s46, s68, 98304
buffer_load_dwordx4 v[208:211], v252, s[4:7], s46 offen offset:128
ds_read_b128 v[220:223], v249 offset:32000
v_cvt_pkrtz_f16_f32 v185, v168, v169
v_cvt_pkrtz_f16_f32 v187, v170, v171
v_mfma_f32_16x16x32_f16 v[56:59], v[224:227], v[236:239], v[56:59]
v_cvt_pkrtz_f16_f32 v189, v172, v173
v_cvt_pkrtz_f16_f32 v191, v174, v175
v_mfma_f32_16x16x32_f16 v[52:55], v[228:231], v[232:235], v[52:55]
ds_read_b128 v[224:227], v248 offset:35840
v_cvt_pkrtz_f16_f32 v193, v176, v177
v_cvt_pk_f16_f32 v203, v178, v179
v_mfma_f32_16x16x32_f16 v[60:63], v[228:231], v[236:239], v[60:63]
v_cvt_pk_f16_f32 v200, v180, v181
v_cvt_pk_f16_f32 v197, v182, v183
v_mfma_f32_16x16x32_bf16 v[168:171], v[240:243], v[96:99], 0
ds_read_b128 v[228:231], v249 offset:32768
v_pk_fma_f16 v202, v203, v203, s48
v_and_b32_e64 v185, s49, v185
v_mfma_f32_16x16x32_bf16 v[176:179], v[240:243], v[100:103], 0
v_pk_fma_f16 v199, v200, v200, s48
v_and_b32 v187, s49, v187
s_waitcnt lgkmcnt(3)
v_mfma_f32_16x16x32_f16 v[64:67], v[244:247], v[232:235], v[64:67]
ds_read_b128 v[240:243], v249 offset:33024
v_pk_fma_f16 v196, v197, v197, s48
v_bfe_u32 v184, v185, 2, 14
v_pk_mul_f16 v202, v203, v202
v_mfma_f32_16x16x32_f16 v[72:75], v[244:247], v[236:239], v[72:75]
v_bfe_u32 v186, v187, 2, 14
v_pk_mul_f16 v199, v200, v199
s_waitcnt vmcnt(5)
v_mfma_f32_16x16x32_bf16 v[152:155], v[18:21], v[12:15], v[152:155]
ds_read_b128 v[244:247], v248 offset:36096
ds_read_u16_d16 v184, v184
ds_read_u16_d16 v186, v186
v_lshrrev_b32 v185, 18, v185
v_pk_mul_f16 v196, v197, v196
v_mfma_f32_16x16x32_bf16 v[156:159], v[16:19], v[12:15], v[156:159]
v_lshrrev_b32_e64 v187, 18, v187
v_mfma_f32_16x16x32_bf16 v[172:175], v[216:219], v[96:99], 0
ds_read_u16_d16_hi v185, v185
ds_read_u16_d16_hi v187, v187
v_exp_f16 v201, v202
v_and_b32 v189, s49, v189
v_mfma_f32_16x16x32_bf16 v[180:183], v[216:219], v[100:103], 0
v_and_b32 v191, s49, v191
s_waitcnt lgkmcnt(6)
v_mfma_f32_16x16x32_f16 v[68:71], v[220:223], v[232:235], v[68:71]
ds_read_b128 v[216:219], v248 offset:36864
v_exp_f16_e64 v198, v199
v_bfe_u32 v188, v189, 2, 14
v_mfma_f32_16x16x32_f16 v[76:79], v[220:223], v[236:239], v[76:79]
v_bfe_u32 v190, v191, 2, 14
v_exp_f16_e64 v195, v196
v_mfma_f32_16x16x32_bf16 v[168:171], v[224:227], v[104:107], v[168:171]
ds_read_b128 v[220:223], v248 offset:37120
ds_read_u16_d16 v188, v188
ds_read_u16_d16 v190, v190
v_lshrrev_b32 v189, 18, v189
v_lshrrev_b32 v191, 18, v191
v_mfma_f32_16x16x32_bf16 v[176:179], v[224:227], v[108:111], v[176:179]
v_exp_f16_sdwa v201, v202 dst_sel:WORD_1 dst_unused:UNUSED_PRESERVE src0_sel:WORD_1
v_mfma_f32_16x16x32_f16 v[80:83], v[228:231], v[232:235], v[80:83]
ds_read_b128 v[224:227], v249 offset:36864
ds_read_u16_d16_hi v189, v189
ds_read_u16_d16_hi v191, v191
v_and_b32 v193, s49, v193
v_bfe_u32 v192, v193, 2, 14
v_mfma_f32_16x16x32_f16 v[88:91], v[228:231], v[236:239], v[88:91]
v_exp_f16_sdwa v198, v199 dst_sel:WORD_1 dst_unused:UNUSED_PRESERVE src0_sel:WORD_1
s_waitcnt lgkmcnt(7)
v_mfma_f32_16x16x32_f16 v[84:87], v[240:243], v[232:235], v[84:87]
ds_read_b128 v[228:231], v249 offset:37120
ds_read_u16_d16 v192, v192
v_lshrrev_b32_e64 v193, 18, v193
v_mfma_f32_16x16x32_f16 v[92:95], v[240:243], v[236:239], v[92:95]
v_exp_f16_sdwa v195, v196 dst_sel:WORD_1 dst_unused:UNUSED_PRESERVE src0_sel:WORD_1
v_pk_add_f16 v201, v201, 1.0 op_sel_hi:[1,0]
v_pk_add_f16 v198, v198, 1.0 op_sel_hi:[1,0]
v_mfma_f32_16x16x32_bf16 v[172:175], v[244:247], v[104:107], v[172:175]
ds_read_b128 v[240:243], v248 offset:40960
ds_read_u16_d16_hi v193, v193
v_pk_add_f16 v195, v195, 1.0 op_sel_hi:[1,0]
v_mfma_f32_16x16x32_bf16 v[180:183], v[244:247], v[108:111], v[180:183]
v_rcp_f16 v202, v201
s_waitcnt lgkmcnt(7)
v_mfma_f32_16x16x32_bf16 v[168:171], v[216:219], v[112:115], v[168:171]
ds_read_b128 v[244:247], v249 offset:37888
v_rcp_f16_e64 v199, v198
v_mfma_f32_16x16x32_bf16 v[176:179], v[216:219], v[116:119], v[176:179]
v_rcp_f16_e64 v196, v195
v_mfma_f32_16x16x32_bf16 v[172:175], v[220:223], v[112:115], v[172:175]
ds_read_b128 v[216:219], v248 offset:41216
v_rcp_f16_sdwa v202, v201 dst_sel:WORD_1 dst_unused:UNUSED_PRESERVE src0_sel:WORD_1
v_mfma_f32_16x16x32_bf16 v[180:183], v[220:223], v[116:119], v[180:183]
v_rcp_f16_sdwa v199, v198 dst_sel:WORD_1 dst_unused:UNUSED_PRESERVE src0_sel:WORD_1
v_or_b32 v232, v184, v185
v_or_b32 v233, v186, v187
s_waitcnt lgkmcnt(4)
v_or_b32 v234, v188, v189
v_rcp_f16_sdwa v196, v195 dst_sel:WORD_1 dst_unused:UNUSED_PRESERVE src0_sel:WORD_1
v_or_b32 v235, v190, v191
s_waitcnt lgkmcnt(2)
v_or_b32_e64 v236, v192, v193
v_pk_mul_f16 v237, v203, v202
v_pk_mul_f16 v238, v200, v199
v_pk_mul_f16 v239, v197, v196
v_mfma_f32_16x16x32_f16 v[48:51], v[224:227], v[232:235], v[48:51]
buffer_load_dwordx4 v[12:15], v252, s[4:7], s69 offen
ds_read_b128 v[220:223], v249 offset:38144
v_cvt_pkrtz_f16_f32 v185, v168, v169
v_cvt_pkrtz_f16_f32 v187, v170, v171
v_cvt_pkrtz_f16_f32 v189, v172, v173
v_mfma_f32_16x16x32_f16 v[56:59], v[224:227], v[236:239], v[56:59]
v_cvt_pkrtz_f16_f32 v191, v174, v175
v_cvt_pkrtz_f16_f32 v193, v176, v177
v_cvt_pk_f16_f32 v203, v178, v179
v_mfma_f32_16x16x32_f16 v[52:55], v[228:231], v[232:235], v[52:55]
ds_read_b128 v[224:227], v248 offset:41984
v_cvt_pk_f16_f32 v200, v180, v181
v_cvt_pk_f16_f32 v197, v182, v183
v_pk_fma_f16 v202, v203, v203, s48
v_cvt_pk_bf16_f32 v136, v136, v137
v_mfma_f32_16x16x32_f16 v[60:63], v[228:231], v[236:239], v[60:63]
v_and_b32_e64 v185, s49, v185
v_cvt_pk_bf16_f32 v137, v138, v139
v_pk_fma_f16 v199, v200, v200, s48
v_mfma_f32_16x16x32_bf16 v[168:171], v[240:243], v[96:99], 0
ds_read_b128 v[228:231], v249 offset:38912
v_and_b32_e64 v187, s49, v187
v_cvt_pk_bf16_f32 v138, v140, v141
v_pk_fma_f16 v196, v197, v197, s48
v_mfma_f32_16x16x32_bf16 v[176:179], v[240:243], v[100:103], 0
v_cvt_pk_bf16_f32 v139, v142, v143
v_bfe_u32 v184, v185, 2, 14
s_setprio 2
v_pk_mul_f16 v202, v203, v202
v_cvt_pk_bf16_f32 v120, v120, v121
s_waitcnt lgkmcnt(2)
v_mfma_f32_16x16x32_f16 v[64:67], v[244:247], v[232:235], v[64:67]
ds_read_b128 v[240:243], v249 offset:39168
ds_read_u16_d16 v184, v184
v_bfe_u32 v186, v187, 2, 14
v_cvt_pk_bf16_f32 v121, v122, v123
v_pk_mul_f16 v199, v200, v199
v_mfma_f32_16x16x32_f16 v[72:75], v[244:247], v[236:239], v[72:75]
v_lshrrev_b32_e64 v185, 18, v185
v_cvt_pk_bf16_f32 v122, v124, v125
v_pk_mul_f16 v196, v197, v196
v_mfma_f32_16x16x32_bf16 v[172:175], v[216:219], v[96:99], 0
ds_read_b128 v[244:247], v248 offset:42240
ds_read_u16_d16 v186, v186
ds_read_u16_d16_hi v185, v185
v_lshrrev_b32_e64 v187, 18, v187
v_cvt_pk_bf16_f32 v123, v126, v127
v_exp_f16_e64 v201, v202
v_mfma_f32_16x16x32_bf16 v[180:183], v[216:219], v[100:103], 0
v_cvt_pk_bf16_f32 v152, v152, v153
v_and_b32_e64 v189, s49, v189
v_cvt_pk_bf16_f32 v153, v154, v155
v_mfma_f32_16x16x32_f16 v[68:71], v[220:223], v[232:235], v[68:71]
ds_read_b128 v[216:219], v248 offset:43008
ds_read_u16_d16_hi v187, v187
v_and_b32_e64 v191, s49, v191
v_cvt_pk_bf16_f32 v154, v156, v157
v_mfma_f32_16x16x32_f16 v[76:79], v[220:223], v[236:239], v[76:79]
v_exp_f16_e64 v198, v199
v_cvt_pk_bf16_f32 v155, v158, v159
s_mov_b64 vcc, s[74:75]
v_bfe_u32 v188, v189, 2, 14
v_bfe_u32 v190, v191, 2, 14
s_waitcnt lgkmcnt(5)
v_mfma_f32_16x16x32_bf16 v[168:171], v[224:227], v[104:107], v[168:171]
ds_read_b128 v[220:223], v248 offset:43264
ds_read_u16_d16 v188, v188
ds_read_u16_d16 v190, v190
v_cndmask_b32 v140, v120, v152, vcc
v_exp_f16 v195, v196
v_mfma_f32_16x16x32_bf16 v[176:179], v[224:227], v[108:111], v[176:179]
v_cndmask_b32 v141, v121, v153, vcc
v_lshrrev_b32_e64 v189, 18, v189
v_cndmask_b32 v142, v122, v154, vcc
v_mfma_f32_16x16x32_f16 v[80:83], v[228:231], v[232:235], v[80:83]
ds_read_b128 v[224:227], v249 offset:43008
ds_read_u16_d16_hi v189, v189
v_lshrrev_b32 v191, 18, v191
v_cndmask_b32 v143, v123, v155, vcc
v_exp_f16_sdwa v201, v202 dst_sel:WORD_1 dst_unused:UNUSED_PRESERVE src0_sel:WORD_1
v_mfma_f32_16x16x32_f16 v[88:91], v[228:231], v[236:239], v[88:91]
v_cndmask_b32_dpp v120, v136, v120, vcc quad_perm:[1,0,3,2] row_mask:0xf bank_mask:0xf
v_and_b32_e64 v193, s49, v193
v_cndmask_b32_dpp v121, v137, v121, vcc quad_perm:[1,0,3,2] row_mask:0xf bank_mask:0xf
v_mfma_f32_16x16x32_f16 v[84:87], v[240:243], v[232:235], v[84:87]
ds_read_b128 v[228:231], v249 offset:43264
ds_read_u16_d16_hi v191, v191
v_bfe_u32 v192, v193, 2, 14
v_exp_f16_sdwa v198, v199 dst_sel:WORD_1 dst_unused:UNUSED_PRESERVE src0_sel:WORD_1
v_mfma_f32_16x16x32_f16 v[92:95], v[240:243], v[236:239], v[92:95]
v_cndmask_b32_dpp v122, v138, v122, vcc quad_perm:[1,0,3,2] row_mask:0xf bank_mask:0xf
v_lshrrev_b32_e64 v193, 18, v193
v_cndmask_b32_dpp v123, v139, v123, vcc quad_perm:[1,0,3,2] row_mask:0xf bank_mask:0xf
s_not_b64 vcc, s[74:75]
s_waitcnt lgkmcnt(4)
v_mfma_f32_16x16x32_bf16 v[172:175], v[244:247], v[104:107], v[172:175]
ds_read_b128 v[240:243], v248 offset:47104
ds_read_u16_d16 v192, v192
ds_read_u16_d16_hi v193, v193
v_exp_f16_sdwa v195, v196 dst_sel:WORD_1 dst_unused:UNUSED_PRESERVE src0_sel:WORD_1
v_cndmask_b32_dpp v152, v136, v152, vcc quad_perm:[1,0,3,2] row_mask:0xf bank_mask:0xf
v_pk_add_f16 v201, v201, 1.0 op_sel_hi:[1,0]
v_mfma_f32_16x16x32_bf16 v[180:183], v[244:247], v[108:111], v[180:183]
v_cndmask_b32_dpp v153, v137, v153, vcc quad_perm:[1,0,3,2] row_mask:0xf bank_mask:0xf
v_pk_add_f16 v198, v198, 1.0 op_sel_hi:[1,0]
v_cndmask_b32_dpp v154, v138, v154, vcc quad_perm:[1,0,3,2] row_mask:0xf bank_mask:0xf
v_mfma_f32_16x16x32_bf16 v[168:171], v[216:219], v[112:115], v[168:171]
ds_read_b128 v[244:247], v249 offset:44032
v_pk_add_f16 v195, v195, 1.0 op_sel_hi:[1,0]
v_rcp_f16_e64 v202, v201
v_cndmask_b32_dpp v155, v139, v155, vcc quad_perm:[1,0,3,2] row_mask:0xf bank_mask:0xf
v_mfma_f32_16x16x32_bf16 v[176:179], v[216:219], v[116:119], v[176:179]
v_rcp_f16_e64 v199, v198
v_mfma_f32_16x16x32_bf16 v[172:175], v[220:223], v[112:115], v[172:175]
ds_read_b128 v[216:219], v248 offset:47360
buffer_store_dwordx4 v[120:123], v255, s[8:11], s68 offen sc1
v_rcp_f16_e64 v196, v195
v_rcp_f16_sdwa v202, v201 dst_sel:WORD_1 dst_unused:UNUSED_PRESERVE src0_sel:WORD_1
v_mfma_f32_16x16x32_bf16 v[180:183], v[220:223], v[116:119], v[180:183]
v_rcp_f16_sdwa v199, v198 dst_sel:WORD_1 dst_unused:UNUSED_PRESERVE src0_sel:WORD_1
v_or_b32 v232, v184, v185
v_or_b32 v233, v186, v187
s_waitcnt lgkmcnt(3)
v_or_b32 v234, v188, v189
v_rcp_f16_sdwa v196, v195 dst_sel:WORD_1 dst_unused:UNUSED_PRESERVE src0_sel:WORD_1
v_or_b32 v235, v190, v191
s_waitcnt lgkmcnt(2)
v_or_b32_e64 v236, v192, v193
v_pk_mul_f16 v237, v203, v202
v_pk_mul_f16 v238, v200, v199
v_pk_mul_f16 v239, v197, v196
v_mfma_f32_16x16x32_f16 v[48:51], v[224:227], v[232:235], v[48:51]
buffer_load_dwordx4 v[204:207], v252, s[4:7], s69 offen offset:64
ds_read_b128 v[220:223], v249 offset:44288
v_cvt_pkrtz_f16_f32 v185, v168, v169
v_cvt_pkrtz_f16_f32 v187, v170, v171
v_mfma_f32_16x16x32_f16 v[56:59], v[224:227], v[236:239], v[56:59]
v_cvt_pkrtz_f16_f32 v189, v172, v173
v_cvt_pkrtz_f16_f32 v191, v174, v175
v_mfma_f32_16x16x32_f16 v[52:55], v[228:231], v[232:235], v[52:55]
ds_read_b128 v[224:227], v248 offset:48128
v_cvt_pkrtz_f16_f32 v193, v176, v177
v_cvt_pk_f16_f32 v203, v178, v179
v_mfma_f32_16x16x32_f16 v[60:63], v[228:231], v[236:239], v[60:63]
v_cvt_pk_f16_f32 v200, v180, v181
v_cvt_pk_f16_f32 v197, v182, v183
s_setprio 1
v_mfma_f32_16x16x32_bf16 v[168:171], v[240:243], v[96:99], 0
ds_read_b128 v[228:231], v249 offset:45056
v_pk_fma_f16 v202, v203, v203, s48
v_and_b32 v185, s49, v185
v_mfma_f32_16x16x32_bf16 v[176:179], v[240:243], v[100:103], 0
v_pk_fma_f16 v199, v200, v200, s48
v_and_b32 v187, s49, v187
s_waitcnt lgkmcnt(3)
v_mfma_f32_16x16x32_f16 v[64:67], v[244:247], v[232:235], v[64:67]
ds_read_b128 v[240:243], v249 offset:45312
v_pk_fma_f16 v196, v197, v197, s48
v_bfe_u32 v184, v185, 2, 14
v_pk_mul_f16 v202, v203, v202
v_mfma_f32_16x16x32_f16 v[72:75], v[244:247], v[236:239], v[72:75]
v_bfe_u32 v186, v187, 2, 14
v_pk_mul_f16 v199, v200, v199
s_waitcnt vmcnt(7)
v_mfma_f32_16x16x32_bf16 v[128:131], v[18:21], v[8:11], v[128:131]
ds_read_b128 v[244:247], v248 offset:48384
ds_read_u16_d16 v184, v184
ds_read_u16_d16 v186, v186
v_lshrrev_b32 v185, 18, v185
v_pk_mul_f16 v196, v197, v196
v_mfma_f32_16x16x32_bf16 v[132:135], v[16:19], v[8:11], v[132:135]
v_lshrrev_b32_e64 v187, 18, v187
v_mfma_f32_16x16x32_bf16 v[172:175], v[216:219], v[96:99], 0
ds_read_u16_d16_hi v185, v185
ds_read_u16_d16_hi v187, v187
v_exp_f16 v201, v202
v_and_b32 v189, s49, v189
v_mfma_f32_16x16x32_bf16 v[180:183], v[216:219], v[100:103], 0
v_and_b32 v191, s49, v191
s_waitcnt lgkmcnt(6)
v_mfma_f32_16x16x32_f16 v[68:71], v[220:223], v[232:235], v[68:71]
ds_read_b128 v[216:219], v248 offset:49152
v_exp_f16_e64 v198, v199
v_bfe_u32 v188, v189, 2, 14
v_mfma_f32_16x16x32_f16 v[76:79], v[220:223], v[236:239], v[76:79]
v_bfe_u32 v190, v191, 2, 14
v_exp_f16_e64 v195, v196
v_mfma_f32_16x16x32_bf16 v[168:171], v[224:227], v[104:107], v[168:171]
buffer_store_dwordx4 v[140:143], v255, s[8:11], s68 offen offset:128 sc1
ds_read_b128 v[220:223], v248 offset:49408
ds_read_u16_d16 v188, v188
ds_read_u16_d16 v190, v190
v_lshrrev_b32 v189, 18, v189
v_lshrrev_b32 v191, 18, v191
v_mfma_f32_16x16x32_bf16 v[176:179], v[224:227], v[108:111], v[176:179]
v_exp_f16_sdwa v201, v202 dst_sel:WORD_1 dst_unused:UNUSED_PRESERVE src0_sel:WORD_1
v_mfma_f32_16x16x32_f16 v[80:83], v[228:231], v[232:235], v[80:83]
ds_read_b128 v[224:227], v249 offset:49152
ds_read_u16_d16_hi v189, v189
ds_read_u16_d16_hi v191, v191
v_and_b32 v193, s49, v193
v_bfe_u32 v192, v193, 2, 14
v_mfma_f32_16x16x32_f16 v[88:91], v[228:231], v[236:239], v[88:91]
v_exp_f16_sdwa v198, v199 dst_sel:WORD_1 dst_unused:UNUSED_PRESERVE src0_sel:WORD_1
s_waitcnt lgkmcnt(7)
v_mfma_f32_16x16x32_f16 v[84:87], v[240:243], v[232:235], v[84:87]
ds_read_b128 v[228:231], v249 offset:49408
ds_read_u16_d16 v192, v192
v_lshrrev_b32_e64 v193, 18, v193
v_mfma_f32_16x16x32_f16 v[92:95], v[240:243], v[236:239], v[92:95]
v_exp_f16_sdwa v195, v196 dst_sel:WORD_1 dst_unused:UNUSED_PRESERVE src0_sel:WORD_1
v_pk_add_f16 v201, v201, 1.0 op_sel_hi:[1,0]
v_pk_add_f16 v198, v198, 1.0 op_sel_hi:[1,0]
v_mfma_f32_16x16x32_bf16 v[172:175], v[244:247], v[104:107], v[172:175]
ds_read_b128 v[240:243], v248 offset:53248
ds_read_u16_d16_hi v193, v193
v_pk_add_f16 v195, v195, 1.0 op_sel_hi:[1,0]
v_mfma_f32_16x16x32_bf16 v[180:183], v[244:247], v[108:111], v[180:183]
v_rcp_f16_e64 v202, v201
s_setprio 0
s_waitcnt lgkmcnt(7)
v_mfma_f32_16x16x32_bf16 v[168:171], v[216:219], v[112:115], v[168:171]
ds_read_b128 v[244:247], v249 offset:50176
v_rcp_f16_e64 v199, v198
v_mfma_f32_16x16x32_bf16 v[176:179], v[216:219], v[116:119], v[176:179]
v_rcp_f16_e64 v196, v195
v_mfma_f32_16x16x32_bf16 v[172:175], v[220:223], v[112:115], v[172:175]
ds_read_b128 v[216:219], v248 offset:53504
v_rcp_f16_sdwa v202, v201 dst_sel:WORD_1 dst_unused:UNUSED_PRESERVE src0_sel:WORD_1
v_mfma_f32_16x16x32_bf16 v[180:183], v[220:223], v[116:119], v[180:183]
v_rcp_f16_sdwa v199, v198 dst_sel:WORD_1 dst_unused:UNUSED_PRESERVE src0_sel:WORD_1
v_or_b32 v232, v184, v185
v_or_b32 v233, v186, v187
s_waitcnt lgkmcnt(4)
v_or_b32 v234, v188, v189
v_rcp_f16_sdwa v196, v195 dst_sel:WORD_1 dst_unused:UNUSED_PRESERVE src0_sel:WORD_1
v_or_b32 v235, v190, v191
s_waitcnt lgkmcnt(2)
v_or_b32 v236, v192, v193
v_pk_mul_f16 v237, v203, v202
v_pk_mul_f16 v238, v200, v199
v_pk_mul_f16 v239, v197, v196
s_setprio 3
v_mfma_f32_16x16x32_f16 v[48:51], v[224:227], v[232:235], v[48:51]
buffer_load_dwordx4 v[8:11], v252, s[4:7], s69 offen offset:128
ds_read_b128 v[220:223], v249 offset:50432
v_cvt_pkrtz_f16_f32 v185, v168, v169
v_cvt_pkrtz_f16_f32 v187, v170, v171
v_mfma_f32_16x16x32_f16 v[56:59], v[224:227], v[236:239], v[56:59]
v_cvt_pkrtz_f16_f32 v189, v172, v173
v_cvt_pkrtz_f16_f32 v191, v174, v175
v_mfma_f32_16x16x32_f16 v[52:55], v[228:231], v[232:235], v[52:55]
ds_read_b128 v[224:227], v248 offset:54272
v_cvt_pkrtz_f16_f32 v193, v176, v177
v_cvt_pk_f16_f32 v203, v178, v179
v_mfma_f32_16x16x32_f16 v[60:63], v[228:231], v[236:239], v[60:63]
v_cvt_pk_f16_f32 v200, v180, v181
v_cvt_pk_f16_f32 v197, v182, v183
v_mfma_f32_16x16x32_bf16 v[168:171], v[240:243], v[96:99], 0
ds_read_b128 v[228:231], v249 offset:51200
v_pk_fma_f16 v202, v203, v203, s48
v_and_b32_e64 v185, s49, v185
v_mfma_f32_16x16x32_bf16 v[176:179], v[240:243], v[100:103], 0
v_pk_fma_f16 v199, v200, v200, s48
v_and_b32 v187, s49, v187
s_waitcnt lgkmcnt(3)
v_mfma_f32_16x16x32_f16 v[64:67], v[244:247], v[232:235], v[64:67]
ds_read_b128 v[240:243], v249 offset:51456
v_pk_fma_f16 v196, v197, v197, s48
v_bfe_u32 v184, v185, 2, 14
v_pk_mul_f16 v202, v203, v202
v_mfma_f32_16x16x32_f16 v[72:75], v[244:247], v[236:239], v[72:75]
v_bfe_u32 v186, v187, 2, 14
v_pk_mul_f16 v199, v200, v199
s_waitcnt vmcnt(7)
v_mfma_f32_16x16x32_bf16 v[144:147], v[18:21], v[44:47], v[144:147]
ds_read_b128 v[244:247], v248 offset:54528
ds_read_u16_d16 v184, v184
ds_read_u16_d16 v186, v186
v_lshrrev_b32 v185, 18, v185
v_pk_mul_f16 v196, v197, v196
v_mfma_f32_16x16x32_bf16 v[148:151], v[16:19], v[44:47], v[148:151]
v_lshrrev_b32_e64 v187, 18, v187
v_mfma_f32_16x16x32_bf16 v[172:175], v[216:219], v[96:99], 0
ds_read_u16_d16_hi v185, v185
ds_read_u16_d16_hi v187, v187
v_exp_f16 v201, v202
v_and_b32 v189, s49, v189
v_mfma_f32_16x16x32_bf16 v[180:183], v[216:219], v[100:103], 0
v_and_b32 v191, s49, v191
s_waitcnt lgkmcnt(6)
v_mfma_f32_16x16x32_f16 v[68:71], v[220:223], v[232:235], v[68:71]
ds_read_b128 v[216:219], v248 offset:55296
v_exp_f16_e64 v198, v199
v_bfe_u32 v188, v189, 2, 14
v_mfma_f32_16x16x32_f16 v[76:79], v[220:223], v[236:239], v[76:79]
v_bfe_u32 v190, v191, 2, 14
v_exp_f16_e64 v195, v196
v_mfma_f32_16x16x32_bf16 v[168:171], v[224:227], v[104:107], v[168:171]
ds_read_b128 v[220:223], v248 offset:55552
ds_read_u16_d16 v188, v188
ds_read_u16_d16 v190, v190
v_lshrrev_b32 v189, 18, v189
v_lshrrev_b32 v191, 18, v191
v_mfma_f32_16x16x32_bf16 v[176:179], v[224:227], v[108:111], v[176:179]
v_exp_f16_sdwa v201, v202 dst_sel:WORD_1 dst_unused:UNUSED_PRESERVE src0_sel:WORD_1
v_mfma_f32_16x16x32_f16 v[80:83], v[228:231], v[232:235], v[80:83]
ds_read_b128 v[224:227], v249 offset:55296
ds_read_u16_d16_hi v189, v189
ds_read_u16_d16_hi v191, v191
v_and_b32 v193, s49, v193
v_bfe_u32 v192, v193, 2, 14
v_mfma_f32_16x16x32_f16 v[88:91], v[228:231], v[236:239], v[88:91]
v_exp_f16_sdwa v198, v199 dst_sel:WORD_1 dst_unused:UNUSED_PRESERVE src0_sel:WORD_1
s_waitcnt lgkmcnt(7)
v_mfma_f32_16x16x32_f16 v[84:87], v[240:243], v[232:235], v[84:87]
ds_read_b128 v[228:231], v249 offset:55552
ds_read_u16_d16 v192, v192
v_lshrrev_b32_e64 v193, 18, v193
v_mfma_f32_16x16x32_f16 v[92:95], v[240:243], v[236:239], v[92:95]
v_exp_f16_sdwa v195, v196 dst_sel:WORD_1 dst_unused:UNUSED_PRESERVE src0_sel:WORD_1
v_pk_add_f16 v201, v201, 1.0 op_sel_hi:[1,0]
v_pk_add_f16 v198, v198, 1.0 op_sel_hi:[1,0]
v_mfma_f32_16x16x32_bf16 v[172:175], v[244:247], v[104:107], v[172:175]
ds_read_b128 v[240:243], v248 offset:59392
ds_read_u16_d16_hi v193, v193
v_pk_add_f16 v195, v195, 1.0 op_sel_hi:[1,0]
v_mfma_f32_16x16x32_bf16 v[180:183], v[244:247], v[108:111], v[180:183]
v_rcp_f16 v202, v201
s_waitcnt lgkmcnt(7)
v_mfma_f32_16x16x32_bf16 v[168:171], v[216:219], v[112:115], v[168:171]
ds_read_b128 v[244:247], v249 offset:56320
v_rcp_f16_e64 v199, v198
v_mfma_f32_16x16x32_bf16 v[176:179], v[216:219], v[116:119], v[176:179]
v_rcp_f16_e64 v196, v195
v_mfma_f32_16x16x32_bf16 v[172:175], v[220:223], v[112:115], v[172:175]
ds_read_b128 v[216:219], v248 offset:59648
v_rcp_f16_sdwa v202, v201 dst_sel:WORD_1 dst_unused:UNUSED_PRESERVE src0_sel:WORD_1
v_mfma_f32_16x16x32_bf16 v[180:183], v[220:223], v[116:119], v[180:183]
v_rcp_f16_sdwa v199, v198 dst_sel:WORD_1 dst_unused:UNUSED_PRESERVE src0_sel:WORD_1
v_or_b32 v232, v184, v185
v_or_b32 v233, v186, v187
s_waitcnt lgkmcnt(4)
v_or_b32 v234, v188, v189
v_rcp_f16_sdwa v196, v195 dst_sel:WORD_1 dst_unused:UNUSED_PRESERVE src0_sel:WORD_1
v_or_b32 v235, v190, v191
s_waitcnt lgkmcnt(2)
v_or_b32_e64 v236, v192, v193
v_pk_mul_f16 v237, v203, v202
v_pk_mul_f16 v238, v200, v199
v_pk_mul_f16 v239, v197, v196
v_mfma_f32_16x16x32_f16 v[48:51], v[224:227], v[232:235], v[48:51]
s_add_u32 s46, s69, 98304
buffer_load_dwordx4 v[44:47], v252, s[4:7], s46 offen
ds_read_b128 v[220:223], v249 offset:56576
v_cvt_pkrtz_f16_f32 v185, v168, v169
v_cvt_pkrtz_f16_f32 v187, v170, v171
v_mfma_f32_16x16x32_f16 v[56:59], v[224:227], v[236:239], v[56:59]
v_cvt_pkrtz_f16_f32 v189, v172, v173
v_cvt_pkrtz_f16_f32 v191, v174, v175
v_mfma_f32_16x16x32_f16 v[52:55], v[228:231], v[232:235], v[52:55]
ds_read_b128 v[224:227], v248 offset:60416
v_cvt_pkrtz_f16_f32 v193, v176, v177
v_cvt_pk_f16_f32 v203, v178, v179
v_cvt_pk_f16_f32 v200, v180, v181
v_mfma_f32_16x16x32_f16 v[60:63], v[228:231], v[236:239], v[60:63]
v_cvt_pk_f16_f32 v197, v182, v183
v_pk_fma_f16 v202, v203, v203, s48
v_mfma_f32_16x16x32_bf16 v[168:171], v[240:243], v[96:99], 0
ds_read_b128 v[228:231], v249 offset:57344
v_and_b32_e64 v185, s49, v185
v_pk_fma_f16 v199, v200, v200, s48
v_mfma_f32_16x16x32_bf16 v[176:179], v[240:243], v[100:103], 0
v_and_b32_e64 v187, s49, v187
v_pk_fma_f16 v196, v197, v197, s48
s_setprio 2
v_bfe_u32 v184, v185, 2, 14
s_waitcnt lgkmcnt(3)
v_mfma_f32_16x16x32_f16 v[64:67], v[244:247], v[232:235], v[64:67]
ds_read_b128 v[240:243], v249 offset:57600
ds_read_u16_d16 v184, v184
v_pk_mul_f16 v202, v203, v202
v_bfe_u32 v186, v187, 2, 14
v_mfma_f32_16x16x32_f16 v[72:75], v[244:247], v[236:239], v[72:75]
v_pk_mul_f16 v199, v200, v199
v_lshrrev_b32_e64 v185, 18, v185
v_mfma_f32_16x16x32_bf16 v[172:175], v[216:219], v[96:99], 0
ds_read_b128 v[244:247], v248 offset:60672
ds_read_u16_d16 v186, v186
ds_read_u16_d16_hi v185, v185
v_pk_mul_f16 v196, v197, v196
v_lshrrev_b32_e64 v187, 18, v187
v_mfma_f32_16x16x32_bf16 v[180:183], v[216:219], v[100:103], 0
v_exp_f16_e64 v201, v202
v_and_b32 v189, s49, v189
s_waitcnt lgkmcnt(5)
v_mfma_f32_16x16x32_f16 v[68:71], v[220:223], v[232:235], v[68:71]
ds_read_b128 v[216:219], v248 offset:61440
ds_read_u16_d16_hi v187, v187
v_and_b32_e64 v191, s49, v191
v_mfma_f32_16x16x32_f16 v[76:79], v[220:223], v[236:239], v[76:79]
v_exp_f16_e64 v198, v199
v_bfe_u32 v188, v189, 2, 14
v_bfe_u32 v190, v191, 2, 14
v_mfma_f32_16x16x32_bf16 v[168:171], v[224:227], v[104:107], v[168:171]
buffer_store_dwordx4 v[152:155], v255, s[8:11], s68 offen offset:256 sc1
ds_read_b128 v[220:223], v248 offset:61696
ds_read_u16_d16 v188, v188
ds_read_u16_d16 v190, v190
v_exp_f16_e64 v195, v196
v_mfma_f32_16x16x32_bf16 v[176:179], v[224:227], v[108:111], v[176:179]
v_lshrrev_b32 v189, 18, v189
v_lshrrev_b32 v191, 18, v191
v_mfma_f32_16x16x32_f16 v[80:83], v[228:231], v[232:235], v[80:83]
ds_read_b128 v[224:227], v249 offset:61440
ds_read_u16_d16_hi v189, v189
ds_read_u16_d16_hi v191, v191
v_exp_f16_sdwa v201, v202 dst_sel:WORD_1 dst_unused:UNUSED_PRESERVE src0_sel:WORD_1
v_and_b32 v193, s49, v193
v_mfma_f32_16x16x32_f16 v[88:91], v[228:231], v[236:239], v[88:91]
v_bfe_u32 v192, v193, 2, 14
s_waitcnt lgkmcnt(8)
v_mfma_f32_16x16x32_f16 v[84:87], v[240:243], v[232:235], v[84:87]
ds_read_b128 v[228:231], v249 offset:61696
ds_read_u16_d16 v192, v192
v_exp_f16_sdwa v198, v199 dst_sel:WORD_1 dst_unused:UNUSED_PRESERVE src0_sel:WORD_1
v_lshrrev_b32_e64 v193, 18, v193
v_mfma_f32_16x16x32_f16 v[92:95], v[240:243], v[236:239], v[92:95]
v_exp_f16_sdwa v195, v196 dst_sel:WORD_1 dst_unused:UNUSED_PRESERVE src0_sel:WORD_1
v_pk_add_f16 v201, v201, 1.0 op_sel_hi:[1,0]
v_mfma_f32_16x16x32_bf16 v[172:175], v[244:247], v[104:107], v[172:175]
ds_read_b128 v[240:243], v249
ds_read_u16_d16_hi v193, v193
v_pk_add_f16 v198, v198, 1.0 op_sel_hi:[1,0]
v_pk_add_f16 v195, v195, 1.0 op_sel_hi:[1,0]
v_mfma_f32_16x16x32_bf16 v[180:183], v[244:247], v[108:111], v[180:183]
v_rcp_f16 v202, v201
s_waitcnt lgkmcnt(7)
v_mfma_f32_16x16x32_bf16 v[168:171], v[216:219], v[112:115], v[168:171]
ds_read_b128 v[244:247], v249 offset:62464
v_rcp_f16_e64 v199, v198
v_mfma_f32_16x16x32_bf16 v[176:179], v[216:219], v[116:119], v[176:179]
v_rcp_f16_e64 v196, v195
v_mfma_f32_16x16x32_bf16 v[172:175], v[220:223], v[112:115], v[172:175]
ds_read_b128 v[216:219], v249 offset:256
v_rcp_f16_sdwa v202, v201 dst_sel:WORD_1 dst_unused:UNUSED_PRESERVE src0_sel:WORD_1
v_mfma_f32_16x16x32_bf16 v[180:183], v[220:223], v[116:119], v[180:183]
v_rcp_f16_sdwa v199, v198 dst_sel:WORD_1 dst_unused:UNUSED_PRESERVE src0_sel:WORD_1
v_or_b32 v232, v184, v185
v_or_b32 v233, v186, v187
s_waitcnt lgkmcnt(4)
v_or_b32 v234, v188, v189
v_rcp_f16_sdwa v196, v195 dst_sel:WORD_1 dst_unused:UNUSED_PRESERVE src0_sel:WORD_1
v_or_b32 v235, v190, v191
s_waitcnt lgkmcnt(2)
v_or_b32_e64 v236, v192, v193
v_pk_mul_f16 v237, v203, v202
v_pk_mul_f16 v238, v200, v199
v_pk_mul_f16 v239, v197, v196
v_mfma_f32_16x16x32_f16 v[48:51], v[224:227], v[232:235], v[48:51]
s_add_u32 s46, s69, 98304
buffer_load_dwordx4 v[40:43], v252, s[4:7], s46 offen offset:64
ds_read_b128 v[220:223], v249 offset:62720
v_cvt_pkrtz_f16_f32 v185, v168, v169
v_cvt_pkrtz_f16_f32 v187, v170, v171
v_mfma_f32_16x16x32_f16 v[56:59], v[224:227], v[236:239], v[56:59]
v_cvt_pkrtz_f16_f32 v189, v172, v173
v_cvt_pkrtz_f16_f32 v191, v174, v175
v_mfma_f32_16x16x32_f16 v[52:55], v[228:231], v[232:235], v[52:55]
ds_read_b128 v[224:227], v249 offset:1024
v_cvt_pkrtz_f16_f32 v193, v176, v177
v_cvt_pk_f16_f32 v203, v178, v179
v_mfma_f32_16x16x32_f16 v[60:63], v[228:231], v[236:239], v[60:63]
v_cvt_pk_f16_f32 v200, v180, v181
v_cvt_pk_f16_f32 v197, v182, v183
s_setprio 1
v_mfma_f32_16x16x32_bf16 v[168:171], v[240:243], v[96:99], 0
ds_read_b128 v[228:231], v249 offset:63488
v_pk_fma_f16 v202, v203, v203, s48
v_and_b32 v185, s49, v185
v_mfma_f32_16x16x32_bf16 v[176:179], v[240:243], v[100:103], 0
v_pk_fma_f16 v199, v200, v200, s48
v_and_b32 v187, s49, v187
s_waitcnt lgkmcnt(3)
v_mfma_f32_16x16x32_f16 v[64:67], v[244:247], v[232:235], v[64:67]
ds_read_b128 v[240:243], v249 offset:63744
v_pk_fma_f16 v196, v197, v197, s48
v_bfe_u32 v184, v185, 2, 14
v_mfma_f32_16x16x32_f16 v[72:75], v[244:247], v[236:239], v[72:75]
v_pk_mul_f16 v202, v203, v202
v_bfe_u32 v186, v187, 2, 14
s_waitcnt vmcnt(8)
v_mfma_f32_16x16x32_bf16 v[160:163], v[18:21], v[208:211], v[160:163]
ds_read_b128 v[244:247], v249 offset:1280
ds_read_u16_d16 v184, v184
ds_read_u16_d16 v186, v186
v_pk_mul_f16 v199, v200, v199
v_lshrrev_b32 v185, 18, v185
v_mfma_f32_16x16x32_bf16 v[164:167], v[16:19], v[208:211], v[164:167]
v_pk_mul_f16 v196, v197, v196
v_lshrrev_b32_e64 v187, 18, v187
v_mfma_f32_16x16x32_bf16 v[172:175], v[216:219], v[96:99], 0
ds_read_u16_d16_hi v185, v185
ds_read_u16_d16_hi v187, v187
v_exp_f16_e64 v201, v202
v_mfma_f32_16x16x32_bf16 v[180:183], v[216:219], v[100:103], 0
v_and_b32_e64 v189, s49, v189
v_and_b32 v191, s49, v191
s_waitcnt lgkmcnt(6)
v_mfma_f32_16x16x32_f16 v[68:71], v[220:223], v[232:235], v[68:71]
ds_read_b128 v[216:219], v249 offset:2048
v_exp_f16_e64 v198, v199
v_mfma_f32_16x16x32_f16 v[76:79], v[220:223], v[236:239], v[76:79]
v_bfe_u32 v188, v189, 2, 14
v_bfe_u32 v190, v191, 2, 14
v_mfma_f32_16x16x32_bf16 v[168:171], v[224:227], v[104:107], v[168:171]
ds_read_b128 v[220:223], v249 offset:2304
ds_read_u16_d16 v188, v188
ds_read_u16_d16 v190, v190
v_exp_f16_e64 v195, v196
v_mfma_f32_16x16x32_bf16 v[176:179], v[224:227], v[108:111], v[176:179]
v_lshrrev_b32 v189, 18, v189
v_lshrrev_b32 v191, 18, v191
v_mfma_f32_16x16x32_f16 v[80:83], v[228:231], v[232:235], v[80:83]
ds_read_b128 v[224:227], v250 offset:2048
ds_read_u16_d16_hi v189, v189
ds_read_u16_d16_hi v191, v191
v_exp_f16_sdwa v201, v202 dst_sel:WORD_1 dst_unused:UNUSED_PRESERVE src0_sel:WORD_1
v_mfma_f32_16x16x32_f16 v[88:91], v[228:231], v[236:239], v[88:91]
v_and_b32 v193, s49, v193
v_bfe_u32 v192, v193, 2, 14
s_waitcnt lgkmcnt(7)
v_mfma_f32_16x16x32_f16 v[84:87], v[240:243], v[232:235], v[84:87]
ds_read_b128 v[228:231], v250 offset:2304
ds_read_u16_d16 v192, v192
v_exp_f16_sdwa v198, v199 dst_sel:WORD_1 dst_unused:UNUSED_PRESERVE src0_sel:WORD_1
v_mfma_f32_16x16x32_f16 v[92:95], v[240:243], v[236:239], v[92:95]
v_lshrrev_b32 v193, 18, v193
s_waitcnt vmcnt(7)
v_mfma_f32_16x16x32_bf16 v[48:51], v[18:21], v[12:15], v[48:51]
ds_read_b128 v[240:243], v249 offset:6144
ds_read_u16_d16_hi v193, v193
v_exp_f16_sdwa v195, v196 dst_sel:WORD_1 dst_unused:UNUSED_PRESERVE src0_sel:WORD_1
v_pk_add_f16 v201, v201, 1.0 op_sel_hi:[1,0]
v_mfma_f32_16x16x32_bf16 v[52:55], v[16:19], v[12:15], v[52:55]
v_pk_add_f16 v198, v198, 1.0 op_sel_hi:[1,0]
v_pk_add_f16 v195, v195, 1.0 op_sel_hi:[1,0]
v_mfma_f32_16x16x32_bf16 v[172:175], v[244:247], v[104:107], v[172:175]
v_rcp_f16 v202, v201
s_setprio 0
v_mfma_f32_16x16x32_bf16 v[180:183], v[244:247], v[108:111], v[180:183]
v_rcp_f16 v199, v198
s_waitcnt lgkmcnt(4)
v_mfma_f32_16x16x32_bf16 v[168:171], v[216:219], v[112:115], v[168:171]
ds_read_b128 v[244:247], v250 offset:3072
v_rcp_f16_e64 v196, v195
v_mfma_f32_16x16x32_bf16 v[176:179], v[216:219], v[116:119], v[176:179]
v_rcp_f16_sdwa v202, v201 dst_sel:WORD_1 dst_unused:UNUSED_PRESERVE src0_sel:WORD_1
v_mfma_f32_16x16x32_bf16 v[172:175], v[220:223], v[112:115], v[172:175]
ds_read_b128 v[216:219], v249 offset:6400
v_rcp_f16_sdwa v199, v198 dst_sel:WORD_1 dst_unused:UNUSED_PRESERVE src0_sel:WORD_1
v_mfma_f32_16x16x32_bf16 v[180:183], v[220:223], v[116:119], v[180:183]
v_or_b32 v232, v184, v185
v_or_b32 v233, v186, v187
v_or_b32_e64 v234, v188, v189
v_rcp_f16_sdwa v196, v195 dst_sel:WORD_1 dst_unused:UNUSED_PRESERVE src0_sel:WORD_1
v_or_b32 v235, v190, v191
s_waitcnt lgkmcnt(2)
v_or_b32_e64 v236, v192, v193
v_pk_mul_f16 v237, v203, v202
v_pk_mul_f16 v238, v200, v199
v_pk_mul_f16 v239, v197, v196
v_mfma_f32_16x16x32_f16 v[48:51], v[224:227], v[232:235], v[48:51]
s_add_u32 s46, s69, 98304
buffer_load_dwordx4 v[208:211], v252, s[4:7], s46 offen offset:128
ds_read_b128 v[220:223], v250 offset:3328
v_cvt_pkrtz_f16_f32 v185, v168, v169
v_cvt_pkrtz_f16_f32 v187, v170, v171
v_cvt_pkrtz_f16_f32 v189, v172, v173
v_mfma_f32_16x16x32_f16 v[56:59], v[224:227], v[236:239], v[56:59]
v_cvt_pkrtz_f16_f32 v191, v174, v175
v_cvt_pkrtz_f16_f32 v193, v176, v177
v_cvt_pk_f16_f32 v203, v178, v179
v_mfma_f32_16x16x32_f16 v[52:55], v[228:231], v[232:235], v[52:55]
ds_read_b128 v[224:227], v249 offset:7168
v_cvt_pk_f16_f32 v200, v180, v181
v_cvt_pk_f16_f32 v197, v182, v183
v_pk_fma_f16 v202, v203, v203, s48
v_mfma_f32_16x16x32_f16 v[60:63], v[228:231], v[236:239], v[60:63]
v_cvt_pk_bf16_f32 v144, v144, v145
v_and_b32_e64 v185, s49, v185
v_cvt_pk_bf16_f32 v145, v146, v147
v_mfma_f32_16x16x32_bf16 v[168:171], v[240:243], v[96:99], 0
ds_read_b128 v[228:231], v250 offset:4096
v_pk_fma_f16 v199, v200, v200, s48
v_and_b32 v187, s49, v187
v_cvt_pk_bf16_f32 v146, v148, v149
v_mfma_f32_16x16x32_bf16 v[176:179], v[240:243], v[100:103], 0
v_pk_fma_f16 v196, v197, v197, s48
v_cvt_pk_bf16_f32 v147, v150, v151
v_bfe_u32 v184, v185, 2, 14
s_waitcnt lgkmcnt(2)
v_mfma_f32_16x16x32_f16 v[64:67], v[244:247], v[232:235], v[64:67]
ds_read_b128 v[240:243], v250 offset:4352
ds_read_u16_d16 v184, v184
v_pk_mul_f16 v202, v203, v202
v_cvt_pk_bf16_f32 v128, v128, v129
v_bfe_u32 v186, v187, 2, 14
v_mfma_f32_16x16x32_f16 v[72:75], v[244:247], v[236:239], v[72:75]
v_cvt_pk_bf16_f32 v129, v130, v131
v_pk_mul_f16 v199, v200, v199
v_lshrrev_b32 v185, 18, v185
s_waitcnt vmcnt(6)
v_mfma_f32_16x16x32_bf16 v[64:67], v[18:21], v[204:207], v[64:67]
ds_read_b128 v[244:247], v249 offset:7424
ds_read_u16_d16 v186, v186
ds_read_u16_d16_hi v185, v185
v_cvt_pk_bf16_f32 v130, v132, v133
v_pk_mul_f16 v196, v197, v196
v_lshrrev_b32_e64 v187, 18, v187
v_mfma_f32_16x16x32_bf16 v[68:71], v[16:19], v[204:207], v[68:71]
v_cvt_pk_bf16_f32 v131, v134, v135
v_exp_f16_e64 v201, v202
v_mfma_f32_16x16x32_bf16 v[172:175], v[216:219], v[96:99], 0
ds_read_u16_d16_hi v187, v187
v_cvt_pk_bf16_f32 v160, v160, v161
v_and_b32_e64 v189, s49, v189
v_cvt_pk_bf16_f32 v161, v162, v163
v_mfma_f32_16x16x32_bf16 v[180:183], v[216:219], v[100:103], 0
v_and_b32_e64 v191, s49, v191
v_cvt_pk_bf16_f32 v162, v164, v165
v_mfma_f32_16x16x32_f16 v[68:71], v[220:223], v[232:235], v[68:71]
ds_read_b128 v[216:219], v249 offset:8192
v_exp_f16 v198, v199
v_cvt_pk_bf16_f32 v163, v166, v167
s_mov_b64 vcc, s[74:75]
v_bfe_u32 v188, v189, 2, 14
v_bfe_u32 v190, v191, 2, 14
v_mfma_f32_16x16x32_f16 v[76:79], v[220:223], v[236:239], v[76:79]
v_cndmask_b32 v148, v128, v160, vcc
v_exp_f16_e64 v195, v196
s_waitcnt lgkmcnt(2)
v_mfma_f32_16x16x32_bf16 v[168:171], v[224:227], v[104:107], v[168:171]
ds_read_b128 v[220:223], v249 offset:8448
ds_read_u16_d16 v188, v188
ds_read_u16_d16 v190, v190
v_cndmask_b32 v149, v129, v161, vcc
v_lshrrev_b32_e64 v189, 18, v189
v_cndmask_b32 v150, v130, v162, vcc
v_mfma_f32_16x16x32_bf16 v[176:179], v[224:227], v[108:111], v[176:179]
v_lshrrev_b32 v191, 18, v191
v_cndmask_b32 v151, v131, v163, vcc
v_mfma_f32_16x16x32_f16 v[80:83], v[228:231], v[232:235], v[80:83]
ds_read_b128 v[224:227], v250 offset:8192
ds_read_u16_d16_hi v189, v189
ds_read_u16_d16_hi v191, v191
v_exp_f16_sdwa v201, v202 dst_sel:WORD_1 dst_unused:UNUSED_PRESERVE src0_sel:WORD_1
v_cndmask_b32_dpp v128, v144, v128, vcc quad_perm:[1,0,3,2] row_mask:0xf bank_mask:0xf
v_and_b32_e64 v193, s49, v193
v_mfma_f32_16x16x32_f16 v[88:91], v[228:231], v[236:239], v[88:91]
v_cndmask_b32_dpp v129, v145, v129, vcc quad_perm:[1,0,3,2] row_mask:0xf bank_mask:0xf
v_bfe_u32 v192, v193, 2, 14
v_mfma_f32_16x16x32_f16 v[84:87], v[240:243], v[232:235], v[84:87]
ds_read_b128 v[228:231], v250 offset:8448
ds_read_u16_d16 v192, v192
v_exp_f16_sdwa v198, v199 dst_sel:WORD_1 dst_unused:UNUSED_PRESERVE src0_sel:WORD_1
v_cndmask_b32_dpp v130, v146, v130, vcc quad_perm:[1,0,3,2] row_mask:0xf bank_mask:0xf
v_lshrrev_b32 v193, 18, v193
v_mfma_f32_16x16x32_f16 v[92:95], v[240:243], v[236:239], v[92:95]
v_cndmask_b32_dpp v131, v147, v131, vcc quad_perm:[1,0,3,2] row_mask:0xf bank_mask:0xf
s_not_b64 vcc, s[74:75]
v_exp_f16_sdwa v195, v196 dst_sel:WORD_1 dst_unused:UNUSED_PRESERVE src0_sel:WORD_1
v_mfma_f32_16x16x32_bf16 v[172:175], v[244:247], v[104:107], v[172:175]
ds_read_b128 v[240:243], v249 offset:12288
ds_read_u16_d16_hi v193, v193
v_cndmask_b32_dpp v160, v144, v160, vcc quad_perm:[1,0,3,2] row_mask:0xf bank_mask:0xf
v_pk_add_f16 v201, v201, 1.0 op_sel_hi:[1,0]
v_cndmask_b32_dpp v161, v145, v161, vcc quad_perm:[1,0,3,2] row_mask:0xf bank_mask:0xf
v_mfma_f32_16x16x32_bf16 v[180:183], v[244:247], v[108:111], v[180:183]
v_pk_add_f16 v198, v198, 1.0 op_sel_hi:[1,0]
v_cndmask_b32_dpp v162, v146, v162, vcc quad_perm:[1,0,3,2] row_mask:0xf bank_mask:0xf
v_pk_add_f16 v195, v195, 1.0 op_sel_hi:[1,0]
s_waitcnt lgkmcnt(4)
v_mfma_f32_16x16x32_bf16 v[168:171], v[216:219], v[112:115], v[168:171]
ds_read_b128 v[244:247], v250 offset:9216
v_rcp_f16 v202, v201
v_cndmask_b32_dpp v163, v147, v163, vcc quad_perm:[1,0,3,2] row_mask:0xf bank_mask:0xf
v_mfma_f32_16x16x32_bf16 v[176:179], v[216:219], v[116:119], v[176:179]
v_rcp_f16_e64 v199, v198
v_mfma_f32_16x16x32_bf16 v[172:175], v[220:223], v[112:115], v[172:175]
ds_read_b128 v[216:219], v249 offset:12544
s_add_u32 s46, s68, 98304
buffer_store_dwordx4 v[128:131], v255, s[8:11], s46 offen sc1
v_rcp_f16_e64 v196, v195
v_rcp_f16_sdwa v202, v201 dst_sel:WORD_1 dst_unused:UNUSED_PRESERVE src0_sel:WORD_1
v_mfma_f32_16x16x32_bf16 v[180:183], v[220:223], v[116:119], v[180:183]
v_rcp_f16_sdwa v199, v198 dst_sel:WORD_1 dst_unused:UNUSED_PRESERVE src0_sel:WORD_1
v_or_b32 v232, v184, v185
v_or_b32 v233, v186, v187
v_or_b32_e64 v234, v188, v189
v_rcp_f16_sdwa v196, v195 dst_sel:WORD_1 dst_unused:UNUSED_PRESERVE src0_sel:WORD_1
v_or_b32 v235, v190, v191
s_waitcnt lgkmcnt(2)
v_or_b32_e64 v236, v192, v193
v_pk_mul_f16 v237, v203, v202
v_pk_mul_f16 v238, v200, v199
v_pk_mul_f16 v239, v197, v196
v_mfma_f32_16x16x32_f16 v[48:51], v[224:227], v[232:235], v[48:51]
s_add_u32 s46, s68, 98304
buffer_store_dwordx4 v[148:151], v255, s[8:11], s46 offen offset:128 sc1
ds_read_b128 v[220:223], v250 offset:9472
v_cvt_pkrtz_f16_f32 v185, v168, v169
v_cvt_pkrtz_f16_f32 v187, v170, v171
v_mfma_f32_16x16x32_f16 v[56:59], v[224:227], v[236:239], v[56:59]
v_cvt_pkrtz_f16_f32 v189, v172, v173
v_cvt_pkrtz_f16_f32 v191, v174, v175
v_mfma_f32_16x16x32_f16 v[52:55], v[228:231], v[232:235], v[52:55]
ds_read_b128 v[224:227], v249 offset:13312
v_cvt_pkrtz_f16_f32 v193, v176, v177
v_cvt_pk_f16_f32 v203, v178, v179
v_mfma_f32_16x16x32_f16 v[60:63], v[228:231], v[236:239], v[60:63]
v_cvt_pk_f16_f32 v200, v180, v181
v_cvt_pk_f16_f32 v197, v182, v183
v_mfma_f32_16x16x32_bf16 v[168:171], v[240:243], v[96:99], 0
ds_read_b128 v[228:231], v250 offset:10240
v_pk_fma_f16 v202, v203, v203, s48
v_and_b32_e64 v185, s49, v185
v_mfma_f32_16x16x32_bf16 v[176:179], v[240:243], v[100:103], 0
v_pk_fma_f16 v199, v200, v200, s48
v_and_b32 v187, s49, v187
s_waitcnt lgkmcnt(3)
v_mfma_f32_16x16x32_f16 v[64:67], v[244:247], v[232:235], v[64:67]
ds_read_b128 v[240:243], v250 offset:10496
v_pk_fma_f16 v196, v197, v197, s48
v_bfe_u32 v184, v185, 2, 14
v_pk_mul_f16 v202, v203, v202
v_mfma_f32_16x16x32_f16 v[72:75], v[244:247], v[236:239], v[72:75]
v_bfe_u32 v186, v187, 2, 14
v_pk_mul_f16 v199, v200, v199
s_waitcnt vmcnt(6)
v_mfma_f32_16x16x32_bf16 v[80:83], v[18:21], v[8:11], v[80:83]
ds_read_b128 v[244:247], v249 offset:13568
ds_read_u16_d16 v184, v184
ds_read_u16_d16 v186, v186
v_lshrrev_b32 v185, 18, v185
v_pk_mul_f16 v196, v197, v196
v_mfma_f32_16x16x32_bf16 v[84:87], v[16:19], v[8:11], v[84:87]
v_lshrrev_b32_e64 v187, 18, v187
v_mfma_f32_16x16x32_bf16 v[172:175], v[216:219], v[96:99], 0
ds_read_u16_d16_hi v185, v185
ds_read_u16_d16_hi v187, v187
v_exp_f16 v201, v202
v_and_b32 v189, s49, v189
v_mfma_f32_16x16x32_bf16 v[180:183], v[216:219], v[100:103], 0
v_and_b32 v191, s49, v191
s_waitcnt lgkmcnt(6)
v_mfma_f32_16x16x32_f16 v[68:71], v[220:223], v[232:235], v[68:71]
ds_read_b128 v[216:219], v249 offset:14336
v_exp_f16_e64 v198, v199
v_bfe_u32 v188, v189, 2, 14
v_mfma_f32_16x16x32_f16 v[76:79], v[220:223], v[236:239], v[76:79]
v_bfe_u32 v190, v191, 2, 14
v_exp_f16_e64 v195, v196
v_mfma_f32_16x16x32_bf16 v[168:171], v[224:227], v[104:107], v[168:171]
ds_read_b128 v[220:223], v249 offset:14592
ds_read_u16_d16 v188, v188
ds_read_u16_d16 v190, v190
v_lshrrev_b32 v189, 18, v189
v_lshrrev_b32 v191, 18, v191
v_mfma_f32_16x16x32_bf16 v[176:179], v[224:227], v[108:111], v[176:179]
v_exp_f16_sdwa v201, v202 dst_sel:WORD_1 dst_unused:UNUSED_PRESERVE src0_sel:WORD_1
v_mfma_f32_16x16x32_f16 v[80:83], v[228:231], v[232:235], v[80:83]
ds_read_b128 v[224:227], v250 offset:14336
ds_read_u16_d16_hi v189, v189
ds_read_u16_d16_hi v191, v191
v_and_b32 v193, s49, v193
v_bfe_u32 v192, v193, 2, 14
v_mfma_f32_16x16x32_f16 v[88:91], v[228:231], v[236:239], v[88:91]
v_exp_f16_sdwa v198, v199 dst_sel:WORD_1 dst_unused:UNUSED_PRESERVE src0_sel:WORD_1
s_waitcnt lgkmcnt(7)
v_mfma_f32_16x16x32_f16 v[84:87], v[240:243], v[232:235], v[84:87]
ds_read_b128 v[228:231], v250 offset:14592
ds_read_u16_d16 v192, v192
v_lshrrev_b32_e64 v193, 18, v193
v_mfma_f32_16x16x32_f16 v[92:95], v[240:243], v[236:239], v[92:95]
v_exp_f16_sdwa v195, v196 dst_sel:WORD_1 dst_unused:UNUSED_PRESERVE src0_sel:WORD_1
v_pk_add_f16 v201, v201, 1.0 op_sel_hi:[1,0]
v_pk_add_f16 v198, v198, 1.0 op_sel_hi:[1,0]
v_mfma_f32_16x16x32_bf16 v[172:175], v[244:247], v[104:107], v[172:175]
ds_read_b128 v[240:243], v249 offset:18432
ds_read_u16_d16_hi v193, v193
v_pk_add_f16 v195, v195, 1.0 op_sel_hi:[1,0]
v_mfma_f32_16x16x32_bf16 v[180:183], v[244:247], v[108:111], v[180:183]
v_rcp_f16 v202, v201
s_waitcnt lgkmcnt(7)
v_mfma_f32_16x16x32_bf16 v[168:171], v[216:219], v[112:115], v[168:171]
ds_read_b128 v[244:247], v250 offset:15360
v_rcp_f16_e64 v199, v198
v_mfma_f32_16x16x32_bf16 v[176:179], v[216:219], v[116:119], v[176:179]
v_rcp_f16_e64 v196, v195
v_mfma_f32_16x16x32_bf16 v[172:175], v[220:223], v[112:115], v[172:175]
ds_read_b128 v[216:219], v249 offset:18688
v_rcp_f16_sdwa v202, v201 dst_sel:WORD_1 dst_unused:UNUSED_PRESERVE src0_sel:WORD_1
v_mfma_f32_16x16x32_bf16 v[180:183], v[220:223], v[116:119], v[180:183]
v_rcp_f16_sdwa v199, v198 dst_sel:WORD_1 dst_unused:UNUSED_PRESERVE src0_sel:WORD_1
v_or_b32 v232, v184, v185
v_or_b32 v233, v186, v187
s_waitcnt lgkmcnt(4)
v_or_b32 v234, v188, v189
v_rcp_f16_sdwa v196, v195 dst_sel:WORD_1 dst_unused:UNUSED_PRESERVE src0_sel:WORD_1
v_or_b32 v235, v190, v191
s_waitcnt lgkmcnt(2)
v_or_b32_e64 v236, v192, v193
v_pk_mul_f16 v237, v203, v202
v_pk_mul_f16 v238, v200, v199
v_pk_mul_f16 v239, v197, v196
v_mfma_f32_16x16x32_f16 v[48:51], v[224:227], v[232:235], v[48:51]
ds_read_b128 v[220:223], v250 offset:15616
v_cvt_pkrtz_f16_f32 v185, v168, v169
v_cvt_pkrtz_f16_f32 v187, v170, v171
v_mfma_f32_16x16x32_f16 v[56:59], v[224:227], v[236:239], v[56:59]
v_cvt_pkrtz_f16_f32 v189, v172, v173
v_cvt_pkrtz_f16_f32 v191, v174, v175
v_mfma_f32_16x16x32_f16 v[52:55], v[228:231], v[232:235], v[52:55]
ds_read_b128 v[224:227], v249 offset:19456
v_cvt_pkrtz_f16_f32 v193, v176, v177
v_cvt_pk_f16_f32 v203, v178, v179
v_mfma_f32_16x16x32_f16 v[60:63], v[228:231], v[236:239], v[60:63]
v_cvt_pk_f16_f32 v200, v180, v181
v_cvt_pk_f16_f32 v197, v182, v183
v_mfma_f32_16x16x32_bf16 v[168:171], v[240:243], v[96:99], 0
ds_read_b128 v[228:231], v250 offset:16384
v_pk_fma_f16 v202, v203, v203, s48
v_and_b32_e64 v185, s49, v185
v_mfma_f32_16x16x32_bf16 v[176:179], v[240:243], v[100:103], 0
v_pk_fma_f16 v199, v200, v200, s48
v_and_b32 v187, s49, v187
s_waitcnt lgkmcnt(3)
v_mfma_f32_16x16x32_f16 v[64:67], v[244:247], v[232:235], v[64:67]
ds_read_b128 v[240:243], v250 offset:16640
v_pk_fma_f16 v196, v197, v197, s48
v_bfe_u32 v184, v185, 2, 14
v_pk_mul_f16 v202, v203, v202
v_mfma_f32_16x16x32_f16 v[72:75], v[244:247], v[236:239], v[72:75]
v_bfe_u32 v186, v187, 2, 14
v_pk_mul_f16 v199, v200, v199
s_waitcnt vmcnt(5)
v_mfma_f32_16x16x32_bf16 v[56:59], v[18:21], v[44:47], v[56:59]
ds_read_b128 v[244:247], v249 offset:19712
ds_read_u16_d16 v184, v184
ds_read_u16_d16 v186, v186
v_lshrrev_b32 v185, 18, v185
v_pk_mul_f16 v196, v197, v196
v_mfma_f32_16x16x32_bf16 v[60:63], v[16:19], v[44:47], v[60:63]
v_lshrrev_b32_e64 v187, 18, v187
v_mfma_f32_16x16x32_bf16 v[172:175], v[216:219], v[96:99], 0
ds_read_u16_d16_hi v185, v185
ds_read_u16_d16_hi v187, v187
v_exp_f16 v201, v202
v_and_b32 v189, s49, v189
v_mfma_f32_16x16x32_bf16 v[180:183], v[216:219], v[100:103], 0
v_and_b32 v191, s49, v191
s_waitcnt lgkmcnt(6)
v_mfma_f32_16x16x32_f16 v[68:71], v[220:223], v[232:235], v[68:71]
ds_read_b128 v[216:219], v249 offset:20480
v_exp_f16_e64 v198, v199
v_bfe_u32 v188, v189, 2, 14
v_mfma_f32_16x16x32_f16 v[76:79], v[220:223], v[236:239], v[76:79]
v_bfe_u32 v190, v191, 2, 14
v_exp_f16_e64 v195, v196
v_mfma_f32_16x16x32_bf16 v[168:171], v[224:227], v[104:107], v[168:171]
ds_read_b128 v[220:223], v249 offset:20736
ds_read_u16_d16 v188, v188
ds_read_u16_d16 v190, v190
v_lshrrev_b32 v189, 18, v189
v_lshrrev_b32 v191, 18, v191
v_mfma_f32_16x16x32_bf16 v[176:179], v[224:227], v[108:111], v[176:179]
v_exp_f16_sdwa v201, v202 dst_sel:WORD_1 dst_unused:UNUSED_PRESERVE src0_sel:WORD_1
v_mfma_f32_16x16x32_f16 v[80:83], v[228:231], v[232:235], v[80:83]
ds_read_b128 v[224:227], v250 offset:20480
ds_read_u16_d16_hi v189, v189
ds_read_u16_d16_hi v191, v191
v_and_b32 v193, s49, v193
v_bfe_u32 v192, v193, 2, 14
v_mfma_f32_16x16x32_f16 v[88:91], v[228:231], v[236:239], v[88:91]
v_exp_f16_sdwa v198, v199 dst_sel:WORD_1 dst_unused:UNUSED_PRESERVE src0_sel:WORD_1
s_waitcnt lgkmcnt(7)
v_mfma_f32_16x16x32_f16 v[84:87], v[240:243], v[232:235], v[84:87]
ds_read_b128 v[228:231], v250 offset:20736
ds_read_u16_d16 v192, v192
v_lshrrev_b32_e64 v193, 18, v193
v_mfma_f32_16x16x32_f16 v[92:95], v[240:243], v[236:239], v[92:95]
v_exp_f16_sdwa v195, v196 dst_sel:WORD_1 dst_unused:UNUSED_PRESERVE src0_sel:WORD_1
v_pk_add_f16 v201, v201, 1.0 op_sel_hi:[1,0]
v_pk_add_f16 v198, v198, 1.0 op_sel_hi:[1,0]
v_mfma_f32_16x16x32_bf16 v[172:175], v[244:247], v[104:107], v[172:175]
ds_read_b128 v[240:243], v250 offset:21504
ds_read_u16_d16_hi v193, v193
v_pk_add_f16 v195, v195, 1.0 op_sel_hi:[1,0]
v_mfma_f32_16x16x32_bf16 v[180:183], v[244:247], v[108:111], v[180:183]
v_rcp_f16 v202, v201
s_waitcnt lgkmcnt(7)
v_mfma_f32_16x16x32_bf16 v[168:171], v[216:219], v[112:115], v[168:171]
ds_read_b128 v[244:247], v250 offset:21760
v_rcp_f16_e64 v199, v198
v_mfma_f32_16x16x32_bf16 v[176:179], v[216:219], v[116:119], v[176:179]
v_rcp_f16_e64 v196, v195
v_mfma_f32_16x16x32_bf16 v[172:175], v[220:223], v[112:115], v[172:175]
ds_read_b128 v[216:219], v250 offset:22528
v_rcp_f16_sdwa v202, v201 dst_sel:WORD_1 dst_unused:UNUSED_PRESERVE src0_sel:WORD_1
v_mfma_f32_16x16x32_bf16 v[180:183], v[220:223], v[116:119], v[180:183]
v_rcp_f16_sdwa v199, v198 dst_sel:WORD_1 dst_unused:UNUSED_PRESERVE src0_sel:WORD_1
v_or_b32 v232, v184, v185
v_or_b32 v233, v186, v187
s_waitcnt lgkmcnt(4)
v_or_b32 v234, v188, v189
v_rcp_f16_sdwa v196, v195 dst_sel:WORD_1 dst_unused:UNUSED_PRESERVE src0_sel:WORD_1
v_or_b32 v235, v190, v191
s_waitcnt lgkmcnt(2)
v_or_b32_e64 v236, v192, v193
v_pk_mul_f16 v237, v203, v202
v_pk_mul_f16 v238, v200, v199
v_pk_mul_f16 v239, v197, v196
v_mfma_f32_16x16x32_f16 v[48:51], v[224:227], v[232:235], v[48:51]
s_add_u32 s46, s68, 98304
buffer_store_dwordx4 v[160:163], v255, s[8:11], s46 offen offset:256 sc1
ds_read_b128 v[220:223], v250 offset:22784
v_cvt_pkrtz_f16_f32 v185, v168, v169
v_cvt_pkrtz_f16_f32 v187, v170, v171
v_cvt_pkrtz_f16_f32 v189, v172, v173
v_cvt_pkrtz_f16_f32 v191, v174, v175
v_mfma_f32_16x16x32_f16 v[56:59], v[224:227], v[236:239], v[56:59]
v_cvt_pkrtz_f16_f32 v193, v176, v177
v_cvt_pk_f16_f32 v203, v178, v179
v_cvt_pk_f16_f32 v200, v180, v181
v_cvt_pk_f16_f32 v197, v182, v183
v_mfma_f32_16x16x32_f16 v[52:55], v[228:231], v[232:235], v[52:55]
ds_read_b128 v[224:227], v250 offset:26624
v_pk_fma_f16 v202, v203, v203, s48
v_and_b32_e64 v185, s49, v185
v_pk_fma_f16 v199, v200, v200, s48
v_and_b32_e64 v187, s49, v187
v_mfma_f32_16x16x32_f16 v[60:63], v[228:231], v[236:239], v[60:63]
v_pk_fma_f16 v196, v197, v197, s48
v_bfe_u32 v184, v185, 2, 14
v_pk_mul_f16 v202, v203, v202
v_bfe_u32 v186, v187, 2, 14
v_mfma_f32_16x16x32_f16 v[64:67], v[240:243], v[232:235], v[64:67]
ds_read_b128 v[228:231], v250 offset:26880
ds_read_u16_d16 v184, v184
ds_read_u16_d16 v186, v186
v_pk_mul_f16 v199, v200, v199
v_lshrrev_b32_e64 v185, 18, v185
v_pk_mul_f16 v196, v197, v196
v_lshrrev_b32_e64 v187, 18, v187
v_mfma_f32_16x16x32_f16 v[72:75], v[240:243], v[236:239], v[72:75]
v_exp_f16 v201, v202
v_and_b32 v189, s49, v189
v_and_b32 v191, s49, v191
s_waitcnt vmcnt(4)
v_mfma_f32_16x16x32_bf16 v[72:75], v[18:21], v[40:43], v[72:75]
ds_read_b128 v[240:243], v250 offset:27648
ds_read_u16_d16_hi v185, v185
ds_read_u16_d16_hi v187, v187
v_exp_f16_e64 v198, v199
v_bfe_u32 v188, v189, 2, 14
v_bfe_u32 v190, v191, 2, 14
v_mfma_f32_16x16x32_bf16 v[76:79], v[16:19], v[40:43], v[76:79]
v_exp_f16 v195, v196
v_lshrrev_b32 v189, 18, v189
v_lshrrev_b32 v191, 18, v191
s_waitcnt lgkmcnt(6)
v_mfma_f32_16x16x32_f16 v[68:71], v[244:247], v[232:235], v[68:71]
ds_read_u16_d16 v188, v188
ds_read_u16_d16 v190, v190
ds_read_u16_d16_hi v189, v189
ds_read_u16_d16_hi v191, v191
v_exp_f16_sdwa v201, v202 dst_sel:WORD_1 dst_unused:UNUSED_PRESERVE src0_sel:WORD_1
v_and_b32_e64 v193, s49, v193
v_bfe_u32 v192, v193, 2, 14
v_mfma_f32_16x16x32_f16 v[76:79], v[244:247], v[236:239], v[76:79]
v_exp_f16_sdwa v198, v199 dst_sel:WORD_1 dst_unused:UNUSED_PRESERVE src0_sel:WORD_1
v_lshrrev_b32_e64 v193, 18, v193
v_mfma_f32_16x16x32_f16 v[80:83], v[216:219], v[232:235], v[80:83]
ds_read_b128 v[244:247], v250 offset:27904
ds_read_u16_d16 v192, v192
ds_read_u16_d16_hi v193, v193
v_exp_f16_sdwa v195, v196 dst_sel:WORD_1 dst_unused:UNUSED_PRESERVE src0_sel:WORD_1
v_pk_add_f16 v201, v201, 1.0 op_sel_hi:[1,0]
v_pk_add_f16 v198, v198, 1.0 op_sel_hi:[1,0]
v_pk_add_f16 v195, v195, 1.0 op_sel_hi:[1,0]
v_mfma_f32_16x16x32_f16 v[88:91], v[216:219], v[236:239], v[88:91]
v_rcp_f16 v202, v201
v_rcp_f16 v199, v198
v_mfma_f32_16x16x32_f16 v[84:87], v[220:223], v[232:235], v[84:87]
ds_read_b128 v[216:219], v250 offset:28672
v_rcp_f16_e64 v196, v195
v_rcp_f16_sdwa v202, v201 dst_sel:WORD_1 dst_unused:UNUSED_PRESERVE src0_sel:WORD_1
v_mfma_f32_16x16x32_f16 v[92:95], v[220:223], v[236:239], v[92:95]
v_rcp_f16_sdwa v199, v198 dst_sel:WORD_1 dst_unused:UNUSED_PRESERVE src0_sel:WORD_1
s_waitcnt lgkmcnt(5)
v_or_b32 v232, v184, v185
v_or_b32_e64 v233, v186, v187
v_or_b32 v234, v188, v189
v_rcp_f16_sdwa v196, v195 dst_sel:WORD_1 dst_unused:UNUSED_PRESERVE src0_sel:WORD_1
s_waitcnt lgkmcnt(4)
v_or_b32 v235, v190, v191
s_waitcnt lgkmcnt(1)
v_or_b32 v236, v192, v193
v_pk_mul_f16 v237, v203, v202
v_pk_mul_f16 v238, v200, v199
v_pk_mul_f16 v239, v197, v196
v_mfma_f32_16x16x32_f16 v[48:51], v[224:227], v[232:235], v[48:51]
ds_read_b128 v[220:223], v250 offset:28928
v_mfma_f32_16x16x32_f16 v[56:59], v[224:227], v[236:239], v[56:59]
v_mfma_f32_16x16x32_f16 v[52:55], v[228:231], v[232:235], v[52:55]
v_mfma_f32_16x16x32_f16 v[60:63], v[228:231], v[236:239], v[60:63]
v_mfma_f32_16x16x32_f16 v[64:67], v[240:243], v[232:235], v[64:67]
v_mfma_f32_16x16x32_f16 v[72:75], v[240:243], v[236:239], v[72:75]
s_waitcnt vmcnt(3)
v_mfma_f32_16x16x32_bf16 v[88:91], v[18:21], v[208:211], v[88:91]
v_mfma_f32_16x16x32_bf16 v[92:95], v[16:19], v[208:211], v[92:95]
v_mfma_f32_16x16x32_f16 v[68:71], v[244:247], v[232:235], v[68:71]
v_mfma_f32_16x16x32_f16 v[76:79], v[244:247], v[236:239], v[76:79]
s_waitcnt lgkmcnt(1)
v_mfma_f32_16x16x32_f16 v[80:83], v[216:219], v[232:235], v[80:83]
v_mfma_f32_16x16x32_f16 v[88:91], v[216:219], v[236:239], v[88:91]
s_waitcnt lgkmcnt(0)
v_mfma_f32_16x16x32_f16 v[84:87], v[220:223], v[232:235], v[84:87]
v_mfma_f32_16x16x32_f16 v[92:95], v[220:223], v[236:239], v[92:95]
v_cvt_pk_bf16_f32 v64, v64, v65
v_cvt_pk_bf16_f32 v65, v66, v67
v_cvt_pk_bf16_f32 v66, v68, v69
v_cvt_pk_bf16_f32 v67, v70, v71
v_cvt_pk_bf16_f32 v48, v48, v49
v_cvt_pk_bf16_f32 v49, v50, v51
v_cvt_pk_bf16_f32 v50, v52, v53
v_cvt_pk_bf16_f32 v51, v54, v55
v_cvt_pk_bf16_f32 v80, v80, v81
v_cvt_pk_bf16_f32 v81, v82, v83
v_cvt_pk_bf16_f32 v82, v84, v85
v_cvt_pk_bf16_f32 v83, v86, v87
s_mov_b64 vcc, s[74:75]
v_cndmask_b32 v68, v48, v80, vcc
v_cndmask_b32 v69, v49, v81, vcc
v_cndmask_b32 v70, v50, v82, vcc
v_cndmask_b32 v71, v51, v83, vcc
v_cndmask_b32_dpp v48, v64, v48, vcc quad_perm:[1,0,3,2] row_mask:0xf bank_mask:0xf
v_cndmask_b32_dpp v49, v65, v49, vcc quad_perm:[1,0,3,2] row_mask:0xf bank_mask:0xf
v_cndmask_b32_dpp v50, v66, v50, vcc quad_perm:[1,0,3,2] row_mask:0xf bank_mask:0xf
v_cndmask_b32_dpp v51, v67, v51, vcc quad_perm:[1,0,3,2] row_mask:0xf bank_mask:0xf
s_not_b64 vcc, s[74:75]
v_cndmask_b32_dpp v80, v64, v80, vcc quad_perm:[1,0,3,2] row_mask:0xf bank_mask:0xf
v_cndmask_b32_dpp v81, v65, v81, vcc quad_perm:[1,0,3,2] row_mask:0xf bank_mask:0xf
v_cndmask_b32_dpp v82, v66, v82, vcc quad_perm:[1,0,3,2] row_mask:0xf bank_mask:0xf
v_cndmask_b32_dpp v83, v67, v83, vcc quad_perm:[1,0,3,2] row_mask:0xf bank_mask:0xf
buffer_store_dwordx4 v[48:51], v255, s[8:11], s69 offen sc1
buffer_store_dwordx4 v[68:71], v255, s[8:11], s69 offen offset:128 sc1
buffer_store_dwordx4 v[80:83], v255, s[8:11], s69 offen offset:256 sc1
v_cvt_pk_bf16_f32 v72, v72, v73
v_cvt_pk_bf16_f32 v73, v74, v75
v_cvt_pk_bf16_f32 v74, v76, v77
v_cvt_pk_bf16_f32 v75, v78, v79
v_cvt_pk_bf16_f32 v56, v56, v57
v_cvt_pk_bf16_f32 v57, v58, v59
v_cvt_pk_bf16_f32 v58, v60, v61
v_cvt_pk_bf16_f32 v59, v62, v63
v_cvt_pk_bf16_f32 v88, v88, v89
v_cvt_pk_bf16_f32 v89, v90, v91
v_cvt_pk_bf16_f32 v90, v92, v93
v_cvt_pk_bf16_f32 v91, v94, v95
s_mov_b64 vcc, s[74:75]
v_cndmask_b32 v76, v56, v88, vcc
v_cndmask_b32 v77, v57, v89, vcc
v_cndmask_b32 v78, v58, v90, vcc
v_cndmask_b32 v79, v59, v91, vcc
v_cndmask_b32_dpp v56, v72, v56, vcc quad_perm:[1,0,3,2] row_mask:0xf bank_mask:0xf
v_cndmask_b32_dpp v57, v73, v57, vcc quad_perm:[1,0,3,2] row_mask:0xf bank_mask:0xf
v_cndmask_b32_dpp v58, v74, v58, vcc quad_perm:[1,0,3,2] row_mask:0xf bank_mask:0xf
v_cndmask_b32_dpp v59, v75, v59, vcc quad_perm:[1,0,3,2] row_mask:0xf bank_mask:0xf
s_not_b64 vcc, s[74:75]
v_cndmask_b32_dpp v88, v72, v88, vcc quad_perm:[1,0,3,2] row_mask:0xf bank_mask:0xf
v_cndmask_b32_dpp v89, v73, v89, vcc quad_perm:[1,0,3,2] row_mask:0xf bank_mask:0xf
v_cndmask_b32_dpp v90, v74, v90, vcc quad_perm:[1,0,3,2] row_mask:0xf bank_mask:0xf
v_cndmask_b32_dpp v91, v75, v91, vcc quad_perm:[1,0,3,2] row_mask:0xf bank_mask:0xf
s_add_u32 s46, s69, 98304
buffer_store_dwordx4 v[56:59], v255, s[8:11], s46 offen sc1
s_add_u32 s46, s69, 98304
buffer_store_dwordx4 v[76:79], v255, s[8:11], s46 offen offset:128 sc1
s_add_u32 s46, s69, 98304
buffer_store_dwordx4 v[88:91], v255, s[8:11], s46 offen offset:256 sc1
s_endpgm
Lpoll:
s_waitcnt vmcnt(0)
Lpoll1:
s_cmp_eq_u32 s77, 2
s_cbranch_scc1 LpollC
v_max_u32 v255, v156, v157
v_max3_u32 v255, v255, v158, v159
v_max3_u32 v255, v255, v160, v161
v_max3_u32 v255, v255, v162, v163
v_max3_u32 v255, v255, v164, v165
v_max3_u32 v255, v255, v166, v167
v_max3_u32 v255, v255, v240, v241
v_max3_u32 v255, v255, v242, v243
v_cmp_eq_u32 vcc, -1, v255
s_nop 4
s_cbranch_vccz LpollR
v_lshlrev_b32 v247, 4, v251
s_lshl_b32 s44, s2, 12
buffer_load_dwordx4 v[156:159], v247, s[32:35], s44 offen sc1
buffer_load_dwordx4 v[160:163], v247, s[32:35], s44 offen offset:1024 sc1
buffer_load_dwordx4 v[164:167], v247, s[32:35], s44 offen offset:2048 sc1
buffer_load_dwordx4 v[240:243], v247, s[32:35], s44 offen offset:3072 sc1
s_setpc_b64 s[78:79]
LpollR:
s_setprio 3
v_add_f32 v156, v156, v160
v_add_f32 v240, v164, v240
v_add_f32 v240, v156, v240
v_add_f32 v157, v157, v161
v_add_f32 v241, v165, v241
v_add_f32 v241, v157, v241
v_add_f32 v158, v158, v162
v_add_f32 v242, v166, v242
v_add_f32 v242, v158, v242
v_add_f32 v159, v159, v163
v_add_f32 v243, v167, v243
v_add_f32 v243, v159, v243
v_add_f32_dpp v240, v240, v240 row_ror:8 row_mask:0xf bank_mask:0xf
s_nop 1
v_add_f32_dpp v240, v240, v240 row_ror:4 row_mask:0xf bank_mask:0xf
s_nop 1
v_add_f32_dpp v240, v240, v240 row_ror:2 row_mask:0xf bank_mask:0xf
s_nop 1
v_add_f32_dpp v240, v240, v240 row_ror:1 row_mask:0xf bank_mask:0xf
v_mov_b32 v255, v240
s_nop 1
v_permlane16_swap_b32 v240, v255
v_add_f32 v240, v240, v255
v_mov_b32 v255, v240
s_nop 1
v_permlane32_swap_b32 v240, v255
v_add_f32 v240, v240, v255
v_min_u32 v240, -2, v240
v_add_f32_dpp v241, v241, v241 row_ror:8 row_mask:0xf bank_mask:0xf
s_nop 1
v_add_f32_dpp v241, v241, v241 row_ror:4 row_mask:0xf bank_mask:0xf
s_nop 1
v_add_f32_dpp v241, v241, v241 row_ror:2 row_mask:0xf bank_mask:0xf
s_nop 1
v_add_f32_dpp v241, v241, v241 row_ror:1 row_mask:0xf bank_mask:0xf
v_mov_b32 v255, v241
s_nop 1
v_permlane16_swap_b32 v241, v255
v_add_f32 v241, v241, v255
v_mov_b32 v255, v241
s_nop 1
v_permlane32_swap_b32 v241, v255
v_add_f32 v241, v241, v255
v_min_u32 v241, -2, v241
v_add_f32_dpp v242, v242, v242 row_ror:8 row_mask:0xf bank_mask:0xf
s_nop 1
v_add_f32_dpp v242, v242, v242 row_ror:4 row_mask:0xf bank_mask:0xf
s_nop 1
v_add_f32_dpp v242, v242, v242 row_ror:2 row_mask:0xf bank_mask:0xf
s_nop 1
v_add_f32_dpp v242, v242, v242 row_ror:1 row_mask:0xf bank_mask:0xf
v_mov_b32 v255, v242
s_nop 1
v_permlane16_swap_b32 v242, v255
v_add_f32 v242, v242, v255
v_mov_b32 v255, v242
s_nop 1
v_permlane32_swap_b32 v242, v255
v_add_f32 v242, v242, v255
v_min_u32 v242, -2, v242
v_add_f32_dpp v243, v243, v243 row_ror:8 row_mask:0xf bank_mask:0xf
s_nop 1
v_add_f32_dpp v243, v243, v243 row_ror:4 row_mask:0xf bank_mask:0xf
s_nop 1
v_add_f32_dpp v243, v243, v243 row_ror:2 row_mask:0xf bank_mask:0xf
s_nop 1
v_add_f32_dpp v243, v243, v243 row_ror:1 row_mask:0xf bank_mask:0xf
v_mov_b32 v255, v243
s_nop 1
v_permlane16_swap_b32 v243, v255
v_add_f32 v243, v243, v255
v_mov_b32 v255, v243
s_nop 1
v_permlane32_swap_b32 v243, v255
v_add_f32_e64 v243, v243, v255
v_min_u32 v243, -2, v243
s_lshl_b32 s44, s2, 4
s_add_u32 s44, s44, 393216
v_lshlrev_b32_e64 v255, 11, v251
s_mov_b64 exec, 0xff
buffer_store_dwordx4 v[240:243], v255, s[32:35], s44 offen sc1
s_mov_b64 exec, -1
s_mov_b32 s77, 2
v_lshlrev_b32_e64 v247, 3, v251
s_and_b32 s44, s2, 7
s_lshl_b32 s44, s44, 11
s_add_u32 s44, s44, 393216
buffer_load_dwordx2 v[156:157], v247, s[32:35], s44 offen sc1
buffer_load_dwordx2 v[158:159], v247, s[32:35], s44 offen offset:512 sc1
buffer_load_dwordx2 v[160:161], v247, s[32:35], s44 offen offset:1024 sc1
s_setpc_b64 s[78:79]
LpollC:
v_max3_u32 v255, v156, v157, v158
v_max3_u32 v255, v255, v159, v160
v_max_u32 v255, v255, v161
v_cmp_eq_u32 vcc, -1, v255
s_nop 4
s_cbranch_vccz LpollS
v_lshlrev_b32 v247, 3, v251
s_and_b32 s44, s2, 7
s_lshl_b32 s44, s44, 11
s_add_u32 s44, s44, 393216
buffer_load_dwordx2 v[156:157], v247, s[32:35], s44 offen sc1
buffer_load_dwordx2 v[158:159], v247, s[32:35], s44 offen offset:512 sc1
buffer_load_dwordx2 v[160:161], v247, s[32:35], s44 offen offset:1024 sc1
s_setpc_b64 s[78:79]
LpollS:
s_setprio 3
s_mov_b32 s43, 1083296634
v_mov_b32 v162, 897988541
v_fma_f32 v156, v156, s43, v162
v_fma_f32 v157, v157, s43, v162
v_fma_f32 v158, v158, s43, v162
v_fma_f32 v159, v159, s43, v162
v_fma_f32 v160, v160, s43, v162
v_fma_f32 v161, v161, s43, v162
v_sqrt_f32 v156, v156
v_sqrt_f32 v157, v157
v_sqrt_f32 v158, v158
v_sqrt_f32 v159, v159
v_sqrt_f32 v160, v160
v_sqrt_f32 v161, v161
v_add_f32 v163, v156, v157
v_add_f32 v163, v163, v158
v_add_f32 v163, v163, v159
v_add_f32 v163, v163, v160
v_add_f32 v163, v163, v161
s_nop 1
v_add_f32_dpp v163, v163, v163 row_ror:8 row_mask:0xf bank_mask:0xf
s_nop 1
v_add_f32_dpp v163, v163, v163 row_ror:4 row_mask:0xf bank_mask:0xf
s_nop 1
v_add_f32_dpp v163, v163, v163 row_ror:2 row_mask:0xf bank_mask:0xf
s_nop 1
v_add_f32_dpp v163, v163, v163 row_ror:1 row_mask:0xf bank_mask:0xf
v_mov_b32 v255, v163
s_nop 1
v_permlane16_swap_b32 v163, v255
v_add_f32 v163, v163, v255
v_mov_b32 v255, v163
s_nop 1
v_permlane32_swap_b32 v163, v255
v_add_f32_e64 v163, v163, v255
s_mov_b32 s43, 992651947
v_fma_f32 v163, v163, s43, v162
v_rcp_f32_e64 v163, v163
v_mov_b32 v162, 3221789604
v_mul_f32 v163, v163, v162
v_lshlrev_b32 v164, 16, v244
v_and_b32 v165, 4294901760, v244
v_mul_f32 v156, v156, v163
v_mul_f32 v157, v157, v163
v_fma_f32 v164, v164, v156, v162
v_fma_f32 v165, v165, v157, v162
v_cvt_pk_f16_f32 v244, v164, v165
v_lshlrev_b32_e64 v164, 16, v245
v_and_b32 v165, 4294901760, v245
v_mul_f32 v158, v158, v163
v_mul_f32 v159, v159, v163
v_fma_f32 v164, v164, v158, v162
v_fma_f32 v165, v165, v159, v162
v_cvt_pk_f16_f32 v245, v164, v165
v_lshlrev_b32_e64 v164, 16, v246
v_and_b32 v165, 4294901760, v246
v_mul_f32 v160, v160, v163
v_mul_f32 v161, v161, v163
v_fma_f32 v164, v164, v160, v162
v_fma_f32 v165, v165, v161, v162
v_cvt_pk_f16_f32 v246, v164, v165
s_mov_b32 s77, 0
s_setpc_b64 s[78:79]
Lend:
s_endpgm

.section .rodata,"a"
.p2align 6
.amdhsa_kernel standalone__modern_conv_block_convnext_v2__vision_kernel
  .amdhsa_next_free_vgpr 256
  .amdhsa_next_free_sgpr 102
  .amdhsa_accum_offset 256
  .amdhsa_group_segment_fixed_size 0
  .amdhsa_kernarg_size 72
  .amdhsa_user_sgpr_count 2
  .amdhsa_user_sgpr_kernarg_segment_ptr 1
  .amdhsa_system_sgpr_workgroup_id_x 1
.end_amdhsa_kernel
```

```asm
; @launch grid=(256,1,1) block=(512,1,1) lds=163840
.amdgcn_target "amdgcn-amd-amdhsa--gfx950"
.text
.globl standalone__modern_conv_block_convnext_v2__vision_kernel
.p2align 8
.type standalone__modern_conv_block_convnext_v2__vision_kernel,@function
standalone__modern_conv_block_convnext_v2__vision_kernel:
Lmain:
s_cmp_ge_u32 s2, 256
s_cbranch_scc1 Lend
s_load_dwordx16 s[80:95], s[0:1], 0
s_load_dwordx2 s[96:97], s[0:1], 64
s_getpc_b64 s[74:75]
Lpc0:
s_sub_u32 s74, s74, Lpc0-Lmain
s_subb_u32 s75, s75, 0
v_lshlrev_b32 v159, 7, v0
s_movk_i32 s43, 64
v_cmp_gt_u32 vcc, s43, v0
s_and_saveexec_b64 s[78:79], vcc
s_cbranch_execz Lpf0x
global_load_dword v255, v159, s[74:75]
Lpf0x:
s_mov_b64 exec, s[78:79]
v_mov_b32 v199, v0
v_and_b32 v251, 63, v0
v_lshrrev_b32 v120, 6, v0
s_nop 0
v_readfirstlane_b32 s40, v120
s_and_b32 s43, s2, 7
s_lshr_b32 s44, s2, 3
s_and_b32 s41, s43, 0
s_lshl_b32 s41, s41, 4
s_and_b32 s45, s44, 15
s_add_u32 s41, s41, s45
s_lshr_b32 s42, s43, 0
s_lshl_b32 s42, s42, 1
s_lshr_b32 s45, s44, 4
s_add_u32 s42, s42, s45
s_lshl_b32 s41, s41, 5
s_lshl_b32 s42, s42, 5
s_lshl_b32 s67, s40, 6
s_cmp_eq_u32 s40, 6
s_cselect_b32 s67, 352, s67
v_add_u32_e64 v125, s67, v251
v_mul_u32_u24 v121, 5462, v125
v_lshrrev_b32 v121, 16, v121
v_mul_u32_u24 v122, 12, v121
v_sub_u32 v122, v125, v122
v_bfe_u32 v123, v121, 2, 2
v_xor_b32 v122, v122, v123
v_add_u32 v123, s41, v121
v_subrev_u32 v123, 1, v123
v_mul_u32_u24 v124, 192, v123
v_lshl_add_u32 v124, v122, 4, v124
v_mov_b32 v240, 2147483648
s_movk_i32 s43, 512
v_cmp_gt_u32 vcc, s43, v123
s_nop 1
v_cndmask_b32 v124, v240, v124, vcc
v_cmp_gt_u32 vcc, 34, v121
s_nop 1
v_cndmask_b32 v240, v240, v124, vcc
s_add_i32 s43, s42, -1
s_mul_i32 s44, s43, 98304
s_cmp_lt_u32 s43, 512
s_cselect_b32 s46, s44, 1073741824
s_mul_i32 s66, s42, 98304
s_mov_b32 s6, 50331648
s_mov_b32 s7, 131072
s_lshl_b32 s67, s67, 4
s_add_u32 s67, s67, 90112
s_cmp_eq_u32 s40, 7
s_cselect_b32 s67, 163840, s67
v_lshlrev_b32 v130, 1, v199
v_add_u32 v155, 768, v199
v_min_u32 v155, 863, v155
v_lshlrev_b32_e64 v131, 1, v155
s_waitcnt lgkmcnt(0)
s_mov_b32 s4, s80
s_and_b32 s5, s81, 65535
s_cmp_ge_u32 s40, 4
s_cbranch_scc1 Lnodw
s_mov_b32 s20, s82
s_and_b32 s21, s83, 65535
s_mov_b32 s22, 1728
s_mov_b32 s23, 131072
buffer_load_ushort v126, v130, s[20:23], 0 offen offset:0
buffer_load_ushort v127, v130, s[20:23], 0 offen offset:512
buffer_load_ushort v128, v130, s[20:23], 0 offen offset:1024
buffer_load_ushort v129, v131, s[20:23], 0 offen offset:0
Lnodw:
s_cmp_eq_u32 s40, 7
s_cbranch_scc1 Lskipx0
s_add_u32 m0, s67, 0
s_nop 0
buffer_load_dwordx4 v240, s[4:7], s46 offen nt lds
s_add_u32 m0, s67, 6656
s_nop 0
buffer_load_dwordx4 v240, s[4:7], s66 offen nt lds
s_add_u32 m0, s67, 13312
s_add_u32 s45, s66, 98304
buffer_load_dwordx4 v240, s[4:7], s45 offen nt lds
s_add_u32 m0, s67, 19968
s_add_u32 s45, s66, 196608
buffer_load_dwordx4 v240, s[4:7], s45 offen nt lds
s_add_u32 m0, s67, 26624
s_add_u32 s45, s66, 294912
buffer_load_dwordx4 v240, s[4:7], s45 offen nt lds
s_add_u32 m0, s67, 33280
s_add_u32 s45, s66, 393216
buffer_load_dwordx4 v240, s[4:7], s45 offen nt lds
Lskipx0:
s_mov_b32 s12, s84
s_and_b32 s13, s85, 65535
s_mov_b32 s14, 73728
s_mov_b32 s15, 131072
v_lshrrev_b32 v189, 2, v251
v_mul_u32_u24 v189, 768, v189
v_and_b32_e64 v125, 3, v251
v_lshl_add_u32 v189, v125, 4, v189
s_and_b32 s43, s40, 3
s_lshl_b32 s3, s43, 6
s_mul_i32 s77, s43, 6144
s_add_u32 s77, s77, 16384
v_mov_b32 v253, 16256
v_mov_b32 v254, 1
s_add_u32 s43, s42, s40
s_add_u32 s43, s43, 1
s_lshl_b32 s43, s43, 9
s_add_u32 s43, s43, s41
s_mul_i32 s47, s43, 192
s_sub_u32 s47, s47, 256
s_and_b32 s43, s40, 1
s_lshl_b32 s46, s43, 4
s_add_u32 s41, s41, s46
s_and_b32 s43, s40, 6
s_add_u32 s42, s42, s43
s_mul_i32 s45, s43, 6656
s_add_u32 s45, s45, 90112
v_and_b32 v131, 15, v251
v_lshrrev_b32 v132, 4, v251
v_mul_u32_u24 v122, 6656, v132
v_add_u32 v122, s45, v122
v_add_u32 v121, s46, v131
v_mul_u32_u24 v123, 192, v121
v_bfe_u32 v124, v121, 2, 2
v_lshl_add_u32 v123, v124, 4, v123
v_add_u32 v242, v122, v123
v_add_u32 v121, 1, v121
v_mul_u32_u24 v123, 192, v121
v_bfe_u32 v124, v121, 2, 2
v_lshl_add_u32 v123, v124, 4, v123
v_add_u32 v243, v122, v123
v_add_u32 v121, 1, v121
v_mul_u32_u24 v123, 192, v121
v_bfe_u32 v124, v121, 2, 2
v_lshl_add_u32 v123, v124, 4, v123
v_add_u32_e64 v244, v122, v123
s_mul_i32 s72, s40, 9216
s_add_u32 s72, s72, 90112
v_bfe_u32 v133, v131, 2, 1
v_sub_u32 v133, v132, v133
v_lshrrev_b32 v134, 3, v131
v_and_b32_e64 v135, 3, v131
v_lshl_add_u32 v135, v134, 2, v135
v_lshlrev_b32_e64 v136, 7, v133
v_lshl_add_u32 v136, v135, 4, v136
v_add_u32 v136, 156672, v136
v_mov_b32 v135, 163840
v_cmp_gt_u32 vcc, 3, v133
s_nop 1
v_cndmask_b32 v245, v135, v136, vcc
v_and_b32 v135, 3, v131
v_mul_u32_u24 v246, 85, v135
s_mov_b32 s16, s86
s_and_b32 s17, s87, 65535
s_mov_b32 s18, 73728
s_mov_b32 s19, 131072
s_mov_b32 s24, s88
s_and_b32 s25, s89, 65535
s_mov_b32 s26, 768
s_mov_b32 s27, 131072
s_mov_b32 s28, s90
s_and_b32 s29, s91, 65535
s_mov_b32 s30, 768
s_mov_b32 s31, 131072
s_mov_b32 s8, s92
s_and_b32 s9, s93, 65535
s_mov_b32 s10, 50331648
s_mov_b32 s11, 131072
s_mov_b32 s36, s94
s_and_b32 s37, s95, 65535
s_mov_b32 s38, 256
s_mov_b32 s39, 131072
s_mov_b32 s32, s96
s_and_b32 s33, s97, 65535
s_mov_b32 s34, 83886080
s_mov_b32 s35, 131072
v_lshlrev_b32 v241, 4, v251
v_and_b32 v133, 35, v251
v_bfe_u32 v134, v251, 2, 2
v_lshl_add_u32 v133, v134, 3, v133
v_bfe_u32 v134, v251, 4, 1
v_lshl_add_u32 v133, v134, 2, v133
v_lshlrev_b32_e64 v248, 4, v133
v_add_u32 v249, 65536, v248
v_add_u32 v250, 131072, v248
s_lshl_b32 s73, s2, 3
s_add_u32 s73, s73, s40
s_lshl_b32 s80, s73, 10
s_add_u32 s80, s80, 4194304
s_mul_i32 s73, s73, 16
s_add_u32 s73, s73, 1048576
s_mul_i32 s46, s41, 192
s_add_u32 s43, s42, 0
s_mul_i32 s43, s43, 98304
s_add_u32 s68, s43, s46
s_add_u32 s43, s42, 8
s_mul_i32 s43, s43, 98304
s_add_u32 s69, s43, s46
s_add_u32 s43, s42, 16
s_mul_i32 s43, s43, 98304
s_add_u32 s70, s43, s46
s_add_u32 s43, s42, 24
s_mul_i32 s43, s43, 98304
s_add_u32 s71, s43, s46
s_mul_i32 s82, s40, 9216
s_mov_b32 s48, 1156203754
s_mov_b32 s49, 4294508536
s_mov_b32 s76, 400000
v_lshrrev_b32 v148, 5, v251
v_lshlrev_b32 v190, 8, v148
v_bfe_u32 v148, v251, 2, 2
v_lshl_add_u32 v190, v148, 6, v190
v_bfe_u32 v148, v251, 4, 1
v_lshl_add_u32 v190, v148, 5, v190
v_bfe_u32 v148, v251, 0, 1
v_lshl_add_u32 v190, v148, 4, v190
v_bfe_u32 v148, v251, 1, 1
v_lshl_add_u32 v190, v148, 3, v190
v_add_u32 v190, s77, v190
v_add_u32 v191, s77, v248
s_cmp_lt_u32 s40, 4
s_cbranch_scc1 Lnoy
v_lshlrev_b32_e64 v24, 6, v199
s_mov_b32 s43, 1065362610
v_mov_b32 v25, 1084047360
v_add_u32 v0, 32772, v24
v_add_u32 v1, 32780, v24
v_add_u32 v2, 32788, v24
v_add_u32 v3, 32796, v24
v_add_u32 v4, 32804, v24
v_add_u32 v5, 32812, v24
v_add_u32 v6, 32820, v24
v_add_u32 v7, 32828, v24
v_cvt_f32_f16 v0, v0
v_cvt_f32_f16 v1, v1
v_cvt_f32_f16 v2, v2
v_cvt_f32_f16 v3, v3
v_cvt_f32_f16 v4, v4
v_cvt_f32_f16 v5, v5
v_cvt_f32_f16 v6, v6
v_cvt_f32_f16 v7, v7
v_mul_f32 v8, v0, v0
v_mul_f32 v9, v1, v1
v_mul_f32 v10, v2, v2
v_mul_f32 v11, v3, v3
v_mul_f32 v12, v4, v4
v_mul_f32 v13, v5, v5
v_mul_f32 v14, v6, v6
v_mul_f32 v15, v7, v7
v_fma_f32 v8, v8, s43, v25
v_fma_f32 v9, v9, s43, v25
v_fma_f32 v10, v10, s43, v25
v_fma_f32 v11, v11, s43, v25
v_fma_f32 v12, v12, s43, v25
v_fma_f32 v13, v13, s43, v25
v_fma_f32 v14, v14, s43, v25
v_fma_f32 v15, v15, s43, v25
v_mul_f32 v8, v0, v8
v_mul_f32 v9, v1, v9
v_mul_f32 v10, v2, v10
v_mul_f32 v11, v3, v11
v_mul_f32 v12, v4, v12
v_mul_f32 v13, v5, v13
v_mul_f32 v14, v6, v14
v_mul_f32 v15, v7, v15
v_exp_f32 v8, v8
v_exp_f32 v9, v9
v_exp_f32 v10, v10
v_exp_f32 v11, v11
v_exp_f32 v12, v12
v_exp_f32 v13, v13
v_exp_f32 v14, v14
v_exp_f32 v15, v15
v_add_f32 v16, 1.0, v8
v_add_f32 v17, 1.0, v9
v_add_f32 v18, 1.0, v10
v_add_f32 v19, 1.0, v11
v_add_f32 v20, 1.0, v12
v_add_f32 v21, 1.0, v13
v_add_f32 v22, 1.0, v14
v_add_f32 v23, 1.0, v15
v_rcp_f32 v16, v16
v_rcp_f32 v17, v17
v_rcp_f32 v18, v18
v_rcp_f32 v19, v19
v_rcp_f32 v20, v20
v_rcp_f32 v21, v21
v_rcp_f32 v22, v22
v_rcp_f32 v23, v23
v_mul_f32 v0, v0, v16
v_mul_f32 v1, v1, v17
v_mul_f32 v2, v2, v18
v_mul_f32 v3, v3, v19
v_mul_f32 v4, v4, v20
v_mul_f32 v5, v5, v21
v_mul_f32 v6, v6, v22
v_mul_f32 v7, v7, v23
v_mul_f32 v8, v8, v0
v_mul_f32 v9, v9, v1
v_mul_f32 v10, v10, v2
v_mul_f32 v11, v11, v3
v_mul_f32 v12, v12, v4
v_mul_f32 v13, v13, v5
v_mul_f32 v14, v14, v6
v_mul_f32 v15, v15, v7
v_cvt_pk_f16_f32 v28, v0, v1
v_cvt_pk_f16_f32 v32, -v8, -v9
v_cvt_pk_f16_f32 v29, v2, v3
v_cvt_pk_f16_f32 v33, -v10, -v11
v_cvt_pk_f16_f32 v30, v4, v5
v_cvt_pk_f16_f32 v34, -v12, -v13
v_cvt_pk_f16_f32 v31, v6, v7
v_cvt_pk_f16_f32 v35, -v14, -v15
v_lshlrev_b32_e64 v24, 4, v199
v_mov_b32 v25, 163840
s_movk_i32 s43, 496
v_cmp_gt_u32 vcc, s43, v199
s_nop 1
v_cndmask_b32 v24, v25, v24, vcc
ds_write_b128 v24, v[32:35]
ds_write_b128 v24, v[28:31] offset:8192
Lnoy:
s_cmp_ge_u32 s40, 4
s_cbranch_scc1 Lnoo
v_add_u32_e64 v152, 0, v199
v_mul_u32_u24 v140, 683, v152
v_lshrrev_b32 v140, 16, v140
v_mul_u32_u24 v142, 11, v140
v_lshrrev_b32 v142, 5, v142
v_lshrrev_b32 v143, 5, v152
v_bfe_u32 v141, v152, 3, 2
v_bfe_u32 v144, v152, 4, 1
v_xor_b32 v141, v141, v144
v_sub_u32 v141, v141, v142
v_mul_i32_i24 v141, 9, v141
v_add_u32 v143, v143, v141
v_lshrrev_b32_e64 v141, 1, v143
v_mul_u32_u24 v141, 368, v141
v_lshl_add_u32 v143, v143, 3, v141
v_lshl_add_u32 v143, v142, 7, v143
v_and_b32_e64 v144, 7, v152
v_lshl_add_u32 v143, v144, 4, v143
v_add_u32 v156, 156672, v143
v_add_u32 v153, 256, v199
v_mul_u32_u24 v140, 683, v153
v_lshrrev_b32 v140, 16, v140
v_mul_u32_u24 v142, 11, v140
v_lshrrev_b32 v142, 5, v142
v_lshrrev_b32 v143, 5, v153
v_bfe_u32 v141, v153, 3, 2
v_bfe_u32 v144, v153, 4, 1
v_xor_b32 v141, v141, v144
v_sub_u32 v141, v141, v142
v_mul_i32_i24 v141, 9, v141
v_add_u32 v143, v143, v141
v_lshrrev_b32_e64 v141, 1, v143
v_mul_u32_u24 v141, 368, v141
v_lshl_add_u32 v143, v143, 3, v141
v_lshl_add_u32 v143, v142, 7, v143
v_and_b32_e64 v144, 7, v153
v_lshl_add_u32 v143, v144, 4, v143
v_add_u32 v157, 156672, v143
v_add_u32 v154, 512, v199
v_mul_u32_u24 v140, 683, v154
v_lshrrev_b32 v140, 16, v140
v_mul_u32_u24 v142, 11, v140
v_lshrrev_b32 v142, 5, v142
v_lshrrev_b32 v143, 5, v154
v_bfe_u32 v141, v154, 3, 2
v_bfe_u32 v144, v154, 4, 1
v_xor_b32 v141, v141, v144
v_sub_u32 v141, v141, v142
v_mul_i32_i24 v141, 9, v141
v_add_u32 v143, v143, v141
v_lshrrev_b32_e64 v141, 1, v143
v_mul_u32_u24 v141, 368, v141
v_lshl_add_u32 v143, v143, 3, v141
v_lshl_add_u32 v143, v142, 7, v143
v_and_b32_e64 v144, 7, v154
v_lshl_add_u32 v143, v144, 4, v143
v_add_u32 v158, 156672, v143
v_mul_u32_u24 v140, 683, v155
v_lshrrev_b32 v140, 16, v140
v_mul_u32_u24 v142, 11, v140
v_lshrrev_b32 v142, 5, v142
v_lshrrev_b32 v143, 5, v155
v_bfe_u32 v141, v155, 3, 2
v_bfe_u32 v144, v155, 4, 1
v_xor_b32 v141, v141, v144
v_sub_u32 v141, v141, v142
v_mul_i32_i24 v141, 9, v141
v_add_u32 v143, v143, v141
v_lshrrev_b32_e64 v141, 1, v143
v_mul_u32_u24 v141, 368, v141
v_lshl_add_u32 v143, v143, 3, v141
v_lshl_add_u32 v143, v142, 7, v143
v_and_b32_e64 v144, 7, v155
v_lshl_add_u32 v143, v144, 4, v143
v_add_u32 v159, 156672, v143
v_mov_b32 v160, 0
v_mov_b32 v161, 0
v_mov_b32_e64 v162, 0
v_mov_b32 v163, 0
s_mov_b64 exec, 1
ds_write_b128 v253, v[160:163]
ds_write_b128 v253, v[160:163] offset:16
s_mov_b64 exec, -1
s_waitcnt vmcnt(6)
v_and_b32_e64 v130, 4, v152
v_cmp_eq_u32 vcc, 0, v130
s_nop 1
v_cndmask_b32 v164, 0, v126, vcc
v_sub_u32 v165, v126, v164
ds_write_b64 v156, v[164:165]
v_and_b32_e64 v130, 4, v153
v_cmp_eq_u32 vcc, 0, v130
s_nop 1
v_cndmask_b32 v166, 0, v127, vcc
v_sub_u32 v167, v127, v166
ds_write_b64 v157, v[166:167]
v_and_b32_e64 v130, 4, v154
v_cmp_eq_u32 vcc, 0, v130
s_nop 1
v_cndmask_b32 v168, 0, v128, vcc
v_sub_u32 v169, v128, v168
ds_write_b64 v158, v[168:169]
v_and_b32_e64 v130, 4, v155
v_cmp_eq_u32 vcc, 0, v130
s_nop 1
v_cndmask_b32 v170, 0, v129, vcc
v_sub_u32 v171, v129, v170
ds_write_b64 v159, v[170:171]
s_waitcnt lgkmcnt(0)
Lnoo:
s_barrier
s_cmp_lt_u32 s40, 4
s_cbranch_scc1 Lnoy2
v_subrev_u32 v199, 256, v199
v_lshlrev_b32_e64 v24, 6, v199
s_mov_b32 s43, 1065362610
v_mov_b32 v25, 1084047360
v_add_u32 v0, 32772, v24
v_add_u32 v1, 32780, v24
v_add_u32 v2, 32788, v24
v_add_u32 v3, 32796, v24
v_add_u32 v4, 32804, v24
v_add_u32 v5, 32812, v24
v_add_u32 v6, 32820, v24
v_add_u32 v7, 32828, v24
v_cvt_f32_f16 v0, v0
v_cvt_f32_f16 v1, v1
v_cvt_f32_f16 v2, v2
v_cvt_f32_f16 v3, v3
v_cvt_f32_f16 v4, v4
v_cvt_f32_f16 v5, v5
v_cvt_f32_f16 v6, v6
v_cvt_f32_f16 v7, v7
v_mul_f32 v8, v0, v0
v_mul_f32 v9, v1, v1
v_mul_f32 v10, v2, v2
v_mul_f32 v11, v3, v3
v_mul_f32 v12, v4, v4
v_mul_f32 v13, v5, v5
v_mul_f32 v14, v6, v6
v_mul_f32 v15, v7, v7
v_fma_f32 v8, v8, s43, v25
v_fma_f32 v9, v9, s43, v25
v_fma_f32 v10, v10, s43, v25
v_fma_f32 v11, v11, s43, v25
v_fma_f32 v12, v12, s43, v25
v_fma_f32 v13, v13, s43, v25
v_fma_f32 v14, v14, s43, v25
v_fma_f32 v15, v15, s43, v25
v_mul_f32 v8, v0, v8
v_mul_f32 v9, v1, v9
v_mul_f32 v10, v2, v10
v_mul_f32 v11, v3, v11
v_mul_f32 v12, v4, v12
v_mul_f32 v13, v5, v13
v_mul_f32 v14, v6, v14
v_mul_f32 v15, v7, v15
v_exp_f32 v8, v8
v_exp_f32 v9, v9
v_exp_f32 v10, v10
v_exp_f32 v11, v11
v_exp_f32 v12, v12
v_exp_f32 v13, v13
v_exp_f32 v14, v14
v_exp_f32 v15, v15
v_add_f32 v16, 1.0, v8
v_add_f32 v17, 1.0, v9
v_add_f32 v18, 1.0, v10
v_add_f32 v19, 1.0, v11
v_add_f32 v20, 1.0, v12
v_add_f32 v21, 1.0, v13
v_add_f32 v22, 1.0, v14
v_add_f32 v23, 1.0, v15
v_rcp_f32 v16, v16
v_rcp_f32 v17, v17
v_rcp_f32 v18, v18
v_rcp_f32 v19, v19
v_rcp_f32 v20, v20
v_rcp_f32 v21, v21
v_rcp_f32 v22, v22
v_rcp_f32 v23, v23
v_mul_f32 v0, v0, v16
v_mul_f32 v1, v1, v17
v_mul_f32 v2, v2, v18
v_mul_f32 v3, v3, v19
v_mul_f32 v4, v4, v20
v_mul_f32 v5, v5, v21
v_mul_f32 v6, v6, v22
v_mul_f32 v7, v7, v23
v_mul_f32 v8, v8, v0
v_mul_f32 v9, v9, v1
v_mul_f32 v10, v10, v2
v_mul_f32 v11, v11, v3
v_mul_f32 v12, v12, v4
v_mul_f32 v13, v13, v5
v_mul_f32 v14, v14, v6
v_mul_f32 v15, v15, v7
v_cvt_pk_f16_f32 v28, v0, v1
v_cvt_pk_f16_f32 v32, -v8, -v9
v_cvt_pk_f16_f32 v29, v2, v3
v_cvt_pk_f16_f32 v33, -v10, -v11
v_cvt_pk_f16_f32 v30, v4, v5
v_cvt_pk_f16_f32 v34, -v12, -v13
v_cvt_pk_f16_f32 v31, v6, v7
v_cvt_pk_f16_f32 v35, -v14, -v15
v_lshlrev_b32_e64 v24, 4, v199
v_mov_b32 v25, 163840
s_movk_i32 s43, 496
v_cmp_gt_u32 vcc, s43, v199
s_nop 1
v_cndmask_b32 v24, v25, v24, vcc
ds_write_b128 v24, v[32:35]
ds_write_b128 v24, v[28:31] offset:8192
Lnoy2:
s_setprio 2
s_cmp_lt_u32 s40, 4
s_cbranch_scc0 Lsu0
s_call_b64 s[78:79], Lpre
s_call_b64 s[78:79], Lrb
s_waitcnt vmcnt(4)
s_mov_b64 exec, 1
ds_add_u32 v253, v254 offset:28
s_mov_b64 exec, -1
v_mov_b32 v253, 16256
Lsw288w:
ds_read_b32 v247, v253 offset:28
s_waitcnt lgkmcnt(0)
v_readfirstlane_b32 s43, v247
s_cmp_eq_u32 s76, 0
s_cbranch_scc1 Lsw288x
s_sub_u32 s76, s76, 1
s_cmp_lt_u32 s43, 8
s_cbranch_scc0 Lsw288x
s_sleep 2
s_branch Lsw288w
Lsw288x:
s_call_b64 s[78:79], Lconv0
s_mov_b64 exec, 1
ds_add_u32 v253, v254 offset:16
s_mov_b64 exec, -1
s_call_b64 s[78:79], Lln0
s_waitcnt vmcnt(0)
s_mov_b64 exec, 1
ds_add_u32 v253, v254 offset:12
s_mov_b64 exec, -1
s_call_b64 s[78:79], Lw1i
Lsu0:
s_cmp_ge_u32 s40, 4
s_cbranch_scc0 Lsu2
s_setprio 3
s_call_b64 s[78:79], Lw1f
s_waitcnt vmcnt(6)
s_mov_b64 exec, 1
ds_add_u32 v253, v254 offset:28
s_mov_b64 exec, -1
s_call_b64 s[78:79], Lrb
s_waitcnt vmcnt(4)
s_call_b64 s[78:79], Lw1a
s_mov_b64 exec, 1
ds_add_u32 v253, v254 offset:20
s_mov_b64 exec, -1
s_call_b64 s[78:79], Lpre
s_waitcnt vmcnt(0)
s_mov_b64 exec, 1
ds_add_u32 v253, v254 offset:12
s_mov_b64 exec, -1
v_mov_b32 v253, 16256
Lsw128w:
ds_read_b32 v247, v253 offset:12
s_waitcnt lgkmcnt(0)
v_readfirstlane_b32 s43, v247
s_cmp_eq_u32 s76, 0
s_cbranch_scc1 Lsw128x
s_sub_u32 s76, s76, 1
s_cmp_lt_u32 s43, 8
s_cbranch_scc0 Lsw128x
s_sleep 2
s_branch Lsw128w
Lsw128x:
s_call_b64 s[78:79], Lconv0
s_mov_b64 exec, 1
ds_add_u32 v253, v254 offset:16
s_mov_b64 exec, -1
s_call_b64 s[78:79], Lln0
Lsu2:
s_branch Lgo
Lconv0:
ds_read_b128 v[192:195], v242
ds_read_b128 v[196:199], v242 offset:64
ds_read_b128 v[200:203], v242 offset:128
ds_read_b128 v[204:207], v243
ds_read_b128 v[208:211], v243 offset:64
ds_read_b128 v[212:215], v243 offset:128
ds_read_b128 v[224:227], v244
ds_read_b128 v[228:231], v244 offset:64
ds_read_b128 v[232:235], v244 offset:128
v_xor_b32 v242, 16, v242
ds_read_b128 v[236:239], v242
ds_read_b128 v[216:219], v242 offset:64
ds_read_b128 v[220:223], v242 offset:128
s_waitcnt lgkmcnt(11)
v_smfmac_f32_16x16x32_bf16 v[0:3], v[48:49], v[192:195], v246
s_waitcnt lgkmcnt(10)
v_smfmac_f32_16x16x32_bf16 v[16:19], v[50:51], v[196:199], v246
s_waitcnt lgkmcnt(9)
v_smfmac_f32_16x16x32_bf16 v[32:35], v[52:53], v[200:203], v246
s_waitcnt lgkmcnt(8)
v_xor_b32 v243, 16, v243
ds_read_b128 v[192:195], v243
ds_read_b128 v[196:199], v243 offset:64
v_smfmac_f32_16x16x32_bf16 v[0:3], v[54:55], v[204:207], v246
s_waitcnt lgkmcnt(9)
v_smfmac_f32_16x16x32_bf16 v[16:19], v[56:57], v[208:211], v246
s_waitcnt lgkmcnt(8)
ds_read_b128 v[200:203], v243 offset:128
v_xor_b32 v244, 16, v244
ds_read_b128 v[204:207], v244
v_smfmac_f32_16x16x32_bf16 v[32:35], v[58:59], v[212:215], v246
s_waitcnt lgkmcnt(9)
v_smfmac_f32_16x16x32_bf16 v[0:3], v[60:61], v[224:227], v246
s_waitcnt lgkmcnt(8)
ds_read_b128 v[208:211], v244 offset:64
ds_read_b128 v[212:215], v244 offset:128
v_smfmac_f32_16x16x32_bf16 v[16:19], v[62:63], v[228:231], v246
s_waitcnt lgkmcnt(9)
v_smfmac_f32_16x16x32_bf16 v[32:35], v[64:65], v[232:235], v246
s_waitcnt lgkmcnt(8)
v_xor_b32 v242, 32, v242
ds_read_b128 v[224:227], v242
ds_read_b128 v[228:231], v242 offset:64
v_smfmac_f32_16x16x32_bf16 v[4:7], v[66:67], v[236:239], v246
s_waitcnt lgkmcnt(9)
v_smfmac_f32_16x16x32_bf16 v[20:23], v[68:69], v[216:219], v246
s_waitcnt lgkmcnt(8)
ds_read_b128 v[232:235], v242 offset:128
v_xor_b32 v243, 32, v243
ds_read_b128 v[236:239], v243
v_smfmac_f32_16x16x32_bf16 v[36:39], v[70:71], v[220:223], v246
s_waitcnt lgkmcnt(9)
v_smfmac_f32_16x16x32_bf16 v[4:7], v[72:73], v[192:195], v246
s_waitcnt lgkmcnt(8)
ds_read_b128 v[216:219], v243 offset:64
ds_read_b128 v[220:223], v243 offset:128
v_smfmac_f32_16x16x32_bf16 v[20:23], v[74:75], v[196:199], v246
s_waitcnt lgkmcnt(9)
v_smfmac_f32_16x16x32_bf16 v[36:39], v[76:77], v[200:203], v246
s_waitcnt lgkmcnt(8)
v_xor_b32 v244, 32, v244
ds_read_b128 v[192:195], v244
ds_read_b128 v[196:199], v244 offset:64
v_smfmac_f32_16x16x32_bf16 v[4:7], v[78:79], v[204:207], v246
s_waitcnt lgkmcnt(9)
v_smfmac_f32_16x16x32_bf16 v[20:23], v[80:81], v[208:211], v246
s_waitcnt lgkmcnt(8)
ds_read_b128 v[200:203], v244 offset:128
v_xor_b32 v242, 16, v242
ds_read_b128 v[204:207], v242
v_smfmac_f32_16x16x32_bf16 v[36:39], v[82:83], v[212:215], v246
s_waitcnt lgkmcnt(9)
v_smfmac_f32_16x16x32_bf16 v[12:15], v[84:85], v[224:227], v246
s_waitcnt lgkmcnt(8)
ds_read_b128 v[208:211], v242 offset:64
ds_read_b128 v[212:215], v242 offset:128
v_smfmac_f32_16x16x32_bf16 v[28:31], v[86:87], v[228:231], v246
s_waitcnt lgkmcnt(9)
v_smfmac_f32_16x16x32_bf16 v[44:47], v[88:89], v[232:235], v246
s_waitcnt lgkmcnt(8)
v_xor_b32 v243, 16, v243
ds_read_b128 v[224:227], v243
ds_read_b128 v[228:231], v243 offset:64
v_smfmac_f32_16x16x32_bf16 v[12:15], v[90:91], v[236:239], v246
s_waitcnt lgkmcnt(9)
v_smfmac_f32_16x16x32_bf16 v[28:31], v[92:93], v[216:219], v246
s_waitcnt lgkmcnt(8)
ds_read_b128 v[232:235], v243 offset:128
v_xor_b32 v244, 16, v244
ds_read_b128 v[236:239], v244
v_smfmac_f32_16x16x32_bf16 v[44:47], v[94:95], v[220:223], v246
s_waitcnt lgkmcnt(9)
v_smfmac_f32_16x16x32_bf16 v[12:15], v[96:97], v[192:195], v246
s_waitcnt lgkmcnt(8)
ds_read_b128 v[216:219], v244 offset:64
ds_read_b128 v[220:223], v244 offset:128
v_smfmac_f32_16x16x32_bf16 v[28:31], v[98:99], v[196:199], v246
s_waitcnt lgkmcnt(9)
v_smfmac_f32_16x16x32_bf16 v[44:47], v[100:101], v[200:203], v246
s_waitcnt lgkmcnt(8)
v_smfmac_f32_16x16x32_bf16 v[8:11], v[102:103], v[204:207], v246
s_waitcnt lgkmcnt(7)
v_smfmac_f32_16x16x32_bf16 v[24:27], v[104:105], v[208:211], v246
s_waitcnt lgkmcnt(6)
v_smfmac_f32_16x16x32_bf16 v[40:43], v[106:107], v[212:215], v246
s_waitcnt lgkmcnt(5)
v_smfmac_f32_16x16x32_bf16 v[8:11], v[108:109], v[224:227], v246
s_waitcnt lgkmcnt(4)
v_smfmac_f32_16x16x32_bf16 v[24:27], v[110:111], v[228:231], v246
s_waitcnt lgkmcnt(3)
v_smfmac_f32_16x16x32_bf16 v[40:43], v[112:113], v[232:235], v246
s_waitcnt lgkmcnt(2)
v_smfmac_f32_16x16x32_bf16 v[8:11], v[114:115], v[236:239], v246
s_waitcnt lgkmcnt(1)
v_smfmac_f32_16x16x32_bf16 v[24:27], v[116:117], v[216:219], v246
s_waitcnt lgkmcnt(0)
v_smfmac_f32_16x16x32_bf16 v[40:43], v[118:119], v[220:223], v246
s_nop 11
s_setpc_b64 s[78:79]
Lln0:
v_pk_add_f32 v[168:169], v[0:1], v[2:3]
v_pk_mul_f32 v[170:171], v[0:1], v[0:1]
v_pk_fma_f32 v[170:171], v[2:3], v[2:3], v[170:171]
v_pk_add_f32 v[168:169], v[168:169], v[4:5]
v_pk_fma_f32 v[170:171], v[4:5], v[4:5], v[170:171]
v_pk_add_f32 v[168:169], v[168:169], v[6:7]
v_pk_fma_f32 v[170:171], v[6:7], v[6:7], v[170:171]
v_pk_add_f32 v[168:169], v[168:169], v[8:9]
v_pk_fma_f32 v[170:171], v[8:9], v[8:9], v[170:171]
v_pk_add_f32 v[168:169], v[168:169], v[10:11]
v_pk_fma_f32 v[170:171], v[10:11], v[10:11], v[170:171]
v_pk_add_f32 v[168:169], v[168:169], v[12:13]
v_pk_fma_f32 v[170:171], v[12:13], v[12:13], v[170:171]
v_pk_add_f32 v[168:169], v[168:169], v[14:15]
v_pk_fma_f32 v[170:171], v[14:15], v[14:15], v[170:171]
v_pk_add_f32 v[168:169], v[168:169], v[16:17]
v_pk_fma_f32 v[170:171], v[16:17], v[16:17], v[170:171]
v_pk_add_f32 v[168:169], v[168:169], v[18:19]
v_pk_fma_f32 v[170:171], v[18:19], v[18:19], v[170:171]
v_pk_add_f32 v[168:169], v[168:169], v[20:21]
v_pk_fma_f32 v[170:171], v[20:21], v[20:21], v[170:171]
v_pk_add_f32 v[168:169], v[168:169], v[22:23]
v_pk_fma_f32 v[170:171], v[22:23], v[22:23], v[170:171]
v_pk_add_f32 v[168:169], v[168:169], v[24:25]
v_pk_fma_f32 v[170:171], v[24:25], v[24:25], v[170:171]
v_pk_add_f32 v[168:169], v[168:169], v[26:27]
v_pk_fma_f32 v[170:171], v[26:27], v[26:27], v[170:171]
v_pk_add_f32 v[168:169], v[168:169], v[28:29]
v_pk_fma_f32 v[170:171], v[28:29], v[28:29], v[170:171]
v_pk_add_f32 v[168:169], v[168:169], v[30:31]
v_pk_fma_f32 v[170:171], v[30:31], v[30:31], v[170:171]
v_pk_add_f32 v[168:169], v[168:169], v[32:33]
v_pk_fma_f32 v[170:171], v[32:33], v[32:33], v[170:171]
v_pk_add_f32 v[168:169], v[168:169], v[34:35]
v_pk_fma_f32 v[170:171], v[34:35], v[34:35], v[170:171]
v_pk_add_f32 v[168:169], v[168:169], v[36:37]
v_pk_fma_f32 v[170:171], v[36:37], v[36:37], v[170:171]
v_pk_add_f32 v[168:169], v[168:169], v[38:39]
v_pk_fma_f32 v[170:171], v[38:39], v[38:39], v[170:171]
v_pk_add_f32 v[168:169], v[168:169], v[40:41]
v_pk_fma_f32 v[170:171], v[40:41], v[40:41], v[170:171]
v_pk_add_f32 v[168:169], v[168:169], v[42:43]
v_pk_fma_f32 v[170:171], v[42:43], v[42:43], v[170:171]
v_pk_add_f32 v[168:169], v[168:169], v[44:45]
v_pk_fma_f32 v[170:171], v[44:45], v[44:45], v[170:171]
v_pk_add_f32 v[168:169], v[168:169], v[46:47]
v_pk_fma_f32 v[170:171], v[46:47], v[46:47], v[170:171]
v_add_f32 v168, v168, v169
v_add_f32 v170, v170, v171
s_nop 1
v_permlane32_swap_b32 v168, v170
v_add_f32_e64 v168, v168, v170
v_mul_f32 v168, 1009429163, v168
v_mov_b32_e64 v170, v168
s_nop 1
v_permlane32_swap_b32 v168, v170
v_fma_f32 v170, -v168, v168, v170
v_max_f32_e64 v170, 0, v170
v_add_f32 v170, 925353388, v170
v_rsq_f32 v170, v170
s_nop 0
v_mul_f32 v172, 3203391086, v170
v_mul_f32_e64 v173, v168, v172
v_pk_fma_f32 v[0:1], v[0:1], v[172:173], v[172:173] op_sel:[0,0,1] op_sel_hi:[1,0,1] neg_lo:[0,0,1] neg_hi:[0,0,1]
v_pk_fma_f32 v[2:3], v[2:3], v[172:173], v[172:173] op_sel:[0,0,1] op_sel_hi:[1,0,1] neg_lo:[0,0,1] neg_hi:[0,0,1]
v_pk_fma_f32 v[4:5], v[4:5], v[172:173], v[172:173] op_sel:[0,0,1] op_sel_hi:[1,0,1] neg_lo:[0,0,1] neg_hi:[0,0,1]
v_pk_fma_f32 v[6:7], v[6:7], v[172:173], v[172:173] op_sel:[0,0,1] op_sel_hi:[1,0,1] neg_lo:[0,0,1] neg_hi:[0,0,1]
v_pk_fma_f32 v[8:9], v[8:9], v[172:173], v[172:173] op_sel:[0,0,1] op_sel_hi:[1,0,1] neg_lo:[0,0,1] neg_hi:[0,0,1]
v_pk_fma_f32 v[10:11], v[10:11], v[172:173], v[172:173] op_sel:[0,0,1] op_sel_hi:[1,0,1] neg_lo:[0,0,1] neg_hi:[0,0,1]
v_pk_fma_f32 v[12:13], v[12:13], v[172:173], v[172:173] op_sel:[0,0,1] op_sel_hi:[1,0,1] neg_lo:[0,0,1] neg_hi:[0,0,1]
v_pk_fma_f32 v[14:15], v[14:15], v[172:173], v[172:173] op_sel:[0,0,1] op_sel_hi:[1,0,1] neg_lo:[0,0,1] neg_hi:[0,0,1]
v_pk_fma_f32 v[16:17], v[16:17], v[172:173], v[172:173] op_sel:[0,0,1] op_sel_hi:[1,0,1] neg_lo:[0,0,1] neg_hi:[0,0,1]
v_pk_fma_f32 v[18:19], v[18:19], v[172:173], v[172:173] op_sel:[0,0,1] op_sel_hi:[1,0,1] neg_lo:[0,0,1] neg_hi:[0,0,1]
v_pk_fma_f32 v[20:21], v[20:21], v[172:173], v[172:173] op_sel:[0,0,1] op_sel_hi:[1,0,1] neg_lo:[0,0,1] neg_hi:[0,0,1]
v_pk_fma_f32 v[22:23], v[22:23], v[172:173], v[172:173] op_sel:[0,0,1] op_sel_hi:[1,0,1] neg_lo:[0,0,1] neg_hi:[0,0,1]
v_pk_fma_f32 v[24:25], v[24:25], v[172:173], v[172:173] op_sel:[0,0,1] op_sel_hi:[1,0,1] neg_lo:[0,0,1] neg_hi:[0,0,1]
v_pk_fma_f32 v[26:27], v[26:27], v[172:173], v[172:173] op_sel:[0,0,1] op_sel_hi:[1,0,1] neg_lo:[0,0,1] neg_hi:[0,0,1]
v_pk_fma_f32 v[28:29], v[28:29], v[172:173], v[172:173] op_sel:[0,0,1] op_sel_hi:[1,0,1] neg_lo:[0,0,1] neg_hi:[0,0,1]
v_pk_fma_f32 v[30:31], v[30:31], v[172:173], v[172:173] op_sel:[0,0,1] op_sel_hi:[1,0,1] neg_lo:[0,0,1] neg_hi:[0,0,1]
v_pk_fma_f32 v[32:33], v[32:33], v[172:173], v[172:173] op_sel:[0,0,1] op_sel_hi:[1,0,1] neg_lo:[0,0,1] neg_hi:[0,0,1]
v_pk_fma_f32 v[34:35], v[34:35], v[172:173], v[172:173] op_sel:[0,0,1] op_sel_hi:[1,0,1] neg_lo:[0,0,1] neg_hi:[0,0,1]
v_pk_fma_f32 v[36:37], v[36:37], v[172:173], v[172:173] op_sel:[0,0,1] op_sel_hi:[1,0,1] neg_lo:[0,0,1] neg_hi:[0,0,1]
v_pk_fma_f32 v[38:39], v[38:39], v[172:173], v[172:173] op_sel:[0,0,1] op_sel_hi:[1,0,1] neg_lo:[0,0,1] neg_hi:[0,0,1]
v_pk_fma_f32 v[40:41], v[40:41], v[172:173], v[172:173] op_sel:[0,0,1] op_sel_hi:[1,0,1] neg_lo:[0,0,1] neg_hi:[0,0,1]
v_pk_fma_f32 v[42:43], v[42:43], v[172:173], v[172:173] op_sel:[0,0,1] op_sel_hi:[1,0,1] neg_lo:[0,0,1] neg_hi:[0,0,1]
v_pk_fma_f32 v[44:45], v[44:45], v[172:173], v[172:173] op_sel:[0,0,1] op_sel_hi:[1,0,1] neg_lo:[0,0,1] neg_hi:[0,0,1]
v_pk_fma_f32 v[46:47], v[46:47], v[172:173], v[172:173] op_sel:[0,0,1] op_sel_hi:[1,0,1] neg_lo:[0,0,1] neg_hi:[0,0,1]
v_cvt_pk_bf16_f32 v48, v0, v1
v_cvt_pk_bf16_f32 v49, v2, v3
v_cvt_pk_bf16_f32 v50, v4, v5
v_cvt_pk_bf16_f32 v51, v6, v7
v_cvt_pk_bf16_f32 v52, v8, v9
v_cvt_pk_bf16_f32 v53, v10, v11
v_cvt_pk_bf16_f32 v54, v12, v13
v_cvt_pk_bf16_f32 v55, v14, v15
v_cvt_pk_bf16_f32 v56, v16, v17
v_cvt_pk_bf16_f32 v57, v18, v19
v_cvt_pk_bf16_f32 v58, v20, v21
v_cvt_pk_bf16_f32 v59, v22, v23
v_cvt_pk_bf16_f32 v60, v24, v25
v_cvt_pk_bf16_f32 v61, v26, v27
v_cvt_pk_bf16_f32 v62, v28, v29
v_cvt_pk_bf16_f32 v63, v30, v31
v_cvt_pk_bf16_f32 v64, v32, v33
v_cvt_pk_bf16_f32 v65, v34, v35
v_cvt_pk_bf16_f32 v66, v36, v37
v_cvt_pk_bf16_f32 v67, v38, v39
v_cvt_pk_bf16_f32 v68, v40, v41
v_cvt_pk_bf16_f32 v69, v42, v43
v_cvt_pk_bf16_f32 v70, v44, v45
v_cvt_pk_bf16_f32 v71, v46, v47
s_nop 1
s_setpc_b64 s[78:79]
Lw1a:
ds_read_b64_tr_b16 v[148:149], v190
ds_read_b64_tr_b16 v[150:151], v190 offset:512
ds_read_b64_tr_b16 v[152:153], v190 offset:1024
ds_read_b64_tr_b16 v[154:155], v190 offset:1536
ds_read_b64_tr_b16 v[156:157], v190 offset:2048
ds_read_b64_tr_b16 v[158:159], v190 offset:2560
ds_read_b64_tr_b16 v[160:161], v190 offset:3072
ds_read_b64_tr_b16 v[162:163], v190 offset:3584
ds_read_b64_tr_b16 v[164:165], v190 offset:4096
ds_read_b64_tr_b16 v[166:167], v190 offset:4608
ds_read_b64_tr_b16 v[168:169], v190 offset:5120
ds_read_b64_tr_b16 v[170:171], v190 offset:5632
s_waitcnt lgkmcnt(10)
ds_write_b128 v191, v[148:151]
s_waitcnt lgkmcnt(9)
ds_write_b128 v191, v[152:155] offset:1024
s_waitcnt lgkmcnt(8)
ds_write_b128 v191, v[156:159] offset:2048
s_waitcnt lgkmcnt(7)
ds_write_b128 v191, v[160:163] offset:3072
s_waitcnt lgkmcnt(6)
ds_write_b128 v191, v[164:167] offset:4096
s_waitcnt lgkmcnt(5)
ds_write_b128 v191, v[168:171] offset:5120
s_waitcnt lgkmcnt(0)
s_setpc_b64 s[78:79]
Lw1i:
s_add_u32 m0, s77, 24576
s_add_u32 s43, s3, 256
buffer_load_dwordx4 v189, s[12:15], s43 offen lds
s_add_u32 m0, s77, 25600
s_add_u32 s43, s3, 24832
buffer_load_dwordx4 v189, s[12:15], s43 offen lds
s_add_u32 m0, s77, 26624
s_add_u32 s43, s3, 49408
buffer_load_dwordx4 v189, s[12:15], s43 offen lds
s_add_u32 m0, s77, 27648
s_add_u32 s43, s3, 12544
buffer_load_dwordx4 v189, s[12:15], s43 offen lds
s_add_u32 m0, s77, 28672
s_add_u32 s43, s3, 37120
buffer_load_dwordx4 v189, s[12:15], s43 offen lds
s_add_u32 m0, s77, 29696
s_add_u32 s43, s3, 61696
buffer_load_dwordx4 v189, s[12:15], s43 offen lds
s_add_u32 m0, s77, 49152
s_add_u32 s43, s3, 512
buffer_load_dwordx4 v189, s[12:15], s43 offen lds
s_add_u32 m0, s77, 50176
s_add_u32 s43, s3, 25088
buffer_load_dwordx4 v189, s[12:15], s43 offen lds
s_add_u32 m0, s77, 51200
s_add_u32 s43, s3, 49664
buffer_load_dwordx4 v189, s[12:15], s43 offen lds
s_add_u32 m0, s77, 52224
s_add_u32 s43, s3, 12800
buffer_load_dwordx4 v189, s[12:15], s43 offen lds
s_add_u32 m0, s77, 53248
s_add_u32 s43, s3, 37376
buffer_load_dwordx4 v189, s[12:15], s43 offen lds
s_add_u32 m0, s77, 54272
s_add_u32 s43, s3, 61952
buffer_load_dwordx4 v189, s[12:15], s43 offen lds
s_setpc_b64 s[78:79]
Lw1b:
s_waitcnt vmcnt(0)
ds_read_b64_tr_b16 v[72:73], v190 offset:24576
ds_read_b64_tr_b16 v[74:75], v190 offset:25088
ds_read_b64_tr_b16 v[76:77], v190 offset:25600
ds_read_b64_tr_b16 v[78:79], v190 offset:26112
ds_read_b64_tr_b16 v[80:81], v190 offset:26624
ds_read_b64_tr_b16 v[82:83], v190 offset:27136
ds_read_b64_tr_b16 v[84:85], v190 offset:27648
ds_read_b64_tr_b16 v[86:87], v190 offset:28160
ds_read_b64_tr_b16 v[88:89], v190 offset:28672
ds_read_b64_tr_b16 v[90:91], v190 offset:29184
ds_read_b64_tr_b16 v[92:93], v190 offset:29696
ds_read_b64_tr_b16 v[94:95], v190 offset:30208
ds_read_b64_tr_b16 v[96:97], v190 offset:49152
ds_read_b64_tr_b16 v[98:99], v190 offset:49664
ds_read_b64_tr_b16 v[100:101], v190 offset:50176
ds_read_b64_tr_b16 v[102:103], v190 offset:50688
ds_read_b64_tr_b16 v[104:105], v190 offset:51200
ds_read_b64_tr_b16 v[106:107], v190 offset:51712
ds_read_b64_tr_b16 v[108:109], v190 offset:52224
ds_read_b64_tr_b16 v[110:111], v190 offset:52736
ds_read_b64_tr_b16 v[112:113], v190 offset:53248
ds_read_b64_tr_b16 v[114:115], v190 offset:53760
ds_read_b64_tr_b16 v[116:117], v190 offset:54272
ds_read_b64_tr_b16 v[118:119], v190 offset:54784
s_waitcnt lgkmcnt(15)
ds_write_b128 v191, v[72:75] offset:24576
ds_write_b128 v191, v[76:79] offset:25600
ds_write_b128 v191, v[80:83] offset:26624
ds_write_b128 v191, v[84:87] offset:27648
s_waitcnt lgkmcnt(15)
ds_write_b128 v191, v[88:91] offset:28672
ds_write_b128 v191, v[92:95] offset:29696
s_waitcnt lgkmcnt(15)
ds_write_b128 v191, v[96:99] offset:49152
s_waitcnt lgkmcnt(15)
ds_write_b128 v191, v[100:103] offset:50176
s_waitcnt lgkmcnt(14)
ds_write_b128 v191, v[104:107] offset:51200
s_waitcnt lgkmcnt(13)
ds_write_b128 v191, v[108:111] offset:52224
s_waitcnt lgkmcnt(12)
ds_write_b128 v191, v[112:115] offset:53248
s_waitcnt lgkmcnt(11)
ds_write_b128 v191, v[116:119] offset:54272
s_waitcnt lgkmcnt(0)
s_setpc_b64 s[78:79]
Lpre:
ds_read_b128 v[48:51], v245
ds_read_b128 v[52:55], v245 offset:384
ds_read_b128 v[56:59], v245 offset:768
ds_read_b128 v[60:63], v245 offset:1152
ds_read_b128 v[64:67], v245 offset:1536
ds_read_b128 v[68:71], v245 offset:1920
ds_read_b128 v[72:75], v245 offset:2304
ds_read_b128 v[76:79], v245 offset:2688
ds_read_b128 v[80:83], v245 offset:3072
ds_read_b128 v[84:87], v245 offset:3456
ds_read_b128 v[88:91], v245 offset:3840
ds_read_b128 v[92:95], v245 offset:4224
ds_read_b128 v[96:99], v245 offset:4608
ds_read_b128 v[100:103], v245 offset:4992
ds_read_b128 v[104:107], v245 offset:5376
ds_read_b128 v[108:111], v245 offset:5760
ds_read_b128 v[112:115], v245 offset:6144
ds_read_b128 v[116:119], v245 offset:6528
v_mov_b32 v0, 0
v_mov_b32 v1, 0
v_mov_b32 v2, 0
v_mov_b32 v3, 0
v_mov_b32 v4, 0
v_mov_b32 v5, 0
v_mov_b32 v6, 0
v_mov_b32 v7, 0
v_mov_b32 v8, 0
v_mov_b32 v9, 0
v_mov_b32 v10, 0
v_mov_b32 v11, 0
v_mov_b32 v12, 0
v_mov_b32 v13, 0
v_mov_b32 v14, 0
v_mov_b32 v15, 0
v_mov_b32 v16, 0
v_mov_b32 v17, 0
v_mov_b32 v18, 0
v_mov_b32 v19, 0
v_mov_b32 v20, 0
v_mov_b32 v21, 0
v_mov_b32 v22, 0
v_mov_b32 v23, 0
v_mov_b32 v24, 0
v_mov_b32 v25, 0
v_mov_b32 v26, 0
v_mov_b32 v27, 0
v_mov_b32 v28, 0
v_mov_b32 v29, 0
v_mov_b32 v30, 0
v_mov_b32 v31, 0
v_mov_b32 v32, 0
v_mov_b32 v33, 0
v_mov_b32 v34, 0
v_mov_b32 v35, 0
v_mov_b32 v36, 0
v_mov_b32 v37, 0
v_mov_b32 v38, 0
v_mov_b32 v39, 0
v_mov_b32 v40, 0
v_mov_b32 v41, 0
v_mov_b32 v42, 0
v_mov_b32 v43, 0
v_mov_b32 v44, 0
v_mov_b32 v45, 0
v_mov_b32_e64 v46, 0
v_mov_b32 v47, 0
s_waitcnt lgkmcnt(0)
s_setpc_b64 s[78:79]
Lrb:
s_add_u32 m0, s67, 39936
s_add_u32 s45, s66, 491520
buffer_load_dwordx4 v240, s[4:7], s45 offen nt lds
s_add_u32 m0, s67, 46592
s_add_u32 s45, s66, 589824
buffer_load_dwordx4 v240, s[4:7], s45 offen nt lds
s_add_u32 m0, s67, 53248
s_add_u32 s45, s66, 688128
buffer_load_dwordx4 v240, s[4:7], s45 offen nt lds
s_add_u32 m0, s67, 59904
s_add_u32 s45, s66, 786432
buffer_load_dwordx4 v240, s[4:7], s45 offen nt lds
s_setpc_b64 s[78:79]
Lw1f:
s_add_u32 m0, s77, 0
s_add_u32 s43, s3, 0
buffer_load_dwordx4 v189, s[12:15], s43 offen lds
s_add_u32 m0, s77, 1024
s_add_u32 s43, s3, 24576
buffer_load_dwordx4 v189, s[12:15], s43 offen lds
s_add_u32 m0, s77, 2048
s_add_u32 s43, s3, 49152
buffer_load_dwordx4 v189, s[12:15], s43 offen lds
s_add_u32 m0, s77, 3072
s_add_u32 s43, s3, 12288
buffer_load_dwordx4 v189, s[12:15], s43 offen lds
s_add_u32 m0, s77, 4096
s_add_u32 s43, s3, 36864
buffer_load_dwordx4 v189, s[12:15], s43 offen lds
s_add_u32 m0, s77, 5120
s_add_u32 s43, s3, 61440
buffer_load_dwordx4 v189, s[12:15], s43 offen lds
s_setpc_b64 s[78:79]
Lgo:
v_mov_b32 v253, 16256
Lsw204w:
ds_read_b32 v247, v253 offset:20
s_waitcnt lgkmcnt(0)
v_readfirstlane_b32 s43, v247
s_cmp_eq_u32 s76, 0
s_cbranch_scc1 Lsw204x
s_sub_u32 s76, s76, 1
s_cmp_lt_u32 s43, 4
s_cbranch_scc0 Lsw204x
s_sleep 2
s_branch Lsw204w
Lsw204x:
s_cmp_lg_u32 s40, 7
s_cbranch_scc1 Lnopf
s_getpc_b64 s[74:75]
Lpc:
s_lshr_b32 s43, s2, 3
s_and_b32 s43, s43, 15
s_lshl_b32 s43, s43, 13
v_lshlrev_b32 v178, 7, v251
v_add_u32 v178, s43, v178
v_min_u32 v178, Lend-Lpc, v178
global_load_dword v255, v178, s[74:75]
Lnopf:
s_add_u32 s66, s66, 786432
ds_read_b128 v[224:227], v248 offset:16384
ds_read_b128 v[228:231], v248 offset:19456
ds_read_b128 v[232:235], v248 offset:17408
ds_read_b128 v[236:239], v248 offset:20480
ds_read_b128 v[216:219], v248 offset:18432
ds_read_b128 v[220:223], v248 offset:21504
s_setprio 2
s_waitcnt lgkmcnt(5)
v_mfma_f32_32x32x16_bf16 v[120:135], v[48:51], v[224:227], 0
s_waitcnt lgkmcnt(4)
ds_read_b128 v[224:227], v248 offset:22528
v_mfma_f32_32x32x16_bf16 v[120:135], v[52:55], v[228:231], v[120:135]
s_waitcnt lgkmcnt(4)
ds_read_b128 v[228:231], v248 offset:25600
v_mfma_f32_32x32x16_bf16 v[120:135], v[56:59], v[232:235], v[120:135]
s_waitcnt lgkmcnt(4)
ds_read_b128 v[232:235], v248 offset:23552
v_mfma_f32_32x32x16_bf16 v[120:135], v[60:63], v[236:239], v[120:135]
s_waitcnt lgkmcnt(4)
ds_read_b128 v[236:239], v248 offset:26624
v_mfma_f32_32x32x16_bf16 v[120:135], v[64:67], v[216:219], v[120:135]
s_waitcnt lgkmcnt(4)
ds_read_b128 v[216:219], v248 offset:24576
v_mfma_f32_32x32x16_bf16 v[120:135], v[68:71], v[220:223], v[120:135]
v_add_u32 v174, -36864, v242
v_subrev_u32 v175, 66560, v174
v_min_u32 v174, v174, v175
v_add_u32 v174, 90112, v174
v_sub_u32 v175, v174, v242
v_add_u32 v242, v175, v242
v_add_u32_e64 v243, v175, v243
v_add_u32 v244, v175, v244
s_nop 3
v_cvt_pkrtz_f16_f32 v137, v120, v121
v_cvt_pkrtz_f16_f32 v139, v122, v123
v_cvt_pkrtz_f16_f32 v141, v124, v125
v_cvt_pkrtz_f16_f32 v143, v126, v127
v_cvt_pkrtz_f16_f32 v145, v128, v129
v_cvt_pk_f16_f32 v155, v130, v131
v_cvt_pk_f16_f32 v152, v132, v133
v_cvt_pk_f16_f32 v149, v134, v135
s_waitcnt lgkmcnt(1)
ds_read_b128 v[220:223], v248 offset:27648
v_mfma_f32_32x32x16_bf16 v[120:135], v[48:51], v[224:227], 0
v_pk_fma_f16 v154, v155, v155, s48
v_and_b32 v137, s49, v137
v_pk_fma_f16 v151, v152, v152, s48
v_and_b32_e64 v139, s49, v139
v_pk_fma_f16 v148, v149, v149, s48
v_pk_mul_f16 v154, v155, v154
v_bfe_u32 v136, v137, 2, 14
v_pk_mul_f16 v151, v152, v151
v_pk_mul_f16 v148, v149, v148
v_bfe_u32 v138, v139, 2, 14
ds_read_b128 v[224:227], v248 offset:28672
ds_read_u16_d16 v136, v136
ds_read_u16_d16 v138, v138
v_mfma_f32_32x32x16_bf16 v[120:135], v[52:55], v[228:231], v[120:135]
v_exp_f16 v153, v154
v_lshrrev_b32 v137, 18, v137
v_exp_f16 v150, v151
v_lshrrev_b32 v139, 18, v139
v_exp_f16 v147, v148
v_and_b32 v141, s49, v141
v_and_b32_e64 v143, s49, v143
ds_read_b128 v[228:231], v248 offset:31744
ds_read_u16_d16_hi v137, v137
ds_read_u16_d16_hi v139, v139
v_mfma_f32_32x32x16_bf16 v[120:135], v[56:59], v[232:235], v[120:135]
v_exp_f16_sdwa v153, v154 dst_sel:WORD_1 dst_unused:UNUSED_PRESERVE src0_sel:WORD_1
v_bfe_u32 v140, v141, 2, 14
v_exp_f16_sdwa v150, v151 dst_sel:WORD_1 dst_unused:UNUSED_PRESERVE src0_sel:WORD_1
v_bfe_u32 v142, v143, 2, 14
v_exp_f16_sdwa v147, v148 dst_sel:WORD_1 dst_unused:UNUSED_PRESERVE src0_sel:WORD_1
v_lshrrev_b32_e64 v141, 18, v141
v_pk_add_f16 v153, v153, 1.0 op_sel_hi:[1,0]
ds_read_b128 v[232:235], v248 offset:29696
ds_read_u16_d16 v140, v140
ds_read_u16_d16 v142, v142
ds_read_u16_d16_hi v141, v141
v_mfma_f32_32x32x16_bf16 v[120:135], v[60:63], v[236:239], v[120:135]
v_lshrrev_b32_e64 v143, 18, v143
v_pk_add_f16 v150, v150, 1.0 op_sel_hi:[1,0]
v_pk_add_f16 v147, v147, 1.0 op_sel_hi:[1,0]
v_and_b32 v145, s49, v145
v_rcp_f16 v154, v153
v_bfe_u32 v144, v145, 2, 14
v_rcp_f16_e64 v151, v150
v_lshrrev_b32 v145, 18, v145
s_waitcnt lgkmcnt(7)
ds_read_b128 v[236:239], v248 offset:32768
ds_read_u16_d16_hi v143, v143
ds_read_u16_d16 v144, v144
ds_read_u16_d16_hi v145, v145
v_mfma_f32_32x32x16_bf16 v[120:135], v[64:67], v[216:219], v[120:135]
v_rcp_f16_e64 v148, v147
v_rcp_f16_sdwa v154, v153 dst_sel:WORD_1 dst_unused:UNUSED_PRESERVE src0_sel:WORD_1
v_fma_mix_f32 v156, v136, v136, 0 op_sel:[0,0,0] op_sel_hi:[1,1,0]
ds_read_b32 v247, v253 offset:16
s_waitcnt lgkmcnt(9)
v_fma_mix_f32 v156, v137, v137, v156 op_sel:[1,1,0] op_sel_hi:[1,1,0]
v_rcp_f16_sdwa v151, v150 dst_sel:WORD_1 dst_unused:UNUSED_PRESERVE src0_sel:WORD_1
v_fma_mix_f32 v156, v138, v138, v156 op_sel:[0,0,0] op_sel_hi:[1,1,0]
ds_read_b128 v[216:219], v248 offset:30720
v_mfma_f32_32x32x16_bf16 v[120:135], v[68:71], v[220:223], v[120:135]
v_rcp_f16_sdwa v148, v147 dst_sel:WORD_1 dst_unused:UNUSED_PRESERVE src0_sel:WORD_1
v_fma_mix_f32 v156, v139, v139, v156 op_sel:[1,1,0] op_sel_hi:[1,1,0]
v_pk_mul_f16 v155, v155, v154
s_waitcnt lgkmcnt(6)
v_fma_mix_f32 v156, v140, v140, v156 op_sel:[0,0,0] op_sel_hi:[1,1,0]
v_pk_mul_f16 v152, v152, v151
v_fma_mix_f32 v156, v141, v141, v156 op_sel:[1,1,0] op_sel_hi:[1,1,0]
v_pk_mul_f16 v149, v149, v148
v_fma_mix_f32 v156, v155, v155, v156 op_sel:[0,0,0] op_sel_hi:[1,1,0]
v_fma_mix_f32 v156, v142, v142, v156 op_sel:[0,0,0] op_sel_hi:[1,1,0]
v_fma_mix_f32 v156, v155, v155, v156 op_sel:[1,1,0] op_sel_hi:[1,1,0]
s_waitcnt lgkmcnt(4)
v_fma_mix_f32 v156, v143, v143, v156 op_sel:[1,1,0] op_sel_hi:[1,1,0]
v_fma_mix_f32 v156, v152, v152, v156 op_sel:[0,0,0] op_sel_hi:[1,1,0]
v_fma_mix_f32 v156, v152, v152, v156 op_sel:[1,1,0] op_sel_hi:[1,1,0]
s_waitcnt lgkmcnt(2)
v_fma_mix_f32 v156, v144, v144, v156 op_sel:[0,0,0] op_sel_hi:[1,1,0]
v_fma_mix_f32 v156, v149, v149, v156 op_sel:[0,0,0] op_sel_hi:[1,1,0]
v_fma_mix_f32 v156, v145, v145, v156 op_sel:[1,1,0] op_sel_hi:[1,1,0]
v_fma_mix_f32 v156, v149, v149, v156 op_sel:[1,1,0] op_sel_hi:[1,1,0]
s_cmp_lt_u32 s40, 4
s_cbranch_scc0 Lsu5
s_call_b64 s[78:79], Lw1b
s_mov_b64 exec, 1
ds_add_u32 v253, v254 offset:24
s_mov_b64 exec, -1
Lsu5:
s_waitcnt lgkmcnt(0)
v_readfirstlane_b32 s43, v247
s_nop 1
s_cmp_ge_u32 s43, 8
s_cbranch_scc1 Lev1
Lev1w:
s_sleep 1
ds_read_b32 v247, v253 offset:16
s_waitcnt lgkmcnt(0)
v_readfirstlane_b32 s43, v247
s_cmp_eq_u32 s76, 0
s_cbranch_scc1 Lev1
s_sub_u32 s76, s76, 1
s_cmp_lt_u32 s43, 8
s_cbranch_scc1 Lev1w
Lev1:
v_cvt_pkrtz_f16_f32 v137, v120, v121
v_cvt_pkrtz_f16_f32 v139, v122, v123
v_cvt_pkrtz_f16_f32 v141, v124, v125
v_cvt_pkrtz_f16_f32 v143, v126, v127
v_cvt_pkrtz_f16_f32 v145, v128, v129
v_cvt_pk_f16_f32 v155, v130, v131
v_cvt_pk_f16_f32 v152, v132, v133
v_cvt_pk_f16_f32 v149, v134, v135
s_add_u32 m0, s67, 0
s_add_u32 s66, s66, 98304
buffer_load_dwordx4 v240, s[4:7], s66 offen lds
ds_read_b128 v[220:223], v248 offset:33792
v_mfma_f32_32x32x16_bf16 v[120:135], v[48:51], v[224:227], 0
v_pk_fma_f16 v154, v155, v155, s48
v_and_b32 v137, s49, v137
v_pk_fma_f16 v151, v152, v152, s48
v_and_b32_e64 v139, s49, v139
v_pk_fma_f16 v148, v149, v149, s48
v_pk_mul_f16 v154, v155, v154
v_bfe_u32 v136, v137, 2, 14
v_pk_mul_f16 v151, v152, v151
v_pk_mul_f16 v148, v149, v148
v_bfe_u32 v138, v139, 2, 14
s_add_u32 m0, s67, 6656
s_add_u32 s66, s66, 98304
buffer_load_dwordx4 v240, s[4:7], s66 offen lds
ds_read_b128 v[224:227], v248 offset:34816
ds_read_u16_d16 v136, v136
ds_read_u16_d16 v138, v138
v_mfma_f32_32x32x16_bf16 v[120:135], v[52:55], v[228:231], v[120:135]
v_exp_f16 v153, v154
v_lshrrev_b32 v137, 18, v137
v_exp_f16 v150, v151
v_lshrrev_b32 v139, 18, v139
v_exp_f16 v147, v148
v_and_b32 v141, s49, v141
v_and_b32_e64 v143, s49, v143
s_add_u32 m0, s67, 13312
s_add_u32 s66, s66, 98304
buffer_load_dwordx4 v240, s[4:7], s66 offen lds
ds_read_b128 v[228:231], v248 offset:37888
ds_read_u16_d16_hi v137, v137
ds_read_u16_d16_hi v139, v139
v_mfma_f32_32x32x16_bf16 v[120:135], v[56:59], v[232:235], v[120:135]
v_exp_f16_sdwa v153, v154 dst_sel:WORD_1 dst_unused:UNUSED_PRESERVE src0_sel:WORD_1
v_bfe_u32 v140, v141, 2, 14
v_exp_f16_sdwa v150, v151 dst_sel:WORD_1 dst_unused:UNUSED_PRESERVE src0_sel:WORD_1
v_bfe_u32 v142, v143, 2, 14
v_exp_f16_sdwa v147, v148 dst_sel:WORD_1 dst_unused:UNUSED_PRESERVE src0_sel:WORD_1
v_lshrrev_b32_e64 v141, 18, v141
v_pk_add_f16 v153, v153, 1.0 op_sel_hi:[1,0]
s_add_u32 m0, s67, 19968
s_add_u32 s66, s66, 98304
buffer_load_dwordx4 v240, s[4:7], s66 offen lds
s_add_u32 m0, s67, 26624
s_add_u32 s66, s66, 98304
buffer_load_dwordx4 v240, s[4:7], s66 offen lds
ds_read_b128 v[232:235], v248 offset:35840
ds_read_u16_d16 v140, v140
ds_read_u16_d16 v142, v142
ds_read_u16_d16_hi v141, v141
v_mfma_f32_32x32x16_bf16 v[120:135], v[60:63], v[236:239], v[120:135]
v_lshrrev_b32_e64 v143, 18, v143
v_pk_add_f16 v150, v150, 1.0 op_sel_hi:[1,0]
v_pk_add_f16 v147, v147, 1.0 op_sel_hi:[1,0]
v_and_b32 v145, s49, v145
v_rcp_f16 v154, v153
v_bfe_u32 v144, v145, 2, 14
v_rcp_f16 v151, v150
v_lshrrev_b32 v145, 18, v145
s_add_u32 m0, s67, 33280
s_add_u32 s66, s66, 98304
buffer_load_dwordx4 v240, s[4:7], s66 offen lds
ds_read_b128 v[236:239], v248 offset:38912
ds_read_u16_d16_hi v143, v143
ds_read_u16_d16 v144, v144
ds_read_u16_d16_hi v145, v145
v_mfma_f32_32x32x16_bf16 v[120:135], v[64:67], v[216:219], v[120:135]
v_rcp_f16_e64 v148, v147
v_rcp_f16_sdwa v154, v153 dst_sel:WORD_1 dst_unused:UNUSED_PRESERVE src0_sel:WORD_1
s_waitcnt lgkmcnt(8)
v_fma_mix_f32 v157, v136, v136, 0 op_sel:[0,0,0] op_sel_hi:[1,1,0]
v_fma_mix_f32 v157, v137, v137, v157 op_sel:[1,1,0] op_sel_hi:[1,1,0]
v_rcp_f16_sdwa v151, v150 dst_sel:WORD_1 dst_unused:UNUSED_PRESERVE src0_sel:WORD_1
v_fma_mix_f32 v157, v138, v138, v157 op_sel:[0,0,0] op_sel_hi:[1,1,0]
s_add_u32 m0, s67, 39936
s_add_u32 s66, s66, 98304
buffer_load_dwordx4 v240, s[4:7], s66 offen lds
ds_read_b128 v[216:219], v248 offset:36864
v_mfma_f32_32x32x16_bf16 v[120:135], v[68:71], v[220:223], v[120:135]
v_rcp_f16_sdwa v148, v147 dst_sel:WORD_1 dst_unused:UNUSED_PRESERVE src0_sel:WORD_1
v_fma_mix_f32 v157, v139, v139, v157 op_sel:[1,1,0] op_sel_hi:[1,1,0]
v_pk_mul_f16 v155, v155, v154
s_waitcnt lgkmcnt(5)
v_fma_mix_f32 v157, v140, v140, v157 op_sel:[0,0,0] op_sel_hi:[1,1,0]
v_pk_mul_f16 v152, v152, v151
v_fma_mix_f32 v157, v141, v141, v157 op_sel:[1,1,0] op_sel_hi:[1,1,0]
v_pk_mul_f16 v149, v149, v148
v_fma_mix_f32 v157, v155, v155, v157 op_sel:[0,0,0] op_sel_hi:[1,1,0]
v_fma_mix_f32 v157, v142, v142, v157 op_sel:[0,0,0] op_sel_hi:[1,1,0]
v_fma_mix_f32 v157, v155, v155, v157 op_sel:[1,1,0] op_sel_hi:[1,1,0]
s_add_u32 m0, s67, 46592
s_add_u32 s66, s66, 98304
buffer_load_dwordx4 v240, s[4:7], s66 offen lds
s_waitcnt lgkmcnt(1)
v_fma_mix_f32 v157, v143, v143, v157 op_sel:[1,1,0] op_sel_hi:[1,1,0]
v_fma_mix_f32 v157, v152, v152, v157 op_sel:[0,0,0] op_sel_hi:[1,1,0]
v_fma_mix_f32 v157, v152, v152, v157 op_sel:[1,1,0] op_sel_hi:[1,1,0]
v_fma_mix_f32 v157, v144, v144, v157 op_sel:[0,0,0] op_sel_hi:[1,1,0]
v_fma_mix_f32 v157, v149, v149, v157 op_sel:[0,0,0] op_sel_hi:[1,1,0]
v_fma_mix_f32 v157, v145, v145, v157 op_sel:[1,1,0] op_sel_hi:[1,1,0]
v_fma_mix_f32 v157, v149, v149, v157 op_sel:[1,1,0] op_sel_hi:[1,1,0]
s_setprio 1
v_cvt_pkrtz_f16_f32 v137, v120, v121
v_cvt_pkrtz_f16_f32 v139, v122, v123
v_cvt_pkrtz_f16_f32 v141, v124, v125
v_cvt_pkrtz_f16_f32 v143, v126, v127
v_cvt_pkrtz_f16_f32 v145, v128, v129
v_cvt_pk_f16_f32 v155, v130, v131
v_cvt_pk_f16_f32 v152, v132, v133
v_cvt_pk_f16_f32 v149, v134, v135
ds_read_b128 v[220:223], v248 offset:39936
v_mfma_f32_32x32x16_bf16 v[120:135], v[48:51], v[224:227], 0
v_pk_fma_f16 v154, v155, v155, s48
v_and_b32_e64 v137, s49, v137
v_pk_fma_f16 v151, v152, v152, s48
v_and_b32_e64 v139, s49, v139
v_pk_fma_f16 v148, v149, v149, s48
v_pk_mul_f16 v154, v155, v154
v_bfe_u32 v136, v137, 2, 14
v_pk_mul_f16 v151, v152, v151
v_pk_mul_f16 v148, v149, v148
v_bfe_u32 v138, v139, 2, 14
ds_read_u16_d16 v136, v136
ds_read_b32 v247, v253 offset:24
ds_read_u16_d16 v138, v138
v_mfma_f32_32x32x16_bf16 v[120:135], v[52:55], v[228:231], v[120:135]
v_exp_f16 v153, v154
v_lshrrev_b32 v137, 18, v137
v_exp_f16 v150, v151
v_lshrrev_b32 v139, 18, v139
v_exp_f16 v147, v148
v_and_b32 v141, s49, v141
v_and_b32_e64 v143, s49, v143
ds_read_u16_d16_hi v137, v137
ds_read_u16_d16_hi v139, v139
v_mfma_f32_32x32x16_bf16 v[120:135], v[56:59], v[232:235], v[120:135]
v_exp_f16_sdwa v153, v154 dst_sel:WORD_1 dst_unused:UNUSED_PRESERVE src0_sel:WORD_1
v_bfe_u32 v140, v141, 2, 14
v_exp_f16_sdwa v150, v151 dst_sel:WORD_1 dst_unused:UNUSED_PRESERVE src0_sel:WORD_1
v_bfe_u32 v142, v143, 2, 14
v_exp_f16_sdwa v147, v148 dst_sel:WORD_1 dst_unused:UNUSED_PRESERVE src0_sel:WORD_1
v_lshrrev_b32_e64 v141, 18, v141
v_pk_add_f16 v153, v153, 1.0 op_sel_hi:[1,0]
ds_read_u16_d16 v140, v140
ds_read_u16_d16 v142, v142
ds_read_u16_d16_hi v141, v141
s_waitcnt lgkmcnt(6)
v_readfirstlane_b32 s43, v247
s_nop 1
s_cmp_ge_u32 s43, 4
s_cbranch_scc1 Lev2
Lev2w:
s_sleep 1
ds_read_b32 v247, v253 offset:24
s_waitcnt lgkmcnt(0)
v_readfirstlane_b32 s43, v247
s_cmp_eq_u32 s76, 0
s_cbranch_scc1 Lev2
s_sub_u32 s76, s76, 1
s_cmp_lt_u32 s43, 4
s_cbranch_scc1 Lev2w
Lev2:
ds_read_b128 v[224:227], v248 offset:40960
ds_read_b128 v[228:231], v248 offset:44032
ds_read_b128 v[232:235], v248 offset:41984
v_mfma_f32_32x32x16_bf16 v[120:135], v[60:63], v[236:239], v[120:135]
v_lshrrev_b32 v143, 18, v143
v_pk_add_f16 v150, v150, 1.0 op_sel_hi:[1,0]
v_pk_add_f16 v147, v147, 1.0 op_sel_hi:[1,0]
v_and_b32 v145, s49, v145
v_rcp_f16 v154, v153
v_bfe_u32 v144, v145, 2, 14
v_rcp_f16 v151, v150
v_lshrrev_b32 v145, 18, v145
ds_read_b128 v[236:239], v248 offset:45056
ds_read_u16_d16_hi v143, v143
ds_read_u16_d16 v144, v144
ds_read_u16_d16_hi v145, v145
v_mfma_f32_32x32x16_bf16 v[120:135], v[64:67], v[216:219], v[120:135]
v_rcp_f16 v148, v147
v_rcp_f16_sdwa v154, v153 dst_sel:WORD_1 dst_unused:UNUSED_PRESERVE src0_sel:WORD_1
v_fma_mix_f32 v158, v136, v136, 0 op_sel:[0,0,0] op_sel_hi:[1,1,0]
s_waitcnt lgkmcnt(7)
v_fma_mix_f32 v158, v137, v137, v158 op_sel:[1,1,0] op_sel_hi:[1,1,0]
v_rcp_f16_sdwa v151, v150 dst_sel:WORD_1 dst_unused:UNUSED_PRESERVE src0_sel:WORD_1
v_fma_mix_f32 v158, v138, v138, v158 op_sel:[0,0,0] op_sel_hi:[1,1,0]
ds_read_b128 v[216:219], v248 offset:43008
v_mfma_f32_32x32x16_bf16 v[120:135], v[68:71], v[220:223], v[120:135]
v_rcp_f16_sdwa v148, v147 dst_sel:WORD_1 dst_unused:UNUSED_PRESERVE src0_sel:WORD_1
v_fma_mix_f32 v158, v139, v139, v158 op_sel:[1,1,0] op_sel_hi:[1,1,0]
v_pk_mul_f16 v155, v155, v154
v_fma_mix_f32 v158, v140, v140, v158 op_sel:[0,0,0] op_sel_hi:[1,1,0]
v_pk_mul_f16 v152, v152, v151
v_fma_mix_f32 v158, v141, v141, v158 op_sel:[1,1,0] op_sel_hi:[1,1,0]
v_pk_mul_f16 v149, v149, v148
v_fma_mix_f32 v158, v155, v155, v158 op_sel:[0,0,0] op_sel_hi:[1,1,0]
v_fma_mix_f32 v158, v142, v142, v158 op_sel:[0,0,0] op_sel_hi:[1,1,0]
v_fma_mix_f32 v158, v155, v155, v158 op_sel:[1,1,0] op_sel_hi:[1,1,0]
s_waitcnt lgkmcnt(3)
v_fma_mix_f32 v158, v143, v143, v158 op_sel:[1,1,0] op_sel_hi:[1,1,0]
v_fma_mix_f32 v158, v152, v152, v158 op_sel:[0,0,0] op_sel_hi:[1,1,0]
v_fma_mix_f32 v158, v152, v152, v158 op_sel:[1,1,0] op_sel_hi:[1,1,0]
s_waitcnt lgkmcnt(1)
v_fma_mix_f32 v158, v144, v144, v158 op_sel:[0,0,0] op_sel_hi:[1,1,0]
v_fma_mix_f32 v158, v149, v149, v158 op_sel:[0,0,0] op_sel_hi:[1,1,0]
v_fma_mix_f32 v158, v145, v145, v158 op_sel:[1,1,0] op_sel_hi:[1,1,0]
v_fma_mix_f32 v158, v149, v149, v158 op_sel:[1,1,0] op_sel_hi:[1,1,0]
v_cvt_pkrtz_f16_f32 v137, v120, v121
v_cvt_pkrtz_f16_f32 v139, v122, v123
v_cvt_pkrtz_f16_f32 v141, v124, v125
v_cvt_pkrtz_f16_f32 v143, v126, v127
v_cvt_pkrtz_f16_f32 v145, v128, v129
v_cvt_pk_f16_f32 v155, v130, v131
v_cvt_pk_f16_f32 v152, v132, v133
v_cvt_pk_f16_f32 v149, v134, v135
ds_read_b128 v[220:223], v248 offset:46080
v_mfma_f32_32x32x16_bf16 v[120:135], v[48:51], v[224:227], 0
v_pk_fma_f16 v154, v155, v155, s48
v_and_b32_e64 v137, s49, v137
v_pk_fma_f16 v151, v152, v152, s48
v_and_b32_e64 v139, s49, v139
v_pk_fma_f16 v148, v149, v149, s48
v_pk_mul_f16 v154, v155, v154
v_bfe_u32 v136, v137, 2, 14
v_pk_mul_f16 v151, v152, v151
v_pk_mul_f16 v148, v149, v148
v_bfe_u32 v138, v139, 2, 14
ds_read_b128 v[224:227], v248 offset:47104
ds_read_u16_d16 v136, v136
ds_read_u16_d16 v138, v138
v_mfma_f32_32x32x16_bf16 v[120:135], v[52:55], v[228:231], v[120:135]
v_exp_f16 v153, v154
v_lshrrev_b32 v137, 18, v137
v_exp_f16 v150, v151
v_lshrrev_b32 v139, 18, v139
v_exp_f16 v147, v148
v_and_b32 v141, s49, v141
v_and_b32_e64 v143, s49, v143
ds_read_b128 v[228:231], v248 offset:50176
ds_read_u16_d16_hi v137, v137
ds_read_u16_d16_hi v139, v139
v_mfma_f32_32x32x16_bf16 v[120:135], v[56:59], v[232:235], v[120:135]
v_exp_f16_sdwa v153, v154 dst_sel:WORD_1 dst_unused:UNUSED_PRESERVE src0_sel:WORD_1
v_bfe_u32 v140, v141, 2, 14
v_exp_f16_sdwa v150, v151 dst_sel:WORD_1 dst_unused:UNUSED_PRESERVE src0_sel:WORD_1
v_bfe_u32 v142, v143, 2, 14
v_exp_f16_sdwa v147, v148 dst_sel:WORD_1 dst_unused:UNUSED_PRESERVE src0_sel:WORD_1
v_lshrrev_b32_e64 v141, 18, v141
v_pk_add_f16 v153, v153, 1.0 op_sel_hi:[1,0]
ds_read_b128 v[232:235], v248 offset:48128
ds_read_u16_d16 v140, v140
ds_read_u16_d16 v142, v142
ds_read_u16_d16_hi v141, v141
v_mfma_f32_32x32x16_bf16 v[120:135], v[60:63], v[236:239], v[120:135]
v_lshrrev_b32_e64 v143, 18, v143
v_pk_add_f16 v150, v150, 1.0 op_sel_hi:[1,0]
v_pk_add_f16 v147, v147, 1.0 op_sel_hi:[1,0]
v_and_b32 v145, s49, v145
v_rcp_f16 v154, v153
v_bfe_u32 v144, v145, 2, 14
v_rcp_f16_e64 v151, v150
v_lshrrev_b32 v145, 18, v145
s_waitcnt lgkmcnt(7)
ds_read_b128 v[236:239], v248 offset:51200
ds_read_u16_d16_hi v143, v143
ds_read_u16_d16 v144, v144
ds_read_u16_d16_hi v145, v145
v_mfma_f32_32x32x16_bf16 v[120:135], v[64:67], v[216:219], v[120:135]
v_rcp_f16 v148, v147
v_rcp_f16_sdwa v154, v153 dst_sel:WORD_1 dst_unused:UNUSED_PRESERVE src0_sel:WORD_1
v_fma_mix_f32 v159, v136, v136, 0 op_sel:[0,0,0] op_sel_hi:[1,1,0]
s_waitcnt lgkmcnt(8)
v_fma_mix_f32 v159, v137, v137, v159 op_sel:[1,1,0] op_sel_hi:[1,1,0]
v_rcp_f16_sdwa v151, v150 dst_sel:WORD_1 dst_unused:UNUSED_PRESERVE src0_sel:WORD_1
v_fma_mix_f32 v159, v138, v138, v159 op_sel:[0,0,0] op_sel_hi:[1,1,0]
ds_read_b128 v[216:219], v248 offset:49152
v_mfma_f32_32x32x16_bf16 v[120:135], v[68:71], v[220:223], v[120:135]
v_rcp_f16_sdwa v148, v147 dst_sel:WORD_1 dst_unused:UNUSED_PRESERVE src0_sel:WORD_1
v_fma_mix_f32 v159, v139, v139, v159 op_sel:[1,1,0] op_sel_hi:[1,1,0]
s_cmp_eq_u32 s40, 7
s_cbranch_scc1 Lrdy8
s_waitcnt vmcnt(0)
Lrdy8:
s_mov_b64 exec, 1
ds_add_u32 v253, v254 offset:12
s_mov_b64 exec, -1
v_pk_mul_f16 v155, v155, v154
s_waitcnt lgkmcnt(6)
v_fma_mix_f32 v159, v140, v140, v159 op_sel:[0,0,0] op_sel_hi:[1,1,0]
v_pk_mul_f16 v152, v152, v151
v_fma_mix_f32 v159, v141, v141, v159 op_sel:[1,1,0] op_sel_hi:[1,1,0]
v_pk_mul_f16 v149, v149, v148
v_fma_mix_f32 v159, v155, v155, v159 op_sel:[0,0,0] op_sel_hi:[1,1,0]
v_fma_mix_f32 v159, v142, v142, v159 op_sel:[0,0,0] op_sel_hi:[1,1,0]
v_fma_mix_f32 v159, v155, v155, v159 op_sel:[1,1,0] op_sel_hi:[1,1,0]
s_waitcnt lgkmcnt(2)
v_fma_mix_f32 v159, v143, v143, v159 op_sel:[1,1,0] op_sel_hi:[1,1,0]
v_fma_mix_f32 v159, v152, v152, v159 op_sel:[0,0,0] op_sel_hi:[1,1,0]
v_fma_mix_f32 v159, v152, v152, v159 op_sel:[1,1,0] op_sel_hi:[1,1,0]
v_fma_mix_f32 v159, v144, v144, v159 op_sel:[0,0,0] op_sel_hi:[1,1,0]
v_fma_mix_f32 v159, v149, v149, v159 op_sel:[0,0,0] op_sel_hi:[1,1,0]
v_fma_mix_f32 v159, v145, v145, v159 op_sel:[1,1,0] op_sel_hi:[1,1,0]
v_fma_mix_f32 v159, v149, v149, v159 op_sel:[1,1,0] op_sel_hi:[1,1,0]
v_cvt_pkrtz_f16_f32 v137, v120, v121
v_cvt_pkrtz_f16_f32 v139, v122, v123
v_cvt_pkrtz_f16_f32 v141, v124, v125
v_cvt_pkrtz_f16_f32 v143, v126, v127
v_cvt_pkrtz_f16_f32 v145, v128, v129
v_cvt_pk_f16_f32 v155, v130, v131
v_cvt_pk_f16_f32 v152, v132, v133
v_cvt_pk_f16_f32 v149, v134, v135
s_setprio 0
ds_read_b128 v[220:223], v248 offset:52224
v_mfma_f32_32x32x16_bf16 v[120:135], v[48:51], v[224:227], 0
v_pk_fma_f16 v154, v155, v155, s48
v_and_b32_e64 v137, s49, v137
v_pk_fma_f16 v151, v152, v152, s48
v_and_b32_e64 v139, s49, v139
v_pk_fma_f16 v148, v149, v149, s48
v_pk_mul_f16 v154, v155, v154
v_bfe_u32 v136, v137, 2, 14
v_pk_mul_f16 v151, v152, v151
v_pk_mul_f16 v148, v149, v148
v_bfe_u32 v138, v139, 2, 14
ds_read_b128 v[224:227], v250 offset:65520
ds_read_u16_d16 v136, v136
ds_read_u16_d16 v138, v138
v_mfma_f32_32x32x16_bf16 v[120:135], v[52:55], v[228:231], v[120:135]
v_exp_f16 v153, v154
v_lshrrev_b32 v137, 18, v137
v_exp_f16 v150, v151
v_lshrrev_b32 v139, 18, v139
v_exp_f16 v147, v148
v_and_b32 v141, s49, v141
v_and_b32_e64 v143, s49, v143
ds_read_b128 v[228:231], v248 offset:53248
ds_read_u16_d16_hi v137, v137
ds_read_b32 v247, v253 offset:12
ds_read_u16_d16_hi v139, v139
v_mfma_f32_32x32x16_bf16 v[120:135], v[56:59], v[232:235], v[120:135]
v_exp_f16_sdwa v153, v154 dst_sel:WORD_1 dst_unused:UNUSED_PRESERVE src0_sel:WORD_1
v_bfe_u32 v140, v141, 2, 14
v_exp_f16_sdwa v150, v151 dst_sel:WORD_1 dst_unused:UNUSED_PRESERVE src0_sel:WORD_1
v_bfe_u32 v142, v143, 2, 14
v_exp_f16_sdwa v147, v148 dst_sel:WORD_1 dst_unused:UNUSED_PRESERVE src0_sel:WORD_1
v_lshrrev_b32_e64 v141, 18, v141
v_pk_add_f16 v153, v153, 1.0 op_sel_hi:[1,0]
ds_read_b128 v[232:235], v248 offset:56320
ds_read_u16_d16 v140, v140
ds_read_u16_d16 v142, v142
ds_read_u16_d16_hi v141, v141
v_mfma_f32_32x32x16_bf16 v[120:135], v[60:63], v[236:239], v[120:135]
v_lshrrev_b32_e64 v143, 18, v143
v_pk_add_f16 v150, v150, 1.0 op_sel_hi:[1,0]
v_pk_add_f16 v147, v147, 1.0 op_sel_hi:[1,0]
v_and_b32 v145, s49, v145
v_rcp_f16 v154, v153
v_bfe_u32 v144, v145, 2, 14
ds_read_u16_d16_hi v143, v143
ds_read_u16_d16 v144, v144
s_waitcnt lgkmcnt(7)
v_readfirstlane_b32 s43, v247
s_nop 1
s_cmp_ge_u32 s43, 16
s_cbranch_scc1 Lev3
Lev3w:
s_sleep 1
ds_read_b32 v247, v253 offset:12
s_waitcnt lgkmcnt(0)
v_readfirstlane_b32 s43, v247
s_cmp_eq_u32 s76, 0
s_cbranch_scc1 Lev3
s_sub_u32 s76, s76, 1
s_cmp_lt_u32 s43, 16
s_cbranch_scc1 Lev3w
Lev3:
v_rcp_f16 v151, v150
v_lshrrev_b32_e64 v145, 18, v145
ds_read_b128 v[236:239], v245 offset:6528
ds_read_b128 v[192:195], v244 offset:128
ds_read_b128 v[196:199], v244 offset:64
ds_read_u16_d16_hi v145, v145
v_mfma_f32_32x32x16_bf16 v[120:135], v[64:67], v[216:219], v[120:135]
v_rcp_f16 v148, v147
v_rcp_f16_sdwa v154, v153 dst_sel:WORD_1 dst_unused:UNUSED_PRESERVE src0_sel:WORD_1
v_fma_mix_f32 v160, v136, v136, 0 op_sel:[0,0,0] op_sel_hi:[1,1,0]
v_fma_mix_f32 v160, v137, v137, v160 op_sel:[1,1,0] op_sel_hi:[1,1,0]
v_rcp_f16_sdwa v151, v150 dst_sel:WORD_1 dst_unused:UNUSED_PRESERVE src0_sel:WORD_1
v_fma_mix_f32 v160, v138, v138, v160 op_sel:[0,0,0] op_sel_hi:[1,1,0]
ds_read_b128 v[216:219], v248 offset:54272
v_mfma_f32_32x32x16_bf16 v[120:135], v[68:71], v[220:223], v[120:135]
v_rcp_f16_sdwa v148, v147 dst_sel:WORD_1 dst_unused:UNUSED_PRESERVE src0_sel:WORD_1
s_waitcnt lgkmcnt(5)
v_fma_mix_f32 v160, v139, v139, v160 op_sel:[1,1,0] op_sel_hi:[1,1,0]
v_pk_mul_f16 v155, v155, v154
v_fma_mix_f32 v160, v140, v140, v160 op_sel:[0,0,0] op_sel_hi:[1,1,0]
v_pk_mul_f16 v152, v152, v151
v_fma_mix_f32 v160, v141, v141, v160 op_sel:[1,1,0] op_sel_hi:[1,1,0]
v_pk_mul_f16 v149, v149, v148
v_fma_mix_f32 v160, v155, v155, v160 op_sel:[0,0,0] op_sel_hi:[1,1,0]
v_fma_mix_f32 v160, v142, v142, v160 op_sel:[0,0,0] op_sel_hi:[1,1,0]
v_fma_mix_f32 v160, v155, v155, v160 op_sel:[1,1,0] op_sel_hi:[1,1,0]
v_fma_mix_f32 v160, v143, v143, v160 op_sel:[1,1,0] op_sel_hi:[1,1,0]
v_fma_mix_f32 v160, v152, v152, v160 op_sel:[0,0,0] op_sel_hi:[1,1,0]
v_fma_mix_f32 v160, v152, v152, v160 op_sel:[1,1,0] op_sel_hi:[1,1,0]
v_fma_mix_f32 v160, v144, v144, v160 op_sel:[0,0,0] op_sel_hi:[1,1,0]
v_fma_mix_f32 v160, v149, v149, v160 op_sel:[0,0,0] op_sel_hi:[1,1,0]
s_waitcnt lgkmcnt(1)
v_fma_mix_f32 v160, v145, v145, v160 op_sel:[1,1,0] op_sel_hi:[1,1,0]
v_fma_mix_f32 v160, v149, v149, v160 op_sel:[1,1,0] op_sel_hi:[1,1,0]
s_setprio 2
v_mfma_f32_32x32x16_bf16 v[0:15], v[224:227], v[224:227], 0
ds_read_b128 v[220:223], v245 offset:6144
ds_read_b128 v[200:203], v244
ds_read_b128 v[204:207], v243 offset:128
v_cvt_pkrtz_f16_f32 v137, v120, v121
v_cvt_pkrtz_f16_f32 v139, v122, v123
v_cvt_pkrtz_f16_f32 v141, v124, v125
v_mfma_f32_32x32x16_bf16 v[16:31], v[224:227], v[224:227], 0
v_cvt_pkrtz_f16_f32 v143, v126, v127
v_cvt_pkrtz_f16_f32 v145, v128, v129
v_cvt_pk_f16_f32 v155, v130, v131
v_mfma_f32_32x32x16_bf16 v[32:47], v[224:227], v[224:227], 0
v_cvt_pk_f16_f32 v152, v132, v133
v_cvt_pk_f16_f32 v149, v134, v135
v_pk_fma_f16 v154, v155, v155, s48
v_mfma_f32_32x32x16_bf16 v[120:135], v[48:51], v[228:231], 0
ds_read_b128 v[224:227], v248 offset:57344
v_and_b32_e64 v137, s49, v137
v_pk_fma_f16 v151, v152, v152, s48
v_and_b32_e64 v139, s49, v139
v_pk_fma_f16 v148, v149, v149, s48
v_pk_mul_f16 v154, v155, v154
v_bfe_u32 v136, v137, 2, 14
v_mfma_f32_32x32x16_bf16 v[120:135], v[52:55], v[232:235], v[120:135]
ds_read_b128 v[228:231], v245 offset:5760
ds_read_b128 v[208:211], v243 offset:64
ds_read_b128 v[212:215], v243
ds_read_u16_d16 v136, v136
v_pk_mul_f16 v151, v152, v151
v_pk_mul_f16 v148, v149, v148
v_bfe_u32 v138, v139, 2, 14
v_exp_f16 v153, v154
v_lshrrev_b32 v137, 18, v137
v_smfmac_f32_16x16x32_bf16 v[40:43], v[238:239], v[192:195], v246
ds_read_b128 v[232:235], v248 offset:55296
ds_read_u16_d16 v138, v138
ds_read_u16_d16_hi v137, v137
v_exp_f16 v150, v151
v_lshrrev_b32 v139, 18, v139
v_smfmac_f32_16x16x32_bf16 v[24:27], v[236:237], v[196:199], v246
v_exp_f16_e64 v147, v148
v_and_b32 v141, s49, v141
s_waitcnt lgkmcnt(7)
v_mfma_f32_32x32x16_bf16 v[120:135], v[56:59], v[216:219], v[120:135]
ds_read_b128 v[236:239], v245 offset:5376
ds_read_b128 v[192:195], v242 offset:128
ds_read_b128 v[196:199], v242 offset:64
ds_read_u16_d16_hi v139, v139
v_and_b32_e64 v143, s49, v143
v_exp_f16_sdwa v153, v154 dst_sel:WORD_1 dst_unused:UNUSED_PRESERVE src0_sel:WORD_1
v_bfe_u32 v140, v141, 2, 14
v_exp_f16_sdwa v150, v151 dst_sel:WORD_1 dst_unused:UNUSED_PRESERVE src0_sel:WORD_1
v_smfmac_f32_16x16x32_bf16 v[8:11], v[222:223], v[200:203], v246
ds_read_b128 v[216:219], v248 offset:58368
ds_read_u16_d16 v140, v140
v_bfe_u32 v142, v143, 2, 14
v_exp_f16_sdwa v147, v148 dst_sel:WORD_1 dst_unused:UNUSED_PRESERVE src0_sel:WORD_1
v_smfmac_f32_16x16x32_bf16 v[40:43], v[220:221], v[204:207], v246
v_lshrrev_b32_e64 v141, 18, v141
v_pk_add_f16 v153, v153, 1.0 op_sel_hi:[1,0]
v_lshrrev_b32 v143, 18, v143
v_mfma_f32_32x32x16_bf16 v[120:135], v[60:63], v[224:227], v[120:135]
ds_read_b128 v[220:223], v245 offset:4992
ds_read_b128 v[200:203], v242
v_xor_b32 v244, 16, v244
ds_read_b128 v[204:207], v244 offset:128
ds_read_u16_d16 v142, v142
ds_read_u16_d16_hi v141, v141
ds_read_u16_d16_hi v143, v143
v_pk_add_f16 v150, v150, 1.0 op_sel_hi:[1,0]
v_pk_add_f16 v147, v147, 1.0 op_sel_hi:[1,0]
v_and_b32_e64 v145, s49, v145
v_rcp_f16 v154, v153
v_bfe_u32 v144, v145, 2, 14
s_waitcnt lgkmcnt(8)
v_smfmac_f32_16x16x32_bf16 v[24:27], v[230:231], v[208:211], v246
ds_read_b128 v[224:227], v245 offset:4608
ds_read_u16_d16 v144, v144
v_rcp_f16 v151, v150
v_lshrrev_b32 v145, 18, v145
v_smfmac_f32_16x16x32_bf16 v[8:11], v[228:229], v[212:215], v246
v_rcp_f16_e64 v148, v147
v_mfma_f32_32x32x16_bf16 v[120:135], v[64:67], v[232:235], v[120:135]
ds_read_b128 v[208:211], v244 offset:64
ds_read_b128 v[212:215], v244
ds_read_b128 v[228:231], v248 offset:59392
ds_read_u16_d16_hi v145, v145
v_rcp_f16_sdwa v154, v153 dst_sel:WORD_1 dst_unused:UNUSED_PRESERVE src0_sel:WORD_1
v_fma_mix_f32 v161, v136, v136, 0 op_sel:[0,0,0] op_sel_hi:[1,1,0]
v_fma_mix_f32 v161, v137, v137, v161 op_sel:[1,1,0] op_sel_hi:[1,1,0]
v_rcp_f16_sdwa v151, v150 dst_sel:WORD_1 dst_unused:UNUSED_PRESERVE src0_sel:WORD_1
v_fma_mix_f32 v161, v138, v138, v161 op_sel:[0,0,0] op_sel_hi:[1,1,0]
v_smfmac_f32_16x16x32_bf16 v[40:43], v[238:239], v[192:195], v246
ds_read_b128 v[232:235], v248 offset:62464
v_rcp_f16_sdwa v148, v147 dst_sel:WORD_1 dst_unused:UNUSED_PRESERVE src0_sel:WORD_1
v_fma_mix_f32 v161, v139, v139, v161 op_sel:[1,1,0] op_sel_hi:[1,1,0]
v_smfmac_f32_16x16x32_bf16 v[24:27], v[236:237], v[196:199], v246
v_pk_mul_f16 v155, v155, v154
s_waitcnt lgkmcnt(7)
v_fma_mix_f32 v161, v140, v140, v161 op_sel:[0,0,0] op_sel_hi:[1,1,0]
v_pk_mul_f16 v152, v152, v151
v_mfma_f32_32x32x16_bf16 v[120:135], v[68:71], v[216:219], v[120:135]
ds_read_b128 v[236:239], v248 offset:60416
v_fma_mix_f32 v161, v141, v141, v161 op_sel:[1,1,0] op_sel_hi:[1,1,0]
v_pk_mul_f16 v149, v149, v148
v_fma_mix_f32 v161, v155, v155, v161 op_sel:[0,0,0] op_sel_hi:[1,1,0]
v_fma_mix_f32 v161, v142, v142, v161 op_sel:[0,0,0] op_sel_hi:[1,1,0]
v_fma_mix_f32 v161, v155, v155, v161 op_sel:[1,1,0] op_sel_hi:[1,1,0]
v_fma_mix_f32 v161, v143, v143, v161 op_sel:[1,1,0] op_sel_hi:[1,1,0]
v_smfmac_f32_16x16x32_bf16 v[8:11], v[222:223], v[200:203], v246
ds_read_b128 v[216:219], v245 offset:4224
v_xor_b32 v243, 16, v243
ds_read_b128 v[192:195], v243 offset:128
ds_read_b128 v[196:199], v243 offset:64
v_fma_mix_f32 v161, v152, v152, v161 op_sel:[0,0,0] op_sel_hi:[1,1,0]
v_fma_mix_f32 v161, v152, v152, v161 op_sel:[1,1,0] op_sel_hi:[1,1,0]
s_waitcnt lgkmcnt(5)
v_fma_mix_f32 v161, v144, v144, v161 op_sel:[0,0,0] op_sel_hi:[1,1,0]
v_smfmac_f32_16x16x32_bf16 v[44:47], v[220:221], v[204:207], v246
v_fma_mix_f32 v161, v149, v149, v161 op_sel:[0,0,0] op_sel_hi:[1,1,0]
v_fma_mix_f32 v161, v145, v145, v161 op_sel:[1,1,0] op_sel_hi:[1,1,0]
v_fma_mix_f32 v161, v149, v149, v161 op_sel:[1,1,0] op_sel_hi:[1,1,0]
s_cmp_lg_u32 s40, 7
s_cbranch_scc1 Lnosent
v_mov_b32 v180, -1
v_mov_b32 v181, -1
v_mov_b32 v182, -1
v_mov_b32 v183, -1
v_lshlrev_b32 v176, 12, v251
v_add_u32 v177, 262144, v176
v_cmp_gt_u32 vcc, 32, v251
v_mov_b32 v178, 2147483648
s_nop 0
v_cndmask_b32 v177, v178, v177, vcc
s_lshl_b32 s43, s2, 4
buffer_store_dwordx4 v[180:183], v176, s[32:35], s43 offen sc1
buffer_store_dwordx4 v[180:183], v177, s[32:35], s43 offen sc1
s_add_u32 s43, s43, 393216
s_cmp_lt_u32 s2, 96
s_cselect_b32 s43, s43, 1073741824
v_lshlrev_b32_e64 v178, 11, v251
s_mov_b64 exec, 0xff
buffer_store_dwordx4 v[180:183], v178, s[32:35], s43 offen sc1
s_mov_b64 exec, -1
s_sub_u32 s43, s2, 96
s_cmp_lt_u32 s43, 96
s_cbranch_scc0 Lnobias
s_lshl_b32 s44, s43, 1
v_mul_u32_u24 v176, 192, v251
v_lshlrev_b32 v177, 1, v251
s_add_u32 s45, s44, 0
buffer_load_ushort v178, v176, s[16:19], s45 offen
buffer_load_ushort v184, v177, s[28:31], 0 offen offset:0
s_add_u32 s45, s44, 12288
buffer_load_ushort v179, v176, s[16:19], s45 offen
buffer_load_ushort v185, v177, s[28:31], 0 offen offset:128
s_add_u32 s45, s44, 24576
buffer_load_ushort v180, v176, s[16:19], s45 offen
buffer_load_ushort v186, v177, s[28:31], 0 offen offset:256
s_add_u32 s45, s44, 36864
buffer_load_ushort v181, v176, s[16:19], s45 offen
buffer_load_ushort v187, v177, s[28:31], 0 offen offset:384
s_add_u32 s45, s44, 49152
buffer_load_ushort v182, v176, s[16:19], s45 offen
buffer_load_ushort v188, v177, s[28:31], 0 offen offset:512
s_add_u32 s45, s44, 61440
buffer_load_ushort v183, v176, s[16:19], s45 offen
buffer_load_ushort v189, v177, s[28:31], 0 offen offset:640
Lnobias:
s_nop 1
Lnosent:
s_setprio 1
v_smfmac_f32_16x16x32_bf16 v[28:31], v[226:227], v[208:211], v246
ds_read_b128 v[220:223], v248 offset:63488
v_cvt_pkrtz_f16_f32 v137, v120, v121
v_cvt_pkrtz_f16_f32 v139, v122, v123
v_cvt_pkrtz_f16_f32 v141, v124, v125
v_cvt_pkrtz_f16_f32 v143, v126, v127
v_smfmac_f32_16x16x32_bf16 v[12:15], v[224:225], v[212:215], v246
v_cvt_pk_f16_f32 v155, v128, v129
v_cvt_pk_f16_f32 v152, v130, v131
v_cvt_pk_f16_f32 v149, v132, v133
v_cvt_pk_f16_f32 v146, v134, v135
v_mfma_f32_32x32x16_bf16 v[120:135], v[48:51], v[228:231], 0
ds_read_b128 v[224:227], v248 offset:61440
v_pk_fma_f16 v154, v155, v155, s48
v_and_b32_e64 v137, s49, v137
v_pk_fma_f16 v151, v152, v152, s48
v_pk_fma_f16 v148, v149, v149, s48
v_and_b32_e64 v139, s49, v139
v_pk_fma_f16 v145, v146, v146, s48
v_pk_mul_f16 v154, v155, v154
v_bfe_u32 v136, v137, 2, 14
s_waitcnt lgkmcnt(2)
v_mfma_f32_32x32x16_bf16 v[120:135], v[52:55], v[232:235], v[120:135]
ds_read_b128 v[228:231], v245 offset:3840
ds_read_b128 v[200:203], v243
v_xor_b32 v242, 16, v242
ds_read_b128 v[204:207], v242 offset:128
ds_read_u16_d16 v136, v136
v_pk_mul_f16 v151, v152, v151
v_pk_mul_f16 v148, v149, v148
v_bfe_u32 v138, v139, 2, 14
v_pk_mul_f16 v145, v146, v145
v_exp_f16 v153, v154
v_lshrrev_b32 v137, 18, v137
v_exp_f16_e64 v150, v151
v_mfma_f32_32x32x16_bf16 v[120:135], v[56:59], v[236:239], v[120:135]
ds_read_b128 v[232:235], v248 offset:64512
ds_read_u16_d16 v138, v138
ds_read_u16_d16_hi v137, v137
v_lshrrev_b32 v139, 18, v139
v_exp_f16 v147, v148
v_and_b32 v141, s49, v141
v_exp_f16 v144, v145
v_and_b32_e64 v143, s49, v143
v_smfmac_f32_16x16x32_bf16 v[44:47], v[218:219], v[192:195], v246
ds_read_b128 v[236:239], v245 offset:3456
ds_read_b128 v[208:211], v242 offset:64
ds_read_b128 v[212:215], v242
ds_read_u16_d16_hi v139, v139
v_exp_f16_sdwa v153, v154 dst_sel:WORD_1 dst_unused:UNUSED_PRESERVE src0_sel:WORD_1
v_bfe_u32 v140, v141, 2, 14
v_exp_f16_sdwa v150, v151 dst_sel:WORD_1 dst_unused:UNUSED_PRESERVE src0_sel:WORD_1
v_smfmac_f32_16x16x32_bf16 v[28:31], v[216:217], v[196:199], v246
v_bfe_u32 v142, v143, 2, 14
v_exp_f16_sdwa v147, v148 dst_sel:WORD_1 dst_unused:UNUSED_PRESERVE src0_sel:WORD_1
v_lshrrev_b32_e64 v141, 18, v141
s_waitcnt lgkmcnt(7)
v_mfma_f32_32x32x16_bf16 v[120:135], v[60:63], v[220:223], v[120:135]
ds_read_b128 v[216:219], v245 offset:3072
v_xor_b32 v244, 32, v244
ds_read_b128 v[192:195], v244 offset:128
ds_read_b128 v[196:199], v244 offset:64
ds_read_u16_d16 v140, v140
ds_read_u16_d16 v142, v142
ds_read_u16_d16_hi v141, v141
v_exp_f16_sdwa v144, v145 dst_sel:WORD_1 dst_unused:UNUSED_PRESERVE src0_sel:WORD_1
v_lshrrev_b32_e64 v143, 18, v143
v_pk_add_f16 v153, v153, 1.0 op_sel_hi:[1,0]
v_pk_add_f16 v150, v150, 1.0 op_sel_hi:[1,0]
v_pk_add_f16 v147, v147, 1.0 op_sel_hi:[1,0]
v_pk_add_f16 v144, v144, 1.0 op_sel_hi:[1,0]
v_rcp_f16_e64 v154, v153
v_mfma_f32_32x32x16_bf16 v[120:135], v[64:67], v[224:227], v[120:135]
ds_read_b128 v[220:223], v249
ds_read_u16_d16_hi v143, v143
v_rcp_f16 v151, v150
v_rcp_f16 v148, v147
v_rcp_f16_e64 v145, v144
v_rcp_f16_sdwa v154, v153 dst_sel:WORD_1 dst_unused:UNUSED_PRESERVE src0_sel:WORD_1
v_smfmac_f32_16x16x32_bf16 v[12:15], v[230:231], v[200:203], v246
ds_read_b128 v[224:227], v249 offset:3072
v_rcp_f16_sdwa v151, v150 dst_sel:WORD_1 dst_unused:UNUSED_PRESERVE src0_sel:WORD_1
s_setprio 0
v_rcp_f16_sdwa v148, v147 dst_sel:WORD_1 dst_unused:UNUSED_PRESERVE src0_sel:WORD_1
v_fma_mix_f32 v162, v136, v136, 0 op_sel:[0,0,0] op_sel_hi:[1,1,0]
v_smfmac_f32_16x16x32_bf16 v[44:47], v[228:229], v[204:207], v246
v_rcp_f16_sdwa v145, v144 dst_sel:WORD_1 dst_unused:UNUSED_PRESERVE src0_sel:WORD_1
s_waitcnt lgkmcnt(5)
v_fma_mix_f32 v162, v137, v137, v162 op_sel:[1,1,0] op_sel_hi:[1,1,0]
v_pk_mul_f16 v155, v155, v154
v_mfma_f32_32x32x16_bf16 v[120:135], v[68:71], v[232:235], v[120:135]
ds_read_b128 v[228:231], v245 offset:2688
ds_read_b128 v[200:203], v244
v_xor_b32 v243, 32, v243
ds_read_b128 v[204:207], v243 offset:128
v_fma_mix_f32 v162, v138, v138, v162 op_sel:[0,0,0] op_sel_hi:[1,1,0]
v_pk_mul_f16 v152, v152, v151
v_pk_mul_f16 v149, v149, v148
v_fma_mix_f32 v162, v139, v139, v162 op_sel:[1,1,0] op_sel_hi:[1,1,0]
v_pk_mul_f16 v146, v146, v145
v_fma_mix_f32 v162, v155, v155, v162 op_sel:[0,0,0] op_sel_hi:[1,1,0]
v_fma_mix_f32 v162, v140, v140, v162 op_sel:[0,0,0] op_sel_hi:[1,1,0]
v_fma_mix_f32 v162, v155, v155, v162 op_sel:[1,1,0] op_sel_hi:[1,1,0]
v_smfmac_f32_16x16x32_bf16 v[28:31], v[238:239], v[208:211], v246
ds_read_b128 v[232:235], v249 offset:1024
v_fma_mix_f32 v162, v152, v152, v162 op_sel:[0,0,0] op_sel_hi:[1,1,0]
s_waitcnt lgkmcnt(4)
v_fma_mix_f32 v162, v141, v141, v162 op_sel:[1,1,0] op_sel_hi:[1,1,0]
v_fma_mix_f32 v162, v152, v152, v162 op_sel:[1,1,0] op_sel_hi:[1,1,0]
v_fma_mix_f32 v162, v149, v149, v162 op_sel:[0,0,0] op_sel_hi:[1,1,0]
v_smfmac_f32_16x16x32_bf16 v[12:15], v[236:237], v[212:215], v246
v_fma_mix_f32 v162, v142, v142, v162 op_sel:[0,0,0] op_sel_hi:[1,1,0]
v_fma_mix_f32 v162, v149, v149, v162 op_sel:[1,1,0] op_sel_hi:[1,1,0]
v_fma_mix_f32 v162, v146, v146, v162 op_sel:[0,0,0] op_sel_hi:[1,1,0]
v_fma_mix_f32 v162, v143, v143, v162 op_sel:[1,1,0] op_sel_hi:[1,1,0]
v_fma_mix_f32 v162, v146, v146, v162 op_sel:[1,1,0] op_sel_hi:[1,1,0]
v_lshlrev_b32_e64 v252, 7, v251
s_add_u32 s46, s47, 1572864
s_mov_b32 exec_lo, 131071
s_mov_b32 exec_hi, 0
s_mov_b32 m0, 16288
s_nop 0
buffer_load_dword v252, s[4:7], s46 offen lds
s_mov_b64 exec, -1
s_setprio 2
v_smfmac_f32_16x16x32_bf16 v[36:39], v[218:219], v[192:195], v246
ds_read_b128 v[236:239], v249 offset:4096
v_cvt_pkrtz_f16_f32 v137, v120, v121
v_cvt_pkrtz_f16_f32 v139, v122, v123
v_cvt_pkrtz_f16_f32 v141, v124, v125
v_smfmac_f32_16x16x32_bf16 v[20:23], v[216:217], v[196:199], v246
v_cvt_pkrtz_f16_f32 v143, v126, v127
v_cvt_pkrtz_f16_f32 v145, v128, v129
v_cvt_pk_f16_f32 v155, v130, v131
v_cvt_pk_f16_f32 v152, v132, v133
v_cvt_pk_f16_f32 v149, v134, v135
v_mfma_f32_32x32x16_bf16 v[120:135], v[48:51], v[220:223], 0
ds_read_b128 v[216:219], v245 offset:2304
ds_read_b128 v[208:211], v243 offset:64
ds_read_b128 v[212:215], v243
v_pk_fma_f16 v154, v155, v155, s48
v_and_b32_e64 v137, s49, v137
v_pk_fma_f16 v151, v152, v152, s48
v_and_b32_e64 v139, s49, v139
v_pk_fma_f16 v148, v149, v149, s48
v_mfma_f32_32x32x16_bf16 v[120:135], v[52:55], v[224:227], v[120:135]
ds_read_b128 v[220:223], v249 offset:2048
v_pk_mul_f16 v154, v155, v154
v_bfe_u32 v136, v137, 2, 14
v_pk_mul_f16 v151, v152, v151
v_pk_mul_f16 v148, v149, v148
v_bfe_u32 v138, v139, 2, 14
v_exp_f16_e64 v153, v154
s_waitcnt lgkmcnt(4)
v_smfmac_f32_16x16x32_bf16 v[4:7], v[230:231], v[200:203], v246
ds_read_b128 v[224:227], v245 offset:1920
v_xor_b32 v242, 32, v242
ds_read_b128 v[192:195], v242 offset:128
ds_read_b128 v[196:199], v242 offset:64
ds_read_u16_d16 v136, v136
ds_read_u16_d16 v138, v138
v_lshrrev_b32 v137, 18, v137
v_exp_f16 v150, v151
v_smfmac_f32_16x16x32_bf16 v[36:39], v[228:229], v[204:207], v246
v_lshrrev_b32 v139, 18, v139
v_exp_f16 v147, v148
v_and_b32_e64 v141, s49, v141
v_mfma_f32_32x32x16_bf16 v[120:135], v[56:59], v[232:235], v[120:135]
ds_read_b128 v[228:231], v249 offset:5120
ds_read_u16_d16_hi v137, v137
ds_read_u16_d16_hi v139, v139
v_and_b32_e64 v143, s49, v143
v_exp_f16_sdwa v153, v154 dst_sel:WORD_1 dst_unused:UNUSED_PRESERVE src0_sel:WORD_1
v_bfe_u32 v140, v141, 2, 14
v_exp_f16_sdwa v150, v151 dst_sel:WORD_1 dst_unused:UNUSED_PRESERVE src0_sel:WORD_1
v_bfe_u32 v142, v143, 2, 14
v_mfma_f32_32x32x16_bf16 v[120:135], v[60:63], v[236:239], v[120:135]
ds_read_b128 v[232:235], v245 offset:1536
ds_read_b128 v[200:203], v242
v_xor_b32 v244, 16, v244
ds_read_b128 v[204:207], v244 offset:128
ds_read_u16_d16 v140, v140
ds_read_u16_d16 v142, v142
v_exp_f16_sdwa v147, v148 dst_sel:WORD_1 dst_unused:UNUSED_PRESERVE src0_sel:WORD_1
v_lshrrev_b32 v141, 18, v141
v_pk_add_f16 v153, v153, 1.0 op_sel_hi:[1,0]
v_lshrrev_b32 v143, 18, v143
v_pk_add_f16 v150, v150, 1.0 op_sel_hi:[1,0]
s_waitcnt lgkmcnt(8)
v_smfmac_f32_16x16x32_bf16 v[20:23], v[218:219], v[208:211], v246
ds_read_b128 v[236:239], v245 offset:1152
ds_read_u16_d16_hi v141, v141
ds_read_u16_d16_hi v143, v143
v_pk_add_f16 v147, v147, 1.0 op_sel_hi:[1,0]
v_and_b32 v145, s49, v145
v_rcp_f16 v154, v153
v_smfmac_f32_16x16x32_bf16 v[4:7], v[216:217], v[212:215], v246
v_bfe_u32 v144, v145, 2, 14
v_rcp_f16_e64 v151, v150
v_mfma_f32_32x32x16_bf16 v[120:135], v[64:67], v[220:223], v[120:135]
ds_read_b128 v[208:211], v244 offset:64
ds_read_b128 v[212:215], v244
ds_read_b128 v[216:219], v249 offset:6144
ds_read_u16_d16 v144, v144
v_lshrrev_b32_e64 v145, 18, v145
v_rcp_f16 v148, v147
v_rcp_f16_sdwa v154, v153 dst_sel:WORD_1 dst_unused:UNUSED_PRESERVE src0_sel:WORD_1
ds_read_u16_d16_hi v145, v145
v_fma_mix_f32 v163, v136, v136, 0 op_sel:[0,0,0] op_sel_hi:[1,1,0]
s_waitcnt lgkmcnt(8)
v_fma_mix_f32 v163, v137, v137, v163 op_sel:[1,1,0] op_sel_hi:[1,1,0]
v_smfmac_f32_16x16x32_bf16 v[36:39], v[226:227], v[192:195], v246
ds_read_b128 v[220:223], v249 offset:9216
v_rcp_f16_sdwa v151, v150 dst_sel:WORD_1 dst_unused:UNUSED_PRESERVE src0_sel:WORD_1
v_fma_mix_f32 v163, v138, v138, v163 op_sel:[0,0,0] op_sel_hi:[1,1,0]
v_smfmac_f32_16x16x32_bf16 v[20:23], v[224:225], v[196:199], v246
v_rcp_f16_sdwa v148, v147 dst_sel:WORD_1 dst_unused:UNUSED_PRESERVE src0_sel:WORD_1
v_fma_mix_f32 v163, v139, v139, v163 op_sel:[1,1,0] op_sel_hi:[1,1,0]
v_pk_mul_f16 v155, v155, v154
v_mfma_f32_32x32x16_bf16 v[120:135], v[68:71], v[228:231], v[120:135]
ds_read_b128 v[224:227], v249 offset:7168
v_fma_mix_f32 v163, v140, v140, v163 op_sel:[0,0,0] op_sel_hi:[1,1,0]
v_pk_mul_f16 v152, v152, v151
s_waitcnt lgkmcnt(7)
v_fma_mix_f32 v163, v141, v141, v163 op_sel:[1,1,0] op_sel_hi:[1,1,0]
v_pk_mul_f16 v149, v149, v148
v_fma_mix_f32 v163, v155, v155, v163 op_sel:[0,0,0] op_sel_hi:[1,1,0]
v_fma_mix_f32 v163, v142, v142, v163 op_sel:[0,0,0] op_sel_hi:[1,1,0]
v_fma_mix_f32 v163, v155, v155, v163 op_sel:[1,1,0] op_sel_hi:[1,1,0]
v_smfmac_f32_16x16x32_bf16 v[4:7], v[234:235], v[200:203], v246
ds_read_b128 v[228:231], v245 offset:768
v_xor_b32 v243, 16, v243
ds_read_b128 v[192:195], v243 offset:128
ds_read_b128 v[196:199], v243 offset:64
v_fma_mix_f32 v163, v143, v143, v163 op_sel:[1,1,0] op_sel_hi:[1,1,0]
v_fma_mix_f32 v163, v152, v152, v163 op_sel:[0,0,0] op_sel_hi:[1,1,0]
v_fma_mix_f32 v163, v152, v152, v163 op_sel:[1,1,0] op_sel_hi:[1,1,0]
v_smfmac_f32_16x16x32_bf16 v[32:35], v[232:233], v[204:207], v246
s_waitcnt lgkmcnt(4)
v_fma_mix_f32 v163, v144, v144, v163 op_sel:[0,0,0] op_sel_hi:[1,1,0]
v_fma_mix_f32 v163, v149, v149, v163 op_sel:[0,0,0] op_sel_hi:[1,1,0]
v_fma_mix_f32 v163, v145, v145, v163 op_sel:[1,1,0] op_sel_hi:[1,1,0]
v_fma_mix_f32 v163, v149, v149, v163 op_sel:[1,1,0] op_sel_hi:[1,1,0]
v_lshlrev_b32 v252, 7, v251
s_add_u32 s46, s47, 1572864
s_mov_b32 exec_lo, 4294836224
s_mov_b32 exec_hi, 3
s_mov_b32 m0, 16220
s_nop 0
buffer_load_dword v252, s[4:7], s46 offen lds
s_mov_b64 exec, -1
s_setprio 1
v_smfmac_f32_16x16x32_bf16 v[16:19], v[238:239], v[208:211], v246
ds_read_b128 v[232:235], v249 offset:10240
v_cvt_pkrtz_f16_f32 v137, v120, v121
v_cvt_pkrtz_f16_f32 v139, v122, v123
v_cvt_pkrtz_f16_f32 v141, v124, v125
v_smfmac_f32_16x16x32_bf16 v[0:3], v[236:237], v[212:215], v246
v_cvt_pkrtz_f16_f32 v143, v126, v127
v_cvt_pk_f16_f32 v155, v128, v129
v_cvt_pk_f16_f32 v152, v130, v131
v_cvt_pk_f16_f32 v149, v132, v133
v_cvt_pk_f16_f32 v146, v134, v135
v_mfma_f32_32x32x16_bf16 v[120:135], v[48:51], v[216:219], 0
ds_read_b128 v[236:239], v249 offset:8192
v_pk_fma_f16 v154, v155, v155, s48
v_and_b32_e64 v137, s49, v137
v_pk_fma_f16 v151, v152, v152, s48
v_pk_fma_f16 v148, v149, v149, s48
v_and_b32 v139, s49, v139
v_pk_fma_f16 v145, v146, v146, s48
v_pk_mul_f16 v154, v155, v154
v_mfma_f32_32x32x16_bf16 v[120:135], v[52:55], v[220:223], v[120:135]
ds_read_b128 v[216:219], v245 offset:384
ds_read_b128 v[200:203], v243
v_xor_b32 v242, 16, v242
ds_read_b128 v[204:207], v242 offset:128
v_bfe_u32 v136, v137, 2, 14
v_pk_mul_f16 v151, v152, v151
v_pk_mul_f16 v148, v149, v148
v_bfe_u32 v138, v139, 2, 14
v_pk_mul_f16 v145, v146, v145
v_exp_f16 v153, v154
s_waitcnt lgkmcnt(4)
v_mfma_f32_32x32x16_bf16 v[120:135], v[56:59], v[224:227], v[120:135]
ds_read_b128 v[220:223], v249 offset:11264
ds_read_u16_d16 v136, v136
ds_read_u16_d16 v138, v138
v_lshrrev_b32 v137, 18, v137
v_exp_f16 v150, v151
v_lshrrev_b32 v139, 18, v139
v_exp_f16 v147, v148
v_and_b32_e64 v141, s49, v141
v_smfmac_f32_16x16x32_bf16 v[32:35], v[230:231], v[192:195], v246
ds_read_b128 v[224:227], v245
ds_read_b128 v[208:211], v242 offset:64
ds_read_b128 v[212:215], v242
ds_read_u16_d16_hi v137, v137
ds_read_u16_d16_hi v139, v139
v_exp_f16 v144, v145
v_and_b32 v143, s49, v143
v_exp_f16_sdwa v153, v154 dst_sel:WORD_1 dst_unused:UNUSED_PRESERVE src0_sel:WORD_1
v_smfmac_f32_16x16x32_bf16 v[16:19], v[228:229], v[196:199], v246
v_bfe_u32 v140, v141, 2, 14
v_exp_f16_sdwa v150, v151 dst_sel:WORD_1 dst_unused:UNUSED_PRESERVE src0_sel:WORD_1
v_mfma_f32_32x32x16_bf16 v[120:135], v[60:63], v[232:235], v[120:135]
ds_read_b128 v[228:231], v249 offset:12288
ds_read_u16_d16 v140, v140
v_bfe_u32 v142, v143, 2, 14
v_exp_f16_sdwa v147, v148 dst_sel:WORD_1 dst_unused:UNUSED_PRESERVE src0_sel:WORD_1
v_lshrrev_b32_e64 v141, 18, v141
v_exp_f16_sdwa v144, v145 dst_sel:WORD_1 dst_unused:UNUSED_PRESERVE src0_sel:WORD_1
v_lshrrev_b32 v143, 18, v143
v_pk_add_f16 v153, v153, 1.0 op_sel_hi:[1,0]
s_waitcnt lgkmcnt(7)
v_mfma_f32_32x32x16_bf16 v[120:135], v[64:67], v[236:239], v[120:135]
ds_read_b128 v[232:235], v249 offset:15360
ds_read_u16_d16 v142, v142
ds_read_u16_d16_hi v141, v141
ds_read_u16_d16_hi v143, v143
v_pk_add_f16 v150, v150, 1.0 op_sel_hi:[1,0]
v_pk_add_f16 v147, v147, 1.0 op_sel_hi:[1,0]
v_pk_add_f16 v144, v144, 1.0 op_sel_hi:[1,0]
v_rcp_f16 v154, v153
v_rcp_f16 v151, v150
v_smfmac_f32_16x16x32_bf16 v[0:3], v[218:219], v[200:203], v246
ds_read_b128 v[236:239], v249 offset:13312
v_rcp_f16 v148, v147
v_rcp_f16 v145, v144
v_smfmac_f32_16x16x32_bf16 v[32:35], v[216:217], v[204:207], v246
v_rcp_f16_sdwa v154, v153 dst_sel:WORD_1 dst_unused:UNUSED_PRESERVE src0_sel:WORD_1
v_rcp_f16_sdwa v151, v150 dst_sel:WORD_1 dst_unused:UNUSED_PRESERVE src0_sel:WORD_1
s_setprio 0
v_mfma_f32_32x32x16_bf16 v[120:135], v[68:71], v[220:223], v[120:135]
ds_read_b128 v[216:219], v249 offset:16384
v_rcp_f16_sdwa v148, v147 dst_sel:WORD_1 dst_unused:UNUSED_PRESERVE src0_sel:WORD_1
v_fma_mix_f32 v164, v136, v136, 0 op_sel:[0,0,0] op_sel_hi:[1,1,0]
v_rcp_f16_sdwa v145, v144 dst_sel:WORD_1 dst_unused:UNUSED_PRESERVE src0_sel:WORD_1
s_waitcnt lgkmcnt(6)
v_fma_mix_f32 v164, v137, v137, v164 op_sel:[1,1,0] op_sel_hi:[1,1,0]
v_pk_mul_f16 v155, v155, v154
v_fma_mix_f32 v164, v138, v138, v164 op_sel:[0,0,0] op_sel_hi:[1,1,0]
v_smfmac_f32_16x16x32_bf16 v[16:19], v[226:227], v[208:211], v246
ds_read_b128 v[220:223], v249 offset:14336
v_pk_mul_f16 v152, v152, v151
v_pk_mul_f16 v149, v149, v148
v_fma_mix_f32 v164, v139, v139, v164 op_sel:[1,1,0] op_sel_hi:[1,1,0]
v_pk_mul_f16 v146, v146, v145
v_smfmac_f32_16x16x32_bf16 v[0:3], v[224:225], v[212:215], v246
s_mov_b64 exec, 1
ds_add_u32 v253, v254 offset:16
s_mov_b64 exec, -1
v_fma_mix_f32 v164, v155, v155, v164 op_sel:[0,0,0] op_sel_hi:[1,1,0]
v_fma_mix_f32 v164, v140, v140, v164 op_sel:[0,0,0] op_sel_hi:[1,1,0]
v_fma_mix_f32 v164, v155, v155, v164 op_sel:[1,1,0] op_sel_hi:[1,1,0]
v_fma_mix_f32 v164, v152, v152, v164 op_sel:[0,0,0] op_sel_hi:[1,1,0]
s_waitcnt lgkmcnt(3)
v_fma_mix_f32 v164, v141, v141, v164 op_sel:[1,1,0] op_sel_hi:[1,1,0]
v_fma_mix_f32 v164, v152, v152, v164 op_sel:[1,1,0] op_sel_hi:[1,1,0]
v_fma_mix_f32 v164, v149, v149, v164 op_sel:[0,0,0] op_sel_hi:[1,1,0]
v_fma_mix_f32 v164, v142, v142, v164 op_sel:[0,0,0] op_sel_hi:[1,1,0]
v_fma_mix_f32 v164, v149, v149, v164 op_sel:[1,1,0] op_sel_hi:[1,1,0]
v_fma_mix_f32 v164, v146, v146, v164 op_sel:[0,0,0] op_sel_hi:[1,1,0]
v_fma_mix_f32 v164, v143, v143, v164 op_sel:[1,1,0] op_sel_hi:[1,1,0]
v_fma_mix_f32 v164, v146, v146, v164 op_sel:[1,1,0] op_sel_hi:[1,1,0]
s_setprio 3
v_pk_add_f32 v[168:169], v[0:1], v[2:3]
v_pk_mul_f32 v[170:171], v[0:1], v[0:1]
v_pk_fma_f32 v[170:171], v[2:3], v[2:3], v[170:171]
v_pk_add_f32 v[168:169], v[168:169], v[4:5]
v_pk_fma_f32 v[170:171], v[4:5], v[4:5], v[170:171]
v_pk_add_f32 v[168:169], v[168:169], v[6:7]
v_pk_fma_f32 v[170:171], v[6:7], v[6:7], v[170:171]
v_pk_add_f32 v[168:169], v[168:169], v[8:9]
v_pk_fma_f32 v[170:171], v[8:9], v[8:9], v[170:171]
v_pk_add_f32 v[168:169], v[168:169], v[10:11]
v_pk_fma_f32 v[170:171], v[10:11], v[10:11], v[170:171]
v_pk_add_f32 v[168:169], v[168:169], v[12:13]
v_pk_fma_f32 v[170:171], v[12:13], v[12:13], v[170:171]
v_pk_add_f32 v[168:169], v[168:169], v[14:15]
v_pk_fma_f32 v[170:171], v[14:15], v[14:15], v[170:171]
v_pk_add_f32 v[168:169], v[168:169], v[16:17]
v_pk_fma_f32 v[170:171], v[16:17], v[16:17], v[170:171]
v_pk_add_f32 v[168:169], v[168:169], v[18:19]
v_pk_fma_f32 v[170:171], v[18:19], v[18:19], v[170:171]
v_pk_add_f32 v[168:169], v[168:169], v[20:21]
v_pk_fma_f32 v[170:171], v[20:21], v[20:21], v[170:171]
v_pk_add_f32 v[168:169], v[168:169], v[22:23]
v_pk_fma_f32 v[170:171], v[22:23], v[22:23], v[170:171]
v_pk_add_f32 v[168:169], v[168:169], v[24:25]
v_pk_fma_f32 v[170:171], v[24:25], v[24:25], v[170:171]
v_pk_add_f32 v[168:169], v[168:169], v[26:27]
v_pk_fma_f32 v[170:171], v[26:27], v[26:27], v[170:171]
v_pk_add_f32 v[168:169], v[168:169], v[28:29]
v_pk_fma_f32 v[170:171], v[28:29], v[28:29], v[170:171]
v_pk_add_f32 v[168:169], v[168:169], v[30:31]
v_pk_fma_f32 v[170:171], v[30:31], v[30:31], v[170:171]
v_pk_add_f32 v[168:169], v[168:169], v[32:33]
v_pk_fma_f32 v[170:171], v[32:33], v[32:33], v[170:171]
v_pk_add_f32 v[168:169], v[168:169], v[34:35]
v_pk_fma_f32 v[170:171], v[34:35], v[34:35], v[170:171]
v_pk_add_f32 v[168:169], v[168:169], v[36:37]
v_pk_fma_f32 v[170:171], v[36:37], v[36:37], v[170:171]
v_pk_add_f32 v[168:169], v[168:169], v[38:39]
v_pk_fma_f32 v[170:171], v[38:39], v[38:39], v[170:171]
v_pk_add_f32 v[168:169], v[168:169], v[40:41]
v_pk_fma_f32 v[170:171], v[40:41], v[40:41], v[170:171]
v_pk_add_f32 v[168:169], v[168:169], v[42:43]
v_pk_fma_f32 v[170:171], v[42:43], v[42:43], v[170:171]
v_pk_add_f32 v[168:169], v[168:169], v[44:45]
v_pk_fma_f32 v[170:171], v[44:45], v[44:45], v[170:171]
v_pk_add_f32 v[168:169], v[168:169], v[46:47]
v_pk_fma_f32 v[170:171], v[46:47], v[46:47], v[170:171]
s_setprio 0
v_add_u32 v174, -36864, v242
v_subrev_u32 v175, 66560, v174
v_min_u32 v174, v174, v175
v_add_u32 v174, 90112, v174
v_sub_u32 v175, v174, v242
v_add_u32 v242, v175, v242
v_add_u32 v243, v175, v243
v_add_u32 v244, v175, v244
v_lshlrev_b32_e64 v252, 7, v251
s_add_u32 s46, s47, 1572864
s_mov_b32 exec_lo, 0
s_mov_b32 exec_hi, 1048572
s_mov_b32 m0, 16152
s_nop 0
buffer_load_dword v252, s[4:7], s46 offen lds
s_mov_b64 exec, -1
s_setprio 2
v_cvt_pkrtz_f16_f32 v137, v120, v121
v_cvt_pkrtz_f16_f32 v139, v122, v123
v_cvt_pkrtz_f16_f32 v141, v124, v125
v_cvt_pkrtz_f16_f32 v143, v126, v127
v_cvt_pkrtz_f16_f32 v145, v128, v129
v_cvt_pk_f16_f32 v155, v130, v131
v_cvt_pk_f16_f32 v152, v132, v133
v_cvt_pk_f16_f32 v149, v134, v135
ds_read_b128 v[224:227], v249 offset:17408
v_mfma_f32_32x32x16_bf16 v[120:135], v[48:51], v[228:231], 0
v_pk_fma_f16 v154, v155, v155, s48
v_add_f32 v168, v168, v169
v_and_b32 v137, s49, v137
v_pk_fma_f16 v151, v152, v152, s48
v_and_b32_e64 v139, s49, v139
v_pk_fma_f16 v148, v149, v149, s48
v_add_f32_e64 v170, v170, v171
v_pk_mul_f16 v154, v155, v154
v_bfe_u32 v136, v137, 2, 14
v_pk_mul_f16 v151, v152, v151
v_pk_mul_f16 v148, v149, v148
v_bfe_u32 v138, v139, 2, 14
ds_read_b128 v[228:231], v249 offset:18432
ds_read_u16_d16 v136, v136
ds_read_u16_d16 v138, v138
v_mfma_f32_32x32x16_bf16 v[120:135], v[52:55], v[232:235], v[120:135]
v_permlane32_swap_b32 v168, v170
v_exp_f16 v153, v154
v_lshrrev_b32 v137, 18, v137
v_exp_f16 v150, v151
v_add_f32 v168, v168, v170
v_lshrrev_b32 v139, 18, v139
v_exp_f16 v147, v148
v_and_b32 v141, s49, v141
v_and_b32_e64 v143, s49, v143
v_mul_f32 v168, 1009429163, v168
ds_read_b128 v[232:235], v249 offset:21504
ds_read_u16_d16_hi v137, v137
ds_read_u16_d16_hi v139, v139
v_mfma_f32_32x32x16_bf16 v[120:135], v[56:59], v[236:239], v[120:135]
v_exp_f16_sdwa v153, v154 dst_sel:WORD_1 dst_unused:UNUSED_PRESERVE src0_sel:WORD_1
v_bfe_u32 v140, v141, 2, 14
v_exp_f16_sdwa v150, v151 dst_sel:WORD_1 dst_unused:UNUSED_PRESERVE src0_sel:WORD_1
v_mov_b32_e64 v170, v168
v_bfe_u32 v142, v143, 2, 14
v_exp_f16_sdwa v147, v148 dst_sel:WORD_1 dst_unused:UNUSED_PRESERVE src0_sel:WORD_1
v_lshrrev_b32_e64 v141, 18, v141
v_permlane32_swap_b32 v168, v170
v_pk_add_f16 v153, v153, 1.0 op_sel_hi:[1,0]
s_waitcnt lgkmcnt(8)
ds_read_b128 v[236:239], v249 offset:19456
ds_read_u16_d16 v140, v140
ds_read_u16_d16 v142, v142
ds_read_u16_d16_hi v141, v141
v_mfma_f32_32x32x16_bf16 v[120:135], v[60:63], v[216:219], v[120:135]
v_lshrrev_b32_e64 v143, 18, v143
v_pk_add_f16 v150, v150, 1.0 op_sel_hi:[1,0]
v_pk_add_f16 v147, v147, 1.0 op_sel_hi:[1,0]
v_and_b32_e64 v145, s49, v145
v_fma_f32 v170, -v168, v168, v170
v_rcp_f16_e64 v154, v153
v_bfe_u32 v144, v145, 2, 14
v_rcp_f16 v151, v150
v_max_f32 v170, 0, v170
v_lshrrev_b32_e64 v145, 18, v145
ds_read_b128 v[216:219], v249 offset:22528
ds_read_u16_d16_hi v143, v143
ds_read_u16_d16 v144, v144
ds_read_u16_d16_hi v145, v145
v_mfma_f32_32x32x16_bf16 v[120:135], v[64:67], v[220:223], v[120:135]
v_rcp_f16 v148, v147
v_rcp_f16_sdwa v154, v153 dst_sel:WORD_1 dst_unused:UNUSED_PRESERVE src0_sel:WORD_1
v_add_f32 v170, 925353388, v170
s_waitcnt lgkmcnt(8)
v_fma_mix_f32 v165, v136, v136, 0 op_sel:[0,0,0] op_sel_hi:[1,1,0]
ds_read_b32 v247, v253 offset:16
v_fma_mix_f32 v165, v137, v137, v165 op_sel:[1,1,0] op_sel_hi:[1,1,0]
v_rcp_f16_sdwa v151, v150 dst_sel:WORD_1 dst_unused:UNUSED_PRESERVE src0_sel:WORD_1
v_rsq_f32_e64 v170, v170
v_fma_mix_f32 v165, v138, v138, v165 op_sel:[0,0,0] op_sel_hi:[1,1,0]
ds_read_b128 v[220:223], v249 offset:20480
v_mfma_f32_32x32x16_bf16 v[120:135], v[68:71], v[224:227], v[120:135]
v_rcp_f16_sdwa v148, v147 dst_sel:WORD_1 dst_unused:UNUSED_PRESERVE src0_sel:WORD_1
v_fma_mix_f32 v165, v139, v139, v165 op_sel:[1,1,0] op_sel_hi:[1,1,0]
v_pk_mul_f16 v155, v155, v154
s_waitcnt lgkmcnt(6)
v_fma_mix_f32 v165, v140, v140, v165 op_sel:[0,0,0] op_sel_hi:[1,1,0]
v_pk_mul_f16 v152, v152, v151
v_fma_mix_f32 v165, v141, v141, v165 op_sel:[1,1,0] op_sel_hi:[1,1,0]
v_pk_mul_f16 v149, v149, v148
v_fma_mix_f32 v165, v155, v155, v165 op_sel:[0,0,0] op_sel_hi:[1,1,0]
v_mul_f32 v172, 3203391086, v170
v_fma_mix_f32 v165, v142, v142, v165 op_sel:[0,0,0] op_sel_hi:[1,1,0]
v_fma_mix_f32 v165, v155, v155, v165 op_sel:[1,1,0] op_sel_hi:[1,1,0]
s_waitcnt lgkmcnt(2)
v_fma_mix_f32 v165, v143, v143, v165 op_sel:[1,1,0] op_sel_hi:[1,1,0]
v_fma_mix_f32 v165, v152, v152, v165 op_sel:[0,0,0] op_sel_hi:[1,1,0]
v_fma_mix_f32 v165, v152, v152, v165 op_sel:[1,1,0] op_sel_hi:[1,1,0]
v_mul_f32 v173, v168, v172
v_fma_mix_f32 v165, v144, v144, v165 op_sel:[0,0,0] op_sel_hi:[1,1,0]
v_fma_mix_f32 v165, v149, v149, v165 op_sel:[0,0,0] op_sel_hi:[1,1,0]
v_fma_mix_f32 v165, v145, v145, v165 op_sel:[1,1,0] op_sel_hi:[1,1,0]
v_fma_mix_f32 v165, v149, v149, v165 op_sel:[1,1,0] op_sel_hi:[1,1,0]
s_setprio 3
v_pk_fma_f32 v[0:1], v[0:1], v[172:173], v[172:173] op_sel:[0,0,1] op_sel_hi:[1,0,1] neg_lo:[0,0,1] neg_hi:[0,0,1]
v_pk_fma_f32 v[2:3], v[2:3], v[172:173], v[172:173] op_sel:[0,0,1] op_sel_hi:[1,0,1] neg_lo:[0,0,1] neg_hi:[0,0,1]
v_pk_fma_f32 v[4:5], v[4:5], v[172:173], v[172:173] op_sel:[0,0,1] op_sel_hi:[1,0,1] neg_lo:[0,0,1] neg_hi:[0,0,1]
v_pk_fma_f32 v[6:7], v[6:7], v[172:173], v[172:173] op_sel:[0,0,1] op_sel_hi:[1,0,1] neg_lo:[0,0,1] neg_hi:[0,0,1]
v_pk_fma_f32 v[8:9], v[8:9], v[172:173], v[172:173] op_sel:[0,0,1] op_sel_hi:[1,0,1] neg_lo:[0,0,1] neg_hi:[0,0,1]
v_pk_fma_f32 v[10:11], v[10:11], v[172:173], v[172:173] op_sel:[0,0,1] op_sel_hi:[1,0,1] neg_lo:[0,0,1] neg_hi:[0,0,1]
v_pk_fma_f32 v[12:13], v[12:13], v[172:173], v[172:173] op_sel:[0,0,1] op_sel_hi:[1,0,1] neg_lo:[0,0,1] neg_hi:[0,0,1]
v_pk_fma_f32 v[14:15], v[14:15], v[172:173], v[172:173] op_sel:[0,0,1] op_sel_hi:[1,0,1] neg_lo:[0,0,1] neg_hi:[0,0,1]
v_pk_fma_f32 v[16:17], v[16:17], v[172:173], v[172:173] op_sel:[0,0,1] op_sel_hi:[1,0,1] neg_lo:[0,0,1] neg_hi:[0,0,1]
v_pk_fma_f32 v[18:19], v[18:19], v[172:173], v[172:173] op_sel:[0,0,1] op_sel_hi:[1,0,1] neg_lo:[0,0,1] neg_hi:[0,0,1]
v_pk_fma_f32 v[20:21], v[20:21], v[172:173], v[172:173] op_sel:[0,0,1] op_sel_hi:[1,0,1] neg_lo:[0,0,1] neg_hi:[0,0,1]
v_pk_fma_f32 v[22:23], v[22:23], v[172:173], v[172:173] op_sel:[0,0,1] op_sel_hi:[1,0,1] neg_lo:[0,0,1] neg_hi:[0,0,1]
v_pk_fma_f32 v[24:25], v[24:25], v[172:173], v[172:173] op_sel:[0,0,1] op_sel_hi:[1,0,1] neg_lo:[0,0,1] neg_hi:[0,0,1]
v_pk_fma_f32 v[26:27], v[26:27], v[172:173], v[172:173] op_sel:[0,0,1] op_sel_hi:[1,0,1] neg_lo:[0,0,1] neg_hi:[0,0,1]
v_pk_fma_f32 v[28:29], v[28:29], v[172:173], v[172:173] op_sel:[0,0,1] op_sel_hi:[1,0,1] neg_lo:[0,0,1] neg_hi:[0,0,1]
v_pk_fma_f32 v[30:31], v[30:31], v[172:173], v[172:173] op_sel:[0,0,1] op_sel_hi:[1,0,1] neg_lo:[0,0,1] neg_hi:[0,0,1]
v_pk_fma_f32 v[32:33], v[32:33], v[172:173], v[172:173] op_sel:[0,0,1] op_sel_hi:[1,0,1] neg_lo:[0,0,1] neg_hi:[0,0,1]
v_pk_fma_f32 v[34:35], v[34:35], v[172:173], v[172:173] op_sel:[0,0,1] op_sel_hi:[1,0,1] neg_lo:[0,0,1] neg_hi:[0,0,1]
v_pk_fma_f32 v[36:37], v[36:37], v[172:173], v[172:173] op_sel:[0,0,1] op_sel_hi:[1,0,1] neg_lo:[0,0,1] neg_hi:[0,0,1]
v_pk_fma_f32 v[38:39], v[38:39], v[172:173], v[172:173] op_sel:[0,0,1] op_sel_hi:[1,0,1] neg_lo:[0,0,1] neg_hi:[0,0,1]
v_pk_fma_f32 v[40:41], v[40:41], v[172:173], v[172:173] op_sel:[0,0,1] op_sel_hi:[1,0,1] neg_lo:[0,0,1] neg_hi:[0,0,1]
v_pk_fma_f32 v[42:43], v[42:43], v[172:173], v[172:173] op_sel:[0,0,1] op_sel_hi:[1,0,1] neg_lo:[0,0,1] neg_hi:[0,0,1]
v_pk_fma_f32 v[44:45], v[44:45], v[172:173], v[172:173] op_sel:[0,0,1] op_sel_hi:[1,0,1] neg_lo:[0,0,1] neg_hi:[0,0,1]
v_pk_fma_f32 v[46:47], v[46:47], v[172:173], v[172:173] op_sel:[0,0,1] op_sel_hi:[1,0,1] neg_lo:[0,0,1] neg_hi:[0,0,1]
s_setprio 2
s_waitcnt lgkmcnt(0)
v_readfirstlane_b32 s43, v247
s_nop 1
s_cmp_ge_u32 s43, 16
s_cbranch_scc1 Lev4
Lev4w:
s_sleep 1
ds_read_b32 v247, v253 offset:16
s_waitcnt lgkmcnt(0)
v_readfirstlane_b32 s43, v247
s_cmp_eq_u32 s76, 0
s_cbranch_scc1 Lev4
s_sub_u32 s76, s76, 1
s_cmp_lt_u32 s43, 16
s_cbranch_scc1 Lev4w
Lev4:
s_setprio 1
v_cvt_pkrtz_f16_f32 v137, v120, v121
v_cvt_pkrtz_f16_f32 v139, v122, v123
v_cvt_pkrtz_f16_f32 v141, v124, v125
v_cvt_pkrtz_f16_f32 v143, v126, v127
v_cvt_pkrtz_f16_f32 v145, v128, v129
v_cvt_pk_f16_f32 v155, v130, v131
v_cvt_pk_f16_f32 v152, v132, v133
v_cvt_pk_f16_f32 v149, v134, v135
s_add_u32 m0, s67, 53248
s_add_u32 s66, s66, 98304
buffer_load_dwordx4 v240, s[4:7], s66 offen lds
ds_read_b128 v[224:227], v249 offset:23552
v_mfma_f32_32x32x16_bf16 v[120:135], v[48:51], v[228:231], 0
v_pk_fma_f16 v154, v155, v155, s48
v_cvt_pk_bf16_f32 v72, v0, v1
v_and_b32 v137, s49, v137
v_pk_fma_f16 v151, v152, v152, s48
v_cvt_pk_bf16_f32 v73, v2, v3
v_and_b32_e64 v139, s49, v139
v_pk_fma_f16 v148, v149, v149, s48
v_pk_mul_f16 v154, v155, v154
v_cvt_pk_bf16_f32 v74, v4, v5
v_bfe_u32 v136, v137, 2, 14
v_pk_mul_f16 v151, v152, v151
v_pk_mul_f16 v148, v149, v148
v_cvt_pk_bf16_f32 v75, v6, v7
v_bfe_u32 v138, v139, 2, 14
s_add_u32 m0, s67, 59904
s_add_u32 s66, s66, 98304
buffer_load_dwordx4 v240, s[4:7], s66 offen lds
ds_read_b128 v[228:231], v248 offset:16384
ds_read_u16_d16 v136, v136
ds_read_u16_d16 v138, v138
v_mfma_f32_32x32x16_bf16 v[120:135], v[52:55], v[232:235], v[120:135]
v_exp_f16_e64 v153, v154
v_cvt_pk_bf16_f32 v76, v8, v9
v_lshrrev_b32 v137, 18, v137
v_exp_f16 v150, v151
v_cvt_pk_bf16_f32 v77, v10, v11
v_lshrrev_b32 v139, 18, v139
v_exp_f16 v147, v148
v_cvt_pk_bf16_f32 v78, v12, v13
v_and_b32_e64 v141, s49, v141
v_and_b32 v143, s49, v143
v_cvt_pk_bf16_f32 v79, v14, v15
s_add_u32 m0, s67, 0
s_add_u32 s66, s66, 98304
buffer_load_dwordx4 v240, s[4:7], s66 offen lds
ds_read_b128 v[232:235], v248 offset:19456
ds_read_u16_d16_hi v137, v137
ds_read_u16_d16_hi v139, v139
v_mfma_f32_32x32x16_bf16 v[120:135], v[56:59], v[236:239], v[120:135]
v_exp_f16_sdwa v153, v154 dst_sel:WORD_1 dst_unused:UNUSED_PRESERVE src0_sel:WORD_1
v_bfe_u32 v140, v141, 2, 14
v_cvt_pk_bf16_f32 v80, v16, v17
v_exp_f16_sdwa v150, v151 dst_sel:WORD_1 dst_unused:UNUSED_PRESERVE src0_sel:WORD_1
v_bfe_u32 v142, v143, 2, 14
v_cvt_pk_bf16_f32 v81, v18, v19
v_exp_f16_sdwa v147, v148 dst_sel:WORD_1 dst_unused:UNUSED_PRESERVE src0_sel:WORD_1
v_cvt_pk_bf16_f32 v82, v20, v21
v_lshrrev_b32_e64 v141, 18, v141
v_pk_add_f16 v153, v153, 1.0 op_sel_hi:[1,0]
v_lshrrev_b32_e64 v143, 18, v143
s_add_u32 m0, s67, 6656
s_add_u32 s66, s66, 98304
buffer_load_dwordx4 v240, s[4:7], s66 offen lds
s_add_u32 m0, s67, 13312
s_add_u32 s66, s66, 98304
buffer_load_dwordx4 v240, s[4:7], s66 offen lds
ds_read_b128 v[236:239], v248 offset:17408
ds_read_u16_d16 v140, v140
ds_read_u16_d16 v142, v142
ds_read_u16_d16_hi v141, v141
ds_read_u16_d16_hi v143, v143
v_mfma_f32_32x32x16_bf16 v[120:135], v[60:63], v[216:219], v[120:135]
v_cvt_pk_bf16_f32 v83, v22, v23
v_pk_add_f16 v150, v150, 1.0 op_sel_hi:[1,0]
v_pk_add_f16 v147, v147, 1.0 op_sel_hi:[1,0]
v_and_b32_e64 v145, s49, v145
v_cvt_pk_bf16_f32 v84, v24, v25
v_rcp_f16_e64 v154, v153
v_bfe_u32 v144, v145, 2, 14
v_cvt_pk_bf16_f32 v85, v26, v27
v_rcp_f16 v151, v150
v_lshrrev_b32 v145, 18, v145
v_cvt_pk_bf16_f32 v86, v28, v29
s_add_u32 m0, s67, 19968
s_add_u32 s66, s66, 98304
buffer_load_dwordx4 v240, s[4:7], s66 offen lds
ds_read_b128 v[216:219], v248 offset:20480
ds_read_u16_d16 v144, v144
ds_read_u16_d16_hi v145, v145
v_mfma_f32_32x32x16_bf16 v[120:135], v[64:67], v[220:223], v[120:135]
v_rcp_f16_e64 v148, v147
v_cvt_pk_bf16_f32 v87, v30, v31
v_rcp_f16_sdwa v154, v153 dst_sel:WORD_1 dst_unused:UNUSED_PRESERVE src0_sel:WORD_1
s_waitcnt lgkmcnt(5)
v_fma_mix_f32 v166, v136, v136, 0 op_sel:[0,0,0] op_sel_hi:[1,1,0]
v_cvt_pk_bf16_f32 v88, v32, v33
s_setprio 0
v_fma_mix_f32 v166, v137, v137, v166 op_sel:[1,1,0] op_sel_hi:[1,1,0]
v_rcp_f16_sdwa v151, v150 dst_sel:WORD_1 dst_unused:UNUSED_PRESERVE src0_sel:WORD_1
v_cvt_pk_bf16_f32 v89, v34, v35
v_fma_mix_f32 v166, v138, v138, v166 op_sel:[0,0,0] op_sel_hi:[1,1,0]
v_rcp_f16_sdwa v148, v147 dst_sel:WORD_1 dst_unused:UNUSED_PRESERVE src0_sel:WORD_1
v_cvt_pk_bf16_f32 v90, v36, v37
s_add_u32 m0, s67, 26624
s_add_u32 s66, s66, 98304
buffer_load_dwordx4 v240, s[4:7], s66 offen lds
ds_read_b128 v[220:223], v248 offset:18432
v_mfma_f32_32x32x16_bf16 v[120:135], v[68:71], v[224:227], v[120:135]
v_fma_mix_f32 v166, v139, v139, v166 op_sel:[1,1,0] op_sel_hi:[1,1,0]
v_pk_mul_f16 v155, v155, v154
v_fma_mix_f32 v166, v140, v140, v166 op_sel:[0,0,0] op_sel_hi:[1,1,0]
v_cvt_pk_bf16_f32 v91, v38, v39
v_pk_mul_f16 v152, v152, v151
s_waitcnt lgkmcnt(1)
v_fma_mix_f32 v166, v141, v141, v166 op_sel:[1,1,0] op_sel_hi:[1,1,0]
v_cvt_pk_bf16_f32 v92, v40, v41
v_pk_mul_f16 v149, v149, v148
v_fma_mix_f32 v166, v155, v155, v166 op_sel:[0,0,0] op_sel_hi:[1,1,0]
v_fma_mix_f32 v166, v142, v142, v166 op_sel:[0,0,0] op_sel_hi:[1,1,0]
v_cvt_pk_bf16_f32 v93, v42, v43
v_fma_mix_f32 v166, v155, v155, v166 op_sel:[1,1,0] op_sel_hi:[1,1,0]
v_fma_mix_f32 v166, v143, v143, v166 op_sel:[1,1,0] op_sel_hi:[1,1,0]
v_fma_mix_f32 v166, v152, v152, v166 op_sel:[0,0,0] op_sel_hi:[1,1,0]
s_add_u32 m0, s67, 33280
s_add_u32 s66, s66, 98304
buffer_load_dwordx4 v240, s[4:7], s66 offen lds
v_cvt_pk_bf16_f32 v94, v44, v45
v_fma_mix_f32 v166, v152, v152, v166 op_sel:[1,1,0] op_sel_hi:[1,1,0]
v_fma_mix_f32 v166, v144, v144, v166 op_sel:[0,0,0] op_sel_hi:[1,1,0]
v_fma_mix_f32 v166, v149, v149, v166 op_sel:[0,0,0] op_sel_hi:[1,1,0]
v_cvt_pk_bf16_f32 v95, v46, v47
v_fma_mix_f32 v166, v145, v145, v166 op_sel:[1,1,0] op_sel_hi:[1,1,0]
v_fma_mix_f32 v166, v149, v149, v166 op_sel:[1,1,0] op_sel_hi:[1,1,0]
s_setprio 2
v_cvt_pkrtz_f16_f32 v137, v120, v121
v_cvt_pkrtz_f16_f32 v139, v122, v123
v_cvt_pkrtz_f16_f32 v141, v124, v125
v_cvt_pkrtz_f16_f32 v143, v126, v127
v_cvt_pkrtz_f16_f32 v145, v128, v129
v_cvt_pk_f16_f32 v155, v130, v131
v_cvt_pk_f16_f32 v152, v132, v133
v_cvt_pk_f16_f32 v149, v134, v135
ds_read_b128 v[224:227], v248 offset:21504
v_mfma_f32_32x32x16_bf16 v[120:135], v[72:75], v[228:231], 0
v_pk_fma_f16 v154, v155, v155, s48
v_and_b32_e64 v137, s49, v137
v_pk_fma_f16 v151, v152, v152, s48
v_and_b32_e64 v139, s49, v139
v_pk_fma_f16 v148, v149, v149, s48
v_pk_mul_f16 v154, v155, v154
v_bfe_u32 v136, v137, 2, 14
v_pk_mul_f16 v151, v152, v151
v_pk_mul_f16 v148, v149, v148
v_bfe_u32 v138, v139, 2, 14
ds_read_b128 v[228:231], v248 offset:22528
ds_read_u16_d16 v136, v136
ds_read_u16_d16 v138, v138
v_mfma_f32_32x32x16_bf16 v[120:135], v[76:79], v[232:235], v[120:135]
v_exp_f16 v153, v154
v_lshrrev_b32 v137, 18, v137
v_exp_f16 v150, v151
v_lshrrev_b32 v139, 18, v139
v_exp_f16 v147, v148
v_and_b32 v141, s49, v141
v_and_b32_e64 v143, s49, v143
ds_read_b128 v[232:235], v248 offset:25600
ds_read_u16_d16_hi v137, v137
ds_read_u16_d16_hi v139, v139
v_mfma_f32_32x32x16_bf16 v[120:135], v[80:83], v[236:239], v[120:135]
v_exp_f16_sdwa v153, v154 dst_sel:WORD_1 dst_unused:UNUSED_PRESERVE src0_sel:WORD_1
v_bfe_u32 v140, v141, 2, 14
v_exp_f16_sdwa v150, v151 dst_sel:WORD_1 dst_unused:UNUSED_PRESERVE src0_sel:WORD_1
v_bfe_u32 v142, v143, 2, 14
v_exp_f16_sdwa v147, v148 dst_sel:WORD_1 dst_unused:UNUSED_PRESERVE src0_sel:WORD_1
v_lshrrev_b32_e64 v141, 18, v141
v_pk_add_f16 v153, v153, 1.0 op_sel_hi:[1,0]
ds_read_b128 v[236:239], v248 offset:23552
ds_read_u16_d16 v140, v140
ds_read_u16_d16 v142, v142
ds_read_u16_d16_hi v141, v141
v_mfma_f32_32x32x16_bf16 v[120:135], v[84:87], v[216:219], v[120:135]
v_lshrrev_b32_e64 v143, 18, v143
v_pk_add_f16 v150, v150, 1.0 op_sel_hi:[1,0]
v_pk_add_f16 v147, v147, 1.0 op_sel_hi:[1,0]
v_and_b32 v145, s49, v145
v_rcp_f16 v154, v153
v_bfe_u32 v144, v145, 2, 14
v_rcp_f16_e64 v151, v150
v_lshrrev_b32 v145, 18, v145
s_waitcnt lgkmcnt(7)
ds_read_b128 v[216:219], v248 offset:26624
ds_read_u16_d16_hi v143, v143
ds_read_u16_d16 v144, v144
ds_read_u16_d16_hi v145, v145
v_mfma_f32_32x32x16_bf16 v[120:135], v[88:91], v[220:223], v[120:135]
v_rcp_f16 v148, v147
v_rcp_f16_sdwa v154, v153 dst_sel:WORD_1 dst_unused:UNUSED_PRESERVE src0_sel:WORD_1
v_fma_mix_f32 v167, v136, v136, 0 op_sel:[0,0,0] op_sel_hi:[1,1,0]
s_waitcnt lgkmcnt(8)
v_fma_mix_f32 v167, v137, v137, v167 op_sel:[1,1,0] op_sel_hi:[1,1,0]
v_rcp_f16_sdwa v151, v150 dst_sel:WORD_1 dst_unused:UNUSED_PRESERVE src0_sel:WORD_1
v_fma_mix_f32 v167, v138, v138, v167 op_sel:[0,0,0] op_sel_hi:[1,1,0]
ds_read_b128 v[220:223], v248 offset:24576
v_mfma_f32_32x32x16_bf16 v[120:135], v[92:95], v[224:227], v[120:135]
v_rcp_f16_sdwa v148, v147 dst_sel:WORD_1 dst_unused:UNUSED_PRESERVE src0_sel:WORD_1
v_fma_mix_f32 v167, v139, v139, v167 op_sel:[1,1,0] op_sel_hi:[1,1,0]
v_pk_mul_f16 v155, v155, v154
s_cmp_eq_u32 s40, 7
s_cbranch_scc1 Lrdy16
s_waitcnt vmcnt(0)
Lrdy16:
s_mov_b64 exec, 1
ds_add_u32 v253, v254 offset:12
s_mov_b64 exec, -1
s_waitcnt lgkmcnt(6)
v_fma_mix_f32 v167, v140, v140, v167 op_sel:[0,0,0] op_sel_hi:[1,1,0]
v_pk_mul_f16 v152, v152, v151
v_fma_mix_f32 v167, v141, v141, v167 op_sel:[1,1,0] op_sel_hi:[1,1,0]
v_pk_mul_f16 v149, v149, v148
v_fma_mix_f32 v167, v155, v155, v167 op_sel:[0,0,0] op_sel_hi:[1,1,0]
v_fma_mix_f32 v167, v142, v142, v167 op_sel:[0,0,0] op_sel_hi:[1,1,0]
v_fma_mix_f32 v167, v155, v155, v167 op_sel:[1,1,0] op_sel_hi:[1,1,0]
s_waitcnt lgkmcnt(2)
v_fma_mix_f32 v167, v143, v143, v167 op_sel:[1,1,0] op_sel_hi:[1,1,0]
v_fma_mix_f32 v167, v152, v152, v167 op_sel:[0,0,0] op_sel_hi:[1,1,0]
v_fma_mix_f32 v167, v152, v152, v167 op_sel:[1,1,0] op_sel_hi:[1,1,0]
v_fma_mix_f32 v167, v144, v144, v167 op_sel:[0,0,0] op_sel_hi:[1,1,0]
v_fma_mix_f32 v167, v149, v149, v167 op_sel:[0,0,0] op_sel_hi:[1,1,0]
v_fma_mix_f32 v167, v145, v145, v167 op_sel:[1,1,0] op_sel_hi:[1,1,0]
v_fma_mix_f32 v167, v149, v149, v167 op_sel:[1,1,0] op_sel_hi:[1,1,0]
s_setprio 1
v_cvt_pkrtz_f16_f32 v137, v120, v121
v_cvt_pkrtz_f16_f32 v139, v122, v123
v_cvt_pkrtz_f16_f32 v141, v124, v125
v_cvt_pkrtz_f16_f32 v143, v126, v127
v_cvt_pkrtz_f16_f32 v145, v128, v129
v_cvt_pk_f16_f32 v155, v130, v131
v_cvt_pk_f16_f32 v152, v132, v133
v_cvt_pk_f16_f32 v149, v134, v135
ds_read_b128 v[224:227], v248 offset:27648
v_mfma_f32_32x32x16_bf16 v[120:135], v[72:75], v[228:231], 0
v_pk_fma_f16 v154, v155, v155, s48
v_and_b32_e64 v137, s49, v137
v_pk_fma_f16 v151, v152, v152, s48
v_and_b32_e64 v139, s49, v139
v_pk_fma_f16 v148, v149, v149, s48
v_pk_mul_f16 v154, v155, v154
v_bfe_u32 v136, v137, 2, 14
v_pk_mul_f16 v151, v152, v151
v_pk_mul_f16 v148, v149, v148
v_bfe_u32 v138, v139, 2, 14
ds_read_b128 v[228:231], v250 offset:65520
ds_read_u16_d16 v136, v136
ds_read_u16_d16 v138, v138
v_mfma_f32_32x32x16_bf16 v[120:135], v[76:79], v[232:235], v[120:135]
v_exp_f16 v153, v154
v_lshrrev_b32 v137, 18, v137
v_exp_f16 v150, v151
v_lshrrev_b32 v139, 18, v139
v_exp_f16 v147, v148
v_and_b32 v141, s49, v141
v_and_b32_e64 v143, s49, v143
ds_read_b128 v[232:235], v248 offset:28672
ds_read_u16_d16_hi v137, v137
ds_read_b32 v247, v253 offset:12
ds_read_u16_d16_hi v139, v139
v_mfma_f32_32x32x16_bf16 v[120:135], v[80:83], v[236:239], v[120:135]
v_exp_f16_sdwa v153, v154 dst_sel:WORD_1 dst_unused:UNUSED_PRESERVE src0_sel:WORD_1
v_bfe_u32 v140, v141, 2, 14
v_exp_f16_sdwa v150, v151 dst_sel:WORD_1 dst_unused:UNUSED_PRESERVE src0_sel:WORD_1
v_bfe_u32 v142, v143, 2, 14
v_exp_f16_sdwa v147, v148 dst_sel:WORD_1 dst_unused:UNUSED_PRESERVE src0_sel:WORD_1
v_lshrrev_b32_e64 v141, 18, v141
v_pk_add_f16 v153, v153, 1.0 op_sel_hi:[1,0]
ds_read_b128 v[236:239], v248 offset:31744
ds_read_u16_d16 v140, v140
ds_read_u16_d16 v142, v142
ds_read_u16_d16_hi v141, v141
v_mfma_f32_32x32x16_bf16 v[120:135], v[84:87], v[216:219], v[120:135]
v_lshrrev_b32_e64 v143, 18, v143
v_pk_add_f16 v150, v150, 1.0 op_sel_hi:[1,0]
v_pk_add_f16 v147, v147, 1.0 op_sel_hi:[1,0]
v_and_b32 v145, s49, v145
v_rcp_f16 v154, v153
v_bfe_u32 v144, v145, 2, 14
ds_read_u16_d16_hi v143, v143
ds_read_u16_d16 v144, v144
s_waitcnt lgkmcnt(7)
v_readfirstlane_b32 s43, v247
s_nop 1
s_cmp_ge_u32 s43, 24
s_cbranch_scc1 Lev5
Lev5w:
s_sleep 1
ds_read_b32 v247, v253 offset:12
s_waitcnt lgkmcnt(0)
v_readfirstlane_b32 s43, v247
s_cmp_eq_u32 s76, 0
s_cbranch_scc1 Lev5
s_sub_u32 s76, s76, 1
s_cmp_lt_u32 s43, 24
s_cbranch_scc1 Lev5w
Lev5:
v_rcp_f16 v151, v150
v_lshrrev_b32_e64 v145, 18, v145
ds_read_b128 v[216:219], v248 offset:29696
ds_read_u16_d16_hi v145, v145
v_mfma_f32_32x32x16_bf16 v[120:135], v[88:91], v[220:223], v[120:135]
v_rcp_f16_e64 v148, v147
v_rcp_f16_sdwa v154, v153 dst_sel:WORD_1 dst_unused:UNUSED_PRESERVE src0_sel:WORD_1
v_fma_mix_f32 v156, v136, v136, v156 op_sel:[0,0,0] op_sel_hi:[1,1,0]
s_setprio 0
v_fma_mix_f32 v156, v137, v137, v156 op_sel:[1,1,0] op_sel_hi:[1,1,0]
v_rcp_f16_sdwa v151, v150 dst_sel:WORD_1 dst_unused:UNUSED_PRESERVE src0_sel:WORD_1
v_fma_mix_f32 v156, v138, v138, v156 op_sel:[0,0,0] op_sel_hi:[1,1,0]
ds_read_b128 v[220:223], v245
ds_read_b128 v[192:195], v242
ds_read_b128 v[196:199], v242 offset:64
v_mfma_f32_32x32x16_bf16 v[120:135], v[92:95], v[224:227], v[120:135]
v_rcp_f16_sdwa v148, v147 dst_sel:WORD_1 dst_unused:UNUSED_PRESERVE src0_sel:WORD_1
s_waitcnt lgkmcnt(5)
v_fma_mix_f32 v156, v139, v139, v156 op_sel:[1,1,0] op_sel_hi:[1,1,0]
v_pk_mul_f16 v155, v155, v154
v_fma_mix_f32 v156, v140, v140, v156 op_sel:[0,0,0] op_sel_hi:[1,1,0]
v_pk_mul_f16 v152, v152, v151
v_fma_mix_f32 v156, v141, v141, v156 op_sel:[1,1,0] op_sel_hi:[1,1,0]
v_pk_mul_f16 v149, v149, v148
v_fma_mix_f32 v156, v155, v155, v156 op_sel:[0,0,0] op_sel_hi:[1,1,0]
v_fma_mix_f32 v156, v142, v142, v156 op_sel:[0,0,0] op_sel_hi:[1,1,0]
v_fma_mix_f32 v156, v155, v155, v156 op_sel:[1,1,0] op_sel_hi:[1,1,0]
v_fma_mix_f32 v156, v143, v143, v156 op_sel:[1,1,0] op_sel_hi:[1,1,0]
v_fma_mix_f32 v156, v152, v152, v156 op_sel:[0,0,0] op_sel_hi:[1,1,0]
v_fma_mix_f32 v156, v152, v152, v156 op_sel:[1,1,0] op_sel_hi:[1,1,0]
v_fma_mix_f32 v156, v144, v144, v156 op_sel:[0,0,0] op_sel_hi:[1,1,0]
v_fma_mix_f32 v156, v149, v149, v156 op_sel:[0,0,0] op_sel_hi:[1,1,0]
s_waitcnt lgkmcnt(3)
v_fma_mix_f32 v156, v145, v145, v156 op_sel:[1,1,0] op_sel_hi:[1,1,0]
v_fma_mix_f32 v156, v149, v149, v156 op_sel:[1,1,0] op_sel_hi:[1,1,0]
s_setprio 2
v_mfma_f32_32x32x16_bf16 v[0:15], v[228:231], v[228:231], 0
buffer_store_dwordx4 v[48:51], v241, s[32:35], s80 offen sc1
ds_read_b128 v[224:227], v248 offset:32768
v_cvt_pkrtz_f16_f32 v137, v120, v121
v_cvt_pkrtz_f16_f32 v139, v122, v123
v_cvt_pkrtz_f16_f32 v141, v124, v125
v_mfma_f32_32x32x16_bf16 v[16:31], v[228:231], v[228:231], 0
v_cvt_pkrtz_f16_f32 v143, v126, v127
v_cvt_pkrtz_f16_f32 v145, v128, v129
v_cvt_pk_f16_f32 v155, v130, v131
v_cvt_pk_f16_f32 v152, v132, v133
v_mfma_f32_32x32x16_bf16 v[32:47], v[228:231], v[228:231], 0
v_cvt_pk_f16_f32 v149, v134, v135
v_pk_fma_f16 v154, v155, v155, s48
v_and_b32_e64 v137, s49, v137
v_mfma_f32_32x32x16_bf16 v[120:135], v[72:75], v[232:235], 0
ds_read_b128 v[228:231], v248 offset:30720
v_pk_fma_f16 v151, v152, v152, s48
v_and_b32_e64 v139, s49, v139
v_pk_fma_f16 v148, v149, v149, s48
v_pk_mul_f16 v154, v155, v154
v_bfe_u32 v136, v137, 2, 14
v_pk_mul_f16 v151, v152, v151
v_pk_mul_f16 v148, v149, v148
v_mfma_f32_32x32x16_bf16 v[120:135], v[76:79], v[236:239], v[120:135]
ds_read_b128 v[232:235], v245 offset:384
ds_read_b128 v[200:203], v242 offset:128
ds_read_b128 v[204:207], v243
ds_read_u16_d16 v136, v136
v_bfe_u32 v138, v139, 2, 14
v_exp_f16 v153, v154
v_lshrrev_b32 v137, 18, v137
v_exp_f16 v150, v151
v_lshrrev_b32 v139, 18, v139
v_mfma_f32_32x32x16_bf16 v[120:135], v[80:83], v[216:219], v[120:135]
ds_read_b128 v[236:239], v248 offset:33792
ds_read_u16_d16 v138, v138
ds_read_u16_d16_hi v137, v137
ds_read_u16_d16_hi v139, v139
v_exp_f16 v147, v148
v_and_b32 v141, s49, v141
v_and_b32 v143, s49, v143
v_exp_f16_sdwa v153, v154 dst_sel:WORD_1 dst_unused:UNUSED_PRESERVE src0_sel:WORD_1
v_bfe_u32 v140, v141, 2, 14
s_waitcnt lgkmcnt(8)
v_smfmac_f32_16x16x32_bf16 v[0:3], v[220:221], v[192:195], v246
ds_read_b128 v[216:219], v245 offset:768
ds_read_b128 v[208:211], v243 offset:64
ds_read_b128 v[212:215], v243 offset:128
ds_read_u16_d16 v140, v140
v_exp_f16_sdwa v150, v151 dst_sel:WORD_1 dst_unused:UNUSED_PRESERVE src0_sel:WORD_1
v_bfe_u32 v142, v143, 2, 14
v_smfmac_f32_16x16x32_bf16 v[16:19], v[222:223], v[196:199], v246
v_exp_f16_sdwa v147, v148 dst_sel:WORD_1 dst_unused:UNUSED_PRESERVE src0_sel:WORD_1
v_lshrrev_b32_e64 v141, 18, v141
v_pk_add_f16 v153, v153, 1.0 op_sel_hi:[1,0]
v_lshrrev_b32_e64 v143, 18, v143
v_mfma_f32_32x32x16_bf16 v[120:135], v[84:87], v[224:227], v[120:135]
ds_read_b128 v[220:223], v245 offset:1152
ds_read_b128 v[192:195], v244
ds_read_b128 v[196:199], v244 offset:64
ds_read_u16_d16 v142, v142
ds_read_u16_d16_hi v141, v141
ds_read_u16_d16_hi v143, v143
v_pk_add_f16 v150, v150, 1.0 op_sel_hi:[1,0]
v_pk_add_f16 v147, v147, 1.0 op_sel_hi:[1,0]
v_and_b32 v145, s49, v145
v_rcp_f16 v154, v153
v_bfe_u32 v144, v145, 2, 14
v_mfma_f32_32x32x16_bf16 v[120:135], v[88:91], v[228:231], v[120:135]
ds_read_b128 v[224:227], v248 offset:34816
ds_read_u16_d16 v144, v144
v_rcp_f16 v151, v150
v_lshrrev_b32 v145, 18, v145
v_rcp_f16_e64 v148, v147
v_rcp_f16_sdwa v154, v153 dst_sel:WORD_1 dst_unused:UNUSED_PRESERVE src0_sel:WORD_1
ds_read_u16_d16_hi v145, v145
s_waitcnt lgkmcnt(9)
v_fma_mix_f32 v157, v136, v136, v157 op_sel:[0,0,0] op_sel_hi:[1,1,0]
v_smfmac_f32_16x16x32_bf16 v[32:35], v[232:233], v[200:203], v246
ds_read_b128 v[228:231], v248 offset:37888
v_fma_mix_f32 v157, v137, v137, v157 op_sel:[1,1,0] op_sel_hi:[1,1,0]
v_rcp_f16_sdwa v151, v150 dst_sel:WORD_1 dst_unused:UNUSED_PRESERVE src0_sel:WORD_1
v_fma_mix_f32 v157, v138, v138, v157 op_sel:[0,0,0] op_sel_hi:[1,1,0]
v_smfmac_f32_16x16x32_bf16 v[0:3], v[234:235], v[204:207], v246
v_rcp_f16_sdwa v148, v147 dst_sel:WORD_1 dst_unused:UNUSED_PRESERVE src0_sel:WORD_1
v_fma_mix_f32 v157, v139, v139, v157 op_sel:[1,1,0] op_sel_hi:[1,1,0]
v_mfma_f32_32x32x16_bf16 v[120:135], v[92:95], v[236:239], v[120:135]
ds_read_b128 v[232:235], v248 offset:35840
v_pk_mul_f16 v155, v155, v154
v_fma_mix_f32 v157, v140, v140, v157 op_sel:[0,0,0] op_sel_hi:[1,1,0]
v_pk_mul_f16 v152, v152, v151
s_waitcnt lgkmcnt(5)
v_fma_mix_f32 v157, v141, v141, v157 op_sel:[1,1,0] op_sel_hi:[1,1,0]
v_pk_mul_f16 v149, v149, v148
v_fma_mix_f32 v157, v155, v155, v157 op_sel:[0,0,0] op_sel_hi:[1,1,0]
v_fma_mix_f32 v157, v142, v142, v157 op_sel:[0,0,0] op_sel_hi:[1,1,0]
v_smfmac_f32_16x16x32_bf16 v[16:19], v[216:217], v[208:211], v246
ds_read_b128 v[236:239], v248 offset:38912
v_fma_mix_f32 v157, v155, v155, v157 op_sel:[1,1,0] op_sel_hi:[1,1,0]
v_fma_mix_f32 v157, v143, v143, v157 op_sel:[1,1,0] op_sel_hi:[1,1,0]
v_fma_mix_f32 v157, v152, v152, v157 op_sel:[0,0,0] op_sel_hi:[1,1,0]
v_fma_mix_f32 v157, v152, v152, v157 op_sel:[1,1,0] op_sel_hi:[1,1,0]
v_smfmac_f32_16x16x32_bf16 v[32:35], v[218:219], v[212:215], v246
s_waitcnt lgkmcnt(3)
v_fma_mix_f32 v157, v144, v144, v157 op_sel:[0,0,0] op_sel_hi:[1,1,0]
v_fma_mix_f32 v157, v149, v149, v157 op_sel:[0,0,0] op_sel_hi:[1,1,0]
v_fma_mix_f32 v157, v145, v145, v157 op_sel:[1,1,0] op_sel_hi:[1,1,0]
v_fma_mix_f32 v157, v149, v149, v157 op_sel:[1,1,0] op_sel_hi:[1,1,0]
s_setprio 1
v_smfmac_f32_16x16x32_bf16 v[0:3], v[220:221], v[192:195], v246
s_add_u32 s46, s80, 2097152
buffer_store_dwordx4 v[52:55], v241, s[32:35], s46 offen sc1
ds_read_b128 v[216:219], v248 offset:36864
v_cvt_pkrtz_f16_f32 v137, v120, v121
v_cvt_pkrtz_f16_f32 v139, v122, v123
v_cvt_pkrtz_f16_f32 v141, v124, v125
v_cvt_pkrtz_f16_f32 v143, v126, v127
v_cvt_pk_f16_f32 v155, v128, v129
v_smfmac_f32_16x16x32_bf16 v[16:19], v[222:223], v[196:199], v246
v_cvt_pk_f16_f32 v152, v130, v131
v_cvt_pk_f16_f32 v149, v132, v133
v_cvt_pk_f16_f32 v146, v134, v135
v_pk_fma_f16 v154, v155, v155, s48
v_and_b32_e64 v137, s49, v137
v_mfma_f32_32x32x16_bf16 v[120:135], v[72:75], v[224:227], 0
ds_read_b128 v[220:223], v248 offset:39936
v_pk_fma_f16 v151, v152, v152, s48
v_pk_fma_f16 v148, v149, v149, s48
v_and_b32_e64 v139, s49, v139
v_pk_fma_f16 v145, v146, v146, s48
v_pk_mul_f16 v154, v155, v154
v_bfe_u32 v136, v137, 2, 14
v_pk_mul_f16 v151, v152, v151
v_pk_mul_f16 v148, v149, v148
v_bfe_u32 v138, v139, 2, 14
v_pk_mul_f16 v145, v146, v145
s_waitcnt lgkmcnt(2)
v_mfma_f32_32x32x16_bf16 v[120:135], v[76:79], v[228:231], v[120:135]
ds_read_b128 v[224:227], v245 offset:1536
ds_read_b128 v[200:203], v244 offset:128
v_xor_b32 v242, 16, v242
ds_read_b128 v[204:207], v242
ds_read_u16_d16 v136, v136
ds_read_u16_d16 v138, v138
v_exp_f16 v153, v154
v_lshrrev_b32 v137, 18, v137
v_exp_f16 v150, v151
v_lshrrev_b32 v139, 18, v139
v_exp_f16 v147, v148
v_and_b32 v141, s49, v141
v_exp_f16_e64 v144, v145
v_mfma_f32_32x32x16_bf16 v[120:135], v[80:83], v[232:235], v[120:135]
ds_read_b128 v[228:231], v245 offset:1920
ds_read_b128 v[208:211], v242 offset:64
ds_read_b128 v[212:215], v242 offset:128
ds_read_u16_d16_hi v137, v137
ds_read_u16_d16_hi v139, v139
v_and_b32_e64 v143, s49, v143
v_exp_f16_sdwa v153, v154 dst_sel:WORD_1 dst_unused:UNUSED_PRESERVE src0_sel:WORD_1
v_bfe_u32 v140, v141, 2, 14
v_exp_f16_sdwa v150, v151 dst_sel:WORD_1 dst_unused:UNUSED_PRESERVE src0_sel:WORD_1
v_bfe_u32 v142, v143, 2, 14
v_exp_f16_sdwa v147, v148 dst_sel:WORD_1 dst_unused:UNUSED_PRESERVE src0_sel:WORD_1
v_lshrrev_b32_e64 v141, 18, v141
v_mfma_f32_32x32x16_bf16 v[120:135], v[84:87], v[236:239], v[120:135]
ds_read_b128 v[232:235], v248 offset:40960
ds_read_u16_d16 v140, v140
ds_read_u16_d16 v142, v142
ds_read_u16_d16_hi v141, v141
v_exp_f16_sdwa v144, v145 dst_sel:WORD_1 dst_unused:UNUSED_PRESERVE src0_sel:WORD_1
v_lshrrev_b32_e64 v143, 18, v143
v_pk_add_f16 v153, v153, 1.0 op_sel_hi:[1,0]
v_pk_add_f16 v150, v150, 1.0 op_sel_hi:[1,0]
v_pk_add_f16 v147, v147, 1.0 op_sel_hi:[1,0]
v_pk_add_f16 v144, v144, 1.0 op_sel_hi:[1,0]
v_rcp_f16_e64 v154, v153
v_rcp_f16 v151, v150
s_waitcnt lgkmcnt(8)
v_mfma_f32_32x32x16_bf16 v[120:135], v[88:91], v[216:219], v[120:135]
ds_read_b128 v[236:239], v248 offset:44032
ds_read_u16_d16_hi v143, v143
v_rcp_f16 v148, v147
v_rcp_f16 v145, v144
v_rcp_f16_sdwa v154, v153 dst_sel:WORD_1 dst_unused:UNUSED_PRESERVE src0_sel:WORD_1
v_rcp_f16_sdwa v151, v150 dst_sel:WORD_1 dst_unused:UNUSED_PRESERVE src0_sel:WORD_1
s_setprio 0
v_rcp_f16_sdwa v148, v147 dst_sel:WORD_1 dst_unused:UNUSED_PRESERVE src0_sel:WORD_1
v_fma_mix_f32 v158, v136, v136, v158 op_sel:[0,0,0] op_sel_hi:[1,1,0]
v_mfma_f32_32x32x16_bf16 v[120:135], v[92:95], v[220:223], v[120:135]
ds_read_b128 v[216:219], v248 offset:41984
v_rcp_f16_sdwa v145, v144 dst_sel:WORD_1 dst_unused:UNUSED_PRESERVE src0_sel:WORD_1
s_waitcnt lgkmcnt(5)
v_fma_mix_f32 v158, v137, v137, v158 op_sel:[1,1,0] op_sel_hi:[1,1,0]
v_pk_mul_f16 v155, v155, v154
v_fma_mix_f32 v158, v138, v138, v158 op_sel:[0,0,0] op_sel_hi:[1,1,0]
v_pk_mul_f16 v152, v152, v151
v_pk_mul_f16 v149, v149, v148
v_fma_mix_f32 v158, v139, v139, v158 op_sel:[1,1,0] op_sel_hi:[1,1,0]
v_pk_mul_f16 v146, v146, v145
v_fma_mix_f32 v158, v155, v155, v158 op_sel:[0,0,0] op_sel_hi:[1,1,0]
v_smfmac_f32_16x16x32_bf16 v[32:35], v[224:225], v[200:203], v246
ds_read_b128 v[220:223], v248 offset:45056
v_fma_mix_f32 v158, v140, v140, v158 op_sel:[0,0,0] op_sel_hi:[1,1,0]
v_fma_mix_f32 v158, v155, v155, v158 op_sel:[1,1,0] op_sel_hi:[1,1,0]
v_fma_mix_f32 v158, v152, v152, v158 op_sel:[0,0,0] op_sel_hi:[1,1,0]
s_waitcnt lgkmcnt(2)
v_fma_mix_f32 v158, v141, v141, v158 op_sel:[1,1,0] op_sel_hi:[1,1,0]
v_fma_mix_f32 v158, v152, v152, v158 op_sel:[1,1,0] op_sel_hi:[1,1,0]
v_smfmac_f32_16x16x32_bf16 v[4:7], v[226:227], v[204:207], v246
v_fma_mix_f32 v158, v149, v149, v158 op_sel:[0,0,0] op_sel_hi:[1,1,0]
v_fma_mix_f32 v158, v142, v142, v158 op_sel:[0,0,0] op_sel_hi:[1,1,0]
v_fma_mix_f32 v158, v149, v149, v158 op_sel:[1,1,0] op_sel_hi:[1,1,0]
v_fma_mix_f32 v158, v146, v146, v158 op_sel:[0,0,0] op_sel_hi:[1,1,0]
v_fma_mix_f32 v158, v143, v143, v158 op_sel:[1,1,0] op_sel_hi:[1,1,0]
v_fma_mix_f32 v158, v146, v146, v158 op_sel:[1,1,0] op_sel_hi:[1,1,0]
s_setprio 2
v_smfmac_f32_16x16x32_bf16 v[20:23], v[228:229], v[208:211], v246
s_add_u32 s46, s80, 4194304
buffer_store_dwordx4 v[56:59], v241, s[32:35], s46 offen sc1
ds_read_b128 v[224:227], v248 offset:43008
v_cvt_pkrtz_f16_f32 v137, v120, v121
v_cvt_pkrtz_f16_f32 v139, v122, v123
v_cvt_pkrtz_f16_f32 v141, v124, v125
v_cvt_pkrtz_f16_f32 v143, v126, v127
v_smfmac_f32_16x16x32_bf16 v[36:39], v[230:231], v[212:215], v246
v_cvt_pkrtz_f16_f32 v145, v128, v129
v_cvt_pk_f16_f32 v155, v130, v131
v_cvt_pk_f16_f32 v152, v132, v133
v_cvt_pk_f16_f32 v149, v134, v135
v_pk_fma_f16 v154, v155, v155, s48
v_mfma_f32_32x32x16_bf16 v[120:135], v[72:75], v[232:235], 0
ds_read_b128 v[228:231], v248 offset:46080
v_and_b32_e64 v137, s49, v137
v_pk_fma_f16 v151, v152, v152, s48
v_and_b32_e64 v139, s49, v139
v_pk_fma_f16 v148, v149, v149, s48
v_pk_mul_f16 v154, v155, v154
v_bfe_u32 v136, v137, 2, 14
v_pk_mul_f16 v151, v152, v151
v_pk_mul_f16 v148, v149, v148
v_bfe_u32 v138, v139, 2, 14
v_mfma_f32_32x32x16_bf16 v[120:135], v[76:79], v[236:239], v[120:135]
ds_read_b128 v[232:235], v245 offset:2304
v_xor_b32 v243, 16, v243
ds_read_b128 v[192:195], v243
ds_read_b128 v[196:199], v243 offset:64
ds_read_u16_d16 v136, v136
ds_read_u16_d16 v138, v138
v_exp_f16 v153, v154
v_lshrrev_b32 v137, 18, v137
v_exp_f16 v150, v151
v_lshrrev_b32 v139, 18, v139
v_exp_f16 v147, v148
v_and_b32 v141, s49, v141
v_and_b32 v143, s49, v143
s_waitcnt lgkmcnt(6)
v_mfma_f32_32x32x16_bf16 v[120:135], v[80:83], v[216:219], v[120:135]
ds_read_b128 v[236:239], v245 offset:2688
ds_read_b128 v[200:203], v243 offset:128
v_xor_b32 v244, 16, v244
ds_read_b128 v[204:207], v244
ds_read_u16_d16_hi v137, v137
ds_read_u16_d16_hi v139, v139
v_exp_f16_sdwa v153, v154 dst_sel:WORD_1 dst_unused:UNUSED_PRESERVE src0_sel:WORD_1
v_bfe_u32 v140, v141, 2, 14
v_exp_f16_sdwa v150, v151 dst_sel:WORD_1 dst_unused:UNUSED_PRESERVE src0_sel:WORD_1
v_bfe_u32 v142, v143, 2, 14
v_exp_f16_sdwa v147, v148 dst_sel:WORD_1 dst_unused:UNUSED_PRESERVE src0_sel:WORD_1
v_lshrrev_b32_e64 v141, 18, v141
v_mfma_f32_32x32x16_bf16 v[120:135], v[84:87], v[220:223], v[120:135]
ds_read_b128 v[216:219], v248 offset:47104
ds_read_u16_d16 v140, v140
ds_read_u16_d16 v142, v142
ds_read_u16_d16_hi v141, v141
v_pk_add_f16 v153, v153, 1.0 op_sel_hi:[1,0]
v_lshrrev_b32_e64 v143, 18, v143
v_pk_add_f16 v150, v150, 1.0 op_sel_hi:[1,0]
v_pk_add_f16 v147, v147, 1.0 op_sel_hi:[1,0]
v_and_b32 v145, s49, v145
v_rcp_f16 v154, v153
v_bfe_u32 v144, v145, 2, 14
v_mfma_f32_32x32x16_bf16 v[120:135], v[88:91], v[224:227], v[120:135]
ds_read_b128 v[220:223], v248 offset:50176
ds_read_u16_d16_hi v143, v143
ds_read_u16_d16 v144, v144
v_rcp_f16 v151, v150
v_lshrrev_b32 v145, 18, v145
v_rcp_f16 v148, v147
v_rcp_f16_sdwa v154, v153 dst_sel:WORD_1 dst_unused:UNUSED_PRESERVE src0_sel:WORD_1
ds_read_u16_d16_hi v145, v145
s_waitcnt lgkmcnt(8)
v_fma_mix_f32 v159, v136, v136, v159 op_sel:[0,0,0] op_sel_hi:[1,1,0]
v_fma_mix_f32 v159, v137, v137, v159 op_sel:[1,1,0] op_sel_hi:[1,1,0]
v_rcp_f16_sdwa v151, v150 dst_sel:WORD_1 dst_unused:UNUSED_PRESERVE src0_sel:WORD_1
v_mfma_f32_32x32x16_bf16 v[120:135], v[92:95], v[228:231], v[120:135]
ds_read_b128 v[224:227], v248 offset:48128
v_fma_mix_f32 v159, v138, v138, v159 op_sel:[0,0,0] op_sel_hi:[1,1,0]
v_rcp_f16_sdwa v148, v147 dst_sel:WORD_1 dst_unused:UNUSED_PRESERVE src0_sel:WORD_1
v_fma_mix_f32 v159, v139, v139, v159 op_sel:[1,1,0] op_sel_hi:[1,1,0]
v_pk_mul_f16 v155, v155, v154
s_waitcnt lgkmcnt(5)
v_fma_mix_f32 v159, v140, v140, v159 op_sel:[0,0,0] op_sel_hi:[1,1,0]
v_pk_mul_f16 v152, v152, v151
v_fma_mix_f32 v159, v141, v141, v159 op_sel:[1,1,0] op_sel_hi:[1,1,0]
v_pk_mul_f16 v149, v149, v148
v_smfmac_f32_16x16x32_bf16 v[4:7], v[232:233], v[192:195], v246
ds_read_b128 v[228:231], v248 offset:51200
v_fma_mix_f32 v159, v155, v155, v159 op_sel:[0,0,0] op_sel_hi:[1,1,0]
v_fma_mix_f32 v159, v142, v142, v159 op_sel:[0,0,0] op_sel_hi:[1,1,0]
v_fma_mix_f32 v159, v155, v155, v159 op_sel:[1,1,0] op_sel_hi:[1,1,0]
s_waitcnt lgkmcnt(3)
v_fma_mix_f32 v159, v143, v143, v159 op_sel:[1,1,0] op_sel_hi:[1,1,0]
v_fma_mix_f32 v159, v152, v152, v159 op_sel:[0,0,0] op_sel_hi:[1,1,0]
v_smfmac_f32_16x16x32_bf16 v[20:23], v[234:235], v[196:199], v246
v_fma_mix_f32 v159, v152, v152, v159 op_sel:[1,1,0] op_sel_hi:[1,1,0]
v_fma_mix_f32 v159, v144, v144, v159 op_sel:[0,0,0] op_sel_hi:[1,1,0]
v_fma_mix_f32 v159, v149, v149, v159 op_sel:[0,0,0] op_sel_hi:[1,1,0]
s_waitcnt lgkmcnt(2)
v_fma_mix_f32 v159, v145, v145, v159 op_sel:[1,1,0] op_sel_hi:[1,1,0]
v_fma_mix_f32 v159, v149, v149, v159 op_sel:[1,1,0] op_sel_hi:[1,1,0]
s_setprio 1
v_smfmac_f32_16x16x32_bf16 v[36:39], v[236:237], v[200:203], v246
s_add_u32 s46, s80, 6291456
buffer_store_dwordx4 v[60:63], v241, s[32:35], s46 offen sc1
ds_read_b128 v[232:235], v248 offset:49152
v_cvt_pkrtz_f16_f32 v137, v120, v121
v_cvt_pkrtz_f16_f32 v139, v122, v123
v_cvt_pkrtz_f16_f32 v141, v124, v125
v_cvt_pkrtz_f16_f32 v143, v126, v127
v_cvt_pk_f16_f32 v155, v128, v129
v_smfmac_f32_16x16x32_bf16 v[4:7], v[238:239], v[204:207], v246
v_cvt_pk_f16_f32 v152, v130, v131
v_cvt_pk_f16_f32 v149, v132, v133
v_cvt_pk_f16_f32 v146, v134, v135
v_pk_fma_f16 v154, v155, v155, s48
v_and_b32_e64 v137, s49, v137
v_mfma_f32_32x32x16_bf16 v[120:135], v[72:75], v[216:219], 0
ds_read_b128 v[236:239], v248 offset:52224
v_pk_fma_f16 v151, v152, v152, s48
v_pk_fma_f16 v148, v149, v149, s48
v_and_b32_e64 v139, s49, v139
v_pk_fma_f16 v145, v146, v146, s48
v_pk_mul_f16 v154, v155, v154
v_bfe_u32 v136, v137, 2, 14
v_pk_mul_f16 v151, v152, v151
v_pk_mul_f16 v148, v149, v148
v_bfe_u32 v138, v139, 2, 14
v_pk_mul_f16 v145, v146, v145
v_mfma_f32_32x32x16_bf16 v[120:135], v[76:79], v[220:223], v[120:135]
ds_read_b128 v[216:219], v245 offset:3072
ds_read_b128 v[208:211], v244 offset:64
ds_read_b128 v[212:215], v244 offset:128
ds_read_u16_d16 v136, v136
ds_read_u16_d16 v138, v138
v_exp_f16 v153, v154
v_lshrrev_b32 v137, 18, v137
v_exp_f16 v150, v151
v_lshrrev_b32 v139, 18, v139
v_exp_f16 v147, v148
v_and_b32 v141, s49, v141
v_exp_f16_e64 v144, v145
s_waitcnt lgkmcnt(6)
v_mfma_f32_32x32x16_bf16 v[120:135], v[80:83], v[224:227], v[120:135]
ds_read_b128 v[220:223], v245 offset:3456
v_xor_b32 v242, 32, v242
ds_read_b128 v[192:195], v242
ds_read_b128 v[196:199], v242 offset:64
ds_read_u16_d16_hi v137, v137
ds_read_u16_d16_hi v139, v139
v_and_b32_e64 v143, s49, v143
v_exp_f16_sdwa v153, v154 dst_sel:WORD_1 dst_unused:UNUSED_PRESERVE src0_sel:WORD_1
v_bfe_u32 v140, v141, 2, 14
v_exp_f16_sdwa v150, v151 dst_sel:WORD_1 dst_unused:UNUSED_PRESERVE src0_sel:WORD_1
v_bfe_u32 v142, v143, 2, 14
v_exp_f16_sdwa v147, v148 dst_sel:WORD_1 dst_unused:UNUSED_PRESERVE src0_sel:WORD_1
v_lshrrev_b32_e64 v141, 18, v141
v_mfma_f32_32x32x16_bf16 v[120:135], v[84:87], v[228:231], v[120:135]
ds_read_b128 v[224:227], v248 offset:53248
ds_read_u16_d16 v140, v140
ds_read_u16_d16 v142, v142
ds_read_u16_d16_hi v141, v141
v_exp_f16_sdwa v144, v145 dst_sel:WORD_1 dst_unused:UNUSED_PRESERVE src0_sel:WORD_1
v_lshrrev_b32_e64 v143, 18, v143
v_pk_add_f16 v153, v153, 1.0 op_sel_hi:[1,0]
v_pk_add_f16 v150, v150, 1.0 op_sel_hi:[1,0]
v_pk_add_f16 v147, v147, 1.0 op_sel_hi:[1,0]
v_pk_add_f16 v144, v144, 1.0 op_sel_hi:[1,0]
v_rcp_f16 v154, v153
v_rcp_f16 v151, v150
v_mfma_f32_32x32x16_bf16 v[120:135], v[88:91], v[232:235], v[120:135]
ds_read_b128 v[228:231], v248 offset:56320
ds_read_u16_d16_hi v143, v143
v_rcp_f16 v148, v147
v_rcp_f16 v145, v144
v_rcp_f16_sdwa v154, v153 dst_sel:WORD_1 dst_unused:UNUSED_PRESERVE src0_sel:WORD_1
v_rcp_f16_sdwa v151, v150 dst_sel:WORD_1 dst_unused:UNUSED_PRESERVE src0_sel:WORD_1
s_setprio 0
v_rcp_f16_sdwa v148, v147 dst_sel:WORD_1 dst_unused:UNUSED_PRESERVE src0_sel:WORD_1
s_waitcnt lgkmcnt(6)
v_fma_mix_f32 v160, v136, v136, v160 op_sel:[0,0,0] op_sel_hi:[1,1,0]
v_mfma_f32_32x32x16_bf16 v[120:135], v[92:95], v[236:239], v[120:135]
ds_read_b128 v[232:235], v248 offset:54272
v_rcp_f16_sdwa v145, v144 dst_sel:WORD_1 dst_unused:UNUSED_PRESERVE src0_sel:WORD_1
v_fma_mix_f32 v160, v137, v137, v160 op_sel:[1,1,0] op_sel_hi:[1,1,0]
v_pk_mul_f16 v155, v155, v154
v_fma_mix_f32 v160, v138, v138, v160 op_sel:[0,0,0] op_sel_hi:[1,1,0]
v_pk_mul_f16 v152, v152, v151
v_pk_mul_f16 v149, v149, v148
v_fma_mix_f32 v160, v139, v139, v160 op_sel:[1,1,0] op_sel_hi:[1,1,0]
v_pk_mul_f16 v146, v146, v145
v_fma_mix_f32 v160, v155, v155, v160 op_sel:[0,0,0] op_sel_hi:[1,1,0]
v_smfmac_f32_16x16x32_bf16 v[20:23], v[216:217], v[208:211], v246
ds_read_b128 v[236:239], v248 offset:57344
s_waitcnt lgkmcnt(4)
v_fma_mix_f32 v160, v140, v140, v160 op_sel:[0,0,0] op_sel_hi:[1,1,0]
v_fma_mix_f32 v160, v155, v155, v160 op_sel:[1,1,0] op_sel_hi:[1,1,0]
v_fma_mix_f32 v160, v152, v152, v160 op_sel:[0,0,0] op_sel_hi:[1,1,0]
v_fma_mix_f32 v160, v141, v141, v160 op_sel:[1,1,0] op_sel_hi:[1,1,0]
v_fma_mix_f32 v160, v152, v152, v160 op_sel:[1,1,0] op_sel_hi:[1,1,0]
v_smfmac_f32_16x16x32_bf16 v[36:39], v[218:219], v[212:215], v246
v_fma_mix_f32 v160, v149, v149, v160 op_sel:[0,0,0] op_sel_hi:[1,1,0]
v_fma_mix_f32 v160, v142, v142, v160 op_sel:[0,0,0] op_sel_hi:[1,1,0]
v_fma_mix_f32 v160, v149, v149, v160 op_sel:[1,1,0] op_sel_hi:[1,1,0]
v_fma_mix_f32 v160, v146, v146, v160 op_sel:[0,0,0] op_sel_hi:[1,1,0]
s_waitcnt lgkmcnt(2)
v_fma_mix_f32 v160, v143, v143, v160 op_sel:[1,1,0] op_sel_hi:[1,1,0]
v_fma_mix_f32 v160, v146, v146, v160 op_sel:[1,1,0] op_sel_hi:[1,1,0]
s_cmp_lg_u32 s40, 7
s_cbranch_scc1 Lnobias2
s_sub_u32 s43, s2, 96
s_cmp_lt_u32 s43, 96
s_cbranch_scc0 Lnobias2
s_waitcnt vmcnt(15)
v_lshlrev_b32 v178, 16, v178
v_lshlrev_b32 v179, 16, v179
v_lshlrev_b32 v180, 16, v180
v_lshlrev_b32 v181, 16, v181
v_lshlrev_b32 v182, 16, v182
v_lshlrev_b32 v183, 16, v183
v_lshlrev_b32 v184, 16, v184
v_lshlrev_b32 v185, 16, v185
v_lshlrev_b32 v186, 16, v186
v_lshlrev_b32 v187, 16, v187
v_lshlrev_b32 v188, 16, v188
v_lshlrev_b32 v189, 16, v189
v_mul_f32 v176, v178, v184
v_fmac_f32 v176, v179, v185
v_fmac_f32 v176, v180, v186
v_fmac_f32 v176, v181, v187
v_fmac_f32 v176, v182, v188
v_fmac_f32 v176, v183, v189
s_nop 1
v_add_f32_dpp v176, v176, v176 row_ror:8 row_mask:0xf bank_mask:0xf
s_nop 1
v_add_f32_dpp v176, v176, v176 row_ror:4 row_mask:0xf bank_mask:0xf
s_nop 1
v_add_f32_dpp v176, v176, v176 row_ror:2 row_mask:0xf bank_mask:0xf
s_nop 1
v_add_f32_dpp v176, v176, v176 row_ror:1 row_mask:0xf bank_mask:0xf
v_mov_b32 v177, v176
s_nop 1
v_permlane16_swap_b32 v176, v177
v_add_f32 v176, v176, v177
v_mov_b32_e64 v177, v176
s_nop 1
v_permlane32_swap_b32 v176, v177
v_add_f32 v176, v176, v177
s_lshl_b32 s44, s43, 2
s_add_u32 s44, s44, 394752
v_lshlrev_b32_e64 v191, 11, v251
s_mov_b64 exec, 0xff
buffer_store_dword v176, v191, s[32:35], s44 offen sc1
s_mov_b64 exec, -1
Lnobias2:
s_setprio 2
v_smfmac_f32_16x16x32_bf16 v[12:15], v[220:221], v[192:195], v246
s_add_u32 s46, s80, 8388608
buffer_store_dwordx4 v[64:67], v241, s[32:35], s46 offen sc1
ds_read_b128 v[216:219], v248 offset:55296
v_cvt_pkrtz_f16_f32 v137, v120, v121
v_cvt_pkrtz_f16_f32 v139, v122, v123
v_cvt_pkrtz_f16_f32 v141, v124, v125
v_cvt_pkrtz_f16_f32 v143, v126, v127
v_smfmac_f32_16x16x32_bf16 v[28:31], v[222:223], v[196:199], v246
v_cvt_pkrtz_f16_f32 v145, v128, v129
v_cvt_pk_f16_f32 v155, v130, v131
v_cvt_pk_f16_f32 v152, v132, v133
v_cvt_pk_f16_f32 v149, v134, v135
v_mfma_f32_32x32x16_bf16 v[120:135], v[72:75], v[224:227], 0
ds_read_b128 v[220:223], v245 offset:3840
ds_read_b128 v[200:203], v242 offset:128
v_xor_b32 v243, 32, v243
ds_read_b128 v[204:207], v243
v_pk_fma_f16 v154, v155, v155, s48
v_and_b32 v137, s49, v137
v_pk_fma_f16 v151, v152, v152, s48
v_and_b32_e64 v139, s49, v139
v_pk_fma_f16 v148, v149, v149, s48
v_pk_mul_f16 v154, v155, v154
v_bfe_u32 v136, v137, 2, 14
v_pk_mul_f16 v151, v152, v151
v_mfma_f32_32x32x16_bf16 v[120:135], v[76:79], v[228:231], v[120:135]
ds_read_b128 v[224:227], v248 offset:58368
ds_read_u16_d16 v136, v136
v_pk_mul_f16 v148, v149, v148
v_bfe_u32 v138, v139, 2, 14
v_exp_f16 v153, v154
v_lshrrev_b32 v137, 18, v137
v_exp_f16_e64 v150, v151
v_lshrrev_b32 v139, 18, v139
s_waitcnt lgkmcnt(5)
v_mfma_f32_32x32x16_bf16 v[120:135], v[80:83], v[232:235], v[120:135]
ds_read_b128 v[228:231], v245 offset:4224
ds_read_b128 v[208:211], v243 offset:64
ds_read_b128 v[212:215], v243 offset:128
ds_read_u16_d16 v138, v138
ds_read_u16_d16_hi v137, v137
ds_read_u16_d16_hi v139, v139
v_exp_f16 v147, v148
v_and_b32 v141, s49, v141
v_and_b32 v143, s49, v143
v_exp_f16_sdwa v153, v154 dst_sel:WORD_1 dst_unused:UNUSED_PRESERVE src0_sel:WORD_1
v_bfe_u32 v140, v141, 2, 14
v_exp_f16_sdwa v150, v151 dst_sel:WORD_1 dst_unused:UNUSED_PRESERVE src0_sel:WORD_1
v_mfma_f32_32x32x16_bf16 v[120:135], v[84:87], v[236:239], v[120:135]
ds_read_b128 v[232:235], v245 offset:4608
v_xor_b32 v244, 32, v244
ds_read_b128 v[192:195], v244
ds_read_b128 v[196:199], v244 offset:64
ds_read_u16_d16 v140, v140
v_bfe_u32 v142, v143, 2, 14
v_exp_f16_sdwa v147, v148 dst_sel:WORD_1 dst_unused:UNUSED_PRESERVE src0_sel:WORD_1
v_lshrrev_b32_e64 v141, 18, v141
v_pk_add_f16 v153, v153, 1.0 op_sel_hi:[1,0]
v_lshrrev_b32_e64 v143, 18, v143
v_pk_add_f16 v150, v150, 1.0 op_sel_hi:[1,0]
v_pk_add_f16 v147, v147, 1.0 op_sel_hi:[1,0]
v_mfma_f32_32x32x16_bf16 v[120:135], v[88:91], v[216:219], v[120:135]
ds_read_b128 v[236:239], v248 offset:59392
ds_read_u16_d16 v142, v142
ds_read_u16_d16_hi v141, v141
ds_read_u16_d16_hi v143, v143
v_and_b32 v145, s49, v145
v_rcp_f16 v154, v153
v_bfe_u32 v144, v145, 2, 14
v_rcp_f16 v151, v150
v_lshrrev_b32 v145, 18, v145
v_rcp_f16 v148, v147
s_waitcnt lgkmcnt(8)
v_smfmac_f32_16x16x32_bf16 v[44:47], v[220:221], v[200:203], v246
ds_read_b128 v[216:219], v248 offset:62464
ds_read_u16_d16 v144, v144
ds_read_u16_d16_hi v145, v145
v_rcp_f16_sdwa v154, v153 dst_sel:WORD_1 dst_unused:UNUSED_PRESERVE src0_sel:WORD_1
v_fma_mix_f32 v161, v136, v136, v161 op_sel:[0,0,0] op_sel_hi:[1,1,0]
v_fma_mix_f32 v161, v137, v137, v161 op_sel:[1,1,0] op_sel_hi:[1,1,0]
v_smfmac_f32_16x16x32_bf16 v[12:15], v[222:223], v[204:207], v246
v_rcp_f16_sdwa v151, v150 dst_sel:WORD_1 dst_unused:UNUSED_PRESERVE src0_sel:WORD_1
v_fma_mix_f32 v161, v138, v138, v161 op_sel:[0,0,0] op_sel_hi:[1,1,0]
v_mfma_f32_32x32x16_bf16 v[120:135], v[92:95], v[224:227], v[120:135]
ds_read_b128 v[220:223], v248 offset:60416
v_rcp_f16_sdwa v148, v147 dst_sel:WORD_1 dst_unused:UNUSED_PRESERVE src0_sel:WORD_1
v_fma_mix_f32 v161, v139, v139, v161 op_sel:[1,1,0] op_sel_hi:[1,1,0]
v_pk_mul_f16 v155, v155, v154
s_waitcnt lgkmcnt(6)
v_fma_mix_f32 v161, v140, v140, v161 op_sel:[0,0,0] op_sel_hi:[1,1,0]
v_pk_mul_f16 v152, v152, v151
s_waitcnt lgkmcnt(4)
v_fma_mix_f32 v161, v141, v141, v161 op_sel:[1,1,0] op_sel_hi:[1,1,0]
v_pk_mul_f16 v149, v149, v148
v_fma_mix_f32 v161, v155, v155, v161 op_sel:[0,0,0] op_sel_hi:[1,1,0]
v_smfmac_f32_16x16x32_bf16 v[28:31], v[228:229], v[208:211], v246
ds_read_b128 v[224:227], v248 offset:63488
v_fma_mix_f32 v161, v142, v142, v161 op_sel:[0,0,0] op_sel_hi:[1,1,0]
v_fma_mix_f32 v161, v155, v155, v161 op_sel:[1,1,0] op_sel_hi:[1,1,0]
v_fma_mix_f32 v161, v143, v143, v161 op_sel:[1,1,0] op_sel_hi:[1,1,0]
v_fma_mix_f32 v161, v152, v152, v161 op_sel:[0,0,0] op_sel_hi:[1,1,0]
v_smfmac_f32_16x16x32_bf16 v[44:47], v[230:231], v[212:215], v246
v_fma_mix_f32 v161, v152, v152, v161 op_sel:[1,1,0] op_sel_hi:[1,1,0]
s_waitcnt lgkmcnt(2)
v_fma_mix_f32 v161, v144, v144, v161 op_sel:[0,0,0] op_sel_hi:[1,1,0]
v_fma_mix_f32 v161, v149, v149, v161 op_sel:[0,0,0] op_sel_hi:[1,1,0]
v_fma_mix_f32 v161, v145, v145, v161 op_sel:[1,1,0] op_sel_hi:[1,1,0]
v_fma_mix_f32 v161, v149, v149, v161 op_sel:[1,1,0] op_sel_hi:[1,1,0]
v_lshlrev_b32 v252, 7, v251
s_add_u32 s46, s47, 2359296
s_mov_b32 exec_lo, 131071
s_mov_b32 exec_hi, 0
s_mov_b32 m0, 16288
s_nop 0
buffer_load_dword v252, s[4:7], s46 offen lds
s_mov_b64 exec, -1
s_setprio 1
v_smfmac_f32_16x16x32_bf16 v[12:15], v[232:233], v[192:195], v246
s_add_u32 s46, s80, 10485760
buffer_store_dwordx4 v[68:71], v241, s[32:35], s46 offen sc1
ds_read_b128 v[228:231], v248 offset:61440
v_cvt_pkrtz_f16_f32 v137, v120, v121
v_cvt_pkrtz_f16_f32 v139, v122, v123
v_cvt_pkrtz_f16_f32 v141, v124, v125
v_cvt_pkrtz_f16_f32 v143, v126, v127
v_cvt_pk_f16_f32 v155, v128, v129
v_smfmac_f32_16x16x32_bf16 v[28:31], v[234:235], v[196:199], v246
v_cvt_pk_f16_f32 v152, v130, v131
v_cvt_pk_f16_f32 v149, v132, v133
v_cvt_pk_f16_f32 v146, v134, v135
v_pk_fma_f16 v154, v155, v155, s48
v_and_b32_e64 v137, s49, v137
v_mfma_f32_32x32x16_bf16 v[120:135], v[72:75], v[236:239], 0
ds_read_b128 v[232:235], v248 offset:64512
v_pk_fma_f16 v151, v152, v152, s48
v_pk_fma_f16 v148, v149, v149, s48
v_and_b32_e64 v139, s49, v139
v_pk_fma_f16 v145, v146, v146, s48
v_pk_mul_f16 v154, v155, v154
v_bfe_u32 v136, v137, 2, 14
v_pk_mul_f16 v151, v152, v151
v_pk_mul_f16 v148, v149, v148
v_bfe_u32 v138, v139, 2, 14
v_pk_mul_f16 v145, v146, v145
v_mfma_f32_32x32x16_bf16 v[120:135], v[76:79], v[216:219], v[120:135]
ds_read_b128 v[236:239], v245 offset:4992
ds_read_b128 v[200:203], v244 offset:128
v_xor_b32 v242, 16, v242
ds_read_b128 v[204:207], v242
ds_read_u16_d16 v136, v136
ds_read_u16_d16 v138, v138
v_exp_f16 v153, v154
v_lshrrev_b32 v137, 18, v137
v_exp_f16 v150, v151
v_lshrrev_b32 v139, 18, v139
v_exp_f16 v147, v148
v_and_b32_e64 v141, s49, v141
v_exp_f16 v144, v145
s_waitcnt lgkmcnt(5)
v_mfma_f32_32x32x16_bf16 v[120:135], v[80:83], v[220:223], v[120:135]
ds_read_b128 v[216:219], v245 offset:5376
ds_read_b128 v[208:211], v242 offset:64
ds_read_b128 v[212:215], v242 offset:128
ds_read_u16_d16_hi v137, v137
ds_read_u16_d16_hi v139, v139
v_and_b32_e64 v143, s49, v143
v_exp_f16_sdwa v153, v154 dst_sel:WORD_1 dst_unused:UNUSED_PRESERVE src0_sel:WORD_1
v_bfe_u32 v140, v141, 2, 14
v_exp_f16_sdwa v150, v151 dst_sel:WORD_1 dst_unused:UNUSED_PRESERVE src0_sel:WORD_1
v_bfe_u32 v142, v143, 2, 14
v_exp_f16_sdwa v147, v148 dst_sel:WORD_1 dst_unused:UNUSED_PRESERVE src0_sel:WORD_1
v_lshrrev_b32_e64 v141, 18, v141
v_mfma_f32_32x32x16_bf16 v[120:135], v[84:87], v[224:227], v[120:135]
ds_read_b128 v[220:223], v249
ds_read_u16_d16 v140, v140
ds_read_u16_d16 v142, v142
ds_read_u16_d16_hi v141, v141
v_exp_f16_sdwa v144, v145 dst_sel:WORD_1 dst_unused:UNUSED_PRESERVE src0_sel:WORD_1
v_lshrrev_b32_e64 v143, 18, v143
v_pk_add_f16 v153, v153, 1.0 op_sel_hi:[1,0]
v_pk_add_f16 v150, v150, 1.0 op_sel_hi:[1,0]
v_pk_add_f16 v147, v147, 1.0 op_sel_hi:[1,0]
v_pk_add_f16 v144, v144, 1.0 op_sel_hi:[1,0]
v_rcp_f16 v154, v153
v_rcp_f16 v151, v150
v_mfma_f32_32x32x16_bf16 v[120:135], v[88:91], v[228:231], v[120:135]
ds_read_b128 v[224:227], v249 offset:3072
ds_read_u16_d16_hi v143, v143
v_rcp_f16 v148, v147
v_rcp_f16 v145, v144
v_rcp_f16_sdwa v154, v153 dst_sel:WORD_1 dst_unused:UNUSED_PRESERVE src0_sel:WORD_1
v_rcp_f16_sdwa v151, v150 dst_sel:WORD_1 dst_unused:UNUSED_PRESERVE src0_sel:WORD_1
s_setprio 0
v_rcp_f16_sdwa v148, v147 dst_sel:WORD_1 dst_unused:UNUSED_PRESERVE src0_sel:WORD_1
s_waitcnt lgkmcnt(6)
v_fma_mix_f32 v162, v136, v136, v162 op_sel:[0,0,0] op_sel_hi:[1,1,0]
v_mfma_f32_32x32x16_bf16 v[120:135], v[92:95], v[232:235], v[120:135]
ds_read_b128 v[228:231], v249 offset:1024
v_rcp_f16_sdwa v145, v144 dst_sel:WORD_1 dst_unused:UNUSED_PRESERVE src0_sel:WORD_1
v_fma_mix_f32 v162, v137, v137, v162 op_sel:[1,1,0] op_sel_hi:[1,1,0]
v_pk_mul_f16 v155, v155, v154
v_fma_mix_f32 v162, v138, v138, v162 op_sel:[0,0,0] op_sel_hi:[1,1,0]
v_pk_mul_f16 v152, v152, v151
v_pk_mul_f16 v149, v149, v148
v_fma_mix_f32 v162, v139, v139, v162 op_sel:[1,1,0] op_sel_hi:[1,1,0]
v_pk_mul_f16 v146, v146, v145
v_fma_mix_f32 v162, v155, v155, v162 op_sel:[0,0,0] op_sel_hi:[1,1,0]
v_smfmac_f32_16x16x32_bf16 v[44:47], v[236:237], v[200:203], v246
ds_read_b128 v[232:235], v249 offset:4096
s_waitcnt lgkmcnt(4)
v_fma_mix_f32 v162, v140, v140, v162 op_sel:[0,0,0] op_sel_hi:[1,1,0]
v_fma_mix_f32 v162, v155, v155, v162 op_sel:[1,1,0] op_sel_hi:[1,1,0]
v_fma_mix_f32 v162, v152, v152, v162 op_sel:[0,0,0] op_sel_hi:[1,1,0]
v_fma_mix_f32 v162, v141, v141, v162 op_sel:[1,1,0] op_sel_hi:[1,1,0]
v_fma_mix_f32 v162, v152, v152, v162 op_sel:[1,1,0] op_sel_hi:[1,1,0]
v_smfmac_f32_16x16x32_bf16 v[8:11], v[238:239], v[204:207], v246
v_fma_mix_f32 v162, v149, v149, v162 op_sel:[0,0,0] op_sel_hi:[1,1,0]
v_fma_mix_f32 v162, v142, v142, v162 op_sel:[0,0,0] op_sel_hi:[1,1,0]
v_fma_mix_f32 v162, v149, v149, v162 op_sel:[1,1,0] op_sel_hi:[1,1,0]
v_fma_mix_f32 v162, v146, v146, v162 op_sel:[0,0,0] op_sel_hi:[1,1,0]
s_waitcnt lgkmcnt(2)
v_fma_mix_f32 v162, v143, v143, v162 op_sel:[1,1,0] op_sel_hi:[1,1,0]
v_fma_mix_f32 v162, v146, v146, v162 op_sel:[1,1,0] op_sel_hi:[1,1,0]
v_lshlrev_b32_e64 v252, 7, v251
s_add_u32 s46, s47, 2359296
s_mov_b32 exec_lo, 4294836224
s_mov_b32 exec_hi, 3
s_mov_b32 m0, 16220
s_nop 0
buffer_load_dword v252, s[4:7], s46 offen lds
s_mov_b64 exec, -1
s_setprio 2
v_smfmac_f32_16x16x32_bf16 v[24:27], v[216:217], v[208:211], v246
ds_read_b128 v[236:239], v249 offset:2048
v_cvt_pkrtz_f16_f32 v137, v120, v121
v_cvt_pkrtz_f16_f32 v139, v122, v123
v_cvt_pkrtz_f16_f32 v141, v124, v125
v_cvt_pkrtz_f16_f32 v143, v126, v127
v_smfmac_f32_16x16x32_bf16 v[40:43], v[218:219], v[212:215], v246
v_cvt_pkrtz_f16_f32 v145, v128, v129
v_cvt_pk_f16_f32 v155, v130, v131
v_cvt_pk_f16_f32 v152, v132, v133
v_cvt_pk_f16_f32 v149, v134, v135
v_pk_fma_f16 v154, v155, v155, s48
v_mfma_f32_32x32x16_bf16 v[120:135], v[72:75], v[220:223], 0
ds_read_b128 v[216:219], v249 offset:5120
v_and_b32_e64 v137, s49, v137
v_pk_fma_f16 v151, v152, v152, s48
v_and_b32_e64 v139, s49, v139
v_pk_fma_f16 v148, v149, v149, s48
v_pk_mul_f16 v154, v155, v154
v_bfe_u32 v136, v137, 2, 14
v_pk_mul_f16 v151, v152, v151
v_pk_mul_f16 v148, v149, v148
v_bfe_u32 v138, v139, 2, 14
v_mfma_f32_32x32x16_bf16 v[120:135], v[76:79], v[224:227], v[120:135]
ds_read_b128 v[220:223], v245 offset:5760
v_xor_b32 v243, 16, v243
ds_read_b128 v[192:195], v243
ds_read_b128 v[196:199], v243 offset:64
ds_read_u16_d16 v136, v136
ds_read_u16_d16 v138, v138
v_exp_f16 v153, v154
v_lshrrev_b32 v137, 18, v137
v_exp_f16 v150, v151
v_lshrrev_b32 v139, 18, v139
v_exp_f16 v147, v148
v_and_b32 v141, s49, v141
v_and_b32 v143, s49, v143
s_waitcnt lgkmcnt(6)
v_mfma_f32_32x32x16_bf16 v[120:135], v[80:83], v[228:231], v[120:135]
ds_read_b128 v[224:227], v245 offset:6144
ds_read_b128 v[200:203], v243 offset:128
v_xor_b32 v244, 16, v244
ds_read_b128 v[204:207], v244
ds_read_u16_d16_hi v137, v137
ds_read_u16_d16_hi v139, v139
v_exp_f16_sdwa v153, v154 dst_sel:WORD_1 dst_unused:UNUSED_PRESERVE src0_sel:WORD_1
v_bfe_u32 v140, v141, 2, 14
v_exp_f16_sdwa v150, v151 dst_sel:WORD_1 dst_unused:UNUSED_PRESERVE src0_sel:WORD_1
v_bfe_u32 v142, v143, 2, 14
v_exp_f16_sdwa v147, v148 dst_sel:WORD_1 dst_unused:UNUSED_PRESERVE src0_sel:WORD_1
v_lshrrev_b32_e64 v141, 18, v141
v_mfma_f32_32x32x16_bf16 v[120:135], v[84:87], v[232:235], v[120:135]
ds_read_b128 v[228:231], v249 offset:6144
ds_read_u16_d16 v140, v140
ds_read_u16_d16 v142, v142
ds_read_u16_d16_hi v141, v141
v_pk_add_f16 v153, v153, 1.0 op_sel_hi:[1,0]
v_lshrrev_b32_e64 v143, 18, v143
v_pk_add_f16 v150, v150, 1.0 op_sel_hi:[1,0]
v_pk_add_f16 v147, v147, 1.0 op_sel_hi:[1,0]
v_and_b32 v145, s49, v145
v_rcp_f16 v154, v153
v_bfe_u32 v144, v145, 2, 14
v_mfma_f32_32x32x16_bf16 v[120:135], v[88:91], v[236:239], v[120:135]
ds_read_b128 v[232:235], v249 offset:9216
ds_read_u16_d16_hi v143, v143
ds_read_u16_d16 v144, v144
v_rcp_f16 v151, v150
v_lshrrev_b32 v145, 18, v145
v_rcp_f16 v148, v147
v_rcp_f16_sdwa v154, v153 dst_sel:WORD_1 dst_unused:UNUSED_PRESERVE src0_sel:WORD_1
ds_read_u16_d16_hi v145, v145
s_waitcnt lgkmcnt(8)
v_fma_mix_f32 v163, v136, v136, v163 op_sel:[0,0,0] op_sel_hi:[1,1,0]
v_fma_mix_f32 v163, v137, v137, v163 op_sel:[1,1,0] op_sel_hi:[1,1,0]
v_rcp_f16_sdwa v151, v150 dst_sel:WORD_1 dst_unused:UNUSED_PRESERVE src0_sel:WORD_1
v_mfma_f32_32x32x16_bf16 v[120:135], v[92:95], v[216:219], v[120:135]
ds_read_b128 v[236:239], v249 offset:7168
v_fma_mix_f32 v163, v138, v138, v163 op_sel:[0,0,0] op_sel_hi:[1,1,0]
v_rcp_f16_sdwa v148, v147 dst_sel:WORD_1 dst_unused:UNUSED_PRESERVE src0_sel:WORD_1
v_fma_mix_f32 v163, v139, v139, v163 op_sel:[1,1,0] op_sel_hi:[1,1,0]
v_pk_mul_f16 v155, v155, v154
s_waitcnt lgkmcnt(5)
v_fma_mix_f32 v163, v140, v140, v163 op_sel:[0,0,0] op_sel_hi:[1,1,0]
v_pk_mul_f16 v152, v152, v151
v_fma_mix_f32 v163, v141, v141, v163 op_sel:[1,1,0] op_sel_hi:[1,1,0]
v_pk_mul_f16 v149, v149, v148
v_smfmac_f32_16x16x32_bf16 v[8:11], v[220:221], v[192:195], v246
ds_read_b128 v[216:219], v249 offset:10240
v_fma_mix_f32 v163, v155, v155, v163 op_sel:[0,0,0] op_sel_hi:[1,1,0]
v_fma_mix_f32 v163, v142, v142, v163 op_sel:[0,0,0] op_sel_hi:[1,1,0]
v_fma_mix_f32 v163, v155, v155, v163 op_sel:[1,1,0] op_sel_hi:[1,1,0]
s_waitcnt lgkmcnt(3)
v_fma_mix_f32 v163, v143, v143, v163 op_sel:[1,1,0] op_sel_hi:[1,1,0]
v_fma_mix_f32 v163, v152, v152, v163 op_sel:[0,0,0] op_sel_hi:[1,1,0]
v_smfmac_f32_16x16x32_bf16 v[24:27], v[222:223], v[196:199], v246
v_fma_mix_f32 v163, v152, v152, v163 op_sel:[1,1,0] op_sel_hi:[1,1,0]
v_fma_mix_f32 v163, v144, v144, v163 op_sel:[0,0,0] op_sel_hi:[1,1,0]
v_fma_mix_f32 v163, v149, v149, v163 op_sel:[0,0,0] op_sel_hi:[1,1,0]
s_waitcnt lgkmcnt(2)
v_fma_mix_f32 v163, v145, v145, v163 op_sel:[1,1,0] op_sel_hi:[1,1,0]
v_fma_mix_f32 v163, v149, v149, v163 op_sel:[1,1,0] op_sel_hi:[1,1,0]
v_lshlrev_b32 v252, 7, v251
s_add_u32 s46, s47, 2359296
s_mov_b32 exec_lo, 0
s_mov_b32 exec_hi, 1048572
s_mov_b32 m0, 16152
s_nop 0
buffer_load_dword v252, s[4:7], s46 offen lds
s_mov_b64 exec, -1
s_setprio 1
v_smfmac_f32_16x16x32_bf16 v[40:43], v[224:225], v[200:203], v246
ds_read_b128 v[220:223], v249 offset:8192
v_cvt_pkrtz_f16_f32 v137, v120, v121
v_cvt_pkrtz_f16_f32 v139, v122, v123
v_cvt_pkrtz_f16_f32 v141, v124, v125
v_cvt_pkrtz_f16_f32 v143, v126, v127
v_smfmac_f32_16x16x32_bf16 v[8:11], v[226:227], v[204:207], v246
v_cvt_pk_f16_f32 v155, v128, v129
v_cvt_pk_f16_f32 v152, v130, v131
v_cvt_pk_f16_f32 v149, v132, v133
v_cvt_pk_f16_f32 v146, v134, v135
v_pk_fma_f16 v154, v155, v155, s48
v_mfma_f32_32x32x16_bf16 v[120:135], v[72:75], v[228:231], 0
ds_read_b128 v[224:227], v249 offset:11264
v_and_b32_e64 v137, s49, v137
v_pk_fma_f16 v151, v152, v152, s48
v_pk_fma_f16 v148, v149, v149, s48
v_and_b32_e64 v139, s49, v139
v_pk_fma_f16 v145, v146, v146, s48
v_pk_mul_f16 v154, v155, v154
v_bfe_u32 v136, v137, 2, 14
v_pk_mul_f16 v151, v152, v151
v_pk_mul_f16 v148, v149, v148
v_bfe_u32 v138, v139, 2, 14
v_mfma_f32_32x32x16_bf16 v[120:135], v[76:79], v[232:235], v[120:135]
ds_read_b128 v[228:231], v245 offset:6528
ds_read_b128 v[208:211], v244 offset:64
ds_read_b128 v[212:215], v244 offset:128
ds_read_u16_d16 v136, v136
ds_read_u16_d16 v138, v138
v_pk_mul_f16 v145, v146, v145
v_exp_f16 v153, v154
v_lshrrev_b32 v137, 18, v137
v_exp_f16 v150, v151
v_lshrrev_b32 v139, 18, v139
v_exp_f16 v147, v148
s_waitcnt lgkmcnt(6)
v_mfma_f32_32x32x16_bf16 v[120:135], v[80:83], v[236:239], v[120:135]
ds_read_b128 v[232:235], v249 offset:12288
ds_read_u16_d16_hi v137, v137
ds_read_u16_d16_hi v139, v139
v_and_b32 v141, s49, v141
v_exp_f16 v144, v145
v_and_b32_e64 v143, s49, v143
v_exp_f16_sdwa v153, v154 dst_sel:WORD_1 dst_unused:UNUSED_PRESERVE src0_sel:WORD_1
v_bfe_u32 v140, v141, 2, 14
v_exp_f16_sdwa v150, v151 dst_sel:WORD_1 dst_unused:UNUSED_PRESERVE src0_sel:WORD_1
v_bfe_u32 v142, v143, 2, 14
v_mfma_f32_32x32x16_bf16 v[120:135], v[84:87], v[216:219], v[120:135]
ds_read_b128 v[236:239], v249 offset:15360
ds_read_u16_d16 v140, v140
ds_read_u16_d16 v142, v142
v_exp_f16_sdwa v147, v148 dst_sel:WORD_1 dst_unused:UNUSED_PRESERVE src0_sel:WORD_1
v_lshrrev_b32_e64 v141, 18, v141
v_exp_f16_sdwa v144, v145 dst_sel:WORD_1 dst_unused:UNUSED_PRESERVE src0_sel:WORD_1
v_lshrrev_b32_e64 v143, 18, v143
v_pk_add_f16 v153, v153, 1.0 op_sel_hi:[1,0]
v_pk_add_f16 v150, v150, 1.0 op_sel_hi:[1,0]
v_pk_add_f16 v147, v147, 1.0 op_sel_hi:[1,0]
v_mfma_f32_32x32x16_bf16 v[120:135], v[88:91], v[220:223], v[120:135]
ds_read_b128 v[216:219], v249 offset:13312
ds_read_u16_d16_hi v141, v141
ds_read_u16_d16_hi v143, v143
v_pk_add_f16 v144, v144, 1.0 op_sel_hi:[1,0]
v_rcp_f16 v154, v153
v_rcp_f16 v151, v150
v_rcp_f16 v148, v147
v_rcp_f16 v145, v144
s_waitcnt lgkmcnt(6)
v_mfma_f32_32x32x16_bf16 v[120:135], v[92:95], v[224:227], v[120:135]
ds_read_b128 v[220:223], v249 offset:16384
v_rcp_f16_sdwa v154, v153 dst_sel:WORD_1 dst_unused:UNUSED_PRESERVE src0_sel:WORD_1
v_rcp_f16_sdwa v151, v150 dst_sel:WORD_1 dst_unused:UNUSED_PRESERVE src0_sel:WORD_1
s_setprio 0
v_rcp_f16_sdwa v148, v147 dst_sel:WORD_1 dst_unused:UNUSED_PRESERVE src0_sel:WORD_1
v_fma_mix_f32 v164, v136, v136, v164 op_sel:[0,0,0] op_sel_hi:[1,1,0]
v_rcp_f16_sdwa v145, v144 dst_sel:WORD_1 dst_unused:UNUSED_PRESERVE src0_sel:WORD_1
v_fma_mix_f32 v164, v137, v137, v164 op_sel:[1,1,0] op_sel_hi:[1,1,0]
v_smfmac_f32_16x16x32_bf16 v[24:27], v[228:229], v[208:211], v246
ds_read_b128 v[224:227], v249 offset:14336
v_pk_mul_f16 v155, v155, v154
v_fma_mix_f32 v164, v138, v138, v164 op_sel:[0,0,0] op_sel_hi:[1,1,0]
v_pk_mul_f16 v152, v152, v151
v_pk_mul_f16 v149, v149, v148
v_fma_mix_f32 v164, v139, v139, v164 op_sel:[1,1,0] op_sel_hi:[1,1,0]
v_smfmac_f32_16x16x32_bf16 v[40:43], v[230:231], v[212:215], v246
s_mov_b64 exec, 1
ds_add_u32 v253, v254 offset:16
s_mov_b64 exec, -1
v_pk_mul_f16 v146, v146, v145
v_fma_mix_f32 v164, v155, v155, v164 op_sel:[0,0,0] op_sel_hi:[1,1,0]
s_waitcnt lgkmcnt(3)
v_fma_mix_f32 v164, v140, v140, v164 op_sel:[0,0,0] op_sel_hi:[1,1,0]
v_fma_mix_f32 v164, v155, v155, v164 op_sel:[1,1,0] op_sel_hi:[1,1,0]
v_fma_mix_f32 v164, v152, v152, v164 op_sel:[0,0,0] op_sel_hi:[1,1,0]
v_fma_mix_f32 v164, v141, v141, v164 op_sel:[1,1,0] op_sel_hi:[1,1,0]
v_fma_mix_f32 v164, v152, v152, v164 op_sel:[1,1,0] op_sel_hi:[1,1,0]
v_fma_mix_f32 v164, v149, v149, v164 op_sel:[0,0,0] op_sel_hi:[1,1,0]
v_fma_mix_f32 v164, v142, v142, v164 op_sel:[0,0,0] op_sel_hi:[1,1,0]
v_fma_mix_f32 v164, v149, v149, v164 op_sel:[1,1,0] op_sel_hi:[1,1,0]
v_fma_mix_f32 v164, v146, v146, v164 op_sel:[0,0,0] op_sel_hi:[1,1,0]
v_fma_mix_f32 v164, v143, v143, v164 op_sel:[1,1,0] op_sel_hi:[1,1,0]
v_fma_mix_f32 v164, v146, v146, v164 op_sel:[1,1,0] op_sel_hi:[1,1,0]
s_setprio 3
v_pk_add_f32 v[168:169], v[0:1], v[2:3]
v_pk_mul_f32 v[170:171], v[0:1], v[0:1]
v_pk_fma_f32 v[170:171], v[2:3], v[2:3], v[170:171]
v_pk_add_f32 v[168:169], v[168:169], v[4:5]
v_pk_fma_f32 v[170:171], v[4:5], v[4:5], v[170:171]
v_pk_add_f32 v[168:169], v[168:169], v[6:7]
v_pk_fma_f32 v[170:171], v[6:7], v[6:7], v[170:171]
v_pk_add_f32 v[168:169], v[168:169], v[8:9]
v_pk_fma_f32 v[170:171], v[8:9], v[8:9], v[170:171]
v_pk_add_f32 v[168:169], v[168:169], v[10:11]
v_pk_fma_f32 v[170:171], v[10:11], v[10:11], v[170:171]
v_pk_add_f32 v[168:169], v[168:169], v[12:13]
v_pk_fma_f32 v[170:171], v[12:13], v[12:13], v[170:171]
v_pk_add_f32 v[168:169], v[168:169], v[14:15]
v_pk_fma_f32 v[170:171], v[14:15], v[14:15], v[170:171]
v_pk_add_f32 v[168:169], v[168:169], v[16:17]
v_pk_fma_f32 v[170:171], v[16:17], v[16:17], v[170:171]
v_pk_add_f32 v[168:169], v[168:169], v[18:19]
v_pk_fma_f32 v[170:171], v[18:19], v[18:19], v[170:171]
v_pk_add_f32 v[168:169], v[168:169], v[20:21]
v_pk_fma_f32 v[170:171], v[20:21], v[20:21], v[170:171]
v_pk_add_f32 v[168:169], v[168:169], v[22:23]
v_pk_fma_f32 v[170:171], v[22:23], v[22:23], v[170:171]
v_pk_add_f32 v[168:169], v[168:169], v[24:25]
v_pk_fma_f32 v[170:171], v[24:25], v[24:25], v[170:171]
v_pk_add_f32 v[168:169], v[168:169], v[26:27]
v_pk_fma_f32 v[170:171], v[26:27], v[26:27], v[170:171]
v_pk_add_f32 v[168:169], v[168:169], v[28:29]
v_pk_fma_f32 v[170:171], v[28:29], v[28:29], v[170:171]
v_pk_add_f32 v[168:169], v[168:169], v[30:31]
v_pk_fma_f32 v[170:171], v[30:31], v[30:31], v[170:171]
v_pk_add_f32 v[168:169], v[168:169], v[32:33]
v_pk_fma_f32 v[170:171], v[32:33], v[32:33], v[170:171]
v_pk_add_f32 v[168:169], v[168:169], v[34:35]
v_pk_fma_f32 v[170:171], v[34:35], v[34:35], v[170:171]
v_pk_add_f32 v[168:169], v[168:169], v[36:37]
v_pk_fma_f32 v[170:171], v[36:37], v[36:37], v[170:171]
v_pk_add_f32 v[168:169], v[168:169], v[38:39]
v_pk_fma_f32 v[170:171], v[38:39], v[38:39], v[170:171]
v_pk_add_f32 v[168:169], v[168:169], v[40:41]
v_pk_fma_f32 v[170:171], v[40:41], v[40:41], v[170:171]
v_pk_add_f32 v[168:169], v[168:169], v[42:43]
v_pk_fma_f32 v[170:171], v[42:43], v[42:43], v[170:171]
v_pk_add_f32 v[168:169], v[168:169], v[44:45]
v_pk_fma_f32 v[170:171], v[44:45], v[44:45], v[170:171]
v_pk_add_f32 v[168:169], v[168:169], v[46:47]
v_pk_fma_f32 v[170:171], v[46:47], v[46:47], v[170:171]
s_setprio 0
v_add_u32 v174, -36864, v242
v_subrev_u32 v175, 66560, v174
v_min_u32 v174, v174, v175
v_add_u32 v174, 90112, v174
v_sub_u32 v175, v174, v242
v_add_u32 v242, v175, v242
v_add_u32_e64 v243, v175, v243
v_add_u32 v244, v175, v244
s_setprio 2
v_cvt_pkrtz_f16_f32 v137, v120, v121
v_cvt_pkrtz_f16_f32 v139, v122, v123
v_cvt_pkrtz_f16_f32 v141, v124, v125
v_cvt_pkrtz_f16_f32 v143, v126, v127
v_cvt_pkrtz_f16_f32 v145, v128, v129
v_cvt_pk_f16_f32 v155, v130, v131
v_cvt_pk_f16_f32 v152, v132, v133
v_cvt_pk_f16_f32 v149, v134, v135
ds_read_b128 v[228:231], v249 offset:17408
v_mfma_f32_32x32x16_bf16 v[120:135], v[72:75], v[232:235], 0
v_pk_fma_f16 v154, v155, v155, s48
v_add_f32 v168, v168, v169
v_and_b32 v137, s49, v137
v_pk_fma_f16 v151, v152, v152, s48
v_and_b32_e64 v139, s49, v139
v_pk_fma_f16 v148, v149, v149, s48
v_add_f32_e64 v170, v170, v171
v_pk_mul_f16 v154, v155, v154
v_bfe_u32 v136, v137, 2, 14
v_pk_mul_f16 v151, v152, v151
v_pk_mul_f16 v148, v149, v148
v_bfe_u32 v138, v139, 2, 14
ds_read_b128 v[232:235], v249 offset:18432
ds_read_u16_d16 v136, v136
ds_read_u16_d16 v138, v138
v_mfma_f32_32x32x16_bf16 v[120:135], v[76:79], v[236:239], v[120:135]
v_permlane32_swap_b32 v168, v170
v_exp_f16 v153, v154
v_lshrrev_b32 v137, 18, v137
v_exp_f16 v150, v151
v_add_f32 v168, v168, v170
v_lshrrev_b32 v139, 18, v139
v_exp_f16 v147, v148
v_and_b32 v141, s49, v141
v_and_b32_e64 v143, s49, v143
v_mul_f32 v168, 1009429163, v168
ds_read_b128 v[236:239], v249 offset:21504
ds_read_u16_d16_hi v137, v137
ds_read_u16_d16_hi v139, v139
v_mfma_f32_32x32x16_bf16 v[120:135], v[80:83], v[216:219], v[120:135]
v_exp_f16_sdwa v153, v154 dst_sel:WORD_1 dst_unused:UNUSED_PRESERVE src0_sel:WORD_1
v_bfe_u32 v140, v141, 2, 14
v_exp_f16_sdwa v150, v151 dst_sel:WORD_1 dst_unused:UNUSED_PRESERVE src0_sel:WORD_1
v_mov_b32_e64 v170, v168
v_bfe_u32 v142, v143, 2, 14
v_exp_f16_sdwa v147, v148 dst_sel:WORD_1 dst_unused:UNUSED_PRESERVE src0_sel:WORD_1
v_lshrrev_b32_e64 v141, 18, v141
v_permlane32_swap_b32 v168, v170
v_pk_add_f16 v153, v153, 1.0 op_sel_hi:[1,0]
s_waitcnt lgkmcnt(8)
ds_read_b128 v[216:219], v249 offset:19456
ds_read_u16_d16 v140, v140
ds_read_u16_d16 v142, v142
ds_read_u16_d16_hi v141, v141
v_mfma_f32_32x32x16_bf16 v[120:135], v[84:87], v[220:223], v[120:135]
v_lshrrev_b32_e64 v143, 18, v143
v_pk_add_f16 v150, v150, 1.0 op_sel_hi:[1,0]
v_pk_add_f16 v147, v147, 1.0 op_sel_hi:[1,0]
v_and_b32_e64 v145, s49, v145
v_fma_f32 v170, -v168, v168, v170
v_rcp_f16_e64 v154, v153
v_bfe_u32 v144, v145, 2, 14
v_rcp_f16 v151, v150
v_max_f32 v170, 0, v170
v_lshrrev_b32_e64 v145, 18, v145
ds_read_b128 v[220:223], v249 offset:22528
ds_read_u16_d16_hi v143, v143
ds_read_u16_d16 v144, v144
ds_read_u16_d16_hi v145, v145
v_mfma_f32_32x32x16_bf16 v[120:135], v[88:91], v[224:227], v[120:135]
v_rcp_f16 v148, v147
v_rcp_f16_sdwa v154, v153 dst_sel:WORD_1 dst_unused:UNUSED_PRESERVE src0_sel:WORD_1
v_add_f32 v170, 925353388, v170
s_waitcnt lgkmcnt(8)
v_fma_mix_f32 v165, v136, v136, v165 op_sel:[0,0,0] op_sel_hi:[1,1,0]
ds_read_b32 v247, v253 offset:16
v_fma_mix_f32 v165, v137, v137, v165 op_sel:[1,1,0] op_sel_hi:[1,1,0]
v_rcp_f16_sdwa v151, v150 dst_sel:WORD_1 dst_unused:UNUSED_PRESERVE src0_sel:WORD_1
v_rsq_f32_e64 v170, v170
v_fma_mix_f32 v165, v138, v138, v165 op_sel:[0,0,0] op_sel_hi:[1,1,0]
ds_read_b128 v[224:227], v249 offset:20480
v_mfma_f32_32x32x16_bf16 v[120:135], v[92:95], v[228:231], v[120:135]
v_rcp_f16_sdwa v148, v147 dst_sel:WORD_1 dst_unused:UNUSED_PRESERVE src0_sel:WORD_1
v_fma_mix_f32 v165, v139, v139, v165 op_sel:[1,1,0] op_sel_hi:[1,1,0]
v_pk_mul_f16 v155, v155, v154
s_waitcnt lgkmcnt(6)
v_fma_mix_f32 v165, v140, v140, v165 op_sel:[0,0,0] op_sel_hi:[1,1,0]
v_pk_mul_f16 v152, v152, v151
v_fma_mix_f32 v165, v141, v141, v165 op_sel:[1,1,0] op_sel_hi:[1,1,0]
v_pk_mul_f16 v149, v149, v148
v_fma_mix_f32 v165, v155, v155, v165 op_sel:[0,0,0] op_sel_hi:[1,1,0]
v_mul_f32 v172, 3203391086, v170
v_fma_mix_f32 v165, v142, v142, v165 op_sel:[0,0,0] op_sel_hi:[1,1,0]
v_fma_mix_f32 v165, v155, v155, v165 op_sel:[1,1,0] op_sel_hi:[1,1,0]
s_waitcnt lgkmcnt(2)
v_fma_mix_f32 v165, v143, v143, v165 op_sel:[1,1,0] op_sel_hi:[1,1,0]
v_fma_mix_f32 v165, v152, v152, v165 op_sel:[0,0,0] op_sel_hi:[1,1,0]
v_fma_mix_f32 v165, v152, v152, v165 op_sel:[1,1,0] op_sel_hi:[1,1,0]
v_mul_f32 v173, v168, v172
v_fma_mix_f32 v165, v144, v144, v165 op_sel:[0,0,0] op_sel_hi:[1,1,0]
v_fma_mix_f32 v165, v149, v149, v165 op_sel:[0,0,0] op_sel_hi:[1,1,0]
v_fma_mix_f32 v165, v145, v145, v165 op_sel:[1,1,0] op_sel_hi:[1,1,0]
v_fma_mix_f32 v165, v149, v149, v165 op_sel:[1,1,0] op_sel_hi:[1,1,0]
s_setprio 3
v_pk_fma_f32 v[0:1], v[0:1], v[172:173], v[172:173] op_sel:[0,0,1] op_sel_hi:[1,0,1] neg_lo:[0,0,1] neg_hi:[0,0,1]
v_pk_fma_f32 v[2:3], v[2:3], v[172:173], v[172:173] op_sel:[0,0,1] op_sel_hi:[1,0,1] neg_lo:[0,0,1] neg_hi:[0,0,1]
v_pk_fma_f32 v[4:5], v[4:5], v[172:173], v[172:173] op_sel:[0,0,1] op_sel_hi:[1,0,1] neg_lo:[0,0,1] neg_hi:[0,0,1]
v_pk_fma_f32 v[6:7], v[6:7], v[172:173], v[172:173] op_sel:[0,0,1] op_sel_hi:[1,0,1] neg_lo:[0,0,1] neg_hi:[0,0,1]
v_pk_fma_f32 v[8:9], v[8:9], v[172:173], v[172:173] op_sel:[0,0,1] op_sel_hi:[1,0,1] neg_lo:[0,0,1] neg_hi:[0,0,1]
v_pk_fma_f32 v[10:11], v[10:11], v[172:173], v[172:173] op_sel:[0,0,1] op_sel_hi:[1,0,1] neg_lo:[0,0,1] neg_hi:[0,0,1]
v_pk_fma_f32 v[12:13], v[12:13], v[172:173], v[172:173] op_sel:[0,0,1] op_sel_hi:[1,0,1] neg_lo:[0,0,1] neg_hi:[0,0,1]
v_pk_fma_f32 v[14:15], v[14:15], v[172:173], v[172:173] op_sel:[0,0,1] op_sel_hi:[1,0,1] neg_lo:[0,0,1] neg_hi:[0,0,1]
v_pk_fma_f32 v[16:17], v[16:17], v[172:173], v[172:173] op_sel:[0,0,1] op_sel_hi:[1,0,1] neg_lo:[0,0,1] neg_hi:[0,0,1]
v_pk_fma_f32 v[18:19], v[18:19], v[172:173], v[172:173] op_sel:[0,0,1] op_sel_hi:[1,0,1] neg_lo:[0,0,1] neg_hi:[0,0,1]
v_pk_fma_f32 v[20:21], v[20:21], v[172:173], v[172:173] op_sel:[0,0,1] op_sel_hi:[1,0,1] neg_lo:[0,0,1] neg_hi:[0,0,1]
v_pk_fma_f32 v[22:23], v[22:23], v[172:173], v[172:173] op_sel:[0,0,1] op_sel_hi:[1,0,1] neg_lo:[0,0,1] neg_hi:[0,0,1]
v_pk_fma_f32 v[24:25], v[24:25], v[172:173], v[172:173] op_sel:[0,0,1] op_sel_hi:[1,0,1] neg_lo:[0,0,1] neg_hi:[0,0,1]
v_pk_fma_f32 v[26:27], v[26:27], v[172:173], v[172:173] op_sel:[0,0,1] op_sel_hi:[1,0,1] neg_lo:[0,0,1] neg_hi:[0,0,1]
v_pk_fma_f32 v[28:29], v[28:29], v[172:173], v[172:173] op_sel:[0,0,1] op_sel_hi:[1,0,1] neg_lo:[0,0,1] neg_hi:[0,0,1]
v_pk_fma_f32 v[30:31], v[30:31], v[172:173], v[172:173] op_sel:[0,0,1] op_sel_hi:[1,0,1] neg_lo:[0,0,1] neg_hi:[0,0,1]
v_pk_fma_f32 v[32:33], v[32:33], v[172:173], v[172:173] op_sel:[0,0,1] op_sel_hi:[1,0,1] neg_lo:[0,0,1] neg_hi:[0,0,1]
v_pk_fma_f32 v[34:35], v[34:35], v[172:173], v[172:173] op_sel:[0,0,1] op_sel_hi:[1,0,1] neg_lo:[0,0,1] neg_hi:[0,0,1]
v_pk_fma_f32 v[36:37], v[36:37], v[172:173], v[172:173] op_sel:[0,0,1] op_sel_hi:[1,0,1] neg_lo:[0,0,1] neg_hi:[0,0,1]
v_pk_fma_f32 v[38:39], v[38:39], v[172:173], v[172:173] op_sel:[0,0,1] op_sel_hi:[1,0,1] neg_lo:[0,0,1] neg_hi:[0,0,1]
v_pk_fma_f32 v[40:41], v[40:41], v[172:173], v[172:173] op_sel:[0,0,1] op_sel_hi:[1,0,1] neg_lo:[0,0,1] neg_hi:[0,0,1]
v_pk_fma_f32 v[42:43], v[42:43], v[172:173], v[172:173] op_sel:[0,0,1] op_sel_hi:[1,0,1] neg_lo:[0,0,1] neg_hi:[0,0,1]
v_pk_fma_f32 v[44:45], v[44:45], v[172:173], v[172:173] op_sel:[0,0,1] op_sel_hi:[1,0,1] neg_lo:[0,0,1] neg_hi:[0,0,1]
v_pk_fma_f32 v[46:47], v[46:47], v[172:173], v[172:173] op_sel:[0,0,1] op_sel_hi:[1,0,1] neg_lo:[0,0,1] neg_hi:[0,0,1]
s_setprio 2
s_waitcnt lgkmcnt(0)
v_readfirstlane_b32 s43, v247
s_nop 1
s_cmp_ge_u32 s43, 24
s_cbranch_scc1 Lev6
Lev6w:
s_sleep 1
ds_read_b32 v247, v253 offset:16
s_waitcnt lgkmcnt(0)
v_readfirstlane_b32 s43, v247
s_cmp_eq_u32 s76, 0
s_cbranch_scc1 Lev6
s_sub_u32 s76, s76, 1
s_cmp_lt_u32 s43, 24
s_cbranch_scc1 Lev6w
Lev6:
s_setprio 1
v_cvt_pkrtz_f16_f32 v137, v120, v121
v_cvt_pkrtz_f16_f32 v139, v122, v123
v_cvt_pkrtz_f16_f32 v141, v124, v125
v_cvt_pkrtz_f16_f32 v143, v126, v127
v_cvt_pkrtz_f16_f32 v145, v128, v129
v_cvt_pk_f16_f32 v155, v130, v131
v_cvt_pk_f16_f32 v152, v132, v133
v_cvt_pk_f16_f32 v149, v134, v135
s_add_u32 m0, s67, 39936
s_add_u32 s66, s66, 98304
buffer_load_dwordx4 v240, s[4:7], s66 offen lds
ds_read_b128 v[228:231], v249 offset:23552
v_mfma_f32_32x32x16_bf16 v[120:135], v[72:75], v[232:235], 0
v_pk_fma_f16 v154, v155, v155, s48
v_cvt_pk_bf16_f32 v96, v0, v1
v_and_b32 v137, s49, v137
v_pk_fma_f16 v151, v152, v152, s48
v_cvt_pk_bf16_f32 v97, v2, v3
v_and_b32_e64 v139, s49, v139
v_pk_fma_f16 v148, v149, v149, s48
v_pk_mul_f16 v154, v155, v154
v_cvt_pk_bf16_f32 v98, v4, v5
v_bfe_u32 v136, v137, 2, 14
v_pk_mul_f16 v151, v152, v151
v_pk_mul_f16 v148, v149, v148
v_cvt_pk_bf16_f32 v99, v6, v7
v_bfe_u32 v138, v139, 2, 14
s_add_u32 m0, s67, 46592
s_add_u32 s66, s66, 98304
buffer_load_dwordx4 v240, s[4:7], s66 offen lds
ds_read_b128 v[232:235], v248 offset:16384
ds_read_u16_d16 v136, v136
ds_read_u16_d16 v138, v138
v_mfma_f32_32x32x16_bf16 v[120:135], v[76:79], v[236:239], v[120:135]
v_exp_f16_e64 v153, v154
v_cvt_pk_bf16_f32 v100, v8, v9
v_lshrrev_b32 v137, 18, v137
v_exp_f16 v150, v151
v_cvt_pk_bf16_f32 v101, v10, v11
v_lshrrev_b32 v139, 18, v139
v_exp_f16 v147, v148
v_cvt_pk_bf16_f32 v102, v12, v13
v_and_b32 v141, s49, v141
v_and_b32 v143, s49, v143
v_cvt_pk_bf16_f32 v103, v14, v15
s_add_u32 m0, s67, 53248
s_add_u32 s66, s66, 98304
buffer_load_dwordx4 v240, s[4:7], s66 offen lds
ds_read_b128 v[236:239], v248 offset:19456
ds_read_u16_d16_hi v137, v137
ds_read_u16_d16_hi v139, v139
v_mfma_f32_32x32x16_bf16 v[120:135], v[80:83], v[216:219], v[120:135]
v_exp_f16_sdwa v153, v154 dst_sel:WORD_1 dst_unused:UNUSED_PRESERVE src0_sel:WORD_1
v_bfe_u32 v140, v141, 2, 14
v_cvt_pk_bf16_f32 v104, v16, v17
v_exp_f16_sdwa v150, v151 dst_sel:WORD_1 dst_unused:UNUSED_PRESERVE src0_sel:WORD_1
v_bfe_u32 v142, v143, 2, 14
v_cvt_pk_bf16_f32 v105, v18, v19
v_exp_f16_sdwa v147, v148 dst_sel:WORD_1 dst_unused:UNUSED_PRESERVE src0_sel:WORD_1
v_cvt_pk_bf16_f32 v106, v20, v21
v_lshrrev_b32_e64 v141, 18, v141
v_pk_add_f16 v153, v153, 1.0 op_sel_hi:[1,0]
v_lshrrev_b32 v143, 18, v143
s_add_u32 m0, s67, 59904
s_add_u32 s66, s66, 98304
buffer_load_dwordx4 v240, s[4:7], s66 offen lds
s_add_u32 m0, s67, 0
s_add_u32 s66, s66, 98304
buffer_load_dwordx4 v240, s[4:7], s66 offen lds
ds_read_b128 v[216:219], v248 offset:17408
ds_read_u16_d16 v140, v140
ds_read_u16_d16 v142, v142
ds_read_u16_d16_hi v141, v141
ds_read_u16_d16_hi v143, v143
v_mfma_f32_32x32x16_bf16 v[120:135], v[84:87], v[220:223], v[120:135]
v_cvt_pk_bf16_f32 v107, v22, v23
v_pk_add_f16 v150, v150, 1.0 op_sel_hi:[1,0]
v_pk_add_f16 v147, v147, 1.0 op_sel_hi:[1,0]
v_and_b32_e64 v145, s49, v145
v_cvt_pk_bf16_f32 v108, v24, v25
v_rcp_f16_e64 v154, v153
v_bfe_u32 v144, v145, 2, 14
v_cvt_pk_bf16_f32 v109, v26, v27
v_rcp_f16 v151, v150
v_lshrrev_b32 v145, 18, v145
v_cvt_pk_bf16_f32 v110, v28, v29
s_add_u32 m0, s67, 6656
s_add_u32 s66, s66, 98304
buffer_load_dwordx4 v240, s[4:7], s66 offen lds
ds_read_b128 v[220:223], v248 offset:20480
ds_read_u16_d16 v144, v144
ds_read_u16_d16_hi v145, v145
v_mfma_f32_32x32x16_bf16 v[120:135], v[88:91], v[224:227], v[120:135]
v_rcp_f16_e64 v148, v147
v_cvt_pk_bf16_f32 v111, v30, v31
v_rcp_f16_sdwa v154, v153 dst_sel:WORD_1 dst_unused:UNUSED_PRESERVE src0_sel:WORD_1
s_waitcnt lgkmcnt(5)
v_fma_mix_f32 v166, v136, v136, v166 op_sel:[0,0,0] op_sel_hi:[1,1,0]
v_cvt_pk_bf16_f32 v112, v32, v33
s_setprio 0
v_fma_mix_f32 v166, v137, v137, v166 op_sel:[1,1,0] op_sel_hi:[1,1,0]
v_rcp_f16_sdwa v151, v150 dst_sel:WORD_1 dst_unused:UNUSED_PRESERVE src0_sel:WORD_1
v_cvt_pk_bf16_f32 v113, v34, v35
v_fma_mix_f32 v166, v138, v138, v166 op_sel:[0,0,0] op_sel_hi:[1,1,0]
v_rcp_f16_sdwa v148, v147 dst_sel:WORD_1 dst_unused:UNUSED_PRESERVE src0_sel:WORD_1
v_cvt_pk_bf16_f32 v114, v36, v37
s_add_u32 m0, s67, 13312
s_add_u32 s66, s66, 98304
buffer_load_dwordx4 v240, s[4:7], s66 offen lds
ds_read_b128 v[224:227], v248 offset:18432
v_mfma_f32_32x32x16_bf16 v[120:135], v[92:95], v[228:231], v[120:135]
v_fma_mix_f32 v166, v139, v139, v166 op_sel:[1,1,0] op_sel_hi:[1,1,0]
v_pk_mul_f16 v155, v155, v154
v_fma_mix_f32 v166, v140, v140, v166 op_sel:[0,0,0] op_sel_hi:[1,1,0]
v_cvt_pk_bf16_f32 v115, v38, v39
v_pk_mul_f16 v152, v152, v151
s_waitcnt lgkmcnt(1)
v_fma_mix_f32 v166, v141, v141, v166 op_sel:[1,1,0] op_sel_hi:[1,1,0]
v_cvt_pk_bf16_f32 v116, v40, v41
v_pk_mul_f16 v149, v149, v148
v_fma_mix_f32 v166, v155, v155, v166 op_sel:[0,0,0] op_sel_hi:[1,1,0]
v_fma_mix_f32 v166, v142, v142, v166 op_sel:[0,0,0] op_sel_hi:[1,1,0]
v_cvt_pk_bf16_f32 v117, v42, v43
v_fma_mix_f32 v166, v155, v155, v166 op_sel:[1,1,0] op_sel_hi:[1,1,0]
v_fma_mix_f32 v166, v143, v143, v166 op_sel:[1,1,0] op_sel_hi:[1,1,0]
v_fma_mix_f32 v166, v152, v152, v166 op_sel:[0,0,0] op_sel_hi:[1,1,0]
s_add_u32 m0, s67, 19968
s_add_u32 s66, s66, 98304
buffer_load_dwordx4 v240, s[4:7], s66 offen lds
v_cvt_pk_bf16_f32 v118, v44, v45
v_fma_mix_f32 v166, v152, v152, v166 op_sel:[1,1,0] op_sel_hi:[1,1,0]
v_fma_mix_f32 v166, v144, v144, v166 op_sel:[0,0,0] op_sel_hi:[1,1,0]
v_fma_mix_f32 v166, v149, v149, v166 op_sel:[0,0,0] op_sel_hi:[1,1,0]
v_cvt_pk_bf16_f32 v119, v46, v47
v_fma_mix_f32 v166, v145, v145, v166 op_sel:[1,1,0] op_sel_hi:[1,1,0]
v_fma_mix_f32 v166, v149, v149, v166 op_sel:[1,1,0] op_sel_hi:[1,1,0]
s_setprio 2
v_cvt_pkrtz_f16_f32 v137, v120, v121
v_cvt_pkrtz_f16_f32 v139, v122, v123
v_cvt_pkrtz_f16_f32 v141, v124, v125
v_cvt_pkrtz_f16_f32 v143, v126, v127
v_cvt_pkrtz_f16_f32 v145, v128, v129
v_cvt_pk_f16_f32 v155, v130, v131
v_cvt_pk_f16_f32 v152, v132, v133
v_cvt_pk_f16_f32 v149, v134, v135
ds_read_b128 v[228:231], v248 offset:21504
v_mfma_f32_32x32x16_bf16 v[120:135], v[96:99], v[232:235], 0
v_pk_fma_f16 v154, v155, v155, s48
v_and_b32_e64 v137, s49, v137
v_pk_fma_f16 v151, v152, v152, s48
v_and_b32_e64 v139, s49, v139
v_pk_fma_f16 v148, v149, v149, s48
v_pk_mul_f16 v154, v155, v154
v_bfe_u32 v136, v137, 2, 14
v_pk_mul_f16 v151, v152, v151
v_pk_mul_f16 v148, v149, v148
v_bfe_u32 v138, v139, 2, 14
ds_read_b128 v[232:235], v248 offset:22528
ds_read_u16_d16 v136, v136
ds_read_u16_d16 v138, v138
v_mfma_f32_32x32x16_bf16 v[120:135], v[100:103], v[236:239], v[120:135]
v_exp_f16 v153, v154
v_lshrrev_b32 v137, 18, v137
v_exp_f16 v150, v151
v_lshrrev_b32 v139, 18, v139
v_exp_f16 v147, v148
v_and_b32 v141, s49, v141
v_and_b32_e64 v143, s49, v143
ds_read_b128 v[236:239], v248 offset:25600
ds_read_u16_d16_hi v137, v137
ds_read_u16_d16_hi v139, v139
v_mfma_f32_32x32x16_bf16 v[120:135], v[104:107], v[216:219], v[120:135]
v_exp_f16_sdwa v153, v154 dst_sel:WORD_1 dst_unused:UNUSED_PRESERVE src0_sel:WORD_1
v_bfe_u32 v140, v141, 2, 14
v_exp_f16_sdwa v150, v151 dst_sel:WORD_1 dst_unused:UNUSED_PRESERVE src0_sel:WORD_1
v_bfe_u32 v142, v143, 2, 14
v_exp_f16_sdwa v147, v148 dst_sel:WORD_1 dst_unused:UNUSED_PRESERVE src0_sel:WORD_1
v_lshrrev_b32_e64 v141, 18, v141
v_pk_add_f16 v153, v153, 1.0 op_sel_hi:[1,0]
ds_read_b128 v[216:219], v248 offset:23552
ds_read_u16_d16 v140, v140
ds_read_u16_d16 v142, v142
ds_read_u16_d16_hi v141, v141
v_mfma_f32_32x32x16_bf16 v[120:135], v[108:111], v[220:223], v[120:135]
v_lshrrev_b32_e64 v143, 18, v143
v_pk_add_f16 v150, v150, 1.0 op_sel_hi:[1,0]
v_pk_add_f16 v147, v147, 1.0 op_sel_hi:[1,0]
v_and_b32 v145, s49, v145
v_rcp_f16 v154, v153
v_bfe_u32 v144, v145, 2, 14
v_rcp_f16_e64 v151, v150
v_lshrrev_b32 v145, 18, v145
s_waitcnt lgkmcnt(7)
ds_read_b128 v[220:223], v248 offset:26624
ds_read_u16_d16_hi v143, v143
ds_read_u16_d16 v144, v144
ds_read_u16_d16_hi v145, v145
v_mfma_f32_32x32x16_bf16 v[120:135], v[112:115], v[224:227], v[120:135]
v_rcp_f16 v148, v147
v_rcp_f16_sdwa v154, v153 dst_sel:WORD_1 dst_unused:UNUSED_PRESERVE src0_sel:WORD_1
v_fma_mix_f32 v167, v136, v136, v167 op_sel:[0,0,0] op_sel_hi:[1,1,0]
s_waitcnt lgkmcnt(8)
v_fma_mix_f32 v167, v137, v137, v167 op_sel:[1,1,0] op_sel_hi:[1,1,0]
v_rcp_f16_sdwa v151, v150 dst_sel:WORD_1 dst_unused:UNUSED_PRESERVE src0_sel:WORD_1
v_fma_mix_f32 v167, v138, v138, v167 op_sel:[0,0,0] op_sel_hi:[1,1,0]
ds_read_b128 v[224:227], v248 offset:24576
v_mfma_f32_32x32x16_bf16 v[120:135], v[116:119], v[228:231], v[120:135]
v_rcp_f16_sdwa v148, v147 dst_sel:WORD_1 dst_unused:UNUSED_PRESERVE src0_sel:WORD_1
v_fma_mix_f32 v167, v139, v139, v167 op_sel:[1,1,0] op_sel_hi:[1,1,0]
v_pk_mul_f16 v155, v155, v154
s_cmp_eq_u32 s40, 7
s_cbranch_scc1 Lrdy24
s_waitcnt vmcnt(0)
Lrdy24:
s_mov_b64 exec, 1
ds_add_u32 v253, v254 offset:12
s_mov_b64 exec, -1
s_waitcnt lgkmcnt(6)
v_fma_mix_f32 v167, v140, v140, v167 op_sel:[0,0,0] op_sel_hi:[1,1,0]
v_pk_mul_f16 v152, v152, v151
v_fma_mix_f32 v167, v141, v141, v167 op_sel:[1,1,0] op_sel_hi:[1,1,0]
v_pk_mul_f16 v149, v149, v148
v_fma_mix_f32 v167, v155, v155, v167 op_sel:[0,0,0] op_sel_hi:[1,1,0]
v_fma_mix_f32 v167, v142, v142, v167 op_sel:[0,0,0] op_sel_hi:[1,1,0]
v_fma_mix_f32 v167, v155, v155, v167 op_sel:[1,1,0] op_sel_hi:[1,1,0]
s_waitcnt lgkmcnt(2)
v_fma_mix_f32 v167, v143, v143, v167 op_sel:[1,1,0] op_sel_hi:[1,1,0]
v_fma_mix_f32 v167, v152, v152, v167 op_sel:[0,0,0] op_sel_hi:[1,1,0]
v_fma_mix_f32 v167, v152, v152, v167 op_sel:[1,1,0] op_sel_hi:[1,1,0]
v_fma_mix_f32 v167, v144, v144, v167 op_sel:[0,0,0] op_sel_hi:[1,1,0]
v_fma_mix_f32 v167, v149, v149, v167 op_sel:[0,0,0] op_sel_hi:[1,1,0]
v_fma_mix_f32 v167, v145, v145, v167 op_sel:[1,1,0] op_sel_hi:[1,1,0]
v_fma_mix_f32 v167, v149, v149, v167 op_sel:[1,1,0] op_sel_hi:[1,1,0]
s_cmp_lg_u32 s40, 7
s_cbranch_scc1 Lnoinit
s_waitcnt vmcnt(13)
v_mov_b32 v255, 1
s_mov_b64 exec, 1
buffer_atomic_add v255, v241, s[36:39], 0 offen
s_mov_b64 exec, -1
Lnoinit:
s_setprio 1
v_cvt_pkrtz_f16_f32 v137, v120, v121
v_cvt_pkrtz_f16_f32 v139, v122, v123
v_cvt_pkrtz_f16_f32 v141, v124, v125
v_cvt_pkrtz_f16_f32 v143, v126, v127
v_cvt_pkrtz_f16_f32 v145, v128, v129
v_cvt_pk_f16_f32 v155, v130, v131
v_cvt_pk_f16_f32 v152, v132, v133
v_cvt_pk_f16_f32 v149, v134, v135
s_add_u32 s46, s80, 12582912
buffer_store_dwordx4 v[72:75], v241, s[32:35], s46 offen sc1
ds_read_b128 v[228:231], v248 offset:27648
v_mfma_f32_32x32x16_bf16 v[120:135], v[96:99], v[232:235], 0
v_pk_fma_f16 v154, v155, v155, s48
v_and_b32_e64 v137, s49, v137
v_pk_fma_f16 v151, v152, v152, s48
v_and_b32_e64 v139, s49, v139
v_pk_fma_f16 v148, v149, v149, s48
v_pk_mul_f16 v154, v155, v154
v_bfe_u32 v136, v137, 2, 14
v_pk_mul_f16 v151, v152, v151
v_pk_mul_f16 v148, v149, v148
v_bfe_u32 v138, v139, 2, 14
ds_read_b128 v[232:235], v250 offset:65520
ds_read_u16_d16 v136, v136
ds_read_u16_d16 v138, v138
v_mfma_f32_32x32x16_bf16 v[120:135], v[100:103], v[236:239], v[120:135]
v_exp_f16 v153, v154
v_lshrrev_b32 v137, 18, v137
v_exp_f16 v150, v151
v_lshrrev_b32 v139, 18, v139
v_exp_f16 v147, v148
v_and_b32 v141, s49, v141
v_and_b32_e64 v143, s49, v143
ds_read_b128 v[236:239], v248 offset:28672
ds_read_u16_d16_hi v137, v137
ds_read_b32 v247, v253 offset:12
ds_read_u16_d16_hi v139, v139
v_mfma_f32_32x32x16_bf16 v[120:135], v[104:107], v[216:219], v[120:135]
v_exp_f16_sdwa v153, v154 dst_sel:WORD_1 dst_unused:UNUSED_PRESERVE src0_sel:WORD_1
v_bfe_u32 v140, v141, 2, 14
v_exp_f16_sdwa v150, v151 dst_sel:WORD_1 dst_unused:UNUSED_PRESERVE src0_sel:WORD_1
v_bfe_u32 v142, v143, 2, 14
v_exp_f16_sdwa v147, v148 dst_sel:WORD_1 dst_unused:UNUSED_PRESERVE src0_sel:WORD_1
v_lshrrev_b32_e64 v141, 18, v141
v_pk_add_f16 v153, v153, 1.0 op_sel_hi:[1,0]
ds_read_b128 v[216:219], v248 offset:31744
ds_read_u16_d16 v140, v140
ds_read_u16_d16 v142, v142
ds_read_u16_d16_hi v141, v141
v_mfma_f32_32x32x16_bf16 v[120:135], v[108:111], v[220:223], v[120:135]
v_lshrrev_b32_e64 v143, 18, v143
v_pk_add_f16 v150, v150, 1.0 op_sel_hi:[1,0]
v_pk_add_f16 v147, v147, 1.0 op_sel_hi:[1,0]
v_and_b32 v145, s49, v145
v_rcp_f16 v154, v153
v_bfe_u32 v144, v145, 2, 14
v_rcp_f16_e64 v151, v150
ds_read_u16_d16_hi v143, v143
ds_read_u16_d16 v144, v144
s_waitcnt lgkmcnt(7)
v_readfirstlane_b32 s43, v247
s_nop 1
s_cmp_ge_u32 s43, 32
s_cbranch_scc1 Lev7
Lev7w:
s_sleep 1
ds_read_b32 v247, v253 offset:12
s_waitcnt lgkmcnt(0)
v_readfirstlane_b32 s43, v247
s_cmp_eq_u32 s76, 0
s_cbranch_scc1 Lev7
s_sub_u32 s76, s76, 1
s_cmp_lt_u32 s43, 32
s_cbranch_scc1 Lev7w
Lev7:
v_lshrrev_b32 v145, 18, v145
ds_read_b128 v[220:223], v248 offset:29696
ds_read_u16_d16_hi v145, v145
v_mfma_f32_32x32x16_bf16 v[120:135], v[112:115], v[224:227], v[120:135]
v_rcp_f16_e64 v148, v147
v_rcp_f16_sdwa v154, v153 dst_sel:WORD_1 dst_unused:UNUSED_PRESERVE src0_sel:WORD_1
v_fma_mix_f32 v156, v136, v136, v156 op_sel:[0,0,0] op_sel_hi:[1,1,0]
s_setprio 0
v_fma_mix_f32 v156, v137, v137, v156 op_sel:[1,1,0] op_sel_hi:[1,1,0]
v_rcp_f16_sdwa v151, v150 dst_sel:WORD_1 dst_unused:UNUSED_PRESERVE src0_sel:WORD_1
v_fma_mix_f32 v156, v138, v138, v156 op_sel:[0,0,0] op_sel_hi:[1,1,0]
ds_read_b128 v[224:227], v245 offset:6528
ds_read_b128 v[192:195], v244 offset:128
ds_read_b128 v[196:199], v244 offset:64
v_mfma_f32_32x32x16_bf16 v[120:135], v[116:119], v[228:231], v[120:135]
v_rcp_f16_sdwa v148, v147 dst_sel:WORD_1 dst_unused:UNUSED_PRESERVE src0_sel:WORD_1
s_waitcnt lgkmcnt(5)
v_fma_mix_f32 v156, v139, v139, v156 op_sel:[1,1,0] op_sel_hi:[1,1,0]
v_pk_mul_f16 v155, v155, v154
v_fma_mix_f32 v156, v140, v140, v156 op_sel:[0,0,0] op_sel_hi:[1,1,0]
v_pk_mul_f16 v152, v152, v151
v_fma_mix_f32 v156, v141, v141, v156 op_sel:[1,1,0] op_sel_hi:[1,1,0]
v_pk_mul_f16 v149, v149, v148
v_fma_mix_f32 v156, v155, v155, v156 op_sel:[0,0,0] op_sel_hi:[1,1,0]
v_fma_mix_f32 v156, v142, v142, v156 op_sel:[0,0,0] op_sel_hi:[1,1,0]
v_fma_mix_f32 v156, v155, v155, v156 op_sel:[1,1,0] op_sel_hi:[1,1,0]
v_fma_mix_f32 v156, v143, v143, v156 op_sel:[1,1,0] op_sel_hi:[1,1,0]
v_fma_mix_f32 v156, v152, v152, v156 op_sel:[0,0,0] op_sel_hi:[1,1,0]
v_fma_mix_f32 v156, v152, v152, v156 op_sel:[1,1,0] op_sel_hi:[1,1,0]
v_fma_mix_f32 v156, v144, v144, v156 op_sel:[0,0,0] op_sel_hi:[1,1,0]
v_fma_mix_f32 v156, v149, v149, v156 op_sel:[0,0,0] op_sel_hi:[1,1,0]
s_waitcnt lgkmcnt(3)
v_fma_mix_f32 v156, v145, v145, v156 op_sel:[1,1,0] op_sel_hi:[1,1,0]
v_fma_mix_f32 v156, v149, v149, v156 op_sel:[1,1,0] op_sel_hi:[1,1,0]
s_setprio 2
v_mfma_f32_32x32x16_bf16 v[0:15], v[232:235], v[232:235], 0
s_add_u32 s46, s80, 14680064
buffer_store_dwordx4 v[76:79], v241, s[32:35], s46 offen sc1
ds_read_b128 v[228:231], v248 offset:32768
v_cvt_pkrtz_f16_f32 v137, v120, v121
v_cvt_pkrtz_f16_f32 v139, v122, v123
v_cvt_pkrtz_f16_f32 v141, v124, v125
v_mfma_f32_32x32x16_bf16 v[16:31], v[232:235], v[232:235], 0
v_cvt_pkrtz_f16_f32 v143, v126, v127
v_cvt_pkrtz_f16_f32 v145, v128, v129
v_cvt_pk_f16_f32 v155, v130, v131
v_cvt_pk_f16_f32 v152, v132, v133
v_mfma_f32_32x32x16_bf16 v[32:47], v[232:235], v[232:235], 0
v_cvt_pk_f16_f32 v149, v134, v135
v_pk_fma_f16 v154, v155, v155, s48
v_and_b32_e64 v137, s49, v137
v_mfma_f32_32x32x16_bf16 v[120:135], v[96:99], v[236:239], 0
ds_read_b128 v[232:235], v248 offset:30720
v_pk_fma_f16 v151, v152, v152, s48
v_and_b32_e64 v139, s49, v139
v_pk_fma_f16 v148, v149, v149, s48
v_pk_mul_f16 v154, v155, v154
v_bfe_u32 v136, v137, 2, 14
v_pk_mul_f16 v151, v152, v151
v_pk_mul_f16 v148, v149, v148
v_mfma_f32_32x32x16_bf16 v[120:135], v[100:103], v[216:219], v[120:135]
ds_read_b128 v[236:239], v245 offset:6144
ds_read_b128 v[200:203], v244
ds_read_b128 v[204:207], v243 offset:128
ds_read_u16_d16 v136, v136
v_bfe_u32 v138, v139, 2, 14
v_exp_f16 v153, v154
v_lshrrev_b32 v137, 18, v137
v_exp_f16 v150, v151
v_lshrrev_b32 v139, 18, v139
v_mfma_f32_32x32x16_bf16 v[120:135], v[104:107], v[220:223], v[120:135]
ds_read_b128 v[216:219], v248 offset:33792
ds_read_u16_d16 v138, v138
ds_read_u16_d16_hi v137, v137
ds_read_u16_d16_hi v139, v139
v_exp_f16 v147, v148
v_and_b32 v141, s49, v141
v_and_b32 v143, s49, v143
v_exp_f16_sdwa v153, v154 dst_sel:WORD_1 dst_unused:UNUSED_PRESERVE src0_sel:WORD_1
v_bfe_u32 v140, v141, 2, 14
s_waitcnt lgkmcnt(8)
v_smfmac_f32_16x16x32_bf16 v[40:43], v[226:227], v[192:195], v246
ds_read_b128 v[220:223], v245 offset:5760
ds_read_b128 v[208:211], v243 offset:64
ds_read_b128 v[212:215], v243
ds_read_u16_d16 v140, v140
v_exp_f16_sdwa v150, v151 dst_sel:WORD_1 dst_unused:UNUSED_PRESERVE src0_sel:WORD_1
v_bfe_u32 v142, v143, 2, 14
v_smfmac_f32_16x16x32_bf16 v[24:27], v[224:225], v[196:199], v246
v_exp_f16_sdwa v147, v148 dst_sel:WORD_1 dst_unused:UNUSED_PRESERVE src0_sel:WORD_1
v_lshrrev_b32_e64 v141, 18, v141
v_pk_add_f16 v153, v153, 1.0 op_sel_hi:[1,0]
v_lshrrev_b32_e64 v143, 18, v143
v_mfma_f32_32x32x16_bf16 v[120:135], v[108:111], v[228:231], v[120:135]
ds_read_b128 v[224:227], v245 offset:5376
ds_read_b128 v[192:195], v242 offset:128
ds_read_b128 v[196:199], v242 offset:64
ds_read_u16_d16 v142, v142
ds_read_u16_d16_hi v141, v141
ds_read_u16_d16_hi v143, v143
v_pk_add_f16 v150, v150, 1.0 op_sel_hi:[1,0]
v_pk_add_f16 v147, v147, 1.0 op_sel_hi:[1,0]
v_and_b32 v145, s49, v145
v_rcp_f16 v154, v153
v_bfe_u32 v144, v145, 2, 14
v_mfma_f32_32x32x16_bf16 v[120:135], v[112:115], v[232:235], v[120:135]
ds_read_b128 v[228:231], v248 offset:34816
ds_read_u16_d16 v144, v144
v_rcp_f16 v151, v150
v_lshrrev_b32 v145, 18, v145
v_rcp_f16_e64 v148, v147
v_rcp_f16_sdwa v154, v153 dst_sel:WORD_1 dst_unused:UNUSED_PRESERVE src0_sel:WORD_1
ds_read_u16_d16_hi v145, v145
s_waitcnt lgkmcnt(9)
v_fma_mix_f32 v157, v136, v136, v157 op_sel:[0,0,0] op_sel_hi:[1,1,0]
v_smfmac_f32_16x16x32_bf16 v[8:11], v[238:239], v[200:203], v246
ds_read_b128 v[232:235], v248 offset:37888
v_fma_mix_f32 v157, v137, v137, v157 op_sel:[1,1,0] op_sel_hi:[1,1,0]
v_rcp_f16_sdwa v151, v150 dst_sel:WORD_1 dst_unused:UNUSED_PRESERVE src0_sel:WORD_1
v_fma_mix_f32 v157, v138, v138, v157 op_sel:[0,0,0] op_sel_hi:[1,1,0]
v_smfmac_f32_16x16x32_bf16 v[40:43], v[236:237], v[204:207], v246
v_rcp_f16_sdwa v148, v147 dst_sel:WORD_1 dst_unused:UNUSED_PRESERVE src0_sel:WORD_1
v_fma_mix_f32 v157, v139, v139, v157 op_sel:[1,1,0] op_sel_hi:[1,1,0]
v_mfma_f32_32x32x16_bf16 v[120:135], v[116:119], v[216:219], v[120:135]
ds_read_b128 v[236:239], v248 offset:35840
v_pk_mul_f16 v155, v155, v154
v_fma_mix_f32 v157, v140, v140, v157 op_sel:[0,0,0] op_sel_hi:[1,1,0]
v_pk_mul_f16 v152, v152, v151
s_waitcnt lgkmcnt(5)
v_fma_mix_f32 v157, v141, v141, v157 op_sel:[1,1,0] op_sel_hi:[1,1,0]
v_pk_mul_f16 v149, v149, v148
v_fma_mix_f32 v157, v155, v155, v157 op_sel:[0,0,0] op_sel_hi:[1,1,0]
v_fma_mix_f32 v157, v142, v142, v157 op_sel:[0,0,0] op_sel_hi:[1,1,0]
v_smfmac_f32_16x16x32_bf16 v[24:27], v[222:223], v[208:211], v246
ds_read_b128 v[216:219], v248 offset:38912
v_fma_mix_f32 v157, v155, v155, v157 op_sel:[1,1,0] op_sel_hi:[1,1,0]
v_fma_mix_f32 v157, v143, v143, v157 op_sel:[1,1,0] op_sel_hi:[1,1,0]
v_fma_mix_f32 v157, v152, v152, v157 op_sel:[0,0,0] op_sel_hi:[1,1,0]
v_fma_mix_f32 v157, v152, v152, v157 op_sel:[1,1,0] op_sel_hi:[1,1,0]
v_smfmac_f32_16x16x32_bf16 v[8:11], v[220:221], v[212:215], v246
s_waitcnt lgkmcnt(3)
v_fma_mix_f32 v157, v144, v144, v157 op_sel:[0,0,0] op_sel_hi:[1,1,0]
v_fma_mix_f32 v157, v149, v149, v157 op_sel:[0,0,0] op_sel_hi:[1,1,0]
v_fma_mix_f32 v157, v145, v145, v157 op_sel:[1,1,0] op_sel_hi:[1,1,0]
v_fma_mix_f32 v157, v149, v149, v157 op_sel:[1,1,0] op_sel_hi:[1,1,0]
s_setprio 1
v_smfmac_f32_16x16x32_bf16 v[40:43], v[226:227], v[192:195], v246
s_add_u32 s46, s80, 16777216
buffer_store_dwordx4 v[80:83], v241, s[32:35], s46 offen sc1
ds_read_b128 v[220:223], v248 offset:36864
v_cvt_pkrtz_f16_f32 v137, v120, v121
v_cvt_pkrtz_f16_f32 v139, v122, v123
v_cvt_pkrtz_f16_f32 v141, v124, v125
v_cvt_pkrtz_f16_f32 v143, v126, v127
v_cvt_pk_f16_f32 v155, v128, v129
v_smfmac_f32_16x16x32_bf16 v[24:27], v[224:225], v[196:199], v246
v_cvt_pk_f16_f32 v152, v130, v131
v_cvt_pk_f16_f32 v149, v132, v133
v_cvt_pk_f16_f32 v146, v134, v135
v_pk_fma_f16 v154, v155, v155, s48
v_and_b32_e64 v137, s49, v137
v_mfma_f32_32x32x16_bf16 v[120:135], v[96:99], v[228:231], 0
ds_read_b128 v[224:227], v248 offset:39936
v_pk_fma_f16 v151, v152, v152, s48
v_pk_fma_f16 v148, v149, v149, s48
v_and_b32_e64 v139, s49, v139
v_pk_fma_f16 v145, v146, v146, s48
v_pk_mul_f16 v154, v155, v154
v_bfe_u32 v136, v137, 2, 14
v_pk_mul_f16 v151, v152, v151
v_pk_mul_f16 v148, v149, v148
v_bfe_u32 v138, v139, 2, 14
v_pk_mul_f16 v145, v146, v145
s_waitcnt lgkmcnt(2)
v_mfma_f32_32x32x16_bf16 v[120:135], v[100:103], v[232:235], v[120:135]
ds_read_b128 v[228:231], v245 offset:4992
ds_read_b128 v[200:203], v242
v_xor_b32 v244, 16, v244
ds_read_b128 v[204:207], v244 offset:128
ds_read_u16_d16 v136, v136
ds_read_u16_d16 v138, v138
v_exp_f16 v153, v154
v_lshrrev_b32 v137, 18, v137
v_exp_f16 v150, v151
v_lshrrev_b32 v139, 18, v139
v_exp_f16 v147, v148
v_and_b32 v141, s49, v141
v_exp_f16_e64 v144, v145
v_mfma_f32_32x32x16_bf16 v[120:135], v[104:107], v[236:239], v[120:135]
ds_read_b128 v[232:235], v245 offset:4608
ds_read_b128 v[208:211], v244 offset:64
ds_read_b128 v[212:215], v244
ds_read_u16_d16_hi v137, v137
ds_read_u16_d16_hi v139, v139
v_and_b32_e64 v143, s49, v143
v_exp_f16_sdwa v153, v154 dst_sel:WORD_1 dst_unused:UNUSED_PRESERVE src0_sel:WORD_1
v_bfe_u32 v140, v141, 2, 14
v_exp_f16_sdwa v150, v151 dst_sel:WORD_1 dst_unused:UNUSED_PRESERVE src0_sel:WORD_1
v_bfe_u32 v142, v143, 2, 14
v_exp_f16_sdwa v147, v148 dst_sel:WORD_1 dst_unused:UNUSED_PRESERVE src0_sel:WORD_1
v_lshrrev_b32_e64 v141, 18, v141
v_mfma_f32_32x32x16_bf16 v[120:135], v[108:111], v[216:219], v[120:135]
ds_read_b128 v[236:239], v248 offset:40960
ds_read_u16_d16 v140, v140
ds_read_u16_d16 v142, v142
ds_read_u16_d16_hi v141, v141
v_exp_f16_sdwa v144, v145 dst_sel:WORD_1 dst_unused:UNUSED_PRESERVE src0_sel:WORD_1
v_lshrrev_b32_e64 v143, 18, v143
v_pk_add_f16 v153, v153, 1.0 op_sel_hi:[1,0]
v_pk_add_f16 v150, v150, 1.0 op_sel_hi:[1,0]
v_pk_add_f16 v147, v147, 1.0 op_sel_hi:[1,0]
v_pk_add_f16 v144, v144, 1.0 op_sel_hi:[1,0]
v_rcp_f16_e64 v154, v153
v_rcp_f16 v151, v150
s_waitcnt lgkmcnt(8)
v_mfma_f32_32x32x16_bf16 v[120:135], v[112:115], v[220:223], v[120:135]
ds_read_b128 v[216:219], v248 offset:44032
ds_read_u16_d16_hi v143, v143
v_rcp_f16 v148, v147
v_rcp_f16 v145, v144
v_rcp_f16_sdwa v154, v153 dst_sel:WORD_1 dst_unused:UNUSED_PRESERVE src0_sel:WORD_1
v_rcp_f16_sdwa v151, v150 dst_sel:WORD_1 dst_unused:UNUSED_PRESERVE src0_sel:WORD_1
s_setprio 0
v_rcp_f16_sdwa v148, v147 dst_sel:WORD_1 dst_unused:UNUSED_PRESERVE src0_sel:WORD_1
v_fma_mix_f32 v158, v136, v136, v158 op_sel:[0,0,0] op_sel_hi:[1,1,0]
v_mfma_f32_32x32x16_bf16 v[120:135], v[116:119], v[224:227], v[120:135]
ds_read_b128 v[220:223], v248 offset:41984
v_rcp_f16_sdwa v145, v144 dst_sel:WORD_1 dst_unused:UNUSED_PRESERVE src0_sel:WORD_1
s_waitcnt lgkmcnt(5)
v_fma_mix_f32 v158, v137, v137, v158 op_sel:[1,1,0] op_sel_hi:[1,1,0]
v_pk_mul_f16 v155, v155, v154
v_fma_mix_f32 v158, v138, v138, v158 op_sel:[0,0,0] op_sel_hi:[1,1,0]
v_pk_mul_f16 v152, v152, v151
v_pk_mul_f16 v149, v149, v148
v_fma_mix_f32 v158, v139, v139, v158 op_sel:[1,1,0] op_sel_hi:[1,1,0]
v_pk_mul_f16 v146, v146, v145
v_fma_mix_f32 v158, v155, v155, v158 op_sel:[0,0,0] op_sel_hi:[1,1,0]
v_smfmac_f32_16x16x32_bf16 v[8:11], v[230:231], v[200:203], v246
ds_read_b128 v[224:227], v248 offset:45056
v_fma_mix_f32 v158, v140, v140, v158 op_sel:[0,0,0] op_sel_hi:[1,1,0]
v_fma_mix_f32 v158, v155, v155, v158 op_sel:[1,1,0] op_sel_hi:[1,1,0]
v_fma_mix_f32 v158, v152, v152, v158 op_sel:[0,0,0] op_sel_hi:[1,1,0]
s_waitcnt lgkmcnt(2)
v_fma_mix_f32 v158, v141, v141, v158 op_sel:[1,1,0] op_sel_hi:[1,1,0]
v_fma_mix_f32 v158, v152, v152, v158 op_sel:[1,1,0] op_sel_hi:[1,1,0]
v_smfmac_f32_16x16x32_bf16 v[44:47], v[228:229], v[204:207], v246
v_fma_mix_f32 v158, v149, v149, v158 op_sel:[0,0,0] op_sel_hi:[1,1,0]
v_fma_mix_f32 v158, v142, v142, v158 op_sel:[0,0,0] op_sel_hi:[1,1,0]
v_fma_mix_f32 v158, v149, v149, v158 op_sel:[1,1,0] op_sel_hi:[1,1,0]
v_fma_mix_f32 v158, v146, v146, v158 op_sel:[0,0,0] op_sel_hi:[1,1,0]
v_fma_mix_f32 v158, v143, v143, v158 op_sel:[1,1,0] op_sel_hi:[1,1,0]
v_fma_mix_f32 v158, v146, v146, v158 op_sel:[1,1,0] op_sel_hi:[1,1,0]
s_setprio 2
v_smfmac_f32_16x16x32_bf16 v[28:31], v[234:235], v[208:211], v246
s_add_u32 s46, s80, 18874368
buffer_store_dwordx4 v[84:87], v241, s[32:35], s46 offen sc1
ds_read_b128 v[228:231], v248 offset:43008
v_cvt_pkrtz_f16_f32 v137, v120, v121
v_cvt_pkrtz_f16_f32 v139, v122, v123
v_cvt_pkrtz_f16_f32 v141, v124, v125
v_cvt_pkrtz_f16_f32 v143, v126, v127
v_smfmac_f32_16x16x32_bf16 v[12:15], v[232:233], v[212:215], v246
v_cvt_pkrtz_f16_f32 v145, v128, v129
v_cvt_pk_f16_f32 v155, v130, v131
v_cvt_pk_f16_f32 v152, v132, v133
v_cvt_pk_f16_f32 v149, v134, v135
v_pk_fma_f16 v154, v155, v155, s48
v_mfma_f32_32x32x16_bf16 v[120:135], v[96:99], v[236:239], 0
ds_read_b128 v[232:235], v248 offset:46080
v_and_b32_e64 v137, s49, v137
v_pk_fma_f16 v151, v152, v152, s48
v_and_b32_e64 v139, s49, v139
v_pk_fma_f16 v148, v149, v149, s48
v_pk_mul_f16 v154, v155, v154
v_bfe_u32 v136, v137, 2, 14
v_pk_mul_f16 v151, v152, v151
v_pk_mul_f16 v148, v149, v148
v_bfe_u32 v138, v139, 2, 14
v_mfma_f32_32x32x16_bf16 v[120:135], v[100:103], v[216:219], v[120:135]
ds_read_b128 v[236:239], v245 offset:4224
v_xor_b32 v243, 16, v243
ds_read_b128 v[192:195], v243 offset:128
ds_read_b128 v[196:199], v243 offset:64
ds_read_u16_d16 v136, v136
ds_read_u16_d16 v138, v138
v_exp_f16 v153, v154
v_lshrrev_b32 v137, 18, v137
v_exp_f16 v150, v151
v_lshrrev_b32 v139, 18, v139
v_exp_f16 v147, v148
v_and_b32 v141, s49, v141
v_and_b32 v143, s49, v143
s_waitcnt lgkmcnt(6)
v_mfma_f32_32x32x16_bf16 v[120:135], v[104:107], v[220:223], v[120:135]
ds_read_b128 v[216:219], v245 offset:3840
ds_read_b128 v[200:203], v243
v_xor_b32 v242, 16, v242
ds_read_b128 v[204:207], v242 offset:128
ds_read_u16_d16_hi v137, v137
ds_read_u16_d16_hi v139, v139
v_exp_f16_sdwa v153, v154 dst_sel:WORD_1 dst_unused:UNUSED_PRESERVE src0_sel:WORD_1
v_bfe_u32 v140, v141, 2, 14
v_exp_f16_sdwa v150, v151 dst_sel:WORD_1 dst_unused:UNUSED_PRESERVE src0_sel:WORD_1
v_bfe_u32 v142, v143, 2, 14
v_exp_f16_sdwa v147, v148 dst_sel:WORD_1 dst_unused:UNUSED_PRESERVE src0_sel:WORD_1
v_lshrrev_b32_e64 v141, 18, v141
v_mfma_f32_32x32x16_bf16 v[120:135], v[108:111], v[224:227], v[120:135]
ds_read_b128 v[220:223], v248 offset:47104
ds_read_u16_d16 v140, v140
ds_read_u16_d16 v142, v142
ds_read_u16_d16_hi v141, v141
v_pk_add_f16 v153, v153, 1.0 op_sel_hi:[1,0]
v_lshrrev_b32_e64 v143, 18, v143
v_pk_add_f16 v150, v150, 1.0 op_sel_hi:[1,0]
v_pk_add_f16 v147, v147, 1.0 op_sel_hi:[1,0]
v_and_b32 v145, s49, v145
v_rcp_f16 v154, v153
v_bfe_u32 v144, v145, 2, 14
v_mfma_f32_32x32x16_bf16 v[120:135], v[112:115], v[228:231], v[120:135]
ds_read_b128 v[224:227], v248 offset:50176
ds_read_u16_d16_hi v143, v143
ds_read_u16_d16 v144, v144
v_rcp_f16 v151, v150
v_lshrrev_b32 v145, 18, v145
v_rcp_f16 v148, v147
v_rcp_f16_sdwa v154, v153 dst_sel:WORD_1 dst_unused:UNUSED_PRESERVE src0_sel:WORD_1
ds_read_u16_d16_hi v145, v145
s_waitcnt lgkmcnt(8)
v_fma_mix_f32 v159, v136, v136, v159 op_sel:[0,0,0] op_sel_hi:[1,1,0]
v_fma_mix_f32 v159, v137, v137, v159 op_sel:[1,1,0] op_sel_hi:[1,1,0]
v_rcp_f16_sdwa v151, v150 dst_sel:WORD_1 dst_unused:UNUSED_PRESERVE src0_sel:WORD_1
v_mfma_f32_32x32x16_bf16 v[120:135], v[116:119], v[232:235], v[120:135]
ds_read_b128 v[228:231], v248 offset:48128
v_fma_mix_f32 v159, v138, v138, v159 op_sel:[0,0,0] op_sel_hi:[1,1,0]
v_rcp_f16_sdwa v148, v147 dst_sel:WORD_1 dst_unused:UNUSED_PRESERVE src0_sel:WORD_1
v_fma_mix_f32 v159, v139, v139, v159 op_sel:[1,1,0] op_sel_hi:[1,1,0]
v_pk_mul_f16 v155, v155, v154
s_waitcnt lgkmcnt(5)
v_fma_mix_f32 v159, v140, v140, v159 op_sel:[0,0,0] op_sel_hi:[1,1,0]
v_pk_mul_f16 v152, v152, v151
v_fma_mix_f32 v159, v141, v141, v159 op_sel:[1,1,0] op_sel_hi:[1,1,0]
v_pk_mul_f16 v149, v149, v148
v_smfmac_f32_16x16x32_bf16 v[44:47], v[238:239], v[192:195], v246
ds_read_b128 v[232:235], v248 offset:51200
v_fma_mix_f32 v159, v155, v155, v159 op_sel:[0,0,0] op_sel_hi:[1,1,0]
v_fma_mix_f32 v159, v142, v142, v159 op_sel:[0,0,0] op_sel_hi:[1,1,0]
v_fma_mix_f32 v159, v155, v155, v159 op_sel:[1,1,0] op_sel_hi:[1,1,0]
s_waitcnt lgkmcnt(3)
v_fma_mix_f32 v159, v143, v143, v159 op_sel:[1,1,0] op_sel_hi:[1,1,0]
v_fma_mix_f32 v159, v152, v152, v159 op_sel:[0,0,0] op_sel_hi:[1,1,0]
v_smfmac_f32_16x16x32_bf16 v[28:31], v[236:237], v[196:199], v246
v_fma_mix_f32 v159, v152, v152, v159 op_sel:[1,1,0] op_sel_hi:[1,1,0]
v_fma_mix_f32 v159, v144, v144, v159 op_sel:[0,0,0] op_sel_hi:[1,1,0]
v_fma_mix_f32 v159, v149, v149, v159 op_sel:[0,0,0] op_sel_hi:[1,1,0]
s_waitcnt lgkmcnt(2)
v_fma_mix_f32 v159, v145, v145, v159 op_sel:[1,1,0] op_sel_hi:[1,1,0]
v_fma_mix_f32 v159, v149, v149, v159 op_sel:[1,1,0] op_sel_hi:[1,1,0]
s_setprio 1
v_smfmac_f32_16x16x32_bf16 v[12:15], v[218:219], v[200:203], v246
s_add_u32 s46, s80, 20971520
buffer_store_dwordx4 v[88:91], v241, s[32:35], s46 offen sc1
ds_read_b128 v[236:239], v248 offset:49152
v_cvt_pkrtz_f16_f32 v137, v120, v121
v_cvt_pkrtz_f16_f32 v139, v122, v123
v_cvt_pkrtz_f16_f32 v141, v124, v125
v_cvt_pkrtz_f16_f32 v143, v126, v127
v_cvt_pk_f16_f32 v155, v128, v129
v_smfmac_f32_16x16x32_bf16 v[44:47], v[216:217], v[204:207], v246
v_cvt_pk_f16_f32 v152, v130, v131
v_cvt_pk_f16_f32 v149, v132, v133
v_cvt_pk_f16_f32 v146, v134, v135
v_pk_fma_f16 v154, v155, v155, s48
v_and_b32_e64 v137, s49, v137
v_mfma_f32_32x32x16_bf16 v[120:135], v[96:99], v[220:223], 0
ds_read_b128 v[216:219], v248 offset:52224
v_pk_fma_f16 v151, v152, v152, s48
v_pk_fma_f16 v148, v149, v149, s48
v_and_b32_e64 v139, s49, v139
v_pk_fma_f16 v145, v146, v146, s48
v_pk_mul_f16 v154, v155, v154
v_bfe_u32 v136, v137, 2, 14
v_pk_mul_f16 v151, v152, v151
v_pk_mul_f16 v148, v149, v148
v_bfe_u32 v138, v139, 2, 14
v_pk_mul_f16 v145, v146, v145
v_mfma_f32_32x32x16_bf16 v[120:135], v[100:103], v[224:227], v[120:135]
ds_read_b128 v[220:223], v245 offset:3456
ds_read_b128 v[208:211], v242 offset:64
ds_read_b128 v[212:215], v242
ds_read_u16_d16 v136, v136
ds_read_u16_d16 v138, v138
v_exp_f16 v153, v154
v_lshrrev_b32 v137, 18, v137
v_exp_f16 v150, v151
v_lshrrev_b32 v139, 18, v139
v_exp_f16 v147, v148
v_and_b32 v141, s49, v141
v_exp_f16_e64 v144, v145
s_waitcnt lgkmcnt(6)
v_mfma_f32_32x32x16_bf16 v[120:135], v[104:107], v[228:231], v[120:135]
ds_read_b128 v[224:227], v245 offset:3072
v_xor_b32 v244, 32, v244
ds_read_b128 v[192:195], v244 offset:128
ds_read_b128 v[196:199], v244 offset:64
ds_read_u16_d16_hi v137, v137
ds_read_u16_d16_hi v139, v139
v_and_b32_e64 v143, s49, v143
v_exp_f16_sdwa v153, v154 dst_sel:WORD_1 dst_unused:UNUSED_PRESERVE src0_sel:WORD_1
v_bfe_u32 v140, v141, 2, 14
v_exp_f16_sdwa v150, v151 dst_sel:WORD_1 dst_unused:UNUSED_PRESERVE src0_sel:WORD_1
v_bfe_u32 v142, v143, 2, 14
v_exp_f16_sdwa v147, v148 dst_sel:WORD_1 dst_unused:UNUSED_PRESERVE src0_sel:WORD_1
v_lshrrev_b32_e64 v141, 18, v141
v_mfma_f32_32x32x16_bf16 v[120:135], v[108:111], v[232:235], v[120:135]
ds_read_b128 v[228:231], v248 offset:53248
ds_read_u16_d16 v140, v140
ds_read_u16_d16 v142, v142
ds_read_u16_d16_hi v141, v141
v_exp_f16_sdwa v144, v145 dst_sel:WORD_1 dst_unused:UNUSED_PRESERVE src0_sel:WORD_1
v_lshrrev_b32_e64 v143, 18, v143
v_pk_add_f16 v153, v153, 1.0 op_sel_hi:[1,0]
v_pk_add_f16 v150, v150, 1.0 op_sel_hi:[1,0]
v_pk_add_f16 v147, v147, 1.0 op_sel_hi:[1,0]
v_pk_add_f16 v144, v144, 1.0 op_sel_hi:[1,0]
v_rcp_f16 v154, v153
v_rcp_f16 v151, v150
v_mfma_f32_32x32x16_bf16 v[120:135], v[112:115], v[236:239], v[120:135]
ds_read_b128 v[232:235], v248 offset:56320
ds_read_u16_d16_hi v143, v143
v_rcp_f16_e64 v148, v147
v_rcp_f16 v145, v144
v_rcp_f16_sdwa v154, v153 dst_sel:WORD_1 dst_unused:UNUSED_PRESERVE src0_sel:WORD_1
v_rcp_f16_sdwa v151, v150 dst_sel:WORD_1 dst_unused:UNUSED_PRESERVE src0_sel:WORD_1
s_setprio 0
v_rcp_f16_sdwa v148, v147 dst_sel:WORD_1 dst_unused:UNUSED_PRESERVE src0_sel:WORD_1
s_waitcnt lgkmcnt(6)
v_fma_mix_f32 v160, v136, v136, v160 op_sel:[0,0,0] op_sel_hi:[1,1,0]
v_mfma_f32_32x32x16_bf16 v[120:135], v[116:119], v[216:219], v[120:135]
ds_read_b128 v[236:239], v248 offset:54272
v_rcp_f16_sdwa v145, v144 dst_sel:WORD_1 dst_unused:UNUSED_PRESERVE src0_sel:WORD_1
v_fma_mix_f32 v160, v137, v137, v160 op_sel:[1,1,0] op_sel_hi:[1,1,0]
v_pk_mul_f16 v155, v155, v154
v_fma_mix_f32 v160, v138, v138, v160 op_sel:[0,0,0] op_sel_hi:[1,1,0]
v_pk_mul_f16 v152, v152, v151
v_pk_mul_f16 v149, v149, v148
v_fma_mix_f32 v160, v139, v139, v160 op_sel:[1,1,0] op_sel_hi:[1,1,0]
v_pk_mul_f16 v146, v146, v145
v_fma_mix_f32 v160, v155, v155, v160 op_sel:[0,0,0] op_sel_hi:[1,1,0]
v_smfmac_f32_16x16x32_bf16 v[28:31], v[222:223], v[208:211], v246
ds_read_b128 v[216:219], v248 offset:57344
s_waitcnt lgkmcnt(4)
v_fma_mix_f32 v160, v140, v140, v160 op_sel:[0,0,0] op_sel_hi:[1,1,0]
v_fma_mix_f32 v160, v155, v155, v160 op_sel:[1,1,0] op_sel_hi:[1,1,0]
v_fma_mix_f32 v160, v152, v152, v160 op_sel:[0,0,0] op_sel_hi:[1,1,0]
v_fma_mix_f32 v160, v141, v141, v160 op_sel:[1,1,0] op_sel_hi:[1,1,0]
v_fma_mix_f32 v160, v152, v152, v160 op_sel:[1,1,0] op_sel_hi:[1,1,0]
v_smfmac_f32_16x16x32_bf16 v[12:15], v[220:221], v[212:215], v246
v_fma_mix_f32 v160, v149, v149, v160 op_sel:[0,0,0] op_sel_hi:[1,1,0]
v_fma_mix_f32 v160, v142, v142, v160 op_sel:[0,0,0] op_sel_hi:[1,1,0]
v_fma_mix_f32 v160, v149, v149, v160 op_sel:[1,1,0] op_sel_hi:[1,1,0]
v_fma_mix_f32 v160, v146, v146, v160 op_sel:[0,0,0] op_sel_hi:[1,1,0]
s_waitcnt lgkmcnt(2)
v_fma_mix_f32 v160, v143, v143, v160 op_sel:[1,1,0] op_sel_hi:[1,1,0]
v_fma_mix_f32 v160, v146, v146, v160 op_sel:[1,1,0] op_sel_hi:[1,1,0]
s_setprio 2
v_smfmac_f32_16x16x32_bf16 v[36:39], v[226:227], v[192:195], v246
s_add_u32 s46, s80, 23068672
buffer_store_dwordx4 v[92:95], v241, s[32:35], s46 offen sc1
ds_read_b128 v[220:223], v248 offset:55296
v_cvt_pkrtz_f16_f32 v137, v120, v121
v_cvt_pkrtz_f16_f32 v139, v122, v123
v_cvt_pkrtz_f16_f32 v141, v124, v125
v_cvt_pkrtz_f16_f32 v143, v126, v127
v_smfmac_f32_16x16x32_bf16 v[20:23], v[224:225], v[196:199], v246
v_cvt_pkrtz_f16_f32 v145, v128, v129
v_cvt_pk_f16_f32 v155, v130, v131
v_cvt_pk_f16_f32 v152, v132, v133
v_cvt_pk_f16_f32 v149, v134, v135
v_mfma_f32_32x32x16_bf16 v[120:135], v[96:99], v[228:231], 0
ds_read_b128 v[224:227], v245 offset:2688
ds_read_b128 v[200:203], v244
v_xor_b32 v243, 32, v243
ds_read_b128 v[204:207], v243 offset:128
v_pk_fma_f16 v154, v155, v155, s48
v_and_b32 v137, s49, v137
v_pk_fma_f16 v151, v152, v152, s48
v_and_b32_e64 v139, s49, v139
v_pk_fma_f16 v148, v149, v149, s48
v_pk_mul_f16 v154, v155, v154
v_bfe_u32 v136, v137, 2, 14
v_pk_mul_f16 v151, v152, v151
v_mfma_f32_32x32x16_bf16 v[120:135], v[100:103], v[232:235], v[120:135]
ds_read_b128 v[228:231], v248 offset:58368
ds_read_u16_d16 v136, v136
v_pk_mul_f16 v148, v149, v148
v_bfe_u32 v138, v139, 2, 14
v_exp_f16 v153, v154
v_lshrrev_b32 v137, 18, v137
v_exp_f16_e64 v150, v151
v_lshrrev_b32 v139, 18, v139
s_waitcnt lgkmcnt(5)
v_mfma_f32_32x32x16_bf16 v[120:135], v[104:107], v[236:239], v[120:135]
ds_read_b128 v[232:235], v245 offset:2304
ds_read_b128 v[208:211], v243 offset:64
ds_read_b128 v[212:215], v243
ds_read_u16_d16 v138, v138
ds_read_u16_d16_hi v137, v137
ds_read_u16_d16_hi v139, v139
v_exp_f16 v147, v148
v_and_b32 v141, s49, v141
v_and_b32 v143, s49, v143
v_exp_f16_sdwa v153, v154 dst_sel:WORD_1 dst_unused:UNUSED_PRESERVE src0_sel:WORD_1
v_bfe_u32 v140, v141, 2, 14
v_exp_f16_sdwa v150, v151 dst_sel:WORD_1 dst_unused:UNUSED_PRESERVE src0_sel:WORD_1
v_mfma_f32_32x32x16_bf16 v[120:135], v[108:111], v[216:219], v[120:135]
ds_read_b128 v[236:239], v245 offset:1920
v_xor_b32 v242, 32, v242
ds_read_b128 v[192:195], v242 offset:128
ds_read_b128 v[196:199], v242 offset:64
ds_read_u16_d16 v140, v140
v_bfe_u32 v142, v143, 2, 14
v_exp_f16_sdwa v147, v148 dst_sel:WORD_1 dst_unused:UNUSED_PRESERVE src0_sel:WORD_1
v_lshrrev_b32_e64 v141, 18, v141
v_pk_add_f16 v153, v153, 1.0 op_sel_hi:[1,0]
v_lshrrev_b32_e64 v143, 18, v143
v_pk_add_f16 v150, v150, 1.0 op_sel_hi:[1,0]
v_pk_add_f16 v147, v147, 1.0 op_sel_hi:[1,0]
v_mfma_f32_32x32x16_bf16 v[120:135], v[112:115], v[220:223], v[120:135]
ds_read_b128 v[216:219], v248 offset:59392
ds_read_u16_d16 v142, v142
ds_read_u16_d16_hi v141, v141
ds_read_u16_d16_hi v143, v143
v_and_b32 v145, s49, v145
v_rcp_f16 v154, v153
v_bfe_u32 v144, v145, 2, 14
v_rcp_f16 v151, v150
v_lshrrev_b32 v145, 18, v145
v_rcp_f16 v148, v147
s_waitcnt lgkmcnt(8)
v_smfmac_f32_16x16x32_bf16 v[4:7], v[226:227], v[200:203], v246
ds_read_b128 v[220:223], v248 offset:62464
ds_read_u16_d16 v144, v144
ds_read_u16_d16_hi v145, v145
v_rcp_f16_sdwa v154, v153 dst_sel:WORD_1 dst_unused:UNUSED_PRESERVE src0_sel:WORD_1
v_fma_mix_f32 v161, v136, v136, v161 op_sel:[0,0,0] op_sel_hi:[1,1,0]
v_fma_mix_f32 v161, v137, v137, v161 op_sel:[1,1,0] op_sel_hi:[1,1,0]
v_smfmac_f32_16x16x32_bf16 v[36:39], v[224:225], v[204:207], v246
v_rcp_f16_sdwa v151, v150 dst_sel:WORD_1 dst_unused:UNUSED_PRESERVE src0_sel:WORD_1
v_fma_mix_f32 v161, v138, v138, v161 op_sel:[0,0,0] op_sel_hi:[1,1,0]
v_mfma_f32_32x32x16_bf16 v[120:135], v[116:119], v[228:231], v[120:135]
ds_read_b128 v[224:227], v248 offset:60416
v_rcp_f16_sdwa v148, v147 dst_sel:WORD_1 dst_unused:UNUSED_PRESERVE src0_sel:WORD_1
v_fma_mix_f32 v161, v139, v139, v161 op_sel:[1,1,0] op_sel_hi:[1,1,0]
v_pk_mul_f16 v155, v155, v154
s_waitcnt lgkmcnt(6)
v_fma_mix_f32 v161, v140, v140, v161 op_sel:[0,0,0] op_sel_hi:[1,1,0]
v_pk_mul_f16 v152, v152, v151
s_waitcnt lgkmcnt(4)
v_fma_mix_f32 v161, v141, v141, v161 op_sel:[1,1,0] op_sel_hi:[1,1,0]
v_pk_mul_f16 v149, v149, v148
v_fma_mix_f32 v161, v155, v155, v161 op_sel:[0,0,0] op_sel_hi:[1,1,0]
v_smfmac_f32_16x16x32_bf16 v[20:23], v[234:235], v[208:211], v246
ds_read_b128 v[228:231], v248 offset:63488
v_fma_mix_f32 v161, v142, v142, v161 op_sel:[0,0,0] op_sel_hi:[1,1,0]
v_fma_mix_f32 v161, v155, v155, v161 op_sel:[1,1,0] op_sel_hi:[1,1,0]
v_fma_mix_f32 v161, v143, v143, v161 op_sel:[1,1,0] op_sel_hi:[1,1,0]
v_fma_mix_f32 v161, v152, v152, v161 op_sel:[0,0,0] op_sel_hi:[1,1,0]
v_smfmac_f32_16x16x32_bf16 v[4:7], v[232:233], v[212:215], v246
v_fma_mix_f32 v161, v152, v152, v161 op_sel:[1,1,0] op_sel_hi:[1,1,0]
s_waitcnt lgkmcnt(2)
v_fma_mix_f32 v161, v144, v144, v161 op_sel:[0,0,0] op_sel_hi:[1,1,0]
v_fma_mix_f32 v161, v149, v149, v161 op_sel:[0,0,0] op_sel_hi:[1,1,0]
v_fma_mix_f32 v161, v145, v145, v161 op_sel:[1,1,0] op_sel_hi:[1,1,0]
v_fma_mix_f32 v161, v149, v149, v161 op_sel:[1,1,0] op_sel_hi:[1,1,0]
s_setprio 1
v_smfmac_f32_16x16x32_bf16 v[36:39], v[238:239], v[192:195], v246
ds_read_b128 v[232:235], v248 offset:61440
v_cvt_pkrtz_f16_f32 v137, v120, v121
v_cvt_pkrtz_f16_f32 v139, v122, v123
v_cvt_pkrtz_f16_f32 v141, v124, v125
v_cvt_pkrtz_f16_f32 v143, v126, v127
v_cvt_pk_f16_f32 v155, v128, v129
v_smfmac_f32_16x16x32_bf16 v[20:23], v[236:237], v[196:199], v246
v_cvt_pk_f16_f32 v152, v130, v131
v_cvt_pk_f16_f32 v149, v132, v133
v_cvt_pk_f16_f32 v146, v134, v135
v_pk_fma_f16 v154, v155, v155, s48
v_and_b32_e64 v137, s49, v137
v_mfma_f32_32x32x16_bf16 v[120:135], v[96:99], v[216:219], 0
ds_read_b128 v[236:239], v248 offset:64512
v_pk_fma_f16 v151, v152, v152, s48
v_pk_fma_f16 v148, v149, v149, s48
v_and_b32_e64 v139, s49, v139
v_pk_fma_f16 v145, v146, v146, s48
v_pk_mul_f16 v154, v155, v154
v_bfe_u32 v136, v137, 2, 14
v_pk_mul_f16 v151, v152, v151
v_pk_mul_f16 v148, v149, v148
v_bfe_u32 v138, v139, 2, 14
v_pk_mul_f16 v145, v146, v145
v_mfma_f32_32x32x16_bf16 v[120:135], v[100:103], v[220:223], v[120:135]
ds_read_b128 v[216:219], v245 offset:1536
ds_read_b128 v[200:203], v242
v_xor_b32 v244, 16, v244
ds_read_b128 v[204:207], v244 offset:128
ds_read_u16_d16 v136, v136
ds_read_u16_d16 v138, v138
v_exp_f16 v153, v154
v_lshrrev_b32 v137, 18, v137
v_exp_f16 v150, v151
v_lshrrev_b32 v139, 18, v139
v_exp_f16 v147, v148
v_and_b32_e64 v141, s49, v141
v_exp_f16 v144, v145
s_waitcnt lgkmcnt(5)
v_mfma_f32_32x32x16_bf16 v[120:135], v[104:107], v[224:227], v[120:135]
ds_read_b128 v[220:223], v245 offset:1152
ds_read_b128 v[208:211], v244 offset:64
ds_read_b128 v[212:215], v244
ds_read_u16_d16_hi v137, v137
ds_read_u16_d16_hi v139, v139
v_and_b32_e64 v143, s49, v143
v_exp_f16_sdwa v153, v154 dst_sel:WORD_1 dst_unused:UNUSED_PRESERVE src0_sel:WORD_1
v_bfe_u32 v140, v141, 2, 14
v_exp_f16_sdwa v150, v151 dst_sel:WORD_1 dst_unused:UNUSED_PRESERVE src0_sel:WORD_1
v_bfe_u32 v142, v143, 2, 14
v_exp_f16_sdwa v147, v148 dst_sel:WORD_1 dst_unused:UNUSED_PRESERVE src0_sel:WORD_1
v_lshrrev_b32_e64 v141, 18, v141
v_mfma_f32_32x32x16_bf16 v[120:135], v[108:111], v[228:231], v[120:135]
ds_read_b128 v[224:227], v249
ds_read_u16_d16 v140, v140
ds_read_u16_d16 v142, v142
ds_read_u16_d16_hi v141, v141
v_exp_f16_sdwa v144, v145 dst_sel:WORD_1 dst_unused:UNUSED_PRESERVE src0_sel:WORD_1
v_lshrrev_b32_e64 v143, 18, v143
v_pk_add_f16 v153, v153, 1.0 op_sel_hi:[1,0]
v_pk_add_f16 v150, v150, 1.0 op_sel_hi:[1,0]
v_pk_add_f16 v147, v147, 1.0 op_sel_hi:[1,0]
v_pk_add_f16 v144, v144, 1.0 op_sel_hi:[1,0]
v_rcp_f16 v154, v153
v_rcp_f16 v151, v150
v_mfma_f32_32x32x16_bf16 v[120:135], v[112:115], v[232:235], v[120:135]
ds_read_b128 v[228:231], v249 offset:3072
ds_read_u16_d16_hi v143, v143
v_rcp_f16 v148, v147
v_rcp_f16 v145, v144
v_rcp_f16_sdwa v154, v153 dst_sel:WORD_1 dst_unused:UNUSED_PRESERVE src0_sel:WORD_1
v_rcp_f16_sdwa v151, v150 dst_sel:WORD_1 dst_unused:UNUSED_PRESERVE src0_sel:WORD_1
s_setprio 0
v_rcp_f16_sdwa v148, v147 dst_sel:WORD_1 dst_unused:UNUSED_PRESERVE src0_sel:WORD_1
s_waitcnt lgkmcnt(6)
v_fma_mix_f32 v162, v136, v136, v162 op_sel:[0,0,0] op_sel_hi:[1,1,0]
v_mfma_f32_32x32x16_bf16 v[120:135], v[116:119], v[236:239], v[120:135]
ds_read_b128 v[232:235], v249 offset:1024
v_rcp_f16_sdwa v145, v144 dst_sel:WORD_1 dst_unused:UNUSED_PRESERVE src0_sel:WORD_1
v_fma_mix_f32 v162, v137, v137, v162 op_sel:[1,1,0] op_sel_hi:[1,1,0]
v_pk_mul_f16 v155, v155, v154
v_fma_mix_f32 v162, v138, v138, v162 op_sel:[0,0,0] op_sel_hi:[1,1,0]
v_pk_mul_f16 v152, v152, v151
v_pk_mul_f16 v149, v149, v148
v_fma_mix_f32 v162, v139, v139, v162 op_sel:[1,1,0] op_sel_hi:[1,1,0]
v_pk_mul_f16 v146, v146, v145
v_fma_mix_f32 v162, v155, v155, v162 op_sel:[0,0,0] op_sel_hi:[1,1,0]
v_smfmac_f32_16x16x32_bf16 v[4:7], v[218:219], v[200:203], v246
ds_read_b128 v[236:239], v249 offset:4096
s_waitcnt lgkmcnt(4)
v_fma_mix_f32 v162, v140, v140, v162 op_sel:[0,0,0] op_sel_hi:[1,1,0]
v_fma_mix_f32 v162, v155, v155, v162 op_sel:[1,1,0] op_sel_hi:[1,1,0]
v_fma_mix_f32 v162, v152, v152, v162 op_sel:[0,0,0] op_sel_hi:[1,1,0]
v_fma_mix_f32 v162, v141, v141, v162 op_sel:[1,1,0] op_sel_hi:[1,1,0]
v_fma_mix_f32 v162, v152, v152, v162 op_sel:[1,1,0] op_sel_hi:[1,1,0]
v_smfmac_f32_16x16x32_bf16 v[32:35], v[216:217], v[204:207], v246
v_fma_mix_f32 v162, v149, v149, v162 op_sel:[0,0,0] op_sel_hi:[1,1,0]
v_fma_mix_f32 v162, v142, v142, v162 op_sel:[0,0,0] op_sel_hi:[1,1,0]
v_fma_mix_f32 v162, v149, v149, v162 op_sel:[1,1,0] op_sel_hi:[1,1,0]
v_fma_mix_f32 v162, v146, v146, v162 op_sel:[0,0,0] op_sel_hi:[1,1,0]
s_waitcnt lgkmcnt(2)
v_fma_mix_f32 v162, v143, v143, v162 op_sel:[1,1,0] op_sel_hi:[1,1,0]
v_fma_mix_f32 v162, v146, v146, v162 op_sel:[1,1,0] op_sel_hi:[1,1,0]
s_cmp_lg_u32 s40, 0
s_cbranch_scc1 Lrs0
v_mov_b32 v90, 0
buffer_load_dword v91, v90, s[36:39], 0 offen sc1
Lrs0:
s_setprio 2
v_smfmac_f32_16x16x32_bf16 v[16:19], v[222:223], v[208:211], v246
ds_read_b128 v[216:219], v249 offset:2048
v_cvt_pkrtz_f16_f32 v137, v120, v121
v_cvt_pkrtz_f16_f32 v139, v122, v123
v_cvt_pkrtz_f16_f32 v141, v124, v125
v_cvt_pkrtz_f16_f32 v143, v126, v127
v_smfmac_f32_16x16x32_bf16 v[0:3], v[220:221], v[212:215], v246
v_cvt_pkrtz_f16_f32 v145, v128, v129
v_cvt_pk_f16_f32 v155, v130, v131
v_cvt_pk_f16_f32 v152, v132, v133
v_cvt_pk_f16_f32 v149, v134, v135
v_pk_fma_f16 v154, v155, v155, s48
v_mfma_f32_32x32x16_bf16 v[120:135], v[96:99], v[224:227], 0
ds_read_b128 v[220:223], v249 offset:5120
v_and_b32_e64 v137, s49, v137
v_pk_fma_f16 v151, v152, v152, s48
v_and_b32_e64 v139, s49, v139
v_pk_fma_f16 v148, v149, v149, s48
v_pk_mul_f16 v154, v155, v154
v_bfe_u32 v136, v137, 2, 14
v_pk_mul_f16 v151, v152, v151
v_pk_mul_f16 v148, v149, v148
v_bfe_u32 v138, v139, 2, 14
v_mfma_f32_32x32x16_bf16 v[120:135], v[100:103], v[228:231], v[120:135]
ds_read_b128 v[224:227], v245 offset:768
v_xor_b32 v243, 16, v243
ds_read_b128 v[192:195], v243 offset:128
ds_read_b128 v[196:199], v243 offset:64
ds_read_u16_d16 v136, v136
ds_read_u16_d16 v138, v138
v_exp_f16 v153, v154
v_lshrrev_b32 v137, 18, v137
v_exp_f16 v150, v151
v_lshrrev_b32 v139, 18, v139
v_exp_f16 v147, v148
v_and_b32 v141, s49, v141
v_and_b32 v143, s49, v143
s_waitcnt lgkmcnt(6)
v_mfma_f32_32x32x16_bf16 v[120:135], v[104:107], v[232:235], v[120:135]
ds_read_b128 v[228:231], v245 offset:384
ds_read_b128 v[200:203], v243
v_xor_b32 v242, 16, v242
ds_read_b128 v[204:207], v242 offset:128
ds_read_u16_d16_hi v137, v137
ds_read_u16_d16_hi v139, v139
v_exp_f16_sdwa v153, v154 dst_sel:WORD_1 dst_unused:UNUSED_PRESERVE src0_sel:WORD_1
v_bfe_u32 v140, v141, 2, 14
v_exp_f16_sdwa v150, v151 dst_sel:WORD_1 dst_unused:UNUSED_PRESERVE src0_sel:WORD_1
v_bfe_u32 v142, v143, 2, 14
v_exp_f16_sdwa v147, v148 dst_sel:WORD_1 dst_unused:UNUSED_PRESERVE src0_sel:WORD_1
v_lshrrev_b32_e64 v141, 18, v141
v_mfma_f32_32x32x16_bf16 v[120:135], v[108:111], v[236:239], v[120:135]
ds_read_b128 v[232:235], v249 offset:6144
ds_read_u16_d16 v140, v140
ds_read_u16_d16 v142, v142
ds_read_u16_d16_hi v141, v141
v_pk_add_f16 v153, v153, 1.0 op_sel_hi:[1,0]
v_lshrrev_b32_e64 v143, 18, v143
v_pk_add_f16 v150, v150, 1.0 op_sel_hi:[1,0]
v_pk_add_f16 v147, v147, 1.0 op_sel_hi:[1,0]
v_and_b32 v145, s49, v145
v_rcp_f16 v154, v153
v_bfe_u32 v144, v145, 2, 14
v_mfma_f32_32x32x16_bf16 v[120:135], v[112:115], v[216:219], v[120:135]
ds_read_b128 v[236:239], v249 offset:9216
ds_read_u16_d16_hi v143, v143
ds_read_u16_d16 v144, v144
v_rcp_f16 v151, v150
v_lshrrev_b32 v145, 18, v145
v_rcp_f16 v148, v147
v_rcp_f16_sdwa v154, v153 dst_sel:WORD_1 dst_unused:UNUSED_PRESERVE src0_sel:WORD_1
ds_read_u16_d16_hi v145, v145
s_waitcnt lgkmcnt(8)
v_fma_mix_f32 v163, v136, v136, v163 op_sel:[0,0,0] op_sel_hi:[1,1,0]
v_fma_mix_f32 v163, v137, v137, v163 op_sel:[1,1,0] op_sel_hi:[1,1,0]
v_rcp_f16_sdwa v151, v150 dst_sel:WORD_1 dst_unused:UNUSED_PRESERVE src0_sel:WORD_1
v_mfma_f32_32x32x16_bf16 v[120:135], v[116:119], v[220:223], v[120:135]
ds_read_b128 v[216:219], v249 offset:7168
v_fma_mix_f32 v163, v138, v138, v163 op_sel:[0,0,0] op_sel_hi:[1,1,0]
v_rcp_f16_sdwa v148, v147 dst_sel:WORD_1 dst_unused:UNUSED_PRESERVE src0_sel:WORD_1
v_fma_mix_f32 v163, v139, v139, v163 op_sel:[1,1,0] op_sel_hi:[1,1,0]
v_pk_mul_f16 v155, v155, v154
s_waitcnt lgkmcnt(5)
v_fma_mix_f32 v163, v140, v140, v163 op_sel:[0,0,0] op_sel_hi:[1,1,0]
v_pk_mul_f16 v152, v152, v151
v_fma_mix_f32 v163, v141, v141, v163 op_sel:[1,1,0] op_sel_hi:[1,1,0]
v_pk_mul_f16 v149, v149, v148
v_smfmac_f32_16x16x32_bf16 v[32:35], v[226:227], v[192:195], v246
ds_read_b128 v[220:223], v249 offset:10240
v_fma_mix_f32 v163, v155, v155, v163 op_sel:[0,0,0] op_sel_hi:[1,1,0]
v_fma_mix_f32 v163, v142, v142, v163 op_sel:[0,0,0] op_sel_hi:[1,1,0]
v_fma_mix_f32 v163, v155, v155, v163 op_sel:[1,1,0] op_sel_hi:[1,1,0]
s_waitcnt lgkmcnt(3)
v_fma_mix_f32 v163, v143, v143, v163 op_sel:[1,1,0] op_sel_hi:[1,1,0]
v_fma_mix_f32 v163, v152, v152, v163 op_sel:[0,0,0] op_sel_hi:[1,1,0]
v_smfmac_f32_16x16x32_bf16 v[16:19], v[224:225], v[196:199], v246
v_fma_mix_f32 v163, v152, v152, v163 op_sel:[1,1,0] op_sel_hi:[1,1,0]
v_fma_mix_f32 v163, v144, v144, v163 op_sel:[0,0,0] op_sel_hi:[1,1,0]
v_fma_mix_f32 v163, v149, v149, v163 op_sel:[0,0,0] op_sel_hi:[1,1,0]
s_waitcnt lgkmcnt(2)
v_fma_mix_f32 v163, v145, v145, v163 op_sel:[1,1,0] op_sel_hi:[1,1,0]
v_fma_mix_f32 v163, v149, v149, v163 op_sel:[1,1,0] op_sel_hi:[1,1,0]
s_setprio 1
v_smfmac_f32_16x16x32_bf16 v[0:3], v[230:231], v[200:203], v246
ds_read_b128 v[224:227], v249 offset:8192
v_cvt_pkrtz_f16_f32 v137, v120, v121
v_cvt_pkrtz_f16_f32 v139, v122, v123
v_cvt_pkrtz_f16_f32 v141, v124, v125
v_cvt_pkrtz_f16_f32 v143, v126, v127
v_smfmac_f32_16x16x32_bf16 v[32:35], v[228:229], v[204:207], v246
v_cvt_pk_f16_f32 v155, v128, v129
v_cvt_pk_f16_f32 v152, v130, v131
v_cvt_pk_f16_f32 v149, v132, v133
v_cvt_pk_f16_f32 v146, v134, v135
v_pk_fma_f16 v154, v155, v155, s48
v_mfma_f32_32x32x16_bf16 v[120:135], v[96:99], v[232:235], 0
ds_read_b128 v[228:231], v249 offset:11264
v_and_b32_e64 v137, s49, v137
v_pk_fma_f16 v151, v152, v152, s48
v_pk_fma_f16 v148, v149, v149, s48
v_and_b32_e64 v139, s49, v139
v_pk_fma_f16 v145, v146, v146, s48
v_pk_mul_f16 v154, v155, v154
v_bfe_u32 v136, v137, 2, 14
v_pk_mul_f16 v151, v152, v151
v_pk_mul_f16 v148, v149, v148
v_bfe_u32 v138, v139, 2, 14
v_mfma_f32_32x32x16_bf16 v[120:135], v[100:103], v[236:239], v[120:135]
ds_read_b128 v[232:235], v245
ds_read_b128 v[208:211], v242 offset:64
ds_read_b128 v[212:215], v242
ds_read_u16_d16 v136, v136
ds_read_u16_d16 v138, v138
v_pk_mul_f16 v145, v146, v145
v_exp_f16 v153, v154
v_lshrrev_b32 v137, 18, v137
v_exp_f16 v150, v151
v_lshrrev_b32 v139, 18, v139
v_exp_f16 v147, v148
s_waitcnt lgkmcnt(6)
v_mfma_f32_32x32x16_bf16 v[120:135], v[104:107], v[216:219], v[120:135]
ds_read_b128 v[236:239], v249 offset:12288
ds_read_u16_d16_hi v137, v137
ds_read_u16_d16_hi v139, v139
v_and_b32 v141, s49, v141
v_exp_f16 v144, v145
v_and_b32_e64 v143, s49, v143
v_exp_f16_sdwa v153, v154 dst_sel:WORD_1 dst_unused:UNUSED_PRESERVE src0_sel:WORD_1
v_bfe_u32 v140, v141, 2, 14
v_exp_f16_sdwa v150, v151 dst_sel:WORD_1 dst_unused:UNUSED_PRESERVE src0_sel:WORD_1
v_bfe_u32 v142, v143, 2, 14
v_mfma_f32_32x32x16_bf16 v[120:135], v[108:111], v[220:223], v[120:135]
ds_read_b128 v[216:219], v249 offset:15360
ds_read_u16_d16 v140, v140
ds_read_u16_d16 v142, v142
v_exp_f16_sdwa v147, v148 dst_sel:WORD_1 dst_unused:UNUSED_PRESERVE src0_sel:WORD_1
v_lshrrev_b32_e64 v141, 18, v141
v_exp_f16_sdwa v144, v145 dst_sel:WORD_1 dst_unused:UNUSED_PRESERVE src0_sel:WORD_1
v_lshrrev_b32_e64 v143, 18, v143
v_pk_add_f16 v153, v153, 1.0 op_sel_hi:[1,0]
v_pk_add_f16 v150, v150, 1.0 op_sel_hi:[1,0]
v_pk_add_f16 v147, v147, 1.0 op_sel_hi:[1,0]
v_mfma_f32_32x32x16_bf16 v[120:135], v[112:115], v[224:227], v[120:135]
ds_read_b128 v[220:223], v249 offset:13312
ds_read_u16_d16_hi v141, v141
ds_read_u16_d16_hi v143, v143
v_pk_add_f16 v144, v144, 1.0 op_sel_hi:[1,0]
v_rcp_f16 v154, v153
v_rcp_f16 v151, v150
v_rcp_f16 v148, v147
v_rcp_f16 v145, v144
s_waitcnt lgkmcnt(6)
v_mfma_f32_32x32x16_bf16 v[120:135], v[116:119], v[228:231], v[120:135]
ds_read_b128 v[224:227], v249 offset:16384
v_rcp_f16_sdwa v154, v153 dst_sel:WORD_1 dst_unused:UNUSED_PRESERVE src0_sel:WORD_1
v_rcp_f16_sdwa v151, v150 dst_sel:WORD_1 dst_unused:UNUSED_PRESERVE src0_sel:WORD_1
s_setprio 0
v_rcp_f16_sdwa v148, v147 dst_sel:WORD_1 dst_unused:UNUSED_PRESERVE src0_sel:WORD_1
v_fma_mix_f32 v164, v136, v136, v164 op_sel:[0,0,0] op_sel_hi:[1,1,0]
v_rcp_f16_sdwa v145, v144 dst_sel:WORD_1 dst_unused:UNUSED_PRESERVE src0_sel:WORD_1
v_fma_mix_f32 v164, v137, v137, v164 op_sel:[1,1,0] op_sel_hi:[1,1,0]
v_smfmac_f32_16x16x32_bf16 v[16:19], v[234:235], v[208:211], v246
ds_read_b128 v[228:231], v249 offset:14336
v_pk_mul_f16 v155, v155, v154
v_fma_mix_f32 v164, v138, v138, v164 op_sel:[0,0,0] op_sel_hi:[1,1,0]
v_pk_mul_f16 v152, v152, v151
v_pk_mul_f16 v149, v149, v148
v_fma_mix_f32 v164, v139, v139, v164 op_sel:[1,1,0] op_sel_hi:[1,1,0]
v_smfmac_f32_16x16x32_bf16 v[0:3], v[232:233], v[212:215], v246
s_mov_b64 exec, 1
ds_add_u32 v253, v254 offset:16
s_mov_b64 exec, -1
v_pk_mul_f16 v146, v146, v145
v_fma_mix_f32 v164, v155, v155, v164 op_sel:[0,0,0] op_sel_hi:[1,1,0]
s_waitcnt lgkmcnt(3)
v_fma_mix_f32 v164, v140, v140, v164 op_sel:[0,0,0] op_sel_hi:[1,1,0]
v_fma_mix_f32 v164, v155, v155, v164 op_sel:[1,1,0] op_sel_hi:[1,1,0]
v_fma_mix_f32 v164, v152, v152, v164 op_sel:[0,0,0] op_sel_hi:[1,1,0]
v_fma_mix_f32 v164, v141, v141, v164 op_sel:[1,1,0] op_sel_hi:[1,1,0]
v_fma_mix_f32 v164, v152, v152, v164 op_sel:[1,1,0] op_sel_hi:[1,1,0]
v_fma_mix_f32 v164, v149, v149, v164 op_sel:[0,0,0] op_sel_hi:[1,1,0]
v_fma_mix_f32 v164, v142, v142, v164 op_sel:[0,0,0] op_sel_hi:[1,1,0]
v_fma_mix_f32 v164, v149, v149, v164 op_sel:[1,1,0] op_sel_hi:[1,1,0]
v_fma_mix_f32 v164, v146, v146, v164 op_sel:[0,0,0] op_sel_hi:[1,1,0]
v_fma_mix_f32 v164, v143, v143, v164 op_sel:[1,1,0] op_sel_hi:[1,1,0]
v_fma_mix_f32 v164, v146, v146, v164 op_sel:[1,1,0] op_sel_hi:[1,1,0]
s_setprio 3
v_pk_add_f32 v[168:169], v[0:1], v[2:3]
v_pk_mul_f32 v[170:171], v[0:1], v[0:1]
v_pk_fma_f32 v[170:171], v[2:3], v[2:3], v[170:171]
v_pk_add_f32 v[168:169], v[168:169], v[4:5]
v_pk_fma_f32 v[170:171], v[4:5], v[4:5], v[170:171]
v_pk_add_f32 v[168:169], v[168:169], v[6:7]
v_pk_fma_f32 v[170:171], v[6:7], v[6:7], v[170:171]
v_pk_add_f32 v[168:169], v[168:169], v[8:9]
v_pk_fma_f32 v[170:171], v[8:9], v[8:9], v[170:171]
v_pk_add_f32 v[168:169], v[168:169], v[10:11]
v_pk_fma_f32 v[170:171], v[10:11], v[10:11], v[170:171]
v_pk_add_f32 v[168:169], v[168:169], v[12:13]
v_pk_fma_f32 v[170:171], v[12:13], v[12:13], v[170:171]
v_pk_add_f32 v[168:169], v[168:169], v[14:15]
v_pk_fma_f32 v[170:171], v[14:15], v[14:15], v[170:171]
v_pk_add_f32 v[168:169], v[168:169], v[16:17]
v_pk_fma_f32 v[170:171], v[16:17], v[16:17], v[170:171]
v_pk_add_f32 v[168:169], v[168:169], v[18:19]
v_pk_fma_f32 v[170:171], v[18:19], v[18:19], v[170:171]
v_pk_add_f32 v[168:169], v[168:169], v[20:21]
v_pk_fma_f32 v[170:171], v[20:21], v[20:21], v[170:171]
v_pk_add_f32 v[168:169], v[168:169], v[22:23]
v_pk_fma_f32 v[170:171], v[22:23], v[22:23], v[170:171]
v_pk_add_f32 v[168:169], v[168:169], v[24:25]
v_pk_fma_f32 v[170:171], v[24:25], v[24:25], v[170:171]
v_pk_add_f32 v[168:169], v[168:169], v[26:27]
v_pk_fma_f32 v[170:171], v[26:27], v[26:27], v[170:171]
v_pk_add_f32 v[168:169], v[168:169], v[28:29]
v_pk_fma_f32 v[170:171], v[28:29], v[28:29], v[170:171]
v_pk_add_f32 v[168:169], v[168:169], v[30:31]
v_pk_fma_f32 v[170:171], v[30:31], v[30:31], v[170:171]
v_pk_add_f32 v[168:169], v[168:169], v[32:33]
v_pk_fma_f32 v[170:171], v[32:33], v[32:33], v[170:171]
v_pk_add_f32 v[168:169], v[168:169], v[34:35]
v_pk_fma_f32 v[170:171], v[34:35], v[34:35], v[170:171]
v_pk_add_f32 v[168:169], v[168:169], v[36:37]
v_pk_fma_f32 v[170:171], v[36:37], v[36:37], v[170:171]
v_pk_add_f32 v[168:169], v[168:169], v[38:39]
v_pk_fma_f32 v[170:171], v[38:39], v[38:39], v[170:171]
v_pk_add_f32 v[168:169], v[168:169], v[40:41]
v_pk_fma_f32 v[170:171], v[40:41], v[40:41], v[170:171]
v_pk_add_f32 v[168:169], v[168:169], v[42:43]
v_pk_fma_f32 v[170:171], v[42:43], v[42:43], v[170:171]
v_pk_add_f32 v[168:169], v[168:169], v[44:45]
v_pk_fma_f32 v[170:171], v[44:45], v[44:45], v[170:171]
v_pk_add_f32 v[168:169], v[168:169], v[46:47]
v_pk_fma_f32 v[170:171], v[46:47], v[46:47], v[170:171]
s_setprio 0
v_lshrrev_b32 v252, 2, v251
v_mul_u32_u24 v252, 192, v252
v_and_b32 v240, 3, v251
v_lshl_add_u32 v252, v240, 4, v252
s_setprio 2
v_cvt_pkrtz_f16_f32 v137, v120, v121
v_cvt_pkrtz_f16_f32 v139, v122, v123
v_cvt_pkrtz_f16_f32 v141, v124, v125
v_cvt_pkrtz_f16_f32 v143, v126, v127
v_cvt_pkrtz_f16_f32 v145, v128, v129
v_cvt_pk_f16_f32 v155, v130, v131
v_cvt_pk_f16_f32 v152, v132, v133
v_cvt_pk_f16_f32 v149, v134, v135
ds_read_b128 v[232:235], v249 offset:17408
v_mfma_f32_32x32x16_bf16 v[120:135], v[236:239], v[96:99], 0
v_pk_fma_f16 v154, v155, v155, s48
v_add_f32 v168, v168, v169
v_and_b32 v137, s49, v137
v_pk_fma_f16 v151, v152, v152, s48
v_and_b32_e64 v139, s49, v139
v_pk_fma_f16 v148, v149, v149, s48
v_add_f32_e64 v170, v170, v171
v_pk_mul_f16 v154, v155, v154
v_bfe_u32 v136, v137, 2, 14
v_pk_mul_f16 v151, v152, v151
v_pk_mul_f16 v148, v149, v148
v_bfe_u32 v138, v139, 2, 14
ds_read_u16_d16 v136, v136
ds_read_u16_d16 v138, v138
v_mfma_f32_32x32x16_bf16 v[120:135], v[216:219], v[100:103], v[120:135]
v_permlane32_swap_b32 v168, v170
v_exp_f16 v153, v154
v_lshrrev_b32 v137, 18, v137
v_exp_f16 v150, v151
v_add_f32 v168, v168, v170
v_lshrrev_b32 v139, 18, v139
v_exp_f16 v147, v148
v_and_b32 v141, s49, v141
v_and_b32_e64 v143, s49, v143
v_mul_f32 v168, 1009429163, v168
ds_read_u16_d16_hi v137, v137
ds_read_u16_d16_hi v139, v139
v_mfma_f32_32x32x16_bf16 v[120:135], v[220:223], v[104:107], v[120:135]
v_exp_f16_sdwa v153, v154 dst_sel:WORD_1 dst_unused:UNUSED_PRESERVE src0_sel:WORD_1
v_bfe_u32 v140, v141, 2, 14
v_exp_f16_sdwa v150, v151 dst_sel:WORD_1 dst_unused:UNUSED_PRESERVE src0_sel:WORD_1
v_mov_b32_e64 v170, v168
v_bfe_u32 v142, v143, 2, 14
v_exp_f16_sdwa v147, v148 dst_sel:WORD_1 dst_unused:UNUSED_PRESERVE src0_sel:WORD_1
v_lshrrev_b32_e64 v141, 18, v141
v_permlane32_swap_b32 v168, v170
v_pk_add_f16 v153, v153, 1.0 op_sel_hi:[1,0]
s_waitcnt lgkmcnt(6)
ds_read_u16_d16 v140, v140
ds_read_u16_d16 v142, v142
ds_read_u16_d16_hi v141, v141
v_mfma_f32_32x32x16_bf16 v[120:135], v[224:227], v[108:111], v[120:135]
v_lshrrev_b32_e64 v143, 18, v143
v_pk_add_f16 v150, v150, 1.0 op_sel_hi:[1,0]
v_pk_add_f16 v147, v147, 1.0 op_sel_hi:[1,0]
v_and_b32_e64 v145, s49, v145
v_fma_f32 v170, -v168, v168, v170
v_rcp_f16_e64 v154, v153
v_bfe_u32 v144, v145, 2, 14
v_rcp_f16 v151, v150
v_max_f32 v170, 0, v170
v_lshrrev_b32_e64 v145, 18, v145
ds_read_b128 v[224:227], v249 offset:18432
ds_read_u16_d16_hi v143, v143
ds_read_u16_d16 v144, v144
ds_read_u16_d16_hi v145, v145
v_mfma_f32_32x32x16_bf16 v[120:135], v[228:231], v[112:115], v[120:135]
v_rcp_f16 v148, v147
v_rcp_f16_sdwa v154, v153 dst_sel:WORD_1 dst_unused:UNUSED_PRESERVE src0_sel:WORD_1
v_add_f32 v170, 925353388, v170
s_waitcnt lgkmcnt(7)
v_fma_mix_f32 v165, v136, v136, v165 op_sel:[0,0,0] op_sel_hi:[1,1,0]
ds_read_b32 v247, v253 offset:16
v_fma_mix_f32 v165, v137, v137, v165 op_sel:[1,1,0] op_sel_hi:[1,1,0]
v_rcp_f16_sdwa v151, v150 dst_sel:WORD_1 dst_unused:UNUSED_PRESERVE src0_sel:WORD_1
v_rsq_f32_e64 v170, v170
v_fma_mix_f32 v165, v138, v138, v165 op_sel:[0,0,0] op_sel_hi:[1,1,0]
ds_read_b128 v[228:231], v249 offset:21504
v_mfma_f32_32x32x16_bf16 v[120:135], v[232:235], v[116:119], v[120:135]
v_rcp_f16_sdwa v148, v147 dst_sel:WORD_1 dst_unused:UNUSED_PRESERVE src0_sel:WORD_1
v_fma_mix_f32 v165, v139, v139, v165 op_sel:[1,1,0] op_sel_hi:[1,1,0]
v_pk_mul_f16 v155, v155, v154
s_waitcnt lgkmcnt(6)
v_fma_mix_f32 v165, v140, v140, v165 op_sel:[0,0,0] op_sel_hi:[1,1,0]
v_pk_mul_f16 v152, v152, v151
v_fma_mix_f32 v165, v141, v141, v165 op_sel:[1,1,0] op_sel_hi:[1,1,0]
v_pk_mul_f16 v149, v149, v148
v_fma_mix_f32 v165, v155, v155, v165 op_sel:[0,0,0] op_sel_hi:[1,1,0]
v_mul_f32 v172, 3203391086, v170
v_fma_mix_f32 v165, v142, v142, v165 op_sel:[0,0,0] op_sel_hi:[1,1,0]
v_fma_mix_f32 v165, v155, v155, v165 op_sel:[1,1,0] op_sel_hi:[1,1,0]
s_waitcnt lgkmcnt(2)
v_fma_mix_f32 v165, v143, v143, v165 op_sel:[1,1,0] op_sel_hi:[1,1,0]
v_fma_mix_f32 v165, v152, v152, v165 op_sel:[0,0,0] op_sel_hi:[1,1,0]
v_fma_mix_f32 v165, v152, v152, v165 op_sel:[1,1,0] op_sel_hi:[1,1,0]
v_mul_f32 v173, v168, v172
v_fma_mix_f32 v165, v144, v144, v165 op_sel:[0,0,0] op_sel_hi:[1,1,0]
v_fma_mix_f32 v165, v149, v149, v165 op_sel:[0,0,0] op_sel_hi:[1,1,0]
v_fma_mix_f32 v165, v145, v145, v165 op_sel:[1,1,0] op_sel_hi:[1,1,0]
v_fma_mix_f32 v165, v149, v149, v165 op_sel:[1,1,0] op_sel_hi:[1,1,0]
s_setprio 3
v_pk_fma_f32 v[0:1], v[0:1], v[172:173], v[172:173] op_sel:[0,0,1] op_sel_hi:[1,0,1] neg_lo:[0,0,1] neg_hi:[0,0,1]
v_pk_fma_f32 v[2:3], v[2:3], v[172:173], v[172:173] op_sel:[0,0,1] op_sel_hi:[1,0,1] neg_lo:[0,0,1] neg_hi:[0,0,1]
v_pk_fma_f32 v[4:5], v[4:5], v[172:173], v[172:173] op_sel:[0,0,1] op_sel_hi:[1,0,1] neg_lo:[0,0,1] neg_hi:[0,0,1]
v_pk_fma_f32 v[6:7], v[6:7], v[172:173], v[172:173] op_sel:[0,0,1] op_sel_hi:[1,0,1] neg_lo:[0,0,1] neg_hi:[0,0,1]
v_pk_fma_f32 v[8:9], v[8:9], v[172:173], v[172:173] op_sel:[0,0,1] op_sel_hi:[1,0,1] neg_lo:[0,0,1] neg_hi:[0,0,1]
v_pk_fma_f32 v[10:11], v[10:11], v[172:173], v[172:173] op_sel:[0,0,1] op_sel_hi:[1,0,1] neg_lo:[0,0,1] neg_hi:[0,0,1]
v_pk_fma_f32 v[12:13], v[12:13], v[172:173], v[172:173] op_sel:[0,0,1] op_sel_hi:[1,0,1] neg_lo:[0,0,1] neg_hi:[0,0,1]
v_pk_fma_f32 v[14:15], v[14:15], v[172:173], v[172:173] op_sel:[0,0,1] op_sel_hi:[1,0,1] neg_lo:[0,0,1] neg_hi:[0,0,1]
v_pk_fma_f32 v[16:17], v[16:17], v[172:173], v[172:173] op_sel:[0,0,1] op_sel_hi:[1,0,1] neg_lo:[0,0,1] neg_hi:[0,0,1]
v_pk_fma_f32 v[18:19], v[18:19], v[172:173], v[172:173] op_sel:[0,0,1] op_sel_hi:[1,0,1] neg_lo:[0,0,1] neg_hi:[0,0,1]
v_pk_fma_f32 v[20:21], v[20:21], v[172:173], v[172:173] op_sel:[0,0,1] op_sel_hi:[1,0,1] neg_lo:[0,0,1] neg_hi:[0,0,1]
v_pk_fma_f32 v[22:23], v[22:23], v[172:173], v[172:173] op_sel:[0,0,1] op_sel_hi:[1,0,1] neg_lo:[0,0,1] neg_hi:[0,0,1]
v_pk_fma_f32 v[24:25], v[24:25], v[172:173], v[172:173] op_sel:[0,0,1] op_sel_hi:[1,0,1] neg_lo:[0,0,1] neg_hi:[0,0,1]
v_pk_fma_f32 v[26:27], v[26:27], v[172:173], v[172:173] op_sel:[0,0,1] op_sel_hi:[1,0,1] neg_lo:[0,0,1] neg_hi:[0,0,1]
v_pk_fma_f32 v[28:29], v[28:29], v[172:173], v[172:173] op_sel:[0,0,1] op_sel_hi:[1,0,1] neg_lo:[0,0,1] neg_hi:[0,0,1]
v_pk_fma_f32 v[30:31], v[30:31], v[172:173], v[172:173] op_sel:[0,0,1] op_sel_hi:[1,0,1] neg_lo:[0,0,1] neg_hi:[0,0,1]
v_pk_fma_f32 v[32:33], v[32:33], v[172:173], v[172:173] op_sel:[0,0,1] op_sel_hi:[1,0,1] neg_lo:[0,0,1] neg_hi:[0,0,1]
v_pk_fma_f32 v[34:35], v[34:35], v[172:173], v[172:173] op_sel:[0,0,1] op_sel_hi:[1,0,1] neg_lo:[0,0,1] neg_hi:[0,0,1]
v_pk_fma_f32 v[36:37], v[36:37], v[172:173], v[172:173] op_sel:[0,0,1] op_sel_hi:[1,0,1] neg_lo:[0,0,1] neg_hi:[0,0,1]
v_pk_fma_f32 v[38:39], v[38:39], v[172:173], v[172:173] op_sel:[0,0,1] op_sel_hi:[1,0,1] neg_lo:[0,0,1] neg_hi:[0,0,1]
v_pk_fma_f32 v[40:41], v[40:41], v[172:173], v[172:173] op_sel:[0,0,1] op_sel_hi:[1,0,1] neg_lo:[0,0,1] neg_hi:[0,0,1]
v_pk_fma_f32 v[42:43], v[42:43], v[172:173], v[172:173] op_sel:[0,0,1] op_sel_hi:[1,0,1] neg_lo:[0,0,1] neg_hi:[0,0,1]
v_pk_fma_f32 v[44:45], v[44:45], v[172:173], v[172:173] op_sel:[0,0,1] op_sel_hi:[1,0,1] neg_lo:[0,0,1] neg_hi:[0,0,1]
v_pk_fma_f32 v[46:47], v[46:47], v[172:173], v[172:173] op_sel:[0,0,1] op_sel_hi:[1,0,1] neg_lo:[0,0,1] neg_hi:[0,0,1]
s_setprio 2
s_cmp_lg_u32 s40, 0
s_cbranch_scc1 Lrs1
v_mov_b32 v90, 0
Lpi:
s_waitcnt vmcnt(0)
v_readfirstlane_b32 s43, v91
s_cmp_eq_u32 s76, 0
s_cbranch_scc1 Lpix
s_sub_u32 s76, s76, 1
s_cmp_ge_u32 s43, 256
s_cbranch_scc1 Lpix
buffer_load_dword v91, v90, s[36:39], 0 offen sc1
s_branch Lpi
Lpix:
v_min_u32 v88, 47, v251
v_lshlrev_b32_e64 v88, 3, v88
s_and_b32 s44, s2, 7
s_lshl_b32 s44, s44, 11
s_add_u32 s44, s44, 394752
buffer_load_dwordx2 v[92:93], v88, s[32:35], s44 offen sc1
Lrs1:
s_waitcnt lgkmcnt(0)
v_readfirstlane_b32 s43, v247
s_nop 1
s_cmp_ge_u32 s43, 32
s_cbranch_scc1 Lev8
Lev8w:
s_sleep 1
ds_read_b32 v247, v253 offset:16
s_waitcnt lgkmcnt(0)
v_readfirstlane_b32 s43, v247
s_cmp_eq_u32 s76, 0
s_cbranch_scc1 Lev8
s_sub_u32 s76, s76, 1
s_cmp_lt_u32 s43, 32
s_cbranch_scc1 Lev8w
Lev8:
s_setprio 1
v_cvt_pkrtz_f16_f32 v137, v120, v121
v_cvt_pkrtz_f16_f32 v139, v122, v123
v_cvt_pkrtz_f16_f32 v141, v124, v125
v_cvt_pkrtz_f16_f32 v143, v126, v127
v_cvt_pkrtz_f16_f32 v145, v128, v129
v_cvt_pk_f16_f32 v155, v130, v131
v_cvt_pk_f16_f32 v152, v132, v133
v_cvt_pk_f16_f32 v149, v134, v135
s_add_u32 m0, s72, 0
s_add_u32 s43, s82, 0
buffer_load_dwordx4 v252, s[16:19], s43 offen lds
ds_read_b128 v[232:235], v249 offset:19456
ds_read_b128 v[236:239], v249 offset:22528
v_mfma_f32_32x32x16_bf16 v[120:135], v[224:227], v[96:99], 0
v_pk_fma_f16 v154, v155, v155, s48
v_and_b32_e64 v192, 1, v251
v_cvt_pk_bf16_f32 v168, v0, v1
v_and_b32_e64 v137, s49, v137
v_pk_fma_f16 v151, v152, v152, s48
v_cvt_pk_bf16_f32 v169, v2, v3
v_lshlrev_b32 v192, 4, v192
v_and_b32 v139, s49, v139
v_pk_fma_f16 v148, v149, v149, s48
v_cvt_pk_bf16_f32 v170, v4, v5
v_pk_mul_f16 v154, v155, v154
v_mov_b32 v193, 15360
v_bfe_u32 v136, v137, 2, 14
v_pk_mul_f16 v151, v152, v151
v_cvt_pk_bf16_f32 v171, v6, v7
ds_read_b128 v[224:227], v249 offset:20480
ds_read_u16_d16 v136, v136
v_mfma_f32_32x32x16_bf16 v[120:135], v[228:231], v[100:103], v[120:135]
v_pk_mul_f16 v148, v149, v148
v_lshlrev_b32_e64 v192, v192, v193
v_bfe_u32 v138, v139, 2, 14
v_cvt_pk_bf16_f32 v172, v8, v9
v_exp_f16 v153, v154
v_lshrrev_b32 v193, 3, v251
v_cvt_pk_bf16_f32 v173, v10, v11
v_lshrrev_b32_e64 v137, 18, v137
v_exp_f16 v150, v151
v_xor_b32 v193, v193, v251
v_cvt_pk_bf16_f32 v174, v12, v13
v_lshrrev_b32 v139, 18, v139
v_exp_f16 v147, v148
s_waitcnt lgkmcnt(2)
s_add_u32 m0, s72, 1024
s_add_u32 s43, s82, 64
buffer_load_dwordx4 v252, s[16:19], s43 offen lds
ds_read_b128 v[228:231], v249 offset:23552
ds_read_u16_d16 v138, v138
ds_read_u16_d16_hi v137, v137
ds_read_u16_d16_hi v139, v139
v_mfma_f32_32x32x16_bf16 v[120:135], v[232:235], v[104:107], v[120:135]
v_and_b32_e64 v193, 4, v193
v_cvt_pk_bf16_f32 v175, v14, v15
v_and_b32_e64 v141, s49, v141
v_cvt_pk_bf16_f32 v176, v16, v17
v_and_b32_e64 v143, s49, v143
v_bfe_u32 v194, v251, 3, 2
v_exp_f16_sdwa v153, v154 dst_sel:WORD_1 dst_unused:UNUSED_PRESERVE src0_sel:WORD_1
v_cvt_pk_bf16_f32 v177, v18, v19
v_bfe_u32 v140, v141, 2, 14
v_lshl_add_u32 v193, v193, 1, 0
v_exp_f16_sdwa v150, v151 dst_sel:WORD_1 dst_unused:UNUSED_PRESERVE src0_sel:WORD_1
v_cvt_pk_bf16_f32 v178, v20, v21
v_bfe_u32 v142, v143, 2, 14
ds_read_b128 v[232:235], v248 offset:16384
ds_read_u16_d16 v140, v140
ds_read_u16_d16 v142, v142
v_mfma_f32_32x32x16_bf16 v[120:135], v[236:239], v[108:111], v[120:135]
v_lshl_add_u32 v193, v194, 1, v193
v_cvt_pk_bf16_f32 v179, v22, v23
v_exp_f16_sdwa v147, v148 dst_sel:WORD_1 dst_unused:UNUSED_PRESERVE src0_sel:WORD_1
v_lshrrev_b32_e64 v141, 18, v141
v_bfe_u32 v194, v251, 1, 1
v_cvt_pk_bf16_f32 v180, v24, v25
v_pk_add_f16 v153, v153, 1.0 op_sel_hi:[1,0]
v_lshrrev_b32_e64 v143, 18, v143
v_cvt_pk_bf16_f32 v181, v26, v27
v_add_u32_e64 v193, v193, v194
v_pk_add_f16 v150, v150, 1.0 op_sel_hi:[1,0]
v_pk_add_f16 v147, v147, 1.0 op_sel_hi:[1,0]
v_cvt_pk_bf16_f32 v182, v28, v29
v_and_b32_e64 v145, s49, v145
v_cmp_eq_u32 vcc, 0, v193
s_nop 1
v_cndmask_b32 v240, 0, v192, vcc
s_waitcnt lgkmcnt(3)
s_add_u32 m0, s72, 2048
s_add_u32 s43, s82, 128
buffer_load_dwordx4 v252, s[16:19], s43 offen lds
ds_read_b128 v[236:239], v248 offset:19456
ds_read_u16_d16_hi v141, v141
ds_read_u16_d16_hi v143, v143
v_mfma_f32_32x32x16_bf16 v[120:135], v[224:227], v[112:115], v[120:135]
v_rcp_f16_e64 v154, v153
v_cvt_pk_bf16_f32 v183, v30, v31
v_bfe_u32 v144, v145, 2, 14
v_cmp_eq_u32 vcc, 1, v193
s_nop 1
v_cndmask_b32 v241, 0, v192, vcc
v_rcp_f16_e64 v151, v150
s_setprio 0
v_cvt_pk_bf16_f32 v184, v32, v33
v_lshrrev_b32 v145, 18, v145
v_cmp_eq_u32 vcc, 2, v193
s_nop 1
v_cndmask_b32 v242, 0, v192, vcc
v_cvt_pk_bf16_f32 v185, v34, v35
v_rcp_f16_e64 v148, v147
ds_read_u16_d16 v144, v144
ds_read_u16_d16_hi v145, v145
v_or_b32 v208, v136, v137
v_cmp_eq_u32 vcc, 3, v193
s_nop 1
v_cndmask_b32 v243, 0, v192, vcc
v_cvt_pk_bf16_f32 v186, v36, v37
ds_read_b128 v[224:227], v248 offset:17408
v_mfma_f32_32x32x16_bf16 v[120:135], v[228:231], v[116:119], v[120:135]
v_or_b32 v209, v138, v139
v_rcp_f16_sdwa v154, v153 dst_sel:WORD_1 dst_unused:UNUSED_PRESERVE src0_sel:WORD_1
v_cmp_eq_u32 vcc, 4, v193
s_nop 1
v_cndmask_b32 v244, 0, v192, vcc
v_cvt_pk_bf16_f32 v187, v38, v39
s_waitcnt lgkmcnt(3)
v_or_b32 v210, v140, v141
v_cvt_pk_bf16_f32 v188, v40, v41
v_rcp_f16_sdwa v151, v150 dst_sel:WORD_1 dst_unused:UNUSED_PRESERVE src0_sel:WORD_1
v_cmp_eq_u32 vcc, 5, v193
s_nop 1
v_cndmask_b32 v245, 0, v192, vcc
v_or_b32 v211, v142, v143
v_cvt_pk_bf16_f32 v189, v42, v43
v_rcp_f16_sdwa v148, v147 dst_sel:WORD_1 dst_unused:UNUSED_PRESERVE src0_sel:WORD_1
v_cmp_eq_u32 vcc, 6, v193
s_nop 1
v_cndmask_b32 v246, 0, v192, vcc
v_cvt_pk_bf16_f32 v190, v44, v45
s_waitcnt lgkmcnt(0)
v_or_b32_e64 v212, v144, v145
v_pk_mul_f16 v213, v155, v154
v_cmp_eq_u32 vcc, 7, v193
s_nop 1
v_cndmask_b32 v247, 0, v192, vcc
v_cvt_pk_bf16_f32 v191, v46, v47
v_pk_mul_f16 v214, v152, v151
v_pk_mul_f16 v215, v149, v148
s_setprio 2
s_add_u32 m0, s72, 3072
s_add_u32 s43, s82, 3072
buffer_load_dwordx4 v252, s[16:19], s43 offen lds
ds_read_b128 v[228:231], v248 offset:20480
v_mfma_f32_32x32x16_f16 v[192:207], v[208:211], v[240:243], 0
v_cvt_pkrtz_f16_f32 v137, v120, v121
v_cvt_pkrtz_f16_f32 v139, v122, v123
v_cvt_pkrtz_f16_f32 v141, v124, v125
v_cvt_pkrtz_f16_f32 v143, v126, v127
v_cvt_pkrtz_f16_f32 v145, v128, v129
v_mfma_f32_32x32x16_f16 v[192:207], v[212:215], v[244:247], v[192:207]
v_cvt_pk_f16_f32 v155, v130, v131
v_cvt_pk_f16_f32 v152, v132, v133
v_cvt_pk_f16_f32 v149, v134, v135
v_pk_fma_f16 v154, v155, v155, s48
v_and_b32_e64 v137, s49, v137
v_mfma_f32_32x32x16_bf16 v[120:135], v[232:235], v[168:171], 0
v_pk_fma_f16 v151, v152, v152, s48
v_and_b32_e64 v139, s49, v139
v_pk_fma_f16 v148, v149, v149, s48
v_pk_mul_f16 v154, v155, v154
v_bfe_u32 v136, v137, 2, 14
v_pk_mul_f16 v151, v152, v151
v_pk_mul_f16 v148, v149, v148
v_bfe_u32 v138, v139, 2, 14
v_fmac_f32 v166, v192, v192
v_exp_f16 v153, v154
s_add_u32 m0, s72, 4096
s_add_u32 s43, s82, 3136
buffer_load_dwordx4 v252, s[16:19], s43 offen lds
ds_read_b128 v[232:235], v248 offset:18432
ds_read_u16_d16 v136, v136
ds_read_u16_d16 v138, v138
v_mfma_f32_32x32x16_bf16 v[120:135], v[236:239], v[172:175], v[120:135]
v_fmac_f32 v166, v193, v193
v_lshrrev_b32 v137, 18, v137
v_exp_f16 v150, v151
v_fmac_f32 v166, v194, v194
v_lshrrev_b32 v139, 18, v139
v_exp_f16 v147, v148
v_fmac_f32 v166, v195, v195
v_and_b32 v141, s49, v141
ds_read_b128 v[236:239], v248 offset:21504
ds_read_u16_d16_hi v137, v137
ds_read_u16_d16_hi v139, v139
v_mfma_f32_32x32x16_bf16 v[120:135], v[224:227], v[176:179], v[120:135]
v_and_b32_e64 v143, s49, v143
v_exp_f16_sdwa v153, v154 dst_sel:WORD_1 dst_unused:UNUSED_PRESERVE src0_sel:WORD_1
v_fmac_f32_e64 v166, v196, v196
v_bfe_u32 v140, v141, 2, 14
v_exp_f16_sdwa v150, v151 dst_sel:WORD_1 dst_unused:UNUSED_PRESERVE src0_sel:WORD_1
v_fmac_f32 v166, v197, v197
v_bfe_u32 v142, v143, 2, 14
v_exp_f16_sdwa v147, v148 dst_sel:WORD_1 dst_unused:UNUSED_PRESERVE src0_sel:WORD_1
s_waitcnt lgkmcnt(6)
ds_read_b128 v[224:227], v248 offset:22528
ds_read_u16_d16 v140, v140
ds_read_u16_d16 v142, v142
v_mfma_f32_32x32x16_bf16 v[120:135], v[228:231], v[180:183], v[120:135]
v_fmac_f32 v166, v198, v198
v_lshrrev_b32 v141, 18, v141
v_pk_add_f16 v153, v153, 1.0 op_sel_hi:[1,0]
v_fmac_f32 v166, v199, v199
v_lshrrev_b32 v143, 18, v143
v_pk_add_f16 v150, v150, 1.0 op_sel_hi:[1,0]
v_pk_add_f16 v147, v147, 1.0 op_sel_hi:[1,0]
v_fmac_f32_e64 v166, v200, v200
v_and_b32 v145, s49, v145
s_waitcnt lgkmcnt(4)
s_add_u32 m0, s72, 5120
s_add_u32 s43, s82, 3200
buffer_load_dwordx4 v252, s[16:19], s43 offen lds
ds_read_b128 v[228:231], v248 offset:25600
ds_read_u16_d16_hi v141, v141
ds_read_u16_d16_hi v143, v143
v_mfma_f32_32x32x16_bf16 v[120:135], v[232:235], v[184:187], v[120:135]
v_rcp_f16 v154, v153
v_fmac_f32 v166, v201, v201
v_bfe_u32 v144, v145, 2, 14
v_rcp_f16 v151, v150
v_fmac_f32 v166, v202, v202
v_lshrrev_b32 v145, 18, v145
v_rcp_f16 v148, v147
v_fmac_f32_e64 v166, v203, v203
ds_read_u16_d16 v144, v144
ds_read_u16_d16_hi v145, v145
v_or_b32_e64 v216, v136, v137
ds_read_b128 v[232:235], v248 offset:23552
v_mfma_f32_32x32x16_bf16 v[120:135], v[236:239], v[188:191], v[120:135]
s_waitcnt lgkmcnt(6)
v_or_b32 v217, v138, v139
v_rcp_f16_sdwa v154, v153 dst_sel:WORD_1 dst_unused:UNUSED_PRESERVE src0_sel:WORD_1
v_fmac_f32 v166, v204, v204
s_waitcnt lgkmcnt(4)
v_or_b32_e64 v218, v140, v141
v_rcp_f16_sdwa v151, v150 dst_sel:WORD_1 dst_unused:UNUSED_PRESERVE src0_sel:WORD_1
v_fmac_f32 v166, v205, v205
s_waitcnt lgkmcnt(3)
v_or_b32_e64 v219, v142, v143
v_rcp_f16_sdwa v148, v147 dst_sel:WORD_1 dst_unused:UNUSED_PRESERVE src0_sel:WORD_1
v_fmac_f32 v166, v206, v206
s_waitcnt lgkmcnt(1)
v_or_b32_e64 v220, v144, v145
v_pk_mul_f16 v221, v155, v154
v_fmac_f32 v166, v207, v207
v_pk_mul_f16 v222, v152, v151
v_pk_mul_f16 v223, v149, v148
s_setprio 1
s_add_u32 m0, s72, 6144
s_add_u32 s43, s82, 6144
buffer_load_dwordx4 v252, s[16:19], s43 offen lds
ds_read_b128 v[236:239], v248 offset:26624
v_mfma_f32_32x32x16_f16 v[192:207], v[216:219], v[240:243], 0
v_cvt_pkrtz_f16_f32 v137, v120, v121
v_cvt_pkrtz_f16_f32 v139, v122, v123
v_cvt_pkrtz_f16_f32 v141, v124, v125
v_cvt_pkrtz_f16_f32 v143, v126, v127
v_cvt_pkrtz_f16_f32 v145, v128, v129
v_mfma_f32_32x32x16_f16 v[192:207], v[220:223], v[244:247], v[192:207]
v_cvt_pk_f16_f32 v155, v130, v131
v_cvt_pk_f16_f32 v152, v132, v133
v_cvt_pk_f16_f32 v149, v134, v135
v_pk_fma_f16 v154, v155, v155, s48
v_and_b32 v255, 51, v251
v_and_b32 v137, s49, v137
v_mfma_f32_32x32x16_bf16 v[120:135], v[224:227], v[168:171], 0
v_pk_fma_f16 v151, v152, v152, s48
v_and_b32_e64 v139, s49, v139
v_pk_fma_f16 v148, v149, v149, s48
v_pk_mul_f16 v154, v155, v154
v_bfe_u32 v136, v137, 2, 14
v_pk_mul_f16 v151, v152, v151
v_pk_mul_f16 v148, v149, v148
v_bfe_u32 v138, v139, 2, 14
v_fmac_f32 v167, v192, v192
v_exp_f16 v153, v154
ds_read_b128 v[224:227], v248 offset:24576
ds_read_u16_d16 v136, v136
ds_read_u16_d16 v138, v138
v_mfma_f32_32x32x16_bf16 v[120:135], v[228:231], v[172:175], v[120:135]
v_bfe_u32 v95, v251, 2, 1
v_fmac_f32 v167, v193, v193
v_lshrrev_b32 v137, 18, v137
v_exp_f16 v150, v151
v_fmac_f32 v167, v194, v194
v_lshrrev_b32 v139, 18, v139
v_exp_f16 v147, v148
v_fmac_f32 v167, v195, v195
v_and_b32 v141, s49, v141
v_and_b32 v143, s49, v143
s_waitcnt lgkmcnt(3)
ds_read_b128 v[228:231], v248 offset:27648
ds_read_u16_d16_hi v137, v137
ds_read_u16_d16_hi v139, v139
v_mfma_f32_32x32x16_bf16 v[120:135], v[232:235], v[176:179], v[120:135]
v_exp_f16_sdwa v153, v154 dst_sel:WORD_1 dst_unused:UNUSED_PRESERVE src0_sel:WORD_1
v_lshl_add_u32 v255, v95, 3, v255
v_fmac_f32_e64 v167, v196, v196
v_bfe_u32 v140, v141, 2, 14
v_exp_f16_sdwa v150, v151 dst_sel:WORD_1 dst_unused:UNUSED_PRESERVE src0_sel:WORD_1
v_fmac_f32_e64 v167, v197, v197
v_bfe_u32 v142, v143, 2, 14
v_exp_f16_sdwa v147, v148 dst_sel:WORD_1 dst_unused:UNUSED_PRESERVE src0_sel:WORD_1
ds_read_b128 v[232:235], v248 offset:28672
ds_read_u16_d16 v140, v140
ds_read_u16_d16 v142, v142
v_mfma_f32_32x32x16_bf16 v[120:135], v[236:239], v[180:183], v[120:135]
v_fmac_f32 v167, v198, v198
v_lshrrev_b32 v141, 18, v141
v_pk_add_f16 v153, v153, 1.0 op_sel_hi:[1,0]
v_bfe_u32 v95, v251, 3, 1
v_fmac_f32 v167, v199, v199
v_lshrrev_b32 v143, 18, v143
v_pk_add_f16 v150, v150, 1.0 op_sel_hi:[1,0]
v_pk_add_f16 v147, v147, 1.0 op_sel_hi:[1,0]
v_fmac_f32 v167, v200, v200
v_and_b32 v145, s49, v145
v_rcp_f16 v154, v153
s_waitcnt lgkmcnt(3)
ds_read_b128 v[236:239], v248 offset:31744
ds_read_u16_d16_hi v141, v141
ds_read_u16_d16_hi v143, v143
v_mfma_f32_32x32x16_bf16 v[120:135], v[224:227], v[184:187], v[120:135]
v_fmac_f32_e64 v167, v201, v201
v_bfe_u32 v144, v145, 2, 14
v_rcp_f16 v151, v150
s_setprio 0
v_lshl_add_u32 v255, v95, 2, v255
v_fmac_f32 v167, v202, v202
v_lshrrev_b32 v145, 18, v145
v_rcp_f16 v148, v147
v_fmac_f32 v167, v203, v203
ds_read_u16_d16 v144, v144
ds_read_u16_d16_hi v145, v145
v_or_b32_e64 v0, v136, v137
ds_read_b128 v[224:227], v248 offset:29696
v_mfma_f32_32x32x16_bf16 v[120:135], v[228:231], v[188:191], v[120:135]
v_or_b32_e64 v1, v138, v139
v_rcp_f16_sdwa v154, v153 dst_sel:WORD_1 dst_unused:UNUSED_PRESERVE src0_sel:WORD_1
v_fmac_f32 v167, v204, v204
s_waitcnt lgkmcnt(4)
v_or_b32_e64 v2, v140, v141
v_rcp_f16_sdwa v151, v150 dst_sel:WORD_1 dst_unused:UNUSED_PRESERVE src0_sel:WORD_1
v_lshl_add_u32 v255, v255, 2, s72
v_fmac_f32 v167, v205, v205
s_waitcnt lgkmcnt(3)
v_or_b32_e64 v3, v142, v143
v_rcp_f16_sdwa v148, v147 dst_sel:WORD_1 dst_unused:UNUSED_PRESERVE src0_sel:WORD_1
v_fmac_f32 v167, v206, v206
s_waitcnt lgkmcnt(1)
v_or_b32_e64 v4, v144, v145
v_pk_mul_f16 v5, v155, v154
v_fmac_f32 v167, v207, v207
v_pk_mul_f16 v6, v152, v151
v_pk_mul_f16 v7, v149, v148
s_setprio 2
ds_read_b128 v[228:231], v248 offset:32768
v_mfma_f32_32x32x16_f16 v[192:207], v[0:3], v[240:243], 0
v_cvt_pkrtz_f16_f32 v137, v120, v121
v_cvt_pkrtz_f16_f32 v139, v122, v123
v_cvt_pkrtz_f16_f32 v141, v124, v125
v_cvt_pkrtz_f16_f32 v143, v126, v127
v_cvt_pkrtz_f16_f32 v145, v128, v129
v_mfma_f32_32x32x16_f16 v[192:207], v[4:7], v[244:247], v[192:207]
v_cvt_pk_f16_f32 v155, v130, v131
v_cvt_pk_f16_f32 v152, v132, v133
v_cvt_pk_f16_f32 v149, v134, v135
v_pk_fma_f16 v154, v155, v155, s48
v_and_b32_e64 v137, s49, v137
v_mfma_f32_32x32x16_bf16 v[120:135], v[232:235], v[168:171], 0
v_pk_fma_f16 v151, v152, v152, s48
v_and_b32_e64 v139, s49, v139
v_pk_fma_f16 v148, v149, v149, s48
v_pk_mul_f16 v154, v155, v154
v_bfe_u32 v136, v137, 2, 14
v_pk_mul_f16 v151, v152, v151
v_pk_mul_f16 v148, v149, v148
v_bfe_u32 v138, v139, 2, 14
v_fmac_f32 v156, v192, v192
v_exp_f16 v153, v154
ds_read_b128 v[232:235], v248 offset:30720
ds_read_u16_d16 v136, v136
ds_read_u16_d16 v138, v138
v_mfma_f32_32x32x16_bf16 v[120:135], v[236:239], v[172:175], v[120:135]
v_fmac_f32 v156, v193, v193
v_lshrrev_b32 v137, 18, v137
v_exp_f16 v150, v151
v_fmac_f32 v156, v194, v194
v_lshrrev_b32 v139, 18, v139
v_exp_f16 v147, v148
v_fmac_f32_e64 v156, v195, v195
v_and_b32 v141, s49, v141
s_waitcnt lgkmcnt(3)
ds_read_b128 v[236:239], v248 offset:33792
ds_read_u16_d16_hi v137, v137
ds_read_u16_d16_hi v139, v139
v_mfma_f32_32x32x16_bf16 v[120:135], v[224:227], v[176:179], v[120:135]
v_and_b32_e64 v143, s49, v143
v_exp_f16_sdwa v153, v154 dst_sel:WORD_1 dst_unused:UNUSED_PRESERVE src0_sel:WORD_1
v_fmac_f32_e64 v156, v196, v196
v_bfe_u32 v140, v141, 2, 14
v_exp_f16_sdwa v150, v151 dst_sel:WORD_1 dst_unused:UNUSED_PRESERVE src0_sel:WORD_1
v_fmac_f32_e64 v156, v197, v197
v_bfe_u32 v142, v143, 2, 14
v_exp_f16_sdwa v147, v148 dst_sel:WORD_1 dst_unused:UNUSED_PRESERVE src0_sel:WORD_1
ds_read_b128 v[224:227], v248 offset:34816
ds_read_u16_d16 v140, v140
ds_read_u16_d16 v142, v142
v_mfma_f32_32x32x16_bf16 v[120:135], v[228:231], v[180:183], v[120:135]
v_fmac_f32 v156, v198, v198
v_lshrrev_b32 v141, 18, v141
v_pk_add_f16 v153, v153, 1.0 op_sel_hi:[1,0]
v_fmac_f32 v156, v199, v199
v_lshrrev_b32 v143, 18, v143
v_pk_add_f16 v150, v150, 1.0 op_sel_hi:[1,0]
v_pk_add_f16 v147, v147, 1.0 op_sel_hi:[1,0]
v_fmac_f32_e64 v156, v200, v200
v_and_b32 v145, s49, v145
s_waitcnt lgkmcnt(5)
ds_read_b128 v[228:231], v248 offset:37888
ds_read_u16_d16_hi v141, v141
ds_read_u16_d16_hi v143, v143
v_mfma_f32_32x32x16_bf16 v[120:135], v[232:235], v[184:187], v[120:135]
v_rcp_f16 v154, v153
v_fmac_f32 v156, v201, v201
v_bfe_u32 v144, v145, 2, 14
v_rcp_f16 v151, v150
v_fmac_f32 v156, v202, v202
v_lshrrev_b32 v145, 18, v145
v_rcp_f16 v148, v147
v_fmac_f32_e64 v156, v203, v203
ds_read_u16_d16 v144, v144
ds_read_u16_d16_hi v145, v145
s_waitcnt lgkmcnt(5)
v_or_b32 v8, v136, v137
ds_read_b128 v[232:235], v248 offset:35840
v_mfma_f32_32x32x16_bf16 v[120:135], v[236:239], v[188:191], v[120:135]
v_or_b32_e64 v9, v138, v139
v_rcp_f16_sdwa v154, v153 dst_sel:WORD_1 dst_unused:UNUSED_PRESERVE src0_sel:WORD_1
v_fmac_f32 v156, v204, v204
s_waitcnt lgkmcnt(4)
v_or_b32_e64 v10, v140, v141
v_rcp_f16_sdwa v151, v150 dst_sel:WORD_1 dst_unused:UNUSED_PRESERVE src0_sel:WORD_1
v_fmac_f32 v156, v205, v205
s_waitcnt lgkmcnt(3)
v_or_b32_e64 v11, v142, v143
v_rcp_f16_sdwa v148, v147 dst_sel:WORD_1 dst_unused:UNUSED_PRESERVE src0_sel:WORD_1
v_fmac_f32 v156, v206, v206
s_waitcnt lgkmcnt(1)
v_or_b32_e64 v12, v144, v145
v_pk_mul_f16 v13, v155, v154
v_fmac_f32_e64 v156, v207, v207
v_pk_mul_f16 v14, v152, v151
v_pk_mul_f16 v15, v149, v148
s_cmp_lg_u32 s40, 0
s_cbranch_scc1 Lrs2
v_min_u32_e64 v88, 47, v251
v_lshlrev_b32 v88, 3, v88
v_add_u32 v89, 7936, v88
v_add_u32 v88, 15872, v88
v_cmp_gt_u32 vcc, 32, v251
s_nop 1
v_cndmask_b32 v88, v88, v89, vcc
s_waitcnt vmcnt(0)
ds_write_b64 v88, v[92:93]
Lrs2:
s_setprio 1
ds_read_b128 v[236:239], v248 offset:38912
v_mfma_f32_32x32x16_f16 v[192:207], v[8:11], v[240:243], 0
v_cvt_pkrtz_f16_f32 v137, v120, v121
v_cvt_pkrtz_f16_f32 v139, v122, v123
v_cvt_pkrtz_f16_f32 v141, v124, v125
v_cvt_pkrtz_f16_f32 v143, v126, v127
v_cvt_pkrtz_f16_f32 v145, v128, v129
v_mfma_f32_32x32x16_f16 v[192:207], v[12:15], v[244:247], v[192:207]
v_cvt_pk_f16_f32 v155, v130, v131
v_cvt_pk_f16_f32 v152, v132, v133
v_cvt_pk_f16_f32 v149, v134, v135
v_pk_fma_f16 v154, v155, v155, s48
v_and_b32_e64 v137, s49, v137
v_mfma_f32_32x32x16_bf16 v[120:135], v[224:227], v[168:171], 0
v_pk_fma_f16 v151, v152, v152, s48
v_and_b32_e64 v139, s49, v139
v_pk_fma_f16 v148, v149, v149, s48
v_pk_mul_f16 v154, v155, v154
v_bfe_u32 v136, v137, 2, 14
v_pk_mul_f16 v151, v152, v151
v_pk_mul_f16 v148, v149, v148
v_bfe_u32 v138, v139, 2, 14
v_fmac_f32 v157, v192, v192
v_exp_f16 v153, v154
ds_read_b128 v[224:227], v248 offset:36864
ds_read_u16_d16 v136, v136
ds_read_u16_d16 v138, v138
v_mfma_f32_32x32x16_bf16 v[120:135], v[228:231], v[172:175], v[120:135]
v_fmac_f32 v157, v193, v193
v_lshrrev_b32 v137, 18, v137
v_exp_f16 v150, v151
v_fmac_f32 v157, v194, v194
v_lshrrev_b32 v139, 18, v139
v_exp_f16 v147, v148
v_fmac_f32 v157, v195, v195
v_and_b32 v141, s49, v141
v_and_b32 v143, s49, v143
s_waitcnt lgkmcnt(3)
ds_read_b128 v[228:231], v248 offset:39936
ds_read_u16_d16_hi v137, v137
ds_read_u16_d16_hi v139, v139
v_mfma_f32_32x32x16_bf16 v[120:135], v[232:235], v[176:179], v[120:135]
v_fmac_f32_e64 v157, v196, v196
v_exp_f16_sdwa v153, v154 dst_sel:WORD_1 dst_unused:UNUSED_PRESERVE src0_sel:WORD_1
v_bfe_u32 v140, v141, 2, 14
v_fmac_f32_e64 v157, v197, v197
v_exp_f16_sdwa v150, v151 dst_sel:WORD_1 dst_unused:UNUSED_PRESERVE src0_sel:WORD_1
v_fmac_f32_e64 v157, v198, v198
v_bfe_u32 v142, v143, 2, 14
v_exp_f16_sdwa v147, v148 dst_sel:WORD_1 dst_unused:UNUSED_PRESERVE src0_sel:WORD_1
ds_read_b128 v[232:235], v248 offset:40960
ds_read_u16_d16 v140, v140
ds_read_u16_d16 v142, v142
v_mfma_f32_32x32x16_bf16 v[120:135], v[236:239], v[180:183], v[120:135]
v_fmac_f32 v157, v199, v199
v_lshrrev_b32 v141, 18, v141
v_pk_add_f16 v153, v153, 1.0 op_sel_hi:[1,0]
v_fmac_f32 v157, v200, v200
v_lshrrev_b32 v143, 18, v143
v_pk_add_f16 v150, v150, 1.0 op_sel_hi:[1,0]
v_pk_add_f16 v147, v147, 1.0 op_sel_hi:[1,0]
v_fmac_f32 v157, v201, v201
v_and_b32 v145, s49, v145
v_rcp_f16 v154, v153
s_waitcnt lgkmcnt(4)
ds_read_b128 v[236:239], v248 offset:44032
ds_read_u16_d16_hi v141, v141
ds_read_u16_d16_hi v143, v143
v_mfma_f32_32x32x16_bf16 v[120:135], v[224:227], v[184:187], v[120:135]
v_fmac_f32_e64 v157, v202, v202
v_bfe_u32 v144, v145, 2, 14
v_rcp_f16 v151, v150
s_setprio 0
v_fmac_f32 v157, v203, v203
v_lshrrev_b32 v145, 18, v145
v_rcp_f16 v148, v147
v_fmac_f32 v157, v204, v204
ds_read_u16_d16 v144, v144
ds_read_u16_d16_hi v145, v145
v_or_b32 v16, v136, v137
v_fmac_f32 v157, v205, v205
ds_read_b128 v[224:227], v248 offset:41984
v_mfma_f32_32x32x16_bf16 v[120:135], v[228:231], v[188:191], v[120:135]
s_waitcnt lgkmcnt(6)
v_or_b32 v17, v138, v139
v_rcp_f16_sdwa v154, v153 dst_sel:WORD_1 dst_unused:UNUSED_PRESERVE src0_sel:WORD_1
v_fmac_f32 v157, v206, v206
s_waitcnt lgkmcnt(4)
v_or_b32_e64 v18, v140, v141
v_rcp_f16_sdwa v151, v150 dst_sel:WORD_1 dst_unused:UNUSED_PRESERVE src0_sel:WORD_1
v_fmac_f32 v157, v207, v207
s_waitcnt lgkmcnt(3)
v_or_b32_e64 v19, v142, v143
v_rcp_f16_sdwa v148, v147 dst_sel:WORD_1 dst_unused:UNUSED_PRESERVE src0_sel:WORD_1
v_permlane32_swap_b32 v156, v157
s_waitcnt lgkmcnt(1)
v_or_b32_e64 v20, v144, v145
v_pk_mul_f16 v21, v155, v154
v_add_f32 v156, v156, v157
ds_write_b32 v255, v156 offset:7168
v_pk_mul_f16 v22, v152, v151
v_pk_mul_f16 v23, v149, v148
s_setprio 2
ds_read_b128 v[228:231], v248 offset:45056
v_mfma_f32_32x32x16_f16 v[192:207], v[16:19], v[240:243], 0
v_cvt_pkrtz_f16_f32 v137, v120, v121
v_cvt_pkrtz_f16_f32 v139, v122, v123
v_cvt_pkrtz_f16_f32 v141, v124, v125
v_cvt_pkrtz_f16_f32 v143, v126, v127
v_cvt_pkrtz_f16_f32 v145, v128, v129
v_mfma_f32_32x32x16_f16 v[192:207], v[20:23], v[244:247], v[192:207]
v_cvt_pk_f16_f32 v155, v130, v131
v_cvt_pk_f16_f32 v152, v132, v133
v_cvt_pk_f16_f32 v149, v134, v135
v_pk_fma_f16 v154, v155, v155, s48
v_and_b32_e64 v137, s49, v137
v_mfma_f32_32x32x16_bf16 v[120:135], v[232:235], v[168:171], 0
v_pk_fma_f16 v151, v152, v152, s48
v_and_b32_e64 v139, s49, v139
v_pk_fma_f16 v148, v149, v149, s48
v_pk_mul_f16 v154, v155, v154
v_bfe_u32 v136, v137, 2, 14
v_pk_mul_f16 v151, v152, v151
v_pk_mul_f16 v148, v149, v148
v_bfe_u32 v138, v139, 2, 14
v_fmac_f32 v158, v192, v192
v_exp_f16 v153, v154
ds_read_b128 v[232:235], v248 offset:43008
ds_read_u16_d16 v136, v136
ds_read_u16_d16 v138, v138
v_mfma_f32_32x32x16_bf16 v[120:135], v[236:239], v[172:175], v[120:135]
v_fmac_f32 v158, v193, v193
v_lshrrev_b32 v137, 18, v137
v_exp_f16 v150, v151
v_fmac_f32 v158, v194, v194
v_lshrrev_b32 v139, 18, v139
v_exp_f16 v147, v148
v_fmac_f32_e64 v158, v195, v195
v_and_b32 v141, s49, v141
s_waitcnt lgkmcnt(5)
ds_read_b128 v[236:239], v248 offset:46080
ds_read_u16_d16_hi v137, v137
ds_read_u16_d16_hi v139, v139
v_mfma_f32_32x32x16_bf16 v[120:135], v[224:227], v[176:179], v[120:135]
v_and_b32_e64 v143, s49, v143
v_exp_f16_sdwa v153, v154 dst_sel:WORD_1 dst_unused:UNUSED_PRESERVE src0_sel:WORD_1
v_fmac_f32_e64 v158, v196, v196
v_bfe_u32 v140, v141, 2, 14
v_exp_f16_sdwa v150, v151 dst_sel:WORD_1 dst_unused:UNUSED_PRESERVE src0_sel:WORD_1
v_fmac_f32 v158, v197, v197
v_bfe_u32 v142, v143, 2, 14
v_exp_f16_sdwa v147, v148 dst_sel:WORD_1 dst_unused:UNUSED_PRESERVE src0_sel:WORD_1
s_waitcnt lgkmcnt(5)
ds_read_b128 v[224:227], v248 offset:47104
ds_read_u16_d16 v140, v140
ds_read_u16_d16 v142, v142
v_mfma_f32_32x32x16_bf16 v[120:135], v[228:231], v[180:183], v[120:135]
v_fmac_f32 v158, v198, v198
v_lshrrev_b32 v141, 18, v141
v_pk_add_f16 v153, v153, 1.0 op_sel_hi:[1,0]
v_fmac_f32 v158, v199, v199
v_lshrrev_b32 v143, 18, v143
v_pk_add_f16 v150, v150, 1.0 op_sel_hi:[1,0]
v_pk_add_f16 v147, v147, 1.0 op_sel_hi:[1,0]
v_fmac_f32 v158, v200, v200
v_and_b32 v145, s49, v145
ds_read_b128 v[228:231], v248 offset:50176
ds_read_u16_d16_hi v141, v141
ds_read_u16_d16_hi v143, v143
v_mfma_f32_32x32x16_bf16 v[120:135], v[232:235], v[184:187], v[120:135]
v_rcp_f16 v154, v153
v_fmac_f32 v158, v201, v201
v_bfe_u32 v144, v145, 2, 14
v_rcp_f16 v151, v150
v_fmac_f32 v158, v202, v202
v_lshrrev_b32 v145, 18, v145
v_rcp_f16 v148, v147
v_fmac_f32_e64 v158, v203, v203
ds_read_u16_d16 v144, v144
ds_read_u16_d16_hi v145, v145
s_waitcnt lgkmcnt(5)
v_or_b32 v24, v136, v137
ds_read_b128 v[232:235], v248 offset:48128
v_mfma_f32_32x32x16_bf16 v[120:135], v[236:239], v[188:191], v[120:135]
v_or_b32_e64 v25, v138, v139
v_rcp_f16_sdwa v154, v153 dst_sel:WORD_1 dst_unused:UNUSED_PRESERVE src0_sel:WORD_1
v_fmac_f32 v158, v204, v204
s_waitcnt lgkmcnt(4)
v_or_b32_e64 v26, v140, v141
v_rcp_f16_sdwa v151, v150 dst_sel:WORD_1 dst_unused:UNUSED_PRESERVE src0_sel:WORD_1
v_fmac_f32 v158, v205, v205
s_waitcnt lgkmcnt(3)
v_or_b32_e64 v27, v142, v143
v_rcp_f16_sdwa v148, v147 dst_sel:WORD_1 dst_unused:UNUSED_PRESERVE src0_sel:WORD_1
v_fmac_f32 v158, v206, v206
s_waitcnt lgkmcnt(1)
v_or_b32_e64 v28, v144, v145
v_pk_mul_f16 v29, v155, v154
v_fmac_f32 v158, v207, v207
v_pk_mul_f16 v30, v152, v151
v_pk_mul_f16 v31, v149, v148
s_setprio 1
ds_read_b128 v[236:239], v248 offset:51200
v_mfma_f32_32x32x16_f16 v[192:207], v[24:27], v[240:243], 0
v_cvt_pkrtz_f16_f32 v137, v120, v121
v_cvt_pkrtz_f16_f32 v139, v122, v123
v_cvt_pkrtz_f16_f32 v141, v124, v125
v_cvt_pkrtz_f16_f32 v143, v126, v127
v_cvt_pkrtz_f16_f32 v145, v128, v129
v_mfma_f32_32x32x16_f16 v[192:207], v[28:31], v[244:247], v[192:207]
v_cvt_pk_f16_f32 v155, v130, v131
v_cvt_pk_f16_f32 v152, v132, v133
v_cvt_pk_f16_f32 v149, v134, v135
v_pk_fma_f16 v154, v155, v155, s48
v_and_b32_e64 v137, s49, v137
v_mfma_f32_32x32x16_bf16 v[120:135], v[224:227], v[168:171], 0
v_pk_fma_f16 v151, v152, v152, s48
v_and_b32_e64 v139, s49, v139
v_pk_fma_f16 v148, v149, v149, s48
v_pk_mul_f16 v154, v155, v154
v_bfe_u32 v136, v137, 2, 14
v_pk_mul_f16 v151, v152, v151
v_pk_mul_f16 v148, v149, v148
v_bfe_u32 v138, v139, 2, 14
v_fmac_f32 v159, v192, v192
v_exp_f16 v153, v154
ds_read_b128 v[224:227], v248 offset:49152
ds_read_u16_d16 v136, v136
ds_read_u16_d16 v138, v138
v_mfma_f32_32x32x16_bf16 v[120:135], v[228:231], v[172:175], v[120:135]
v_fmac_f32 v159, v193, v193
v_lshrrev_b32 v137, 18, v137
v_exp_f16 v150, v151
v_fmac_f32 v159, v194, v194
v_lshrrev_b32 v139, 18, v139
v_exp_f16 v147, v148
v_fmac_f32 v159, v195, v195
v_and_b32 v141, s49, v141
v_and_b32 v143, s49, v143
s_waitcnt lgkmcnt(3)
ds_read_b128 v[228:231], v248 offset:52224
ds_read_u16_d16_hi v137, v137
ds_read_u16_d16_hi v139, v139
v_mfma_f32_32x32x16_bf16 v[120:135], v[232:235], v[176:179], v[120:135]
v_fmac_f32_e64 v159, v196, v196
v_exp_f16_sdwa v153, v154 dst_sel:WORD_1 dst_unused:UNUSED_PRESERVE src0_sel:WORD_1
v_bfe_u32 v140, v141, 2, 14
v_fmac_f32_e64 v159, v197, v197
v_exp_f16_sdwa v150, v151 dst_sel:WORD_1 dst_unused:UNUSED_PRESERVE src0_sel:WORD_1
v_fmac_f32_e64 v159, v198, v198
v_bfe_u32 v142, v143, 2, 14
v_exp_f16_sdwa v147, v148 dst_sel:WORD_1 dst_unused:UNUSED_PRESERVE src0_sel:WORD_1
ds_read_b128 v[232:235], v248 offset:53248
ds_read_u16_d16 v140, v140
ds_read_u16_d16 v142, v142
v_mfma_f32_32x32x16_bf16 v[120:135], v[236:239], v[180:183], v[120:135]
v_fmac_f32 v159, v199, v199
v_lshrrev_b32 v141, 18, v141
v_pk_add_f16 v153, v153, 1.0 op_sel_hi:[1,0]
v_fmac_f32 v159, v200, v200
v_lshrrev_b32 v143, 18, v143
v_pk_add_f16 v150, v150, 1.0 op_sel_hi:[1,0]
v_pk_add_f16 v147, v147, 1.0 op_sel_hi:[1,0]
v_fmac_f32 v159, v201, v201
v_and_b32 v145, s49, v145
v_rcp_f16 v154, v153
s_waitcnt lgkmcnt(4)
ds_read_b128 v[236:239], v248 offset:56320
ds_read_u16_d16_hi v141, v141
ds_read_u16_d16_hi v143, v143
v_mfma_f32_32x32x16_bf16 v[120:135], v[224:227], v[184:187], v[120:135]
v_fmac_f32_e64 v159, v202, v202
v_bfe_u32 v144, v145, 2, 14
v_rcp_f16 v151, v150
s_setprio 0
v_fmac_f32 v159, v203, v203
v_lshrrev_b32 v145, 18, v145
v_rcp_f16 v148, v147
v_fmac_f32 v159, v204, v204
ds_read_u16_d16 v144, v144
ds_read_u16_d16_hi v145, v145
v_or_b32 v32, v136, v137
v_fmac_f32 v159, v205, v205
ds_read_b128 v[224:227], v248 offset:54272
v_mfma_f32_32x32x16_bf16 v[120:135], v[228:231], v[188:191], v[120:135]
s_waitcnt lgkmcnt(6)
v_or_b32 v33, v138, v139
v_rcp_f16_sdwa v154, v153 dst_sel:WORD_1 dst_unused:UNUSED_PRESERVE src0_sel:WORD_1
v_fmac_f32 v159, v206, v206
s_waitcnt lgkmcnt(4)
v_or_b32_e64 v34, v140, v141
v_rcp_f16_sdwa v151, v150 dst_sel:WORD_1 dst_unused:UNUSED_PRESERVE src0_sel:WORD_1
v_fmac_f32 v159, v207, v207
s_waitcnt lgkmcnt(3)
v_or_b32_e64 v35, v142, v143
v_rcp_f16_sdwa v148, v147 dst_sel:WORD_1 dst_unused:UNUSED_PRESERVE src0_sel:WORD_1
v_permlane32_swap_b32 v158, v159
s_waitcnt lgkmcnt(1)
v_or_b32_e64 v36, v144, v145
v_pk_mul_f16 v37, v155, v154
v_add_f32 v158, v158, v159
ds_write_b32 v255, v158 offset:7424
v_pk_mul_f16 v38, v152, v151
v_pk_mul_f16 v39, v149, v148
s_setprio 2
ds_read_b128 v[228:231], v248 offset:57344
v_mfma_f32_32x32x16_f16 v[192:207], v[32:35], v[240:243], 0
v_cvt_pkrtz_f16_f32 v137, v120, v121
v_cvt_pkrtz_f16_f32 v139, v122, v123
v_cvt_pkrtz_f16_f32 v141, v124, v125
v_cvt_pkrtz_f16_f32 v143, v126, v127
v_cvt_pkrtz_f16_f32 v145, v128, v129
v_mfma_f32_32x32x16_f16 v[192:207], v[36:39], v[244:247], v[192:207]
v_cvt_pk_f16_f32 v155, v130, v131
v_cvt_pk_f16_f32 v152, v132, v133
v_cvt_pk_f16_f32 v149, v134, v135
v_pk_fma_f16 v154, v155, v155, s48
v_and_b32_e64 v137, s49, v137
v_mfma_f32_32x32x16_bf16 v[120:135], v[232:235], v[168:171], 0
v_pk_fma_f16 v151, v152, v152, s48
v_and_b32_e64 v139, s49, v139
v_pk_fma_f16 v148, v149, v149, s48
v_pk_mul_f16 v154, v155, v154
v_bfe_u32 v136, v137, 2, 14
v_pk_mul_f16 v151, v152, v151
v_pk_mul_f16 v148, v149, v148
v_bfe_u32 v138, v139, 2, 14
v_fmac_f32 v160, v192, v192
v_exp_f16 v153, v154
ds_read_b128 v[232:235], v248 offset:55296
ds_read_u16_d16 v136, v136
ds_read_u16_d16 v138, v138
v_mfma_f32_32x32x16_bf16 v[120:135], v[236:239], v[172:175], v[120:135]
v_fmac_f32 v160, v193, v193
v_lshrrev_b32 v137, 18, v137
v_exp_f16 v150, v151
v_fmac_f32 v160, v194, v194
v_lshrrev_b32 v139, 18, v139
v_exp_f16 v147, v148
v_fmac_f32_e64 v160, v195, v195
v_and_b32 v141, s49, v141
s_waitcnt lgkmcnt(5)
ds_read_b128 v[236:239], v248 offset:58368
ds_read_u16_d16_hi v137, v137
ds_read_u16_d16_hi v139, v139
v_mfma_f32_32x32x16_bf16 v[120:135], v[224:227], v[176:179], v[120:135]
v_and_b32_e64 v143, s49, v143
v_exp_f16_sdwa v153, v154 dst_sel:WORD_1 dst_unused:UNUSED_PRESERVE src0_sel:WORD_1
v_fmac_f32_e64 v160, v196, v196
v_bfe_u32 v140, v141, 2, 14
v_exp_f16_sdwa v150, v151 dst_sel:WORD_1 dst_unused:UNUSED_PRESERVE src0_sel:WORD_1
v_fmac_f32 v160, v197, v197
v_bfe_u32 v142, v143, 2, 14
v_exp_f16_sdwa v147, v148 dst_sel:WORD_1 dst_unused:UNUSED_PRESERVE src0_sel:WORD_1
s_waitcnt lgkmcnt(5)
ds_read_b128 v[224:227], v248 offset:59392
ds_read_u16_d16 v140, v140
ds_read_u16_d16 v142, v142
v_mfma_f32_32x32x16_bf16 v[120:135], v[228:231], v[180:183], v[120:135]
v_fmac_f32 v160, v198, v198
v_lshrrev_b32 v141, 18, v141
v_pk_add_f16 v153, v153, 1.0 op_sel_hi:[1,0]
v_fmac_f32 v160, v199, v199
v_lshrrev_b32 v143, 18, v143
v_pk_add_f16 v150, v150, 1.0 op_sel_hi:[1,0]
v_pk_add_f16 v147, v147, 1.0 op_sel_hi:[1,0]
v_fmac_f32 v160, v200, v200
v_and_b32 v145, s49, v145
ds_read_b128 v[228:231], v248 offset:62464
ds_read_u16_d16_hi v141, v141
ds_read_u16_d16_hi v143, v143
v_mfma_f32_32x32x16_bf16 v[120:135], v[232:235], v[184:187], v[120:135]
v_rcp_f16 v154, v153
v_fmac_f32 v160, v201, v201
v_bfe_u32 v144, v145, 2, 14
v_rcp_f16 v151, v150
v_fmac_f32 v160, v202, v202
v_lshrrev_b32 v145, 18, v145
v_rcp_f16 v148, v147
v_fmac_f32_e64 v160, v203, v203
ds_read_u16_d16 v144, v144
ds_read_u16_d16_hi v145, v145
s_waitcnt lgkmcnt(5)
v_or_b32 v40, v136, v137
ds_read_b128 v[232:235], v248 offset:60416
v_mfma_f32_32x32x16_bf16 v[120:135], v[236:239], v[188:191], v[120:135]
v_or_b32_e64 v41, v138, v139
v_rcp_f16_sdwa v154, v153 dst_sel:WORD_1 dst_unused:UNUSED_PRESERVE src0_sel:WORD_1
v_fmac_f32 v160, v204, v204
s_waitcnt lgkmcnt(4)
v_or_b32_e64 v42, v140, v141
v_rcp_f16_sdwa v151, v150 dst_sel:WORD_1 dst_unused:UNUSED_PRESERVE src0_sel:WORD_1
v_fmac_f32 v160, v205, v205
s_waitcnt lgkmcnt(3)
v_or_b32_e64 v43, v142, v143
v_rcp_f16_sdwa v148, v147 dst_sel:WORD_1 dst_unused:UNUSED_PRESERVE src0_sel:WORD_1
v_fmac_f32 v160, v206, v206
s_waitcnt lgkmcnt(1)
v_or_b32_e64 v44, v144, v145
v_pk_mul_f16 v45, v155, v154
v_fmac_f32 v160, v207, v207
v_pk_mul_f16 v46, v152, v151
v_pk_mul_f16 v47, v149, v148
s_setprio 1
ds_read_b128 v[236:239], v248 offset:63488
v_mfma_f32_32x32x16_f16 v[192:207], v[40:43], v[240:243], 0
v_cvt_pkrtz_f16_f32 v137, v120, v121
v_cvt_pkrtz_f16_f32 v139, v122, v123
v_cvt_pkrtz_f16_f32 v141, v124, v125
v_cvt_pkrtz_f16_f32 v143, v126, v127
v_cvt_pkrtz_f16_f32 v145, v128, v129
v_mfma_f32_32x32x16_f16 v[192:207], v[44:47], v[244:247], v[192:207]
v_cvt_pk_f16_f32 v155, v130, v131
v_cvt_pk_f16_f32 v152, v132, v133
v_cvt_pk_f16_f32 v149, v134, v135
v_pk_fma_f16 v154, v155, v155, s48
v_and_b32_e64 v137, s49, v137
v_mfma_f32_32x32x16_bf16 v[120:135], v[224:227], v[168:171], 0
v_pk_fma_f16 v151, v152, v152, s48
v_and_b32_e64 v139, s49, v139
v_pk_fma_f16 v148, v149, v149, s48
v_pk_mul_f16 v154, v155, v154
v_bfe_u32 v136, v137, 2, 14
v_pk_mul_f16 v151, v152, v151
v_pk_mul_f16 v148, v149, v148
v_bfe_u32 v138, v139, 2, 14
v_fmac_f32 v161, v192, v192
v_exp_f16 v153, v154
ds_read_b128 v[224:227], v248 offset:61440
ds_read_u16_d16 v136, v136
ds_read_u16_d16 v138, v138
v_mfma_f32_32x32x16_bf16 v[120:135], v[228:231], v[172:175], v[120:135]
v_fmac_f32 v161, v193, v193
v_lshrrev_b32 v137, 18, v137
v_exp_f16 v150, v151
v_fmac_f32 v161, v194, v194
v_lshrrev_b32 v139, 18, v139
v_exp_f16 v147, v148
v_fmac_f32 v161, v195, v195
v_and_b32 v141, s49, v141
v_and_b32 v143, s49, v143
s_waitcnt lgkmcnt(3)
ds_read_b128 v[228:231], v248 offset:64512
ds_read_u16_d16_hi v137, v137
ds_read_u16_d16_hi v139, v139
v_mfma_f32_32x32x16_bf16 v[120:135], v[232:235], v[176:179], v[120:135]
v_fmac_f32_e64 v161, v196, v196
v_exp_f16_sdwa v153, v154 dst_sel:WORD_1 dst_unused:UNUSED_PRESERVE src0_sel:WORD_1
v_bfe_u32 v140, v141, 2, 14
v_fmac_f32_e64 v161, v197, v197
v_exp_f16_sdwa v150, v151 dst_sel:WORD_1 dst_unused:UNUSED_PRESERVE src0_sel:WORD_1
v_fmac_f32_e64 v161, v198, v198
v_bfe_u32 v142, v143, 2, 14
v_exp_f16_sdwa v147, v148 dst_sel:WORD_1 dst_unused:UNUSED_PRESERVE src0_sel:WORD_1
ds_read_b128 v[232:235], v249
ds_read_u16_d16 v140, v140
ds_read_u16_d16 v142, v142
v_mfma_f32_32x32x16_bf16 v[120:135], v[236:239], v[180:183], v[120:135]
v_fmac_f32 v161, v199, v199
v_lshrrev_b32 v141, 18, v141
v_pk_add_f16 v153, v153, 1.0 op_sel_hi:[1,0]
v_fmac_f32 v161, v200, v200
v_lshrrev_b32 v143, 18, v143
v_pk_add_f16 v150, v150, 1.0 op_sel_hi:[1,0]
v_pk_add_f16 v147, v147, 1.0 op_sel_hi:[1,0]
v_fmac_f32 v161, v201, v201
v_and_b32 v145, s49, v145
v_rcp_f16 v154, v153
s_waitcnt lgkmcnt(4)
ds_read_b128 v[236:239], v249 offset:3072
ds_read_u16_d16_hi v141, v141
ds_read_u16_d16_hi v143, v143
v_mfma_f32_32x32x16_bf16 v[120:135], v[224:227], v[184:187], v[120:135]
v_fmac_f32_e64 v161, v202, v202
v_bfe_u32 v144, v145, 2, 14
v_rcp_f16 v151, v150
s_setprio 0
v_fmac_f32 v161, v203, v203
v_lshrrev_b32 v145, 18, v145
v_rcp_f16 v148, v147
v_fmac_f32 v161, v204, v204
ds_read_u16_d16 v144, v144
ds_read_u16_d16_hi v145, v145
v_or_b32 v48, v136, v137
v_fmac_f32 v161, v205, v205
ds_read_b128 v[224:227], v249 offset:1024
v_mfma_f32_32x32x16_bf16 v[120:135], v[228:231], v[188:191], v[120:135]
s_waitcnt lgkmcnt(6)
v_or_b32 v49, v138, v139
v_rcp_f16_sdwa v154, v153 dst_sel:WORD_1 dst_unused:UNUSED_PRESERVE src0_sel:WORD_1
v_fmac_f32 v161, v206, v206
s_waitcnt lgkmcnt(4)
v_or_b32_e64 v50, v140, v141
v_rcp_f16_sdwa v151, v150 dst_sel:WORD_1 dst_unused:UNUSED_PRESERVE src0_sel:WORD_1
v_fmac_f32 v161, v207, v207
s_waitcnt lgkmcnt(3)
v_or_b32_e64 v51, v142, v143
v_rcp_f16_sdwa v148, v147 dst_sel:WORD_1 dst_unused:UNUSED_PRESERVE src0_sel:WORD_1
v_permlane32_swap_b32 v160, v161
s_waitcnt lgkmcnt(1)
v_or_b32_e64 v52, v144, v145
v_pk_mul_f16 v53, v155, v154
v_add_f32 v160, v160, v161
ds_write_b32 v255, v160 offset:7680
v_pk_mul_f16 v54, v152, v151
v_pk_mul_f16 v55, v149, v148
s_setprio 2
ds_read_b128 v[228:231], v249 offset:4096
v_mfma_f32_32x32x16_f16 v[192:207], v[48:51], v[240:243], 0
v_cvt_pkrtz_f16_f32 v137, v120, v121
v_cvt_pkrtz_f16_f32 v139, v122, v123
v_cvt_pkrtz_f16_f32 v141, v124, v125
v_cvt_pkrtz_f16_f32 v143, v126, v127
v_cvt_pkrtz_f16_f32 v145, v128, v129
v_mfma_f32_32x32x16_f16 v[192:207], v[52:55], v[244:247], v[192:207]
v_cvt_pk_f16_f32 v155, v130, v131
v_cvt_pk_f16_f32 v152, v132, v133
v_cvt_pk_f16_f32 v149, v134, v135
v_pk_fma_f16 v154, v155, v155, s48
v_and_b32_e64 v137, s49, v137
v_mfma_f32_32x32x16_bf16 v[120:135], v[232:235], v[168:171], 0
v_pk_fma_f16 v151, v152, v152, s48
v_and_b32_e64 v139, s49, v139
v_pk_fma_f16 v148, v149, v149, s48
v_pk_mul_f16 v154, v155, v154
v_bfe_u32 v136, v137, 2, 14
v_pk_mul_f16 v151, v152, v151
v_pk_mul_f16 v148, v149, v148
v_bfe_u32 v138, v139, 2, 14
v_fmac_f32 v162, v192, v192
v_exp_f16 v153, v154
ds_read_b128 v[232:235], v249 offset:2048
ds_read_u16_d16 v136, v136
ds_read_u16_d16 v138, v138
v_mfma_f32_32x32x16_bf16 v[120:135], v[236:239], v[172:175], v[120:135]
v_fmac_f32 v162, v193, v193
v_lshrrev_b32 v137, 18, v137
v_exp_f16 v150, v151
v_fmac_f32 v162, v194, v194
v_lshrrev_b32 v139, 18, v139
v_exp_f16 v147, v148
v_fmac_f32_e64 v162, v195, v195
v_and_b32 v141, s49, v141
s_waitcnt lgkmcnt(5)
ds_read_b128 v[236:239], v249 offset:5120
ds_read_u16_d16_hi v137, v137
ds_read_u16_d16_hi v139, v139
v_mfma_f32_32x32x16_bf16 v[120:135], v[224:227], v[176:179], v[120:135]
v_and_b32_e64 v143, s49, v143
v_exp_f16_sdwa v153, v154 dst_sel:WORD_1 dst_unused:UNUSED_PRESERVE src0_sel:WORD_1
v_fmac_f32_e64 v162, v196, v196
v_bfe_u32 v140, v141, 2, 14
v_exp_f16_sdwa v150, v151 dst_sel:WORD_1 dst_unused:UNUSED_PRESERVE src0_sel:WORD_1
v_fmac_f32 v162, v197, v197
v_bfe_u32 v142, v143, 2, 14
v_exp_f16_sdwa v147, v148 dst_sel:WORD_1 dst_unused:UNUSED_PRESERVE src0_sel:WORD_1
s_waitcnt lgkmcnt(5)
ds_read_b128 v[224:227], v249 offset:6144
ds_read_u16_d16 v140, v140
ds_read_u16_d16 v142, v142
v_mfma_f32_32x32x16_bf16 v[120:135], v[228:231], v[180:183], v[120:135]
v_fmac_f32 v162, v198, v198
v_lshrrev_b32 v141, 18, v141
v_pk_add_f16 v153, v153, 1.0 op_sel_hi:[1,0]
v_fmac_f32 v162, v199, v199
v_lshrrev_b32 v143, 18, v143
v_pk_add_f16 v150, v150, 1.0 op_sel_hi:[1,0]
v_pk_add_f16 v147, v147, 1.0 op_sel_hi:[1,0]
v_fmac_f32 v162, v200, v200
v_and_b32 v145, s49, v145
ds_read_b128 v[228:231], v249 offset:9216
ds_read_u16_d16_hi v141, v141
ds_read_u16_d16_hi v143, v143
v_mfma_f32_32x32x16_bf16 v[120:135], v[232:235], v[184:187], v[120:135]
v_rcp_f16 v154, v153
v_fmac_f32 v162, v201, v201
v_bfe_u32 v144, v145, 2, 14
v_rcp_f16 v151, v150
v_fmac_f32 v162, v202, v202
v_lshrrev_b32 v145, 18, v145
v_rcp_f16 v148, v147
v_fmac_f32_e64 v162, v203, v203
ds_read_u16_d16 v144, v144
ds_read_u16_d16_hi v145, v145
s_waitcnt lgkmcnt(5)
v_or_b32 v56, v136, v137
ds_read_b128 v[232:235], v249 offset:7168
v_mfma_f32_32x32x16_bf16 v[120:135], v[236:239], v[188:191], v[120:135]
v_or_b32_e64 v57, v138, v139
v_rcp_f16_sdwa v154, v153 dst_sel:WORD_1 dst_unused:UNUSED_PRESERVE src0_sel:WORD_1
v_fmac_f32 v162, v204, v204
s_waitcnt lgkmcnt(4)
v_or_b32_e64 v58, v140, v141
v_rcp_f16_sdwa v151, v150 dst_sel:WORD_1 dst_unused:UNUSED_PRESERVE src0_sel:WORD_1
v_fmac_f32 v162, v205, v205
s_waitcnt lgkmcnt(3)
v_or_b32_e64 v59, v142, v143
v_rcp_f16_sdwa v148, v147 dst_sel:WORD_1 dst_unused:UNUSED_PRESERVE src0_sel:WORD_1
v_fmac_f32 v162, v206, v206
s_waitcnt lgkmcnt(1)
v_or_b32_e64 v60, v144, v145
v_pk_mul_f16 v61, v155, v154
v_fmac_f32 v162, v207, v207
v_pk_mul_f16 v62, v152, v151
v_pk_mul_f16 v63, v149, v148
s_setprio 1
ds_read_b128 v[236:239], v249 offset:10240
v_mfma_f32_32x32x16_f16 v[192:207], v[56:59], v[240:243], 0
v_cvt_pkrtz_f16_f32 v137, v120, v121
v_cvt_pkrtz_f16_f32 v139, v122, v123
v_cvt_pkrtz_f16_f32 v141, v124, v125
v_cvt_pkrtz_f16_f32 v143, v126, v127
v_cvt_pkrtz_f16_f32 v145, v128, v129
v_mfma_f32_32x32x16_f16 v[192:207], v[60:63], v[244:247], v[192:207]
v_cvt_pk_f16_f32 v155, v130, v131
v_cvt_pk_f16_f32 v152, v132, v133
v_cvt_pk_f16_f32 v149, v134, v135
v_pk_fma_f16 v154, v155, v155, s48
v_and_b32_e64 v137, s49, v137
v_mfma_f32_32x32x16_bf16 v[120:135], v[224:227], v[168:171], 0
v_pk_fma_f16 v151, v152, v152, s48
v_and_b32_e64 v139, s49, v139
v_pk_fma_f16 v148, v149, v149, s48
v_pk_mul_f16 v154, v155, v154
v_bfe_u32 v136, v137, 2, 14
v_pk_mul_f16 v151, v152, v151
v_pk_mul_f16 v148, v149, v148
v_bfe_u32 v138, v139, 2, 14
v_fmac_f32 v163, v192, v192
v_exp_f16 v153, v154
ds_read_b128 v[224:227], v249 offset:8192
ds_read_u16_d16 v136, v136
ds_read_u16_d16 v138, v138
v_mfma_f32_32x32x16_bf16 v[120:135], v[228:231], v[172:175], v[120:135]
v_fmac_f32 v163, v193, v193
v_lshrrev_b32 v137, 18, v137
v_exp_f16 v150, v151
v_fmac_f32 v163, v194, v194
v_lshrrev_b32 v139, 18, v139
v_exp_f16 v147, v148
v_fmac_f32 v163, v195, v195
v_and_b32 v141, s49, v141
v_and_b32 v143, s49, v143
s_waitcnt lgkmcnt(3)
ds_read_b128 v[228:231], v249 offset:11264
ds_read_u16_d16_hi v137, v137
ds_read_u16_d16_hi v139, v139
v_mfma_f32_32x32x16_bf16 v[120:135], v[232:235], v[176:179], v[120:135]
v_fmac_f32_e64 v163, v196, v196
v_exp_f16_sdwa v153, v154 dst_sel:WORD_1 dst_unused:UNUSED_PRESERVE src0_sel:WORD_1
v_bfe_u32 v140, v141, 2, 14
v_fmac_f32_e64 v163, v197, v197
v_exp_f16_sdwa v150, v151 dst_sel:WORD_1 dst_unused:UNUSED_PRESERVE src0_sel:WORD_1
v_fmac_f32_e64 v163, v198, v198
v_bfe_u32 v142, v143, 2, 14
v_exp_f16_sdwa v147, v148 dst_sel:WORD_1 dst_unused:UNUSED_PRESERVE src0_sel:WORD_1
ds_read_b128 v[232:235], v249 offset:12288
ds_read_u16_d16 v140, v140
ds_read_u16_d16 v142, v142
v_mfma_f32_32x32x16_bf16 v[120:135], v[236:239], v[180:183], v[120:135]
v_fmac_f32 v163, v199, v199
v_lshrrev_b32 v141, 18, v141
v_pk_add_f16 v153, v153, 1.0 op_sel_hi:[1,0]
v_fmac_f32 v163, v200, v200
v_lshrrev_b32 v143, 18, v143
v_pk_add_f16 v150, v150, 1.0 op_sel_hi:[1,0]
v_pk_add_f16 v147, v147, 1.0 op_sel_hi:[1,0]
v_fmac_f32 v163, v201, v201
v_and_b32 v145, s49, v145
v_rcp_f16 v154, v153
s_waitcnt lgkmcnt(4)
ds_read_b128 v[236:239], v249 offset:15360
ds_read_u16_d16_hi v141, v141
ds_read_u16_d16_hi v143, v143
v_mfma_f32_32x32x16_bf16 v[120:135], v[224:227], v[184:187], v[120:135]
v_fmac_f32_e64 v163, v202, v202
v_bfe_u32 v144, v145, 2, 14
v_rcp_f16 v151, v150
s_setprio 0
v_fmac_f32 v163, v203, v203
v_lshrrev_b32 v145, 18, v145
v_rcp_f16 v148, v147
v_fmac_f32 v163, v204, v204
ds_read_u16_d16 v144, v144
ds_read_u16_d16_hi v145, v145
v_or_b32 v64, v136, v137
v_fmac_f32 v163, v205, v205
ds_read_b128 v[224:227], v249 offset:13312
v_mfma_f32_32x32x16_bf16 v[120:135], v[228:231], v[188:191], v[120:135]
s_waitcnt lgkmcnt(6)
v_or_b32 v65, v138, v139
v_rcp_f16_sdwa v154, v153 dst_sel:WORD_1 dst_unused:UNUSED_PRESERVE src0_sel:WORD_1
v_fmac_f32 v163, v206, v206
s_waitcnt lgkmcnt(4)
v_or_b32_e64 v66, v140, v141
v_rcp_f16_sdwa v151, v150 dst_sel:WORD_1 dst_unused:UNUSED_PRESERVE src0_sel:WORD_1
v_fmac_f32 v163, v207, v207
s_waitcnt lgkmcnt(3)
v_or_b32_e64 v67, v142, v143
v_rcp_f16_sdwa v148, v147 dst_sel:WORD_1 dst_unused:UNUSED_PRESERVE src0_sel:WORD_1
v_permlane32_swap_b32 v162, v163
s_waitcnt lgkmcnt(1)
v_or_b32_e64 v68, v144, v145
v_pk_mul_f16 v69, v155, v154
v_add_f32 v162, v162, v163
ds_write_b32 v255, v162 offset:7936
v_pk_mul_f16 v70, v152, v151
v_pk_mul_f16 v71, v149, v148
s_setprio 2
ds_read_b128 v[228:231], v249 offset:16384
v_mfma_f32_32x32x16_f16 v[192:207], v[64:67], v[240:243], 0
v_cvt_pkrtz_f16_f32 v137, v120, v121
v_cvt_pkrtz_f16_f32 v139, v122, v123
v_cvt_pkrtz_f16_f32 v141, v124, v125
v_cvt_pkrtz_f16_f32 v143, v126, v127
v_cvt_pkrtz_f16_f32 v145, v128, v129
v_mfma_f32_32x32x16_f16 v[192:207], v[68:71], v[244:247], v[192:207]
v_cvt_pk_f16_f32 v155, v130, v131
v_cvt_pk_f16_f32 v152, v132, v133
v_cvt_pk_f16_f32 v149, v134, v135
v_pk_fma_f16 v154, v155, v155, s48
v_and_b32_e64 v137, s49, v137
v_mfma_f32_32x32x16_bf16 v[120:135], v[232:235], v[168:171], 0
v_pk_fma_f16 v151, v152, v152, s48
v_and_b32_e64 v139, s49, v139
v_pk_fma_f16 v148, v149, v149, s48
v_pk_mul_f16 v154, v155, v154
v_bfe_u32 v136, v137, 2, 14
v_pk_mul_f16 v151, v152, v151
v_pk_mul_f16 v148, v149, v148
v_bfe_u32 v138, v139, 2, 14
v_fmac_f32 v164, v192, v192
v_exp_f16 v153, v154
ds_read_b128 v[232:235], v249 offset:14336
ds_read_u16_d16 v136, v136
ds_read_u16_d16 v138, v138
v_mfma_f32_32x32x16_bf16 v[120:135], v[236:239], v[172:175], v[120:135]
v_fmac_f32 v164, v193, v193
v_lshrrev_b32 v137, 18, v137
v_exp_f16 v150, v151
v_fmac_f32 v164, v194, v194
v_lshrrev_b32 v139, 18, v139
v_exp_f16 v147, v148
v_fmac_f32_e64 v164, v195, v195
v_and_b32 v141, s49, v141
s_waitcnt lgkmcnt(5)
ds_read_b128 v[236:239], v249 offset:17408
ds_read_u16_d16_hi v137, v137
ds_read_u16_d16_hi v139, v139
v_mfma_f32_32x32x16_bf16 v[120:135], v[224:227], v[176:179], v[120:135]
v_and_b32_e64 v143, s49, v143
v_exp_f16_sdwa v153, v154 dst_sel:WORD_1 dst_unused:UNUSED_PRESERVE src0_sel:WORD_1
v_fmac_f32_e64 v164, v196, v196
v_bfe_u32 v140, v141, 2, 14
v_exp_f16_sdwa v150, v151 dst_sel:WORD_1 dst_unused:UNUSED_PRESERVE src0_sel:WORD_1
v_fmac_f32 v164, v197, v197
v_bfe_u32 v142, v143, 2, 14
v_exp_f16_sdwa v147, v148 dst_sel:WORD_1 dst_unused:UNUSED_PRESERVE src0_sel:WORD_1
s_waitcnt lgkmcnt(5)
ds_read_b128 v[224:227], v249 offset:18432
ds_read_u16_d16 v140, v140
ds_read_u16_d16 v142, v142
v_mfma_f32_32x32x16_bf16 v[120:135], v[228:231], v[180:183], v[120:135]
v_fmac_f32 v164, v198, v198
v_lshrrev_b32 v141, 18, v141
v_pk_add_f16 v153, v153, 1.0 op_sel_hi:[1,0]
v_fmac_f32 v164, v199, v199
v_lshrrev_b32 v143, 18, v143
v_pk_add_f16 v150, v150, 1.0 op_sel_hi:[1,0]
v_pk_add_f16 v147, v147, 1.0 op_sel_hi:[1,0]
v_fmac_f32 v164, v200, v200
v_and_b32 v145, s49, v145
ds_read_b128 v[228:231], v249 offset:21504
ds_read_u16_d16_hi v141, v141
ds_read_u16_d16_hi v143, v143
v_mfma_f32_32x32x16_bf16 v[120:135], v[232:235], v[184:187], v[120:135]
v_rcp_f16 v154, v153
v_fmac_f32 v164, v201, v201
v_bfe_u32 v144, v145, 2, 14
v_rcp_f16 v151, v150
v_fmac_f32 v164, v202, v202
v_lshrrev_b32 v145, 18, v145
v_rcp_f16 v148, v147
v_fmac_f32_e64 v164, v203, v203
ds_read_u16_d16 v144, v144
ds_read_u16_d16_hi v145, v145
s_waitcnt lgkmcnt(5)
v_or_b32 v72, v136, v137
ds_read_b128 v[232:235], v249 offset:19456
v_mfma_f32_32x32x16_bf16 v[120:135], v[236:239], v[188:191], v[120:135]
v_or_b32_e64 v73, v138, v139
v_rcp_f16_sdwa v154, v153 dst_sel:WORD_1 dst_unused:UNUSED_PRESERVE src0_sel:WORD_1
v_fmac_f32 v164, v204, v204
s_waitcnt lgkmcnt(4)
v_or_b32_e64 v74, v140, v141
v_rcp_f16_sdwa v151, v150 dst_sel:WORD_1 dst_unused:UNUSED_PRESERVE src0_sel:WORD_1
v_fmac_f32 v164, v205, v205
s_waitcnt lgkmcnt(3)
v_or_b32_e64 v75, v142, v143
v_rcp_f16_sdwa v148, v147 dst_sel:WORD_1 dst_unused:UNUSED_PRESERVE src0_sel:WORD_1
v_fmac_f32 v164, v206, v206
s_waitcnt lgkmcnt(1)
v_or_b32_e64 v76, v144, v145
v_pk_mul_f16 v77, v155, v154
v_fmac_f32 v164, v207, v207
v_pk_mul_f16 v78, v152, v151
v_pk_mul_f16 v79, v149, v148
s_setprio 1
ds_read_b128 v[236:239], v249 offset:22528
v_mfma_f32_32x32x16_f16 v[192:207], v[72:75], v[240:243], 0
v_cvt_pkrtz_f16_f32 v137, v120, v121
v_cvt_pkrtz_f16_f32 v139, v122, v123
v_cvt_pkrtz_f16_f32 v141, v124, v125
v_cvt_pkrtz_f16_f32 v143, v126, v127
v_cvt_pkrtz_f16_f32 v145, v128, v129
v_mfma_f32_32x32x16_f16 v[192:207], v[76:79], v[244:247], v[192:207]
v_cvt_pk_f16_f32 v155, v130, v131
v_cvt_pk_f16_f32 v152, v132, v133
v_cvt_pk_f16_f32 v149, v134, v135
v_pk_fma_f16 v154, v155, v155, s48
v_and_b32_e64 v137, s49, v137
v_mfma_f32_32x32x16_bf16 v[120:135], v[224:227], v[168:171], 0
v_pk_fma_f16 v151, v152, v152, s48
v_and_b32_e64 v139, s49, v139
v_pk_fma_f16 v148, v149, v149, s48
v_pk_mul_f16 v154, v155, v154
v_bfe_u32 v136, v137, 2, 14
v_pk_mul_f16 v151, v152, v151
v_pk_mul_f16 v148, v149, v148
v_bfe_u32 v138, v139, 2, 14
v_fmac_f32 v165, v192, v192
v_exp_f16 v153, v154
ds_read_b128 v[224:227], v249 offset:20480
ds_read_u16_d16 v136, v136
ds_read_u16_d16 v138, v138
v_mfma_f32_32x32x16_bf16 v[120:135], v[228:231], v[172:175], v[120:135]
v_fmac_f32 v165, v193, v193
v_lshrrev_b32 v137, 18, v137
v_exp_f16 v150, v151
v_fmac_f32 v165, v194, v194
v_lshrrev_b32 v139, 18, v139
v_exp_f16 v147, v148
v_fmac_f32 v165, v195, v195
v_and_b32 v141, s49, v141
v_and_b32 v143, s49, v143
s_waitcnt lgkmcnt(3)
ds_read_b128 v[228:231], v249 offset:23552
ds_read_u16_d16_hi v137, v137
ds_read_u16_d16_hi v139, v139
v_mfma_f32_32x32x16_bf16 v[120:135], v[232:235], v[176:179], v[120:135]
v_fmac_f32_e64 v165, v196, v196
v_exp_f16_sdwa v153, v154 dst_sel:WORD_1 dst_unused:UNUSED_PRESERVE src0_sel:WORD_1
v_bfe_u32 v140, v141, 2, 14
v_fmac_f32_e64 v165, v197, v197
v_exp_f16_sdwa v150, v151 dst_sel:WORD_1 dst_unused:UNUSED_PRESERVE src0_sel:WORD_1
v_fmac_f32_e64 v165, v198, v198
v_bfe_u32 v142, v143, 2, 14
v_exp_f16_sdwa v147, v148 dst_sel:WORD_1 dst_unused:UNUSED_PRESERVE src0_sel:WORD_1
ds_read_b128 v[232:235], v248 offset:40960
ds_read_u16_d16 v140, v140
ds_read_u16_d16 v142, v142
v_mfma_f32_32x32x16_bf16 v[120:135], v[236:239], v[180:183], v[120:135]
v_fmac_f32 v165, v199, v199
v_lshrrev_b32 v141, 18, v141
v_pk_add_f16 v153, v153, 1.0 op_sel_hi:[1,0]
v_fmac_f32 v165, v200, v200
v_lshrrev_b32 v143, 18, v143
v_pk_add_f16 v150, v150, 1.0 op_sel_hi:[1,0]
v_pk_add_f16 v147, v147, 1.0 op_sel_hi:[1,0]
v_fmac_f32 v165, v201, v201
v_and_b32 v145, s49, v145
v_rcp_f16 v154, v153
s_waitcnt lgkmcnt(4)
ds_read_b128 v[236:239], v248 offset:44032
ds_read_u16_d16_hi v141, v141
ds_read_u16_d16_hi v143, v143
v_mfma_f32_32x32x16_bf16 v[120:135], v[224:227], v[184:187], v[120:135]
v_fmac_f32_e64 v165, v202, v202
v_bfe_u32 v144, v145, 2, 14
v_rcp_f16 v151, v150
s_setprio 0
v_fmac_f32 v165, v203, v203
v_lshrrev_b32 v145, 18, v145
v_rcp_f16 v148, v147
v_fmac_f32 v165, v204, v204
ds_read_u16_d16 v144, v144
ds_read_u16_d16_hi v145, v145
v_or_b32 v80, v136, v137
v_fmac_f32 v165, v205, v205
ds_read_b128 v[224:227], v248 offset:41984
v_mfma_f32_32x32x16_bf16 v[120:135], v[228:231], v[188:191], v[120:135]
s_waitcnt lgkmcnt(6)
v_or_b32 v81, v138, v139
v_rcp_f16_sdwa v154, v153 dst_sel:WORD_1 dst_unused:UNUSED_PRESERVE src0_sel:WORD_1
v_fmac_f32 v165, v206, v206
s_waitcnt lgkmcnt(4)
v_or_b32_e64 v82, v140, v141
v_rcp_f16_sdwa v151, v150 dst_sel:WORD_1 dst_unused:UNUSED_PRESERVE src0_sel:WORD_1
v_fmac_f32 v165, v207, v207
s_waitcnt lgkmcnt(3)
v_or_b32_e64 v83, v142, v143
v_rcp_f16_sdwa v148, v147 dst_sel:WORD_1 dst_unused:UNUSED_PRESERVE src0_sel:WORD_1
v_permlane32_swap_b32 v164, v165
s_waitcnt lgkmcnt(1)
v_or_b32_e64 v84, v144, v145
v_pk_mul_f16 v85, v155, v154
v_add_f32 v164, v164, v165
ds_write_b32 v255, v164 offset:8192
v_pk_mul_f16 v86, v152, v151
v_pk_mul_f16 v87, v149, v148
s_setprio 2
ds_read_b128 v[228:231], v248 offset:45056
v_mfma_f32_32x32x16_f16 v[192:207], v[80:83], v[240:243], 0
v_cvt_pkrtz_f16_f32 v137, v120, v121
v_cvt_pkrtz_f16_f32 v139, v122, v123
v_cvt_pkrtz_f16_f32 v141, v124, v125
v_cvt_pkrtz_f16_f32 v143, v126, v127
v_cvt_pkrtz_f16_f32 v145, v128, v129
v_mfma_f32_32x32x16_f16 v[192:207], v[84:87], v[244:247], v[192:207]
v_cvt_pk_f16_f32 v155, v130, v131
v_cvt_pk_f16_f32 v152, v132, v133
v_cvt_pk_f16_f32 v149, v134, v135
v_pk_fma_f16 v154, v155, v155, s48
v_and_b32_e64 v137, s49, v137
v_mfma_f32_32x32x16_bf16 v[120:135], v[232:235], v[96:99], 0
v_pk_fma_f16 v151, v152, v152, s48
v_and_b32_e64 v139, s49, v139
v_pk_fma_f16 v148, v149, v149, s48
v_pk_mul_f16 v154, v155, v154
v_bfe_u32 v136, v137, 2, 14
v_pk_mul_f16 v151, v152, v151
v_pk_mul_f16 v148, v149, v148
v_bfe_u32 v138, v139, 2, 14
v_fmac_f32 v166, v192, v192
v_exp_f16 v153, v154
ds_read_b128 v[232:235], v248 offset:43008
ds_read_u16_d16 v136, v136
ds_read_u16_d16 v138, v138
v_mfma_f32_32x32x16_bf16 v[120:135], v[236:239], v[100:103], v[120:135]
v_fmac_f32 v166, v193, v193
v_lshrrev_b32 v137, 18, v137
v_exp_f16 v150, v151
v_fmac_f32 v166, v194, v194
v_lshrrev_b32 v139, 18, v139
v_exp_f16 v147, v148
v_fmac_f32_e64 v166, v195, v195
v_and_b32 v141, s49, v141
s_waitcnt lgkmcnt(5)
ds_read_b128 v[236:239], v248 offset:46080
ds_read_u16_d16_hi v137, v137
ds_read_u16_d16_hi v139, v139
v_mfma_f32_32x32x16_bf16 v[120:135], v[224:227], v[104:107], v[120:135]
v_and_b32_e64 v143, s49, v143
v_exp_f16_sdwa v153, v154 dst_sel:WORD_1 dst_unused:UNUSED_PRESERVE src0_sel:WORD_1
v_fmac_f32_e64 v166, v196, v196
v_bfe_u32 v140, v141, 2, 14
v_exp_f16_sdwa v150, v151 dst_sel:WORD_1 dst_unused:UNUSED_PRESERVE src0_sel:WORD_1
v_fmac_f32 v166, v197, v197
v_bfe_u32 v142, v143, 2, 14
v_exp_f16_sdwa v147, v148 dst_sel:WORD_1 dst_unused:UNUSED_PRESERVE src0_sel:WORD_1
s_waitcnt lgkmcnt(5)
ds_read_b128 v[224:227], v248 offset:47104
ds_read_u16_d16 v140, v140
ds_read_u16_d16 v142, v142
v_mfma_f32_32x32x16_bf16 v[120:135], v[228:231], v[108:111], v[120:135]
v_fmac_f32 v166, v198, v198
v_lshrrev_b32 v141, 18, v141
v_pk_add_f16 v153, v153, 1.0 op_sel_hi:[1,0]
v_fmac_f32 v166, v199, v199
v_lshrrev_b32 v143, 18, v143
v_pk_add_f16 v150, v150, 1.0 op_sel_hi:[1,0]
v_pk_add_f16 v147, v147, 1.0 op_sel_hi:[1,0]
v_fmac_f32 v166, v200, v200
v_and_b32 v145, s49, v145
ds_read_b128 v[228:231], v248 offset:50176
ds_read_u16_d16_hi v141, v141
ds_read_u16_d16_hi v143, v143
v_mfma_f32_32x32x16_bf16 v[120:135], v[232:235], v[112:115], v[120:135]
v_rcp_f16 v154, v153
v_fmac_f32 v166, v201, v201
v_bfe_u32 v144, v145, 2, 14
v_rcp_f16 v151, v150
v_fmac_f32 v166, v202, v202
v_lshrrev_b32 v145, 18, v145
v_rcp_f16 v148, v147
v_fmac_f32_e64 v166, v203, v203
ds_read_u16_d16 v144, v144
ds_read_u16_d16_hi v145, v145
s_waitcnt lgkmcnt(5)
v_or_b32 v88, v136, v137
ds_read_b128 v[232:235], v248 offset:48128
v_mfma_f32_32x32x16_bf16 v[120:135], v[236:239], v[116:119], v[120:135]
v_or_b32_e64 v89, v138, v139
v_rcp_f16_sdwa v154, v153 dst_sel:WORD_1 dst_unused:UNUSED_PRESERVE src0_sel:WORD_1
v_fmac_f32 v166, v204, v204
s_waitcnt lgkmcnt(4)
v_or_b32_e64 v90, v140, v141
v_rcp_f16_sdwa v151, v150 dst_sel:WORD_1 dst_unused:UNUSED_PRESERVE src0_sel:WORD_1
v_fmac_f32 v166, v205, v205
s_waitcnt lgkmcnt(3)
v_or_b32_e64 v91, v142, v143
v_rcp_f16_sdwa v148, v147 dst_sel:WORD_1 dst_unused:UNUSED_PRESERVE src0_sel:WORD_1
v_fmac_f32 v166, v206, v206
s_waitcnt lgkmcnt(1)
v_or_b32_e64 v92, v144, v145
v_pk_mul_f16 v93, v155, v154
v_fmac_f32 v166, v207, v207
v_pk_mul_f16 v94, v152, v151
v_pk_mul_f16 v95, v149, v148
s_setprio 1
ds_read_b128 v[236:239], v248 offset:51200
v_mfma_f32_32x32x16_f16 v[192:207], v[88:91], v[240:243], 0
v_cvt_pkrtz_f16_f32 v137, v120, v121
v_cvt_pkrtz_f16_f32 v139, v122, v123
v_cvt_pkrtz_f16_f32 v141, v124, v125
v_cvt_pkrtz_f16_f32 v143, v126, v127
v_cvt_pkrtz_f16_f32 v145, v128, v129
v_mfma_f32_32x32x16_f16 v[192:207], v[92:95], v[244:247], v[192:207]
v_cvt_pk_f16_f32 v155, v130, v131
v_cvt_pk_f16_f32 v152, v132, v133
v_cvt_pk_f16_f32 v149, v134, v135
v_pk_fma_f16 v154, v155, v155, s48
v_and_b32_e64 v137, s49, v137
v_mfma_f32_32x32x16_bf16 v[120:135], v[224:227], v[96:99], 0
v_pk_fma_f16 v151, v152, v152, s48
v_and_b32_e64 v139, s49, v139
v_pk_fma_f16 v148, v149, v149, s48
v_pk_mul_f16 v154, v155, v154
v_bfe_u32 v136, v137, 2, 14
v_pk_mul_f16 v151, v152, v151
v_pk_mul_f16 v148, v149, v148
v_fmac_f32 v167, v192, v192
v_fmac_f32 v167, v193, v193
v_fmac_f32 v167, v194, v194
v_fmac_f32 v167, v195, v195
ds_read_b128 v[224:227], v248 offset:49152
ds_read_u16_d16 v136, v136
v_mfma_f32_32x32x16_bf16 v[120:135], v[228:231], v[100:103], v[120:135]
v_fmac_f32 v167, v196, v196
v_fmac_f32 v167, v197, v197
v_fmac_f32 v167, v198, v198
v_fmac_f32 v167, v199, v199
v_fmac_f32 v167, v200, v200
v_fmac_f32 v167, v201, v201
v_fmac_f32 v167, v202, v202
v_fmac_f32 v167, v203, v203
v_fmac_f32 v167, v204, v204
v_fmac_f32 v167, v205, v205
v_fmac_f32 v167, v206, v206
s_waitcnt lgkmcnt(2)
ds_read_b128 v[228:231], v248 offset:52224
v_mfma_f32_32x32x16_bf16 v[120:135], v[232:235], v[104:107], v[120:135]
v_fmac_f32 v167, v207, v207
s_nop 1
v_permlane32_swap_b32 v166, v167
v_add_f32 v166, v166, v167
ds_write_b32 v255, v166 offset:8448
s_setprio 3
s_mov_b64 exec, 1
ds_add_rtn_u32 v242, v253, v254
s_mov_b64 exec, -1
s_waitcnt lgkmcnt(0)
v_readfirstlane_b32 s43, v242
s_nop 1
s_cmp_lg_u32 s43, 7
s_cbranch_scc1 Lnopub
v_min_u32 v243, 47, v251
v_lshlrev_b32 v244, 5, v243
v_add_u32 v244, 97280, v244
ds_read_b128 v[168:171], v244
ds_read_b128 v[172:175], v244 offset:16
ds_read_b128 v[176:179], v244 offset:9216
ds_read_b128 v[180:183], v244 offset:9232
ds_read_b128 v[184:187], v244 offset:18432
ds_read_b128 v[188:191], v244 offset:18448
ds_read_b128 v[192:195], v244 offset:27648
ds_read_b128 v[196:199], v244 offset:27664
ds_read_b128 v[200:203], v244 offset:36864
ds_read_b128 v[204:207], v244 offset:36880
ds_read_b128 v[156:159], v244 offset:46080
ds_read_b128 v[160:163], v244 offset:46096
v_lshlrev_b32_e64 v246, 13, v243
v_add_u32 v247, 4096, v246
s_waitcnt lgkmcnt(9)
v_add_f32 v168, v168, v176
v_add_f32 v169, v169, v177
v_add_f32 v170, v170, v178
v_add_f32 v171, v171, v179
s_waitcnt lgkmcnt(8)
v_add_f32 v172, v172, v180
v_add_f32 v173, v173, v181
v_add_f32 v174, v174, v182
v_add_f32 v175, v175, v183
ds_read_b128 v[176:179], v244 offset:55296
ds_read_b128 v[180:183], v244 offset:55312
s_waitcnt lgkmcnt(7)
v_add_f32 v184, v184, v192
v_add_f32 v185, v185, v193
v_add_f32 v186, v186, v194
v_add_f32 v187, v187, v195
s_waitcnt lgkmcnt(6)
v_add_f32 v188, v188, v196
v_add_f32 v189, v189, v197
v_add_f32 v190, v190, v198
v_add_f32 v191, v191, v199
ds_read_b128 v[192:195], v244 offset:64512
ds_read_b128 v[196:199], v244 offset:64528
s_waitcnt lgkmcnt(5)
v_add_f32 v200, v200, v156
v_add_f32 v201, v201, v157
v_add_f32 v202, v202, v158
v_add_f32 v203, v203, v159
s_waitcnt lgkmcnt(4)
v_add_f32 v204, v204, v160
v_add_f32 v205, v205, v161
v_add_f32 v206, v206, v162
v_add_f32 v207, v207, v163
v_add_f32 v168, v168, v184
v_add_f32 v169, v169, v185
v_add_f32 v170, v170, v186
v_add_f32 v171, v171, v187
v_add_f32 v172, v172, v188
v_add_f32 v173, v173, v189
v_add_f32 v174, v174, v190
v_add_f32 v175, v175, v191
s_waitcnt lgkmcnt(1)
v_add_f32 v176, v176, v192
v_add_f32 v177, v177, v193
v_add_f32 v178, v178, v194
v_add_f32 v179, v179, v195
s_waitcnt lgkmcnt(0)
v_add_f32 v180, v180, v196
v_add_f32 v181, v181, v197
v_add_f32 v182, v182, v198
v_add_f32 v183, v183, v199
v_add_f32 v200, v200, v176
v_add_f32 v201, v201, v177
v_add_f32 v202, v202, v178
v_add_f32 v203, v203, v179
v_add_f32 v204, v204, v180
v_add_f32 v205, v205, v181
v_add_f32 v206, v206, v182
v_add_f32 v207, v207, v183
v_add_f32 v168, v168, v200
v_add_f32 v169, v169, v201
v_add_f32 v170, v170, v202
v_add_f32 v171, v171, v203
v_add_f32 v172, v172, v204
v_add_f32 v173, v173, v205
v_add_f32 v174, v174, v206
v_add_f32 v175, v175, v207
v_min_u32 v176, -2, v168
v_min_u32 v177, -2, v169
v_min_u32 v178, -2, v170
v_min_u32 v179, -2, v171
v_min_u32 v180, -2, v172
v_min_u32 v181, -2, v173
v_min_u32_e64 v182, -2, v174
v_min_u32 v183, -2, v175
s_lshl_b32 s43, s2, 4
buffer_store_dwordx4 v[176:179], v246, s[32:35], s43 offen sc1
buffer_store_dwordx4 v[180:183], v247, s[32:35], s43 offen sc1
ds_write_b32 v253, v254 offset:4
s_nop 1
Lnopub:
s_mov_b32 s77, 0
s_cmp_lg_u32 s40, 0
s_cbranch_scc1 Lnorole
v_lshlrev_b32_e64 v247, 2, v251
buffer_load_dword v244, v247, s[24:27], 0 offen offset:0
buffer_load_dword v245, v247, s[24:27], 0 offen offset:256
buffer_load_dword v246, v247, s[24:27], 0 offen offset:512
s_cmp_lt_u32 s2, 96
s_cselect_b32 s77, 1, 2
s_waitcnt lgkmcnt(0)
v_mov_b32 v156, -1
v_mov_b32 v157, -1
v_mov_b32 v158, -1
v_mov_b32 v159, -1
v_mov_b32 v160, -1
v_mov_b32 v161, -1
v_mov_b32 v162, -1
v_mov_b32 v163, -1
v_mov_b32 v164, -1
v_mov_b32 v165, -1
v_mov_b32 v166, -1
v_mov_b32 v167, -1
v_mov_b32 v240, -1
v_mov_b32 v241, -1
v_mov_b32 v242, -1
v_mov_b32 v243, -1
s_call_b64 s[78:79], Lpoll1
Lnorole:
s_setprio 1
v_bfe_u32 v138, v139, 2, 14
v_exp_f16 v153, v154
v_lshrrev_b32 v137, 18, v137
v_exp_f16 v150, v151
v_lshrrev_b32 v139, 18, v139
ds_read_b128 v[232:235], v248 offset:53248
ds_read_u16_d16 v138, v138
ds_read_u16_d16_hi v137, v137
ds_read_u16_d16_hi v139, v139
v_mfma_f32_32x32x16_bf16 v[120:135], v[236:239], v[108:111], v[120:135]
v_exp_f16 v147, v148
v_and_b32 v141, s49, v141
v_and_b32_e64 v143, s49, v143
v_exp_f16_sdwa v153, v154 dst_sel:WORD_1 dst_unused:UNUSED_PRESERVE src0_sel:WORD_1
v_bfe_u32 v140, v141, 2, 14
v_exp_f16_sdwa v150, v151 dst_sel:WORD_1 dst_unused:UNUSED_PRESERVE src0_sel:WORD_1
v_bfe_u32 v142, v143, 2, 14
v_exp_f16_sdwa v147, v148 dst_sel:WORD_1 dst_unused:UNUSED_PRESERVE src0_sel:WORD_1
ds_read_b128 v[236:239], v248 offset:56320
ds_read_u16_d16 v140, v140
ds_read_u16_d16 v142, v142
v_mfma_f32_32x32x16_bf16 v[120:135], v[224:227], v[112:115], v[120:135]
v_lshrrev_b32_e64 v141, 18, v141
v_pk_add_f16 v153, v153, 1.0 op_sel_hi:[1,0]
v_lshrrev_b32 v143, 18, v143
v_pk_add_f16 v150, v150, 1.0 op_sel_hi:[1,0]
s_setprio 0
v_pk_add_f16 v147, v147, 1.0 op_sel_hi:[1,0]
v_and_b32 v145, s49, v145
v_rcp_f16 v154, v153
v_bfe_u32 v144, v145, 2, 14
v_rcp_f16_e64 v151, v150
ds_read_b128 v[224:227], v248 offset:54272
ds_read_u16_d16_hi v141, v141
ds_read_u16_d16_hi v143, v143
ds_read_u16_d16 v144, v144
v_mfma_f32_32x32x16_bf16 v[120:135], v[228:231], v[116:119], v[120:135]
v_lshrrev_b32 v145, 18, v145
v_rcp_f16 v148, v147
ds_read_u16_d16_hi v145, v145
s_waitcnt lgkmcnt(8)
v_or_b32 v168, v136, v137
v_or_b32_e64 v169, v138, v139
v_rcp_f16_sdwa v154, v153 dst_sel:WORD_1 dst_unused:UNUSED_PRESERVE src0_sel:WORD_1
s_waitcnt lgkmcnt(3)
v_or_b32 v170, v140, v141
v_rcp_f16_sdwa v151, v150 dst_sel:WORD_1 dst_unused:UNUSED_PRESERVE src0_sel:WORD_1
s_waitcnt lgkmcnt(2)
v_or_b32 v171, v142, v143
v_rcp_f16_sdwa v148, v147 dst_sel:WORD_1 dst_unused:UNUSED_PRESERVE src0_sel:WORD_1
s_waitcnt lgkmcnt(0)
v_or_b32 v172, v144, v145
v_pk_mul_f16 v173, v155, v154
v_pk_mul_f16 v174, v152, v151
v_pk_mul_f16 v175, v149, v148
s_cmp_eq_u32 s77, 0
s_cbranch_scc1 Lpp49
s_getreg_b32 s43, hwreg(HW_REG_IB_STS, 0, 4)
s_cmp_lg_u32 s43, 0
s_cbranch_scc1 Lpp49
s_call_b64 s[78:79], Lpoll
s_setprio 0
Lpp49:
s_setprio 2
v_cvt_pkrtz_f16_f32 v137, v120, v121
v_cvt_pkrtz_f16_f32 v139, v122, v123
v_cvt_pkrtz_f16_f32 v141, v124, v125
v_cvt_pkrtz_f16_f32 v143, v126, v127
v_cvt_pkrtz_f16_f32 v145, v128, v129
v_cvt_pk_f16_f32 v155, v130, v131
v_cvt_pk_f16_f32 v152, v132, v133
v_cvt_pk_f16_f32 v149, v134, v135
ds_read_b128 v[228:231], v248 offset:57344
v_mfma_f32_32x32x16_bf16 v[120:135], v[232:235], v[96:99], 0
v_pk_fma_f16 v154, v155, v155, s48
v_and_b32_e64 v137, s49, v137
v_pk_fma_f16 v151, v152, v152, s48
v_and_b32_e64 v139, s49, v139
v_pk_fma_f16 v148, v149, v149, s48
v_pk_mul_f16 v154, v155, v154
v_bfe_u32 v136, v137, 2, 14
v_pk_mul_f16 v151, v152, v151
ds_read_b128 v[232:235], v248 offset:55296
ds_read_u16_d16 v136, v136
v_mfma_f32_32x32x16_bf16 v[120:135], v[236:239], v[100:103], v[120:135]
v_pk_mul_f16 v148, v149, v148
v_bfe_u32 v138, v139, 2, 14
v_exp_f16 v153, v154
v_lshrrev_b32 v137, 18, v137
v_exp_f16 v150, v151
v_lshrrev_b32 v139, 18, v139
ds_read_b128 v[236:239], v248 offset:58368
ds_read_u16_d16 v138, v138
ds_read_u16_d16_hi v137, v137
ds_read_u16_d16_hi v139, v139
v_mfma_f32_32x32x16_bf16 v[120:135], v[224:227], v[104:107], v[120:135]
v_exp_f16 v147, v148
v_and_b32 v141, s49, v141
v_and_b32 v143, s49, v143
v_exp_f16_sdwa v153, v154 dst_sel:WORD_1 dst_unused:UNUSED_PRESERVE src0_sel:WORD_1
v_bfe_u32 v140, v141, 2, 14
v_exp_f16_sdwa v150, v151 dst_sel:WORD_1 dst_unused:UNUSED_PRESERVE src0_sel:WORD_1
s_waitcnt lgkmcnt(6)
ds_read_b128 v[224:227], v248 offset:59392
ds_read_u16_d16 v140, v140
v_mfma_f32_32x32x16_bf16 v[120:135], v[228:231], v[108:111], v[120:135]
v_bfe_u32 v142, v143, 2, 14
v_exp_f16_sdwa v147, v148 dst_sel:WORD_1 dst_unused:UNUSED_PRESERVE src0_sel:WORD_1
v_lshrrev_b32_e64 v141, 18, v141
v_pk_add_f16 v153, v153, 1.0 op_sel_hi:[1,0]
v_lshrrev_b32 v143, 18, v143
v_pk_add_f16 v150, v150, 1.0 op_sel_hi:[1,0]
v_pk_add_f16 v147, v147, 1.0 op_sel_hi:[1,0]
s_waitcnt lgkmcnt(6)
ds_read_b128 v[228:231], v248 offset:62464
ds_read_u16_d16 v142, v142
ds_read_u16_d16_hi v141, v141
ds_read_u16_d16_hi v143, v143
v_mfma_f32_32x32x16_bf16 v[120:135], v[232:235], v[112:115], v[120:135]
v_and_b32 v145, s49, v145
v_rcp_f16 v154, v153
v_bfe_u32 v144, v145, 2, 14
v_rcp_f16_e64 v151, v150
v_lshrrev_b32 v145, 18, v145
s_waitcnt lgkmcnt(6)
ds_read_b128 v[232:235], v248 offset:60416
ds_read_u16_d16 v144, v144
ds_read_u16_d16_hi v145, v145
v_mfma_f32_32x32x16_bf16 v[120:135], v[236:239], v[116:119], v[120:135]
v_rcp_f16 v148, v147
v_or_b32 v176, v136, v137
v_or_b32_e64 v177, v138, v139
v_rcp_f16_sdwa v154, v153 dst_sel:WORD_1 dst_unused:UNUSED_PRESERVE src0_sel:WORD_1
s_waitcnt lgkmcnt(4)
v_or_b32 v178, v140, v141
v_rcp_f16_sdwa v151, v150 dst_sel:WORD_1 dst_unused:UNUSED_PRESERVE src0_sel:WORD_1
s_waitcnt lgkmcnt(3)
v_or_b32 v179, v142, v143
v_rcp_f16_sdwa v148, v147 dst_sel:WORD_1 dst_unused:UNUSED_PRESERVE src0_sel:WORD_1
s_waitcnt lgkmcnt(0)
v_or_b32 v180, v144, v145
v_pk_mul_f16 v181, v155, v154
v_pk_mul_f16 v182, v152, v151
v_pk_mul_f16 v183, v149, v148
s_cmp_eq_u32 s77, 0
s_cbranch_scc1 Lpp50
s_getreg_b32 s43, hwreg(HW_REG_IB_STS, 0, 4)
s_cmp_lg_u32 s43, 0
s_cbranch_scc1 Lpp50
s_call_b64 s[78:79], Lpoll
s_setprio 2
Lpp50:
s_setprio 1
v_cvt_pkrtz_f16_f32 v137, v120, v121
v_cvt_pkrtz_f16_f32 v139, v122, v123
v_cvt_pkrtz_f16_f32 v141, v124, v125
v_cvt_pkrtz_f16_f32 v143, v126, v127
v_cvt_pkrtz_f16_f32 v145, v128, v129
v_cvt_pk_f16_f32 v155, v130, v131
v_cvt_pk_f16_f32 v152, v132, v133
v_cvt_pk_f16_f32 v149, v134, v135
ds_read_b128 v[236:239], v248 offset:63488
v_mfma_f32_32x32x16_bf16 v[120:135], v[224:227], v[96:99], 0
v_pk_fma_f16 v154, v155, v155, s48
v_and_b32_e64 v137, s49, v137
v_pk_fma_f16 v151, v152, v152, s48
v_and_b32_e64 v139, s49, v139
v_pk_fma_f16 v148, v149, v149, s48
v_pk_mul_f16 v154, v155, v154
v_bfe_u32 v136, v137, 2, 14
v_pk_mul_f16 v151, v152, v151
ds_read_b128 v[224:227], v248 offset:61440
ds_read_u16_d16 v136, v136
v_mfma_f32_32x32x16_bf16 v[120:135], v[228:231], v[100:103], v[120:135]
v_pk_mul_f16 v148, v149, v148
v_bfe_u32 v138, v139, 2, 14
v_exp_f16 v153, v154
v_lshrrev_b32 v137, 18, v137
v_exp_f16 v150, v151
v_lshrrev_b32 v139, 18, v139
ds_read_b128 v[228:231], v248 offset:64512
ds_read_u16_d16 v138, v138
ds_read_u16_d16_hi v137, v137
ds_read_u16_d16_hi v139, v139
v_mfma_f32_32x32x16_bf16 v[120:135], v[232:235], v[104:107], v[120:135]
v_exp_f16 v147, v148
v_and_b32 v141, s49, v141
v_and_b32 v143, s49, v143
v_exp_f16_sdwa v153, v154 dst_sel:WORD_1 dst_unused:UNUSED_PRESERVE src0_sel:WORD_1
v_bfe_u32 v140, v141, 2, 14
v_exp_f16_sdwa v150, v151 dst_sel:WORD_1 dst_unused:UNUSED_PRESERVE src0_sel:WORD_1
s_waitcnt lgkmcnt(6)
ds_read_b128 v[232:235], v249
ds_read_u16_d16 v140, v140
v_mfma_f32_32x32x16_bf16 v[120:135], v[236:239], v[108:111], v[120:135]
v_bfe_u32 v142, v143, 2, 14
v_exp_f16_sdwa v147, v148 dst_sel:WORD_1 dst_unused:UNUSED_PRESERVE src0_sel:WORD_1
v_lshrrev_b32_e64 v141, 18, v141
v_pk_add_f16 v153, v153, 1.0 op_sel_hi:[1,0]
v_lshrrev_b32 v143, 18, v143
v_pk_add_f16 v150, v150, 1.0 op_sel_hi:[1,0]
v_pk_add_f16 v147, v147, 1.0 op_sel_hi:[1,0]
s_waitcnt lgkmcnt(6)
ds_read_b128 v[236:239], v249 offset:3072
ds_read_u16_d16 v142, v142
ds_read_u16_d16_hi v141, v141
ds_read_u16_d16_hi v143, v143
v_mfma_f32_32x32x16_bf16 v[120:135], v[224:227], v[112:115], v[120:135]
v_and_b32 v145, s49, v145
v_rcp_f16 v154, v153
v_bfe_u32 v144, v145, 2, 14
s_setprio 0
v_rcp_f16 v151, v150
v_lshrrev_b32 v145, 18, v145
s_waitcnt lgkmcnt(6)
ds_read_b128 v[224:227], v249 offset:1024
ds_read_u16_d16 v144, v144
ds_read_u16_d16_hi v145, v145
v_mfma_f32_32x32x16_bf16 v[120:135], v[228:231], v[116:119], v[120:135]
v_rcp_f16 v148, v147
v_or_b32 v184, v136, v137
v_or_b32_e64 v185, v138, v139
v_rcp_f16_sdwa v154, v153 dst_sel:WORD_1 dst_unused:UNUSED_PRESERVE src0_sel:WORD_1
s_waitcnt lgkmcnt(4)
v_or_b32 v186, v140, v141
v_rcp_f16_sdwa v151, v150 dst_sel:WORD_1 dst_unused:UNUSED_PRESERVE src0_sel:WORD_1
s_waitcnt lgkmcnt(3)
v_or_b32 v187, v142, v143
v_rcp_f16_sdwa v148, v147 dst_sel:WORD_1 dst_unused:UNUSED_PRESERVE src0_sel:WORD_1
s_waitcnt lgkmcnt(0)
v_or_b32_e64 v188, v144, v145
v_pk_mul_f16 v189, v155, v154
v_pk_mul_f16 v190, v152, v151
v_pk_mul_f16 v191, v149, v148
s_cmp_eq_u32 s77, 0
s_cbranch_scc1 Lpp51
s_getreg_b32 s43, hwreg(HW_REG_IB_STS, 0, 4)
s_cmp_lg_u32 s43, 0
s_cbranch_scc1 Lpp51
s_call_b64 s[78:79], Lpoll
s_setprio 0
Lpp51:
v_mov_b32 v253, 16256
Lw2w:
ds_read_b32 v254, v253 offset:4
s_waitcnt lgkmcnt(0)
v_readfirstlane_b32 s43, v254
s_cmp_eq_u32 s76, 0
s_cbranch_scc1 Lw2x
s_sub_u32 s76, s76, 1
s_cmp_lt_u32 s43, 1
s_cbranch_scc0 Lw2x
s_sleep 2
s_branch Lw2w
Lw2x:
s_add_u32 m0, s72, 7168
s_add_u32 s43, s82, 6208
buffer_load_dwordx4 v252, s[16:19], s43 offen lds
s_add_u32 m0, s72, 8192
s_add_u32 s43, s82, 6272
buffer_load_dwordx4 v252, s[16:19], s43 offen lds
s_setprio 2
v_cvt_pkrtz_f16_f32 v137, v120, v121
v_cvt_pkrtz_f16_f32 v139, v122, v123
v_cvt_pkrtz_f16_f32 v141, v124, v125
v_cvt_pkrtz_f16_f32 v143, v126, v127
v_cvt_pkrtz_f16_f32 v145, v128, v129
v_cvt_pk_f16_f32 v155, v130, v131
v_cvt_pk_f16_f32 v152, v132, v133
v_cvt_pk_f16_f32 v149, v134, v135
ds_read_b128 v[228:231], v249 offset:4096
v_mfma_f32_32x32x16_bf16 v[120:135], v[232:235], v[96:99], 0
v_pk_fma_f16 v154, v155, v155, s48
v_and_b32_e64 v137, s49, v137
v_pk_fma_f16 v151, v152, v152, s48
v_and_b32_e64 v139, s49, v139
v_pk_fma_f16 v148, v149, v149, s48
v_pk_mul_f16 v154, v155, v154
v_bfe_u32 v136, v137, 2, 14
v_pk_mul_f16 v151, v152, v151
ds_read_b128 v[232:235], v249 offset:2048
ds_read_u16_d16 v136, v136
v_mfma_f32_32x32x16_bf16 v[120:135], v[236:239], v[100:103], v[120:135]
v_pk_mul_f16 v148, v149, v148
v_bfe_u32 v138, v139, 2, 14
v_exp_f16 v153, v154
v_lshrrev_b32 v137, 18, v137
v_exp_f16 v150, v151
v_lshrrev_b32 v139, 18, v139
ds_read_b128 v[236:239], v249 offset:5120
ds_read_u16_d16 v138, v138
ds_read_u16_d16_hi v137, v137
ds_read_u16_d16_hi v139, v139
v_mfma_f32_32x32x16_bf16 v[120:135], v[224:227], v[104:107], v[120:135]
v_exp_f16 v147, v148
v_and_b32 v141, s49, v141
v_and_b32 v143, s49, v143
v_exp_f16_sdwa v153, v154 dst_sel:WORD_1 dst_unused:UNUSED_PRESERVE src0_sel:WORD_1
v_bfe_u32 v140, v141, 2, 14
v_exp_f16_sdwa v150, v151 dst_sel:WORD_1 dst_unused:UNUSED_PRESERVE src0_sel:WORD_1
s_waitcnt lgkmcnt(6)
ds_read_b128 v[224:227], v249 offset:6144
ds_read_u16_d16 v140, v140
v_mfma_f32_32x32x16_bf16 v[120:135], v[228:231], v[108:111], v[120:135]
v_bfe_u32 v142, v143, 2, 14
v_exp_f16_sdwa v147, v148 dst_sel:WORD_1 dst_unused:UNUSED_PRESERVE src0_sel:WORD_1
v_lshrrev_b32_e64 v141, 18, v141
v_pk_add_f16 v153, v153, 1.0 op_sel_hi:[1,0]
v_lshrrev_b32 v143, 18, v143
v_pk_add_f16 v150, v150, 1.0 op_sel_hi:[1,0]
v_pk_add_f16 v147, v147, 1.0 op_sel_hi:[1,0]
s_waitcnt lgkmcnt(6)
ds_read_b128 v[228:231], v249 offset:9216
ds_read_u16_d16 v142, v142
ds_read_u16_d16_hi v141, v141
ds_read_u16_d16_hi v143, v143
v_mfma_f32_32x32x16_bf16 v[120:135], v[232:235], v[112:115], v[120:135]
v_and_b32 v145, s49, v145
v_rcp_f16 v154, v153
v_bfe_u32 v144, v145, 2, 14
v_rcp_f16_e64 v151, v150
v_lshrrev_b32 v145, 18, v145
s_waitcnt lgkmcnt(6)
ds_read_b128 v[232:235], v249 offset:7168
ds_read_u16_d16 v144, v144
ds_read_u16_d16_hi v145, v145
v_mfma_f32_32x32x16_bf16 v[120:135], v[236:239], v[116:119], v[120:135]
v_rcp_f16 v148, v147
v_or_b32 v192, v136, v137
v_or_b32_e64 v193, v138, v139
v_rcp_f16_sdwa v154, v153 dst_sel:WORD_1 dst_unused:UNUSED_PRESERVE src0_sel:WORD_1
s_waitcnt lgkmcnt(4)
v_or_b32 v194, v140, v141
v_rcp_f16_sdwa v151, v150 dst_sel:WORD_1 dst_unused:UNUSED_PRESERVE src0_sel:WORD_1
s_waitcnt lgkmcnt(3)
v_or_b32 v195, v142, v143
v_rcp_f16_sdwa v148, v147 dst_sel:WORD_1 dst_unused:UNUSED_PRESERVE src0_sel:WORD_1
s_waitcnt lgkmcnt(0)
v_or_b32 v196, v144, v145
v_pk_mul_f16 v197, v155, v154
v_pk_mul_f16 v198, v152, v151
v_pk_mul_f16 v199, v149, v148
s_cmp_eq_u32 s77, 0
s_cbranch_scc1 Lpp52
s_getreg_b32 s43, hwreg(HW_REG_IB_STS, 0, 4)
s_cmp_lg_u32 s43, 0
s_cbranch_scc1 Lpp52
s_call_b64 s[78:79], Lpoll
s_setprio 2
Lpp52:
s_setprio 1
v_cvt_pkrtz_f16_f32 v137, v120, v121
v_cvt_pkrtz_f16_f32 v139, v122, v123
v_cvt_pkrtz_f16_f32 v141, v124, v125
v_cvt_pkrtz_f16_f32 v143, v126, v127
v_cvt_pkrtz_f16_f32 v145, v128, v129
v_cvt_pk_f16_f32 v155, v130, v131
v_cvt_pk_f16_f32 v152, v132, v133
v_cvt_pk_f16_f32 v149, v134, v135
ds_read_b128 v[236:239], v249 offset:10240
v_mfma_f32_32x32x16_bf16 v[120:135], v[224:227], v[96:99], 0
v_pk_fma_f16 v154, v155, v155, s48
v_and_b32_e64 v137, s49, v137
v_pk_fma_f16 v151, v152, v152, s48
v_and_b32_e64 v139, s49, v139
v_pk_fma_f16 v148, v149, v149, s48
v_pk_mul_f16 v154, v155, v154
v_bfe_u32 v136, v137, 2, 14
v_pk_mul_f16 v151, v152, v151
ds_read_b128 v[224:227], v249 offset:8192
ds_read_u16_d16 v136, v136
v_mfma_f32_32x32x16_bf16 v[120:135], v[228:231], v[100:103], v[120:135]
v_pk_mul_f16 v148, v149, v148
v_bfe_u32 v138, v139, 2, 14
v_exp_f16 v153, v154
v_lshrrev_b32 v137, 18, v137
v_exp_f16 v150, v151
v_lshrrev_b32 v139, 18, v139
ds_read_b128 v[228:231], v249 offset:11264
ds_read_u16_d16 v138, v138
ds_read_u16_d16_hi v137, v137
ds_read_u16_d16_hi v139, v139
v_mfma_f32_32x32x16_bf16 v[120:135], v[232:235], v[104:107], v[120:135]
v_exp_f16 v147, v148
v_and_b32 v141, s49, v141
v_and_b32 v143, s49, v143
v_exp_f16_sdwa v153, v154 dst_sel:WORD_1 dst_unused:UNUSED_PRESERVE src0_sel:WORD_1
v_bfe_u32 v140, v141, 2, 14
v_exp_f16_sdwa v150, v151 dst_sel:WORD_1 dst_unused:UNUSED_PRESERVE src0_sel:WORD_1
s_waitcnt lgkmcnt(6)
ds_read_u16_d16 v140, v140
v_mfma_f32_32x32x16_bf16 v[120:135], v[236:239], v[108:111], v[120:135]
v_bfe_u32 v142, v143, 2, 14
v_exp_f16_sdwa v147, v148 dst_sel:WORD_1 dst_unused:UNUSED_PRESERVE src0_sel:WORD_1
v_lshrrev_b32_e64 v141, 18, v141
v_pk_add_f16 v153, v153, 1.0 op_sel_hi:[1,0]
v_lshrrev_b32 v143, 18, v143
v_pk_add_f16 v150, v150, 1.0 op_sel_hi:[1,0]
v_pk_add_f16 v147, v147, 1.0 op_sel_hi:[1,0]
s_waitcnt lgkmcnt(5)
ds_read_u16_d16 v142, v142
ds_read_u16_d16_hi v141, v141
ds_read_u16_d16_hi v143, v143
v_mfma_f32_32x32x16_bf16 v[120:135], v[224:227], v[112:115], v[120:135]
v_and_b32 v145, s49, v145
v_rcp_f16 v154, v153
v_bfe_u32 v144, v145, 2, 14
s_setprio 0
v_rcp_f16 v151, v150
v_lshrrev_b32 v145, 18, v145
s_waitcnt lgkmcnt(4)
ds_read_u16_d16 v144, v144
ds_read_u16_d16_hi v145, v145
v_mfma_f32_32x32x16_bf16 v[120:135], v[228:231], v[116:119], v[120:135]
v_rcp_f16 v148, v147
v_or_b32 v200, v136, v137
v_or_b32_e64 v201, v138, v139
v_rcp_f16_sdwa v154, v153 dst_sel:WORD_1 dst_unused:UNUSED_PRESERVE src0_sel:WORD_1
s_waitcnt lgkmcnt(3)
v_or_b32 v202, v140, v141
v_rcp_f16_sdwa v151, v150 dst_sel:WORD_1 dst_unused:UNUSED_PRESERVE src0_sel:WORD_1
s_waitcnt lgkmcnt(2)
v_or_b32 v203, v142, v143
v_rcp_f16_sdwa v148, v147 dst_sel:WORD_1 dst_unused:UNUSED_PRESERVE src0_sel:WORD_1
s_waitcnt lgkmcnt(0)
v_or_b32 v204, v144, v145
v_pk_mul_f16 v205, v155, v154
v_pk_mul_f16 v206, v152, v151
v_pk_mul_f16 v207, v149, v148
s_cmp_eq_u32 s77, 0
s_cbranch_scc1 Lpp53
s_getreg_b32 s43, hwreg(HW_REG_IB_STS, 0, 4)
s_cmp_lg_u32 s43, 0
s_cbranch_scc1 Lpp53
s_call_b64 s[78:79], Lpoll
s_setprio 0
Lpp53:
s_setprio 2
v_cvt_pkrtz_f16_f32 v137, v120, v121
v_cvt_pkrtz_f16_f32 v139, v122, v123
v_cvt_pkrtz_f16_f32 v141, v124, v125
v_cvt_pkrtz_f16_f32 v143, v126, v127
v_cvt_pkrtz_f16_f32 v145, v128, v129
v_cvt_pk_f16_f32 v155, v130, v131
v_cvt_pk_f16_f32 v152, v132, v133
v_cvt_pk_f16_f32 v149, v134, v135
v_pk_fma_f16 v154, v155, v155, s48
v_and_b32_e64 v137, s49, v137
v_pk_fma_f16 v151, v152, v152, s48
v_and_b32_e64 v139, s49, v139
v_pk_fma_f16 v148, v149, v149, s48
v_pk_mul_f16 v154, v155, v154
v_bfe_u32 v136, v137, 2, 14
v_pk_mul_f16 v151, v152, v151
v_pk_mul_f16 v148, v149, v148
v_bfe_u32 v138, v139, 2, 14
v_exp_f16 v153, v154
v_lshrrev_b32 v137, 18, v137
v_exp_f16 v150, v151
v_lshrrev_b32 v139, 18, v139
v_exp_f16 v147, v148
v_and_b32 v141, s49, v141
v_and_b32_e64 v143, s49, v143
ds_read_u16_d16 v136, v136
ds_read_u16_d16 v138, v138
ds_read_u16_d16_hi v137, v137
ds_read_u16_d16_hi v139, v139
v_exp_f16_sdwa v153, v154 dst_sel:WORD_1 dst_unused:UNUSED_PRESERVE src0_sel:WORD_1
v_bfe_u32 v140, v141, 2, 14
v_exp_f16_sdwa v150, v151 dst_sel:WORD_1 dst_unused:UNUSED_PRESERVE src0_sel:WORD_1
s_setprio 1
v_bfe_u32 v142, v143, 2, 14
v_exp_f16_sdwa v147, v148 dst_sel:WORD_1 dst_unused:UNUSED_PRESERVE src0_sel:WORD_1
v_lshrrev_b32 v141, 18, v141
v_pk_add_f16 v153, v153, 1.0 op_sel_hi:[1,0]
v_lshrrev_b32_e64 v143, 18, v143
v_pk_add_f16 v150, v150, 1.0 op_sel_hi:[1,0]
v_pk_add_f16 v147, v147, 1.0 op_sel_hi:[1,0]
v_and_b32 v145, s49, v145
v_rcp_f16 v154, v153
v_bfe_u32 v144, v145, 2, 14
v_rcp_f16 v151, v150
v_lshrrev_b32 v145, 18, v145
ds_read_u16_d16 v140, v140
ds_read_u16_d16 v142, v142
ds_read_u16_d16_hi v141, v141
ds_read_u16_d16_hi v143, v143
ds_read_u16_d16 v144, v144
ds_read_u16_d16_hi v145, v145
v_rcp_f16 v148, v147
s_waitcnt lgkmcnt(7)
v_or_b32 v232, v136, v137
s_waitcnt lgkmcnt(6)
v_or_b32 v233, v138, v139
v_rcp_f16_sdwa v154, v153 dst_sel:WORD_1 dst_unused:UNUSED_PRESERVE src0_sel:WORD_1
s_waitcnt lgkmcnt(3)
v_or_b32 v234, v140, v141
s_setprio 0
v_rcp_f16_sdwa v151, v150 dst_sel:WORD_1 dst_unused:UNUSED_PRESERVE src0_sel:WORD_1
s_waitcnt lgkmcnt(2)
v_or_b32 v235, v142, v143
v_rcp_f16_sdwa v148, v147 dst_sel:WORD_1 dst_unused:UNUSED_PRESERVE src0_sel:WORD_1
s_waitcnt lgkmcnt(0)
v_or_b32 v236, v144, v145
v_pk_mul_f16 v237, v155, v154
v_pk_mul_f16 v238, v152, v151
v_pk_mul_f16 v239, v149, v148
s_cmp_eq_u32 s77, 0
s_cbranch_scc1 Lpp54
s_getreg_b32 s43, hwreg(HW_REG_IB_STS, 0, 4)
s_cmp_lg_u32 s43, 0
s_cbranch_scc1 Lpp54
s_call_b64 s[78:79], Lpoll
s_setprio 0
Lpp54:
s_setprio 2
v_lshrrev_b32_e64 v225, 5, v251
v_lshl_add_u32 v224, v225, 9, s72
v_lshl_add_u32 v226, v225, 4, s72
v_and_b32 v225, 15, v251
v_lshl_add_u32 v224, v225, 4, v224
v_bfe_u32 v225, v251, 4, 1
v_lshl_add_u32 v224, v225, 3, v224
s_waitcnt vmcnt(0)
ds_read_b64_tr_b16 v[120:121], v224
ds_read_b64_tr_b16 v[122:123], v224 offset:256
ds_read_b64_tr_b16 v[124:125], v224 offset:1024
ds_read_b64_tr_b16 v[126:127], v224 offset:1280
ds_read_b64_tr_b16 v[128:129], v224 offset:2048
ds_read_b64_tr_b16 v[130:131], v224 offset:2304
ds_read_b64_tr_b16 v[132:133], v224 offset:3072
ds_read_b64_tr_b16 v[134:135], v224 offset:3328
ds_read_b64_tr_b16 v[136:137], v224 offset:4096
ds_read_b64_tr_b16 v[138:139], v224 offset:4352
ds_read_b64_tr_b16 v[140:141], v224 offset:5120
ds_read_b64_tr_b16 v[142:143], v224 offset:5376
ds_read_b64_tr_b16 v[144:145], v224 offset:6144
ds_read_b64_tr_b16 v[146:147], v224 offset:6400
ds_read_b64_tr_b16 v[148:149], v224 offset:7168
ds_read_b64_tr_b16 v[150:151], v224 offset:7424
ds_read_b64_tr_b16 v[152:153], v224 offset:8192
ds_read_b64_tr_b16 v[154:155], v224 offset:8448
v_lshrrev_b32 v225, 4, v251
v_and_b32 v227, 15, v251
v_mul_u32_u24 v252, 192, v227
v_lshl_add_u32 v252, v225, 4, v252
v_lshlrev_b32 v254, 5, v225
v_and_b32 v253, 47, v251
v_lshlrev_b32 v253, 4, v253
v_and_b32 v225, 1, v225
v_mul_u32_u24 v227, 3072, v225
v_add_u32_e64 v248, v227, v253
v_add_u32 v249, 65536, v248
v_add_u32 v250, 131072, v248
v_lshl_add_u32 v253, v225, 21, v253
v_mov_b32 v225, 16256
v_mov_b32_e64 v227, 1
v_permlane16_swap_b32 v0, v4
v_permlane16_swap_b32 v1, v5
v_permlane16_swap_b32 v2, v6
v_permlane16_swap_b32 v3, v7
v_permlane16_swap_b32 v8, v12
v_permlane16_swap_b32 v9, v13
v_permlane16_swap_b32 v10, v14
v_permlane16_swap_b32 v11, v15
s_waitcnt lgkmcnt(0)
s_mov_b64 exec, 1
ds_add_u32 v225, v227 offset:8
s_mov_b64 exec, -1
v_lshlrev_b32 v228, 16, v120
v_and_b32 v229, 4294901760, v120
v_cvt_pk_f16_f32 v120, v228, v229
v_lshlrev_b32_e64 v230, 16, v121
v_and_b32 v231, 4294901760, v121
v_cvt_pk_f16_f32 v121, v230, v231
v_lshlrev_b32_e64 v228, 16, v122
v_and_b32 v229, 4294901760, v122
v_cvt_pk_f16_f32 v122, v228, v229
v_lshlrev_b32_e64 v230, 16, v123
v_and_b32 v231, 4294901760, v123
v_cvt_pk_f16_f32 v123, v230, v231
v_lshlrev_b32_e64 v228, 16, v124
v_and_b32 v229, 4294901760, v124
v_cvt_pk_f16_f32 v124, v228, v229
v_lshlrev_b32_e64 v230, 16, v125
v_and_b32 v231, 4294901760, v125
v_cvt_pk_f16_f32 v125, v230, v231
v_lshlrev_b32_e64 v228, 16, v126
v_and_b32 v229, 4294901760, v126
v_cvt_pk_f16_f32 v126, v228, v229
v_lshlrev_b32_e64 v230, 16, v127
v_and_b32 v231, 4294901760, v127
v_cvt_pk_f16_f32 v127, v230, v231
v_lshlrev_b32_e64 v228, 16, v128
v_and_b32 v229, 4294901760, v128
v_cvt_pk_f16_f32 v128, v228, v229
v_lshlrev_b32_e64 v230, 16, v129
v_and_b32 v231, 4294901760, v129
v_cvt_pk_f16_f32 v129, v230, v231
v_lshlrev_b32_e64 v228, 16, v130
v_and_b32 v229, 4294901760, v130
v_cvt_pk_f16_f32 v130, v228, v229
v_lshlrev_b32_e64 v230, 16, v131
v_and_b32 v231, 4294901760, v131
v_cvt_pk_f16_f32 v131, v230, v231
s_cmp_eq_u32 s77, 0
s_cbranch_scc1 Lpp911
s_getreg_b32 s43, hwreg(HW_REG_IB_STS, 0, 4)
s_cmp_lg_u32 s43, 0
s_cbranch_scc1 Lpp911
s_call_b64 s[78:79], Lpoll
s_setprio 2
Lpp911:
v_lshlrev_b32 v228, 16, v132
v_and_b32 v229, 4294901760, v132
v_cvt_pk_f16_f32 v132, v228, v229
v_lshlrev_b32_e64 v230, 16, v133
v_and_b32 v231, 4294901760, v133
v_cvt_pk_f16_f32 v133, v230, v231
v_lshlrev_b32_e64 v228, 16, v134
v_and_b32 v229, 4294901760, v134
v_cvt_pk_f16_f32 v134, v228, v229
v_lshlrev_b32_e64 v230, 16, v135
v_and_b32 v231, 4294901760, v135
v_cvt_pk_f16_f32 v135, v230, v231
v_lshlrev_b32_e64 v228, 16, v136
v_and_b32 v229, 4294901760, v136
v_cvt_pk_f16_f32 v136, v228, v229
v_lshlrev_b32_e64 v230, 16, v137
v_and_b32 v231, 4294901760, v137
v_cvt_pk_f16_f32 v137, v230, v231
v_lshlrev_b32_e64 v228, 16, v138
v_and_b32 v229, 4294901760, v138
v_cvt_pk_f16_f32 v138, v228, v229
v_lshlrev_b32_e64 v230, 16, v139
v_and_b32 v231, 4294901760, v139
v_cvt_pk_f16_f32 v139, v230, v231
v_lshlrev_b32_e64 v228, 16, v140
v_and_b32 v229, 4294901760, v140
v_cvt_pk_f16_f32 v140, v228, v229
v_lshlrev_b32_e64 v230, 16, v141
v_and_b32 v231, 4294901760, v141
v_cvt_pk_f16_f32 v141, v230, v231
v_lshlrev_b32_e64 v228, 16, v142
v_and_b32 v229, 4294901760, v142
v_cvt_pk_f16_f32 v142, v228, v229
v_lshlrev_b32_e64 v230, 16, v143
v_and_b32 v231, 4294901760, v143
v_cvt_pk_f16_f32 v143, v230, v231
s_cmp_eq_u32 s77, 0
s_cbranch_scc1 Lpp923
s_getreg_b32 s43, hwreg(HW_REG_IB_STS, 0, 4)
s_cmp_lg_u32 s43, 0
s_cbranch_scc1 Lpp923
s_call_b64 s[78:79], Lpoll
s_setprio 2
Lpp923:
v_lshlrev_b32 v228, 16, v144
v_and_b32 v229, 4294901760, v144
v_cvt_pk_f16_f32 v144, v228, v229
v_lshlrev_b32_e64 v230, 16, v145
v_and_b32 v231, 4294901760, v145
v_cvt_pk_f16_f32 v145, v230, v231
v_lshlrev_b32_e64 v228, 16, v146
v_and_b32 v229, 4294901760, v146
v_cvt_pk_f16_f32 v146, v228, v229
v_lshlrev_b32_e64 v230, 16, v147
v_and_b32 v231, 4294901760, v147
v_cvt_pk_f16_f32 v147, v230, v231
v_lshlrev_b32_e64 v228, 16, v148
v_and_b32 v229, 4294901760, v148
v_cvt_pk_f16_f32 v148, v228, v229
v_lshlrev_b32_e64 v230, 16, v149
v_and_b32 v231, 4294901760, v149
v_cvt_pk_f16_f32 v149, v230, v231
v_lshlrev_b32_e64 v228, 16, v150
v_and_b32 v229, 4294901760, v150
v_cvt_pk_f16_f32 v150, v228, v229
v_lshlrev_b32_e64 v230, 16, v151
v_and_b32 v231, 4294901760, v151
v_cvt_pk_f16_f32 v151, v230, v231
v_lshlrev_b32_e64 v228, 16, v152
v_and_b32 v229, 4294901760, v152
v_cvt_pk_f16_f32 v152, v228, v229
v_lshlrev_b32_e64 v230, 16, v153
v_and_b32 v231, 4294901760, v153
v_cvt_pk_f16_f32 v153, v230, v231
v_lshlrev_b32_e64 v228, 16, v154
v_and_b32 v229, 4294901760, v154
v_cvt_pk_f16_f32 v154, v228, v229
v_lshlrev_b32_e64 v230, 16, v155
v_and_b32 v231, 4294901760, v155
v_cvt_pk_f16_f32 v155, v230, v231
s_cmp_eq_u32 s77, 0
s_cbranch_scc1 Lpp935
s_getreg_b32 s43, hwreg(HW_REG_IB_STS, 0, 4)
s_cmp_lg_u32 s43, 0
s_cbranch_scc1 Lpp935
s_call_b64 s[78:79], Lpoll
s_setprio 2
Lpp935:
v_lshl_add_u32 v224, v251, 4, s72
Lspin:
s_cmp_eq_u32 s77, 0
s_cbranch_scc1 Lspinx
s_cmp_eq_u32 s76, 0
s_cbranch_scc1 Lspinx
s_sub_u32 s76, s76, 1
s_call_b64 s[78:79], Lpoll
s_branch Lspin
Lspinx:
s_cmp_lg_u32 s40, 0
s_cbranch_scc1 Lnofin
v_add_u32_e64 v162, 0, v251
v_mul_u32_u24 v165, 2731, v162
v_lshrrev_b32_e64 v165, 16, v165
v_mul_u32_u24 v165, 9120, v165
v_lshl_add_u32 v162, v162, 2, v165
v_add_u32 v162, 90112, v162
v_add_u32_e64 v163, 64, v251
v_mul_u32_u24 v165, 2731, v163
v_lshrrev_b32_e64 v165, 16, v165
v_mul_u32_u24 v165, 9120, v165
v_lshl_add_u32 v163, v163, 2, v165
v_add_u32 v163, 90112, v163
v_add_u32 v164, 128, v251
v_mul_u32_u24 v165, 2731, v164
v_lshrrev_b32_e64 v165, 16, v165
v_mul_u32_u24 v165, 9120, v165
v_lshl_add_u32 v164, v164, 2, v165
v_add_u32 v164, 90112, v164
v_mov_b32 v165, 16256
Lrrw:
ds_read_b32 v166, v165 offset:8
s_waitcnt lgkmcnt(0)
v_readfirstlane_b32 s43, v166
s_cmp_eq_u32 s76, 0
s_cbranch_scc1 Lrrx
s_sub_u32 s76, s76, 1
s_cmp_lt_u32 s43, 8
s_cbranch_scc0 Lrrx
s_sleep 2
s_branch Lrrw
Lrrx:
ds_write_b32 v162, v244
ds_write_b32 v163, v245
ds_write_b32 v164, v246
Lnofin:
s_waitcnt lgkmcnt(0)
s_barrier
ds_read_b128 v[156:159], v226
ds_read_b128 v[160:163], v226 offset:32
ds_read_b128 v[164:167], v226 offset:64
s_waitcnt lgkmcnt(0)
v_pk_mul_f16 v120, v120, v156
v_pk_mul_f16 v121, v121, v157
v_pk_mul_f16 v122, v122, v158
v_pk_mul_f16 v123, v123, v159
ds_write_b128 v224, v[120:123]
v_pk_mul_f16 v124, v124, v156
v_pk_mul_f16 v125, v125, v157
v_pk_mul_f16 v126, v126, v158
v_pk_mul_f16 v127, v127, v159
ds_write_b128 v224, v[124:127] offset:1024
v_pk_mul_f16 v128, v128, v156
v_pk_mul_f16 v129, v129, v157
v_pk_mul_f16 v130, v130, v158
v_pk_mul_f16 v131, v131, v159
ds_write_b128 v224, v[128:131] offset:2048
v_pk_mul_f16 v132, v132, v160
v_pk_mul_f16 v133, v133, v161
v_pk_mul_f16 v134, v134, v162
v_pk_mul_f16 v135, v135, v163
ds_write_b128 v224, v[132:135] offset:3072
v_pk_mul_f16 v136, v136, v160
v_pk_mul_f16 v137, v137, v161
v_pk_mul_f16 v138, v138, v162
v_pk_mul_f16 v139, v139, v163
ds_write_b128 v224, v[136:139] offset:4096
v_pk_mul_f16 v140, v140, v160
v_pk_mul_f16 v141, v141, v161
v_pk_mul_f16 v142, v142, v162
v_pk_mul_f16 v143, v143, v163
ds_write_b128 v224, v[140:143] offset:5120
v_pk_mul_f16 v144, v144, v164
v_pk_mul_f16 v145, v145, v165
v_pk_mul_f16 v146, v146, v166
v_pk_mul_f16 v147, v147, v167
ds_write_b128 v224, v[144:147] offset:6144
v_pk_mul_f16 v148, v148, v164
v_pk_mul_f16 v149, v149, v165
v_pk_mul_f16 v150, v150, v166
v_pk_mul_f16 v151, v151, v167
ds_write_b128 v224, v[148:151] offset:7168
v_pk_mul_f16 v152, v152, v164
v_pk_mul_f16 v153, v153, v165
v_pk_mul_f16 v154, v154, v166
v_pk_mul_f16 v155, v155, v167
ds_write_b128 v224, v[152:155] offset:8192
s_waitcnt lgkmcnt(0)
s_barrier
s_setprio 3
ds_read_b128 v[224:227], v249 offset:24576
ds_read_b128 v[228:231], v254 offset:7936
ds_read_b128 v[240:243], v249 offset:24832
ds_read_b128 v[244:247], v254 offset:7952
s_waitcnt lgkmcnt(2)
v_mfma_f32_16x16x32_f16 v[120:123], v[224:227], v[0:3], v[228:231]
v_mfma_f32_16x16x32_f16 v[128:131], v[224:227], v[4:7], v[228:231]
v_permlane16_swap_b32 v16, v20
s_waitcnt lgkmcnt(0)
v_mfma_f32_16x16x32_f16 v[124:127], v[240:243], v[0:3], v[244:247]
ds_read_b128 v[224:227], v249 offset:25600
ds_read_b128 v[228:231], v254 offset:8064
v_mfma_f32_16x16x32_f16 v[132:135], v[240:243], v[4:7], v[244:247]
v_permlane16_swap_b32 v17, v21
s_waitcnt lgkmcnt(0)
v_mfma_f32_16x16x32_f16 v[136:139], v[224:227], v[0:3], v[228:231]
ds_read_b128 v[240:243], v249 offset:25856
ds_read_b128 v[244:247], v254 offset:8080
v_mfma_f32_16x16x32_f16 v[144:147], v[224:227], v[4:7], v[228:231]
v_permlane16_swap_b32 v18, v22
s_waitcnt lgkmcnt(0)
v_mfma_f32_16x16x32_f16 v[140:143], v[240:243], v[0:3], v[244:247]
ds_read_b128 v[224:227], v249 offset:26624
ds_read_b128 v[228:231], v254 offset:16128
v_mfma_f32_16x16x32_f16 v[148:151], v[240:243], v[4:7], v[244:247]
v_permlane16_swap_b32 v19, v23
s_waitcnt lgkmcnt(0)
v_mfma_f32_16x16x32_f16 v[152:155], v[224:227], v[0:3], v[228:231]
ds_read_b128 v[240:243], v249 offset:26880
ds_read_b128 v[244:247], v254 offset:16144
v_mfma_f32_16x16x32_f16 v[160:163], v[224:227], v[4:7], v[228:231]
v_permlane16_swap_b32 v24, v28
s_waitcnt lgkmcnt(0)
v_mfma_f32_16x16x32_f16 v[156:159], v[240:243], v[0:3], v[244:247]
ds_read_b128 v[224:227], v249 offset:30720
ds_read_b128 v[228:231], v249 offset:30976
v_mfma_f32_16x16x32_f16 v[164:167], v[240:243], v[4:7], v[244:247]
v_permlane16_swap_b32 v25, v29
s_waitcnt lgkmcnt(1)
v_mfma_f32_16x16x32_f16 v[120:123], v[224:227], v[8:11], v[120:123]
ds_read_b128 v[240:243], v249 offset:31744
ds_read_b128 v[244:247], v249 offset:32000
v_mfma_f32_16x16x32_f16 v[128:131], v[224:227], v[12:15], v[128:131]
v_permlane16_swap_b32 v26, v30
s_waitcnt lgkmcnt(2)
v_mfma_f32_16x16x32_f16 v[124:127], v[228:231], v[8:11], v[124:127]
ds_read_b128 v[224:227], v249 offset:32768
v_mfma_f32_16x16x32_f16 v[132:135], v[228:231], v[12:15], v[132:135]
v_permlane16_swap_b32 v27, v31
s_waitcnt lgkmcnt(2)
v_mfma_f32_16x16x32_f16 v[136:139], v[240:243], v[8:11], v[136:139]
ds_read_b128 v[228:231], v249 offset:33024
v_mfma_f32_16x16x32_f16 v[144:147], v[240:243], v[12:15], v[144:147]
v_permlane16_swap_b32 v96, v100
s_waitcnt lgkmcnt(2)
v_mfma_f32_16x16x32_f16 v[140:143], v[244:247], v[8:11], v[140:143]
ds_read_b128 v[240:243], v249 offset:36864
v_mfma_f32_16x16x32_f16 v[148:151], v[244:247], v[12:15], v[148:151]
v_permlane16_swap_b32 v97, v101
s_waitcnt lgkmcnt(2)
v_mfma_f32_16x16x32_f16 v[152:155], v[224:227], v[8:11], v[152:155]
ds_read_b128 v[244:247], v249 offset:37120
v_mfma_f32_16x16x32_f16 v[160:163], v[224:227], v[12:15], v[160:163]
v_permlane16_swap_b32 v98, v102
s_waitcnt lgkmcnt(2)
v_mfma_f32_16x16x32_f16 v[156:159], v[228:231], v[8:11], v[156:159]
ds_read_b128 v[224:227], v249 offset:37888
v_mfma_f32_16x16x32_f16 v[164:167], v[228:231], v[12:15], v[164:167]
v_permlane16_swap_b32 v99, v103
s_waitcnt lgkmcnt(2)
v_mfma_f32_16x16x32_f16 v[120:123], v[240:243], v[16:19], v[120:123]
buffer_load_dwordx4 v[12:15], v252, s[4:7], s71 offen
ds_read_b128 v[228:231], v249 offset:38144
v_mfma_f32_16x16x32_f16 v[128:131], v[240:243], v[20:23], v[128:131]
v_permlane16_swap_b32 v32, v36
s_waitcnt lgkmcnt(2)
v_mfma_f32_16x16x32_f16 v[124:127], v[244:247], v[16:19], v[124:127]
ds_read_b128 v[240:243], v249 offset:38912
v_mfma_f32_16x16x32_f16 v[132:135], v[244:247], v[20:23], v[132:135]
v_permlane16_swap_b32 v33, v37
s_waitcnt lgkmcnt(2)
v_mfma_f32_16x16x32_f16 v[136:139], v[224:227], v[16:19], v[136:139]
ds_read_b128 v[244:247], v249 offset:39168
v_mfma_f32_16x16x32_f16 v[144:147], v[224:227], v[20:23], v[144:147]
v_permlane16_swap_b32 v34, v38
s_waitcnt lgkmcnt(2)
v_mfma_f32_16x16x32_f16 v[140:143], v[228:231], v[16:19], v[140:143]
buffer_load_dwordx4 v[8:11], v252, s[4:7], s71 offen offset:64
ds_read_b128 v[224:227], v249 offset:43008
v_mfma_f32_16x16x32_f16 v[148:151], v[228:231], v[20:23], v[148:151]
v_permlane16_swap_b32 v35, v39
s_waitcnt lgkmcnt(2)
v_mfma_f32_16x16x32_f16 v[152:155], v[240:243], v[16:19], v[152:155]
ds_read_b128 v[228:231], v249 offset:43264
v_mfma_f32_16x16x32_f16 v[160:163], v[240:243], v[20:23], v[160:163]
v_permlane16_swap_b32 v40, v44
s_waitcnt lgkmcnt(2)
v_mfma_f32_16x16x32_f16 v[156:159], v[244:247], v[16:19], v[156:159]
ds_read_b128 v[240:243], v249 offset:44032
v_mfma_f32_16x16x32_f16 v[164:167], v[244:247], v[20:23], v[164:167]
v_permlane16_swap_b32 v41, v45
s_waitcnt lgkmcnt(2)
v_mfma_f32_16x16x32_f16 v[120:123], v[224:227], v[24:27], v[120:123]
buffer_load_dwordx4 v[4:7], v252, s[4:7], s71 offen offset:128
ds_read_b128 v[244:247], v249 offset:44288
v_mfma_f32_16x16x32_f16 v[128:131], v[224:227], v[28:31], v[128:131]
v_permlane16_swap_b32 v42, v46
s_waitcnt lgkmcnt(2)
v_mfma_f32_16x16x32_f16 v[124:127], v[228:231], v[24:27], v[124:127]
ds_read_b128 v[224:227], v249 offset:45056
v_mfma_f32_16x16x32_f16 v[132:135], v[228:231], v[28:31], v[132:135]
v_permlane16_swap_b32 v43, v47
s_waitcnt lgkmcnt(2)
v_mfma_f32_16x16x32_f16 v[136:139], v[240:243], v[24:27], v[136:139]
ds_read_b128 v[228:231], v249 offset:45312
v_mfma_f32_16x16x32_f16 v[144:147], v[240:243], v[28:31], v[144:147]
v_permlane16_swap_b32 v104, v108
s_waitcnt lgkmcnt(2)
v_mfma_f32_16x16x32_f16 v[140:143], v[244:247], v[24:27], v[140:143]
s_add_u32 s46, s71, 98304
buffer_load_dwordx4 v[0:3], v252, s[4:7], s46 offen
ds_read_b128 v[240:243], v249 offset:49152
v_mfma_f32_16x16x32_f16 v[148:151], v[244:247], v[28:31], v[148:151]
v_permlane16_swap_b32 v105, v109
s_waitcnt lgkmcnt(2)
v_mfma_f32_16x16x32_f16 v[152:155], v[224:227], v[24:27], v[152:155]
ds_read_b128 v[244:247], v249 offset:49408
v_mfma_f32_16x16x32_f16 v[160:163], v[224:227], v[28:31], v[160:163]
v_permlane16_swap_b32 v106, v110
s_waitcnt lgkmcnt(2)
v_mfma_f32_16x16x32_f16 v[156:159], v[228:231], v[24:27], v[156:159]
ds_read_b128 v[224:227], v249 offset:50176
v_mfma_f32_16x16x32_f16 v[164:167], v[228:231], v[28:31], v[164:167]
v_permlane16_swap_b32 v107, v111
s_waitcnt lgkmcnt(2)
v_mfma_f32_16x16x32_f16 v[120:123], v[240:243], v[32:35], v[120:123]
buffer_load_dwordx4 v[24:27], v253, s[32:35], s80 offen nt
ds_read_b128 v[228:231], v249 offset:50432
v_mfma_f32_16x16x32_f16 v[128:131], v[240:243], v[36:39], v[128:131]
v_permlane16_swap_b32 v48, v52
s_waitcnt lgkmcnt(2)
v_mfma_f32_16x16x32_f16 v[124:127], v[244:247], v[32:35], v[124:127]
ds_read_b128 v[240:243], v249 offset:51200
v_mfma_f32_16x16x32_f16 v[132:135], v[244:247], v[36:39], v[132:135]
v_permlane16_swap_b32 v49, v53
s_waitcnt lgkmcnt(2)
v_mfma_f32_16x16x32_f16 v[136:139], v[224:227], v[32:35], v[136:139]
ds_read_b128 v[244:247], v249 offset:51456
v_permlane16_swap_b32 v50, v54
v_mfma_f32_16x16x32_f16 v[144:147], v[224:227], v[36:39], v[144:147]
s_waitcnt lgkmcnt(2)
v_mfma_f32_16x16x32_f16 v[140:143], v[228:231], v[32:35], v[140:143]
ds_read_b128 v[224:227], v249 offset:55296
v_permlane16_swap_b32 v51, v55
v_mfma_f32_16x16x32_f16 v[148:151], v[228:231], v[36:39], v[148:151]
v_permlane16_swap_b32 v56, v60
s_waitcnt lgkmcnt(2)
v_mfma_f32_16x16x32_f16 v[152:155], v[240:243], v[32:35], v[152:155]
ds_read_b128 v[228:231], v249 offset:55552
v_mfma_f32_16x16x32_f16 v[160:163], v[240:243], v[36:39], v[160:163]
v_permlane16_swap_b32 v57, v61
s_waitcnt lgkmcnt(2)
v_mfma_f32_16x16x32_f16 v[156:159], v[244:247], v[32:35], v[156:159]
ds_read_b128 v[240:243], v249 offset:56320
v_permlane16_swap_b32 v58, v62
v_mfma_f32_16x16x32_f16 v[164:167], v[244:247], v[36:39], v[164:167]
s_waitcnt lgkmcnt(2)
v_mfma_f32_16x16x32_f16 v[120:123], v[224:227], v[40:43], v[120:123]
buffer_load_dwordx4 v[28:31], v253, s[32:35], s80 offen offset:256 nt
ds_read_b128 v[244:247], v249 offset:56576
v_permlane16_swap_b32 v59, v63
v_mfma_f32_16x16x32_f16 v[128:131], v[224:227], v[44:47], v[128:131]
v_and_b32_e64 v16, 1, v251
v_lshlrev_b32 v16, 4, v16
s_waitcnt lgkmcnt(2)
v_mfma_f32_16x16x32_f16 v[124:127], v[228:231], v[40:43], v[124:127]
ds_read_b128 v[224:227], v249 offset:57344
v_mov_b32 v17, 16256
v_mfma_f32_16x16x32_f16 v[132:135], v[228:231], v[44:47], v[132:135]
v_lshlrev_b32 v16, v16, v17
s_waitcnt lgkmcnt(2)
v_mfma_f32_16x16x32_f16 v[136:139], v[240:243], v[40:43], v[136:139]
ds_read_b128 v[228:231], v249 offset:57600
v_lshrrev_b32 v17, 2, v251
v_mfma_f32_16x16x32_f16 v[144:147], v[240:243], v[44:47], v[144:147]
v_xor_b32 v17, v17, v251
v_and_b32 v17, 12, v17
s_waitcnt lgkmcnt(2)
v_mfma_f32_16x16x32_f16 v[140:143], v[244:247], v[40:43], v[140:143]
ds_read_b128 v[240:243], v249 offset:61440
v_and_b32_e64 v20, 2, v251
v_mfma_f32_16x16x32_f16 v[148:151], v[244:247], v[44:47], v[148:151]
v_or_b32 v17, v17, v20
s_waitcnt lgkmcnt(2)
v_mfma_f32_16x16x32_f16 v[152:155], v[224:227], v[40:43], v[152:155]
ds_read_b128 v[244:247], v249 offset:61696
v_cmp_eq_u32 vcc, 0, v17
s_nop 1
v_cndmask_b32 v18, 0, v16, vcc
v_cmp_eq_u32 vcc, 2, v17
s_nop 1
v_cndmask_b32 v19, 0, v16, vcc
v_mfma_f32_16x16x32_f16 v[160:163], v[224:227], v[44:47], v[160:163]
v_mov_b32 v16, 0
s_waitcnt lgkmcnt(2)
v_mfma_f32_16x16x32_f16 v[156:159], v[228:231], v[40:43], v[156:159]
ds_read_b128 v[224:227], v249 offset:62464
v_mov_b32_e64 v17, 0
v_mfma_f32_16x16x32_f16 v[164:167], v[228:231], v[44:47], v[164:167]
v_mov_b32 v20, 0
v_mov_b32 v21, 0
s_waitcnt lgkmcnt(2)
v_mfma_f32_16x16x32_f16 v[120:123], v[240:243], v[48:51], v[120:123]
s_add_u32 s46, s80, 4194304
buffer_load_dwordx4 v[32:35], v253, s[32:35], s46 offen nt
ds_read_b128 v[228:231], v249 offset:62720
v_mfma_f32_16x16x32_f16 v[128:131], v[240:243], v[52:55], v[128:131]
s_waitcnt lgkmcnt(2)
v_mfma_f32_16x16x32_f16 v[124:127], v[244:247], v[48:51], v[124:127]
ds_read_b128 v[240:243], v249 offset:63488
v_permlane16_swap_b32 v64, v68
v_mfma_f32_16x16x32_f16 v[132:135], v[244:247], v[52:55], v[132:135]
s_waitcnt lgkmcnt(2)
v_mfma_f32_16x16x32_f16 v[136:139], v[224:227], v[48:51], v[136:139]
ds_read_b128 v[244:247], v249 offset:63744
v_permlane16_swap_b32 v65, v69
v_mfma_f32_16x16x32_f16 v[144:147], v[224:227], v[52:55], v[144:147]
s_waitcnt lgkmcnt(2)
v_mfma_f32_16x16x32_f16 v[140:143], v[228:231], v[48:51], v[140:143]
ds_read_b128 v[224:227], v250 offset:2048
v_permlane16_swap_b32 v66, v70
v_mfma_f32_16x16x32_f16 v[148:151], v[228:231], v[52:55], v[148:151]
s_waitcnt lgkmcnt(2)
v_mfma_f32_16x16x32_f16 v[152:155], v[240:243], v[48:51], v[152:155]
ds_read_b128 v[228:231], v250 offset:2304
v_mfma_f32_16x16x32_f16 v[160:163], v[240:243], v[52:55], v[160:163]
v_permlane16_swap_b32 v67, v71
s_waitcnt lgkmcnt(2)
v_mfma_f32_16x16x32_f16 v[156:159], v[244:247], v[48:51], v[156:159]
ds_read_b128 v[240:243], v250 offset:3072
v_mfma_f32_16x16x32_f16 v[164:167], v[244:247], v[52:55], v[164:167]
v_permlane16_swap_b32 v72, v76
s_waitcnt lgkmcnt(2)
v_mfma_f32_16x16x32_f16 v[120:123], v[224:227], v[56:59], v[120:123]
ds_read_b128 v[244:247], v250 offset:3328
v_mfma_f32_16x16x32_f16 v[128:131], v[224:227], v[60:63], v[128:131]
v_permlane16_swap_b32 v73, v77
s_waitcnt lgkmcnt(2)
v_mfma_f32_16x16x32_f16 v[124:127], v[228:231], v[56:59], v[124:127]
s_add_u32 s46, s80, 4194304
buffer_load_dwordx4 v[36:39], v253, s[32:35], s46 offen offset:256 nt
ds_read_b128 v[224:227], v250 offset:4096
v_mfma_f32_16x16x32_f16 v[132:135], v[228:231], v[60:63], v[132:135]
s_waitcnt lgkmcnt(2)
v_mfma_f32_16x16x32_f16 v[136:139], v[240:243], v[56:59], v[136:139]
ds_read_b128 v[228:231], v250 offset:4352
v_permlane16_swap_b32 v74, v78
v_mfma_f32_16x16x32_f16 v[144:147], v[240:243], v[60:63], v[144:147]
s_waitcnt lgkmcnt(2)
v_mfma_f32_16x16x32_f16 v[140:143], v[244:247], v[56:59], v[140:143]
ds_read_b128 v[240:243], v250 offset:8192
v_permlane16_swap_b32 v75, v79
v_mfma_f32_16x16x32_f16 v[148:151], v[244:247], v[60:63], v[148:151]
s_waitcnt lgkmcnt(2)
v_mfma_f32_16x16x32_f16 v[152:155], v[224:227], v[56:59], v[152:155]
ds_read_b128 v[244:247], v250 offset:8448
v_permlane16_swap_b32 v192, v196
v_mfma_f32_16x16x32_f16 v[160:163], v[224:227], v[60:63], v[160:163]
s_waitcnt lgkmcnt(2)
v_mfma_f32_16x16x32_f16 v[156:159], v[228:231], v[56:59], v[156:159]
ds_read_b128 v[224:227], v250 offset:9216
v_mfma_f32_16x16x32_f16 v[164:167], v[228:231], v[60:63], v[164:167]
v_permlane16_swap_b32 v193, v197
s_waitcnt vmcnt(7)
v_mfma_f32_16x16x32_bf16 v[120:123], v[18:21], v[12:15], v[120:123]
ds_read_b128 v[228:231], v250 offset:9472
v_mfma_f32_16x16x32_bf16 v[124:127], v[16:19], v[12:15], v[124:127]
v_permlane16_swap_b32 v194, v198
s_waitcnt vmcnt(6)
v_mfma_f32_16x16x32_bf16 v[136:139], v[18:21], v[8:11], v[136:139]
v_mfma_f32_16x16x32_bf16 v[140:143], v[16:19], v[8:11], v[140:143]
v_permlane16_swap_b32 v195, v199
s_waitcnt lgkmcnt(3)
v_mfma_f32_16x16x32_f16 v[120:123], v[240:243], v[64:67], v[120:123]
s_add_u32 s46, s80, 8388608
buffer_load_dwordx4 v[40:43], v253, s[32:35], s46 offen nt
v_mfma_f32_16x16x32_f16 v[128:131], v[240:243], v[68:71], v[128:131]
s_waitcnt lgkmcnt(2)
v_mfma_f32_16x16x32_f16 v[124:127], v[244:247], v[64:67], v[124:127]
ds_read_b128 v[240:243], v250 offset:10240
v_permlane16_swap_b32 v80, v84
v_mfma_f32_16x16x32_f16 v[132:135], v[244:247], v[68:71], v[132:135]
s_waitcnt lgkmcnt(2)
v_mfma_f32_16x16x32_f16 v[136:139], v[224:227], v[64:67], v[136:139]
ds_read_b128 v[244:247], v250 offset:10496
v_permlane16_swap_b32 v81, v85
v_mfma_f32_16x16x32_f16 v[144:147], v[224:227], v[68:71], v[144:147]
s_waitcnt lgkmcnt(2)
v_mfma_f32_16x16x32_f16 v[140:143], v[228:231], v[64:67], v[140:143]
ds_read_b128 v[224:227], v250 offset:14336
v_permlane16_swap_b32 v82, v86
v_mfma_f32_16x16x32_f16 v[148:151], v[228:231], v[68:71], v[148:151]
s_waitcnt lgkmcnt(2)
v_mfma_f32_16x16x32_f16 v[152:155], v[240:243], v[64:67], v[152:155]
s_add_u32 s46, s80, 8388608
buffer_load_dwordx4 v[44:47], v253, s[32:35], s46 offen offset:256 nt
ds_read_b128 v[228:231], v250 offset:14592
v_mfma_f32_16x16x32_f16 v[160:163], v[240:243], v[68:71], v[160:163]
v_permlane16_swap_b32 v83, v87
s_waitcnt lgkmcnt(2)
v_mfma_f32_16x16x32_f16 v[156:159], v[244:247], v[64:67], v[156:159]
ds_read_b128 v[240:243], v250 offset:15360
v_mfma_f32_16x16x32_f16 v[164:167], v[244:247], v[68:71], v[164:167]
v_permlane16_swap_b32 v88, v92
s_waitcnt lgkmcnt(2)
v_mfma_f32_16x16x32_f16 v[120:123], v[224:227], v[72:75], v[120:123]
ds_read_b128 v[244:247], v250 offset:15616
v_mfma_f32_16x16x32_f16 v[128:131], v[224:227], v[76:79], v[128:131]
v_permlane16_swap_b32 v89, v93
s_waitcnt lgkmcnt(2)
v_mfma_f32_16x16x32_f16 v[124:127], v[228:231], v[72:75], v[124:127]
s_add_u32 s46, s71, 98304
buffer_load_dwordx4 v[8:11], v252, s[4:7], s46 offen offset:64
ds_read_b128 v[224:227], v250 offset:16384
v_mfma_f32_16x16x32_f16 v[132:135], v[228:231], v[76:79], v[132:135]
s_waitcnt lgkmcnt(2)
v_mfma_f32_16x16x32_f16 v[136:139], v[240:243], v[72:75], v[136:139]
ds_read_b128 v[228:231], v250 offset:16640
v_permlane16_swap_b32 v90, v94
v_mfma_f32_16x16x32_f16 v[144:147], v[240:243], v[76:79], v[144:147]
s_waitcnt lgkmcnt(2)
v_mfma_f32_16x16x32_f16 v[140:143], v[244:247], v[72:75], v[140:143]
ds_read_b128 v[240:243], v250 offset:20480
v_permlane16_swap_b32 v91, v95
v_mfma_f32_16x16x32_f16 v[148:151], v[244:247], v[76:79], v[148:151]
s_waitcnt lgkmcnt(2)
v_mfma_f32_16x16x32_f16 v[152:155], v[224:227], v[72:75], v[152:155]
ds_read_b128 v[244:247], v250 offset:20736
v_permlane16_swap_b32 v184, v188
v_mfma_f32_16x16x32_f16 v[160:163], v[224:227], v[76:79], v[160:163]
s_waitcnt lgkmcnt(2)
v_mfma_f32_16x16x32_f16 v[156:159], v[228:231], v[72:75], v[156:159]
s_add_u32 s46, s71, 98304
buffer_load_dwordx4 v[12:15], v252, s[4:7], s46 offen offset:128
ds_read_b128 v[224:227], v250 offset:21504
v_mfma_f32_16x16x32_f16 v[164:167], v[228:231], v[76:79], v[164:167]
v_permlane16_swap_b32 v185, v189
s_waitcnt vmcnt(9)
v_mfma_f32_16x16x32_bf16 v[152:155], v[18:21], v[4:7], v[152:155]
ds_read_b128 v[228:231], v250 offset:21760
v_mfma_f32_16x16x32_bf16 v[156:159], v[16:19], v[4:7], v[156:159]
v_permlane16_swap_b32 v186, v190
s_waitcnt vmcnt(8)
v_mfma_f32_16x16x32_bf16 v[128:131], v[18:21], v[0:3], v[128:131]
v_mfma_f32_16x16x32_bf16 v[132:135], v[16:19], v[0:3], v[132:135]
v_permlane16_swap_b32 v187, v191
v_and_b32 v255, 1, v251
v_lshlrev_b32 v255, 7, v255
v_sub_u32 v255, v252, v255
s_mov_b32 s74, 1431655765
s_mov_b32 s75, 1431655765
s_waitcnt lgkmcnt(3)
v_mfma_f32_16x16x32_f16 v[120:123], v[240:243], v[80:83], v[120:123]
buffer_load_dwordx4 v[4:7], v252, s[4:7], s70 offen
v_mfma_f32_16x16x32_f16 v[128:131], v[240:243], v[84:87], v[128:131]
v_permlane16_swap_b32 v168, v172
s_waitcnt lgkmcnt(2)
v_mfma_f32_16x16x32_f16 v[124:127], v[244:247], v[80:83], v[124:127]
ds_read_b128 v[240:243], v250 offset:22528
v_mfma_f32_16x16x32_f16 v[132:135], v[244:247], v[84:87], v[132:135]
v_permlane16_swap_b32 v169, v173
s_waitcnt lgkmcnt(2)
v_mfma_f32_16x16x32_f16 v[136:139], v[224:227], v[80:83], v[136:139]
ds_read_b128 v[244:247], v250 offset:22784
v_mfma_f32_16x16x32_f16 v[144:147], v[224:227], v[84:87], v[144:147]
v_permlane16_swap_b32 v170, v174
s_waitcnt lgkmcnt(2)
v_mfma_f32_16x16x32_f16 v[140:143], v[228:231], v[80:83], v[140:143]
ds_read_b128 v[224:227], v250 offset:26624
v_mfma_f32_16x16x32_f16 v[148:151], v[228:231], v[84:87], v[148:151]
v_permlane16_swap_b32 v171, v175
s_waitcnt lgkmcnt(2)
v_mfma_f32_16x16x32_f16 v[152:155], v[240:243], v[80:83], v[152:155]
ds_read_b128 v[228:231], v250 offset:26880
v_mfma_f32_16x16x32_f16 v[160:163], v[240:243], v[84:87], v[160:163]
v_permlane16_swap_b32 v176, v180
s_waitcnt lgkmcnt(2)
v_mfma_f32_16x16x32_f16 v[156:159], v[244:247], v[80:83], v[156:159]
ds_read_b128 v[240:243], v250 offset:27648
v_mfma_f32_16x16x32_f16 v[164:167], v[244:247], v[84:87], v[164:167]
v_permlane16_swap_b32 v177, v181
s_waitcnt lgkmcnt(2)
v_mfma_f32_16x16x32_f16 v[120:123], v[224:227], v[88:91], v[120:123]
buffer_load_dwordx4 v[0:3], v252, s[4:7], s70 offen offset:64
ds_read_b128 v[244:247], v250 offset:27904
v_mfma_f32_16x16x32_f16 v[128:131], v[224:227], v[92:95], v[128:131]
v_permlane16_swap_b32 v178, v182
s_waitcnt lgkmcnt(2)
v_mfma_f32_16x16x32_f16 v[124:127], v[228:231], v[88:91], v[124:127]
ds_read_b128 v[224:227], v250 offset:28672
v_mfma_f32_16x16x32_f16 v[132:135], v[228:231], v[92:95], v[132:135]
v_permlane16_swap_b32 v179, v183
s_waitcnt lgkmcnt(2)
v_mfma_f32_16x16x32_f16 v[136:139], v[240:243], v[88:91], v[136:139]
ds_read_b128 v[228:231], v250 offset:28928
v_mfma_f32_16x16x32_f16 v[144:147], v[240:243], v[92:95], v[144:147]
v_permlane16_swap_b32 v112, v116
s_waitcnt lgkmcnt(2)
v_mfma_f32_16x16x32_f16 v[140:143], v[244:247], v[88:91], v[140:143]
ds_read_b128 v[240:243], v249 offset:49152
v_mfma_f32_16x16x32_f16 v[148:151], v[244:247], v[92:95], v[148:151]
v_permlane16_swap_b32 v113, v117
s_waitcnt lgkmcnt(2)
v_mfma_f32_16x16x32_f16 v[152:155], v[224:227], v[88:91], v[152:155]
ds_read_b128 v[244:247], v254 offset:7936
v_mfma_f32_16x16x32_f16 v[160:163], v[224:227], v[92:95], v[160:163]
v_permlane16_swap_b32 v114, v118
s_waitcnt lgkmcnt(2)
v_mfma_f32_16x16x32_f16 v[156:159], v[228:231], v[88:91], v[156:159]
ds_read_b128 v[224:227], v249 offset:49408
v_mfma_f32_16x16x32_f16 v[164:167], v[228:231], v[92:95], v[164:167]
v_permlane16_swap_b32 v115, v119
s_waitcnt lgkmcnt(1)
v_mfma_f32_16x16x32_f16 v[48:51], v[240:243], v[168:171], v[244:247]
ds_read_b128 v[228:231], v254 offset:7952
v_mfma_f32_16x16x32_f16 v[56:59], v[240:243], v[172:175], v[244:247]
s_waitcnt lgkmcnt(0)
v_mfma_f32_16x16x32_f16 v[52:55], v[224:227], v[168:171], v[228:231]
ds_read_b128 v[240:243], v249 offset:50176
ds_read_b128 v[244:247], v254 offset:8064
v_mfma_f32_16x16x32_f16 v[60:63], v[224:227], v[172:175], v[228:231]
s_waitcnt lgkmcnt(0)
v_mfma_f32_16x16x32_f16 v[64:67], v[240:243], v[168:171], v[244:247]
ds_read_b128 v[224:227], v249 offset:50432
ds_read_b128 v[228:231], v254 offset:8080
v_mfma_f32_16x16x32_f16 v[72:75], v[240:243], v[172:175], v[244:247]
s_waitcnt lgkmcnt(0)
v_mfma_f32_16x16x32_f16 v[68:71], v[224:227], v[168:171], v[228:231]
ds_read_b128 v[240:243], v249 offset:51200
ds_read_b128 v[244:247], v254 offset:16128
v_cvt_pk_bf16_f32 v136, v136, v137
v_mfma_f32_16x16x32_f16 v[76:79], v[224:227], v[172:175], v[228:231]
v_cvt_pk_bf16_f32 v137, v138, v139
s_waitcnt lgkmcnt(0)
v_mfma_f32_16x16x32_f16 v[80:83], v[240:243], v[168:171], v[244:247]
ds_read_b128 v[224:227], v249 offset:51456
ds_read_b128 v[228:231], v254 offset:16144
v_cvt_pk_bf16_f32 v138, v140, v141
v_mfma_f32_16x16x32_f16 v[88:91], v[240:243], v[172:175], v[244:247]
v_cvt_pk_bf16_f32 v139, v142, v143
s_waitcnt lgkmcnt(0)
v_mfma_f32_16x16x32_f16 v[84:87], v[224:227], v[168:171], v[228:231]
ds_read_b128 v[240:243], v249 offset:55296
ds_read_b128 v[244:247], v249 offset:55552
v_cvt_pk_bf16_f32 v120, v120, v121
v_mfma_f32_16x16x32_f16 v[92:95], v[224:227], v[172:175], v[228:231]
v_cvt_pk_bf16_f32 v121, v122, v123
s_waitcnt lgkmcnt(1)
v_mfma_f32_16x16x32_f16 v[48:51], v[240:243], v[176:179], v[48:51]
ds_read_b128 v[224:227], v249 offset:56320
ds_read_b128 v[228:231], v249 offset:56576
v_cvt_pk_bf16_f32 v122, v124, v125
v_mfma_f32_16x16x32_f16 v[56:59], v[240:243], v[180:183], v[56:59]
v_cvt_pk_bf16_f32 v123, v126, v127
s_waitcnt lgkmcnt(2)
v_mfma_f32_16x16x32_f16 v[52:55], v[244:247], v[176:179], v[52:55]
ds_read_b128 v[240:243], v249 offset:57344
v_cvt_pk_bf16_f32 v152, v152, v153
v_cvt_pk_bf16_f32 v153, v154, v155
v_mfma_f32_16x16x32_f16 v[60:63], v[244:247], v[180:183], v[60:63]
v_cvt_pk_bf16_f32 v154, v156, v157
s_waitcnt lgkmcnt(2)
v_mfma_f32_16x16x32_f16 v[64:67], v[224:227], v[176:179], v[64:67]
ds_read_b128 v[244:247], v249 offset:57600
v_cvt_pk_bf16_f32 v155, v158, v159
s_mov_b64 vcc, s[74:75]
v_mfma_f32_16x16x32_f16 v[72:75], v[224:227], v[180:183], v[72:75]
v_cndmask_b32 v140, v120, v152, vcc
s_waitcnt lgkmcnt(2)
v_mfma_f32_16x16x32_f16 v[68:71], v[228:231], v[176:179], v[68:71]
ds_read_b128 v[224:227], v249 offset:61440
v_cndmask_b32 v141, v121, v153, vcc
v_mfma_f32_16x16x32_f16 v[76:79], v[228:231], v[180:183], v[76:79]
v_cndmask_b32 v142, v122, v154, vcc
s_waitcnt lgkmcnt(2)
v_mfma_f32_16x16x32_f16 v[80:83], v[240:243], v[176:179], v[80:83]
ds_read_b128 v[228:231], v249 offset:61696
v_cndmask_b32 v143, v123, v155, vcc
v_mfma_f32_16x16x32_f16 v[88:91], v[240:243], v[180:183], v[88:91]
v_cndmask_b32_dpp v120, v136, v120, vcc quad_perm:[1,0,3,2] row_mask:0xf bank_mask:0xf
s_waitcnt lgkmcnt(2)
v_mfma_f32_16x16x32_f16 v[84:87], v[244:247], v[176:179], v[84:87]
ds_read_b128 v[240:243], v248 offset:16384
v_cndmask_b32_dpp v121, v137, v121, vcc quad_perm:[1,0,3,2] row_mask:0xf bank_mask:0xf
v_mfma_f32_16x16x32_f16 v[92:95], v[244:247], v[180:183], v[92:95]
v_cndmask_b32_dpp v122, v138, v122, vcc quad_perm:[1,0,3,2] row_mask:0xf bank_mask:0xf
s_waitcnt vmcnt(3)
v_mfma_f32_16x16x32_bf16 v[144:147], v[18:21], v[8:11], v[144:147]
ds_read_b128 v[244:247], v249 offset:62464
v_cndmask_b32_dpp v123, v139, v123, vcc quad_perm:[1,0,3,2] row_mask:0xf bank_mask:0xf
s_not_b64 vcc, s[74:75]
v_mfma_f32_16x16x32_bf16 v[148:151], v[16:19], v[8:11], v[148:151]
v_cndmask_b32_dpp v152, v136, v152, vcc quad_perm:[1,0,3,2] row_mask:0xf bank_mask:0xf
s_waitcnt vmcnt(2)
v_mfma_f32_16x16x32_bf16 v[160:163], v[18:21], v[12:15], v[160:163]
v_cndmask_b32_dpp v153, v137, v153, vcc quad_perm:[1,0,3,2] row_mask:0xf bank_mask:0xf
v_mfma_f32_16x16x32_bf16 v[164:167], v[16:19], v[12:15], v[164:167]
v_cndmask_b32_dpp v154, v138, v154, vcc quad_perm:[1,0,3,2] row_mask:0xf bank_mask:0xf
v_cndmask_b32_dpp v155, v139, v155, vcc quad_perm:[1,0,3,2] row_mask:0xf bank_mask:0xf
s_waitcnt lgkmcnt(3)
v_mfma_f32_16x16x32_f16 v[48:51], v[224:227], v[184:187], v[48:51]
buffer_load_dwordx4 v[8:11], v252, s[4:7], s70 offen offset:128
buffer_store_dwordx4 v[120:123], v255, s[8:11], s71 offen sc1
v_mfma_f32_16x16x32_f16 v[56:59], v[224:227], v[188:191], v[56:59]
s_waitcnt lgkmcnt(2)
v_mfma_f32_16x16x32_f16 v[52:55], v[228:231], v[184:187], v[52:55]
ds_read_b128 v[224:227], v249 offset:62720
v_permlane16_swap_b32 v200, v204
v_mfma_f32_16x16x32_f16 v[60:63], v[228:231], v[188:191], v[60:63]
s_waitcnt lgkmcnt(2)
v_mfma_f32_16x16x32_bf16 v[168:171], v[240:243], v[96:99], 0
ds_read_b128 v[228:231], v249 offset:63488
v_permlane16_swap_b32 v201, v205
v_mfma_f32_16x16x32_bf16 v[176:179], v[240:243], v[100:103], 0
s_waitcnt lgkmcnt(2)
v_mfma_f32_16x16x32_f16 v[64:67], v[244:247], v[184:187], v[64:67]
ds_read_b128 v[240:243], v249 offset:63744
v_mfma_f32_16x16x32_f16 v[72:75], v[244:247], v[188:191], v[72:75]
v_permlane16_swap_b32 v202, v206
s_waitcnt lgkmcnt(2)
v_mfma_f32_16x16x32_f16 v[68:71], v[224:227], v[184:187], v[68:71]
ds_read_b128 v[244:247], v248 offset:16640
v_mfma_f32_16x16x32_f16 v[76:79], v[224:227], v[188:191], v[76:79]
v_permlane16_swap_b32 v203, v207
s_waitcnt lgkmcnt(2)
v_mfma_f32_16x16x32_f16 v[80:83], v[228:231], v[184:187], v[80:83]
s_add_u32 s46, s70, 98304
buffer_load_dwordx4 v[12:15], v252, s[4:7], s46 offen
ds_read_b128 v[224:227], v250 offset:2048
v_mfma_f32_16x16x32_f16 v[88:91], v[228:231], v[188:191], v[88:91]
s_waitcnt lgkmcnt(2)
v_mfma_f32_16x16x32_f16 v[84:87], v[240:243], v[184:187], v[84:87]
ds_read_b128 v[228:231], v250 offset:2304
v_permlane16_swap_b32 v232, v236
v_mfma_f32_16x16x32_f16 v[92:95], v[240:243], v[188:191], v[92:95]
s_waitcnt lgkmcnt(2)
v_mfma_f32_16x16x32_bf16 v[172:175], v[244:247], v[96:99], 0
ds_read_b128 v[240:243], v250 offset:3072
v_permlane16_swap_b32 v233, v237
v_mfma_f32_16x16x32_bf16 v[180:183], v[244:247], v[100:103], 0
s_waitcnt lgkmcnt(2)
v_mfma_f32_16x16x32_f16 v[48:51], v[224:227], v[192:195], v[48:51]
ds_read_b128 v[244:247], v250 offset:3328
v_mfma_f32_16x16x32_f16 v[56:59], v[224:227], v[196:199], v[56:59]
v_permlane16_swap_b32 v234, v238
s_waitcnt lgkmcnt(2)
v_mfma_f32_16x16x32_f16 v[52:55], v[228:231], v[192:195], v[52:55]
ds_read_b128 v[224:227], v248 offset:17408
v_mfma_f32_16x16x32_f16 v[60:63], v[228:231], v[196:199], v[60:63]
v_permlane16_swap_b32 v235, v239
s_waitcnt lgkmcnt(2)
v_mfma_f32_16x16x32_f16 v[64:67], v[240:243], v[192:195], v[64:67]
buffer_store_dwordx4 v[140:143], v255, s[8:11], s71 offen offset:128 sc1
ds_read_b128 v[228:231], v250 offset:4096
v_mfma_f32_16x16x32_f16 v[72:75], v[240:243], v[196:199], v[72:75]
s_waitcnt lgkmcnt(2)
v_mfma_f32_16x16x32_f16 v[68:71], v[244:247], v[192:195], v[68:71]
ds_read_b128 v[240:243], v250 offset:4352
v_permlane16_swap_b32 v208, v212
v_mfma_f32_16x16x32_f16 v[76:79], v[244:247], v[196:199], v[76:79]
s_waitcnt lgkmcnt(2)
v_mfma_f32_16x16x32_bf16 v[168:171], v[224:227], v[104:107], v[168:171]
ds_read_b128 v[244:247], v250 offset:8192
v_permlane16_swap_b32 v209, v213
v_mfma_f32_16x16x32_bf16 v[176:179], v[224:227], v[108:111], v[176:179]
s_waitcnt lgkmcnt(2)
v_mfma_f32_16x16x32_f16 v[80:83], v[228:231], v[192:195], v[80:83]
ds_read_b128 v[224:227], v250 offset:8448
v_mfma_f32_16x16x32_f16 v[88:91], v[228:231], v[196:199], v[88:91]
v_permlane16_swap_b32 v210, v214
s_waitcnt lgkmcnt(2)
v_mfma_f32_16x16x32_f16 v[84:87], v[240:243], v[192:195], v[84:87]
ds_read_b128 v[228:231], v248 offset:17664
v_mfma_f32_16x16x32_f16 v[92:95], v[240:243], v[196:199], v[92:95]
v_permlane16_swap_b32 v211, v215
s_waitcnt lgkmcnt(2)
v_mfma_f32_16x16x32_f16 v[48:51], v[244:247], v[200:203], v[48:51]
buffer_store_dwordx4 v[152:155], v255, s[8:11], s71 offen offset:256 sc1
ds_read_b128 v[240:243], v250 offset:9216
v_mfma_f32_16x16x32_f16 v[56:59], v[244:247], v[204:207], v[56:59]
s_waitcnt lgkmcnt(2)
v_mfma_f32_16x16x32_f16 v[52:55], v[224:227], v[200:203], v[52:55]
ds_read_b128 v[244:247], v250 offset:9472
v_mfma_f32_16x16x32_f16 v[60:63], v[224:227], v[204:207], v[60:63]
s_waitcnt lgkmcnt(2)
v_mfma_f32_16x16x32_bf16 v[172:175], v[228:231], v[104:107], v[172:175]
ds_read_b128 v[224:227], v250 offset:10240
v_mfma_f32_16x16x32_bf16 v[180:183], v[228:231], v[108:111], v[180:183]
s_waitcnt lgkmcnt(2)
v_mfma_f32_16x16x32_f16 v[64:67], v[240:243], v[200:203], v[64:67]
ds_read_b128 v[228:231], v250 offset:10496
v_mfma_f32_16x16x32_f16 v[72:75], v[240:243], v[204:207], v[72:75]
s_waitcnt lgkmcnt(2)
v_mfma_f32_16x16x32_f16 v[68:71], v[244:247], v[200:203], v[68:71]
ds_read_b128 v[240:243], v248 offset:18432
v_mfma_f32_16x16x32_f16 v[76:79], v[244:247], v[204:207], v[76:79]
s_waitcnt lgkmcnt(2)
v_mfma_f32_16x16x32_f16 v[80:83], v[224:227], v[200:203], v[80:83]
ds_read_b128 v[244:247], v250 offset:14336
v_permlane16_swap_b32 v216, v220
v_mfma_f32_16x16x32_f16 v[88:91], v[224:227], v[204:207], v[88:91]
s_waitcnt lgkmcnt(2)
v_mfma_f32_16x16x32_f16 v[84:87], v[228:231], v[200:203], v[84:87]
ds_read_b128 v[224:227], v250 offset:14592
v_mfma_f32_16x16x32_f16 v[92:95], v[228:231], v[204:207], v[92:95]
s_waitcnt lgkmcnt(2)
v_mfma_f32_16x16x32_bf16 v[168:171], v[240:243], v[112:115], v[168:171]
ds_read_b128 v[228:231], v250 offset:15360
v_mfma_f32_16x16x32_bf16 v[176:179], v[240:243], v[116:119], v[176:179]
s_waitcnt lgkmcnt(2)
v_mfma_f32_16x16x32_f16 v[48:51], v[244:247], v[232:235], v[48:51]
ds_read_b128 v[240:243], v250 offset:15616
v_mfma_f32_16x16x32_f16 v[56:59], v[244:247], v[236:239], v[56:59]
s_waitcnt lgkmcnt(2)
v_mfma_f32_16x16x32_f16 v[52:55], v[224:227], v[232:235], v[52:55]
ds_read_b128 v[244:247], v248 offset:18688
v_mfma_f32_16x16x32_f16 v[60:63], v[224:227], v[236:239], v[60:63]
s_waitcnt lgkmcnt(2)
v_mfma_f32_16x16x32_f16 v[64:67], v[228:231], v[232:235], v[64:67]
ds_read_b128 v[224:227], v250 offset:16384
v_mfma_f32_16x16x32_f16 v[72:75], v[228:231], v[236:239], v[72:75]
v_permlane16_swap_b32 v217, v221
s_waitcnt lgkmcnt(2)
v_mfma_f32_16x16x32_f16 v[68:71], v[240:243], v[232:235], v[68:71]
ds_read_b128 v[228:231], v250 offset:16640
v_mfma_f32_16x16x32_f16 v[76:79], v[240:243], v[236:239], v[76:79]
s_waitcnt lgkmcnt(2)
v_mfma_f32_16x16x32_bf16 v[172:175], v[244:247], v[112:115], v[172:175]
ds_read_b128 v[240:243], v250 offset:20480
v_mfma_f32_16x16x32_bf16 v[180:183], v[244:247], v[116:119], v[180:183]
s_waitcnt lgkmcnt(2)
v_mfma_f32_16x16x32_f16 v[80:83], v[224:227], v[232:235], v[80:83]
ds_read_b128 v[244:247], v250 offset:20736
v_mfma_f32_16x16x32_f16 v[88:91], v[224:227], v[236:239], v[88:91]
s_waitcnt lgkmcnt(2)
v_mfma_f32_16x16x32_f16 v[84:87], v[228:231], v[232:235], v[84:87]
ds_read_b128 v[224:227], v250 offset:21504
v_mfma_f32_16x16x32_f16 v[92:95], v[228:231], v[236:239], v[92:95]
s_waitcnt lgkmcnt(2)
v_mfma_f32_16x16x32_f16 v[48:51], v[240:243], v[208:211], v[48:51]
ds_read_b128 v[228:231], v250 offset:21760
v_mfma_f32_16x16x32_f16 v[56:59], v[240:243], v[212:215], v[56:59]
v_permlane16_swap_b32 v218, v222
s_waitcnt lgkmcnt(2)
v_mfma_f32_16x16x32_f16 v[52:55], v[244:247], v[208:211], v[52:55]
ds_read_b128 v[240:243], v250 offset:22528
v_mfma_f32_16x16x32_f16 v[60:63], v[244:247], v[212:215], v[60:63]
s_waitcnt lgkmcnt(2)
v_mfma_f32_16x16x32_f16 v[64:67], v[224:227], v[208:211], v[64:67]
ds_read_b128 v[244:247], v250 offset:22784
v_mfma_f32_16x16x32_f16 v[72:75], v[224:227], v[212:215], v[72:75]
s_waitcnt lgkmcnt(2)
v_mfma_f32_16x16x32_f16 v[68:71], v[228:231], v[208:211], v[68:71]
ds_read_b128 v[224:227], v250 offset:26624
v_mfma_f32_16x16x32_f16 v[76:79], v[228:231], v[212:215], v[76:79]
s_waitcnt lgkmcnt(2)
v_mfma_f32_16x16x32_f16 v[80:83], v[240:243], v[208:211], v[80:83]
ds_read_b128 v[228:231], v250 offset:26880
v_mfma_f32_16x16x32_f16 v[88:91], v[240:243], v[212:215], v[88:91]
s_waitcnt lgkmcnt(2)
v_mfma_f32_16x16x32_f16 v[84:87], v[244:247], v[208:211], v[84:87]
ds_read_b128 v[240:243], v248 offset:22528
v_mfma_f32_16x16x32_f16 v[92:95], v[244:247], v[212:215], v[92:95]
v_permlane16_swap_b32 v219, v223
s_setprio 3
s_waitcnt lgkmcnt(2)
v_mfma_f32_16x16x32_f16 v[48:51], v[224:227], v[216:219], v[48:51]
s_add_u32 s46, s70, 98304
buffer_load_dwordx4 v[208:211], v252, s[4:7], s46 offen offset:64
ds_read_b128 v[244:247], v250 offset:27648
v_cvt_pkrtz_f16_f32 v185, v168, v169
v_cvt_pkrtz_f16_f32 v187, v170, v171
v_cvt_pkrtz_f16_f32 v189, v172, v173
v_mfma_f32_16x16x32_f16 v[56:59], v[224:227], v[220:223], v[56:59]
v_cvt_pkrtz_f16_f32 v191, v174, v175
v_cvt_pkrtz_f16_f32 v193, v176, v177
v_cvt_pk_f16_f32 v203, v178, v179
s_waitcnt lgkmcnt(2)
v_mfma_f32_16x16x32_f16 v[52:55], v[228:231], v[216:219], v[52:55]
ds_read_b128 v[224:227], v248 offset:22784
v_cvt_pk_f16_f32 v200, v180, v181
v_cvt_pk_f16_f32 v197, v182, v183
v_pk_fma_f16 v202, v203, v203, s48
v_cvt_pk_bf16_f32 v144, v144, v145
v_mfma_f32_16x16x32_f16 v[60:63], v[228:231], v[220:223], v[60:63]
v_and_b32 v185, s49, v185
v_cvt_pk_bf16_f32 v145, v146, v147
v_pk_fma_f16 v199, v200, v200, s48
s_waitcnt lgkmcnt(2)
v_mfma_f32_16x16x32_bf16 v[168:171], v[240:243], v[96:99], 0
ds_read_b128 v[228:231], v250 offset:27904
v_and_b32 v187, s49, v187
v_cvt_pk_bf16_f32 v146, v148, v149
v_pk_fma_f16 v196, v197, v197, s48
v_mfma_f32_16x16x32_bf16 v[176:179], v[240:243], v[100:103], 0
v_bfe_u32 v184, v185, 2, 14
v_cvt_pk_bf16_f32 v147, v150, v151
v_pk_mul_f16 v202, v203, v202
v_cvt_pk_bf16_f32 v128, v128, v129
s_waitcnt lgkmcnt(2)
v_mfma_f32_16x16x32_f16 v[64:67], v[244:247], v[216:219], v[64:67]
ds_read_b128 v[240:243], v248 offset:23552
ds_read_u16_d16 v184, v184
v_bfe_u32 v186, v187, 2, 14
v_pk_mul_f16 v199, v200, v199
v_cvt_pk_bf16_f32 v129, v130, v131
v_mfma_f32_16x16x32_f16 v[72:75], v[244:247], v[220:223], v[72:75]
v_lshrrev_b32 v185, 18, v185
v_pk_mul_f16 v196, v197, v196
v_cvt_pk_bf16_f32 v130, v132, v133
s_waitcnt lgkmcnt(3)
v_mfma_f32_16x16x32_bf16 v[172:175], v[224:227], v[96:99], 0
ds_read_b128 v[244:247], v250 offset:28672
ds_read_u16_d16 v186, v186
ds_read_u16_d16_hi v185, v185
v_lshrrev_b32_e64 v187, 18, v187
v_cvt_pk_bf16_f32 v131, v134, v135
v_exp_f16_e64 v201, v202
v_mfma_f32_16x16x32_bf16 v[180:183], v[224:227], v[100:103], 0
v_cvt_pk_bf16_f32 v160, v160, v161
v_and_b32_e64 v189, s49, v189
v_and_b32 v191, s49, v191
s_waitcnt lgkmcnt(5)
v_mfma_f32_16x16x32_f16 v[68:71], v[228:231], v[216:219], v[68:71]
ds_read_b128 v[224:227], v250 offset:28928
ds_read_u16_d16_hi v187, v187
v_cvt_pk_bf16_f32 v161, v162, v163
v_exp_f16_e64 v198, v199
v_mfma_f32_16x16x32_f16 v[76:79], v[228:231], v[220:223], v[76:79]
v_cvt_pk_bf16_f32 v162, v164, v165
v_bfe_u32 v188, v189, 2, 14
v_cvt_pk_bf16_f32 v163, v166, v167
s_mov_b64 vcc, s[74:75]
v_bfe_u32 v190, v191, 2, 14
s_waitcnt lgkmcnt(5)
v_mfma_f32_16x16x32_bf16 v[168:171], v[240:243], v[104:107], v[168:171]
s_add_u32 s46, s70, 98304
buffer_load_dwordx4 v[204:207], v252, s[4:7], s46 offen offset:128
ds_read_b128 v[228:231], v248 offset:23808
ds_read_u16_d16 v188, v188
ds_read_u16_d16 v190, v190
v_exp_f16 v195, v196
v_cndmask_b32 v148, v128, v160, vcc
v_mfma_f32_16x16x32_bf16 v[176:179], v[240:243], v[108:111], v[176:179]
v_cndmask_b32 v149, v129, v161, vcc
v_lshrrev_b32 v189, 18, v189
v_lshrrev_b32 v191, 18, v191
s_waitcnt lgkmcnt(5)
v_mfma_f32_16x16x32_f16 v[80:83], v[244:247], v[216:219], v[80:83]
ds_read_b128 v[240:243], v248 offset:24576
ds_read_u16_d16_hi v189, v189
ds_read_u16_d16_hi v191, v191
v_cndmask_b32 v150, v130, v162, vcc
v_exp_f16_sdwa v201, v202 dst_sel:WORD_1 dst_unused:UNUSED_PRESERVE src0_sel:WORD_1
v_cndmask_b32 v151, v131, v163, vcc
v_mfma_f32_16x16x32_f16 v[88:91], v[244:247], v[220:223], v[88:91]
v_and_b32 v193, s49, v193
v_cndmask_b32_dpp v128, v144, v128, vcc quad_perm:[1,0,3,2] row_mask:0xf bank_mask:0xf
v_bfe_u32 v192, v193, 2, 14
s_waitcnt lgkmcnt(6)
v_mfma_f32_16x16x32_f16 v[84:87], v[224:227], v[216:219], v[84:87]
ds_read_b128 v[244:247], v248 offset:24832
ds_read_u16_d16 v192, v192
v_exp_f16_sdwa v198, v199 dst_sel:WORD_1 dst_unused:UNUSED_PRESERVE src0_sel:WORD_1
v_cndmask_b32_dpp v129, v145, v129, vcc quad_perm:[1,0,3,2] row_mask:0xf bank_mask:0xf
v_mfma_f32_16x16x32_f16 v[92:95], v[224:227], v[220:223], v[92:95]
v_lshrrev_b32_e64 v193, 18, v193
v_cndmask_b32_dpp v130, v146, v130, vcc quad_perm:[1,0,3,2] row_mask:0xf bank_mask:0xf
v_exp_f16_sdwa v195, v196 dst_sel:WORD_1 dst_unused:UNUSED_PRESERVE src0_sel:WORD_1
s_waitcnt lgkmcnt(5)
v_mfma_f32_16x16x32_bf16 v[172:175], v[228:231], v[104:107], v[172:175]
ds_read_b128 v[224:227], v249 offset:24576
ds_read_u16_d16_hi v193, v193
v_cndmask_b32_dpp v131, v147, v131, vcc quad_perm:[1,0,3,2] row_mask:0xf bank_mask:0xf
s_not_b64 vcc, s[74:75]
v_pk_add_f16 v201, v201, 1.0 op_sel_hi:[1,0]
v_cndmask_b32_dpp v160, v144, v160, vcc quad_perm:[1,0,3,2] row_mask:0xf bank_mask:0xf
v_mfma_f32_16x16x32_bf16 v[180:183], v[228:231], v[108:111], v[180:183]
v_pk_add_f16 v198, v198, 1.0 op_sel_hi:[1,0]
v_pk_add_f16 v195, v195, 1.0 op_sel_hi:[1,0]
v_cndmask_b32_dpp v161, v145, v161, vcc quad_perm:[1,0,3,2] row_mask:0xf bank_mask:0xf
s_waitcnt lgkmcnt(4)
v_mfma_f32_16x16x32_bf16 v[168:171], v[240:243], v[112:115], v[168:171]
ds_read_b128 v[228:231], v249 offset:24832
v_rcp_f16 v202, v201
v_cndmask_b32_dpp v162, v146, v162, vcc quad_perm:[1,0,3,2] row_mask:0xf bank_mask:0xf
v_mfma_f32_16x16x32_bf16 v[176:179], v[240:243], v[116:119], v[176:179]
v_rcp_f16 v199, v198
v_cndmask_b32_dpp v163, v147, v163, vcc quad_perm:[1,0,3,2] row_mask:0xf bank_mask:0xf
s_waitcnt lgkmcnt(3)
v_mfma_f32_16x16x32_bf16 v[172:175], v[244:247], v[112:115], v[172:175]
ds_read_b128 v[240:243], v248 offset:28672
s_add_u32 s46, s71, 98304
buffer_store_dwordx4 v[128:131], v255, s[8:11], s46 offen sc1
v_rcp_f16_e64 v196, v195
v_rcp_f16_sdwa v202, v201 dst_sel:WORD_1 dst_unused:UNUSED_PRESERVE src0_sel:WORD_1
v_mfma_f32_16x16x32_bf16 v[180:183], v[244:247], v[116:119], v[180:183]
v_rcp_f16_sdwa v199, v198 dst_sel:WORD_1 dst_unused:UNUSED_PRESERVE src0_sel:WORD_1
v_or_b32 v232, v184, v185
v_or_b32 v233, v186, v187
v_or_b32_e64 v234, v188, v189
v_rcp_f16_sdwa v196, v195 dst_sel:WORD_1 dst_unused:UNUSED_PRESERVE src0_sel:WORD_1
v_or_b32 v235, v190, v191
s_waitcnt lgkmcnt(2)
v_or_b32_e64 v236, v192, v193
v_pk_mul_f16 v237, v203, v202
v_pk_mul_f16 v238, v200, v199
v_pk_mul_f16 v239, v197, v196
v_mfma_f32_16x16x32_f16 v[48:51], v[224:227], v[232:235], v[48:51]
s_add_u32 s46, s71, 98304
buffer_store_dwordx4 v[148:151], v255, s[8:11], s46 offen offset:128 sc1
ds_read_b128 v[244:247], v249 offset:25600
ds_read_b128 v[216:219], v248 offset:28928
ds_read_b128 v[220:223], v249 offset:25856
v_cvt_pkrtz_f16_f32 v185, v168, v169
v_cvt_pkrtz_f16_f32 v187, v170, v171
v_mfma_f32_16x16x32_f16 v[56:59], v[224:227], v[236:239], v[56:59]
v_cvt_pkrtz_f16_f32 v189, v172, v173
v_cvt_pkrtz_f16_f32 v191, v174, v175
s_waitcnt lgkmcnt(3)
v_mfma_f32_16x16x32_f16 v[52:55], v[228:231], v[232:235], v[52:55]
ds_read_b128 v[224:227], v248 offset:29696
v_cvt_pkrtz_f16_f32 v193, v176, v177
v_cvt_pk_f16_f32 v203, v178, v179
v_mfma_f32_16x16x32_f16 v[60:63], v[228:231], v[236:239], v[60:63]
v_cvt_pk_f16_f32 v200, v180, v181
v_cvt_pk_f16_f32 v197, v182, v183
v_mfma_f32_16x16x32_bf16 v[168:171], v[240:243], v[96:99], 0
ds_read_b128 v[228:231], v249 offset:26624
v_pk_fma_f16 v202, v203, v203, s48
v_and_b32 v185, s49, v185
v_mfma_f32_16x16x32_bf16 v[176:179], v[240:243], v[100:103], 0
v_pk_fma_f16 v199, v200, v200, s48
v_and_b32 v187, s49, v187
s_waitcnt lgkmcnt(4)
v_mfma_f32_16x16x32_f16 v[64:67], v[244:247], v[232:235], v[64:67]
ds_read_b128 v[240:243], v249 offset:26880
v_pk_fma_f16 v196, v197, v197, s48
s_setprio 2
v_bfe_u32 v184, v185, 2, 14
v_pk_mul_f16 v202, v203, v202
v_mfma_f32_16x16x32_f16 v[72:75], v[244:247], v[236:239], v[72:75]
v_bfe_u32 v186, v187, 2, 14
v_pk_mul_f16 v199, v200, v199
s_waitcnt vmcnt(10)
v_mfma_f32_16x16x32_bf16 v[48:51], v[18:21], v[4:7], v[48:51]
ds_read_b128 v[244:247], v248 offset:29952
ds_read_u16_d16 v184, v184
ds_read_u16_d16 v186, v186
v_lshrrev_b32_e64 v185, 18, v185
v_pk_mul_f16 v196, v197, v196
v_mfma_f32_16x16x32_bf16 v[52:55], v[16:19], v[4:7], v[52:55]
v_lshrrev_b32 v187, 18, v187
s_waitcnt lgkmcnt(4)
v_mfma_f32_16x16x32_bf16 v[172:175], v[216:219], v[96:99], 0
ds_read_u16_d16_hi v185, v185
ds_read_u16_d16_hi v187, v187
v_exp_f16 v201, v202
v_and_b32 v189, s49, v189
v_mfma_f32_16x16x32_bf16 v[180:183], v[216:219], v[100:103], 0
v_and_b32_e64 v191, s49, v191
v_mfma_f32_16x16x32_f16 v[68:71], v[220:223], v[232:235], v[68:71]
ds_read_b128 v[216:219], v248 offset:30720
v_exp_f16_e64 v198, v199
v_bfe_u32 v188, v189, 2, 14
v_mfma_f32_16x16x32_f16 v[76:79], v[220:223], v[236:239], v[76:79]
v_bfe_u32 v190, v191, 2, 14
v_exp_f16_e64 v195, v196
v_mfma_f32_16x16x32_bf16 v[168:171], v[224:227], v[104:107], v[168:171]
ds_read_b128 v[220:223], v248 offset:30976
ds_read_u16_d16 v188, v188
ds_read_u16_d16 v190, v190
v_lshrrev_b32 v189, 18, v189
v_lshrrev_b32 v191, 18, v191
v_mfma_f32_16x16x32_bf16 v[176:179], v[224:227], v[108:111], v[176:179]
v_exp_f16_sdwa v201, v202 dst_sel:WORD_1 dst_unused:UNUSED_PRESERVE src0_sel:WORD_1
v_mfma_f32_16x16x32_f16 v[80:83], v[228:231], v[232:235], v[80:83]
ds_read_b128 v[224:227], v249 offset:30720
ds_read_u16_d16_hi v189, v189
ds_read_u16_d16_hi v191, v191
v_and_b32 v193, s49, v193
v_bfe_u32 v192, v193, 2, 14
v_mfma_f32_16x16x32_f16 v[88:91], v[228:231], v[236:239], v[88:91]
v_exp_f16_sdwa v198, v199 dst_sel:WORD_1 dst_unused:UNUSED_PRESERVE src0_sel:WORD_1
s_waitcnt lgkmcnt(7)
v_mfma_f32_16x16x32_f16 v[84:87], v[240:243], v[232:235], v[84:87]
ds_read_b128 v[228:231], v249 offset:30976
ds_read_u16_d16 v192, v192
v_lshrrev_b32_e64 v193, 18, v193
v_mfma_f32_16x16x32_f16 v[92:95], v[240:243], v[236:239], v[92:95]
v_exp_f16_sdwa v195, v196 dst_sel:WORD_1 dst_unused:UNUSED_PRESERVE src0_sel:WORD_1
v_pk_add_f16 v201, v201, 1.0 op_sel_hi:[1,0]
v_pk_add_f16 v198, v198, 1.0 op_sel_hi:[1,0]
v_mfma_f32_16x16x32_bf16 v[172:175], v[244:247], v[104:107], v[172:175]
ds_read_b128 v[240:243], v248 offset:34816
ds_read_u16_d16_hi v193, v193
v_pk_add_f16 v195, v195, 1.0 op_sel_hi:[1,0]
v_mfma_f32_16x16x32_bf16 v[180:183], v[244:247], v[108:111], v[180:183]
v_rcp_f16 v202, v201
s_waitcnt lgkmcnt(7)
v_mfma_f32_16x16x32_bf16 v[168:171], v[216:219], v[112:115], v[168:171]
ds_read_b128 v[244:247], v249 offset:31744
v_rcp_f16_e64 v199, v198
v_mfma_f32_16x16x32_bf16 v[176:179], v[216:219], v[116:119], v[176:179]
v_rcp_f16_e64 v196, v195
v_mfma_f32_16x16x32_bf16 v[172:175], v[220:223], v[112:115], v[172:175]
ds_read_b128 v[216:219], v248 offset:35072
v_rcp_f16_sdwa v202, v201 dst_sel:WORD_1 dst_unused:UNUSED_PRESERVE src0_sel:WORD_1
v_mfma_f32_16x16x32_bf16 v[180:183], v[220:223], v[116:119], v[180:183]
v_rcp_f16_sdwa v199, v198 dst_sel:WORD_1 dst_unused:UNUSED_PRESERVE src0_sel:WORD_1
v_or_b32 v232, v184, v185
v_or_b32 v233, v186, v187
s_waitcnt lgkmcnt(4)
v_or_b32 v234, v188, v189
v_rcp_f16_sdwa v196, v195 dst_sel:WORD_1 dst_unused:UNUSED_PRESERVE src0_sel:WORD_1
v_or_b32 v235, v190, v191
s_waitcnt lgkmcnt(2)
v_or_b32_e64 v236, v192, v193
v_pk_mul_f16 v237, v203, v202
v_pk_mul_f16 v238, v200, v199
v_pk_mul_f16 v239, v197, v196
v_mfma_f32_16x16x32_f16 v[48:51], v[224:227], v[232:235], v[48:51]
s_add_u32 s46, s71, 98304
buffer_store_dwordx4 v[160:163], v255, s[8:11], s46 offen offset:256 sc1
ds_read_b128 v[220:223], v249 offset:32000
v_cvt_pkrtz_f16_f32 v185, v168, v169
v_cvt_pkrtz_f16_f32 v187, v170, v171
v_mfma_f32_16x16x32_f16 v[56:59], v[224:227], v[236:239], v[56:59]
v_cvt_pkrtz_f16_f32 v189, v172, v173
v_cvt_pkrtz_f16_f32 v191, v174, v175
v_mfma_f32_16x16x32_f16 v[52:55], v[228:231], v[232:235], v[52:55]
ds_read_b128 v[224:227], v248 offset:35840
v_cvt_pkrtz_f16_f32 v193, v176, v177
v_cvt_pk_f16_f32 v203, v178, v179
v_mfma_f32_16x16x32_f16 v[60:63], v[228:231], v[236:239], v[60:63]
v_cvt_pk_f16_f32 v200, v180, v181
v_cvt_pk_f16_f32 v197, v182, v183
s_setprio 1
v_mfma_f32_16x16x32_bf16 v[168:171], v[240:243], v[96:99], 0
ds_read_b128 v[228:231], v249 offset:32768
v_pk_fma_f16 v202, v203, v203, s48
v_and_b32 v185, s49, v185
v_mfma_f32_16x16x32_bf16 v[176:179], v[240:243], v[100:103], 0
v_pk_fma_f16 v199, v200, v200, s48
v_and_b32 v187, s49, v187
s_waitcnt lgkmcnt(3)
v_mfma_f32_16x16x32_f16 v[64:67], v[244:247], v[232:235], v[64:67]
ds_read_b128 v[240:243], v249 offset:33024
v_pk_fma_f16 v196, v197, v197, s48
v_bfe_u32 v184, v185, 2, 14
v_pk_mul_f16 v202, v203, v202
v_mfma_f32_16x16x32_f16 v[72:75], v[244:247], v[236:239], v[72:75]
v_bfe_u32 v186, v187, 2, 14
v_pk_mul_f16 v199, v200, v199
s_waitcnt vmcnt(10)
v_mfma_f32_16x16x32_bf16 v[64:67], v[18:21], v[0:3], v[64:67]
ds_read_b128 v[244:247], v248 offset:36096
ds_read_u16_d16 v184, v184
ds_read_u16_d16 v186, v186
v_lshrrev_b32 v185, 18, v185
v_pk_mul_f16 v196, v197, v196
v_mfma_f32_16x16x32_bf16 v[68:71], v[16:19], v[0:3], v[68:71]
v_lshrrev_b32_e64 v187, 18, v187
v_mfma_f32_16x16x32_bf16 v[172:175], v[216:219], v[96:99], 0
ds_read_u16_d16_hi v185, v185
ds_read_u16_d16_hi v187, v187
v_exp_f16 v201, v202
v_and_b32 v189, s49, v189
v_mfma_f32_16x16x32_bf16 v[180:183], v[216:219], v[100:103], 0
v_and_b32 v191, s49, v191
s_waitcnt lgkmcnt(6)
v_mfma_f32_16x16x32_f16 v[68:71], v[220:223], v[232:235], v[68:71]
ds_read_b128 v[216:219], v248 offset:36864
v_exp_f16_e64 v198, v199
v_bfe_u32 v188, v189, 2, 14
v_mfma_f32_16x16x32_f16 v[76:79], v[220:223], v[236:239], v[76:79]
v_bfe_u32 v190, v191, 2, 14
v_exp_f16_e64 v195, v196
v_mfma_f32_16x16x32_bf16 v[168:171], v[224:227], v[104:107], v[168:171]
ds_read_b128 v[220:223], v248 offset:37120
ds_read_u16_d16 v188, v188
ds_read_u16_d16 v190, v190
v_lshrrev_b32 v189, 18, v189
v_lshrrev_b32 v191, 18, v191
v_mfma_f32_16x16x32_bf16 v[176:179], v[224:227], v[108:111], v[176:179]
v_exp_f16_sdwa v201, v202 dst_sel:WORD_1 dst_unused:UNUSED_PRESERVE src0_sel:WORD_1
v_mfma_f32_16x16x32_f16 v[80:83], v[228:231], v[232:235], v[80:83]
ds_read_b128 v[224:227], v249 offset:36864
ds_read_u16_d16_hi v189, v189
ds_read_u16_d16_hi v191, v191
v_and_b32 v193, s49, v193
v_bfe_u32 v192, v193, 2, 14
v_mfma_f32_16x16x32_f16 v[88:91], v[228:231], v[236:239], v[88:91]
v_exp_f16_sdwa v198, v199 dst_sel:WORD_1 dst_unused:UNUSED_PRESERVE src0_sel:WORD_1
s_waitcnt lgkmcnt(7)
v_mfma_f32_16x16x32_f16 v[84:87], v[240:243], v[232:235], v[84:87]
ds_read_b128 v[228:231], v249 offset:37120
ds_read_u16_d16 v192, v192
v_lshrrev_b32_e64 v193, 18, v193
v_mfma_f32_16x16x32_f16 v[92:95], v[240:243], v[236:239], v[92:95]
v_exp_f16_sdwa v195, v196 dst_sel:WORD_1 dst_unused:UNUSED_PRESERVE src0_sel:WORD_1
v_pk_add_f16 v201, v201, 1.0 op_sel_hi:[1,0]
v_pk_add_f16 v198, v198, 1.0 op_sel_hi:[1,0]
v_mfma_f32_16x16x32_bf16 v[172:175], v[244:247], v[104:107], v[172:175]
ds_read_b128 v[240:243], v248 offset:16384
ds_read_u16_d16_hi v193, v193
v_pk_add_f16 v195, v195, 1.0 op_sel_hi:[1,0]
v_mfma_f32_16x16x32_bf16 v[180:183], v[244:247], v[108:111], v[180:183]
v_rcp_f16_e64 v202, v201
s_setprio 0
s_waitcnt lgkmcnt(7)
v_mfma_f32_16x16x32_bf16 v[168:171], v[216:219], v[112:115], v[168:171]
ds_read_b128 v[244:247], v249 offset:37888
v_rcp_f16_e64 v199, v198
v_mfma_f32_16x16x32_bf16 v[176:179], v[216:219], v[116:119], v[176:179]
v_rcp_f16_e64 v196, v195
v_mfma_f32_16x16x32_bf16 v[172:175], v[220:223], v[112:115], v[172:175]
ds_read_b128 v[216:219], v248 offset:16640
v_rcp_f16_sdwa v202, v201 dst_sel:WORD_1 dst_unused:UNUSED_PRESERVE src0_sel:WORD_1
v_mfma_f32_16x16x32_bf16 v[180:183], v[220:223], v[116:119], v[180:183]
v_rcp_f16_sdwa v199, v198 dst_sel:WORD_1 dst_unused:UNUSED_PRESERVE src0_sel:WORD_1
v_or_b32 v232, v184, v185
v_or_b32 v233, v186, v187
s_waitcnt lgkmcnt(4)
v_or_b32 v234, v188, v189
v_rcp_f16_sdwa v196, v195 dst_sel:WORD_1 dst_unused:UNUSED_PRESERVE src0_sel:WORD_1
v_or_b32 v235, v190, v191
s_waitcnt lgkmcnt(2)
v_or_b32 v236, v192, v193
v_pk_mul_f16 v237, v203, v202
v_pk_mul_f16 v238, v200, v199
v_pk_mul_f16 v239, v197, v196
s_setprio 3
v_mfma_f32_16x16x32_f16 v[48:51], v[224:227], v[232:235], v[48:51]
s_add_u32 s46, s80, 12582912
buffer_load_dwordx4 v[96:99], v253, s[32:35], s46 offen nt
ds_read_b128 v[220:223], v249 offset:38144
v_cvt_pkrtz_f16_f32 v185, v168, v169
v_cvt_pkrtz_f16_f32 v187, v170, v171
v_mfma_f32_16x16x32_f16 v[56:59], v[224:227], v[236:239], v[56:59]
v_cvt_pkrtz_f16_f32 v189, v172, v173
v_cvt_pkrtz_f16_f32 v191, v174, v175
v_mfma_f32_16x16x32_f16 v[52:55], v[228:231], v[232:235], v[52:55]
ds_read_b128 v[224:227], v248 offset:17408
v_cvt_pkrtz_f16_f32 v193, v176, v177
v_cvt_pk_f16_f32 v203, v178, v179
v_mfma_f32_16x16x32_f16 v[60:63], v[228:231], v[236:239], v[60:63]
v_cvt_pk_f16_f32 v200, v180, v181
v_cvt_pk_f16_f32 v197, v182, v183
v_mfma_f32_16x16x32_bf16 v[168:171], v[240:243], v[24:27], 0
ds_read_b128 v[228:231], v249 offset:38912
v_pk_fma_f16 v202, v203, v203, s48
v_and_b32_e64 v185, s49, v185
v_mfma_f32_16x16x32_bf16 v[176:179], v[240:243], v[28:31], 0
v_pk_fma_f16 v199, v200, v200, s48
v_and_b32 v187, s49, v187
s_waitcnt lgkmcnt(3)
v_mfma_f32_16x16x32_f16 v[64:67], v[244:247], v[232:235], v[64:67]
ds_read_b128 v[240:243], v249 offset:39168
v_pk_fma_f16 v196, v197, v197, s48
v_bfe_u32 v184, v185, 2, 14
v_pk_mul_f16 v202, v203, v202
v_mfma_f32_16x16x32_f16 v[72:75], v[244:247], v[236:239], v[72:75]
v_bfe_u32 v186, v187, 2, 14
v_pk_mul_f16 v199, v200, v199
s_waitcnt vmcnt(10)
v_mfma_f32_16x16x32_bf16 v[80:83], v[18:21], v[8:11], v[80:83]
ds_read_b128 v[244:247], v248 offset:17664
ds_read_u16_d16 v184, v184
ds_read_u16_d16 v186, v186
v_lshrrev_b32 v185, 18, v185
v_pk_mul_f16 v196, v197, v196
v_mfma_f32_16x16x32_bf16 v[84:87], v[16:19], v[8:11], v[84:87]
v_lshrrev_b32_e64 v187, 18, v187
v_mfma_f32_16x16x32_bf16 v[172:175], v[216:219], v[24:27], 0
ds_read_u16_d16_hi v185, v185
ds_read_u16_d16_hi v187, v187
v_exp_f16 v201, v202
v_and_b32 v189, s49, v189
v_mfma_f32_16x16x32_bf16 v[180:183], v[216:219], v[28:31], 0
v_and_b32 v191, s49, v191
s_waitcnt lgkmcnt(6)
v_mfma_f32_16x16x32_f16 v[68:71], v[220:223], v[232:235], v[68:71]
ds_read_b128 v[216:219], v248 offset:18432
v_exp_f16_e64 v198, v199
v_bfe_u32 v188, v189, 2, 14
v_mfma_f32_16x16x32_f16 v[76:79], v[220:223], v[236:239], v[76:79]
v_bfe_u32 v190, v191, 2, 14
v_exp_f16_e64 v195, v196
v_mfma_f32_16x16x32_bf16 v[168:171], v[224:227], v[32:35], v[168:171]
ds_read_b128 v[220:223], v248 offset:18688
ds_read_u16_d16 v188, v188
ds_read_u16_d16 v190, v190
v_lshrrev_b32 v189, 18, v189
v_lshrrev_b32 v191, 18, v191
v_mfma_f32_16x16x32_bf16 v[176:179], v[224:227], v[36:39], v[176:179]
v_exp_f16_sdwa v201, v202 dst_sel:WORD_1 dst_unused:UNUSED_PRESERVE src0_sel:WORD_1
v_mfma_f32_16x16x32_f16 v[80:83], v[228:231], v[232:235], v[80:83]
ds_read_b128 v[224:227], v249 offset:43008
ds_read_u16_d16_hi v189, v189
ds_read_u16_d16_hi v191, v191
v_and_b32 v193, s49, v193
v_bfe_u32 v192, v193, 2, 14
v_mfma_f32_16x16x32_f16 v[88:91], v[228:231], v[236:239], v[88:91]
v_exp_f16_sdwa v198, v199 dst_sel:WORD_1 dst_unused:UNUSED_PRESERVE src0_sel:WORD_1
s_waitcnt lgkmcnt(7)
v_mfma_f32_16x16x32_f16 v[84:87], v[240:243], v[232:235], v[84:87]
ds_read_b128 v[228:231], v249 offset:43264
ds_read_u16_d16 v192, v192
v_lshrrev_b32_e64 v193, 18, v193
v_mfma_f32_16x16x32_f16 v[92:95], v[240:243], v[236:239], v[92:95]
v_exp_f16_sdwa v195, v196 dst_sel:WORD_1 dst_unused:UNUSED_PRESERVE src0_sel:WORD_1
v_pk_add_f16 v201, v201, 1.0 op_sel_hi:[1,0]
v_pk_add_f16 v198, v198, 1.0 op_sel_hi:[1,0]
v_mfma_f32_16x16x32_bf16 v[172:175], v[244:247], v[32:35], v[172:175]
ds_read_b128 v[240:243], v248 offset:22528
ds_read_u16_d16_hi v193, v193
v_pk_add_f16 v195, v195, 1.0 op_sel_hi:[1,0]
v_mfma_f32_16x16x32_bf16 v[180:183], v[244:247], v[36:39], v[180:183]
v_rcp_f16 v202, v201
s_waitcnt lgkmcnt(7)
v_mfma_f32_16x16x32_bf16 v[168:171], v[216:219], v[40:43], v[168:171]
ds_read_b128 v[244:247], v249 offset:44032
v_rcp_f16_e64 v199, v198
v_mfma_f32_16x16x32_bf16 v[176:179], v[216:219], v[44:47], v[176:179]
v_rcp_f16_e64 v196, v195
v_mfma_f32_16x16x32_bf16 v[172:175], v[220:223], v[40:43], v[172:175]
ds_read_b128 v[216:219], v248 offset:22784
v_rcp_f16_sdwa v202, v201 dst_sel:WORD_1 dst_unused:UNUSED_PRESERVE src0_sel:WORD_1
v_mfma_f32_16x16x32_bf16 v[180:183], v[220:223], v[44:47], v[180:183]
v_rcp_f16_sdwa v199, v198 dst_sel:WORD_1 dst_unused:UNUSED_PRESERVE src0_sel:WORD_1
v_or_b32 v232, v184, v185
v_or_b32 v233, v186, v187
s_waitcnt lgkmcnt(4)
v_or_b32 v234, v188, v189
v_rcp_f16_sdwa v196, v195 dst_sel:WORD_1 dst_unused:UNUSED_PRESERVE src0_sel:WORD_1
v_or_b32 v235, v190, v191
s_waitcnt lgkmcnt(2)
v_or_b32_e64 v236, v192, v193
v_pk_mul_f16 v237, v203, v202
v_pk_mul_f16 v238, v200, v199
v_pk_mul_f16 v239, v197, v196
v_mfma_f32_16x16x32_f16 v[48:51], v[224:227], v[232:235], v[48:51]
s_add_u32 s46, s80, 12582912
buffer_load_dwordx4 v[100:103], v253, s[32:35], s46 offen offset:256 nt
ds_read_b128 v[220:223], v249 offset:44288
v_cvt_pkrtz_f16_f32 v185, v168, v169
v_cvt_pkrtz_f16_f32 v187, v170, v171
v_mfma_f32_16x16x32_f16 v[56:59], v[224:227], v[236:239], v[56:59]
v_cvt_pkrtz_f16_f32 v189, v172, v173
v_cvt_pkrtz_f16_f32 v191, v174, v175
v_mfma_f32_16x16x32_f16 v[52:55], v[228:231], v[232:235], v[52:55]
ds_read_b128 v[224:227], v248 offset:23552
v_cvt_pkrtz_f16_f32 v193, v176, v177
v_cvt_pk_f16_f32 v203, v178, v179
v_mfma_f32_16x16x32_f16 v[60:63], v[228:231], v[236:239], v[60:63]
v_cvt_pk_f16_f32 v200, v180, v181
v_cvt_pk_f16_f32 v197, v182, v183
v_mfma_f32_16x16x32_bf16 v[168:171], v[240:243], v[24:27], 0
ds_read_b128 v[228:231], v249 offset:45056
v_pk_fma_f16 v202, v203, v203, s48
v_and_b32_e64 v185, s49, v185
v_mfma_f32_16x16x32_bf16 v[176:179], v[240:243], v[28:31], 0
v_pk_fma_f16 v199, v200, v200, s48
v_and_b32 v187, s49, v187
s_waitcnt lgkmcnt(3)
v_mfma_f32_16x16x32_f16 v[64:67], v[244:247], v[232:235], v[64:67]
ds_read_b128 v[240:243], v249 offset:45312
v_pk_fma_f16 v196, v197, v197, s48
s_setprio 2
v_bfe_u32 v184, v185, 2, 14
v_pk_mul_f16 v202, v203, v202
v_mfma_f32_16x16x32_f16 v[72:75], v[244:247], v[236:239], v[72:75]
v_bfe_u32 v186, v187, 2, 14
v_pk_mul_f16 v199, v200, v199
s_waitcnt vmcnt(9)
v_mfma_f32_16x16x32_bf16 v[56:59], v[18:21], v[12:15], v[56:59]
ds_read_b128 v[244:247], v248 offset:23808
ds_read_u16_d16 v184, v184
ds_read_u16_d16 v186, v186
v_lshrrev_b32_e64 v185, 18, v185
v_pk_mul_f16 v196, v197, v196
v_mfma_f32_16x16x32_bf16 v[60:63], v[16:19], v[12:15], v[60:63]
v_lshrrev_b32_e64 v187, 18, v187
v_mfma_f32_16x16x32_bf16 v[172:175], v[216:219], v[24:27], 0
ds_read_u16_d16_hi v185, v185
ds_read_u16_d16_hi v187, v187
v_exp_f16 v201, v202
v_and_b32 v189, s49, v189
v_mfma_f32_16x16x32_bf16 v[180:183], v[216:219], v[28:31], 0
v_and_b32 v191, s49, v191
s_waitcnt lgkmcnt(6)
v_mfma_f32_16x16x32_f16 v[68:71], v[220:223], v[232:235], v[68:71]
ds_read_b128 v[216:219], v248 offset:24576
v_exp_f16_e64 v198, v199
v_bfe_u32 v188, v189, 2, 14
v_mfma_f32_16x16x32_f16 v[76:79], v[220:223], v[236:239], v[76:79]
v_bfe_u32 v190, v191, 2, 14
v_exp_f16_e64 v195, v196
v_mfma_f32_16x16x32_bf16 v[168:171], v[224:227], v[32:35], v[168:171]
ds_read_b128 v[220:223], v248 offset:24832
ds_read_u16_d16 v188, v188
ds_read_u16_d16 v190, v190
v_lshrrev_b32 v189, 18, v189
v_lshrrev_b32 v191, 18, v191
v_mfma_f32_16x16x32_bf16 v[176:179], v[224:227], v[36:39], v[176:179]
v_exp_f16_sdwa v201, v202 dst_sel:WORD_1 dst_unused:UNUSED_PRESERVE src0_sel:WORD_1
v_mfma_f32_16x16x32_f16 v[80:83], v[228:231], v[232:235], v[80:83]
ds_read_b128 v[224:227], v249 offset:24576
ds_read_u16_d16_hi v189, v189
ds_read_u16_d16_hi v191, v191
v_and_b32 v193, s49, v193
v_bfe_u32 v192, v193, 2, 14
v_mfma_f32_16x16x32_f16 v[88:91], v[228:231], v[236:239], v[88:91]
v_exp_f16_sdwa v198, v199 dst_sel:WORD_1 dst_unused:UNUSED_PRESERVE src0_sel:WORD_1
s_waitcnt lgkmcnt(7)
v_mfma_f32_16x16x32_f16 v[84:87], v[240:243], v[232:235], v[84:87]
ds_read_b128 v[228:231], v254 offset:7936
ds_read_u16_d16 v192, v192
v_lshrrev_b32_e64 v193, 18, v193
v_mfma_f32_16x16x32_f16 v[92:95], v[240:243], v[236:239], v[92:95]
v_exp_f16_sdwa v195, v196 dst_sel:WORD_1 dst_unused:UNUSED_PRESERVE src0_sel:WORD_1
v_pk_add_f16 v201, v201, 1.0 op_sel_hi:[1,0]
v_pk_add_f16 v198, v198, 1.0 op_sel_hi:[1,0]
v_mfma_f32_16x16x32_bf16 v[172:175], v[244:247], v[32:35], v[172:175]
ds_read_b128 v[240:243], v249 offset:24832
ds_read_u16_d16_hi v193, v193
v_pk_add_f16 v195, v195, 1.0 op_sel_hi:[1,0]
v_mfma_f32_16x16x32_bf16 v[180:183], v[244:247], v[36:39], v[180:183]
v_rcp_f16 v202, v201
s_waitcnt lgkmcnt(7)
v_mfma_f32_16x16x32_bf16 v[168:171], v[216:219], v[40:43], v[168:171]
ds_read_b128 v[244:247], v254 offset:7952
v_rcp_f16_e64 v199, v198
v_mfma_f32_16x16x32_bf16 v[176:179], v[216:219], v[44:47], v[176:179]
v_rcp_f16_e64 v196, v195
v_mfma_f32_16x16x32_bf16 v[172:175], v[220:223], v[40:43], v[172:175]
ds_read_b128 v[216:219], v248 offset:28672
v_rcp_f16_sdwa v202, v201 dst_sel:WORD_1 dst_unused:UNUSED_PRESERVE src0_sel:WORD_1
v_mfma_f32_16x16x32_bf16 v[180:183], v[220:223], v[44:47], v[180:183]
v_rcp_f16_sdwa v199, v198 dst_sel:WORD_1 dst_unused:UNUSED_PRESERVE src0_sel:WORD_1
v_or_b32 v232, v184, v185
v_or_b32 v233, v186, v187
s_waitcnt lgkmcnt(4)
v_or_b32 v234, v188, v189
v_rcp_f16_sdwa v196, v195 dst_sel:WORD_1 dst_unused:UNUSED_PRESERVE src0_sel:WORD_1
v_or_b32 v235, v190, v191
s_waitcnt lgkmcnt(2)
v_or_b32 v236, v192, v193
v_pk_mul_f16 v237, v203, v202
v_pk_mul_f16 v238, v200, v199
v_pk_mul_f16 v239, v197, v196
v_mfma_f32_16x16x32_f16 v[120:123], v[224:227], v[232:235], v[228:231]
s_add_u32 s46, s80, 16777216
buffer_load_dwordx4 v[104:107], v253, s[32:35], s46 offen nt
ds_read_b128 v[220:223], v249 offset:25600
v_cvt_pkrtz_f16_f32 v185, v168, v169
v_cvt_pkrtz_f16_f32 v187, v170, v171
v_mfma_f32_16x16x32_f16 v[128:131], v[224:227], v[236:239], v[228:231]
v_cvt_pkrtz_f16_f32 v189, v172, v173
v_cvt_pkrtz_f16_f32 v191, v174, v175
s_waitcnt lgkmcnt(2)
v_mfma_f32_16x16x32_f16 v[124:127], v[240:243], v[232:235], v[244:247]
ds_read_b128 v[224:227], v254 offset:8064
ds_read_b128 v[228:231], v248 offset:28928
v_cvt_pkrtz_f16_f32 v193, v176, v177
v_cvt_pk_f16_f32 v203, v178, v179
v_mfma_f32_16x16x32_f16 v[132:135], v[240:243], v[236:239], v[244:247]
v_cvt_pk_f16_f32 v200, v180, v181
v_cvt_pk_f16_f32 v197, v182, v183
s_setprio 1
s_waitcnt lgkmcnt(3)
v_mfma_f32_16x16x32_bf16 v[168:171], v[216:219], v[24:27], 0
ds_read_b128 v[240:243], v249 offset:25856
ds_read_b128 v[244:247], v254 offset:8080
v_pk_fma_f16 v202, v203, v203, s48
v_and_b32_e64 v185, s49, v185
v_mfma_f32_16x16x32_bf16 v[176:179], v[216:219], v[28:31], 0
v_pk_fma_f16 v199, v200, v200, s48
v_and_b32 v187, s49, v187
s_waitcnt lgkmcnt(3)
v_mfma_f32_16x16x32_f16 v[136:139], v[220:223], v[232:235], v[224:227]
ds_read_b128 v[216:219], v248 offset:29696
v_pk_fma_f16 v196, v197, v197, s48
v_bfe_u32 v184, v185, 2, 14
v_pk_mul_f16 v202, v203, v202
v_mfma_f32_16x16x32_f16 v[144:147], v[220:223], v[236:239], v[224:227]
v_bfe_u32 v186, v187, 2, 14
v_pk_mul_f16 v199, v200, v199
s_waitcnt vmcnt(7)
v_mfma_f32_16x16x32_bf16 v[72:75], v[18:21], v[208:211], v[72:75]
ds_read_b128 v[220:223], v249 offset:26624
ds_read_b128 v[224:227], v254 offset:16128
ds_read_u16_d16 v184, v184
ds_read_u16_d16 v186, v186
v_lshrrev_b32 v185, 18, v185
v_pk_mul_f16 v196, v197, v196
v_mfma_f32_16x16x32_bf16 v[76:79], v[16:19], v[208:211], v[76:79]
v_lshrrev_b32 v187, 18, v187
s_waitcnt lgkmcnt(5)
v_mfma_f32_16x16x32_bf16 v[172:175], v[228:231], v[24:27], 0
ds_read_u16_d16_hi v185, v185
ds_read_u16_d16_hi v187, v187
v_exp_f16 v201, v202
v_and_b32 v189, s49, v189
v_mfma_f32_16x16x32_bf16 v[180:183], v[228:231], v[28:31], 0
v_and_b32_e64 v191, s49, v191
v_mfma_f32_16x16x32_f16 v[140:143], v[240:243], v[232:235], v[244:247]
ds_read_b128 v[228:231], v249 offset:26880
v_exp_f16_e64 v198, v199
v_bfe_u32 v188, v189, 2, 14
v_mfma_f32_16x16x32_f16 v[148:151], v[240:243], v[236:239], v[244:247]
v_bfe_u32 v190, v191, 2, 14
v_exp_f16 v195, v196
s_waitcnt lgkmcnt(7)
v_mfma_f32_16x16x32_bf16 v[168:171], v[216:219], v[32:35], v[168:171]
ds_read_b128 v[240:243], v254 offset:16144
ds_read_b128 v[244:247], v248 offset:29952
ds_read_u16_d16 v188, v188
ds_read_u16_d16 v190, v190
v_lshrrev_b32_e64 v189, 18, v189
v_lshrrev_b32 v191, 18, v191
v_mfma_f32_16x16x32_bf16 v[176:179], v[216:219], v[36:39], v[176:179]
v_exp_f16_sdwa v201, v202 dst_sel:WORD_1 dst_unused:UNUSED_PRESERVE src0_sel:WORD_1
s_waitcnt lgkmcnt(7)
v_mfma_f32_16x16x32_f16 v[152:155], v[220:223], v[232:235], v[224:227]
ds_read_b128 v[216:219], v248 offset:30720
ds_read_u16_d16_hi v189, v189
ds_read_u16_d16_hi v191, v191
v_and_b32 v193, s49, v193
v_bfe_u32 v192, v193, 2, 14
v_mfma_f32_16x16x32_f16 v[160:163], v[220:223], v[236:239], v[224:227]
v_exp_f16_sdwa v198, v199 dst_sel:WORD_1 dst_unused:UNUSED_PRESERVE src0_sel:WORD_1
s_waitcnt lgkmcnt(6)
v_mfma_f32_16x16x32_f16 v[156:159], v[228:231], v[232:235], v[240:243]
ds_read_b128 v[220:223], v248 offset:30976
ds_read_b128 v[224:227], v249 offset:30720
ds_read_u16_d16 v192, v192
v_lshrrev_b32 v193, 18, v193
v_mfma_f32_16x16x32_f16 v[164:167], v[228:231], v[236:239], v[240:243]
v_exp_f16_sdwa v195, v196 dst_sel:WORD_1 dst_unused:UNUSED_PRESERVE src0_sel:WORD_1
v_pk_add_f16 v201, v201, 1.0 op_sel_hi:[1,0]
v_pk_add_f16 v198, v198, 1.0 op_sel_hi:[1,0]
s_waitcnt lgkmcnt(7)
v_mfma_f32_16x16x32_bf16 v[172:175], v[244:247], v[32:35], v[172:175]
ds_read_b128 v[228:231], v249 offset:30976
ds_read_b128 v[240:243], v248 offset:34816
ds_read_u16_d16_hi v193, v193
v_pk_add_f16 v195, v195, 1.0 op_sel_hi:[1,0]
v_mfma_f32_16x16x32_bf16 v[180:183], v[244:247], v[36:39], v[180:183]
v_rcp_f16_e64 v202, v201
s_setprio 0
s_waitcnt lgkmcnt(7)
v_mfma_f32_16x16x32_bf16 v[168:171], v[216:219], v[40:43], v[168:171]
ds_read_b128 v[244:247], v249 offset:31744
v_rcp_f16_e64 v199, v198
v_mfma_f32_16x16x32_bf16 v[176:179], v[216:219], v[44:47], v[176:179]
v_rcp_f16 v196, v195
s_waitcnt lgkmcnt(6)
v_mfma_f32_16x16x32_bf16 v[172:175], v[220:223], v[40:43], v[172:175]
ds_read_b128 v[216:219], v248 offset:35072
v_rcp_f16_sdwa v202, v201 dst_sel:WORD_1 dst_unused:UNUSED_PRESERVE src0_sel:WORD_1
v_mfma_f32_16x16x32_bf16 v[180:183], v[220:223], v[44:47], v[180:183]
v_rcp_f16_sdwa v199, v198 dst_sel:WORD_1 dst_unused:UNUSED_PRESERVE src0_sel:WORD_1
v_or_b32 v232, v184, v185
v_or_b32 v233, v186, v187
v_or_b32_e64 v234, v188, v189
v_rcp_f16_sdwa v196, v195 dst_sel:WORD_1 dst_unused:UNUSED_PRESERVE src0_sel:WORD_1
v_or_b32 v235, v190, v191
s_waitcnt lgkmcnt(2)
v_or_b32 v236, v192, v193
v_pk_mul_f16 v237, v203, v202
v_pk_mul_f16 v238, v200, v199
v_pk_mul_f16 v239, v197, v196
s_setprio 3
v_mfma_f32_16x16x32_f16 v[120:123], v[224:227], v[232:235], v[120:123]
s_add_u32 s46, s80, 16777216
buffer_load_dwordx4 v[108:111], v253, s[32:35], s46 offen offset:256 nt
ds_read_b128 v[220:223], v249 offset:32000
v_cvt_pkrtz_f16_f32 v185, v168, v169
v_cvt_pkrtz_f16_f32 v187, v170, v171
v_mfma_f32_16x16x32_f16 v[128:131], v[224:227], v[236:239], v[128:131]
v_cvt_pkrtz_f16_f32 v189, v172, v173
v_cvt_pkrtz_f16_f32 v191, v174, v175
v_mfma_f32_16x16x32_f16 v[124:127], v[228:231], v[232:235], v[124:127]
ds_read_b128 v[224:227], v248 offset:35840
v_cvt_pkrtz_f16_f32 v193, v176, v177
v_cvt_pk_f16_f32 v203, v178, v179
v_mfma_f32_16x16x32_f16 v[132:135], v[228:231], v[236:239], v[132:135]
v_cvt_pk_f16_f32 v200, v180, v181
v_cvt_pk_f16_f32 v197, v182, v183
v_mfma_f32_16x16x32_bf16 v[168:171], v[240:243], v[24:27], 0
ds_read_b128 v[228:231], v249 offset:32768
v_pk_fma_f16 v202, v203, v203, s48
v_and_b32_e64 v185, s49, v185
v_mfma_f32_16x16x32_bf16 v[176:179], v[240:243], v[28:31], 0
v_pk_fma_f16 v199, v200, v200, s48
v_and_b32 v187, s49, v187
s_waitcnt lgkmcnt(3)
v_mfma_f32_16x16x32_f16 v[136:139], v[244:247], v[232:235], v[136:139]
ds_read_b128 v[240:243], v249 offset:33024
v_pk_fma_f16 v196, v197, v197, s48
v_bfe_u32 v184, v185, 2, 14
v_pk_mul_f16 v202, v203, v202
v_mfma_f32_16x16x32_f16 v[144:147], v[244:247], v[236:239], v[144:147]
v_bfe_u32 v186, v187, 2, 14
v_pk_mul_f16 v199, v200, v199
s_waitcnt vmcnt(7)
v_mfma_f32_16x16x32_bf16 v[88:91], v[18:21], v[204:207], v[88:91]
ds_read_b128 v[244:247], v248 offset:36096
ds_read_u16_d16 v184, v184
ds_read_u16_d16 v186, v186
v_lshrrev_b32 v185, 18, v185
v_pk_mul_f16 v196, v197, v196
v_mfma_f32_16x16x32_bf16 v[92:95], v[16:19], v[204:207], v[92:95]
v_lshrrev_b32_e64 v187, 18, v187
v_mfma_f32_16x16x32_bf16 v[172:175], v[216:219], v[24:27], 0
ds_read_u16_d16_hi v185, v185
ds_read_u16_d16_hi v187, v187
v_exp_f16 v201, v202
v_and_b32 v189, s49, v189
v_mfma_f32_16x16x32_bf16 v[180:183], v[216:219], v[28:31], 0
v_and_b32 v191, s49, v191
s_waitcnt lgkmcnt(6)
v_mfma_f32_16x16x32_f16 v[140:143], v[220:223], v[232:235], v[140:143]
ds_read_b128 v[216:219], v248 offset:36864
v_exp_f16_e64 v198, v199
v_bfe_u32 v188, v189, 2, 14
v_mfma_f32_16x16x32_f16 v[148:151], v[220:223], v[236:239], v[148:151]
v_bfe_u32 v190, v191, 2, 14
v_exp_f16_e64 v195, v196
v_mfma_f32_16x16x32_bf16 v[168:171], v[224:227], v[32:35], v[168:171]
ds_read_b128 v[220:223], v248 offset:37120
ds_read_u16_d16 v188, v188
ds_read_u16_d16 v190, v190
v_lshrrev_b32 v189, 18, v189
v_lshrrev_b32 v191, 18, v191
v_mfma_f32_16x16x32_bf16 v[176:179], v[224:227], v[36:39], v[176:179]
v_exp_f16_sdwa v201, v202 dst_sel:WORD_1 dst_unused:UNUSED_PRESERVE src0_sel:WORD_1
v_mfma_f32_16x16x32_f16 v[152:155], v[228:231], v[232:235], v[152:155]
ds_read_b128 v[224:227], v249 offset:36864
ds_read_u16_d16_hi v189, v189
ds_read_u16_d16_hi v191, v191
v_and_b32 v193, s49, v193
v_bfe_u32 v192, v193, 2, 14
v_mfma_f32_16x16x32_f16 v[160:163], v[228:231], v[236:239], v[160:163]
v_exp_f16_sdwa v198, v199 dst_sel:WORD_1 dst_unused:UNUSED_PRESERVE src0_sel:WORD_1
s_waitcnt lgkmcnt(7)
v_mfma_f32_16x16x32_f16 v[156:159], v[240:243], v[232:235], v[156:159]
ds_read_b128 v[228:231], v249 offset:37120
ds_read_u16_d16 v192, v192
v_lshrrev_b32_e64 v193, 18, v193
v_mfma_f32_16x16x32_f16 v[164:167], v[240:243], v[236:239], v[164:167]
v_exp_f16_sdwa v195, v196 dst_sel:WORD_1 dst_unused:UNUSED_PRESERVE src0_sel:WORD_1
v_pk_add_f16 v201, v201, 1.0 op_sel_hi:[1,0]
v_pk_add_f16 v198, v198, 1.0 op_sel_hi:[1,0]
v_mfma_f32_16x16x32_bf16 v[172:175], v[244:247], v[32:35], v[172:175]
ds_read_b128 v[240:243], v248 offset:40960
ds_read_u16_d16_hi v193, v193
v_pk_add_f16 v195, v195, 1.0 op_sel_hi:[1,0]
v_mfma_f32_16x16x32_bf16 v[180:183], v[244:247], v[36:39], v[180:183]
v_rcp_f16 v202, v201
s_waitcnt lgkmcnt(7)
v_mfma_f32_16x16x32_bf16 v[168:171], v[216:219], v[40:43], v[168:171]
ds_read_b128 v[244:247], v249 offset:37888
v_rcp_f16_e64 v199, v198
v_mfma_f32_16x16x32_bf16 v[176:179], v[216:219], v[44:47], v[176:179]
v_rcp_f16_e64 v196, v195
v_mfma_f32_16x16x32_bf16 v[172:175], v[220:223], v[40:43], v[172:175]
ds_read_b128 v[216:219], v248 offset:41216
v_rcp_f16_sdwa v202, v201 dst_sel:WORD_1 dst_unused:UNUSED_PRESERVE src0_sel:WORD_1
v_mfma_f32_16x16x32_bf16 v[180:183], v[220:223], v[44:47], v[180:183]
v_rcp_f16_sdwa v199, v198 dst_sel:WORD_1 dst_unused:UNUSED_PRESERVE src0_sel:WORD_1
v_or_b32 v232, v184, v185
v_or_b32 v233, v186, v187
s_waitcnt lgkmcnt(4)
v_or_b32 v234, v188, v189
v_rcp_f16_sdwa v196, v195 dst_sel:WORD_1 dst_unused:UNUSED_PRESERVE src0_sel:WORD_1
v_or_b32 v235, v190, v191
s_waitcnt lgkmcnt(2)
v_or_b32_e64 v236, v192, v193
v_pk_mul_f16 v237, v203, v202
v_pk_mul_f16 v238, v200, v199
v_pk_mul_f16 v239, v197, v196
v_mfma_f32_16x16x32_f16 v[120:123], v[224:227], v[232:235], v[120:123]
s_add_u32 s46, s80, 20971520
buffer_load_dwordx4 v[112:115], v253, s[32:35], s46 offen nt
ds_read_b128 v[220:223], v249 offset:38144
v_cvt_pkrtz_f16_f32 v185, v168, v169
v_cvt_pkrtz_f16_f32 v187, v170, v171
v_cvt_pkrtz_f16_f32 v189, v172, v173
v_mfma_f32_16x16x32_f16 v[128:131], v[224:227], v[236:239], v[128:131]
v_cvt_pkrtz_f16_f32 v191, v174, v175
v_cvt_pkrtz_f16_f32 v193, v176, v177
v_cvt_pk_f16_f32 v203, v178, v179
v_mfma_f32_16x16x32_f16 v[124:127], v[228:231], v[232:235], v[124:127]
ds_read_b128 v[224:227], v248 offset:41984
v_cvt_pk_f16_f32 v200, v180, v181
v_cvt_pk_f16_f32 v197, v182, v183
v_pk_fma_f16 v202, v203, v203, s48
v_cvt_pk_bf16_f32 v64, v64, v65
v_mfma_f32_16x16x32_f16 v[132:135], v[228:231], v[236:239], v[132:135]
v_and_b32_e64 v185, s49, v185
v_cvt_pk_bf16_f32 v65, v66, v67
v_pk_fma_f16 v199, v200, v200, s48
v_mfma_f32_16x16x32_bf16 v[168:171], v[240:243], v[24:27], 0
ds_read_b128 v[228:231], v249 offset:38912
v_and_b32_e64 v187, s49, v187
v_cvt_pk_bf16_f32 v66, v68, v69
v_pk_fma_f16 v196, v197, v197, s48
v_mfma_f32_16x16x32_bf16 v[176:179], v[240:243], v[28:31], 0
v_cvt_pk_bf16_f32 v67, v70, v71
v_bfe_u32 v184, v185, 2, 14
s_setprio 2
v_pk_mul_f16 v202, v203, v202
v_cvt_pk_bf16_f32 v48, v48, v49
s_waitcnt lgkmcnt(2)
v_mfma_f32_16x16x32_f16 v[136:139], v[244:247], v[232:235], v[136:139]
ds_read_b128 v[240:243], v249 offset:39168
ds_read_u16_d16 v184, v184
v_bfe_u32 v186, v187, 2, 14
v_cvt_pk_bf16_f32 v49, v50, v51
v_pk_mul_f16 v199, v200, v199
v_mfma_f32_16x16x32_f16 v[144:147], v[244:247], v[236:239], v[144:147]
v_lshrrev_b32_e64 v185, 18, v185
v_cvt_pk_bf16_f32 v50, v52, v53
v_pk_mul_f16 v196, v197, v196
v_mfma_f32_16x16x32_bf16 v[172:175], v[216:219], v[24:27], 0
ds_read_b128 v[244:247], v248 offset:42240
ds_read_u16_d16 v186, v186
ds_read_u16_d16_hi v185, v185
v_lshrrev_b32_e64 v187, 18, v187
v_cvt_pk_bf16_f32 v51, v54, v55
v_exp_f16_e64 v201, v202
v_mfma_f32_16x16x32_bf16 v[180:183], v[216:219], v[28:31], 0
v_cvt_pk_bf16_f32 v80, v80, v81
v_and_b32_e64 v189, s49, v189
v_cvt_pk_bf16_f32 v81, v82, v83
v_mfma_f32_16x16x32_f16 v[140:143], v[220:223], v[232:235], v[140:143]
ds_read_b128 v[216:219], v248 offset:43008
ds_read_u16_d16_hi v187, v187
v_and_b32_e64 v191, s49, v191
v_cvt_pk_bf16_f32 v82, v84, v85
v_mfma_f32_16x16x32_f16 v[148:151], v[220:223], v[236:239], v[148:151]
v_exp_f16_e64 v198, v199
v_cvt_pk_bf16_f32 v83, v86, v87
s_mov_b64 vcc, s[74:75]
v_bfe_u32 v188, v189, 2, 14
v_bfe_u32 v190, v191, 2, 14
s_waitcnt lgkmcnt(5)
v_mfma_f32_16x16x32_bf16 v[168:171], v[224:227], v[32:35], v[168:171]
ds_read_b128 v[220:223], v248 offset:43264
ds_read_u16_d16 v188, v188
ds_read_u16_d16 v190, v190
v_cndmask_b32 v68, v48, v80, vcc
v_exp_f16 v195, v196
v_mfma_f32_16x16x32_bf16 v[176:179], v[224:227], v[36:39], v[176:179]
v_cndmask_b32 v69, v49, v81, vcc
v_lshrrev_b32_e64 v189, 18, v189
v_cndmask_b32 v70, v50, v82, vcc
v_mfma_f32_16x16x32_f16 v[152:155], v[228:231], v[232:235], v[152:155]
ds_read_b128 v[224:227], v249 offset:43008
ds_read_u16_d16_hi v189, v189
v_lshrrev_b32 v191, 18, v191
v_cndmask_b32 v71, v51, v83, vcc
v_exp_f16_sdwa v201, v202 dst_sel:WORD_1 dst_unused:UNUSED_PRESERVE src0_sel:WORD_1
v_mfma_f32_16x16x32_f16 v[160:163], v[228:231], v[236:239], v[160:163]
v_cndmask_b32_dpp v48, v64, v48, vcc quad_perm:[1,0,3,2] row_mask:0xf bank_mask:0xf
v_and_b32_e64 v193, s49, v193
v_cndmask_b32_dpp v49, v65, v49, vcc quad_perm:[1,0,3,2] row_mask:0xf bank_mask:0xf
v_mfma_f32_16x16x32_f16 v[156:159], v[240:243], v[232:235], v[156:159]
ds_read_b128 v[228:231], v249 offset:43264
ds_read_u16_d16_hi v191, v191
v_bfe_u32 v192, v193, 2, 14
v_exp_f16_sdwa v198, v199 dst_sel:WORD_1 dst_unused:UNUSED_PRESERVE src0_sel:WORD_1
v_mfma_f32_16x16x32_f16 v[164:167], v[240:243], v[236:239], v[164:167]
v_cndmask_b32_dpp v50, v66, v50, vcc quad_perm:[1,0,3,2] row_mask:0xf bank_mask:0xf
v_lshrrev_b32_e64 v193, 18, v193
v_cndmask_b32_dpp v51, v67, v51, vcc quad_perm:[1,0,3,2] row_mask:0xf bank_mask:0xf
s_not_b64 vcc, s[74:75]
s_waitcnt lgkmcnt(4)
v_mfma_f32_16x16x32_bf16 v[172:175], v[244:247], v[32:35], v[172:175]
ds_read_b128 v[240:243], v248 offset:47104
ds_read_u16_d16 v192, v192
ds_read_u16_d16_hi v193, v193
v_exp_f16_sdwa v195, v196 dst_sel:WORD_1 dst_unused:UNUSED_PRESERVE src0_sel:WORD_1
v_cndmask_b32_dpp v80, v64, v80, vcc quad_perm:[1,0,3,2] row_mask:0xf bank_mask:0xf
v_pk_add_f16 v201, v201, 1.0 op_sel_hi:[1,0]
v_mfma_f32_16x16x32_bf16 v[180:183], v[244:247], v[36:39], v[180:183]
v_cndmask_b32_dpp v81, v65, v81, vcc quad_perm:[1,0,3,2] row_mask:0xf bank_mask:0xf
v_pk_add_f16 v198, v198, 1.0 op_sel_hi:[1,0]
v_cndmask_b32_dpp v82, v66, v82, vcc quad_perm:[1,0,3,2] row_mask:0xf bank_mask:0xf
v_mfma_f32_16x16x32_bf16 v[168:171], v[216:219], v[40:43], v[168:171]
ds_read_b128 v[244:247], v249 offset:44032
v_pk_add_f16 v195, v195, 1.0 op_sel_hi:[1,0]
v_rcp_f16_e64 v202, v201
v_cndmask_b32_dpp v83, v67, v83, vcc quad_perm:[1,0,3,2] row_mask:0xf bank_mask:0xf
v_mfma_f32_16x16x32_bf16 v[176:179], v[216:219], v[44:47], v[176:179]
v_rcp_f16_e64 v199, v198
v_mfma_f32_16x16x32_bf16 v[172:175], v[220:223], v[40:43], v[172:175]
ds_read_b128 v[216:219], v248 offset:47360
buffer_store_dwordx4 v[48:51], v255, s[8:11], s70 offen sc1
v_rcp_f16_e64 v196, v195
v_rcp_f16_sdwa v202, v201 dst_sel:WORD_1 dst_unused:UNUSED_PRESERVE src0_sel:WORD_1
v_mfma_f32_16x16x32_bf16 v[180:183], v[220:223], v[44:47], v[180:183]
v_rcp_f16_sdwa v199, v198 dst_sel:WORD_1 dst_unused:UNUSED_PRESERVE src0_sel:WORD_1
v_or_b32 v232, v184, v185
v_or_b32 v233, v186, v187
s_waitcnt lgkmcnt(3)
v_or_b32 v234, v188, v189
v_rcp_f16_sdwa v196, v195 dst_sel:WORD_1 dst_unused:UNUSED_PRESERVE src0_sel:WORD_1
v_or_b32 v235, v190, v191
s_waitcnt lgkmcnt(2)
v_or_b32_e64 v236, v192, v193
v_pk_mul_f16 v237, v203, v202
v_pk_mul_f16 v238, v200, v199
v_pk_mul_f16 v239, v197, v196
v_mfma_f32_16x16x32_f16 v[120:123], v[224:227], v[232:235], v[120:123]
buffer_store_dwordx4 v[68:71], v255, s[8:11], s70 offen offset:128 sc1
ds_read_b128 v[220:223], v249 offset:44288
v_cvt_pkrtz_f16_f32 v185, v168, v169
v_cvt_pkrtz_f16_f32 v187, v170, v171
v_mfma_f32_16x16x32_f16 v[128:131], v[224:227], v[236:239], v[128:131]
v_cvt_pkrtz_f16_f32 v189, v172, v173
v_cvt_pkrtz_f16_f32 v191, v174, v175
v_mfma_f32_16x16x32_f16 v[124:127], v[228:231], v[232:235], v[124:127]
ds_read_b128 v[224:227], v248 offset:48128
v_cvt_pkrtz_f16_f32 v193, v176, v177
v_cvt_pk_f16_f32 v203, v178, v179
v_cvt_pk_f16_f32 v200, v180, v181
v_mfma_f32_16x16x32_f16 v[132:135], v[228:231], v[236:239], v[132:135]
v_cvt_pk_f16_f32 v197, v182, v183
s_setprio 1
v_pk_fma_f16 v202, v203, v203, s48
v_mfma_f32_16x16x32_bf16 v[168:171], v[240:243], v[24:27], 0
ds_read_b128 v[228:231], v249 offset:45056
v_and_b32 v185, s49, v185
v_pk_fma_f16 v199, v200, v200, s48
v_mfma_f32_16x16x32_bf16 v[176:179], v[240:243], v[28:31], 0
v_and_b32 v187, s49, v187
v_pk_fma_f16 v196, v197, v197, s48
v_bfe_u32 v184, v185, 2, 14
s_waitcnt lgkmcnt(3)
v_mfma_f32_16x16x32_f16 v[136:139], v[244:247], v[232:235], v[136:139]
ds_read_b128 v[240:243], v249 offset:45312
ds_read_u16_d16 v184, v184
v_pk_mul_f16 v202, v203, v202
v_bfe_u32 v186, v187, 2, 14
v_mfma_f32_16x16x32_f16 v[144:147], v[244:247], v[236:239], v[144:147]
v_pk_mul_f16 v199, v200, v199
v_lshrrev_b32_e64 v185, 18, v185
v_mfma_f32_16x16x32_bf16 v[172:175], v[216:219], v[24:27], 0
ds_read_b128 v[244:247], v248 offset:48384
ds_read_u16_d16 v186, v186
ds_read_u16_d16_hi v185, v185
v_pk_mul_f16 v196, v197, v196
v_lshrrev_b32_e64 v187, 18, v187
v_mfma_f32_16x16x32_bf16 v[180:183], v[216:219], v[28:31], 0
v_exp_f16_e64 v201, v202
v_and_b32 v189, s49, v189
s_waitcnt lgkmcnt(5)
v_mfma_f32_16x16x32_f16 v[140:143], v[220:223], v[232:235], v[140:143]
ds_read_b128 v[216:219], v248 offset:49152
ds_read_u16_d16_hi v187, v187
v_and_b32_e64 v191, s49, v191
v_mfma_f32_16x16x32_f16 v[148:151], v[220:223], v[236:239], v[148:151]
v_exp_f16_e64 v198, v199
v_bfe_u32 v188, v189, 2, 14
v_bfe_u32 v190, v191, 2, 14
v_mfma_f32_16x16x32_bf16 v[168:171], v[224:227], v[32:35], v[168:171]
s_add_u32 s46, s80, 20971520
buffer_load_dwordx4 v[116:119], v253, s[32:35], s46 offen offset:256 nt
ds_read_b128 v[220:223], v248 offset:49408
ds_read_u16_d16 v188, v188
ds_read_u16_d16 v190, v190
v_exp_f16_e64 v195, v196
v_mfma_f32_16x16x32_bf16 v[176:179], v[224:227], v[36:39], v[176:179]
v_lshrrev_b32 v189, 18, v189
v_lshrrev_b32 v191, 18, v191
v_mfma_f32_16x16x32_f16 v[152:155], v[228:231], v[232:235], v[152:155]
ds_read_b128 v[224:227], v249 offset:49152
ds_read_u16_d16_hi v189, v189
ds_read_u16_d16_hi v191, v191
v_exp_f16_sdwa v201, v202 dst_sel:WORD_1 dst_unused:UNUSED_PRESERVE src0_sel:WORD_1
v_and_b32 v193, s49, v193
v_mfma_f32_16x16x32_f16 v[160:163], v[228:231], v[236:239], v[160:163]
v_bfe_u32 v192, v193, 2, 14
s_waitcnt lgkmcnt(7)
v_mfma_f32_16x16x32_f16 v[156:159], v[240:243], v[232:235], v[156:159]
ds_read_b128 v[228:231], v249 offset:49408
ds_read_u16_d16 v192, v192
v_exp_f16_sdwa v198, v199 dst_sel:WORD_1 dst_unused:UNUSED_PRESERVE src0_sel:WORD_1
v_lshrrev_b32_e64 v193, 18, v193
v_mfma_f32_16x16x32_f16 v[164:167], v[240:243], v[236:239], v[164:167]
v_exp_f16_sdwa v195, v196 dst_sel:WORD_1 dst_unused:UNUSED_PRESERVE src0_sel:WORD_1
v_pk_add_f16 v201, v201, 1.0 op_sel_hi:[1,0]
v_mfma_f32_16x16x32_bf16 v[172:175], v[244:247], v[32:35], v[172:175]
ds_read_b128 v[240:243], v248 offset:53248
ds_read_u16_d16_hi v193, v193
v_pk_add_f16 v198, v198, 1.0 op_sel_hi:[1,0]
v_pk_add_f16 v195, v195, 1.0 op_sel_hi:[1,0]
v_mfma_f32_16x16x32_bf16 v[180:183], v[244:247], v[36:39], v[180:183]
v_rcp_f16 v202, v201
s_setprio 0
v_mfma_f32_16x16x32_bf16 v[168:171], v[216:219], v[40:43], v[168:171]
ds_read_b128 v[244:247], v249 offset:50176
v_rcp_f16_e64 v199, v198
v_mfma_f32_16x16x32_bf16 v[176:179], v[216:219], v[44:47], v[176:179]
v_rcp_f16 v196, v195
s_waitcnt lgkmcnt(5)
v_mfma_f32_16x16x32_bf16 v[172:175], v[220:223], v[40:43], v[172:175]
ds_read_b128 v[216:219], v248 offset:53504
v_rcp_f16_sdwa v202, v201 dst_sel:WORD_1 dst_unused:UNUSED_PRESERVE src0_sel:WORD_1
v_mfma_f32_16x16x32_bf16 v[180:183], v[220:223], v[44:47], v[180:183]
v_rcp_f16_sdwa v199, v198 dst_sel:WORD_1 dst_unused:UNUSED_PRESERVE src0_sel:WORD_1
v_or_b32 v232, v184, v185
v_or_b32 v233, v186, v187
v_or_b32_e64 v234, v188, v189
v_rcp_f16_sdwa v196, v195 dst_sel:WORD_1 dst_unused:UNUSED_PRESERVE src0_sel:WORD_1
v_or_b32 v235, v190, v191
s_waitcnt lgkmcnt(2)
v_or_b32 v236, v192, v193
v_pk_mul_f16 v237, v203, v202
v_pk_mul_f16 v238, v200, v199
v_pk_mul_f16 v239, v197, v196
s_setprio 3
v_mfma_f32_16x16x32_f16 v[120:123], v[224:227], v[232:235], v[120:123]
ds_read_b128 v[220:223], v249 offset:50432
v_cvt_pkrtz_f16_f32 v185, v168, v169
v_cvt_pkrtz_f16_f32 v187, v170, v171
v_mfma_f32_16x16x32_f16 v[128:131], v[224:227], v[236:239], v[128:131]
v_cvt_pkrtz_f16_f32 v189, v172, v173
v_cvt_pkrtz_f16_f32 v191, v174, v175
v_mfma_f32_16x16x32_f16 v[124:127], v[228:231], v[232:235], v[124:127]
ds_read_b128 v[224:227], v248 offset:54272
v_cvt_pkrtz_f16_f32 v193, v176, v177
v_cvt_pk_f16_f32 v203, v178, v179
v_cvt_pk_f16_f32 v200, v180, v181
v_mfma_f32_16x16x32_f16 v[132:135], v[228:231], v[236:239], v[132:135]
v_cvt_pk_f16_f32 v197, v182, v183
v_pk_fma_f16 v202, v203, v203, s48
v_mfma_f32_16x16x32_bf16 v[168:171], v[240:243], v[24:27], 0
ds_read_b128 v[228:231], v249 offset:51200
v_and_b32_e64 v185, s49, v185
v_pk_fma_f16 v199, v200, v200, s48
v_mfma_f32_16x16x32_bf16 v[176:179], v[240:243], v[28:31], 0
v_and_b32 v187, s49, v187
v_pk_fma_f16 v196, v197, v197, s48
v_bfe_u32 v184, v185, 2, 14
s_waitcnt lgkmcnt(3)
v_mfma_f32_16x16x32_f16 v[136:139], v[244:247], v[232:235], v[136:139]
ds_read_b128 v[240:243], v249 offset:51456
ds_read_u16_d16 v184, v184
v_pk_mul_f16 v202, v203, v202
v_bfe_u32 v186, v187, 2, 14
v_mfma_f32_16x16x32_f16 v[144:147], v[244:247], v[236:239], v[144:147]
v_pk_mul_f16 v199, v200, v199
v_lshrrev_b32_e64 v185, 18, v185
v_mfma_f32_16x16x32_bf16 v[172:175], v[216:219], v[24:27], 0
ds_read_b128 v[244:247], v248 offset:54528
ds_read_u16_d16 v186, v186
ds_read_u16_d16_hi v185, v185
v_pk_mul_f16 v196, v197, v196
v_lshrrev_b32_e64 v187, 18, v187
v_mfma_f32_16x16x32_bf16 v[180:183], v[216:219], v[28:31], 0
v_exp_f16_e64 v201, v202
v_and_b32 v189, s49, v189
s_waitcnt lgkmcnt(5)
v_mfma_f32_16x16x32_f16 v[140:143], v[220:223], v[232:235], v[140:143]
ds_read_b128 v[216:219], v248 offset:55296
ds_read_u16_d16_hi v187, v187
v_and_b32_e64 v191, s49, v191
v_mfma_f32_16x16x32_f16 v[148:151], v[220:223], v[236:239], v[148:151]
v_exp_f16_e64 v198, v199
v_bfe_u32 v188, v189, 2, 14
v_bfe_u32 v190, v191, 2, 14
v_mfma_f32_16x16x32_bf16 v[168:171], v[224:227], v[32:35], v[168:171]
ds_read_b128 v[220:223], v248 offset:55552
ds_read_u16_d16 v188, v188
ds_read_u16_d16 v190, v190
v_exp_f16_e64 v195, v196
v_mfma_f32_16x16x32_bf16 v[176:179], v[224:227], v[36:39], v[176:179]
v_lshrrev_b32 v189, 18, v189
v_lshrrev_b32 v191, 18, v191
v_mfma_f32_16x16x32_f16 v[152:155], v[228:231], v[232:235], v[152:155]
ds_read_b128 v[224:227], v249 offset:55296
ds_read_u16_d16_hi v189, v189
ds_read_u16_d16_hi v191, v191
v_exp_f16_sdwa v201, v202 dst_sel:WORD_1 dst_unused:UNUSED_PRESERVE src0_sel:WORD_1
v_and_b32 v193, s49, v193
v_mfma_f32_16x16x32_f16 v[160:163], v[228:231], v[236:239], v[160:163]
v_bfe_u32 v192, v193, 2, 14
s_waitcnt lgkmcnt(8)
v_mfma_f32_16x16x32_f16 v[156:159], v[240:243], v[232:235], v[156:159]
ds_read_b128 v[228:231], v249 offset:55552
ds_read_u16_d16 v192, v192
v_exp_f16_sdwa v198, v199 dst_sel:WORD_1 dst_unused:UNUSED_PRESERVE src0_sel:WORD_1
v_lshrrev_b32_e64 v193, 18, v193
v_mfma_f32_16x16x32_f16 v[164:167], v[240:243], v[236:239], v[164:167]
v_exp_f16_sdwa v195, v196 dst_sel:WORD_1 dst_unused:UNUSED_PRESERVE src0_sel:WORD_1
v_pk_add_f16 v201, v201, 1.0 op_sel_hi:[1,0]
v_mfma_f32_16x16x32_bf16 v[172:175], v[244:247], v[32:35], v[172:175]
ds_read_b128 v[240:243], v248 offset:59392
ds_read_u16_d16_hi v193, v193
v_pk_add_f16 v198, v198, 1.0 op_sel_hi:[1,0]
v_pk_add_f16 v195, v195, 1.0 op_sel_hi:[1,0]
v_mfma_f32_16x16x32_bf16 v[180:183], v[244:247], v[36:39], v[180:183]
v_rcp_f16 v202, v201
s_waitcnt lgkmcnt(7)
v_mfma_f32_16x16x32_bf16 v[168:171], v[216:219], v[40:43], v[168:171]
ds_read_b128 v[244:247], v249 offset:56320
v_rcp_f16_e64 v199, v198
v_mfma_f32_16x16x32_bf16 v[176:179], v[216:219], v[44:47], v[176:179]
v_rcp_f16_e64 v196, v195
v_mfma_f32_16x16x32_bf16 v[172:175], v[220:223], v[40:43], v[172:175]
ds_read_b128 v[216:219], v248 offset:59648
v_rcp_f16_sdwa v202, v201 dst_sel:WORD_1 dst_unused:UNUSED_PRESERVE src0_sel:WORD_1
v_mfma_f32_16x16x32_bf16 v[180:183], v[220:223], v[44:47], v[180:183]
v_rcp_f16_sdwa v199, v198 dst_sel:WORD_1 dst_unused:UNUSED_PRESERVE src0_sel:WORD_1
v_or_b32 v232, v184, v185
v_or_b32 v233, v186, v187
s_waitcnt lgkmcnt(4)
v_or_b32 v234, v188, v189
v_rcp_f16_sdwa v196, v195 dst_sel:WORD_1 dst_unused:UNUSED_PRESERVE src0_sel:WORD_1
v_or_b32 v235, v190, v191
s_waitcnt lgkmcnt(2)
v_or_b32_e64 v236, v192, v193
v_pk_mul_f16 v237, v203, v202
v_pk_mul_f16 v238, v200, v199
v_pk_mul_f16 v239, v197, v196
v_mfma_f32_16x16x32_f16 v[120:123], v[224:227], v[232:235], v[120:123]
buffer_load_dwordx4 v[204:207], v252, s[4:7], s68 offen
ds_read_b128 v[220:223], v249 offset:56576
v_cvt_pkrtz_f16_f32 v185, v168, v169
v_cvt_pkrtz_f16_f32 v187, v170, v171
v_mfma_f32_16x16x32_f16 v[128:131], v[224:227], v[236:239], v[128:131]
v_cvt_pkrtz_f16_f32 v189, v172, v173
v_cvt_pkrtz_f16_f32 v191, v174, v175
v_mfma_f32_16x16x32_f16 v[124:127], v[228:231], v[232:235], v[124:127]
ds_read_b128 v[224:227], v248 offset:60416
v_cvt_pkrtz_f16_f32 v193, v176, v177
v_cvt_pk_f16_f32 v203, v178, v179
v_cvt_pk_f16_f32 v200, v180, v181
v_mfma_f32_16x16x32_f16 v[132:135], v[228:231], v[236:239], v[132:135]
v_cvt_pk_f16_f32 v197, v182, v183
v_pk_fma_f16 v202, v203, v203, s48
v_mfma_f32_16x16x32_bf16 v[168:171], v[240:243], v[24:27], 0
ds_read_b128 v[228:231], v249 offset:57344
v_and_b32_e64 v185, s49, v185
v_pk_fma_f16 v199, v200, v200, s48
v_mfma_f32_16x16x32_bf16 v[176:179], v[240:243], v[28:31], 0
v_and_b32_e64 v187, s49, v187
v_pk_fma_f16 v196, v197, v197, s48
s_setprio 2
v_bfe_u32 v184, v185, 2, 14
s_waitcnt lgkmcnt(3)
v_mfma_f32_16x16x32_f16 v[136:139], v[244:247], v[232:235], v[136:139]
ds_read_b128 v[240:243], v249 offset:57600
ds_read_u16_d16 v184, v184
v_pk_mul_f16 v202, v203, v202
v_bfe_u32 v186, v187, 2, 14
v_mfma_f32_16x16x32_f16 v[144:147], v[244:247], v[236:239], v[144:147]
v_pk_mul_f16 v199, v200, v199
v_lshrrev_b32_e64 v185, 18, v185
v_mfma_f32_16x16x32_bf16 v[172:175], v[216:219], v[24:27], 0
ds_read_b128 v[244:247], v248 offset:60672
ds_read_u16_d16 v186, v186
ds_read_u16_d16_hi v185, v185
v_pk_mul_f16 v196, v197, v196
v_lshrrev_b32_e64 v187, 18, v187
v_mfma_f32_16x16x32_bf16 v[180:183], v[216:219], v[28:31], 0
v_exp_f16_e64 v201, v202
v_and_b32 v189, s49, v189
s_waitcnt lgkmcnt(5)
v_mfma_f32_16x16x32_f16 v[140:143], v[220:223], v[232:235], v[140:143]
ds_read_b128 v[216:219], v248 offset:61440
ds_read_u16_d16_hi v187, v187
v_and_b32_e64 v191, s49, v191
v_mfma_f32_16x16x32_f16 v[148:151], v[220:223], v[236:239], v[148:151]
v_exp_f16_e64 v198, v199
v_bfe_u32 v188, v189, 2, 14
v_bfe_u32 v190, v191, 2, 14
v_mfma_f32_16x16x32_bf16 v[168:171], v[224:227], v[32:35], v[168:171]
buffer_store_dwordx4 v[80:83], v255, s[8:11], s70 offen offset:256 sc1
ds_read_b128 v[220:223], v248 offset:61696
ds_read_u16_d16 v188, v188
ds_read_u16_d16 v190, v190
v_exp_f16_e64 v195, v196
v_mfma_f32_16x16x32_bf16 v[176:179], v[224:227], v[36:39], v[176:179]
v_lshrrev_b32 v189, 18, v189
v_lshrrev_b32 v191, 18, v191
v_mfma_f32_16x16x32_f16 v[152:155], v[228:231], v[232:235], v[152:155]
ds_read_b128 v[224:227], v249 offset:61440
ds_read_u16_d16_hi v189, v189
ds_read_u16_d16_hi v191, v191
v_exp_f16_sdwa v201, v202 dst_sel:WORD_1 dst_unused:UNUSED_PRESERVE src0_sel:WORD_1
v_and_b32 v193, s49, v193
v_mfma_f32_16x16x32_f16 v[160:163], v[228:231], v[236:239], v[160:163]
v_bfe_u32 v192, v193, 2, 14
s_waitcnt lgkmcnt(8)
v_mfma_f32_16x16x32_f16 v[156:159], v[240:243], v[232:235], v[156:159]
ds_read_b128 v[228:231], v249 offset:61696
ds_read_u16_d16 v192, v192
v_exp_f16_sdwa v198, v199 dst_sel:WORD_1 dst_unused:UNUSED_PRESERVE src0_sel:WORD_1
v_lshrrev_b32_e64 v193, 18, v193
v_mfma_f32_16x16x32_f16 v[164:167], v[240:243], v[236:239], v[164:167]
v_exp_f16_sdwa v195, v196 dst_sel:WORD_1 dst_unused:UNUSED_PRESERVE src0_sel:WORD_1
v_pk_add_f16 v201, v201, 1.0 op_sel_hi:[1,0]
v_mfma_f32_16x16x32_bf16 v[172:175], v[244:247], v[32:35], v[172:175]
ds_read_b128 v[240:243], v249
ds_read_u16_d16_hi v193, v193
v_pk_add_f16 v198, v198, 1.0 op_sel_hi:[1,0]
v_pk_add_f16 v195, v195, 1.0 op_sel_hi:[1,0]
v_mfma_f32_16x16x32_bf16 v[180:183], v[244:247], v[36:39], v[180:183]
v_rcp_f16 v202, v201
s_waitcnt lgkmcnt(7)
v_mfma_f32_16x16x32_bf16 v[168:171], v[216:219], v[40:43], v[168:171]
ds_read_b128 v[244:247], v249 offset:62464
v_rcp_f16_e64 v199, v198
v_mfma_f32_16x16x32_bf16 v[176:179], v[216:219], v[44:47], v[176:179]
v_rcp_f16_e64 v196, v195
v_mfma_f32_16x16x32_bf16 v[172:175], v[220:223], v[40:43], v[172:175]
ds_read_b128 v[216:219], v249 offset:256
v_rcp_f16_sdwa v202, v201 dst_sel:WORD_1 dst_unused:UNUSED_PRESERVE src0_sel:WORD_1
v_mfma_f32_16x16x32_bf16 v[180:183], v[220:223], v[44:47], v[180:183]
v_rcp_f16_sdwa v199, v198 dst_sel:WORD_1 dst_unused:UNUSED_PRESERVE src0_sel:WORD_1
v_or_b32 v232, v184, v185
v_or_b32 v233, v186, v187
s_waitcnt lgkmcnt(4)
v_or_b32 v234, v188, v189
v_rcp_f16_sdwa v196, v195 dst_sel:WORD_1 dst_unused:UNUSED_PRESERVE src0_sel:WORD_1
v_or_b32 v235, v190, v191
s_waitcnt lgkmcnt(2)
v_or_b32_e64 v236, v192, v193
v_pk_mul_f16 v237, v203, v202
v_pk_mul_f16 v238, v200, v199
v_pk_mul_f16 v239, v197, v196
v_mfma_f32_16x16x32_f16 v[120:123], v[224:227], v[232:235], v[120:123]
buffer_load_dwordx4 v[208:211], v252, s[4:7], s68 offen offset:64
ds_read_b128 v[220:223], v249 offset:62720
v_cvt_pkrtz_f16_f32 v185, v168, v169
v_cvt_pkrtz_f16_f32 v187, v170, v171
v_mfma_f32_16x16x32_f16 v[128:131], v[224:227], v[236:239], v[128:131]
v_cvt_pkrtz_f16_f32 v189, v172, v173
v_cvt_pkrtz_f16_f32 v191, v174, v175
v_mfma_f32_16x16x32_f16 v[124:127], v[228:231], v[232:235], v[124:127]
ds_read_b128 v[224:227], v249 offset:1024
v_cvt_pkrtz_f16_f32 v193, v176, v177
v_cvt_pk_f16_f32 v203, v178, v179
v_cvt_pk_f16_f32 v200, v180, v181
v_mfma_f32_16x16x32_f16 v[132:135], v[228:231], v[236:239], v[132:135]
v_cvt_pk_f16_f32 v197, v182, v183
s_setprio 1
v_pk_fma_f16 v202, v203, v203, s48
v_mfma_f32_16x16x32_bf16 v[168:171], v[240:243], v[24:27], 0
ds_read_b128 v[228:231], v249 offset:63488
v_and_b32 v185, s49, v185
v_pk_fma_f16 v199, v200, v200, s48
v_mfma_f32_16x16x32_bf16 v[176:179], v[240:243], v[28:31], 0
v_and_b32 v187, s49, v187
v_pk_fma_f16 v196, v197, v197, s48
v_bfe_u32 v184, v185, 2, 14
s_waitcnt lgkmcnt(3)
v_mfma_f32_16x16x32_f16 v[136:139], v[244:247], v[232:235], v[136:139]
ds_read_b128 v[240:243], v249 offset:63744
ds_read_u16_d16 v184, v184
v_pk_mul_f16 v202, v203, v202
v_bfe_u32 v186, v187, 2, 14
v_mfma_f32_16x16x32_f16 v[144:147], v[244:247], v[236:239], v[144:147]
v_pk_mul_f16 v199, v200, v199
v_lshrrev_b32_e64 v185, 18, v185
v_mfma_f32_16x16x32_bf16 v[172:175], v[216:219], v[24:27], 0
ds_read_b128 v[244:247], v249 offset:1280
ds_read_u16_d16 v186, v186
ds_read_u16_d16_hi v185, v185
v_pk_mul_f16 v196, v197, v196
v_lshrrev_b32_e64 v187, 18, v187
v_mfma_f32_16x16x32_bf16 v[180:183], v[216:219], v[28:31], 0
v_exp_f16_e64 v201, v202
v_and_b32 v189, s49, v189
s_waitcnt lgkmcnt(5)
v_mfma_f32_16x16x32_f16 v[140:143], v[220:223], v[232:235], v[140:143]
ds_read_b128 v[216:219], v249 offset:2048
ds_read_u16_d16_hi v187, v187
v_and_b32_e64 v191, s49, v191
v_mfma_f32_16x16x32_f16 v[148:151], v[220:223], v[236:239], v[148:151]
v_exp_f16_e64 v198, v199
v_bfe_u32 v188, v189, 2, 14
v_bfe_u32 v190, v191, 2, 14
v_mfma_f32_16x16x32_bf16 v[168:171], v[224:227], v[32:35], v[168:171]
ds_read_b128 v[220:223], v249 offset:2304
ds_read_u16_d16 v188, v188
ds_read_u16_d16 v190, v190
v_exp_f16_e64 v195, v196
v_mfma_f32_16x16x32_bf16 v[176:179], v[224:227], v[36:39], v[176:179]
v_lshrrev_b32 v189, 18, v189
v_lshrrev_b32 v191, 18, v191
v_mfma_f32_16x16x32_f16 v[152:155], v[228:231], v[232:235], v[152:155]
ds_read_b128 v[224:227], v250 offset:2048
ds_read_u16_d16_hi v189, v189
ds_read_u16_d16_hi v191, v191
v_exp_f16_sdwa v201, v202 dst_sel:WORD_1 dst_unused:UNUSED_PRESERVE src0_sel:WORD_1
v_and_b32 v193, s49, v193
v_mfma_f32_16x16x32_f16 v[160:163], v[228:231], v[236:239], v[160:163]
v_bfe_u32 v192, v193, 2, 14
s_waitcnt lgkmcnt(8)
v_mfma_f32_16x16x32_f16 v[156:159], v[240:243], v[232:235], v[156:159]
ds_read_b128 v[228:231], v250 offset:2304
ds_read_u16_d16 v192, v192
v_exp_f16_sdwa v198, v199 dst_sel:WORD_1 dst_unused:UNUSED_PRESERVE src0_sel:WORD_1
v_lshrrev_b32_e64 v193, 18, v193
v_mfma_f32_16x16x32_f16 v[164:167], v[240:243], v[236:239], v[164:167]
v_exp_f16_sdwa v195, v196 dst_sel:WORD_1 dst_unused:UNUSED_PRESERVE src0_sel:WORD_1
v_pk_add_f16 v201, v201, 1.0 op_sel_hi:[1,0]
v_mfma_f32_16x16x32_bf16 v[172:175], v[244:247], v[32:35], v[172:175]
ds_read_b128 v[240:243], v249 offset:6144
ds_read_u16_d16_hi v193, v193
v_pk_add_f16 v198, v198, 1.0 op_sel_hi:[1,0]
v_pk_add_f16 v195, v195, 1.0 op_sel_hi:[1,0]
v_mfma_f32_16x16x32_bf16 v[180:183], v[244:247], v[36:39], v[180:183]
v_rcp_f16_e64 v202, v201
s_setprio 0
s_waitcnt lgkmcnt(7)
v_mfma_f32_16x16x32_bf16 v[168:171], v[216:219], v[40:43], v[168:171]
ds_read_b128 v[244:247], v250 offset:3072
v_rcp_f16_e64 v199, v198
v_mfma_f32_16x16x32_bf16 v[176:179], v[216:219], v[44:47], v[176:179]
v_rcp_f16_e64 v196, v195
v_mfma_f32_16x16x32_bf16 v[172:175], v[220:223], v[40:43], v[172:175]
ds_read_b128 v[216:219], v249 offset:6400
v_rcp_f16_sdwa v202, v201 dst_sel:WORD_1 dst_unused:UNUSED_PRESERVE src0_sel:WORD_1
v_mfma_f32_16x16x32_bf16 v[180:183], v[220:223], v[44:47], v[180:183]
v_rcp_f16_sdwa v199, v198 dst_sel:WORD_1 dst_unused:UNUSED_PRESERVE src0_sel:WORD_1
v_or_b32 v232, v184, v185
v_or_b32 v233, v186, v187
s_waitcnt lgkmcnt(4)
v_or_b32 v234, v188, v189
v_rcp_f16_sdwa v196, v195 dst_sel:WORD_1 dst_unused:UNUSED_PRESERVE src0_sel:WORD_1
v_or_b32 v235, v190, v191
s_waitcnt lgkmcnt(2)
v_or_b32 v236, v192, v193
v_pk_mul_f16 v237, v203, v202
v_pk_mul_f16 v238, v200, v199
v_pk_mul_f16 v239, v197, v196
s_setprio 3
v_mfma_f32_16x16x32_f16 v[120:123], v[224:227], v[232:235], v[120:123]
ds_read_b128 v[220:223], v250 offset:3328
v_cvt_pkrtz_f16_f32 v185, v168, v169
v_cvt_pkrtz_f16_f32 v187, v170, v171
v_cvt_pkrtz_f16_f32 v189, v172, v173
v_mfma_f32_16x16x32_f16 v[128:131], v[224:227], v[236:239], v[128:131]
v_cvt_pkrtz_f16_f32 v191, v174, v175
v_cvt_pkrtz_f16_f32 v193, v176, v177
v_cvt_pk_f16_f32 v203, v178, v179
v_mfma_f32_16x16x32_f16 v[124:127], v[228:231], v[232:235], v[124:127]
ds_read_b128 v[224:227], v249 offset:7168
v_cvt_pk_f16_f32 v200, v180, v181
v_cvt_pk_f16_f32 v197, v182, v183
v_pk_fma_f16 v202, v203, v203, s48
v_cvt_pk_bf16_f32 v72, v72, v73
v_mfma_f32_16x16x32_f16 v[132:135], v[228:231], v[236:239], v[132:135]
v_and_b32_e64 v185, s49, v185
v_cvt_pk_bf16_f32 v73, v74, v75
v_pk_fma_f16 v199, v200, v200, s48
v_mfma_f32_16x16x32_bf16 v[168:171], v[240:243], v[24:27], 0
ds_read_b128 v[228:231], v250 offset:4096
v_and_b32 v187, s49, v187
v_cvt_pk_bf16_f32 v74, v76, v77
v_pk_fma_f16 v196, v197, v197, s48
v_mfma_f32_16x16x32_bf16 v[176:179], v[240:243], v[28:31], 0
v_cvt_pk_bf16_f32 v75, v78, v79
v_bfe_u32 v184, v185, 2, 14
v_pk_mul_f16 v202, v203, v202
v_cvt_pk_bf16_f32 v56, v56, v57
s_waitcnt lgkmcnt(2)
v_mfma_f32_16x16x32_f16 v[136:139], v[244:247], v[232:235], v[136:139]
ds_read_b128 v[240:243], v250 offset:4352
ds_read_u16_d16 v184, v184
v_bfe_u32 v186, v187, 2, 14
v_cvt_pk_bf16_f32 v57, v58, v59
v_pk_mul_f16 v199, v200, v199
v_mfma_f32_16x16x32_f16 v[144:147], v[244:247], v[236:239], v[144:147]
v_lshrrev_b32_e64 v185, 18, v185
v_cvt_pk_bf16_f32 v58, v60, v61
v_pk_mul_f16 v196, v197, v196
v_mfma_f32_16x16x32_bf16 v[172:175], v[216:219], v[24:27], 0
ds_read_b128 v[244:247], v249 offset:7424
ds_read_u16_d16 v186, v186
ds_read_u16_d16_hi v185, v185
v_lshrrev_b32_e64 v187, 18, v187
v_cvt_pk_bf16_f32 v59, v62, v63
v_exp_f16_e64 v201, v202
v_mfma_f32_16x16x32_bf16 v[180:183], v[216:219], v[28:31], 0
v_cvt_pk_bf16_f32 v88, v88, v89
v_and_b32_e64 v189, s49, v189
v_cvt_pk_bf16_f32 v89, v90, v91
v_mfma_f32_16x16x32_f16 v[140:143], v[220:223], v[232:235], v[140:143]
ds_read_b128 v[216:219], v249 offset:8192
ds_read_u16_d16_hi v187, v187
v_and_b32_e64 v191, s49, v191
v_cvt_pk_bf16_f32 v90, v92, v93
v_mfma_f32_16x16x32_f16 v[148:151], v[220:223], v[236:239], v[148:151]
v_exp_f16_e64 v198, v199
v_cvt_pk_bf16_f32 v91, v94, v95
s_mov_b64 vcc, s[74:75]
v_bfe_u32 v188, v189, 2, 14
v_bfe_u32 v190, v191, 2, 14
s_waitcnt lgkmcnt(5)
v_mfma_f32_16x16x32_bf16 v[168:171], v[224:227], v[32:35], v[168:171]
ds_read_b128 v[220:223], v249 offset:8448
ds_read_u16_d16 v188, v188
ds_read_u16_d16 v190, v190
v_cndmask_b32 v76, v56, v88, vcc
v_exp_f16 v195, v196
v_mfma_f32_16x16x32_bf16 v[176:179], v[224:227], v[36:39], v[176:179]
v_cndmask_b32 v77, v57, v89, vcc
v_lshrrev_b32_e64 v189, 18, v189
v_cndmask_b32 v78, v58, v90, vcc
v_mfma_f32_16x16x32_f16 v[152:155], v[228:231], v[232:235], v[152:155]
ds_read_b128 v[224:227], v250 offset:8192
ds_read_u16_d16_hi v189, v189
v_lshrrev_b32 v191, 18, v191
v_cndmask_b32 v79, v59, v91, vcc
v_exp_f16_sdwa v201, v202 dst_sel:WORD_1 dst_unused:UNUSED_PRESERVE src0_sel:WORD_1
v_mfma_f32_16x16x32_f16 v[160:163], v[228:231], v[236:239], v[160:163]
v_cndmask_b32_dpp v56, v72, v56, vcc quad_perm:[1,0,3,2] row_mask:0xf bank_mask:0xf
v_and_b32_e64 v193, s49, v193
v_cndmask_b32_dpp v57, v73, v57, vcc quad_perm:[1,0,3,2] row_mask:0xf bank_mask:0xf
v_mfma_f32_16x16x32_f16 v[156:159], v[240:243], v[232:235], v[156:159]
ds_read_b128 v[228:231], v250 offset:8448
ds_read_u16_d16_hi v191, v191
v_bfe_u32 v192, v193, 2, 14
v_exp_f16_sdwa v198, v199 dst_sel:WORD_1 dst_unused:UNUSED_PRESERVE src0_sel:WORD_1
v_mfma_f32_16x16x32_f16 v[164:167], v[240:243], v[236:239], v[164:167]
v_cndmask_b32_dpp v58, v74, v58, vcc quad_perm:[1,0,3,2] row_mask:0xf bank_mask:0xf
v_lshrrev_b32_e64 v193, 18, v193
v_cndmask_b32_dpp v59, v75, v59, vcc quad_perm:[1,0,3,2] row_mask:0xf bank_mask:0xf
s_not_b64 vcc, s[74:75]
s_waitcnt lgkmcnt(4)
v_mfma_f32_16x16x32_bf16 v[172:175], v[244:247], v[32:35], v[172:175]
ds_read_b128 v[240:243], v249 offset:12288
ds_read_u16_d16 v192, v192
ds_read_u16_d16_hi v193, v193
v_exp_f16_sdwa v195, v196 dst_sel:WORD_1 dst_unused:UNUSED_PRESERVE src0_sel:WORD_1
v_cndmask_b32_dpp v88, v72, v88, vcc quad_perm:[1,0,3,2] row_mask:0xf bank_mask:0xf
v_pk_add_f16 v201, v201, 1.0 op_sel_hi:[1,0]
v_mfma_f32_16x16x32_bf16 v[180:183], v[244:247], v[36:39], v[180:183]
v_cndmask_b32_dpp v89, v73, v89, vcc quad_perm:[1,0,3,2] row_mask:0xf bank_mask:0xf
v_pk_add_f16 v198, v198, 1.0 op_sel_hi:[1,0]
v_cndmask_b32_dpp v90, v74, v90, vcc quad_perm:[1,0,3,2] row_mask:0xf bank_mask:0xf
v_mfma_f32_16x16x32_bf16 v[168:171], v[216:219], v[40:43], v[168:171]
ds_read_b128 v[244:247], v250 offset:9216
v_pk_add_f16 v195, v195, 1.0 op_sel_hi:[1,0]
v_rcp_f16_e64 v202, v201
v_cndmask_b32_dpp v91, v75, v91, vcc quad_perm:[1,0,3,2] row_mask:0xf bank_mask:0xf
v_mfma_f32_16x16x32_bf16 v[176:179], v[216:219], v[44:47], v[176:179]
v_rcp_f16_e64 v199, v198
v_mfma_f32_16x16x32_bf16 v[172:175], v[220:223], v[40:43], v[172:175]
ds_read_b128 v[216:219], v249 offset:12544
s_add_u32 s46, s70, 98304
buffer_store_dwordx4 v[56:59], v255, s[8:11], s46 offen sc1
v_rcp_f16_e64 v196, v195
v_rcp_f16_sdwa v202, v201 dst_sel:WORD_1 dst_unused:UNUSED_PRESERVE src0_sel:WORD_1
v_mfma_f32_16x16x32_bf16 v[180:183], v[220:223], v[44:47], v[180:183]
v_rcp_f16_sdwa v199, v198 dst_sel:WORD_1 dst_unused:UNUSED_PRESERVE src0_sel:WORD_1
v_or_b32 v232, v184, v185
v_or_b32 v233, v186, v187
s_waitcnt lgkmcnt(2)
v_or_b32 v234, v188, v189
v_rcp_f16_sdwa v196, v195 dst_sel:WORD_1 dst_unused:UNUSED_PRESERVE src0_sel:WORD_1
v_or_b32 v235, v190, v191
v_or_b32 v236, v192, v193
v_pk_mul_f16 v237, v203, v202
v_pk_mul_f16 v238, v200, v199
v_pk_mul_f16 v239, v197, v196
v_mfma_f32_16x16x32_f16 v[120:123], v[224:227], v[232:235], v[120:123]
buffer_load_dwordx4 v[12:15], v252, s[4:7], s68 offen offset:128
ds_read_b128 v[220:223], v250 offset:9472
v_cvt_pkrtz_f16_f32 v185, v168, v169
v_cvt_pkrtz_f16_f32 v187, v170, v171
v_mfma_f32_16x16x32_f16 v[128:131], v[224:227], v[236:239], v[128:131]
v_cvt_pkrtz_f16_f32 v189, v172, v173
v_cvt_pkrtz_f16_f32 v191, v174, v175
v_mfma_f32_16x16x32_f16 v[124:127], v[228:231], v[232:235], v[124:127]
ds_read_b128 v[224:227], v249 offset:13312
v_cvt_pkrtz_f16_f32 v193, v176, v177
v_cvt_pk_f16_f32 v203, v178, v179
v_cvt_pk_f16_f32 v200, v180, v181
v_mfma_f32_16x16x32_f16 v[132:135], v[228:231], v[236:239], v[132:135]
v_cvt_pk_f16_f32 v197, v182, v183
v_pk_fma_f16 v202, v203, v203, s48
v_mfma_f32_16x16x32_bf16 v[168:171], v[240:243], v[24:27], 0
ds_read_b128 v[228:231], v250 offset:10240
v_and_b32_e64 v185, s49, v185
v_pk_fma_f16 v199, v200, v200, s48
v_mfma_f32_16x16x32_bf16 v[176:179], v[240:243], v[28:31], 0
v_and_b32_e64 v187, s49, v187
v_pk_fma_f16 v196, v197, v197, s48
s_setprio 2
v_bfe_u32 v184, v185, 2, 14
s_waitcnt lgkmcnt(3)
v_mfma_f32_16x16x32_f16 v[136:139], v[244:247], v[232:235], v[136:139]
ds_read_b128 v[240:243], v250 offset:10496
ds_read_u16_d16 v184, v184
v_pk_mul_f16 v202, v203, v202
v_bfe_u32 v186, v187, 2, 14
v_mfma_f32_16x16x32_f16 v[144:147], v[244:247], v[236:239], v[144:147]
v_pk_mul_f16 v199, v200, v199
v_lshrrev_b32_e64 v185, 18, v185
v_mfma_f32_16x16x32_bf16 v[172:175], v[216:219], v[24:27], 0
ds_read_b128 v[244:247], v249 offset:13568
ds_read_u16_d16 v186, v186
ds_read_u16_d16_hi v185, v185
v_pk_mul_f16 v196, v197, v196
v_lshrrev_b32_e64 v187, 18, v187
v_mfma_f32_16x16x32_bf16 v[180:183], v[216:219], v[28:31], 0
v_exp_f16_e64 v201, v202
v_and_b32 v189, s49, v189
s_waitcnt lgkmcnt(5)
v_mfma_f32_16x16x32_f16 v[140:143], v[220:223], v[232:235], v[140:143]
ds_read_b128 v[216:219], v249 offset:14336
ds_read_u16_d16_hi v187, v187
v_and_b32_e64 v191, s49, v191
v_mfma_f32_16x16x32_f16 v[148:151], v[220:223], v[236:239], v[148:151]
v_exp_f16_e64 v198, v199
v_bfe_u32 v188, v189, 2, 14
v_bfe_u32 v190, v191, 2, 14
v_mfma_f32_16x16x32_bf16 v[168:171], v[224:227], v[32:35], v[168:171]
ds_read_b128 v[220:223], v249 offset:14592
ds_read_u16_d16 v188, v188
ds_read_u16_d16 v190, v190
v_exp_f16_e64 v195, v196
v_mfma_f32_16x16x32_bf16 v[176:179], v[224:227], v[36:39], v[176:179]
v_lshrrev_b32 v189, 18, v189
v_lshrrev_b32 v191, 18, v191
v_mfma_f32_16x16x32_f16 v[152:155], v[228:231], v[232:235], v[152:155]
ds_read_b128 v[224:227], v250 offset:14336
ds_read_u16_d16_hi v189, v189
ds_read_u16_d16_hi v191, v191
v_exp_f16_sdwa v201, v202 dst_sel:WORD_1 dst_unused:UNUSED_PRESERVE src0_sel:WORD_1
v_and_b32 v193, s49, v193
v_mfma_f32_16x16x32_f16 v[160:163], v[228:231], v[236:239], v[160:163]
v_bfe_u32 v192, v193, 2, 14
s_waitcnt lgkmcnt(8)
v_mfma_f32_16x16x32_f16 v[156:159], v[240:243], v[232:235], v[156:159]
ds_read_b128 v[228:231], v250 offset:14592
ds_read_u16_d16 v192, v192
v_exp_f16_sdwa v198, v199 dst_sel:WORD_1 dst_unused:UNUSED_PRESERVE src0_sel:WORD_1
v_lshrrev_b32_e64 v193, 18, v193
v_mfma_f32_16x16x32_f16 v[164:167], v[240:243], v[236:239], v[164:167]
v_exp_f16_sdwa v195, v196 dst_sel:WORD_1 dst_unused:UNUSED_PRESERVE src0_sel:WORD_1
v_pk_add_f16 v201, v201, 1.0 op_sel_hi:[1,0]
v_mfma_f32_16x16x32_bf16 v[172:175], v[244:247], v[32:35], v[172:175]
ds_read_b128 v[240:243], v249 offset:18432
ds_read_u16_d16_hi v193, v193
v_pk_add_f16 v198, v198, 1.0 op_sel_hi:[1,0]
v_pk_add_f16 v195, v195, 1.0 op_sel_hi:[1,0]
v_mfma_f32_16x16x32_bf16 v[180:183], v[244:247], v[36:39], v[180:183]
v_rcp_f16 v202, v201
s_waitcnt lgkmcnt(7)
v_mfma_f32_16x16x32_bf16 v[168:171], v[216:219], v[40:43], v[168:171]
ds_read_b128 v[244:247], v250 offset:15360
v_rcp_f16_e64 v199, v198
v_mfma_f32_16x16x32_bf16 v[176:179], v[216:219], v[44:47], v[176:179]
v_rcp_f16_e64 v196, v195
v_mfma_f32_16x16x32_bf16 v[172:175], v[220:223], v[40:43], v[172:175]
ds_read_b128 v[216:219], v249 offset:18688
v_rcp_f16_sdwa v202, v201 dst_sel:WORD_1 dst_unused:UNUSED_PRESERVE src0_sel:WORD_1
v_mfma_f32_16x16x32_bf16 v[180:183], v[220:223], v[44:47], v[180:183]
v_rcp_f16_sdwa v199, v198 dst_sel:WORD_1 dst_unused:UNUSED_PRESERVE src0_sel:WORD_1
v_or_b32 v232, v184, v185
v_or_b32 v233, v186, v187
s_waitcnt lgkmcnt(4)
v_or_b32 v234, v188, v189
v_rcp_f16_sdwa v196, v195 dst_sel:WORD_1 dst_unused:UNUSED_PRESERVE src0_sel:WORD_1
v_or_b32 v235, v190, v191
s_waitcnt lgkmcnt(2)
v_or_b32_e64 v236, v192, v193
v_pk_mul_f16 v237, v203, v202
v_pk_mul_f16 v238, v200, v199
v_pk_mul_f16 v239, v197, v196
v_mfma_f32_16x16x32_f16 v[120:123], v[224:227], v[232:235], v[120:123]
s_add_u32 s46, s68, 98304
buffer_load_dwordx4 v[8:11], v252, s[4:7], s46 offen
ds_read_b128 v[220:223], v250 offset:15616
v_cvt_pkrtz_f16_f32 v185, v168, v169
v_cvt_pkrtz_f16_f32 v187, v170, v171
v_mfma_f32_16x16x32_f16 v[128:131], v[224:227], v[236:239], v[128:131]
v_cvt_pkrtz_f16_f32 v189, v172, v173
v_cvt_pkrtz_f16_f32 v191, v174, v175
v_mfma_f32_16x16x32_f16 v[124:127], v[228:231], v[232:235], v[124:127]
ds_read_b128 v[224:227], v249 offset:19456
v_cvt_pkrtz_f16_f32 v193, v176, v177
v_cvt_pk_f16_f32 v203, v178, v179
v_cvt_pk_f16_f32 v200, v180, v181
v_mfma_f32_16x16x32_f16 v[132:135], v[228:231], v[236:239], v[132:135]
v_cvt_pk_f16_f32 v197, v182, v183
s_setprio 1
v_pk_fma_f16 v202, v203, v203, s48
v_mfma_f32_16x16x32_bf16 v[168:171], v[240:243], v[24:27], 0
ds_read_b128 v[228:231], v250 offset:16384
v_and_b32 v185, s49, v185
v_pk_fma_f16 v199, v200, v200, s48
v_mfma_f32_16x16x32_bf16 v[176:179], v[240:243], v[28:31], 0
v_and_b32 v187, s49, v187
v_pk_fma_f16 v196, v197, v197, s48
v_bfe_u32 v184, v185, 2, 14
s_waitcnt lgkmcnt(3)
v_mfma_f32_16x16x32_f16 v[136:139], v[244:247], v[232:235], v[136:139]
ds_read_b128 v[240:243], v250 offset:16640
ds_read_u16_d16 v184, v184
v_pk_mul_f16 v202, v203, v202
v_bfe_u32 v186, v187, 2, 14
v_mfma_f32_16x16x32_f16 v[144:147], v[244:247], v[236:239], v[144:147]
v_pk_mul_f16 v199, v200, v199
v_lshrrev_b32_e64 v185, 18, v185
v_mfma_f32_16x16x32_bf16 v[172:175], v[216:219], v[24:27], 0
ds_read_b128 v[244:247], v249 offset:19712
ds_read_u16_d16 v186, v186
ds_read_u16_d16_hi v185, v185
v_pk_mul_f16 v196, v197, v196
v_lshrrev_b32_e64 v187, 18, v187
v_mfma_f32_16x16x32_bf16 v[180:183], v[216:219], v[28:31], 0
v_exp_f16_e64 v201, v202
v_and_b32 v189, s49, v189
s_waitcnt lgkmcnt(5)
v_mfma_f32_16x16x32_f16 v[140:143], v[220:223], v[232:235], v[140:143]
ds_read_b128 v[216:219], v249 offset:20480
ds_read_u16_d16_hi v187, v187
v_and_b32_e64 v191, s49, v191
v_mfma_f32_16x16x32_f16 v[148:151], v[220:223], v[236:239], v[148:151]
v_exp_f16_e64 v198, v199
v_bfe_u32 v188, v189, 2, 14
v_bfe_u32 v190, v191, 2, 14
v_mfma_f32_16x16x32_bf16 v[168:171], v[224:227], v[32:35], v[168:171]
s_add_u32 s46, s70, 98304
buffer_store_dwordx4 v[76:79], v255, s[8:11], s46 offen offset:128 sc1
ds_read_b128 v[220:223], v249 offset:20736
ds_read_u16_d16 v188, v188
ds_read_u16_d16 v190, v190
v_exp_f16_e64 v195, v196
v_mfma_f32_16x16x32_bf16 v[176:179], v[224:227], v[36:39], v[176:179]
v_lshrrev_b32 v189, 18, v189
v_lshrrev_b32 v191, 18, v191
v_mfma_f32_16x16x32_f16 v[152:155], v[228:231], v[232:235], v[152:155]
ds_read_b128 v[224:227], v250 offset:20480
ds_read_u16_d16_hi v189, v189
ds_read_u16_d16_hi v191, v191
v_exp_f16_sdwa v201, v202 dst_sel:WORD_1 dst_unused:UNUSED_PRESERVE src0_sel:WORD_1
v_and_b32 v193, s49, v193
v_mfma_f32_16x16x32_f16 v[160:163], v[228:231], v[236:239], v[160:163]
v_bfe_u32 v192, v193, 2, 14
s_waitcnt lgkmcnt(7)
v_mfma_f32_16x16x32_f16 v[156:159], v[240:243], v[232:235], v[156:159]
ds_read_b128 v[228:231], v250 offset:20736
ds_read_u16_d16 v192, v192
v_exp_f16_sdwa v198, v199 dst_sel:WORD_1 dst_unused:UNUSED_PRESERVE src0_sel:WORD_1
v_lshrrev_b32_e64 v193, 18, v193
v_mfma_f32_16x16x32_f16 v[164:167], v[240:243], v[236:239], v[164:167]
v_exp_f16_sdwa v195, v196 dst_sel:WORD_1 dst_unused:UNUSED_PRESERVE src0_sel:WORD_1
v_pk_add_f16 v201, v201, 1.0 op_sel_hi:[1,0]
v_mfma_f32_16x16x32_bf16 v[172:175], v[244:247], v[32:35], v[172:175]
ds_read_b128 v[240:243], v248 offset:16384
ds_read_u16_d16_hi v193, v193
v_pk_add_f16 v198, v198, 1.0 op_sel_hi:[1,0]
v_pk_add_f16 v195, v195, 1.0 op_sel_hi:[1,0]
v_mfma_f32_16x16x32_bf16 v[180:183], v[244:247], v[36:39], v[180:183]
v_rcp_f16 v202, v201
s_setprio 0
v_mfma_f32_16x16x32_bf16 v[168:171], v[216:219], v[40:43], v[168:171]
ds_read_b128 v[244:247], v250 offset:21504
v_rcp_f16_e64 v199, v198
v_mfma_f32_16x16x32_bf16 v[176:179], v[216:219], v[44:47], v[176:179]
v_rcp_f16 v196, v195
s_waitcnt lgkmcnt(5)
v_mfma_f32_16x16x32_bf16 v[172:175], v[220:223], v[40:43], v[172:175]
ds_read_b128 v[216:219], v248 offset:16640
v_rcp_f16_sdwa v202, v201 dst_sel:WORD_1 dst_unused:UNUSED_PRESERVE src0_sel:WORD_1
v_mfma_f32_16x16x32_bf16 v[180:183], v[220:223], v[44:47], v[180:183]
v_rcp_f16_sdwa v199, v198 dst_sel:WORD_1 dst_unused:UNUSED_PRESERVE src0_sel:WORD_1
v_or_b32 v232, v184, v185
v_or_b32 v233, v186, v187
v_or_b32_e64 v234, v188, v189
v_rcp_f16_sdwa v196, v195 dst_sel:WORD_1 dst_unused:UNUSED_PRESERVE src0_sel:WORD_1
v_or_b32 v235, v190, v191
s_waitcnt lgkmcnt(2)
v_or_b32 v236, v192, v193
v_pk_mul_f16 v237, v203, v202
v_pk_mul_f16 v238, v200, v199
v_pk_mul_f16 v239, v197, v196
s_setprio 3
v_mfma_f32_16x16x32_f16 v[120:123], v[224:227], v[232:235], v[120:123]
ds_read_b128 v[220:223], v250 offset:21760
v_cvt_pkrtz_f16_f32 v185, v168, v169
v_cvt_pkrtz_f16_f32 v187, v170, v171
v_mfma_f32_16x16x32_f16 v[128:131], v[224:227], v[236:239], v[128:131]
v_cvt_pkrtz_f16_f32 v189, v172, v173
v_cvt_pkrtz_f16_f32 v191, v174, v175
v_mfma_f32_16x16x32_f16 v[124:127], v[228:231], v[232:235], v[124:127]
ds_read_b128 v[224:227], v248 offset:17408
v_cvt_pkrtz_f16_f32 v193, v176, v177
v_cvt_pk_f16_f32 v203, v178, v179
v_cvt_pk_f16_f32 v200, v180, v181
v_mfma_f32_16x16x32_f16 v[132:135], v[228:231], v[236:239], v[132:135]
v_cvt_pk_f16_f32 v197, v182, v183
v_pk_fma_f16 v202, v203, v203, s48
s_waitcnt vmcnt(14)
v_mfma_f32_16x16x32_bf16 v[168:171], v[240:243], v[96:99], 0
ds_read_b128 v[228:231], v250 offset:22528
v_and_b32_e64 v185, s49, v185
v_pk_fma_f16 v199, v200, v200, s48
s_waitcnt vmcnt(13)
v_mfma_f32_16x16x32_bf16 v[176:179], v[240:243], v[100:103], 0
v_and_b32 v187, s49, v187
v_pk_fma_f16 v196, v197, v197, s48
v_bfe_u32 v184, v185, 2, 14
s_waitcnt lgkmcnt(3)
v_mfma_f32_16x16x32_f16 v[136:139], v[244:247], v[232:235], v[136:139]
ds_read_b128 v[240:243], v250 offset:22784
ds_read_u16_d16 v184, v184
v_pk_mul_f16 v202, v203, v202
v_bfe_u32 v186, v187, 2, 14
v_mfma_f32_16x16x32_f16 v[144:147], v[244:247], v[236:239], v[144:147]
v_pk_mul_f16 v199, v200, v199
v_lshrrev_b32_e64 v185, 18, v185
v_mfma_f32_16x16x32_bf16 v[172:175], v[216:219], v[96:99], 0
ds_read_b128 v[244:247], v248 offset:17664
ds_read_u16_d16 v186, v186
ds_read_u16_d16_hi v185, v185
v_pk_mul_f16 v196, v197, v196
v_lshrrev_b32_e64 v187, 18, v187
v_mfma_f32_16x16x32_bf16 v[180:183], v[216:219], v[100:103], 0
v_exp_f16_e64 v201, v202
v_and_b32 v189, s49, v189
s_waitcnt lgkmcnt(5)
v_mfma_f32_16x16x32_f16 v[140:143], v[220:223], v[232:235], v[140:143]
ds_read_b128 v[216:219], v248 offset:18432
ds_read_u16_d16_hi v187, v187
v_and_b32_e64 v191, s49, v191
v_mfma_f32_16x16x32_f16 v[148:151], v[220:223], v[236:239], v[148:151]
v_exp_f16 v198, v199
v_bfe_u32 v188, v189, 2, 14
v_bfe_u32 v190, v191, 2, 14
s_waitcnt vmcnt(12)
v_mfma_f32_16x16x32_bf16 v[168:171], v[224:227], v[104:107], v[168:171]
ds_read_b128 v[220:223], v248 offset:18688
ds_read_u16_d16 v188, v188
ds_read_u16_d16 v190, v190
v_exp_f16 v195, v196
s_waitcnt vmcnt(11)
v_mfma_f32_16x16x32_bf16 v[176:179], v[224:227], v[108:111], v[176:179]
v_lshrrev_b32 v189, 18, v189
v_lshrrev_b32 v191, 18, v191
v_mfma_f32_16x16x32_f16 v[152:155], v[228:231], v[232:235], v[152:155]
ds_read_b128 v[224:227], v250 offset:26624
ds_read_u16_d16_hi v189, v189
ds_read_u16_d16_hi v191, v191
v_exp_f16_sdwa v201, v202 dst_sel:WORD_1 dst_unused:UNUSED_PRESERVE src0_sel:WORD_1
v_and_b32 v193, s49, v193
v_mfma_f32_16x16x32_f16 v[160:163], v[228:231], v[236:239], v[160:163]
v_bfe_u32 v192, v193, 2, 14
s_waitcnt lgkmcnt(7)
v_mfma_f32_16x16x32_f16 v[156:159], v[240:243], v[232:235], v[156:159]
ds_read_b128 v[228:231], v250 offset:26880
ds_read_u16_d16 v192, v192
v_exp_f16_sdwa v198, v199 dst_sel:WORD_1 dst_unused:UNUSED_PRESERVE src0_sel:WORD_1
v_lshrrev_b32_e64 v193, 18, v193
v_mfma_f32_16x16x32_f16 v[164:167], v[240:243], v[236:239], v[164:167]
v_exp_f16_sdwa v195, v196 dst_sel:WORD_1 dst_unused:UNUSED_PRESERVE src0_sel:WORD_1
v_pk_add_f16 v201, v201, 1.0 op_sel_hi:[1,0]
v_mfma_f32_16x16x32_bf16 v[172:175], v[244:247], v[104:107], v[172:175]
ds_read_b128 v[240:243], v248 offset:22528
ds_read_u16_d16_hi v193, v193
v_pk_add_f16 v198, v198, 1.0 op_sel_hi:[1,0]
v_pk_add_f16 v195, v195, 1.0 op_sel_hi:[1,0]
v_mfma_f32_16x16x32_bf16 v[180:183], v[244:247], v[108:111], v[180:183]
v_rcp_f16 v202, v201
s_waitcnt vmcnt(10)
v_mfma_f32_16x16x32_bf16 v[168:171], v[216:219], v[112:115], v[168:171]
ds_read_b128 v[244:247], v250 offset:27648
v_rcp_f16 v199, v198
s_waitcnt vmcnt(7)
v_mfma_f32_16x16x32_bf16 v[176:179], v[216:219], v[116:119], v[176:179]
v_rcp_f16 v196, v195
s_waitcnt lgkmcnt(5)
v_mfma_f32_16x16x32_bf16 v[172:175], v[220:223], v[112:115], v[172:175]
ds_read_b128 v[216:219], v248 offset:22784
v_rcp_f16_sdwa v202, v201 dst_sel:WORD_1 dst_unused:UNUSED_PRESERVE src0_sel:WORD_1
v_mfma_f32_16x16x32_bf16 v[180:183], v[220:223], v[116:119], v[180:183]
v_rcp_f16_sdwa v199, v198 dst_sel:WORD_1 dst_unused:UNUSED_PRESERVE src0_sel:WORD_1
v_or_b32 v232, v184, v185
v_or_b32 v233, v186, v187
v_or_b32_e64 v234, v188, v189
v_rcp_f16_sdwa v196, v195 dst_sel:WORD_1 dst_unused:UNUSED_PRESERVE src0_sel:WORD_1
v_or_b32 v235, v190, v191
s_waitcnt lgkmcnt(2)
v_or_b32_e64 v236, v192, v193
v_pk_mul_f16 v237, v203, v202
v_pk_mul_f16 v238, v200, v199
v_pk_mul_f16 v239, v197, v196
v_mfma_f32_16x16x32_f16 v[120:123], v[224:227], v[232:235], v[120:123]
s_add_u32 s46, s68, 98304
buffer_load_dwordx4 v[44:47], v252, s[4:7], s46 offen offset:64
ds_read_b128 v[220:223], v250 offset:27904
v_cvt_pkrtz_f16_f32 v185, v168, v169
v_cvt_pkrtz_f16_f32 v187, v170, v171
v_mfma_f32_16x16x32_f16 v[128:131], v[224:227], v[236:239], v[128:131]
v_cvt_pkrtz_f16_f32 v189, v172, v173
v_cvt_pkrtz_f16_f32 v191, v174, v175
v_mfma_f32_16x16x32_f16 v[124:127], v[228:231], v[232:235], v[124:127]
ds_read_b128 v[224:227], v248 offset:23552
v_cvt_pkrtz_f16_f32 v193, v176, v177
v_cvt_pk_f16_f32 v203, v178, v179
v_mfma_f32_16x16x32_f16 v[132:135], v[228:231], v[236:239], v[132:135]
v_cvt_pk_f16_f32 v200, v180, v181
v_cvt_pk_f16_f32 v197, v182, v183
v_mfma_f32_16x16x32_bf16 v[168:171], v[240:243], v[96:99], 0
ds_read_b128 v[228:231], v250 offset:28672
v_pk_fma_f16 v202, v203, v203, s48
v_and_b32_e64 v185, s49, v185
v_mfma_f32_16x16x32_bf16 v[176:179], v[240:243], v[100:103], 0
v_pk_fma_f16 v199, v200, v200, s48
v_and_b32 v187, s49, v187
s_waitcnt lgkmcnt(3)
v_mfma_f32_16x16x32_f16 v[136:139], v[244:247], v[232:235], v[136:139]
ds_read_b128 v[240:243], v250 offset:28928
v_pk_fma_f16 v196, v197, v197, s48
s_setprio 2
v_bfe_u32 v184, v185, 2, 14
v_pk_mul_f16 v202, v203, v202
v_mfma_f32_16x16x32_f16 v[144:147], v[244:247], v[236:239], v[144:147]
v_bfe_u32 v186, v187, 2, 14
v_pk_mul_f16 v199, v200, v199
s_waitcnt vmcnt(7)
v_mfma_f32_16x16x32_bf16 v[120:123], v[18:21], v[204:207], v[120:123]
ds_read_b128 v[244:247], v248 offset:23808
ds_read_u16_d16 v184, v184
ds_read_u16_d16 v186, v186
v_lshrrev_b32_e64 v185, 18, v185
v_pk_mul_f16 v196, v197, v196
v_mfma_f32_16x16x32_bf16 v[124:127], v[16:19], v[204:207], v[124:127]
v_lshrrev_b32_e64 v187, 18, v187
v_mfma_f32_16x16x32_bf16 v[172:175], v[216:219], v[96:99], 0
ds_read_u16_d16_hi v185, v185
ds_read_u16_d16_hi v187, v187
v_exp_f16 v201, v202
v_and_b32 v189, s49, v189
v_mfma_f32_16x16x32_bf16 v[180:183], v[216:219], v[100:103], 0
v_and_b32 v191, s49, v191
s_waitcnt lgkmcnt(6)
v_mfma_f32_16x16x32_f16 v[140:143], v[220:223], v[232:235], v[140:143]
ds_read_b128 v[216:219], v248 offset:24576
v_exp_f16_e64 v198, v199
v_bfe_u32 v188, v189, 2, 14
v_mfma_f32_16x16x32_f16 v[148:151], v[220:223], v[236:239], v[148:151]
v_bfe_u32 v190, v191, 2, 14
v_exp_f16_e64 v195, v196
v_mfma_f32_16x16x32_bf16 v[168:171], v[224:227], v[104:107], v[168:171]
s_add_u32 s46, s70, 98304
buffer_store_dwordx4 v[88:91], v255, s[8:11], s46 offen offset:256 sc1
ds_read_b128 v[220:223], v248 offset:24832
ds_read_u16_d16 v188, v188
ds_read_u16_d16 v190, v190
v_lshrrev_b32 v189, 18, v189
v_lshrrev_b32 v191, 18, v191
v_mfma_f32_16x16x32_bf16 v[176:179], v[224:227], v[108:111], v[176:179]
v_exp_f16_sdwa v201, v202 dst_sel:WORD_1 dst_unused:UNUSED_PRESERVE src0_sel:WORD_1
v_mfma_f32_16x16x32_f16 v[152:155], v[228:231], v[232:235], v[152:155]
ds_read_b128 v[224:227], v249 offset:24576
ds_read_u16_d16_hi v189, v189
ds_read_u16_d16_hi v191, v191
v_and_b32 v193, s49, v193
v_bfe_u32 v192, v193, 2, 14
v_mfma_f32_16x16x32_f16 v[160:163], v[228:231], v[236:239], v[160:163]
v_exp_f16_sdwa v198, v199 dst_sel:WORD_1 dst_unused:UNUSED_PRESERVE src0_sel:WORD_1
s_waitcnt lgkmcnt(7)
v_mfma_f32_16x16x32_f16 v[156:159], v[240:243], v[232:235], v[156:159]
ds_read_b128 v[228:231], v254 offset:7936
ds_read_u16_d16 v192, v192
v_lshrrev_b32_e64 v193, 18, v193
v_mfma_f32_16x16x32_f16 v[164:167], v[240:243], v[236:239], v[164:167]
v_exp_f16_sdwa v195, v196 dst_sel:WORD_1 dst_unused:UNUSED_PRESERVE src0_sel:WORD_1
v_pk_add_f16 v201, v201, 1.0 op_sel_hi:[1,0]
v_pk_add_f16 v198, v198, 1.0 op_sel_hi:[1,0]
v_mfma_f32_16x16x32_bf16 v[172:175], v[244:247], v[104:107], v[172:175]
ds_read_b128 v[240:243], v249 offset:24832
ds_read_u16_d16_hi v193, v193
v_pk_add_f16 v195, v195, 1.0 op_sel_hi:[1,0]
v_mfma_f32_16x16x32_bf16 v[180:183], v[244:247], v[108:111], v[180:183]
v_rcp_f16 v202, v201
s_waitcnt lgkmcnt(7)
v_mfma_f32_16x16x32_bf16 v[168:171], v[216:219], v[112:115], v[168:171]
ds_read_b128 v[244:247], v254 offset:7952
v_rcp_f16_e64 v199, v198
v_mfma_f32_16x16x32_bf16 v[176:179], v[216:219], v[116:119], v[176:179]
v_rcp_f16_e64 v196, v195
v_mfma_f32_16x16x32_bf16 v[172:175], v[220:223], v[112:115], v[172:175]
ds_read_b128 v[216:219], v248 offset:28672
v_rcp_f16_sdwa v202, v201 dst_sel:WORD_1 dst_unused:UNUSED_PRESERVE src0_sel:WORD_1
v_mfma_f32_16x16x32_bf16 v[180:183], v[220:223], v[116:119], v[180:183]
v_rcp_f16_sdwa v199, v198 dst_sel:WORD_1 dst_unused:UNUSED_PRESERVE src0_sel:WORD_1
v_or_b32 v232, v184, v185
v_or_b32 v233, v186, v187
s_waitcnt lgkmcnt(4)
v_or_b32 v234, v188, v189
v_rcp_f16_sdwa v196, v195 dst_sel:WORD_1 dst_unused:UNUSED_PRESERVE src0_sel:WORD_1
v_or_b32 v235, v190, v191
s_waitcnt lgkmcnt(2)
v_or_b32 v236, v192, v193
v_pk_mul_f16 v237, v203, v202
v_pk_mul_f16 v238, v200, v199
v_pk_mul_f16 v239, v197, v196
v_mfma_f32_16x16x32_f16 v[48:51], v[224:227], v[232:235], v[228:231]
ds_read_b128 v[220:223], v249 offset:25600
v_cvt_pkrtz_f16_f32 v185, v168, v169
v_cvt_pkrtz_f16_f32 v187, v170, v171
v_mfma_f32_16x16x32_f16 v[56:59], v[224:227], v[236:239], v[228:231]
v_cvt_pkrtz_f16_f32 v189, v172, v173
v_cvt_pkrtz_f16_f32 v191, v174, v175
s_waitcnt lgkmcnt(2)
v_mfma_f32_16x16x32_f16 v[52:55], v[240:243], v[232:235], v[244:247]
ds_read_b128 v[224:227], v254 offset:8064
ds_read_b128 v[228:231], v248 offset:28928
v_cvt_pkrtz_f16_f32 v193, v176, v177
v_cvt_pk_f16_f32 v203, v178, v179
v_mfma_f32_16x16x32_f16 v[60:63], v[240:243], v[236:239], v[244:247]
v_cvt_pk_f16_f32 v200, v180, v181
v_cvt_pk_f16_f32 v197, v182, v183
s_setprio 1
s_waitcnt lgkmcnt(3)
v_mfma_f32_16x16x32_bf16 v[168:171], v[216:219], v[96:99], 0
ds_read_b128 v[240:243], v249 offset:25856
ds_read_b128 v[244:247], v254 offset:8080
v_pk_fma_f16 v202, v203, v203, s48
v_and_b32_e64 v185, s49, v185
v_mfma_f32_16x16x32_bf16 v[176:179], v[216:219], v[100:103], 0
v_pk_fma_f16 v199, v200, v200, s48
v_and_b32 v187, s49, v187
s_waitcnt lgkmcnt(3)
v_mfma_f32_16x16x32_f16 v[64:67], v[220:223], v[232:235], v[224:227]
ds_read_b128 v[216:219], v248 offset:29696
v_pk_fma_f16 v196, v197, v197, s48
v_bfe_u32 v184, v185, 2, 14
v_pk_mul_f16 v202, v203, v202
v_mfma_f32_16x16x32_f16 v[72:75], v[220:223], v[236:239], v[224:227]
v_bfe_u32 v186, v187, 2, 14
v_pk_mul_f16 v199, v200, v199
s_waitcnt vmcnt(6)
v_mfma_f32_16x16x32_bf16 v[136:139], v[18:21], v[208:211], v[136:139]
ds_read_b128 v[220:223], v249 offset:26624
ds_read_b128 v[224:227], v254 offset:16128
ds_read_u16_d16 v184, v184
ds_read_u16_d16 v186, v186
v_lshrrev_b32 v185, 18, v185
v_pk_mul_f16 v196, v197, v196
v_mfma_f32_16x16x32_bf16 v[140:143], v[16:19], v[208:211], v[140:143]
v_lshrrev_b32 v187, 18, v187
s_waitcnt lgkmcnt(5)
v_mfma_f32_16x16x32_bf16 v[172:175], v[228:231], v[96:99], 0
ds_read_u16_d16_hi v185, v185
ds_read_u16_d16_hi v187, v187
v_exp_f16 v201, v202
v_and_b32 v189, s49, v189
v_mfma_f32_16x16x32_bf16 v[180:183], v[228:231], v[100:103], 0
v_and_b32_e64 v191, s49, v191
v_mfma_f32_16x16x32_f16 v[68:71], v[240:243], v[232:235], v[244:247]
ds_read_b128 v[228:231], v249 offset:26880
v_exp_f16_e64 v198, v199
v_bfe_u32 v188, v189, 2, 14
v_mfma_f32_16x16x32_f16 v[76:79], v[240:243], v[236:239], v[244:247]
v_bfe_u32 v190, v191, 2, 14
v_exp_f16 v195, v196
s_waitcnt lgkmcnt(7)
v_mfma_f32_16x16x32_bf16 v[168:171], v[216:219], v[104:107], v[168:171]
ds_read_b128 v[240:243], v254 offset:16144
ds_read_b128 v[244:247], v248 offset:29952
ds_read_u16_d16 v188, v188
ds_read_u16_d16 v190, v190
v_lshrrev_b32_e64 v189, 18, v189
v_lshrrev_b32 v191, 18, v191
v_mfma_f32_16x16x32_bf16 v[176:179], v[216:219], v[108:111], v[176:179]
v_exp_f16_sdwa v201, v202 dst_sel:WORD_1 dst_unused:UNUSED_PRESERVE src0_sel:WORD_1
s_waitcnt lgkmcnt(7)
v_mfma_f32_16x16x32_f16 v[80:83], v[220:223], v[232:235], v[224:227]
ds_read_b128 v[216:219], v248 offset:30720
ds_read_u16_d16_hi v189, v189
ds_read_u16_d16_hi v191, v191
v_and_b32 v193, s49, v193
v_bfe_u32 v192, v193, 2, 14
v_mfma_f32_16x16x32_f16 v[88:91], v[220:223], v[236:239], v[224:227]
v_exp_f16_sdwa v198, v199 dst_sel:WORD_1 dst_unused:UNUSED_PRESERVE src0_sel:WORD_1
s_waitcnt lgkmcnt(6)
v_mfma_f32_16x16x32_f16 v[84:87], v[228:231], v[232:235], v[240:243]
ds_read_b128 v[220:223], v248 offset:30976
ds_read_b128 v[224:227], v249 offset:30720
ds_read_u16_d16 v192, v192
v_lshrrev_b32 v193, 18, v193
v_mfma_f32_16x16x32_f16 v[92:95], v[228:231], v[236:239], v[240:243]
v_exp_f16_sdwa v195, v196 dst_sel:WORD_1 dst_unused:UNUSED_PRESERVE src0_sel:WORD_1
v_pk_add_f16 v201, v201, 1.0 op_sel_hi:[1,0]
v_pk_add_f16 v198, v198, 1.0 op_sel_hi:[1,0]
s_waitcnt lgkmcnt(7)
v_mfma_f32_16x16x32_bf16 v[172:175], v[244:247], v[104:107], v[172:175]
ds_read_b128 v[228:231], v249 offset:30976
ds_read_b128 v[240:243], v248 offset:34816
ds_read_u16_d16_hi v193, v193
v_pk_add_f16 v195, v195, 1.0 op_sel_hi:[1,0]
v_mfma_f32_16x16x32_bf16 v[180:183], v[244:247], v[108:111], v[180:183]
v_rcp_f16_e64 v202, v201
s_setprio 0
s_waitcnt lgkmcnt(7)
v_mfma_f32_16x16x32_bf16 v[168:171], v[216:219], v[112:115], v[168:171]
ds_read_b128 v[244:247], v249 offset:31744
v_rcp_f16_e64 v199, v198
v_mfma_f32_16x16x32_bf16 v[176:179], v[216:219], v[116:119], v[176:179]
v_rcp_f16 v196, v195
s_waitcnt lgkmcnt(6)
v_mfma_f32_16x16x32_bf16 v[172:175], v[220:223], v[112:115], v[172:175]
ds_read_b128 v[216:219], v248 offset:35072
v_rcp_f16_sdwa v202, v201 dst_sel:WORD_1 dst_unused:UNUSED_PRESERVE src0_sel:WORD_1
v_mfma_f32_16x16x32_bf16 v[180:183], v[220:223], v[116:119], v[180:183]
v_rcp_f16_sdwa v199, v198 dst_sel:WORD_1 dst_unused:UNUSED_PRESERVE src0_sel:WORD_1
v_or_b32 v232, v184, v185
v_or_b32 v233, v186, v187
v_or_b32_e64 v234, v188, v189
v_rcp_f16_sdwa v196, v195 dst_sel:WORD_1 dst_unused:UNUSED_PRESERVE src0_sel:WORD_1
v_or_b32 v235, v190, v191
s_waitcnt lgkmcnt(2)
v_or_b32 v236, v192, v193
v_pk_mul_f16 v237, v203, v202
v_pk_mul_f16 v238, v200, v199
v_pk_mul_f16 v239, v197, v196
s_setprio 3
v_mfma_f32_16x16x32_f16 v[48:51], v[224:227], v[232:235], v[48:51]
s_add_u32 s46, s68, 98304
buffer_load_dwordx4 v[208:211], v252, s[4:7], s46 offen offset:128
ds_read_b128 v[220:223], v249 offset:32000
v_cvt_pkrtz_f16_f32 v185, v168, v169
v_cvt_pkrtz_f16_f32 v187, v170, v171
v_mfma_f32_16x16x32_f16 v[56:59], v[224:227], v[236:239], v[56:59]
v_cvt_pkrtz_f16_f32 v189, v172, v173
v_cvt_pkrtz_f16_f32 v191, v174, v175
v_mfma_f32_16x16x32_f16 v[52:55], v[228:231], v[232:235], v[52:55]
ds_read_b128 v[224:227], v248 offset:35840
v_cvt_pkrtz_f16_f32 v193, v176, v177
v_cvt_pk_f16_f32 v203, v178, v179
v_mfma_f32_16x16x32_f16 v[60:63], v[228:231], v[236:239], v[60:63]
v_cvt_pk_f16_f32 v200, v180, v181
v_cvt_pk_f16_f32 v197, v182, v183
v_mfma_f32_16x16x32_bf16 v[168:171], v[240:243], v[96:99], 0
ds_read_b128 v[228:231], v249 offset:32768
v_pk_fma_f16 v202, v203, v203, s48
v_and_b32_e64 v185, s49, v185
v_mfma_f32_16x16x32_bf16 v[176:179], v[240:243], v[100:103], 0
v_pk_fma_f16 v199, v200, v200, s48
v_and_b32 v187, s49, v187
s_waitcnt lgkmcnt(3)
v_mfma_f32_16x16x32_f16 v[64:67], v[244:247], v[232:235], v[64:67]
ds_read_b128 v[240:243], v249 offset:33024
v_pk_fma_f16 v196, v197, v197, s48
v_bfe_u32 v184, v185, 2, 14
v_pk_mul_f16 v202, v203, v202
v_mfma_f32_16x16x32_f16 v[72:75], v[244:247], v[236:239], v[72:75]
v_bfe_u32 v186, v187, 2, 14
v_pk_mul_f16 v199, v200, v199
s_waitcnt vmcnt(5)
v_mfma_f32_16x16x32_bf16 v[152:155], v[18:21], v[12:15], v[152:155]
ds_read_b128 v[244:247], v248 offset:36096
ds_read_u16_d16 v184, v184
ds_read_u16_d16 v186, v186
v_lshrrev_b32 v185, 18, v185
v_pk_mul_f16 v196, v197, v196
v_mfma_f32_16x16x32_bf16 v[156:159], v[16:19], v[12:15], v[156:159]
v_lshrrev_b32_e64 v187, 18, v187
v_mfma_f32_16x16x32_bf16 v[172:175], v[216:219], v[96:99], 0
ds_read_u16_d16_hi v185, v185
ds_read_u16_d16_hi v187, v187
v_exp_f16 v201, v202
v_and_b32 v189, s49, v189
v_mfma_f32_16x16x32_bf16 v[180:183], v[216:219], v[100:103], 0
v_and_b32 v191, s49, v191
s_waitcnt lgkmcnt(6)
v_mfma_f32_16x16x32_f16 v[68:71], v[220:223], v[232:235], v[68:71]
ds_read_b128 v[216:219], v248 offset:36864
v_exp_f16_e64 v198, v199
v_bfe_u32 v188, v189, 2, 14
v_mfma_f32_16x16x32_f16 v[76:79], v[220:223], v[236:239], v[76:79]
v_bfe_u32 v190, v191, 2, 14
v_exp_f16_e64 v195, v196
v_mfma_f32_16x16x32_bf16 v[168:171], v[224:227], v[104:107], v[168:171]
ds_read_b128 v[220:223], v248 offset:37120
ds_read_u16_d16 v188, v188
ds_read_u16_d16 v190, v190
v_lshrrev_b32 v189, 18, v189
v_lshrrev_b32 v191, 18, v191
v_mfma_f32_16x16x32_bf16 v[176:179], v[224:227], v[108:111], v[176:179]
v_exp_f16_sdwa v201, v202 dst_sel:WORD_1 dst_unused:UNUSED_PRESERVE src0_sel:WORD_1
v_mfma_f32_16x16x32_f16 v[80:83], v[228:231], v[232:235], v[80:83]
ds_read_b128 v[224:227], v249 offset:36864
ds_read_u16_d16_hi v189, v189
ds_read_u16_d16_hi v191, v191
v_and_b32 v193, s49, v193
v_bfe_u32 v192, v193, 2, 14
v_mfma_f32_16x16x32_f16 v[88:91], v[228:231], v[236:239], v[88:91]
v_exp_f16_sdwa v198, v199 dst_sel:WORD_1 dst_unused:UNUSED_PRESERVE src0_sel:WORD_1
s_waitcnt lgkmcnt(7)
v_mfma_f32_16x16x32_f16 v[84:87], v[240:243], v[232:235], v[84:87]
ds_read_b128 v[228:231], v249 offset:37120
ds_read_u16_d16 v192, v192
v_lshrrev_b32_e64 v193, 18, v193
v_mfma_f32_16x16x32_f16 v[92:95], v[240:243], v[236:239], v[92:95]
v_exp_f16_sdwa v195, v196 dst_sel:WORD_1 dst_unused:UNUSED_PRESERVE src0_sel:WORD_1
v_pk_add_f16 v201, v201, 1.0 op_sel_hi:[1,0]
v_pk_add_f16 v198, v198, 1.0 op_sel_hi:[1,0]
v_mfma_f32_16x16x32_bf16 v[172:175], v[244:247], v[104:107], v[172:175]
ds_read_b128 v[240:243], v248 offset:40960
ds_read_u16_d16_hi v193, v193
v_pk_add_f16 v195, v195, 1.0 op_sel_hi:[1,0]
v_mfma_f32_16x16x32_bf16 v[180:183], v[244:247], v[108:111], v[180:183]
v_rcp_f16 v202, v201
s_waitcnt lgkmcnt(7)
v_mfma_f32_16x16x32_bf16 v[168:171], v[216:219], v[112:115], v[168:171]
ds_read_b128 v[244:247], v249 offset:37888
v_rcp_f16_e64 v199, v198
v_mfma_f32_16x16x32_bf16 v[176:179], v[216:219], v[116:119], v[176:179]
v_rcp_f16_e64 v196, v195
v_mfma_f32_16x16x32_bf16 v[172:175], v[220:223], v[112:115], v[172:175]
ds_read_b128 v[216:219], v248 offset:41216
v_rcp_f16_sdwa v202, v201 dst_sel:WORD_1 dst_unused:UNUSED_PRESERVE src0_sel:WORD_1
v_mfma_f32_16x16x32_bf16 v[180:183], v[220:223], v[116:119], v[180:183]
v_rcp_f16_sdwa v199, v198 dst_sel:WORD_1 dst_unused:UNUSED_PRESERVE src0_sel:WORD_1
v_or_b32 v232, v184, v185
v_or_b32 v233, v186, v187
s_waitcnt lgkmcnt(4)
v_or_b32 v234, v188, v189
v_rcp_f16_sdwa v196, v195 dst_sel:WORD_1 dst_unused:UNUSED_PRESERVE src0_sel:WORD_1
v_or_b32 v235, v190, v191
s_waitcnt lgkmcnt(2)
v_or_b32_e64 v236, v192, v193
v_pk_mul_f16 v237, v203, v202
v_pk_mul_f16 v238, v200, v199
v_pk_mul_f16 v239, v197, v196
v_mfma_f32_16x16x32_f16 v[48:51], v[224:227], v[232:235], v[48:51]
buffer_load_dwordx4 v[12:15], v252, s[4:7], s69 offen
ds_read_b128 v[220:223], v249 offset:38144
v_cvt_pkrtz_f16_f32 v185, v168, v169
v_cvt_pkrtz_f16_f32 v187, v170, v171
v_cvt_pkrtz_f16_f32 v189, v172, v173
v_mfma_f32_16x16x32_f16 v[56:59], v[224:227], v[236:239], v[56:59]
v_cvt_pkrtz_f16_f32 v191, v174, v175
v_cvt_pkrtz_f16_f32 v193, v176, v177
v_cvt_pk_f16_f32 v203, v178, v179
v_mfma_f32_16x16x32_f16 v[52:55], v[228:231], v[232:235], v[52:55]
ds_read_b128 v[224:227], v248 offset:41984
v_cvt_pk_f16_f32 v200, v180, v181
v_cvt_pk_f16_f32 v197, v182, v183
v_pk_fma_f16 v202, v203, v203, s48
v_cvt_pk_bf16_f32 v136, v136, v137
v_mfma_f32_16x16x32_f16 v[60:63], v[228:231], v[236:239], v[60:63]
v_and_b32_e64 v185, s49, v185
v_cvt_pk_bf16_f32 v137, v138, v139
v_pk_fma_f16 v199, v200, v200, s48
v_mfma_f32_16x16x32_bf16 v[168:171], v[240:243], v[96:99], 0
ds_read_b128 v[228:231], v249 offset:38912
v_and_b32_e64 v187, s49, v187
v_cvt_pk_bf16_f32 v138, v140, v141
v_pk_fma_f16 v196, v197, v197, s48
v_mfma_f32_16x16x32_bf16 v[176:179], v[240:243], v[100:103], 0
v_cvt_pk_bf16_f32 v139, v142, v143
v_bfe_u32 v184, v185, 2, 14
s_setprio 2
v_pk_mul_f16 v202, v203, v202
v_cvt_pk_bf16_f32 v120, v120, v121
s_waitcnt lgkmcnt(2)
v_mfma_f32_16x16x32_f16 v[64:67], v[244:247], v[232:235], v[64:67]
ds_read_b128 v[240:243], v249 offset:39168
ds_read_u16_d16 v184, v184
v_bfe_u32 v186, v187, 2, 14
v_cvt_pk_bf16_f32 v121, v122, v123
v_pk_mul_f16 v199, v200, v199
v_mfma_f32_16x16x32_f16 v[72:75], v[244:247], v[236:239], v[72:75]
v_lshrrev_b32_e64 v185, 18, v185
v_cvt_pk_bf16_f32 v122, v124, v125
v_pk_mul_f16 v196, v197, v196
v_mfma_f32_16x16x32_bf16 v[172:175], v[216:219], v[96:99], 0
ds_read_b128 v[244:247], v248 offset:42240
ds_read_u16_d16 v186, v186
ds_read_u16_d16_hi v185, v185
v_lshrrev_b32_e64 v187, 18, v187
v_cvt_pk_bf16_f32 v123, v126, v127
v_exp_f16_e64 v201, v202
v_mfma_f32_16x16x32_bf16 v[180:183], v[216:219], v[100:103], 0
v_cvt_pk_bf16_f32 v152, v152, v153
v_and_b32_e64 v189, s49, v189
v_cvt_pk_bf16_f32 v153, v154, v155
v_mfma_f32_16x16x32_f16 v[68:71], v[220:223], v[232:235], v[68:71]
ds_read_b128 v[216:219], v248 offset:43008
ds_read_u16_d16_hi v187, v187
v_and_b32_e64 v191, s49, v191
v_cvt_pk_bf16_f32 v154, v156, v157
v_mfma_f32_16x16x32_f16 v[76:79], v[220:223], v[236:239], v[76:79]
v_exp_f16_e64 v198, v199
v_cvt_pk_bf16_f32 v155, v158, v159
s_mov_b64 vcc, s[74:75]
v_bfe_u32 v188, v189, 2, 14
v_bfe_u32 v190, v191, 2, 14
s_waitcnt lgkmcnt(5)
v_mfma_f32_16x16x32_bf16 v[168:171], v[224:227], v[104:107], v[168:171]
ds_read_b128 v[220:223], v248 offset:43264
ds_read_u16_d16 v188, v188
ds_read_u16_d16 v190, v190
v_cndmask_b32 v140, v120, v152, vcc
v_exp_f16 v195, v196
v_mfma_f32_16x16x32_bf16 v[176:179], v[224:227], v[108:111], v[176:179]
v_cndmask_b32 v141, v121, v153, vcc
v_lshrrev_b32_e64 v189, 18, v189
v_cndmask_b32 v142, v122, v154, vcc
v_mfma_f32_16x16x32_f16 v[80:83], v[228:231], v[232:235], v[80:83]
ds_read_b128 v[224:227], v249 offset:43008
ds_read_u16_d16_hi v189, v189
v_lshrrev_b32 v191, 18, v191
v_cndmask_b32 v143, v123, v155, vcc
v_exp_f16_sdwa v201, v202 dst_sel:WORD_1 dst_unused:UNUSED_PRESERVE src0_sel:WORD_1
v_mfma_f32_16x16x32_f16 v[88:91], v[228:231], v[236:239], v[88:91]
v_cndmask_b32_dpp v120, v136, v120, vcc quad_perm:[1,0,3,2] row_mask:0xf bank_mask:0xf
v_and_b32_e64 v193, s49, v193
v_cndmask_b32_dpp v121, v137, v121, vcc quad_perm:[1,0,3,2] row_mask:0xf bank_mask:0xf
v_mfma_f32_16x16x32_f16 v[84:87], v[240:243], v[232:235], v[84:87]
ds_read_b128 v[228:231], v249 offset:43264
ds_read_u16_d16_hi v191, v191
v_bfe_u32 v192, v193, 2, 14
v_exp_f16_sdwa v198, v199 dst_sel:WORD_1 dst_unused:UNUSED_PRESERVE src0_sel:WORD_1
v_mfma_f32_16x16x32_f16 v[92:95], v[240:243], v[236:239], v[92:95]
v_cndmask_b32_dpp v122, v138, v122, vcc quad_perm:[1,0,3,2] row_mask:0xf bank_mask:0xf
v_lshrrev_b32_e64 v193, 18, v193
v_cndmask_b32_dpp v123, v139, v123, vcc quad_perm:[1,0,3,2] row_mask:0xf bank_mask:0xf
s_not_b64 vcc, s[74:75]
s_waitcnt lgkmcnt(4)
v_mfma_f32_16x16x32_bf16 v[172:175], v[244:247], v[104:107], v[172:175]
ds_read_b128 v[240:243], v248 offset:47104
ds_read_u16_d16 v192, v192
ds_read_u16_d16_hi v193, v193
v_exp_f16_sdwa v195, v196 dst_sel:WORD_1 dst_unused:UNUSED_PRESERVE src0_sel:WORD_1
v_cndmask_b32_dpp v152, v136, v152, vcc quad_perm:[1,0,3,2] row_mask:0xf bank_mask:0xf
v_pk_add_f16 v201, v201, 1.0 op_sel_hi:[1,0]
v_mfma_f32_16x16x32_bf16 v[180:183], v[244:247], v[108:111], v[180:183]
v_cndmask_b32_dpp v153, v137, v153, vcc quad_perm:[1,0,3,2] row_mask:0xf bank_mask:0xf
v_pk_add_f16 v198, v198, 1.0 op_sel_hi:[1,0]
v_cndmask_b32_dpp v154, v138, v154, vcc quad_perm:[1,0,3,2] row_mask:0xf bank_mask:0xf
v_mfma_f32_16x16x32_bf16 v[168:171], v[216:219], v[112:115], v[168:171]
ds_read_b128 v[244:247], v249 offset:44032
v_pk_add_f16 v195, v195, 1.0 op_sel_hi:[1,0]
v_rcp_f16_e64 v202, v201
v_cndmask_b32_dpp v155, v139, v155, vcc quad_perm:[1,0,3,2] row_mask:0xf bank_mask:0xf
v_mfma_f32_16x16x32_bf16 v[176:179], v[216:219], v[116:119], v[176:179]
v_rcp_f16_e64 v199, v198
v_mfma_f32_16x16x32_bf16 v[172:175], v[220:223], v[112:115], v[172:175]
ds_read_b128 v[216:219], v248 offset:47360
buffer_store_dwordx4 v[120:123], v255, s[8:11], s68 offen sc1
v_rcp_f16_e64 v196, v195
v_rcp_f16_sdwa v202, v201 dst_sel:WORD_1 dst_unused:UNUSED_PRESERVE src0_sel:WORD_1
v_mfma_f32_16x16x32_bf16 v[180:183], v[220:223], v[116:119], v[180:183]
v_rcp_f16_sdwa v199, v198 dst_sel:WORD_1 dst_unused:UNUSED_PRESERVE src0_sel:WORD_1
v_or_b32 v232, v184, v185
v_or_b32 v233, v186, v187
s_waitcnt lgkmcnt(3)
v_or_b32 v234, v188, v189
v_rcp_f16_sdwa v196, v195 dst_sel:WORD_1 dst_unused:UNUSED_PRESERVE src0_sel:WORD_1
v_or_b32 v235, v190, v191
s_waitcnt lgkmcnt(2)
v_or_b32_e64 v236, v192, v193
v_pk_mul_f16 v237, v203, v202
v_pk_mul_f16 v238, v200, v199
v_pk_mul_f16 v239, v197, v196
v_mfma_f32_16x16x32_f16 v[48:51], v[224:227], v[232:235], v[48:51]
buffer_load_dwordx4 v[204:207], v252, s[4:7], s69 offen offset:64
ds_read_b128 v[220:223], v249 offset:44288
v_cvt_pkrtz_f16_f32 v185, v168, v169
v_cvt_pkrtz_f16_f32 v187, v170, v171
v_mfma_f32_16x16x32_f16 v[56:59], v[224:227], v[236:239], v[56:59]
v_cvt_pkrtz_f16_f32 v189, v172, v173
v_cvt_pkrtz_f16_f32 v191, v174, v175
v_mfma_f32_16x16x32_f16 v[52:55], v[228:231], v[232:235], v[52:55]
ds_read_b128 v[224:227], v248 offset:48128
v_cvt_pkrtz_f16_f32 v193, v176, v177
v_cvt_pk_f16_f32 v203, v178, v179
v_mfma_f32_16x16x32_f16 v[60:63], v[228:231], v[236:239], v[60:63]
v_cvt_pk_f16_f32 v200, v180, v181
v_cvt_pk_f16_f32 v197, v182, v183
s_setprio 1
v_mfma_f32_16x16x32_bf16 v[168:171], v[240:243], v[96:99], 0
ds_read_b128 v[228:231], v249 offset:45056
v_pk_fma_f16 v202, v203, v203, s48
v_and_b32 v185, s49, v185
v_mfma_f32_16x16x32_bf16 v[176:179], v[240:243], v[100:103], 0
v_pk_fma_f16 v199, v200, v200, s48
v_and_b32 v187, s49, v187
s_waitcnt lgkmcnt(3)
v_mfma_f32_16x16x32_f16 v[64:67], v[244:247], v[232:235], v[64:67]
ds_read_b128 v[240:243], v249 offset:45312
v_pk_fma_f16 v196, v197, v197, s48
v_bfe_u32 v184, v185, 2, 14
v_pk_mul_f16 v202, v203, v202
v_mfma_f32_16x16x32_f16 v[72:75], v[244:247], v[236:239], v[72:75]
v_bfe_u32 v186, v187, 2, 14
v_pk_mul_f16 v199, v200, v199
s_waitcnt vmcnt(7)
v_mfma_f32_16x16x32_bf16 v[128:131], v[18:21], v[8:11], v[128:131]
ds_read_b128 v[244:247], v248 offset:48384
ds_read_u16_d16 v184, v184
ds_read_u16_d16 v186, v186
v_lshrrev_b32 v185, 18, v185
v_pk_mul_f16 v196, v197, v196
v_mfma_f32_16x16x32_bf16 v[132:135], v[16:19], v[8:11], v[132:135]
v_lshrrev_b32_e64 v187, 18, v187
v_mfma_f32_16x16x32_bf16 v[172:175], v[216:219], v[96:99], 0
ds_read_u16_d16_hi v185, v185
ds_read_u16_d16_hi v187, v187
v_exp_f16 v201, v202
v_and_b32 v189, s49, v189
v_mfma_f32_16x16x32_bf16 v[180:183], v[216:219], v[100:103], 0
v_and_b32 v191, s49, v191
s_waitcnt lgkmcnt(6)
v_mfma_f32_16x16x32_f16 v[68:71], v[220:223], v[232:235], v[68:71]
ds_read_b128 v[216:219], v248 offset:49152
v_exp_f16_e64 v198, v199
v_bfe_u32 v188, v189, 2, 14
v_mfma_f32_16x16x32_f16 v[76:79], v[220:223], v[236:239], v[76:79]
v_bfe_u32 v190, v191, 2, 14
v_exp_f16_e64 v195, v196
v_mfma_f32_16x16x32_bf16 v[168:171], v[224:227], v[104:107], v[168:171]
buffer_store_dwordx4 v[140:143], v255, s[8:11], s68 offen offset:128 sc1
ds_read_b128 v[220:223], v248 offset:49408
ds_read_u16_d16 v188, v188
ds_read_u16_d16 v190, v190
v_lshrrev_b32 v189, 18, v189
v_lshrrev_b32 v191, 18, v191
v_mfma_f32_16x16x32_bf16 v[176:179], v[224:227], v[108:111], v[176:179]
v_exp_f16_sdwa v201, v202 dst_sel:WORD_1 dst_unused:UNUSED_PRESERVE src0_sel:WORD_1
v_mfma_f32_16x16x32_f16 v[80:83], v[228:231], v[232:235], v[80:83]
ds_read_b128 v[224:227], v249 offset:49152
ds_read_u16_d16_hi v189, v189
ds_read_u16_d16_hi v191, v191
v_and_b32 v193, s49, v193
v_bfe_u32 v192, v193, 2, 14
v_mfma_f32_16x16x32_f16 v[88:91], v[228:231], v[236:239], v[88:91]
v_exp_f16_sdwa v198, v199 dst_sel:WORD_1 dst_unused:UNUSED_PRESERVE src0_sel:WORD_1
s_waitcnt lgkmcnt(7)
v_mfma_f32_16x16x32_f16 v[84:87], v[240:243], v[232:235], v[84:87]
ds_read_b128 v[228:231], v249 offset:49408
ds_read_u16_d16 v192, v192
v_lshrrev_b32_e64 v193, 18, v193
v_mfma_f32_16x16x32_f16 v[92:95], v[240:243], v[236:239], v[92:95]
v_exp_f16_sdwa v195, v196 dst_sel:WORD_1 dst_unused:UNUSED_PRESERVE src0_sel:WORD_1
v_pk_add_f16 v201, v201, 1.0 op_sel_hi:[1,0]
v_pk_add_f16 v198, v198, 1.0 op_sel_hi:[1,0]
v_mfma_f32_16x16x32_bf16 v[172:175], v[244:247], v[104:107], v[172:175]
ds_read_b128 v[240:243], v248 offset:53248
ds_read_u16_d16_hi v193, v193
v_pk_add_f16 v195, v195, 1.0 op_sel_hi:[1,0]
v_mfma_f32_16x16x32_bf16 v[180:183], v[244:247], v[108:111], v[180:183]
v_rcp_f16_e64 v202, v201
s_setprio 0
s_waitcnt lgkmcnt(7)
v_mfma_f32_16x16x32_bf16 v[168:171], v[216:219], v[112:115], v[168:171]
ds_read_b128 v[244:247], v249 offset:50176
v_rcp_f16_e64 v199, v198
v_mfma_f32_16x16x32_bf16 v[176:179], v[216:219], v[116:119], v[176:179]
v_rcp_f16_e64 v196, v195
v_mfma_f32_16x16x32_bf16 v[172:175], v[220:223], v[112:115], v[172:175]
ds_read_b128 v[216:219], v248 offset:53504
v_rcp_f16_sdwa v202, v201 dst_sel:WORD_1 dst_unused:UNUSED_PRESERVE src0_sel:WORD_1
v_mfma_f32_16x16x32_bf16 v[180:183], v[220:223], v[116:119], v[180:183]
v_rcp_f16_sdwa v199, v198 dst_sel:WORD_1 dst_unused:UNUSED_PRESERVE src0_sel:WORD_1
v_or_b32 v232, v184, v185
v_or_b32 v233, v186, v187
s_waitcnt lgkmcnt(4)
v_or_b32 v234, v188, v189
v_rcp_f16_sdwa v196, v195 dst_sel:WORD_1 dst_unused:UNUSED_PRESERVE src0_sel:WORD_1
v_or_b32 v235, v190, v191
s_waitcnt lgkmcnt(2)
v_or_b32 v236, v192, v193
v_pk_mul_f16 v237, v203, v202
v_pk_mul_f16 v238, v200, v199
v_pk_mul_f16 v239, v197, v196
s_setprio 3
v_mfma_f32_16x16x32_f16 v[48:51], v[224:227], v[232:235], v[48:51]
buffer_load_dwordx4 v[8:11], v252, s[4:7], s69 offen offset:128
ds_read_b128 v[220:223], v249 offset:50432
v_cvt_pkrtz_f16_f32 v185, v168, v169
v_cvt_pkrtz_f16_f32 v187, v170, v171
v_mfma_f32_16x16x32_f16 v[56:59], v[224:227], v[236:239], v[56:59]
v_cvt_pkrtz_f16_f32 v189, v172, v173
v_cvt_pkrtz_f16_f32 v191, v174, v175
v_mfma_f32_16x16x32_f16 v[52:55], v[228:231], v[232:235], v[52:55]
ds_read_b128 v[224:227], v248 offset:54272
v_cvt_pkrtz_f16_f32 v193, v176, v177
v_cvt_pk_f16_f32 v203, v178, v179
v_mfma_f32_16x16x32_f16 v[60:63], v[228:231], v[236:239], v[60:63]
v_cvt_pk_f16_f32 v200, v180, v181
v_cvt_pk_f16_f32 v197, v182, v183
v_mfma_f32_16x16x32_bf16 v[168:171], v[240:243], v[96:99], 0
ds_read_b128 v[228:231], v249 offset:51200
v_pk_fma_f16 v202, v203, v203, s48
v_and_b32_e64 v185, s49, v185
v_mfma_f32_16x16x32_bf16 v[176:179], v[240:243], v[100:103], 0
v_pk_fma_f16 v199, v200, v200, s48
v_and_b32 v187, s49, v187
s_waitcnt lgkmcnt(3)
v_mfma_f32_16x16x32_f16 v[64:67], v[244:247], v[232:235], v[64:67]
ds_read_b128 v[240:243], v249 offset:51456
v_pk_fma_f16 v196, v197, v197, s48
v_bfe_u32 v184, v185, 2, 14
v_pk_mul_f16 v202, v203, v202
v_mfma_f32_16x16x32_f16 v[72:75], v[244:247], v[236:239], v[72:75]
v_bfe_u32 v186, v187, 2, 14
v_pk_mul_f16 v199, v200, v199
s_waitcnt vmcnt(7)
v_mfma_f32_16x16x32_bf16 v[144:147], v[18:21], v[44:47], v[144:147]
ds_read_b128 v[244:247], v248 offset:54528
ds_read_u16_d16 v184, v184
ds_read_u16_d16 v186, v186
v_lshrrev_b32 v185, 18, v185
v_pk_mul_f16 v196, v197, v196
v_mfma_f32_16x16x32_bf16 v[148:151], v[16:19], v[44:47], v[148:151]
v_lshrrev_b32_e64 v187, 18, v187
v_mfma_f32_16x16x32_bf16 v[172:175], v[216:219], v[96:99], 0
ds_read_u16_d16_hi v185, v185
ds_read_u16_d16_hi v187, v187
v_exp_f16 v201, v202
v_and_b32 v189, s49, v189
v_mfma_f32_16x16x32_bf16 v[180:183], v[216:219], v[100:103], 0
v_and_b32 v191, s49, v191
s_waitcnt lgkmcnt(6)
v_mfma_f32_16x16x32_f16 v[68:71], v[220:223], v[232:235], v[68:71]
ds_read_b128 v[216:219], v248 offset:55296
v_exp_f16_e64 v198, v199
v_bfe_u32 v188, v189, 2, 14
v_mfma_f32_16x16x32_f16 v[76:79], v[220:223], v[236:239], v[76:79]
v_bfe_u32 v190, v191, 2, 14
v_exp_f16_e64 v195, v196
v_mfma_f32_16x16x32_bf16 v[168:171], v[224:227], v[104:107], v[168:171]
ds_read_b128 v[220:223], v248 offset:55552
ds_read_u16_d16 v188, v188
ds_read_u16_d16 v190, v190
v_lshrrev_b32 v189, 18, v189
v_lshrrev_b32 v191, 18, v191
v_mfma_f32_16x16x32_bf16 v[176:179], v[224:227], v[108:111], v[176:179]
v_exp_f16_sdwa v201, v202 dst_sel:WORD_1 dst_unused:UNUSED_PRESERVE src0_sel:WORD_1
v_mfma_f32_16x16x32_f16 v[80:83], v[228:231], v[232:235], v[80:83]
ds_read_b128 v[224:227], v249 offset:55296
ds_read_u16_d16_hi v189, v189
ds_read_u16_d16_hi v191, v191
v_and_b32 v193, s49, v193
v_bfe_u32 v192, v193, 2, 14
v_mfma_f32_16x16x32_f16 v[88:91], v[228:231], v[236:239], v[88:91]
v_exp_f16_sdwa v198, v199 dst_sel:WORD_1 dst_unused:UNUSED_PRESERVE src0_sel:WORD_1
s_waitcnt lgkmcnt(7)
v_mfma_f32_16x16x32_f16 v[84:87], v[240:243], v[232:235], v[84:87]
ds_read_b128 v[228:231], v249 offset:55552
ds_read_u16_d16 v192, v192
v_lshrrev_b32_e64 v193, 18, v193
v_mfma_f32_16x16x32_f16 v[92:95], v[240:243], v[236:239], v[92:95]
v_exp_f16_sdwa v195, v196 dst_sel:WORD_1 dst_unused:UNUSED_PRESERVE src0_sel:WORD_1
v_pk_add_f16 v201, v201, 1.0 op_sel_hi:[1,0]
v_pk_add_f16 v198, v198, 1.0 op_sel_hi:[1,0]
v_mfma_f32_16x16x32_bf16 v[172:175], v[244:247], v[104:107], v[172:175]
ds_read_b128 v[240:243], v248 offset:59392
ds_read_u16_d16_hi v193, v193
v_pk_add_f16 v195, v195, 1.0 op_sel_hi:[1,0]
v_mfma_f32_16x16x32_bf16 v[180:183], v[244:247], v[108:111], v[180:183]
v_rcp_f16 v202, v201
s_waitcnt lgkmcnt(7)
v_mfma_f32_16x16x32_bf16 v[168:171], v[216:219], v[112:115], v[168:171]
ds_read_b128 v[244:247], v249 offset:56320
v_rcp_f16_e64 v199, v198
v_mfma_f32_16x16x32_bf16 v[176:179], v[216:219], v[116:119], v[176:179]
v_rcp_f16_e64 v196, v195
v_mfma_f32_16x16x32_bf16 v[172:175], v[220:223], v[112:115], v[172:175]
ds_read_b128 v[216:219], v248 offset:59648
v_rcp_f16_sdwa v202, v201 dst_sel:WORD_1 dst_unused:UNUSED_PRESERVE src0_sel:WORD_1
v_mfma_f32_16x16x32_bf16 v[180:183], v[220:223], v[116:119], v[180:183]
v_rcp_f16_sdwa v199, v198 dst_sel:WORD_1 dst_unused:UNUSED_PRESERVE src0_sel:WORD_1
v_or_b32 v232, v184, v185
v_or_b32 v233, v186, v187
s_waitcnt lgkmcnt(4)
v_or_b32 v234, v188, v189
v_rcp_f16_sdwa v196, v195 dst_sel:WORD_1 dst_unused:UNUSED_PRESERVE src0_sel:WORD_1
v_or_b32 v235, v190, v191
s_waitcnt lgkmcnt(2)
v_or_b32_e64 v236, v192, v193
v_pk_mul_f16 v237, v203, v202
v_pk_mul_f16 v238, v200, v199
v_pk_mul_f16 v239, v197, v196
v_mfma_f32_16x16x32_f16 v[48:51], v[224:227], v[232:235], v[48:51]
s_add_u32 s46, s69, 98304
buffer_load_dwordx4 v[44:47], v252, s[4:7], s46 offen
ds_read_b128 v[220:223], v249 offset:56576
v_cvt_pkrtz_f16_f32 v185, v168, v169
v_cvt_pkrtz_f16_f32 v187, v170, v171
v_mfma_f32_16x16x32_f16 v[56:59], v[224:227], v[236:239], v[56:59]
v_cvt_pkrtz_f16_f32 v189, v172, v173
v_cvt_pkrtz_f16_f32 v191, v174, v175
v_mfma_f32_16x16x32_f16 v[52:55], v[228:231], v[232:235], v[52:55]
ds_read_b128 v[224:227], v248 offset:60416
v_cvt_pkrtz_f16_f32 v193, v176, v177
v_cvt_pk_f16_f32 v203, v178, v179
v_cvt_pk_f16_f32 v200, v180, v181
v_mfma_f32_16x16x32_f16 v[60:63], v[228:231], v[236:239], v[60:63]
v_cvt_pk_f16_f32 v197, v182, v183
v_pk_fma_f16 v202, v203, v203, s48
v_mfma_f32_16x16x32_bf16 v[168:171], v[240:243], v[96:99], 0
ds_read_b128 v[228:231], v249 offset:57344
v_and_b32_e64 v185, s49, v185
v_pk_fma_f16 v199, v200, v200, s48
v_mfma_f32_16x16x32_bf16 v[176:179], v[240:243], v[100:103], 0
v_and_b32_e64 v187, s49, v187
v_pk_fma_f16 v196, v197, v197, s48
s_setprio 2
v_bfe_u32 v184, v185, 2, 14
s_waitcnt lgkmcnt(3)
v_mfma_f32_16x16x32_f16 v[64:67], v[244:247], v[232:235], v[64:67]
ds_read_b128 v[240:243], v249 offset:57600
ds_read_u16_d16 v184, v184
v_pk_mul_f16 v202, v203, v202
v_bfe_u32 v186, v187, 2, 14
v_mfma_f32_16x16x32_f16 v[72:75], v[244:247], v[236:239], v[72:75]
v_pk_mul_f16 v199, v200, v199
v_lshrrev_b32_e64 v185, 18, v185
v_mfma_f32_16x16x32_bf16 v[172:175], v[216:219], v[96:99], 0
ds_read_b128 v[244:247], v248 offset:60672
ds_read_u16_d16 v186, v186
ds_read_u16_d16_hi v185, v185
v_pk_mul_f16 v196, v197, v196
v_lshrrev_b32_e64 v187, 18, v187
v_mfma_f32_16x16x32_bf16 v[180:183], v[216:219], v[100:103], 0
v_exp_f16_e64 v201, v202
v_and_b32 v189, s49, v189
s_waitcnt lgkmcnt(5)
v_mfma_f32_16x16x32_f16 v[68:71], v[220:223], v[232:235], v[68:71]
ds_read_b128 v[216:219], v248 offset:61440
ds_read_u16_d16_hi v187, v187
v_and_b32_e64 v191, s49, v191
v_mfma_f32_16x16x32_f16 v[76:79], v[220:223], v[236:239], v[76:79]
v_exp_f16_e64 v198, v199
v_bfe_u32 v188, v189, 2, 14
v_bfe_u32 v190, v191, 2, 14
v_mfma_f32_16x16x32_bf16 v[168:171], v[224:227], v[104:107], v[168:171]
buffer_store_dwordx4 v[152:155], v255, s[8:11], s68 offen offset:256 sc1
ds_read_b128 v[220:223], v248 offset:61696
ds_read_u16_d16 v188, v188
ds_read_u16_d16 v190, v190
v_exp_f16_e64 v195, v196
v_mfma_f32_16x16x32_bf16 v[176:179], v[224:227], v[108:111], v[176:179]
v_lshrrev_b32 v189, 18, v189
v_lshrrev_b32 v191, 18, v191
v_mfma_f32_16x16x32_f16 v[80:83], v[228:231], v[232:235], v[80:83]
ds_read_b128 v[224:227], v249 offset:61440
ds_read_u16_d16_hi v189, v189
ds_read_u16_d16_hi v191, v191
v_exp_f16_sdwa v201, v202 dst_sel:WORD_1 dst_unused:UNUSED_PRESERVE src0_sel:WORD_1
v_and_b32 v193, s49, v193
v_mfma_f32_16x16x32_f16 v[88:91], v[228:231], v[236:239], v[88:91]
v_bfe_u32 v192, v193, 2, 14
s_waitcnt lgkmcnt(8)
v_mfma_f32_16x16x32_f16 v[84:87], v[240:243], v[232:235], v[84:87]
ds_read_b128 v[228:231], v249 offset:61696
ds_read_u16_d16 v192, v192
v_exp_f16_sdwa v198, v199 dst_sel:WORD_1 dst_unused:UNUSED_PRESERVE src0_sel:WORD_1
v_lshrrev_b32_e64 v193, 18, v193
v_mfma_f32_16x16x32_f16 v[92:95], v[240:243], v[236:239], v[92:95]
v_exp_f16_sdwa v195, v196 dst_sel:WORD_1 dst_unused:UNUSED_PRESERVE src0_sel:WORD_1
v_pk_add_f16 v201, v201, 1.0 op_sel_hi:[1,0]
v_mfma_f32_16x16x32_bf16 v[172:175], v[244:247], v[104:107], v[172:175]
ds_read_b128 v[240:243], v249
ds_read_u16_d16_hi v193, v193
v_pk_add_f16 v198, v198, 1.0 op_sel_hi:[1,0]
v_pk_add_f16 v195, v195, 1.0 op_sel_hi:[1,0]
v_mfma_f32_16x16x32_bf16 v[180:183], v[244:247], v[108:111], v[180:183]
v_rcp_f16 v202, v201
s_waitcnt lgkmcnt(7)
v_mfma_f32_16x16x32_bf16 v[168:171], v[216:219], v[112:115], v[168:171]
ds_read_b128 v[244:247], v249 offset:62464
v_rcp_f16_e64 v199, v198
v_mfma_f32_16x16x32_bf16 v[176:179], v[216:219], v[116:119], v[176:179]
v_rcp_f16_e64 v196, v195
v_mfma_f32_16x16x32_bf16 v[172:175], v[220:223], v[112:115], v[172:175]
ds_read_b128 v[216:219], v249 offset:256
v_rcp_f16_sdwa v202, v201 dst_sel:WORD_1 dst_unused:UNUSED_PRESERVE src0_sel:WORD_1
v_mfma_f32_16x16x32_bf16 v[180:183], v[220:223], v[116:119], v[180:183]
v_rcp_f16_sdwa v199, v198 dst_sel:WORD_1 dst_unused:UNUSED_PRESERVE src0_sel:WORD_1
v_or_b32 v232, v184, v185
v_or_b32 v233, v186, v187
s_waitcnt lgkmcnt(4)
v_or_b32 v234, v188, v189
v_rcp_f16_sdwa v196, v195 dst_sel:WORD_1 dst_unused:UNUSED_PRESERVE src0_sel:WORD_1
v_or_b32 v235, v190, v191
s_waitcnt lgkmcnt(2)
v_or_b32_e64 v236, v192, v193
v_pk_mul_f16 v237, v203, v202
v_pk_mul_f16 v238, v200, v199
v_pk_mul_f16 v239, v197, v196
v_mfma_f32_16x16x32_f16 v[48:51], v[224:227], v[232:235], v[48:51]
s_add_u32 s46, s69, 98304
buffer_load_dwordx4 v[40:43], v252, s[4:7], s46 offen offset:64
ds_read_b128 v[220:223], v249 offset:62720
v_cvt_pkrtz_f16_f32 v185, v168, v169
v_cvt_pkrtz_f16_f32 v187, v170, v171
v_mfma_f32_16x16x32_f16 v[56:59], v[224:227], v[236:239], v[56:59]
v_cvt_pkrtz_f16_f32 v189, v172, v173
v_cvt_pkrtz_f16_f32 v191, v174, v175
v_mfma_f32_16x16x32_f16 v[52:55], v[228:231], v[232:235], v[52:55]
ds_read_b128 v[224:227], v249 offset:1024
v_cvt_pkrtz_f16_f32 v193, v176, v177
v_cvt_pk_f16_f32 v203, v178, v179
v_mfma_f32_16x16x32_f16 v[60:63], v[228:231], v[236:239], v[60:63]
v_cvt_pk_f16_f32 v200, v180, v181
v_cvt_pk_f16_f32 v197, v182, v183
s_setprio 1
v_mfma_f32_16x16x32_bf16 v[168:171], v[240:243], v[96:99], 0
ds_read_b128 v[228:231], v249 offset:63488
v_pk_fma_f16 v202, v203, v203, s48
v_and_b32 v185, s49, v185
v_mfma_f32_16x16x32_bf16 v[176:179], v[240:243], v[100:103], 0
v_pk_fma_f16 v199, v200, v200, s48
v_and_b32 v187, s49, v187
s_waitcnt lgkmcnt(3)
v_mfma_f32_16x16x32_f16 v[64:67], v[244:247], v[232:235], v[64:67]
ds_read_b128 v[240:243], v249 offset:63744
v_pk_fma_f16 v196, v197, v197, s48
v_bfe_u32 v184, v185, 2, 14
v_mfma_f32_16x16x32_f16 v[72:75], v[244:247], v[236:239], v[72:75]
v_pk_mul_f16 v202, v203, v202
v_bfe_u32 v186, v187, 2, 14
s_waitcnt vmcnt(8)
v_mfma_f32_16x16x32_bf16 v[160:163], v[18:21], v[208:211], v[160:163]
ds_read_b128 v[244:247], v249 offset:1280
ds_read_u16_d16 v184, v184
ds_read_u16_d16 v186, v186
v_pk_mul_f16 v199, v200, v199
v_lshrrev_b32 v185, 18, v185
v_mfma_f32_16x16x32_bf16 v[164:167], v[16:19], v[208:211], v[164:167]
v_pk_mul_f16 v196, v197, v196
v_lshrrev_b32_e64 v187, 18, v187
v_mfma_f32_16x16x32_bf16 v[172:175], v[216:219], v[96:99], 0
ds_read_u16_d16_hi v185, v185
ds_read_u16_d16_hi v187, v187
v_exp_f16_e64 v201, v202
v_mfma_f32_16x16x32_bf16 v[180:183], v[216:219], v[100:103], 0
v_and_b32_e64 v189, s49, v189
v_and_b32 v191, s49, v191
s_waitcnt lgkmcnt(6)
v_mfma_f32_16x16x32_f16 v[68:71], v[220:223], v[232:235], v[68:71]
ds_read_b128 v[216:219], v249 offset:2048
v_exp_f16_e64 v198, v199
v_mfma_f32_16x16x32_f16 v[76:79], v[220:223], v[236:239], v[76:79]
v_bfe_u32 v188, v189, 2, 14
v_bfe_u32 v190, v191, 2, 14
v_mfma_f32_16x16x32_bf16 v[168:171], v[224:227], v[104:107], v[168:171]
ds_read_b128 v[220:223], v249 offset:2304
ds_read_u16_d16 v188, v188
ds_read_u16_d16 v190, v190
v_exp_f16_e64 v195, v196
v_mfma_f32_16x16x32_bf16 v[176:179], v[224:227], v[108:111], v[176:179]
v_lshrrev_b32 v189, 18, v189
v_lshrrev_b32 v191, 18, v191
v_mfma_f32_16x16x32_f16 v[80:83], v[228:231], v[232:235], v[80:83]
ds_read_b128 v[224:227], v250 offset:2048
ds_read_u16_d16_hi v189, v189
ds_read_u16_d16_hi v191, v191
v_exp_f16_sdwa v201, v202 dst_sel:WORD_1 dst_unused:UNUSED_PRESERVE src0_sel:WORD_1
v_mfma_f32_16x16x32_f16 v[88:91], v[228:231], v[236:239], v[88:91]
v_and_b32 v193, s49, v193
v_bfe_u32 v192, v193, 2, 14
s_waitcnt lgkmcnt(7)
v_mfma_f32_16x16x32_f16 v[84:87], v[240:243], v[232:235], v[84:87]
ds_read_b128 v[228:231], v250 offset:2304
ds_read_u16_d16 v192, v192
v_exp_f16_sdwa v198, v199 dst_sel:WORD_1 dst_unused:UNUSED_PRESERVE src0_sel:WORD_1
v_mfma_f32_16x16x32_f16 v[92:95], v[240:243], v[236:239], v[92:95]
v_lshrrev_b32 v193, 18, v193
s_waitcnt vmcnt(7)
v_mfma_f32_16x16x32_bf16 v[48:51], v[18:21], v[12:15], v[48:51]
ds_read_b128 v[240:243], v249 offset:6144
ds_read_u16_d16_hi v193, v193
v_exp_f16_sdwa v195, v196 dst_sel:WORD_1 dst_unused:UNUSED_PRESERVE src0_sel:WORD_1
v_pk_add_f16 v201, v201, 1.0 op_sel_hi:[1,0]
v_mfma_f32_16x16x32_bf16 v[52:55], v[16:19], v[12:15], v[52:55]
v_pk_add_f16 v198, v198, 1.0 op_sel_hi:[1,0]
v_pk_add_f16 v195, v195, 1.0 op_sel_hi:[1,0]
v_mfma_f32_16x16x32_bf16 v[172:175], v[244:247], v[104:107], v[172:175]
v_rcp_f16 v202, v201
s_setprio 0
v_mfma_f32_16x16x32_bf16 v[180:183], v[244:247], v[108:111], v[180:183]
v_rcp_f16 v199, v198
s_waitcnt lgkmcnt(4)
v_mfma_f32_16x16x32_bf16 v[168:171], v[216:219], v[112:115], v[168:171]
ds_read_b128 v[244:247], v250 offset:3072
v_rcp_f16_e64 v196, v195
v_mfma_f32_16x16x32_bf16 v[176:179], v[216:219], v[116:119], v[176:179]
v_rcp_f16_sdwa v202, v201 dst_sel:WORD_1 dst_unused:UNUSED_PRESERVE src0_sel:WORD_1
v_mfma_f32_16x16x32_bf16 v[172:175], v[220:223], v[112:115], v[172:175]
ds_read_b128 v[216:219], v249 offset:6400
v_rcp_f16_sdwa v199, v198 dst_sel:WORD_1 dst_unused:UNUSED_PRESERVE src0_sel:WORD_1
v_mfma_f32_16x16x32_bf16 v[180:183], v[220:223], v[116:119], v[180:183]
v_or_b32 v232, v184, v185
v_or_b32 v233, v186, v187
v_or_b32_e64 v234, v188, v189
v_rcp_f16_sdwa v196, v195 dst_sel:WORD_1 dst_unused:UNUSED_PRESERVE src0_sel:WORD_1
v_or_b32 v235, v190, v191
s_waitcnt lgkmcnt(2)
v_or_b32_e64 v236, v192, v193
v_pk_mul_f16 v237, v203, v202
v_pk_mul_f16 v238, v200, v199
v_pk_mul_f16 v239, v197, v196
v_mfma_f32_16x16x32_f16 v[48:51], v[224:227], v[232:235], v[48:51]
s_add_u32 s46, s69, 98304
buffer_load_dwordx4 v[208:211], v252, s[4:7], s46 offen offset:128
ds_read_b128 v[220:223], v250 offset:3328
v_cvt_pkrtz_f16_f32 v185, v168, v169
v_cvt_pkrtz_f16_f32 v187, v170, v171
v_cvt_pkrtz_f16_f32 v189, v172, v173
v_mfma_f32_16x16x32_f16 v[56:59], v[224:227], v[236:239], v[56:59]
v_cvt_pkrtz_f16_f32 v191, v174, v175
v_cvt_pkrtz_f16_f32 v193, v176, v177
v_cvt_pk_f16_f32 v203, v178, v179
v_mfma_f32_16x16x32_f16 v[52:55], v[228:231], v[232:235], v[52:55]
ds_read_b128 v[224:227], v249 offset:7168
v_cvt_pk_f16_f32 v200, v180, v181
v_cvt_pk_f16_f32 v197, v182, v183
v_pk_fma_f16 v202, v203, v203, s48
v_mfma_f32_16x16x32_f16 v[60:63], v[228:231], v[236:239], v[60:63]
v_cvt_pk_bf16_f32 v144, v144, v145
v_and_b32_e64 v185, s49, v185
v_cvt_pk_bf16_f32 v145, v146, v147
v_mfma_f32_16x16x32_bf16 v[168:171], v[240:243], v[96:99], 0
ds_read_b128 v[228:231], v250 offset:4096
v_pk_fma_f16 v199, v200, v200, s48
v_and_b32 v187, s49, v187
v_cvt_pk_bf16_f32 v146, v148, v149
v_mfma_f32_16x16x32_bf16 v[176:179], v[240:243], v[100:103], 0
v_pk_fma_f16 v196, v197, v197, s48
v_cvt_pk_bf16_f32 v147, v150, v151
v_bfe_u32 v184, v185, 2, 14
s_waitcnt lgkmcnt(2)
v_mfma_f32_16x16x32_f16 v[64:67], v[244:247], v[232:235], v[64:67]
ds_read_b128 v[240:243], v250 offset:4352
ds_read_u16_d16 v184, v184
v_pk_mul_f16 v202, v203, v202
v_cvt_pk_bf16_f32 v128, v128, v129
v_bfe_u32 v186, v187, 2, 14
v_mfma_f32_16x16x32_f16 v[72:75], v[244:247], v[236:239], v[72:75]
v_cvt_pk_bf16_f32 v129, v130, v131
v_pk_mul_f16 v199, v200, v199
v_lshrrev_b32 v185, 18, v185
s_waitcnt vmcnt(6)
v_mfma_f32_16x16x32_bf16 v[64:67], v[18:21], v[204:207], v[64:67]
ds_read_b128 v[244:247], v249 offset:7424
ds_read_u16_d16 v186, v186
ds_read_u16_d16_hi v185, v185
v_cvt_pk_bf16_f32 v130, v132, v133
v_pk_mul_f16 v196, v197, v196
v_lshrrev_b32_e64 v187, 18, v187
v_mfma_f32_16x16x32_bf16 v[68:71], v[16:19], v[204:207], v[68:71]
v_cvt_pk_bf16_f32 v131, v134, v135
v_exp_f16_e64 v201, v202
v_mfma_f32_16x16x32_bf16 v[172:175], v[216:219], v[96:99], 0
ds_read_u16_d16_hi v187, v187
v_cvt_pk_bf16_f32 v160, v160, v161
v_and_b32_e64 v189, s49, v189
v_cvt_pk_bf16_f32 v161, v162, v163
v_mfma_f32_16x16x32_bf16 v[180:183], v[216:219], v[100:103], 0
v_and_b32_e64 v191, s49, v191
v_cvt_pk_bf16_f32 v162, v164, v165
v_mfma_f32_16x16x32_f16 v[68:71], v[220:223], v[232:235], v[68:71]
ds_read_b128 v[216:219], v249 offset:8192
v_exp_f16 v198, v199
v_cvt_pk_bf16_f32 v163, v166, v167
s_mov_b64 vcc, s[74:75]
v_bfe_u32 v188, v189, 2, 14
v_bfe_u32 v190, v191, 2, 14
v_mfma_f32_16x16x32_f16 v[76:79], v[220:223], v[236:239], v[76:79]
v_cndmask_b32 v148, v128, v160, vcc
v_exp_f16_e64 v195, v196
s_waitcnt lgkmcnt(2)
v_mfma_f32_16x16x32_bf16 v[168:171], v[224:227], v[104:107], v[168:171]
ds_read_b128 v[220:223], v249 offset:8448
ds_read_u16_d16 v188, v188
ds_read_u16_d16 v190, v190
v_cndmask_b32 v149, v129, v161, vcc
v_lshrrev_b32_e64 v189, 18, v189
v_cndmask_b32 v150, v130, v162, vcc
v_mfma_f32_16x16x32_bf16 v[176:179], v[224:227], v[108:111], v[176:179]
v_lshrrev_b32 v191, 18, v191
v_cndmask_b32 v151, v131, v163, vcc
v_mfma_f32_16x16x32_f16 v[80:83], v[228:231], v[232:235], v[80:83]
ds_read_b128 v[224:227], v250 offset:8192
ds_read_u16_d16_hi v189, v189
ds_read_u16_d16_hi v191, v191
v_exp_f16_sdwa v201, v202 dst_sel:WORD_1 dst_unused:UNUSED_PRESERVE src0_sel:WORD_1
v_cndmask_b32_dpp v128, v144, v128, vcc quad_perm:[1,0,3,2] row_mask:0xf bank_mask:0xf
v_and_b32_e64 v193, s49, v193
v_mfma_f32_16x16x32_f16 v[88:91], v[228:231], v[236:239], v[88:91]
v_cndmask_b32_dpp v129, v145, v129, vcc quad_perm:[1,0,3,2] row_mask:0xf bank_mask:0xf
v_bfe_u32 v192, v193, 2, 14
v_mfma_f32_16x16x32_f16 v[84:87], v[240:243], v[232:235], v[84:87]
ds_read_b128 v[228:231], v250 offset:8448
ds_read_u16_d16 v192, v192
v_exp_f16_sdwa v198, v199 dst_sel:WORD_1 dst_unused:UNUSED_PRESERVE src0_sel:WORD_1
v_cndmask_b32_dpp v130, v146, v130, vcc quad_perm:[1,0,3,2] row_mask:0xf bank_mask:0xf
v_lshrrev_b32 v193, 18, v193
v_mfma_f32_16x16x32_f16 v[92:95], v[240:243], v[236:239], v[92:95]
v_cndmask_b32_dpp v131, v147, v131, vcc quad_perm:[1,0,3,2] row_mask:0xf bank_mask:0xf
s_not_b64 vcc, s[74:75]
v_exp_f16_sdwa v195, v196 dst_sel:WORD_1 dst_unused:UNUSED_PRESERVE src0_sel:WORD_1
v_mfma_f32_16x16x32_bf16 v[172:175], v[244:247], v[104:107], v[172:175]
ds_read_b128 v[240:243], v249 offset:12288
ds_read_u16_d16_hi v193, v193
v_cndmask_b32_dpp v160, v144, v160, vcc quad_perm:[1,0,3,2] row_mask:0xf bank_mask:0xf
v_pk_add_f16 v201, v201, 1.0 op_sel_hi:[1,0]
v_cndmask_b32_dpp v161, v145, v161, vcc quad_perm:[1,0,3,2] row_mask:0xf bank_mask:0xf
v_mfma_f32_16x16x32_bf16 v[180:183], v[244:247], v[108:111], v[180:183]
v_pk_add_f16 v198, v198, 1.0 op_sel_hi:[1,0]
v_cndmask_b32_dpp v162, v146, v162, vcc quad_perm:[1,0,3,2] row_mask:0xf bank_mask:0xf
v_pk_add_f16 v195, v195, 1.0 op_sel_hi:[1,0]
s_waitcnt lgkmcnt(4)
v_mfma_f32_16x16x32_bf16 v[168:171], v[216:219], v[112:115], v[168:171]
ds_read_b128 v[244:247], v250 offset:9216
v_rcp_f16 v202, v201
v_cndmask_b32_dpp v163, v147, v163, vcc quad_perm:[1,0,3,2] row_mask:0xf bank_mask:0xf
v_mfma_f32_16x16x32_bf16 v[176:179], v[216:219], v[116:119], v[176:179]
v_rcp_f16_e64 v199, v198
v_mfma_f32_16x16x32_bf16 v[172:175], v[220:223], v[112:115], v[172:175]
ds_read_b128 v[216:219], v249 offset:12544
s_add_u32 s46, s68, 98304
buffer_store_dwordx4 v[128:131], v255, s[8:11], s46 offen sc1
v_rcp_f16_e64 v196, v195
v_rcp_f16_sdwa v202, v201 dst_sel:WORD_1 dst_unused:UNUSED_PRESERVE src0_sel:WORD_1
v_mfma_f32_16x16x32_bf16 v[180:183], v[220:223], v[116:119], v[180:183]
v_rcp_f16_sdwa v199, v198 dst_sel:WORD_1 dst_unused:UNUSED_PRESERVE src0_sel:WORD_1
v_or_b32 v232, v184, v185
v_or_b32 v233, v186, v187
v_or_b32_e64 v234, v188, v189
v_rcp_f16_sdwa v196, v195 dst_sel:WORD_1 dst_unused:UNUSED_PRESERVE src0_sel:WORD_1
v_or_b32 v235, v190, v191
s_waitcnt lgkmcnt(2)
v_or_b32_e64 v236, v192, v193
v_pk_mul_f16 v237, v203, v202
v_pk_mul_f16 v238, v200, v199
v_pk_mul_f16 v239, v197, v196
v_mfma_f32_16x16x32_f16 v[48:51], v[224:227], v[232:235], v[48:51]
s_add_u32 s46, s68, 98304
buffer_store_dwordx4 v[148:151], v255, s[8:11], s46 offen offset:128 sc1
ds_read_b128 v[220:223], v250 offset:9472
v_cvt_pkrtz_f16_f32 v185, v168, v169
v_cvt_pkrtz_f16_f32 v187, v170, v171
v_mfma_f32_16x16x32_f16 v[56:59], v[224:227], v[236:239], v[56:59]
v_cvt_pkrtz_f16_f32 v189, v172, v173
v_cvt_pkrtz_f16_f32 v191, v174, v175
v_mfma_f32_16x16x32_f16 v[52:55], v[228:231], v[232:235], v[52:55]
ds_read_b128 v[224:227], v249 offset:13312
v_cvt_pkrtz_f16_f32 v193, v176, v177
v_cvt_pk_f16_f32 v203, v178, v179
v_mfma_f32_16x16x32_f16 v[60:63], v[228:231], v[236:239], v[60:63]
v_cvt_pk_f16_f32 v200, v180, v181
v_cvt_pk_f16_f32 v197, v182, v183
v_mfma_f32_16x16x32_bf16 v[168:171], v[240:243], v[96:99], 0
ds_read_b128 v[228:231], v250 offset:10240
v_pk_fma_f16 v202, v203, v203, s48
v_and_b32_e64 v185, s49, v185
v_mfma_f32_16x16x32_bf16 v[176:179], v[240:243], v[100:103], 0
v_pk_fma_f16 v199, v200, v200, s48
v_and_b32 v187, s49, v187
s_waitcnt lgkmcnt(3)
v_mfma_f32_16x16x32_f16 v[64:67], v[244:247], v[232:235], v[64:67]
ds_read_b128 v[240:243], v250 offset:10496
v_pk_fma_f16 v196, v197, v197, s48
v_bfe_u32 v184, v185, 2, 14
v_pk_mul_f16 v202, v203, v202
v_mfma_f32_16x16x32_f16 v[72:75], v[244:247], v[236:239], v[72:75]
v_bfe_u32 v186, v187, 2, 14
v_pk_mul_f16 v199, v200, v199
s_waitcnt vmcnt(6)
v_mfma_f32_16x16x32_bf16 v[80:83], v[18:21], v[8:11], v[80:83]
ds_read_b128 v[244:247], v249 offset:13568
ds_read_u16_d16 v184, v184
ds_read_u16_d16 v186, v186
v_lshrrev_b32 v185, 18, v185
v_pk_mul_f16 v196, v197, v196
v_mfma_f32_16x16x32_bf16 v[84:87], v[16:19], v[8:11], v[84:87]
v_lshrrev_b32_e64 v187, 18, v187
v_mfma_f32_16x16x32_bf16 v[172:175], v[216:219], v[96:99], 0
ds_read_u16_d16_hi v185, v185
ds_read_u16_d16_hi v187, v187
v_exp_f16 v201, v202
v_and_b32 v189, s49, v189
v_mfma_f32_16x16x32_bf16 v[180:183], v[216:219], v[100:103], 0
v_and_b32 v191, s49, v191
s_waitcnt lgkmcnt(6)
v_mfma_f32_16x16x32_f16 v[68:71], v[220:223], v[232:235], v[68:71]
ds_read_b128 v[216:219], v249 offset:14336
v_exp_f16_e64 v198, v199
v_bfe_u32 v188, v189, 2, 14
v_mfma_f32_16x16x32_f16 v[76:79], v[220:223], v[236:239], v[76:79]
v_bfe_u32 v190, v191, 2, 14
v_exp_f16_e64 v195, v196
v_mfma_f32_16x16x32_bf16 v[168:171], v[224:227], v[104:107], v[168:171]
ds_read_b128 v[220:223], v249 offset:14592
ds_read_u16_d16 v188, v188
ds_read_u16_d16 v190, v190
v_lshrrev_b32 v189, 18, v189
v_lshrrev_b32 v191, 18, v191
v_mfma_f32_16x16x32_bf16 v[176:179], v[224:227], v[108:111], v[176:179]
v_exp_f16_sdwa v201, v202 dst_sel:WORD_1 dst_unused:UNUSED_PRESERVE src0_sel:WORD_1
v_mfma_f32_16x16x32_f16 v[80:83], v[228:231], v[232:235], v[80:83]
ds_read_b128 v[224:227], v250 offset:14336
ds_read_u16_d16_hi v189, v189
ds_read_u16_d16_hi v191, v191
v_and_b32 v193, s49, v193
v_bfe_u32 v192, v193, 2, 14
v_mfma_f32_16x16x32_f16 v[88:91], v[228:231], v[236:239], v[88:91]
v_exp_f16_sdwa v198, v199 dst_sel:WORD_1 dst_unused:UNUSED_PRESERVE src0_sel:WORD_1
s_waitcnt lgkmcnt(7)
v_mfma_f32_16x16x32_f16 v[84:87], v[240:243], v[232:235], v[84:87]
ds_read_b128 v[228:231], v250 offset:14592
ds_read_u16_d16 v192, v192
v_lshrrev_b32_e64 v193, 18, v193
v_mfma_f32_16x16x32_f16 v[92:95], v[240:243], v[236:239], v[92:95]
v_exp_f16_sdwa v195, v196 dst_sel:WORD_1 dst_unused:UNUSED_PRESERVE src0_sel:WORD_1
v_pk_add_f16 v201, v201, 1.0 op_sel_hi:[1,0]
v_pk_add_f16 v198, v198, 1.0 op_sel_hi:[1,0]
v_mfma_f32_16x16x32_bf16 v[172:175], v[244:247], v[104:107], v[172:175]
ds_read_b128 v[240:243], v249 offset:18432
ds_read_u16_d16_hi v193, v193
v_pk_add_f16 v195, v195, 1.0 op_sel_hi:[1,0]
v_mfma_f32_16x16x32_bf16 v[180:183], v[244:247], v[108:111], v[180:183]
v_rcp_f16 v202, v201
s_waitcnt lgkmcnt(7)
v_mfma_f32_16x16x32_bf16 v[168:171], v[216:219], v[112:115], v[168:171]
ds_read_b128 v[244:247], v250 offset:15360
v_rcp_f16_e64 v199, v198
v_mfma_f32_16x16x32_bf16 v[176:179], v[216:219], v[116:119], v[176:179]
v_rcp_f16_e64 v196, v195
v_mfma_f32_16x16x32_bf16 v[172:175], v[220:223], v[112:115], v[172:175]
ds_read_b128 v[216:219], v249 offset:18688
v_rcp_f16_sdwa v202, v201 dst_sel:WORD_1 dst_unused:UNUSED_PRESERVE src0_sel:WORD_1
v_mfma_f32_16x16x32_bf16 v[180:183], v[220:223], v[116:119], v[180:183]
v_rcp_f16_sdwa v199, v198 dst_sel:WORD_1 dst_unused:UNUSED_PRESERVE src0_sel:WORD_1
v_or_b32 v232, v184, v185
v_or_b32 v233, v186, v187
s_waitcnt lgkmcnt(4)
v_or_b32 v234, v188, v189
v_rcp_f16_sdwa v196, v195 dst_sel:WORD_1 dst_unused:UNUSED_PRESERVE src0_sel:WORD_1
v_or_b32 v235, v190, v191
s_waitcnt lgkmcnt(2)
v_or_b32_e64 v236, v192, v193
v_pk_mul_f16 v237, v203, v202
v_pk_mul_f16 v238, v200, v199
v_pk_mul_f16 v239, v197, v196
v_mfma_f32_16x16x32_f16 v[48:51], v[224:227], v[232:235], v[48:51]
ds_read_b128 v[220:223], v250 offset:15616
v_cvt_pkrtz_f16_f32 v185, v168, v169
v_cvt_pkrtz_f16_f32 v187, v170, v171
v_mfma_f32_16x16x32_f16 v[56:59], v[224:227], v[236:239], v[56:59]
v_cvt_pkrtz_f16_f32 v189, v172, v173
v_cvt_pkrtz_f16_f32 v191, v174, v175
v_mfma_f32_16x16x32_f16 v[52:55], v[228:231], v[232:235], v[52:55]
ds_read_b128 v[224:227], v249 offset:19456
v_cvt_pkrtz_f16_f32 v193, v176, v177
v_cvt_pk_f16_f32 v203, v178, v179
v_mfma_f32_16x16x32_f16 v[60:63], v[228:231], v[236:239], v[60:63]
v_cvt_pk_f16_f32 v200, v180, v181
v_cvt_pk_f16_f32 v197, v182, v183
v_mfma_f32_16x16x32_bf16 v[168:171], v[240:243], v[96:99], 0
ds_read_b128 v[228:231], v250 offset:16384
v_pk_fma_f16 v202, v203, v203, s48
v_and_b32_e64 v185, s49, v185
v_mfma_f32_16x16x32_bf16 v[176:179], v[240:243], v[100:103], 0
v_pk_fma_f16 v199, v200, v200, s48
v_and_b32 v187, s49, v187
s_waitcnt lgkmcnt(3)
v_mfma_f32_16x16x32_f16 v[64:67], v[244:247], v[232:235], v[64:67]
ds_read_b128 v[240:243], v250 offset:16640
v_pk_fma_f16 v196, v197, v197, s48
v_bfe_u32 v184, v185, 2, 14
v_pk_mul_f16 v202, v203, v202
v_mfma_f32_16x16x32_f16 v[72:75], v[244:247], v[236:239], v[72:75]
v_bfe_u32 v186, v187, 2, 14
v_pk_mul_f16 v199, v200, v199
s_waitcnt vmcnt(5)
v_mfma_f32_16x16x32_bf16 v[56:59], v[18:21], v[44:47], v[56:59]
ds_read_b128 v[244:247], v249 offset:19712
ds_read_u16_d16 v184, v184
ds_read_u16_d16 v186, v186
v_lshrrev_b32 v185, 18, v185
v_pk_mul_f16 v196, v197, v196
v_mfma_f32_16x16x32_bf16 v[60:63], v[16:19], v[44:47], v[60:63]
v_lshrrev_b32_e64 v187, 18, v187
v_mfma_f32_16x16x32_bf16 v[172:175], v[216:219], v[96:99], 0
ds_read_u16_d16_hi v185, v185
ds_read_u16_d16_hi v187, v187
v_exp_f16 v201, v202
v_and_b32 v189, s49, v189
v_mfma_f32_16x16x32_bf16 v[180:183], v[216:219], v[100:103], 0
v_and_b32 v191, s49, v191
s_waitcnt lgkmcnt(6)
v_mfma_f32_16x16x32_f16 v[68:71], v[220:223], v[232:235], v[68:71]
ds_read_b128 v[216:219], v249 offset:20480
v_exp_f16_e64 v198, v199
v_bfe_u32 v188, v189, 2, 14
v_mfma_f32_16x16x32_f16 v[76:79], v[220:223], v[236:239], v[76:79]
v_bfe_u32 v190, v191, 2, 14
v_exp_f16_e64 v195, v196
v_mfma_f32_16x16x32_bf16 v[168:171], v[224:227], v[104:107], v[168:171]
ds_read_b128 v[220:223], v249 offset:20736
ds_read_u16_d16 v188, v188
ds_read_u16_d16 v190, v190
v_lshrrev_b32 v189, 18, v189
v_lshrrev_b32 v191, 18, v191
v_mfma_f32_16x16x32_bf16 v[176:179], v[224:227], v[108:111], v[176:179]
v_exp_f16_sdwa v201, v202 dst_sel:WORD_1 dst_unused:UNUSED_PRESERVE src0_sel:WORD_1
v_mfma_f32_16x16x32_f16 v[80:83], v[228:231], v[232:235], v[80:83]
ds_read_b128 v[224:227], v250 offset:20480
ds_read_u16_d16_hi v189, v189
ds_read_u16_d16_hi v191, v191
v_and_b32 v193, s49, v193
v_bfe_u32 v192, v193, 2, 14
v_mfma_f32_16x16x32_f16 v[88:91], v[228:231], v[236:239], v[88:91]
v_exp_f16_sdwa v198, v199 dst_sel:WORD_1 dst_unused:UNUSED_PRESERVE src0_sel:WORD_1
s_waitcnt lgkmcnt(7)
v_mfma_f32_16x16x32_f16 v[84:87], v[240:243], v[232:235], v[84:87]
ds_read_b128 v[228:231], v250 offset:20736
ds_read_u16_d16 v192, v192
v_lshrrev_b32_e64 v193, 18, v193
v_mfma_f32_16x16x32_f16 v[92:95], v[240:243], v[236:239], v[92:95]
v_exp_f16_sdwa v195, v196 dst_sel:WORD_1 dst_unused:UNUSED_PRESERVE src0_sel:WORD_1
v_pk_add_f16 v201, v201, 1.0 op_sel_hi:[1,0]
v_pk_add_f16 v198, v198, 1.0 op_sel_hi:[1,0]
v_mfma_f32_16x16x32_bf16 v[172:175], v[244:247], v[104:107], v[172:175]
ds_read_b128 v[240:243], v250 offset:21504
ds_read_u16_d16_hi v193, v193
v_pk_add_f16 v195, v195, 1.0 op_sel_hi:[1,0]
v_mfma_f32_16x16x32_bf16 v[180:183], v[244:247], v[108:111], v[180:183]
v_rcp_f16 v202, v201
s_waitcnt lgkmcnt(7)
v_mfma_f32_16x16x32_bf16 v[168:171], v[216:219], v[112:115], v[168:171]
ds_read_b128 v[244:247], v250 offset:21760
v_rcp_f16_e64 v199, v198
v_mfma_f32_16x16x32_bf16 v[176:179], v[216:219], v[116:119], v[176:179]
v_rcp_f16_e64 v196, v195
v_mfma_f32_16x16x32_bf16 v[172:175], v[220:223], v[112:115], v[172:175]
ds_read_b128 v[216:219], v250 offset:22528
v_rcp_f16_sdwa v202, v201 dst_sel:WORD_1 dst_unused:UNUSED_PRESERVE src0_sel:WORD_1
v_mfma_f32_16x16x32_bf16 v[180:183], v[220:223], v[116:119], v[180:183]
v_rcp_f16_sdwa v199, v198 dst_sel:WORD_1 dst_unused:UNUSED_PRESERVE src0_sel:WORD_1
v_or_b32 v232, v184, v185
v_or_b32 v233, v186, v187
s_waitcnt lgkmcnt(4)
v_or_b32 v234, v188, v189
v_rcp_f16_sdwa v196, v195 dst_sel:WORD_1 dst_unused:UNUSED_PRESERVE src0_sel:WORD_1
v_or_b32 v235, v190, v191
s_waitcnt lgkmcnt(2)
v_or_b32_e64 v236, v192, v193
v_pk_mul_f16 v237, v203, v202
v_pk_mul_f16 v238, v200, v199
v_pk_mul_f16 v239, v197, v196
v_mfma_f32_16x16x32_f16 v[48:51], v[224:227], v[232:235], v[48:51]
s_add_u32 s46, s68, 98304
buffer_store_dwordx4 v[160:163], v255, s[8:11], s46 offen offset:256 sc1
ds_read_b128 v[220:223], v250 offset:22784
v_cvt_pkrtz_f16_f32 v185, v168, v169
v_cvt_pkrtz_f16_f32 v187, v170, v171
v_cvt_pkrtz_f16_f32 v189, v172, v173
v_cvt_pkrtz_f16_f32 v191, v174, v175
v_mfma_f32_16x16x32_f16 v[56:59], v[224:227], v[236:239], v[56:59]
v_cvt_pkrtz_f16_f32 v193, v176, v177
v_cvt_pk_f16_f32 v203, v178, v179
v_cvt_pk_f16_f32 v200, v180, v181
v_cvt_pk_f16_f32 v197, v182, v183
v_mfma_f32_16x16x32_f16 v[52:55], v[228:231], v[232:235], v[52:55]
ds_read_b128 v[224:227], v250 offset:26624
v_pk_fma_f16 v202, v203, v203, s48
v_and_b32_e64 v185, s49, v185
v_pk_fma_f16 v199, v200, v200, s48
v_and_b32_e64 v187, s49, v187
v_mfma_f32_16x16x32_f16 v[60:63], v[228:231], v[236:239], v[60:63]
v_pk_fma_f16 v196, v197, v197, s48
v_bfe_u32 v184, v185, 2, 14
v_pk_mul_f16 v202, v203, v202
v_bfe_u32 v186, v187, 2, 14
v_mfma_f32_16x16x32_f16 v[64:67], v[240:243], v[232:235], v[64:67]
ds_read_b128 v[228:231], v250 offset:26880
ds_read_u16_d16 v184, v184
ds_read_u16_d16 v186, v186
v_pk_mul_f16 v199, v200, v199
v_lshrrev_b32_e64 v185, 18, v185
v_pk_mul_f16 v196, v197, v196
v_lshrrev_b32_e64 v187, 18, v187
v_mfma_f32_16x16x32_f16 v[72:75], v[240:243], v[236:239], v[72:75]
v_exp_f16 v201, v202
v_and_b32 v189, s49, v189
v_and_b32 v191, s49, v191
s_waitcnt vmcnt(4)
v_mfma_f32_16x16x32_bf16 v[72:75], v[18:21], v[40:43], v[72:75]
ds_read_b128 v[240:243], v250 offset:27648
ds_read_u16_d16_hi v185, v185
ds_read_u16_d16_hi v187, v187
v_exp_f16_e64 v198, v199
v_bfe_u32 v188, v189, 2, 14
v_bfe_u32 v190, v191, 2, 14
v_mfma_f32_16x16x32_bf16 v[76:79], v[16:19], v[40:43], v[76:79]
v_exp_f16 v195, v196
v_lshrrev_b32 v189, 18, v189
v_lshrrev_b32 v191, 18, v191
s_waitcnt lgkmcnt(6)
v_mfma_f32_16x16x32_f16 v[68:71], v[244:247], v[232:235], v[68:71]
ds_read_u16_d16 v188, v188
ds_read_u16_d16 v190, v190
ds_read_u16_d16_hi v189, v189
ds_read_u16_d16_hi v191, v191
v_exp_f16_sdwa v201, v202 dst_sel:WORD_1 dst_unused:UNUSED_PRESERVE src0_sel:WORD_1
v_and_b32_e64 v193, s49, v193
v_bfe_u32 v192, v193, 2, 14
v_mfma_f32_16x16x32_f16 v[76:79], v[244:247], v[236:239], v[76:79]
v_exp_f16_sdwa v198, v199 dst_sel:WORD_1 dst_unused:UNUSED_PRESERVE src0_sel:WORD_1
v_lshrrev_b32_e64 v193, 18, v193
v_mfma_f32_16x16x32_f16 v[80:83], v[216:219], v[232:235], v[80:83]
ds_read_b128 v[244:247], v250 offset:27904
ds_read_u16_d16 v192, v192
ds_read_u16_d16_hi v193, v193
v_exp_f16_sdwa v195, v196 dst_sel:WORD_1 dst_unused:UNUSED_PRESERVE src0_sel:WORD_1
v_pk_add_f16 v201, v201, 1.0 op_sel_hi:[1,0]
v_pk_add_f16 v198, v198, 1.0 op_sel_hi:[1,0]
v_pk_add_f16 v195, v195, 1.0 op_sel_hi:[1,0]
v_mfma_f32_16x16x32_f16 v[88:91], v[216:219], v[236:239], v[88:91]
v_rcp_f16 v202, v201
v_rcp_f16 v199, v198
v_mfma_f32_16x16x32_f16 v[84:87], v[220:223], v[232:235], v[84:87]
ds_read_b128 v[216:219], v250 offset:28672
v_rcp_f16_e64 v196, v195
v_rcp_f16_sdwa v202, v201 dst_sel:WORD_1 dst_unused:UNUSED_PRESERVE src0_sel:WORD_1
v_mfma_f32_16x16x32_f16 v[92:95], v[220:223], v[236:239], v[92:95]
v_rcp_f16_sdwa v199, v198 dst_sel:WORD_1 dst_unused:UNUSED_PRESERVE src0_sel:WORD_1
s_waitcnt lgkmcnt(5)
v_or_b32 v232, v184, v185
v_or_b32_e64 v233, v186, v187
v_or_b32 v234, v188, v189
v_rcp_f16_sdwa v196, v195 dst_sel:WORD_1 dst_unused:UNUSED_PRESERVE src0_sel:WORD_1
s_waitcnt lgkmcnt(4)
v_or_b32 v235, v190, v191
s_waitcnt lgkmcnt(1)
v_or_b32 v236, v192, v193
v_pk_mul_f16 v237, v203, v202
v_pk_mul_f16 v238, v200, v199
v_pk_mul_f16 v239, v197, v196
v_mfma_f32_16x16x32_f16 v[48:51], v[224:227], v[232:235], v[48:51]
ds_read_b128 v[220:223], v250 offset:28928
v_mfma_f32_16x16x32_f16 v[56:59], v[224:227], v[236:239], v[56:59]
v_mfma_f32_16x16x32_f16 v[52:55], v[228:231], v[232:235], v[52:55]
v_mfma_f32_16x16x32_f16 v[60:63], v[228:231], v[236:239], v[60:63]
v_mfma_f32_16x16x32_f16 v[64:67], v[240:243], v[232:235], v[64:67]
v_mfma_f32_16x16x32_f16 v[72:75], v[240:243], v[236:239], v[72:75]
s_waitcnt vmcnt(3)
v_mfma_f32_16x16x32_bf16 v[88:91], v[18:21], v[208:211], v[88:91]
v_mfma_f32_16x16x32_bf16 v[92:95], v[16:19], v[208:211], v[92:95]
v_mfma_f32_16x16x32_f16 v[68:71], v[244:247], v[232:235], v[68:71]
v_mfma_f32_16x16x32_f16 v[76:79], v[244:247], v[236:239], v[76:79]
s_waitcnt lgkmcnt(1)
v_mfma_f32_16x16x32_f16 v[80:83], v[216:219], v[232:235], v[80:83]
v_mfma_f32_16x16x32_f16 v[88:91], v[216:219], v[236:239], v[88:91]
s_waitcnt lgkmcnt(0)
v_mfma_f32_16x16x32_f16 v[84:87], v[220:223], v[232:235], v[84:87]
v_mfma_f32_16x16x32_f16 v[92:95], v[220:223], v[236:239], v[92:95]
v_cvt_pk_bf16_f32 v64, v64, v65
v_cvt_pk_bf16_f32 v65, v66, v67
v_cvt_pk_bf16_f32 v66, v68, v69
v_cvt_pk_bf16_f32 v67, v70, v71
v_cvt_pk_bf16_f32 v48, v48, v49
v_cvt_pk_bf16_f32 v49, v50, v51
v_cvt_pk_bf16_f32 v50, v52, v53
v_cvt_pk_bf16_f32 v51, v54, v55
v_cvt_pk_bf16_f32 v80, v80, v81
v_cvt_pk_bf16_f32 v81, v82, v83
v_cvt_pk_bf16_f32 v82, v84, v85
v_cvt_pk_bf16_f32 v83, v86, v87
s_mov_b64 vcc, s[74:75]
v_cndmask_b32 v68, v48, v80, vcc
v_cndmask_b32 v69, v49, v81, vcc
v_cndmask_b32 v70, v50, v82, vcc
v_cndmask_b32 v71, v51, v83, vcc
v_cndmask_b32_dpp v48, v64, v48, vcc quad_perm:[1,0,3,2] row_mask:0xf bank_mask:0xf
v_cndmask_b32_dpp v49, v65, v49, vcc quad_perm:[1,0,3,2] row_mask:0xf bank_mask:0xf
v_cndmask_b32_dpp v50, v66, v50, vcc quad_perm:[1,0,3,2] row_mask:0xf bank_mask:0xf
v_cndmask_b32_dpp v51, v67, v51, vcc quad_perm:[1,0,3,2] row_mask:0xf bank_mask:0xf
s_not_b64 vcc, s[74:75]
v_cndmask_b32_dpp v80, v64, v80, vcc quad_perm:[1,0,3,2] row_mask:0xf bank_mask:0xf
v_cndmask_b32_dpp v81, v65, v81, vcc quad_perm:[1,0,3,2] row_mask:0xf bank_mask:0xf
v_cndmask_b32_dpp v82, v66, v82, vcc quad_perm:[1,0,3,2] row_mask:0xf bank_mask:0xf
v_cndmask_b32_dpp v83, v67, v83, vcc quad_perm:[1,0,3,2] row_mask:0xf bank_mask:0xf
buffer_store_dwordx4 v[48:51], v255, s[8:11], s69 offen sc1
buffer_store_dwordx4 v[68:71], v255, s[8:11], s69 offen offset:128 sc1
buffer_store_dwordx4 v[80:83], v255, s[8:11], s69 offen offset:256 sc1
v_cvt_pk_bf16_f32 v72, v72, v73
v_cvt_pk_bf16_f32 v73, v74, v75
v_cvt_pk_bf16_f32 v74, v76, v77
v_cvt_pk_bf16_f32 v75, v78, v79
v_cvt_pk_bf16_f32 v56, v56, v57
v_cvt_pk_bf16_f32 v57, v58, v59
v_cvt_pk_bf16_f32 v58, v60, v61
v_cvt_pk_bf16_f32 v59, v62, v63
v_cvt_pk_bf16_f32 v88, v88, v89
v_cvt_pk_bf16_f32 v89, v90, v91
v_cvt_pk_bf16_f32 v90, v92, v93
v_cvt_pk_bf16_f32 v91, v94, v95
s_mov_b64 vcc, s[74:75]
v_cndmask_b32 v76, v56, v88, vcc
v_cndmask_b32 v77, v57, v89, vcc
v_cndmask_b32 v78, v58, v90, vcc
v_cndmask_b32 v79, v59, v91, vcc
v_cndmask_b32_dpp v56, v72, v56, vcc quad_perm:[1,0,3,2] row_mask:0xf bank_mask:0xf
v_cndmask_b32_dpp v57, v73, v57, vcc quad_perm:[1,0,3,2] row_mask:0xf bank_mask:0xf
v_cndmask_b32_dpp v58, v74, v58, vcc quad_perm:[1,0,3,2] row_mask:0xf bank_mask:0xf
v_cndmask_b32_dpp v59, v75, v59, vcc quad_perm:[1,0,3,2] row_mask:0xf bank_mask:0xf
s_not_b64 vcc, s[74:75]
v_cndmask_b32_dpp v88, v72, v88, vcc quad_perm:[1,0,3,2] row_mask:0xf bank_mask:0xf
v_cndmask_b32_dpp v89, v73, v89, vcc quad_perm:[1,0,3,2] row_mask:0xf bank_mask:0xf
v_cndmask_b32_dpp v90, v74, v90, vcc quad_perm:[1,0,3,2] row_mask:0xf bank_mask:0xf
v_cndmask_b32_dpp v91, v75, v91, vcc quad_perm:[1,0,3,2] row_mask:0xf bank_mask:0xf
s_add_u32 s46, s69, 98304
buffer_store_dwordx4 v[56:59], v255, s[8:11], s46 offen sc1
s_add_u32 s46, s69, 98304
buffer_store_dwordx4 v[76:79], v255, s[8:11], s46 offen offset:128 sc1
s_add_u32 s46, s69, 98304
buffer_store_dwordx4 v[88:91], v255, s[8:11], s46 offen offset:256 sc1
s_endpgm
Lpoll:
s_waitcnt vmcnt(0)
Lpoll1:
s_cmp_eq_u32 s77, 2
s_cbranch_scc1 LpollC
v_max_u32 v255, v156, v157
v_max3_u32 v255, v255, v158, v159
v_max3_u32 v255, v255, v160, v161
v_max3_u32 v255, v255, v162, v163
v_max3_u32 v255, v255, v164, v165
v_max3_u32 v255, v255, v166, v167
v_max3_u32 v255, v255, v240, v241
v_max3_u32 v255, v255, v242, v243
v_cmp_eq_u32 vcc, -1, v255
s_nop 4
s_cbranch_vccz LpollR
v_lshlrev_b32 v247, 4, v251
s_lshl_b32 s44, s2, 12
buffer_load_dwordx4 v[156:159], v247, s[32:35], s44 offen sc1
buffer_load_dwordx4 v[160:163], v247, s[32:35], s44 offen offset:1024 sc1
buffer_load_dwordx4 v[164:167], v247, s[32:35], s44 offen offset:2048 sc1
buffer_load_dwordx4 v[240:243], v247, s[32:35], s44 offen offset:3072 sc1
s_setpc_b64 s[78:79]
LpollR:
s_setprio 3
v_add_f32 v156, v156, v160
v_add_f32 v240, v164, v240
v_add_f32 v240, v156, v240
v_add_f32 v157, v157, v161
v_add_f32 v241, v165, v241
v_add_f32 v241, v157, v241
v_add_f32 v158, v158, v162
v_add_f32 v242, v166, v242
v_add_f32 v242, v158, v242
v_add_f32 v159, v159, v163
v_add_f32 v243, v167, v243
v_add_f32 v243, v159, v243
v_add_f32_dpp v240, v240, v240 row_ror:8 row_mask:0xf bank_mask:0xf
s_nop 1
v_add_f32_dpp v240, v240, v240 row_ror:4 row_mask:0xf bank_mask:0xf
s_nop 1
v_add_f32_dpp v240, v240, v240 row_ror:2 row_mask:0xf bank_mask:0xf
s_nop 1
v_add_f32_dpp v240, v240, v240 row_ror:1 row_mask:0xf bank_mask:0xf
v_mov_b32 v255, v240
s_nop 1
v_permlane16_swap_b32 v240, v255
v_add_f32 v240, v240, v255
v_mov_b32 v255, v240
s_nop 1
v_permlane32_swap_b32 v240, v255
v_add_f32 v240, v240, v255
v_min_u32 v240, -2, v240
v_add_f32_dpp v241, v241, v241 row_ror:8 row_mask:0xf bank_mask:0xf
s_nop 1
v_add_f32_dpp v241, v241, v241 row_ror:4 row_mask:0xf bank_mask:0xf
s_nop 1
v_add_f32_dpp v241, v241, v241 row_ror:2 row_mask:0xf bank_mask:0xf
s_nop 1
v_add_f32_dpp v241, v241, v241 row_ror:1 row_mask:0xf bank_mask:0xf
v_mov_b32 v255, v241
s_nop 1
v_permlane16_swap_b32 v241, v255
v_add_f32 v241, v241, v255
v_mov_b32 v255, v241
s_nop 1
v_permlane32_swap_b32 v241, v255
v_add_f32 v241, v241, v255
v_min_u32 v241, -2, v241
v_add_f32_dpp v242, v242, v242 row_ror:8 row_mask:0xf bank_mask:0xf
s_nop 1
v_add_f32_dpp v242, v242, v242 row_ror:4 row_mask:0xf bank_mask:0xf
s_nop 1
v_add_f32_dpp v242, v242, v242 row_ror:2 row_mask:0xf bank_mask:0xf
s_nop 1
v_add_f32_dpp v242, v242, v242 row_ror:1 row_mask:0xf bank_mask:0xf
v_mov_b32 v255, v242
s_nop 1
v_permlane16_swap_b32 v242, v255
v_add_f32 v242, v242, v255
v_mov_b32 v255, v242
s_nop 1
v_permlane32_swap_b32 v242, v255
v_add_f32 v242, v242, v255
v_min_u32 v242, -2, v242
v_add_f32_dpp v243, v243, v243 row_ror:8 row_mask:0xf bank_mask:0xf
s_nop 1
v_add_f32_dpp v243, v243, v243 row_ror:4 row_mask:0xf bank_mask:0xf
s_nop 1
v_add_f32_dpp v243, v243, v243 row_ror:2 row_mask:0xf bank_mask:0xf
s_nop 1
v_add_f32_dpp v243, v243, v243 row_ror:1 row_mask:0xf bank_mask:0xf
v_mov_b32 v255, v243
s_nop 1
v_permlane16_swap_b32 v243, v255
v_add_f32 v243, v243, v255
v_mov_b32 v255, v243
s_nop 1
v_permlane32_swap_b32 v243, v255
v_add_f32_e64 v243, v243, v255
v_min_u32 v243, -2, v243
s_lshl_b32 s44, s2, 4
s_add_u32 s44, s44, 393216
v_lshlrev_b32_e64 v255, 11, v251
s_mov_b64 exec, 0xff
buffer_store_dwordx4 v[240:243], v255, s[32:35], s44 offen sc1
s_mov_b64 exec, -1
s_cmp_eq_u32 s40, 0
s_cselect_b32 s77, 2, 0
s_cbranch_scc0 LpollRx
v_lshlrev_b32_e64 v247, 3, v251
s_and_b32 s44, s2, 7
s_lshl_b32 s44, s44, 11
s_add_u32 s44, s44, 393216
buffer_load_dwordx2 v[156:157], v247, s[32:35], s44 offen sc1
buffer_load_dwordx2 v[158:159], v247, s[32:35], s44 offen offset:512 sc1
buffer_load_dwordx2 v[160:161], v247, s[32:35], s44 offen offset:1024 sc1
LpollRx:
s_setpc_b64 s[78:79]
LpollC:
v_max3_u32 v255, v156, v157, v158
v_max3_u32 v255, v255, v159, v160
v_max_u32 v255, v255, v161
v_cmp_eq_u32 vcc, -1, v255
s_nop 4
s_cbranch_vccz LpollS
v_lshlrev_b32 v247, 3, v251
s_and_b32 s44, s2, 7
s_lshl_b32 s44, s44, 11
s_add_u32 s44, s44, 393216
buffer_load_dwordx2 v[156:157], v247, s[32:35], s44 offen sc1
buffer_load_dwordx2 v[158:159], v247, s[32:35], s44 offen offset:512 sc1
buffer_load_dwordx2 v[160:161], v247, s[32:35], s44 offen offset:1024 sc1
s_setpc_b64 s[78:79]
LpollS:
s_setprio 3
s_mov_b32 s43, 1083296634
v_mov_b32 v162, 897988541
v_fma_f32 v156, v156, s43, v162
v_fma_f32 v157, v157, s43, v162
v_fma_f32 v158, v158, s43, v162
v_fma_f32 v159, v159, s43, v162
v_fma_f32 v160, v160, s43, v162
v_fma_f32 v161, v161, s43, v162
v_sqrt_f32 v156, v156
v_sqrt_f32 v157, v157
v_sqrt_f32 v158, v158
v_sqrt_f32 v159, v159
v_sqrt_f32 v160, v160
v_sqrt_f32 v161, v161
v_add_f32 v163, v156, v157
v_add_f32 v163, v163, v158
v_add_f32 v163, v163, v159
v_add_f32 v163, v163, v160
v_add_f32 v163, v163, v161
s_nop 1
v_add_f32_dpp v163, v163, v163 row_ror:8 row_mask:0xf bank_mask:0xf
s_nop 1
v_add_f32_dpp v163, v163, v163 row_ror:4 row_mask:0xf bank_mask:0xf
s_nop 1
v_add_f32_dpp v163, v163, v163 row_ror:2 row_mask:0xf bank_mask:0xf
s_nop 1
v_add_f32_dpp v163, v163, v163 row_ror:1 row_mask:0xf bank_mask:0xf
v_mov_b32 v255, v163
s_nop 1
v_permlane16_swap_b32 v163, v255
v_add_f32 v163, v163, v255
v_mov_b32 v255, v163
s_nop 1
v_permlane32_swap_b32 v163, v255
v_add_f32_e64 v163, v163, v255
s_mov_b32 s43, 992651947
v_fma_f32 v163, v163, s43, v162
v_rcp_f32_e64 v163, v163
v_mov_b32 v162, 3221789604
v_mul_f32 v163, v163, v162
v_lshlrev_b32 v164, 16, v244
v_and_b32 v165, 4294901760, v244
v_mul_f32 v156, v156, v163
v_mul_f32 v157, v157, v163
v_fma_f32 v164, v164, v156, v162
v_fma_f32 v165, v165, v157, v162
v_cvt_pk_f16_f32 v244, v164, v165
v_lshlrev_b32_e64 v164, 16, v245
v_and_b32 v165, 4294901760, v245
v_mul_f32 v158, v158, v163
v_mul_f32 v159, v159, v163
v_fma_f32 v164, v164, v158, v162
v_fma_f32 v165, v165, v159, v162
v_cvt_pk_f16_f32 v245, v164, v165
v_lshlrev_b32_e64 v164, 16, v246
v_and_b32 v165, 4294901760, v246
v_mul_f32 v160, v160, v163
v_mul_f32 v161, v161, v163
v_fma_f32 v164, v164, v160, v162
v_fma_f32 v165, v165, v161, v162
v_cvt_pk_f16_f32 v246, v164, v165
s_mov_b32 s77, 0
s_setpc_b64 s[78:79]
Lend:
s_endpgm

.section .rodata,"a"
.p2align 6
.amdhsa_kernel standalone__modern_conv_block_convnext_v2__vision_kernel
  .amdhsa_next_free_vgpr 256
  .amdhsa_next_free_sgpr 102
  .amdhsa_accum_offset 256
  .amdhsa_group_segment_fixed_size 0
  .amdhsa_kernarg_size 72
  .amdhsa_user_sgpr_count 2
  .amdhsa_user_sgpr_kernarg_segment_ptr 1
  .amdhsa_system_sgpr_workgroup_id_x 1
.end_amdhsa_kernel
```

```asm
; @launch grid=(256,1,1) block=(512,1,1) lds=163840
.amdgcn_target "amdgcn-amd-amdhsa--gfx950"
.text
.globl standalone__modern_conv_block_convnext_v2__vision_kernel
.p2align 8
.type standalone__modern_conv_block_convnext_v2__vision_kernel,@function
standalone__modern_conv_block_convnext_v2__vision_kernel:
Lmain:
s_cmp_ge_u32 s2, 256
s_cbranch_scc1 Lend
s_load_dwordx16 s[80:95], s[0:1], 0
s_load_dwordx2 s[96:97], s[0:1], 64
s_getpc_b64 s[74:75]
Lpc0:
s_sub_u32 s74, s74, Lpc0-Lmain
s_subb_u32 s75, s75, 0
v_lshlrev_b32 v159, 7, v0
s_movk_i32 s43, 64
v_cmp_gt_u32 vcc, s43, v0
s_and_saveexec_b64 s[78:79], vcc
s_cbranch_execz Lpf0x
global_load_dword v255, v159, s[74:75]
Lpf0x:
s_mov_b64 exec, s[78:79]
v_mov_b32 v199, v0
v_and_b32 v251, 63, v0
v_lshrrev_b32 v120, 6, v0
s_nop 0
v_readfirstlane_b32 s40, v120
s_and_b32 s43, s2, 7
s_lshr_b32 s44, s2, 3
s_and_b32 s41, s43, 0
s_lshl_b32 s41, s41, 4
s_and_b32 s45, s44, 15
s_add_u32 s41, s41, s45
s_lshr_b32 s42, s43, 0
s_lshl_b32 s42, s42, 1
s_lshr_b32 s45, s44, 4
s_add_u32 s42, s42, s45
s_lshl_b32 s41, s41, 5
s_lshl_b32 s42, s42, 5
s_lshl_b32 s67, s40, 6
s_cmp_eq_u32 s40, 6
s_cselect_b32 s67, 352, s67
v_add_u32_e64 v125, s67, v251
v_mul_u32_u24 v121, 5462, v125
v_lshrrev_b32 v121, 16, v121
v_mul_u32_u24 v122, 12, v121
v_sub_u32 v122, v125, v122
v_bfe_u32 v123, v121, 2, 2
v_xor_b32 v122, v122, v123
v_add_u32 v123, s41, v121
v_subrev_u32 v123, 1, v123
v_mul_u32_u24 v124, 192, v123
v_lshl_add_u32 v124, v122, 4, v124
v_mov_b32 v240, 2147483648
s_movk_i32 s43, 512
v_cmp_gt_u32 vcc, s43, v123
s_nop 1
v_cndmask_b32 v124, v240, v124, vcc
v_cmp_gt_u32 vcc, 34, v121
s_nop 1
v_cndmask_b32 v240, v240, v124, vcc
s_add_i32 s43, s42, -1
s_mul_i32 s44, s43, 98304
s_cmp_lt_u32 s43, 512
s_cselect_b32 s46, s44, 1073741824
s_mul_i32 s66, s42, 98304
s_mov_b32 s6, 50331648
s_mov_b32 s7, 131072
s_lshl_b32 s67, s67, 4
s_add_u32 s67, s67, 90112
s_cmp_eq_u32 s40, 7
s_cselect_b32 s67, 163840, s67
v_lshlrev_b32 v130, 1, v199
v_add_u32 v155, 768, v199
v_min_u32 v155, 863, v155
v_lshlrev_b32_e64 v131, 1, v155
s_waitcnt lgkmcnt(0)
s_mov_b32 s4, s80
s_and_b32 s5, s81, 65535
s_cmp_ge_u32 s40, 4
s_cbranch_scc1 Lnodw
s_mov_b32 s20, s82
s_and_b32 s21, s83, 65535
s_mov_b32 s22, 1728
s_mov_b32 s23, 131072
buffer_load_ushort v126, v130, s[20:23], 0 offen offset:0
buffer_load_ushort v127, v130, s[20:23], 0 offen offset:512
buffer_load_ushort v128, v130, s[20:23], 0 offen offset:1024
buffer_load_ushort v129, v131, s[20:23], 0 offen offset:0
Lnodw:
s_cmp_eq_u32 s40, 7
s_cbranch_scc1 Lskipx0
s_add_u32 m0, s67, 0
s_nop 0
buffer_load_dwordx4 v240, s[4:7], s46 offen nt lds
s_add_u32 m0, s67, 6656
s_nop 0
buffer_load_dwordx4 v240, s[4:7], s66 offen nt lds
s_add_u32 m0, s67, 13312
s_add_u32 s45, s66, 98304
buffer_load_dwordx4 v240, s[4:7], s45 offen nt lds
s_add_u32 m0, s67, 19968
s_add_u32 s45, s66, 196608
buffer_load_dwordx4 v240, s[4:7], s45 offen nt lds
s_add_u32 m0, s67, 26624
s_add_u32 s45, s66, 294912
buffer_load_dwordx4 v240, s[4:7], s45 offen nt lds
s_add_u32 m0, s67, 33280
s_add_u32 s45, s66, 393216
buffer_load_dwordx4 v240, s[4:7], s45 offen nt lds
Lskipx0:
s_mov_b32 s12, s84
s_and_b32 s13, s85, 65535
s_mov_b32 s14, 73728
s_mov_b32 s15, 131072
v_lshrrev_b32 v189, 2, v251
v_mul_u32_u24 v189, 768, v189
v_and_b32_e64 v125, 3, v251
v_lshl_add_u32 v189, v125, 4, v189
s_and_b32 s43, s40, 3
s_lshl_b32 s3, s43, 6
s_mul_i32 s77, s43, 6144
s_add_u32 s77, s77, 16384
v_mov_b32 v253, 16256
v_mov_b32 v254, 1
s_add_u32 s43, s42, s40
s_add_u32 s43, s43, 1
s_lshl_b32 s43, s43, 9
s_add_u32 s43, s43, s41
s_mul_i32 s47, s43, 192
s_sub_u32 s47, s47, 256
s_and_b32 s43, s40, 1
s_lshl_b32 s46, s43, 4
s_add_u32 s41, s41, s46
s_and_b32 s43, s40, 6
s_add_u32 s42, s42, s43
s_mul_i32 s45, s43, 6656
s_add_u32 s45, s45, 90112
v_and_b32 v131, 15, v251
v_lshrrev_b32 v132, 4, v251
v_mul_u32_u24 v122, 6656, v132
v_add_u32 v122, s45, v122
v_add_u32 v121, s46, v131
v_mul_u32_u24 v123, 192, v121
v_bfe_u32 v124, v121, 2, 2
v_lshl_add_u32 v123, v124, 4, v123
v_add_u32 v242, v122, v123
v_add_u32 v121, 1, v121
v_mul_u32_u24 v123, 192, v121
v_bfe_u32 v124, v121, 2, 2
v_lshl_add_u32 v123, v124, 4, v123
v_add_u32 v243, v122, v123
v_add_u32 v121, 1, v121
v_mul_u32_u24 v123, 192, v121
v_bfe_u32 v124, v121, 2, 2
v_lshl_add_u32 v123, v124, 4, v123
v_add_u32_e64 v244, v122, v123
s_mul_i32 s72, s40, 9216
s_add_u32 s72, s72, 90112
v_bfe_u32 v133, v131, 2, 1
v_sub_u32 v133, v132, v133
v_lshrrev_b32 v134, 3, v131
v_and_b32_e64 v135, 3, v131
v_lshl_add_u32 v135, v134, 2, v135
v_lshlrev_b32_e64 v136, 7, v133
v_lshl_add_u32 v136, v135, 4, v136
v_add_u32 v136, 156672, v136
v_mov_b32 v135, 163840
v_cmp_gt_u32 vcc, 3, v133
s_nop 1
v_cndmask_b32 v245, v135, v136, vcc
v_and_b32 v135, 3, v131
v_mul_u32_u24 v246, 85, v135
s_mov_b32 s16, s86
s_and_b32 s17, s87, 65535
s_mov_b32 s18, 73728
s_mov_b32 s19, 131072
s_mov_b32 s24, s88
s_and_b32 s25, s89, 65535
s_mov_b32 s26, 768
s_mov_b32 s27, 131072
s_mov_b32 s28, s90
s_and_b32 s29, s91, 65535
s_mov_b32 s30, 768
s_mov_b32 s31, 131072
s_mov_b32 s8, s92
s_and_b32 s9, s93, 65535
s_mov_b32 s10, 50331648
s_mov_b32 s11, 131072
s_mov_b32 s36, s94
s_and_b32 s37, s95, 65535
s_mov_b32 s38, 256
s_mov_b32 s39, 131072
s_mov_b32 s32, s96
s_and_b32 s33, s97, 65535
s_mov_b32 s34, 83886080
s_mov_b32 s35, 131072
v_lshlrev_b32 v241, 4, v251
v_and_b32 v133, 35, v251
v_bfe_u32 v134, v251, 2, 2
v_lshl_add_u32 v133, v134, 3, v133
v_bfe_u32 v134, v251, 4, 1
v_lshl_add_u32 v133, v134, 2, v133
v_lshlrev_b32_e64 v248, 4, v133
v_add_u32 v249, 65536, v248
v_add_u32 v250, 131072, v248
s_lshl_b32 s73, s2, 3
s_add_u32 s73, s73, s40
s_lshl_b32 s80, s73, 10
s_add_u32 s80, s80, 4194304
s_mul_i32 s73, s73, 16
s_add_u32 s73, s73, 1048576
s_mul_i32 s46, s41, 192
s_add_u32 s43, s42, 0
s_mul_i32 s43, s43, 98304
s_add_u32 s68, s43, s46
s_add_u32 s43, s42, 8
s_mul_i32 s43, s43, 98304
s_add_u32 s69, s43, s46
s_add_u32 s43, s42, 16
s_mul_i32 s43, s43, 98304
s_add_u32 s70, s43, s46
s_add_u32 s43, s42, 24
s_mul_i32 s43, s43, 98304
s_add_u32 s71, s43, s46
s_mul_i32 s82, s40, 9216
s_mov_b32 s48, 1156203754
s_mov_b32 s49, 4294508536
s_mov_b32 s76, 400000
v_lshrrev_b32 v148, 5, v251
v_lshlrev_b32 v190, 8, v148
v_bfe_u32 v148, v251, 2, 2
v_lshl_add_u32 v190, v148, 6, v190
v_bfe_u32 v148, v251, 4, 1
v_lshl_add_u32 v190, v148, 5, v190
v_bfe_u32 v148, v251, 0, 1
v_lshl_add_u32 v190, v148, 4, v190
v_bfe_u32 v148, v251, 1, 1
v_lshl_add_u32 v190, v148, 3, v190
v_add_u32 v190, s77, v190
v_add_u32 v191, s77, v248
s_cmp_lt_u32 s40, 4
s_cbranch_scc1 Lnoy
v_lshlrev_b32_e64 v24, 6, v199
s_mov_b32 s43, 1065362610
v_mov_b32 v25, 1084047360
v_add_u32 v0, 32772, v24
v_add_u32 v1, 32780, v24
v_add_u32 v2, 32788, v24
v_add_u32 v3, 32796, v24
v_add_u32 v4, 32804, v24
v_add_u32 v5, 32812, v24
v_add_u32 v6, 32820, v24
v_add_u32 v7, 32828, v24
v_cvt_f32_f16 v0, v0
v_cvt_f32_f16 v1, v1
v_cvt_f32_f16 v2, v2
v_cvt_f32_f16 v3, v3
v_cvt_f32_f16 v4, v4
v_cvt_f32_f16 v5, v5
v_cvt_f32_f16 v6, v6
v_cvt_f32_f16 v7, v7
v_mul_f32 v8, v0, v0
v_mul_f32 v9, v1, v1
v_mul_f32 v10, v2, v2
v_mul_f32 v11, v3, v3
v_mul_f32 v12, v4, v4
v_mul_f32 v13, v5, v5
v_mul_f32 v14, v6, v6
v_mul_f32 v15, v7, v7
v_fma_f32 v8, v8, s43, v25
v_fma_f32 v9, v9, s43, v25
v_fma_f32 v10, v10, s43, v25
v_fma_f32 v11, v11, s43, v25
v_fma_f32 v12, v12, s43, v25
v_fma_f32 v13, v13, s43, v25
v_fma_f32 v14, v14, s43, v25
v_fma_f32 v15, v15, s43, v25
v_mul_f32 v8, v0, v8
v_mul_f32 v9, v1, v9
v_mul_f32 v10, v2, v10
v_mul_f32 v11, v3, v11
v_mul_f32 v12, v4, v12
v_mul_f32 v13, v5, v13
v_mul_f32 v14, v6, v14
v_mul_f32 v15, v7, v15
v_exp_f32 v8, v8
v_exp_f32 v9, v9
v_exp_f32 v10, v10
v_exp_f32 v11, v11
v_exp_f32 v12, v12
v_exp_f32 v13, v13
v_exp_f32 v14, v14
v_exp_f32 v15, v15
v_add_f32 v16, 1.0, v8
v_add_f32 v17, 1.0, v9
v_add_f32 v18, 1.0, v10
v_add_f32 v19, 1.0, v11
v_add_f32 v20, 1.0, v12
v_add_f32 v21, 1.0, v13
v_add_f32 v22, 1.0, v14
v_add_f32 v23, 1.0, v15
v_rcp_f32 v16, v16
v_rcp_f32 v17, v17
v_rcp_f32 v18, v18
v_rcp_f32 v19, v19
v_rcp_f32 v20, v20
v_rcp_f32 v21, v21
v_rcp_f32 v22, v22
v_rcp_f32 v23, v23
v_mul_f32 v0, v0, v16
v_mul_f32 v1, v1, v17
v_mul_f32 v2, v2, v18
v_mul_f32 v3, v3, v19
v_mul_f32 v4, v4, v20
v_mul_f32 v5, v5, v21
v_mul_f32 v6, v6, v22
v_mul_f32 v7, v7, v23
v_mul_f32 v8, v8, v0
v_mul_f32 v9, v9, v1
v_mul_f32 v10, v10, v2
v_mul_f32 v11, v11, v3
v_mul_f32 v12, v12, v4
v_mul_f32 v13, v13, v5
v_mul_f32 v14, v14, v6
v_mul_f32 v15, v15, v7
v_cvt_pk_f16_f32 v28, v0, v1
v_cvt_pk_f16_f32 v32, -v8, -v9
v_cvt_pk_f16_f32 v29, v2, v3
v_cvt_pk_f16_f32 v33, -v10, -v11
v_cvt_pk_f16_f32 v30, v4, v5
v_cvt_pk_f16_f32 v34, -v12, -v13
v_cvt_pk_f16_f32 v31, v6, v7
v_cvt_pk_f16_f32 v35, -v14, -v15
v_lshlrev_b32_e64 v24, 4, v199
v_mov_b32 v25, 163840
s_movk_i32 s43, 496
v_cmp_gt_u32 vcc, s43, v199
s_nop 1
v_cndmask_b32 v24, v25, v24, vcc
ds_write_b128 v24, v[32:35]
ds_write_b128 v24, v[28:31] offset:8192
Lnoy:
s_cmp_ge_u32 s40, 4
s_cbranch_scc1 Lnoo
v_add_u32_e64 v152, 0, v199
v_mul_u32_u24 v140, 683, v152
v_lshrrev_b32 v140, 16, v140
v_mul_u32_u24 v142, 11, v140
v_lshrrev_b32 v142, 5, v142
v_lshrrev_b32 v143, 5, v152
v_bfe_u32 v141, v152, 3, 2
v_bfe_u32 v144, v152, 4, 1
v_xor_b32 v141, v141, v144
v_sub_u32 v141, v141, v142
v_mul_i32_i24 v141, 9, v141
v_add_u32 v143, v143, v141
v_lshrrev_b32_e64 v141, 1, v143
v_mul_u32_u24 v141, 368, v141
v_lshl_add_u32 v143, v143, 3, v141
v_lshl_add_u32 v143, v142, 7, v143
v_and_b32_e64 v144, 7, v152
v_lshl_add_u32 v143, v144, 4, v143
v_add_u32 v156, 156672, v143
v_add_u32 v153, 256, v199
v_mul_u32_u24 v140, 683, v153
v_lshrrev_b32 v140, 16, v140
v_mul_u32_u24 v142, 11, v140
v_lshrrev_b32 v142, 5, v142
v_lshrrev_b32 v143, 5, v153
v_bfe_u32 v141, v153, 3, 2
v_bfe_u32 v144, v153, 4, 1
v_xor_b32 v141, v141, v144
v_sub_u32 v141, v141, v142
v_mul_i32_i24 v141, 9, v141
v_add_u32 v143, v143, v141
v_lshrrev_b32_e64 v141, 1, v143
v_mul_u32_u24 v141, 368, v141
v_lshl_add_u32 v143, v143, 3, v141
v_lshl_add_u32 v143, v142, 7, v143
v_and_b32_e64 v144, 7, v153
v_lshl_add_u32 v143, v144, 4, v143
v_add_u32 v157, 156672, v143
v_add_u32 v154, 512, v199
v_mul_u32_u24 v140, 683, v154
v_lshrrev_b32 v140, 16, v140
v_mul_u32_u24 v142, 11, v140
v_lshrrev_b32 v142, 5, v142
v_lshrrev_b32 v143, 5, v154
v_bfe_u32 v141, v154, 3, 2
v_bfe_u32 v144, v154, 4, 1
v_xor_b32 v141, v141, v144
v_sub_u32 v141, v141, v142
v_mul_i32_i24 v141, 9, v141
v_add_u32 v143, v143, v141
v_lshrrev_b32_e64 v141, 1, v143
v_mul_u32_u24 v141, 368, v141
v_lshl_add_u32 v143, v143, 3, v141
v_lshl_add_u32 v143, v142, 7, v143
v_and_b32_e64 v144, 7, v154
v_lshl_add_u32 v143, v144, 4, v143
v_add_u32 v158, 156672, v143
v_mul_u32_u24 v140, 683, v155
v_lshrrev_b32 v140, 16, v140
v_mul_u32_u24 v142, 11, v140
v_lshrrev_b32 v142, 5, v142
v_lshrrev_b32 v143, 5, v155
v_bfe_u32 v141, v155, 3, 2
v_bfe_u32 v144, v155, 4, 1
v_xor_b32 v141, v141, v144
v_sub_u32 v141, v141, v142
v_mul_i32_i24 v141, 9, v141
v_add_u32 v143, v143, v141
v_lshrrev_b32_e64 v141, 1, v143
v_mul_u32_u24 v141, 368, v141
v_lshl_add_u32 v143, v143, 3, v141
v_lshl_add_u32 v143, v142, 7, v143
v_and_b32_e64 v144, 7, v155
v_lshl_add_u32 v143, v144, 4, v143
v_add_u32 v159, 156672, v143
v_mov_b32 v160, 0
v_mov_b32 v161, 0
v_mov_b32_e64 v162, 0
v_mov_b32 v163, 0
s_mov_b64 exec, 1
ds_write_b128 v253, v[160:163]
ds_write_b128 v253, v[160:163] offset:16
s_mov_b64 exec, -1
s_waitcnt vmcnt(6)
v_and_b32_e64 v130, 4, v152
v_cmp_eq_u32 vcc, 0, v130
s_nop 1
v_cndmask_b32 v164, 0, v126, vcc
v_sub_u32 v165, v126, v164
ds_write_b64 v156, v[164:165]
v_and_b32_e64 v130, 4, v153
v_cmp_eq_u32 vcc, 0, v130
s_nop 1
v_cndmask_b32 v166, 0, v127, vcc
v_sub_u32 v167, v127, v166
ds_write_b64 v157, v[166:167]
v_and_b32_e64 v130, 4, v154
v_cmp_eq_u32 vcc, 0, v130
s_nop 1
v_cndmask_b32 v168, 0, v128, vcc
v_sub_u32 v169, v128, v168
ds_write_b64 v158, v[168:169]
v_and_b32_e64 v130, 4, v155
v_cmp_eq_u32 vcc, 0, v130
s_nop 1
v_cndmask_b32 v170, 0, v129, vcc
v_sub_u32 v171, v129, v170
ds_write_b64 v159, v[170:171]
s_waitcnt lgkmcnt(0)
Lnoo:
s_barrier
s_cmp_lt_u32 s40, 4
s_cbranch_scc1 Lnoy2
v_subrev_u32 v199, 256, v199
v_lshlrev_b32_e64 v24, 6, v199
s_mov_b32 s43, 1065362610
v_mov_b32 v25, 1084047360
v_add_u32 v0, 32772, v24
v_add_u32 v1, 32780, v24
v_add_u32 v2, 32788, v24
v_add_u32 v3, 32796, v24
v_add_u32 v4, 32804, v24
v_add_u32 v5, 32812, v24
v_add_u32 v6, 32820, v24
v_add_u32 v7, 32828, v24
v_cvt_f32_f16 v0, v0
v_cvt_f32_f16 v1, v1
v_cvt_f32_f16 v2, v2
v_cvt_f32_f16 v3, v3
v_cvt_f32_f16 v4, v4
v_cvt_f32_f16 v5, v5
v_cvt_f32_f16 v6, v6
v_cvt_f32_f16 v7, v7
v_mul_f32 v8, v0, v0
v_mul_f32 v9, v1, v1
v_mul_f32 v10, v2, v2
v_mul_f32 v11, v3, v3
v_mul_f32 v12, v4, v4
v_mul_f32 v13, v5, v5
v_mul_f32 v14, v6, v6
v_mul_f32 v15, v7, v7
v_fma_f32 v8, v8, s43, v25
v_fma_f32 v9, v9, s43, v25
v_fma_f32 v10, v10, s43, v25
v_fma_f32 v11, v11, s43, v25
v_fma_f32 v12, v12, s43, v25
v_fma_f32 v13, v13, s43, v25
v_fma_f32 v14, v14, s43, v25
v_fma_f32 v15, v15, s43, v25
v_mul_f32 v8, v0, v8
v_mul_f32 v9, v1, v9
v_mul_f32 v10, v2, v10
v_mul_f32 v11, v3, v11
v_mul_f32 v12, v4, v12
v_mul_f32 v13, v5, v13
v_mul_f32 v14, v6, v14
v_mul_f32 v15, v7, v15
v_exp_f32 v8, v8
v_exp_f32 v9, v9
v_exp_f32 v10, v10
v_exp_f32 v11, v11
v_exp_f32 v12, v12
v_exp_f32 v13, v13
v_exp_f32 v14, v14
v_exp_f32 v15, v15
v_add_f32 v16, 1.0, v8
v_add_f32 v17, 1.0, v9
v_add_f32 v18, 1.0, v10
v_add_f32 v19, 1.0, v11
v_add_f32 v20, 1.0, v12
v_add_f32 v21, 1.0, v13
v_add_f32 v22, 1.0, v14
v_add_f32 v23, 1.0, v15
v_rcp_f32 v16, v16
v_rcp_f32 v17, v17
v_rcp_f32 v18, v18
v_rcp_f32 v19, v19
v_rcp_f32 v20, v20
v_rcp_f32 v21, v21
v_rcp_f32 v22, v22
v_rcp_f32 v23, v23
v_mul_f32 v0, v0, v16
v_mul_f32 v1, v1, v17
v_mul_f32 v2, v2, v18
v_mul_f32 v3, v3, v19
v_mul_f32 v4, v4, v20
v_mul_f32 v5, v5, v21
v_mul_f32 v6, v6, v22
v_mul_f32 v7, v7, v23
v_mul_f32 v8, v8, v0
v_mul_f32 v9, v9, v1
v_mul_f32 v10, v10, v2
v_mul_f32 v11, v11, v3
v_mul_f32 v12, v12, v4
v_mul_f32 v13, v13, v5
v_mul_f32 v14, v14, v6
v_mul_f32 v15, v15, v7
v_cvt_pk_f16_f32 v28, v0, v1
v_cvt_pk_f16_f32 v32, -v8, -v9
v_cvt_pk_f16_f32 v29, v2, v3
v_cvt_pk_f16_f32 v33, -v10, -v11
v_cvt_pk_f16_f32 v30, v4, v5
v_cvt_pk_f16_f32 v34, -v12, -v13
v_cvt_pk_f16_f32 v31, v6, v7
v_cvt_pk_f16_f32 v35, -v14, -v15
v_lshlrev_b32_e64 v24, 4, v199
v_mov_b32 v25, 163840
s_movk_i32 s43, 496
v_cmp_gt_u32 vcc, s43, v199
s_nop 1
v_cndmask_b32 v24, v25, v24, vcc
ds_write_b128 v24, v[32:35]
ds_write_b128 v24, v[28:31] offset:8192
Lnoy2:
s_setprio 2
s_cmp_lt_u32 s40, 4
s_cbranch_scc0 Lsu0
s_call_b64 s[78:79], Lpre
s_call_b64 s[78:79], Lrb
s_waitcnt vmcnt(4)
s_mov_b64 exec, 1
ds_add_u32 v253, v254 offset:28
s_mov_b64 exec, -1
v_mov_b32 v253, 16256
Lsw288w:
ds_read_b32 v247, v253 offset:28
s_waitcnt lgkmcnt(0)
v_readfirstlane_b32 s43, v247
s_cmp_eq_u32 s76, 0
s_cbranch_scc1 Lsw288x
s_sub_u32 s76, s76, 1
s_cmp_lt_u32 s43, 8
s_cbranch_scc0 Lsw288x
s_sleep 2
s_branch Lsw288w
Lsw288x:
s_call_b64 s[78:79], Lconv0
s_mov_b64 exec, 1
ds_add_u32 v253, v254 offset:16
s_mov_b64 exec, -1
s_call_b64 s[78:79], Lln0
s_waitcnt vmcnt(0)
s_mov_b64 exec, 1
ds_add_u32 v253, v254 offset:12
s_mov_b64 exec, -1
s_call_b64 s[78:79], Lw1i
Lsu0:
s_cmp_ge_u32 s40, 4
s_cbranch_scc0 Lsu2
s_setprio 3
s_call_b64 s[78:79], Lw1f
s_waitcnt vmcnt(6)
s_mov_b64 exec, 1
ds_add_u32 v253, v254 offset:28
s_mov_b64 exec, -1
s_call_b64 s[78:79], Lrb
s_waitcnt vmcnt(4)
s_call_b64 s[78:79], Lw1a
s_mov_b64 exec, 1
ds_add_u32 v253, v254 offset:20
s_mov_b64 exec, -1
s_call_b64 s[78:79], Lpre
s_waitcnt vmcnt(0)
s_mov_b64 exec, 1
ds_add_u32 v253, v254 offset:12
s_mov_b64 exec, -1
v_mov_b32 v253, 16256
Lsw128w:
ds_read_b32 v247, v253 offset:12
s_waitcnt lgkmcnt(0)
v_readfirstlane_b32 s43, v247
s_cmp_eq_u32 s76, 0
s_cbranch_scc1 Lsw128x
s_sub_u32 s76, s76, 1
s_cmp_lt_u32 s43, 8
s_cbranch_scc0 Lsw128x
s_sleep 2
s_branch Lsw128w
Lsw128x:
s_call_b64 s[78:79], Lconv0
s_mov_b64 exec, 1
ds_add_u32 v253, v254 offset:16
s_mov_b64 exec, -1
s_call_b64 s[78:79], Lln0
Lsu2:
s_branch Lgo
Lconv0:
ds_read_b128 v[192:195], v242
ds_read_b128 v[196:199], v242 offset:64
ds_read_b128 v[200:203], v242 offset:128
ds_read_b128 v[204:207], v243
ds_read_b128 v[208:211], v243 offset:64
ds_read_b128 v[212:215], v243 offset:128
ds_read_b128 v[224:227], v244
ds_read_b128 v[228:231], v244 offset:64
ds_read_b128 v[232:235], v244 offset:128
v_xor_b32 v242, 16, v242
ds_read_b128 v[236:239], v242
ds_read_b128 v[216:219], v242 offset:64
ds_read_b128 v[220:223], v242 offset:128
s_waitcnt lgkmcnt(11)
v_smfmac_f32_16x16x32_bf16 v[0:3], v[48:49], v[192:195], v246
s_waitcnt lgkmcnt(10)
v_smfmac_f32_16x16x32_bf16 v[16:19], v[50:51], v[196:199], v246
s_waitcnt lgkmcnt(9)
v_smfmac_f32_16x16x32_bf16 v[32:35], v[52:53], v[200:203], v246
s_waitcnt lgkmcnt(8)
v_xor_b32 v243, 16, v243
ds_read_b128 v[192:195], v243
ds_read_b128 v[196:199], v243 offset:64
v_smfmac_f32_16x16x32_bf16 v[0:3], v[54:55], v[204:207], v246
s_waitcnt lgkmcnt(9)
v_smfmac_f32_16x16x32_bf16 v[16:19], v[56:57], v[208:211], v246
s_waitcnt lgkmcnt(8)
ds_read_b128 v[200:203], v243 offset:128
v_xor_b32 v244, 16, v244
ds_read_b128 v[204:207], v244
v_smfmac_f32_16x16x32_bf16 v[32:35], v[58:59], v[212:215], v246
s_waitcnt lgkmcnt(9)
v_smfmac_f32_16x16x32_bf16 v[0:3], v[60:61], v[224:227], v246
s_waitcnt lgkmcnt(8)
ds_read_b128 v[208:211], v244 offset:64
ds_read_b128 v[212:215], v244 offset:128
v_smfmac_f32_16x16x32_bf16 v[16:19], v[62:63], v[228:231], v246
s_waitcnt lgkmcnt(9)
v_smfmac_f32_16x16x32_bf16 v[32:35], v[64:65], v[232:235], v246
s_waitcnt lgkmcnt(8)
v_xor_b32 v242, 32, v242
ds_read_b128 v[224:227], v242
ds_read_b128 v[228:231], v242 offset:64
v_smfmac_f32_16x16x32_bf16 v[4:7], v[66:67], v[236:239], v246
s_waitcnt lgkmcnt(9)
v_smfmac_f32_16x16x32_bf16 v[20:23], v[68:69], v[216:219], v246
s_waitcnt lgkmcnt(8)
ds_read_b128 v[232:235], v242 offset:128
v_xor_b32 v243, 32, v243
ds_read_b128 v[236:239], v243
v_smfmac_f32_16x16x32_bf16 v[36:39], v[70:71], v[220:223], v246
s_waitcnt lgkmcnt(9)
v_smfmac_f32_16x16x32_bf16 v[4:7], v[72:73], v[192:195], v246
s_waitcnt lgkmcnt(8)
ds_read_b128 v[216:219], v243 offset:64
ds_read_b128 v[220:223], v243 offset:128
v_smfmac_f32_16x16x32_bf16 v[20:23], v[74:75], v[196:199], v246
s_waitcnt lgkmcnt(9)
v_smfmac_f32_16x16x32_bf16 v[36:39], v[76:77], v[200:203], v246
s_waitcnt lgkmcnt(8)
v_xor_b32 v244, 32, v244
ds_read_b128 v[192:195], v244
ds_read_b128 v[196:199], v244 offset:64
v_smfmac_f32_16x16x32_bf16 v[4:7], v[78:79], v[204:207], v246
s_waitcnt lgkmcnt(9)
v_smfmac_f32_16x16x32_bf16 v[20:23], v[80:81], v[208:211], v246
s_waitcnt lgkmcnt(8)
ds_read_b128 v[200:203], v244 offset:128
v_xor_b32 v242, 16, v242
ds_read_b128 v[204:207], v242
v_smfmac_f32_16x16x32_bf16 v[36:39], v[82:83], v[212:215], v246
s_waitcnt lgkmcnt(9)
v_smfmac_f32_16x16x32_bf16 v[12:15], v[84:85], v[224:227], v246
s_waitcnt lgkmcnt(8)
ds_read_b128 v[208:211], v242 offset:64
ds_read_b128 v[212:215], v242 offset:128
v_smfmac_f32_16x16x32_bf16 v[28:31], v[86:87], v[228:231], v246
s_waitcnt lgkmcnt(9)
v_smfmac_f32_16x16x32_bf16 v[44:47], v[88:89], v[232:235], v246
s_waitcnt lgkmcnt(8)
v_xor_b32 v243, 16, v243
ds_read_b128 v[224:227], v243
ds_read_b128 v[228:231], v243 offset:64
v_smfmac_f32_16x16x32_bf16 v[12:15], v[90:91], v[236:239], v246
s_waitcnt lgkmcnt(9)
v_smfmac_f32_16x16x32_bf16 v[28:31], v[92:93], v[216:219], v246
s_waitcnt lgkmcnt(8)
ds_read_b128 v[232:235], v243 offset:128
v_xor_b32 v244, 16, v244
ds_read_b128 v[236:239], v244
v_smfmac_f32_16x16x32_bf16 v[44:47], v[94:95], v[220:223], v246
s_waitcnt lgkmcnt(9)
v_smfmac_f32_16x16x32_bf16 v[12:15], v[96:97], v[192:195], v246
s_waitcnt lgkmcnt(8)
ds_read_b128 v[216:219], v244 offset:64
ds_read_b128 v[220:223], v244 offset:128
v_smfmac_f32_16x16x32_bf16 v[28:31], v[98:99], v[196:199], v246
s_waitcnt lgkmcnt(9)
v_smfmac_f32_16x16x32_bf16 v[44:47], v[100:101], v[200:203], v246
s_waitcnt lgkmcnt(8)
v_smfmac_f32_16x16x32_bf16 v[8:11], v[102:103], v[204:207], v246
s_waitcnt lgkmcnt(7)
v_smfmac_f32_16x16x32_bf16 v[24:27], v[104:105], v[208:211], v246
s_waitcnt lgkmcnt(6)
v_smfmac_f32_16x16x32_bf16 v[40:43], v[106:107], v[212:215], v246
s_waitcnt lgkmcnt(5)
v_smfmac_f32_16x16x32_bf16 v[8:11], v[108:109], v[224:227], v246
s_waitcnt lgkmcnt(4)
v_smfmac_f32_16x16x32_bf16 v[24:27], v[110:111], v[228:231], v246
s_waitcnt lgkmcnt(3)
v_smfmac_f32_16x16x32_bf16 v[40:43], v[112:113], v[232:235], v246
s_waitcnt lgkmcnt(2)
v_smfmac_f32_16x16x32_bf16 v[8:11], v[114:115], v[236:239], v246
s_waitcnt lgkmcnt(1)
v_smfmac_f32_16x16x32_bf16 v[24:27], v[116:117], v[216:219], v246
s_waitcnt lgkmcnt(0)
v_smfmac_f32_16x16x32_bf16 v[40:43], v[118:119], v[220:223], v246
s_nop 11
s_setpc_b64 s[78:79]
Lln0:
v_pk_add_f32 v[168:169], v[0:1], v[2:3]
v_pk_mul_f32 v[170:171], v[0:1], v[0:1]
v_pk_fma_f32 v[170:171], v[2:3], v[2:3], v[170:171]
v_pk_add_f32 v[168:169], v[168:169], v[4:5]
v_pk_fma_f32 v[170:171], v[4:5], v[4:5], v[170:171]
v_pk_add_f32 v[168:169], v[168:169], v[6:7]
v_pk_fma_f32 v[170:171], v[6:7], v[6:7], v[170:171]
v_pk_add_f32 v[168:169], v[168:169], v[8:9]
v_pk_fma_f32 v[170:171], v[8:9], v[8:9], v[170:171]
v_pk_add_f32 v[168:169], v[168:169], v[10:11]
v_pk_fma_f32 v[170:171], v[10:11], v[10:11], v[170:171]
v_pk_add_f32 v[168:169], v[168:169], v[12:13]
v_pk_fma_f32 v[170:171], v[12:13], v[12:13], v[170:171]
v_pk_add_f32 v[168:169], v[168:169], v[14:15]
v_pk_fma_f32 v[170:171], v[14:15], v[14:15], v[170:171]
v_pk_add_f32 v[168:169], v[168:169], v[16:17]
v_pk_fma_f32 v[170:171], v[16:17], v[16:17], v[170:171]
v_pk_add_f32 v[168:169], v[168:169], v[18:19]
v_pk_fma_f32 v[170:171], v[18:19], v[18:19], v[170:171]
v_pk_add_f32 v[168:169], v[168:169], v[20:21]
v_pk_fma_f32 v[170:171], v[20:21], v[20:21], v[170:171]
v_pk_add_f32 v[168:169], v[168:169], v[22:23]
v_pk_fma_f32 v[170:171], v[22:23], v[22:23], v[170:171]
v_pk_add_f32 v[168:169], v[168:169], v[24:25]
v_pk_fma_f32 v[170:171], v[24:25], v[24:25], v[170:171]
v_pk_add_f32 v[168:169], v[168:169], v[26:27]
v_pk_fma_f32 v[170:171], v[26:27], v[26:27], v[170:171]
v_pk_add_f32 v[168:169], v[168:169], v[28:29]
v_pk_fma_f32 v[170:171], v[28:29], v[28:29], v[170:171]
v_pk_add_f32 v[168:169], v[168:169], v[30:31]
v_pk_fma_f32 v[170:171], v[30:31], v[30:31], v[170:171]
v_pk_add_f32 v[168:169], v[168:169], v[32:33]
v_pk_fma_f32 v[170:171], v[32:33], v[32:33], v[170:171]
v_pk_add_f32 v[168:169], v[168:169], v[34:35]
v_pk_fma_f32 v[170:171], v[34:35], v[34:35], v[170:171]
v_pk_add_f32 v[168:169], v[168:169], v[36:37]
v_pk_fma_f32 v[170:171], v[36:37], v[36:37], v[170:171]
v_pk_add_f32 v[168:169], v[168:169], v[38:39]
v_pk_fma_f32 v[170:171], v[38:39], v[38:39], v[170:171]
v_pk_add_f32 v[168:169], v[168:169], v[40:41]
v_pk_fma_f32 v[170:171], v[40:41], v[40:41], v[170:171]
v_pk_add_f32 v[168:169], v[168:169], v[42:43]
v_pk_fma_f32 v[170:171], v[42:43], v[42:43], v[170:171]
v_pk_add_f32 v[168:169], v[168:169], v[44:45]
v_pk_fma_f32 v[170:171], v[44:45], v[44:45], v[170:171]
v_pk_add_f32 v[168:169], v[168:169], v[46:47]
v_pk_fma_f32 v[170:171], v[46:47], v[46:47], v[170:171]
v_add_f32 v168, v168, v169
v_add_f32 v170, v170, v171
s_nop 1
v_permlane32_swap_b32 v168, v170
v_add_f32_e64 v168, v168, v170
v_mul_f32 v168, 1009429163, v168
v_mov_b32_e64 v170, v168
s_nop 1
v_permlane32_swap_b32 v168, v170
v_fma_f32 v170, -v168, v168, v170
v_max_f32_e64 v170, 0, v170
v_add_f32 v170, 925353388, v170
v_rsq_f32 v170, v170
s_nop 0
v_mul_f32 v172, 3203391086, v170
v_mul_f32_e64 v173, v168, v172
v_pk_fma_f32 v[0:1], v[0:1], v[172:173], v[172:173] op_sel:[0,0,1] op_sel_hi:[1,0,1] neg_lo:[0,0,1] neg_hi:[0,0,1]
v_pk_fma_f32 v[2:3], v[2:3], v[172:173], v[172:173] op_sel:[0,0,1] op_sel_hi:[1,0,1] neg_lo:[0,0,1] neg_hi:[0,0,1]
v_pk_fma_f32 v[4:5], v[4:5], v[172:173], v[172:173] op_sel:[0,0,1] op_sel_hi:[1,0,1] neg_lo:[0,0,1] neg_hi:[0,0,1]
v_pk_fma_f32 v[6:7], v[6:7], v[172:173], v[172:173] op_sel:[0,0,1] op_sel_hi:[1,0,1] neg_lo:[0,0,1] neg_hi:[0,0,1]
v_pk_fma_f32 v[8:9], v[8:9], v[172:173], v[172:173] op_sel:[0,0,1] op_sel_hi:[1,0,1] neg_lo:[0,0,1] neg_hi:[0,0,1]
v_pk_fma_f32 v[10:11], v[10:11], v[172:173], v[172:173] op_sel:[0,0,1] op_sel_hi:[1,0,1] neg_lo:[0,0,1] neg_hi:[0,0,1]
v_pk_fma_f32 v[12:13], v[12:13], v[172:173], v[172:173] op_sel:[0,0,1] op_sel_hi:[1,0,1] neg_lo:[0,0,1] neg_hi:[0,0,1]
v_pk_fma_f32 v[14:15], v[14:15], v[172:173], v[172:173] op_sel:[0,0,1] op_sel_hi:[1,0,1] neg_lo:[0,0,1] neg_hi:[0,0,1]
v_pk_fma_f32 v[16:17], v[16:17], v[172:173], v[172:173] op_sel:[0,0,1] op_sel_hi:[1,0,1] neg_lo:[0,0,1] neg_hi:[0,0,1]
v_pk_fma_f32 v[18:19], v[18:19], v[172:173], v[172:173] op_sel:[0,0,1] op_sel_hi:[1,0,1] neg_lo:[0,0,1] neg_hi:[0,0,1]
v_pk_fma_f32 v[20:21], v[20:21], v[172:173], v[172:173] op_sel:[0,0,1] op_sel_hi:[1,0,1] neg_lo:[0,0,1] neg_hi:[0,0,1]
v_pk_fma_f32 v[22:23], v[22:23], v[172:173], v[172:173] op_sel:[0,0,1] op_sel_hi:[1,0,1] neg_lo:[0,0,1] neg_hi:[0,0,1]
v_pk_fma_f32 v[24:25], v[24:25], v[172:173], v[172:173] op_sel:[0,0,1] op_sel_hi:[1,0,1] neg_lo:[0,0,1] neg_hi:[0,0,1]
v_pk_fma_f32 v[26:27], v[26:27], v[172:173], v[172:173] op_sel:[0,0,1] op_sel_hi:[1,0,1] neg_lo:[0,0,1] neg_hi:[0,0,1]
v_pk_fma_f32 v[28:29], v[28:29], v[172:173], v[172:173] op_sel:[0,0,1] op_sel_hi:[1,0,1] neg_lo:[0,0,1] neg_hi:[0,0,1]
v_pk_fma_f32 v[30:31], v[30:31], v[172:173], v[172:173] op_sel:[0,0,1] op_sel_hi:[1,0,1] neg_lo:[0,0,1] neg_hi:[0,0,1]
v_pk_fma_f32 v[32:33], v[32:33], v[172:173], v[172:173] op_sel:[0,0,1] op_sel_hi:[1,0,1] neg_lo:[0,0,1] neg_hi:[0,0,1]
v_pk_fma_f32 v[34:35], v[34:35], v[172:173], v[172:173] op_sel:[0,0,1] op_sel_hi:[1,0,1] neg_lo:[0,0,1] neg_hi:[0,0,1]
v_pk_fma_f32 v[36:37], v[36:37], v[172:173], v[172:173] op_sel:[0,0,1] op_sel_hi:[1,0,1] neg_lo:[0,0,1] neg_hi:[0,0,1]
v_pk_fma_f32 v[38:39], v[38:39], v[172:173], v[172:173] op_sel:[0,0,1] op_sel_hi:[1,0,1] neg_lo:[0,0,1] neg_hi:[0,0,1]
v_pk_fma_f32 v[40:41], v[40:41], v[172:173], v[172:173] op_sel:[0,0,1] op_sel_hi:[1,0,1] neg_lo:[0,0,1] neg_hi:[0,0,1]
v_pk_fma_f32 v[42:43], v[42:43], v[172:173], v[172:173] op_sel:[0,0,1] op_sel_hi:[1,0,1] neg_lo:[0,0,1] neg_hi:[0,0,1]
v_pk_fma_f32 v[44:45], v[44:45], v[172:173], v[172:173] op_sel:[0,0,1] op_sel_hi:[1,0,1] neg_lo:[0,0,1] neg_hi:[0,0,1]
v_pk_fma_f32 v[46:47], v[46:47], v[172:173], v[172:173] op_sel:[0,0,1] op_sel_hi:[1,0,1] neg_lo:[0,0,1] neg_hi:[0,0,1]
v_cvt_pk_bf16_f32 v48, v0, v1
v_cvt_pk_bf16_f32 v49, v2, v3
v_cvt_pk_bf16_f32 v50, v4, v5
v_cvt_pk_bf16_f32 v51, v6, v7
v_cvt_pk_bf16_f32 v52, v8, v9
v_cvt_pk_bf16_f32 v53, v10, v11
v_cvt_pk_bf16_f32 v54, v12, v13
v_cvt_pk_bf16_f32 v55, v14, v15
v_cvt_pk_bf16_f32 v56, v16, v17
v_cvt_pk_bf16_f32 v57, v18, v19
v_cvt_pk_bf16_f32 v58, v20, v21
v_cvt_pk_bf16_f32 v59, v22, v23
v_cvt_pk_bf16_f32 v60, v24, v25
v_cvt_pk_bf16_f32 v61, v26, v27
v_cvt_pk_bf16_f32 v62, v28, v29
v_cvt_pk_bf16_f32 v63, v30, v31
v_cvt_pk_bf16_f32 v64, v32, v33
v_cvt_pk_bf16_f32 v65, v34, v35
v_cvt_pk_bf16_f32 v66, v36, v37
v_cvt_pk_bf16_f32 v67, v38, v39
v_cvt_pk_bf16_f32 v68, v40, v41
v_cvt_pk_bf16_f32 v69, v42, v43
v_cvt_pk_bf16_f32 v70, v44, v45
v_cvt_pk_bf16_f32 v71, v46, v47
s_nop 1
s_setpc_b64 s[78:79]
Lw1a:
ds_read_b64_tr_b16 v[148:149], v190
ds_read_b64_tr_b16 v[150:151], v190 offset:512
ds_read_b64_tr_b16 v[152:153], v190 offset:1024
ds_read_b64_tr_b16 v[154:155], v190 offset:1536
ds_read_b64_tr_b16 v[156:157], v190 offset:2048
ds_read_b64_tr_b16 v[158:159], v190 offset:2560
ds_read_b64_tr_b16 v[160:161], v190 offset:3072
ds_read_b64_tr_b16 v[162:163], v190 offset:3584
ds_read_b64_tr_b16 v[164:165], v190 offset:4096
ds_read_b64_tr_b16 v[166:167], v190 offset:4608
ds_read_b64_tr_b16 v[168:169], v190 offset:5120
ds_read_b64_tr_b16 v[170:171], v190 offset:5632
s_waitcnt lgkmcnt(10)
ds_write_b128 v191, v[148:151]
s_waitcnt lgkmcnt(9)
ds_write_b128 v191, v[152:155] offset:1024
s_waitcnt lgkmcnt(8)
ds_write_b128 v191, v[156:159] offset:2048
s_waitcnt lgkmcnt(7)
ds_write_b128 v191, v[160:163] offset:3072
s_waitcnt lgkmcnt(6)
ds_write_b128 v191, v[164:167] offset:4096
s_waitcnt lgkmcnt(5)
ds_write_b128 v191, v[168:171] offset:5120
s_waitcnt lgkmcnt(0)
s_setpc_b64 s[78:79]
Lw1i:
s_add_u32 m0, s77, 24576
s_add_u32 s43, s3, 256
buffer_load_dwordx4 v189, s[12:15], s43 offen lds
s_add_u32 m0, s77, 25600
s_add_u32 s43, s3, 24832
buffer_load_dwordx4 v189, s[12:15], s43 offen lds
s_add_u32 m0, s77, 26624
s_add_u32 s43, s3, 49408
buffer_load_dwordx4 v189, s[12:15], s43 offen lds
s_add_u32 m0, s77, 27648
s_add_u32 s43, s3, 12544
buffer_load_dwordx4 v189, s[12:15], s43 offen lds
s_add_u32 m0, s77, 28672
s_add_u32 s43, s3, 37120
buffer_load_dwordx4 v189, s[12:15], s43 offen lds
s_add_u32 m0, s77, 29696
s_add_u32 s43, s3, 61696
buffer_load_dwordx4 v189, s[12:15], s43 offen lds
s_add_u32 m0, s77, 49152
s_add_u32 s43, s3, 512
buffer_load_dwordx4 v189, s[12:15], s43 offen lds
s_add_u32 m0, s77, 50176
s_add_u32 s43, s3, 25088
buffer_load_dwordx4 v189, s[12:15], s43 offen lds
s_add_u32 m0, s77, 51200
s_add_u32 s43, s3, 49664
buffer_load_dwordx4 v189, s[12:15], s43 offen lds
s_add_u32 m0, s77, 52224
s_add_u32 s43, s3, 12800
buffer_load_dwordx4 v189, s[12:15], s43 offen lds
s_add_u32 m0, s77, 53248
s_add_u32 s43, s3, 37376
buffer_load_dwordx4 v189, s[12:15], s43 offen lds
s_add_u32 m0, s77, 54272
s_add_u32 s43, s3, 61952
buffer_load_dwordx4 v189, s[12:15], s43 offen lds
s_setpc_b64 s[78:79]
Lw1b:
ds_read_b64_tr_b16 v[72:73], v190 offset:24576
ds_read_b64_tr_b16 v[74:75], v190 offset:25088
ds_read_b64_tr_b16 v[76:77], v190 offset:25600
ds_read_b64_tr_b16 v[78:79], v190 offset:26112
ds_read_b64_tr_b16 v[80:81], v190 offset:26624
ds_read_b64_tr_b16 v[82:83], v190 offset:27136
ds_read_b64_tr_b16 v[84:85], v190 offset:27648
ds_read_b64_tr_b16 v[86:87], v190 offset:28160
ds_read_b64_tr_b16 v[88:89], v190 offset:28672
ds_read_b64_tr_b16 v[90:91], v190 offset:29184
ds_read_b64_tr_b16 v[92:93], v190 offset:29696
ds_read_b64_tr_b16 v[94:95], v190 offset:30208
s_waitcnt lgkmcnt(10)
ds_write_b128 v191, v[72:75] offset:24576
s_waitcnt lgkmcnt(9)
ds_write_b128 v191, v[76:79] offset:25600
s_waitcnt lgkmcnt(8)
ds_write_b128 v191, v[80:83] offset:26624
s_waitcnt lgkmcnt(7)
ds_write_b128 v191, v[84:87] offset:27648
s_waitcnt lgkmcnt(6)
ds_write_b128 v191, v[88:91] offset:28672
s_waitcnt lgkmcnt(5)
ds_write_b128 v191, v[92:95] offset:29696
s_waitcnt lgkmcnt(0)
s_setpc_b64 s[78:79]
Lw1c:
ds_read_b64_tr_b16 v[72:73], v190 offset:49152
ds_read_b64_tr_b16 v[74:75], v190 offset:49664
ds_read_b64_tr_b16 v[76:77], v190 offset:50176
ds_read_b64_tr_b16 v[78:79], v190 offset:50688
ds_read_b64_tr_b16 v[80:81], v190 offset:51200
ds_read_b64_tr_b16 v[82:83], v190 offset:51712
ds_read_b64_tr_b16 v[84:85], v190 offset:52224
ds_read_b64_tr_b16 v[86:87], v190 offset:52736
ds_read_b64_tr_b16 v[88:89], v190 offset:53248
ds_read_b64_tr_b16 v[90:91], v190 offset:53760
ds_read_b64_tr_b16 v[92:93], v190 offset:54272
ds_read_b64_tr_b16 v[94:95], v190 offset:54784
s_waitcnt lgkmcnt(10)
ds_write_b128 v191, v[72:75] offset:49152
s_waitcnt lgkmcnt(9)
ds_write_b128 v191, v[76:79] offset:50176
s_waitcnt lgkmcnt(8)
ds_write_b128 v191, v[80:83] offset:51200
s_waitcnt lgkmcnt(7)
ds_write_b128 v191, v[84:87] offset:52224
s_waitcnt lgkmcnt(6)
ds_write_b128 v191, v[88:91] offset:53248
s_waitcnt lgkmcnt(5)
ds_write_b128 v191, v[92:95] offset:54272
s_waitcnt lgkmcnt(0)
s_setpc_b64 s[78:79]
Lpre:
ds_read_b128 v[48:51], v245
ds_read_b128 v[52:55], v245 offset:384
ds_read_b128 v[56:59], v245 offset:768
ds_read_b128 v[60:63], v245 offset:1152
ds_read_b128 v[64:67], v245 offset:1536
ds_read_b128 v[68:71], v245 offset:1920
ds_read_b128 v[72:75], v245 offset:2304
ds_read_b128 v[76:79], v245 offset:2688
ds_read_b128 v[80:83], v245 offset:3072
ds_read_b128 v[84:87], v245 offset:3456
ds_read_b128 v[88:91], v245 offset:3840
ds_read_b128 v[92:95], v245 offset:4224
ds_read_b128 v[96:99], v245 offset:4608
ds_read_b128 v[100:103], v245 offset:4992
ds_read_b128 v[104:107], v245 offset:5376
ds_read_b128 v[108:111], v245 offset:5760
ds_read_b128 v[112:115], v245 offset:6144
ds_read_b128 v[116:119], v245 offset:6528
v_mov_b32 v0, 0
v_mov_b32 v1, 0
v_mov_b32 v2, 0
v_mov_b32 v3, 0
v_mov_b32 v4, 0
v_mov_b32 v5, 0
v_mov_b32 v6, 0
v_mov_b32 v7, 0
v_mov_b32 v8, 0
v_mov_b32 v9, 0
v_mov_b32 v10, 0
v_mov_b32 v11, 0
v_mov_b32 v12, 0
v_mov_b32 v13, 0
v_mov_b32 v14, 0
v_mov_b32 v15, 0
v_mov_b32 v16, 0
v_mov_b32 v17, 0
v_mov_b32 v18, 0
v_mov_b32 v19, 0
v_mov_b32 v20, 0
v_mov_b32 v21, 0
v_mov_b32 v22, 0
v_mov_b32 v23, 0
v_mov_b32 v24, 0
v_mov_b32 v25, 0
v_mov_b32 v26, 0
v_mov_b32 v27, 0
v_mov_b32 v28, 0
v_mov_b32 v29, 0
v_mov_b32 v30, 0
v_mov_b32 v31, 0
v_mov_b32 v32, 0
v_mov_b32 v33, 0
v_mov_b32 v34, 0
v_mov_b32 v35, 0
v_mov_b32 v36, 0
v_mov_b32 v37, 0
v_mov_b32 v38, 0
v_mov_b32 v39, 0
v_mov_b32 v40, 0
v_mov_b32 v41, 0
v_mov_b32 v42, 0
v_mov_b32 v43, 0
v_mov_b32 v44, 0
v_mov_b32 v45, 0
v_mov_b32 v46, 0
v_mov_b32 v47, 0
s_waitcnt lgkmcnt(0)
s_setpc_b64 s[78:79]
Lrb:
s_add_u32 m0, s67, 39936
s_add_u32 s45, s66, 491520
buffer_load_dwordx4 v240, s[4:7], s45 offen nt lds
s_add_u32 m0, s67, 46592
s_add_u32 s45, s66, 589824
buffer_load_dwordx4 v240, s[4:7], s45 offen nt lds
s_add_u32 m0, s67, 53248
s_add_u32 s45, s66, 688128
buffer_load_dwordx4 v240, s[4:7], s45 offen nt lds
s_add_u32 m0, s67, 59904
s_add_u32 s45, s66, 786432
buffer_load_dwordx4 v240, s[4:7], s45 offen nt lds
s_setpc_b64 s[78:79]
Lw1f:
s_add_u32 m0, s77, 0
s_add_u32 s43, s3, 0
buffer_load_dwordx4 v189, s[12:15], s43 offen lds
s_add_u32 m0, s77, 1024
s_add_u32 s43, s3, 24576
buffer_load_dwordx4 v189, s[12:15], s43 offen lds
s_add_u32 m0, s77, 2048
s_add_u32 s43, s3, 49152
buffer_load_dwordx4 v189, s[12:15], s43 offen lds
s_add_u32 m0, s77, 3072
s_add_u32 s43, s3, 12288
buffer_load_dwordx4 v189, s[12:15], s43 offen lds
s_add_u32 m0, s77, 4096
s_add_u32 s43, s3, 36864
buffer_load_dwordx4 v189, s[12:15], s43 offen lds
s_add_u32 m0, s77, 5120
s_add_u32 s43, s3, 61440
buffer_load_dwordx4 v189, s[12:15], s43 offen lds
s_setpc_b64 s[78:79]
Lgo:
v_mov_b32 v253, 16256
Lsw204w:
ds_read_b32 v247, v253 offset:20
s_waitcnt lgkmcnt(0)
v_readfirstlane_b32 s43, v247
s_cmp_eq_u32 s76, 0
s_cbranch_scc1 Lsw204x
s_sub_u32 s76, s76, 1
s_cmp_lt_u32 s43, 4
s_cbranch_scc0 Lsw204x
s_sleep 2
s_branch Lsw204w
Lsw204x:
s_cmp_lg_u32 s40, 7
s_cbranch_scc1 Lnopf
s_getpc_b64 s[74:75]
Lpc:
s_lshr_b32 s43, s2, 3
s_and_b32 s43, s43, 15
s_lshl_b32 s43, s43, 13
v_lshlrev_b32 v102, 7, v251
v_add_u32 v102, s43, v102
v_min_u32 v102, Lend-Lpc, v102
global_load_dword v255, v102, s[74:75]
Lnopf:
s_add_u32 s66, s66, 786432
ds_read_b128 v[224:227], v248 offset:16384
ds_read_b128 v[228:231], v248 offset:19456
ds_read_b128 v[232:235], v248 offset:17408
ds_read_b128 v[236:239], v248 offset:20480
ds_read_b128 v[216:219], v248 offset:18432
ds_read_b128 v[220:223], v248 offset:21504
s_setprio 2
s_waitcnt lgkmcnt(5)
v_mfma_f32_32x32x16_bf16 v[120:135], v[48:51], v[224:227], 0
s_waitcnt lgkmcnt(4)
ds_read_b128 v[224:227], v248 offset:22528
v_mfma_f32_32x32x16_bf16 v[120:135], v[52:55], v[228:231], v[120:135]
s_waitcnt lgkmcnt(4)
ds_read_b128 v[228:231], v248 offset:25600
v_mfma_f32_32x32x16_bf16 v[120:135], v[56:59], v[232:235], v[120:135]
s_waitcnt lgkmcnt(4)
ds_read_b128 v[232:235], v248 offset:23552
v_mfma_f32_32x32x16_bf16 v[120:135], v[60:63], v[236:239], v[120:135]
s_waitcnt lgkmcnt(4)
ds_read_b128 v[236:239], v248 offset:26624
v_mfma_f32_32x32x16_bf16 v[120:135], v[64:67], v[216:219], v[120:135]
s_waitcnt lgkmcnt(4)
ds_read_b128 v[216:219], v248 offset:24576
v_mfma_f32_32x32x16_bf16 v[120:135], v[68:71], v[220:223], v[120:135]
v_add_u32 v174, -36864, v242
v_subrev_u32 v175, 66560, v174
v_min_u32 v174, v174, v175
v_add_u32 v174, 90112, v174
v_sub_u32 v175, v174, v242
v_add_u32 v242, v175, v242
v_add_u32_e64 v243, v175, v243
v_add_u32 v244, v175, v244
s_nop 3
v_cvt_pkrtz_f16_f32 v137, v120, v121
v_cvt_pkrtz_f16_f32 v139, v122, v123
v_cvt_pkrtz_f16_f32 v141, v124, v125
v_cvt_pkrtz_f16_f32 v143, v126, v127
v_cvt_pkrtz_f16_f32 v177, v128, v129
v_cvt_pk_f16_f32 v155, v130, v131
v_cvt_pk_f16_f32 v152, v132, v133
v_cvt_pk_f16_f32 v149, v134, v135
s_waitcnt lgkmcnt(1)
ds_read_b128 v[220:223], v248 offset:27648
v_mfma_f32_32x32x16_bf16 v[120:135], v[48:51], v[224:227], 0
v_pk_fma_f16 v154, v155, v155, s48
v_and_b32 v137, s49, v137
v_pk_fma_f16 v151, v152, v152, s48
v_pk_fma_f16 v148, v149, v149, s48
v_bfe_u32 v136, v137, 2, 14
v_pk_mul_f16 v154, v155, v154
v_pk_mul_f16 v151, v152, v151
v_pk_mul_f16 v148, v149, v148
ds_read_b128 v[224:227], v248 offset:28672
ds_read_u16_d16 v136, v136
v_mfma_f32_32x32x16_bf16 v[120:135], v[52:55], v[228:231], v[120:135]
v_lshrrev_b32 v137, 18, v137
v_exp_f16 v153, v154
v_exp_f16 v150, v151
v_and_b32 v139, s49, v139
v_exp_f16_e64 v147, v148
v_bfe_u32 v138, v139, 2, 14
ds_read_b128 v[228:231], v248 offset:31744
ds_read_u16_d16_hi v137, v137
ds_read_u16_d16 v138, v138
v_mfma_f32_32x32x16_bf16 v[120:135], v[56:59], v[232:235], v[120:135]
v_exp_f16_sdwa v153, v154 dst_sel:WORD_1 dst_unused:UNUSED_PRESERVE src0_sel:WORD_1
v_lshrrev_b32_e64 v139, 18, v139
v_exp_f16_sdwa v150, v151 dst_sel:WORD_1 dst_unused:UNUSED_PRESERVE src0_sel:WORD_1
v_exp_f16_sdwa v147, v148 dst_sel:WORD_1 dst_unused:UNUSED_PRESERVE src0_sel:WORD_1
v_and_b32_e64 v141, s49, v141
ds_read_b128 v[232:235], v248 offset:29696
ds_read_u16_d16_hi v139, v139
v_mfma_f32_32x32x16_bf16 v[120:135], v[60:63], v[236:239], v[120:135]
v_pk_add_f16 v153, v153, 1.0 op_sel_hi:[1,0]
v_bfe_u32 v140, v141, 2, 14
v_pk_add_f16 v150, v150, 1.0 op_sel_hi:[1,0]
v_pk_add_f16 v147, v147, 1.0 op_sel_hi:[1,0]
v_rcp_f16 v154, v153
v_lshrrev_b32 v141, 18, v141
v_rcp_f16 v151, v150
s_waitcnt lgkmcnt(5)
ds_read_b128 v[236:239], v248 offset:32768
ds_read_u16_d16 v140, v140
ds_read_u16_d16_hi v141, v141
v_mfma_f32_32x32x16_bf16 v[120:135], v[64:67], v[216:219], v[120:135]
v_and_b32 v143, s49, v143
v_rcp_f16 v148, v147
v_bfe_u32 v142, v143, 2, 14
v_rcp_f16_sdwa v154, v153 dst_sel:WORD_1 dst_unused:UNUSED_PRESERVE src0_sel:WORD_1
v_rcp_f16_sdwa v151, v150 dst_sel:WORD_1 dst_unused:UNUSED_PRESERVE src0_sel:WORD_1
ds_read_b128 v[216:219], v248 offset:30720
ds_read_u16_d16 v142, v142
ds_read_b32 v247, v253 offset:16
v_mfma_f32_32x32x16_bf16 v[120:135], v[68:71], v[220:223], v[120:135]
v_lshrrev_b32_e64 v143, 18, v143
v_rcp_f16_sdwa v148, v147 dst_sel:WORD_1 dst_unused:UNUSED_PRESERVE src0_sel:WORD_1
v_and_b32_e64 v177, s49, v177
v_pk_mul_f16 v155, v155, v154
v_pk_mul_f16 v152, v152, v151
v_bfe_u32 v176, v177, 2, 14
v_pk_mul_f16 v149, v149, v148
v_fma_mix_f32 v156, v155, v155, 0 op_sel:[0,0,0] op_sel_hi:[1,1,0]
v_fma_mix_f32 v156, v155, v155, v156 op_sel:[1,1,0] op_sel_hi:[1,1,0]
v_lshrrev_b32_e64 v177, 18, v177
v_fma_mix_f32 v156, v152, v152, v156 op_sel:[0,0,0] op_sel_hi:[1,1,0]
v_fma_mix_f32 v156, v152, v152, v156 op_sel:[1,1,0] op_sel_hi:[1,1,0]
v_fma_mix_f32 v156, v149, v149, v156 op_sel:[0,0,0] op_sel_hi:[1,1,0]
v_fma_mix_f32 v156, v149, v149, v156 op_sel:[1,1,0] op_sel_hi:[1,1,0]
ds_read_u16_d16_hi v143, v143
ds_read_u16_d16 v176, v176
ds_read_u16_d16_hi v177, v177
s_waitcnt lgkmcnt(3)
v_readfirstlane_b32 s43, v247
s_nop 1
s_cmp_ge_u32 s43, 8
s_cbranch_scc1 Lev1
Lev1w:
s_sleep 1
ds_read_b32 v247, v253 offset:16
s_waitcnt lgkmcnt(0)
v_readfirstlane_b32 s43, v247
s_cmp_eq_u32 s76, 0
s_cbranch_scc1 Lev1
s_sub_u32 s76, s76, 1
s_cmp_lt_u32 s43, 8
s_cbranch_scc1 Lev1w
Lev1:
v_cvt_pkrtz_f16_f32 v179, v120, v121
v_cvt_pkrtz_f16_f32 v181, v122, v123
v_cvt_pkrtz_f16_f32 v183, v124, v125
v_cvt_pkrtz_f16_f32 v185, v126, v127
v_cvt_pkrtz_f16_f32 v187, v128, v129
v_cvt_pk_f16_f32 v155, v130, v131
v_cvt_pk_f16_f32 v152, v132, v133
v_cvt_pk_f16_f32 v149, v134, v135
s_add_u32 m0, s67, 0
s_add_u32 s66, s66, 98304
buffer_load_dwordx4 v240, s[4:7], s66 offen lds
ds_read_b128 v[220:223], v248 offset:33792
v_mfma_f32_32x32x16_bf16 v[120:135], v[48:51], v[224:227], 0
v_pk_fma_f16 v154, v155, v155, s48
v_and_b32_e64 v179, s49, v179
v_fma_mix_f32 v156, v136, v136, v156 op_sel:[0,0,0] op_sel_hi:[1,1,0]
v_pk_fma_f16 v151, v152, v152, s48
v_pk_fma_f16 v148, v149, v149, s48
v_bfe_u32 v178, v179, 2, 14
v_pk_mul_f16 v154, v155, v154
v_pk_mul_f16 v151, v152, v151
v_fma_mix_f32 v156, v137, v137, v156 op_sel:[1,1,0] op_sel_hi:[1,1,0]
v_lshrrev_b32_e64 v179, 18, v179
s_add_u32 m0, s67, 6656
s_add_u32 s66, s66, 98304
buffer_load_dwordx4 v240, s[4:7], s66 offen lds
ds_read_b128 v[224:227], v248 offset:34816
ds_read_u16_d16 v178, v178
ds_read_u16_d16_hi v179, v179
v_mfma_f32_32x32x16_bf16 v[120:135], v[52:55], v[228:231], v[120:135]
v_pk_mul_f16 v148, v149, v148
v_exp_f16 v153, v154
v_exp_f16 v150, v151
v_and_b32_e64 v181, s49, v181
v_fma_mix_f32 v156, v138, v138, v156 op_sel:[0,0,0] op_sel_hi:[1,1,0]
v_exp_f16_e64 v147, v148
v_bfe_u32 v180, v181, 2, 14
s_add_u32 m0, s67, 13312
s_add_u32 s66, s66, 98304
buffer_load_dwordx4 v240, s[4:7], s66 offen lds
ds_read_b128 v[228:231], v248 offset:37888
ds_read_u16_d16 v180, v180
v_mfma_f32_32x32x16_bf16 v[120:135], v[56:59], v[232:235], v[120:135]
v_exp_f16_sdwa v153, v154 dst_sel:WORD_1 dst_unused:UNUSED_PRESERVE src0_sel:WORD_1
v_lshrrev_b32_e64 v181, 18, v181
v_fma_mix_f32 v156, v139, v139, v156 op_sel:[1,1,0] op_sel_hi:[1,1,0]
v_exp_f16_sdwa v150, v151 dst_sel:WORD_1 dst_unused:UNUSED_PRESERVE src0_sel:WORD_1
v_exp_f16_sdwa v147, v148 dst_sel:WORD_1 dst_unused:UNUSED_PRESERVE src0_sel:WORD_1
v_and_b32_e64 v183, s49, v183
v_fma_mix_f32 v156, v140, v140, v156 op_sel:[0,0,0] op_sel_hi:[1,1,0]
s_add_u32 m0, s67, 19968
s_add_u32 s66, s66, 98304
buffer_load_dwordx4 v240, s[4:7], s66 offen lds
s_add_u32 m0, s67, 26624
s_add_u32 s66, s66, 98304
buffer_load_dwordx4 v240, s[4:7], s66 offen lds
ds_read_b128 v[232:235], v248 offset:35840
ds_read_u16_d16_hi v181, v181
v_mfma_f32_32x32x16_bf16 v[120:135], v[60:63], v[236:239], v[120:135]
v_pk_add_f16 v153, v153, 1.0 op_sel_hi:[1,0]
v_bfe_u32 v182, v183, 2, 14
v_pk_add_f16 v150, v150, 1.0 op_sel_hi:[1,0]
v_pk_add_f16 v147, v147, 1.0 op_sel_hi:[1,0]
v_rcp_f16 v154, v153
v_lshrrev_b32 v183, 18, v183
v_fma_mix_f32 v156, v141, v141, v156 op_sel:[1,1,0] op_sel_hi:[1,1,0]
v_rcp_f16_e64 v151, v150
s_add_u32 m0, s67, 33280
s_add_u32 s66, s66, 98304
buffer_load_dwordx4 v240, s[4:7], s66 offen lds
ds_read_b128 v[236:239], v248 offset:38912
ds_read_u16_d16 v182, v182
ds_read_u16_d16_hi v183, v183
v_mfma_f32_32x32x16_bf16 v[120:135], v[64:67], v[216:219], v[120:135]
v_and_b32 v185, s49, v185
v_rcp_f16 v148, v147
v_fma_mix_f32 v156, v142, v142, v156 op_sel:[0,0,0] op_sel_hi:[1,1,0]
v_bfe_u32 v184, v185, 2, 14
v_rcp_f16_sdwa v154, v153 dst_sel:WORD_1 dst_unused:UNUSED_PRESERVE src0_sel:WORD_1
v_rcp_f16_sdwa v151, v150 dst_sel:WORD_1 dst_unused:UNUSED_PRESERVE src0_sel:WORD_1
v_lshrrev_b32 v185, 18, v185
s_waitcnt lgkmcnt(4)
s_add_u32 m0, s67, 39936
s_add_u32 s66, s66, 98304
buffer_load_dwordx4 v240, s[4:7], s66 offen lds
ds_read_b128 v[216:219], v248 offset:36864
ds_read_u16_d16 v184, v184
ds_read_u16_d16_hi v185, v185
v_mfma_f32_32x32x16_bf16 v[120:135], v[68:71], v[220:223], v[120:135]
v_fma_mix_f32 v156, v143, v143, v156 op_sel:[1,1,0] op_sel_hi:[1,1,0]
v_rcp_f16_sdwa v148, v147 dst_sel:WORD_1 dst_unused:UNUSED_PRESERVE src0_sel:WORD_1
v_and_b32_e64 v187, s49, v187
v_pk_mul_f16 v155, v155, v154
v_fma_mix_f32 v156, v176, v176, v156 op_sel:[0,0,0] op_sel_hi:[1,1,0]
v_pk_mul_f16 v152, v152, v151
v_bfe_u32 v186, v187, 2, 14
v_pk_mul_f16 v149, v149, v148
v_fma_mix_f32 v157, v155, v155, 0 op_sel:[0,0,0] op_sel_hi:[1,1,0]
s_add_u32 m0, s67, 46592
s_add_u32 s66, s66, 98304
buffer_load_dwordx4 v240, s[4:7], s66 offen lds
v_fma_mix_f32 v157, v155, v155, v157 op_sel:[1,1,0] op_sel_hi:[1,1,0]
v_lshrrev_b32 v187, 18, v187
v_fma_mix_f32 v156, v177, v177, v156 op_sel:[1,1,0] op_sel_hi:[1,1,0]
v_fma_mix_f32 v157, v152, v152, v157 op_sel:[0,0,0] op_sel_hi:[1,1,0]
v_fma_mix_f32 v157, v152, v152, v157 op_sel:[1,1,0] op_sel_hi:[1,1,0]
v_fma_mix_f32 v157, v149, v149, v157 op_sel:[0,0,0] op_sel_hi:[1,1,0]
v_fma_mix_f32 v157, v149, v149, v157 op_sel:[1,1,0] op_sel_hi:[1,1,0]
s_cmp_lt_u32 s40, 4
s_cbranch_scc0 Lsu5
s_waitcnt vmcnt(14)
s_call_b64 s[78:79], Lw1b
s_mov_b64 exec, 1
ds_add_u32 v253, v254 offset:24
s_mov_b64 exec, -1
Lsu5:
s_setprio 1
v_cvt_pkrtz_f16_f32 v137, v120, v121
v_cvt_pkrtz_f16_f32 v139, v122, v123
v_cvt_pkrtz_f16_f32 v141, v124, v125
v_cvt_pkrtz_f16_f32 v143, v126, v127
v_cvt_pkrtz_f16_f32 v177, v128, v129
v_cvt_pk_f16_f32 v155, v130, v131
v_cvt_pk_f16_f32 v152, v132, v133
v_cvt_pk_f16_f32 v149, v134, v135
ds_read_b128 v[220:223], v248 offset:39936
ds_read_u16_d16 v186, v186
ds_read_u16_d16_hi v187, v187
v_mfma_f32_32x32x16_bf16 v[120:135], v[48:51], v[224:227], 0
v_pk_fma_f16 v154, v155, v155, s48
v_and_b32_e64 v137, s49, v137
v_fma_mix_f32 v157, v178, v178, v157 op_sel:[0,0,0] op_sel_hi:[1,1,0]
v_pk_fma_f16 v151, v152, v152, s48
v_pk_fma_f16 v148, v149, v149, s48
v_bfe_u32 v136, v137, 2, 14
v_pk_mul_f16 v154, v155, v154
v_pk_mul_f16 v151, v152, v151
v_fma_mix_f32 v157, v179, v179, v157 op_sel:[1,1,0] op_sel_hi:[1,1,0]
v_lshrrev_b32_e64 v137, 18, v137
ds_read_u16_d16 v136, v136
ds_read_b32 v247, v253 offset:24
ds_read_u16_d16_hi v137, v137
v_mfma_f32_32x32x16_bf16 v[120:135], v[52:55], v[228:231], v[120:135]
v_pk_mul_f16 v148, v149, v148
v_exp_f16 v153, v154
v_exp_f16 v150, v151
v_and_b32_e64 v139, s49, v139
v_fma_mix_f32 v157, v180, v180, v157 op_sel:[0,0,0] op_sel_hi:[1,1,0]
v_exp_f16_e64 v147, v148
v_bfe_u32 v138, v139, 2, 14
ds_read_u16_d16 v138, v138
v_mfma_f32_32x32x16_bf16 v[120:135], v[56:59], v[232:235], v[120:135]
v_exp_f16_sdwa v153, v154 dst_sel:WORD_1 dst_unused:UNUSED_PRESERVE src0_sel:WORD_1
v_lshrrev_b32 v139, 18, v139
s_waitcnt lgkmcnt(4)
v_fma_mix_f32 v157, v181, v181, v157 op_sel:[1,1,0] op_sel_hi:[1,1,0]
v_exp_f16_sdwa v150, v151 dst_sel:WORD_1 dst_unused:UNUSED_PRESERVE src0_sel:WORD_1
v_exp_f16_sdwa v147, v148 dst_sel:WORD_1 dst_unused:UNUSED_PRESERVE src0_sel:WORD_1
v_and_b32 v141, s49, v141
v_fma_mix_f32 v157, v182, v182, v157 op_sel:[0,0,0] op_sel_hi:[1,1,0]
ds_read_u16_d16_hi v139, v139
s_waitcnt lgkmcnt(3)
v_readfirstlane_b32 s43, v247
s_nop 1
s_cmp_ge_u32 s43, 4
s_cbranch_scc1 Lev2
Lev2w:
s_sleep 1
ds_read_b32 v247, v253 offset:24
s_waitcnt lgkmcnt(0)
v_readfirstlane_b32 s43, v247
s_cmp_eq_u32 s76, 0
s_cbranch_scc1 Lev2
s_sub_u32 s76, s76, 1
s_cmp_lt_u32 s43, 4
s_cbranch_scc1 Lev2w
Lev2:
ds_read_b128 v[224:227], v248 offset:40960
ds_read_b128 v[228:231], v248 offset:44032
ds_read_b128 v[232:235], v248 offset:41984
v_mfma_f32_32x32x16_bf16 v[120:135], v[60:63], v[236:239], v[120:135]
v_pk_add_f16 v153, v153, 1.0 op_sel_hi:[1,0]
v_bfe_u32 v140, v141, 2, 14
v_pk_add_f16 v150, v150, 1.0 op_sel_hi:[1,0]
v_pk_add_f16 v147, v147, 1.0 op_sel_hi:[1,0]
v_rcp_f16 v154, v153
v_lshrrev_b32 v141, 18, v141
v_fma_mix_f32 v157, v183, v183, v157 op_sel:[1,1,0] op_sel_hi:[1,1,0]
v_rcp_f16_e64 v151, v150
ds_read_b128 v[236:239], v248 offset:45056
ds_read_u16_d16 v140, v140
ds_read_u16_d16_hi v141, v141
v_mfma_f32_32x32x16_bf16 v[120:135], v[64:67], v[216:219], v[120:135]
v_and_b32 v143, s49, v143
v_rcp_f16 v148, v147
v_fma_mix_f32 v157, v184, v184, v157 op_sel:[0,0,0] op_sel_hi:[1,1,0]
v_bfe_u32 v142, v143, 2, 14
v_rcp_f16_sdwa v154, v153 dst_sel:WORD_1 dst_unused:UNUSED_PRESERVE src0_sel:WORD_1
v_rcp_f16_sdwa v151, v150 dst_sel:WORD_1 dst_unused:UNUSED_PRESERVE src0_sel:WORD_1
v_lshrrev_b32_e64 v143, 18, v143
ds_read_b128 v[216:219], v248 offset:43008
ds_read_u16_d16 v142, v142
ds_read_u16_d16_hi v143, v143
v_mfma_f32_32x32x16_bf16 v[120:135], v[68:71], v[220:223], v[120:135]
v_fma_mix_f32 v157, v185, v185, v157 op_sel:[1,1,0] op_sel_hi:[1,1,0]
v_rcp_f16_sdwa v148, v147 dst_sel:WORD_1 dst_unused:UNUSED_PRESERVE src0_sel:WORD_1
v_and_b32_e64 v177, s49, v177
v_pk_mul_f16 v155, v155, v154
v_fma_mix_f32 v157, v186, v186, v157 op_sel:[0,0,0] op_sel_hi:[1,1,0]
v_pk_mul_f16 v152, v152, v151
v_bfe_u32 v176, v177, 2, 14
v_pk_mul_f16 v149, v149, v148
v_fma_mix_f32 v158, v155, v155, 0 op_sel:[0,0,0] op_sel_hi:[1,1,0]
v_fma_mix_f32 v158, v155, v155, v158 op_sel:[1,1,0] op_sel_hi:[1,1,0]
v_lshrrev_b32_e64 v177, 18, v177
v_fma_mix_f32 v157, v187, v187, v157 op_sel:[1,1,0] op_sel_hi:[1,1,0]
v_fma_mix_f32 v158, v152, v152, v158 op_sel:[0,0,0] op_sel_hi:[1,1,0]
v_fma_mix_f32 v158, v152, v152, v158 op_sel:[1,1,0] op_sel_hi:[1,1,0]
v_fma_mix_f32 v158, v149, v149, v158 op_sel:[0,0,0] op_sel_hi:[1,1,0]
v_fma_mix_f32 v158, v149, v149, v158 op_sel:[1,1,0] op_sel_hi:[1,1,0]
v_cvt_pkrtz_f16_f32 v179, v120, v121
v_cvt_pkrtz_f16_f32 v181, v122, v123
v_cvt_pkrtz_f16_f32 v183, v124, v125
v_cvt_pkrtz_f16_f32 v185, v126, v127
v_cvt_pkrtz_f16_f32 v187, v128, v129
v_cvt_pk_f16_f32 v155, v130, v131
v_cvt_pk_f16_f32 v152, v132, v133
v_cvt_pk_f16_f32 v149, v134, v135
s_waitcnt lgkmcnt(0)
ds_read_b128 v[220:223], v248 offset:46080
ds_read_u16_d16 v176, v176
ds_read_u16_d16_hi v177, v177
v_mfma_f32_32x32x16_bf16 v[120:135], v[48:51], v[224:227], 0
v_pk_fma_f16 v154, v155, v155, s48
v_and_b32 v179, s49, v179
v_fma_mix_f32 v158, v136, v136, v158 op_sel:[0,0,0] op_sel_hi:[1,1,0]
v_pk_fma_f16 v151, v152, v152, s48
v_pk_fma_f16 v148, v149, v149, s48
v_bfe_u32 v178, v179, 2, 14
v_pk_mul_f16 v154, v155, v154
v_pk_mul_f16 v151, v152, v151
v_fma_mix_f32 v158, v137, v137, v158 op_sel:[1,1,0] op_sel_hi:[1,1,0]
v_lshrrev_b32_e64 v179, 18, v179
ds_read_b128 v[224:227], v248 offset:47104
ds_read_u16_d16 v178, v178
ds_read_u16_d16_hi v179, v179
v_mfma_f32_32x32x16_bf16 v[120:135], v[52:55], v[228:231], v[120:135]
v_pk_mul_f16 v148, v149, v148
v_exp_f16 v153, v154
v_exp_f16 v150, v151
v_and_b32_e64 v181, s49, v181
v_fma_mix_f32 v158, v138, v138, v158 op_sel:[0,0,0] op_sel_hi:[1,1,0]
v_exp_f16_e64 v147, v148
v_bfe_u32 v180, v181, 2, 14
ds_read_b128 v[228:231], v248 offset:50176
ds_read_u16_d16 v180, v180
v_mfma_f32_32x32x16_bf16 v[120:135], v[56:59], v[232:235], v[120:135]
v_exp_f16_sdwa v153, v154 dst_sel:WORD_1 dst_unused:UNUSED_PRESERVE src0_sel:WORD_1
v_lshrrev_b32_e64 v181, 18, v181
v_fma_mix_f32 v158, v139, v139, v158 op_sel:[1,1,0] op_sel_hi:[1,1,0]
v_exp_f16_sdwa v150, v151 dst_sel:WORD_1 dst_unused:UNUSED_PRESERVE src0_sel:WORD_1
v_exp_f16_sdwa v147, v148 dst_sel:WORD_1 dst_unused:UNUSED_PRESERVE src0_sel:WORD_1
v_and_b32_e64 v183, s49, v183
v_fma_mix_f32 v158, v140, v140, v158 op_sel:[0,0,0] op_sel_hi:[1,1,0]
ds_read_b128 v[232:235], v248 offset:48128
ds_read_u16_d16_hi v181, v181
v_mfma_f32_32x32x16_bf16 v[120:135], v[60:63], v[236:239], v[120:135]
v_pk_add_f16 v153, v153, 1.0 op_sel_hi:[1,0]
v_bfe_u32 v182, v183, 2, 14
v_pk_add_f16 v150, v150, 1.0 op_sel_hi:[1,0]
v_pk_add_f16 v147, v147, 1.0 op_sel_hi:[1,0]
v_rcp_f16 v154, v153
v_lshrrev_b32 v183, 18, v183
v_fma_mix_f32 v158, v141, v141, v158 op_sel:[1,1,0] op_sel_hi:[1,1,0]
v_rcp_f16_e64 v151, v150
ds_read_b128 v[236:239], v248 offset:51200
ds_read_u16_d16 v182, v182
ds_read_u16_d16_hi v183, v183
v_mfma_f32_32x32x16_bf16 v[120:135], v[64:67], v[216:219], v[120:135]
v_and_b32 v185, s49, v185
v_rcp_f16 v148, v147
v_fma_mix_f32 v158, v142, v142, v158 op_sel:[0,0,0] op_sel_hi:[1,1,0]
v_bfe_u32 v184, v185, 2, 14
v_rcp_f16_sdwa v154, v153 dst_sel:WORD_1 dst_unused:UNUSED_PRESERVE src0_sel:WORD_1
v_rcp_f16_sdwa v151, v150 dst_sel:WORD_1 dst_unused:UNUSED_PRESERVE src0_sel:WORD_1
v_lshrrev_b32 v185, 18, v185
s_waitcnt lgkmcnt(5)
ds_read_b128 v[216:219], v248 offset:49152
ds_read_u16_d16 v184, v184
ds_read_u16_d16_hi v185, v185
v_mfma_f32_32x32x16_bf16 v[120:135], v[68:71], v[220:223], v[120:135]
v_fma_mix_f32 v158, v143, v143, v158 op_sel:[1,1,0] op_sel_hi:[1,1,0]
v_rcp_f16_sdwa v148, v147 dst_sel:WORD_1 dst_unused:UNUSED_PRESERVE src0_sel:WORD_1
s_cmp_eq_u32 s40, 7
s_cbranch_scc1 Lrdy8
s_waitcnt vmcnt(0)
Lrdy8:
s_mov_b64 exec, 1
ds_add_u32 v253, v254 offset:12
s_mov_b64 exec, -1
v_and_b32 v187, s49, v187
v_pk_mul_f16 v155, v155, v154
v_fma_mix_f32 v158, v176, v176, v158 op_sel:[0,0,0] op_sel_hi:[1,1,0]
v_pk_mul_f16 v152, v152, v151
v_bfe_u32 v186, v187, 2, 14
v_pk_mul_f16 v149, v149, v148
v_fma_mix_f32 v159, v155, v155, 0 op_sel:[0,0,0] op_sel_hi:[1,1,0]
v_fma_mix_f32 v159, v155, v155, v159 op_sel:[1,1,0] op_sel_hi:[1,1,0]
v_lshrrev_b32_e64 v187, 18, v187
v_fma_mix_f32 v158, v177, v177, v158 op_sel:[1,1,0] op_sel_hi:[1,1,0]
v_fma_mix_f32 v159, v152, v152, v159 op_sel:[0,0,0] op_sel_hi:[1,1,0]
v_fma_mix_f32 v159, v152, v152, v159 op_sel:[1,1,0] op_sel_hi:[1,1,0]
v_fma_mix_f32 v159, v149, v149, v159 op_sel:[0,0,0] op_sel_hi:[1,1,0]
v_fma_mix_f32 v159, v149, v149, v159 op_sel:[1,1,0] op_sel_hi:[1,1,0]
s_cmp_lt_u32 s40, 4
s_cbranch_scc0 Lsu6
s_waitcnt vmcnt(8)
s_call_b64 s[78:79], Lw1c
s_mov_b64 exec, 1
ds_add_u32 v253, v254 offset:28
s_mov_b64 exec, -1
Lsu6:
v_cvt_pkrtz_f16_f32 v137, v120, v121
v_cvt_pkrtz_f16_f32 v139, v122, v123
v_cvt_pkrtz_f16_f32 v141, v124, v125
v_cvt_pkrtz_f16_f32 v143, v126, v127
v_cvt_pkrtz_f16_f32 v177, v128, v129
v_cvt_pk_f16_f32 v155, v130, v131
v_cvt_pk_f16_f32 v152, v132, v133
v_cvt_pk_f16_f32 v149, v134, v135
s_setprio 0
ds_read_b128 v[220:223], v248 offset:52224
ds_read_u16_d16 v186, v186
ds_read_u16_d16_hi v187, v187
v_mfma_f32_32x32x16_bf16 v[120:135], v[48:51], v[224:227], 0
v_pk_fma_f16 v154, v155, v155, s48
v_and_b32 v137, s49, v137
v_fma_mix_f32 v159, v178, v178, v159 op_sel:[0,0,0] op_sel_hi:[1,1,0]
v_pk_fma_f16 v151, v152, v152, s48
v_pk_fma_f16 v148, v149, v149, s48
v_bfe_u32 v136, v137, 2, 14
v_pk_mul_f16 v154, v155, v154
v_pk_mul_f16 v151, v152, v151
v_fma_mix_f32 v159, v179, v179, v159 op_sel:[1,1,0] op_sel_hi:[1,1,0]
v_lshrrev_b32_e64 v137, 18, v137
ds_read_b128 v[224:227], v250 offset:65520
ds_read_u16_d16 v136, v136
ds_read_u16_d16_hi v137, v137
v_mfma_f32_32x32x16_bf16 v[120:135], v[52:55], v[228:231], v[120:135]
v_pk_mul_f16 v148, v149, v148
v_exp_f16 v153, v154
v_exp_f16 v150, v151
v_and_b32_e64 v139, s49, v139
v_fma_mix_f32 v159, v180, v180, v159 op_sel:[0,0,0] op_sel_hi:[1,1,0]
v_exp_f16 v147, v148
v_bfe_u32 v138, v139, 2, 14
s_waitcnt lgkmcnt(7)
ds_read_b128 v[228:231], v248 offset:53248
ds_read_b32 v247, v253 offset:12
ds_read_u16_d16 v138, v138
v_mfma_f32_32x32x16_bf16 v[120:135], v[56:59], v[232:235], v[120:135]
v_exp_f16_sdwa v153, v154 dst_sel:WORD_1 dst_unused:UNUSED_PRESERVE src0_sel:WORD_1
v_lshrrev_b32_e64 v139, 18, v139
v_fma_mix_f32 v159, v181, v181, v159 op_sel:[1,1,0] op_sel_hi:[1,1,0]
v_exp_f16_sdwa v150, v151 dst_sel:WORD_1 dst_unused:UNUSED_PRESERVE src0_sel:WORD_1
v_exp_f16_sdwa v147, v148 dst_sel:WORD_1 dst_unused:UNUSED_PRESERVE src0_sel:WORD_1
v_and_b32_e64 v141, s49, v141
v_fma_mix_f32 v159, v182, v182, v159 op_sel:[0,0,0] op_sel_hi:[1,1,0]
ds_read_b128 v[232:235], v248 offset:56320
ds_read_u16_d16_hi v139, v139
v_mfma_f32_32x32x16_bf16 v[120:135], v[60:63], v[236:239], v[120:135]
v_pk_add_f16 v153, v153, 1.0 op_sel_hi:[1,0]
v_bfe_u32 v140, v141, 2, 14
v_pk_add_f16 v150, v150, 1.0 op_sel_hi:[1,0]
v_pk_add_f16 v147, v147, 1.0 op_sel_hi:[1,0]
v_rcp_f16 v154, v153
v_lshrrev_b32 v141, 18, v141
ds_read_u16_d16 v140, v140
ds_read_u16_d16_hi v141, v141
s_waitcnt lgkmcnt(5)
v_readfirstlane_b32 s43, v247
s_nop 1
s_cmp_ge_u32 s43, 16
s_cbranch_scc1 Lev3
Lev3w:
s_sleep 1
ds_read_b32 v247, v253 offset:12
s_waitcnt lgkmcnt(0)
v_readfirstlane_b32 s43, v247
s_cmp_eq_u32 s76, 0
s_cbranch_scc1 Lev3
s_sub_u32 s76, s76, 1
s_cmp_lt_u32 s43, 16
s_cbranch_scc1 Lev3w
Lev3:
v_fma_mix_f32 v159, v183, v183, v159 op_sel:[1,1,0] op_sel_hi:[1,1,0]
v_rcp_f16 v151, v150
ds_read_b128 v[236:239], v245 offset:6528
ds_read_b128 v[192:195], v244 offset:128
ds_read_b128 v[196:199], v244 offset:64
v_mfma_f32_32x32x16_bf16 v[120:135], v[64:67], v[216:219], v[120:135]
v_and_b32 v143, s49, v143
v_rcp_f16 v148, v147
v_fma_mix_f32 v159, v184, v184, v159 op_sel:[0,0,0] op_sel_hi:[1,1,0]
v_bfe_u32 v142, v143, 2, 14
v_rcp_f16_sdwa v154, v153 dst_sel:WORD_1 dst_unused:UNUSED_PRESERVE src0_sel:WORD_1
v_rcp_f16_sdwa v151, v150 dst_sel:WORD_1 dst_unused:UNUSED_PRESERVE src0_sel:WORD_1
v_lshrrev_b32_e64 v143, 18, v143
ds_read_b128 v[216:219], v248 offset:54272
ds_read_u16_d16 v142, v142
ds_read_u16_d16_hi v143, v143
v_mfma_f32_32x32x16_bf16 v[120:135], v[68:71], v[220:223], v[120:135]
v_fma_mix_f32 v159, v185, v185, v159 op_sel:[1,1,0] op_sel_hi:[1,1,0]
v_rcp_f16_sdwa v148, v147 dst_sel:WORD_1 dst_unused:UNUSED_PRESERVE src0_sel:WORD_1
v_and_b32_e64 v177, s49, v177
v_pk_mul_f16 v155, v155, v154
v_fma_mix_f32 v159, v186, v186, v159 op_sel:[0,0,0] op_sel_hi:[1,1,0]
v_pk_mul_f16 v152, v152, v151
v_bfe_u32 v176, v177, 2, 14
v_pk_mul_f16 v149, v149, v148
v_fma_mix_f32 v160, v155, v155, 0 op_sel:[0,0,0] op_sel_hi:[1,1,0]
v_fma_mix_f32 v160, v155, v155, v160 op_sel:[1,1,0] op_sel_hi:[1,1,0]
v_lshrrev_b32 v177, 18, v177
v_fma_mix_f32 v159, v187, v187, v159 op_sel:[1,1,0] op_sel_hi:[1,1,0]
v_fma_mix_f32 v160, v152, v152, v160 op_sel:[0,0,0] op_sel_hi:[1,1,0]
v_fma_mix_f32 v160, v152, v152, v160 op_sel:[1,1,0] op_sel_hi:[1,1,0]
v_fma_mix_f32 v160, v149, v149, v160 op_sel:[0,0,0] op_sel_hi:[1,1,0]
v_fma_mix_f32 v160, v149, v149, v160 op_sel:[1,1,0] op_sel_hi:[1,1,0]
s_setprio 2
v_mfma_f32_32x32x16_bf16 v[0:15], v[224:227], v[224:227], 0
ds_read_b128 v[220:223], v245 offset:6144
ds_read_b128 v[200:203], v244
ds_read_b128 v[204:207], v243 offset:128
ds_read_u16_d16 v176, v176
ds_read_u16_d16_hi v177, v177
v_cvt_pkrtz_f16_f32 v179, v120, v121
v_cvt_pkrtz_f16_f32 v181, v122, v123
v_cvt_pkrtz_f16_f32 v183, v124, v125
v_mfma_f32_32x32x16_bf16 v[16:31], v[224:227], v[224:227], 0
v_cvt_pkrtz_f16_f32 v185, v126, v127
v_cvt_pkrtz_f16_f32 v187, v128, v129
v_cvt_pk_f16_f32 v155, v130, v131
v_mfma_f32_32x32x16_bf16 v[32:47], v[224:227], v[224:227], 0
v_cvt_pk_f16_f32 v152, v132, v133
v_cvt_pk_f16_f32 v149, v134, v135
v_pk_fma_f16 v154, v155, v155, s48
v_mfma_f32_32x32x16_bf16 v[120:135], v[48:51], v[228:231], 0
ds_read_b128 v[224:227], v248 offset:57344
v_and_b32 v179, s49, v179
v_fma_mix_f32 v160, v136, v136, v160 op_sel:[0,0,0] op_sel_hi:[1,1,0]
v_pk_fma_f16 v151, v152, v152, s48
v_pk_fma_f16 v148, v149, v149, s48
v_bfe_u32 v178, v179, 2, 14
v_pk_mul_f16 v154, v155, v154
s_waitcnt lgkmcnt(6)
v_mfma_f32_32x32x16_bf16 v[120:135], v[52:55], v[232:235], v[120:135]
ds_read_b128 v[228:231], v245 offset:5760
ds_read_b128 v[208:211], v243 offset:64
ds_read_b128 v[212:215], v243
ds_read_u16_d16 v178, v178
v_pk_mul_f16 v151, v152, v151
v_fma_mix_f32 v160, v137, v137, v160 op_sel:[1,1,0] op_sel_hi:[1,1,0]
v_lshrrev_b32_e64 v179, 18, v179
v_pk_mul_f16 v148, v149, v148
v_exp_f16_e64 v153, v154
v_smfmac_f32_16x16x32_bf16 v[40:43], v[238:239], v[192:195], v246
ds_read_b128 v[232:235], v248 offset:55296
ds_read_u16_d16_hi v179, v179
v_exp_f16 v150, v151
v_and_b32 v181, s49, v181
v_smfmac_f32_16x16x32_bf16 v[24:27], v[236:237], v[196:199], v246
v_fma_mix_f32 v160, v138, v138, v160 op_sel:[0,0,0] op_sel_hi:[1,1,0]
v_exp_f16_e64 v147, v148
v_mfma_f32_32x32x16_bf16 v[120:135], v[56:59], v[216:219], v[120:135]
ds_read_b128 v[236:239], v245 offset:5376
ds_read_b128 v[192:195], v242 offset:128
ds_read_b128 v[196:199], v242 offset:64
v_bfe_u32 v180, v181, 2, 14
v_exp_f16_sdwa v153, v154 dst_sel:WORD_1 dst_unused:UNUSED_PRESERVE src0_sel:WORD_1
v_lshrrev_b32 v181, 18, v181
v_fma_mix_f32 v160, v139, v139, v160 op_sel:[1,1,0] op_sel_hi:[1,1,0]
s_waitcnt lgkmcnt(8)
v_smfmac_f32_16x16x32_bf16 v[8:11], v[222:223], v[200:203], v246
ds_read_b128 v[216:219], v248 offset:58368
ds_read_u16_d16 v180, v180
ds_read_u16_d16_hi v181, v181
v_exp_f16_sdwa v150, v151 dst_sel:WORD_1 dst_unused:UNUSED_PRESERVE src0_sel:WORD_1
v_exp_f16_sdwa v147, v148 dst_sel:WORD_1 dst_unused:UNUSED_PRESERVE src0_sel:WORD_1
v_smfmac_f32_16x16x32_bf16 v[40:43], v[220:221], v[204:207], v246
v_and_b32_e64 v183, s49, v183
v_fma_mix_f32 v160, v140, v140, v160 op_sel:[0,0,0] op_sel_hi:[1,1,0]
v_pk_add_f16 v153, v153, 1.0 op_sel_hi:[1,0]
v_mfma_f32_32x32x16_bf16 v[120:135], v[60:63], v[224:227], v[120:135]
ds_read_b128 v[220:223], v245 offset:4992
ds_read_b128 v[200:203], v242
v_xor_b32 v244, 16, v244
ds_read_b128 v[204:207], v244 offset:128
v_bfe_u32 v182, v183, 2, 14
v_pk_add_f16 v150, v150, 1.0 op_sel_hi:[1,0]
v_pk_add_f16 v147, v147, 1.0 op_sel_hi:[1,0]
v_rcp_f16 v154, v153
v_lshrrev_b32 v183, 18, v183
s_waitcnt lgkmcnt(6)
v_smfmac_f32_16x16x32_bf16 v[24:27], v[230:231], v[208:211], v246
ds_read_b128 v[224:227], v245 offset:4608
ds_read_u16_d16 v182, v182
ds_read_u16_d16_hi v183, v183
v_fma_mix_f32 v160, v141, v141, v160 op_sel:[1,1,0] op_sel_hi:[1,1,0]
v_rcp_f16_e64 v151, v150
v_smfmac_f32_16x16x32_bf16 v[8:11], v[228:229], v[212:215], v246
v_and_b32 v185, s49, v185
v_rcp_f16 v148, v147
v_mfma_f32_32x32x16_bf16 v[120:135], v[64:67], v[232:235], v[120:135]
ds_read_b128 v[208:211], v244 offset:64
ds_read_b128 v[212:215], v244
ds_read_b128 v[228:231], v248 offset:59392
v_fma_mix_f32 v160, v142, v142, v160 op_sel:[0,0,0] op_sel_hi:[1,1,0]
v_bfe_u32 v184, v185, 2, 14
v_rcp_f16_sdwa v154, v153 dst_sel:WORD_1 dst_unused:UNUSED_PRESERVE src0_sel:WORD_1
v_rcp_f16_sdwa v151, v150 dst_sel:WORD_1 dst_unused:UNUSED_PRESERVE src0_sel:WORD_1
v_smfmac_f32_16x16x32_bf16 v[40:43], v[238:239], v[192:195], v246
ds_read_b128 v[232:235], v248 offset:62464
ds_read_u16_d16 v184, v184
ds_read_b32 v247, v253 offset:28
v_lshrrev_b32_e64 v185, 18, v185
v_fma_mix_f32 v160, v143, v143, v160 op_sel:[1,1,0] op_sel_hi:[1,1,0]
v_smfmac_f32_16x16x32_bf16 v[24:27], v[236:237], v[196:199], v246
v_rcp_f16_sdwa v148, v147 dst_sel:WORD_1 dst_unused:UNUSED_PRESERVE src0_sel:WORD_1
v_and_b32 v187, s49, v187
v_pk_mul_f16 v155, v155, v154
s_waitcnt lgkmcnt(7)
v_mfma_f32_32x32x16_bf16 v[120:135], v[68:71], v[216:219], v[120:135]
ds_read_b128 v[236:239], v248 offset:60416
ds_read_u16_d16_hi v185, v185
v_fma_mix_f32 v160, v176, v176, v160 op_sel:[0,0,0] op_sel_hi:[1,1,0]
v_pk_mul_f16 v152, v152, v151
v_bfe_u32 v186, v187, 2, 14
v_pk_mul_f16 v149, v149, v148
v_fma_mix_f32 v161, v155, v155, 0 op_sel:[0,0,0] op_sel_hi:[1,1,0]
v_fma_mix_f32 v161, v155, v155, v161 op_sel:[1,1,0] op_sel_hi:[1,1,0]
v_smfmac_f32_16x16x32_bf16 v[8:11], v[222:223], v[200:203], v246
ds_read_b128 v[216:219], v245 offset:4224
v_xor_b32 v243, 16, v243
ds_read_b128 v[192:195], v243 offset:128
ds_read_b128 v[196:199], v243 offset:64
ds_read_u16_d16 v186, v186
v_lshrrev_b32 v187, 18, v187
v_fma_mix_f32 v160, v177, v177, v160 op_sel:[1,1,0] op_sel_hi:[1,1,0]
v_fma_mix_f32 v161, v152, v152, v161 op_sel:[0,0,0] op_sel_hi:[1,1,0]
v_smfmac_f32_16x16x32_bf16 v[44:47], v[220:221], v[204:207], v246
v_fma_mix_f32 v161, v152, v152, v161 op_sel:[1,1,0] op_sel_hi:[1,1,0]
v_fma_mix_f32 v161, v149, v149, v161 op_sel:[0,0,0] op_sel_hi:[1,1,0]
v_fma_mix_f32 v161, v149, v149, v161 op_sel:[1,1,0] op_sel_hi:[1,1,0]
s_cmp_lg_u32 s40, 7
s_cbranch_scc1 Lnosent
v_mov_b32 v104, -1
v_mov_b32 v105, -1
v_mov_b32 v106, -1
v_mov_b32 v107, -1
v_lshlrev_b32_e64 v100, 12, v251
v_add_u32 v101, 262144, v100
v_cmp_gt_u32 vcc, 32, v251
v_mov_b32 v102, 2147483648
s_nop 0
v_cndmask_b32 v101, v102, v101, vcc
s_lshl_b32 s43, s2, 4
buffer_store_dwordx4 v[104:107], v100, s[32:35], s43 offen sc1
buffer_store_dwordx4 v[104:107], v101, s[32:35], s43 offen sc1
s_add_u32 s43, s43, 393216
s_cmp_lt_u32 s2, 96
s_cselect_b32 s43, s43, 1073741824
v_lshlrev_b32_e64 v102, 11, v251
s_mov_b64 exec, 0xff
buffer_store_dwordx4 v[104:107], v102, s[32:35], s43 offen sc1
s_mov_b64 exec, -1
s_sub_u32 s43, s2, 96
s_cmp_lt_u32 s43, 96
s_cbranch_scc0 Lnobias
s_lshl_b32 s44, s43, 1
v_mul_u32_u24 v100, 192, v251
v_lshlrev_b32 v101, 1, v251
s_add_u32 s45, s44, 0
buffer_load_ushort v102, v100, s[16:19], s45 offen
buffer_load_ushort v108, v101, s[28:31], 0 offen offset:0
s_add_u32 s45, s44, 12288
buffer_load_ushort v103, v100, s[16:19], s45 offen
buffer_load_ushort v109, v101, s[28:31], 0 offen offset:128
s_add_u32 s45, s44, 24576
buffer_load_ushort v104, v100, s[16:19], s45 offen
buffer_load_ushort v110, v101, s[28:31], 0 offen offset:256
s_add_u32 s45, s44, 36864
buffer_load_ushort v105, v100, s[16:19], s45 offen
buffer_load_ushort v111, v101, s[28:31], 0 offen offset:384
s_add_u32 s45, s44, 49152
buffer_load_ushort v106, v100, s[16:19], s45 offen
buffer_load_ushort v112, v101, s[28:31], 0 offen offset:512
s_add_u32 s45, s44, 61440
buffer_load_ushort v107, v100, s[16:19], s45 offen
buffer_load_ushort v113, v101, s[28:31], 0 offen offset:640
Lnobias:
s_nop 1
Lnosent:
ds_read_u16_d16_hi v187, v187
s_waitcnt lgkmcnt(1)
v_readfirstlane_b32 s43, v247
s_nop 1
s_cmp_ge_u32 s43, 12
s_cbranch_scc1 Lev4
Lev4w:
s_sleep 1
ds_read_b32 v247, v253 offset:28
s_waitcnt lgkmcnt(0)
v_readfirstlane_b32 s43, v247
s_cmp_eq_u32 s76, 0
s_cbranch_scc1 Lev4
s_sub_u32 s76, s76, 1
s_cmp_lt_u32 s43, 12
s_cbranch_scc1 Lev4w
Lev4:
s_setprio 1
v_smfmac_f32_16x16x32_bf16 v[28:31], v[226:227], v[208:211], v246
ds_read_b128 v[220:223], v248 offset:63488
v_cvt_pkrtz_f16_f32 v137, v120, v121
v_cvt_pkrtz_f16_f32 v139, v122, v123
v_cvt_pkrtz_f16_f32 v141, v124, v125
v_cvt_pkrtz_f16_f32 v143, v126, v127
v_smfmac_f32_16x16x32_bf16 v[12:15], v[224:225], v[212:215], v246
v_cvt_pk_f16_f32 v155, v128, v129
v_cvt_pk_f16_f32 v152, v130, v131
v_cvt_pk_f16_f32 v149, v132, v133
v_cvt_pk_f16_f32 v146, v134, v135
v_mfma_f32_32x32x16_bf16 v[120:135], v[48:51], v[228:231], 0
ds_read_b128 v[224:227], v248 offset:61440
v_pk_fma_f16 v154, v155, v155, s48
v_and_b32 v137, s49, v137
v_fma_mix_f32 v161, v178, v178, v161 op_sel:[0,0,0] op_sel_hi:[1,1,0]
v_pk_fma_f16 v151, v152, v152, s48
v_pk_fma_f16 v148, v149, v149, s48
v_pk_fma_f16 v145, v146, v146, s48
v_pk_mul_f16 v154, v155, v154
v_bfe_u32 v136, v137, 2, 14
v_pk_mul_f16 v151, v152, v151
v_mfma_f32_32x32x16_bf16 v[120:135], v[52:55], v[232:235], v[120:135]
ds_read_b128 v[228:231], v245 offset:3840
ds_read_b128 v[200:203], v243
v_xor_b32 v242, 16, v242
ds_read_b128 v[204:207], v242 offset:128
ds_read_u16_d16 v136, v136
v_fma_mix_f32 v161, v179, v179, v161 op_sel:[1,1,0] op_sel_hi:[1,1,0]
v_pk_mul_f16 v148, v149, v148
v_pk_mul_f16 v145, v146, v145
v_exp_f16 v153, v154
v_lshrrev_b32 v137, 18, v137
v_exp_f16 v150, v151
v_mfma_f32_32x32x16_bf16 v[120:135], v[56:59], v[236:239], v[120:135]
ds_read_b128 v[232:235], v248 offset:64512
ds_read_u16_d16_hi v137, v137
v_fma_mix_f32 v161, v180, v180, v161 op_sel:[0,0,0] op_sel_hi:[1,1,0]
v_exp_f16 v147, v148
v_and_b32 v139, s49, v139
v_exp_f16_e64 v144, v145
v_exp_f16_sdwa v153, v154 dst_sel:WORD_1 dst_unused:UNUSED_PRESERVE src0_sel:WORD_1
v_fma_mix_f32 v161, v181, v181, v161 op_sel:[1,1,0] op_sel_hi:[1,1,0]
v_smfmac_f32_16x16x32_bf16 v[44:47], v[218:219], v[192:195], v246
ds_read_b128 v[236:239], v245 offset:3456
ds_read_b128 v[208:211], v242 offset:64
ds_read_b128 v[212:215], v242
v_bfe_u32 v138, v139, 2, 14
v_exp_f16_sdwa v150, v151 dst_sel:WORD_1 dst_unused:UNUSED_PRESERVE src0_sel:WORD_1
v_smfmac_f32_16x16x32_bf16 v[28:31], v[216:217], v[196:199], v246
v_exp_f16_sdwa v147, v148 dst_sel:WORD_1 dst_unused:UNUSED_PRESERVE src0_sel:WORD_1
v_exp_f16_sdwa v144, v145 dst_sel:WORD_1 dst_unused:UNUSED_PRESERVE src0_sel:WORD_1
v_lshrrev_b32_e64 v139, 18, v139
s_waitcnt lgkmcnt(5)
v_mfma_f32_32x32x16_bf16 v[120:135], v[60:63], v[220:223], v[120:135]
ds_read_b128 v[216:219], v245 offset:3072
v_xor_b32 v244, 32, v244
ds_read_b128 v[192:195], v244 offset:128
ds_read_b128 v[196:199], v244 offset:64
ds_read_u16_d16 v138, v138
ds_read_u16_d16_hi v139, v139
v_fma_mix_f32 v161, v182, v182, v161 op_sel:[0,0,0] op_sel_hi:[1,1,0]
v_pk_add_f16 v153, v153, 1.0 op_sel_hi:[1,0]
v_pk_add_f16 v150, v150, 1.0 op_sel_hi:[1,0]
v_pk_add_f16 v147, v147, 1.0 op_sel_hi:[1,0]
v_and_b32_e64 v141, s49, v141
v_pk_add_f16 v144, v144, 1.0 op_sel_hi:[1,0]
v_rcp_f16_e64 v154, v153
v_fma_mix_f32 v161, v183, v183, v161 op_sel:[1,1,0] op_sel_hi:[1,1,0]
v_mfma_f32_32x32x16_bf16 v[120:135], v[64:67], v[224:227], v[120:135]
ds_read_b128 v[220:223], v249
v_rcp_f16_e64 v151, v150
v_bfe_u32 v140, v141, 2, 14
v_rcp_f16_e64 v148, v147
v_fma_mix_f32 v161, v184, v184, v161 op_sel:[0,0,0] op_sel_hi:[1,1,0]
v_rcp_f16 v145, v144
v_lshrrev_b32 v141, 18, v141
v_smfmac_f32_16x16x32_bf16 v[12:15], v[230:231], v[200:203], v246
ds_read_b128 v[224:227], v249 offset:3072
ds_read_u16_d16 v140, v140
ds_read_u16_d16_hi v141, v141
v_rcp_f16_sdwa v154, v153 dst_sel:WORD_1 dst_unused:UNUSED_PRESERVE src0_sel:WORD_1
s_setprio 0
v_rcp_f16_sdwa v151, v150 dst_sel:WORD_1 dst_unused:UNUSED_PRESERVE src0_sel:WORD_1
v_smfmac_f32_16x16x32_bf16 v[44:47], v[228:229], v[204:207], v246
v_fma_mix_f32 v161, v185, v185, v161 op_sel:[1,1,0] op_sel_hi:[1,1,0]
v_and_b32 v143, s49, v143
v_rcp_f16_sdwa v148, v147 dst_sel:WORD_1 dst_unused:UNUSED_PRESERVE src0_sel:WORD_1
s_waitcnt lgkmcnt(4)
v_mfma_f32_32x32x16_bf16 v[120:135], v[68:71], v[232:235], v[120:135]
ds_read_b128 v[228:231], v245 offset:2688
ds_read_b128 v[200:203], v244
v_xor_b32 v243, 32, v243
ds_read_b128 v[204:207], v243 offset:128
v_rcp_f16_sdwa v145, v144 dst_sel:WORD_1 dst_unused:UNUSED_PRESERVE src0_sel:WORD_1
v_pk_mul_f16 v155, v155, v154
v_bfe_u32 v142, v143, 2, 14
v_fma_mix_f32 v161, v186, v186, v161 op_sel:[0,0,0] op_sel_hi:[1,1,0]
v_pk_mul_f16 v152, v152, v151
v_pk_mul_f16 v149, v149, v148
v_pk_mul_f16 v146, v146, v145
v_fma_mix_f32 v162, v155, v155, 0 op_sel:[0,0,0] op_sel_hi:[1,1,0]
v_smfmac_f32_16x16x32_bf16 v[28:31], v[238:239], v[208:211], v246
ds_read_b128 v[232:235], v249 offset:1024
ds_read_u16_d16 v142, v142
v_lshrrev_b32_e64 v143, 18, v143
v_fma_mix_f32 v162, v155, v155, v162 op_sel:[1,1,0] op_sel_hi:[1,1,0]
v_fma_mix_f32 v162, v152, v152, v162 op_sel:[0,0,0] op_sel_hi:[1,1,0]
v_fma_mix_f32 v161, v187, v187, v161 op_sel:[1,1,0] op_sel_hi:[1,1,0]
v_smfmac_f32_16x16x32_bf16 v[12:15], v[236:237], v[212:215], v246
v_fma_mix_f32 v162, v152, v152, v162 op_sel:[1,1,0] op_sel_hi:[1,1,0]
v_fma_mix_f32 v162, v149, v149, v162 op_sel:[0,0,0] op_sel_hi:[1,1,0]
v_fma_mix_f32 v162, v149, v149, v162 op_sel:[1,1,0] op_sel_hi:[1,1,0]
v_fma_mix_f32 v162, v146, v146, v162 op_sel:[0,0,0] op_sel_hi:[1,1,0]
v_fma_mix_f32 v162, v146, v146, v162 op_sel:[1,1,0] op_sel_hi:[1,1,0]
v_lshlrev_b32_e64 v252, 7, v251
s_add_u32 s46, s47, 1572864
s_mov_b32 exec_lo, 131071
s_mov_b32 exec_hi, 0
s_mov_b32 m0, 16288
s_nop 0
buffer_load_dword v252, s[4:7], s46 offen lds
s_mov_b64 exec, -1
s_setprio 2
v_smfmac_f32_16x16x32_bf16 v[36:39], v[218:219], v[192:195], v246
ds_read_b128 v[236:239], v249 offset:4096
ds_read_u16_d16_hi v143, v143
v_cvt_pkrtz_f16_f32 v179, v120, v121
v_cvt_pkrtz_f16_f32 v181, v122, v123
v_cvt_pkrtz_f16_f32 v183, v124, v125
v_smfmac_f32_16x16x32_bf16 v[20:23], v[216:217], v[196:199], v246
v_cvt_pkrtz_f16_f32 v185, v126, v127
v_cvt_pkrtz_f16_f32 v187, v128, v129
v_cvt_pk_f16_f32 v155, v130, v131
v_cvt_pk_f16_f32 v152, v132, v133
v_cvt_pk_f16_f32 v149, v134, v135
s_waitcnt lgkmcnt(2)
v_mfma_f32_32x32x16_bf16 v[120:135], v[48:51], v[220:223], 0
ds_read_b128 v[216:219], v245 offset:2304
ds_read_b128 v[208:211], v243 offset:64
ds_read_b128 v[212:215], v243
v_pk_fma_f16 v154, v155, v155, s48
v_and_b32 v179, s49, v179
v_fma_mix_f32 v162, v136, v136, v162 op_sel:[0,0,0] op_sel_hi:[1,1,0]
v_pk_fma_f16 v151, v152, v152, s48
v_pk_fma_f16 v148, v149, v149, s48
v_mfma_f32_32x32x16_bf16 v[120:135], v[52:55], v[224:227], v[120:135]
ds_read_b128 v[220:223], v249 offset:2048
v_bfe_u32 v178, v179, 2, 14
v_pk_mul_f16 v154, v155, v154
v_pk_mul_f16 v151, v152, v151
v_pk_mul_f16 v148, v149, v148
v_lshrrev_b32 v179, 18, v179
v_fma_mix_f32 v162, v137, v137, v162 op_sel:[1,1,0] op_sel_hi:[1,1,0]
v_smfmac_f32_16x16x32_bf16 v[4:7], v[230:231], v[200:203], v246
ds_read_b128 v[224:227], v245 offset:1920
v_xor_b32 v242, 32, v242
ds_read_b128 v[192:195], v242 offset:128
ds_read_b128 v[196:199], v242 offset:64
ds_read_u16_d16 v178, v178
ds_read_u16_d16_hi v179, v179
v_exp_f16 v153, v154
v_and_b32 v181, s49, v181
v_smfmac_f32_16x16x32_bf16 v[36:39], v[228:229], v[204:207], v246
v_exp_f16 v150, v151
v_exp_f16 v147, v148
v_mfma_f32_32x32x16_bf16 v[120:135], v[56:59], v[232:235], v[120:135]
ds_read_b128 v[228:231], v249 offset:5120
v_bfe_u32 v180, v181, 2, 14
v_fma_mix_f32 v162, v138, v138, v162 op_sel:[0,0,0] op_sel_hi:[1,1,0]
v_exp_f16_sdwa v153, v154 dst_sel:WORD_1 dst_unused:UNUSED_PRESERVE src0_sel:WORD_1
v_lshrrev_b32_e64 v181, 18, v181
v_exp_f16_sdwa v150, v151 dst_sel:WORD_1 dst_unused:UNUSED_PRESERVE src0_sel:WORD_1
s_waitcnt lgkmcnt(6)
v_mfma_f32_32x32x16_bf16 v[120:135], v[60:63], v[236:239], v[120:135]
ds_read_b128 v[232:235], v245 offset:1536
ds_read_b128 v[200:203], v242
v_xor_b32 v244, 16, v244
ds_read_b128 v[204:207], v244 offset:128
ds_read_u16_d16 v180, v180
ds_read_u16_d16_hi v181, v181
v_fma_mix_f32 v162, v139, v139, v162 op_sel:[1,1,0] op_sel_hi:[1,1,0]
v_and_b32_e64 v183, s49, v183
v_exp_f16_sdwa v147, v148 dst_sel:WORD_1 dst_unused:UNUSED_PRESERVE src0_sel:WORD_1
v_pk_add_f16 v153, v153, 1.0 op_sel_hi:[1,0]
v_bfe_u32 v182, v183, 2, 14
v_smfmac_f32_16x16x32_bf16 v[20:23], v[218:219], v[208:211], v246
ds_read_b128 v[236:239], v245 offset:1152
ds_read_u16_d16 v182, v182
v_pk_add_f16 v150, v150, 1.0 op_sel_hi:[1,0]
v_pk_add_f16 v147, v147, 1.0 op_sel_hi:[1,0]
v_rcp_f16_e64 v154, v153
v_smfmac_f32_16x16x32_bf16 v[4:7], v[216:217], v[212:215], v246
v_lshrrev_b32_e64 v183, 18, v183
v_fma_mix_f32 v162, v140, v140, v162 op_sel:[0,0,0] op_sel_hi:[1,1,0]
v_mfma_f32_32x32x16_bf16 v[120:135], v[64:67], v[220:223], v[120:135]
ds_read_b128 v[208:211], v244 offset:64
ds_read_b128 v[212:215], v244
ds_read_b128 v[216:219], v249 offset:6144
ds_read_u16_d16_hi v183, v183
v_rcp_f16 v151, v150
v_and_b32 v185, s49, v185
v_rcp_f16 v148, v147
v_fma_mix_f32 v162, v141, v141, v162 op_sel:[1,1,0] op_sel_hi:[1,1,0]
v_bfe_u32 v184, v185, 2, 14
s_waitcnt lgkmcnt(6)
v_smfmac_f32_16x16x32_bf16 v[36:39], v[226:227], v[192:195], v246
ds_read_b128 v[220:223], v249 offset:9216
ds_read_u16_d16 v184, v184
v_rcp_f16_sdwa v154, v153 dst_sel:WORD_1 dst_unused:UNUSED_PRESERVE src0_sel:WORD_1
v_rcp_f16_sdwa v151, v150 dst_sel:WORD_1 dst_unused:UNUSED_PRESERVE src0_sel:WORD_1
v_smfmac_f32_16x16x32_bf16 v[20:23], v[224:225], v[196:199], v246
v_lshrrev_b32_e64 v185, 18, v185
v_rcp_f16_sdwa v148, v147 dst_sel:WORD_1 dst_unused:UNUSED_PRESERVE src0_sel:WORD_1
v_mfma_f32_32x32x16_bf16 v[120:135], v[68:71], v[228:231], v[120:135]
ds_read_b128 v[224:227], v249 offset:7168
ds_read_u16_d16_hi v185, v185
v_and_b32_e64 v187, s49, v187
v_fma_mix_f32 v162, v142, v142, v162 op_sel:[0,0,0] op_sel_hi:[1,1,0]
v_pk_mul_f16 v155, v155, v154
v_pk_mul_f16 v152, v152, v151
v_bfe_u32 v186, v187, 2, 14
v_pk_mul_f16 v149, v149, v148
v_fma_mix_f32 v163, v155, v155, 0 op_sel:[0,0,0] op_sel_hi:[1,1,0]
v_smfmac_f32_16x16x32_bf16 v[4:7], v[234:235], v[200:203], v246
ds_read_b128 v[228:231], v245 offset:768
v_xor_b32 v243, 16, v243
ds_read_b128 v[192:195], v243 offset:128
ds_read_b128 v[196:199], v243 offset:64
ds_read_u16_d16 v186, v186
v_fma_mix_f32 v162, v143, v143, v162 op_sel:[1,1,0] op_sel_hi:[1,1,0]
v_lshrrev_b32 v187, 18, v187
v_fma_mix_f32 v163, v155, v155, v163 op_sel:[1,1,0] op_sel_hi:[1,1,0]
v_smfmac_f32_16x16x32_bf16 v[32:35], v[232:233], v[204:207], v246
v_fma_mix_f32 v163, v152, v152, v163 op_sel:[0,0,0] op_sel_hi:[1,1,0]
v_fma_mix_f32 v163, v152, v152, v163 op_sel:[1,1,0] op_sel_hi:[1,1,0]
v_fma_mix_f32 v163, v149, v149, v163 op_sel:[0,0,0] op_sel_hi:[1,1,0]
v_fma_mix_f32 v163, v149, v149, v163 op_sel:[1,1,0] op_sel_hi:[1,1,0]
v_lshlrev_b32 v252, 7, v251
s_add_u32 s46, s47, 1572864
s_mov_b32 exec_lo, 4294836224
s_mov_b32 exec_hi, 3
s_mov_b32 m0, 16220
s_nop 0
buffer_load_dword v252, s[4:7], s46 offen lds
s_mov_b64 exec, -1
s_setprio 1
s_waitcnt lgkmcnt(4)
v_smfmac_f32_16x16x32_bf16 v[16:19], v[238:239], v[208:211], v246
ds_read_b128 v[232:235], v249 offset:10240
ds_read_u16_d16_hi v187, v187
v_cvt_pkrtz_f16_f32 v137, v120, v121
v_cvt_pkrtz_f16_f32 v139, v122, v123
v_cvt_pkrtz_f16_f32 v141, v124, v125
v_smfmac_f32_16x16x32_bf16 v[0:3], v[236:237], v[212:215], v246
v_cvt_pkrtz_f16_f32 v143, v126, v127
v_cvt_pk_f16_f32 v155, v128, v129
v_cvt_pk_f16_f32 v152, v130, v131
v_cvt_pk_f16_f32 v149, v132, v133
v_cvt_pk_f16_f32 v146, v134, v135
v_mfma_f32_32x32x16_bf16 v[120:135], v[48:51], v[216:219], 0
ds_read_b128 v[236:239], v249 offset:8192
v_pk_fma_f16 v154, v155, v155, s48
v_and_b32_e64 v137, s49, v137
v_fma_mix_f32 v163, v178, v178, v163 op_sel:[0,0,0] op_sel_hi:[1,1,0]
v_pk_fma_f16 v151, v152, v152, s48
v_pk_fma_f16 v148, v149, v149, s48
v_pk_fma_f16 v145, v146, v146, s48
v_pk_mul_f16 v154, v155, v154
v_mfma_f32_32x32x16_bf16 v[120:135], v[52:55], v[220:223], v[120:135]
ds_read_b128 v[216:219], v245 offset:384
ds_read_b128 v[200:203], v243
v_xor_b32 v242, 16, v242
ds_read_b128 v[204:207], v242 offset:128
v_bfe_u32 v136, v137, 2, 14
v_pk_mul_f16 v151, v152, v151
v_fma_mix_f32 v163, v179, v179, v163 op_sel:[1,1,0] op_sel_hi:[1,1,0]
v_pk_mul_f16 v148, v149, v148
v_pk_mul_f16 v145, v146, v145
v_exp_f16 v153, v154
v_lshrrev_b32_e64 v137, 18, v137
v_mfma_f32_32x32x16_bf16 v[120:135], v[56:59], v[224:227], v[120:135]
ds_read_b128 v[220:223], v249 offset:11264
ds_read_u16_d16 v136, v136
ds_read_u16_d16_hi v137, v137
v_exp_f16_e64 v150, v151
v_fma_mix_f32 v163, v180, v180, v163 op_sel:[0,0,0] op_sel_hi:[1,1,0]
v_exp_f16 v147, v148
v_and_b32 v139, s49, v139
v_exp_f16 v144, v145
s_waitcnt lgkmcnt(6)
v_smfmac_f32_16x16x32_bf16 v[32:35], v[230:231], v[192:195], v246
ds_read_b128 v[224:227], v245
ds_read_b128 v[208:211], v242 offset:64
ds_read_b128 v[212:215], v242
v_exp_f16_sdwa v153, v154 dst_sel:WORD_1 dst_unused:UNUSED_PRESERVE src0_sel:WORD_1
v_fma_mix_f32 v163, v181, v181, v163 op_sel:[1,1,0] op_sel_hi:[1,1,0]
v_bfe_u32 v138, v139, 2, 14
v_smfmac_f32_16x16x32_bf16 v[16:19], v[228:229], v[196:199], v246
v_exp_f16_sdwa v150, v151 dst_sel:WORD_1 dst_unused:UNUSED_PRESERVE src0_sel:WORD_1
v_mfma_f32_32x32x16_bf16 v[120:135], v[60:63], v[232:235], v[120:135]
ds_read_b128 v[228:231], v249 offset:12288
ds_read_u16_d16 v138, v138
v_exp_f16_sdwa v147, v148 dst_sel:WORD_1 dst_unused:UNUSED_PRESERVE src0_sel:WORD_1
v_exp_f16_sdwa v144, v145 dst_sel:WORD_1 dst_unused:UNUSED_PRESERVE src0_sel:WORD_1
v_lshrrev_b32_e64 v139, 18, v139
v_fma_mix_f32 v163, v182, v182, v163 op_sel:[0,0,0] op_sel_hi:[1,1,0]
v_pk_add_f16 v153, v153, 1.0 op_sel_hi:[1,0]
v_pk_add_f16 v150, v150, 1.0 op_sel_hi:[1,0]
v_pk_add_f16 v147, v147, 1.0 op_sel_hi:[1,0]
v_mfma_f32_32x32x16_bf16 v[120:135], v[64:67], v[236:239], v[120:135]
ds_read_b128 v[232:235], v249 offset:15360
ds_read_u16_d16_hi v139, v139
v_and_b32_e64 v141, s49, v141
v_pk_add_f16 v144, v144, 1.0 op_sel_hi:[1,0]
v_rcp_f16_e64 v154, v153
v_fma_mix_f32 v163, v183, v183, v163 op_sel:[1,1,0] op_sel_hi:[1,1,0]
v_rcp_f16 v151, v150
v_bfe_u32 v140, v141, 2, 14
s_waitcnt lgkmcnt(4)
v_smfmac_f32_16x16x32_bf16 v[0:3], v[218:219], v[200:203], v246
ds_read_b128 v[236:239], v249 offset:13312
ds_read_u16_d16 v140, v140
v_rcp_f16_e64 v148, v147
v_fma_mix_f32 v163, v184, v184, v163 op_sel:[0,0,0] op_sel_hi:[1,1,0]
v_smfmac_f32_16x16x32_bf16 v[32:35], v[216:217], v[204:207], v246
v_rcp_f16_e64 v145, v144
v_lshrrev_b32 v141, 18, v141
v_rcp_f16_sdwa v154, v153 dst_sel:WORD_1 dst_unused:UNUSED_PRESERVE src0_sel:WORD_1
s_setprio 0
v_mfma_f32_32x32x16_bf16 v[120:135], v[68:71], v[220:223], v[120:135]
ds_read_b128 v[216:219], v249 offset:16384
ds_read_u16_d16_hi v141, v141
v_rcp_f16_sdwa v151, v150 dst_sel:WORD_1 dst_unused:UNUSED_PRESERVE src0_sel:WORD_1
v_fma_mix_f32 v163, v185, v185, v163 op_sel:[1,1,0] op_sel_hi:[1,1,0]
v_and_b32_e64 v143, s49, v143
v_rcp_f16_sdwa v148, v147 dst_sel:WORD_1 dst_unused:UNUSED_PRESERVE src0_sel:WORD_1
v_rcp_f16_sdwa v145, v144 dst_sel:WORD_1 dst_unused:UNUSED_PRESERVE src0_sel:WORD_1
v_smfmac_f32_16x16x32_bf16 v[16:19], v[226:227], v[208:211], v246
ds_read_b128 v[220:223], v249 offset:14336
v_pk_mul_f16 v155, v155, v154
v_bfe_u32 v142, v143, 2, 14
v_fma_mix_f32 v163, v186, v186, v163 op_sel:[0,0,0] op_sel_hi:[1,1,0]
v_pk_mul_f16 v152, v152, v151
v_smfmac_f32_16x16x32_bf16 v[0:3], v[224:225], v[212:215], v246
s_mov_b64 exec, 1
ds_add_u32 v253, v254 offset:16
s_mov_b64 exec, -1
v_pk_mul_f16 v149, v149, v148
v_pk_mul_f16 v146, v146, v145
v_fma_mix_f32 v164, v155, v155, 0 op_sel:[0,0,0] op_sel_hi:[1,1,0]
v_lshrrev_b32 v143, 18, v143
v_fma_mix_f32 v164, v155, v155, v164 op_sel:[1,1,0] op_sel_hi:[1,1,0]
v_fma_mix_f32 v164, v152, v152, v164 op_sel:[0,0,0] op_sel_hi:[1,1,0]
v_fma_mix_f32 v163, v187, v187, v163 op_sel:[1,1,0] op_sel_hi:[1,1,0]
v_fma_mix_f32 v164, v152, v152, v164 op_sel:[1,1,0] op_sel_hi:[1,1,0]
v_fma_mix_f32 v164, v149, v149, v164 op_sel:[0,0,0] op_sel_hi:[1,1,0]
v_fma_mix_f32 v164, v149, v149, v164 op_sel:[1,1,0] op_sel_hi:[1,1,0]
v_fma_mix_f32 v164, v146, v146, v164 op_sel:[0,0,0] op_sel_hi:[1,1,0]
v_fma_mix_f32 v164, v146, v146, v164 op_sel:[1,1,0] op_sel_hi:[1,1,0]
s_setprio 3
v_pk_add_f32 v[168:169], v[0:1], v[2:3]
v_pk_mul_f32 v[170:171], v[0:1], v[0:1]
v_pk_fma_f32 v[170:171], v[2:3], v[2:3], v[170:171]
v_pk_add_f32 v[168:169], v[168:169], v[4:5]
v_pk_fma_f32 v[170:171], v[4:5], v[4:5], v[170:171]
v_pk_add_f32 v[168:169], v[168:169], v[6:7]
v_pk_fma_f32 v[170:171], v[6:7], v[6:7], v[170:171]
v_pk_add_f32 v[168:169], v[168:169], v[8:9]
v_pk_fma_f32 v[170:171], v[8:9], v[8:9], v[170:171]
v_pk_add_f32 v[168:169], v[168:169], v[10:11]
v_pk_fma_f32 v[170:171], v[10:11], v[10:11], v[170:171]
v_pk_add_f32 v[168:169], v[168:169], v[12:13]
v_pk_fma_f32 v[170:171], v[12:13], v[12:13], v[170:171]
v_pk_add_f32 v[168:169], v[168:169], v[14:15]
v_pk_fma_f32 v[170:171], v[14:15], v[14:15], v[170:171]
v_pk_add_f32 v[168:169], v[168:169], v[16:17]
v_pk_fma_f32 v[170:171], v[16:17], v[16:17], v[170:171]
v_pk_add_f32 v[168:169], v[168:169], v[18:19]
v_pk_fma_f32 v[170:171], v[18:19], v[18:19], v[170:171]
v_pk_add_f32 v[168:169], v[168:169], v[20:21]
v_pk_fma_f32 v[170:171], v[20:21], v[20:21], v[170:171]
v_pk_add_f32 v[168:169], v[168:169], v[22:23]
v_pk_fma_f32 v[170:171], v[22:23], v[22:23], v[170:171]
v_pk_add_f32 v[168:169], v[168:169], v[24:25]
v_pk_fma_f32 v[170:171], v[24:25], v[24:25], v[170:171]
v_pk_add_f32 v[168:169], v[168:169], v[26:27]
v_pk_fma_f32 v[170:171], v[26:27], v[26:27], v[170:171]
v_pk_add_f32 v[168:169], v[168:169], v[28:29]
v_pk_fma_f32 v[170:171], v[28:29], v[28:29], v[170:171]
v_pk_add_f32 v[168:169], v[168:169], v[30:31]
v_pk_fma_f32 v[170:171], v[30:31], v[30:31], v[170:171]
v_pk_add_f32 v[168:169], v[168:169], v[32:33]
v_pk_fma_f32 v[170:171], v[32:33], v[32:33], v[170:171]
v_pk_add_f32 v[168:169], v[168:169], v[34:35]
v_pk_fma_f32 v[170:171], v[34:35], v[34:35], v[170:171]
v_pk_add_f32 v[168:169], v[168:169], v[36:37]
v_pk_fma_f32 v[170:171], v[36:37], v[36:37], v[170:171]
v_pk_add_f32 v[168:169], v[168:169], v[38:39]
v_pk_fma_f32 v[170:171], v[38:39], v[38:39], v[170:171]
v_pk_add_f32 v[168:169], v[168:169], v[40:41]
v_pk_fma_f32 v[170:171], v[40:41], v[40:41], v[170:171]
v_pk_add_f32 v[168:169], v[168:169], v[42:43]
v_pk_fma_f32 v[170:171], v[42:43], v[42:43], v[170:171]
v_pk_add_f32 v[168:169], v[168:169], v[44:45]
v_pk_fma_f32 v[170:171], v[44:45], v[44:45], v[170:171]
v_pk_add_f32 v[168:169], v[168:169], v[46:47]
v_pk_fma_f32 v[170:171], v[46:47], v[46:47], v[170:171]
s_setprio 0
v_add_u32 v174, -36864, v242
v_subrev_u32 v175, 66560, v174
v_min_u32 v174, v174, v175
v_add_u32 v174, 90112, v174
v_sub_u32 v175, v174, v242
v_add_u32 v242, v175, v242
v_add_u32 v243, v175, v243
v_add_u32 v244, v175, v244
v_lshlrev_b32_e64 v252, 7, v251
s_add_u32 s46, s47, 1572864
s_mov_b32 exec_lo, 0
s_mov_b32 exec_hi, 1048572
s_mov_b32 m0, 16152
s_nop 0
buffer_load_dword v252, s[4:7], s46 offen lds
s_mov_b64 exec, -1
s_setprio 2
v_cvt_pkrtz_f16_f32 v179, v120, v121
v_cvt_pkrtz_f16_f32 v181, v122, v123
v_cvt_pkrtz_f16_f32 v183, v124, v125
v_cvt_pkrtz_f16_f32 v185, v126, v127
v_cvt_pkrtz_f16_f32 v187, v128, v129
v_cvt_pk_f16_f32 v155, v130, v131
v_cvt_pk_f16_f32 v152, v132, v133
v_cvt_pk_f16_f32 v149, v134, v135
s_waitcnt lgkmcnt(1)
ds_read_b128 v[224:227], v249 offset:17408
ds_read_u16_d16 v142, v142
ds_read_u16_d16_hi v143, v143
v_mfma_f32_32x32x16_bf16 v[120:135], v[48:51], v[228:231], 0
v_pk_fma_f16 v154, v155, v155, s48
v_add_f32 v168, v168, v169
v_and_b32_e64 v179, s49, v179
v_fma_mix_f32 v164, v136, v136, v164 op_sel:[0,0,0] op_sel_hi:[1,1,0]
v_pk_fma_f16 v151, v152, v152, s48
v_pk_fma_f16 v148, v149, v149, s48
v_add_f32_e64 v170, v170, v171
v_bfe_u32 v178, v179, 2, 14
v_pk_mul_f16 v154, v155, v154
v_pk_mul_f16 v151, v152, v151
v_pk_mul_f16 v148, v149, v148
v_lshrrev_b32_e64 v179, 18, v179
ds_read_b128 v[228:231], v249 offset:18432
ds_read_u16_d16 v178, v178
ds_read_u16_d16_hi v179, v179
v_mfma_f32_32x32x16_bf16 v[120:135], v[52:55], v[232:235], v[120:135]
v_permlane32_swap_b32 v168, v170
v_fma_mix_f32 v164, v137, v137, v164 op_sel:[1,1,0] op_sel_hi:[1,1,0]
v_exp_f16 v153, v154
v_and_b32 v181, s49, v181
v_add_f32 v168, v168, v170
v_exp_f16 v150, v151
v_exp_f16 v147, v148
v_bfe_u32 v180, v181, 2, 14
v_mul_f32 v168, 1009429163, v168
ds_read_b128 v[232:235], v249 offset:21504
ds_read_u16_d16 v180, v180
v_mfma_f32_32x32x16_bf16 v[120:135], v[56:59], v[236:239], v[120:135]
v_fma_mix_f32 v164, v138, v138, v164 op_sel:[0,0,0] op_sel_hi:[1,1,0]
v_exp_f16_sdwa v153, v154 dst_sel:WORD_1 dst_unused:UNUSED_PRESERVE src0_sel:WORD_1
v_lshrrev_b32_e64 v181, 18, v181
v_exp_f16_sdwa v150, v151 dst_sel:WORD_1 dst_unused:UNUSED_PRESERVE src0_sel:WORD_1
v_mov_b32_e64 v170, v168
v_fma_mix_f32 v164, v139, v139, v164 op_sel:[1,1,0] op_sel_hi:[1,1,0]
v_and_b32 v183, s49, v183
v_exp_f16_sdwa v147, v148 dst_sel:WORD_1 dst_unused:UNUSED_PRESERVE src0_sel:WORD_1
v_permlane32_swap_b32 v168, v170
ds_read_b128 v[236:239], v249 offset:19456
ds_read_u16_d16_hi v181, v181
v_mfma_f32_32x32x16_bf16 v[120:135], v[60:63], v[216:219], v[120:135]
v_pk_add_f16 v153, v153, 1.0 op_sel_hi:[1,0]
v_bfe_u32 v182, v183, 2, 14
v_pk_add_f16 v150, v150, 1.0 op_sel_hi:[1,0]
v_pk_add_f16 v147, v147, 1.0 op_sel_hi:[1,0]
v_fma_f32 v170, -v168, v168, v170
v_rcp_f16 v154, v153
v_lshrrev_b32 v183, 18, v183
v_fma_mix_f32 v164, v140, v140, v164 op_sel:[0,0,0] op_sel_hi:[1,1,0]
v_rcp_f16 v151, v150
v_max_f32 v170, 0, v170
ds_read_b128 v[216:219], v249 offset:22528
ds_read_u16_d16 v182, v182
ds_read_u16_d16_hi v183, v183
v_mfma_f32_32x32x16_bf16 v[120:135], v[64:67], v[220:223], v[120:135]
v_and_b32 v185, s49, v185
v_rcp_f16 v148, v147
v_add_f32 v170, 925353388, v170
v_fma_mix_f32 v164, v141, v141, v164 op_sel:[1,1,0] op_sel_hi:[1,1,0]
v_bfe_u32 v184, v185, 2, 14
v_rcp_f16_sdwa v154, v153 dst_sel:WORD_1 dst_unused:UNUSED_PRESERVE src0_sel:WORD_1
v_rcp_f16_sdwa v151, v150 dst_sel:WORD_1 dst_unused:UNUSED_PRESERVE src0_sel:WORD_1
v_rsq_f32 v170, v170
s_waitcnt lgkmcnt(4)
ds_read_b128 v[220:223], v249 offset:20480
ds_read_b32 v247, v253 offset:16
ds_read_u16_d16 v184, v184
v_mfma_f32_32x32x16_bf16 v[120:135], v[68:71], v[224:227], v[120:135]
v_lshrrev_b32_e64 v185, 18, v185
v_rcp_f16_sdwa v148, v147 dst_sel:WORD_1 dst_unused:UNUSED_PRESERVE src0_sel:WORD_1
v_and_b32_e64 v187, s49, v187
v_fma_mix_f32 v164, v142, v142, v164 op_sel:[0,0,0] op_sel_hi:[1,1,0]
v_pk_mul_f16 v155, v155, v154
v_pk_mul_f16 v152, v152, v151
v_bfe_u32 v186, v187, 2, 14
v_mul_f32 v172, 3203391086, v170
v_pk_mul_f16 v149, v149, v148
v_fma_mix_f32 v165, v155, v155, 0 op_sel:[0,0,0] op_sel_hi:[1,1,0]
v_fma_mix_f32 v164, v143, v143, v164 op_sel:[1,1,0] op_sel_hi:[1,1,0]
v_lshrrev_b32_e64 v187, 18, v187
v_fma_mix_f32 v165, v155, v155, v165 op_sel:[1,1,0] op_sel_hi:[1,1,0]
v_mul_f32 v173, v168, v172
v_fma_mix_f32 v165, v152, v152, v165 op_sel:[0,0,0] op_sel_hi:[1,1,0]
v_fma_mix_f32 v165, v152, v152, v165 op_sel:[1,1,0] op_sel_hi:[1,1,0]
v_fma_mix_f32 v165, v149, v149, v165 op_sel:[0,0,0] op_sel_hi:[1,1,0]
v_fma_mix_f32 v165, v149, v149, v165 op_sel:[1,1,0] op_sel_hi:[1,1,0]
s_setprio 3
v_pk_fma_f32 v[0:1], v[0:1], v[172:173], v[172:173] op_sel:[0,0,1] op_sel_hi:[1,0,1] neg_lo:[0,0,1] neg_hi:[0,0,1]
v_pk_fma_f32 v[2:3], v[2:3], v[172:173], v[172:173] op_sel:[0,0,1] op_sel_hi:[1,0,1] neg_lo:[0,0,1] neg_hi:[0,0,1]
v_pk_fma_f32 v[4:5], v[4:5], v[172:173], v[172:173] op_sel:[0,0,1] op_sel_hi:[1,0,1] neg_lo:[0,0,1] neg_hi:[0,0,1]
v_pk_fma_f32 v[6:7], v[6:7], v[172:173], v[172:173] op_sel:[0,0,1] op_sel_hi:[1,0,1] neg_lo:[0,0,1] neg_hi:[0,0,1]
v_pk_fma_f32 v[8:9], v[8:9], v[172:173], v[172:173] op_sel:[0,0,1] op_sel_hi:[1,0,1] neg_lo:[0,0,1] neg_hi:[0,0,1]
v_pk_fma_f32 v[10:11], v[10:11], v[172:173], v[172:173] op_sel:[0,0,1] op_sel_hi:[1,0,1] neg_lo:[0,0,1] neg_hi:[0,0,1]
v_pk_fma_f32 v[12:13], v[12:13], v[172:173], v[172:173] op_sel:[0,0,1] op_sel_hi:[1,0,1] neg_lo:[0,0,1] neg_hi:[0,0,1]
v_pk_fma_f32 v[14:15], v[14:15], v[172:173], v[172:173] op_sel:[0,0,1] op_sel_hi:[1,0,1] neg_lo:[0,0,1] neg_hi:[0,0,1]
v_pk_fma_f32 v[16:17], v[16:17], v[172:173], v[172:173] op_sel:[0,0,1] op_sel_hi:[1,0,1] neg_lo:[0,0,1] neg_hi:[0,0,1]
v_pk_fma_f32 v[18:19], v[18:19], v[172:173], v[172:173] op_sel:[0,0,1] op_sel_hi:[1,0,1] neg_lo:[0,0,1] neg_hi:[0,0,1]
v_pk_fma_f32 v[20:21], v[20:21], v[172:173], v[172:173] op_sel:[0,0,1] op_sel_hi:[1,0,1] neg_lo:[0,0,1] neg_hi:[0,0,1]
v_pk_fma_f32 v[22:23], v[22:23], v[172:173], v[172:173] op_sel:[0,0,1] op_sel_hi:[1,0,1] neg_lo:[0,0,1] neg_hi:[0,0,1]
v_pk_fma_f32 v[24:25], v[24:25], v[172:173], v[172:173] op_sel:[0,0,1] op_sel_hi:[1,0,1] neg_lo:[0,0,1] neg_hi:[0,0,1]
v_pk_fma_f32 v[26:27], v[26:27], v[172:173], v[172:173] op_sel:[0,0,1] op_sel_hi:[1,0,1] neg_lo:[0,0,1] neg_hi:[0,0,1]
v_pk_fma_f32 v[28:29], v[28:29], v[172:173], v[172:173] op_sel:[0,0,1] op_sel_hi:[1,0,1] neg_lo:[0,0,1] neg_hi:[0,0,1]
v_pk_fma_f32 v[30:31], v[30:31], v[172:173], v[172:173] op_sel:[0,0,1] op_sel_hi:[1,0,1] neg_lo:[0,0,1] neg_hi:[0,0,1]
v_pk_fma_f32 v[32:33], v[32:33], v[172:173], v[172:173] op_sel:[0,0,1] op_sel_hi:[1,0,1] neg_lo:[0,0,1] neg_hi:[0,0,1]
v_pk_fma_f32 v[34:35], v[34:35], v[172:173], v[172:173] op_sel:[0,0,1] op_sel_hi:[1,0,1] neg_lo:[0,0,1] neg_hi:[0,0,1]
v_pk_fma_f32 v[36:37], v[36:37], v[172:173], v[172:173] op_sel:[0,0,1] op_sel_hi:[1,0,1] neg_lo:[0,0,1] neg_hi:[0,0,1]
v_pk_fma_f32 v[38:39], v[38:39], v[172:173], v[172:173] op_sel:[0,0,1] op_sel_hi:[1,0,1] neg_lo:[0,0,1] neg_hi:[0,0,1]
v_pk_fma_f32 v[40:41], v[40:41], v[172:173], v[172:173] op_sel:[0,0,1] op_sel_hi:[1,0,1] neg_lo:[0,0,1] neg_hi:[0,0,1]
v_pk_fma_f32 v[42:43], v[42:43], v[172:173], v[172:173] op_sel:[0,0,1] op_sel_hi:[1,0,1] neg_lo:[0,0,1] neg_hi:[0,0,1]
v_pk_fma_f32 v[44:45], v[44:45], v[172:173], v[172:173] op_sel:[0,0,1] op_sel_hi:[1,0,1] neg_lo:[0,0,1] neg_hi:[0,0,1]
v_pk_fma_f32 v[46:47], v[46:47], v[172:173], v[172:173] op_sel:[0,0,1] op_sel_hi:[1,0,1] neg_lo:[0,0,1] neg_hi:[0,0,1]
s_setprio 2
ds_read_u16_d16_hi v185, v185
ds_read_u16_d16 v186, v186
ds_read_u16_d16_hi v187, v187
s_waitcnt lgkmcnt(3)
v_readfirstlane_b32 s43, v247
s_nop 1
s_cmp_ge_u32 s43, 16
s_cbranch_scc1 Lev5
Lev5w:
s_sleep 1
ds_read_b32 v247, v253 offset:16
s_waitcnt lgkmcnt(0)
v_readfirstlane_b32 s43, v247
s_cmp_eq_u32 s76, 0
s_cbranch_scc1 Lev5
s_sub_u32 s76, s76, 1
s_cmp_lt_u32 s43, 16
s_cbranch_scc1 Lev5w
Lev5:
s_setprio 1
v_cvt_pkrtz_f16_f32 v137, v120, v121
v_cvt_pkrtz_f16_f32 v139, v122, v123
v_cvt_pkrtz_f16_f32 v141, v124, v125
v_cvt_pkrtz_f16_f32 v143, v126, v127
v_cvt_pkrtz_f16_f32 v177, v128, v129
v_cvt_pk_f16_f32 v155, v130, v131
v_cvt_pk_f16_f32 v152, v132, v133
v_cvt_pk_f16_f32 v149, v134, v135
s_add_u32 m0, s67, 53248
s_add_u32 s66, s66, 98304
buffer_load_dwordx4 v240, s[4:7], s66 offen lds
ds_read_b128 v[224:227], v249 offset:23552
v_mfma_f32_32x32x16_bf16 v[120:135], v[48:51], v[228:231], 0
v_pk_fma_f16 v154, v155, v155, s48
v_cvt_pk_bf16_f32 v72, v0, v1
v_and_b32 v137, s49, v137
v_fma_mix_f32 v165, v178, v178, v165 op_sel:[0,0,0] op_sel_hi:[1,1,0]
v_cvt_pk_bf16_f32 v73, v2, v3
v_pk_fma_f16 v151, v152, v152, s48
v_pk_fma_f16 v148, v149, v149, s48
v_bfe_u32 v136, v137, 2, 14
v_cvt_pk_bf16_f32 v74, v4, v5
v_pk_mul_f16 v154, v155, v154
v_pk_mul_f16 v151, v152, v151
v_fma_mix_f32 v165, v179, v179, v165 op_sel:[1,1,0] op_sel_hi:[1,1,0]
v_cvt_pk_bf16_f32 v75, v6, v7
v_lshrrev_b32_e64 v137, 18, v137
s_add_u32 m0, s67, 59904
s_add_u32 s66, s66, 98304
buffer_load_dwordx4 v240, s[4:7], s66 offen lds
ds_read_b128 v[228:231], v248 offset:16384
ds_read_u16_d16 v136, v136
ds_read_u16_d16_hi v137, v137
v_mfma_f32_32x32x16_bf16 v[120:135], v[52:55], v[232:235], v[120:135]
v_pk_mul_f16 v148, v149, v148
v_exp_f16_e64 v153, v154
v_cvt_pk_bf16_f32 v76, v8, v9
v_exp_f16_e64 v150, v151
v_cvt_pk_bf16_f32 v77, v10, v11
v_and_b32_e64 v139, s49, v139
v_fma_mix_f32 v165, v180, v180, v165 op_sel:[0,0,0] op_sel_hi:[1,1,0]
v_cvt_pk_bf16_f32 v78, v12, v13
v_exp_f16 v147, v148
v_bfe_u32 v138, v139, 2, 14
v_cvt_pk_bf16_f32 v79, v14, v15
s_add_u32 m0, s67, 0
s_add_u32 s66, s66, 98304
buffer_load_dwordx4 v240, s[4:7], s66 offen lds
ds_read_b128 v[232:235], v248 offset:19456
ds_read_u16_d16 v138, v138
v_mfma_f32_32x32x16_bf16 v[120:135], v[56:59], v[236:239], v[120:135]
v_exp_f16_sdwa v153, v154 dst_sel:WORD_1 dst_unused:UNUSED_PRESERVE src0_sel:WORD_1
v_lshrrev_b32_e64 v139, 18, v139
v_cvt_pk_bf16_f32 v80, v16, v17
v_fma_mix_f32 v165, v181, v181, v165 op_sel:[1,1,0] op_sel_hi:[1,1,0]
v_exp_f16_sdwa v150, v151 dst_sel:WORD_1 dst_unused:UNUSED_PRESERVE src0_sel:WORD_1
v_cvt_pk_bf16_f32 v81, v18, v19
v_exp_f16_sdwa v147, v148 dst_sel:WORD_1 dst_unused:UNUSED_PRESERVE src0_sel:WORD_1
v_cvt_pk_bf16_f32 v82, v20, v21
v_and_b32_e64 v141, s49, v141
v_fma_mix_f32 v165, v182, v182, v165 op_sel:[0,0,0] op_sel_hi:[1,1,0]
v_pk_add_f16 v153, v153, 1.0 op_sel_hi:[1,0]
s_add_u32 m0, s67, 6656
s_add_u32 s66, s66, 98304
buffer_load_dwordx4 v240, s[4:7], s66 offen lds
s_add_u32 m0, s67, 13312
s_add_u32 s66, s66, 98304
buffer_load_dwordx4 v240, s[4:7], s66 offen lds
ds_read_b128 v[236:239], v248 offset:17408
ds_read_u16_d16_hi v139, v139
v_mfma_f32_32x32x16_bf16 v[120:135], v[60:63], v[216:219], v[120:135]
v_cvt_pk_bf16_f32 v83, v22, v23
v_bfe_u32 v140, v141, 2, 14
v_pk_add_f16 v150, v150, 1.0 op_sel_hi:[1,0]
v_pk_add_f16 v147, v147, 1.0 op_sel_hi:[1,0]
v_cvt_pk_bf16_f32 v84, v24, v25
v_rcp_f16 v154, v153
v_lshrrev_b32 v141, 18, v141
v_cvt_pk_bf16_f32 v85, v26, v27
v_fma_mix_f32 v165, v183, v183, v165 op_sel:[1,1,0] op_sel_hi:[1,1,0]
v_rcp_f16_e64 v151, v150
v_cvt_pk_bf16_f32 v86, v28, v29
v_and_b32_e64 v143, s49, v143
s_add_u32 m0, s67, 19968
s_add_u32 s66, s66, 98304
buffer_load_dwordx4 v240, s[4:7], s66 offen lds
ds_read_b128 v[216:219], v248 offset:20480
ds_read_u16_d16 v140, v140
ds_read_u16_d16_hi v141, v141
v_mfma_f32_32x32x16_bf16 v[120:135], v[64:67], v[220:223], v[120:135]
v_rcp_f16 v148, v147
v_cvt_pk_bf16_f32 v87, v30, v31
v_fma_mix_f32 v165, v184, v184, v165 op_sel:[0,0,0] op_sel_hi:[1,1,0]
v_bfe_u32 v142, v143, 2, 14
v_cvt_pk_bf16_f32 v88, v32, v33
s_setprio 0
v_rcp_f16_sdwa v154, v153 dst_sel:WORD_1 dst_unused:UNUSED_PRESERVE src0_sel:WORD_1
v_rcp_f16_sdwa v151, v150 dst_sel:WORD_1 dst_unused:UNUSED_PRESERVE src0_sel:WORD_1
v_cvt_pk_bf16_f32 v89, v34, v35
v_lshrrev_b32 v143, 18, v143
s_waitcnt lgkmcnt(3)
v_fma_mix_f32 v165, v185, v185, v165 op_sel:[1,1,0] op_sel_hi:[1,1,0]
v_cvt_pk_bf16_f32 v90, v36, v37
s_add_u32 m0, s67, 26624
s_add_u32 s66, s66, 98304
buffer_load_dwordx4 v240, s[4:7], s66 offen lds
ds_read_b128 v[220:223], v248 offset:18432
ds_read_u16_d16 v142, v142
ds_read_u16_d16_hi v143, v143
v_mfma_f32_32x32x16_bf16 v[120:135], v[68:71], v[224:227], v[120:135]
v_rcp_f16_sdwa v148, v147 dst_sel:WORD_1 dst_unused:UNUSED_PRESERVE src0_sel:WORD_1
v_and_b32_e64 v177, s49, v177
v_cvt_pk_bf16_f32 v91, v38, v39
v_pk_mul_f16 v155, v155, v154
v_fma_mix_f32 v165, v186, v186, v165 op_sel:[0,0,0] op_sel_hi:[1,1,0]
v_cvt_pk_bf16_f32 v92, v40, v41
v_pk_mul_f16 v152, v152, v151
v_bfe_u32 v176, v177, 2, 14
v_pk_mul_f16 v149, v149, v148
v_cvt_pk_bf16_f32 v93, v42, v43
v_fma_mix_f32 v166, v155, v155, 0 op_sel:[0,0,0] op_sel_hi:[1,1,0]
v_fma_mix_f32 v166, v155, v155, v166 op_sel:[1,1,0] op_sel_hi:[1,1,0]
v_lshrrev_b32 v177, 18, v177
s_add_u32 m0, s67, 33280
s_add_u32 s66, s66, 98304
buffer_load_dwordx4 v240, s[4:7], s66 offen lds
v_cvt_pk_bf16_f32 v94, v44, v45
v_fma_mix_f32 v165, v187, v187, v165 op_sel:[1,1,0] op_sel_hi:[1,1,0]
v_fma_mix_f32 v166, v152, v152, v166 op_sel:[0,0,0] op_sel_hi:[1,1,0]
v_fma_mix_f32 v166, v152, v152, v166 op_sel:[1,1,0] op_sel_hi:[1,1,0]
v_cvt_pk_bf16_f32 v95, v46, v47
v_fma_mix_f32 v166, v149, v149, v166 op_sel:[0,0,0] op_sel_hi:[1,1,0]
v_fma_mix_f32 v166, v149, v149, v166 op_sel:[1,1,0] op_sel_hi:[1,1,0]
s_setprio 2
v_cvt_pkrtz_f16_f32 v179, v120, v121
v_cvt_pkrtz_f16_f32 v181, v122, v123
v_cvt_pkrtz_f16_f32 v183, v124, v125
v_cvt_pkrtz_f16_f32 v185, v126, v127
v_cvt_pkrtz_f16_f32 v187, v128, v129
v_cvt_pk_f16_f32 v155, v130, v131
v_cvt_pk_f16_f32 v152, v132, v133
v_cvt_pk_f16_f32 v149, v134, v135
ds_read_b128 v[224:227], v248 offset:21504
ds_read_u16_d16 v176, v176
ds_read_u16_d16_hi v177, v177
v_mfma_f32_32x32x16_bf16 v[120:135], v[72:75], v[228:231], 0
v_pk_fma_f16 v154, v155, v155, s48
v_and_b32_e64 v179, s49, v179
v_fma_mix_f32 v166, v136, v136, v166 op_sel:[0,0,0] op_sel_hi:[1,1,0]
v_pk_fma_f16 v151, v152, v152, s48
v_pk_fma_f16 v148, v149, v149, s48
v_bfe_u32 v178, v179, 2, 14
v_pk_mul_f16 v154, v155, v154
v_pk_mul_f16 v151, v152, v151
v_fma_mix_f32 v166, v137, v137, v166 op_sel:[1,1,0] op_sel_hi:[1,1,0]
v_lshrrev_b32_e64 v179, 18, v179
ds_read_b128 v[228:231], v248 offset:22528
ds_read_u16_d16 v178, v178
ds_read_u16_d16_hi v179, v179
v_mfma_f32_32x32x16_bf16 v[120:135], v[76:79], v[232:235], v[120:135]
v_pk_mul_f16 v148, v149, v148
v_exp_f16 v153, v154
v_exp_f16 v150, v151
v_and_b32_e64 v181, s49, v181
v_fma_mix_f32 v166, v138, v138, v166 op_sel:[0,0,0] op_sel_hi:[1,1,0]
v_exp_f16_e64 v147, v148
v_bfe_u32 v180, v181, 2, 14
ds_read_b128 v[232:235], v248 offset:25600
ds_read_u16_d16 v180, v180
v_mfma_f32_32x32x16_bf16 v[120:135], v[80:83], v[236:239], v[120:135]
v_exp_f16_sdwa v153, v154 dst_sel:WORD_1 dst_unused:UNUSED_PRESERVE src0_sel:WORD_1
v_lshrrev_b32_e64 v181, 18, v181
v_fma_mix_f32 v166, v139, v139, v166 op_sel:[1,1,0] op_sel_hi:[1,1,0]
v_exp_f16_sdwa v150, v151 dst_sel:WORD_1 dst_unused:UNUSED_PRESERVE src0_sel:WORD_1
v_exp_f16_sdwa v147, v148 dst_sel:WORD_1 dst_unused:UNUSED_PRESERVE src0_sel:WORD_1
v_and_b32 v183, s49, v183
s_waitcnt lgkmcnt(5)
v_fma_mix_f32 v166, v140, v140, v166 op_sel:[0,0,0] op_sel_hi:[1,1,0]
ds_read_b128 v[236:239], v248 offset:23552
ds_read_u16_d16_hi v181, v181
v_mfma_f32_32x32x16_bf16 v[120:135], v[84:87], v[216:219], v[120:135]
v_pk_add_f16 v153, v153, 1.0 op_sel_hi:[1,0]
v_bfe_u32 v182, v183, 2, 14
v_pk_add_f16 v150, v150, 1.0 op_sel_hi:[1,0]
v_pk_add_f16 v147, v147, 1.0 op_sel_hi:[1,0]
v_rcp_f16 v154, v153
v_lshrrev_b32 v183, 18, v183
v_fma_mix_f32 v166, v141, v141, v166 op_sel:[1,1,0] op_sel_hi:[1,1,0]
v_rcp_f16_e64 v151, v150
ds_read_b128 v[216:219], v248 offset:26624
ds_read_u16_d16 v182, v182
ds_read_u16_d16_hi v183, v183
v_mfma_f32_32x32x16_bf16 v[120:135], v[88:91], v[220:223], v[120:135]
v_and_b32 v185, s49, v185
v_rcp_f16 v148, v147
v_fma_mix_f32 v166, v142, v142, v166 op_sel:[0,0,0] op_sel_hi:[1,1,0]
v_bfe_u32 v184, v185, 2, 14
v_rcp_f16_sdwa v154, v153 dst_sel:WORD_1 dst_unused:UNUSED_PRESERVE src0_sel:WORD_1
v_rcp_f16_sdwa v151, v150 dst_sel:WORD_1 dst_unused:UNUSED_PRESERVE src0_sel:WORD_1
v_lshrrev_b32_e64 v185, 18, v185
ds_read_b128 v[220:223], v248 offset:24576
ds_read_u16_d16 v184, v184
ds_read_u16_d16_hi v185, v185
v_mfma_f32_32x32x16_bf16 v[120:135], v[92:95], v[224:227], v[120:135]
v_fma_mix_f32 v166, v143, v143, v166 op_sel:[1,1,0] op_sel_hi:[1,1,0]
v_rcp_f16_sdwa v148, v147 dst_sel:WORD_1 dst_unused:UNUSED_PRESERVE src0_sel:WORD_1
s_cmp_eq_u32 s40, 7
s_cbranch_scc1 Lrdy16
s_waitcnt vmcnt(0)
Lrdy16:
s_mov_b64 exec, 1
ds_add_u32 v253, v254 offset:12
s_mov_b64 exec, -1
v_and_b32 v187, s49, v187
v_pk_mul_f16 v155, v155, v154
v_fma_mix_f32 v166, v176, v176, v166 op_sel:[0,0,0] op_sel_hi:[1,1,0]
v_pk_mul_f16 v152, v152, v151
v_bfe_u32 v186, v187, 2, 14
v_pk_mul_f16 v149, v149, v148
v_fma_mix_f32 v167, v155, v155, 0 op_sel:[0,0,0] op_sel_hi:[1,1,0]
v_fma_mix_f32 v167, v155, v155, v167 op_sel:[1,1,0] op_sel_hi:[1,1,0]
v_lshrrev_b32_e64 v187, 18, v187
v_fma_mix_f32 v166, v177, v177, v166 op_sel:[1,1,0] op_sel_hi:[1,1,0]
v_fma_mix_f32 v167, v152, v152, v167 op_sel:[0,0,0] op_sel_hi:[1,1,0]
v_fma_mix_f32 v167, v152, v152, v167 op_sel:[1,1,0] op_sel_hi:[1,1,0]
v_fma_mix_f32 v167, v149, v149, v167 op_sel:[0,0,0] op_sel_hi:[1,1,0]
v_fma_mix_f32 v167, v149, v149, v167 op_sel:[1,1,0] op_sel_hi:[1,1,0]
s_setprio 1
v_cvt_pkrtz_f16_f32 v137, v120, v121
v_cvt_pkrtz_f16_f32 v139, v122, v123
v_cvt_pkrtz_f16_f32 v141, v124, v125
v_cvt_pkrtz_f16_f32 v143, v126, v127
v_cvt_pkrtz_f16_f32 v177, v128, v129
v_cvt_pk_f16_f32 v155, v130, v131
v_cvt_pk_f16_f32 v152, v132, v133
v_cvt_pk_f16_f32 v149, v134, v135
s_waitcnt lgkmcnt(1)
ds_read_b128 v[224:227], v248 offset:27648
ds_read_u16_d16 v186, v186
ds_read_u16_d16_hi v187, v187
v_mfma_f32_32x32x16_bf16 v[120:135], v[72:75], v[228:231], 0
v_pk_fma_f16 v154, v155, v155, s48
v_and_b32_e64 v137, s49, v137
v_fma_mix_f32 v167, v178, v178, v167 op_sel:[0,0,0] op_sel_hi:[1,1,0]
v_pk_fma_f16 v151, v152, v152, s48
v_pk_fma_f16 v148, v149, v149, s48
v_bfe_u32 v136, v137, 2, 14
v_pk_mul_f16 v154, v155, v154
v_pk_mul_f16 v151, v152, v151
v_fma_mix_f32 v167, v179, v179, v167 op_sel:[1,1,0] op_sel_hi:[1,1,0]
v_lshrrev_b32_e64 v137, 18, v137
ds_read_b128 v[228:231], v250 offset:65520
ds_read_u16_d16 v136, v136
ds_read_u16_d16_hi v137, v137
v_mfma_f32_32x32x16_bf16 v[120:135], v[76:79], v[232:235], v[120:135]
v_pk_mul_f16 v148, v149, v148
v_exp_f16 v153, v154
v_exp_f16 v150, v151
v_and_b32_e64 v139, s49, v139
v_fma_mix_f32 v167, v180, v180, v167 op_sel:[0,0,0] op_sel_hi:[1,1,0]
v_exp_f16_e64 v147, v148
v_bfe_u32 v138, v139, 2, 14
ds_read_b128 v[232:235], v248 offset:28672
ds_read_b32 v247, v253 offset:12
ds_read_u16_d16 v138, v138
v_mfma_f32_32x32x16_bf16 v[120:135], v[80:83], v[236:239], v[120:135]
v_exp_f16_sdwa v153, v154 dst_sel:WORD_1 dst_unused:UNUSED_PRESERVE src0_sel:WORD_1
v_lshrrev_b32_e64 v139, 18, v139
v_fma_mix_f32 v167, v181, v181, v167 op_sel:[1,1,0] op_sel_hi:[1,1,0]
v_exp_f16_sdwa v150, v151 dst_sel:WORD_1 dst_unused:UNUSED_PRESERVE src0_sel:WORD_1
v_exp_f16_sdwa v147, v148 dst_sel:WORD_1 dst_unused:UNUSED_PRESERVE src0_sel:WORD_1
v_and_b32_e64 v141, s49, v141
v_fma_mix_f32 v167, v182, v182, v167 op_sel:[0,0,0] op_sel_hi:[1,1,0]
ds_read_b128 v[236:239], v248 offset:31744
ds_read_u16_d16_hi v139, v139
v_mfma_f32_32x32x16_bf16 v[120:135], v[84:87], v[216:219], v[120:135]
v_pk_add_f16 v153, v153, 1.0 op_sel_hi:[1,0]
v_bfe_u32 v140, v141, 2, 14
v_pk_add_f16 v150, v150, 1.0 op_sel_hi:[1,0]
v_pk_add_f16 v147, v147, 1.0 op_sel_hi:[1,0]
v_rcp_f16 v154, v153
v_lshrrev_b32 v141, 18, v141
ds_read_u16_d16 v140, v140
ds_read_u16_d16_hi v141, v141
s_waitcnt lgkmcnt(5)
v_readfirstlane_b32 s43, v247
s_nop 1
s_cmp_ge_u32 s43, 24
s_cbranch_scc1 Lev6
Lev6w:
s_sleep 1
ds_read_b32 v247, v253 offset:12
s_waitcnt lgkmcnt(0)
v_readfirstlane_b32 s43, v247
s_cmp_eq_u32 s76, 0
s_cbranch_scc1 Lev6
s_sub_u32 s76, s76, 1
s_cmp_lt_u32 s43, 24
s_cbranch_scc1 Lev6w
Lev6:
v_fma_mix_f32 v167, v183, v183, v167 op_sel:[1,1,0] op_sel_hi:[1,1,0]
v_rcp_f16 v151, v150
ds_read_b128 v[216:219], v248 offset:29696
v_mfma_f32_32x32x16_bf16 v[120:135], v[88:91], v[220:223], v[120:135]
v_and_b32 v143, s49, v143
v_rcp_f16 v148, v147
v_fma_mix_f32 v167, v184, v184, v167 op_sel:[0,0,0] op_sel_hi:[1,1,0]
v_bfe_u32 v142, v143, 2, 14
s_setprio 0
v_rcp_f16_sdwa v154, v153 dst_sel:WORD_1 dst_unused:UNUSED_PRESERVE src0_sel:WORD_1
v_rcp_f16_sdwa v151, v150 dst_sel:WORD_1 dst_unused:UNUSED_PRESERVE src0_sel:WORD_1
v_lshrrev_b32 v143, 18, v143
ds_read_b128 v[220:223], v245
ds_read_b128 v[192:195], v242
ds_read_b128 v[196:199], v242 offset:64
ds_read_u16_d16 v142, v142
ds_read_u16_d16_hi v143, v143
v_mfma_f32_32x32x16_bf16 v[120:135], v[92:95], v[224:227], v[120:135]
v_fma_mix_f32 v167, v185, v185, v167 op_sel:[1,1,0] op_sel_hi:[1,1,0]
v_rcp_f16_sdwa v148, v147 dst_sel:WORD_1 dst_unused:UNUSED_PRESERVE src0_sel:WORD_1
v_and_b32_e64 v177, s49, v177
v_pk_mul_f16 v155, v155, v154
v_fma_mix_f32 v167, v186, v186, v167 op_sel:[0,0,0] op_sel_hi:[1,1,0]
v_pk_mul_f16 v152, v152, v151
v_bfe_u32 v176, v177, 2, 14
v_pk_mul_f16 v149, v149, v148
v_fma_mix_f32 v156, v155, v155, v156 op_sel:[0,0,0] op_sel_hi:[1,1,0]
v_fma_mix_f32 v156, v155, v155, v156 op_sel:[1,1,0] op_sel_hi:[1,1,0]
v_lshrrev_b32 v177, 18, v177
v_fma_mix_f32 v167, v187, v187, v167 op_sel:[1,1,0] op_sel_hi:[1,1,0]
v_fma_mix_f32 v156, v152, v152, v156 op_sel:[0,0,0] op_sel_hi:[1,1,0]
v_fma_mix_f32 v156, v152, v152, v156 op_sel:[1,1,0] op_sel_hi:[1,1,0]
v_fma_mix_f32 v156, v149, v149, v156 op_sel:[0,0,0] op_sel_hi:[1,1,0]
v_fma_mix_f32 v156, v149, v149, v156 op_sel:[1,1,0] op_sel_hi:[1,1,0]
s_setprio 2
v_mfma_f32_32x32x16_bf16 v[0:15], v[228:231], v[228:231], 0
buffer_store_dwordx4 v[48:51], v241, s[32:35], s80 offen sc1
ds_read_b128 v[224:227], v248 offset:32768
ds_read_u16_d16 v176, v176
ds_read_u16_d16_hi v177, v177
v_cvt_pkrtz_f16_f32 v179, v120, v121
v_cvt_pkrtz_f16_f32 v181, v122, v123
v_cvt_pkrtz_f16_f32 v183, v124, v125
v_mfma_f32_32x32x16_bf16 v[16:31], v[228:231], v[228:231], 0
v_cvt_pkrtz_f16_f32 v185, v126, v127
v_cvt_pkrtz_f16_f32 v187, v128, v129
v_cvt_pk_f16_f32 v155, v130, v131
v_cvt_pk_f16_f32 v152, v132, v133
v_mfma_f32_32x32x16_bf16 v[32:47], v[228:231], v[228:231], 0
v_cvt_pk_f16_f32 v149, v134, v135
v_pk_fma_f16 v154, v155, v155, s48
v_and_b32_e64 v179, s49, v179
v_mfma_f32_32x32x16_bf16 v[120:135], v[72:75], v[232:235], 0
ds_read_b128 v[228:231], v248 offset:30720
v_fma_mix_f32 v156, v136, v136, v156 op_sel:[0,0,0] op_sel_hi:[1,1,0]
v_pk_fma_f16 v151, v152, v152, s48
v_pk_fma_f16 v148, v149, v149, s48
v_bfe_u32 v178, v179, 2, 14
v_pk_mul_f16 v154, v155, v154
v_pk_mul_f16 v151, v152, v151
v_fma_mix_f32 v156, v137, v137, v156 op_sel:[1,1,0] op_sel_hi:[1,1,0]
s_waitcnt lgkmcnt(4)
v_mfma_f32_32x32x16_bf16 v[120:135], v[76:79], v[236:239], v[120:135]
ds_read_b128 v[232:235], v245 offset:384
ds_read_b128 v[200:203], v242 offset:128
ds_read_b128 v[204:207], v243
ds_read_u16_d16 v178, v178
v_lshrrev_b32 v179, 18, v179
v_pk_mul_f16 v148, v149, v148
v_exp_f16 v153, v154
v_exp_f16 v150, v151
v_and_b32_e64 v181, s49, v181
v_fma_mix_f32 v156, v138, v138, v156 op_sel:[0,0,0] op_sel_hi:[1,1,0]
v_mfma_f32_32x32x16_bf16 v[120:135], v[80:83], v[216:219], v[120:135]
ds_read_b128 v[236:239], v248 offset:33792
ds_read_u16_d16_hi v179, v179
v_exp_f16_e64 v147, v148
v_bfe_u32 v180, v181, 2, 14
v_exp_f16_sdwa v153, v154 dst_sel:WORD_1 dst_unused:UNUSED_PRESERVE src0_sel:WORD_1
v_lshrrev_b32_e64 v181, 18, v181
v_fma_mix_f32 v156, v139, v139, v156 op_sel:[1,1,0] op_sel_hi:[1,1,0]
v_smfmac_f32_16x16x32_bf16 v[0:3], v[220:221], v[192:195], v246
ds_read_b128 v[216:219], v245 offset:768
ds_read_b128 v[208:211], v243 offset:64
ds_read_b128 v[212:215], v243 offset:128
ds_read_u16_d16 v180, v180
ds_read_u16_d16_hi v181, v181
v_exp_f16_sdwa v150, v151 dst_sel:WORD_1 dst_unused:UNUSED_PRESERVE src0_sel:WORD_1
v_smfmac_f32_16x16x32_bf16 v[16:19], v[222:223], v[196:199], v246
v_exp_f16_sdwa v147, v148 dst_sel:WORD_1 dst_unused:UNUSED_PRESERVE src0_sel:WORD_1
v_and_b32 v183, s49, v183
v_fma_mix_f32 v156, v140, v140, v156 op_sel:[0,0,0] op_sel_hi:[1,1,0]
v_pk_add_f16 v153, v153, 1.0 op_sel_hi:[1,0]
s_waitcnt lgkmcnt(7)
v_mfma_f32_32x32x16_bf16 v[120:135], v[84:87], v[224:227], v[120:135]
ds_read_b128 v[220:223], v245 offset:1152
ds_read_b128 v[192:195], v244
ds_read_b128 v[196:199], v244 offset:64
v_bfe_u32 v182, v183, 2, 14
v_pk_add_f16 v150, v150, 1.0 op_sel_hi:[1,0]
v_pk_add_f16 v147, v147, 1.0 op_sel_hi:[1,0]
v_rcp_f16 v154, v153
v_lshrrev_b32 v183, 18, v183
v_fma_mix_f32 v156, v141, v141, v156 op_sel:[1,1,0] op_sel_hi:[1,1,0]
v_mfma_f32_32x32x16_bf16 v[120:135], v[88:91], v[228:231], v[120:135]
ds_read_b128 v[224:227], v248 offset:34816
ds_read_u16_d16 v182, v182
ds_read_u16_d16_hi v183, v183
v_rcp_f16 v151, v150
v_and_b32 v185, s49, v185
v_rcp_f16_e64 v148, v147
v_fma_mix_f32 v156, v142, v142, v156 op_sel:[0,0,0] op_sel_hi:[1,1,0]
v_bfe_u32 v184, v185, 2, 14
v_smfmac_f32_16x16x32_bf16 v[32:35], v[232:233], v[200:203], v246
ds_read_b128 v[228:231], v248 offset:37888
ds_read_u16_d16 v184, v184
v_rcp_f16_sdwa v154, v153 dst_sel:WORD_1 dst_unused:UNUSED_PRESERVE src0_sel:WORD_1
v_rcp_f16_sdwa v151, v150 dst_sel:WORD_1 dst_unused:UNUSED_PRESERVE src0_sel:WORD_1
v_smfmac_f32_16x16x32_bf16 v[0:3], v[234:235], v[204:207], v246
v_lshrrev_b32 v185, 18, v185
v_fma_mix_f32 v156, v143, v143, v156 op_sel:[1,1,0] op_sel_hi:[1,1,0]
s_waitcnt lgkmcnt(6)
v_mfma_f32_32x32x16_bf16 v[120:135], v[92:95], v[236:239], v[120:135]
ds_read_b128 v[232:235], v248 offset:35840
ds_read_u16_d16_hi v185, v185
v_rcp_f16_sdwa v148, v147 dst_sel:WORD_1 dst_unused:UNUSED_PRESERVE src0_sel:WORD_1
v_and_b32_e64 v187, s49, v187
v_pk_mul_f16 v155, v155, v154
v_fma_mix_f32 v156, v176, v176, v156 op_sel:[0,0,0] op_sel_hi:[1,1,0]
v_pk_mul_f16 v152, v152, v151
v_bfe_u32 v186, v187, 2, 14
v_pk_mul_f16 v149, v149, v148
v_smfmac_f32_16x16x32_bf16 v[16:19], v[216:217], v[208:211], v246
ds_read_b128 v[236:239], v248 offset:38912
ds_read_u16_d16 v186, v186
v_fma_mix_f32 v157, v155, v155, v157 op_sel:[0,0,0] op_sel_hi:[1,1,0]
v_fma_mix_f32 v157, v155, v155, v157 op_sel:[1,1,0] op_sel_hi:[1,1,0]
v_lshrrev_b32_e64 v187, 18, v187
v_fma_mix_f32 v156, v177, v177, v156 op_sel:[1,1,0] op_sel_hi:[1,1,0]
v_smfmac_f32_16x16x32_bf16 v[32:35], v[218:219], v[212:215], v246
v_fma_mix_f32 v157, v152, v152, v157 op_sel:[0,0,0] op_sel_hi:[1,1,0]
v_fma_mix_f32 v157, v152, v152, v157 op_sel:[1,1,0] op_sel_hi:[1,1,0]
v_fma_mix_f32 v157, v149, v149, v157 op_sel:[0,0,0] op_sel_hi:[1,1,0]
v_fma_mix_f32 v157, v149, v149, v157 op_sel:[1,1,0] op_sel_hi:[1,1,0]
s_setprio 1
v_smfmac_f32_16x16x32_bf16 v[0:3], v[220:221], v[192:195], v246
s_waitcnt lgkmcnt(4)
s_add_u32 s46, s80, 2097152
buffer_store_dwordx4 v[52:55], v241, s[32:35], s46 offen sc1
ds_read_b128 v[216:219], v248 offset:36864
ds_read_u16_d16_hi v187, v187
v_cvt_pkrtz_f16_f32 v137, v120, v121
v_cvt_pkrtz_f16_f32 v139, v122, v123
v_cvt_pkrtz_f16_f32 v141, v124, v125
v_cvt_pkrtz_f16_f32 v143, v126, v127
v_cvt_pk_f16_f32 v155, v128, v129
v_smfmac_f32_16x16x32_bf16 v[16:19], v[222:223], v[196:199], v246
v_cvt_pk_f16_f32 v152, v130, v131
v_cvt_pk_f16_f32 v149, v132, v133
v_cvt_pk_f16_f32 v146, v134, v135
v_pk_fma_f16 v154, v155, v155, s48
v_and_b32_e64 v137, s49, v137
v_mfma_f32_32x32x16_bf16 v[120:135], v[72:75], v[224:227], 0
ds_read_b128 v[220:223], v248 offset:39936
v_fma_mix_f32 v157, v178, v178, v157 op_sel:[0,0,0] op_sel_hi:[1,1,0]
v_pk_fma_f16 v151, v152, v152, s48
v_pk_fma_f16 v148, v149, v149, s48
v_pk_fma_f16 v145, v146, v146, s48
v_pk_mul_f16 v154, v155, v154
v_bfe_u32 v136, v137, 2, 14
v_pk_mul_f16 v151, v152, v151
v_fma_mix_f32 v157, v179, v179, v157 op_sel:[1,1,0] op_sel_hi:[1,1,0]
v_pk_mul_f16 v148, v149, v148
v_pk_mul_f16 v145, v146, v145
v_mfma_f32_32x32x16_bf16 v[120:135], v[76:79], v[228:231], v[120:135]
ds_read_b128 v[224:227], v245 offset:1536
ds_read_b128 v[200:203], v244 offset:128
v_xor_b32 v242, 16, v242
ds_read_b128 v[204:207], v242
ds_read_u16_d16 v136, v136
v_exp_f16 v153, v154
v_lshrrev_b32 v137, 18, v137
v_exp_f16 v150, v151
v_fma_mix_f32 v157, v180, v180, v157 op_sel:[0,0,0] op_sel_hi:[1,1,0]
v_exp_f16 v147, v148
v_and_b32 v139, s49, v139
v_exp_f16 v144, v145
s_waitcnt lgkmcnt(5)
v_mfma_f32_32x32x16_bf16 v[120:135], v[80:83], v[232:235], v[120:135]
ds_read_b128 v[228:231], v245 offset:1920
ds_read_b128 v[208:211], v242 offset:64
ds_read_b128 v[212:215], v242 offset:128
ds_read_u16_d16_hi v137, v137
v_exp_f16_sdwa v153, v154 dst_sel:WORD_1 dst_unused:UNUSED_PRESERVE src0_sel:WORD_1
v_fma_mix_f32 v157, v181, v181, v157 op_sel:[1,1,0] op_sel_hi:[1,1,0]
v_bfe_u32 v138, v139, 2, 14
v_exp_f16_sdwa v150, v151 dst_sel:WORD_1 dst_unused:UNUSED_PRESERVE src0_sel:WORD_1
v_exp_f16_sdwa v147, v148 dst_sel:WORD_1 dst_unused:UNUSED_PRESERVE src0_sel:WORD_1
v_exp_f16_sdwa v144, v145 dst_sel:WORD_1 dst_unused:UNUSED_PRESERVE src0_sel:WORD_1
v_lshrrev_b32_e64 v139, 18, v139
v_fma_mix_f32 v157, v182, v182, v157 op_sel:[0,0,0] op_sel_hi:[1,1,0]
v_mfma_f32_32x32x16_bf16 v[120:135], v[84:87], v[236:239], v[120:135]
ds_read_b128 v[232:235], v248 offset:40960
ds_read_u16_d16 v138, v138
ds_read_u16_d16_hi v139, v139
v_pk_add_f16 v153, v153, 1.0 op_sel_hi:[1,0]
v_pk_add_f16 v150, v150, 1.0 op_sel_hi:[1,0]
v_pk_add_f16 v147, v147, 1.0 op_sel_hi:[1,0]
v_and_b32_e64 v141, s49, v141
v_pk_add_f16 v144, v144, 1.0 op_sel_hi:[1,0]
v_rcp_f16_e64 v154, v153
v_fma_mix_f32 v157, v183, v183, v157 op_sel:[1,1,0] op_sel_hi:[1,1,0]
v_rcp_f16_e64 v151, v150
v_mfma_f32_32x32x16_bf16 v[120:135], v[88:91], v[216:219], v[120:135]
ds_read_b128 v[236:239], v248 offset:44032
v_bfe_u32 v140, v141, 2, 14
v_rcp_f16_e64 v148, v147
v_fma_mix_f32 v157, v184, v184, v157 op_sel:[0,0,0] op_sel_hi:[1,1,0]
v_rcp_f16 v145, v144
v_lshrrev_b32 v141, 18, v141
v_rcp_f16_sdwa v154, v153 dst_sel:WORD_1 dst_unused:UNUSED_PRESERVE src0_sel:WORD_1
s_setprio 0
v_rcp_f16_sdwa v151, v150 dst_sel:WORD_1 dst_unused:UNUSED_PRESERVE src0_sel:WORD_1
s_waitcnt lgkmcnt(4)
v_mfma_f32_32x32x16_bf16 v[120:135], v[92:95], v[220:223], v[120:135]
ds_read_b128 v[216:219], v248 offset:41984
ds_read_u16_d16 v140, v140
ds_read_u16_d16_hi v141, v141
v_fma_mix_f32 v157, v185, v185, v157 op_sel:[1,1,0] op_sel_hi:[1,1,0]
v_and_b32_e64 v143, s49, v143
v_rcp_f16_sdwa v148, v147 dst_sel:WORD_1 dst_unused:UNUSED_PRESERVE src0_sel:WORD_1
v_rcp_f16_sdwa v145, v144 dst_sel:WORD_1 dst_unused:UNUSED_PRESERVE src0_sel:WORD_1
v_pk_mul_f16 v155, v155, v154
v_bfe_u32 v142, v143, 2, 14
v_fma_mix_f32 v157, v186, v186, v157 op_sel:[0,0,0] op_sel_hi:[1,1,0]
v_pk_mul_f16 v152, v152, v151
v_pk_mul_f16 v149, v149, v148
v_smfmac_f32_16x16x32_bf16 v[32:35], v[224:225], v[200:203], v246
ds_read_b128 v[220:223], v248 offset:45056
ds_read_u16_d16 v142, v142
v_pk_mul_f16 v146, v146, v145
v_fma_mix_f32 v158, v155, v155, v158 op_sel:[0,0,0] op_sel_hi:[1,1,0]
v_lshrrev_b32 v143, 18, v143
v_fma_mix_f32 v158, v155, v155, v158 op_sel:[1,1,0] op_sel_hi:[1,1,0]
v_fma_mix_f32 v158, v152, v152, v158 op_sel:[0,0,0] op_sel_hi:[1,1,0]
v_smfmac_f32_16x16x32_bf16 v[4:7], v[226:227], v[204:207], v246
v_fma_mix_f32 v157, v187, v187, v157 op_sel:[1,1,0] op_sel_hi:[1,1,0]
v_fma_mix_f32 v158, v152, v152, v158 op_sel:[1,1,0] op_sel_hi:[1,1,0]
v_fma_mix_f32 v158, v149, v149, v158 op_sel:[0,0,0] op_sel_hi:[1,1,0]
v_fma_mix_f32 v158, v149, v149, v158 op_sel:[1,1,0] op_sel_hi:[1,1,0]
v_fma_mix_f32 v158, v146, v146, v158 op_sel:[0,0,0] op_sel_hi:[1,1,0]
v_fma_mix_f32 v158, v146, v146, v158 op_sel:[1,1,0] op_sel_hi:[1,1,0]
s_setprio 2
v_smfmac_f32_16x16x32_bf16 v[20:23], v[228:229], v[208:211], v246
s_add_u32 s46, s80, 4194304
buffer_store_dwordx4 v[56:59], v241, s[32:35], s46 offen sc1
ds_read_b128 v[224:227], v248 offset:43008
ds_read_u16_d16_hi v143, v143
v_cvt_pkrtz_f16_f32 v179, v120, v121
v_cvt_pkrtz_f16_f32 v181, v122, v123
v_cvt_pkrtz_f16_f32 v183, v124, v125
v_cvt_pkrtz_f16_f32 v185, v126, v127
v_smfmac_f32_16x16x32_bf16 v[36:39], v[230:231], v[212:215], v246
v_cvt_pkrtz_f16_f32 v187, v128, v129
v_cvt_pk_f16_f32 v155, v130, v131
v_cvt_pk_f16_f32 v152, v132, v133
v_cvt_pk_f16_f32 v149, v134, v135
v_pk_fma_f16 v154, v155, v155, s48
s_waitcnt lgkmcnt(2)
v_mfma_f32_32x32x16_bf16 v[120:135], v[72:75], v[232:235], 0
ds_read_b128 v[228:231], v248 offset:46080
v_and_b32 v179, s49, v179
v_fma_mix_f32 v158, v136, v136, v158 op_sel:[0,0,0] op_sel_hi:[1,1,0]
v_pk_fma_f16 v151, v152, v152, s48
v_pk_fma_f16 v148, v149, v149, s48
v_bfe_u32 v178, v179, 2, 14
v_pk_mul_f16 v154, v155, v154
v_pk_mul_f16 v151, v152, v151
v_pk_mul_f16 v148, v149, v148
v_lshrrev_b32 v179, 18, v179
v_mfma_f32_32x32x16_bf16 v[120:135], v[76:79], v[236:239], v[120:135]
ds_read_b128 v[232:235], v245 offset:2304
v_xor_b32 v243, 16, v243
ds_read_b128 v[192:195], v243
ds_read_b128 v[196:199], v243 offset:64
ds_read_u16_d16 v178, v178
ds_read_u16_d16_hi v179, v179
v_fma_mix_f32 v158, v137, v137, v158 op_sel:[1,1,0] op_sel_hi:[1,1,0]
v_exp_f16 v153, v154
v_and_b32 v181, s49, v181
v_exp_f16 v150, v151
v_exp_f16 v147, v148
v_bfe_u32 v180, v181, 2, 14
v_mfma_f32_32x32x16_bf16 v[120:135], v[80:83], v[216:219], v[120:135]
ds_read_b128 v[236:239], v245 offset:2688
ds_read_b128 v[200:203], v243 offset:128
v_xor_b32 v244, 16, v244
ds_read_b128 v[204:207], v244
ds_read_u16_d16 v180, v180
v_fma_mix_f32 v158, v138, v138, v158 op_sel:[0,0,0] op_sel_hi:[1,1,0]
v_exp_f16_sdwa v153, v154 dst_sel:WORD_1 dst_unused:UNUSED_PRESERVE src0_sel:WORD_1
v_lshrrev_b32 v181, 18, v181
v_exp_f16_sdwa v150, v151 dst_sel:WORD_1 dst_unused:UNUSED_PRESERVE src0_sel:WORD_1
v_fma_mix_f32 v158, v139, v139, v158 op_sel:[1,1,0] op_sel_hi:[1,1,0]
v_and_b32_e64 v183, s49, v183
v_mfma_f32_32x32x16_bf16 v[120:135], v[84:87], v[220:223], v[120:135]
ds_read_b128 v[216:219], v248 offset:47104
ds_read_u16_d16_hi v181, v181
v_exp_f16_sdwa v147, v148 dst_sel:WORD_1 dst_unused:UNUSED_PRESERVE src0_sel:WORD_1
v_pk_add_f16 v153, v153, 1.0 op_sel_hi:[1,0]
v_bfe_u32 v182, v183, 2, 14
v_pk_add_f16 v150, v150, 1.0 op_sel_hi:[1,0]
v_pk_add_f16 v147, v147, 1.0 op_sel_hi:[1,0]
v_rcp_f16_e64 v154, v153
v_lshrrev_b32 v183, 18, v183
v_fma_mix_f32 v158, v140, v140, v158 op_sel:[0,0,0] op_sel_hi:[1,1,0]
s_waitcnt lgkmcnt(6)
v_mfma_f32_32x32x16_bf16 v[120:135], v[88:91], v[224:227], v[120:135]
ds_read_b128 v[220:223], v248 offset:50176
ds_read_u16_d16 v182, v182
ds_read_u16_d16_hi v183, v183
v_rcp_f16 v151, v150
v_and_b32 v185, s49, v185
v_rcp_f16_e64 v148, v147
v_fma_mix_f32 v158, v141, v141, v158 op_sel:[1,1,0] op_sel_hi:[1,1,0]
v_bfe_u32 v184, v185, 2, 14
v_rcp_f16_sdwa v154, v153 dst_sel:WORD_1 dst_unused:UNUSED_PRESERVE src0_sel:WORD_1
v_mfma_f32_32x32x16_bf16 v[120:135], v[92:95], v[228:231], v[120:135]
ds_read_b128 v[224:227], v248 offset:48128
ds_read_u16_d16 v184, v184
v_rcp_f16_sdwa v151, v150 dst_sel:WORD_1 dst_unused:UNUSED_PRESERVE src0_sel:WORD_1
v_lshrrev_b32_e64 v185, 18, v185
v_rcp_f16_sdwa v148, v147 dst_sel:WORD_1 dst_unused:UNUSED_PRESERVE src0_sel:WORD_1
v_and_b32_e64 v187, s49, v187
v_fma_mix_f32 v158, v142, v142, v158 op_sel:[0,0,0] op_sel_hi:[1,1,0]
v_pk_mul_f16 v155, v155, v154
v_pk_mul_f16 v152, v152, v151
v_smfmac_f32_16x16x32_bf16 v[4:7], v[232:233], v[192:195], v246
ds_read_b128 v[228:231], v248 offset:51200
ds_read_u16_d16_hi v185, v185
v_bfe_u32 v186, v187, 2, 14
v_pk_mul_f16 v149, v149, v148
v_fma_mix_f32 v159, v155, v155, v159 op_sel:[0,0,0] op_sel_hi:[1,1,0]
v_fma_mix_f32 v158, v143, v143, v158 op_sel:[1,1,0] op_sel_hi:[1,1,0]
v_lshrrev_b32_e64 v187, 18, v187
v_smfmac_f32_16x16x32_bf16 v[20:23], v[234:235], v[196:199], v246
v_fma_mix_f32 v159, v155, v155, v159 op_sel:[1,1,0] op_sel_hi:[1,1,0]
v_fma_mix_f32 v159, v152, v152, v159 op_sel:[0,0,0] op_sel_hi:[1,1,0]
v_fma_mix_f32 v159, v152, v152, v159 op_sel:[1,1,0] op_sel_hi:[1,1,0]
v_fma_mix_f32 v159, v149, v149, v159 op_sel:[0,0,0] op_sel_hi:[1,1,0]
v_fma_mix_f32 v159, v149, v149, v159 op_sel:[1,1,0] op_sel_hi:[1,1,0]
s_setprio 1
s_waitcnt lgkmcnt(4)
v_smfmac_f32_16x16x32_bf16 v[36:39], v[236:237], v[200:203], v246
s_add_u32 s46, s80, 6291456
buffer_store_dwordx4 v[60:63], v241, s[32:35], s46 offen sc1
ds_read_b128 v[232:235], v248 offset:49152
ds_read_u16_d16 v186, v186
ds_read_u16_d16_hi v187, v187
v_cvt_pkrtz_f16_f32 v137, v120, v121
v_cvt_pkrtz_f16_f32 v139, v122, v123
v_cvt_pkrtz_f16_f32 v141, v124, v125
v_cvt_pkrtz_f16_f32 v143, v126, v127
v_cvt_pk_f16_f32 v155, v128, v129
v_smfmac_f32_16x16x32_bf16 v[4:7], v[238:239], v[204:207], v246
v_cvt_pk_f16_f32 v152, v130, v131
v_cvt_pk_f16_f32 v149, v132, v133
v_cvt_pk_f16_f32 v146, v134, v135
v_pk_fma_f16 v154, v155, v155, s48
v_and_b32_e64 v137, s49, v137
v_mfma_f32_32x32x16_bf16 v[120:135], v[72:75], v[216:219], 0
ds_read_b128 v[236:239], v248 offset:52224
v_fma_mix_f32 v159, v178, v178, v159 op_sel:[0,0,0] op_sel_hi:[1,1,0]
v_pk_fma_f16 v151, v152, v152, s48
v_pk_fma_f16 v148, v149, v149, s48
v_pk_fma_f16 v145, v146, v146, s48
v_pk_mul_f16 v154, v155, v154
v_bfe_u32 v136, v137, 2, 14
v_pk_mul_f16 v151, v152, v151
v_fma_mix_f32 v159, v179, v179, v159 op_sel:[1,1,0] op_sel_hi:[1,1,0]
v_pk_mul_f16 v148, v149, v148
v_pk_mul_f16 v145, v146, v145
v_mfma_f32_32x32x16_bf16 v[120:135], v[76:79], v[220:223], v[120:135]
ds_read_b128 v[216:219], v245 offset:3072
ds_read_b128 v[208:211], v244 offset:64
ds_read_b128 v[212:215], v244 offset:128
ds_read_u16_d16 v136, v136
v_exp_f16 v153, v154
v_lshrrev_b32 v137, 18, v137
v_exp_f16_e64 v150, v151
v_fma_mix_f32 v159, v180, v180, v159 op_sel:[0,0,0] op_sel_hi:[1,1,0]
v_exp_f16 v147, v148
v_and_b32 v139, s49, v139
v_exp_f16_e64 v144, v145
s_waitcnt lgkmcnt(5)
v_mfma_f32_32x32x16_bf16 v[120:135], v[80:83], v[224:227], v[120:135]
ds_read_b128 v[220:223], v245 offset:3456
v_xor_b32 v242, 32, v242
ds_read_b128 v[192:195], v242
ds_read_b128 v[196:199], v242 offset:64
ds_read_u16_d16_hi v137, v137
v_exp_f16_sdwa v153, v154 dst_sel:WORD_1 dst_unused:UNUSED_PRESERVE src0_sel:WORD_1
v_fma_mix_f32 v159, v181, v181, v159 op_sel:[1,1,0] op_sel_hi:[1,1,0]
v_bfe_u32 v138, v139, 2, 14
v_exp_f16_sdwa v150, v151 dst_sel:WORD_1 dst_unused:UNUSED_PRESERVE src0_sel:WORD_1
v_exp_f16_sdwa v147, v148 dst_sel:WORD_1 dst_unused:UNUSED_PRESERVE src0_sel:WORD_1
v_exp_f16_sdwa v144, v145 dst_sel:WORD_1 dst_unused:UNUSED_PRESERVE src0_sel:WORD_1
v_lshrrev_b32_e64 v139, 18, v139
v_fma_mix_f32 v159, v182, v182, v159 op_sel:[0,0,0] op_sel_hi:[1,1,0]
v_mfma_f32_32x32x16_bf16 v[120:135], v[84:87], v[228:231], v[120:135]
ds_read_b128 v[224:227], v248 offset:53248
ds_read_u16_d16 v138, v138
ds_read_u16_d16_hi v139, v139
v_pk_add_f16 v153, v153, 1.0 op_sel_hi:[1,0]
v_pk_add_f16 v150, v150, 1.0 op_sel_hi:[1,0]
v_pk_add_f16 v147, v147, 1.0 op_sel_hi:[1,0]
v_and_b32_e64 v141, s49, v141
v_pk_add_f16 v144, v144, 1.0 op_sel_hi:[1,0]
v_rcp_f16_e64 v154, v153
v_fma_mix_f32 v159, v183, v183, v159 op_sel:[1,1,0] op_sel_hi:[1,1,0]
v_rcp_f16_e64 v151, v150
v_mfma_f32_32x32x16_bf16 v[120:135], v[88:91], v[232:235], v[120:135]
ds_read_b128 v[228:231], v248 offset:56320
v_bfe_u32 v140, v141, 2, 14
v_rcp_f16_e64 v148, v147
v_fma_mix_f32 v159, v184, v184, v159 op_sel:[0,0,0] op_sel_hi:[1,1,0]
v_rcp_f16 v145, v144
v_lshrrev_b32 v141, 18, v141
v_rcp_f16_sdwa v154, v153 dst_sel:WORD_1 dst_unused:UNUSED_PRESERVE src0_sel:WORD_1
s_setprio 0
v_rcp_f16_sdwa v151, v150 dst_sel:WORD_1 dst_unused:UNUSED_PRESERVE src0_sel:WORD_1
s_waitcnt lgkmcnt(4)
v_mfma_f32_32x32x16_bf16 v[120:135], v[92:95], v[236:239], v[120:135]
ds_read_b128 v[232:235], v248 offset:54272
ds_read_u16_d16 v140, v140
ds_read_u16_d16_hi v141, v141
v_fma_mix_f32 v159, v185, v185, v159 op_sel:[1,1,0] op_sel_hi:[1,1,0]
v_and_b32_e64 v143, s49, v143
v_rcp_f16_sdwa v148, v147 dst_sel:WORD_1 dst_unused:UNUSED_PRESERVE src0_sel:WORD_1
v_rcp_f16_sdwa v145, v144 dst_sel:WORD_1 dst_unused:UNUSED_PRESERVE src0_sel:WORD_1
v_pk_mul_f16 v155, v155, v154
v_bfe_u32 v142, v143, 2, 14
v_fma_mix_f32 v159, v186, v186, v159 op_sel:[0,0,0] op_sel_hi:[1,1,0]
v_pk_mul_f16 v152, v152, v151
v_pk_mul_f16 v149, v149, v148
v_smfmac_f32_16x16x32_bf16 v[20:23], v[216:217], v[208:211], v246
ds_read_b128 v[236:239], v248 offset:57344
ds_read_u16_d16 v142, v142
v_pk_mul_f16 v146, v146, v145
v_fma_mix_f32 v160, v155, v155, v160 op_sel:[0,0,0] op_sel_hi:[1,1,0]
v_lshrrev_b32_e64 v143, 18, v143
v_fma_mix_f32 v160, v155, v155, v160 op_sel:[1,1,0] op_sel_hi:[1,1,0]
v_fma_mix_f32 v160, v152, v152, v160 op_sel:[0,0,0] op_sel_hi:[1,1,0]
v_smfmac_f32_16x16x32_bf16 v[36:39], v[218:219], v[212:215], v246
v_fma_mix_f32 v159, v187, v187, v159 op_sel:[1,1,0] op_sel_hi:[1,1,0]
v_fma_mix_f32 v160, v152, v152, v160 op_sel:[1,1,0] op_sel_hi:[1,1,0]
v_fma_mix_f32 v160, v149, v149, v160 op_sel:[0,0,0] op_sel_hi:[1,1,0]
v_fma_mix_f32 v160, v149, v149, v160 op_sel:[1,1,0] op_sel_hi:[1,1,0]
v_fma_mix_f32 v160, v146, v146, v160 op_sel:[0,0,0] op_sel_hi:[1,1,0]
v_fma_mix_f32 v160, v146, v146, v160 op_sel:[1,1,0] op_sel_hi:[1,1,0]
s_cmp_lg_u32 s40, 7
s_cbranch_scc1 Lnobias2
s_sub_u32 s43, s2, 96
s_cmp_lt_u32 s43, 96
s_cbranch_scc0 Lnobias2
s_waitcnt vmcnt(15)
v_lshlrev_b32 v102, 16, v102
v_lshlrev_b32 v103, 16, v103
v_lshlrev_b32 v104, 16, v104
v_lshlrev_b32 v105, 16, v105
v_lshlrev_b32 v106, 16, v106
v_lshlrev_b32 v107, 16, v107
v_lshlrev_b32 v108, 16, v108
v_lshlrev_b32 v109, 16, v109
v_lshlrev_b32 v110, 16, v110
v_lshlrev_b32 v111, 16, v111
v_lshlrev_b32 v112, 16, v112
v_lshlrev_b32 v113, 16, v113
v_mul_f32 v100, v102, v108
v_fmac_f32 v100, v103, v109
v_fmac_f32 v100, v104, v110
v_fmac_f32 v100, v105, v111
v_fmac_f32 v100, v106, v112
v_fmac_f32 v100, v107, v113
s_nop 1
v_add_f32_dpp v100, v100, v100 row_ror:8 row_mask:0xf bank_mask:0xf
s_nop 1
v_add_f32_dpp v100, v100, v100 row_ror:4 row_mask:0xf bank_mask:0xf
s_nop 1
v_add_f32_dpp v100, v100, v100 row_ror:2 row_mask:0xf bank_mask:0xf
s_nop 1
v_add_f32_dpp v100, v100, v100 row_ror:1 row_mask:0xf bank_mask:0xf
v_mov_b32 v101, v100
s_nop 1
v_permlane16_swap_b32 v100, v101
v_add_f32 v100, v100, v101
v_mov_b32_e64 v101, v100
s_nop 1
v_permlane32_swap_b32 v100, v101
v_add_f32 v100, v100, v101
s_lshl_b32 s44, s43, 2
s_add_u32 s44, s44, 394752
v_lshlrev_b32_e64 v115, 11, v251
s_mov_b64 exec, 0xff
buffer_store_dword v100, v115, s[32:35], s44 offen sc1
s_mov_b64 exec, -1
Lnobias2:
s_setprio 2
v_smfmac_f32_16x16x32_bf16 v[12:15], v[220:221], v[192:195], v246
s_add_u32 s46, s80, 8388608
buffer_store_dwordx4 v[64:67], v241, s[32:35], s46 offen sc1
ds_read_b128 v[216:219], v248 offset:55296
ds_read_u16_d16_hi v143, v143
v_cvt_pkrtz_f16_f32 v179, v120, v121
v_cvt_pkrtz_f16_f32 v181, v122, v123
v_cvt_pkrtz_f16_f32 v183, v124, v125
v_cvt_pkrtz_f16_f32 v185, v126, v127
v_smfmac_f32_16x16x32_bf16 v[28:31], v[222:223], v[196:199], v246
v_cvt_pkrtz_f16_f32 v187, v128, v129
v_cvt_pk_f16_f32 v155, v130, v131
v_cvt_pk_f16_f32 v152, v132, v133
v_cvt_pk_f16_f32 v149, v134, v135
s_waitcnt lgkmcnt(2)
v_mfma_f32_32x32x16_bf16 v[120:135], v[72:75], v[224:227], 0
ds_read_b128 v[220:223], v245 offset:3840
ds_read_b128 v[200:203], v242 offset:128
v_xor_b32 v243, 32, v243
ds_read_b128 v[204:207], v243
v_pk_fma_f16 v154, v155, v155, s48
v_and_b32_e64 v179, s49, v179
v_fma_mix_f32 v160, v136, v136, v160 op_sel:[0,0,0] op_sel_hi:[1,1,0]
v_pk_fma_f16 v151, v152, v152, s48
v_pk_fma_f16 v148, v149, v149, s48
v_bfe_u32 v178, v179, 2, 14
v_pk_mul_f16 v154, v155, v154
v_pk_mul_f16 v151, v152, v151
v_mfma_f32_32x32x16_bf16 v[120:135], v[76:79], v[228:231], v[120:135]
ds_read_b128 v[224:227], v248 offset:58368
ds_read_u16_d16 v178, v178
v_pk_mul_f16 v148, v149, v148
v_lshrrev_b32_e64 v179, 18, v179
v_fma_mix_f32 v160, v137, v137, v160 op_sel:[1,1,0] op_sel_hi:[1,1,0]
v_exp_f16 v153, v154
v_and_b32 v181, s49, v181
v_exp_f16_e64 v150, v151
v_mfma_f32_32x32x16_bf16 v[120:135], v[80:83], v[232:235], v[120:135]
ds_read_b128 v[228:231], v245 offset:4224
ds_read_b128 v[208:211], v243 offset:64
ds_read_b128 v[212:215], v243 offset:128
ds_read_u16_d16_hi v179, v179
v_exp_f16_e64 v147, v148
v_bfe_u32 v180, v181, 2, 14
v_fma_mix_f32 v160, v138, v138, v160 op_sel:[0,0,0] op_sel_hi:[1,1,0]
v_exp_f16_sdwa v153, v154 dst_sel:WORD_1 dst_unused:UNUSED_PRESERVE src0_sel:WORD_1
v_lshrrev_b32 v181, 18, v181
v_mfma_f32_32x32x16_bf16 v[120:135], v[84:87], v[236:239], v[120:135]
ds_read_b128 v[232:235], v245 offset:4608
v_xor_b32 v244, 32, v244
ds_read_b128 v[192:195], v244
ds_read_b128 v[196:199], v244 offset:64
ds_read_u16_d16 v180, v180
ds_read_u16_d16_hi v181, v181
v_exp_f16_sdwa v150, v151 dst_sel:WORD_1 dst_unused:UNUSED_PRESERVE src0_sel:WORD_1
v_fma_mix_f32 v160, v139, v139, v160 op_sel:[1,1,0] op_sel_hi:[1,1,0]
v_and_b32 v183, s49, v183
v_exp_f16_sdwa v147, v148 dst_sel:WORD_1 dst_unused:UNUSED_PRESERVE src0_sel:WORD_1
v_pk_add_f16 v153, v153, 1.0 op_sel_hi:[1,0]
v_bfe_u32 v182, v183, 2, 14
v_pk_add_f16 v150, v150, 1.0 op_sel_hi:[1,0]
s_waitcnt lgkmcnt(9)
v_mfma_f32_32x32x16_bf16 v[120:135], v[88:91], v[216:219], v[120:135]
ds_read_b128 v[236:239], v248 offset:59392
ds_read_u16_d16 v182, v182
v_pk_add_f16 v147, v147, 1.0 op_sel_hi:[1,0]
v_rcp_f16 v154, v153
v_lshrrev_b32 v183, 18, v183
v_fma_mix_f32 v160, v140, v140, v160 op_sel:[0,0,0] op_sel_hi:[1,1,0]
v_rcp_f16 v151, v150
v_and_b32 v185, s49, v185
v_smfmac_f32_16x16x32_bf16 v[44:47], v[220:221], v[200:203], v246
ds_read_b128 v[216:219], v248 offset:62464
ds_read_u16_d16_hi v183, v183
v_rcp_f16_e64 v148, v147
v_fma_mix_f32 v160, v141, v141, v160 op_sel:[1,1,0] op_sel_hi:[1,1,0]
v_bfe_u32 v184, v185, 2, 14
v_smfmac_f32_16x16x32_bf16 v[12:15], v[222:223], v[204:207], v246
v_rcp_f16_sdwa v154, v153 dst_sel:WORD_1 dst_unused:UNUSED_PRESERVE src0_sel:WORD_1
v_rcp_f16_sdwa v151, v150 dst_sel:WORD_1 dst_unused:UNUSED_PRESERVE src0_sel:WORD_1
v_mfma_f32_32x32x16_bf16 v[120:135], v[92:95], v[224:227], v[120:135]
ds_read_b128 v[220:223], v248 offset:60416
ds_read_u16_d16 v184, v184
v_lshrrev_b32_e64 v185, 18, v185
v_rcp_f16_sdwa v148, v147 dst_sel:WORD_1 dst_unused:UNUSED_PRESERVE src0_sel:WORD_1
v_and_b32 v187, s49, v187
v_fma_mix_f32 v160, v142, v142, v160 op_sel:[0,0,0] op_sel_hi:[1,1,0]
v_pk_mul_f16 v155, v155, v154
v_pk_mul_f16 v152, v152, v151
v_bfe_u32 v186, v187, 2, 14
s_waitcnt lgkmcnt(4)
v_smfmac_f32_16x16x32_bf16 v[28:31], v[228:229], v[208:211], v246
ds_read_b128 v[224:227], v248 offset:63488
ds_read_u16_d16_hi v185, v185
ds_read_u16_d16 v186, v186
v_pk_mul_f16 v149, v149, v148
v_fma_mix_f32 v161, v155, v155, v161 op_sel:[0,0,0] op_sel_hi:[1,1,0]
v_fma_mix_f32 v160, v143, v143, v160 op_sel:[1,1,0] op_sel_hi:[1,1,0]
v_lshrrev_b32_e64 v187, 18, v187
v_smfmac_f32_16x16x32_bf16 v[44:47], v[230:231], v[212:215], v246
v_fma_mix_f32 v161, v155, v155, v161 op_sel:[1,1,0] op_sel_hi:[1,1,0]
v_fma_mix_f32 v161, v152, v152, v161 op_sel:[0,0,0] op_sel_hi:[1,1,0]
v_fma_mix_f32 v161, v152, v152, v161 op_sel:[1,1,0] op_sel_hi:[1,1,0]
v_fma_mix_f32 v161, v149, v149, v161 op_sel:[0,0,0] op_sel_hi:[1,1,0]
v_fma_mix_f32 v161, v149, v149, v161 op_sel:[1,1,0] op_sel_hi:[1,1,0]
v_lshlrev_b32_e64 v252, 7, v251
s_add_u32 s46, s47, 2359296
s_mov_b32 exec_lo, 131071
s_mov_b32 exec_hi, 0
s_mov_b32 m0, 16288
s_nop 0
buffer_load_dword v252, s[4:7], s46 offen lds
s_mov_b64 exec, -1
s_setprio 1
v_smfmac_f32_16x16x32_bf16 v[12:15], v[232:233], v[192:195], v246
s_add_u32 s46, s80, 10485760
buffer_store_dwordx4 v[68:71], v241, s[32:35], s46 offen sc1
ds_read_b128 v[228:231], v248 offset:61440
ds_read_u16_d16_hi v187, v187
v_cvt_pkrtz_f16_f32 v137, v120, v121
v_cvt_pkrtz_f16_f32 v139, v122, v123
v_cvt_pkrtz_f16_f32 v141, v124, v125
v_cvt_pkrtz_f16_f32 v143, v126, v127
v_cvt_pk_f16_f32 v155, v128, v129
v_smfmac_f32_16x16x32_bf16 v[28:31], v[234:235], v[196:199], v246
v_cvt_pk_f16_f32 v152, v130, v131
v_cvt_pk_f16_f32 v149, v132, v133
v_cvt_pk_f16_f32 v146, v134, v135
v_pk_fma_f16 v154, v155, v155, s48
v_and_b32_e64 v137, s49, v137
v_mfma_f32_32x32x16_bf16 v[120:135], v[72:75], v[236:239], 0
ds_read_b128 v[232:235], v248 offset:64512
v_fma_mix_f32 v161, v178, v178, v161 op_sel:[0,0,0] op_sel_hi:[1,1,0]
v_pk_fma_f16 v151, v152, v152, s48
v_pk_fma_f16 v148, v149, v149, s48
v_pk_fma_f16 v145, v146, v146, s48
v_pk_mul_f16 v154, v155, v154
v_bfe_u32 v136, v137, 2, 14
v_pk_mul_f16 v151, v152, v151
v_fma_mix_f32 v161, v179, v179, v161 op_sel:[1,1,0] op_sel_hi:[1,1,0]
v_pk_mul_f16 v148, v149, v148
v_pk_mul_f16 v145, v146, v145
s_waitcnt lgkmcnt(2)
v_mfma_f32_32x32x16_bf16 v[120:135], v[76:79], v[216:219], v[120:135]
ds_read_b128 v[236:239], v245 offset:4992
ds_read_b128 v[200:203], v244 offset:128
v_xor_b32 v242, 16, v242
ds_read_b128 v[204:207], v242
ds_read_u16_d16 v136, v136
v_exp_f16 v153, v154
v_lshrrev_b32 v137, 18, v137
v_exp_f16_e64 v150, v151
v_fma_mix_f32 v161, v180, v180, v161 op_sel:[0,0,0] op_sel_hi:[1,1,0]
v_exp_f16 v147, v148
v_and_b32 v139, s49, v139
v_exp_f16_e64 v144, v145
v_mfma_f32_32x32x16_bf16 v[120:135], v[80:83], v[220:223], v[120:135]
ds_read_b128 v[216:219], v245 offset:5376
ds_read_b128 v[208:211], v242 offset:64
ds_read_b128 v[212:215], v242 offset:128
ds_read_u16_d16_hi v137, v137
v_exp_f16_sdwa v153, v154 dst_sel:WORD_1 dst_unused:UNUSED_PRESERVE src0_sel:WORD_1
v_fma_mix_f32 v161, v181, v181, v161 op_sel:[1,1,0] op_sel_hi:[1,1,0]
v_bfe_u32 v138, v139, 2, 14
v_exp_f16_sdwa v150, v151 dst_sel:WORD_1 dst_unused:UNUSED_PRESERVE src0_sel:WORD_1
v_exp_f16_sdwa v147, v148 dst_sel:WORD_1 dst_unused:UNUSED_PRESERVE src0_sel:WORD_1
v_exp_f16_sdwa v144, v145 dst_sel:WORD_1 dst_unused:UNUSED_PRESERVE src0_sel:WORD_1
v_lshrrev_b32_e64 v139, 18, v139
v_fma_mix_f32 v161, v182, v182, v161 op_sel:[0,0,0] op_sel_hi:[1,1,0]
v_mfma_f32_32x32x16_bf16 v[120:135], v[84:87], v[224:227], v[120:135]
ds_read_b128 v[220:223], v249
ds_read_u16_d16 v138, v138
ds_read_u16_d16_hi v139, v139
v_pk_add_f16 v153, v153, 1.0 op_sel_hi:[1,0]
v_pk_add_f16 v150, v150, 1.0 op_sel_hi:[1,0]
v_pk_add_f16 v147, v147, 1.0 op_sel_hi:[1,0]
v_and_b32_e64 v141, s49, v141
v_pk_add_f16 v144, v144, 1.0 op_sel_hi:[1,0]
v_rcp_f16_e64 v154, v153
v_fma_mix_f32 v161, v183, v183, v161 op_sel:[1,1,0] op_sel_hi:[1,1,0]
v_rcp_f16_e64 v151, v150
v_mfma_f32_32x32x16_bf16 v[120:135], v[88:91], v[228:231], v[120:135]
ds_read_b128 v[224:227], v249 offset:3072
v_bfe_u32 v140, v141, 2, 14
v_rcp_f16_e64 v148, v147
v_fma_mix_f32 v161, v184, v184, v161 op_sel:[0,0,0] op_sel_hi:[1,1,0]
v_rcp_f16 v145, v144
v_lshrrev_b32 v141, 18, v141
v_rcp_f16_sdwa v154, v153 dst_sel:WORD_1 dst_unused:UNUSED_PRESERVE src0_sel:WORD_1
s_setprio 0
v_rcp_f16_sdwa v151, v150 dst_sel:WORD_1 dst_unused:UNUSED_PRESERVE src0_sel:WORD_1
s_waitcnt lgkmcnt(4)
v_mfma_f32_32x32x16_bf16 v[120:135], v[92:95], v[232:235], v[120:135]
ds_read_b128 v[228:231], v249 offset:1024
ds_read_u16_d16 v140, v140
ds_read_u16_d16_hi v141, v141
v_fma_mix_f32 v161, v185, v185, v161 op_sel:[1,1,0] op_sel_hi:[1,1,0]
v_and_b32_e64 v143, s49, v143
v_rcp_f16_sdwa v148, v147 dst_sel:WORD_1 dst_unused:UNUSED_PRESERVE src0_sel:WORD_1
v_rcp_f16_sdwa v145, v144 dst_sel:WORD_1 dst_unused:UNUSED_PRESERVE src0_sel:WORD_1
v_pk_mul_f16 v155, v155, v154
v_bfe_u32 v142, v143, 2, 14
v_fma_mix_f32 v161, v186, v186, v161 op_sel:[0,0,0] op_sel_hi:[1,1,0]
v_pk_mul_f16 v152, v152, v151
v_pk_mul_f16 v149, v149, v148
v_smfmac_f32_16x16x32_bf16 v[44:47], v[236:237], v[200:203], v246
ds_read_b128 v[232:235], v249 offset:4096
ds_read_u16_d16 v142, v142
v_pk_mul_f16 v146, v146, v145
v_fma_mix_f32 v162, v155, v155, v162 op_sel:[0,0,0] op_sel_hi:[1,1,0]
v_lshrrev_b32_e64 v143, 18, v143
v_fma_mix_f32 v162, v155, v155, v162 op_sel:[1,1,0] op_sel_hi:[1,1,0]
v_fma_mix_f32 v162, v152, v152, v162 op_sel:[0,0,0] op_sel_hi:[1,1,0]
v_smfmac_f32_16x16x32_bf16 v[8:11], v[238:239], v[204:207], v246
v_fma_mix_f32 v161, v187, v187, v161 op_sel:[1,1,0] op_sel_hi:[1,1,0]
v_fma_mix_f32 v162, v152, v152, v162 op_sel:[1,1,0] op_sel_hi:[1,1,0]
v_fma_mix_f32 v162, v149, v149, v162 op_sel:[0,0,0] op_sel_hi:[1,1,0]
v_fma_mix_f32 v162, v149, v149, v162 op_sel:[1,1,0] op_sel_hi:[1,1,0]
v_fma_mix_f32 v162, v146, v146, v162 op_sel:[0,0,0] op_sel_hi:[1,1,0]
v_fma_mix_f32 v162, v146, v146, v162 op_sel:[1,1,0] op_sel_hi:[1,1,0]
v_lshlrev_b32_e64 v252, 7, v251
s_add_u32 s46, s47, 2359296
s_mov_b32 exec_lo, 4294836224
s_mov_b32 exec_hi, 3
s_mov_b32 m0, 16220
s_nop 0
buffer_load_dword v252, s[4:7], s46 offen lds
s_mov_b64 exec, -1
s_setprio 2
v_smfmac_f32_16x16x32_bf16 v[24:27], v[216:217], v[208:211], v246
ds_read_b128 v[236:239], v249 offset:2048
ds_read_u16_d16_hi v143, v143
v_cvt_pkrtz_f16_f32 v179, v120, v121
v_cvt_pkrtz_f16_f32 v181, v122, v123
v_cvt_pkrtz_f16_f32 v183, v124, v125
v_cvt_pkrtz_f16_f32 v185, v126, v127
v_smfmac_f32_16x16x32_bf16 v[40:43], v[218:219], v[212:215], v246
v_cvt_pkrtz_f16_f32 v187, v128, v129
v_cvt_pk_f16_f32 v155, v130, v131
v_cvt_pk_f16_f32 v152, v132, v133
v_cvt_pk_f16_f32 v149, v134, v135
v_pk_fma_f16 v154, v155, v155, s48
s_waitcnt lgkmcnt(2)
v_mfma_f32_32x32x16_bf16 v[120:135], v[72:75], v[220:223], 0
ds_read_b128 v[216:219], v249 offset:5120
v_and_b32 v179, s49, v179
v_fma_mix_f32 v162, v136, v136, v162 op_sel:[0,0,0] op_sel_hi:[1,1,0]
v_pk_fma_f16 v151, v152, v152, s48
v_pk_fma_f16 v148, v149, v149, s48
v_bfe_u32 v178, v179, 2, 14
v_pk_mul_f16 v154, v155, v154
v_pk_mul_f16 v151, v152, v151
v_pk_mul_f16 v148, v149, v148
v_lshrrev_b32 v179, 18, v179
v_mfma_f32_32x32x16_bf16 v[120:135], v[76:79], v[224:227], v[120:135]
ds_read_b128 v[220:223], v245 offset:5760
v_xor_b32 v243, 16, v243
ds_read_b128 v[192:195], v243
ds_read_b128 v[196:199], v243 offset:64
ds_read_u16_d16 v178, v178
ds_read_u16_d16_hi v179, v179
v_fma_mix_f32 v162, v137, v137, v162 op_sel:[1,1,0] op_sel_hi:[1,1,0]
v_exp_f16 v153, v154
v_and_b32 v181, s49, v181
v_exp_f16 v150, v151
v_exp_f16 v147, v148
v_bfe_u32 v180, v181, 2, 14
v_mfma_f32_32x32x16_bf16 v[120:135], v[80:83], v[228:231], v[120:135]
ds_read_b128 v[224:227], v245 offset:6144
ds_read_b128 v[200:203], v243 offset:128
v_xor_b32 v244, 16, v244
ds_read_b128 v[204:207], v244
ds_read_u16_d16 v180, v180
v_fma_mix_f32 v162, v138, v138, v162 op_sel:[0,0,0] op_sel_hi:[1,1,0]
v_exp_f16_sdwa v153, v154 dst_sel:WORD_1 dst_unused:UNUSED_PRESERVE src0_sel:WORD_1
v_lshrrev_b32 v181, 18, v181
v_exp_f16_sdwa v150, v151 dst_sel:WORD_1 dst_unused:UNUSED_PRESERVE src0_sel:WORD_1
v_fma_mix_f32 v162, v139, v139, v162 op_sel:[1,1,0] op_sel_hi:[1,1,0]
v_and_b32_e64 v183, s49, v183
v_mfma_f32_32x32x16_bf16 v[120:135], v[84:87], v[232:235], v[120:135]
ds_read_b128 v[228:231], v249 offset:6144
ds_read_u16_d16_hi v181, v181
v_exp_f16_sdwa v147, v148 dst_sel:WORD_1 dst_unused:UNUSED_PRESERVE src0_sel:WORD_1
v_pk_add_f16 v153, v153, 1.0 op_sel_hi:[1,0]
v_bfe_u32 v182, v183, 2, 14
v_pk_add_f16 v150, v150, 1.0 op_sel_hi:[1,0]
v_pk_add_f16 v147, v147, 1.0 op_sel_hi:[1,0]
v_rcp_f16_e64 v154, v153
v_lshrrev_b32 v183, 18, v183
v_fma_mix_f32 v162, v140, v140, v162 op_sel:[0,0,0] op_sel_hi:[1,1,0]
s_waitcnt lgkmcnt(6)
v_mfma_f32_32x32x16_bf16 v[120:135], v[88:91], v[236:239], v[120:135]
ds_read_b128 v[232:235], v249 offset:9216
ds_read_u16_d16 v182, v182
ds_read_u16_d16_hi v183, v183
v_rcp_f16 v151, v150
v_and_b32 v185, s49, v185
v_rcp_f16_e64 v148, v147
v_fma_mix_f32 v162, v141, v141, v162 op_sel:[1,1,0] op_sel_hi:[1,1,0]
v_bfe_u32 v184, v185, 2, 14
v_rcp_f16_sdwa v154, v153 dst_sel:WORD_1 dst_unused:UNUSED_PRESERVE src0_sel:WORD_1
v_mfma_f32_32x32x16_bf16 v[120:135], v[92:95], v[216:219], v[120:135]
ds_read_b128 v[236:239], v249 offset:7168
ds_read_u16_d16 v184, v184
v_rcp_f16_sdwa v151, v150 dst_sel:WORD_1 dst_unused:UNUSED_PRESERVE src0_sel:WORD_1
v_lshrrev_b32_e64 v185, 18, v185
v_rcp_f16_sdwa v148, v147 dst_sel:WORD_1 dst_unused:UNUSED_PRESERVE src0_sel:WORD_1
v_and_b32_e64 v187, s49, v187
v_fma_mix_f32 v162, v142, v142, v162 op_sel:[0,0,0] op_sel_hi:[1,1,0]
v_pk_mul_f16 v155, v155, v154
v_pk_mul_f16 v152, v152, v151
v_smfmac_f32_16x16x32_bf16 v[8:11], v[220:221], v[192:195], v246
ds_read_b128 v[216:219], v249 offset:10240
ds_read_u16_d16_hi v185, v185
v_bfe_u32 v186, v187, 2, 14
v_pk_mul_f16 v149, v149, v148
v_fma_mix_f32 v163, v155, v155, v163 op_sel:[0,0,0] op_sel_hi:[1,1,0]
v_fma_mix_f32 v162, v143, v143, v162 op_sel:[1,1,0] op_sel_hi:[1,1,0]
v_lshrrev_b32_e64 v187, 18, v187
v_smfmac_f32_16x16x32_bf16 v[24:27], v[222:223], v[196:199], v246
v_fma_mix_f32 v163, v155, v155, v163 op_sel:[1,1,0] op_sel_hi:[1,1,0]
v_fma_mix_f32 v163, v152, v152, v163 op_sel:[0,0,0] op_sel_hi:[1,1,0]
v_fma_mix_f32 v163, v152, v152, v163 op_sel:[1,1,0] op_sel_hi:[1,1,0]
v_fma_mix_f32 v163, v149, v149, v163 op_sel:[0,0,0] op_sel_hi:[1,1,0]
v_fma_mix_f32 v163, v149, v149, v163 op_sel:[1,1,0] op_sel_hi:[1,1,0]
v_lshlrev_b32 v252, 7, v251
s_add_u32 s46, s47, 2359296
s_mov_b32 exec_lo, 0
s_mov_b32 exec_hi, 1048572
s_mov_b32 m0, 16152
s_nop 0
buffer_load_dword v252, s[4:7], s46 offen lds
s_mov_b64 exec, -1
s_setprio 1
s_waitcnt lgkmcnt(2)
v_smfmac_f32_16x16x32_bf16 v[40:43], v[224:225], v[200:203], v246
ds_read_b128 v[220:223], v249 offset:8192
ds_read_u16_d16 v186, v186
ds_read_u16_d16_hi v187, v187
v_cvt_pkrtz_f16_f32 v137, v120, v121
v_cvt_pkrtz_f16_f32 v139, v122, v123
v_cvt_pkrtz_f16_f32 v141, v124, v125
v_cvt_pkrtz_f16_f32 v143, v126, v127
v_smfmac_f32_16x16x32_bf16 v[8:11], v[226:227], v[204:207], v246
v_cvt_pk_f16_f32 v155, v128, v129
v_cvt_pk_f16_f32 v152, v130, v131
v_cvt_pk_f16_f32 v149, v132, v133
v_cvt_pk_f16_f32 v146, v134, v135
v_pk_fma_f16 v154, v155, v155, s48
v_mfma_f32_32x32x16_bf16 v[120:135], v[72:75], v[228:231], 0
ds_read_b128 v[224:227], v249 offset:11264
v_and_b32_e64 v137, s49, v137
v_fma_mix_f32 v163, v178, v178, v163 op_sel:[0,0,0] op_sel_hi:[1,1,0]
v_pk_fma_f16 v151, v152, v152, s48
v_pk_fma_f16 v148, v149, v149, s48
v_pk_fma_f16 v145, v146, v146, s48
v_pk_mul_f16 v154, v155, v154
v_bfe_u32 v136, v137, 2, 14
v_pk_mul_f16 v151, v152, v151
v_fma_mix_f32 v163, v179, v179, v163 op_sel:[1,1,0] op_sel_hi:[1,1,0]
v_pk_mul_f16 v148, v149, v148
v_mfma_f32_32x32x16_bf16 v[120:135], v[76:79], v[232:235], v[120:135]
ds_read_b128 v[228:231], v245 offset:6528
ds_read_b128 v[208:211], v244 offset:64
ds_read_b128 v[212:215], v244 offset:128
ds_read_u16_d16 v136, v136
v_pk_mul_f16 v145, v146, v145
v_exp_f16 v153, v154
v_lshrrev_b32 v137, 18, v137
v_exp_f16_e64 v150, v151
v_fma_mix_f32 v163, v180, v180, v163 op_sel:[0,0,0] op_sel_hi:[1,1,0]
v_exp_f16 v147, v148
v_and_b32 v139, s49, v139
v_mfma_f32_32x32x16_bf16 v[120:135], v[80:83], v[236:239], v[120:135]
ds_read_b128 v[232:235], v249 offset:12288
ds_read_u16_d16_hi v137, v137
v_exp_f16_e64 v144, v145
v_exp_f16_sdwa v153, v154 dst_sel:WORD_1 dst_unused:UNUSED_PRESERVE src0_sel:WORD_1
v_fma_mix_f32 v163, v181, v181, v163 op_sel:[1,1,0] op_sel_hi:[1,1,0]
v_bfe_u32 v138, v139, 2, 14
v_exp_f16_sdwa v150, v151 dst_sel:WORD_1 dst_unused:UNUSED_PRESERVE src0_sel:WORD_1
v_exp_f16_sdwa v147, v148 dst_sel:WORD_1 dst_unused:UNUSED_PRESERVE src0_sel:WORD_1
s_waitcnt lgkmcnt(6)
v_mfma_f32_32x32x16_bf16 v[120:135], v[84:87], v[216:219], v[120:135]
ds_read_b128 v[236:239], v249 offset:15360
ds_read_u16_d16 v138, v138
v_exp_f16_sdwa v144, v145 dst_sel:WORD_1 dst_unused:UNUSED_PRESERVE src0_sel:WORD_1
v_lshrrev_b32 v139, 18, v139
v_fma_mix_f32 v163, v182, v182, v163 op_sel:[0,0,0] op_sel_hi:[1,1,0]
v_pk_add_f16 v153, v153, 1.0 op_sel_hi:[1,0]
v_pk_add_f16 v150, v150, 1.0 op_sel_hi:[1,0]
v_pk_add_f16 v147, v147, 1.0 op_sel_hi:[1,0]
v_and_b32_e64 v141, s49, v141
v_pk_add_f16 v144, v144, 1.0 op_sel_hi:[1,0]
v_mfma_f32_32x32x16_bf16 v[120:135], v[88:91], v[220:223], v[120:135]
ds_read_b128 v[216:219], v249 offset:13312
ds_read_u16_d16_hi v139, v139
v_rcp_f16_e64 v154, v153
v_fma_mix_f32 v163, v183, v183, v163 op_sel:[1,1,0] op_sel_hi:[1,1,0]
v_rcp_f16_e64 v151, v150
v_bfe_u32 v140, v141, 2, 14
v_rcp_f16_e64 v148, v147
v_fma_mix_f32 v163, v184, v184, v163 op_sel:[0,0,0] op_sel_hi:[1,1,0]
v_mfma_f32_32x32x16_bf16 v[120:135], v[92:95], v[224:227], v[120:135]
ds_read_b128 v[220:223], v249 offset:16384
ds_read_u16_d16 v140, v140
v_rcp_f16_e64 v145, v144
v_lshrrev_b32 v141, 18, v141
v_rcp_f16_sdwa v154, v153 dst_sel:WORD_1 dst_unused:UNUSED_PRESERVE src0_sel:WORD_1
s_setprio 0
v_rcp_f16_sdwa v151, v150 dst_sel:WORD_1 dst_unused:UNUSED_PRESERVE src0_sel:WORD_1
v_fma_mix_f32 v163, v185, v185, v163 op_sel:[1,1,0] op_sel_hi:[1,1,0]
v_and_b32 v143, s49, v143
v_rcp_f16_sdwa v148, v147 dst_sel:WORD_1 dst_unused:UNUSED_PRESERVE src0_sel:WORD_1
s_waitcnt lgkmcnt(4)
v_smfmac_f32_16x16x32_bf16 v[24:27], v[228:229], v[208:211], v246
ds_read_b128 v[224:227], v249 offset:14336
ds_read_u16_d16_hi v141, v141
v_rcp_f16_sdwa v145, v144 dst_sel:WORD_1 dst_unused:UNUSED_PRESERVE src0_sel:WORD_1
v_pk_mul_f16 v155, v155, v154
v_bfe_u32 v142, v143, 2, 14
v_fma_mix_f32 v163, v186, v186, v163 op_sel:[0,0,0] op_sel_hi:[1,1,0]
v_smfmac_f32_16x16x32_bf16 v[40:43], v[230:231], v[212:215], v246
s_mov_b64 exec, 1
ds_add_u32 v253, v254 offset:16
s_mov_b64 exec, -1
v_pk_mul_f16 v152, v152, v151
v_pk_mul_f16 v149, v149, v148
v_pk_mul_f16 v146, v146, v145
v_fma_mix_f32 v164, v155, v155, v164 op_sel:[0,0,0] op_sel_hi:[1,1,0]
v_lshrrev_b32 v143, 18, v143
v_fma_mix_f32 v164, v155, v155, v164 op_sel:[1,1,0] op_sel_hi:[1,1,0]
v_fma_mix_f32 v164, v152, v152, v164 op_sel:[0,0,0] op_sel_hi:[1,1,0]
v_fma_mix_f32 v163, v187, v187, v163 op_sel:[1,1,0] op_sel_hi:[1,1,0]
v_fma_mix_f32 v164, v152, v152, v164 op_sel:[1,1,0] op_sel_hi:[1,1,0]
v_fma_mix_f32 v164, v149, v149, v164 op_sel:[0,0,0] op_sel_hi:[1,1,0]
v_fma_mix_f32 v164, v149, v149, v164 op_sel:[1,1,0] op_sel_hi:[1,1,0]
v_fma_mix_f32 v164, v146, v146, v164 op_sel:[0,0,0] op_sel_hi:[1,1,0]
v_fma_mix_f32 v164, v146, v146, v164 op_sel:[1,1,0] op_sel_hi:[1,1,0]
s_setprio 3
v_pk_add_f32 v[168:169], v[0:1], v[2:3]
v_pk_mul_f32 v[170:171], v[0:1], v[0:1]
v_pk_fma_f32 v[170:171], v[2:3], v[2:3], v[170:171]
v_pk_add_f32 v[168:169], v[168:169], v[4:5]
v_pk_fma_f32 v[170:171], v[4:5], v[4:5], v[170:171]
v_pk_add_f32 v[168:169], v[168:169], v[6:7]
v_pk_fma_f32 v[170:171], v[6:7], v[6:7], v[170:171]
v_pk_add_f32 v[168:169], v[168:169], v[8:9]
v_pk_fma_f32 v[170:171], v[8:9], v[8:9], v[170:171]
v_pk_add_f32 v[168:169], v[168:169], v[10:11]
v_pk_fma_f32 v[170:171], v[10:11], v[10:11], v[170:171]
v_pk_add_f32 v[168:169], v[168:169], v[12:13]
v_pk_fma_f32 v[170:171], v[12:13], v[12:13], v[170:171]
v_pk_add_f32 v[168:169], v[168:169], v[14:15]
v_pk_fma_f32 v[170:171], v[14:15], v[14:15], v[170:171]
v_pk_add_f32 v[168:169], v[168:169], v[16:17]
v_pk_fma_f32 v[170:171], v[16:17], v[16:17], v[170:171]
v_pk_add_f32 v[168:169], v[168:169], v[18:19]
v_pk_fma_f32 v[170:171], v[18:19], v[18:19], v[170:171]
v_pk_add_f32 v[168:169], v[168:169], v[20:21]
v_pk_fma_f32 v[170:171], v[20:21], v[20:21], v[170:171]
v_pk_add_f32 v[168:169], v[168:169], v[22:23]
v_pk_fma_f32 v[170:171], v[22:23], v[22:23], v[170:171]
v_pk_add_f32 v[168:169], v[168:169], v[24:25]
v_pk_fma_f32 v[170:171], v[24:25], v[24:25], v[170:171]
v_pk_add_f32 v[168:169], v[168:169], v[26:27]
v_pk_fma_f32 v[170:171], v[26:27], v[26:27], v[170:171]
v_pk_add_f32 v[168:169], v[168:169], v[28:29]
v_pk_fma_f32 v[170:171], v[28:29], v[28:29], v[170:171]
v_pk_add_f32 v[168:169], v[168:169], v[30:31]
v_pk_fma_f32 v[170:171], v[30:31], v[30:31], v[170:171]
v_pk_add_f32 v[168:169], v[168:169], v[32:33]
v_pk_fma_f32 v[170:171], v[32:33], v[32:33], v[170:171]
v_pk_add_f32 v[168:169], v[168:169], v[34:35]
v_pk_fma_f32 v[170:171], v[34:35], v[34:35], v[170:171]
v_pk_add_f32 v[168:169], v[168:169], v[36:37]
v_pk_fma_f32 v[170:171], v[36:37], v[36:37], v[170:171]
v_pk_add_f32 v[168:169], v[168:169], v[38:39]
v_pk_fma_f32 v[170:171], v[38:39], v[38:39], v[170:171]
v_pk_add_f32 v[168:169], v[168:169], v[40:41]
v_pk_fma_f32 v[170:171], v[40:41], v[40:41], v[170:171]
v_pk_add_f32 v[168:169], v[168:169], v[42:43]
v_pk_fma_f32 v[170:171], v[42:43], v[42:43], v[170:171]
v_pk_add_f32 v[168:169], v[168:169], v[44:45]
v_pk_fma_f32 v[170:171], v[44:45], v[44:45], v[170:171]
v_pk_add_f32 v[168:169], v[168:169], v[46:47]
v_pk_fma_f32 v[170:171], v[46:47], v[46:47], v[170:171]
s_setprio 0
v_add_u32 v174, -36864, v242
v_subrev_u32 v175, 66560, v174
v_min_u32 v174, v174, v175
v_add_u32 v174, 90112, v174
v_sub_u32 v175, v174, v242
v_add_u32 v242, v175, v242
v_add_u32_e64 v243, v175, v243
v_add_u32 v244, v175, v244
s_setprio 2
v_cvt_pkrtz_f16_f32 v179, v120, v121
v_cvt_pkrtz_f16_f32 v181, v122, v123
v_cvt_pkrtz_f16_f32 v183, v124, v125
v_cvt_pkrtz_f16_f32 v185, v126, v127
v_cvt_pkrtz_f16_f32 v187, v128, v129
v_cvt_pk_f16_f32 v155, v130, v131
v_cvt_pk_f16_f32 v152, v132, v133
v_cvt_pk_f16_f32 v149, v134, v135
ds_read_b128 v[228:231], v249 offset:17408
ds_read_u16_d16 v142, v142
ds_read_u16_d16_hi v143, v143
v_mfma_f32_32x32x16_bf16 v[120:135], v[72:75], v[232:235], 0
v_pk_fma_f16 v154, v155, v155, s48
v_add_f32 v168, v168, v169
v_and_b32 v179, s49, v179
v_fma_mix_f32 v164, v136, v136, v164 op_sel:[0,0,0] op_sel_hi:[1,1,0]
v_pk_fma_f16 v151, v152, v152, s48
v_pk_fma_f16 v148, v149, v149, s48
v_add_f32_e64 v170, v170, v171
v_bfe_u32 v178, v179, 2, 14
v_pk_mul_f16 v154, v155, v154
v_pk_mul_f16 v151, v152, v151
v_pk_mul_f16 v148, v149, v148
v_lshrrev_b32_e64 v179, 18, v179
ds_read_b128 v[232:235], v249 offset:18432
ds_read_u16_d16 v178, v178
ds_read_u16_d16_hi v179, v179
v_mfma_f32_32x32x16_bf16 v[120:135], v[76:79], v[236:239], v[120:135]
v_permlane32_swap_b32 v168, v170
v_fma_mix_f32 v164, v137, v137, v164 op_sel:[1,1,0] op_sel_hi:[1,1,0]
v_exp_f16 v153, v154
v_and_b32 v181, s49, v181
v_add_f32 v168, v168, v170
v_exp_f16_e64 v150, v151
v_exp_f16 v147, v148
v_bfe_u32 v180, v181, 2, 14
v_mul_f32 v168, 1009429163, v168
s_waitcnt lgkmcnt(7)
ds_read_b128 v[236:239], v249 offset:21504
ds_read_u16_d16 v180, v180
v_mfma_f32_32x32x16_bf16 v[120:135], v[80:83], v[216:219], v[120:135]
v_fma_mix_f32 v164, v138, v138, v164 op_sel:[0,0,0] op_sel_hi:[1,1,0]
v_exp_f16_sdwa v153, v154 dst_sel:WORD_1 dst_unused:UNUSED_PRESERVE src0_sel:WORD_1
v_lshrrev_b32_e64 v181, 18, v181
v_exp_f16_sdwa v150, v151 dst_sel:WORD_1 dst_unused:UNUSED_PRESERVE src0_sel:WORD_1
v_mov_b32_e64 v170, v168
v_fma_mix_f32 v164, v139, v139, v164 op_sel:[1,1,0] op_sel_hi:[1,1,0]
v_and_b32 v183, s49, v183
v_exp_f16_sdwa v147, v148 dst_sel:WORD_1 dst_unused:UNUSED_PRESERVE src0_sel:WORD_1
v_permlane32_swap_b32 v168, v170
ds_read_b128 v[216:219], v249 offset:19456
ds_read_u16_d16_hi v181, v181
v_mfma_f32_32x32x16_bf16 v[120:135], v[84:87], v[220:223], v[120:135]
v_pk_add_f16 v153, v153, 1.0 op_sel_hi:[1,0]
v_bfe_u32 v182, v183, 2, 14
v_pk_add_f16 v150, v150, 1.0 op_sel_hi:[1,0]
v_pk_add_f16 v147, v147, 1.0 op_sel_hi:[1,0]
v_fma_f32 v170, -v168, v168, v170
v_rcp_f16 v154, v153
v_lshrrev_b32 v183, 18, v183
v_fma_mix_f32 v164, v140, v140, v164 op_sel:[0,0,0] op_sel_hi:[1,1,0]
v_rcp_f16 v151, v150
v_max_f32 v170, 0, v170
ds_read_b128 v[220:223], v249 offset:22528
ds_read_u16_d16 v182, v182
ds_read_u16_d16_hi v183, v183
v_mfma_f32_32x32x16_bf16 v[120:135], v[88:91], v[224:227], v[120:135]
v_and_b32 v185, s49, v185
v_rcp_f16 v148, v147
v_add_f32 v170, 925353388, v170
v_fma_mix_f32 v164, v141, v141, v164 op_sel:[1,1,0] op_sel_hi:[1,1,0]
v_bfe_u32 v184, v185, 2, 14
v_rcp_f16_sdwa v154, v153 dst_sel:WORD_1 dst_unused:UNUSED_PRESERVE src0_sel:WORD_1
v_rcp_f16_sdwa v151, v150 dst_sel:WORD_1 dst_unused:UNUSED_PRESERVE src0_sel:WORD_1
v_rsq_f32 v170, v170
s_waitcnt lgkmcnt(4)
ds_read_b128 v[224:227], v249 offset:20480
ds_read_b32 v247, v253 offset:16
ds_read_u16_d16 v184, v184
v_mfma_f32_32x32x16_bf16 v[120:135], v[92:95], v[228:231], v[120:135]
v_lshrrev_b32_e64 v185, 18, v185
v_rcp_f16_sdwa v148, v147 dst_sel:WORD_1 dst_unused:UNUSED_PRESERVE src0_sel:WORD_1
v_and_b32_e64 v187, s49, v187
v_fma_mix_f32 v164, v142, v142, v164 op_sel:[0,0,0] op_sel_hi:[1,1,0]
v_pk_mul_f16 v155, v155, v154
v_pk_mul_f16 v152, v152, v151
v_bfe_u32 v186, v187, 2, 14
v_mul_f32 v172, 3203391086, v170
v_pk_mul_f16 v149, v149, v148
v_fma_mix_f32 v165, v155, v155, v165 op_sel:[0,0,0] op_sel_hi:[1,1,0]
v_fma_mix_f32 v164, v143, v143, v164 op_sel:[1,1,0] op_sel_hi:[1,1,0]
v_lshrrev_b32_e64 v187, 18, v187
v_fma_mix_f32 v165, v155, v155, v165 op_sel:[1,1,0] op_sel_hi:[1,1,0]
v_mul_f32 v173, v168, v172
v_fma_mix_f32 v165, v152, v152, v165 op_sel:[0,0,0] op_sel_hi:[1,1,0]
v_fma_mix_f32 v165, v152, v152, v165 op_sel:[1,1,0] op_sel_hi:[1,1,0]
v_fma_mix_f32 v165, v149, v149, v165 op_sel:[0,0,0] op_sel_hi:[1,1,0]
v_fma_mix_f32 v165, v149, v149, v165 op_sel:[1,1,0] op_sel_hi:[1,1,0]
s_setprio 3
v_pk_fma_f32 v[0:1], v[0:1], v[172:173], v[172:173] op_sel:[0,0,1] op_sel_hi:[1,0,1] neg_lo:[0,0,1] neg_hi:[0,0,1]
v_pk_fma_f32 v[2:3], v[2:3], v[172:173], v[172:173] op_sel:[0,0,1] op_sel_hi:[1,0,1] neg_lo:[0,0,1] neg_hi:[0,0,1]
v_pk_fma_f32 v[4:5], v[4:5], v[172:173], v[172:173] op_sel:[0,0,1] op_sel_hi:[1,0,1] neg_lo:[0,0,1] neg_hi:[0,0,1]
v_pk_fma_f32 v[6:7], v[6:7], v[172:173], v[172:173] op_sel:[0,0,1] op_sel_hi:[1,0,1] neg_lo:[0,0,1] neg_hi:[0,0,1]
v_pk_fma_f32 v[8:9], v[8:9], v[172:173], v[172:173] op_sel:[0,0,1] op_sel_hi:[1,0,1] neg_lo:[0,0,1] neg_hi:[0,0,1]
v_pk_fma_f32 v[10:11], v[10:11], v[172:173], v[172:173] op_sel:[0,0,1] op_sel_hi:[1,0,1] neg_lo:[0,0,1] neg_hi:[0,0,1]
v_pk_fma_f32 v[12:13], v[12:13], v[172:173], v[172:173] op_sel:[0,0,1] op_sel_hi:[1,0,1] neg_lo:[0,0,1] neg_hi:[0,0,1]
v_pk_fma_f32 v[14:15], v[14:15], v[172:173], v[172:173] op_sel:[0,0,1] op_sel_hi:[1,0,1] neg_lo:[0,0,1] neg_hi:[0,0,1]
v_pk_fma_f32 v[16:17], v[16:17], v[172:173], v[172:173] op_sel:[0,0,1] op_sel_hi:[1,0,1] neg_lo:[0,0,1] neg_hi:[0,0,1]
v_pk_fma_f32 v[18:19], v[18:19], v[172:173], v[172:173] op_sel:[0,0,1] op_sel_hi:[1,0,1] neg_lo:[0,0,1] neg_hi:[0,0,1]
v_pk_fma_f32 v[20:21], v[20:21], v[172:173], v[172:173] op_sel:[0,0,1] op_sel_hi:[1,0,1] neg_lo:[0,0,1] neg_hi:[0,0,1]
v_pk_fma_f32 v[22:23], v[22:23], v[172:173], v[172:173] op_sel:[0,0,1] op_sel_hi:[1,0,1] neg_lo:[0,0,1] neg_hi:[0,0,1]
v_pk_fma_f32 v[24:25], v[24:25], v[172:173], v[172:173] op_sel:[0,0,1] op_sel_hi:[1,0,1] neg_lo:[0,0,1] neg_hi:[0,0,1]
v_pk_fma_f32 v[26:27], v[26:27], v[172:173], v[172:173] op_sel:[0,0,1] op_sel_hi:[1,0,1] neg_lo:[0,0,1] neg_hi:[0,0,1]
v_pk_fma_f32 v[28:29], v[28:29], v[172:173], v[172:173] op_sel:[0,0,1] op_sel_hi:[1,0,1] neg_lo:[0,0,1] neg_hi:[0,0,1]
v_pk_fma_f32 v[30:31], v[30:31], v[172:173], v[172:173] op_sel:[0,0,1] op_sel_hi:[1,0,1] neg_lo:[0,0,1] neg_hi:[0,0,1]
v_pk_fma_f32 v[32:33], v[32:33], v[172:173], v[172:173] op_sel:[0,0,1] op_sel_hi:[1,0,1] neg_lo:[0,0,1] neg_hi:[0,0,1]
v_pk_fma_f32 v[34:35], v[34:35], v[172:173], v[172:173] op_sel:[0,0,1] op_sel_hi:[1,0,1] neg_lo:[0,0,1] neg_hi:[0,0,1]
v_pk_fma_f32 v[36:37], v[36:37], v[172:173], v[172:173] op_sel:[0,0,1] op_sel_hi:[1,0,1] neg_lo:[0,0,1] neg_hi:[0,0,1]
v_pk_fma_f32 v[38:39], v[38:39], v[172:173], v[172:173] op_sel:[0,0,1] op_sel_hi:[1,0,1] neg_lo:[0,0,1] neg_hi:[0,0,1]
v_pk_fma_f32 v[40:41], v[40:41], v[172:173], v[172:173] op_sel:[0,0,1] op_sel_hi:[1,0,1] neg_lo:[0,0,1] neg_hi:[0,0,1]
v_pk_fma_f32 v[42:43], v[42:43], v[172:173], v[172:173] op_sel:[0,0,1] op_sel_hi:[1,0,1] neg_lo:[0,0,1] neg_hi:[0,0,1]
v_pk_fma_f32 v[44:45], v[44:45], v[172:173], v[172:173] op_sel:[0,0,1] op_sel_hi:[1,0,1] neg_lo:[0,0,1] neg_hi:[0,0,1]
v_pk_fma_f32 v[46:47], v[46:47], v[172:173], v[172:173] op_sel:[0,0,1] op_sel_hi:[1,0,1] neg_lo:[0,0,1] neg_hi:[0,0,1]
s_setprio 2
ds_read_u16_d16_hi v185, v185
ds_read_u16_d16 v186, v186
ds_read_u16_d16_hi v187, v187
s_waitcnt lgkmcnt(3)
v_readfirstlane_b32 s43, v247
s_nop 1
s_cmp_ge_u32 s43, 24
s_cbranch_scc1 Lev7
Lev7w:
s_sleep 1
ds_read_b32 v247, v253 offset:16
s_waitcnt lgkmcnt(0)
v_readfirstlane_b32 s43, v247
s_cmp_eq_u32 s76, 0
s_cbranch_scc1 Lev7
s_sub_u32 s76, s76, 1
s_cmp_lt_u32 s43, 24
s_cbranch_scc1 Lev7w
Lev7:
s_setprio 1
v_cvt_pkrtz_f16_f32 v137, v120, v121
v_cvt_pkrtz_f16_f32 v139, v122, v123
v_cvt_pkrtz_f16_f32 v141, v124, v125
v_cvt_pkrtz_f16_f32 v143, v126, v127
v_cvt_pkrtz_f16_f32 v177, v128, v129
v_cvt_pk_f16_f32 v155, v130, v131
v_cvt_pk_f16_f32 v152, v132, v133
v_cvt_pk_f16_f32 v149, v134, v135
s_add_u32 m0, s67, 39936
s_add_u32 s66, s66, 98304
buffer_load_dwordx4 v240, s[4:7], s66 offen lds
ds_read_b128 v[228:231], v249 offset:23552
v_mfma_f32_32x32x16_bf16 v[120:135], v[72:75], v[232:235], 0
v_pk_fma_f16 v154, v155, v155, s48
v_cvt_pk_bf16_f32 v96, v0, v1
v_and_b32 v137, s49, v137
v_fma_mix_f32 v165, v178, v178, v165 op_sel:[0,0,0] op_sel_hi:[1,1,0]
v_cvt_pk_bf16_f32 v97, v2, v3
v_pk_fma_f16 v151, v152, v152, s48
v_pk_fma_f16 v148, v149, v149, s48
v_bfe_u32 v136, v137, 2, 14
v_cvt_pk_bf16_f32 v98, v4, v5
v_pk_mul_f16 v154, v155, v154
v_pk_mul_f16 v151, v152, v151
v_fma_mix_f32 v165, v179, v179, v165 op_sel:[1,1,0] op_sel_hi:[1,1,0]
v_cvt_pk_bf16_f32 v99, v6, v7
v_lshrrev_b32_e64 v137, 18, v137
s_add_u32 m0, s67, 46592
s_add_u32 s66, s66, 98304
buffer_load_dwordx4 v240, s[4:7], s66 offen lds
ds_read_b128 v[232:235], v248 offset:16384
ds_read_u16_d16 v136, v136
ds_read_u16_d16_hi v137, v137
v_mfma_f32_32x32x16_bf16 v[120:135], v[76:79], v[236:239], v[120:135]
v_pk_mul_f16 v148, v149, v148
v_exp_f16_e64 v153, v154
v_cvt_pk_bf16_f32 v100, v8, v9
v_exp_f16_e64 v150, v151
v_cvt_pk_bf16_f32 v101, v10, v11
v_and_b32_e64 v139, s49, v139
v_fma_mix_f32 v165, v180, v180, v165 op_sel:[0,0,0] op_sel_hi:[1,1,0]
v_cvt_pk_bf16_f32 v102, v12, v13
v_exp_f16_e64 v147, v148
v_bfe_u32 v138, v139, 2, 14
v_cvt_pk_bf16_f32 v103, v14, v15
s_add_u32 m0, s67, 53248
s_add_u32 s66, s66, 98304
buffer_load_dwordx4 v240, s[4:7], s66 offen lds
ds_read_b128 v[236:239], v248 offset:19456
ds_read_u16_d16 v138, v138
v_mfma_f32_32x32x16_bf16 v[120:135], v[80:83], v[216:219], v[120:135]
v_exp_f16_sdwa v153, v154 dst_sel:WORD_1 dst_unused:UNUSED_PRESERVE src0_sel:WORD_1
v_lshrrev_b32_e64 v139, 18, v139
v_cvt_pk_bf16_f32 v104, v16, v17
v_fma_mix_f32 v165, v181, v181, v165 op_sel:[1,1,0] op_sel_hi:[1,1,0]
v_exp_f16_sdwa v150, v151 dst_sel:WORD_1 dst_unused:UNUSED_PRESERVE src0_sel:WORD_1
v_cvt_pk_bf16_f32 v105, v18, v19
v_exp_f16_sdwa v147, v148 dst_sel:WORD_1 dst_unused:UNUSED_PRESERVE src0_sel:WORD_1
v_cvt_pk_bf16_f32 v106, v20, v21
v_and_b32 v141, s49, v141
v_fma_mix_f32 v165, v182, v182, v165 op_sel:[0,0,0] op_sel_hi:[1,1,0]
v_pk_add_f16 v153, v153, 1.0 op_sel_hi:[1,0]
s_add_u32 m0, s67, 59904
s_add_u32 s66, s66, 98304
buffer_load_dwordx4 v240, s[4:7], s66 offen lds
s_add_u32 m0, s67, 0
s_add_u32 s66, s66, 98304
buffer_load_dwordx4 v240, s[4:7], s66 offen lds
ds_read_b128 v[216:219], v248 offset:17408
ds_read_u16_d16_hi v139, v139
v_mfma_f32_32x32x16_bf16 v[120:135], v[84:87], v[220:223], v[120:135]
v_cvt_pk_bf16_f32 v107, v22, v23
v_bfe_u32 v140, v141, 2, 14
v_pk_add_f16 v150, v150, 1.0 op_sel_hi:[1,0]
v_pk_add_f16 v147, v147, 1.0 op_sel_hi:[1,0]
v_cvt_pk_bf16_f32 v108, v24, v25
v_rcp_f16 v154, v153
v_lshrrev_b32 v141, 18, v141
v_cvt_pk_bf16_f32 v109, v26, v27
v_fma_mix_f32 v165, v183, v183, v165 op_sel:[1,1,0] op_sel_hi:[1,1,0]
v_rcp_f16_e64 v151, v150
v_cvt_pk_bf16_f32 v110, v28, v29
v_and_b32_e64 v143, s49, v143
s_add_u32 m0, s67, 6656
s_add_u32 s66, s66, 98304
buffer_load_dwordx4 v240, s[4:7], s66 offen lds
ds_read_b128 v[220:223], v248 offset:20480
ds_read_u16_d16 v140, v140
ds_read_u16_d16_hi v141, v141
v_mfma_f32_32x32x16_bf16 v[120:135], v[88:91], v[224:227], v[120:135]
v_rcp_f16 v148, v147
v_cvt_pk_bf16_f32 v111, v30, v31
v_fma_mix_f32 v165, v184, v184, v165 op_sel:[0,0,0] op_sel_hi:[1,1,0]
v_bfe_u32 v142, v143, 2, 14
v_cvt_pk_bf16_f32 v112, v32, v33
s_setprio 0
v_rcp_f16_sdwa v154, v153 dst_sel:WORD_1 dst_unused:UNUSED_PRESERVE src0_sel:WORD_1
v_rcp_f16_sdwa v151, v150 dst_sel:WORD_1 dst_unused:UNUSED_PRESERVE src0_sel:WORD_1
v_cvt_pk_bf16_f32 v113, v34, v35
v_lshrrev_b32 v143, 18, v143
s_waitcnt lgkmcnt(3)
v_fma_mix_f32 v165, v185, v185, v165 op_sel:[1,1,0] op_sel_hi:[1,1,0]
v_cvt_pk_bf16_f32 v114, v36, v37
s_add_u32 m0, s67, 13312
s_add_u32 s66, s66, 98304
buffer_load_dwordx4 v240, s[4:7], s66 offen lds
ds_read_b128 v[224:227], v248 offset:18432
ds_read_u16_d16 v142, v142
ds_read_u16_d16_hi v143, v143
v_mfma_f32_32x32x16_bf16 v[120:135], v[92:95], v[228:231], v[120:135]
v_rcp_f16_sdwa v148, v147 dst_sel:WORD_1 dst_unused:UNUSED_PRESERVE src0_sel:WORD_1
v_and_b32_e64 v177, s49, v177
v_cvt_pk_bf16_f32 v115, v38, v39
v_pk_mul_f16 v155, v155, v154
v_fma_mix_f32 v165, v186, v186, v165 op_sel:[0,0,0] op_sel_hi:[1,1,0]
v_cvt_pk_bf16_f32 v116, v40, v41
v_pk_mul_f16 v152, v152, v151
v_bfe_u32 v176, v177, 2, 14
v_pk_mul_f16 v149, v149, v148
v_cvt_pk_bf16_f32 v117, v42, v43
v_fma_mix_f32 v166, v155, v155, v166 op_sel:[0,0,0] op_sel_hi:[1,1,0]
v_fma_mix_f32 v166, v155, v155, v166 op_sel:[1,1,0] op_sel_hi:[1,1,0]
v_lshrrev_b32 v177, 18, v177
s_add_u32 m0, s67, 19968
s_add_u32 s66, s66, 98304
buffer_load_dwordx4 v240, s[4:7], s66 offen lds
v_cvt_pk_bf16_f32 v118, v44, v45
v_fma_mix_f32 v165, v187, v187, v165 op_sel:[1,1,0] op_sel_hi:[1,1,0]
v_fma_mix_f32 v166, v152, v152, v166 op_sel:[0,0,0] op_sel_hi:[1,1,0]
v_fma_mix_f32 v166, v152, v152, v166 op_sel:[1,1,0] op_sel_hi:[1,1,0]
v_cvt_pk_bf16_f32 v119, v46, v47
v_fma_mix_f32 v166, v149, v149, v166 op_sel:[0,0,0] op_sel_hi:[1,1,0]
v_fma_mix_f32 v166, v149, v149, v166 op_sel:[1,1,0] op_sel_hi:[1,1,0]
s_setprio 2
v_cvt_pkrtz_f16_f32 v179, v120, v121
v_cvt_pkrtz_f16_f32 v181, v122, v123
v_cvt_pkrtz_f16_f32 v183, v124, v125
v_cvt_pkrtz_f16_f32 v185, v126, v127
v_cvt_pkrtz_f16_f32 v187, v128, v129
v_cvt_pk_f16_f32 v155, v130, v131
v_cvt_pk_f16_f32 v152, v132, v133
v_cvt_pk_f16_f32 v149, v134, v135
ds_read_b128 v[228:231], v248 offset:21504
ds_read_u16_d16 v176, v176
ds_read_u16_d16_hi v177, v177
v_mfma_f32_32x32x16_bf16 v[120:135], v[96:99], v[232:235], 0
v_pk_fma_f16 v154, v155, v155, s48
v_and_b32_e64 v179, s49, v179
v_fma_mix_f32 v166, v136, v136, v166 op_sel:[0,0,0] op_sel_hi:[1,1,0]
v_pk_fma_f16 v151, v152, v152, s48
v_pk_fma_f16 v148, v149, v149, s48
v_bfe_u32 v178, v179, 2, 14
v_pk_mul_f16 v154, v155, v154
v_pk_mul_f16 v151, v152, v151
v_fma_mix_f32 v166, v137, v137, v166 op_sel:[1,1,0] op_sel_hi:[1,1,0]
v_lshrrev_b32_e64 v179, 18, v179
ds_read_b128 v[232:235], v248 offset:22528
ds_read_u16_d16 v178, v178
ds_read_u16_d16_hi v179, v179
v_mfma_f32_32x32x16_bf16 v[120:135], v[100:103], v[236:239], v[120:135]
v_pk_mul_f16 v148, v149, v148
v_exp_f16 v153, v154
v_exp_f16 v150, v151
v_and_b32_e64 v181, s49, v181
v_fma_mix_f32 v166, v138, v138, v166 op_sel:[0,0,0] op_sel_hi:[1,1,0]
v_exp_f16_e64 v147, v148
v_bfe_u32 v180, v181, 2, 14
ds_read_b128 v[236:239], v248 offset:25600
ds_read_u16_d16 v180, v180
v_mfma_f32_32x32x16_bf16 v[120:135], v[104:107], v[216:219], v[120:135]
v_exp_f16_sdwa v153, v154 dst_sel:WORD_1 dst_unused:UNUSED_PRESERVE src0_sel:WORD_1
v_lshrrev_b32_e64 v181, 18, v181
v_fma_mix_f32 v166, v139, v139, v166 op_sel:[1,1,0] op_sel_hi:[1,1,0]
v_exp_f16_sdwa v150, v151 dst_sel:WORD_1 dst_unused:UNUSED_PRESERVE src0_sel:WORD_1
v_exp_f16_sdwa v147, v148 dst_sel:WORD_1 dst_unused:UNUSED_PRESERVE src0_sel:WORD_1
v_and_b32 v183, s49, v183
s_waitcnt lgkmcnt(5)
v_fma_mix_f32 v166, v140, v140, v166 op_sel:[0,0,0] op_sel_hi:[1,1,0]
ds_read_b128 v[216:219], v248 offset:23552
ds_read_u16_d16_hi v181, v181
v_mfma_f32_32x32x16_bf16 v[120:135], v[108:111], v[220:223], v[120:135]
v_pk_add_f16 v153, v153, 1.0 op_sel_hi:[1,0]
v_bfe_u32 v182, v183, 2, 14
v_pk_add_f16 v150, v150, 1.0 op_sel_hi:[1,0]
v_pk_add_f16 v147, v147, 1.0 op_sel_hi:[1,0]
v_rcp_f16 v154, v153
v_lshrrev_b32 v183, 18, v183
v_fma_mix_f32 v166, v141, v141, v166 op_sel:[1,1,0] op_sel_hi:[1,1,0]
v_rcp_f16_e64 v151, v150
ds_read_b128 v[220:223], v248 offset:26624
ds_read_u16_d16 v182, v182
ds_read_u16_d16_hi v183, v183
v_mfma_f32_32x32x16_bf16 v[120:135], v[112:115], v[224:227], v[120:135]
v_and_b32 v185, s49, v185
v_rcp_f16 v148, v147
v_fma_mix_f32 v166, v142, v142, v166 op_sel:[0,0,0] op_sel_hi:[1,1,0]
v_bfe_u32 v184, v185, 2, 14
v_rcp_f16_sdwa v154, v153 dst_sel:WORD_1 dst_unused:UNUSED_PRESERVE src0_sel:WORD_1
v_rcp_f16_sdwa v151, v150 dst_sel:WORD_1 dst_unused:UNUSED_PRESERVE src0_sel:WORD_1
v_lshrrev_b32_e64 v185, 18, v185
ds_read_b128 v[224:227], v248 offset:24576
ds_read_u16_d16 v184, v184
ds_read_u16_d16_hi v185, v185
v_mfma_f32_32x32x16_bf16 v[120:135], v[116:119], v[228:231], v[120:135]
v_fma_mix_f32 v166, v143, v143, v166 op_sel:[1,1,0] op_sel_hi:[1,1,0]
v_rcp_f16_sdwa v148, v147 dst_sel:WORD_1 dst_unused:UNUSED_PRESERVE src0_sel:WORD_1
s_cmp_eq_u32 s40, 7
s_cbranch_scc1 Lrdy24
s_waitcnt vmcnt(0)
Lrdy24:
s_mov_b64 exec, 1
ds_add_u32 v253, v254 offset:12
s_mov_b64 exec, -1
v_and_b32 v187, s49, v187
v_pk_mul_f16 v155, v155, v154
v_fma_mix_f32 v166, v176, v176, v166 op_sel:[0,0,0] op_sel_hi:[1,1,0]
v_pk_mul_f16 v152, v152, v151
v_bfe_u32 v186, v187, 2, 14
v_pk_mul_f16 v149, v149, v148
v_fma_mix_f32 v167, v155, v155, v167 op_sel:[0,0,0] op_sel_hi:[1,1,0]
v_fma_mix_f32 v167, v155, v155, v167 op_sel:[1,1,0] op_sel_hi:[1,1,0]
v_lshrrev_b32_e64 v187, 18, v187
v_fma_mix_f32 v166, v177, v177, v166 op_sel:[1,1,0] op_sel_hi:[1,1,0]
v_fma_mix_f32 v167, v152, v152, v167 op_sel:[0,0,0] op_sel_hi:[1,1,0]
v_fma_mix_f32 v167, v152, v152, v167 op_sel:[1,1,0] op_sel_hi:[1,1,0]
v_fma_mix_f32 v167, v149, v149, v167 op_sel:[0,0,0] op_sel_hi:[1,1,0]
v_fma_mix_f32 v167, v149, v149, v167 op_sel:[1,1,0] op_sel_hi:[1,1,0]
s_cmp_lg_u32 s40, 7
s_cbranch_scc1 Lnoinit
s_waitcnt vmcnt(13)
v_mov_b32_e64 v255, 1
s_mov_b64 exec, 1
buffer_atomic_add v255, v241, s[36:39], 0 offen
s_mov_b64 exec, -1
Lnoinit:
s_setprio 1
v_cvt_pkrtz_f16_f32 v137, v120, v121
v_cvt_pkrtz_f16_f32 v139, v122, v123
v_cvt_pkrtz_f16_f32 v141, v124, v125
v_cvt_pkrtz_f16_f32 v143, v126, v127
v_cvt_pkrtz_f16_f32 v177, v128, v129
v_cvt_pk_f16_f32 v155, v130, v131
v_cvt_pk_f16_f32 v152, v132, v133
v_cvt_pk_f16_f32 v149, v134, v135
s_waitcnt lgkmcnt(1)
s_add_u32 s46, s80, 12582912
buffer_store_dwordx4 v[72:75], v241, s[32:35], s46 offen sc1
ds_read_b128 v[228:231], v248 offset:27648
ds_read_u16_d16 v186, v186
ds_read_u16_d16_hi v187, v187
v_mfma_f32_32x32x16_bf16 v[120:135], v[96:99], v[232:235], 0
v_pk_fma_f16 v154, v155, v155, s48
v_and_b32 v137, s49, v137
v_fma_mix_f32 v167, v178, v178, v167 op_sel:[0,0,0] op_sel_hi:[1,1,0]
v_pk_fma_f16 v151, v152, v152, s48
v_pk_fma_f16 v148, v149, v149, s48
v_bfe_u32 v136, v137, 2, 14
v_pk_mul_f16 v154, v155, v154
v_pk_mul_f16 v151, v152, v151
v_fma_mix_f32 v167, v179, v179, v167 op_sel:[1,1,0] op_sel_hi:[1,1,0]
v_lshrrev_b32_e64 v137, 18, v137
ds_read_b128 v[232:235], v250 offset:65520
ds_read_u16_d16 v136, v136
ds_read_u16_d16_hi v137, v137
v_mfma_f32_32x32x16_bf16 v[120:135], v[100:103], v[236:239], v[120:135]
v_pk_mul_f16 v148, v149, v148
v_exp_f16 v153, v154
v_exp_f16 v150, v151
v_and_b32_e64 v139, s49, v139
v_fma_mix_f32 v167, v180, v180, v167 op_sel:[0,0,0] op_sel_hi:[1,1,0]
v_exp_f16_e64 v147, v148
v_bfe_u32 v138, v139, 2, 14
ds_read_b128 v[236:239], v248 offset:28672
ds_read_b32 v247, v253 offset:12
ds_read_u16_d16 v138, v138
v_mfma_f32_32x32x16_bf16 v[120:135], v[104:107], v[216:219], v[120:135]
v_exp_f16_sdwa v153, v154 dst_sel:WORD_1 dst_unused:UNUSED_PRESERVE src0_sel:WORD_1
v_lshrrev_b32_e64 v139, 18, v139
v_fma_mix_f32 v167, v181, v181, v167 op_sel:[1,1,0] op_sel_hi:[1,1,0]
v_exp_f16_sdwa v150, v151 dst_sel:WORD_1 dst_unused:UNUSED_PRESERVE src0_sel:WORD_1
v_exp_f16_sdwa v147, v148 dst_sel:WORD_1 dst_unused:UNUSED_PRESERVE src0_sel:WORD_1
v_and_b32_e64 v141, s49, v141
v_fma_mix_f32 v167, v182, v182, v167 op_sel:[0,0,0] op_sel_hi:[1,1,0]
ds_read_b128 v[216:219], v248 offset:31744
ds_read_u16_d16_hi v139, v139
v_mfma_f32_32x32x16_bf16 v[120:135], v[108:111], v[220:223], v[120:135]
v_pk_add_f16 v153, v153, 1.0 op_sel_hi:[1,0]
v_bfe_u32 v140, v141, 2, 14
v_pk_add_f16 v150, v150, 1.0 op_sel_hi:[1,0]
v_pk_add_f16 v147, v147, 1.0 op_sel_hi:[1,0]
v_rcp_f16 v154, v153
v_lshrrev_b32 v141, 18, v141
v_fma_mix_f32 v167, v183, v183, v167 op_sel:[1,1,0] op_sel_hi:[1,1,0]
ds_read_u16_d16 v140, v140
ds_read_u16_d16_hi v141, v141
s_waitcnt lgkmcnt(5)
v_readfirstlane_b32 s43, v247
s_nop 1
s_cmp_ge_u32 s43, 32
s_cbranch_scc1 Lev8
Lev8w:
s_sleep 1
ds_read_b32 v247, v253 offset:12
s_waitcnt lgkmcnt(0)
v_readfirstlane_b32 s43, v247
s_cmp_eq_u32 s76, 0
s_cbranch_scc1 Lev8
s_sub_u32 s76, s76, 1
s_cmp_lt_u32 s43, 32
s_cbranch_scc1 Lev8w
Lev8:
v_rcp_f16 v151, v150
ds_read_b128 v[220:223], v248 offset:29696
v_mfma_f32_32x32x16_bf16 v[120:135], v[112:115], v[224:227], v[120:135]
v_and_b32 v143, s49, v143
v_rcp_f16 v148, v147
v_fma_mix_f32 v167, v184, v184, v167 op_sel:[0,0,0] op_sel_hi:[1,1,0]
v_bfe_u32 v142, v143, 2, 14
s_setprio 0
v_rcp_f16_sdwa v154, v153 dst_sel:WORD_1 dst_unused:UNUSED_PRESERVE src0_sel:WORD_1
v_rcp_f16_sdwa v151, v150 dst_sel:WORD_1 dst_unused:UNUSED_PRESERVE src0_sel:WORD_1
v_lshrrev_b32 v143, 18, v143
ds_read_b128 v[224:227], v245 offset:6528
ds_read_b128 v[192:195], v244 offset:128
ds_read_b128 v[196:199], v244 offset:64
ds_read_u16_d16 v142, v142
ds_read_u16_d16_hi v143, v143
v_mfma_f32_32x32x16_bf16 v[120:135], v[116:119], v[228:231], v[120:135]
v_fma_mix_f32 v167, v185, v185, v167 op_sel:[1,1,0] op_sel_hi:[1,1,0]
v_rcp_f16_sdwa v148, v147 dst_sel:WORD_1 dst_unused:UNUSED_PRESERVE src0_sel:WORD_1
v_and_b32_e64 v177, s49, v177
v_pk_mul_f16 v155, v155, v154
v_fma_mix_f32 v167, v186, v186, v167 op_sel:[0,0,0] op_sel_hi:[1,1,0]
v_pk_mul_f16 v152, v152, v151
v_bfe_u32 v176, v177, 2, 14
v_pk_mul_f16 v149, v149, v148
v_fma_mix_f32 v156, v155, v155, v156 op_sel:[0,0,0] op_sel_hi:[1,1,0]
v_fma_mix_f32 v156, v155, v155, v156 op_sel:[1,1,0] op_sel_hi:[1,1,0]
v_lshrrev_b32 v177, 18, v177
v_fma_mix_f32 v167, v187, v187, v167 op_sel:[1,1,0] op_sel_hi:[1,1,0]
v_fma_mix_f32 v156, v152, v152, v156 op_sel:[0,0,0] op_sel_hi:[1,1,0]
v_fma_mix_f32 v156, v152, v152, v156 op_sel:[1,1,0] op_sel_hi:[1,1,0]
v_fma_mix_f32 v156, v149, v149, v156 op_sel:[0,0,0] op_sel_hi:[1,1,0]
v_fma_mix_f32 v156, v149, v149, v156 op_sel:[1,1,0] op_sel_hi:[1,1,0]
s_setprio 2
v_mfma_f32_32x32x16_bf16 v[0:15], v[232:235], v[232:235], 0
s_add_u32 s46, s80, 14680064
buffer_store_dwordx4 v[76:79], v241, s[32:35], s46 offen sc1
ds_read_b128 v[228:231], v248 offset:32768
ds_read_u16_d16 v176, v176
ds_read_u16_d16_hi v177, v177
v_cvt_pkrtz_f16_f32 v179, v120, v121
v_cvt_pkrtz_f16_f32 v181, v122, v123
v_cvt_pkrtz_f16_f32 v183, v124, v125
v_mfma_f32_32x32x16_bf16 v[16:31], v[232:235], v[232:235], 0
v_cvt_pkrtz_f16_f32 v185, v126, v127
v_cvt_pkrtz_f16_f32 v187, v128, v129
v_cvt_pk_f16_f32 v155, v130, v131
v_cvt_pk_f16_f32 v152, v132, v133
v_mfma_f32_32x32x16_bf16 v[32:47], v[232:235], v[232:235], 0
v_cvt_pk_f16_f32 v149, v134, v135
v_pk_fma_f16 v154, v155, v155, s48
v_and_b32_e64 v179, s49, v179
v_mfma_f32_32x32x16_bf16 v[120:135], v[96:99], v[236:239], 0
ds_read_b128 v[232:235], v248 offset:30720
v_fma_mix_f32 v156, v136, v136, v156 op_sel:[0,0,0] op_sel_hi:[1,1,0]
v_pk_fma_f16 v151, v152, v152, s48
v_pk_fma_f16 v148, v149, v149, s48
v_bfe_u32 v178, v179, 2, 14
v_pk_mul_f16 v154, v155, v154
v_pk_mul_f16 v151, v152, v151
v_fma_mix_f32 v156, v137, v137, v156 op_sel:[1,1,0] op_sel_hi:[1,1,0]
s_waitcnt lgkmcnt(4)
v_mfma_f32_32x32x16_bf16 v[120:135], v[100:103], v[216:219], v[120:135]
ds_read_b128 v[236:239], v245 offset:6144
ds_read_b128 v[200:203], v244
ds_read_b128 v[204:207], v243 offset:128
ds_read_u16_d16 v178, v178
v_lshrrev_b32 v179, 18, v179
v_pk_mul_f16 v148, v149, v148
v_exp_f16 v153, v154
v_exp_f16 v150, v151
v_and_b32_e64 v181, s49, v181
v_fma_mix_f32 v156, v138, v138, v156 op_sel:[0,0,0] op_sel_hi:[1,1,0]
v_mfma_f32_32x32x16_bf16 v[120:135], v[104:107], v[220:223], v[120:135]
ds_read_b128 v[216:219], v248 offset:33792
ds_read_u16_d16_hi v179, v179
v_exp_f16_e64 v147, v148
v_bfe_u32 v180, v181, 2, 14
v_exp_f16_sdwa v153, v154 dst_sel:WORD_1 dst_unused:UNUSED_PRESERVE src0_sel:WORD_1
v_lshrrev_b32_e64 v181, 18, v181
v_fma_mix_f32 v156, v139, v139, v156 op_sel:[1,1,0] op_sel_hi:[1,1,0]
v_smfmac_f32_16x16x32_bf16 v[40:43], v[226:227], v[192:195], v246
ds_read_b128 v[220:223], v245 offset:5760
ds_read_b128 v[208:211], v243 offset:64
ds_read_b128 v[212:215], v243
ds_read_u16_d16 v180, v180
ds_read_u16_d16_hi v181, v181
v_exp_f16_sdwa v150, v151 dst_sel:WORD_1 dst_unused:UNUSED_PRESERVE src0_sel:WORD_1
v_smfmac_f32_16x16x32_bf16 v[24:27], v[224:225], v[196:199], v246
v_exp_f16_sdwa v147, v148 dst_sel:WORD_1 dst_unused:UNUSED_PRESERVE src0_sel:WORD_1
v_and_b32 v183, s49, v183
v_fma_mix_f32 v156, v140, v140, v156 op_sel:[0,0,0] op_sel_hi:[1,1,0]
v_pk_add_f16 v153, v153, 1.0 op_sel_hi:[1,0]
s_waitcnt lgkmcnt(7)
v_mfma_f32_32x32x16_bf16 v[120:135], v[108:111], v[228:231], v[120:135]
ds_read_b128 v[224:227], v245 offset:5376
ds_read_b128 v[192:195], v242 offset:128
ds_read_b128 v[196:199], v242 offset:64
v_bfe_u32 v182, v183, 2, 14
v_pk_add_f16 v150, v150, 1.0 op_sel_hi:[1,0]
v_pk_add_f16 v147, v147, 1.0 op_sel_hi:[1,0]
v_rcp_f16 v154, v153
v_lshrrev_b32 v183, 18, v183
v_fma_mix_f32 v156, v141, v141, v156 op_sel:[1,1,0] op_sel_hi:[1,1,0]
v_mfma_f32_32x32x16_bf16 v[120:135], v[112:115], v[232:235], v[120:135]
ds_read_b128 v[228:231], v248 offset:34816
ds_read_u16_d16 v182, v182
ds_read_u16_d16_hi v183, v183
v_rcp_f16 v151, v150
v_and_b32 v185, s49, v185
v_rcp_f16_e64 v148, v147
v_fma_mix_f32 v156, v142, v142, v156 op_sel:[0,0,0] op_sel_hi:[1,1,0]
v_bfe_u32 v184, v185, 2, 14
v_smfmac_f32_16x16x32_bf16 v[8:11], v[238:239], v[200:203], v246
ds_read_b128 v[232:235], v248 offset:37888
ds_read_u16_d16 v184, v184
v_rcp_f16_sdwa v154, v153 dst_sel:WORD_1 dst_unused:UNUSED_PRESERVE src0_sel:WORD_1
v_rcp_f16_sdwa v151, v150 dst_sel:WORD_1 dst_unused:UNUSED_PRESERVE src0_sel:WORD_1
v_smfmac_f32_16x16x32_bf16 v[40:43], v[236:237], v[204:207], v246
v_lshrrev_b32 v185, 18, v185
v_fma_mix_f32 v156, v143, v143, v156 op_sel:[1,1,0] op_sel_hi:[1,1,0]
s_waitcnt lgkmcnt(6)
v_mfma_f32_32x32x16_bf16 v[120:135], v[116:119], v[216:219], v[120:135]
ds_read_b128 v[236:239], v248 offset:35840
ds_read_u16_d16_hi v185, v185
v_rcp_f16_sdwa v148, v147 dst_sel:WORD_1 dst_unused:UNUSED_PRESERVE src0_sel:WORD_1
v_and_b32_e64 v187, s49, v187
v_pk_mul_f16 v155, v155, v154
v_fma_mix_f32 v156, v176, v176, v156 op_sel:[0,0,0] op_sel_hi:[1,1,0]
v_pk_mul_f16 v152, v152, v151
v_bfe_u32 v186, v187, 2, 14
v_pk_mul_f16 v149, v149, v148
v_smfmac_f32_16x16x32_bf16 v[24:27], v[222:223], v[208:211], v246
ds_read_b128 v[216:219], v248 offset:38912
ds_read_u16_d16 v186, v186
v_fma_mix_f32 v157, v155, v155, v157 op_sel:[0,0,0] op_sel_hi:[1,1,0]
v_fma_mix_f32 v157, v155, v155, v157 op_sel:[1,1,0] op_sel_hi:[1,1,0]
v_lshrrev_b32_e64 v187, 18, v187
v_fma_mix_f32 v156, v177, v177, v156 op_sel:[1,1,0] op_sel_hi:[1,1,0]
v_smfmac_f32_16x16x32_bf16 v[8:11], v[220:221], v[212:215], v246
v_fma_mix_f32 v157, v152, v152, v157 op_sel:[0,0,0] op_sel_hi:[1,1,0]
v_fma_mix_f32 v157, v152, v152, v157 op_sel:[1,1,0] op_sel_hi:[1,1,0]
v_fma_mix_f32 v157, v149, v149, v157 op_sel:[0,0,0] op_sel_hi:[1,1,0]
v_fma_mix_f32 v157, v149, v149, v157 op_sel:[1,1,0] op_sel_hi:[1,1,0]
s_setprio 1
v_smfmac_f32_16x16x32_bf16 v[40:43], v[226:227], v[192:195], v246
s_waitcnt lgkmcnt(4)
s_add_u32 s46, s80, 16777216
buffer_store_dwordx4 v[80:83], v241, s[32:35], s46 offen sc1
ds_read_b128 v[220:223], v248 offset:36864
ds_read_u16_d16_hi v187, v187
v_cvt_pkrtz_f16_f32 v137, v120, v121
v_cvt_pkrtz_f16_f32 v139, v122, v123
v_cvt_pkrtz_f16_f32 v141, v124, v125
v_cvt_pkrtz_f16_f32 v143, v126, v127
v_cvt_pk_f16_f32 v155, v128, v129
v_smfmac_f32_16x16x32_bf16 v[24:27], v[224:225], v[196:199], v246
v_cvt_pk_f16_f32 v152, v130, v131
v_cvt_pk_f16_f32 v149, v132, v133
v_cvt_pk_f16_f32 v146, v134, v135
v_pk_fma_f16 v154, v155, v155, s48
v_and_b32_e64 v137, s49, v137
v_mfma_f32_32x32x16_bf16 v[120:135], v[96:99], v[228:231], 0
ds_read_b128 v[224:227], v248 offset:39936
v_fma_mix_f32 v157, v178, v178, v157 op_sel:[0,0,0] op_sel_hi:[1,1,0]
v_pk_fma_f16 v151, v152, v152, s48
v_pk_fma_f16 v148, v149, v149, s48
v_pk_fma_f16 v145, v146, v146, s48
v_pk_mul_f16 v154, v155, v154
v_bfe_u32 v136, v137, 2, 14
v_pk_mul_f16 v151, v152, v151
v_fma_mix_f32 v157, v179, v179, v157 op_sel:[1,1,0] op_sel_hi:[1,1,0]
v_pk_mul_f16 v148, v149, v148
v_pk_mul_f16 v145, v146, v145
v_mfma_f32_32x32x16_bf16 v[120:135], v[100:103], v[232:235], v[120:135]
ds_read_b128 v[228:231], v245 offset:4992
ds_read_b128 v[200:203], v242
v_xor_b32 v244, 16, v244
ds_read_b128 v[204:207], v244 offset:128
ds_read_u16_d16 v136, v136
v_exp_f16 v153, v154
v_lshrrev_b32 v137, 18, v137
v_exp_f16 v150, v151
v_fma_mix_f32 v157, v180, v180, v157 op_sel:[0,0,0] op_sel_hi:[1,1,0]
v_exp_f16 v147, v148
v_and_b32 v139, s49, v139
v_exp_f16 v144, v145
s_waitcnt lgkmcnt(5)
v_mfma_f32_32x32x16_bf16 v[120:135], v[104:107], v[236:239], v[120:135]
ds_read_b128 v[232:235], v245 offset:4608
ds_read_b128 v[208:211], v244 offset:64
ds_read_b128 v[212:215], v244
ds_read_u16_d16_hi v137, v137
v_exp_f16_sdwa v153, v154 dst_sel:WORD_1 dst_unused:UNUSED_PRESERVE src0_sel:WORD_1
v_fma_mix_f32 v157, v181, v181, v157 op_sel:[1,1,0] op_sel_hi:[1,1,0]
v_bfe_u32 v138, v139, 2, 14
v_exp_f16_sdwa v150, v151 dst_sel:WORD_1 dst_unused:UNUSED_PRESERVE src0_sel:WORD_1
v_exp_f16_sdwa v147, v148 dst_sel:WORD_1 dst_unused:UNUSED_PRESERVE src0_sel:WORD_1
v_exp_f16_sdwa v144, v145 dst_sel:WORD_1 dst_unused:UNUSED_PRESERVE src0_sel:WORD_1
v_lshrrev_b32_e64 v139, 18, v139
v_fma_mix_f32 v157, v182, v182, v157 op_sel:[0,0,0] op_sel_hi:[1,1,0]
v_mfma_f32_32x32x16_bf16 v[120:135], v[108:111], v[216:219], v[120:135]
ds_read_b128 v[236:239], v248 offset:40960
ds_read_u16_d16 v138, v138
ds_read_u16_d16_hi v139, v139
v_pk_add_f16 v153, v153, 1.0 op_sel_hi:[1,0]
v_pk_add_f16 v150, v150, 1.0 op_sel_hi:[1,0]
v_pk_add_f16 v147, v147, 1.0 op_sel_hi:[1,0]
v_and_b32_e64 v141, s49, v141
v_pk_add_f16 v144, v144, 1.0 op_sel_hi:[1,0]
v_rcp_f16_e64 v154, v153
v_fma_mix_f32 v157, v183, v183, v157 op_sel:[1,1,0] op_sel_hi:[1,1,0]
v_rcp_f16_e64 v151, v150
v_mfma_f32_32x32x16_bf16 v[120:135], v[112:115], v[220:223], v[120:135]
ds_read_b128 v[216:219], v248 offset:44032
v_bfe_u32 v140, v141, 2, 14
v_rcp_f16_e64 v148, v147
v_fma_mix_f32 v157, v184, v184, v157 op_sel:[0,0,0] op_sel_hi:[1,1,0]
v_rcp_f16 v145, v144
v_lshrrev_b32 v141, 18, v141
v_rcp_f16_sdwa v154, v153 dst_sel:WORD_1 dst_unused:UNUSED_PRESERVE src0_sel:WORD_1
s_setprio 0
v_rcp_f16_sdwa v151, v150 dst_sel:WORD_1 dst_unused:UNUSED_PRESERVE src0_sel:WORD_1
s_waitcnt lgkmcnt(4)
v_mfma_f32_32x32x16_bf16 v[120:135], v[116:119], v[224:227], v[120:135]
ds_read_b128 v[220:223], v248 offset:41984
ds_read_u16_d16 v140, v140
ds_read_u16_d16_hi v141, v141
v_fma_mix_f32 v157, v185, v185, v157 op_sel:[1,1,0] op_sel_hi:[1,1,0]
v_and_b32_e64 v143, s49, v143
v_rcp_f16_sdwa v148, v147 dst_sel:WORD_1 dst_unused:UNUSED_PRESERVE src0_sel:WORD_1
v_rcp_f16_sdwa v145, v144 dst_sel:WORD_1 dst_unused:UNUSED_PRESERVE src0_sel:WORD_1
v_pk_mul_f16 v155, v155, v154
v_bfe_u32 v142, v143, 2, 14
v_fma_mix_f32 v157, v186, v186, v157 op_sel:[0,0,0] op_sel_hi:[1,1,0]
v_pk_mul_f16 v152, v152, v151
v_pk_mul_f16 v149, v149, v148
v_smfmac_f32_16x16x32_bf16 v[8:11], v[230:231], v[200:203], v246
ds_read_b128 v[224:227], v248 offset:45056
ds_read_u16_d16 v142, v142
v_pk_mul_f16 v146, v146, v145
v_fma_mix_f32 v158, v155, v155, v158 op_sel:[0,0,0] op_sel_hi:[1,1,0]
v_lshrrev_b32 v143, 18, v143
v_fma_mix_f32 v158, v155, v155, v158 op_sel:[1,1,0] op_sel_hi:[1,1,0]
v_fma_mix_f32 v158, v152, v152, v158 op_sel:[0,0,0] op_sel_hi:[1,1,0]
v_smfmac_f32_16x16x32_bf16 v[44:47], v[228:229], v[204:207], v246
v_fma_mix_f32 v157, v187, v187, v157 op_sel:[1,1,0] op_sel_hi:[1,1,0]
v_fma_mix_f32 v158, v152, v152, v158 op_sel:[1,1,0] op_sel_hi:[1,1,0]
v_fma_mix_f32 v158, v149, v149, v158 op_sel:[0,0,0] op_sel_hi:[1,1,0]
v_fma_mix_f32 v158, v149, v149, v158 op_sel:[1,1,0] op_sel_hi:[1,1,0]
v_fma_mix_f32 v158, v146, v146, v158 op_sel:[0,0,0] op_sel_hi:[1,1,0]
v_fma_mix_f32 v158, v146, v146, v158 op_sel:[1,1,0] op_sel_hi:[1,1,0]
s_setprio 2
v_smfmac_f32_16x16x32_bf16 v[28:31], v[234:235], v[208:211], v246
s_add_u32 s46, s80, 18874368
buffer_store_dwordx4 v[84:87], v241, s[32:35], s46 offen sc1
ds_read_b128 v[228:231], v248 offset:43008
ds_read_u16_d16_hi v143, v143
v_cvt_pkrtz_f16_f32 v179, v120, v121
v_cvt_pkrtz_f16_f32 v181, v122, v123
v_cvt_pkrtz_f16_f32 v183, v124, v125
v_cvt_pkrtz_f16_f32 v185, v126, v127
v_smfmac_f32_16x16x32_bf16 v[12:15], v[232:233], v[212:215], v246
v_cvt_pkrtz_f16_f32 v187, v128, v129
v_cvt_pk_f16_f32 v155, v130, v131
v_cvt_pk_f16_f32 v152, v132, v133
v_cvt_pk_f16_f32 v149, v134, v135
v_pk_fma_f16 v154, v155, v155, s48
s_waitcnt lgkmcnt(2)
v_mfma_f32_32x32x16_bf16 v[120:135], v[96:99], v[236:239], 0
ds_read_b128 v[232:235], v248 offset:46080
v_and_b32 v179, s49, v179
v_fma_mix_f32 v158, v136, v136, v158 op_sel:[0,0,0] op_sel_hi:[1,1,0]
v_pk_fma_f16 v151, v152, v152, s48
v_pk_fma_f16 v148, v149, v149, s48
v_bfe_u32 v178, v179, 2, 14
v_pk_mul_f16 v154, v155, v154
v_pk_mul_f16 v151, v152, v151
v_pk_mul_f16 v148, v149, v148
v_lshrrev_b32 v179, 18, v179
v_mfma_f32_32x32x16_bf16 v[120:135], v[100:103], v[216:219], v[120:135]
ds_read_b128 v[236:239], v245 offset:4224
v_xor_b32 v243, 16, v243
ds_read_b128 v[192:195], v243 offset:128
ds_read_b128 v[196:199], v243 offset:64
ds_read_u16_d16 v178, v178
ds_read_u16_d16_hi v179, v179
v_fma_mix_f32 v158, v137, v137, v158 op_sel:[1,1,0] op_sel_hi:[1,1,0]
v_exp_f16 v153, v154
v_and_b32 v181, s49, v181
v_exp_f16 v150, v151
v_exp_f16 v147, v148
v_bfe_u32 v180, v181, 2, 14
v_mfma_f32_32x32x16_bf16 v[120:135], v[104:107], v[220:223], v[120:135]
ds_read_b128 v[216:219], v245 offset:3840
ds_read_b128 v[200:203], v243
v_xor_b32 v242, 16, v242
ds_read_b128 v[204:207], v242 offset:128
ds_read_u16_d16 v180, v180
v_fma_mix_f32 v158, v138, v138, v158 op_sel:[0,0,0] op_sel_hi:[1,1,0]
v_exp_f16_sdwa v153, v154 dst_sel:WORD_1 dst_unused:UNUSED_PRESERVE src0_sel:WORD_1
v_lshrrev_b32 v181, 18, v181
v_exp_f16_sdwa v150, v151 dst_sel:WORD_1 dst_unused:UNUSED_PRESERVE src0_sel:WORD_1
v_fma_mix_f32 v158, v139, v139, v158 op_sel:[1,1,0] op_sel_hi:[1,1,0]
v_and_b32_e64 v183, s49, v183
v_mfma_f32_32x32x16_bf16 v[120:135], v[108:111], v[224:227], v[120:135]
ds_read_b128 v[220:223], v248 offset:47104
ds_read_u16_d16_hi v181, v181
v_exp_f16_sdwa v147, v148 dst_sel:WORD_1 dst_unused:UNUSED_PRESERVE src0_sel:WORD_1
v_pk_add_f16 v153, v153, 1.0 op_sel_hi:[1,0]
v_bfe_u32 v182, v183, 2, 14
v_pk_add_f16 v150, v150, 1.0 op_sel_hi:[1,0]
v_pk_add_f16 v147, v147, 1.0 op_sel_hi:[1,0]
v_rcp_f16_e64 v154, v153
v_lshrrev_b32 v183, 18, v183
v_fma_mix_f32 v158, v140, v140, v158 op_sel:[0,0,0] op_sel_hi:[1,1,0]
s_waitcnt lgkmcnt(6)
v_mfma_f32_32x32x16_bf16 v[120:135], v[112:115], v[228:231], v[120:135]
ds_read_b128 v[224:227], v248 offset:50176
ds_read_u16_d16 v182, v182
ds_read_u16_d16_hi v183, v183
v_rcp_f16 v151, v150
v_and_b32 v185, s49, v185
v_rcp_f16_e64 v148, v147
v_fma_mix_f32 v158, v141, v141, v158 op_sel:[1,1,0] op_sel_hi:[1,1,0]
v_bfe_u32 v184, v185, 2, 14
v_rcp_f16_sdwa v154, v153 dst_sel:WORD_1 dst_unused:UNUSED_PRESERVE src0_sel:WORD_1
v_mfma_f32_32x32x16_bf16 v[120:135], v[116:119], v[232:235], v[120:135]
ds_read_b128 v[228:231], v248 offset:48128
ds_read_u16_d16 v184, v184
v_rcp_f16_sdwa v151, v150 dst_sel:WORD_1 dst_unused:UNUSED_PRESERVE src0_sel:WORD_1
v_lshrrev_b32_e64 v185, 18, v185
v_rcp_f16_sdwa v148, v147 dst_sel:WORD_1 dst_unused:UNUSED_PRESERVE src0_sel:WORD_1
v_and_b32_e64 v187, s49, v187
v_fma_mix_f32 v158, v142, v142, v158 op_sel:[0,0,0] op_sel_hi:[1,1,0]
v_pk_mul_f16 v155, v155, v154
v_pk_mul_f16 v152, v152, v151
v_smfmac_f32_16x16x32_bf16 v[44:47], v[238:239], v[192:195], v246
ds_read_b128 v[232:235], v248 offset:51200
ds_read_u16_d16_hi v185, v185
v_bfe_u32 v186, v187, 2, 14
v_pk_mul_f16 v149, v149, v148
v_fma_mix_f32 v159, v155, v155, v159 op_sel:[0,0,0] op_sel_hi:[1,1,0]
v_fma_mix_f32 v158, v143, v143, v158 op_sel:[1,1,0] op_sel_hi:[1,1,0]
v_lshrrev_b32_e64 v187, 18, v187
v_smfmac_f32_16x16x32_bf16 v[28:31], v[236:237], v[196:199], v246
v_fma_mix_f32 v159, v155, v155, v159 op_sel:[1,1,0] op_sel_hi:[1,1,0]
v_fma_mix_f32 v159, v152, v152, v159 op_sel:[0,0,0] op_sel_hi:[1,1,0]
v_fma_mix_f32 v159, v152, v152, v159 op_sel:[1,1,0] op_sel_hi:[1,1,0]
v_fma_mix_f32 v159, v149, v149, v159 op_sel:[0,0,0] op_sel_hi:[1,1,0]
v_fma_mix_f32 v159, v149, v149, v159 op_sel:[1,1,0] op_sel_hi:[1,1,0]
s_setprio 1
s_waitcnt lgkmcnt(4)
v_smfmac_f32_16x16x32_bf16 v[12:15], v[218:219], v[200:203], v246
s_add_u32 s46, s80, 20971520
buffer_store_dwordx4 v[88:91], v241, s[32:35], s46 offen sc1
ds_read_b128 v[236:239], v248 offset:49152
ds_read_u16_d16 v186, v186
ds_read_u16_d16_hi v187, v187
v_cvt_pkrtz_f16_f32 v137, v120, v121
v_cvt_pkrtz_f16_f32 v139, v122, v123
v_cvt_pkrtz_f16_f32 v141, v124, v125
v_cvt_pkrtz_f16_f32 v143, v126, v127
v_cvt_pk_f16_f32 v155, v128, v129
v_smfmac_f32_16x16x32_bf16 v[44:47], v[216:217], v[204:207], v246
v_cvt_pk_f16_f32 v152, v130, v131
v_cvt_pk_f16_f32 v149, v132, v133
v_cvt_pk_f16_f32 v146, v134, v135
v_pk_fma_f16 v154, v155, v155, s48
v_and_b32_e64 v137, s49, v137
v_mfma_f32_32x32x16_bf16 v[120:135], v[96:99], v[220:223], 0
ds_read_b128 v[216:219], v248 offset:52224
v_fma_mix_f32 v159, v178, v178, v159 op_sel:[0,0,0] op_sel_hi:[1,1,0]
v_pk_fma_f16 v151, v152, v152, s48
v_pk_fma_f16 v148, v149, v149, s48
v_pk_fma_f16 v145, v146, v146, s48
v_pk_mul_f16 v154, v155, v154
v_bfe_u32 v136, v137, 2, 14
v_pk_mul_f16 v151, v152, v151
v_fma_mix_f32 v159, v179, v179, v159 op_sel:[1,1,0] op_sel_hi:[1,1,0]
v_pk_mul_f16 v148, v149, v148
v_pk_mul_f16 v145, v146, v145
v_mfma_f32_32x32x16_bf16 v[120:135], v[100:103], v[224:227], v[120:135]
ds_read_b128 v[220:223], v245 offset:3456
ds_read_b128 v[208:211], v242 offset:64
ds_read_b128 v[212:215], v242
ds_read_u16_d16 v136, v136
v_exp_f16 v153, v154
v_lshrrev_b32 v137, 18, v137
v_exp_f16_e64 v150, v151
v_fma_mix_f32 v159, v180, v180, v159 op_sel:[0,0,0] op_sel_hi:[1,1,0]
v_exp_f16 v147, v148
v_and_b32 v139, s49, v139
v_exp_f16_e64 v144, v145
s_waitcnt lgkmcnt(5)
v_mfma_f32_32x32x16_bf16 v[120:135], v[104:107], v[228:231], v[120:135]
ds_read_b128 v[224:227], v245 offset:3072
v_xor_b32 v244, 32, v244
ds_read_b128 v[192:195], v244 offset:128
ds_read_b128 v[196:199], v244 offset:64
ds_read_u16_d16_hi v137, v137
v_exp_f16_sdwa v153, v154 dst_sel:WORD_1 dst_unused:UNUSED_PRESERVE src0_sel:WORD_1
v_fma_mix_f32 v159, v181, v181, v159 op_sel:[1,1,0] op_sel_hi:[1,1,0]
v_bfe_u32 v138, v139, 2, 14
v_exp_f16_sdwa v150, v151 dst_sel:WORD_1 dst_unused:UNUSED_PRESERVE src0_sel:WORD_1
v_exp_f16_sdwa v147, v148 dst_sel:WORD_1 dst_unused:UNUSED_PRESERVE src0_sel:WORD_1
v_exp_f16_sdwa v144, v145 dst_sel:WORD_1 dst_unused:UNUSED_PRESERVE src0_sel:WORD_1
v_lshrrev_b32_e64 v139, 18, v139
v_fma_mix_f32 v159, v182, v182, v159 op_sel:[0,0,0] op_sel_hi:[1,1,0]
v_mfma_f32_32x32x16_bf16 v[120:135], v[108:111], v[232:235], v[120:135]
ds_read_b128 v[228:231], v248 offset:53248
ds_read_u16_d16 v138, v138
ds_read_u16_d16_hi v139, v139
v_pk_add_f16 v153, v153, 1.0 op_sel_hi:[1,0]
v_pk_add_f16 v150, v150, 1.0 op_sel_hi:[1,0]
v_pk_add_f16 v147, v147, 1.0 op_sel_hi:[1,0]
v_and_b32_e64 v141, s49, v141
v_pk_add_f16 v144, v144, 1.0 op_sel_hi:[1,0]
v_rcp_f16_e64 v154, v153
v_fma_mix_f32 v159, v183, v183, v159 op_sel:[1,1,0] op_sel_hi:[1,1,0]
v_rcp_f16_e64 v151, v150
v_mfma_f32_32x32x16_bf16 v[120:135], v[112:115], v[236:239], v[120:135]
ds_read_b128 v[232:235], v248 offset:56320
v_bfe_u32 v140, v141, 2, 14
v_rcp_f16_e64 v148, v147
v_fma_mix_f32 v159, v184, v184, v159 op_sel:[0,0,0] op_sel_hi:[1,1,0]
v_rcp_f16 v145, v144
v_lshrrev_b32 v141, 18, v141
v_rcp_f16_sdwa v154, v153 dst_sel:WORD_1 dst_unused:UNUSED_PRESERVE src0_sel:WORD_1
s_setprio 0
v_rcp_f16_sdwa v151, v150 dst_sel:WORD_1 dst_unused:UNUSED_PRESERVE src0_sel:WORD_1
s_waitcnt lgkmcnt(4)
v_mfma_f32_32x32x16_bf16 v[120:135], v[116:119], v[216:219], v[120:135]
ds_read_b128 v[236:239], v248 offset:54272
ds_read_u16_d16 v140, v140
ds_read_u16_d16_hi v141, v141
v_fma_mix_f32 v159, v185, v185, v159 op_sel:[1,1,0] op_sel_hi:[1,1,0]
v_and_b32_e64 v143, s49, v143
v_rcp_f16_sdwa v148, v147 dst_sel:WORD_1 dst_unused:UNUSED_PRESERVE src0_sel:WORD_1
v_rcp_f16_sdwa v145, v144 dst_sel:WORD_1 dst_unused:UNUSED_PRESERVE src0_sel:WORD_1
v_pk_mul_f16 v155, v155, v154
v_bfe_u32 v142, v143, 2, 14
v_fma_mix_f32 v159, v186, v186, v159 op_sel:[0,0,0] op_sel_hi:[1,1,0]
v_pk_mul_f16 v152, v152, v151
v_pk_mul_f16 v149, v149, v148
v_smfmac_f32_16x16x32_bf16 v[28:31], v[222:223], v[208:211], v246
ds_read_b128 v[216:219], v248 offset:57344
ds_read_u16_d16 v142, v142
v_pk_mul_f16 v146, v146, v145
v_fma_mix_f32 v160, v155, v155, v160 op_sel:[0,0,0] op_sel_hi:[1,1,0]
v_lshrrev_b32 v143, 18, v143
v_fma_mix_f32 v160, v155, v155, v160 op_sel:[1,1,0] op_sel_hi:[1,1,0]
v_fma_mix_f32 v160, v152, v152, v160 op_sel:[0,0,0] op_sel_hi:[1,1,0]
v_smfmac_f32_16x16x32_bf16 v[12:15], v[220:221], v[212:215], v246
v_fma_mix_f32 v159, v187, v187, v159 op_sel:[1,1,0] op_sel_hi:[1,1,0]
v_fma_mix_f32 v160, v152, v152, v160 op_sel:[1,1,0] op_sel_hi:[1,1,0]
v_fma_mix_f32 v160, v149, v149, v160 op_sel:[0,0,0] op_sel_hi:[1,1,0]
v_fma_mix_f32 v160, v149, v149, v160 op_sel:[1,1,0] op_sel_hi:[1,1,0]
v_fma_mix_f32 v160, v146, v146, v160 op_sel:[0,0,0] op_sel_hi:[1,1,0]
v_fma_mix_f32 v160, v146, v146, v160 op_sel:[1,1,0] op_sel_hi:[1,1,0]
s_setprio 2
v_smfmac_f32_16x16x32_bf16 v[36:39], v[226:227], v[192:195], v246
s_add_u32 s46, s80, 23068672
buffer_store_dwordx4 v[92:95], v241, s[32:35], s46 offen sc1
ds_read_b128 v[220:223], v248 offset:55296
ds_read_u16_d16_hi v143, v143
v_cvt_pkrtz_f16_f32 v179, v120, v121
v_cvt_pkrtz_f16_f32 v181, v122, v123
v_cvt_pkrtz_f16_f32 v183, v124, v125
v_cvt_pkrtz_f16_f32 v185, v126, v127
v_smfmac_f32_16x16x32_bf16 v[20:23], v[224:225], v[196:199], v246
v_cvt_pkrtz_f16_f32 v187, v128, v129
v_cvt_pk_f16_f32 v155, v130, v131
v_cvt_pk_f16_f32 v152, v132, v133
v_cvt_pk_f16_f32 v149, v134, v135
s_waitcnt lgkmcnt(2)
v_mfma_f32_32x32x16_bf16 v[120:135], v[96:99], v[228:231], 0
ds_read_b128 v[224:227], v245 offset:2688
ds_read_b128 v[200:203], v244
v_xor_b32 v243, 32, v243
ds_read_b128 v[204:207], v243 offset:128
v_pk_fma_f16 v154, v155, v155, s48
v_and_b32_e64 v179, s49, v179
v_fma_mix_f32 v160, v136, v136, v160 op_sel:[0,0,0] op_sel_hi:[1,1,0]
v_pk_fma_f16 v151, v152, v152, s48
v_pk_fma_f16 v148, v149, v149, s48
v_bfe_u32 v178, v179, 2, 14
v_pk_mul_f16 v154, v155, v154
v_pk_mul_f16 v151, v152, v151
v_mfma_f32_32x32x16_bf16 v[120:135], v[100:103], v[232:235], v[120:135]
ds_read_b128 v[228:231], v248 offset:58368
ds_read_u16_d16 v178, v178
v_pk_mul_f16 v148, v149, v148
v_lshrrev_b32_e64 v179, 18, v179
v_fma_mix_f32 v160, v137, v137, v160 op_sel:[1,1,0] op_sel_hi:[1,1,0]
v_exp_f16 v153, v154
v_and_b32 v181, s49, v181
v_exp_f16_e64 v150, v151
v_mfma_f32_32x32x16_bf16 v[120:135], v[104:107], v[236:239], v[120:135]
ds_read_b128 v[232:235], v245 offset:2304
ds_read_b128 v[208:211], v243 offset:64
ds_read_b128 v[212:215], v243
ds_read_u16_d16_hi v179, v179
v_exp_f16_e64 v147, v148
v_bfe_u32 v180, v181, 2, 14
v_fma_mix_f32 v160, v138, v138, v160 op_sel:[0,0,0] op_sel_hi:[1,1,0]
v_exp_f16_sdwa v153, v154 dst_sel:WORD_1 dst_unused:UNUSED_PRESERVE src0_sel:WORD_1
v_lshrrev_b32 v181, 18, v181
v_mfma_f32_32x32x16_bf16 v[120:135], v[108:111], v[216:219], v[120:135]
ds_read_b128 v[236:239], v245 offset:1920
v_xor_b32 v242, 32, v242
ds_read_b128 v[192:195], v242 offset:128
ds_read_b128 v[196:199], v242 offset:64
ds_read_u16_d16 v180, v180
ds_read_u16_d16_hi v181, v181
v_exp_f16_sdwa v150, v151 dst_sel:WORD_1 dst_unused:UNUSED_PRESERVE src0_sel:WORD_1
v_fma_mix_f32 v160, v139, v139, v160 op_sel:[1,1,0] op_sel_hi:[1,1,0]
v_and_b32 v183, s49, v183
v_exp_f16_sdwa v147, v148 dst_sel:WORD_1 dst_unused:UNUSED_PRESERVE src0_sel:WORD_1
v_pk_add_f16 v153, v153, 1.0 op_sel_hi:[1,0]
v_bfe_u32 v182, v183, 2, 14
v_pk_add_f16 v150, v150, 1.0 op_sel_hi:[1,0]
s_waitcnt lgkmcnt(9)
v_mfma_f32_32x32x16_bf16 v[120:135], v[112:115], v[220:223], v[120:135]
ds_read_b128 v[216:219], v248 offset:59392
ds_read_u16_d16 v182, v182
v_pk_add_f16 v147, v147, 1.0 op_sel_hi:[1,0]
v_rcp_f16 v154, v153
v_lshrrev_b32 v183, 18, v183
v_fma_mix_f32 v160, v140, v140, v160 op_sel:[0,0,0] op_sel_hi:[1,1,0]
v_rcp_f16 v151, v150
v_and_b32 v185, s49, v185
v_smfmac_f32_16x16x32_bf16 v[4:7], v[226:227], v[200:203], v246
ds_read_b128 v[220:223], v248 offset:62464
ds_read_u16_d16_hi v183, v183
v_rcp_f16_e64 v148, v147
v_fma_mix_f32 v160, v141, v141, v160 op_sel:[1,1,0] op_sel_hi:[1,1,0]
v_bfe_u32 v184, v185, 2, 14
v_smfmac_f32_16x16x32_bf16 v[36:39], v[224:225], v[204:207], v246
v_rcp_f16_sdwa v154, v153 dst_sel:WORD_1 dst_unused:UNUSED_PRESERVE src0_sel:WORD_1
v_rcp_f16_sdwa v151, v150 dst_sel:WORD_1 dst_unused:UNUSED_PRESERVE src0_sel:WORD_1
v_mfma_f32_32x32x16_bf16 v[120:135], v[116:119], v[228:231], v[120:135]
ds_read_b128 v[224:227], v248 offset:60416
ds_read_u16_d16 v184, v184
v_lshrrev_b32_e64 v185, 18, v185
v_rcp_f16_sdwa v148, v147 dst_sel:WORD_1 dst_unused:UNUSED_PRESERVE src0_sel:WORD_1
v_and_b32 v187, s49, v187
v_fma_mix_f32 v160, v142, v142, v160 op_sel:[0,0,0] op_sel_hi:[1,1,0]
v_pk_mul_f16 v155, v155, v154
v_pk_mul_f16 v152, v152, v151
v_bfe_u32 v186, v187, 2, 14
s_waitcnt lgkmcnt(4)
v_smfmac_f32_16x16x32_bf16 v[20:23], v[234:235], v[208:211], v246
ds_read_b128 v[228:231], v248 offset:63488
ds_read_u16_d16_hi v185, v185
ds_read_u16_d16 v186, v186
v_pk_mul_f16 v149, v149, v148
v_fma_mix_f32 v161, v155, v155, v161 op_sel:[0,0,0] op_sel_hi:[1,1,0]
v_fma_mix_f32 v160, v143, v143, v160 op_sel:[1,1,0] op_sel_hi:[1,1,0]
v_lshrrev_b32 v187, 18, v187
v_smfmac_f32_16x16x32_bf16 v[4:7], v[232:233], v[212:215], v246
v_fma_mix_f32 v161, v155, v155, v161 op_sel:[1,1,0] op_sel_hi:[1,1,0]
v_fma_mix_f32 v161, v152, v152, v161 op_sel:[0,0,0] op_sel_hi:[1,1,0]
v_fma_mix_f32 v161, v152, v152, v161 op_sel:[1,1,0] op_sel_hi:[1,1,0]
v_fma_mix_f32 v161, v149, v149, v161 op_sel:[0,0,0] op_sel_hi:[1,1,0]
v_fma_mix_f32 v161, v149, v149, v161 op_sel:[1,1,0] op_sel_hi:[1,1,0]
s_setprio 1
v_smfmac_f32_16x16x32_bf16 v[36:39], v[238:239], v[192:195], v246
ds_read_b128 v[232:235], v248 offset:61440
ds_read_u16_d16_hi v187, v187
v_cvt_pkrtz_f16_f32 v137, v120, v121
v_cvt_pkrtz_f16_f32 v139, v122, v123
v_cvt_pkrtz_f16_f32 v141, v124, v125
v_cvt_pkrtz_f16_f32 v143, v126, v127
v_cvt_pk_f16_f32 v155, v128, v129
v_smfmac_f32_16x16x32_bf16 v[20:23], v[236:237], v[196:199], v246
v_cvt_pk_f16_f32 v152, v130, v131
v_cvt_pk_f16_f32 v149, v132, v133
v_cvt_pk_f16_f32 v146, v134, v135
v_pk_fma_f16 v154, v155, v155, s48
v_and_b32_e64 v137, s49, v137
v_mfma_f32_32x32x16_bf16 v[120:135], v[96:99], v[216:219], 0
ds_read_b128 v[236:239], v248 offset:64512
v_fma_mix_f32 v161, v178, v178, v161 op_sel:[0,0,0] op_sel_hi:[1,1,0]
v_pk_fma_f16 v151, v152, v152, s48
v_pk_fma_f16 v148, v149, v149, s48
v_pk_fma_f16 v145, v146, v146, s48
v_pk_mul_f16 v154, v155, v154
v_bfe_u32 v136, v137, 2, 14
v_pk_mul_f16 v151, v152, v151
v_fma_mix_f32 v161, v179, v179, v161 op_sel:[1,1,0] op_sel_hi:[1,1,0]
v_pk_mul_f16 v148, v149, v148
v_pk_mul_f16 v145, v146, v145
s_waitcnt lgkmcnt(2)
v_mfma_f32_32x32x16_bf16 v[120:135], v[100:103], v[220:223], v[120:135]
ds_read_b128 v[216:219], v245 offset:1536
ds_read_b128 v[200:203], v242
v_xor_b32 v244, 16, v244
ds_read_b128 v[204:207], v244 offset:128
ds_read_u16_d16 v136, v136
v_exp_f16 v153, v154
v_lshrrev_b32 v137, 18, v137
v_exp_f16_e64 v150, v151
v_fma_mix_f32 v161, v180, v180, v161 op_sel:[0,0,0] op_sel_hi:[1,1,0]
v_exp_f16 v147, v148
v_and_b32 v139, s49, v139
v_exp_f16_e64 v144, v145
v_mfma_f32_32x32x16_bf16 v[120:135], v[104:107], v[224:227], v[120:135]
ds_read_b128 v[220:223], v245 offset:1152
ds_read_b128 v[208:211], v244 offset:64
ds_read_b128 v[212:215], v244
ds_read_u16_d16_hi v137, v137
v_exp_f16_sdwa v153, v154 dst_sel:WORD_1 dst_unused:UNUSED_PRESERVE src0_sel:WORD_1
v_fma_mix_f32 v161, v181, v181, v161 op_sel:[1,1,0] op_sel_hi:[1,1,0]
v_bfe_u32 v138, v139, 2, 14
v_exp_f16_sdwa v150, v151 dst_sel:WORD_1 dst_unused:UNUSED_PRESERVE src0_sel:WORD_1
v_exp_f16_sdwa v147, v148 dst_sel:WORD_1 dst_unused:UNUSED_PRESERVE src0_sel:WORD_1
v_exp_f16_sdwa v144, v145 dst_sel:WORD_1 dst_unused:UNUSED_PRESERVE src0_sel:WORD_1
v_lshrrev_b32_e64 v139, 18, v139
v_fma_mix_f32 v161, v182, v182, v161 op_sel:[0,0,0] op_sel_hi:[1,1,0]
v_mfma_f32_32x32x16_bf16 v[120:135], v[108:111], v[228:231], v[120:135]
ds_read_b128 v[224:227], v249
ds_read_u16_d16 v138, v138
ds_read_u16_d16_hi v139, v139
v_pk_add_f16 v153, v153, 1.0 op_sel_hi:[1,0]
v_pk_add_f16 v150, v150, 1.0 op_sel_hi:[1,0]
v_pk_add_f16 v147, v147, 1.0 op_sel_hi:[1,0]
v_and_b32_e64 v141, s49, v141
v_pk_add_f16 v144, v144, 1.0 op_sel_hi:[1,0]
v_rcp_f16_e64 v154, v153
v_fma_mix_f32 v161, v183, v183, v161 op_sel:[1,1,0] op_sel_hi:[1,1,0]
v_rcp_f16_e64 v151, v150
v_mfma_f32_32x32x16_bf16 v[120:135], v[112:115], v[232:235], v[120:135]
ds_read_b128 v[228:231], v249 offset:3072
v_bfe_u32 v140, v141, 2, 14
v_rcp_f16_e64 v148, v147
v_fma_mix_f32 v161, v184, v184, v161 op_sel:[0,0,0] op_sel_hi:[1,1,0]
v_rcp_f16 v145, v144
v_lshrrev_b32 v141, 18, v141
v_rcp_f16_sdwa v154, v153 dst_sel:WORD_1 dst_unused:UNUSED_PRESERVE src0_sel:WORD_1
s_setprio 0
v_rcp_f16_sdwa v151, v150 dst_sel:WORD_1 dst_unused:UNUSED_PRESERVE src0_sel:WORD_1
s_waitcnt lgkmcnt(4)
v_mfma_f32_32x32x16_bf16 v[120:135], v[116:119], v[236:239], v[120:135]
ds_read_b128 v[232:235], v249 offset:1024
ds_read_u16_d16 v140, v140
ds_read_u16_d16_hi v141, v141
v_fma_mix_f32 v161, v185, v185, v161 op_sel:[1,1,0] op_sel_hi:[1,1,0]
v_and_b32_e64 v143, s49, v143
v_rcp_f16_sdwa v148, v147 dst_sel:WORD_1 dst_unused:UNUSED_PRESERVE src0_sel:WORD_1
v_rcp_f16_sdwa v145, v144 dst_sel:WORD_1 dst_unused:UNUSED_PRESERVE src0_sel:WORD_1
v_pk_mul_f16 v155, v155, v154
v_bfe_u32 v142, v143, 2, 14
v_fma_mix_f32 v161, v186, v186, v161 op_sel:[0,0,0] op_sel_hi:[1,1,0]
v_pk_mul_f16 v152, v152, v151
v_pk_mul_f16 v149, v149, v148
v_smfmac_f32_16x16x32_bf16 v[4:7], v[218:219], v[200:203], v246
ds_read_b128 v[236:239], v249 offset:4096
ds_read_u16_d16 v142, v142
v_pk_mul_f16 v146, v146, v145
v_fma_mix_f32 v162, v155, v155, v162 op_sel:[0,0,0] op_sel_hi:[1,1,0]
v_lshrrev_b32 v143, 18, v143
v_fma_mix_f32 v162, v155, v155, v162 op_sel:[1,1,0] op_sel_hi:[1,1,0]
v_fma_mix_f32 v162, v152, v152, v162 op_sel:[0,0,0] op_sel_hi:[1,1,0]
v_smfmac_f32_16x16x32_bf16 v[32:35], v[216:217], v[204:207], v246
v_fma_mix_f32 v161, v187, v187, v161 op_sel:[1,1,0] op_sel_hi:[1,1,0]
v_fma_mix_f32 v162, v152, v152, v162 op_sel:[1,1,0] op_sel_hi:[1,1,0]
v_fma_mix_f32 v162, v149, v149, v162 op_sel:[0,0,0] op_sel_hi:[1,1,0]
v_fma_mix_f32 v162, v149, v149, v162 op_sel:[1,1,0] op_sel_hi:[1,1,0]
v_fma_mix_f32 v162, v146, v146, v162 op_sel:[0,0,0] op_sel_hi:[1,1,0]
v_fma_mix_f32 v162, v146, v146, v162 op_sel:[1,1,0] op_sel_hi:[1,1,0]
s_setprio 2
v_smfmac_f32_16x16x32_bf16 v[16:19], v[222:223], v[208:211], v246
ds_read_b128 v[216:219], v249 offset:2048
ds_read_u16_d16_hi v143, v143
v_cvt_pkrtz_f16_f32 v179, v120, v121
v_cvt_pkrtz_f16_f32 v181, v122, v123
v_cvt_pkrtz_f16_f32 v183, v124, v125
v_cvt_pkrtz_f16_f32 v185, v126, v127
v_smfmac_f32_16x16x32_bf16 v[0:3], v[220:221], v[212:215], v246
v_cvt_pkrtz_f16_f32 v187, v128, v129
v_cvt_pk_f16_f32 v155, v130, v131
v_cvt_pk_f16_f32 v152, v132, v133
v_cvt_pk_f16_f32 v149, v134, v135
v_pk_fma_f16 v154, v155, v155, s48
s_waitcnt lgkmcnt(2)
v_mfma_f32_32x32x16_bf16 v[120:135], v[96:99], v[224:227], 0
ds_read_b128 v[220:223], v249 offset:5120
v_and_b32 v179, s49, v179
v_fma_mix_f32 v162, v136, v136, v162 op_sel:[0,0,0] op_sel_hi:[1,1,0]
v_pk_fma_f16 v151, v152, v152, s48
v_pk_fma_f16 v148, v149, v149, s48
v_bfe_u32 v178, v179, 2, 14
v_pk_mul_f16 v154, v155, v154
v_pk_mul_f16 v151, v152, v151
v_pk_mul_f16 v148, v149, v148
v_lshrrev_b32 v179, 18, v179
v_mfma_f32_32x32x16_bf16 v[120:135], v[100:103], v[228:231], v[120:135]
ds_read_b128 v[224:227], v245 offset:768
v_xor_b32 v243, 16, v243
ds_read_b128 v[192:195], v243 offset:128
ds_read_b128 v[196:199], v243 offset:64
ds_read_u16_d16 v178, v178
ds_read_u16_d16_hi v179, v179
v_fma_mix_f32 v162, v137, v137, v162 op_sel:[1,1,0] op_sel_hi:[1,1,0]
v_exp_f16 v153, v154
v_and_b32 v181, s49, v181
v_exp_f16 v150, v151
v_exp_f16 v147, v148
v_bfe_u32 v180, v181, 2, 14
v_mfma_f32_32x32x16_bf16 v[120:135], v[104:107], v[232:235], v[120:135]
ds_read_b128 v[228:231], v245 offset:384
ds_read_b128 v[200:203], v243
v_xor_b32 v242, 16, v242
ds_read_b128 v[204:207], v242 offset:128
ds_read_u16_d16 v180, v180
v_fma_mix_f32 v162, v138, v138, v162 op_sel:[0,0,0] op_sel_hi:[1,1,0]
v_exp_f16_sdwa v153, v154 dst_sel:WORD_1 dst_unused:UNUSED_PRESERVE src0_sel:WORD_1
v_lshrrev_b32 v181, 18, v181
v_exp_f16_sdwa v150, v151 dst_sel:WORD_1 dst_unused:UNUSED_PRESERVE src0_sel:WORD_1
v_fma_mix_f32 v162, v139, v139, v162 op_sel:[1,1,0] op_sel_hi:[1,1,0]
v_and_b32_e64 v183, s49, v183
v_mfma_f32_32x32x16_bf16 v[120:135], v[108:111], v[236:239], v[120:135]
ds_read_b128 v[232:235], v249 offset:6144
ds_read_u16_d16_hi v181, v181
v_exp_f16_sdwa v147, v148 dst_sel:WORD_1 dst_unused:UNUSED_PRESERVE src0_sel:WORD_1
v_pk_add_f16 v153, v153, 1.0 op_sel_hi:[1,0]
v_bfe_u32 v182, v183, 2, 14
v_pk_add_f16 v150, v150, 1.0 op_sel_hi:[1,0]
v_pk_add_f16 v147, v147, 1.0 op_sel_hi:[1,0]
v_rcp_f16_e64 v154, v153
v_lshrrev_b32 v183, 18, v183
v_fma_mix_f32 v162, v140, v140, v162 op_sel:[0,0,0] op_sel_hi:[1,1,0]
s_waitcnt lgkmcnt(6)
v_mfma_f32_32x32x16_bf16 v[120:135], v[112:115], v[216:219], v[120:135]
ds_read_b128 v[236:239], v249 offset:9216
ds_read_u16_d16 v182, v182
ds_read_u16_d16_hi v183, v183
v_rcp_f16 v151, v150
v_and_b32 v185, s49, v185
v_rcp_f16_e64 v148, v147
v_fma_mix_f32 v162, v141, v141, v162 op_sel:[1,1,0] op_sel_hi:[1,1,0]
v_bfe_u32 v184, v185, 2, 14
v_rcp_f16_sdwa v154, v153 dst_sel:WORD_1 dst_unused:UNUSED_PRESERVE src0_sel:WORD_1
v_mfma_f32_32x32x16_bf16 v[120:135], v[116:119], v[220:223], v[120:135]
ds_read_b128 v[216:219], v249 offset:7168
ds_read_u16_d16 v184, v184
v_rcp_f16_sdwa v151, v150 dst_sel:WORD_1 dst_unused:UNUSED_PRESERVE src0_sel:WORD_1
v_lshrrev_b32_e64 v185, 18, v185
v_rcp_f16_sdwa v148, v147 dst_sel:WORD_1 dst_unused:UNUSED_PRESERVE src0_sel:WORD_1
v_and_b32_e64 v187, s49, v187
v_fma_mix_f32 v162, v142, v142, v162 op_sel:[0,0,0] op_sel_hi:[1,1,0]
v_pk_mul_f16 v155, v155, v154
v_pk_mul_f16 v152, v152, v151
v_smfmac_f32_16x16x32_bf16 v[32:35], v[226:227], v[192:195], v246
ds_read_b128 v[220:223], v249 offset:10240
ds_read_u16_d16_hi v185, v185
v_bfe_u32 v186, v187, 2, 14
v_pk_mul_f16 v149, v149, v148
v_fma_mix_f32 v163, v155, v155, v163 op_sel:[0,0,0] op_sel_hi:[1,1,0]
v_fma_mix_f32 v162, v143, v143, v162 op_sel:[1,1,0] op_sel_hi:[1,1,0]
v_lshrrev_b32_e64 v187, 18, v187
v_smfmac_f32_16x16x32_bf16 v[16:19], v[224:225], v[196:199], v246
v_fma_mix_f32 v163, v155, v155, v163 op_sel:[1,1,0] op_sel_hi:[1,1,0]
v_fma_mix_f32 v163, v152, v152, v163 op_sel:[0,0,0] op_sel_hi:[1,1,0]
v_fma_mix_f32 v163, v152, v152, v163 op_sel:[1,1,0] op_sel_hi:[1,1,0]
v_fma_mix_f32 v163, v149, v149, v163 op_sel:[0,0,0] op_sel_hi:[1,1,0]
v_fma_mix_f32 v163, v149, v149, v163 op_sel:[1,1,0] op_sel_hi:[1,1,0]
s_setprio 1
s_waitcnt lgkmcnt(4)
v_smfmac_f32_16x16x32_bf16 v[0:3], v[230:231], v[200:203], v246
ds_read_b128 v[224:227], v249 offset:8192
ds_read_u16_d16 v186, v186
ds_read_u16_d16_hi v187, v187
v_cvt_pkrtz_f16_f32 v137, v120, v121
v_cvt_pkrtz_f16_f32 v139, v122, v123
v_cvt_pkrtz_f16_f32 v141, v124, v125
v_cvt_pkrtz_f16_f32 v143, v126, v127
v_smfmac_f32_16x16x32_bf16 v[32:35], v[228:229], v[204:207], v246
v_cvt_pk_f16_f32 v155, v128, v129
v_cvt_pk_f16_f32 v152, v130, v131
v_cvt_pk_f16_f32 v149, v132, v133
v_cvt_pk_f16_f32 v146, v134, v135
v_pk_fma_f16 v154, v155, v155, s48
v_mfma_f32_32x32x16_bf16 v[120:135], v[96:99], v[232:235], 0
ds_read_b128 v[228:231], v249 offset:11264
v_and_b32_e64 v137, s49, v137
v_fma_mix_f32 v163, v178, v178, v163 op_sel:[0,0,0] op_sel_hi:[1,1,0]
v_pk_fma_f16 v151, v152, v152, s48
v_pk_fma_f16 v148, v149, v149, s48
v_pk_fma_f16 v145, v146, v146, s48
v_pk_mul_f16 v154, v155, v154
v_bfe_u32 v136, v137, 2, 14
v_pk_mul_f16 v151, v152, v151
v_fma_mix_f32 v163, v179, v179, v163 op_sel:[1,1,0] op_sel_hi:[1,1,0]
v_pk_mul_f16 v148, v149, v148
v_mfma_f32_32x32x16_bf16 v[120:135], v[100:103], v[236:239], v[120:135]
ds_read_b128 v[232:235], v245
ds_read_b128 v[208:211], v242 offset:64
ds_read_b128 v[212:215], v242
ds_read_u16_d16 v136, v136
v_pk_mul_f16 v145, v146, v145
v_exp_f16 v153, v154
v_lshrrev_b32 v137, 18, v137
v_exp_f16_e64 v150, v151
v_fma_mix_f32 v163, v180, v180, v163 op_sel:[0,0,0] op_sel_hi:[1,1,0]
v_exp_f16_e64 v147, v148
v_and_b32 v139, s49, v139
s_waitcnt lgkmcnt(5)
v_mfma_f32_32x32x16_bf16 v[120:135], v[104:107], v[216:219], v[120:135]
ds_read_b128 v[236:239], v249 offset:12288
ds_read_u16_d16_hi v137, v137
v_exp_f16_e64 v144, v145
v_exp_f16_sdwa v153, v154 dst_sel:WORD_1 dst_unused:UNUSED_PRESERVE src0_sel:WORD_1
v_fma_mix_f32 v163, v181, v181, v163 op_sel:[1,1,0] op_sel_hi:[1,1,0]
v_bfe_u32 v138, v139, 2, 14
v_exp_f16_sdwa v150, v151 dst_sel:WORD_1 dst_unused:UNUSED_PRESERVE src0_sel:WORD_1
v_exp_f16_sdwa v147, v148 dst_sel:WORD_1 dst_unused:UNUSED_PRESERVE src0_sel:WORD_1
v_mfma_f32_32x32x16_bf16 v[120:135], v[108:111], v[220:223], v[120:135]
ds_read_b128 v[216:219], v249 offset:15360
ds_read_u16_d16 v138, v138
v_exp_f16_sdwa v144, v145 dst_sel:WORD_1 dst_unused:UNUSED_PRESERVE src0_sel:WORD_1
v_lshrrev_b32_e64 v139, 18, v139
v_fma_mix_f32 v163, v182, v182, v163 op_sel:[0,0,0] op_sel_hi:[1,1,0]
v_pk_add_f16 v153, v153, 1.0 op_sel_hi:[1,0]
v_pk_add_f16 v150, v150, 1.0 op_sel_hi:[1,0]
v_pk_add_f16 v147, v147, 1.0 op_sel_hi:[1,0]
v_and_b32_e64 v141, s49, v141
v_pk_add_f16 v144, v144, 1.0 op_sel_hi:[1,0]
v_mfma_f32_32x32x16_bf16 v[120:135], v[112:115], v[224:227], v[120:135]
ds_read_b128 v[220:223], v249 offset:13312
ds_read_u16_d16_hi v139, v139
v_rcp_f16_e64 v154, v153
v_fma_mix_f32 v163, v183, v183, v163 op_sel:[1,1,0] op_sel_hi:[1,1,0]
v_rcp_f16_e64 v151, v150
v_bfe_u32 v140, v141, 2, 14
v_rcp_f16 v148, v147
v_fma_mix_f32 v163, v184, v184, v163 op_sel:[0,0,0] op_sel_hi:[1,1,0]
s_waitcnt lgkmcnt(4)
v_mfma_f32_32x32x16_bf16 v[120:135], v[116:119], v[228:231], v[120:135]
ds_read_b128 v[224:227], v249 offset:16384
ds_read_u16_d16 v140, v140
v_rcp_f16_e64 v145, v144
v_lshrrev_b32 v141, 18, v141
v_rcp_f16_sdwa v154, v153 dst_sel:WORD_1 dst_unused:UNUSED_PRESERVE src0_sel:WORD_1
s_setprio 0
v_rcp_f16_sdwa v151, v150 dst_sel:WORD_1 dst_unused:UNUSED_PRESERVE src0_sel:WORD_1
v_fma_mix_f32 v163, v185, v185, v163 op_sel:[1,1,0] op_sel_hi:[1,1,0]
v_and_b32_e64 v143, s49, v143
v_rcp_f16_sdwa v148, v147 dst_sel:WORD_1 dst_unused:UNUSED_PRESERVE src0_sel:WORD_1
v_smfmac_f32_16x16x32_bf16 v[16:19], v[234:235], v[208:211], v246
ds_read_b128 v[228:231], v249 offset:14336
ds_read_u16_d16_hi v141, v141
v_rcp_f16_sdwa v145, v144 dst_sel:WORD_1 dst_unused:UNUSED_PRESERVE src0_sel:WORD_1
v_pk_mul_f16 v155, v155, v154
v_bfe_u32 v142, v143, 2, 14
v_fma_mix_f32 v163, v186, v186, v163 op_sel:[0,0,0] op_sel_hi:[1,1,0]
v_smfmac_f32_16x16x32_bf16 v[0:3], v[232:233], v[212:215], v246
s_mov_b64 exec, 1
ds_add_u32 v253, v254 offset:16
s_mov_b64 exec, -1
v_pk_mul_f16 v152, v152, v151
v_pk_mul_f16 v149, v149, v148
v_pk_mul_f16 v146, v146, v145
v_fma_mix_f32 v164, v155, v155, v164 op_sel:[0,0,0] op_sel_hi:[1,1,0]
v_lshrrev_b32 v143, 18, v143
v_fma_mix_f32 v164, v155, v155, v164 op_sel:[1,1,0] op_sel_hi:[1,1,0]
v_fma_mix_f32 v164, v152, v152, v164 op_sel:[0,0,0] op_sel_hi:[1,1,0]
v_fma_mix_f32 v163, v187, v187, v163 op_sel:[1,1,0] op_sel_hi:[1,1,0]
v_fma_mix_f32 v164, v152, v152, v164 op_sel:[1,1,0] op_sel_hi:[1,1,0]
v_fma_mix_f32 v164, v149, v149, v164 op_sel:[0,0,0] op_sel_hi:[1,1,0]
v_fma_mix_f32 v164, v149, v149, v164 op_sel:[1,1,0] op_sel_hi:[1,1,0]
v_fma_mix_f32 v164, v146, v146, v164 op_sel:[0,0,0] op_sel_hi:[1,1,0]
v_fma_mix_f32 v164, v146, v146, v164 op_sel:[1,1,0] op_sel_hi:[1,1,0]
s_setprio 3
v_pk_add_f32 v[168:169], v[0:1], v[2:3]
v_pk_mul_f32 v[170:171], v[0:1], v[0:1]
v_pk_fma_f32 v[170:171], v[2:3], v[2:3], v[170:171]
v_pk_add_f32 v[168:169], v[168:169], v[4:5]
v_pk_fma_f32 v[170:171], v[4:5], v[4:5], v[170:171]
v_pk_add_f32 v[168:169], v[168:169], v[6:7]
v_pk_fma_f32 v[170:171], v[6:7], v[6:7], v[170:171]
v_pk_add_f32 v[168:169], v[168:169], v[8:9]
v_pk_fma_f32 v[170:171], v[8:9], v[8:9], v[170:171]
v_pk_add_f32 v[168:169], v[168:169], v[10:11]
v_pk_fma_f32 v[170:171], v[10:11], v[10:11], v[170:171]
v_pk_add_f32 v[168:169], v[168:169], v[12:13]
v_pk_fma_f32 v[170:171], v[12:13], v[12:13], v[170:171]
v_pk_add_f32 v[168:169], v[168:169], v[14:15]
v_pk_fma_f32 v[170:171], v[14:15], v[14:15], v[170:171]
v_pk_add_f32 v[168:169], v[168:169], v[16:17]
v_pk_fma_f32 v[170:171], v[16:17], v[16:17], v[170:171]
v_pk_add_f32 v[168:169], v[168:169], v[18:19]
v_pk_fma_f32 v[170:171], v[18:19], v[18:19], v[170:171]
v_pk_add_f32 v[168:169], v[168:169], v[20:21]
v_pk_fma_f32 v[170:171], v[20:21], v[20:21], v[170:171]
v_pk_add_f32 v[168:169], v[168:169], v[22:23]
v_pk_fma_f32 v[170:171], v[22:23], v[22:23], v[170:171]
v_pk_add_f32 v[168:169], v[168:169], v[24:25]
v_pk_fma_f32 v[170:171], v[24:25], v[24:25], v[170:171]
v_pk_add_f32 v[168:169], v[168:169], v[26:27]
v_pk_fma_f32 v[170:171], v[26:27], v[26:27], v[170:171]
v_pk_add_f32 v[168:169], v[168:169], v[28:29]
v_pk_fma_f32 v[170:171], v[28:29], v[28:29], v[170:171]
v_pk_add_f32 v[168:169], v[168:169], v[30:31]
v_pk_fma_f32 v[170:171], v[30:31], v[30:31], v[170:171]
v_pk_add_f32 v[168:169], v[168:169], v[32:33]
v_pk_fma_f32 v[170:171], v[32:33], v[32:33], v[170:171]
v_pk_add_f32 v[168:169], v[168:169], v[34:35]
v_pk_fma_f32 v[170:171], v[34:35], v[34:35], v[170:171]
v_pk_add_f32 v[168:169], v[168:169], v[36:37]
v_pk_fma_f32 v[170:171], v[36:37], v[36:37], v[170:171]
v_pk_add_f32 v[168:169], v[168:169], v[38:39]
v_pk_fma_f32 v[170:171], v[38:39], v[38:39], v[170:171]
v_pk_add_f32 v[168:169], v[168:169], v[40:41]
v_pk_fma_f32 v[170:171], v[40:41], v[40:41], v[170:171]
v_pk_add_f32 v[168:169], v[168:169], v[42:43]
v_pk_fma_f32 v[170:171], v[42:43], v[42:43], v[170:171]
v_pk_add_f32 v[168:169], v[168:169], v[44:45]
v_pk_fma_f32 v[170:171], v[44:45], v[44:45], v[170:171]
v_pk_add_f32 v[168:169], v[168:169], v[46:47]
v_pk_fma_f32 v[170:171], v[46:47], v[46:47], v[170:171]
s_setprio 0
v_lshrrev_b32 v252, 2, v251
v_mul_u32_u24 v252, 192, v252
v_and_b32 v240, 3, v251
v_lshl_add_u32 v252, v240, 4, v252
s_setprio 2
v_cvt_pkrtz_f16_f32 v179, v120, v121
v_cvt_pkrtz_f16_f32 v181, v122, v123
v_cvt_pkrtz_f16_f32 v183, v124, v125
v_cvt_pkrtz_f16_f32 v185, v126, v127
v_cvt_pkrtz_f16_f32 v187, v128, v129
v_cvt_pk_f16_f32 v155, v130, v131
v_cvt_pk_f16_f32 v152, v132, v133
v_cvt_pk_f16_f32 v149, v134, v135
ds_read_b128 v[232:235], v249 offset:17408
ds_read_u16_d16 v142, v142
ds_read_u16_d16_hi v143, v143
v_mfma_f32_32x32x16_bf16 v[120:135], v[236:239], v[96:99], 0
v_pk_fma_f16 v154, v155, v155, s48
v_add_f32 v168, v168, v169
v_and_b32 v179, s49, v179
v_fma_mix_f32 v164, v136, v136, v164 op_sel:[0,0,0] op_sel_hi:[1,1,0]
v_pk_fma_f16 v151, v152, v152, s48
v_bfe_u32 v178, v179, 2, 14
v_pk_fma_f16 v148, v149, v149, s48
v_add_f32_e64 v170, v170, v171
v_pk_mul_f16 v154, v155, v154
v_lshrrev_b32_e64 v179, 18, v179
v_fma_mix_f32 v164, v137, v137, v164 op_sel:[1,1,0] op_sel_hi:[1,1,0]
v_pk_mul_f16 v151, v152, v151
v_and_b32 v181, s49, v181
s_waitcnt lgkmcnt(4)
ds_read_u16_d16 v178, v178
ds_read_u16_d16_hi v179, v179
v_mfma_f32_32x32x16_bf16 v[120:135], v[216:219], v[100:103], v[120:135]
v_permlane32_swap_b32 v168, v170
v_pk_mul_f16 v148, v149, v148
v_exp_f16 v153, v154
v_bfe_u32 v180, v181, 2, 14
v_fma_mix_f32 v164, v138, v138, v164 op_sel:[0,0,0] op_sel_hi:[1,1,0]
v_exp_f16 v150, v151
v_add_f32 v168, v168, v170
v_lshrrev_b32_e64 v181, 18, v181
v_fma_mix_f32 v164, v139, v139, v164 op_sel:[1,1,0] op_sel_hi:[1,1,0]
v_and_b32 v183, s49, v183
v_exp_f16 v147, v148
ds_read_u16_d16 v180, v180
ds_read_u16_d16_hi v181, v181
v_mfma_f32_32x32x16_bf16 v[120:135], v[220:223], v[104:107], v[120:135]
v_mul_f32 v168, 1009429163, v168
v_bfe_u32 v182, v183, 2, 14
v_exp_f16_sdwa v153, v154 dst_sel:WORD_1 dst_unused:UNUSED_PRESERVE src0_sel:WORD_1
v_lshrrev_b32 v183, 18, v183
v_mov_b32 v170, v168
v_fma_mix_f32 v164, v140, v140, v164 op_sel:[0,0,0] op_sel_hi:[1,1,0]
v_exp_f16_sdwa v150, v151 dst_sel:WORD_1 dst_unused:UNUSED_PRESERVE src0_sel:WORD_1
v_and_b32 v185, s49, v185
v_fma_mix_f32 v164, v141, v141, v164 op_sel:[1,1,0] op_sel_hi:[1,1,0]
v_exp_f16_sdwa v147, v148 dst_sel:WORD_1 dst_unused:UNUSED_PRESERVE src0_sel:WORD_1
v_permlane32_swap_b32 v168, v170
ds_read_u16_d16 v182, v182
ds_read_u16_d16_hi v183, v183
v_mfma_f32_32x32x16_bf16 v[120:135], v[224:227], v[108:111], v[120:135]
v_bfe_u32 v184, v185, 2, 14
v_pk_add_f16 v153, v153, 1.0 op_sel_hi:[1,0]
v_lshrrev_b32 v185, 18, v185
s_waitcnt lgkmcnt(4)
v_fma_mix_f32 v164, v142, v142, v164 op_sel:[0,0,0] op_sel_hi:[1,1,0]
v_fma_f32 v170, -v168, v168, v170
v_pk_add_f16 v150, v150, 1.0 op_sel_hi:[1,0]
v_and_b32_e64 v187, s49, v187
v_pk_add_f16 v147, v147, 1.0 op_sel_hi:[1,0]
v_rcp_f16 v154, v153
v_max_f32 v170, 0, v170
v_bfe_u32 v186, v187, 2, 14
v_fma_mix_f32 v164, v143, v143, v164 op_sel:[1,1,0] op_sel_hi:[1,1,0]
v_lshrrev_b32_e64 v187, 18, v187
ds_read_b128 v[224:227], v249 offset:18432
ds_read_u16_d16 v184, v184
ds_read_u16_d16_hi v185, v185
ds_read_u16_d16 v186, v186
ds_read_u16_d16_hi v187, v187
v_mfma_f32_32x32x16_bf16 v[120:135], v[228:231], v[112:115], v[120:135]
v_rcp_f16 v151, v150
v_rcp_f16 v148, v147
v_add_f32 v170, 925353388, v170
v_rcp_f16_sdwa v154, v153 dst_sel:WORD_1 dst_unused:UNUSED_PRESERVE src0_sel:WORD_1
v_fma_mix_f32 v165, v178, v178, v165 op_sel:[0,0,0] op_sel_hi:[1,1,0]
v_fma_mix_f32 v165, v179, v179, v165 op_sel:[1,1,0] op_sel_hi:[1,1,0]
v_rsq_f32 v170, v170
v_rcp_f16_sdwa v151, v150 dst_sel:WORD_1 dst_unused:UNUSED_PRESERVE src0_sel:WORD_1
s_waitcnt lgkmcnt(5)
v_fma_mix_f32 v165, v180, v180, v165 op_sel:[0,0,0] op_sel_hi:[1,1,0]
ds_read_b128 v[228:231], v249 offset:21504
ds_read_b32 v247, v253 offset:16
v_mfma_f32_32x32x16_bf16 v[120:135], v[232:235], v[116:119], v[120:135]
v_rcp_f16_sdwa v148, v147 dst_sel:WORD_1 dst_unused:UNUSED_PRESERVE src0_sel:WORD_1
v_fma_mix_f32 v165, v181, v181, v165 op_sel:[1,1,0] op_sel_hi:[1,1,0]
v_pk_mul_f16 v155, v155, v154
v_fma_mix_f32 v165, v182, v182, v165 op_sel:[0,0,0] op_sel_hi:[1,1,0]
v_pk_mul_f16 v152, v152, v151
v_fma_mix_f32 v165, v183, v183, v165 op_sel:[1,1,0] op_sel_hi:[1,1,0]
v_pk_mul_f16 v149, v149, v148
v_mul_f32 v172, 3203391086, v170
v_fma_mix_f32 v165, v155, v155, v165 op_sel:[0,0,0] op_sel_hi:[1,1,0]
s_waitcnt lgkmcnt(3)
v_fma_mix_f32 v165, v184, v184, v165 op_sel:[0,0,0] op_sel_hi:[1,1,0]
v_fma_mix_f32 v165, v155, v155, v165 op_sel:[1,1,0] op_sel_hi:[1,1,0]
v_fma_mix_f32 v165, v185, v185, v165 op_sel:[1,1,0] op_sel_hi:[1,1,0]
v_fma_mix_f32 v165, v152, v152, v165 op_sel:[0,0,0] op_sel_hi:[1,1,0]
v_mul_f32 v173, v168, v172
v_fma_mix_f32 v165, v152, v152, v165 op_sel:[1,1,0] op_sel_hi:[1,1,0]
v_fma_mix_f32 v165, v186, v186, v165 op_sel:[0,0,0] op_sel_hi:[1,1,0]
v_fma_mix_f32 v165, v149, v149, v165 op_sel:[0,0,0] op_sel_hi:[1,1,0]
s_waitcnt lgkmcnt(2)
v_fma_mix_f32 v165, v187, v187, v165 op_sel:[1,1,0] op_sel_hi:[1,1,0]
v_fma_mix_f32 v165, v149, v149, v165 op_sel:[1,1,0] op_sel_hi:[1,1,0]
s_setprio 3
v_pk_fma_f32 v[0:1], v[0:1], v[172:173], v[172:173] op_sel:[0,0,1] op_sel_hi:[1,0,1] neg_lo:[0,0,1] neg_hi:[0,0,1]
v_pk_fma_f32 v[2:3], v[2:3], v[172:173], v[172:173] op_sel:[0,0,1] op_sel_hi:[1,0,1] neg_lo:[0,0,1] neg_hi:[0,0,1]
v_pk_fma_f32 v[4:5], v[4:5], v[172:173], v[172:173] op_sel:[0,0,1] op_sel_hi:[1,0,1] neg_lo:[0,0,1] neg_hi:[0,0,1]
v_pk_fma_f32 v[6:7], v[6:7], v[172:173], v[172:173] op_sel:[0,0,1] op_sel_hi:[1,0,1] neg_lo:[0,0,1] neg_hi:[0,0,1]
v_pk_fma_f32 v[8:9], v[8:9], v[172:173], v[172:173] op_sel:[0,0,1] op_sel_hi:[1,0,1] neg_lo:[0,0,1] neg_hi:[0,0,1]
v_pk_fma_f32 v[10:11], v[10:11], v[172:173], v[172:173] op_sel:[0,0,1] op_sel_hi:[1,0,1] neg_lo:[0,0,1] neg_hi:[0,0,1]
v_pk_fma_f32 v[12:13], v[12:13], v[172:173], v[172:173] op_sel:[0,0,1] op_sel_hi:[1,0,1] neg_lo:[0,0,1] neg_hi:[0,0,1]
v_pk_fma_f32 v[14:15], v[14:15], v[172:173], v[172:173] op_sel:[0,0,1] op_sel_hi:[1,0,1] neg_lo:[0,0,1] neg_hi:[0,0,1]
v_pk_fma_f32 v[16:17], v[16:17], v[172:173], v[172:173] op_sel:[0,0,1] op_sel_hi:[1,0,1] neg_lo:[0,0,1] neg_hi:[0,0,1]
v_pk_fma_f32 v[18:19], v[18:19], v[172:173], v[172:173] op_sel:[0,0,1] op_sel_hi:[1,0,1] neg_lo:[0,0,1] neg_hi:[0,0,1]
v_pk_fma_f32 v[20:21], v[20:21], v[172:173], v[172:173] op_sel:[0,0,1] op_sel_hi:[1,0,1] neg_lo:[0,0,1] neg_hi:[0,0,1]
v_pk_fma_f32 v[22:23], v[22:23], v[172:173], v[172:173] op_sel:[0,0,1] op_sel_hi:[1,0,1] neg_lo:[0,0,1] neg_hi:[0,0,1]
v_pk_fma_f32 v[24:25], v[24:25], v[172:173], v[172:173] op_sel:[0,0,1] op_sel_hi:[1,0,1] neg_lo:[0,0,1] neg_hi:[0,0,1]
v_pk_fma_f32 v[26:27], v[26:27], v[172:173], v[172:173] op_sel:[0,0,1] op_sel_hi:[1,0,1] neg_lo:[0,0,1] neg_hi:[0,0,1]
v_pk_fma_f32 v[28:29], v[28:29], v[172:173], v[172:173] op_sel:[0,0,1] op_sel_hi:[1,0,1] neg_lo:[0,0,1] neg_hi:[0,0,1]
v_pk_fma_f32 v[30:31], v[30:31], v[172:173], v[172:173] op_sel:[0,0,1] op_sel_hi:[1,0,1] neg_lo:[0,0,1] neg_hi:[0,0,1]
v_pk_fma_f32 v[32:33], v[32:33], v[172:173], v[172:173] op_sel:[0,0,1] op_sel_hi:[1,0,1] neg_lo:[0,0,1] neg_hi:[0,0,1]
v_pk_fma_f32 v[34:35], v[34:35], v[172:173], v[172:173] op_sel:[0,0,1] op_sel_hi:[1,0,1] neg_lo:[0,0,1] neg_hi:[0,0,1]
v_pk_fma_f32 v[36:37], v[36:37], v[172:173], v[172:173] op_sel:[0,0,1] op_sel_hi:[1,0,1] neg_lo:[0,0,1] neg_hi:[0,0,1]
v_pk_fma_f32 v[38:39], v[38:39], v[172:173], v[172:173] op_sel:[0,0,1] op_sel_hi:[1,0,1] neg_lo:[0,0,1] neg_hi:[0,0,1]
v_pk_fma_f32 v[40:41], v[40:41], v[172:173], v[172:173] op_sel:[0,0,1] op_sel_hi:[1,0,1] neg_lo:[0,0,1] neg_hi:[0,0,1]
v_pk_fma_f32 v[42:43], v[42:43], v[172:173], v[172:173] op_sel:[0,0,1] op_sel_hi:[1,0,1] neg_lo:[0,0,1] neg_hi:[0,0,1]
v_pk_fma_f32 v[44:45], v[44:45], v[172:173], v[172:173] op_sel:[0,0,1] op_sel_hi:[1,0,1] neg_lo:[0,0,1] neg_hi:[0,0,1]
v_pk_fma_f32 v[46:47], v[46:47], v[172:173], v[172:173] op_sel:[0,0,1] op_sel_hi:[1,0,1] neg_lo:[0,0,1] neg_hi:[0,0,1]
s_setprio 2
s_waitcnt lgkmcnt(0)
v_readfirstlane_b32 s43, v247
s_nop 1
s_cmp_ge_u32 s43, 32
s_cbranch_scc1 Lev9
Lev9w:
s_sleep 1
ds_read_b32 v247, v253 offset:16
s_waitcnt lgkmcnt(0)
v_readfirstlane_b32 s43, v247
s_cmp_eq_u32 s76, 0
s_cbranch_scc1 Lev9
s_sub_u32 s76, s76, 1
s_cmp_lt_u32 s43, 32
s_cbranch_scc1 Lev9w
Lev9:
s_setprio 1
v_cvt_pkrtz_f16_f32 v137, v120, v121
v_cvt_pkrtz_f16_f32 v139, v122, v123
v_cvt_pkrtz_f16_f32 v141, v124, v125
v_cvt_pkrtz_f16_f32 v143, v126, v127
v_cvt_pkrtz_f16_f32 v145, v128, v129
v_cvt_pk_f16_f32 v155, v130, v131
v_cvt_pk_f16_f32 v152, v132, v133
v_cvt_pk_f16_f32 v149, v134, v135
s_add_u32 m0, s72, 0
s_add_u32 s43, s82, 0
buffer_load_dwordx4 v252, s[16:19], s43 offen lds
ds_read_b128 v[232:235], v249 offset:19456
ds_read_b128 v[236:239], v249 offset:22528
v_mfma_f32_32x32x16_bf16 v[120:135], v[224:227], v[96:99], 0
v_pk_fma_f16 v154, v155, v155, s48
v_and_b32 v192, 1, v251
v_cvt_pk_bf16_f32 v168, v0, v1
v_and_b32_e64 v137, s49, v137
v_pk_fma_f16 v151, v152, v152, s48
v_cvt_pk_bf16_f32 v169, v2, v3
v_lshlrev_b32 v192, 4, v192
v_and_b32 v139, s49, v139
v_pk_fma_f16 v148, v149, v149, s48
v_cvt_pk_bf16_f32 v170, v4, v5
v_pk_mul_f16 v154, v155, v154
v_mov_b32 v193, 15360
v_bfe_u32 v136, v137, 2, 14
v_pk_mul_f16 v151, v152, v151
v_cvt_pk_bf16_f32 v171, v6, v7
ds_read_b128 v[224:227], v249 offset:20480
ds_read_u16_d16 v136, v136
v_mfma_f32_32x32x16_bf16 v[120:135], v[228:231], v[100:103], v[120:135]
v_pk_mul_f16 v148, v149, v148
v_lshlrev_b32_e64 v192, v192, v193
v_bfe_u32 v138, v139, 2, 14
v_cvt_pk_bf16_f32 v172, v8, v9
v_exp_f16 v153, v154
v_lshrrev_b32 v193, 3, v251
v_cvt_pk_bf16_f32 v173, v10, v11
v_lshrrev_b32_e64 v137, 18, v137
v_exp_f16 v150, v151
v_xor_b32 v193, v193, v251
v_cvt_pk_bf16_f32 v174, v12, v13
v_lshrrev_b32 v139, 18, v139
v_exp_f16 v147, v148
s_waitcnt lgkmcnt(2)
s_add_u32 m0, s72, 1024
s_add_u32 s43, s82, 64
buffer_load_dwordx4 v252, s[16:19], s43 offen lds
ds_read_b128 v[228:231], v249 offset:23552
ds_read_u16_d16 v138, v138
ds_read_u16_d16_hi v137, v137
ds_read_u16_d16_hi v139, v139
v_mfma_f32_32x32x16_bf16 v[120:135], v[232:235], v[104:107], v[120:135]
v_and_b32_e64 v193, 4, v193
v_cvt_pk_bf16_f32 v175, v14, v15
v_and_b32_e64 v141, s49, v141
v_cvt_pk_bf16_f32 v176, v16, v17
v_and_b32_e64 v143, s49, v143
v_bfe_u32 v194, v251, 3, 2
v_exp_f16_sdwa v153, v154 dst_sel:WORD_1 dst_unused:UNUSED_PRESERVE src0_sel:WORD_1
v_cvt_pk_bf16_f32 v177, v18, v19
v_bfe_u32 v140, v141, 2, 14
v_lshl_add_u32 v193, v193, 1, 0
v_exp_f16_sdwa v150, v151 dst_sel:WORD_1 dst_unused:UNUSED_PRESERVE src0_sel:WORD_1
v_cvt_pk_bf16_f32 v178, v20, v21
v_bfe_u32 v142, v143, 2, 14
ds_read_b128 v[232:235], v248 offset:16384
ds_read_u16_d16 v140, v140
ds_read_u16_d16 v142, v142
v_mfma_f32_32x32x16_bf16 v[120:135], v[236:239], v[108:111], v[120:135]
v_lshl_add_u32 v193, v194, 1, v193
v_cvt_pk_bf16_f32 v179, v22, v23
v_exp_f16_sdwa v147, v148 dst_sel:WORD_1 dst_unused:UNUSED_PRESERVE src0_sel:WORD_1
v_lshrrev_b32_e64 v141, 18, v141
v_bfe_u32 v194, v251, 1, 1
v_cvt_pk_bf16_f32 v180, v24, v25
v_pk_add_f16 v153, v153, 1.0 op_sel_hi:[1,0]
v_lshrrev_b32_e64 v143, 18, v143
v_cvt_pk_bf16_f32 v181, v26, v27
v_add_u32_e64 v193, v193, v194
v_pk_add_f16 v150, v150, 1.0 op_sel_hi:[1,0]
v_pk_add_f16 v147, v147, 1.0 op_sel_hi:[1,0]
v_cvt_pk_bf16_f32 v182, v28, v29
v_and_b32_e64 v145, s49, v145
v_cmp_eq_u32 vcc, 0, v193
s_nop 1
v_cndmask_b32 v240, 0, v192, vcc
s_waitcnt lgkmcnt(3)
s_add_u32 m0, s72, 2048
s_add_u32 s43, s82, 128
buffer_load_dwordx4 v252, s[16:19], s43 offen lds
ds_read_b128 v[236:239], v248 offset:19456
ds_read_u16_d16_hi v141, v141
ds_read_u16_d16_hi v143, v143
v_mfma_f32_32x32x16_bf16 v[120:135], v[224:227], v[112:115], v[120:135]
v_rcp_f16_e64 v154, v153
v_cvt_pk_bf16_f32 v183, v30, v31
v_bfe_u32 v144, v145, 2, 14
v_cmp_eq_u32 vcc, 1, v193
s_nop 1
v_cndmask_b32 v241, 0, v192, vcc
v_rcp_f16_e64 v151, v150
s_setprio 0
v_cvt_pk_bf16_f32 v184, v32, v33
v_lshrrev_b32 v145, 18, v145
v_cmp_eq_u32 vcc, 2, v193
s_nop 1
v_cndmask_b32 v242, 0, v192, vcc
v_cvt_pk_bf16_f32 v185, v34, v35
v_rcp_f16_e64 v148, v147
v_or_b32 v208, v136, v137
v_cmp_eq_u32 vcc, 3, v193
s_nop 1
v_cndmask_b32 v243, 0, v192, vcc
v_cvt_pk_bf16_f32 v186, v36, v37
ds_read_b128 v[224:227], v248 offset:17408
ds_read_u16_d16 v144, v144
ds_read_u16_d16_hi v145, v145
v_mfma_f32_32x32x16_bf16 v[120:135], v[228:231], v[116:119], v[120:135]
v_or_b32 v209, v138, v139
v_rcp_f16_sdwa v154, v153 dst_sel:WORD_1 dst_unused:UNUSED_PRESERVE src0_sel:WORD_1
v_cmp_eq_u32 vcc, 4, v193
s_nop 1
v_cndmask_b32 v244, 0, v192, vcc
v_cvt_pk_bf16_f32 v187, v38, v39
s_waitcnt lgkmcnt(3)
v_or_b32 v210, v140, v141
v_cvt_pk_bf16_f32 v188, v40, v41
v_rcp_f16_sdwa v151, v150 dst_sel:WORD_1 dst_unused:UNUSED_PRESERVE src0_sel:WORD_1
v_cmp_eq_u32 vcc, 5, v193
s_nop 1
v_cndmask_b32 v245, 0, v192, vcc
v_or_b32 v211, v142, v143
v_cvt_pk_bf16_f32 v189, v42, v43
v_rcp_f16_sdwa v148, v147 dst_sel:WORD_1 dst_unused:UNUSED_PRESERVE src0_sel:WORD_1
v_cmp_eq_u32 vcc, 6, v193
s_nop 1
v_cndmask_b32 v246, 0, v192, vcc
v_cvt_pk_bf16_f32 v190, v44, v45
s_waitcnt lgkmcnt(0)
v_or_b32_e64 v212, v144, v145
v_pk_mul_f16 v213, v155, v154
v_cmp_eq_u32 vcc, 7, v193
s_nop 1
v_cndmask_b32 v247, 0, v192, vcc
v_cvt_pk_bf16_f32 v191, v46, v47
v_pk_mul_f16 v214, v152, v151
v_pk_mul_f16 v215, v149, v148
s_setprio 2
s_add_u32 m0, s72, 3072
s_add_u32 s43, s82, 3072
buffer_load_dwordx4 v252, s[16:19], s43 offen lds
ds_read_b128 v[228:231], v248 offset:20480
v_mfma_f32_32x32x16_f16 v[192:207], v[208:211], v[240:243], 0
v_cvt_pkrtz_f16_f32 v137, v120, v121
v_cvt_pkrtz_f16_f32 v139, v122, v123
v_cvt_pkrtz_f16_f32 v141, v124, v125
v_cvt_pkrtz_f16_f32 v143, v126, v127
v_cvt_pkrtz_f16_f32 v145, v128, v129
v_mfma_f32_32x32x16_f16 v[192:207], v[212:215], v[244:247], v[192:207]
v_cvt_pk_f16_f32 v155, v130, v131
v_cvt_pk_f16_f32 v152, v132, v133
v_cvt_pk_f16_f32 v149, v134, v135
v_pk_fma_f16 v154, v155, v155, s48
v_and_b32_e64 v137, s49, v137
v_mfma_f32_32x32x16_bf16 v[120:135], v[232:235], v[168:171], 0
v_pk_fma_f16 v151, v152, v152, s48
v_and_b32_e64 v139, s49, v139
v_pk_fma_f16 v148, v149, v149, s48
v_pk_mul_f16 v154, v155, v154
v_bfe_u32 v136, v137, 2, 14
v_pk_mul_f16 v151, v152, v151
v_pk_mul_f16 v148, v149, v148
v_bfe_u32 v138, v139, 2, 14
v_fmac_f32 v166, v192, v192
v_exp_f16 v153, v154
s_add_u32 m0, s72, 4096
s_add_u32 s43, s82, 3136
buffer_load_dwordx4 v252, s[16:19], s43 offen lds
ds_read_b128 v[232:235], v248 offset:18432
ds_read_u16_d16 v136, v136
ds_read_u16_d16 v138, v138
v_mfma_f32_32x32x16_bf16 v[120:135], v[236:239], v[172:175], v[120:135]
v_fmac_f32 v166, v193, v193
v_lshrrev_b32 v137, 18, v137
v_exp_f16 v150, v151
v_fmac_f32 v166, v194, v194
v_lshrrev_b32 v139, 18, v139
v_exp_f16 v147, v148
v_fmac_f32 v166, v195, v195
v_and_b32 v141, s49, v141
ds_read_b128 v[236:239], v248 offset:21504
ds_read_u16_d16_hi v137, v137
ds_read_u16_d16_hi v139, v139
v_mfma_f32_32x32x16_bf16 v[120:135], v[224:227], v[176:179], v[120:135]
v_and_b32_e64 v143, s49, v143
v_exp_f16_sdwa v153, v154 dst_sel:WORD_1 dst_unused:UNUSED_PRESERVE src0_sel:WORD_1
v_fmac_f32_e64 v166, v196, v196
v_bfe_u32 v140, v141, 2, 14
v_exp_f16_sdwa v150, v151 dst_sel:WORD_1 dst_unused:UNUSED_PRESERVE src0_sel:WORD_1
v_fmac_f32 v166, v197, v197
v_bfe_u32 v142, v143, 2, 14
v_exp_f16_sdwa v147, v148 dst_sel:WORD_1 dst_unused:UNUSED_PRESERVE src0_sel:WORD_1
s_waitcnt lgkmcnt(6)
ds_read_b128 v[224:227], v248 offset:22528
ds_read_u16_d16 v140, v140
ds_read_u16_d16 v142, v142
v_mfma_f32_32x32x16_bf16 v[120:135], v[228:231], v[180:183], v[120:135]
v_fmac_f32 v166, v198, v198
v_lshrrev_b32 v141, 18, v141
v_pk_add_f16 v153, v153, 1.0 op_sel_hi:[1,0]
v_fmac_f32 v166, v199, v199
v_lshrrev_b32 v143, 18, v143
v_pk_add_f16 v150, v150, 1.0 op_sel_hi:[1,0]
v_pk_add_f16 v147, v147, 1.0 op_sel_hi:[1,0]
v_fmac_f32_e64 v166, v200, v200
v_and_b32 v145, s49, v145
s_waitcnt lgkmcnt(4)
s_add_u32 m0, s72, 5120
s_add_u32 s43, s82, 3200
buffer_load_dwordx4 v252, s[16:19], s43 offen lds
ds_read_b128 v[228:231], v248 offset:25600
ds_read_u16_d16_hi v141, v141
ds_read_u16_d16_hi v143, v143
v_mfma_f32_32x32x16_bf16 v[120:135], v[232:235], v[184:187], v[120:135]
v_rcp_f16 v154, v153
v_fmac_f32 v166, v201, v201
v_bfe_u32 v144, v145, 2, 14
v_rcp_f16 v151, v150
v_fmac_f32 v166, v202, v202
v_lshrrev_b32 v145, 18, v145
v_rcp_f16 v148, v147
v_fmac_f32 v166, v203, v203
v_or_b32 v216, v136, v137
ds_read_b128 v[232:235], v248 offset:23552
ds_read_u16_d16 v144, v144
ds_read_u16_d16_hi v145, v145
v_mfma_f32_32x32x16_bf16 v[120:135], v[236:239], v[188:191], v[120:135]
s_waitcnt lgkmcnt(6)
v_or_b32 v217, v138, v139
v_rcp_f16_sdwa v154, v153 dst_sel:WORD_1 dst_unused:UNUSED_PRESERVE src0_sel:WORD_1
v_fmac_f32 v166, v204, v204
s_waitcnt lgkmcnt(4)
v_or_b32_e64 v218, v140, v141
v_rcp_f16_sdwa v151, v150 dst_sel:WORD_1 dst_unused:UNUSED_PRESERVE src0_sel:WORD_1
v_fmac_f32 v166, v205, v205
s_waitcnt lgkmcnt(3)
v_or_b32_e64 v219, v142, v143
v_rcp_f16_sdwa v148, v147 dst_sel:WORD_1 dst_unused:UNUSED_PRESERVE src0_sel:WORD_1
v_fmac_f32 v166, v206, v206
s_waitcnt lgkmcnt(0)
v_or_b32_e64 v220, v144, v145
v_pk_mul_f16 v221, v155, v154
v_fmac_f32_e64 v166, v207, v207
v_pk_mul_f16 v222, v152, v151
v_pk_mul_f16 v223, v149, v148
s_cmp_lg_u32 s40, 0
s_cbranch_scc1 Lrs0
v_mov_b32 v90, 0
buffer_load_dword v91, v90, s[36:39], 0 offen sc1
Lrs0:
s_setprio 1
s_add_u32 m0, s72, 6144
s_add_u32 s43, s82, 6144
buffer_load_dwordx4 v252, s[16:19], s43 offen lds
ds_read_b128 v[236:239], v248 offset:26624
v_mfma_f32_32x32x16_f16 v[192:207], v[216:219], v[240:243], 0
v_cvt_pkrtz_f16_f32 v137, v120, v121
v_cvt_pkrtz_f16_f32 v139, v122, v123
v_cvt_pkrtz_f16_f32 v141, v124, v125
v_cvt_pkrtz_f16_f32 v143, v126, v127
v_cvt_pkrtz_f16_f32 v145, v128, v129
v_mfma_f32_32x32x16_f16 v[192:207], v[220:223], v[244:247], v[192:207]
v_cvt_pk_f16_f32 v155, v130, v131
v_cvt_pk_f16_f32 v152, v132, v133
v_cvt_pk_f16_f32 v149, v134, v135
v_pk_fma_f16 v154, v155, v155, s48
v_and_b32 v255, 51, v251
v_and_b32 v137, s49, v137
v_mfma_f32_32x32x16_bf16 v[120:135], v[224:227], v[168:171], 0
v_pk_fma_f16 v151, v152, v152, s48
v_and_b32_e64 v139, s49, v139
v_pk_fma_f16 v148, v149, v149, s48
v_pk_mul_f16 v154, v155, v154
v_bfe_u32 v136, v137, 2, 14
v_pk_mul_f16 v151, v152, v151
v_pk_mul_f16 v148, v149, v148
v_bfe_u32 v138, v139, 2, 14
v_fmac_f32 v167, v192, v192
v_exp_f16 v153, v154
ds_read_b128 v[224:227], v248 offset:24576
ds_read_u16_d16 v136, v136
ds_read_u16_d16 v138, v138
v_mfma_f32_32x32x16_bf16 v[120:135], v[228:231], v[172:175], v[120:135]
v_bfe_u32 v95, v251, 2, 1
v_fmac_f32 v167, v193, v193
v_lshrrev_b32 v137, 18, v137
v_exp_f16 v150, v151
v_fmac_f32 v167, v194, v194
v_lshrrev_b32 v139, 18, v139
v_exp_f16 v147, v148
v_fmac_f32 v167, v195, v195
v_and_b32 v141, s49, v141
v_and_b32_e64 v143, s49, v143
ds_read_b128 v[228:231], v248 offset:27648
ds_read_u16_d16_hi v137, v137
ds_read_u16_d16_hi v139, v139
v_mfma_f32_32x32x16_bf16 v[120:135], v[232:235], v[176:179], v[120:135]
v_exp_f16_sdwa v153, v154 dst_sel:WORD_1 dst_unused:UNUSED_PRESERVE src0_sel:WORD_1
v_lshl_add_u32 v255, v95, 3, v255
v_fmac_f32_e64 v167, v196, v196
v_bfe_u32 v140, v141, 2, 14
v_exp_f16_sdwa v150, v151 dst_sel:WORD_1 dst_unused:UNUSED_PRESERVE src0_sel:WORD_1
v_fmac_f32 v167, v197, v197
v_bfe_u32 v142, v143, 2, 14
v_exp_f16_sdwa v147, v148 dst_sel:WORD_1 dst_unused:UNUSED_PRESERVE src0_sel:WORD_1
s_waitcnt lgkmcnt(4)
ds_read_b128 v[232:235], v248 offset:28672
ds_read_u16_d16 v140, v140
ds_read_u16_d16 v142, v142
v_mfma_f32_32x32x16_bf16 v[120:135], v[236:239], v[180:183], v[120:135]
v_fmac_f32 v167, v198, v198
v_lshrrev_b32 v141, 18, v141
v_pk_add_f16 v153, v153, 1.0 op_sel_hi:[1,0]
v_bfe_u32 v95, v251, 3, 1
v_fmac_f32 v167, v199, v199
v_lshrrev_b32 v143, 18, v143
v_pk_add_f16 v150, v150, 1.0 op_sel_hi:[1,0]
v_pk_add_f16 v147, v147, 1.0 op_sel_hi:[1,0]
v_fmac_f32 v167, v200, v200
v_and_b32 v145, s49, v145
v_rcp_f16_e64 v154, v153
ds_read_b128 v[236:239], v248 offset:31744
ds_read_u16_d16_hi v141, v141
ds_read_u16_d16_hi v143, v143
v_mfma_f32_32x32x16_bf16 v[120:135], v[224:227], v[184:187], v[120:135]
v_fmac_f32_e64 v167, v201, v201
v_bfe_u32 v144, v145, 2, 14
v_rcp_f16 v151, v150
s_setprio 0
v_lshl_add_u32 v255, v95, 2, v255
v_fmac_f32 v167, v202, v202
v_lshrrev_b32 v145, 18, v145
v_rcp_f16 v148, v147
v_fmac_f32 v167, v203, v203
s_waitcnt lgkmcnt(3)
v_or_b32 v0, v136, v137
ds_read_b128 v[224:227], v248 offset:29696
ds_read_u16_d16 v144, v144
ds_read_u16_d16_hi v145, v145
v_mfma_f32_32x32x16_bf16 v[120:135], v[228:231], v[188:191], v[120:135]
v_or_b32_e64 v1, v138, v139
v_rcp_f16_sdwa v154, v153 dst_sel:WORD_1 dst_unused:UNUSED_PRESERVE src0_sel:WORD_1
v_fmac_f32 v167, v204, v204
s_waitcnt lgkmcnt(4)
v_or_b32_e64 v2, v140, v141
v_rcp_f16_sdwa v151, v150 dst_sel:WORD_1 dst_unused:UNUSED_PRESERVE src0_sel:WORD_1
v_lshl_add_u32 v255, v255, 2, s72
v_fmac_f32 v167, v205, v205
s_waitcnt lgkmcnt(3)
v_or_b32_e64 v3, v142, v143
v_rcp_f16_sdwa v148, v147 dst_sel:WORD_1 dst_unused:UNUSED_PRESERVE src0_sel:WORD_1
v_fmac_f32 v167, v206, v206
s_waitcnt lgkmcnt(0)
v_or_b32_e64 v4, v144, v145
v_pk_mul_f16 v5, v155, v154
v_fmac_f32 v167, v207, v207
v_pk_mul_f16 v6, v152, v151
v_pk_mul_f16 v7, v149, v148
s_setprio 2
ds_read_b128 v[228:231], v248 offset:32768
v_mfma_f32_32x32x16_f16 v[192:207], v[0:3], v[240:243], 0
v_cvt_pkrtz_f16_f32 v137, v120, v121
v_cvt_pkrtz_f16_f32 v139, v122, v123
v_cvt_pkrtz_f16_f32 v141, v124, v125
v_cvt_pkrtz_f16_f32 v143, v126, v127
v_cvt_pkrtz_f16_f32 v145, v128, v129
v_mfma_f32_32x32x16_f16 v[192:207], v[4:7], v[244:247], v[192:207]
v_cvt_pk_f16_f32 v155, v130, v131
v_cvt_pk_f16_f32 v152, v132, v133
v_cvt_pk_f16_f32 v149, v134, v135
v_pk_fma_f16 v154, v155, v155, s48
v_and_b32_e64 v137, s49, v137
v_mfma_f32_32x32x16_bf16 v[120:135], v[232:235], v[168:171], 0
v_pk_fma_f16 v151, v152, v152, s48
v_and_b32_e64 v139, s49, v139
v_pk_fma_f16 v148, v149, v149, s48
v_pk_mul_f16 v154, v155, v154
v_bfe_u32 v136, v137, 2, 14
v_pk_mul_f16 v151, v152, v151
v_pk_mul_f16 v148, v149, v148
v_bfe_u32 v138, v139, 2, 14
v_fmac_f32 v156, v192, v192
v_exp_f16 v153, v154
ds_read_b128 v[232:235], v248 offset:30720
ds_read_u16_d16 v136, v136
ds_read_u16_d16 v138, v138
v_mfma_f32_32x32x16_bf16 v[120:135], v[236:239], v[172:175], v[120:135]
v_fmac_f32 v156, v193, v193
v_lshrrev_b32 v137, 18, v137
v_exp_f16 v150, v151
v_fmac_f32 v156, v194, v194
v_lshrrev_b32 v139, 18, v139
v_exp_f16 v147, v148
v_fmac_f32 v156, v195, v195
v_and_b32 v141, s49, v141
ds_read_b128 v[236:239], v248 offset:33792
ds_read_u16_d16_hi v137, v137
ds_read_u16_d16_hi v139, v139
v_mfma_f32_32x32x16_bf16 v[120:135], v[224:227], v[176:179], v[120:135]
v_and_b32_e64 v143, s49, v143
v_exp_f16_sdwa v153, v154 dst_sel:WORD_1 dst_unused:UNUSED_PRESERVE src0_sel:WORD_1
v_fmac_f32_e64 v156, v196, v196
v_bfe_u32 v140, v141, 2, 14
v_exp_f16_sdwa v150, v151 dst_sel:WORD_1 dst_unused:UNUSED_PRESERVE src0_sel:WORD_1
v_fmac_f32 v156, v197, v197
v_bfe_u32 v142, v143, 2, 14
v_exp_f16_sdwa v147, v148 dst_sel:WORD_1 dst_unused:UNUSED_PRESERVE src0_sel:WORD_1
s_waitcnt lgkmcnt(6)
ds_read_b128 v[224:227], v248 offset:34816
ds_read_u16_d16 v140, v140
ds_read_u16_d16 v142, v142
v_mfma_f32_32x32x16_bf16 v[120:135], v[228:231], v[180:183], v[120:135]
v_fmac_f32 v156, v198, v198
v_lshrrev_b32 v141, 18, v141
v_pk_add_f16 v153, v153, 1.0 op_sel_hi:[1,0]
v_fmac_f32 v156, v199, v199
v_lshrrev_b32 v143, 18, v143
v_pk_add_f16 v150, v150, 1.0 op_sel_hi:[1,0]
v_pk_add_f16 v147, v147, 1.0 op_sel_hi:[1,0]
v_fmac_f32_e64 v156, v200, v200
v_and_b32 v145, s49, v145
s_waitcnt lgkmcnt(4)
ds_read_b128 v[228:231], v248 offset:37888
ds_read_u16_d16_hi v141, v141
ds_read_u16_d16_hi v143, v143
v_mfma_f32_32x32x16_bf16 v[120:135], v[232:235], v[184:187], v[120:135]
v_rcp_f16 v154, v153
v_fmac_f32 v156, v201, v201
v_bfe_u32 v144, v145, 2, 14
v_rcp_f16 v151, v150
v_fmac_f32 v156, v202, v202
v_lshrrev_b32 v145, 18, v145
v_rcp_f16 v148, v147
v_fmac_f32 v156, v203, v203
v_or_b32 v8, v136, v137
ds_read_b128 v[232:235], v248 offset:35840
ds_read_u16_d16 v144, v144
ds_read_u16_d16_hi v145, v145
v_mfma_f32_32x32x16_bf16 v[120:135], v[236:239], v[188:191], v[120:135]
s_waitcnt lgkmcnt(6)
v_or_b32 v9, v138, v139
v_rcp_f16_sdwa v154, v153 dst_sel:WORD_1 dst_unused:UNUSED_PRESERVE src0_sel:WORD_1
v_fmac_f32 v156, v204, v204
s_waitcnt lgkmcnt(4)
v_or_b32_e64 v10, v140, v141
v_rcp_f16_sdwa v151, v150 dst_sel:WORD_1 dst_unused:UNUSED_PRESERVE src0_sel:WORD_1
v_fmac_f32 v156, v205, v205
s_waitcnt lgkmcnt(3)
v_or_b32_e64 v11, v142, v143
v_rcp_f16_sdwa v148, v147 dst_sel:WORD_1 dst_unused:UNUSED_PRESERVE src0_sel:WORD_1
v_fmac_f32 v156, v206, v206
s_waitcnt lgkmcnt(0)
v_or_b32_e64 v12, v144, v145
v_pk_mul_f16 v13, v155, v154
v_fmac_f32 v156, v207, v207
v_pk_mul_f16 v14, v152, v151
v_pk_mul_f16 v15, v149, v148
s_setprio 1
ds_read_b128 v[236:239], v248 offset:38912
v_mfma_f32_32x32x16_f16 v[192:207], v[8:11], v[240:243], 0
v_cvt_pkrtz_f16_f32 v137, v120, v121
v_cvt_pkrtz_f16_f32 v139, v122, v123
v_cvt_pkrtz_f16_f32 v141, v124, v125
v_cvt_pkrtz_f16_f32 v143, v126, v127
v_cvt_pkrtz_f16_f32 v145, v128, v129
v_mfma_f32_32x32x16_f16 v[192:207], v[12:15], v[244:247], v[192:207]
v_cvt_pk_f16_f32 v155, v130, v131
v_cvt_pk_f16_f32 v152, v132, v133
v_cvt_pk_f16_f32 v149, v134, v135
v_pk_fma_f16 v154, v155, v155, s48
v_and_b32_e64 v137, s49, v137
v_pk_fma_f16 v151, v152, v152, s48
v_mfma_f32_32x32x16_bf16 v[120:135], v[224:227], v[168:171], 0
v_and_b32_e64 v139, s49, v139
v_pk_fma_f16 v148, v149, v149, s48
v_pk_mul_f16 v154, v155, v154
v_bfe_u32 v136, v137, 2, 14
v_pk_mul_f16 v151, v152, v151
v_pk_mul_f16 v148, v149, v148
v_bfe_u32 v138, v139, 2, 14
v_fmac_f32 v157, v192, v192
v_exp_f16 v153, v154
v_fmac_f32_e64 v157, v193, v193
ds_read_b128 v[224:227], v248 offset:36864
ds_read_u16_d16 v136, v136
ds_read_u16_d16 v138, v138
v_mfma_f32_32x32x16_bf16 v[120:135], v[228:231], v[172:175], v[120:135]
v_lshrrev_b32 v137, 18, v137
v_exp_f16 v150, v151
v_fmac_f32 v157, v194, v194
v_lshrrev_b32 v139, 18, v139
v_exp_f16 v147, v148
v_fmac_f32 v157, v195, v195
v_and_b32 v141, s49, v141
v_fmac_f32 v157, v196, v196
v_and_b32_e64 v143, s49, v143
ds_read_b128 v[228:231], v248 offset:39936
ds_read_u16_d16_hi v137, v137
ds_read_u16_d16_hi v139, v139
v_mfma_f32_32x32x16_bf16 v[120:135], v[232:235], v[176:179], v[120:135]
v_exp_f16_sdwa v153, v154 dst_sel:WORD_1 dst_unused:UNUSED_PRESERVE src0_sel:WORD_1
v_fmac_f32_e64 v157, v197, v197
v_bfe_u32 v140, v141, 2, 14
v_exp_f16_sdwa v150, v151 dst_sel:WORD_1 dst_unused:UNUSED_PRESERVE src0_sel:WORD_1
v_fmac_f32_e64 v157, v198, v198
v_bfe_u32 v142, v143, 2, 14
v_exp_f16_sdwa v147, v148 dst_sel:WORD_1 dst_unused:UNUSED_PRESERVE src0_sel:WORD_1
v_fmac_f32 v157, v199, v199
s_waitcnt lgkmcnt(5)
ds_read_b128 v[232:235], v248 offset:40960
ds_read_u16_d16 v140, v140
ds_read_u16_d16 v142, v142
v_mfma_f32_32x32x16_bf16 v[120:135], v[236:239], v[180:183], v[120:135]
v_lshrrev_b32 v141, 18, v141
v_fmac_f32 v157, v200, v200
v_pk_add_f16 v153, v153, 1.0 op_sel_hi:[1,0]
v_lshrrev_b32_e64 v143, 18, v143
v_pk_add_f16 v150, v150, 1.0 op_sel_hi:[1,0]
v_fmac_f32_e64 v157, v201, v201
v_pk_add_f16 v147, v147, 1.0 op_sel_hi:[1,0]
v_and_b32 v145, s49, v145
v_fmac_f32 v157, v202, v202
v_rcp_f16_e64 v154, v153
ds_read_b128 v[236:239], v248 offset:44032
ds_read_u16_d16_hi v141, v141
ds_read_u16_d16_hi v143, v143
v_mfma_f32_32x32x16_bf16 v[120:135], v[224:227], v[184:187], v[120:135]
v_bfe_u32 v144, v145, 2, 14
v_fmac_f32 v157, v203, v203
v_rcp_f16 v151, v150
s_setprio 0
v_fmac_f32 v157, v204, v204
v_lshrrev_b32 v145, 18, v145
v_rcp_f16 v148, v147
v_fmac_f32 v157, v205, v205
s_waitcnt lgkmcnt(4)
v_or_b32 v16, v136, v137
v_or_b32 v17, v138, v139
ds_read_b128 v[224:227], v248 offset:41984
ds_read_u16_d16 v144, v144
ds_read_u16_d16_hi v145, v145
v_mfma_f32_32x32x16_bf16 v[120:135], v[228:231], v[188:191], v[120:135]
v_fmac_f32_e64 v157, v206, v206
v_rcp_f16_sdwa v154, v153 dst_sel:WORD_1 dst_unused:UNUSED_PRESERVE src0_sel:WORD_1
s_waitcnt lgkmcnt(4)
v_or_b32 v18, v140, v141
v_fmac_f32_e64 v157, v207, v207
v_rcp_f16_sdwa v151, v150 dst_sel:WORD_1 dst_unused:UNUSED_PRESERVE src0_sel:WORD_1
s_nop 0
v_permlane32_swap_b32 v156, v157
s_waitcnt lgkmcnt(3)
v_or_b32 v19, v142, v143
v_rcp_f16_sdwa v148, v147 dst_sel:WORD_1 dst_unused:UNUSED_PRESERVE src0_sel:WORD_1
s_waitcnt lgkmcnt(0)
v_or_b32 v20, v144, v145
v_pk_mul_f16 v21, v155, v154
v_add_f32_e64 v156, v156, v157
ds_write_b32 v255, v156 offset:7168
v_pk_mul_f16 v22, v152, v151
v_pk_mul_f16 v23, v149, v148
s_cmp_lg_u32 s40, 0
s_cbranch_scc1 Lrs1
v_mov_b32 v90, 0
Lpi:
s_waitcnt vmcnt(0)
v_readfirstlane_b32 s43, v91
s_cmp_eq_u32 s76, 0
s_cbranch_scc1 Lpix
s_sub_u32 s76, s76, 1
s_cmp_ge_u32 s43, 256
s_cbranch_scc1 Lpix
buffer_load_dword v91, v90, s[36:39], 0 offen sc1
s_branch Lpi
Lpix:
v_min_u32_e64 v88, 47, v251
v_lshlrev_b32 v88, 3, v88
s_and_b32 s44, s2, 7
s_lshl_b32 s44, s44, 11
s_add_u32 s44, s44, 394752
buffer_load_dwordx2 v[92:93], v88, s[32:35], s44 offen sc1
Lrs1:
s_setprio 2
ds_read_b128 v[228:231], v248 offset:45056
v_mfma_f32_32x32x16_f16 v[192:207], v[16:19], v[240:243], 0
v_cvt_pkrtz_f16_f32 v137, v120, v121
v_cvt_pkrtz_f16_f32 v139, v122, v123
v_cvt_pkrtz_f16_f32 v141, v124, v125
v_cvt_pkrtz_f16_f32 v143, v126, v127
v_cvt_pkrtz_f16_f32 v145, v128, v129
v_mfma_f32_32x32x16_f16 v[192:207], v[20:23], v[244:247], v[192:207]
v_cvt_pk_f16_f32 v155, v130, v131
v_cvt_pk_f16_f32 v152, v132, v133
v_cvt_pk_f16_f32 v149, v134, v135
v_pk_fma_f16 v154, v155, v155, s48
v_and_b32_e64 v137, s49, v137
v_mfma_f32_32x32x16_bf16 v[120:135], v[232:235], v[168:171], 0
v_pk_fma_f16 v151, v152, v152, s48
v_and_b32_e64 v139, s49, v139
v_pk_fma_f16 v148, v149, v149, s48
v_pk_mul_f16 v154, v155, v154
v_bfe_u32 v136, v137, 2, 14
v_pk_mul_f16 v151, v152, v151
v_pk_mul_f16 v148, v149, v148
v_bfe_u32 v138, v139, 2, 14
v_fmac_f32 v158, v192, v192
v_exp_f16 v153, v154
ds_read_b128 v[232:235], v248 offset:43008
ds_read_u16_d16 v136, v136
ds_read_u16_d16 v138, v138
v_mfma_f32_32x32x16_bf16 v[120:135], v[236:239], v[172:175], v[120:135]
v_fmac_f32 v158, v193, v193
v_lshrrev_b32 v137, 18, v137
v_exp_f16 v150, v151
v_fmac_f32 v158, v194, v194
v_lshrrev_b32 v139, 18, v139
v_exp_f16 v147, v148
v_fmac_f32 v158, v195, v195
v_and_b32 v141, s49, v141
ds_read_b128 v[236:239], v248 offset:46080
ds_read_u16_d16_hi v137, v137
ds_read_u16_d16_hi v139, v139
v_mfma_f32_32x32x16_bf16 v[120:135], v[224:227], v[176:179], v[120:135]
v_and_b32_e64 v143, s49, v143
v_exp_f16_sdwa v153, v154 dst_sel:WORD_1 dst_unused:UNUSED_PRESERVE src0_sel:WORD_1
v_fmac_f32_e64 v158, v196, v196
v_bfe_u32 v140, v141, 2, 14
v_exp_f16_sdwa v150, v151 dst_sel:WORD_1 dst_unused:UNUSED_PRESERVE src0_sel:WORD_1
v_fmac_f32 v158, v197, v197
v_bfe_u32 v142, v143, 2, 14
v_exp_f16_sdwa v147, v148 dst_sel:WORD_1 dst_unused:UNUSED_PRESERVE src0_sel:WORD_1
s_waitcnt lgkmcnt(6)
ds_read_b128 v[224:227], v248 offset:47104
ds_read_u16_d16 v140, v140
ds_read_u16_d16 v142, v142
v_mfma_f32_32x32x16_bf16 v[120:135], v[228:231], v[180:183], v[120:135]
v_fmac_f32 v158, v198, v198
v_lshrrev_b32 v141, 18, v141
v_pk_add_f16 v153, v153, 1.0 op_sel_hi:[1,0]
v_fmac_f32 v158, v199, v199
v_lshrrev_b32 v143, 18, v143
v_pk_add_f16 v150, v150, 1.0 op_sel_hi:[1,0]
v_pk_add_f16 v147, v147, 1.0 op_sel_hi:[1,0]
v_fmac_f32_e64 v158, v200, v200
v_and_b32 v145, s49, v145
s_waitcnt lgkmcnt(4)
ds_read_b128 v[228:231], v248 offset:50176
ds_read_u16_d16_hi v141, v141
ds_read_u16_d16_hi v143, v143
v_mfma_f32_32x32x16_bf16 v[120:135], v[232:235], v[184:187], v[120:135]
v_rcp_f16 v154, v153
v_fmac_f32 v158, v201, v201
v_bfe_u32 v144, v145, 2, 14
v_rcp_f16 v151, v150
v_fmac_f32 v158, v202, v202
v_lshrrev_b32 v145, 18, v145
v_rcp_f16 v148, v147
v_fmac_f32 v158, v203, v203
v_or_b32 v24, v136, v137
ds_read_b128 v[232:235], v248 offset:48128
ds_read_u16_d16 v144, v144
ds_read_u16_d16_hi v145, v145
v_mfma_f32_32x32x16_bf16 v[120:135], v[236:239], v[188:191], v[120:135]
s_waitcnt lgkmcnt(6)
v_or_b32 v25, v138, v139
v_rcp_f16_sdwa v154, v153 dst_sel:WORD_1 dst_unused:UNUSED_PRESERVE src0_sel:WORD_1
v_fmac_f32 v158, v204, v204
s_waitcnt lgkmcnt(4)
v_or_b32_e64 v26, v140, v141
v_rcp_f16_sdwa v151, v150 dst_sel:WORD_1 dst_unused:UNUSED_PRESERVE src0_sel:WORD_1
v_fmac_f32 v158, v205, v205
s_waitcnt lgkmcnt(3)
v_or_b32_e64 v27, v142, v143
v_rcp_f16_sdwa v148, v147 dst_sel:WORD_1 dst_unused:UNUSED_PRESERVE src0_sel:WORD_1
v_fmac_f32 v158, v206, v206
s_waitcnt lgkmcnt(0)
v_or_b32_e64 v28, v144, v145
v_pk_mul_f16 v29, v155, v154
v_fmac_f32 v158, v207, v207
v_pk_mul_f16 v30, v152, v151
v_pk_mul_f16 v31, v149, v148
s_setprio 1
ds_read_b128 v[236:239], v248 offset:51200
v_mfma_f32_32x32x16_f16 v[192:207], v[24:27], v[240:243], 0
v_cvt_pkrtz_f16_f32 v137, v120, v121
v_cvt_pkrtz_f16_f32 v139, v122, v123
v_cvt_pkrtz_f16_f32 v141, v124, v125
v_cvt_pkrtz_f16_f32 v143, v126, v127
v_cvt_pkrtz_f16_f32 v145, v128, v129
v_mfma_f32_32x32x16_f16 v[192:207], v[28:31], v[244:247], v[192:207]
v_cvt_pk_f16_f32 v155, v130, v131
v_cvt_pk_f16_f32 v152, v132, v133
v_cvt_pk_f16_f32 v149, v134, v135
v_pk_fma_f16 v154, v155, v155, s48
v_and_b32_e64 v137, s49, v137
v_pk_fma_f16 v151, v152, v152, s48
v_mfma_f32_32x32x16_bf16 v[120:135], v[224:227], v[168:171], 0
v_and_b32_e64 v139, s49, v139
v_pk_fma_f16 v148, v149, v149, s48
v_pk_mul_f16 v154, v155, v154
v_bfe_u32 v136, v137, 2, 14
v_pk_mul_f16 v151, v152, v151
v_pk_mul_f16 v148, v149, v148
v_bfe_u32 v138, v139, 2, 14
v_fmac_f32 v159, v192, v192
v_exp_f16 v153, v154
v_fmac_f32_e64 v159, v193, v193
ds_read_b128 v[224:227], v248 offset:49152
ds_read_u16_d16 v136, v136
ds_read_u16_d16 v138, v138
v_mfma_f32_32x32x16_bf16 v[120:135], v[228:231], v[172:175], v[120:135]
v_lshrrev_b32 v137, 18, v137
v_exp_f16 v150, v151
v_fmac_f32 v159, v194, v194
v_lshrrev_b32 v139, 18, v139
v_exp_f16 v147, v148
v_fmac_f32 v159, v195, v195
v_and_b32 v141, s49, v141
v_fmac_f32 v159, v196, v196
v_and_b32_e64 v143, s49, v143
ds_read_b128 v[228:231], v248 offset:52224
ds_read_u16_d16_hi v137, v137
ds_read_u16_d16_hi v139, v139
v_mfma_f32_32x32x16_bf16 v[120:135], v[232:235], v[176:179], v[120:135]
v_exp_f16_sdwa v153, v154 dst_sel:WORD_1 dst_unused:UNUSED_PRESERVE src0_sel:WORD_1
v_fmac_f32_e64 v159, v197, v197
v_bfe_u32 v140, v141, 2, 14
v_exp_f16_sdwa v150, v151 dst_sel:WORD_1 dst_unused:UNUSED_PRESERVE src0_sel:WORD_1
v_fmac_f32_e64 v159, v198, v198
v_bfe_u32 v142, v143, 2, 14
v_exp_f16_sdwa v147, v148 dst_sel:WORD_1 dst_unused:UNUSED_PRESERVE src0_sel:WORD_1
v_fmac_f32 v159, v199, v199
s_waitcnt lgkmcnt(5)
ds_read_b128 v[232:235], v248 offset:53248
ds_read_u16_d16 v140, v140
ds_read_u16_d16 v142, v142
v_mfma_f32_32x32x16_bf16 v[120:135], v[236:239], v[180:183], v[120:135]
v_lshrrev_b32 v141, 18, v141
v_fmac_f32 v159, v200, v200
v_pk_add_f16 v153, v153, 1.0 op_sel_hi:[1,0]
v_lshrrev_b32_e64 v143, 18, v143
v_pk_add_f16 v150, v150, 1.0 op_sel_hi:[1,0]
v_fmac_f32_e64 v159, v201, v201
v_pk_add_f16 v147, v147, 1.0 op_sel_hi:[1,0]
v_and_b32 v145, s49, v145
v_fmac_f32 v159, v202, v202
v_rcp_f16_e64 v154, v153
ds_read_b128 v[236:239], v248 offset:56320
ds_read_u16_d16_hi v141, v141
ds_read_u16_d16_hi v143, v143
v_mfma_f32_32x32x16_bf16 v[120:135], v[224:227], v[184:187], v[120:135]
v_bfe_u32 v144, v145, 2, 14
v_fmac_f32 v159, v203, v203
v_rcp_f16 v151, v150
s_setprio 0
v_fmac_f32 v159, v204, v204
v_lshrrev_b32 v145, 18, v145
v_rcp_f16 v148, v147
v_fmac_f32 v159, v205, v205
s_waitcnt lgkmcnt(4)
v_or_b32 v32, v136, v137
v_or_b32 v33, v138, v139
ds_read_b128 v[224:227], v248 offset:54272
ds_read_u16_d16 v144, v144
ds_read_u16_d16_hi v145, v145
v_mfma_f32_32x32x16_bf16 v[120:135], v[228:231], v[188:191], v[120:135]
v_fmac_f32_e64 v159, v206, v206
v_rcp_f16_sdwa v154, v153 dst_sel:WORD_1 dst_unused:UNUSED_PRESERVE src0_sel:WORD_1
s_waitcnt lgkmcnt(4)
v_or_b32 v34, v140, v141
v_fmac_f32_e64 v159, v207, v207
v_rcp_f16_sdwa v151, v150 dst_sel:WORD_1 dst_unused:UNUSED_PRESERVE src0_sel:WORD_1
s_nop 0
v_permlane32_swap_b32 v158, v159
s_waitcnt lgkmcnt(3)
v_or_b32 v35, v142, v143
v_rcp_f16_sdwa v148, v147 dst_sel:WORD_1 dst_unused:UNUSED_PRESERVE src0_sel:WORD_1
s_waitcnt lgkmcnt(0)
v_or_b32 v36, v144, v145
v_pk_mul_f16 v37, v155, v154
v_add_f32 v158, v158, v159
ds_write_b32 v255, v158 offset:7424
v_pk_mul_f16 v38, v152, v151
v_pk_mul_f16 v39, v149, v148
s_setprio 2
ds_read_b128 v[228:231], v248 offset:57344
v_mfma_f32_32x32x16_f16 v[192:207], v[32:35], v[240:243], 0
v_cvt_pkrtz_f16_f32 v137, v120, v121
v_cvt_pkrtz_f16_f32 v139, v122, v123
v_cvt_pkrtz_f16_f32 v141, v124, v125
v_cvt_pkrtz_f16_f32 v143, v126, v127
v_cvt_pkrtz_f16_f32 v145, v128, v129
v_mfma_f32_32x32x16_f16 v[192:207], v[36:39], v[244:247], v[192:207]
v_cvt_pk_f16_f32 v155, v130, v131
v_cvt_pk_f16_f32 v152, v132, v133
v_cvt_pk_f16_f32 v149, v134, v135
v_pk_fma_f16 v154, v155, v155, s48
v_and_b32_e64 v137, s49, v137
v_mfma_f32_32x32x16_bf16 v[120:135], v[232:235], v[168:171], 0
v_pk_fma_f16 v151, v152, v152, s48
v_and_b32_e64 v139, s49, v139
v_pk_fma_f16 v148, v149, v149, s48
v_pk_mul_f16 v154, v155, v154
v_bfe_u32 v136, v137, 2, 14
v_pk_mul_f16 v151, v152, v151
v_pk_mul_f16 v148, v149, v148
v_bfe_u32 v138, v139, 2, 14
v_fmac_f32 v160, v192, v192
v_exp_f16 v153, v154
ds_read_b128 v[232:235], v248 offset:55296
ds_read_u16_d16 v136, v136
ds_read_u16_d16 v138, v138
v_mfma_f32_32x32x16_bf16 v[120:135], v[236:239], v[172:175], v[120:135]
v_fmac_f32 v160, v193, v193
v_lshrrev_b32 v137, 18, v137
v_exp_f16 v150, v151
v_fmac_f32 v160, v194, v194
v_lshrrev_b32 v139, 18, v139
v_exp_f16 v147, v148
v_fmac_f32 v160, v195, v195
v_and_b32 v141, s49, v141
ds_read_b128 v[236:239], v248 offset:58368
ds_read_u16_d16_hi v137, v137
ds_read_u16_d16_hi v139, v139
v_mfma_f32_32x32x16_bf16 v[120:135], v[224:227], v[176:179], v[120:135]
v_and_b32_e64 v143, s49, v143
v_exp_f16_sdwa v153, v154 dst_sel:WORD_1 dst_unused:UNUSED_PRESERVE src0_sel:WORD_1
v_fmac_f32_e64 v160, v196, v196
v_bfe_u32 v140, v141, 2, 14
v_exp_f16_sdwa v150, v151 dst_sel:WORD_1 dst_unused:UNUSED_PRESERVE src0_sel:WORD_1
v_fmac_f32 v160, v197, v197
v_bfe_u32 v142, v143, 2, 14
v_exp_f16_sdwa v147, v148 dst_sel:WORD_1 dst_unused:UNUSED_PRESERVE src0_sel:WORD_1
s_waitcnt lgkmcnt(6)
ds_read_b128 v[224:227], v248 offset:59392
ds_read_u16_d16 v140, v140
ds_read_u16_d16 v142, v142
v_mfma_f32_32x32x16_bf16 v[120:135], v[228:231], v[180:183], v[120:135]
v_fmac_f32 v160, v198, v198
v_lshrrev_b32 v141, 18, v141
v_pk_add_f16 v153, v153, 1.0 op_sel_hi:[1,0]
v_fmac_f32 v160, v199, v199
v_lshrrev_b32 v143, 18, v143
v_pk_add_f16 v150, v150, 1.0 op_sel_hi:[1,0]
v_pk_add_f16 v147, v147, 1.0 op_sel_hi:[1,0]
v_fmac_f32_e64 v160, v200, v200
v_and_b32 v145, s49, v145
s_waitcnt lgkmcnt(4)
ds_read_b128 v[228:231], v248 offset:62464
ds_read_u16_d16_hi v141, v141
ds_read_u16_d16_hi v143, v143
v_mfma_f32_32x32x16_bf16 v[120:135], v[232:235], v[184:187], v[120:135]
v_rcp_f16 v154, v153
v_fmac_f32 v160, v201, v201
v_bfe_u32 v144, v145, 2, 14
v_rcp_f16 v151, v150
v_fmac_f32 v160, v202, v202
v_lshrrev_b32 v145, 18, v145
v_rcp_f16 v148, v147
v_fmac_f32 v160, v203, v203
v_or_b32 v40, v136, v137
ds_read_b128 v[232:235], v248 offset:60416
ds_read_u16_d16 v144, v144
ds_read_u16_d16_hi v145, v145
v_mfma_f32_32x32x16_bf16 v[120:135], v[236:239], v[188:191], v[120:135]
s_waitcnt lgkmcnt(6)
v_or_b32 v41, v138, v139
v_rcp_f16_sdwa v154, v153 dst_sel:WORD_1 dst_unused:UNUSED_PRESERVE src0_sel:WORD_1
v_fmac_f32 v160, v204, v204
s_waitcnt lgkmcnt(4)
v_or_b32_e64 v42, v140, v141
v_rcp_f16_sdwa v151, v150 dst_sel:WORD_1 dst_unused:UNUSED_PRESERVE src0_sel:WORD_1
v_fmac_f32 v160, v205, v205
s_waitcnt lgkmcnt(3)
v_or_b32_e64 v43, v142, v143
v_rcp_f16_sdwa v148, v147 dst_sel:WORD_1 dst_unused:UNUSED_PRESERVE src0_sel:WORD_1
v_fmac_f32 v160, v206, v206
s_waitcnt lgkmcnt(0)
v_or_b32_e64 v44, v144, v145
v_pk_mul_f16 v45, v155, v154
v_fmac_f32_e64 v160, v207, v207
v_pk_mul_f16 v46, v152, v151
v_pk_mul_f16 v47, v149, v148
s_cmp_lg_u32 s40, 0
s_cbranch_scc1 Lrs2
v_min_u32 v88, 47, v251
v_lshlrev_b32 v88, 3, v88
v_add_u32 v89, 7936, v88
v_add_u32 v88, 15872, v88
v_cmp_gt_u32 vcc, 32, v251
s_nop 1
v_cndmask_b32 v88, v88, v89, vcc
s_waitcnt vmcnt(0)
ds_write_b64 v88, v[92:93]
Lrs2:
s_setprio 1
ds_read_b128 v[236:239], v248 offset:63488
v_mfma_f32_32x32x16_f16 v[192:207], v[40:43], v[240:243], 0
v_cvt_pkrtz_f16_f32 v137, v120, v121
v_cvt_pkrtz_f16_f32 v139, v122, v123
v_cvt_pkrtz_f16_f32 v141, v124, v125
v_cvt_pkrtz_f16_f32 v143, v126, v127
s_waitcnt lgkmcnt(1)
v_cvt_pkrtz_f16_f32 v145, v128, v129
v_mfma_f32_32x32x16_f16 v[192:207], v[44:47], v[244:247], v[192:207]
v_cvt_pk_f16_f32 v155, v130, v131
v_cvt_pk_f16_f32 v152, v132, v133
v_cvt_pk_f16_f32 v149, v134, v135
v_pk_fma_f16 v154, v155, v155, s48
v_and_b32_e64 v137, s49, v137
v_pk_fma_f16 v151, v152, v152, s48
v_mfma_f32_32x32x16_bf16 v[120:135], v[224:227], v[168:171], 0
v_and_b32_e64 v139, s49, v139
v_pk_fma_f16 v148, v149, v149, s48
v_pk_mul_f16 v154, v155, v154
v_bfe_u32 v136, v137, 2, 14
v_pk_mul_f16 v151, v152, v151
v_pk_mul_f16 v148, v149, v148
v_bfe_u32 v138, v139, 2, 14
v_fmac_f32 v161, v192, v192
v_exp_f16 v153, v154
v_fmac_f32_e64 v161, v193, v193
ds_read_b128 v[224:227], v248 offset:61440
ds_read_u16_d16 v136, v136
ds_read_u16_d16 v138, v138
v_mfma_f32_32x32x16_bf16 v[120:135], v[228:231], v[172:175], v[120:135]
v_lshrrev_b32 v137, 18, v137
v_exp_f16 v150, v151
v_fmac_f32 v161, v194, v194
v_lshrrev_b32 v139, 18, v139
v_exp_f16 v147, v148
v_fmac_f32 v161, v195, v195
v_and_b32 v141, s49, v141
v_fmac_f32 v161, v196, v196
v_and_b32_e64 v143, s49, v143
ds_read_b128 v[228:231], v248 offset:64512
ds_read_u16_d16_hi v137, v137
ds_read_u16_d16_hi v139, v139
v_mfma_f32_32x32x16_bf16 v[120:135], v[232:235], v[176:179], v[120:135]
v_exp_f16_sdwa v153, v154 dst_sel:WORD_1 dst_unused:UNUSED_PRESERVE src0_sel:WORD_1
v_fmac_f32_e64 v161, v197, v197
v_bfe_u32 v140, v141, 2, 14
v_exp_f16_sdwa v150, v151 dst_sel:WORD_1 dst_unused:UNUSED_PRESERVE src0_sel:WORD_1
v_fmac_f32_e64 v161, v198, v198
v_bfe_u32 v142, v143, 2, 14
v_exp_f16_sdwa v147, v148 dst_sel:WORD_1 dst_unused:UNUSED_PRESERVE src0_sel:WORD_1
v_fmac_f32 v161, v199, v199
s_waitcnt lgkmcnt(5)
ds_read_b128 v[232:235], v249
ds_read_u16_d16 v140, v140
ds_read_u16_d16 v142, v142
v_mfma_f32_32x32x16_bf16 v[120:135], v[236:239], v[180:183], v[120:135]
v_lshrrev_b32 v141, 18, v141
v_fmac_f32 v161, v200, v200
v_pk_add_f16 v153, v153, 1.0 op_sel_hi:[1,0]
v_lshrrev_b32_e64 v143, 18, v143
v_pk_add_f16 v150, v150, 1.0 op_sel_hi:[1,0]
v_fmac_f32_e64 v161, v201, v201
v_pk_add_f16 v147, v147, 1.0 op_sel_hi:[1,0]
v_and_b32 v145, s49, v145
v_fmac_f32 v161, v202, v202
v_rcp_f16_e64 v154, v153
ds_read_b128 v[236:239], v249 offset:3072
ds_read_u16_d16_hi v141, v141
ds_read_u16_d16_hi v143, v143
v_mfma_f32_32x32x16_bf16 v[120:135], v[224:227], v[184:187], v[120:135]
v_bfe_u32 v144, v145, 2, 14
v_fmac_f32 v161, v203, v203
v_rcp_f16 v151, v150
s_setprio 0
v_fmac_f32 v161, v204, v204
v_lshrrev_b32 v145, 18, v145
v_rcp_f16 v148, v147
v_fmac_f32 v161, v205, v205
s_waitcnt lgkmcnt(4)
v_or_b32 v48, v136, v137
v_or_b32 v49, v138, v139
ds_read_b128 v[224:227], v249 offset:1024
ds_read_u16_d16 v144, v144
ds_read_u16_d16_hi v145, v145
v_mfma_f32_32x32x16_bf16 v[120:135], v[228:231], v[188:191], v[120:135]
v_fmac_f32_e64 v161, v206, v206
v_rcp_f16_sdwa v154, v153 dst_sel:WORD_1 dst_unused:UNUSED_PRESERVE src0_sel:WORD_1
s_waitcnt lgkmcnt(4)
v_or_b32 v50, v140, v141
v_fmac_f32_e64 v161, v207, v207
v_rcp_f16_sdwa v151, v150 dst_sel:WORD_1 dst_unused:UNUSED_PRESERVE src0_sel:WORD_1
s_nop 0
v_permlane32_swap_b32 v160, v161
s_waitcnt lgkmcnt(3)
v_or_b32 v51, v142, v143
v_rcp_f16_sdwa v148, v147 dst_sel:WORD_1 dst_unused:UNUSED_PRESERVE src0_sel:WORD_1
s_waitcnt lgkmcnt(0)
v_or_b32 v52, v144, v145
v_pk_mul_f16 v53, v155, v154
v_add_f32 v160, v160, v161
ds_write_b32 v255, v160 offset:7680
v_pk_mul_f16 v54, v152, v151
v_pk_mul_f16 v55, v149, v148
s_setprio 2
ds_read_b128 v[228:231], v249 offset:4096
v_mfma_f32_32x32x16_f16 v[192:207], v[48:51], v[240:243], 0
v_cvt_pkrtz_f16_f32 v137, v120, v121
v_cvt_pkrtz_f16_f32 v139, v122, v123
v_cvt_pkrtz_f16_f32 v141, v124, v125
v_cvt_pkrtz_f16_f32 v143, v126, v127
v_cvt_pkrtz_f16_f32 v145, v128, v129
v_mfma_f32_32x32x16_f16 v[192:207], v[52:55], v[244:247], v[192:207]
v_cvt_pk_f16_f32 v155, v130, v131
v_cvt_pk_f16_f32 v152, v132, v133
v_cvt_pk_f16_f32 v149, v134, v135
v_pk_fma_f16 v154, v155, v155, s48
v_and_b32_e64 v137, s49, v137
v_mfma_f32_32x32x16_bf16 v[120:135], v[232:235], v[168:171], 0
v_pk_fma_f16 v151, v152, v152, s48
v_and_b32_e64 v139, s49, v139
v_pk_fma_f16 v148, v149, v149, s48
v_pk_mul_f16 v154, v155, v154
v_bfe_u32 v136, v137, 2, 14
v_pk_mul_f16 v151, v152, v151
v_pk_mul_f16 v148, v149, v148
v_bfe_u32 v138, v139, 2, 14
v_fmac_f32 v162, v192, v192
v_exp_f16 v153, v154
ds_read_b128 v[232:235], v249 offset:2048
ds_read_u16_d16 v136, v136
ds_read_u16_d16 v138, v138
v_mfma_f32_32x32x16_bf16 v[120:135], v[236:239], v[172:175], v[120:135]
v_fmac_f32 v162, v193, v193
v_lshrrev_b32 v137, 18, v137
v_exp_f16 v150, v151
v_fmac_f32 v162, v194, v194
v_lshrrev_b32 v139, 18, v139
v_exp_f16 v147, v148
v_fmac_f32 v162, v195, v195
v_and_b32 v141, s49, v141
ds_read_b128 v[236:239], v249 offset:5120
ds_read_u16_d16_hi v137, v137
ds_read_u16_d16_hi v139, v139
v_mfma_f32_32x32x16_bf16 v[120:135], v[224:227], v[176:179], v[120:135]
v_and_b32_e64 v143, s49, v143
v_exp_f16_sdwa v153, v154 dst_sel:WORD_1 dst_unused:UNUSED_PRESERVE src0_sel:WORD_1
v_fmac_f32_e64 v162, v196, v196
v_bfe_u32 v140, v141, 2, 14
v_exp_f16_sdwa v150, v151 dst_sel:WORD_1 dst_unused:UNUSED_PRESERVE src0_sel:WORD_1
v_fmac_f32 v162, v197, v197
v_bfe_u32 v142, v143, 2, 14
v_exp_f16_sdwa v147, v148 dst_sel:WORD_1 dst_unused:UNUSED_PRESERVE src0_sel:WORD_1
s_waitcnt lgkmcnt(6)
ds_read_b128 v[224:227], v249 offset:6144
ds_read_u16_d16 v140, v140
ds_read_u16_d16 v142, v142
v_mfma_f32_32x32x16_bf16 v[120:135], v[228:231], v[180:183], v[120:135]
v_fmac_f32 v162, v198, v198
v_lshrrev_b32 v141, 18, v141
v_pk_add_f16 v153, v153, 1.0 op_sel_hi:[1,0]
v_fmac_f32 v162, v199, v199
v_lshrrev_b32 v143, 18, v143
v_pk_add_f16 v150, v150, 1.0 op_sel_hi:[1,0]
v_pk_add_f16 v147, v147, 1.0 op_sel_hi:[1,0]
v_fmac_f32_e64 v162, v200, v200
v_and_b32 v145, s49, v145
s_waitcnt lgkmcnt(4)
ds_read_b128 v[228:231], v249 offset:9216
ds_read_u16_d16_hi v141, v141
ds_read_u16_d16_hi v143, v143
v_mfma_f32_32x32x16_bf16 v[120:135], v[232:235], v[184:187], v[120:135]
v_rcp_f16 v154, v153
v_fmac_f32 v162, v201, v201
v_bfe_u32 v144, v145, 2, 14
v_rcp_f16 v151, v150
v_fmac_f32 v162, v202, v202
v_lshrrev_b32 v145, 18, v145
v_rcp_f16 v148, v147
v_fmac_f32 v162, v203, v203
v_or_b32 v56, v136, v137
ds_read_b128 v[232:235], v249 offset:7168
ds_read_u16_d16 v144, v144
ds_read_u16_d16_hi v145, v145
v_mfma_f32_32x32x16_bf16 v[120:135], v[236:239], v[188:191], v[120:135]
s_waitcnt lgkmcnt(6)
v_or_b32 v57, v138, v139
v_rcp_f16_sdwa v154, v153 dst_sel:WORD_1 dst_unused:UNUSED_PRESERVE src0_sel:WORD_1
v_fmac_f32 v162, v204, v204
s_waitcnt lgkmcnt(4)
v_or_b32_e64 v58, v140, v141
v_rcp_f16_sdwa v151, v150 dst_sel:WORD_1 dst_unused:UNUSED_PRESERVE src0_sel:WORD_1
v_fmac_f32 v162, v205, v205
s_waitcnt lgkmcnt(3)
v_or_b32_e64 v59, v142, v143
v_rcp_f16_sdwa v148, v147 dst_sel:WORD_1 dst_unused:UNUSED_PRESERVE src0_sel:WORD_1
v_fmac_f32 v162, v206, v206
s_waitcnt lgkmcnt(0)
v_or_b32_e64 v60, v144, v145
v_pk_mul_f16 v61, v155, v154
v_fmac_f32 v162, v207, v207
v_pk_mul_f16 v62, v152, v151
v_pk_mul_f16 v63, v149, v148
s_setprio 1
ds_read_b128 v[236:239], v249 offset:10240
v_mfma_f32_32x32x16_f16 v[192:207], v[56:59], v[240:243], 0
v_cvt_pkrtz_f16_f32 v137, v120, v121
v_cvt_pkrtz_f16_f32 v139, v122, v123
v_cvt_pkrtz_f16_f32 v141, v124, v125
v_cvt_pkrtz_f16_f32 v143, v126, v127
v_cvt_pkrtz_f16_f32 v145, v128, v129
v_mfma_f32_32x32x16_f16 v[192:207], v[60:63], v[244:247], v[192:207]
v_cvt_pk_f16_f32 v155, v130, v131
v_cvt_pk_f16_f32 v152, v132, v133
v_cvt_pk_f16_f32 v149, v134, v135
v_pk_fma_f16 v154, v155, v155, s48
v_and_b32_e64 v137, s49, v137
v_pk_fma_f16 v151, v152, v152, s48
v_mfma_f32_32x32x16_bf16 v[120:135], v[224:227], v[168:171], 0
v_and_b32_e64 v139, s49, v139
v_pk_fma_f16 v148, v149, v149, s48
v_pk_mul_f16 v154, v155, v154
v_bfe_u32 v136, v137, 2, 14
v_pk_mul_f16 v151, v152, v151
v_pk_mul_f16 v148, v149, v148
v_bfe_u32 v138, v139, 2, 14
v_fmac_f32 v163, v192, v192
v_exp_f16 v153, v154
v_fmac_f32_e64 v163, v193, v193
ds_read_b128 v[224:227], v249 offset:8192
ds_read_u16_d16 v136, v136
ds_read_u16_d16 v138, v138
v_mfma_f32_32x32x16_bf16 v[120:135], v[228:231], v[172:175], v[120:135]
v_lshrrev_b32 v137, 18, v137
v_exp_f16 v150, v151
v_fmac_f32 v163, v194, v194
v_lshrrev_b32 v139, 18, v139
v_exp_f16 v147, v148
v_fmac_f32 v163, v195, v195
v_and_b32 v141, s49, v141
v_fmac_f32 v163, v196, v196
v_and_b32_e64 v143, s49, v143
ds_read_b128 v[228:231], v249 offset:11264
ds_read_u16_d16_hi v137, v137
ds_read_u16_d16_hi v139, v139
v_mfma_f32_32x32x16_bf16 v[120:135], v[232:235], v[176:179], v[120:135]
v_exp_f16_sdwa v153, v154 dst_sel:WORD_1 dst_unused:UNUSED_PRESERVE src0_sel:WORD_1
v_fmac_f32_e64 v163, v197, v197
v_bfe_u32 v140, v141, 2, 14
v_exp_f16_sdwa v150, v151 dst_sel:WORD_1 dst_unused:UNUSED_PRESERVE src0_sel:WORD_1
v_fmac_f32_e64 v163, v198, v198
v_bfe_u32 v142, v143, 2, 14
v_exp_f16_sdwa v147, v148 dst_sel:WORD_1 dst_unused:UNUSED_PRESERVE src0_sel:WORD_1
v_fmac_f32 v163, v199, v199
s_waitcnt lgkmcnt(5)
ds_read_b128 v[232:235], v249 offset:12288
ds_read_u16_d16 v140, v140
ds_read_u16_d16 v142, v142
v_mfma_f32_32x32x16_bf16 v[120:135], v[236:239], v[180:183], v[120:135]
v_lshrrev_b32 v141, 18, v141
v_fmac_f32 v163, v200, v200
v_pk_add_f16 v153, v153, 1.0 op_sel_hi:[1,0]
v_lshrrev_b32_e64 v143, 18, v143
v_pk_add_f16 v150, v150, 1.0 op_sel_hi:[1,0]
v_fmac_f32_e64 v163, v201, v201
v_pk_add_f16 v147, v147, 1.0 op_sel_hi:[1,0]
v_and_b32 v145, s49, v145
v_fmac_f32 v163, v202, v202
v_rcp_f16_e64 v154, v153
ds_read_b128 v[236:239], v249 offset:15360
ds_read_u16_d16_hi v141, v141
ds_read_u16_d16_hi v143, v143
v_mfma_f32_32x32x16_bf16 v[120:135], v[224:227], v[184:187], v[120:135]
v_bfe_u32 v144, v145, 2, 14
v_fmac_f32 v163, v203, v203
v_rcp_f16 v151, v150
s_setprio 0
v_fmac_f32 v163, v204, v204
v_lshrrev_b32 v145, 18, v145
v_rcp_f16 v148, v147
v_fmac_f32 v163, v205, v205
s_waitcnt lgkmcnt(4)
v_or_b32 v64, v136, v137
v_or_b32 v65, v138, v139
ds_read_b128 v[224:227], v249 offset:13312
ds_read_u16_d16 v144, v144
ds_read_u16_d16_hi v145, v145
v_mfma_f32_32x32x16_bf16 v[120:135], v[228:231], v[188:191], v[120:135]
v_fmac_f32_e64 v163, v206, v206
v_rcp_f16_sdwa v154, v153 dst_sel:WORD_1 dst_unused:UNUSED_PRESERVE src0_sel:WORD_1
s_waitcnt lgkmcnt(4)
v_or_b32 v66, v140, v141
v_fmac_f32_e64 v163, v207, v207
v_rcp_f16_sdwa v151, v150 dst_sel:WORD_1 dst_unused:UNUSED_PRESERVE src0_sel:WORD_1
s_nop 0
v_permlane32_swap_b32 v162, v163
s_waitcnt lgkmcnt(3)
v_or_b32 v67, v142, v143
v_rcp_f16_sdwa v148, v147 dst_sel:WORD_1 dst_unused:UNUSED_PRESERVE src0_sel:WORD_1
s_waitcnt lgkmcnt(0)
v_or_b32 v68, v144, v145
v_pk_mul_f16 v69, v155, v154
v_add_f32 v162, v162, v163
ds_write_b32 v255, v162 offset:7936
v_pk_mul_f16 v70, v152, v151
v_pk_mul_f16 v71, v149, v148
s_setprio 2
ds_read_b128 v[228:231], v249 offset:16384
v_mfma_f32_32x32x16_f16 v[192:207], v[64:67], v[240:243], 0
v_cvt_pkrtz_f16_f32 v137, v120, v121
v_cvt_pkrtz_f16_f32 v139, v122, v123
v_cvt_pkrtz_f16_f32 v141, v124, v125
v_cvt_pkrtz_f16_f32 v143, v126, v127
v_cvt_pkrtz_f16_f32 v145, v128, v129
v_mfma_f32_32x32x16_f16 v[192:207], v[68:71], v[244:247], v[192:207]
v_cvt_pk_f16_f32 v155, v130, v131
v_cvt_pk_f16_f32 v152, v132, v133
v_cvt_pk_f16_f32 v149, v134, v135
v_pk_fma_f16 v154, v155, v155, s48
v_and_b32_e64 v137, s49, v137
v_mfma_f32_32x32x16_bf16 v[120:135], v[232:235], v[168:171], 0
v_pk_fma_f16 v151, v152, v152, s48
v_and_b32_e64 v139, s49, v139
v_pk_fma_f16 v148, v149, v149, s48
v_pk_mul_f16 v154, v155, v154
v_bfe_u32 v136, v137, 2, 14
v_pk_mul_f16 v151, v152, v151
v_pk_mul_f16 v148, v149, v148
v_bfe_u32 v138, v139, 2, 14
v_fmac_f32 v164, v192, v192
v_exp_f16 v153, v154
ds_read_b128 v[232:235], v249 offset:14336
ds_read_u16_d16 v136, v136
ds_read_u16_d16 v138, v138
v_mfma_f32_32x32x16_bf16 v[120:135], v[236:239], v[172:175], v[120:135]
v_fmac_f32 v164, v193, v193
v_lshrrev_b32 v137, 18, v137
v_exp_f16 v150, v151
v_fmac_f32 v164, v194, v194
v_lshrrev_b32 v139, 18, v139
v_exp_f16 v147, v148
v_fmac_f32 v164, v195, v195
v_and_b32 v141, s49, v141
ds_read_b128 v[236:239], v249 offset:17408
ds_read_u16_d16_hi v137, v137
ds_read_u16_d16_hi v139, v139
v_mfma_f32_32x32x16_bf16 v[120:135], v[224:227], v[176:179], v[120:135]
v_and_b32_e64 v143, s49, v143
v_exp_f16_sdwa v153, v154 dst_sel:WORD_1 dst_unused:UNUSED_PRESERVE src0_sel:WORD_1
v_fmac_f32_e64 v164, v196, v196
v_bfe_u32 v140, v141, 2, 14
v_exp_f16_sdwa v150, v151 dst_sel:WORD_1 dst_unused:UNUSED_PRESERVE src0_sel:WORD_1
v_fmac_f32 v164, v197, v197
v_bfe_u32 v142, v143, 2, 14
v_exp_f16_sdwa v147, v148 dst_sel:WORD_1 dst_unused:UNUSED_PRESERVE src0_sel:WORD_1
s_waitcnt lgkmcnt(6)
ds_read_b128 v[224:227], v249 offset:18432
ds_read_u16_d16 v140, v140
ds_read_u16_d16 v142, v142
v_mfma_f32_32x32x16_bf16 v[120:135], v[228:231], v[180:183], v[120:135]
v_fmac_f32 v164, v198, v198
v_lshrrev_b32 v141, 18, v141
v_pk_add_f16 v153, v153, 1.0 op_sel_hi:[1,0]
v_fmac_f32 v164, v199, v199
v_lshrrev_b32 v143, 18, v143
v_pk_add_f16 v150, v150, 1.0 op_sel_hi:[1,0]
v_pk_add_f16 v147, v147, 1.0 op_sel_hi:[1,0]
v_fmac_f32_e64 v164, v200, v200
v_and_b32 v145, s49, v145
s_waitcnt lgkmcnt(4)
ds_read_b128 v[228:231], v249 offset:21504
ds_read_u16_d16_hi v141, v141
ds_read_u16_d16_hi v143, v143
v_mfma_f32_32x32x16_bf16 v[120:135], v[232:235], v[184:187], v[120:135]
v_rcp_f16 v154, v153
v_fmac_f32 v164, v201, v201
v_bfe_u32 v144, v145, 2, 14
v_rcp_f16 v151, v150
v_fmac_f32 v164, v202, v202
v_lshrrev_b32 v145, 18, v145
v_rcp_f16 v148, v147
v_fmac_f32 v164, v203, v203
v_or_b32 v72, v136, v137
ds_read_b128 v[232:235], v249 offset:19456
ds_read_u16_d16 v144, v144
ds_read_u16_d16_hi v145, v145
v_mfma_f32_32x32x16_bf16 v[120:135], v[236:239], v[188:191], v[120:135]
s_waitcnt lgkmcnt(6)
v_or_b32 v73, v138, v139
v_rcp_f16_sdwa v154, v153 dst_sel:WORD_1 dst_unused:UNUSED_PRESERVE src0_sel:WORD_1
v_fmac_f32 v164, v204, v204
s_waitcnt lgkmcnt(4)
v_or_b32_e64 v74, v140, v141
v_rcp_f16_sdwa v151, v150 dst_sel:WORD_1 dst_unused:UNUSED_PRESERVE src0_sel:WORD_1
v_fmac_f32 v164, v205, v205
s_waitcnt lgkmcnt(3)
v_or_b32_e64 v75, v142, v143
v_rcp_f16_sdwa v148, v147 dst_sel:WORD_1 dst_unused:UNUSED_PRESERVE src0_sel:WORD_1
v_fmac_f32 v164, v206, v206
s_waitcnt lgkmcnt(0)
v_or_b32_e64 v76, v144, v145
v_pk_mul_f16 v77, v155, v154
v_fmac_f32 v164, v207, v207
v_pk_mul_f16 v78, v152, v151
v_pk_mul_f16 v79, v149, v148
s_setprio 1
ds_read_b128 v[236:239], v249 offset:22528
v_mfma_f32_32x32x16_f16 v[192:207], v[72:75], v[240:243], 0
v_cvt_pkrtz_f16_f32 v137, v120, v121
v_cvt_pkrtz_f16_f32 v139, v122, v123
v_cvt_pkrtz_f16_f32 v141, v124, v125
v_cvt_pkrtz_f16_f32 v143, v126, v127
v_cvt_pkrtz_f16_f32 v145, v128, v129
v_mfma_f32_32x32x16_f16 v[192:207], v[76:79], v[244:247], v[192:207]
v_cvt_pk_f16_f32 v155, v130, v131
v_cvt_pk_f16_f32 v152, v132, v133
v_cvt_pk_f16_f32 v149, v134, v135
v_pk_fma_f16 v154, v155, v155, s48
v_and_b32_e64 v137, s49, v137
v_pk_fma_f16 v151, v152, v152, s48
v_mfma_f32_32x32x16_bf16 v[120:135], v[224:227], v[168:171], 0
v_and_b32_e64 v139, s49, v139
v_pk_fma_f16 v148, v149, v149, s48
v_pk_mul_f16 v154, v155, v154
v_bfe_u32 v136, v137, 2, 14
v_pk_mul_f16 v151, v152, v151
v_pk_mul_f16 v148, v149, v148
v_bfe_u32 v138, v139, 2, 14
v_fmac_f32 v165, v192, v192
v_exp_f16 v153, v154
v_fmac_f32_e64 v165, v193, v193
ds_read_b128 v[224:227], v249 offset:20480
ds_read_u16_d16 v136, v136
ds_read_u16_d16 v138, v138
v_mfma_f32_32x32x16_bf16 v[120:135], v[228:231], v[172:175], v[120:135]
v_lshrrev_b32 v137, 18, v137
v_exp_f16 v150, v151
v_fmac_f32 v165, v194, v194
v_lshrrev_b32 v139, 18, v139
v_exp_f16 v147, v148
v_fmac_f32 v165, v195, v195
v_and_b32 v141, s49, v141
v_fmac_f32 v165, v196, v196
v_and_b32_e64 v143, s49, v143
ds_read_b128 v[228:231], v249 offset:23552
ds_read_u16_d16_hi v137, v137
ds_read_u16_d16_hi v139, v139
v_mfma_f32_32x32x16_bf16 v[120:135], v[232:235], v[176:179], v[120:135]
v_exp_f16_sdwa v153, v154 dst_sel:WORD_1 dst_unused:UNUSED_PRESERVE src0_sel:WORD_1
v_fmac_f32_e64 v165, v197, v197
v_bfe_u32 v140, v141, 2, 14
v_exp_f16_sdwa v150, v151 dst_sel:WORD_1 dst_unused:UNUSED_PRESERVE src0_sel:WORD_1
v_fmac_f32_e64 v165, v198, v198
v_bfe_u32 v142, v143, 2, 14
v_exp_f16_sdwa v147, v148 dst_sel:WORD_1 dst_unused:UNUSED_PRESERVE src0_sel:WORD_1
v_fmac_f32 v165, v199, v199
s_waitcnt lgkmcnt(5)
ds_read_b128 v[232:235], v248 offset:40960
ds_read_u16_d16 v140, v140
ds_read_u16_d16 v142, v142
v_mfma_f32_32x32x16_bf16 v[120:135], v[236:239], v[180:183], v[120:135]
v_lshrrev_b32 v141, 18, v141
v_fmac_f32 v165, v200, v200
v_pk_add_f16 v153, v153, 1.0 op_sel_hi:[1,0]
v_lshrrev_b32_e64 v143, 18, v143
v_pk_add_f16 v150, v150, 1.0 op_sel_hi:[1,0]
v_fmac_f32_e64 v165, v201, v201
v_pk_add_f16 v147, v147, 1.0 op_sel_hi:[1,0]
v_and_b32 v145, s49, v145
v_fmac_f32 v165, v202, v202
v_rcp_f16_e64 v154, v153
ds_read_b128 v[236:239], v248 offset:44032
ds_read_u16_d16_hi v141, v141
ds_read_u16_d16_hi v143, v143
v_mfma_f32_32x32x16_bf16 v[120:135], v[224:227], v[184:187], v[120:135]
v_bfe_u32 v144, v145, 2, 14
v_fmac_f32 v165, v203, v203
v_rcp_f16 v151, v150
s_setprio 0
v_fmac_f32 v165, v204, v204
v_lshrrev_b32 v145, 18, v145
v_rcp_f16 v148, v147
v_fmac_f32 v165, v205, v205
s_waitcnt lgkmcnt(4)
v_or_b32 v80, v136, v137
v_or_b32 v81, v138, v139
ds_read_b128 v[224:227], v248 offset:41984
ds_read_u16_d16 v144, v144
ds_read_u16_d16_hi v145, v145
v_mfma_f32_32x32x16_bf16 v[120:135], v[228:231], v[188:191], v[120:135]
v_fmac_f32_e64 v165, v206, v206
v_rcp_f16_sdwa v154, v153 dst_sel:WORD_1 dst_unused:UNUSED_PRESERVE src0_sel:WORD_1
s_waitcnt lgkmcnt(4)
v_or_b32 v82, v140, v141
v_fmac_f32_e64 v165, v207, v207
v_rcp_f16_sdwa v151, v150 dst_sel:WORD_1 dst_unused:UNUSED_PRESERVE src0_sel:WORD_1
s_nop 0
v_permlane32_swap_b32 v164, v165
s_waitcnt lgkmcnt(3)
v_or_b32 v83, v142, v143
v_rcp_f16_sdwa v148, v147 dst_sel:WORD_1 dst_unused:UNUSED_PRESERVE src0_sel:WORD_1
s_waitcnt lgkmcnt(0)
v_or_b32 v84, v144, v145
v_pk_mul_f16 v85, v155, v154
v_add_f32 v164, v164, v165
ds_write_b32 v255, v164 offset:8192
v_pk_mul_f16 v86, v152, v151
v_pk_mul_f16 v87, v149, v148
s_setprio 2
ds_read_b128 v[228:231], v248 offset:45056
v_mfma_f32_32x32x16_f16 v[192:207], v[80:83], v[240:243], 0
v_cvt_pkrtz_f16_f32 v137, v120, v121
v_cvt_pkrtz_f16_f32 v139, v122, v123
v_cvt_pkrtz_f16_f32 v141, v124, v125
v_cvt_pkrtz_f16_f32 v143, v126, v127
v_cvt_pkrtz_f16_f32 v145, v128, v129
v_mfma_f32_32x32x16_f16 v[192:207], v[84:87], v[244:247], v[192:207]
v_cvt_pk_f16_f32 v155, v130, v131
v_cvt_pk_f16_f32 v152, v132, v133
v_cvt_pk_f16_f32 v149, v134, v135
v_pk_fma_f16 v154, v155, v155, s48
v_and_b32_e64 v137, s49, v137
v_mfma_f32_32x32x16_bf16 v[120:135], v[232:235], v[96:99], 0
v_pk_fma_f16 v151, v152, v152, s48
v_and_b32_e64 v139, s49, v139
v_pk_fma_f16 v148, v149, v149, s48
v_pk_mul_f16 v154, v155, v154
v_bfe_u32 v136, v137, 2, 14
v_pk_mul_f16 v151, v152, v151
v_pk_mul_f16 v148, v149, v148
v_bfe_u32 v138, v139, 2, 14
v_fmac_f32 v166, v192, v192
v_exp_f16 v153, v154
ds_read_b128 v[232:235], v248 offset:43008
ds_read_u16_d16 v136, v136
ds_read_u16_d16 v138, v138
v_mfma_f32_32x32x16_bf16 v[120:135], v[236:239], v[100:103], v[120:135]
v_fmac_f32 v166, v193, v193
v_lshrrev_b32 v137, 18, v137
v_exp_f16 v150, v151
v_fmac_f32 v166, v194, v194
v_lshrrev_b32 v139, 18, v139
v_exp_f16 v147, v148
v_fmac_f32 v166, v195, v195
v_and_b32 v141, s49, v141
ds_read_b128 v[236:239], v248 offset:46080
ds_read_u16_d16_hi v137, v137
ds_read_u16_d16_hi v139, v139
v_mfma_f32_32x32x16_bf16 v[120:135], v[224:227], v[104:107], v[120:135]
v_and_b32_e64 v143, s49, v143
v_exp_f16_sdwa v153, v154 dst_sel:WORD_1 dst_unused:UNUSED_PRESERVE src0_sel:WORD_1
v_fmac_f32_e64 v166, v196, v196
v_bfe_u32 v140, v141, 2, 14
v_exp_f16_sdwa v150, v151 dst_sel:WORD_1 dst_unused:UNUSED_PRESERVE src0_sel:WORD_1
v_fmac_f32 v166, v197, v197
v_bfe_u32 v142, v143, 2, 14
v_exp_f16_sdwa v147, v148 dst_sel:WORD_1 dst_unused:UNUSED_PRESERVE src0_sel:WORD_1
s_waitcnt lgkmcnt(6)
ds_read_b128 v[224:227], v248 offset:47104
ds_read_u16_d16 v140, v140
ds_read_u16_d16 v142, v142
v_mfma_f32_32x32x16_bf16 v[120:135], v[228:231], v[108:111], v[120:135]
v_fmac_f32 v166, v198, v198
v_lshrrev_b32 v141, 18, v141
v_pk_add_f16 v153, v153, 1.0 op_sel_hi:[1,0]
v_fmac_f32 v166, v199, v199
v_lshrrev_b32 v143, 18, v143
v_pk_add_f16 v150, v150, 1.0 op_sel_hi:[1,0]
v_pk_add_f16 v147, v147, 1.0 op_sel_hi:[1,0]
v_fmac_f32_e64 v166, v200, v200
v_and_b32 v145, s49, v145
s_waitcnt lgkmcnt(4)
ds_read_b128 v[228:231], v248 offset:50176
ds_read_u16_d16_hi v141, v141
ds_read_u16_d16_hi v143, v143
v_mfma_f32_32x32x16_bf16 v[120:135], v[232:235], v[112:115], v[120:135]
v_rcp_f16 v154, v153
v_fmac_f32 v166, v201, v201
v_bfe_u32 v144, v145, 2, 14
v_rcp_f16 v151, v150
v_fmac_f32 v166, v202, v202
v_lshrrev_b32 v145, 18, v145
v_rcp_f16 v148, v147
v_fmac_f32 v166, v203, v203
v_or_b32 v88, v136, v137
ds_read_b128 v[232:235], v248 offset:48128
ds_read_u16_d16 v144, v144
ds_read_u16_d16_hi v145, v145
v_mfma_f32_32x32x16_bf16 v[120:135], v[236:239], v[116:119], v[120:135]
s_waitcnt lgkmcnt(6)
v_or_b32 v89, v138, v139
v_rcp_f16_sdwa v154, v153 dst_sel:WORD_1 dst_unused:UNUSED_PRESERVE src0_sel:WORD_1
v_fmac_f32 v166, v204, v204
s_waitcnt lgkmcnt(4)
v_or_b32_e64 v90, v140, v141
v_rcp_f16_sdwa v151, v150 dst_sel:WORD_1 dst_unused:UNUSED_PRESERVE src0_sel:WORD_1
v_fmac_f32 v166, v205, v205
s_waitcnt lgkmcnt(3)
v_or_b32_e64 v91, v142, v143
v_rcp_f16_sdwa v148, v147 dst_sel:WORD_1 dst_unused:UNUSED_PRESERVE src0_sel:WORD_1
v_fmac_f32 v166, v206, v206
s_waitcnt lgkmcnt(0)
v_or_b32_e64 v92, v144, v145
v_pk_mul_f16 v93, v155, v154
v_fmac_f32 v166, v207, v207
v_pk_mul_f16 v94, v152, v151
v_pk_mul_f16 v95, v149, v148
s_setprio 1
ds_read_b128 v[236:239], v248 offset:51200
v_mfma_f32_32x32x16_f16 v[192:207], v[88:91], v[240:243], 0
v_cvt_pkrtz_f16_f32 v137, v120, v121
v_cvt_pkrtz_f16_f32 v139, v122, v123
v_cvt_pkrtz_f16_f32 v141, v124, v125
v_cvt_pkrtz_f16_f32 v143, v126, v127
v_cvt_pkrtz_f16_f32 v145, v128, v129
v_mfma_f32_32x32x16_f16 v[192:207], v[92:95], v[244:247], v[192:207]
v_cvt_pk_f16_f32 v155, v130, v131
v_cvt_pk_f16_f32 v152, v132, v133
v_cvt_pk_f16_f32 v149, v134, v135
v_pk_fma_f16 v154, v155, v155, s48
v_and_b32_e64 v137, s49, v137
v_pk_fma_f16 v151, v152, v152, s48
v_mfma_f32_32x32x16_bf16 v[120:135], v[224:227], v[96:99], 0
v_and_b32_e64 v139, s49, v139
v_pk_fma_f16 v148, v149, v149, s48
v_pk_mul_f16 v154, v155, v154
v_bfe_u32 v136, v137, 2, 14
v_pk_mul_f16 v151, v152, v151
v_pk_mul_f16 v148, v149, v148
v_fmac_f32 v167, v192, v192
v_fmac_f32 v167, v193, v193
v_fmac_f32 v167, v194, v194
v_fmac_f32 v167, v195, v195
v_fmac_f32_e64 v167, v196, v196
ds_read_b128 v[224:227], v248 offset:49152
ds_read_u16_d16 v136, v136
v_mfma_f32_32x32x16_bf16 v[120:135], v[228:231], v[100:103], v[120:135]
v_fmac_f32 v167, v197, v197
v_fmac_f32 v167, v198, v198
v_fmac_f32 v167, v199, v199
v_fmac_f32 v167, v200, v200
v_fmac_f32 v167, v201, v201
v_fmac_f32 v167, v202, v202
v_fmac_f32 v167, v203, v203
v_fmac_f32 v167, v204, v204
v_fmac_f32 v167, v205, v205
v_fmac_f32 v167, v206, v206
v_fmac_f32_e64 v167, v207, v207
ds_read_b128 v[228:231], v248 offset:52224
v_mfma_f32_32x32x16_bf16 v[120:135], v[232:235], v[104:107], v[120:135]
v_permlane32_swap_b32 v166, v167
v_add_f32 v166, v166, v167
ds_write_b32 v255, v166 offset:8448
s_setprio 3
s_mov_b64 exec, 1
ds_add_rtn_u32 v242, v253, v254
s_mov_b64 exec, -1
s_waitcnt lgkmcnt(0)
v_readfirstlane_b32 s43, v242
s_nop 1
s_cmp_lg_u32 s43, 7
s_cbranch_scc1 Lnopub
v_min_u32 v243, 47, v251
v_lshlrev_b32 v244, 5, v243
v_add_u32 v244, 97280, v244
ds_read_b128 v[168:171], v244
ds_read_b128 v[172:175], v244 offset:16
ds_read_b128 v[176:179], v244 offset:9216
ds_read_b128 v[180:183], v244 offset:9232
ds_read_b128 v[184:187], v244 offset:18432
ds_read_b128 v[188:191], v244 offset:18448
ds_read_b128 v[192:195], v244 offset:27648
ds_read_b128 v[196:199], v244 offset:27664
ds_read_b128 v[200:203], v244 offset:36864
ds_read_b128 v[204:207], v244 offset:36880
ds_read_b128 v[156:159], v244 offset:46080
ds_read_b128 v[160:163], v244 offset:46096
v_lshlrev_b32_e64 v246, 13, v243
v_add_u32 v247, 4096, v246
s_waitcnt lgkmcnt(9)
v_add_f32 v168, v168, v176
v_add_f32 v169, v169, v177
v_add_f32 v170, v170, v178
v_add_f32 v171, v171, v179
s_waitcnt lgkmcnt(8)
v_add_f32 v172, v172, v180
v_add_f32 v173, v173, v181
v_add_f32 v174, v174, v182
v_add_f32 v175, v175, v183
ds_read_b128 v[176:179], v244 offset:55296
ds_read_b128 v[180:183], v244 offset:55312
s_waitcnt lgkmcnt(7)
v_add_f32 v184, v184, v192
v_add_f32 v185, v185, v193
v_add_f32 v186, v186, v194
v_add_f32 v187, v187, v195
s_waitcnt lgkmcnt(6)
v_add_f32 v188, v188, v196
v_add_f32 v189, v189, v197
v_add_f32 v190, v190, v198
v_add_f32 v191, v191, v199
ds_read_b128 v[192:195], v244 offset:64512
ds_read_b128 v[196:199], v244 offset:64528
s_waitcnt lgkmcnt(5)
v_add_f32 v200, v200, v156
v_add_f32 v201, v201, v157
v_add_f32 v202, v202, v158
v_add_f32 v203, v203, v159
s_waitcnt lgkmcnt(4)
v_add_f32 v204, v204, v160
v_add_f32 v205, v205, v161
v_add_f32 v206, v206, v162
v_add_f32 v207, v207, v163
v_add_f32 v168, v168, v184
v_add_f32 v169, v169, v185
v_add_f32 v170, v170, v186
v_add_f32 v171, v171, v187
v_add_f32 v172, v172, v188
v_add_f32 v173, v173, v189
v_add_f32 v174, v174, v190
v_add_f32 v175, v175, v191
s_waitcnt lgkmcnt(1)
v_add_f32 v176, v176, v192
v_add_f32 v177, v177, v193
v_add_f32 v178, v178, v194
v_add_f32 v179, v179, v195
s_waitcnt lgkmcnt(0)
v_add_f32 v180, v180, v196
v_add_f32 v181, v181, v197
v_add_f32 v182, v182, v198
v_add_f32 v183, v183, v199
v_add_f32 v200, v200, v176
v_add_f32 v201, v201, v177
v_add_f32 v202, v202, v178
v_add_f32 v203, v203, v179
v_add_f32 v204, v204, v180
v_add_f32 v205, v205, v181
v_add_f32 v206, v206, v182
v_add_f32 v207, v207, v183
v_add_f32 v168, v168, v200
v_add_f32 v169, v169, v201
v_add_f32 v170, v170, v202
v_add_f32 v171, v171, v203
v_add_f32 v172, v172, v204
v_add_f32 v173, v173, v205
v_add_f32 v174, v174, v206
v_add_f32 v175, v175, v207
v_min_u32 v176, -2, v168
v_min_u32 v177, -2, v169
v_min_u32 v178, -2, v170
v_min_u32 v179, -2, v171
v_min_u32 v180, -2, v172
v_min_u32 v181, -2, v173
v_min_u32_e64 v182, -2, v174
v_min_u32 v183, -2, v175
s_lshl_b32 s43, s2, 4
buffer_store_dwordx4 v[176:179], v246, s[32:35], s43 offen sc1
buffer_store_dwordx4 v[180:183], v247, s[32:35], s43 offen sc1
ds_write_b32 v253, v254 offset:4
s_nop 1
Lnopub:
s_mov_b32 s77, 0
s_cmp_lg_u32 s40, 0
s_cbranch_scc1 Lnorole
v_lshlrev_b32_e64 v247, 2, v251
buffer_load_dword v244, v247, s[24:27], 0 offen offset:0
buffer_load_dword v245, v247, s[24:27], 0 offen offset:256
buffer_load_dword v246, v247, s[24:27], 0 offen offset:512
s_cmp_lt_u32 s2, 96
s_cselect_b32 s77, 1, 2
s_waitcnt lgkmcnt(0)
v_mov_b32 v156, -1
v_mov_b32 v157, -1
v_mov_b32 v158, -1
v_mov_b32 v159, -1
v_mov_b32 v160, -1
v_mov_b32 v161, -1
v_mov_b32 v162, -1
v_mov_b32 v163, -1
v_mov_b32 v164, -1
v_mov_b32 v165, -1
v_mov_b32 v166, -1
v_mov_b32 v167, -1
v_mov_b32 v240, -1
v_mov_b32 v241, -1
v_mov_b32 v242, -1
v_mov_b32 v243, -1
s_call_b64 s[78:79], Lpoll1
Lnorole:
s_setprio 1
v_bfe_u32 v138, v139, 2, 14
v_exp_f16 v153, v154
v_lshrrev_b32 v137, 18, v137
v_exp_f16 v150, v151
v_lshrrev_b32 v139, 18, v139
ds_read_b128 v[232:235], v248 offset:53248
ds_read_u16_d16 v138, v138
ds_read_u16_d16_hi v137, v137
ds_read_u16_d16_hi v139, v139
v_mfma_f32_32x32x16_bf16 v[120:135], v[236:239], v[108:111], v[120:135]
v_exp_f16 v147, v148
v_and_b32 v141, s49, v141
v_and_b32_e64 v143, s49, v143
v_exp_f16_sdwa v153, v154 dst_sel:WORD_1 dst_unused:UNUSED_PRESERVE src0_sel:WORD_1
v_bfe_u32 v140, v141, 2, 14
v_exp_f16_sdwa v150, v151 dst_sel:WORD_1 dst_unused:UNUSED_PRESERVE src0_sel:WORD_1
v_bfe_u32 v142, v143, 2, 14
v_exp_f16_sdwa v147, v148 dst_sel:WORD_1 dst_unused:UNUSED_PRESERVE src0_sel:WORD_1
ds_read_b128 v[236:239], v248 offset:56320
ds_read_u16_d16 v140, v140
ds_read_u16_d16 v142, v142
v_mfma_f32_32x32x16_bf16 v[120:135], v[224:227], v[112:115], v[120:135]
v_lshrrev_b32_e64 v141, 18, v141
v_pk_add_f16 v153, v153, 1.0 op_sel_hi:[1,0]
v_lshrrev_b32 v143, 18, v143
v_pk_add_f16 v150, v150, 1.0 op_sel_hi:[1,0]
s_setprio 0
v_pk_add_f16 v147, v147, 1.0 op_sel_hi:[1,0]
v_and_b32 v145, s49, v145
v_rcp_f16 v154, v153
v_bfe_u32 v144, v145, 2, 14
v_rcp_f16_e64 v151, v150
ds_read_b128 v[224:227], v248 offset:54272
ds_read_u16_d16_hi v141, v141
ds_read_u16_d16_hi v143, v143
ds_read_u16_d16 v144, v144
v_mfma_f32_32x32x16_bf16 v[120:135], v[228:231], v[116:119], v[120:135]
v_lshrrev_b32 v145, 18, v145
v_rcp_f16 v148, v147
s_waitcnt lgkmcnt(7)
v_or_b32 v168, v136, v137
v_or_b32_e64 v169, v138, v139
v_rcp_f16_sdwa v154, v153 dst_sel:WORD_1 dst_unused:UNUSED_PRESERVE src0_sel:WORD_1
s_waitcnt lgkmcnt(2)
v_or_b32 v170, v140, v141
v_rcp_f16_sdwa v151, v150 dst_sel:WORD_1 dst_unused:UNUSED_PRESERVE src0_sel:WORD_1
s_waitcnt lgkmcnt(1)
v_or_b32 v171, v142, v143
v_rcp_f16_sdwa v148, v147 dst_sel:WORD_1 dst_unused:UNUSED_PRESERVE src0_sel:WORD_1
ds_read_u16_d16_hi v145, v145
s_waitcnt lgkmcnt(0)
v_or_b32 v172, v144, v145
v_pk_mul_f16 v173, v155, v154
v_pk_mul_f16 v174, v152, v151
v_pk_mul_f16 v175, v149, v148
s_cmp_eq_u32 s77, 0
s_cbranch_scc1 Lpp49
s_getreg_b32 s43, hwreg(HW_REG_IB_STS, 0, 4)
s_cmp_lg_u32 s43, 0
s_cbranch_scc1 Lpp49
s_call_b64 s[78:79], Lpoll
s_setprio 0
Lpp49:
s_setprio 2
v_cvt_pkrtz_f16_f32 v137, v120, v121
v_cvt_pkrtz_f16_f32 v139, v122, v123
v_cvt_pkrtz_f16_f32 v141, v124, v125
v_cvt_pkrtz_f16_f32 v143, v126, v127
v_cvt_pkrtz_f16_f32 v145, v128, v129
v_cvt_pk_f16_f32 v155, v130, v131
v_cvt_pk_f16_f32 v152, v132, v133
v_cvt_pk_f16_f32 v149, v134, v135
ds_read_b128 v[228:231], v248 offset:57344
v_mfma_f32_32x32x16_bf16 v[120:135], v[232:235], v[96:99], 0
v_pk_fma_f16 v154, v155, v155, s48
v_and_b32_e64 v137, s49, v137
v_pk_fma_f16 v151, v152, v152, s48
v_and_b32_e64 v139, s49, v139
v_pk_fma_f16 v148, v149, v149, s48
v_pk_mul_f16 v154, v155, v154
v_bfe_u32 v136, v137, 2, 14
v_pk_mul_f16 v151, v152, v151
ds_read_b128 v[232:235], v248 offset:55296
ds_read_u16_d16 v136, v136
v_mfma_f32_32x32x16_bf16 v[120:135], v[236:239], v[100:103], v[120:135]
v_pk_mul_f16 v148, v149, v148
v_bfe_u32 v138, v139, 2, 14
v_exp_f16 v153, v154
v_lshrrev_b32 v137, 18, v137
v_exp_f16 v150, v151
v_lshrrev_b32 v139, 18, v139
ds_read_b128 v[236:239], v248 offset:58368
ds_read_u16_d16 v138, v138
ds_read_u16_d16_hi v137, v137
ds_read_u16_d16_hi v139, v139
v_mfma_f32_32x32x16_bf16 v[120:135], v[224:227], v[104:107], v[120:135]
v_exp_f16 v147, v148
v_and_b32 v141, s49, v141
v_and_b32 v143, s49, v143
v_exp_f16_sdwa v153, v154 dst_sel:WORD_1 dst_unused:UNUSED_PRESERVE src0_sel:WORD_1
v_bfe_u32 v140, v141, 2, 14
v_exp_f16_sdwa v150, v151 dst_sel:WORD_1 dst_unused:UNUSED_PRESERVE src0_sel:WORD_1
s_waitcnt lgkmcnt(6)
ds_read_b128 v[224:227], v248 offset:59392
ds_read_u16_d16 v140, v140
v_mfma_f32_32x32x16_bf16 v[120:135], v[228:231], v[108:111], v[120:135]
v_bfe_u32 v142, v143, 2, 14
v_exp_f16_sdwa v147, v148 dst_sel:WORD_1 dst_unused:UNUSED_PRESERVE src0_sel:WORD_1
v_lshrrev_b32_e64 v141, 18, v141
v_pk_add_f16 v153, v153, 1.0 op_sel_hi:[1,0]
v_lshrrev_b32 v143, 18, v143
v_pk_add_f16 v150, v150, 1.0 op_sel_hi:[1,0]
v_pk_add_f16 v147, v147, 1.0 op_sel_hi:[1,0]
s_waitcnt lgkmcnt(6)
ds_read_b128 v[228:231], v248 offset:62464
ds_read_u16_d16 v142, v142
ds_read_u16_d16_hi v141, v141
ds_read_u16_d16_hi v143, v143
v_mfma_f32_32x32x16_bf16 v[120:135], v[232:235], v[112:115], v[120:135]
v_and_b32 v145, s49, v145
v_rcp_f16 v154, v153
v_bfe_u32 v144, v145, 2, 14
v_rcp_f16_e64 v151, v150
v_lshrrev_b32 v145, 18, v145
s_waitcnt lgkmcnt(6)
ds_read_b128 v[232:235], v248 offset:60416
ds_read_u16_d16 v144, v144
ds_read_u16_d16_hi v145, v145
v_mfma_f32_32x32x16_bf16 v[120:135], v[236:239], v[116:119], v[120:135]
v_rcp_f16 v148, v147
v_or_b32 v176, v136, v137
v_or_b32_e64 v177, v138, v139
v_rcp_f16_sdwa v154, v153 dst_sel:WORD_1 dst_unused:UNUSED_PRESERVE src0_sel:WORD_1
s_waitcnt lgkmcnt(4)
v_or_b32 v178, v140, v141
v_rcp_f16_sdwa v151, v150 dst_sel:WORD_1 dst_unused:UNUSED_PRESERVE src0_sel:WORD_1
s_waitcnt lgkmcnt(3)
v_or_b32 v179, v142, v143
v_rcp_f16_sdwa v148, v147 dst_sel:WORD_1 dst_unused:UNUSED_PRESERVE src0_sel:WORD_1
s_waitcnt lgkmcnt(0)
v_or_b32 v180, v144, v145
v_pk_mul_f16 v181, v155, v154
v_pk_mul_f16 v182, v152, v151
v_pk_mul_f16 v183, v149, v148
s_cmp_eq_u32 s77, 0
s_cbranch_scc1 Lpp50
s_getreg_b32 s43, hwreg(HW_REG_IB_STS, 0, 4)
s_cmp_lg_u32 s43, 0
s_cbranch_scc1 Lpp50
s_call_b64 s[78:79], Lpoll
s_setprio 2
Lpp50:
s_setprio 1
v_cvt_pkrtz_f16_f32 v137, v120, v121
v_cvt_pkrtz_f16_f32 v139, v122, v123
v_cvt_pkrtz_f16_f32 v141, v124, v125
v_cvt_pkrtz_f16_f32 v143, v126, v127
v_cvt_pkrtz_f16_f32 v145, v128, v129
v_cvt_pk_f16_f32 v155, v130, v131
v_cvt_pk_f16_f32 v152, v132, v133
v_cvt_pk_f16_f32 v149, v134, v135
ds_read_b128 v[236:239], v248 offset:63488
v_mfma_f32_32x32x16_bf16 v[120:135], v[224:227], v[96:99], 0
v_pk_fma_f16 v154, v155, v155, s48
v_and_b32_e64 v137, s49, v137
v_pk_fma_f16 v151, v152, v152, s48
v_and_b32_e64 v139, s49, v139
v_pk_fma_f16 v148, v149, v149, s48
v_pk_mul_f16 v154, v155, v154
v_bfe_u32 v136, v137, 2, 14
v_pk_mul_f16 v151, v152, v151
ds_read_b128 v[224:227], v248 offset:61440
ds_read_u16_d16 v136, v136
v_mfma_f32_32x32x16_bf16 v[120:135], v[228:231], v[100:103], v[120:135]
v_pk_mul_f16 v148, v149, v148
v_bfe_u32 v138, v139, 2, 14
v_exp_f16 v153, v154
v_lshrrev_b32 v137, 18, v137
v_exp_f16 v150, v151
v_lshrrev_b32 v139, 18, v139
ds_read_b128 v[228:231], v248 offset:64512
ds_read_u16_d16 v138, v138
ds_read_u16_d16_hi v137, v137
ds_read_u16_d16_hi v139, v139
v_mfma_f32_32x32x16_bf16 v[120:135], v[232:235], v[104:107], v[120:135]
v_exp_f16 v147, v148
v_and_b32 v141, s49, v141
v_and_b32 v143, s49, v143
v_exp_f16_sdwa v153, v154 dst_sel:WORD_1 dst_unused:UNUSED_PRESERVE src0_sel:WORD_1
v_bfe_u32 v140, v141, 2, 14
v_exp_f16_sdwa v150, v151 dst_sel:WORD_1 dst_unused:UNUSED_PRESERVE src0_sel:WORD_1
s_waitcnt lgkmcnt(6)
ds_read_b128 v[232:235], v249
ds_read_u16_d16 v140, v140
v_mfma_f32_32x32x16_bf16 v[120:135], v[236:239], v[108:111], v[120:135]
v_bfe_u32 v142, v143, 2, 14
v_exp_f16_sdwa v147, v148 dst_sel:WORD_1 dst_unused:UNUSED_PRESERVE src0_sel:WORD_1
v_lshrrev_b32_e64 v141, 18, v141
v_pk_add_f16 v153, v153, 1.0 op_sel_hi:[1,0]
v_lshrrev_b32 v143, 18, v143
v_pk_add_f16 v150, v150, 1.0 op_sel_hi:[1,0]
v_pk_add_f16 v147, v147, 1.0 op_sel_hi:[1,0]
s_waitcnt lgkmcnt(6)
ds_read_b128 v[236:239], v249 offset:3072
ds_read_u16_d16 v142, v142
ds_read_u16_d16_hi v141, v141
ds_read_u16_d16_hi v143, v143
v_mfma_f32_32x32x16_bf16 v[120:135], v[224:227], v[112:115], v[120:135]
v_and_b32 v145, s49, v145
v_rcp_f16 v154, v153
v_bfe_u32 v144, v145, 2, 14
s_setprio 0
v_rcp_f16 v151, v150
v_lshrrev_b32 v145, 18, v145
s_waitcnt lgkmcnt(6)
ds_read_b128 v[224:227], v249 offset:1024
ds_read_u16_d16 v144, v144
ds_read_u16_d16_hi v145, v145
v_mfma_f32_32x32x16_bf16 v[120:135], v[228:231], v[116:119], v[120:135]
v_rcp_f16 v148, v147
v_or_b32 v184, v136, v137
v_or_b32_e64 v185, v138, v139
v_rcp_f16_sdwa v154, v153 dst_sel:WORD_1 dst_unused:UNUSED_PRESERVE src0_sel:WORD_1
s_waitcnt lgkmcnt(4)
v_or_b32 v186, v140, v141
v_rcp_f16_sdwa v151, v150 dst_sel:WORD_1 dst_unused:UNUSED_PRESERVE src0_sel:WORD_1
s_waitcnt lgkmcnt(3)
v_or_b32 v187, v142, v143
v_rcp_f16_sdwa v148, v147 dst_sel:WORD_1 dst_unused:UNUSED_PRESERVE src0_sel:WORD_1
s_waitcnt lgkmcnt(0)
v_or_b32_e64 v188, v144, v145
v_pk_mul_f16 v189, v155, v154
v_pk_mul_f16 v190, v152, v151
v_pk_mul_f16 v191, v149, v148
s_cmp_eq_u32 s77, 0
s_cbranch_scc1 Lpp51
s_getreg_b32 s43, hwreg(HW_REG_IB_STS, 0, 4)
s_cmp_lg_u32 s43, 0
s_cbranch_scc1 Lpp51
s_call_b64 s[78:79], Lpoll
s_setprio 0
Lpp51:
v_mov_b32 v253, 16256
Lw2w:
ds_read_b32 v254, v253 offset:4
s_waitcnt lgkmcnt(0)
v_readfirstlane_b32 s43, v254
s_cmp_eq_u32 s76, 0
s_cbranch_scc1 Lw2x
s_sub_u32 s76, s76, 1
s_cmp_lt_u32 s43, 1
s_cbranch_scc0 Lw2x
s_sleep 2
s_branch Lw2w
Lw2x:
s_add_u32 m0, s72, 7168
s_add_u32 s43, s82, 6208
buffer_load_dwordx4 v252, s[16:19], s43 offen lds
s_add_u32 m0, s72, 8192
s_add_u32 s43, s82, 6272
buffer_load_dwordx4 v252, s[16:19], s43 offen lds
s_setprio 2
v_cvt_pkrtz_f16_f32 v137, v120, v121
v_cvt_pkrtz_f16_f32 v139, v122, v123
v_cvt_pkrtz_f16_f32 v141, v124, v125
v_cvt_pkrtz_f16_f32 v143, v126, v127
v_cvt_pkrtz_f16_f32 v145, v128, v129
v_cvt_pk_f16_f32 v155, v130, v131
v_cvt_pk_f16_f32 v152, v132, v133
v_cvt_pk_f16_f32 v149, v134, v135
ds_read_b128 v[228:231], v249 offset:4096
v_mfma_f32_32x32x16_bf16 v[120:135], v[232:235], v[96:99], 0
v_pk_fma_f16 v154, v155, v155, s48
v_and_b32_e64 v137, s49, v137
v_pk_fma_f16 v151, v152, v152, s48
v_and_b32_e64 v139, s49, v139
v_pk_fma_f16 v148, v149, v149, s48
v_pk_mul_f16 v154, v155, v154
v_bfe_u32 v136, v137, 2, 14
v_pk_mul_f16 v151, v152, v151
ds_read_b128 v[232:235], v249 offset:2048
ds_read_u16_d16 v136, v136
v_mfma_f32_32x32x16_bf16 v[120:135], v[236:239], v[100:103], v[120:135]
v_pk_mul_f16 v148, v149, v148
v_bfe_u32 v138, v139, 2, 14
v_exp_f16 v153, v154
v_lshrrev_b32 v137, 18, v137
v_exp_f16 v150, v151
v_lshrrev_b32 v139, 18, v139
ds_read_b128 v[236:239], v249 offset:5120
ds_read_u16_d16 v138, v138
ds_read_u16_d16_hi v137, v137
ds_read_u16_d16_hi v139, v139
v_mfma_f32_32x32x16_bf16 v[120:135], v[224:227], v[104:107], v[120:135]
v_exp_f16 v147, v148
v_and_b32 v141, s49, v141
v_and_b32 v143, s49, v143
v_exp_f16_sdwa v153, v154 dst_sel:WORD_1 dst_unused:UNUSED_PRESERVE src0_sel:WORD_1
v_bfe_u32 v140, v141, 2, 14
v_exp_f16_sdwa v150, v151 dst_sel:WORD_1 dst_unused:UNUSED_PRESERVE src0_sel:WORD_1
s_waitcnt lgkmcnt(6)
ds_read_b128 v[224:227], v249 offset:6144
ds_read_u16_d16 v140, v140
v_mfma_f32_32x32x16_bf16 v[120:135], v[228:231], v[108:111], v[120:135]
v_bfe_u32 v142, v143, 2, 14
v_exp_f16_sdwa v147, v148 dst_sel:WORD_1 dst_unused:UNUSED_PRESERVE src0_sel:WORD_1
v_lshrrev_b32_e64 v141, 18, v141
v_pk_add_f16 v153, v153, 1.0 op_sel_hi:[1,0]
v_lshrrev_b32 v143, 18, v143
v_pk_add_f16 v150, v150, 1.0 op_sel_hi:[1,0]
v_pk_add_f16 v147, v147, 1.0 op_sel_hi:[1,0]
s_waitcnt lgkmcnt(6)
ds_read_b128 v[228:231], v249 offset:9216
ds_read_u16_d16 v142, v142
ds_read_u16_d16_hi v141, v141
ds_read_u16_d16_hi v143, v143
v_mfma_f32_32x32x16_bf16 v[120:135], v[232:235], v[112:115], v[120:135]
v_and_b32 v145, s49, v145
v_rcp_f16 v154, v153
v_bfe_u32 v144, v145, 2, 14
v_rcp_f16_e64 v151, v150
v_lshrrev_b32 v145, 18, v145
s_waitcnt lgkmcnt(6)
ds_read_b128 v[232:235], v249 offset:7168
ds_read_u16_d16 v144, v144
ds_read_u16_d16_hi v145, v145
v_mfma_f32_32x32x16_bf16 v[120:135], v[236:239], v[116:119], v[120:135]
v_rcp_f16 v148, v147
v_or_b32 v192, v136, v137
v_or_b32_e64 v193, v138, v139
v_rcp_f16_sdwa v154, v153 dst_sel:WORD_1 dst_unused:UNUSED_PRESERVE src0_sel:WORD_1
s_waitcnt lgkmcnt(4)
v_or_b32 v194, v140, v141
v_rcp_f16_sdwa v151, v150 dst_sel:WORD_1 dst_unused:UNUSED_PRESERVE src0_sel:WORD_1
s_waitcnt lgkmcnt(3)
v_or_b32 v195, v142, v143
v_rcp_f16_sdwa v148, v147 dst_sel:WORD_1 dst_unused:UNUSED_PRESERVE src0_sel:WORD_1
s_waitcnt lgkmcnt(0)
v_or_b32 v196, v144, v145
v_pk_mul_f16 v197, v155, v154
v_pk_mul_f16 v198, v152, v151
v_pk_mul_f16 v199, v149, v148
s_cmp_eq_u32 s77, 0
s_cbranch_scc1 Lpp52
s_getreg_b32 s43, hwreg(HW_REG_IB_STS, 0, 4)
s_cmp_lg_u32 s43, 0
s_cbranch_scc1 Lpp52
s_call_b64 s[78:79], Lpoll
s_setprio 2
Lpp52:
s_setprio 1
v_cvt_pkrtz_f16_f32 v137, v120, v121
v_cvt_pkrtz_f16_f32 v139, v122, v123
v_cvt_pkrtz_f16_f32 v141, v124, v125
v_cvt_pkrtz_f16_f32 v143, v126, v127
v_cvt_pkrtz_f16_f32 v145, v128, v129
v_cvt_pk_f16_f32 v155, v130, v131
v_cvt_pk_f16_f32 v152, v132, v133
v_cvt_pk_f16_f32 v149, v134, v135
ds_read_b128 v[236:239], v249 offset:10240
v_mfma_f32_32x32x16_bf16 v[120:135], v[224:227], v[96:99], 0
v_pk_fma_f16 v154, v155, v155, s48
v_and_b32_e64 v137, s49, v137
v_pk_fma_f16 v151, v152, v152, s48
v_and_b32_e64 v139, s49, v139
v_pk_fma_f16 v148, v149, v149, s48
v_pk_mul_f16 v154, v155, v154
v_bfe_u32 v136, v137, 2, 14
v_pk_mul_f16 v151, v152, v151
ds_read_b128 v[224:227], v249 offset:8192
ds_read_u16_d16 v136, v136
v_mfma_f32_32x32x16_bf16 v[120:135], v[228:231], v[100:103], v[120:135]
v_pk_mul_f16 v148, v149, v148
v_bfe_u32 v138, v139, 2, 14
v_exp_f16 v153, v154
v_lshrrev_b32 v137, 18, v137
v_exp_f16 v150, v151
v_lshrrev_b32 v139, 18, v139
ds_read_b128 v[228:231], v249 offset:11264
ds_read_u16_d16 v138, v138
ds_read_u16_d16_hi v137, v137
ds_read_u16_d16_hi v139, v139
v_mfma_f32_32x32x16_bf16 v[120:135], v[232:235], v[104:107], v[120:135]
v_exp_f16 v147, v148
v_and_b32 v141, s49, v141
v_and_b32 v143, s49, v143
v_exp_f16_sdwa v153, v154 dst_sel:WORD_1 dst_unused:UNUSED_PRESERVE src0_sel:WORD_1
v_bfe_u32 v140, v141, 2, 14
v_exp_f16_sdwa v150, v151 dst_sel:WORD_1 dst_unused:UNUSED_PRESERVE src0_sel:WORD_1
s_waitcnt lgkmcnt(6)
ds_read_u16_d16 v140, v140
v_mfma_f32_32x32x16_bf16 v[120:135], v[236:239], v[108:111], v[120:135]
v_bfe_u32 v142, v143, 2, 14
v_exp_f16_sdwa v147, v148 dst_sel:WORD_1 dst_unused:UNUSED_PRESERVE src0_sel:WORD_1
v_lshrrev_b32_e64 v141, 18, v141
v_pk_add_f16 v153, v153, 1.0 op_sel_hi:[1,0]
v_lshrrev_b32 v143, 18, v143
v_pk_add_f16 v150, v150, 1.0 op_sel_hi:[1,0]
v_pk_add_f16 v147, v147, 1.0 op_sel_hi:[1,0]
s_waitcnt lgkmcnt(5)
ds_read_u16_d16 v142, v142
ds_read_u16_d16_hi v141, v141
ds_read_u16_d16_hi v143, v143
v_mfma_f32_32x32x16_bf16 v[120:135], v[224:227], v[112:115], v[120:135]
v_and_b32 v145, s49, v145
v_rcp_f16 v154, v153
v_bfe_u32 v144, v145, 2, 14
s_setprio 0
v_rcp_f16 v151, v150
v_lshrrev_b32 v145, 18, v145
s_waitcnt lgkmcnt(4)
ds_read_u16_d16 v144, v144
ds_read_u16_d16_hi v145, v145
v_mfma_f32_32x32x16_bf16 v[120:135], v[228:231], v[116:119], v[120:135]
v_rcp_f16 v148, v147
v_or_b32 v200, v136, v137
v_or_b32_e64 v201, v138, v139
v_rcp_f16_sdwa v154, v153 dst_sel:WORD_1 dst_unused:UNUSED_PRESERVE src0_sel:WORD_1
s_waitcnt lgkmcnt(3)
v_or_b32 v202, v140, v141
v_rcp_f16_sdwa v151, v150 dst_sel:WORD_1 dst_unused:UNUSED_PRESERVE src0_sel:WORD_1
s_waitcnt lgkmcnt(2)
v_or_b32 v203, v142, v143
v_rcp_f16_sdwa v148, v147 dst_sel:WORD_1 dst_unused:UNUSED_PRESERVE src0_sel:WORD_1
s_waitcnt lgkmcnt(0)
v_or_b32 v204, v144, v145
v_pk_mul_f16 v205, v155, v154
v_pk_mul_f16 v206, v152, v151
v_pk_mul_f16 v207, v149, v148
s_cmp_eq_u32 s77, 0
s_cbranch_scc1 Lpp53
s_getreg_b32 s43, hwreg(HW_REG_IB_STS, 0, 4)
s_cmp_lg_u32 s43, 0
s_cbranch_scc1 Lpp53
s_call_b64 s[78:79], Lpoll
s_setprio 0
Lpp53:
s_setprio 2
v_cvt_pkrtz_f16_f32 v137, v120, v121
v_cvt_pkrtz_f16_f32 v139, v122, v123
v_cvt_pkrtz_f16_f32 v141, v124, v125
v_cvt_pkrtz_f16_f32 v143, v126, v127
v_cvt_pkrtz_f16_f32 v145, v128, v129
v_cvt_pk_f16_f32 v155, v130, v131
v_cvt_pk_f16_f32 v152, v132, v133
v_cvt_pk_f16_f32 v149, v134, v135
v_pk_fma_f16 v154, v155, v155, s48
v_and_b32_e64 v137, s49, v137
v_pk_fma_f16 v151, v152, v152, s48
v_and_b32_e64 v139, s49, v139
v_pk_fma_f16 v148, v149, v149, s48
v_pk_mul_f16 v154, v155, v154
v_bfe_u32 v136, v137, 2, 14
v_pk_mul_f16 v151, v152, v151
v_pk_mul_f16 v148, v149, v148
v_bfe_u32 v138, v139, 2, 14
v_exp_f16 v153, v154
v_lshrrev_b32 v137, 18, v137
v_exp_f16 v150, v151
v_lshrrev_b32 v139, 18, v139
v_exp_f16 v147, v148
v_and_b32 v141, s49, v141
v_and_b32_e64 v143, s49, v143
ds_read_u16_d16 v136, v136
ds_read_u16_d16 v138, v138
ds_read_u16_d16_hi v137, v137
ds_read_u16_d16_hi v139, v139
v_exp_f16_sdwa v153, v154 dst_sel:WORD_1 dst_unused:UNUSED_PRESERVE src0_sel:WORD_1
v_bfe_u32 v140, v141, 2, 14
v_exp_f16_sdwa v150, v151 dst_sel:WORD_1 dst_unused:UNUSED_PRESERVE src0_sel:WORD_1
s_setprio 1
v_bfe_u32 v142, v143, 2, 14
v_exp_f16_sdwa v147, v148 dst_sel:WORD_1 dst_unused:UNUSED_PRESERVE src0_sel:WORD_1
v_lshrrev_b32 v141, 18, v141
v_pk_add_f16 v153, v153, 1.0 op_sel_hi:[1,0]
v_lshrrev_b32_e64 v143, 18, v143
v_pk_add_f16 v150, v150, 1.0 op_sel_hi:[1,0]
v_pk_add_f16 v147, v147, 1.0 op_sel_hi:[1,0]
v_and_b32 v145, s49, v145
v_rcp_f16 v154, v153
v_bfe_u32 v144, v145, 2, 14
v_rcp_f16 v151, v150
v_lshrrev_b32 v145, 18, v145
ds_read_u16_d16 v140, v140
ds_read_u16_d16 v142, v142
ds_read_u16_d16_hi v141, v141
ds_read_u16_d16_hi v143, v143
ds_read_u16_d16 v144, v144
ds_read_u16_d16_hi v145, v145
v_rcp_f16 v148, v147
s_waitcnt lgkmcnt(7)
v_or_b32 v232, v136, v137
s_waitcnt lgkmcnt(6)
v_or_b32 v233, v138, v139
v_rcp_f16_sdwa v154, v153 dst_sel:WORD_1 dst_unused:UNUSED_PRESERVE src0_sel:WORD_1
s_waitcnt lgkmcnt(3)
v_or_b32 v234, v140, v141
s_setprio 0
v_rcp_f16_sdwa v151, v150 dst_sel:WORD_1 dst_unused:UNUSED_PRESERVE src0_sel:WORD_1
s_waitcnt lgkmcnt(2)
v_or_b32 v235, v142, v143
v_rcp_f16_sdwa v148, v147 dst_sel:WORD_1 dst_unused:UNUSED_PRESERVE src0_sel:WORD_1
s_waitcnt lgkmcnt(0)
v_or_b32 v236, v144, v145
v_pk_mul_f16 v237, v155, v154
v_pk_mul_f16 v238, v152, v151
v_pk_mul_f16 v239, v149, v148
s_cmp_eq_u32 s77, 0
s_cbranch_scc1 Lpp54
s_getreg_b32 s43, hwreg(HW_REG_IB_STS, 0, 4)
s_cmp_lg_u32 s43, 0
s_cbranch_scc1 Lpp54
s_call_b64 s[78:79], Lpoll
s_setprio 0
Lpp54:
s_setprio 2
v_lshrrev_b32_e64 v225, 5, v251
v_lshl_add_u32 v224, v225, 9, s72
v_lshl_add_u32 v226, v225, 4, s72
v_and_b32 v225, 15, v251
v_lshl_add_u32 v224, v225, 4, v224
v_bfe_u32 v225, v251, 4, 1
v_lshl_add_u32 v224, v225, 3, v224
s_waitcnt vmcnt(0)
ds_read_b64_tr_b16 v[120:121], v224
ds_read_b64_tr_b16 v[122:123], v224 offset:256
ds_read_b64_tr_b16 v[124:125], v224 offset:1024
ds_read_b64_tr_b16 v[126:127], v224 offset:1280
ds_read_b64_tr_b16 v[128:129], v224 offset:2048
ds_read_b64_tr_b16 v[130:131], v224 offset:2304
ds_read_b64_tr_b16 v[132:133], v224 offset:3072
ds_read_b64_tr_b16 v[134:135], v224 offset:3328
ds_read_b64_tr_b16 v[136:137], v224 offset:4096
ds_read_b64_tr_b16 v[138:139], v224 offset:4352
ds_read_b64_tr_b16 v[140:141], v224 offset:5120
ds_read_b64_tr_b16 v[142:143], v224 offset:5376
ds_read_b64_tr_b16 v[144:145], v224 offset:6144
ds_read_b64_tr_b16 v[146:147], v224 offset:6400
ds_read_b64_tr_b16 v[148:149], v224 offset:7168
ds_read_b64_tr_b16 v[150:151], v224 offset:7424
ds_read_b64_tr_b16 v[152:153], v224 offset:8192
ds_read_b64_tr_b16 v[154:155], v224 offset:8448
v_lshrrev_b32 v225, 4, v251
v_and_b32 v227, 15, v251
v_mul_u32_u24 v252, 192, v227
v_lshl_add_u32 v252, v225, 4, v252
v_lshlrev_b32 v254, 5, v225
v_and_b32 v253, 47, v251
v_lshlrev_b32 v253, 4, v253
v_and_b32 v225, 1, v225
v_mul_u32_u24 v227, 3072, v225
v_add_u32_e64 v248, v227, v253
v_add_u32 v249, 65536, v248
v_add_u32 v250, 131072, v248
v_lshl_add_u32 v253, v225, 21, v253
v_mov_b32 v225, 16256
v_mov_b32_e64 v227, 1
v_permlane16_swap_b32 v0, v4
v_permlane16_swap_b32 v1, v5
v_permlane16_swap_b32 v2, v6
v_permlane16_swap_b32 v3, v7
v_permlane16_swap_b32 v8, v12
v_permlane16_swap_b32 v9, v13
v_permlane16_swap_b32 v10, v14
v_permlane16_swap_b32 v11, v15
s_waitcnt lgkmcnt(0)
s_mov_b64 exec, 1
ds_add_u32 v225, v227 offset:8
s_mov_b64 exec, -1
v_lshlrev_b32 v228, 16, v120
v_and_b32 v229, 4294901760, v120
v_cvt_pk_f16_f32 v120, v228, v229
v_lshlrev_b32_e64 v230, 16, v121
v_and_b32 v231, 4294901760, v121
v_cvt_pk_f16_f32 v121, v230, v231
v_lshlrev_b32_e64 v228, 16, v122
v_and_b32 v229, 4294901760, v122
v_cvt_pk_f16_f32 v122, v228, v229
v_lshlrev_b32_e64 v230, 16, v123
v_and_b32 v231, 4294901760, v123
v_cvt_pk_f16_f32 v123, v230, v231
v_lshlrev_b32_e64 v228, 16, v124
v_and_b32 v229, 4294901760, v124
v_cvt_pk_f16_f32 v124, v228, v229
v_lshlrev_b32_e64 v230, 16, v125
v_and_b32 v231, 4294901760, v125
v_cvt_pk_f16_f32 v125, v230, v231
v_lshlrev_b32_e64 v228, 16, v126
v_and_b32 v229, 4294901760, v126
v_cvt_pk_f16_f32 v126, v228, v229
v_lshlrev_b32_e64 v230, 16, v127
v_and_b32 v231, 4294901760, v127
v_cvt_pk_f16_f32 v127, v230, v231
v_lshlrev_b32_e64 v228, 16, v128
v_and_b32 v229, 4294901760, v128
v_cvt_pk_f16_f32 v128, v228, v229
v_lshlrev_b32_e64 v230, 16, v129
v_and_b32 v231, 4294901760, v129
v_cvt_pk_f16_f32 v129, v230, v231
v_lshlrev_b32_e64 v228, 16, v130
v_and_b32 v229, 4294901760, v130
v_cvt_pk_f16_f32 v130, v228, v229
v_lshlrev_b32_e64 v230, 16, v131
v_and_b32 v231, 4294901760, v131
v_cvt_pk_f16_f32 v131, v230, v231
s_cmp_eq_u32 s77, 0
s_cbranch_scc1 Lpp911
s_getreg_b32 s43, hwreg(HW_REG_IB_STS, 0, 4)
s_cmp_lg_u32 s43, 0
s_cbranch_scc1 Lpp911
s_call_b64 s[78:79], Lpoll
s_setprio 2
Lpp911:
v_lshlrev_b32 v228, 16, v132
v_and_b32 v229, 4294901760, v132
v_cvt_pk_f16_f32 v132, v228, v229
v_lshlrev_b32_e64 v230, 16, v133
v_and_b32 v231, 4294901760, v133
v_cvt_pk_f16_f32 v133, v230, v231
v_lshlrev_b32_e64 v228, 16, v134
v_and_b32 v229, 4294901760, v134
v_cvt_pk_f16_f32 v134, v228, v229
v_lshlrev_b32_e64 v230, 16, v135
v_and_b32 v231, 4294901760, v135
v_cvt_pk_f16_f32 v135, v230, v231
v_lshlrev_b32_e64 v228, 16, v136
v_and_b32 v229, 4294901760, v136
v_cvt_pk_f16_f32 v136, v228, v229
v_lshlrev_b32_e64 v230, 16, v137
v_and_b32 v231, 4294901760, v137
v_cvt_pk_f16_f32 v137, v230, v231
v_lshlrev_b32_e64 v228, 16, v138
v_and_b32 v229, 4294901760, v138
v_cvt_pk_f16_f32 v138, v228, v229
v_lshlrev_b32_e64 v230, 16, v139
v_and_b32 v231, 4294901760, v139
v_cvt_pk_f16_f32 v139, v230, v231
v_lshlrev_b32_e64 v228, 16, v140
v_and_b32 v229, 4294901760, v140
v_cvt_pk_f16_f32 v140, v228, v229
v_lshlrev_b32_e64 v230, 16, v141
v_and_b32 v231, 4294901760, v141
v_cvt_pk_f16_f32 v141, v230, v231
v_lshlrev_b32_e64 v228, 16, v142
v_and_b32 v229, 4294901760, v142
v_cvt_pk_f16_f32 v142, v228, v229
v_lshlrev_b32_e64 v230, 16, v143
v_and_b32 v231, 4294901760, v143
v_cvt_pk_f16_f32 v143, v230, v231
s_cmp_eq_u32 s77, 0
s_cbranch_scc1 Lpp923
s_getreg_b32 s43, hwreg(HW_REG_IB_STS, 0, 4)
s_cmp_lg_u32 s43, 0
s_cbranch_scc1 Lpp923
s_call_b64 s[78:79], Lpoll
s_setprio 2
Lpp923:
v_lshlrev_b32 v228, 16, v144
v_and_b32 v229, 4294901760, v144
v_cvt_pk_f16_f32 v144, v228, v229
v_lshlrev_b32_e64 v230, 16, v145
v_and_b32 v231, 4294901760, v145
v_cvt_pk_f16_f32 v145, v230, v231
v_lshlrev_b32_e64 v228, 16, v146
v_and_b32 v229, 4294901760, v146
v_cvt_pk_f16_f32 v146, v228, v229
v_lshlrev_b32_e64 v230, 16, v147
v_and_b32 v231, 4294901760, v147
v_cvt_pk_f16_f32 v147, v230, v231
v_lshlrev_b32_e64 v228, 16, v148
v_and_b32 v229, 4294901760, v148
v_cvt_pk_f16_f32 v148, v228, v229
v_lshlrev_b32_e64 v230, 16, v149
v_and_b32 v231, 4294901760, v149
v_cvt_pk_f16_f32 v149, v230, v231
v_lshlrev_b32_e64 v228, 16, v150
v_and_b32 v229, 4294901760, v150
v_cvt_pk_f16_f32 v150, v228, v229
v_lshlrev_b32_e64 v230, 16, v151
v_and_b32 v231, 4294901760, v151
v_cvt_pk_f16_f32 v151, v230, v231
v_lshlrev_b32_e64 v228, 16, v152
v_and_b32 v229, 4294901760, v152
v_cvt_pk_f16_f32 v152, v228, v229
v_lshlrev_b32_e64 v230, 16, v153
v_and_b32 v231, 4294901760, v153
v_cvt_pk_f16_f32 v153, v230, v231
v_lshlrev_b32_e64 v228, 16, v154
v_and_b32 v229, 4294901760, v154
v_cvt_pk_f16_f32 v154, v228, v229
v_lshlrev_b32_e64 v230, 16, v155
v_and_b32 v231, 4294901760, v155
v_cvt_pk_f16_f32 v155, v230, v231
s_cmp_eq_u32 s77, 0
s_cbranch_scc1 Lpp935
s_getreg_b32 s43, hwreg(HW_REG_IB_STS, 0, 4)
s_cmp_lg_u32 s43, 0
s_cbranch_scc1 Lpp935
s_call_b64 s[78:79], Lpoll
s_setprio 2
Lpp935:
v_lshl_add_u32 v224, v251, 4, s72
Lspin:
s_cmp_eq_u32 s77, 0
s_cbranch_scc1 Lspinx
s_cmp_eq_u32 s76, 0
s_cbranch_scc1 Lspinx
s_sub_u32 s76, s76, 1
s_call_b64 s[78:79], Lpoll
s_branch Lspin
Lspinx:
s_cmp_lg_u32 s40, 0
s_cbranch_scc1 Lnofin
v_add_u32_e64 v162, 0, v251
v_mul_u32_u24 v165, 2731, v162
v_lshrrev_b32_e64 v165, 16, v165
v_mul_u32_u24 v165, 9120, v165
v_lshl_add_u32 v162, v162, 2, v165
v_add_u32 v162, 90112, v162
v_add_u32_e64 v163, 64, v251
v_mul_u32_u24 v165, 2731, v163
v_lshrrev_b32_e64 v165, 16, v165
v_mul_u32_u24 v165, 9120, v165
v_lshl_add_u32 v163, v163, 2, v165
v_add_u32 v163, 90112, v163
v_add_u32 v164, 128, v251
v_mul_u32_u24 v165, 2731, v164
v_lshrrev_b32_e64 v165, 16, v165
v_mul_u32_u24 v165, 9120, v165
v_lshl_add_u32 v164, v164, 2, v165
v_add_u32 v164, 90112, v164
v_mov_b32 v165, 16256
Lrrw:
ds_read_b32 v166, v165 offset:8
s_waitcnt lgkmcnt(0)
v_readfirstlane_b32 s43, v166
s_cmp_eq_u32 s76, 0
s_cbranch_scc1 Lrrx
s_sub_u32 s76, s76, 1
s_cmp_lt_u32 s43, 8
s_cbranch_scc0 Lrrx
s_sleep 2
s_branch Lrrw
Lrrx:
ds_write_b32 v162, v244
ds_write_b32 v163, v245
ds_write_b32 v164, v246
Lnofin:
s_waitcnt lgkmcnt(0)
s_barrier
ds_read_b128 v[156:159], v226
ds_read_b128 v[160:163], v226 offset:32
ds_read_b128 v[164:167], v226 offset:64
s_waitcnt lgkmcnt(0)
v_pk_mul_f16 v120, v120, v156
v_pk_mul_f16 v121, v121, v157
v_pk_mul_f16 v122, v122, v158
v_pk_mul_f16 v123, v123, v159
ds_write_b128 v224, v[120:123]
v_pk_mul_f16 v124, v124, v156
v_pk_mul_f16 v125, v125, v157
v_pk_mul_f16 v126, v126, v158
v_pk_mul_f16 v127, v127, v159
ds_write_b128 v224, v[124:127] offset:1024
v_pk_mul_f16 v128, v128, v156
v_pk_mul_f16 v129, v129, v157
v_pk_mul_f16 v130, v130, v158
v_pk_mul_f16 v131, v131, v159
ds_write_b128 v224, v[128:131] offset:2048
v_pk_mul_f16 v132, v132, v160
v_pk_mul_f16 v133, v133, v161
v_pk_mul_f16 v134, v134, v162
v_pk_mul_f16 v135, v135, v163
ds_write_b128 v224, v[132:135] offset:3072
v_pk_mul_f16 v136, v136, v160
v_pk_mul_f16 v137, v137, v161
v_pk_mul_f16 v138, v138, v162
v_pk_mul_f16 v139, v139, v163
ds_write_b128 v224, v[136:139] offset:4096
v_pk_mul_f16 v140, v140, v160
v_pk_mul_f16 v141, v141, v161
v_pk_mul_f16 v142, v142, v162
v_pk_mul_f16 v143, v143, v163
ds_write_b128 v224, v[140:143] offset:5120
v_pk_mul_f16 v144, v144, v164
v_pk_mul_f16 v145, v145, v165
v_pk_mul_f16 v146, v146, v166
v_pk_mul_f16 v147, v147, v167
ds_write_b128 v224, v[144:147] offset:6144
v_pk_mul_f16 v148, v148, v164
v_pk_mul_f16 v149, v149, v165
v_pk_mul_f16 v150, v150, v166
v_pk_mul_f16 v151, v151, v167
ds_write_b128 v224, v[148:151] offset:7168
v_pk_mul_f16 v152, v152, v164
v_pk_mul_f16 v153, v153, v165
v_pk_mul_f16 v154, v154, v166
v_pk_mul_f16 v155, v155, v167
ds_write_b128 v224, v[152:155] offset:8192
s_waitcnt lgkmcnt(0)
s_barrier
s_setprio 3
ds_read_b128 v[224:227], v249 offset:24576
ds_read_b128 v[228:231], v254 offset:7936
ds_read_b128 v[240:243], v249 offset:24832
ds_read_b128 v[244:247], v254 offset:7952
s_waitcnt lgkmcnt(2)
v_mfma_f32_16x16x32_f16 v[120:123], v[224:227], v[0:3], v[228:231]
v_mfma_f32_16x16x32_f16 v[128:131], v[224:227], v[4:7], v[228:231]
v_permlane16_swap_b32 v16, v20
s_waitcnt lgkmcnt(0)
v_mfma_f32_16x16x32_f16 v[124:127], v[240:243], v[0:3], v[244:247]
ds_read_b128 v[224:227], v249 offset:25600
ds_read_b128 v[228:231], v254 offset:8064
v_mfma_f32_16x16x32_f16 v[132:135], v[240:243], v[4:7], v[244:247]
v_permlane16_swap_b32 v17, v21
s_waitcnt lgkmcnt(0)
v_mfma_f32_16x16x32_f16 v[136:139], v[224:227], v[0:3], v[228:231]
ds_read_b128 v[240:243], v249 offset:25856
ds_read_b128 v[244:247], v254 offset:8080
v_mfma_f32_16x16x32_f16 v[144:147], v[224:227], v[4:7], v[228:231]
v_permlane16_swap_b32 v18, v22
s_waitcnt lgkmcnt(0)
v_mfma_f32_16x16x32_f16 v[140:143], v[240:243], v[0:3], v[244:247]
ds_read_b128 v[224:227], v249 offset:26624
ds_read_b128 v[228:231], v254 offset:16128
v_mfma_f32_16x16x32_f16 v[148:151], v[240:243], v[4:7], v[244:247]
v_permlane16_swap_b32 v19, v23
s_waitcnt lgkmcnt(0)
v_mfma_f32_16x16x32_f16 v[152:155], v[224:227], v[0:3], v[228:231]
ds_read_b128 v[240:243], v249 offset:26880
ds_read_b128 v[244:247], v254 offset:16144
v_mfma_f32_16x16x32_f16 v[160:163], v[224:227], v[4:7], v[228:231]
v_permlane16_swap_b32 v24, v28
s_waitcnt lgkmcnt(0)
v_mfma_f32_16x16x32_f16 v[156:159], v[240:243], v[0:3], v[244:247]
ds_read_b128 v[224:227], v249 offset:30720
ds_read_b128 v[228:231], v249 offset:30976
v_mfma_f32_16x16x32_f16 v[164:167], v[240:243], v[4:7], v[244:247]
v_permlane16_swap_b32 v25, v29
s_waitcnt lgkmcnt(1)
v_mfma_f32_16x16x32_f16 v[120:123], v[224:227], v[8:11], v[120:123]
ds_read_b128 v[240:243], v249 offset:31744
ds_read_b128 v[244:247], v249 offset:32000
v_mfma_f32_16x16x32_f16 v[128:131], v[224:227], v[12:15], v[128:131]
v_permlane16_swap_b32 v26, v30
s_waitcnt lgkmcnt(2)
v_mfma_f32_16x16x32_f16 v[124:127], v[228:231], v[8:11], v[124:127]
ds_read_b128 v[224:227], v249 offset:32768
v_mfma_f32_16x16x32_f16 v[132:135], v[228:231], v[12:15], v[132:135]
v_permlane16_swap_b32 v27, v31
s_waitcnt lgkmcnt(2)
v_mfma_f32_16x16x32_f16 v[136:139], v[240:243], v[8:11], v[136:139]
ds_read_b128 v[228:231], v249 offset:33024
v_mfma_f32_16x16x32_f16 v[144:147], v[240:243], v[12:15], v[144:147]
v_permlane16_swap_b32 v96, v100
s_waitcnt lgkmcnt(2)
v_mfma_f32_16x16x32_f16 v[140:143], v[244:247], v[8:11], v[140:143]
ds_read_b128 v[240:243], v249 offset:36864
v_mfma_f32_16x16x32_f16 v[148:151], v[244:247], v[12:15], v[148:151]
v_permlane16_swap_b32 v97, v101
s_waitcnt lgkmcnt(2)
v_mfma_f32_16x16x32_f16 v[152:155], v[224:227], v[8:11], v[152:155]
ds_read_b128 v[244:247], v249 offset:37120
v_mfma_f32_16x16x32_f16 v[160:163], v[224:227], v[12:15], v[160:163]
v_permlane16_swap_b32 v98, v102
s_waitcnt lgkmcnt(2)
v_mfma_f32_16x16x32_f16 v[156:159], v[228:231], v[8:11], v[156:159]
ds_read_b128 v[224:227], v249 offset:37888
v_mfma_f32_16x16x32_f16 v[164:167], v[228:231], v[12:15], v[164:167]
v_permlane16_swap_b32 v99, v103
s_waitcnt lgkmcnt(2)
v_mfma_f32_16x16x32_f16 v[120:123], v[240:243], v[16:19], v[120:123]
buffer_load_dwordx4 v[12:15], v252, s[4:7], s71 offen
ds_read_b128 v[228:231], v249 offset:38144
v_mfma_f32_16x16x32_f16 v[128:131], v[240:243], v[20:23], v[128:131]
v_permlane16_swap_b32 v32, v36
s_waitcnt lgkmcnt(2)
v_mfma_f32_16x16x32_f16 v[124:127], v[244:247], v[16:19], v[124:127]
ds_read_b128 v[240:243], v249 offset:38912
v_mfma_f32_16x16x32_f16 v[132:135], v[244:247], v[20:23], v[132:135]
v_permlane16_swap_b32 v33, v37
s_waitcnt lgkmcnt(2)
v_mfma_f32_16x16x32_f16 v[136:139], v[224:227], v[16:19], v[136:139]
ds_read_b128 v[244:247], v249 offset:39168
v_mfma_f32_16x16x32_f16 v[144:147], v[224:227], v[20:23], v[144:147]
v_permlane16_swap_b32 v34, v38
s_waitcnt lgkmcnt(2)
v_mfma_f32_16x16x32_f16 v[140:143], v[228:231], v[16:19], v[140:143]
buffer_load_dwordx4 v[8:11], v252, s[4:7], s71 offen offset:64
ds_read_b128 v[224:227], v249 offset:43008
v_mfma_f32_16x16x32_f16 v[148:151], v[228:231], v[20:23], v[148:151]
v_permlane16_swap_b32 v35, v39
s_waitcnt lgkmcnt(2)
v_mfma_f32_16x16x32_f16 v[152:155], v[240:243], v[16:19], v[152:155]
ds_read_b128 v[228:231], v249 offset:43264
v_mfma_f32_16x16x32_f16 v[160:163], v[240:243], v[20:23], v[160:163]
v_permlane16_swap_b32 v40, v44
s_waitcnt lgkmcnt(2)
v_mfma_f32_16x16x32_f16 v[156:159], v[244:247], v[16:19], v[156:159]
ds_read_b128 v[240:243], v249 offset:44032
v_mfma_f32_16x16x32_f16 v[164:167], v[244:247], v[20:23], v[164:167]
v_permlane16_swap_b32 v41, v45
s_waitcnt lgkmcnt(2)
v_mfma_f32_16x16x32_f16 v[120:123], v[224:227], v[24:27], v[120:123]
buffer_load_dwordx4 v[4:7], v252, s[4:7], s71 offen offset:128
ds_read_b128 v[244:247], v249 offset:44288
v_mfma_f32_16x16x32_f16 v[128:131], v[224:227], v[28:31], v[128:131]
v_permlane16_swap_b32 v42, v46
s_waitcnt lgkmcnt(2)
v_mfma_f32_16x16x32_f16 v[124:127], v[228:231], v[24:27], v[124:127]
ds_read_b128 v[224:227], v249 offset:45056
v_mfma_f32_16x16x32_f16 v[132:135], v[228:231], v[28:31], v[132:135]
v_permlane16_swap_b32 v43, v47
s_waitcnt lgkmcnt(2)
v_mfma_f32_16x16x32_f16 v[136:139], v[240:243], v[24:27], v[136:139]
ds_read_b128 v[228:231], v249 offset:45312
v_mfma_f32_16x16x32_f16 v[144:147], v[240:243], v[28:31], v[144:147]
v_permlane16_swap_b32 v104, v108
s_waitcnt lgkmcnt(2)
v_mfma_f32_16x16x32_f16 v[140:143], v[244:247], v[24:27], v[140:143]
s_add_u32 s46, s71, 98304
buffer_load_dwordx4 v[0:3], v252, s[4:7], s46 offen
ds_read_b128 v[240:243], v249 offset:49152
v_mfma_f32_16x16x32_f16 v[148:151], v[244:247], v[28:31], v[148:151]
v_permlane16_swap_b32 v105, v109
s_waitcnt lgkmcnt(2)
v_mfma_f32_16x16x32_f16 v[152:155], v[224:227], v[24:27], v[152:155]
ds_read_b128 v[244:247], v249 offset:49408
v_mfma_f32_16x16x32_f16 v[160:163], v[224:227], v[28:31], v[160:163]
v_permlane16_swap_b32 v106, v110
s_waitcnt lgkmcnt(2)
v_mfma_f32_16x16x32_f16 v[156:159], v[228:231], v[24:27], v[156:159]
ds_read_b128 v[224:227], v249 offset:50176
v_mfma_f32_16x16x32_f16 v[164:167], v[228:231], v[28:31], v[164:167]
v_permlane16_swap_b32 v107, v111
s_waitcnt lgkmcnt(2)
v_mfma_f32_16x16x32_f16 v[120:123], v[240:243], v[32:35], v[120:123]
buffer_load_dwordx4 v[24:27], v253, s[32:35], s80 offen nt
ds_read_b128 v[228:231], v249 offset:50432
v_mfma_f32_16x16x32_f16 v[128:131], v[240:243], v[36:39], v[128:131]
v_permlane16_swap_b32 v48, v52
s_waitcnt lgkmcnt(2)
v_mfma_f32_16x16x32_f16 v[124:127], v[244:247], v[32:35], v[124:127]
ds_read_b128 v[240:243], v249 offset:51200
v_mfma_f32_16x16x32_f16 v[132:135], v[244:247], v[36:39], v[132:135]
v_permlane16_swap_b32 v49, v53
s_waitcnt lgkmcnt(2)
v_mfma_f32_16x16x32_f16 v[136:139], v[224:227], v[32:35], v[136:139]
ds_read_b128 v[244:247], v249 offset:51456
v_permlane16_swap_b32 v50, v54
v_mfma_f32_16x16x32_f16 v[144:147], v[224:227], v[36:39], v[144:147]
s_waitcnt lgkmcnt(2)
v_mfma_f32_16x16x32_f16 v[140:143], v[228:231], v[32:35], v[140:143]
ds_read_b128 v[224:227], v249 offset:55296
v_permlane16_swap_b32 v51, v55
v_mfma_f32_16x16x32_f16 v[148:151], v[228:231], v[36:39], v[148:151]
v_permlane16_swap_b32 v56, v60
s_waitcnt lgkmcnt(2)
v_mfma_f32_16x16x32_f16 v[152:155], v[240:243], v[32:35], v[152:155]
ds_read_b128 v[228:231], v249 offset:55552
v_mfma_f32_16x16x32_f16 v[160:163], v[240:243], v[36:39], v[160:163]
v_permlane16_swap_b32 v57, v61
s_waitcnt lgkmcnt(2)
v_mfma_f32_16x16x32_f16 v[156:159], v[244:247], v[32:35], v[156:159]
ds_read_b128 v[240:243], v249 offset:56320
v_permlane16_swap_b32 v58, v62
v_mfma_f32_16x16x32_f16 v[164:167], v[244:247], v[36:39], v[164:167]
s_waitcnt lgkmcnt(2)
v_mfma_f32_16x16x32_f16 v[120:123], v[224:227], v[40:43], v[120:123]
buffer_load_dwordx4 v[28:31], v253, s[32:35], s80 offen offset:256 nt
ds_read_b128 v[244:247], v249 offset:56576
v_permlane16_swap_b32 v59, v63
v_mfma_f32_16x16x32_f16 v[128:131], v[224:227], v[44:47], v[128:131]
v_and_b32_e64 v16, 1, v251
v_lshlrev_b32 v16, 4, v16
s_waitcnt lgkmcnt(2)
v_mfma_f32_16x16x32_f16 v[124:127], v[228:231], v[40:43], v[124:127]
ds_read_b128 v[224:227], v249 offset:57344
v_mov_b32 v17, 16256
v_mfma_f32_16x16x32_f16 v[132:135], v[228:231], v[44:47], v[132:135]
v_lshlrev_b32 v16, v16, v17
s_waitcnt lgkmcnt(2)
v_mfma_f32_16x16x32_f16 v[136:139], v[240:243], v[40:43], v[136:139]
ds_read_b128 v[228:231], v249 offset:57600
v_lshrrev_b32 v17, 2, v251
v_mfma_f32_16x16x32_f16 v[144:147], v[240:243], v[44:47], v[144:147]
v_xor_b32 v17, v17, v251
v_and_b32 v17, 12, v17
s_waitcnt lgkmcnt(2)
v_mfma_f32_16x16x32_f16 v[140:143], v[244:247], v[40:43], v[140:143]
ds_read_b128 v[240:243], v249 offset:61440
v_and_b32_e64 v20, 2, v251
v_mfma_f32_16x16x32_f16 v[148:151], v[244:247], v[44:47], v[148:151]
v_or_b32 v17, v17, v20
s_waitcnt lgkmcnt(2)
v_mfma_f32_16x16x32_f16 v[152:155], v[224:227], v[40:43], v[152:155]
ds_read_b128 v[244:247], v249 offset:61696
v_cmp_eq_u32 vcc, 0, v17
s_nop 1
v_cndmask_b32 v18, 0, v16, vcc
v_cmp_eq_u32 vcc, 2, v17
s_nop 1
v_cndmask_b32 v19, 0, v16, vcc
v_mfma_f32_16x16x32_f16 v[160:163], v[224:227], v[44:47], v[160:163]
v_mov_b32 v16, 0
s_waitcnt lgkmcnt(2)
v_mfma_f32_16x16x32_f16 v[156:159], v[228:231], v[40:43], v[156:159]
ds_read_b128 v[224:227], v249 offset:62464
v_mov_b32_e64 v17, 0
v_mfma_f32_16x16x32_f16 v[164:167], v[228:231], v[44:47], v[164:167]
v_mov_b32 v20, 0
v_mov_b32 v21, 0
s_waitcnt lgkmcnt(2)
v_mfma_f32_16x16x32_f16 v[120:123], v[240:243], v[48:51], v[120:123]
s_add_u32 s46, s80, 4194304
buffer_load_dwordx4 v[32:35], v253, s[32:35], s46 offen nt
ds_read_b128 v[228:231], v249 offset:62720
v_mfma_f32_16x16x32_f16 v[128:131], v[240:243], v[52:55], v[128:131]
s_waitcnt lgkmcnt(2)
v_mfma_f32_16x16x32_f16 v[124:127], v[244:247], v[48:51], v[124:127]
ds_read_b128 v[240:243], v249 offset:63488
v_permlane16_swap_b32 v64, v68
v_mfma_f32_16x16x32_f16 v[132:135], v[244:247], v[52:55], v[132:135]
s_waitcnt lgkmcnt(2)
v_mfma_f32_16x16x32_f16 v[136:139], v[224:227], v[48:51], v[136:139]
ds_read_b128 v[244:247], v249 offset:63744
v_permlane16_swap_b32 v65, v69
v_mfma_f32_16x16x32_f16 v[144:147], v[224:227], v[52:55], v[144:147]
s_waitcnt lgkmcnt(2)
v_mfma_f32_16x16x32_f16 v[140:143], v[228:231], v[48:51], v[140:143]
ds_read_b128 v[224:227], v250 offset:2048
v_permlane16_swap_b32 v66, v70
v_mfma_f32_16x16x32_f16 v[148:151], v[228:231], v[52:55], v[148:151]
s_waitcnt lgkmcnt(2)
v_mfma_f32_16x16x32_f16 v[152:155], v[240:243], v[48:51], v[152:155]
ds_read_b128 v[228:231], v250 offset:2304
v_mfma_f32_16x16x32_f16 v[160:163], v[240:243], v[52:55], v[160:163]
v_permlane16_swap_b32 v67, v71
s_waitcnt lgkmcnt(2)
v_mfma_f32_16x16x32_f16 v[156:159], v[244:247], v[48:51], v[156:159]
ds_read_b128 v[240:243], v250 offset:3072
v_mfma_f32_16x16x32_f16 v[164:167], v[244:247], v[52:55], v[164:167]
v_permlane16_swap_b32 v72, v76
s_waitcnt lgkmcnt(2)
v_mfma_f32_16x16x32_f16 v[120:123], v[224:227], v[56:59], v[120:123]
ds_read_b128 v[244:247], v250 offset:3328
v_mfma_f32_16x16x32_f16 v[128:131], v[224:227], v[60:63], v[128:131]
v_permlane16_swap_b32 v73, v77
s_waitcnt lgkmcnt(2)
v_mfma_f32_16x16x32_f16 v[124:127], v[228:231], v[56:59], v[124:127]
s_add_u32 s46, s80, 4194304
buffer_load_dwordx4 v[36:39], v253, s[32:35], s46 offen offset:256 nt
ds_read_b128 v[224:227], v250 offset:4096
v_mfma_f32_16x16x32_f16 v[132:135], v[228:231], v[60:63], v[132:135]
s_waitcnt lgkmcnt(2)
v_mfma_f32_16x16x32_f16 v[136:139], v[240:243], v[56:59], v[136:139]
ds_read_b128 v[228:231], v250 offset:4352
v_permlane16_swap_b32 v74, v78
v_mfma_f32_16x16x32_f16 v[144:147], v[240:243], v[60:63], v[144:147]
s_waitcnt lgkmcnt(2)
v_mfma_f32_16x16x32_f16 v[140:143], v[244:247], v[56:59], v[140:143]
ds_read_b128 v[240:243], v250 offset:8192
v_permlane16_swap_b32 v75, v79
v_mfma_f32_16x16x32_f16 v[148:151], v[244:247], v[60:63], v[148:151]
s_waitcnt lgkmcnt(2)
v_mfma_f32_16x16x32_f16 v[152:155], v[224:227], v[56:59], v[152:155]
ds_read_b128 v[244:247], v250 offset:8448
v_permlane16_swap_b32 v192, v196
v_mfma_f32_16x16x32_f16 v[160:163], v[224:227], v[60:63], v[160:163]
s_waitcnt lgkmcnt(2)
v_mfma_f32_16x16x32_f16 v[156:159], v[228:231], v[56:59], v[156:159]
ds_read_b128 v[224:227], v250 offset:9216
v_mfma_f32_16x16x32_f16 v[164:167], v[228:231], v[60:63], v[164:167]
v_permlane16_swap_b32 v193, v197
s_waitcnt vmcnt(7)
v_mfma_f32_16x16x32_bf16 v[120:123], v[18:21], v[12:15], v[120:123]
ds_read_b128 v[228:231], v250 offset:9472
v_mfma_f32_16x16x32_bf16 v[124:127], v[16:19], v[12:15], v[124:127]
v_permlane16_swap_b32 v194, v198
s_waitcnt vmcnt(6)
v_mfma_f32_16x16x32_bf16 v[136:139], v[18:21], v[8:11], v[136:139]
v_mfma_f32_16x16x32_bf16 v[140:143], v[16:19], v[8:11], v[140:143]
v_permlane16_swap_b32 v195, v199
s_waitcnt lgkmcnt(3)
v_mfma_f32_16x16x32_f16 v[120:123], v[240:243], v[64:67], v[120:123]
s_add_u32 s46, s80, 8388608
buffer_load_dwordx4 v[40:43], v253, s[32:35], s46 offen nt
v_mfma_f32_16x16x32_f16 v[128:131], v[240:243], v[68:71], v[128:131]
s_waitcnt lgkmcnt(2)
v_mfma_f32_16x16x32_f16 v[124:127], v[244:247], v[64:67], v[124:127]
ds_read_b128 v[240:243], v250 offset:10240
v_permlane16_swap_b32 v80, v84
v_mfma_f32_16x16x32_f16 v[132:135], v[244:247], v[68:71], v[132:135]
s_waitcnt lgkmcnt(2)
v_mfma_f32_16x16x32_f16 v[136:139], v[224:227], v[64:67], v[136:139]
ds_read_b128 v[244:247], v250 offset:10496
v_permlane16_swap_b32 v81, v85
v_mfma_f32_16x16x32_f16 v[144:147], v[224:227], v[68:71], v[144:147]
s_waitcnt lgkmcnt(2)
v_mfma_f32_16x16x32_f16 v[140:143], v[228:231], v[64:67], v[140:143]
ds_read_b128 v[224:227], v250 offset:14336
v_permlane16_swap_b32 v82, v86
v_mfma_f32_16x16x32_f16 v[148:151], v[228:231], v[68:71], v[148:151]
s_waitcnt lgkmcnt(2)
v_mfma_f32_16x16x32_f16 v[152:155], v[240:243], v[64:67], v[152:155]
s_add_u32 s46, s80, 8388608
buffer_load_dwordx4 v[44:47], v253, s[32:35], s46 offen offset:256 nt
ds_read_b128 v[228:231], v250 offset:14592
v_mfma_f32_16x16x32_f16 v[160:163], v[240:243], v[68:71], v[160:163]
v_permlane16_swap_b32 v83, v87
s_waitcnt lgkmcnt(2)
v_mfma_f32_16x16x32_f16 v[156:159], v[244:247], v[64:67], v[156:159]
ds_read_b128 v[240:243], v250 offset:15360
v_mfma_f32_16x16x32_f16 v[164:167], v[244:247], v[68:71], v[164:167]
v_permlane16_swap_b32 v88, v92
s_waitcnt lgkmcnt(2)
v_mfma_f32_16x16x32_f16 v[120:123], v[224:227], v[72:75], v[120:123]
ds_read_b128 v[244:247], v250 offset:15616
v_mfma_f32_16x16x32_f16 v[128:131], v[224:227], v[76:79], v[128:131]
v_permlane16_swap_b32 v89, v93
s_waitcnt lgkmcnt(2)
v_mfma_f32_16x16x32_f16 v[124:127], v[228:231], v[72:75], v[124:127]
s_add_u32 s46, s71, 98304
buffer_load_dwordx4 v[8:11], v252, s[4:7], s46 offen offset:64
ds_read_b128 v[224:227], v250 offset:16384
v_mfma_f32_16x16x32_f16 v[132:135], v[228:231], v[76:79], v[132:135]
s_waitcnt lgkmcnt(2)
v_mfma_f32_16x16x32_f16 v[136:139], v[240:243], v[72:75], v[136:139]
ds_read_b128 v[228:231], v250 offset:16640
v_permlane16_swap_b32 v90, v94
v_mfma_f32_16x16x32_f16 v[144:147], v[240:243], v[76:79], v[144:147]
s_waitcnt lgkmcnt(2)
v_mfma_f32_16x16x32_f16 v[140:143], v[244:247], v[72:75], v[140:143]
ds_read_b128 v[240:243], v250 offset:20480
v_permlane16_swap_b32 v91, v95
v_mfma_f32_16x16x32_f16 v[148:151], v[244:247], v[76:79], v[148:151]
s_waitcnt lgkmcnt(2)
v_mfma_f32_16x16x32_f16 v[152:155], v[224:227], v[72:75], v[152:155]
ds_read_b128 v[244:247], v250 offset:20736
v_permlane16_swap_b32 v184, v188
v_mfma_f32_16x16x32_f16 v[160:163], v[224:227], v[76:79], v[160:163]
s_waitcnt lgkmcnt(2)
v_mfma_f32_16x16x32_f16 v[156:159], v[228:231], v[72:75], v[156:159]
s_add_u32 s46, s71, 98304
buffer_load_dwordx4 v[12:15], v252, s[4:7], s46 offen offset:128
ds_read_b128 v[224:227], v250 offset:21504
v_mfma_f32_16x16x32_f16 v[164:167], v[228:231], v[76:79], v[164:167]
v_permlane16_swap_b32 v185, v189
s_waitcnt vmcnt(9)
v_mfma_f32_16x16x32_bf16 v[152:155], v[18:21], v[4:7], v[152:155]
ds_read_b128 v[228:231], v250 offset:21760
v_mfma_f32_16x16x32_bf16 v[156:159], v[16:19], v[4:7], v[156:159]
v_permlane16_swap_b32 v186, v190
s_waitcnt vmcnt(8)
v_mfma_f32_16x16x32_bf16 v[128:131], v[18:21], v[0:3], v[128:131]
v_mfma_f32_16x16x32_bf16 v[132:135], v[16:19], v[0:3], v[132:135]
v_permlane16_swap_b32 v187, v191
v_and_b32 v255, 1, v251
v_lshlrev_b32 v255, 7, v255
v_sub_u32 v255, v252, v255
s_mov_b32 s74, 1431655765
s_mov_b32 s75, 1431655765
s_waitcnt lgkmcnt(3)
v_mfma_f32_16x16x32_f16 v[120:123], v[240:243], v[80:83], v[120:123]
buffer_load_dwordx4 v[4:7], v252, s[4:7], s70 offen
v_mfma_f32_16x16x32_f16 v[128:131], v[240:243], v[84:87], v[128:131]
v_permlane16_swap_b32 v168, v172
s_waitcnt lgkmcnt(2)
v_mfma_f32_16x16x32_f16 v[124:127], v[244:247], v[80:83], v[124:127]
ds_read_b128 v[240:243], v250 offset:22528
v_mfma_f32_16x16x32_f16 v[132:135], v[244:247], v[84:87], v[132:135]
v_permlane16_swap_b32 v169, v173
s_waitcnt lgkmcnt(2)
v_mfma_f32_16x16x32_f16 v[136:139], v[224:227], v[80:83], v[136:139]
ds_read_b128 v[244:247], v250 offset:22784
v_mfma_f32_16x16x32_f16 v[144:147], v[224:227], v[84:87], v[144:147]
v_permlane16_swap_b32 v170, v174
s_waitcnt lgkmcnt(2)
v_mfma_f32_16x16x32_f16 v[140:143], v[228:231], v[80:83], v[140:143]
ds_read_b128 v[224:227], v250 offset:26624
v_mfma_f32_16x16x32_f16 v[148:151], v[228:231], v[84:87], v[148:151]
v_permlane16_swap_b32 v171, v175
s_waitcnt lgkmcnt(2)
v_mfma_f32_16x16x32_f16 v[152:155], v[240:243], v[80:83], v[152:155]
ds_read_b128 v[228:231], v250 offset:26880
v_mfma_f32_16x16x32_f16 v[160:163], v[240:243], v[84:87], v[160:163]
v_permlane16_swap_b32 v176, v180
s_waitcnt lgkmcnt(2)
v_mfma_f32_16x16x32_f16 v[156:159], v[244:247], v[80:83], v[156:159]
ds_read_b128 v[240:243], v250 offset:27648
v_mfma_f32_16x16x32_f16 v[164:167], v[244:247], v[84:87], v[164:167]
v_permlane16_swap_b32 v177, v181
s_waitcnt lgkmcnt(2)
v_mfma_f32_16x16x32_f16 v[120:123], v[224:227], v[88:91], v[120:123]
buffer_load_dwordx4 v[0:3], v252, s[4:7], s70 offen offset:64
ds_read_b128 v[244:247], v250 offset:27904
v_mfma_f32_16x16x32_f16 v[128:131], v[224:227], v[92:95], v[128:131]
v_permlane16_swap_b32 v178, v182
s_waitcnt lgkmcnt(2)
v_mfma_f32_16x16x32_f16 v[124:127], v[228:231], v[88:91], v[124:127]
ds_read_b128 v[224:227], v250 offset:28672
v_mfma_f32_16x16x32_f16 v[132:135], v[228:231], v[92:95], v[132:135]
v_permlane16_swap_b32 v179, v183
s_waitcnt lgkmcnt(2)
v_mfma_f32_16x16x32_f16 v[136:139], v[240:243], v[88:91], v[136:139]
ds_read_b128 v[228:231], v250 offset:28928
v_mfma_f32_16x16x32_f16 v[144:147], v[240:243], v[92:95], v[144:147]
v_permlane16_swap_b32 v112, v116
s_waitcnt lgkmcnt(2)
v_mfma_f32_16x16x32_f16 v[140:143], v[244:247], v[88:91], v[140:143]
ds_read_b128 v[240:243], v249 offset:49152
v_mfma_f32_16x16x32_f16 v[148:151], v[244:247], v[92:95], v[148:151]
v_permlane16_swap_b32 v113, v117
s_waitcnt lgkmcnt(2)
v_mfma_f32_16x16x32_f16 v[152:155], v[224:227], v[88:91], v[152:155]
ds_read_b128 v[244:247], v254 offset:7936
v_mfma_f32_16x16x32_f16 v[160:163], v[224:227], v[92:95], v[160:163]
v_permlane16_swap_b32 v114, v118
s_waitcnt lgkmcnt(2)
v_mfma_f32_16x16x32_f16 v[156:159], v[228:231], v[88:91], v[156:159]
ds_read_b128 v[224:227], v249 offset:49408
v_mfma_f32_16x16x32_f16 v[164:167], v[228:231], v[92:95], v[164:167]
v_permlane16_swap_b32 v115, v119
s_waitcnt lgkmcnt(1)
v_mfma_f32_16x16x32_f16 v[48:51], v[240:243], v[168:171], v[244:247]
ds_read_b128 v[228:231], v254 offset:7952
v_mfma_f32_16x16x32_f16 v[56:59], v[240:243], v[172:175], v[244:247]
s_waitcnt lgkmcnt(0)
v_mfma_f32_16x16x32_f16 v[52:55], v[224:227], v[168:171], v[228:231]
ds_read_b128 v[240:243], v249 offset:50176
ds_read_b128 v[244:247], v254 offset:8064
v_mfma_f32_16x16x32_f16 v[60:63], v[224:227], v[172:175], v[228:231]
s_waitcnt lgkmcnt(0)
v_mfma_f32_16x16x32_f16 v[64:67], v[240:243], v[168:171], v[244:247]
ds_read_b128 v[224:227], v249 offset:50432
ds_read_b128 v[228:231], v254 offset:8080
v_mfma_f32_16x16x32_f16 v[72:75], v[240:243], v[172:175], v[244:247]
s_waitcnt lgkmcnt(0)
v_mfma_f32_16x16x32_f16 v[68:71], v[224:227], v[168:171], v[228:231]
ds_read_b128 v[240:243], v249 offset:51200
ds_read_b128 v[244:247], v254 offset:16128
v_cvt_pk_bf16_f32 v136, v136, v137
v_mfma_f32_16x16x32_f16 v[76:79], v[224:227], v[172:175], v[228:231]
v_cvt_pk_bf16_f32 v137, v138, v139
s_waitcnt lgkmcnt(0)
v_mfma_f32_16x16x32_f16 v[80:83], v[240:243], v[168:171], v[244:247]
ds_read_b128 v[224:227], v249 offset:51456
ds_read_b128 v[228:231], v254 offset:16144
v_cvt_pk_bf16_f32 v138, v140, v141
v_mfma_f32_16x16x32_f16 v[88:91], v[240:243], v[172:175], v[244:247]
v_cvt_pk_bf16_f32 v139, v142, v143
s_waitcnt lgkmcnt(0)
v_mfma_f32_16x16x32_f16 v[84:87], v[224:227], v[168:171], v[228:231]
ds_read_b128 v[240:243], v249 offset:55296
ds_read_b128 v[244:247], v249 offset:55552
v_cvt_pk_bf16_f32 v120, v120, v121
v_mfma_f32_16x16x32_f16 v[92:95], v[224:227], v[172:175], v[228:231]
v_cvt_pk_bf16_f32 v121, v122, v123
s_waitcnt lgkmcnt(1)
v_mfma_f32_16x16x32_f16 v[48:51], v[240:243], v[176:179], v[48:51]
ds_read_b128 v[224:227], v249 offset:56320
ds_read_b128 v[228:231], v249 offset:56576
v_cvt_pk_bf16_f32 v122, v124, v125
v_mfma_f32_16x16x32_f16 v[56:59], v[240:243], v[180:183], v[56:59]
v_cvt_pk_bf16_f32 v123, v126, v127
s_waitcnt lgkmcnt(2)
v_mfma_f32_16x16x32_f16 v[52:55], v[244:247], v[176:179], v[52:55]
ds_read_b128 v[240:243], v249 offset:57344
v_cvt_pk_bf16_f32 v152, v152, v153
v_cvt_pk_bf16_f32 v153, v154, v155
v_mfma_f32_16x16x32_f16 v[60:63], v[244:247], v[180:183], v[60:63]
v_cvt_pk_bf16_f32 v154, v156, v157
s_waitcnt lgkmcnt(2)
v_mfma_f32_16x16x32_f16 v[64:67], v[224:227], v[176:179], v[64:67]
ds_read_b128 v[244:247], v249 offset:57600
v_cvt_pk_bf16_f32 v155, v158, v159
s_mov_b64 vcc, s[74:75]
v_mfma_f32_16x16x32_f16 v[72:75], v[224:227], v[180:183], v[72:75]
v_cndmask_b32 v140, v120, v152, vcc
s_waitcnt lgkmcnt(2)
v_mfma_f32_16x16x32_f16 v[68:71], v[228:231], v[176:179], v[68:71]
ds_read_b128 v[224:227], v249 offset:61440
v_cndmask_b32 v141, v121, v153, vcc
v_mfma_f32_16x16x32_f16 v[76:79], v[228:231], v[180:183], v[76:79]
v_cndmask_b32 v142, v122, v154, vcc
s_waitcnt lgkmcnt(2)
v_mfma_f32_16x16x32_f16 v[80:83], v[240:243], v[176:179], v[80:83]
ds_read_b128 v[228:231], v249 offset:61696
v_cndmask_b32 v143, v123, v155, vcc
v_mfma_f32_16x16x32_f16 v[88:91], v[240:243], v[180:183], v[88:91]
v_cndmask_b32_dpp v120, v136, v120, vcc quad_perm:[1,0,3,2] row_mask:0xf bank_mask:0xf
s_waitcnt lgkmcnt(2)
v_mfma_f32_16x16x32_f16 v[84:87], v[244:247], v[176:179], v[84:87]
ds_read_b128 v[240:243], v248 offset:16384
v_cndmask_b32_dpp v121, v137, v121, vcc quad_perm:[1,0,3,2] row_mask:0xf bank_mask:0xf
v_mfma_f32_16x16x32_f16 v[92:95], v[244:247], v[180:183], v[92:95]
v_cndmask_b32_dpp v122, v138, v122, vcc quad_perm:[1,0,3,2] row_mask:0xf bank_mask:0xf
s_waitcnt vmcnt(3)
v_mfma_f32_16x16x32_bf16 v[144:147], v[18:21], v[8:11], v[144:147]
ds_read_b128 v[244:247], v249 offset:62464
v_cndmask_b32_dpp v123, v139, v123, vcc quad_perm:[1,0,3,2] row_mask:0xf bank_mask:0xf
s_not_b64 vcc, s[74:75]
v_mfma_f32_16x16x32_bf16 v[148:151], v[16:19], v[8:11], v[148:151]
v_cndmask_b32_dpp v152, v136, v152, vcc quad_perm:[1,0,3,2] row_mask:0xf bank_mask:0xf
s_waitcnt vmcnt(2)
v_mfma_f32_16x16x32_bf16 v[160:163], v[18:21], v[12:15], v[160:163]
v_cndmask_b32_dpp v153, v137, v153, vcc quad_perm:[1,0,3,2] row_mask:0xf bank_mask:0xf
v_mfma_f32_16x16x32_bf16 v[164:167], v[16:19], v[12:15], v[164:167]
v_cndmask_b32_dpp v154, v138, v154, vcc quad_perm:[1,0,3,2] row_mask:0xf bank_mask:0xf
v_cndmask_b32_dpp v155, v139, v155, vcc quad_perm:[1,0,3,2] row_mask:0xf bank_mask:0xf
s_waitcnt lgkmcnt(3)
v_mfma_f32_16x16x32_f16 v[48:51], v[224:227], v[184:187], v[48:51]
buffer_load_dwordx4 v[8:11], v252, s[4:7], s70 offen offset:128
buffer_store_dwordx4 v[120:123], v255, s[8:11], s71 offen sc1
v_mfma_f32_16x16x32_f16 v[56:59], v[224:227], v[188:191], v[56:59]
s_waitcnt lgkmcnt(2)
v_mfma_f32_16x16x32_f16 v[52:55], v[228:231], v[184:187], v[52:55]
ds_read_b128 v[224:227], v249 offset:62720
v_permlane16_swap_b32 v200, v204
v_mfma_f32_16x16x32_f16 v[60:63], v[228:231], v[188:191], v[60:63]
s_waitcnt lgkmcnt(2)
v_mfma_f32_16x16x32_bf16 v[168:171], v[240:243], v[96:99], 0
ds_read_b128 v[228:231], v249 offset:63488
v_permlane16_swap_b32 v201, v205
v_mfma_f32_16x16x32_bf16 v[176:179], v[240:243], v[100:103], 0
s_waitcnt lgkmcnt(2)
v_mfma_f32_16x16x32_f16 v[64:67], v[244:247], v[184:187], v[64:67]
ds_read_b128 v[240:243], v249 offset:63744
v_mfma_f32_16x16x32_f16 v[72:75], v[244:247], v[188:191], v[72:75]
v_permlane16_swap_b32 v202, v206
s_waitcnt lgkmcnt(2)
v_mfma_f32_16x16x32_f16 v[68:71], v[224:227], v[184:187], v[68:71]
ds_read_b128 v[244:247], v248 offset:16640
v_mfma_f32_16x16x32_f16 v[76:79], v[224:227], v[188:191], v[76:79]
v_permlane16_swap_b32 v203, v207
s_waitcnt lgkmcnt(2)
v_mfma_f32_16x16x32_f16 v[80:83], v[228:231], v[184:187], v[80:83]
s_add_u32 s46, s70, 98304
buffer_load_dwordx4 v[12:15], v252, s[4:7], s46 offen
ds_read_b128 v[224:227], v250 offset:2048
v_mfma_f32_16x16x32_f16 v[88:91], v[228:231], v[188:191], v[88:91]
s_waitcnt lgkmcnt(2)
v_mfma_f32_16x16x32_f16 v[84:87], v[240:243], v[184:187], v[84:87]
ds_read_b128 v[228:231], v250 offset:2304
v_permlane16_swap_b32 v232, v236
v_mfma_f32_16x16x32_f16 v[92:95], v[240:243], v[188:191], v[92:95]
s_waitcnt lgkmcnt(2)
v_mfma_f32_16x16x32_bf16 v[172:175], v[244:247], v[96:99], 0
ds_read_b128 v[240:243], v250 offset:3072
v_permlane16_swap_b32 v233, v237
v_mfma_f32_16x16x32_bf16 v[180:183], v[244:247], v[100:103], 0
s_waitcnt lgkmcnt(2)
v_mfma_f32_16x16x32_f16 v[48:51], v[224:227], v[192:195], v[48:51]
ds_read_b128 v[244:247], v250 offset:3328
v_mfma_f32_16x16x32_f16 v[56:59], v[224:227], v[196:199], v[56:59]
v_permlane16_swap_b32 v234, v238
s_waitcnt lgkmcnt(2)
v_mfma_f32_16x16x32_f16 v[52:55], v[228:231], v[192:195], v[52:55]
ds_read_b128 v[224:227], v248 offset:17408
v_mfma_f32_16x16x32_f16 v[60:63], v[228:231], v[196:199], v[60:63]
v_permlane16_swap_b32 v235, v239
s_waitcnt lgkmcnt(2)
v_mfma_f32_16x16x32_f16 v[64:67], v[240:243], v[192:195], v[64:67]
buffer_store_dwordx4 v[140:143], v255, s[8:11], s71 offen offset:128 sc1
ds_read_b128 v[228:231], v250 offset:4096
v_mfma_f32_16x16x32_f16 v[72:75], v[240:243], v[196:199], v[72:75]
s_waitcnt lgkmcnt(2)
v_mfma_f32_16x16x32_f16 v[68:71], v[244:247], v[192:195], v[68:71]
ds_read_b128 v[240:243], v250 offset:4352
v_permlane16_swap_b32 v208, v212
v_mfma_f32_16x16x32_f16 v[76:79], v[244:247], v[196:199], v[76:79]
s_waitcnt lgkmcnt(2)
v_mfma_f32_16x16x32_bf16 v[168:171], v[224:227], v[104:107], v[168:171]
ds_read_b128 v[244:247], v250 offset:8192
v_permlane16_swap_b32 v209, v213
v_mfma_f32_16x16x32_bf16 v[176:179], v[224:227], v[108:111], v[176:179]
s_waitcnt lgkmcnt(2)
v_mfma_f32_16x16x32_f16 v[80:83], v[228:231], v[192:195], v[80:83]
ds_read_b128 v[224:227], v250 offset:8448
v_mfma_f32_16x16x32_f16 v[88:91], v[228:231], v[196:199], v[88:91]
v_permlane16_swap_b32 v210, v214
s_waitcnt lgkmcnt(2)
v_mfma_f32_16x16x32_f16 v[84:87], v[240:243], v[192:195], v[84:87]
ds_read_b128 v[228:231], v248 offset:17664
v_mfma_f32_16x16x32_f16 v[92:95], v[240:243], v[196:199], v[92:95]
v_permlane16_swap_b32 v211, v215
s_waitcnt lgkmcnt(2)
v_mfma_f32_16x16x32_f16 v[48:51], v[244:247], v[200:203], v[48:51]
buffer_store_dwordx4 v[152:155], v255, s[8:11], s71 offen offset:256 sc1
ds_read_b128 v[240:243], v250 offset:9216
v_mfma_f32_16x16x32_f16 v[56:59], v[244:247], v[204:207], v[56:59]
s_waitcnt lgkmcnt(2)
v_mfma_f32_16x16x32_f16 v[52:55], v[224:227], v[200:203], v[52:55]
ds_read_b128 v[244:247], v250 offset:9472
v_mfma_f32_16x16x32_f16 v[60:63], v[224:227], v[204:207], v[60:63]
s_waitcnt lgkmcnt(2)
v_mfma_f32_16x16x32_bf16 v[172:175], v[228:231], v[104:107], v[172:175]
ds_read_b128 v[224:227], v250 offset:10240
v_mfma_f32_16x16x32_bf16 v[180:183], v[228:231], v[108:111], v[180:183]
s_waitcnt lgkmcnt(2)
v_mfma_f32_16x16x32_f16 v[64:67], v[240:243], v[200:203], v[64:67]
ds_read_b128 v[228:231], v250 offset:10496
v_mfma_f32_16x16x32_f16 v[72:75], v[240:243], v[204:207], v[72:75]
s_waitcnt lgkmcnt(2)
v_mfma_f32_16x16x32_f16 v[68:71], v[244:247], v[200:203], v[68:71]
ds_read_b128 v[240:243], v248 offset:18432
v_mfma_f32_16x16x32_f16 v[76:79], v[244:247], v[204:207], v[76:79]
s_waitcnt lgkmcnt(2)
v_mfma_f32_16x16x32_f16 v[80:83], v[224:227], v[200:203], v[80:83]
ds_read_b128 v[244:247], v250 offset:14336
v_permlane16_swap_b32 v216, v220
v_mfma_f32_16x16x32_f16 v[88:91], v[224:227], v[204:207], v[88:91]
s_waitcnt lgkmcnt(2)
v_mfma_f32_16x16x32_f16 v[84:87], v[228:231], v[200:203], v[84:87]
ds_read_b128 v[224:227], v250 offset:14592
v_mfma_f32_16x16x32_f16 v[92:95], v[228:231], v[204:207], v[92:95]
s_waitcnt lgkmcnt(2)
v_mfma_f32_16x16x32_bf16 v[168:171], v[240:243], v[112:115], v[168:171]
ds_read_b128 v[228:231], v250 offset:15360
v_mfma_f32_16x16x32_bf16 v[176:179], v[240:243], v[116:119], v[176:179]
s_waitcnt lgkmcnt(2)
v_mfma_f32_16x16x32_f16 v[48:51], v[244:247], v[232:235], v[48:51]
ds_read_b128 v[240:243], v250 offset:15616
v_mfma_f32_16x16x32_f16 v[56:59], v[244:247], v[236:239], v[56:59]
s_waitcnt lgkmcnt(2)
v_mfma_f32_16x16x32_f16 v[52:55], v[224:227], v[232:235], v[52:55]
ds_read_b128 v[244:247], v248 offset:18688
v_mfma_f32_16x16x32_f16 v[60:63], v[224:227], v[236:239], v[60:63]
s_waitcnt lgkmcnt(2)
v_mfma_f32_16x16x32_f16 v[64:67], v[228:231], v[232:235], v[64:67]
ds_read_b128 v[224:227], v250 offset:16384
v_mfma_f32_16x16x32_f16 v[72:75], v[228:231], v[236:239], v[72:75]
v_permlane16_swap_b32 v217, v221
s_waitcnt lgkmcnt(2)
v_mfma_f32_16x16x32_f16 v[68:71], v[240:243], v[232:235], v[68:71]
ds_read_b128 v[228:231], v250 offset:16640
v_mfma_f32_16x16x32_f16 v[76:79], v[240:243], v[236:239], v[76:79]
s_waitcnt lgkmcnt(2)
v_mfma_f32_16x16x32_bf16 v[172:175], v[244:247], v[112:115], v[172:175]
ds_read_b128 v[240:243], v250 offset:20480
v_mfma_f32_16x16x32_bf16 v[180:183], v[244:247], v[116:119], v[180:183]
s_waitcnt lgkmcnt(2)
v_mfma_f32_16x16x32_f16 v[80:83], v[224:227], v[232:235], v[80:83]
ds_read_b128 v[244:247], v250 offset:20736
v_mfma_f32_16x16x32_f16 v[88:91], v[224:227], v[236:239], v[88:91]
s_waitcnt lgkmcnt(2)
v_mfma_f32_16x16x32_f16 v[84:87], v[228:231], v[232:235], v[84:87]
ds_read_b128 v[224:227], v250 offset:21504
v_mfma_f32_16x16x32_f16 v[92:95], v[228:231], v[236:239], v[92:95]
s_waitcnt lgkmcnt(2)
v_mfma_f32_16x16x32_f16 v[48:51], v[240:243], v[208:211], v[48:51]
ds_read_b128 v[228:231], v250 offset:21760
v_mfma_f32_16x16x32_f16 v[56:59], v[240:243], v[212:215], v[56:59]
v_permlane16_swap_b32 v218, v222
s_waitcnt lgkmcnt(2)
v_mfma_f32_16x16x32_f16 v[52:55], v[244:247], v[208:211], v[52:55]
ds_read_b128 v[240:243], v250 offset:22528
v_mfma_f32_16x16x32_f16 v[60:63], v[244:247], v[212:215], v[60:63]
s_waitcnt lgkmcnt(2)
v_mfma_f32_16x16x32_f16 v[64:67], v[224:227], v[208:211], v[64:67]
ds_read_b128 v[244:247], v250 offset:22784
v_mfma_f32_16x16x32_f16 v[72:75], v[224:227], v[212:215], v[72:75]
s_waitcnt lgkmcnt(2)
v_mfma_f32_16x16x32_f16 v[68:71], v[228:231], v[208:211], v[68:71]
ds_read_b128 v[224:227], v250 offset:26624
v_mfma_f32_16x16x32_f16 v[76:79], v[228:231], v[212:215], v[76:79]
s_waitcnt lgkmcnt(2)
v_mfma_f32_16x16x32_f16 v[80:83], v[240:243], v[208:211], v[80:83]
ds_read_b128 v[228:231], v250 offset:26880
v_mfma_f32_16x16x32_f16 v[88:91], v[240:243], v[212:215], v[88:91]
s_waitcnt lgkmcnt(2)
v_mfma_f32_16x16x32_f16 v[84:87], v[244:247], v[208:211], v[84:87]
ds_read_b128 v[240:243], v248 offset:22528
v_mfma_f32_16x16x32_f16 v[92:95], v[244:247], v[212:215], v[92:95]
v_permlane16_swap_b32 v219, v223
s_setprio 3
s_waitcnt lgkmcnt(2)
v_mfma_f32_16x16x32_f16 v[48:51], v[224:227], v[216:219], v[48:51]
s_add_u32 s46, s70, 98304
buffer_load_dwordx4 v[208:211], v252, s[4:7], s46 offen offset:64
ds_read_b128 v[244:247], v250 offset:27648
v_cvt_pkrtz_f16_f32 v185, v168, v169
v_cvt_pkrtz_f16_f32 v187, v170, v171
v_cvt_pkrtz_f16_f32 v189, v172, v173
v_mfma_f32_16x16x32_f16 v[56:59], v[224:227], v[220:223], v[56:59]
v_cvt_pkrtz_f16_f32 v191, v174, v175
v_cvt_pkrtz_f16_f32 v193, v176, v177
v_cvt_pk_f16_f32 v203, v178, v179
s_waitcnt lgkmcnt(2)
v_mfma_f32_16x16x32_f16 v[52:55], v[228:231], v[216:219], v[52:55]
ds_read_b128 v[224:227], v248 offset:22784
v_cvt_pk_f16_f32 v200, v180, v181
v_cvt_pk_f16_f32 v197, v182, v183
v_pk_fma_f16 v202, v203, v203, s48
v_cvt_pk_bf16_f32 v144, v144, v145
v_mfma_f32_16x16x32_f16 v[60:63], v[228:231], v[220:223], v[60:63]
v_and_b32 v185, s49, v185
v_cvt_pk_bf16_f32 v145, v146, v147
v_pk_fma_f16 v199, v200, v200, s48
s_waitcnt lgkmcnt(2)
v_mfma_f32_16x16x32_bf16 v[168:171], v[240:243], v[96:99], 0
ds_read_b128 v[228:231], v250 offset:27904
v_and_b32 v187, s49, v187
v_cvt_pk_bf16_f32 v146, v148, v149
v_pk_fma_f16 v196, v197, v197, s48
v_mfma_f32_16x16x32_bf16 v[176:179], v[240:243], v[100:103], 0
v_bfe_u32 v184, v185, 2, 14
v_cvt_pk_bf16_f32 v147, v150, v151
v_pk_mul_f16 v202, v203, v202
v_cvt_pk_bf16_f32 v128, v128, v129
s_waitcnt lgkmcnt(2)
v_mfma_f32_16x16x32_f16 v[64:67], v[244:247], v[216:219], v[64:67]
ds_read_b128 v[240:243], v248 offset:23552
ds_read_u16_d16 v184, v184
v_bfe_u32 v186, v187, 2, 14
v_pk_mul_f16 v199, v200, v199
v_cvt_pk_bf16_f32 v129, v130, v131
v_mfma_f32_16x16x32_f16 v[72:75], v[244:247], v[220:223], v[72:75]
v_lshrrev_b32 v185, 18, v185
v_pk_mul_f16 v196, v197, v196
v_cvt_pk_bf16_f32 v130, v132, v133
s_waitcnt lgkmcnt(3)
v_mfma_f32_16x16x32_bf16 v[172:175], v[224:227], v[96:99], 0
ds_read_b128 v[244:247], v250 offset:28672
ds_read_u16_d16 v186, v186
ds_read_u16_d16_hi v185, v185
v_lshrrev_b32_e64 v187, 18, v187
v_cvt_pk_bf16_f32 v131, v134, v135
v_exp_f16_e64 v201, v202
v_mfma_f32_16x16x32_bf16 v[180:183], v[224:227], v[100:103], 0
v_cvt_pk_bf16_f32 v160, v160, v161
v_and_b32_e64 v189, s49, v189
v_and_b32 v191, s49, v191
s_waitcnt lgkmcnt(5)
v_mfma_f32_16x16x32_f16 v[68:71], v[228:231], v[216:219], v[68:71]
ds_read_b128 v[224:227], v250 offset:28928
ds_read_u16_d16_hi v187, v187
v_cvt_pk_bf16_f32 v161, v162, v163
v_exp_f16_e64 v198, v199
v_mfma_f32_16x16x32_f16 v[76:79], v[228:231], v[220:223], v[76:79]
v_cvt_pk_bf16_f32 v162, v164, v165
v_bfe_u32 v188, v189, 2, 14
v_cvt_pk_bf16_f32 v163, v166, v167
s_mov_b64 vcc, s[74:75]
v_bfe_u32 v190, v191, 2, 14
s_waitcnt lgkmcnt(5)
v_mfma_f32_16x16x32_bf16 v[168:171], v[240:243], v[104:107], v[168:171]
s_add_u32 s46, s70, 98304
buffer_load_dwordx4 v[204:207], v252, s[4:7], s46 offen offset:128
ds_read_b128 v[228:231], v248 offset:23808
ds_read_u16_d16 v188, v188
ds_read_u16_d16 v190, v190
v_exp_f16 v195, v196
v_cndmask_b32 v148, v128, v160, vcc
v_mfma_f32_16x16x32_bf16 v[176:179], v[240:243], v[108:111], v[176:179]
v_cndmask_b32 v149, v129, v161, vcc
v_lshrrev_b32 v189, 18, v189
v_lshrrev_b32 v191, 18, v191
s_waitcnt lgkmcnt(5)
v_mfma_f32_16x16x32_f16 v[80:83], v[244:247], v[216:219], v[80:83]
ds_read_b128 v[240:243], v248 offset:24576
ds_read_u16_d16_hi v189, v189
ds_read_u16_d16_hi v191, v191
v_cndmask_b32 v150, v130, v162, vcc
v_exp_f16_sdwa v201, v202 dst_sel:WORD_1 dst_unused:UNUSED_PRESERVE src0_sel:WORD_1
v_cndmask_b32 v151, v131, v163, vcc
v_mfma_f32_16x16x32_f16 v[88:91], v[244:247], v[220:223], v[88:91]
v_and_b32 v193, s49, v193
v_cndmask_b32_dpp v128, v144, v128, vcc quad_perm:[1,0,3,2] row_mask:0xf bank_mask:0xf
v_bfe_u32 v192, v193, 2, 14
s_waitcnt lgkmcnt(6)
v_mfma_f32_16x16x32_f16 v[84:87], v[224:227], v[216:219], v[84:87]
ds_read_b128 v[244:247], v248 offset:24832
ds_read_u16_d16 v192, v192
v_exp_f16_sdwa v198, v199 dst_sel:WORD_1 dst_unused:UNUSED_PRESERVE src0_sel:WORD_1
v_cndmask_b32_dpp v129, v145, v129, vcc quad_perm:[1,0,3,2] row_mask:0xf bank_mask:0xf
v_mfma_f32_16x16x32_f16 v[92:95], v[224:227], v[220:223], v[92:95]
v_lshrrev_b32_e64 v193, 18, v193
v_cndmask_b32_dpp v130, v146, v130, vcc quad_perm:[1,0,3,2] row_mask:0xf bank_mask:0xf
v_exp_f16_sdwa v195, v196 dst_sel:WORD_1 dst_unused:UNUSED_PRESERVE src0_sel:WORD_1
s_waitcnt lgkmcnt(5)
v_mfma_f32_16x16x32_bf16 v[172:175], v[228:231], v[104:107], v[172:175]
ds_read_b128 v[224:227], v249 offset:24576
ds_read_u16_d16_hi v193, v193
v_cndmask_b32_dpp v131, v147, v131, vcc quad_perm:[1,0,3,2] row_mask:0xf bank_mask:0xf
s_not_b64 vcc, s[74:75]
v_pk_add_f16 v201, v201, 1.0 op_sel_hi:[1,0]
v_cndmask_b32_dpp v160, v144, v160, vcc quad_perm:[1,0,3,2] row_mask:0xf bank_mask:0xf
v_mfma_f32_16x16x32_bf16 v[180:183], v[228:231], v[108:111], v[180:183]
v_pk_add_f16 v198, v198, 1.0 op_sel_hi:[1,0]
v_pk_add_f16 v195, v195, 1.0 op_sel_hi:[1,0]
v_cndmask_b32_dpp v161, v145, v161, vcc quad_perm:[1,0,3,2] row_mask:0xf bank_mask:0xf
s_waitcnt lgkmcnt(4)
v_mfma_f32_16x16x32_bf16 v[168:171], v[240:243], v[112:115], v[168:171]
ds_read_b128 v[228:231], v249 offset:24832
v_rcp_f16 v202, v201
v_cndmask_b32_dpp v162, v146, v162, vcc quad_perm:[1,0,3,2] row_mask:0xf bank_mask:0xf
v_mfma_f32_16x16x32_bf16 v[176:179], v[240:243], v[116:119], v[176:179]
v_rcp_f16 v199, v198
v_cndmask_b32_dpp v163, v147, v163, vcc quad_perm:[1,0,3,2] row_mask:0xf bank_mask:0xf
s_waitcnt lgkmcnt(3)
v_mfma_f32_16x16x32_bf16 v[172:175], v[244:247], v[112:115], v[172:175]
ds_read_b128 v[240:243], v248 offset:28672
s_add_u32 s46, s71, 98304
buffer_store_dwordx4 v[128:131], v255, s[8:11], s46 offen sc1
v_rcp_f16_e64 v196, v195
v_rcp_f16_sdwa v202, v201 dst_sel:WORD_1 dst_unused:UNUSED_PRESERVE src0_sel:WORD_1
v_mfma_f32_16x16x32_bf16 v[180:183], v[244:247], v[116:119], v[180:183]
v_rcp_f16_sdwa v199, v198 dst_sel:WORD_1 dst_unused:UNUSED_PRESERVE src0_sel:WORD_1
v_or_b32 v232, v184, v185
v_or_b32 v233, v186, v187
v_or_b32_e64 v234, v188, v189
v_rcp_f16_sdwa v196, v195 dst_sel:WORD_1 dst_unused:UNUSED_PRESERVE src0_sel:WORD_1
v_or_b32 v235, v190, v191
s_waitcnt lgkmcnt(2)
v_or_b32_e64 v236, v192, v193
v_pk_mul_f16 v237, v203, v202
v_pk_mul_f16 v238, v200, v199
v_pk_mul_f16 v239, v197, v196
v_mfma_f32_16x16x32_f16 v[48:51], v[224:227], v[232:235], v[48:51]
s_add_u32 s46, s71, 98304
buffer_store_dwordx4 v[148:151], v255, s[8:11], s46 offen offset:128 sc1
ds_read_b128 v[244:247], v249 offset:25600
ds_read_b128 v[216:219], v248 offset:28928
ds_read_b128 v[220:223], v249 offset:25856
v_cvt_pkrtz_f16_f32 v185, v168, v169
v_cvt_pkrtz_f16_f32 v187, v170, v171
v_mfma_f32_16x16x32_f16 v[56:59], v[224:227], v[236:239], v[56:59]
v_cvt_pkrtz_f16_f32 v189, v172, v173
v_cvt_pkrtz_f16_f32 v191, v174, v175
s_waitcnt lgkmcnt(3)
v_mfma_f32_16x16x32_f16 v[52:55], v[228:231], v[232:235], v[52:55]
ds_read_b128 v[224:227], v248 offset:29696
v_cvt_pkrtz_f16_f32 v193, v176, v177
v_cvt_pk_f16_f32 v203, v178, v179
v_mfma_f32_16x16x32_f16 v[60:63], v[228:231], v[236:239], v[60:63]
v_cvt_pk_f16_f32 v200, v180, v181
v_cvt_pk_f16_f32 v197, v182, v183
v_mfma_f32_16x16x32_bf16 v[168:171], v[240:243], v[96:99], 0
ds_read_b128 v[228:231], v249 offset:26624
v_pk_fma_f16 v202, v203, v203, s48
v_and_b32 v185, s49, v185
v_mfma_f32_16x16x32_bf16 v[176:179], v[240:243], v[100:103], 0
v_pk_fma_f16 v199, v200, v200, s48
v_and_b32 v187, s49, v187
s_waitcnt lgkmcnt(4)
v_mfma_f32_16x16x32_f16 v[64:67], v[244:247], v[232:235], v[64:67]
ds_read_b128 v[240:243], v249 offset:26880
v_pk_fma_f16 v196, v197, v197, s48
s_setprio 2
v_bfe_u32 v184, v185, 2, 14
v_pk_mul_f16 v202, v203, v202
v_mfma_f32_16x16x32_f16 v[72:75], v[244:247], v[236:239], v[72:75]
v_bfe_u32 v186, v187, 2, 14
v_pk_mul_f16 v199, v200, v199
s_waitcnt vmcnt(10)
v_mfma_f32_16x16x32_bf16 v[48:51], v[18:21], v[4:7], v[48:51]
ds_read_b128 v[244:247], v248 offset:29952
ds_read_u16_d16 v184, v184
ds_read_u16_d16 v186, v186
v_lshrrev_b32_e64 v185, 18, v185
v_pk_mul_f16 v196, v197, v196
v_mfma_f32_16x16x32_bf16 v[52:55], v[16:19], v[4:7], v[52:55]
v_lshrrev_b32 v187, 18, v187
s_waitcnt lgkmcnt(4)
v_mfma_f32_16x16x32_bf16 v[172:175], v[216:219], v[96:99], 0
ds_read_u16_d16_hi v185, v185
ds_read_u16_d16_hi v187, v187
v_exp_f16 v201, v202
v_and_b32 v189, s49, v189
v_mfma_f32_16x16x32_bf16 v[180:183], v[216:219], v[100:103], 0
v_and_b32_e64 v191, s49, v191
v_mfma_f32_16x16x32_f16 v[68:71], v[220:223], v[232:235], v[68:71]
ds_read_b128 v[216:219], v248 offset:30720
v_exp_f16_e64 v198, v199
v_bfe_u32 v188, v189, 2, 14
v_mfma_f32_16x16x32_f16 v[76:79], v[220:223], v[236:239], v[76:79]
v_bfe_u32 v190, v191, 2, 14
v_exp_f16_e64 v195, v196
v_mfma_f32_16x16x32_bf16 v[168:171], v[224:227], v[104:107], v[168:171]
ds_read_b128 v[220:223], v248 offset:30976
ds_read_u16_d16 v188, v188
ds_read_u16_d16 v190, v190
v_lshrrev_b32 v189, 18, v189
v_lshrrev_b32 v191, 18, v191
v_mfma_f32_16x16x32_bf16 v[176:179], v[224:227], v[108:111], v[176:179]
v_exp_f16_sdwa v201, v202 dst_sel:WORD_1 dst_unused:UNUSED_PRESERVE src0_sel:WORD_1
v_mfma_f32_16x16x32_f16 v[80:83], v[228:231], v[232:235], v[80:83]
ds_read_b128 v[224:227], v249 offset:30720
ds_read_u16_d16_hi v189, v189
ds_read_u16_d16_hi v191, v191
v_and_b32 v193, s49, v193
v_bfe_u32 v192, v193, 2, 14
v_mfma_f32_16x16x32_f16 v[88:91], v[228:231], v[236:239], v[88:91]
v_exp_f16_sdwa v198, v199 dst_sel:WORD_1 dst_unused:UNUSED_PRESERVE src0_sel:WORD_1
s_waitcnt lgkmcnt(7)
v_mfma_f32_16x16x32_f16 v[84:87], v[240:243], v[232:235], v[84:87]
ds_read_b128 v[228:231], v249 offset:30976
ds_read_u16_d16 v192, v192
v_lshrrev_b32_e64 v193, 18, v193
v_mfma_f32_16x16x32_f16 v[92:95], v[240:243], v[236:239], v[92:95]
v_exp_f16_sdwa v195, v196 dst_sel:WORD_1 dst_unused:UNUSED_PRESERVE src0_sel:WORD_1
v_pk_add_f16 v201, v201, 1.0 op_sel_hi:[1,0]
v_pk_add_f16 v198, v198, 1.0 op_sel_hi:[1,0]
v_mfma_f32_16x16x32_bf16 v[172:175], v[244:247], v[104:107], v[172:175]
ds_read_b128 v[240:243], v248 offset:34816
ds_read_u16_d16_hi v193, v193
v_pk_add_f16 v195, v195, 1.0 op_sel_hi:[1,0]
v_mfma_f32_16x16x32_bf16 v[180:183], v[244:247], v[108:111], v[180:183]
v_rcp_f16 v202, v201
s_waitcnt lgkmcnt(7)
v_mfma_f32_16x16x32_bf16 v[168:171], v[216:219], v[112:115], v[168:171]
ds_read_b128 v[244:247], v249 offset:31744
v_rcp_f16_e64 v199, v198
v_mfma_f32_16x16x32_bf16 v[176:179], v[216:219], v[116:119], v[176:179]
v_rcp_f16_e64 v196, v195
v_mfma_f32_16x16x32_bf16 v[172:175], v[220:223], v[112:115], v[172:175]
ds_read_b128 v[216:219], v248 offset:35072
v_rcp_f16_sdwa v202, v201 dst_sel:WORD_1 dst_unused:UNUSED_PRESERVE src0_sel:WORD_1
v_mfma_f32_16x16x32_bf16 v[180:183], v[220:223], v[116:119], v[180:183]
v_rcp_f16_sdwa v199, v198 dst_sel:WORD_1 dst_unused:UNUSED_PRESERVE src0_sel:WORD_1
v_or_b32 v232, v184, v185
v_or_b32 v233, v186, v187
s_waitcnt lgkmcnt(4)
v_or_b32 v234, v188, v189
v_rcp_f16_sdwa v196, v195 dst_sel:WORD_1 dst_unused:UNUSED_PRESERVE src0_sel:WORD_1
v_or_b32 v235, v190, v191
s_waitcnt lgkmcnt(2)
v_or_b32_e64 v236, v192, v193
v_pk_mul_f16 v237, v203, v202
v_pk_mul_f16 v238, v200, v199
v_pk_mul_f16 v239, v197, v196
v_mfma_f32_16x16x32_f16 v[48:51], v[224:227], v[232:235], v[48:51]
s_add_u32 s46, s71, 98304
buffer_store_dwordx4 v[160:163], v255, s[8:11], s46 offen offset:256 sc1
ds_read_b128 v[220:223], v249 offset:32000
v_cvt_pkrtz_f16_f32 v185, v168, v169
v_cvt_pkrtz_f16_f32 v187, v170, v171
v_mfma_f32_16x16x32_f16 v[56:59], v[224:227], v[236:239], v[56:59]
v_cvt_pkrtz_f16_f32 v189, v172, v173
v_cvt_pkrtz_f16_f32 v191, v174, v175
v_mfma_f32_16x16x32_f16 v[52:55], v[228:231], v[232:235], v[52:55]
ds_read_b128 v[224:227], v248 offset:35840
v_cvt_pkrtz_f16_f32 v193, v176, v177
v_cvt_pk_f16_f32 v203, v178, v179
v_mfma_f32_16x16x32_f16 v[60:63], v[228:231], v[236:239], v[60:63]
v_cvt_pk_f16_f32 v200, v180, v181
v_cvt_pk_f16_f32 v197, v182, v183
s_setprio 1
v_mfma_f32_16x16x32_bf16 v[168:171], v[240:243], v[96:99], 0
ds_read_b128 v[228:231], v249 offset:32768
v_pk_fma_f16 v202, v203, v203, s48
v_and_b32 v185, s49, v185
v_mfma_f32_16x16x32_bf16 v[176:179], v[240:243], v[100:103], 0
v_pk_fma_f16 v199, v200, v200, s48
v_and_b32 v187, s49, v187
s_waitcnt lgkmcnt(3)
v_mfma_f32_16x16x32_f16 v[64:67], v[244:247], v[232:235], v[64:67]
ds_read_b128 v[240:243], v249 offset:33024
v_pk_fma_f16 v196, v197, v197, s48
v_bfe_u32 v184, v185, 2, 14
v_pk_mul_f16 v202, v203, v202
v_mfma_f32_16x16x32_f16 v[72:75], v[244:247], v[236:239], v[72:75]
v_bfe_u32 v186, v187, 2, 14
v_pk_mul_f16 v199, v200, v199
s_waitcnt vmcnt(10)
v_mfma_f32_16x16x32_bf16 v[64:67], v[18:21], v[0:3], v[64:67]
ds_read_b128 v[244:247], v248 offset:36096
ds_read_u16_d16 v184, v184
ds_read_u16_d16 v186, v186
v_lshrrev_b32 v185, 18, v185
v_pk_mul_f16 v196, v197, v196
v_mfma_f32_16x16x32_bf16 v[68:71], v[16:19], v[0:3], v[68:71]
v_lshrrev_b32_e64 v187, 18, v187
v_mfma_f32_16x16x32_bf16 v[172:175], v[216:219], v[96:99], 0
ds_read_u16_d16_hi v185, v185
ds_read_u16_d16_hi v187, v187
v_exp_f16 v201, v202
v_and_b32 v189, s49, v189
v_mfma_f32_16x16x32_bf16 v[180:183], v[216:219], v[100:103], 0
v_and_b32 v191, s49, v191
s_waitcnt lgkmcnt(6)
v_mfma_f32_16x16x32_f16 v[68:71], v[220:223], v[232:235], v[68:71]
ds_read_b128 v[216:219], v248 offset:36864
v_exp_f16_e64 v198, v199
v_bfe_u32 v188, v189, 2, 14
v_mfma_f32_16x16x32_f16 v[76:79], v[220:223], v[236:239], v[76:79]
v_bfe_u32 v190, v191, 2, 14
v_exp_f16_e64 v195, v196
v_mfma_f32_16x16x32_bf16 v[168:171], v[224:227], v[104:107], v[168:171]
ds_read_b128 v[220:223], v248 offset:37120
ds_read_u16_d16 v188, v188
ds_read_u16_d16 v190, v190
v_lshrrev_b32 v189, 18, v189
v_lshrrev_b32 v191, 18, v191
v_mfma_f32_16x16x32_bf16 v[176:179], v[224:227], v[108:111], v[176:179]
v_exp_f16_sdwa v201, v202 dst_sel:WORD_1 dst_unused:UNUSED_PRESERVE src0_sel:WORD_1
v_mfma_f32_16x16x32_f16 v[80:83], v[228:231], v[232:235], v[80:83]
ds_read_b128 v[224:227], v249 offset:36864
ds_read_u16_d16_hi v189, v189
ds_read_u16_d16_hi v191, v191
v_and_b32 v193, s49, v193
v_bfe_u32 v192, v193, 2, 14
v_mfma_f32_16x16x32_f16 v[88:91], v[228:231], v[236:239], v[88:91]
v_exp_f16_sdwa v198, v199 dst_sel:WORD_1 dst_unused:UNUSED_PRESERVE src0_sel:WORD_1
s_waitcnt lgkmcnt(7)
v_mfma_f32_16x16x32_f16 v[84:87], v[240:243], v[232:235], v[84:87]
ds_read_b128 v[228:231], v249 offset:37120
ds_read_u16_d16 v192, v192
v_lshrrev_b32_e64 v193, 18, v193
v_mfma_f32_16x16x32_f16 v[92:95], v[240:243], v[236:239], v[92:95]
v_exp_f16_sdwa v195, v196 dst_sel:WORD_1 dst_unused:UNUSED_PRESERVE src0_sel:WORD_1
v_pk_add_f16 v201, v201, 1.0 op_sel_hi:[1,0]
v_pk_add_f16 v198, v198, 1.0 op_sel_hi:[1,0]
v_mfma_f32_16x16x32_bf16 v[172:175], v[244:247], v[104:107], v[172:175]
ds_read_b128 v[240:243], v248 offset:16384
ds_read_u16_d16_hi v193, v193
v_pk_add_f16 v195, v195, 1.0 op_sel_hi:[1,0]
v_mfma_f32_16x16x32_bf16 v[180:183], v[244:247], v[108:111], v[180:183]
v_rcp_f16_e64 v202, v201
s_setprio 0
s_waitcnt lgkmcnt(7)
v_mfma_f32_16x16x32_bf16 v[168:171], v[216:219], v[112:115], v[168:171]
ds_read_b128 v[244:247], v249 offset:37888
v_rcp_f16_e64 v199, v198
v_mfma_f32_16x16x32_bf16 v[176:179], v[216:219], v[116:119], v[176:179]
v_rcp_f16_e64 v196, v195
v_mfma_f32_16x16x32_bf16 v[172:175], v[220:223], v[112:115], v[172:175]
ds_read_b128 v[216:219], v248 offset:16640
v_rcp_f16_sdwa v202, v201 dst_sel:WORD_1 dst_unused:UNUSED_PRESERVE src0_sel:WORD_1
v_mfma_f32_16x16x32_bf16 v[180:183], v[220:223], v[116:119], v[180:183]
v_rcp_f16_sdwa v199, v198 dst_sel:WORD_1 dst_unused:UNUSED_PRESERVE src0_sel:WORD_1
v_or_b32 v232, v184, v185
v_or_b32 v233, v186, v187
s_waitcnt lgkmcnt(4)
v_or_b32 v234, v188, v189
v_rcp_f16_sdwa v196, v195 dst_sel:WORD_1 dst_unused:UNUSED_PRESERVE src0_sel:WORD_1
v_or_b32 v235, v190, v191
s_waitcnt lgkmcnt(2)
v_or_b32 v236, v192, v193
v_pk_mul_f16 v237, v203, v202
v_pk_mul_f16 v238, v200, v199
v_pk_mul_f16 v239, v197, v196
s_setprio 3
v_mfma_f32_16x16x32_f16 v[48:51], v[224:227], v[232:235], v[48:51]
s_add_u32 s46, s80, 12582912
buffer_load_dwordx4 v[96:99], v253, s[32:35], s46 offen nt
ds_read_b128 v[220:223], v249 offset:38144
v_cvt_pkrtz_f16_f32 v185, v168, v169
v_cvt_pkrtz_f16_f32 v187, v170, v171
v_mfma_f32_16x16x32_f16 v[56:59], v[224:227], v[236:239], v[56:59]
v_cvt_pkrtz_f16_f32 v189, v172, v173
v_cvt_pkrtz_f16_f32 v191, v174, v175
v_mfma_f32_16x16x32_f16 v[52:55], v[228:231], v[232:235], v[52:55]
ds_read_b128 v[224:227], v248 offset:17408
v_cvt_pkrtz_f16_f32 v193, v176, v177
v_cvt_pk_f16_f32 v203, v178, v179
v_mfma_f32_16x16x32_f16 v[60:63], v[228:231], v[236:239], v[60:63]
v_cvt_pk_f16_f32 v200, v180, v181
v_cvt_pk_f16_f32 v197, v182, v183
v_mfma_f32_16x16x32_bf16 v[168:171], v[240:243], v[24:27], 0
ds_read_b128 v[228:231], v249 offset:38912
v_pk_fma_f16 v202, v203, v203, s48
v_and_b32_e64 v185, s49, v185
v_mfma_f32_16x16x32_bf16 v[176:179], v[240:243], v[28:31], 0
v_pk_fma_f16 v199, v200, v200, s48
v_and_b32 v187, s49, v187
s_waitcnt lgkmcnt(3)
v_mfma_f32_16x16x32_f16 v[64:67], v[244:247], v[232:235], v[64:67]
ds_read_b128 v[240:243], v249 offset:39168
v_pk_fma_f16 v196, v197, v197, s48
v_bfe_u32 v184, v185, 2, 14
v_pk_mul_f16 v202, v203, v202
v_mfma_f32_16x16x32_f16 v[72:75], v[244:247], v[236:239], v[72:75]
v_bfe_u32 v186, v187, 2, 14
v_pk_mul_f16 v199, v200, v199
s_waitcnt vmcnt(10)
v_mfma_f32_16x16x32_bf16 v[80:83], v[18:21], v[8:11], v[80:83]
ds_read_b128 v[244:247], v248 offset:17664
ds_read_u16_d16 v184, v184
ds_read_u16_d16 v186, v186
v_lshrrev_b32 v185, 18, v185
v_pk_mul_f16 v196, v197, v196
v_mfma_f32_16x16x32_bf16 v[84:87], v[16:19], v[8:11], v[84:87]
v_lshrrev_b32_e64 v187, 18, v187
v_mfma_f32_16x16x32_bf16 v[172:175], v[216:219], v[24:27], 0
ds_read_u16_d16_hi v185, v185
ds_read_u16_d16_hi v187, v187
v_exp_f16 v201, v202
v_and_b32 v189, s49, v189
v_mfma_f32_16x16x32_bf16 v[180:183], v[216:219], v[28:31], 0
v_and_b32 v191, s49, v191
s_waitcnt lgkmcnt(6)
v_mfma_f32_16x16x32_f16 v[68:71], v[220:223], v[232:235], v[68:71]
ds_read_b128 v[216:219], v248 offset:18432
v_exp_f16_e64 v198, v199
v_bfe_u32 v188, v189, 2, 14
v_mfma_f32_16x16x32_f16 v[76:79], v[220:223], v[236:239], v[76:79]
v_bfe_u32 v190, v191, 2, 14
v_exp_f16_e64 v195, v196
v_mfma_f32_16x16x32_bf16 v[168:171], v[224:227], v[32:35], v[168:171]
ds_read_b128 v[220:223], v248 offset:18688
ds_read_u16_d16 v188, v188
ds_read_u16_d16 v190, v190
v_lshrrev_b32 v189, 18, v189
v_lshrrev_b32 v191, 18, v191
v_mfma_f32_16x16x32_bf16 v[176:179], v[224:227], v[36:39], v[176:179]
v_exp_f16_sdwa v201, v202 dst_sel:WORD_1 dst_unused:UNUSED_PRESERVE src0_sel:WORD_1
v_mfma_f32_16x16x32_f16 v[80:83], v[228:231], v[232:235], v[80:83]
ds_read_b128 v[224:227], v249 offset:43008
ds_read_u16_d16_hi v189, v189
ds_read_u16_d16_hi v191, v191
v_and_b32 v193, s49, v193
v_bfe_u32 v192, v193, 2, 14
v_mfma_f32_16x16x32_f16 v[88:91], v[228:231], v[236:239], v[88:91]
v_exp_f16_sdwa v198, v199 dst_sel:WORD_1 dst_unused:UNUSED_PRESERVE src0_sel:WORD_1
s_waitcnt lgkmcnt(7)
v_mfma_f32_16x16x32_f16 v[84:87], v[240:243], v[232:235], v[84:87]
ds_read_b128 v[228:231], v249 offset:43264
ds_read_u16_d16 v192, v192
v_lshrrev_b32_e64 v193, 18, v193
v_mfma_f32_16x16x32_f16 v[92:95], v[240:243], v[236:239], v[92:95]
v_exp_f16_sdwa v195, v196 dst_sel:WORD_1 dst_unused:UNUSED_PRESERVE src0_sel:WORD_1
v_pk_add_f16 v201, v201, 1.0 op_sel_hi:[1,0]
v_pk_add_f16 v198, v198, 1.0 op_sel_hi:[1,0]
v_mfma_f32_16x16x32_bf16 v[172:175], v[244:247], v[32:35], v[172:175]
ds_read_b128 v[240:243], v248 offset:22528
ds_read_u16_d16_hi v193, v193
v_pk_add_f16 v195, v195, 1.0 op_sel_hi:[1,0]
v_mfma_f32_16x16x32_bf16 v[180:183], v[244:247], v[36:39], v[180:183]
v_rcp_f16 v202, v201
s_waitcnt lgkmcnt(7)
v_mfma_f32_16x16x32_bf16 v[168:171], v[216:219], v[40:43], v[168:171]
ds_read_b128 v[244:247], v249 offset:44032
v_rcp_f16_e64 v199, v198
v_mfma_f32_16x16x32_bf16 v[176:179], v[216:219], v[44:47], v[176:179]
v_rcp_f16_e64 v196, v195
v_mfma_f32_16x16x32_bf16 v[172:175], v[220:223], v[40:43], v[172:175]
ds_read_b128 v[216:219], v248 offset:22784
v_rcp_f16_sdwa v202, v201 dst_sel:WORD_1 dst_unused:UNUSED_PRESERVE src0_sel:WORD_1
v_mfma_f32_16x16x32_bf16 v[180:183], v[220:223], v[44:47], v[180:183]
v_rcp_f16_sdwa v199, v198 dst_sel:WORD_1 dst_unused:UNUSED_PRESERVE src0_sel:WORD_1
v_or_b32 v232, v184, v185
v_or_b32 v233, v186, v187
s_waitcnt lgkmcnt(4)
v_or_b32 v234, v188, v189
v_rcp_f16_sdwa v196, v195 dst_sel:WORD_1 dst_unused:UNUSED_PRESERVE src0_sel:WORD_1
v_or_b32 v235, v190, v191
s_waitcnt lgkmcnt(2)
v_or_b32_e64 v236, v192, v193
v_pk_mul_f16 v237, v203, v202
v_pk_mul_f16 v238, v200, v199
v_pk_mul_f16 v239, v197, v196
v_mfma_f32_16x16x32_f16 v[48:51], v[224:227], v[232:235], v[48:51]
s_add_u32 s46, s80, 12582912
buffer_load_dwordx4 v[100:103], v253, s[32:35], s46 offen offset:256 nt
ds_read_b128 v[220:223], v249 offset:44288
v_cvt_pkrtz_f16_f32 v185, v168, v169
v_cvt_pkrtz_f16_f32 v187, v170, v171
v_mfma_f32_16x16x32_f16 v[56:59], v[224:227], v[236:239], v[56:59]
v_cvt_pkrtz_f16_f32 v189, v172, v173
v_cvt_pkrtz_f16_f32 v191, v174, v175
v_mfma_f32_16x16x32_f16 v[52:55], v[228:231], v[232:235], v[52:55]
ds_read_b128 v[224:227], v248 offset:23552
v_cvt_pkrtz_f16_f32 v193, v176, v177
v_cvt_pk_f16_f32 v203, v178, v179
v_mfma_f32_16x16x32_f16 v[60:63], v[228:231], v[236:239], v[60:63]
v_cvt_pk_f16_f32 v200, v180, v181
v_cvt_pk_f16_f32 v197, v182, v183
v_mfma_f32_16x16x32_bf16 v[168:171], v[240:243], v[24:27], 0
ds_read_b128 v[228:231], v249 offset:45056
v_pk_fma_f16 v202, v203, v203, s48
v_and_b32_e64 v185, s49, v185
v_mfma_f32_16x16x32_bf16 v[176:179], v[240:243], v[28:31], 0
v_pk_fma_f16 v199, v200, v200, s48
v_and_b32 v187, s49, v187
s_waitcnt lgkmcnt(3)
v_mfma_f32_16x16x32_f16 v[64:67], v[244:247], v[232:235], v[64:67]
ds_read_b128 v[240:243], v249 offset:45312
v_pk_fma_f16 v196, v197, v197, s48
s_setprio 2
v_bfe_u32 v184, v185, 2, 14
v_pk_mul_f16 v202, v203, v202
v_mfma_f32_16x16x32_f16 v[72:75], v[244:247], v[236:239], v[72:75]
v_bfe_u32 v186, v187, 2, 14
v_pk_mul_f16 v199, v200, v199
s_waitcnt vmcnt(9)
v_mfma_f32_16x16x32_bf16 v[56:59], v[18:21], v[12:15], v[56:59]
ds_read_b128 v[244:247], v248 offset:23808
ds_read_u16_d16 v184, v184
ds_read_u16_d16 v186, v186
v_lshrrev_b32_e64 v185, 18, v185
v_pk_mul_f16 v196, v197, v196
v_mfma_f32_16x16x32_bf16 v[60:63], v[16:19], v[12:15], v[60:63]
v_lshrrev_b32_e64 v187, 18, v187
v_mfma_f32_16x16x32_bf16 v[172:175], v[216:219], v[24:27], 0
ds_read_u16_d16_hi v185, v185
ds_read_u16_d16_hi v187, v187
v_exp_f16 v201, v202
v_and_b32 v189, s49, v189
v_mfma_f32_16x16x32_bf16 v[180:183], v[216:219], v[28:31], 0
v_and_b32 v191, s49, v191
s_waitcnt lgkmcnt(6)
v_mfma_f32_16x16x32_f16 v[68:71], v[220:223], v[232:235], v[68:71]
ds_read_b128 v[216:219], v248 offset:24576
v_exp_f16_e64 v198, v199
v_bfe_u32 v188, v189, 2, 14
v_mfma_f32_16x16x32_f16 v[76:79], v[220:223], v[236:239], v[76:79]
v_bfe_u32 v190, v191, 2, 14
v_exp_f16_e64 v195, v196
v_mfma_f32_16x16x32_bf16 v[168:171], v[224:227], v[32:35], v[168:171]
ds_read_b128 v[220:223], v248 offset:24832
ds_read_u16_d16 v188, v188
ds_read_u16_d16 v190, v190
v_lshrrev_b32 v189, 18, v189
v_lshrrev_b32 v191, 18, v191
v_mfma_f32_16x16x32_bf16 v[176:179], v[224:227], v[36:39], v[176:179]
v_exp_f16_sdwa v201, v202 dst_sel:WORD_1 dst_unused:UNUSED_PRESERVE src0_sel:WORD_1
v_mfma_f32_16x16x32_f16 v[80:83], v[228:231], v[232:235], v[80:83]
ds_read_b128 v[224:227], v249 offset:24576
ds_read_u16_d16_hi v189, v189
ds_read_u16_d16_hi v191, v191
v_and_b32 v193, s49, v193
v_bfe_u32 v192, v193, 2, 14
v_mfma_f32_16x16x32_f16 v[88:91], v[228:231], v[236:239], v[88:91]
v_exp_f16_sdwa v198, v199 dst_sel:WORD_1 dst_unused:UNUSED_PRESERVE src0_sel:WORD_1
s_waitcnt lgkmcnt(7)
v_mfma_f32_16x16x32_f16 v[84:87], v[240:243], v[232:235], v[84:87]
ds_read_b128 v[228:231], v254 offset:7936
ds_read_u16_d16 v192, v192
v_lshrrev_b32_e64 v193, 18, v193
v_mfma_f32_16x16x32_f16 v[92:95], v[240:243], v[236:239], v[92:95]
v_exp_f16_sdwa v195, v196 dst_sel:WORD_1 dst_unused:UNUSED_PRESERVE src0_sel:WORD_1
v_pk_add_f16 v201, v201, 1.0 op_sel_hi:[1,0]
v_pk_add_f16 v198, v198, 1.0 op_sel_hi:[1,0]
v_mfma_f32_16x16x32_bf16 v[172:175], v[244:247], v[32:35], v[172:175]
ds_read_b128 v[240:243], v249 offset:24832
ds_read_u16_d16_hi v193, v193
v_pk_add_f16 v195, v195, 1.0 op_sel_hi:[1,0]
v_mfma_f32_16x16x32_bf16 v[180:183], v[244:247], v[36:39], v[180:183]
v_rcp_f16 v202, v201
s_waitcnt lgkmcnt(7)
v_mfma_f32_16x16x32_bf16 v[168:171], v[216:219], v[40:43], v[168:171]
ds_read_b128 v[244:247], v254 offset:7952
v_rcp_f16_e64 v199, v198
v_mfma_f32_16x16x32_bf16 v[176:179], v[216:219], v[44:47], v[176:179]
v_rcp_f16_e64 v196, v195
v_mfma_f32_16x16x32_bf16 v[172:175], v[220:223], v[40:43], v[172:175]
ds_read_b128 v[216:219], v248 offset:28672
v_rcp_f16_sdwa v202, v201 dst_sel:WORD_1 dst_unused:UNUSED_PRESERVE src0_sel:WORD_1
v_mfma_f32_16x16x32_bf16 v[180:183], v[220:223], v[44:47], v[180:183]
v_rcp_f16_sdwa v199, v198 dst_sel:WORD_1 dst_unused:UNUSED_PRESERVE src0_sel:WORD_1
v_or_b32 v232, v184, v185
v_or_b32 v233, v186, v187
s_waitcnt lgkmcnt(4)
v_or_b32 v234, v188, v189
v_rcp_f16_sdwa v196, v195 dst_sel:WORD_1 dst_unused:UNUSED_PRESERVE src0_sel:WORD_1
v_or_b32 v235, v190, v191
s_waitcnt lgkmcnt(2)
v_or_b32 v236, v192, v193
v_pk_mul_f16 v237, v203, v202
v_pk_mul_f16 v238, v200, v199
v_pk_mul_f16 v239, v197, v196
v_mfma_f32_16x16x32_f16 v[120:123], v[224:227], v[232:235], v[228:231]
s_add_u32 s46, s80, 16777216
buffer_load_dwordx4 v[104:107], v253, s[32:35], s46 offen nt
ds_read_b128 v[220:223], v249 offset:25600
v_cvt_pkrtz_f16_f32 v185, v168, v169
v_cvt_pkrtz_f16_f32 v187, v170, v171
v_mfma_f32_16x16x32_f16 v[128:131], v[224:227], v[236:239], v[228:231]
v_cvt_pkrtz_f16_f32 v189, v172, v173
v_cvt_pkrtz_f16_f32 v191, v174, v175
s_waitcnt lgkmcnt(2)
v_mfma_f32_16x16x32_f16 v[124:127], v[240:243], v[232:235], v[244:247]
ds_read_b128 v[224:227], v254 offset:8064
ds_read_b128 v[228:231], v248 offset:28928
v_cvt_pkrtz_f16_f32 v193, v176, v177
v_cvt_pk_f16_f32 v203, v178, v179
v_mfma_f32_16x16x32_f16 v[132:135], v[240:243], v[236:239], v[244:247]
v_cvt_pk_f16_f32 v200, v180, v181
v_cvt_pk_f16_f32 v197, v182, v183
s_setprio 1
s_waitcnt lgkmcnt(3)
v_mfma_f32_16x16x32_bf16 v[168:171], v[216:219], v[24:27], 0
ds_read_b128 v[240:243], v249 offset:25856
ds_read_b128 v[244:247], v254 offset:8080
v_pk_fma_f16 v202, v203, v203, s48
v_and_b32_e64 v185, s49, v185
v_mfma_f32_16x16x32_bf16 v[176:179], v[216:219], v[28:31], 0
v_pk_fma_f16 v199, v200, v200, s48
v_and_b32 v187, s49, v187
s_waitcnt lgkmcnt(3)
v_mfma_f32_16x16x32_f16 v[136:139], v[220:223], v[232:235], v[224:227]
ds_read_b128 v[216:219], v248 offset:29696
v_pk_fma_f16 v196, v197, v197, s48
v_bfe_u32 v184, v185, 2, 14
v_pk_mul_f16 v202, v203, v202
v_mfma_f32_16x16x32_f16 v[144:147], v[220:223], v[236:239], v[224:227]
v_bfe_u32 v186, v187, 2, 14
v_pk_mul_f16 v199, v200, v199
s_waitcnt vmcnt(7)
v_mfma_f32_16x16x32_bf16 v[72:75], v[18:21], v[208:211], v[72:75]
ds_read_b128 v[220:223], v249 offset:26624
ds_read_b128 v[224:227], v254 offset:16128
ds_read_u16_d16 v184, v184
ds_read_u16_d16 v186, v186
v_lshrrev_b32 v185, 18, v185
v_pk_mul_f16 v196, v197, v196
v_mfma_f32_16x16x32_bf16 v[76:79], v[16:19], v[208:211], v[76:79]
v_lshrrev_b32 v187, 18, v187
s_waitcnt lgkmcnt(5)
v_mfma_f32_16x16x32_bf16 v[172:175], v[228:231], v[24:27], 0
ds_read_u16_d16_hi v185, v185
ds_read_u16_d16_hi v187, v187
v_exp_f16 v201, v202
v_and_b32 v189, s49, v189
v_mfma_f32_16x16x32_bf16 v[180:183], v[228:231], v[28:31], 0
v_and_b32_e64 v191, s49, v191
v_mfma_f32_16x16x32_f16 v[140:143], v[240:243], v[232:235], v[244:247]
ds_read_b128 v[228:231], v249 offset:26880
v_exp_f16_e64 v198, v199
v_bfe_u32 v188, v189, 2, 14
v_mfma_f32_16x16x32_f16 v[148:151], v[240:243], v[236:239], v[244:247]
v_bfe_u32 v190, v191, 2, 14
v_exp_f16 v195, v196
s_waitcnt lgkmcnt(7)
v_mfma_f32_16x16x32_bf16 v[168:171], v[216:219], v[32:35], v[168:171]
ds_read_b128 v[240:243], v254 offset:16144
ds_read_b128 v[244:247], v248 offset:29952
ds_read_u16_d16 v188, v188
ds_read_u16_d16 v190, v190
v_lshrrev_b32_e64 v189, 18, v189
v_lshrrev_b32 v191, 18, v191
v_mfma_f32_16x16x32_bf16 v[176:179], v[216:219], v[36:39], v[176:179]
v_exp_f16_sdwa v201, v202 dst_sel:WORD_1 dst_unused:UNUSED_PRESERVE src0_sel:WORD_1
s_waitcnt lgkmcnt(7)
v_mfma_f32_16x16x32_f16 v[152:155], v[220:223], v[232:235], v[224:227]
ds_read_b128 v[216:219], v248 offset:30720
ds_read_u16_d16_hi v189, v189
ds_read_u16_d16_hi v191, v191
v_and_b32 v193, s49, v193
v_bfe_u32 v192, v193, 2, 14
v_mfma_f32_16x16x32_f16 v[160:163], v[220:223], v[236:239], v[224:227]
v_exp_f16_sdwa v198, v199 dst_sel:WORD_1 dst_unused:UNUSED_PRESERVE src0_sel:WORD_1
s_waitcnt lgkmcnt(6)
v_mfma_f32_16x16x32_f16 v[156:159], v[228:231], v[232:235], v[240:243]
ds_read_b128 v[220:223], v248 offset:30976
ds_read_b128 v[224:227], v249 offset:30720
ds_read_u16_d16 v192, v192
v_lshrrev_b32 v193, 18, v193
v_mfma_f32_16x16x32_f16 v[164:167], v[228:231], v[236:239], v[240:243]
v_exp_f16_sdwa v195, v196 dst_sel:WORD_1 dst_unused:UNUSED_PRESERVE src0_sel:WORD_1
v_pk_add_f16 v201, v201, 1.0 op_sel_hi:[1,0]
v_pk_add_f16 v198, v198, 1.0 op_sel_hi:[1,0]
s_waitcnt lgkmcnt(7)
v_mfma_f32_16x16x32_bf16 v[172:175], v[244:247], v[32:35], v[172:175]
ds_read_b128 v[228:231], v249 offset:30976
ds_read_b128 v[240:243], v248 offset:40960
ds_read_u16_d16_hi v193, v193
v_pk_add_f16 v195, v195, 1.0 op_sel_hi:[1,0]
v_mfma_f32_16x16x32_bf16 v[180:183], v[244:247], v[36:39], v[180:183]
v_rcp_f16_e64 v202, v201
s_setprio 0
s_waitcnt lgkmcnt(7)
v_mfma_f32_16x16x32_bf16 v[168:171], v[216:219], v[40:43], v[168:171]
ds_read_b128 v[244:247], v249 offset:31744
v_rcp_f16_e64 v199, v198
v_mfma_f32_16x16x32_bf16 v[176:179], v[216:219], v[44:47], v[176:179]
v_rcp_f16 v196, v195
s_waitcnt lgkmcnt(6)
v_mfma_f32_16x16x32_bf16 v[172:175], v[220:223], v[40:43], v[172:175]
ds_read_b128 v[216:219], v248 offset:41216
v_rcp_f16_sdwa v202, v201 dst_sel:WORD_1 dst_unused:UNUSED_PRESERVE src0_sel:WORD_1
v_mfma_f32_16x16x32_bf16 v[180:183], v[220:223], v[44:47], v[180:183]
v_rcp_f16_sdwa v199, v198 dst_sel:WORD_1 dst_unused:UNUSED_PRESERVE src0_sel:WORD_1
v_or_b32 v232, v184, v185
v_or_b32 v233, v186, v187
v_or_b32_e64 v234, v188, v189
v_rcp_f16_sdwa v196, v195 dst_sel:WORD_1 dst_unused:UNUSED_PRESERVE src0_sel:WORD_1
v_or_b32 v235, v190, v191
s_waitcnt lgkmcnt(2)
v_or_b32 v236, v192, v193
v_pk_mul_f16 v237, v203, v202
v_pk_mul_f16 v238, v200, v199
v_pk_mul_f16 v239, v197, v196
s_setprio 3
v_mfma_f32_16x16x32_f16 v[120:123], v[224:227], v[232:235], v[120:123]
s_add_u32 s46, s80, 16777216
buffer_load_dwordx4 v[108:111], v253, s[32:35], s46 offen offset:256 nt
ds_read_b128 v[220:223], v249 offset:32000
v_cvt_pkrtz_f16_f32 v185, v168, v169
v_cvt_pkrtz_f16_f32 v187, v170, v171
v_mfma_f32_16x16x32_f16 v[128:131], v[224:227], v[236:239], v[128:131]
v_cvt_pkrtz_f16_f32 v189, v172, v173
v_cvt_pkrtz_f16_f32 v191, v174, v175
v_mfma_f32_16x16x32_f16 v[124:127], v[228:231], v[232:235], v[124:127]
ds_read_b128 v[224:227], v248 offset:41984
v_cvt_pkrtz_f16_f32 v193, v176, v177
v_cvt_pk_f16_f32 v203, v178, v179
v_mfma_f32_16x16x32_f16 v[132:135], v[228:231], v[236:239], v[132:135]
v_cvt_pk_f16_f32 v200, v180, v181
v_cvt_pk_f16_f32 v197, v182, v183
v_mfma_f32_16x16x32_bf16 v[168:171], v[240:243], v[24:27], 0
ds_read_b128 v[228:231], v249 offset:32768
v_pk_fma_f16 v202, v203, v203, s48
v_and_b32_e64 v185, s49, v185
v_mfma_f32_16x16x32_bf16 v[176:179], v[240:243], v[28:31], 0
v_pk_fma_f16 v199, v200, v200, s48
v_and_b32 v187, s49, v187
s_waitcnt lgkmcnt(3)
v_mfma_f32_16x16x32_f16 v[136:139], v[244:247], v[232:235], v[136:139]
ds_read_b128 v[240:243], v249 offset:33024
v_pk_fma_f16 v196, v197, v197, s48
v_bfe_u32 v184, v185, 2, 14
v_pk_mul_f16 v202, v203, v202
v_mfma_f32_16x16x32_f16 v[144:147], v[244:247], v[236:239], v[144:147]
v_bfe_u32 v186, v187, 2, 14
v_pk_mul_f16 v199, v200, v199
s_waitcnt vmcnt(7)
v_mfma_f32_16x16x32_bf16 v[88:91], v[18:21], v[204:207], v[88:91]
ds_read_b128 v[244:247], v248 offset:42240
ds_read_u16_d16 v184, v184
ds_read_u16_d16 v186, v186
v_lshrrev_b32 v185, 18, v185
v_pk_mul_f16 v196, v197, v196
v_mfma_f32_16x16x32_bf16 v[92:95], v[16:19], v[204:207], v[92:95]
v_lshrrev_b32_e64 v187, 18, v187
v_mfma_f32_16x16x32_bf16 v[172:175], v[216:219], v[24:27], 0
ds_read_u16_d16_hi v185, v185
ds_read_u16_d16_hi v187, v187
v_exp_f16 v201, v202
v_and_b32 v189, s49, v189
v_mfma_f32_16x16x32_bf16 v[180:183], v[216:219], v[28:31], 0
v_and_b32 v191, s49, v191
s_waitcnt lgkmcnt(6)
v_mfma_f32_16x16x32_f16 v[140:143], v[220:223], v[232:235], v[140:143]
ds_read_b128 v[216:219], v248 offset:43008
v_exp_f16_e64 v198, v199
v_bfe_u32 v188, v189, 2, 14
v_mfma_f32_16x16x32_f16 v[148:151], v[220:223], v[236:239], v[148:151]
v_bfe_u32 v190, v191, 2, 14
v_exp_f16_e64 v195, v196
v_mfma_f32_16x16x32_bf16 v[168:171], v[224:227], v[32:35], v[168:171]
ds_read_b128 v[220:223], v248 offset:43264
ds_read_u16_d16 v188, v188
ds_read_u16_d16 v190, v190
v_lshrrev_b32 v189, 18, v189
v_lshrrev_b32 v191, 18, v191
v_mfma_f32_16x16x32_bf16 v[176:179], v[224:227], v[36:39], v[176:179]
v_exp_f16_sdwa v201, v202 dst_sel:WORD_1 dst_unused:UNUSED_PRESERVE src0_sel:WORD_1
v_mfma_f32_16x16x32_f16 v[152:155], v[228:231], v[232:235], v[152:155]
ds_read_b128 v[224:227], v249 offset:36864
ds_read_u16_d16_hi v189, v189
ds_read_u16_d16_hi v191, v191
v_and_b32 v193, s49, v193
v_bfe_u32 v192, v193, 2, 14
v_mfma_f32_16x16x32_f16 v[160:163], v[228:231], v[236:239], v[160:163]
v_exp_f16_sdwa v198, v199 dst_sel:WORD_1 dst_unused:UNUSED_PRESERVE src0_sel:WORD_1
s_waitcnt lgkmcnt(7)
v_mfma_f32_16x16x32_f16 v[156:159], v[240:243], v[232:235], v[156:159]
ds_read_b128 v[228:231], v249 offset:37120
ds_read_u16_d16 v192, v192
v_lshrrev_b32_e64 v193, 18, v193
v_mfma_f32_16x16x32_f16 v[164:167], v[240:243], v[236:239], v[164:167]
v_exp_f16_sdwa v195, v196 dst_sel:WORD_1 dst_unused:UNUSED_PRESERVE src0_sel:WORD_1
v_pk_add_f16 v201, v201, 1.0 op_sel_hi:[1,0]
v_pk_add_f16 v198, v198, 1.0 op_sel_hi:[1,0]
v_mfma_f32_16x16x32_bf16 v[172:175], v[244:247], v[32:35], v[172:175]
ds_read_b128 v[240:243], v248 offset:34816
ds_read_u16_d16_hi v193, v193
v_pk_add_f16 v195, v195, 1.0 op_sel_hi:[1,0]
v_mfma_f32_16x16x32_bf16 v[180:183], v[244:247], v[36:39], v[180:183]
v_rcp_f16 v202, v201
s_waitcnt lgkmcnt(7)
v_mfma_f32_16x16x32_bf16 v[168:171], v[216:219], v[40:43], v[168:171]
ds_read_b128 v[244:247], v249 offset:37888
v_rcp_f16_e64 v199, v198
v_mfma_f32_16x16x32_bf16 v[176:179], v[216:219], v[44:47], v[176:179]
v_rcp_f16_e64 v196, v195
v_mfma_f32_16x16x32_bf16 v[172:175], v[220:223], v[40:43], v[172:175]
ds_read_b128 v[216:219], v248 offset:35072
v_rcp_f16_sdwa v202, v201 dst_sel:WORD_1 dst_unused:UNUSED_PRESERVE src0_sel:WORD_1
v_mfma_f32_16x16x32_bf16 v[180:183], v[220:223], v[44:47], v[180:183]
v_rcp_f16_sdwa v199, v198 dst_sel:WORD_1 dst_unused:UNUSED_PRESERVE src0_sel:WORD_1
v_or_b32 v232, v184, v185
v_or_b32 v233, v186, v187
s_waitcnt lgkmcnt(4)
v_or_b32 v234, v188, v189
v_rcp_f16_sdwa v196, v195 dst_sel:WORD_1 dst_unused:UNUSED_PRESERVE src0_sel:WORD_1
v_or_b32 v235, v190, v191
s_waitcnt lgkmcnt(2)
v_or_b32_e64 v236, v192, v193
v_pk_mul_f16 v237, v203, v202
v_pk_mul_f16 v238, v200, v199
v_pk_mul_f16 v239, v197, v196
v_mfma_f32_16x16x32_f16 v[120:123], v[224:227], v[232:235], v[120:123]
s_add_u32 s46, s80, 20971520
buffer_load_dwordx4 v[112:115], v253, s[32:35], s46 offen nt
ds_read_b128 v[220:223], v249 offset:38144
v_cvt_pkrtz_f16_f32 v185, v168, v169
v_cvt_pkrtz_f16_f32 v187, v170, v171
v_cvt_pkrtz_f16_f32 v189, v172, v173
v_mfma_f32_16x16x32_f16 v[128:131], v[224:227], v[236:239], v[128:131]
v_cvt_pkrtz_f16_f32 v191, v174, v175
v_cvt_pkrtz_f16_f32 v193, v176, v177
v_cvt_pk_f16_f32 v203, v178, v179
v_mfma_f32_16x16x32_f16 v[124:127], v[228:231], v[232:235], v[124:127]
ds_read_b128 v[224:227], v248 offset:35840
v_cvt_pk_f16_f32 v200, v180, v181
v_cvt_pk_f16_f32 v197, v182, v183
v_pk_fma_f16 v202, v203, v203, s48
v_cvt_pk_bf16_f32 v64, v64, v65
v_mfma_f32_16x16x32_f16 v[132:135], v[228:231], v[236:239], v[132:135]
v_and_b32_e64 v185, s49, v185
v_cvt_pk_bf16_f32 v65, v66, v67
v_pk_fma_f16 v199, v200, v200, s48
v_mfma_f32_16x16x32_bf16 v[168:171], v[240:243], v[24:27], 0
ds_read_b128 v[228:231], v249 offset:38912
v_and_b32_e64 v187, s49, v187
v_cvt_pk_bf16_f32 v66, v68, v69
v_pk_fma_f16 v196, v197, v197, s48
v_mfma_f32_16x16x32_bf16 v[176:179], v[240:243], v[28:31], 0
v_cvt_pk_bf16_f32 v67, v70, v71
v_bfe_u32 v184, v185, 2, 14
s_setprio 2
v_pk_mul_f16 v202, v203, v202
v_cvt_pk_bf16_f32 v48, v48, v49
s_waitcnt lgkmcnt(2)
v_mfma_f32_16x16x32_f16 v[136:139], v[244:247], v[232:235], v[136:139]
ds_read_b128 v[240:243], v249 offset:39168
ds_read_u16_d16 v184, v184
v_bfe_u32 v186, v187, 2, 14
v_cvt_pk_bf16_f32 v49, v50, v51
v_pk_mul_f16 v199, v200, v199
v_mfma_f32_16x16x32_f16 v[144:147], v[244:247], v[236:239], v[144:147]
v_lshrrev_b32_e64 v185, 18, v185
v_cvt_pk_bf16_f32 v50, v52, v53
v_pk_mul_f16 v196, v197, v196
v_mfma_f32_16x16x32_bf16 v[172:175], v[216:219], v[24:27], 0
ds_read_b128 v[244:247], v248 offset:36096
ds_read_u16_d16 v186, v186
ds_read_u16_d16_hi v185, v185
v_lshrrev_b32_e64 v187, 18, v187
v_cvt_pk_bf16_f32 v51, v54, v55
v_exp_f16_e64 v201, v202
v_mfma_f32_16x16x32_bf16 v[180:183], v[216:219], v[28:31], 0
v_cvt_pk_bf16_f32 v80, v80, v81
v_and_b32_e64 v189, s49, v189
v_cvt_pk_bf16_f32 v81, v82, v83
v_mfma_f32_16x16x32_f16 v[140:143], v[220:223], v[232:235], v[140:143]
ds_read_b128 v[216:219], v248 offset:36864
ds_read_u16_d16_hi v187, v187
v_and_b32_e64 v191, s49, v191
v_cvt_pk_bf16_f32 v82, v84, v85
v_mfma_f32_16x16x32_f16 v[148:151], v[220:223], v[236:239], v[148:151]
v_exp_f16_e64 v198, v199
v_cvt_pk_bf16_f32 v83, v86, v87
s_mov_b64 vcc, s[74:75]
v_bfe_u32 v188, v189, 2, 14
v_bfe_u32 v190, v191, 2, 14
s_waitcnt lgkmcnt(5)
v_mfma_f32_16x16x32_bf16 v[168:171], v[224:227], v[32:35], v[168:171]
ds_read_b128 v[220:223], v248 offset:37120
ds_read_u16_d16 v188, v188
ds_read_u16_d16 v190, v190
v_cndmask_b32 v68, v48, v80, vcc
v_exp_f16 v195, v196
v_mfma_f32_16x16x32_bf16 v[176:179], v[224:227], v[36:39], v[176:179]
v_cndmask_b32 v69, v49, v81, vcc
v_lshrrev_b32_e64 v189, 18, v189
v_cndmask_b32 v70, v50, v82, vcc
v_mfma_f32_16x16x32_f16 v[152:155], v[228:231], v[232:235], v[152:155]
ds_read_b128 v[224:227], v249 offset:49152
ds_read_u16_d16_hi v189, v189
v_lshrrev_b32 v191, 18, v191
v_cndmask_b32 v71, v51, v83, vcc
v_exp_f16_sdwa v201, v202 dst_sel:WORD_1 dst_unused:UNUSED_PRESERVE src0_sel:WORD_1
v_mfma_f32_16x16x32_f16 v[160:163], v[228:231], v[236:239], v[160:163]
v_cndmask_b32_dpp v48, v64, v48, vcc quad_perm:[1,0,3,2] row_mask:0xf bank_mask:0xf
v_and_b32_e64 v193, s49, v193
v_cndmask_b32_dpp v49, v65, v49, vcc quad_perm:[1,0,3,2] row_mask:0xf bank_mask:0xf
v_mfma_f32_16x16x32_f16 v[156:159], v[240:243], v[232:235], v[156:159]
ds_read_b128 v[228:231], v249 offset:49408
ds_read_u16_d16_hi v191, v191
v_bfe_u32 v192, v193, 2, 14
v_exp_f16_sdwa v198, v199 dst_sel:WORD_1 dst_unused:UNUSED_PRESERVE src0_sel:WORD_1
v_mfma_f32_16x16x32_f16 v[164:167], v[240:243], v[236:239], v[164:167]
v_cndmask_b32_dpp v50, v66, v50, vcc quad_perm:[1,0,3,2] row_mask:0xf bank_mask:0xf
v_lshrrev_b32_e64 v193, 18, v193
v_cndmask_b32_dpp v51, v67, v51, vcc quad_perm:[1,0,3,2] row_mask:0xf bank_mask:0xf
s_not_b64 vcc, s[74:75]
s_waitcnt lgkmcnt(4)
v_mfma_f32_16x16x32_bf16 v[172:175], v[244:247], v[32:35], v[172:175]
ds_read_b128 v[240:243], v248 offset:47104
ds_read_u16_d16 v192, v192
ds_read_u16_d16_hi v193, v193
v_exp_f16_sdwa v195, v196 dst_sel:WORD_1 dst_unused:UNUSED_PRESERVE src0_sel:WORD_1
v_cndmask_b32_dpp v80, v64, v80, vcc quad_perm:[1,0,3,2] row_mask:0xf bank_mask:0xf
v_pk_add_f16 v201, v201, 1.0 op_sel_hi:[1,0]
v_mfma_f32_16x16x32_bf16 v[180:183], v[244:247], v[36:39], v[180:183]
v_cndmask_b32_dpp v81, v65, v81, vcc quad_perm:[1,0,3,2] row_mask:0xf bank_mask:0xf
v_pk_add_f16 v198, v198, 1.0 op_sel_hi:[1,0]
v_cndmask_b32_dpp v82, v66, v82, vcc quad_perm:[1,0,3,2] row_mask:0xf bank_mask:0xf
v_mfma_f32_16x16x32_bf16 v[168:171], v[216:219], v[40:43], v[168:171]
ds_read_b128 v[244:247], v249 offset:50176
v_pk_add_f16 v195, v195, 1.0 op_sel_hi:[1,0]
v_rcp_f16_e64 v202, v201
v_cndmask_b32_dpp v83, v67, v83, vcc quad_perm:[1,0,3,2] row_mask:0xf bank_mask:0xf
v_mfma_f32_16x16x32_bf16 v[176:179], v[216:219], v[44:47], v[176:179]
v_rcp_f16_e64 v199, v198
v_mfma_f32_16x16x32_bf16 v[172:175], v[220:223], v[40:43], v[172:175]
ds_read_b128 v[216:219], v248 offset:47360
buffer_store_dwordx4 v[48:51], v255, s[8:11], s70 offen sc1
v_rcp_f16_e64 v196, v195
v_rcp_f16_sdwa v202, v201 dst_sel:WORD_1 dst_unused:UNUSED_PRESERVE src0_sel:WORD_1
v_mfma_f32_16x16x32_bf16 v[180:183], v[220:223], v[44:47], v[180:183]
v_rcp_f16_sdwa v199, v198 dst_sel:WORD_1 dst_unused:UNUSED_PRESERVE src0_sel:WORD_1
v_or_b32 v232, v184, v185
v_or_b32 v233, v186, v187
s_waitcnt lgkmcnt(3)
v_or_b32 v234, v188, v189
v_rcp_f16_sdwa v196, v195 dst_sel:WORD_1 dst_unused:UNUSED_PRESERVE src0_sel:WORD_1
v_or_b32 v235, v190, v191
s_waitcnt lgkmcnt(2)
v_or_b32_e64 v236, v192, v193
v_pk_mul_f16 v237, v203, v202
v_pk_mul_f16 v238, v200, v199
v_pk_mul_f16 v239, v197, v196
v_mfma_f32_16x16x32_f16 v[120:123], v[224:227], v[232:235], v[120:123]
buffer_store_dwordx4 v[68:71], v255, s[8:11], s70 offen offset:128 sc1
ds_read_b128 v[220:223], v249 offset:50432
v_cvt_pkrtz_f16_f32 v185, v168, v169
v_cvt_pkrtz_f16_f32 v187, v170, v171
v_mfma_f32_16x16x32_f16 v[128:131], v[224:227], v[236:239], v[128:131]
v_cvt_pkrtz_f16_f32 v189, v172, v173
v_cvt_pkrtz_f16_f32 v191, v174, v175
v_mfma_f32_16x16x32_f16 v[124:127], v[228:231], v[232:235], v[124:127]
ds_read_b128 v[224:227], v248 offset:48128
v_cvt_pkrtz_f16_f32 v193, v176, v177
v_cvt_pk_f16_f32 v203, v178, v179
v_cvt_pk_f16_f32 v200, v180, v181
v_mfma_f32_16x16x32_f16 v[132:135], v[228:231], v[236:239], v[132:135]
v_cvt_pk_f16_f32 v197, v182, v183
s_setprio 1
v_pk_fma_f16 v202, v203, v203, s48
v_mfma_f32_16x16x32_bf16 v[168:171], v[240:243], v[24:27], 0
ds_read_b128 v[228:231], v249 offset:51200
v_and_b32 v185, s49, v185
v_pk_fma_f16 v199, v200, v200, s48
v_mfma_f32_16x16x32_bf16 v[176:179], v[240:243], v[28:31], 0
v_and_b32 v187, s49, v187
v_pk_fma_f16 v196, v197, v197, s48
v_bfe_u32 v184, v185, 2, 14
s_waitcnt lgkmcnt(3)
v_mfma_f32_16x16x32_f16 v[136:139], v[244:247], v[232:235], v[136:139]
ds_read_b128 v[240:243], v249 offset:51456
ds_read_u16_d16 v184, v184
v_pk_mul_f16 v202, v203, v202
v_bfe_u32 v186, v187, 2, 14
v_mfma_f32_16x16x32_f16 v[144:147], v[244:247], v[236:239], v[144:147]
v_pk_mul_f16 v199, v200, v199
v_lshrrev_b32_e64 v185, 18, v185
v_mfma_f32_16x16x32_bf16 v[172:175], v[216:219], v[24:27], 0
ds_read_b128 v[244:247], v248 offset:48384
ds_read_u16_d16 v186, v186
ds_read_u16_d16_hi v185, v185
v_pk_mul_f16 v196, v197, v196
v_lshrrev_b32_e64 v187, 18, v187
v_mfma_f32_16x16x32_bf16 v[180:183], v[216:219], v[28:31], 0
v_exp_f16_e64 v201, v202
v_and_b32 v189, s49, v189
s_waitcnt lgkmcnt(5)
v_mfma_f32_16x16x32_f16 v[140:143], v[220:223], v[232:235], v[140:143]
ds_read_b128 v[216:219], v248 offset:49152
ds_read_u16_d16_hi v187, v187
v_and_b32_e64 v191, s49, v191
v_mfma_f32_16x16x32_f16 v[148:151], v[220:223], v[236:239], v[148:151]
v_exp_f16_e64 v198, v199
v_bfe_u32 v188, v189, 2, 14
v_bfe_u32 v190, v191, 2, 14
v_mfma_f32_16x16x32_bf16 v[168:171], v[224:227], v[32:35], v[168:171]
s_add_u32 s46, s80, 20971520
buffer_load_dwordx4 v[116:119], v253, s[32:35], s46 offen offset:256 nt
ds_read_b128 v[220:223], v248 offset:49408
ds_read_u16_d16 v188, v188
ds_read_u16_d16 v190, v190
v_exp_f16_e64 v195, v196
v_mfma_f32_16x16x32_bf16 v[176:179], v[224:227], v[36:39], v[176:179]
v_lshrrev_b32 v189, 18, v189
v_lshrrev_b32 v191, 18, v191
v_mfma_f32_16x16x32_f16 v[152:155], v[228:231], v[232:235], v[152:155]
ds_read_b128 v[224:227], v249 offset:43008
ds_read_u16_d16_hi v189, v189
ds_read_u16_d16_hi v191, v191
v_exp_f16_sdwa v201, v202 dst_sel:WORD_1 dst_unused:UNUSED_PRESERVE src0_sel:WORD_1
v_and_b32 v193, s49, v193
v_mfma_f32_16x16x32_f16 v[160:163], v[228:231], v[236:239], v[160:163]
v_bfe_u32 v192, v193, 2, 14
s_waitcnt lgkmcnt(7)
v_mfma_f32_16x16x32_f16 v[156:159], v[240:243], v[232:235], v[156:159]
ds_read_b128 v[228:231], v249 offset:43264
ds_read_u16_d16 v192, v192
v_exp_f16_sdwa v198, v199 dst_sel:WORD_1 dst_unused:UNUSED_PRESERVE src0_sel:WORD_1
v_lshrrev_b32_e64 v193, 18, v193
v_mfma_f32_16x16x32_f16 v[164:167], v[240:243], v[236:239], v[164:167]
v_exp_f16_sdwa v195, v196 dst_sel:WORD_1 dst_unused:UNUSED_PRESERVE src0_sel:WORD_1
v_pk_add_f16 v201, v201, 1.0 op_sel_hi:[1,0]
v_mfma_f32_16x16x32_bf16 v[172:175], v[244:247], v[32:35], v[172:175]
ds_read_b128 v[240:243], v248 offset:53248
ds_read_u16_d16_hi v193, v193
v_pk_add_f16 v198, v198, 1.0 op_sel_hi:[1,0]
v_pk_add_f16 v195, v195, 1.0 op_sel_hi:[1,0]
v_mfma_f32_16x16x32_bf16 v[180:183], v[244:247], v[36:39], v[180:183]
v_rcp_f16 v202, v201
s_setprio 0
v_mfma_f32_16x16x32_bf16 v[168:171], v[216:219], v[40:43], v[168:171]
ds_read_b128 v[244:247], v249 offset:44032
v_rcp_f16_e64 v199, v198
v_mfma_f32_16x16x32_bf16 v[176:179], v[216:219], v[44:47], v[176:179]
v_rcp_f16 v196, v195
s_waitcnt lgkmcnt(5)
v_mfma_f32_16x16x32_bf16 v[172:175], v[220:223], v[40:43], v[172:175]
ds_read_b128 v[216:219], v248 offset:53504
v_rcp_f16_sdwa v202, v201 dst_sel:WORD_1 dst_unused:UNUSED_PRESERVE src0_sel:WORD_1
v_mfma_f32_16x16x32_bf16 v[180:183], v[220:223], v[44:47], v[180:183]
v_rcp_f16_sdwa v199, v198 dst_sel:WORD_1 dst_unused:UNUSED_PRESERVE src0_sel:WORD_1
v_or_b32 v232, v184, v185
v_or_b32 v233, v186, v187
v_or_b32_e64 v234, v188, v189
v_rcp_f16_sdwa v196, v195 dst_sel:WORD_1 dst_unused:UNUSED_PRESERVE src0_sel:WORD_1
v_or_b32 v235, v190, v191
s_waitcnt lgkmcnt(2)
v_or_b32 v236, v192, v193
v_pk_mul_f16 v237, v203, v202
v_pk_mul_f16 v238, v200, v199
v_pk_mul_f16 v239, v197, v196
s_setprio 3
v_mfma_f32_16x16x32_f16 v[120:123], v[224:227], v[232:235], v[120:123]
ds_read_b128 v[220:223], v249 offset:44288
v_cvt_pkrtz_f16_f32 v185, v168, v169
v_cvt_pkrtz_f16_f32 v187, v170, v171
v_mfma_f32_16x16x32_f16 v[128:131], v[224:227], v[236:239], v[128:131]
v_cvt_pkrtz_f16_f32 v189, v172, v173
v_cvt_pkrtz_f16_f32 v191, v174, v175
v_mfma_f32_16x16x32_f16 v[124:127], v[228:231], v[232:235], v[124:127]
ds_read_b128 v[224:227], v248 offset:54272
v_cvt_pkrtz_f16_f32 v193, v176, v177
v_cvt_pk_f16_f32 v203, v178, v179
v_cvt_pk_f16_f32 v200, v180, v181
v_mfma_f32_16x16x32_f16 v[132:135], v[228:231], v[236:239], v[132:135]
v_cvt_pk_f16_f32 v197, v182, v183
v_pk_fma_f16 v202, v203, v203, s48
v_mfma_f32_16x16x32_bf16 v[168:171], v[240:243], v[24:27], 0
ds_read_b128 v[228:231], v249 offset:45056
v_and_b32_e64 v185, s49, v185
v_pk_fma_f16 v199, v200, v200, s48
v_mfma_f32_16x16x32_bf16 v[176:179], v[240:243], v[28:31], 0
v_and_b32 v187, s49, v187
v_pk_fma_f16 v196, v197, v197, s48
v_bfe_u32 v184, v185, 2, 14
s_waitcnt lgkmcnt(3)
v_mfma_f32_16x16x32_f16 v[136:139], v[244:247], v[232:235], v[136:139]
ds_read_b128 v[240:243], v249 offset:45312
ds_read_u16_d16 v184, v184
v_pk_mul_f16 v202, v203, v202
v_bfe_u32 v186, v187, 2, 14
v_mfma_f32_16x16x32_f16 v[144:147], v[244:247], v[236:239], v[144:147]
v_pk_mul_f16 v199, v200, v199
v_lshrrev_b32_e64 v185, 18, v185
v_mfma_f32_16x16x32_bf16 v[172:175], v[216:219], v[24:27], 0
ds_read_b128 v[244:247], v248 offset:54528
ds_read_u16_d16 v186, v186
ds_read_u16_d16_hi v185, v185
v_pk_mul_f16 v196, v197, v196
v_lshrrev_b32_e64 v187, 18, v187
v_mfma_f32_16x16x32_bf16 v[180:183], v[216:219], v[28:31], 0
v_exp_f16_e64 v201, v202
v_and_b32 v189, s49, v189
s_waitcnt lgkmcnt(5)
v_mfma_f32_16x16x32_f16 v[140:143], v[220:223], v[232:235], v[140:143]
ds_read_b128 v[216:219], v248 offset:55296
ds_read_u16_d16_hi v187, v187
v_and_b32_e64 v191, s49, v191
v_mfma_f32_16x16x32_f16 v[148:151], v[220:223], v[236:239], v[148:151]
v_exp_f16_e64 v198, v199
v_bfe_u32 v188, v189, 2, 14
v_bfe_u32 v190, v191, 2, 14
v_mfma_f32_16x16x32_bf16 v[168:171], v[224:227], v[32:35], v[168:171]
ds_read_b128 v[220:223], v248 offset:55552
ds_read_u16_d16 v188, v188
ds_read_u16_d16 v190, v190
v_exp_f16_e64 v195, v196
v_mfma_f32_16x16x32_bf16 v[176:179], v[224:227], v[36:39], v[176:179]
v_lshrrev_b32 v189, 18, v189
v_lshrrev_b32 v191, 18, v191
v_mfma_f32_16x16x32_f16 v[152:155], v[228:231], v[232:235], v[152:155]
ds_read_b128 v[224:227], v249 offset:55296
ds_read_u16_d16_hi v189, v189
ds_read_u16_d16_hi v191, v191
v_exp_f16_sdwa v201, v202 dst_sel:WORD_1 dst_unused:UNUSED_PRESERVE src0_sel:WORD_1
v_and_b32 v193, s49, v193
v_mfma_f32_16x16x32_f16 v[160:163], v[228:231], v[236:239], v[160:163]
v_bfe_u32 v192, v193, 2, 14
s_waitcnt lgkmcnt(8)
v_mfma_f32_16x16x32_f16 v[156:159], v[240:243], v[232:235], v[156:159]
ds_read_b128 v[228:231], v249 offset:55552
ds_read_u16_d16 v192, v192
v_exp_f16_sdwa v198, v199 dst_sel:WORD_1 dst_unused:UNUSED_PRESERVE src0_sel:WORD_1
v_lshrrev_b32_e64 v193, 18, v193
v_mfma_f32_16x16x32_f16 v[164:167], v[240:243], v[236:239], v[164:167]
v_exp_f16_sdwa v195, v196 dst_sel:WORD_1 dst_unused:UNUSED_PRESERVE src0_sel:WORD_1
v_pk_add_f16 v201, v201, 1.0 op_sel_hi:[1,0]
v_mfma_f32_16x16x32_bf16 v[172:175], v[244:247], v[32:35], v[172:175]
ds_read_b128 v[240:243], v248 offset:59392
ds_read_u16_d16_hi v193, v193
v_pk_add_f16 v198, v198, 1.0 op_sel_hi:[1,0]
v_pk_add_f16 v195, v195, 1.0 op_sel_hi:[1,0]
v_mfma_f32_16x16x32_bf16 v[180:183], v[244:247], v[36:39], v[180:183]
v_rcp_f16 v202, v201
s_waitcnt lgkmcnt(7)
v_mfma_f32_16x16x32_bf16 v[168:171], v[216:219], v[40:43], v[168:171]
ds_read_b128 v[244:247], v249 offset:56320
v_rcp_f16_e64 v199, v198
v_mfma_f32_16x16x32_bf16 v[176:179], v[216:219], v[44:47], v[176:179]
v_rcp_f16_e64 v196, v195
v_mfma_f32_16x16x32_bf16 v[172:175], v[220:223], v[40:43], v[172:175]
ds_read_b128 v[216:219], v248 offset:59648
v_rcp_f16_sdwa v202, v201 dst_sel:WORD_1 dst_unused:UNUSED_PRESERVE src0_sel:WORD_1
v_mfma_f32_16x16x32_bf16 v[180:183], v[220:223], v[44:47], v[180:183]
v_rcp_f16_sdwa v199, v198 dst_sel:WORD_1 dst_unused:UNUSED_PRESERVE src0_sel:WORD_1
v_or_b32 v232, v184, v185
v_or_b32 v233, v186, v187
s_waitcnt lgkmcnt(4)
v_or_b32 v234, v188, v189
v_rcp_f16_sdwa v196, v195 dst_sel:WORD_1 dst_unused:UNUSED_PRESERVE src0_sel:WORD_1
v_or_b32 v235, v190, v191
s_waitcnt lgkmcnt(2)
v_or_b32_e64 v236, v192, v193
v_pk_mul_f16 v237, v203, v202
v_pk_mul_f16 v238, v200, v199
v_pk_mul_f16 v239, v197, v196
v_mfma_f32_16x16x32_f16 v[120:123], v[224:227], v[232:235], v[120:123]
buffer_load_dwordx4 v[204:207], v252, s[4:7], s68 offen
ds_read_b128 v[220:223], v249 offset:56576
v_cvt_pkrtz_f16_f32 v185, v168, v169
v_cvt_pkrtz_f16_f32 v187, v170, v171
v_mfma_f32_16x16x32_f16 v[128:131], v[224:227], v[236:239], v[128:131]
v_cvt_pkrtz_f16_f32 v189, v172, v173
v_cvt_pkrtz_f16_f32 v191, v174, v175
v_mfma_f32_16x16x32_f16 v[124:127], v[228:231], v[232:235], v[124:127]
ds_read_b128 v[224:227], v248 offset:60416
v_cvt_pkrtz_f16_f32 v193, v176, v177
v_cvt_pk_f16_f32 v203, v178, v179
v_cvt_pk_f16_f32 v200, v180, v181
v_mfma_f32_16x16x32_f16 v[132:135], v[228:231], v[236:239], v[132:135]
v_cvt_pk_f16_f32 v197, v182, v183
v_pk_fma_f16 v202, v203, v203, s48
v_mfma_f32_16x16x32_bf16 v[168:171], v[240:243], v[24:27], 0
ds_read_b128 v[228:231], v249 offset:57344
v_and_b32_e64 v185, s49, v185
v_pk_fma_f16 v199, v200, v200, s48
v_mfma_f32_16x16x32_bf16 v[176:179], v[240:243], v[28:31], 0
v_and_b32_e64 v187, s49, v187
v_pk_fma_f16 v196, v197, v197, s48
s_setprio 2
v_bfe_u32 v184, v185, 2, 14
s_waitcnt lgkmcnt(3)
v_mfma_f32_16x16x32_f16 v[136:139], v[244:247], v[232:235], v[136:139]
ds_read_b128 v[240:243], v249 offset:57600
ds_read_u16_d16 v184, v184
v_pk_mul_f16 v202, v203, v202
v_bfe_u32 v186, v187, 2, 14
v_mfma_f32_16x16x32_f16 v[144:147], v[244:247], v[236:239], v[144:147]
v_pk_mul_f16 v199, v200, v199
v_lshrrev_b32_e64 v185, 18, v185
v_mfma_f32_16x16x32_bf16 v[172:175], v[216:219], v[24:27], 0
ds_read_b128 v[244:247], v248 offset:60672
ds_read_u16_d16 v186, v186
ds_read_u16_d16_hi v185, v185
v_pk_mul_f16 v196, v197, v196
v_lshrrev_b32_e64 v187, 18, v187
v_mfma_f32_16x16x32_bf16 v[180:183], v[216:219], v[28:31], 0
v_exp_f16_e64 v201, v202
v_and_b32 v189, s49, v189
s_waitcnt lgkmcnt(5)
v_mfma_f32_16x16x32_f16 v[140:143], v[220:223], v[232:235], v[140:143]
ds_read_b128 v[216:219], v248 offset:61440
ds_read_u16_d16_hi v187, v187
v_and_b32_e64 v191, s49, v191
v_mfma_f32_16x16x32_f16 v[148:151], v[220:223], v[236:239], v[148:151]
v_exp_f16_e64 v198, v199
v_bfe_u32 v188, v189, 2, 14
v_bfe_u32 v190, v191, 2, 14
v_mfma_f32_16x16x32_bf16 v[168:171], v[224:227], v[32:35], v[168:171]
buffer_store_dwordx4 v[80:83], v255, s[8:11], s70 offen offset:256 sc1
ds_read_b128 v[220:223], v248 offset:61696
ds_read_u16_d16 v188, v188
ds_read_u16_d16 v190, v190
v_exp_f16_e64 v195, v196
v_mfma_f32_16x16x32_bf16 v[176:179], v[224:227], v[36:39], v[176:179]
v_lshrrev_b32 v189, 18, v189
v_lshrrev_b32 v191, 18, v191
v_mfma_f32_16x16x32_f16 v[152:155], v[228:231], v[232:235], v[152:155]
ds_read_b128 v[224:227], v249 offset:61440
ds_read_u16_d16_hi v189, v189
ds_read_u16_d16_hi v191, v191
v_exp_f16_sdwa v201, v202 dst_sel:WORD_1 dst_unused:UNUSED_PRESERVE src0_sel:WORD_1
v_and_b32 v193, s49, v193
v_mfma_f32_16x16x32_f16 v[160:163], v[228:231], v[236:239], v[160:163]
v_bfe_u32 v192, v193, 2, 14
s_waitcnt lgkmcnt(8)
v_mfma_f32_16x16x32_f16 v[156:159], v[240:243], v[232:235], v[156:159]
ds_read_b128 v[228:231], v249 offset:61696
ds_read_u16_d16 v192, v192
v_exp_f16_sdwa v198, v199 dst_sel:WORD_1 dst_unused:UNUSED_PRESERVE src0_sel:WORD_1
v_lshrrev_b32_e64 v193, 18, v193
v_mfma_f32_16x16x32_f16 v[164:167], v[240:243], v[236:239], v[164:167]
v_exp_f16_sdwa v195, v196 dst_sel:WORD_1 dst_unused:UNUSED_PRESERVE src0_sel:WORD_1
v_pk_add_f16 v201, v201, 1.0 op_sel_hi:[1,0]
v_mfma_f32_16x16x32_bf16 v[172:175], v[244:247], v[32:35], v[172:175]
ds_read_b128 v[240:243], v249
ds_read_u16_d16_hi v193, v193
v_pk_add_f16 v198, v198, 1.0 op_sel_hi:[1,0]
v_pk_add_f16 v195, v195, 1.0 op_sel_hi:[1,0]
v_mfma_f32_16x16x32_bf16 v[180:183], v[244:247], v[36:39], v[180:183]
v_rcp_f16 v202, v201
s_waitcnt lgkmcnt(7)
v_mfma_f32_16x16x32_bf16 v[168:171], v[216:219], v[40:43], v[168:171]
ds_read_b128 v[244:247], v249 offset:62464
v_rcp_f16_e64 v199, v198
v_mfma_f32_16x16x32_bf16 v[176:179], v[216:219], v[44:47], v[176:179]
v_rcp_f16_e64 v196, v195
v_mfma_f32_16x16x32_bf16 v[172:175], v[220:223], v[40:43], v[172:175]
ds_read_b128 v[216:219], v249 offset:256
v_rcp_f16_sdwa v202, v201 dst_sel:WORD_1 dst_unused:UNUSED_PRESERVE src0_sel:WORD_1
v_mfma_f32_16x16x32_bf16 v[180:183], v[220:223], v[44:47], v[180:183]
v_rcp_f16_sdwa v199, v198 dst_sel:WORD_1 dst_unused:UNUSED_PRESERVE src0_sel:WORD_1
v_or_b32 v232, v184, v185
v_or_b32 v233, v186, v187
s_waitcnt lgkmcnt(4)
v_or_b32 v234, v188, v189
v_rcp_f16_sdwa v196, v195 dst_sel:WORD_1 dst_unused:UNUSED_PRESERVE src0_sel:WORD_1
v_or_b32 v235, v190, v191
s_waitcnt lgkmcnt(2)
v_or_b32_e64 v236, v192, v193
v_pk_mul_f16 v237, v203, v202
v_pk_mul_f16 v238, v200, v199
v_pk_mul_f16 v239, v197, v196
v_mfma_f32_16x16x32_f16 v[120:123], v[224:227], v[232:235], v[120:123]
buffer_load_dwordx4 v[208:211], v252, s[4:7], s68 offen offset:64
ds_read_b128 v[220:223], v249 offset:62720
v_cvt_pkrtz_f16_f32 v185, v168, v169
v_cvt_pkrtz_f16_f32 v187, v170, v171
v_mfma_f32_16x16x32_f16 v[128:131], v[224:227], v[236:239], v[128:131]
v_cvt_pkrtz_f16_f32 v189, v172, v173
v_cvt_pkrtz_f16_f32 v191, v174, v175
v_mfma_f32_16x16x32_f16 v[124:127], v[228:231], v[232:235], v[124:127]
ds_read_b128 v[224:227], v249 offset:1024
v_cvt_pkrtz_f16_f32 v193, v176, v177
v_cvt_pk_f16_f32 v203, v178, v179
v_cvt_pk_f16_f32 v200, v180, v181
v_mfma_f32_16x16x32_f16 v[132:135], v[228:231], v[236:239], v[132:135]
v_cvt_pk_f16_f32 v197, v182, v183
s_setprio 1
v_pk_fma_f16 v202, v203, v203, s48
v_mfma_f32_16x16x32_bf16 v[168:171], v[240:243], v[24:27], 0
ds_read_b128 v[228:231], v249 offset:63488
v_and_b32 v185, s49, v185
v_pk_fma_f16 v199, v200, v200, s48
v_mfma_f32_16x16x32_bf16 v[176:179], v[240:243], v[28:31], 0
v_and_b32 v187, s49, v187
v_pk_fma_f16 v196, v197, v197, s48
v_bfe_u32 v184, v185, 2, 14
s_waitcnt lgkmcnt(3)
v_mfma_f32_16x16x32_f16 v[136:139], v[244:247], v[232:235], v[136:139]
ds_read_b128 v[240:243], v249 offset:63744
ds_read_u16_d16 v184, v184
v_pk_mul_f16 v202, v203, v202
v_bfe_u32 v186, v187, 2, 14
v_mfma_f32_16x16x32_f16 v[144:147], v[244:247], v[236:239], v[144:147]
v_pk_mul_f16 v199, v200, v199
v_lshrrev_b32_e64 v185, 18, v185
v_mfma_f32_16x16x32_bf16 v[172:175], v[216:219], v[24:27], 0
ds_read_b128 v[244:247], v249 offset:1280
ds_read_u16_d16 v186, v186
ds_read_u16_d16_hi v185, v185
v_pk_mul_f16 v196, v197, v196
v_lshrrev_b32_e64 v187, 18, v187
v_mfma_f32_16x16x32_bf16 v[180:183], v[216:219], v[28:31], 0
v_exp_f16_e64 v201, v202
v_and_b32 v189, s49, v189
s_waitcnt lgkmcnt(5)
v_mfma_f32_16x16x32_f16 v[140:143], v[220:223], v[232:235], v[140:143]
ds_read_b128 v[216:219], v249 offset:2048
ds_read_u16_d16_hi v187, v187
v_and_b32_e64 v191, s49, v191
v_mfma_f32_16x16x32_f16 v[148:151], v[220:223], v[236:239], v[148:151]
v_exp_f16_e64 v198, v199
v_bfe_u32 v188, v189, 2, 14
v_bfe_u32 v190, v191, 2, 14
v_mfma_f32_16x16x32_bf16 v[168:171], v[224:227], v[32:35], v[168:171]
ds_read_b128 v[220:223], v249 offset:2304
ds_read_u16_d16 v188, v188
ds_read_u16_d16 v190, v190
v_exp_f16_e64 v195, v196
v_mfma_f32_16x16x32_bf16 v[176:179], v[224:227], v[36:39], v[176:179]
v_lshrrev_b32 v189, 18, v189
v_lshrrev_b32 v191, 18, v191
v_mfma_f32_16x16x32_f16 v[152:155], v[228:231], v[232:235], v[152:155]
ds_read_b128 v[224:227], v250 offset:2048
ds_read_u16_d16_hi v189, v189
ds_read_u16_d16_hi v191, v191
v_exp_f16_sdwa v201, v202 dst_sel:WORD_1 dst_unused:UNUSED_PRESERVE src0_sel:WORD_1
v_and_b32 v193, s49, v193
v_mfma_f32_16x16x32_f16 v[160:163], v[228:231], v[236:239], v[160:163]
v_bfe_u32 v192, v193, 2, 14
s_waitcnt lgkmcnt(8)
v_mfma_f32_16x16x32_f16 v[156:159], v[240:243], v[232:235], v[156:159]
ds_read_b128 v[228:231], v250 offset:2304
ds_read_u16_d16 v192, v192
v_exp_f16_sdwa v198, v199 dst_sel:WORD_1 dst_unused:UNUSED_PRESERVE src0_sel:WORD_1
v_lshrrev_b32_e64 v193, 18, v193
v_mfma_f32_16x16x32_f16 v[164:167], v[240:243], v[236:239], v[164:167]
v_exp_f16_sdwa v195, v196 dst_sel:WORD_1 dst_unused:UNUSED_PRESERVE src0_sel:WORD_1
v_pk_add_f16 v201, v201, 1.0 op_sel_hi:[1,0]
v_mfma_f32_16x16x32_bf16 v[172:175], v[244:247], v[32:35], v[172:175]
ds_read_b128 v[240:243], v249 offset:6144
ds_read_u16_d16_hi v193, v193
v_pk_add_f16 v198, v198, 1.0 op_sel_hi:[1,0]
v_pk_add_f16 v195, v195, 1.0 op_sel_hi:[1,0]
v_mfma_f32_16x16x32_bf16 v[180:183], v[244:247], v[36:39], v[180:183]
v_rcp_f16_e64 v202, v201
s_setprio 0
s_waitcnt lgkmcnt(7)
v_mfma_f32_16x16x32_bf16 v[168:171], v[216:219], v[40:43], v[168:171]
ds_read_b128 v[244:247], v250 offset:3072
v_rcp_f16_e64 v199, v198
v_mfma_f32_16x16x32_bf16 v[176:179], v[216:219], v[44:47], v[176:179]
v_rcp_f16_e64 v196, v195
v_mfma_f32_16x16x32_bf16 v[172:175], v[220:223], v[40:43], v[172:175]
ds_read_b128 v[216:219], v249 offset:6400
v_rcp_f16_sdwa v202, v201 dst_sel:WORD_1 dst_unused:UNUSED_PRESERVE src0_sel:WORD_1
v_mfma_f32_16x16x32_bf16 v[180:183], v[220:223], v[44:47], v[180:183]
v_rcp_f16_sdwa v199, v198 dst_sel:WORD_1 dst_unused:UNUSED_PRESERVE src0_sel:WORD_1
v_or_b32 v232, v184, v185
v_or_b32 v233, v186, v187
s_waitcnt lgkmcnt(4)
v_or_b32 v234, v188, v189
v_rcp_f16_sdwa v196, v195 dst_sel:WORD_1 dst_unused:UNUSED_PRESERVE src0_sel:WORD_1
v_or_b32 v235, v190, v191
s_waitcnt lgkmcnt(2)
v_or_b32 v236, v192, v193
v_pk_mul_f16 v237, v203, v202
v_pk_mul_f16 v238, v200, v199
v_pk_mul_f16 v239, v197, v196
s_setprio 3
v_mfma_f32_16x16x32_f16 v[120:123], v[224:227], v[232:235], v[120:123]
ds_read_b128 v[220:223], v250 offset:3328
v_cvt_pkrtz_f16_f32 v185, v168, v169
v_cvt_pkrtz_f16_f32 v187, v170, v171
v_cvt_pkrtz_f16_f32 v189, v172, v173
v_mfma_f32_16x16x32_f16 v[128:131], v[224:227], v[236:239], v[128:131]
v_cvt_pkrtz_f16_f32 v191, v174, v175
v_cvt_pkrtz_f16_f32 v193, v176, v177
v_cvt_pk_f16_f32 v203, v178, v179
v_mfma_f32_16x16x32_f16 v[124:127], v[228:231], v[232:235], v[124:127]
ds_read_b128 v[224:227], v249 offset:7168
v_cvt_pk_f16_f32 v200, v180, v181
v_cvt_pk_f16_f32 v197, v182, v183
v_pk_fma_f16 v202, v203, v203, s48
v_cvt_pk_bf16_f32 v72, v72, v73
v_mfma_f32_16x16x32_f16 v[132:135], v[228:231], v[236:239], v[132:135]
v_and_b32_e64 v185, s49, v185
v_cvt_pk_bf16_f32 v73, v74, v75
v_pk_fma_f16 v199, v200, v200, s48
v_mfma_f32_16x16x32_bf16 v[168:171], v[240:243], v[24:27], 0
ds_read_b128 v[228:231], v250 offset:4096
v_and_b32 v187, s49, v187
v_cvt_pk_bf16_f32 v74, v76, v77
v_pk_fma_f16 v196, v197, v197, s48
v_mfma_f32_16x16x32_bf16 v[176:179], v[240:243], v[28:31], 0
v_cvt_pk_bf16_f32 v75, v78, v79
v_bfe_u32 v184, v185, 2, 14
v_pk_mul_f16 v202, v203, v202
v_cvt_pk_bf16_f32 v56, v56, v57
s_waitcnt lgkmcnt(2)
v_mfma_f32_16x16x32_f16 v[136:139], v[244:247], v[232:235], v[136:139]
ds_read_b128 v[240:243], v250 offset:4352
ds_read_u16_d16 v184, v184
v_bfe_u32 v186, v187, 2, 14
v_cvt_pk_bf16_f32 v57, v58, v59
v_pk_mul_f16 v199, v200, v199
v_mfma_f32_16x16x32_f16 v[144:147], v[244:247], v[236:239], v[144:147]
v_lshrrev_b32_e64 v185, 18, v185
v_cvt_pk_bf16_f32 v58, v60, v61
v_pk_mul_f16 v196, v197, v196
v_mfma_f32_16x16x32_bf16 v[172:175], v[216:219], v[24:27], 0
ds_read_b128 v[244:247], v249 offset:7424
ds_read_u16_d16 v186, v186
ds_read_u16_d16_hi v185, v185
v_lshrrev_b32_e64 v187, 18, v187
v_cvt_pk_bf16_f32 v59, v62, v63
v_exp_f16_e64 v201, v202
v_mfma_f32_16x16x32_bf16 v[180:183], v[216:219], v[28:31], 0
v_cvt_pk_bf16_f32 v88, v88, v89
v_and_b32_e64 v189, s49, v189
v_cvt_pk_bf16_f32 v89, v90, v91
v_mfma_f32_16x16x32_f16 v[140:143], v[220:223], v[232:235], v[140:143]
ds_read_b128 v[216:219], v249 offset:8192
ds_read_u16_d16_hi v187, v187
v_and_b32_e64 v191, s49, v191
v_cvt_pk_bf16_f32 v90, v92, v93
v_mfma_f32_16x16x32_f16 v[148:151], v[220:223], v[236:239], v[148:151]
v_exp_f16_e64 v198, v199
v_cvt_pk_bf16_f32 v91, v94, v95
s_mov_b64 vcc, s[74:75]
v_bfe_u32 v188, v189, 2, 14
v_bfe_u32 v190, v191, 2, 14
s_waitcnt lgkmcnt(5)
v_mfma_f32_16x16x32_bf16 v[168:171], v[224:227], v[32:35], v[168:171]
ds_read_b128 v[220:223], v249 offset:8448
ds_read_u16_d16 v188, v188
ds_read_u16_d16 v190, v190
v_cndmask_b32 v76, v56, v88, vcc
v_exp_f16 v195, v196
v_mfma_f32_16x16x32_bf16 v[176:179], v[224:227], v[36:39], v[176:179]
v_cndmask_b32 v77, v57, v89, vcc
v_lshrrev_b32_e64 v189, 18, v189
v_cndmask_b32 v78, v58, v90, vcc
v_mfma_f32_16x16x32_f16 v[152:155], v[228:231], v[232:235], v[152:155]
ds_read_b128 v[224:227], v250 offset:8192
ds_read_u16_d16_hi v189, v189
v_lshrrev_b32 v191, 18, v191
v_cndmask_b32 v79, v59, v91, vcc
v_exp_f16_sdwa v201, v202 dst_sel:WORD_1 dst_unused:UNUSED_PRESERVE src0_sel:WORD_1
v_mfma_f32_16x16x32_f16 v[160:163], v[228:231], v[236:239], v[160:163]
v_cndmask_b32_dpp v56, v72, v56, vcc quad_perm:[1,0,3,2] row_mask:0xf bank_mask:0xf
v_and_b32_e64 v193, s49, v193
v_cndmask_b32_dpp v57, v73, v57, vcc quad_perm:[1,0,3,2] row_mask:0xf bank_mask:0xf
v_mfma_f32_16x16x32_f16 v[156:159], v[240:243], v[232:235], v[156:159]
ds_read_b128 v[228:231], v250 offset:8448
ds_read_u16_d16_hi v191, v191
v_bfe_u32 v192, v193, 2, 14
v_exp_f16_sdwa v198, v199 dst_sel:WORD_1 dst_unused:UNUSED_PRESERVE src0_sel:WORD_1
v_mfma_f32_16x16x32_f16 v[164:167], v[240:243], v[236:239], v[164:167]
v_cndmask_b32_dpp v58, v74, v58, vcc quad_perm:[1,0,3,2] row_mask:0xf bank_mask:0xf
v_lshrrev_b32_e64 v193, 18, v193
v_cndmask_b32_dpp v59, v75, v59, vcc quad_perm:[1,0,3,2] row_mask:0xf bank_mask:0xf
s_not_b64 vcc, s[74:75]
s_waitcnt lgkmcnt(4)
v_mfma_f32_16x16x32_bf16 v[172:175], v[244:247], v[32:35], v[172:175]
ds_read_b128 v[240:243], v249 offset:12288
ds_read_u16_d16 v192, v192
ds_read_u16_d16_hi v193, v193
v_exp_f16_sdwa v195, v196 dst_sel:WORD_1 dst_unused:UNUSED_PRESERVE src0_sel:WORD_1
v_cndmask_b32_dpp v88, v72, v88, vcc quad_perm:[1,0,3,2] row_mask:0xf bank_mask:0xf
v_pk_add_f16 v201, v201, 1.0 op_sel_hi:[1,0]
v_mfma_f32_16x16x32_bf16 v[180:183], v[244:247], v[36:39], v[180:183]
v_cndmask_b32_dpp v89, v73, v89, vcc quad_perm:[1,0,3,2] row_mask:0xf bank_mask:0xf
v_pk_add_f16 v198, v198, 1.0 op_sel_hi:[1,0]
v_cndmask_b32_dpp v90, v74, v90, vcc quad_perm:[1,0,3,2] row_mask:0xf bank_mask:0xf
v_mfma_f32_16x16x32_bf16 v[168:171], v[216:219], v[40:43], v[168:171]
ds_read_b128 v[244:247], v250 offset:9216
v_pk_add_f16 v195, v195, 1.0 op_sel_hi:[1,0]
v_rcp_f16_e64 v202, v201
v_cndmask_b32_dpp v91, v75, v91, vcc quad_perm:[1,0,3,2] row_mask:0xf bank_mask:0xf
v_mfma_f32_16x16x32_bf16 v[176:179], v[216:219], v[44:47], v[176:179]
v_rcp_f16_e64 v199, v198
v_mfma_f32_16x16x32_bf16 v[172:175], v[220:223], v[40:43], v[172:175]
ds_read_b128 v[216:219], v249 offset:12544
s_add_u32 s46, s70, 98304
buffer_store_dwordx4 v[56:59], v255, s[8:11], s46 offen sc1
v_rcp_f16_e64 v196, v195
v_rcp_f16_sdwa v202, v201 dst_sel:WORD_1 dst_unused:UNUSED_PRESERVE src0_sel:WORD_1
v_mfma_f32_16x16x32_bf16 v[180:183], v[220:223], v[44:47], v[180:183]
v_rcp_f16_sdwa v199, v198 dst_sel:WORD_1 dst_unused:UNUSED_PRESERVE src0_sel:WORD_1
v_or_b32 v232, v184, v185
v_or_b32 v233, v186, v187
s_waitcnt lgkmcnt(2)
v_or_b32 v234, v188, v189
v_rcp_f16_sdwa v196, v195 dst_sel:WORD_1 dst_unused:UNUSED_PRESERVE src0_sel:WORD_1
v_or_b32 v235, v190, v191
v_or_b32 v236, v192, v193
v_pk_mul_f16 v237, v203, v202
v_pk_mul_f16 v238, v200, v199
v_pk_mul_f16 v239, v197, v196
v_mfma_f32_16x16x32_f16 v[120:123], v[224:227], v[232:235], v[120:123]
buffer_load_dwordx4 v[12:15], v252, s[4:7], s68 offen offset:128
ds_read_b128 v[220:223], v250 offset:9472
v_cvt_pkrtz_f16_f32 v185, v168, v169
v_cvt_pkrtz_f16_f32 v187, v170, v171
v_mfma_f32_16x16x32_f16 v[128:131], v[224:227], v[236:239], v[128:131]
v_cvt_pkrtz_f16_f32 v189, v172, v173
v_cvt_pkrtz_f16_f32 v191, v174, v175
v_mfma_f32_16x16x32_f16 v[124:127], v[228:231], v[232:235], v[124:127]
ds_read_b128 v[224:227], v249 offset:13312
v_cvt_pkrtz_f16_f32 v193, v176, v177
v_cvt_pk_f16_f32 v203, v178, v179
v_cvt_pk_f16_f32 v200, v180, v181
v_mfma_f32_16x16x32_f16 v[132:135], v[228:231], v[236:239], v[132:135]
v_cvt_pk_f16_f32 v197, v182, v183
v_pk_fma_f16 v202, v203, v203, s48
v_mfma_f32_16x16x32_bf16 v[168:171], v[240:243], v[24:27], 0
ds_read_b128 v[228:231], v250 offset:10240
v_and_b32_e64 v185, s49, v185
v_pk_fma_f16 v199, v200, v200, s48
v_mfma_f32_16x16x32_bf16 v[176:179], v[240:243], v[28:31], 0
v_and_b32_e64 v187, s49, v187
v_pk_fma_f16 v196, v197, v197, s48
s_setprio 2
v_bfe_u32 v184, v185, 2, 14
s_waitcnt lgkmcnt(3)
v_mfma_f32_16x16x32_f16 v[136:139], v[244:247], v[232:235], v[136:139]
ds_read_b128 v[240:243], v250 offset:10496
ds_read_u16_d16 v184, v184
v_pk_mul_f16 v202, v203, v202
v_bfe_u32 v186, v187, 2, 14
v_mfma_f32_16x16x32_f16 v[144:147], v[244:247], v[236:239], v[144:147]
v_pk_mul_f16 v199, v200, v199
v_lshrrev_b32_e64 v185, 18, v185
v_mfma_f32_16x16x32_bf16 v[172:175], v[216:219], v[24:27], 0
ds_read_b128 v[244:247], v249 offset:13568
ds_read_u16_d16 v186, v186
ds_read_u16_d16_hi v185, v185
v_pk_mul_f16 v196, v197, v196
v_lshrrev_b32_e64 v187, 18, v187
v_mfma_f32_16x16x32_bf16 v[180:183], v[216:219], v[28:31], 0
v_exp_f16_e64 v201, v202
v_and_b32 v189, s49, v189
s_waitcnt lgkmcnt(5)
v_mfma_f32_16x16x32_f16 v[140:143], v[220:223], v[232:235], v[140:143]
ds_read_b128 v[216:219], v249 offset:14336
ds_read_u16_d16_hi v187, v187
v_and_b32_e64 v191, s49, v191
v_mfma_f32_16x16x32_f16 v[148:151], v[220:223], v[236:239], v[148:151]
v_exp_f16_e64 v198, v199
v_bfe_u32 v188, v189, 2, 14
v_bfe_u32 v190, v191, 2, 14
v_mfma_f32_16x16x32_bf16 v[168:171], v[224:227], v[32:35], v[168:171]
ds_read_b128 v[220:223], v249 offset:14592
ds_read_u16_d16 v188, v188
ds_read_u16_d16 v190, v190
v_exp_f16_e64 v195, v196
v_mfma_f32_16x16x32_bf16 v[176:179], v[224:227], v[36:39], v[176:179]
v_lshrrev_b32 v189, 18, v189
v_lshrrev_b32 v191, 18, v191
v_mfma_f32_16x16x32_f16 v[152:155], v[228:231], v[232:235], v[152:155]
ds_read_b128 v[224:227], v250 offset:14336
ds_read_u16_d16_hi v189, v189
ds_read_u16_d16_hi v191, v191
v_exp_f16_sdwa v201, v202 dst_sel:WORD_1 dst_unused:UNUSED_PRESERVE src0_sel:WORD_1
v_and_b32 v193, s49, v193
v_mfma_f32_16x16x32_f16 v[160:163], v[228:231], v[236:239], v[160:163]
v_bfe_u32 v192, v193, 2, 14
s_waitcnt lgkmcnt(8)
v_mfma_f32_16x16x32_f16 v[156:159], v[240:243], v[232:235], v[156:159]
ds_read_b128 v[228:231], v250 offset:14592
ds_read_u16_d16 v192, v192
v_exp_f16_sdwa v198, v199 dst_sel:WORD_1 dst_unused:UNUSED_PRESERVE src0_sel:WORD_1
v_lshrrev_b32_e64 v193, 18, v193
v_mfma_f32_16x16x32_f16 v[164:167], v[240:243], v[236:239], v[164:167]
v_exp_f16_sdwa v195, v196 dst_sel:WORD_1 dst_unused:UNUSED_PRESERVE src0_sel:WORD_1
v_pk_add_f16 v201, v201, 1.0 op_sel_hi:[1,0]
v_mfma_f32_16x16x32_bf16 v[172:175], v[244:247], v[32:35], v[172:175]
ds_read_b128 v[240:243], v249 offset:18432
ds_read_u16_d16_hi v193, v193
v_pk_add_f16 v198, v198, 1.0 op_sel_hi:[1,0]
v_pk_add_f16 v195, v195, 1.0 op_sel_hi:[1,0]
v_mfma_f32_16x16x32_bf16 v[180:183], v[244:247], v[36:39], v[180:183]
v_rcp_f16 v202, v201
s_waitcnt lgkmcnt(7)
v_mfma_f32_16x16x32_bf16 v[168:171], v[216:219], v[40:43], v[168:171]
ds_read_b128 v[244:247], v250 offset:15360
v_rcp_f16_e64 v199, v198
v_mfma_f32_16x16x32_bf16 v[176:179], v[216:219], v[44:47], v[176:179]
v_rcp_f16_e64 v196, v195
v_mfma_f32_16x16x32_bf16 v[172:175], v[220:223], v[40:43], v[172:175]
ds_read_b128 v[216:219], v249 offset:18688
v_rcp_f16_sdwa v202, v201 dst_sel:WORD_1 dst_unused:UNUSED_PRESERVE src0_sel:WORD_1
v_mfma_f32_16x16x32_bf16 v[180:183], v[220:223], v[44:47], v[180:183]
v_rcp_f16_sdwa v199, v198 dst_sel:WORD_1 dst_unused:UNUSED_PRESERVE src0_sel:WORD_1
v_or_b32 v232, v184, v185
v_or_b32 v233, v186, v187
s_waitcnt lgkmcnt(4)
v_or_b32 v234, v188, v189
v_rcp_f16_sdwa v196, v195 dst_sel:WORD_1 dst_unused:UNUSED_PRESERVE src0_sel:WORD_1
v_or_b32 v235, v190, v191
s_waitcnt lgkmcnt(2)
v_or_b32_e64 v236, v192, v193
v_pk_mul_f16 v237, v203, v202
v_pk_mul_f16 v238, v200, v199
v_pk_mul_f16 v239, v197, v196
v_mfma_f32_16x16x32_f16 v[120:123], v[224:227], v[232:235], v[120:123]
s_add_u32 s46, s68, 98304
buffer_load_dwordx4 v[8:11], v252, s[4:7], s46 offen
ds_read_b128 v[220:223], v250 offset:15616
v_cvt_pkrtz_f16_f32 v185, v168, v169
v_cvt_pkrtz_f16_f32 v187, v170, v171
v_mfma_f32_16x16x32_f16 v[128:131], v[224:227], v[236:239], v[128:131]
v_cvt_pkrtz_f16_f32 v189, v172, v173
v_cvt_pkrtz_f16_f32 v191, v174, v175
v_mfma_f32_16x16x32_f16 v[124:127], v[228:231], v[232:235], v[124:127]
ds_read_b128 v[224:227], v249 offset:19456
v_cvt_pkrtz_f16_f32 v193, v176, v177
v_cvt_pk_f16_f32 v203, v178, v179
v_cvt_pk_f16_f32 v200, v180, v181
v_mfma_f32_16x16x32_f16 v[132:135], v[228:231], v[236:239], v[132:135]
v_cvt_pk_f16_f32 v197, v182, v183
s_setprio 1
v_pk_fma_f16 v202, v203, v203, s48
v_mfma_f32_16x16x32_bf16 v[168:171], v[240:243], v[24:27], 0
ds_read_b128 v[228:231], v250 offset:16384
v_and_b32 v185, s49, v185
v_pk_fma_f16 v199, v200, v200, s48
v_mfma_f32_16x16x32_bf16 v[176:179], v[240:243], v[28:31], 0
v_and_b32 v187, s49, v187
v_pk_fma_f16 v196, v197, v197, s48
v_bfe_u32 v184, v185, 2, 14
s_waitcnt lgkmcnt(3)
v_mfma_f32_16x16x32_f16 v[136:139], v[244:247], v[232:235], v[136:139]
ds_read_b128 v[240:243], v250 offset:16640
ds_read_u16_d16 v184, v184
v_pk_mul_f16 v202, v203, v202
v_bfe_u32 v186, v187, 2, 14
v_mfma_f32_16x16x32_f16 v[144:147], v[244:247], v[236:239], v[144:147]
v_pk_mul_f16 v199, v200, v199
v_lshrrev_b32_e64 v185, 18, v185
v_mfma_f32_16x16x32_bf16 v[172:175], v[216:219], v[24:27], 0
ds_read_b128 v[244:247], v249 offset:19712
ds_read_u16_d16 v186, v186
ds_read_u16_d16_hi v185, v185
v_pk_mul_f16 v196, v197, v196
v_lshrrev_b32_e64 v187, 18, v187
v_mfma_f32_16x16x32_bf16 v[180:183], v[216:219], v[28:31], 0
v_exp_f16_e64 v201, v202
v_and_b32 v189, s49, v189
s_waitcnt lgkmcnt(5)
v_mfma_f32_16x16x32_f16 v[140:143], v[220:223], v[232:235], v[140:143]
ds_read_b128 v[216:219], v249 offset:20480
ds_read_u16_d16_hi v187, v187
v_and_b32_e64 v191, s49, v191
v_mfma_f32_16x16x32_f16 v[148:151], v[220:223], v[236:239], v[148:151]
v_exp_f16_e64 v198, v199
v_bfe_u32 v188, v189, 2, 14
v_bfe_u32 v190, v191, 2, 14
v_mfma_f32_16x16x32_bf16 v[168:171], v[224:227], v[32:35], v[168:171]
s_add_u32 s46, s70, 98304
buffer_store_dwordx4 v[76:79], v255, s[8:11], s46 offen offset:128 sc1
ds_read_b128 v[220:223], v249 offset:20736
ds_read_u16_d16 v188, v188
ds_read_u16_d16 v190, v190
v_exp_f16_e64 v195, v196
v_mfma_f32_16x16x32_bf16 v[176:179], v[224:227], v[36:39], v[176:179]
v_lshrrev_b32 v189, 18, v189
v_lshrrev_b32 v191, 18, v191
v_mfma_f32_16x16x32_f16 v[152:155], v[228:231], v[232:235], v[152:155]
ds_read_b128 v[224:227], v250 offset:20480
ds_read_u16_d16_hi v189, v189
ds_read_u16_d16_hi v191, v191
v_exp_f16_sdwa v201, v202 dst_sel:WORD_1 dst_unused:UNUSED_PRESERVE src0_sel:WORD_1
v_and_b32 v193, s49, v193
v_mfma_f32_16x16x32_f16 v[160:163], v[228:231], v[236:239], v[160:163]
v_bfe_u32 v192, v193, 2, 14
s_waitcnt lgkmcnt(7)
v_mfma_f32_16x16x32_f16 v[156:159], v[240:243], v[232:235], v[156:159]
ds_read_b128 v[228:231], v250 offset:20736
ds_read_u16_d16 v192, v192
v_exp_f16_sdwa v198, v199 dst_sel:WORD_1 dst_unused:UNUSED_PRESERVE src0_sel:WORD_1
v_lshrrev_b32_e64 v193, 18, v193
v_mfma_f32_16x16x32_f16 v[164:167], v[240:243], v[236:239], v[164:167]
v_exp_f16_sdwa v195, v196 dst_sel:WORD_1 dst_unused:UNUSED_PRESERVE src0_sel:WORD_1
v_pk_add_f16 v201, v201, 1.0 op_sel_hi:[1,0]
v_mfma_f32_16x16x32_bf16 v[172:175], v[244:247], v[32:35], v[172:175]
ds_read_b128 v[240:243], v248 offset:16384
ds_read_u16_d16_hi v193, v193
v_pk_add_f16 v198, v198, 1.0 op_sel_hi:[1,0]
v_pk_add_f16 v195, v195, 1.0 op_sel_hi:[1,0]
v_mfma_f32_16x16x32_bf16 v[180:183], v[244:247], v[36:39], v[180:183]
v_rcp_f16 v202, v201
s_setprio 0
v_mfma_f32_16x16x32_bf16 v[168:171], v[216:219], v[40:43], v[168:171]
ds_read_b128 v[244:247], v250 offset:21504
v_rcp_f16_e64 v199, v198
v_mfma_f32_16x16x32_bf16 v[176:179], v[216:219], v[44:47], v[176:179]
v_rcp_f16 v196, v195
s_waitcnt lgkmcnt(5)
v_mfma_f32_16x16x32_bf16 v[172:175], v[220:223], v[40:43], v[172:175]
ds_read_b128 v[216:219], v248 offset:16640
v_rcp_f16_sdwa v202, v201 dst_sel:WORD_1 dst_unused:UNUSED_PRESERVE src0_sel:WORD_1
v_mfma_f32_16x16x32_bf16 v[180:183], v[220:223], v[44:47], v[180:183]
v_rcp_f16_sdwa v199, v198 dst_sel:WORD_1 dst_unused:UNUSED_PRESERVE src0_sel:WORD_1
v_or_b32 v232, v184, v185
v_or_b32 v233, v186, v187
v_or_b32_e64 v234, v188, v189
v_rcp_f16_sdwa v196, v195 dst_sel:WORD_1 dst_unused:UNUSED_PRESERVE src0_sel:WORD_1
v_or_b32 v235, v190, v191
s_waitcnt lgkmcnt(2)
v_or_b32 v236, v192, v193
v_pk_mul_f16 v237, v203, v202
v_pk_mul_f16 v238, v200, v199
v_pk_mul_f16 v239, v197, v196
s_setprio 3
v_mfma_f32_16x16x32_f16 v[120:123], v[224:227], v[232:235], v[120:123]
ds_read_b128 v[220:223], v250 offset:21760
v_cvt_pkrtz_f16_f32 v185, v168, v169
v_cvt_pkrtz_f16_f32 v187, v170, v171
v_mfma_f32_16x16x32_f16 v[128:131], v[224:227], v[236:239], v[128:131]
v_cvt_pkrtz_f16_f32 v189, v172, v173
v_cvt_pkrtz_f16_f32 v191, v174, v175
v_mfma_f32_16x16x32_f16 v[124:127], v[228:231], v[232:235], v[124:127]
ds_read_b128 v[224:227], v248 offset:17408
v_cvt_pkrtz_f16_f32 v193, v176, v177
v_cvt_pk_f16_f32 v203, v178, v179
v_cvt_pk_f16_f32 v200, v180, v181
v_mfma_f32_16x16x32_f16 v[132:135], v[228:231], v[236:239], v[132:135]
v_cvt_pk_f16_f32 v197, v182, v183
v_pk_fma_f16 v202, v203, v203, s48
s_waitcnt vmcnt(14)
v_mfma_f32_16x16x32_bf16 v[168:171], v[240:243], v[96:99], 0
ds_read_b128 v[228:231], v250 offset:22528
v_and_b32_e64 v185, s49, v185
v_pk_fma_f16 v199, v200, v200, s48
s_waitcnt vmcnt(13)
v_mfma_f32_16x16x32_bf16 v[176:179], v[240:243], v[100:103], 0
v_and_b32 v187, s49, v187
v_pk_fma_f16 v196, v197, v197, s48
v_bfe_u32 v184, v185, 2, 14
s_waitcnt lgkmcnt(3)
v_mfma_f32_16x16x32_f16 v[136:139], v[244:247], v[232:235], v[136:139]
ds_read_b128 v[240:243], v250 offset:22784
ds_read_u16_d16 v184, v184
v_pk_mul_f16 v202, v203, v202
v_bfe_u32 v186, v187, 2, 14
v_mfma_f32_16x16x32_f16 v[144:147], v[244:247], v[236:239], v[144:147]
v_pk_mul_f16 v199, v200, v199
v_lshrrev_b32_e64 v185, 18, v185
v_mfma_f32_16x16x32_bf16 v[172:175], v[216:219], v[96:99], 0
ds_read_b128 v[244:247], v248 offset:17664
ds_read_u16_d16 v186, v186
ds_read_u16_d16_hi v185, v185
v_pk_mul_f16 v196, v197, v196
v_lshrrev_b32_e64 v187, 18, v187
v_mfma_f32_16x16x32_bf16 v[180:183], v[216:219], v[100:103], 0
v_exp_f16_e64 v201, v202
v_and_b32 v189, s49, v189
s_waitcnt lgkmcnt(5)
v_mfma_f32_16x16x32_f16 v[140:143], v[220:223], v[232:235], v[140:143]
ds_read_b128 v[216:219], v248 offset:18432
ds_read_u16_d16_hi v187, v187
v_and_b32_e64 v191, s49, v191
v_mfma_f32_16x16x32_f16 v[148:151], v[220:223], v[236:239], v[148:151]
v_exp_f16 v198, v199
v_bfe_u32 v188, v189, 2, 14
v_bfe_u32 v190, v191, 2, 14
s_waitcnt vmcnt(12)
v_mfma_f32_16x16x32_bf16 v[168:171], v[224:227], v[104:107], v[168:171]
ds_read_b128 v[220:223], v248 offset:18688
ds_read_u16_d16 v188, v188
ds_read_u16_d16 v190, v190
v_exp_f16 v195, v196
s_waitcnt vmcnt(11)
v_mfma_f32_16x16x32_bf16 v[176:179], v[224:227], v[108:111], v[176:179]
v_lshrrev_b32 v189, 18, v189
v_lshrrev_b32 v191, 18, v191
v_mfma_f32_16x16x32_f16 v[152:155], v[228:231], v[232:235], v[152:155]
ds_read_b128 v[224:227], v250 offset:26624
ds_read_u16_d16_hi v189, v189
ds_read_u16_d16_hi v191, v191
v_exp_f16_sdwa v201, v202 dst_sel:WORD_1 dst_unused:UNUSED_PRESERVE src0_sel:WORD_1
v_and_b32 v193, s49, v193
v_mfma_f32_16x16x32_f16 v[160:163], v[228:231], v[236:239], v[160:163]
v_bfe_u32 v192, v193, 2, 14
s_waitcnt lgkmcnt(7)
v_mfma_f32_16x16x32_f16 v[156:159], v[240:243], v[232:235], v[156:159]
ds_read_b128 v[228:231], v250 offset:26880
ds_read_u16_d16 v192, v192
v_exp_f16_sdwa v198, v199 dst_sel:WORD_1 dst_unused:UNUSED_PRESERVE src0_sel:WORD_1
v_lshrrev_b32_e64 v193, 18, v193
v_mfma_f32_16x16x32_f16 v[164:167], v[240:243], v[236:239], v[164:167]
v_exp_f16_sdwa v195, v196 dst_sel:WORD_1 dst_unused:UNUSED_PRESERVE src0_sel:WORD_1
v_pk_add_f16 v201, v201, 1.0 op_sel_hi:[1,0]
v_mfma_f32_16x16x32_bf16 v[172:175], v[244:247], v[104:107], v[172:175]
ds_read_b128 v[240:243], v248 offset:22528
ds_read_u16_d16_hi v193, v193
v_pk_add_f16 v198, v198, 1.0 op_sel_hi:[1,0]
v_pk_add_f16 v195, v195, 1.0 op_sel_hi:[1,0]
v_mfma_f32_16x16x32_bf16 v[180:183], v[244:247], v[108:111], v[180:183]
v_rcp_f16 v202, v201
s_waitcnt vmcnt(10)
v_mfma_f32_16x16x32_bf16 v[168:171], v[216:219], v[112:115], v[168:171]
ds_read_b128 v[244:247], v250 offset:27648
v_rcp_f16 v199, v198
s_waitcnt vmcnt(7)
v_mfma_f32_16x16x32_bf16 v[176:179], v[216:219], v[116:119], v[176:179]
v_rcp_f16 v196, v195
s_waitcnt lgkmcnt(5)
v_mfma_f32_16x16x32_bf16 v[172:175], v[220:223], v[112:115], v[172:175]
ds_read_b128 v[216:219], v248 offset:22784
v_rcp_f16_sdwa v202, v201 dst_sel:WORD_1 dst_unused:UNUSED_PRESERVE src0_sel:WORD_1
v_mfma_f32_16x16x32_bf16 v[180:183], v[220:223], v[116:119], v[180:183]
v_rcp_f16_sdwa v199, v198 dst_sel:WORD_1 dst_unused:UNUSED_PRESERVE src0_sel:WORD_1
v_or_b32 v232, v184, v185
v_or_b32 v233, v186, v187
v_or_b32_e64 v234, v188, v189
v_rcp_f16_sdwa v196, v195 dst_sel:WORD_1 dst_unused:UNUSED_PRESERVE src0_sel:WORD_1
v_or_b32 v235, v190, v191
s_waitcnt lgkmcnt(2)
v_or_b32_e64 v236, v192, v193
v_pk_mul_f16 v237, v203, v202
v_pk_mul_f16 v238, v200, v199
v_pk_mul_f16 v239, v197, v196
v_mfma_f32_16x16x32_f16 v[120:123], v[224:227], v[232:235], v[120:123]
s_add_u32 s46, s68, 98304
buffer_load_dwordx4 v[44:47], v252, s[4:7], s46 offen offset:64
ds_read_b128 v[220:223], v250 offset:27904
v_cvt_pkrtz_f16_f32 v185, v168, v169
v_cvt_pkrtz_f16_f32 v187, v170, v171
v_mfma_f32_16x16x32_f16 v[128:131], v[224:227], v[236:239], v[128:131]
v_cvt_pkrtz_f16_f32 v189, v172, v173
v_cvt_pkrtz_f16_f32 v191, v174, v175
v_mfma_f32_16x16x32_f16 v[124:127], v[228:231], v[232:235], v[124:127]
ds_read_b128 v[224:227], v248 offset:23552
v_cvt_pkrtz_f16_f32 v193, v176, v177
v_cvt_pk_f16_f32 v203, v178, v179
v_mfma_f32_16x16x32_f16 v[132:135], v[228:231], v[236:239], v[132:135]
v_cvt_pk_f16_f32 v200, v180, v181
v_cvt_pk_f16_f32 v197, v182, v183
v_mfma_f32_16x16x32_bf16 v[168:171], v[240:243], v[96:99], 0
ds_read_b128 v[228:231], v250 offset:28672
v_pk_fma_f16 v202, v203, v203, s48
v_and_b32_e64 v185, s49, v185
v_mfma_f32_16x16x32_bf16 v[176:179], v[240:243], v[100:103], 0
v_pk_fma_f16 v199, v200, v200, s48
v_and_b32 v187, s49, v187
s_waitcnt lgkmcnt(3)
v_mfma_f32_16x16x32_f16 v[136:139], v[244:247], v[232:235], v[136:139]
ds_read_b128 v[240:243], v250 offset:28928
v_pk_fma_f16 v196, v197, v197, s48
s_setprio 2
v_bfe_u32 v184, v185, 2, 14
v_pk_mul_f16 v202, v203, v202
v_mfma_f32_16x16x32_f16 v[144:147], v[244:247], v[236:239], v[144:147]
v_bfe_u32 v186, v187, 2, 14
v_pk_mul_f16 v199, v200, v199
s_waitcnt vmcnt(7)
v_mfma_f32_16x16x32_bf16 v[120:123], v[18:21], v[204:207], v[120:123]
ds_read_b128 v[244:247], v248 offset:23808
ds_read_u16_d16 v184, v184
ds_read_u16_d16 v186, v186
v_lshrrev_b32_e64 v185, 18, v185
v_pk_mul_f16 v196, v197, v196
v_mfma_f32_16x16x32_bf16 v[124:127], v[16:19], v[204:207], v[124:127]
v_lshrrev_b32_e64 v187, 18, v187
v_mfma_f32_16x16x32_bf16 v[172:175], v[216:219], v[96:99], 0
ds_read_u16_d16_hi v185, v185
ds_read_u16_d16_hi v187, v187
v_exp_f16 v201, v202
v_and_b32 v189, s49, v189
v_mfma_f32_16x16x32_bf16 v[180:183], v[216:219], v[100:103], 0
v_and_b32 v191, s49, v191
s_waitcnt lgkmcnt(6)
v_mfma_f32_16x16x32_f16 v[140:143], v[220:223], v[232:235], v[140:143]
ds_read_b128 v[216:219], v248 offset:24576
v_exp_f16_e64 v198, v199
v_bfe_u32 v188, v189, 2, 14
v_mfma_f32_16x16x32_f16 v[148:151], v[220:223], v[236:239], v[148:151]
v_bfe_u32 v190, v191, 2, 14
v_exp_f16_e64 v195, v196
v_mfma_f32_16x16x32_bf16 v[168:171], v[224:227], v[104:107], v[168:171]
s_add_u32 s46, s70, 98304
buffer_store_dwordx4 v[88:91], v255, s[8:11], s46 offen offset:256 sc1
ds_read_b128 v[220:223], v248 offset:24832
ds_read_u16_d16 v188, v188
ds_read_u16_d16 v190, v190
v_lshrrev_b32 v189, 18, v189
v_lshrrev_b32 v191, 18, v191
v_mfma_f32_16x16x32_bf16 v[176:179], v[224:227], v[108:111], v[176:179]
v_exp_f16_sdwa v201, v202 dst_sel:WORD_1 dst_unused:UNUSED_PRESERVE src0_sel:WORD_1
v_mfma_f32_16x16x32_f16 v[152:155], v[228:231], v[232:235], v[152:155]
ds_read_b128 v[224:227], v249 offset:24576
ds_read_u16_d16_hi v189, v189
ds_read_u16_d16_hi v191, v191
v_and_b32 v193, s49, v193
v_bfe_u32 v192, v193, 2, 14
v_mfma_f32_16x16x32_f16 v[160:163], v[228:231], v[236:239], v[160:163]
v_exp_f16_sdwa v198, v199 dst_sel:WORD_1 dst_unused:UNUSED_PRESERVE src0_sel:WORD_1
s_waitcnt lgkmcnt(7)
v_mfma_f32_16x16x32_f16 v[156:159], v[240:243], v[232:235], v[156:159]
ds_read_b128 v[228:231], v254 offset:7936
ds_read_u16_d16 v192, v192
v_lshrrev_b32_e64 v193, 18, v193
v_mfma_f32_16x16x32_f16 v[164:167], v[240:243], v[236:239], v[164:167]
v_exp_f16_sdwa v195, v196 dst_sel:WORD_1 dst_unused:UNUSED_PRESERVE src0_sel:WORD_1
v_pk_add_f16 v201, v201, 1.0 op_sel_hi:[1,0]
v_pk_add_f16 v198, v198, 1.0 op_sel_hi:[1,0]
v_mfma_f32_16x16x32_bf16 v[172:175], v[244:247], v[104:107], v[172:175]
ds_read_b128 v[240:243], v249 offset:24832
ds_read_u16_d16_hi v193, v193
v_pk_add_f16 v195, v195, 1.0 op_sel_hi:[1,0]
v_mfma_f32_16x16x32_bf16 v[180:183], v[244:247], v[108:111], v[180:183]
v_rcp_f16 v202, v201
s_waitcnt lgkmcnt(7)
v_mfma_f32_16x16x32_bf16 v[168:171], v[216:219], v[112:115], v[168:171]
ds_read_b128 v[244:247], v254 offset:7952
v_rcp_f16_e64 v199, v198
v_mfma_f32_16x16x32_bf16 v[176:179], v[216:219], v[116:119], v[176:179]
v_rcp_f16_e64 v196, v195
v_mfma_f32_16x16x32_bf16 v[172:175], v[220:223], v[112:115], v[172:175]
ds_read_b128 v[216:219], v248 offset:28672
v_rcp_f16_sdwa v202, v201 dst_sel:WORD_1 dst_unused:UNUSED_PRESERVE src0_sel:WORD_1
v_mfma_f32_16x16x32_bf16 v[180:183], v[220:223], v[116:119], v[180:183]
v_rcp_f16_sdwa v199, v198 dst_sel:WORD_1 dst_unused:UNUSED_PRESERVE src0_sel:WORD_1
v_or_b32 v232, v184, v185
v_or_b32 v233, v186, v187
s_waitcnt lgkmcnt(4)
v_or_b32 v234, v188, v189
v_rcp_f16_sdwa v196, v195 dst_sel:WORD_1 dst_unused:UNUSED_PRESERVE src0_sel:WORD_1
v_or_b32 v235, v190, v191
s_waitcnt lgkmcnt(2)
v_or_b32 v236, v192, v193
v_pk_mul_f16 v237, v203, v202
v_pk_mul_f16 v238, v200, v199
v_pk_mul_f16 v239, v197, v196
v_mfma_f32_16x16x32_f16 v[48:51], v[224:227], v[232:235], v[228:231]
ds_read_b128 v[220:223], v249 offset:25600
v_cvt_pkrtz_f16_f32 v185, v168, v169
v_cvt_pkrtz_f16_f32 v187, v170, v171
v_mfma_f32_16x16x32_f16 v[56:59], v[224:227], v[236:239], v[228:231]
v_cvt_pkrtz_f16_f32 v189, v172, v173
v_cvt_pkrtz_f16_f32 v191, v174, v175
s_waitcnt lgkmcnt(2)
v_mfma_f32_16x16x32_f16 v[52:55], v[240:243], v[232:235], v[244:247]
ds_read_b128 v[224:227], v254 offset:8064
ds_read_b128 v[228:231], v248 offset:28928
v_cvt_pkrtz_f16_f32 v193, v176, v177
v_cvt_pk_f16_f32 v203, v178, v179
v_mfma_f32_16x16x32_f16 v[60:63], v[240:243], v[236:239], v[244:247]
v_cvt_pk_f16_f32 v200, v180, v181
v_cvt_pk_f16_f32 v197, v182, v183
s_setprio 1
s_waitcnt lgkmcnt(3)
v_mfma_f32_16x16x32_bf16 v[168:171], v[216:219], v[96:99], 0
ds_read_b128 v[240:243], v249 offset:25856
ds_read_b128 v[244:247], v254 offset:8080
v_pk_fma_f16 v202, v203, v203, s48
v_and_b32_e64 v185, s49, v185
v_mfma_f32_16x16x32_bf16 v[176:179], v[216:219], v[100:103], 0
v_pk_fma_f16 v199, v200, v200, s48
v_and_b32 v187, s49, v187
s_waitcnt lgkmcnt(3)
v_mfma_f32_16x16x32_f16 v[64:67], v[220:223], v[232:235], v[224:227]
ds_read_b128 v[216:219], v248 offset:29696
v_pk_fma_f16 v196, v197, v197, s48
v_bfe_u32 v184, v185, 2, 14
v_pk_mul_f16 v202, v203, v202
v_mfma_f32_16x16x32_f16 v[72:75], v[220:223], v[236:239], v[224:227]
v_bfe_u32 v186, v187, 2, 14
v_pk_mul_f16 v199, v200, v199
s_waitcnt vmcnt(6)
v_mfma_f32_16x16x32_bf16 v[136:139], v[18:21], v[208:211], v[136:139]
ds_read_b128 v[220:223], v249 offset:26624
ds_read_b128 v[224:227], v254 offset:16128
ds_read_u16_d16 v184, v184
ds_read_u16_d16 v186, v186
v_lshrrev_b32 v185, 18, v185
v_pk_mul_f16 v196, v197, v196
v_mfma_f32_16x16x32_bf16 v[140:143], v[16:19], v[208:211], v[140:143]
v_lshrrev_b32 v187, 18, v187
s_waitcnt lgkmcnt(5)
v_mfma_f32_16x16x32_bf16 v[172:175], v[228:231], v[96:99], 0
ds_read_u16_d16_hi v185, v185
ds_read_u16_d16_hi v187, v187
v_exp_f16 v201, v202
v_and_b32 v189, s49, v189
v_mfma_f32_16x16x32_bf16 v[180:183], v[228:231], v[100:103], 0
v_and_b32_e64 v191, s49, v191
v_mfma_f32_16x16x32_f16 v[68:71], v[240:243], v[232:235], v[244:247]
ds_read_b128 v[228:231], v249 offset:26880
v_exp_f16_e64 v198, v199
v_bfe_u32 v188, v189, 2, 14
v_mfma_f32_16x16x32_f16 v[76:79], v[240:243], v[236:239], v[244:247]
v_bfe_u32 v190, v191, 2, 14
v_exp_f16 v195, v196
s_waitcnt lgkmcnt(7)
v_mfma_f32_16x16x32_bf16 v[168:171], v[216:219], v[104:107], v[168:171]
ds_read_b128 v[240:243], v254 offset:16144
ds_read_b128 v[244:247], v248 offset:29952
ds_read_u16_d16 v188, v188
ds_read_u16_d16 v190, v190
v_lshrrev_b32_e64 v189, 18, v189
v_lshrrev_b32 v191, 18, v191
v_mfma_f32_16x16x32_bf16 v[176:179], v[216:219], v[108:111], v[176:179]
v_exp_f16_sdwa v201, v202 dst_sel:WORD_1 dst_unused:UNUSED_PRESERVE src0_sel:WORD_1
s_waitcnt lgkmcnt(7)
v_mfma_f32_16x16x32_f16 v[80:83], v[220:223], v[232:235], v[224:227]
ds_read_b128 v[216:219], v248 offset:30720
ds_read_u16_d16_hi v189, v189
ds_read_u16_d16_hi v191, v191
v_and_b32 v193, s49, v193
v_bfe_u32 v192, v193, 2, 14
v_mfma_f32_16x16x32_f16 v[88:91], v[220:223], v[236:239], v[224:227]
v_exp_f16_sdwa v198, v199 dst_sel:WORD_1 dst_unused:UNUSED_PRESERVE src0_sel:WORD_1
s_waitcnt lgkmcnt(6)
v_mfma_f32_16x16x32_f16 v[84:87], v[228:231], v[232:235], v[240:243]
ds_read_b128 v[220:223], v248 offset:30976
ds_read_b128 v[224:227], v249 offset:30720
ds_read_u16_d16 v192, v192
v_lshrrev_b32 v193, 18, v193
v_mfma_f32_16x16x32_f16 v[92:95], v[228:231], v[236:239], v[240:243]
v_exp_f16_sdwa v195, v196 dst_sel:WORD_1 dst_unused:UNUSED_PRESERVE src0_sel:WORD_1
v_pk_add_f16 v201, v201, 1.0 op_sel_hi:[1,0]
v_pk_add_f16 v198, v198, 1.0 op_sel_hi:[1,0]
s_waitcnt lgkmcnt(7)
v_mfma_f32_16x16x32_bf16 v[172:175], v[244:247], v[104:107], v[172:175]
ds_read_b128 v[228:231], v249 offset:30976
ds_read_b128 v[240:243], v248 offset:34816
ds_read_u16_d16_hi v193, v193
v_pk_add_f16 v195, v195, 1.0 op_sel_hi:[1,0]
v_mfma_f32_16x16x32_bf16 v[180:183], v[244:247], v[108:111], v[180:183]
v_rcp_f16_e64 v202, v201
s_setprio 0
s_waitcnt lgkmcnt(7)
v_mfma_f32_16x16x32_bf16 v[168:171], v[216:219], v[112:115], v[168:171]
ds_read_b128 v[244:247], v249 offset:31744
v_rcp_f16_e64 v199, v198
v_mfma_f32_16x16x32_bf16 v[176:179], v[216:219], v[116:119], v[176:179]
v_rcp_f16 v196, v195
s_waitcnt lgkmcnt(6)
v_mfma_f32_16x16x32_bf16 v[172:175], v[220:223], v[112:115], v[172:175]
ds_read_b128 v[216:219], v248 offset:35072
v_rcp_f16_sdwa v202, v201 dst_sel:WORD_1 dst_unused:UNUSED_PRESERVE src0_sel:WORD_1
v_mfma_f32_16x16x32_bf16 v[180:183], v[220:223], v[116:119], v[180:183]
v_rcp_f16_sdwa v199, v198 dst_sel:WORD_1 dst_unused:UNUSED_PRESERVE src0_sel:WORD_1
v_or_b32 v232, v184, v185
v_or_b32 v233, v186, v187
v_or_b32_e64 v234, v188, v189
v_rcp_f16_sdwa v196, v195 dst_sel:WORD_1 dst_unused:UNUSED_PRESERVE src0_sel:WORD_1
v_or_b32 v235, v190, v191
s_waitcnt lgkmcnt(2)
v_or_b32 v236, v192, v193
v_pk_mul_f16 v237, v203, v202
v_pk_mul_f16 v238, v200, v199
v_pk_mul_f16 v239, v197, v196
s_setprio 3
v_mfma_f32_16x16x32_f16 v[48:51], v[224:227], v[232:235], v[48:51]
s_add_u32 s46, s68, 98304
buffer_load_dwordx4 v[208:211], v252, s[4:7], s46 offen offset:128
ds_read_b128 v[220:223], v249 offset:32000
v_cvt_pkrtz_f16_f32 v185, v168, v169
v_cvt_pkrtz_f16_f32 v187, v170, v171
v_mfma_f32_16x16x32_f16 v[56:59], v[224:227], v[236:239], v[56:59]
v_cvt_pkrtz_f16_f32 v189, v172, v173
v_cvt_pkrtz_f16_f32 v191, v174, v175
v_mfma_f32_16x16x32_f16 v[52:55], v[228:231], v[232:235], v[52:55]
ds_read_b128 v[224:227], v248 offset:35840
v_cvt_pkrtz_f16_f32 v193, v176, v177
v_cvt_pk_f16_f32 v203, v178, v179
v_mfma_f32_16x16x32_f16 v[60:63], v[228:231], v[236:239], v[60:63]
v_cvt_pk_f16_f32 v200, v180, v181
v_cvt_pk_f16_f32 v197, v182, v183
v_mfma_f32_16x16x32_bf16 v[168:171], v[240:243], v[96:99], 0
ds_read_b128 v[228:231], v249 offset:32768
v_pk_fma_f16 v202, v203, v203, s48
v_and_b32_e64 v185, s49, v185
v_mfma_f32_16x16x32_bf16 v[176:179], v[240:243], v[100:103], 0
v_pk_fma_f16 v199, v200, v200, s48
v_and_b32 v187, s49, v187
s_waitcnt lgkmcnt(3)
v_mfma_f32_16x16x32_f16 v[64:67], v[244:247], v[232:235], v[64:67]
ds_read_b128 v[240:243], v249 offset:33024
v_pk_fma_f16 v196, v197, v197, s48
v_bfe_u32 v184, v185, 2, 14
v_pk_mul_f16 v202, v203, v202
v_mfma_f32_16x16x32_f16 v[72:75], v[244:247], v[236:239], v[72:75]
v_bfe_u32 v186, v187, 2, 14
v_pk_mul_f16 v199, v200, v199
s_waitcnt vmcnt(5)
v_mfma_f32_16x16x32_bf16 v[152:155], v[18:21], v[12:15], v[152:155]
ds_read_b128 v[244:247], v248 offset:36096
ds_read_u16_d16 v184, v184
ds_read_u16_d16 v186, v186
v_lshrrev_b32 v185, 18, v185
v_pk_mul_f16 v196, v197, v196
v_mfma_f32_16x16x32_bf16 v[156:159], v[16:19], v[12:15], v[156:159]
v_lshrrev_b32_e64 v187, 18, v187
v_mfma_f32_16x16x32_bf16 v[172:175], v[216:219], v[96:99], 0
ds_read_u16_d16_hi v185, v185
ds_read_u16_d16_hi v187, v187
v_exp_f16 v201, v202
v_and_b32 v189, s49, v189
v_mfma_f32_16x16x32_bf16 v[180:183], v[216:219], v[100:103], 0
v_and_b32 v191, s49, v191
s_waitcnt lgkmcnt(6)
v_mfma_f32_16x16x32_f16 v[68:71], v[220:223], v[232:235], v[68:71]
ds_read_b128 v[216:219], v248 offset:36864
v_exp_f16_e64 v198, v199
v_bfe_u32 v188, v189, 2, 14
v_mfma_f32_16x16x32_f16 v[76:79], v[220:223], v[236:239], v[76:79]
v_bfe_u32 v190, v191, 2, 14
v_exp_f16_e64 v195, v196
v_mfma_f32_16x16x32_bf16 v[168:171], v[224:227], v[104:107], v[168:171]
ds_read_b128 v[220:223], v248 offset:37120
ds_read_u16_d16 v188, v188
ds_read_u16_d16 v190, v190
v_lshrrev_b32 v189, 18, v189
v_lshrrev_b32 v191, 18, v191
v_mfma_f32_16x16x32_bf16 v[176:179], v[224:227], v[108:111], v[176:179]
v_exp_f16_sdwa v201, v202 dst_sel:WORD_1 dst_unused:UNUSED_PRESERVE src0_sel:WORD_1
v_mfma_f32_16x16x32_f16 v[80:83], v[228:231], v[232:235], v[80:83]
ds_read_b128 v[224:227], v249 offset:36864
ds_read_u16_d16_hi v189, v189
ds_read_u16_d16_hi v191, v191
v_and_b32 v193, s49, v193
v_bfe_u32 v192, v193, 2, 14
v_mfma_f32_16x16x32_f16 v[88:91], v[228:231], v[236:239], v[88:91]
v_exp_f16_sdwa v198, v199 dst_sel:WORD_1 dst_unused:UNUSED_PRESERVE src0_sel:WORD_1
s_waitcnt lgkmcnt(7)
v_mfma_f32_16x16x32_f16 v[84:87], v[240:243], v[232:235], v[84:87]
ds_read_b128 v[228:231], v249 offset:37120
ds_read_u16_d16 v192, v192
v_lshrrev_b32_e64 v193, 18, v193
v_mfma_f32_16x16x32_f16 v[92:95], v[240:243], v[236:239], v[92:95]
v_exp_f16_sdwa v195, v196 dst_sel:WORD_1 dst_unused:UNUSED_PRESERVE src0_sel:WORD_1
v_pk_add_f16 v201, v201, 1.0 op_sel_hi:[1,0]
v_pk_add_f16 v198, v198, 1.0 op_sel_hi:[1,0]
v_mfma_f32_16x16x32_bf16 v[172:175], v[244:247], v[104:107], v[172:175]
ds_read_b128 v[240:243], v248 offset:40960
ds_read_u16_d16_hi v193, v193
v_pk_add_f16 v195, v195, 1.0 op_sel_hi:[1,0]
v_mfma_f32_16x16x32_bf16 v[180:183], v[244:247], v[108:111], v[180:183]
v_rcp_f16 v202, v201
s_waitcnt lgkmcnt(7)
v_mfma_f32_16x16x32_bf16 v[168:171], v[216:219], v[112:115], v[168:171]
ds_read_b128 v[244:247], v249 offset:37888
v_rcp_f16_e64 v199, v198
v_mfma_f32_16x16x32_bf16 v[176:179], v[216:219], v[116:119], v[176:179]
v_rcp_f16_e64 v196, v195
v_mfma_f32_16x16x32_bf16 v[172:175], v[220:223], v[112:115], v[172:175]
ds_read_b128 v[216:219], v248 offset:41216
v_rcp_f16_sdwa v202, v201 dst_sel:WORD_1 dst_unused:UNUSED_PRESERVE src0_sel:WORD_1
v_mfma_f32_16x16x32_bf16 v[180:183], v[220:223], v[116:119], v[180:183]
v_rcp_f16_sdwa v199, v198 dst_sel:WORD_1 dst_unused:UNUSED_PRESERVE src0_sel:WORD_1
v_or_b32 v232, v184, v185
v_or_b32 v233, v186, v187
s_waitcnt lgkmcnt(4)
v_or_b32 v234, v188, v189
v_rcp_f16_sdwa v196, v195 dst_sel:WORD_1 dst_unused:UNUSED_PRESERVE src0_sel:WORD_1
v_or_b32 v235, v190, v191
s_waitcnt lgkmcnt(2)
v_or_b32_e64 v236, v192, v193
v_pk_mul_f16 v237, v203, v202
v_pk_mul_f16 v238, v200, v199
v_pk_mul_f16 v239, v197, v196
v_mfma_f32_16x16x32_f16 v[48:51], v[224:227], v[232:235], v[48:51]
buffer_load_dwordx4 v[12:15], v252, s[4:7], s69 offen
ds_read_b128 v[220:223], v249 offset:38144
v_cvt_pkrtz_f16_f32 v185, v168, v169
v_cvt_pkrtz_f16_f32 v187, v170, v171
v_cvt_pkrtz_f16_f32 v189, v172, v173
v_mfma_f32_16x16x32_f16 v[56:59], v[224:227], v[236:239], v[56:59]
v_cvt_pkrtz_f16_f32 v191, v174, v175
v_cvt_pkrtz_f16_f32 v193, v176, v177
v_cvt_pk_f16_f32 v203, v178, v179
v_mfma_f32_16x16x32_f16 v[52:55], v[228:231], v[232:235], v[52:55]
ds_read_b128 v[224:227], v248 offset:41984
v_cvt_pk_f16_f32 v200, v180, v181
v_cvt_pk_f16_f32 v197, v182, v183
v_pk_fma_f16 v202, v203, v203, s48
v_cvt_pk_bf16_f32 v136, v136, v137
v_mfma_f32_16x16x32_f16 v[60:63], v[228:231], v[236:239], v[60:63]
v_and_b32_e64 v185, s49, v185
v_cvt_pk_bf16_f32 v137, v138, v139
v_pk_fma_f16 v199, v200, v200, s48
v_mfma_f32_16x16x32_bf16 v[168:171], v[240:243], v[96:99], 0
ds_read_b128 v[228:231], v249 offset:38912
v_and_b32_e64 v187, s49, v187
v_cvt_pk_bf16_f32 v138, v140, v141
v_pk_fma_f16 v196, v197, v197, s48
v_mfma_f32_16x16x32_bf16 v[176:179], v[240:243], v[100:103], 0
v_cvt_pk_bf16_f32 v139, v142, v143
v_bfe_u32 v184, v185, 2, 14
s_setprio 2
v_pk_mul_f16 v202, v203, v202
v_cvt_pk_bf16_f32 v120, v120, v121
s_waitcnt lgkmcnt(2)
v_mfma_f32_16x16x32_f16 v[64:67], v[244:247], v[232:235], v[64:67]
ds_read_b128 v[240:243], v249 offset:39168
ds_read_u16_d16 v184, v184
v_bfe_u32 v186, v187, 2, 14
v_cvt_pk_bf16_f32 v121, v122, v123
v_pk_mul_f16 v199, v200, v199
v_mfma_f32_16x16x32_f16 v[72:75], v[244:247], v[236:239], v[72:75]
v_lshrrev_b32_e64 v185, 18, v185
v_cvt_pk_bf16_f32 v122, v124, v125
v_pk_mul_f16 v196, v197, v196
v_mfma_f32_16x16x32_bf16 v[172:175], v[216:219], v[96:99], 0
ds_read_b128 v[244:247], v248 offset:42240
ds_read_u16_d16 v186, v186
ds_read_u16_d16_hi v185, v185
v_lshrrev_b32_e64 v187, 18, v187
v_cvt_pk_bf16_f32 v123, v126, v127
v_exp_f16_e64 v201, v202
v_mfma_f32_16x16x32_bf16 v[180:183], v[216:219], v[100:103], 0
v_cvt_pk_bf16_f32 v152, v152, v153
v_and_b32_e64 v189, s49, v189
v_cvt_pk_bf16_f32 v153, v154, v155
v_mfma_f32_16x16x32_f16 v[68:71], v[220:223], v[232:235], v[68:71]
ds_read_b128 v[216:219], v248 offset:43008
ds_read_u16_d16_hi v187, v187
v_and_b32_e64 v191, s49, v191
v_cvt_pk_bf16_f32 v154, v156, v157
v_mfma_f32_16x16x32_f16 v[76:79], v[220:223], v[236:239], v[76:79]
v_exp_f16_e64 v198, v199
v_cvt_pk_bf16_f32 v155, v158, v159
s_mov_b64 vcc, s[74:75]
v_bfe_u32 v188, v189, 2, 14
v_bfe_u32 v190, v191, 2, 14
s_waitcnt lgkmcnt(5)
v_mfma_f32_16x16x32_bf16 v[168:171], v[224:227], v[104:107], v[168:171]
ds_read_b128 v[220:223], v248 offset:43264
ds_read_u16_d16 v188, v188
ds_read_u16_d16 v190, v190
v_cndmask_b32 v140, v120, v152, vcc
v_exp_f16 v195, v196
v_mfma_f32_16x16x32_bf16 v[176:179], v[224:227], v[108:111], v[176:179]
v_cndmask_b32 v141, v121, v153, vcc
v_lshrrev_b32_e64 v189, 18, v189
v_cndmask_b32 v142, v122, v154, vcc
v_mfma_f32_16x16x32_f16 v[80:83], v[228:231], v[232:235], v[80:83]
ds_read_b128 v[224:227], v249 offset:43008
ds_read_u16_d16_hi v189, v189
v_lshrrev_b32 v191, 18, v191
v_cndmask_b32 v143, v123, v155, vcc
v_exp_f16_sdwa v201, v202 dst_sel:WORD_1 dst_unused:UNUSED_PRESERVE src0_sel:WORD_1
v_mfma_f32_16x16x32_f16 v[88:91], v[228:231], v[236:239], v[88:91]
v_cndmask_b32_dpp v120, v136, v120, vcc quad_perm:[1,0,3,2] row_mask:0xf bank_mask:0xf
v_and_b32_e64 v193, s49, v193
v_cndmask_b32_dpp v121, v137, v121, vcc quad_perm:[1,0,3,2] row_mask:0xf bank_mask:0xf
v_mfma_f32_16x16x32_f16 v[84:87], v[240:243], v[232:235], v[84:87]
ds_read_b128 v[228:231], v249 offset:43264
ds_read_u16_d16_hi v191, v191
v_bfe_u32 v192, v193, 2, 14
v_exp_f16_sdwa v198, v199 dst_sel:WORD_1 dst_unused:UNUSED_PRESERVE src0_sel:WORD_1
v_mfma_f32_16x16x32_f16 v[92:95], v[240:243], v[236:239], v[92:95]
v_cndmask_b32_dpp v122, v138, v122, vcc quad_perm:[1,0,3,2] row_mask:0xf bank_mask:0xf
v_lshrrev_b32_e64 v193, 18, v193
v_cndmask_b32_dpp v123, v139, v123, vcc quad_perm:[1,0,3,2] row_mask:0xf bank_mask:0xf
s_not_b64 vcc, s[74:75]
s_waitcnt lgkmcnt(4)
v_mfma_f32_16x16x32_bf16 v[172:175], v[244:247], v[104:107], v[172:175]
ds_read_b128 v[240:243], v248 offset:47104
ds_read_u16_d16 v192, v192
ds_read_u16_d16_hi v193, v193
v_exp_f16_sdwa v195, v196 dst_sel:WORD_1 dst_unused:UNUSED_PRESERVE src0_sel:WORD_1
v_cndmask_b32_dpp v152, v136, v152, vcc quad_perm:[1,0,3,2] row_mask:0xf bank_mask:0xf
v_pk_add_f16 v201, v201, 1.0 op_sel_hi:[1,0]
v_mfma_f32_16x16x32_bf16 v[180:183], v[244:247], v[108:111], v[180:183]
v_cndmask_b32_dpp v153, v137, v153, vcc quad_perm:[1,0,3,2] row_mask:0xf bank_mask:0xf
v_pk_add_f16 v198, v198, 1.0 op_sel_hi:[1,0]
v_cndmask_b32_dpp v154, v138, v154, vcc quad_perm:[1,0,3,2] row_mask:0xf bank_mask:0xf
v_mfma_f32_16x16x32_bf16 v[168:171], v[216:219], v[112:115], v[168:171]
ds_read_b128 v[244:247], v249 offset:44032
v_pk_add_f16 v195, v195, 1.0 op_sel_hi:[1,0]
v_rcp_f16_e64 v202, v201
v_cndmask_b32_dpp v155, v139, v155, vcc quad_perm:[1,0,3,2] row_mask:0xf bank_mask:0xf
v_mfma_f32_16x16x32_bf16 v[176:179], v[216:219], v[116:119], v[176:179]
v_rcp_f16_e64 v199, v198
v_mfma_f32_16x16x32_bf16 v[172:175], v[220:223], v[112:115], v[172:175]
ds_read_b128 v[216:219], v248 offset:47360
buffer_store_dwordx4 v[120:123], v255, s[8:11], s68 offen sc1
v_rcp_f16_e64 v196, v195
v_rcp_f16_sdwa v202, v201 dst_sel:WORD_1 dst_unused:UNUSED_PRESERVE src0_sel:WORD_1
v_mfma_f32_16x16x32_bf16 v[180:183], v[220:223], v[116:119], v[180:183]
v_rcp_f16_sdwa v199, v198 dst_sel:WORD_1 dst_unused:UNUSED_PRESERVE src0_sel:WORD_1
v_or_b32 v232, v184, v185
v_or_b32 v233, v186, v187
s_waitcnt lgkmcnt(3)
v_or_b32 v234, v188, v189
v_rcp_f16_sdwa v196, v195 dst_sel:WORD_1 dst_unused:UNUSED_PRESERVE src0_sel:WORD_1
v_or_b32 v235, v190, v191
s_waitcnt lgkmcnt(2)
v_or_b32_e64 v236, v192, v193
v_pk_mul_f16 v237, v203, v202
v_pk_mul_f16 v238, v200, v199
v_pk_mul_f16 v239, v197, v196
v_mfma_f32_16x16x32_f16 v[48:51], v[224:227], v[232:235], v[48:51]
buffer_load_dwordx4 v[204:207], v252, s[4:7], s69 offen offset:64
ds_read_b128 v[220:223], v249 offset:44288
v_cvt_pkrtz_f16_f32 v185, v168, v169
v_cvt_pkrtz_f16_f32 v187, v170, v171
v_mfma_f32_16x16x32_f16 v[56:59], v[224:227], v[236:239], v[56:59]
v_cvt_pkrtz_f16_f32 v189, v172, v173
v_cvt_pkrtz_f16_f32 v191, v174, v175
v_mfma_f32_16x16x32_f16 v[52:55], v[228:231], v[232:235], v[52:55]
ds_read_b128 v[224:227], v248 offset:48128
v_cvt_pkrtz_f16_f32 v193, v176, v177
v_cvt_pk_f16_f32 v203, v178, v179
v_mfma_f32_16x16x32_f16 v[60:63], v[228:231], v[236:239], v[60:63]
v_cvt_pk_f16_f32 v200, v180, v181
v_cvt_pk_f16_f32 v197, v182, v183
s_setprio 1
v_mfma_f32_16x16x32_bf16 v[168:171], v[240:243], v[96:99], 0
ds_read_b128 v[228:231], v249 offset:45056
v_pk_fma_f16 v202, v203, v203, s48
v_and_b32 v185, s49, v185
v_mfma_f32_16x16x32_bf16 v[176:179], v[240:243], v[100:103], 0
v_pk_fma_f16 v199, v200, v200, s48
v_and_b32 v187, s49, v187
s_waitcnt lgkmcnt(3)
v_mfma_f32_16x16x32_f16 v[64:67], v[244:247], v[232:235], v[64:67]
ds_read_b128 v[240:243], v249 offset:45312
v_pk_fma_f16 v196, v197, v197, s48
v_bfe_u32 v184, v185, 2, 14
v_pk_mul_f16 v202, v203, v202
v_mfma_f32_16x16x32_f16 v[72:75], v[244:247], v[236:239], v[72:75]
v_bfe_u32 v186, v187, 2, 14
v_pk_mul_f16 v199, v200, v199
s_waitcnt vmcnt(7)
v_mfma_f32_16x16x32_bf16 v[128:131], v[18:21], v[8:11], v[128:131]
ds_read_b128 v[244:247], v248 offset:48384
ds_read_u16_d16 v184, v184
ds_read_u16_d16 v186, v186
v_lshrrev_b32 v185, 18, v185
v_pk_mul_f16 v196, v197, v196
v_mfma_f32_16x16x32_bf16 v[132:135], v[16:19], v[8:11], v[132:135]
v_lshrrev_b32_e64 v187, 18, v187
v_mfma_f32_16x16x32_bf16 v[172:175], v[216:219], v[96:99], 0
ds_read_u16_d16_hi v185, v185
ds_read_u16_d16_hi v187, v187
v_exp_f16 v201, v202
v_and_b32 v189, s49, v189
v_mfma_f32_16x16x32_bf16 v[180:183], v[216:219], v[100:103], 0
v_and_b32 v191, s49, v191
s_waitcnt lgkmcnt(6)
v_mfma_f32_16x16x32_f16 v[68:71], v[220:223], v[232:235], v[68:71]
ds_read_b128 v[216:219], v248 offset:49152
v_exp_f16_e64 v198, v199
v_bfe_u32 v188, v189, 2, 14
v_mfma_f32_16x16x32_f16 v[76:79], v[220:223], v[236:239], v[76:79]
v_bfe_u32 v190, v191, 2, 14
v_exp_f16_e64 v195, v196
v_mfma_f32_16x16x32_bf16 v[168:171], v[224:227], v[104:107], v[168:171]
buffer_store_dwordx4 v[140:143], v255, s[8:11], s68 offen offset:128 sc1
ds_read_b128 v[220:223], v248 offset:49408
ds_read_u16_d16 v188, v188
ds_read_u16_d16 v190, v190
v_lshrrev_b32 v189, 18, v189
v_lshrrev_b32 v191, 18, v191
v_mfma_f32_16x16x32_bf16 v[176:179], v[224:227], v[108:111], v[176:179]
v_exp_f16_sdwa v201, v202 dst_sel:WORD_1 dst_unused:UNUSED_PRESERVE src0_sel:WORD_1
v_mfma_f32_16x16x32_f16 v[80:83], v[228:231], v[232:235], v[80:83]
ds_read_b128 v[224:227], v249 offset:49152
ds_read_u16_d16_hi v189, v189
ds_read_u16_d16_hi v191, v191
v_and_b32 v193, s49, v193
v_bfe_u32 v192, v193, 2, 14
v_mfma_f32_16x16x32_f16 v[88:91], v[228:231], v[236:239], v[88:91]
v_exp_f16_sdwa v198, v199 dst_sel:WORD_1 dst_unused:UNUSED_PRESERVE src0_sel:WORD_1
s_waitcnt lgkmcnt(7)
v_mfma_f32_16x16x32_f16 v[84:87], v[240:243], v[232:235], v[84:87]
ds_read_b128 v[228:231], v249 offset:49408
ds_read_u16_d16 v192, v192
v_lshrrev_b32_e64 v193, 18, v193
v_mfma_f32_16x16x32_f16 v[92:95], v[240:243], v[236:239], v[92:95]
v_exp_f16_sdwa v195, v196 dst_sel:WORD_1 dst_unused:UNUSED_PRESERVE src0_sel:WORD_1
v_pk_add_f16 v201, v201, 1.0 op_sel_hi:[1,0]
v_pk_add_f16 v198, v198, 1.0 op_sel_hi:[1,0]
v_mfma_f32_16x16x32_bf16 v[172:175], v[244:247], v[104:107], v[172:175]
ds_read_b128 v[240:243], v248 offset:53248
ds_read_u16_d16_hi v193, v193
v_pk_add_f16 v195, v195, 1.0 op_sel_hi:[1,0]
v_mfma_f32_16x16x32_bf16 v[180:183], v[244:247], v[108:111], v[180:183]
v_rcp_f16_e64 v202, v201
s_setprio 0
s_waitcnt lgkmcnt(7)
v_mfma_f32_16x16x32_bf16 v[168:171], v[216:219], v[112:115], v[168:171]
ds_read_b128 v[244:247], v249 offset:50176
v_rcp_f16_e64 v199, v198
v_mfma_f32_16x16x32_bf16 v[176:179], v[216:219], v[116:119], v[176:179]
v_rcp_f16_e64 v196, v195
v_mfma_f32_16x16x32_bf16 v[172:175], v[220:223], v[112:115], v[172:175]
ds_read_b128 v[216:219], v248 offset:53504
v_rcp_f16_sdwa v202, v201 dst_sel:WORD_1 dst_unused:UNUSED_PRESERVE src0_sel:WORD_1
v_mfma_f32_16x16x32_bf16 v[180:183], v[220:223], v[116:119], v[180:183]
v_rcp_f16_sdwa v199, v198 dst_sel:WORD_1 dst_unused:UNUSED_PRESERVE src0_sel:WORD_1
v_or_b32 v232, v184, v185
v_or_b32 v233, v186, v187
s_waitcnt lgkmcnt(4)
v_or_b32 v234, v188, v189
v_rcp_f16_sdwa v196, v195 dst_sel:WORD_1 dst_unused:UNUSED_PRESERVE src0_sel:WORD_1
v_or_b32 v235, v190, v191
s_waitcnt lgkmcnt(2)
v_or_b32 v236, v192, v193
v_pk_mul_f16 v237, v203, v202
v_pk_mul_f16 v238, v200, v199
v_pk_mul_f16 v239, v197, v196
s_setprio 3
v_mfma_f32_16x16x32_f16 v[48:51], v[224:227], v[232:235], v[48:51]
buffer_load_dwordx4 v[8:11], v252, s[4:7], s69 offen offset:128
ds_read_b128 v[220:223], v249 offset:50432
v_cvt_pkrtz_f16_f32 v185, v168, v169
v_cvt_pkrtz_f16_f32 v187, v170, v171
v_mfma_f32_16x16x32_f16 v[56:59], v[224:227], v[236:239], v[56:59]
v_cvt_pkrtz_f16_f32 v189, v172, v173
v_cvt_pkrtz_f16_f32 v191, v174, v175
v_mfma_f32_16x16x32_f16 v[52:55], v[228:231], v[232:235], v[52:55]
ds_read_b128 v[224:227], v248 offset:54272
v_cvt_pkrtz_f16_f32 v193, v176, v177
v_cvt_pk_f16_f32 v203, v178, v179
v_mfma_f32_16x16x32_f16 v[60:63], v[228:231], v[236:239], v[60:63]
v_cvt_pk_f16_f32 v200, v180, v181
v_cvt_pk_f16_f32 v197, v182, v183
v_mfma_f32_16x16x32_bf16 v[168:171], v[240:243], v[96:99], 0
ds_read_b128 v[228:231], v249 offset:51200
v_pk_fma_f16 v202, v203, v203, s48
v_and_b32_e64 v185, s49, v185
v_mfma_f32_16x16x32_bf16 v[176:179], v[240:243], v[100:103], 0
v_pk_fma_f16 v199, v200, v200, s48
v_and_b32 v187, s49, v187
s_waitcnt lgkmcnt(3)
v_mfma_f32_16x16x32_f16 v[64:67], v[244:247], v[232:235], v[64:67]
ds_read_b128 v[240:243], v249 offset:51456
v_pk_fma_f16 v196, v197, v197, s48
v_bfe_u32 v184, v185, 2, 14
v_pk_mul_f16 v202, v203, v202
v_mfma_f32_16x16x32_f16 v[72:75], v[244:247], v[236:239], v[72:75]
v_bfe_u32 v186, v187, 2, 14
v_pk_mul_f16 v199, v200, v199
s_waitcnt vmcnt(7)
v_mfma_f32_16x16x32_bf16 v[144:147], v[18:21], v[44:47], v[144:147]
ds_read_b128 v[244:247], v248 offset:54528
ds_read_u16_d16 v184, v184
ds_read_u16_d16 v186, v186
v_lshrrev_b32 v185, 18, v185
v_pk_mul_f16 v196, v197, v196
v_mfma_f32_16x16x32_bf16 v[148:151], v[16:19], v[44:47], v[148:151]
v_lshrrev_b32_e64 v187, 18, v187
v_mfma_f32_16x16x32_bf16 v[172:175], v[216:219], v[96:99], 0
ds_read_u16_d16_hi v185, v185
ds_read_u16_d16_hi v187, v187
v_exp_f16 v201, v202
v_and_b32 v189, s49, v189
v_mfma_f32_16x16x32_bf16 v[180:183], v[216:219], v[100:103], 0
v_and_b32 v191, s49, v191
s_waitcnt lgkmcnt(6)
v_mfma_f32_16x16x32_f16 v[68:71], v[220:223], v[232:235], v[68:71]
ds_read_b128 v[216:219], v248 offset:55296
v_exp_f16_e64 v198, v199
v_bfe_u32 v188, v189, 2, 14
v_mfma_f32_16x16x32_f16 v[76:79], v[220:223], v[236:239], v[76:79]
v_bfe_u32 v190, v191, 2, 14
v_exp_f16_e64 v195, v196
v_mfma_f32_16x16x32_bf16 v[168:171], v[224:227], v[104:107], v[168:171]
ds_read_b128 v[220:223], v248 offset:55552
ds_read_u16_d16 v188, v188
ds_read_u16_d16 v190, v190
v_lshrrev_b32 v189, 18, v189
v_lshrrev_b32 v191, 18, v191
v_mfma_f32_16x16x32_bf16 v[176:179], v[224:227], v[108:111], v[176:179]
v_exp_f16_sdwa v201, v202 dst_sel:WORD_1 dst_unused:UNUSED_PRESERVE src0_sel:WORD_1
v_mfma_f32_16x16x32_f16 v[80:83], v[228:231], v[232:235], v[80:83]
ds_read_b128 v[224:227], v249 offset:55296
ds_read_u16_d16_hi v189, v189
ds_read_u16_d16_hi v191, v191
v_and_b32 v193, s49, v193
v_bfe_u32 v192, v193, 2, 14
v_mfma_f32_16x16x32_f16 v[88:91], v[228:231], v[236:239], v[88:91]
v_exp_f16_sdwa v198, v199 dst_sel:WORD_1 dst_unused:UNUSED_PRESERVE src0_sel:WORD_1
s_waitcnt lgkmcnt(7)
v_mfma_f32_16x16x32_f16 v[84:87], v[240:243], v[232:235], v[84:87]
ds_read_b128 v[228:231], v249 offset:55552
ds_read_u16_d16 v192, v192
v_lshrrev_b32_e64 v193, 18, v193
v_mfma_f32_16x16x32_f16 v[92:95], v[240:243], v[236:239], v[92:95]
v_exp_f16_sdwa v195, v196 dst_sel:WORD_1 dst_unused:UNUSED_PRESERVE src0_sel:WORD_1
v_pk_add_f16 v201, v201, 1.0 op_sel_hi:[1,0]
v_pk_add_f16 v198, v198, 1.0 op_sel_hi:[1,0]
v_mfma_f32_16x16x32_bf16 v[172:175], v[244:247], v[104:107], v[172:175]
ds_read_b128 v[240:243], v248 offset:59392
ds_read_u16_d16_hi v193, v193
v_pk_add_f16 v195, v195, 1.0 op_sel_hi:[1,0]
v_mfma_f32_16x16x32_bf16 v[180:183], v[244:247], v[108:111], v[180:183]
v_rcp_f16 v202, v201
s_waitcnt lgkmcnt(7)
v_mfma_f32_16x16x32_bf16 v[168:171], v[216:219], v[112:115], v[168:171]
ds_read_b128 v[244:247], v249 offset:56320
v_rcp_f16_e64 v199, v198
v_mfma_f32_16x16x32_bf16 v[176:179], v[216:219], v[116:119], v[176:179]
v_rcp_f16_e64 v196, v195
v_mfma_f32_16x16x32_bf16 v[172:175], v[220:223], v[112:115], v[172:175]
ds_read_b128 v[216:219], v248 offset:59648
v_rcp_f16_sdwa v202, v201 dst_sel:WORD_1 dst_unused:UNUSED_PRESERVE src0_sel:WORD_1
v_mfma_f32_16x16x32_bf16 v[180:183], v[220:223], v[116:119], v[180:183]
v_rcp_f16_sdwa v199, v198 dst_sel:WORD_1 dst_unused:UNUSED_PRESERVE src0_sel:WORD_1
v_or_b32 v232, v184, v185
v_or_b32 v233, v186, v187
s_waitcnt lgkmcnt(4)
v_or_b32 v234, v188, v189
v_rcp_f16_sdwa v196, v195 dst_sel:WORD_1 dst_unused:UNUSED_PRESERVE src0_sel:WORD_1
v_or_b32 v235, v190, v191
s_waitcnt lgkmcnt(2)
v_or_b32_e64 v236, v192, v193
v_pk_mul_f16 v237, v203, v202
v_pk_mul_f16 v238, v200, v199
v_pk_mul_f16 v239, v197, v196
v_mfma_f32_16x16x32_f16 v[48:51], v[224:227], v[232:235], v[48:51]
s_add_u32 s46, s69, 98304
buffer_load_dwordx4 v[44:47], v252, s[4:7], s46 offen
ds_read_b128 v[220:223], v249 offset:56576
v_cvt_pkrtz_f16_f32 v185, v168, v169
v_cvt_pkrtz_f16_f32 v187, v170, v171
v_mfma_f32_16x16x32_f16 v[56:59], v[224:227], v[236:239], v[56:59]
v_cvt_pkrtz_f16_f32 v189, v172, v173
v_cvt_pkrtz_f16_f32 v191, v174, v175
v_mfma_f32_16x16x32_f16 v[52:55], v[228:231], v[232:235], v[52:55]
ds_read_b128 v[224:227], v248 offset:60416
v_cvt_pkrtz_f16_f32 v193, v176, v177
v_cvt_pk_f16_f32 v203, v178, v179
v_cvt_pk_f16_f32 v200, v180, v181
v_mfma_f32_16x16x32_f16 v[60:63], v[228:231], v[236:239], v[60:63]
v_cvt_pk_f16_f32 v197, v182, v183
v_pk_fma_f16 v202, v203, v203, s48
v_mfma_f32_16x16x32_bf16 v[168:171], v[240:243], v[96:99], 0
ds_read_b128 v[228:231], v249 offset:57344
v_and_b32_e64 v185, s49, v185
v_pk_fma_f16 v199, v200, v200, s48
v_mfma_f32_16x16x32_bf16 v[176:179], v[240:243], v[100:103], 0
v_and_b32_e64 v187, s49, v187
v_pk_fma_f16 v196, v197, v197, s48
s_setprio 2
v_bfe_u32 v184, v185, 2, 14
s_waitcnt lgkmcnt(3)
v_mfma_f32_16x16x32_f16 v[64:67], v[244:247], v[232:235], v[64:67]
ds_read_b128 v[240:243], v249 offset:57600
ds_read_u16_d16 v184, v184
v_pk_mul_f16 v202, v203, v202
v_bfe_u32 v186, v187, 2, 14
v_mfma_f32_16x16x32_f16 v[72:75], v[244:247], v[236:239], v[72:75]
v_pk_mul_f16 v199, v200, v199
v_lshrrev_b32_e64 v185, 18, v185
v_mfma_f32_16x16x32_bf16 v[172:175], v[216:219], v[96:99], 0
ds_read_b128 v[244:247], v248 offset:60672
ds_read_u16_d16 v186, v186
ds_read_u16_d16_hi v185, v185
v_pk_mul_f16 v196, v197, v196
v_lshrrev_b32_e64 v187, 18, v187
v_mfma_f32_16x16x32_bf16 v[180:183], v[216:219], v[100:103], 0
v_exp_f16_e64 v201, v202
v_and_b32 v189, s49, v189
s_waitcnt lgkmcnt(5)
v_mfma_f32_16x16x32_f16 v[68:71], v[220:223], v[232:235], v[68:71]
ds_read_b128 v[216:219], v248 offset:61440
ds_read_u16_d16_hi v187, v187
v_and_b32_e64 v191, s49, v191
v_mfma_f32_16x16x32_f16 v[76:79], v[220:223], v[236:239], v[76:79]
v_exp_f16_e64 v198, v199
v_bfe_u32 v188, v189, 2, 14
v_bfe_u32 v190, v191, 2, 14
v_mfma_f32_16x16x32_bf16 v[168:171], v[224:227], v[104:107], v[168:171]
buffer_store_dwordx4 v[152:155], v255, s[8:11], s68 offen offset:256 sc1
ds_read_b128 v[220:223], v248 offset:61696
ds_read_u16_d16 v188, v188
ds_read_u16_d16 v190, v190
v_exp_f16_e64 v195, v196
v_mfma_f32_16x16x32_bf16 v[176:179], v[224:227], v[108:111], v[176:179]
v_lshrrev_b32 v189, 18, v189
v_lshrrev_b32 v191, 18, v191
v_mfma_f32_16x16x32_f16 v[80:83], v[228:231], v[232:235], v[80:83]
ds_read_b128 v[224:227], v249 offset:61440
ds_read_u16_d16_hi v189, v189
ds_read_u16_d16_hi v191, v191
v_exp_f16_sdwa v201, v202 dst_sel:WORD_1 dst_unused:UNUSED_PRESERVE src0_sel:WORD_1
v_and_b32 v193, s49, v193
v_mfma_f32_16x16x32_f16 v[88:91], v[228:231], v[236:239], v[88:91]
v_bfe_u32 v192, v193, 2, 14
s_waitcnt lgkmcnt(8)
v_mfma_f32_16x16x32_f16 v[84:87], v[240:243], v[232:235], v[84:87]
ds_read_b128 v[228:231], v249 offset:61696
ds_read_u16_d16 v192, v192
v_exp_f16_sdwa v198, v199 dst_sel:WORD_1 dst_unused:UNUSED_PRESERVE src0_sel:WORD_1
v_lshrrev_b32_e64 v193, 18, v193
v_mfma_f32_16x16x32_f16 v[92:95], v[240:243], v[236:239], v[92:95]
v_exp_f16_sdwa v195, v196 dst_sel:WORD_1 dst_unused:UNUSED_PRESERVE src0_sel:WORD_1
v_pk_add_f16 v201, v201, 1.0 op_sel_hi:[1,0]
v_mfma_f32_16x16x32_bf16 v[172:175], v[244:247], v[104:107], v[172:175]
ds_read_b128 v[240:243], v249
ds_read_u16_d16_hi v193, v193
v_pk_add_f16 v198, v198, 1.0 op_sel_hi:[1,0]
v_pk_add_f16 v195, v195, 1.0 op_sel_hi:[1,0]
v_mfma_f32_16x16x32_bf16 v[180:183], v[244:247], v[108:111], v[180:183]
v_rcp_f16 v202, v201
s_waitcnt lgkmcnt(7)
v_mfma_f32_16x16x32_bf16 v[168:171], v[216:219], v[112:115], v[168:171]
ds_read_b128 v[244:247], v249 offset:62464
v_rcp_f16_e64 v199, v198
v_mfma_f32_16x16x32_bf16 v[176:179], v[216:219], v[116:119], v[176:179]
v_rcp_f16_e64 v196, v195
v_mfma_f32_16x16x32_bf16 v[172:175], v[220:223], v[112:115], v[172:175]
ds_read_b128 v[216:219], v249 offset:256
v_rcp_f16_sdwa v202, v201 dst_sel:WORD_1 dst_unused:UNUSED_PRESERVE src0_sel:WORD_1
v_mfma_f32_16x16x32_bf16 v[180:183], v[220:223], v[116:119], v[180:183]
v_rcp_f16_sdwa v199, v198 dst_sel:WORD_1 dst_unused:UNUSED_PRESERVE src0_sel:WORD_1
v_or_b32 v232, v184, v185
v_or_b32 v233, v186, v187
s_waitcnt lgkmcnt(4)
v_or_b32 v234, v188, v189
v_rcp_f16_sdwa v196, v195 dst_sel:WORD_1 dst_unused:UNUSED_PRESERVE src0_sel:WORD_1
v_or_b32 v235, v190, v191
s_waitcnt lgkmcnt(2)
v_or_b32_e64 v236, v192, v193
v_pk_mul_f16 v237, v203, v202
v_pk_mul_f16 v238, v200, v199
v_pk_mul_f16 v239, v197, v196
v_mfma_f32_16x16x32_f16 v[48:51], v[224:227], v[232:235], v[48:51]
s_add_u32 s46, s69, 98304
buffer_load_dwordx4 v[40:43], v252, s[4:7], s46 offen offset:64
ds_read_b128 v[220:223], v249 offset:62720
v_cvt_pkrtz_f16_f32 v185, v168, v169
v_cvt_pkrtz_f16_f32 v187, v170, v171
v_mfma_f32_16x16x32_f16 v[56:59], v[224:227], v[236:239], v[56:59]
v_cvt_pkrtz_f16_f32 v189, v172, v173
v_cvt_pkrtz_f16_f32 v191, v174, v175
v_mfma_f32_16x16x32_f16 v[52:55], v[228:231], v[232:235], v[52:55]
ds_read_b128 v[224:227], v249 offset:1024
v_cvt_pkrtz_f16_f32 v193, v176, v177
v_cvt_pk_f16_f32 v203, v178, v179
v_mfma_f32_16x16x32_f16 v[60:63], v[228:231], v[236:239], v[60:63]
v_cvt_pk_f16_f32 v200, v180, v181
v_cvt_pk_f16_f32 v197, v182, v183
s_setprio 1
v_mfma_f32_16x16x32_bf16 v[168:171], v[240:243], v[96:99], 0
ds_read_b128 v[228:231], v249 offset:63488
v_pk_fma_f16 v202, v203, v203, s48
v_and_b32 v185, s49, v185
v_mfma_f32_16x16x32_bf16 v[176:179], v[240:243], v[100:103], 0
v_pk_fma_f16 v199, v200, v200, s48
v_and_b32 v187, s49, v187
s_waitcnt lgkmcnt(3)
v_mfma_f32_16x16x32_f16 v[64:67], v[244:247], v[232:235], v[64:67]
ds_read_b128 v[240:243], v249 offset:63744
v_pk_fma_f16 v196, v197, v197, s48
v_bfe_u32 v184, v185, 2, 14
v_mfma_f32_16x16x32_f16 v[72:75], v[244:247], v[236:239], v[72:75]
v_pk_mul_f16 v202, v203, v202
v_bfe_u32 v186, v187, 2, 14
s_waitcnt vmcnt(8)
v_mfma_f32_16x16x32_bf16 v[160:163], v[18:21], v[208:211], v[160:163]
ds_read_b128 v[244:247], v249 offset:1280
ds_read_u16_d16 v184, v184
ds_read_u16_d16 v186, v186
v_pk_mul_f16 v199, v200, v199
v_lshrrev_b32 v185, 18, v185
v_mfma_f32_16x16x32_bf16 v[164:167], v[16:19], v[208:211], v[164:167]
v_pk_mul_f16 v196, v197, v196
v_lshrrev_b32_e64 v187, 18, v187
v_mfma_f32_16x16x32_bf16 v[172:175], v[216:219], v[96:99], 0
ds_read_u16_d16_hi v185, v185
ds_read_u16_d16_hi v187, v187
v_exp_f16_e64 v201, v202
v_mfma_f32_16x16x32_bf16 v[180:183], v[216:219], v[100:103], 0
v_and_b32_e64 v189, s49, v189
v_and_b32 v191, s49, v191
s_waitcnt lgkmcnt(6)
v_mfma_f32_16x16x32_f16 v[68:71], v[220:223], v[232:235], v[68:71]
ds_read_b128 v[216:219], v249 offset:2048
v_exp_f16_e64 v198, v199
v_mfma_f32_16x16x32_f16 v[76:79], v[220:223], v[236:239], v[76:79]
v_bfe_u32 v188, v189, 2, 14
v_bfe_u32 v190, v191, 2, 14
v_mfma_f32_16x16x32_bf16 v[168:171], v[224:227], v[104:107], v[168:171]
ds_read_b128 v[220:223], v249 offset:2304
ds_read_u16_d16 v188, v188
ds_read_u16_d16 v190, v190
v_exp_f16_e64 v195, v196
v_mfma_f32_16x16x32_bf16 v[176:179], v[224:227], v[108:111], v[176:179]
v_lshrrev_b32 v189, 18, v189
v_lshrrev_b32 v191, 18, v191
v_mfma_f32_16x16x32_f16 v[80:83], v[228:231], v[232:235], v[80:83]
ds_read_b128 v[224:227], v250 offset:2048
ds_read_u16_d16_hi v189, v189
ds_read_u16_d16_hi v191, v191
v_exp_f16_sdwa v201, v202 dst_sel:WORD_1 dst_unused:UNUSED_PRESERVE src0_sel:WORD_1
v_mfma_f32_16x16x32_f16 v[88:91], v[228:231], v[236:239], v[88:91]
v_and_b32 v193, s49, v193
v_bfe_u32 v192, v193, 2, 14
s_waitcnt lgkmcnt(7)
v_mfma_f32_16x16x32_f16 v[84:87], v[240:243], v[232:235], v[84:87]
ds_read_b128 v[228:231], v250 offset:2304
ds_read_u16_d16 v192, v192
v_exp_f16_sdwa v198, v199 dst_sel:WORD_1 dst_unused:UNUSED_PRESERVE src0_sel:WORD_1
v_mfma_f32_16x16x32_f16 v[92:95], v[240:243], v[236:239], v[92:95]
v_lshrrev_b32 v193, 18, v193
s_waitcnt vmcnt(7)
v_mfma_f32_16x16x32_bf16 v[48:51], v[18:21], v[12:15], v[48:51]
ds_read_b128 v[240:243], v249 offset:6144
ds_read_u16_d16_hi v193, v193
v_exp_f16_sdwa v195, v196 dst_sel:WORD_1 dst_unused:UNUSED_PRESERVE src0_sel:WORD_1
v_pk_add_f16 v201, v201, 1.0 op_sel_hi:[1,0]
v_mfma_f32_16x16x32_bf16 v[52:55], v[16:19], v[12:15], v[52:55]
v_pk_add_f16 v198, v198, 1.0 op_sel_hi:[1,0]
v_pk_add_f16 v195, v195, 1.0 op_sel_hi:[1,0]
v_mfma_f32_16x16x32_bf16 v[172:175], v[244:247], v[104:107], v[172:175]
v_rcp_f16 v202, v201
s_setprio 0
v_mfma_f32_16x16x32_bf16 v[180:183], v[244:247], v[108:111], v[180:183]
v_rcp_f16 v199, v198
s_waitcnt lgkmcnt(4)
v_mfma_f32_16x16x32_bf16 v[168:171], v[216:219], v[112:115], v[168:171]
ds_read_b128 v[244:247], v250 offset:3072
v_rcp_f16_e64 v196, v195
v_mfma_f32_16x16x32_bf16 v[176:179], v[216:219], v[116:119], v[176:179]
v_rcp_f16_sdwa v202, v201 dst_sel:WORD_1 dst_unused:UNUSED_PRESERVE src0_sel:WORD_1
v_mfma_f32_16x16x32_bf16 v[172:175], v[220:223], v[112:115], v[172:175]
ds_read_b128 v[216:219], v249 offset:6400
v_rcp_f16_sdwa v199, v198 dst_sel:WORD_1 dst_unused:UNUSED_PRESERVE src0_sel:WORD_1
v_mfma_f32_16x16x32_bf16 v[180:183], v[220:223], v[116:119], v[180:183]
v_or_b32 v232, v184, v185
v_or_b32 v233, v186, v187
v_or_b32_e64 v234, v188, v189
v_rcp_f16_sdwa v196, v195 dst_sel:WORD_1 dst_unused:UNUSED_PRESERVE src0_sel:WORD_1
v_or_b32 v235, v190, v191
s_waitcnt lgkmcnt(2)
v_or_b32_e64 v236, v192, v193
v_pk_mul_f16 v237, v203, v202
v_pk_mul_f16 v238, v200, v199
v_pk_mul_f16 v239, v197, v196
v_mfma_f32_16x16x32_f16 v[48:51], v[224:227], v[232:235], v[48:51]
s_add_u32 s46, s69, 98304
buffer_load_dwordx4 v[208:211], v252, s[4:7], s46 offen offset:128
ds_read_b128 v[220:223], v250 offset:3328
v_cvt_pkrtz_f16_f32 v185, v168, v169
v_cvt_pkrtz_f16_f32 v187, v170, v171
v_cvt_pkrtz_f16_f32 v189, v172, v173
v_mfma_f32_16x16x32_f16 v[56:59], v[224:227], v[236:239], v[56:59]
v_cvt_pkrtz_f16_f32 v191, v174, v175
v_cvt_pkrtz_f16_f32 v193, v176, v177
v_cvt_pk_f16_f32 v203, v178, v179
v_mfma_f32_16x16x32_f16 v[52:55], v[228:231], v[232:235], v[52:55]
ds_read_b128 v[224:227], v249 offset:7168
v_cvt_pk_f16_f32 v200, v180, v181
v_cvt_pk_f16_f32 v197, v182, v183
v_pk_fma_f16 v202, v203, v203, s48
v_mfma_f32_16x16x32_f16 v[60:63], v[228:231], v[236:239], v[60:63]
v_cvt_pk_bf16_f32 v144, v144, v145
v_and_b32_e64 v185, s49, v185
v_cvt_pk_bf16_f32 v145, v146, v147
v_mfma_f32_16x16x32_bf16 v[168:171], v[240:243], v[96:99], 0
ds_read_b128 v[228:231], v250 offset:4096
v_pk_fma_f16 v199, v200, v200, s48
v_and_b32 v187, s49, v187
v_cvt_pk_bf16_f32 v146, v148, v149
v_mfma_f32_16x16x32_bf16 v[176:179], v[240:243], v[100:103], 0
v_pk_fma_f16 v196, v197, v197, s48
v_cvt_pk_bf16_f32 v147, v150, v151
v_bfe_u32 v184, v185, 2, 14
s_waitcnt lgkmcnt(2)
v_mfma_f32_16x16x32_f16 v[64:67], v[244:247], v[232:235], v[64:67]
ds_read_b128 v[240:243], v250 offset:4352
ds_read_u16_d16 v184, v184
v_pk_mul_f16 v202, v203, v202
v_cvt_pk_bf16_f32 v128, v128, v129
v_bfe_u32 v186, v187, 2, 14
v_mfma_f32_16x16x32_f16 v[72:75], v[244:247], v[236:239], v[72:75]
v_cvt_pk_bf16_f32 v129, v130, v131
v_pk_mul_f16 v199, v200, v199
v_lshrrev_b32 v185, 18, v185
s_waitcnt vmcnt(6)
v_mfma_f32_16x16x32_bf16 v[64:67], v[18:21], v[204:207], v[64:67]
ds_read_b128 v[244:247], v249 offset:7424
ds_read_u16_d16 v186, v186
ds_read_u16_d16_hi v185, v185
v_cvt_pk_bf16_f32 v130, v132, v133
v_pk_mul_f16 v196, v197, v196
v_lshrrev_b32_e64 v187, 18, v187
v_mfma_f32_16x16x32_bf16 v[68:71], v[16:19], v[204:207], v[68:71]
v_cvt_pk_bf16_f32 v131, v134, v135
v_exp_f16_e64 v201, v202
v_mfma_f32_16x16x32_bf16 v[172:175], v[216:219], v[96:99], 0
ds_read_u16_d16_hi v187, v187
v_cvt_pk_bf16_f32 v160, v160, v161
v_and_b32_e64 v189, s49, v189
v_cvt_pk_bf16_f32 v161, v162, v163
v_mfma_f32_16x16x32_bf16 v[180:183], v[216:219], v[100:103], 0
v_and_b32_e64 v191, s49, v191
v_cvt_pk_bf16_f32 v162, v164, v165
v_mfma_f32_16x16x32_f16 v[68:71], v[220:223], v[232:235], v[68:71]
ds_read_b128 v[216:219], v249 offset:8192
v_exp_f16 v198, v199
v_cvt_pk_bf16_f32 v163, v166, v167
s_mov_b64 vcc, s[74:75]
v_bfe_u32 v188, v189, 2, 14
v_bfe_u32 v190, v191, 2, 14
v_mfma_f32_16x16x32_f16 v[76:79], v[220:223], v[236:239], v[76:79]
v_cndmask_b32 v148, v128, v160, vcc
v_exp_f16_e64 v195, v196
s_waitcnt lgkmcnt(2)
v_mfma_f32_16x16x32_bf16 v[168:171], v[224:227], v[104:107], v[168:171]
ds_read_b128 v[220:223], v249 offset:8448
ds_read_u16_d16 v188, v188
ds_read_u16_d16 v190, v190
v_cndmask_b32 v149, v129, v161, vcc
v_lshrrev_b32_e64 v189, 18, v189
v_cndmask_b32 v150, v130, v162, vcc
v_mfma_f32_16x16x32_bf16 v[176:179], v[224:227], v[108:111], v[176:179]
v_lshrrev_b32 v191, 18, v191
v_cndmask_b32 v151, v131, v163, vcc
v_mfma_f32_16x16x32_f16 v[80:83], v[228:231], v[232:235], v[80:83]
ds_read_b128 v[224:227], v250 offset:8192
ds_read_u16_d16_hi v189, v189
ds_read_u16_d16_hi v191, v191
v_exp_f16_sdwa v201, v202 dst_sel:WORD_1 dst_unused:UNUSED_PRESERVE src0_sel:WORD_1
v_cndmask_b32_dpp v128, v144, v128, vcc quad_perm:[1,0,3,2] row_mask:0xf bank_mask:0xf
v_and_b32_e64 v193, s49, v193
v_mfma_f32_16x16x32_f16 v[88:91], v[228:231], v[236:239], v[88:91]
v_cndmask_b32_dpp v129, v145, v129, vcc quad_perm:[1,0,3,2] row_mask:0xf bank_mask:0xf
v_bfe_u32 v192, v193, 2, 14
v_mfma_f32_16x16x32_f16 v[84:87], v[240:243], v[232:235], v[84:87]
ds_read_b128 v[228:231], v250 offset:8448
ds_read_u16_d16 v192, v192
v_exp_f16_sdwa v198, v199 dst_sel:WORD_1 dst_unused:UNUSED_PRESERVE src0_sel:WORD_1
v_cndmask_b32_dpp v130, v146, v130, vcc quad_perm:[1,0,3,2] row_mask:0xf bank_mask:0xf
v_lshrrev_b32 v193, 18, v193
v_mfma_f32_16x16x32_f16 v[92:95], v[240:243], v[236:239], v[92:95]
v_cndmask_b32_dpp v131, v147, v131, vcc quad_perm:[1,0,3,2] row_mask:0xf bank_mask:0xf
s_not_b64 vcc, s[74:75]
v_exp_f16_sdwa v195, v196 dst_sel:WORD_1 dst_unused:UNUSED_PRESERVE src0_sel:WORD_1
v_mfma_f32_16x16x32_bf16 v[172:175], v[244:247], v[104:107], v[172:175]
ds_read_b128 v[240:243], v249 offset:12288
ds_read_u16_d16_hi v193, v193
v_cndmask_b32_dpp v160, v144, v160, vcc quad_perm:[1,0,3,2] row_mask:0xf bank_mask:0xf
v_pk_add_f16 v201, v201, 1.0 op_sel_hi:[1,0]
v_cndmask_b32_dpp v161, v145, v161, vcc quad_perm:[1,0,3,2] row_mask:0xf bank_mask:0xf
v_mfma_f32_16x16x32_bf16 v[180:183], v[244:247], v[108:111], v[180:183]
v_pk_add_f16 v198, v198, 1.0 op_sel_hi:[1,0]
v_cndmask_b32_dpp v162, v146, v162, vcc quad_perm:[1,0,3,2] row_mask:0xf bank_mask:0xf
v_pk_add_f16 v195, v195, 1.0 op_sel_hi:[1,0]
s_waitcnt lgkmcnt(4)
v_mfma_f32_16x16x32_bf16 v[168:171], v[216:219], v[112:115], v[168:171]
ds_read_b128 v[244:247], v250 offset:9216
v_rcp_f16 v202, v201
v_cndmask_b32_dpp v163, v147, v163, vcc quad_perm:[1,0,3,2] row_mask:0xf bank_mask:0xf
v_mfma_f32_16x16x32_bf16 v[176:179], v[216:219], v[116:119], v[176:179]
v_rcp_f16_e64 v199, v198
v_mfma_f32_16x16x32_bf16 v[172:175], v[220:223], v[112:115], v[172:175]
ds_read_b128 v[216:219], v249 offset:12544
s_add_u32 s46, s68, 98304
buffer_store_dwordx4 v[128:131], v255, s[8:11], s46 offen sc1
v_rcp_f16_e64 v196, v195
v_rcp_f16_sdwa v202, v201 dst_sel:WORD_1 dst_unused:UNUSED_PRESERVE src0_sel:WORD_1
v_mfma_f32_16x16x32_bf16 v[180:183], v[220:223], v[116:119], v[180:183]
v_rcp_f16_sdwa v199, v198 dst_sel:WORD_1 dst_unused:UNUSED_PRESERVE src0_sel:WORD_1
v_or_b32 v232, v184, v185
v_or_b32 v233, v186, v187
v_or_b32_e64 v234, v188, v189
v_rcp_f16_sdwa v196, v195 dst_sel:WORD_1 dst_unused:UNUSED_PRESERVE src0_sel:WORD_1
v_or_b32 v235, v190, v191
s_waitcnt lgkmcnt(2)
v_or_b32_e64 v236, v192, v193
v_pk_mul_f16 v237, v203, v202
v_pk_mul_f16 v238, v200, v199
v_pk_mul_f16 v239, v197, v196
v_mfma_f32_16x16x32_f16 v[48:51], v[224:227], v[232:235], v[48:51]
s_add_u32 s46, s68, 98304
buffer_store_dwordx4 v[148:151], v255, s[8:11], s46 offen offset:128 sc1
ds_read_b128 v[220:223], v250 offset:9472
v_cvt_pkrtz_f16_f32 v185, v168, v169
v_cvt_pkrtz_f16_f32 v187, v170, v171
v_mfma_f32_16x16x32_f16 v[56:59], v[224:227], v[236:239], v[56:59]
v_cvt_pkrtz_f16_f32 v189, v172, v173
v_cvt_pkrtz_f16_f32 v191, v174, v175
v_mfma_f32_16x16x32_f16 v[52:55], v[228:231], v[232:235], v[52:55]
ds_read_b128 v[224:227], v249 offset:13312
v_cvt_pkrtz_f16_f32 v193, v176, v177
v_cvt_pk_f16_f32 v203, v178, v179
v_mfma_f32_16x16x32_f16 v[60:63], v[228:231], v[236:239], v[60:63]
v_cvt_pk_f16_f32 v200, v180, v181
v_cvt_pk_f16_f32 v197, v182, v183
v_mfma_f32_16x16x32_bf16 v[168:171], v[240:243], v[96:99], 0
ds_read_b128 v[228:231], v250 offset:10240
v_pk_fma_f16 v202, v203, v203, s48
v_and_b32_e64 v185, s49, v185
v_mfma_f32_16x16x32_bf16 v[176:179], v[240:243], v[100:103], 0
v_pk_fma_f16 v199, v200, v200, s48
v_and_b32 v187, s49, v187
s_waitcnt lgkmcnt(3)
v_mfma_f32_16x16x32_f16 v[64:67], v[244:247], v[232:235], v[64:67]
ds_read_b128 v[240:243], v250 offset:10496
v_pk_fma_f16 v196, v197, v197, s48
v_bfe_u32 v184, v185, 2, 14
v_pk_mul_f16 v202, v203, v202
v_mfma_f32_16x16x32_f16 v[72:75], v[244:247], v[236:239], v[72:75]
v_bfe_u32 v186, v187, 2, 14
v_pk_mul_f16 v199, v200, v199
s_waitcnt vmcnt(6)
v_mfma_f32_16x16x32_bf16 v[80:83], v[18:21], v[8:11], v[80:83]
ds_read_b128 v[244:247], v249 offset:13568
ds_read_u16_d16 v184, v184
ds_read_u16_d16 v186, v186
v_lshrrev_b32 v185, 18, v185
v_pk_mul_f16 v196, v197, v196
v_mfma_f32_16x16x32_bf16 v[84:87], v[16:19], v[8:11], v[84:87]
v_lshrrev_b32_e64 v187, 18, v187
v_mfma_f32_16x16x32_bf16 v[172:175], v[216:219], v[96:99], 0
ds_read_u16_d16_hi v185, v185
ds_read_u16_d16_hi v187, v187
v_exp_f16 v201, v202
v_and_b32 v189, s49, v189
v_mfma_f32_16x16x32_bf16 v[180:183], v[216:219], v[100:103], 0
v_and_b32 v191, s49, v191
s_waitcnt lgkmcnt(6)
v_mfma_f32_16x16x32_f16 v[68:71], v[220:223], v[232:235], v[68:71]
ds_read_b128 v[216:219], v249 offset:14336
v_exp_f16_e64 v198, v199
v_bfe_u32 v188, v189, 2, 14
v_mfma_f32_16x16x32_f16 v[76:79], v[220:223], v[236:239], v[76:79]
v_bfe_u32 v190, v191, 2, 14
v_exp_f16_e64 v195, v196
v_mfma_f32_16x16x32_bf16 v[168:171], v[224:227], v[104:107], v[168:171]
ds_read_b128 v[220:223], v249 offset:14592
ds_read_u16_d16 v188, v188
ds_read_u16_d16 v190, v190
v_lshrrev_b32 v189, 18, v189
v_lshrrev_b32 v191, 18, v191
v_mfma_f32_16x16x32_bf16 v[176:179], v[224:227], v[108:111], v[176:179]
v_exp_f16_sdwa v201, v202 dst_sel:WORD_1 dst_unused:UNUSED_PRESERVE src0_sel:WORD_1
v_mfma_f32_16x16x32_f16 v[80:83], v[228:231], v[232:235], v[80:83]
ds_read_b128 v[224:227], v250 offset:14336
ds_read_u16_d16_hi v189, v189
ds_read_u16_d16_hi v191, v191
v_and_b32 v193, s49, v193
v_bfe_u32 v192, v193, 2, 14
v_mfma_f32_16x16x32_f16 v[88:91], v[228:231], v[236:239], v[88:91]
v_exp_f16_sdwa v198, v199 dst_sel:WORD_1 dst_unused:UNUSED_PRESERVE src0_sel:WORD_1
s_waitcnt lgkmcnt(7)
v_mfma_f32_16x16x32_f16 v[84:87], v[240:243], v[232:235], v[84:87]
ds_read_b128 v[228:231], v250 offset:14592
ds_read_u16_d16 v192, v192
v_lshrrev_b32_e64 v193, 18, v193
v_mfma_f32_16x16x32_f16 v[92:95], v[240:243], v[236:239], v[92:95]
v_exp_f16_sdwa v195, v196 dst_sel:WORD_1 dst_unused:UNUSED_PRESERVE src0_sel:WORD_1
v_pk_add_f16 v201, v201, 1.0 op_sel_hi:[1,0]
v_pk_add_f16 v198, v198, 1.0 op_sel_hi:[1,0]
v_mfma_f32_16x16x32_bf16 v[172:175], v[244:247], v[104:107], v[172:175]
ds_read_b128 v[240:243], v249 offset:18432
ds_read_u16_d16_hi v193, v193
v_pk_add_f16 v195, v195, 1.0 op_sel_hi:[1,0]
v_mfma_f32_16x16x32_bf16 v[180:183], v[244:247], v[108:111], v[180:183]
v_rcp_f16 v202, v201
s_waitcnt lgkmcnt(7)
v_mfma_f32_16x16x32_bf16 v[168:171], v[216:219], v[112:115], v[168:171]
ds_read_b128 v[244:247], v250 offset:15360
v_rcp_f16_e64 v199, v198
v_mfma_f32_16x16x32_bf16 v[176:179], v[216:219], v[116:119], v[176:179]
v_rcp_f16_e64 v196, v195
v_mfma_f32_16x16x32_bf16 v[172:175], v[220:223], v[112:115], v[172:175]
ds_read_b128 v[216:219], v249 offset:18688
v_rcp_f16_sdwa v202, v201 dst_sel:WORD_1 dst_unused:UNUSED_PRESERVE src0_sel:WORD_1
v_mfma_f32_16x16x32_bf16 v[180:183], v[220:223], v[116:119], v[180:183]
v_rcp_f16_sdwa v199, v198 dst_sel:WORD_1 dst_unused:UNUSED_PRESERVE src0_sel:WORD_1
v_or_b32 v232, v184, v185
v_or_b32 v233, v186, v187
s_waitcnt lgkmcnt(4)
v_or_b32 v234, v188, v189
v_rcp_f16_sdwa v196, v195 dst_sel:WORD_1 dst_unused:UNUSED_PRESERVE src0_sel:WORD_1
v_or_b32 v235, v190, v191
s_waitcnt lgkmcnt(2)
v_or_b32_e64 v236, v192, v193
v_pk_mul_f16 v237, v203, v202
v_pk_mul_f16 v238, v200, v199
v_pk_mul_f16 v239, v197, v196
v_mfma_f32_16x16x32_f16 v[48:51], v[224:227], v[232:235], v[48:51]
ds_read_b128 v[220:223], v250 offset:15616
v_cvt_pkrtz_f16_f32 v185, v168, v169
v_cvt_pkrtz_f16_f32 v187, v170, v171
v_mfma_f32_16x16x32_f16 v[56:59], v[224:227], v[236:239], v[56:59]
v_cvt_pkrtz_f16_f32 v189, v172, v173
v_cvt_pkrtz_f16_f32 v191, v174, v175
v_mfma_f32_16x16x32_f16 v[52:55], v[228:231], v[232:235], v[52:55]
ds_read_b128 v[224:227], v249 offset:19456
v_cvt_pkrtz_f16_f32 v193, v176, v177
v_cvt_pk_f16_f32 v203, v178, v179
v_mfma_f32_16x16x32_f16 v[60:63], v[228:231], v[236:239], v[60:63]
v_cvt_pk_f16_f32 v200, v180, v181
v_cvt_pk_f16_f32 v197, v182, v183
v_mfma_f32_16x16x32_bf16 v[168:171], v[240:243], v[96:99], 0
ds_read_b128 v[228:231], v250 offset:16384
v_pk_fma_f16 v202, v203, v203, s48
v_and_b32_e64 v185, s49, v185
v_mfma_f32_16x16x32_bf16 v[176:179], v[240:243], v[100:103], 0
v_pk_fma_f16 v199, v200, v200, s48
v_and_b32 v187, s49, v187
s_waitcnt lgkmcnt(3)
v_mfma_f32_16x16x32_f16 v[64:67], v[244:247], v[232:235], v[64:67]
ds_read_b128 v[240:243], v250 offset:16640
v_pk_fma_f16 v196, v197, v197, s48
v_bfe_u32 v184, v185, 2, 14
v_pk_mul_f16 v202, v203, v202
v_mfma_f32_16x16x32_f16 v[72:75], v[244:247], v[236:239], v[72:75]
v_bfe_u32 v186, v187, 2, 14
v_pk_mul_f16 v199, v200, v199
s_waitcnt vmcnt(5)
v_mfma_f32_16x16x32_bf16 v[56:59], v[18:21], v[44:47], v[56:59]
ds_read_b128 v[244:247], v249 offset:19712
ds_read_u16_d16 v184, v184
ds_read_u16_d16 v186, v186
v_lshrrev_b32 v185, 18, v185
v_pk_mul_f16 v196, v197, v196
v_mfma_f32_16x16x32_bf16 v[60:63], v[16:19], v[44:47], v[60:63]
v_lshrrev_b32_e64 v187, 18, v187
v_mfma_f32_16x16x32_bf16 v[172:175], v[216:219], v[96:99], 0
ds_read_u16_d16_hi v185, v185
ds_read_u16_d16_hi v187, v187
v_exp_f16 v201, v202
v_and_b32 v189, s49, v189
v_mfma_f32_16x16x32_bf16 v[180:183], v[216:219], v[100:103], 0
v_and_b32 v191, s49, v191
s_waitcnt lgkmcnt(6)
v_mfma_f32_16x16x32_f16 v[68:71], v[220:223], v[232:235], v[68:71]
ds_read_b128 v[216:219], v249 offset:20480
v_exp_f16_e64 v198, v199
v_bfe_u32 v188, v189, 2, 14
v_mfma_f32_16x16x32_f16 v[76:79], v[220:223], v[236:239], v[76:79]
v_bfe_u32 v190, v191, 2, 14
v_exp_f16_e64 v195, v196
v_mfma_f32_16x16x32_bf16 v[168:171], v[224:227], v[104:107], v[168:171]
ds_read_b128 v[220:223], v249 offset:20736
ds_read_u16_d16 v188, v188
ds_read_u16_d16 v190, v190
v_lshrrev_b32 v189, 18, v189
v_lshrrev_b32 v191, 18, v191
v_mfma_f32_16x16x32_bf16 v[176:179], v[224:227], v[108:111], v[176:179]
v_exp_f16_sdwa v201, v202 dst_sel:WORD_1 dst_unused:UNUSED_PRESERVE src0_sel:WORD_1
v_mfma_f32_16x16x32_f16 v[80:83], v[228:231], v[232:235], v[80:83]
ds_read_b128 v[224:227], v250 offset:20480
ds_read_u16_d16_hi v189, v189
ds_read_u16_d16_hi v191, v191
v_and_b32 v193, s49, v193
v_bfe_u32 v192, v193, 2, 14
v_mfma_f32_16x16x32_f16 v[88:91], v[228:231], v[236:239], v[88:91]
v_exp_f16_sdwa v198, v199 dst_sel:WORD_1 dst_unused:UNUSED_PRESERVE src0_sel:WORD_1
s_waitcnt lgkmcnt(7)
v_mfma_f32_16x16x32_f16 v[84:87], v[240:243], v[232:235], v[84:87]
ds_read_b128 v[228:231], v250 offset:20736
ds_read_u16_d16 v192, v192
v_lshrrev_b32_e64 v193, 18, v193
v_mfma_f32_16x16x32_f16 v[92:95], v[240:243], v[236:239], v[92:95]
v_exp_f16_sdwa v195, v196 dst_sel:WORD_1 dst_unused:UNUSED_PRESERVE src0_sel:WORD_1
v_pk_add_f16 v201, v201, 1.0 op_sel_hi:[1,0]
v_pk_add_f16 v198, v198, 1.0 op_sel_hi:[1,0]
v_mfma_f32_16x16x32_bf16 v[172:175], v[244:247], v[104:107], v[172:175]
ds_read_b128 v[240:243], v250 offset:21504
ds_read_u16_d16_hi v193, v193
v_pk_add_f16 v195, v195, 1.0 op_sel_hi:[1,0]
v_mfma_f32_16x16x32_bf16 v[180:183], v[244:247], v[108:111], v[180:183]
v_rcp_f16 v202, v201
s_waitcnt lgkmcnt(7)
v_mfma_f32_16x16x32_bf16 v[168:171], v[216:219], v[112:115], v[168:171]
ds_read_b128 v[244:247], v250 offset:21760
v_rcp_f16_e64 v199, v198
v_mfma_f32_16x16x32_bf16 v[176:179], v[216:219], v[116:119], v[176:179]
v_rcp_f16_e64 v196, v195
v_mfma_f32_16x16x32_bf16 v[172:175], v[220:223], v[112:115], v[172:175]
ds_read_b128 v[216:219], v250 offset:22528
v_rcp_f16_sdwa v202, v201 dst_sel:WORD_1 dst_unused:UNUSED_PRESERVE src0_sel:WORD_1
v_mfma_f32_16x16x32_bf16 v[180:183], v[220:223], v[116:119], v[180:183]
v_rcp_f16_sdwa v199, v198 dst_sel:WORD_1 dst_unused:UNUSED_PRESERVE src0_sel:WORD_1
v_or_b32 v232, v184, v185
v_or_b32 v233, v186, v187
s_waitcnt lgkmcnt(4)
v_or_b32 v234, v188, v189
v_rcp_f16_sdwa v196, v195 dst_sel:WORD_1 dst_unused:UNUSED_PRESERVE src0_sel:WORD_1
v_or_b32 v235, v190, v191
s_waitcnt lgkmcnt(2)
v_or_b32_e64 v236, v192, v193
v_pk_mul_f16 v237, v203, v202
v_pk_mul_f16 v238, v200, v199
v_pk_mul_f16 v239, v197, v196
v_mfma_f32_16x16x32_f16 v[48:51], v[224:227], v[232:235], v[48:51]
s_add_u32 s46, s68, 98304
buffer_store_dwordx4 v[160:163], v255, s[8:11], s46 offen offset:256 sc1
ds_read_b128 v[220:223], v250 offset:22784
v_cvt_pkrtz_f16_f32 v185, v168, v169
v_cvt_pkrtz_f16_f32 v187, v170, v171
v_cvt_pkrtz_f16_f32 v189, v172, v173
v_cvt_pkrtz_f16_f32 v191, v174, v175
v_mfma_f32_16x16x32_f16 v[56:59], v[224:227], v[236:239], v[56:59]
v_cvt_pkrtz_f16_f32 v193, v176, v177
v_cvt_pk_f16_f32 v203, v178, v179
v_cvt_pk_f16_f32 v200, v180, v181
v_cvt_pk_f16_f32 v197, v182, v183
v_mfma_f32_16x16x32_f16 v[52:55], v[228:231], v[232:235], v[52:55]
ds_read_b128 v[224:227], v250 offset:26624
v_pk_fma_f16 v202, v203, v203, s48
v_and_b32_e64 v185, s49, v185
v_pk_fma_f16 v199, v200, v200, s48
v_and_b32_e64 v187, s49, v187
v_mfma_f32_16x16x32_f16 v[60:63], v[228:231], v[236:239], v[60:63]
v_pk_fma_f16 v196, v197, v197, s48
v_bfe_u32 v184, v185, 2, 14
v_pk_mul_f16 v202, v203, v202
v_bfe_u32 v186, v187, 2, 14
v_mfma_f32_16x16x32_f16 v[64:67], v[240:243], v[232:235], v[64:67]
ds_read_b128 v[228:231], v250 offset:26880
ds_read_u16_d16 v184, v184
ds_read_u16_d16 v186, v186
v_pk_mul_f16 v199, v200, v199
v_lshrrev_b32_e64 v185, 18, v185
v_pk_mul_f16 v196, v197, v196
v_lshrrev_b32_e64 v187, 18, v187
v_mfma_f32_16x16x32_f16 v[72:75], v[240:243], v[236:239], v[72:75]
v_exp_f16 v201, v202
v_and_b32 v189, s49, v189
v_and_b32 v191, s49, v191
s_waitcnt vmcnt(4)
v_mfma_f32_16x16x32_bf16 v[72:75], v[18:21], v[40:43], v[72:75]
ds_read_b128 v[240:243], v250 offset:27648
ds_read_u16_d16_hi v185, v185
ds_read_u16_d16_hi v187, v187
v_exp_f16_e64 v198, v199
v_bfe_u32 v188, v189, 2, 14
v_bfe_u32 v190, v191, 2, 14
v_mfma_f32_16x16x32_bf16 v[76:79], v[16:19], v[40:43], v[76:79]
v_exp_f16 v195, v196
v_lshrrev_b32 v189, 18, v189
v_lshrrev_b32 v191, 18, v191
s_waitcnt lgkmcnt(6)
v_mfma_f32_16x16x32_f16 v[68:71], v[244:247], v[232:235], v[68:71]
ds_read_u16_d16 v188, v188
ds_read_u16_d16 v190, v190
ds_read_u16_d16_hi v189, v189
ds_read_u16_d16_hi v191, v191
v_exp_f16_sdwa v201, v202 dst_sel:WORD_1 dst_unused:UNUSED_PRESERVE src0_sel:WORD_1
v_and_b32_e64 v193, s49, v193
v_bfe_u32 v192, v193, 2, 14
v_mfma_f32_16x16x32_f16 v[76:79], v[244:247], v[236:239], v[76:79]
v_exp_f16_sdwa v198, v199 dst_sel:WORD_1 dst_unused:UNUSED_PRESERVE src0_sel:WORD_1
v_lshrrev_b32_e64 v193, 18, v193
v_mfma_f32_16x16x32_f16 v[80:83], v[216:219], v[232:235], v[80:83]
ds_read_b128 v[244:247], v250 offset:27904
ds_read_u16_d16 v192, v192
ds_read_u16_d16_hi v193, v193
v_exp_f16_sdwa v195, v196 dst_sel:WORD_1 dst_unused:UNUSED_PRESERVE src0_sel:WORD_1
v_pk_add_f16 v201, v201, 1.0 op_sel_hi:[1,0]
v_pk_add_f16 v198, v198, 1.0 op_sel_hi:[1,0]
v_pk_add_f16 v195, v195, 1.0 op_sel_hi:[1,0]
v_mfma_f32_16x16x32_f16 v[88:91], v[216:219], v[236:239], v[88:91]
v_rcp_f16 v202, v201
v_rcp_f16 v199, v198
v_mfma_f32_16x16x32_f16 v[84:87], v[220:223], v[232:235], v[84:87]
ds_read_b128 v[216:219], v250 offset:28672
v_rcp_f16_e64 v196, v195
v_rcp_f16_sdwa v202, v201 dst_sel:WORD_1 dst_unused:UNUSED_PRESERVE src0_sel:WORD_1
v_mfma_f32_16x16x32_f16 v[92:95], v[220:223], v[236:239], v[92:95]
v_rcp_f16_sdwa v199, v198 dst_sel:WORD_1 dst_unused:UNUSED_PRESERVE src0_sel:WORD_1
s_waitcnt lgkmcnt(5)
v_or_b32 v232, v184, v185
v_or_b32_e64 v233, v186, v187
v_or_b32 v234, v188, v189
v_rcp_f16_sdwa v196, v195 dst_sel:WORD_1 dst_unused:UNUSED_PRESERVE src0_sel:WORD_1
s_waitcnt lgkmcnt(4)
v_or_b32 v235, v190, v191
s_waitcnt lgkmcnt(1)
v_or_b32 v236, v192, v193
v_pk_mul_f16 v237, v203, v202
v_pk_mul_f16 v238, v200, v199
v_pk_mul_f16 v239, v197, v196
v_mfma_f32_16x16x32_f16 v[48:51], v[224:227], v[232:235], v[48:51]
ds_read_b128 v[220:223], v250 offset:28928
v_mfma_f32_16x16x32_f16 v[56:59], v[224:227], v[236:239], v[56:59]
v_mfma_f32_16x16x32_f16 v[52:55], v[228:231], v[232:235], v[52:55]
v_mfma_f32_16x16x32_f16 v[60:63], v[228:231], v[236:239], v[60:63]
v_mfma_f32_16x16x32_f16 v[64:67], v[240:243], v[232:235], v[64:67]
v_mfma_f32_16x16x32_f16 v[72:75], v[240:243], v[236:239], v[72:75]
s_waitcnt vmcnt(3)
v_mfma_f32_16x16x32_bf16 v[88:91], v[18:21], v[208:211], v[88:91]
v_mfma_f32_16x16x32_bf16 v[92:95], v[16:19], v[208:211], v[92:95]
v_mfma_f32_16x16x32_f16 v[68:71], v[244:247], v[232:235], v[68:71]
v_mfma_f32_16x16x32_f16 v[76:79], v[244:247], v[236:239], v[76:79]
s_waitcnt lgkmcnt(1)
v_mfma_f32_16x16x32_f16 v[80:83], v[216:219], v[232:235], v[80:83]
v_mfma_f32_16x16x32_f16 v[88:91], v[216:219], v[236:239], v[88:91]
s_waitcnt lgkmcnt(0)
v_mfma_f32_16x16x32_f16 v[84:87], v[220:223], v[232:235], v[84:87]
v_mfma_f32_16x16x32_f16 v[92:95], v[220:223], v[236:239], v[92:95]
v_cvt_pk_bf16_f32 v64, v64, v65
v_cvt_pk_bf16_f32 v65, v66, v67
v_cvt_pk_bf16_f32 v66, v68, v69
v_cvt_pk_bf16_f32 v67, v70, v71
v_cvt_pk_bf16_f32 v48, v48, v49
v_cvt_pk_bf16_f32 v49, v50, v51
v_cvt_pk_bf16_f32 v50, v52, v53
v_cvt_pk_bf16_f32 v51, v54, v55
v_cvt_pk_bf16_f32 v80, v80, v81
v_cvt_pk_bf16_f32 v81, v82, v83
v_cvt_pk_bf16_f32 v82, v84, v85
v_cvt_pk_bf16_f32 v83, v86, v87
s_mov_b64 vcc, s[74:75]
v_cndmask_b32 v68, v48, v80, vcc
v_cndmask_b32 v69, v49, v81, vcc
v_cndmask_b32 v70, v50, v82, vcc
v_cndmask_b32 v71, v51, v83, vcc
v_cndmask_b32_dpp v48, v64, v48, vcc quad_perm:[1,0,3,2] row_mask:0xf bank_mask:0xf
v_cndmask_b32_dpp v49, v65, v49, vcc quad_perm:[1,0,3,2] row_mask:0xf bank_mask:0xf
v_cndmask_b32_dpp v50, v66, v50, vcc quad_perm:[1,0,3,2] row_mask:0xf bank_mask:0xf
v_cndmask_b32_dpp v51, v67, v51, vcc quad_perm:[1,0,3,2] row_mask:0xf bank_mask:0xf
s_not_b64 vcc, s[74:75]
v_cndmask_b32_dpp v80, v64, v80, vcc quad_perm:[1,0,3,2] row_mask:0xf bank_mask:0xf
v_cndmask_b32_dpp v81, v65, v81, vcc quad_perm:[1,0,3,2] row_mask:0xf bank_mask:0xf
v_cndmask_b32_dpp v82, v66, v82, vcc quad_perm:[1,0,3,2] row_mask:0xf bank_mask:0xf
v_cndmask_b32_dpp v83, v67, v83, vcc quad_perm:[1,0,3,2] row_mask:0xf bank_mask:0xf
buffer_store_dwordx4 v[48:51], v255, s[8:11], s69 offen sc1
buffer_store_dwordx4 v[68:71], v255, s[8:11], s69 offen offset:128 sc1
buffer_store_dwordx4 v[80:83], v255, s[8:11], s69 offen offset:256 sc1
v_cvt_pk_bf16_f32 v72, v72, v73
v_cvt_pk_bf16_f32 v73, v74, v75
v_cvt_pk_bf16_f32 v74, v76, v77
v_cvt_pk_bf16_f32 v75, v78, v79
v_cvt_pk_bf16_f32 v56, v56, v57
v_cvt_pk_bf16_f32 v57, v58, v59
v_cvt_pk_bf16_f32 v58, v60, v61
v_cvt_pk_bf16_f32 v59, v62, v63
v_cvt_pk_bf16_f32 v88, v88, v89
v_cvt_pk_bf16_f32 v89, v90, v91
v_cvt_pk_bf16_f32 v90, v92, v93
v_cvt_pk_bf16_f32 v91, v94, v95
s_mov_b64 vcc, s[74:75]
v_cndmask_b32 v76, v56, v88, vcc
v_cndmask_b32 v77, v57, v89, vcc
v_cndmask_b32 v78, v58, v90, vcc
v_cndmask_b32 v79, v59, v91, vcc
v_cndmask_b32_dpp v56, v72, v56, vcc quad_perm:[1,0,3,2] row_mask:0xf bank_mask:0xf
v_cndmask_b32_dpp v57, v73, v57, vcc quad_perm:[1,0,3,2] row_mask:0xf bank_mask:0xf
v_cndmask_b32_dpp v58, v74, v58, vcc quad_perm:[1,0,3,2] row_mask:0xf bank_mask:0xf
v_cndmask_b32_dpp v59, v75, v59, vcc quad_perm:[1,0,3,2] row_mask:0xf bank_mask:0xf
s_not_b64 vcc, s[74:75]
v_cndmask_b32_dpp v88, v72, v88, vcc quad_perm:[1,0,3,2] row_mask:0xf bank_mask:0xf
v_cndmask_b32_dpp v89, v73, v89, vcc quad_perm:[1,0,3,2] row_mask:0xf bank_mask:0xf
v_cndmask_b32_dpp v90, v74, v90, vcc quad_perm:[1,0,3,2] row_mask:0xf bank_mask:0xf
v_cndmask_b32_dpp v91, v75, v91, vcc quad_perm:[1,0,3,2] row_mask:0xf bank_mask:0xf
s_add_u32 s46, s69, 98304
buffer_store_dwordx4 v[56:59], v255, s[8:11], s46 offen sc1
s_add_u32 s46, s69, 98304
buffer_store_dwordx4 v[76:79], v255, s[8:11], s46 offen offset:128 sc1
s_add_u32 s46, s69, 98304
buffer_store_dwordx4 v[88:91], v255, s[8:11], s46 offen offset:256 sc1
s_endpgm
Lpoll:
s_waitcnt vmcnt(0)
Lpoll1:
s_cmp_eq_u32 s77, 2
s_cbranch_scc1 LpollC
v_max_u32 v255, v156, v157
v_max3_u32 v255, v255, v158, v159
v_max3_u32 v255, v255, v160, v161
v_max3_u32 v255, v255, v162, v163
v_max3_u32 v255, v255, v164, v165
v_max3_u32 v255, v255, v166, v167
v_max3_u32 v255, v255, v240, v241
v_max3_u32 v255, v255, v242, v243
v_cmp_eq_u32 vcc, -1, v255
s_nop 4
s_cbranch_vccz LpollR
v_lshlrev_b32 v247, 4, v251
s_lshl_b32 s44, s2, 12
buffer_load_dwordx4 v[156:159], v247, s[32:35], s44 offen sc1
buffer_load_dwordx4 v[160:163], v247, s[32:35], s44 offen offset:1024 sc1
buffer_load_dwordx4 v[164:167], v247, s[32:35], s44 offen offset:2048 sc1
buffer_load_dwordx4 v[240:243], v247, s[32:35], s44 offen offset:3072 sc1
s_setpc_b64 s[78:79]
LpollR:
s_setprio 3
v_add_f32 v156, v156, v160
v_add_f32 v240, v164, v240
v_add_f32 v240, v156, v240
v_add_f32 v157, v157, v161
v_add_f32 v241, v165, v241
v_add_f32 v241, v157, v241
v_add_f32 v158, v158, v162
v_add_f32 v242, v166, v242
v_add_f32 v242, v158, v242
v_add_f32 v159, v159, v163
v_add_f32 v243, v167, v243
v_add_f32 v243, v159, v243
v_add_f32_dpp v240, v240, v240 row_ror:8 row_mask:0xf bank_mask:0xf
s_nop 1
v_add_f32_dpp v240, v240, v240 row_ror:4 row_mask:0xf bank_mask:0xf
s_nop 1
v_add_f32_dpp v240, v240, v240 row_ror:2 row_mask:0xf bank_mask:0xf
s_nop 1
v_add_f32_dpp v240, v240, v240 row_ror:1 row_mask:0xf bank_mask:0xf
v_mov_b32 v255, v240
s_nop 1
v_permlane16_swap_b32 v240, v255
v_add_f32 v240, v240, v255
v_mov_b32 v255, v240
s_nop 1
v_permlane32_swap_b32 v240, v255
v_add_f32 v240, v240, v255
v_min_u32 v240, -2, v240
v_add_f32_dpp v241, v241, v241 row_ror:8 row_mask:0xf bank_mask:0xf
s_nop 1
v_add_f32_dpp v241, v241, v241 row_ror:4 row_mask:0xf bank_mask:0xf
s_nop 1
v_add_f32_dpp v241, v241, v241 row_ror:2 row_mask:0xf bank_mask:0xf
s_nop 1
v_add_f32_dpp v241, v241, v241 row_ror:1 row_mask:0xf bank_mask:0xf
v_mov_b32 v255, v241
s_nop 1
v_permlane16_swap_b32 v241, v255
v_add_f32 v241, v241, v255
v_mov_b32 v255, v241
s_nop 1
v_permlane32_swap_b32 v241, v255
v_add_f32 v241, v241, v255
v_min_u32 v241, -2, v241
v_add_f32_dpp v242, v242, v242 row_ror:8 row_mask:0xf bank_mask:0xf
s_nop 1
v_add_f32_dpp v242, v242, v242 row_ror:4 row_mask:0xf bank_mask:0xf
s_nop 1
v_add_f32_dpp v242, v242, v242 row_ror:2 row_mask:0xf bank_mask:0xf
s_nop 1
v_add_f32_dpp v242, v242, v242 row_ror:1 row_mask:0xf bank_mask:0xf
v_mov_b32 v255, v242
s_nop 1
v_permlane16_swap_b32 v242, v255
v_add_f32 v242, v242, v255
v_mov_b32 v255, v242
s_nop 1
v_permlane32_swap_b32 v242, v255
v_add_f32 v242, v242, v255
v_min_u32 v242, -2, v242
v_add_f32_dpp v243, v243, v243 row_ror:8 row_mask:0xf bank_mask:0xf
s_nop 1
v_add_f32_dpp v243, v243, v243 row_ror:4 row_mask:0xf bank_mask:0xf
s_nop 1
v_add_f32_dpp v243, v243, v243 row_ror:2 row_mask:0xf bank_mask:0xf
s_nop 1
v_add_f32_dpp v243, v243, v243 row_ror:1 row_mask:0xf bank_mask:0xf
v_mov_b32 v255, v243
s_nop 1
v_permlane16_swap_b32 v243, v255
v_add_f32 v243, v243, v255
v_mov_b32 v255, v243
s_nop 1
v_permlane32_swap_b32 v243, v255
v_add_f32_e64 v243, v243, v255
v_min_u32 v243, -2, v243
s_lshl_b32 s44, s2, 4
s_add_u32 s44, s44, 393216
v_lshlrev_b32_e64 v255, 11, v251
s_mov_b64 exec, 0xff
buffer_store_dwordx4 v[240:243], v255, s[32:35], s44 offen sc1
s_mov_b64 exec, -1
s_cmp_eq_u32 s40, 0
s_cselect_b32 s77, 2, 0
s_cbranch_scc0 LpollRx
v_lshlrev_b32_e64 v247, 3, v251
s_and_b32 s44, s2, 7
s_lshl_b32 s44, s44, 11
s_add_u32 s44, s44, 393216
buffer_load_dwordx2 v[156:157], v247, s[32:35], s44 offen sc1
buffer_load_dwordx2 v[158:159], v247, s[32:35], s44 offen offset:512 sc1
buffer_load_dwordx2 v[160:161], v247, s[32:35], s44 offen offset:1024 sc1
LpollRx:
s_setpc_b64 s[78:79]
LpollC:
v_max3_u32 v255, v156, v157, v158
v_max3_u32 v255, v255, v159, v160
v_max_u32 v255, v255, v161
v_cmp_eq_u32 vcc, -1, v255
s_nop 4
s_cbranch_vccz LpollS
v_lshlrev_b32 v247, 3, v251
s_and_b32 s44, s2, 7
s_lshl_b32 s44, s44, 11
s_add_u32 s44, s44, 393216
buffer_load_dwordx2 v[156:157], v247, s[32:35], s44 offen sc1
buffer_load_dwordx2 v[158:159], v247, s[32:35], s44 offen offset:512 sc1
buffer_load_dwordx2 v[160:161], v247, s[32:35], s44 offen offset:1024 sc1
s_setpc_b64 s[78:79]
LpollS:
s_setprio 3
s_mov_b32 s43, 1083296634
v_mov_b32 v162, 897988541
v_fma_f32 v156, v156, s43, v162
v_fma_f32 v157, v157, s43, v162
v_fma_f32 v158, v158, s43, v162
v_fma_f32 v159, v159, s43, v162
v_fma_f32 v160, v160, s43, v162
v_fma_f32 v161, v161, s43, v162
v_sqrt_f32 v156, v156
v_sqrt_f32 v157, v157
v_sqrt_f32 v158, v158
v_sqrt_f32 v159, v159
v_sqrt_f32 v160, v160
v_sqrt_f32 v161, v161
v_add_f32 v163, v156, v157
v_add_f32 v163, v163, v158
v_add_f32 v163, v163, v159
v_add_f32 v163, v163, v160
v_add_f32 v163, v163, v161
s_nop 1
v_add_f32_dpp v163, v163, v163 row_ror:8 row_mask:0xf bank_mask:0xf
s_nop 1
v_add_f32_dpp v163, v163, v163 row_ror:4 row_mask:0xf bank_mask:0xf
s_nop 1
v_add_f32_dpp v163, v163, v163 row_ror:2 row_mask:0xf bank_mask:0xf
s_nop 1
v_add_f32_dpp v163, v163, v163 row_ror:1 row_mask:0xf bank_mask:0xf
v_mov_b32 v255, v163
s_nop 1
v_permlane16_swap_b32 v163, v255
v_add_f32 v163, v163, v255
v_mov_b32 v255, v163
s_nop 1
v_permlane32_swap_b32 v163, v255
v_add_f32_e64 v163, v163, v255
s_mov_b32 s43, 992651947
v_fma_f32 v163, v163, s43, v162
v_rcp_f32_e64 v163, v163
v_mov_b32 v162, 3221789604
v_mul_f32 v163, v163, v162
v_lshlrev_b32 v164, 16, v244
v_and_b32 v165, 4294901760, v244
v_mul_f32 v156, v156, v163
v_mul_f32 v157, v157, v163
v_fma_f32 v164, v164, v156, v162
v_fma_f32 v165, v165, v157, v162
v_cvt_pk_f16_f32 v244, v164, v165
v_lshlrev_b32_e64 v164, 16, v245
v_and_b32 v165, 4294901760, v245
v_mul_f32 v158, v158, v163
v_mul_f32 v159, v159, v163
v_fma_f32 v164, v164, v158, v162
v_fma_f32 v165, v165, v159, v162
v_cvt_pk_f16_f32 v245, v164, v165
v_lshlrev_b32_e64 v164, 16, v246
v_and_b32 v165, 4294901760, v246
v_mul_f32 v160, v160, v163
v_mul_f32 v161, v161, v163
v_fma_f32 v164, v164, v160, v162
v_fma_f32 v165, v165, v161, v162
v_cvt_pk_f16_f32 v246, v164, v165
s_mov_b32 s77, 0
s_setpc_b64 s[78:79]
Lend:
s_endpgm

.section .rodata,"a"
.p2align 6
.amdhsa_kernel standalone__modern_conv_block_convnext_v2__vision_kernel
  .amdhsa_next_free_vgpr 256
  .amdhsa_next_free_sgpr 102
  .amdhsa_accum_offset 256
  .amdhsa_group_segment_fixed_size 0
  .amdhsa_kernarg_size 72
  .amdhsa_user_sgpr_count 2
  .amdhsa_user_sgpr_kernarg_segment_ptr 1
  .amdhsa_system_sgpr_workgroup_id_x 1
.end_amdhsa_kernel
```

```asm
; @launch grid=(256,1,1) block=(512,1,1) lds=163840
.amdgcn_target "amdgcn-amd-amdhsa--gfx950"
.text
.globl standalone__modern_conv_block_convnext_v2__vision_kernel
.p2align 8
.type standalone__modern_conv_block_convnext_v2__vision_kernel,@function
standalone__modern_conv_block_convnext_v2__vision_kernel:
Lmain:
s_cmp_ge_u32 s2, 256
s_cbranch_scc1 Lend
s_load_dwordx16 s[80:95], s[0:1], 0
s_load_dwordx2 s[96:97], s[0:1], 64
s_getpc_b64 s[74:75]
Lpc0:
s_sub_u32 s74, s74, Lpc0-Lmain
s_subb_u32 s75, s75, 0
v_lshlrev_b32 v159, 7, v0
s_movk_i32 s43, 64
v_cmp_gt_u32 vcc, s43, v0
s_and_saveexec_b64 s[78:79], vcc
s_cbranch_execz Lpf0x
global_load_dword v255, v159, s[74:75]
Lpf0x:
s_mov_b64 exec, s[78:79]
v_mov_b32 v199, v0
v_and_b32 v251, 63, v0
v_lshrrev_b32 v120, 6, v0
s_nop 0
v_readfirstlane_b32 s40, v120
s_and_b32 s43, s2, 7
s_lshr_b32 s44, s2, 3
s_and_b32 s41, s43, 0
s_lshl_b32 s41, s41, 4
s_and_b32 s45, s44, 15
s_add_u32 s41, s41, s45
s_lshr_b32 s42, s43, 0
s_lshl_b32 s42, s42, 1
s_lshr_b32 s45, s44, 4
s_add_u32 s42, s42, s45
s_lshl_b32 s41, s41, 5
s_lshl_b32 s42, s42, 5
s_lshl_b32 s67, s40, 6
s_cmp_eq_u32 s40, 6
s_cselect_b32 s67, 352, s67
v_add_u32_e64 v125, s67, v251
v_mul_u32_u24 v121, 5462, v125
v_lshrrev_b32 v121, 16, v121
v_mul_u32_u24 v122, 12, v121
v_sub_u32 v122, v125, v122
v_bfe_u32 v123, v121, 2, 2
v_xor_b32 v122, v122, v123
v_add_u32 v123, s41, v121
v_subrev_u32 v123, 1, v123
v_mul_u32_u24 v124, 192, v123
v_lshl_add_u32 v124, v122, 4, v124
v_mov_b32 v240, 2147483648
s_movk_i32 s43, 512
v_cmp_gt_u32 vcc, s43, v123
s_nop 1
v_cndmask_b32 v124, v240, v124, vcc
v_cmp_gt_u32 vcc, 34, v121
s_nop 1
v_cndmask_b32 v240, v240, v124, vcc
s_add_i32 s43, s42, -1
s_mul_i32 s44, s43, 98304
s_cmp_lt_u32 s43, 512
s_cselect_b32 s46, s44, 1073741824
s_mul_i32 s66, s42, 98304
s_mov_b32 s6, 50331648
s_mov_b32 s7, 131072
s_lshl_b32 s67, s67, 4
s_add_u32 s67, s67, 90112
s_cmp_eq_u32 s40, 7
s_cselect_b32 s67, 163840, s67
v_lshlrev_b32 v130, 1, v199
v_add_u32 v155, 768, v199
v_min_u32 v155, 863, v155
v_lshlrev_b32_e64 v131, 1, v155
s_waitcnt lgkmcnt(0)
s_mov_b32 s4, s80
s_and_b32 s5, s81, 65535
s_cmp_ge_u32 s40, 4
s_cbranch_scc1 Lnodw
s_mov_b32 s20, s82
s_and_b32 s21, s83, 65535
s_mov_b32 s22, 1728
s_mov_b32 s23, 131072
buffer_load_ushort v126, v130, s[20:23], 0 offen offset:0
buffer_load_ushort v127, v130, s[20:23], 0 offen offset:512
buffer_load_ushort v128, v130, s[20:23], 0 offen offset:1024
buffer_load_ushort v129, v131, s[20:23], 0 offen offset:0
Lnodw:
s_cmp_eq_u32 s40, 7
s_cbranch_scc1 Lskipx0
s_add_u32 m0, s67, 0
s_nop 0
buffer_load_dwordx4 v240, s[4:7], s46 offen nt lds
s_add_u32 m0, s67, 6656
s_nop 0
buffer_load_dwordx4 v240, s[4:7], s66 offen nt lds
s_add_u32 m0, s67, 13312
s_add_u32 s45, s66, 98304
buffer_load_dwordx4 v240, s[4:7], s45 offen nt lds
s_add_u32 m0, s67, 19968
s_add_u32 s45, s66, 196608
buffer_load_dwordx4 v240, s[4:7], s45 offen nt lds
s_add_u32 m0, s67, 26624
s_add_u32 s45, s66, 294912
buffer_load_dwordx4 v240, s[4:7], s45 offen nt lds
s_add_u32 m0, s67, 33280
s_add_u32 s45, s66, 393216
buffer_load_dwordx4 v240, s[4:7], s45 offen nt lds
Lskipx0:
s_mov_b32 s12, s84
s_and_b32 s13, s85, 65535
s_mov_b32 s14, 73728
s_mov_b32 s15, 131072
v_lshrrev_b32 v189, 2, v251
v_mul_u32_u24 v189, 768, v189
v_and_b32_e64 v125, 3, v251
v_lshl_add_u32 v189, v125, 4, v189
s_and_b32 s43, s40, 3
s_lshl_b32 s3, s43, 6
s_mul_i32 s77, s43, 6144
s_add_u32 s77, s77, 16384
v_mov_b32 v253, 16256
v_mov_b32 v254, 1
s_add_u32 s43, s42, s40
s_add_u32 s43, s43, 1
s_lshl_b32 s43, s43, 9
s_add_u32 s43, s43, s41
s_mul_i32 s47, s43, 192
s_sub_u32 s47, s47, 256
s_and_b32 s43, s40, 1
s_lshl_b32 s46, s43, 4
s_add_u32 s41, s41, s46
s_and_b32 s43, s40, 6
s_add_u32 s42, s42, s43
s_mul_i32 s45, s43, 6656
s_add_u32 s45, s45, 90112
v_and_b32 v131, 15, v251
v_lshrrev_b32 v132, 4, v251
v_mul_u32_u24 v122, 6656, v132
v_add_u32 v122, s45, v122
v_add_u32 v121, s46, v131
v_mul_u32_u24 v123, 192, v121
v_bfe_u32 v124, v121, 2, 2
v_lshl_add_u32 v123, v124, 4, v123
v_add_u32 v242, v122, v123
v_add_u32 v121, 1, v121
v_mul_u32_u24 v123, 192, v121
v_bfe_u32 v124, v121, 2, 2
v_lshl_add_u32 v123, v124, 4, v123
v_add_u32 v243, v122, v123
v_add_u32 v121, 1, v121
v_mul_u32_u24 v123, 192, v121
v_bfe_u32 v124, v121, 2, 2
v_lshl_add_u32 v123, v124, 4, v123
v_add_u32_e64 v244, v122, v123
s_mul_i32 s72, s40, 9216
s_add_u32 s72, s72, 90112
v_bfe_u32 v133, v131, 2, 1
v_sub_u32 v133, v132, v133
v_lshrrev_b32 v134, 3, v131
v_and_b32_e64 v135, 3, v131
v_lshl_add_u32 v135, v134, 2, v135
v_lshlrev_b32_e64 v136, 7, v133
v_lshl_add_u32 v136, v135, 4, v136
v_add_u32 v136, 156672, v136
v_mov_b32 v135, 163840
v_cmp_gt_u32 vcc, 3, v133
s_nop 1
v_cndmask_b32 v245, v135, v136, vcc
v_and_b32 v135, 3, v131
v_mul_u32_u24 v246, 85, v135
s_mov_b32 s16, s86
s_and_b32 s17, s87, 65535
s_mov_b32 s18, 73728
s_mov_b32 s19, 131072
s_mov_b32 s24, s88
s_and_b32 s25, s89, 65535
s_mov_b32 s26, 768
s_mov_b32 s27, 131072
s_mov_b32 s28, s90
s_and_b32 s29, s91, 65535
s_mov_b32 s30, 768
s_mov_b32 s31, 131072
s_mov_b32 s8, s92
s_and_b32 s9, s93, 65535
s_mov_b32 s10, 50331648
s_mov_b32 s11, 131072
s_mov_b32 s36, s94
s_and_b32 s37, s95, 65535
s_mov_b32 s38, 256
s_mov_b32 s39, 131072
s_mov_b32 s32, s96
s_and_b32 s33, s97, 65535
s_mov_b32 s34, 83886080
s_mov_b32 s35, 131072
v_lshlrev_b32 v241, 4, v251
v_and_b32 v133, 35, v251
v_bfe_u32 v134, v251, 2, 2
v_lshl_add_u32 v133, v134, 3, v133
v_bfe_u32 v134, v251, 4, 1
v_lshl_add_u32 v133, v134, 2, v133
v_lshlrev_b32_e64 v248, 4, v133
v_add_u32 v249, 65536, v248
v_add_u32 v250, 131072, v248
s_lshl_b32 s73, s2, 3
s_add_u32 s73, s73, s40
s_lshl_b32 s80, s73, 10
s_add_u32 s80, s80, 4194304
s_mul_i32 s73, s73, 16
s_add_u32 s73, s73, 1048576
s_mul_i32 s46, s41, 192
s_add_u32 s43, s42, 0
s_mul_i32 s43, s43, 98304
s_add_u32 s68, s43, s46
s_add_u32 s43, s42, 8
s_mul_i32 s43, s43, 98304
s_add_u32 s69, s43, s46
s_add_u32 s43, s42, 16
s_mul_i32 s43, s43, 98304
s_add_u32 s70, s43, s46
s_add_u32 s43, s42, 24
s_mul_i32 s43, s43, 98304
s_add_u32 s71, s43, s46
s_mul_i32 s82, s40, 9216
s_mov_b32 s48, 1156203754
s_mov_b32 s49, 4294508536
s_mov_b32 s76, 400000
v_lshrrev_b32 v148, 5, v251
v_lshlrev_b32 v190, 8, v148
v_bfe_u32 v148, v251, 2, 2
v_lshl_add_u32 v190, v148, 6, v190
v_bfe_u32 v148, v251, 4, 1
v_lshl_add_u32 v190, v148, 5, v190
v_bfe_u32 v148, v251, 0, 1
v_lshl_add_u32 v190, v148, 4, v190
v_bfe_u32 v148, v251, 1, 1
v_lshl_add_u32 v190, v148, 3, v190
v_add_u32 v190, s77, v190
v_add_u32 v191, s77, v248
s_cmp_lt_u32 s40, 4
s_cbranch_scc1 Lnoy
v_lshlrev_b32_e64 v24, 6, v199
s_mov_b32 s43, 1065362610
v_mov_b32 v25, 1084047360
v_add_u32 v0, 32772, v24
v_add_u32 v1, 32780, v24
v_add_u32 v2, 32788, v24
v_add_u32 v3, 32796, v24
v_add_u32 v4, 32804, v24
v_add_u32 v5, 32812, v24
v_add_u32 v6, 32820, v24
v_add_u32 v7, 32828, v24
v_cvt_f32_f16 v0, v0
v_cvt_f32_f16 v1, v1
v_cvt_f32_f16 v2, v2
v_cvt_f32_f16 v3, v3
v_cvt_f32_f16 v4, v4
v_cvt_f32_f16 v5, v5
v_cvt_f32_f16 v6, v6
v_cvt_f32_f16 v7, v7
v_mul_f32 v8, v0, v0
v_mul_f32 v9, v1, v1
v_mul_f32 v10, v2, v2
v_mul_f32 v11, v3, v3
v_mul_f32 v12, v4, v4
v_mul_f32 v13, v5, v5
v_mul_f32 v14, v6, v6
v_mul_f32 v15, v7, v7
v_fma_f32 v8, v8, s43, v25
v_fma_f32 v9, v9, s43, v25
v_fma_f32 v10, v10, s43, v25
v_fma_f32 v11, v11, s43, v25
v_fma_f32 v12, v12, s43, v25
v_fma_f32 v13, v13, s43, v25
v_fma_f32 v14, v14, s43, v25
v_fma_f32 v15, v15, s43, v25
v_mul_f32 v8, v0, v8
v_mul_f32 v9, v1, v9
v_mul_f32 v10, v2, v10
v_mul_f32 v11, v3, v11
v_mul_f32 v12, v4, v12
v_mul_f32 v13, v5, v13
v_mul_f32 v14, v6, v14
v_mul_f32 v15, v7, v15
v_exp_f32 v8, v8
v_exp_f32 v9, v9
v_exp_f32 v10, v10
v_exp_f32 v11, v11
v_exp_f32 v12, v12
v_exp_f32 v13, v13
v_exp_f32 v14, v14
v_exp_f32 v15, v15
v_add_f32 v16, 1.0, v8
v_add_f32 v17, 1.0, v9
v_add_f32 v18, 1.0, v10
v_add_f32 v19, 1.0, v11
v_add_f32 v20, 1.0, v12
v_add_f32 v21, 1.0, v13
v_add_f32 v22, 1.0, v14
v_add_f32 v23, 1.0, v15
v_rcp_f32 v16, v16
v_rcp_f32 v17, v17
v_rcp_f32 v18, v18
v_rcp_f32 v19, v19
v_rcp_f32 v20, v20
v_rcp_f32 v21, v21
v_rcp_f32 v22, v22
v_rcp_f32 v23, v23
v_mul_f32 v0, v0, v16
v_mul_f32 v1, v1, v17
v_mul_f32 v2, v2, v18
v_mul_f32 v3, v3, v19
v_mul_f32 v4, v4, v20
v_mul_f32 v5, v5, v21
v_mul_f32 v6, v6, v22
v_mul_f32 v7, v7, v23
v_mul_f32 v8, v8, v0
v_mul_f32 v9, v9, v1
v_mul_f32 v10, v10, v2
v_mul_f32 v11, v11, v3
v_mul_f32 v12, v12, v4
v_mul_f32 v13, v13, v5
v_mul_f32 v14, v14, v6
v_mul_f32 v15, v15, v7
v_cvt_pk_f16_f32 v28, v0, v1
v_cvt_pk_f16_f32 v32, -v8, -v9
v_cvt_pk_f16_f32 v29, v2, v3
v_cvt_pk_f16_f32 v33, -v10, -v11
v_cvt_pk_f16_f32 v30, v4, v5
v_cvt_pk_f16_f32 v34, -v12, -v13
v_cvt_pk_f16_f32 v31, v6, v7
v_cvt_pk_f16_f32 v35, -v14, -v15
v_lshlrev_b32_e64 v24, 4, v199
v_mov_b32 v25, 163840
s_movk_i32 s43, 496
v_cmp_gt_u32 vcc, s43, v199
s_nop 1
v_cndmask_b32 v24, v25, v24, vcc
ds_write_b128 v24, v[32:35]
ds_write_b128 v24, v[28:31] offset:8192
Lnoy:
s_cmp_ge_u32 s40, 4
s_cbranch_scc1 Lnoo
v_add_u32_e64 v152, 0, v199
v_mul_u32_u24 v140, 683, v152
v_lshrrev_b32 v140, 16, v140
v_mul_u32_u24 v142, 11, v140
v_lshrrev_b32 v142, 5, v142
v_lshrrev_b32 v143, 5, v152
v_bfe_u32 v141, v152, 3, 2
v_bfe_u32 v144, v152, 4, 1
v_xor_b32 v141, v141, v144
v_sub_u32 v141, v141, v142
v_mul_i32_i24 v141, 9, v141
v_add_u32 v143, v143, v141
v_lshrrev_b32_e64 v141, 1, v143
v_mul_u32_u24 v141, 368, v141
v_lshl_add_u32 v143, v143, 3, v141
v_lshl_add_u32 v143, v142, 7, v143
v_and_b32_e64 v144, 7, v152
v_lshl_add_u32 v143, v144, 4, v143
v_add_u32 v156, 156672, v143
v_add_u32 v153, 256, v199
v_mul_u32_u24 v140, 683, v153
v_lshrrev_b32 v140, 16, v140
v_mul_u32_u24 v142, 11, v140
v_lshrrev_b32 v142, 5, v142
v_lshrrev_b32 v143, 5, v153
v_bfe_u32 v141, v153, 3, 2
v_bfe_u32 v144, v153, 4, 1
v_xor_b32 v141, v141, v144
v_sub_u32 v141, v141, v142
v_mul_i32_i24 v141, 9, v141
v_add_u32 v143, v143, v141
v_lshrrev_b32_e64 v141, 1, v143
v_mul_u32_u24 v141, 368, v141
v_lshl_add_u32 v143, v143, 3, v141
v_lshl_add_u32 v143, v142, 7, v143
v_and_b32_e64 v144, 7, v153
v_lshl_add_u32 v143, v144, 4, v143
v_add_u32 v157, 156672, v143
v_add_u32 v154, 512, v199
v_mul_u32_u24 v140, 683, v154
v_lshrrev_b32 v140, 16, v140
v_mul_u32_u24 v142, 11, v140
v_lshrrev_b32 v142, 5, v142
v_lshrrev_b32 v143, 5, v154
v_bfe_u32 v141, v154, 3, 2
v_bfe_u32 v144, v154, 4, 1
v_xor_b32 v141, v141, v144
v_sub_u32 v141, v141, v142
v_mul_i32_i24 v141, 9, v141
v_add_u32 v143, v143, v141
v_lshrrev_b32_e64 v141, 1, v143
v_mul_u32_u24 v141, 368, v141
v_lshl_add_u32 v143, v143, 3, v141
v_lshl_add_u32 v143, v142, 7, v143
v_and_b32_e64 v144, 7, v154
v_lshl_add_u32 v143, v144, 4, v143
v_add_u32 v158, 156672, v143
v_mul_u32_u24 v140, 683, v155
v_lshrrev_b32 v140, 16, v140
v_mul_u32_u24 v142, 11, v140
v_lshrrev_b32 v142, 5, v142
v_lshrrev_b32 v143, 5, v155
v_bfe_u32 v141, v155, 3, 2
v_bfe_u32 v144, v155, 4, 1
v_xor_b32 v141, v141, v144
v_sub_u32 v141, v141, v142
v_mul_i32_i24 v141, 9, v141
v_add_u32 v143, v143, v141
v_lshrrev_b32_e64 v141, 1, v143
v_mul_u32_u24 v141, 368, v141
v_lshl_add_u32 v143, v143, 3, v141
v_lshl_add_u32 v143, v142, 7, v143
v_and_b32_e64 v144, 7, v155
v_lshl_add_u32 v143, v144, 4, v143
v_add_u32 v159, 156672, v143
v_mov_b32 v160, 0
v_mov_b32 v161, 0
v_mov_b32_e64 v162, 0
v_mov_b32 v163, 0
s_mov_b64 exec, 1
ds_write_b128 v253, v[160:163]
ds_write_b128 v253, v[160:163] offset:16
s_mov_b64 exec, -1
s_waitcnt vmcnt(6)
v_and_b32_e64 v130, 4, v152
v_cmp_eq_u32 vcc, 0, v130
s_nop 1
v_cndmask_b32 v164, 0, v126, vcc
v_sub_u32 v165, v126, v164
ds_write_b64 v156, v[164:165]
v_and_b32_e64 v130, 4, v153
v_cmp_eq_u32 vcc, 0, v130
s_nop 1
v_cndmask_b32 v166, 0, v127, vcc
v_sub_u32 v167, v127, v166
ds_write_b64 v157, v[166:167]
v_and_b32_e64 v130, 4, v154
v_cmp_eq_u32 vcc, 0, v130
s_nop 1
v_cndmask_b32 v168, 0, v128, vcc
v_sub_u32 v169, v128, v168
ds_write_b64 v158, v[168:169]
v_and_b32_e64 v130, 4, v155
v_cmp_eq_u32 vcc, 0, v130
s_nop 1
v_cndmask_b32 v170, 0, v129, vcc
v_sub_u32 v171, v129, v170
ds_write_b64 v159, v[170:171]
s_waitcnt lgkmcnt(0)
Lnoo:
s_barrier
s_cmp_lt_u32 s40, 4
s_cbranch_scc1 Lnoy2
v_subrev_u32 v199, 256, v199
v_lshlrev_b32_e64 v24, 6, v199
s_mov_b32 s43, 1065362610
v_mov_b32 v25, 1084047360
v_add_u32 v0, 32772, v24
v_add_u32 v1, 32780, v24
v_add_u32 v2, 32788, v24
v_add_u32 v3, 32796, v24
v_add_u32 v4, 32804, v24
v_add_u32 v5, 32812, v24
v_add_u32 v6, 32820, v24
v_add_u32 v7, 32828, v24
v_cvt_f32_f16 v0, v0
v_cvt_f32_f16 v1, v1
v_cvt_f32_f16 v2, v2
v_cvt_f32_f16 v3, v3
v_cvt_f32_f16 v4, v4
v_cvt_f32_f16 v5, v5
v_cvt_f32_f16 v6, v6
v_cvt_f32_f16 v7, v7
v_mul_f32 v8, v0, v0
v_mul_f32 v9, v1, v1
v_mul_f32 v10, v2, v2
v_mul_f32 v11, v3, v3
v_mul_f32 v12, v4, v4
v_mul_f32 v13, v5, v5
v_mul_f32 v14, v6, v6
v_mul_f32 v15, v7, v7
v_fma_f32 v8, v8, s43, v25
v_fma_f32 v9, v9, s43, v25
v_fma_f32 v10, v10, s43, v25
v_fma_f32 v11, v11, s43, v25
v_fma_f32 v12, v12, s43, v25
v_fma_f32 v13, v13, s43, v25
v_fma_f32 v14, v14, s43, v25
v_fma_f32 v15, v15, s43, v25
v_mul_f32 v8, v0, v8
v_mul_f32 v9, v1, v9
v_mul_f32 v10, v2, v10
v_mul_f32 v11, v3, v11
v_mul_f32 v12, v4, v12
v_mul_f32 v13, v5, v13
v_mul_f32 v14, v6, v14
v_mul_f32 v15, v7, v15
v_exp_f32 v8, v8
v_exp_f32 v9, v9
v_exp_f32 v10, v10
v_exp_f32 v11, v11
v_exp_f32 v12, v12
v_exp_f32 v13, v13
v_exp_f32 v14, v14
v_exp_f32 v15, v15
v_add_f32 v16, 1.0, v8
v_add_f32 v17, 1.0, v9
v_add_f32 v18, 1.0, v10
v_add_f32 v19, 1.0, v11
v_add_f32 v20, 1.0, v12
v_add_f32 v21, 1.0, v13
v_add_f32 v22, 1.0, v14
v_add_f32 v23, 1.0, v15
v_rcp_f32 v16, v16
v_rcp_f32 v17, v17
v_rcp_f32 v18, v18
v_rcp_f32 v19, v19
v_rcp_f32 v20, v20
v_rcp_f32 v21, v21
v_rcp_f32 v22, v22
v_rcp_f32 v23, v23
v_mul_f32 v0, v0, v16
v_mul_f32 v1, v1, v17
v_mul_f32 v2, v2, v18
v_mul_f32 v3, v3, v19
v_mul_f32 v4, v4, v20
v_mul_f32 v5, v5, v21
v_mul_f32 v6, v6, v22
v_mul_f32 v7, v7, v23
v_mul_f32 v8, v8, v0
v_mul_f32 v9, v9, v1
v_mul_f32 v10, v10, v2
v_mul_f32 v11, v11, v3
v_mul_f32 v12, v12, v4
v_mul_f32 v13, v13, v5
v_mul_f32 v14, v14, v6
v_mul_f32 v15, v15, v7
v_cvt_pk_f16_f32 v28, v0, v1
v_cvt_pk_f16_f32 v32, -v8, -v9
v_cvt_pk_f16_f32 v29, v2, v3
v_cvt_pk_f16_f32 v33, -v10, -v11
v_cvt_pk_f16_f32 v30, v4, v5
v_cvt_pk_f16_f32 v34, -v12, -v13
v_cvt_pk_f16_f32 v31, v6, v7
v_cvt_pk_f16_f32 v35, -v14, -v15
v_lshlrev_b32_e64 v24, 4, v199
v_mov_b32 v25, 163840
s_movk_i32 s43, 496
v_cmp_gt_u32 vcc, s43, v199
s_nop 1
v_cndmask_b32 v24, v25, v24, vcc
ds_write_b128 v24, v[32:35]
ds_write_b128 v24, v[28:31] offset:8192
Lnoy2:
s_setprio 2
s_cmp_lt_u32 s40, 4
s_cbranch_scc0 Lsu0
s_call_b64 s[78:79], Lpre
s_call_b64 s[78:79], Lrb
s_waitcnt vmcnt(4)
s_mov_b64 exec, 1
ds_add_u32 v253, v254 offset:28
s_mov_b64 exec, -1
v_mov_b32 v253, 16256
Lsw288w:
ds_read_b32 v247, v253 offset:28
s_waitcnt lgkmcnt(0)
v_readfirstlane_b32 s43, v247
s_cmp_eq_u32 s76, 0
s_cbranch_scc1 Lsw288x
s_sub_u32 s76, s76, 1
s_cmp_lt_u32 s43, 8
s_cbranch_scc0 Lsw288x
s_sleep 2
s_branch Lsw288w
Lsw288x:
s_call_b64 s[78:79], Lconv0
s_mov_b64 exec, 1
ds_add_u32 v253, v254 offset:16
s_mov_b64 exec, -1
s_call_b64 s[78:79], Lln0
s_waitcnt vmcnt(0)
s_mov_b64 exec, 1
ds_add_u32 v253, v254 offset:12
s_mov_b64 exec, -1
s_call_b64 s[78:79], Lw1i
Lsu0:
s_cmp_ge_u32 s40, 4
s_cbranch_scc0 Lsu2
s_setprio 3
s_call_b64 s[78:79], Lw1f
s_waitcnt vmcnt(6)
s_mov_b64 exec, 1
ds_add_u32 v253, v254 offset:28
s_mov_b64 exec, -1
s_call_b64 s[78:79], Lrb
s_waitcnt vmcnt(4)
s_call_b64 s[78:79], Lw1a
s_mov_b64 exec, 1
ds_add_u32 v253, v254 offset:20
s_mov_b64 exec, -1
s_call_b64 s[78:79], Lpre
s_waitcnt vmcnt(0)
s_mov_b64 exec, 1
ds_add_u32 v253, v254 offset:12
s_mov_b64 exec, -1
v_mov_b32 v253, 16256
Lsw128w:
ds_read_b32 v247, v253 offset:12
s_waitcnt lgkmcnt(0)
v_readfirstlane_b32 s43, v247
s_cmp_eq_u32 s76, 0
s_cbranch_scc1 Lsw128x
s_sub_u32 s76, s76, 1
s_cmp_lt_u32 s43, 8
s_cbranch_scc0 Lsw128x
s_sleep 2
s_branch Lsw128w
Lsw128x:
s_call_b64 s[78:79], Lconv0
s_mov_b64 exec, 1
ds_add_u32 v253, v254 offset:16
s_mov_b64 exec, -1
s_call_b64 s[78:79], Lln0
Lsu2:
s_branch Lgo
Lconv0:
ds_read_b128 v[192:195], v242
ds_read_b128 v[196:199], v242 offset:64
ds_read_b128 v[200:203], v242 offset:128
ds_read_b128 v[204:207], v243
ds_read_b128 v[208:211], v243 offset:64
ds_read_b128 v[212:215], v243 offset:128
ds_read_b128 v[224:227], v244
ds_read_b128 v[228:231], v244 offset:64
ds_read_b128 v[232:235], v244 offset:128
v_xor_b32 v242, 16, v242
ds_read_b128 v[236:239], v242
ds_read_b128 v[216:219], v242 offset:64
ds_read_b128 v[220:223], v242 offset:128
s_waitcnt lgkmcnt(11)
v_smfmac_f32_16x16x32_bf16 v[0:3], v[48:49], v[192:195], v246
s_waitcnt lgkmcnt(10)
v_smfmac_f32_16x16x32_bf16 v[16:19], v[50:51], v[196:199], v246
s_waitcnt lgkmcnt(9)
v_smfmac_f32_16x16x32_bf16 v[32:35], v[52:53], v[200:203], v246
s_waitcnt lgkmcnt(8)
v_xor_b32 v243, 16, v243
ds_read_b128 v[192:195], v243
ds_read_b128 v[196:199], v243 offset:64
v_smfmac_f32_16x16x32_bf16 v[0:3], v[54:55], v[204:207], v246
s_waitcnt lgkmcnt(9)
v_smfmac_f32_16x16x32_bf16 v[16:19], v[56:57], v[208:211], v246
s_waitcnt lgkmcnt(8)
ds_read_b128 v[200:203], v243 offset:128
v_xor_b32 v244, 16, v244
ds_read_b128 v[204:207], v244
v_smfmac_f32_16x16x32_bf16 v[32:35], v[58:59], v[212:215], v246
s_waitcnt lgkmcnt(9)
v_smfmac_f32_16x16x32_bf16 v[0:3], v[60:61], v[224:227], v246
s_waitcnt lgkmcnt(8)
ds_read_b128 v[208:211], v244 offset:64
ds_read_b128 v[212:215], v244 offset:128
v_smfmac_f32_16x16x32_bf16 v[16:19], v[62:63], v[228:231], v246
s_waitcnt lgkmcnt(9)
v_smfmac_f32_16x16x32_bf16 v[32:35], v[64:65], v[232:235], v246
s_waitcnt lgkmcnt(8)
v_xor_b32 v242, 32, v242
ds_read_b128 v[224:227], v242
ds_read_b128 v[228:231], v242 offset:64
v_smfmac_f32_16x16x32_bf16 v[4:7], v[66:67], v[236:239], v246
s_waitcnt lgkmcnt(9)
v_smfmac_f32_16x16x32_bf16 v[20:23], v[68:69], v[216:219], v246
s_waitcnt lgkmcnt(8)
ds_read_b128 v[232:235], v242 offset:128
v_xor_b32 v243, 32, v243
ds_read_b128 v[236:239], v243
v_smfmac_f32_16x16x32_bf16 v[36:39], v[70:71], v[220:223], v246
s_waitcnt lgkmcnt(9)
v_smfmac_f32_16x16x32_bf16 v[4:7], v[72:73], v[192:195], v246
s_waitcnt lgkmcnt(8)
ds_read_b128 v[216:219], v243 offset:64
ds_read_b128 v[220:223], v243 offset:128
v_smfmac_f32_16x16x32_bf16 v[20:23], v[74:75], v[196:199], v246
s_waitcnt lgkmcnt(9)
v_smfmac_f32_16x16x32_bf16 v[36:39], v[76:77], v[200:203], v246
s_waitcnt lgkmcnt(8)
v_xor_b32 v244, 32, v244
ds_read_b128 v[192:195], v244
ds_read_b128 v[196:199], v244 offset:64
v_smfmac_f32_16x16x32_bf16 v[4:7], v[78:79], v[204:207], v246
s_waitcnt lgkmcnt(9)
v_smfmac_f32_16x16x32_bf16 v[20:23], v[80:81], v[208:211], v246
s_waitcnt lgkmcnt(8)
ds_read_b128 v[200:203], v244 offset:128
v_xor_b32 v242, 16, v242
ds_read_b128 v[204:207], v242
v_smfmac_f32_16x16x32_bf16 v[36:39], v[82:83], v[212:215], v246
s_waitcnt lgkmcnt(9)
v_smfmac_f32_16x16x32_bf16 v[12:15], v[84:85], v[224:227], v246
s_waitcnt lgkmcnt(8)
ds_read_b128 v[208:211], v242 offset:64
ds_read_b128 v[212:215], v242 offset:128
v_smfmac_f32_16x16x32_bf16 v[28:31], v[86:87], v[228:231], v246
s_waitcnt lgkmcnt(9)
v_smfmac_f32_16x16x32_bf16 v[44:47], v[88:89], v[232:235], v246
s_waitcnt lgkmcnt(8)
v_xor_b32 v243, 16, v243
ds_read_b128 v[224:227], v243
ds_read_b128 v[228:231], v243 offset:64
v_smfmac_f32_16x16x32_bf16 v[12:15], v[90:91], v[236:239], v246
s_waitcnt lgkmcnt(9)
v_smfmac_f32_16x16x32_bf16 v[28:31], v[92:93], v[216:219], v246
s_waitcnt lgkmcnt(8)
ds_read_b128 v[232:235], v243 offset:128
v_xor_b32 v244, 16, v244
ds_read_b128 v[236:239], v244
v_smfmac_f32_16x16x32_bf16 v[44:47], v[94:95], v[220:223], v246
s_waitcnt lgkmcnt(9)
v_smfmac_f32_16x16x32_bf16 v[12:15], v[96:97], v[192:195], v246
s_waitcnt lgkmcnt(8)
ds_read_b128 v[216:219], v244 offset:64
ds_read_b128 v[220:223], v244 offset:128
v_smfmac_f32_16x16x32_bf16 v[28:31], v[98:99], v[196:199], v246
s_waitcnt lgkmcnt(9)
v_smfmac_f32_16x16x32_bf16 v[44:47], v[100:101], v[200:203], v246
s_waitcnt lgkmcnt(8)
v_smfmac_f32_16x16x32_bf16 v[8:11], v[102:103], v[204:207], v246
s_waitcnt lgkmcnt(7)
v_smfmac_f32_16x16x32_bf16 v[24:27], v[104:105], v[208:211], v246
s_waitcnt lgkmcnt(6)
v_smfmac_f32_16x16x32_bf16 v[40:43], v[106:107], v[212:215], v246
s_waitcnt lgkmcnt(5)
v_smfmac_f32_16x16x32_bf16 v[8:11], v[108:109], v[224:227], v246
s_waitcnt lgkmcnt(4)
v_smfmac_f32_16x16x32_bf16 v[24:27], v[110:111], v[228:231], v246
s_waitcnt lgkmcnt(3)
v_smfmac_f32_16x16x32_bf16 v[40:43], v[112:113], v[232:235], v246
s_waitcnt lgkmcnt(2)
v_smfmac_f32_16x16x32_bf16 v[8:11], v[114:115], v[236:239], v246
s_waitcnt lgkmcnt(1)
v_smfmac_f32_16x16x32_bf16 v[24:27], v[116:117], v[216:219], v246
s_waitcnt lgkmcnt(0)
v_smfmac_f32_16x16x32_bf16 v[40:43], v[118:119], v[220:223], v246
s_nop 11
s_setpc_b64 s[78:79]
Lln0:
v_pk_add_f32 v[168:169], v[0:1], v[2:3]
v_pk_mul_f32 v[170:171], v[0:1], v[0:1]
v_pk_fma_f32 v[170:171], v[2:3], v[2:3], v[170:171]
v_pk_add_f32 v[168:169], v[168:169], v[4:5]
v_pk_fma_f32 v[170:171], v[4:5], v[4:5], v[170:171]
v_pk_add_f32 v[168:169], v[168:169], v[6:7]
v_pk_fma_f32 v[170:171], v[6:7], v[6:7], v[170:171]
v_pk_add_f32 v[168:169], v[168:169], v[8:9]
v_pk_fma_f32 v[170:171], v[8:9], v[8:9], v[170:171]
v_pk_add_f32 v[168:169], v[168:169], v[10:11]
v_pk_fma_f32 v[170:171], v[10:11], v[10:11], v[170:171]
v_pk_add_f32 v[168:169], v[168:169], v[12:13]
v_pk_fma_f32 v[170:171], v[12:13], v[12:13], v[170:171]
v_pk_add_f32 v[168:169], v[168:169], v[14:15]
v_pk_fma_f32 v[170:171], v[14:15], v[14:15], v[170:171]
v_pk_add_f32 v[168:169], v[168:169], v[16:17]
v_pk_fma_f32 v[170:171], v[16:17], v[16:17], v[170:171]
v_pk_add_f32 v[168:169], v[168:169], v[18:19]
v_pk_fma_f32 v[170:171], v[18:19], v[18:19], v[170:171]
v_pk_add_f32 v[168:169], v[168:169], v[20:21]
v_pk_fma_f32 v[170:171], v[20:21], v[20:21], v[170:171]
v_pk_add_f32 v[168:169], v[168:169], v[22:23]
v_pk_fma_f32 v[170:171], v[22:23], v[22:23], v[170:171]
v_pk_add_f32 v[168:169], v[168:169], v[24:25]
v_pk_fma_f32 v[170:171], v[24:25], v[24:25], v[170:171]
v_pk_add_f32 v[168:169], v[168:169], v[26:27]
v_pk_fma_f32 v[170:171], v[26:27], v[26:27], v[170:171]
v_pk_add_f32 v[168:169], v[168:169], v[28:29]
v_pk_fma_f32 v[170:171], v[28:29], v[28:29], v[170:171]
v_pk_add_f32 v[168:169], v[168:169], v[30:31]
v_pk_fma_f32 v[170:171], v[30:31], v[30:31], v[170:171]
v_pk_add_f32 v[168:169], v[168:169], v[32:33]
v_pk_fma_f32 v[170:171], v[32:33], v[32:33], v[170:171]
v_pk_add_f32 v[168:169], v[168:169], v[34:35]
v_pk_fma_f32 v[170:171], v[34:35], v[34:35], v[170:171]
v_pk_add_f32 v[168:169], v[168:169], v[36:37]
v_pk_fma_f32 v[170:171], v[36:37], v[36:37], v[170:171]
v_pk_add_f32 v[168:169], v[168:169], v[38:39]
v_pk_fma_f32 v[170:171], v[38:39], v[38:39], v[170:171]
v_pk_add_f32 v[168:169], v[168:169], v[40:41]
v_pk_fma_f32 v[170:171], v[40:41], v[40:41], v[170:171]
v_pk_add_f32 v[168:169], v[168:169], v[42:43]
v_pk_fma_f32 v[170:171], v[42:43], v[42:43], v[170:171]
v_pk_add_f32 v[168:169], v[168:169], v[44:45]
v_pk_fma_f32 v[170:171], v[44:45], v[44:45], v[170:171]
v_pk_add_f32 v[168:169], v[168:169], v[46:47]
v_pk_fma_f32 v[170:171], v[46:47], v[46:47], v[170:171]
v_add_f32 v168, v168, v169
v_add_f32 v170, v170, v171
s_nop 1
v_permlane32_swap_b32 v168, v170
v_add_f32_e64 v168, v168, v170
v_mul_f32 v168, 1009429163, v168
v_mov_b32_e64 v170, v168
s_nop 1
v_permlane32_swap_b32 v168, v170
v_fma_f32 v170, -v168, v168, v170
v_max_f32_e64 v170, 0, v170
v_add_f32 v170, 925353388, v170
v_rsq_f32 v170, v170
s_nop 0
v_mul_f32 v172, 3203391086, v170
v_mul_f32_e64 v173, v168, v172
v_pk_fma_f32 v[0:1], v[0:1], v[172:173], v[172:173] op_sel:[0,0,1] op_sel_hi:[1,0,1] neg_lo:[0,0,1] neg_hi:[0,0,1]
v_pk_fma_f32 v[2:3], v[2:3], v[172:173], v[172:173] op_sel:[0,0,1] op_sel_hi:[1,0,1] neg_lo:[0,0,1] neg_hi:[0,0,1]
v_pk_fma_f32 v[4:5], v[4:5], v[172:173], v[172:173] op_sel:[0,0,1] op_sel_hi:[1,0,1] neg_lo:[0,0,1] neg_hi:[0,0,1]
v_pk_fma_f32 v[6:7], v[6:7], v[172:173], v[172:173] op_sel:[0,0,1] op_sel_hi:[1,0,1] neg_lo:[0,0,1] neg_hi:[0,0,1]
v_pk_fma_f32 v[8:9], v[8:9], v[172:173], v[172:173] op_sel:[0,0,1] op_sel_hi:[1,0,1] neg_lo:[0,0,1] neg_hi:[0,0,1]
v_pk_fma_f32 v[10:11], v[10:11], v[172:173], v[172:173] op_sel:[0,0,1] op_sel_hi:[1,0,1] neg_lo:[0,0,1] neg_hi:[0,0,1]
v_pk_fma_f32 v[12:13], v[12:13], v[172:173], v[172:173] op_sel:[0,0,1] op_sel_hi:[1,0,1] neg_lo:[0,0,1] neg_hi:[0,0,1]
v_pk_fma_f32 v[14:15], v[14:15], v[172:173], v[172:173] op_sel:[0,0,1] op_sel_hi:[1,0,1] neg_lo:[0,0,1] neg_hi:[0,0,1]
v_pk_fma_f32 v[16:17], v[16:17], v[172:173], v[172:173] op_sel:[0,0,1] op_sel_hi:[1,0,1] neg_lo:[0,0,1] neg_hi:[0,0,1]
v_pk_fma_f32 v[18:19], v[18:19], v[172:173], v[172:173] op_sel:[0,0,1] op_sel_hi:[1,0,1] neg_lo:[0,0,1] neg_hi:[0,0,1]
v_pk_fma_f32 v[20:21], v[20:21], v[172:173], v[172:173] op_sel:[0,0,1] op_sel_hi:[1,0,1] neg_lo:[0,0,1] neg_hi:[0,0,1]
v_pk_fma_f32 v[22:23], v[22:23], v[172:173], v[172:173] op_sel:[0,0,1] op_sel_hi:[1,0,1] neg_lo:[0,0,1] neg_hi:[0,0,1]
v_pk_fma_f32 v[24:25], v[24:25], v[172:173], v[172:173] op_sel:[0,0,1] op_sel_hi:[1,0,1] neg_lo:[0,0,1] neg_hi:[0,0,1]
v_pk_fma_f32 v[26:27], v[26:27], v[172:173], v[172:173] op_sel:[0,0,1] op_sel_hi:[1,0,1] neg_lo:[0,0,1] neg_hi:[0,0,1]
v_pk_fma_f32 v[28:29], v[28:29], v[172:173], v[172:173] op_sel:[0,0,1] op_sel_hi:[1,0,1] neg_lo:[0,0,1] neg_hi:[0,0,1]
v_pk_fma_f32 v[30:31], v[30:31], v[172:173], v[172:173] op_sel:[0,0,1] op_sel_hi:[1,0,1] neg_lo:[0,0,1] neg_hi:[0,0,1]
v_pk_fma_f32 v[32:33], v[32:33], v[172:173], v[172:173] op_sel:[0,0,1] op_sel_hi:[1,0,1] neg_lo:[0,0,1] neg_hi:[0,0,1]
v_pk_fma_f32 v[34:35], v[34:35], v[172:173], v[172:173] op_sel:[0,0,1] op_sel_hi:[1,0,1] neg_lo:[0,0,1] neg_hi:[0,0,1]
v_pk_fma_f32 v[36:37], v[36:37], v[172:173], v[172:173] op_sel:[0,0,1] op_sel_hi:[1,0,1] neg_lo:[0,0,1] neg_hi:[0,0,1]
v_pk_fma_f32 v[38:39], v[38:39], v[172:173], v[172:173] op_sel:[0,0,1] op_sel_hi:[1,0,1] neg_lo:[0,0,1] neg_hi:[0,0,1]
v_pk_fma_f32 v[40:41], v[40:41], v[172:173], v[172:173] op_sel:[0,0,1] op_sel_hi:[1,0,1] neg_lo:[0,0,1] neg_hi:[0,0,1]
v_pk_fma_f32 v[42:43], v[42:43], v[172:173], v[172:173] op_sel:[0,0,1] op_sel_hi:[1,0,1] neg_lo:[0,0,1] neg_hi:[0,0,1]
v_pk_fma_f32 v[44:45], v[44:45], v[172:173], v[172:173] op_sel:[0,0,1] op_sel_hi:[1,0,1] neg_lo:[0,0,1] neg_hi:[0,0,1]
v_pk_fma_f32 v[46:47], v[46:47], v[172:173], v[172:173] op_sel:[0,0,1] op_sel_hi:[1,0,1] neg_lo:[0,0,1] neg_hi:[0,0,1]
v_cvt_pk_bf16_f32 v48, v0, v1
v_cvt_pk_bf16_f32 v49, v2, v3
v_cvt_pk_bf16_f32 v50, v4, v5
v_cvt_pk_bf16_f32 v51, v6, v7
v_cvt_pk_bf16_f32 v52, v8, v9
v_cvt_pk_bf16_f32 v53, v10, v11
v_cvt_pk_bf16_f32 v54, v12, v13
v_cvt_pk_bf16_f32 v55, v14, v15
v_cvt_pk_bf16_f32 v56, v16, v17
v_cvt_pk_bf16_f32 v57, v18, v19
v_cvt_pk_bf16_f32 v58, v20, v21
v_cvt_pk_bf16_f32 v59, v22, v23
v_cvt_pk_bf16_f32 v60, v24, v25
v_cvt_pk_bf16_f32 v61, v26, v27
v_cvt_pk_bf16_f32 v62, v28, v29
v_cvt_pk_bf16_f32 v63, v30, v31
v_cvt_pk_bf16_f32 v64, v32, v33
v_cvt_pk_bf16_f32 v65, v34, v35
v_cvt_pk_bf16_f32 v66, v36, v37
v_cvt_pk_bf16_f32 v67, v38, v39
v_cvt_pk_bf16_f32 v68, v40, v41
v_cvt_pk_bf16_f32 v69, v42, v43
v_cvt_pk_bf16_f32 v70, v44, v45
v_cvt_pk_bf16_f32 v71, v46, v47
s_nop 1
s_setpc_b64 s[78:79]
Lw1a:
ds_read_b64_tr_b16 v[148:149], v190
ds_read_b64_tr_b16 v[150:151], v190 offset:512
ds_read_b64_tr_b16 v[152:153], v190 offset:1024
ds_read_b64_tr_b16 v[154:155], v190 offset:1536
ds_read_b64_tr_b16 v[156:157], v190 offset:2048
ds_read_b64_tr_b16 v[158:159], v190 offset:2560
ds_read_b64_tr_b16 v[160:161], v190 offset:3072
ds_read_b64_tr_b16 v[162:163], v190 offset:3584
ds_read_b64_tr_b16 v[164:165], v190 offset:4096
ds_read_b64_tr_b16 v[166:167], v190 offset:4608
ds_read_b64_tr_b16 v[168:169], v190 offset:5120
ds_read_b64_tr_b16 v[170:171], v190 offset:5632
s_waitcnt lgkmcnt(10)
ds_write_b128 v191, v[148:151]
s_waitcnt lgkmcnt(9)
ds_write_b128 v191, v[152:155] offset:1024
s_waitcnt lgkmcnt(8)
ds_write_b128 v191, v[156:159] offset:2048
s_waitcnt lgkmcnt(7)
ds_write_b128 v191, v[160:163] offset:3072
s_waitcnt lgkmcnt(6)
ds_write_b128 v191, v[164:167] offset:4096
s_waitcnt lgkmcnt(5)
ds_write_b128 v191, v[168:171] offset:5120
s_waitcnt lgkmcnt(0)
s_setpc_b64 s[78:79]
Lw1i:
s_add_u32 m0, s77, 24576
s_add_u32 s43, s3, 256
buffer_load_dwordx4 v189, s[12:15], s43 offen lds
s_add_u32 m0, s77, 25600
s_add_u32 s43, s3, 24832
buffer_load_dwordx4 v189, s[12:15], s43 offen lds
s_add_u32 m0, s77, 26624
s_add_u32 s43, s3, 49408
buffer_load_dwordx4 v189, s[12:15], s43 offen lds
s_add_u32 m0, s77, 27648
s_add_u32 s43, s3, 12544
buffer_load_dwordx4 v189, s[12:15], s43 offen lds
s_add_u32 m0, s77, 28672
s_add_u32 s43, s3, 37120
buffer_load_dwordx4 v189, s[12:15], s43 offen lds
s_add_u32 m0, s77, 29696
s_add_u32 s43, s3, 61696
buffer_load_dwordx4 v189, s[12:15], s43 offen lds
s_add_u32 m0, s77, 49152
s_add_u32 s43, s3, 512
buffer_load_dwordx4 v189, s[12:15], s43 offen lds
s_add_u32 m0, s77, 50176
s_add_u32 s43, s3, 25088
buffer_load_dwordx4 v189, s[12:15], s43 offen lds
s_add_u32 m0, s77, 51200
s_add_u32 s43, s3, 49664
buffer_load_dwordx4 v189, s[12:15], s43 offen lds
s_add_u32 m0, s77, 52224
s_add_u32 s43, s3, 12800
buffer_load_dwordx4 v189, s[12:15], s43 offen lds
s_add_u32 m0, s77, 53248
s_add_u32 s43, s3, 37376
buffer_load_dwordx4 v189, s[12:15], s43 offen lds
s_add_u32 m0, s77, 54272
s_add_u32 s43, s3, 61952
buffer_load_dwordx4 v189, s[12:15], s43 offen lds
s_setpc_b64 s[78:79]
Lw1b:
ds_read_b64_tr_b16 v[72:73], v190 offset:24576
ds_read_b64_tr_b16 v[74:75], v190 offset:25088
ds_read_b64_tr_b16 v[76:77], v190 offset:25600
ds_read_b64_tr_b16 v[78:79], v190 offset:26112
ds_read_b64_tr_b16 v[80:81], v190 offset:26624
ds_read_b64_tr_b16 v[82:83], v190 offset:27136
ds_read_b64_tr_b16 v[84:85], v190 offset:27648
ds_read_b64_tr_b16 v[86:87], v190 offset:28160
ds_read_b64_tr_b16 v[88:89], v190 offset:28672
ds_read_b64_tr_b16 v[90:91], v190 offset:29184
ds_read_b64_tr_b16 v[92:93], v190 offset:29696
ds_read_b64_tr_b16 v[94:95], v190 offset:30208
s_waitcnt lgkmcnt(10)
ds_write_b128 v191, v[72:75] offset:24576
s_waitcnt lgkmcnt(9)
ds_write_b128 v191, v[76:79] offset:25600
s_waitcnt lgkmcnt(8)
ds_write_b128 v191, v[80:83] offset:26624
s_waitcnt lgkmcnt(7)
ds_write_b128 v191, v[84:87] offset:27648
s_waitcnt lgkmcnt(6)
ds_write_b128 v191, v[88:91] offset:28672
s_waitcnt lgkmcnt(5)
ds_write_b128 v191, v[92:95] offset:29696
s_waitcnt lgkmcnt(0)
s_setpc_b64 s[78:79]
Lw1c:
ds_read_b64_tr_b16 v[72:73], v190 offset:49152
ds_read_b64_tr_b16 v[74:75], v190 offset:49664
ds_read_b64_tr_b16 v[76:77], v190 offset:50176
ds_read_b64_tr_b16 v[78:79], v190 offset:50688
ds_read_b64_tr_b16 v[80:81], v190 offset:51200
ds_read_b64_tr_b16 v[82:83], v190 offset:51712
ds_read_b64_tr_b16 v[84:85], v190 offset:52224
ds_read_b64_tr_b16 v[86:87], v190 offset:52736
ds_read_b64_tr_b16 v[88:89], v190 offset:53248
ds_read_b64_tr_b16 v[90:91], v190 offset:53760
ds_read_b64_tr_b16 v[92:93], v190 offset:54272
ds_read_b64_tr_b16 v[94:95], v190 offset:54784
s_waitcnt lgkmcnt(10)
ds_write_b128 v191, v[72:75] offset:49152
s_waitcnt lgkmcnt(9)
ds_write_b128 v191, v[76:79] offset:50176
s_waitcnt lgkmcnt(8)
ds_write_b128 v191, v[80:83] offset:51200
s_waitcnt lgkmcnt(7)
ds_write_b128 v191, v[84:87] offset:52224
s_waitcnt lgkmcnt(6)
ds_write_b128 v191, v[88:91] offset:53248
s_waitcnt lgkmcnt(5)
ds_write_b128 v191, v[92:95] offset:54272
s_waitcnt lgkmcnt(0)
s_setpc_b64 s[78:79]
Lpre:
ds_read_b128 v[48:51], v245
ds_read_b128 v[52:55], v245 offset:384
ds_read_b128 v[56:59], v245 offset:768
ds_read_b128 v[60:63], v245 offset:1152
ds_read_b128 v[64:67], v245 offset:1536
ds_read_b128 v[68:71], v245 offset:1920
ds_read_b128 v[72:75], v245 offset:2304
ds_read_b128 v[76:79], v245 offset:2688
ds_read_b128 v[80:83], v245 offset:3072
ds_read_b128 v[84:87], v245 offset:3456
ds_read_b128 v[88:91], v245 offset:3840
ds_read_b128 v[92:95], v245 offset:4224
ds_read_b128 v[96:99], v245 offset:4608
ds_read_b128 v[100:103], v245 offset:4992
ds_read_b128 v[104:107], v245 offset:5376
ds_read_b128 v[108:111], v245 offset:5760
ds_read_b128 v[112:115], v245 offset:6144
ds_read_b128 v[116:119], v245 offset:6528
v_mov_b32 v0, 0
v_mov_b32 v1, 0
v_mov_b32 v2, 0
v_mov_b32 v3, 0
v_mov_b32 v4, 0
v_mov_b32 v5, 0
v_mov_b32 v6, 0
v_mov_b32 v7, 0
v_mov_b32 v8, 0
v_mov_b32 v9, 0
v_mov_b32 v10, 0
v_mov_b32 v11, 0
v_mov_b32 v12, 0
v_mov_b32 v13, 0
v_mov_b32 v14, 0
v_mov_b32 v15, 0
v_mov_b32 v16, 0
v_mov_b32 v17, 0
v_mov_b32 v18, 0
v_mov_b32 v19, 0
v_mov_b32 v20, 0
v_mov_b32 v21, 0
v_mov_b32 v22, 0
v_mov_b32 v23, 0
v_mov_b32 v24, 0
v_mov_b32 v25, 0
v_mov_b32 v26, 0
v_mov_b32 v27, 0
v_mov_b32 v28, 0
v_mov_b32 v29, 0
v_mov_b32 v30, 0
v_mov_b32 v31, 0
v_mov_b32 v32, 0
v_mov_b32 v33, 0
v_mov_b32 v34, 0
v_mov_b32 v35, 0
v_mov_b32 v36, 0
v_mov_b32 v37, 0
v_mov_b32 v38, 0
v_mov_b32 v39, 0
v_mov_b32 v40, 0
v_mov_b32 v41, 0
v_mov_b32 v42, 0
v_mov_b32 v43, 0
v_mov_b32 v44, 0
v_mov_b32 v45, 0
v_mov_b32 v46, 0
v_mov_b32 v47, 0
s_waitcnt lgkmcnt(0)
s_setpc_b64 s[78:79]
Lrb:
s_add_u32 m0, s67, 39936
s_add_u32 s45, s66, 491520
buffer_load_dwordx4 v240, s[4:7], s45 offen nt lds
s_add_u32 m0, s67, 46592
s_add_u32 s45, s66, 589824
buffer_load_dwordx4 v240, s[4:7], s45 offen nt lds
s_add_u32 m0, s67, 53248
s_add_u32 s45, s66, 688128
buffer_load_dwordx4 v240, s[4:7], s45 offen nt lds
s_add_u32 m0, s67, 59904
s_add_u32 s45, s66, 786432
buffer_load_dwordx4 v240, s[4:7], s45 offen nt lds
s_setpc_b64 s[78:79]
Lw1f:
s_add_u32 m0, s77, 0
s_add_u32 s43, s3, 0
buffer_load_dwordx4 v189, s[12:15], s43 offen lds
s_add_u32 m0, s77, 1024
s_add_u32 s43, s3, 24576
buffer_load_dwordx4 v189, s[12:15], s43 offen lds
s_add_u32 m0, s77, 2048
s_add_u32 s43, s3, 49152
buffer_load_dwordx4 v189, s[12:15], s43 offen lds
s_add_u32 m0, s77, 3072
s_add_u32 s43, s3, 12288
buffer_load_dwordx4 v189, s[12:15], s43 offen lds
s_add_u32 m0, s77, 4096
s_add_u32 s43, s3, 36864
buffer_load_dwordx4 v189, s[12:15], s43 offen lds
s_add_u32 m0, s77, 5120
s_add_u32 s43, s3, 61440
buffer_load_dwordx4 v189, s[12:15], s43 offen lds
s_setpc_b64 s[78:79]
Lgo:
v_mov_b32 v253, 16256
Lsw204w:
ds_read_b32 v247, v253 offset:20
s_waitcnt lgkmcnt(0)
v_readfirstlane_b32 s43, v247
s_cmp_eq_u32 s76, 0
s_cbranch_scc1 Lsw204x
s_sub_u32 s76, s76, 1
s_cmp_lt_u32 s43, 4
s_cbranch_scc0 Lsw204x
s_sleep 2
s_branch Lsw204w
Lsw204x:
s_cmp_lg_u32 s40, 7
s_cbranch_scc1 Lnopf
s_getpc_b64 s[74:75]
Lpc:
s_lshr_b32 s43, s2, 3
s_and_b32 s43, s43, 15
s_lshl_b32 s43, s43, 13
v_lshlrev_b32 v102, 7, v251
v_add_u32 v102, s43, v102
v_min_u32 v102, Lend-Lpc, v102
global_load_dword v255, v102, s[74:75]
Lnopf:
s_add_u32 s66, s66, 786432
ds_read_b128 v[224:227], v248 offset:16384
ds_read_b128 v[228:231], v248 offset:19456
ds_read_b128 v[232:235], v248 offset:17408
ds_read_b128 v[236:239], v248 offset:20480
ds_read_b128 v[216:219], v248 offset:18432
ds_read_b128 v[220:223], v248 offset:21504
s_setprio 2
s_waitcnt lgkmcnt(5)
v_mfma_f32_32x32x16_bf16 v[120:135], v[48:51], v[224:227], 0
s_waitcnt lgkmcnt(4)
ds_read_b128 v[224:227], v248 offset:22528
v_mfma_f32_32x32x16_bf16 v[120:135], v[52:55], v[228:231], v[120:135]
s_waitcnt lgkmcnt(4)
ds_read_b128 v[228:231], v248 offset:25600
v_mfma_f32_32x32x16_bf16 v[120:135], v[56:59], v[232:235], v[120:135]
s_waitcnt lgkmcnt(4)
ds_read_b128 v[232:235], v248 offset:23552
v_mfma_f32_32x32x16_bf16 v[120:135], v[60:63], v[236:239], v[120:135]
s_waitcnt lgkmcnt(4)
ds_read_b128 v[236:239], v248 offset:26624
v_mfma_f32_32x32x16_bf16 v[120:135], v[64:67], v[216:219], v[120:135]
s_waitcnt lgkmcnt(4)
ds_read_b128 v[216:219], v248 offset:24576
v_mfma_f32_32x32x16_bf16 v[120:135], v[68:71], v[220:223], v[120:135]
v_add_u32 v174, -36864, v242
v_subrev_u32 v175, 66560, v174
v_min_u32 v174, v174, v175
v_add_u32 v174, 90112, v174
v_sub_u32 v175, v174, v242
v_add_u32 v242, v175, v242
v_add_u32_e64 v243, v175, v243
v_add_u32 v244, v175, v244
s_nop 3
v_cvt_pkrtz_f16_f32 v137, v120, v121
v_cvt_pkrtz_f16_f32 v139, v122, v123
v_cvt_pkrtz_f16_f32 v141, v124, v125
v_cvt_pkrtz_f16_f32 v143, v126, v127
v_cvt_pkrtz_f16_f32 v177, v128, v129
v_cvt_pk_f16_f32 v155, v130, v131
v_cvt_pk_f16_f32 v152, v132, v133
v_cvt_pk_f16_f32 v149, v134, v135
s_waitcnt lgkmcnt(1)
ds_read_b128 v[220:223], v248 offset:27648
v_mfma_f32_32x32x16_bf16 v[120:135], v[48:51], v[224:227], 0
v_pk_fma_f16 v154, v155, v155, s48
v_and_b32 v137, s49, v137
v_pk_fma_f16 v151, v152, v152, s48
v_pk_fma_f16 v148, v149, v149, s48
v_bfe_u32 v136, v137, 2, 14
v_pk_mul_f16 v154, v155, v154
v_pk_mul_f16 v151, v152, v151
v_pk_mul_f16 v148, v149, v148
ds_read_b128 v[224:227], v248 offset:28672
ds_read_u16_d16 v136, v136
v_mfma_f32_32x32x16_bf16 v[120:135], v[52:55], v[228:231], v[120:135]
v_lshrrev_b32 v137, 18, v137
v_exp_f16 v153, v154
v_exp_f16 v150, v151
v_and_b32 v139, s49, v139
v_exp_f16_e64 v147, v148
v_bfe_u32 v138, v139, 2, 14
ds_read_b128 v[228:231], v248 offset:31744
ds_read_u16_d16_hi v137, v137
ds_read_u16_d16 v138, v138
v_mfma_f32_32x32x16_bf16 v[120:135], v[56:59], v[232:235], v[120:135]
v_exp_f16_sdwa v153, v154 dst_sel:WORD_1 dst_unused:UNUSED_PRESERVE src0_sel:WORD_1
v_lshrrev_b32_e64 v139, 18, v139
v_exp_f16_sdwa v150, v151 dst_sel:WORD_1 dst_unused:UNUSED_PRESERVE src0_sel:WORD_1
v_exp_f16_sdwa v147, v148 dst_sel:WORD_1 dst_unused:UNUSED_PRESERVE src0_sel:WORD_1
v_and_b32_e64 v141, s49, v141
ds_read_b128 v[232:235], v248 offset:29696
ds_read_u16_d16_hi v139, v139
v_mfma_f32_32x32x16_bf16 v[120:135], v[60:63], v[236:239], v[120:135]
v_pk_add_f16 v153, v153, 1.0 op_sel_hi:[1,0]
v_bfe_u32 v140, v141, 2, 14
v_pk_add_f16 v150, v150, 1.0 op_sel_hi:[1,0]
v_pk_add_f16 v147, v147, 1.0 op_sel_hi:[1,0]
v_rcp_f16 v154, v153
v_lshrrev_b32 v141, 18, v141
v_rcp_f16 v151, v150
s_waitcnt lgkmcnt(5)
ds_read_b128 v[236:239], v248 offset:32768
ds_read_u16_d16 v140, v140
ds_read_u16_d16_hi v141, v141
v_mfma_f32_32x32x16_bf16 v[120:135], v[64:67], v[216:219], v[120:135]
v_and_b32 v143, s49, v143
v_rcp_f16 v148, v147
v_bfe_u32 v142, v143, 2, 14
v_rcp_f16_sdwa v154, v153 dst_sel:WORD_1 dst_unused:UNUSED_PRESERVE src0_sel:WORD_1
v_rcp_f16_sdwa v151, v150 dst_sel:WORD_1 dst_unused:UNUSED_PRESERVE src0_sel:WORD_1
ds_read_b128 v[216:219], v248 offset:30720
ds_read_u16_d16 v142, v142
ds_read_b32 v247, v253 offset:16
v_mfma_f32_32x32x16_bf16 v[120:135], v[68:71], v[220:223], v[120:135]
v_lshrrev_b32_e64 v143, 18, v143
v_rcp_f16_sdwa v148, v147 dst_sel:WORD_1 dst_unused:UNUSED_PRESERVE src0_sel:WORD_1
v_and_b32_e64 v177, s49, v177
v_pk_mul_f16 v155, v155, v154
v_pk_mul_f16 v152, v152, v151
v_bfe_u32 v176, v177, 2, 14
v_pk_mul_f16 v149, v149, v148
v_fma_mix_f32 v156, v155, v155, 0 op_sel:[0,0,0] op_sel_hi:[1,1,0]
v_fma_mix_f32 v156, v155, v155, v156 op_sel:[1,1,0] op_sel_hi:[1,1,0]
v_lshrrev_b32_e64 v177, 18, v177
v_fma_mix_f32 v156, v152, v152, v156 op_sel:[0,0,0] op_sel_hi:[1,1,0]
v_fma_mix_f32 v156, v152, v152, v156 op_sel:[1,1,0] op_sel_hi:[1,1,0]
v_fma_mix_f32 v156, v149, v149, v156 op_sel:[0,0,0] op_sel_hi:[1,1,0]
v_fma_mix_f32 v156, v149, v149, v156 op_sel:[1,1,0] op_sel_hi:[1,1,0]
ds_read_u16_d16_hi v143, v143
ds_read_u16_d16 v176, v176
ds_read_u16_d16_hi v177, v177
s_waitcnt lgkmcnt(3)
v_readfirstlane_b32 s43, v247
s_nop 1
s_cmp_ge_u32 s43, 8
s_cbranch_scc1 Lev1
Lev1w:
s_sleep 1
ds_read_b32 v247, v253 offset:16
s_waitcnt lgkmcnt(0)
v_readfirstlane_b32 s43, v247
s_cmp_eq_u32 s76, 0
s_cbranch_scc1 Lev1
s_sub_u32 s76, s76, 1
s_cmp_lt_u32 s43, 8
s_cbranch_scc1 Lev1w
Lev1:
v_cvt_pkrtz_f16_f32 v179, v120, v121
v_cvt_pkrtz_f16_f32 v181, v122, v123
v_cvt_pkrtz_f16_f32 v183, v124, v125
v_cvt_pkrtz_f16_f32 v185, v126, v127
v_cvt_pkrtz_f16_f32 v187, v128, v129
v_cvt_pk_f16_f32 v155, v130, v131
v_cvt_pk_f16_f32 v152, v132, v133
v_cvt_pk_f16_f32 v149, v134, v135
s_add_u32 m0, s67, 0
s_add_u32 s66, s66, 98304
buffer_load_dwordx4 v240, s[4:7], s66 offen lds
ds_read_b128 v[220:223], v248 offset:33792
v_mfma_f32_32x32x16_bf16 v[120:135], v[48:51], v[224:227], 0
v_pk_fma_f16 v154, v155, v155, s48
v_and_b32_e64 v179, s49, v179
v_fma_mix_f32 v156, v136, v136, v156 op_sel:[0,0,0] op_sel_hi:[1,1,0]
v_pk_fma_f16 v151, v152, v152, s48
v_pk_fma_f16 v148, v149, v149, s48
v_bfe_u32 v178, v179, 2, 14
v_pk_mul_f16 v154, v155, v154
v_pk_mul_f16 v151, v152, v151
v_fma_mix_f32 v156, v137, v137, v156 op_sel:[1,1,0] op_sel_hi:[1,1,0]
v_lshrrev_b32_e64 v179, 18, v179
s_add_u32 m0, s67, 6656
s_add_u32 s66, s66, 98304
buffer_load_dwordx4 v240, s[4:7], s66 offen lds
ds_read_b128 v[224:227], v248 offset:34816
ds_read_u16_d16 v178, v178
ds_read_u16_d16_hi v179, v179
v_mfma_f32_32x32x16_bf16 v[120:135], v[52:55], v[228:231], v[120:135]
v_pk_mul_f16 v148, v149, v148
v_exp_f16 v153, v154
v_exp_f16 v150, v151
v_and_b32_e64 v181, s49, v181
v_fma_mix_f32 v156, v138, v138, v156 op_sel:[0,0,0] op_sel_hi:[1,1,0]
v_exp_f16_e64 v147, v148
v_bfe_u32 v180, v181, 2, 14
s_add_u32 m0, s67, 13312
s_add_u32 s66, s66, 98304
buffer_load_dwordx4 v240, s[4:7], s66 offen lds
ds_read_b128 v[228:231], v248 offset:37888
ds_read_u16_d16 v180, v180
v_mfma_f32_32x32x16_bf16 v[120:135], v[56:59], v[232:235], v[120:135]
v_exp_f16_sdwa v153, v154 dst_sel:WORD_1 dst_unused:UNUSED_PRESERVE src0_sel:WORD_1
v_lshrrev_b32_e64 v181, 18, v181
v_fma_mix_f32 v156, v139, v139, v156 op_sel:[1,1,0] op_sel_hi:[1,1,0]
v_exp_f16_sdwa v150, v151 dst_sel:WORD_1 dst_unused:UNUSED_PRESERVE src0_sel:WORD_1
v_exp_f16_sdwa v147, v148 dst_sel:WORD_1 dst_unused:UNUSED_PRESERVE src0_sel:WORD_1
v_and_b32_e64 v183, s49, v183
v_fma_mix_f32 v156, v140, v140, v156 op_sel:[0,0,0] op_sel_hi:[1,1,0]
s_add_u32 m0, s67, 19968
s_add_u32 s66, s66, 98304
buffer_load_dwordx4 v240, s[4:7], s66 offen lds
s_add_u32 m0, s67, 26624
s_add_u32 s66, s66, 98304
buffer_load_dwordx4 v240, s[4:7], s66 offen lds
ds_read_b128 v[232:235], v248 offset:35840
ds_read_u16_d16_hi v181, v181
v_mfma_f32_32x32x16_bf16 v[120:135], v[60:63], v[236:239], v[120:135]
v_pk_add_f16 v153, v153, 1.0 op_sel_hi:[1,0]
v_bfe_u32 v182, v183, 2, 14
v_pk_add_f16 v150, v150, 1.0 op_sel_hi:[1,0]
v_pk_add_f16 v147, v147, 1.0 op_sel_hi:[1,0]
v_rcp_f16 v154, v153
v_lshrrev_b32 v183, 18, v183
v_fma_mix_f32 v156, v141, v141, v156 op_sel:[1,1,0] op_sel_hi:[1,1,0]
v_rcp_f16_e64 v151, v150
s_add_u32 m0, s67, 33280
s_add_u32 s66, s66, 98304
buffer_load_dwordx4 v240, s[4:7], s66 offen lds
ds_read_b128 v[236:239], v248 offset:38912
ds_read_u16_d16 v182, v182
ds_read_u16_d16_hi v183, v183
v_mfma_f32_32x32x16_bf16 v[120:135], v[64:67], v[216:219], v[120:135]
v_and_b32 v185, s49, v185
v_rcp_f16 v148, v147
v_fma_mix_f32 v156, v142, v142, v156 op_sel:[0,0,0] op_sel_hi:[1,1,0]
v_bfe_u32 v184, v185, 2, 14
v_rcp_f16_sdwa v154, v153 dst_sel:WORD_1 dst_unused:UNUSED_PRESERVE src0_sel:WORD_1
v_rcp_f16_sdwa v151, v150 dst_sel:WORD_1 dst_unused:UNUSED_PRESERVE src0_sel:WORD_1
v_lshrrev_b32 v185, 18, v185
s_waitcnt lgkmcnt(4)
s_add_u32 m0, s67, 39936
s_add_u32 s66, s66, 98304
buffer_load_dwordx4 v240, s[4:7], s66 offen lds
ds_read_b128 v[216:219], v248 offset:36864
ds_read_u16_d16 v184, v184
ds_read_u16_d16_hi v185, v185
v_mfma_f32_32x32x16_bf16 v[120:135], v[68:71], v[220:223], v[120:135]
v_fma_mix_f32 v156, v143, v143, v156 op_sel:[1,1,0] op_sel_hi:[1,1,0]
v_rcp_f16_sdwa v148, v147 dst_sel:WORD_1 dst_unused:UNUSED_PRESERVE src0_sel:WORD_1
v_and_b32_e64 v187, s49, v187
v_pk_mul_f16 v155, v155, v154
v_fma_mix_f32 v156, v176, v176, v156 op_sel:[0,0,0] op_sel_hi:[1,1,0]
v_pk_mul_f16 v152, v152, v151
v_bfe_u32 v186, v187, 2, 14
v_pk_mul_f16 v149, v149, v148
v_fma_mix_f32 v157, v155, v155, 0 op_sel:[0,0,0] op_sel_hi:[1,1,0]
s_add_u32 m0, s67, 46592
s_add_u32 s66, s66, 98304
buffer_load_dwordx4 v240, s[4:7], s66 offen lds
v_fma_mix_f32 v157, v155, v155, v157 op_sel:[1,1,0] op_sel_hi:[1,1,0]
v_lshrrev_b32 v187, 18, v187
v_fma_mix_f32 v156, v177, v177, v156 op_sel:[1,1,0] op_sel_hi:[1,1,0]
v_fma_mix_f32 v157, v152, v152, v157 op_sel:[0,0,0] op_sel_hi:[1,1,0]
v_fma_mix_f32 v157, v152, v152, v157 op_sel:[1,1,0] op_sel_hi:[1,1,0]
v_fma_mix_f32 v157, v149, v149, v157 op_sel:[0,0,0] op_sel_hi:[1,1,0]
v_fma_mix_f32 v157, v149, v149, v157 op_sel:[1,1,0] op_sel_hi:[1,1,0]
s_cmp_lt_u32 s40, 4
s_cbranch_scc0 Lsu5
s_waitcnt vmcnt(14)
s_call_b64 s[78:79], Lw1b
s_mov_b64 exec, 1
ds_add_u32 v253, v254 offset:24
s_mov_b64 exec, -1
Lsu5:
s_setprio 1
v_cvt_pkrtz_f16_f32 v137, v120, v121
v_cvt_pkrtz_f16_f32 v139, v122, v123
v_cvt_pkrtz_f16_f32 v141, v124, v125
v_cvt_pkrtz_f16_f32 v143, v126, v127
v_cvt_pkrtz_f16_f32 v177, v128, v129
v_cvt_pk_f16_f32 v155, v130, v131
v_cvt_pk_f16_f32 v152, v132, v133
v_cvt_pk_f16_f32 v149, v134, v135
ds_read_b128 v[220:223], v248 offset:39936
ds_read_u16_d16 v186, v186
ds_read_u16_d16_hi v187, v187
v_mfma_f32_32x32x16_bf16 v[120:135], v[48:51], v[224:227], 0
v_pk_fma_f16 v154, v155, v155, s48
v_and_b32_e64 v137, s49, v137
v_fma_mix_f32 v157, v178, v178, v157 op_sel:[0,0,0] op_sel_hi:[1,1,0]
v_pk_fma_f16 v151, v152, v152, s48
v_pk_fma_f16 v148, v149, v149, s48
v_bfe_u32 v136, v137, 2, 14
v_pk_mul_f16 v154, v155, v154
v_pk_mul_f16 v151, v152, v151
v_fma_mix_f32 v157, v179, v179, v157 op_sel:[1,1,0] op_sel_hi:[1,1,0]
v_lshrrev_b32_e64 v137, 18, v137
ds_read_u16_d16 v136, v136
ds_read_b32 v247, v253 offset:24
ds_read_u16_d16_hi v137, v137
v_mfma_f32_32x32x16_bf16 v[120:135], v[52:55], v[228:231], v[120:135]
v_pk_mul_f16 v148, v149, v148
v_exp_f16 v153, v154
v_exp_f16 v150, v151
v_and_b32_e64 v139, s49, v139
v_fma_mix_f32 v157, v180, v180, v157 op_sel:[0,0,0] op_sel_hi:[1,1,0]
v_exp_f16_e64 v147, v148
v_bfe_u32 v138, v139, 2, 14
ds_read_u16_d16 v138, v138
v_mfma_f32_32x32x16_bf16 v[120:135], v[56:59], v[232:235], v[120:135]
v_exp_f16_sdwa v153, v154 dst_sel:WORD_1 dst_unused:UNUSED_PRESERVE src0_sel:WORD_1
v_lshrrev_b32 v139, 18, v139
s_waitcnt lgkmcnt(4)
v_fma_mix_f32 v157, v181, v181, v157 op_sel:[1,1,0] op_sel_hi:[1,1,0]
v_exp_f16_sdwa v150, v151 dst_sel:WORD_1 dst_unused:UNUSED_PRESERVE src0_sel:WORD_1
v_exp_f16_sdwa v147, v148 dst_sel:WORD_1 dst_unused:UNUSED_PRESERVE src0_sel:WORD_1
v_and_b32 v141, s49, v141
v_fma_mix_f32 v157, v182, v182, v157 op_sel:[0,0,0] op_sel_hi:[1,1,0]
ds_read_u16_d16_hi v139, v139
s_waitcnt lgkmcnt(3)
v_readfirstlane_b32 s43, v247
s_nop 1
s_cmp_ge_u32 s43, 4
s_cbranch_scc1 Lev2
Lev2w:
s_sleep 1
ds_read_b32 v247, v253 offset:24
s_waitcnt lgkmcnt(0)
v_readfirstlane_b32 s43, v247
s_cmp_eq_u32 s76, 0
s_cbranch_scc1 Lev2
s_sub_u32 s76, s76, 1
s_cmp_lt_u32 s43, 4
s_cbranch_scc1 Lev2w
Lev2:
ds_read_b128 v[224:227], v248 offset:40960
ds_read_b128 v[228:231], v248 offset:44032
ds_read_b128 v[232:235], v248 offset:41984
v_mfma_f32_32x32x16_bf16 v[120:135], v[60:63], v[236:239], v[120:135]
v_pk_add_f16 v153, v153, 1.0 op_sel_hi:[1,0]
v_bfe_u32 v140, v141, 2, 14
v_pk_add_f16 v150, v150, 1.0 op_sel_hi:[1,0]
v_pk_add_f16 v147, v147, 1.0 op_sel_hi:[1,0]
v_rcp_f16 v154, v153
v_lshrrev_b32 v141, 18, v141
v_fma_mix_f32 v157, v183, v183, v157 op_sel:[1,1,0] op_sel_hi:[1,1,0]
v_rcp_f16_e64 v151, v150
ds_read_b128 v[236:239], v248 offset:45056
ds_read_u16_d16 v140, v140
ds_read_u16_d16_hi v141, v141
v_mfma_f32_32x32x16_bf16 v[120:135], v[64:67], v[216:219], v[120:135]
v_and_b32 v143, s49, v143
v_rcp_f16 v148, v147
v_fma_mix_f32 v157, v184, v184, v157 op_sel:[0,0,0] op_sel_hi:[1,1,0]
v_bfe_u32 v142, v143, 2, 14
v_rcp_f16_sdwa v154, v153 dst_sel:WORD_1 dst_unused:UNUSED_PRESERVE src0_sel:WORD_1
v_rcp_f16_sdwa v151, v150 dst_sel:WORD_1 dst_unused:UNUSED_PRESERVE src0_sel:WORD_1
v_lshrrev_b32_e64 v143, 18, v143
ds_read_b128 v[216:219], v248 offset:43008
ds_read_u16_d16 v142, v142
ds_read_u16_d16_hi v143, v143
v_mfma_f32_32x32x16_bf16 v[120:135], v[68:71], v[220:223], v[120:135]
v_fma_mix_f32 v157, v185, v185, v157 op_sel:[1,1,0] op_sel_hi:[1,1,0]
v_rcp_f16_sdwa v148, v147 dst_sel:WORD_1 dst_unused:UNUSED_PRESERVE src0_sel:WORD_1
v_and_b32_e64 v177, s49, v177
v_pk_mul_f16 v155, v155, v154
v_fma_mix_f32 v157, v186, v186, v157 op_sel:[0,0,0] op_sel_hi:[1,1,0]
v_pk_mul_f16 v152, v152, v151
v_bfe_u32 v176, v177, 2, 14
v_pk_mul_f16 v149, v149, v148
v_fma_mix_f32 v158, v155, v155, 0 op_sel:[0,0,0] op_sel_hi:[1,1,0]
v_fma_mix_f32 v158, v155, v155, v158 op_sel:[1,1,0] op_sel_hi:[1,1,0]
v_lshrrev_b32_e64 v177, 18, v177
v_fma_mix_f32 v157, v187, v187, v157 op_sel:[1,1,0] op_sel_hi:[1,1,0]
v_fma_mix_f32 v158, v152, v152, v158 op_sel:[0,0,0] op_sel_hi:[1,1,0]
v_fma_mix_f32 v158, v152, v152, v158 op_sel:[1,1,0] op_sel_hi:[1,1,0]
v_fma_mix_f32 v158, v149, v149, v158 op_sel:[0,0,0] op_sel_hi:[1,1,0]
v_fma_mix_f32 v158, v149, v149, v158 op_sel:[1,1,0] op_sel_hi:[1,1,0]
v_cvt_pkrtz_f16_f32 v179, v120, v121
v_cvt_pkrtz_f16_f32 v181, v122, v123
v_cvt_pkrtz_f16_f32 v183, v124, v125
v_cvt_pkrtz_f16_f32 v185, v126, v127
v_cvt_pkrtz_f16_f32 v187, v128, v129
v_cvt_pk_f16_f32 v155, v130, v131
v_cvt_pk_f16_f32 v152, v132, v133
v_cvt_pk_f16_f32 v149, v134, v135
s_waitcnt lgkmcnt(0)
ds_read_b128 v[220:223], v248 offset:46080
ds_read_u16_d16 v176, v176
ds_read_u16_d16_hi v177, v177
v_mfma_f32_32x32x16_bf16 v[120:135], v[48:51], v[224:227], 0
v_pk_fma_f16 v154, v155, v155, s48
v_and_b32 v179, s49, v179
v_fma_mix_f32 v158, v136, v136, v158 op_sel:[0,0,0] op_sel_hi:[1,1,0]
v_pk_fma_f16 v151, v152, v152, s48
v_pk_fma_f16 v148, v149, v149, s48
v_bfe_u32 v178, v179, 2, 14
v_pk_mul_f16 v154, v155, v154
v_pk_mul_f16 v151, v152, v151
v_fma_mix_f32 v158, v137, v137, v158 op_sel:[1,1,0] op_sel_hi:[1,1,0]
v_lshrrev_b32_e64 v179, 18, v179
ds_read_b128 v[224:227], v248 offset:47104
ds_read_u16_d16 v178, v178
ds_read_u16_d16_hi v179, v179
v_mfma_f32_32x32x16_bf16 v[120:135], v[52:55], v[228:231], v[120:135]
v_pk_mul_f16 v148, v149, v148
v_exp_f16 v153, v154
v_exp_f16 v150, v151
v_and_b32_e64 v181, s49, v181
v_fma_mix_f32 v158, v138, v138, v158 op_sel:[0,0,0] op_sel_hi:[1,1,0]
v_exp_f16_e64 v147, v148
v_bfe_u32 v180, v181, 2, 14
ds_read_b128 v[228:231], v248 offset:50176
ds_read_u16_d16 v180, v180
v_mfma_f32_32x32x16_bf16 v[120:135], v[56:59], v[232:235], v[120:135]
v_exp_f16_sdwa v153, v154 dst_sel:WORD_1 dst_unused:UNUSED_PRESERVE src0_sel:WORD_1
v_lshrrev_b32_e64 v181, 18, v181
v_fma_mix_f32 v158, v139, v139, v158 op_sel:[1,1,0] op_sel_hi:[1,1,0]
v_exp_f16_sdwa v150, v151 dst_sel:WORD_1 dst_unused:UNUSED_PRESERVE src0_sel:WORD_1
v_exp_f16_sdwa v147, v148 dst_sel:WORD_1 dst_unused:UNUSED_PRESERVE src0_sel:WORD_1
v_and_b32_e64 v183, s49, v183
v_fma_mix_f32 v158, v140, v140, v158 op_sel:[0,0,0] op_sel_hi:[1,1,0]
ds_read_b128 v[232:235], v248 offset:48128
ds_read_u16_d16_hi v181, v181
v_mfma_f32_32x32x16_bf16 v[120:135], v[60:63], v[236:239], v[120:135]
v_pk_add_f16 v153, v153, 1.0 op_sel_hi:[1,0]
v_bfe_u32 v182, v183, 2, 14
v_pk_add_f16 v150, v150, 1.0 op_sel_hi:[1,0]
v_pk_add_f16 v147, v147, 1.0 op_sel_hi:[1,0]
v_rcp_f16 v154, v153
v_lshrrev_b32 v183, 18, v183
v_fma_mix_f32 v158, v141, v141, v158 op_sel:[1,1,0] op_sel_hi:[1,1,0]
v_rcp_f16_e64 v151, v150
ds_read_b128 v[236:239], v248 offset:51200
ds_read_u16_d16 v182, v182
ds_read_u16_d16_hi v183, v183
v_mfma_f32_32x32x16_bf16 v[120:135], v[64:67], v[216:219], v[120:135]
v_and_b32 v185, s49, v185
v_rcp_f16 v148, v147
v_fma_mix_f32 v158, v142, v142, v158 op_sel:[0,0,0] op_sel_hi:[1,1,0]
v_bfe_u32 v184, v185, 2, 14
v_rcp_f16_sdwa v154, v153 dst_sel:WORD_1 dst_unused:UNUSED_PRESERVE src0_sel:WORD_1
v_rcp_f16_sdwa v151, v150 dst_sel:WORD_1 dst_unused:UNUSED_PRESERVE src0_sel:WORD_1
v_lshrrev_b32 v185, 18, v185
s_waitcnt lgkmcnt(5)
ds_read_b128 v[216:219], v248 offset:49152
ds_read_u16_d16 v184, v184
ds_read_u16_d16_hi v185, v185
v_mfma_f32_32x32x16_bf16 v[120:135], v[68:71], v[220:223], v[120:135]
v_fma_mix_f32 v158, v143, v143, v158 op_sel:[1,1,0] op_sel_hi:[1,1,0]
v_rcp_f16_sdwa v148, v147 dst_sel:WORD_1 dst_unused:UNUSED_PRESERVE src0_sel:WORD_1
s_cmp_eq_u32 s40, 7
s_cbranch_scc1 Lrdy8
s_waitcnt vmcnt(0)
Lrdy8:
s_mov_b64 exec, 1
ds_add_u32 v253, v254 offset:12
s_mov_b64 exec, -1
v_and_b32 v187, s49, v187
v_pk_mul_f16 v155, v155, v154
v_fma_mix_f32 v158, v176, v176, v158 op_sel:[0,0,0] op_sel_hi:[1,1,0]
v_pk_mul_f16 v152, v152, v151
v_bfe_u32 v186, v187, 2, 14
v_pk_mul_f16 v149, v149, v148
v_fma_mix_f32 v159, v155, v155, 0 op_sel:[0,0,0] op_sel_hi:[1,1,0]
v_fma_mix_f32 v159, v155, v155, v159 op_sel:[1,1,0] op_sel_hi:[1,1,0]
v_lshrrev_b32_e64 v187, 18, v187
v_fma_mix_f32 v158, v177, v177, v158 op_sel:[1,1,0] op_sel_hi:[1,1,0]
v_fma_mix_f32 v159, v152, v152, v159 op_sel:[0,0,0] op_sel_hi:[1,1,0]
v_fma_mix_f32 v159, v152, v152, v159 op_sel:[1,1,0] op_sel_hi:[1,1,0]
v_fma_mix_f32 v159, v149, v149, v159 op_sel:[0,0,0] op_sel_hi:[1,1,0]
v_fma_mix_f32 v159, v149, v149, v159 op_sel:[1,1,0] op_sel_hi:[1,1,0]
s_cmp_lt_u32 s40, 4
s_cbranch_scc0 Lsu6
s_waitcnt vmcnt(8)
s_call_b64 s[78:79], Lw1c
s_mov_b64 exec, 1
ds_add_u32 v253, v254 offset:28
s_mov_b64 exec, -1
Lsu6:
v_cvt_pkrtz_f16_f32 v137, v120, v121
v_cvt_pkrtz_f16_f32 v139, v122, v123
v_cvt_pkrtz_f16_f32 v141, v124, v125
v_cvt_pkrtz_f16_f32 v143, v126, v127
v_cvt_pkrtz_f16_f32 v177, v128, v129
v_cvt_pk_f16_f32 v155, v130, v131
v_cvt_pk_f16_f32 v152, v132, v133
v_cvt_pk_f16_f32 v149, v134, v135
s_setprio 0
ds_read_b128 v[220:223], v248 offset:52224
ds_read_u16_d16 v186, v186
ds_read_u16_d16_hi v187, v187
v_mfma_f32_32x32x16_bf16 v[120:135], v[48:51], v[224:227], 0
v_pk_fma_f16 v154, v155, v155, s48
v_and_b32 v137, s49, v137
v_fma_mix_f32 v159, v178, v178, v159 op_sel:[0,0,0] op_sel_hi:[1,1,0]
v_pk_fma_f16 v151, v152, v152, s48
v_pk_fma_f16 v148, v149, v149, s48
v_bfe_u32 v136, v137, 2, 14
v_pk_mul_f16 v154, v155, v154
v_pk_mul_f16 v151, v152, v151
v_fma_mix_f32 v159, v179, v179, v159 op_sel:[1,1,0] op_sel_hi:[1,1,0]
v_lshrrev_b32_e64 v137, 18, v137
ds_read_b128 v[224:227], v250 offset:65520
ds_read_u16_d16 v136, v136
ds_read_u16_d16_hi v137, v137
v_mfma_f32_32x32x16_bf16 v[120:135], v[52:55], v[228:231], v[120:135]
v_pk_mul_f16 v148, v149, v148
v_exp_f16 v153, v154
v_exp_f16 v150, v151
v_and_b32_e64 v139, s49, v139
v_fma_mix_f32 v159, v180, v180, v159 op_sel:[0,0,0] op_sel_hi:[1,1,0]
v_exp_f16 v147, v148
v_bfe_u32 v138, v139, 2, 14
s_waitcnt lgkmcnt(7)
ds_read_b128 v[228:231], v248 offset:53248
ds_read_b32 v247, v253 offset:12
ds_read_u16_d16 v138, v138
v_mfma_f32_32x32x16_bf16 v[120:135], v[56:59], v[232:235], v[120:135]
v_exp_f16_sdwa v153, v154 dst_sel:WORD_1 dst_unused:UNUSED_PRESERVE src0_sel:WORD_1
v_lshrrev_b32_e64 v139, 18, v139
v_fma_mix_f32 v159, v181, v181, v159 op_sel:[1,1,0] op_sel_hi:[1,1,0]
v_exp_f16_sdwa v150, v151 dst_sel:WORD_1 dst_unused:UNUSED_PRESERVE src0_sel:WORD_1
v_exp_f16_sdwa v147, v148 dst_sel:WORD_1 dst_unused:UNUSED_PRESERVE src0_sel:WORD_1
v_and_b32_e64 v141, s49, v141
v_fma_mix_f32 v159, v182, v182, v159 op_sel:[0,0,0] op_sel_hi:[1,1,0]
ds_read_b128 v[232:235], v248 offset:56320
ds_read_u16_d16_hi v139, v139
v_mfma_f32_32x32x16_bf16 v[120:135], v[60:63], v[236:239], v[120:135]
v_pk_add_f16 v153, v153, 1.0 op_sel_hi:[1,0]
v_bfe_u32 v140, v141, 2, 14
v_pk_add_f16 v150, v150, 1.0 op_sel_hi:[1,0]
v_pk_add_f16 v147, v147, 1.0 op_sel_hi:[1,0]
v_rcp_f16 v154, v153
v_lshrrev_b32 v141, 18, v141
ds_read_u16_d16 v140, v140
ds_read_u16_d16_hi v141, v141
s_waitcnt lgkmcnt(5)
v_readfirstlane_b32 s43, v247
s_nop 1
s_cmp_ge_u32 s43, 16
s_cbranch_scc1 Lev3
Lev3w:
s_sleep 1
ds_read_b32 v247, v253 offset:12
s_waitcnt lgkmcnt(0)
v_readfirstlane_b32 s43, v247
s_cmp_eq_u32 s76, 0
s_cbranch_scc1 Lev3
s_sub_u32 s76, s76, 1
s_cmp_lt_u32 s43, 16
s_cbranch_scc1 Lev3w
Lev3:
v_fma_mix_f32 v159, v183, v183, v159 op_sel:[1,1,0] op_sel_hi:[1,1,0]
v_rcp_f16 v151, v150
ds_read_b128 v[236:239], v245 offset:6528
ds_read_b128 v[192:195], v244 offset:128
ds_read_b128 v[196:199], v244 offset:64
v_mfma_f32_32x32x16_bf16 v[120:135], v[64:67], v[216:219], v[120:135]
v_and_b32 v143, s49, v143
v_rcp_f16 v148, v147
v_fma_mix_f32 v159, v184, v184, v159 op_sel:[0,0,0] op_sel_hi:[1,1,0]
v_bfe_u32 v142, v143, 2, 14
v_rcp_f16_sdwa v154, v153 dst_sel:WORD_1 dst_unused:UNUSED_PRESERVE src0_sel:WORD_1
v_rcp_f16_sdwa v151, v150 dst_sel:WORD_1 dst_unused:UNUSED_PRESERVE src0_sel:WORD_1
v_lshrrev_b32_e64 v143, 18, v143
ds_read_b128 v[216:219], v248 offset:54272
ds_read_u16_d16 v142, v142
ds_read_u16_d16_hi v143, v143
v_mfma_f32_32x32x16_bf16 v[120:135], v[68:71], v[220:223], v[120:135]
v_fma_mix_f32 v159, v185, v185, v159 op_sel:[1,1,0] op_sel_hi:[1,1,0]
v_rcp_f16_sdwa v148, v147 dst_sel:WORD_1 dst_unused:UNUSED_PRESERVE src0_sel:WORD_1
v_and_b32_e64 v177, s49, v177
v_pk_mul_f16 v155, v155, v154
v_fma_mix_f32 v159, v186, v186, v159 op_sel:[0,0,0] op_sel_hi:[1,1,0]
v_pk_mul_f16 v152, v152, v151
v_bfe_u32 v176, v177, 2, 14
v_pk_mul_f16 v149, v149, v148
v_fma_mix_f32 v160, v155, v155, 0 op_sel:[0,0,0] op_sel_hi:[1,1,0]
v_fma_mix_f32 v160, v155, v155, v160 op_sel:[1,1,0] op_sel_hi:[1,1,0]
v_lshrrev_b32 v177, 18, v177
v_fma_mix_f32 v159, v187, v187, v159 op_sel:[1,1,0] op_sel_hi:[1,1,0]
v_fma_mix_f32 v160, v152, v152, v160 op_sel:[0,0,0] op_sel_hi:[1,1,0]
v_fma_mix_f32 v160, v152, v152, v160 op_sel:[1,1,0] op_sel_hi:[1,1,0]
v_fma_mix_f32 v160, v149, v149, v160 op_sel:[0,0,0] op_sel_hi:[1,1,0]
v_fma_mix_f32 v160, v149, v149, v160 op_sel:[1,1,0] op_sel_hi:[1,1,0]
s_setprio 2
v_mfma_f32_32x32x16_bf16 v[0:15], v[224:227], v[224:227], 0
ds_read_b128 v[220:223], v245 offset:6144
ds_read_b128 v[200:203], v244
ds_read_b128 v[204:207], v243 offset:128
ds_read_u16_d16 v176, v176
ds_read_u16_d16_hi v177, v177
v_cvt_pkrtz_f16_f32 v179, v120, v121
v_cvt_pkrtz_f16_f32 v181, v122, v123
v_cvt_pkrtz_f16_f32 v183, v124, v125
v_mfma_f32_32x32x16_bf16 v[16:31], v[224:227], v[224:227], 0
v_cvt_pkrtz_f16_f32 v185, v126, v127
v_cvt_pkrtz_f16_f32 v187, v128, v129
v_cvt_pk_f16_f32 v155, v130, v131
v_mfma_f32_32x32x16_bf16 v[32:47], v[224:227], v[224:227], 0
v_cvt_pk_f16_f32 v152, v132, v133
v_cvt_pk_f16_f32 v149, v134, v135
v_pk_fma_f16 v154, v155, v155, s48
v_mfma_f32_32x32x16_bf16 v[120:135], v[48:51], v[228:231], 0
ds_read_b128 v[224:227], v248 offset:57344
v_and_b32 v179, s49, v179
v_fma_mix_f32 v160, v136, v136, v160 op_sel:[0,0,0] op_sel_hi:[1,1,0]
v_pk_fma_f16 v151, v152, v152, s48
v_pk_fma_f16 v148, v149, v149, s48
v_bfe_u32 v178, v179, 2, 14
v_pk_mul_f16 v154, v155, v154
s_waitcnt lgkmcnt(6)
v_mfma_f32_32x32x16_bf16 v[120:135], v[52:55], v[232:235], v[120:135]
ds_read_b128 v[228:231], v245 offset:5760
ds_read_b128 v[208:211], v243 offset:64
ds_read_b128 v[212:215], v243
ds_read_u16_d16 v178, v178
v_pk_mul_f16 v151, v152, v151
v_fma_mix_f32 v160, v137, v137, v160 op_sel:[1,1,0] op_sel_hi:[1,1,0]
v_lshrrev_b32_e64 v179, 18, v179
v_pk_mul_f16 v148, v149, v148
v_exp_f16_e64 v153, v154
v_smfmac_f32_16x16x32_bf16 v[40:43], v[238:239], v[192:195], v246
ds_read_b128 v[232:235], v248 offset:55296
ds_read_u16_d16_hi v179, v179
v_exp_f16 v150, v151
v_and_b32 v181, s49, v181
v_smfmac_f32_16x16x32_bf16 v[24:27], v[236:237], v[196:199], v246
v_fma_mix_f32 v160, v138, v138, v160 op_sel:[0,0,0] op_sel_hi:[1,1,0]
v_exp_f16_e64 v147, v148
v_mfma_f32_32x32x16_bf16 v[120:135], v[56:59], v[216:219], v[120:135]
ds_read_b128 v[236:239], v245 offset:5376
ds_read_b128 v[192:195], v242 offset:128
ds_read_b128 v[196:199], v242 offset:64
v_bfe_u32 v180, v181, 2, 14
v_exp_f16_sdwa v153, v154 dst_sel:WORD_1 dst_unused:UNUSED_PRESERVE src0_sel:WORD_1
v_lshrrev_b32 v181, 18, v181
v_fma_mix_f32 v160, v139, v139, v160 op_sel:[1,1,0] op_sel_hi:[1,1,0]
s_waitcnt lgkmcnt(8)
v_smfmac_f32_16x16x32_bf16 v[8:11], v[222:223], v[200:203], v246
ds_read_b128 v[216:219], v248 offset:58368
ds_read_u16_d16 v180, v180
ds_read_u16_d16_hi v181, v181
v_exp_f16_sdwa v150, v151 dst_sel:WORD_1 dst_unused:UNUSED_PRESERVE src0_sel:WORD_1
v_exp_f16_sdwa v147, v148 dst_sel:WORD_1 dst_unused:UNUSED_PRESERVE src0_sel:WORD_1
v_smfmac_f32_16x16x32_bf16 v[40:43], v[220:221], v[204:207], v246
v_and_b32_e64 v183, s49, v183
v_fma_mix_f32 v160, v140, v140, v160 op_sel:[0,0,0] op_sel_hi:[1,1,0]
v_pk_add_f16 v153, v153, 1.0 op_sel_hi:[1,0]
v_mfma_f32_32x32x16_bf16 v[120:135], v[60:63], v[224:227], v[120:135]
ds_read_b128 v[220:223], v245 offset:4992
ds_read_b128 v[200:203], v242
v_xor_b32 v244, 16, v244
ds_read_b128 v[204:207], v244 offset:128
v_bfe_u32 v182, v183, 2, 14
v_pk_add_f16 v150, v150, 1.0 op_sel_hi:[1,0]
v_pk_add_f16 v147, v147, 1.0 op_sel_hi:[1,0]
v_rcp_f16 v154, v153
v_lshrrev_b32 v183, 18, v183
s_waitcnt lgkmcnt(6)
v_smfmac_f32_16x16x32_bf16 v[24:27], v[230:231], v[208:211], v246
ds_read_b128 v[224:227], v245 offset:4608
ds_read_u16_d16 v182, v182
ds_read_u16_d16_hi v183, v183
v_fma_mix_f32 v160, v141, v141, v160 op_sel:[1,1,0] op_sel_hi:[1,1,0]
v_rcp_f16_e64 v151, v150
v_smfmac_f32_16x16x32_bf16 v[8:11], v[228:229], v[212:215], v246
v_and_b32 v185, s49, v185
v_rcp_f16 v148, v147
v_mfma_f32_32x32x16_bf16 v[120:135], v[64:67], v[232:235], v[120:135]
ds_read_b128 v[208:211], v244 offset:64
ds_read_b128 v[212:215], v244
ds_read_b128 v[228:231], v248 offset:59392
v_fma_mix_f32 v160, v142, v142, v160 op_sel:[0,0,0] op_sel_hi:[1,1,0]
v_bfe_u32 v184, v185, 2, 14
v_rcp_f16_sdwa v154, v153 dst_sel:WORD_1 dst_unused:UNUSED_PRESERVE src0_sel:WORD_1
v_rcp_f16_sdwa v151, v150 dst_sel:WORD_1 dst_unused:UNUSED_PRESERVE src0_sel:WORD_1
v_smfmac_f32_16x16x32_bf16 v[40:43], v[238:239], v[192:195], v246
ds_read_b128 v[232:235], v248 offset:62464
ds_read_u16_d16 v184, v184
ds_read_b32 v247, v253 offset:28
v_lshrrev_b32_e64 v185, 18, v185
v_fma_mix_f32 v160, v143, v143, v160 op_sel:[1,1,0] op_sel_hi:[1,1,0]
v_smfmac_f32_16x16x32_bf16 v[24:27], v[236:237], v[196:199], v246
v_rcp_f16_sdwa v148, v147 dst_sel:WORD_1 dst_unused:UNUSED_PRESERVE src0_sel:WORD_1
v_and_b32 v187, s49, v187
v_pk_mul_f16 v155, v155, v154
s_waitcnt lgkmcnt(7)
v_mfma_f32_32x32x16_bf16 v[120:135], v[68:71], v[216:219], v[120:135]
ds_read_b128 v[236:239], v248 offset:60416
ds_read_u16_d16_hi v185, v185
v_fma_mix_f32 v160, v176, v176, v160 op_sel:[0,0,0] op_sel_hi:[1,1,0]
v_pk_mul_f16 v152, v152, v151
v_bfe_u32 v186, v187, 2, 14
v_pk_mul_f16 v149, v149, v148
v_fma_mix_f32 v161, v155, v155, 0 op_sel:[0,0,0] op_sel_hi:[1,1,0]
v_fma_mix_f32 v161, v155, v155, v161 op_sel:[1,1,0] op_sel_hi:[1,1,0]
v_smfmac_f32_16x16x32_bf16 v[8:11], v[222:223], v[200:203], v246
ds_read_b128 v[216:219], v245 offset:4224
v_xor_b32 v243, 16, v243
ds_read_b128 v[192:195], v243 offset:128
ds_read_b128 v[196:199], v243 offset:64
ds_read_u16_d16 v186, v186
v_lshrrev_b32 v187, 18, v187
v_fma_mix_f32 v160, v177, v177, v160 op_sel:[1,1,0] op_sel_hi:[1,1,0]
v_fma_mix_f32 v161, v152, v152, v161 op_sel:[0,0,0] op_sel_hi:[1,1,0]
v_smfmac_f32_16x16x32_bf16 v[44:47], v[220:221], v[204:207], v246
v_fma_mix_f32 v161, v152, v152, v161 op_sel:[1,1,0] op_sel_hi:[1,1,0]
v_fma_mix_f32 v161, v149, v149, v161 op_sel:[0,0,0] op_sel_hi:[1,1,0]
v_fma_mix_f32 v161, v149, v149, v161 op_sel:[1,1,0] op_sel_hi:[1,1,0]
s_cmp_lg_u32 s40, 7
s_cbranch_scc1 Lnosent
v_mov_b32 v104, -1
v_mov_b32 v105, -1
v_mov_b32 v106, -1
v_mov_b32 v107, -1
v_lshlrev_b32_e64 v100, 12, v251
v_add_u32 v101, 262144, v100
v_cmp_gt_u32 vcc, 32, v251
v_mov_b32 v102, 2147483648
s_nop 0
v_cndmask_b32 v101, v102, v101, vcc
s_lshl_b32 s43, s2, 4
buffer_store_dwordx4 v[104:107], v100, s[32:35], s43 offen sc1
buffer_store_dwordx4 v[104:107], v101, s[32:35], s43 offen sc1
s_add_u32 s43, s43, 393216
s_cmp_lt_u32 s2, 96
s_cselect_b32 s43, s43, 1073741824
v_lshlrev_b32_e64 v102, 11, v251
s_mov_b64 exec, 0xff
buffer_store_dwordx4 v[104:107], v102, s[32:35], s43 offen sc1
s_mov_b64 exec, -1
s_sub_u32 s43, s2, 96
s_cmp_lt_u32 s43, 96
s_cbranch_scc0 Lnobias
s_lshl_b32 s44, s43, 1
v_mul_u32_u24 v100, 192, v251
v_lshlrev_b32 v101, 1, v251
s_add_u32 s45, s44, 0
buffer_load_ushort v102, v100, s[16:19], s45 offen
buffer_load_ushort v108, v101, s[28:31], 0 offen offset:0
s_add_u32 s45, s44, 12288
buffer_load_ushort v103, v100, s[16:19], s45 offen
buffer_load_ushort v109, v101, s[28:31], 0 offen offset:128
s_add_u32 s45, s44, 24576
buffer_load_ushort v104, v100, s[16:19], s45 offen
buffer_load_ushort v110, v101, s[28:31], 0 offen offset:256
s_add_u32 s45, s44, 36864
buffer_load_ushort v105, v100, s[16:19], s45 offen
buffer_load_ushort v111, v101, s[28:31], 0 offen offset:384
s_add_u32 s45, s44, 49152
buffer_load_ushort v106, v100, s[16:19], s45 offen
buffer_load_ushort v112, v101, s[28:31], 0 offen offset:512
s_add_u32 s45, s44, 61440
buffer_load_ushort v107, v100, s[16:19], s45 offen
buffer_load_ushort v113, v101, s[28:31], 0 offen offset:640
Lnobias:
s_nop 1
Lnosent:
ds_read_u16_d16_hi v187, v187
s_waitcnt lgkmcnt(1)
v_readfirstlane_b32 s43, v247
s_nop 1
s_cmp_ge_u32 s43, 12
s_cbranch_scc1 Lev4
Lev4w:
s_sleep 1
ds_read_b32 v247, v253 offset:28
s_waitcnt lgkmcnt(0)
v_readfirstlane_b32 s43, v247
s_cmp_eq_u32 s76, 0
s_cbranch_scc1 Lev4
s_sub_u32 s76, s76, 1
s_cmp_lt_u32 s43, 12
s_cbranch_scc1 Lev4w
Lev4:
s_setprio 1
v_smfmac_f32_16x16x32_bf16 v[28:31], v[226:227], v[208:211], v246
ds_read_b128 v[220:223], v248 offset:63488
v_cvt_pkrtz_f16_f32 v137, v120, v121
v_cvt_pkrtz_f16_f32 v139, v122, v123
v_cvt_pkrtz_f16_f32 v141, v124, v125
v_cvt_pkrtz_f16_f32 v143, v126, v127
v_smfmac_f32_16x16x32_bf16 v[12:15], v[224:225], v[212:215], v246
v_cvt_pk_f16_f32 v155, v128, v129
v_cvt_pk_f16_f32 v152, v130, v131
v_cvt_pk_f16_f32 v149, v132, v133
v_cvt_pk_f16_f32 v146, v134, v135
v_mfma_f32_32x32x16_bf16 v[120:135], v[48:51], v[228:231], 0
ds_read_b128 v[224:227], v248 offset:61440
v_pk_fma_f16 v154, v155, v155, s48
v_and_b32 v137, s49, v137
v_fma_mix_f32 v161, v178, v178, v161 op_sel:[0,0,0] op_sel_hi:[1,1,0]
v_pk_fma_f16 v151, v152, v152, s48
v_pk_fma_f16 v148, v149, v149, s48
v_pk_fma_f16 v145, v146, v146, s48
v_pk_mul_f16 v154, v155, v154
v_bfe_u32 v136, v137, 2, 14
v_pk_mul_f16 v151, v152, v151
v_mfma_f32_32x32x16_bf16 v[120:135], v[52:55], v[232:235], v[120:135]
ds_read_b128 v[228:231], v245 offset:3840
ds_read_b128 v[200:203], v243
v_xor_b32 v242, 16, v242
ds_read_b128 v[204:207], v242 offset:128
ds_read_u16_d16 v136, v136
v_fma_mix_f32 v161, v179, v179, v161 op_sel:[1,1,0] op_sel_hi:[1,1,0]
v_pk_mul_f16 v148, v149, v148
v_pk_mul_f16 v145, v146, v145
v_exp_f16 v153, v154
v_lshrrev_b32 v137, 18, v137
v_exp_f16 v150, v151
v_mfma_f32_32x32x16_bf16 v[120:135], v[56:59], v[236:239], v[120:135]
ds_read_b128 v[232:235], v248 offset:64512
ds_read_u16_d16_hi v137, v137
v_fma_mix_f32 v161, v180, v180, v161 op_sel:[0,0,0] op_sel_hi:[1,1,0]
v_exp_f16 v147, v148
v_and_b32 v139, s49, v139
v_exp_f16_e64 v144, v145
v_exp_f16_sdwa v153, v154 dst_sel:WORD_1 dst_unused:UNUSED_PRESERVE src0_sel:WORD_1
v_fma_mix_f32 v161, v181, v181, v161 op_sel:[1,1,0] op_sel_hi:[1,1,0]
v_smfmac_f32_16x16x32_bf16 v[44:47], v[218:219], v[192:195], v246
ds_read_b128 v[236:239], v245 offset:3456
ds_read_b128 v[208:211], v242 offset:64
ds_read_b128 v[212:215], v242
v_bfe_u32 v138, v139, 2, 14
v_exp_f16_sdwa v150, v151 dst_sel:WORD_1 dst_unused:UNUSED_PRESERVE src0_sel:WORD_1
v_smfmac_f32_16x16x32_bf16 v[28:31], v[216:217], v[196:199], v246
v_exp_f16_sdwa v147, v148 dst_sel:WORD_1 dst_unused:UNUSED_PRESERVE src0_sel:WORD_1
v_exp_f16_sdwa v144, v145 dst_sel:WORD_1 dst_unused:UNUSED_PRESERVE src0_sel:WORD_1
v_lshrrev_b32_e64 v139, 18, v139
s_waitcnt lgkmcnt(5)
v_mfma_f32_32x32x16_bf16 v[120:135], v[60:63], v[220:223], v[120:135]
ds_read_b128 v[216:219], v245 offset:3072
v_xor_b32 v244, 32, v244
ds_read_b128 v[192:195], v244 offset:128
ds_read_b128 v[196:199], v244 offset:64
ds_read_u16_d16 v138, v138
ds_read_u16_d16_hi v139, v139
v_fma_mix_f32 v161, v182, v182, v161 op_sel:[0,0,0] op_sel_hi:[1,1,0]
v_pk_add_f16 v153, v153, 1.0 op_sel_hi:[1,0]
v_pk_add_f16 v150, v150, 1.0 op_sel_hi:[1,0]
v_pk_add_f16 v147, v147, 1.0 op_sel_hi:[1,0]
v_and_b32_e64 v141, s49, v141
v_pk_add_f16 v144, v144, 1.0 op_sel_hi:[1,0]
v_rcp_f16_e64 v154, v153
v_fma_mix_f32 v161, v183, v183, v161 op_sel:[1,1,0] op_sel_hi:[1,1,0]
v_mfma_f32_32x32x16_bf16 v[120:135], v[64:67], v[224:227], v[120:135]
ds_read_b128 v[220:223], v249
v_rcp_f16_e64 v151, v150
v_bfe_u32 v140, v141, 2, 14
v_rcp_f16_e64 v148, v147
v_fma_mix_f32 v161, v184, v184, v161 op_sel:[0,0,0] op_sel_hi:[1,1,0]
v_rcp_f16 v145, v144
v_lshrrev_b32 v141, 18, v141
v_smfmac_f32_16x16x32_bf16 v[12:15], v[230:231], v[200:203], v246
ds_read_b128 v[224:227], v249 offset:3072
ds_read_u16_d16 v140, v140
ds_read_u16_d16_hi v141, v141
v_rcp_f16_sdwa v154, v153 dst_sel:WORD_1 dst_unused:UNUSED_PRESERVE src0_sel:WORD_1
s_setprio 0
v_rcp_f16_sdwa v151, v150 dst_sel:WORD_1 dst_unused:UNUSED_PRESERVE src0_sel:WORD_1
v_smfmac_f32_16x16x32_bf16 v[44:47], v[228:229], v[204:207], v246
v_fma_mix_f32 v161, v185, v185, v161 op_sel:[1,1,0] op_sel_hi:[1,1,0]
v_and_b32 v143, s49, v143
v_rcp_f16_sdwa v148, v147 dst_sel:WORD_1 dst_unused:UNUSED_PRESERVE src0_sel:WORD_1
s_waitcnt lgkmcnt(4)
v_mfma_f32_32x32x16_bf16 v[120:135], v[68:71], v[232:235], v[120:135]
ds_read_b128 v[228:231], v245 offset:2688
ds_read_b128 v[200:203], v244
v_xor_b32 v243, 32, v243
ds_read_b128 v[204:207], v243 offset:128
v_rcp_f16_sdwa v145, v144 dst_sel:WORD_1 dst_unused:UNUSED_PRESERVE src0_sel:WORD_1
v_pk_mul_f16 v155, v155, v154
v_bfe_u32 v142, v143, 2, 14
v_fma_mix_f32 v161, v186, v186, v161 op_sel:[0,0,0] op_sel_hi:[1,1,0]
v_pk_mul_f16 v152, v152, v151
v_pk_mul_f16 v149, v149, v148
v_pk_mul_f16 v146, v146, v145
v_fma_mix_f32 v162, v155, v155, 0 op_sel:[0,0,0] op_sel_hi:[1,1,0]
v_smfmac_f32_16x16x32_bf16 v[28:31], v[238:239], v[208:211], v246
ds_read_b128 v[232:235], v249 offset:1024
ds_read_u16_d16 v142, v142
v_lshrrev_b32_e64 v143, 18, v143
v_fma_mix_f32 v162, v155, v155, v162 op_sel:[1,1,0] op_sel_hi:[1,1,0]
v_fma_mix_f32 v162, v152, v152, v162 op_sel:[0,0,0] op_sel_hi:[1,1,0]
v_fma_mix_f32 v161, v187, v187, v161 op_sel:[1,1,0] op_sel_hi:[1,1,0]
v_smfmac_f32_16x16x32_bf16 v[12:15], v[236:237], v[212:215], v246
v_fma_mix_f32 v162, v152, v152, v162 op_sel:[1,1,0] op_sel_hi:[1,1,0]
v_fma_mix_f32 v162, v149, v149, v162 op_sel:[0,0,0] op_sel_hi:[1,1,0]
v_fma_mix_f32 v162, v149, v149, v162 op_sel:[1,1,0] op_sel_hi:[1,1,0]
v_fma_mix_f32 v162, v146, v146, v162 op_sel:[0,0,0] op_sel_hi:[1,1,0]
v_fma_mix_f32 v162, v146, v146, v162 op_sel:[1,1,0] op_sel_hi:[1,1,0]
v_lshlrev_b32_e64 v252, 7, v251
s_add_u32 s46, s47, 1572864
s_mov_b32 exec_lo, 131071
s_mov_b32 exec_hi, 0
s_mov_b32 m0, 16288
s_nop 0
buffer_load_dword v252, s[4:7], s46 offen lds
s_mov_b64 exec, -1
s_setprio 2
v_smfmac_f32_16x16x32_bf16 v[36:39], v[218:219], v[192:195], v246
ds_read_b128 v[236:239], v249 offset:4096
ds_read_u16_d16_hi v143, v143
v_cvt_pkrtz_f16_f32 v179, v120, v121
v_cvt_pkrtz_f16_f32 v181, v122, v123
v_cvt_pkrtz_f16_f32 v183, v124, v125
v_smfmac_f32_16x16x32_bf16 v[20:23], v[216:217], v[196:199], v246
v_cvt_pkrtz_f16_f32 v185, v126, v127
v_cvt_pkrtz_f16_f32 v187, v128, v129
v_cvt_pk_f16_f32 v155, v130, v131
v_cvt_pk_f16_f32 v152, v132, v133
v_cvt_pk_f16_f32 v149, v134, v135
s_waitcnt lgkmcnt(2)
v_mfma_f32_32x32x16_bf16 v[120:135], v[48:51], v[220:223], 0
ds_read_b128 v[216:219], v245 offset:2304
ds_read_b128 v[208:211], v243 offset:64
ds_read_b128 v[212:215], v243
v_pk_fma_f16 v154, v155, v155, s48
v_and_b32 v179, s49, v179
v_fma_mix_f32 v162, v136, v136, v162 op_sel:[0,0,0] op_sel_hi:[1,1,0]
v_pk_fma_f16 v151, v152, v152, s48
v_pk_fma_f16 v148, v149, v149, s48
v_mfma_f32_32x32x16_bf16 v[120:135], v[52:55], v[224:227], v[120:135]
ds_read_b128 v[220:223], v249 offset:2048
v_bfe_u32 v178, v179, 2, 14
v_pk_mul_f16 v154, v155, v154
v_pk_mul_f16 v151, v152, v151
v_pk_mul_f16 v148, v149, v148
v_lshrrev_b32 v179, 18, v179
v_fma_mix_f32 v162, v137, v137, v162 op_sel:[1,1,0] op_sel_hi:[1,1,0]
v_smfmac_f32_16x16x32_bf16 v[4:7], v[230:231], v[200:203], v246
ds_read_b128 v[224:227], v245 offset:1920
v_xor_b32 v242, 32, v242
ds_read_b128 v[192:195], v242 offset:128
ds_read_b128 v[196:199], v242 offset:64
ds_read_u16_d16 v178, v178
ds_read_u16_d16_hi v179, v179
v_exp_f16 v153, v154
v_and_b32 v181, s49, v181
v_smfmac_f32_16x16x32_bf16 v[36:39], v[228:229], v[204:207], v246
v_exp_f16 v150, v151
v_exp_f16 v147, v148
v_mfma_f32_32x32x16_bf16 v[120:135], v[56:59], v[232:235], v[120:135]
ds_read_b128 v[228:231], v249 offset:5120
v_bfe_u32 v180, v181, 2, 14
v_fma_mix_f32 v162, v138, v138, v162 op_sel:[0,0,0] op_sel_hi:[1,1,0]
v_exp_f16_sdwa v153, v154 dst_sel:WORD_1 dst_unused:UNUSED_PRESERVE src0_sel:WORD_1
v_lshrrev_b32_e64 v181, 18, v181
v_exp_f16_sdwa v150, v151 dst_sel:WORD_1 dst_unused:UNUSED_PRESERVE src0_sel:WORD_1
s_waitcnt lgkmcnt(6)
v_mfma_f32_32x32x16_bf16 v[120:135], v[60:63], v[236:239], v[120:135]
ds_read_b128 v[232:235], v245 offset:1536
ds_read_b128 v[200:203], v242
v_xor_b32 v244, 16, v244
ds_read_b128 v[204:207], v244 offset:128
ds_read_u16_d16 v180, v180
ds_read_u16_d16_hi v181, v181
v_fma_mix_f32 v162, v139, v139, v162 op_sel:[1,1,0] op_sel_hi:[1,1,0]
v_and_b32_e64 v183, s49, v183
v_exp_f16_sdwa v147, v148 dst_sel:WORD_1 dst_unused:UNUSED_PRESERVE src0_sel:WORD_1
v_pk_add_f16 v153, v153, 1.0 op_sel_hi:[1,0]
v_bfe_u32 v182, v183, 2, 14
v_smfmac_f32_16x16x32_bf16 v[20:23], v[218:219], v[208:211], v246
ds_read_b128 v[236:239], v245 offset:1152
ds_read_u16_d16 v182, v182
v_pk_add_f16 v150, v150, 1.0 op_sel_hi:[1,0]
v_pk_add_f16 v147, v147, 1.0 op_sel_hi:[1,0]
v_rcp_f16_e64 v154, v153
v_smfmac_f32_16x16x32_bf16 v[4:7], v[216:217], v[212:215], v246
v_lshrrev_b32_e64 v183, 18, v183
v_fma_mix_f32 v162, v140, v140, v162 op_sel:[0,0,0] op_sel_hi:[1,1,0]
v_mfma_f32_32x32x16_bf16 v[120:135], v[64:67], v[220:223], v[120:135]
ds_read_b128 v[208:211], v244 offset:64
ds_read_b128 v[212:215], v244
ds_read_b128 v[216:219], v249 offset:6144
ds_read_u16_d16_hi v183, v183
v_rcp_f16 v151, v150
v_and_b32 v185, s49, v185
v_rcp_f16 v148, v147
v_fma_mix_f32 v162, v141, v141, v162 op_sel:[1,1,0] op_sel_hi:[1,1,0]
v_bfe_u32 v184, v185, 2, 14
s_waitcnt lgkmcnt(6)
v_smfmac_f32_16x16x32_bf16 v[36:39], v[226:227], v[192:195], v246
ds_read_b128 v[220:223], v249 offset:9216
ds_read_u16_d16 v184, v184
v_rcp_f16_sdwa v154, v153 dst_sel:WORD_1 dst_unused:UNUSED_PRESERVE src0_sel:WORD_1
v_rcp_f16_sdwa v151, v150 dst_sel:WORD_1 dst_unused:UNUSED_PRESERVE src0_sel:WORD_1
v_smfmac_f32_16x16x32_bf16 v[20:23], v[224:225], v[196:199], v246
v_lshrrev_b32_e64 v185, 18, v185
v_rcp_f16_sdwa v148, v147 dst_sel:WORD_1 dst_unused:UNUSED_PRESERVE src0_sel:WORD_1
v_mfma_f32_32x32x16_bf16 v[120:135], v[68:71], v[228:231], v[120:135]
ds_read_b128 v[224:227], v249 offset:7168
ds_read_u16_d16_hi v185, v185
v_and_b32_e64 v187, s49, v187
v_fma_mix_f32 v162, v142, v142, v162 op_sel:[0,0,0] op_sel_hi:[1,1,0]
v_pk_mul_f16 v155, v155, v154
v_pk_mul_f16 v152, v152, v151
v_bfe_u32 v186, v187, 2, 14
v_pk_mul_f16 v149, v149, v148
v_fma_mix_f32 v163, v155, v155, 0 op_sel:[0,0,0] op_sel_hi:[1,1,0]
v_smfmac_f32_16x16x32_bf16 v[4:7], v[234:235], v[200:203], v246
ds_read_b128 v[228:231], v245 offset:768
v_xor_b32 v243, 16, v243
ds_read_b128 v[192:195], v243 offset:128
ds_read_b128 v[196:199], v243 offset:64
ds_read_u16_d16 v186, v186
v_fma_mix_f32 v162, v143, v143, v162 op_sel:[1,1,0] op_sel_hi:[1,1,0]
v_lshrrev_b32 v187, 18, v187
v_fma_mix_f32 v163, v155, v155, v163 op_sel:[1,1,0] op_sel_hi:[1,1,0]
v_smfmac_f32_16x16x32_bf16 v[32:35], v[232:233], v[204:207], v246
v_fma_mix_f32 v163, v152, v152, v163 op_sel:[0,0,0] op_sel_hi:[1,1,0]
v_fma_mix_f32 v163, v152, v152, v163 op_sel:[1,1,0] op_sel_hi:[1,1,0]
v_fma_mix_f32 v163, v149, v149, v163 op_sel:[0,0,0] op_sel_hi:[1,1,0]
v_fma_mix_f32 v163, v149, v149, v163 op_sel:[1,1,0] op_sel_hi:[1,1,0]
v_lshlrev_b32 v252, 7, v251
s_add_u32 s46, s47, 1572864
s_mov_b32 exec_lo, 4294836224
s_mov_b32 exec_hi, 3
s_mov_b32 m0, 16220
s_nop 0
buffer_load_dword v252, s[4:7], s46 offen lds
s_mov_b64 exec, -1
s_setprio 1
s_waitcnt lgkmcnt(4)
v_smfmac_f32_16x16x32_bf16 v[16:19], v[238:239], v[208:211], v246
ds_read_b128 v[232:235], v249 offset:10240
ds_read_u16_d16_hi v187, v187
v_cvt_pkrtz_f16_f32 v137, v120, v121
v_cvt_pkrtz_f16_f32 v139, v122, v123
v_cvt_pkrtz_f16_f32 v141, v124, v125
v_smfmac_f32_16x16x32_bf16 v[0:3], v[236:237], v[212:215], v246
v_cvt_pkrtz_f16_f32 v143, v126, v127
v_cvt_pk_f16_f32 v155, v128, v129
v_cvt_pk_f16_f32 v152, v130, v131
v_cvt_pk_f16_f32 v149, v132, v133
v_cvt_pk_f16_f32 v146, v134, v135
v_mfma_f32_32x32x16_bf16 v[120:135], v[48:51], v[216:219], 0
ds_read_b128 v[236:239], v249 offset:8192
v_pk_fma_f16 v154, v155, v155, s48
v_and_b32_e64 v137, s49, v137
v_fma_mix_f32 v163, v178, v178, v163 op_sel:[0,0,0] op_sel_hi:[1,1,0]
v_pk_fma_f16 v151, v152, v152, s48
v_pk_fma_f16 v148, v149, v149, s48
v_pk_fma_f16 v145, v146, v146, s48
v_pk_mul_f16 v154, v155, v154
v_mfma_f32_32x32x16_bf16 v[120:135], v[52:55], v[220:223], v[120:135]
ds_read_b128 v[216:219], v245 offset:384
ds_read_b128 v[200:203], v243
v_xor_b32 v242, 16, v242
ds_read_b128 v[204:207], v242 offset:128
v_bfe_u32 v136, v137, 2, 14
v_pk_mul_f16 v151, v152, v151
v_fma_mix_f32 v163, v179, v179, v163 op_sel:[1,1,0] op_sel_hi:[1,1,0]
v_pk_mul_f16 v148, v149, v148
v_pk_mul_f16 v145, v146, v145
v_exp_f16 v153, v154
v_lshrrev_b32_e64 v137, 18, v137
v_mfma_f32_32x32x16_bf16 v[120:135], v[56:59], v[224:227], v[120:135]
ds_read_b128 v[220:223], v249 offset:11264
ds_read_u16_d16 v136, v136
ds_read_u16_d16_hi v137, v137
v_exp_f16_e64 v150, v151
v_fma_mix_f32 v163, v180, v180, v163 op_sel:[0,0,0] op_sel_hi:[1,1,0]
v_exp_f16 v147, v148
v_and_b32 v139, s49, v139
v_exp_f16 v144, v145
s_waitcnt lgkmcnt(6)
v_smfmac_f32_16x16x32_bf16 v[32:35], v[230:231], v[192:195], v246
ds_read_b128 v[224:227], v245
ds_read_b128 v[208:211], v242 offset:64
ds_read_b128 v[212:215], v242
v_exp_f16_sdwa v153, v154 dst_sel:WORD_1 dst_unused:UNUSED_PRESERVE src0_sel:WORD_1
v_fma_mix_f32 v163, v181, v181, v163 op_sel:[1,1,0] op_sel_hi:[1,1,0]
v_bfe_u32 v138, v139, 2, 14
v_smfmac_f32_16x16x32_bf16 v[16:19], v[228:229], v[196:199], v246
v_exp_f16_sdwa v150, v151 dst_sel:WORD_1 dst_unused:UNUSED_PRESERVE src0_sel:WORD_1
v_mfma_f32_32x32x16_bf16 v[120:135], v[60:63], v[232:235], v[120:135]
ds_read_b128 v[228:231], v249 offset:12288
ds_read_u16_d16 v138, v138
v_exp_f16_sdwa v147, v148 dst_sel:WORD_1 dst_unused:UNUSED_PRESERVE src0_sel:WORD_1
v_exp_f16_sdwa v144, v145 dst_sel:WORD_1 dst_unused:UNUSED_PRESERVE src0_sel:WORD_1
v_lshrrev_b32_e64 v139, 18, v139
v_fma_mix_f32 v163, v182, v182, v163 op_sel:[0,0,0] op_sel_hi:[1,1,0]
v_pk_add_f16 v153, v153, 1.0 op_sel_hi:[1,0]
v_pk_add_f16 v150, v150, 1.0 op_sel_hi:[1,0]
v_pk_add_f16 v147, v147, 1.0 op_sel_hi:[1,0]
v_mfma_f32_32x32x16_bf16 v[120:135], v[64:67], v[236:239], v[120:135]
ds_read_b128 v[232:235], v249 offset:15360
ds_read_u16_d16_hi v139, v139
v_and_b32_e64 v141, s49, v141
v_pk_add_f16 v144, v144, 1.0 op_sel_hi:[1,0]
v_rcp_f16_e64 v154, v153
v_fma_mix_f32 v163, v183, v183, v163 op_sel:[1,1,0] op_sel_hi:[1,1,0]
v_rcp_f16 v151, v150
v_bfe_u32 v140, v141, 2, 14
s_waitcnt lgkmcnt(4)
v_smfmac_f32_16x16x32_bf16 v[0:3], v[218:219], v[200:203], v246
ds_read_b128 v[236:239], v249 offset:13312
ds_read_u16_d16 v140, v140
v_rcp_f16_e64 v148, v147
v_fma_mix_f32 v163, v184, v184, v163 op_sel:[0,0,0] op_sel_hi:[1,1,0]
v_smfmac_f32_16x16x32_bf16 v[32:35], v[216:217], v[204:207], v246
v_rcp_f16_e64 v145, v144
v_lshrrev_b32 v141, 18, v141
v_rcp_f16_sdwa v154, v153 dst_sel:WORD_1 dst_unused:UNUSED_PRESERVE src0_sel:WORD_1
s_setprio 0
v_mfma_f32_32x32x16_bf16 v[120:135], v[68:71], v[220:223], v[120:135]
ds_read_b128 v[216:219], v249 offset:16384
ds_read_u16_d16_hi v141, v141
v_rcp_f16_sdwa v151, v150 dst_sel:WORD_1 dst_unused:UNUSED_PRESERVE src0_sel:WORD_1
v_fma_mix_f32 v163, v185, v185, v163 op_sel:[1,1,0] op_sel_hi:[1,1,0]
v_and_b32_e64 v143, s49, v143
v_rcp_f16_sdwa v148, v147 dst_sel:WORD_1 dst_unused:UNUSED_PRESERVE src0_sel:WORD_1
v_rcp_f16_sdwa v145, v144 dst_sel:WORD_1 dst_unused:UNUSED_PRESERVE src0_sel:WORD_1
v_smfmac_f32_16x16x32_bf16 v[16:19], v[226:227], v[208:211], v246
ds_read_b128 v[220:223], v249 offset:14336
v_pk_mul_f16 v155, v155, v154
v_bfe_u32 v142, v143, 2, 14
v_fma_mix_f32 v163, v186, v186, v163 op_sel:[0,0,0] op_sel_hi:[1,1,0]
v_pk_mul_f16 v152, v152, v151
v_smfmac_f32_16x16x32_bf16 v[0:3], v[224:225], v[212:215], v246
s_mov_b64 exec, 1
ds_add_u32 v253, v254 offset:16
s_mov_b64 exec, -1
v_pk_mul_f16 v149, v149, v148
v_pk_mul_f16 v146, v146, v145
v_fma_mix_f32 v164, v155, v155, 0 op_sel:[0,0,0] op_sel_hi:[1,1,0]
v_lshrrev_b32 v143, 18, v143
v_fma_mix_f32 v164, v155, v155, v164 op_sel:[1,1,0] op_sel_hi:[1,1,0]
v_fma_mix_f32 v164, v152, v152, v164 op_sel:[0,0,0] op_sel_hi:[1,1,0]
v_fma_mix_f32 v163, v187, v187, v163 op_sel:[1,1,0] op_sel_hi:[1,1,0]
v_fma_mix_f32 v164, v152, v152, v164 op_sel:[1,1,0] op_sel_hi:[1,1,0]
v_fma_mix_f32 v164, v149, v149, v164 op_sel:[0,0,0] op_sel_hi:[1,1,0]
v_fma_mix_f32 v164, v149, v149, v164 op_sel:[1,1,0] op_sel_hi:[1,1,0]
v_fma_mix_f32 v164, v146, v146, v164 op_sel:[0,0,0] op_sel_hi:[1,1,0]
v_fma_mix_f32 v164, v146, v146, v164 op_sel:[1,1,0] op_sel_hi:[1,1,0]
s_setprio 3
v_pk_add_f32 v[168:169], v[0:1], v[2:3]
v_pk_mul_f32 v[170:171], v[0:1], v[0:1]
v_pk_fma_f32 v[170:171], v[2:3], v[2:3], v[170:171]
v_pk_add_f32 v[168:169], v[168:169], v[4:5]
v_pk_fma_f32 v[170:171], v[4:5], v[4:5], v[170:171]
v_pk_add_f32 v[168:169], v[168:169], v[6:7]
v_pk_fma_f32 v[170:171], v[6:7], v[6:7], v[170:171]
v_pk_add_f32 v[168:169], v[168:169], v[8:9]
v_pk_fma_f32 v[170:171], v[8:9], v[8:9], v[170:171]
v_pk_add_f32 v[168:169], v[168:169], v[10:11]
v_pk_fma_f32 v[170:171], v[10:11], v[10:11], v[170:171]
v_pk_add_f32 v[168:169], v[168:169], v[12:13]
v_pk_fma_f32 v[170:171], v[12:13], v[12:13], v[170:171]
v_pk_add_f32 v[168:169], v[168:169], v[14:15]
v_pk_fma_f32 v[170:171], v[14:15], v[14:15], v[170:171]
v_pk_add_f32 v[168:169], v[168:169], v[16:17]
v_pk_fma_f32 v[170:171], v[16:17], v[16:17], v[170:171]
v_pk_add_f32 v[168:169], v[168:169], v[18:19]
v_pk_fma_f32 v[170:171], v[18:19], v[18:19], v[170:171]
v_pk_add_f32 v[168:169], v[168:169], v[20:21]
v_pk_fma_f32 v[170:171], v[20:21], v[20:21], v[170:171]
v_pk_add_f32 v[168:169], v[168:169], v[22:23]
v_pk_fma_f32 v[170:171], v[22:23], v[22:23], v[170:171]
v_pk_add_f32 v[168:169], v[168:169], v[24:25]
v_pk_fma_f32 v[170:171], v[24:25], v[24:25], v[170:171]
v_pk_add_f32 v[168:169], v[168:169], v[26:27]
v_pk_fma_f32 v[170:171], v[26:27], v[26:27], v[170:171]
v_pk_add_f32 v[168:169], v[168:169], v[28:29]
v_pk_fma_f32 v[170:171], v[28:29], v[28:29], v[170:171]
v_pk_add_f32 v[168:169], v[168:169], v[30:31]
v_pk_fma_f32 v[170:171], v[30:31], v[30:31], v[170:171]
v_pk_add_f32 v[168:169], v[168:169], v[32:33]
v_pk_fma_f32 v[170:171], v[32:33], v[32:33], v[170:171]
v_pk_add_f32 v[168:169], v[168:169], v[34:35]
v_pk_fma_f32 v[170:171], v[34:35], v[34:35], v[170:171]
v_pk_add_f32 v[168:169], v[168:169], v[36:37]
v_pk_fma_f32 v[170:171], v[36:37], v[36:37], v[170:171]
v_pk_add_f32 v[168:169], v[168:169], v[38:39]
v_pk_fma_f32 v[170:171], v[38:39], v[38:39], v[170:171]
v_pk_add_f32 v[168:169], v[168:169], v[40:41]
v_pk_fma_f32 v[170:171], v[40:41], v[40:41], v[170:171]
v_pk_add_f32 v[168:169], v[168:169], v[42:43]
v_pk_fma_f32 v[170:171], v[42:43], v[42:43], v[170:171]
v_pk_add_f32 v[168:169], v[168:169], v[44:45]
v_pk_fma_f32 v[170:171], v[44:45], v[44:45], v[170:171]
v_pk_add_f32 v[168:169], v[168:169], v[46:47]
v_pk_fma_f32 v[170:171], v[46:47], v[46:47], v[170:171]
s_setprio 0
v_add_u32 v174, -36864, v242
v_subrev_u32 v175, 66560, v174
v_min_u32 v174, v174, v175
v_add_u32 v174, 90112, v174
v_sub_u32 v175, v174, v242
v_add_u32 v242, v175, v242
v_add_u32 v243, v175, v243
v_add_u32 v244, v175, v244
v_lshlrev_b32_e64 v252, 7, v251
s_add_u32 s46, s47, 1572864
s_mov_b32 exec_lo, 0
s_mov_b32 exec_hi, 1048572
s_mov_b32 m0, 16152
s_nop 0
buffer_load_dword v252, s[4:7], s46 offen lds
s_mov_b64 exec, -1
s_setprio 2
v_cvt_pkrtz_f16_f32 v179, v120, v121
v_cvt_pkrtz_f16_f32 v181, v122, v123
v_cvt_pkrtz_f16_f32 v183, v124, v125
v_cvt_pkrtz_f16_f32 v185, v126, v127
v_cvt_pkrtz_f16_f32 v187, v128, v129
v_cvt_pk_f16_f32 v155, v130, v131
v_cvt_pk_f16_f32 v152, v132, v133
v_cvt_pk_f16_f32 v149, v134, v135
s_waitcnt lgkmcnt(1)
ds_read_b128 v[224:227], v249 offset:17408
ds_read_u16_d16 v142, v142
ds_read_u16_d16_hi v143, v143
v_mfma_f32_32x32x16_bf16 v[120:135], v[48:51], v[228:231], 0
v_pk_fma_f16 v154, v155, v155, s48
v_add_f32 v168, v168, v169
v_and_b32_e64 v179, s49, v179
v_fma_mix_f32 v164, v136, v136, v164 op_sel:[0,0,0] op_sel_hi:[1,1,0]
v_pk_fma_f16 v151, v152, v152, s48
v_pk_fma_f16 v148, v149, v149, s48
v_add_f32_e64 v170, v170, v171
v_bfe_u32 v178, v179, 2, 14
v_pk_mul_f16 v154, v155, v154
v_pk_mul_f16 v151, v152, v151
v_pk_mul_f16 v148, v149, v148
v_lshrrev_b32_e64 v179, 18, v179
ds_read_b128 v[228:231], v249 offset:18432
ds_read_u16_d16 v178, v178
ds_read_u16_d16_hi v179, v179
v_mfma_f32_32x32x16_bf16 v[120:135], v[52:55], v[232:235], v[120:135]
v_permlane32_swap_b32 v168, v170
v_fma_mix_f32 v164, v137, v137, v164 op_sel:[1,1,0] op_sel_hi:[1,1,0]
v_exp_f16 v153, v154
v_and_b32 v181, s49, v181
v_add_f32 v168, v168, v170
v_exp_f16 v150, v151
v_exp_f16 v147, v148
v_bfe_u32 v180, v181, 2, 14
v_mul_f32 v168, 1009429163, v168
ds_read_b128 v[232:235], v249 offset:21504
ds_read_u16_d16 v180, v180
v_mfma_f32_32x32x16_bf16 v[120:135], v[56:59], v[236:239], v[120:135]
v_fma_mix_f32 v164, v138, v138, v164 op_sel:[0,0,0] op_sel_hi:[1,1,0]
v_exp_f16_sdwa v153, v154 dst_sel:WORD_1 dst_unused:UNUSED_PRESERVE src0_sel:WORD_1
v_lshrrev_b32_e64 v181, 18, v181
v_exp_f16_sdwa v150, v151 dst_sel:WORD_1 dst_unused:UNUSED_PRESERVE src0_sel:WORD_1
v_mov_b32_e64 v170, v168
v_fma_mix_f32 v164, v139, v139, v164 op_sel:[1,1,0] op_sel_hi:[1,1,0]
v_and_b32 v183, s49, v183
v_exp_f16_sdwa v147, v148 dst_sel:WORD_1 dst_unused:UNUSED_PRESERVE src0_sel:WORD_1
v_permlane32_swap_b32 v168, v170
ds_read_b128 v[236:239], v249 offset:19456
ds_read_u16_d16_hi v181, v181
v_mfma_f32_32x32x16_bf16 v[120:135], v[60:63], v[216:219], v[120:135]
v_pk_add_f16 v153, v153, 1.0 op_sel_hi:[1,0]
v_bfe_u32 v182, v183, 2, 14
v_pk_add_f16 v150, v150, 1.0 op_sel_hi:[1,0]
v_pk_add_f16 v147, v147, 1.0 op_sel_hi:[1,0]
v_fma_f32 v170, -v168, v168, v170
v_rcp_f16 v154, v153
v_lshrrev_b32 v183, 18, v183
v_fma_mix_f32 v164, v140, v140, v164 op_sel:[0,0,0] op_sel_hi:[1,1,0]
v_rcp_f16 v151, v150
v_max_f32 v170, 0, v170
ds_read_b128 v[216:219], v249 offset:22528
ds_read_u16_d16 v182, v182
ds_read_u16_d16_hi v183, v183
v_mfma_f32_32x32x16_bf16 v[120:135], v[64:67], v[220:223], v[120:135]
v_and_b32 v185, s49, v185
v_rcp_f16 v148, v147
v_add_f32 v170, 925353388, v170
v_fma_mix_f32 v164, v141, v141, v164 op_sel:[1,1,0] op_sel_hi:[1,1,0]
v_bfe_u32 v184, v185, 2, 14
v_rcp_f16_sdwa v154, v153 dst_sel:WORD_1 dst_unused:UNUSED_PRESERVE src0_sel:WORD_1
v_rcp_f16_sdwa v151, v150 dst_sel:WORD_1 dst_unused:UNUSED_PRESERVE src0_sel:WORD_1
v_rsq_f32 v170, v170
s_waitcnt lgkmcnt(4)
ds_read_b128 v[220:223], v249 offset:20480
ds_read_b32 v247, v253 offset:16
ds_read_u16_d16 v184, v184
v_mfma_f32_32x32x16_bf16 v[120:135], v[68:71], v[224:227], v[120:135]
v_lshrrev_b32_e64 v185, 18, v185
v_rcp_f16_sdwa v148, v147 dst_sel:WORD_1 dst_unused:UNUSED_PRESERVE src0_sel:WORD_1
v_and_b32_e64 v187, s49, v187
v_fma_mix_f32 v164, v142, v142, v164 op_sel:[0,0,0] op_sel_hi:[1,1,0]
v_pk_mul_f16 v155, v155, v154
v_pk_mul_f16 v152, v152, v151
v_bfe_u32 v186, v187, 2, 14
v_mul_f32 v172, 3203391086, v170
v_pk_mul_f16 v149, v149, v148
v_fma_mix_f32 v165, v155, v155, 0 op_sel:[0,0,0] op_sel_hi:[1,1,0]
v_fma_mix_f32 v164, v143, v143, v164 op_sel:[1,1,0] op_sel_hi:[1,1,0]
v_lshrrev_b32_e64 v187, 18, v187
v_fma_mix_f32 v165, v155, v155, v165 op_sel:[1,1,0] op_sel_hi:[1,1,0]
v_mul_f32 v173, v168, v172
v_fma_mix_f32 v165, v152, v152, v165 op_sel:[0,0,0] op_sel_hi:[1,1,0]
v_fma_mix_f32 v165, v152, v152, v165 op_sel:[1,1,0] op_sel_hi:[1,1,0]
v_fma_mix_f32 v165, v149, v149, v165 op_sel:[0,0,0] op_sel_hi:[1,1,0]
v_fma_mix_f32 v165, v149, v149, v165 op_sel:[1,1,0] op_sel_hi:[1,1,0]
s_setprio 3
v_pk_fma_f32 v[0:1], v[0:1], v[172:173], v[172:173] op_sel:[0,0,1] op_sel_hi:[1,0,1] neg_lo:[0,0,1] neg_hi:[0,0,1]
v_pk_fma_f32 v[2:3], v[2:3], v[172:173], v[172:173] op_sel:[0,0,1] op_sel_hi:[1,0,1] neg_lo:[0,0,1] neg_hi:[0,0,1]
v_pk_fma_f32 v[4:5], v[4:5], v[172:173], v[172:173] op_sel:[0,0,1] op_sel_hi:[1,0,1] neg_lo:[0,0,1] neg_hi:[0,0,1]
v_pk_fma_f32 v[6:7], v[6:7], v[172:173], v[172:173] op_sel:[0,0,1] op_sel_hi:[1,0,1] neg_lo:[0,0,1] neg_hi:[0,0,1]
v_pk_fma_f32 v[8:9], v[8:9], v[172:173], v[172:173] op_sel:[0,0,1] op_sel_hi:[1,0,1] neg_lo:[0,0,1] neg_hi:[0,0,1]
v_pk_fma_f32 v[10:11], v[10:11], v[172:173], v[172:173] op_sel:[0,0,1] op_sel_hi:[1,0,1] neg_lo:[0,0,1] neg_hi:[0,0,1]
v_pk_fma_f32 v[12:13], v[12:13], v[172:173], v[172:173] op_sel:[0,0,1] op_sel_hi:[1,0,1] neg_lo:[0,0,1] neg_hi:[0,0,1]
v_pk_fma_f32 v[14:15], v[14:15], v[172:173], v[172:173] op_sel:[0,0,1] op_sel_hi:[1,0,1] neg_lo:[0,0,1] neg_hi:[0,0,1]
v_pk_fma_f32 v[16:17], v[16:17], v[172:173], v[172:173] op_sel:[0,0,1] op_sel_hi:[1,0,1] neg_lo:[0,0,1] neg_hi:[0,0,1]
v_pk_fma_f32 v[18:19], v[18:19], v[172:173], v[172:173] op_sel:[0,0,1] op_sel_hi:[1,0,1] neg_lo:[0,0,1] neg_hi:[0,0,1]
v_pk_fma_f32 v[20:21], v[20:21], v[172:173], v[172:173] op_sel:[0,0,1] op_sel_hi:[1,0,1] neg_lo:[0,0,1] neg_hi:[0,0,1]
v_pk_fma_f32 v[22:23], v[22:23], v[172:173], v[172:173] op_sel:[0,0,1] op_sel_hi:[1,0,1] neg_lo:[0,0,1] neg_hi:[0,0,1]
v_pk_fma_f32 v[24:25], v[24:25], v[172:173], v[172:173] op_sel:[0,0,1] op_sel_hi:[1,0,1] neg_lo:[0,0,1] neg_hi:[0,0,1]
v_pk_fma_f32 v[26:27], v[26:27], v[172:173], v[172:173] op_sel:[0,0,1] op_sel_hi:[1,0,1] neg_lo:[0,0,1] neg_hi:[0,0,1]
v_pk_fma_f32 v[28:29], v[28:29], v[172:173], v[172:173] op_sel:[0,0,1] op_sel_hi:[1,0,1] neg_lo:[0,0,1] neg_hi:[0,0,1]
v_pk_fma_f32 v[30:31], v[30:31], v[172:173], v[172:173] op_sel:[0,0,1] op_sel_hi:[1,0,1] neg_lo:[0,0,1] neg_hi:[0,0,1]
v_pk_fma_f32 v[32:33], v[32:33], v[172:173], v[172:173] op_sel:[0,0,1] op_sel_hi:[1,0,1] neg_lo:[0,0,1] neg_hi:[0,0,1]
v_pk_fma_f32 v[34:35], v[34:35], v[172:173], v[172:173] op_sel:[0,0,1] op_sel_hi:[1,0,1] neg_lo:[0,0,1] neg_hi:[0,0,1]
v_pk_fma_f32 v[36:37], v[36:37], v[172:173], v[172:173] op_sel:[0,0,1] op_sel_hi:[1,0,1] neg_lo:[0,0,1] neg_hi:[0,0,1]
v_pk_fma_f32 v[38:39], v[38:39], v[172:173], v[172:173] op_sel:[0,0,1] op_sel_hi:[1,0,1] neg_lo:[0,0,1] neg_hi:[0,0,1]
v_pk_fma_f32 v[40:41], v[40:41], v[172:173], v[172:173] op_sel:[0,0,1] op_sel_hi:[1,0,1] neg_lo:[0,0,1] neg_hi:[0,0,1]
v_pk_fma_f32 v[42:43], v[42:43], v[172:173], v[172:173] op_sel:[0,0,1] op_sel_hi:[1,0,1] neg_lo:[0,0,1] neg_hi:[0,0,1]
v_pk_fma_f32 v[44:45], v[44:45], v[172:173], v[172:173] op_sel:[0,0,1] op_sel_hi:[1,0,1] neg_lo:[0,0,1] neg_hi:[0,0,1]
v_pk_fma_f32 v[46:47], v[46:47], v[172:173], v[172:173] op_sel:[0,0,1] op_sel_hi:[1,0,1] neg_lo:[0,0,1] neg_hi:[0,0,1]
s_setprio 2
ds_read_u16_d16_hi v185, v185
ds_read_u16_d16 v186, v186
ds_read_u16_d16_hi v187, v187
s_waitcnt lgkmcnt(3)
v_readfirstlane_b32 s43, v247
s_nop 1
s_cmp_ge_u32 s43, 16
s_cbranch_scc1 Lev5
Lev5w:
s_sleep 1
ds_read_b32 v247, v253 offset:16
s_waitcnt lgkmcnt(0)
v_readfirstlane_b32 s43, v247
s_cmp_eq_u32 s76, 0
s_cbranch_scc1 Lev5
s_sub_u32 s76, s76, 1
s_cmp_lt_u32 s43, 16
s_cbranch_scc1 Lev5w
Lev5:
s_setprio 1
v_cvt_pkrtz_f16_f32 v137, v120, v121
v_cvt_pkrtz_f16_f32 v139, v122, v123
v_cvt_pkrtz_f16_f32 v141, v124, v125
v_cvt_pkrtz_f16_f32 v143, v126, v127
v_cvt_pkrtz_f16_f32 v177, v128, v129
v_cvt_pk_f16_f32 v155, v130, v131
v_cvt_pk_f16_f32 v152, v132, v133
v_cvt_pk_f16_f32 v149, v134, v135
s_add_u32 m0, s67, 53248
s_add_u32 s66, s66, 98304
buffer_load_dwordx4 v240, s[4:7], s66 offen lds
ds_read_b128 v[224:227], v249 offset:23552
v_mfma_f32_32x32x16_bf16 v[120:135], v[48:51], v[228:231], 0
v_pk_fma_f16 v154, v155, v155, s48
v_cvt_pk_bf16_f32 v72, v0, v1
v_and_b32 v137, s49, v137
v_fma_mix_f32 v165, v178, v178, v165 op_sel:[0,0,0] op_sel_hi:[1,1,0]
v_cvt_pk_bf16_f32 v73, v2, v3
v_pk_fma_f16 v151, v152, v152, s48
v_pk_fma_f16 v148, v149, v149, s48
v_bfe_u32 v136, v137, 2, 14
v_cvt_pk_bf16_f32 v74, v4, v5
v_pk_mul_f16 v154, v155, v154
v_pk_mul_f16 v151, v152, v151
v_fma_mix_f32 v165, v179, v179, v165 op_sel:[1,1,0] op_sel_hi:[1,1,0]
v_cvt_pk_bf16_f32 v75, v6, v7
v_lshrrev_b32_e64 v137, 18, v137
s_add_u32 m0, s67, 59904
s_add_u32 s66, s66, 98304
buffer_load_dwordx4 v240, s[4:7], s66 offen lds
ds_read_b128 v[228:231], v248 offset:16384
ds_read_u16_d16 v136, v136
ds_read_u16_d16_hi v137, v137
v_mfma_f32_32x32x16_bf16 v[120:135], v[52:55], v[232:235], v[120:135]
v_pk_mul_f16 v148, v149, v148
v_exp_f16_e64 v153, v154
v_cvt_pk_bf16_f32 v76, v8, v9
v_exp_f16_e64 v150, v151
v_cvt_pk_bf16_f32 v77, v10, v11
v_and_b32_e64 v139, s49, v139
v_fma_mix_f32 v165, v180, v180, v165 op_sel:[0,0,0] op_sel_hi:[1,1,0]
v_cvt_pk_bf16_f32 v78, v12, v13
v_exp_f16 v147, v148
v_bfe_u32 v138, v139, 2, 14
v_cvt_pk_bf16_f32 v79, v14, v15
s_add_u32 m0, s67, 0
s_add_u32 s66, s66, 98304
buffer_load_dwordx4 v240, s[4:7], s66 offen lds
ds_read_b128 v[232:235], v248 offset:19456
ds_read_u16_d16 v138, v138
v_mfma_f32_32x32x16_bf16 v[120:135], v[56:59], v[236:239], v[120:135]
v_exp_f16_sdwa v153, v154 dst_sel:WORD_1 dst_unused:UNUSED_PRESERVE src0_sel:WORD_1
v_lshrrev_b32_e64 v139, 18, v139
v_cvt_pk_bf16_f32 v80, v16, v17
v_fma_mix_f32 v165, v181, v181, v165 op_sel:[1,1,0] op_sel_hi:[1,1,0]
v_exp_f16_sdwa v150, v151 dst_sel:WORD_1 dst_unused:UNUSED_PRESERVE src0_sel:WORD_1
v_cvt_pk_bf16_f32 v81, v18, v19
v_exp_f16_sdwa v147, v148 dst_sel:WORD_1 dst_unused:UNUSED_PRESERVE src0_sel:WORD_1
v_cvt_pk_bf16_f32 v82, v20, v21
v_and_b32_e64 v141, s49, v141
v_fma_mix_f32 v165, v182, v182, v165 op_sel:[0,0,0] op_sel_hi:[1,1,0]
v_pk_add_f16 v153, v153, 1.0 op_sel_hi:[1,0]
s_add_u32 m0, s67, 6656
s_add_u32 s66, s66, 98304
buffer_load_dwordx4 v240, s[4:7], s66 offen lds
s_add_u32 m0, s67, 13312
s_add_u32 s66, s66, 98304
buffer_load_dwordx4 v240, s[4:7], s66 offen lds
ds_read_b128 v[236:239], v248 offset:17408
ds_read_u16_d16_hi v139, v139
v_mfma_f32_32x32x16_bf16 v[120:135], v[60:63], v[216:219], v[120:135]
v_cvt_pk_bf16_f32 v83, v22, v23
v_bfe_u32 v140, v141, 2, 14
v_pk_add_f16 v150, v150, 1.0 op_sel_hi:[1,0]
v_pk_add_f16 v147, v147, 1.0 op_sel_hi:[1,0]
v_cvt_pk_bf16_f32 v84, v24, v25
v_rcp_f16 v154, v153
v_lshrrev_b32 v141, 18, v141
v_cvt_pk_bf16_f32 v85, v26, v27
v_fma_mix_f32 v165, v183, v183, v165 op_sel:[1,1,0] op_sel_hi:[1,1,0]
v_rcp_f16_e64 v151, v150
v_cvt_pk_bf16_f32 v86, v28, v29
v_and_b32_e64 v143, s49, v143
s_add_u32 m0, s67, 19968
s_add_u32 s66, s66, 98304
buffer_load_dwordx4 v240, s[4:7], s66 offen lds
ds_read_b128 v[216:219], v248 offset:20480
ds_read_u16_d16 v140, v140
ds_read_u16_d16_hi v141, v141
v_mfma_f32_32x32x16_bf16 v[120:135], v[64:67], v[220:223], v[120:135]
v_rcp_f16 v148, v147
v_cvt_pk_bf16_f32 v87, v30, v31
v_fma_mix_f32 v165, v184, v184, v165 op_sel:[0,0,0] op_sel_hi:[1,1,0]
v_bfe_u32 v142, v143, 2, 14
v_cvt_pk_bf16_f32 v88, v32, v33
s_setprio 0
v_rcp_f16_sdwa v154, v153 dst_sel:WORD_1 dst_unused:UNUSED_PRESERVE src0_sel:WORD_1
v_rcp_f16_sdwa v151, v150 dst_sel:WORD_1 dst_unused:UNUSED_PRESERVE src0_sel:WORD_1
v_cvt_pk_bf16_f32 v89, v34, v35
v_lshrrev_b32 v143, 18, v143
s_waitcnt lgkmcnt(3)
v_fma_mix_f32 v165, v185, v185, v165 op_sel:[1,1,0] op_sel_hi:[1,1,0]
v_cvt_pk_bf16_f32 v90, v36, v37
s_add_u32 m0, s67, 26624
s_add_u32 s66, s66, 98304
buffer_load_dwordx4 v240, s[4:7], s66 offen lds
ds_read_b128 v[220:223], v248 offset:18432
ds_read_u16_d16 v142, v142
ds_read_u16_d16_hi v143, v143
v_mfma_f32_32x32x16_bf16 v[120:135], v[68:71], v[224:227], v[120:135]
v_rcp_f16_sdwa v148, v147 dst_sel:WORD_1 dst_unused:UNUSED_PRESERVE src0_sel:WORD_1
v_and_b32_e64 v177, s49, v177
v_cvt_pk_bf16_f32 v91, v38, v39
v_pk_mul_f16 v155, v155, v154
v_fma_mix_f32 v165, v186, v186, v165 op_sel:[0,0,0] op_sel_hi:[1,1,0]
v_cvt_pk_bf16_f32 v92, v40, v41
v_pk_mul_f16 v152, v152, v151
v_bfe_u32 v176, v177, 2, 14
v_pk_mul_f16 v149, v149, v148
v_cvt_pk_bf16_f32 v93, v42, v43
v_fma_mix_f32 v166, v155, v155, 0 op_sel:[0,0,0] op_sel_hi:[1,1,0]
v_fma_mix_f32 v166, v155, v155, v166 op_sel:[1,1,0] op_sel_hi:[1,1,0]
v_lshrrev_b32 v177, 18, v177
s_add_u32 m0, s67, 33280
s_add_u32 s66, s66, 98304
buffer_load_dwordx4 v240, s[4:7], s66 offen lds
v_cvt_pk_bf16_f32 v94, v44, v45
v_fma_mix_f32 v165, v187, v187, v165 op_sel:[1,1,0] op_sel_hi:[1,1,0]
v_fma_mix_f32 v166, v152, v152, v166 op_sel:[0,0,0] op_sel_hi:[1,1,0]
v_fma_mix_f32 v166, v152, v152, v166 op_sel:[1,1,0] op_sel_hi:[1,1,0]
v_cvt_pk_bf16_f32 v95, v46, v47
v_fma_mix_f32 v166, v149, v149, v166 op_sel:[0,0,0] op_sel_hi:[1,1,0]
v_fma_mix_f32 v166, v149, v149, v166 op_sel:[1,1,0] op_sel_hi:[1,1,0]
s_setprio 2
v_cvt_pkrtz_f16_f32 v179, v120, v121
v_cvt_pkrtz_f16_f32 v181, v122, v123
v_cvt_pkrtz_f16_f32 v183, v124, v125
v_cvt_pkrtz_f16_f32 v185, v126, v127
v_cvt_pkrtz_f16_f32 v187, v128, v129
v_cvt_pk_f16_f32 v155, v130, v131
v_cvt_pk_f16_f32 v152, v132, v133
v_cvt_pk_f16_f32 v149, v134, v135
ds_read_b128 v[224:227], v248 offset:21504
ds_read_u16_d16 v176, v176
ds_read_u16_d16_hi v177, v177
v_mfma_f32_32x32x16_bf16 v[120:135], v[72:75], v[228:231], 0
v_pk_fma_f16 v154, v155, v155, s48
v_and_b32_e64 v179, s49, v179
v_fma_mix_f32 v166, v136, v136, v166 op_sel:[0,0,0] op_sel_hi:[1,1,0]
v_pk_fma_f16 v151, v152, v152, s48
v_pk_fma_f16 v148, v149, v149, s48
v_bfe_u32 v178, v179, 2, 14
v_pk_mul_f16 v154, v155, v154
v_pk_mul_f16 v151, v152, v151
v_fma_mix_f32 v166, v137, v137, v166 op_sel:[1,1,0] op_sel_hi:[1,1,0]
v_lshrrev_b32_e64 v179, 18, v179
ds_read_b128 v[228:231], v248 offset:22528
ds_read_u16_d16 v178, v178
ds_read_u16_d16_hi v179, v179
v_mfma_f32_32x32x16_bf16 v[120:135], v[76:79], v[232:235], v[120:135]
v_pk_mul_f16 v148, v149, v148
v_exp_f16 v153, v154
v_exp_f16 v150, v151
v_and_b32_e64 v181, s49, v181
v_fma_mix_f32 v166, v138, v138, v166 op_sel:[0,0,0] op_sel_hi:[1,1,0]
v_exp_f16_e64 v147, v148
v_bfe_u32 v180, v181, 2, 14
ds_read_b128 v[232:235], v248 offset:25600
ds_read_u16_d16 v180, v180
v_mfma_f32_32x32x16_bf16 v[120:135], v[80:83], v[236:239], v[120:135]
v_exp_f16_sdwa v153, v154 dst_sel:WORD_1 dst_unused:UNUSED_PRESERVE src0_sel:WORD_1
v_lshrrev_b32_e64 v181, 18, v181
v_fma_mix_f32 v166, v139, v139, v166 op_sel:[1,1,0] op_sel_hi:[1,1,0]
v_exp_f16_sdwa v150, v151 dst_sel:WORD_1 dst_unused:UNUSED_PRESERVE src0_sel:WORD_1
v_exp_f16_sdwa v147, v148 dst_sel:WORD_1 dst_unused:UNUSED_PRESERVE src0_sel:WORD_1
v_and_b32 v183, s49, v183
s_waitcnt lgkmcnt(5)
v_fma_mix_f32 v166, v140, v140, v166 op_sel:[0,0,0] op_sel_hi:[1,1,0]
ds_read_b128 v[236:239], v248 offset:23552
ds_read_u16_d16_hi v181, v181
v_mfma_f32_32x32x16_bf16 v[120:135], v[84:87], v[216:219], v[120:135]
v_pk_add_f16 v153, v153, 1.0 op_sel_hi:[1,0]
v_bfe_u32 v182, v183, 2, 14
v_pk_add_f16 v150, v150, 1.0 op_sel_hi:[1,0]
v_pk_add_f16 v147, v147, 1.0 op_sel_hi:[1,0]
v_rcp_f16 v154, v153
v_lshrrev_b32 v183, 18, v183
v_fma_mix_f32 v166, v141, v141, v166 op_sel:[1,1,0] op_sel_hi:[1,1,0]
v_rcp_f16_e64 v151, v150
ds_read_b128 v[216:219], v248 offset:26624
ds_read_u16_d16 v182, v182
ds_read_u16_d16_hi v183, v183
v_mfma_f32_32x32x16_bf16 v[120:135], v[88:91], v[220:223], v[120:135]
v_and_b32 v185, s49, v185
v_rcp_f16 v148, v147
v_fma_mix_f32 v166, v142, v142, v166 op_sel:[0,0,0] op_sel_hi:[1,1,0]
v_bfe_u32 v184, v185, 2, 14
v_rcp_f16_sdwa v154, v153 dst_sel:WORD_1 dst_unused:UNUSED_PRESERVE src0_sel:WORD_1
v_rcp_f16_sdwa v151, v150 dst_sel:WORD_1 dst_unused:UNUSED_PRESERVE src0_sel:WORD_1
v_lshrrev_b32_e64 v185, 18, v185
ds_read_b128 v[220:223], v248 offset:24576
ds_read_u16_d16 v184, v184
ds_read_u16_d16_hi v185, v185
v_mfma_f32_32x32x16_bf16 v[120:135], v[92:95], v[224:227], v[120:135]
v_fma_mix_f32 v166, v143, v143, v166 op_sel:[1,1,0] op_sel_hi:[1,1,0]
v_rcp_f16_sdwa v148, v147 dst_sel:WORD_1 dst_unused:UNUSED_PRESERVE src0_sel:WORD_1
s_cmp_eq_u32 s40, 7
s_cbranch_scc1 Lrdy16
s_waitcnt vmcnt(0)
Lrdy16:
s_mov_b64 exec, 1
ds_add_u32 v253, v254 offset:12
s_mov_b64 exec, -1
v_and_b32 v187, s49, v187
v_pk_mul_f16 v155, v155, v154
v_fma_mix_f32 v166, v176, v176, v166 op_sel:[0,0,0] op_sel_hi:[1,1,0]
v_pk_mul_f16 v152, v152, v151
v_bfe_u32 v186, v187, 2, 14
v_pk_mul_f16 v149, v149, v148
v_fma_mix_f32 v167, v155, v155, 0 op_sel:[0,0,0] op_sel_hi:[1,1,0]
v_fma_mix_f32 v167, v155, v155, v167 op_sel:[1,1,0] op_sel_hi:[1,1,0]
v_lshrrev_b32_e64 v187, 18, v187
v_fma_mix_f32 v166, v177, v177, v166 op_sel:[1,1,0] op_sel_hi:[1,1,0]
v_fma_mix_f32 v167, v152, v152, v167 op_sel:[0,0,0] op_sel_hi:[1,1,0]
v_fma_mix_f32 v167, v152, v152, v167 op_sel:[1,1,0] op_sel_hi:[1,1,0]
v_fma_mix_f32 v167, v149, v149, v167 op_sel:[0,0,0] op_sel_hi:[1,1,0]
v_fma_mix_f32 v167, v149, v149, v167 op_sel:[1,1,0] op_sel_hi:[1,1,0]
s_setprio 1
v_cvt_pkrtz_f16_f32 v137, v120, v121
v_cvt_pkrtz_f16_f32 v139, v122, v123
v_cvt_pkrtz_f16_f32 v141, v124, v125
v_cvt_pkrtz_f16_f32 v143, v126, v127
v_cvt_pkrtz_f16_f32 v177, v128, v129
v_cvt_pk_f16_f32 v155, v130, v131
v_cvt_pk_f16_f32 v152, v132, v133
v_cvt_pk_f16_f32 v149, v134, v135
s_waitcnt lgkmcnt(1)
ds_read_b128 v[224:227], v248 offset:27648
ds_read_u16_d16 v186, v186
ds_read_u16_d16_hi v187, v187
v_mfma_f32_32x32x16_bf16 v[120:135], v[72:75], v[228:231], 0
v_pk_fma_f16 v154, v155, v155, s48
v_and_b32_e64 v137, s49, v137
v_fma_mix_f32 v167, v178, v178, v167 op_sel:[0,0,0] op_sel_hi:[1,1,0]
v_pk_fma_f16 v151, v152, v152, s48
v_pk_fma_f16 v148, v149, v149, s48
v_bfe_u32 v136, v137, 2, 14
v_pk_mul_f16 v154, v155, v154
v_pk_mul_f16 v151, v152, v151
v_fma_mix_f32 v167, v179, v179, v167 op_sel:[1,1,0] op_sel_hi:[1,1,0]
v_lshrrev_b32_e64 v137, 18, v137
ds_read_b128 v[228:231], v250 offset:65520
ds_read_u16_d16 v136, v136
ds_read_u16_d16_hi v137, v137
v_mfma_f32_32x32x16_bf16 v[120:135], v[76:79], v[232:235], v[120:135]
v_pk_mul_f16 v148, v149, v148
v_exp_f16 v153, v154
v_exp_f16 v150, v151
v_and_b32_e64 v139, s49, v139
v_fma_mix_f32 v167, v180, v180, v167 op_sel:[0,0,0] op_sel_hi:[1,1,0]
v_exp_f16_e64 v147, v148
v_bfe_u32 v138, v139, 2, 14
ds_read_b128 v[232:235], v248 offset:28672
ds_read_b32 v247, v253 offset:12
ds_read_u16_d16 v138, v138
v_mfma_f32_32x32x16_bf16 v[120:135], v[80:83], v[236:239], v[120:135]
v_exp_f16_sdwa v153, v154 dst_sel:WORD_1 dst_unused:UNUSED_PRESERVE src0_sel:WORD_1
v_lshrrev_b32_e64 v139, 18, v139
v_fma_mix_f32 v167, v181, v181, v167 op_sel:[1,1,0] op_sel_hi:[1,1,0]
v_exp_f16_sdwa v150, v151 dst_sel:WORD_1 dst_unused:UNUSED_PRESERVE src0_sel:WORD_1
v_exp_f16_sdwa v147, v148 dst_sel:WORD_1 dst_unused:UNUSED_PRESERVE src0_sel:WORD_1
v_and_b32_e64 v141, s49, v141
v_fma_mix_f32 v167, v182, v182, v167 op_sel:[0,0,0] op_sel_hi:[1,1,0]
ds_read_b128 v[236:239], v248 offset:31744
ds_read_u16_d16_hi v139, v139
v_mfma_f32_32x32x16_bf16 v[120:135], v[84:87], v[216:219], v[120:135]
v_pk_add_f16 v153, v153, 1.0 op_sel_hi:[1,0]
v_bfe_u32 v140, v141, 2, 14
v_pk_add_f16 v150, v150, 1.0 op_sel_hi:[1,0]
v_pk_add_f16 v147, v147, 1.0 op_sel_hi:[1,0]
v_rcp_f16 v154, v153
v_lshrrev_b32 v141, 18, v141
ds_read_u16_d16 v140, v140
ds_read_u16_d16_hi v141, v141
s_waitcnt lgkmcnt(5)
v_readfirstlane_b32 s43, v247
s_nop 1
s_cmp_ge_u32 s43, 24
s_cbranch_scc1 Lev6
Lev6w:
s_sleep 1
ds_read_b32 v247, v253 offset:12
s_waitcnt lgkmcnt(0)
v_readfirstlane_b32 s43, v247
s_cmp_eq_u32 s76, 0
s_cbranch_scc1 Lev6
s_sub_u32 s76, s76, 1
s_cmp_lt_u32 s43, 24
s_cbranch_scc1 Lev6w
Lev6:
v_fma_mix_f32 v167, v183, v183, v167 op_sel:[1,1,0] op_sel_hi:[1,1,0]
v_rcp_f16 v151, v150
ds_read_b128 v[216:219], v248 offset:29696
v_mfma_f32_32x32x16_bf16 v[120:135], v[88:91], v[220:223], v[120:135]
v_and_b32 v143, s49, v143
v_rcp_f16 v148, v147
v_fma_mix_f32 v167, v184, v184, v167 op_sel:[0,0,0] op_sel_hi:[1,1,0]
v_bfe_u32 v142, v143, 2, 14
s_setprio 0
v_rcp_f16_sdwa v154, v153 dst_sel:WORD_1 dst_unused:UNUSED_PRESERVE src0_sel:WORD_1
v_rcp_f16_sdwa v151, v150 dst_sel:WORD_1 dst_unused:UNUSED_PRESERVE src0_sel:WORD_1
v_lshrrev_b32 v143, 18, v143
ds_read_b128 v[220:223], v245
ds_read_b128 v[192:195], v242
ds_read_b128 v[196:199], v242 offset:64
ds_read_u16_d16 v142, v142
ds_read_u16_d16_hi v143, v143
v_mfma_f32_32x32x16_bf16 v[120:135], v[92:95], v[224:227], v[120:135]
v_fma_mix_f32 v167, v185, v185, v167 op_sel:[1,1,0] op_sel_hi:[1,1,0]
v_rcp_f16_sdwa v148, v147 dst_sel:WORD_1 dst_unused:UNUSED_PRESERVE src0_sel:WORD_1
v_and_b32_e64 v177, s49, v177
v_pk_mul_f16 v155, v155, v154
v_fma_mix_f32 v167, v186, v186, v167 op_sel:[0,0,0] op_sel_hi:[1,1,0]
v_pk_mul_f16 v152, v152, v151
v_bfe_u32 v176, v177, 2, 14
v_pk_mul_f16 v149, v149, v148
v_fma_mix_f32 v156, v155, v155, v156 op_sel:[0,0,0] op_sel_hi:[1,1,0]
v_fma_mix_f32 v156, v155, v155, v156 op_sel:[1,1,0] op_sel_hi:[1,1,0]
v_lshrrev_b32 v177, 18, v177
v_fma_mix_f32 v167, v187, v187, v167 op_sel:[1,1,0] op_sel_hi:[1,1,0]
v_fma_mix_f32 v156, v152, v152, v156 op_sel:[0,0,0] op_sel_hi:[1,1,0]
v_fma_mix_f32 v156, v152, v152, v156 op_sel:[1,1,0] op_sel_hi:[1,1,0]
v_fma_mix_f32 v156, v149, v149, v156 op_sel:[0,0,0] op_sel_hi:[1,1,0]
v_fma_mix_f32 v156, v149, v149, v156 op_sel:[1,1,0] op_sel_hi:[1,1,0]
s_setprio 2
v_mfma_f32_32x32x16_bf16 v[0:15], v[228:231], v[228:231], 0
buffer_store_dwordx4 v[48:51], v241, s[32:35], s80 offen sc1
ds_read_b128 v[224:227], v248 offset:32768
ds_read_u16_d16 v176, v176
ds_read_u16_d16_hi v177, v177
v_cvt_pkrtz_f16_f32 v179, v120, v121
v_cvt_pkrtz_f16_f32 v181, v122, v123
v_cvt_pkrtz_f16_f32 v183, v124, v125
v_mfma_f32_32x32x16_bf16 v[16:31], v[228:231], v[228:231], 0
v_cvt_pkrtz_f16_f32 v185, v126, v127
v_cvt_pkrtz_f16_f32 v187, v128, v129
v_cvt_pk_f16_f32 v155, v130, v131
v_cvt_pk_f16_f32 v152, v132, v133
v_mfma_f32_32x32x16_bf16 v[32:47], v[228:231], v[228:231], 0
v_cvt_pk_f16_f32 v149, v134, v135
v_pk_fma_f16 v154, v155, v155, s48
v_and_b32_e64 v179, s49, v179
v_mfma_f32_32x32x16_bf16 v[120:135], v[72:75], v[232:235], 0
ds_read_b128 v[228:231], v248 offset:30720
v_fma_mix_f32 v156, v136, v136, v156 op_sel:[0,0,0] op_sel_hi:[1,1,0]
v_pk_fma_f16 v151, v152, v152, s48
v_pk_fma_f16 v148, v149, v149, s48
v_bfe_u32 v178, v179, 2, 14
v_pk_mul_f16 v154, v155, v154
v_pk_mul_f16 v151, v152, v151
v_fma_mix_f32 v156, v137, v137, v156 op_sel:[1,1,0] op_sel_hi:[1,1,0]
s_waitcnt lgkmcnt(4)
v_mfma_f32_32x32x16_bf16 v[120:135], v[76:79], v[236:239], v[120:135]
ds_read_b128 v[232:235], v245 offset:384
ds_read_b128 v[200:203], v242 offset:128
ds_read_b128 v[204:207], v243
ds_read_u16_d16 v178, v178
v_lshrrev_b32 v179, 18, v179
v_pk_mul_f16 v148, v149, v148
v_exp_f16 v153, v154
v_exp_f16 v150, v151
v_and_b32_e64 v181, s49, v181
v_fma_mix_f32 v156, v138, v138, v156 op_sel:[0,0,0] op_sel_hi:[1,1,0]
v_mfma_f32_32x32x16_bf16 v[120:135], v[80:83], v[216:219], v[120:135]
ds_read_b128 v[236:239], v248 offset:33792
ds_read_u16_d16_hi v179, v179
v_exp_f16_e64 v147, v148
v_bfe_u32 v180, v181, 2, 14
v_exp_f16_sdwa v153, v154 dst_sel:WORD_1 dst_unused:UNUSED_PRESERVE src0_sel:WORD_1
v_lshrrev_b32_e64 v181, 18, v181
v_fma_mix_f32 v156, v139, v139, v156 op_sel:[1,1,0] op_sel_hi:[1,1,0]
v_smfmac_f32_16x16x32_bf16 v[0:3], v[220:221], v[192:195], v246
ds_read_b128 v[216:219], v245 offset:768
ds_read_b128 v[208:211], v243 offset:64
ds_read_b128 v[212:215], v243 offset:128
ds_read_u16_d16 v180, v180
ds_read_u16_d16_hi v181, v181
v_exp_f16_sdwa v150, v151 dst_sel:WORD_1 dst_unused:UNUSED_PRESERVE src0_sel:WORD_1
v_smfmac_f32_16x16x32_bf16 v[16:19], v[222:223], v[196:199], v246
v_exp_f16_sdwa v147, v148 dst_sel:WORD_1 dst_unused:UNUSED_PRESERVE src0_sel:WORD_1
v_and_b32 v183, s49, v183
v_fma_mix_f32 v156, v140, v140, v156 op_sel:[0,0,0] op_sel_hi:[1,1,0]
v_pk_add_f16 v153, v153, 1.0 op_sel_hi:[1,0]
s_waitcnt lgkmcnt(7)
v_mfma_f32_32x32x16_bf16 v[120:135], v[84:87], v[224:227], v[120:135]
ds_read_b128 v[220:223], v245 offset:1152
ds_read_b128 v[192:195], v244
ds_read_b128 v[196:199], v244 offset:64
v_bfe_u32 v182, v183, 2, 14
v_pk_add_f16 v150, v150, 1.0 op_sel_hi:[1,0]
v_pk_add_f16 v147, v147, 1.0 op_sel_hi:[1,0]
v_rcp_f16 v154, v153
v_lshrrev_b32 v183, 18, v183
v_fma_mix_f32 v156, v141, v141, v156 op_sel:[1,1,0] op_sel_hi:[1,1,0]
v_mfma_f32_32x32x16_bf16 v[120:135], v[88:91], v[228:231], v[120:135]
ds_read_b128 v[224:227], v248 offset:34816
ds_read_u16_d16 v182, v182
ds_read_u16_d16_hi v183, v183
v_rcp_f16 v151, v150
v_and_b32 v185, s49, v185
v_rcp_f16_e64 v148, v147
v_fma_mix_f32 v156, v142, v142, v156 op_sel:[0,0,0] op_sel_hi:[1,1,0]
v_bfe_u32 v184, v185, 2, 14
v_smfmac_f32_16x16x32_bf16 v[32:35], v[232:233], v[200:203], v246
ds_read_b128 v[228:231], v248 offset:37888
ds_read_u16_d16 v184, v184
v_rcp_f16_sdwa v154, v153 dst_sel:WORD_1 dst_unused:UNUSED_PRESERVE src0_sel:WORD_1
v_rcp_f16_sdwa v151, v150 dst_sel:WORD_1 dst_unused:UNUSED_PRESERVE src0_sel:WORD_1
v_smfmac_f32_16x16x32_bf16 v[0:3], v[234:235], v[204:207], v246
v_lshrrev_b32 v185, 18, v185
v_fma_mix_f32 v156, v143, v143, v156 op_sel:[1,1,0] op_sel_hi:[1,1,0]
s_waitcnt lgkmcnt(6)
v_mfma_f32_32x32x16_bf16 v[120:135], v[92:95], v[236:239], v[120:135]
ds_read_b128 v[232:235], v248 offset:35840
ds_read_u16_d16_hi v185, v185
v_rcp_f16_sdwa v148, v147 dst_sel:WORD_1 dst_unused:UNUSED_PRESERVE src0_sel:WORD_1
v_and_b32_e64 v187, s49, v187
v_pk_mul_f16 v155, v155, v154
v_fma_mix_f32 v156, v176, v176, v156 op_sel:[0,0,0] op_sel_hi:[1,1,0]
v_pk_mul_f16 v152, v152, v151
v_bfe_u32 v186, v187, 2, 14
v_pk_mul_f16 v149, v149, v148
v_smfmac_f32_16x16x32_bf16 v[16:19], v[216:217], v[208:211], v246
ds_read_b128 v[236:239], v248 offset:38912
ds_read_u16_d16 v186, v186
v_fma_mix_f32 v157, v155, v155, v157 op_sel:[0,0,0] op_sel_hi:[1,1,0]
v_fma_mix_f32 v157, v155, v155, v157 op_sel:[1,1,0] op_sel_hi:[1,1,0]
v_lshrrev_b32_e64 v187, 18, v187
v_fma_mix_f32 v156, v177, v177, v156 op_sel:[1,1,0] op_sel_hi:[1,1,0]
v_smfmac_f32_16x16x32_bf16 v[32:35], v[218:219], v[212:215], v246
v_fma_mix_f32 v157, v152, v152, v157 op_sel:[0,0,0] op_sel_hi:[1,1,0]
v_fma_mix_f32 v157, v152, v152, v157 op_sel:[1,1,0] op_sel_hi:[1,1,0]
v_fma_mix_f32 v157, v149, v149, v157 op_sel:[0,0,0] op_sel_hi:[1,1,0]
v_fma_mix_f32 v157, v149, v149, v157 op_sel:[1,1,0] op_sel_hi:[1,1,0]
s_setprio 1
v_smfmac_f32_16x16x32_bf16 v[0:3], v[220:221], v[192:195], v246
s_waitcnt lgkmcnt(4)
s_add_u32 s46, s80, 2097152
buffer_store_dwordx4 v[52:55], v241, s[32:35], s46 offen sc1
ds_read_b128 v[216:219], v248 offset:36864
ds_read_u16_d16_hi v187, v187
v_cvt_pkrtz_f16_f32 v137, v120, v121
v_cvt_pkrtz_f16_f32 v139, v122, v123
v_cvt_pkrtz_f16_f32 v141, v124, v125
v_cvt_pkrtz_f16_f32 v143, v126, v127
v_cvt_pk_f16_f32 v155, v128, v129
v_smfmac_f32_16x16x32_bf16 v[16:19], v[222:223], v[196:199], v246
v_cvt_pk_f16_f32 v152, v130, v131
v_cvt_pk_f16_f32 v149, v132, v133
v_cvt_pk_f16_f32 v146, v134, v135
v_pk_fma_f16 v154, v155, v155, s48
v_and_b32_e64 v137, s49, v137
v_mfma_f32_32x32x16_bf16 v[120:135], v[72:75], v[224:227], 0
ds_read_b128 v[220:223], v248 offset:39936
v_fma_mix_f32 v157, v178, v178, v157 op_sel:[0,0,0] op_sel_hi:[1,1,0]
v_pk_fma_f16 v151, v152, v152, s48
v_pk_fma_f16 v148, v149, v149, s48
v_pk_fma_f16 v145, v146, v146, s48
v_pk_mul_f16 v154, v155, v154
v_bfe_u32 v136, v137, 2, 14
v_pk_mul_f16 v151, v152, v151
v_fma_mix_f32 v157, v179, v179, v157 op_sel:[1,1,0] op_sel_hi:[1,1,0]
v_pk_mul_f16 v148, v149, v148
v_pk_mul_f16 v145, v146, v145
v_mfma_f32_32x32x16_bf16 v[120:135], v[76:79], v[228:231], v[120:135]
ds_read_b128 v[224:227], v245 offset:1536
ds_read_b128 v[200:203], v244 offset:128
v_xor_b32 v242, 16, v242
ds_read_b128 v[204:207], v242
ds_read_u16_d16 v136, v136
v_exp_f16 v153, v154
v_lshrrev_b32 v137, 18, v137
v_exp_f16 v150, v151
v_fma_mix_f32 v157, v180, v180, v157 op_sel:[0,0,0] op_sel_hi:[1,1,0]
v_exp_f16 v147, v148
v_and_b32 v139, s49, v139
v_exp_f16 v144, v145
s_waitcnt lgkmcnt(5)
v_mfma_f32_32x32x16_bf16 v[120:135], v[80:83], v[232:235], v[120:135]
ds_read_b128 v[228:231], v245 offset:1920
ds_read_b128 v[208:211], v242 offset:64
ds_read_b128 v[212:215], v242 offset:128
ds_read_u16_d16_hi v137, v137
v_exp_f16_sdwa v153, v154 dst_sel:WORD_1 dst_unused:UNUSED_PRESERVE src0_sel:WORD_1
v_fma_mix_f32 v157, v181, v181, v157 op_sel:[1,1,0] op_sel_hi:[1,1,0]
v_bfe_u32 v138, v139, 2, 14
v_exp_f16_sdwa v150, v151 dst_sel:WORD_1 dst_unused:UNUSED_PRESERVE src0_sel:WORD_1
v_exp_f16_sdwa v147, v148 dst_sel:WORD_1 dst_unused:UNUSED_PRESERVE src0_sel:WORD_1
v_exp_f16_sdwa v144, v145 dst_sel:WORD_1 dst_unused:UNUSED_PRESERVE src0_sel:WORD_1
v_lshrrev_b32_e64 v139, 18, v139
v_fma_mix_f32 v157, v182, v182, v157 op_sel:[0,0,0] op_sel_hi:[1,1,0]
v_mfma_f32_32x32x16_bf16 v[120:135], v[84:87], v[236:239], v[120:135]
ds_read_b128 v[232:235], v248 offset:40960
ds_read_u16_d16 v138, v138
ds_read_u16_d16_hi v139, v139
v_pk_add_f16 v153, v153, 1.0 op_sel_hi:[1,0]
v_pk_add_f16 v150, v150, 1.0 op_sel_hi:[1,0]
v_pk_add_f16 v147, v147, 1.0 op_sel_hi:[1,0]
v_and_b32_e64 v141, s49, v141
v_pk_add_f16 v144, v144, 1.0 op_sel_hi:[1,0]
v_rcp_f16_e64 v154, v153
v_fma_mix_f32 v157, v183, v183, v157 op_sel:[1,1,0] op_sel_hi:[1,1,0]
v_rcp_f16_e64 v151, v150
v_mfma_f32_32x32x16_bf16 v[120:135], v[88:91], v[216:219], v[120:135]
ds_read_b128 v[236:239], v248 offset:44032
v_bfe_u32 v140, v141, 2, 14
v_rcp_f16_e64 v148, v147
v_fma_mix_f32 v157, v184, v184, v157 op_sel:[0,0,0] op_sel_hi:[1,1,0]
v_rcp_f16 v145, v144
v_lshrrev_b32 v141, 18, v141
v_rcp_f16_sdwa v154, v153 dst_sel:WORD_1 dst_unused:UNUSED_PRESERVE src0_sel:WORD_1
s_setprio 0
v_rcp_f16_sdwa v151, v150 dst_sel:WORD_1 dst_unused:UNUSED_PRESERVE src0_sel:WORD_1
s_waitcnt lgkmcnt(4)
v_mfma_f32_32x32x16_bf16 v[120:135], v[92:95], v[220:223], v[120:135]
ds_read_b128 v[216:219], v248 offset:41984
ds_read_u16_d16 v140, v140
ds_read_u16_d16_hi v141, v141
v_fma_mix_f32 v157, v185, v185, v157 op_sel:[1,1,0] op_sel_hi:[1,1,0]
v_and_b32_e64 v143, s49, v143
v_rcp_f16_sdwa v148, v147 dst_sel:WORD_1 dst_unused:UNUSED_PRESERVE src0_sel:WORD_1
v_rcp_f16_sdwa v145, v144 dst_sel:WORD_1 dst_unused:UNUSED_PRESERVE src0_sel:WORD_1
v_pk_mul_f16 v155, v155, v154
v_bfe_u32 v142, v143, 2, 14
v_fma_mix_f32 v157, v186, v186, v157 op_sel:[0,0,0] op_sel_hi:[1,1,0]
v_pk_mul_f16 v152, v152, v151
v_pk_mul_f16 v149, v149, v148
v_smfmac_f32_16x16x32_bf16 v[32:35], v[224:225], v[200:203], v246
ds_read_b128 v[220:223], v248 offset:45056
ds_read_u16_d16 v142, v142
v_pk_mul_f16 v146, v146, v145
v_fma_mix_f32 v158, v155, v155, v158 op_sel:[0,0,0] op_sel_hi:[1,1,0]
v_lshrrev_b32 v143, 18, v143
v_fma_mix_f32 v158, v155, v155, v158 op_sel:[1,1,0] op_sel_hi:[1,1,0]
v_fma_mix_f32 v158, v152, v152, v158 op_sel:[0,0,0] op_sel_hi:[1,1,0]
v_smfmac_f32_16x16x32_bf16 v[4:7], v[226:227], v[204:207], v246
v_fma_mix_f32 v157, v187, v187, v157 op_sel:[1,1,0] op_sel_hi:[1,1,0]
v_fma_mix_f32 v158, v152, v152, v158 op_sel:[1,1,0] op_sel_hi:[1,1,0]
v_fma_mix_f32 v158, v149, v149, v158 op_sel:[0,0,0] op_sel_hi:[1,1,0]
v_fma_mix_f32 v158, v149, v149, v158 op_sel:[1,1,0] op_sel_hi:[1,1,0]
v_fma_mix_f32 v158, v146, v146, v158 op_sel:[0,0,0] op_sel_hi:[1,1,0]
v_fma_mix_f32 v158, v146, v146, v158 op_sel:[1,1,0] op_sel_hi:[1,1,0]
s_setprio 2
v_smfmac_f32_16x16x32_bf16 v[20:23], v[228:229], v[208:211], v246
s_add_u32 s46, s80, 4194304
buffer_store_dwordx4 v[56:59], v241, s[32:35], s46 offen sc1
ds_read_b128 v[224:227], v248 offset:43008
ds_read_u16_d16_hi v143, v143
v_cvt_pkrtz_f16_f32 v179, v120, v121
v_cvt_pkrtz_f16_f32 v181, v122, v123
v_cvt_pkrtz_f16_f32 v183, v124, v125
v_cvt_pkrtz_f16_f32 v185, v126, v127
v_smfmac_f32_16x16x32_bf16 v[36:39], v[230:231], v[212:215], v246
v_cvt_pkrtz_f16_f32 v187, v128, v129
v_cvt_pk_f16_f32 v155, v130, v131
v_cvt_pk_f16_f32 v152, v132, v133
v_cvt_pk_f16_f32 v149, v134, v135
v_pk_fma_f16 v154, v155, v155, s48
s_waitcnt lgkmcnt(2)
v_mfma_f32_32x32x16_bf16 v[120:135], v[72:75], v[232:235], 0
ds_read_b128 v[228:231], v248 offset:46080
v_and_b32 v179, s49, v179
v_fma_mix_f32 v158, v136, v136, v158 op_sel:[0,0,0] op_sel_hi:[1,1,0]
v_pk_fma_f16 v151, v152, v152, s48
v_pk_fma_f16 v148, v149, v149, s48
v_bfe_u32 v178, v179, 2, 14
v_pk_mul_f16 v154, v155, v154
v_pk_mul_f16 v151, v152, v151
v_pk_mul_f16 v148, v149, v148
v_lshrrev_b32 v179, 18, v179
v_mfma_f32_32x32x16_bf16 v[120:135], v[76:79], v[236:239], v[120:135]
ds_read_b128 v[232:235], v245 offset:2304
v_xor_b32 v243, 16, v243
ds_read_b128 v[192:195], v243
ds_read_b128 v[196:199], v243 offset:64
ds_read_u16_d16 v178, v178
ds_read_u16_d16_hi v179, v179
v_fma_mix_f32 v158, v137, v137, v158 op_sel:[1,1,0] op_sel_hi:[1,1,0]
v_exp_f16 v153, v154
v_and_b32 v181, s49, v181
v_exp_f16 v150, v151
v_exp_f16 v147, v148
v_bfe_u32 v180, v181, 2, 14
v_mfma_f32_32x32x16_bf16 v[120:135], v[80:83], v[216:219], v[120:135]
ds_read_b128 v[236:239], v245 offset:2688
ds_read_b128 v[200:203], v243 offset:128
v_xor_b32 v244, 16, v244
ds_read_b128 v[204:207], v244
ds_read_u16_d16 v180, v180
v_fma_mix_f32 v158, v138, v138, v158 op_sel:[0,0,0] op_sel_hi:[1,1,0]
v_exp_f16_sdwa v153, v154 dst_sel:WORD_1 dst_unused:UNUSED_PRESERVE src0_sel:WORD_1
v_lshrrev_b32 v181, 18, v181
v_exp_f16_sdwa v150, v151 dst_sel:WORD_1 dst_unused:UNUSED_PRESERVE src0_sel:WORD_1
v_fma_mix_f32 v158, v139, v139, v158 op_sel:[1,1,0] op_sel_hi:[1,1,0]
v_and_b32_e64 v183, s49, v183
v_mfma_f32_32x32x16_bf16 v[120:135], v[84:87], v[220:223], v[120:135]
ds_read_b128 v[216:219], v248 offset:47104
ds_read_u16_d16_hi v181, v181
v_exp_f16_sdwa v147, v148 dst_sel:WORD_1 dst_unused:UNUSED_PRESERVE src0_sel:WORD_1
v_pk_add_f16 v153, v153, 1.0 op_sel_hi:[1,0]
v_bfe_u32 v182, v183, 2, 14
v_pk_add_f16 v150, v150, 1.0 op_sel_hi:[1,0]
v_pk_add_f16 v147, v147, 1.0 op_sel_hi:[1,0]
v_rcp_f16_e64 v154, v153
v_lshrrev_b32 v183, 18, v183
v_fma_mix_f32 v158, v140, v140, v158 op_sel:[0,0,0] op_sel_hi:[1,1,0]
s_waitcnt lgkmcnt(6)
v_mfma_f32_32x32x16_bf16 v[120:135], v[88:91], v[224:227], v[120:135]
ds_read_b128 v[220:223], v248 offset:50176
ds_read_u16_d16 v182, v182
ds_read_u16_d16_hi v183, v183
v_rcp_f16 v151, v150
v_and_b32 v185, s49, v185
v_rcp_f16_e64 v148, v147
v_fma_mix_f32 v158, v141, v141, v158 op_sel:[1,1,0] op_sel_hi:[1,1,0]
v_bfe_u32 v184, v185, 2, 14
v_rcp_f16_sdwa v154, v153 dst_sel:WORD_1 dst_unused:UNUSED_PRESERVE src0_sel:WORD_1
v_mfma_f32_32x32x16_bf16 v[120:135], v[92:95], v[228:231], v[120:135]
ds_read_b128 v[224:227], v248 offset:48128
ds_read_u16_d16 v184, v184
v_rcp_f16_sdwa v151, v150 dst_sel:WORD_1 dst_unused:UNUSED_PRESERVE src0_sel:WORD_1
v_lshrrev_b32_e64 v185, 18, v185
v_rcp_f16_sdwa v148, v147 dst_sel:WORD_1 dst_unused:UNUSED_PRESERVE src0_sel:WORD_1
v_and_b32_e64 v187, s49, v187
v_fma_mix_f32 v158, v142, v142, v158 op_sel:[0,0,0] op_sel_hi:[1,1,0]
v_pk_mul_f16 v155, v155, v154
v_pk_mul_f16 v152, v152, v151
v_smfmac_f32_16x16x32_bf16 v[4:7], v[232:233], v[192:195], v246
ds_read_b128 v[228:231], v248 offset:51200
ds_read_u16_d16_hi v185, v185
v_bfe_u32 v186, v187, 2, 14
v_pk_mul_f16 v149, v149, v148
v_fma_mix_f32 v159, v155, v155, v159 op_sel:[0,0,0] op_sel_hi:[1,1,0]
v_fma_mix_f32 v158, v143, v143, v158 op_sel:[1,1,0] op_sel_hi:[1,1,0]
v_lshrrev_b32_e64 v187, 18, v187
v_smfmac_f32_16x16x32_bf16 v[20:23], v[234:235], v[196:199], v246
v_fma_mix_f32 v159, v155, v155, v159 op_sel:[1,1,0] op_sel_hi:[1,1,0]
v_fma_mix_f32 v159, v152, v152, v159 op_sel:[0,0,0] op_sel_hi:[1,1,0]
v_fma_mix_f32 v159, v152, v152, v159 op_sel:[1,1,0] op_sel_hi:[1,1,0]
v_fma_mix_f32 v159, v149, v149, v159 op_sel:[0,0,0] op_sel_hi:[1,1,0]
v_fma_mix_f32 v159, v149, v149, v159 op_sel:[1,1,0] op_sel_hi:[1,1,0]
s_setprio 1
s_waitcnt lgkmcnt(4)
v_smfmac_f32_16x16x32_bf16 v[36:39], v[236:237], v[200:203], v246
s_add_u32 s46, s80, 6291456
buffer_store_dwordx4 v[60:63], v241, s[32:35], s46 offen sc1
ds_read_b128 v[232:235], v248 offset:49152
ds_read_u16_d16 v186, v186
ds_read_u16_d16_hi v187, v187
v_cvt_pkrtz_f16_f32 v137, v120, v121
v_cvt_pkrtz_f16_f32 v139, v122, v123
v_cvt_pkrtz_f16_f32 v141, v124, v125
v_cvt_pkrtz_f16_f32 v143, v126, v127
v_cvt_pk_f16_f32 v155, v128, v129
v_smfmac_f32_16x16x32_bf16 v[4:7], v[238:239], v[204:207], v246
v_cvt_pk_f16_f32 v152, v130, v131
v_cvt_pk_f16_f32 v149, v132, v133
v_cvt_pk_f16_f32 v146, v134, v135
v_pk_fma_f16 v154, v155, v155, s48
v_and_b32_e64 v137, s49, v137
v_mfma_f32_32x32x16_bf16 v[120:135], v[72:75], v[216:219], 0
ds_read_b128 v[236:239], v248 offset:52224
v_fma_mix_f32 v159, v178, v178, v159 op_sel:[0,0,0] op_sel_hi:[1,1,0]
v_pk_fma_f16 v151, v152, v152, s48
v_pk_fma_f16 v148, v149, v149, s48
v_pk_fma_f16 v145, v146, v146, s48
v_pk_mul_f16 v154, v155, v154
v_bfe_u32 v136, v137, 2, 14
v_pk_mul_f16 v151, v152, v151
v_fma_mix_f32 v159, v179, v179, v159 op_sel:[1,1,0] op_sel_hi:[1,1,0]
v_pk_mul_f16 v148, v149, v148
v_pk_mul_f16 v145, v146, v145
v_mfma_f32_32x32x16_bf16 v[120:135], v[76:79], v[220:223], v[120:135]
ds_read_b128 v[216:219], v245 offset:3072
ds_read_b128 v[208:211], v244 offset:64
ds_read_b128 v[212:215], v244 offset:128
ds_read_u16_d16 v136, v136
v_exp_f16 v153, v154
v_lshrrev_b32 v137, 18, v137
v_exp_f16_e64 v150, v151
v_fma_mix_f32 v159, v180, v180, v159 op_sel:[0,0,0] op_sel_hi:[1,1,0]
v_exp_f16 v147, v148
v_and_b32 v139, s49, v139
v_exp_f16_e64 v144, v145
s_waitcnt lgkmcnt(5)
v_mfma_f32_32x32x16_bf16 v[120:135], v[80:83], v[224:227], v[120:135]
ds_read_b128 v[220:223], v245 offset:3456
v_xor_b32 v242, 32, v242
ds_read_b128 v[192:195], v242
ds_read_b128 v[196:199], v242 offset:64
ds_read_u16_d16_hi v137, v137
v_exp_f16_sdwa v153, v154 dst_sel:WORD_1 dst_unused:UNUSED_PRESERVE src0_sel:WORD_1
v_fma_mix_f32 v159, v181, v181, v159 op_sel:[1,1,0] op_sel_hi:[1,1,0]
v_bfe_u32 v138, v139, 2, 14
v_exp_f16_sdwa v150, v151 dst_sel:WORD_1 dst_unused:UNUSED_PRESERVE src0_sel:WORD_1
v_exp_f16_sdwa v147, v148 dst_sel:WORD_1 dst_unused:UNUSED_PRESERVE src0_sel:WORD_1
v_exp_f16_sdwa v144, v145 dst_sel:WORD_1 dst_unused:UNUSED_PRESERVE src0_sel:WORD_1
v_lshrrev_b32_e64 v139, 18, v139
v_fma_mix_f32 v159, v182, v182, v159 op_sel:[0,0,0] op_sel_hi:[1,1,0]
v_mfma_f32_32x32x16_bf16 v[120:135], v[84:87], v[228:231], v[120:135]
ds_read_b128 v[224:227], v248 offset:53248
ds_read_u16_d16 v138, v138
ds_read_u16_d16_hi v139, v139
v_pk_add_f16 v153, v153, 1.0 op_sel_hi:[1,0]
v_pk_add_f16 v150, v150, 1.0 op_sel_hi:[1,0]
v_pk_add_f16 v147, v147, 1.0 op_sel_hi:[1,0]
v_and_b32_e64 v141, s49, v141
v_pk_add_f16 v144, v144, 1.0 op_sel_hi:[1,0]
v_rcp_f16_e64 v154, v153
v_fma_mix_f32 v159, v183, v183, v159 op_sel:[1,1,0] op_sel_hi:[1,1,0]
v_rcp_f16_e64 v151, v150
v_mfma_f32_32x32x16_bf16 v[120:135], v[88:91], v[232:235], v[120:135]
ds_read_b128 v[228:231], v248 offset:56320
v_bfe_u32 v140, v141, 2, 14
v_rcp_f16_e64 v148, v147
v_fma_mix_f32 v159, v184, v184, v159 op_sel:[0,0,0] op_sel_hi:[1,1,0]
v_rcp_f16 v145, v144
v_lshrrev_b32 v141, 18, v141
v_rcp_f16_sdwa v154, v153 dst_sel:WORD_1 dst_unused:UNUSED_PRESERVE src0_sel:WORD_1
s_setprio 0
v_rcp_f16_sdwa v151, v150 dst_sel:WORD_1 dst_unused:UNUSED_PRESERVE src0_sel:WORD_1
s_waitcnt lgkmcnt(4)
v_mfma_f32_32x32x16_bf16 v[120:135], v[92:95], v[236:239], v[120:135]
ds_read_b128 v[232:235], v248 offset:54272
ds_read_u16_d16 v140, v140
ds_read_u16_d16_hi v141, v141
v_fma_mix_f32 v159, v185, v185, v159 op_sel:[1,1,0] op_sel_hi:[1,1,0]
v_and_b32_e64 v143, s49, v143
v_rcp_f16_sdwa v148, v147 dst_sel:WORD_1 dst_unused:UNUSED_PRESERVE src0_sel:WORD_1
v_rcp_f16_sdwa v145, v144 dst_sel:WORD_1 dst_unused:UNUSED_PRESERVE src0_sel:WORD_1
v_pk_mul_f16 v155, v155, v154
v_bfe_u32 v142, v143, 2, 14
v_fma_mix_f32 v159, v186, v186, v159 op_sel:[0,0,0] op_sel_hi:[1,1,0]
v_pk_mul_f16 v152, v152, v151
v_pk_mul_f16 v149, v149, v148
v_smfmac_f32_16x16x32_bf16 v[20:23], v[216:217], v[208:211], v246
ds_read_b128 v[236:239], v248 offset:57344
ds_read_u16_d16 v142, v142
v_pk_mul_f16 v146, v146, v145
v_fma_mix_f32 v160, v155, v155, v160 op_sel:[0,0,0] op_sel_hi:[1,1,0]
v_lshrrev_b32_e64 v143, 18, v143
v_fma_mix_f32 v160, v155, v155, v160 op_sel:[1,1,0] op_sel_hi:[1,1,0]
v_fma_mix_f32 v160, v152, v152, v160 op_sel:[0,0,0] op_sel_hi:[1,1,0]
v_smfmac_f32_16x16x32_bf16 v[36:39], v[218:219], v[212:215], v246
v_fma_mix_f32 v159, v187, v187, v159 op_sel:[1,1,0] op_sel_hi:[1,1,0]
v_fma_mix_f32 v160, v152, v152, v160 op_sel:[1,1,0] op_sel_hi:[1,1,0]
v_fma_mix_f32 v160, v149, v149, v160 op_sel:[0,0,0] op_sel_hi:[1,1,0]
v_fma_mix_f32 v160, v149, v149, v160 op_sel:[1,1,0] op_sel_hi:[1,1,0]
v_fma_mix_f32 v160, v146, v146, v160 op_sel:[0,0,0] op_sel_hi:[1,1,0]
v_fma_mix_f32 v160, v146, v146, v160 op_sel:[1,1,0] op_sel_hi:[1,1,0]
s_cmp_lg_u32 s40, 7
s_cbranch_scc1 Lnobias2
s_sub_u32 s43, s2, 96
s_cmp_lt_u32 s43, 96
s_cbranch_scc0 Lnobias2
s_waitcnt vmcnt(15)
v_lshlrev_b32 v102, 16, v102
v_lshlrev_b32 v103, 16, v103
v_lshlrev_b32 v104, 16, v104
v_lshlrev_b32 v105, 16, v105
v_lshlrev_b32 v106, 16, v106
v_lshlrev_b32 v107, 16, v107
v_lshlrev_b32 v108, 16, v108
v_lshlrev_b32 v109, 16, v109
v_lshlrev_b32 v110, 16, v110
v_lshlrev_b32 v111, 16, v111
v_lshlrev_b32 v112, 16, v112
v_lshlrev_b32 v113, 16, v113
v_mul_f32 v100, v102, v108
v_fmac_f32 v100, v103, v109
v_fmac_f32 v100, v104, v110
v_fmac_f32 v100, v105, v111
v_fmac_f32 v100, v106, v112
v_fmac_f32 v100, v107, v113
s_nop 1
v_add_f32_dpp v100, v100, v100 row_ror:8 row_mask:0xf bank_mask:0xf
s_nop 1
v_add_f32_dpp v100, v100, v100 row_ror:4 row_mask:0xf bank_mask:0xf
s_nop 1
v_add_f32_dpp v100, v100, v100 row_ror:2 row_mask:0xf bank_mask:0xf
s_nop 1
v_add_f32_dpp v100, v100, v100 row_ror:1 row_mask:0xf bank_mask:0xf
v_mov_b32 v101, v100
s_nop 1
v_permlane16_swap_b32 v100, v101
v_add_f32 v100, v100, v101
v_mov_b32_e64 v101, v100
s_nop 1
v_permlane32_swap_b32 v100, v101
v_add_f32 v100, v100, v101
s_lshl_b32 s44, s43, 2
s_add_u32 s44, s44, 394752
v_lshlrev_b32_e64 v115, 11, v251
s_mov_b64 exec, 0xff
buffer_store_dword v100, v115, s[32:35], s44 offen sc1
s_mov_b64 exec, -1
Lnobias2:
s_setprio 2
v_smfmac_f32_16x16x32_bf16 v[12:15], v[220:221], v[192:195], v246
s_add_u32 s46, s80, 8388608
buffer_store_dwordx4 v[64:67], v241, s[32:35], s46 offen sc1
ds_read_b128 v[216:219], v248 offset:55296
ds_read_u16_d16_hi v143, v143
v_cvt_pkrtz_f16_f32 v179, v120, v121
v_cvt_pkrtz_f16_f32 v181, v122, v123
v_cvt_pkrtz_f16_f32 v183, v124, v125
v_cvt_pkrtz_f16_f32 v185, v126, v127
v_smfmac_f32_16x16x32_bf16 v[28:31], v[222:223], v[196:199], v246
v_cvt_pkrtz_f16_f32 v187, v128, v129
v_cvt_pk_f16_f32 v155, v130, v131
v_cvt_pk_f16_f32 v152, v132, v133
v_cvt_pk_f16_f32 v149, v134, v135
s_waitcnt lgkmcnt(2)
v_mfma_f32_32x32x16_bf16 v[120:135], v[72:75], v[224:227], 0
ds_read_b128 v[220:223], v245 offset:3840
ds_read_b128 v[200:203], v242 offset:128
v_xor_b32 v243, 32, v243
ds_read_b128 v[204:207], v243
v_pk_fma_f16 v154, v155, v155, s48
v_and_b32_e64 v179, s49, v179
v_fma_mix_f32 v160, v136, v136, v160 op_sel:[0,0,0] op_sel_hi:[1,1,0]
v_pk_fma_f16 v151, v152, v152, s48
v_pk_fma_f16 v148, v149, v149, s48
v_bfe_u32 v178, v179, 2, 14
v_pk_mul_f16 v154, v155, v154
v_pk_mul_f16 v151, v152, v151
v_mfma_f32_32x32x16_bf16 v[120:135], v[76:79], v[228:231], v[120:135]
ds_read_b128 v[224:227], v248 offset:58368
ds_read_u16_d16 v178, v178
v_pk_mul_f16 v148, v149, v148
v_lshrrev_b32_e64 v179, 18, v179
v_fma_mix_f32 v160, v137, v137, v160 op_sel:[1,1,0] op_sel_hi:[1,1,0]
v_exp_f16 v153, v154
v_and_b32 v181, s49, v181
v_exp_f16_e64 v150, v151
v_mfma_f32_32x32x16_bf16 v[120:135], v[80:83], v[232:235], v[120:135]
ds_read_b128 v[228:231], v245 offset:4224
ds_read_b128 v[208:211], v243 offset:64
ds_read_b128 v[212:215], v243 offset:128
ds_read_u16_d16_hi v179, v179
v_exp_f16_e64 v147, v148
v_bfe_u32 v180, v181, 2, 14
v_fma_mix_f32 v160, v138, v138, v160 op_sel:[0,0,0] op_sel_hi:[1,1,0]
v_exp_f16_sdwa v153, v154 dst_sel:WORD_1 dst_unused:UNUSED_PRESERVE src0_sel:WORD_1
v_lshrrev_b32 v181, 18, v181
v_mfma_f32_32x32x16_bf16 v[120:135], v[84:87], v[236:239], v[120:135]
ds_read_b128 v[232:235], v245 offset:4608
v_xor_b32 v244, 32, v244
ds_read_b128 v[192:195], v244
ds_read_b128 v[196:199], v244 offset:64
ds_read_u16_d16 v180, v180
ds_read_u16_d16_hi v181, v181
v_exp_f16_sdwa v150, v151 dst_sel:WORD_1 dst_unused:UNUSED_PRESERVE src0_sel:WORD_1
v_fma_mix_f32 v160, v139, v139, v160 op_sel:[1,1,0] op_sel_hi:[1,1,0]
v_and_b32 v183, s49, v183
v_exp_f16_sdwa v147, v148 dst_sel:WORD_1 dst_unused:UNUSED_PRESERVE src0_sel:WORD_1
v_pk_add_f16 v153, v153, 1.0 op_sel_hi:[1,0]
v_bfe_u32 v182, v183, 2, 14
v_pk_add_f16 v150, v150, 1.0 op_sel_hi:[1,0]
s_waitcnt lgkmcnt(9)
v_mfma_f32_32x32x16_bf16 v[120:135], v[88:91], v[216:219], v[120:135]
ds_read_b128 v[236:239], v248 offset:59392
ds_read_u16_d16 v182, v182
v_pk_add_f16 v147, v147, 1.0 op_sel_hi:[1,0]
v_rcp_f16 v154, v153
v_lshrrev_b32 v183, 18, v183
v_fma_mix_f32 v160, v140, v140, v160 op_sel:[0,0,0] op_sel_hi:[1,1,0]
v_rcp_f16 v151, v150
v_and_b32 v185, s49, v185
v_smfmac_f32_16x16x32_bf16 v[44:47], v[220:221], v[200:203], v246
ds_read_b128 v[216:219], v248 offset:62464
ds_read_u16_d16_hi v183, v183
v_rcp_f16_e64 v148, v147
v_fma_mix_f32 v160, v141, v141, v160 op_sel:[1,1,0] op_sel_hi:[1,1,0]
v_bfe_u32 v184, v185, 2, 14
v_smfmac_f32_16x16x32_bf16 v[12:15], v[222:223], v[204:207], v246
v_rcp_f16_sdwa v154, v153 dst_sel:WORD_1 dst_unused:UNUSED_PRESERVE src0_sel:WORD_1
v_rcp_f16_sdwa v151, v150 dst_sel:WORD_1 dst_unused:UNUSED_PRESERVE src0_sel:WORD_1
v_mfma_f32_32x32x16_bf16 v[120:135], v[92:95], v[224:227], v[120:135]
ds_read_b128 v[220:223], v248 offset:60416
ds_read_u16_d16 v184, v184
v_lshrrev_b32_e64 v185, 18, v185
v_rcp_f16_sdwa v148, v147 dst_sel:WORD_1 dst_unused:UNUSED_PRESERVE src0_sel:WORD_1
v_and_b32 v187, s49, v187
v_fma_mix_f32 v160, v142, v142, v160 op_sel:[0,0,0] op_sel_hi:[1,1,0]
v_pk_mul_f16 v155, v155, v154
v_pk_mul_f16 v152, v152, v151
v_bfe_u32 v186, v187, 2, 14
s_waitcnt lgkmcnt(4)
v_smfmac_f32_16x16x32_bf16 v[28:31], v[228:229], v[208:211], v246
ds_read_b128 v[224:227], v248 offset:63488
ds_read_u16_d16_hi v185, v185
ds_read_u16_d16 v186, v186
v_pk_mul_f16 v149, v149, v148
v_fma_mix_f32 v161, v155, v155, v161 op_sel:[0,0,0] op_sel_hi:[1,1,0]
v_fma_mix_f32 v160, v143, v143, v160 op_sel:[1,1,0] op_sel_hi:[1,1,0]
v_lshrrev_b32_e64 v187, 18, v187
v_smfmac_f32_16x16x32_bf16 v[44:47], v[230:231], v[212:215], v246
v_fma_mix_f32 v161, v155, v155, v161 op_sel:[1,1,0] op_sel_hi:[1,1,0]
v_fma_mix_f32 v161, v152, v152, v161 op_sel:[0,0,0] op_sel_hi:[1,1,0]
v_fma_mix_f32 v161, v152, v152, v161 op_sel:[1,1,0] op_sel_hi:[1,1,0]
v_fma_mix_f32 v161, v149, v149, v161 op_sel:[0,0,0] op_sel_hi:[1,1,0]
v_fma_mix_f32 v161, v149, v149, v161 op_sel:[1,1,0] op_sel_hi:[1,1,0]
v_lshlrev_b32_e64 v252, 7, v251
s_add_u32 s46, s47, 2359296
s_mov_b32 exec_lo, 131071
s_mov_b32 exec_hi, 0
s_mov_b32 m0, 16288
s_nop 0
buffer_load_dword v252, s[4:7], s46 offen lds
s_mov_b64 exec, -1
s_setprio 1
v_smfmac_f32_16x16x32_bf16 v[12:15], v[232:233], v[192:195], v246
s_add_u32 s46, s80, 10485760
buffer_store_dwordx4 v[68:71], v241, s[32:35], s46 offen sc1
ds_read_b128 v[228:231], v248 offset:61440
ds_read_u16_d16_hi v187, v187
v_cvt_pkrtz_f16_f32 v137, v120, v121
v_cvt_pkrtz_f16_f32 v139, v122, v123
v_cvt_pkrtz_f16_f32 v141, v124, v125
v_cvt_pkrtz_f16_f32 v143, v126, v127
v_cvt_pk_f16_f32 v155, v128, v129
v_smfmac_f32_16x16x32_bf16 v[28:31], v[234:235], v[196:199], v246
v_cvt_pk_f16_f32 v152, v130, v131
v_cvt_pk_f16_f32 v149, v132, v133
v_cvt_pk_f16_f32 v146, v134, v135
v_pk_fma_f16 v154, v155, v155, s48
v_and_b32_e64 v137, s49, v137
v_mfma_f32_32x32x16_bf16 v[120:135], v[72:75], v[236:239], 0
ds_read_b128 v[232:235], v248 offset:64512
v_fma_mix_f32 v161, v178, v178, v161 op_sel:[0,0,0] op_sel_hi:[1,1,0]
v_pk_fma_f16 v151, v152, v152, s48
v_pk_fma_f16 v148, v149, v149, s48
v_pk_fma_f16 v145, v146, v146, s48
v_pk_mul_f16 v154, v155, v154
v_bfe_u32 v136, v137, 2, 14
v_pk_mul_f16 v151, v152, v151
v_fma_mix_f32 v161, v179, v179, v161 op_sel:[1,1,0] op_sel_hi:[1,1,0]
v_pk_mul_f16 v148, v149, v148
v_pk_mul_f16 v145, v146, v145
s_waitcnt lgkmcnt(2)
v_mfma_f32_32x32x16_bf16 v[120:135], v[76:79], v[216:219], v[120:135]
ds_read_b128 v[236:239], v245 offset:4992
ds_read_b128 v[200:203], v244 offset:128
v_xor_b32 v242, 16, v242
ds_read_b128 v[204:207], v242
ds_read_u16_d16 v136, v136
v_exp_f16 v153, v154
v_lshrrev_b32 v137, 18, v137
v_exp_f16_e64 v150, v151
v_fma_mix_f32 v161, v180, v180, v161 op_sel:[0,0,0] op_sel_hi:[1,1,0]
v_exp_f16 v147, v148
v_and_b32 v139, s49, v139
v_exp_f16_e64 v144, v145
v_mfma_f32_32x32x16_bf16 v[120:135], v[80:83], v[220:223], v[120:135]
ds_read_b128 v[216:219], v245 offset:5376
ds_read_b128 v[208:211], v242 offset:64
ds_read_b128 v[212:215], v242 offset:128
ds_read_u16_d16_hi v137, v137
v_exp_f16_sdwa v153, v154 dst_sel:WORD_1 dst_unused:UNUSED_PRESERVE src0_sel:WORD_1
v_fma_mix_f32 v161, v181, v181, v161 op_sel:[1,1,0] op_sel_hi:[1,1,0]
v_bfe_u32 v138, v139, 2, 14
v_exp_f16_sdwa v150, v151 dst_sel:WORD_1 dst_unused:UNUSED_PRESERVE src0_sel:WORD_1
v_exp_f16_sdwa v147, v148 dst_sel:WORD_1 dst_unused:UNUSED_PRESERVE src0_sel:WORD_1
v_exp_f16_sdwa v144, v145 dst_sel:WORD_1 dst_unused:UNUSED_PRESERVE src0_sel:WORD_1
v_lshrrev_b32_e64 v139, 18, v139
v_fma_mix_f32 v161, v182, v182, v161 op_sel:[0,0,0] op_sel_hi:[1,1,0]
v_mfma_f32_32x32x16_bf16 v[120:135], v[84:87], v[224:227], v[120:135]
ds_read_b128 v[220:223], v249
ds_read_u16_d16 v138, v138
ds_read_u16_d16_hi v139, v139
v_pk_add_f16 v153, v153, 1.0 op_sel_hi:[1,0]
v_pk_add_f16 v150, v150, 1.0 op_sel_hi:[1,0]
v_pk_add_f16 v147, v147, 1.0 op_sel_hi:[1,0]
v_and_b32_e64 v141, s49, v141
v_pk_add_f16 v144, v144, 1.0 op_sel_hi:[1,0]
v_rcp_f16_e64 v154, v153
v_fma_mix_f32 v161, v183, v183, v161 op_sel:[1,1,0] op_sel_hi:[1,1,0]
v_rcp_f16_e64 v151, v150
v_mfma_f32_32x32x16_bf16 v[120:135], v[88:91], v[228:231], v[120:135]
ds_read_b128 v[224:227], v249 offset:3072
v_bfe_u32 v140, v141, 2, 14
v_rcp_f16_e64 v148, v147
v_fma_mix_f32 v161, v184, v184, v161 op_sel:[0,0,0] op_sel_hi:[1,1,0]
v_rcp_f16 v145, v144
v_lshrrev_b32 v141, 18, v141
v_rcp_f16_sdwa v154, v153 dst_sel:WORD_1 dst_unused:UNUSED_PRESERVE src0_sel:WORD_1
s_setprio 0
v_rcp_f16_sdwa v151, v150 dst_sel:WORD_1 dst_unused:UNUSED_PRESERVE src0_sel:WORD_1
s_waitcnt lgkmcnt(4)
v_mfma_f32_32x32x16_bf16 v[120:135], v[92:95], v[232:235], v[120:135]
ds_read_b128 v[228:231], v249 offset:1024
ds_read_u16_d16 v140, v140
ds_read_u16_d16_hi v141, v141
v_fma_mix_f32 v161, v185, v185, v161 op_sel:[1,1,0] op_sel_hi:[1,1,0]
v_and_b32_e64 v143, s49, v143
v_rcp_f16_sdwa v148, v147 dst_sel:WORD_1 dst_unused:UNUSED_PRESERVE src0_sel:WORD_1
v_rcp_f16_sdwa v145, v144 dst_sel:WORD_1 dst_unused:UNUSED_PRESERVE src0_sel:WORD_1
v_pk_mul_f16 v155, v155, v154
v_bfe_u32 v142, v143, 2, 14
v_fma_mix_f32 v161, v186, v186, v161 op_sel:[0,0,0] op_sel_hi:[1,1,0]
v_pk_mul_f16 v152, v152, v151
v_pk_mul_f16 v149, v149, v148
v_smfmac_f32_16x16x32_bf16 v[44:47], v[236:237], v[200:203], v246
ds_read_b128 v[232:235], v249 offset:4096
ds_read_u16_d16 v142, v142
v_pk_mul_f16 v146, v146, v145
v_fma_mix_f32 v162, v155, v155, v162 op_sel:[0,0,0] op_sel_hi:[1,1,0]
v_lshrrev_b32_e64 v143, 18, v143
v_fma_mix_f32 v162, v155, v155, v162 op_sel:[1,1,0] op_sel_hi:[1,1,0]
v_fma_mix_f32 v162, v152, v152, v162 op_sel:[0,0,0] op_sel_hi:[1,1,0]
v_smfmac_f32_16x16x32_bf16 v[8:11], v[238:239], v[204:207], v246
v_fma_mix_f32 v161, v187, v187, v161 op_sel:[1,1,0] op_sel_hi:[1,1,0]
v_fma_mix_f32 v162, v152, v152, v162 op_sel:[1,1,0] op_sel_hi:[1,1,0]
v_fma_mix_f32 v162, v149, v149, v162 op_sel:[0,0,0] op_sel_hi:[1,1,0]
v_fma_mix_f32 v162, v149, v149, v162 op_sel:[1,1,0] op_sel_hi:[1,1,0]
v_fma_mix_f32 v162, v146, v146, v162 op_sel:[0,0,0] op_sel_hi:[1,1,0]
v_fma_mix_f32 v162, v146, v146, v162 op_sel:[1,1,0] op_sel_hi:[1,1,0]
v_lshlrev_b32_e64 v252, 7, v251
s_add_u32 s46, s47, 2359296
s_mov_b32 exec_lo, 4294836224
s_mov_b32 exec_hi, 3
s_mov_b32 m0, 16220
s_nop 0
buffer_load_dword v252, s[4:7], s46 offen lds
s_mov_b64 exec, -1
s_setprio 2
v_smfmac_f32_16x16x32_bf16 v[24:27], v[216:217], v[208:211], v246
ds_read_b128 v[236:239], v249 offset:2048
ds_read_u16_d16_hi v143, v143
v_cvt_pkrtz_f16_f32 v179, v120, v121
v_cvt_pkrtz_f16_f32 v181, v122, v123
v_cvt_pkrtz_f16_f32 v183, v124, v125
v_cvt_pkrtz_f16_f32 v185, v126, v127
v_smfmac_f32_16x16x32_bf16 v[40:43], v[218:219], v[212:215], v246
v_cvt_pkrtz_f16_f32 v187, v128, v129
v_cvt_pk_f16_f32 v155, v130, v131
v_cvt_pk_f16_f32 v152, v132, v133
v_cvt_pk_f16_f32 v149, v134, v135
v_pk_fma_f16 v154, v155, v155, s48
s_waitcnt lgkmcnt(2)
v_mfma_f32_32x32x16_bf16 v[120:135], v[72:75], v[220:223], 0
ds_read_b128 v[216:219], v249 offset:5120
v_and_b32 v179, s49, v179
v_fma_mix_f32 v162, v136, v136, v162 op_sel:[0,0,0] op_sel_hi:[1,1,0]
v_pk_fma_f16 v151, v152, v152, s48
v_pk_fma_f16 v148, v149, v149, s48
v_bfe_u32 v178, v179, 2, 14
v_pk_mul_f16 v154, v155, v154
v_pk_mul_f16 v151, v152, v151
v_pk_mul_f16 v148, v149, v148
v_lshrrev_b32 v179, 18, v179
v_mfma_f32_32x32x16_bf16 v[120:135], v[76:79], v[224:227], v[120:135]
ds_read_b128 v[220:223], v245 offset:5760
v_xor_b32 v243, 16, v243
ds_read_b128 v[192:195], v243
ds_read_b128 v[196:199], v243 offset:64
ds_read_u16_d16 v178, v178
ds_read_u16_d16_hi v179, v179
v_fma_mix_f32 v162, v137, v137, v162 op_sel:[1,1,0] op_sel_hi:[1,1,0]
v_exp_f16 v153, v154
v_and_b32 v181, s49, v181
v_exp_f16 v150, v151
v_exp_f16 v147, v148
v_bfe_u32 v180, v181, 2, 14
v_mfma_f32_32x32x16_bf16 v[120:135], v[80:83], v[228:231], v[120:135]
ds_read_b128 v[224:227], v245 offset:6144
ds_read_b128 v[200:203], v243 offset:128
v_xor_b32 v244, 16, v244
ds_read_b128 v[204:207], v244
ds_read_u16_d16 v180, v180
v_fma_mix_f32 v162, v138, v138, v162 op_sel:[0,0,0] op_sel_hi:[1,1,0]
v_exp_f16_sdwa v153, v154 dst_sel:WORD_1 dst_unused:UNUSED_PRESERVE src0_sel:WORD_1
v_lshrrev_b32 v181, 18, v181
v_exp_f16_sdwa v150, v151 dst_sel:WORD_1 dst_unused:UNUSED_PRESERVE src0_sel:WORD_1
v_fma_mix_f32 v162, v139, v139, v162 op_sel:[1,1,0] op_sel_hi:[1,1,0]
v_and_b32_e64 v183, s49, v183
v_mfma_f32_32x32x16_bf16 v[120:135], v[84:87], v[232:235], v[120:135]
ds_read_b128 v[228:231], v249 offset:6144
ds_read_u16_d16_hi v181, v181
v_exp_f16_sdwa v147, v148 dst_sel:WORD_1 dst_unused:UNUSED_PRESERVE src0_sel:WORD_1
v_pk_add_f16 v153, v153, 1.0 op_sel_hi:[1,0]
v_bfe_u32 v182, v183, 2, 14
v_pk_add_f16 v150, v150, 1.0 op_sel_hi:[1,0]
v_pk_add_f16 v147, v147, 1.0 op_sel_hi:[1,0]
v_rcp_f16_e64 v154, v153
v_lshrrev_b32 v183, 18, v183
v_fma_mix_f32 v162, v140, v140, v162 op_sel:[0,0,0] op_sel_hi:[1,1,0]
s_waitcnt lgkmcnt(6)
v_mfma_f32_32x32x16_bf16 v[120:135], v[88:91], v[236:239], v[120:135]
ds_read_b128 v[232:235], v249 offset:9216
ds_read_u16_d16 v182, v182
ds_read_u16_d16_hi v183, v183
v_rcp_f16 v151, v150
v_and_b32 v185, s49, v185
v_rcp_f16_e64 v148, v147
v_fma_mix_f32 v162, v141, v141, v162 op_sel:[1,1,0] op_sel_hi:[1,1,0]
v_bfe_u32 v184, v185, 2, 14
v_rcp_f16_sdwa v154, v153 dst_sel:WORD_1 dst_unused:UNUSED_PRESERVE src0_sel:WORD_1
v_mfma_f32_32x32x16_bf16 v[120:135], v[92:95], v[216:219], v[120:135]
ds_read_b128 v[236:239], v249 offset:7168
ds_read_u16_d16 v184, v184
v_rcp_f16_sdwa v151, v150 dst_sel:WORD_1 dst_unused:UNUSED_PRESERVE src0_sel:WORD_1
v_lshrrev_b32_e64 v185, 18, v185
v_rcp_f16_sdwa v148, v147 dst_sel:WORD_1 dst_unused:UNUSED_PRESERVE src0_sel:WORD_1
v_and_b32_e64 v187, s49, v187
v_fma_mix_f32 v162, v142, v142, v162 op_sel:[0,0,0] op_sel_hi:[1,1,0]
v_pk_mul_f16 v155, v155, v154
v_pk_mul_f16 v152, v152, v151
v_smfmac_f32_16x16x32_bf16 v[8:11], v[220:221], v[192:195], v246
ds_read_b128 v[216:219], v249 offset:10240
ds_read_u16_d16_hi v185, v185
v_bfe_u32 v186, v187, 2, 14
v_pk_mul_f16 v149, v149, v148
v_fma_mix_f32 v163, v155, v155, v163 op_sel:[0,0,0] op_sel_hi:[1,1,0]
v_fma_mix_f32 v162, v143, v143, v162 op_sel:[1,1,0] op_sel_hi:[1,1,0]
v_lshrrev_b32_e64 v187, 18, v187
v_smfmac_f32_16x16x32_bf16 v[24:27], v[222:223], v[196:199], v246
v_fma_mix_f32 v163, v155, v155, v163 op_sel:[1,1,0] op_sel_hi:[1,1,0]
v_fma_mix_f32 v163, v152, v152, v163 op_sel:[0,0,0] op_sel_hi:[1,1,0]
v_fma_mix_f32 v163, v152, v152, v163 op_sel:[1,1,0] op_sel_hi:[1,1,0]
v_fma_mix_f32 v163, v149, v149, v163 op_sel:[0,0,0] op_sel_hi:[1,1,0]
v_fma_mix_f32 v163, v149, v149, v163 op_sel:[1,1,0] op_sel_hi:[1,1,0]
v_lshlrev_b32 v252, 7, v251
s_add_u32 s46, s47, 2359296
s_mov_b32 exec_lo, 0
s_mov_b32 exec_hi, 1048572
s_mov_b32 m0, 16152
s_nop 0
buffer_load_dword v252, s[4:7], s46 offen lds
s_mov_b64 exec, -1
s_setprio 1
s_waitcnt lgkmcnt(2)
v_smfmac_f32_16x16x32_bf16 v[40:43], v[224:225], v[200:203], v246
ds_read_b128 v[220:223], v249 offset:8192
ds_read_u16_d16 v186, v186
ds_read_u16_d16_hi v187, v187
v_cvt_pkrtz_f16_f32 v137, v120, v121
v_cvt_pkrtz_f16_f32 v139, v122, v123
v_cvt_pkrtz_f16_f32 v141, v124, v125
v_cvt_pkrtz_f16_f32 v143, v126, v127
v_smfmac_f32_16x16x32_bf16 v[8:11], v[226:227], v[204:207], v246
v_cvt_pk_f16_f32 v155, v128, v129
v_cvt_pk_f16_f32 v152, v130, v131
v_cvt_pk_f16_f32 v149, v132, v133
v_cvt_pk_f16_f32 v146, v134, v135
v_pk_fma_f16 v154, v155, v155, s48
v_mfma_f32_32x32x16_bf16 v[120:135], v[72:75], v[228:231], 0
ds_read_b128 v[224:227], v249 offset:11264
v_and_b32_e64 v137, s49, v137
v_fma_mix_f32 v163, v178, v178, v163 op_sel:[0,0,0] op_sel_hi:[1,1,0]
v_pk_fma_f16 v151, v152, v152, s48
v_pk_fma_f16 v148, v149, v149, s48
v_pk_fma_f16 v145, v146, v146, s48
v_pk_mul_f16 v154, v155, v154
v_bfe_u32 v136, v137, 2, 14
v_pk_mul_f16 v151, v152, v151
v_fma_mix_f32 v163, v179, v179, v163 op_sel:[1,1,0] op_sel_hi:[1,1,0]
v_pk_mul_f16 v148, v149, v148
v_mfma_f32_32x32x16_bf16 v[120:135], v[76:79], v[232:235], v[120:135]
ds_read_b128 v[228:231], v245 offset:6528
ds_read_b128 v[208:211], v244 offset:64
ds_read_b128 v[212:215], v244 offset:128
ds_read_u16_d16 v136, v136
v_pk_mul_f16 v145, v146, v145
v_exp_f16 v153, v154
v_lshrrev_b32 v137, 18, v137
v_exp_f16_e64 v150, v151
v_fma_mix_f32 v163, v180, v180, v163 op_sel:[0,0,0] op_sel_hi:[1,1,0]
v_exp_f16 v147, v148
v_and_b32 v139, s49, v139
v_mfma_f32_32x32x16_bf16 v[120:135], v[80:83], v[236:239], v[120:135]
ds_read_b128 v[232:235], v249 offset:12288
ds_read_u16_d16_hi v137, v137
v_exp_f16_e64 v144, v145
v_exp_f16_sdwa v153, v154 dst_sel:WORD_1 dst_unused:UNUSED_PRESERVE src0_sel:WORD_1
v_fma_mix_f32 v163, v181, v181, v163 op_sel:[1,1,0] op_sel_hi:[1,1,0]
v_bfe_u32 v138, v139, 2, 14
v_exp_f16_sdwa v150, v151 dst_sel:WORD_1 dst_unused:UNUSED_PRESERVE src0_sel:WORD_1
v_exp_f16_sdwa v147, v148 dst_sel:WORD_1 dst_unused:UNUSED_PRESERVE src0_sel:WORD_1
s_waitcnt lgkmcnt(6)
v_mfma_f32_32x32x16_bf16 v[120:135], v[84:87], v[216:219], v[120:135]
ds_read_b128 v[236:239], v249 offset:15360
ds_read_u16_d16 v138, v138
v_exp_f16_sdwa v144, v145 dst_sel:WORD_1 dst_unused:UNUSED_PRESERVE src0_sel:WORD_1
v_lshrrev_b32 v139, 18, v139
v_fma_mix_f32 v163, v182, v182, v163 op_sel:[0,0,0] op_sel_hi:[1,1,0]
v_pk_add_f16 v153, v153, 1.0 op_sel_hi:[1,0]
v_pk_add_f16 v150, v150, 1.0 op_sel_hi:[1,0]
v_pk_add_f16 v147, v147, 1.0 op_sel_hi:[1,0]
v_and_b32_e64 v141, s49, v141
v_pk_add_f16 v144, v144, 1.0 op_sel_hi:[1,0]
v_mfma_f32_32x32x16_bf16 v[120:135], v[88:91], v[220:223], v[120:135]
ds_read_b128 v[216:219], v249 offset:13312
ds_read_u16_d16_hi v139, v139
v_rcp_f16_e64 v154, v153
v_fma_mix_f32 v163, v183, v183, v163 op_sel:[1,1,0] op_sel_hi:[1,1,0]
v_rcp_f16_e64 v151, v150
v_bfe_u32 v140, v141, 2, 14
v_rcp_f16_e64 v148, v147
v_fma_mix_f32 v163, v184, v184, v163 op_sel:[0,0,0] op_sel_hi:[1,1,0]
v_mfma_f32_32x32x16_bf16 v[120:135], v[92:95], v[224:227], v[120:135]
ds_read_b128 v[220:223], v249 offset:16384
ds_read_u16_d16 v140, v140
v_rcp_f16_e64 v145, v144
v_lshrrev_b32 v141, 18, v141
v_rcp_f16_sdwa v154, v153 dst_sel:WORD_1 dst_unused:UNUSED_PRESERVE src0_sel:WORD_1
s_setprio 0
v_rcp_f16_sdwa v151, v150 dst_sel:WORD_1 dst_unused:UNUSED_PRESERVE src0_sel:WORD_1
v_fma_mix_f32 v163, v185, v185, v163 op_sel:[1,1,0] op_sel_hi:[1,1,0]
v_and_b32 v143, s49, v143
v_rcp_f16_sdwa v148, v147 dst_sel:WORD_1 dst_unused:UNUSED_PRESERVE src0_sel:WORD_1
s_waitcnt lgkmcnt(4)
v_smfmac_f32_16x16x32_bf16 v[24:27], v[228:229], v[208:211], v246
ds_read_b128 v[224:227], v249 offset:14336
ds_read_u16_d16_hi v141, v141
v_rcp_f16_sdwa v145, v144 dst_sel:WORD_1 dst_unused:UNUSED_PRESERVE src0_sel:WORD_1
v_pk_mul_f16 v155, v155, v154
v_bfe_u32 v142, v143, 2, 14
v_fma_mix_f32 v163, v186, v186, v163 op_sel:[0,0,0] op_sel_hi:[1,1,0]
v_smfmac_f32_16x16x32_bf16 v[40:43], v[230:231], v[212:215], v246
s_mov_b64 exec, 1
ds_add_u32 v253, v254 offset:16
s_mov_b64 exec, -1
v_pk_mul_f16 v152, v152, v151
v_pk_mul_f16 v149, v149, v148
v_pk_mul_f16 v146, v146, v145
v_fma_mix_f32 v164, v155, v155, v164 op_sel:[0,0,0] op_sel_hi:[1,1,0]
v_lshrrev_b32 v143, 18, v143
v_fma_mix_f32 v164, v155, v155, v164 op_sel:[1,1,0] op_sel_hi:[1,1,0]
v_fma_mix_f32 v164, v152, v152, v164 op_sel:[0,0,0] op_sel_hi:[1,1,0]
v_fma_mix_f32 v163, v187, v187, v163 op_sel:[1,1,0] op_sel_hi:[1,1,0]
v_fma_mix_f32 v164, v152, v152, v164 op_sel:[1,1,0] op_sel_hi:[1,1,0]
v_fma_mix_f32 v164, v149, v149, v164 op_sel:[0,0,0] op_sel_hi:[1,1,0]
v_fma_mix_f32 v164, v149, v149, v164 op_sel:[1,1,0] op_sel_hi:[1,1,0]
v_fma_mix_f32 v164, v146, v146, v164 op_sel:[0,0,0] op_sel_hi:[1,1,0]
v_fma_mix_f32 v164, v146, v146, v164 op_sel:[1,1,0] op_sel_hi:[1,1,0]
s_setprio 3
v_pk_add_f32 v[168:169], v[0:1], v[2:3]
v_pk_mul_f32 v[170:171], v[0:1], v[0:1]
v_pk_fma_f32 v[170:171], v[2:3], v[2:3], v[170:171]
v_pk_add_f32 v[168:169], v[168:169], v[4:5]
v_pk_fma_f32 v[170:171], v[4:5], v[4:5], v[170:171]
v_pk_add_f32 v[168:169], v[168:169], v[6:7]
v_pk_fma_f32 v[170:171], v[6:7], v[6:7], v[170:171]
v_pk_add_f32 v[168:169], v[168:169], v[8:9]
v_pk_fma_f32 v[170:171], v[8:9], v[8:9], v[170:171]
v_pk_add_f32 v[168:169], v[168:169], v[10:11]
v_pk_fma_f32 v[170:171], v[10:11], v[10:11], v[170:171]
v_pk_add_f32 v[168:169], v[168:169], v[12:13]
v_pk_fma_f32 v[170:171], v[12:13], v[12:13], v[170:171]
v_pk_add_f32 v[168:169], v[168:169], v[14:15]
v_pk_fma_f32 v[170:171], v[14:15], v[14:15], v[170:171]
v_pk_add_f32 v[168:169], v[168:169], v[16:17]
v_pk_fma_f32 v[170:171], v[16:17], v[16:17], v[170:171]
v_pk_add_f32 v[168:169], v[168:169], v[18:19]
v_pk_fma_f32 v[170:171], v[18:19], v[18:19], v[170:171]
v_pk_add_f32 v[168:169], v[168:169], v[20:21]
v_pk_fma_f32 v[170:171], v[20:21], v[20:21], v[170:171]
v_pk_add_f32 v[168:169], v[168:169], v[22:23]
v_pk_fma_f32 v[170:171], v[22:23], v[22:23], v[170:171]
v_pk_add_f32 v[168:169], v[168:169], v[24:25]
v_pk_fma_f32 v[170:171], v[24:25], v[24:25], v[170:171]
v_pk_add_f32 v[168:169], v[168:169], v[26:27]
v_pk_fma_f32 v[170:171], v[26:27], v[26:27], v[170:171]
v_pk_add_f32 v[168:169], v[168:169], v[28:29]
v_pk_fma_f32 v[170:171], v[28:29], v[28:29], v[170:171]
v_pk_add_f32 v[168:169], v[168:169], v[30:31]
v_pk_fma_f32 v[170:171], v[30:31], v[30:31], v[170:171]
v_pk_add_f32 v[168:169], v[168:169], v[32:33]
v_pk_fma_f32 v[170:171], v[32:33], v[32:33], v[170:171]
v_pk_add_f32 v[168:169], v[168:169], v[34:35]
v_pk_fma_f32 v[170:171], v[34:35], v[34:35], v[170:171]
v_pk_add_f32 v[168:169], v[168:169], v[36:37]
v_pk_fma_f32 v[170:171], v[36:37], v[36:37], v[170:171]
v_pk_add_f32 v[168:169], v[168:169], v[38:39]
v_pk_fma_f32 v[170:171], v[38:39], v[38:39], v[170:171]
v_pk_add_f32 v[168:169], v[168:169], v[40:41]
v_pk_fma_f32 v[170:171], v[40:41], v[40:41], v[170:171]
v_pk_add_f32 v[168:169], v[168:169], v[42:43]
v_pk_fma_f32 v[170:171], v[42:43], v[42:43], v[170:171]
v_pk_add_f32 v[168:169], v[168:169], v[44:45]
v_pk_fma_f32 v[170:171], v[44:45], v[44:45], v[170:171]
v_pk_add_f32 v[168:169], v[168:169], v[46:47]
v_pk_fma_f32 v[170:171], v[46:47], v[46:47], v[170:171]
s_setprio 0
v_add_u32 v174, -36864, v242
v_subrev_u32 v175, 66560, v174
v_min_u32 v174, v174, v175
v_add_u32 v174, 90112, v174
v_sub_u32 v175, v174, v242
v_add_u32 v242, v175, v242
v_add_u32_e64 v243, v175, v243
v_add_u32 v244, v175, v244
s_setprio 2
v_cvt_pkrtz_f16_f32 v179, v120, v121
v_cvt_pkrtz_f16_f32 v181, v122, v123
v_cvt_pkrtz_f16_f32 v183, v124, v125
v_cvt_pkrtz_f16_f32 v185, v126, v127
v_cvt_pkrtz_f16_f32 v187, v128, v129
v_cvt_pk_f16_f32 v155, v130, v131
v_cvt_pk_f16_f32 v152, v132, v133
v_cvt_pk_f16_f32 v149, v134, v135
ds_read_b128 v[228:231], v249 offset:17408
ds_read_u16_d16 v142, v142
ds_read_u16_d16_hi v143, v143
v_mfma_f32_32x32x16_bf16 v[120:135], v[72:75], v[232:235], 0
v_pk_fma_f16 v154, v155, v155, s48
v_add_f32 v168, v168, v169
v_and_b32 v179, s49, v179
v_fma_mix_f32 v164, v136, v136, v164 op_sel:[0,0,0] op_sel_hi:[1,1,0]
v_pk_fma_f16 v151, v152, v152, s48
v_pk_fma_f16 v148, v149, v149, s48
v_add_f32_e64 v170, v170, v171
v_bfe_u32 v178, v179, 2, 14
v_pk_mul_f16 v154, v155, v154
v_pk_mul_f16 v151, v152, v151
v_pk_mul_f16 v148, v149, v148
v_lshrrev_b32_e64 v179, 18, v179
ds_read_b128 v[232:235], v249 offset:18432
ds_read_u16_d16 v178, v178
ds_read_u16_d16_hi v179, v179
v_mfma_f32_32x32x16_bf16 v[120:135], v[76:79], v[236:239], v[120:135]
v_permlane32_swap_b32 v168, v170
v_fma_mix_f32 v164, v137, v137, v164 op_sel:[1,1,0] op_sel_hi:[1,1,0]
v_exp_f16 v153, v154
v_and_b32 v181, s49, v181
v_add_f32 v168, v168, v170
v_exp_f16_e64 v150, v151
v_exp_f16 v147, v148
v_bfe_u32 v180, v181, 2, 14
v_mul_f32 v168, 1009429163, v168
s_waitcnt lgkmcnt(7)
ds_read_b128 v[236:239], v249 offset:21504
ds_read_u16_d16 v180, v180
v_mfma_f32_32x32x16_bf16 v[120:135], v[80:83], v[216:219], v[120:135]
v_fma_mix_f32 v164, v138, v138, v164 op_sel:[0,0,0] op_sel_hi:[1,1,0]
v_exp_f16_sdwa v153, v154 dst_sel:WORD_1 dst_unused:UNUSED_PRESERVE src0_sel:WORD_1
v_lshrrev_b32_e64 v181, 18, v181
v_exp_f16_sdwa v150, v151 dst_sel:WORD_1 dst_unused:UNUSED_PRESERVE src0_sel:WORD_1
v_mov_b32_e64 v170, v168
v_fma_mix_f32 v164, v139, v139, v164 op_sel:[1,1,0] op_sel_hi:[1,1,0]
v_and_b32 v183, s49, v183
v_exp_f16_sdwa v147, v148 dst_sel:WORD_1 dst_unused:UNUSED_PRESERVE src0_sel:WORD_1
v_permlane32_swap_b32 v168, v170
ds_read_b128 v[216:219], v249 offset:19456
ds_read_u16_d16_hi v181, v181
v_mfma_f32_32x32x16_bf16 v[120:135], v[84:87], v[220:223], v[120:135]
v_pk_add_f16 v153, v153, 1.0 op_sel_hi:[1,0]
v_bfe_u32 v182, v183, 2, 14
v_pk_add_f16 v150, v150, 1.0 op_sel_hi:[1,0]
v_pk_add_f16 v147, v147, 1.0 op_sel_hi:[1,0]
v_fma_f32 v170, -v168, v168, v170
v_rcp_f16 v154, v153
v_lshrrev_b32 v183, 18, v183
v_fma_mix_f32 v164, v140, v140, v164 op_sel:[0,0,0] op_sel_hi:[1,1,0]
v_rcp_f16 v151, v150
v_max_f32 v170, 0, v170
ds_read_b128 v[220:223], v249 offset:22528
ds_read_u16_d16 v182, v182
ds_read_u16_d16_hi v183, v183
v_mfma_f32_32x32x16_bf16 v[120:135], v[88:91], v[224:227], v[120:135]
v_and_b32 v185, s49, v185
v_rcp_f16 v148, v147
v_add_f32 v170, 925353388, v170
v_fma_mix_f32 v164, v141, v141, v164 op_sel:[1,1,0] op_sel_hi:[1,1,0]
v_bfe_u32 v184, v185, 2, 14
v_rcp_f16_sdwa v154, v153 dst_sel:WORD_1 dst_unused:UNUSED_PRESERVE src0_sel:WORD_1
v_rcp_f16_sdwa v151, v150 dst_sel:WORD_1 dst_unused:UNUSED_PRESERVE src0_sel:WORD_1
v_rsq_f32 v170, v170
s_waitcnt lgkmcnt(4)
ds_read_b128 v[224:227], v249 offset:20480
ds_read_b32 v247, v253 offset:16
ds_read_u16_d16 v184, v184
v_mfma_f32_32x32x16_bf16 v[120:135], v[92:95], v[228:231], v[120:135]
v_lshrrev_b32_e64 v185, 18, v185
v_rcp_f16_sdwa v148, v147 dst_sel:WORD_1 dst_unused:UNUSED_PRESERVE src0_sel:WORD_1
v_and_b32_e64 v187, s49, v187
v_fma_mix_f32 v164, v142, v142, v164 op_sel:[0,0,0] op_sel_hi:[1,1,0]
v_pk_mul_f16 v155, v155, v154
v_pk_mul_f16 v152, v152, v151
v_bfe_u32 v186, v187, 2, 14
v_mul_f32 v172, 3203391086, v170
v_pk_mul_f16 v149, v149, v148
v_fma_mix_f32 v165, v155, v155, v165 op_sel:[0,0,0] op_sel_hi:[1,1,0]
v_fma_mix_f32 v164, v143, v143, v164 op_sel:[1,1,0] op_sel_hi:[1,1,0]
v_lshrrev_b32_e64 v187, 18, v187
v_fma_mix_f32 v165, v155, v155, v165 op_sel:[1,1,0] op_sel_hi:[1,1,0]
v_mul_f32 v173, v168, v172
v_fma_mix_f32 v165, v152, v152, v165 op_sel:[0,0,0] op_sel_hi:[1,1,0]
v_fma_mix_f32 v165, v152, v152, v165 op_sel:[1,1,0] op_sel_hi:[1,1,0]
v_fma_mix_f32 v165, v149, v149, v165 op_sel:[0,0,0] op_sel_hi:[1,1,0]
v_fma_mix_f32 v165, v149, v149, v165 op_sel:[1,1,0] op_sel_hi:[1,1,0]
s_setprio 3
v_pk_fma_f32 v[0:1], v[0:1], v[172:173], v[172:173] op_sel:[0,0,1] op_sel_hi:[1,0,1] neg_lo:[0,0,1] neg_hi:[0,0,1]
v_pk_fma_f32 v[2:3], v[2:3], v[172:173], v[172:173] op_sel:[0,0,1] op_sel_hi:[1,0,1] neg_lo:[0,0,1] neg_hi:[0,0,1]
v_pk_fma_f32 v[4:5], v[4:5], v[172:173], v[172:173] op_sel:[0,0,1] op_sel_hi:[1,0,1] neg_lo:[0,0,1] neg_hi:[0,0,1]
v_pk_fma_f32 v[6:7], v[6:7], v[172:173], v[172:173] op_sel:[0,0,1] op_sel_hi:[1,0,1] neg_lo:[0,0,1] neg_hi:[0,0,1]
v_pk_fma_f32 v[8:9], v[8:9], v[172:173], v[172:173] op_sel:[0,0,1] op_sel_hi:[1,0,1] neg_lo:[0,0,1] neg_hi:[0,0,1]
v_pk_fma_f32 v[10:11], v[10:11], v[172:173], v[172:173] op_sel:[0,0,1] op_sel_hi:[1,0,1] neg_lo:[0,0,1] neg_hi:[0,0,1]
v_pk_fma_f32 v[12:13], v[12:13], v[172:173], v[172:173] op_sel:[0,0,1] op_sel_hi:[1,0,1] neg_lo:[0,0,1] neg_hi:[0,0,1]
v_pk_fma_f32 v[14:15], v[14:15], v[172:173], v[172:173] op_sel:[0,0,1] op_sel_hi:[1,0,1] neg_lo:[0,0,1] neg_hi:[0,0,1]
v_pk_fma_f32 v[16:17], v[16:17], v[172:173], v[172:173] op_sel:[0,0,1] op_sel_hi:[1,0,1] neg_lo:[0,0,1] neg_hi:[0,0,1]
v_pk_fma_f32 v[18:19], v[18:19], v[172:173], v[172:173] op_sel:[0,0,1] op_sel_hi:[1,0,1] neg_lo:[0,0,1] neg_hi:[0,0,1]
v_pk_fma_f32 v[20:21], v[20:21], v[172:173], v[172:173] op_sel:[0,0,1] op_sel_hi:[1,0,1] neg_lo:[0,0,1] neg_hi:[0,0,1]
v_pk_fma_f32 v[22:23], v[22:23], v[172:173], v[172:173] op_sel:[0,0,1] op_sel_hi:[1,0,1] neg_lo:[0,0,1] neg_hi:[0,0,1]
v_pk_fma_f32 v[24:25], v[24:25], v[172:173], v[172:173] op_sel:[0,0,1] op_sel_hi:[1,0,1] neg_lo:[0,0,1] neg_hi:[0,0,1]
v_pk_fma_f32 v[26:27], v[26:27], v[172:173], v[172:173] op_sel:[0,0,1] op_sel_hi:[1,0,1] neg_lo:[0,0,1] neg_hi:[0,0,1]
v_pk_fma_f32 v[28:29], v[28:29], v[172:173], v[172:173] op_sel:[0,0,1] op_sel_hi:[1,0,1] neg_lo:[0,0,1] neg_hi:[0,0,1]
v_pk_fma_f32 v[30:31], v[30:31], v[172:173], v[172:173] op_sel:[0,0,1] op_sel_hi:[1,0,1] neg_lo:[0,0,1] neg_hi:[0,0,1]
v_pk_fma_f32 v[32:33], v[32:33], v[172:173], v[172:173] op_sel:[0,0,1] op_sel_hi:[1,0,1] neg_lo:[0,0,1] neg_hi:[0,0,1]
v_pk_fma_f32 v[34:35], v[34:35], v[172:173], v[172:173] op_sel:[0,0,1] op_sel_hi:[1,0,1] neg_lo:[0,0,1] neg_hi:[0,0,1]
v_pk_fma_f32 v[36:37], v[36:37], v[172:173], v[172:173] op_sel:[0,0,1] op_sel_hi:[1,0,1] neg_lo:[0,0,1] neg_hi:[0,0,1]
v_pk_fma_f32 v[38:39], v[38:39], v[172:173], v[172:173] op_sel:[0,0,1] op_sel_hi:[1,0,1] neg_lo:[0,0,1] neg_hi:[0,0,1]
v_pk_fma_f32 v[40:41], v[40:41], v[172:173], v[172:173] op_sel:[0,0,1] op_sel_hi:[1,0,1] neg_lo:[0,0,1] neg_hi:[0,0,1]
v_pk_fma_f32 v[42:43], v[42:43], v[172:173], v[172:173] op_sel:[0,0,1] op_sel_hi:[1,0,1] neg_lo:[0,0,1] neg_hi:[0,0,1]
v_pk_fma_f32 v[44:45], v[44:45], v[172:173], v[172:173] op_sel:[0,0,1] op_sel_hi:[1,0,1] neg_lo:[0,0,1] neg_hi:[0,0,1]
v_pk_fma_f32 v[46:47], v[46:47], v[172:173], v[172:173] op_sel:[0,0,1] op_sel_hi:[1,0,1] neg_lo:[0,0,1] neg_hi:[0,0,1]
s_setprio 2
ds_read_u16_d16_hi v185, v185
ds_read_u16_d16 v186, v186
ds_read_u16_d16_hi v187, v187
s_waitcnt lgkmcnt(3)
v_readfirstlane_b32 s43, v247
s_nop 1
s_cmp_ge_u32 s43, 24
s_cbranch_scc1 Lev7
Lev7w:
s_sleep 1
ds_read_b32 v247, v253 offset:16
s_waitcnt lgkmcnt(0)
v_readfirstlane_b32 s43, v247
s_cmp_eq_u32 s76, 0
s_cbranch_scc1 Lev7
s_sub_u32 s76, s76, 1
s_cmp_lt_u32 s43, 24
s_cbranch_scc1 Lev7w
Lev7:
s_setprio 1
v_cvt_pkrtz_f16_f32 v137, v120, v121
v_cvt_pkrtz_f16_f32 v139, v122, v123
v_cvt_pkrtz_f16_f32 v141, v124, v125
v_cvt_pkrtz_f16_f32 v143, v126, v127
v_cvt_pkrtz_f16_f32 v177, v128, v129
v_cvt_pk_f16_f32 v155, v130, v131
v_cvt_pk_f16_f32 v152, v132, v133
v_cvt_pk_f16_f32 v149, v134, v135
s_add_u32 m0, s67, 39936
s_add_u32 s66, s66, 98304
buffer_load_dwordx4 v240, s[4:7], s66 offen lds
ds_read_b128 v[228:231], v249 offset:23552
v_mfma_f32_32x32x16_bf16 v[120:135], v[72:75], v[232:235], 0
v_pk_fma_f16 v154, v155, v155, s48
v_cvt_pk_bf16_f32 v96, v0, v1
v_and_b32 v137, s49, v137
v_fma_mix_f32 v165, v178, v178, v165 op_sel:[0,0,0] op_sel_hi:[1,1,0]
v_cvt_pk_bf16_f32 v97, v2, v3
v_pk_fma_f16 v151, v152, v152, s48
v_pk_fma_f16 v148, v149, v149, s48
v_bfe_u32 v136, v137, 2, 14
v_cvt_pk_bf16_f32 v98, v4, v5
v_pk_mul_f16 v154, v155, v154
v_pk_mul_f16 v151, v152, v151
v_fma_mix_f32 v165, v179, v179, v165 op_sel:[1,1,0] op_sel_hi:[1,1,0]
v_cvt_pk_bf16_f32 v99, v6, v7
v_lshrrev_b32_e64 v137, 18, v137
s_add_u32 m0, s67, 46592
s_add_u32 s66, s66, 98304
buffer_load_dwordx4 v240, s[4:7], s66 offen lds
ds_read_b128 v[232:235], v248 offset:16384
ds_read_u16_d16 v136, v136
ds_read_u16_d16_hi v137, v137
v_mfma_f32_32x32x16_bf16 v[120:135], v[76:79], v[236:239], v[120:135]
v_pk_mul_f16 v148, v149, v148
v_exp_f16_e64 v153, v154
v_cvt_pk_bf16_f32 v100, v8, v9
v_exp_f16_e64 v150, v151
v_cvt_pk_bf16_f32 v101, v10, v11
v_and_b32_e64 v139, s49, v139
v_fma_mix_f32 v165, v180, v180, v165 op_sel:[0,0,0] op_sel_hi:[1,1,0]
v_cvt_pk_bf16_f32 v102, v12, v13
v_exp_f16_e64 v147, v148
v_bfe_u32 v138, v139, 2, 14
v_cvt_pk_bf16_f32 v103, v14, v15
s_add_u32 m0, s67, 53248
s_add_u32 s66, s66, 98304
buffer_load_dwordx4 v240, s[4:7], s66 offen lds
ds_read_b128 v[236:239], v248 offset:19456
ds_read_u16_d16 v138, v138
v_mfma_f32_32x32x16_bf16 v[120:135], v[80:83], v[216:219], v[120:135]
v_exp_f16_sdwa v153, v154 dst_sel:WORD_1 dst_unused:UNUSED_PRESERVE src0_sel:WORD_1
v_lshrrev_b32_e64 v139, 18, v139
v_cvt_pk_bf16_f32 v104, v16, v17
v_fma_mix_f32 v165, v181, v181, v165 op_sel:[1,1,0] op_sel_hi:[1,1,0]
v_exp_f16_sdwa v150, v151 dst_sel:WORD_1 dst_unused:UNUSED_PRESERVE src0_sel:WORD_1
v_cvt_pk_bf16_f32 v105, v18, v19
v_exp_f16_sdwa v147, v148 dst_sel:WORD_1 dst_unused:UNUSED_PRESERVE src0_sel:WORD_1
v_cvt_pk_bf16_f32 v106, v20, v21
v_and_b32 v141, s49, v141
v_fma_mix_f32 v165, v182, v182, v165 op_sel:[0,0,0] op_sel_hi:[1,1,0]
v_pk_add_f16 v153, v153, 1.0 op_sel_hi:[1,0]
s_add_u32 m0, s67, 59904
s_add_u32 s66, s66, 98304
buffer_load_dwordx4 v240, s[4:7], s66 offen lds
s_add_u32 m0, s67, 0
s_add_u32 s66, s66, 98304
buffer_load_dwordx4 v240, s[4:7], s66 offen lds
ds_read_b128 v[216:219], v248 offset:17408
ds_read_u16_d16_hi v139, v139
v_mfma_f32_32x32x16_bf16 v[120:135], v[84:87], v[220:223], v[120:135]
v_cvt_pk_bf16_f32 v107, v22, v23
v_bfe_u32 v140, v141, 2, 14
v_pk_add_f16 v150, v150, 1.0 op_sel_hi:[1,0]
v_pk_add_f16 v147, v147, 1.0 op_sel_hi:[1,0]
v_cvt_pk_bf16_f32 v108, v24, v25
v_rcp_f16 v154, v153
v_lshrrev_b32 v141, 18, v141
v_cvt_pk_bf16_f32 v109, v26, v27
v_fma_mix_f32 v165, v183, v183, v165 op_sel:[1,1,0] op_sel_hi:[1,1,0]
v_rcp_f16_e64 v151, v150
v_cvt_pk_bf16_f32 v110, v28, v29
v_and_b32_e64 v143, s49, v143
s_add_u32 m0, s67, 6656
s_add_u32 s66, s66, 98304
buffer_load_dwordx4 v240, s[4:7], s66 offen lds
ds_read_b128 v[220:223], v248 offset:20480
ds_read_u16_d16 v140, v140
ds_read_u16_d16_hi v141, v141
v_mfma_f32_32x32x16_bf16 v[120:135], v[88:91], v[224:227], v[120:135]
v_rcp_f16 v148, v147
v_cvt_pk_bf16_f32 v111, v30, v31
v_fma_mix_f32 v165, v184, v184, v165 op_sel:[0,0,0] op_sel_hi:[1,1,0]
v_bfe_u32 v142, v143, 2, 14
v_cvt_pk_bf16_f32 v112, v32, v33
s_setprio 0
v_rcp_f16_sdwa v154, v153 dst_sel:WORD_1 dst_unused:UNUSED_PRESERVE src0_sel:WORD_1
v_rcp_f16_sdwa v151, v150 dst_sel:WORD_1 dst_unused:UNUSED_PRESERVE src0_sel:WORD_1
v_cvt_pk_bf16_f32 v113, v34, v35
v_lshrrev_b32 v143, 18, v143
s_waitcnt lgkmcnt(3)
v_fma_mix_f32 v165, v185, v185, v165 op_sel:[1,1,0] op_sel_hi:[1,1,0]
v_cvt_pk_bf16_f32 v114, v36, v37
s_add_u32 m0, s67, 13312
s_add_u32 s66, s66, 98304
buffer_load_dwordx4 v240, s[4:7], s66 offen lds
ds_read_b128 v[224:227], v248 offset:18432
ds_read_u16_d16 v142, v142
ds_read_u16_d16_hi v143, v143
v_mfma_f32_32x32x16_bf16 v[120:135], v[92:95], v[228:231], v[120:135]
v_rcp_f16_sdwa v148, v147 dst_sel:WORD_1 dst_unused:UNUSED_PRESERVE src0_sel:WORD_1
v_and_b32_e64 v177, s49, v177
v_cvt_pk_bf16_f32 v115, v38, v39
v_pk_mul_f16 v155, v155, v154
v_fma_mix_f32 v165, v186, v186, v165 op_sel:[0,0,0] op_sel_hi:[1,1,0]
v_cvt_pk_bf16_f32 v116, v40, v41
v_pk_mul_f16 v152, v152, v151
v_bfe_u32 v176, v177, 2, 14
v_pk_mul_f16 v149, v149, v148
v_cvt_pk_bf16_f32 v117, v42, v43
v_fma_mix_f32 v166, v155, v155, v166 op_sel:[0,0,0] op_sel_hi:[1,1,0]
v_fma_mix_f32 v166, v155, v155, v166 op_sel:[1,1,0] op_sel_hi:[1,1,0]
v_lshrrev_b32 v177, 18, v177
s_add_u32 m0, s67, 19968
s_add_u32 s66, s66, 98304
buffer_load_dwordx4 v240, s[4:7], s66 offen lds
v_cvt_pk_bf16_f32 v118, v44, v45
v_fma_mix_f32 v165, v187, v187, v165 op_sel:[1,1,0] op_sel_hi:[1,1,0]
v_fma_mix_f32 v166, v152, v152, v166 op_sel:[0,0,0] op_sel_hi:[1,1,0]
v_fma_mix_f32 v166, v152, v152, v166 op_sel:[1,1,0] op_sel_hi:[1,1,0]
v_cvt_pk_bf16_f32 v119, v46, v47
v_fma_mix_f32 v166, v149, v149, v166 op_sel:[0,0,0] op_sel_hi:[1,1,0]
v_fma_mix_f32 v166, v149, v149, v166 op_sel:[1,1,0] op_sel_hi:[1,1,0]
s_setprio 2
v_cvt_pkrtz_f16_f32 v179, v120, v121
v_cvt_pkrtz_f16_f32 v181, v122, v123
v_cvt_pkrtz_f16_f32 v183, v124, v125
v_cvt_pkrtz_f16_f32 v185, v126, v127
v_cvt_pkrtz_f16_f32 v187, v128, v129
v_cvt_pk_f16_f32 v155, v130, v131
v_cvt_pk_f16_f32 v152, v132, v133
v_cvt_pk_f16_f32 v149, v134, v135
ds_read_b128 v[228:231], v248 offset:21504
ds_read_u16_d16 v176, v176
ds_read_u16_d16_hi v177, v177
v_mfma_f32_32x32x16_bf16 v[120:135], v[96:99], v[232:235], 0
v_pk_fma_f16 v154, v155, v155, s48
v_and_b32_e64 v179, s49, v179
v_fma_mix_f32 v166, v136, v136, v166 op_sel:[0,0,0] op_sel_hi:[1,1,0]
v_pk_fma_f16 v151, v152, v152, s48
v_pk_fma_f16 v148, v149, v149, s48
v_bfe_u32 v178, v179, 2, 14
v_pk_mul_f16 v154, v155, v154
v_pk_mul_f16 v151, v152, v151
v_fma_mix_f32 v166, v137, v137, v166 op_sel:[1,1,0] op_sel_hi:[1,1,0]
v_lshrrev_b32_e64 v179, 18, v179
ds_read_b128 v[232:235], v248 offset:22528
ds_read_u16_d16 v178, v178
ds_read_u16_d16_hi v179, v179
v_mfma_f32_32x32x16_bf16 v[120:135], v[100:103], v[236:239], v[120:135]
v_pk_mul_f16 v148, v149, v148
v_exp_f16 v153, v154
v_exp_f16 v150, v151
v_and_b32_e64 v181, s49, v181
v_fma_mix_f32 v166, v138, v138, v166 op_sel:[0,0,0] op_sel_hi:[1,1,0]
v_exp_f16_e64 v147, v148
v_bfe_u32 v180, v181, 2, 14
ds_read_b128 v[236:239], v248 offset:25600
ds_read_u16_d16 v180, v180
v_mfma_f32_32x32x16_bf16 v[120:135], v[104:107], v[216:219], v[120:135]
v_exp_f16_sdwa v153, v154 dst_sel:WORD_1 dst_unused:UNUSED_PRESERVE src0_sel:WORD_1
v_lshrrev_b32_e64 v181, 18, v181
v_fma_mix_f32 v166, v139, v139, v166 op_sel:[1,1,0] op_sel_hi:[1,1,0]
v_exp_f16_sdwa v150, v151 dst_sel:WORD_1 dst_unused:UNUSED_PRESERVE src0_sel:WORD_1
v_exp_f16_sdwa v147, v148 dst_sel:WORD_1 dst_unused:UNUSED_PRESERVE src0_sel:WORD_1
v_and_b32 v183, s49, v183
s_waitcnt lgkmcnt(5)
v_fma_mix_f32 v166, v140, v140, v166 op_sel:[0,0,0] op_sel_hi:[1,1,0]
ds_read_b128 v[216:219], v248 offset:23552
ds_read_u16_d16_hi v181, v181
v_mfma_f32_32x32x16_bf16 v[120:135], v[108:111], v[220:223], v[120:135]
v_pk_add_f16 v153, v153, 1.0 op_sel_hi:[1,0]
v_bfe_u32 v182, v183, 2, 14
v_pk_add_f16 v150, v150, 1.0 op_sel_hi:[1,0]
v_pk_add_f16 v147, v147, 1.0 op_sel_hi:[1,0]
v_rcp_f16 v154, v153
v_lshrrev_b32 v183, 18, v183
v_fma_mix_f32 v166, v141, v141, v166 op_sel:[1,1,0] op_sel_hi:[1,1,0]
v_rcp_f16_e64 v151, v150
ds_read_b128 v[220:223], v248 offset:26624
ds_read_u16_d16 v182, v182
ds_read_u16_d16_hi v183, v183
v_mfma_f32_32x32x16_bf16 v[120:135], v[112:115], v[224:227], v[120:135]
v_and_b32 v185, s49, v185
v_rcp_f16 v148, v147
v_fma_mix_f32 v166, v142, v142, v166 op_sel:[0,0,0] op_sel_hi:[1,1,0]
v_bfe_u32 v184, v185, 2, 14
v_rcp_f16_sdwa v154, v153 dst_sel:WORD_1 dst_unused:UNUSED_PRESERVE src0_sel:WORD_1
v_rcp_f16_sdwa v151, v150 dst_sel:WORD_1 dst_unused:UNUSED_PRESERVE src0_sel:WORD_1
v_lshrrev_b32_e64 v185, 18, v185
ds_read_b128 v[224:227], v248 offset:24576
ds_read_u16_d16 v184, v184
ds_read_u16_d16_hi v185, v185
v_mfma_f32_32x32x16_bf16 v[120:135], v[116:119], v[228:231], v[120:135]
v_fma_mix_f32 v166, v143, v143, v166 op_sel:[1,1,0] op_sel_hi:[1,1,0]
v_rcp_f16_sdwa v148, v147 dst_sel:WORD_1 dst_unused:UNUSED_PRESERVE src0_sel:WORD_1
s_cmp_eq_u32 s40, 7
s_cbranch_scc1 Lrdy24
s_waitcnt vmcnt(0)
Lrdy24:
s_mov_b64 exec, 1
ds_add_u32 v253, v254 offset:12
s_mov_b64 exec, -1
v_and_b32 v187, s49, v187
v_pk_mul_f16 v155, v155, v154
v_fma_mix_f32 v166, v176, v176, v166 op_sel:[0,0,0] op_sel_hi:[1,1,0]
v_pk_mul_f16 v152, v152, v151
v_bfe_u32 v186, v187, 2, 14
v_pk_mul_f16 v149, v149, v148
v_fma_mix_f32 v167, v155, v155, v167 op_sel:[0,0,0] op_sel_hi:[1,1,0]
v_fma_mix_f32 v167, v155, v155, v167 op_sel:[1,1,0] op_sel_hi:[1,1,0]
v_lshrrev_b32_e64 v187, 18, v187
v_fma_mix_f32 v166, v177, v177, v166 op_sel:[1,1,0] op_sel_hi:[1,1,0]
v_fma_mix_f32 v167, v152, v152, v167 op_sel:[0,0,0] op_sel_hi:[1,1,0]
v_fma_mix_f32 v167, v152, v152, v167 op_sel:[1,1,0] op_sel_hi:[1,1,0]
v_fma_mix_f32 v167, v149, v149, v167 op_sel:[0,0,0] op_sel_hi:[1,1,0]
v_fma_mix_f32 v167, v149, v149, v167 op_sel:[1,1,0] op_sel_hi:[1,1,0]
s_cmp_lg_u32 s40, 7
s_cbranch_scc1 Lnoinit
s_waitcnt vmcnt(13)
v_mov_b32_e64 v255, 1
s_mov_b64 exec, 1
buffer_atomic_add v255, v241, s[36:39], 0 offen
s_mov_b64 exec, -1
Lnoinit:
s_setprio 1
v_cvt_pkrtz_f16_f32 v137, v120, v121
v_cvt_pkrtz_f16_f32 v139, v122, v123
v_cvt_pkrtz_f16_f32 v141, v124, v125
v_cvt_pkrtz_f16_f32 v143, v126, v127
v_cvt_pkrtz_f16_f32 v177, v128, v129
v_cvt_pk_f16_f32 v155, v130, v131
v_cvt_pk_f16_f32 v152, v132, v133
v_cvt_pk_f16_f32 v149, v134, v135
s_waitcnt lgkmcnt(1)
s_add_u32 s46, s80, 12582912
buffer_store_dwordx4 v[72:75], v241, s[32:35], s46 offen sc1
ds_read_b128 v[228:231], v248 offset:27648
ds_read_u16_d16 v186, v186
ds_read_u16_d16_hi v187, v187
v_mfma_f32_32x32x16_bf16 v[120:135], v[96:99], v[232:235], 0
v_pk_fma_f16 v154, v155, v155, s48
v_and_b32 v137, s49, v137
v_fma_mix_f32 v167, v178, v178, v167 op_sel:[0,0,0] op_sel_hi:[1,1,0]
v_pk_fma_f16 v151, v152, v152, s48
v_pk_fma_f16 v148, v149, v149, s48
v_bfe_u32 v136, v137, 2, 14
v_pk_mul_f16 v154, v155, v154
v_pk_mul_f16 v151, v152, v151
v_fma_mix_f32 v167, v179, v179, v167 op_sel:[1,1,0] op_sel_hi:[1,1,0]
v_lshrrev_b32_e64 v137, 18, v137
ds_read_b128 v[232:235], v250 offset:65520
ds_read_u16_d16 v136, v136
ds_read_u16_d16_hi v137, v137
v_mfma_f32_32x32x16_bf16 v[120:135], v[100:103], v[236:239], v[120:135]
v_pk_mul_f16 v148, v149, v148
v_exp_f16 v153, v154
v_exp_f16 v150, v151
v_and_b32_e64 v139, s49, v139
v_fma_mix_f32 v167, v180, v180, v167 op_sel:[0,0,0] op_sel_hi:[1,1,0]
v_exp_f16_e64 v147, v148
v_bfe_u32 v138, v139, 2, 14
ds_read_b128 v[236:239], v248 offset:28672
ds_read_b32 v247, v253 offset:12
ds_read_u16_d16 v138, v138
v_mfma_f32_32x32x16_bf16 v[120:135], v[104:107], v[216:219], v[120:135]
v_exp_f16_sdwa v153, v154 dst_sel:WORD_1 dst_unused:UNUSED_PRESERVE src0_sel:WORD_1
v_lshrrev_b32_e64 v139, 18, v139
v_fma_mix_f32 v167, v181, v181, v167 op_sel:[1,1,0] op_sel_hi:[1,1,0]
v_exp_f16_sdwa v150, v151 dst_sel:WORD_1 dst_unused:UNUSED_PRESERVE src0_sel:WORD_1
v_exp_f16_sdwa v147, v148 dst_sel:WORD_1 dst_unused:UNUSED_PRESERVE src0_sel:WORD_1
v_and_b32_e64 v141, s49, v141
v_fma_mix_f32 v167, v182, v182, v167 op_sel:[0,0,0] op_sel_hi:[1,1,0]
ds_read_b128 v[216:219], v248 offset:31744
ds_read_u16_d16_hi v139, v139
v_mfma_f32_32x32x16_bf16 v[120:135], v[108:111], v[220:223], v[120:135]
v_pk_add_f16 v153, v153, 1.0 op_sel_hi:[1,0]
v_bfe_u32 v140, v141, 2, 14
v_pk_add_f16 v150, v150, 1.0 op_sel_hi:[1,0]
v_pk_add_f16 v147, v147, 1.0 op_sel_hi:[1,0]
v_rcp_f16 v154, v153
v_lshrrev_b32 v141, 18, v141
v_fma_mix_f32 v167, v183, v183, v167 op_sel:[1,1,0] op_sel_hi:[1,1,0]
ds_read_u16_d16 v140, v140
ds_read_u16_d16_hi v141, v141
s_waitcnt lgkmcnt(5)
v_readfirstlane_b32 s43, v247
s_nop 1
s_cmp_ge_u32 s43, 32
s_cbranch_scc1 Lev8
Lev8w:
s_sleep 1
ds_read_b32 v247, v253 offset:12
s_waitcnt lgkmcnt(0)
v_readfirstlane_b32 s43, v247
s_cmp_eq_u32 s76, 0
s_cbranch_scc1 Lev8
s_sub_u32 s76, s76, 1
s_cmp_lt_u32 s43, 32
s_cbranch_scc1 Lev8w
Lev8:
v_rcp_f16 v151, v150
ds_read_b128 v[220:223], v248 offset:29696
v_mfma_f32_32x32x16_bf16 v[120:135], v[112:115], v[224:227], v[120:135]
v_and_b32 v143, s49, v143
v_rcp_f16 v148, v147
v_fma_mix_f32 v167, v184, v184, v167 op_sel:[0,0,0] op_sel_hi:[1,1,0]
v_bfe_u32 v142, v143, 2, 14
s_setprio 0
v_rcp_f16_sdwa v154, v153 dst_sel:WORD_1 dst_unused:UNUSED_PRESERVE src0_sel:WORD_1
v_rcp_f16_sdwa v151, v150 dst_sel:WORD_1 dst_unused:UNUSED_PRESERVE src0_sel:WORD_1
v_lshrrev_b32 v143, 18, v143
ds_read_b128 v[224:227], v245 offset:6528
ds_read_b128 v[192:195], v244 offset:128
ds_read_b128 v[196:199], v244 offset:64
ds_read_u16_d16 v142, v142
ds_read_u16_d16_hi v143, v143
v_mfma_f32_32x32x16_bf16 v[120:135], v[116:119], v[228:231], v[120:135]
v_fma_mix_f32 v167, v185, v185, v167 op_sel:[1,1,0] op_sel_hi:[1,1,0]
v_rcp_f16_sdwa v148, v147 dst_sel:WORD_1 dst_unused:UNUSED_PRESERVE src0_sel:WORD_1
v_and_b32_e64 v177, s49, v177
v_pk_mul_f16 v155, v155, v154
v_fma_mix_f32 v167, v186, v186, v167 op_sel:[0,0,0] op_sel_hi:[1,1,0]
v_pk_mul_f16 v152, v152, v151
v_bfe_u32 v176, v177, 2, 14
v_pk_mul_f16 v149, v149, v148
v_fma_mix_f32 v156, v155, v155, v156 op_sel:[0,0,0] op_sel_hi:[1,1,0]
v_fma_mix_f32 v156, v155, v155, v156 op_sel:[1,1,0] op_sel_hi:[1,1,0]
v_lshrrev_b32 v177, 18, v177
v_fma_mix_f32 v167, v187, v187, v167 op_sel:[1,1,0] op_sel_hi:[1,1,0]
v_fma_mix_f32 v156, v152, v152, v156 op_sel:[0,0,0] op_sel_hi:[1,1,0]
v_fma_mix_f32 v156, v152, v152, v156 op_sel:[1,1,0] op_sel_hi:[1,1,0]
v_fma_mix_f32 v156, v149, v149, v156 op_sel:[0,0,0] op_sel_hi:[1,1,0]
v_fma_mix_f32 v156, v149, v149, v156 op_sel:[1,1,0] op_sel_hi:[1,1,0]
s_setprio 2
v_mfma_f32_32x32x16_bf16 v[0:15], v[232:235], v[232:235], 0
s_add_u32 s46, s80, 14680064
buffer_store_dwordx4 v[76:79], v241, s[32:35], s46 offen sc1
ds_read_b128 v[228:231], v248 offset:32768
ds_read_u16_d16 v176, v176
ds_read_u16_d16_hi v177, v177
v_cvt_pkrtz_f16_f32 v179, v120, v121
v_cvt_pkrtz_f16_f32 v181, v122, v123
v_cvt_pkrtz_f16_f32 v183, v124, v125
v_mfma_f32_32x32x16_bf16 v[16:31], v[232:235], v[232:235], 0
v_cvt_pkrtz_f16_f32 v185, v126, v127
v_cvt_pkrtz_f16_f32 v187, v128, v129
v_cvt_pk_f16_f32 v155, v130, v131
v_cvt_pk_f16_f32 v152, v132, v133
v_mfma_f32_32x32x16_bf16 v[32:47], v[232:235], v[232:235], 0
v_cvt_pk_f16_f32 v149, v134, v135
v_pk_fma_f16 v154, v155, v155, s48
v_and_b32_e64 v179, s49, v179
v_mfma_f32_32x32x16_bf16 v[120:135], v[96:99], v[236:239], 0
ds_read_b128 v[232:235], v248 offset:30720
v_fma_mix_f32 v156, v136, v136, v156 op_sel:[0,0,0] op_sel_hi:[1,1,0]
v_pk_fma_f16 v151, v152, v152, s48
v_pk_fma_f16 v148, v149, v149, s48
v_bfe_u32 v178, v179, 2, 14
v_pk_mul_f16 v154, v155, v154
v_pk_mul_f16 v151, v152, v151
v_fma_mix_f32 v156, v137, v137, v156 op_sel:[1,1,0] op_sel_hi:[1,1,0]
s_waitcnt lgkmcnt(4)
v_mfma_f32_32x32x16_bf16 v[120:135], v[100:103], v[216:219], v[120:135]
ds_read_b128 v[236:239], v245 offset:6144
ds_read_b128 v[200:203], v244
ds_read_b128 v[204:207], v243 offset:128
ds_read_u16_d16 v178, v178
v_lshrrev_b32 v179, 18, v179
v_pk_mul_f16 v148, v149, v148
v_exp_f16 v153, v154
v_exp_f16 v150, v151
v_and_b32_e64 v181, s49, v181
v_fma_mix_f32 v156, v138, v138, v156 op_sel:[0,0,0] op_sel_hi:[1,1,0]
v_mfma_f32_32x32x16_bf16 v[120:135], v[104:107], v[220:223], v[120:135]
ds_read_b128 v[216:219], v248 offset:33792
ds_read_u16_d16_hi v179, v179
v_exp_f16_e64 v147, v148
v_bfe_u32 v180, v181, 2, 14
v_exp_f16_sdwa v153, v154 dst_sel:WORD_1 dst_unused:UNUSED_PRESERVE src0_sel:WORD_1
v_lshrrev_b32_e64 v181, 18, v181
v_fma_mix_f32 v156, v139, v139, v156 op_sel:[1,1,0] op_sel_hi:[1,1,0]
v_smfmac_f32_16x16x32_bf16 v[40:43], v[226:227], v[192:195], v246
ds_read_b128 v[220:223], v245 offset:5760
ds_read_b128 v[208:211], v243 offset:64
ds_read_b128 v[212:215], v243
ds_read_u16_d16 v180, v180
ds_read_u16_d16_hi v181, v181
v_exp_f16_sdwa v150, v151 dst_sel:WORD_1 dst_unused:UNUSED_PRESERVE src0_sel:WORD_1
v_smfmac_f32_16x16x32_bf16 v[24:27], v[224:225], v[196:199], v246
v_exp_f16_sdwa v147, v148 dst_sel:WORD_1 dst_unused:UNUSED_PRESERVE src0_sel:WORD_1
v_and_b32 v183, s49, v183
v_fma_mix_f32 v156, v140, v140, v156 op_sel:[0,0,0] op_sel_hi:[1,1,0]
v_pk_add_f16 v153, v153, 1.0 op_sel_hi:[1,0]
s_waitcnt lgkmcnt(7)
v_mfma_f32_32x32x16_bf16 v[120:135], v[108:111], v[228:231], v[120:135]
ds_read_b128 v[224:227], v245 offset:5376
ds_read_b128 v[192:195], v242 offset:128
ds_read_b128 v[196:199], v242 offset:64
v_bfe_u32 v182, v183, 2, 14
v_pk_add_f16 v150, v150, 1.0 op_sel_hi:[1,0]
v_pk_add_f16 v147, v147, 1.0 op_sel_hi:[1,0]
v_rcp_f16 v154, v153
v_lshrrev_b32 v183, 18, v183
v_fma_mix_f32 v156, v141, v141, v156 op_sel:[1,1,0] op_sel_hi:[1,1,0]
v_mfma_f32_32x32x16_bf16 v[120:135], v[112:115], v[232:235], v[120:135]
ds_read_b128 v[228:231], v248 offset:34816
ds_read_u16_d16 v182, v182
ds_read_u16_d16_hi v183, v183
v_rcp_f16 v151, v150
v_and_b32 v185, s49, v185
v_rcp_f16_e64 v148, v147
v_fma_mix_f32 v156, v142, v142, v156 op_sel:[0,0,0] op_sel_hi:[1,1,0]
v_bfe_u32 v184, v185, 2, 14
v_smfmac_f32_16x16x32_bf16 v[8:11], v[238:239], v[200:203], v246
ds_read_b128 v[232:235], v248 offset:37888
ds_read_u16_d16 v184, v184
v_rcp_f16_sdwa v154, v153 dst_sel:WORD_1 dst_unused:UNUSED_PRESERVE src0_sel:WORD_1
v_rcp_f16_sdwa v151, v150 dst_sel:WORD_1 dst_unused:UNUSED_PRESERVE src0_sel:WORD_1
v_smfmac_f32_16x16x32_bf16 v[40:43], v[236:237], v[204:207], v246
v_lshrrev_b32 v185, 18, v185
v_fma_mix_f32 v156, v143, v143, v156 op_sel:[1,1,0] op_sel_hi:[1,1,0]
s_waitcnt lgkmcnt(6)
v_mfma_f32_32x32x16_bf16 v[120:135], v[116:119], v[216:219], v[120:135]
ds_read_b128 v[236:239], v248 offset:35840
ds_read_u16_d16_hi v185, v185
v_rcp_f16_sdwa v148, v147 dst_sel:WORD_1 dst_unused:UNUSED_PRESERVE src0_sel:WORD_1
v_and_b32_e64 v187, s49, v187
v_pk_mul_f16 v155, v155, v154
v_fma_mix_f32 v156, v176, v176, v156 op_sel:[0,0,0] op_sel_hi:[1,1,0]
v_pk_mul_f16 v152, v152, v151
v_bfe_u32 v186, v187, 2, 14
v_pk_mul_f16 v149, v149, v148
v_smfmac_f32_16x16x32_bf16 v[24:27], v[222:223], v[208:211], v246
ds_read_b128 v[216:219], v248 offset:38912
ds_read_u16_d16 v186, v186
v_fma_mix_f32 v157, v155, v155, v157 op_sel:[0,0,0] op_sel_hi:[1,1,0]
v_fma_mix_f32 v157, v155, v155, v157 op_sel:[1,1,0] op_sel_hi:[1,1,0]
v_lshrrev_b32_e64 v187, 18, v187
v_fma_mix_f32 v156, v177, v177, v156 op_sel:[1,1,0] op_sel_hi:[1,1,0]
v_smfmac_f32_16x16x32_bf16 v[8:11], v[220:221], v[212:215], v246
v_fma_mix_f32 v157, v152, v152, v157 op_sel:[0,0,0] op_sel_hi:[1,1,0]
v_fma_mix_f32 v157, v152, v152, v157 op_sel:[1,1,0] op_sel_hi:[1,1,0]
v_fma_mix_f32 v157, v149, v149, v157 op_sel:[0,0,0] op_sel_hi:[1,1,0]
v_fma_mix_f32 v157, v149, v149, v157 op_sel:[1,1,0] op_sel_hi:[1,1,0]
s_setprio 1
v_smfmac_f32_16x16x32_bf16 v[40:43], v[226:227], v[192:195], v246
s_waitcnt lgkmcnt(4)
s_add_u32 s46, s80, 16777216
buffer_store_dwordx4 v[80:83], v241, s[32:35], s46 offen sc1
ds_read_b128 v[220:223], v248 offset:36864
ds_read_u16_d16_hi v187, v187
v_cvt_pkrtz_f16_f32 v137, v120, v121
v_cvt_pkrtz_f16_f32 v139, v122, v123
v_cvt_pkrtz_f16_f32 v141, v124, v125
v_cvt_pkrtz_f16_f32 v143, v126, v127
v_cvt_pk_f16_f32 v155, v128, v129
v_smfmac_f32_16x16x32_bf16 v[24:27], v[224:225], v[196:199], v246
v_cvt_pk_f16_f32 v152, v130, v131
v_cvt_pk_f16_f32 v149, v132, v133
v_cvt_pk_f16_f32 v146, v134, v135
v_pk_fma_f16 v154, v155, v155, s48
v_and_b32_e64 v137, s49, v137
v_mfma_f32_32x32x16_bf16 v[120:135], v[96:99], v[228:231], 0
ds_read_b128 v[224:227], v248 offset:39936
v_fma_mix_f32 v157, v178, v178, v157 op_sel:[0,0,0] op_sel_hi:[1,1,0]
v_pk_fma_f16 v151, v152, v152, s48
v_pk_fma_f16 v148, v149, v149, s48
v_pk_fma_f16 v145, v146, v146, s48
v_pk_mul_f16 v154, v155, v154
v_bfe_u32 v136, v137, 2, 14
v_pk_mul_f16 v151, v152, v151
v_fma_mix_f32 v157, v179, v179, v157 op_sel:[1,1,0] op_sel_hi:[1,1,0]
v_pk_mul_f16 v148, v149, v148
v_pk_mul_f16 v145, v146, v145
v_mfma_f32_32x32x16_bf16 v[120:135], v[100:103], v[232:235], v[120:135]
ds_read_b128 v[228:231], v245 offset:4992
ds_read_b128 v[200:203], v242
v_xor_b32 v244, 16, v244
ds_read_b128 v[204:207], v244 offset:128
ds_read_u16_d16 v136, v136
v_exp_f16 v153, v154
v_lshrrev_b32 v137, 18, v137
v_exp_f16 v150, v151
v_fma_mix_f32 v157, v180, v180, v157 op_sel:[0,0,0] op_sel_hi:[1,1,0]
v_exp_f16 v147, v148
v_and_b32 v139, s49, v139
v_exp_f16 v144, v145
s_waitcnt lgkmcnt(5)
v_mfma_f32_32x32x16_bf16 v[120:135], v[104:107], v[236:239], v[120:135]
ds_read_b128 v[232:235], v245 offset:4608
ds_read_b128 v[208:211], v244 offset:64
ds_read_b128 v[212:215], v244
ds_read_u16_d16_hi v137, v137
v_exp_f16_sdwa v153, v154 dst_sel:WORD_1 dst_unused:UNUSED_PRESERVE src0_sel:WORD_1
v_fma_mix_f32 v157, v181, v181, v157 op_sel:[1,1,0] op_sel_hi:[1,1,0]
v_bfe_u32 v138, v139, 2, 14
v_exp_f16_sdwa v150, v151 dst_sel:WORD_1 dst_unused:UNUSED_PRESERVE src0_sel:WORD_1
v_exp_f16_sdwa v147, v148 dst_sel:WORD_1 dst_unused:UNUSED_PRESERVE src0_sel:WORD_1
v_exp_f16_sdwa v144, v145 dst_sel:WORD_1 dst_unused:UNUSED_PRESERVE src0_sel:WORD_1
v_lshrrev_b32_e64 v139, 18, v139
v_fma_mix_f32 v157, v182, v182, v157 op_sel:[0,0,0] op_sel_hi:[1,1,0]
v_mfma_f32_32x32x16_bf16 v[120:135], v[108:111], v[216:219], v[120:135]
ds_read_b128 v[236:239], v248 offset:40960
ds_read_u16_d16 v138, v138
ds_read_u16_d16_hi v139, v139
v_pk_add_f16 v153, v153, 1.0 op_sel_hi:[1,0]
v_pk_add_f16 v150, v150, 1.0 op_sel_hi:[1,0]
v_pk_add_f16 v147, v147, 1.0 op_sel_hi:[1,0]
v_and_b32_e64 v141, s49, v141
v_pk_add_f16 v144, v144, 1.0 op_sel_hi:[1,0]
v_rcp_f16_e64 v154, v153
v_fma_mix_f32 v157, v183, v183, v157 op_sel:[1,1,0] op_sel_hi:[1,1,0]
v_rcp_f16_e64 v151, v150
v_mfma_f32_32x32x16_bf16 v[120:135], v[112:115], v[220:223], v[120:135]
ds_read_b128 v[216:219], v248 offset:44032
v_bfe_u32 v140, v141, 2, 14
v_rcp_f16_e64 v148, v147
v_fma_mix_f32 v157, v184, v184, v157 op_sel:[0,0,0] op_sel_hi:[1,1,0]
v_rcp_f16 v145, v144
v_lshrrev_b32 v141, 18, v141
v_rcp_f16_sdwa v154, v153 dst_sel:WORD_1 dst_unused:UNUSED_PRESERVE src0_sel:WORD_1
s_setprio 0
v_rcp_f16_sdwa v151, v150 dst_sel:WORD_1 dst_unused:UNUSED_PRESERVE src0_sel:WORD_1
s_waitcnt lgkmcnt(4)
v_mfma_f32_32x32x16_bf16 v[120:135], v[116:119], v[224:227], v[120:135]
ds_read_b128 v[220:223], v248 offset:41984
ds_read_u16_d16 v140, v140
ds_read_u16_d16_hi v141, v141
v_fma_mix_f32 v157, v185, v185, v157 op_sel:[1,1,0] op_sel_hi:[1,1,0]
v_and_b32_e64 v143, s49, v143
v_rcp_f16_sdwa v148, v147 dst_sel:WORD_1 dst_unused:UNUSED_PRESERVE src0_sel:WORD_1
v_rcp_f16_sdwa v145, v144 dst_sel:WORD_1 dst_unused:UNUSED_PRESERVE src0_sel:WORD_1
v_pk_mul_f16 v155, v155, v154
v_bfe_u32 v142, v143, 2, 14
v_fma_mix_f32 v157, v186, v186, v157 op_sel:[0,0,0] op_sel_hi:[1,1,0]
v_pk_mul_f16 v152, v152, v151
v_pk_mul_f16 v149, v149, v148
v_smfmac_f32_16x16x32_bf16 v[8:11], v[230:231], v[200:203], v246
ds_read_b128 v[224:227], v248 offset:45056
ds_read_u16_d16 v142, v142
v_pk_mul_f16 v146, v146, v145
v_fma_mix_f32 v158, v155, v155, v158 op_sel:[0,0,0] op_sel_hi:[1,1,0]
v_lshrrev_b32 v143, 18, v143
v_fma_mix_f32 v158, v155, v155, v158 op_sel:[1,1,0] op_sel_hi:[1,1,0]
v_fma_mix_f32 v158, v152, v152, v158 op_sel:[0,0,0] op_sel_hi:[1,1,0]
v_smfmac_f32_16x16x32_bf16 v[44:47], v[228:229], v[204:207], v246
v_fma_mix_f32 v157, v187, v187, v157 op_sel:[1,1,0] op_sel_hi:[1,1,0]
v_fma_mix_f32 v158, v152, v152, v158 op_sel:[1,1,0] op_sel_hi:[1,1,0]
v_fma_mix_f32 v158, v149, v149, v158 op_sel:[0,0,0] op_sel_hi:[1,1,0]
v_fma_mix_f32 v158, v149, v149, v158 op_sel:[1,1,0] op_sel_hi:[1,1,0]
v_fma_mix_f32 v158, v146, v146, v158 op_sel:[0,0,0] op_sel_hi:[1,1,0]
v_fma_mix_f32 v158, v146, v146, v158 op_sel:[1,1,0] op_sel_hi:[1,1,0]
s_setprio 2
v_smfmac_f32_16x16x32_bf16 v[28:31], v[234:235], v[208:211], v246
s_add_u32 s46, s80, 18874368
buffer_store_dwordx4 v[84:87], v241, s[32:35], s46 offen sc1
ds_read_b128 v[228:231], v248 offset:43008
ds_read_u16_d16_hi v143, v143
v_cvt_pkrtz_f16_f32 v179, v120, v121
v_cvt_pkrtz_f16_f32 v181, v122, v123
v_cvt_pkrtz_f16_f32 v183, v124, v125
v_cvt_pkrtz_f16_f32 v185, v126, v127
v_smfmac_f32_16x16x32_bf16 v[12:15], v[232:233], v[212:215], v246
v_cvt_pkrtz_f16_f32 v187, v128, v129
v_cvt_pk_f16_f32 v155, v130, v131
v_cvt_pk_f16_f32 v152, v132, v133
v_cvt_pk_f16_f32 v149, v134, v135
v_pk_fma_f16 v154, v155, v155, s48
s_waitcnt lgkmcnt(2)
v_mfma_f32_32x32x16_bf16 v[120:135], v[96:99], v[236:239], 0
ds_read_b128 v[232:235], v248 offset:46080
v_and_b32 v179, s49, v179
v_fma_mix_f32 v158, v136, v136, v158 op_sel:[0,0,0] op_sel_hi:[1,1,0]
v_pk_fma_f16 v151, v152, v152, s48
v_pk_fma_f16 v148, v149, v149, s48
v_bfe_u32 v178, v179, 2, 14
v_pk_mul_f16 v154, v155, v154
v_pk_mul_f16 v151, v152, v151
v_pk_mul_f16 v148, v149, v148
v_lshrrev_b32 v179, 18, v179
v_mfma_f32_32x32x16_bf16 v[120:135], v[100:103], v[216:219], v[120:135]
ds_read_b128 v[236:239], v245 offset:4224
v_xor_b32 v243, 16, v243
ds_read_b128 v[192:195], v243 offset:128
ds_read_b128 v[196:199], v243 offset:64
ds_read_u16_d16 v178, v178
ds_read_u16_d16_hi v179, v179
v_fma_mix_f32 v158, v137, v137, v158 op_sel:[1,1,0] op_sel_hi:[1,1,0]
v_exp_f16 v153, v154
v_and_b32 v181, s49, v181
v_exp_f16 v150, v151
v_exp_f16 v147, v148
v_bfe_u32 v180, v181, 2, 14
v_mfma_f32_32x32x16_bf16 v[120:135], v[104:107], v[220:223], v[120:135]
ds_read_b128 v[216:219], v245 offset:3840
ds_read_b128 v[200:203], v243
v_xor_b32 v242, 16, v242
ds_read_b128 v[204:207], v242 offset:128
ds_read_u16_d16 v180, v180
v_fma_mix_f32 v158, v138, v138, v158 op_sel:[0,0,0] op_sel_hi:[1,1,0]
v_exp_f16_sdwa v153, v154 dst_sel:WORD_1 dst_unused:UNUSED_PRESERVE src0_sel:WORD_1
v_lshrrev_b32 v181, 18, v181
v_exp_f16_sdwa v150, v151 dst_sel:WORD_1 dst_unused:UNUSED_PRESERVE src0_sel:WORD_1
v_fma_mix_f32 v158, v139, v139, v158 op_sel:[1,1,0] op_sel_hi:[1,1,0]
v_and_b32_e64 v183, s49, v183
v_mfma_f32_32x32x16_bf16 v[120:135], v[108:111], v[224:227], v[120:135]
ds_read_b128 v[220:223], v248 offset:47104
ds_read_u16_d16_hi v181, v181
v_exp_f16_sdwa v147, v148 dst_sel:WORD_1 dst_unused:UNUSED_PRESERVE src0_sel:WORD_1
v_pk_add_f16 v153, v153, 1.0 op_sel_hi:[1,0]
v_bfe_u32 v182, v183, 2, 14
v_pk_add_f16 v150, v150, 1.0 op_sel_hi:[1,0]
v_pk_add_f16 v147, v147, 1.0 op_sel_hi:[1,0]
v_rcp_f16_e64 v154, v153
v_lshrrev_b32 v183, 18, v183
v_fma_mix_f32 v158, v140, v140, v158 op_sel:[0,0,0] op_sel_hi:[1,1,0]
s_waitcnt lgkmcnt(6)
v_mfma_f32_32x32x16_bf16 v[120:135], v[112:115], v[228:231], v[120:135]
ds_read_b128 v[224:227], v248 offset:50176
ds_read_u16_d16 v182, v182
ds_read_u16_d16_hi v183, v183
v_rcp_f16 v151, v150
v_and_b32 v185, s49, v185
v_rcp_f16_e64 v148, v147
v_fma_mix_f32 v158, v141, v141, v158 op_sel:[1,1,0] op_sel_hi:[1,1,0]
v_bfe_u32 v184, v185, 2, 14
v_rcp_f16_sdwa v154, v153 dst_sel:WORD_1 dst_unused:UNUSED_PRESERVE src0_sel:WORD_1
v_mfma_f32_32x32x16_bf16 v[120:135], v[116:119], v[232:235], v[120:135]
ds_read_b128 v[228:231], v248 offset:48128
ds_read_u16_d16 v184, v184
v_rcp_f16_sdwa v151, v150 dst_sel:WORD_1 dst_unused:UNUSED_PRESERVE src0_sel:WORD_1
v_lshrrev_b32_e64 v185, 18, v185
v_rcp_f16_sdwa v148, v147 dst_sel:WORD_1 dst_unused:UNUSED_PRESERVE src0_sel:WORD_1
v_and_b32_e64 v187, s49, v187
v_fma_mix_f32 v158, v142, v142, v158 op_sel:[0,0,0] op_sel_hi:[1,1,0]
v_pk_mul_f16 v155, v155, v154
v_pk_mul_f16 v152, v152, v151
v_smfmac_f32_16x16x32_bf16 v[44:47], v[238:239], v[192:195], v246
ds_read_b128 v[232:235], v248 offset:51200
ds_read_u16_d16_hi v185, v185
v_bfe_u32 v186, v187, 2, 14
v_pk_mul_f16 v149, v149, v148
v_fma_mix_f32 v159, v155, v155, v159 op_sel:[0,0,0] op_sel_hi:[1,1,0]
v_fma_mix_f32 v158, v143, v143, v158 op_sel:[1,1,0] op_sel_hi:[1,1,0]
v_lshrrev_b32_e64 v187, 18, v187
v_smfmac_f32_16x16x32_bf16 v[28:31], v[236:237], v[196:199], v246
v_fma_mix_f32 v159, v155, v155, v159 op_sel:[1,1,0] op_sel_hi:[1,1,0]
v_fma_mix_f32 v159, v152, v152, v159 op_sel:[0,0,0] op_sel_hi:[1,1,0]
v_fma_mix_f32 v159, v152, v152, v159 op_sel:[1,1,0] op_sel_hi:[1,1,0]
v_fma_mix_f32 v159, v149, v149, v159 op_sel:[0,0,0] op_sel_hi:[1,1,0]
v_fma_mix_f32 v159, v149, v149, v159 op_sel:[1,1,0] op_sel_hi:[1,1,0]
s_setprio 1
s_waitcnt lgkmcnt(4)
v_smfmac_f32_16x16x32_bf16 v[12:15], v[218:219], v[200:203], v246
s_add_u32 s46, s80, 20971520
buffer_store_dwordx4 v[88:91], v241, s[32:35], s46 offen sc1
ds_read_b128 v[236:239], v248 offset:49152
ds_read_u16_d16 v186, v186
ds_read_u16_d16_hi v187, v187
v_cvt_pkrtz_f16_f32 v137, v120, v121
v_cvt_pkrtz_f16_f32 v139, v122, v123
v_cvt_pkrtz_f16_f32 v141, v124, v125
v_cvt_pkrtz_f16_f32 v143, v126, v127
v_cvt_pk_f16_f32 v155, v128, v129
v_smfmac_f32_16x16x32_bf16 v[44:47], v[216:217], v[204:207], v246
v_cvt_pk_f16_f32 v152, v130, v131
v_cvt_pk_f16_f32 v149, v132, v133
v_cvt_pk_f16_f32 v146, v134, v135
v_pk_fma_f16 v154, v155, v155, s48
v_and_b32_e64 v137, s49, v137
v_mfma_f32_32x32x16_bf16 v[120:135], v[96:99], v[220:223], 0
ds_read_b128 v[216:219], v248 offset:52224
v_fma_mix_f32 v159, v178, v178, v159 op_sel:[0,0,0] op_sel_hi:[1,1,0]
v_pk_fma_f16 v151, v152, v152, s48
v_pk_fma_f16 v148, v149, v149, s48
v_pk_fma_f16 v145, v146, v146, s48
v_pk_mul_f16 v154, v155, v154
v_bfe_u32 v136, v137, 2, 14
v_pk_mul_f16 v151, v152, v151
v_fma_mix_f32 v159, v179, v179, v159 op_sel:[1,1,0] op_sel_hi:[1,1,0]
v_pk_mul_f16 v148, v149, v148
v_pk_mul_f16 v145, v146, v145
v_mfma_f32_32x32x16_bf16 v[120:135], v[100:103], v[224:227], v[120:135]
ds_read_b128 v[220:223], v245 offset:3456
ds_read_b128 v[208:211], v242 offset:64
ds_read_b128 v[212:215], v242
ds_read_u16_d16 v136, v136
v_exp_f16 v153, v154
v_lshrrev_b32 v137, 18, v137
v_exp_f16_e64 v150, v151
v_fma_mix_f32 v159, v180, v180, v159 op_sel:[0,0,0] op_sel_hi:[1,1,0]
v_exp_f16 v147, v148
v_and_b32 v139, s49, v139
v_exp_f16_e64 v144, v145
s_waitcnt lgkmcnt(5)
v_mfma_f32_32x32x16_bf16 v[120:135], v[104:107], v[228:231], v[120:135]
ds_read_b128 v[224:227], v245 offset:3072
v_xor_b32 v244, 32, v244
ds_read_b128 v[192:195], v244 offset:128
ds_read_b128 v[196:199], v244 offset:64
ds_read_u16_d16_hi v137, v137
v_exp_f16_sdwa v153, v154 dst_sel:WORD_1 dst_unused:UNUSED_PRESERVE src0_sel:WORD_1
v_fma_mix_f32 v159, v181, v181, v159 op_sel:[1,1,0] op_sel_hi:[1,1,0]
v_bfe_u32 v138, v139, 2, 14
v_exp_f16_sdwa v150, v151 dst_sel:WORD_1 dst_unused:UNUSED_PRESERVE src0_sel:WORD_1
v_exp_f16_sdwa v147, v148 dst_sel:WORD_1 dst_unused:UNUSED_PRESERVE src0_sel:WORD_1
v_exp_f16_sdwa v144, v145 dst_sel:WORD_1 dst_unused:UNUSED_PRESERVE src0_sel:WORD_1
v_lshrrev_b32_e64 v139, 18, v139
v_fma_mix_f32 v159, v182, v182, v159 op_sel:[0,0,0] op_sel_hi:[1,1,0]
v_mfma_f32_32x32x16_bf16 v[120:135], v[108:111], v[232:235], v[120:135]
ds_read_b128 v[228:231], v248 offset:53248
ds_read_u16_d16 v138, v138
ds_read_u16_d16_hi v139, v139
v_pk_add_f16 v153, v153, 1.0 op_sel_hi:[1,0]
v_pk_add_f16 v150, v150, 1.0 op_sel_hi:[1,0]
v_pk_add_f16 v147, v147, 1.0 op_sel_hi:[1,0]
v_and_b32_e64 v141, s49, v141
v_pk_add_f16 v144, v144, 1.0 op_sel_hi:[1,0]
v_rcp_f16_e64 v154, v153
v_fma_mix_f32 v159, v183, v183, v159 op_sel:[1,1,0] op_sel_hi:[1,1,0]
v_rcp_f16_e64 v151, v150
v_mfma_f32_32x32x16_bf16 v[120:135], v[112:115], v[236:239], v[120:135]
ds_read_b128 v[232:235], v248 offset:56320
v_bfe_u32 v140, v141, 2, 14
v_rcp_f16_e64 v148, v147
v_fma_mix_f32 v159, v184, v184, v159 op_sel:[0,0,0] op_sel_hi:[1,1,0]
v_rcp_f16 v145, v144
v_lshrrev_b32 v141, 18, v141
v_rcp_f16_sdwa v154, v153 dst_sel:WORD_1 dst_unused:UNUSED_PRESERVE src0_sel:WORD_1
s_setprio 0
v_rcp_f16_sdwa v151, v150 dst_sel:WORD_1 dst_unused:UNUSED_PRESERVE src0_sel:WORD_1
s_waitcnt lgkmcnt(4)
v_mfma_f32_32x32x16_bf16 v[120:135], v[116:119], v[216:219], v[120:135]
ds_read_b128 v[236:239], v248 offset:54272
ds_read_u16_d16 v140, v140
ds_read_u16_d16_hi v141, v141
v_fma_mix_f32 v159, v185, v185, v159 op_sel:[1,1,0] op_sel_hi:[1,1,0]
v_and_b32_e64 v143, s49, v143
v_rcp_f16_sdwa v148, v147 dst_sel:WORD_1 dst_unused:UNUSED_PRESERVE src0_sel:WORD_1
v_rcp_f16_sdwa v145, v144 dst_sel:WORD_1 dst_unused:UNUSED_PRESERVE src0_sel:WORD_1
v_pk_mul_f16 v155, v155, v154
v_bfe_u32 v142, v143, 2, 14
v_fma_mix_f32 v159, v186, v186, v159 op_sel:[0,0,0] op_sel_hi:[1,1,0]
v_pk_mul_f16 v152, v152, v151
v_pk_mul_f16 v149, v149, v148
v_smfmac_f32_16x16x32_bf16 v[28:31], v[222:223], v[208:211], v246
ds_read_b128 v[216:219], v248 offset:57344
ds_read_u16_d16 v142, v142
v_pk_mul_f16 v146, v146, v145
v_fma_mix_f32 v160, v155, v155, v160 op_sel:[0,0,0] op_sel_hi:[1,1,0]
v_lshrrev_b32 v143, 18, v143
v_fma_mix_f32 v160, v155, v155, v160 op_sel:[1,1,0] op_sel_hi:[1,1,0]
v_fma_mix_f32 v160, v152, v152, v160 op_sel:[0,0,0] op_sel_hi:[1,1,0]
v_smfmac_f32_16x16x32_bf16 v[12:15], v[220:221], v[212:215], v246
v_fma_mix_f32 v159, v187, v187, v159 op_sel:[1,1,0] op_sel_hi:[1,1,0]
v_fma_mix_f32 v160, v152, v152, v160 op_sel:[1,1,0] op_sel_hi:[1,1,0]
v_fma_mix_f32 v160, v149, v149, v160 op_sel:[0,0,0] op_sel_hi:[1,1,0]
v_fma_mix_f32 v160, v149, v149, v160 op_sel:[1,1,0] op_sel_hi:[1,1,0]
v_fma_mix_f32 v160, v146, v146, v160 op_sel:[0,0,0] op_sel_hi:[1,1,0]
v_fma_mix_f32 v160, v146, v146, v160 op_sel:[1,1,0] op_sel_hi:[1,1,0]
s_setprio 2
v_smfmac_f32_16x16x32_bf16 v[36:39], v[226:227], v[192:195], v246
s_add_u32 s46, s80, 23068672
buffer_store_dwordx4 v[92:95], v241, s[32:35], s46 offen sc1
ds_read_b128 v[220:223], v248 offset:55296
ds_read_u16_d16_hi v143, v143
v_cvt_pkrtz_f16_f32 v179, v120, v121
v_cvt_pkrtz_f16_f32 v181, v122, v123
v_cvt_pkrtz_f16_f32 v183, v124, v125
v_cvt_pkrtz_f16_f32 v185, v126, v127
v_smfmac_f32_16x16x32_bf16 v[20:23], v[224:225], v[196:199], v246
v_cvt_pkrtz_f16_f32 v187, v128, v129
v_cvt_pk_f16_f32 v155, v130, v131
v_cvt_pk_f16_f32 v152, v132, v133
v_cvt_pk_f16_f32 v149, v134, v135
s_waitcnt lgkmcnt(2)
v_mfma_f32_32x32x16_bf16 v[120:135], v[96:99], v[228:231], 0
ds_read_b128 v[224:227], v245 offset:2688
ds_read_b128 v[200:203], v244
v_xor_b32 v243, 32, v243
ds_read_b128 v[204:207], v243 offset:128
v_pk_fma_f16 v154, v155, v155, s48
v_and_b32_e64 v179, s49, v179
v_fma_mix_f32 v160, v136, v136, v160 op_sel:[0,0,0] op_sel_hi:[1,1,0]
v_pk_fma_f16 v151, v152, v152, s48
v_pk_fma_f16 v148, v149, v149, s48
v_bfe_u32 v178, v179, 2, 14
v_pk_mul_f16 v154, v155, v154
v_pk_mul_f16 v151, v152, v151
v_mfma_f32_32x32x16_bf16 v[120:135], v[100:103], v[232:235], v[120:135]
ds_read_b128 v[228:231], v248 offset:58368
ds_read_u16_d16 v178, v178
v_pk_mul_f16 v148, v149, v148
v_lshrrev_b32_e64 v179, 18, v179
v_fma_mix_f32 v160, v137, v137, v160 op_sel:[1,1,0] op_sel_hi:[1,1,0]
v_exp_f16 v153, v154
v_and_b32 v181, s49, v181
v_exp_f16_e64 v150, v151
v_mfma_f32_32x32x16_bf16 v[120:135], v[104:107], v[236:239], v[120:135]
ds_read_b128 v[232:235], v245 offset:2304
ds_read_b128 v[208:211], v243 offset:64
ds_read_b128 v[212:215], v243
ds_read_u16_d16_hi v179, v179
v_exp_f16_e64 v147, v148
v_bfe_u32 v180, v181, 2, 14
v_fma_mix_f32 v160, v138, v138, v160 op_sel:[0,0,0] op_sel_hi:[1,1,0]
v_exp_f16_sdwa v153, v154 dst_sel:WORD_1 dst_unused:UNUSED_PRESERVE src0_sel:WORD_1
v_lshrrev_b32 v181, 18, v181
v_mfma_f32_32x32x16_bf16 v[120:135], v[108:111], v[216:219], v[120:135]
ds_read_b128 v[236:239], v245 offset:1920
v_xor_b32 v242, 32, v242
ds_read_b128 v[192:195], v242 offset:128
ds_read_b128 v[196:199], v242 offset:64
ds_read_u16_d16 v180, v180
ds_read_u16_d16_hi v181, v181
v_exp_f16_sdwa v150, v151 dst_sel:WORD_1 dst_unused:UNUSED_PRESERVE src0_sel:WORD_1
v_fma_mix_f32 v160, v139, v139, v160 op_sel:[1,1,0] op_sel_hi:[1,1,0]
v_and_b32 v183, s49, v183
v_exp_f16_sdwa v147, v148 dst_sel:WORD_1 dst_unused:UNUSED_PRESERVE src0_sel:WORD_1
v_pk_add_f16 v153, v153, 1.0 op_sel_hi:[1,0]
v_bfe_u32 v182, v183, 2, 14
v_pk_add_f16 v150, v150, 1.0 op_sel_hi:[1,0]
s_waitcnt lgkmcnt(9)
v_mfma_f32_32x32x16_bf16 v[120:135], v[112:115], v[220:223], v[120:135]
ds_read_b128 v[216:219], v248 offset:59392
ds_read_u16_d16 v182, v182
v_pk_add_f16 v147, v147, 1.0 op_sel_hi:[1,0]
v_rcp_f16 v154, v153
v_lshrrev_b32 v183, 18, v183
v_fma_mix_f32 v160, v140, v140, v160 op_sel:[0,0,0] op_sel_hi:[1,1,0]
v_rcp_f16 v151, v150
v_and_b32 v185, s49, v185
v_smfmac_f32_16x16x32_bf16 v[4:7], v[226:227], v[200:203], v246
ds_read_b128 v[220:223], v248 offset:62464
ds_read_u16_d16_hi v183, v183
v_rcp_f16_e64 v148, v147
v_fma_mix_f32 v160, v141, v141, v160 op_sel:[1,1,0] op_sel_hi:[1,1,0]
v_bfe_u32 v184, v185, 2, 14
v_smfmac_f32_16x16x32_bf16 v[36:39], v[224:225], v[204:207], v246
v_rcp_f16_sdwa v154, v153 dst_sel:WORD_1 dst_unused:UNUSED_PRESERVE src0_sel:WORD_1
v_rcp_f16_sdwa v151, v150 dst_sel:WORD_1 dst_unused:UNUSED_PRESERVE src0_sel:WORD_1
v_mfma_f32_32x32x16_bf16 v[120:135], v[116:119], v[228:231], v[120:135]
ds_read_b128 v[224:227], v248 offset:60416
ds_read_u16_d16 v184, v184
v_lshrrev_b32_e64 v185, 18, v185
v_rcp_f16_sdwa v148, v147 dst_sel:WORD_1 dst_unused:UNUSED_PRESERVE src0_sel:WORD_1
v_and_b32 v187, s49, v187
v_fma_mix_f32 v160, v142, v142, v160 op_sel:[0,0,0] op_sel_hi:[1,1,0]
v_pk_mul_f16 v155, v155, v154
v_pk_mul_f16 v152, v152, v151
v_bfe_u32 v186, v187, 2, 14
s_waitcnt lgkmcnt(4)
v_smfmac_f32_16x16x32_bf16 v[20:23], v[234:235], v[208:211], v246
ds_read_b128 v[228:231], v248 offset:63488
ds_read_u16_d16_hi v185, v185
ds_read_u16_d16 v186, v186
v_pk_mul_f16 v149, v149, v148
v_fma_mix_f32 v161, v155, v155, v161 op_sel:[0,0,0] op_sel_hi:[1,1,0]
v_fma_mix_f32 v160, v143, v143, v160 op_sel:[1,1,0] op_sel_hi:[1,1,0]
v_lshrrev_b32 v187, 18, v187
v_smfmac_f32_16x16x32_bf16 v[4:7], v[232:233], v[212:215], v246
v_fma_mix_f32 v161, v155, v155, v161 op_sel:[1,1,0] op_sel_hi:[1,1,0]
v_fma_mix_f32 v161, v152, v152, v161 op_sel:[0,0,0] op_sel_hi:[1,1,0]
v_fma_mix_f32 v161, v152, v152, v161 op_sel:[1,1,0] op_sel_hi:[1,1,0]
v_fma_mix_f32 v161, v149, v149, v161 op_sel:[0,0,0] op_sel_hi:[1,1,0]
v_fma_mix_f32 v161, v149, v149, v161 op_sel:[1,1,0] op_sel_hi:[1,1,0]
s_setprio 1
v_smfmac_f32_16x16x32_bf16 v[36:39], v[238:239], v[192:195], v246
ds_read_b128 v[232:235], v248 offset:61440
ds_read_u16_d16_hi v187, v187
v_cvt_pkrtz_f16_f32 v137, v120, v121
v_cvt_pkrtz_f16_f32 v139, v122, v123
v_cvt_pkrtz_f16_f32 v141, v124, v125
v_cvt_pkrtz_f16_f32 v143, v126, v127
v_cvt_pk_f16_f32 v155, v128, v129
v_smfmac_f32_16x16x32_bf16 v[20:23], v[236:237], v[196:199], v246
v_cvt_pk_f16_f32 v152, v130, v131
v_cvt_pk_f16_f32 v149, v132, v133
v_cvt_pk_f16_f32 v146, v134, v135
v_pk_fma_f16 v154, v155, v155, s48
v_and_b32_e64 v137, s49, v137
v_mfma_f32_32x32x16_bf16 v[120:135], v[96:99], v[216:219], 0
ds_read_b128 v[236:239], v248 offset:64512
v_fma_mix_f32 v161, v178, v178, v161 op_sel:[0,0,0] op_sel_hi:[1,1,0]
v_pk_fma_f16 v151, v152, v152, s48
v_pk_fma_f16 v148, v149, v149, s48
v_pk_fma_f16 v145, v146, v146, s48
v_pk_mul_f16 v154, v155, v154
v_bfe_u32 v136, v137, 2, 14
v_pk_mul_f16 v151, v152, v151
v_fma_mix_f32 v161, v179, v179, v161 op_sel:[1,1,0] op_sel_hi:[1,1,0]
v_pk_mul_f16 v148, v149, v148
v_pk_mul_f16 v145, v146, v145
s_waitcnt lgkmcnt(2)
v_mfma_f32_32x32x16_bf16 v[120:135], v[100:103], v[220:223], v[120:135]
ds_read_b128 v[216:219], v245 offset:1536
ds_read_b128 v[200:203], v242
v_xor_b32 v244, 16, v244
ds_read_b128 v[204:207], v244 offset:128
ds_read_u16_d16 v136, v136
v_exp_f16 v153, v154
v_lshrrev_b32 v137, 18, v137
v_exp_f16_e64 v150, v151
v_fma_mix_f32 v161, v180, v180, v161 op_sel:[0,0,0] op_sel_hi:[1,1,0]
v_exp_f16 v147, v148
v_and_b32 v139, s49, v139
v_exp_f16_e64 v144, v145
v_mfma_f32_32x32x16_bf16 v[120:135], v[104:107], v[224:227], v[120:135]
ds_read_b128 v[220:223], v245 offset:1152
ds_read_b128 v[208:211], v244 offset:64
ds_read_b128 v[212:215], v244
ds_read_u16_d16_hi v137, v137
v_exp_f16_sdwa v153, v154 dst_sel:WORD_1 dst_unused:UNUSED_PRESERVE src0_sel:WORD_1
v_fma_mix_f32 v161, v181, v181, v161 op_sel:[1,1,0] op_sel_hi:[1,1,0]
v_bfe_u32 v138, v139, 2, 14
v_exp_f16_sdwa v150, v151 dst_sel:WORD_1 dst_unused:UNUSED_PRESERVE src0_sel:WORD_1
v_exp_f16_sdwa v147, v148 dst_sel:WORD_1 dst_unused:UNUSED_PRESERVE src0_sel:WORD_1
v_exp_f16_sdwa v144, v145 dst_sel:WORD_1 dst_unused:UNUSED_PRESERVE src0_sel:WORD_1
v_lshrrev_b32_e64 v139, 18, v139
v_fma_mix_f32 v161, v182, v182, v161 op_sel:[0,0,0] op_sel_hi:[1,1,0]
v_mfma_f32_32x32x16_bf16 v[120:135], v[108:111], v[228:231], v[120:135]
ds_read_b128 v[224:227], v249
ds_read_u16_d16 v138, v138
ds_read_u16_d16_hi v139, v139
v_pk_add_f16 v153, v153, 1.0 op_sel_hi:[1,0]
v_pk_add_f16 v150, v150, 1.0 op_sel_hi:[1,0]
v_pk_add_f16 v147, v147, 1.0 op_sel_hi:[1,0]
v_and_b32_e64 v141, s49, v141
v_pk_add_f16 v144, v144, 1.0 op_sel_hi:[1,0]
v_rcp_f16_e64 v154, v153
v_fma_mix_f32 v161, v183, v183, v161 op_sel:[1,1,0] op_sel_hi:[1,1,0]
v_rcp_f16_e64 v151, v150
v_mfma_f32_32x32x16_bf16 v[120:135], v[112:115], v[232:235], v[120:135]
ds_read_b128 v[228:231], v249 offset:3072
v_bfe_u32 v140, v141, 2, 14
v_rcp_f16_e64 v148, v147
v_fma_mix_f32 v161, v184, v184, v161 op_sel:[0,0,0] op_sel_hi:[1,1,0]
v_rcp_f16 v145, v144
v_lshrrev_b32 v141, 18, v141
v_rcp_f16_sdwa v154, v153 dst_sel:WORD_1 dst_unused:UNUSED_PRESERVE src0_sel:WORD_1
s_setprio 0
v_rcp_f16_sdwa v151, v150 dst_sel:WORD_1 dst_unused:UNUSED_PRESERVE src0_sel:WORD_1
s_waitcnt lgkmcnt(4)
v_mfma_f32_32x32x16_bf16 v[120:135], v[116:119], v[236:239], v[120:135]
ds_read_b128 v[232:235], v249 offset:1024
ds_read_u16_d16 v140, v140
ds_read_u16_d16_hi v141, v141
v_fma_mix_f32 v161, v185, v185, v161 op_sel:[1,1,0] op_sel_hi:[1,1,0]
v_and_b32_e64 v143, s49, v143
v_rcp_f16_sdwa v148, v147 dst_sel:WORD_1 dst_unused:UNUSED_PRESERVE src0_sel:WORD_1
v_rcp_f16_sdwa v145, v144 dst_sel:WORD_1 dst_unused:UNUSED_PRESERVE src0_sel:WORD_1
v_pk_mul_f16 v155, v155, v154
v_bfe_u32 v142, v143, 2, 14
v_fma_mix_f32 v161, v186, v186, v161 op_sel:[0,0,0] op_sel_hi:[1,1,0]
v_pk_mul_f16 v152, v152, v151
v_pk_mul_f16 v149, v149, v148
v_smfmac_f32_16x16x32_bf16 v[4:7], v[218:219], v[200:203], v246
ds_read_b128 v[236:239], v249 offset:4096
ds_read_u16_d16 v142, v142
v_pk_mul_f16 v146, v146, v145
v_fma_mix_f32 v162, v155, v155, v162 op_sel:[0,0,0] op_sel_hi:[1,1,0]
v_lshrrev_b32 v143, 18, v143
v_fma_mix_f32 v162, v155, v155, v162 op_sel:[1,1,0] op_sel_hi:[1,1,0]
v_fma_mix_f32 v162, v152, v152, v162 op_sel:[0,0,0] op_sel_hi:[1,1,0]
v_smfmac_f32_16x16x32_bf16 v[32:35], v[216:217], v[204:207], v246
v_fma_mix_f32 v161, v187, v187, v161 op_sel:[1,1,0] op_sel_hi:[1,1,0]
v_fma_mix_f32 v162, v152, v152, v162 op_sel:[1,1,0] op_sel_hi:[1,1,0]
v_fma_mix_f32 v162, v149, v149, v162 op_sel:[0,0,0] op_sel_hi:[1,1,0]
v_fma_mix_f32 v162, v149, v149, v162 op_sel:[1,1,0] op_sel_hi:[1,1,0]
v_fma_mix_f32 v162, v146, v146, v162 op_sel:[0,0,0] op_sel_hi:[1,1,0]
v_fma_mix_f32 v162, v146, v146, v162 op_sel:[1,1,0] op_sel_hi:[1,1,0]
s_setprio 2
v_smfmac_f32_16x16x32_bf16 v[16:19], v[222:223], v[208:211], v246
ds_read_b128 v[216:219], v249 offset:2048
ds_read_u16_d16_hi v143, v143
v_cvt_pkrtz_f16_f32 v179, v120, v121
v_cvt_pkrtz_f16_f32 v181, v122, v123
v_cvt_pkrtz_f16_f32 v183, v124, v125
v_cvt_pkrtz_f16_f32 v185, v126, v127
v_smfmac_f32_16x16x32_bf16 v[0:3], v[220:221], v[212:215], v246
v_cvt_pkrtz_f16_f32 v187, v128, v129
v_cvt_pk_f16_f32 v155, v130, v131
v_cvt_pk_f16_f32 v152, v132, v133
v_cvt_pk_f16_f32 v149, v134, v135
v_pk_fma_f16 v154, v155, v155, s48
s_waitcnt lgkmcnt(2)
v_mfma_f32_32x32x16_bf16 v[120:135], v[96:99], v[224:227], 0
ds_read_b128 v[220:223], v249 offset:5120
v_and_b32 v179, s49, v179
v_fma_mix_f32 v162, v136, v136, v162 op_sel:[0,0,0] op_sel_hi:[1,1,0]
v_pk_fma_f16 v151, v152, v152, s48
v_pk_fma_f16 v148, v149, v149, s48
v_bfe_u32 v178, v179, 2, 14
v_pk_mul_f16 v154, v155, v154
v_pk_mul_f16 v151, v152, v151
v_pk_mul_f16 v148, v149, v148
v_lshrrev_b32 v179, 18, v179
v_mfma_f32_32x32x16_bf16 v[120:135], v[100:103], v[228:231], v[120:135]
ds_read_b128 v[224:227], v245 offset:768
v_xor_b32 v243, 16, v243
ds_read_b128 v[192:195], v243 offset:128
ds_read_b128 v[196:199], v243 offset:64
ds_read_u16_d16 v178, v178
ds_read_u16_d16_hi v179, v179
v_fma_mix_f32 v162, v137, v137, v162 op_sel:[1,1,0] op_sel_hi:[1,1,0]
v_exp_f16 v153, v154
v_and_b32 v181, s49, v181
v_exp_f16 v150, v151
v_exp_f16 v147, v148
v_bfe_u32 v180, v181, 2, 14
v_mfma_f32_32x32x16_bf16 v[120:135], v[104:107], v[232:235], v[120:135]
ds_read_b128 v[228:231], v245 offset:384
ds_read_b128 v[200:203], v243
v_xor_b32 v242, 16, v242
ds_read_b128 v[204:207], v242 offset:128
ds_read_u16_d16 v180, v180
v_fma_mix_f32 v162, v138, v138, v162 op_sel:[0,0,0] op_sel_hi:[1,1,0]
v_exp_f16_sdwa v153, v154 dst_sel:WORD_1 dst_unused:UNUSED_PRESERVE src0_sel:WORD_1
v_lshrrev_b32 v181, 18, v181
v_exp_f16_sdwa v150, v151 dst_sel:WORD_1 dst_unused:UNUSED_PRESERVE src0_sel:WORD_1
v_fma_mix_f32 v162, v139, v139, v162 op_sel:[1,1,0] op_sel_hi:[1,1,0]
v_and_b32_e64 v183, s49, v183
v_mfma_f32_32x32x16_bf16 v[120:135], v[108:111], v[236:239], v[120:135]
ds_read_b128 v[232:235], v249 offset:6144
ds_read_u16_d16_hi v181, v181
v_exp_f16_sdwa v147, v148 dst_sel:WORD_1 dst_unused:UNUSED_PRESERVE src0_sel:WORD_1
v_pk_add_f16 v153, v153, 1.0 op_sel_hi:[1,0]
v_bfe_u32 v182, v183, 2, 14
v_pk_add_f16 v150, v150, 1.0 op_sel_hi:[1,0]
v_pk_add_f16 v147, v147, 1.0 op_sel_hi:[1,0]
v_rcp_f16_e64 v154, v153
v_lshrrev_b32 v183, 18, v183
v_fma_mix_f32 v162, v140, v140, v162 op_sel:[0,0,0] op_sel_hi:[1,1,0]
s_waitcnt lgkmcnt(6)
v_mfma_f32_32x32x16_bf16 v[120:135], v[112:115], v[216:219], v[120:135]
ds_read_b128 v[236:239], v249 offset:9216
ds_read_u16_d16 v182, v182
ds_read_u16_d16_hi v183, v183
v_rcp_f16 v151, v150
v_and_b32 v185, s49, v185
v_rcp_f16_e64 v148, v147
v_fma_mix_f32 v162, v141, v141, v162 op_sel:[1,1,0] op_sel_hi:[1,1,0]
v_bfe_u32 v184, v185, 2, 14
v_rcp_f16_sdwa v154, v153 dst_sel:WORD_1 dst_unused:UNUSED_PRESERVE src0_sel:WORD_1
v_mfma_f32_32x32x16_bf16 v[120:135], v[116:119], v[220:223], v[120:135]
ds_read_b128 v[216:219], v249 offset:7168
ds_read_u16_d16 v184, v184
v_rcp_f16_sdwa v151, v150 dst_sel:WORD_1 dst_unused:UNUSED_PRESERVE src0_sel:WORD_1
v_lshrrev_b32_e64 v185, 18, v185
v_rcp_f16_sdwa v148, v147 dst_sel:WORD_1 dst_unused:UNUSED_PRESERVE src0_sel:WORD_1
v_and_b32_e64 v187, s49, v187
v_fma_mix_f32 v162, v142, v142, v162 op_sel:[0,0,0] op_sel_hi:[1,1,0]
v_pk_mul_f16 v155, v155, v154
v_pk_mul_f16 v152, v152, v151
v_smfmac_f32_16x16x32_bf16 v[32:35], v[226:227], v[192:195], v246
ds_read_b128 v[220:223], v249 offset:10240
ds_read_u16_d16_hi v185, v185
v_bfe_u32 v186, v187, 2, 14
v_pk_mul_f16 v149, v149, v148
v_fma_mix_f32 v163, v155, v155, v163 op_sel:[0,0,0] op_sel_hi:[1,1,0]
v_fma_mix_f32 v162, v143, v143, v162 op_sel:[1,1,0] op_sel_hi:[1,1,0]
v_lshrrev_b32_e64 v187, 18, v187
v_smfmac_f32_16x16x32_bf16 v[16:19], v[224:225], v[196:199], v246
v_fma_mix_f32 v163, v155, v155, v163 op_sel:[1,1,0] op_sel_hi:[1,1,0]
v_fma_mix_f32 v163, v152, v152, v163 op_sel:[0,0,0] op_sel_hi:[1,1,0]
v_fma_mix_f32 v163, v152, v152, v163 op_sel:[1,1,0] op_sel_hi:[1,1,0]
v_fma_mix_f32 v163, v149, v149, v163 op_sel:[0,0,0] op_sel_hi:[1,1,0]
v_fma_mix_f32 v163, v149, v149, v163 op_sel:[1,1,0] op_sel_hi:[1,1,0]
s_setprio 1
s_waitcnt lgkmcnt(4)
v_smfmac_f32_16x16x32_bf16 v[0:3], v[230:231], v[200:203], v246
ds_read_b128 v[224:227], v249 offset:8192
ds_read_u16_d16 v186, v186
ds_read_u16_d16_hi v187, v187
v_cvt_pkrtz_f16_f32 v137, v120, v121
v_cvt_pkrtz_f16_f32 v139, v122, v123
v_cvt_pkrtz_f16_f32 v141, v124, v125
v_cvt_pkrtz_f16_f32 v143, v126, v127
v_smfmac_f32_16x16x32_bf16 v[32:35], v[228:229], v[204:207], v246
v_cvt_pk_f16_f32 v155, v128, v129
v_cvt_pk_f16_f32 v152, v130, v131
v_cvt_pk_f16_f32 v149, v132, v133
v_cvt_pk_f16_f32 v146, v134, v135
v_pk_fma_f16 v154, v155, v155, s48
v_mfma_f32_32x32x16_bf16 v[120:135], v[96:99], v[232:235], 0
ds_read_b128 v[228:231], v249 offset:11264
v_and_b32_e64 v137, s49, v137
v_fma_mix_f32 v163, v178, v178, v163 op_sel:[0,0,0] op_sel_hi:[1,1,0]
v_pk_fma_f16 v151, v152, v152, s48
v_pk_fma_f16 v148, v149, v149, s48
v_pk_fma_f16 v145, v146, v146, s48
v_pk_mul_f16 v154, v155, v154
v_bfe_u32 v136, v137, 2, 14
v_pk_mul_f16 v151, v152, v151
v_fma_mix_f32 v163, v179, v179, v163 op_sel:[1,1,0] op_sel_hi:[1,1,0]
v_pk_mul_f16 v148, v149, v148
v_mfma_f32_32x32x16_bf16 v[120:135], v[100:103], v[236:239], v[120:135]
ds_read_b128 v[232:235], v245
ds_read_b128 v[208:211], v242 offset:64
ds_read_b128 v[212:215], v242
ds_read_u16_d16 v136, v136
v_pk_mul_f16 v145, v146, v145
v_exp_f16 v153, v154
v_lshrrev_b32 v137, 18, v137
v_exp_f16_e64 v150, v151
v_fma_mix_f32 v163, v180, v180, v163 op_sel:[0,0,0] op_sel_hi:[1,1,0]
v_exp_f16_e64 v147, v148
v_and_b32 v139, s49, v139
s_waitcnt lgkmcnt(5)
v_mfma_f32_32x32x16_bf16 v[120:135], v[104:107], v[216:219], v[120:135]
ds_read_b128 v[236:239], v249 offset:12288
ds_read_u16_d16_hi v137, v137
v_exp_f16_e64 v144, v145
v_exp_f16_sdwa v153, v154 dst_sel:WORD_1 dst_unused:UNUSED_PRESERVE src0_sel:WORD_1
v_fma_mix_f32 v163, v181, v181, v163 op_sel:[1,1,0] op_sel_hi:[1,1,0]
v_bfe_u32 v138, v139, 2, 14
v_exp_f16_sdwa v150, v151 dst_sel:WORD_1 dst_unused:UNUSED_PRESERVE src0_sel:WORD_1
v_exp_f16_sdwa v147, v148 dst_sel:WORD_1 dst_unused:UNUSED_PRESERVE src0_sel:WORD_1
v_mfma_f32_32x32x16_bf16 v[120:135], v[108:111], v[220:223], v[120:135]
ds_read_b128 v[216:219], v249 offset:15360
ds_read_u16_d16 v138, v138
v_exp_f16_sdwa v144, v145 dst_sel:WORD_1 dst_unused:UNUSED_PRESERVE src0_sel:WORD_1
v_lshrrev_b32_e64 v139, 18, v139
v_fma_mix_f32 v163, v182, v182, v163 op_sel:[0,0,0] op_sel_hi:[1,1,0]
v_pk_add_f16 v153, v153, 1.0 op_sel_hi:[1,0]
v_pk_add_f16 v150, v150, 1.0 op_sel_hi:[1,0]
v_pk_add_f16 v147, v147, 1.0 op_sel_hi:[1,0]
v_and_b32_e64 v141, s49, v141
v_pk_add_f16 v144, v144, 1.0 op_sel_hi:[1,0]
v_mfma_f32_32x32x16_bf16 v[120:135], v[112:115], v[224:227], v[120:135]
ds_read_b128 v[220:223], v249 offset:13312
ds_read_u16_d16_hi v139, v139
v_rcp_f16_e64 v154, v153
v_fma_mix_f32 v163, v183, v183, v163 op_sel:[1,1,0] op_sel_hi:[1,1,0]
v_rcp_f16_e64 v151, v150
v_bfe_u32 v140, v141, 2, 14
v_rcp_f16 v148, v147
v_fma_mix_f32 v163, v184, v184, v163 op_sel:[0,0,0] op_sel_hi:[1,1,0]
s_waitcnt lgkmcnt(4)
v_mfma_f32_32x32x16_bf16 v[120:135], v[116:119], v[228:231], v[120:135]
ds_read_b128 v[224:227], v249 offset:16384
ds_read_u16_d16 v140, v140
v_rcp_f16_e64 v145, v144
v_lshrrev_b32 v141, 18, v141
v_rcp_f16_sdwa v154, v153 dst_sel:WORD_1 dst_unused:UNUSED_PRESERVE src0_sel:WORD_1
s_setprio 0
v_rcp_f16_sdwa v151, v150 dst_sel:WORD_1 dst_unused:UNUSED_PRESERVE src0_sel:WORD_1
v_fma_mix_f32 v163, v185, v185, v163 op_sel:[1,1,0] op_sel_hi:[1,1,0]
v_and_b32_e64 v143, s49, v143
v_rcp_f16_sdwa v148, v147 dst_sel:WORD_1 dst_unused:UNUSED_PRESERVE src0_sel:WORD_1
v_smfmac_f32_16x16x32_bf16 v[16:19], v[234:235], v[208:211], v246
ds_read_b128 v[228:231], v249 offset:14336
ds_read_u16_d16_hi v141, v141
v_rcp_f16_sdwa v145, v144 dst_sel:WORD_1 dst_unused:UNUSED_PRESERVE src0_sel:WORD_1
v_pk_mul_f16 v155, v155, v154
v_bfe_u32 v142, v143, 2, 14
v_fma_mix_f32 v163, v186, v186, v163 op_sel:[0,0,0] op_sel_hi:[1,1,0]
v_smfmac_f32_16x16x32_bf16 v[0:3], v[232:233], v[212:215], v246
s_mov_b64 exec, 1
ds_add_u32 v253, v254 offset:16
s_mov_b64 exec, -1
v_pk_mul_f16 v152, v152, v151
v_pk_mul_f16 v149, v149, v148
v_pk_mul_f16 v146, v146, v145
v_fma_mix_f32 v164, v155, v155, v164 op_sel:[0,0,0] op_sel_hi:[1,1,0]
v_lshrrev_b32 v143, 18, v143
v_fma_mix_f32 v164, v155, v155, v164 op_sel:[1,1,0] op_sel_hi:[1,1,0]
v_fma_mix_f32 v164, v152, v152, v164 op_sel:[0,0,0] op_sel_hi:[1,1,0]
v_fma_mix_f32 v163, v187, v187, v163 op_sel:[1,1,0] op_sel_hi:[1,1,0]
v_fma_mix_f32 v164, v152, v152, v164 op_sel:[1,1,0] op_sel_hi:[1,1,0]
v_fma_mix_f32 v164, v149, v149, v164 op_sel:[0,0,0] op_sel_hi:[1,1,0]
v_fma_mix_f32 v164, v149, v149, v164 op_sel:[1,1,0] op_sel_hi:[1,1,0]
v_fma_mix_f32 v164, v146, v146, v164 op_sel:[0,0,0] op_sel_hi:[1,1,0]
v_fma_mix_f32 v164, v146, v146, v164 op_sel:[1,1,0] op_sel_hi:[1,1,0]
s_setprio 3
v_pk_add_f32 v[168:169], v[0:1], v[2:3]
v_pk_mul_f32 v[170:171], v[0:1], v[0:1]
v_pk_fma_f32 v[170:171], v[2:3], v[2:3], v[170:171]
v_pk_add_f32 v[168:169], v[168:169], v[4:5]
v_pk_fma_f32 v[170:171], v[4:5], v[4:5], v[170:171]
v_pk_add_f32 v[168:169], v[168:169], v[6:7]
v_pk_fma_f32 v[170:171], v[6:7], v[6:7], v[170:171]
v_pk_add_f32 v[168:169], v[168:169], v[8:9]
v_pk_fma_f32 v[170:171], v[8:9], v[8:9], v[170:171]
v_pk_add_f32 v[168:169], v[168:169], v[10:11]
v_pk_fma_f32 v[170:171], v[10:11], v[10:11], v[170:171]
v_pk_add_f32 v[168:169], v[168:169], v[12:13]
v_pk_fma_f32 v[170:171], v[12:13], v[12:13], v[170:171]
v_pk_add_f32 v[168:169], v[168:169], v[14:15]
v_pk_fma_f32 v[170:171], v[14:15], v[14:15], v[170:171]
v_pk_add_f32 v[168:169], v[168:169], v[16:17]
v_pk_fma_f32 v[170:171], v[16:17], v[16:17], v[170:171]
v_pk_add_f32 v[168:169], v[168:169], v[18:19]
v_pk_fma_f32 v[170:171], v[18:19], v[18:19], v[170:171]
v_pk_add_f32 v[168:169], v[168:169], v[20:21]
v_pk_fma_f32 v[170:171], v[20:21], v[20:21], v[170:171]
v_pk_add_f32 v[168:169], v[168:169], v[22:23]
v_pk_fma_f32 v[170:171], v[22:23], v[22:23], v[170:171]
v_pk_add_f32 v[168:169], v[168:169], v[24:25]
v_pk_fma_f32 v[170:171], v[24:25], v[24:25], v[170:171]
v_pk_add_f32 v[168:169], v[168:169], v[26:27]
v_pk_fma_f32 v[170:171], v[26:27], v[26:27], v[170:171]
v_pk_add_f32 v[168:169], v[168:169], v[28:29]
v_pk_fma_f32 v[170:171], v[28:29], v[28:29], v[170:171]
v_pk_add_f32 v[168:169], v[168:169], v[30:31]
v_pk_fma_f32 v[170:171], v[30:31], v[30:31], v[170:171]
v_pk_add_f32 v[168:169], v[168:169], v[32:33]
v_pk_fma_f32 v[170:171], v[32:33], v[32:33], v[170:171]
v_pk_add_f32 v[168:169], v[168:169], v[34:35]
v_pk_fma_f32 v[170:171], v[34:35], v[34:35], v[170:171]
v_pk_add_f32 v[168:169], v[168:169], v[36:37]
v_pk_fma_f32 v[170:171], v[36:37], v[36:37], v[170:171]
v_pk_add_f32 v[168:169], v[168:169], v[38:39]
v_pk_fma_f32 v[170:171], v[38:39], v[38:39], v[170:171]
v_pk_add_f32 v[168:169], v[168:169], v[40:41]
v_pk_fma_f32 v[170:171], v[40:41], v[40:41], v[170:171]
v_pk_add_f32 v[168:169], v[168:169], v[42:43]
v_pk_fma_f32 v[170:171], v[42:43], v[42:43], v[170:171]
v_pk_add_f32 v[168:169], v[168:169], v[44:45]
v_pk_fma_f32 v[170:171], v[44:45], v[44:45], v[170:171]
v_pk_add_f32 v[168:169], v[168:169], v[46:47]
v_pk_fma_f32 v[170:171], v[46:47], v[46:47], v[170:171]
s_setprio 0
v_lshrrev_b32 v252, 2, v251
v_mul_u32_u24 v252, 192, v252
v_and_b32 v240, 3, v251
v_lshl_add_u32 v252, v240, 4, v252
s_setprio 2
v_cvt_pkrtz_f16_f32 v179, v120, v121
v_cvt_pkrtz_f16_f32 v181, v122, v123
v_cvt_pkrtz_f16_f32 v183, v124, v125
v_cvt_pkrtz_f16_f32 v185, v126, v127
v_cvt_pkrtz_f16_f32 v187, v128, v129
v_cvt_pk_f16_f32 v155, v130, v131
v_cvt_pk_f16_f32 v152, v132, v133
v_cvt_pk_f16_f32 v149, v134, v135
ds_read_b128 v[232:235], v249 offset:17408
ds_read_u16_d16 v142, v142
ds_read_u16_d16_hi v143, v143
v_mfma_f32_32x32x16_bf16 v[120:135], v[236:239], v[96:99], 0
v_pk_fma_f16 v154, v155, v155, s48
v_add_f32 v168, v168, v169
v_and_b32 v179, s49, v179
v_fma_mix_f32 v164, v136, v136, v164 op_sel:[0,0,0] op_sel_hi:[1,1,0]
v_pk_fma_f16 v151, v152, v152, s48
v_bfe_u32 v178, v179, 2, 14
v_pk_fma_f16 v148, v149, v149, s48
v_add_f32_e64 v170, v170, v171
v_pk_mul_f16 v154, v155, v154
v_lshrrev_b32_e64 v179, 18, v179
v_fma_mix_f32 v164, v137, v137, v164 op_sel:[1,1,0] op_sel_hi:[1,1,0]
v_pk_mul_f16 v151, v152, v151
v_and_b32 v181, s49, v181
s_waitcnt lgkmcnt(4)
ds_read_u16_d16 v178, v178
ds_read_u16_d16_hi v179, v179
v_mfma_f32_32x32x16_bf16 v[120:135], v[216:219], v[100:103], v[120:135]
v_permlane32_swap_b32 v168, v170
v_pk_mul_f16 v148, v149, v148
v_exp_f16 v153, v154
v_bfe_u32 v180, v181, 2, 14
v_fma_mix_f32 v164, v138, v138, v164 op_sel:[0,0,0] op_sel_hi:[1,1,0]
v_exp_f16 v150, v151
v_add_f32 v168, v168, v170
v_lshrrev_b32_e64 v181, 18, v181
v_fma_mix_f32 v164, v139, v139, v164 op_sel:[1,1,0] op_sel_hi:[1,1,0]
v_and_b32 v183, s49, v183
v_exp_f16 v147, v148
ds_read_u16_d16 v180, v180
ds_read_u16_d16_hi v181, v181
v_mfma_f32_32x32x16_bf16 v[120:135], v[220:223], v[104:107], v[120:135]
v_mul_f32 v168, 1009429163, v168
v_bfe_u32 v182, v183, 2, 14
v_exp_f16_sdwa v153, v154 dst_sel:WORD_1 dst_unused:UNUSED_PRESERVE src0_sel:WORD_1
v_lshrrev_b32 v183, 18, v183
v_mov_b32 v170, v168
v_fma_mix_f32 v164, v140, v140, v164 op_sel:[0,0,0] op_sel_hi:[1,1,0]
v_exp_f16_sdwa v150, v151 dst_sel:WORD_1 dst_unused:UNUSED_PRESERVE src0_sel:WORD_1
v_and_b32 v185, s49, v185
v_fma_mix_f32 v164, v141, v141, v164 op_sel:[1,1,0] op_sel_hi:[1,1,0]
v_exp_f16_sdwa v147, v148 dst_sel:WORD_1 dst_unused:UNUSED_PRESERVE src0_sel:WORD_1
v_permlane32_swap_b32 v168, v170
ds_read_u16_d16 v182, v182
ds_read_u16_d16_hi v183, v183
v_mfma_f32_32x32x16_bf16 v[120:135], v[224:227], v[108:111], v[120:135]
v_bfe_u32 v184, v185, 2, 14
v_pk_add_f16 v153, v153, 1.0 op_sel_hi:[1,0]
v_lshrrev_b32 v185, 18, v185
s_waitcnt lgkmcnt(4)
v_fma_mix_f32 v164, v142, v142, v164 op_sel:[0,0,0] op_sel_hi:[1,1,0]
v_fma_f32 v170, -v168, v168, v170
v_pk_add_f16 v150, v150, 1.0 op_sel_hi:[1,0]
v_and_b32_e64 v187, s49, v187
v_pk_add_f16 v147, v147, 1.0 op_sel_hi:[1,0]
v_rcp_f16 v154, v153
v_max_f32 v170, 0, v170
v_bfe_u32 v186, v187, 2, 14
v_fma_mix_f32 v164, v143, v143, v164 op_sel:[1,1,0] op_sel_hi:[1,1,0]
v_lshrrev_b32_e64 v187, 18, v187
ds_read_b128 v[224:227], v249 offset:18432
ds_read_u16_d16 v184, v184
ds_read_u16_d16_hi v185, v185
ds_read_u16_d16 v186, v186
ds_read_u16_d16_hi v187, v187
v_mfma_f32_32x32x16_bf16 v[120:135], v[228:231], v[112:115], v[120:135]
v_rcp_f16 v151, v150
v_rcp_f16 v148, v147
v_add_f32 v170, 925353388, v170
v_rcp_f16_sdwa v154, v153 dst_sel:WORD_1 dst_unused:UNUSED_PRESERVE src0_sel:WORD_1
v_fma_mix_f32 v165, v178, v178, v165 op_sel:[0,0,0] op_sel_hi:[1,1,0]
v_fma_mix_f32 v165, v179, v179, v165 op_sel:[1,1,0] op_sel_hi:[1,1,0]
v_rsq_f32 v170, v170
v_rcp_f16_sdwa v151, v150 dst_sel:WORD_1 dst_unused:UNUSED_PRESERVE src0_sel:WORD_1
s_waitcnt lgkmcnt(5)
v_fma_mix_f32 v165, v180, v180, v165 op_sel:[0,0,0] op_sel_hi:[1,1,0]
ds_read_b128 v[228:231], v249 offset:21504
ds_read_b32 v247, v253 offset:16
v_mfma_f32_32x32x16_bf16 v[120:135], v[232:235], v[116:119], v[120:135]
v_rcp_f16_sdwa v148, v147 dst_sel:WORD_1 dst_unused:UNUSED_PRESERVE src0_sel:WORD_1
v_fma_mix_f32 v165, v181, v181, v165 op_sel:[1,1,0] op_sel_hi:[1,1,0]
v_pk_mul_f16 v155, v155, v154
v_fma_mix_f32 v165, v182, v182, v165 op_sel:[0,0,0] op_sel_hi:[1,1,0]
v_pk_mul_f16 v152, v152, v151
v_fma_mix_f32 v165, v183, v183, v165 op_sel:[1,1,0] op_sel_hi:[1,1,0]
v_pk_mul_f16 v149, v149, v148
v_mul_f32 v172, 3203391086, v170
v_fma_mix_f32 v165, v155, v155, v165 op_sel:[0,0,0] op_sel_hi:[1,1,0]
s_waitcnt lgkmcnt(3)
v_fma_mix_f32 v165, v184, v184, v165 op_sel:[0,0,0] op_sel_hi:[1,1,0]
v_fma_mix_f32 v165, v155, v155, v165 op_sel:[1,1,0] op_sel_hi:[1,1,0]
v_fma_mix_f32 v165, v185, v185, v165 op_sel:[1,1,0] op_sel_hi:[1,1,0]
v_fma_mix_f32 v165, v152, v152, v165 op_sel:[0,0,0] op_sel_hi:[1,1,0]
v_mul_f32 v173, v168, v172
v_fma_mix_f32 v165, v152, v152, v165 op_sel:[1,1,0] op_sel_hi:[1,1,0]
v_fma_mix_f32 v165, v186, v186, v165 op_sel:[0,0,0] op_sel_hi:[1,1,0]
v_fma_mix_f32 v165, v149, v149, v165 op_sel:[0,0,0] op_sel_hi:[1,1,0]
s_waitcnt lgkmcnt(2)
v_fma_mix_f32 v165, v187, v187, v165 op_sel:[1,1,0] op_sel_hi:[1,1,0]
v_fma_mix_f32 v165, v149, v149, v165 op_sel:[1,1,0] op_sel_hi:[1,1,0]
s_setprio 3
v_pk_fma_f32 v[0:1], v[0:1], v[172:173], v[172:173] op_sel:[0,0,1] op_sel_hi:[1,0,1] neg_lo:[0,0,1] neg_hi:[0,0,1]
v_pk_fma_f32 v[2:3], v[2:3], v[172:173], v[172:173] op_sel:[0,0,1] op_sel_hi:[1,0,1] neg_lo:[0,0,1] neg_hi:[0,0,1]
v_pk_fma_f32 v[4:5], v[4:5], v[172:173], v[172:173] op_sel:[0,0,1] op_sel_hi:[1,0,1] neg_lo:[0,0,1] neg_hi:[0,0,1]
v_pk_fma_f32 v[6:7], v[6:7], v[172:173], v[172:173] op_sel:[0,0,1] op_sel_hi:[1,0,1] neg_lo:[0,0,1] neg_hi:[0,0,1]
v_pk_fma_f32 v[8:9], v[8:9], v[172:173], v[172:173] op_sel:[0,0,1] op_sel_hi:[1,0,1] neg_lo:[0,0,1] neg_hi:[0,0,1]
v_pk_fma_f32 v[10:11], v[10:11], v[172:173], v[172:173] op_sel:[0,0,1] op_sel_hi:[1,0,1] neg_lo:[0,0,1] neg_hi:[0,0,1]
v_pk_fma_f32 v[12:13], v[12:13], v[172:173], v[172:173] op_sel:[0,0,1] op_sel_hi:[1,0,1] neg_lo:[0,0,1] neg_hi:[0,0,1]
v_pk_fma_f32 v[14:15], v[14:15], v[172:173], v[172:173] op_sel:[0,0,1] op_sel_hi:[1,0,1] neg_lo:[0,0,1] neg_hi:[0,0,1]
v_pk_fma_f32 v[16:17], v[16:17], v[172:173], v[172:173] op_sel:[0,0,1] op_sel_hi:[1,0,1] neg_lo:[0,0,1] neg_hi:[0,0,1]
v_pk_fma_f32 v[18:19], v[18:19], v[172:173], v[172:173] op_sel:[0,0,1] op_sel_hi:[1,0,1] neg_lo:[0,0,1] neg_hi:[0,0,1]
v_pk_fma_f32 v[20:21], v[20:21], v[172:173], v[172:173] op_sel:[0,0,1] op_sel_hi:[1,0,1] neg_lo:[0,0,1] neg_hi:[0,0,1]
v_pk_fma_f32 v[22:23], v[22:23], v[172:173], v[172:173] op_sel:[0,0,1] op_sel_hi:[1,0,1] neg_lo:[0,0,1] neg_hi:[0,0,1]
v_pk_fma_f32 v[24:25], v[24:25], v[172:173], v[172:173] op_sel:[0,0,1] op_sel_hi:[1,0,1] neg_lo:[0,0,1] neg_hi:[0,0,1]
v_pk_fma_f32 v[26:27], v[26:27], v[172:173], v[172:173] op_sel:[0,0,1] op_sel_hi:[1,0,1] neg_lo:[0,0,1] neg_hi:[0,0,1]
v_pk_fma_f32 v[28:29], v[28:29], v[172:173], v[172:173] op_sel:[0,0,1] op_sel_hi:[1,0,1] neg_lo:[0,0,1] neg_hi:[0,0,1]
v_pk_fma_f32 v[30:31], v[30:31], v[172:173], v[172:173] op_sel:[0,0,1] op_sel_hi:[1,0,1] neg_lo:[0,0,1] neg_hi:[0,0,1]
v_pk_fma_f32 v[32:33], v[32:33], v[172:173], v[172:173] op_sel:[0,0,1] op_sel_hi:[1,0,1] neg_lo:[0,0,1] neg_hi:[0,0,1]
v_pk_fma_f32 v[34:35], v[34:35], v[172:173], v[172:173] op_sel:[0,0,1] op_sel_hi:[1,0,1] neg_lo:[0,0,1] neg_hi:[0,0,1]
v_pk_fma_f32 v[36:37], v[36:37], v[172:173], v[172:173] op_sel:[0,0,1] op_sel_hi:[1,0,1] neg_lo:[0,0,1] neg_hi:[0,0,1]
v_pk_fma_f32 v[38:39], v[38:39], v[172:173], v[172:173] op_sel:[0,0,1] op_sel_hi:[1,0,1] neg_lo:[0,0,1] neg_hi:[0,0,1]
v_pk_fma_f32 v[40:41], v[40:41], v[172:173], v[172:173] op_sel:[0,0,1] op_sel_hi:[1,0,1] neg_lo:[0,0,1] neg_hi:[0,0,1]
v_pk_fma_f32 v[42:43], v[42:43], v[172:173], v[172:173] op_sel:[0,0,1] op_sel_hi:[1,0,1] neg_lo:[0,0,1] neg_hi:[0,0,1]
v_pk_fma_f32 v[44:45], v[44:45], v[172:173], v[172:173] op_sel:[0,0,1] op_sel_hi:[1,0,1] neg_lo:[0,0,1] neg_hi:[0,0,1]
v_pk_fma_f32 v[46:47], v[46:47], v[172:173], v[172:173] op_sel:[0,0,1] op_sel_hi:[1,0,1] neg_lo:[0,0,1] neg_hi:[0,0,1]
s_setprio 2
s_waitcnt lgkmcnt(0)
v_readfirstlane_b32 s43, v247
s_nop 1
s_cmp_ge_u32 s43, 32
s_cbranch_scc1 Lev9
Lev9w:
s_sleep 1
ds_read_b32 v247, v253 offset:16
s_waitcnt lgkmcnt(0)
v_readfirstlane_b32 s43, v247
s_cmp_eq_u32 s76, 0
s_cbranch_scc1 Lev9
s_sub_u32 s76, s76, 1
s_cmp_lt_u32 s43, 32
s_cbranch_scc1 Lev9w
Lev9:
s_setprio 1
v_cvt_pkrtz_f16_f32 v137, v120, v121
v_cvt_pkrtz_f16_f32 v139, v122, v123
v_cvt_pkrtz_f16_f32 v141, v124, v125
v_cvt_pkrtz_f16_f32 v143, v126, v127
v_cvt_pkrtz_f16_f32 v145, v128, v129
v_cvt_pk_f16_f32 v155, v130, v131
v_cvt_pk_f16_f32 v152, v132, v133
v_cvt_pk_f16_f32 v149, v134, v135
s_add_u32 m0, s72, 0
s_add_u32 s43, s82, 0
buffer_load_dwordx4 v252, s[16:19], s43 offen lds
ds_read_b128 v[232:235], v249 offset:19456
ds_read_b128 v[236:239], v249 offset:22528
v_mfma_f32_32x32x16_bf16 v[120:135], v[224:227], v[96:99], 0
v_pk_fma_f16 v154, v155, v155, s48
v_and_b32 v192, 1, v251
v_cvt_pk_bf16_f32 v168, v0, v1
v_and_b32_e64 v137, s49, v137
v_pk_fma_f16 v151, v152, v152, s48
v_cvt_pk_bf16_f32 v169, v2, v3
v_lshlrev_b32 v192, 4, v192
v_and_b32 v139, s49, v139
v_pk_fma_f16 v148, v149, v149, s48
v_cvt_pk_bf16_f32 v170, v4, v5
v_pk_mul_f16 v154, v155, v154
v_mov_b32 v193, 15360
v_bfe_u32 v136, v137, 2, 14
v_pk_mul_f16 v151, v152, v151
v_cvt_pk_bf16_f32 v171, v6, v7
ds_read_b128 v[224:227], v249 offset:20480
ds_read_u16_d16 v136, v136
v_mfma_f32_32x32x16_bf16 v[120:135], v[228:231], v[100:103], v[120:135]
v_pk_mul_f16 v148, v149, v148
v_lshlrev_b32_e64 v192, v192, v193
v_bfe_u32 v138, v139, 2, 14
v_cvt_pk_bf16_f32 v172, v8, v9
v_exp_f16 v153, v154
v_lshrrev_b32 v193, 3, v251
v_cvt_pk_bf16_f32 v173, v10, v11
v_lshrrev_b32_e64 v137, 18, v137
v_exp_f16 v150, v151
v_xor_b32 v193, v193, v251
v_cvt_pk_bf16_f32 v174, v12, v13
v_lshrrev_b32 v139, 18, v139
v_exp_f16 v147, v148
s_waitcnt lgkmcnt(2)
s_add_u32 m0, s72, 1024
s_add_u32 s43, s82, 64
buffer_load_dwordx4 v252, s[16:19], s43 offen lds
ds_read_b128 v[228:231], v249 offset:23552
ds_read_u16_d16 v138, v138
ds_read_u16_d16_hi v137, v137
ds_read_u16_d16_hi v139, v139
v_mfma_f32_32x32x16_bf16 v[120:135], v[232:235], v[104:107], v[120:135]
v_and_b32_e64 v193, 4, v193
v_cvt_pk_bf16_f32 v175, v14, v15
v_and_b32_e64 v141, s49, v141
v_cvt_pk_bf16_f32 v176, v16, v17
v_and_b32_e64 v143, s49, v143
v_bfe_u32 v194, v251, 3, 2
v_exp_f16_sdwa v153, v154 dst_sel:WORD_1 dst_unused:UNUSED_PRESERVE src0_sel:WORD_1
v_cvt_pk_bf16_f32 v177, v18, v19
v_bfe_u32 v140, v141, 2, 14
v_lshl_add_u32 v193, v193, 1, 0
v_exp_f16_sdwa v150, v151 dst_sel:WORD_1 dst_unused:UNUSED_PRESERVE src0_sel:WORD_1
v_cvt_pk_bf16_f32 v178, v20, v21
v_bfe_u32 v142, v143, 2, 14
ds_read_b128 v[232:235], v248 offset:16384
ds_read_u16_d16 v140, v140
ds_read_u16_d16 v142, v142
v_mfma_f32_32x32x16_bf16 v[120:135], v[236:239], v[108:111], v[120:135]
v_lshl_add_u32 v193, v194, 1, v193
v_cvt_pk_bf16_f32 v179, v22, v23
v_exp_f16_sdwa v147, v148 dst_sel:WORD_1 dst_unused:UNUSED_PRESERVE src0_sel:WORD_1
v_lshrrev_b32_e64 v141, 18, v141
v_bfe_u32 v194, v251, 1, 1
v_cvt_pk_bf16_f32 v180, v24, v25
v_pk_add_f16 v153, v153, 1.0 op_sel_hi:[1,0]
v_lshrrev_b32_e64 v143, 18, v143
v_cvt_pk_bf16_f32 v181, v26, v27
v_add_u32_e64 v193, v193, v194
v_pk_add_f16 v150, v150, 1.0 op_sel_hi:[1,0]
v_pk_add_f16 v147, v147, 1.0 op_sel_hi:[1,0]
v_cvt_pk_bf16_f32 v182, v28, v29
v_and_b32_e64 v145, s49, v145
v_cmp_eq_u32 vcc, 0, v193
s_nop 1
v_cndmask_b32 v240, 0, v192, vcc
s_waitcnt lgkmcnt(3)
s_add_u32 m0, s72, 2048
s_add_u32 s43, s82, 128
buffer_load_dwordx4 v252, s[16:19], s43 offen lds
ds_read_b128 v[236:239], v248 offset:19456
ds_read_u16_d16_hi v141, v141
ds_read_u16_d16_hi v143, v143
v_mfma_f32_32x32x16_bf16 v[120:135], v[224:227], v[112:115], v[120:135]
v_rcp_f16_e64 v154, v153
v_cvt_pk_bf16_f32 v183, v30, v31
v_bfe_u32 v144, v145, 2, 14
v_cmp_eq_u32 vcc, 1, v193
s_nop 1
v_cndmask_b32 v241, 0, v192, vcc
v_rcp_f16_e64 v151, v150
s_setprio 0
v_cvt_pk_bf16_f32 v184, v32, v33
v_lshrrev_b32 v145, 18, v145
v_cmp_eq_u32 vcc, 2, v193
s_nop 1
v_cndmask_b32 v242, 0, v192, vcc
v_cvt_pk_bf16_f32 v185, v34, v35
v_rcp_f16_e64 v148, v147
v_or_b32 v208, v136, v137
v_cmp_eq_u32 vcc, 3, v193
s_nop 1
v_cndmask_b32 v243, 0, v192, vcc
v_cvt_pk_bf16_f32 v186, v36, v37
ds_read_b128 v[224:227], v248 offset:17408
ds_read_u16_d16 v144, v144
ds_read_u16_d16_hi v145, v145
v_mfma_f32_32x32x16_bf16 v[120:135], v[228:231], v[116:119], v[120:135]
v_or_b32 v209, v138, v139
v_rcp_f16_sdwa v154, v153 dst_sel:WORD_1 dst_unused:UNUSED_PRESERVE src0_sel:WORD_1
v_cmp_eq_u32 vcc, 4, v193
s_nop 1
v_cndmask_b32 v244, 0, v192, vcc
v_cvt_pk_bf16_f32 v187, v38, v39
s_waitcnt lgkmcnt(3)
v_or_b32 v210, v140, v141
v_cvt_pk_bf16_f32 v188, v40, v41
v_rcp_f16_sdwa v151, v150 dst_sel:WORD_1 dst_unused:UNUSED_PRESERVE src0_sel:WORD_1
v_cmp_eq_u32 vcc, 5, v193
s_nop 1
v_cndmask_b32 v245, 0, v192, vcc
v_or_b32 v211, v142, v143
v_cvt_pk_bf16_f32 v189, v42, v43
v_rcp_f16_sdwa v148, v147 dst_sel:WORD_1 dst_unused:UNUSED_PRESERVE src0_sel:WORD_1
v_cmp_eq_u32 vcc, 6, v193
s_nop 1
v_cndmask_b32 v246, 0, v192, vcc
v_cvt_pk_bf16_f32 v190, v44, v45
s_waitcnt lgkmcnt(0)
v_or_b32_e64 v212, v144, v145
v_pk_mul_f16 v213, v155, v154
v_cmp_eq_u32 vcc, 7, v193
s_nop 1
v_cndmask_b32 v247, 0, v192, vcc
v_cvt_pk_bf16_f32 v191, v46, v47
v_pk_mul_f16 v214, v152, v151
v_pk_mul_f16 v215, v149, v148
s_setprio 2
s_add_u32 m0, s72, 3072
s_add_u32 s43, s82, 3072
buffer_load_dwordx4 v252, s[16:19], s43 offen lds
ds_read_b128 v[228:231], v248 offset:20480
v_mfma_f32_32x32x16_f16 v[192:207], v[208:211], v[240:243], 0
v_cvt_pkrtz_f16_f32 v137, v120, v121
v_cvt_pkrtz_f16_f32 v139, v122, v123
v_cvt_pkrtz_f16_f32 v141, v124, v125
v_cvt_pkrtz_f16_f32 v143, v126, v127
v_cvt_pkrtz_f16_f32 v145, v128, v129
v_mfma_f32_32x32x16_f16 v[192:207], v[212:215], v[244:247], v[192:207]
v_cvt_pk_f16_f32 v155, v130, v131
v_cvt_pk_f16_f32 v152, v132, v133
v_cvt_pk_f16_f32 v149, v134, v135
v_pk_fma_f16 v154, v155, v155, s48
v_and_b32_e64 v137, s49, v137
v_mfma_f32_32x32x16_bf16 v[120:135], v[232:235], v[168:171], 0
v_pk_fma_f16 v151, v152, v152, s48
v_and_b32_e64 v139, s49, v139
v_pk_fma_f16 v148, v149, v149, s48
v_pk_mul_f16 v154, v155, v154
v_bfe_u32 v136, v137, 2, 14
v_pk_mul_f16 v151, v152, v151
v_pk_mul_f16 v148, v149, v148
v_bfe_u32 v138, v139, 2, 14
v_fmac_f32 v166, v192, v192
v_exp_f16 v153, v154
s_add_u32 m0, s72, 4096
s_add_u32 s43, s82, 3136
buffer_load_dwordx4 v252, s[16:19], s43 offen lds
ds_read_b128 v[232:235], v248 offset:18432
ds_read_u16_d16 v136, v136
ds_read_u16_d16 v138, v138
v_mfma_f32_32x32x16_bf16 v[120:135], v[236:239], v[172:175], v[120:135]
v_fmac_f32 v166, v193, v193
v_lshrrev_b32 v137, 18, v137
v_exp_f16 v150, v151
v_fmac_f32 v166, v194, v194
v_lshrrev_b32 v139, 18, v139
v_exp_f16 v147, v148
v_fmac_f32 v166, v195, v195
v_and_b32 v141, s49, v141
ds_read_b128 v[236:239], v248 offset:21504
ds_read_u16_d16_hi v137, v137
ds_read_u16_d16_hi v139, v139
v_mfma_f32_32x32x16_bf16 v[120:135], v[224:227], v[176:179], v[120:135]
v_and_b32_e64 v143, s49, v143
v_exp_f16_sdwa v153, v154 dst_sel:WORD_1 dst_unused:UNUSED_PRESERVE src0_sel:WORD_1
v_fmac_f32_e64 v166, v196, v196
v_bfe_u32 v140, v141, 2, 14
v_exp_f16_sdwa v150, v151 dst_sel:WORD_1 dst_unused:UNUSED_PRESERVE src0_sel:WORD_1
v_fmac_f32 v166, v197, v197
v_bfe_u32 v142, v143, 2, 14
v_exp_f16_sdwa v147, v148 dst_sel:WORD_1 dst_unused:UNUSED_PRESERVE src0_sel:WORD_1
s_waitcnt lgkmcnt(6)
ds_read_b128 v[224:227], v248 offset:22528
ds_read_u16_d16 v140, v140
ds_read_u16_d16 v142, v142
v_mfma_f32_32x32x16_bf16 v[120:135], v[228:231], v[180:183], v[120:135]
v_fmac_f32 v166, v198, v198
v_lshrrev_b32 v141, 18, v141
v_pk_add_f16 v153, v153, 1.0 op_sel_hi:[1,0]
v_fmac_f32 v166, v199, v199
v_lshrrev_b32 v143, 18, v143
v_pk_add_f16 v150, v150, 1.0 op_sel_hi:[1,0]
v_pk_add_f16 v147, v147, 1.0 op_sel_hi:[1,0]
v_fmac_f32_e64 v166, v200, v200
v_and_b32 v145, s49, v145
s_waitcnt lgkmcnt(4)
s_add_u32 m0, s72, 5120
s_add_u32 s43, s82, 3200
buffer_load_dwordx4 v252, s[16:19], s43 offen lds
ds_read_b128 v[228:231], v248 offset:25600
ds_read_u16_d16_hi v141, v141
ds_read_u16_d16_hi v143, v143
v_mfma_f32_32x32x16_bf16 v[120:135], v[232:235], v[184:187], v[120:135]
v_rcp_f16 v154, v153
v_fmac_f32 v166, v201, v201
v_bfe_u32 v144, v145, 2, 14
v_rcp_f16 v151, v150
v_fmac_f32 v166, v202, v202
v_lshrrev_b32 v145, 18, v145
v_rcp_f16 v148, v147
v_fmac_f32 v166, v203, v203
v_or_b32 v216, v136, v137
ds_read_b128 v[232:235], v248 offset:23552
ds_read_u16_d16 v144, v144
ds_read_u16_d16_hi v145, v145
v_mfma_f32_32x32x16_bf16 v[120:135], v[236:239], v[188:191], v[120:135]
s_waitcnt lgkmcnt(6)
v_or_b32 v217, v138, v139
v_rcp_f16_sdwa v154, v153 dst_sel:WORD_1 dst_unused:UNUSED_PRESERVE src0_sel:WORD_1
v_fmac_f32 v166, v204, v204
s_waitcnt lgkmcnt(4)
v_or_b32_e64 v218, v140, v141
v_rcp_f16_sdwa v151, v150 dst_sel:WORD_1 dst_unused:UNUSED_PRESERVE src0_sel:WORD_1
v_fmac_f32 v166, v205, v205
s_waitcnt lgkmcnt(3)
v_or_b32_e64 v219, v142, v143
v_rcp_f16_sdwa v148, v147 dst_sel:WORD_1 dst_unused:UNUSED_PRESERVE src0_sel:WORD_1
v_fmac_f32 v166, v206, v206
s_waitcnt lgkmcnt(0)
v_or_b32_e64 v220, v144, v145
v_pk_mul_f16 v221, v155, v154
v_fmac_f32_e64 v166, v207, v207
v_pk_mul_f16 v222, v152, v151
v_pk_mul_f16 v223, v149, v148
s_cmp_lg_u32 s40, 0
s_cbranch_scc1 Lrs0
v_mov_b32 v90, 0
buffer_load_dword v91, v90, s[36:39], 0 offen sc1
Lrs0:
s_setprio 1
s_add_u32 m0, s72, 6144
s_add_u32 s43, s82, 6144
buffer_load_dwordx4 v252, s[16:19], s43 offen lds
ds_read_b128 v[236:239], v248 offset:26624
v_mfma_f32_32x32x16_f16 v[192:207], v[216:219], v[240:243], 0
v_cvt_pkrtz_f16_f32 v137, v120, v121
v_cvt_pkrtz_f16_f32 v139, v122, v123
v_cvt_pkrtz_f16_f32 v141, v124, v125
v_cvt_pkrtz_f16_f32 v143, v126, v127
v_cvt_pkrtz_f16_f32 v145, v128, v129
v_mfma_f32_32x32x16_f16 v[192:207], v[220:223], v[244:247], v[192:207]
v_cvt_pk_f16_f32 v155, v130, v131
v_cvt_pk_f16_f32 v152, v132, v133
v_cvt_pk_f16_f32 v149, v134, v135
v_pk_fma_f16 v154, v155, v155, s48
v_and_b32 v255, 51, v251
v_and_b32 v137, s49, v137
v_mfma_f32_32x32x16_bf16 v[120:135], v[224:227], v[168:171], 0
v_pk_fma_f16 v151, v152, v152, s48
v_and_b32_e64 v139, s49, v139
v_pk_fma_f16 v148, v149, v149, s48
v_pk_mul_f16 v154, v155, v154
v_bfe_u32 v136, v137, 2, 14
v_pk_mul_f16 v151, v152, v151
v_pk_mul_f16 v148, v149, v148
v_bfe_u32 v138, v139, 2, 14
v_fmac_f32 v167, v192, v192
v_exp_f16 v153, v154
ds_read_b128 v[224:227], v248 offset:24576
ds_read_u16_d16 v136, v136
ds_read_u16_d16 v138, v138
v_mfma_f32_32x32x16_bf16 v[120:135], v[228:231], v[172:175], v[120:135]
v_bfe_u32 v95, v251, 2, 1
v_fmac_f32 v167, v193, v193
v_lshrrev_b32 v137, 18, v137
v_exp_f16 v150, v151
v_fmac_f32 v167, v194, v194
v_lshrrev_b32 v139, 18, v139
v_exp_f16 v147, v148
v_fmac_f32 v167, v195, v195
v_and_b32 v141, s49, v141
v_and_b32_e64 v143, s49, v143
ds_read_b128 v[228:231], v248 offset:27648
ds_read_u16_d16_hi v137, v137
ds_read_u16_d16_hi v139, v139
v_mfma_f32_32x32x16_bf16 v[120:135], v[232:235], v[176:179], v[120:135]
v_exp_f16_sdwa v153, v154 dst_sel:WORD_1 dst_unused:UNUSED_PRESERVE src0_sel:WORD_1
v_lshl_add_u32 v255, v95, 3, v255
v_fmac_f32_e64 v167, v196, v196
v_bfe_u32 v140, v141, 2, 14
v_exp_f16_sdwa v150, v151 dst_sel:WORD_1 dst_unused:UNUSED_PRESERVE src0_sel:WORD_1
v_fmac_f32 v167, v197, v197
v_bfe_u32 v142, v143, 2, 14
v_exp_f16_sdwa v147, v148 dst_sel:WORD_1 dst_unused:UNUSED_PRESERVE src0_sel:WORD_1
s_waitcnt lgkmcnt(4)
ds_read_b128 v[232:235], v248 offset:28672
ds_read_u16_d16 v140, v140
ds_read_u16_d16 v142, v142
v_mfma_f32_32x32x16_bf16 v[120:135], v[236:239], v[180:183], v[120:135]
v_fmac_f32 v167, v198, v198
v_lshrrev_b32 v141, 18, v141
v_pk_add_f16 v153, v153, 1.0 op_sel_hi:[1,0]
v_bfe_u32 v95, v251, 3, 1
v_fmac_f32 v167, v199, v199
v_lshrrev_b32 v143, 18, v143
v_pk_add_f16 v150, v150, 1.0 op_sel_hi:[1,0]
v_pk_add_f16 v147, v147, 1.0 op_sel_hi:[1,0]
v_fmac_f32 v167, v200, v200
v_and_b32 v145, s49, v145
v_rcp_f16_e64 v154, v153
ds_read_b128 v[236:239], v248 offset:31744
ds_read_u16_d16_hi v141, v141
ds_read_u16_d16_hi v143, v143
v_mfma_f32_32x32x16_bf16 v[120:135], v[224:227], v[184:187], v[120:135]
v_fmac_f32_e64 v167, v201, v201
v_bfe_u32 v144, v145, 2, 14
v_rcp_f16 v151, v150
s_setprio 0
v_lshl_add_u32 v255, v95, 2, v255
v_fmac_f32 v167, v202, v202
v_lshrrev_b32 v145, 18, v145
v_rcp_f16 v148, v147
v_fmac_f32 v167, v203, v203
s_waitcnt lgkmcnt(3)
v_or_b32 v0, v136, v137
ds_read_b128 v[224:227], v248 offset:29696
ds_read_u16_d16 v144, v144
ds_read_u16_d16_hi v145, v145
v_mfma_f32_32x32x16_bf16 v[120:135], v[228:231], v[188:191], v[120:135]
v_or_b32_e64 v1, v138, v139
v_rcp_f16_sdwa v154, v153 dst_sel:WORD_1 dst_unused:UNUSED_PRESERVE src0_sel:WORD_1
v_fmac_f32 v167, v204, v204
s_waitcnt lgkmcnt(4)
v_or_b32_e64 v2, v140, v141
v_rcp_f16_sdwa v151, v150 dst_sel:WORD_1 dst_unused:UNUSED_PRESERVE src0_sel:WORD_1
v_lshl_add_u32 v255, v255, 2, s72
v_fmac_f32 v167, v205, v205
s_waitcnt lgkmcnt(3)
v_or_b32_e64 v3, v142, v143
v_rcp_f16_sdwa v148, v147 dst_sel:WORD_1 dst_unused:UNUSED_PRESERVE src0_sel:WORD_1
v_fmac_f32 v167, v206, v206
s_waitcnt lgkmcnt(0)
v_or_b32_e64 v4, v144, v145
v_pk_mul_f16 v5, v155, v154
v_fmac_f32 v167, v207, v207
v_pk_mul_f16 v6, v152, v151
v_pk_mul_f16 v7, v149, v148
s_setprio 2
ds_read_b128 v[228:231], v248 offset:32768
v_mfma_f32_32x32x16_f16 v[192:207], v[0:3], v[240:243], 0
v_cvt_pkrtz_f16_f32 v137, v120, v121
v_cvt_pkrtz_f16_f32 v139, v122, v123
v_cvt_pkrtz_f16_f32 v141, v124, v125
v_cvt_pkrtz_f16_f32 v143, v126, v127
v_cvt_pkrtz_f16_f32 v145, v128, v129
v_mfma_f32_32x32x16_f16 v[192:207], v[4:7], v[244:247], v[192:207]
v_cvt_pk_f16_f32 v155, v130, v131
v_cvt_pk_f16_f32 v152, v132, v133
v_cvt_pk_f16_f32 v149, v134, v135
v_pk_fma_f16 v154, v155, v155, s48
v_and_b32_e64 v137, s49, v137
v_mfma_f32_32x32x16_bf16 v[120:135], v[232:235], v[168:171], 0
v_pk_fma_f16 v151, v152, v152, s48
v_and_b32_e64 v139, s49, v139
v_pk_fma_f16 v148, v149, v149, s48
v_pk_mul_f16 v154, v155, v154
v_bfe_u32 v136, v137, 2, 14
v_pk_mul_f16 v151, v152, v151
v_pk_mul_f16 v148, v149, v148
v_bfe_u32 v138, v139, 2, 14
v_fmac_f32 v156, v192, v192
v_exp_f16 v153, v154
ds_read_b128 v[232:235], v248 offset:30720
ds_read_u16_d16 v136, v136
ds_read_u16_d16 v138, v138
v_mfma_f32_32x32x16_bf16 v[120:135], v[236:239], v[172:175], v[120:135]
v_fmac_f32 v156, v193, v193
v_lshrrev_b32 v137, 18, v137
v_exp_f16 v150, v151
v_fmac_f32 v156, v194, v194
v_lshrrev_b32 v139, 18, v139
v_exp_f16 v147, v148
v_fmac_f32 v156, v195, v195
v_and_b32 v141, s49, v141
ds_read_b128 v[236:239], v248 offset:33792
ds_read_u16_d16_hi v137, v137
ds_read_u16_d16_hi v139, v139
v_mfma_f32_32x32x16_bf16 v[120:135], v[224:227], v[176:179], v[120:135]
v_and_b32_e64 v143, s49, v143
v_exp_f16_sdwa v153, v154 dst_sel:WORD_1 dst_unused:UNUSED_PRESERVE src0_sel:WORD_1
v_fmac_f32_e64 v156, v196, v196
v_bfe_u32 v140, v141, 2, 14
v_exp_f16_sdwa v150, v151 dst_sel:WORD_1 dst_unused:UNUSED_PRESERVE src0_sel:WORD_1
v_fmac_f32 v156, v197, v197
v_bfe_u32 v142, v143, 2, 14
v_exp_f16_sdwa v147, v148 dst_sel:WORD_1 dst_unused:UNUSED_PRESERVE src0_sel:WORD_1
s_waitcnt lgkmcnt(6)
ds_read_b128 v[224:227], v248 offset:34816
ds_read_u16_d16 v140, v140
ds_read_u16_d16 v142, v142
v_mfma_f32_32x32x16_bf16 v[120:135], v[228:231], v[180:183], v[120:135]
v_fmac_f32 v156, v198, v198
v_lshrrev_b32 v141, 18, v141
v_pk_add_f16 v153, v153, 1.0 op_sel_hi:[1,0]
v_fmac_f32 v156, v199, v199
v_lshrrev_b32 v143, 18, v143
v_pk_add_f16 v150, v150, 1.0 op_sel_hi:[1,0]
v_pk_add_f16 v147, v147, 1.0 op_sel_hi:[1,0]
v_fmac_f32_e64 v156, v200, v200
v_and_b32 v145, s49, v145
s_waitcnt lgkmcnt(4)
ds_read_b128 v[228:231], v248 offset:37888
ds_read_u16_d16_hi v141, v141
ds_read_u16_d16_hi v143, v143
v_mfma_f32_32x32x16_bf16 v[120:135], v[232:235], v[184:187], v[120:135]
v_rcp_f16 v154, v153
v_fmac_f32 v156, v201, v201
v_bfe_u32 v144, v145, 2, 14
v_rcp_f16 v151, v150
v_fmac_f32 v156, v202, v202
v_lshrrev_b32 v145, 18, v145
v_rcp_f16 v148, v147
v_fmac_f32 v156, v203, v203
v_or_b32 v8, v136, v137
ds_read_b128 v[232:235], v248 offset:35840
ds_read_u16_d16 v144, v144
ds_read_u16_d16_hi v145, v145
v_mfma_f32_32x32x16_bf16 v[120:135], v[236:239], v[188:191], v[120:135]
s_waitcnt lgkmcnt(6)
v_or_b32 v9, v138, v139
v_rcp_f16_sdwa v154, v153 dst_sel:WORD_1 dst_unused:UNUSED_PRESERVE src0_sel:WORD_1
v_fmac_f32 v156, v204, v204
s_waitcnt lgkmcnt(4)
v_or_b32_e64 v10, v140, v141
v_rcp_f16_sdwa v151, v150 dst_sel:WORD_1 dst_unused:UNUSED_PRESERVE src0_sel:WORD_1
v_fmac_f32 v156, v205, v205
s_waitcnt lgkmcnt(3)
v_or_b32_e64 v11, v142, v143
v_rcp_f16_sdwa v148, v147 dst_sel:WORD_1 dst_unused:UNUSED_PRESERVE src0_sel:WORD_1
v_fmac_f32 v156, v206, v206
s_waitcnt lgkmcnt(0)
v_or_b32_e64 v12, v144, v145
v_pk_mul_f16 v13, v155, v154
v_fmac_f32 v156, v207, v207
v_pk_mul_f16 v14, v152, v151
v_pk_mul_f16 v15, v149, v148
s_setprio 1
ds_read_b128 v[236:239], v248 offset:38912
v_mfma_f32_32x32x16_f16 v[192:207], v[8:11], v[240:243], 0
v_cvt_pkrtz_f16_f32 v137, v120, v121
v_cvt_pkrtz_f16_f32 v139, v122, v123
v_cvt_pkrtz_f16_f32 v141, v124, v125
v_cvt_pkrtz_f16_f32 v143, v126, v127
v_cvt_pkrtz_f16_f32 v145, v128, v129
v_mfma_f32_32x32x16_f16 v[192:207], v[12:15], v[244:247], v[192:207]
v_cvt_pk_f16_f32 v155, v130, v131
v_cvt_pk_f16_f32 v152, v132, v133
v_cvt_pk_f16_f32 v149, v134, v135
v_pk_fma_f16 v154, v155, v155, s48
v_and_b32_e64 v137, s49, v137
v_pk_fma_f16 v151, v152, v152, s48
v_mfma_f32_32x32x16_bf16 v[120:135], v[224:227], v[168:171], 0
v_and_b32_e64 v139, s49, v139
v_pk_fma_f16 v148, v149, v149, s48
v_pk_mul_f16 v154, v155, v154
v_bfe_u32 v136, v137, 2, 14
v_pk_mul_f16 v151, v152, v151
v_pk_mul_f16 v148, v149, v148
v_bfe_u32 v138, v139, 2, 14
v_fmac_f32 v157, v192, v192
v_exp_f16 v153, v154
v_fmac_f32_e64 v157, v193, v193
ds_read_b128 v[224:227], v248 offset:36864
ds_read_u16_d16 v136, v136
ds_read_u16_d16 v138, v138
v_mfma_f32_32x32x16_bf16 v[120:135], v[228:231], v[172:175], v[120:135]
v_lshrrev_b32 v137, 18, v137
v_exp_f16 v150, v151
v_fmac_f32 v157, v194, v194
v_lshrrev_b32 v139, 18, v139
v_exp_f16 v147, v148
v_fmac_f32 v157, v195, v195
v_and_b32 v141, s49, v141
v_fmac_f32 v157, v196, v196
v_and_b32_e64 v143, s49, v143
ds_read_b128 v[228:231], v248 offset:39936
ds_read_u16_d16_hi v137, v137
ds_read_u16_d16_hi v139, v139
v_mfma_f32_32x32x16_bf16 v[120:135], v[232:235], v[176:179], v[120:135]
v_exp_f16_sdwa v153, v154 dst_sel:WORD_1 dst_unused:UNUSED_PRESERVE src0_sel:WORD_1
v_fmac_f32_e64 v157, v197, v197
v_bfe_u32 v140, v141, 2, 14
v_exp_f16_sdwa v150, v151 dst_sel:WORD_1 dst_unused:UNUSED_PRESERVE src0_sel:WORD_1
v_fmac_f32_e64 v157, v198, v198
v_bfe_u32 v142, v143, 2, 14
v_exp_f16_sdwa v147, v148 dst_sel:WORD_1 dst_unused:UNUSED_PRESERVE src0_sel:WORD_1
v_fmac_f32 v157, v199, v199
s_waitcnt lgkmcnt(5)
ds_read_b128 v[232:235], v248 offset:40960
ds_read_u16_d16 v140, v140
ds_read_u16_d16 v142, v142
v_mfma_f32_32x32x16_bf16 v[120:135], v[236:239], v[180:183], v[120:135]
v_lshrrev_b32 v141, 18, v141
v_fmac_f32 v157, v200, v200
v_pk_add_f16 v153, v153, 1.0 op_sel_hi:[1,0]
v_lshrrev_b32_e64 v143, 18, v143
v_pk_add_f16 v150, v150, 1.0 op_sel_hi:[1,0]
v_fmac_f32_e64 v157, v201, v201
v_pk_add_f16 v147, v147, 1.0 op_sel_hi:[1,0]
v_and_b32 v145, s49, v145
v_fmac_f32 v157, v202, v202
v_rcp_f16_e64 v154, v153
ds_read_b128 v[236:239], v248 offset:44032
ds_read_u16_d16_hi v141, v141
ds_read_u16_d16_hi v143, v143
v_mfma_f32_32x32x16_bf16 v[120:135], v[224:227], v[184:187], v[120:135]
v_bfe_u32 v144, v145, 2, 14
v_fmac_f32 v157, v203, v203
v_rcp_f16 v151, v150
s_setprio 0
v_fmac_f32 v157, v204, v204
v_lshrrev_b32 v145, 18, v145
v_rcp_f16 v148, v147
v_fmac_f32 v157, v205, v205
s_waitcnt lgkmcnt(4)
v_or_b32 v16, v136, v137
v_or_b32 v17, v138, v139
ds_read_b128 v[224:227], v248 offset:41984
ds_read_u16_d16 v144, v144
ds_read_u16_d16_hi v145, v145
v_mfma_f32_32x32x16_bf16 v[120:135], v[228:231], v[188:191], v[120:135]
v_fmac_f32_e64 v157, v206, v206
v_rcp_f16_sdwa v154, v153 dst_sel:WORD_1 dst_unused:UNUSED_PRESERVE src0_sel:WORD_1
s_waitcnt lgkmcnt(4)
v_or_b32 v18, v140, v141
v_fmac_f32_e64 v157, v207, v207
v_rcp_f16_sdwa v151, v150 dst_sel:WORD_1 dst_unused:UNUSED_PRESERVE src0_sel:WORD_1
s_nop 0
v_permlane32_swap_b32 v156, v157
s_waitcnt lgkmcnt(3)
v_or_b32 v19, v142, v143
v_rcp_f16_sdwa v148, v147 dst_sel:WORD_1 dst_unused:UNUSED_PRESERVE src0_sel:WORD_1
s_waitcnt lgkmcnt(0)
v_or_b32 v20, v144, v145
v_pk_mul_f16 v21, v155, v154
v_add_f32_e64 v156, v156, v157
ds_write_b32 v255, v156 offset:7168
v_pk_mul_f16 v22, v152, v151
v_pk_mul_f16 v23, v149, v148
s_cmp_lg_u32 s40, 0
s_cbranch_scc1 Lrs1
v_mov_b32 v90, 0
Lpi:
s_waitcnt vmcnt(0)
v_readfirstlane_b32 s43, v91
s_cmp_eq_u32 s76, 0
s_cbranch_scc1 Lpix
s_sub_u32 s76, s76, 1
s_cmp_ge_u32 s43, 256
s_cbranch_scc1 Lpix
buffer_load_dword v91, v90, s[36:39], 0 offen sc1
s_branch Lpi
Lpix:
v_min_u32_e64 v88, 47, v251
v_lshlrev_b32 v88, 3, v88
s_and_b32 s44, s2, 7
s_lshl_b32 s44, s44, 11
s_add_u32 s44, s44, 394752
buffer_load_dwordx2 v[92:93], v88, s[32:35], s44 offen sc1
Lrs1:
s_setprio 2
ds_read_b128 v[228:231], v248 offset:45056
v_mfma_f32_32x32x16_f16 v[192:207], v[16:19], v[240:243], 0
v_cvt_pkrtz_f16_f32 v137, v120, v121
v_cvt_pkrtz_f16_f32 v139, v122, v123
v_cvt_pkrtz_f16_f32 v141, v124, v125
v_cvt_pkrtz_f16_f32 v143, v126, v127
v_cvt_pkrtz_f16_f32 v145, v128, v129
v_mfma_f32_32x32x16_f16 v[192:207], v[20:23], v[244:247], v[192:207]
v_cvt_pk_f16_f32 v155, v130, v131
v_cvt_pk_f16_f32 v152, v132, v133
v_cvt_pk_f16_f32 v149, v134, v135
v_pk_fma_f16 v154, v155, v155, s48
v_and_b32_e64 v137, s49, v137
v_mfma_f32_32x32x16_bf16 v[120:135], v[232:235], v[168:171], 0
v_pk_fma_f16 v151, v152, v152, s48
v_and_b32_e64 v139, s49, v139
v_pk_fma_f16 v148, v149, v149, s48
v_pk_mul_f16 v154, v155, v154
v_bfe_u32 v136, v137, 2, 14
v_pk_mul_f16 v151, v152, v151
v_pk_mul_f16 v148, v149, v148
v_bfe_u32 v138, v139, 2, 14
v_fmac_f32 v158, v192, v192
v_exp_f16 v153, v154
ds_read_b128 v[232:235], v248 offset:43008
ds_read_u16_d16 v136, v136
ds_read_u16_d16 v138, v138
v_mfma_f32_32x32x16_bf16 v[120:135], v[236:239], v[172:175], v[120:135]
v_fmac_f32 v158, v193, v193
v_lshrrev_b32 v137, 18, v137
v_exp_f16 v150, v151
v_fmac_f32 v158, v194, v194
v_lshrrev_b32 v139, 18, v139
v_exp_f16 v147, v148
v_fmac_f32 v158, v195, v195
v_and_b32 v141, s49, v141
ds_read_b128 v[236:239], v248 offset:46080
ds_read_u16_d16_hi v137, v137
ds_read_u16_d16_hi v139, v139
v_mfma_f32_32x32x16_bf16 v[120:135], v[224:227], v[176:179], v[120:135]
v_and_b32_e64 v143, s49, v143
v_exp_f16_sdwa v153, v154 dst_sel:WORD_1 dst_unused:UNUSED_PRESERVE src0_sel:WORD_1
v_fmac_f32_e64 v158, v196, v196
v_bfe_u32 v140, v141, 2, 14
v_exp_f16_sdwa v150, v151 dst_sel:WORD_1 dst_unused:UNUSED_PRESERVE src0_sel:WORD_1
v_fmac_f32 v158, v197, v197
v_bfe_u32 v142, v143, 2, 14
v_exp_f16_sdwa v147, v148 dst_sel:WORD_1 dst_unused:UNUSED_PRESERVE src0_sel:WORD_1
s_waitcnt lgkmcnt(6)
ds_read_b128 v[224:227], v248 offset:47104
ds_read_u16_d16 v140, v140
ds_read_u16_d16 v142, v142
v_mfma_f32_32x32x16_bf16 v[120:135], v[228:231], v[180:183], v[120:135]
v_fmac_f32 v158, v198, v198
v_lshrrev_b32 v141, 18, v141
v_pk_add_f16 v153, v153, 1.0 op_sel_hi:[1,0]
v_fmac_f32 v158, v199, v199
v_lshrrev_b32 v143, 18, v143
v_pk_add_f16 v150, v150, 1.0 op_sel_hi:[1,0]
v_pk_add_f16 v147, v147, 1.0 op_sel_hi:[1,0]
v_fmac_f32_e64 v158, v200, v200
v_and_b32 v145, s49, v145
s_waitcnt lgkmcnt(4)
ds_read_b128 v[228:231], v248 offset:50176
ds_read_u16_d16_hi v141, v141
ds_read_u16_d16_hi v143, v143
v_mfma_f32_32x32x16_bf16 v[120:135], v[232:235], v[184:187], v[120:135]
v_rcp_f16 v154, v153
v_fmac_f32 v158, v201, v201
v_bfe_u32 v144, v145, 2, 14
v_rcp_f16 v151, v150
v_fmac_f32 v158, v202, v202
v_lshrrev_b32 v145, 18, v145
v_rcp_f16 v148, v147
v_fmac_f32 v158, v203, v203
v_or_b32 v24, v136, v137
ds_read_b128 v[232:235], v248 offset:48128
ds_read_u16_d16 v144, v144
ds_read_u16_d16_hi v145, v145
v_mfma_f32_32x32x16_bf16 v[120:135], v[236:239], v[188:191], v[120:135]
s_waitcnt lgkmcnt(6)
v_or_b32 v25, v138, v139
v_rcp_f16_sdwa v154, v153 dst_sel:WORD_1 dst_unused:UNUSED_PRESERVE src0_sel:WORD_1
v_fmac_f32 v158, v204, v204
s_waitcnt lgkmcnt(4)
v_or_b32_e64 v26, v140, v141
v_rcp_f16_sdwa v151, v150 dst_sel:WORD_1 dst_unused:UNUSED_PRESERVE src0_sel:WORD_1
v_fmac_f32 v158, v205, v205
s_waitcnt lgkmcnt(3)
v_or_b32_e64 v27, v142, v143
v_rcp_f16_sdwa v148, v147 dst_sel:WORD_1 dst_unused:UNUSED_PRESERVE src0_sel:WORD_1
v_fmac_f32 v158, v206, v206
s_waitcnt lgkmcnt(0)
v_or_b32_e64 v28, v144, v145
v_pk_mul_f16 v29, v155, v154
v_fmac_f32 v158, v207, v207
v_pk_mul_f16 v30, v152, v151
v_pk_mul_f16 v31, v149, v148
s_setprio 1
ds_read_b128 v[236:239], v248 offset:51200
v_mfma_f32_32x32x16_f16 v[192:207], v[24:27], v[240:243], 0
v_cvt_pkrtz_f16_f32 v137, v120, v121
v_cvt_pkrtz_f16_f32 v139, v122, v123
v_cvt_pkrtz_f16_f32 v141, v124, v125
v_cvt_pkrtz_f16_f32 v143, v126, v127
v_cvt_pkrtz_f16_f32 v145, v128, v129
v_mfma_f32_32x32x16_f16 v[192:207], v[28:31], v[244:247], v[192:207]
v_cvt_pk_f16_f32 v155, v130, v131
v_cvt_pk_f16_f32 v152, v132, v133
v_cvt_pk_f16_f32 v149, v134, v135
v_pk_fma_f16 v154, v155, v155, s48
v_and_b32_e64 v137, s49, v137
v_pk_fma_f16 v151, v152, v152, s48
v_mfma_f32_32x32x16_bf16 v[120:135], v[224:227], v[168:171], 0
v_and_b32_e64 v139, s49, v139
v_pk_fma_f16 v148, v149, v149, s48
v_pk_mul_f16 v154, v155, v154
v_bfe_u32 v136, v137, 2, 14
v_pk_mul_f16 v151, v152, v151
v_pk_mul_f16 v148, v149, v148
v_bfe_u32 v138, v139, 2, 14
v_fmac_f32 v159, v192, v192
v_exp_f16 v153, v154
v_fmac_f32_e64 v159, v193, v193
ds_read_b128 v[224:227], v248 offset:49152
ds_read_u16_d16 v136, v136
ds_read_u16_d16 v138, v138
v_mfma_f32_32x32x16_bf16 v[120:135], v[228:231], v[172:175], v[120:135]
v_lshrrev_b32 v137, 18, v137
v_exp_f16 v150, v151
v_fmac_f32 v159, v194, v194
v_lshrrev_b32 v139, 18, v139
v_exp_f16 v147, v148
v_fmac_f32 v159, v195, v195
v_and_b32 v141, s49, v141
v_fmac_f32 v159, v196, v196
v_and_b32_e64 v143, s49, v143
ds_read_b128 v[228:231], v248 offset:52224
ds_read_u16_d16_hi v137, v137
ds_read_u16_d16_hi v139, v139
v_mfma_f32_32x32x16_bf16 v[120:135], v[232:235], v[176:179], v[120:135]
v_exp_f16_sdwa v153, v154 dst_sel:WORD_1 dst_unused:UNUSED_PRESERVE src0_sel:WORD_1
v_fmac_f32_e64 v159, v197, v197
v_bfe_u32 v140, v141, 2, 14
v_exp_f16_sdwa v150, v151 dst_sel:WORD_1 dst_unused:UNUSED_PRESERVE src0_sel:WORD_1
v_fmac_f32_e64 v159, v198, v198
v_bfe_u32 v142, v143, 2, 14
v_exp_f16_sdwa v147, v148 dst_sel:WORD_1 dst_unused:UNUSED_PRESERVE src0_sel:WORD_1
v_fmac_f32 v159, v199, v199
s_waitcnt lgkmcnt(5)
ds_read_b128 v[232:235], v248 offset:53248
ds_read_u16_d16 v140, v140
ds_read_u16_d16 v142, v142
v_mfma_f32_32x32x16_bf16 v[120:135], v[236:239], v[180:183], v[120:135]
v_lshrrev_b32 v141, 18, v141
v_fmac_f32 v159, v200, v200
v_pk_add_f16 v153, v153, 1.0 op_sel_hi:[1,0]
v_lshrrev_b32_e64 v143, 18, v143
v_pk_add_f16 v150, v150, 1.0 op_sel_hi:[1,0]
v_fmac_f32_e64 v159, v201, v201
v_pk_add_f16 v147, v147, 1.0 op_sel_hi:[1,0]
v_and_b32 v145, s49, v145
v_fmac_f32 v159, v202, v202
v_rcp_f16_e64 v154, v153
ds_read_b128 v[236:239], v248 offset:56320
ds_read_u16_d16_hi v141, v141
ds_read_u16_d16_hi v143, v143
v_mfma_f32_32x32x16_bf16 v[120:135], v[224:227], v[184:187], v[120:135]
v_bfe_u32 v144, v145, 2, 14
v_fmac_f32 v159, v203, v203
v_rcp_f16 v151, v150
s_setprio 0
v_fmac_f32 v159, v204, v204
v_lshrrev_b32 v145, 18, v145
v_rcp_f16 v148, v147
v_fmac_f32 v159, v205, v205
s_waitcnt lgkmcnt(4)
v_or_b32 v32, v136, v137
v_or_b32 v33, v138, v139
ds_read_b128 v[224:227], v248 offset:54272
ds_read_u16_d16 v144, v144
ds_read_u16_d16_hi v145, v145
v_mfma_f32_32x32x16_bf16 v[120:135], v[228:231], v[188:191], v[120:135]
v_fmac_f32_e64 v159, v206, v206
v_rcp_f16_sdwa v154, v153 dst_sel:WORD_1 dst_unused:UNUSED_PRESERVE src0_sel:WORD_1
s_waitcnt lgkmcnt(4)
v_or_b32 v34, v140, v141
v_fmac_f32_e64 v159, v207, v207
v_rcp_f16_sdwa v151, v150 dst_sel:WORD_1 dst_unused:UNUSED_PRESERVE src0_sel:WORD_1
s_nop 0
v_permlane32_swap_b32 v158, v159
s_waitcnt lgkmcnt(3)
v_or_b32 v35, v142, v143
v_rcp_f16_sdwa v148, v147 dst_sel:WORD_1 dst_unused:UNUSED_PRESERVE src0_sel:WORD_1
s_waitcnt lgkmcnt(0)
v_or_b32 v36, v144, v145
v_pk_mul_f16 v37, v155, v154
v_add_f32 v158, v158, v159
ds_write_b32 v255, v158 offset:7424
v_pk_mul_f16 v38, v152, v151
v_pk_mul_f16 v39, v149, v148
s_setprio 2
ds_read_b128 v[228:231], v248 offset:57344
v_mfma_f32_32x32x16_f16 v[192:207], v[32:35], v[240:243], 0
v_cvt_pkrtz_f16_f32 v137, v120, v121
v_cvt_pkrtz_f16_f32 v139, v122, v123
v_cvt_pkrtz_f16_f32 v141, v124, v125
v_cvt_pkrtz_f16_f32 v143, v126, v127
v_cvt_pkrtz_f16_f32 v145, v128, v129
v_mfma_f32_32x32x16_f16 v[192:207], v[36:39], v[244:247], v[192:207]
v_cvt_pk_f16_f32 v155, v130, v131
v_cvt_pk_f16_f32 v152, v132, v133
v_cvt_pk_f16_f32 v149, v134, v135
v_pk_fma_f16 v154, v155, v155, s48
v_and_b32_e64 v137, s49, v137
v_mfma_f32_32x32x16_bf16 v[120:135], v[232:235], v[168:171], 0
v_pk_fma_f16 v151, v152, v152, s48
v_and_b32_e64 v139, s49, v139
v_pk_fma_f16 v148, v149, v149, s48
v_pk_mul_f16 v154, v155, v154
v_bfe_u32 v136, v137, 2, 14
v_pk_mul_f16 v151, v152, v151
v_pk_mul_f16 v148, v149, v148
v_bfe_u32 v138, v139, 2, 14
v_fmac_f32 v160, v192, v192
v_exp_f16 v153, v154
ds_read_b128 v[232:235], v248 offset:55296
ds_read_u16_d16 v136, v136
ds_read_u16_d16 v138, v138
v_mfma_f32_32x32x16_bf16 v[120:135], v[236:239], v[172:175], v[120:135]
v_fmac_f32 v160, v193, v193
v_lshrrev_b32 v137, 18, v137
v_exp_f16 v150, v151
v_fmac_f32 v160, v194, v194
v_lshrrev_b32 v139, 18, v139
v_exp_f16 v147, v148
v_fmac_f32 v160, v195, v195
v_and_b32 v141, s49, v141
ds_read_b128 v[236:239], v248 offset:58368
ds_read_u16_d16_hi v137, v137
ds_read_u16_d16_hi v139, v139
v_mfma_f32_32x32x16_bf16 v[120:135], v[224:227], v[176:179], v[120:135]
v_and_b32_e64 v143, s49, v143
v_exp_f16_sdwa v153, v154 dst_sel:WORD_1 dst_unused:UNUSED_PRESERVE src0_sel:WORD_1
v_fmac_f32_e64 v160, v196, v196
v_bfe_u32 v140, v141, 2, 14
v_exp_f16_sdwa v150, v151 dst_sel:WORD_1 dst_unused:UNUSED_PRESERVE src0_sel:WORD_1
v_fmac_f32 v160, v197, v197
v_bfe_u32 v142, v143, 2, 14
v_exp_f16_sdwa v147, v148 dst_sel:WORD_1 dst_unused:UNUSED_PRESERVE src0_sel:WORD_1
s_waitcnt lgkmcnt(6)
ds_read_b128 v[224:227], v248 offset:59392
ds_read_u16_d16 v140, v140
ds_read_u16_d16 v142, v142
v_mfma_f32_32x32x16_bf16 v[120:135], v[228:231], v[180:183], v[120:135]
v_fmac_f32 v160, v198, v198
v_lshrrev_b32 v141, 18, v141
v_pk_add_f16 v153, v153, 1.0 op_sel_hi:[1,0]
v_fmac_f32 v160, v199, v199
v_lshrrev_b32 v143, 18, v143
v_pk_add_f16 v150, v150, 1.0 op_sel_hi:[1,0]
v_pk_add_f16 v147, v147, 1.0 op_sel_hi:[1,0]
v_fmac_f32_e64 v160, v200, v200
v_and_b32 v145, s49, v145
s_waitcnt lgkmcnt(4)
ds_read_b128 v[228:231], v248 offset:62464
ds_read_u16_d16_hi v141, v141
ds_read_u16_d16_hi v143, v143
v_mfma_f32_32x32x16_bf16 v[120:135], v[232:235], v[184:187], v[120:135]
v_rcp_f16 v154, v153
v_fmac_f32 v160, v201, v201
v_bfe_u32 v144, v145, 2, 14
v_rcp_f16 v151, v150
v_fmac_f32 v160, v202, v202
v_lshrrev_b32 v145, 18, v145
v_rcp_f16 v148, v147
v_fmac_f32 v160, v203, v203
v_or_b32 v40, v136, v137
ds_read_b128 v[232:235], v248 offset:60416
ds_read_u16_d16 v144, v144
ds_read_u16_d16_hi v145, v145
v_mfma_f32_32x32x16_bf16 v[120:135], v[236:239], v[188:191], v[120:135]
s_waitcnt lgkmcnt(6)
v_or_b32 v41, v138, v139
v_rcp_f16_sdwa v154, v153 dst_sel:WORD_1 dst_unused:UNUSED_PRESERVE src0_sel:WORD_1
v_fmac_f32 v160, v204, v204
s_waitcnt lgkmcnt(4)
v_or_b32_e64 v42, v140, v141
v_rcp_f16_sdwa v151, v150 dst_sel:WORD_1 dst_unused:UNUSED_PRESERVE src0_sel:WORD_1
v_fmac_f32 v160, v205, v205
s_waitcnt lgkmcnt(3)
v_or_b32_e64 v43, v142, v143
v_rcp_f16_sdwa v148, v147 dst_sel:WORD_1 dst_unused:UNUSED_PRESERVE src0_sel:WORD_1
v_fmac_f32 v160, v206, v206
s_waitcnt lgkmcnt(0)
v_or_b32_e64 v44, v144, v145
v_pk_mul_f16 v45, v155, v154
v_fmac_f32_e64 v160, v207, v207
v_pk_mul_f16 v46, v152, v151
v_pk_mul_f16 v47, v149, v148
s_cmp_lg_u32 s40, 0
s_cbranch_scc1 Lrs2
v_min_u32 v88, 47, v251
v_lshlrev_b32 v88, 3, v88
v_add_u32 v89, 7936, v88
v_add_u32 v88, 15872, v88
v_cmp_gt_u32 vcc, 32, v251
s_nop 1
v_cndmask_b32 v88, v88, v89, vcc
s_waitcnt vmcnt(0)
ds_write_b64 v88, v[92:93]
Lrs2:
s_setprio 1
ds_read_b128 v[236:239], v248 offset:63488
v_mfma_f32_32x32x16_f16 v[192:207], v[40:43], v[240:243], 0
v_cvt_pkrtz_f16_f32 v137, v120, v121
v_cvt_pkrtz_f16_f32 v139, v122, v123
v_cvt_pkrtz_f16_f32 v141, v124, v125
v_cvt_pkrtz_f16_f32 v143, v126, v127
s_waitcnt lgkmcnt(1)
v_cvt_pkrtz_f16_f32 v145, v128, v129
v_mfma_f32_32x32x16_f16 v[192:207], v[44:47], v[244:247], v[192:207]
v_cvt_pk_f16_f32 v155, v130, v131
v_cvt_pk_f16_f32 v152, v132, v133
v_cvt_pk_f16_f32 v149, v134, v135
v_pk_fma_f16 v154, v155, v155, s48
v_and_b32_e64 v137, s49, v137
v_pk_fma_f16 v151, v152, v152, s48
v_mfma_f32_32x32x16_bf16 v[120:135], v[224:227], v[168:171], 0
v_and_b32_e64 v139, s49, v139
v_pk_fma_f16 v148, v149, v149, s48
v_pk_mul_f16 v154, v155, v154
v_bfe_u32 v136, v137, 2, 14
v_pk_mul_f16 v151, v152, v151
v_pk_mul_f16 v148, v149, v148
v_bfe_u32 v138, v139, 2, 14
v_fmac_f32 v161, v192, v192
v_exp_f16 v153, v154
v_fmac_f32_e64 v161, v193, v193
ds_read_b128 v[224:227], v248 offset:61440
ds_read_u16_d16 v136, v136
ds_read_u16_d16 v138, v138
v_mfma_f32_32x32x16_bf16 v[120:135], v[228:231], v[172:175], v[120:135]
v_lshrrev_b32 v137, 18, v137
v_exp_f16 v150, v151
v_fmac_f32 v161, v194, v194
v_lshrrev_b32 v139, 18, v139
v_exp_f16 v147, v148
v_fmac_f32 v161, v195, v195
v_and_b32 v141, s49, v141
v_fmac_f32 v161, v196, v196
v_and_b32_e64 v143, s49, v143
ds_read_b128 v[228:231], v248 offset:64512
ds_read_u16_d16_hi v137, v137
ds_read_u16_d16_hi v139, v139
v_mfma_f32_32x32x16_bf16 v[120:135], v[232:235], v[176:179], v[120:135]
v_exp_f16_sdwa v153, v154 dst_sel:WORD_1 dst_unused:UNUSED_PRESERVE src0_sel:WORD_1
v_fmac_f32_e64 v161, v197, v197
v_bfe_u32 v140, v141, 2, 14
v_exp_f16_sdwa v150, v151 dst_sel:WORD_1 dst_unused:UNUSED_PRESERVE src0_sel:WORD_1
v_fmac_f32_e64 v161, v198, v198
v_bfe_u32 v142, v143, 2, 14
v_exp_f16_sdwa v147, v148 dst_sel:WORD_1 dst_unused:UNUSED_PRESERVE src0_sel:WORD_1
v_fmac_f32 v161, v199, v199
s_waitcnt lgkmcnt(5)
ds_read_b128 v[232:235], v249
ds_read_u16_d16 v140, v140
ds_read_u16_d16 v142, v142
v_mfma_f32_32x32x16_bf16 v[120:135], v[236:239], v[180:183], v[120:135]
v_lshrrev_b32 v141, 18, v141
v_fmac_f32 v161, v200, v200
v_pk_add_f16 v153, v153, 1.0 op_sel_hi:[1,0]
v_lshrrev_b32_e64 v143, 18, v143
v_pk_add_f16 v150, v150, 1.0 op_sel_hi:[1,0]
v_fmac_f32_e64 v161, v201, v201
v_pk_add_f16 v147, v147, 1.0 op_sel_hi:[1,0]
v_and_b32 v145, s49, v145
v_fmac_f32 v161, v202, v202
v_rcp_f16_e64 v154, v153
ds_read_b128 v[236:239], v249 offset:3072
ds_read_u16_d16_hi v141, v141
ds_read_u16_d16_hi v143, v143
v_mfma_f32_32x32x16_bf16 v[120:135], v[224:227], v[184:187], v[120:135]
v_bfe_u32 v144, v145, 2, 14
v_fmac_f32 v161, v203, v203
v_rcp_f16 v151, v150
s_setprio 0
v_fmac_f32 v161, v204, v204
v_lshrrev_b32 v145, 18, v145
v_rcp_f16 v148, v147
v_fmac_f32 v161, v205, v205
s_waitcnt lgkmcnt(4)
v_or_b32 v48, v136, v137
v_or_b32 v49, v138, v139
ds_read_b128 v[224:227], v249 offset:1024
ds_read_u16_d16 v144, v144
ds_read_u16_d16_hi v145, v145
v_mfma_f32_32x32x16_bf16 v[120:135], v[228:231], v[188:191], v[120:135]
v_fmac_f32_e64 v161, v206, v206
v_rcp_f16_sdwa v154, v153 dst_sel:WORD_1 dst_unused:UNUSED_PRESERVE src0_sel:WORD_1
s_waitcnt lgkmcnt(4)
v_or_b32 v50, v140, v141
v_fmac_f32_e64 v161, v207, v207
v_rcp_f16_sdwa v151, v150 dst_sel:WORD_1 dst_unused:UNUSED_PRESERVE src0_sel:WORD_1
s_nop 0
v_permlane32_swap_b32 v160, v161
s_waitcnt lgkmcnt(3)
v_or_b32 v51, v142, v143
v_rcp_f16_sdwa v148, v147 dst_sel:WORD_1 dst_unused:UNUSED_PRESERVE src0_sel:WORD_1
s_waitcnt lgkmcnt(0)
v_or_b32 v52, v144, v145
v_pk_mul_f16 v53, v155, v154
v_add_f32 v160, v160, v161
ds_write_b32 v255, v160 offset:7680
v_pk_mul_f16 v54, v152, v151
v_pk_mul_f16 v55, v149, v148
s_setprio 2
ds_read_b128 v[228:231], v249 offset:4096
v_mfma_f32_32x32x16_f16 v[192:207], v[48:51], v[240:243], 0
v_cvt_pkrtz_f16_f32 v137, v120, v121
v_cvt_pkrtz_f16_f32 v139, v122, v123
v_cvt_pkrtz_f16_f32 v141, v124, v125
v_cvt_pkrtz_f16_f32 v143, v126, v127
v_cvt_pkrtz_f16_f32 v145, v128, v129
v_mfma_f32_32x32x16_f16 v[192:207], v[52:55], v[244:247], v[192:207]
v_cvt_pk_f16_f32 v155, v130, v131
v_cvt_pk_f16_f32 v152, v132, v133
v_cvt_pk_f16_f32 v149, v134, v135
v_pk_fma_f16 v154, v155, v155, s48
v_and_b32_e64 v137, s49, v137
v_mfma_f32_32x32x16_bf16 v[120:135], v[232:235], v[168:171], 0
v_pk_fma_f16 v151, v152, v152, s48
v_and_b32_e64 v139, s49, v139
v_pk_fma_f16 v148, v149, v149, s48
v_pk_mul_f16 v154, v155, v154
v_bfe_u32 v136, v137, 2, 14
v_pk_mul_f16 v151, v152, v151
v_pk_mul_f16 v148, v149, v148
v_bfe_u32 v138, v139, 2, 14
v_fmac_f32 v162, v192, v192
v_exp_f16 v153, v154
ds_read_b128 v[232:235], v249 offset:2048
ds_read_u16_d16 v136, v136
ds_read_u16_d16 v138, v138
v_mfma_f32_32x32x16_bf16 v[120:135], v[236:239], v[172:175], v[120:135]
v_fmac_f32 v162, v193, v193
v_lshrrev_b32 v137, 18, v137
v_exp_f16 v150, v151
v_fmac_f32 v162, v194, v194
v_lshrrev_b32 v139, 18, v139
v_exp_f16 v147, v148
v_fmac_f32 v162, v195, v195
v_and_b32 v141, s49, v141
ds_read_b128 v[236:239], v249 offset:5120
ds_read_u16_d16_hi v137, v137
ds_read_u16_d16_hi v139, v139
v_mfma_f32_32x32x16_bf16 v[120:135], v[224:227], v[176:179], v[120:135]
v_and_b32_e64 v143, s49, v143
v_exp_f16_sdwa v153, v154 dst_sel:WORD_1 dst_unused:UNUSED_PRESERVE src0_sel:WORD_1
v_fmac_f32_e64 v162, v196, v196
v_bfe_u32 v140, v141, 2, 14
v_exp_f16_sdwa v150, v151 dst_sel:WORD_1 dst_unused:UNUSED_PRESERVE src0_sel:WORD_1
v_fmac_f32 v162, v197, v197
v_bfe_u32 v142, v143, 2, 14
v_exp_f16_sdwa v147, v148 dst_sel:WORD_1 dst_unused:UNUSED_PRESERVE src0_sel:WORD_1
s_waitcnt lgkmcnt(6)
ds_read_b128 v[224:227], v249 offset:6144
ds_read_u16_d16 v140, v140
ds_read_u16_d16 v142, v142
v_mfma_f32_32x32x16_bf16 v[120:135], v[228:231], v[180:183], v[120:135]
v_fmac_f32 v162, v198, v198
v_lshrrev_b32 v141, 18, v141
v_pk_add_f16 v153, v153, 1.0 op_sel_hi:[1,0]
v_fmac_f32 v162, v199, v199
v_lshrrev_b32 v143, 18, v143
v_pk_add_f16 v150, v150, 1.0 op_sel_hi:[1,0]
v_pk_add_f16 v147, v147, 1.0 op_sel_hi:[1,0]
v_fmac_f32_e64 v162, v200, v200
v_and_b32 v145, s49, v145
s_waitcnt lgkmcnt(4)
ds_read_b128 v[228:231], v249 offset:9216
ds_read_u16_d16_hi v141, v141
ds_read_u16_d16_hi v143, v143
v_mfma_f32_32x32x16_bf16 v[120:135], v[232:235], v[184:187], v[120:135]
v_rcp_f16 v154, v153
v_fmac_f32 v162, v201, v201
v_bfe_u32 v144, v145, 2, 14
v_rcp_f16 v151, v150
v_fmac_f32 v162, v202, v202
v_lshrrev_b32 v145, 18, v145
v_rcp_f16 v148, v147
v_fmac_f32 v162, v203, v203
v_or_b32 v56, v136, v137
ds_read_b128 v[232:235], v249 offset:7168
ds_read_u16_d16 v144, v144
ds_read_u16_d16_hi v145, v145
v_mfma_f32_32x32x16_bf16 v[120:135], v[236:239], v[188:191], v[120:135]
s_waitcnt lgkmcnt(6)
v_or_b32 v57, v138, v139
v_rcp_f16_sdwa v154, v153 dst_sel:WORD_1 dst_unused:UNUSED_PRESERVE src0_sel:WORD_1
v_fmac_f32 v162, v204, v204
s_waitcnt lgkmcnt(4)
v_or_b32_e64 v58, v140, v141
v_rcp_f16_sdwa v151, v150 dst_sel:WORD_1 dst_unused:UNUSED_PRESERVE src0_sel:WORD_1
v_fmac_f32 v162, v205, v205
s_waitcnt lgkmcnt(3)
v_or_b32_e64 v59, v142, v143
v_rcp_f16_sdwa v148, v147 dst_sel:WORD_1 dst_unused:UNUSED_PRESERVE src0_sel:WORD_1
v_fmac_f32 v162, v206, v206
s_waitcnt lgkmcnt(0)
v_or_b32_e64 v60, v144, v145
v_pk_mul_f16 v61, v155, v154
v_fmac_f32 v162, v207, v207
v_pk_mul_f16 v62, v152, v151
v_pk_mul_f16 v63, v149, v148
s_setprio 1
ds_read_b128 v[236:239], v249 offset:10240
v_mfma_f32_32x32x16_f16 v[192:207], v[56:59], v[240:243], 0
v_cvt_pkrtz_f16_f32 v137, v120, v121
v_cvt_pkrtz_f16_f32 v139, v122, v123
v_cvt_pkrtz_f16_f32 v141, v124, v125
v_cvt_pkrtz_f16_f32 v143, v126, v127
v_cvt_pkrtz_f16_f32 v145, v128, v129
v_mfma_f32_32x32x16_f16 v[192:207], v[60:63], v[244:247], v[192:207]
v_cvt_pk_f16_f32 v155, v130, v131
v_cvt_pk_f16_f32 v152, v132, v133
v_cvt_pk_f16_f32 v149, v134, v135
v_pk_fma_f16 v154, v155, v155, s48
v_and_b32_e64 v137, s49, v137
v_pk_fma_f16 v151, v152, v152, s48
v_mfma_f32_32x32x16_bf16 v[120:135], v[224:227], v[168:171], 0
v_and_b32_e64 v139, s49, v139
v_pk_fma_f16 v148, v149, v149, s48
v_pk_mul_f16 v154, v155, v154
v_bfe_u32 v136, v137, 2, 14
v_pk_mul_f16 v151, v152, v151
v_pk_mul_f16 v148, v149, v148
v_bfe_u32 v138, v139, 2, 14
v_fmac_f32 v163, v192, v192
v_exp_f16 v153, v154
v_fmac_f32_e64 v163, v193, v193
ds_read_b128 v[224:227], v249 offset:8192
ds_read_u16_d16 v136, v136
ds_read_u16_d16 v138, v138
v_mfma_f32_32x32x16_bf16 v[120:135], v[228:231], v[172:175], v[120:135]
v_lshrrev_b32 v137, 18, v137
v_exp_f16 v150, v151
v_fmac_f32 v163, v194, v194
v_lshrrev_b32 v139, 18, v139
v_exp_f16 v147, v148
v_fmac_f32 v163, v195, v195
v_and_b32 v141, s49, v141
v_fmac_f32 v163, v196, v196
v_and_b32_e64 v143, s49, v143
ds_read_b128 v[228:231], v249 offset:11264
ds_read_u16_d16_hi v137, v137
ds_read_u16_d16_hi v139, v139
v_mfma_f32_32x32x16_bf16 v[120:135], v[232:235], v[176:179], v[120:135]
v_exp_f16_sdwa v153, v154 dst_sel:WORD_1 dst_unused:UNUSED_PRESERVE src0_sel:WORD_1
v_fmac_f32_e64 v163, v197, v197
v_bfe_u32 v140, v141, 2, 14
v_exp_f16_sdwa v150, v151 dst_sel:WORD_1 dst_unused:UNUSED_PRESERVE src0_sel:WORD_1
v_fmac_f32_e64 v163, v198, v198
v_bfe_u32 v142, v143, 2, 14
v_exp_f16_sdwa v147, v148 dst_sel:WORD_1 dst_unused:UNUSED_PRESERVE src0_sel:WORD_1
v_fmac_f32 v163, v199, v199
s_waitcnt lgkmcnt(5)
ds_read_b128 v[232:235], v249 offset:12288
ds_read_u16_d16 v140, v140
ds_read_u16_d16 v142, v142
v_mfma_f32_32x32x16_bf16 v[120:135], v[236:239], v[180:183], v[120:135]
v_lshrrev_b32 v141, 18, v141
v_fmac_f32 v163, v200, v200
v_pk_add_f16 v153, v153, 1.0 op_sel_hi:[1,0]
v_lshrrev_b32_e64 v143, 18, v143
v_pk_add_f16 v150, v150, 1.0 op_sel_hi:[1,0]
v_fmac_f32_e64 v163, v201, v201
v_pk_add_f16 v147, v147, 1.0 op_sel_hi:[1,0]
v_and_b32 v145, s49, v145
v_fmac_f32 v163, v202, v202
v_rcp_f16_e64 v154, v153
ds_read_b128 v[236:239], v249 offset:15360
ds_read_u16_d16_hi v141, v141
ds_read_u16_d16_hi v143, v143
v_mfma_f32_32x32x16_bf16 v[120:135], v[224:227], v[184:187], v[120:135]
v_bfe_u32 v144, v145, 2, 14
v_fmac_f32 v163, v203, v203
v_rcp_f16 v151, v150
s_setprio 0
v_fmac_f32 v163, v204, v204
v_lshrrev_b32 v145, 18, v145
v_rcp_f16 v148, v147
v_fmac_f32 v163, v205, v205
s_waitcnt lgkmcnt(4)
v_or_b32 v64, v136, v137
v_or_b32 v65, v138, v139
ds_read_b128 v[224:227], v249 offset:13312
ds_read_u16_d16 v144, v144
ds_read_u16_d16_hi v145, v145
v_mfma_f32_32x32x16_bf16 v[120:135], v[228:231], v[188:191], v[120:135]
v_fmac_f32_e64 v163, v206, v206
v_rcp_f16_sdwa v154, v153 dst_sel:WORD_1 dst_unused:UNUSED_PRESERVE src0_sel:WORD_1
s_waitcnt lgkmcnt(4)
v_or_b32 v66, v140, v141
v_fmac_f32_e64 v163, v207, v207
v_rcp_f16_sdwa v151, v150 dst_sel:WORD_1 dst_unused:UNUSED_PRESERVE src0_sel:WORD_1
s_nop 0
v_permlane32_swap_b32 v162, v163
s_waitcnt lgkmcnt(3)
v_or_b32 v67, v142, v143
v_rcp_f16_sdwa v148, v147 dst_sel:WORD_1 dst_unused:UNUSED_PRESERVE src0_sel:WORD_1
s_waitcnt lgkmcnt(0)
v_or_b32 v68, v144, v145
v_pk_mul_f16 v69, v155, v154
v_add_f32 v162, v162, v163
ds_write_b32 v255, v162 offset:7936
v_pk_mul_f16 v70, v152, v151
v_pk_mul_f16 v71, v149, v148
s_setprio 2
ds_read_b128 v[228:231], v249 offset:16384
v_mfma_f32_32x32x16_f16 v[192:207], v[64:67], v[240:243], 0
v_cvt_pkrtz_f16_f32 v137, v120, v121
v_cvt_pkrtz_f16_f32 v139, v122, v123
v_cvt_pkrtz_f16_f32 v141, v124, v125
v_cvt_pkrtz_f16_f32 v143, v126, v127
v_cvt_pkrtz_f16_f32 v145, v128, v129
v_mfma_f32_32x32x16_f16 v[192:207], v[68:71], v[244:247], v[192:207]
v_cvt_pk_f16_f32 v155, v130, v131
v_cvt_pk_f16_f32 v152, v132, v133
v_cvt_pk_f16_f32 v149, v134, v135
v_pk_fma_f16 v154, v155, v155, s48
v_and_b32_e64 v137, s49, v137
v_mfma_f32_32x32x16_bf16 v[120:135], v[232:235], v[168:171], 0
v_pk_fma_f16 v151, v152, v152, s48
v_and_b32_e64 v139, s49, v139
v_pk_fma_f16 v148, v149, v149, s48
v_pk_mul_f16 v154, v155, v154
v_bfe_u32 v136, v137, 2, 14
v_pk_mul_f16 v151, v152, v151
v_pk_mul_f16 v148, v149, v148
v_bfe_u32 v138, v139, 2, 14
v_fmac_f32 v164, v192, v192
v_exp_f16 v153, v154
ds_read_b128 v[232:235], v249 offset:14336
ds_read_u16_d16 v136, v136
ds_read_u16_d16 v138, v138
v_mfma_f32_32x32x16_bf16 v[120:135], v[236:239], v[172:175], v[120:135]
v_fmac_f32 v164, v193, v193
v_lshrrev_b32 v137, 18, v137
v_exp_f16 v150, v151
v_fmac_f32 v164, v194, v194
v_lshrrev_b32 v139, 18, v139
v_exp_f16 v147, v148
v_fmac_f32 v164, v195, v195
v_and_b32 v141, s49, v141
ds_read_b128 v[236:239], v249 offset:17408
ds_read_u16_d16_hi v137, v137
ds_read_u16_d16_hi v139, v139
v_mfma_f32_32x32x16_bf16 v[120:135], v[224:227], v[176:179], v[120:135]
v_and_b32_e64 v143, s49, v143
v_exp_f16_sdwa v153, v154 dst_sel:WORD_1 dst_unused:UNUSED_PRESERVE src0_sel:WORD_1
v_fmac_f32_e64 v164, v196, v196
v_bfe_u32 v140, v141, 2, 14
v_exp_f16_sdwa v150, v151 dst_sel:WORD_1 dst_unused:UNUSED_PRESERVE src0_sel:WORD_1
v_fmac_f32 v164, v197, v197
v_bfe_u32 v142, v143, 2, 14
v_exp_f16_sdwa v147, v148 dst_sel:WORD_1 dst_unused:UNUSED_PRESERVE src0_sel:WORD_1
s_waitcnt lgkmcnt(6)
ds_read_b128 v[224:227], v249 offset:18432
ds_read_u16_d16 v140, v140
ds_read_u16_d16 v142, v142
v_mfma_f32_32x32x16_bf16 v[120:135], v[228:231], v[180:183], v[120:135]
v_fmac_f32 v164, v198, v198
v_lshrrev_b32 v141, 18, v141
v_pk_add_f16 v153, v153, 1.0 op_sel_hi:[1,0]
v_fmac_f32 v164, v199, v199
v_lshrrev_b32 v143, 18, v143
v_pk_add_f16 v150, v150, 1.0 op_sel_hi:[1,0]
v_pk_add_f16 v147, v147, 1.0 op_sel_hi:[1,0]
v_fmac_f32_e64 v164, v200, v200
v_and_b32 v145, s49, v145
s_waitcnt lgkmcnt(4)
ds_read_b128 v[228:231], v249 offset:21504
ds_read_u16_d16_hi v141, v141
ds_read_u16_d16_hi v143, v143
v_mfma_f32_32x32x16_bf16 v[120:135], v[232:235], v[184:187], v[120:135]
v_rcp_f16 v154, v153
v_fmac_f32 v164, v201, v201
v_bfe_u32 v144, v145, 2, 14
v_rcp_f16 v151, v150
v_fmac_f32 v164, v202, v202
v_lshrrev_b32 v145, 18, v145
v_rcp_f16 v148, v147
v_fmac_f32 v164, v203, v203
v_or_b32 v72, v136, v137
ds_read_b128 v[232:235], v249 offset:19456
ds_read_u16_d16 v144, v144
ds_read_u16_d16_hi v145, v145
v_mfma_f32_32x32x16_bf16 v[120:135], v[236:239], v[188:191], v[120:135]
s_waitcnt lgkmcnt(6)
v_or_b32 v73, v138, v139
v_rcp_f16_sdwa v154, v153 dst_sel:WORD_1 dst_unused:UNUSED_PRESERVE src0_sel:WORD_1
v_fmac_f32 v164, v204, v204
s_waitcnt lgkmcnt(4)
v_or_b32_e64 v74, v140, v141
v_rcp_f16_sdwa v151, v150 dst_sel:WORD_1 dst_unused:UNUSED_PRESERVE src0_sel:WORD_1
v_fmac_f32 v164, v205, v205
s_waitcnt lgkmcnt(3)
v_or_b32_e64 v75, v142, v143
v_rcp_f16_sdwa v148, v147 dst_sel:WORD_1 dst_unused:UNUSED_PRESERVE src0_sel:WORD_1
v_fmac_f32 v164, v206, v206
s_waitcnt lgkmcnt(0)
v_or_b32_e64 v76, v144, v145
v_pk_mul_f16 v77, v155, v154
v_fmac_f32 v164, v207, v207
v_pk_mul_f16 v78, v152, v151
v_pk_mul_f16 v79, v149, v148
s_setprio 1
ds_read_b128 v[236:239], v249 offset:22528
v_mfma_f32_32x32x16_f16 v[192:207], v[72:75], v[240:243], 0
v_cvt_pkrtz_f16_f32 v137, v120, v121
v_cvt_pkrtz_f16_f32 v139, v122, v123
v_cvt_pkrtz_f16_f32 v141, v124, v125
v_cvt_pkrtz_f16_f32 v143, v126, v127
v_cvt_pkrtz_f16_f32 v145, v128, v129
v_mfma_f32_32x32x16_f16 v[192:207], v[76:79], v[244:247], v[192:207]
v_cvt_pk_f16_f32 v155, v130, v131
v_cvt_pk_f16_f32 v152, v132, v133
v_cvt_pk_f16_f32 v149, v134, v135
v_pk_fma_f16 v154, v155, v155, s48
v_and_b32_e64 v137, s49, v137
v_pk_fma_f16 v151, v152, v152, s48
v_mfma_f32_32x32x16_bf16 v[120:135], v[224:227], v[168:171], 0
v_and_b32_e64 v139, s49, v139
v_pk_fma_f16 v148, v149, v149, s48
v_pk_mul_f16 v154, v155, v154
v_bfe_u32 v136, v137, 2, 14
v_pk_mul_f16 v151, v152, v151
v_pk_mul_f16 v148, v149, v148
v_bfe_u32 v138, v139, 2, 14
v_fmac_f32 v165, v192, v192
v_exp_f16 v153, v154
v_fmac_f32_e64 v165, v193, v193
ds_read_b128 v[224:227], v249 offset:20480
ds_read_u16_d16 v136, v136
ds_read_u16_d16 v138, v138
v_mfma_f32_32x32x16_bf16 v[120:135], v[228:231], v[172:175], v[120:135]
v_lshrrev_b32 v137, 18, v137
v_exp_f16 v150, v151
v_fmac_f32 v165, v194, v194
v_lshrrev_b32 v139, 18, v139
v_exp_f16 v147, v148
v_fmac_f32 v165, v195, v195
v_and_b32 v141, s49, v141
v_fmac_f32 v165, v196, v196
v_and_b32_e64 v143, s49, v143
ds_read_b128 v[228:231], v249 offset:23552
ds_read_u16_d16_hi v137, v137
ds_read_u16_d16_hi v139, v139
v_mfma_f32_32x32x16_bf16 v[120:135], v[232:235], v[176:179], v[120:135]
v_exp_f16_sdwa v153, v154 dst_sel:WORD_1 dst_unused:UNUSED_PRESERVE src0_sel:WORD_1
v_fmac_f32_e64 v165, v197, v197
v_bfe_u32 v140, v141, 2, 14
v_exp_f16_sdwa v150, v151 dst_sel:WORD_1 dst_unused:UNUSED_PRESERVE src0_sel:WORD_1
v_fmac_f32_e64 v165, v198, v198
v_bfe_u32 v142, v143, 2, 14
v_exp_f16_sdwa v147, v148 dst_sel:WORD_1 dst_unused:UNUSED_PRESERVE src0_sel:WORD_1
v_fmac_f32 v165, v199, v199
s_waitcnt lgkmcnt(5)
ds_read_b128 v[232:235], v248 offset:40960
ds_read_u16_d16 v140, v140
ds_read_u16_d16 v142, v142
v_mfma_f32_32x32x16_bf16 v[120:135], v[236:239], v[180:183], v[120:135]
v_lshrrev_b32 v141, 18, v141
v_fmac_f32 v165, v200, v200
v_pk_add_f16 v153, v153, 1.0 op_sel_hi:[1,0]
v_lshrrev_b32_e64 v143, 18, v143
v_pk_add_f16 v150, v150, 1.0 op_sel_hi:[1,0]
v_fmac_f32_e64 v165, v201, v201
v_pk_add_f16 v147, v147, 1.0 op_sel_hi:[1,0]
v_and_b32 v145, s49, v145
v_fmac_f32 v165, v202, v202
v_rcp_f16_e64 v154, v153
ds_read_b128 v[236:239], v248 offset:44032
ds_read_u16_d16_hi v141, v141
ds_read_u16_d16_hi v143, v143
v_mfma_f32_32x32x16_bf16 v[120:135], v[224:227], v[184:187], v[120:135]
v_bfe_u32 v144, v145, 2, 14
v_fmac_f32 v165, v203, v203
v_rcp_f16 v151, v150
s_setprio 0
v_fmac_f32 v165, v204, v204
v_lshrrev_b32 v145, 18, v145
v_rcp_f16 v148, v147
v_fmac_f32 v165, v205, v205
s_waitcnt lgkmcnt(4)
v_or_b32 v80, v136, v137
v_or_b32 v81, v138, v139
ds_read_b128 v[224:227], v248 offset:41984
ds_read_u16_d16 v144, v144
ds_read_u16_d16_hi v145, v145
v_mfma_f32_32x32x16_bf16 v[120:135], v[228:231], v[188:191], v[120:135]
v_fmac_f32_e64 v165, v206, v206
v_rcp_f16_sdwa v154, v153 dst_sel:WORD_1 dst_unused:UNUSED_PRESERVE src0_sel:WORD_1
s_waitcnt lgkmcnt(4)
v_or_b32 v82, v140, v141
v_fmac_f32_e64 v165, v207, v207
v_rcp_f16_sdwa v151, v150 dst_sel:WORD_1 dst_unused:UNUSED_PRESERVE src0_sel:WORD_1
s_nop 0
v_permlane32_swap_b32 v164, v165
s_waitcnt lgkmcnt(3)
v_or_b32 v83, v142, v143
v_rcp_f16_sdwa v148, v147 dst_sel:WORD_1 dst_unused:UNUSED_PRESERVE src0_sel:WORD_1
s_waitcnt lgkmcnt(0)
v_or_b32 v84, v144, v145
v_pk_mul_f16 v85, v155, v154
v_add_f32 v164, v164, v165
ds_write_b32 v255, v164 offset:8192
v_pk_mul_f16 v86, v152, v151
v_pk_mul_f16 v87, v149, v148
s_setprio 2
ds_read_b128 v[228:231], v248 offset:45056
v_mfma_f32_32x32x16_f16 v[192:207], v[80:83], v[240:243], 0
v_cvt_pkrtz_f16_f32 v137, v120, v121
v_cvt_pkrtz_f16_f32 v139, v122, v123
v_cvt_pkrtz_f16_f32 v141, v124, v125
v_cvt_pkrtz_f16_f32 v143, v126, v127
v_cvt_pkrtz_f16_f32 v145, v128, v129
v_mfma_f32_32x32x16_f16 v[192:207], v[84:87], v[244:247], v[192:207]
v_cvt_pk_f16_f32 v155, v130, v131
v_cvt_pk_f16_f32 v152, v132, v133
v_cvt_pk_f16_f32 v149, v134, v135
v_pk_fma_f16 v154, v155, v155, s48
v_and_b32_e64 v137, s49, v137
v_mfma_f32_32x32x16_bf16 v[120:135], v[232:235], v[96:99], 0
v_pk_fma_f16 v151, v152, v152, s48
v_and_b32_e64 v139, s49, v139
v_pk_fma_f16 v148, v149, v149, s48
v_pk_mul_f16 v154, v155, v154
v_bfe_u32 v136, v137, 2, 14
v_pk_mul_f16 v151, v152, v151
v_pk_mul_f16 v148, v149, v148
v_bfe_u32 v138, v139, 2, 14
v_fmac_f32 v166, v192, v192
v_exp_f16 v153, v154
ds_read_b128 v[232:235], v248 offset:43008
ds_read_u16_d16 v136, v136
ds_read_u16_d16 v138, v138
v_mfma_f32_32x32x16_bf16 v[120:135], v[236:239], v[100:103], v[120:135]
v_fmac_f32 v166, v193, v193
v_lshrrev_b32 v137, 18, v137
v_exp_f16 v150, v151
v_fmac_f32 v166, v194, v194
v_lshrrev_b32 v139, 18, v139
v_exp_f16 v147, v148
v_fmac_f32 v166, v195, v195
v_and_b32 v141, s49, v141
ds_read_b128 v[236:239], v248 offset:46080
ds_read_u16_d16_hi v137, v137
ds_read_u16_d16_hi v139, v139
v_mfma_f32_32x32x16_bf16 v[120:135], v[224:227], v[104:107], v[120:135]
v_and_b32_e64 v143, s49, v143
v_exp_f16_sdwa v153, v154 dst_sel:WORD_1 dst_unused:UNUSED_PRESERVE src0_sel:WORD_1
v_fmac_f32_e64 v166, v196, v196
v_bfe_u32 v140, v141, 2, 14
v_exp_f16_sdwa v150, v151 dst_sel:WORD_1 dst_unused:UNUSED_PRESERVE src0_sel:WORD_1
v_fmac_f32 v166, v197, v197
v_bfe_u32 v142, v143, 2, 14
v_exp_f16_sdwa v147, v148 dst_sel:WORD_1 dst_unused:UNUSED_PRESERVE src0_sel:WORD_1
s_waitcnt lgkmcnt(6)
ds_read_b128 v[224:227], v248 offset:47104
ds_read_u16_d16 v140, v140
ds_read_u16_d16 v142, v142
v_mfma_f32_32x32x16_bf16 v[120:135], v[228:231], v[108:111], v[120:135]
v_fmac_f32 v166, v198, v198
v_lshrrev_b32 v141, 18, v141
v_pk_add_f16 v153, v153, 1.0 op_sel_hi:[1,0]
v_fmac_f32 v166, v199, v199
v_lshrrev_b32 v143, 18, v143
v_pk_add_f16 v150, v150, 1.0 op_sel_hi:[1,0]
v_pk_add_f16 v147, v147, 1.0 op_sel_hi:[1,0]
v_fmac_f32_e64 v166, v200, v200
v_and_b32 v145, s49, v145
s_waitcnt lgkmcnt(4)
ds_read_b128 v[228:231], v248 offset:50176
ds_read_u16_d16_hi v141, v141
ds_read_u16_d16_hi v143, v143
v_mfma_f32_32x32x16_bf16 v[120:135], v[232:235], v[112:115], v[120:135]
v_rcp_f16 v154, v153
v_fmac_f32 v166, v201, v201
v_bfe_u32 v144, v145, 2, 14
v_rcp_f16 v151, v150
v_fmac_f32 v166, v202, v202
v_lshrrev_b32 v145, 18, v145
v_rcp_f16 v148, v147
v_fmac_f32 v166, v203, v203
v_or_b32 v88, v136, v137
ds_read_b128 v[232:235], v248 offset:48128
ds_read_u16_d16 v144, v144
ds_read_u16_d16_hi v145, v145
v_mfma_f32_32x32x16_bf16 v[120:135], v[236:239], v[116:119], v[120:135]
s_waitcnt lgkmcnt(6)
v_or_b32 v89, v138, v139
v_rcp_f16_sdwa v154, v153 dst_sel:WORD_1 dst_unused:UNUSED_PRESERVE src0_sel:WORD_1
v_fmac_f32 v166, v204, v204
s_waitcnt lgkmcnt(4)
v_or_b32_e64 v90, v140, v141
v_rcp_f16_sdwa v151, v150 dst_sel:WORD_1 dst_unused:UNUSED_PRESERVE src0_sel:WORD_1
v_fmac_f32 v166, v205, v205
s_waitcnt lgkmcnt(3)
v_or_b32_e64 v91, v142, v143
v_rcp_f16_sdwa v148, v147 dst_sel:WORD_1 dst_unused:UNUSED_PRESERVE src0_sel:WORD_1
v_fmac_f32 v166, v206, v206
s_waitcnt lgkmcnt(0)
v_or_b32_e64 v92, v144, v145
v_pk_mul_f16 v93, v155, v154
v_fmac_f32 v166, v207, v207
v_pk_mul_f16 v94, v152, v151
v_pk_mul_f16 v95, v149, v148
s_setprio 1
ds_read_b128 v[236:239], v248 offset:51200
v_mfma_f32_32x32x16_f16 v[192:207], v[88:91], v[240:243], 0
v_cvt_pkrtz_f16_f32 v137, v120, v121
v_cvt_pkrtz_f16_f32 v139, v122, v123
v_cvt_pkrtz_f16_f32 v141, v124, v125
v_cvt_pkrtz_f16_f32 v143, v126, v127
v_cvt_pkrtz_f16_f32 v145, v128, v129
v_mfma_f32_32x32x16_f16 v[192:207], v[92:95], v[244:247], v[192:207]
v_cvt_pk_f16_f32 v155, v130, v131
v_cvt_pk_f16_f32 v152, v132, v133
v_cvt_pk_f16_f32 v149, v134, v135
v_pk_fma_f16 v154, v155, v155, s48
v_and_b32_e64 v137, s49, v137
v_pk_fma_f16 v151, v152, v152, s48
v_mfma_f32_32x32x16_bf16 v[120:135], v[224:227], v[96:99], 0
v_and_b32_e64 v139, s49, v139
v_pk_fma_f16 v148, v149, v149, s48
v_pk_mul_f16 v154, v155, v154
v_bfe_u32 v136, v137, 2, 14
v_pk_mul_f16 v151, v152, v151
v_pk_mul_f16 v148, v149, v148
v_fmac_f32 v167, v192, v192
v_fmac_f32 v167, v193, v193
v_fmac_f32 v167, v194, v194
v_fmac_f32 v167, v195, v195
v_fmac_f32_e64 v167, v196, v196
ds_read_b128 v[224:227], v248 offset:49152
ds_read_u16_d16 v136, v136
v_mfma_f32_32x32x16_bf16 v[120:135], v[228:231], v[100:103], v[120:135]
v_fmac_f32 v167, v197, v197
v_fmac_f32 v167, v198, v198
v_fmac_f32 v167, v199, v199
v_fmac_f32 v167, v200, v200
v_fmac_f32 v167, v201, v201
v_fmac_f32 v167, v202, v202
v_fmac_f32 v167, v203, v203
v_fmac_f32 v167, v204, v204
v_fmac_f32 v167, v205, v205
v_fmac_f32 v167, v206, v206
v_fmac_f32_e64 v167, v207, v207
ds_read_b128 v[228:231], v248 offset:52224
v_mfma_f32_32x32x16_bf16 v[120:135], v[232:235], v[104:107], v[120:135]
v_permlane32_swap_b32 v166, v167
v_add_f32 v166, v166, v167
ds_write_b32 v255, v166 offset:8448
s_setprio 3
s_mov_b64 exec, 1
ds_add_rtn_u32 v242, v253, v254
s_mov_b64 exec, -1
s_waitcnt lgkmcnt(0)
v_readfirstlane_b32 s43, v242
s_nop 1
s_cmp_lg_u32 s43, 7
s_cbranch_scc1 Lnopub
v_min_u32 v243, 47, v251
v_lshlrev_b32 v244, 5, v243
v_add_u32 v244, 97280, v244
ds_read_b128 v[176:179], v244
ds_read_b128 v[180:183], v244 offset:16
ds_read_b128 v[184:187], v244 offset:9216
ds_read_b128 v[188:191], v244 offset:9232
ds_read_b128 v[192:195], v244 offset:18432
ds_read_b128 v[196:199], v244 offset:18448
ds_read_b128 v[200:203], v244 offset:27648
ds_read_b128 v[204:207], v244 offset:27664
ds_read_b128 v[156:159], v244 offset:36864
ds_read_b128 v[160:163], v244 offset:36880
v_lshlrev_b32_e64 v246, 13, v243
v_add_u32 v247, 4096, v246
s_waitcnt lgkmcnt(7)
v_add_f32 v176, v176, v184
v_add_f32 v177, v177, v185
v_add_f32 v178, v178, v186
v_add_f32 v179, v179, v187
s_waitcnt lgkmcnt(6)
v_add_f32 v180, v180, v188
v_add_f32 v181, v181, v189
v_add_f32 v182, v182, v190
v_add_f32 v183, v183, v191
ds_read_b128 v[184:187], v244 offset:46080
ds_read_b128 v[188:191], v244 offset:46096
s_waitcnt lgkmcnt(5)
v_add_f32 v192, v192, v200
v_add_f32 v193, v193, v201
v_add_f32 v194, v194, v202
v_add_f32 v195, v195, v203
s_waitcnt lgkmcnt(4)
v_add_f32 v196, v196, v204
v_add_f32 v197, v197, v205
v_add_f32 v198, v198, v206
v_add_f32 v199, v199, v207
ds_read_b128 v[200:203], v244 offset:55296
ds_read_b128 v[204:207], v244 offset:55312
v_add_f32 v176, v176, v192
v_add_f32 v177, v177, v193
v_add_f32 v178, v178, v194
v_add_f32 v179, v179, v195
v_add_f32 v180, v180, v196
v_add_f32 v181, v181, v197
v_add_f32 v182, v182, v198
v_add_f32 v183, v183, v199
ds_read_b128 v[192:195], v244 offset:64512
ds_read_b128 v[196:199], v244 offset:64528
s_waitcnt lgkmcnt(5)
v_add_f32 v156, v156, v184
v_add_f32 v157, v157, v185
v_add_f32 v158, v158, v186
v_add_f32 v159, v159, v187
s_waitcnt lgkmcnt(4)
v_add_f32 v160, v160, v188
v_add_f32 v161, v161, v189
v_add_f32 v162, v162, v190
v_add_f32 v163, v163, v191
s_waitcnt lgkmcnt(1)
v_add_f32 v200, v200, v192
v_add_f32 v201, v201, v193
v_add_f32 v202, v202, v194
v_add_f32 v203, v203, v195
s_waitcnt lgkmcnt(0)
v_add_f32 v204, v204, v196
v_add_f32 v205, v205, v197
v_add_f32 v206, v206, v198
v_add_f32 v207, v207, v199
v_add_f32 v156, v156, v200
v_add_f32 v157, v157, v201
v_add_f32 v158, v158, v202
v_add_f32 v159, v159, v203
v_add_f32 v160, v160, v204
v_add_f32 v161, v161, v205
v_add_f32 v162, v162, v206
v_add_f32 v163, v163, v207
v_add_f32 v176, v176, v156
v_add_f32 v177, v177, v157
v_add_f32 v178, v178, v158
v_add_f32 v179, v179, v159
v_add_f32 v180, v180, v160
v_add_f32 v181, v181, v161
v_add_f32 v182, v182, v162
v_add_f32 v183, v183, v163
v_min_u32 v184, -2, v176
v_min_u32 v185, -2, v177
v_min_u32 v186, -2, v178
v_min_u32 v187, -2, v179
v_min_u32 v188, -2, v180
v_min_u32 v189, -2, v181
v_min_u32_e64 v190, -2, v182
v_min_u32 v191, -2, v183
s_lshl_b32 s43, s2, 4
buffer_store_dwordx4 v[184:187], v246, s[32:35], s43 offen sc1
buffer_store_dwordx4 v[188:191], v247, s[32:35], s43 offen sc1
ds_write_b32 v253, v254 offset:4
s_nop 1
Lnopub:
s_mov_b32 s77, 0
s_cmp_lg_u32 s40, 0
s_cbranch_scc1 Lnorole
v_lshlrev_b32_e64 v247, 2, v251
buffer_load_dword v244, v247, s[24:27], 0 offen offset:0
buffer_load_dword v245, v247, s[24:27], 0 offen offset:256
buffer_load_dword v246, v247, s[24:27], 0 offen offset:512
s_cmp_lt_u32 s2, 96
s_cselect_b32 s77, 1, 2
s_waitcnt lgkmcnt(0)
v_mov_b32 v156, -1
v_mov_b32 v157, -1
v_mov_b32 v158, -1
v_mov_b32 v159, -1
v_mov_b32 v160, -1
v_mov_b32 v161, -1
v_mov_b32 v162, -1
v_mov_b32 v163, -1
v_mov_b32 v164, -1
v_mov_b32 v165, -1
v_mov_b32 v166, -1
v_mov_b32 v167, -1
v_mov_b32 v240, -1
v_mov_b32 v241, -1
v_mov_b32 v242, -1
v_mov_b32 v243, -1
s_call_b64 s[78:79], Lpoll1
Lnorole:
s_setprio 1
v_bfe_u32 v138, v139, 2, 14
v_exp_f16 v153, v154
v_lshrrev_b32 v137, 18, v137
v_exp_f16 v150, v151
v_lshrrev_b32 v139, 18, v139
ds_read_b128 v[232:235], v248 offset:53248
ds_read_u16_d16 v138, v138
ds_read_u16_d16_hi v137, v137
ds_read_u16_d16_hi v139, v139
v_mfma_f32_32x32x16_bf16 v[120:135], v[236:239], v[108:111], v[120:135]
v_exp_f16 v147, v148
v_and_b32 v141, s49, v141
v_and_b32_e64 v143, s49, v143
v_exp_f16_sdwa v153, v154 dst_sel:WORD_1 dst_unused:UNUSED_PRESERVE src0_sel:WORD_1
v_bfe_u32 v140, v141, 2, 14
v_exp_f16_sdwa v150, v151 dst_sel:WORD_1 dst_unused:UNUSED_PRESERVE src0_sel:WORD_1
v_bfe_u32 v142, v143, 2, 14
v_exp_f16_sdwa v147, v148 dst_sel:WORD_1 dst_unused:UNUSED_PRESERVE src0_sel:WORD_1
ds_read_b128 v[236:239], v248 offset:56320
ds_read_u16_d16 v140, v140
ds_read_u16_d16 v142, v142
v_mfma_f32_32x32x16_bf16 v[120:135], v[224:227], v[112:115], v[120:135]
v_lshrrev_b32_e64 v141, 18, v141
v_pk_add_f16 v153, v153, 1.0 op_sel_hi:[1,0]
v_lshrrev_b32 v143, 18, v143
v_pk_add_f16 v150, v150, 1.0 op_sel_hi:[1,0]
s_setprio 0
v_pk_add_f16 v147, v147, 1.0 op_sel_hi:[1,0]
v_and_b32 v145, s49, v145
v_rcp_f16 v154, v153
v_bfe_u32 v144, v145, 2, 14
v_rcp_f16_e64 v151, v150
ds_read_b128 v[224:227], v248 offset:54272
ds_read_u16_d16_hi v141, v141
ds_read_u16_d16_hi v143, v143
ds_read_u16_d16 v144, v144
v_mfma_f32_32x32x16_bf16 v[120:135], v[228:231], v[116:119], v[120:135]
v_lshrrev_b32 v145, 18, v145
v_rcp_f16 v148, v147
s_waitcnt lgkmcnt(7)
v_or_b32 v168, v136, v137
v_or_b32_e64 v169, v138, v139
v_rcp_f16_sdwa v154, v153 dst_sel:WORD_1 dst_unused:UNUSED_PRESERVE src0_sel:WORD_1
s_waitcnt lgkmcnt(2)
v_or_b32 v170, v140, v141
v_rcp_f16_sdwa v151, v150 dst_sel:WORD_1 dst_unused:UNUSED_PRESERVE src0_sel:WORD_1
s_waitcnt lgkmcnt(1)
v_or_b32 v171, v142, v143
v_rcp_f16_sdwa v148, v147 dst_sel:WORD_1 dst_unused:UNUSED_PRESERVE src0_sel:WORD_1
ds_read_u16_d16_hi v145, v145
s_waitcnt lgkmcnt(0)
v_or_b32 v172, v144, v145
v_pk_mul_f16 v173, v155, v154
v_pk_mul_f16 v174, v152, v151
v_pk_mul_f16 v175, v149, v148
s_cmp_eq_u32 s77, 0
s_cbranch_scc1 Lpp49
s_getreg_b32 s43, hwreg(HW_REG_IB_STS, 0, 4)
s_cmp_lg_u32 s43, 0
s_cbranch_scc1 Lpp49
s_call_b64 s[78:79], Lpoll
s_setprio 0
Lpp49:
s_setprio 2
v_cvt_pkrtz_f16_f32 v137, v120, v121
v_cvt_pkrtz_f16_f32 v139, v122, v123
v_cvt_pkrtz_f16_f32 v141, v124, v125
v_cvt_pkrtz_f16_f32 v143, v126, v127
v_cvt_pkrtz_f16_f32 v145, v128, v129
v_cvt_pk_f16_f32 v155, v130, v131
v_cvt_pk_f16_f32 v152, v132, v133
v_cvt_pk_f16_f32 v149, v134, v135
ds_read_b128 v[228:231], v248 offset:57344
v_mfma_f32_32x32x16_bf16 v[120:135], v[232:235], v[96:99], 0
v_pk_fma_f16 v154, v155, v155, s48
v_and_b32_e64 v137, s49, v137
v_pk_fma_f16 v151, v152, v152, s48
v_and_b32_e64 v139, s49, v139
v_pk_fma_f16 v148, v149, v149, s48
v_pk_mul_f16 v154, v155, v154
v_bfe_u32 v136, v137, 2, 14
v_pk_mul_f16 v151, v152, v151
ds_read_b128 v[232:235], v248 offset:55296
ds_read_u16_d16 v136, v136
v_mfma_f32_32x32x16_bf16 v[120:135], v[236:239], v[100:103], v[120:135]
v_pk_mul_f16 v148, v149, v148
v_bfe_u32 v138, v139, 2, 14
v_exp_f16 v153, v154
v_lshrrev_b32 v137, 18, v137
v_exp_f16 v150, v151
v_lshrrev_b32 v139, 18, v139
ds_read_b128 v[236:239], v248 offset:58368
ds_read_u16_d16 v138, v138
ds_read_u16_d16_hi v137, v137
ds_read_u16_d16_hi v139, v139
v_mfma_f32_32x32x16_bf16 v[120:135], v[224:227], v[104:107], v[120:135]
v_exp_f16 v147, v148
v_and_b32 v141, s49, v141
v_and_b32 v143, s49, v143
v_exp_f16_sdwa v153, v154 dst_sel:WORD_1 dst_unused:UNUSED_PRESERVE src0_sel:WORD_1
v_bfe_u32 v140, v141, 2, 14
v_exp_f16_sdwa v150, v151 dst_sel:WORD_1 dst_unused:UNUSED_PRESERVE src0_sel:WORD_1
s_waitcnt lgkmcnt(6)
ds_read_b128 v[224:227], v248 offset:59392
ds_read_u16_d16 v140, v140
v_mfma_f32_32x32x16_bf16 v[120:135], v[228:231], v[108:111], v[120:135]
v_bfe_u32 v142, v143, 2, 14
v_exp_f16_sdwa v147, v148 dst_sel:WORD_1 dst_unused:UNUSED_PRESERVE src0_sel:WORD_1
v_lshrrev_b32_e64 v141, 18, v141
v_pk_add_f16 v153, v153, 1.0 op_sel_hi:[1,0]
v_lshrrev_b32 v143, 18, v143
v_pk_add_f16 v150, v150, 1.0 op_sel_hi:[1,0]
v_pk_add_f16 v147, v147, 1.0 op_sel_hi:[1,0]
s_waitcnt lgkmcnt(6)
ds_read_b128 v[228:231], v248 offset:62464
ds_read_u16_d16 v142, v142
ds_read_u16_d16_hi v141, v141
ds_read_u16_d16_hi v143, v143
v_mfma_f32_32x32x16_bf16 v[120:135], v[232:235], v[112:115], v[120:135]
v_and_b32 v145, s49, v145
v_rcp_f16 v154, v153
v_bfe_u32 v144, v145, 2, 14
v_rcp_f16_e64 v151, v150
v_lshrrev_b32 v145, 18, v145
s_waitcnt lgkmcnt(6)
ds_read_b128 v[232:235], v248 offset:60416
ds_read_u16_d16 v144, v144
ds_read_u16_d16_hi v145, v145
v_mfma_f32_32x32x16_bf16 v[120:135], v[236:239], v[116:119], v[120:135]
v_rcp_f16 v148, v147
v_or_b32 v176, v136, v137
v_or_b32_e64 v177, v138, v139
v_rcp_f16_sdwa v154, v153 dst_sel:WORD_1 dst_unused:UNUSED_PRESERVE src0_sel:WORD_1
s_waitcnt lgkmcnt(4)
v_or_b32 v178, v140, v141
v_rcp_f16_sdwa v151, v150 dst_sel:WORD_1 dst_unused:UNUSED_PRESERVE src0_sel:WORD_1
s_waitcnt lgkmcnt(3)
v_or_b32 v179, v142, v143
v_rcp_f16_sdwa v148, v147 dst_sel:WORD_1 dst_unused:UNUSED_PRESERVE src0_sel:WORD_1
s_waitcnt lgkmcnt(0)
v_or_b32 v180, v144, v145
v_pk_mul_f16 v181, v155, v154
v_pk_mul_f16 v182, v152, v151
v_pk_mul_f16 v183, v149, v148
s_cmp_eq_u32 s77, 0
s_cbranch_scc1 Lpp50
s_getreg_b32 s43, hwreg(HW_REG_IB_STS, 0, 4)
s_cmp_lg_u32 s43, 0
s_cbranch_scc1 Lpp50
s_call_b64 s[78:79], Lpoll
s_setprio 2
Lpp50:
s_setprio 1
v_cvt_pkrtz_f16_f32 v137, v120, v121
v_cvt_pkrtz_f16_f32 v139, v122, v123
v_cvt_pkrtz_f16_f32 v141, v124, v125
v_cvt_pkrtz_f16_f32 v143, v126, v127
v_cvt_pkrtz_f16_f32 v145, v128, v129
v_cvt_pk_f16_f32 v155, v130, v131
v_cvt_pk_f16_f32 v152, v132, v133
v_cvt_pk_f16_f32 v149, v134, v135
ds_read_b128 v[236:239], v248 offset:63488
v_mfma_f32_32x32x16_bf16 v[120:135], v[224:227], v[96:99], 0
v_pk_fma_f16 v154, v155, v155, s48
v_and_b32_e64 v137, s49, v137
v_pk_fma_f16 v151, v152, v152, s48
v_and_b32_e64 v139, s49, v139
v_pk_fma_f16 v148, v149, v149, s48
v_pk_mul_f16 v154, v155, v154
v_bfe_u32 v136, v137, 2, 14
v_pk_mul_f16 v151, v152, v151
ds_read_b128 v[224:227], v248 offset:61440
ds_read_u16_d16 v136, v136
v_mfma_f32_32x32x16_bf16 v[120:135], v[228:231], v[100:103], v[120:135]
v_pk_mul_f16 v148, v149, v148
v_bfe_u32 v138, v139, 2, 14
v_exp_f16 v153, v154
v_lshrrev_b32 v137, 18, v137
v_exp_f16 v150, v151
v_lshrrev_b32 v139, 18, v139
ds_read_b128 v[228:231], v248 offset:64512
ds_read_u16_d16 v138, v138
ds_read_u16_d16_hi v137, v137
ds_read_u16_d16_hi v139, v139
v_mfma_f32_32x32x16_bf16 v[120:135], v[232:235], v[104:107], v[120:135]
v_exp_f16 v147, v148
v_and_b32 v141, s49, v141
v_and_b32 v143, s49, v143
v_exp_f16_sdwa v153, v154 dst_sel:WORD_1 dst_unused:UNUSED_PRESERVE src0_sel:WORD_1
v_bfe_u32 v140, v141, 2, 14
v_exp_f16_sdwa v150, v151 dst_sel:WORD_1 dst_unused:UNUSED_PRESERVE src0_sel:WORD_1
s_waitcnt lgkmcnt(6)
ds_read_b128 v[232:235], v249
ds_read_u16_d16 v140, v140
v_mfma_f32_32x32x16_bf16 v[120:135], v[236:239], v[108:111], v[120:135]
v_bfe_u32 v142, v143, 2, 14
v_exp_f16_sdwa v147, v148 dst_sel:WORD_1 dst_unused:UNUSED_PRESERVE src0_sel:WORD_1
v_lshrrev_b32_e64 v141, 18, v141
v_pk_add_f16 v153, v153, 1.0 op_sel_hi:[1,0]
v_lshrrev_b32 v143, 18, v143
v_pk_add_f16 v150, v150, 1.0 op_sel_hi:[1,0]
v_pk_add_f16 v147, v147, 1.0 op_sel_hi:[1,0]
s_waitcnt lgkmcnt(6)
ds_read_b128 v[236:239], v249 offset:3072
ds_read_u16_d16 v142, v142
ds_read_u16_d16_hi v141, v141
ds_read_u16_d16_hi v143, v143
v_mfma_f32_32x32x16_bf16 v[120:135], v[224:227], v[112:115], v[120:135]
v_and_b32 v145, s49, v145
v_rcp_f16 v154, v153
v_bfe_u32 v144, v145, 2, 14
s_setprio 0
v_rcp_f16 v151, v150
v_lshrrev_b32 v145, 18, v145
s_waitcnt lgkmcnt(6)
ds_read_b128 v[224:227], v249 offset:1024
ds_read_u16_d16 v144, v144
ds_read_u16_d16_hi v145, v145
v_mfma_f32_32x32x16_bf16 v[120:135], v[228:231], v[116:119], v[120:135]
v_rcp_f16 v148, v147
v_or_b32 v184, v136, v137
v_or_b32_e64 v185, v138, v139
v_rcp_f16_sdwa v154, v153 dst_sel:WORD_1 dst_unused:UNUSED_PRESERVE src0_sel:WORD_1
s_waitcnt lgkmcnt(4)
v_or_b32 v186, v140, v141
v_rcp_f16_sdwa v151, v150 dst_sel:WORD_1 dst_unused:UNUSED_PRESERVE src0_sel:WORD_1
s_waitcnt lgkmcnt(3)
v_or_b32 v187, v142, v143
v_rcp_f16_sdwa v148, v147 dst_sel:WORD_1 dst_unused:UNUSED_PRESERVE src0_sel:WORD_1
s_waitcnt lgkmcnt(0)
v_or_b32_e64 v188, v144, v145
v_pk_mul_f16 v189, v155, v154
v_pk_mul_f16 v190, v152, v151
v_pk_mul_f16 v191, v149, v148
s_cmp_eq_u32 s77, 0
s_cbranch_scc1 Lpp51
s_getreg_b32 s43, hwreg(HW_REG_IB_STS, 0, 4)
s_cmp_lg_u32 s43, 0
s_cbranch_scc1 Lpp51
s_call_b64 s[78:79], Lpoll
s_setprio 0
Lpp51:
v_mov_b32 v253, 16256
Lw2w:
ds_read_b32 v254, v253 offset:4
s_waitcnt lgkmcnt(0)
v_readfirstlane_b32 s43, v254
s_cmp_eq_u32 s76, 0
s_cbranch_scc1 Lw2x
s_sub_u32 s76, s76, 1
s_cmp_lt_u32 s43, 1
s_cbranch_scc0 Lw2x
s_sleep 2
s_branch Lw2w
Lw2x:
s_add_u32 m0, s72, 7168
s_add_u32 s43, s82, 6208
buffer_load_dwordx4 v252, s[16:19], s43 offen lds
s_add_u32 m0, s72, 8192
s_add_u32 s43, s82, 6272
buffer_load_dwordx4 v252, s[16:19], s43 offen lds
s_setprio 2
v_cvt_pkrtz_f16_f32 v137, v120, v121
v_cvt_pkrtz_f16_f32 v139, v122, v123
v_cvt_pkrtz_f16_f32 v141, v124, v125
v_cvt_pkrtz_f16_f32 v143, v126, v127
v_cvt_pkrtz_f16_f32 v145, v128, v129
v_cvt_pk_f16_f32 v155, v130, v131
v_cvt_pk_f16_f32 v152, v132, v133
v_cvt_pk_f16_f32 v149, v134, v135
ds_read_b128 v[228:231], v249 offset:4096
v_mfma_f32_32x32x16_bf16 v[120:135], v[232:235], v[96:99], 0
v_pk_fma_f16 v154, v155, v155, s48
v_and_b32_e64 v137, s49, v137
v_pk_fma_f16 v151, v152, v152, s48
v_and_b32_e64 v139, s49, v139
v_pk_fma_f16 v148, v149, v149, s48
v_pk_mul_f16 v154, v155, v154
v_bfe_u32 v136, v137, 2, 14
v_pk_mul_f16 v151, v152, v151
ds_read_b128 v[232:235], v249 offset:2048
ds_read_u16_d16 v136, v136
v_mfma_f32_32x32x16_bf16 v[120:135], v[236:239], v[100:103], v[120:135]
v_pk_mul_f16 v148, v149, v148
v_bfe_u32 v138, v139, 2, 14
v_exp_f16 v153, v154
v_lshrrev_b32 v137, 18, v137
v_exp_f16 v150, v151
v_lshrrev_b32 v139, 18, v139
ds_read_b128 v[236:239], v249 offset:5120
ds_read_u16_d16 v138, v138
ds_read_u16_d16_hi v137, v137
ds_read_u16_d16_hi v139, v139
v_mfma_f32_32x32x16_bf16 v[120:135], v[224:227], v[104:107], v[120:135]
v_exp_f16 v147, v148
v_and_b32 v141, s49, v141
v_and_b32 v143, s49, v143
v_exp_f16_sdwa v153, v154 dst_sel:WORD_1 dst_unused:UNUSED_PRESERVE src0_sel:WORD_1
v_bfe_u32 v140, v141, 2, 14
v_exp_f16_sdwa v150, v151 dst_sel:WORD_1 dst_unused:UNUSED_PRESERVE src0_sel:WORD_1
s_waitcnt lgkmcnt(6)
ds_read_b128 v[224:227], v249 offset:6144
ds_read_u16_d16 v140, v140
v_mfma_f32_32x32x16_bf16 v[120:135], v[228:231], v[108:111], v[120:135]
v_bfe_u32 v142, v143, 2, 14
v_exp_f16_sdwa v147, v148 dst_sel:WORD_1 dst_unused:UNUSED_PRESERVE src0_sel:WORD_1
v_lshrrev_b32_e64 v141, 18, v141
v_pk_add_f16 v153, v153, 1.0 op_sel_hi:[1,0]
v_lshrrev_b32 v143, 18, v143
v_pk_add_f16 v150, v150, 1.0 op_sel_hi:[1,0]
v_pk_add_f16 v147, v147, 1.0 op_sel_hi:[1,0]
s_waitcnt lgkmcnt(6)
ds_read_b128 v[228:231], v249 offset:9216
ds_read_u16_d16 v142, v142
ds_read_u16_d16_hi v141, v141
ds_read_u16_d16_hi v143, v143
v_mfma_f32_32x32x16_bf16 v[120:135], v[232:235], v[112:115], v[120:135]
v_and_b32 v145, s49, v145
v_rcp_f16 v154, v153
v_bfe_u32 v144, v145, 2, 14
v_rcp_f16_e64 v151, v150
v_lshrrev_b32 v145, 18, v145
s_waitcnt lgkmcnt(6)
ds_read_b128 v[232:235], v249 offset:7168
ds_read_u16_d16 v144, v144
ds_read_u16_d16_hi v145, v145
v_mfma_f32_32x32x16_bf16 v[120:135], v[236:239], v[116:119], v[120:135]
v_rcp_f16 v148, v147
v_or_b32 v192, v136, v137
v_or_b32_e64 v193, v138, v139
v_rcp_f16_sdwa v154, v153 dst_sel:WORD_1 dst_unused:UNUSED_PRESERVE src0_sel:WORD_1
s_waitcnt lgkmcnt(4)
v_or_b32 v194, v140, v141
v_rcp_f16_sdwa v151, v150 dst_sel:WORD_1 dst_unused:UNUSED_PRESERVE src0_sel:WORD_1
s_waitcnt lgkmcnt(3)
v_or_b32 v195, v142, v143
v_rcp_f16_sdwa v148, v147 dst_sel:WORD_1 dst_unused:UNUSED_PRESERVE src0_sel:WORD_1
s_waitcnt lgkmcnt(0)
v_or_b32 v196, v144, v145
v_pk_mul_f16 v197, v155, v154
v_pk_mul_f16 v198, v152, v151
v_pk_mul_f16 v199, v149, v148
s_cmp_eq_u32 s77, 0
s_cbranch_scc1 Lpp52
s_getreg_b32 s43, hwreg(HW_REG_IB_STS, 0, 4)
s_cmp_lg_u32 s43, 0
s_cbranch_scc1 Lpp52
s_call_b64 s[78:79], Lpoll
s_setprio 2
Lpp52:
s_setprio 1
v_cvt_pkrtz_f16_f32 v137, v120, v121
v_cvt_pkrtz_f16_f32 v139, v122, v123
v_cvt_pkrtz_f16_f32 v141, v124, v125
v_cvt_pkrtz_f16_f32 v143, v126, v127
v_cvt_pkrtz_f16_f32 v145, v128, v129
v_cvt_pk_f16_f32 v155, v130, v131
v_cvt_pk_f16_f32 v152, v132, v133
v_cvt_pk_f16_f32 v149, v134, v135
ds_read_b128 v[236:239], v249 offset:10240
v_mfma_f32_32x32x16_bf16 v[120:135], v[224:227], v[96:99], 0
v_pk_fma_f16 v154, v155, v155, s48
v_and_b32_e64 v137, s49, v137
v_pk_fma_f16 v151, v152, v152, s48
v_and_b32_e64 v139, s49, v139
v_pk_fma_f16 v148, v149, v149, s48
v_pk_mul_f16 v154, v155, v154
v_bfe_u32 v136, v137, 2, 14
v_pk_mul_f16 v151, v152, v151
ds_read_b128 v[224:227], v249 offset:8192
ds_read_u16_d16 v136, v136
v_mfma_f32_32x32x16_bf16 v[120:135], v[228:231], v[100:103], v[120:135]
v_pk_mul_f16 v148, v149, v148
v_bfe_u32 v138, v139, 2, 14
v_exp_f16 v153, v154
v_lshrrev_b32 v137, 18, v137
v_exp_f16 v150, v151
v_lshrrev_b32 v139, 18, v139
ds_read_b128 v[228:231], v249 offset:11264
ds_read_u16_d16 v138, v138
ds_read_u16_d16_hi v137, v137
ds_read_u16_d16_hi v139, v139
v_mfma_f32_32x32x16_bf16 v[120:135], v[232:235], v[104:107], v[120:135]
v_exp_f16 v147, v148
v_and_b32 v141, s49, v141
v_and_b32 v143, s49, v143
v_exp_f16_sdwa v153, v154 dst_sel:WORD_1 dst_unused:UNUSED_PRESERVE src0_sel:WORD_1
v_bfe_u32 v140, v141, 2, 14
v_exp_f16_sdwa v150, v151 dst_sel:WORD_1 dst_unused:UNUSED_PRESERVE src0_sel:WORD_1
s_waitcnt lgkmcnt(6)
ds_read_u16_d16 v140, v140
v_mfma_f32_32x32x16_bf16 v[120:135], v[236:239], v[108:111], v[120:135]
v_bfe_u32 v142, v143, 2, 14
v_exp_f16_sdwa v147, v148 dst_sel:WORD_1 dst_unused:UNUSED_PRESERVE src0_sel:WORD_1
v_lshrrev_b32_e64 v141, 18, v141
v_pk_add_f16 v153, v153, 1.0 op_sel_hi:[1,0]
v_lshrrev_b32 v143, 18, v143
v_pk_add_f16 v150, v150, 1.0 op_sel_hi:[1,0]
v_pk_add_f16 v147, v147, 1.0 op_sel_hi:[1,0]
s_waitcnt lgkmcnt(5)
ds_read_u16_d16 v142, v142
ds_read_u16_d16_hi v141, v141
ds_read_u16_d16_hi v143, v143
v_mfma_f32_32x32x16_bf16 v[120:135], v[224:227], v[112:115], v[120:135]
v_and_b32 v145, s49, v145
v_rcp_f16 v154, v153
v_bfe_u32 v144, v145, 2, 14
s_setprio 0
v_rcp_f16 v151, v150
v_lshrrev_b32 v145, 18, v145
s_waitcnt lgkmcnt(4)
ds_read_u16_d16 v144, v144
ds_read_u16_d16_hi v145, v145
v_mfma_f32_32x32x16_bf16 v[120:135], v[228:231], v[116:119], v[120:135]
v_rcp_f16 v148, v147
v_or_b32 v200, v136, v137
v_or_b32_e64 v201, v138, v139
v_rcp_f16_sdwa v154, v153 dst_sel:WORD_1 dst_unused:UNUSED_PRESERVE src0_sel:WORD_1
s_waitcnt lgkmcnt(3)
v_or_b32 v202, v140, v141
v_rcp_f16_sdwa v151, v150 dst_sel:WORD_1 dst_unused:UNUSED_PRESERVE src0_sel:WORD_1
s_waitcnt lgkmcnt(2)
v_or_b32 v203, v142, v143
v_rcp_f16_sdwa v148, v147 dst_sel:WORD_1 dst_unused:UNUSED_PRESERVE src0_sel:WORD_1
s_waitcnt lgkmcnt(0)
v_or_b32 v204, v144, v145
v_pk_mul_f16 v205, v155, v154
v_pk_mul_f16 v206, v152, v151
v_pk_mul_f16 v207, v149, v148
s_cmp_eq_u32 s77, 0
s_cbranch_scc1 Lpp53
s_getreg_b32 s43, hwreg(HW_REG_IB_STS, 0, 4)
s_cmp_lg_u32 s43, 0
s_cbranch_scc1 Lpp53
s_call_b64 s[78:79], Lpoll
s_setprio 0
Lpp53:
s_setprio 2
v_cvt_pkrtz_f16_f32 v137, v120, v121
v_cvt_pkrtz_f16_f32 v139, v122, v123
v_cvt_pkrtz_f16_f32 v141, v124, v125
v_cvt_pkrtz_f16_f32 v143, v126, v127
v_cvt_pkrtz_f16_f32 v145, v128, v129
v_cvt_pk_f16_f32 v155, v130, v131
v_cvt_pk_f16_f32 v152, v132, v133
v_cvt_pk_f16_f32 v149, v134, v135
v_pk_fma_f16 v154, v155, v155, s48
v_and_b32_e64 v137, s49, v137
v_pk_fma_f16 v151, v152, v152, s48
v_and_b32_e64 v139, s49, v139
v_pk_fma_f16 v148, v149, v149, s48
v_pk_mul_f16 v154, v155, v154
v_bfe_u32 v136, v137, 2, 14
v_pk_mul_f16 v151, v152, v151
v_pk_mul_f16 v148, v149, v148
v_bfe_u32 v138, v139, 2, 14
v_exp_f16 v153, v154
v_lshrrev_b32 v137, 18, v137
v_exp_f16 v150, v151
v_lshrrev_b32 v139, 18, v139
v_exp_f16 v147, v148
v_and_b32 v141, s49, v141
v_and_b32_e64 v143, s49, v143
ds_read_u16_d16 v136, v136
ds_read_u16_d16 v138, v138
ds_read_u16_d16_hi v137, v137
ds_read_u16_d16_hi v139, v139
v_exp_f16_sdwa v153, v154 dst_sel:WORD_1 dst_unused:UNUSED_PRESERVE src0_sel:WORD_1
v_bfe_u32 v140, v141, 2, 14
v_exp_f16_sdwa v150, v151 dst_sel:WORD_1 dst_unused:UNUSED_PRESERVE src0_sel:WORD_1
s_setprio 1
v_bfe_u32 v142, v143, 2, 14
v_exp_f16_sdwa v147, v148 dst_sel:WORD_1 dst_unused:UNUSED_PRESERVE src0_sel:WORD_1
v_lshrrev_b32 v141, 18, v141
v_pk_add_f16 v153, v153, 1.0 op_sel_hi:[1,0]
v_lshrrev_b32_e64 v143, 18, v143
v_pk_add_f16 v150, v150, 1.0 op_sel_hi:[1,0]
v_pk_add_f16 v147, v147, 1.0 op_sel_hi:[1,0]
v_and_b32 v145, s49, v145
v_rcp_f16 v154, v153
v_bfe_u32 v144, v145, 2, 14
v_rcp_f16 v151, v150
v_lshrrev_b32 v145, 18, v145
ds_read_u16_d16 v140, v140
ds_read_u16_d16 v142, v142
ds_read_u16_d16_hi v141, v141
ds_read_u16_d16_hi v143, v143
ds_read_u16_d16 v144, v144
ds_read_u16_d16_hi v145, v145
v_rcp_f16 v148, v147
s_waitcnt lgkmcnt(7)
v_or_b32 v232, v136, v137
s_waitcnt lgkmcnt(6)
v_or_b32 v233, v138, v139
v_rcp_f16_sdwa v154, v153 dst_sel:WORD_1 dst_unused:UNUSED_PRESERVE src0_sel:WORD_1
s_waitcnt lgkmcnt(3)
v_or_b32 v234, v140, v141
s_setprio 0
v_rcp_f16_sdwa v151, v150 dst_sel:WORD_1 dst_unused:UNUSED_PRESERVE src0_sel:WORD_1
s_waitcnt lgkmcnt(2)
v_or_b32 v235, v142, v143
v_rcp_f16_sdwa v148, v147 dst_sel:WORD_1 dst_unused:UNUSED_PRESERVE src0_sel:WORD_1
s_waitcnt lgkmcnt(0)
v_or_b32 v236, v144, v145
v_pk_mul_f16 v237, v155, v154
v_pk_mul_f16 v238, v152, v151
v_pk_mul_f16 v239, v149, v148
s_cmp_eq_u32 s77, 0
s_cbranch_scc1 Lpp54
s_getreg_b32 s43, hwreg(HW_REG_IB_STS, 0, 4)
s_cmp_lg_u32 s43, 0
s_cbranch_scc1 Lpp54
s_call_b64 s[78:79], Lpoll
s_setprio 0
Lpp54:
s_setprio 2
v_lshrrev_b32_e64 v225, 5, v251
v_lshl_add_u32 v224, v225, 9, s72
v_lshl_add_u32 v226, v225, 4, s72
v_and_b32 v225, 15, v251
v_lshl_add_u32 v224, v225, 4, v224
v_bfe_u32 v225, v251, 4, 1
v_lshl_add_u32 v224, v225, 3, v224
s_waitcnt vmcnt(0)
ds_read_b64_tr_b16 v[120:121], v224
ds_read_b64_tr_b16 v[122:123], v224 offset:256
ds_read_b64_tr_b16 v[124:125], v224 offset:1024
ds_read_b64_tr_b16 v[126:127], v224 offset:1280
ds_read_b64_tr_b16 v[128:129], v224 offset:2048
ds_read_b64_tr_b16 v[130:131], v224 offset:2304
ds_read_b64_tr_b16 v[132:133], v224 offset:3072
ds_read_b64_tr_b16 v[134:135], v224 offset:3328
ds_read_b64_tr_b16 v[136:137], v224 offset:4096
ds_read_b64_tr_b16 v[138:139], v224 offset:4352
ds_read_b64_tr_b16 v[140:141], v224 offset:5120
ds_read_b64_tr_b16 v[142:143], v224 offset:5376
ds_read_b64_tr_b16 v[144:145], v224 offset:6144
ds_read_b64_tr_b16 v[146:147], v224 offset:6400
ds_read_b64_tr_b16 v[148:149], v224 offset:7168
ds_read_b64_tr_b16 v[150:151], v224 offset:7424
ds_read_b64_tr_b16 v[152:153], v224 offset:8192
ds_read_b64_tr_b16 v[154:155], v224 offset:8448
v_lshrrev_b32 v225, 4, v251
v_and_b32 v227, 15, v251
v_mul_u32_u24 v252, 192, v227
v_lshl_add_u32 v252, v225, 4, v252
v_lshlrev_b32 v254, 5, v225
v_and_b32 v253, 47, v251
v_lshlrev_b32 v253, 4, v253
v_and_b32 v225, 1, v225
v_mul_u32_u24 v227, 3072, v225
v_add_u32_e64 v248, v227, v253
v_add_u32 v249, 65536, v248
v_add_u32 v250, 131072, v248
v_lshl_add_u32 v253, v225, 21, v253
v_mov_b32 v225, 16256
v_mov_b32_e64 v227, 1
v_permlane16_swap_b32 v0, v4
v_permlane16_swap_b32 v1, v5
v_permlane16_swap_b32 v2, v6
v_permlane16_swap_b32 v3, v7
v_permlane16_swap_b32 v8, v12
v_permlane16_swap_b32 v9, v13
v_permlane16_swap_b32 v10, v14
v_permlane16_swap_b32 v11, v15
s_waitcnt lgkmcnt(0)
s_mov_b64 exec, 1
ds_add_u32 v225, v227 offset:8
s_mov_b64 exec, -1
v_lshlrev_b32 v228, 16, v120
v_and_b32 v229, 4294901760, v120
v_cvt_pk_f16_f32 v120, v228, v229
v_lshlrev_b32_e64 v230, 16, v121
v_and_b32 v231, 4294901760, v121
v_cvt_pk_f16_f32 v121, v230, v231
v_lshlrev_b32_e64 v228, 16, v122
v_and_b32 v229, 4294901760, v122
v_cvt_pk_f16_f32 v122, v228, v229
v_lshlrev_b32_e64 v230, 16, v123
v_and_b32 v231, 4294901760, v123
v_cvt_pk_f16_f32 v123, v230, v231
v_lshlrev_b32_e64 v228, 16, v124
v_and_b32 v229, 4294901760, v124
v_cvt_pk_f16_f32 v124, v228, v229
v_lshlrev_b32_e64 v230, 16, v125
v_and_b32 v231, 4294901760, v125
v_cvt_pk_f16_f32 v125, v230, v231
v_lshlrev_b32_e64 v228, 16, v126
v_and_b32 v229, 4294901760, v126
v_cvt_pk_f16_f32 v126, v228, v229
v_lshlrev_b32_e64 v230, 16, v127
v_and_b32 v231, 4294901760, v127
v_cvt_pk_f16_f32 v127, v230, v231
v_lshlrev_b32_e64 v228, 16, v128
v_and_b32 v229, 4294901760, v128
v_cvt_pk_f16_f32 v128, v228, v229
v_lshlrev_b32_e64 v230, 16, v129
v_and_b32 v231, 4294901760, v129
v_cvt_pk_f16_f32 v129, v230, v231
v_lshlrev_b32_e64 v228, 16, v130
v_and_b32 v229, 4294901760, v130
v_cvt_pk_f16_f32 v130, v228, v229
v_lshlrev_b32_e64 v230, 16, v131
v_and_b32 v231, 4294901760, v131
v_cvt_pk_f16_f32 v131, v230, v231
s_cmp_eq_u32 s77, 0
s_cbranch_scc1 Lpp911
s_getreg_b32 s43, hwreg(HW_REG_IB_STS, 0, 4)
s_cmp_lg_u32 s43, 0
s_cbranch_scc1 Lpp911
s_call_b64 s[78:79], Lpoll
s_setprio 2
Lpp911:
v_lshlrev_b32 v228, 16, v132
v_and_b32 v229, 4294901760, v132
v_cvt_pk_f16_f32 v132, v228, v229
v_lshlrev_b32_e64 v230, 16, v133
v_and_b32 v231, 4294901760, v133
v_cvt_pk_f16_f32 v133, v230, v231
v_lshlrev_b32_e64 v228, 16, v134
v_and_b32 v229, 4294901760, v134
v_cvt_pk_f16_f32 v134, v228, v229
v_lshlrev_b32_e64 v230, 16, v135
v_and_b32 v231, 4294901760, v135
v_cvt_pk_f16_f32 v135, v230, v231
v_lshlrev_b32_e64 v228, 16, v136
v_and_b32 v229, 4294901760, v136
v_cvt_pk_f16_f32 v136, v228, v229
v_lshlrev_b32_e64 v230, 16, v137
v_and_b32 v231, 4294901760, v137
v_cvt_pk_f16_f32 v137, v230, v231
v_lshlrev_b32_e64 v228, 16, v138
v_and_b32 v229, 4294901760, v138
v_cvt_pk_f16_f32 v138, v228, v229
v_lshlrev_b32_e64 v230, 16, v139
v_and_b32 v231, 4294901760, v139
v_cvt_pk_f16_f32 v139, v230, v231
v_lshlrev_b32_e64 v228, 16, v140
v_and_b32 v229, 4294901760, v140
v_cvt_pk_f16_f32 v140, v228, v229
v_lshlrev_b32_e64 v230, 16, v141
v_and_b32 v231, 4294901760, v141
v_cvt_pk_f16_f32 v141, v230, v231
v_lshlrev_b32_e64 v228, 16, v142
v_and_b32 v229, 4294901760, v142
v_cvt_pk_f16_f32 v142, v228, v229
v_lshlrev_b32_e64 v230, 16, v143
v_and_b32 v231, 4294901760, v143
v_cvt_pk_f16_f32 v143, v230, v231
s_cmp_eq_u32 s77, 0
s_cbranch_scc1 Lpp923
s_getreg_b32 s43, hwreg(HW_REG_IB_STS, 0, 4)
s_cmp_lg_u32 s43, 0
s_cbranch_scc1 Lpp923
s_call_b64 s[78:79], Lpoll
s_setprio 2
Lpp923:
v_lshlrev_b32 v228, 16, v144
v_and_b32 v229, 4294901760, v144
v_cvt_pk_f16_f32 v144, v228, v229
v_lshlrev_b32_e64 v230, 16, v145
v_and_b32 v231, 4294901760, v145
v_cvt_pk_f16_f32 v145, v230, v231
v_lshlrev_b32_e64 v228, 16, v146
v_and_b32 v229, 4294901760, v146
v_cvt_pk_f16_f32 v146, v228, v229
v_lshlrev_b32_e64 v230, 16, v147
v_and_b32 v231, 4294901760, v147
v_cvt_pk_f16_f32 v147, v230, v231
v_lshlrev_b32_e64 v228, 16, v148
v_and_b32 v229, 4294901760, v148
v_cvt_pk_f16_f32 v148, v228, v229
v_lshlrev_b32_e64 v230, 16, v149
v_and_b32 v231, 4294901760, v149
v_cvt_pk_f16_f32 v149, v230, v231
v_lshlrev_b32_e64 v228, 16, v150
v_and_b32 v229, 4294901760, v150
v_cvt_pk_f16_f32 v150, v228, v229
v_lshlrev_b32_e64 v230, 16, v151
v_and_b32 v231, 4294901760, v151
v_cvt_pk_f16_f32 v151, v230, v231
v_lshlrev_b32_e64 v228, 16, v152
v_and_b32 v229, 4294901760, v152
v_cvt_pk_f16_f32 v152, v228, v229
v_lshlrev_b32_e64 v230, 16, v153
v_and_b32 v231, 4294901760, v153
v_cvt_pk_f16_f32 v153, v230, v231
v_lshlrev_b32_e64 v228, 16, v154
v_and_b32 v229, 4294901760, v154
v_cvt_pk_f16_f32 v154, v228, v229
v_lshlrev_b32_e64 v230, 16, v155
v_and_b32 v231, 4294901760, v155
v_cvt_pk_f16_f32 v155, v230, v231
s_cmp_eq_u32 s77, 0
s_cbranch_scc1 Lpp935
s_getreg_b32 s43, hwreg(HW_REG_IB_STS, 0, 4)
s_cmp_lg_u32 s43, 0
s_cbranch_scc1 Lpp935
s_call_b64 s[78:79], Lpoll
s_setprio 2
Lpp935:
v_lshl_add_u32 v224, v251, 4, s72
Lspin:
s_cmp_eq_u32 s77, 0
s_cbranch_scc1 Lspinx
s_cmp_eq_u32 s76, 0
s_cbranch_scc1 Lspinx
s_sub_u32 s76, s76, 1
s_call_b64 s[78:79], Lpoll
s_branch Lspin
Lspinx:
s_cmp_lg_u32 s40, 0
s_cbranch_scc1 Lnofin
v_add_u32_e64 v162, 0, v251
v_mul_u32_u24 v165, 2731, v162
v_lshrrev_b32_e64 v165, 16, v165
v_mul_u32_u24 v165, 9120, v165
v_lshl_add_u32 v162, v162, 2, v165
v_add_u32 v162, 90112, v162
v_add_u32_e64 v163, 64, v251
v_mul_u32_u24 v165, 2731, v163
v_lshrrev_b32_e64 v165, 16, v165
v_mul_u32_u24 v165, 9120, v165
v_lshl_add_u32 v163, v163, 2, v165
v_add_u32 v163, 90112, v163
v_add_u32 v164, 128, v251
v_mul_u32_u24 v165, 2731, v164
v_lshrrev_b32_e64 v165, 16, v165
v_mul_u32_u24 v165, 9120, v165
v_lshl_add_u32 v164, v164, 2, v165
v_add_u32 v164, 90112, v164
v_mov_b32 v165, 16256
Lrrw:
ds_read_b32 v166, v165 offset:8
s_waitcnt lgkmcnt(0)
v_readfirstlane_b32 s43, v166
s_cmp_eq_u32 s76, 0
s_cbranch_scc1 Lrrx
s_sub_u32 s76, s76, 1
s_cmp_lt_u32 s43, 8
s_cbranch_scc0 Lrrx
s_sleep 2
s_branch Lrrw
Lrrx:
ds_write_b32 v162, v244
ds_write_b32 v163, v245
ds_write_b32 v164, v246
Lnofin:
s_waitcnt lgkmcnt(0)
s_barrier
ds_read_b128 v[156:159], v226
ds_read_b128 v[160:163], v226 offset:32
ds_read_b128 v[164:167], v226 offset:64
s_waitcnt lgkmcnt(0)
v_pk_mul_f16 v120, v120, v156
v_pk_mul_f16 v121, v121, v157
v_pk_mul_f16 v122, v122, v158
v_pk_mul_f16 v123, v123, v159
ds_write_b128 v224, v[120:123]
v_pk_mul_f16 v124, v124, v156
v_pk_mul_f16 v125, v125, v157
v_pk_mul_f16 v126, v126, v158
v_pk_mul_f16 v127, v127, v159
ds_write_b128 v224, v[124:127] offset:1024
v_pk_mul_f16 v128, v128, v156
v_pk_mul_f16 v129, v129, v157
v_pk_mul_f16 v130, v130, v158
v_pk_mul_f16 v131, v131, v159
ds_write_b128 v224, v[128:131] offset:2048
v_pk_mul_f16 v132, v132, v160
v_pk_mul_f16 v133, v133, v161
v_pk_mul_f16 v134, v134, v162
v_pk_mul_f16 v135, v135, v163
ds_write_b128 v224, v[132:135] offset:3072
v_pk_mul_f16 v136, v136, v160
v_pk_mul_f16 v137, v137, v161
v_pk_mul_f16 v138, v138, v162
v_pk_mul_f16 v139, v139, v163
ds_write_b128 v224, v[136:139] offset:4096
v_pk_mul_f16 v140, v140, v160
v_pk_mul_f16 v141, v141, v161
v_pk_mul_f16 v142, v142, v162
v_pk_mul_f16 v143, v143, v163
ds_write_b128 v224, v[140:143] offset:5120
v_pk_mul_f16 v144, v144, v164
v_pk_mul_f16 v145, v145, v165
v_pk_mul_f16 v146, v146, v166
v_pk_mul_f16 v147, v147, v167
ds_write_b128 v224, v[144:147] offset:6144
v_pk_mul_f16 v148, v148, v164
v_pk_mul_f16 v149, v149, v165
v_pk_mul_f16 v150, v150, v166
v_pk_mul_f16 v151, v151, v167
ds_write_b128 v224, v[148:151] offset:7168
v_pk_mul_f16 v152, v152, v164
v_pk_mul_f16 v153, v153, v165
v_pk_mul_f16 v154, v154, v166
v_pk_mul_f16 v155, v155, v167
ds_write_b128 v224, v[152:155] offset:8192
s_waitcnt lgkmcnt(0)
s_barrier
s_setprio 3
ds_read_b128 v[224:227], v249 offset:24576
ds_read_b128 v[228:231], v254 offset:7936
ds_read_b128 v[240:243], v249 offset:24832
ds_read_b128 v[244:247], v254 offset:7952
s_waitcnt lgkmcnt(2)
v_mfma_f32_16x16x32_f16 v[120:123], v[224:227], v[0:3], v[228:231]
v_mfma_f32_16x16x32_f16 v[128:131], v[224:227], v[4:7], v[228:231]
v_permlane16_swap_b32 v16, v20
s_waitcnt lgkmcnt(0)
v_mfma_f32_16x16x32_f16 v[124:127], v[240:243], v[0:3], v[244:247]
ds_read_b128 v[224:227], v249 offset:25600
ds_read_b128 v[228:231], v254 offset:8064
v_mfma_f32_16x16x32_f16 v[132:135], v[240:243], v[4:7], v[244:247]
v_permlane16_swap_b32 v17, v21
s_waitcnt lgkmcnt(0)
v_mfma_f32_16x16x32_f16 v[136:139], v[224:227], v[0:3], v[228:231]
ds_read_b128 v[240:243], v249 offset:25856
ds_read_b128 v[244:247], v254 offset:8080
v_mfma_f32_16x16x32_f16 v[144:147], v[224:227], v[4:7], v[228:231]
v_permlane16_swap_b32 v18, v22
s_waitcnt lgkmcnt(0)
v_mfma_f32_16x16x32_f16 v[140:143], v[240:243], v[0:3], v[244:247]
ds_read_b128 v[224:227], v249 offset:26624
ds_read_b128 v[228:231], v254 offset:16128
v_mfma_f32_16x16x32_f16 v[148:151], v[240:243], v[4:7], v[244:247]
v_permlane16_swap_b32 v19, v23
s_waitcnt lgkmcnt(0)
v_mfma_f32_16x16x32_f16 v[152:155], v[224:227], v[0:3], v[228:231]
ds_read_b128 v[240:243], v249 offset:26880
ds_read_b128 v[244:247], v254 offset:16144
v_mfma_f32_16x16x32_f16 v[160:163], v[224:227], v[4:7], v[228:231]
v_permlane16_swap_b32 v24, v28
s_waitcnt lgkmcnt(0)
v_mfma_f32_16x16x32_f16 v[156:159], v[240:243], v[0:3], v[244:247]
ds_read_b128 v[224:227], v249 offset:30720
ds_read_b128 v[228:231], v249 offset:30976
v_mfma_f32_16x16x32_f16 v[164:167], v[240:243], v[4:7], v[244:247]
v_permlane16_swap_b32 v25, v29
s_waitcnt lgkmcnt(1)
v_mfma_f32_16x16x32_f16 v[120:123], v[224:227], v[8:11], v[120:123]
ds_read_b128 v[240:243], v249 offset:31744
ds_read_b128 v[244:247], v249 offset:32000
v_mfma_f32_16x16x32_f16 v[128:131], v[224:227], v[12:15], v[128:131]
v_permlane16_swap_b32 v26, v30
s_waitcnt lgkmcnt(2)
v_mfma_f32_16x16x32_f16 v[124:127], v[228:231], v[8:11], v[124:127]
ds_read_b128 v[224:227], v249 offset:32768
v_mfma_f32_16x16x32_f16 v[132:135], v[228:231], v[12:15], v[132:135]
v_permlane16_swap_b32 v27, v31
s_waitcnt lgkmcnt(2)
v_mfma_f32_16x16x32_f16 v[136:139], v[240:243], v[8:11], v[136:139]
ds_read_b128 v[228:231], v249 offset:33024
v_mfma_f32_16x16x32_f16 v[144:147], v[240:243], v[12:15], v[144:147]
v_permlane16_swap_b32 v96, v100
s_waitcnt lgkmcnt(2)
v_mfma_f32_16x16x32_f16 v[140:143], v[244:247], v[8:11], v[140:143]
ds_read_b128 v[240:243], v249 offset:36864
v_mfma_f32_16x16x32_f16 v[148:151], v[244:247], v[12:15], v[148:151]
v_permlane16_swap_b32 v97, v101
s_waitcnt lgkmcnt(2)
v_mfma_f32_16x16x32_f16 v[152:155], v[224:227], v[8:11], v[152:155]
ds_read_b128 v[244:247], v249 offset:37120
v_mfma_f32_16x16x32_f16 v[160:163], v[224:227], v[12:15], v[160:163]
v_permlane16_swap_b32 v98, v102
s_waitcnt lgkmcnt(2)
v_mfma_f32_16x16x32_f16 v[156:159], v[228:231], v[8:11], v[156:159]
ds_read_b128 v[224:227], v249 offset:37888
v_mfma_f32_16x16x32_f16 v[164:167], v[228:231], v[12:15], v[164:167]
v_permlane16_swap_b32 v99, v103
s_waitcnt lgkmcnt(2)
v_mfma_f32_16x16x32_f16 v[120:123], v[240:243], v[16:19], v[120:123]
buffer_load_dwordx4 v[12:15], v252, s[4:7], s71 offen
ds_read_b128 v[228:231], v249 offset:38144
v_mfma_f32_16x16x32_f16 v[128:131], v[240:243], v[20:23], v[128:131]
v_permlane16_swap_b32 v32, v36
s_waitcnt lgkmcnt(2)
v_mfma_f32_16x16x32_f16 v[124:127], v[244:247], v[16:19], v[124:127]
ds_read_b128 v[240:243], v249 offset:38912
v_mfma_f32_16x16x32_f16 v[132:135], v[244:247], v[20:23], v[132:135]
v_permlane16_swap_b32 v33, v37
s_waitcnt lgkmcnt(2)
v_mfma_f32_16x16x32_f16 v[136:139], v[224:227], v[16:19], v[136:139]
ds_read_b128 v[244:247], v249 offset:39168
v_mfma_f32_16x16x32_f16 v[144:147], v[224:227], v[20:23], v[144:147]
v_permlane16_swap_b32 v34, v38
s_waitcnt lgkmcnt(2)
v_mfma_f32_16x16x32_f16 v[140:143], v[228:231], v[16:19], v[140:143]
buffer_load_dwordx4 v[8:11], v252, s[4:7], s71 offen offset:64
ds_read_b128 v[224:227], v249 offset:43008
v_mfma_f32_16x16x32_f16 v[148:151], v[228:231], v[20:23], v[148:151]
v_permlane16_swap_b32 v35, v39
s_waitcnt lgkmcnt(2)
v_mfma_f32_16x16x32_f16 v[152:155], v[240:243], v[16:19], v[152:155]
ds_read_b128 v[228:231], v249 offset:43264
v_mfma_f32_16x16x32_f16 v[160:163], v[240:243], v[20:23], v[160:163]
v_permlane16_swap_b32 v40, v44
s_waitcnt lgkmcnt(2)
v_mfma_f32_16x16x32_f16 v[156:159], v[244:247], v[16:19], v[156:159]
ds_read_b128 v[240:243], v249 offset:44032
v_mfma_f32_16x16x32_f16 v[164:167], v[244:247], v[20:23], v[164:167]
v_permlane16_swap_b32 v41, v45
s_waitcnt lgkmcnt(2)
v_mfma_f32_16x16x32_f16 v[120:123], v[224:227], v[24:27], v[120:123]
buffer_load_dwordx4 v[4:7], v252, s[4:7], s71 offen offset:128
ds_read_b128 v[244:247], v249 offset:44288
v_mfma_f32_16x16x32_f16 v[128:131], v[224:227], v[28:31], v[128:131]
v_permlane16_swap_b32 v42, v46
s_waitcnt lgkmcnt(2)
v_mfma_f32_16x16x32_f16 v[124:127], v[228:231], v[24:27], v[124:127]
ds_read_b128 v[224:227], v249 offset:45056
v_mfma_f32_16x16x32_f16 v[132:135], v[228:231], v[28:31], v[132:135]
v_permlane16_swap_b32 v43, v47
s_waitcnt lgkmcnt(2)
v_mfma_f32_16x16x32_f16 v[136:139], v[240:243], v[24:27], v[136:139]
ds_read_b128 v[228:231], v249 offset:45312
v_mfma_f32_16x16x32_f16 v[144:147], v[240:243], v[28:31], v[144:147]
v_permlane16_swap_b32 v104, v108
s_waitcnt lgkmcnt(2)
v_mfma_f32_16x16x32_f16 v[140:143], v[244:247], v[24:27], v[140:143]
s_add_u32 s46, s71, 98304
buffer_load_dwordx4 v[0:3], v252, s[4:7], s46 offen
ds_read_b128 v[240:243], v249 offset:49152
v_mfma_f32_16x16x32_f16 v[148:151], v[244:247], v[28:31], v[148:151]
v_permlane16_swap_b32 v105, v109
s_waitcnt lgkmcnt(2)
v_mfma_f32_16x16x32_f16 v[152:155], v[224:227], v[24:27], v[152:155]
ds_read_b128 v[244:247], v249 offset:49408
v_mfma_f32_16x16x32_f16 v[160:163], v[224:227], v[28:31], v[160:163]
v_permlane16_swap_b32 v106, v110
s_waitcnt lgkmcnt(2)
v_mfma_f32_16x16x32_f16 v[156:159], v[228:231], v[24:27], v[156:159]
ds_read_b128 v[224:227], v249 offset:50176
v_mfma_f32_16x16x32_f16 v[164:167], v[228:231], v[28:31], v[164:167]
v_permlane16_swap_b32 v107, v111
s_waitcnt lgkmcnt(2)
v_mfma_f32_16x16x32_f16 v[120:123], v[240:243], v[32:35], v[120:123]
buffer_load_dwordx4 v[24:27], v253, s[32:35], s80 offen nt
ds_read_b128 v[228:231], v249 offset:50432
v_mfma_f32_16x16x32_f16 v[128:131], v[240:243], v[36:39], v[128:131]
v_permlane16_swap_b32 v48, v52
s_waitcnt lgkmcnt(2)
v_mfma_f32_16x16x32_f16 v[124:127], v[244:247], v[32:35], v[124:127]
ds_read_b128 v[240:243], v249 offset:51200
v_mfma_f32_16x16x32_f16 v[132:135], v[244:247], v[36:39], v[132:135]
v_permlane16_swap_b32 v49, v53
s_waitcnt lgkmcnt(2)
v_mfma_f32_16x16x32_f16 v[136:139], v[224:227], v[32:35], v[136:139]
ds_read_b128 v[244:247], v249 offset:51456
v_permlane16_swap_b32 v50, v54
v_mfma_f32_16x16x32_f16 v[144:147], v[224:227], v[36:39], v[144:147]
s_waitcnt lgkmcnt(2)
v_mfma_f32_16x16x32_f16 v[140:143], v[228:231], v[32:35], v[140:143]
ds_read_b128 v[224:227], v249 offset:55296
v_permlane16_swap_b32 v51, v55
v_mfma_f32_16x16x32_f16 v[148:151], v[228:231], v[36:39], v[148:151]
v_permlane16_swap_b32 v56, v60
s_waitcnt lgkmcnt(2)
v_mfma_f32_16x16x32_f16 v[152:155], v[240:243], v[32:35], v[152:155]
ds_read_b128 v[228:231], v249 offset:55552
v_mfma_f32_16x16x32_f16 v[160:163], v[240:243], v[36:39], v[160:163]
v_permlane16_swap_b32 v57, v61
s_waitcnt lgkmcnt(2)
v_mfma_f32_16x16x32_f16 v[156:159], v[244:247], v[32:35], v[156:159]
ds_read_b128 v[240:243], v249 offset:56320
v_permlane16_swap_b32 v58, v62
v_mfma_f32_16x16x32_f16 v[164:167], v[244:247], v[36:39], v[164:167]
s_waitcnt lgkmcnt(2)
v_mfma_f32_16x16x32_f16 v[120:123], v[224:227], v[40:43], v[120:123]
buffer_load_dwordx4 v[28:31], v253, s[32:35], s80 offen offset:256 nt
ds_read_b128 v[244:247], v249 offset:56576
v_permlane16_swap_b32 v59, v63
v_mfma_f32_16x16x32_f16 v[128:131], v[224:227], v[44:47], v[128:131]
v_and_b32_e64 v16, 1, v251
v_lshlrev_b32 v16, 4, v16
s_waitcnt lgkmcnt(2)
v_mfma_f32_16x16x32_f16 v[124:127], v[228:231], v[40:43], v[124:127]
ds_read_b128 v[224:227], v249 offset:57344
v_mov_b32 v17, 16256
v_mfma_f32_16x16x32_f16 v[132:135], v[228:231], v[44:47], v[132:135]
v_lshlrev_b32 v16, v16, v17
s_waitcnt lgkmcnt(2)
v_mfma_f32_16x16x32_f16 v[136:139], v[240:243], v[40:43], v[136:139]
ds_read_b128 v[228:231], v249 offset:57600
v_lshrrev_b32 v17, 2, v251
v_mfma_f32_16x16x32_f16 v[144:147], v[240:243], v[44:47], v[144:147]
v_xor_b32 v17, v17, v251
v_and_b32 v17, 12, v17
s_waitcnt lgkmcnt(2)
v_mfma_f32_16x16x32_f16 v[140:143], v[244:247], v[40:43], v[140:143]
ds_read_b128 v[240:243], v249 offset:61440
v_and_b32_e64 v20, 2, v251
v_mfma_f32_16x16x32_f16 v[148:151], v[244:247], v[44:47], v[148:151]
v_or_b32 v17, v17, v20
s_waitcnt lgkmcnt(2)
v_mfma_f32_16x16x32_f16 v[152:155], v[224:227], v[40:43], v[152:155]
ds_read_b128 v[244:247], v249 offset:61696
v_cmp_eq_u32 vcc, 0, v17
s_nop 1
v_cndmask_b32 v18, 0, v16, vcc
v_cmp_eq_u32 vcc, 2, v17
s_nop 1
v_cndmask_b32 v19, 0, v16, vcc
v_mfma_f32_16x16x32_f16 v[160:163], v[224:227], v[44:47], v[160:163]
v_mov_b32 v16, 0
s_waitcnt lgkmcnt(2)
v_mfma_f32_16x16x32_f16 v[156:159], v[228:231], v[40:43], v[156:159]
ds_read_b128 v[224:227], v249 offset:62464
v_mov_b32_e64 v17, 0
v_mfma_f32_16x16x32_f16 v[164:167], v[228:231], v[44:47], v[164:167]
v_mov_b32 v20, 0
v_mov_b32 v21, 0
s_waitcnt lgkmcnt(2)
v_mfma_f32_16x16x32_f16 v[120:123], v[240:243], v[48:51], v[120:123]
s_add_u32 s46, s80, 4194304
buffer_load_dwordx4 v[32:35], v253, s[32:35], s46 offen nt
ds_read_b128 v[228:231], v249 offset:62720
v_mfma_f32_16x16x32_f16 v[128:131], v[240:243], v[52:55], v[128:131]
s_waitcnt lgkmcnt(2)
v_mfma_f32_16x16x32_f16 v[124:127], v[244:247], v[48:51], v[124:127]
ds_read_b128 v[240:243], v249 offset:63488
v_permlane16_swap_b32 v64, v68
v_mfma_f32_16x16x32_f16 v[132:135], v[244:247], v[52:55], v[132:135]
s_waitcnt lgkmcnt(2)
v_mfma_f32_16x16x32_f16 v[136:139], v[224:227], v[48:51], v[136:139]
ds_read_b128 v[244:247], v249 offset:63744
v_permlane16_swap_b32 v65, v69
v_mfma_f32_16x16x32_f16 v[144:147], v[224:227], v[52:55], v[144:147]
s_waitcnt lgkmcnt(2)
v_mfma_f32_16x16x32_f16 v[140:143], v[228:231], v[48:51], v[140:143]
ds_read_b128 v[224:227], v250 offset:2048
v_permlane16_swap_b32 v66, v70
v_mfma_f32_16x16x32_f16 v[148:151], v[228:231], v[52:55], v[148:151]
s_waitcnt lgkmcnt(2)
v_mfma_f32_16x16x32_f16 v[152:155], v[240:243], v[48:51], v[152:155]
ds_read_b128 v[228:231], v250 offset:2304
v_mfma_f32_16x16x32_f16 v[160:163], v[240:243], v[52:55], v[160:163]
v_permlane16_swap_b32 v67, v71
s_waitcnt lgkmcnt(2)
v_mfma_f32_16x16x32_f16 v[156:159], v[244:247], v[48:51], v[156:159]
ds_read_b128 v[240:243], v250 offset:3072
v_mfma_f32_16x16x32_f16 v[164:167], v[244:247], v[52:55], v[164:167]
v_permlane16_swap_b32 v72, v76
s_waitcnt lgkmcnt(2)
v_mfma_f32_16x16x32_f16 v[120:123], v[224:227], v[56:59], v[120:123]
ds_read_b128 v[244:247], v250 offset:3328
v_mfma_f32_16x16x32_f16 v[128:131], v[224:227], v[60:63], v[128:131]
v_permlane16_swap_b32 v73, v77
s_waitcnt lgkmcnt(2)
v_mfma_f32_16x16x32_f16 v[124:127], v[228:231], v[56:59], v[124:127]
s_add_u32 s46, s80, 4194304
buffer_load_dwordx4 v[36:39], v253, s[32:35], s46 offen offset:256 nt
ds_read_b128 v[224:227], v250 offset:4096
v_mfma_f32_16x16x32_f16 v[132:135], v[228:231], v[60:63], v[132:135]
s_waitcnt lgkmcnt(2)
v_mfma_f32_16x16x32_f16 v[136:139], v[240:243], v[56:59], v[136:139]
ds_read_b128 v[228:231], v250 offset:4352
v_permlane16_swap_b32 v74, v78
v_mfma_f32_16x16x32_f16 v[144:147], v[240:243], v[60:63], v[144:147]
s_waitcnt lgkmcnt(2)
v_mfma_f32_16x16x32_f16 v[140:143], v[244:247], v[56:59], v[140:143]
ds_read_b128 v[240:243], v250 offset:8192
v_permlane16_swap_b32 v75, v79
v_mfma_f32_16x16x32_f16 v[148:151], v[244:247], v[60:63], v[148:151]
s_waitcnt lgkmcnt(2)
v_mfma_f32_16x16x32_f16 v[152:155], v[224:227], v[56:59], v[152:155]
ds_read_b128 v[244:247], v250 offset:8448
v_permlane16_swap_b32 v192, v196
v_mfma_f32_16x16x32_f16 v[160:163], v[224:227], v[60:63], v[160:163]
s_waitcnt lgkmcnt(2)
v_mfma_f32_16x16x32_f16 v[156:159], v[228:231], v[56:59], v[156:159]
ds_read_b128 v[224:227], v250 offset:9216
v_mfma_f32_16x16x32_f16 v[164:167], v[228:231], v[60:63], v[164:167]
v_permlane16_swap_b32 v193, v197
s_waitcnt vmcnt(7)
v_mfma_f32_16x16x32_bf16 v[120:123], v[18:21], v[12:15], v[120:123]
ds_read_b128 v[228:231], v250 offset:9472
v_mfma_f32_16x16x32_bf16 v[124:127], v[16:19], v[12:15], v[124:127]
v_permlane16_swap_b32 v194, v198
s_waitcnt vmcnt(6)
v_mfma_f32_16x16x32_bf16 v[136:139], v[18:21], v[8:11], v[136:139]
v_mfma_f32_16x16x32_bf16 v[140:143], v[16:19], v[8:11], v[140:143]
v_permlane16_swap_b32 v195, v199
s_waitcnt lgkmcnt(3)
v_mfma_f32_16x16x32_f16 v[120:123], v[240:243], v[64:67], v[120:123]
s_add_u32 s46, s80, 8388608
buffer_load_dwordx4 v[40:43], v253, s[32:35], s46 offen nt
v_mfma_f32_16x16x32_f16 v[128:131], v[240:243], v[68:71], v[128:131]
s_waitcnt lgkmcnt(2)
v_mfma_f32_16x16x32_f16 v[124:127], v[244:247], v[64:67], v[124:127]
ds_read_b128 v[240:243], v250 offset:10240
v_permlane16_swap_b32 v80, v84
v_mfma_f32_16x16x32_f16 v[132:135], v[244:247], v[68:71], v[132:135]
s_waitcnt lgkmcnt(2)
v_mfma_f32_16x16x32_f16 v[136:139], v[224:227], v[64:67], v[136:139]
ds_read_b128 v[244:247], v250 offset:10496
v_permlane16_swap_b32 v81, v85
v_mfma_f32_16x16x32_f16 v[144:147], v[224:227], v[68:71], v[144:147]
s_waitcnt lgkmcnt(2)
v_mfma_f32_16x16x32_f16 v[140:143], v[228:231], v[64:67], v[140:143]
ds_read_b128 v[224:227], v250 offset:14336
v_permlane16_swap_b32 v82, v86
v_mfma_f32_16x16x32_f16 v[148:151], v[228:231], v[68:71], v[148:151]
s_waitcnt lgkmcnt(2)
v_mfma_f32_16x16x32_f16 v[152:155], v[240:243], v[64:67], v[152:155]
s_add_u32 s46, s80, 8388608
buffer_load_dwordx4 v[44:47], v253, s[32:35], s46 offen offset:256 nt
ds_read_b128 v[228:231], v250 offset:14592
v_mfma_f32_16x16x32_f16 v[160:163], v[240:243], v[68:71], v[160:163]
v_permlane16_swap_b32 v83, v87
s_waitcnt lgkmcnt(2)
v_mfma_f32_16x16x32_f16 v[156:159], v[244:247], v[64:67], v[156:159]
ds_read_b128 v[240:243], v250 offset:15360
v_mfma_f32_16x16x32_f16 v[164:167], v[244:247], v[68:71], v[164:167]
v_permlane16_swap_b32 v88, v92
s_waitcnt lgkmcnt(2)
v_mfma_f32_16x16x32_f16 v[120:123], v[224:227], v[72:75], v[120:123]
ds_read_b128 v[244:247], v250 offset:15616
v_mfma_f32_16x16x32_f16 v[128:131], v[224:227], v[76:79], v[128:131]
v_permlane16_swap_b32 v89, v93
s_waitcnt lgkmcnt(2)
v_mfma_f32_16x16x32_f16 v[124:127], v[228:231], v[72:75], v[124:127]
s_add_u32 s46, s71, 98304
buffer_load_dwordx4 v[8:11], v252, s[4:7], s46 offen offset:64
ds_read_b128 v[224:227], v250 offset:16384
v_mfma_f32_16x16x32_f16 v[132:135], v[228:231], v[76:79], v[132:135]
s_waitcnt lgkmcnt(2)
v_mfma_f32_16x16x32_f16 v[136:139], v[240:243], v[72:75], v[136:139]
ds_read_b128 v[228:231], v250 offset:16640
v_permlane16_swap_b32 v90, v94
v_mfma_f32_16x16x32_f16 v[144:147], v[240:243], v[76:79], v[144:147]
s_waitcnt lgkmcnt(2)
v_mfma_f32_16x16x32_f16 v[140:143], v[244:247], v[72:75], v[140:143]
ds_read_b128 v[240:243], v250 offset:20480
v_permlane16_swap_b32 v91, v95
v_mfma_f32_16x16x32_f16 v[148:151], v[244:247], v[76:79], v[148:151]
s_waitcnt lgkmcnt(2)
v_mfma_f32_16x16x32_f16 v[152:155], v[224:227], v[72:75], v[152:155]
ds_read_b128 v[244:247], v250 offset:20736
v_permlane16_swap_b32 v184, v188
v_mfma_f32_16x16x32_f16 v[160:163], v[224:227], v[76:79], v[160:163]
s_waitcnt lgkmcnt(2)
v_mfma_f32_16x16x32_f16 v[156:159], v[228:231], v[72:75], v[156:159]
s_add_u32 s46, s71, 98304
buffer_load_dwordx4 v[12:15], v252, s[4:7], s46 offen offset:128
ds_read_b128 v[224:227], v250 offset:21504
v_mfma_f32_16x16x32_f16 v[164:167], v[228:231], v[76:79], v[164:167]
v_permlane16_swap_b32 v185, v189
s_waitcnt vmcnt(9)
v_mfma_f32_16x16x32_bf16 v[152:155], v[18:21], v[4:7], v[152:155]
ds_read_b128 v[228:231], v250 offset:21760
v_mfma_f32_16x16x32_bf16 v[156:159], v[16:19], v[4:7], v[156:159]
v_permlane16_swap_b32 v186, v190
s_waitcnt vmcnt(8)
v_mfma_f32_16x16x32_bf16 v[128:131], v[18:21], v[0:3], v[128:131]
v_mfma_f32_16x16x32_bf16 v[132:135], v[16:19], v[0:3], v[132:135]
v_permlane16_swap_b32 v187, v191
v_and_b32 v255, 1, v251
v_lshlrev_b32 v255, 7, v255
v_sub_u32 v255, v252, v255
s_mov_b32 s74, 1431655765
s_mov_b32 s75, 1431655765
s_waitcnt lgkmcnt(3)
v_mfma_f32_16x16x32_f16 v[120:123], v[240:243], v[80:83], v[120:123]
buffer_load_dwordx4 v[4:7], v252, s[4:7], s70 offen
v_mfma_f32_16x16x32_f16 v[128:131], v[240:243], v[84:87], v[128:131]
v_permlane16_swap_b32 v168, v172
s_waitcnt lgkmcnt(2)
v_mfma_f32_16x16x32_f16 v[124:127], v[244:247], v[80:83], v[124:127]
ds_read_b128 v[240:243], v250 offset:22528
v_mfma_f32_16x16x32_f16 v[132:135], v[244:247], v[84:87], v[132:135]
v_permlane16_swap_b32 v169, v173
s_waitcnt lgkmcnt(2)
v_mfma_f32_16x16x32_f16 v[136:139], v[224:227], v[80:83], v[136:139]
ds_read_b128 v[244:247], v250 offset:22784
v_mfma_f32_16x16x32_f16 v[144:147], v[224:227], v[84:87], v[144:147]
v_permlane16_swap_b32 v170, v174
s_waitcnt lgkmcnt(2)
v_mfma_f32_16x16x32_f16 v[140:143], v[228:231], v[80:83], v[140:143]
ds_read_b128 v[224:227], v250 offset:26624
v_mfma_f32_16x16x32_f16 v[148:151], v[228:231], v[84:87], v[148:151]
v_permlane16_swap_b32 v171, v175
s_waitcnt lgkmcnt(2)
v_mfma_f32_16x16x32_f16 v[152:155], v[240:243], v[80:83], v[152:155]
ds_read_b128 v[228:231], v250 offset:26880
v_mfma_f32_16x16x32_f16 v[160:163], v[240:243], v[84:87], v[160:163]
v_permlane16_swap_b32 v176, v180
s_waitcnt lgkmcnt(2)
v_mfma_f32_16x16x32_f16 v[156:159], v[244:247], v[80:83], v[156:159]
ds_read_b128 v[240:243], v250 offset:27648
v_mfma_f32_16x16x32_f16 v[164:167], v[244:247], v[84:87], v[164:167]
v_permlane16_swap_b32 v177, v181
s_waitcnt lgkmcnt(2)
v_mfma_f32_16x16x32_f16 v[120:123], v[224:227], v[88:91], v[120:123]
buffer_load_dwordx4 v[0:3], v252, s[4:7], s70 offen offset:64
ds_read_b128 v[244:247], v250 offset:27904
v_mfma_f32_16x16x32_f16 v[128:131], v[224:227], v[92:95], v[128:131]
v_permlane16_swap_b32 v178, v182
s_waitcnt lgkmcnt(2)
v_mfma_f32_16x16x32_f16 v[124:127], v[228:231], v[88:91], v[124:127]
ds_read_b128 v[224:227], v250 offset:28672
v_mfma_f32_16x16x32_f16 v[132:135], v[228:231], v[92:95], v[132:135]
v_permlane16_swap_b32 v179, v183
s_waitcnt lgkmcnt(2)
v_mfma_f32_16x16x32_f16 v[136:139], v[240:243], v[88:91], v[136:139]
ds_read_b128 v[228:231], v250 offset:28928
v_mfma_f32_16x16x32_f16 v[144:147], v[240:243], v[92:95], v[144:147]
v_permlane16_swap_b32 v112, v116
s_waitcnt lgkmcnt(2)
v_mfma_f32_16x16x32_f16 v[140:143], v[244:247], v[88:91], v[140:143]
ds_read_b128 v[240:243], v249 offset:49152
v_mfma_f32_16x16x32_f16 v[148:151], v[244:247], v[92:95], v[148:151]
v_permlane16_swap_b32 v113, v117
s_waitcnt lgkmcnt(2)
v_mfma_f32_16x16x32_f16 v[152:155], v[224:227], v[88:91], v[152:155]
ds_read_b128 v[244:247], v254 offset:7936
v_mfma_f32_16x16x32_f16 v[160:163], v[224:227], v[92:95], v[160:163]
v_permlane16_swap_b32 v114, v118
s_waitcnt lgkmcnt(2)
v_mfma_f32_16x16x32_f16 v[156:159], v[228:231], v[88:91], v[156:159]
ds_read_b128 v[224:227], v249 offset:49408
v_mfma_f32_16x16x32_f16 v[164:167], v[228:231], v[92:95], v[164:167]
v_permlane16_swap_b32 v115, v119
s_waitcnt lgkmcnt(1)
v_mfma_f32_16x16x32_f16 v[48:51], v[240:243], v[168:171], v[244:247]
ds_read_b128 v[228:231], v254 offset:7952
v_mfma_f32_16x16x32_f16 v[56:59], v[240:243], v[172:175], v[244:247]
s_waitcnt lgkmcnt(0)
v_mfma_f32_16x16x32_f16 v[52:55], v[224:227], v[168:171], v[228:231]
ds_read_b128 v[240:243], v249 offset:50176
ds_read_b128 v[244:247], v254 offset:8064
v_mfma_f32_16x16x32_f16 v[60:63], v[224:227], v[172:175], v[228:231]
s_waitcnt lgkmcnt(0)
v_mfma_f32_16x16x32_f16 v[64:67], v[240:243], v[168:171], v[244:247]
ds_read_b128 v[224:227], v249 offset:50432
ds_read_b128 v[228:231], v254 offset:8080
v_mfma_f32_16x16x32_f16 v[72:75], v[240:243], v[172:175], v[244:247]
s_waitcnt lgkmcnt(0)
v_mfma_f32_16x16x32_f16 v[68:71], v[224:227], v[168:171], v[228:231]
ds_read_b128 v[240:243], v249 offset:51200
ds_read_b128 v[244:247], v254 offset:16128
v_cvt_pk_bf16_f32 v136, v136, v137
v_mfma_f32_16x16x32_f16 v[76:79], v[224:227], v[172:175], v[228:231]
v_cvt_pk_bf16_f32 v137, v138, v139
s_waitcnt lgkmcnt(0)
v_mfma_f32_16x16x32_f16 v[80:83], v[240:243], v[168:171], v[244:247]
ds_read_b128 v[224:227], v249 offset:51456
ds_read_b128 v[228:231], v254 offset:16144
v_cvt_pk_bf16_f32 v138, v140, v141
v_mfma_f32_16x16x32_f16 v[88:91], v[240:243], v[172:175], v[244:247]
v_cvt_pk_bf16_f32 v139, v142, v143
s_waitcnt lgkmcnt(0)
v_mfma_f32_16x16x32_f16 v[84:87], v[224:227], v[168:171], v[228:231]
ds_read_b128 v[240:243], v249 offset:55296
ds_read_b128 v[244:247], v249 offset:55552
v_cvt_pk_bf16_f32 v120, v120, v121
v_mfma_f32_16x16x32_f16 v[92:95], v[224:227], v[172:175], v[228:231]
v_cvt_pk_bf16_f32 v121, v122, v123
s_waitcnt lgkmcnt(1)
v_mfma_f32_16x16x32_f16 v[48:51], v[240:243], v[176:179], v[48:51]
ds_read_b128 v[224:227], v249 offset:56320
ds_read_b128 v[228:231], v249 offset:56576
v_cvt_pk_bf16_f32 v122, v124, v125
v_mfma_f32_16x16x32_f16 v[56:59], v[240:243], v[180:183], v[56:59]
v_cvt_pk_bf16_f32 v123, v126, v127
s_waitcnt lgkmcnt(2)
v_mfma_f32_16x16x32_f16 v[52:55], v[244:247], v[176:179], v[52:55]
ds_read_b128 v[240:243], v249 offset:57344
v_cvt_pk_bf16_f32 v152, v152, v153
v_cvt_pk_bf16_f32 v153, v154, v155
v_mfma_f32_16x16x32_f16 v[60:63], v[244:247], v[180:183], v[60:63]
v_cvt_pk_bf16_f32 v154, v156, v157
s_waitcnt lgkmcnt(2)
v_mfma_f32_16x16x32_f16 v[64:67], v[224:227], v[176:179], v[64:67]
ds_read_b128 v[244:247], v249 offset:57600
v_cvt_pk_bf16_f32 v155, v158, v159
s_mov_b64 vcc, s[74:75]
v_mfma_f32_16x16x32_f16 v[72:75], v[224:227], v[180:183], v[72:75]
v_cndmask_b32 v140, v120, v152, vcc
s_waitcnt lgkmcnt(2)
v_mfma_f32_16x16x32_f16 v[68:71], v[228:231], v[176:179], v[68:71]
ds_read_b128 v[224:227], v249 offset:61440
v_cndmask_b32 v141, v121, v153, vcc
v_mfma_f32_16x16x32_f16 v[76:79], v[228:231], v[180:183], v[76:79]
v_cndmask_b32 v142, v122, v154, vcc
s_waitcnt lgkmcnt(2)
v_mfma_f32_16x16x32_f16 v[80:83], v[240:243], v[176:179], v[80:83]
ds_read_b128 v[228:231], v249 offset:61696
v_cndmask_b32 v143, v123, v155, vcc
v_mfma_f32_16x16x32_f16 v[88:91], v[240:243], v[180:183], v[88:91]
v_cndmask_b32_dpp v120, v136, v120, vcc quad_perm:[1,0,3,2] row_mask:0xf bank_mask:0xf
s_waitcnt lgkmcnt(2)
v_mfma_f32_16x16x32_f16 v[84:87], v[244:247], v[176:179], v[84:87]
ds_read_b128 v[240:243], v248 offset:16384
v_cndmask_b32_dpp v121, v137, v121, vcc quad_perm:[1,0,3,2] row_mask:0xf bank_mask:0xf
v_mfma_f32_16x16x32_f16 v[92:95], v[244:247], v[180:183], v[92:95]
v_cndmask_b32_dpp v122, v138, v122, vcc quad_perm:[1,0,3,2] row_mask:0xf bank_mask:0xf
s_waitcnt vmcnt(3)
v_mfma_f32_16x16x32_bf16 v[144:147], v[18:21], v[8:11], v[144:147]
ds_read_b128 v[244:247], v249 offset:62464
v_cndmask_b32_dpp v123, v139, v123, vcc quad_perm:[1,0,3,2] row_mask:0xf bank_mask:0xf
s_not_b64 vcc, s[74:75]
v_mfma_f32_16x16x32_bf16 v[148:151], v[16:19], v[8:11], v[148:151]
v_cndmask_b32_dpp v152, v136, v152, vcc quad_perm:[1,0,3,2] row_mask:0xf bank_mask:0xf
s_waitcnt vmcnt(2)
v_mfma_f32_16x16x32_bf16 v[160:163], v[18:21], v[12:15], v[160:163]
v_cndmask_b32_dpp v153, v137, v153, vcc quad_perm:[1,0,3,2] row_mask:0xf bank_mask:0xf
v_mfma_f32_16x16x32_bf16 v[164:167], v[16:19], v[12:15], v[164:167]
v_cndmask_b32_dpp v154, v138, v154, vcc quad_perm:[1,0,3,2] row_mask:0xf bank_mask:0xf
v_cndmask_b32_dpp v155, v139, v155, vcc quad_perm:[1,0,3,2] row_mask:0xf bank_mask:0xf
s_waitcnt lgkmcnt(3)
v_mfma_f32_16x16x32_f16 v[48:51], v[224:227], v[184:187], v[48:51]
buffer_load_dwordx4 v[8:11], v252, s[4:7], s70 offen offset:128
buffer_store_dwordx4 v[120:123], v255, s[8:11], s71 offen sc1
v_mfma_f32_16x16x32_f16 v[56:59], v[224:227], v[188:191], v[56:59]
s_waitcnt lgkmcnt(2)
v_mfma_f32_16x16x32_f16 v[52:55], v[228:231], v[184:187], v[52:55]
ds_read_b128 v[224:227], v249 offset:62720
v_permlane16_swap_b32 v200, v204
v_mfma_f32_16x16x32_f16 v[60:63], v[228:231], v[188:191], v[60:63]
s_waitcnt lgkmcnt(2)
v_mfma_f32_16x16x32_bf16 v[168:171], v[240:243], v[96:99], 0
ds_read_b128 v[228:231], v249 offset:63488
v_permlane16_swap_b32 v201, v205
v_mfma_f32_16x16x32_bf16 v[176:179], v[240:243], v[100:103], 0
s_waitcnt lgkmcnt(2)
v_mfma_f32_16x16x32_f16 v[64:67], v[244:247], v[184:187], v[64:67]
ds_read_b128 v[240:243], v249 offset:63744
v_mfma_f32_16x16x32_f16 v[72:75], v[244:247], v[188:191], v[72:75]
v_permlane16_swap_b32 v202, v206
s_waitcnt lgkmcnt(2)
v_mfma_f32_16x16x32_f16 v[68:71], v[224:227], v[184:187], v[68:71]
ds_read_b128 v[244:247], v248 offset:16640
v_mfma_f32_16x16x32_f16 v[76:79], v[224:227], v[188:191], v[76:79]
v_permlane16_swap_b32 v203, v207
s_waitcnt lgkmcnt(2)
v_mfma_f32_16x16x32_f16 v[80:83], v[228:231], v[184:187], v[80:83]
s_add_u32 s46, s70, 98304
buffer_load_dwordx4 v[12:15], v252, s[4:7], s46 offen
ds_read_b128 v[224:227], v250 offset:2048
v_mfma_f32_16x16x32_f16 v[88:91], v[228:231], v[188:191], v[88:91]
s_waitcnt lgkmcnt(2)
v_mfma_f32_16x16x32_f16 v[84:87], v[240:243], v[184:187], v[84:87]
ds_read_b128 v[228:231], v250 offset:2304
v_permlane16_swap_b32 v232, v236
v_mfma_f32_16x16x32_f16 v[92:95], v[240:243], v[188:191], v[92:95]
s_waitcnt lgkmcnt(2)
v_mfma_f32_16x16x32_bf16 v[172:175], v[244:247], v[96:99], 0
ds_read_b128 v[240:243], v250 offset:3072
v_permlane16_swap_b32 v233, v237
v_mfma_f32_16x16x32_bf16 v[180:183], v[244:247], v[100:103], 0
s_waitcnt lgkmcnt(2)
v_mfma_f32_16x16x32_f16 v[48:51], v[224:227], v[192:195], v[48:51]
ds_read_b128 v[244:247], v250 offset:3328
v_mfma_f32_16x16x32_f16 v[56:59], v[224:227], v[196:199], v[56:59]
v_permlane16_swap_b32 v234, v238
s_waitcnt lgkmcnt(2)
v_mfma_f32_16x16x32_f16 v[52:55], v[228:231], v[192:195], v[52:55]
ds_read_b128 v[224:227], v248 offset:17408
v_mfma_f32_16x16x32_f16 v[60:63], v[228:231], v[196:199], v[60:63]
v_permlane16_swap_b32 v235, v239
s_waitcnt lgkmcnt(2)
v_mfma_f32_16x16x32_f16 v[64:67], v[240:243], v[192:195], v[64:67]
buffer_store_dwordx4 v[140:143], v255, s[8:11], s71 offen offset:128 sc1
ds_read_b128 v[228:231], v250 offset:4096
v_mfma_f32_16x16x32_f16 v[72:75], v[240:243], v[196:199], v[72:75]
s_waitcnt lgkmcnt(2)
v_mfma_f32_16x16x32_f16 v[68:71], v[244:247], v[192:195], v[68:71]
ds_read_b128 v[240:243], v250 offset:4352
v_permlane16_swap_b32 v208, v212
v_mfma_f32_16x16x32_f16 v[76:79], v[244:247], v[196:199], v[76:79]
s_waitcnt lgkmcnt(2)
v_mfma_f32_16x16x32_bf16 v[168:171], v[224:227], v[104:107], v[168:171]
ds_read_b128 v[244:247], v250 offset:8192
v_permlane16_swap_b32 v209, v213
v_mfma_f32_16x16x32_bf16 v[176:179], v[224:227], v[108:111], v[176:179]
s_waitcnt lgkmcnt(2)
v_mfma_f32_16x16x32_f16 v[80:83], v[228:231], v[192:195], v[80:83]
ds_read_b128 v[224:227], v250 offset:8448
v_mfma_f32_16x16x32_f16 v[88:91], v[228:231], v[196:199], v[88:91]
v_permlane16_swap_b32 v210, v214
s_waitcnt lgkmcnt(2)
v_mfma_f32_16x16x32_f16 v[84:87], v[240:243], v[192:195], v[84:87]
ds_read_b128 v[228:231], v248 offset:17664
v_mfma_f32_16x16x32_f16 v[92:95], v[240:243], v[196:199], v[92:95]
v_permlane16_swap_b32 v211, v215
s_waitcnt lgkmcnt(2)
v_mfma_f32_16x16x32_f16 v[48:51], v[244:247], v[200:203], v[48:51]
buffer_store_dwordx4 v[152:155], v255, s[8:11], s71 offen offset:256 sc1
ds_read_b128 v[240:243], v250 offset:9216
v_mfma_f32_16x16x32_f16 v[56:59], v[244:247], v[204:207], v[56:59]
s_waitcnt lgkmcnt(2)
v_mfma_f32_16x16x32_f16 v[52:55], v[224:227], v[200:203], v[52:55]
ds_read_b128 v[244:247], v250 offset:9472
v_mfma_f32_16x16x32_f16 v[60:63], v[224:227], v[204:207], v[60:63]
s_waitcnt lgkmcnt(2)
v_mfma_f32_16x16x32_bf16 v[172:175], v[228:231], v[104:107], v[172:175]
ds_read_b128 v[224:227], v250 offset:10240
v_mfma_f32_16x16x32_bf16 v[180:183], v[228:231], v[108:111], v[180:183]
s_waitcnt lgkmcnt(2)
v_mfma_f32_16x16x32_f16 v[64:67], v[240:243], v[200:203], v[64:67]
ds_read_b128 v[228:231], v250 offset:10496
v_mfma_f32_16x16x32_f16 v[72:75], v[240:243], v[204:207], v[72:75]
s_waitcnt lgkmcnt(2)
v_mfma_f32_16x16x32_f16 v[68:71], v[244:247], v[200:203], v[68:71]
ds_read_b128 v[240:243], v248 offset:18432
v_mfma_f32_16x16x32_f16 v[76:79], v[244:247], v[204:207], v[76:79]
s_waitcnt lgkmcnt(2)
v_mfma_f32_16x16x32_f16 v[80:83], v[224:227], v[200:203], v[80:83]
ds_read_b128 v[244:247], v250 offset:14336
v_permlane16_swap_b32 v216, v220
v_mfma_f32_16x16x32_f16 v[88:91], v[224:227], v[204:207], v[88:91]
s_waitcnt lgkmcnt(2)
v_mfma_f32_16x16x32_f16 v[84:87], v[228:231], v[200:203], v[84:87]
ds_read_b128 v[224:227], v250 offset:14592
v_mfma_f32_16x16x32_f16 v[92:95], v[228:231], v[204:207], v[92:95]
s_waitcnt lgkmcnt(2)
v_mfma_f32_16x16x32_bf16 v[168:171], v[240:243], v[112:115], v[168:171]
ds_read_b128 v[228:231], v250 offset:15360
v_mfma_f32_16x16x32_bf16 v[176:179], v[240:243], v[116:119], v[176:179]
s_waitcnt lgkmcnt(2)
v_mfma_f32_16x16x32_f16 v[48:51], v[244:247], v[232:235], v[48:51]
ds_read_b128 v[240:243], v250 offset:15616
v_mfma_f32_16x16x32_f16 v[56:59], v[244:247], v[236:239], v[56:59]
s_waitcnt lgkmcnt(2)
v_mfma_f32_16x16x32_f16 v[52:55], v[224:227], v[232:235], v[52:55]
ds_read_b128 v[244:247], v248 offset:18688
v_mfma_f32_16x16x32_f16 v[60:63], v[224:227], v[236:239], v[60:63]
s_waitcnt lgkmcnt(2)
v_mfma_f32_16x16x32_f16 v[64:67], v[228:231], v[232:235], v[64:67]
ds_read_b128 v[224:227], v250 offset:16384
v_mfma_f32_16x16x32_f16 v[72:75], v[228:231], v[236:239], v[72:75]
v_permlane16_swap_b32 v217, v221
s_waitcnt lgkmcnt(2)
v_mfma_f32_16x16x32_f16 v[68:71], v[240:243], v[232:235], v[68:71]
ds_read_b128 v[228:231], v250 offset:16640
v_mfma_f32_16x16x32_f16 v[76:79], v[240:243], v[236:239], v[76:79]
s_waitcnt lgkmcnt(2)
v_mfma_f32_16x16x32_bf16 v[172:175], v[244:247], v[112:115], v[172:175]
ds_read_b128 v[240:243], v250 offset:20480
v_mfma_f32_16x16x32_bf16 v[180:183], v[244:247], v[116:119], v[180:183]
s_waitcnt lgkmcnt(2)
v_mfma_f32_16x16x32_f16 v[80:83], v[224:227], v[232:235], v[80:83]
ds_read_b128 v[244:247], v250 offset:20736
v_mfma_f32_16x16x32_f16 v[88:91], v[224:227], v[236:239], v[88:91]
s_waitcnt lgkmcnt(2)
v_mfma_f32_16x16x32_f16 v[84:87], v[228:231], v[232:235], v[84:87]
ds_read_b128 v[224:227], v250 offset:21504
v_mfma_f32_16x16x32_f16 v[92:95], v[228:231], v[236:239], v[92:95]
s_waitcnt lgkmcnt(2)
v_mfma_f32_16x16x32_f16 v[48:51], v[240:243], v[208:211], v[48:51]
ds_read_b128 v[228:231], v250 offset:21760
v_mfma_f32_16x16x32_f16 v[56:59], v[240:243], v[212:215], v[56:59]
v_permlane16_swap_b32 v218, v222
s_waitcnt lgkmcnt(2)
v_mfma_f32_16x16x32_f16 v[52:55], v[244:247], v[208:211], v[52:55]
ds_read_b128 v[240:243], v250 offset:22528
v_mfma_f32_16x16x32_f16 v[60:63], v[244:247], v[212:215], v[60:63]
s_waitcnt lgkmcnt(2)
v_mfma_f32_16x16x32_f16 v[64:67], v[224:227], v[208:211], v[64:67]
ds_read_b128 v[244:247], v250 offset:22784
v_mfma_f32_16x16x32_f16 v[72:75], v[224:227], v[212:215], v[72:75]
s_waitcnt lgkmcnt(2)
v_mfma_f32_16x16x32_f16 v[68:71], v[228:231], v[208:211], v[68:71]
ds_read_b128 v[224:227], v250 offset:26624
v_mfma_f32_16x16x32_f16 v[76:79], v[228:231], v[212:215], v[76:79]
s_waitcnt lgkmcnt(2)
v_mfma_f32_16x16x32_f16 v[80:83], v[240:243], v[208:211], v[80:83]
ds_read_b128 v[228:231], v250 offset:26880
v_mfma_f32_16x16x32_f16 v[88:91], v[240:243], v[212:215], v[88:91]
s_waitcnt lgkmcnt(2)
v_mfma_f32_16x16x32_f16 v[84:87], v[244:247], v[208:211], v[84:87]
ds_read_b128 v[240:243], v248 offset:22528
v_mfma_f32_16x16x32_f16 v[92:95], v[244:247], v[212:215], v[92:95]
v_permlane16_swap_b32 v219, v223
s_setprio 3
s_waitcnt lgkmcnt(2)
v_mfma_f32_16x16x32_f16 v[48:51], v[224:227], v[216:219], v[48:51]
s_add_u32 s46, s70, 98304
buffer_load_dwordx4 v[208:211], v252, s[4:7], s46 offen offset:64
ds_read_b128 v[244:247], v250 offset:27648
v_cvt_pkrtz_f16_f32 v185, v168, v169
v_cvt_pkrtz_f16_f32 v187, v170, v171
v_cvt_pkrtz_f16_f32 v189, v172, v173
v_mfma_f32_16x16x32_f16 v[56:59], v[224:227], v[220:223], v[56:59]
v_cvt_pkrtz_f16_f32 v191, v174, v175
v_cvt_pkrtz_f16_f32 v193, v176, v177
v_cvt_pk_f16_f32 v203, v178, v179
s_waitcnt lgkmcnt(2)
v_mfma_f32_16x16x32_f16 v[52:55], v[228:231], v[216:219], v[52:55]
ds_read_b128 v[224:227], v248 offset:22784
v_cvt_pk_f16_f32 v200, v180, v181
v_cvt_pk_f16_f32 v197, v182, v183
v_pk_fma_f16 v202, v203, v203, s48
v_cvt_pk_bf16_f32 v144, v144, v145
v_mfma_f32_16x16x32_f16 v[60:63], v[228:231], v[220:223], v[60:63]
v_and_b32 v185, s49, v185
v_cvt_pk_bf16_f32 v145, v146, v147
v_pk_fma_f16 v199, v200, v200, s48
s_waitcnt lgkmcnt(2)
v_mfma_f32_16x16x32_bf16 v[168:171], v[240:243], v[96:99], 0
ds_read_b128 v[228:231], v250 offset:27904
v_and_b32 v187, s49, v187
v_cvt_pk_bf16_f32 v146, v148, v149
v_pk_fma_f16 v196, v197, v197, s48
v_mfma_f32_16x16x32_bf16 v[176:179], v[240:243], v[100:103], 0
v_bfe_u32 v184, v185, 2, 14
v_cvt_pk_bf16_f32 v147, v150, v151
v_pk_mul_f16 v202, v203, v202
v_cvt_pk_bf16_f32 v128, v128, v129
s_waitcnt lgkmcnt(2)
v_mfma_f32_16x16x32_f16 v[64:67], v[244:247], v[216:219], v[64:67]
ds_read_b128 v[240:243], v248 offset:23552
ds_read_u16_d16 v184, v184
v_bfe_u32 v186, v187, 2, 14
v_pk_mul_f16 v199, v200, v199
v_cvt_pk_bf16_f32 v129, v130, v131
v_mfma_f32_16x16x32_f16 v[72:75], v[244:247], v[220:223], v[72:75]
v_lshrrev_b32 v185, 18, v185
v_pk_mul_f16 v196, v197, v196
v_cvt_pk_bf16_f32 v130, v132, v133
s_waitcnt lgkmcnt(3)
v_mfma_f32_16x16x32_bf16 v[172:175], v[224:227], v[96:99], 0
ds_read_b128 v[244:247], v250 offset:28672
ds_read_u16_d16 v186, v186
ds_read_u16_d16_hi v185, v185
v_lshrrev_b32_e64 v187, 18, v187
v_cvt_pk_bf16_f32 v131, v134, v135
v_exp_f16_e64 v201, v202
v_mfma_f32_16x16x32_bf16 v[180:183], v[224:227], v[100:103], 0
v_cvt_pk_bf16_f32 v160, v160, v161
v_and_b32_e64 v189, s49, v189
v_and_b32 v191, s49, v191
s_waitcnt lgkmcnt(5)
v_mfma_f32_16x16x32_f16 v[68:71], v[228:231], v[216:219], v[68:71]
ds_read_b128 v[224:227], v250 offset:28928
ds_read_u16_d16_hi v187, v187
v_cvt_pk_bf16_f32 v161, v162, v163
v_exp_f16_e64 v198, v199
v_mfma_f32_16x16x32_f16 v[76:79], v[228:231], v[220:223], v[76:79]
v_cvt_pk_bf16_f32 v162, v164, v165
v_bfe_u32 v188, v189, 2, 14
v_cvt_pk_bf16_f32 v163, v166, v167
s_mov_b64 vcc, s[74:75]
v_bfe_u32 v190, v191, 2, 14
s_waitcnt lgkmcnt(5)
v_mfma_f32_16x16x32_bf16 v[168:171], v[240:243], v[104:107], v[168:171]
s_add_u32 s46, s70, 98304
buffer_load_dwordx4 v[204:207], v252, s[4:7], s46 offen offset:128
ds_read_b128 v[228:231], v248 offset:23808
ds_read_u16_d16 v188, v188
ds_read_u16_d16 v190, v190
v_exp_f16 v195, v196
v_cndmask_b32 v148, v128, v160, vcc
v_mfma_f32_16x16x32_bf16 v[176:179], v[240:243], v[108:111], v[176:179]
v_cndmask_b32 v149, v129, v161, vcc
v_lshrrev_b32 v189, 18, v189
v_lshrrev_b32 v191, 18, v191
s_waitcnt lgkmcnt(5)
v_mfma_f32_16x16x32_f16 v[80:83], v[244:247], v[216:219], v[80:83]
ds_read_b128 v[240:243], v248 offset:24576
ds_read_u16_d16_hi v189, v189
ds_read_u16_d16_hi v191, v191
v_cndmask_b32 v150, v130, v162, vcc
v_exp_f16_sdwa v201, v202 dst_sel:WORD_1 dst_unused:UNUSED_PRESERVE src0_sel:WORD_1
v_cndmask_b32 v151, v131, v163, vcc
v_mfma_f32_16x16x32_f16 v[88:91], v[244:247], v[220:223], v[88:91]
v_and_b32 v193, s49, v193
v_cndmask_b32_dpp v128, v144, v128, vcc quad_perm:[1,0,3,2] row_mask:0xf bank_mask:0xf
v_bfe_u32 v192, v193, 2, 14
s_waitcnt lgkmcnt(6)
v_mfma_f32_16x16x32_f16 v[84:87], v[224:227], v[216:219], v[84:87]
ds_read_b128 v[244:247], v248 offset:24832
ds_read_u16_d16 v192, v192
v_exp_f16_sdwa v198, v199 dst_sel:WORD_1 dst_unused:UNUSED_PRESERVE src0_sel:WORD_1
v_cndmask_b32_dpp v129, v145, v129, vcc quad_perm:[1,0,3,2] row_mask:0xf bank_mask:0xf
v_mfma_f32_16x16x32_f16 v[92:95], v[224:227], v[220:223], v[92:95]
v_lshrrev_b32_e64 v193, 18, v193
v_cndmask_b32_dpp v130, v146, v130, vcc quad_perm:[1,0,3,2] row_mask:0xf bank_mask:0xf
v_exp_f16_sdwa v195, v196 dst_sel:WORD_1 dst_unused:UNUSED_PRESERVE src0_sel:WORD_1
s_waitcnt lgkmcnt(5)
v_mfma_f32_16x16x32_bf16 v[172:175], v[228:231], v[104:107], v[172:175]
ds_read_b128 v[224:227], v249 offset:24576
ds_read_u16_d16_hi v193, v193
v_cndmask_b32_dpp v131, v147, v131, vcc quad_perm:[1,0,3,2] row_mask:0xf bank_mask:0xf
s_not_b64 vcc, s[74:75]
v_pk_add_f16 v201, v201, 1.0 op_sel_hi:[1,0]
v_cndmask_b32_dpp v160, v144, v160, vcc quad_perm:[1,0,3,2] row_mask:0xf bank_mask:0xf
v_mfma_f32_16x16x32_bf16 v[180:183], v[228:231], v[108:111], v[180:183]
v_pk_add_f16 v198, v198, 1.0 op_sel_hi:[1,0]
v_pk_add_f16 v195, v195, 1.0 op_sel_hi:[1,0]
v_cndmask_b32_dpp v161, v145, v161, vcc quad_perm:[1,0,3,2] row_mask:0xf bank_mask:0xf
s_waitcnt lgkmcnt(4)
v_mfma_f32_16x16x32_bf16 v[168:171], v[240:243], v[112:115], v[168:171]
ds_read_b128 v[228:231], v249 offset:24832
v_rcp_f16 v202, v201
v_cndmask_b32_dpp v162, v146, v162, vcc quad_perm:[1,0,3,2] row_mask:0xf bank_mask:0xf
v_mfma_f32_16x16x32_bf16 v[176:179], v[240:243], v[116:119], v[176:179]
v_rcp_f16 v199, v198
v_cndmask_b32_dpp v163, v147, v163, vcc quad_perm:[1,0,3,2] row_mask:0xf bank_mask:0xf
s_waitcnt lgkmcnt(3)
v_mfma_f32_16x16x32_bf16 v[172:175], v[244:247], v[112:115], v[172:175]
ds_read_b128 v[240:243], v248 offset:28672
s_add_u32 s46, s71, 98304
buffer_store_dwordx4 v[128:131], v255, s[8:11], s46 offen sc1
v_rcp_f16_e64 v196, v195
v_rcp_f16_sdwa v202, v201 dst_sel:WORD_1 dst_unused:UNUSED_PRESERVE src0_sel:WORD_1
v_mfma_f32_16x16x32_bf16 v[180:183], v[244:247], v[116:119], v[180:183]
v_rcp_f16_sdwa v199, v198 dst_sel:WORD_1 dst_unused:UNUSED_PRESERVE src0_sel:WORD_1
v_or_b32 v232, v184, v185
v_or_b32 v233, v186, v187
v_or_b32_e64 v234, v188, v189
v_rcp_f16_sdwa v196, v195 dst_sel:WORD_1 dst_unused:UNUSED_PRESERVE src0_sel:WORD_1
v_or_b32 v235, v190, v191
s_waitcnt lgkmcnt(2)
v_or_b32_e64 v236, v192, v193
v_pk_mul_f16 v237, v203, v202
v_pk_mul_f16 v238, v200, v199
v_pk_mul_f16 v239, v197, v196
v_mfma_f32_16x16x32_f16 v[48:51], v[224:227], v[232:235], v[48:51]
s_add_u32 s46, s71, 98304
buffer_store_dwordx4 v[148:151], v255, s[8:11], s46 offen offset:128 sc1
ds_read_b128 v[244:247], v249 offset:25600
ds_read_b128 v[216:219], v248 offset:28928
ds_read_b128 v[220:223], v249 offset:25856
v_cvt_pkrtz_f16_f32 v185, v168, v169
v_cvt_pkrtz_f16_f32 v187, v170, v171
v_mfma_f32_16x16x32_f16 v[56:59], v[224:227], v[236:239], v[56:59]
v_cvt_pkrtz_f16_f32 v189, v172, v173
v_cvt_pkrtz_f16_f32 v191, v174, v175
s_waitcnt lgkmcnt(3)
v_mfma_f32_16x16x32_f16 v[52:55], v[228:231], v[232:235], v[52:55]
ds_read_b128 v[224:227], v248 offset:29696
v_cvt_pkrtz_f16_f32 v193, v176, v177
v_cvt_pk_f16_f32 v203, v178, v179
v_mfma_f32_16x16x32_f16 v[60:63], v[228:231], v[236:239], v[60:63]
v_cvt_pk_f16_f32 v200, v180, v181
v_cvt_pk_f16_f32 v197, v182, v183
v_mfma_f32_16x16x32_bf16 v[168:171], v[240:243], v[96:99], 0
ds_read_b128 v[228:231], v249 offset:26624
v_pk_fma_f16 v202, v203, v203, s48
v_and_b32 v185, s49, v185
v_mfma_f32_16x16x32_bf16 v[176:179], v[240:243], v[100:103], 0
v_pk_fma_f16 v199, v200, v200, s48
v_and_b32 v187, s49, v187
s_waitcnt lgkmcnt(4)
v_mfma_f32_16x16x32_f16 v[64:67], v[244:247], v[232:235], v[64:67]
ds_read_b128 v[240:243], v249 offset:26880
v_pk_fma_f16 v196, v197, v197, s48
s_setprio 2
v_bfe_u32 v184, v185, 2, 14
v_pk_mul_f16 v202, v203, v202
v_mfma_f32_16x16x32_f16 v[72:75], v[244:247], v[236:239], v[72:75]
v_bfe_u32 v186, v187, 2, 14
v_pk_mul_f16 v199, v200, v199
s_waitcnt vmcnt(10)
v_mfma_f32_16x16x32_bf16 v[48:51], v[18:21], v[4:7], v[48:51]
ds_read_b128 v[244:247], v248 offset:29952
ds_read_u16_d16 v184, v184
ds_read_u16_d16 v186, v186
v_lshrrev_b32_e64 v185, 18, v185
v_pk_mul_f16 v196, v197, v196
v_mfma_f32_16x16x32_bf16 v[52:55], v[16:19], v[4:7], v[52:55]
v_lshrrev_b32 v187, 18, v187
s_waitcnt lgkmcnt(4)
v_mfma_f32_16x16x32_bf16 v[172:175], v[216:219], v[96:99], 0
ds_read_u16_d16_hi v185, v185
ds_read_u16_d16_hi v187, v187
v_exp_f16 v201, v202
v_and_b32 v189, s49, v189
v_mfma_f32_16x16x32_bf16 v[180:183], v[216:219], v[100:103], 0
v_and_b32_e64 v191, s49, v191
v_mfma_f32_16x16x32_f16 v[68:71], v[220:223], v[232:235], v[68:71]
ds_read_b128 v[216:219], v248 offset:30720
v_exp_f16_e64 v198, v199
v_bfe_u32 v188, v189, 2, 14
v_mfma_f32_16x16x32_f16 v[76:79], v[220:223], v[236:239], v[76:79]
v_bfe_u32 v190, v191, 2, 14
v_exp_f16_e64 v195, v196
v_mfma_f32_16x16x32_bf16 v[168:171], v[224:227], v[104:107], v[168:171]
ds_read_b128 v[220:223], v248 offset:30976
ds_read_u16_d16 v188, v188
ds_read_u16_d16 v190, v190
v_lshrrev_b32 v189, 18, v189
v_lshrrev_b32 v191, 18, v191
v_mfma_f32_16x16x32_bf16 v[176:179], v[224:227], v[108:111], v[176:179]
v_exp_f16_sdwa v201, v202 dst_sel:WORD_1 dst_unused:UNUSED_PRESERVE src0_sel:WORD_1
v_mfma_f32_16x16x32_f16 v[80:83], v[228:231], v[232:235], v[80:83]
ds_read_b128 v[224:227], v249 offset:30720
ds_read_u16_d16_hi v189, v189
ds_read_u16_d16_hi v191, v191
v_and_b32 v193, s49, v193
v_bfe_u32 v192, v193, 2, 14
v_mfma_f32_16x16x32_f16 v[88:91], v[228:231], v[236:239], v[88:91]
v_exp_f16_sdwa v198, v199 dst_sel:WORD_1 dst_unused:UNUSED_PRESERVE src0_sel:WORD_1
s_waitcnt lgkmcnt(7)
v_mfma_f32_16x16x32_f16 v[84:87], v[240:243], v[232:235], v[84:87]
ds_read_b128 v[228:231], v249 offset:30976
ds_read_u16_d16 v192, v192
v_lshrrev_b32_e64 v193, 18, v193
v_mfma_f32_16x16x32_f16 v[92:95], v[240:243], v[236:239], v[92:95]
v_exp_f16_sdwa v195, v196 dst_sel:WORD_1 dst_unused:UNUSED_PRESERVE src0_sel:WORD_1
v_pk_add_f16 v201, v201, 1.0 op_sel_hi:[1,0]
v_pk_add_f16 v198, v198, 1.0 op_sel_hi:[1,0]
v_mfma_f32_16x16x32_bf16 v[172:175], v[244:247], v[104:107], v[172:175]
ds_read_b128 v[240:243], v248 offset:34816
ds_read_u16_d16_hi v193, v193
v_pk_add_f16 v195, v195, 1.0 op_sel_hi:[1,0]
v_mfma_f32_16x16x32_bf16 v[180:183], v[244:247], v[108:111], v[180:183]
v_rcp_f16 v202, v201
s_waitcnt lgkmcnt(7)
v_mfma_f32_16x16x32_bf16 v[168:171], v[216:219], v[112:115], v[168:171]
ds_read_b128 v[244:247], v249 offset:31744
v_rcp_f16_e64 v199, v198
v_mfma_f32_16x16x32_bf16 v[176:179], v[216:219], v[116:119], v[176:179]
v_rcp_f16_e64 v196, v195
v_mfma_f32_16x16x32_bf16 v[172:175], v[220:223], v[112:115], v[172:175]
ds_read_b128 v[216:219], v248 offset:35072
v_rcp_f16_sdwa v202, v201 dst_sel:WORD_1 dst_unused:UNUSED_PRESERVE src0_sel:WORD_1
v_mfma_f32_16x16x32_bf16 v[180:183], v[220:223], v[116:119], v[180:183]
v_rcp_f16_sdwa v199, v198 dst_sel:WORD_1 dst_unused:UNUSED_PRESERVE src0_sel:WORD_1
v_or_b32 v232, v184, v185
v_or_b32 v233, v186, v187
s_waitcnt lgkmcnt(4)
v_or_b32 v234, v188, v189
v_rcp_f16_sdwa v196, v195 dst_sel:WORD_1 dst_unused:UNUSED_PRESERVE src0_sel:WORD_1
v_or_b32 v235, v190, v191
s_waitcnt lgkmcnt(2)
v_or_b32_e64 v236, v192, v193
v_pk_mul_f16 v237, v203, v202
v_pk_mul_f16 v238, v200, v199
v_pk_mul_f16 v239, v197, v196
v_mfma_f32_16x16x32_f16 v[48:51], v[224:227], v[232:235], v[48:51]
s_add_u32 s46, s71, 98304
buffer_store_dwordx4 v[160:163], v255, s[8:11], s46 offen offset:256 sc1
ds_read_b128 v[220:223], v249 offset:32000
v_cvt_pkrtz_f16_f32 v185, v168, v169
v_cvt_pkrtz_f16_f32 v187, v170, v171
v_mfma_f32_16x16x32_f16 v[56:59], v[224:227], v[236:239], v[56:59]
v_cvt_pkrtz_f16_f32 v189, v172, v173
v_cvt_pkrtz_f16_f32 v191, v174, v175
v_mfma_f32_16x16x32_f16 v[52:55], v[228:231], v[232:235], v[52:55]
ds_read_b128 v[224:227], v248 offset:35840
v_cvt_pkrtz_f16_f32 v193, v176, v177
v_cvt_pk_f16_f32 v203, v178, v179
v_mfma_f32_16x16x32_f16 v[60:63], v[228:231], v[236:239], v[60:63]
v_cvt_pk_f16_f32 v200, v180, v181
v_cvt_pk_f16_f32 v197, v182, v183
s_setprio 1
v_mfma_f32_16x16x32_bf16 v[168:171], v[240:243], v[96:99], 0
ds_read_b128 v[228:231], v249 offset:32768
v_pk_fma_f16 v202, v203, v203, s48
v_and_b32 v185, s49, v185
v_mfma_f32_16x16x32_bf16 v[176:179], v[240:243], v[100:103], 0
v_pk_fma_f16 v199, v200, v200, s48
v_and_b32 v187, s49, v187
s_waitcnt lgkmcnt(3)
v_mfma_f32_16x16x32_f16 v[64:67], v[244:247], v[232:235], v[64:67]
ds_read_b128 v[240:243], v249 offset:33024
v_pk_fma_f16 v196, v197, v197, s48
v_bfe_u32 v184, v185, 2, 14
v_pk_mul_f16 v202, v203, v202
v_mfma_f32_16x16x32_f16 v[72:75], v[244:247], v[236:239], v[72:75]
v_bfe_u32 v186, v187, 2, 14
v_pk_mul_f16 v199, v200, v199
s_waitcnt vmcnt(10)
v_mfma_f32_16x16x32_bf16 v[64:67], v[18:21], v[0:3], v[64:67]
ds_read_b128 v[244:247], v248 offset:36096
ds_read_u16_d16 v184, v184
ds_read_u16_d16 v186, v186
v_lshrrev_b32 v185, 18, v185
v_pk_mul_f16 v196, v197, v196
v_mfma_f32_16x16x32_bf16 v[68:71], v[16:19], v[0:3], v[68:71]
v_lshrrev_b32_e64 v187, 18, v187
v_mfma_f32_16x16x32_bf16 v[172:175], v[216:219], v[96:99], 0
ds_read_u16_d16_hi v185, v185
ds_read_u16_d16_hi v187, v187
v_exp_f16 v201, v202
v_and_b32 v189, s49, v189
v_mfma_f32_16x16x32_bf16 v[180:183], v[216:219], v[100:103], 0
v_and_b32 v191, s49, v191
s_waitcnt lgkmcnt(6)
v_mfma_f32_16x16x32_f16 v[68:71], v[220:223], v[232:235], v[68:71]
ds_read_b128 v[216:219], v248 offset:36864
v_exp_f16_e64 v198, v199
v_bfe_u32 v188, v189, 2, 14
v_mfma_f32_16x16x32_f16 v[76:79], v[220:223], v[236:239], v[76:79]
v_bfe_u32 v190, v191, 2, 14
v_exp_f16_e64 v195, v196
v_mfma_f32_16x16x32_bf16 v[168:171], v[224:227], v[104:107], v[168:171]
ds_read_b128 v[220:223], v248 offset:37120
ds_read_u16_d16 v188, v188
ds_read_u16_d16 v190, v190
v_lshrrev_b32 v189, 18, v189
v_lshrrev_b32 v191, 18, v191
v_mfma_f32_16x16x32_bf16 v[176:179], v[224:227], v[108:111], v[176:179]
v_exp_f16_sdwa v201, v202 dst_sel:WORD_1 dst_unused:UNUSED_PRESERVE src0_sel:WORD_1
v_mfma_f32_16x16x32_f16 v[80:83], v[228:231], v[232:235], v[80:83]
ds_read_b128 v[224:227], v249 offset:36864
ds_read_u16_d16_hi v189, v189
ds_read_u16_d16_hi v191, v191
v_and_b32 v193, s49, v193
v_bfe_u32 v192, v193, 2, 14
v_mfma_f32_16x16x32_f16 v[88:91], v[228:231], v[236:239], v[88:91]
v_exp_f16_sdwa v198, v199 dst_sel:WORD_1 dst_unused:UNUSED_PRESERVE src0_sel:WORD_1
s_waitcnt lgkmcnt(7)
v_mfma_f32_16x16x32_f16 v[84:87], v[240:243], v[232:235], v[84:87]
ds_read_b128 v[228:231], v249 offset:37120
ds_read_u16_d16 v192, v192
v_lshrrev_b32_e64 v193, 18, v193
v_mfma_f32_16x16x32_f16 v[92:95], v[240:243], v[236:239], v[92:95]
v_exp_f16_sdwa v195, v196 dst_sel:WORD_1 dst_unused:UNUSED_PRESERVE src0_sel:WORD_1
v_pk_add_f16 v201, v201, 1.0 op_sel_hi:[1,0]
v_pk_add_f16 v198, v198, 1.0 op_sel_hi:[1,0]
v_mfma_f32_16x16x32_bf16 v[172:175], v[244:247], v[104:107], v[172:175]
ds_read_b128 v[240:243], v248 offset:16384
ds_read_u16_d16_hi v193, v193
v_pk_add_f16 v195, v195, 1.0 op_sel_hi:[1,0]
v_mfma_f32_16x16x32_bf16 v[180:183], v[244:247], v[108:111], v[180:183]
v_rcp_f16_e64 v202, v201
s_setprio 0
s_waitcnt lgkmcnt(7)
v_mfma_f32_16x16x32_bf16 v[168:171], v[216:219], v[112:115], v[168:171]
ds_read_b128 v[244:247], v249 offset:37888
v_rcp_f16_e64 v199, v198
v_mfma_f32_16x16x32_bf16 v[176:179], v[216:219], v[116:119], v[176:179]
v_rcp_f16_e64 v196, v195
v_mfma_f32_16x16x32_bf16 v[172:175], v[220:223], v[112:115], v[172:175]
ds_read_b128 v[216:219], v248 offset:16640
v_rcp_f16_sdwa v202, v201 dst_sel:WORD_1 dst_unused:UNUSED_PRESERVE src0_sel:WORD_1
v_mfma_f32_16x16x32_bf16 v[180:183], v[220:223], v[116:119], v[180:183]
v_rcp_f16_sdwa v199, v198 dst_sel:WORD_1 dst_unused:UNUSED_PRESERVE src0_sel:WORD_1
v_or_b32 v232, v184, v185
v_or_b32 v233, v186, v187
s_waitcnt lgkmcnt(4)
v_or_b32 v234, v188, v189
v_rcp_f16_sdwa v196, v195 dst_sel:WORD_1 dst_unused:UNUSED_PRESERVE src0_sel:WORD_1
v_or_b32 v235, v190, v191
s_waitcnt lgkmcnt(2)
v_or_b32 v236, v192, v193
v_pk_mul_f16 v237, v203, v202
v_pk_mul_f16 v238, v200, v199
v_pk_mul_f16 v239, v197, v196
s_setprio 3
v_mfma_f32_16x16x32_f16 v[48:51], v[224:227], v[232:235], v[48:51]
s_add_u32 s46, s80, 12582912
buffer_load_dwordx4 v[96:99], v253, s[32:35], s46 offen nt
ds_read_b128 v[220:223], v249 offset:38144
v_cvt_pkrtz_f16_f32 v185, v168, v169
v_cvt_pkrtz_f16_f32 v187, v170, v171
v_mfma_f32_16x16x32_f16 v[56:59], v[224:227], v[236:239], v[56:59]
v_cvt_pkrtz_f16_f32 v189, v172, v173
v_cvt_pkrtz_f16_f32 v191, v174, v175
v_mfma_f32_16x16x32_f16 v[52:55], v[228:231], v[232:235], v[52:55]
ds_read_b128 v[224:227], v248 offset:17408
v_cvt_pkrtz_f16_f32 v193, v176, v177
v_cvt_pk_f16_f32 v203, v178, v179
v_mfma_f32_16x16x32_f16 v[60:63], v[228:231], v[236:239], v[60:63]
v_cvt_pk_f16_f32 v200, v180, v181
v_cvt_pk_f16_f32 v197, v182, v183
v_mfma_f32_16x16x32_bf16 v[168:171], v[240:243], v[24:27], 0
ds_read_b128 v[228:231], v249 offset:38912
v_pk_fma_f16 v202, v203, v203, s48
v_and_b32_e64 v185, s49, v185
v_mfma_f32_16x16x32_bf16 v[176:179], v[240:243], v[28:31], 0
v_pk_fma_f16 v199, v200, v200, s48
v_and_b32 v187, s49, v187
s_waitcnt lgkmcnt(3)
v_mfma_f32_16x16x32_f16 v[64:67], v[244:247], v[232:235], v[64:67]
ds_read_b128 v[240:243], v249 offset:39168
v_pk_fma_f16 v196, v197, v197, s48
v_bfe_u32 v184, v185, 2, 14
v_pk_mul_f16 v202, v203, v202
v_mfma_f32_16x16x32_f16 v[72:75], v[244:247], v[236:239], v[72:75]
v_bfe_u32 v186, v187, 2, 14
v_pk_mul_f16 v199, v200, v199
s_waitcnt vmcnt(10)
v_mfma_f32_16x16x32_bf16 v[80:83], v[18:21], v[8:11], v[80:83]
ds_read_b128 v[244:247], v248 offset:17664
ds_read_u16_d16 v184, v184
ds_read_u16_d16 v186, v186
v_lshrrev_b32 v185, 18, v185
v_pk_mul_f16 v196, v197, v196
v_mfma_f32_16x16x32_bf16 v[84:87], v[16:19], v[8:11], v[84:87]
v_lshrrev_b32_e64 v187, 18, v187
v_mfma_f32_16x16x32_bf16 v[172:175], v[216:219], v[24:27], 0
ds_read_u16_d16_hi v185, v185
ds_read_u16_d16_hi v187, v187
v_exp_f16 v201, v202
v_and_b32 v189, s49, v189
v_mfma_f32_16x16x32_bf16 v[180:183], v[216:219], v[28:31], 0
v_and_b32 v191, s49, v191
s_waitcnt lgkmcnt(6)
v_mfma_f32_16x16x32_f16 v[68:71], v[220:223], v[232:235], v[68:71]
ds_read_b128 v[216:219], v248 offset:18432
v_exp_f16_e64 v198, v199
v_bfe_u32 v188, v189, 2, 14
v_mfma_f32_16x16x32_f16 v[76:79], v[220:223], v[236:239], v[76:79]
v_bfe_u32 v190, v191, 2, 14
v_exp_f16_e64 v195, v196
v_mfma_f32_16x16x32_bf16 v[168:171], v[224:227], v[32:35], v[168:171]
ds_read_b128 v[220:223], v248 offset:18688
ds_read_u16_d16 v188, v188
ds_read_u16_d16 v190, v190
v_lshrrev_b32 v189, 18, v189
v_lshrrev_b32 v191, 18, v191
v_mfma_f32_16x16x32_bf16 v[176:179], v[224:227], v[36:39], v[176:179]
v_exp_f16_sdwa v201, v202 dst_sel:WORD_1 dst_unused:UNUSED_PRESERVE src0_sel:WORD_1
v_mfma_f32_16x16x32_f16 v[80:83], v[228:231], v[232:235], v[80:83]
ds_read_b128 v[224:227], v249 offset:43008
ds_read_u16_d16_hi v189, v189
ds_read_u16_d16_hi v191, v191
v_and_b32 v193, s49, v193
v_bfe_u32 v192, v193, 2, 14
v_mfma_f32_16x16x32_f16 v[88:91], v[228:231], v[236:239], v[88:91]
v_exp_f16_sdwa v198, v199 dst_sel:WORD_1 dst_unused:UNUSED_PRESERVE src0_sel:WORD_1
s_waitcnt lgkmcnt(7)
v_mfma_f32_16x16x32_f16 v[84:87], v[240:243], v[232:235], v[84:87]
ds_read_b128 v[228:231], v249 offset:43264
ds_read_u16_d16 v192, v192
v_lshrrev_b32_e64 v193, 18, v193
v_mfma_f32_16x16x32_f16 v[92:95], v[240:243], v[236:239], v[92:95]
v_exp_f16_sdwa v195, v196 dst_sel:WORD_1 dst_unused:UNUSED_PRESERVE src0_sel:WORD_1
v_pk_add_f16 v201, v201, 1.0 op_sel_hi:[1,0]
v_pk_add_f16 v198, v198, 1.0 op_sel_hi:[1,0]
v_mfma_f32_16x16x32_bf16 v[172:175], v[244:247], v[32:35], v[172:175]
ds_read_b128 v[240:243], v248 offset:22528
ds_read_u16_d16_hi v193, v193
v_pk_add_f16 v195, v195, 1.0 op_sel_hi:[1,0]
v_mfma_f32_16x16x32_bf16 v[180:183], v[244:247], v[36:39], v[180:183]
v_rcp_f16 v202, v201
s_waitcnt lgkmcnt(7)
v_mfma_f32_16x16x32_bf16 v[168:171], v[216:219], v[40:43], v[168:171]
ds_read_b128 v[244:247], v249 offset:44032
v_rcp_f16_e64 v199, v198
v_mfma_f32_16x16x32_bf16 v[176:179], v[216:219], v[44:47], v[176:179]
v_rcp_f16_e64 v196, v195
v_mfma_f32_16x16x32_bf16 v[172:175], v[220:223], v[40:43], v[172:175]
ds_read_b128 v[216:219], v248 offset:22784
v_rcp_f16_sdwa v202, v201 dst_sel:WORD_1 dst_unused:UNUSED_PRESERVE src0_sel:WORD_1
v_mfma_f32_16x16x32_bf16 v[180:183], v[220:223], v[44:47], v[180:183]
v_rcp_f16_sdwa v199, v198 dst_sel:WORD_1 dst_unused:UNUSED_PRESERVE src0_sel:WORD_1
v_or_b32 v232, v184, v185
v_or_b32 v233, v186, v187
s_waitcnt lgkmcnt(4)
v_or_b32 v234, v188, v189
v_rcp_f16_sdwa v196, v195 dst_sel:WORD_1 dst_unused:UNUSED_PRESERVE src0_sel:WORD_1
v_or_b32 v235, v190, v191
s_waitcnt lgkmcnt(2)
v_or_b32_e64 v236, v192, v193
v_pk_mul_f16 v237, v203, v202
v_pk_mul_f16 v238, v200, v199
v_pk_mul_f16 v239, v197, v196
v_mfma_f32_16x16x32_f16 v[48:51], v[224:227], v[232:235], v[48:51]
s_add_u32 s46, s80, 12582912
buffer_load_dwordx4 v[100:103], v253, s[32:35], s46 offen offset:256 nt
ds_read_b128 v[220:223], v249 offset:44288
v_cvt_pkrtz_f16_f32 v185, v168, v169
v_cvt_pkrtz_f16_f32 v187, v170, v171
v_mfma_f32_16x16x32_f16 v[56:59], v[224:227], v[236:239], v[56:59]
v_cvt_pkrtz_f16_f32 v189, v172, v173
v_cvt_pkrtz_f16_f32 v191, v174, v175
v_mfma_f32_16x16x32_f16 v[52:55], v[228:231], v[232:235], v[52:55]
ds_read_b128 v[224:227], v248 offset:23552
v_cvt_pkrtz_f16_f32 v193, v176, v177
v_cvt_pk_f16_f32 v203, v178, v179
v_mfma_f32_16x16x32_f16 v[60:63], v[228:231], v[236:239], v[60:63]
v_cvt_pk_f16_f32 v200, v180, v181
v_cvt_pk_f16_f32 v197, v182, v183
v_mfma_f32_16x16x32_bf16 v[168:171], v[240:243], v[24:27], 0
ds_read_b128 v[228:231], v249 offset:45056
v_pk_fma_f16 v202, v203, v203, s48
v_and_b32_e64 v185, s49, v185
v_mfma_f32_16x16x32_bf16 v[176:179], v[240:243], v[28:31], 0
v_pk_fma_f16 v199, v200, v200, s48
v_and_b32 v187, s49, v187
s_waitcnt lgkmcnt(3)
v_mfma_f32_16x16x32_f16 v[64:67], v[244:247], v[232:235], v[64:67]
ds_read_b128 v[240:243], v249 offset:45312
v_pk_fma_f16 v196, v197, v197, s48
s_setprio 2
v_bfe_u32 v184, v185, 2, 14
v_pk_mul_f16 v202, v203, v202
v_mfma_f32_16x16x32_f16 v[72:75], v[244:247], v[236:239], v[72:75]
v_bfe_u32 v186, v187, 2, 14
v_pk_mul_f16 v199, v200, v199
s_waitcnt vmcnt(9)
v_mfma_f32_16x16x32_bf16 v[56:59], v[18:21], v[12:15], v[56:59]
ds_read_b128 v[244:247], v248 offset:23808
ds_read_u16_d16 v184, v184
ds_read_u16_d16 v186, v186
v_lshrrev_b32_e64 v185, 18, v185
v_pk_mul_f16 v196, v197, v196
v_mfma_f32_16x16x32_bf16 v[60:63], v[16:19], v[12:15], v[60:63]
v_lshrrev_b32_e64 v187, 18, v187
v_mfma_f32_16x16x32_bf16 v[172:175], v[216:219], v[24:27], 0
ds_read_u16_d16_hi v185, v185
ds_read_u16_d16_hi v187, v187
v_exp_f16 v201, v202
v_and_b32 v189, s49, v189
v_mfma_f32_16x16x32_bf16 v[180:183], v[216:219], v[28:31], 0
v_and_b32 v191, s49, v191
s_waitcnt lgkmcnt(6)
v_mfma_f32_16x16x32_f16 v[68:71], v[220:223], v[232:235], v[68:71]
ds_read_b128 v[216:219], v248 offset:24576
v_exp_f16_e64 v198, v199
v_bfe_u32 v188, v189, 2, 14
v_mfma_f32_16x16x32_f16 v[76:79], v[220:223], v[236:239], v[76:79]
v_bfe_u32 v190, v191, 2, 14
v_exp_f16_e64 v195, v196
v_mfma_f32_16x16x32_bf16 v[168:171], v[224:227], v[32:35], v[168:171]
ds_read_b128 v[220:223], v248 offset:24832
ds_read_u16_d16 v188, v188
ds_read_u16_d16 v190, v190
v_lshrrev_b32 v189, 18, v189
v_lshrrev_b32 v191, 18, v191
v_mfma_f32_16x16x32_bf16 v[176:179], v[224:227], v[36:39], v[176:179]
v_exp_f16_sdwa v201, v202 dst_sel:WORD_1 dst_unused:UNUSED_PRESERVE src0_sel:WORD_1
v_mfma_f32_16x16x32_f16 v[80:83], v[228:231], v[232:235], v[80:83]
ds_read_b128 v[224:227], v249 offset:24576
ds_read_u16_d16_hi v189, v189
ds_read_u16_d16_hi v191, v191
v_and_b32 v193, s49, v193
v_bfe_u32 v192, v193, 2, 14
v_mfma_f32_16x16x32_f16 v[88:91], v[228:231], v[236:239], v[88:91]
v_exp_f16_sdwa v198, v199 dst_sel:WORD_1 dst_unused:UNUSED_PRESERVE src0_sel:WORD_1
s_waitcnt lgkmcnt(7)
v_mfma_f32_16x16x32_f16 v[84:87], v[240:243], v[232:235], v[84:87]
ds_read_b128 v[228:231], v254 offset:7936
ds_read_u16_d16 v192, v192
v_lshrrev_b32_e64 v193, 18, v193
v_mfma_f32_16x16x32_f16 v[92:95], v[240:243], v[236:239], v[92:95]
v_exp_f16_sdwa v195, v196 dst_sel:WORD_1 dst_unused:UNUSED_PRESERVE src0_sel:WORD_1
v_pk_add_f16 v201, v201, 1.0 op_sel_hi:[1,0]
v_pk_add_f16 v198, v198, 1.0 op_sel_hi:[1,0]
v_mfma_f32_16x16x32_bf16 v[172:175], v[244:247], v[32:35], v[172:175]
ds_read_b128 v[240:243], v249 offset:24832
ds_read_u16_d16_hi v193, v193
v_pk_add_f16 v195, v195, 1.0 op_sel_hi:[1,0]
v_mfma_f32_16x16x32_bf16 v[180:183], v[244:247], v[36:39], v[180:183]
v_rcp_f16 v202, v201
s_waitcnt lgkmcnt(7)
v_mfma_f32_16x16x32_bf16 v[168:171], v[216:219], v[40:43], v[168:171]
ds_read_b128 v[244:247], v254 offset:7952
v_rcp_f16_e64 v199, v198
v_mfma_f32_16x16x32_bf16 v[176:179], v[216:219], v[44:47], v[176:179]
v_rcp_f16_e64 v196, v195
v_mfma_f32_16x16x32_bf16 v[172:175], v[220:223], v[40:43], v[172:175]
ds_read_b128 v[216:219], v248 offset:28672
v_rcp_f16_sdwa v202, v201 dst_sel:WORD_1 dst_unused:UNUSED_PRESERVE src0_sel:WORD_1
v_mfma_f32_16x16x32_bf16 v[180:183], v[220:223], v[44:47], v[180:183]
v_rcp_f16_sdwa v199, v198 dst_sel:WORD_1 dst_unused:UNUSED_PRESERVE src0_sel:WORD_1
v_or_b32 v232, v184, v185
v_or_b32 v233, v186, v187
s_waitcnt lgkmcnt(4)
v_or_b32 v234, v188, v189
v_rcp_f16_sdwa v196, v195 dst_sel:WORD_1 dst_unused:UNUSED_PRESERVE src0_sel:WORD_1
v_or_b32 v235, v190, v191
s_waitcnt lgkmcnt(2)
v_or_b32 v236, v192, v193
v_pk_mul_f16 v237, v203, v202
v_pk_mul_f16 v238, v200, v199
v_pk_mul_f16 v239, v197, v196
v_mfma_f32_16x16x32_f16 v[120:123], v[224:227], v[232:235], v[228:231]
s_add_u32 s46, s80, 16777216
buffer_load_dwordx4 v[104:107], v253, s[32:35], s46 offen nt
ds_read_b128 v[220:223], v249 offset:25600
v_cvt_pkrtz_f16_f32 v185, v168, v169
v_cvt_pkrtz_f16_f32 v187, v170, v171
v_mfma_f32_16x16x32_f16 v[128:131], v[224:227], v[236:239], v[228:231]
v_cvt_pkrtz_f16_f32 v189, v172, v173
v_cvt_pkrtz_f16_f32 v191, v174, v175
s_waitcnt lgkmcnt(2)
v_mfma_f32_16x16x32_f16 v[124:127], v[240:243], v[232:235], v[244:247]
ds_read_b128 v[224:227], v254 offset:8064
ds_read_b128 v[228:231], v248 offset:28928
v_cvt_pkrtz_f16_f32 v193, v176, v177
v_cvt_pk_f16_f32 v203, v178, v179
v_mfma_f32_16x16x32_f16 v[132:135], v[240:243], v[236:239], v[244:247]
v_cvt_pk_f16_f32 v200, v180, v181
v_cvt_pk_f16_f32 v197, v182, v183
s_setprio 1
s_waitcnt lgkmcnt(3)
v_mfma_f32_16x16x32_bf16 v[168:171], v[216:219], v[24:27], 0
ds_read_b128 v[240:243], v249 offset:25856
ds_read_b128 v[244:247], v254 offset:8080
v_pk_fma_f16 v202, v203, v203, s48
v_and_b32_e64 v185, s49, v185
v_mfma_f32_16x16x32_bf16 v[176:179], v[216:219], v[28:31], 0
v_pk_fma_f16 v199, v200, v200, s48
v_and_b32 v187, s49, v187
s_waitcnt lgkmcnt(3)
v_mfma_f32_16x16x32_f16 v[136:139], v[220:223], v[232:235], v[224:227]
ds_read_b128 v[216:219], v248 offset:29696
v_pk_fma_f16 v196, v197, v197, s48
v_bfe_u32 v184, v185, 2, 14
v_pk_mul_f16 v202, v203, v202
v_mfma_f32_16x16x32_f16 v[144:147], v[220:223], v[236:239], v[224:227]
v_bfe_u32 v186, v187, 2, 14
v_pk_mul_f16 v199, v200, v199
s_waitcnt vmcnt(7)
v_mfma_f32_16x16x32_bf16 v[72:75], v[18:21], v[208:211], v[72:75]
ds_read_b128 v[220:223], v249 offset:26624
ds_read_b128 v[224:227], v254 offset:16128
ds_read_u16_d16 v184, v184
ds_read_u16_d16 v186, v186
v_lshrrev_b32 v185, 18, v185
v_pk_mul_f16 v196, v197, v196
v_mfma_f32_16x16x32_bf16 v[76:79], v[16:19], v[208:211], v[76:79]
v_lshrrev_b32 v187, 18, v187
s_waitcnt lgkmcnt(5)
v_mfma_f32_16x16x32_bf16 v[172:175], v[228:231], v[24:27], 0
ds_read_u16_d16_hi v185, v185
ds_read_u16_d16_hi v187, v187
v_exp_f16 v201, v202
v_and_b32 v189, s49, v189
v_mfma_f32_16x16x32_bf16 v[180:183], v[228:231], v[28:31], 0
v_and_b32_e64 v191, s49, v191
v_mfma_f32_16x16x32_f16 v[140:143], v[240:243], v[232:235], v[244:247]
ds_read_b128 v[228:231], v249 offset:26880
v_exp_f16_e64 v198, v199
v_bfe_u32 v188, v189, 2, 14
v_mfma_f32_16x16x32_f16 v[148:151], v[240:243], v[236:239], v[244:247]
v_bfe_u32 v190, v191, 2, 14
v_exp_f16 v195, v196
s_waitcnt lgkmcnt(7)
v_mfma_f32_16x16x32_bf16 v[168:171], v[216:219], v[32:35], v[168:171]
ds_read_b128 v[240:243], v254 offset:16144
ds_read_b128 v[244:247], v248 offset:29952
ds_read_u16_d16 v188, v188
ds_read_u16_d16 v190, v190
v_lshrrev_b32_e64 v189, 18, v189
v_lshrrev_b32 v191, 18, v191
v_mfma_f32_16x16x32_bf16 v[176:179], v[216:219], v[36:39], v[176:179]
v_exp_f16_sdwa v201, v202 dst_sel:WORD_1 dst_unused:UNUSED_PRESERVE src0_sel:WORD_1
s_waitcnt lgkmcnt(7)
v_mfma_f32_16x16x32_f16 v[152:155], v[220:223], v[232:235], v[224:227]
ds_read_b128 v[216:219], v248 offset:30720
ds_read_u16_d16_hi v189, v189
ds_read_u16_d16_hi v191, v191
v_and_b32 v193, s49, v193
v_bfe_u32 v192, v193, 2, 14
v_mfma_f32_16x16x32_f16 v[160:163], v[220:223], v[236:239], v[224:227]
v_exp_f16_sdwa v198, v199 dst_sel:WORD_1 dst_unused:UNUSED_PRESERVE src0_sel:WORD_1
s_waitcnt lgkmcnt(6)
v_mfma_f32_16x16x32_f16 v[156:159], v[228:231], v[232:235], v[240:243]
ds_read_b128 v[220:223], v248 offset:30976
ds_read_b128 v[224:227], v249 offset:30720
ds_read_u16_d16 v192, v192
v_lshrrev_b32 v193, 18, v193
v_mfma_f32_16x16x32_f16 v[164:167], v[228:231], v[236:239], v[240:243]
v_exp_f16_sdwa v195, v196 dst_sel:WORD_1 dst_unused:UNUSED_PRESERVE src0_sel:WORD_1
v_pk_add_f16 v201, v201, 1.0 op_sel_hi:[1,0]
v_pk_add_f16 v198, v198, 1.0 op_sel_hi:[1,0]
s_waitcnt lgkmcnt(7)
v_mfma_f32_16x16x32_bf16 v[172:175], v[244:247], v[32:35], v[172:175]
ds_read_b128 v[228:231], v249 offset:30976
ds_read_b128 v[240:243], v248 offset:40960
ds_read_u16_d16_hi v193, v193
v_pk_add_f16 v195, v195, 1.0 op_sel_hi:[1,0]
v_mfma_f32_16x16x32_bf16 v[180:183], v[244:247], v[36:39], v[180:183]
v_rcp_f16_e64 v202, v201
s_setprio 0
s_waitcnt lgkmcnt(7)
v_mfma_f32_16x16x32_bf16 v[168:171], v[216:219], v[40:43], v[168:171]
ds_read_b128 v[244:247], v249 offset:31744
v_rcp_f16_e64 v199, v198
v_mfma_f32_16x16x32_bf16 v[176:179], v[216:219], v[44:47], v[176:179]
v_rcp_f16 v196, v195
s_waitcnt lgkmcnt(6)
v_mfma_f32_16x16x32_bf16 v[172:175], v[220:223], v[40:43], v[172:175]
ds_read_b128 v[216:219], v248 offset:41216
v_rcp_f16_sdwa v202, v201 dst_sel:WORD_1 dst_unused:UNUSED_PRESERVE src0_sel:WORD_1
v_mfma_f32_16x16x32_bf16 v[180:183], v[220:223], v[44:47], v[180:183]
v_rcp_f16_sdwa v199, v198 dst_sel:WORD_1 dst_unused:UNUSED_PRESERVE src0_sel:WORD_1
v_or_b32 v232, v184, v185
v_or_b32 v233, v186, v187
v_or_b32_e64 v234, v188, v189
v_rcp_f16_sdwa v196, v195 dst_sel:WORD_1 dst_unused:UNUSED_PRESERVE src0_sel:WORD_1
v_or_b32 v235, v190, v191
s_waitcnt lgkmcnt(2)
v_or_b32 v236, v192, v193
v_pk_mul_f16 v237, v203, v202
v_pk_mul_f16 v238, v200, v199
v_pk_mul_f16 v239, v197, v196
s_setprio 3
v_mfma_f32_16x16x32_f16 v[120:123], v[224:227], v[232:235], v[120:123]
s_add_u32 s46, s80, 16777216
buffer_load_dwordx4 v[108:111], v253, s[32:35], s46 offen offset:256 nt
ds_read_b128 v[220:223], v249 offset:32000
v_cvt_pkrtz_f16_f32 v185, v168, v169
v_cvt_pkrtz_f16_f32 v187, v170, v171
v_mfma_f32_16x16x32_f16 v[128:131], v[224:227], v[236:239], v[128:131]
v_cvt_pkrtz_f16_f32 v189, v172, v173
v_cvt_pkrtz_f16_f32 v191, v174, v175
v_mfma_f32_16x16x32_f16 v[124:127], v[228:231], v[232:235], v[124:127]
ds_read_b128 v[224:227], v248 offset:41984
v_cvt_pkrtz_f16_f32 v193, v176, v177
v_cvt_pk_f16_f32 v203, v178, v179
v_mfma_f32_16x16x32_f16 v[132:135], v[228:231], v[236:239], v[132:135]
v_cvt_pk_f16_f32 v200, v180, v181
v_cvt_pk_f16_f32 v197, v182, v183
v_mfma_f32_16x16x32_bf16 v[168:171], v[240:243], v[24:27], 0
ds_read_b128 v[228:231], v249 offset:32768
v_pk_fma_f16 v202, v203, v203, s48
v_and_b32_e64 v185, s49, v185
v_mfma_f32_16x16x32_bf16 v[176:179], v[240:243], v[28:31], 0
v_pk_fma_f16 v199, v200, v200, s48
v_and_b32 v187, s49, v187
s_waitcnt lgkmcnt(3)
v_mfma_f32_16x16x32_f16 v[136:139], v[244:247], v[232:235], v[136:139]
ds_read_b128 v[240:243], v249 offset:33024
v_pk_fma_f16 v196, v197, v197, s48
v_bfe_u32 v184, v185, 2, 14
v_pk_mul_f16 v202, v203, v202
v_mfma_f32_16x16x32_f16 v[144:147], v[244:247], v[236:239], v[144:147]
v_bfe_u32 v186, v187, 2, 14
v_pk_mul_f16 v199, v200, v199
s_waitcnt vmcnt(7)
v_mfma_f32_16x16x32_bf16 v[88:91], v[18:21], v[204:207], v[88:91]
ds_read_b128 v[244:247], v248 offset:42240
ds_read_u16_d16 v184, v184
ds_read_u16_d16 v186, v186
v_lshrrev_b32 v185, 18, v185
v_pk_mul_f16 v196, v197, v196
v_mfma_f32_16x16x32_bf16 v[92:95], v[16:19], v[204:207], v[92:95]
v_lshrrev_b32_e64 v187, 18, v187
v_mfma_f32_16x16x32_bf16 v[172:175], v[216:219], v[24:27], 0
ds_read_u16_d16_hi v185, v185
ds_read_u16_d16_hi v187, v187
v_exp_f16 v201, v202
v_and_b32 v189, s49, v189
v_mfma_f32_16x16x32_bf16 v[180:183], v[216:219], v[28:31], 0
v_and_b32 v191, s49, v191
s_waitcnt lgkmcnt(6)
v_mfma_f32_16x16x32_f16 v[140:143], v[220:223], v[232:235], v[140:143]
ds_read_b128 v[216:219], v248 offset:43008
v_exp_f16_e64 v198, v199
v_bfe_u32 v188, v189, 2, 14
v_mfma_f32_16x16x32_f16 v[148:151], v[220:223], v[236:239], v[148:151]
v_bfe_u32 v190, v191, 2, 14
v_exp_f16_e64 v195, v196
v_mfma_f32_16x16x32_bf16 v[168:171], v[224:227], v[32:35], v[168:171]
ds_read_b128 v[220:223], v248 offset:43264
ds_read_u16_d16 v188, v188
ds_read_u16_d16 v190, v190
v_lshrrev_b32 v189, 18, v189
v_lshrrev_b32 v191, 18, v191
v_mfma_f32_16x16x32_bf16 v[176:179], v[224:227], v[36:39], v[176:179]
v_exp_f16_sdwa v201, v202 dst_sel:WORD_1 dst_unused:UNUSED_PRESERVE src0_sel:WORD_1
v_mfma_f32_16x16x32_f16 v[152:155], v[228:231], v[232:235], v[152:155]
ds_read_b128 v[224:227], v249 offset:36864
ds_read_u16_d16_hi v189, v189
ds_read_u16_d16_hi v191, v191
v_and_b32 v193, s49, v193
v_bfe_u32 v192, v193, 2, 14
v_mfma_f32_16x16x32_f16 v[160:163], v[228:231], v[236:239], v[160:163]
v_exp_f16_sdwa v198, v199 dst_sel:WORD_1 dst_unused:UNUSED_PRESERVE src0_sel:WORD_1
s_waitcnt lgkmcnt(7)
v_mfma_f32_16x16x32_f16 v[156:159], v[240:243], v[232:235], v[156:159]
ds_read_b128 v[228:231], v249 offset:37120
ds_read_u16_d16 v192, v192
v_lshrrev_b32_e64 v193, 18, v193
v_mfma_f32_16x16x32_f16 v[164:167], v[240:243], v[236:239], v[164:167]
v_exp_f16_sdwa v195, v196 dst_sel:WORD_1 dst_unused:UNUSED_PRESERVE src0_sel:WORD_1
v_pk_add_f16 v201, v201, 1.0 op_sel_hi:[1,0]
v_pk_add_f16 v198, v198, 1.0 op_sel_hi:[1,0]
v_mfma_f32_16x16x32_bf16 v[172:175], v[244:247], v[32:35], v[172:175]
ds_read_b128 v[240:243], v248 offset:34816
ds_read_u16_d16_hi v193, v193
v_pk_add_f16 v195, v195, 1.0 op_sel_hi:[1,0]
v_mfma_f32_16x16x32_bf16 v[180:183], v[244:247], v[36:39], v[180:183]
v_rcp_f16 v202, v201
s_waitcnt lgkmcnt(7)
v_mfma_f32_16x16x32_bf16 v[168:171], v[216:219], v[40:43], v[168:171]
ds_read_b128 v[244:247], v249 offset:37888
v_rcp_f16_e64 v199, v198
v_mfma_f32_16x16x32_bf16 v[176:179], v[216:219], v[44:47], v[176:179]
v_rcp_f16_e64 v196, v195
v_mfma_f32_16x16x32_bf16 v[172:175], v[220:223], v[40:43], v[172:175]
ds_read_b128 v[216:219], v248 offset:35072
v_rcp_f16_sdwa v202, v201 dst_sel:WORD_1 dst_unused:UNUSED_PRESERVE src0_sel:WORD_1
v_mfma_f32_16x16x32_bf16 v[180:183], v[220:223], v[44:47], v[180:183]
v_rcp_f16_sdwa v199, v198 dst_sel:WORD_1 dst_unused:UNUSED_PRESERVE src0_sel:WORD_1
v_or_b32 v232, v184, v185
v_or_b32 v233, v186, v187
s_waitcnt lgkmcnt(4)
v_or_b32 v234, v188, v189
v_rcp_f16_sdwa v196, v195 dst_sel:WORD_1 dst_unused:UNUSED_PRESERVE src0_sel:WORD_1
v_or_b32 v235, v190, v191
s_waitcnt lgkmcnt(2)
v_or_b32_e64 v236, v192, v193
v_pk_mul_f16 v237, v203, v202
v_pk_mul_f16 v238, v200, v199
v_pk_mul_f16 v239, v197, v196
v_mfma_f32_16x16x32_f16 v[120:123], v[224:227], v[232:235], v[120:123]
s_add_u32 s46, s80, 20971520
buffer_load_dwordx4 v[112:115], v253, s[32:35], s46 offen nt
ds_read_b128 v[220:223], v249 offset:38144
v_cvt_pkrtz_f16_f32 v185, v168, v169
v_cvt_pkrtz_f16_f32 v187, v170, v171
v_cvt_pkrtz_f16_f32 v189, v172, v173
v_mfma_f32_16x16x32_f16 v[128:131], v[224:227], v[236:239], v[128:131]
v_cvt_pkrtz_f16_f32 v191, v174, v175
v_cvt_pkrtz_f16_f32 v193, v176, v177
v_cvt_pk_f16_f32 v203, v178, v179
v_mfma_f32_16x16x32_f16 v[124:127], v[228:231], v[232:235], v[124:127]
ds_read_b128 v[224:227], v248 offset:35840
v_cvt_pk_f16_f32 v200, v180, v181
v_cvt_pk_f16_f32 v197, v182, v183
v_pk_fma_f16 v202, v203, v203, s48
v_cvt_pk_bf16_f32 v64, v64, v65
v_mfma_f32_16x16x32_f16 v[132:135], v[228:231], v[236:239], v[132:135]
v_and_b32_e64 v185, s49, v185
v_cvt_pk_bf16_f32 v65, v66, v67
v_pk_fma_f16 v199, v200, v200, s48
v_mfma_f32_16x16x32_bf16 v[168:171], v[240:243], v[24:27], 0
ds_read_b128 v[228:231], v249 offset:38912
v_and_b32_e64 v187, s49, v187
v_cvt_pk_bf16_f32 v66, v68, v69
v_pk_fma_f16 v196, v197, v197, s48
v_mfma_f32_16x16x32_bf16 v[176:179], v[240:243], v[28:31], 0
v_cvt_pk_bf16_f32 v67, v70, v71
v_bfe_u32 v184, v185, 2, 14
s_setprio 2
v_pk_mul_f16 v202, v203, v202
v_cvt_pk_bf16_f32 v48, v48, v49
s_waitcnt lgkmcnt(2)
v_mfma_f32_16x16x32_f16 v[136:139], v[244:247], v[232:235], v[136:139]
ds_read_b128 v[240:243], v249 offset:39168
ds_read_u16_d16 v184, v184
v_bfe_u32 v186, v187, 2, 14
v_cvt_pk_bf16_f32 v49, v50, v51
v_pk_mul_f16 v199, v200, v199
v_mfma_f32_16x16x32_f16 v[144:147], v[244:247], v[236:239], v[144:147]
v_lshrrev_b32_e64 v185, 18, v185
v_cvt_pk_bf16_f32 v50, v52, v53
v_pk_mul_f16 v196, v197, v196
v_mfma_f32_16x16x32_bf16 v[172:175], v[216:219], v[24:27], 0
ds_read_b128 v[244:247], v248 offset:36096
ds_read_u16_d16 v186, v186
ds_read_u16_d16_hi v185, v185
v_lshrrev_b32_e64 v187, 18, v187
v_cvt_pk_bf16_f32 v51, v54, v55
v_exp_f16_e64 v201, v202
v_mfma_f32_16x16x32_bf16 v[180:183], v[216:219], v[28:31], 0
v_cvt_pk_bf16_f32 v80, v80, v81
v_and_b32_e64 v189, s49, v189
v_cvt_pk_bf16_f32 v81, v82, v83
v_mfma_f32_16x16x32_f16 v[140:143], v[220:223], v[232:235], v[140:143]
ds_read_b128 v[216:219], v248 offset:36864
ds_read_u16_d16_hi v187, v187
v_and_b32_e64 v191, s49, v191
v_cvt_pk_bf16_f32 v82, v84, v85
v_mfma_f32_16x16x32_f16 v[148:151], v[220:223], v[236:239], v[148:151]
v_exp_f16_e64 v198, v199
v_cvt_pk_bf16_f32 v83, v86, v87
s_mov_b64 vcc, s[74:75]
v_bfe_u32 v188, v189, 2, 14
v_bfe_u32 v190, v191, 2, 14
s_waitcnt lgkmcnt(5)
v_mfma_f32_16x16x32_bf16 v[168:171], v[224:227], v[32:35], v[168:171]
ds_read_b128 v[220:223], v248 offset:37120
ds_read_u16_d16 v188, v188
ds_read_u16_d16 v190, v190
v_cndmask_b32 v68, v48, v80, vcc
v_exp_f16 v195, v196
v_mfma_f32_16x16x32_bf16 v[176:179], v[224:227], v[36:39], v[176:179]
v_cndmask_b32 v69, v49, v81, vcc
v_lshrrev_b32_e64 v189, 18, v189
v_cndmask_b32 v70, v50, v82, vcc
v_mfma_f32_16x16x32_f16 v[152:155], v[228:231], v[232:235], v[152:155]
ds_read_b128 v[224:227], v249 offset:49152
ds_read_u16_d16_hi v189, v189
v_lshrrev_b32 v191, 18, v191
v_cndmask_b32 v71, v51, v83, vcc
v_exp_f16_sdwa v201, v202 dst_sel:WORD_1 dst_unused:UNUSED_PRESERVE src0_sel:WORD_1
v_mfma_f32_16x16x32_f16 v[160:163], v[228:231], v[236:239], v[160:163]
v_cndmask_b32_dpp v48, v64, v48, vcc quad_perm:[1,0,3,2] row_mask:0xf bank_mask:0xf
v_and_b32_e64 v193, s49, v193
v_cndmask_b32_dpp v49, v65, v49, vcc quad_perm:[1,0,3,2] row_mask:0xf bank_mask:0xf
v_mfma_f32_16x16x32_f16 v[156:159], v[240:243], v[232:235], v[156:159]
ds_read_b128 v[228:231], v249 offset:49408
ds_read_u16_d16_hi v191, v191
v_bfe_u32 v192, v193, 2, 14
v_exp_f16_sdwa v198, v199 dst_sel:WORD_1 dst_unused:UNUSED_PRESERVE src0_sel:WORD_1
v_mfma_f32_16x16x32_f16 v[164:167], v[240:243], v[236:239], v[164:167]
v_cndmask_b32_dpp v50, v66, v50, vcc quad_perm:[1,0,3,2] row_mask:0xf bank_mask:0xf
v_lshrrev_b32_e64 v193, 18, v193
v_cndmask_b32_dpp v51, v67, v51, vcc quad_perm:[1,0,3,2] row_mask:0xf bank_mask:0xf
s_not_b64 vcc, s[74:75]
s_waitcnt lgkmcnt(4)
v_mfma_f32_16x16x32_bf16 v[172:175], v[244:247], v[32:35], v[172:175]
ds_read_b128 v[240:243], v248 offset:47104
ds_read_u16_d16 v192, v192
ds_read_u16_d16_hi v193, v193
v_exp_f16_sdwa v195, v196 dst_sel:WORD_1 dst_unused:UNUSED_PRESERVE src0_sel:WORD_1
v_cndmask_b32_dpp v80, v64, v80, vcc quad_perm:[1,0,3,2] row_mask:0xf bank_mask:0xf
v_pk_add_f16 v201, v201, 1.0 op_sel_hi:[1,0]
v_mfma_f32_16x16x32_bf16 v[180:183], v[244:247], v[36:39], v[180:183]
v_cndmask_b32_dpp v81, v65, v81, vcc quad_perm:[1,0,3,2] row_mask:0xf bank_mask:0xf
v_pk_add_f16 v198, v198, 1.0 op_sel_hi:[1,0]
v_cndmask_b32_dpp v82, v66, v82, vcc quad_perm:[1,0,3,2] row_mask:0xf bank_mask:0xf
v_mfma_f32_16x16x32_bf16 v[168:171], v[216:219], v[40:43], v[168:171]
ds_read_b128 v[244:247], v249 offset:50176
v_pk_add_f16 v195, v195, 1.0 op_sel_hi:[1,0]
v_rcp_f16_e64 v202, v201
v_cndmask_b32_dpp v83, v67, v83, vcc quad_perm:[1,0,3,2] row_mask:0xf bank_mask:0xf
v_mfma_f32_16x16x32_bf16 v[176:179], v[216:219], v[44:47], v[176:179]
v_rcp_f16_e64 v199, v198
v_mfma_f32_16x16x32_bf16 v[172:175], v[220:223], v[40:43], v[172:175]
ds_read_b128 v[216:219], v248 offset:47360
buffer_store_dwordx4 v[48:51], v255, s[8:11], s70 offen sc1
v_rcp_f16_e64 v196, v195
v_rcp_f16_sdwa v202, v201 dst_sel:WORD_1 dst_unused:UNUSED_PRESERVE src0_sel:WORD_1
v_mfma_f32_16x16x32_bf16 v[180:183], v[220:223], v[44:47], v[180:183]
v_rcp_f16_sdwa v199, v198 dst_sel:WORD_1 dst_unused:UNUSED_PRESERVE src0_sel:WORD_1
v_or_b32 v232, v184, v185
v_or_b32 v233, v186, v187
s_waitcnt lgkmcnt(3)
v_or_b32 v234, v188, v189
v_rcp_f16_sdwa v196, v195 dst_sel:WORD_1 dst_unused:UNUSED_PRESERVE src0_sel:WORD_1
v_or_b32 v235, v190, v191
s_waitcnt lgkmcnt(2)
v_or_b32_e64 v236, v192, v193
v_pk_mul_f16 v237, v203, v202
v_pk_mul_f16 v238, v200, v199
v_pk_mul_f16 v239, v197, v196
v_mfma_f32_16x16x32_f16 v[120:123], v[224:227], v[232:235], v[120:123]
buffer_store_dwordx4 v[68:71], v255, s[8:11], s70 offen offset:128 sc1
ds_read_b128 v[220:223], v249 offset:50432
v_cvt_pkrtz_f16_f32 v185, v168, v169
v_cvt_pkrtz_f16_f32 v187, v170, v171
v_mfma_f32_16x16x32_f16 v[128:131], v[224:227], v[236:239], v[128:131]
v_cvt_pkrtz_f16_f32 v189, v172, v173
v_cvt_pkrtz_f16_f32 v191, v174, v175
v_mfma_f32_16x16x32_f16 v[124:127], v[228:231], v[232:235], v[124:127]
ds_read_b128 v[224:227], v248 offset:48128
v_cvt_pkrtz_f16_f32 v193, v176, v177
v_cvt_pk_f16_f32 v203, v178, v179
v_cvt_pk_f16_f32 v200, v180, v181
v_mfma_f32_16x16x32_f16 v[132:135], v[228:231], v[236:239], v[132:135]
v_cvt_pk_f16_f32 v197, v182, v183
s_setprio 1
v_pk_fma_f16 v202, v203, v203, s48
v_mfma_f32_16x16x32_bf16 v[168:171], v[240:243], v[24:27], 0
ds_read_b128 v[228:231], v249 offset:51200
v_and_b32 v185, s49, v185
v_pk_fma_f16 v199, v200, v200, s48
v_mfma_f32_16x16x32_bf16 v[176:179], v[240:243], v[28:31], 0
v_and_b32 v187, s49, v187
v_pk_fma_f16 v196, v197, v197, s48
v_bfe_u32 v184, v185, 2, 14
s_waitcnt lgkmcnt(3)
v_mfma_f32_16x16x32_f16 v[136:139], v[244:247], v[232:235], v[136:139]
ds_read_b128 v[240:243], v249 offset:51456
ds_read_u16_d16 v184, v184
v_pk_mul_f16 v202, v203, v202
v_bfe_u32 v186, v187, 2, 14
v_mfma_f32_16x16x32_f16 v[144:147], v[244:247], v[236:239], v[144:147]
v_pk_mul_f16 v199, v200, v199
v_lshrrev_b32_e64 v185, 18, v185
v_mfma_f32_16x16x32_bf16 v[172:175], v[216:219], v[24:27], 0
ds_read_b128 v[244:247], v248 offset:48384
ds_read_u16_d16 v186, v186
ds_read_u16_d16_hi v185, v185
v_pk_mul_f16 v196, v197, v196
v_lshrrev_b32_e64 v187, 18, v187
v_mfma_f32_16x16x32_bf16 v[180:183], v[216:219], v[28:31], 0
v_exp_f16_e64 v201, v202
v_and_b32 v189, s49, v189
s_waitcnt lgkmcnt(5)
v_mfma_f32_16x16x32_f16 v[140:143], v[220:223], v[232:235], v[140:143]
ds_read_b128 v[216:219], v248 offset:49152
ds_read_u16_d16_hi v187, v187
v_and_b32_e64 v191, s49, v191
v_mfma_f32_16x16x32_f16 v[148:151], v[220:223], v[236:239], v[148:151]
v_exp_f16_e64 v198, v199
v_bfe_u32 v188, v189, 2, 14
v_bfe_u32 v190, v191, 2, 14
v_mfma_f32_16x16x32_bf16 v[168:171], v[224:227], v[32:35], v[168:171]
s_add_u32 s46, s80, 20971520
buffer_load_dwordx4 v[116:119], v253, s[32:35], s46 offen offset:256 nt
ds_read_b128 v[220:223], v248 offset:49408
ds_read_u16_d16 v188, v188
ds_read_u16_d16 v190, v190
v_exp_f16_e64 v195, v196
v_mfma_f32_16x16x32_bf16 v[176:179], v[224:227], v[36:39], v[176:179]
v_lshrrev_b32 v189, 18, v189
v_lshrrev_b32 v191, 18, v191
v_mfma_f32_16x16x32_f16 v[152:155], v[228:231], v[232:235], v[152:155]
ds_read_b128 v[224:227], v249 offset:43008
ds_read_u16_d16_hi v189, v189
ds_read_u16_d16_hi v191, v191
v_exp_f16_sdwa v201, v202 dst_sel:WORD_1 dst_unused:UNUSED_PRESERVE src0_sel:WORD_1
v_and_b32 v193, s49, v193
v_mfma_f32_16x16x32_f16 v[160:163], v[228:231], v[236:239], v[160:163]
v_bfe_u32 v192, v193, 2, 14
s_waitcnt lgkmcnt(7)
v_mfma_f32_16x16x32_f16 v[156:159], v[240:243], v[232:235], v[156:159]
ds_read_b128 v[228:231], v249 offset:43264
ds_read_u16_d16 v192, v192
v_exp_f16_sdwa v198, v199 dst_sel:WORD_1 dst_unused:UNUSED_PRESERVE src0_sel:WORD_1
v_lshrrev_b32_e64 v193, 18, v193
v_mfma_f32_16x16x32_f16 v[164:167], v[240:243], v[236:239], v[164:167]
v_exp_f16_sdwa v195, v196 dst_sel:WORD_1 dst_unused:UNUSED_PRESERVE src0_sel:WORD_1
v_pk_add_f16 v201, v201, 1.0 op_sel_hi:[1,0]
v_mfma_f32_16x16x32_bf16 v[172:175], v[244:247], v[32:35], v[172:175]
ds_read_b128 v[240:243], v248 offset:53248
ds_read_u16_d16_hi v193, v193
v_pk_add_f16 v198, v198, 1.0 op_sel_hi:[1,0]
v_pk_add_f16 v195, v195, 1.0 op_sel_hi:[1,0]
v_mfma_f32_16x16x32_bf16 v[180:183], v[244:247], v[36:39], v[180:183]
v_rcp_f16 v202, v201
s_setprio 0
v_mfma_f32_16x16x32_bf16 v[168:171], v[216:219], v[40:43], v[168:171]
ds_read_b128 v[244:247], v249 offset:44032
v_rcp_f16_e64 v199, v198
v_mfma_f32_16x16x32_bf16 v[176:179], v[216:219], v[44:47], v[176:179]
v_rcp_f16 v196, v195
s_waitcnt lgkmcnt(5)
v_mfma_f32_16x16x32_bf16 v[172:175], v[220:223], v[40:43], v[172:175]
ds_read_b128 v[216:219], v248 offset:53504
v_rcp_f16_sdwa v202, v201 dst_sel:WORD_1 dst_unused:UNUSED_PRESERVE src0_sel:WORD_1
v_mfma_f32_16x16x32_bf16 v[180:183], v[220:223], v[44:47], v[180:183]
v_rcp_f16_sdwa v199, v198 dst_sel:WORD_1 dst_unused:UNUSED_PRESERVE src0_sel:WORD_1
v_or_b32 v232, v184, v185
v_or_b32 v233, v186, v187
v_or_b32_e64 v234, v188, v189
v_rcp_f16_sdwa v196, v195 dst_sel:WORD_1 dst_unused:UNUSED_PRESERVE src0_sel:WORD_1
v_or_b32 v235, v190, v191
s_waitcnt lgkmcnt(2)
v_or_b32 v236, v192, v193
v_pk_mul_f16 v237, v203, v202
v_pk_mul_f16 v238, v200, v199
v_pk_mul_f16 v239, v197, v196
s_setprio 3
v_mfma_f32_16x16x32_f16 v[120:123], v[224:227], v[232:235], v[120:123]
ds_read_b128 v[220:223], v249 offset:44288
v_cvt_pkrtz_f16_f32 v185, v168, v169
v_cvt_pkrtz_f16_f32 v187, v170, v171
v_mfma_f32_16x16x32_f16 v[128:131], v[224:227], v[236:239], v[128:131]
v_cvt_pkrtz_f16_f32 v189, v172, v173
v_cvt_pkrtz_f16_f32 v191, v174, v175
v_mfma_f32_16x16x32_f16 v[124:127], v[228:231], v[232:235], v[124:127]
ds_read_b128 v[224:227], v248 offset:54272
v_cvt_pkrtz_f16_f32 v193, v176, v177
v_cvt_pk_f16_f32 v203, v178, v179
v_cvt_pk_f16_f32 v200, v180, v181
v_mfma_f32_16x16x32_f16 v[132:135], v[228:231], v[236:239], v[132:135]
v_cvt_pk_f16_f32 v197, v182, v183
v_pk_fma_f16 v202, v203, v203, s48
v_mfma_f32_16x16x32_bf16 v[168:171], v[240:243], v[24:27], 0
ds_read_b128 v[228:231], v249 offset:45056
v_and_b32_e64 v185, s49, v185
v_pk_fma_f16 v199, v200, v200, s48
v_mfma_f32_16x16x32_bf16 v[176:179], v[240:243], v[28:31], 0
v_and_b32 v187, s49, v187
v_pk_fma_f16 v196, v197, v197, s48
v_bfe_u32 v184, v185, 2, 14
s_waitcnt lgkmcnt(3)
v_mfma_f32_16x16x32_f16 v[136:139], v[244:247], v[232:235], v[136:139]
ds_read_b128 v[240:243], v249 offset:45312
ds_read_u16_d16 v184, v184
v_pk_mul_f16 v202, v203, v202
v_bfe_u32 v186, v187, 2, 14
v_mfma_f32_16x16x32_f16 v[144:147], v[244:247], v[236:239], v[144:147]
v_pk_mul_f16 v199, v200, v199
v_lshrrev_b32_e64 v185, 18, v185
v_mfma_f32_16x16x32_bf16 v[172:175], v[216:219], v[24:27], 0
ds_read_b128 v[244:247], v248 offset:54528
ds_read_u16_d16 v186, v186
ds_read_u16_d16_hi v185, v185
v_pk_mul_f16 v196, v197, v196
v_lshrrev_b32_e64 v187, 18, v187
v_mfma_f32_16x16x32_bf16 v[180:183], v[216:219], v[28:31], 0
v_exp_f16_e64 v201, v202
v_and_b32 v189, s49, v189
s_waitcnt lgkmcnt(5)
v_mfma_f32_16x16x32_f16 v[140:143], v[220:223], v[232:235], v[140:143]
ds_read_b128 v[216:219], v248 offset:55296
ds_read_u16_d16_hi v187, v187
v_and_b32_e64 v191, s49, v191
v_mfma_f32_16x16x32_f16 v[148:151], v[220:223], v[236:239], v[148:151]
v_exp_f16_e64 v198, v199
v_bfe_u32 v188, v189, 2, 14
v_bfe_u32 v190, v191, 2, 14
v_mfma_f32_16x16x32_bf16 v[168:171], v[224:227], v[32:35], v[168:171]
ds_read_b128 v[220:223], v248 offset:55552
ds_read_u16_d16 v188, v188
ds_read_u16_d16 v190, v190
v_exp_f16_e64 v195, v196
v_mfma_f32_16x16x32_bf16 v[176:179], v[224:227], v[36:39], v[176:179]
v_lshrrev_b32 v189, 18, v189
v_lshrrev_b32 v191, 18, v191
v_mfma_f32_16x16x32_f16 v[152:155], v[228:231], v[232:235], v[152:155]
ds_read_b128 v[224:227], v249 offset:55296
ds_read_u16_d16_hi v189, v189
ds_read_u16_d16_hi v191, v191
v_exp_f16_sdwa v201, v202 dst_sel:WORD_1 dst_unused:UNUSED_PRESERVE src0_sel:WORD_1
v_and_b32 v193, s49, v193
v_mfma_f32_16x16x32_f16 v[160:163], v[228:231], v[236:239], v[160:163]
v_bfe_u32 v192, v193, 2, 14
s_waitcnt lgkmcnt(8)
v_mfma_f32_16x16x32_f16 v[156:159], v[240:243], v[232:235], v[156:159]
ds_read_b128 v[228:231], v249 offset:55552
ds_read_u16_d16 v192, v192
v_exp_f16_sdwa v198, v199 dst_sel:WORD_1 dst_unused:UNUSED_PRESERVE src0_sel:WORD_1
v_lshrrev_b32_e64 v193, 18, v193
v_mfma_f32_16x16x32_f16 v[164:167], v[240:243], v[236:239], v[164:167]
v_exp_f16_sdwa v195, v196 dst_sel:WORD_1 dst_unused:UNUSED_PRESERVE src0_sel:WORD_1
v_pk_add_f16 v201, v201, 1.0 op_sel_hi:[1,0]
v_mfma_f32_16x16x32_bf16 v[172:175], v[244:247], v[32:35], v[172:175]
ds_read_b128 v[240:243], v248 offset:59392
ds_read_u16_d16_hi v193, v193
v_pk_add_f16 v198, v198, 1.0 op_sel_hi:[1,0]
v_pk_add_f16 v195, v195, 1.0 op_sel_hi:[1,0]
v_mfma_f32_16x16x32_bf16 v[180:183], v[244:247], v[36:39], v[180:183]
v_rcp_f16 v202, v201
s_waitcnt lgkmcnt(7)
v_mfma_f32_16x16x32_bf16 v[168:171], v[216:219], v[40:43], v[168:171]
ds_read_b128 v[244:247], v249 offset:56320
v_rcp_f16_e64 v199, v198
v_mfma_f32_16x16x32_bf16 v[176:179], v[216:219], v[44:47], v[176:179]
v_rcp_f16_e64 v196, v195
v_mfma_f32_16x16x32_bf16 v[172:175], v[220:223], v[40:43], v[172:175]
ds_read_b128 v[216:219], v248 offset:59648
v_rcp_f16_sdwa v202, v201 dst_sel:WORD_1 dst_unused:UNUSED_PRESERVE src0_sel:WORD_1
v_mfma_f32_16x16x32_bf16 v[180:183], v[220:223], v[44:47], v[180:183]
v_rcp_f16_sdwa v199, v198 dst_sel:WORD_1 dst_unused:UNUSED_PRESERVE src0_sel:WORD_1
v_or_b32 v232, v184, v185
v_or_b32 v233, v186, v187
s_waitcnt lgkmcnt(4)
v_or_b32 v234, v188, v189
v_rcp_f16_sdwa v196, v195 dst_sel:WORD_1 dst_unused:UNUSED_PRESERVE src0_sel:WORD_1
v_or_b32 v235, v190, v191
s_waitcnt lgkmcnt(2)
v_or_b32_e64 v236, v192, v193
v_pk_mul_f16 v237, v203, v202
v_pk_mul_f16 v238, v200, v199
v_pk_mul_f16 v239, v197, v196
v_mfma_f32_16x16x32_f16 v[120:123], v[224:227], v[232:235], v[120:123]
buffer_load_dwordx4 v[204:207], v252, s[4:7], s68 offen
ds_read_b128 v[220:223], v249 offset:56576
v_cvt_pkrtz_f16_f32 v185, v168, v169
v_cvt_pkrtz_f16_f32 v187, v170, v171
v_mfma_f32_16x16x32_f16 v[128:131], v[224:227], v[236:239], v[128:131]
v_cvt_pkrtz_f16_f32 v189, v172, v173
v_cvt_pkrtz_f16_f32 v191, v174, v175
v_mfma_f32_16x16x32_f16 v[124:127], v[228:231], v[232:235], v[124:127]
ds_read_b128 v[224:227], v248 offset:60416
v_cvt_pkrtz_f16_f32 v193, v176, v177
v_cvt_pk_f16_f32 v203, v178, v179
v_cvt_pk_f16_f32 v200, v180, v181
v_mfma_f32_16x16x32_f16 v[132:135], v[228:231], v[236:239], v[132:135]
v_cvt_pk_f16_f32 v197, v182, v183
v_pk_fma_f16 v202, v203, v203, s48
v_mfma_f32_16x16x32_bf16 v[168:171], v[240:243], v[24:27], 0
ds_read_b128 v[228:231], v249 offset:57344
v_and_b32_e64 v185, s49, v185
v_pk_fma_f16 v199, v200, v200, s48
v_mfma_f32_16x16x32_bf16 v[176:179], v[240:243], v[28:31], 0
v_and_b32_e64 v187, s49, v187
v_pk_fma_f16 v196, v197, v197, s48
s_setprio 2
v_bfe_u32 v184, v185, 2, 14
s_waitcnt lgkmcnt(3)
v_mfma_f32_16x16x32_f16 v[136:139], v[244:247], v[232:235], v[136:139]
ds_read_b128 v[240:243], v249 offset:57600
ds_read_u16_d16 v184, v184
v_pk_mul_f16 v202, v203, v202
v_bfe_u32 v186, v187, 2, 14
v_mfma_f32_16x16x32_f16 v[144:147], v[244:247], v[236:239], v[144:147]
v_pk_mul_f16 v199, v200, v199
v_lshrrev_b32_e64 v185, 18, v185
v_mfma_f32_16x16x32_bf16 v[172:175], v[216:219], v[24:27], 0
ds_read_b128 v[244:247], v248 offset:60672
ds_read_u16_d16 v186, v186
ds_read_u16_d16_hi v185, v185
v_pk_mul_f16 v196, v197, v196
v_lshrrev_b32_e64 v187, 18, v187
v_mfma_f32_16x16x32_bf16 v[180:183], v[216:219], v[28:31], 0
v_exp_f16_e64 v201, v202
v_and_b32 v189, s49, v189
s_waitcnt lgkmcnt(5)
v_mfma_f32_16x16x32_f16 v[140:143], v[220:223], v[232:235], v[140:143]
ds_read_b128 v[216:219], v248 offset:61440
ds_read_u16_d16_hi v187, v187
v_and_b32_e64 v191, s49, v191
v_mfma_f32_16x16x32_f16 v[148:151], v[220:223], v[236:239], v[148:151]
v_exp_f16_e64 v198, v199
v_bfe_u32 v188, v189, 2, 14
v_bfe_u32 v190, v191, 2, 14
v_mfma_f32_16x16x32_bf16 v[168:171], v[224:227], v[32:35], v[168:171]
buffer_store_dwordx4 v[80:83], v255, s[8:11], s70 offen offset:256 sc1
ds_read_b128 v[220:223], v248 offset:61696
ds_read_u16_d16 v188, v188
ds_read_u16_d16 v190, v190
v_exp_f16_e64 v195, v196
v_mfma_f32_16x16x32_bf16 v[176:179], v[224:227], v[36:39], v[176:179]
v_lshrrev_b32 v189, 18, v189
v_lshrrev_b32 v191, 18, v191
v_mfma_f32_16x16x32_f16 v[152:155], v[228:231], v[232:235], v[152:155]
ds_read_b128 v[224:227], v249 offset:61440
ds_read_u16_d16_hi v189, v189
ds_read_u16_d16_hi v191, v191
v_exp_f16_sdwa v201, v202 dst_sel:WORD_1 dst_unused:UNUSED_PRESERVE src0_sel:WORD_1
v_and_b32 v193, s49, v193
v_mfma_f32_16x16x32_f16 v[160:163], v[228:231], v[236:239], v[160:163]
v_bfe_u32 v192, v193, 2, 14
s_waitcnt lgkmcnt(8)
v_mfma_f32_16x16x32_f16 v[156:159], v[240:243], v[232:235], v[156:159]
ds_read_b128 v[228:231], v249 offset:61696
ds_read_u16_d16 v192, v192
v_exp_f16_sdwa v198, v199 dst_sel:WORD_1 dst_unused:UNUSED_PRESERVE src0_sel:WORD_1
v_lshrrev_b32_e64 v193, 18, v193
v_mfma_f32_16x16x32_f16 v[164:167], v[240:243], v[236:239], v[164:167]
v_exp_f16_sdwa v195, v196 dst_sel:WORD_1 dst_unused:UNUSED_PRESERVE src0_sel:WORD_1
v_pk_add_f16 v201, v201, 1.0 op_sel_hi:[1,0]
v_mfma_f32_16x16x32_bf16 v[172:175], v[244:247], v[32:35], v[172:175]
ds_read_b128 v[240:243], v249
ds_read_u16_d16_hi v193, v193
v_pk_add_f16 v198, v198, 1.0 op_sel_hi:[1,0]
v_pk_add_f16 v195, v195, 1.0 op_sel_hi:[1,0]
v_mfma_f32_16x16x32_bf16 v[180:183], v[244:247], v[36:39], v[180:183]
v_rcp_f16 v202, v201
s_waitcnt lgkmcnt(7)
v_mfma_f32_16x16x32_bf16 v[168:171], v[216:219], v[40:43], v[168:171]
ds_read_b128 v[244:247], v249 offset:62464
v_rcp_f16_e64 v199, v198
v_mfma_f32_16x16x32_bf16 v[176:179], v[216:219], v[44:47], v[176:179]
v_rcp_f16_e64 v196, v195
v_mfma_f32_16x16x32_bf16 v[172:175], v[220:223], v[40:43], v[172:175]
ds_read_b128 v[216:219], v249 offset:256
v_rcp_f16_sdwa v202, v201 dst_sel:WORD_1 dst_unused:UNUSED_PRESERVE src0_sel:WORD_1
v_mfma_f32_16x16x32_bf16 v[180:183], v[220:223], v[44:47], v[180:183]
v_rcp_f16_sdwa v199, v198 dst_sel:WORD_1 dst_unused:UNUSED_PRESERVE src0_sel:WORD_1
v_or_b32 v232, v184, v185
v_or_b32 v233, v186, v187
s_waitcnt lgkmcnt(4)
v_or_b32 v234, v188, v189
v_rcp_f16_sdwa v196, v195 dst_sel:WORD_1 dst_unused:UNUSED_PRESERVE src0_sel:WORD_1
v_or_b32 v235, v190, v191
s_waitcnt lgkmcnt(2)
v_or_b32_e64 v236, v192, v193
v_pk_mul_f16 v237, v203, v202
v_pk_mul_f16 v238, v200, v199
v_pk_mul_f16 v239, v197, v196
v_mfma_f32_16x16x32_f16 v[120:123], v[224:227], v[232:235], v[120:123]
buffer_load_dwordx4 v[208:211], v252, s[4:7], s68 offen offset:64
ds_read_b128 v[220:223], v249 offset:62720
v_cvt_pkrtz_f16_f32 v185, v168, v169
v_cvt_pkrtz_f16_f32 v187, v170, v171
v_mfma_f32_16x16x32_f16 v[128:131], v[224:227], v[236:239], v[128:131]
v_cvt_pkrtz_f16_f32 v189, v172, v173
v_cvt_pkrtz_f16_f32 v191, v174, v175
v_mfma_f32_16x16x32_f16 v[124:127], v[228:231], v[232:235], v[124:127]
ds_read_b128 v[224:227], v249 offset:1024
v_cvt_pkrtz_f16_f32 v193, v176, v177
v_cvt_pk_f16_f32 v203, v178, v179
v_cvt_pk_f16_f32 v200, v180, v181
v_mfma_f32_16x16x32_f16 v[132:135], v[228:231], v[236:239], v[132:135]
v_cvt_pk_f16_f32 v197, v182, v183
s_setprio 1
v_pk_fma_f16 v202, v203, v203, s48
v_mfma_f32_16x16x32_bf16 v[168:171], v[240:243], v[24:27], 0
ds_read_b128 v[228:231], v249 offset:63488
v_and_b32 v185, s49, v185
v_pk_fma_f16 v199, v200, v200, s48
v_mfma_f32_16x16x32_bf16 v[176:179], v[240:243], v[28:31], 0
v_and_b32 v187, s49, v187
v_pk_fma_f16 v196, v197, v197, s48
v_bfe_u32 v184, v185, 2, 14
s_waitcnt lgkmcnt(3)
v_mfma_f32_16x16x32_f16 v[136:139], v[244:247], v[232:235], v[136:139]
ds_read_b128 v[240:243], v249 offset:63744
ds_read_u16_d16 v184, v184
v_pk_mul_f16 v202, v203, v202
v_bfe_u32 v186, v187, 2, 14
v_mfma_f32_16x16x32_f16 v[144:147], v[244:247], v[236:239], v[144:147]
v_pk_mul_f16 v199, v200, v199
v_lshrrev_b32_e64 v185, 18, v185
v_mfma_f32_16x16x32_bf16 v[172:175], v[216:219], v[24:27], 0
ds_read_b128 v[244:247], v249 offset:1280
ds_read_u16_d16 v186, v186
ds_read_u16_d16_hi v185, v185
v_pk_mul_f16 v196, v197, v196
v_lshrrev_b32_e64 v187, 18, v187
v_mfma_f32_16x16x32_bf16 v[180:183], v[216:219], v[28:31], 0
v_exp_f16_e64 v201, v202
v_and_b32 v189, s49, v189
s_waitcnt lgkmcnt(5)
v_mfma_f32_16x16x32_f16 v[140:143], v[220:223], v[232:235], v[140:143]
ds_read_b128 v[216:219], v249 offset:2048
ds_read_u16_d16_hi v187, v187
v_and_b32_e64 v191, s49, v191
v_mfma_f32_16x16x32_f16 v[148:151], v[220:223], v[236:239], v[148:151]
v_exp_f16_e64 v198, v199
v_bfe_u32 v188, v189, 2, 14
v_bfe_u32 v190, v191, 2, 14
v_mfma_f32_16x16x32_bf16 v[168:171], v[224:227], v[32:35], v[168:171]
ds_read_b128 v[220:223], v249 offset:2304
ds_read_u16_d16 v188, v188
ds_read_u16_d16 v190, v190
v_exp_f16_e64 v195, v196
v_mfma_f32_16x16x32_bf16 v[176:179], v[224:227], v[36:39], v[176:179]
v_lshrrev_b32 v189, 18, v189
v_lshrrev_b32 v191, 18, v191
v_mfma_f32_16x16x32_f16 v[152:155], v[228:231], v[232:235], v[152:155]
ds_read_b128 v[224:227], v250 offset:2048
ds_read_u16_d16_hi v189, v189
ds_read_u16_d16_hi v191, v191
v_exp_f16_sdwa v201, v202 dst_sel:WORD_1 dst_unused:UNUSED_PRESERVE src0_sel:WORD_1
v_and_b32 v193, s49, v193
v_mfma_f32_16x16x32_f16 v[160:163], v[228:231], v[236:239], v[160:163]
v_bfe_u32 v192, v193, 2, 14
s_waitcnt lgkmcnt(8)
v_mfma_f32_16x16x32_f16 v[156:159], v[240:243], v[232:235], v[156:159]
ds_read_b128 v[228:231], v250 offset:2304
ds_read_u16_d16 v192, v192
v_exp_f16_sdwa v198, v199 dst_sel:WORD_1 dst_unused:UNUSED_PRESERVE src0_sel:WORD_1
v_lshrrev_b32_e64 v193, 18, v193
v_mfma_f32_16x16x32_f16 v[164:167], v[240:243], v[236:239], v[164:167]
v_exp_f16_sdwa v195, v196 dst_sel:WORD_1 dst_unused:UNUSED_PRESERVE src0_sel:WORD_1
v_pk_add_f16 v201, v201, 1.0 op_sel_hi:[1,0]
v_mfma_f32_16x16x32_bf16 v[172:175], v[244:247], v[32:35], v[172:175]
ds_read_b128 v[240:243], v249 offset:6144
ds_read_u16_d16_hi v193, v193
v_pk_add_f16 v198, v198, 1.0 op_sel_hi:[1,0]
v_pk_add_f16 v195, v195, 1.0 op_sel_hi:[1,0]
v_mfma_f32_16x16x32_bf16 v[180:183], v[244:247], v[36:39], v[180:183]
v_rcp_f16_e64 v202, v201
s_setprio 0
s_waitcnt lgkmcnt(7)
v_mfma_f32_16x16x32_bf16 v[168:171], v[216:219], v[40:43], v[168:171]
ds_read_b128 v[244:247], v250 offset:3072
v_rcp_f16_e64 v199, v198
v_mfma_f32_16x16x32_bf16 v[176:179], v[216:219], v[44:47], v[176:179]
v_rcp_f16_e64 v196, v195
v_mfma_f32_16x16x32_bf16 v[172:175], v[220:223], v[40:43], v[172:175]
ds_read_b128 v[216:219], v249 offset:6400
v_rcp_f16_sdwa v202, v201 dst_sel:WORD_1 dst_unused:UNUSED_PRESERVE src0_sel:WORD_1
v_mfma_f32_16x16x32_bf16 v[180:183], v[220:223], v[44:47], v[180:183]
v_rcp_f16_sdwa v199, v198 dst_sel:WORD_1 dst_unused:UNUSED_PRESERVE src0_sel:WORD_1
v_or_b32 v232, v184, v185
v_or_b32 v233, v186, v187
s_waitcnt lgkmcnt(4)
v_or_b32 v234, v188, v189
v_rcp_f16_sdwa v196, v195 dst_sel:WORD_1 dst_unused:UNUSED_PRESERVE src0_sel:WORD_1
v_or_b32 v235, v190, v191
s_waitcnt lgkmcnt(2)
v_or_b32 v236, v192, v193
v_pk_mul_f16 v237, v203, v202
v_pk_mul_f16 v238, v200, v199
v_pk_mul_f16 v239, v197, v196
s_setprio 3
v_mfma_f32_16x16x32_f16 v[120:123], v[224:227], v[232:235], v[120:123]
ds_read_b128 v[220:223], v250 offset:3328
v_cvt_pkrtz_f16_f32 v185, v168, v169
v_cvt_pkrtz_f16_f32 v187, v170, v171
v_cvt_pkrtz_f16_f32 v189, v172, v173
v_mfma_f32_16x16x32_f16 v[128:131], v[224:227], v[236:239], v[128:131]
v_cvt_pkrtz_f16_f32 v191, v174, v175
v_cvt_pkrtz_f16_f32 v193, v176, v177
v_cvt_pk_f16_f32 v203, v178, v179
v_mfma_f32_16x16x32_f16 v[124:127], v[228:231], v[232:235], v[124:127]
ds_read_b128 v[224:227], v249 offset:7168
v_cvt_pk_f16_f32 v200, v180, v181
v_cvt_pk_f16_f32 v197, v182, v183
v_pk_fma_f16 v202, v203, v203, s48
v_cvt_pk_bf16_f32 v72, v72, v73
v_mfma_f32_16x16x32_f16 v[132:135], v[228:231], v[236:239], v[132:135]
v_and_b32_e64 v185, s49, v185
v_cvt_pk_bf16_f32 v73, v74, v75
v_pk_fma_f16 v199, v200, v200, s48
v_mfma_f32_16x16x32_bf16 v[168:171], v[240:243], v[24:27], 0
ds_read_b128 v[228:231], v250 offset:4096
v_and_b32 v187, s49, v187
v_cvt_pk_bf16_f32 v74, v76, v77
v_pk_fma_f16 v196, v197, v197, s48
v_mfma_f32_16x16x32_bf16 v[176:179], v[240:243], v[28:31], 0
v_cvt_pk_bf16_f32 v75, v78, v79
v_bfe_u32 v184, v185, 2, 14
v_pk_mul_f16 v202, v203, v202
v_cvt_pk_bf16_f32 v56, v56, v57
s_waitcnt lgkmcnt(2)
v_mfma_f32_16x16x32_f16 v[136:139], v[244:247], v[232:235], v[136:139]
ds_read_b128 v[240:243], v250 offset:4352
ds_read_u16_d16 v184, v184
v_bfe_u32 v186, v187, 2, 14
v_cvt_pk_bf16_f32 v57, v58, v59
v_pk_mul_f16 v199, v200, v199
v_mfma_f32_16x16x32_f16 v[144:147], v[244:247], v[236:239], v[144:147]
v_lshrrev_b32_e64 v185, 18, v185
v_cvt_pk_bf16_f32 v58, v60, v61
v_pk_mul_f16 v196, v197, v196
v_mfma_f32_16x16x32_bf16 v[172:175], v[216:219], v[24:27], 0
ds_read_b128 v[244:247], v249 offset:7424
ds_read_u16_d16 v186, v186
ds_read_u16_d16_hi v185, v185
v_lshrrev_b32_e64 v187, 18, v187
v_cvt_pk_bf16_f32 v59, v62, v63
v_exp_f16_e64 v201, v202
v_mfma_f32_16x16x32_bf16 v[180:183], v[216:219], v[28:31], 0
v_cvt_pk_bf16_f32 v88, v88, v89
v_and_b32_e64 v189, s49, v189
v_cvt_pk_bf16_f32 v89, v90, v91
v_mfma_f32_16x16x32_f16 v[140:143], v[220:223], v[232:235], v[140:143]
ds_read_b128 v[216:219], v249 offset:8192
ds_read_u16_d16_hi v187, v187
v_and_b32_e64 v191, s49, v191
v_cvt_pk_bf16_f32 v90, v92, v93
v_mfma_f32_16x16x32_f16 v[148:151], v[220:223], v[236:239], v[148:151]
v_exp_f16_e64 v198, v199
v_cvt_pk_bf16_f32 v91, v94, v95
s_mov_b64 vcc, s[74:75]
v_bfe_u32 v188, v189, 2, 14
v_bfe_u32 v190, v191, 2, 14
s_waitcnt lgkmcnt(5)
v_mfma_f32_16x16x32_bf16 v[168:171], v[224:227], v[32:35], v[168:171]
ds_read_b128 v[220:223], v249 offset:8448
ds_read_u16_d16 v188, v188
ds_read_u16_d16 v190, v190
v_cndmask_b32 v76, v56, v88, vcc
v_exp_f16 v195, v196
v_mfma_f32_16x16x32_bf16 v[176:179], v[224:227], v[36:39], v[176:179]
v_cndmask_b32 v77, v57, v89, vcc
v_lshrrev_b32_e64 v189, 18, v189
v_cndmask_b32 v78, v58, v90, vcc
v_mfma_f32_16x16x32_f16 v[152:155], v[228:231], v[232:235], v[152:155]
ds_read_b128 v[224:227], v250 offset:8192
ds_read_u16_d16_hi v189, v189
v_lshrrev_b32 v191, 18, v191
v_cndmask_b32 v79, v59, v91, vcc
v_exp_f16_sdwa v201, v202 dst_sel:WORD_1 dst_unused:UNUSED_PRESERVE src0_sel:WORD_1
v_mfma_f32_16x16x32_f16 v[160:163], v[228:231], v[236:239], v[160:163]
v_cndmask_b32_dpp v56, v72, v56, vcc quad_perm:[1,0,3,2] row_mask:0xf bank_mask:0xf
v_and_b32_e64 v193, s49, v193
v_cndmask_b32_dpp v57, v73, v57, vcc quad_perm:[1,0,3,2] row_mask:0xf bank_mask:0xf
v_mfma_f32_16x16x32_f16 v[156:159], v[240:243], v[232:235], v[156:159]
ds_read_b128 v[228:231], v250 offset:8448
ds_read_u16_d16_hi v191, v191
v_bfe_u32 v192, v193, 2, 14
v_exp_f16_sdwa v198, v199 dst_sel:WORD_1 dst_unused:UNUSED_PRESERVE src0_sel:WORD_1
v_mfma_f32_16x16x32_f16 v[164:167], v[240:243], v[236:239], v[164:167]
v_cndmask_b32_dpp v58, v74, v58, vcc quad_perm:[1,0,3,2] row_mask:0xf bank_mask:0xf
v_lshrrev_b32_e64 v193, 18, v193
v_cndmask_b32_dpp v59, v75, v59, vcc quad_perm:[1,0,3,2] row_mask:0xf bank_mask:0xf
s_not_b64 vcc, s[74:75]
s_waitcnt lgkmcnt(4)
v_mfma_f32_16x16x32_bf16 v[172:175], v[244:247], v[32:35], v[172:175]
ds_read_b128 v[240:243], v249 offset:12288
ds_read_u16_d16 v192, v192
ds_read_u16_d16_hi v193, v193
v_exp_f16_sdwa v195, v196 dst_sel:WORD_1 dst_unused:UNUSED_PRESERVE src0_sel:WORD_1
v_cndmask_b32_dpp v88, v72, v88, vcc quad_perm:[1,0,3,2] row_mask:0xf bank_mask:0xf
v_pk_add_f16 v201, v201, 1.0 op_sel_hi:[1,0]
v_mfma_f32_16x16x32_bf16 v[180:183], v[244:247], v[36:39], v[180:183]
v_cndmask_b32_dpp v89, v73, v89, vcc quad_perm:[1,0,3,2] row_mask:0xf bank_mask:0xf
v_pk_add_f16 v198, v198, 1.0 op_sel_hi:[1,0]
v_cndmask_b32_dpp v90, v74, v90, vcc quad_perm:[1,0,3,2] row_mask:0xf bank_mask:0xf
v_mfma_f32_16x16x32_bf16 v[168:171], v[216:219], v[40:43], v[168:171]
ds_read_b128 v[244:247], v250 offset:9216
v_pk_add_f16 v195, v195, 1.0 op_sel_hi:[1,0]
v_rcp_f16_e64 v202, v201
v_cndmask_b32_dpp v91, v75, v91, vcc quad_perm:[1,0,3,2] row_mask:0xf bank_mask:0xf
v_mfma_f32_16x16x32_bf16 v[176:179], v[216:219], v[44:47], v[176:179]
v_rcp_f16_e64 v199, v198
v_mfma_f32_16x16x32_bf16 v[172:175], v[220:223], v[40:43], v[172:175]
ds_read_b128 v[216:219], v249 offset:12544
s_add_u32 s46, s70, 98304
buffer_store_dwordx4 v[56:59], v255, s[8:11], s46 offen sc1
v_rcp_f16_e64 v196, v195
v_rcp_f16_sdwa v202, v201 dst_sel:WORD_1 dst_unused:UNUSED_PRESERVE src0_sel:WORD_1
v_mfma_f32_16x16x32_bf16 v[180:183], v[220:223], v[44:47], v[180:183]
v_rcp_f16_sdwa v199, v198 dst_sel:WORD_1 dst_unused:UNUSED_PRESERVE src0_sel:WORD_1
v_or_b32 v232, v184, v185
v_or_b32 v233, v186, v187
s_waitcnt lgkmcnt(2)
v_or_b32 v234, v188, v189
v_rcp_f16_sdwa v196, v195 dst_sel:WORD_1 dst_unused:UNUSED_PRESERVE src0_sel:WORD_1
v_or_b32 v235, v190, v191
v_or_b32 v236, v192, v193
v_pk_mul_f16 v237, v203, v202
v_pk_mul_f16 v238, v200, v199
v_pk_mul_f16 v239, v197, v196
v_mfma_f32_16x16x32_f16 v[120:123], v[224:227], v[232:235], v[120:123]
buffer_load_dwordx4 v[12:15], v252, s[4:7], s68 offen offset:128
ds_read_b128 v[220:223], v250 offset:9472
v_cvt_pkrtz_f16_f32 v185, v168, v169
v_cvt_pkrtz_f16_f32 v187, v170, v171
v_mfma_f32_16x16x32_f16 v[128:131], v[224:227], v[236:239], v[128:131]
v_cvt_pkrtz_f16_f32 v189, v172, v173
v_cvt_pkrtz_f16_f32 v191, v174, v175
v_mfma_f32_16x16x32_f16 v[124:127], v[228:231], v[232:235], v[124:127]
ds_read_b128 v[224:227], v249 offset:13312
v_cvt_pkrtz_f16_f32 v193, v176, v177
v_cvt_pk_f16_f32 v203, v178, v179
v_cvt_pk_f16_f32 v200, v180, v181
v_mfma_f32_16x16x32_f16 v[132:135], v[228:231], v[236:239], v[132:135]
v_cvt_pk_f16_f32 v197, v182, v183
v_pk_fma_f16 v202, v203, v203, s48
v_mfma_f32_16x16x32_bf16 v[168:171], v[240:243], v[24:27], 0
ds_read_b128 v[228:231], v250 offset:10240
v_and_b32_e64 v185, s49, v185
v_pk_fma_f16 v199, v200, v200, s48
v_mfma_f32_16x16x32_bf16 v[176:179], v[240:243], v[28:31], 0
v_and_b32_e64 v187, s49, v187
v_pk_fma_f16 v196, v197, v197, s48
s_setprio 2
v_bfe_u32 v184, v185, 2, 14
s_waitcnt lgkmcnt(3)
v_mfma_f32_16x16x32_f16 v[136:139], v[244:247], v[232:235], v[136:139]
ds_read_b128 v[240:243], v250 offset:10496
ds_read_u16_d16 v184, v184
v_pk_mul_f16 v202, v203, v202
v_bfe_u32 v186, v187, 2, 14
v_mfma_f32_16x16x32_f16 v[144:147], v[244:247], v[236:239], v[144:147]
v_pk_mul_f16 v199, v200, v199
v_lshrrev_b32_e64 v185, 18, v185
v_mfma_f32_16x16x32_bf16 v[172:175], v[216:219], v[24:27], 0
ds_read_b128 v[244:247], v249 offset:13568
ds_read_u16_d16 v186, v186
ds_read_u16_d16_hi v185, v185
v_pk_mul_f16 v196, v197, v196
v_lshrrev_b32_e64 v187, 18, v187
v_mfma_f32_16x16x32_bf16 v[180:183], v[216:219], v[28:31], 0
v_exp_f16_e64 v201, v202
v_and_b32 v189, s49, v189
s_waitcnt lgkmcnt(5)
v_mfma_f32_16x16x32_f16 v[140:143], v[220:223], v[232:235], v[140:143]
ds_read_b128 v[216:219], v249 offset:14336
ds_read_u16_d16_hi v187, v187
v_and_b32_e64 v191, s49, v191
v_mfma_f32_16x16x32_f16 v[148:151], v[220:223], v[236:239], v[148:151]
v_exp_f16_e64 v198, v199
v_bfe_u32 v188, v189, 2, 14
v_bfe_u32 v190, v191, 2, 14
v_mfma_f32_16x16x32_bf16 v[168:171], v[224:227], v[32:35], v[168:171]
ds_read_b128 v[220:223], v249 offset:14592
ds_read_u16_d16 v188, v188
ds_read_u16_d16 v190, v190
v_exp_f16_e64 v195, v196
v_mfma_f32_16x16x32_bf16 v[176:179], v[224:227], v[36:39], v[176:179]
v_lshrrev_b32 v189, 18, v189
v_lshrrev_b32 v191, 18, v191
v_mfma_f32_16x16x32_f16 v[152:155], v[228:231], v[232:235], v[152:155]
ds_read_b128 v[224:227], v250 offset:14336
ds_read_u16_d16_hi v189, v189
ds_read_u16_d16_hi v191, v191
v_exp_f16_sdwa v201, v202 dst_sel:WORD_1 dst_unused:UNUSED_PRESERVE src0_sel:WORD_1
v_and_b32 v193, s49, v193
v_mfma_f32_16x16x32_f16 v[160:163], v[228:231], v[236:239], v[160:163]
v_bfe_u32 v192, v193, 2, 14
s_waitcnt lgkmcnt(8)
v_mfma_f32_16x16x32_f16 v[156:159], v[240:243], v[232:235], v[156:159]
ds_read_b128 v[228:231], v250 offset:14592
ds_read_u16_d16 v192, v192
v_exp_f16_sdwa v198, v199 dst_sel:WORD_1 dst_unused:UNUSED_PRESERVE src0_sel:WORD_1
v_lshrrev_b32_e64 v193, 18, v193
v_mfma_f32_16x16x32_f16 v[164:167], v[240:243], v[236:239], v[164:167]
v_exp_f16_sdwa v195, v196 dst_sel:WORD_1 dst_unused:UNUSED_PRESERVE src0_sel:WORD_1
v_pk_add_f16 v201, v201, 1.0 op_sel_hi:[1,0]
v_mfma_f32_16x16x32_bf16 v[172:175], v[244:247], v[32:35], v[172:175]
ds_read_b128 v[240:243], v249 offset:18432
ds_read_u16_d16_hi v193, v193
v_pk_add_f16 v198, v198, 1.0 op_sel_hi:[1,0]
v_pk_add_f16 v195, v195, 1.0 op_sel_hi:[1,0]
v_mfma_f32_16x16x32_bf16 v[180:183], v[244:247], v[36:39], v[180:183]
v_rcp_f16 v202, v201
s_waitcnt lgkmcnt(7)
v_mfma_f32_16x16x32_bf16 v[168:171], v[216:219], v[40:43], v[168:171]
ds_read_b128 v[244:247], v250 offset:15360
v_rcp_f16_e64 v199, v198
v_mfma_f32_16x16x32_bf16 v[176:179], v[216:219], v[44:47], v[176:179]
v_rcp_f16_e64 v196, v195
v_mfma_f32_16x16x32_bf16 v[172:175], v[220:223], v[40:43], v[172:175]
ds_read_b128 v[216:219], v249 offset:18688
v_rcp_f16_sdwa v202, v201 dst_sel:WORD_1 dst_unused:UNUSED_PRESERVE src0_sel:WORD_1
v_mfma_f32_16x16x32_bf16 v[180:183], v[220:223], v[44:47], v[180:183]
v_rcp_f16_sdwa v199, v198 dst_sel:WORD_1 dst_unused:UNUSED_PRESERVE src0_sel:WORD_1
v_or_b32 v232, v184, v185
v_or_b32 v233, v186, v187
s_waitcnt lgkmcnt(4)
v_or_b32 v234, v188, v189
v_rcp_f16_sdwa v196, v195 dst_sel:WORD_1 dst_unused:UNUSED_PRESERVE src0_sel:WORD_1
v_or_b32 v235, v190, v191
s_waitcnt lgkmcnt(2)
v_or_b32_e64 v236, v192, v193
v_pk_mul_f16 v237, v203, v202
v_pk_mul_f16 v238, v200, v199
v_pk_mul_f16 v239, v197, v196
v_mfma_f32_16x16x32_f16 v[120:123], v[224:227], v[232:235], v[120:123]
s_add_u32 s46, s68, 98304
buffer_load_dwordx4 v[8:11], v252, s[4:7], s46 offen
ds_read_b128 v[220:223], v250 offset:15616
v_cvt_pkrtz_f16_f32 v185, v168, v169
v_cvt_pkrtz_f16_f32 v187, v170, v171
v_mfma_f32_16x16x32_f16 v[128:131], v[224:227], v[236:239], v[128:131]
v_cvt_pkrtz_f16_f32 v189, v172, v173
v_cvt_pkrtz_f16_f32 v191, v174, v175
v_mfma_f32_16x16x32_f16 v[124:127], v[228:231], v[232:235], v[124:127]
ds_read_b128 v[224:227], v249 offset:19456
v_cvt_pkrtz_f16_f32 v193, v176, v177
v_cvt_pk_f16_f32 v203, v178, v179
v_cvt_pk_f16_f32 v200, v180, v181
v_mfma_f32_16x16x32_f16 v[132:135], v[228:231], v[236:239], v[132:135]
v_cvt_pk_f16_f32 v197, v182, v183
s_setprio 1
v_pk_fma_f16 v202, v203, v203, s48
v_mfma_f32_16x16x32_bf16 v[168:171], v[240:243], v[24:27], 0
ds_read_b128 v[228:231], v250 offset:16384
v_and_b32 v185, s49, v185
v_pk_fma_f16 v199, v200, v200, s48
v_mfma_f32_16x16x32_bf16 v[176:179], v[240:243], v[28:31], 0
v_and_b32 v187, s49, v187
v_pk_fma_f16 v196, v197, v197, s48
v_bfe_u32 v184, v185, 2, 14
s_waitcnt lgkmcnt(3)
v_mfma_f32_16x16x32_f16 v[136:139], v[244:247], v[232:235], v[136:139]
ds_read_b128 v[240:243], v250 offset:16640
ds_read_u16_d16 v184, v184
v_pk_mul_f16 v202, v203, v202
v_bfe_u32 v186, v187, 2, 14
v_mfma_f32_16x16x32_f16 v[144:147], v[244:247], v[236:239], v[144:147]
v_pk_mul_f16 v199, v200, v199
v_lshrrev_b32_e64 v185, 18, v185
v_mfma_f32_16x16x32_bf16 v[172:175], v[216:219], v[24:27], 0
ds_read_b128 v[244:247], v249 offset:19712
ds_read_u16_d16 v186, v186
ds_read_u16_d16_hi v185, v185
v_pk_mul_f16 v196, v197, v196
v_lshrrev_b32_e64 v187, 18, v187
v_mfma_f32_16x16x32_bf16 v[180:183], v[216:219], v[28:31], 0
v_exp_f16_e64 v201, v202
v_and_b32 v189, s49, v189
s_waitcnt lgkmcnt(5)
v_mfma_f32_16x16x32_f16 v[140:143], v[220:223], v[232:235], v[140:143]
ds_read_b128 v[216:219], v249 offset:20480
ds_read_u16_d16_hi v187, v187
v_and_b32_e64 v191, s49, v191
v_mfma_f32_16x16x32_f16 v[148:151], v[220:223], v[236:239], v[148:151]
v_exp_f16_e64 v198, v199
v_bfe_u32 v188, v189, 2, 14
v_bfe_u32 v190, v191, 2, 14
v_mfma_f32_16x16x32_bf16 v[168:171], v[224:227], v[32:35], v[168:171]
s_add_u32 s46, s70, 98304
buffer_store_dwordx4 v[76:79], v255, s[8:11], s46 offen offset:128 sc1
ds_read_b128 v[220:223], v249 offset:20736
ds_read_u16_d16 v188, v188
ds_read_u16_d16 v190, v190
v_exp_f16_e64 v195, v196
v_mfma_f32_16x16x32_bf16 v[176:179], v[224:227], v[36:39], v[176:179]
v_lshrrev_b32 v189, 18, v189
v_lshrrev_b32 v191, 18, v191
v_mfma_f32_16x16x32_f16 v[152:155], v[228:231], v[232:235], v[152:155]
ds_read_b128 v[224:227], v250 offset:20480
ds_read_u16_d16_hi v189, v189
ds_read_u16_d16_hi v191, v191
v_exp_f16_sdwa v201, v202 dst_sel:WORD_1 dst_unused:UNUSED_PRESERVE src0_sel:WORD_1
v_and_b32 v193, s49, v193
v_mfma_f32_16x16x32_f16 v[160:163], v[228:231], v[236:239], v[160:163]
v_bfe_u32 v192, v193, 2, 14
s_waitcnt lgkmcnt(7)
v_mfma_f32_16x16x32_f16 v[156:159], v[240:243], v[232:235], v[156:159]
ds_read_b128 v[228:231], v250 offset:20736
ds_read_u16_d16 v192, v192
v_exp_f16_sdwa v198, v199 dst_sel:WORD_1 dst_unused:UNUSED_PRESERVE src0_sel:WORD_1
v_lshrrev_b32_e64 v193, 18, v193
v_mfma_f32_16x16x32_f16 v[164:167], v[240:243], v[236:239], v[164:167]
v_exp_f16_sdwa v195, v196 dst_sel:WORD_1 dst_unused:UNUSED_PRESERVE src0_sel:WORD_1
v_pk_add_f16 v201, v201, 1.0 op_sel_hi:[1,0]
v_mfma_f32_16x16x32_bf16 v[172:175], v[244:247], v[32:35], v[172:175]
ds_read_b128 v[240:243], v248 offset:16384
ds_read_u16_d16_hi v193, v193
v_pk_add_f16 v198, v198, 1.0 op_sel_hi:[1,0]
v_pk_add_f16 v195, v195, 1.0 op_sel_hi:[1,0]
v_mfma_f32_16x16x32_bf16 v[180:183], v[244:247], v[36:39], v[180:183]
v_rcp_f16 v202, v201
s_setprio 0
v_mfma_f32_16x16x32_bf16 v[168:171], v[216:219], v[40:43], v[168:171]
ds_read_b128 v[244:247], v250 offset:21504
v_rcp_f16_e64 v199, v198
v_mfma_f32_16x16x32_bf16 v[176:179], v[216:219], v[44:47], v[176:179]
v_rcp_f16 v196, v195
s_waitcnt lgkmcnt(5)
v_mfma_f32_16x16x32_bf16 v[172:175], v[220:223], v[40:43], v[172:175]
ds_read_b128 v[216:219], v248 offset:16640
v_rcp_f16_sdwa v202, v201 dst_sel:WORD_1 dst_unused:UNUSED_PRESERVE src0_sel:WORD_1
v_mfma_f32_16x16x32_bf16 v[180:183], v[220:223], v[44:47], v[180:183]
v_rcp_f16_sdwa v199, v198 dst_sel:WORD_1 dst_unused:UNUSED_PRESERVE src0_sel:WORD_1
v_or_b32 v232, v184, v185
v_or_b32 v233, v186, v187
v_or_b32_e64 v234, v188, v189
v_rcp_f16_sdwa v196, v195 dst_sel:WORD_1 dst_unused:UNUSED_PRESERVE src0_sel:WORD_1
v_or_b32 v235, v190, v191
s_waitcnt lgkmcnt(2)
v_or_b32 v236, v192, v193
v_pk_mul_f16 v237, v203, v202
v_pk_mul_f16 v238, v200, v199
v_pk_mul_f16 v239, v197, v196
s_setprio 3
v_mfma_f32_16x16x32_f16 v[120:123], v[224:227], v[232:235], v[120:123]
ds_read_b128 v[220:223], v250 offset:21760
v_cvt_pkrtz_f16_f32 v185, v168, v169
v_cvt_pkrtz_f16_f32 v187, v170, v171
v_mfma_f32_16x16x32_f16 v[128:131], v[224:227], v[236:239], v[128:131]
v_cvt_pkrtz_f16_f32 v189, v172, v173
v_cvt_pkrtz_f16_f32 v191, v174, v175
v_mfma_f32_16x16x32_f16 v[124:127], v[228:231], v[232:235], v[124:127]
ds_read_b128 v[224:227], v248 offset:17408
v_cvt_pkrtz_f16_f32 v193, v176, v177
v_cvt_pk_f16_f32 v203, v178, v179
v_cvt_pk_f16_f32 v200, v180, v181
v_mfma_f32_16x16x32_f16 v[132:135], v[228:231], v[236:239], v[132:135]
v_cvt_pk_f16_f32 v197, v182, v183
v_pk_fma_f16 v202, v203, v203, s48
s_waitcnt vmcnt(14)
v_mfma_f32_16x16x32_bf16 v[168:171], v[240:243], v[96:99], 0
ds_read_b128 v[228:231], v250 offset:22528
v_and_b32_e64 v185, s49, v185
v_pk_fma_f16 v199, v200, v200, s48
s_waitcnt vmcnt(13)
v_mfma_f32_16x16x32_bf16 v[176:179], v[240:243], v[100:103], 0
v_and_b32 v187, s49, v187
v_pk_fma_f16 v196, v197, v197, s48
v_bfe_u32 v184, v185, 2, 14
s_waitcnt lgkmcnt(3)
v_mfma_f32_16x16x32_f16 v[136:139], v[244:247], v[232:235], v[136:139]
ds_read_b128 v[240:243], v250 offset:22784
ds_read_u16_d16 v184, v184
v_pk_mul_f16 v202, v203, v202
v_bfe_u32 v186, v187, 2, 14
v_mfma_f32_16x16x32_f16 v[144:147], v[244:247], v[236:239], v[144:147]
v_pk_mul_f16 v199, v200, v199
v_lshrrev_b32_e64 v185, 18, v185
v_mfma_f32_16x16x32_bf16 v[172:175], v[216:219], v[96:99], 0
ds_read_b128 v[244:247], v248 offset:17664
ds_read_u16_d16 v186, v186
ds_read_u16_d16_hi v185, v185
v_pk_mul_f16 v196, v197, v196
v_lshrrev_b32_e64 v187, 18, v187
v_mfma_f32_16x16x32_bf16 v[180:183], v[216:219], v[100:103], 0
v_exp_f16_e64 v201, v202
v_and_b32 v189, s49, v189
s_waitcnt lgkmcnt(5)
v_mfma_f32_16x16x32_f16 v[140:143], v[220:223], v[232:235], v[140:143]
ds_read_b128 v[216:219], v248 offset:18432
ds_read_u16_d16_hi v187, v187
v_and_b32_e64 v191, s49, v191
v_mfma_f32_16x16x32_f16 v[148:151], v[220:223], v[236:239], v[148:151]
v_exp_f16 v198, v199
v_bfe_u32 v188, v189, 2, 14
v_bfe_u32 v190, v191, 2, 14
s_waitcnt vmcnt(12)
v_mfma_f32_16x16x32_bf16 v[168:171], v[224:227], v[104:107], v[168:171]
ds_read_b128 v[220:223], v248 offset:18688
ds_read_u16_d16 v188, v188
ds_read_u16_d16 v190, v190
v_exp_f16 v195, v196
s_waitcnt vmcnt(11)
v_mfma_f32_16x16x32_bf16 v[176:179], v[224:227], v[108:111], v[176:179]
v_lshrrev_b32 v189, 18, v189
v_lshrrev_b32 v191, 18, v191
v_mfma_f32_16x16x32_f16 v[152:155], v[228:231], v[232:235], v[152:155]
ds_read_b128 v[224:227], v250 offset:26624
ds_read_u16_d16_hi v189, v189
ds_read_u16_d16_hi v191, v191
v_exp_f16_sdwa v201, v202 dst_sel:WORD_1 dst_unused:UNUSED_PRESERVE src0_sel:WORD_1
v_and_b32 v193, s49, v193
v_mfma_f32_16x16x32_f16 v[160:163], v[228:231], v[236:239], v[160:163]
v_bfe_u32 v192, v193, 2, 14
s_waitcnt lgkmcnt(7)
v_mfma_f32_16x16x32_f16 v[156:159], v[240:243], v[232:235], v[156:159]
ds_read_b128 v[228:231], v250 offset:26880
ds_read_u16_d16 v192, v192
v_exp_f16_sdwa v198, v199 dst_sel:WORD_1 dst_unused:UNUSED_PRESERVE src0_sel:WORD_1
v_lshrrev_b32_e64 v193, 18, v193
v_mfma_f32_16x16x32_f16 v[164:167], v[240:243], v[236:239], v[164:167]
v_exp_f16_sdwa v195, v196 dst_sel:WORD_1 dst_unused:UNUSED_PRESERVE src0_sel:WORD_1
v_pk_add_f16 v201, v201, 1.0 op_sel_hi:[1,0]
v_mfma_f32_16x16x32_bf16 v[172:175], v[244:247], v[104:107], v[172:175]
ds_read_b128 v[240:243], v248 offset:22528
ds_read_u16_d16_hi v193, v193
v_pk_add_f16 v198, v198, 1.0 op_sel_hi:[1,0]
v_pk_add_f16 v195, v195, 1.0 op_sel_hi:[1,0]
v_mfma_f32_16x16x32_bf16 v[180:183], v[244:247], v[108:111], v[180:183]
v_rcp_f16 v202, v201
s_waitcnt vmcnt(10)
v_mfma_f32_16x16x32_bf16 v[168:171], v[216:219], v[112:115], v[168:171]
ds_read_b128 v[244:247], v250 offset:27648
v_rcp_f16 v199, v198
s_waitcnt vmcnt(7)
v_mfma_f32_16x16x32_bf16 v[176:179], v[216:219], v[116:119], v[176:179]
v_rcp_f16 v196, v195
s_waitcnt lgkmcnt(5)
v_mfma_f32_16x16x32_bf16 v[172:175], v[220:223], v[112:115], v[172:175]
ds_read_b128 v[216:219], v248 offset:22784
v_rcp_f16_sdwa v202, v201 dst_sel:WORD_1 dst_unused:UNUSED_PRESERVE src0_sel:WORD_1
v_mfma_f32_16x16x32_bf16 v[180:183], v[220:223], v[116:119], v[180:183]
v_rcp_f16_sdwa v199, v198 dst_sel:WORD_1 dst_unused:UNUSED_PRESERVE src0_sel:WORD_1
v_or_b32 v232, v184, v185
v_or_b32 v233, v186, v187
v_or_b32_e64 v234, v188, v189
v_rcp_f16_sdwa v196, v195 dst_sel:WORD_1 dst_unused:UNUSED_PRESERVE src0_sel:WORD_1
v_or_b32 v235, v190, v191
s_waitcnt lgkmcnt(2)
v_or_b32_e64 v236, v192, v193
v_pk_mul_f16 v237, v203, v202
v_pk_mul_f16 v238, v200, v199
v_pk_mul_f16 v239, v197, v196
v_mfma_f32_16x16x32_f16 v[120:123], v[224:227], v[232:235], v[120:123]
s_add_u32 s46, s68, 98304
buffer_load_dwordx4 v[44:47], v252, s[4:7], s46 offen offset:64
ds_read_b128 v[220:223], v250 offset:27904
v_cvt_pkrtz_f16_f32 v185, v168, v169
v_cvt_pkrtz_f16_f32 v187, v170, v171
v_mfma_f32_16x16x32_f16 v[128:131], v[224:227], v[236:239], v[128:131]
v_cvt_pkrtz_f16_f32 v189, v172, v173
v_cvt_pkrtz_f16_f32 v191, v174, v175
v_mfma_f32_16x16x32_f16 v[124:127], v[228:231], v[232:235], v[124:127]
ds_read_b128 v[224:227], v248 offset:23552
v_cvt_pkrtz_f16_f32 v193, v176, v177
v_cvt_pk_f16_f32 v203, v178, v179
v_mfma_f32_16x16x32_f16 v[132:135], v[228:231], v[236:239], v[132:135]
v_cvt_pk_f16_f32 v200, v180, v181
v_cvt_pk_f16_f32 v197, v182, v183
v_mfma_f32_16x16x32_bf16 v[168:171], v[240:243], v[96:99], 0
ds_read_b128 v[228:231], v250 offset:28672
v_pk_fma_f16 v202, v203, v203, s48
v_and_b32_e64 v185, s49, v185
v_mfma_f32_16x16x32_bf16 v[176:179], v[240:243], v[100:103], 0
v_pk_fma_f16 v199, v200, v200, s48
v_and_b32 v187, s49, v187
s_waitcnt lgkmcnt(3)
v_mfma_f32_16x16x32_f16 v[136:139], v[244:247], v[232:235], v[136:139]
ds_read_b128 v[240:243], v250 offset:28928
v_pk_fma_f16 v196, v197, v197, s48
s_setprio 2
v_bfe_u32 v184, v185, 2, 14
v_pk_mul_f16 v202, v203, v202
v_mfma_f32_16x16x32_f16 v[144:147], v[244:247], v[236:239], v[144:147]
v_bfe_u32 v186, v187, 2, 14
v_pk_mul_f16 v199, v200, v199
s_waitcnt vmcnt(7)
v_mfma_f32_16x16x32_bf16 v[120:123], v[18:21], v[204:207], v[120:123]
ds_read_b128 v[244:247], v248 offset:23808
ds_read_u16_d16 v184, v184
ds_read_u16_d16 v186, v186
v_lshrrev_b32_e64 v185, 18, v185
v_pk_mul_f16 v196, v197, v196
v_mfma_f32_16x16x32_bf16 v[124:127], v[16:19], v[204:207], v[124:127]
v_lshrrev_b32_e64 v187, 18, v187
v_mfma_f32_16x16x32_bf16 v[172:175], v[216:219], v[96:99], 0
ds_read_u16_d16_hi v185, v185
ds_read_u16_d16_hi v187, v187
v_exp_f16 v201, v202
v_and_b32 v189, s49, v189
v_mfma_f32_16x16x32_bf16 v[180:183], v[216:219], v[100:103], 0
v_and_b32 v191, s49, v191
s_waitcnt lgkmcnt(6)
v_mfma_f32_16x16x32_f16 v[140:143], v[220:223], v[232:235], v[140:143]
ds_read_b128 v[216:219], v248 offset:24576
v_exp_f16_e64 v198, v199
v_bfe_u32 v188, v189, 2, 14
v_mfma_f32_16x16x32_f16 v[148:151], v[220:223], v[236:239], v[148:151]
v_bfe_u32 v190, v191, 2, 14
v_exp_f16_e64 v195, v196
v_mfma_f32_16x16x32_bf16 v[168:171], v[224:227], v[104:107], v[168:171]
s_add_u32 s46, s70, 98304
buffer_store_dwordx4 v[88:91], v255, s[8:11], s46 offen offset:256 sc1
ds_read_b128 v[220:223], v248 offset:24832
ds_read_u16_d16 v188, v188
ds_read_u16_d16 v190, v190
v_lshrrev_b32 v189, 18, v189
v_lshrrev_b32 v191, 18, v191
v_mfma_f32_16x16x32_bf16 v[176:179], v[224:227], v[108:111], v[176:179]
v_exp_f16_sdwa v201, v202 dst_sel:WORD_1 dst_unused:UNUSED_PRESERVE src0_sel:WORD_1
v_mfma_f32_16x16x32_f16 v[152:155], v[228:231], v[232:235], v[152:155]
ds_read_b128 v[224:227], v249 offset:24576
ds_read_u16_d16_hi v189, v189
ds_read_u16_d16_hi v191, v191
v_and_b32 v193, s49, v193
v_bfe_u32 v192, v193, 2, 14
v_mfma_f32_16x16x32_f16 v[160:163], v[228:231], v[236:239], v[160:163]
v_exp_f16_sdwa v198, v199 dst_sel:WORD_1 dst_unused:UNUSED_PRESERVE src0_sel:WORD_1
s_waitcnt lgkmcnt(7)
v_mfma_f32_16x16x32_f16 v[156:159], v[240:243], v[232:235], v[156:159]
ds_read_b128 v[228:231], v254 offset:7936
ds_read_u16_d16 v192, v192
v_lshrrev_b32_e64 v193, 18, v193
v_mfma_f32_16x16x32_f16 v[164:167], v[240:243], v[236:239], v[164:167]
v_exp_f16_sdwa v195, v196 dst_sel:WORD_1 dst_unused:UNUSED_PRESERVE src0_sel:WORD_1
v_pk_add_f16 v201, v201, 1.0 op_sel_hi:[1,0]
v_pk_add_f16 v198, v198, 1.0 op_sel_hi:[1,0]
v_mfma_f32_16x16x32_bf16 v[172:175], v[244:247], v[104:107], v[172:175]
ds_read_b128 v[240:243], v249 offset:24832
ds_read_u16_d16_hi v193, v193
v_pk_add_f16 v195, v195, 1.0 op_sel_hi:[1,0]
v_mfma_f32_16x16x32_bf16 v[180:183], v[244:247], v[108:111], v[180:183]
v_rcp_f16 v202, v201
s_waitcnt lgkmcnt(7)
v_mfma_f32_16x16x32_bf16 v[168:171], v[216:219], v[112:115], v[168:171]
ds_read_b128 v[244:247], v254 offset:7952
v_rcp_f16_e64 v199, v198
v_mfma_f32_16x16x32_bf16 v[176:179], v[216:219], v[116:119], v[176:179]
v_rcp_f16_e64 v196, v195
v_mfma_f32_16x16x32_bf16 v[172:175], v[220:223], v[112:115], v[172:175]
ds_read_b128 v[216:219], v248 offset:28672
v_rcp_f16_sdwa v202, v201 dst_sel:WORD_1 dst_unused:UNUSED_PRESERVE src0_sel:WORD_1
v_mfma_f32_16x16x32_bf16 v[180:183], v[220:223], v[116:119], v[180:183]
v_rcp_f16_sdwa v199, v198 dst_sel:WORD_1 dst_unused:UNUSED_PRESERVE src0_sel:WORD_1
v_or_b32 v232, v184, v185
v_or_b32 v233, v186, v187
s_waitcnt lgkmcnt(4)
v_or_b32 v234, v188, v189
v_rcp_f16_sdwa v196, v195 dst_sel:WORD_1 dst_unused:UNUSED_PRESERVE src0_sel:WORD_1
v_or_b32 v235, v190, v191
s_waitcnt lgkmcnt(2)
v_or_b32 v236, v192, v193
v_pk_mul_f16 v237, v203, v202
v_pk_mul_f16 v238, v200, v199
v_pk_mul_f16 v239, v197, v196
v_mfma_f32_16x16x32_f16 v[48:51], v[224:227], v[232:235], v[228:231]
ds_read_b128 v[220:223], v249 offset:25600
v_cvt_pkrtz_f16_f32 v185, v168, v169
v_cvt_pkrtz_f16_f32 v187, v170, v171
v_mfma_f32_16x16x32_f16 v[56:59], v[224:227], v[236:239], v[228:231]
v_cvt_pkrtz_f16_f32 v189, v172, v173
v_cvt_pkrtz_f16_f32 v191, v174, v175
s_waitcnt lgkmcnt(2)
v_mfma_f32_16x16x32_f16 v[52:55], v[240:243], v[232:235], v[244:247]
ds_read_b128 v[224:227], v254 offset:8064
ds_read_b128 v[228:231], v248 offset:28928
v_cvt_pkrtz_f16_f32 v193, v176, v177
v_cvt_pk_f16_f32 v203, v178, v179
v_mfma_f32_16x16x32_f16 v[60:63], v[240:243], v[236:239], v[244:247]
v_cvt_pk_f16_f32 v200, v180, v181
v_cvt_pk_f16_f32 v197, v182, v183
s_setprio 1
s_waitcnt lgkmcnt(3)
v_mfma_f32_16x16x32_bf16 v[168:171], v[216:219], v[96:99], 0
ds_read_b128 v[240:243], v249 offset:25856
ds_read_b128 v[244:247], v254 offset:8080
v_pk_fma_f16 v202, v203, v203, s48
v_and_b32_e64 v185, s49, v185
v_mfma_f32_16x16x32_bf16 v[176:179], v[216:219], v[100:103], 0
v_pk_fma_f16 v199, v200, v200, s48
v_and_b32 v187, s49, v187
s_waitcnt lgkmcnt(3)
v_mfma_f32_16x16x32_f16 v[64:67], v[220:223], v[232:235], v[224:227]
ds_read_b128 v[216:219], v248 offset:29696
v_pk_fma_f16 v196, v197, v197, s48
v_bfe_u32 v184, v185, 2, 14
v_pk_mul_f16 v202, v203, v202
v_mfma_f32_16x16x32_f16 v[72:75], v[220:223], v[236:239], v[224:227]
v_bfe_u32 v186, v187, 2, 14
v_pk_mul_f16 v199, v200, v199
s_waitcnt vmcnt(6)
v_mfma_f32_16x16x32_bf16 v[136:139], v[18:21], v[208:211], v[136:139]
ds_read_b128 v[220:223], v249 offset:26624
ds_read_b128 v[224:227], v254 offset:16128
ds_read_u16_d16 v184, v184
ds_read_u16_d16 v186, v186
v_lshrrev_b32 v185, 18, v185
v_pk_mul_f16 v196, v197, v196
v_mfma_f32_16x16x32_bf16 v[140:143], v[16:19], v[208:211], v[140:143]
v_lshrrev_b32 v187, 18, v187
s_waitcnt lgkmcnt(5)
v_mfma_f32_16x16x32_bf16 v[172:175], v[228:231], v[96:99], 0
ds_read_u16_d16_hi v185, v185
ds_read_u16_d16_hi v187, v187
v_exp_f16 v201, v202
v_and_b32 v189, s49, v189
v_mfma_f32_16x16x32_bf16 v[180:183], v[228:231], v[100:103], 0
v_and_b32_e64 v191, s49, v191
v_mfma_f32_16x16x32_f16 v[68:71], v[240:243], v[232:235], v[244:247]
ds_read_b128 v[228:231], v249 offset:26880
v_exp_f16_e64 v198, v199
v_bfe_u32 v188, v189, 2, 14
v_mfma_f32_16x16x32_f16 v[76:79], v[240:243], v[236:239], v[244:247]
v_bfe_u32 v190, v191, 2, 14
v_exp_f16 v195, v196
s_waitcnt lgkmcnt(7)
v_mfma_f32_16x16x32_bf16 v[168:171], v[216:219], v[104:107], v[168:171]
ds_read_b128 v[240:243], v254 offset:16144
ds_read_b128 v[244:247], v248 offset:29952
ds_read_u16_d16 v188, v188
ds_read_u16_d16 v190, v190
v_lshrrev_b32_e64 v189, 18, v189
v_lshrrev_b32 v191, 18, v191
v_mfma_f32_16x16x32_bf16 v[176:179], v[216:219], v[108:111], v[176:179]
v_exp_f16_sdwa v201, v202 dst_sel:WORD_1 dst_unused:UNUSED_PRESERVE src0_sel:WORD_1
s_waitcnt lgkmcnt(7)
v_mfma_f32_16x16x32_f16 v[80:83], v[220:223], v[232:235], v[224:227]
ds_read_b128 v[216:219], v248 offset:30720
ds_read_u16_d16_hi v189, v189
ds_read_u16_d16_hi v191, v191
v_and_b32 v193, s49, v193
v_bfe_u32 v192, v193, 2, 14
v_mfma_f32_16x16x32_f16 v[88:91], v[220:223], v[236:239], v[224:227]
v_exp_f16_sdwa v198, v199 dst_sel:WORD_1 dst_unused:UNUSED_PRESERVE src0_sel:WORD_1
s_waitcnt lgkmcnt(6)
v_mfma_f32_16x16x32_f16 v[84:87], v[228:231], v[232:235], v[240:243]
ds_read_b128 v[220:223], v248 offset:30976
ds_read_b128 v[224:227], v249 offset:30720
ds_read_u16_d16 v192, v192
v_lshrrev_b32 v193, 18, v193
v_mfma_f32_16x16x32_f16 v[92:95], v[228:231], v[236:239], v[240:243]
v_exp_f16_sdwa v195, v196 dst_sel:WORD_1 dst_unused:UNUSED_PRESERVE src0_sel:WORD_1
v_pk_add_f16 v201, v201, 1.0 op_sel_hi:[1,0]
v_pk_add_f16 v198, v198, 1.0 op_sel_hi:[1,0]
s_waitcnt lgkmcnt(7)
v_mfma_f32_16x16x32_bf16 v[172:175], v[244:247], v[104:107], v[172:175]
ds_read_b128 v[228:231], v249 offset:30976
ds_read_b128 v[240:243], v248 offset:34816
ds_read_u16_d16_hi v193, v193
v_pk_add_f16 v195, v195, 1.0 op_sel_hi:[1,0]
v_mfma_f32_16x16x32_bf16 v[180:183], v[244:247], v[108:111], v[180:183]
v_rcp_f16_e64 v202, v201
s_setprio 0
s_waitcnt lgkmcnt(7)
v_mfma_f32_16x16x32_bf16 v[168:171], v[216:219], v[112:115], v[168:171]
ds_read_b128 v[244:247], v249 offset:31744
v_rcp_f16_e64 v199, v198
v_mfma_f32_16x16x32_bf16 v[176:179], v[216:219], v[116:119], v[176:179]
v_rcp_f16 v196, v195
s_waitcnt lgkmcnt(6)
v_mfma_f32_16x16x32_bf16 v[172:175], v[220:223], v[112:115], v[172:175]
ds_read_b128 v[216:219], v248 offset:35072
v_rcp_f16_sdwa v202, v201 dst_sel:WORD_1 dst_unused:UNUSED_PRESERVE src0_sel:WORD_1
v_mfma_f32_16x16x32_bf16 v[180:183], v[220:223], v[116:119], v[180:183]
v_rcp_f16_sdwa v199, v198 dst_sel:WORD_1 dst_unused:UNUSED_PRESERVE src0_sel:WORD_1
v_or_b32 v232, v184, v185
v_or_b32 v233, v186, v187
v_or_b32_e64 v234, v188, v189
v_rcp_f16_sdwa v196, v195 dst_sel:WORD_1 dst_unused:UNUSED_PRESERVE src0_sel:WORD_1
v_or_b32 v235, v190, v191
s_waitcnt lgkmcnt(2)
v_or_b32 v236, v192, v193
v_pk_mul_f16 v237, v203, v202
v_pk_mul_f16 v238, v200, v199
v_pk_mul_f16 v239, v197, v196
s_setprio 3
v_mfma_f32_16x16x32_f16 v[48:51], v[224:227], v[232:235], v[48:51]
s_add_u32 s46, s68, 98304
buffer_load_dwordx4 v[208:211], v252, s[4:7], s46 offen offset:128
ds_read_b128 v[220:223], v249 offset:32000
v_cvt_pkrtz_f16_f32 v185, v168, v169
v_cvt_pkrtz_f16_f32 v187, v170, v171
v_mfma_f32_16x16x32_f16 v[56:59], v[224:227], v[236:239], v[56:59]
v_cvt_pkrtz_f16_f32 v189, v172, v173
v_cvt_pkrtz_f16_f32 v191, v174, v175
v_mfma_f32_16x16x32_f16 v[52:55], v[228:231], v[232:235], v[52:55]
ds_read_b128 v[224:227], v248 offset:35840
v_cvt_pkrtz_f16_f32 v193, v176, v177
v_cvt_pk_f16_f32 v203, v178, v179
v_mfma_f32_16x16x32_f16 v[60:63], v[228:231], v[236:239], v[60:63]
v_cvt_pk_f16_f32 v200, v180, v181
v_cvt_pk_f16_f32 v197, v182, v183
v_mfma_f32_16x16x32_bf16 v[168:171], v[240:243], v[96:99], 0
ds_read_b128 v[228:231], v249 offset:32768
v_pk_fma_f16 v202, v203, v203, s48
v_and_b32_e64 v185, s49, v185
v_mfma_f32_16x16x32_bf16 v[176:179], v[240:243], v[100:103], 0
v_pk_fma_f16 v199, v200, v200, s48
v_and_b32 v187, s49, v187
s_waitcnt lgkmcnt(3)
v_mfma_f32_16x16x32_f16 v[64:67], v[244:247], v[232:235], v[64:67]
ds_read_b128 v[240:243], v249 offset:33024
v_pk_fma_f16 v196, v197, v197, s48
v_bfe_u32 v184, v185, 2, 14
v_pk_mul_f16 v202, v203, v202
v_mfma_f32_16x16x32_f16 v[72:75], v[244:247], v[236:239], v[72:75]
v_bfe_u32 v186, v187, 2, 14
v_pk_mul_f16 v199, v200, v199
s_waitcnt vmcnt(5)
v_mfma_f32_16x16x32_bf16 v[152:155], v[18:21], v[12:15], v[152:155]
ds_read_b128 v[244:247], v248 offset:36096
ds_read_u16_d16 v184, v184
ds_read_u16_d16 v186, v186
v_lshrrev_b32 v185, 18, v185
v_pk_mul_f16 v196, v197, v196
v_mfma_f32_16x16x32_bf16 v[156:159], v[16:19], v[12:15], v[156:159]
v_lshrrev_b32_e64 v187, 18, v187
v_mfma_f32_16x16x32_bf16 v[172:175], v[216:219], v[96:99], 0
ds_read_u16_d16_hi v185, v185
ds_read_u16_d16_hi v187, v187
v_exp_f16 v201, v202
v_and_b32 v189, s49, v189
v_mfma_f32_16x16x32_bf16 v[180:183], v[216:219], v[100:103], 0
v_and_b32 v191, s49, v191
s_waitcnt lgkmcnt(6)
v_mfma_f32_16x16x32_f16 v[68:71], v[220:223], v[232:235], v[68:71]
ds_read_b128 v[216:219], v248 offset:36864
v_exp_f16_e64 v198, v199
v_bfe_u32 v188, v189, 2, 14
v_mfma_f32_16x16x32_f16 v[76:79], v[220:223], v[236:239], v[76:79]
v_bfe_u32 v190, v191, 2, 14
v_exp_f16_e64 v195, v196
v_mfma_f32_16x16x32_bf16 v[168:171], v[224:227], v[104:107], v[168:171]
ds_read_b128 v[220:223], v248 offset:37120
ds_read_u16_d16 v188, v188
ds_read_u16_d16 v190, v190
v_lshrrev_b32 v189, 18, v189
v_lshrrev_b32 v191, 18, v191
v_mfma_f32_16x16x32_bf16 v[176:179], v[224:227], v[108:111], v[176:179]
v_exp_f16_sdwa v201, v202 dst_sel:WORD_1 dst_unused:UNUSED_PRESERVE src0_sel:WORD_1
v_mfma_f32_16x16x32_f16 v[80:83], v[228:231], v[232:235], v[80:83]
ds_read_b128 v[224:227], v249 offset:36864
ds_read_u16_d16_hi v189, v189
ds_read_u16_d16_hi v191, v191
v_and_b32 v193, s49, v193
v_bfe_u32 v192, v193, 2, 14
v_mfma_f32_16x16x32_f16 v[88:91], v[228:231], v[236:239], v[88:91]
v_exp_f16_sdwa v198, v199 dst_sel:WORD_1 dst_unused:UNUSED_PRESERVE src0_sel:WORD_1
s_waitcnt lgkmcnt(7)
v_mfma_f32_16x16x32_f16 v[84:87], v[240:243], v[232:235], v[84:87]
ds_read_b128 v[228:231], v249 offset:37120
ds_read_u16_d16 v192, v192
v_lshrrev_b32_e64 v193, 18, v193
v_mfma_f32_16x16x32_f16 v[92:95], v[240:243], v[236:239], v[92:95]
v_exp_f16_sdwa v195, v196 dst_sel:WORD_1 dst_unused:UNUSED_PRESERVE src0_sel:WORD_1
v_pk_add_f16 v201, v201, 1.0 op_sel_hi:[1,0]
v_pk_add_f16 v198, v198, 1.0 op_sel_hi:[1,0]
v_mfma_f32_16x16x32_bf16 v[172:175], v[244:247], v[104:107], v[172:175]
ds_read_b128 v[240:243], v248 offset:40960
ds_read_u16_d16_hi v193, v193
v_pk_add_f16 v195, v195, 1.0 op_sel_hi:[1,0]
v_mfma_f32_16x16x32_bf16 v[180:183], v[244:247], v[108:111], v[180:183]
v_rcp_f16 v202, v201
s_waitcnt lgkmcnt(7)
v_mfma_f32_16x16x32_bf16 v[168:171], v[216:219], v[112:115], v[168:171]
ds_read_b128 v[244:247], v249 offset:37888
v_rcp_f16_e64 v199, v198
v_mfma_f32_16x16x32_bf16 v[176:179], v[216:219], v[116:119], v[176:179]
v_rcp_f16_e64 v196, v195
v_mfma_f32_16x16x32_bf16 v[172:175], v[220:223], v[112:115], v[172:175]
ds_read_b128 v[216:219], v248 offset:41216
v_rcp_f16_sdwa v202, v201 dst_sel:WORD_1 dst_unused:UNUSED_PRESERVE src0_sel:WORD_1
v_mfma_f32_16x16x32_bf16 v[180:183], v[220:223], v[116:119], v[180:183]
v_rcp_f16_sdwa v199, v198 dst_sel:WORD_1 dst_unused:UNUSED_PRESERVE src0_sel:WORD_1
v_or_b32 v232, v184, v185
v_or_b32 v233, v186, v187
s_waitcnt lgkmcnt(4)
v_or_b32 v234, v188, v189
v_rcp_f16_sdwa v196, v195 dst_sel:WORD_1 dst_unused:UNUSED_PRESERVE src0_sel:WORD_1
v_or_b32 v235, v190, v191
s_waitcnt lgkmcnt(2)
v_or_b32_e64 v236, v192, v193
v_pk_mul_f16 v237, v203, v202
v_pk_mul_f16 v238, v200, v199
v_pk_mul_f16 v239, v197, v196
v_mfma_f32_16x16x32_f16 v[48:51], v[224:227], v[232:235], v[48:51]
buffer_load_dwordx4 v[12:15], v252, s[4:7], s69 offen
ds_read_b128 v[220:223], v249 offset:38144
v_cvt_pkrtz_f16_f32 v185, v168, v169
v_cvt_pkrtz_f16_f32 v187, v170, v171
v_cvt_pkrtz_f16_f32 v189, v172, v173
v_mfma_f32_16x16x32_f16 v[56:59], v[224:227], v[236:239], v[56:59]
v_cvt_pkrtz_f16_f32 v191, v174, v175
v_cvt_pkrtz_f16_f32 v193, v176, v177
v_cvt_pk_f16_f32 v203, v178, v179
v_mfma_f32_16x16x32_f16 v[52:55], v[228:231], v[232:235], v[52:55]
ds_read_b128 v[224:227], v248 offset:41984
v_cvt_pk_f16_f32 v200, v180, v181
v_cvt_pk_f16_f32 v197, v182, v183
v_pk_fma_f16 v202, v203, v203, s48
v_cvt_pk_bf16_f32 v136, v136, v137
v_mfma_f32_16x16x32_f16 v[60:63], v[228:231], v[236:239], v[60:63]
v_and_b32_e64 v185, s49, v185
v_cvt_pk_bf16_f32 v137, v138, v139
v_pk_fma_f16 v199, v200, v200, s48
v_mfma_f32_16x16x32_bf16 v[168:171], v[240:243], v[96:99], 0
ds_read_b128 v[228:231], v249 offset:38912
v_and_b32_e64 v187, s49, v187
v_cvt_pk_bf16_f32 v138, v140, v141
v_pk_fma_f16 v196, v197, v197, s48
v_mfma_f32_16x16x32_bf16 v[176:179], v[240:243], v[100:103], 0
v_cvt_pk_bf16_f32 v139, v142, v143
v_bfe_u32 v184, v185, 2, 14
s_setprio 2
v_pk_mul_f16 v202, v203, v202
v_cvt_pk_bf16_f32 v120, v120, v121
s_waitcnt lgkmcnt(2)
v_mfma_f32_16x16x32_f16 v[64:67], v[244:247], v[232:235], v[64:67]
ds_read_b128 v[240:243], v249 offset:39168
ds_read_u16_d16 v184, v184
v_bfe_u32 v186, v187, 2, 14
v_cvt_pk_bf16_f32 v121, v122, v123
v_pk_mul_f16 v199, v200, v199
v_mfma_f32_16x16x32_f16 v[72:75], v[244:247], v[236:239], v[72:75]
v_lshrrev_b32_e64 v185, 18, v185
v_cvt_pk_bf16_f32 v122, v124, v125
v_pk_mul_f16 v196, v197, v196
v_mfma_f32_16x16x32_bf16 v[172:175], v[216:219], v[96:99], 0
ds_read_b128 v[244:247], v248 offset:42240
ds_read_u16_d16 v186, v186
ds_read_u16_d16_hi v185, v185
v_lshrrev_b32_e64 v187, 18, v187
v_cvt_pk_bf16_f32 v123, v126, v127
v_exp_f16_e64 v201, v202
v_mfma_f32_16x16x32_bf16 v[180:183], v[216:219], v[100:103], 0
v_cvt_pk_bf16_f32 v152, v152, v153
v_and_b32_e64 v189, s49, v189
v_cvt_pk_bf16_f32 v153, v154, v155
v_mfma_f32_16x16x32_f16 v[68:71], v[220:223], v[232:235], v[68:71]
ds_read_b128 v[216:219], v248 offset:43008
ds_read_u16_d16_hi v187, v187
v_and_b32_e64 v191, s49, v191
v_cvt_pk_bf16_f32 v154, v156, v157
v_mfma_f32_16x16x32_f16 v[76:79], v[220:223], v[236:239], v[76:79]
v_exp_f16_e64 v198, v199
v_cvt_pk_bf16_f32 v155, v158, v159
s_mov_b64 vcc, s[74:75]
v_bfe_u32 v188, v189, 2, 14
v_bfe_u32 v190, v191, 2, 14
s_waitcnt lgkmcnt(5)
v_mfma_f32_16x16x32_bf16 v[168:171], v[224:227], v[104:107], v[168:171]
ds_read_b128 v[220:223], v248 offset:43264
ds_read_u16_d16 v188, v188
ds_read_u16_d16 v190, v190
v_cndmask_b32 v140, v120, v152, vcc
v_exp_f16 v195, v196
v_mfma_f32_16x16x32_bf16 v[176:179], v[224:227], v[108:111], v[176:179]
v_cndmask_b32 v141, v121, v153, vcc
v_lshrrev_b32_e64 v189, 18, v189
v_cndmask_b32 v142, v122, v154, vcc
v_mfma_f32_16x16x32_f16 v[80:83], v[228:231], v[232:235], v[80:83]
ds_read_b128 v[224:227], v249 offset:43008
ds_read_u16_d16_hi v189, v189
v_lshrrev_b32 v191, 18, v191
v_cndmask_b32 v143, v123, v155, vcc
v_exp_f16_sdwa v201, v202 dst_sel:WORD_1 dst_unused:UNUSED_PRESERVE src0_sel:WORD_1
v_mfma_f32_16x16x32_f16 v[88:91], v[228:231], v[236:239], v[88:91]
v_cndmask_b32_dpp v120, v136, v120, vcc quad_perm:[1,0,3,2] row_mask:0xf bank_mask:0xf
v_and_b32_e64 v193, s49, v193
v_cndmask_b32_dpp v121, v137, v121, vcc quad_perm:[1,0,3,2] row_mask:0xf bank_mask:0xf
v_mfma_f32_16x16x32_f16 v[84:87], v[240:243], v[232:235], v[84:87]
ds_read_b128 v[228:231], v249 offset:43264
ds_read_u16_d16_hi v191, v191
v_bfe_u32 v192, v193, 2, 14
v_exp_f16_sdwa v198, v199 dst_sel:WORD_1 dst_unused:UNUSED_PRESERVE src0_sel:WORD_1
v_mfma_f32_16x16x32_f16 v[92:95], v[240:243], v[236:239], v[92:95]
v_cndmask_b32_dpp v122, v138, v122, vcc quad_perm:[1,0,3,2] row_mask:0xf bank_mask:0xf
v_lshrrev_b32_e64 v193, 18, v193
v_cndmask_b32_dpp v123, v139, v123, vcc quad_perm:[1,0,3,2] row_mask:0xf bank_mask:0xf
s_not_b64 vcc, s[74:75]
s_waitcnt lgkmcnt(4)
v_mfma_f32_16x16x32_bf16 v[172:175], v[244:247], v[104:107], v[172:175]
ds_read_b128 v[240:243], v248 offset:47104
ds_read_u16_d16 v192, v192
ds_read_u16_d16_hi v193, v193
v_exp_f16_sdwa v195, v196 dst_sel:WORD_1 dst_unused:UNUSED_PRESERVE src0_sel:WORD_1
v_cndmask_b32_dpp v152, v136, v152, vcc quad_perm:[1,0,3,2] row_mask:0xf bank_mask:0xf
v_pk_add_f16 v201, v201, 1.0 op_sel_hi:[1,0]
v_mfma_f32_16x16x32_bf16 v[180:183], v[244:247], v[108:111], v[180:183]
v_cndmask_b32_dpp v153, v137, v153, vcc quad_perm:[1,0,3,2] row_mask:0xf bank_mask:0xf
v_pk_add_f16 v198, v198, 1.0 op_sel_hi:[1,0]
v_cndmask_b32_dpp v154, v138, v154, vcc quad_perm:[1,0,3,2] row_mask:0xf bank_mask:0xf
v_mfma_f32_16x16x32_bf16 v[168:171], v[216:219], v[112:115], v[168:171]
ds_read_b128 v[244:247], v249 offset:44032
v_pk_add_f16 v195, v195, 1.0 op_sel_hi:[1,0]
v_rcp_f16_e64 v202, v201
v_cndmask_b32_dpp v155, v139, v155, vcc quad_perm:[1,0,3,2] row_mask:0xf bank_mask:0xf
v_mfma_f32_16x16x32_bf16 v[176:179], v[216:219], v[116:119], v[176:179]
v_rcp_f16_e64 v199, v198
v_mfma_f32_16x16x32_bf16 v[172:175], v[220:223], v[112:115], v[172:175]
ds_read_b128 v[216:219], v248 offset:47360
buffer_store_dwordx4 v[120:123], v255, s[8:11], s68 offen sc1
v_rcp_f16_e64 v196, v195
v_rcp_f16_sdwa v202, v201 dst_sel:WORD_1 dst_unused:UNUSED_PRESERVE src0_sel:WORD_1
v_mfma_f32_16x16x32_bf16 v[180:183], v[220:223], v[116:119], v[180:183]
v_rcp_f16_sdwa v199, v198 dst_sel:WORD_1 dst_unused:UNUSED_PRESERVE src0_sel:WORD_1
v_or_b32 v232, v184, v185
v_or_b32 v233, v186, v187
s_waitcnt lgkmcnt(3)
v_or_b32 v234, v188, v189
v_rcp_f16_sdwa v196, v195 dst_sel:WORD_1 dst_unused:UNUSED_PRESERVE src0_sel:WORD_1
v_or_b32 v235, v190, v191
s_waitcnt lgkmcnt(2)
v_or_b32_e64 v236, v192, v193
v_pk_mul_f16 v237, v203, v202
v_pk_mul_f16 v238, v200, v199
v_pk_mul_f16 v239, v197, v196
v_mfma_f32_16x16x32_f16 v[48:51], v[224:227], v[232:235], v[48:51]
buffer_load_dwordx4 v[204:207], v252, s[4:7], s69 offen offset:64
ds_read_b128 v[220:223], v249 offset:44288
v_cvt_pkrtz_f16_f32 v185, v168, v169
v_cvt_pkrtz_f16_f32 v187, v170, v171
v_mfma_f32_16x16x32_f16 v[56:59], v[224:227], v[236:239], v[56:59]
v_cvt_pkrtz_f16_f32 v189, v172, v173
v_cvt_pkrtz_f16_f32 v191, v174, v175
v_mfma_f32_16x16x32_f16 v[52:55], v[228:231], v[232:235], v[52:55]
ds_read_b128 v[224:227], v248 offset:48128
v_cvt_pkrtz_f16_f32 v193, v176, v177
v_cvt_pk_f16_f32 v203, v178, v179
v_mfma_f32_16x16x32_f16 v[60:63], v[228:231], v[236:239], v[60:63]
v_cvt_pk_f16_f32 v200, v180, v181
v_cvt_pk_f16_f32 v197, v182, v183
s_setprio 1
v_mfma_f32_16x16x32_bf16 v[168:171], v[240:243], v[96:99], 0
ds_read_b128 v[228:231], v249 offset:45056
v_pk_fma_f16 v202, v203, v203, s48
v_and_b32 v185, s49, v185
v_mfma_f32_16x16x32_bf16 v[176:179], v[240:243], v[100:103], 0
v_pk_fma_f16 v199, v200, v200, s48
v_and_b32 v187, s49, v187
s_waitcnt lgkmcnt(3)
v_mfma_f32_16x16x32_f16 v[64:67], v[244:247], v[232:235], v[64:67]
ds_read_b128 v[240:243], v249 offset:45312
v_pk_fma_f16 v196, v197, v197, s48
v_bfe_u32 v184, v185, 2, 14
v_pk_mul_f16 v202, v203, v202
v_mfma_f32_16x16x32_f16 v[72:75], v[244:247], v[236:239], v[72:75]
v_bfe_u32 v186, v187, 2, 14
v_pk_mul_f16 v199, v200, v199
s_waitcnt vmcnt(7)
v_mfma_f32_16x16x32_bf16 v[128:131], v[18:21], v[8:11], v[128:131]
ds_read_b128 v[244:247], v248 offset:48384
ds_read_u16_d16 v184, v184
ds_read_u16_d16 v186, v186
v_lshrrev_b32 v185, 18, v185
v_pk_mul_f16 v196, v197, v196
v_mfma_f32_16x16x32_bf16 v[132:135], v[16:19], v[8:11], v[132:135]
v_lshrrev_b32_e64 v187, 18, v187
v_mfma_f32_16x16x32_bf16 v[172:175], v[216:219], v[96:99], 0
ds_read_u16_d16_hi v185, v185
ds_read_u16_d16_hi v187, v187
v_exp_f16 v201, v202
v_and_b32 v189, s49, v189
v_mfma_f32_16x16x32_bf16 v[180:183], v[216:219], v[100:103], 0
v_and_b32 v191, s49, v191
s_waitcnt lgkmcnt(6)
v_mfma_f32_16x16x32_f16 v[68:71], v[220:223], v[232:235], v[68:71]
ds_read_b128 v[216:219], v248 offset:49152
v_exp_f16_e64 v198, v199
v_bfe_u32 v188, v189, 2, 14
v_mfma_f32_16x16x32_f16 v[76:79], v[220:223], v[236:239], v[76:79]
v_bfe_u32 v190, v191, 2, 14
v_exp_f16_e64 v195, v196
v_mfma_f32_16x16x32_bf16 v[168:171], v[224:227], v[104:107], v[168:171]
buffer_store_dwordx4 v[140:143], v255, s[8:11], s68 offen offset:128 sc1
ds_read_b128 v[220:223], v248 offset:49408
ds_read_u16_d16 v188, v188
ds_read_u16_d16 v190, v190
v_lshrrev_b32 v189, 18, v189
v_lshrrev_b32 v191, 18, v191
v_mfma_f32_16x16x32_bf16 v[176:179], v[224:227], v[108:111], v[176:179]
v_exp_f16_sdwa v201, v202 dst_sel:WORD_1 dst_unused:UNUSED_PRESERVE src0_sel:WORD_1
v_mfma_f32_16x16x32_f16 v[80:83], v[228:231], v[232:235], v[80:83]
ds_read_b128 v[224:227], v249 offset:49152
ds_read_u16_d16_hi v189, v189
ds_read_u16_d16_hi v191, v191
v_and_b32 v193, s49, v193
v_bfe_u32 v192, v193, 2, 14
v_mfma_f32_16x16x32_f16 v[88:91], v[228:231], v[236:239], v[88:91]
v_exp_f16_sdwa v198, v199 dst_sel:WORD_1 dst_unused:UNUSED_PRESERVE src0_sel:WORD_1
s_waitcnt lgkmcnt(7)
v_mfma_f32_16x16x32_f16 v[84:87], v[240:243], v[232:235], v[84:87]
ds_read_b128 v[228:231], v249 offset:49408
ds_read_u16_d16 v192, v192
v_lshrrev_b32_e64 v193, 18, v193
v_mfma_f32_16x16x32_f16 v[92:95], v[240:243], v[236:239], v[92:95]
v_exp_f16_sdwa v195, v196 dst_sel:WORD_1 dst_unused:UNUSED_PRESERVE src0_sel:WORD_1
v_pk_add_f16 v201, v201, 1.0 op_sel_hi:[1,0]
v_pk_add_f16 v198, v198, 1.0 op_sel_hi:[1,0]
v_mfma_f32_16x16x32_bf16 v[172:175], v[244:247], v[104:107], v[172:175]
ds_read_b128 v[240:243], v248 offset:53248
ds_read_u16_d16_hi v193, v193
v_pk_add_f16 v195, v195, 1.0 op_sel_hi:[1,0]
v_mfma_f32_16x16x32_bf16 v[180:183], v[244:247], v[108:111], v[180:183]
v_rcp_f16_e64 v202, v201
s_setprio 0
s_waitcnt lgkmcnt(7)
v_mfma_f32_16x16x32_bf16 v[168:171], v[216:219], v[112:115], v[168:171]
ds_read_b128 v[244:247], v249 offset:50176
v_rcp_f16_e64 v199, v198
v_mfma_f32_16x16x32_bf16 v[176:179], v[216:219], v[116:119], v[176:179]
v_rcp_f16_e64 v196, v195
v_mfma_f32_16x16x32_bf16 v[172:175], v[220:223], v[112:115], v[172:175]
ds_read_b128 v[216:219], v248 offset:53504
v_rcp_f16_sdwa v202, v201 dst_sel:WORD_1 dst_unused:UNUSED_PRESERVE src0_sel:WORD_1
v_mfma_f32_16x16x32_bf16 v[180:183], v[220:223], v[116:119], v[180:183]
v_rcp_f16_sdwa v199, v198 dst_sel:WORD_1 dst_unused:UNUSED_PRESERVE src0_sel:WORD_1
v_or_b32 v232, v184, v185
v_or_b32 v233, v186, v187
s_waitcnt lgkmcnt(4)
v_or_b32 v234, v188, v189
v_rcp_f16_sdwa v196, v195 dst_sel:WORD_1 dst_unused:UNUSED_PRESERVE src0_sel:WORD_1
v_or_b32 v235, v190, v191
s_waitcnt lgkmcnt(2)
v_or_b32 v236, v192, v193
v_pk_mul_f16 v237, v203, v202
v_pk_mul_f16 v238, v200, v199
v_pk_mul_f16 v239, v197, v196
s_setprio 3
v_mfma_f32_16x16x32_f16 v[48:51], v[224:227], v[232:235], v[48:51]
buffer_load_dwordx4 v[8:11], v252, s[4:7], s69 offen offset:128
ds_read_b128 v[220:223], v249 offset:50432
v_cvt_pkrtz_f16_f32 v185, v168, v169
v_cvt_pkrtz_f16_f32 v187, v170, v171
v_mfma_f32_16x16x32_f16 v[56:59], v[224:227], v[236:239], v[56:59]
v_cvt_pkrtz_f16_f32 v189, v172, v173
v_cvt_pkrtz_f16_f32 v191, v174, v175
v_mfma_f32_16x16x32_f16 v[52:55], v[228:231], v[232:235], v[52:55]
ds_read_b128 v[224:227], v248 offset:54272
v_cvt_pkrtz_f16_f32 v193, v176, v177
v_cvt_pk_f16_f32 v203, v178, v179
v_mfma_f32_16x16x32_f16 v[60:63], v[228:231], v[236:239], v[60:63]
v_cvt_pk_f16_f32 v200, v180, v181
v_cvt_pk_f16_f32 v197, v182, v183
v_mfma_f32_16x16x32_bf16 v[168:171], v[240:243], v[96:99], 0
ds_read_b128 v[228:231], v249 offset:51200
v_pk_fma_f16 v202, v203, v203, s48
v_and_b32_e64 v185, s49, v185
v_mfma_f32_16x16x32_bf16 v[176:179], v[240:243], v[100:103], 0
v_pk_fma_f16 v199, v200, v200, s48
v_and_b32 v187, s49, v187
s_waitcnt lgkmcnt(3)
v_mfma_f32_16x16x32_f16 v[64:67], v[244:247], v[232:235], v[64:67]
ds_read_b128 v[240:243], v249 offset:51456
v_pk_fma_f16 v196, v197, v197, s48
v_bfe_u32 v184, v185, 2, 14
v_pk_mul_f16 v202, v203, v202
v_mfma_f32_16x16x32_f16 v[72:75], v[244:247], v[236:239], v[72:75]
v_bfe_u32 v186, v187, 2, 14
v_pk_mul_f16 v199, v200, v199
s_waitcnt vmcnt(7)
v_mfma_f32_16x16x32_bf16 v[144:147], v[18:21], v[44:47], v[144:147]
ds_read_b128 v[244:247], v248 offset:54528
ds_read_u16_d16 v184, v184
ds_read_u16_d16 v186, v186
v_lshrrev_b32 v185, 18, v185
v_pk_mul_f16 v196, v197, v196
v_mfma_f32_16x16x32_bf16 v[148:151], v[16:19], v[44:47], v[148:151]
v_lshrrev_b32_e64 v187, 18, v187
v_mfma_f32_16x16x32_bf16 v[172:175], v[216:219], v[96:99], 0
ds_read_u16_d16_hi v185, v185
ds_read_u16_d16_hi v187, v187
v_exp_f16 v201, v202
v_and_b32 v189, s49, v189
v_mfma_f32_16x16x32_bf16 v[180:183], v[216:219], v[100:103], 0
v_and_b32 v191, s49, v191
s_waitcnt lgkmcnt(6)
v_mfma_f32_16x16x32_f16 v[68:71], v[220:223], v[232:235], v[68:71]
ds_read_b128 v[216:219], v248 offset:55296
v_exp_f16_e64 v198, v199
v_bfe_u32 v188, v189, 2, 14
v_mfma_f32_16x16x32_f16 v[76:79], v[220:223], v[236:239], v[76:79]
v_bfe_u32 v190, v191, 2, 14
v_exp_f16_e64 v195, v196
v_mfma_f32_16x16x32_bf16 v[168:171], v[224:227], v[104:107], v[168:171]
ds_read_b128 v[220:223], v248 offset:55552
ds_read_u16_d16 v188, v188
ds_read_u16_d16 v190, v190
v_lshrrev_b32 v189, 18, v189
v_lshrrev_b32 v191, 18, v191
v_mfma_f32_16x16x32_bf16 v[176:179], v[224:227], v[108:111], v[176:179]
v_exp_f16_sdwa v201, v202 dst_sel:WORD_1 dst_unused:UNUSED_PRESERVE src0_sel:WORD_1
v_mfma_f32_16x16x32_f16 v[80:83], v[228:231], v[232:235], v[80:83]
ds_read_b128 v[224:227], v249 offset:55296
ds_read_u16_d16_hi v189, v189
ds_read_u16_d16_hi v191, v191
v_and_b32 v193, s49, v193
v_bfe_u32 v192, v193, 2, 14
v_mfma_f32_16x16x32_f16 v[88:91], v[228:231], v[236:239], v[88:91]
v_exp_f16_sdwa v198, v199 dst_sel:WORD_1 dst_unused:UNUSED_PRESERVE src0_sel:WORD_1
s_waitcnt lgkmcnt(7)
v_mfma_f32_16x16x32_f16 v[84:87], v[240:243], v[232:235], v[84:87]
ds_read_b128 v[228:231], v249 offset:55552
ds_read_u16_d16 v192, v192
v_lshrrev_b32_e64 v193, 18, v193
v_mfma_f32_16x16x32_f16 v[92:95], v[240:243], v[236:239], v[92:95]
v_exp_f16_sdwa v195, v196 dst_sel:WORD_1 dst_unused:UNUSED_PRESERVE src0_sel:WORD_1
v_pk_add_f16 v201, v201, 1.0 op_sel_hi:[1,0]
v_pk_add_f16 v198, v198, 1.0 op_sel_hi:[1,0]
v_mfma_f32_16x16x32_bf16 v[172:175], v[244:247], v[104:107], v[172:175]
ds_read_b128 v[240:243], v248 offset:59392
ds_read_u16_d16_hi v193, v193
v_pk_add_f16 v195, v195, 1.0 op_sel_hi:[1,0]
v_mfma_f32_16x16x32_bf16 v[180:183], v[244:247], v[108:111], v[180:183]
v_rcp_f16 v202, v201
s_waitcnt lgkmcnt(7)
v_mfma_f32_16x16x32_bf16 v[168:171], v[216:219], v[112:115], v[168:171]
ds_read_b128 v[244:247], v249 offset:56320
v_rcp_f16_e64 v199, v198
v_mfma_f32_16x16x32_bf16 v[176:179], v[216:219], v[116:119], v[176:179]
v_rcp_f16_e64 v196, v195
v_mfma_f32_16x16x32_bf16 v[172:175], v[220:223], v[112:115], v[172:175]
ds_read_b128 v[216:219], v248 offset:59648
v_rcp_f16_sdwa v202, v201 dst_sel:WORD_1 dst_unused:UNUSED_PRESERVE src0_sel:WORD_1
v_mfma_f32_16x16x32_bf16 v[180:183], v[220:223], v[116:119], v[180:183]
v_rcp_f16_sdwa v199, v198 dst_sel:WORD_1 dst_unused:UNUSED_PRESERVE src0_sel:WORD_1
v_or_b32 v232, v184, v185
v_or_b32 v233, v186, v187
s_waitcnt lgkmcnt(4)
v_or_b32 v234, v188, v189
v_rcp_f16_sdwa v196, v195 dst_sel:WORD_1 dst_unused:UNUSED_PRESERVE src0_sel:WORD_1
v_or_b32 v235, v190, v191
s_waitcnt lgkmcnt(2)
v_or_b32_e64 v236, v192, v193
v_pk_mul_f16 v237, v203, v202
v_pk_mul_f16 v238, v200, v199
v_pk_mul_f16 v239, v197, v196
v_mfma_f32_16x16x32_f16 v[48:51], v[224:227], v[232:235], v[48:51]
s_add_u32 s46, s69, 98304
buffer_load_dwordx4 v[44:47], v252, s[4:7], s46 offen
ds_read_b128 v[220:223], v249 offset:56576
v_cvt_pkrtz_f16_f32 v185, v168, v169
v_cvt_pkrtz_f16_f32 v187, v170, v171
v_mfma_f32_16x16x32_f16 v[56:59], v[224:227], v[236:239], v[56:59]
v_cvt_pkrtz_f16_f32 v189, v172, v173
v_cvt_pkrtz_f16_f32 v191, v174, v175
v_mfma_f32_16x16x32_f16 v[52:55], v[228:231], v[232:235], v[52:55]
ds_read_b128 v[224:227], v248 offset:60416
v_cvt_pkrtz_f16_f32 v193, v176, v177
v_cvt_pk_f16_f32 v203, v178, v179
v_cvt_pk_f16_f32 v200, v180, v181
v_mfma_f32_16x16x32_f16 v[60:63], v[228:231], v[236:239], v[60:63]
v_cvt_pk_f16_f32 v197, v182, v183
v_pk_fma_f16 v202, v203, v203, s48
v_mfma_f32_16x16x32_bf16 v[168:171], v[240:243], v[96:99], 0
ds_read_b128 v[228:231], v249 offset:57344
v_and_b32_e64 v185, s49, v185
v_pk_fma_f16 v199, v200, v200, s48
v_mfma_f32_16x16x32_bf16 v[176:179], v[240:243], v[100:103], 0
v_and_b32_e64 v187, s49, v187
v_pk_fma_f16 v196, v197, v197, s48
s_setprio 2
v_bfe_u32 v184, v185, 2, 14
s_waitcnt lgkmcnt(3)
v_mfma_f32_16x16x32_f16 v[64:67], v[244:247], v[232:235], v[64:67]
ds_read_b128 v[240:243], v249 offset:57600
ds_read_u16_d16 v184, v184
v_pk_mul_f16 v202, v203, v202
v_bfe_u32 v186, v187, 2, 14
v_mfma_f32_16x16x32_f16 v[72:75], v[244:247], v[236:239], v[72:75]
v_pk_mul_f16 v199, v200, v199
v_lshrrev_b32_e64 v185, 18, v185
v_mfma_f32_16x16x32_bf16 v[172:175], v[216:219], v[96:99], 0
ds_read_b128 v[244:247], v248 offset:60672
ds_read_u16_d16 v186, v186
ds_read_u16_d16_hi v185, v185
v_pk_mul_f16 v196, v197, v196
v_lshrrev_b32_e64 v187, 18, v187
v_mfma_f32_16x16x32_bf16 v[180:183], v[216:219], v[100:103], 0
v_exp_f16_e64 v201, v202
v_and_b32 v189, s49, v189
s_waitcnt lgkmcnt(5)
v_mfma_f32_16x16x32_f16 v[68:71], v[220:223], v[232:235], v[68:71]
ds_read_b128 v[216:219], v248 offset:61440
ds_read_u16_d16_hi v187, v187
v_and_b32_e64 v191, s49, v191
v_mfma_f32_16x16x32_f16 v[76:79], v[220:223], v[236:239], v[76:79]
v_exp_f16_e64 v198, v199
v_bfe_u32 v188, v189, 2, 14
v_bfe_u32 v190, v191, 2, 14
v_mfma_f32_16x16x32_bf16 v[168:171], v[224:227], v[104:107], v[168:171]
buffer_store_dwordx4 v[152:155], v255, s[8:11], s68 offen offset:256 sc1
ds_read_b128 v[220:223], v248 offset:61696
ds_read_u16_d16 v188, v188
ds_read_u16_d16 v190, v190
v_exp_f16_e64 v195, v196
v_mfma_f32_16x16x32_bf16 v[176:179], v[224:227], v[108:111], v[176:179]
v_lshrrev_b32 v189, 18, v189
v_lshrrev_b32 v191, 18, v191
v_mfma_f32_16x16x32_f16 v[80:83], v[228:231], v[232:235], v[80:83]
ds_read_b128 v[224:227], v249 offset:61440
ds_read_u16_d16_hi v189, v189
ds_read_u16_d16_hi v191, v191
v_exp_f16_sdwa v201, v202 dst_sel:WORD_1 dst_unused:UNUSED_PRESERVE src0_sel:WORD_1
v_and_b32 v193, s49, v193
v_mfma_f32_16x16x32_f16 v[88:91], v[228:231], v[236:239], v[88:91]
v_bfe_u32 v192, v193, 2, 14
s_waitcnt lgkmcnt(8)
v_mfma_f32_16x16x32_f16 v[84:87], v[240:243], v[232:235], v[84:87]
ds_read_b128 v[228:231], v249 offset:61696
ds_read_u16_d16 v192, v192
v_exp_f16_sdwa v198, v199 dst_sel:WORD_1 dst_unused:UNUSED_PRESERVE src0_sel:WORD_1
v_lshrrev_b32_e64 v193, 18, v193
v_mfma_f32_16x16x32_f16 v[92:95], v[240:243], v[236:239], v[92:95]
v_exp_f16_sdwa v195, v196 dst_sel:WORD_1 dst_unused:UNUSED_PRESERVE src0_sel:WORD_1
v_pk_add_f16 v201, v201, 1.0 op_sel_hi:[1,0]
v_mfma_f32_16x16x32_bf16 v[172:175], v[244:247], v[104:107], v[172:175]
ds_read_b128 v[240:243], v249
ds_read_u16_d16_hi v193, v193
v_pk_add_f16 v198, v198, 1.0 op_sel_hi:[1,0]
v_pk_add_f16 v195, v195, 1.0 op_sel_hi:[1,0]
v_mfma_f32_16x16x32_bf16 v[180:183], v[244:247], v[108:111], v[180:183]
v_rcp_f16 v202, v201
s_waitcnt lgkmcnt(7)
v_mfma_f32_16x16x32_bf16 v[168:171], v[216:219], v[112:115], v[168:171]
ds_read_b128 v[244:247], v249 offset:62464
v_rcp_f16_e64 v199, v198
v_mfma_f32_16x16x32_bf16 v[176:179], v[216:219], v[116:119], v[176:179]
v_rcp_f16_e64 v196, v195
v_mfma_f32_16x16x32_bf16 v[172:175], v[220:223], v[112:115], v[172:175]
ds_read_b128 v[216:219], v249 offset:256
v_rcp_f16_sdwa v202, v201 dst_sel:WORD_1 dst_unused:UNUSED_PRESERVE src0_sel:WORD_1
v_mfma_f32_16x16x32_bf16 v[180:183], v[220:223], v[116:119], v[180:183]
v_rcp_f16_sdwa v199, v198 dst_sel:WORD_1 dst_unused:UNUSED_PRESERVE src0_sel:WORD_1
v_or_b32 v232, v184, v185
v_or_b32 v233, v186, v187
s_waitcnt lgkmcnt(4)
v_or_b32 v234, v188, v189
v_rcp_f16_sdwa v196, v195 dst_sel:WORD_1 dst_unused:UNUSED_PRESERVE src0_sel:WORD_1
v_or_b32 v235, v190, v191
s_waitcnt lgkmcnt(2)
v_or_b32_e64 v236, v192, v193
v_pk_mul_f16 v237, v203, v202
v_pk_mul_f16 v238, v200, v199
v_pk_mul_f16 v239, v197, v196
v_mfma_f32_16x16x32_f16 v[48:51], v[224:227], v[232:235], v[48:51]
s_add_u32 s46, s69, 98304
buffer_load_dwordx4 v[40:43], v252, s[4:7], s46 offen offset:64
ds_read_b128 v[220:223], v249 offset:62720
v_cvt_pkrtz_f16_f32 v185, v168, v169
v_cvt_pkrtz_f16_f32 v187, v170, v171
v_mfma_f32_16x16x32_f16 v[56:59], v[224:227], v[236:239], v[56:59]
v_cvt_pkrtz_f16_f32 v189, v172, v173
v_cvt_pkrtz_f16_f32 v191, v174, v175
v_mfma_f32_16x16x32_f16 v[52:55], v[228:231], v[232:235], v[52:55]
ds_read_b128 v[224:227], v249 offset:1024
v_cvt_pkrtz_f16_f32 v193, v176, v177
v_cvt_pk_f16_f32 v203, v178, v179
v_mfma_f32_16x16x32_f16 v[60:63], v[228:231], v[236:239], v[60:63]
v_cvt_pk_f16_f32 v200, v180, v181
v_cvt_pk_f16_f32 v197, v182, v183
s_setprio 1
v_mfma_f32_16x16x32_bf16 v[168:171], v[240:243], v[96:99], 0
ds_read_b128 v[228:231], v249 offset:63488
v_pk_fma_f16 v202, v203, v203, s48
v_and_b32 v185, s49, v185
v_mfma_f32_16x16x32_bf16 v[176:179], v[240:243], v[100:103], 0
v_pk_fma_f16 v199, v200, v200, s48
v_and_b32 v187, s49, v187
s_waitcnt lgkmcnt(3)
v_mfma_f32_16x16x32_f16 v[64:67], v[244:247], v[232:235], v[64:67]
ds_read_b128 v[240:243], v249 offset:63744
v_pk_fma_f16 v196, v197, v197, s48
v_bfe_u32 v184, v185, 2, 14
v_mfma_f32_16x16x32_f16 v[72:75], v[244:247], v[236:239], v[72:75]
v_pk_mul_f16 v202, v203, v202
v_bfe_u32 v186, v187, 2, 14
s_waitcnt vmcnt(8)
v_mfma_f32_16x16x32_bf16 v[160:163], v[18:21], v[208:211], v[160:163]
ds_read_b128 v[244:247], v249 offset:1280
ds_read_u16_d16 v184, v184
ds_read_u16_d16 v186, v186
v_pk_mul_f16 v199, v200, v199
v_lshrrev_b32 v185, 18, v185
v_mfma_f32_16x16x32_bf16 v[164:167], v[16:19], v[208:211], v[164:167]
v_pk_mul_f16 v196, v197, v196
v_lshrrev_b32_e64 v187, 18, v187
v_mfma_f32_16x16x32_bf16 v[172:175], v[216:219], v[96:99], 0
ds_read_u16_d16_hi v185, v185
ds_read_u16_d16_hi v187, v187
v_exp_f16_e64 v201, v202
v_mfma_f32_16x16x32_bf16 v[180:183], v[216:219], v[100:103], 0
v_and_b32_e64 v189, s49, v189
v_and_b32 v191, s49, v191
s_waitcnt lgkmcnt(6)
v_mfma_f32_16x16x32_f16 v[68:71], v[220:223], v[232:235], v[68:71]
ds_read_b128 v[216:219], v249 offset:2048
v_exp_f16_e64 v198, v199
v_mfma_f32_16x16x32_f16 v[76:79], v[220:223], v[236:239], v[76:79]
v_bfe_u32 v188, v189, 2, 14
v_bfe_u32 v190, v191, 2, 14
v_mfma_f32_16x16x32_bf16 v[168:171], v[224:227], v[104:107], v[168:171]
ds_read_b128 v[220:223], v249 offset:2304
ds_read_u16_d16 v188, v188
ds_read_u16_d16 v190, v190
v_exp_f16_e64 v195, v196
v_mfma_f32_16x16x32_bf16 v[176:179], v[224:227], v[108:111], v[176:179]
v_lshrrev_b32 v189, 18, v189
v_lshrrev_b32 v191, 18, v191
v_mfma_f32_16x16x32_f16 v[80:83], v[228:231], v[232:235], v[80:83]
ds_read_b128 v[224:227], v250 offset:2048
ds_read_u16_d16_hi v189, v189
ds_read_u16_d16_hi v191, v191
v_exp_f16_sdwa v201, v202 dst_sel:WORD_1 dst_unused:UNUSED_PRESERVE src0_sel:WORD_1
v_mfma_f32_16x16x32_f16 v[88:91], v[228:231], v[236:239], v[88:91]
v_and_b32 v193, s49, v193
v_bfe_u32 v192, v193, 2, 14
s_waitcnt lgkmcnt(7)
v_mfma_f32_16x16x32_f16 v[84:87], v[240:243], v[232:235], v[84:87]
ds_read_b128 v[228:231], v250 offset:2304
ds_read_u16_d16 v192, v192
v_exp_f16_sdwa v198, v199 dst_sel:WORD_1 dst_unused:UNUSED_PRESERVE src0_sel:WORD_1
v_mfma_f32_16x16x32_f16 v[92:95], v[240:243], v[236:239], v[92:95]
v_lshrrev_b32 v193, 18, v193
s_waitcnt vmcnt(7)
v_mfma_f32_16x16x32_bf16 v[48:51], v[18:21], v[12:15], v[48:51]
ds_read_b128 v[240:243], v249 offset:6144
ds_read_u16_d16_hi v193, v193
v_exp_f16_sdwa v195, v196 dst_sel:WORD_1 dst_unused:UNUSED_PRESERVE src0_sel:WORD_1
v_pk_add_f16 v201, v201, 1.0 op_sel_hi:[1,0]
v_mfma_f32_16x16x32_bf16 v[52:55], v[16:19], v[12:15], v[52:55]
v_pk_add_f16 v198, v198, 1.0 op_sel_hi:[1,0]
v_pk_add_f16 v195, v195, 1.0 op_sel_hi:[1,0]
v_mfma_f32_16x16x32_bf16 v[172:175], v[244:247], v[104:107], v[172:175]
v_rcp_f16 v202, v201
s_setprio 0
v_mfma_f32_16x16x32_bf16 v[180:183], v[244:247], v[108:111], v[180:183]
v_rcp_f16 v199, v198
s_waitcnt lgkmcnt(4)
v_mfma_f32_16x16x32_bf16 v[168:171], v[216:219], v[112:115], v[168:171]
ds_read_b128 v[244:247], v250 offset:3072
v_rcp_f16_e64 v196, v195
v_mfma_f32_16x16x32_bf16 v[176:179], v[216:219], v[116:119], v[176:179]
v_rcp_f16_sdwa v202, v201 dst_sel:WORD_1 dst_unused:UNUSED_PRESERVE src0_sel:WORD_1
v_mfma_f32_16x16x32_bf16 v[172:175], v[220:223], v[112:115], v[172:175]
ds_read_b128 v[216:219], v249 offset:6400
v_rcp_f16_sdwa v199, v198 dst_sel:WORD_1 dst_unused:UNUSED_PRESERVE src0_sel:WORD_1
v_mfma_f32_16x16x32_bf16 v[180:183], v[220:223], v[116:119], v[180:183]
v_or_b32 v232, v184, v185
v_or_b32 v233, v186, v187
v_or_b32_e64 v234, v188, v189
v_rcp_f16_sdwa v196, v195 dst_sel:WORD_1 dst_unused:UNUSED_PRESERVE src0_sel:WORD_1
v_or_b32 v235, v190, v191
s_waitcnt lgkmcnt(2)
v_or_b32_e64 v236, v192, v193
v_pk_mul_f16 v237, v203, v202
v_pk_mul_f16 v238, v200, v199
v_pk_mul_f16 v239, v197, v196
v_mfma_f32_16x16x32_f16 v[48:51], v[224:227], v[232:235], v[48:51]
s_add_u32 s46, s69, 98304
buffer_load_dwordx4 v[208:211], v252, s[4:7], s46 offen offset:128
ds_read_b128 v[220:223], v250 offset:3328
v_cvt_pkrtz_f16_f32 v185, v168, v169
v_cvt_pkrtz_f16_f32 v187, v170, v171
v_cvt_pkrtz_f16_f32 v189, v172, v173
v_mfma_f32_16x16x32_f16 v[56:59], v[224:227], v[236:239], v[56:59]
v_cvt_pkrtz_f16_f32 v191, v174, v175
v_cvt_pkrtz_f16_f32 v193, v176, v177
v_cvt_pk_f16_f32 v203, v178, v179
v_mfma_f32_16x16x32_f16 v[52:55], v[228:231], v[232:235], v[52:55]
ds_read_b128 v[224:227], v249 offset:7168
v_cvt_pk_f16_f32 v200, v180, v181
v_cvt_pk_f16_f32 v197, v182, v183
v_pk_fma_f16 v202, v203, v203, s48
v_mfma_f32_16x16x32_f16 v[60:63], v[228:231], v[236:239], v[60:63]
v_cvt_pk_bf16_f32 v144, v144, v145
v_and_b32_e64 v185, s49, v185
v_cvt_pk_bf16_f32 v145, v146, v147
v_mfma_f32_16x16x32_bf16 v[168:171], v[240:243], v[96:99], 0
ds_read_b128 v[228:231], v250 offset:4096
v_pk_fma_f16 v199, v200, v200, s48
v_and_b32 v187, s49, v187
v_cvt_pk_bf16_f32 v146, v148, v149
v_mfma_f32_16x16x32_bf16 v[176:179], v[240:243], v[100:103], 0
v_pk_fma_f16 v196, v197, v197, s48
v_cvt_pk_bf16_f32 v147, v150, v151
v_bfe_u32 v184, v185, 2, 14
s_waitcnt lgkmcnt(2)
v_mfma_f32_16x16x32_f16 v[64:67], v[244:247], v[232:235], v[64:67]
ds_read_b128 v[240:243], v250 offset:4352
ds_read_u16_d16 v184, v184
v_pk_mul_f16 v202, v203, v202
v_cvt_pk_bf16_f32 v128, v128, v129
v_bfe_u32 v186, v187, 2, 14
v_mfma_f32_16x16x32_f16 v[72:75], v[244:247], v[236:239], v[72:75]
v_cvt_pk_bf16_f32 v129, v130, v131
v_pk_mul_f16 v199, v200, v199
v_lshrrev_b32 v185, 18, v185
s_waitcnt vmcnt(6)
v_mfma_f32_16x16x32_bf16 v[64:67], v[18:21], v[204:207], v[64:67]
ds_read_b128 v[244:247], v249 offset:7424
ds_read_u16_d16 v186, v186
ds_read_u16_d16_hi v185, v185
v_cvt_pk_bf16_f32 v130, v132, v133
v_pk_mul_f16 v196, v197, v196
v_lshrrev_b32_e64 v187, 18, v187
v_mfma_f32_16x16x32_bf16 v[68:71], v[16:19], v[204:207], v[68:71]
v_cvt_pk_bf16_f32 v131, v134, v135
v_exp_f16_e64 v201, v202
v_mfma_f32_16x16x32_bf16 v[172:175], v[216:219], v[96:99], 0
ds_read_u16_d16_hi v187, v187
v_cvt_pk_bf16_f32 v160, v160, v161
v_and_b32_e64 v189, s49, v189
v_cvt_pk_bf16_f32 v161, v162, v163
v_mfma_f32_16x16x32_bf16 v[180:183], v[216:219], v[100:103], 0
v_and_b32_e64 v191, s49, v191
v_cvt_pk_bf16_f32 v162, v164, v165
v_mfma_f32_16x16x32_f16 v[68:71], v[220:223], v[232:235], v[68:71]
ds_read_b128 v[216:219], v249 offset:8192
v_exp_f16 v198, v199
v_cvt_pk_bf16_f32 v163, v166, v167
s_mov_b64 vcc, s[74:75]
v_bfe_u32 v188, v189, 2, 14
v_bfe_u32 v190, v191, 2, 14
v_mfma_f32_16x16x32_f16 v[76:79], v[220:223], v[236:239], v[76:79]
v_cndmask_b32 v148, v128, v160, vcc
v_exp_f16_e64 v195, v196
s_waitcnt lgkmcnt(2)
v_mfma_f32_16x16x32_bf16 v[168:171], v[224:227], v[104:107], v[168:171]
ds_read_b128 v[220:223], v249 offset:8448
ds_read_u16_d16 v188, v188
ds_read_u16_d16 v190, v190
v_cndmask_b32 v149, v129, v161, vcc
v_lshrrev_b32_e64 v189, 18, v189
v_cndmask_b32 v150, v130, v162, vcc
v_mfma_f32_16x16x32_bf16 v[176:179], v[224:227], v[108:111], v[176:179]
v_lshrrev_b32 v191, 18, v191
v_cndmask_b32 v151, v131, v163, vcc
v_mfma_f32_16x16x32_f16 v[80:83], v[228:231], v[232:235], v[80:83]
ds_read_b128 v[224:227], v250 offset:8192
ds_read_u16_d16_hi v189, v189
ds_read_u16_d16_hi v191, v191
v_exp_f16_sdwa v201, v202 dst_sel:WORD_1 dst_unused:UNUSED_PRESERVE src0_sel:WORD_1
v_cndmask_b32_dpp v128, v144, v128, vcc quad_perm:[1,0,3,2] row_mask:0xf bank_mask:0xf
v_and_b32_e64 v193, s49, v193
v_mfma_f32_16x16x32_f16 v[88:91], v[228:231], v[236:239], v[88:91]
v_cndmask_b32_dpp v129, v145, v129, vcc quad_perm:[1,0,3,2] row_mask:0xf bank_mask:0xf
v_bfe_u32 v192, v193, 2, 14
v_mfma_f32_16x16x32_f16 v[84:87], v[240:243], v[232:235], v[84:87]
ds_read_b128 v[228:231], v250 offset:8448
ds_read_u16_d16 v192, v192
v_exp_f16_sdwa v198, v199 dst_sel:WORD_1 dst_unused:UNUSED_PRESERVE src0_sel:WORD_1
v_cndmask_b32_dpp v130, v146, v130, vcc quad_perm:[1,0,3,2] row_mask:0xf bank_mask:0xf
v_lshrrev_b32 v193, 18, v193
v_mfma_f32_16x16x32_f16 v[92:95], v[240:243], v[236:239], v[92:95]
v_cndmask_b32_dpp v131, v147, v131, vcc quad_perm:[1,0,3,2] row_mask:0xf bank_mask:0xf
s_not_b64 vcc, s[74:75]
v_exp_f16_sdwa v195, v196 dst_sel:WORD_1 dst_unused:UNUSED_PRESERVE src0_sel:WORD_1
v_mfma_f32_16x16x32_bf16 v[172:175], v[244:247], v[104:107], v[172:175]
ds_read_b128 v[240:243], v249 offset:12288
ds_read_u16_d16_hi v193, v193
v_cndmask_b32_dpp v160, v144, v160, vcc quad_perm:[1,0,3,2] row_mask:0xf bank_mask:0xf
v_pk_add_f16 v201, v201, 1.0 op_sel_hi:[1,0]
v_cndmask_b32_dpp v161, v145, v161, vcc quad_perm:[1,0,3,2] row_mask:0xf bank_mask:0xf
v_mfma_f32_16x16x32_bf16 v[180:183], v[244:247], v[108:111], v[180:183]
v_pk_add_f16 v198, v198, 1.0 op_sel_hi:[1,0]
v_cndmask_b32_dpp v162, v146, v162, vcc quad_perm:[1,0,3,2] row_mask:0xf bank_mask:0xf
v_pk_add_f16 v195, v195, 1.0 op_sel_hi:[1,0]
s_waitcnt lgkmcnt(4)
v_mfma_f32_16x16x32_bf16 v[168:171], v[216:219], v[112:115], v[168:171]
ds_read_b128 v[244:247], v250 offset:9216
v_rcp_f16 v202, v201
v_cndmask_b32_dpp v163, v147, v163, vcc quad_perm:[1,0,3,2] row_mask:0xf bank_mask:0xf
v_mfma_f32_16x16x32_bf16 v[176:179], v[216:219], v[116:119], v[176:179]
v_rcp_f16_e64 v199, v198
v_mfma_f32_16x16x32_bf16 v[172:175], v[220:223], v[112:115], v[172:175]
ds_read_b128 v[216:219], v249 offset:12544
s_add_u32 s46, s68, 98304
buffer_store_dwordx4 v[128:131], v255, s[8:11], s46 offen sc1
v_rcp_f16_e64 v196, v195
v_rcp_f16_sdwa v202, v201 dst_sel:WORD_1 dst_unused:UNUSED_PRESERVE src0_sel:WORD_1
v_mfma_f32_16x16x32_bf16 v[180:183], v[220:223], v[116:119], v[180:183]
v_rcp_f16_sdwa v199, v198 dst_sel:WORD_1 dst_unused:UNUSED_PRESERVE src0_sel:WORD_1
v_or_b32 v232, v184, v185
v_or_b32 v233, v186, v187
v_or_b32_e64 v234, v188, v189
v_rcp_f16_sdwa v196, v195 dst_sel:WORD_1 dst_unused:UNUSED_PRESERVE src0_sel:WORD_1
v_or_b32 v235, v190, v191
s_waitcnt lgkmcnt(2)
v_or_b32_e64 v236, v192, v193
v_pk_mul_f16 v237, v203, v202
v_pk_mul_f16 v238, v200, v199
v_pk_mul_f16 v239, v197, v196
v_mfma_f32_16x16x32_f16 v[48:51], v[224:227], v[232:235], v[48:51]
s_add_u32 s46, s68, 98304
buffer_store_dwordx4 v[148:151], v255, s[8:11], s46 offen offset:128 sc1
ds_read_b128 v[220:223], v250 offset:9472
v_cvt_pkrtz_f16_f32 v185, v168, v169
v_cvt_pkrtz_f16_f32 v187, v170, v171
v_mfma_f32_16x16x32_f16 v[56:59], v[224:227], v[236:239], v[56:59]
v_cvt_pkrtz_f16_f32 v189, v172, v173
v_cvt_pkrtz_f16_f32 v191, v174, v175
v_mfma_f32_16x16x32_f16 v[52:55], v[228:231], v[232:235], v[52:55]
ds_read_b128 v[224:227], v249 offset:13312
v_cvt_pkrtz_f16_f32 v193, v176, v177
v_cvt_pk_f16_f32 v203, v178, v179
v_mfma_f32_16x16x32_f16 v[60:63], v[228:231], v[236:239], v[60:63]
v_cvt_pk_f16_f32 v200, v180, v181
v_cvt_pk_f16_f32 v197, v182, v183
v_mfma_f32_16x16x32_bf16 v[168:171], v[240:243], v[96:99], 0
ds_read_b128 v[228:231], v250 offset:10240
v_pk_fma_f16 v202, v203, v203, s48
v_and_b32_e64 v185, s49, v185
v_mfma_f32_16x16x32_bf16 v[176:179], v[240:243], v[100:103], 0
v_pk_fma_f16 v199, v200, v200, s48
v_and_b32 v187, s49, v187
s_waitcnt lgkmcnt(3)
v_mfma_f32_16x16x32_f16 v[64:67], v[244:247], v[232:235], v[64:67]
ds_read_b128 v[240:243], v250 offset:10496
v_pk_fma_f16 v196, v197, v197, s48
v_bfe_u32 v184, v185, 2, 14
v_pk_mul_f16 v202, v203, v202
v_mfma_f32_16x16x32_f16 v[72:75], v[244:247], v[236:239], v[72:75]
v_bfe_u32 v186, v187, 2, 14
v_pk_mul_f16 v199, v200, v199
s_waitcnt vmcnt(6)
v_mfma_f32_16x16x32_bf16 v[80:83], v[18:21], v[8:11], v[80:83]
ds_read_b128 v[244:247], v249 offset:13568
ds_read_u16_d16 v184, v184
ds_read_u16_d16 v186, v186
v_lshrrev_b32 v185, 18, v185
v_pk_mul_f16 v196, v197, v196
v_mfma_f32_16x16x32_bf16 v[84:87], v[16:19], v[8:11], v[84:87]
v_lshrrev_b32_e64 v187, 18, v187
v_mfma_f32_16x16x32_bf16 v[172:175], v[216:219], v[96:99], 0
ds_read_u16_d16_hi v185, v185
ds_read_u16_d16_hi v187, v187
v_exp_f16 v201, v202
v_and_b32 v189, s49, v189
v_mfma_f32_16x16x32_bf16 v[180:183], v[216:219], v[100:103], 0
v_and_b32 v191, s49, v191
s_waitcnt lgkmcnt(6)
v_mfma_f32_16x16x32_f16 v[68:71], v[220:223], v[232:235], v[68:71]
ds_read_b128 v[216:219], v249 offset:14336
v_exp_f16_e64 v198, v199
v_bfe_u32 v188, v189, 2, 14
v_mfma_f32_16x16x32_f16 v[76:79], v[220:223], v[236:239], v[76:79]
v_bfe_u32 v190, v191, 2, 14
v_exp_f16_e64 v195, v196
v_mfma_f32_16x16x32_bf16 v[168:171], v[224:227], v[104:107], v[168:171]
ds_read_b128 v[220:223], v249 offset:14592
ds_read_u16_d16 v188, v188
ds_read_u16_d16 v190, v190
v_lshrrev_b32 v189, 18, v189
v_lshrrev_b32 v191, 18, v191
v_mfma_f32_16x16x32_bf16 v[176:179], v[224:227], v[108:111], v[176:179]
v_exp_f16_sdwa v201, v202 dst_sel:WORD_1 dst_unused:UNUSED_PRESERVE src0_sel:WORD_1
v_mfma_f32_16x16x32_f16 v[80:83], v[228:231], v[232:235], v[80:83]
ds_read_b128 v[224:227], v250 offset:14336
ds_read_u16_d16_hi v189, v189
ds_read_u16_d16_hi v191, v191
v_and_b32 v193, s49, v193
v_bfe_u32 v192, v193, 2, 14
v_mfma_f32_16x16x32_f16 v[88:91], v[228:231], v[236:239], v[88:91]
v_exp_f16_sdwa v198, v199 dst_sel:WORD_1 dst_unused:UNUSED_PRESERVE src0_sel:WORD_1
s_waitcnt lgkmcnt(7)
v_mfma_f32_16x16x32_f16 v[84:87], v[240:243], v[232:235], v[84:87]
ds_read_b128 v[228:231], v250 offset:14592
ds_read_u16_d16 v192, v192
v_lshrrev_b32_e64 v193, 18, v193
v_mfma_f32_16x16x32_f16 v[92:95], v[240:243], v[236:239], v[92:95]
v_exp_f16_sdwa v195, v196 dst_sel:WORD_1 dst_unused:UNUSED_PRESERVE src0_sel:WORD_1
v_pk_add_f16 v201, v201, 1.0 op_sel_hi:[1,0]
v_pk_add_f16 v198, v198, 1.0 op_sel_hi:[1,0]
v_mfma_f32_16x16x32_bf16 v[172:175], v[244:247], v[104:107], v[172:175]
ds_read_b128 v[240:243], v249 offset:18432
ds_read_u16_d16_hi v193, v193
v_pk_add_f16 v195, v195, 1.0 op_sel_hi:[1,0]
v_mfma_f32_16x16x32_bf16 v[180:183], v[244:247], v[108:111], v[180:183]
v_rcp_f16 v202, v201
s_waitcnt lgkmcnt(7)
v_mfma_f32_16x16x32_bf16 v[168:171], v[216:219], v[112:115], v[168:171]
ds_read_b128 v[244:247], v250 offset:15360
v_rcp_f16_e64 v199, v198
v_mfma_f32_16x16x32_bf16 v[176:179], v[216:219], v[116:119], v[176:179]
v_rcp_f16_e64 v196, v195
v_mfma_f32_16x16x32_bf16 v[172:175], v[220:223], v[112:115], v[172:175]
ds_read_b128 v[216:219], v249 offset:18688
v_rcp_f16_sdwa v202, v201 dst_sel:WORD_1 dst_unused:UNUSED_PRESERVE src0_sel:WORD_1
v_mfma_f32_16x16x32_bf16 v[180:183], v[220:223], v[116:119], v[180:183]
v_rcp_f16_sdwa v199, v198 dst_sel:WORD_1 dst_unused:UNUSED_PRESERVE src0_sel:WORD_1
v_or_b32 v232, v184, v185
v_or_b32 v233, v186, v187
s_waitcnt lgkmcnt(4)
v_or_b32 v234, v188, v189
v_rcp_f16_sdwa v196, v195 dst_sel:WORD_1 dst_unused:UNUSED_PRESERVE src0_sel:WORD_1
v_or_b32 v235, v190, v191
s_waitcnt lgkmcnt(2)
v_or_b32_e64 v236, v192, v193
v_pk_mul_f16 v237, v203, v202
v_pk_mul_f16 v238, v200, v199
v_pk_mul_f16 v239, v197, v196
v_mfma_f32_16x16x32_f16 v[48:51], v[224:227], v[232:235], v[48:51]
ds_read_b128 v[220:223], v250 offset:15616
v_cvt_pkrtz_f16_f32 v185, v168, v169
v_cvt_pkrtz_f16_f32 v187, v170, v171
v_mfma_f32_16x16x32_f16 v[56:59], v[224:227], v[236:239], v[56:59]
v_cvt_pkrtz_f16_f32 v189, v172, v173
v_cvt_pkrtz_f16_f32 v191, v174, v175
v_mfma_f32_16x16x32_f16 v[52:55], v[228:231], v[232:235], v[52:55]
ds_read_b128 v[224:227], v249 offset:19456
v_cvt_pkrtz_f16_f32 v193, v176, v177
v_cvt_pk_f16_f32 v203, v178, v179
v_mfma_f32_16x16x32_f16 v[60:63], v[228:231], v[236:239], v[60:63]
v_cvt_pk_f16_f32 v200, v180, v181
v_cvt_pk_f16_f32 v197, v182, v183
v_mfma_f32_16x16x32_bf16 v[168:171], v[240:243], v[96:99], 0
ds_read_b128 v[228:231], v250 offset:16384
v_pk_fma_f16 v202, v203, v203, s48
v_and_b32_e64 v185, s49, v185
v_mfma_f32_16x16x32_bf16 v[176:179], v[240:243], v[100:103], 0
v_pk_fma_f16 v199, v200, v200, s48
v_and_b32 v187, s49, v187
s_waitcnt lgkmcnt(3)
v_mfma_f32_16x16x32_f16 v[64:67], v[244:247], v[232:235], v[64:67]
ds_read_b128 v[240:243], v250 offset:16640
v_pk_fma_f16 v196, v197, v197, s48
v_bfe_u32 v184, v185, 2, 14
v_pk_mul_f16 v202, v203, v202
v_mfma_f32_16x16x32_f16 v[72:75], v[244:247], v[236:239], v[72:75]
v_bfe_u32 v186, v187, 2, 14
v_pk_mul_f16 v199, v200, v199
s_waitcnt vmcnt(5)
v_mfma_f32_16x16x32_bf16 v[56:59], v[18:21], v[44:47], v[56:59]
ds_read_b128 v[244:247], v249 offset:19712
ds_read_u16_d16 v184, v184
ds_read_u16_d16 v186, v186
v_lshrrev_b32 v185, 18, v185
v_pk_mul_f16 v196, v197, v196
v_mfma_f32_16x16x32_bf16 v[60:63], v[16:19], v[44:47], v[60:63]
v_lshrrev_b32_e64 v187, 18, v187
v_mfma_f32_16x16x32_bf16 v[172:175], v[216:219], v[96:99], 0
ds_read_u16_d16_hi v185, v185
ds_read_u16_d16_hi v187, v187
v_exp_f16 v201, v202
v_and_b32 v189, s49, v189
v_mfma_f32_16x16x32_bf16 v[180:183], v[216:219], v[100:103], 0
v_and_b32 v191, s49, v191
s_waitcnt lgkmcnt(6)
v_mfma_f32_16x16x32_f16 v[68:71], v[220:223], v[232:235], v[68:71]
ds_read_b128 v[216:219], v249 offset:20480
v_exp_f16_e64 v198, v199
v_bfe_u32 v188, v189, 2, 14
v_mfma_f32_16x16x32_f16 v[76:79], v[220:223], v[236:239], v[76:79]
v_bfe_u32 v190, v191, 2, 14
v_exp_f16_e64 v195, v196
v_mfma_f32_16x16x32_bf16 v[168:171], v[224:227], v[104:107], v[168:171]
ds_read_b128 v[220:223], v249 offset:20736
ds_read_u16_d16 v188, v188
ds_read_u16_d16 v190, v190
v_lshrrev_b32 v189, 18, v189
v_lshrrev_b32 v191, 18, v191
v_mfma_f32_16x16x32_bf16 v[176:179], v[224:227], v[108:111], v[176:179]
v_exp_f16_sdwa v201, v202 dst_sel:WORD_1 dst_unused:UNUSED_PRESERVE src0_sel:WORD_1
v_mfma_f32_16x16x32_f16 v[80:83], v[228:231], v[232:235], v[80:83]
ds_read_b128 v[224:227], v250 offset:20480
ds_read_u16_d16_hi v189, v189
ds_read_u16_d16_hi v191, v191
v_and_b32 v193, s49, v193
v_bfe_u32 v192, v193, 2, 14
v_mfma_f32_16x16x32_f16 v[88:91], v[228:231], v[236:239], v[88:91]
v_exp_f16_sdwa v198, v199 dst_sel:WORD_1 dst_unused:UNUSED_PRESERVE src0_sel:WORD_1
s_waitcnt lgkmcnt(7)
v_mfma_f32_16x16x32_f16 v[84:87], v[240:243], v[232:235], v[84:87]
ds_read_b128 v[228:231], v250 offset:20736
ds_read_u16_d16 v192, v192
v_lshrrev_b32_e64 v193, 18, v193
v_mfma_f32_16x16x32_f16 v[92:95], v[240:243], v[236:239], v[92:95]
v_exp_f16_sdwa v195, v196 dst_sel:WORD_1 dst_unused:UNUSED_PRESERVE src0_sel:WORD_1
v_pk_add_f16 v201, v201, 1.0 op_sel_hi:[1,0]
v_pk_add_f16 v198, v198, 1.0 op_sel_hi:[1,0]
v_mfma_f32_16x16x32_bf16 v[172:175], v[244:247], v[104:107], v[172:175]
ds_read_b128 v[240:243], v250 offset:21504
ds_read_u16_d16_hi v193, v193
v_pk_add_f16 v195, v195, 1.0 op_sel_hi:[1,0]
v_mfma_f32_16x16x32_bf16 v[180:183], v[244:247], v[108:111], v[180:183]
v_rcp_f16 v202, v201
s_waitcnt lgkmcnt(7)
v_mfma_f32_16x16x32_bf16 v[168:171], v[216:219], v[112:115], v[168:171]
ds_read_b128 v[244:247], v250 offset:21760
v_rcp_f16_e64 v199, v198
v_mfma_f32_16x16x32_bf16 v[176:179], v[216:219], v[116:119], v[176:179]
v_rcp_f16_e64 v196, v195
v_mfma_f32_16x16x32_bf16 v[172:175], v[220:223], v[112:115], v[172:175]
ds_read_b128 v[216:219], v250 offset:22528
v_rcp_f16_sdwa v202, v201 dst_sel:WORD_1 dst_unused:UNUSED_PRESERVE src0_sel:WORD_1
v_mfma_f32_16x16x32_bf16 v[180:183], v[220:223], v[116:119], v[180:183]
v_rcp_f16_sdwa v199, v198 dst_sel:WORD_1 dst_unused:UNUSED_PRESERVE src0_sel:WORD_1
v_or_b32 v232, v184, v185
v_or_b32 v233, v186, v187
s_waitcnt lgkmcnt(4)
v_or_b32 v234, v188, v189
v_rcp_f16_sdwa v196, v195 dst_sel:WORD_1 dst_unused:UNUSED_PRESERVE src0_sel:WORD_1
v_or_b32 v235, v190, v191
s_waitcnt lgkmcnt(2)
v_or_b32_e64 v236, v192, v193
v_pk_mul_f16 v237, v203, v202
v_pk_mul_f16 v238, v200, v199
v_pk_mul_f16 v239, v197, v196
v_mfma_f32_16x16x32_f16 v[48:51], v[224:227], v[232:235], v[48:51]
s_add_u32 s46, s68, 98304
buffer_store_dwordx4 v[160:163], v255, s[8:11], s46 offen offset:256 sc1
ds_read_b128 v[220:223], v250 offset:22784
v_cvt_pkrtz_f16_f32 v185, v168, v169
v_cvt_pkrtz_f16_f32 v187, v170, v171
v_cvt_pkrtz_f16_f32 v189, v172, v173
v_cvt_pkrtz_f16_f32 v191, v174, v175
v_mfma_f32_16x16x32_f16 v[56:59], v[224:227], v[236:239], v[56:59]
v_cvt_pkrtz_f16_f32 v193, v176, v177
v_cvt_pk_f16_f32 v203, v178, v179
v_cvt_pk_f16_f32 v200, v180, v181
v_cvt_pk_f16_f32 v197, v182, v183
v_mfma_f32_16x16x32_f16 v[52:55], v[228:231], v[232:235], v[52:55]
ds_read_b128 v[224:227], v250 offset:26624
v_pk_fma_f16 v202, v203, v203, s48
v_and_b32_e64 v185, s49, v185
v_pk_fma_f16 v199, v200, v200, s48
v_and_b32_e64 v187, s49, v187
v_mfma_f32_16x16x32_f16 v[60:63], v[228:231], v[236:239], v[60:63]
v_pk_fma_f16 v196, v197, v197, s48
v_bfe_u32 v184, v185, 2, 14
v_pk_mul_f16 v202, v203, v202
v_bfe_u32 v186, v187, 2, 14
v_mfma_f32_16x16x32_f16 v[64:67], v[240:243], v[232:235], v[64:67]
ds_read_b128 v[228:231], v250 offset:26880
ds_read_u16_d16 v184, v184
ds_read_u16_d16 v186, v186
v_pk_mul_f16 v199, v200, v199
v_lshrrev_b32_e64 v185, 18, v185
v_pk_mul_f16 v196, v197, v196
v_lshrrev_b32_e64 v187, 18, v187
v_mfma_f32_16x16x32_f16 v[72:75], v[240:243], v[236:239], v[72:75]
v_exp_f16 v201, v202
v_and_b32 v189, s49, v189
v_and_b32 v191, s49, v191
s_waitcnt vmcnt(4)
v_mfma_f32_16x16x32_bf16 v[72:75], v[18:21], v[40:43], v[72:75]
ds_read_b128 v[240:243], v250 offset:27648
ds_read_u16_d16_hi v185, v185
ds_read_u16_d16_hi v187, v187
v_exp_f16_e64 v198, v199
v_bfe_u32 v188, v189, 2, 14
v_bfe_u32 v190, v191, 2, 14
v_mfma_f32_16x16x32_bf16 v[76:79], v[16:19], v[40:43], v[76:79]
v_exp_f16 v195, v196
v_lshrrev_b32 v189, 18, v189
v_lshrrev_b32 v191, 18, v191
s_waitcnt lgkmcnt(6)
v_mfma_f32_16x16x32_f16 v[68:71], v[244:247], v[232:235], v[68:71]
ds_read_u16_d16 v188, v188
ds_read_u16_d16 v190, v190
ds_read_u16_d16_hi v189, v189
ds_read_u16_d16_hi v191, v191
v_exp_f16_sdwa v201, v202 dst_sel:WORD_1 dst_unused:UNUSED_PRESERVE src0_sel:WORD_1
v_and_b32_e64 v193, s49, v193
v_bfe_u32 v192, v193, 2, 14
v_mfma_f32_16x16x32_f16 v[76:79], v[244:247], v[236:239], v[76:79]
v_exp_f16_sdwa v198, v199 dst_sel:WORD_1 dst_unused:UNUSED_PRESERVE src0_sel:WORD_1
v_lshrrev_b32_e64 v193, 18, v193
v_mfma_f32_16x16x32_f16 v[80:83], v[216:219], v[232:235], v[80:83]
ds_read_b128 v[244:247], v250 offset:27904
ds_read_u16_d16 v192, v192
ds_read_u16_d16_hi v193, v193
v_exp_f16_sdwa v195, v196 dst_sel:WORD_1 dst_unused:UNUSED_PRESERVE src0_sel:WORD_1
v_pk_add_f16 v201, v201, 1.0 op_sel_hi:[1,0]
v_pk_add_f16 v198, v198, 1.0 op_sel_hi:[1,0]
v_pk_add_f16 v195, v195, 1.0 op_sel_hi:[1,0]
v_mfma_f32_16x16x32_f16 v[88:91], v[216:219], v[236:239], v[88:91]
v_rcp_f16 v202, v201
v_rcp_f16 v199, v198
v_mfma_f32_16x16x32_f16 v[84:87], v[220:223], v[232:235], v[84:87]
ds_read_b128 v[216:219], v250 offset:28672
v_rcp_f16_e64 v196, v195
v_rcp_f16_sdwa v202, v201 dst_sel:WORD_1 dst_unused:UNUSED_PRESERVE src0_sel:WORD_1
v_mfma_f32_16x16x32_f16 v[92:95], v[220:223], v[236:239], v[92:95]
v_rcp_f16_sdwa v199, v198 dst_sel:WORD_1 dst_unused:UNUSED_PRESERVE src0_sel:WORD_1
s_waitcnt lgkmcnt(5)
v_or_b32 v232, v184, v185
v_or_b32_e64 v233, v186, v187
v_or_b32 v234, v188, v189
v_rcp_f16_sdwa v196, v195 dst_sel:WORD_1 dst_unused:UNUSED_PRESERVE src0_sel:WORD_1
s_waitcnt lgkmcnt(4)
v_or_b32 v235, v190, v191
s_waitcnt lgkmcnt(1)
v_or_b32 v236, v192, v193
v_pk_mul_f16 v237, v203, v202
v_pk_mul_f16 v238, v200, v199
v_pk_mul_f16 v239, v197, v196
v_mfma_f32_16x16x32_f16 v[48:51], v[224:227], v[232:235], v[48:51]
ds_read_b128 v[220:223], v250 offset:28928
v_mfma_f32_16x16x32_f16 v[56:59], v[224:227], v[236:239], v[56:59]
v_mfma_f32_16x16x32_f16 v[52:55], v[228:231], v[232:235], v[52:55]
v_mfma_f32_16x16x32_f16 v[60:63], v[228:231], v[236:239], v[60:63]
v_mfma_f32_16x16x32_f16 v[64:67], v[240:243], v[232:235], v[64:67]
v_mfma_f32_16x16x32_f16 v[72:75], v[240:243], v[236:239], v[72:75]
s_waitcnt vmcnt(3)
v_mfma_f32_16x16x32_bf16 v[88:91], v[18:21], v[208:211], v[88:91]
v_mfma_f32_16x16x32_bf16 v[92:95], v[16:19], v[208:211], v[92:95]
v_mfma_f32_16x16x32_f16 v[68:71], v[244:247], v[232:235], v[68:71]
v_mfma_f32_16x16x32_f16 v[76:79], v[244:247], v[236:239], v[76:79]
s_waitcnt lgkmcnt(1)
v_mfma_f32_16x16x32_f16 v[80:83], v[216:219], v[232:235], v[80:83]
v_mfma_f32_16x16x32_f16 v[88:91], v[216:219], v[236:239], v[88:91]
s_waitcnt lgkmcnt(0)
v_mfma_f32_16x16x32_f16 v[84:87], v[220:223], v[232:235], v[84:87]
v_mfma_f32_16x16x32_f16 v[92:95], v[220:223], v[236:239], v[92:95]
v_cvt_pk_bf16_f32 v64, v64, v65
v_cvt_pk_bf16_f32 v65, v66, v67
v_cvt_pk_bf16_f32 v66, v68, v69
v_cvt_pk_bf16_f32 v67, v70, v71
v_cvt_pk_bf16_f32 v48, v48, v49
v_cvt_pk_bf16_f32 v49, v50, v51
v_cvt_pk_bf16_f32 v50, v52, v53
v_cvt_pk_bf16_f32 v51, v54, v55
v_cvt_pk_bf16_f32 v80, v80, v81
v_cvt_pk_bf16_f32 v81, v82, v83
v_cvt_pk_bf16_f32 v82, v84, v85
v_cvt_pk_bf16_f32 v83, v86, v87
s_mov_b64 vcc, s[74:75]
v_cndmask_b32 v68, v48, v80, vcc
v_cndmask_b32 v69, v49, v81, vcc
v_cndmask_b32 v70, v50, v82, vcc
v_cndmask_b32 v71, v51, v83, vcc
v_cndmask_b32_dpp v48, v64, v48, vcc quad_perm:[1,0,3,2] row_mask:0xf bank_mask:0xf
v_cndmask_b32_dpp v49, v65, v49, vcc quad_perm:[1,0,3,2] row_mask:0xf bank_mask:0xf
v_cndmask_b32_dpp v50, v66, v50, vcc quad_perm:[1,0,3,2] row_mask:0xf bank_mask:0xf
v_cndmask_b32_dpp v51, v67, v51, vcc quad_perm:[1,0,3,2] row_mask:0xf bank_mask:0xf
s_not_b64 vcc, s[74:75]
v_cndmask_b32_dpp v80, v64, v80, vcc quad_perm:[1,0,3,2] row_mask:0xf bank_mask:0xf
v_cndmask_b32_dpp v81, v65, v81, vcc quad_perm:[1,0,3,2] row_mask:0xf bank_mask:0xf
v_cndmask_b32_dpp v82, v66, v82, vcc quad_perm:[1,0,3,2] row_mask:0xf bank_mask:0xf
v_cndmask_b32_dpp v83, v67, v83, vcc quad_perm:[1,0,3,2] row_mask:0xf bank_mask:0xf
buffer_store_dwordx4 v[48:51], v255, s[8:11], s69 offen sc1
buffer_store_dwordx4 v[68:71], v255, s[8:11], s69 offen offset:128 sc1
buffer_store_dwordx4 v[80:83], v255, s[8:11], s69 offen offset:256 sc1
v_cvt_pk_bf16_f32 v72, v72, v73
v_cvt_pk_bf16_f32 v73, v74, v75
v_cvt_pk_bf16_f32 v74, v76, v77
v_cvt_pk_bf16_f32 v75, v78, v79
v_cvt_pk_bf16_f32 v56, v56, v57
v_cvt_pk_bf16_f32 v57, v58, v59
v_cvt_pk_bf16_f32 v58, v60, v61
v_cvt_pk_bf16_f32 v59, v62, v63
v_cvt_pk_bf16_f32 v88, v88, v89
v_cvt_pk_bf16_f32 v89, v90, v91
v_cvt_pk_bf16_f32 v90, v92, v93
v_cvt_pk_bf16_f32 v91, v94, v95
s_mov_b64 vcc, s[74:75]
v_cndmask_b32 v76, v56, v88, vcc
v_cndmask_b32 v77, v57, v89, vcc
v_cndmask_b32 v78, v58, v90, vcc
v_cndmask_b32 v79, v59, v91, vcc
v_cndmask_b32_dpp v56, v72, v56, vcc quad_perm:[1,0,3,2] row_mask:0xf bank_mask:0xf
v_cndmask_b32_dpp v57, v73, v57, vcc quad_perm:[1,0,3,2] row_mask:0xf bank_mask:0xf
v_cndmask_b32_dpp v58, v74, v58, vcc quad_perm:[1,0,3,2] row_mask:0xf bank_mask:0xf
v_cndmask_b32_dpp v59, v75, v59, vcc quad_perm:[1,0,3,2] row_mask:0xf bank_mask:0xf
s_not_b64 vcc, s[74:75]
v_cndmask_b32_dpp v88, v72, v88, vcc quad_perm:[1,0,3,2] row_mask:0xf bank_mask:0xf
v_cndmask_b32_dpp v89, v73, v89, vcc quad_perm:[1,0,3,2] row_mask:0xf bank_mask:0xf
v_cndmask_b32_dpp v90, v74, v90, vcc quad_perm:[1,0,3,2] row_mask:0xf bank_mask:0xf
v_cndmask_b32_dpp v91, v75, v91, vcc quad_perm:[1,0,3,2] row_mask:0xf bank_mask:0xf
s_add_u32 s46, s69, 98304
buffer_store_dwordx4 v[56:59], v255, s[8:11], s46 offen sc1
s_add_u32 s46, s69, 98304
buffer_store_dwordx4 v[76:79], v255, s[8:11], s46 offen offset:128 sc1
s_add_u32 s46, s69, 98304
buffer_store_dwordx4 v[88:91], v255, s[8:11], s46 offen offset:256 sc1
s_endpgm
Lpoll:
s_waitcnt vmcnt(0)
Lpoll1:
s_cmp_eq_u32 s77, 2
s_cbranch_scc1 LpollC
v_max_u32 v255, v156, v157
v_max3_u32 v255, v255, v158, v159
v_max3_u32 v255, v255, v160, v161
v_max3_u32 v255, v255, v162, v163
v_max3_u32 v255, v255, v164, v165
v_max3_u32 v255, v255, v166, v167
v_max3_u32 v255, v255, v240, v241
v_max3_u32 v255, v255, v242, v243
v_cmp_eq_u32 vcc, -1, v255
s_nop 4
s_cbranch_vccz LpollR
v_lshlrev_b32 v247, 4, v251
s_lshl_b32 s44, s2, 12
buffer_load_dwordx4 v[156:159], v247, s[32:35], s44 offen sc1
buffer_load_dwordx4 v[160:163], v247, s[32:35], s44 offen offset:1024 sc1
buffer_load_dwordx4 v[164:167], v247, s[32:35], s44 offen offset:2048 sc1
buffer_load_dwordx4 v[240:243], v247, s[32:35], s44 offen offset:3072 sc1
s_setpc_b64 s[78:79]
LpollR:
s_setprio 3
v_add_f32 v156, v156, v160
v_add_f32 v240, v164, v240
v_add_f32 v240, v156, v240
v_add_f32 v157, v157, v161
v_add_f32 v241, v165, v241
v_add_f32 v241, v157, v241
v_add_f32 v158, v158, v162
v_add_f32 v242, v166, v242
v_add_f32 v242, v158, v242
v_add_f32 v159, v159, v163
v_add_f32 v243, v167, v243
v_add_f32 v243, v159, v243
v_add_f32_dpp v240, v240, v240 row_ror:8 row_mask:0xf bank_mask:0xf
s_nop 1
v_add_f32_dpp v240, v240, v240 row_ror:4 row_mask:0xf bank_mask:0xf
s_nop 1
v_add_f32_dpp v240, v240, v240 row_ror:2 row_mask:0xf bank_mask:0xf
s_nop 1
v_add_f32_dpp v240, v240, v240 row_ror:1 row_mask:0xf bank_mask:0xf
v_mov_b32 v255, v240
s_nop 1
v_permlane16_swap_b32 v240, v255
v_add_f32 v240, v240, v255
v_mov_b32 v255, v240
s_nop 1
v_permlane32_swap_b32 v240, v255
v_add_f32 v240, v240, v255
v_min_u32 v240, -2, v240
v_add_f32_dpp v241, v241, v241 row_ror:8 row_mask:0xf bank_mask:0xf
s_nop 1
v_add_f32_dpp v241, v241, v241 row_ror:4 row_mask:0xf bank_mask:0xf
s_nop 1
v_add_f32_dpp v241, v241, v241 row_ror:2 row_mask:0xf bank_mask:0xf
s_nop 1
v_add_f32_dpp v241, v241, v241 row_ror:1 row_mask:0xf bank_mask:0xf
v_mov_b32 v255, v241
s_nop 1
v_permlane16_swap_b32 v241, v255
v_add_f32 v241, v241, v255
v_mov_b32 v255, v241
s_nop 1
v_permlane32_swap_b32 v241, v255
v_add_f32 v241, v241, v255
v_min_u32 v241, -2, v241
v_add_f32_dpp v242, v242, v242 row_ror:8 row_mask:0xf bank_mask:0xf
s_nop 1
v_add_f32_dpp v242, v242, v242 row_ror:4 row_mask:0xf bank_mask:0xf
s_nop 1
v_add_f32_dpp v242, v242, v242 row_ror:2 row_mask:0xf bank_mask:0xf
s_nop 1
v_add_f32_dpp v242, v242, v242 row_ror:1 row_mask:0xf bank_mask:0xf
v_mov_b32 v255, v242
s_nop 1
v_permlane16_swap_b32 v242, v255
v_add_f32 v242, v242, v255
v_mov_b32 v255, v242
s_nop 1
v_permlane32_swap_b32 v242, v255
v_add_f32 v242, v242, v255
v_min_u32 v242, -2, v242
v_add_f32_dpp v243, v243, v243 row_ror:8 row_mask:0xf bank_mask:0xf
s_nop 1
v_add_f32_dpp v243, v243, v243 row_ror:4 row_mask:0xf bank_mask:0xf
s_nop 1
v_add_f32_dpp v243, v243, v243 row_ror:2 row_mask:0xf bank_mask:0xf
s_nop 1
v_add_f32_dpp v243, v243, v243 row_ror:1 row_mask:0xf bank_mask:0xf
v_mov_b32 v255, v243
s_nop 1
v_permlane16_swap_b32 v243, v255
v_add_f32 v243, v243, v255
v_mov_b32 v255, v243
s_nop 1
v_permlane32_swap_b32 v243, v255
v_add_f32_e64 v243, v243, v255
v_min_u32 v243, -2, v243
s_lshl_b32 s44, s2, 4
s_add_u32 s44, s44, 393216
v_lshlrev_b32_e64 v255, 11, v251
s_mov_b64 exec, 0xff
buffer_store_dwordx4 v[240:243], v255, s[32:35], s44 offen sc1
s_mov_b64 exec, -1
s_cmp_eq_u32 s40, 0
s_cselect_b32 s77, 2, 0
s_cbranch_scc0 LpollRx
v_lshlrev_b32_e64 v247, 3, v251
s_and_b32 s44, s2, 7
s_lshl_b32 s44, s44, 11
s_add_u32 s44, s44, 393216
buffer_load_dwordx2 v[156:157], v247, s[32:35], s44 offen sc1
buffer_load_dwordx2 v[158:159], v247, s[32:35], s44 offen offset:512 sc1
buffer_load_dwordx2 v[160:161], v247, s[32:35], s44 offen offset:1024 sc1
LpollRx:
s_setpc_b64 s[78:79]
LpollC:
v_max3_u32 v255, v156, v157, v158
v_max3_u32 v255, v255, v159, v160
v_max_u32 v255, v255, v161
v_cmp_eq_u32 vcc, -1, v255
s_nop 4
s_cbranch_vccz LpollS
v_lshlrev_b32 v247, 3, v251
s_and_b32 s44, s2, 7
s_lshl_b32 s44, s44, 11
s_add_u32 s44, s44, 393216
buffer_load_dwordx2 v[156:157], v247, s[32:35], s44 offen sc1
buffer_load_dwordx2 v[158:159], v247, s[32:35], s44 offen offset:512 sc1
buffer_load_dwordx2 v[160:161], v247, s[32:35], s44 offen offset:1024 sc1
s_setpc_b64 s[78:79]
LpollS:
s_setprio 3
s_mov_b32 s43, 1083296634
v_mov_b32 v162, 897988541
v_fma_f32 v156, v156, s43, v162
v_fma_f32 v157, v157, s43, v162
v_fma_f32 v158, v158, s43, v162
v_fma_f32 v159, v159, s43, v162
v_fma_f32 v160, v160, s43, v162
v_fma_f32 v161, v161, s43, v162
v_sqrt_f32 v156, v156
v_sqrt_f32 v157, v157
v_sqrt_f32 v158, v158
v_sqrt_f32 v159, v159
v_sqrt_f32 v160, v160
v_sqrt_f32 v161, v161
v_add_f32 v163, v156, v157
v_add_f32 v163, v163, v158
v_add_f32 v163, v163, v159
v_add_f32 v163, v163, v160
v_add_f32 v163, v163, v161
s_nop 1
v_add_f32_dpp v163, v163, v163 row_ror:8 row_mask:0xf bank_mask:0xf
s_nop 1
v_add_f32_dpp v163, v163, v163 row_ror:4 row_mask:0xf bank_mask:0xf
s_nop 1
v_add_f32_dpp v163, v163, v163 row_ror:2 row_mask:0xf bank_mask:0xf
s_nop 1
v_add_f32_dpp v163, v163, v163 row_ror:1 row_mask:0xf bank_mask:0xf
v_mov_b32 v255, v163
s_nop 1
v_permlane16_swap_b32 v163, v255
v_add_f32 v163, v163, v255
v_mov_b32 v255, v163
s_nop 1
v_permlane32_swap_b32 v163, v255
v_add_f32_e64 v163, v163, v255
s_mov_b32 s43, 992651947
v_fma_f32 v163, v163, s43, v162
v_rcp_f32_e64 v163, v163
v_mov_b32 v162, 3221789604
v_mul_f32 v163, v163, v162
v_lshlrev_b32 v164, 16, v244
v_and_b32 v165, 4294901760, v244
v_mul_f32 v156, v156, v163
v_mul_f32 v157, v157, v163
v_fma_f32 v164, v164, v156, v162
v_fma_f32 v165, v165, v157, v162
v_cvt_pk_f16_f32 v244, v164, v165
v_lshlrev_b32_e64 v164, 16, v245
v_and_b32 v165, 4294901760, v245
v_mul_f32 v158, v158, v163
v_mul_f32 v159, v159, v163
v_fma_f32 v164, v164, v158, v162
v_fma_f32 v165, v165, v159, v162
v_cvt_pk_f16_f32 v245, v164, v165
v_lshlrev_b32_e64 v164, 16, v246
v_and_b32 v165, 4294901760, v246
v_mul_f32 v160, v160, v163
v_mul_f32 v161, v161, v163
v_fma_f32 v164, v164, v160, v162
v_fma_f32 v165, v165, v161, v162
v_cvt_pk_f16_f32 v246, v164, v165
s_mov_b32 s77, 0
s_setpc_b64 s[78:79]
Lend:
s_endpgm

.section .rodata,"a"
.p2align 6
.amdhsa_kernel standalone__modern_conv_block_convnext_v2__vision_kernel
  .amdhsa_next_free_vgpr 256
  .amdhsa_next_free_sgpr 102
  .amdhsa_accum_offset 256
  .amdhsa_group_segment_fixed_size 0
  .amdhsa_kernarg_size 72
  .amdhsa_user_sgpr_count 2
  .amdhsa_user_sgpr_kernarg_segment_ptr 1
  .amdhsa_system_sgpr_workgroup_id_x 1
.end_amdhsa_kernel
```

```asm
; @launch grid=(256,1,1) block=(512,1,1) lds=163840
.amdgcn_target "amdgcn-amd-amdhsa--gfx950"
.text
.globl standalone__modern_conv_block_convnext_v2__vision_kernel
.p2align 8
.type standalone__modern_conv_block_convnext_v2__vision_kernel,@function
standalone__modern_conv_block_convnext_v2__vision_kernel:
Lmain:
s_cmp_ge_u32 s2, 256
s_cbranch_scc1 Lend
s_load_dwordx16 s[80:95], s[0:1], 0
s_load_dwordx2 s[96:97], s[0:1], 64
s_getpc_b64 s[74:75]
Lpc0:
s_sub_u32 s74, s74, Lpc0-Lmain
s_subb_u32 s75, s75, 0
v_lshlrev_b32 v159, 7, v0
s_movk_i32 s43, 64
v_cmp_gt_u32 vcc, s43, v0
s_and_saveexec_b64 s[78:79], vcc
s_cbranch_execz Lpf0x
global_load_dword v255, v159, s[74:75]
Lpf0x:
s_mov_b64 exec, s[78:79]
v_mov_b32 v199, v0
v_and_b32 v251, 63, v0
v_lshrrev_b32 v120, 6, v0
s_nop 0
v_readfirstlane_b32 s40, v120
s_and_b32 s43, s2, 7
s_lshr_b32 s44, s2, 3
s_and_b32 s41, s43, 0
s_lshl_b32 s41, s41, 4
s_and_b32 s45, s44, 15
s_add_u32 s41, s41, s45
s_lshr_b32 s42, s43, 0
s_lshl_b32 s42, s42, 1
s_lshr_b32 s45, s44, 4
s_add_u32 s42, s42, s45
s_lshl_b32 s41, s41, 5
s_lshl_b32 s42, s42, 5
s_lshl_b32 s67, s40, 6
s_cmp_eq_u32 s40, 6
s_cselect_b32 s67, 352, s67
v_add_u32_e64 v125, s67, v251
v_mul_u32_u24 v121, 5462, v125
v_lshrrev_b32 v121, 16, v121
v_mul_u32_u24 v122, 12, v121
v_sub_u32 v122, v125, v122
v_bfe_u32 v123, v121, 2, 2
v_xor_b32 v122, v122, v123
v_add_u32 v123, s41, v121
v_subrev_u32 v123, 1, v123
v_mul_u32_u24 v124, 192, v123
v_lshl_add_u32 v124, v122, 4, v124
v_mov_b32 v240, 2147483648
s_movk_i32 s43, 512
v_cmp_gt_u32 vcc, s43, v123
s_nop 1
v_cndmask_b32 v124, v240, v124, vcc
v_cmp_gt_u32 vcc, 34, v121
s_nop 1
v_cndmask_b32 v240, v240, v124, vcc
s_add_i32 s43, s42, -1
s_mul_i32 s44, s43, 98304
s_cmp_lt_u32 s43, 512
s_cselect_b32 s46, s44, 1073741824
s_mul_i32 s66, s42, 98304
s_mov_b32 s6, 50331648
s_mov_b32 s7, 131072
s_lshl_b32 s67, s67, 4
s_add_u32 s67, s67, 90112
s_cmp_eq_u32 s40, 7
s_cselect_b32 s67, 163840, s67
v_lshlrev_b32 v130, 1, v199
v_add_u32 v155, 768, v199
v_min_u32 v155, 863, v155
v_lshlrev_b32_e64 v131, 1, v155
s_waitcnt lgkmcnt(0)
s_mov_b32 s4, s80
s_and_b32 s5, s81, 65535
s_cmp_ge_u32 s40, 4
s_cbranch_scc1 Lnodw
s_mov_b32 s20, s82
s_and_b32 s21, s83, 65535
s_mov_b32 s22, 1728
s_mov_b32 s23, 131072
buffer_load_ushort v126, v130, s[20:23], 0 offen offset:0
buffer_load_ushort v127, v130, s[20:23], 0 offen offset:512
buffer_load_ushort v128, v130, s[20:23], 0 offen offset:1024
buffer_load_ushort v129, v131, s[20:23], 0 offen offset:0
Lnodw:
s_cmp_eq_u32 s40, 7
s_cbranch_scc1 Lskipx0
s_add_u32 m0, s67, 0
s_nop 0
buffer_load_dwordx4 v240, s[4:7], s46 offen nt lds
s_add_u32 m0, s67, 6656
s_nop 0
buffer_load_dwordx4 v240, s[4:7], s66 offen nt lds
s_add_u32 m0, s67, 13312
s_add_u32 s45, s66, 98304
buffer_load_dwordx4 v240, s[4:7], s45 offen nt lds
s_add_u32 m0, s67, 19968
s_add_u32 s45, s66, 196608
buffer_load_dwordx4 v240, s[4:7], s45 offen nt lds
s_add_u32 m0, s67, 26624
s_add_u32 s45, s66, 294912
buffer_load_dwordx4 v240, s[4:7], s45 offen nt lds
s_add_u32 m0, s67, 33280
s_add_u32 s45, s66, 393216
buffer_load_dwordx4 v240, s[4:7], s45 offen nt lds
Lskipx0:
s_mov_b32 s12, s84
s_and_b32 s13, s85, 65535
s_mov_b32 s14, 73728
s_mov_b32 s15, 131072
v_lshrrev_b32 v189, 2, v251
v_mul_u32_u24 v189, 768, v189
v_and_b32_e64 v125, 3, v251
v_lshl_add_u32 v189, v125, 4, v189
s_and_b32 s43, s40, 3
s_lshl_b32 s3, s43, 6
s_mul_i32 s77, s43, 6144
s_add_u32 s77, s77, 16384
v_mov_b32 v253, 16256
v_mov_b32 v254, 1
s_add_u32 s43, s42, s40
s_add_u32 s43, s43, 1
s_lshl_b32 s43, s43, 9
s_add_u32 s43, s43, s41
s_mul_i32 s47, s43, 192
s_sub_u32 s47, s47, 256
s_and_b32 s43, s40, 1
s_lshl_b32 s46, s43, 4
s_add_u32 s41, s41, s46
s_and_b32 s43, s40, 6
s_add_u32 s42, s42, s43
s_mul_i32 s45, s43, 6656
s_add_u32 s45, s45, 90112
v_and_b32 v131, 15, v251
v_lshrrev_b32 v132, 4, v251
v_mul_u32_u24 v122, 6656, v132
v_add_u32 v122, s45, v122
v_add_u32 v121, s46, v131
v_mul_u32_u24 v123, 192, v121
v_bfe_u32 v124, v121, 2, 2
v_lshl_add_u32 v123, v124, 4, v123
v_add_u32 v242, v122, v123
v_add_u32 v121, 1, v121
v_mul_u32_u24 v123, 192, v121
v_bfe_u32 v124, v121, 2, 2
v_lshl_add_u32 v123, v124, 4, v123
v_add_u32 v243, v122, v123
v_add_u32 v121, 1, v121
v_mul_u32_u24 v123, 192, v121
v_bfe_u32 v124, v121, 2, 2
v_lshl_add_u32 v123, v124, 4, v123
v_add_u32_e64 v244, v122, v123
s_mul_i32 s72, s40, 9216
s_add_u32 s72, s72, 90112
v_bfe_u32 v133, v131, 2, 1
v_sub_u32 v133, v132, v133
v_lshrrev_b32 v134, 3, v131
v_and_b32_e64 v135, 3, v131
v_lshl_add_u32 v135, v134, 2, v135
v_lshlrev_b32_e64 v136, 7, v133
v_lshl_add_u32 v136, v135, 4, v136
v_add_u32 v136, 156672, v136
v_mov_b32 v135, 163840
v_cmp_gt_u32 vcc, 3, v133
s_nop 1
v_cndmask_b32 v245, v135, v136, vcc
v_and_b32 v135, 3, v131
v_mul_u32_u24 v246, 85, v135
s_mov_b32 s16, s86
s_and_b32 s17, s87, 65535
s_mov_b32 s18, 73728
s_mov_b32 s19, 131072
s_mov_b32 s24, s88
s_and_b32 s25, s89, 65535
s_mov_b32 s26, 768
s_mov_b32 s27, 131072
s_mov_b32 s28, s90
s_and_b32 s29, s91, 65535
s_mov_b32 s30, 768
s_mov_b32 s31, 131072
s_mov_b32 s8, s92
s_and_b32 s9, s93, 65535
s_mov_b32 s10, 50331648
s_mov_b32 s11, 131072
s_mov_b32 s36, s94
s_and_b32 s37, s95, 65535
s_mov_b32 s38, 256
s_mov_b32 s39, 131072
s_mov_b32 s32, s96
s_and_b32 s33, s97, 65535
s_mov_b32 s34, 83886080
s_mov_b32 s35, 131072
v_lshlrev_b32 v241, 4, v251
v_and_b32 v133, 35, v251
v_bfe_u32 v134, v251, 2, 2
v_lshl_add_u32 v133, v134, 3, v133
v_bfe_u32 v134, v251, 4, 1
v_lshl_add_u32 v133, v134, 2, v133
v_lshlrev_b32_e64 v248, 4, v133
v_add_u32 v249, 65536, v248
v_add_u32 v250, 131072, v248
s_lshl_b32 s73, s2, 3
s_add_u32 s73, s73, s40
s_lshl_b32 s80, s73, 10
s_add_u32 s80, s80, 4194304
s_mul_i32 s73, s73, 16
s_add_u32 s73, s73, 1048576
s_mul_i32 s46, s41, 192
s_add_u32 s43, s42, 0
s_mul_i32 s43, s43, 98304
s_add_u32 s68, s43, s46
s_add_u32 s43, s42, 8
s_mul_i32 s43, s43, 98304
s_add_u32 s69, s43, s46
s_add_u32 s43, s42, 16
s_mul_i32 s43, s43, 98304
s_add_u32 s70, s43, s46
s_add_u32 s43, s42, 24
s_mul_i32 s43, s43, 98304
s_add_u32 s71, s43, s46
s_mul_i32 s82, s40, 9216
s_mov_b32 s48, 1156203754
s_mov_b32 s49, 4294508536
s_mov_b32 s76, 400000
v_lshrrev_b32 v148, 5, v251
v_lshlrev_b32 v190, 8, v148
v_bfe_u32 v148, v251, 2, 2
v_lshl_add_u32 v190, v148, 6, v190
v_bfe_u32 v148, v251, 4, 1
v_lshl_add_u32 v190, v148, 5, v190
v_bfe_u32 v148, v251, 0, 1
v_lshl_add_u32 v190, v148, 4, v190
v_bfe_u32 v148, v251, 1, 1
v_lshl_add_u32 v190, v148, 3, v190
v_add_u32 v190, s77, v190
v_add_u32 v191, s77, v248
s_cmp_lt_u32 s40, 4
s_cbranch_scc1 Lnoy
v_lshlrev_b32_e64 v24, 6, v199
s_mov_b32 s43, 1065362610
v_mov_b32 v25, 1084047360
v_add_u32 v0, 32772, v24
v_add_u32 v1, 32780, v24
v_add_u32 v2, 32788, v24
v_add_u32 v3, 32796, v24
v_add_u32 v4, 32804, v24
v_add_u32 v5, 32812, v24
v_add_u32 v6, 32820, v24
v_add_u32 v7, 32828, v24
v_cvt_f32_f16 v0, v0
v_cvt_f32_f16 v1, v1
v_cvt_f32_f16 v2, v2
v_cvt_f32_f16 v3, v3
v_cvt_f32_f16 v4, v4
v_cvt_f32_f16 v5, v5
v_cvt_f32_f16 v6, v6
v_cvt_f32_f16 v7, v7
v_mul_f32 v8, v0, v0
v_mul_f32 v9, v1, v1
v_mul_f32 v10, v2, v2
v_mul_f32 v11, v3, v3
v_mul_f32 v12, v4, v4
v_mul_f32 v13, v5, v5
v_mul_f32 v14, v6, v6
v_mul_f32 v15, v7, v7
v_fma_f32 v8, v8, s43, v25
v_fma_f32 v9, v9, s43, v25
v_fma_f32 v10, v10, s43, v25
v_fma_f32 v11, v11, s43, v25
v_fma_f32 v12, v12, s43, v25
v_fma_f32 v13, v13, s43, v25
v_fma_f32 v14, v14, s43, v25
v_fma_f32 v15, v15, s43, v25
v_mul_f32 v8, v0, v8
v_mul_f32 v9, v1, v9
v_mul_f32 v10, v2, v10
v_mul_f32 v11, v3, v11
v_mul_f32 v12, v4, v12
v_mul_f32 v13, v5, v13
v_mul_f32 v14, v6, v14
v_mul_f32 v15, v7, v15
v_exp_f32 v8, v8
v_exp_f32 v9, v9
v_exp_f32 v10, v10
v_exp_f32 v11, v11
v_exp_f32 v12, v12
v_exp_f32 v13, v13
v_exp_f32 v14, v14
v_exp_f32 v15, v15
v_add_f32 v16, 1.0, v8
v_add_f32 v17, 1.0, v9
v_add_f32 v18, 1.0, v10
v_add_f32 v19, 1.0, v11
v_add_f32 v20, 1.0, v12
v_add_f32 v21, 1.0, v13
v_add_f32 v22, 1.0, v14
v_add_f32 v23, 1.0, v15
v_rcp_f32 v16, v16
v_rcp_f32 v17, v17
v_rcp_f32 v18, v18
v_rcp_f32 v19, v19
v_rcp_f32 v20, v20
v_rcp_f32 v21, v21
v_rcp_f32 v22, v22
v_rcp_f32 v23, v23
v_mul_f32 v0, v0, v16
v_mul_f32 v1, v1, v17
v_mul_f32 v2, v2, v18
v_mul_f32 v3, v3, v19
v_mul_f32 v4, v4, v20
v_mul_f32 v5, v5, v21
v_mul_f32 v6, v6, v22
v_mul_f32 v7, v7, v23
v_mul_f32 v8, v8, v0
v_mul_f32 v9, v9, v1
v_mul_f32 v10, v10, v2
v_mul_f32 v11, v11, v3
v_mul_f32 v12, v12, v4
v_mul_f32 v13, v13, v5
v_mul_f32 v14, v14, v6
v_mul_f32 v15, v15, v7
v_cvt_pk_f16_f32 v28, v0, v1
v_cvt_pk_f16_f32 v32, -v8, -v9
v_cvt_pk_f16_f32 v29, v2, v3
v_cvt_pk_f16_f32 v33, -v10, -v11
v_cvt_pk_f16_f32 v30, v4, v5
v_cvt_pk_f16_f32 v34, -v12, -v13
v_cvt_pk_f16_f32 v31, v6, v7
v_cvt_pk_f16_f32 v35, -v14, -v15
v_lshlrev_b32_e64 v24, 4, v199
v_mov_b32 v25, 163840
s_movk_i32 s43, 496
v_cmp_gt_u32 vcc, s43, v199
s_nop 1
v_cndmask_b32 v24, v25, v24, vcc
ds_write_b128 v24, v[32:35]
ds_write_b128 v24, v[28:31] offset:8192
Lnoy:
s_cmp_ge_u32 s40, 4
s_cbranch_scc1 Lnoo
v_add_u32_e64 v152, 0, v199
v_mul_u32_u24 v140, 683, v152
v_lshrrev_b32 v140, 16, v140
v_mul_u32_u24 v142, 11, v140
v_lshrrev_b32 v142, 5, v142
v_lshrrev_b32 v143, 5, v152
v_bfe_u32 v141, v152, 3, 2
v_bfe_u32 v144, v152, 4, 1
v_xor_b32 v141, v141, v144
v_sub_u32 v141, v141, v142
v_mul_i32_i24 v141, 9, v141
v_add_u32 v143, v143, v141
v_lshrrev_b32_e64 v141, 1, v143
v_mul_u32_u24 v141, 368, v141
v_lshl_add_u32 v143, v143, 3, v141
v_lshl_add_u32 v143, v142, 7, v143
v_and_b32_e64 v144, 7, v152
v_lshl_add_u32 v143, v144, 4, v143
v_add_u32 v156, 156672, v143
v_add_u32 v153, 256, v199
v_mul_u32_u24 v140, 683, v153
v_lshrrev_b32 v140, 16, v140
v_mul_u32_u24 v142, 11, v140
v_lshrrev_b32 v142, 5, v142
v_lshrrev_b32 v143, 5, v153
v_bfe_u32 v141, v153, 3, 2
v_bfe_u32 v144, v153, 4, 1
v_xor_b32 v141, v141, v144
v_sub_u32 v141, v141, v142
v_mul_i32_i24 v141, 9, v141
v_add_u32 v143, v143, v141
v_lshrrev_b32_e64 v141, 1, v143
v_mul_u32_u24 v141, 368, v141
v_lshl_add_u32 v143, v143, 3, v141
v_lshl_add_u32 v143, v142, 7, v143
v_and_b32_e64 v144, 7, v153
v_lshl_add_u32 v143, v144, 4, v143
v_add_u32 v157, 156672, v143
v_add_u32 v154, 512, v199
v_mul_u32_u24 v140, 683, v154
v_lshrrev_b32 v140, 16, v140
v_mul_u32_u24 v142, 11, v140
v_lshrrev_b32 v142, 5, v142
v_lshrrev_b32 v143, 5, v154
v_bfe_u32 v141, v154, 3, 2
v_bfe_u32 v144, v154, 4, 1
v_xor_b32 v141, v141, v144
v_sub_u32 v141, v141, v142
v_mul_i32_i24 v141, 9, v141
v_add_u32 v143, v143, v141
v_lshrrev_b32_e64 v141, 1, v143
v_mul_u32_u24 v141, 368, v141
v_lshl_add_u32 v143, v143, 3, v141
v_lshl_add_u32 v143, v142, 7, v143
v_and_b32_e64 v144, 7, v154
v_lshl_add_u32 v143, v144, 4, v143
v_add_u32 v158, 156672, v143
v_mul_u32_u24 v140, 683, v155
v_lshrrev_b32 v140, 16, v140
v_mul_u32_u24 v142, 11, v140
v_lshrrev_b32 v142, 5, v142
v_lshrrev_b32 v143, 5, v155
v_bfe_u32 v141, v155, 3, 2
v_bfe_u32 v144, v155, 4, 1
v_xor_b32 v141, v141, v144
v_sub_u32 v141, v141, v142
v_mul_i32_i24 v141, 9, v141
v_add_u32 v143, v143, v141
v_lshrrev_b32_e64 v141, 1, v143
v_mul_u32_u24 v141, 368, v141
v_lshl_add_u32 v143, v143, 3, v141
v_lshl_add_u32 v143, v142, 7, v143
v_and_b32_e64 v144, 7, v155
v_lshl_add_u32 v143, v144, 4, v143
v_add_u32 v159, 156672, v143
v_mov_b32 v160, 0
v_mov_b32 v161, 0
v_mov_b32_e64 v162, 0
v_mov_b32 v163, 0
s_mov_b64 exec, 1
ds_write_b128 v253, v[160:163]
ds_write_b128 v253, v[160:163] offset:16
s_mov_b64 exec, -1
s_waitcnt vmcnt(6)
v_and_b32_e64 v130, 4, v152
v_cmp_eq_u32 vcc, 0, v130
s_nop 1
v_cndmask_b32 v164, 0, v126, vcc
v_sub_u32 v165, v126, v164
ds_write_b64 v156, v[164:165]
v_and_b32_e64 v130, 4, v153
v_cmp_eq_u32 vcc, 0, v130
s_nop 1
v_cndmask_b32 v166, 0, v127, vcc
v_sub_u32 v167, v127, v166
ds_write_b64 v157, v[166:167]
v_and_b32_e64 v130, 4, v154
v_cmp_eq_u32 vcc, 0, v130
s_nop 1
v_cndmask_b32 v168, 0, v128, vcc
v_sub_u32 v169, v128, v168
ds_write_b64 v158, v[168:169]
v_and_b32_e64 v130, 4, v155
v_cmp_eq_u32 vcc, 0, v130
s_nop 1
v_cndmask_b32 v170, 0, v129, vcc
v_sub_u32 v171, v129, v170
ds_write_b64 v159, v[170:171]
s_waitcnt lgkmcnt(0)
Lnoo:
s_barrier
s_cmp_lt_u32 s40, 4
s_cbranch_scc1 Lnoy2
v_subrev_u32 v199, 256, v199
v_lshlrev_b32_e64 v24, 6, v199
s_mov_b32 s43, 1065362610
v_mov_b32 v25, 1084047360
v_add_u32 v0, 32772, v24
v_add_u32 v1, 32780, v24
v_add_u32 v2, 32788, v24
v_add_u32 v3, 32796, v24
v_add_u32 v4, 32804, v24
v_add_u32 v5, 32812, v24
v_add_u32 v6, 32820, v24
v_add_u32 v7, 32828, v24
v_cvt_f32_f16 v0, v0
v_cvt_f32_f16 v1, v1
v_cvt_f32_f16 v2, v2
v_cvt_f32_f16 v3, v3
v_cvt_f32_f16 v4, v4
v_cvt_f32_f16 v5, v5
v_cvt_f32_f16 v6, v6
v_cvt_f32_f16 v7, v7
v_mul_f32 v8, v0, v0
v_mul_f32 v9, v1, v1
v_mul_f32 v10, v2, v2
v_mul_f32 v11, v3, v3
v_mul_f32 v12, v4, v4
v_mul_f32 v13, v5, v5
v_mul_f32 v14, v6, v6
v_mul_f32 v15, v7, v7
v_fma_f32 v8, v8, s43, v25
v_fma_f32 v9, v9, s43, v25
v_fma_f32 v10, v10, s43, v25
v_fma_f32 v11, v11, s43, v25
v_fma_f32 v12, v12, s43, v25
v_fma_f32 v13, v13, s43, v25
v_fma_f32 v14, v14, s43, v25
v_fma_f32 v15, v15, s43, v25
v_mul_f32 v8, v0, v8
v_mul_f32 v9, v1, v9
v_mul_f32 v10, v2, v10
v_mul_f32 v11, v3, v11
v_mul_f32 v12, v4, v12
v_mul_f32 v13, v5, v13
v_mul_f32 v14, v6, v14
v_mul_f32 v15, v7, v15
v_exp_f32 v8, v8
v_exp_f32 v9, v9
v_exp_f32 v10, v10
v_exp_f32 v11, v11
v_exp_f32 v12, v12
v_exp_f32 v13, v13
v_exp_f32 v14, v14
v_exp_f32 v15, v15
v_add_f32 v16, 1.0, v8
v_add_f32 v17, 1.0, v9
v_add_f32 v18, 1.0, v10
v_add_f32 v19, 1.0, v11
v_add_f32 v20, 1.0, v12
v_add_f32 v21, 1.0, v13
v_add_f32 v22, 1.0, v14
v_add_f32 v23, 1.0, v15
v_rcp_f32 v16, v16
v_rcp_f32 v17, v17
v_rcp_f32 v18, v18
v_rcp_f32 v19, v19
v_rcp_f32 v20, v20
v_rcp_f32 v21, v21
v_rcp_f32 v22, v22
v_rcp_f32 v23, v23
v_mul_f32 v0, v0, v16
v_mul_f32 v1, v1, v17
v_mul_f32 v2, v2, v18
v_mul_f32 v3, v3, v19
v_mul_f32 v4, v4, v20
v_mul_f32 v5, v5, v21
v_mul_f32 v6, v6, v22
v_mul_f32 v7, v7, v23
v_mul_f32 v8, v8, v0
v_mul_f32 v9, v9, v1
v_mul_f32 v10, v10, v2
v_mul_f32 v11, v11, v3
v_mul_f32 v12, v12, v4
v_mul_f32 v13, v13, v5
v_mul_f32 v14, v14, v6
v_mul_f32 v15, v15, v7
v_cvt_pk_f16_f32 v28, v0, v1
v_cvt_pk_f16_f32 v32, -v8, -v9
v_cvt_pk_f16_f32 v29, v2, v3
v_cvt_pk_f16_f32 v33, -v10, -v11
v_cvt_pk_f16_f32 v30, v4, v5
v_cvt_pk_f16_f32 v34, -v12, -v13
v_cvt_pk_f16_f32 v31, v6, v7
v_cvt_pk_f16_f32 v35, -v14, -v15
v_lshlrev_b32_e64 v24, 4, v199
v_mov_b32 v25, 163840
s_movk_i32 s43, 496
v_cmp_gt_u32 vcc, s43, v199
s_nop 1
v_cndmask_b32 v24, v25, v24, vcc
ds_write_b128 v24, v[32:35]
ds_write_b128 v24, v[28:31] offset:8192
Lnoy2:
s_setprio 2
s_cmp_lt_u32 s40, 4
s_cbranch_scc0 Lsu0
s_call_b64 s[78:79], Lpre
s_call_b64 s[78:79], Lrb
s_waitcnt vmcnt(4)
s_mov_b64 exec, 1
ds_add_u32 v253, v254 offset:28
s_mov_b64 exec, -1
v_mov_b32 v253, 16256
Lsw288w:
ds_read_b32 v247, v253 offset:28
s_waitcnt lgkmcnt(0)
v_readfirstlane_b32 s43, v247
s_cmp_eq_u32 s76, 0
s_cbranch_scc1 Lsw288x
s_sub_u32 s76, s76, 1
s_cmp_lt_u32 s43, 8
s_cbranch_scc0 Lsw288x
s_sleep 2
s_branch Lsw288w
Lsw288x:
s_call_b64 s[78:79], Lconv0
s_mov_b64 exec, 1
ds_add_u32 v253, v254 offset:16
s_mov_b64 exec, -1
s_call_b64 s[78:79], Lln0
s_waitcnt vmcnt(0)
s_mov_b64 exec, 1
ds_add_u32 v253, v254 offset:12
s_mov_b64 exec, -1
s_call_b64 s[78:79], Lw1i
Lsu0:
s_cmp_ge_u32 s40, 4
s_cbranch_scc0 Lsu2
s_setprio 3
s_call_b64 s[78:79], Lw1f
s_waitcnt vmcnt(6)
s_mov_b64 exec, 1
ds_add_u32 v253, v254 offset:28
s_mov_b64 exec, -1
s_call_b64 s[78:79], Lrb
s_waitcnt vmcnt(4)
s_call_b64 s[78:79], Lw1a
s_mov_b64 exec, 1
ds_add_u32 v253, v254 offset:20
s_mov_b64 exec, -1
s_call_b64 s[78:79], Lpre
s_waitcnt vmcnt(0)
s_mov_b64 exec, 1
ds_add_u32 v253, v254 offset:12
s_mov_b64 exec, -1
v_mov_b32 v253, 16256
Lsw128w:
ds_read_b32 v247, v253 offset:12
s_waitcnt lgkmcnt(0)
v_readfirstlane_b32 s43, v247
s_cmp_eq_u32 s76, 0
s_cbranch_scc1 Lsw128x
s_sub_u32 s76, s76, 1
s_cmp_lt_u32 s43, 8
s_cbranch_scc0 Lsw128x
s_sleep 2
s_branch Lsw128w
Lsw128x:
s_call_b64 s[78:79], Lconv0
s_mov_b64 exec, 1
ds_add_u32 v253, v254 offset:16
s_mov_b64 exec, -1
s_call_b64 s[78:79], Lln0
Lsu2:
s_branch Lgo
Lconv0:
ds_read_b128 v[192:195], v242
ds_read_b128 v[196:199], v242 offset:64
ds_read_b128 v[200:203], v242 offset:128
ds_read_b128 v[204:207], v243
ds_read_b128 v[208:211], v243 offset:64
ds_read_b128 v[212:215], v243 offset:128
ds_read_b128 v[224:227], v244
ds_read_b128 v[228:231], v244 offset:64
ds_read_b128 v[232:235], v244 offset:128
v_xor_b32 v242, 16, v242
ds_read_b128 v[236:239], v242
ds_read_b128 v[216:219], v242 offset:64
ds_read_b128 v[220:223], v242 offset:128
s_waitcnt lgkmcnt(11)
v_smfmac_f32_16x16x32_bf16 v[0:3], v[48:49], v[192:195], v246
s_waitcnt lgkmcnt(10)
v_smfmac_f32_16x16x32_bf16 v[16:19], v[50:51], v[196:199], v246
s_waitcnt lgkmcnt(9)
v_smfmac_f32_16x16x32_bf16 v[32:35], v[52:53], v[200:203], v246
s_waitcnt lgkmcnt(8)
v_xor_b32 v243, 16, v243
ds_read_b128 v[192:195], v243
ds_read_b128 v[196:199], v243 offset:64
v_smfmac_f32_16x16x32_bf16 v[0:3], v[54:55], v[204:207], v246
s_waitcnt lgkmcnt(9)
v_smfmac_f32_16x16x32_bf16 v[16:19], v[56:57], v[208:211], v246
s_waitcnt lgkmcnt(8)
ds_read_b128 v[200:203], v243 offset:128
v_xor_b32 v244, 16, v244
ds_read_b128 v[204:207], v244
v_smfmac_f32_16x16x32_bf16 v[32:35], v[58:59], v[212:215], v246
s_waitcnt lgkmcnt(9)
v_smfmac_f32_16x16x32_bf16 v[0:3], v[60:61], v[224:227], v246
s_waitcnt lgkmcnt(8)
ds_read_b128 v[208:211], v244 offset:64
ds_read_b128 v[212:215], v244 offset:128
v_smfmac_f32_16x16x32_bf16 v[16:19], v[62:63], v[228:231], v246
s_waitcnt lgkmcnt(9)
v_smfmac_f32_16x16x32_bf16 v[32:35], v[64:65], v[232:235], v246
s_waitcnt lgkmcnt(8)
v_xor_b32 v242, 32, v242
ds_read_b128 v[224:227], v242
ds_read_b128 v[228:231], v242 offset:64
v_smfmac_f32_16x16x32_bf16 v[4:7], v[66:67], v[236:239], v246
s_waitcnt lgkmcnt(9)
v_smfmac_f32_16x16x32_bf16 v[20:23], v[68:69], v[216:219], v246
s_waitcnt lgkmcnt(8)
ds_read_b128 v[232:235], v242 offset:128
v_xor_b32 v243, 32, v243
ds_read_b128 v[236:239], v243
v_smfmac_f32_16x16x32_bf16 v[36:39], v[70:71], v[220:223], v246
s_waitcnt lgkmcnt(9)
v_smfmac_f32_16x16x32_bf16 v[4:7], v[72:73], v[192:195], v246
s_waitcnt lgkmcnt(8)
ds_read_b128 v[216:219], v243 offset:64
ds_read_b128 v[220:223], v243 offset:128
v_smfmac_f32_16x16x32_bf16 v[20:23], v[74:75], v[196:199], v246
s_waitcnt lgkmcnt(9)
v_smfmac_f32_16x16x32_bf16 v[36:39], v[76:77], v[200:203], v246
s_waitcnt lgkmcnt(8)
v_xor_b32 v244, 32, v244
ds_read_b128 v[192:195], v244
ds_read_b128 v[196:199], v244 offset:64
v_smfmac_f32_16x16x32_bf16 v[4:7], v[78:79], v[204:207], v246
s_waitcnt lgkmcnt(9)
v_smfmac_f32_16x16x32_bf16 v[20:23], v[80:81], v[208:211], v246
s_waitcnt lgkmcnt(8)
ds_read_b128 v[200:203], v244 offset:128
v_xor_b32 v242, 16, v242
ds_read_b128 v[204:207], v242
v_smfmac_f32_16x16x32_bf16 v[36:39], v[82:83], v[212:215], v246
s_waitcnt lgkmcnt(9)
v_smfmac_f32_16x16x32_bf16 v[12:15], v[84:85], v[224:227], v246
s_waitcnt lgkmcnt(8)
ds_read_b128 v[208:211], v242 offset:64
ds_read_b128 v[212:215], v242 offset:128
v_smfmac_f32_16x16x32_bf16 v[28:31], v[86:87], v[228:231], v246
s_waitcnt lgkmcnt(9)
v_smfmac_f32_16x16x32_bf16 v[44:47], v[88:89], v[232:235], v246
s_waitcnt lgkmcnt(8)
v_xor_b32 v243, 16, v243
ds_read_b128 v[224:227], v243
ds_read_b128 v[228:231], v243 offset:64
v_smfmac_f32_16x16x32_bf16 v[12:15], v[90:91], v[236:239], v246
s_waitcnt lgkmcnt(9)
v_smfmac_f32_16x16x32_bf16 v[28:31], v[92:93], v[216:219], v246
s_waitcnt lgkmcnt(8)
ds_read_b128 v[232:235], v243 offset:128
v_xor_b32 v244, 16, v244
ds_read_b128 v[236:239], v244
v_smfmac_f32_16x16x32_bf16 v[44:47], v[94:95], v[220:223], v246
s_waitcnt lgkmcnt(9)
v_smfmac_f32_16x16x32_bf16 v[12:15], v[96:97], v[192:195], v246
s_waitcnt lgkmcnt(8)
ds_read_b128 v[216:219], v244 offset:64
ds_read_b128 v[220:223], v244 offset:128
v_smfmac_f32_16x16x32_bf16 v[28:31], v[98:99], v[196:199], v246
s_waitcnt lgkmcnt(9)
v_smfmac_f32_16x16x32_bf16 v[44:47], v[100:101], v[200:203], v246
s_waitcnt lgkmcnt(8)
v_smfmac_f32_16x16x32_bf16 v[8:11], v[102:103], v[204:207], v246
s_waitcnt lgkmcnt(7)
v_smfmac_f32_16x16x32_bf16 v[24:27], v[104:105], v[208:211], v246
s_waitcnt lgkmcnt(6)
v_smfmac_f32_16x16x32_bf16 v[40:43], v[106:107], v[212:215], v246
s_waitcnt lgkmcnt(5)
v_smfmac_f32_16x16x32_bf16 v[8:11], v[108:109], v[224:227], v246
s_waitcnt lgkmcnt(4)
v_smfmac_f32_16x16x32_bf16 v[24:27], v[110:111], v[228:231], v246
s_waitcnt lgkmcnt(3)
v_smfmac_f32_16x16x32_bf16 v[40:43], v[112:113], v[232:235], v246
s_waitcnt lgkmcnt(2)
v_smfmac_f32_16x16x32_bf16 v[8:11], v[114:115], v[236:239], v246
s_waitcnt lgkmcnt(1)
v_smfmac_f32_16x16x32_bf16 v[24:27], v[116:117], v[216:219], v246
s_waitcnt lgkmcnt(0)
v_smfmac_f32_16x16x32_bf16 v[40:43], v[118:119], v[220:223], v246
s_nop 11
s_setpc_b64 s[78:79]
Lln0:
v_pk_add_f32 v[168:169], v[0:1], v[2:3]
v_pk_mul_f32 v[170:171], v[0:1], v[0:1]
v_pk_fma_f32 v[170:171], v[2:3], v[2:3], v[170:171]
v_pk_add_f32 v[168:169], v[168:169], v[4:5]
v_pk_fma_f32 v[170:171], v[4:5], v[4:5], v[170:171]
v_pk_add_f32 v[168:169], v[168:169], v[6:7]
v_pk_fma_f32 v[170:171], v[6:7], v[6:7], v[170:171]
v_pk_add_f32 v[168:169], v[168:169], v[8:9]
v_pk_fma_f32 v[170:171], v[8:9], v[8:9], v[170:171]
v_pk_add_f32 v[168:169], v[168:169], v[10:11]
v_pk_fma_f32 v[170:171], v[10:11], v[10:11], v[170:171]
v_pk_add_f32 v[168:169], v[168:169], v[12:13]
v_pk_fma_f32 v[170:171], v[12:13], v[12:13], v[170:171]
v_pk_add_f32 v[168:169], v[168:169], v[14:15]
v_pk_fma_f32 v[170:171], v[14:15], v[14:15], v[170:171]
v_pk_add_f32 v[168:169], v[168:169], v[16:17]
v_pk_fma_f32 v[170:171], v[16:17], v[16:17], v[170:171]
v_pk_add_f32 v[168:169], v[168:169], v[18:19]
v_pk_fma_f32 v[170:171], v[18:19], v[18:19], v[170:171]
v_pk_add_f32 v[168:169], v[168:169], v[20:21]
v_pk_fma_f32 v[170:171], v[20:21], v[20:21], v[170:171]
v_pk_add_f32 v[168:169], v[168:169], v[22:23]
v_pk_fma_f32 v[170:171], v[22:23], v[22:23], v[170:171]
v_pk_add_f32 v[168:169], v[168:169], v[24:25]
v_pk_fma_f32 v[170:171], v[24:25], v[24:25], v[170:171]
v_pk_add_f32 v[168:169], v[168:169], v[26:27]
v_pk_fma_f32 v[170:171], v[26:27], v[26:27], v[170:171]
v_pk_add_f32 v[168:169], v[168:169], v[28:29]
v_pk_fma_f32 v[170:171], v[28:29], v[28:29], v[170:171]
v_pk_add_f32 v[168:169], v[168:169], v[30:31]
v_pk_fma_f32 v[170:171], v[30:31], v[30:31], v[170:171]
v_pk_add_f32 v[168:169], v[168:169], v[32:33]
v_pk_fma_f32 v[170:171], v[32:33], v[32:33], v[170:171]
v_pk_add_f32 v[168:169], v[168:169], v[34:35]
v_pk_fma_f32 v[170:171], v[34:35], v[34:35], v[170:171]
v_pk_add_f32 v[168:169], v[168:169], v[36:37]
v_pk_fma_f32 v[170:171], v[36:37], v[36:37], v[170:171]
v_pk_add_f32 v[168:169], v[168:169], v[38:39]
v_pk_fma_f32 v[170:171], v[38:39], v[38:39], v[170:171]
v_pk_add_f32 v[168:169], v[168:169], v[40:41]
v_pk_fma_f32 v[170:171], v[40:41], v[40:41], v[170:171]
v_pk_add_f32 v[168:169], v[168:169], v[42:43]
v_pk_fma_f32 v[170:171], v[42:43], v[42:43], v[170:171]
v_pk_add_f32 v[168:169], v[168:169], v[44:45]
v_pk_fma_f32 v[170:171], v[44:45], v[44:45], v[170:171]
v_pk_add_f32 v[168:169], v[168:169], v[46:47]
v_pk_fma_f32 v[170:171], v[46:47], v[46:47], v[170:171]
v_add_f32 v168, v168, v169
v_add_f32 v170, v170, v171
s_nop 1
v_permlane32_swap_b32 v168, v170
v_add_f32_e64 v168, v168, v170
v_mul_f32 v168, 1009429163, v168
v_mov_b32_e64 v170, v168
s_nop 1
v_permlane32_swap_b32 v168, v170
v_fma_f32 v170, -v168, v168, v170
v_max_f32_e64 v170, 0, v170
v_add_f32 v170, 925353388, v170
v_rsq_f32 v170, v170
s_nop 0
v_mul_f32 v172, 3203391086, v170
v_mul_f32_e64 v173, v168, v172
v_pk_fma_f32 v[0:1], v[0:1], v[172:173], v[172:173] op_sel:[0,0,1] op_sel_hi:[1,0,1] neg_lo:[0,0,1] neg_hi:[0,0,1]
v_pk_fma_f32 v[2:3], v[2:3], v[172:173], v[172:173] op_sel:[0,0,1] op_sel_hi:[1,0,1] neg_lo:[0,0,1] neg_hi:[0,0,1]
v_pk_fma_f32 v[4:5], v[4:5], v[172:173], v[172:173] op_sel:[0,0,1] op_sel_hi:[1,0,1] neg_lo:[0,0,1] neg_hi:[0,0,1]
v_pk_fma_f32 v[6:7], v[6:7], v[172:173], v[172:173] op_sel:[0,0,1] op_sel_hi:[1,0,1] neg_lo:[0,0,1] neg_hi:[0,0,1]
v_pk_fma_f32 v[8:9], v[8:9], v[172:173], v[172:173] op_sel:[0,0,1] op_sel_hi:[1,0,1] neg_lo:[0,0,1] neg_hi:[0,0,1]
v_pk_fma_f32 v[10:11], v[10:11], v[172:173], v[172:173] op_sel:[0,0,1] op_sel_hi:[1,0,1] neg_lo:[0,0,1] neg_hi:[0,0,1]
v_pk_fma_f32 v[12:13], v[12:13], v[172:173], v[172:173] op_sel:[0,0,1] op_sel_hi:[1,0,1] neg_lo:[0,0,1] neg_hi:[0,0,1]
v_pk_fma_f32 v[14:15], v[14:15], v[172:173], v[172:173] op_sel:[0,0,1] op_sel_hi:[1,0,1] neg_lo:[0,0,1] neg_hi:[0,0,1]
v_pk_fma_f32 v[16:17], v[16:17], v[172:173], v[172:173] op_sel:[0,0,1] op_sel_hi:[1,0,1] neg_lo:[0,0,1] neg_hi:[0,0,1]
v_pk_fma_f32 v[18:19], v[18:19], v[172:173], v[172:173] op_sel:[0,0,1] op_sel_hi:[1,0,1] neg_lo:[0,0,1] neg_hi:[0,0,1]
v_pk_fma_f32 v[20:21], v[20:21], v[172:173], v[172:173] op_sel:[0,0,1] op_sel_hi:[1,0,1] neg_lo:[0,0,1] neg_hi:[0,0,1]
v_pk_fma_f32 v[22:23], v[22:23], v[172:173], v[172:173] op_sel:[0,0,1] op_sel_hi:[1,0,1] neg_lo:[0,0,1] neg_hi:[0,0,1]
v_pk_fma_f32 v[24:25], v[24:25], v[172:173], v[172:173] op_sel:[0,0,1] op_sel_hi:[1,0,1] neg_lo:[0,0,1] neg_hi:[0,0,1]
v_pk_fma_f32 v[26:27], v[26:27], v[172:173], v[172:173] op_sel:[0,0,1] op_sel_hi:[1,0,1] neg_lo:[0,0,1] neg_hi:[0,0,1]
v_pk_fma_f32 v[28:29], v[28:29], v[172:173], v[172:173] op_sel:[0,0,1] op_sel_hi:[1,0,1] neg_lo:[0,0,1] neg_hi:[0,0,1]
v_pk_fma_f32 v[30:31], v[30:31], v[172:173], v[172:173] op_sel:[0,0,1] op_sel_hi:[1,0,1] neg_lo:[0,0,1] neg_hi:[0,0,1]
v_pk_fma_f32 v[32:33], v[32:33], v[172:173], v[172:173] op_sel:[0,0,1] op_sel_hi:[1,0,1] neg_lo:[0,0,1] neg_hi:[0,0,1]
v_pk_fma_f32 v[34:35], v[34:35], v[172:173], v[172:173] op_sel:[0,0,1] op_sel_hi:[1,0,1] neg_lo:[0,0,1] neg_hi:[0,0,1]
v_pk_fma_f32 v[36:37], v[36:37], v[172:173], v[172:173] op_sel:[0,0,1] op_sel_hi:[1,0,1] neg_lo:[0,0,1] neg_hi:[0,0,1]
v_pk_fma_f32 v[38:39], v[38:39], v[172:173], v[172:173] op_sel:[0,0,1] op_sel_hi:[1,0,1] neg_lo:[0,0,1] neg_hi:[0,0,1]
v_pk_fma_f32 v[40:41], v[40:41], v[172:173], v[172:173] op_sel:[0,0,1] op_sel_hi:[1,0,1] neg_lo:[0,0,1] neg_hi:[0,0,1]
v_pk_fma_f32 v[42:43], v[42:43], v[172:173], v[172:173] op_sel:[0,0,1] op_sel_hi:[1,0,1] neg_lo:[0,0,1] neg_hi:[0,0,1]
v_pk_fma_f32 v[44:45], v[44:45], v[172:173], v[172:173] op_sel:[0,0,1] op_sel_hi:[1,0,1] neg_lo:[0,0,1] neg_hi:[0,0,1]
v_pk_fma_f32 v[46:47], v[46:47], v[172:173], v[172:173] op_sel:[0,0,1] op_sel_hi:[1,0,1] neg_lo:[0,0,1] neg_hi:[0,0,1]
v_cvt_pk_bf16_f32 v48, v0, v1
v_cvt_pk_bf16_f32 v49, v2, v3
v_cvt_pk_bf16_f32 v50, v4, v5
v_cvt_pk_bf16_f32 v51, v6, v7
v_cvt_pk_bf16_f32 v52, v8, v9
v_cvt_pk_bf16_f32 v53, v10, v11
v_cvt_pk_bf16_f32 v54, v12, v13
v_cvt_pk_bf16_f32 v55, v14, v15
v_cvt_pk_bf16_f32 v56, v16, v17
v_cvt_pk_bf16_f32 v57, v18, v19
v_cvt_pk_bf16_f32 v58, v20, v21
v_cvt_pk_bf16_f32 v59, v22, v23
v_cvt_pk_bf16_f32 v60, v24, v25
v_cvt_pk_bf16_f32 v61, v26, v27
v_cvt_pk_bf16_f32 v62, v28, v29
v_cvt_pk_bf16_f32 v63, v30, v31
v_cvt_pk_bf16_f32 v64, v32, v33
v_cvt_pk_bf16_f32 v65, v34, v35
v_cvt_pk_bf16_f32 v66, v36, v37
v_cvt_pk_bf16_f32 v67, v38, v39
v_cvt_pk_bf16_f32 v68, v40, v41
v_cvt_pk_bf16_f32 v69, v42, v43
v_cvt_pk_bf16_f32 v70, v44, v45
v_cvt_pk_bf16_f32 v71, v46, v47
s_nop 1
s_setpc_b64 s[78:79]
Lw1a:
ds_read_b64_tr_b16 v[148:149], v190
ds_read_b64_tr_b16 v[150:151], v190 offset:512
ds_read_b64_tr_b16 v[152:153], v190 offset:1024
ds_read_b64_tr_b16 v[154:155], v190 offset:1536
ds_read_b64_tr_b16 v[156:157], v190 offset:2048
ds_read_b64_tr_b16 v[158:159], v190 offset:2560
ds_read_b64_tr_b16 v[160:161], v190 offset:3072
ds_read_b64_tr_b16 v[162:163], v190 offset:3584
ds_read_b64_tr_b16 v[164:165], v190 offset:4096
ds_read_b64_tr_b16 v[166:167], v190 offset:4608
ds_read_b64_tr_b16 v[168:169], v190 offset:5120
ds_read_b64_tr_b16 v[170:171], v190 offset:5632
s_waitcnt lgkmcnt(10)
ds_write_b128 v191, v[148:151]
s_waitcnt lgkmcnt(9)
ds_write_b128 v191, v[152:155] offset:1024
s_waitcnt lgkmcnt(8)
ds_write_b128 v191, v[156:159] offset:2048
s_waitcnt lgkmcnt(7)
ds_write_b128 v191, v[160:163] offset:3072
s_waitcnt lgkmcnt(6)
ds_write_b128 v191, v[164:167] offset:4096
s_waitcnt lgkmcnt(5)
ds_write_b128 v191, v[168:171] offset:5120
s_waitcnt lgkmcnt(0)
s_setpc_b64 s[78:79]
Lw1i:
s_add_u32 m0, s77, 24576
s_add_u32 s43, s3, 256
buffer_load_dwordx4 v189, s[12:15], s43 offen lds
s_add_u32 m0, s77, 25600
s_add_u32 s43, s3, 24832
buffer_load_dwordx4 v189, s[12:15], s43 offen lds
s_add_u32 m0, s77, 26624
s_add_u32 s43, s3, 49408
buffer_load_dwordx4 v189, s[12:15], s43 offen lds
s_add_u32 m0, s77, 27648
s_add_u32 s43, s3, 12544
buffer_load_dwordx4 v189, s[12:15], s43 offen lds
s_add_u32 m0, s77, 28672
s_add_u32 s43, s3, 37120
buffer_load_dwordx4 v189, s[12:15], s43 offen lds
s_add_u32 m0, s77, 29696
s_add_u32 s43, s3, 61696
buffer_load_dwordx4 v189, s[12:15], s43 offen lds
s_add_u32 m0, s77, 49152
s_add_u32 s43, s3, 512
buffer_load_dwordx4 v189, s[12:15], s43 offen lds
s_add_u32 m0, s77, 50176
s_add_u32 s43, s3, 25088
buffer_load_dwordx4 v189, s[12:15], s43 offen lds
s_add_u32 m0, s77, 51200
s_add_u32 s43, s3, 49664
buffer_load_dwordx4 v189, s[12:15], s43 offen lds
s_add_u32 m0, s77, 52224
s_add_u32 s43, s3, 12800
buffer_load_dwordx4 v189, s[12:15], s43 offen lds
s_add_u32 m0, s77, 53248
s_add_u32 s43, s3, 37376
buffer_load_dwordx4 v189, s[12:15], s43 offen lds
s_add_u32 m0, s77, 54272
s_add_u32 s43, s3, 61952
buffer_load_dwordx4 v189, s[12:15], s43 offen lds
s_setpc_b64 s[78:79]
Lw1b:
ds_read_b64_tr_b16 v[72:73], v190 offset:24576
ds_read_b64_tr_b16 v[74:75], v190 offset:25088
ds_read_b64_tr_b16 v[76:77], v190 offset:25600
ds_read_b64_tr_b16 v[78:79], v190 offset:26112
ds_read_b64_tr_b16 v[80:81], v190 offset:26624
ds_read_b64_tr_b16 v[82:83], v190 offset:27136
ds_read_b64_tr_b16 v[84:85], v190 offset:27648
ds_read_b64_tr_b16 v[86:87], v190 offset:28160
ds_read_b64_tr_b16 v[88:89], v190 offset:28672
ds_read_b64_tr_b16 v[90:91], v190 offset:29184
ds_read_b64_tr_b16 v[92:93], v190 offset:29696
ds_read_b64_tr_b16 v[94:95], v190 offset:30208
s_waitcnt lgkmcnt(10)
ds_write_b128 v191, v[72:75] offset:24576
s_waitcnt lgkmcnt(9)
ds_write_b128 v191, v[76:79] offset:25600
s_waitcnt lgkmcnt(8)
ds_write_b128 v191, v[80:83] offset:26624
s_waitcnt lgkmcnt(7)
ds_write_b128 v191, v[84:87] offset:27648
s_waitcnt lgkmcnt(6)
ds_write_b128 v191, v[88:91] offset:28672
s_waitcnt lgkmcnt(5)
ds_write_b128 v191, v[92:95] offset:29696
s_waitcnt lgkmcnt(0)
s_setpc_b64 s[78:79]
Lw1c:
ds_read_b64_tr_b16 v[72:73], v190 offset:49152
ds_read_b64_tr_b16 v[74:75], v190 offset:49664
ds_read_b64_tr_b16 v[76:77], v190 offset:50176
ds_read_b64_tr_b16 v[78:79], v190 offset:50688
ds_read_b64_tr_b16 v[80:81], v190 offset:51200
ds_read_b64_tr_b16 v[82:83], v190 offset:51712
ds_read_b64_tr_b16 v[84:85], v190 offset:52224
ds_read_b64_tr_b16 v[86:87], v190 offset:52736
ds_read_b64_tr_b16 v[88:89], v190 offset:53248
ds_read_b64_tr_b16 v[90:91], v190 offset:53760
ds_read_b64_tr_b16 v[92:93], v190 offset:54272
ds_read_b64_tr_b16 v[94:95], v190 offset:54784
s_waitcnt lgkmcnt(10)
ds_write_b128 v191, v[72:75] offset:49152
s_waitcnt lgkmcnt(9)
ds_write_b128 v191, v[76:79] offset:50176
s_waitcnt lgkmcnt(8)
ds_write_b128 v191, v[80:83] offset:51200
s_waitcnt lgkmcnt(7)
ds_write_b128 v191, v[84:87] offset:52224
s_waitcnt lgkmcnt(6)
ds_write_b128 v191, v[88:91] offset:53248
s_waitcnt lgkmcnt(5)
ds_write_b128 v191, v[92:95] offset:54272
s_waitcnt lgkmcnt(0)
s_setpc_b64 s[78:79]
Lpre:
ds_read_b128 v[48:51], v245
ds_read_b128 v[52:55], v245 offset:384
ds_read_b128 v[56:59], v245 offset:768
ds_read_b128 v[60:63], v245 offset:1152
ds_read_b128 v[64:67], v245 offset:1536
ds_read_b128 v[68:71], v245 offset:1920
ds_read_b128 v[72:75], v245 offset:2304
ds_read_b128 v[76:79], v245 offset:2688
ds_read_b128 v[80:83], v245 offset:3072
ds_read_b128 v[84:87], v245 offset:3456
ds_read_b128 v[88:91], v245 offset:3840
ds_read_b128 v[92:95], v245 offset:4224
ds_read_b128 v[96:99], v245 offset:4608
ds_read_b128 v[100:103], v245 offset:4992
ds_read_b128 v[104:107], v245 offset:5376
ds_read_b128 v[108:111], v245 offset:5760
ds_read_b128 v[112:115], v245 offset:6144
ds_read_b128 v[116:119], v245 offset:6528
v_mov_b32 v0, 0
v_mov_b32 v1, 0
v_mov_b32 v2, 0
v_mov_b32 v3, 0
v_mov_b32 v4, 0
v_mov_b32 v5, 0
v_mov_b32 v6, 0
v_mov_b32 v7, 0
v_mov_b32 v8, 0
v_mov_b32 v9, 0
v_mov_b32 v10, 0
v_mov_b32 v11, 0
v_mov_b32 v12, 0
v_mov_b32 v13, 0
v_mov_b32 v14, 0
v_mov_b32 v15, 0
v_mov_b32 v16, 0
v_mov_b32 v17, 0
v_mov_b32 v18, 0
v_mov_b32 v19, 0
v_mov_b32 v20, 0
v_mov_b32 v21, 0
v_mov_b32 v22, 0
v_mov_b32 v23, 0
v_mov_b32 v24, 0
v_mov_b32 v25, 0
v_mov_b32 v26, 0
v_mov_b32 v27, 0
v_mov_b32 v28, 0
v_mov_b32 v29, 0
v_mov_b32 v30, 0
v_mov_b32 v31, 0
v_mov_b32 v32, 0
v_mov_b32 v33, 0
v_mov_b32 v34, 0
v_mov_b32 v35, 0
v_mov_b32 v36, 0
v_mov_b32 v37, 0
v_mov_b32 v38, 0
v_mov_b32 v39, 0
v_mov_b32 v40, 0
v_mov_b32 v41, 0
v_mov_b32 v42, 0
v_mov_b32 v43, 0
v_mov_b32 v44, 0
v_mov_b32 v45, 0
v_mov_b32 v46, 0
v_mov_b32 v47, 0
s_waitcnt lgkmcnt(0)
s_setpc_b64 s[78:79]
Lrb:
s_add_u32 m0, s67, 39936
s_add_u32 s45, s66, 491520
buffer_load_dwordx4 v240, s[4:7], s45 offen nt lds
s_add_u32 m0, s67, 46592
s_add_u32 s45, s66, 589824
buffer_load_dwordx4 v240, s[4:7], s45 offen nt lds
s_add_u32 m0, s67, 53248
s_add_u32 s45, s66, 688128
buffer_load_dwordx4 v240, s[4:7], s45 offen nt lds
s_add_u32 m0, s67, 59904
s_add_u32 s45, s66, 786432
buffer_load_dwordx4 v240, s[4:7], s45 offen nt lds
s_setpc_b64 s[78:79]
Lw1f:
s_add_u32 m0, s77, 0
s_add_u32 s43, s3, 0
buffer_load_dwordx4 v189, s[12:15], s43 offen lds
s_add_u32 m0, s77, 1024
s_add_u32 s43, s3, 24576
buffer_load_dwordx4 v189, s[12:15], s43 offen lds
s_add_u32 m0, s77, 2048
s_add_u32 s43, s3, 49152
buffer_load_dwordx4 v189, s[12:15], s43 offen lds
s_add_u32 m0, s77, 3072
s_add_u32 s43, s3, 12288
buffer_load_dwordx4 v189, s[12:15], s43 offen lds
s_add_u32 m0, s77, 4096
s_add_u32 s43, s3, 36864
buffer_load_dwordx4 v189, s[12:15], s43 offen lds
s_add_u32 m0, s77, 5120
s_add_u32 s43, s3, 61440
buffer_load_dwordx4 v189, s[12:15], s43 offen lds
s_setpc_b64 s[78:79]
Lgo:
v_mov_b32 v253, 16256
Lsw204w:
ds_read_b32 v247, v253 offset:20
s_waitcnt lgkmcnt(0)
v_readfirstlane_b32 s43, v247
s_cmp_eq_u32 s76, 0
s_cbranch_scc1 Lsw204x
s_sub_u32 s76, s76, 1
s_cmp_lt_u32 s43, 4
s_cbranch_scc0 Lsw204x
s_sleep 2
s_branch Lsw204w
Lsw204x:
s_cmp_lg_u32 s40, 7
s_cbranch_scc1 Lnopf
s_getpc_b64 s[74:75]
Lpc:
s_lshr_b32 s43, s2, 3
s_and_b32 s43, s43, 15
s_lshl_b32 s43, s43, 13
v_lshlrev_b32 v102, 7, v251
v_add_u32 v102, s43, v102
v_min_u32 v102, Lend-Lpc, v102
global_load_dword v255, v102, s[74:75]
Lnopf:
s_add_u32 s66, s66, 786432
ds_read_b128 v[224:227], v248 offset:16384
ds_read_b128 v[228:231], v248 offset:19456
ds_read_b128 v[232:235], v248 offset:17408
ds_read_b128 v[236:239], v248 offset:20480
ds_read_b128 v[216:219], v248 offset:18432
ds_read_b128 v[220:223], v248 offset:21504
s_setprio 2
s_waitcnt lgkmcnt(5)
v_mfma_f32_32x32x16_bf16 v[120:135], v[48:51], v[224:227], 0
s_waitcnt lgkmcnt(4)
ds_read_b128 v[224:227], v248 offset:22528
v_mfma_f32_32x32x16_bf16 v[120:135], v[52:55], v[228:231], v[120:135]
s_waitcnt lgkmcnt(4)
ds_read_b128 v[228:231], v248 offset:25600
v_mfma_f32_32x32x16_bf16 v[120:135], v[56:59], v[232:235], v[120:135]
s_waitcnt lgkmcnt(4)
ds_read_b128 v[232:235], v248 offset:23552
v_mfma_f32_32x32x16_bf16 v[120:135], v[60:63], v[236:239], v[120:135]
s_waitcnt lgkmcnt(4)
ds_read_b128 v[236:239], v248 offset:26624
v_mfma_f32_32x32x16_bf16 v[120:135], v[64:67], v[216:219], v[120:135]
s_waitcnt lgkmcnt(4)
ds_read_b128 v[216:219], v248 offset:24576
v_mfma_f32_32x32x16_bf16 v[120:135], v[68:71], v[220:223], v[120:135]
v_add_u32 v174, -36864, v242
v_subrev_u32 v175, 66560, v174
v_min_u32 v174, v174, v175
v_add_u32 v174, 90112, v174
v_sub_u32 v175, v174, v242
v_add_u32 v242, v175, v242
v_add_u32_e64 v243, v175, v243
v_add_u32 v244, v175, v244
s_nop 3
v_cvt_pkrtz_f16_f32 v137, v120, v121
v_cvt_pkrtz_f16_f32 v139, v122, v123
v_cvt_pkrtz_f16_f32 v141, v124, v125
v_cvt_pkrtz_f16_f32 v143, v126, v127
v_cvt_pkrtz_f16_f32 v177, v128, v129
v_cvt_pk_f16_f32 v155, v130, v131
v_cvt_pk_f16_f32 v152, v132, v133
v_cvt_pk_f16_f32 v149, v134, v135
s_waitcnt lgkmcnt(1)
ds_read_b128 v[220:223], v248 offset:27648
v_mfma_f32_32x32x16_bf16 v[120:135], v[48:51], v[224:227], 0
v_pk_fma_f16 v154, v155, v155, s48
v_and_b32 v137, s49, v137
v_pk_fma_f16 v151, v152, v152, s48
v_pk_fma_f16 v148, v149, v149, s48
v_bfe_u32 v136, v137, 2, 14
v_pk_mul_f16 v154, v155, v154
v_pk_mul_f16 v151, v152, v151
v_pk_mul_f16 v148, v149, v148
ds_read_b128 v[224:227], v248 offset:28672
ds_read_u16_d16 v136, v136
v_mfma_f32_32x32x16_bf16 v[120:135], v[52:55], v[228:231], v[120:135]
v_lshrrev_b32 v137, 18, v137
v_exp_f16 v153, v154
v_exp_f16 v150, v151
v_and_b32 v139, s49, v139
v_exp_f16_e64 v147, v148
v_bfe_u32 v138, v139, 2, 14
ds_read_b128 v[228:231], v248 offset:31744
ds_read_u16_d16_hi v137, v137
ds_read_u16_d16 v138, v138
v_mfma_f32_32x32x16_bf16 v[120:135], v[56:59], v[232:235], v[120:135]
v_exp_f16_sdwa v153, v154 dst_sel:WORD_1 dst_unused:UNUSED_PRESERVE src0_sel:WORD_1
v_lshrrev_b32_e64 v139, 18, v139
v_exp_f16_sdwa v150, v151 dst_sel:WORD_1 dst_unused:UNUSED_PRESERVE src0_sel:WORD_1
v_exp_f16_sdwa v147, v148 dst_sel:WORD_1 dst_unused:UNUSED_PRESERVE src0_sel:WORD_1
v_and_b32_e64 v141, s49, v141
ds_read_b128 v[232:235], v248 offset:29696
ds_read_u16_d16_hi v139, v139
v_mfma_f32_32x32x16_bf16 v[120:135], v[60:63], v[236:239], v[120:135]
v_pk_add_f16 v153, v153, 1.0 op_sel_hi:[1,0]
v_bfe_u32 v140, v141, 2, 14
v_pk_add_f16 v150, v150, 1.0 op_sel_hi:[1,0]
v_pk_add_f16 v147, v147, 1.0 op_sel_hi:[1,0]
v_rcp_f16 v154, v153
v_lshrrev_b32 v141, 18, v141
v_rcp_f16 v151, v150
s_waitcnt lgkmcnt(5)
ds_read_b128 v[236:239], v248 offset:32768
ds_read_u16_d16 v140, v140
ds_read_u16_d16_hi v141, v141
v_mfma_f32_32x32x16_bf16 v[120:135], v[64:67], v[216:219], v[120:135]
v_and_b32 v143, s49, v143
v_rcp_f16 v148, v147
v_bfe_u32 v142, v143, 2, 14
v_rcp_f16_sdwa v154, v153 dst_sel:WORD_1 dst_unused:UNUSED_PRESERVE src0_sel:WORD_1
v_rcp_f16_sdwa v151, v150 dst_sel:WORD_1 dst_unused:UNUSED_PRESERVE src0_sel:WORD_1
ds_read_b128 v[216:219], v248 offset:30720
ds_read_u16_d16 v142, v142
ds_read_b32 v247, v253 offset:16
v_mfma_f32_32x32x16_bf16 v[120:135], v[68:71], v[220:223], v[120:135]
v_lshrrev_b32_e64 v143, 18, v143
v_rcp_f16_sdwa v148, v147 dst_sel:WORD_1 dst_unused:UNUSED_PRESERVE src0_sel:WORD_1
v_and_b32_e64 v177, s49, v177
v_pk_mul_f16 v155, v155, v154
v_pk_mul_f16 v152, v152, v151
v_bfe_u32 v176, v177, 2, 14
v_pk_mul_f16 v149, v149, v148
v_fma_mix_f32 v156, v155, v155, 0 op_sel:[0,0,0] op_sel_hi:[1,1,0]
v_fma_mix_f32 v156, v155, v155, v156 op_sel:[1,1,0] op_sel_hi:[1,1,0]
v_lshrrev_b32_e64 v177, 18, v177
v_fma_mix_f32 v156, v152, v152, v156 op_sel:[0,0,0] op_sel_hi:[1,1,0]
v_fma_mix_f32 v156, v152, v152, v156 op_sel:[1,1,0] op_sel_hi:[1,1,0]
v_fma_mix_f32 v156, v149, v149, v156 op_sel:[0,0,0] op_sel_hi:[1,1,0]
v_fma_mix_f32 v156, v149, v149, v156 op_sel:[1,1,0] op_sel_hi:[1,1,0]
ds_read_u16_d16_hi v143, v143
ds_read_u16_d16 v176, v176
ds_read_u16_d16_hi v177, v177
s_waitcnt lgkmcnt(3)
v_readfirstlane_b32 s43, v247
s_nop 1
s_cmp_ge_u32 s43, 8
s_cbranch_scc1 Lev1
Lev1w:
s_sleep 1
ds_read_b32 v247, v253 offset:16
s_waitcnt lgkmcnt(0)
v_readfirstlane_b32 s43, v247
s_cmp_eq_u32 s76, 0
s_cbranch_scc1 Lev1
s_sub_u32 s76, s76, 1
s_cmp_lt_u32 s43, 8
s_cbranch_scc1 Lev1w
Lev1:
v_cvt_pkrtz_f16_f32 v179, v120, v121
v_cvt_pkrtz_f16_f32 v181, v122, v123
v_cvt_pkrtz_f16_f32 v183, v124, v125
v_cvt_pkrtz_f16_f32 v185, v126, v127
v_cvt_pkrtz_f16_f32 v187, v128, v129
v_cvt_pk_f16_f32 v155, v130, v131
v_cvt_pk_f16_f32 v152, v132, v133
v_cvt_pk_f16_f32 v149, v134, v135
s_add_u32 m0, s67, 0
s_add_u32 s66, s66, 98304
buffer_load_dwordx4 v240, s[4:7], s66 offen lds
ds_read_b128 v[220:223], v248 offset:33792
v_mfma_f32_32x32x16_bf16 v[120:135], v[48:51], v[224:227], 0
v_pk_fma_f16 v154, v155, v155, s48
v_and_b32_e64 v179, s49, v179
v_fma_mix_f32 v156, v136, v136, v156 op_sel:[0,0,0] op_sel_hi:[1,1,0]
v_pk_fma_f16 v151, v152, v152, s48
v_pk_fma_f16 v148, v149, v149, s48
v_bfe_u32 v178, v179, 2, 14
v_pk_mul_f16 v154, v155, v154
v_pk_mul_f16 v151, v152, v151
v_fma_mix_f32 v156, v137, v137, v156 op_sel:[1,1,0] op_sel_hi:[1,1,0]
v_lshrrev_b32_e64 v179, 18, v179
s_add_u32 m0, s67, 6656
s_add_u32 s66, s66, 98304
buffer_load_dwordx4 v240, s[4:7], s66 offen lds
ds_read_b128 v[224:227], v248 offset:34816
ds_read_u16_d16 v178, v178
ds_read_u16_d16_hi v179, v179
v_mfma_f32_32x32x16_bf16 v[120:135], v[52:55], v[228:231], v[120:135]
v_pk_mul_f16 v148, v149, v148
v_exp_f16 v153, v154
v_exp_f16 v150, v151
v_and_b32_e64 v181, s49, v181
v_fma_mix_f32 v156, v138, v138, v156 op_sel:[0,0,0] op_sel_hi:[1,1,0]
v_exp_f16_e64 v147, v148
v_bfe_u32 v180, v181, 2, 14
s_add_u32 m0, s67, 13312
s_add_u32 s66, s66, 98304
buffer_load_dwordx4 v240, s[4:7], s66 offen lds
ds_read_b128 v[228:231], v248 offset:37888
ds_read_u16_d16 v180, v180
v_mfma_f32_32x32x16_bf16 v[120:135], v[56:59], v[232:235], v[120:135]
v_exp_f16_sdwa v153, v154 dst_sel:WORD_1 dst_unused:UNUSED_PRESERVE src0_sel:WORD_1
v_lshrrev_b32_e64 v181, 18, v181
v_fma_mix_f32 v156, v139, v139, v156 op_sel:[1,1,0] op_sel_hi:[1,1,0]
v_exp_f16_sdwa v150, v151 dst_sel:WORD_1 dst_unused:UNUSED_PRESERVE src0_sel:WORD_1
v_exp_f16_sdwa v147, v148 dst_sel:WORD_1 dst_unused:UNUSED_PRESERVE src0_sel:WORD_1
v_and_b32_e64 v183, s49, v183
v_fma_mix_f32 v156, v140, v140, v156 op_sel:[0,0,0] op_sel_hi:[1,1,0]
s_add_u32 m0, s67, 19968
s_add_u32 s66, s66, 98304
buffer_load_dwordx4 v240, s[4:7], s66 offen lds
s_add_u32 m0, s67, 26624
s_add_u32 s66, s66, 98304
buffer_load_dwordx4 v240, s[4:7], s66 offen lds
ds_read_b128 v[232:235], v248 offset:35840
ds_read_u16_d16_hi v181, v181
v_mfma_f32_32x32x16_bf16 v[120:135], v[60:63], v[236:239], v[120:135]
v_pk_add_f16 v153, v153, 1.0 op_sel_hi:[1,0]
v_bfe_u32 v182, v183, 2, 14
v_pk_add_f16 v150, v150, 1.0 op_sel_hi:[1,0]
v_pk_add_f16 v147, v147, 1.0 op_sel_hi:[1,0]
v_rcp_f16 v154, v153
v_lshrrev_b32 v183, 18, v183
v_fma_mix_f32 v156, v141, v141, v156 op_sel:[1,1,0] op_sel_hi:[1,1,0]
v_rcp_f16_e64 v151, v150
s_add_u32 m0, s67, 33280
s_add_u32 s66, s66, 98304
buffer_load_dwordx4 v240, s[4:7], s66 offen lds
ds_read_b128 v[236:239], v248 offset:38912
ds_read_u16_d16 v182, v182
ds_read_u16_d16_hi v183, v183
v_mfma_f32_32x32x16_bf16 v[120:135], v[64:67], v[216:219], v[120:135]
v_and_b32 v185, s49, v185
v_rcp_f16 v148, v147
v_fma_mix_f32 v156, v142, v142, v156 op_sel:[0,0,0] op_sel_hi:[1,1,0]
v_bfe_u32 v184, v185, 2, 14
v_rcp_f16_sdwa v154, v153 dst_sel:WORD_1 dst_unused:UNUSED_PRESERVE src0_sel:WORD_1
v_rcp_f16_sdwa v151, v150 dst_sel:WORD_1 dst_unused:UNUSED_PRESERVE src0_sel:WORD_1
v_lshrrev_b32 v185, 18, v185
s_waitcnt lgkmcnt(4)
s_add_u32 m0, s67, 39936
s_add_u32 s66, s66, 98304
buffer_load_dwordx4 v240, s[4:7], s66 offen lds
ds_read_b128 v[216:219], v248 offset:36864
ds_read_u16_d16 v184, v184
ds_read_u16_d16_hi v185, v185
v_mfma_f32_32x32x16_bf16 v[120:135], v[68:71], v[220:223], v[120:135]
v_fma_mix_f32 v156, v143, v143, v156 op_sel:[1,1,0] op_sel_hi:[1,1,0]
v_rcp_f16_sdwa v148, v147 dst_sel:WORD_1 dst_unused:UNUSED_PRESERVE src0_sel:WORD_1
v_and_b32_e64 v187, s49, v187
v_pk_mul_f16 v155, v155, v154
v_fma_mix_f32 v156, v176, v176, v156 op_sel:[0,0,0] op_sel_hi:[1,1,0]
v_pk_mul_f16 v152, v152, v151
v_bfe_u32 v186, v187, 2, 14
v_pk_mul_f16 v149, v149, v148
v_fma_mix_f32 v157, v155, v155, 0 op_sel:[0,0,0] op_sel_hi:[1,1,0]
s_add_u32 m0, s67, 46592
s_add_u32 s66, s66, 98304
buffer_load_dwordx4 v240, s[4:7], s66 offen lds
v_fma_mix_f32 v157, v155, v155, v157 op_sel:[1,1,0] op_sel_hi:[1,1,0]
v_lshrrev_b32 v187, 18, v187
v_fma_mix_f32 v156, v177, v177, v156 op_sel:[1,1,0] op_sel_hi:[1,1,0]
v_fma_mix_f32 v157, v152, v152, v157 op_sel:[0,0,0] op_sel_hi:[1,1,0]
v_fma_mix_f32 v157, v152, v152, v157 op_sel:[1,1,0] op_sel_hi:[1,1,0]
v_fma_mix_f32 v157, v149, v149, v157 op_sel:[0,0,0] op_sel_hi:[1,1,0]
v_fma_mix_f32 v157, v149, v149, v157 op_sel:[1,1,0] op_sel_hi:[1,1,0]
s_cmp_lt_u32 s40, 4
s_cbranch_scc0 Lsu5
s_waitcnt vmcnt(14)
s_call_b64 s[78:79], Lw1b
s_mov_b64 exec, 1
ds_add_u32 v253, v254 offset:24
s_mov_b64 exec, -1
Lsu5:
s_setprio 1
v_cvt_pkrtz_f16_f32 v137, v120, v121
v_cvt_pkrtz_f16_f32 v139, v122, v123
v_cvt_pkrtz_f16_f32 v141, v124, v125
v_cvt_pkrtz_f16_f32 v143, v126, v127
v_cvt_pkrtz_f16_f32 v177, v128, v129
v_cvt_pk_f16_f32 v155, v130, v131
v_cvt_pk_f16_f32 v152, v132, v133
v_cvt_pk_f16_f32 v149, v134, v135
ds_read_b128 v[220:223], v248 offset:39936
ds_read_u16_d16 v186, v186
ds_read_u16_d16_hi v187, v187
v_mfma_f32_32x32x16_bf16 v[120:135], v[48:51], v[224:227], 0
v_pk_fma_f16 v154, v155, v155, s48
v_and_b32_e64 v137, s49, v137
v_fma_mix_f32 v157, v178, v178, v157 op_sel:[0,0,0] op_sel_hi:[1,1,0]
v_pk_fma_f16 v151, v152, v152, s48
v_pk_fma_f16 v148, v149, v149, s48
v_bfe_u32 v136, v137, 2, 14
v_pk_mul_f16 v154, v155, v154
v_pk_mul_f16 v151, v152, v151
v_fma_mix_f32 v157, v179, v179, v157 op_sel:[1,1,0] op_sel_hi:[1,1,0]
v_lshrrev_b32_e64 v137, 18, v137
ds_read_u16_d16 v136, v136
ds_read_b32 v247, v253 offset:24
ds_read_u16_d16_hi v137, v137
v_mfma_f32_32x32x16_bf16 v[120:135], v[52:55], v[228:231], v[120:135]
v_pk_mul_f16 v148, v149, v148
v_exp_f16 v153, v154
v_exp_f16 v150, v151
v_and_b32_e64 v139, s49, v139
v_fma_mix_f32 v157, v180, v180, v157 op_sel:[0,0,0] op_sel_hi:[1,1,0]
v_exp_f16_e64 v147, v148
v_bfe_u32 v138, v139, 2, 14
ds_read_u16_d16 v138, v138
v_mfma_f32_32x32x16_bf16 v[120:135], v[56:59], v[232:235], v[120:135]
v_exp_f16_sdwa v153, v154 dst_sel:WORD_1 dst_unused:UNUSED_PRESERVE src0_sel:WORD_1
v_lshrrev_b32 v139, 18, v139
s_waitcnt lgkmcnt(4)
v_fma_mix_f32 v157, v181, v181, v157 op_sel:[1,1,0] op_sel_hi:[1,1,0]
v_exp_f16_sdwa v150, v151 dst_sel:WORD_1 dst_unused:UNUSED_PRESERVE src0_sel:WORD_1
v_exp_f16_sdwa v147, v148 dst_sel:WORD_1 dst_unused:UNUSED_PRESERVE src0_sel:WORD_1
v_and_b32 v141, s49, v141
v_fma_mix_f32 v157, v182, v182, v157 op_sel:[0,0,0] op_sel_hi:[1,1,0]
ds_read_u16_d16_hi v139, v139
s_waitcnt lgkmcnt(3)
v_readfirstlane_b32 s43, v247
s_nop 1
s_cmp_ge_u32 s43, 4
s_cbranch_scc1 Lev2
Lev2w:
s_sleep 1
ds_read_b32 v247, v253 offset:24
s_waitcnt lgkmcnt(0)
v_readfirstlane_b32 s43, v247
s_cmp_eq_u32 s76, 0
s_cbranch_scc1 Lev2
s_sub_u32 s76, s76, 1
s_cmp_lt_u32 s43, 4
s_cbranch_scc1 Lev2w
Lev2:
ds_read_b128 v[224:227], v248 offset:40960
ds_read_b128 v[228:231], v248 offset:44032
ds_read_b128 v[232:235], v248 offset:41984
v_mfma_f32_32x32x16_bf16 v[120:135], v[60:63], v[236:239], v[120:135]
v_pk_add_f16 v153, v153, 1.0 op_sel_hi:[1,0]
v_bfe_u32 v140, v141, 2, 14
v_pk_add_f16 v150, v150, 1.0 op_sel_hi:[1,0]
v_pk_add_f16 v147, v147, 1.0 op_sel_hi:[1,0]
v_rcp_f16 v154, v153
v_lshrrev_b32 v141, 18, v141
v_fma_mix_f32 v157, v183, v183, v157 op_sel:[1,1,0] op_sel_hi:[1,1,0]
v_rcp_f16_e64 v151, v150
ds_read_b128 v[236:239], v248 offset:45056
ds_read_u16_d16 v140, v140
ds_read_u16_d16_hi v141, v141
v_mfma_f32_32x32x16_bf16 v[120:135], v[64:67], v[216:219], v[120:135]
v_and_b32 v143, s49, v143
v_rcp_f16 v148, v147
v_fma_mix_f32 v157, v184, v184, v157 op_sel:[0,0,0] op_sel_hi:[1,1,0]
v_bfe_u32 v142, v143, 2, 14
v_rcp_f16_sdwa v154, v153 dst_sel:WORD_1 dst_unused:UNUSED_PRESERVE src0_sel:WORD_1
v_rcp_f16_sdwa v151, v150 dst_sel:WORD_1 dst_unused:UNUSED_PRESERVE src0_sel:WORD_1
v_lshrrev_b32_e64 v143, 18, v143
ds_read_b128 v[216:219], v248 offset:43008
ds_read_u16_d16 v142, v142
ds_read_u16_d16_hi v143, v143
v_mfma_f32_32x32x16_bf16 v[120:135], v[68:71], v[220:223], v[120:135]
v_fma_mix_f32 v157, v185, v185, v157 op_sel:[1,1,0] op_sel_hi:[1,1,0]
v_rcp_f16_sdwa v148, v147 dst_sel:WORD_1 dst_unused:UNUSED_PRESERVE src0_sel:WORD_1
v_and_b32_e64 v177, s49, v177
v_pk_mul_f16 v155, v155, v154
v_fma_mix_f32 v157, v186, v186, v157 op_sel:[0,0,0] op_sel_hi:[1,1,0]
v_pk_mul_f16 v152, v152, v151
v_bfe_u32 v176, v177, 2, 14
v_pk_mul_f16 v149, v149, v148
v_fma_mix_f32 v158, v155, v155, 0 op_sel:[0,0,0] op_sel_hi:[1,1,0]
v_fma_mix_f32 v158, v155, v155, v158 op_sel:[1,1,0] op_sel_hi:[1,1,0]
v_lshrrev_b32_e64 v177, 18, v177
v_fma_mix_f32 v157, v187, v187, v157 op_sel:[1,1,0] op_sel_hi:[1,1,0]
v_fma_mix_f32 v158, v152, v152, v158 op_sel:[0,0,0] op_sel_hi:[1,1,0]
v_fma_mix_f32 v158, v152, v152, v158 op_sel:[1,1,0] op_sel_hi:[1,1,0]
v_fma_mix_f32 v158, v149, v149, v158 op_sel:[0,0,0] op_sel_hi:[1,1,0]
v_fma_mix_f32 v158, v149, v149, v158 op_sel:[1,1,0] op_sel_hi:[1,1,0]
v_cvt_pkrtz_f16_f32 v179, v120, v121
v_cvt_pkrtz_f16_f32 v181, v122, v123
v_cvt_pkrtz_f16_f32 v183, v124, v125
v_cvt_pkrtz_f16_f32 v185, v126, v127
v_cvt_pkrtz_f16_f32 v187, v128, v129
v_cvt_pk_f16_f32 v155, v130, v131
v_cvt_pk_f16_f32 v152, v132, v133
v_cvt_pk_f16_f32 v149, v134, v135
s_waitcnt lgkmcnt(0)
ds_read_b128 v[220:223], v248 offset:46080
ds_read_u16_d16 v176, v176
ds_read_u16_d16_hi v177, v177
v_mfma_f32_32x32x16_bf16 v[120:135], v[48:51], v[224:227], 0
v_pk_fma_f16 v154, v155, v155, s48
v_and_b32 v179, s49, v179
v_fma_mix_f32 v158, v136, v136, v158 op_sel:[0,0,0] op_sel_hi:[1,1,0]
v_pk_fma_f16 v151, v152, v152, s48
v_pk_fma_f16 v148, v149, v149, s48
v_bfe_u32 v178, v179, 2, 14
v_pk_mul_f16 v154, v155, v154
v_pk_mul_f16 v151, v152, v151
v_fma_mix_f32 v158, v137, v137, v158 op_sel:[1,1,0] op_sel_hi:[1,1,0]
v_lshrrev_b32_e64 v179, 18, v179
ds_read_b128 v[224:227], v248 offset:47104
ds_read_u16_d16 v178, v178
ds_read_u16_d16_hi v179, v179
v_mfma_f32_32x32x16_bf16 v[120:135], v[52:55], v[228:231], v[120:135]
v_pk_mul_f16 v148, v149, v148
v_exp_f16 v153, v154
v_exp_f16 v150, v151
v_and_b32_e64 v181, s49, v181
v_fma_mix_f32 v158, v138, v138, v158 op_sel:[0,0,0] op_sel_hi:[1,1,0]
v_exp_f16_e64 v147, v148
v_bfe_u32 v180, v181, 2, 14
ds_read_b128 v[228:231], v248 offset:50176
ds_read_u16_d16 v180, v180
v_mfma_f32_32x32x16_bf16 v[120:135], v[56:59], v[232:235], v[120:135]
v_exp_f16_sdwa v153, v154 dst_sel:WORD_1 dst_unused:UNUSED_PRESERVE src0_sel:WORD_1
v_lshrrev_b32_e64 v181, 18, v181
v_fma_mix_f32 v158, v139, v139, v158 op_sel:[1,1,0] op_sel_hi:[1,1,0]
v_exp_f16_sdwa v150, v151 dst_sel:WORD_1 dst_unused:UNUSED_PRESERVE src0_sel:WORD_1
v_exp_f16_sdwa v147, v148 dst_sel:WORD_1 dst_unused:UNUSED_PRESERVE src0_sel:WORD_1
v_and_b32_e64 v183, s49, v183
v_fma_mix_f32 v158, v140, v140, v158 op_sel:[0,0,0] op_sel_hi:[1,1,0]
ds_read_b128 v[232:235], v248 offset:48128
ds_read_u16_d16_hi v181, v181
v_mfma_f32_32x32x16_bf16 v[120:135], v[60:63], v[236:239], v[120:135]
v_pk_add_f16 v153, v153, 1.0 op_sel_hi:[1,0]
v_bfe_u32 v182, v183, 2, 14
v_pk_add_f16 v150, v150, 1.0 op_sel_hi:[1,0]
v_pk_add_f16 v147, v147, 1.0 op_sel_hi:[1,0]
v_rcp_f16 v154, v153
v_lshrrev_b32 v183, 18, v183
v_fma_mix_f32 v158, v141, v141, v158 op_sel:[1,1,0] op_sel_hi:[1,1,0]
v_rcp_f16_e64 v151, v150
ds_read_b128 v[236:239], v248 offset:51200
ds_read_u16_d16 v182, v182
ds_read_u16_d16_hi v183, v183
v_mfma_f32_32x32x16_bf16 v[120:135], v[64:67], v[216:219], v[120:135]
v_and_b32 v185, s49, v185
v_rcp_f16 v148, v147
v_fma_mix_f32 v158, v142, v142, v158 op_sel:[0,0,0] op_sel_hi:[1,1,0]
v_bfe_u32 v184, v185, 2, 14
v_rcp_f16_sdwa v154, v153 dst_sel:WORD_1 dst_unused:UNUSED_PRESERVE src0_sel:WORD_1
v_rcp_f16_sdwa v151, v150 dst_sel:WORD_1 dst_unused:UNUSED_PRESERVE src0_sel:WORD_1
v_lshrrev_b32 v185, 18, v185
s_waitcnt lgkmcnt(5)
ds_read_b128 v[216:219], v248 offset:49152
ds_read_u16_d16 v184, v184
ds_read_u16_d16_hi v185, v185
v_mfma_f32_32x32x16_bf16 v[120:135], v[68:71], v[220:223], v[120:135]
v_fma_mix_f32 v158, v143, v143, v158 op_sel:[1,1,0] op_sel_hi:[1,1,0]
v_rcp_f16_sdwa v148, v147 dst_sel:WORD_1 dst_unused:UNUSED_PRESERVE src0_sel:WORD_1
s_cmp_eq_u32 s40, 7
s_cbranch_scc1 Lrdy8
s_waitcnt vmcnt(0)
Lrdy8:
s_mov_b64 exec, 1
ds_add_u32 v253, v254 offset:12
s_mov_b64 exec, -1
v_and_b32 v187, s49, v187
v_pk_mul_f16 v155, v155, v154
v_fma_mix_f32 v158, v176, v176, v158 op_sel:[0,0,0] op_sel_hi:[1,1,0]
v_pk_mul_f16 v152, v152, v151
v_bfe_u32 v186, v187, 2, 14
v_pk_mul_f16 v149, v149, v148
v_fma_mix_f32 v159, v155, v155, 0 op_sel:[0,0,0] op_sel_hi:[1,1,0]
v_fma_mix_f32 v159, v155, v155, v159 op_sel:[1,1,0] op_sel_hi:[1,1,0]
v_lshrrev_b32_e64 v187, 18, v187
v_fma_mix_f32 v158, v177, v177, v158 op_sel:[1,1,0] op_sel_hi:[1,1,0]
v_fma_mix_f32 v159, v152, v152, v159 op_sel:[0,0,0] op_sel_hi:[1,1,0]
v_fma_mix_f32 v159, v152, v152, v159 op_sel:[1,1,0] op_sel_hi:[1,1,0]
v_fma_mix_f32 v159, v149, v149, v159 op_sel:[0,0,0] op_sel_hi:[1,1,0]
v_fma_mix_f32 v159, v149, v149, v159 op_sel:[1,1,0] op_sel_hi:[1,1,0]
s_cmp_lt_u32 s40, 4
s_cbranch_scc0 Lsu6
s_waitcnt vmcnt(8)
s_call_b64 s[78:79], Lw1c
s_mov_b64 exec, 1
ds_add_u32 v253, v254 offset:28
s_mov_b64 exec, -1
Lsu6:
v_cvt_pkrtz_f16_f32 v137, v120, v121
v_cvt_pkrtz_f16_f32 v139, v122, v123
v_cvt_pkrtz_f16_f32 v141, v124, v125
v_cvt_pkrtz_f16_f32 v143, v126, v127
v_cvt_pkrtz_f16_f32 v177, v128, v129
v_cvt_pk_f16_f32 v155, v130, v131
v_cvt_pk_f16_f32 v152, v132, v133
v_cvt_pk_f16_f32 v149, v134, v135
s_setprio 0
ds_read_b128 v[220:223], v248 offset:52224
ds_read_u16_d16 v186, v186
ds_read_u16_d16_hi v187, v187
v_mfma_f32_32x32x16_bf16 v[120:135], v[48:51], v[224:227], 0
v_pk_fma_f16 v154, v155, v155, s48
v_and_b32 v137, s49, v137
v_fma_mix_f32 v159, v178, v178, v159 op_sel:[0,0,0] op_sel_hi:[1,1,0]
v_pk_fma_f16 v151, v152, v152, s48
v_pk_fma_f16 v148, v149, v149, s48
v_bfe_u32 v136, v137, 2, 14
v_pk_mul_f16 v154, v155, v154
v_pk_mul_f16 v151, v152, v151
v_fma_mix_f32 v159, v179, v179, v159 op_sel:[1,1,0] op_sel_hi:[1,1,0]
v_lshrrev_b32_e64 v137, 18, v137
ds_read_b128 v[224:227], v250 offset:65520
ds_read_u16_d16 v136, v136
ds_read_u16_d16_hi v137, v137
v_mfma_f32_32x32x16_bf16 v[120:135], v[52:55], v[228:231], v[120:135]
v_pk_mul_f16 v148, v149, v148
v_exp_f16 v153, v154
v_exp_f16 v150, v151
v_and_b32_e64 v139, s49, v139
v_fma_mix_f32 v159, v180, v180, v159 op_sel:[0,0,0] op_sel_hi:[1,1,0]
v_exp_f16 v147, v148
v_bfe_u32 v138, v139, 2, 14
s_waitcnt lgkmcnt(7)
ds_read_b128 v[228:231], v248 offset:53248
ds_read_b32 v247, v253 offset:12
ds_read_u16_d16 v138, v138
v_mfma_f32_32x32x16_bf16 v[120:135], v[56:59], v[232:235], v[120:135]
v_exp_f16_sdwa v153, v154 dst_sel:WORD_1 dst_unused:UNUSED_PRESERVE src0_sel:WORD_1
v_lshrrev_b32_e64 v139, 18, v139
v_fma_mix_f32 v159, v181, v181, v159 op_sel:[1,1,0] op_sel_hi:[1,1,0]
v_exp_f16_sdwa v150, v151 dst_sel:WORD_1 dst_unused:UNUSED_PRESERVE src0_sel:WORD_1
v_exp_f16_sdwa v147, v148 dst_sel:WORD_1 dst_unused:UNUSED_PRESERVE src0_sel:WORD_1
v_and_b32_e64 v141, s49, v141
v_fma_mix_f32 v159, v182, v182, v159 op_sel:[0,0,0] op_sel_hi:[1,1,0]
ds_read_b128 v[232:235], v248 offset:56320
ds_read_u16_d16_hi v139, v139
v_mfma_f32_32x32x16_bf16 v[120:135], v[60:63], v[236:239], v[120:135]
v_pk_add_f16 v153, v153, 1.0 op_sel_hi:[1,0]
v_bfe_u32 v140, v141, 2, 14
v_pk_add_f16 v150, v150, 1.0 op_sel_hi:[1,0]
v_pk_add_f16 v147, v147, 1.0 op_sel_hi:[1,0]
v_rcp_f16 v154, v153
v_lshrrev_b32 v141, 18, v141
ds_read_u16_d16 v140, v140
ds_read_u16_d16_hi v141, v141
s_waitcnt lgkmcnt(5)
v_readfirstlane_b32 s43, v247
s_nop 1
s_cmp_ge_u32 s43, 16
s_cbranch_scc1 Lev3
Lev3w:
s_sleep 1
ds_read_b32 v247, v253 offset:12
s_waitcnt lgkmcnt(0)
v_readfirstlane_b32 s43, v247
s_cmp_eq_u32 s76, 0
s_cbranch_scc1 Lev3
s_sub_u32 s76, s76, 1
s_cmp_lt_u32 s43, 16
s_cbranch_scc1 Lev3w
Lev3:
v_fma_mix_f32 v159, v183, v183, v159 op_sel:[1,1,0] op_sel_hi:[1,1,0]
v_rcp_f16 v151, v150
ds_read_b128 v[236:239], v245 offset:6528
ds_read_b128 v[192:195], v244 offset:128
ds_read_b128 v[196:199], v244 offset:64
v_mfma_f32_32x32x16_bf16 v[120:135], v[64:67], v[216:219], v[120:135]
v_and_b32 v143, s49, v143
v_rcp_f16 v148, v147
v_fma_mix_f32 v159, v184, v184, v159 op_sel:[0,0,0] op_sel_hi:[1,1,0]
v_bfe_u32 v142, v143, 2, 14
v_rcp_f16_sdwa v154, v153 dst_sel:WORD_1 dst_unused:UNUSED_PRESERVE src0_sel:WORD_1
v_rcp_f16_sdwa v151, v150 dst_sel:WORD_1 dst_unused:UNUSED_PRESERVE src0_sel:WORD_1
v_lshrrev_b32_e64 v143, 18, v143
ds_read_b128 v[216:219], v248 offset:54272
ds_read_u16_d16 v142, v142
ds_read_u16_d16_hi v143, v143
v_mfma_f32_32x32x16_bf16 v[120:135], v[68:71], v[220:223], v[120:135]
v_fma_mix_f32 v159, v185, v185, v159 op_sel:[1,1,0] op_sel_hi:[1,1,0]
v_rcp_f16_sdwa v148, v147 dst_sel:WORD_1 dst_unused:UNUSED_PRESERVE src0_sel:WORD_1
v_and_b32_e64 v177, s49, v177
v_pk_mul_f16 v155, v155, v154
v_fma_mix_f32 v159, v186, v186, v159 op_sel:[0,0,0] op_sel_hi:[1,1,0]
v_pk_mul_f16 v152, v152, v151
v_bfe_u32 v176, v177, 2, 14
v_pk_mul_f16 v149, v149, v148
v_fma_mix_f32 v160, v155, v155, 0 op_sel:[0,0,0] op_sel_hi:[1,1,0]
v_fma_mix_f32 v160, v155, v155, v160 op_sel:[1,1,0] op_sel_hi:[1,1,0]
v_lshrrev_b32 v177, 18, v177
v_fma_mix_f32 v159, v187, v187, v159 op_sel:[1,1,0] op_sel_hi:[1,1,0]
v_fma_mix_f32 v160, v152, v152, v160 op_sel:[0,0,0] op_sel_hi:[1,1,0]
v_fma_mix_f32 v160, v152, v152, v160 op_sel:[1,1,0] op_sel_hi:[1,1,0]
v_fma_mix_f32 v160, v149, v149, v160 op_sel:[0,0,0] op_sel_hi:[1,1,0]
v_fma_mix_f32 v160, v149, v149, v160 op_sel:[1,1,0] op_sel_hi:[1,1,0]
s_setprio 2
v_mfma_f32_32x32x16_bf16 v[0:15], v[224:227], v[224:227], 0
ds_read_b128 v[220:223], v245 offset:6144
ds_read_b128 v[200:203], v244
ds_read_b128 v[204:207], v243 offset:128
ds_read_u16_d16 v176, v176
ds_read_u16_d16_hi v177, v177
v_cvt_pkrtz_f16_f32 v179, v120, v121
v_cvt_pkrtz_f16_f32 v181, v122, v123
v_cvt_pkrtz_f16_f32 v183, v124, v125
v_mfma_f32_32x32x16_bf16 v[16:31], v[224:227], v[224:227], 0
v_cvt_pkrtz_f16_f32 v185, v126, v127
v_cvt_pkrtz_f16_f32 v187, v128, v129
v_cvt_pk_f16_f32 v155, v130, v131
v_mfma_f32_32x32x16_bf16 v[32:47], v[224:227], v[224:227], 0
v_cvt_pk_f16_f32 v152, v132, v133
v_cvt_pk_f16_f32 v149, v134, v135
v_pk_fma_f16 v154, v155, v155, s48
v_mfma_f32_32x32x16_bf16 v[120:135], v[48:51], v[228:231], 0
ds_read_b128 v[224:227], v248 offset:57344
v_and_b32 v179, s49, v179
v_fma_mix_f32 v160, v136, v136, v160 op_sel:[0,0,0] op_sel_hi:[1,1,0]
v_pk_fma_f16 v151, v152, v152, s48
v_pk_fma_f16 v148, v149, v149, s48
v_bfe_u32 v178, v179, 2, 14
v_pk_mul_f16 v154, v155, v154
s_waitcnt lgkmcnt(6)
v_mfma_f32_32x32x16_bf16 v[120:135], v[52:55], v[232:235], v[120:135]
ds_read_b128 v[228:231], v245 offset:5760
ds_read_b128 v[208:211], v243 offset:64
ds_read_b128 v[212:215], v243
ds_read_u16_d16 v178, v178
v_pk_mul_f16 v151, v152, v151
v_fma_mix_f32 v160, v137, v137, v160 op_sel:[1,1,0] op_sel_hi:[1,1,0]
v_lshrrev_b32_e64 v179, 18, v179
v_pk_mul_f16 v148, v149, v148
v_exp_f16_e64 v153, v154
v_smfmac_f32_16x16x32_bf16 v[40:43], v[238:239], v[192:195], v246
ds_read_b128 v[232:235], v248 offset:55296
ds_read_u16_d16_hi v179, v179
v_exp_f16 v150, v151
v_and_b32 v181, s49, v181
v_smfmac_f32_16x16x32_bf16 v[24:27], v[236:237], v[196:199], v246
v_fma_mix_f32 v160, v138, v138, v160 op_sel:[0,0,0] op_sel_hi:[1,1,0]
v_exp_f16_e64 v147, v148
v_mfma_f32_32x32x16_bf16 v[120:135], v[56:59], v[216:219], v[120:135]
ds_read_b128 v[236:239], v245 offset:5376
ds_read_b128 v[192:195], v242 offset:128
ds_read_b128 v[196:199], v242 offset:64
v_bfe_u32 v180, v181, 2, 14
v_exp_f16_sdwa v153, v154 dst_sel:WORD_1 dst_unused:UNUSED_PRESERVE src0_sel:WORD_1
v_lshrrev_b32 v181, 18, v181
v_fma_mix_f32 v160, v139, v139, v160 op_sel:[1,1,0] op_sel_hi:[1,1,0]
s_waitcnt lgkmcnt(8)
v_smfmac_f32_16x16x32_bf16 v[8:11], v[222:223], v[200:203], v246
ds_read_b128 v[216:219], v248 offset:58368
ds_read_u16_d16 v180, v180
ds_read_u16_d16_hi v181, v181
v_exp_f16_sdwa v150, v151 dst_sel:WORD_1 dst_unused:UNUSED_PRESERVE src0_sel:WORD_1
v_exp_f16_sdwa v147, v148 dst_sel:WORD_1 dst_unused:UNUSED_PRESERVE src0_sel:WORD_1
v_smfmac_f32_16x16x32_bf16 v[40:43], v[220:221], v[204:207], v246
v_and_b32_e64 v183, s49, v183
v_fma_mix_f32 v160, v140, v140, v160 op_sel:[0,0,0] op_sel_hi:[1,1,0]
v_pk_add_f16 v153, v153, 1.0 op_sel_hi:[1,0]
v_mfma_f32_32x32x16_bf16 v[120:135], v[60:63], v[224:227], v[120:135]
ds_read_b128 v[220:223], v245 offset:4992
ds_read_b128 v[200:203], v242
v_xor_b32 v244, 16, v244
ds_read_b128 v[204:207], v244 offset:128
v_bfe_u32 v182, v183, 2, 14
v_pk_add_f16 v150, v150, 1.0 op_sel_hi:[1,0]
v_pk_add_f16 v147, v147, 1.0 op_sel_hi:[1,0]
v_rcp_f16 v154, v153
v_lshrrev_b32 v183, 18, v183
s_waitcnt lgkmcnt(6)
v_smfmac_f32_16x16x32_bf16 v[24:27], v[230:231], v[208:211], v246
ds_read_b128 v[224:227], v245 offset:4608
ds_read_u16_d16 v182, v182
ds_read_u16_d16_hi v183, v183
v_fma_mix_f32 v160, v141, v141, v160 op_sel:[1,1,0] op_sel_hi:[1,1,0]
v_rcp_f16_e64 v151, v150
v_smfmac_f32_16x16x32_bf16 v[8:11], v[228:229], v[212:215], v246
v_and_b32 v185, s49, v185
v_rcp_f16 v148, v147
v_mfma_f32_32x32x16_bf16 v[120:135], v[64:67], v[232:235], v[120:135]
ds_read_b128 v[208:211], v244 offset:64
ds_read_b128 v[212:215], v244
ds_read_b128 v[228:231], v248 offset:59392
v_fma_mix_f32 v160, v142, v142, v160 op_sel:[0,0,0] op_sel_hi:[1,1,0]
v_bfe_u32 v184, v185, 2, 14
v_rcp_f16_sdwa v154, v153 dst_sel:WORD_1 dst_unused:UNUSED_PRESERVE src0_sel:WORD_1
v_rcp_f16_sdwa v151, v150 dst_sel:WORD_1 dst_unused:UNUSED_PRESERVE src0_sel:WORD_1
v_smfmac_f32_16x16x32_bf16 v[40:43], v[238:239], v[192:195], v246
ds_read_b128 v[232:235], v248 offset:62464
ds_read_u16_d16 v184, v184
ds_read_b32 v247, v253 offset:28
v_lshrrev_b32_e64 v185, 18, v185
v_fma_mix_f32 v160, v143, v143, v160 op_sel:[1,1,0] op_sel_hi:[1,1,0]
v_smfmac_f32_16x16x32_bf16 v[24:27], v[236:237], v[196:199], v246
v_rcp_f16_sdwa v148, v147 dst_sel:WORD_1 dst_unused:UNUSED_PRESERVE src0_sel:WORD_1
v_and_b32 v187, s49, v187
v_pk_mul_f16 v155, v155, v154
s_waitcnt lgkmcnt(7)
v_mfma_f32_32x32x16_bf16 v[120:135], v[68:71], v[216:219], v[120:135]
ds_read_b128 v[236:239], v248 offset:60416
ds_read_u16_d16_hi v185, v185
v_fma_mix_f32 v160, v176, v176, v160 op_sel:[0,0,0] op_sel_hi:[1,1,0]
v_pk_mul_f16 v152, v152, v151
v_bfe_u32 v186, v187, 2, 14
v_pk_mul_f16 v149, v149, v148
v_fma_mix_f32 v161, v155, v155, 0 op_sel:[0,0,0] op_sel_hi:[1,1,0]
v_fma_mix_f32 v161, v155, v155, v161 op_sel:[1,1,0] op_sel_hi:[1,1,0]
v_smfmac_f32_16x16x32_bf16 v[8:11], v[222:223], v[200:203], v246
ds_read_b128 v[216:219], v245 offset:4224
v_xor_b32 v243, 16, v243
ds_read_b128 v[192:195], v243 offset:128
ds_read_b128 v[196:199], v243 offset:64
ds_read_u16_d16 v186, v186
v_lshrrev_b32 v187, 18, v187
v_fma_mix_f32 v160, v177, v177, v160 op_sel:[1,1,0] op_sel_hi:[1,1,0]
v_fma_mix_f32 v161, v152, v152, v161 op_sel:[0,0,0] op_sel_hi:[1,1,0]
v_smfmac_f32_16x16x32_bf16 v[44:47], v[220:221], v[204:207], v246
v_fma_mix_f32 v161, v152, v152, v161 op_sel:[1,1,0] op_sel_hi:[1,1,0]
v_fma_mix_f32 v161, v149, v149, v161 op_sel:[0,0,0] op_sel_hi:[1,1,0]
v_fma_mix_f32 v161, v149, v149, v161 op_sel:[1,1,0] op_sel_hi:[1,1,0]
s_cmp_lg_u32 s40, 7
s_cbranch_scc1 Lnosent
v_mov_b32 v104, -1
v_mov_b32 v105, -1
v_mov_b32 v106, -1
v_mov_b32 v107, -1
v_lshlrev_b32_e64 v100, 12, v251
v_add_u32 v101, 262144, v100
v_cmp_gt_u32 vcc, 32, v251
v_mov_b32 v102, 2147483648
s_nop 0
v_cndmask_b32 v101, v102, v101, vcc
s_lshl_b32 s43, s2, 4
buffer_store_dwordx4 v[104:107], v100, s[32:35], s43 offen sc1
buffer_store_dwordx4 v[104:107], v101, s[32:35], s43 offen sc1
s_add_u32 s43, s43, 393216
s_cmp_lt_u32 s2, 96
s_cselect_b32 s43, s43, 1073741824
v_lshlrev_b32_e64 v102, 11, v251
s_mov_b64 exec, 0xff
buffer_store_dwordx4 v[104:107], v102, s[32:35], s43 offen sc1
s_mov_b64 exec, -1
s_sub_u32 s43, s2, 96
s_cmp_lt_u32 s43, 96
s_cbranch_scc0 Lnobias
s_lshl_b32 s44, s43, 1
v_mul_u32_u24 v100, 192, v251
v_lshlrev_b32 v101, 1, v251
s_add_u32 s45, s44, 0
buffer_load_ushort v102, v100, s[16:19], s45 offen
buffer_load_ushort v108, v101, s[28:31], 0 offen offset:0
s_add_u32 s45, s44, 12288
buffer_load_ushort v103, v100, s[16:19], s45 offen
buffer_load_ushort v109, v101, s[28:31], 0 offen offset:128
s_add_u32 s45, s44, 24576
buffer_load_ushort v104, v100, s[16:19], s45 offen
buffer_load_ushort v110, v101, s[28:31], 0 offen offset:256
s_add_u32 s45, s44, 36864
buffer_load_ushort v105, v100, s[16:19], s45 offen
buffer_load_ushort v111, v101, s[28:31], 0 offen offset:384
s_add_u32 s45, s44, 49152
buffer_load_ushort v106, v100, s[16:19], s45 offen
buffer_load_ushort v112, v101, s[28:31], 0 offen offset:512
s_add_u32 s45, s44, 61440
buffer_load_ushort v107, v100, s[16:19], s45 offen
buffer_load_ushort v113, v101, s[28:31], 0 offen offset:640
Lnobias:
s_nop 1
Lnosent:
ds_read_u16_d16_hi v187, v187
s_waitcnt lgkmcnt(1)
v_readfirstlane_b32 s43, v247
s_nop 1
s_cmp_ge_u32 s43, 12
s_cbranch_scc1 Lev4
Lev4w:
s_sleep 1
ds_read_b32 v247, v253 offset:28
s_waitcnt lgkmcnt(0)
v_readfirstlane_b32 s43, v247
s_cmp_eq_u32 s76, 0
s_cbranch_scc1 Lev4
s_sub_u32 s76, s76, 1
s_cmp_lt_u32 s43, 12
s_cbranch_scc1 Lev4w
Lev4:
s_setprio 1
v_smfmac_f32_16x16x32_bf16 v[28:31], v[226:227], v[208:211], v246
ds_read_b128 v[220:223], v248 offset:63488
v_cvt_pkrtz_f16_f32 v137, v120, v121
v_cvt_pkrtz_f16_f32 v139, v122, v123
v_cvt_pkrtz_f16_f32 v141, v124, v125
v_cvt_pkrtz_f16_f32 v143, v126, v127
v_smfmac_f32_16x16x32_bf16 v[12:15], v[224:225], v[212:215], v246
v_cvt_pk_f16_f32 v155, v128, v129
v_cvt_pk_f16_f32 v152, v130, v131
v_cvt_pk_f16_f32 v149, v132, v133
v_cvt_pk_f16_f32 v146, v134, v135
v_mfma_f32_32x32x16_bf16 v[120:135], v[48:51], v[228:231], 0
ds_read_b128 v[224:227], v248 offset:61440
v_pk_fma_f16 v154, v155, v155, s48
v_and_b32 v137, s49, v137
v_fma_mix_f32 v161, v178, v178, v161 op_sel:[0,0,0] op_sel_hi:[1,1,0]
v_pk_fma_f16 v151, v152, v152, s48
v_pk_fma_f16 v148, v149, v149, s48
v_pk_fma_f16 v145, v146, v146, s48
v_pk_mul_f16 v154, v155, v154
v_bfe_u32 v136, v137, 2, 14
v_pk_mul_f16 v151, v152, v151
v_mfma_f32_32x32x16_bf16 v[120:135], v[52:55], v[232:235], v[120:135]
ds_read_b128 v[228:231], v245 offset:3840
ds_read_b128 v[200:203], v243
v_xor_b32 v242, 16, v242
ds_read_b128 v[204:207], v242 offset:128
ds_read_u16_d16 v136, v136
v_fma_mix_f32 v161, v179, v179, v161 op_sel:[1,1,0] op_sel_hi:[1,1,0]
v_pk_mul_f16 v148, v149, v148
v_pk_mul_f16 v145, v146, v145
v_exp_f16 v153, v154
v_lshrrev_b32 v137, 18, v137
v_exp_f16 v150, v151
v_mfma_f32_32x32x16_bf16 v[120:135], v[56:59], v[236:239], v[120:135]
ds_read_b128 v[232:235], v248 offset:64512
ds_read_u16_d16_hi v137, v137
v_fma_mix_f32 v161, v180, v180, v161 op_sel:[0,0,0] op_sel_hi:[1,1,0]
v_exp_f16 v147, v148
v_and_b32 v139, s49, v139
v_exp_f16_e64 v144, v145
v_exp_f16_sdwa v153, v154 dst_sel:WORD_1 dst_unused:UNUSED_PRESERVE src0_sel:WORD_1
v_fma_mix_f32 v161, v181, v181, v161 op_sel:[1,1,0] op_sel_hi:[1,1,0]
v_smfmac_f32_16x16x32_bf16 v[44:47], v[218:219], v[192:195], v246
ds_read_b128 v[236:239], v245 offset:3456
ds_read_b128 v[208:211], v242 offset:64
ds_read_b128 v[212:215], v242
v_bfe_u32 v138, v139, 2, 14
v_exp_f16_sdwa v150, v151 dst_sel:WORD_1 dst_unused:UNUSED_PRESERVE src0_sel:WORD_1
v_smfmac_f32_16x16x32_bf16 v[28:31], v[216:217], v[196:199], v246
v_exp_f16_sdwa v147, v148 dst_sel:WORD_1 dst_unused:UNUSED_PRESERVE src0_sel:WORD_1
v_exp_f16_sdwa v144, v145 dst_sel:WORD_1 dst_unused:UNUSED_PRESERVE src0_sel:WORD_1
v_lshrrev_b32_e64 v139, 18, v139
s_waitcnt lgkmcnt(5)
v_mfma_f32_32x32x16_bf16 v[120:135], v[60:63], v[220:223], v[120:135]
ds_read_b128 v[216:219], v245 offset:3072
v_xor_b32 v244, 32, v244
ds_read_b128 v[192:195], v244 offset:128
ds_read_b128 v[196:199], v244 offset:64
ds_read_u16_d16 v138, v138
ds_read_u16_d16_hi v139, v139
v_fma_mix_f32 v161, v182, v182, v161 op_sel:[0,0,0] op_sel_hi:[1,1,0]
v_pk_add_f16 v153, v153, 1.0 op_sel_hi:[1,0]
v_pk_add_f16 v150, v150, 1.0 op_sel_hi:[1,0]
v_pk_add_f16 v147, v147, 1.0 op_sel_hi:[1,0]
v_and_b32_e64 v141, s49, v141
v_pk_add_f16 v144, v144, 1.0 op_sel_hi:[1,0]
v_rcp_f16_e64 v154, v153
v_fma_mix_f32 v161, v183, v183, v161 op_sel:[1,1,0] op_sel_hi:[1,1,0]
v_mfma_f32_32x32x16_bf16 v[120:135], v[64:67], v[224:227], v[120:135]
ds_read_b128 v[220:223], v249
v_rcp_f16_e64 v151, v150
v_bfe_u32 v140, v141, 2, 14
v_rcp_f16_e64 v148, v147
v_fma_mix_f32 v161, v184, v184, v161 op_sel:[0,0,0] op_sel_hi:[1,1,0]
v_rcp_f16 v145, v144
v_lshrrev_b32 v141, 18, v141
v_smfmac_f32_16x16x32_bf16 v[12:15], v[230:231], v[200:203], v246
ds_read_b128 v[224:227], v249 offset:3072
ds_read_u16_d16 v140, v140
ds_read_u16_d16_hi v141, v141
v_rcp_f16_sdwa v154, v153 dst_sel:WORD_1 dst_unused:UNUSED_PRESERVE src0_sel:WORD_1
s_setprio 0
v_rcp_f16_sdwa v151, v150 dst_sel:WORD_1 dst_unused:UNUSED_PRESERVE src0_sel:WORD_1
v_smfmac_f32_16x16x32_bf16 v[44:47], v[228:229], v[204:207], v246
v_fma_mix_f32 v161, v185, v185, v161 op_sel:[1,1,0] op_sel_hi:[1,1,0]
v_and_b32 v143, s49, v143
v_rcp_f16_sdwa v148, v147 dst_sel:WORD_1 dst_unused:UNUSED_PRESERVE src0_sel:WORD_1
s_waitcnt lgkmcnt(4)
v_mfma_f32_32x32x16_bf16 v[120:135], v[68:71], v[232:235], v[120:135]
ds_read_b128 v[228:231], v245 offset:2688
ds_read_b128 v[200:203], v244
v_xor_b32 v243, 32, v243
ds_read_b128 v[204:207], v243 offset:128
v_rcp_f16_sdwa v145, v144 dst_sel:WORD_1 dst_unused:UNUSED_PRESERVE src0_sel:WORD_1
v_pk_mul_f16 v155, v155, v154
v_bfe_u32 v142, v143, 2, 14
v_fma_mix_f32 v161, v186, v186, v161 op_sel:[0,0,0] op_sel_hi:[1,1,0]
v_pk_mul_f16 v152, v152, v151
v_pk_mul_f16 v149, v149, v148
v_pk_mul_f16 v146, v146, v145
v_fma_mix_f32 v162, v155, v155, 0 op_sel:[0,0,0] op_sel_hi:[1,1,0]
v_smfmac_f32_16x16x32_bf16 v[28:31], v[238:239], v[208:211], v246
ds_read_b128 v[232:235], v249 offset:1024
ds_read_u16_d16 v142, v142
v_lshrrev_b32_e64 v143, 18, v143
v_fma_mix_f32 v162, v155, v155, v162 op_sel:[1,1,0] op_sel_hi:[1,1,0]
v_fma_mix_f32 v162, v152, v152, v162 op_sel:[0,0,0] op_sel_hi:[1,1,0]
v_fma_mix_f32 v161, v187, v187, v161 op_sel:[1,1,0] op_sel_hi:[1,1,0]
v_smfmac_f32_16x16x32_bf16 v[12:15], v[236:237], v[212:215], v246
v_fma_mix_f32 v162, v152, v152, v162 op_sel:[1,1,0] op_sel_hi:[1,1,0]
v_fma_mix_f32 v162, v149, v149, v162 op_sel:[0,0,0] op_sel_hi:[1,1,0]
v_fma_mix_f32 v162, v149, v149, v162 op_sel:[1,1,0] op_sel_hi:[1,1,0]
v_fma_mix_f32 v162, v146, v146, v162 op_sel:[0,0,0] op_sel_hi:[1,1,0]
v_fma_mix_f32 v162, v146, v146, v162 op_sel:[1,1,0] op_sel_hi:[1,1,0]
v_lshlrev_b32_e64 v252, 7, v251
s_add_u32 s46, s47, 1572864
s_mov_b32 exec_lo, 131071
s_mov_b32 exec_hi, 0
s_mov_b32 m0, 16288
s_nop 0
buffer_load_dword v252, s[4:7], s46 offen lds
s_mov_b64 exec, -1
s_setprio 2
v_smfmac_f32_16x16x32_bf16 v[36:39], v[218:219], v[192:195], v246
ds_read_b128 v[236:239], v249 offset:4096
ds_read_u16_d16_hi v143, v143
v_cvt_pkrtz_f16_f32 v179, v120, v121
v_cvt_pkrtz_f16_f32 v181, v122, v123
v_cvt_pkrtz_f16_f32 v183, v124, v125
v_smfmac_f32_16x16x32_bf16 v[20:23], v[216:217], v[196:199], v246
v_cvt_pkrtz_f16_f32 v185, v126, v127
v_cvt_pkrtz_f16_f32 v187, v128, v129
v_cvt_pk_f16_f32 v155, v130, v131
v_cvt_pk_f16_f32 v152, v132, v133
v_cvt_pk_f16_f32 v149, v134, v135
s_waitcnt lgkmcnt(2)
v_mfma_f32_32x32x16_bf16 v[120:135], v[48:51], v[220:223], 0
ds_read_b128 v[216:219], v245 offset:2304
ds_read_b128 v[208:211], v243 offset:64
ds_read_b128 v[212:215], v243
v_pk_fma_f16 v154, v155, v155, s48
v_and_b32 v179, s49, v179
v_fma_mix_f32 v162, v136, v136, v162 op_sel:[0,0,0] op_sel_hi:[1,1,0]
v_pk_fma_f16 v151, v152, v152, s48
v_pk_fma_f16 v148, v149, v149, s48
v_mfma_f32_32x32x16_bf16 v[120:135], v[52:55], v[224:227], v[120:135]
ds_read_b128 v[220:223], v249 offset:2048
v_bfe_u32 v178, v179, 2, 14
v_pk_mul_f16 v154, v155, v154
v_pk_mul_f16 v151, v152, v151
v_pk_mul_f16 v148, v149, v148
v_lshrrev_b32 v179, 18, v179
v_fma_mix_f32 v162, v137, v137, v162 op_sel:[1,1,0] op_sel_hi:[1,1,0]
v_smfmac_f32_16x16x32_bf16 v[4:7], v[230:231], v[200:203], v246
ds_read_b128 v[224:227], v245 offset:1920
v_xor_b32 v242, 32, v242
ds_read_b128 v[192:195], v242 offset:128
ds_read_b128 v[196:199], v242 offset:64
ds_read_u16_d16 v178, v178
ds_read_u16_d16_hi v179, v179
v_exp_f16 v153, v154
v_and_b32 v181, s49, v181
v_smfmac_f32_16x16x32_bf16 v[36:39], v[228:229], v[204:207], v246
v_exp_f16 v150, v151
v_exp_f16 v147, v148
v_mfma_f32_32x32x16_bf16 v[120:135], v[56:59], v[232:235], v[120:135]
ds_read_b128 v[228:231], v249 offset:5120
v_bfe_u32 v180, v181, 2, 14
v_fma_mix_f32 v162, v138, v138, v162 op_sel:[0,0,0] op_sel_hi:[1,1,0]
v_exp_f16_sdwa v153, v154 dst_sel:WORD_1 dst_unused:UNUSED_PRESERVE src0_sel:WORD_1
v_lshrrev_b32_e64 v181, 18, v181
v_exp_f16_sdwa v150, v151 dst_sel:WORD_1 dst_unused:UNUSED_PRESERVE src0_sel:WORD_1
s_waitcnt lgkmcnt(6)
v_mfma_f32_32x32x16_bf16 v[120:135], v[60:63], v[236:239], v[120:135]
ds_read_b128 v[232:235], v245 offset:1536
ds_read_b128 v[200:203], v242
v_xor_b32 v244, 16, v244
ds_read_b128 v[204:207], v244 offset:128
ds_read_u16_d16 v180, v180
ds_read_u16_d16_hi v181, v181
v_fma_mix_f32 v162, v139, v139, v162 op_sel:[1,1,0] op_sel_hi:[1,1,0]
v_and_b32_e64 v183, s49, v183
v_exp_f16_sdwa v147, v148 dst_sel:WORD_1 dst_unused:UNUSED_PRESERVE src0_sel:WORD_1
v_pk_add_f16 v153, v153, 1.0 op_sel_hi:[1,0]
v_bfe_u32 v182, v183, 2, 14
v_smfmac_f32_16x16x32_bf16 v[20:23], v[218:219], v[208:211], v246
ds_read_b128 v[236:239], v245 offset:1152
ds_read_u16_d16 v182, v182
v_pk_add_f16 v150, v150, 1.0 op_sel_hi:[1,0]
v_pk_add_f16 v147, v147, 1.0 op_sel_hi:[1,0]
v_rcp_f16_e64 v154, v153
v_smfmac_f32_16x16x32_bf16 v[4:7], v[216:217], v[212:215], v246
v_lshrrev_b32_e64 v183, 18, v183
v_fma_mix_f32 v162, v140, v140, v162 op_sel:[0,0,0] op_sel_hi:[1,1,0]
v_mfma_f32_32x32x16_bf16 v[120:135], v[64:67], v[220:223], v[120:135]
ds_read_b128 v[208:211], v244 offset:64
ds_read_b128 v[212:215], v244
ds_read_b128 v[216:219], v249 offset:6144
ds_read_u16_d16_hi v183, v183
v_rcp_f16 v151, v150
v_and_b32 v185, s49, v185
v_rcp_f16 v148, v147
v_fma_mix_f32 v162, v141, v141, v162 op_sel:[1,1,0] op_sel_hi:[1,1,0]
v_bfe_u32 v184, v185, 2, 14
s_waitcnt lgkmcnt(6)
v_smfmac_f32_16x16x32_bf16 v[36:39], v[226:227], v[192:195], v246
ds_read_b128 v[220:223], v249 offset:9216
ds_read_u16_d16 v184, v184
v_rcp_f16_sdwa v154, v153 dst_sel:WORD_1 dst_unused:UNUSED_PRESERVE src0_sel:WORD_1
v_rcp_f16_sdwa v151, v150 dst_sel:WORD_1 dst_unused:UNUSED_PRESERVE src0_sel:WORD_1
v_smfmac_f32_16x16x32_bf16 v[20:23], v[224:225], v[196:199], v246
v_lshrrev_b32_e64 v185, 18, v185
v_rcp_f16_sdwa v148, v147 dst_sel:WORD_1 dst_unused:UNUSED_PRESERVE src0_sel:WORD_1
v_mfma_f32_32x32x16_bf16 v[120:135], v[68:71], v[228:231], v[120:135]
ds_read_b128 v[224:227], v249 offset:7168
ds_read_u16_d16_hi v185, v185
v_and_b32_e64 v187, s49, v187
v_fma_mix_f32 v162, v142, v142, v162 op_sel:[0,0,0] op_sel_hi:[1,1,0]
v_pk_mul_f16 v155, v155, v154
v_pk_mul_f16 v152, v152, v151
v_bfe_u32 v186, v187, 2, 14
v_pk_mul_f16 v149, v149, v148
v_fma_mix_f32 v163, v155, v155, 0 op_sel:[0,0,0] op_sel_hi:[1,1,0]
v_smfmac_f32_16x16x32_bf16 v[4:7], v[234:235], v[200:203], v246
ds_read_b128 v[228:231], v245 offset:768
v_xor_b32 v243, 16, v243
ds_read_b128 v[192:195], v243 offset:128
ds_read_b128 v[196:199], v243 offset:64
ds_read_u16_d16 v186, v186
v_fma_mix_f32 v162, v143, v143, v162 op_sel:[1,1,0] op_sel_hi:[1,1,0]
v_lshrrev_b32 v187, 18, v187
v_fma_mix_f32 v163, v155, v155, v163 op_sel:[1,1,0] op_sel_hi:[1,1,0]
v_smfmac_f32_16x16x32_bf16 v[32:35], v[232:233], v[204:207], v246
v_fma_mix_f32 v163, v152, v152, v163 op_sel:[0,0,0] op_sel_hi:[1,1,0]
v_fma_mix_f32 v163, v152, v152, v163 op_sel:[1,1,0] op_sel_hi:[1,1,0]
v_fma_mix_f32 v163, v149, v149, v163 op_sel:[0,0,0] op_sel_hi:[1,1,0]
v_fma_mix_f32 v163, v149, v149, v163 op_sel:[1,1,0] op_sel_hi:[1,1,0]
v_lshlrev_b32 v252, 7, v251
s_add_u32 s46, s47, 1572864
s_mov_b32 exec_lo, 4294836224
s_mov_b32 exec_hi, 3
s_mov_b32 m0, 16220
s_nop 0
buffer_load_dword v252, s[4:7], s46 offen lds
s_mov_b64 exec, -1
s_setprio 1
s_waitcnt lgkmcnt(4)
v_smfmac_f32_16x16x32_bf16 v[16:19], v[238:239], v[208:211], v246
ds_read_b128 v[232:235], v249 offset:10240
ds_read_u16_d16_hi v187, v187
v_cvt_pkrtz_f16_f32 v137, v120, v121
v_cvt_pkrtz_f16_f32 v139, v122, v123
v_cvt_pkrtz_f16_f32 v141, v124, v125
v_smfmac_f32_16x16x32_bf16 v[0:3], v[236:237], v[212:215], v246
v_cvt_pkrtz_f16_f32 v143, v126, v127
v_cvt_pk_f16_f32 v155, v128, v129
v_cvt_pk_f16_f32 v152, v130, v131
v_cvt_pk_f16_f32 v149, v132, v133
v_cvt_pk_f16_f32 v146, v134, v135
v_mfma_f32_32x32x16_bf16 v[120:135], v[48:51], v[216:219], 0
ds_read_b128 v[236:239], v249 offset:8192
v_pk_fma_f16 v154, v155, v155, s48
v_and_b32_e64 v137, s49, v137
v_fma_mix_f32 v163, v178, v178, v163 op_sel:[0,0,0] op_sel_hi:[1,1,0]
v_pk_fma_f16 v151, v152, v152, s48
v_pk_fma_f16 v148, v149, v149, s48
v_pk_fma_f16 v145, v146, v146, s48
v_pk_mul_f16 v154, v155, v154
v_mfma_f32_32x32x16_bf16 v[120:135], v[52:55], v[220:223], v[120:135]
ds_read_b128 v[216:219], v245 offset:384
ds_read_b128 v[200:203], v243
v_xor_b32 v242, 16, v242
ds_read_b128 v[204:207], v242 offset:128
v_bfe_u32 v136, v137, 2, 14
v_pk_mul_f16 v151, v152, v151
v_fma_mix_f32 v163, v179, v179, v163 op_sel:[1,1,0] op_sel_hi:[1,1,0]
v_pk_mul_f16 v148, v149, v148
v_pk_mul_f16 v145, v146, v145
v_exp_f16 v153, v154
v_lshrrev_b32_e64 v137, 18, v137
v_mfma_f32_32x32x16_bf16 v[120:135], v[56:59], v[224:227], v[120:135]
ds_read_b128 v[220:223], v249 offset:11264
ds_read_u16_d16 v136, v136
ds_read_u16_d16_hi v137, v137
v_exp_f16_e64 v150, v151
v_fma_mix_f32 v163, v180, v180, v163 op_sel:[0,0,0] op_sel_hi:[1,1,0]
v_exp_f16 v147, v148
v_and_b32 v139, s49, v139
v_exp_f16 v144, v145
s_waitcnt lgkmcnt(6)
v_smfmac_f32_16x16x32_bf16 v[32:35], v[230:231], v[192:195], v246
ds_read_b128 v[224:227], v245
ds_read_b128 v[208:211], v242 offset:64
ds_read_b128 v[212:215], v242
v_exp_f16_sdwa v153, v154 dst_sel:WORD_1 dst_unused:UNUSED_PRESERVE src0_sel:WORD_1
v_fma_mix_f32 v163, v181, v181, v163 op_sel:[1,1,0] op_sel_hi:[1,1,0]
v_bfe_u32 v138, v139, 2, 14
v_smfmac_f32_16x16x32_bf16 v[16:19], v[228:229], v[196:199], v246
v_exp_f16_sdwa v150, v151 dst_sel:WORD_1 dst_unused:UNUSED_PRESERVE src0_sel:WORD_1
v_mfma_f32_32x32x16_bf16 v[120:135], v[60:63], v[232:235], v[120:135]
ds_read_b128 v[228:231], v249 offset:12288
ds_read_u16_d16 v138, v138
v_exp_f16_sdwa v147, v148 dst_sel:WORD_1 dst_unused:UNUSED_PRESERVE src0_sel:WORD_1
v_exp_f16_sdwa v144, v145 dst_sel:WORD_1 dst_unused:UNUSED_PRESERVE src0_sel:WORD_1
v_lshrrev_b32_e64 v139, 18, v139
v_fma_mix_f32 v163, v182, v182, v163 op_sel:[0,0,0] op_sel_hi:[1,1,0]
v_pk_add_f16 v153, v153, 1.0 op_sel_hi:[1,0]
v_pk_add_f16 v150, v150, 1.0 op_sel_hi:[1,0]
v_pk_add_f16 v147, v147, 1.0 op_sel_hi:[1,0]
v_mfma_f32_32x32x16_bf16 v[120:135], v[64:67], v[236:239], v[120:135]
ds_read_b128 v[232:235], v249 offset:15360
ds_read_u16_d16_hi v139, v139
v_and_b32_e64 v141, s49, v141
v_pk_add_f16 v144, v144, 1.0 op_sel_hi:[1,0]
v_rcp_f16_e64 v154, v153
v_fma_mix_f32 v163, v183, v183, v163 op_sel:[1,1,0] op_sel_hi:[1,1,0]
v_rcp_f16 v151, v150
v_bfe_u32 v140, v141, 2, 14
s_waitcnt lgkmcnt(4)
v_smfmac_f32_16x16x32_bf16 v[0:3], v[218:219], v[200:203], v246
ds_read_b128 v[236:239], v249 offset:13312
ds_read_u16_d16 v140, v140
v_rcp_f16_e64 v148, v147
v_fma_mix_f32 v163, v184, v184, v163 op_sel:[0,0,0] op_sel_hi:[1,1,0]
v_smfmac_f32_16x16x32_bf16 v[32:35], v[216:217], v[204:207], v246
v_rcp_f16_e64 v145, v144
v_lshrrev_b32 v141, 18, v141
v_rcp_f16_sdwa v154, v153 dst_sel:WORD_1 dst_unused:UNUSED_PRESERVE src0_sel:WORD_1
s_setprio 0
v_mfma_f32_32x32x16_bf16 v[120:135], v[68:71], v[220:223], v[120:135]
ds_read_b128 v[216:219], v249 offset:16384
ds_read_u16_d16_hi v141, v141
v_rcp_f16_sdwa v151, v150 dst_sel:WORD_1 dst_unused:UNUSED_PRESERVE src0_sel:WORD_1
v_fma_mix_f32 v163, v185, v185, v163 op_sel:[1,1,0] op_sel_hi:[1,1,0]
v_and_b32_e64 v143, s49, v143
v_rcp_f16_sdwa v148, v147 dst_sel:WORD_1 dst_unused:UNUSED_PRESERVE src0_sel:WORD_1
v_rcp_f16_sdwa v145, v144 dst_sel:WORD_1 dst_unused:UNUSED_PRESERVE src0_sel:WORD_1
v_smfmac_f32_16x16x32_bf16 v[16:19], v[226:227], v[208:211], v246
ds_read_b128 v[220:223], v249 offset:14336
v_pk_mul_f16 v155, v155, v154
v_bfe_u32 v142, v143, 2, 14
v_fma_mix_f32 v163, v186, v186, v163 op_sel:[0,0,0] op_sel_hi:[1,1,0]
v_pk_mul_f16 v152, v152, v151
v_smfmac_f32_16x16x32_bf16 v[0:3], v[224:225], v[212:215], v246
s_mov_b64 exec, 1
ds_add_u32 v253, v254 offset:16
s_mov_b64 exec, -1
v_pk_mul_f16 v149, v149, v148
v_pk_mul_f16 v146, v146, v145
v_fma_mix_f32 v164, v155, v155, 0 op_sel:[0,0,0] op_sel_hi:[1,1,0]
v_lshrrev_b32 v143, 18, v143
v_fma_mix_f32 v164, v155, v155, v164 op_sel:[1,1,0] op_sel_hi:[1,1,0]
v_fma_mix_f32 v164, v152, v152, v164 op_sel:[0,0,0] op_sel_hi:[1,1,0]
v_fma_mix_f32 v163, v187, v187, v163 op_sel:[1,1,0] op_sel_hi:[1,1,0]
v_fma_mix_f32 v164, v152, v152, v164 op_sel:[1,1,0] op_sel_hi:[1,1,0]
v_fma_mix_f32 v164, v149, v149, v164 op_sel:[0,0,0] op_sel_hi:[1,1,0]
v_fma_mix_f32 v164, v149, v149, v164 op_sel:[1,1,0] op_sel_hi:[1,1,0]
v_fma_mix_f32 v164, v146, v146, v164 op_sel:[0,0,0] op_sel_hi:[1,1,0]
v_fma_mix_f32 v164, v146, v146, v164 op_sel:[1,1,0] op_sel_hi:[1,1,0]
s_setprio 3
v_pk_add_f32 v[168:169], v[0:1], v[2:3]
v_pk_mul_f32 v[170:171], v[0:1], v[0:1]
v_pk_fma_f32 v[170:171], v[2:3], v[2:3], v[170:171]
v_pk_add_f32 v[168:169], v[168:169], v[4:5]
v_pk_fma_f32 v[170:171], v[4:5], v[4:5], v[170:171]
v_pk_add_f32 v[168:169], v[168:169], v[6:7]
v_pk_fma_f32 v[170:171], v[6:7], v[6:7], v[170:171]
v_pk_add_f32 v[168:169], v[168:169], v[8:9]
v_pk_fma_f32 v[170:171], v[8:9], v[8:9], v[170:171]
v_pk_add_f32 v[168:169], v[168:169], v[10:11]
v_pk_fma_f32 v[170:171], v[10:11], v[10:11], v[170:171]
v_pk_add_f32 v[168:169], v[168:169], v[12:13]
v_pk_fma_f32 v[170:171], v[12:13], v[12:13], v[170:171]
v_pk_add_f32 v[168:169], v[168:169], v[14:15]
v_pk_fma_f32 v[170:171], v[14:15], v[14:15], v[170:171]
v_pk_add_f32 v[168:169], v[168:169], v[16:17]
v_pk_fma_f32 v[170:171], v[16:17], v[16:17], v[170:171]
v_pk_add_f32 v[168:169], v[168:169], v[18:19]
v_pk_fma_f32 v[170:171], v[18:19], v[18:19], v[170:171]
v_pk_add_f32 v[168:169], v[168:169], v[20:21]
v_pk_fma_f32 v[170:171], v[20:21], v[20:21], v[170:171]
v_pk_add_f32 v[168:169], v[168:169], v[22:23]
v_pk_fma_f32 v[170:171], v[22:23], v[22:23], v[170:171]
v_pk_add_f32 v[168:169], v[168:169], v[24:25]
v_pk_fma_f32 v[170:171], v[24:25], v[24:25], v[170:171]
v_pk_add_f32 v[168:169], v[168:169], v[26:27]
v_pk_fma_f32 v[170:171], v[26:27], v[26:27], v[170:171]
v_pk_add_f32 v[168:169], v[168:169], v[28:29]
v_pk_fma_f32 v[170:171], v[28:29], v[28:29], v[170:171]
v_pk_add_f32 v[168:169], v[168:169], v[30:31]
v_pk_fma_f32 v[170:171], v[30:31], v[30:31], v[170:171]
v_pk_add_f32 v[168:169], v[168:169], v[32:33]
v_pk_fma_f32 v[170:171], v[32:33], v[32:33], v[170:171]
v_pk_add_f32 v[168:169], v[168:169], v[34:35]
v_pk_fma_f32 v[170:171], v[34:35], v[34:35], v[170:171]
v_pk_add_f32 v[168:169], v[168:169], v[36:37]
v_pk_fma_f32 v[170:171], v[36:37], v[36:37], v[170:171]
v_pk_add_f32 v[168:169], v[168:169], v[38:39]
v_pk_fma_f32 v[170:171], v[38:39], v[38:39], v[170:171]
v_pk_add_f32 v[168:169], v[168:169], v[40:41]
v_pk_fma_f32 v[170:171], v[40:41], v[40:41], v[170:171]
v_pk_add_f32 v[168:169], v[168:169], v[42:43]
v_pk_fma_f32 v[170:171], v[42:43], v[42:43], v[170:171]
v_pk_add_f32 v[168:169], v[168:169], v[44:45]
v_pk_fma_f32 v[170:171], v[44:45], v[44:45], v[170:171]
v_pk_add_f32 v[168:169], v[168:169], v[46:47]
v_pk_fma_f32 v[170:171], v[46:47], v[46:47], v[170:171]
s_setprio 0
v_add_u32 v174, -36864, v242
v_subrev_u32 v175, 66560, v174
v_min_u32 v174, v174, v175
v_add_u32 v174, 90112, v174
v_sub_u32 v175, v174, v242
v_add_u32 v242, v175, v242
v_add_u32 v243, v175, v243
v_add_u32 v244, v175, v244
v_lshlrev_b32_e64 v252, 7, v251
s_add_u32 s46, s47, 1572864
s_mov_b32 exec_lo, 0
s_mov_b32 exec_hi, 1048572
s_mov_b32 m0, 16152
s_nop 0
buffer_load_dword v252, s[4:7], s46 offen lds
s_mov_b64 exec, -1
s_setprio 2
v_cvt_pkrtz_f16_f32 v179, v120, v121
v_cvt_pkrtz_f16_f32 v181, v122, v123
v_cvt_pkrtz_f16_f32 v183, v124, v125
v_cvt_pkrtz_f16_f32 v185, v126, v127
v_cvt_pkrtz_f16_f32 v187, v128, v129
v_cvt_pkrtz_f16_f32 v189, v130, v131
v_cvt_pk_f16_f32 v155, v132, v133
v_cvt_pk_f16_f32 v152, v134, v135
s_waitcnt lgkmcnt(1)
ds_read_b128 v[224:227], v249 offset:17408
ds_read_u16_d16 v142, v142
ds_read_u16_d16_hi v143, v143
v_mfma_f32_32x32x16_bf16 v[120:135], v[48:51], v[228:231], 0
v_pk_fma_f16 v154, v155, v155, s48
v_add_f32 v168, v168, v169
v_and_b32_e64 v179, s49, v179
v_fma_mix_f32 v164, v136, v136, v164 op_sel:[0,0,0] op_sel_hi:[1,1,0]
v_bfe_u32 v178, v179, 2, 14
v_add_f32_e64 v170, v170, v171
v_pk_fma_f16 v151, v152, v152, s48
v_pk_mul_f16 v154, v155, v154
v_lshrrev_b32_e64 v179, 18, v179
v_pk_mul_f16 v151, v152, v151
ds_read_b128 v[228:231], v249 offset:18432
ds_read_u16_d16 v178, v178
ds_read_u16_d16_hi v179, v179
v_mfma_f32_32x32x16_bf16 v[120:135], v[52:55], v[232:235], v[120:135]
v_permlane32_swap_b32 v168, v170
v_fma_mix_f32 v164, v137, v137, v164 op_sel:[1,1,0] op_sel_hi:[1,1,0]
v_and_b32 v181, s49, v181
v_exp_f16 v153, v154
v_add_f32 v168, v168, v170
v_bfe_u32 v180, v181, 2, 14
v_exp_f16 v150, v151
v_lshrrev_b32 v181, 18, v181
ds_read_b128 v[232:235], v249 offset:21504
ds_read_u16_d16 v180, v180
ds_read_u16_d16_hi v181, v181
v_mfma_f32_32x32x16_bf16 v[120:135], v[56:59], v[236:239], v[120:135]
v_mul_f32 v168, 1009429163, v168
v_fma_mix_f32 v164, v138, v138, v164 op_sel:[0,0,0] op_sel_hi:[1,1,0]
v_exp_f16_sdwa v153, v154 dst_sel:WORD_1 dst_unused:UNUSED_PRESERVE src0_sel:WORD_1
v_and_b32 v183, s49, v183
v_mov_b32 v170, v168
v_exp_f16_sdwa v150, v151 dst_sel:WORD_1 dst_unused:UNUSED_PRESERVE src0_sel:WORD_1
v_bfe_u32 v182, v183, 2, 14
v_fma_mix_f32 v164, v139, v139, v164 op_sel:[1,1,0] op_sel_hi:[1,1,0]
v_permlane32_swap_b32 v168, v170
ds_read_b128 v[236:239], v249 offset:19456
ds_read_u16_d16 v182, v182
v_mfma_f32_32x32x16_bf16 v[120:135], v[60:63], v[216:219], v[120:135]
v_lshrrev_b32 v183, 18, v183
v_pk_add_f16 v153, v153, 1.0 op_sel_hi:[1,0]
v_pk_add_f16 v150, v150, 1.0 op_sel_hi:[1,0]
v_and_b32_e64 v185, s49, v185
v_fma_f32 v170, -v168, v168, v170
v_rcp_f16_e64 v154, v153
v_bfe_u32 v184, v185, 2, 14
v_max_f32_e64 v170, 0, v170
v_fma_mix_f32 v164, v140, v140, v164 op_sel:[0,0,0] op_sel_hi:[1,1,0]
ds_read_b128 v[216:219], v249 offset:22528
ds_read_u16_d16_hi v183, v183
ds_read_u16_d16 v184, v184
v_mfma_f32_32x32x16_bf16 v[120:135], v[64:67], v[220:223], v[120:135]
v_lshrrev_b32 v185, 18, v185
v_rcp_f16 v151, v150
v_add_f32 v170, 925353388, v170
v_and_b32_e64 v187, s49, v187
v_fma_mix_f32 v164, v141, v141, v164 op_sel:[1,1,0] op_sel_hi:[1,1,0]
v_rcp_f16_sdwa v154, v153 dst_sel:WORD_1 dst_unused:UNUSED_PRESERVE src0_sel:WORD_1
v_rsq_f32 v170, v170
s_waitcnt lgkmcnt(5)
ds_read_b128 v[220:223], v249 offset:20480
ds_read_u16_d16_hi v185, v185
ds_read_b32 v247, v253 offset:16
v_mfma_f32_32x32x16_bf16 v[120:135], v[68:71], v[224:227], v[120:135]
v_bfe_u32 v186, v187, 2, 14
v_rcp_f16_sdwa v151, v150 dst_sel:WORD_1 dst_unused:UNUSED_PRESERVE src0_sel:WORD_1
v_lshrrev_b32_e64 v187, 18, v187
v_fma_mix_f32 v164, v142, v142, v164 op_sel:[0,0,0] op_sel_hi:[1,1,0]
v_and_b32_e64 v189, s49, v189
v_pk_mul_f16 v155, v155, v154
v_pk_mul_f16 v152, v152, v151
v_mul_f32 v172, 3203391086, v170
v_bfe_u32 v188, v189, 2, 14
v_fma_mix_f32 v165, v155, v155, 0 op_sel:[0,0,0] op_sel_hi:[1,1,0]
v_fma_mix_f32 v164, v143, v143, v164 op_sel:[1,1,0] op_sel_hi:[1,1,0]
v_lshrrev_b32_e64 v189, 18, v189
v_mul_f32 v173, v168, v172
v_fma_mix_f32 v165, v155, v155, v165 op_sel:[1,1,0] op_sel_hi:[1,1,0]
v_fma_mix_f32 v165, v152, v152, v165 op_sel:[0,0,0] op_sel_hi:[1,1,0]
v_fma_mix_f32 v165, v152, v152, v165 op_sel:[1,1,0] op_sel_hi:[1,1,0]
s_setprio 3
v_pk_fma_f32 v[0:1], v[0:1], v[172:173], v[172:173] op_sel:[0,0,1] op_sel_hi:[1,0,1] neg_lo:[0,0,1] neg_hi:[0,0,1]
v_pk_fma_f32 v[2:3], v[2:3], v[172:173], v[172:173] op_sel:[0,0,1] op_sel_hi:[1,0,1] neg_lo:[0,0,1] neg_hi:[0,0,1]
v_pk_fma_f32 v[4:5], v[4:5], v[172:173], v[172:173] op_sel:[0,0,1] op_sel_hi:[1,0,1] neg_lo:[0,0,1] neg_hi:[0,0,1]
v_pk_fma_f32 v[6:7], v[6:7], v[172:173], v[172:173] op_sel:[0,0,1] op_sel_hi:[1,0,1] neg_lo:[0,0,1] neg_hi:[0,0,1]
v_pk_fma_f32 v[8:9], v[8:9], v[172:173], v[172:173] op_sel:[0,0,1] op_sel_hi:[1,0,1] neg_lo:[0,0,1] neg_hi:[0,0,1]
v_pk_fma_f32 v[10:11], v[10:11], v[172:173], v[172:173] op_sel:[0,0,1] op_sel_hi:[1,0,1] neg_lo:[0,0,1] neg_hi:[0,0,1]
v_pk_fma_f32 v[12:13], v[12:13], v[172:173], v[172:173] op_sel:[0,0,1] op_sel_hi:[1,0,1] neg_lo:[0,0,1] neg_hi:[0,0,1]
v_pk_fma_f32 v[14:15], v[14:15], v[172:173], v[172:173] op_sel:[0,0,1] op_sel_hi:[1,0,1] neg_lo:[0,0,1] neg_hi:[0,0,1]
v_pk_fma_f32 v[16:17], v[16:17], v[172:173], v[172:173] op_sel:[0,0,1] op_sel_hi:[1,0,1] neg_lo:[0,0,1] neg_hi:[0,0,1]
v_pk_fma_f32 v[18:19], v[18:19], v[172:173], v[172:173] op_sel:[0,0,1] op_sel_hi:[1,0,1] neg_lo:[0,0,1] neg_hi:[0,0,1]
v_pk_fma_f32 v[20:21], v[20:21], v[172:173], v[172:173] op_sel:[0,0,1] op_sel_hi:[1,0,1] neg_lo:[0,0,1] neg_hi:[0,0,1]
v_pk_fma_f32 v[22:23], v[22:23], v[172:173], v[172:173] op_sel:[0,0,1] op_sel_hi:[1,0,1] neg_lo:[0,0,1] neg_hi:[0,0,1]
v_pk_fma_f32 v[24:25], v[24:25], v[172:173], v[172:173] op_sel:[0,0,1] op_sel_hi:[1,0,1] neg_lo:[0,0,1] neg_hi:[0,0,1]
v_pk_fma_f32 v[26:27], v[26:27], v[172:173], v[172:173] op_sel:[0,0,1] op_sel_hi:[1,0,1] neg_lo:[0,0,1] neg_hi:[0,0,1]
v_pk_fma_f32 v[28:29], v[28:29], v[172:173], v[172:173] op_sel:[0,0,1] op_sel_hi:[1,0,1] neg_lo:[0,0,1] neg_hi:[0,0,1]
v_pk_fma_f32 v[30:31], v[30:31], v[172:173], v[172:173] op_sel:[0,0,1] op_sel_hi:[1,0,1] neg_lo:[0,0,1] neg_hi:[0,0,1]
v_pk_fma_f32 v[32:33], v[32:33], v[172:173], v[172:173] op_sel:[0,0,1] op_sel_hi:[1,0,1] neg_lo:[0,0,1] neg_hi:[0,0,1]
v_pk_fma_f32 v[34:35], v[34:35], v[172:173], v[172:173] op_sel:[0,0,1] op_sel_hi:[1,0,1] neg_lo:[0,0,1] neg_hi:[0,0,1]
v_pk_fma_f32 v[36:37], v[36:37], v[172:173], v[172:173] op_sel:[0,0,1] op_sel_hi:[1,0,1] neg_lo:[0,0,1] neg_hi:[0,0,1]
v_pk_fma_f32 v[38:39], v[38:39], v[172:173], v[172:173] op_sel:[0,0,1] op_sel_hi:[1,0,1] neg_lo:[0,0,1] neg_hi:[0,0,1]
v_pk_fma_f32 v[40:41], v[40:41], v[172:173], v[172:173] op_sel:[0,0,1] op_sel_hi:[1,0,1] neg_lo:[0,0,1] neg_hi:[0,0,1]
v_pk_fma_f32 v[42:43], v[42:43], v[172:173], v[172:173] op_sel:[0,0,1] op_sel_hi:[1,0,1] neg_lo:[0,0,1] neg_hi:[0,0,1]
v_pk_fma_f32 v[44:45], v[44:45], v[172:173], v[172:173] op_sel:[0,0,1] op_sel_hi:[1,0,1] neg_lo:[0,0,1] neg_hi:[0,0,1]
v_pk_fma_f32 v[46:47], v[46:47], v[172:173], v[172:173] op_sel:[0,0,1] op_sel_hi:[1,0,1] neg_lo:[0,0,1] neg_hi:[0,0,1]
s_setprio 2
ds_read_u16_d16 v186, v186
ds_read_u16_d16_hi v187, v187
ds_read_u16_d16 v188, v188
ds_read_u16_d16_hi v189, v189
s_waitcnt lgkmcnt(4)
v_readfirstlane_b32 s43, v247
s_nop 1
s_cmp_ge_u32 s43, 16
s_cbranch_scc1 Lev5
Lev5w:
s_sleep 1
ds_read_b32 v247, v253 offset:16
s_waitcnt lgkmcnt(0)
v_readfirstlane_b32 s43, v247
s_cmp_eq_u32 s76, 0
s_cbranch_scc1 Lev5
s_sub_u32 s76, s76, 1
s_cmp_lt_u32 s43, 16
s_cbranch_scc1 Lev5w
Lev5:
s_setprio 1
v_cvt_pkrtz_f16_f32 v137, v120, v121
v_cvt_pkrtz_f16_f32 v139, v122, v123
v_cvt_pkrtz_f16_f32 v141, v124, v125
v_cvt_pkrtz_f16_f32 v143, v126, v127
v_cvt_pkrtz_f16_f32 v177, v128, v129
v_cvt_pkrtz_f16_f32 v191, v130, v131
v_cvt_pk_f16_f32 v155, v132, v133
v_cvt_pk_f16_f32 v152, v134, v135
s_add_u32 m0, s67, 53248
s_add_u32 s66, s66, 98304
buffer_load_dwordx4 v240, s[4:7], s66 offen lds
ds_read_b128 v[224:227], v249 offset:23552
v_mfma_f32_32x32x16_bf16 v[120:135], v[48:51], v[228:231], 0
v_pk_fma_f16 v154, v155, v155, s48
v_cvt_pk_bf16_f32 v72, v0, v1
v_and_b32 v137, s49, v137
v_fma_mix_f32 v165, v178, v178, v165 op_sel:[0,0,0] op_sel_hi:[1,1,0]
v_cvt_pk_bf16_f32 v73, v2, v3
v_pk_fma_f16 v151, v152, v152, s48
v_bfe_u32 v136, v137, 2, 14
v_cvt_pk_bf16_f32 v74, v4, v5
v_pk_mul_f16 v154, v155, v154
v_fma_mix_f32 v165, v179, v179, v165 op_sel:[1,1,0] op_sel_hi:[1,1,0]
v_lshrrev_b32_e64 v137, 18, v137
v_cvt_pk_bf16_f32 v75, v6, v7
s_add_u32 m0, s67, 59904
s_add_u32 s66, s66, 98304
buffer_load_dwordx4 v240, s[4:7], s66 offen lds
ds_read_b128 v[228:231], v248 offset:16384
ds_read_u16_d16 v136, v136
ds_read_u16_d16_hi v137, v137
v_mfma_f32_32x32x16_bf16 v[120:135], v[52:55], v[232:235], v[120:135]
v_pk_mul_f16 v151, v152, v151
v_exp_f16_e64 v153, v154
v_cvt_pk_bf16_f32 v76, v8, v9
v_and_b32_e64 v139, s49, v139
v_fma_mix_f32 v165, v180, v180, v165 op_sel:[0,0,0] op_sel_hi:[1,1,0]
v_cvt_pk_bf16_f32 v77, v10, v11
v_bfe_u32 v138, v139, 2, 14
v_exp_f16_e64 v150, v151
v_cvt_pk_bf16_f32 v78, v12, v13
v_lshrrev_b32 v139, 18, v139
v_cvt_pk_bf16_f32 v79, v14, v15
s_add_u32 m0, s67, 0
s_add_u32 s66, s66, 98304
buffer_load_dwordx4 v240, s[4:7], s66 offen lds
ds_read_b128 v[232:235], v248 offset:19456
ds_read_u16_d16 v138, v138
ds_read_u16_d16_hi v139, v139
v_mfma_f32_32x32x16_bf16 v[120:135], v[56:59], v[236:239], v[120:135]
v_fma_mix_f32 v165, v181, v181, v165 op_sel:[1,1,0] op_sel_hi:[1,1,0]
v_exp_f16_sdwa v153, v154 dst_sel:WORD_1 dst_unused:UNUSED_PRESERVE src0_sel:WORD_1
v_cvt_pk_bf16_f32 v80, v16, v17
v_and_b32_e64 v141, s49, v141
v_fma_mix_f32 v165, v182, v182, v165 op_sel:[0,0,0] op_sel_hi:[1,1,0]
v_cvt_pk_bf16_f32 v81, v18, v19
v_bfe_u32 v140, v141, 2, 14
v_exp_f16_sdwa v150, v151 dst_sel:WORD_1 dst_unused:UNUSED_PRESERVE src0_sel:WORD_1
v_cvt_pk_bf16_f32 v82, v20, v21
v_lshrrev_b32_e64 v141, 18, v141
s_add_u32 m0, s67, 6656
s_add_u32 s66, s66, 98304
buffer_load_dwordx4 v240, s[4:7], s66 offen lds
s_add_u32 m0, s67, 13312
s_add_u32 s66, s66, 98304
buffer_load_dwordx4 v240, s[4:7], s66 offen lds
ds_read_b128 v[236:239], v248 offset:17408
ds_read_u16_d16 v140, v140
ds_read_u16_d16_hi v141, v141
v_mfma_f32_32x32x16_bf16 v[120:135], v[60:63], v[216:219], v[120:135]
v_fma_mix_f32 v165, v183, v183, v165 op_sel:[1,1,0] op_sel_hi:[1,1,0]
v_cvt_pk_bf16_f32 v83, v22, v23
v_pk_add_f16 v153, v153, 1.0 op_sel_hi:[1,0]
v_pk_add_f16 v150, v150, 1.0 op_sel_hi:[1,0]
v_and_b32_e64 v143, s49, v143
v_cvt_pk_bf16_f32 v84, v24, v25
v_rcp_f16_e64 v154, v153
v_cvt_pk_bf16_f32 v85, v26, v27
v_bfe_u32 v142, v143, 2, 14
v_fma_mix_f32 v165, v184, v184, v165 op_sel:[0,0,0] op_sel_hi:[1,1,0]
v_cvt_pk_bf16_f32 v86, v28, v29
s_add_u32 m0, s67, 19968
s_add_u32 s66, s66, 98304
buffer_load_dwordx4 v240, s[4:7], s66 offen lds
ds_read_b128 v[216:219], v248 offset:20480
ds_read_u16_d16 v142, v142
v_mfma_f32_32x32x16_bf16 v[120:135], v[64:67], v[220:223], v[120:135]
v_rcp_f16 v151, v150
v_lshrrev_b32 v143, 18, v143
v_cvt_pk_bf16_f32 v87, v30, v31
v_fma_mix_f32 v165, v185, v185, v165 op_sel:[1,1,0] op_sel_hi:[1,1,0]
v_and_b32_e64 v177, s49, v177
s_setprio 0
v_cvt_pk_bf16_f32 v88, v32, v33
v_rcp_f16_sdwa v154, v153 dst_sel:WORD_1 dst_unused:UNUSED_PRESERVE src0_sel:WORD_1
v_bfe_u32 v176, v177, 2, 14
v_cvt_pk_bf16_f32 v89, v34, v35
s_waitcnt lgkmcnt(2)
v_fma_mix_f32 v165, v186, v186, v165 op_sel:[0,0,0] op_sel_hi:[1,1,0]
v_rcp_f16_sdwa v151, v150 dst_sel:WORD_1 dst_unused:UNUSED_PRESERVE src0_sel:WORD_1
s_add_u32 m0, s67, 26624
s_add_u32 s66, s66, 98304
buffer_load_dwordx4 v240, s[4:7], s66 offen lds
ds_read_b128 v[220:223], v248 offset:18432
ds_read_u16_d16_hi v143, v143
ds_read_u16_d16 v176, v176
v_mfma_f32_32x32x16_bf16 v[120:135], v[68:71], v[224:227], v[120:135]
v_cvt_pk_bf16_f32 v90, v36, v37
v_lshrrev_b32_e64 v177, 18, v177
v_cvt_pk_bf16_f32 v91, v38, v39
v_fma_mix_f32 v165, v187, v187, v165 op_sel:[1,1,0] op_sel_hi:[1,1,0]
v_and_b32_e64 v191, s49, v191
v_pk_mul_f16 v155, v155, v154
v_cvt_pk_bf16_f32 v92, v40, v41
v_pk_mul_f16 v152, v152, v151
v_bfe_u32 v190, v191, 2, 14
v_cvt_pk_bf16_f32 v93, v42, v43
v_fma_mix_f32 v165, v188, v188, v165 op_sel:[0,0,0] op_sel_hi:[1,1,0]
v_fma_mix_f32 v166, v155, v155, 0 op_sel:[0,0,0] op_sel_hi:[1,1,0]
s_add_u32 m0, s67, 33280
s_add_u32 s66, s66, 98304
buffer_load_dwordx4 v240, s[4:7], s66 offen lds
v_lshrrev_b32 v191, 18, v191
v_cvt_pk_bf16_f32 v94, v44, v45
v_fma_mix_f32 v166, v155, v155, v166 op_sel:[1,1,0] op_sel_hi:[1,1,0]
v_fma_mix_f32 v165, v189, v189, v165 op_sel:[1,1,0] op_sel_hi:[1,1,0]
v_cvt_pk_bf16_f32 v95, v46, v47
v_fma_mix_f32 v166, v152, v152, v166 op_sel:[0,0,0] op_sel_hi:[1,1,0]
v_fma_mix_f32 v166, v152, v152, v166 op_sel:[1,1,0] op_sel_hi:[1,1,0]
s_setprio 2
v_cvt_pkrtz_f16_f32 v179, v120, v121
v_cvt_pkrtz_f16_f32 v181, v122, v123
v_cvt_pkrtz_f16_f32 v183, v124, v125
v_cvt_pkrtz_f16_f32 v185, v126, v127
v_cvt_pkrtz_f16_f32 v187, v128, v129
v_cvt_pk_f16_f32 v155, v130, v131
v_cvt_pk_f16_f32 v152, v132, v133
v_cvt_pk_f16_f32 v149, v134, v135
ds_read_b128 v[224:227], v248 offset:21504
ds_read_u16_d16_hi v177, v177
ds_read_u16_d16 v190, v190
ds_read_u16_d16_hi v191, v191
v_mfma_f32_32x32x16_bf16 v[120:135], v[72:75], v[228:231], 0
v_pk_fma_f16 v154, v155, v155, s48
v_and_b32_e64 v179, s49, v179
v_fma_mix_f32 v166, v136, v136, v166 op_sel:[0,0,0] op_sel_hi:[1,1,0]
v_pk_fma_f16 v151, v152, v152, s48
v_pk_fma_f16 v148, v149, v149, s48
v_bfe_u32 v178, v179, 2, 14
v_pk_mul_f16 v154, v155, v154
v_fma_mix_f32 v166, v137, v137, v166 op_sel:[1,1,0] op_sel_hi:[1,1,0]
v_pk_mul_f16 v151, v152, v151
v_lshrrev_b32_e64 v179, 18, v179
ds_read_b128 v[228:231], v248 offset:22528
ds_read_u16_d16 v178, v178
ds_read_u16_d16_hi v179, v179
v_mfma_f32_32x32x16_bf16 v[120:135], v[76:79], v[232:235], v[120:135]
v_pk_mul_f16 v148, v149, v148
v_exp_f16_e64 v153, v154
v_fma_mix_f32 v166, v138, v138, v166 op_sel:[0,0,0] op_sel_hi:[1,1,0]
v_and_b32 v181, s49, v181
v_exp_f16 v150, v151
v_exp_f16_e64 v147, v148
v_bfe_u32 v180, v181, 2, 14
v_fma_mix_f32 v166, v139, v139, v166 op_sel:[1,1,0] op_sel_hi:[1,1,0]
ds_read_b128 v[232:235], v248 offset:25600
ds_read_u16_d16 v180, v180
v_mfma_f32_32x32x16_bf16 v[120:135], v[80:83], v[236:239], v[120:135]
v_exp_f16_sdwa v153, v154 dst_sel:WORD_1 dst_unused:UNUSED_PRESERVE src0_sel:WORD_1
v_lshrrev_b32_e64 v181, 18, v181
v_exp_f16_sdwa v150, v151 dst_sel:WORD_1 dst_unused:UNUSED_PRESERVE src0_sel:WORD_1
v_fma_mix_f32 v166, v140, v140, v166 op_sel:[0,0,0] op_sel_hi:[1,1,0]
v_and_b32 v183, s49, v183
v_exp_f16_sdwa v147, v148 dst_sel:WORD_1 dst_unused:UNUSED_PRESERVE src0_sel:WORD_1
v_fma_mix_f32 v166, v141, v141, v166 op_sel:[1,1,0] op_sel_hi:[1,1,0]
s_waitcnt lgkmcnt(5)
ds_read_b128 v[236:239], v248 offset:23552
ds_read_u16_d16_hi v181, v181
v_mfma_f32_32x32x16_bf16 v[120:135], v[84:87], v[216:219], v[120:135]
v_pk_add_f16 v153, v153, 1.0 op_sel_hi:[1,0]
v_bfe_u32 v182, v183, 2, 14
v_pk_add_f16 v150, v150, 1.0 op_sel_hi:[1,0]
v_pk_add_f16 v147, v147, 1.0 op_sel_hi:[1,0]
v_rcp_f16 v154, v153
v_lshrrev_b32 v183, 18, v183
v_fma_mix_f32 v166, v142, v142, v166 op_sel:[0,0,0] op_sel_hi:[1,1,0]
v_rcp_f16 v151, v150
v_and_b32 v185, s49, v185
ds_read_b128 v[216:219], v248 offset:26624
ds_read_u16_d16 v182, v182
ds_read_u16_d16_hi v183, v183
v_mfma_f32_32x32x16_bf16 v[120:135], v[88:91], v[220:223], v[120:135]
v_fma_mix_f32 v166, v143, v143, v166 op_sel:[1,1,0] op_sel_hi:[1,1,0]
v_rcp_f16_e64 v148, v147
v_bfe_u32 v184, v185, 2, 14
v_rcp_f16_sdwa v154, v153 dst_sel:WORD_1 dst_unused:UNUSED_PRESERVE src0_sel:WORD_1
v_fma_mix_f32 v166, v176, v176, v166 op_sel:[0,0,0] op_sel_hi:[1,1,0]
v_rcp_f16_sdwa v151, v150 dst_sel:WORD_1 dst_unused:UNUSED_PRESERVE src0_sel:WORD_1
v_lshrrev_b32_e64 v185, 18, v185
ds_read_b128 v[220:223], v248 offset:24576
ds_read_u16_d16 v184, v184
ds_read_u16_d16_hi v185, v185
v_mfma_f32_32x32x16_bf16 v[120:135], v[92:95], v[224:227], v[120:135]
v_rcp_f16_sdwa v148, v147 dst_sel:WORD_1 dst_unused:UNUSED_PRESERVE src0_sel:WORD_1
s_cmp_eq_u32 s40, 7
s_cbranch_scc1 Lrdy16
s_waitcnt vmcnt(0)
Lrdy16:
s_mov_b64 exec, 1
ds_add_u32 v253, v254 offset:12
s_mov_b64 exec, -1
v_and_b32 v187, s49, v187
v_fma_mix_f32 v166, v177, v177, v166 op_sel:[1,1,0] op_sel_hi:[1,1,0]
v_pk_mul_f16 v155, v155, v154
v_pk_mul_f16 v152, v152, v151
v_pk_mul_f16 v149, v149, v148
v_bfe_u32 v186, v187, 2, 14
v_fma_mix_f32 v166, v190, v190, v166 op_sel:[0,0,0] op_sel_hi:[1,1,0]
v_fma_mix_f32 v167, v155, v155, 0 op_sel:[0,0,0] op_sel_hi:[1,1,0]
v_fma_mix_f32 v167, v155, v155, v167 op_sel:[1,1,0] op_sel_hi:[1,1,0]
v_lshrrev_b32_e64 v187, 18, v187
v_fma_mix_f32 v167, v152, v152, v167 op_sel:[0,0,0] op_sel_hi:[1,1,0]
v_fma_mix_f32 v166, v191, v191, v166 op_sel:[1,1,0] op_sel_hi:[1,1,0]
v_fma_mix_f32 v167, v152, v152, v167 op_sel:[1,1,0] op_sel_hi:[1,1,0]
v_fma_mix_f32 v167, v149, v149, v167 op_sel:[0,0,0] op_sel_hi:[1,1,0]
v_fma_mix_f32 v167, v149, v149, v167 op_sel:[1,1,0] op_sel_hi:[1,1,0]
s_setprio 1
v_cvt_pkrtz_f16_f32 v137, v120, v121
v_cvt_pkrtz_f16_f32 v139, v122, v123
v_cvt_pkrtz_f16_f32 v141, v124, v125
v_cvt_pkrtz_f16_f32 v143, v126, v127
v_cvt_pkrtz_f16_f32 v177, v128, v129
v_cvt_pk_f16_f32 v155, v130, v131
v_cvt_pk_f16_f32 v152, v132, v133
v_cvt_pk_f16_f32 v149, v134, v135
s_waitcnt lgkmcnt(1)
ds_read_b128 v[224:227], v248 offset:27648
ds_read_u16_d16 v186, v186
ds_read_u16_d16_hi v187, v187
v_mfma_f32_32x32x16_bf16 v[120:135], v[72:75], v[228:231], 0
v_pk_fma_f16 v154, v155, v155, s48
v_and_b32_e64 v137, s49, v137
v_fma_mix_f32 v167, v178, v178, v167 op_sel:[0,0,0] op_sel_hi:[1,1,0]
v_pk_fma_f16 v151, v152, v152, s48
v_pk_fma_f16 v148, v149, v149, s48
v_bfe_u32 v136, v137, 2, 14
v_pk_mul_f16 v154, v155, v154
v_pk_mul_f16 v151, v152, v151
v_fma_mix_f32 v167, v179, v179, v167 op_sel:[1,1,0] op_sel_hi:[1,1,0]
v_lshrrev_b32_e64 v137, 18, v137
ds_read_b128 v[228:231], v250 offset:65520
ds_read_u16_d16 v136, v136
ds_read_u16_d16_hi v137, v137
v_mfma_f32_32x32x16_bf16 v[120:135], v[76:79], v[232:235], v[120:135]
v_pk_mul_f16 v148, v149, v148
v_exp_f16 v153, v154
v_exp_f16 v150, v151
v_and_b32_e64 v139, s49, v139
v_fma_mix_f32 v167, v180, v180, v167 op_sel:[0,0,0] op_sel_hi:[1,1,0]
v_exp_f16_e64 v147, v148
v_bfe_u32 v138, v139, 2, 14
ds_read_b128 v[232:235], v248 offset:28672
ds_read_b32 v247, v253 offset:12
ds_read_u16_d16 v138, v138
v_mfma_f32_32x32x16_bf16 v[120:135], v[80:83], v[236:239], v[120:135]
v_exp_f16_sdwa v153, v154 dst_sel:WORD_1 dst_unused:UNUSED_PRESERVE src0_sel:WORD_1
v_lshrrev_b32_e64 v139, 18, v139
v_fma_mix_f32 v167, v181, v181, v167 op_sel:[1,1,0] op_sel_hi:[1,1,0]
v_exp_f16_sdwa v150, v151 dst_sel:WORD_1 dst_unused:UNUSED_PRESERVE src0_sel:WORD_1
v_exp_f16_sdwa v147, v148 dst_sel:WORD_1 dst_unused:UNUSED_PRESERVE src0_sel:WORD_1
v_and_b32_e64 v141, s49, v141
v_fma_mix_f32 v167, v182, v182, v167 op_sel:[0,0,0] op_sel_hi:[1,1,0]
ds_read_b128 v[236:239], v248 offset:31744
ds_read_u16_d16_hi v139, v139
v_mfma_f32_32x32x16_bf16 v[120:135], v[84:87], v[216:219], v[120:135]
v_pk_add_f16 v153, v153, 1.0 op_sel_hi:[1,0]
v_bfe_u32 v140, v141, 2, 14
v_pk_add_f16 v150, v150, 1.0 op_sel_hi:[1,0]
v_pk_add_f16 v147, v147, 1.0 op_sel_hi:[1,0]
v_rcp_f16 v154, v153
v_lshrrev_b32 v141, 18, v141
ds_read_u16_d16 v140, v140
ds_read_u16_d16_hi v141, v141
s_waitcnt lgkmcnt(5)
v_readfirstlane_b32 s43, v247
s_nop 1
s_cmp_ge_u32 s43, 24
s_cbranch_scc1 Lev6
Lev6w:
s_sleep 1
ds_read_b32 v247, v253 offset:12
s_waitcnt lgkmcnt(0)
v_readfirstlane_b32 s43, v247
s_cmp_eq_u32 s76, 0
s_cbranch_scc1 Lev6
s_sub_u32 s76, s76, 1
s_cmp_lt_u32 s43, 24
s_cbranch_scc1 Lev6w
Lev6:
v_fma_mix_f32 v167, v183, v183, v167 op_sel:[1,1,0] op_sel_hi:[1,1,0]
v_rcp_f16 v151, v150
ds_read_b128 v[216:219], v248 offset:29696
v_mfma_f32_32x32x16_bf16 v[120:135], v[88:91], v[220:223], v[120:135]
v_and_b32 v143, s49, v143
v_rcp_f16 v148, v147
v_fma_mix_f32 v167, v184, v184, v167 op_sel:[0,0,0] op_sel_hi:[1,1,0]
v_bfe_u32 v142, v143, 2, 14
s_setprio 0
v_rcp_f16_sdwa v154, v153 dst_sel:WORD_1 dst_unused:UNUSED_PRESERVE src0_sel:WORD_1
v_rcp_f16_sdwa v151, v150 dst_sel:WORD_1 dst_unused:UNUSED_PRESERVE src0_sel:WORD_1
v_lshrrev_b32 v143, 18, v143
ds_read_b128 v[220:223], v245
ds_read_b128 v[192:195], v242
ds_read_b128 v[196:199], v242 offset:64
ds_read_u16_d16 v142, v142
ds_read_u16_d16_hi v143, v143
v_mfma_f32_32x32x16_bf16 v[120:135], v[92:95], v[224:227], v[120:135]
v_fma_mix_f32 v167, v185, v185, v167 op_sel:[1,1,0] op_sel_hi:[1,1,0]
v_rcp_f16_sdwa v148, v147 dst_sel:WORD_1 dst_unused:UNUSED_PRESERVE src0_sel:WORD_1
v_and_b32_e64 v177, s49, v177
v_pk_mul_f16 v155, v155, v154
v_fma_mix_f32 v167, v186, v186, v167 op_sel:[0,0,0] op_sel_hi:[1,1,0]
v_pk_mul_f16 v152, v152, v151
v_bfe_u32 v176, v177, 2, 14
v_pk_mul_f16 v149, v149, v148
v_fma_mix_f32 v156, v155, v155, v156 op_sel:[0,0,0] op_sel_hi:[1,1,0]
v_fma_mix_f32 v156, v155, v155, v156 op_sel:[1,1,0] op_sel_hi:[1,1,0]
v_lshrrev_b32 v177, 18, v177
v_fma_mix_f32 v167, v187, v187, v167 op_sel:[1,1,0] op_sel_hi:[1,1,0]
v_fma_mix_f32 v156, v152, v152, v156 op_sel:[0,0,0] op_sel_hi:[1,1,0]
v_fma_mix_f32 v156, v152, v152, v156 op_sel:[1,1,0] op_sel_hi:[1,1,0]
v_fma_mix_f32 v156, v149, v149, v156 op_sel:[0,0,0] op_sel_hi:[1,1,0]
v_fma_mix_f32 v156, v149, v149, v156 op_sel:[1,1,0] op_sel_hi:[1,1,0]
s_setprio 2
v_mfma_f32_32x32x16_bf16 v[0:15], v[228:231], v[228:231], 0
buffer_store_dwordx4 v[48:51], v241, s[32:35], s80 offen sc1
ds_read_b128 v[224:227], v248 offset:32768
ds_read_u16_d16 v176, v176
ds_read_u16_d16_hi v177, v177
v_cvt_pkrtz_f16_f32 v179, v120, v121
v_cvt_pkrtz_f16_f32 v181, v122, v123
v_cvt_pkrtz_f16_f32 v183, v124, v125
v_mfma_f32_32x32x16_bf16 v[16:31], v[228:231], v[228:231], 0
v_cvt_pkrtz_f16_f32 v185, v126, v127
v_cvt_pkrtz_f16_f32 v187, v128, v129
v_cvt_pk_f16_f32 v155, v130, v131
v_cvt_pk_f16_f32 v152, v132, v133
v_mfma_f32_32x32x16_bf16 v[32:47], v[228:231], v[228:231], 0
v_cvt_pk_f16_f32 v149, v134, v135
v_pk_fma_f16 v154, v155, v155, s48
v_and_b32_e64 v179, s49, v179
v_mfma_f32_32x32x16_bf16 v[120:135], v[72:75], v[232:235], 0
ds_read_b128 v[228:231], v248 offset:30720
v_fma_mix_f32 v156, v136, v136, v156 op_sel:[0,0,0] op_sel_hi:[1,1,0]
v_pk_fma_f16 v151, v152, v152, s48
v_pk_fma_f16 v148, v149, v149, s48
v_bfe_u32 v178, v179, 2, 14
v_pk_mul_f16 v154, v155, v154
v_pk_mul_f16 v151, v152, v151
v_fma_mix_f32 v156, v137, v137, v156 op_sel:[1,1,0] op_sel_hi:[1,1,0]
s_waitcnt lgkmcnt(4)
v_mfma_f32_32x32x16_bf16 v[120:135], v[76:79], v[236:239], v[120:135]
ds_read_b128 v[232:235], v245 offset:384
ds_read_b128 v[200:203], v242 offset:128
ds_read_b128 v[204:207], v243
ds_read_u16_d16 v178, v178
v_lshrrev_b32 v179, 18, v179
v_pk_mul_f16 v148, v149, v148
v_exp_f16 v153, v154
v_exp_f16 v150, v151
v_and_b32_e64 v181, s49, v181
v_fma_mix_f32 v156, v138, v138, v156 op_sel:[0,0,0] op_sel_hi:[1,1,0]
v_mfma_f32_32x32x16_bf16 v[120:135], v[80:83], v[216:219], v[120:135]
ds_read_b128 v[236:239], v248 offset:33792
ds_read_u16_d16_hi v179, v179
v_exp_f16_e64 v147, v148
v_bfe_u32 v180, v181, 2, 14
v_exp_f16_sdwa v153, v154 dst_sel:WORD_1 dst_unused:UNUSED_PRESERVE src0_sel:WORD_1
v_lshrrev_b32_e64 v181, 18, v181
v_fma_mix_f32 v156, v139, v139, v156 op_sel:[1,1,0] op_sel_hi:[1,1,0]
v_smfmac_f32_16x16x32_bf16 v[0:3], v[220:221], v[192:195], v246
ds_read_b128 v[216:219], v245 offset:768
ds_read_b128 v[208:211], v243 offset:64
ds_read_b128 v[212:215], v243 offset:128
ds_read_u16_d16 v180, v180
ds_read_u16_d16_hi v181, v181
v_exp_f16_sdwa v150, v151 dst_sel:WORD_1 dst_unused:UNUSED_PRESERVE src0_sel:WORD_1
v_smfmac_f32_16x16x32_bf16 v[16:19], v[222:223], v[196:199], v246
v_exp_f16_sdwa v147, v148 dst_sel:WORD_1 dst_unused:UNUSED_PRESERVE src0_sel:WORD_1
v_and_b32 v183, s49, v183
v_fma_mix_f32 v156, v140, v140, v156 op_sel:[0,0,0] op_sel_hi:[1,1,0]
v_pk_add_f16 v153, v153, 1.0 op_sel_hi:[1,0]
s_waitcnt lgkmcnt(7)
v_mfma_f32_32x32x16_bf16 v[120:135], v[84:87], v[224:227], v[120:135]
ds_read_b128 v[220:223], v245 offset:1152
ds_read_b128 v[192:195], v244
ds_read_b128 v[196:199], v244 offset:64
v_bfe_u32 v182, v183, 2, 14
v_pk_add_f16 v150, v150, 1.0 op_sel_hi:[1,0]
v_pk_add_f16 v147, v147, 1.0 op_sel_hi:[1,0]
v_rcp_f16 v154, v153
v_lshrrev_b32 v183, 18, v183
v_fma_mix_f32 v156, v141, v141, v156 op_sel:[1,1,0] op_sel_hi:[1,1,0]
v_mfma_f32_32x32x16_bf16 v[120:135], v[88:91], v[228:231], v[120:135]
ds_read_b128 v[224:227], v248 offset:34816
ds_read_u16_d16 v182, v182
ds_read_u16_d16_hi v183, v183
v_rcp_f16 v151, v150
v_and_b32 v185, s49, v185
v_rcp_f16_e64 v148, v147
v_fma_mix_f32 v156, v142, v142, v156 op_sel:[0,0,0] op_sel_hi:[1,1,0]
v_bfe_u32 v184, v185, 2, 14
v_smfmac_f32_16x16x32_bf16 v[32:35], v[232:233], v[200:203], v246
ds_read_b128 v[228:231], v248 offset:37888
ds_read_u16_d16 v184, v184
v_rcp_f16_sdwa v154, v153 dst_sel:WORD_1 dst_unused:UNUSED_PRESERVE src0_sel:WORD_1
v_rcp_f16_sdwa v151, v150 dst_sel:WORD_1 dst_unused:UNUSED_PRESERVE src0_sel:WORD_1
v_smfmac_f32_16x16x32_bf16 v[0:3], v[234:235], v[204:207], v246
v_lshrrev_b32 v185, 18, v185
v_fma_mix_f32 v156, v143, v143, v156 op_sel:[1,1,0] op_sel_hi:[1,1,0]
s_waitcnt lgkmcnt(6)
v_mfma_f32_32x32x16_bf16 v[120:135], v[92:95], v[236:239], v[120:135]
ds_read_b128 v[232:235], v248 offset:35840
ds_read_u16_d16_hi v185, v185
v_rcp_f16_sdwa v148, v147 dst_sel:WORD_1 dst_unused:UNUSED_PRESERVE src0_sel:WORD_1
v_and_b32_e64 v187, s49, v187
v_pk_mul_f16 v155, v155, v154
v_fma_mix_f32 v156, v176, v176, v156 op_sel:[0,0,0] op_sel_hi:[1,1,0]
v_pk_mul_f16 v152, v152, v151
v_bfe_u32 v186, v187, 2, 14
v_pk_mul_f16 v149, v149, v148
v_smfmac_f32_16x16x32_bf16 v[16:19], v[216:217], v[208:211], v246
ds_read_b128 v[236:239], v248 offset:38912
ds_read_u16_d16 v186, v186
v_fma_mix_f32 v157, v155, v155, v157 op_sel:[0,0,0] op_sel_hi:[1,1,0]
v_fma_mix_f32 v157, v155, v155, v157 op_sel:[1,1,0] op_sel_hi:[1,1,0]
v_lshrrev_b32_e64 v187, 18, v187
v_fma_mix_f32 v156, v177, v177, v156 op_sel:[1,1,0] op_sel_hi:[1,1,0]
v_smfmac_f32_16x16x32_bf16 v[32:35], v[218:219], v[212:215], v246
v_fma_mix_f32 v157, v152, v152, v157 op_sel:[0,0,0] op_sel_hi:[1,1,0]
v_fma_mix_f32 v157, v152, v152, v157 op_sel:[1,1,0] op_sel_hi:[1,1,0]
v_fma_mix_f32 v157, v149, v149, v157 op_sel:[0,0,0] op_sel_hi:[1,1,0]
v_fma_mix_f32 v157, v149, v149, v157 op_sel:[1,1,0] op_sel_hi:[1,1,0]
s_setprio 1
v_smfmac_f32_16x16x32_bf16 v[0:3], v[220:221], v[192:195], v246
s_waitcnt lgkmcnt(4)
s_add_u32 s46, s80, 2097152
buffer_store_dwordx4 v[52:55], v241, s[32:35], s46 offen sc1
ds_read_b128 v[216:219], v248 offset:36864
ds_read_u16_d16_hi v187, v187
v_cvt_pkrtz_f16_f32 v137, v120, v121
v_cvt_pkrtz_f16_f32 v139, v122, v123
v_cvt_pkrtz_f16_f32 v141, v124, v125
v_cvt_pkrtz_f16_f32 v143, v126, v127
v_cvt_pk_f16_f32 v155, v128, v129
v_smfmac_f32_16x16x32_bf16 v[16:19], v[222:223], v[196:199], v246
v_cvt_pk_f16_f32 v152, v130, v131
v_cvt_pk_f16_f32 v149, v132, v133
v_cvt_pk_f16_f32 v146, v134, v135
v_pk_fma_f16 v154, v155, v155, s48
v_and_b32_e64 v137, s49, v137
v_mfma_f32_32x32x16_bf16 v[120:135], v[72:75], v[224:227], 0
ds_read_b128 v[220:223], v248 offset:39936
v_fma_mix_f32 v157, v178, v178, v157 op_sel:[0,0,0] op_sel_hi:[1,1,0]
v_pk_fma_f16 v151, v152, v152, s48
v_pk_fma_f16 v148, v149, v149, s48
v_pk_fma_f16 v145, v146, v146, s48
v_pk_mul_f16 v154, v155, v154
v_bfe_u32 v136, v137, 2, 14
v_pk_mul_f16 v151, v152, v151
v_fma_mix_f32 v157, v179, v179, v157 op_sel:[1,1,0] op_sel_hi:[1,1,0]
v_pk_mul_f16 v148, v149, v148
v_pk_mul_f16 v145, v146, v145
v_mfma_f32_32x32x16_bf16 v[120:135], v[76:79], v[228:231], v[120:135]
ds_read_b128 v[224:227], v245 offset:1536
ds_read_b128 v[200:203], v244 offset:128
v_xor_b32 v242, 16, v242
ds_read_b128 v[204:207], v242
ds_read_u16_d16 v136, v136
v_exp_f16 v153, v154
v_lshrrev_b32 v137, 18, v137
v_exp_f16 v150, v151
v_fma_mix_f32 v157, v180, v180, v157 op_sel:[0,0,0] op_sel_hi:[1,1,0]
v_exp_f16 v147, v148
v_and_b32 v139, s49, v139
v_exp_f16 v144, v145
s_waitcnt lgkmcnt(5)
v_mfma_f32_32x32x16_bf16 v[120:135], v[80:83], v[232:235], v[120:135]
ds_read_b128 v[228:231], v245 offset:1920
ds_read_b128 v[208:211], v242 offset:64
ds_read_b128 v[212:215], v242 offset:128
ds_read_u16_d16_hi v137, v137
v_exp_f16_sdwa v153, v154 dst_sel:WORD_1 dst_unused:UNUSED_PRESERVE src0_sel:WORD_1
v_fma_mix_f32 v157, v181, v181, v157 op_sel:[1,1,0] op_sel_hi:[1,1,0]
v_bfe_u32 v138, v139, 2, 14
v_exp_f16_sdwa v150, v151 dst_sel:WORD_1 dst_unused:UNUSED_PRESERVE src0_sel:WORD_1
v_exp_f16_sdwa v147, v148 dst_sel:WORD_1 dst_unused:UNUSED_PRESERVE src0_sel:WORD_1
v_exp_f16_sdwa v144, v145 dst_sel:WORD_1 dst_unused:UNUSED_PRESERVE src0_sel:WORD_1
v_lshrrev_b32_e64 v139, 18, v139
v_fma_mix_f32 v157, v182, v182, v157 op_sel:[0,0,0] op_sel_hi:[1,1,0]
v_mfma_f32_32x32x16_bf16 v[120:135], v[84:87], v[236:239], v[120:135]
ds_read_b128 v[232:235], v248 offset:40960
ds_read_u16_d16 v138, v138
ds_read_u16_d16_hi v139, v139
v_pk_add_f16 v153, v153, 1.0 op_sel_hi:[1,0]
v_pk_add_f16 v150, v150, 1.0 op_sel_hi:[1,0]
v_pk_add_f16 v147, v147, 1.0 op_sel_hi:[1,0]
v_and_b32_e64 v141, s49, v141
v_pk_add_f16 v144, v144, 1.0 op_sel_hi:[1,0]
v_rcp_f16_e64 v154, v153
v_fma_mix_f32 v157, v183, v183, v157 op_sel:[1,1,0] op_sel_hi:[1,1,0]
v_rcp_f16_e64 v151, v150
v_mfma_f32_32x32x16_bf16 v[120:135], v[88:91], v[216:219], v[120:135]
ds_read_b128 v[236:239], v248 offset:44032
v_bfe_u32 v140, v141, 2, 14
v_rcp_f16_e64 v148, v147
v_fma_mix_f32 v157, v184, v184, v157 op_sel:[0,0,0] op_sel_hi:[1,1,0]
v_rcp_f16 v145, v144
v_lshrrev_b32 v141, 18, v141
v_rcp_f16_sdwa v154, v153 dst_sel:WORD_1 dst_unused:UNUSED_PRESERVE src0_sel:WORD_1
s_setprio 0
v_rcp_f16_sdwa v151, v150 dst_sel:WORD_1 dst_unused:UNUSED_PRESERVE src0_sel:WORD_1
s_waitcnt lgkmcnt(4)
v_mfma_f32_32x32x16_bf16 v[120:135], v[92:95], v[220:223], v[120:135]
ds_read_b128 v[216:219], v248 offset:41984
ds_read_u16_d16 v140, v140
ds_read_u16_d16_hi v141, v141
v_fma_mix_f32 v157, v185, v185, v157 op_sel:[1,1,0] op_sel_hi:[1,1,0]
v_and_b32_e64 v143, s49, v143
v_rcp_f16_sdwa v148, v147 dst_sel:WORD_1 dst_unused:UNUSED_PRESERVE src0_sel:WORD_1
v_rcp_f16_sdwa v145, v144 dst_sel:WORD_1 dst_unused:UNUSED_PRESERVE src0_sel:WORD_1
v_pk_mul_f16 v155, v155, v154
v_bfe_u32 v142, v143, 2, 14
v_fma_mix_f32 v157, v186, v186, v157 op_sel:[0,0,0] op_sel_hi:[1,1,0]
v_pk_mul_f16 v152, v152, v151
v_pk_mul_f16 v149, v149, v148
v_smfmac_f32_16x16x32_bf16 v[32:35], v[224:225], v[200:203], v246
ds_read_b128 v[220:223], v248 offset:45056
ds_read_u16_d16 v142, v142
v_pk_mul_f16 v146, v146, v145
v_fma_mix_f32 v158, v155, v155, v158 op_sel:[0,0,0] op_sel_hi:[1,1,0]
v_lshrrev_b32 v143, 18, v143
v_fma_mix_f32 v158, v155, v155, v158 op_sel:[1,1,0] op_sel_hi:[1,1,0]
v_fma_mix_f32 v158, v152, v152, v158 op_sel:[0,0,0] op_sel_hi:[1,1,0]
v_smfmac_f32_16x16x32_bf16 v[4:7], v[226:227], v[204:207], v246
v_fma_mix_f32 v157, v187, v187, v157 op_sel:[1,1,0] op_sel_hi:[1,1,0]
v_fma_mix_f32 v158, v152, v152, v158 op_sel:[1,1,0] op_sel_hi:[1,1,0]
v_fma_mix_f32 v158, v149, v149, v158 op_sel:[0,0,0] op_sel_hi:[1,1,0]
v_fma_mix_f32 v158, v149, v149, v158 op_sel:[1,1,0] op_sel_hi:[1,1,0]
v_fma_mix_f32 v158, v146, v146, v158 op_sel:[0,0,0] op_sel_hi:[1,1,0]
v_fma_mix_f32 v158, v146, v146, v158 op_sel:[1,1,0] op_sel_hi:[1,1,0]
s_setprio 2
v_smfmac_f32_16x16x32_bf16 v[20:23], v[228:229], v[208:211], v246
s_add_u32 s46, s80, 4194304
buffer_store_dwordx4 v[56:59], v241, s[32:35], s46 offen sc1
ds_read_b128 v[224:227], v248 offset:43008
ds_read_u16_d16_hi v143, v143
v_cvt_pkrtz_f16_f32 v179, v120, v121
v_cvt_pkrtz_f16_f32 v181, v122, v123
v_cvt_pkrtz_f16_f32 v183, v124, v125
v_cvt_pkrtz_f16_f32 v185, v126, v127
v_smfmac_f32_16x16x32_bf16 v[36:39], v[230:231], v[212:215], v246
v_cvt_pkrtz_f16_f32 v187, v128, v129
v_cvt_pk_f16_f32 v155, v130, v131
v_cvt_pk_f16_f32 v152, v132, v133
v_cvt_pk_f16_f32 v149, v134, v135
v_pk_fma_f16 v154, v155, v155, s48
s_waitcnt lgkmcnt(2)
v_mfma_f32_32x32x16_bf16 v[120:135], v[72:75], v[232:235], 0
ds_read_b128 v[228:231], v248 offset:46080
v_and_b32 v179, s49, v179
v_fma_mix_f32 v158, v136, v136, v158 op_sel:[0,0,0] op_sel_hi:[1,1,0]
v_pk_fma_f16 v151, v152, v152, s48
v_pk_fma_f16 v148, v149, v149, s48
v_bfe_u32 v178, v179, 2, 14
v_pk_mul_f16 v154, v155, v154
v_pk_mul_f16 v151, v152, v151
v_pk_mul_f16 v148, v149, v148
v_lshrrev_b32 v179, 18, v179
v_mfma_f32_32x32x16_bf16 v[120:135], v[76:79], v[236:239], v[120:135]
ds_read_b128 v[232:235], v245 offset:2304
v_xor_b32 v243, 16, v243
ds_read_b128 v[192:195], v243
ds_read_b128 v[196:199], v243 offset:64
ds_read_u16_d16 v178, v178
ds_read_u16_d16_hi v179, v179
v_fma_mix_f32 v158, v137, v137, v158 op_sel:[1,1,0] op_sel_hi:[1,1,0]
v_exp_f16 v153, v154
v_and_b32 v181, s49, v181
v_exp_f16 v150, v151
v_exp_f16 v147, v148
v_bfe_u32 v180, v181, 2, 14
v_mfma_f32_32x32x16_bf16 v[120:135], v[80:83], v[216:219], v[120:135]
ds_read_b128 v[236:239], v245 offset:2688
ds_read_b128 v[200:203], v243 offset:128
v_xor_b32 v244, 16, v244
ds_read_b128 v[204:207], v244
ds_read_u16_d16 v180, v180
v_fma_mix_f32 v158, v138, v138, v158 op_sel:[0,0,0] op_sel_hi:[1,1,0]
v_exp_f16_sdwa v153, v154 dst_sel:WORD_1 dst_unused:UNUSED_PRESERVE src0_sel:WORD_1
v_lshrrev_b32 v181, 18, v181
v_exp_f16_sdwa v150, v151 dst_sel:WORD_1 dst_unused:UNUSED_PRESERVE src0_sel:WORD_1
v_fma_mix_f32 v158, v139, v139, v158 op_sel:[1,1,0] op_sel_hi:[1,1,0]
v_and_b32_e64 v183, s49, v183
v_mfma_f32_32x32x16_bf16 v[120:135], v[84:87], v[220:223], v[120:135]
ds_read_b128 v[216:219], v248 offset:47104
ds_read_u16_d16_hi v181, v181
v_exp_f16_sdwa v147, v148 dst_sel:WORD_1 dst_unused:UNUSED_PRESERVE src0_sel:WORD_1
v_pk_add_f16 v153, v153, 1.0 op_sel_hi:[1,0]
v_bfe_u32 v182, v183, 2, 14
v_pk_add_f16 v150, v150, 1.0 op_sel_hi:[1,0]
v_pk_add_f16 v147, v147, 1.0 op_sel_hi:[1,0]
v_rcp_f16_e64 v154, v153
v_lshrrev_b32 v183, 18, v183
v_fma_mix_f32 v158, v140, v140, v158 op_sel:[0,0,0] op_sel_hi:[1,1,0]
s_waitcnt lgkmcnt(6)
v_mfma_f32_32x32x16_bf16 v[120:135], v[88:91], v[224:227], v[120:135]
ds_read_b128 v[220:223], v248 offset:50176
ds_read_u16_d16 v182, v182
ds_read_u16_d16_hi v183, v183
v_rcp_f16 v151, v150
v_and_b32 v185, s49, v185
v_rcp_f16_e64 v148, v147
v_fma_mix_f32 v158, v141, v141, v158 op_sel:[1,1,0] op_sel_hi:[1,1,0]
v_bfe_u32 v184, v185, 2, 14
v_rcp_f16_sdwa v154, v153 dst_sel:WORD_1 dst_unused:UNUSED_PRESERVE src0_sel:WORD_1
v_mfma_f32_32x32x16_bf16 v[120:135], v[92:95], v[228:231], v[120:135]
ds_read_b128 v[224:227], v248 offset:48128
ds_read_u16_d16 v184, v184
v_rcp_f16_sdwa v151, v150 dst_sel:WORD_1 dst_unused:UNUSED_PRESERVE src0_sel:WORD_1
v_lshrrev_b32_e64 v185, 18, v185
v_rcp_f16_sdwa v148, v147 dst_sel:WORD_1 dst_unused:UNUSED_PRESERVE src0_sel:WORD_1
v_and_b32_e64 v187, s49, v187
v_fma_mix_f32 v158, v142, v142, v158 op_sel:[0,0,0] op_sel_hi:[1,1,0]
v_pk_mul_f16 v155, v155, v154
v_pk_mul_f16 v152, v152, v151
v_smfmac_f32_16x16x32_bf16 v[4:7], v[232:233], v[192:195], v246
ds_read_b128 v[228:231], v248 offset:51200
ds_read_u16_d16_hi v185, v185
v_bfe_u32 v186, v187, 2, 14
v_pk_mul_f16 v149, v149, v148
v_fma_mix_f32 v159, v155, v155, v159 op_sel:[0,0,0] op_sel_hi:[1,1,0]
v_fma_mix_f32 v158, v143, v143, v158 op_sel:[1,1,0] op_sel_hi:[1,1,0]
v_lshrrev_b32_e64 v187, 18, v187
v_smfmac_f32_16x16x32_bf16 v[20:23], v[234:235], v[196:199], v246
v_fma_mix_f32 v159, v155, v155, v159 op_sel:[1,1,0] op_sel_hi:[1,1,0]
v_fma_mix_f32 v159, v152, v152, v159 op_sel:[0,0,0] op_sel_hi:[1,1,0]
v_fma_mix_f32 v159, v152, v152, v159 op_sel:[1,1,0] op_sel_hi:[1,1,0]
v_fma_mix_f32 v159, v149, v149, v159 op_sel:[0,0,0] op_sel_hi:[1,1,0]
v_fma_mix_f32 v159, v149, v149, v159 op_sel:[1,1,0] op_sel_hi:[1,1,0]
s_setprio 1
s_waitcnt lgkmcnt(4)
v_smfmac_f32_16x16x32_bf16 v[36:39], v[236:237], v[200:203], v246
s_add_u32 s46, s80, 6291456
buffer_store_dwordx4 v[60:63], v241, s[32:35], s46 offen sc1
ds_read_b128 v[232:235], v248 offset:49152
ds_read_u16_d16 v186, v186
ds_read_u16_d16_hi v187, v187
v_cvt_pkrtz_f16_f32 v137, v120, v121
v_cvt_pkrtz_f16_f32 v139, v122, v123
v_cvt_pkrtz_f16_f32 v141, v124, v125
v_cvt_pkrtz_f16_f32 v143, v126, v127
v_cvt_pk_f16_f32 v155, v128, v129
v_smfmac_f32_16x16x32_bf16 v[4:7], v[238:239], v[204:207], v246
v_cvt_pk_f16_f32 v152, v130, v131
v_cvt_pk_f16_f32 v149, v132, v133
v_cvt_pk_f16_f32 v146, v134, v135
v_pk_fma_f16 v154, v155, v155, s48
v_and_b32_e64 v137, s49, v137
v_mfma_f32_32x32x16_bf16 v[120:135], v[72:75], v[216:219], 0
ds_read_b128 v[236:239], v248 offset:52224
v_fma_mix_f32 v159, v178, v178, v159 op_sel:[0,0,0] op_sel_hi:[1,1,0]
v_pk_fma_f16 v151, v152, v152, s48
v_pk_fma_f16 v148, v149, v149, s48
v_pk_fma_f16 v145, v146, v146, s48
v_pk_mul_f16 v154, v155, v154
v_bfe_u32 v136, v137, 2, 14
v_pk_mul_f16 v151, v152, v151
v_fma_mix_f32 v159, v179, v179, v159 op_sel:[1,1,0] op_sel_hi:[1,1,0]
v_pk_mul_f16 v148, v149, v148
v_pk_mul_f16 v145, v146, v145
v_mfma_f32_32x32x16_bf16 v[120:135], v[76:79], v[220:223], v[120:135]
ds_read_b128 v[216:219], v245 offset:3072
ds_read_b128 v[208:211], v244 offset:64
ds_read_b128 v[212:215], v244 offset:128
ds_read_u16_d16 v136, v136
v_exp_f16 v153, v154
v_lshrrev_b32 v137, 18, v137
v_exp_f16_e64 v150, v151
v_fma_mix_f32 v159, v180, v180, v159 op_sel:[0,0,0] op_sel_hi:[1,1,0]
v_exp_f16 v147, v148
v_and_b32 v139, s49, v139
v_exp_f16_e64 v144, v145
s_waitcnt lgkmcnt(5)
v_mfma_f32_32x32x16_bf16 v[120:135], v[80:83], v[224:227], v[120:135]
ds_read_b128 v[220:223], v245 offset:3456
v_xor_b32 v242, 32, v242
ds_read_b128 v[192:195], v242
ds_read_b128 v[196:199], v242 offset:64
ds_read_u16_d16_hi v137, v137
v_exp_f16_sdwa v153, v154 dst_sel:WORD_1 dst_unused:UNUSED_PRESERVE src0_sel:WORD_1
v_fma_mix_f32 v159, v181, v181, v159 op_sel:[1,1,0] op_sel_hi:[1,1,0]
v_bfe_u32 v138, v139, 2, 14
v_exp_f16_sdwa v150, v151 dst_sel:WORD_1 dst_unused:UNUSED_PRESERVE src0_sel:WORD_1
v_exp_f16_sdwa v147, v148 dst_sel:WORD_1 dst_unused:UNUSED_PRESERVE src0_sel:WORD_1
v_exp_f16_sdwa v144, v145 dst_sel:WORD_1 dst_unused:UNUSED_PRESERVE src0_sel:WORD_1
v_lshrrev_b32_e64 v139, 18, v139
v_fma_mix_f32 v159, v182, v182, v159 op_sel:[0,0,0] op_sel_hi:[1,1,0]
v_mfma_f32_32x32x16_bf16 v[120:135], v[84:87], v[228:231], v[120:135]
ds_read_b128 v[224:227], v248 offset:53248
ds_read_u16_d16 v138, v138
ds_read_u16_d16_hi v139, v139
v_pk_add_f16 v153, v153, 1.0 op_sel_hi:[1,0]
v_pk_add_f16 v150, v150, 1.0 op_sel_hi:[1,0]
v_pk_add_f16 v147, v147, 1.0 op_sel_hi:[1,0]
v_and_b32_e64 v141, s49, v141
v_pk_add_f16 v144, v144, 1.0 op_sel_hi:[1,0]
v_rcp_f16_e64 v154, v153
v_fma_mix_f32 v159, v183, v183, v159 op_sel:[1,1,0] op_sel_hi:[1,1,0]
v_rcp_f16_e64 v151, v150
v_mfma_f32_32x32x16_bf16 v[120:135], v[88:91], v[232:235], v[120:135]
ds_read_b128 v[228:231], v248 offset:56320
v_bfe_u32 v140, v141, 2, 14
v_rcp_f16_e64 v148, v147
v_fma_mix_f32 v159, v184, v184, v159 op_sel:[0,0,0] op_sel_hi:[1,1,0]
v_rcp_f16 v145, v144
v_lshrrev_b32 v141, 18, v141
v_rcp_f16_sdwa v154, v153 dst_sel:WORD_1 dst_unused:UNUSED_PRESERVE src0_sel:WORD_1
s_setprio 0
v_rcp_f16_sdwa v151, v150 dst_sel:WORD_1 dst_unused:UNUSED_PRESERVE src0_sel:WORD_1
s_waitcnt lgkmcnt(4)
v_mfma_f32_32x32x16_bf16 v[120:135], v[92:95], v[236:239], v[120:135]
ds_read_b128 v[232:235], v248 offset:54272
ds_read_u16_d16 v140, v140
ds_read_u16_d16_hi v141, v141
v_fma_mix_f32 v159, v185, v185, v159 op_sel:[1,1,0] op_sel_hi:[1,1,0]
v_and_b32_e64 v143, s49, v143
v_rcp_f16_sdwa v148, v147 dst_sel:WORD_1 dst_unused:UNUSED_PRESERVE src0_sel:WORD_1
v_rcp_f16_sdwa v145, v144 dst_sel:WORD_1 dst_unused:UNUSED_PRESERVE src0_sel:WORD_1
v_pk_mul_f16 v155, v155, v154
v_bfe_u32 v142, v143, 2, 14
v_fma_mix_f32 v159, v186, v186, v159 op_sel:[0,0,0] op_sel_hi:[1,1,0]
v_pk_mul_f16 v152, v152, v151
v_pk_mul_f16 v149, v149, v148
v_smfmac_f32_16x16x32_bf16 v[20:23], v[216:217], v[208:211], v246
ds_read_b128 v[236:239], v248 offset:57344
ds_read_u16_d16 v142, v142
v_pk_mul_f16 v146, v146, v145
v_fma_mix_f32 v160, v155, v155, v160 op_sel:[0,0,0] op_sel_hi:[1,1,0]
v_lshrrev_b32_e64 v143, 18, v143
v_fma_mix_f32 v160, v155, v155, v160 op_sel:[1,1,0] op_sel_hi:[1,1,0]
v_fma_mix_f32 v160, v152, v152, v160 op_sel:[0,0,0] op_sel_hi:[1,1,0]
v_smfmac_f32_16x16x32_bf16 v[36:39], v[218:219], v[212:215], v246
v_fma_mix_f32 v159, v187, v187, v159 op_sel:[1,1,0] op_sel_hi:[1,1,0]
v_fma_mix_f32 v160, v152, v152, v160 op_sel:[1,1,0] op_sel_hi:[1,1,0]
v_fma_mix_f32 v160, v149, v149, v160 op_sel:[0,0,0] op_sel_hi:[1,1,0]
v_fma_mix_f32 v160, v149, v149, v160 op_sel:[1,1,0] op_sel_hi:[1,1,0]
v_fma_mix_f32 v160, v146, v146, v160 op_sel:[0,0,0] op_sel_hi:[1,1,0]
v_fma_mix_f32 v160, v146, v146, v160 op_sel:[1,1,0] op_sel_hi:[1,1,0]
s_cmp_lg_u32 s40, 7
s_cbranch_scc1 Lnobias2
s_sub_u32 s43, s2, 96
s_cmp_lt_u32 s43, 96
s_cbranch_scc0 Lnobias2
s_waitcnt vmcnt(15)
v_lshlrev_b32 v102, 16, v102
v_lshlrev_b32 v103, 16, v103
v_lshlrev_b32 v104, 16, v104
v_lshlrev_b32 v105, 16, v105
v_lshlrev_b32 v106, 16, v106
v_lshlrev_b32 v107, 16, v107
v_lshlrev_b32 v108, 16, v108
v_lshlrev_b32 v109, 16, v109
v_lshlrev_b32 v110, 16, v110
v_lshlrev_b32 v111, 16, v111
v_lshlrev_b32 v112, 16, v112
v_lshlrev_b32 v113, 16, v113
v_mul_f32 v100, v102, v108
v_fmac_f32 v100, v103, v109
v_fmac_f32 v100, v104, v110
v_fmac_f32 v100, v105, v111
v_fmac_f32 v100, v106, v112
v_fmac_f32 v100, v107, v113
s_nop 1
v_add_f32_dpp v100, v100, v100 row_ror:8 row_mask:0xf bank_mask:0xf
s_nop 1
v_add_f32_dpp v100, v100, v100 row_ror:4 row_mask:0xf bank_mask:0xf
s_nop 1
v_add_f32_dpp v100, v100, v100 row_ror:2 row_mask:0xf bank_mask:0xf
s_nop 1
v_add_f32_dpp v100, v100, v100 row_ror:1 row_mask:0xf bank_mask:0xf
v_mov_b32 v101, v100
s_nop 1
v_permlane16_swap_b32 v100, v101
v_add_f32 v100, v100, v101
v_mov_b32_e64 v101, v100
s_nop 1
v_permlane32_swap_b32 v100, v101
v_add_f32 v100, v100, v101
s_lshl_b32 s44, s43, 2
s_add_u32 s44, s44, 394752
v_lshlrev_b32_e64 v115, 11, v251
s_mov_b64 exec, 0xff
buffer_store_dword v100, v115, s[32:35], s44 offen sc1
s_mov_b64 exec, -1
Lnobias2:
s_setprio 2
v_smfmac_f32_16x16x32_bf16 v[12:15], v[220:221], v[192:195], v246
s_add_u32 s46, s80, 8388608
buffer_store_dwordx4 v[64:67], v241, s[32:35], s46 offen sc1
ds_read_b128 v[216:219], v248 offset:55296
ds_read_u16_d16_hi v143, v143
v_cvt_pkrtz_f16_f32 v179, v120, v121
v_cvt_pkrtz_f16_f32 v181, v122, v123
v_cvt_pkrtz_f16_f32 v183, v124, v125
v_cvt_pkrtz_f16_f32 v185, v126, v127
v_smfmac_f32_16x16x32_bf16 v[28:31], v[222:223], v[196:199], v246
v_cvt_pkrtz_f16_f32 v187, v128, v129
v_cvt_pk_f16_f32 v155, v130, v131
v_cvt_pk_f16_f32 v152, v132, v133
v_cvt_pk_f16_f32 v149, v134, v135
s_waitcnt lgkmcnt(2)
v_mfma_f32_32x32x16_bf16 v[120:135], v[72:75], v[224:227], 0
ds_read_b128 v[220:223], v245 offset:3840
ds_read_b128 v[200:203], v242 offset:128
v_xor_b32 v243, 32, v243
ds_read_b128 v[204:207], v243
v_pk_fma_f16 v154, v155, v155, s48
v_and_b32_e64 v179, s49, v179
v_fma_mix_f32 v160, v136, v136, v160 op_sel:[0,0,0] op_sel_hi:[1,1,0]
v_pk_fma_f16 v151, v152, v152, s48
v_pk_fma_f16 v148, v149, v149, s48
v_bfe_u32 v178, v179, 2, 14
v_pk_mul_f16 v154, v155, v154
v_pk_mul_f16 v151, v152, v151
v_mfma_f32_32x32x16_bf16 v[120:135], v[76:79], v[228:231], v[120:135]
ds_read_b128 v[224:227], v248 offset:58368
ds_read_u16_d16 v178, v178
v_pk_mul_f16 v148, v149, v148
v_lshrrev_b32_e64 v179, 18, v179
v_fma_mix_f32 v160, v137, v137, v160 op_sel:[1,1,0] op_sel_hi:[1,1,0]
v_exp_f16 v153, v154
v_and_b32 v181, s49, v181
v_exp_f16_e64 v150, v151
v_mfma_f32_32x32x16_bf16 v[120:135], v[80:83], v[232:235], v[120:135]
ds_read_b128 v[228:231], v245 offset:4224
ds_read_b128 v[208:211], v243 offset:64
ds_read_b128 v[212:215], v243 offset:128
ds_read_u16_d16_hi v179, v179
v_exp_f16_e64 v147, v148
v_bfe_u32 v180, v181, 2, 14
v_fma_mix_f32 v160, v138, v138, v160 op_sel:[0,0,0] op_sel_hi:[1,1,0]
v_exp_f16_sdwa v153, v154 dst_sel:WORD_1 dst_unused:UNUSED_PRESERVE src0_sel:WORD_1
v_lshrrev_b32 v181, 18, v181
v_mfma_f32_32x32x16_bf16 v[120:135], v[84:87], v[236:239], v[120:135]
ds_read_b128 v[232:235], v245 offset:4608
v_xor_b32 v244, 32, v244
ds_read_b128 v[192:195], v244
ds_read_b128 v[196:199], v244 offset:64
ds_read_u16_d16 v180, v180
ds_read_u16_d16_hi v181, v181
v_exp_f16_sdwa v150, v151 dst_sel:WORD_1 dst_unused:UNUSED_PRESERVE src0_sel:WORD_1
v_fma_mix_f32 v160, v139, v139, v160 op_sel:[1,1,0] op_sel_hi:[1,1,0]
v_and_b32 v183, s49, v183
v_exp_f16_sdwa v147, v148 dst_sel:WORD_1 dst_unused:UNUSED_PRESERVE src0_sel:WORD_1
v_pk_add_f16 v153, v153, 1.0 op_sel_hi:[1,0]
v_bfe_u32 v182, v183, 2, 14
v_pk_add_f16 v150, v150, 1.0 op_sel_hi:[1,0]
s_waitcnt lgkmcnt(9)
v_mfma_f32_32x32x16_bf16 v[120:135], v[88:91], v[216:219], v[120:135]
ds_read_b128 v[236:239], v248 offset:59392
ds_read_u16_d16 v182, v182
v_pk_add_f16 v147, v147, 1.0 op_sel_hi:[1,0]
v_rcp_f16 v154, v153
v_lshrrev_b32 v183, 18, v183
v_fma_mix_f32 v160, v140, v140, v160 op_sel:[0,0,0] op_sel_hi:[1,1,0]
v_rcp_f16 v151, v150
v_and_b32 v185, s49, v185
v_smfmac_f32_16x16x32_bf16 v[44:47], v[220:221], v[200:203], v246
ds_read_b128 v[216:219], v248 offset:62464
ds_read_u16_d16_hi v183, v183
v_rcp_f16_e64 v148, v147
v_fma_mix_f32 v160, v141, v141, v160 op_sel:[1,1,0] op_sel_hi:[1,1,0]
v_bfe_u32 v184, v185, 2, 14
v_smfmac_f32_16x16x32_bf16 v[12:15], v[222:223], v[204:207], v246
v_rcp_f16_sdwa v154, v153 dst_sel:WORD_1 dst_unused:UNUSED_PRESERVE src0_sel:WORD_1
v_rcp_f16_sdwa v151, v150 dst_sel:WORD_1 dst_unused:UNUSED_PRESERVE src0_sel:WORD_1
v_mfma_f32_32x32x16_bf16 v[120:135], v[92:95], v[224:227], v[120:135]
ds_read_b128 v[220:223], v248 offset:60416
ds_read_u16_d16 v184, v184
v_lshrrev_b32_e64 v185, 18, v185
v_rcp_f16_sdwa v148, v147 dst_sel:WORD_1 dst_unused:UNUSED_PRESERVE src0_sel:WORD_1
v_and_b32 v187, s49, v187
v_fma_mix_f32 v160, v142, v142, v160 op_sel:[0,0,0] op_sel_hi:[1,1,0]
v_pk_mul_f16 v155, v155, v154
v_pk_mul_f16 v152, v152, v151
v_bfe_u32 v186, v187, 2, 14
s_waitcnt lgkmcnt(4)
v_smfmac_f32_16x16x32_bf16 v[28:31], v[228:229], v[208:211], v246
ds_read_b128 v[224:227], v248 offset:63488
ds_read_u16_d16_hi v185, v185
ds_read_u16_d16 v186, v186
v_pk_mul_f16 v149, v149, v148
v_fma_mix_f32 v161, v155, v155, v161 op_sel:[0,0,0] op_sel_hi:[1,1,0]
v_fma_mix_f32 v160, v143, v143, v160 op_sel:[1,1,0] op_sel_hi:[1,1,0]
v_lshrrev_b32_e64 v187, 18, v187
v_smfmac_f32_16x16x32_bf16 v[44:47], v[230:231], v[212:215], v246
v_fma_mix_f32 v161, v155, v155, v161 op_sel:[1,1,0] op_sel_hi:[1,1,0]
v_fma_mix_f32 v161, v152, v152, v161 op_sel:[0,0,0] op_sel_hi:[1,1,0]
v_fma_mix_f32 v161, v152, v152, v161 op_sel:[1,1,0] op_sel_hi:[1,1,0]
v_fma_mix_f32 v161, v149, v149, v161 op_sel:[0,0,0] op_sel_hi:[1,1,0]
v_fma_mix_f32 v161, v149, v149, v161 op_sel:[1,1,0] op_sel_hi:[1,1,0]
v_lshlrev_b32_e64 v252, 7, v251
s_add_u32 s46, s47, 2359296
s_mov_b32 exec_lo, 131071
s_mov_b32 exec_hi, 0
s_mov_b32 m0, 16288
s_nop 0
buffer_load_dword v252, s[4:7], s46 offen lds
s_mov_b64 exec, -1
s_setprio 1
v_smfmac_f32_16x16x32_bf16 v[12:15], v[232:233], v[192:195], v246
s_add_u32 s46, s80, 10485760
buffer_store_dwordx4 v[68:71], v241, s[32:35], s46 offen sc1
ds_read_b128 v[228:231], v248 offset:61440
ds_read_u16_d16_hi v187, v187
v_cvt_pkrtz_f16_f32 v137, v120, v121
v_cvt_pkrtz_f16_f32 v139, v122, v123
v_cvt_pkrtz_f16_f32 v141, v124, v125
v_cvt_pkrtz_f16_f32 v143, v126, v127
v_cvt_pk_f16_f32 v155, v128, v129
v_smfmac_f32_16x16x32_bf16 v[28:31], v[234:235], v[196:199], v246
v_cvt_pk_f16_f32 v152, v130, v131
v_cvt_pk_f16_f32 v149, v132, v133
v_cvt_pk_f16_f32 v146, v134, v135
v_pk_fma_f16 v154, v155, v155, s48
v_and_b32_e64 v137, s49, v137
v_mfma_f32_32x32x16_bf16 v[120:135], v[72:75], v[236:239], 0
ds_read_b128 v[232:235], v248 offset:64512
v_fma_mix_f32 v161, v178, v178, v161 op_sel:[0,0,0] op_sel_hi:[1,1,0]
v_pk_fma_f16 v151, v152, v152, s48
v_pk_fma_f16 v148, v149, v149, s48
v_pk_fma_f16 v145, v146, v146, s48
v_pk_mul_f16 v154, v155, v154
v_bfe_u32 v136, v137, 2, 14
v_pk_mul_f16 v151, v152, v151
v_fma_mix_f32 v161, v179, v179, v161 op_sel:[1,1,0] op_sel_hi:[1,1,0]
v_pk_mul_f16 v148, v149, v148
v_pk_mul_f16 v145, v146, v145
s_waitcnt lgkmcnt(2)
v_mfma_f32_32x32x16_bf16 v[120:135], v[76:79], v[216:219], v[120:135]
ds_read_b128 v[236:239], v245 offset:4992
ds_read_b128 v[200:203], v244 offset:128
v_xor_b32 v242, 16, v242
ds_read_b128 v[204:207], v242
ds_read_u16_d16 v136, v136
v_exp_f16 v153, v154
v_lshrrev_b32 v137, 18, v137
v_exp_f16_e64 v150, v151
v_fma_mix_f32 v161, v180, v180, v161 op_sel:[0,0,0] op_sel_hi:[1,1,0]
v_exp_f16 v147, v148
v_and_b32 v139, s49, v139
v_exp_f16_e64 v144, v145
v_mfma_f32_32x32x16_bf16 v[120:135], v[80:83], v[220:223], v[120:135]
ds_read_b128 v[216:219], v245 offset:5376
ds_read_b128 v[208:211], v242 offset:64
ds_read_b128 v[212:215], v242 offset:128
ds_read_u16_d16_hi v137, v137
v_exp_f16_sdwa v153, v154 dst_sel:WORD_1 dst_unused:UNUSED_PRESERVE src0_sel:WORD_1
v_fma_mix_f32 v161, v181, v181, v161 op_sel:[1,1,0] op_sel_hi:[1,1,0]
v_bfe_u32 v138, v139, 2, 14
v_exp_f16_sdwa v150, v151 dst_sel:WORD_1 dst_unused:UNUSED_PRESERVE src0_sel:WORD_1
v_exp_f16_sdwa v147, v148 dst_sel:WORD_1 dst_unused:UNUSED_PRESERVE src0_sel:WORD_1
v_exp_f16_sdwa v144, v145 dst_sel:WORD_1 dst_unused:UNUSED_PRESERVE src0_sel:WORD_1
v_lshrrev_b32_e64 v139, 18, v139
v_fma_mix_f32 v161, v182, v182, v161 op_sel:[0,0,0] op_sel_hi:[1,1,0]
v_mfma_f32_32x32x16_bf16 v[120:135], v[84:87], v[224:227], v[120:135]
ds_read_b128 v[220:223], v249
ds_read_u16_d16 v138, v138
ds_read_u16_d16_hi v139, v139
v_pk_add_f16 v153, v153, 1.0 op_sel_hi:[1,0]
v_pk_add_f16 v150, v150, 1.0 op_sel_hi:[1,0]
v_pk_add_f16 v147, v147, 1.0 op_sel_hi:[1,0]
v_and_b32_e64 v141, s49, v141
v_pk_add_f16 v144, v144, 1.0 op_sel_hi:[1,0]
v_rcp_f16_e64 v154, v153
v_fma_mix_f32 v161, v183, v183, v161 op_sel:[1,1,0] op_sel_hi:[1,1,0]
v_rcp_f16_e64 v151, v150
v_mfma_f32_32x32x16_bf16 v[120:135], v[88:91], v[228:231], v[120:135]
ds_read_b128 v[224:227], v249 offset:3072
v_bfe_u32 v140, v141, 2, 14
v_rcp_f16_e64 v148, v147
v_fma_mix_f32 v161, v184, v184, v161 op_sel:[0,0,0] op_sel_hi:[1,1,0]
v_rcp_f16 v145, v144
v_lshrrev_b32 v141, 18, v141
v_rcp_f16_sdwa v154, v153 dst_sel:WORD_1 dst_unused:UNUSED_PRESERVE src0_sel:WORD_1
s_setprio 0
v_rcp_f16_sdwa v151, v150 dst_sel:WORD_1 dst_unused:UNUSED_PRESERVE src0_sel:WORD_1
s_waitcnt lgkmcnt(4)
v_mfma_f32_32x32x16_bf16 v[120:135], v[92:95], v[232:235], v[120:135]
ds_read_b128 v[228:231], v249 offset:1024
ds_read_u16_d16 v140, v140
ds_read_u16_d16_hi v141, v141
v_fma_mix_f32 v161, v185, v185, v161 op_sel:[1,1,0] op_sel_hi:[1,1,0]
v_and_b32_e64 v143, s49, v143
v_rcp_f16_sdwa v148, v147 dst_sel:WORD_1 dst_unused:UNUSED_PRESERVE src0_sel:WORD_1
v_rcp_f16_sdwa v145, v144 dst_sel:WORD_1 dst_unused:UNUSED_PRESERVE src0_sel:WORD_1
v_pk_mul_f16 v155, v155, v154
v_bfe_u32 v142, v143, 2, 14
v_fma_mix_f32 v161, v186, v186, v161 op_sel:[0,0,0] op_sel_hi:[1,1,0]
v_pk_mul_f16 v152, v152, v151
v_pk_mul_f16 v149, v149, v148
v_smfmac_f32_16x16x32_bf16 v[44:47], v[236:237], v[200:203], v246
ds_read_b128 v[232:235], v249 offset:4096
ds_read_u16_d16 v142, v142
v_pk_mul_f16 v146, v146, v145
v_fma_mix_f32 v162, v155, v155, v162 op_sel:[0,0,0] op_sel_hi:[1,1,0]
v_lshrrev_b32_e64 v143, 18, v143
v_fma_mix_f32 v162, v155, v155, v162 op_sel:[1,1,0] op_sel_hi:[1,1,0]
v_fma_mix_f32 v162, v152, v152, v162 op_sel:[0,0,0] op_sel_hi:[1,1,0]
v_smfmac_f32_16x16x32_bf16 v[8:11], v[238:239], v[204:207], v246
v_fma_mix_f32 v161, v187, v187, v161 op_sel:[1,1,0] op_sel_hi:[1,1,0]
v_fma_mix_f32 v162, v152, v152, v162 op_sel:[1,1,0] op_sel_hi:[1,1,0]
v_fma_mix_f32 v162, v149, v149, v162 op_sel:[0,0,0] op_sel_hi:[1,1,0]
v_fma_mix_f32 v162, v149, v149, v162 op_sel:[1,1,0] op_sel_hi:[1,1,0]
v_fma_mix_f32 v162, v146, v146, v162 op_sel:[0,0,0] op_sel_hi:[1,1,0]
v_fma_mix_f32 v162, v146, v146, v162 op_sel:[1,1,0] op_sel_hi:[1,1,0]
v_lshlrev_b32_e64 v252, 7, v251
s_add_u32 s46, s47, 2359296
s_mov_b32 exec_lo, 4294836224
s_mov_b32 exec_hi, 3
s_mov_b32 m0, 16220
s_nop 0
buffer_load_dword v252, s[4:7], s46 offen lds
s_mov_b64 exec, -1
s_setprio 2
v_smfmac_f32_16x16x32_bf16 v[24:27], v[216:217], v[208:211], v246
ds_read_b128 v[236:239], v249 offset:2048
ds_read_u16_d16_hi v143, v143
v_cvt_pkrtz_f16_f32 v179, v120, v121
v_cvt_pkrtz_f16_f32 v181, v122, v123
v_cvt_pkrtz_f16_f32 v183, v124, v125
v_cvt_pkrtz_f16_f32 v185, v126, v127
v_smfmac_f32_16x16x32_bf16 v[40:43], v[218:219], v[212:215], v246
v_cvt_pkrtz_f16_f32 v187, v128, v129
v_cvt_pk_f16_f32 v155, v130, v131
v_cvt_pk_f16_f32 v152, v132, v133
v_cvt_pk_f16_f32 v149, v134, v135
v_pk_fma_f16 v154, v155, v155, s48
s_waitcnt lgkmcnt(2)
v_mfma_f32_32x32x16_bf16 v[120:135], v[72:75], v[220:223], 0
ds_read_b128 v[216:219], v249 offset:5120
v_and_b32 v179, s49, v179
v_fma_mix_f32 v162, v136, v136, v162 op_sel:[0,0,0] op_sel_hi:[1,1,0]
v_pk_fma_f16 v151, v152, v152, s48
v_pk_fma_f16 v148, v149, v149, s48
v_bfe_u32 v178, v179, 2, 14
v_pk_mul_f16 v154, v155, v154
v_pk_mul_f16 v151, v152, v151
v_pk_mul_f16 v148, v149, v148
v_lshrrev_b32 v179, 18, v179
v_mfma_f32_32x32x16_bf16 v[120:135], v[76:79], v[224:227], v[120:135]
ds_read_b128 v[220:223], v245 offset:5760
v_xor_b32 v243, 16, v243
ds_read_b128 v[192:195], v243
ds_read_b128 v[196:199], v243 offset:64
ds_read_u16_d16 v178, v178
ds_read_u16_d16_hi v179, v179
v_fma_mix_f32 v162, v137, v137, v162 op_sel:[1,1,0] op_sel_hi:[1,1,0]
v_exp_f16 v153, v154
v_and_b32 v181, s49, v181
v_exp_f16 v150, v151
v_exp_f16 v147, v148
v_bfe_u32 v180, v181, 2, 14
v_mfma_f32_32x32x16_bf16 v[120:135], v[80:83], v[228:231], v[120:135]
ds_read_b128 v[224:227], v245 offset:6144
ds_read_b128 v[200:203], v243 offset:128
v_xor_b32 v244, 16, v244
ds_read_b128 v[204:207], v244
ds_read_u16_d16 v180, v180
v_fma_mix_f32 v162, v138, v138, v162 op_sel:[0,0,0] op_sel_hi:[1,1,0]
v_exp_f16_sdwa v153, v154 dst_sel:WORD_1 dst_unused:UNUSED_PRESERVE src0_sel:WORD_1
v_lshrrev_b32 v181, 18, v181
v_exp_f16_sdwa v150, v151 dst_sel:WORD_1 dst_unused:UNUSED_PRESERVE src0_sel:WORD_1
v_fma_mix_f32 v162, v139, v139, v162 op_sel:[1,1,0] op_sel_hi:[1,1,0]
v_and_b32_e64 v183, s49, v183
v_mfma_f32_32x32x16_bf16 v[120:135], v[84:87], v[232:235], v[120:135]
ds_read_b128 v[228:231], v249 offset:6144
ds_read_u16_d16_hi v181, v181
v_exp_f16_sdwa v147, v148 dst_sel:WORD_1 dst_unused:UNUSED_PRESERVE src0_sel:WORD_1
v_pk_add_f16 v153, v153, 1.0 op_sel_hi:[1,0]
v_bfe_u32 v182, v183, 2, 14
v_pk_add_f16 v150, v150, 1.0 op_sel_hi:[1,0]
v_pk_add_f16 v147, v147, 1.0 op_sel_hi:[1,0]
v_rcp_f16_e64 v154, v153
v_lshrrev_b32 v183, 18, v183
v_fma_mix_f32 v162, v140, v140, v162 op_sel:[0,0,0] op_sel_hi:[1,1,0]
s_waitcnt lgkmcnt(6)
v_mfma_f32_32x32x16_bf16 v[120:135], v[88:91], v[236:239], v[120:135]
ds_read_b128 v[232:235], v249 offset:9216
ds_read_u16_d16 v182, v182
ds_read_u16_d16_hi v183, v183
v_rcp_f16 v151, v150
v_and_b32 v185, s49, v185
v_rcp_f16_e64 v148, v147
v_fma_mix_f32 v162, v141, v141, v162 op_sel:[1,1,0] op_sel_hi:[1,1,0]
v_bfe_u32 v184, v185, 2, 14
v_rcp_f16_sdwa v154, v153 dst_sel:WORD_1 dst_unused:UNUSED_PRESERVE src0_sel:WORD_1
v_mfma_f32_32x32x16_bf16 v[120:135], v[92:95], v[216:219], v[120:135]
ds_read_b128 v[236:239], v249 offset:7168
ds_read_u16_d16 v184, v184
v_rcp_f16_sdwa v151, v150 dst_sel:WORD_1 dst_unused:UNUSED_PRESERVE src0_sel:WORD_1
v_lshrrev_b32_e64 v185, 18, v185
v_rcp_f16_sdwa v148, v147 dst_sel:WORD_1 dst_unused:UNUSED_PRESERVE src0_sel:WORD_1
v_and_b32_e64 v187, s49, v187
v_fma_mix_f32 v162, v142, v142, v162 op_sel:[0,0,0] op_sel_hi:[1,1,0]
v_pk_mul_f16 v155, v155, v154
v_pk_mul_f16 v152, v152, v151
v_smfmac_f32_16x16x32_bf16 v[8:11], v[220:221], v[192:195], v246
ds_read_b128 v[216:219], v249 offset:10240
ds_read_u16_d16_hi v185, v185
v_bfe_u32 v186, v187, 2, 14
v_pk_mul_f16 v149, v149, v148
v_fma_mix_f32 v163, v155, v155, v163 op_sel:[0,0,0] op_sel_hi:[1,1,0]
v_fma_mix_f32 v162, v143, v143, v162 op_sel:[1,1,0] op_sel_hi:[1,1,0]
v_lshrrev_b32_e64 v187, 18, v187
v_smfmac_f32_16x16x32_bf16 v[24:27], v[222:223], v[196:199], v246
v_fma_mix_f32 v163, v155, v155, v163 op_sel:[1,1,0] op_sel_hi:[1,1,0]
v_fma_mix_f32 v163, v152, v152, v163 op_sel:[0,0,0] op_sel_hi:[1,1,0]
v_fma_mix_f32 v163, v152, v152, v163 op_sel:[1,1,0] op_sel_hi:[1,1,0]
v_fma_mix_f32 v163, v149, v149, v163 op_sel:[0,0,0] op_sel_hi:[1,1,0]
v_fma_mix_f32 v163, v149, v149, v163 op_sel:[1,1,0] op_sel_hi:[1,1,0]
v_lshlrev_b32 v252, 7, v251
s_add_u32 s46, s47, 2359296
s_mov_b32 exec_lo, 0
s_mov_b32 exec_hi, 1048572
s_mov_b32 m0, 16152
s_nop 0
buffer_load_dword v252, s[4:7], s46 offen lds
s_mov_b64 exec, -1
s_setprio 1
s_waitcnt lgkmcnt(2)
v_smfmac_f32_16x16x32_bf16 v[40:43], v[224:225], v[200:203], v246
ds_read_b128 v[220:223], v249 offset:8192
ds_read_u16_d16 v186, v186
ds_read_u16_d16_hi v187, v187
v_cvt_pkrtz_f16_f32 v137, v120, v121
v_cvt_pkrtz_f16_f32 v139, v122, v123
v_cvt_pkrtz_f16_f32 v141, v124, v125
v_cvt_pkrtz_f16_f32 v143, v126, v127
v_smfmac_f32_16x16x32_bf16 v[8:11], v[226:227], v[204:207], v246
v_cvt_pk_f16_f32 v155, v128, v129
v_cvt_pk_f16_f32 v152, v130, v131
v_cvt_pk_f16_f32 v149, v132, v133
v_cvt_pk_f16_f32 v146, v134, v135
v_pk_fma_f16 v154, v155, v155, s48
v_mfma_f32_32x32x16_bf16 v[120:135], v[72:75], v[228:231], 0
ds_read_b128 v[224:227], v249 offset:11264
v_and_b32_e64 v137, s49, v137
v_fma_mix_f32 v163, v178, v178, v163 op_sel:[0,0,0] op_sel_hi:[1,1,0]
v_pk_fma_f16 v151, v152, v152, s48
v_pk_fma_f16 v148, v149, v149, s48
v_pk_fma_f16 v145, v146, v146, s48
v_pk_mul_f16 v154, v155, v154
v_bfe_u32 v136, v137, 2, 14
v_pk_mul_f16 v151, v152, v151
v_fma_mix_f32 v163, v179, v179, v163 op_sel:[1,1,0] op_sel_hi:[1,1,0]
v_pk_mul_f16 v148, v149, v148
v_mfma_f32_32x32x16_bf16 v[120:135], v[76:79], v[232:235], v[120:135]
ds_read_b128 v[228:231], v245 offset:6528
ds_read_b128 v[208:211], v244 offset:64
ds_read_b128 v[212:215], v244 offset:128
ds_read_u16_d16 v136, v136
v_pk_mul_f16 v145, v146, v145
v_exp_f16 v153, v154
v_lshrrev_b32 v137, 18, v137
v_exp_f16_e64 v150, v151
v_fma_mix_f32 v163, v180, v180, v163 op_sel:[0,0,0] op_sel_hi:[1,1,0]
v_exp_f16 v147, v148
v_and_b32 v139, s49, v139
v_mfma_f32_32x32x16_bf16 v[120:135], v[80:83], v[236:239], v[120:135]
ds_read_b128 v[232:235], v249 offset:12288
ds_read_u16_d16_hi v137, v137
v_exp_f16_e64 v144, v145
v_exp_f16_sdwa v153, v154 dst_sel:WORD_1 dst_unused:UNUSED_PRESERVE src0_sel:WORD_1
v_fma_mix_f32 v163, v181, v181, v163 op_sel:[1,1,0] op_sel_hi:[1,1,0]
v_bfe_u32 v138, v139, 2, 14
v_exp_f16_sdwa v150, v151 dst_sel:WORD_1 dst_unused:UNUSED_PRESERVE src0_sel:WORD_1
v_exp_f16_sdwa v147, v148 dst_sel:WORD_1 dst_unused:UNUSED_PRESERVE src0_sel:WORD_1
s_waitcnt lgkmcnt(6)
v_mfma_f32_32x32x16_bf16 v[120:135], v[84:87], v[216:219], v[120:135]
ds_read_b128 v[236:239], v249 offset:15360
ds_read_u16_d16 v138, v138
v_exp_f16_sdwa v144, v145 dst_sel:WORD_1 dst_unused:UNUSED_PRESERVE src0_sel:WORD_1
v_lshrrev_b32 v139, 18, v139
v_fma_mix_f32 v163, v182, v182, v163 op_sel:[0,0,0] op_sel_hi:[1,1,0]
v_pk_add_f16 v153, v153, 1.0 op_sel_hi:[1,0]
v_pk_add_f16 v150, v150, 1.0 op_sel_hi:[1,0]
v_pk_add_f16 v147, v147, 1.0 op_sel_hi:[1,0]
v_and_b32_e64 v141, s49, v141
v_pk_add_f16 v144, v144, 1.0 op_sel_hi:[1,0]
v_mfma_f32_32x32x16_bf16 v[120:135], v[88:91], v[220:223], v[120:135]
ds_read_b128 v[216:219], v249 offset:13312
ds_read_u16_d16_hi v139, v139
v_rcp_f16_e64 v154, v153
v_fma_mix_f32 v163, v183, v183, v163 op_sel:[1,1,0] op_sel_hi:[1,1,0]
v_rcp_f16_e64 v151, v150
v_bfe_u32 v140, v141, 2, 14
v_rcp_f16_e64 v148, v147
v_fma_mix_f32 v163, v184, v184, v163 op_sel:[0,0,0] op_sel_hi:[1,1,0]
v_mfma_f32_32x32x16_bf16 v[120:135], v[92:95], v[224:227], v[120:135]
ds_read_b128 v[220:223], v249 offset:16384
ds_read_u16_d16 v140, v140
v_rcp_f16_e64 v145, v144
v_lshrrev_b32 v141, 18, v141
v_rcp_f16_sdwa v154, v153 dst_sel:WORD_1 dst_unused:UNUSED_PRESERVE src0_sel:WORD_1
s_setprio 0
v_rcp_f16_sdwa v151, v150 dst_sel:WORD_1 dst_unused:UNUSED_PRESERVE src0_sel:WORD_1
v_fma_mix_f32 v163, v185, v185, v163 op_sel:[1,1,0] op_sel_hi:[1,1,0]
v_and_b32 v143, s49, v143
v_rcp_f16_sdwa v148, v147 dst_sel:WORD_1 dst_unused:UNUSED_PRESERVE src0_sel:WORD_1
s_waitcnt lgkmcnt(4)
v_smfmac_f32_16x16x32_bf16 v[24:27], v[228:229], v[208:211], v246
ds_read_b128 v[224:227], v249 offset:14336
ds_read_u16_d16_hi v141, v141
v_rcp_f16_sdwa v145, v144 dst_sel:WORD_1 dst_unused:UNUSED_PRESERVE src0_sel:WORD_1
v_pk_mul_f16 v155, v155, v154
v_bfe_u32 v142, v143, 2, 14
v_fma_mix_f32 v163, v186, v186, v163 op_sel:[0,0,0] op_sel_hi:[1,1,0]
v_smfmac_f32_16x16x32_bf16 v[40:43], v[230:231], v[212:215], v246
s_mov_b64 exec, 1
ds_add_u32 v253, v254 offset:16
s_mov_b64 exec, -1
v_pk_mul_f16 v152, v152, v151
v_pk_mul_f16 v149, v149, v148
v_pk_mul_f16 v146, v146, v145
v_fma_mix_f32 v164, v155, v155, v164 op_sel:[0,0,0] op_sel_hi:[1,1,0]
v_lshrrev_b32 v143, 18, v143
v_fma_mix_f32 v164, v155, v155, v164 op_sel:[1,1,0] op_sel_hi:[1,1,0]
v_fma_mix_f32 v164, v152, v152, v164 op_sel:[0,0,0] op_sel_hi:[1,1,0]
v_fma_mix_f32 v163, v187, v187, v163 op_sel:[1,1,0] op_sel_hi:[1,1,0]
v_fma_mix_f32 v164, v152, v152, v164 op_sel:[1,1,0] op_sel_hi:[1,1,0]
v_fma_mix_f32 v164, v149, v149, v164 op_sel:[0,0,0] op_sel_hi:[1,1,0]
v_fma_mix_f32 v164, v149, v149, v164 op_sel:[1,1,0] op_sel_hi:[1,1,0]
v_fma_mix_f32 v164, v146, v146, v164 op_sel:[0,0,0] op_sel_hi:[1,1,0]
v_fma_mix_f32 v164, v146, v146, v164 op_sel:[1,1,0] op_sel_hi:[1,1,0]
s_setprio 3
v_pk_add_f32 v[168:169], v[0:1], v[2:3]
v_pk_mul_f32 v[170:171], v[0:1], v[0:1]
v_pk_fma_f32 v[170:171], v[2:3], v[2:3], v[170:171]
v_pk_add_f32 v[168:169], v[168:169], v[4:5]
v_pk_fma_f32 v[170:171], v[4:5], v[4:5], v[170:171]
v_pk_add_f32 v[168:169], v[168:169], v[6:7]
v_pk_fma_f32 v[170:171], v[6:7], v[6:7], v[170:171]
v_pk_add_f32 v[168:169], v[168:169], v[8:9]
v_pk_fma_f32 v[170:171], v[8:9], v[8:9], v[170:171]
v_pk_add_f32 v[168:169], v[168:169], v[10:11]
v_pk_fma_f32 v[170:171], v[10:11], v[10:11], v[170:171]
v_pk_add_f32 v[168:169], v[168:169], v[12:13]
v_pk_fma_f32 v[170:171], v[12:13], v[12:13], v[170:171]
v_pk_add_f32 v[168:169], v[168:169], v[14:15]
v_pk_fma_f32 v[170:171], v[14:15], v[14:15], v[170:171]
v_pk_add_f32 v[168:169], v[168:169], v[16:17]
v_pk_fma_f32 v[170:171], v[16:17], v[16:17], v[170:171]
v_pk_add_f32 v[168:169], v[168:169], v[18:19]
v_pk_fma_f32 v[170:171], v[18:19], v[18:19], v[170:171]
v_pk_add_f32 v[168:169], v[168:169], v[20:21]
v_pk_fma_f32 v[170:171], v[20:21], v[20:21], v[170:171]
v_pk_add_f32 v[168:169], v[168:169], v[22:23]
v_pk_fma_f32 v[170:171], v[22:23], v[22:23], v[170:171]
v_pk_add_f32 v[168:169], v[168:169], v[24:25]
v_pk_fma_f32 v[170:171], v[24:25], v[24:25], v[170:171]
v_pk_add_f32 v[168:169], v[168:169], v[26:27]
v_pk_fma_f32 v[170:171], v[26:27], v[26:27], v[170:171]
v_pk_add_f32 v[168:169], v[168:169], v[28:29]
v_pk_fma_f32 v[170:171], v[28:29], v[28:29], v[170:171]
v_pk_add_f32 v[168:169], v[168:169], v[30:31]
v_pk_fma_f32 v[170:171], v[30:31], v[30:31], v[170:171]
v_pk_add_f32 v[168:169], v[168:169], v[32:33]
v_pk_fma_f32 v[170:171], v[32:33], v[32:33], v[170:171]
v_pk_add_f32 v[168:169], v[168:169], v[34:35]
v_pk_fma_f32 v[170:171], v[34:35], v[34:35], v[170:171]
v_pk_add_f32 v[168:169], v[168:169], v[36:37]
v_pk_fma_f32 v[170:171], v[36:37], v[36:37], v[170:171]
v_pk_add_f32 v[168:169], v[168:169], v[38:39]
v_pk_fma_f32 v[170:171], v[38:39], v[38:39], v[170:171]
v_pk_add_f32 v[168:169], v[168:169], v[40:41]
v_pk_fma_f32 v[170:171], v[40:41], v[40:41], v[170:171]
v_pk_add_f32 v[168:169], v[168:169], v[42:43]
v_pk_fma_f32 v[170:171], v[42:43], v[42:43], v[170:171]
v_pk_add_f32 v[168:169], v[168:169], v[44:45]
v_pk_fma_f32 v[170:171], v[44:45], v[44:45], v[170:171]
v_pk_add_f32 v[168:169], v[168:169], v[46:47]
v_pk_fma_f32 v[170:171], v[46:47], v[46:47], v[170:171]
s_setprio 0
v_add_u32 v174, -36864, v242
v_subrev_u32 v175, 66560, v174
v_min_u32 v174, v174, v175
v_add_u32 v174, 90112, v174
v_sub_u32 v175, v174, v242
v_add_u32 v242, v175, v242
v_add_u32_e64 v243, v175, v243
v_add_u32 v244, v175, v244
s_setprio 2
v_cvt_pkrtz_f16_f32 v179, v120, v121
v_cvt_pkrtz_f16_f32 v181, v122, v123
v_cvt_pkrtz_f16_f32 v183, v124, v125
v_cvt_pkrtz_f16_f32 v185, v126, v127
v_cvt_pkrtz_f16_f32 v187, v128, v129
v_cvt_pkrtz_f16_f32 v189, v130, v131
v_cvt_pk_f16_f32 v155, v132, v133
v_cvt_pk_f16_f32 v152, v134, v135
ds_read_b128 v[228:231], v249 offset:17408
ds_read_u16_d16 v142, v142
ds_read_u16_d16_hi v143, v143
v_mfma_f32_32x32x16_bf16 v[120:135], v[72:75], v[232:235], 0
v_pk_fma_f16 v154, v155, v155, s48
v_add_f32 v168, v168, v169
v_and_b32 v179, s49, v179
v_fma_mix_f32 v164, v136, v136, v164 op_sel:[0,0,0] op_sel_hi:[1,1,0]
v_bfe_u32 v178, v179, 2, 14
v_add_f32_e64 v170, v170, v171
v_pk_fma_f16 v151, v152, v152, s48
v_pk_mul_f16 v154, v155, v154
v_lshrrev_b32_e64 v179, 18, v179
v_pk_mul_f16 v151, v152, v151
ds_read_b128 v[232:235], v249 offset:18432
ds_read_u16_d16 v178, v178
ds_read_u16_d16_hi v179, v179
v_mfma_f32_32x32x16_bf16 v[120:135], v[76:79], v[236:239], v[120:135]
v_permlane32_swap_b32 v168, v170
v_fma_mix_f32 v164, v137, v137, v164 op_sel:[1,1,0] op_sel_hi:[1,1,0]
v_and_b32 v181, s49, v181
v_exp_f16 v153, v154
v_add_f32 v168, v168, v170
v_bfe_u32 v180, v181, 2, 14
v_exp_f16_e64 v150, v151
v_lshrrev_b32 v181, 18, v181
s_waitcnt lgkmcnt(7)
ds_read_b128 v[236:239], v249 offset:21504
ds_read_u16_d16 v180, v180
ds_read_u16_d16_hi v181, v181
v_mfma_f32_32x32x16_bf16 v[120:135], v[80:83], v[216:219], v[120:135]
v_mul_f32 v168, 1009429163, v168
v_fma_mix_f32 v164, v138, v138, v164 op_sel:[0,0,0] op_sel_hi:[1,1,0]
v_exp_f16_sdwa v153, v154 dst_sel:WORD_1 dst_unused:UNUSED_PRESERVE src0_sel:WORD_1
v_and_b32 v183, s49, v183
v_mov_b32 v170, v168
v_exp_f16_sdwa v150, v151 dst_sel:WORD_1 dst_unused:UNUSED_PRESERVE src0_sel:WORD_1
v_bfe_u32 v182, v183, 2, 14
v_fma_mix_f32 v164, v139, v139, v164 op_sel:[1,1,0] op_sel_hi:[1,1,0]
v_permlane32_swap_b32 v168, v170
ds_read_b128 v[216:219], v249 offset:19456
ds_read_u16_d16 v182, v182
v_mfma_f32_32x32x16_bf16 v[120:135], v[84:87], v[220:223], v[120:135]
v_lshrrev_b32 v183, 18, v183
v_pk_add_f16 v153, v153, 1.0 op_sel_hi:[1,0]
v_pk_add_f16 v150, v150, 1.0 op_sel_hi:[1,0]
v_and_b32_e64 v185, s49, v185
v_fma_f32 v170, -v168, v168, v170
v_rcp_f16_e64 v154, v153
v_bfe_u32 v184, v185, 2, 14
v_max_f32_e64 v170, 0, v170
v_fma_mix_f32 v164, v140, v140, v164 op_sel:[0,0,0] op_sel_hi:[1,1,0]
ds_read_b128 v[220:223], v249 offset:22528
ds_read_u16_d16_hi v183, v183
ds_read_u16_d16 v184, v184
v_mfma_f32_32x32x16_bf16 v[120:135], v[88:91], v[224:227], v[120:135]
v_lshrrev_b32 v185, 18, v185
v_rcp_f16 v151, v150
v_add_f32 v170, 925353388, v170
v_and_b32_e64 v187, s49, v187
v_fma_mix_f32 v164, v141, v141, v164 op_sel:[1,1,0] op_sel_hi:[1,1,0]
v_rcp_f16_sdwa v154, v153 dst_sel:WORD_1 dst_unused:UNUSED_PRESERVE src0_sel:WORD_1
v_rsq_f32 v170, v170
s_waitcnt lgkmcnt(5)
ds_read_b128 v[224:227], v249 offset:20480
ds_read_u16_d16_hi v185, v185
ds_read_b32 v247, v253 offset:16
v_mfma_f32_32x32x16_bf16 v[120:135], v[92:95], v[228:231], v[120:135]
v_bfe_u32 v186, v187, 2, 14
v_rcp_f16_sdwa v151, v150 dst_sel:WORD_1 dst_unused:UNUSED_PRESERVE src0_sel:WORD_1
v_lshrrev_b32_e64 v187, 18, v187
v_fma_mix_f32 v164, v142, v142, v164 op_sel:[0,0,0] op_sel_hi:[1,1,0]
v_and_b32_e64 v189, s49, v189
v_pk_mul_f16 v155, v155, v154
v_pk_mul_f16 v152, v152, v151
v_mul_f32 v172, 3203391086, v170
v_bfe_u32 v188, v189, 2, 14
v_fma_mix_f32 v165, v155, v155, v165 op_sel:[0,0,0] op_sel_hi:[1,1,0]
v_fma_mix_f32 v164, v143, v143, v164 op_sel:[1,1,0] op_sel_hi:[1,1,0]
v_lshrrev_b32_e64 v189, 18, v189
v_mul_f32 v173, v168, v172
v_fma_mix_f32 v165, v155, v155, v165 op_sel:[1,1,0] op_sel_hi:[1,1,0]
v_fma_mix_f32 v165, v152, v152, v165 op_sel:[0,0,0] op_sel_hi:[1,1,0]
v_fma_mix_f32 v165, v152, v152, v165 op_sel:[1,1,0] op_sel_hi:[1,1,0]
s_setprio 3
v_pk_fma_f32 v[0:1], v[0:1], v[172:173], v[172:173] op_sel:[0,0,1] op_sel_hi:[1,0,1] neg_lo:[0,0,1] neg_hi:[0,0,1]
v_pk_fma_f32 v[2:3], v[2:3], v[172:173], v[172:173] op_sel:[0,0,1] op_sel_hi:[1,0,1] neg_lo:[0,0,1] neg_hi:[0,0,1]
v_pk_fma_f32 v[4:5], v[4:5], v[172:173], v[172:173] op_sel:[0,0,1] op_sel_hi:[1,0,1] neg_lo:[0,0,1] neg_hi:[0,0,1]
v_pk_fma_f32 v[6:7], v[6:7], v[172:173], v[172:173] op_sel:[0,0,1] op_sel_hi:[1,0,1] neg_lo:[0,0,1] neg_hi:[0,0,1]
v_pk_fma_f32 v[8:9], v[8:9], v[172:173], v[172:173] op_sel:[0,0,1] op_sel_hi:[1,0,1] neg_lo:[0,0,1] neg_hi:[0,0,1]
v_pk_fma_f32 v[10:11], v[10:11], v[172:173], v[172:173] op_sel:[0,0,1] op_sel_hi:[1,0,1] neg_lo:[0,0,1] neg_hi:[0,0,1]
v_pk_fma_f32 v[12:13], v[12:13], v[172:173], v[172:173] op_sel:[0,0,1] op_sel_hi:[1,0,1] neg_lo:[0,0,1] neg_hi:[0,0,1]
v_pk_fma_f32 v[14:15], v[14:15], v[172:173], v[172:173] op_sel:[0,0,1] op_sel_hi:[1,0,1] neg_lo:[0,0,1] neg_hi:[0,0,1]
v_pk_fma_f32 v[16:17], v[16:17], v[172:173], v[172:173] op_sel:[0,0,1] op_sel_hi:[1,0,1] neg_lo:[0,0,1] neg_hi:[0,0,1]
v_pk_fma_f32 v[18:19], v[18:19], v[172:173], v[172:173] op_sel:[0,0,1] op_sel_hi:[1,0,1] neg_lo:[0,0,1] neg_hi:[0,0,1]
v_pk_fma_f32 v[20:21], v[20:21], v[172:173], v[172:173] op_sel:[0,0,1] op_sel_hi:[1,0,1] neg_lo:[0,0,1] neg_hi:[0,0,1]
v_pk_fma_f32 v[22:23], v[22:23], v[172:173], v[172:173] op_sel:[0,0,1] op_sel_hi:[1,0,1] neg_lo:[0,0,1] neg_hi:[0,0,1]
v_pk_fma_f32 v[24:25], v[24:25], v[172:173], v[172:173] op_sel:[0,0,1] op_sel_hi:[1,0,1] neg_lo:[0,0,1] neg_hi:[0,0,1]
v_pk_fma_f32 v[26:27], v[26:27], v[172:173], v[172:173] op_sel:[0,0,1] op_sel_hi:[1,0,1] neg_lo:[0,0,1] neg_hi:[0,0,1]
v_pk_fma_f32 v[28:29], v[28:29], v[172:173], v[172:173] op_sel:[0,0,1] op_sel_hi:[1,0,1] neg_lo:[0,0,1] neg_hi:[0,0,1]
v_pk_fma_f32 v[30:31], v[30:31], v[172:173], v[172:173] op_sel:[0,0,1] op_sel_hi:[1,0,1] neg_lo:[0,0,1] neg_hi:[0,0,1]
v_pk_fma_f32 v[32:33], v[32:33], v[172:173], v[172:173] op_sel:[0,0,1] op_sel_hi:[1,0,1] neg_lo:[0,0,1] neg_hi:[0,0,1]
v_pk_fma_f32 v[34:35], v[34:35], v[172:173], v[172:173] op_sel:[0,0,1] op_sel_hi:[1,0,1] neg_lo:[0,0,1] neg_hi:[0,0,1]
v_pk_fma_f32 v[36:37], v[36:37], v[172:173], v[172:173] op_sel:[0,0,1] op_sel_hi:[1,0,1] neg_lo:[0,0,1] neg_hi:[0,0,1]
v_pk_fma_f32 v[38:39], v[38:39], v[172:173], v[172:173] op_sel:[0,0,1] op_sel_hi:[1,0,1] neg_lo:[0,0,1] neg_hi:[0,0,1]
v_pk_fma_f32 v[40:41], v[40:41], v[172:173], v[172:173] op_sel:[0,0,1] op_sel_hi:[1,0,1] neg_lo:[0,0,1] neg_hi:[0,0,1]
v_pk_fma_f32 v[42:43], v[42:43], v[172:173], v[172:173] op_sel:[0,0,1] op_sel_hi:[1,0,1] neg_lo:[0,0,1] neg_hi:[0,0,1]
v_pk_fma_f32 v[44:45], v[44:45], v[172:173], v[172:173] op_sel:[0,0,1] op_sel_hi:[1,0,1] neg_lo:[0,0,1] neg_hi:[0,0,1]
v_pk_fma_f32 v[46:47], v[46:47], v[172:173], v[172:173] op_sel:[0,0,1] op_sel_hi:[1,0,1] neg_lo:[0,0,1] neg_hi:[0,0,1]
s_setprio 2
ds_read_u16_d16 v186, v186
ds_read_u16_d16_hi v187, v187
ds_read_u16_d16 v188, v188
ds_read_u16_d16_hi v189, v189
s_waitcnt lgkmcnt(4)
v_readfirstlane_b32 s43, v247
s_nop 1
s_cmp_ge_u32 s43, 24
s_cbranch_scc1 Lev7
Lev7w:
s_sleep 1
ds_read_b32 v247, v253 offset:16
s_waitcnt lgkmcnt(0)
v_readfirstlane_b32 s43, v247
s_cmp_eq_u32 s76, 0
s_cbranch_scc1 Lev7
s_sub_u32 s76, s76, 1
s_cmp_lt_u32 s43, 24
s_cbranch_scc1 Lev7w
Lev7:
s_setprio 1
v_cvt_pkrtz_f16_f32 v137, v120, v121
v_cvt_pkrtz_f16_f32 v139, v122, v123
v_cvt_pkrtz_f16_f32 v141, v124, v125
v_cvt_pkrtz_f16_f32 v143, v126, v127
v_cvt_pkrtz_f16_f32 v177, v128, v129
v_cvt_pkrtz_f16_f32 v191, v130, v131
v_cvt_pk_f16_f32 v155, v132, v133
v_cvt_pk_f16_f32 v152, v134, v135
s_add_u32 m0, s67, 39936
s_add_u32 s66, s66, 98304
buffer_load_dwordx4 v240, s[4:7], s66 offen lds
ds_read_b128 v[228:231], v249 offset:23552
v_mfma_f32_32x32x16_bf16 v[120:135], v[72:75], v[232:235], 0
v_pk_fma_f16 v154, v155, v155, s48
v_cvt_pk_bf16_f32 v96, v0, v1
v_and_b32 v137, s49, v137
v_fma_mix_f32 v165, v178, v178, v165 op_sel:[0,0,0] op_sel_hi:[1,1,0]
v_cvt_pk_bf16_f32 v97, v2, v3
v_pk_fma_f16 v151, v152, v152, s48
v_bfe_u32 v136, v137, 2, 14
v_cvt_pk_bf16_f32 v98, v4, v5
v_pk_mul_f16 v154, v155, v154
v_fma_mix_f32 v165, v179, v179, v165 op_sel:[1,1,0] op_sel_hi:[1,1,0]
v_lshrrev_b32_e64 v137, 18, v137
v_cvt_pk_bf16_f32 v99, v6, v7
s_add_u32 m0, s67, 46592
s_add_u32 s66, s66, 98304
buffer_load_dwordx4 v240, s[4:7], s66 offen lds
ds_read_b128 v[232:235], v248 offset:16384
ds_read_u16_d16 v136, v136
ds_read_u16_d16_hi v137, v137
v_mfma_f32_32x32x16_bf16 v[120:135], v[76:79], v[236:239], v[120:135]
v_pk_mul_f16 v151, v152, v151
v_exp_f16_e64 v153, v154
v_cvt_pk_bf16_f32 v100, v8, v9
v_and_b32_e64 v139, s49, v139
v_fma_mix_f32 v165, v180, v180, v165 op_sel:[0,0,0] op_sel_hi:[1,1,0]
v_cvt_pk_bf16_f32 v101, v10, v11
v_bfe_u32 v138, v139, 2, 14
v_exp_f16_e64 v150, v151
v_cvt_pk_bf16_f32 v102, v12, v13
v_lshrrev_b32_e64 v139, 18, v139
v_cvt_pk_bf16_f32 v103, v14, v15
s_add_u32 m0, s67, 53248
s_add_u32 s66, s66, 98304
buffer_load_dwordx4 v240, s[4:7], s66 offen lds
ds_read_b128 v[236:239], v248 offset:19456
ds_read_u16_d16 v138, v138
ds_read_u16_d16_hi v139, v139
v_mfma_f32_32x32x16_bf16 v[120:135], v[80:83], v[216:219], v[120:135]
v_fma_mix_f32 v165, v181, v181, v165 op_sel:[1,1,0] op_sel_hi:[1,1,0]
v_exp_f16_sdwa v153, v154 dst_sel:WORD_1 dst_unused:UNUSED_PRESERVE src0_sel:WORD_1
v_cvt_pk_bf16_f32 v104, v16, v17
v_and_b32_e64 v141, s49, v141
v_fma_mix_f32 v165, v182, v182, v165 op_sel:[0,0,0] op_sel_hi:[1,1,0]
v_cvt_pk_bf16_f32 v105, v18, v19
v_bfe_u32 v140, v141, 2, 14
v_exp_f16_sdwa v150, v151 dst_sel:WORD_1 dst_unused:UNUSED_PRESERVE src0_sel:WORD_1
v_cvt_pk_bf16_f32 v106, v20, v21
v_lshrrev_b32 v141, 18, v141
s_add_u32 m0, s67, 59904
s_add_u32 s66, s66, 98304
buffer_load_dwordx4 v240, s[4:7], s66 offen lds
s_add_u32 m0, s67, 0
s_add_u32 s66, s66, 98304
buffer_load_dwordx4 v240, s[4:7], s66 offen lds
ds_read_b128 v[216:219], v248 offset:17408
ds_read_u16_d16 v140, v140
ds_read_u16_d16_hi v141, v141
v_mfma_f32_32x32x16_bf16 v[120:135], v[84:87], v[220:223], v[120:135]
v_fma_mix_f32 v165, v183, v183, v165 op_sel:[1,1,0] op_sel_hi:[1,1,0]
v_cvt_pk_bf16_f32 v107, v22, v23
v_pk_add_f16 v153, v153, 1.0 op_sel_hi:[1,0]
v_pk_add_f16 v150, v150, 1.0 op_sel_hi:[1,0]
v_and_b32_e64 v143, s49, v143
v_cvt_pk_bf16_f32 v108, v24, v25
v_rcp_f16_e64 v154, v153
v_cvt_pk_bf16_f32 v109, v26, v27
v_bfe_u32 v142, v143, 2, 14
v_fma_mix_f32 v165, v184, v184, v165 op_sel:[0,0,0] op_sel_hi:[1,1,0]
v_cvt_pk_bf16_f32 v110, v28, v29
s_add_u32 m0, s67, 6656
s_add_u32 s66, s66, 98304
buffer_load_dwordx4 v240, s[4:7], s66 offen lds
ds_read_b128 v[220:223], v248 offset:20480
ds_read_u16_d16 v142, v142
v_mfma_f32_32x32x16_bf16 v[120:135], v[88:91], v[224:227], v[120:135]
v_rcp_f16 v151, v150
v_lshrrev_b32 v143, 18, v143
v_cvt_pk_bf16_f32 v111, v30, v31
v_fma_mix_f32 v165, v185, v185, v165 op_sel:[1,1,0] op_sel_hi:[1,1,0]
v_and_b32_e64 v177, s49, v177
s_setprio 0
v_cvt_pk_bf16_f32 v112, v32, v33
v_rcp_f16_sdwa v154, v153 dst_sel:WORD_1 dst_unused:UNUSED_PRESERVE src0_sel:WORD_1
v_bfe_u32 v176, v177, 2, 14
v_cvt_pk_bf16_f32 v113, v34, v35
s_waitcnt lgkmcnt(2)
v_fma_mix_f32 v165, v186, v186, v165 op_sel:[0,0,0] op_sel_hi:[1,1,0]
v_rcp_f16_sdwa v151, v150 dst_sel:WORD_1 dst_unused:UNUSED_PRESERVE src0_sel:WORD_1
s_add_u32 m0, s67, 13312
s_add_u32 s66, s66, 98304
buffer_load_dwordx4 v240, s[4:7], s66 offen lds
ds_read_b128 v[224:227], v248 offset:18432
ds_read_u16_d16_hi v143, v143
ds_read_u16_d16 v176, v176
v_mfma_f32_32x32x16_bf16 v[120:135], v[92:95], v[228:231], v[120:135]
v_cvt_pk_bf16_f32 v114, v36, v37
v_lshrrev_b32_e64 v177, 18, v177
v_cvt_pk_bf16_f32 v115, v38, v39
v_fma_mix_f32 v165, v187, v187, v165 op_sel:[1,1,0] op_sel_hi:[1,1,0]
v_and_b32_e64 v191, s49, v191
v_pk_mul_f16 v155, v155, v154
v_cvt_pk_bf16_f32 v116, v40, v41
v_pk_mul_f16 v152, v152, v151
v_bfe_u32 v190, v191, 2, 14
v_cvt_pk_bf16_f32 v117, v42, v43
v_fma_mix_f32 v165, v188, v188, v165 op_sel:[0,0,0] op_sel_hi:[1,1,0]
v_fma_mix_f32 v166, v155, v155, v166 op_sel:[0,0,0] op_sel_hi:[1,1,0]
s_add_u32 m0, s67, 19968
s_add_u32 s66, s66, 98304
buffer_load_dwordx4 v240, s[4:7], s66 offen lds
v_lshrrev_b32 v191, 18, v191
v_cvt_pk_bf16_f32 v118, v44, v45
v_fma_mix_f32 v166, v155, v155, v166 op_sel:[1,1,0] op_sel_hi:[1,1,0]
v_fma_mix_f32 v165, v189, v189, v165 op_sel:[1,1,0] op_sel_hi:[1,1,0]
v_cvt_pk_bf16_f32 v119, v46, v47
v_fma_mix_f32 v166, v152, v152, v166 op_sel:[0,0,0] op_sel_hi:[1,1,0]
v_fma_mix_f32 v166, v152, v152, v166 op_sel:[1,1,0] op_sel_hi:[1,1,0]
s_setprio 2
v_cvt_pkrtz_f16_f32 v179, v120, v121
v_cvt_pkrtz_f16_f32 v181, v122, v123
v_cvt_pkrtz_f16_f32 v183, v124, v125
v_cvt_pkrtz_f16_f32 v185, v126, v127
v_cvt_pkrtz_f16_f32 v187, v128, v129
v_cvt_pk_f16_f32 v155, v130, v131
v_cvt_pk_f16_f32 v152, v132, v133
v_cvt_pk_f16_f32 v149, v134, v135
ds_read_b128 v[228:231], v248 offset:21504
ds_read_u16_d16_hi v177, v177
ds_read_u16_d16 v190, v190
ds_read_u16_d16_hi v191, v191
v_mfma_f32_32x32x16_bf16 v[120:135], v[96:99], v[232:235], 0
v_pk_fma_f16 v154, v155, v155, s48
v_and_b32_e64 v179, s49, v179
v_fma_mix_f32 v166, v136, v136, v166 op_sel:[0,0,0] op_sel_hi:[1,1,0]
v_pk_fma_f16 v151, v152, v152, s48
v_pk_fma_f16 v148, v149, v149, s48
v_bfe_u32 v178, v179, 2, 14
v_pk_mul_f16 v154, v155, v154
v_fma_mix_f32 v166, v137, v137, v166 op_sel:[1,1,0] op_sel_hi:[1,1,0]
v_pk_mul_f16 v151, v152, v151
v_lshrrev_b32_e64 v179, 18, v179
ds_read_b128 v[232:235], v248 offset:22528
ds_read_u16_d16 v178, v178
ds_read_u16_d16_hi v179, v179
v_mfma_f32_32x32x16_bf16 v[120:135], v[100:103], v[236:239], v[120:135]
v_pk_mul_f16 v148, v149, v148
v_exp_f16_e64 v153, v154
v_fma_mix_f32 v166, v138, v138, v166 op_sel:[0,0,0] op_sel_hi:[1,1,0]
v_and_b32 v181, s49, v181
v_exp_f16 v150, v151
v_exp_f16_e64 v147, v148
v_bfe_u32 v180, v181, 2, 14
v_fma_mix_f32 v166, v139, v139, v166 op_sel:[1,1,0] op_sel_hi:[1,1,0]
ds_read_b128 v[236:239], v248 offset:25600
ds_read_u16_d16 v180, v180
v_mfma_f32_32x32x16_bf16 v[120:135], v[104:107], v[216:219], v[120:135]
v_exp_f16_sdwa v153, v154 dst_sel:WORD_1 dst_unused:UNUSED_PRESERVE src0_sel:WORD_1
v_lshrrev_b32_e64 v181, 18, v181
v_exp_f16_sdwa v150, v151 dst_sel:WORD_1 dst_unused:UNUSED_PRESERVE src0_sel:WORD_1
v_fma_mix_f32 v166, v140, v140, v166 op_sel:[0,0,0] op_sel_hi:[1,1,0]
v_and_b32 v183, s49, v183
v_exp_f16_sdwa v147, v148 dst_sel:WORD_1 dst_unused:UNUSED_PRESERVE src0_sel:WORD_1
v_fma_mix_f32 v166, v141, v141, v166 op_sel:[1,1,0] op_sel_hi:[1,1,0]
s_waitcnt lgkmcnt(5)
ds_read_b128 v[216:219], v248 offset:23552
ds_read_u16_d16_hi v181, v181
v_mfma_f32_32x32x16_bf16 v[120:135], v[108:111], v[220:223], v[120:135]
v_pk_add_f16 v153, v153, 1.0 op_sel_hi:[1,0]
v_bfe_u32 v182, v183, 2, 14
v_pk_add_f16 v150, v150, 1.0 op_sel_hi:[1,0]
v_pk_add_f16 v147, v147, 1.0 op_sel_hi:[1,0]
v_rcp_f16 v154, v153
v_lshrrev_b32 v183, 18, v183
v_fma_mix_f32 v166, v142, v142, v166 op_sel:[0,0,0] op_sel_hi:[1,1,0]
v_rcp_f16 v151, v150
v_and_b32 v185, s49, v185
ds_read_b128 v[220:223], v248 offset:26624
ds_read_u16_d16 v182, v182
ds_read_u16_d16_hi v183, v183
v_mfma_f32_32x32x16_bf16 v[120:135], v[112:115], v[224:227], v[120:135]
v_fma_mix_f32 v166, v143, v143, v166 op_sel:[1,1,0] op_sel_hi:[1,1,0]
v_rcp_f16_e64 v148, v147
v_bfe_u32 v184, v185, 2, 14
v_rcp_f16_sdwa v154, v153 dst_sel:WORD_1 dst_unused:UNUSED_PRESERVE src0_sel:WORD_1
v_fma_mix_f32 v166, v176, v176, v166 op_sel:[0,0,0] op_sel_hi:[1,1,0]
v_rcp_f16_sdwa v151, v150 dst_sel:WORD_1 dst_unused:UNUSED_PRESERVE src0_sel:WORD_1
v_lshrrev_b32_e64 v185, 18, v185
ds_read_b128 v[224:227], v248 offset:24576
ds_read_u16_d16 v184, v184
ds_read_u16_d16_hi v185, v185
v_mfma_f32_32x32x16_bf16 v[120:135], v[116:119], v[228:231], v[120:135]
v_rcp_f16_sdwa v148, v147 dst_sel:WORD_1 dst_unused:UNUSED_PRESERVE src0_sel:WORD_1
s_cmp_eq_u32 s40, 7
s_cbranch_scc1 Lrdy24
s_waitcnt vmcnt(0)
Lrdy24:
s_mov_b64 exec, 1
ds_add_u32 v253, v254 offset:12
s_mov_b64 exec, -1
v_and_b32 v187, s49, v187
v_fma_mix_f32 v166, v177, v177, v166 op_sel:[1,1,0] op_sel_hi:[1,1,0]
v_pk_mul_f16 v155, v155, v154
v_pk_mul_f16 v152, v152, v151
v_pk_mul_f16 v149, v149, v148
v_bfe_u32 v186, v187, 2, 14
v_fma_mix_f32 v166, v190, v190, v166 op_sel:[0,0,0] op_sel_hi:[1,1,0]
v_fma_mix_f32 v167, v155, v155, v167 op_sel:[0,0,0] op_sel_hi:[1,1,0]
v_fma_mix_f32 v167, v155, v155, v167 op_sel:[1,1,0] op_sel_hi:[1,1,0]
v_lshrrev_b32_e64 v187, 18, v187
v_fma_mix_f32 v167, v152, v152, v167 op_sel:[0,0,0] op_sel_hi:[1,1,0]
v_fma_mix_f32 v166, v191, v191, v166 op_sel:[1,1,0] op_sel_hi:[1,1,0]
v_fma_mix_f32 v167, v152, v152, v167 op_sel:[1,1,0] op_sel_hi:[1,1,0]
v_fma_mix_f32 v167, v149, v149, v167 op_sel:[0,0,0] op_sel_hi:[1,1,0]
v_fma_mix_f32 v167, v149, v149, v167 op_sel:[1,1,0] op_sel_hi:[1,1,0]
s_cmp_lg_u32 s40, 7
s_cbranch_scc1 Lnoinit
s_waitcnt vmcnt(13)
v_mov_b32_e64 v255, 1
s_mov_b64 exec, 1
buffer_atomic_add v255, v241, s[36:39], 0 offen
s_mov_b64 exec, -1
Lnoinit:
s_setprio 1
v_cvt_pkrtz_f16_f32 v137, v120, v121
v_cvt_pkrtz_f16_f32 v139, v122, v123
v_cvt_pkrtz_f16_f32 v141, v124, v125
v_cvt_pkrtz_f16_f32 v143, v126, v127
v_cvt_pkrtz_f16_f32 v177, v128, v129
v_cvt_pk_f16_f32 v155, v130, v131
v_cvt_pk_f16_f32 v152, v132, v133
v_cvt_pk_f16_f32 v149, v134, v135
s_waitcnt lgkmcnt(1)
s_add_u32 s46, s80, 12582912
buffer_store_dwordx4 v[72:75], v241, s[32:35], s46 offen sc1
ds_read_b128 v[228:231], v248 offset:27648
ds_read_u16_d16 v186, v186
ds_read_u16_d16_hi v187, v187
v_mfma_f32_32x32x16_bf16 v[120:135], v[96:99], v[232:235], 0
v_pk_fma_f16 v154, v155, v155, s48
v_and_b32 v137, s49, v137
v_fma_mix_f32 v167, v178, v178, v167 op_sel:[0,0,0] op_sel_hi:[1,1,0]
v_pk_fma_f16 v151, v152, v152, s48
v_pk_fma_f16 v148, v149, v149, s48
v_bfe_u32 v136, v137, 2, 14
v_pk_mul_f16 v154, v155, v154
v_pk_mul_f16 v151, v152, v151
v_fma_mix_f32 v167, v179, v179, v167 op_sel:[1,1,0] op_sel_hi:[1,1,0]
v_lshrrev_b32_e64 v137, 18, v137
ds_read_b128 v[232:235], v250 offset:65520
ds_read_u16_d16 v136, v136
ds_read_u16_d16_hi v137, v137
v_mfma_f32_32x32x16_bf16 v[120:135], v[100:103], v[236:239], v[120:135]
v_pk_mul_f16 v148, v149, v148
v_exp_f16 v153, v154
v_exp_f16 v150, v151
v_and_b32_e64 v139, s49, v139
v_fma_mix_f32 v167, v180, v180, v167 op_sel:[0,0,0] op_sel_hi:[1,1,0]
v_exp_f16_e64 v147, v148
v_bfe_u32 v138, v139, 2, 14
ds_read_b128 v[236:239], v248 offset:28672
ds_read_b32 v247, v253 offset:12
ds_read_u16_d16 v138, v138
v_mfma_f32_32x32x16_bf16 v[120:135], v[104:107], v[216:219], v[120:135]
v_exp_f16_sdwa v153, v154 dst_sel:WORD_1 dst_unused:UNUSED_PRESERVE src0_sel:WORD_1
v_lshrrev_b32_e64 v139, 18, v139
v_fma_mix_f32 v167, v181, v181, v167 op_sel:[1,1,0] op_sel_hi:[1,1,0]
v_exp_f16_sdwa v150, v151 dst_sel:WORD_1 dst_unused:UNUSED_PRESERVE src0_sel:WORD_1
v_exp_f16_sdwa v147, v148 dst_sel:WORD_1 dst_unused:UNUSED_PRESERVE src0_sel:WORD_1
v_and_b32_e64 v141, s49, v141
v_fma_mix_f32 v167, v182, v182, v167 op_sel:[0,0,0] op_sel_hi:[1,1,0]
ds_read_b128 v[216:219], v248 offset:31744
ds_read_u16_d16_hi v139, v139
v_mfma_f32_32x32x16_bf16 v[120:135], v[108:111], v[220:223], v[120:135]
v_pk_add_f16 v153, v153, 1.0 op_sel_hi:[1,0]
v_bfe_u32 v140, v141, 2, 14
v_pk_add_f16 v150, v150, 1.0 op_sel_hi:[1,0]
v_pk_add_f16 v147, v147, 1.0 op_sel_hi:[1,0]
v_rcp_f16 v154, v153
v_lshrrev_b32 v141, 18, v141
v_fma_mix_f32 v167, v183, v183, v167 op_sel:[1,1,0] op_sel_hi:[1,1,0]
ds_read_u16_d16 v140, v140
ds_read_u16_d16_hi v141, v141
s_waitcnt lgkmcnt(5)
v_readfirstlane_b32 s43, v247
s_nop 1
s_cmp_ge_u32 s43, 32
s_cbranch_scc1 Lev8
Lev8w:
s_sleep 1
ds_read_b32 v247, v253 offset:12
s_waitcnt lgkmcnt(0)
v_readfirstlane_b32 s43, v247
s_cmp_eq_u32 s76, 0
s_cbranch_scc1 Lev8
s_sub_u32 s76, s76, 1
s_cmp_lt_u32 s43, 32
s_cbranch_scc1 Lev8w
Lev8:
v_rcp_f16 v151, v150
ds_read_b128 v[220:223], v248 offset:29696
v_mfma_f32_32x32x16_bf16 v[120:135], v[112:115], v[224:227], v[120:135]
v_and_b32 v143, s49, v143
v_rcp_f16 v148, v147
v_fma_mix_f32 v167, v184, v184, v167 op_sel:[0,0,0] op_sel_hi:[1,1,0]
v_bfe_u32 v142, v143, 2, 14
s_setprio 0
v_rcp_f16_sdwa v154, v153 dst_sel:WORD_1 dst_unused:UNUSED_PRESERVE src0_sel:WORD_1
v_rcp_f16_sdwa v151, v150 dst_sel:WORD_1 dst_unused:UNUSED_PRESERVE src0_sel:WORD_1
v_lshrrev_b32 v143, 18, v143
ds_read_b128 v[224:227], v245 offset:6528
ds_read_b128 v[192:195], v244 offset:128
ds_read_b128 v[196:199], v244 offset:64
ds_read_u16_d16 v142, v142
ds_read_u16_d16_hi v143, v143
v_mfma_f32_32x32x16_bf16 v[120:135], v[116:119], v[228:231], v[120:135]
v_fma_mix_f32 v167, v185, v185, v167 op_sel:[1,1,0] op_sel_hi:[1,1,0]
v_rcp_f16_sdwa v148, v147 dst_sel:WORD_1 dst_unused:UNUSED_PRESERVE src0_sel:WORD_1
v_and_b32_e64 v177, s49, v177
v_pk_mul_f16 v155, v155, v154
v_fma_mix_f32 v167, v186, v186, v167 op_sel:[0,0,0] op_sel_hi:[1,1,0]
v_pk_mul_f16 v152, v152, v151
v_bfe_u32 v176, v177, 2, 14
v_pk_mul_f16 v149, v149, v148
v_fma_mix_f32 v156, v155, v155, v156 op_sel:[0,0,0] op_sel_hi:[1,1,0]
v_fma_mix_f32 v156, v155, v155, v156 op_sel:[1,1,0] op_sel_hi:[1,1,0]
v_lshrrev_b32 v177, 18, v177
v_fma_mix_f32 v167, v187, v187, v167 op_sel:[1,1,0] op_sel_hi:[1,1,0]
v_fma_mix_f32 v156, v152, v152, v156 op_sel:[0,0,0] op_sel_hi:[1,1,0]
v_fma_mix_f32 v156, v152, v152, v156 op_sel:[1,1,0] op_sel_hi:[1,1,0]
v_fma_mix_f32 v156, v149, v149, v156 op_sel:[0,0,0] op_sel_hi:[1,1,0]
v_fma_mix_f32 v156, v149, v149, v156 op_sel:[1,1,0] op_sel_hi:[1,1,0]
s_setprio 2
v_mfma_f32_32x32x16_bf16 v[0:15], v[232:235], v[232:235], 0
s_add_u32 s46, s80, 14680064
buffer_store_dwordx4 v[76:79], v241, s[32:35], s46 offen sc1
ds_read_b128 v[228:231], v248 offset:32768
ds_read_u16_d16 v176, v176
ds_read_u16_d16_hi v177, v177
v_cvt_pkrtz_f16_f32 v179, v120, v121
v_cvt_pkrtz_f16_f32 v181, v122, v123
v_cvt_pkrtz_f16_f32 v183, v124, v125
v_mfma_f32_32x32x16_bf16 v[16:31], v[232:235], v[232:235], 0
v_cvt_pkrtz_f16_f32 v185, v126, v127
v_cvt_pkrtz_f16_f32 v187, v128, v129
v_cvt_pk_f16_f32 v155, v130, v131
v_cvt_pk_f16_f32 v152, v132, v133
v_mfma_f32_32x32x16_bf16 v[32:47], v[232:235], v[232:235], 0
v_cvt_pk_f16_f32 v149, v134, v135
v_pk_fma_f16 v154, v155, v155, s48
v_and_b32_e64 v179, s49, v179
v_mfma_f32_32x32x16_bf16 v[120:135], v[96:99], v[236:239], 0
ds_read_b128 v[232:235], v248 offset:30720
v_fma_mix_f32 v156, v136, v136, v156 op_sel:[0,0,0] op_sel_hi:[1,1,0]
v_pk_fma_f16 v151, v152, v152, s48
v_pk_fma_f16 v148, v149, v149, s48
v_bfe_u32 v178, v179, 2, 14
v_pk_mul_f16 v154, v155, v154
v_pk_mul_f16 v151, v152, v151
v_fma_mix_f32 v156, v137, v137, v156 op_sel:[1,1,0] op_sel_hi:[1,1,0]
s_waitcnt lgkmcnt(4)
v_mfma_f32_32x32x16_bf16 v[120:135], v[100:103], v[216:219], v[120:135]
ds_read_b128 v[236:239], v245 offset:6144
ds_read_b128 v[200:203], v244
ds_read_b128 v[204:207], v243 offset:128
ds_read_u16_d16 v178, v178
v_lshrrev_b32 v179, 18, v179
v_pk_mul_f16 v148, v149, v148
v_exp_f16 v153, v154
v_exp_f16 v150, v151
v_and_b32_e64 v181, s49, v181
v_fma_mix_f32 v156, v138, v138, v156 op_sel:[0,0,0] op_sel_hi:[1,1,0]
v_mfma_f32_32x32x16_bf16 v[120:135], v[104:107], v[220:223], v[120:135]
ds_read_b128 v[216:219], v248 offset:33792
ds_read_u16_d16_hi v179, v179
v_exp_f16_e64 v147, v148
v_bfe_u32 v180, v181, 2, 14
v_exp_f16_sdwa v153, v154 dst_sel:WORD_1 dst_unused:UNUSED_PRESERVE src0_sel:WORD_1
v_lshrrev_b32_e64 v181, 18, v181
v_fma_mix_f32 v156, v139, v139, v156 op_sel:[1,1,0] op_sel_hi:[1,1,0]
v_smfmac_f32_16x16x32_bf16 v[40:43], v[226:227], v[192:195], v246
ds_read_b128 v[220:223], v245 offset:5760
ds_read_b128 v[208:211], v243 offset:64
ds_read_b128 v[212:215], v243
ds_read_u16_d16 v180, v180
ds_read_u16_d16_hi v181, v181
v_exp_f16_sdwa v150, v151 dst_sel:WORD_1 dst_unused:UNUSED_PRESERVE src0_sel:WORD_1
v_smfmac_f32_16x16x32_bf16 v[24:27], v[224:225], v[196:199], v246
v_exp_f16_sdwa v147, v148 dst_sel:WORD_1 dst_unused:UNUSED_PRESERVE src0_sel:WORD_1
v_and_b32 v183, s49, v183
v_fma_mix_f32 v156, v140, v140, v156 op_sel:[0,0,0] op_sel_hi:[1,1,0]
v_pk_add_f16 v153, v153, 1.0 op_sel_hi:[1,0]
s_waitcnt lgkmcnt(7)
v_mfma_f32_32x32x16_bf16 v[120:135], v[108:111], v[228:231], v[120:135]
ds_read_b128 v[224:227], v245 offset:5376
ds_read_b128 v[192:195], v242 offset:128
ds_read_b128 v[196:199], v242 offset:64
v_bfe_u32 v182, v183, 2, 14
v_pk_add_f16 v150, v150, 1.0 op_sel_hi:[1,0]
v_pk_add_f16 v147, v147, 1.0 op_sel_hi:[1,0]
v_rcp_f16 v154, v153
v_lshrrev_b32 v183, 18, v183
v_fma_mix_f32 v156, v141, v141, v156 op_sel:[1,1,0] op_sel_hi:[1,1,0]
v_mfma_f32_32x32x16_bf16 v[120:135], v[112:115], v[232:235], v[120:135]
ds_read_b128 v[228:231], v248 offset:34816
ds_read_u16_d16 v182, v182
ds_read_u16_d16_hi v183, v183
v_rcp_f16 v151, v150
v_and_b32 v185, s49, v185
v_rcp_f16_e64 v148, v147
v_fma_mix_f32 v156, v142, v142, v156 op_sel:[0,0,0] op_sel_hi:[1,1,0]
v_bfe_u32 v184, v185, 2, 14
v_smfmac_f32_16x16x32_bf16 v[8:11], v[238:239], v[200:203], v246
ds_read_b128 v[232:235], v248 offset:37888
ds_read_u16_d16 v184, v184
v_rcp_f16_sdwa v154, v153 dst_sel:WORD_1 dst_unused:UNUSED_PRESERVE src0_sel:WORD_1
v_rcp_f16_sdwa v151, v150 dst_sel:WORD_1 dst_unused:UNUSED_PRESERVE src0_sel:WORD_1
v_smfmac_f32_16x16x32_bf16 v[40:43], v[236:237], v[204:207], v246
v_lshrrev_b32 v185, 18, v185
v_fma_mix_f32 v156, v143, v143, v156 op_sel:[1,1,0] op_sel_hi:[1,1,0]
s_waitcnt lgkmcnt(6)
v_mfma_f32_32x32x16_bf16 v[120:135], v[116:119], v[216:219], v[120:135]
ds_read_b128 v[236:239], v248 offset:35840
ds_read_u16_d16_hi v185, v185
v_rcp_f16_sdwa v148, v147 dst_sel:WORD_1 dst_unused:UNUSED_PRESERVE src0_sel:WORD_1
v_and_b32_e64 v187, s49, v187
v_pk_mul_f16 v155, v155, v154
v_fma_mix_f32 v156, v176, v176, v156 op_sel:[0,0,0] op_sel_hi:[1,1,0]
v_pk_mul_f16 v152, v152, v151
v_bfe_u32 v186, v187, 2, 14
v_pk_mul_f16 v149, v149, v148
v_smfmac_f32_16x16x32_bf16 v[24:27], v[222:223], v[208:211], v246
ds_read_b128 v[216:219], v248 offset:38912
ds_read_u16_d16 v186, v186
v_fma_mix_f32 v157, v155, v155, v157 op_sel:[0,0,0] op_sel_hi:[1,1,0]
v_fma_mix_f32 v157, v155, v155, v157 op_sel:[1,1,0] op_sel_hi:[1,1,0]
v_lshrrev_b32_e64 v187, 18, v187
v_fma_mix_f32 v156, v177, v177, v156 op_sel:[1,1,0] op_sel_hi:[1,1,0]
v_smfmac_f32_16x16x32_bf16 v[8:11], v[220:221], v[212:215], v246
v_fma_mix_f32 v157, v152, v152, v157 op_sel:[0,0,0] op_sel_hi:[1,1,0]
v_fma_mix_f32 v157, v152, v152, v157 op_sel:[1,1,0] op_sel_hi:[1,1,0]
v_fma_mix_f32 v157, v149, v149, v157 op_sel:[0,0,0] op_sel_hi:[1,1,0]
v_fma_mix_f32 v157, v149, v149, v157 op_sel:[1,1,0] op_sel_hi:[1,1,0]
s_setprio 1
v_smfmac_f32_16x16x32_bf16 v[40:43], v[226:227], v[192:195], v246
s_waitcnt lgkmcnt(4)
s_add_u32 s46, s80, 16777216
buffer_store_dwordx4 v[80:83], v241, s[32:35], s46 offen sc1
ds_read_b128 v[220:223], v248 offset:36864
ds_read_u16_d16_hi v187, v187
v_cvt_pkrtz_f16_f32 v137, v120, v121
v_cvt_pkrtz_f16_f32 v139, v122, v123
v_cvt_pkrtz_f16_f32 v141, v124, v125
v_cvt_pkrtz_f16_f32 v143, v126, v127
v_cvt_pk_f16_f32 v155, v128, v129
v_smfmac_f32_16x16x32_bf16 v[24:27], v[224:225], v[196:199], v246
v_cvt_pk_f16_f32 v152, v130, v131
v_cvt_pk_f16_f32 v149, v132, v133
v_cvt_pk_f16_f32 v146, v134, v135
v_pk_fma_f16 v154, v155, v155, s48
v_and_b32_e64 v137, s49, v137
v_mfma_f32_32x32x16_bf16 v[120:135], v[96:99], v[228:231], 0
ds_read_b128 v[224:227], v248 offset:39936
v_fma_mix_f32 v157, v178, v178, v157 op_sel:[0,0,0] op_sel_hi:[1,1,0]
v_pk_fma_f16 v151, v152, v152, s48
v_pk_fma_f16 v148, v149, v149, s48
v_pk_fma_f16 v145, v146, v146, s48
v_pk_mul_f16 v154, v155, v154
v_bfe_u32 v136, v137, 2, 14
v_pk_mul_f16 v151, v152, v151
v_fma_mix_f32 v157, v179, v179, v157 op_sel:[1,1,0] op_sel_hi:[1,1,0]
v_pk_mul_f16 v148, v149, v148
v_pk_mul_f16 v145, v146, v145
v_mfma_f32_32x32x16_bf16 v[120:135], v[100:103], v[232:235], v[120:135]
ds_read_b128 v[228:231], v245 offset:4992
ds_read_b128 v[200:203], v242
v_xor_b32 v244, 16, v244
ds_read_b128 v[204:207], v244 offset:128
ds_read_u16_d16 v136, v136
v_exp_f16 v153, v154
v_lshrrev_b32 v137, 18, v137
v_exp_f16 v150, v151
v_fma_mix_f32 v157, v180, v180, v157 op_sel:[0,0,0] op_sel_hi:[1,1,0]
v_exp_f16 v147, v148
v_and_b32 v139, s49, v139
v_exp_f16 v144, v145
s_waitcnt lgkmcnt(5)
v_mfma_f32_32x32x16_bf16 v[120:135], v[104:107], v[236:239], v[120:135]
ds_read_b128 v[232:235], v245 offset:4608
ds_read_b128 v[208:211], v244 offset:64
ds_read_b128 v[212:215], v244
ds_read_u16_d16_hi v137, v137
v_exp_f16_sdwa v153, v154 dst_sel:WORD_1 dst_unused:UNUSED_PRESERVE src0_sel:WORD_1
v_fma_mix_f32 v157, v181, v181, v157 op_sel:[1,1,0] op_sel_hi:[1,1,0]
v_bfe_u32 v138, v139, 2, 14
v_exp_f16_sdwa v150, v151 dst_sel:WORD_1 dst_unused:UNUSED_PRESERVE src0_sel:WORD_1
v_exp_f16_sdwa v147, v148 dst_sel:WORD_1 dst_unused:UNUSED_PRESERVE src0_sel:WORD_1
v_exp_f16_sdwa v144, v145 dst_sel:WORD_1 dst_unused:UNUSED_PRESERVE src0_sel:WORD_1
v_lshrrev_b32_e64 v139, 18, v139
v_fma_mix_f32 v157, v182, v182, v157 op_sel:[0,0,0] op_sel_hi:[1,1,0]
v_mfma_f32_32x32x16_bf16 v[120:135], v[108:111], v[216:219], v[120:135]
ds_read_b128 v[236:239], v248 offset:40960
ds_read_u16_d16 v138, v138
ds_read_u16_d16_hi v139, v139
v_pk_add_f16 v153, v153, 1.0 op_sel_hi:[1,0]
v_pk_add_f16 v150, v150, 1.0 op_sel_hi:[1,0]
v_pk_add_f16 v147, v147, 1.0 op_sel_hi:[1,0]
v_and_b32_e64 v141, s49, v141
v_pk_add_f16 v144, v144, 1.0 op_sel_hi:[1,0]
v_rcp_f16_e64 v154, v153
v_fma_mix_f32 v157, v183, v183, v157 op_sel:[1,1,0] op_sel_hi:[1,1,0]
v_rcp_f16_e64 v151, v150
v_mfma_f32_32x32x16_bf16 v[120:135], v[112:115], v[220:223], v[120:135]
ds_read_b128 v[216:219], v248 offset:44032
v_bfe_u32 v140, v141, 2, 14
v_rcp_f16_e64 v148, v147
v_fma_mix_f32 v157, v184, v184, v157 op_sel:[0,0,0] op_sel_hi:[1,1,0]
v_rcp_f16 v145, v144
v_lshrrev_b32 v141, 18, v141
v_rcp_f16_sdwa v154, v153 dst_sel:WORD_1 dst_unused:UNUSED_PRESERVE src0_sel:WORD_1
s_setprio 0
v_rcp_f16_sdwa v151, v150 dst_sel:WORD_1 dst_unused:UNUSED_PRESERVE src0_sel:WORD_1
s_waitcnt lgkmcnt(4)
v_mfma_f32_32x32x16_bf16 v[120:135], v[116:119], v[224:227], v[120:135]
ds_read_b128 v[220:223], v248 offset:41984
ds_read_u16_d16 v140, v140
ds_read_u16_d16_hi v141, v141
v_fma_mix_f32 v157, v185, v185, v157 op_sel:[1,1,0] op_sel_hi:[1,1,0]
v_and_b32_e64 v143, s49, v143
v_rcp_f16_sdwa v148, v147 dst_sel:WORD_1 dst_unused:UNUSED_PRESERVE src0_sel:WORD_1
v_rcp_f16_sdwa v145, v144 dst_sel:WORD_1 dst_unused:UNUSED_PRESERVE src0_sel:WORD_1
v_pk_mul_f16 v155, v155, v154
v_bfe_u32 v142, v143, 2, 14
v_fma_mix_f32 v157, v186, v186, v157 op_sel:[0,0,0] op_sel_hi:[1,1,0]
v_pk_mul_f16 v152, v152, v151
v_pk_mul_f16 v149, v149, v148
v_smfmac_f32_16x16x32_bf16 v[8:11], v[230:231], v[200:203], v246
ds_read_b128 v[224:227], v248 offset:45056
ds_read_u16_d16 v142, v142
v_pk_mul_f16 v146, v146, v145
v_fma_mix_f32 v158, v155, v155, v158 op_sel:[0,0,0] op_sel_hi:[1,1,0]
v_lshrrev_b32 v143, 18, v143
v_fma_mix_f32 v158, v155, v155, v158 op_sel:[1,1,0] op_sel_hi:[1,1,0]
v_fma_mix_f32 v158, v152, v152, v158 op_sel:[0,0,0] op_sel_hi:[1,1,0]
v_smfmac_f32_16x16x32_bf16 v[44:47], v[228:229], v[204:207], v246
v_fma_mix_f32 v157, v187, v187, v157 op_sel:[1,1,0] op_sel_hi:[1,1,0]
v_fma_mix_f32 v158, v152, v152, v158 op_sel:[1,1,0] op_sel_hi:[1,1,0]
v_fma_mix_f32 v158, v149, v149, v158 op_sel:[0,0,0] op_sel_hi:[1,1,0]
v_fma_mix_f32 v158, v149, v149, v158 op_sel:[1,1,0] op_sel_hi:[1,1,0]
v_fma_mix_f32 v158, v146, v146, v158 op_sel:[0,0,0] op_sel_hi:[1,1,0]
v_fma_mix_f32 v158, v146, v146, v158 op_sel:[1,1,0] op_sel_hi:[1,1,0]
s_setprio 2
v_smfmac_f32_16x16x32_bf16 v[28:31], v[234:235], v[208:211], v246
s_add_u32 s46, s80, 18874368
buffer_store_dwordx4 v[84:87], v241, s[32:35], s46 offen sc1
ds_read_b128 v[228:231], v248 offset:43008
ds_read_u16_d16_hi v143, v143
v_cvt_pkrtz_f16_f32 v179, v120, v121
v_cvt_pkrtz_f16_f32 v181, v122, v123
v_cvt_pkrtz_f16_f32 v183, v124, v125
v_cvt_pkrtz_f16_f32 v185, v126, v127
v_smfmac_f32_16x16x32_bf16 v[12:15], v[232:233], v[212:215], v246
v_cvt_pkrtz_f16_f32 v187, v128, v129
v_cvt_pk_f16_f32 v155, v130, v131
v_cvt_pk_f16_f32 v152, v132, v133
v_cvt_pk_f16_f32 v149, v134, v135
v_pk_fma_f16 v154, v155, v155, s48
s_waitcnt lgkmcnt(2)
v_mfma_f32_32x32x16_bf16 v[120:135], v[96:99], v[236:239], 0
ds_read_b128 v[232:235], v248 offset:46080
v_and_b32 v179, s49, v179
v_fma_mix_f32 v158, v136, v136, v158 op_sel:[0,0,0] op_sel_hi:[1,1,0]
v_pk_fma_f16 v151, v152, v152, s48
v_pk_fma_f16 v148, v149, v149, s48
v_bfe_u32 v178, v179, 2, 14
v_pk_mul_f16 v154, v155, v154
v_pk_mul_f16 v151, v152, v151
v_pk_mul_f16 v148, v149, v148
v_lshrrev_b32 v179, 18, v179
v_mfma_f32_32x32x16_bf16 v[120:135], v[100:103], v[216:219], v[120:135]
ds_read_b128 v[236:239], v245 offset:4224
v_xor_b32 v243, 16, v243
ds_read_b128 v[192:195], v243 offset:128
ds_read_b128 v[196:199], v243 offset:64
ds_read_u16_d16 v178, v178
ds_read_u16_d16_hi v179, v179
v_fma_mix_f32 v158, v137, v137, v158 op_sel:[1,1,0] op_sel_hi:[1,1,0]
v_exp_f16 v153, v154
v_and_b32 v181, s49, v181
v_exp_f16 v150, v151
v_exp_f16 v147, v148
v_bfe_u32 v180, v181, 2, 14
v_mfma_f32_32x32x16_bf16 v[120:135], v[104:107], v[220:223], v[120:135]
ds_read_b128 v[216:219], v245 offset:3840
ds_read_b128 v[200:203], v243
v_xor_b32 v242, 16, v242
ds_read_b128 v[204:207], v242 offset:128
ds_read_u16_d16 v180, v180
v_fma_mix_f32 v158, v138, v138, v158 op_sel:[0,0,0] op_sel_hi:[1,1,0]
v_exp_f16_sdwa v153, v154 dst_sel:WORD_1 dst_unused:UNUSED_PRESERVE src0_sel:WORD_1
v_lshrrev_b32 v181, 18, v181
v_exp_f16_sdwa v150, v151 dst_sel:WORD_1 dst_unused:UNUSED_PRESERVE src0_sel:WORD_1
v_fma_mix_f32 v158, v139, v139, v158 op_sel:[1,1,0] op_sel_hi:[1,1,0]
v_and_b32_e64 v183, s49, v183
v_mfma_f32_32x32x16_bf16 v[120:135], v[108:111], v[224:227], v[120:135]
ds_read_b128 v[220:223], v248 offset:47104
ds_read_u16_d16_hi v181, v181
v_exp_f16_sdwa v147, v148 dst_sel:WORD_1 dst_unused:UNUSED_PRESERVE src0_sel:WORD_1
v_pk_add_f16 v153, v153, 1.0 op_sel_hi:[1,0]
v_bfe_u32 v182, v183, 2, 14
v_pk_add_f16 v150, v150, 1.0 op_sel_hi:[1,0]
v_pk_add_f16 v147, v147, 1.0 op_sel_hi:[1,0]
v_rcp_f16_e64 v154, v153
v_lshrrev_b32 v183, 18, v183
v_fma_mix_f32 v158, v140, v140, v158 op_sel:[0,0,0] op_sel_hi:[1,1,0]
s_waitcnt lgkmcnt(6)
v_mfma_f32_32x32x16_bf16 v[120:135], v[112:115], v[228:231], v[120:135]
ds_read_b128 v[224:227], v248 offset:50176
ds_read_u16_d16 v182, v182
ds_read_u16_d16_hi v183, v183
v_rcp_f16 v151, v150
v_and_b32 v185, s49, v185
v_rcp_f16_e64 v148, v147
v_fma_mix_f32 v158, v141, v141, v158 op_sel:[1,1,0] op_sel_hi:[1,1,0]
v_bfe_u32 v184, v185, 2, 14
v_rcp_f16_sdwa v154, v153 dst_sel:WORD_1 dst_unused:UNUSED_PRESERVE src0_sel:WORD_1
v_mfma_f32_32x32x16_bf16 v[120:135], v[116:119], v[232:235], v[120:135]
ds_read_b128 v[228:231], v248 offset:48128
ds_read_u16_d16 v184, v184
v_rcp_f16_sdwa v151, v150 dst_sel:WORD_1 dst_unused:UNUSED_PRESERVE src0_sel:WORD_1
v_lshrrev_b32_e64 v185, 18, v185
v_rcp_f16_sdwa v148, v147 dst_sel:WORD_1 dst_unused:UNUSED_PRESERVE src0_sel:WORD_1
v_and_b32_e64 v187, s49, v187
v_fma_mix_f32 v158, v142, v142, v158 op_sel:[0,0,0] op_sel_hi:[1,1,0]
v_pk_mul_f16 v155, v155, v154
v_pk_mul_f16 v152, v152, v151
v_smfmac_f32_16x16x32_bf16 v[44:47], v[238:239], v[192:195], v246
ds_read_b128 v[232:235], v248 offset:51200
ds_read_u16_d16_hi v185, v185
v_bfe_u32 v186, v187, 2, 14
v_pk_mul_f16 v149, v149, v148
v_fma_mix_f32 v159, v155, v155, v159 op_sel:[0,0,0] op_sel_hi:[1,1,0]
v_fma_mix_f32 v158, v143, v143, v158 op_sel:[1,1,0] op_sel_hi:[1,1,0]
v_lshrrev_b32_e64 v187, 18, v187
v_smfmac_f32_16x16x32_bf16 v[28:31], v[236:237], v[196:199], v246
v_fma_mix_f32 v159, v155, v155, v159 op_sel:[1,1,0] op_sel_hi:[1,1,0]
v_fma_mix_f32 v159, v152, v152, v159 op_sel:[0,0,0] op_sel_hi:[1,1,0]
v_fma_mix_f32 v159, v152, v152, v159 op_sel:[1,1,0] op_sel_hi:[1,1,0]
v_fma_mix_f32 v159, v149, v149, v159 op_sel:[0,0,0] op_sel_hi:[1,1,0]
v_fma_mix_f32 v159, v149, v149, v159 op_sel:[1,1,0] op_sel_hi:[1,1,0]
s_setprio 1
s_waitcnt lgkmcnt(4)
v_smfmac_f32_16x16x32_bf16 v[12:15], v[218:219], v[200:203], v246
s_add_u32 s46, s80, 20971520
buffer_store_dwordx4 v[88:91], v241, s[32:35], s46 offen sc1
ds_read_b128 v[236:239], v248 offset:49152
ds_read_u16_d16 v186, v186
ds_read_u16_d16_hi v187, v187
v_cvt_pkrtz_f16_f32 v137, v120, v121
v_cvt_pkrtz_f16_f32 v139, v122, v123
v_cvt_pkrtz_f16_f32 v141, v124, v125
v_cvt_pkrtz_f16_f32 v143, v126, v127
v_cvt_pk_f16_f32 v155, v128, v129
v_smfmac_f32_16x16x32_bf16 v[44:47], v[216:217], v[204:207], v246
v_cvt_pk_f16_f32 v152, v130, v131
v_cvt_pk_f16_f32 v149, v132, v133
v_cvt_pk_f16_f32 v146, v134, v135
v_pk_fma_f16 v154, v155, v155, s48
v_and_b32_e64 v137, s49, v137
v_mfma_f32_32x32x16_bf16 v[120:135], v[96:99], v[220:223], 0
ds_read_b128 v[216:219], v248 offset:52224
v_fma_mix_f32 v159, v178, v178, v159 op_sel:[0,0,0] op_sel_hi:[1,1,0]
v_pk_fma_f16 v151, v152, v152, s48
v_pk_fma_f16 v148, v149, v149, s48
v_pk_fma_f16 v145, v146, v146, s48
v_pk_mul_f16 v154, v155, v154
v_bfe_u32 v136, v137, 2, 14
v_pk_mul_f16 v151, v152, v151
v_fma_mix_f32 v159, v179, v179, v159 op_sel:[1,1,0] op_sel_hi:[1,1,0]
v_pk_mul_f16 v148, v149, v148
v_pk_mul_f16 v145, v146, v145
v_mfma_f32_32x32x16_bf16 v[120:135], v[100:103], v[224:227], v[120:135]
ds_read_b128 v[220:223], v245 offset:3456
ds_read_b128 v[208:211], v242 offset:64
ds_read_b128 v[212:215], v242
ds_read_u16_d16 v136, v136
v_exp_f16 v153, v154
v_lshrrev_b32 v137, 18, v137
v_exp_f16_e64 v150, v151
v_fma_mix_f32 v159, v180, v180, v159 op_sel:[0,0,0] op_sel_hi:[1,1,0]
v_exp_f16 v147, v148
v_and_b32 v139, s49, v139
v_exp_f16_e64 v144, v145
s_waitcnt lgkmcnt(5)
v_mfma_f32_32x32x16_bf16 v[120:135], v[104:107], v[228:231], v[120:135]
ds_read_b128 v[224:227], v245 offset:3072
v_xor_b32 v244, 32, v244
ds_read_b128 v[192:195], v244 offset:128
ds_read_b128 v[196:199], v244 offset:64
ds_read_u16_d16_hi v137, v137
v_exp_f16_sdwa v153, v154 dst_sel:WORD_1 dst_unused:UNUSED_PRESERVE src0_sel:WORD_1
v_fma_mix_f32 v159, v181, v181, v159 op_sel:[1,1,0] op_sel_hi:[1,1,0]
v_bfe_u32 v138, v139, 2, 14
v_exp_f16_sdwa v150, v151 dst_sel:WORD_1 dst_unused:UNUSED_PRESERVE src0_sel:WORD_1
v_exp_f16_sdwa v147, v148 dst_sel:WORD_1 dst_unused:UNUSED_PRESERVE src0_sel:WORD_1
v_exp_f16_sdwa v144, v145 dst_sel:WORD_1 dst_unused:UNUSED_PRESERVE src0_sel:WORD_1
v_lshrrev_b32_e64 v139, 18, v139
v_fma_mix_f32 v159, v182, v182, v159 op_sel:[0,0,0] op_sel_hi:[1,1,0]
v_mfma_f32_32x32x16_bf16 v[120:135], v[108:111], v[232:235], v[120:135]
ds_read_b128 v[228:231], v248 offset:53248
ds_read_u16_d16 v138, v138
ds_read_u16_d16_hi v139, v139
v_pk_add_f16 v153, v153, 1.0 op_sel_hi:[1,0]
v_pk_add_f16 v150, v150, 1.0 op_sel_hi:[1,0]
v_pk_add_f16 v147, v147, 1.0 op_sel_hi:[1,0]
v_and_b32_e64 v141, s49, v141
v_pk_add_f16 v144, v144, 1.0 op_sel_hi:[1,0]
v_rcp_f16_e64 v154, v153
v_fma_mix_f32 v159, v183, v183, v159 op_sel:[1,1,0] op_sel_hi:[1,1,0]
v_rcp_f16_e64 v151, v150
v_mfma_f32_32x32x16_bf16 v[120:135], v[112:115], v[236:239], v[120:135]
ds_read_b128 v[232:235], v248 offset:56320
v_bfe_u32 v140, v141, 2, 14
v_rcp_f16_e64 v148, v147
v_fma_mix_f32 v159, v184, v184, v159 op_sel:[0,0,0] op_sel_hi:[1,1,0]
v_rcp_f16 v145, v144
v_lshrrev_b32 v141, 18, v141
v_rcp_f16_sdwa v154, v153 dst_sel:WORD_1 dst_unused:UNUSED_PRESERVE src0_sel:WORD_1
s_setprio 0
v_rcp_f16_sdwa v151, v150 dst_sel:WORD_1 dst_unused:UNUSED_PRESERVE src0_sel:WORD_1
s_waitcnt lgkmcnt(4)
v_mfma_f32_32x32x16_bf16 v[120:135], v[116:119], v[216:219], v[120:135]
ds_read_b128 v[236:239], v248 offset:54272
ds_read_u16_d16 v140, v140
ds_read_u16_d16_hi v141, v141
v_fma_mix_f32 v159, v185, v185, v159 op_sel:[1,1,0] op_sel_hi:[1,1,0]
v_and_b32_e64 v143, s49, v143
v_rcp_f16_sdwa v148, v147 dst_sel:WORD_1 dst_unused:UNUSED_PRESERVE src0_sel:WORD_1
v_rcp_f16_sdwa v145, v144 dst_sel:WORD_1 dst_unused:UNUSED_PRESERVE src0_sel:WORD_1
v_pk_mul_f16 v155, v155, v154
v_bfe_u32 v142, v143, 2, 14
v_fma_mix_f32 v159, v186, v186, v159 op_sel:[0,0,0] op_sel_hi:[1,1,0]
v_pk_mul_f16 v152, v152, v151
v_pk_mul_f16 v149, v149, v148
v_smfmac_f32_16x16x32_bf16 v[28:31], v[222:223], v[208:211], v246
ds_read_b128 v[216:219], v248 offset:57344
ds_read_u16_d16 v142, v142
v_pk_mul_f16 v146, v146, v145
v_fma_mix_f32 v160, v155, v155, v160 op_sel:[0,0,0] op_sel_hi:[1,1,0]
v_lshrrev_b32 v143, 18, v143
v_fma_mix_f32 v160, v155, v155, v160 op_sel:[1,1,0] op_sel_hi:[1,1,0]
v_fma_mix_f32 v160, v152, v152, v160 op_sel:[0,0,0] op_sel_hi:[1,1,0]
v_smfmac_f32_16x16x32_bf16 v[12:15], v[220:221], v[212:215], v246
v_fma_mix_f32 v159, v187, v187, v159 op_sel:[1,1,0] op_sel_hi:[1,1,0]
v_fma_mix_f32 v160, v152, v152, v160 op_sel:[1,1,0] op_sel_hi:[1,1,0]
v_fma_mix_f32 v160, v149, v149, v160 op_sel:[0,0,0] op_sel_hi:[1,1,0]
v_fma_mix_f32 v160, v149, v149, v160 op_sel:[1,1,0] op_sel_hi:[1,1,0]
v_fma_mix_f32 v160, v146, v146, v160 op_sel:[0,0,0] op_sel_hi:[1,1,0]
v_fma_mix_f32 v160, v146, v146, v160 op_sel:[1,1,0] op_sel_hi:[1,1,0]
s_setprio 2
v_smfmac_f32_16x16x32_bf16 v[36:39], v[226:227], v[192:195], v246
s_add_u32 s46, s80, 23068672
buffer_store_dwordx4 v[92:95], v241, s[32:35], s46 offen sc1
ds_read_b128 v[220:223], v248 offset:55296
ds_read_u16_d16_hi v143, v143
v_cvt_pkrtz_f16_f32 v179, v120, v121
v_cvt_pkrtz_f16_f32 v181, v122, v123
v_cvt_pkrtz_f16_f32 v183, v124, v125
v_cvt_pkrtz_f16_f32 v185, v126, v127
v_smfmac_f32_16x16x32_bf16 v[20:23], v[224:225], v[196:199], v246
v_cvt_pkrtz_f16_f32 v187, v128, v129
v_cvt_pk_f16_f32 v155, v130, v131
v_cvt_pk_f16_f32 v152, v132, v133
v_cvt_pk_f16_f32 v149, v134, v135
s_waitcnt lgkmcnt(2)
v_mfma_f32_32x32x16_bf16 v[120:135], v[96:99], v[228:231], 0
ds_read_b128 v[224:227], v245 offset:2688
ds_read_b128 v[200:203], v244
v_xor_b32 v243, 32, v243
ds_read_b128 v[204:207], v243 offset:128
v_pk_fma_f16 v154, v155, v155, s48
v_and_b32_e64 v179, s49, v179
v_fma_mix_f32 v160, v136, v136, v160 op_sel:[0,0,0] op_sel_hi:[1,1,0]
v_pk_fma_f16 v151, v152, v152, s48
v_pk_fma_f16 v148, v149, v149, s48
v_bfe_u32 v178, v179, 2, 14
v_pk_mul_f16 v154, v155, v154
v_pk_mul_f16 v151, v152, v151
v_mfma_f32_32x32x16_bf16 v[120:135], v[100:103], v[232:235], v[120:135]
ds_read_b128 v[228:231], v248 offset:58368
ds_read_u16_d16 v178, v178
v_pk_mul_f16 v148, v149, v148
v_lshrrev_b32_e64 v179, 18, v179
v_fma_mix_f32 v160, v137, v137, v160 op_sel:[1,1,0] op_sel_hi:[1,1,0]
v_exp_f16 v153, v154
v_and_b32 v181, s49, v181
v_exp_f16_e64 v150, v151
v_mfma_f32_32x32x16_bf16 v[120:135], v[104:107], v[236:239], v[120:135]
ds_read_b128 v[232:235], v245 offset:2304
ds_read_b128 v[208:211], v243 offset:64
ds_read_b128 v[212:215], v243
ds_read_u16_d16_hi v179, v179
v_exp_f16_e64 v147, v148
v_bfe_u32 v180, v181, 2, 14
v_fma_mix_f32 v160, v138, v138, v160 op_sel:[0,0,0] op_sel_hi:[1,1,0]
v_exp_f16_sdwa v153, v154 dst_sel:WORD_1 dst_unused:UNUSED_PRESERVE src0_sel:WORD_1
v_lshrrev_b32 v181, 18, v181
v_mfma_f32_32x32x16_bf16 v[120:135], v[108:111], v[216:219], v[120:135]
ds_read_b128 v[236:239], v245 offset:1920
v_xor_b32 v242, 32, v242
ds_read_b128 v[192:195], v242 offset:128
ds_read_b128 v[196:199], v242 offset:64
ds_read_u16_d16 v180, v180
ds_read_u16_d16_hi v181, v181
v_exp_f16_sdwa v150, v151 dst_sel:WORD_1 dst_unused:UNUSED_PRESERVE src0_sel:WORD_1
v_fma_mix_f32 v160, v139, v139, v160 op_sel:[1,1,0] op_sel_hi:[1,1,0]
v_and_b32 v183, s49, v183
v_exp_f16_sdwa v147, v148 dst_sel:WORD_1 dst_unused:UNUSED_PRESERVE src0_sel:WORD_1
v_pk_add_f16 v153, v153, 1.0 op_sel_hi:[1,0]
v_bfe_u32 v182, v183, 2, 14
v_pk_add_f16 v150, v150, 1.0 op_sel_hi:[1,0]
s_waitcnt lgkmcnt(9)
v_mfma_f32_32x32x16_bf16 v[120:135], v[112:115], v[220:223], v[120:135]
ds_read_b128 v[216:219], v248 offset:59392
ds_read_u16_d16 v182, v182
v_pk_add_f16 v147, v147, 1.0 op_sel_hi:[1,0]
v_rcp_f16 v154, v153
v_lshrrev_b32 v183, 18, v183
v_fma_mix_f32 v160, v140, v140, v160 op_sel:[0,0,0] op_sel_hi:[1,1,0]
v_rcp_f16 v151, v150
v_and_b32 v185, s49, v185
v_smfmac_f32_16x16x32_bf16 v[4:7], v[226:227], v[200:203], v246
ds_read_b128 v[220:223], v248 offset:62464
ds_read_u16_d16_hi v183, v183
v_rcp_f16_e64 v148, v147
v_fma_mix_f32 v160, v141, v141, v160 op_sel:[1,1,0] op_sel_hi:[1,1,0]
v_bfe_u32 v184, v185, 2, 14
v_smfmac_f32_16x16x32_bf16 v[36:39], v[224:225], v[204:207], v246
v_rcp_f16_sdwa v154, v153 dst_sel:WORD_1 dst_unused:UNUSED_PRESERVE src0_sel:WORD_1
v_rcp_f16_sdwa v151, v150 dst_sel:WORD_1 dst_unused:UNUSED_PRESERVE src0_sel:WORD_1
v_mfma_f32_32x32x16_bf16 v[120:135], v[116:119], v[228:231], v[120:135]
ds_read_b128 v[224:227], v248 offset:60416
ds_read_u16_d16 v184, v184
v_lshrrev_b32_e64 v185, 18, v185
v_rcp_f16_sdwa v148, v147 dst_sel:WORD_1 dst_unused:UNUSED_PRESERVE src0_sel:WORD_1
v_and_b32 v187, s49, v187
v_fma_mix_f32 v160, v142, v142, v160 op_sel:[0,0,0] op_sel_hi:[1,1,0]
v_pk_mul_f16 v155, v155, v154
v_pk_mul_f16 v152, v152, v151
v_bfe_u32 v186, v187, 2, 14
s_waitcnt lgkmcnt(4)
v_smfmac_f32_16x16x32_bf16 v[20:23], v[234:235], v[208:211], v246
ds_read_b128 v[228:231], v248 offset:63488
ds_read_u16_d16_hi v185, v185
ds_read_u16_d16 v186, v186
v_pk_mul_f16 v149, v149, v148
v_fma_mix_f32 v161, v155, v155, v161 op_sel:[0,0,0] op_sel_hi:[1,1,0]
v_fma_mix_f32 v160, v143, v143, v160 op_sel:[1,1,0] op_sel_hi:[1,1,0]
v_lshrrev_b32 v187, 18, v187
v_smfmac_f32_16x16x32_bf16 v[4:7], v[232:233], v[212:215], v246
v_fma_mix_f32 v161, v155, v155, v161 op_sel:[1,1,0] op_sel_hi:[1,1,0]
v_fma_mix_f32 v161, v152, v152, v161 op_sel:[0,0,0] op_sel_hi:[1,1,0]
v_fma_mix_f32 v161, v152, v152, v161 op_sel:[1,1,0] op_sel_hi:[1,1,0]
v_fma_mix_f32 v161, v149, v149, v161 op_sel:[0,0,0] op_sel_hi:[1,1,0]
v_fma_mix_f32 v161, v149, v149, v161 op_sel:[1,1,0] op_sel_hi:[1,1,0]
s_setprio 1
v_smfmac_f32_16x16x32_bf16 v[36:39], v[238:239], v[192:195], v246
ds_read_b128 v[232:235], v248 offset:61440
ds_read_u16_d16_hi v187, v187
v_cvt_pkrtz_f16_f32 v137, v120, v121
v_cvt_pkrtz_f16_f32 v139, v122, v123
v_cvt_pkrtz_f16_f32 v141, v124, v125
v_cvt_pkrtz_f16_f32 v143, v126, v127
v_cvt_pk_f16_f32 v155, v128, v129
v_smfmac_f32_16x16x32_bf16 v[20:23], v[236:237], v[196:199], v246
v_cvt_pk_f16_f32 v152, v130, v131
v_cvt_pk_f16_f32 v149, v132, v133
v_cvt_pk_f16_f32 v146, v134, v135
v_pk_fma_f16 v154, v155, v155, s48
v_and_b32_e64 v137, s49, v137
v_mfma_f32_32x32x16_bf16 v[120:135], v[96:99], v[216:219], 0
ds_read_b128 v[236:239], v248 offset:64512
v_fma_mix_f32 v161, v178, v178, v161 op_sel:[0,0,0] op_sel_hi:[1,1,0]
v_pk_fma_f16 v151, v152, v152, s48
v_pk_fma_f16 v148, v149, v149, s48
v_pk_fma_f16 v145, v146, v146, s48
v_pk_mul_f16 v154, v155, v154
v_bfe_u32 v136, v137, 2, 14
v_pk_mul_f16 v151, v152, v151
v_fma_mix_f32 v161, v179, v179, v161 op_sel:[1,1,0] op_sel_hi:[1,1,0]
v_pk_mul_f16 v148, v149, v148
v_pk_mul_f16 v145, v146, v145
s_waitcnt lgkmcnt(2)
v_mfma_f32_32x32x16_bf16 v[120:135], v[100:103], v[220:223], v[120:135]
ds_read_b128 v[216:219], v245 offset:1536
ds_read_b128 v[200:203], v242
v_xor_b32 v244, 16, v244
ds_read_b128 v[204:207], v244 offset:128
ds_read_u16_d16 v136, v136
v_exp_f16 v153, v154
v_lshrrev_b32 v137, 18, v137
v_exp_f16_e64 v150, v151
v_fma_mix_f32 v161, v180, v180, v161 op_sel:[0,0,0] op_sel_hi:[1,1,0]
v_exp_f16 v147, v148
v_and_b32 v139, s49, v139
v_exp_f16_e64 v144, v145
v_mfma_f32_32x32x16_bf16 v[120:135], v[104:107], v[224:227], v[120:135]
ds_read_b128 v[220:223], v245 offset:1152
ds_read_b128 v[208:211], v244 offset:64
ds_read_b128 v[212:215], v244
ds_read_u16_d16_hi v137, v137
v_exp_f16_sdwa v153, v154 dst_sel:WORD_1 dst_unused:UNUSED_PRESERVE src0_sel:WORD_1
v_fma_mix_f32 v161, v181, v181, v161 op_sel:[1,1,0] op_sel_hi:[1,1,0]
v_bfe_u32 v138, v139, 2, 14
v_exp_f16_sdwa v150, v151 dst_sel:WORD_1 dst_unused:UNUSED_PRESERVE src0_sel:WORD_1
v_exp_f16_sdwa v147, v148 dst_sel:WORD_1 dst_unused:UNUSED_PRESERVE src0_sel:WORD_1
v_exp_f16_sdwa v144, v145 dst_sel:WORD_1 dst_unused:UNUSED_PRESERVE src0_sel:WORD_1
v_lshrrev_b32_e64 v139, 18, v139
v_fma_mix_f32 v161, v182, v182, v161 op_sel:[0,0,0] op_sel_hi:[1,1,0]
v_mfma_f32_32x32x16_bf16 v[120:135], v[108:111], v[228:231], v[120:135]
ds_read_b128 v[224:227], v249
ds_read_u16_d16 v138, v138
ds_read_u16_d16_hi v139, v139
v_pk_add_f16 v153, v153, 1.0 op_sel_hi:[1,0]
v_pk_add_f16 v150, v150, 1.0 op_sel_hi:[1,0]
v_pk_add_f16 v147, v147, 1.0 op_sel_hi:[1,0]
v_and_b32_e64 v141, s49, v141
v_pk_add_f16 v144, v144, 1.0 op_sel_hi:[1,0]
v_rcp_f16_e64 v154, v153
v_fma_mix_f32 v161, v183, v183, v161 op_sel:[1,1,0] op_sel_hi:[1,1,0]
v_rcp_f16_e64 v151, v150
v_mfma_f32_32x32x16_bf16 v[120:135], v[112:115], v[232:235], v[120:135]
ds_read_b128 v[228:231], v249 offset:3072
v_bfe_u32 v140, v141, 2, 14
v_rcp_f16_e64 v148, v147
v_fma_mix_f32 v161, v184, v184, v161 op_sel:[0,0,0] op_sel_hi:[1,1,0]
v_rcp_f16 v145, v144
v_lshrrev_b32 v141, 18, v141
v_rcp_f16_sdwa v154, v153 dst_sel:WORD_1 dst_unused:UNUSED_PRESERVE src0_sel:WORD_1
s_setprio 0
v_rcp_f16_sdwa v151, v150 dst_sel:WORD_1 dst_unused:UNUSED_PRESERVE src0_sel:WORD_1
s_waitcnt lgkmcnt(4)
v_mfma_f32_32x32x16_bf16 v[120:135], v[116:119], v[236:239], v[120:135]
ds_read_b128 v[232:235], v249 offset:1024
ds_read_u16_d16 v140, v140
ds_read_u16_d16_hi v141, v141
v_fma_mix_f32 v161, v185, v185, v161 op_sel:[1,1,0] op_sel_hi:[1,1,0]
v_and_b32_e64 v143, s49, v143
v_rcp_f16_sdwa v148, v147 dst_sel:WORD_1 dst_unused:UNUSED_PRESERVE src0_sel:WORD_1
v_rcp_f16_sdwa v145, v144 dst_sel:WORD_1 dst_unused:UNUSED_PRESERVE src0_sel:WORD_1
v_pk_mul_f16 v155, v155, v154
v_bfe_u32 v142, v143, 2, 14
v_fma_mix_f32 v161, v186, v186, v161 op_sel:[0,0,0] op_sel_hi:[1,1,0]
v_pk_mul_f16 v152, v152, v151
v_pk_mul_f16 v149, v149, v148
v_smfmac_f32_16x16x32_bf16 v[4:7], v[218:219], v[200:203], v246
ds_read_b128 v[236:239], v249 offset:4096
ds_read_u16_d16 v142, v142
v_pk_mul_f16 v146, v146, v145
v_fma_mix_f32 v162, v155, v155, v162 op_sel:[0,0,0] op_sel_hi:[1,1,0]
v_lshrrev_b32 v143, 18, v143
v_fma_mix_f32 v162, v155, v155, v162 op_sel:[1,1,0] op_sel_hi:[1,1,0]
v_fma_mix_f32 v162, v152, v152, v162 op_sel:[0,0,0] op_sel_hi:[1,1,0]
v_smfmac_f32_16x16x32_bf16 v[32:35], v[216:217], v[204:207], v246
v_fma_mix_f32 v161, v187, v187, v161 op_sel:[1,1,0] op_sel_hi:[1,1,0]
v_fma_mix_f32 v162, v152, v152, v162 op_sel:[1,1,0] op_sel_hi:[1,1,0]
v_fma_mix_f32 v162, v149, v149, v162 op_sel:[0,0,0] op_sel_hi:[1,1,0]
v_fma_mix_f32 v162, v149, v149, v162 op_sel:[1,1,0] op_sel_hi:[1,1,0]
v_fma_mix_f32 v162, v146, v146, v162 op_sel:[0,0,0] op_sel_hi:[1,1,0]
v_fma_mix_f32 v162, v146, v146, v162 op_sel:[1,1,0] op_sel_hi:[1,1,0]
s_setprio 2
v_smfmac_f32_16x16x32_bf16 v[16:19], v[222:223], v[208:211], v246
ds_read_b128 v[216:219], v249 offset:2048
ds_read_u16_d16_hi v143, v143
v_cvt_pkrtz_f16_f32 v179, v120, v121
v_cvt_pkrtz_f16_f32 v181, v122, v123
v_cvt_pkrtz_f16_f32 v183, v124, v125
v_cvt_pkrtz_f16_f32 v185, v126, v127
v_smfmac_f32_16x16x32_bf16 v[0:3], v[220:221], v[212:215], v246
v_cvt_pkrtz_f16_f32 v187, v128, v129
v_cvt_pk_f16_f32 v155, v130, v131
v_cvt_pk_f16_f32 v152, v132, v133
v_cvt_pk_f16_f32 v149, v134, v135
v_pk_fma_f16 v154, v155, v155, s48
s_waitcnt lgkmcnt(2)
v_mfma_f32_32x32x16_bf16 v[120:135], v[96:99], v[224:227], 0
ds_read_b128 v[220:223], v249 offset:5120
v_and_b32 v179, s49, v179
v_fma_mix_f32 v162, v136, v136, v162 op_sel:[0,0,0] op_sel_hi:[1,1,0]
v_pk_fma_f16 v151, v152, v152, s48
v_pk_fma_f16 v148, v149, v149, s48
v_bfe_u32 v178, v179, 2, 14
v_pk_mul_f16 v154, v155, v154
v_pk_mul_f16 v151, v152, v151
v_pk_mul_f16 v148, v149, v148
v_lshrrev_b32 v179, 18, v179
v_mfma_f32_32x32x16_bf16 v[120:135], v[100:103], v[228:231], v[120:135]
ds_read_b128 v[224:227], v245 offset:768
v_xor_b32 v243, 16, v243
ds_read_b128 v[192:195], v243 offset:128
ds_read_b128 v[196:199], v243 offset:64
ds_read_u16_d16 v178, v178
ds_read_u16_d16_hi v179, v179
v_fma_mix_f32 v162, v137, v137, v162 op_sel:[1,1,0] op_sel_hi:[1,1,0]
v_exp_f16 v153, v154
v_and_b32 v181, s49, v181
v_exp_f16 v150, v151
v_exp_f16 v147, v148
v_bfe_u32 v180, v181, 2, 14
v_mfma_f32_32x32x16_bf16 v[120:135], v[104:107], v[232:235], v[120:135]
ds_read_b128 v[228:231], v245 offset:384
ds_read_b128 v[200:203], v243
v_xor_b32 v242, 16, v242
ds_read_b128 v[204:207], v242 offset:128
ds_read_u16_d16 v180, v180
v_fma_mix_f32 v162, v138, v138, v162 op_sel:[0,0,0] op_sel_hi:[1,1,0]
v_exp_f16_sdwa v153, v154 dst_sel:WORD_1 dst_unused:UNUSED_PRESERVE src0_sel:WORD_1
v_lshrrev_b32 v181, 18, v181
v_exp_f16_sdwa v150, v151 dst_sel:WORD_1 dst_unused:UNUSED_PRESERVE src0_sel:WORD_1
v_fma_mix_f32 v162, v139, v139, v162 op_sel:[1,1,0] op_sel_hi:[1,1,0]
v_and_b32_e64 v183, s49, v183
v_mfma_f32_32x32x16_bf16 v[120:135], v[108:111], v[236:239], v[120:135]
ds_read_b128 v[232:235], v249 offset:6144
ds_read_u16_d16_hi v181, v181
v_exp_f16_sdwa v147, v148 dst_sel:WORD_1 dst_unused:UNUSED_PRESERVE src0_sel:WORD_1
v_pk_add_f16 v153, v153, 1.0 op_sel_hi:[1,0]
v_bfe_u32 v182, v183, 2, 14
v_pk_add_f16 v150, v150, 1.0 op_sel_hi:[1,0]
v_pk_add_f16 v147, v147, 1.0 op_sel_hi:[1,0]
v_rcp_f16_e64 v154, v153
v_lshrrev_b32 v183, 18, v183
v_fma_mix_f32 v162, v140, v140, v162 op_sel:[0,0,0] op_sel_hi:[1,1,0]
s_waitcnt lgkmcnt(6)
v_mfma_f32_32x32x16_bf16 v[120:135], v[112:115], v[216:219], v[120:135]
ds_read_b128 v[236:239], v249 offset:9216
ds_read_u16_d16 v182, v182
ds_read_u16_d16_hi v183, v183
v_rcp_f16 v151, v150
v_and_b32 v185, s49, v185
v_rcp_f16_e64 v148, v147
v_fma_mix_f32 v162, v141, v141, v162 op_sel:[1,1,0] op_sel_hi:[1,1,0]
v_bfe_u32 v184, v185, 2, 14
v_rcp_f16_sdwa v154, v153 dst_sel:WORD_1 dst_unused:UNUSED_PRESERVE src0_sel:WORD_1
v_mfma_f32_32x32x16_bf16 v[120:135], v[116:119], v[220:223], v[120:135]
ds_read_b128 v[216:219], v249 offset:7168
ds_read_u16_d16 v184, v184
v_rcp_f16_sdwa v151, v150 dst_sel:WORD_1 dst_unused:UNUSED_PRESERVE src0_sel:WORD_1
v_lshrrev_b32_e64 v185, 18, v185
v_rcp_f16_sdwa v148, v147 dst_sel:WORD_1 dst_unused:UNUSED_PRESERVE src0_sel:WORD_1
v_and_b32_e64 v187, s49, v187
v_fma_mix_f32 v162, v142, v142, v162 op_sel:[0,0,0] op_sel_hi:[1,1,0]
v_pk_mul_f16 v155, v155, v154
v_pk_mul_f16 v152, v152, v151
v_smfmac_f32_16x16x32_bf16 v[32:35], v[226:227], v[192:195], v246
ds_read_b128 v[220:223], v249 offset:10240
ds_read_u16_d16_hi v185, v185
v_bfe_u32 v186, v187, 2, 14
v_pk_mul_f16 v149, v149, v148
v_fma_mix_f32 v163, v155, v155, v163 op_sel:[0,0,0] op_sel_hi:[1,1,0]
v_fma_mix_f32 v162, v143, v143, v162 op_sel:[1,1,0] op_sel_hi:[1,1,0]
v_lshrrev_b32_e64 v187, 18, v187
v_smfmac_f32_16x16x32_bf16 v[16:19], v[224:225], v[196:199], v246
v_fma_mix_f32 v163, v155, v155, v163 op_sel:[1,1,0] op_sel_hi:[1,1,0]
v_fma_mix_f32 v163, v152, v152, v163 op_sel:[0,0,0] op_sel_hi:[1,1,0]
v_fma_mix_f32 v163, v152, v152, v163 op_sel:[1,1,0] op_sel_hi:[1,1,0]
v_fma_mix_f32 v163, v149, v149, v163 op_sel:[0,0,0] op_sel_hi:[1,1,0]
v_fma_mix_f32 v163, v149, v149, v163 op_sel:[1,1,0] op_sel_hi:[1,1,0]
s_setprio 1
s_waitcnt lgkmcnt(4)
v_smfmac_f32_16x16x32_bf16 v[0:3], v[230:231], v[200:203], v246
ds_read_b128 v[224:227], v249 offset:8192
ds_read_u16_d16 v186, v186
ds_read_u16_d16_hi v187, v187
v_cvt_pkrtz_f16_f32 v137, v120, v121
v_cvt_pkrtz_f16_f32 v139, v122, v123
v_cvt_pkrtz_f16_f32 v141, v124, v125
v_cvt_pkrtz_f16_f32 v143, v126, v127
v_smfmac_f32_16x16x32_bf16 v[32:35], v[228:229], v[204:207], v246
v_cvt_pk_f16_f32 v155, v128, v129
v_cvt_pk_f16_f32 v152, v130, v131
v_cvt_pk_f16_f32 v149, v132, v133
v_cvt_pk_f16_f32 v146, v134, v135
v_pk_fma_f16 v154, v155, v155, s48
v_mfma_f32_32x32x16_bf16 v[120:135], v[96:99], v[232:235], 0
ds_read_b128 v[228:231], v249 offset:11264
v_and_b32_e64 v137, s49, v137
v_fma_mix_f32 v163, v178, v178, v163 op_sel:[0,0,0] op_sel_hi:[1,1,0]
v_pk_fma_f16 v151, v152, v152, s48
v_pk_fma_f16 v148, v149, v149, s48
v_pk_fma_f16 v145, v146, v146, s48
v_pk_mul_f16 v154, v155, v154
v_bfe_u32 v136, v137, 2, 14
v_pk_mul_f16 v151, v152, v151
v_fma_mix_f32 v163, v179, v179, v163 op_sel:[1,1,0] op_sel_hi:[1,1,0]
v_pk_mul_f16 v148, v149, v148
v_mfma_f32_32x32x16_bf16 v[120:135], v[100:103], v[236:239], v[120:135]
ds_read_b128 v[232:235], v245
ds_read_b128 v[208:211], v242 offset:64
ds_read_b128 v[212:215], v242
ds_read_u16_d16 v136, v136
v_pk_mul_f16 v145, v146, v145
v_exp_f16 v153, v154
v_lshrrev_b32 v137, 18, v137
v_exp_f16_e64 v150, v151
v_fma_mix_f32 v163, v180, v180, v163 op_sel:[0,0,0] op_sel_hi:[1,1,0]
v_exp_f16_e64 v147, v148
v_and_b32 v139, s49, v139
s_waitcnt lgkmcnt(5)
v_mfma_f32_32x32x16_bf16 v[120:135], v[104:107], v[216:219], v[120:135]
ds_read_b128 v[236:239], v249 offset:12288
ds_read_u16_d16_hi v137, v137
v_exp_f16_e64 v144, v145
v_exp_f16_sdwa v153, v154 dst_sel:WORD_1 dst_unused:UNUSED_PRESERVE src0_sel:WORD_1
v_fma_mix_f32 v163, v181, v181, v163 op_sel:[1,1,0] op_sel_hi:[1,1,0]
v_bfe_u32 v138, v139, 2, 14
v_exp_f16_sdwa v150, v151 dst_sel:WORD_1 dst_unused:UNUSED_PRESERVE src0_sel:WORD_1
v_exp_f16_sdwa v147, v148 dst_sel:WORD_1 dst_unused:UNUSED_PRESERVE src0_sel:WORD_1
v_mfma_f32_32x32x16_bf16 v[120:135], v[108:111], v[220:223], v[120:135]
ds_read_b128 v[216:219], v249 offset:15360
ds_read_u16_d16 v138, v138
v_exp_f16_sdwa v144, v145 dst_sel:WORD_1 dst_unused:UNUSED_PRESERVE src0_sel:WORD_1
v_lshrrev_b32_e64 v139, 18, v139
v_fma_mix_f32 v163, v182, v182, v163 op_sel:[0,0,0] op_sel_hi:[1,1,0]
v_pk_add_f16 v153, v153, 1.0 op_sel_hi:[1,0]
v_pk_add_f16 v150, v150, 1.0 op_sel_hi:[1,0]
v_pk_add_f16 v147, v147, 1.0 op_sel_hi:[1,0]
v_and_b32_e64 v141, s49, v141
v_pk_add_f16 v144, v144, 1.0 op_sel_hi:[1,0]
v_mfma_f32_32x32x16_bf16 v[120:135], v[112:115], v[224:227], v[120:135]
ds_read_b128 v[220:223], v249 offset:13312
ds_read_u16_d16_hi v139, v139
v_rcp_f16_e64 v154, v153
v_fma_mix_f32 v163, v183, v183, v163 op_sel:[1,1,0] op_sel_hi:[1,1,0]
v_rcp_f16_e64 v151, v150
v_bfe_u32 v140, v141, 2, 14
v_rcp_f16 v148, v147
v_fma_mix_f32 v163, v184, v184, v163 op_sel:[0,0,0] op_sel_hi:[1,1,0]
s_waitcnt lgkmcnt(4)
v_mfma_f32_32x32x16_bf16 v[120:135], v[116:119], v[228:231], v[120:135]
ds_read_b128 v[224:227], v249 offset:16384
ds_read_u16_d16 v140, v140
v_rcp_f16_e64 v145, v144
v_lshrrev_b32 v141, 18, v141
v_rcp_f16_sdwa v154, v153 dst_sel:WORD_1 dst_unused:UNUSED_PRESERVE src0_sel:WORD_1
s_setprio 0
v_rcp_f16_sdwa v151, v150 dst_sel:WORD_1 dst_unused:UNUSED_PRESERVE src0_sel:WORD_1
v_fma_mix_f32 v163, v185, v185, v163 op_sel:[1,1,0] op_sel_hi:[1,1,0]
v_and_b32_e64 v143, s49, v143
v_rcp_f16_sdwa v148, v147 dst_sel:WORD_1 dst_unused:UNUSED_PRESERVE src0_sel:WORD_1
v_smfmac_f32_16x16x32_bf16 v[16:19], v[234:235], v[208:211], v246
ds_read_b128 v[228:231], v249 offset:14336
ds_read_u16_d16_hi v141, v141
v_rcp_f16_sdwa v145, v144 dst_sel:WORD_1 dst_unused:UNUSED_PRESERVE src0_sel:WORD_1
v_pk_mul_f16 v155, v155, v154
v_bfe_u32 v142, v143, 2, 14
v_fma_mix_f32 v163, v186, v186, v163 op_sel:[0,0,0] op_sel_hi:[1,1,0]
v_smfmac_f32_16x16x32_bf16 v[0:3], v[232:233], v[212:215], v246
s_mov_b64 exec, 1
ds_add_u32 v253, v254 offset:16
s_mov_b64 exec, -1
v_pk_mul_f16 v152, v152, v151
v_pk_mul_f16 v149, v149, v148
v_pk_mul_f16 v146, v146, v145
v_fma_mix_f32 v164, v155, v155, v164 op_sel:[0,0,0] op_sel_hi:[1,1,0]
v_lshrrev_b32 v143, 18, v143
v_fma_mix_f32 v164, v155, v155, v164 op_sel:[1,1,0] op_sel_hi:[1,1,0]
v_fma_mix_f32 v164, v152, v152, v164 op_sel:[0,0,0] op_sel_hi:[1,1,0]
v_fma_mix_f32 v163, v187, v187, v163 op_sel:[1,1,0] op_sel_hi:[1,1,0]
v_fma_mix_f32 v164, v152, v152, v164 op_sel:[1,1,0] op_sel_hi:[1,1,0]
v_fma_mix_f32 v164, v149, v149, v164 op_sel:[0,0,0] op_sel_hi:[1,1,0]
v_fma_mix_f32 v164, v149, v149, v164 op_sel:[1,1,0] op_sel_hi:[1,1,0]
v_fma_mix_f32 v164, v146, v146, v164 op_sel:[0,0,0] op_sel_hi:[1,1,0]
v_fma_mix_f32 v164, v146, v146, v164 op_sel:[1,1,0] op_sel_hi:[1,1,0]
s_setprio 3
v_pk_add_f32 v[168:169], v[0:1], v[2:3]
v_pk_mul_f32 v[170:171], v[0:1], v[0:1]
v_pk_fma_f32 v[170:171], v[2:3], v[2:3], v[170:171]
v_pk_add_f32 v[168:169], v[168:169], v[4:5]
v_pk_fma_f32 v[170:171], v[4:5], v[4:5], v[170:171]
v_pk_add_f32 v[168:169], v[168:169], v[6:7]
v_pk_fma_f32 v[170:171], v[6:7], v[6:7], v[170:171]
v_pk_add_f32 v[168:169], v[168:169], v[8:9]
v_pk_fma_f32 v[170:171], v[8:9], v[8:9], v[170:171]
v_pk_add_f32 v[168:169], v[168:169], v[10:11]
v_pk_fma_f32 v[170:171], v[10:11], v[10:11], v[170:171]
v_pk_add_f32 v[168:169], v[168:169], v[12:13]
v_pk_fma_f32 v[170:171], v[12:13], v[12:13], v[170:171]
v_pk_add_f32 v[168:169], v[168:169], v[14:15]
v_pk_fma_f32 v[170:171], v[14:15], v[14:15], v[170:171]
v_pk_add_f32 v[168:169], v[168:169], v[16:17]
v_pk_fma_f32 v[170:171], v[16:17], v[16:17], v[170:171]
v_pk_add_f32 v[168:169], v[168:169], v[18:19]
v_pk_fma_f32 v[170:171], v[18:19], v[18:19], v[170:171]
v_pk_add_f32 v[168:169], v[168:169], v[20:21]
v_pk_fma_f32 v[170:171], v[20:21], v[20:21], v[170:171]
v_pk_add_f32 v[168:169], v[168:169], v[22:23]
v_pk_fma_f32 v[170:171], v[22:23], v[22:23], v[170:171]
v_pk_add_f32 v[168:169], v[168:169], v[24:25]
v_pk_fma_f32 v[170:171], v[24:25], v[24:25], v[170:171]
v_pk_add_f32 v[168:169], v[168:169], v[26:27]
v_pk_fma_f32 v[170:171], v[26:27], v[26:27], v[170:171]
v_pk_add_f32 v[168:169], v[168:169], v[28:29]
v_pk_fma_f32 v[170:171], v[28:29], v[28:29], v[170:171]
v_pk_add_f32 v[168:169], v[168:169], v[30:31]
v_pk_fma_f32 v[170:171], v[30:31], v[30:31], v[170:171]
v_pk_add_f32 v[168:169], v[168:169], v[32:33]
v_pk_fma_f32 v[170:171], v[32:33], v[32:33], v[170:171]
v_pk_add_f32 v[168:169], v[168:169], v[34:35]
v_pk_fma_f32 v[170:171], v[34:35], v[34:35], v[170:171]
v_pk_add_f32 v[168:169], v[168:169], v[36:37]
v_pk_fma_f32 v[170:171], v[36:37], v[36:37], v[170:171]
v_pk_add_f32 v[168:169], v[168:169], v[38:39]
v_pk_fma_f32 v[170:171], v[38:39], v[38:39], v[170:171]
v_pk_add_f32 v[168:169], v[168:169], v[40:41]
v_pk_fma_f32 v[170:171], v[40:41], v[40:41], v[170:171]
v_pk_add_f32 v[168:169], v[168:169], v[42:43]
v_pk_fma_f32 v[170:171], v[42:43], v[42:43], v[170:171]
v_pk_add_f32 v[168:169], v[168:169], v[44:45]
v_pk_fma_f32 v[170:171], v[44:45], v[44:45], v[170:171]
v_pk_add_f32 v[168:169], v[168:169], v[46:47]
v_pk_fma_f32 v[170:171], v[46:47], v[46:47], v[170:171]
s_setprio 0
v_lshrrev_b32 v252, 2, v251
v_mul_u32_u24 v252, 192, v252
v_and_b32 v240, 3, v251
v_lshl_add_u32 v252, v240, 4, v252
s_setprio 2
v_cvt_pkrtz_f16_f32 v179, v120, v121
v_cvt_pkrtz_f16_f32 v181, v122, v123
v_cvt_pkrtz_f16_f32 v183, v124, v125
v_cvt_pkrtz_f16_f32 v185, v126, v127
v_cvt_pkrtz_f16_f32 v187, v128, v129
v_cvt_pkrtz_f16_f32 v189, v130, v131
v_cvt_pk_f16_f32 v155, v132, v133
v_cvt_pk_f16_f32 v152, v134, v135
ds_read_b128 v[232:235], v249 offset:17408
ds_read_u16_d16 v142, v142
ds_read_u16_d16_hi v143, v143
v_mfma_f32_32x32x16_bf16 v[120:135], v[236:239], v[96:99], 0
v_pk_fma_f16 v154, v155, v155, s48
v_add_f32 v168, v168, v169
v_and_b32 v179, s49, v179
v_fma_mix_f32 v164, v136, v136, v164 op_sel:[0,0,0] op_sel_hi:[1,1,0]
v_bfe_u32 v178, v179, 2, 14
v_pk_fma_f16 v151, v152, v152, s48
v_add_f32_e64 v170, v170, v171
v_pk_mul_f16 v154, v155, v154
v_lshrrev_b32_e64 v179, 18, v179
v_pk_mul_f16 v151, v152, v151
v_fma_mix_f32 v164, v137, v137, v164 op_sel:[1,1,0] op_sel_hi:[1,1,0]
v_and_b32 v181, s49, v181
s_waitcnt lgkmcnt(4)
ds_read_u16_d16 v178, v178
ds_read_u16_d16_hi v179, v179
v_mfma_f32_32x32x16_bf16 v[120:135], v[216:219], v[100:103], v[120:135]
v_permlane32_swap_b32 v168, v170
v_exp_f16 v153, v154
v_bfe_u32 v180, v181, 2, 14
v_exp_f16 v150, v151
v_add_f32 v168, v168, v170
v_lshrrev_b32_e64 v181, 18, v181
v_fma_mix_f32 v164, v138, v138, v164 op_sel:[0,0,0] op_sel_hi:[1,1,0]
v_and_b32_e64 v183, s49, v183
v_exp_f16_sdwa v153, v154 dst_sel:WORD_1 dst_unused:UNUSED_PRESERVE src0_sel:WORD_1
ds_read_u16_d16 v180, v180
ds_read_u16_d16_hi v181, v181
v_mfma_f32_32x32x16_bf16 v[120:135], v[220:223], v[104:107], v[120:135]
v_mul_f32 v168, 1009429163, v168
v_bfe_u32 v182, v183, 2, 14
v_fma_mix_f32 v164, v139, v139, v164 op_sel:[1,1,0] op_sel_hi:[1,1,0]
v_exp_f16_sdwa v150, v151 dst_sel:WORD_1 dst_unused:UNUSED_PRESERVE src0_sel:WORD_1
v_mov_b32 v170, v168
v_lshrrev_b32 v183, 18, v183
v_pk_add_f16 v153, v153, 1.0 op_sel_hi:[1,0]
v_and_b32 v185, s49, v185
v_fma_mix_f32 v164, v140, v140, v164 op_sel:[0,0,0] op_sel_hi:[1,1,0]
v_bfe_u32 v184, v185, 2, 14
v_permlane32_swap_b32 v168, v170
v_pk_add_f16 v150, v150, 1.0 op_sel_hi:[1,0]
ds_read_u16_d16 v182, v182
ds_read_u16_d16_hi v183, v183
ds_read_u16_d16 v184, v184
v_mfma_f32_32x32x16_bf16 v[120:135], v[224:227], v[108:111], v[120:135]
v_rcp_f16 v154, v153
v_lshrrev_b32 v185, 18, v185
v_fma_mix_f32 v164, v141, v141, v164 op_sel:[1,1,0] op_sel_hi:[1,1,0]
v_fma_f32 v170, -v168, v168, v170
v_and_b32 v187, s49, v187
v_rcp_f16 v151, v150
v_bfe_u32 v186, v187, 2, 14
v_max_f32_e64 v170, 0, v170
v_rcp_f16_sdwa v154, v153 dst_sel:WORD_1 dst_unused:UNUSED_PRESERVE src0_sel:WORD_1
ds_read_b128 v[224:227], v249 offset:18432
ds_read_u16_d16_hi v185, v185
ds_read_u16_d16 v186, v186
v_mfma_f32_32x32x16_bf16 v[120:135], v[228:231], v[112:115], v[120:135]
v_lshrrev_b32 v187, 18, v187
s_waitcnt lgkmcnt(6)
v_fma_mix_f32 v164, v142, v142, v164 op_sel:[0,0,0] op_sel_hi:[1,1,0]
v_and_b32_e64 v189, s49, v189
v_add_f32 v170, 925353388, v170
v_rcp_f16_sdwa v151, v150 dst_sel:WORD_1 dst_unused:UNUSED_PRESERVE src0_sel:WORD_1
v_bfe_u32 v188, v189, 2, 14
v_fma_mix_f32 v164, v143, v143, v164 op_sel:[1,1,0] op_sel_hi:[1,1,0]
v_pk_mul_f16 v155, v155, v154
v_rsq_f32 v170, v170
v_lshrrev_b32 v189, 18, v189
ds_read_b128 v[228:231], v249 offset:21504
ds_read_u16_d16_hi v187, v187
ds_read_b32 v247, v253 offset:16
ds_read_u16_d16 v188, v188
ds_read_u16_d16_hi v189, v189
v_mfma_f32_32x32x16_bf16 v[120:135], v[232:235], v[116:119], v[120:135]
v_pk_mul_f16 v152, v152, v151
v_fma_mix_f32 v165, v155, v155, v165 op_sel:[0,0,0] op_sel_hi:[1,1,0]
v_fma_mix_f32 v165, v178, v178, v165 op_sel:[0,0,0] op_sel_hi:[1,1,0]
v_fma_mix_f32 v165, v179, v179, v165 op_sel:[1,1,0] op_sel_hi:[1,1,0]
v_fma_mix_f32 v165, v180, v180, v165 op_sel:[0,0,0] op_sel_hi:[1,1,0]
v_fma_mix_f32 v165, v155, v155, v165 op_sel:[1,1,0] op_sel_hi:[1,1,0]
v_fma_mix_f32 v165, v181, v181, v165 op_sel:[1,1,0] op_sel_hi:[1,1,0]
s_waitcnt lgkmcnt(5)
v_fma_mix_f32 v165, v182, v182, v165 op_sel:[0,0,0] op_sel_hi:[1,1,0]
v_mul_f32 v172, 3203391086, v170
v_fma_mix_f32 v165, v183, v183, v165 op_sel:[1,1,0] op_sel_hi:[1,1,0]
v_fma_mix_f32 v165, v152, v152, v165 op_sel:[0,0,0] op_sel_hi:[1,1,0]
v_fma_mix_f32 v165, v184, v184, v165 op_sel:[0,0,0] op_sel_hi:[1,1,0]
v_fma_mix_f32 v165, v185, v185, v165 op_sel:[1,1,0] op_sel_hi:[1,1,0]
v_fma_mix_f32 v165, v186, v186, v165 op_sel:[0,0,0] op_sel_hi:[1,1,0]
v_mul_f32 v173, v168, v172
v_fma_mix_f32 v165, v152, v152, v165 op_sel:[1,1,0] op_sel_hi:[1,1,0]
s_waitcnt lgkmcnt(3)
v_fma_mix_f32 v165, v187, v187, v165 op_sel:[1,1,0] op_sel_hi:[1,1,0]
s_waitcnt lgkmcnt(1)
v_fma_mix_f32 v165, v188, v188, v165 op_sel:[0,0,0] op_sel_hi:[1,1,0]
s_waitcnt lgkmcnt(0)
v_fma_mix_f32 v165, v189, v189, v165 op_sel:[1,1,0] op_sel_hi:[1,1,0]
s_setprio 3
v_pk_fma_f32 v[0:1], v[0:1], v[172:173], v[172:173] op_sel:[0,0,1] op_sel_hi:[1,0,1] neg_lo:[0,0,1] neg_hi:[0,0,1]
v_pk_fma_f32 v[2:3], v[2:3], v[172:173], v[172:173] op_sel:[0,0,1] op_sel_hi:[1,0,1] neg_lo:[0,0,1] neg_hi:[0,0,1]
v_pk_fma_f32 v[4:5], v[4:5], v[172:173], v[172:173] op_sel:[0,0,1] op_sel_hi:[1,0,1] neg_lo:[0,0,1] neg_hi:[0,0,1]
v_pk_fma_f32 v[6:7], v[6:7], v[172:173], v[172:173] op_sel:[0,0,1] op_sel_hi:[1,0,1] neg_lo:[0,0,1] neg_hi:[0,0,1]
v_pk_fma_f32 v[8:9], v[8:9], v[172:173], v[172:173] op_sel:[0,0,1] op_sel_hi:[1,0,1] neg_lo:[0,0,1] neg_hi:[0,0,1]
v_pk_fma_f32 v[10:11], v[10:11], v[172:173], v[172:173] op_sel:[0,0,1] op_sel_hi:[1,0,1] neg_lo:[0,0,1] neg_hi:[0,0,1]
v_pk_fma_f32 v[12:13], v[12:13], v[172:173], v[172:173] op_sel:[0,0,1] op_sel_hi:[1,0,1] neg_lo:[0,0,1] neg_hi:[0,0,1]
v_pk_fma_f32 v[14:15], v[14:15], v[172:173], v[172:173] op_sel:[0,0,1] op_sel_hi:[1,0,1] neg_lo:[0,0,1] neg_hi:[0,0,1]
v_pk_fma_f32 v[16:17], v[16:17], v[172:173], v[172:173] op_sel:[0,0,1] op_sel_hi:[1,0,1] neg_lo:[0,0,1] neg_hi:[0,0,1]
v_pk_fma_f32 v[18:19], v[18:19], v[172:173], v[172:173] op_sel:[0,0,1] op_sel_hi:[1,0,1] neg_lo:[0,0,1] neg_hi:[0,0,1]
v_pk_fma_f32 v[20:21], v[20:21], v[172:173], v[172:173] op_sel:[0,0,1] op_sel_hi:[1,0,1] neg_lo:[0,0,1] neg_hi:[0,0,1]
v_pk_fma_f32 v[22:23], v[22:23], v[172:173], v[172:173] op_sel:[0,0,1] op_sel_hi:[1,0,1] neg_lo:[0,0,1] neg_hi:[0,0,1]
v_pk_fma_f32 v[24:25], v[24:25], v[172:173], v[172:173] op_sel:[0,0,1] op_sel_hi:[1,0,1] neg_lo:[0,0,1] neg_hi:[0,0,1]
v_pk_fma_f32 v[26:27], v[26:27], v[172:173], v[172:173] op_sel:[0,0,1] op_sel_hi:[1,0,1] neg_lo:[0,0,1] neg_hi:[0,0,1]
v_pk_fma_f32 v[28:29], v[28:29], v[172:173], v[172:173] op_sel:[0,0,1] op_sel_hi:[1,0,1] neg_lo:[0,0,1] neg_hi:[0,0,1]
v_pk_fma_f32 v[30:31], v[30:31], v[172:173], v[172:173] op_sel:[0,0,1] op_sel_hi:[1,0,1] neg_lo:[0,0,1] neg_hi:[0,0,1]
v_pk_fma_f32 v[32:33], v[32:33], v[172:173], v[172:173] op_sel:[0,0,1] op_sel_hi:[1,0,1] neg_lo:[0,0,1] neg_hi:[0,0,1]
v_pk_fma_f32 v[34:35], v[34:35], v[172:173], v[172:173] op_sel:[0,0,1] op_sel_hi:[1,0,1] neg_lo:[0,0,1] neg_hi:[0,0,1]
v_pk_fma_f32 v[36:37], v[36:37], v[172:173], v[172:173] op_sel:[0,0,1] op_sel_hi:[1,0,1] neg_lo:[0,0,1] neg_hi:[0,0,1]
v_pk_fma_f32 v[38:39], v[38:39], v[172:173], v[172:173] op_sel:[0,0,1] op_sel_hi:[1,0,1] neg_lo:[0,0,1] neg_hi:[0,0,1]
v_pk_fma_f32 v[40:41], v[40:41], v[172:173], v[172:173] op_sel:[0,0,1] op_sel_hi:[1,0,1] neg_lo:[0,0,1] neg_hi:[0,0,1]
v_pk_fma_f32 v[42:43], v[42:43], v[172:173], v[172:173] op_sel:[0,0,1] op_sel_hi:[1,0,1] neg_lo:[0,0,1] neg_hi:[0,0,1]
v_pk_fma_f32 v[44:45], v[44:45], v[172:173], v[172:173] op_sel:[0,0,1] op_sel_hi:[1,0,1] neg_lo:[0,0,1] neg_hi:[0,0,1]
v_pk_fma_f32 v[46:47], v[46:47], v[172:173], v[172:173] op_sel:[0,0,1] op_sel_hi:[1,0,1] neg_lo:[0,0,1] neg_hi:[0,0,1]
s_setprio 2
v_readfirstlane_b32 s43, v247
s_nop 1
s_cmp_ge_u32 s43, 32
s_cbranch_scc1 Lev9
Lev9w:
s_sleep 1
ds_read_b32 v247, v253 offset:16
s_waitcnt lgkmcnt(0)
v_readfirstlane_b32 s43, v247
s_cmp_eq_u32 s76, 0
s_cbranch_scc1 Lev9
s_sub_u32 s76, s76, 1
s_cmp_lt_u32 s43, 32
s_cbranch_scc1 Lev9w
Lev9:
s_setprio 1
v_cvt_pkrtz_f16_f32 v137, v120, v121
v_cvt_pkrtz_f16_f32 v139, v122, v123
v_cvt_pkrtz_f16_f32 v141, v124, v125
v_cvt_pkrtz_f16_f32 v143, v126, v127
v_cvt_pkrtz_f16_f32 v145, v128, v129
v_cvt_pkrtz_f16_f32 v147, v130, v131
v_cvt_pk_f16_f32 v155, v132, v133
v_cvt_pk_f16_f32 v152, v134, v135
s_add_u32 m0, s72, 0
s_add_u32 s43, s82, 0
buffer_load_dwordx4 v252, s[16:19], s43 offen lds
ds_read_b128 v[232:235], v249 offset:19456
ds_read_b128 v[236:239], v249 offset:22528
v_mfma_f32_32x32x16_bf16 v[120:135], v[224:227], v[96:99], 0
v_pk_fma_f16 v154, v155, v155, s48
v_and_b32_e64 v192, 1, v251
v_cvt_pk_bf16_f32 v168, v0, v1
v_and_b32_e64 v137, s49, v137
v_pk_fma_f16 v151, v152, v152, s48
v_lshlrev_b32_e64 v192, 4, v192
v_cvt_pk_bf16_f32 v169, v2, v3
v_and_b32_e64 v139, s49, v139
v_pk_mul_f16 v154, v155, v154
v_cvt_pk_bf16_f32 v170, v4, v5
v_mov_b32 v193, 15360
v_bfe_u32 v136, v137, 2, 14
v_pk_mul_f16 v151, v152, v151
v_cvt_pk_bf16_f32 v171, v6, v7
ds_read_b128 v[224:227], v249 offset:20480
ds_read_u16_d16 v136, v136
v_mfma_f32_32x32x16_bf16 v[120:135], v[228:231], v[100:103], v[120:135]
v_lshlrev_b32_e64 v192, v192, v193
v_bfe_u32 v138, v139, 2, 14
v_exp_f16_e64 v153, v154
v_cvt_pk_bf16_f32 v172, v8, v9
v_lshrrev_b32 v193, 3, v251
v_lshrrev_b32 v137, 18, v137
v_cvt_pk_bf16_f32 v173, v10, v11
v_exp_f16 v150, v151
v_xor_b32 v193, v193, v251
v_cvt_pk_bf16_f32 v174, v12, v13
v_lshrrev_b32 v139, 18, v139
v_and_b32 v141, s49, v141
s_waitcnt lgkmcnt(2)
s_add_u32 m0, s72, 1024
s_add_u32 s43, s82, 64
buffer_load_dwordx4 v252, s[16:19], s43 offen lds
ds_read_b128 v[228:231], v249 offset:23552
ds_read_u16_d16 v138, v138
ds_read_u16_d16_hi v137, v137
ds_read_u16_d16_hi v139, v139
v_mfma_f32_32x32x16_bf16 v[120:135], v[232:235], v[104:107], v[120:135]
v_and_b32_e64 v193, 4, v193
v_cvt_pk_bf16_f32 v175, v14, v15
v_exp_f16_sdwa v153, v154 dst_sel:WORD_1 dst_unused:UNUSED_PRESERVE src0_sel:WORD_1
v_cvt_pk_bf16_f32 v176, v16, v17
v_bfe_u32 v194, v251, 3, 2
v_and_b32_e64 v143, s49, v143
v_bfe_u32 v140, v141, 2, 14
v_cvt_pk_bf16_f32 v177, v18, v19
v_lshl_add_u32 v193, v193, 1, 0
v_exp_f16_sdwa v150, v151 dst_sel:WORD_1 dst_unused:UNUSED_PRESERVE src0_sel:WORD_1
v_cvt_pk_bf16_f32 v178, v20, v21
v_bfe_u32 v142, v143, 2, 14
v_lshl_add_u32 v193, v194, 1, v193
ds_read_b128 v[232:235], v248 offset:16384
ds_read_u16_d16 v140, v140
ds_read_u16_d16 v142, v142
v_mfma_f32_32x32x16_bf16 v[120:135], v[236:239], v[108:111], v[120:135]
v_pk_add_f16 v153, v153, 1.0 op_sel_hi:[1,0]
v_cvt_pk_bf16_f32 v179, v22, v23
v_lshrrev_b32_e64 v141, 18, v141
v_pk_add_f16 v150, v150, 1.0 op_sel_hi:[1,0]
v_bfe_u32 v194, v251, 1, 1
v_cvt_pk_bf16_f32 v180, v24, v25
v_lshrrev_b32 v143, 18, v143
v_rcp_f16 v154, v153
v_add_u32_e64 v193, v193, v194
v_cvt_pk_bf16_f32 v181, v26, v27
v_and_b32_e64 v145, s49, v145
v_cvt_pk_bf16_f32 v182, v28, v29
v_cmp_eq_u32 vcc, 0, v193
s_nop 1
v_cndmask_b32 v240, 0, v192, vcc
s_waitcnt lgkmcnt(3)
s_add_u32 m0, s72, 2048
s_add_u32 s43, s82, 128
buffer_load_dwordx4 v252, s[16:19], s43 offen lds
ds_read_b128 v[236:239], v248 offset:19456
ds_read_u16_d16_hi v141, v141
ds_read_u16_d16_hi v143, v143
v_mfma_f32_32x32x16_bf16 v[120:135], v[224:227], v[112:115], v[120:135]
v_and_b32_e64 v147, s49, v147
v_rcp_f16 v151, v150
v_cmp_eq_u32 vcc, 1, v193
s_nop 1
v_cndmask_b32 v241, 0, v192, vcc
v_cvt_pk_bf16_f32 v183, v30, v31
v_bfe_u32 v144, v145, 2, 14
s_setprio 0
v_cvt_pk_bf16_f32 v184, v32, v33
v_rcp_f16_sdwa v154, v153 dst_sel:WORD_1 dst_unused:UNUSED_PRESERVE src0_sel:WORD_1
v_cmp_eq_u32 vcc, 2, v193
s_nop 1
v_cndmask_b32 v242, 0, v192, vcc
v_cvt_pk_bf16_f32 v185, v34, v35
v_bfe_u32 v146, v147, 2, 14
v_lshrrev_b32 v145, 18, v145
v_cmp_eq_u32 vcc, 3, v193
s_nop 1
v_cndmask_b32 v243, 0, v192, vcc
ds_read_b128 v[224:227], v248 offset:17408
ds_read_u16_d16 v144, v144
ds_read_u16_d16 v146, v146
ds_read_u16_d16_hi v145, v145
v_mfma_f32_32x32x16_bf16 v[120:135], v[228:231], v[116:119], v[120:135]
v_cvt_pk_bf16_f32 v186, v36, v37
v_rcp_f16_sdwa v151, v150 dst_sel:WORD_1 dst_unused:UNUSED_PRESERVE src0_sel:WORD_1
v_cmp_eq_u32 vcc, 4, v193
s_nop 1
v_cndmask_b32 v244, 0, v192, vcc
v_cvt_pk_bf16_f32 v187, v38, v39
v_lshrrev_b32 v147, 18, v147
v_or_b32_e64 v208, v136, v137
v_cvt_pk_bf16_f32 v188, v40, v41
v_cmp_eq_u32 vcc, 5, v193
s_nop 1
v_cndmask_b32 v245, 0, v192, vcc
v_or_b32 v209, v138, v139
s_waitcnt lgkmcnt(4)
v_or_b32 v210, v140, v141
v_cvt_pk_bf16_f32 v189, v42, v43
v_cmp_eq_u32 vcc, 6, v193
s_nop 1
v_cndmask_b32 v246, 0, v192, vcc
v_or_b32 v211, v142, v143
s_waitcnt lgkmcnt(0)
v_or_b32 v212, v144, v145
v_cvt_pk_bf16_f32 v190, v44, v45
ds_read_u16_d16_hi v147, v147
s_waitcnt lgkmcnt(0)
v_or_b32 v213, v146, v147
v_cmp_eq_u32 vcc, 7, v193
s_nop 1
v_cndmask_b32 v247, 0, v192, vcc
v_pk_mul_f16 v214, v155, v154
v_cvt_pk_bf16_f32 v191, v46, v47
v_pk_mul_f16 v215, v152, v151
s_setprio 2
s_add_u32 m0, s72, 3072
s_add_u32 s43, s82, 3072
buffer_load_dwordx4 v252, s[16:19], s43 offen lds
ds_read_b128 v[228:231], v248 offset:20480
v_mfma_f32_32x32x16_f16 v[192:207], v[208:211], v[240:243], 0
v_cvt_pkrtz_f16_f32 v137, v120, v121
v_cvt_pkrtz_f16_f32 v139, v122, v123
v_cvt_pkrtz_f16_f32 v141, v124, v125
v_cvt_pkrtz_f16_f32 v143, v126, v127
v_cvt_pkrtz_f16_f32 v145, v128, v129
v_mfma_f32_32x32x16_f16 v[192:207], v[212:215], v[244:247], v[192:207]
v_cvt_pk_f16_f32 v155, v130, v131
v_cvt_pk_f16_f32 v152, v132, v133
v_cvt_pk_f16_f32 v149, v134, v135
v_pk_fma_f16 v154, v155, v155, s48
v_and_b32_e64 v137, s49, v137
v_mfma_f32_32x32x16_bf16 v[120:135], v[232:235], v[168:171], 0
v_pk_fma_f16 v151, v152, v152, s48
v_and_b32_e64 v139, s49, v139
v_pk_fma_f16 v148, v149, v149, s48
v_pk_mul_f16 v154, v155, v154
v_bfe_u32 v136, v137, 2, 14
v_pk_mul_f16 v151, v152, v151
v_pk_mul_f16 v148, v149, v148
v_bfe_u32 v138, v139, 2, 14
v_fmac_f32 v166, v192, v192
v_exp_f16 v153, v154
s_add_u32 m0, s72, 4096
s_add_u32 s43, s82, 3136
buffer_load_dwordx4 v252, s[16:19], s43 offen lds
ds_read_b128 v[232:235], v248 offset:18432
ds_read_u16_d16 v136, v136
ds_read_u16_d16 v138, v138
v_mfma_f32_32x32x16_bf16 v[120:135], v[236:239], v[172:175], v[120:135]
v_fmac_f32 v166, v193, v193
v_lshrrev_b32 v137, 18, v137
v_exp_f16 v150, v151
v_fmac_f32 v166, v194, v194
v_lshrrev_b32 v139, 18, v139
v_exp_f16 v147, v148
v_fmac_f32 v166, v195, v195
v_and_b32 v141, s49, v141
ds_read_b128 v[236:239], v248 offset:21504
ds_read_u16_d16_hi v137, v137
ds_read_u16_d16_hi v139, v139
v_mfma_f32_32x32x16_bf16 v[120:135], v[224:227], v[176:179], v[120:135]
v_and_b32_e64 v143, s49, v143
v_exp_f16_sdwa v153, v154 dst_sel:WORD_1 dst_unused:UNUSED_PRESERVE src0_sel:WORD_1
v_fmac_f32_e64 v166, v196, v196
v_bfe_u32 v140, v141, 2, 14
v_exp_f16_sdwa v150, v151 dst_sel:WORD_1 dst_unused:UNUSED_PRESERVE src0_sel:WORD_1
v_fmac_f32 v166, v197, v197
v_bfe_u32 v142, v143, 2, 14
v_exp_f16_sdwa v147, v148 dst_sel:WORD_1 dst_unused:UNUSED_PRESERVE src0_sel:WORD_1
s_waitcnt lgkmcnt(6)
ds_read_b128 v[224:227], v248 offset:22528
ds_read_u16_d16 v140, v140
ds_read_u16_d16 v142, v142
v_mfma_f32_32x32x16_bf16 v[120:135], v[228:231], v[180:183], v[120:135]
v_fmac_f32 v166, v198, v198
v_lshrrev_b32 v141, 18, v141
v_pk_add_f16 v153, v153, 1.0 op_sel_hi:[1,0]
v_fmac_f32 v166, v199, v199
v_lshrrev_b32 v143, 18, v143
v_pk_add_f16 v150, v150, 1.0 op_sel_hi:[1,0]
v_pk_add_f16 v147, v147, 1.0 op_sel_hi:[1,0]
v_fmac_f32_e64 v166, v200, v200
v_and_b32 v145, s49, v145
s_waitcnt lgkmcnt(4)
s_add_u32 m0, s72, 5120
s_add_u32 s43, s82, 3200
buffer_load_dwordx4 v252, s[16:19], s43 offen lds
ds_read_b128 v[228:231], v248 offset:25600
ds_read_u16_d16_hi v141, v141
ds_read_u16_d16_hi v143, v143
v_mfma_f32_32x32x16_bf16 v[120:135], v[232:235], v[184:187], v[120:135]
v_rcp_f16 v154, v153
v_fmac_f32 v166, v201, v201
v_bfe_u32 v144, v145, 2, 14
v_rcp_f16 v151, v150
v_fmac_f32 v166, v202, v202
v_lshrrev_b32 v145, 18, v145
v_rcp_f16 v148, v147
v_fmac_f32 v166, v203, v203
v_or_b32 v216, v136, v137
ds_read_b128 v[232:235], v248 offset:23552
ds_read_u16_d16 v144, v144
ds_read_u16_d16_hi v145, v145
v_mfma_f32_32x32x16_bf16 v[120:135], v[236:239], v[188:191], v[120:135]
s_waitcnt lgkmcnt(6)
v_or_b32 v217, v138, v139
v_rcp_f16_sdwa v154, v153 dst_sel:WORD_1 dst_unused:UNUSED_PRESERVE src0_sel:WORD_1
v_fmac_f32 v166, v204, v204
s_waitcnt lgkmcnt(4)
v_or_b32_e64 v218, v140, v141
v_rcp_f16_sdwa v151, v150 dst_sel:WORD_1 dst_unused:UNUSED_PRESERVE src0_sel:WORD_1
v_fmac_f32 v166, v205, v205
s_waitcnt lgkmcnt(3)
v_or_b32_e64 v219, v142, v143
v_rcp_f16_sdwa v148, v147 dst_sel:WORD_1 dst_unused:UNUSED_PRESERVE src0_sel:WORD_1
v_fmac_f32 v166, v206, v206
s_waitcnt lgkmcnt(0)
v_or_b32_e64 v220, v144, v145
v_pk_mul_f16 v221, v155, v154
v_fmac_f32_e64 v166, v207, v207
v_pk_mul_f16 v222, v152, v151
v_pk_mul_f16 v223, v149, v148
s_cmp_lg_u32 s40, 0
s_cbranch_scc1 Lrs0
v_mov_b32 v90, 0
buffer_load_dword v91, v90, s[36:39], 0 offen sc1
Lrs0:
s_setprio 1
s_add_u32 m0, s72, 6144
s_add_u32 s43, s82, 6144
buffer_load_dwordx4 v252, s[16:19], s43 offen lds
ds_read_b128 v[236:239], v248 offset:26624
v_mfma_f32_32x32x16_f16 v[192:207], v[216:219], v[240:243], 0
v_cvt_pkrtz_f16_f32 v137, v120, v121
v_cvt_pkrtz_f16_f32 v139, v122, v123
v_cvt_pkrtz_f16_f32 v141, v124, v125
v_cvt_pkrtz_f16_f32 v143, v126, v127
v_cvt_pkrtz_f16_f32 v145, v128, v129
v_mfma_f32_32x32x16_f16 v[192:207], v[220:223], v[244:247], v[192:207]
v_cvt_pkrtz_f16_f32 v147, v130, v131
v_cvt_pk_f16_f32 v155, v132, v133
v_cvt_pk_f16_f32 v152, v134, v135
v_pk_fma_f16 v154, v155, v155, s48
v_and_b32_e64 v255, 51, v251
v_mfma_f32_32x32x16_bf16 v[120:135], v[224:227], v[168:171], 0
v_and_b32_e64 v137, s49, v137
v_pk_fma_f16 v151, v152, v152, s48
v_and_b32_e64 v139, s49, v139
v_pk_mul_f16 v154, v155, v154
v_bfe_u32 v136, v137, 2, 14
v_pk_mul_f16 v151, v152, v151
v_bfe_u32 v138, v139, 2, 14
v_exp_f16 v153, v154
v_fmac_f32 v167, v192, v192
ds_read_b128 v[224:227], v248 offset:24576
ds_read_u16_d16 v136, v136
ds_read_u16_d16 v138, v138
v_mfma_f32_32x32x16_bf16 v[120:135], v[228:231], v[172:175], v[120:135]
v_bfe_u32 v95, v251, 2, 1
v_lshrrev_b32 v137, 18, v137
v_fmac_f32 v167, v193, v193
v_exp_f16 v150, v151
v_lshrrev_b32 v139, 18, v139
v_fmac_f32 v167, v194, v194
v_and_b32 v141, s49, v141
v_exp_f16_sdwa v153, v154 dst_sel:WORD_1 dst_unused:UNUSED_PRESERVE src0_sel:WORD_1
ds_read_b128 v[228:231], v248 offset:27648
ds_read_u16_d16_hi v137, v137
ds_read_u16_d16_hi v139, v139
v_mfma_f32_32x32x16_bf16 v[120:135], v[232:235], v[176:179], v[120:135]
v_fmac_f32 v167, v195, v195
v_and_b32 v143, s49, v143
v_lshl_add_u32 v255, v95, 3, v255
v_bfe_u32 v140, v141, 2, 14
v_fmac_f32_e64 v167, v196, v196
v_exp_f16_sdwa v150, v151 dst_sel:WORD_1 dst_unused:UNUSED_PRESERVE src0_sel:WORD_1
v_fmac_f32_e64 v167, v197, v197
v_bfe_u32 v142, v143, 2, 14
v_pk_add_f16 v153, v153, 1.0 op_sel_hi:[1,0]
v_lshrrev_b32 v141, 18, v141
s_waitcnt lgkmcnt(4)
ds_read_b128 v[232:235], v248 offset:28672
ds_read_u16_d16 v140, v140
ds_read_u16_d16 v142, v142
ds_read_u16_d16_hi v141, v141
v_mfma_f32_32x32x16_bf16 v[120:135], v[236:239], v[180:183], v[120:135]
v_fmac_f32_e64 v167, v198, v198
v_pk_add_f16 v150, v150, 1.0 op_sel_hi:[1,0]
v_lshrrev_b32_e64 v143, 18, v143
v_bfe_u32 v95, v251, 3, 1
v_fmac_f32 v167, v199, v199
v_rcp_f16 v154, v153
v_and_b32 v145, s49, v145
v_fmac_f32 v167, v200, v200
v_and_b32_e64 v147, s49, v147
ds_read_b128 v[236:239], v248 offset:31744
ds_read_u16_d16_hi v143, v143
v_mfma_f32_32x32x16_bf16 v[120:135], v[224:227], v[184:187], v[120:135]
v_rcp_f16_e64 v151, v150
v_fmac_f32 v167, v201, v201
v_bfe_u32 v144, v145, 2, 14
s_setprio 0
v_lshl_add_u32 v255, v95, 2, v255
v_rcp_f16_sdwa v154, v153 dst_sel:WORD_1 dst_unused:UNUSED_PRESERVE src0_sel:WORD_1
v_fmac_f32_e64 v167, v202, v202
v_bfe_u32 v146, v147, 2, 14
v_fmac_f32 v167, v203, v203
s_waitcnt lgkmcnt(4)
ds_read_b128 v[224:227], v248 offset:29696
ds_read_u16_d16 v144, v144
ds_read_u16_d16 v146, v146
v_mfma_f32_32x32x16_bf16 v[120:135], v[228:231], v[188:191], v[120:135]
v_lshrrev_b32_e64 v145, 18, v145
v_rcp_f16_sdwa v151, v150 dst_sel:WORD_1 dst_unused:UNUSED_PRESERVE src0_sel:WORD_1
v_fmac_f32 v167, v204, v204
v_lshrrev_b32 v147, 18, v147
v_or_b32_e64 v0, v136, v137
v_lshl_add_u32 v255, v255, 2, s72
v_fmac_f32 v167, v205, v205
v_or_b32 v1, v138, v139
s_waitcnt lgkmcnt(4)
v_or_b32 v2, v140, v141
s_waitcnt lgkmcnt(3)
v_or_b32 v3, v142, v143
v_fmac_f32_e64 v167, v206, v206
ds_read_u16_d16_hi v145, v145
ds_read_u16_d16_hi v147, v147
s_waitcnt lgkmcnt(1)
v_or_b32 v4, v144, v145
s_waitcnt lgkmcnt(0)
v_or_b32 v5, v146, v147
v_fmac_f32 v167, v207, v207
v_pk_mul_f16 v6, v155, v154
v_pk_mul_f16 v7, v152, v151
s_setprio 2
ds_read_b128 v[228:231], v248 offset:32768
v_mfma_f32_32x32x16_f16 v[192:207], v[0:3], v[240:243], 0
v_cvt_pkrtz_f16_f32 v137, v120, v121
v_cvt_pkrtz_f16_f32 v139, v122, v123
v_cvt_pkrtz_f16_f32 v141, v124, v125
v_cvt_pkrtz_f16_f32 v143, v126, v127
v_cvt_pkrtz_f16_f32 v145, v128, v129
v_mfma_f32_32x32x16_f16 v[192:207], v[4:7], v[244:247], v[192:207]
v_cvt_pk_f16_f32 v155, v130, v131
v_cvt_pk_f16_f32 v152, v132, v133
v_cvt_pk_f16_f32 v149, v134, v135
v_pk_fma_f16 v154, v155, v155, s48
v_and_b32_e64 v137, s49, v137
v_mfma_f32_32x32x16_bf16 v[120:135], v[232:235], v[168:171], 0
v_pk_fma_f16 v151, v152, v152, s48
v_and_b32_e64 v139, s49, v139
v_pk_fma_f16 v148, v149, v149, s48
v_pk_mul_f16 v154, v155, v154
v_bfe_u32 v136, v137, 2, 14
v_pk_mul_f16 v151, v152, v151
v_pk_mul_f16 v148, v149, v148
v_bfe_u32 v138, v139, 2, 14
v_fmac_f32 v156, v192, v192
v_exp_f16 v153, v154
ds_read_b128 v[232:235], v248 offset:30720
ds_read_u16_d16 v136, v136
ds_read_u16_d16 v138, v138
v_mfma_f32_32x32x16_bf16 v[120:135], v[236:239], v[172:175], v[120:135]
v_fmac_f32 v156, v193, v193
v_lshrrev_b32 v137, 18, v137
v_exp_f16 v150, v151
v_fmac_f32 v156, v194, v194
v_lshrrev_b32 v139, 18, v139
v_exp_f16 v147, v148
v_fmac_f32 v156, v195, v195
v_and_b32 v141, s49, v141
ds_read_b128 v[236:239], v248 offset:33792
ds_read_u16_d16_hi v137, v137
ds_read_u16_d16_hi v139, v139
v_mfma_f32_32x32x16_bf16 v[120:135], v[224:227], v[176:179], v[120:135]
v_and_b32_e64 v143, s49, v143
v_exp_f16_sdwa v153, v154 dst_sel:WORD_1 dst_unused:UNUSED_PRESERVE src0_sel:WORD_1
v_fmac_f32_e64 v156, v196, v196
v_bfe_u32 v140, v141, 2, 14
v_exp_f16_sdwa v150, v151 dst_sel:WORD_1 dst_unused:UNUSED_PRESERVE src0_sel:WORD_1
v_fmac_f32 v156, v197, v197
v_bfe_u32 v142, v143, 2, 14
v_exp_f16_sdwa v147, v148 dst_sel:WORD_1 dst_unused:UNUSED_PRESERVE src0_sel:WORD_1
s_waitcnt lgkmcnt(6)
ds_read_b128 v[224:227], v248 offset:34816
ds_read_u16_d16 v140, v140
ds_read_u16_d16 v142, v142
v_mfma_f32_32x32x16_bf16 v[120:135], v[228:231], v[180:183], v[120:135]
v_fmac_f32 v156, v198, v198
v_lshrrev_b32 v141, 18, v141
v_pk_add_f16 v153, v153, 1.0 op_sel_hi:[1,0]
v_fmac_f32 v156, v199, v199
v_lshrrev_b32 v143, 18, v143
v_pk_add_f16 v150, v150, 1.0 op_sel_hi:[1,0]
v_pk_add_f16 v147, v147, 1.0 op_sel_hi:[1,0]
v_fmac_f32_e64 v156, v200, v200
v_and_b32 v145, s49, v145
s_waitcnt lgkmcnt(4)
ds_read_b128 v[228:231], v248 offset:37888
ds_read_u16_d16_hi v141, v141
ds_read_u16_d16_hi v143, v143
v_mfma_f32_32x32x16_bf16 v[120:135], v[232:235], v[184:187], v[120:135]
v_rcp_f16 v154, v153
v_fmac_f32 v156, v201, v201
v_bfe_u32 v144, v145, 2, 14
v_rcp_f16 v151, v150
v_fmac_f32 v156, v202, v202
v_lshrrev_b32 v145, 18, v145
v_rcp_f16 v148, v147
v_fmac_f32 v156, v203, v203
v_or_b32 v8, v136, v137
ds_read_b128 v[232:235], v248 offset:35840
ds_read_u16_d16 v144, v144
ds_read_u16_d16_hi v145, v145
v_mfma_f32_32x32x16_bf16 v[120:135], v[236:239], v[188:191], v[120:135]
s_waitcnt lgkmcnt(6)
v_or_b32 v9, v138, v139
v_rcp_f16_sdwa v154, v153 dst_sel:WORD_1 dst_unused:UNUSED_PRESERVE src0_sel:WORD_1
v_fmac_f32 v156, v204, v204
s_waitcnt lgkmcnt(4)
v_or_b32_e64 v10, v140, v141
v_rcp_f16_sdwa v151, v150 dst_sel:WORD_1 dst_unused:UNUSED_PRESERVE src0_sel:WORD_1
v_fmac_f32 v156, v205, v205
s_waitcnt lgkmcnt(3)
v_or_b32_e64 v11, v142, v143
v_rcp_f16_sdwa v148, v147 dst_sel:WORD_1 dst_unused:UNUSED_PRESERVE src0_sel:WORD_1
v_fmac_f32 v156, v206, v206
s_waitcnt lgkmcnt(0)
v_or_b32_e64 v12, v144, v145
v_pk_mul_f16 v13, v155, v154
v_fmac_f32 v156, v207, v207
v_pk_mul_f16 v14, v152, v151
v_pk_mul_f16 v15, v149, v148
s_setprio 1
ds_read_b128 v[236:239], v248 offset:38912
v_mfma_f32_32x32x16_f16 v[192:207], v[8:11], v[240:243], 0
v_cvt_pkrtz_f16_f32 v137, v120, v121
v_cvt_pkrtz_f16_f32 v139, v122, v123
v_cvt_pkrtz_f16_f32 v141, v124, v125
v_cvt_pkrtz_f16_f32 v143, v126, v127
v_mfma_f32_32x32x16_f16 v[192:207], v[12:15], v[244:247], v[192:207]
v_cvt_pkrtz_f16_f32 v145, v128, v129
v_cvt_pkrtz_f16_f32 v147, v130, v131
v_cvt_pk_f16_f32 v155, v132, v133
v_cvt_pk_f16_f32 v152, v134, v135
v_pk_fma_f16 v154, v155, v155, s48
v_mfma_f32_32x32x16_bf16 v[120:135], v[224:227], v[168:171], 0
v_and_b32_e64 v137, s49, v137
v_pk_fma_f16 v151, v152, v152, s48
v_and_b32_e64 v139, s49, v139
v_pk_mul_f16 v154, v155, v154
v_bfe_u32 v136, v137, 2, 14
v_pk_mul_f16 v151, v152, v151
v_bfe_u32 v138, v139, 2, 14
v_exp_f16 v153, v154
v_fmac_f32 v157, v192, v192
ds_read_b128 v[224:227], v248 offset:36864
ds_read_u16_d16 v136, v136
ds_read_u16_d16 v138, v138
v_mfma_f32_32x32x16_bf16 v[120:135], v[228:231], v[172:175], v[120:135]
v_lshrrev_b32 v137, 18, v137
v_fmac_f32 v157, v193, v193
v_exp_f16 v150, v151
v_fmac_f32 v157, v194, v194
v_lshrrev_b32 v139, 18, v139
v_and_b32 v141, s49, v141
v_fmac_f32_e64 v157, v195, v195
v_exp_f16_sdwa v153, v154 dst_sel:WORD_1 dst_unused:UNUSED_PRESERVE src0_sel:WORD_1
ds_read_b128 v[228:231], v248 offset:39936
ds_read_u16_d16_hi v137, v137
ds_read_u16_d16_hi v139, v139
v_mfma_f32_32x32x16_bf16 v[120:135], v[232:235], v[176:179], v[120:135]
v_fmac_f32 v157, v196, v196
v_and_b32 v143, s49, v143
v_bfe_u32 v140, v141, 2, 14
v_fmac_f32_e64 v157, v197, v197
v_exp_f16_sdwa v150, v151 dst_sel:WORD_1 dst_unused:UNUSED_PRESERVE src0_sel:WORD_1
v_fmac_f32_e64 v157, v198, v198
v_bfe_u32 v142, v143, 2, 14
v_pk_add_f16 v153, v153, 1.0 op_sel_hi:[1,0]
v_fmac_f32 v157, v199, v199
s_waitcnt lgkmcnt(5)
ds_read_b128 v[232:235], v248 offset:40960
ds_read_u16_d16 v140, v140
ds_read_u16_d16 v142, v142
v_mfma_f32_32x32x16_bf16 v[120:135], v[236:239], v[180:183], v[120:135]
v_lshrrev_b32_e64 v141, 18, v141
v_pk_add_f16 v150, v150, 1.0 op_sel_hi:[1,0]
v_fmac_f32 v157, v200, v200
v_lshrrev_b32 v143, 18, v143
v_rcp_f16 v154, v153
v_fmac_f32 v157, v201, v201
v_and_b32 v145, s49, v145
v_and_b32 v147, s49, v147
v_fmac_f32_e64 v157, v202, v202
ds_read_b128 v[236:239], v248 offset:44032
ds_read_u16_d16_hi v141, v141
ds_read_u16_d16_hi v143, v143
v_mfma_f32_32x32x16_bf16 v[120:135], v[224:227], v[184:187], v[120:135]
v_rcp_f16 v151, v150
v_fmac_f32 v157, v203, v203
v_bfe_u32 v144, v145, 2, 14
s_setprio 0
v_rcp_f16_sdwa v154, v153 dst_sel:WORD_1 dst_unused:UNUSED_PRESERVE src0_sel:WORD_1
v_fmac_f32 v157, v204, v204
v_bfe_u32 v146, v147, 2, 14
v_fmac_f32_e64 v157, v205, v205
v_lshrrev_b32 v145, 18, v145
s_waitcnt lgkmcnt(4)
ds_read_b128 v[224:227], v248 offset:41984
ds_read_u16_d16 v144, v144
ds_read_u16_d16 v146, v146
ds_read_u16_d16_hi v145, v145
v_mfma_f32_32x32x16_bf16 v[120:135], v[228:231], v[188:191], v[120:135]
v_rcp_f16_sdwa v151, v150 dst_sel:WORD_1 dst_unused:UNUSED_PRESERVE src0_sel:WORD_1
v_fmac_f32 v157, v206, v206
v_lshrrev_b32 v147, 18, v147
v_fmac_f32 v157, v207, v207
v_or_b32 v16, v136, v137
v_or_b32 v17, v138, v139
v_permlane32_swap_b32 v156, v157
s_waitcnt lgkmcnt(5)
v_or_b32 v18, v140, v141
s_waitcnt lgkmcnt(4)
v_or_b32 v19, v142, v143
s_waitcnt lgkmcnt(0)
v_or_b32 v20, v144, v145
ds_read_u16_d16_hi v147, v147
s_waitcnt lgkmcnt(0)
v_or_b32 v21, v146, v147
v_add_f32_e64 v156, v156, v157
ds_write_b32 v255, v156 offset:7168
v_pk_mul_f16 v22, v155, v154
v_pk_mul_f16 v23, v152, v151
s_cmp_lg_u32 s40, 0
s_cbranch_scc1 Lrs1
v_mov_b32 v90, 0
Lpi:
s_waitcnt vmcnt(0)
v_readfirstlane_b32 s43, v91
s_cmp_eq_u32 s76, 0
s_cbranch_scc1 Lpix
s_sub_u32 s76, s76, 1
s_cmp_ge_u32 s43, 256
s_cbranch_scc1 Lpix
buffer_load_dword v91, v90, s[36:39], 0 offen sc1
s_branch Lpi
Lpix:
v_min_u32_e64 v88, 47, v251
v_lshlrev_b32 v88, 3, v88
s_and_b32 s44, s2, 7
s_lshl_b32 s44, s44, 11
s_add_u32 s44, s44, 394752
buffer_load_dwordx2 v[92:93], v88, s[32:35], s44 offen sc1
Lrs1:
s_setprio 2
ds_read_b128 v[228:231], v248 offset:45056
v_mfma_f32_32x32x16_f16 v[192:207], v[16:19], v[240:243], 0
v_cvt_pkrtz_f16_f32 v137, v120, v121
v_cvt_pkrtz_f16_f32 v139, v122, v123
v_cvt_pkrtz_f16_f32 v141, v124, v125
v_cvt_pkrtz_f16_f32 v143, v126, v127
v_cvt_pkrtz_f16_f32 v145, v128, v129
v_mfma_f32_32x32x16_f16 v[192:207], v[20:23], v[244:247], v[192:207]
v_cvt_pk_f16_f32 v155, v130, v131
v_cvt_pk_f16_f32 v152, v132, v133
v_cvt_pk_f16_f32 v149, v134, v135
v_pk_fma_f16 v154, v155, v155, s48
v_and_b32_e64 v137, s49, v137
v_mfma_f32_32x32x16_bf16 v[120:135], v[232:235], v[168:171], 0
v_pk_fma_f16 v151, v152, v152, s48
v_and_b32_e64 v139, s49, v139
v_pk_fma_f16 v148, v149, v149, s48
v_pk_mul_f16 v154, v155, v154
v_bfe_u32 v136, v137, 2, 14
v_pk_mul_f16 v151, v152, v151
v_pk_mul_f16 v148, v149, v148
v_bfe_u32 v138, v139, 2, 14
v_fmac_f32 v158, v192, v192
v_exp_f16 v153, v154
ds_read_b128 v[232:235], v248 offset:43008
ds_read_u16_d16 v136, v136
ds_read_u16_d16 v138, v138
v_mfma_f32_32x32x16_bf16 v[120:135], v[236:239], v[172:175], v[120:135]
v_fmac_f32 v158, v193, v193
v_lshrrev_b32 v137, 18, v137
v_exp_f16 v150, v151
v_fmac_f32 v158, v194, v194
v_lshrrev_b32 v139, 18, v139
v_exp_f16 v147, v148
v_fmac_f32 v158, v195, v195
v_and_b32 v141, s49, v141
ds_read_b128 v[236:239], v248 offset:46080
ds_read_u16_d16_hi v137, v137
ds_read_u16_d16_hi v139, v139
v_mfma_f32_32x32x16_bf16 v[120:135], v[224:227], v[176:179], v[120:135]
v_and_b32_e64 v143, s49, v143
v_exp_f16_sdwa v153, v154 dst_sel:WORD_1 dst_unused:UNUSED_PRESERVE src0_sel:WORD_1
v_fmac_f32_e64 v158, v196, v196
v_bfe_u32 v140, v141, 2, 14
v_exp_f16_sdwa v150, v151 dst_sel:WORD_1 dst_unused:UNUSED_PRESERVE src0_sel:WORD_1
v_fmac_f32 v158, v197, v197
v_bfe_u32 v142, v143, 2, 14
v_exp_f16_sdwa v147, v148 dst_sel:WORD_1 dst_unused:UNUSED_PRESERVE src0_sel:WORD_1
s_waitcnt lgkmcnt(6)
ds_read_b128 v[224:227], v248 offset:47104
ds_read_u16_d16 v140, v140
ds_read_u16_d16 v142, v142
v_mfma_f32_32x32x16_bf16 v[120:135], v[228:231], v[180:183], v[120:135]
v_fmac_f32 v158, v198, v198
v_lshrrev_b32 v141, 18, v141
v_pk_add_f16 v153, v153, 1.0 op_sel_hi:[1,0]
v_fmac_f32 v158, v199, v199
v_lshrrev_b32 v143, 18, v143
v_pk_add_f16 v150, v150, 1.0 op_sel_hi:[1,0]
v_pk_add_f16 v147, v147, 1.0 op_sel_hi:[1,0]
v_fmac_f32_e64 v158, v200, v200
v_and_b32 v145, s49, v145
s_waitcnt lgkmcnt(4)
ds_read_b128 v[228:231], v248 offset:50176
ds_read_u16_d16_hi v141, v141
ds_read_u16_d16_hi v143, v143
v_mfma_f32_32x32x16_bf16 v[120:135], v[232:235], v[184:187], v[120:135]
v_rcp_f16 v154, v153
v_fmac_f32 v158, v201, v201
v_bfe_u32 v144, v145, 2, 14
v_rcp_f16 v151, v150
v_fmac_f32 v158, v202, v202
v_lshrrev_b32 v145, 18, v145
v_rcp_f16 v148, v147
v_fmac_f32 v158, v203, v203
v_or_b32 v24, v136, v137
ds_read_b128 v[232:235], v248 offset:48128
ds_read_u16_d16 v144, v144
ds_read_u16_d16_hi v145, v145
v_mfma_f32_32x32x16_bf16 v[120:135], v[236:239], v[188:191], v[120:135]
s_waitcnt lgkmcnt(6)
v_or_b32 v25, v138, v139
v_rcp_f16_sdwa v154, v153 dst_sel:WORD_1 dst_unused:UNUSED_PRESERVE src0_sel:WORD_1
v_fmac_f32 v158, v204, v204
s_waitcnt lgkmcnt(4)
v_or_b32_e64 v26, v140, v141
v_rcp_f16_sdwa v151, v150 dst_sel:WORD_1 dst_unused:UNUSED_PRESERVE src0_sel:WORD_1
v_fmac_f32 v158, v205, v205
s_waitcnt lgkmcnt(3)
v_or_b32_e64 v27, v142, v143
v_rcp_f16_sdwa v148, v147 dst_sel:WORD_1 dst_unused:UNUSED_PRESERVE src0_sel:WORD_1
v_fmac_f32 v158, v206, v206
s_waitcnt lgkmcnt(0)
v_or_b32_e64 v28, v144, v145
v_pk_mul_f16 v29, v155, v154
v_fmac_f32 v158, v207, v207
v_pk_mul_f16 v30, v152, v151
v_pk_mul_f16 v31, v149, v148
s_setprio 1
ds_read_b128 v[236:239], v248 offset:51200
v_mfma_f32_32x32x16_f16 v[192:207], v[24:27], v[240:243], 0
v_cvt_pkrtz_f16_f32 v137, v120, v121
v_cvt_pkrtz_f16_f32 v139, v122, v123
v_cvt_pkrtz_f16_f32 v141, v124, v125
v_cvt_pkrtz_f16_f32 v143, v126, v127
v_mfma_f32_32x32x16_f16 v[192:207], v[28:31], v[244:247], v[192:207]
v_cvt_pkrtz_f16_f32 v145, v128, v129
v_cvt_pkrtz_f16_f32 v147, v130, v131
v_cvt_pk_f16_f32 v155, v132, v133
v_cvt_pk_f16_f32 v152, v134, v135
v_pk_fma_f16 v154, v155, v155, s48
v_mfma_f32_32x32x16_bf16 v[120:135], v[224:227], v[168:171], 0
v_and_b32_e64 v137, s49, v137
v_pk_fma_f16 v151, v152, v152, s48
v_and_b32_e64 v139, s49, v139
v_pk_mul_f16 v154, v155, v154
v_bfe_u32 v136, v137, 2, 14
v_pk_mul_f16 v151, v152, v151
v_bfe_u32 v138, v139, 2, 14
v_exp_f16 v153, v154
v_fmac_f32 v159, v192, v192
ds_read_b128 v[224:227], v248 offset:49152
ds_read_u16_d16 v136, v136
ds_read_u16_d16 v138, v138
v_mfma_f32_32x32x16_bf16 v[120:135], v[228:231], v[172:175], v[120:135]
v_lshrrev_b32 v137, 18, v137
v_fmac_f32 v159, v193, v193
v_exp_f16 v150, v151
v_fmac_f32 v159, v194, v194
v_lshrrev_b32 v139, 18, v139
v_and_b32 v141, s49, v141
v_fmac_f32_e64 v159, v195, v195
v_exp_f16_sdwa v153, v154 dst_sel:WORD_1 dst_unused:UNUSED_PRESERVE src0_sel:WORD_1
ds_read_b128 v[228:231], v248 offset:52224
ds_read_u16_d16_hi v137, v137
ds_read_u16_d16_hi v139, v139
v_mfma_f32_32x32x16_bf16 v[120:135], v[232:235], v[176:179], v[120:135]
v_fmac_f32 v159, v196, v196
v_and_b32 v143, s49, v143
v_bfe_u32 v140, v141, 2, 14
v_fmac_f32_e64 v159, v197, v197
v_exp_f16_sdwa v150, v151 dst_sel:WORD_1 dst_unused:UNUSED_PRESERVE src0_sel:WORD_1
v_fmac_f32_e64 v159, v198, v198
v_bfe_u32 v142, v143, 2, 14
v_pk_add_f16 v153, v153, 1.0 op_sel_hi:[1,0]
v_fmac_f32 v159, v199, v199
s_waitcnt lgkmcnt(5)
ds_read_b128 v[232:235], v248 offset:53248
ds_read_u16_d16 v140, v140
ds_read_u16_d16 v142, v142
v_mfma_f32_32x32x16_bf16 v[120:135], v[236:239], v[180:183], v[120:135]
v_lshrrev_b32_e64 v141, 18, v141
v_pk_add_f16 v150, v150, 1.0 op_sel_hi:[1,0]
v_fmac_f32 v159, v200, v200
v_lshrrev_b32 v143, 18, v143
v_rcp_f16 v154, v153
v_fmac_f32 v159, v201, v201
v_and_b32 v145, s49, v145
v_and_b32 v147, s49, v147
v_fmac_f32_e64 v159, v202, v202
ds_read_b128 v[236:239], v248 offset:56320
ds_read_u16_d16_hi v141, v141
ds_read_u16_d16_hi v143, v143
v_mfma_f32_32x32x16_bf16 v[120:135], v[224:227], v[184:187], v[120:135]
v_rcp_f16 v151, v150
v_fmac_f32 v159, v203, v203
v_bfe_u32 v144, v145, 2, 14
s_setprio 0
v_rcp_f16_sdwa v154, v153 dst_sel:WORD_1 dst_unused:UNUSED_PRESERVE src0_sel:WORD_1
v_fmac_f32 v159, v204, v204
v_bfe_u32 v146, v147, 2, 14
v_fmac_f32_e64 v159, v205, v205
v_lshrrev_b32 v145, 18, v145
s_waitcnt lgkmcnt(4)
ds_read_b128 v[224:227], v248 offset:54272
ds_read_u16_d16 v144, v144
ds_read_u16_d16 v146, v146
ds_read_u16_d16_hi v145, v145
v_mfma_f32_32x32x16_bf16 v[120:135], v[228:231], v[188:191], v[120:135]
v_rcp_f16_sdwa v151, v150 dst_sel:WORD_1 dst_unused:UNUSED_PRESERVE src0_sel:WORD_1
v_fmac_f32 v159, v206, v206
v_lshrrev_b32 v147, 18, v147
v_fmac_f32 v159, v207, v207
v_or_b32 v32, v136, v137
v_or_b32 v33, v138, v139
v_permlane32_swap_b32 v158, v159
s_waitcnt lgkmcnt(5)
v_or_b32 v34, v140, v141
s_waitcnt lgkmcnt(4)
v_or_b32 v35, v142, v143
s_waitcnt lgkmcnt(0)
v_or_b32 v36, v144, v145
ds_read_u16_d16_hi v147, v147
s_waitcnt lgkmcnt(0)
v_or_b32 v37, v146, v147
v_add_f32 v158, v158, v159
ds_write_b32 v255, v158 offset:7424
v_pk_mul_f16 v38, v155, v154
v_pk_mul_f16 v39, v152, v151
s_setprio 2
ds_read_b128 v[228:231], v248 offset:57344
v_mfma_f32_32x32x16_f16 v[192:207], v[32:35], v[240:243], 0
v_cvt_pkrtz_f16_f32 v137, v120, v121
v_cvt_pkrtz_f16_f32 v139, v122, v123
v_cvt_pkrtz_f16_f32 v141, v124, v125
v_cvt_pkrtz_f16_f32 v143, v126, v127
v_cvt_pkrtz_f16_f32 v145, v128, v129
v_mfma_f32_32x32x16_f16 v[192:207], v[36:39], v[244:247], v[192:207]
v_cvt_pk_f16_f32 v155, v130, v131
v_cvt_pk_f16_f32 v152, v132, v133
v_cvt_pk_f16_f32 v149, v134, v135
v_pk_fma_f16 v154, v155, v155, s48
v_and_b32_e64 v137, s49, v137
v_mfma_f32_32x32x16_bf16 v[120:135], v[232:235], v[168:171], 0
v_pk_fma_f16 v151, v152, v152, s48
v_and_b32_e64 v139, s49, v139
v_pk_fma_f16 v148, v149, v149, s48
v_pk_mul_f16 v154, v155, v154
v_bfe_u32 v136, v137, 2, 14
v_pk_mul_f16 v151, v152, v151
v_pk_mul_f16 v148, v149, v148
v_bfe_u32 v138, v139, 2, 14
v_fmac_f32 v160, v192, v192
v_exp_f16 v153, v154
ds_read_b128 v[232:235], v248 offset:55296
ds_read_u16_d16 v136, v136
ds_read_u16_d16 v138, v138
v_mfma_f32_32x32x16_bf16 v[120:135], v[236:239], v[172:175], v[120:135]
v_fmac_f32 v160, v193, v193
v_lshrrev_b32 v137, 18, v137
v_exp_f16 v150, v151
v_fmac_f32 v160, v194, v194
v_lshrrev_b32 v139, 18, v139
v_exp_f16 v147, v148
v_fmac_f32 v160, v195, v195
v_and_b32 v141, s49, v141
ds_read_b128 v[236:239], v248 offset:58368
ds_read_u16_d16_hi v137, v137
ds_read_u16_d16_hi v139, v139
v_mfma_f32_32x32x16_bf16 v[120:135], v[224:227], v[176:179], v[120:135]
v_and_b32_e64 v143, s49, v143
v_exp_f16_sdwa v153, v154 dst_sel:WORD_1 dst_unused:UNUSED_PRESERVE src0_sel:WORD_1
v_fmac_f32_e64 v160, v196, v196
v_bfe_u32 v140, v141, 2, 14
v_exp_f16_sdwa v150, v151 dst_sel:WORD_1 dst_unused:UNUSED_PRESERVE src0_sel:WORD_1
v_fmac_f32 v160, v197, v197
v_bfe_u32 v142, v143, 2, 14
v_exp_f16_sdwa v147, v148 dst_sel:WORD_1 dst_unused:UNUSED_PRESERVE src0_sel:WORD_1
s_waitcnt lgkmcnt(6)
ds_read_b128 v[224:227], v248 offset:59392
ds_read_u16_d16 v140, v140
ds_read_u16_d16 v142, v142
v_mfma_f32_32x32x16_bf16 v[120:135], v[228:231], v[180:183], v[120:135]
v_fmac_f32 v160, v198, v198
v_lshrrev_b32 v141, 18, v141
v_pk_add_f16 v153, v153, 1.0 op_sel_hi:[1,0]
v_fmac_f32 v160, v199, v199
v_lshrrev_b32 v143, 18, v143
v_pk_add_f16 v150, v150, 1.0 op_sel_hi:[1,0]
v_pk_add_f16 v147, v147, 1.0 op_sel_hi:[1,0]
v_fmac_f32_e64 v160, v200, v200
v_and_b32 v145, s49, v145
s_waitcnt lgkmcnt(4)
ds_read_b128 v[228:231], v248 offset:62464
ds_read_u16_d16_hi v141, v141
ds_read_u16_d16_hi v143, v143
v_mfma_f32_32x32x16_bf16 v[120:135], v[232:235], v[184:187], v[120:135]
v_rcp_f16 v154, v153
v_fmac_f32 v160, v201, v201
v_bfe_u32 v144, v145, 2, 14
v_rcp_f16 v151, v150
v_fmac_f32 v160, v202, v202
v_lshrrev_b32 v145, 18, v145
v_rcp_f16 v148, v147
v_fmac_f32 v160, v203, v203
v_or_b32 v40, v136, v137
ds_read_b128 v[232:235], v248 offset:60416
ds_read_u16_d16 v144, v144
ds_read_u16_d16_hi v145, v145
v_mfma_f32_32x32x16_bf16 v[120:135], v[236:239], v[188:191], v[120:135]
s_waitcnt lgkmcnt(6)
v_or_b32 v41, v138, v139
v_rcp_f16_sdwa v154, v153 dst_sel:WORD_1 dst_unused:UNUSED_PRESERVE src0_sel:WORD_1
v_fmac_f32 v160, v204, v204
s_waitcnt lgkmcnt(4)
v_or_b32_e64 v42, v140, v141
v_rcp_f16_sdwa v151, v150 dst_sel:WORD_1 dst_unused:UNUSED_PRESERVE src0_sel:WORD_1
v_fmac_f32 v160, v205, v205
s_waitcnt lgkmcnt(3)
v_or_b32_e64 v43, v142, v143
v_rcp_f16_sdwa v148, v147 dst_sel:WORD_1 dst_unused:UNUSED_PRESERVE src0_sel:WORD_1
v_fmac_f32 v160, v206, v206
s_waitcnt lgkmcnt(0)
v_or_b32_e64 v44, v144, v145
v_pk_mul_f16 v45, v155, v154
v_fmac_f32_e64 v160, v207, v207
v_pk_mul_f16 v46, v152, v151
v_pk_mul_f16 v47, v149, v148
s_cmp_lg_u32 s40, 0
s_cbranch_scc1 Lrs2
v_min_u32 v88, 47, v251
v_lshlrev_b32 v88, 3, v88
v_add_u32 v89, 7936, v88
v_add_u32 v88, 15872, v88
v_cmp_gt_u32 vcc, 32, v251
s_nop 1
v_cndmask_b32 v88, v88, v89, vcc
s_waitcnt vmcnt(0)
ds_write_b64 v88, v[92:93]
Lrs2:
s_setprio 1
ds_read_b128 v[236:239], v248 offset:63488
v_mfma_f32_32x32x16_f16 v[192:207], v[40:43], v[240:243], 0
v_cvt_pkrtz_f16_f32 v137, v120, v121
v_cvt_pkrtz_f16_f32 v139, v122, v123
v_cvt_pkrtz_f16_f32 v141, v124, v125
v_cvt_pkrtz_f16_f32 v143, v126, v127
v_mfma_f32_32x32x16_f16 v[192:207], v[44:47], v[244:247], v[192:207]
s_waitcnt lgkmcnt(1)
v_cvt_pkrtz_f16_f32 v145, v128, v129
v_cvt_pkrtz_f16_f32 v147, v130, v131
v_cvt_pk_f16_f32 v155, v132, v133
v_cvt_pk_f16_f32 v152, v134, v135
v_pk_fma_f16 v154, v155, v155, s48
v_mfma_f32_32x32x16_bf16 v[120:135], v[224:227], v[168:171], 0
v_and_b32_e64 v137, s49, v137
v_pk_fma_f16 v151, v152, v152, s48
v_and_b32_e64 v139, s49, v139
v_pk_mul_f16 v154, v155, v154
v_bfe_u32 v136, v137, 2, 14
v_pk_mul_f16 v151, v152, v151
v_bfe_u32 v138, v139, 2, 14
v_exp_f16 v153, v154
v_fmac_f32 v161, v192, v192
ds_read_b128 v[224:227], v248 offset:61440
ds_read_u16_d16 v136, v136
ds_read_u16_d16 v138, v138
v_mfma_f32_32x32x16_bf16 v[120:135], v[228:231], v[172:175], v[120:135]
v_lshrrev_b32 v137, 18, v137
v_fmac_f32 v161, v193, v193
v_exp_f16 v150, v151
v_fmac_f32 v161, v194, v194
v_lshrrev_b32 v139, 18, v139
v_and_b32 v141, s49, v141
v_fmac_f32_e64 v161, v195, v195
v_exp_f16_sdwa v153, v154 dst_sel:WORD_1 dst_unused:UNUSED_PRESERVE src0_sel:WORD_1
ds_read_b128 v[228:231], v248 offset:64512
ds_read_u16_d16_hi v137, v137
ds_read_u16_d16_hi v139, v139
v_mfma_f32_32x32x16_bf16 v[120:135], v[232:235], v[176:179], v[120:135]
v_fmac_f32 v161, v196, v196
v_and_b32 v143, s49, v143
v_bfe_u32 v140, v141, 2, 14
v_fmac_f32_e64 v161, v197, v197
v_exp_f16_sdwa v150, v151 dst_sel:WORD_1 dst_unused:UNUSED_PRESERVE src0_sel:WORD_1
v_fmac_f32_e64 v161, v198, v198
v_bfe_u32 v142, v143, 2, 14
v_pk_add_f16 v153, v153, 1.0 op_sel_hi:[1,0]
v_fmac_f32 v161, v199, v199
s_waitcnt lgkmcnt(5)
ds_read_b128 v[232:235], v249
ds_read_u16_d16 v140, v140
ds_read_u16_d16 v142, v142
v_mfma_f32_32x32x16_bf16 v[120:135], v[236:239], v[180:183], v[120:135]
v_lshrrev_b32_e64 v141, 18, v141
v_pk_add_f16 v150, v150, 1.0 op_sel_hi:[1,0]
v_fmac_f32 v161, v200, v200
v_lshrrev_b32 v143, 18, v143
v_rcp_f16 v154, v153
v_fmac_f32 v161, v201, v201
v_and_b32 v145, s49, v145
v_and_b32 v147, s49, v147
v_fmac_f32_e64 v161, v202, v202
ds_read_b128 v[236:239], v249 offset:3072
ds_read_u16_d16_hi v141, v141
ds_read_u16_d16_hi v143, v143
v_mfma_f32_32x32x16_bf16 v[120:135], v[224:227], v[184:187], v[120:135]
v_rcp_f16 v151, v150
v_fmac_f32 v161, v203, v203
v_bfe_u32 v144, v145, 2, 14
s_setprio 0
v_rcp_f16_sdwa v154, v153 dst_sel:WORD_1 dst_unused:UNUSED_PRESERVE src0_sel:WORD_1
v_fmac_f32 v161, v204, v204
v_bfe_u32 v146, v147, 2, 14
v_fmac_f32_e64 v161, v205, v205
v_lshrrev_b32 v145, 18, v145
s_waitcnt lgkmcnt(4)
ds_read_b128 v[224:227], v249 offset:1024
ds_read_u16_d16 v144, v144
ds_read_u16_d16 v146, v146
ds_read_u16_d16_hi v145, v145
v_mfma_f32_32x32x16_bf16 v[120:135], v[228:231], v[188:191], v[120:135]
v_rcp_f16_sdwa v151, v150 dst_sel:WORD_1 dst_unused:UNUSED_PRESERVE src0_sel:WORD_1
v_fmac_f32 v161, v206, v206
v_lshrrev_b32 v147, 18, v147
v_fmac_f32 v161, v207, v207
v_or_b32 v48, v136, v137
v_or_b32 v49, v138, v139
v_permlane32_swap_b32 v160, v161
s_waitcnt lgkmcnt(5)
v_or_b32 v50, v140, v141
s_waitcnt lgkmcnt(4)
v_or_b32 v51, v142, v143
s_waitcnt lgkmcnt(0)
v_or_b32 v52, v144, v145
ds_read_u16_d16_hi v147, v147
s_waitcnt lgkmcnt(0)
v_or_b32 v53, v146, v147
v_add_f32 v160, v160, v161
ds_write_b32 v255, v160 offset:7680
v_pk_mul_f16 v54, v155, v154
v_pk_mul_f16 v55, v152, v151
s_setprio 2
ds_read_b128 v[228:231], v249 offset:4096
v_mfma_f32_32x32x16_f16 v[192:207], v[48:51], v[240:243], 0
v_cvt_pkrtz_f16_f32 v137, v120, v121
v_cvt_pkrtz_f16_f32 v139, v122, v123
v_cvt_pkrtz_f16_f32 v141, v124, v125
v_cvt_pkrtz_f16_f32 v143, v126, v127
v_cvt_pkrtz_f16_f32 v145, v128, v129
v_mfma_f32_32x32x16_f16 v[192:207], v[52:55], v[244:247], v[192:207]
v_cvt_pk_f16_f32 v155, v130, v131
v_cvt_pk_f16_f32 v152, v132, v133
v_cvt_pk_f16_f32 v149, v134, v135
v_pk_fma_f16 v154, v155, v155, s48
v_and_b32_e64 v137, s49, v137
v_mfma_f32_32x32x16_bf16 v[120:135], v[232:235], v[168:171], 0
v_pk_fma_f16 v151, v152, v152, s48
v_and_b32_e64 v139, s49, v139
v_pk_fma_f16 v148, v149, v149, s48
v_pk_mul_f16 v154, v155, v154
v_bfe_u32 v136, v137, 2, 14
v_pk_mul_f16 v151, v152, v151
v_pk_mul_f16 v148, v149, v148
v_bfe_u32 v138, v139, 2, 14
v_fmac_f32 v162, v192, v192
v_exp_f16 v153, v154
ds_read_b128 v[232:235], v249 offset:2048
ds_read_u16_d16 v136, v136
ds_read_u16_d16 v138, v138
v_mfma_f32_32x32x16_bf16 v[120:135], v[236:239], v[172:175], v[120:135]
v_fmac_f32 v162, v193, v193
v_lshrrev_b32 v137, 18, v137
v_exp_f16 v150, v151
v_fmac_f32 v162, v194, v194
v_lshrrev_b32 v139, 18, v139
v_exp_f16 v147, v148
v_fmac_f32 v162, v195, v195
v_and_b32 v141, s49, v141
ds_read_b128 v[236:239], v249 offset:5120
ds_read_u16_d16_hi v137, v137
ds_read_u16_d16_hi v139, v139
v_mfma_f32_32x32x16_bf16 v[120:135], v[224:227], v[176:179], v[120:135]
v_and_b32_e64 v143, s49, v143
v_exp_f16_sdwa v153, v154 dst_sel:WORD_1 dst_unused:UNUSED_PRESERVE src0_sel:WORD_1
v_fmac_f32_e64 v162, v196, v196
v_bfe_u32 v140, v141, 2, 14
v_exp_f16_sdwa v150, v151 dst_sel:WORD_1 dst_unused:UNUSED_PRESERVE src0_sel:WORD_1
v_fmac_f32 v162, v197, v197
v_bfe_u32 v142, v143, 2, 14
v_exp_f16_sdwa v147, v148 dst_sel:WORD_1 dst_unused:UNUSED_PRESERVE src0_sel:WORD_1
s_waitcnt lgkmcnt(6)
ds_read_b128 v[224:227], v249 offset:6144
ds_read_u16_d16 v140, v140
ds_read_u16_d16 v142, v142
v_mfma_f32_32x32x16_bf16 v[120:135], v[228:231], v[180:183], v[120:135]
v_fmac_f32 v162, v198, v198
v_lshrrev_b32 v141, 18, v141
v_pk_add_f16 v153, v153, 1.0 op_sel_hi:[1,0]
v_fmac_f32 v162, v199, v199
v_lshrrev_b32 v143, 18, v143
v_pk_add_f16 v150, v150, 1.0 op_sel_hi:[1,0]
v_pk_add_f16 v147, v147, 1.0 op_sel_hi:[1,0]
v_fmac_f32_e64 v162, v200, v200
v_and_b32 v145, s49, v145
s_waitcnt lgkmcnt(4)
ds_read_b128 v[228:231], v249 offset:9216
ds_read_u16_d16_hi v141, v141
ds_read_u16_d16_hi v143, v143
v_mfma_f32_32x32x16_bf16 v[120:135], v[232:235], v[184:187], v[120:135]
v_rcp_f16 v154, v153
v_fmac_f32 v162, v201, v201
v_bfe_u32 v144, v145, 2, 14
v_rcp_f16 v151, v150
v_fmac_f32 v162, v202, v202
v_lshrrev_b32 v145, 18, v145
v_rcp_f16 v148, v147
v_fmac_f32 v162, v203, v203
v_or_b32 v56, v136, v137
ds_read_b128 v[232:235], v249 offset:7168
ds_read_u16_d16 v144, v144
ds_read_u16_d16_hi v145, v145
v_mfma_f32_32x32x16_bf16 v[120:135], v[236:239], v[188:191], v[120:135]
s_waitcnt lgkmcnt(6)
v_or_b32 v57, v138, v139
v_rcp_f16_sdwa v154, v153 dst_sel:WORD_1 dst_unused:UNUSED_PRESERVE src0_sel:WORD_1
v_fmac_f32 v162, v204, v204
s_waitcnt lgkmcnt(4)
v_or_b32_e64 v58, v140, v141
v_rcp_f16_sdwa v151, v150 dst_sel:WORD_1 dst_unused:UNUSED_PRESERVE src0_sel:WORD_1
v_fmac_f32 v162, v205, v205
s_waitcnt lgkmcnt(3)
v_or_b32_e64 v59, v142, v143
v_rcp_f16_sdwa v148, v147 dst_sel:WORD_1 dst_unused:UNUSED_PRESERVE src0_sel:WORD_1
v_fmac_f32 v162, v206, v206
s_waitcnt lgkmcnt(0)
v_or_b32_e64 v60, v144, v145
v_pk_mul_f16 v61, v155, v154
v_fmac_f32 v162, v207, v207
v_pk_mul_f16 v62, v152, v151
v_pk_mul_f16 v63, v149, v148
s_setprio 1
ds_read_b128 v[236:239], v249 offset:10240
v_mfma_f32_32x32x16_f16 v[192:207], v[56:59], v[240:243], 0
v_cvt_pkrtz_f16_f32 v137, v120, v121
v_cvt_pkrtz_f16_f32 v139, v122, v123
v_cvt_pkrtz_f16_f32 v141, v124, v125
v_cvt_pkrtz_f16_f32 v143, v126, v127
v_mfma_f32_32x32x16_f16 v[192:207], v[60:63], v[244:247], v[192:207]
v_cvt_pkrtz_f16_f32 v145, v128, v129
v_cvt_pkrtz_f16_f32 v147, v130, v131
v_cvt_pk_f16_f32 v155, v132, v133
v_cvt_pk_f16_f32 v152, v134, v135
v_pk_fma_f16 v154, v155, v155, s48
v_mfma_f32_32x32x16_bf16 v[120:135], v[224:227], v[168:171], 0
v_and_b32_e64 v137, s49, v137
v_pk_fma_f16 v151, v152, v152, s48
v_and_b32_e64 v139, s49, v139
v_pk_mul_f16 v154, v155, v154
v_bfe_u32 v136, v137, 2, 14
v_pk_mul_f16 v151, v152, v151
v_bfe_u32 v138, v139, 2, 14
v_exp_f16 v153, v154
v_fmac_f32 v163, v192, v192
ds_read_b128 v[224:227], v249 offset:8192
ds_read_u16_d16 v136, v136
ds_read_u16_d16 v138, v138
v_mfma_f32_32x32x16_bf16 v[120:135], v[228:231], v[172:175], v[120:135]
v_lshrrev_b32 v137, 18, v137
v_fmac_f32 v163, v193, v193
v_exp_f16 v150, v151
v_fmac_f32 v163, v194, v194
v_lshrrev_b32 v139, 18, v139
v_and_b32 v141, s49, v141
v_fmac_f32_e64 v163, v195, v195
v_exp_f16_sdwa v153, v154 dst_sel:WORD_1 dst_unused:UNUSED_PRESERVE src0_sel:WORD_1
ds_read_b128 v[228:231], v249 offset:11264
ds_read_u16_d16_hi v137, v137
ds_read_u16_d16_hi v139, v139
v_mfma_f32_32x32x16_bf16 v[120:135], v[232:235], v[176:179], v[120:135]
v_fmac_f32 v163, v196, v196
v_and_b32 v143, s49, v143
v_bfe_u32 v140, v141, 2, 14
v_fmac_f32_e64 v163, v197, v197
v_exp_f16_sdwa v150, v151 dst_sel:WORD_1 dst_unused:UNUSED_PRESERVE src0_sel:WORD_1
v_fmac_f32_e64 v163, v198, v198
v_bfe_u32 v142, v143, 2, 14
v_pk_add_f16 v153, v153, 1.0 op_sel_hi:[1,0]
v_fmac_f32 v163, v199, v199
s_waitcnt lgkmcnt(5)
ds_read_b128 v[232:235], v249 offset:12288
ds_read_u16_d16 v140, v140
ds_read_u16_d16 v142, v142
v_mfma_f32_32x32x16_bf16 v[120:135], v[236:239], v[180:183], v[120:135]
v_lshrrev_b32_e64 v141, 18, v141
v_pk_add_f16 v150, v150, 1.0 op_sel_hi:[1,0]
v_fmac_f32 v163, v200, v200
v_lshrrev_b32 v143, 18, v143
v_rcp_f16 v154, v153
v_fmac_f32 v163, v201, v201
v_and_b32 v145, s49, v145
v_and_b32 v147, s49, v147
v_fmac_f32_e64 v163, v202, v202
ds_read_b128 v[236:239], v249 offset:15360
ds_read_u16_d16_hi v141, v141
ds_read_u16_d16_hi v143, v143
v_mfma_f32_32x32x16_bf16 v[120:135], v[224:227], v[184:187], v[120:135]
v_rcp_f16 v151, v150
v_fmac_f32 v163, v203, v203
v_bfe_u32 v144, v145, 2, 14
s_setprio 0
v_rcp_f16_sdwa v154, v153 dst_sel:WORD_1 dst_unused:UNUSED_PRESERVE src0_sel:WORD_1
v_fmac_f32 v163, v204, v204
v_bfe_u32 v146, v147, 2, 14
v_fmac_f32_e64 v163, v205, v205
v_lshrrev_b32 v145, 18, v145
s_waitcnt lgkmcnt(4)
ds_read_b128 v[224:227], v249 offset:13312
ds_read_u16_d16 v144, v144
ds_read_u16_d16 v146, v146
ds_read_u16_d16_hi v145, v145
v_mfma_f32_32x32x16_bf16 v[120:135], v[228:231], v[188:191], v[120:135]
v_rcp_f16_sdwa v151, v150 dst_sel:WORD_1 dst_unused:UNUSED_PRESERVE src0_sel:WORD_1
v_fmac_f32 v163, v206, v206
v_lshrrev_b32 v147, 18, v147
v_fmac_f32 v163, v207, v207
v_or_b32 v64, v136, v137
v_or_b32 v65, v138, v139
v_permlane32_swap_b32 v162, v163
s_waitcnt lgkmcnt(5)
v_or_b32 v66, v140, v141
s_waitcnt lgkmcnt(4)
v_or_b32 v67, v142, v143
s_waitcnt lgkmcnt(0)
v_or_b32 v68, v144, v145
ds_read_u16_d16_hi v147, v147
s_waitcnt lgkmcnt(0)
v_or_b32 v69, v146, v147
v_add_f32 v162, v162, v163
ds_write_b32 v255, v162 offset:7936
v_pk_mul_f16 v70, v155, v154
v_pk_mul_f16 v71, v152, v151
s_setprio 2
ds_read_b128 v[228:231], v249 offset:16384
v_mfma_f32_32x32x16_f16 v[192:207], v[64:67], v[240:243], 0
v_cvt_pkrtz_f16_f32 v137, v120, v121
v_cvt_pkrtz_f16_f32 v139, v122, v123
v_cvt_pkrtz_f16_f32 v141, v124, v125
v_cvt_pkrtz_f16_f32 v143, v126, v127
v_cvt_pkrtz_f16_f32 v145, v128, v129
v_mfma_f32_32x32x16_f16 v[192:207], v[68:71], v[244:247], v[192:207]
v_cvt_pk_f16_f32 v155, v130, v131
v_cvt_pk_f16_f32 v152, v132, v133
v_cvt_pk_f16_f32 v149, v134, v135
v_pk_fma_f16 v154, v155, v155, s48
v_and_b32_e64 v137, s49, v137
v_mfma_f32_32x32x16_bf16 v[120:135], v[232:235], v[168:171], 0
v_pk_fma_f16 v151, v152, v152, s48
v_and_b32_e64 v139, s49, v139
v_pk_fma_f16 v148, v149, v149, s48
v_pk_mul_f16 v154, v155, v154
v_bfe_u32 v136, v137, 2, 14
v_pk_mul_f16 v151, v152, v151
v_pk_mul_f16 v148, v149, v148
v_bfe_u32 v138, v139, 2, 14
v_fmac_f32 v164, v192, v192
v_exp_f16 v153, v154
ds_read_b128 v[232:235], v249 offset:14336
ds_read_u16_d16 v136, v136
ds_read_u16_d16 v138, v138
v_mfma_f32_32x32x16_bf16 v[120:135], v[236:239], v[172:175], v[120:135]
v_fmac_f32 v164, v193, v193
v_lshrrev_b32 v137, 18, v137
v_exp_f16 v150, v151
v_fmac_f32 v164, v194, v194
v_lshrrev_b32 v139, 18, v139
v_exp_f16 v147, v148
v_fmac_f32 v164, v195, v195
v_and_b32 v141, s49, v141
ds_read_b128 v[236:239], v249 offset:17408
ds_read_u16_d16_hi v137, v137
ds_read_u16_d16_hi v139, v139
v_mfma_f32_32x32x16_bf16 v[120:135], v[224:227], v[176:179], v[120:135]
v_and_b32_e64 v143, s49, v143
v_exp_f16_sdwa v153, v154 dst_sel:WORD_1 dst_unused:UNUSED_PRESERVE src0_sel:WORD_1
v_fmac_f32_e64 v164, v196, v196
v_bfe_u32 v140, v141, 2, 14
v_exp_f16_sdwa v150, v151 dst_sel:WORD_1 dst_unused:UNUSED_PRESERVE src0_sel:WORD_1
v_fmac_f32 v164, v197, v197
v_bfe_u32 v142, v143, 2, 14
v_exp_f16_sdwa v147, v148 dst_sel:WORD_1 dst_unused:UNUSED_PRESERVE src0_sel:WORD_1
s_waitcnt lgkmcnt(6)
ds_read_b128 v[224:227], v249 offset:18432
ds_read_u16_d16 v140, v140
ds_read_u16_d16 v142, v142
v_mfma_f32_32x32x16_bf16 v[120:135], v[228:231], v[180:183], v[120:135]
v_fmac_f32 v164, v198, v198
v_lshrrev_b32 v141, 18, v141
v_pk_add_f16 v153, v153, 1.0 op_sel_hi:[1,0]
v_fmac_f32 v164, v199, v199
v_lshrrev_b32 v143, 18, v143
v_pk_add_f16 v150, v150, 1.0 op_sel_hi:[1,0]
v_pk_add_f16 v147, v147, 1.0 op_sel_hi:[1,0]
v_fmac_f32_e64 v164, v200, v200
v_and_b32 v145, s49, v145
s_waitcnt lgkmcnt(4)
ds_read_b128 v[228:231], v249 offset:21504
ds_read_u16_d16_hi v141, v141
ds_read_u16_d16_hi v143, v143
v_mfma_f32_32x32x16_bf16 v[120:135], v[232:235], v[184:187], v[120:135]
v_rcp_f16 v154, v153
v_fmac_f32 v164, v201, v201
v_bfe_u32 v144, v145, 2, 14
v_rcp_f16 v151, v150
v_fmac_f32 v164, v202, v202
v_lshrrev_b32 v145, 18, v145
v_rcp_f16 v148, v147
v_fmac_f32 v164, v203, v203
v_or_b32 v72, v136, v137
ds_read_b128 v[232:235], v249 offset:19456
ds_read_u16_d16 v144, v144
ds_read_u16_d16_hi v145, v145
v_mfma_f32_32x32x16_bf16 v[120:135], v[236:239], v[188:191], v[120:135]
s_waitcnt lgkmcnt(6)
v_or_b32 v73, v138, v139
v_rcp_f16_sdwa v154, v153 dst_sel:WORD_1 dst_unused:UNUSED_PRESERVE src0_sel:WORD_1
v_fmac_f32 v164, v204, v204
s_waitcnt lgkmcnt(4)
v_or_b32_e64 v74, v140, v141
v_rcp_f16_sdwa v151, v150 dst_sel:WORD_1 dst_unused:UNUSED_PRESERVE src0_sel:WORD_1
v_fmac_f32 v164, v205, v205
s_waitcnt lgkmcnt(3)
v_or_b32_e64 v75, v142, v143
v_rcp_f16_sdwa v148, v147 dst_sel:WORD_1 dst_unused:UNUSED_PRESERVE src0_sel:WORD_1
v_fmac_f32 v164, v206, v206
s_waitcnt lgkmcnt(0)
v_or_b32_e64 v76, v144, v145
v_pk_mul_f16 v77, v155, v154
v_fmac_f32 v164, v207, v207
v_pk_mul_f16 v78, v152, v151
v_pk_mul_f16 v79, v149, v148
s_setprio 1
ds_read_b128 v[236:239], v249 offset:22528
v_mfma_f32_32x32x16_f16 v[192:207], v[72:75], v[240:243], 0
v_cvt_pkrtz_f16_f32 v137, v120, v121
v_cvt_pkrtz_f16_f32 v139, v122, v123
v_cvt_pkrtz_f16_f32 v141, v124, v125
v_cvt_pkrtz_f16_f32 v143, v126, v127
v_mfma_f32_32x32x16_f16 v[192:207], v[76:79], v[244:247], v[192:207]
v_cvt_pkrtz_f16_f32 v145, v128, v129
v_cvt_pkrtz_f16_f32 v147, v130, v131
v_cvt_pk_f16_f32 v155, v132, v133
v_cvt_pk_f16_f32 v152, v134, v135
v_pk_fma_f16 v154, v155, v155, s48
v_mfma_f32_32x32x16_bf16 v[120:135], v[224:227], v[168:171], 0
v_and_b32_e64 v137, s49, v137
v_pk_fma_f16 v151, v152, v152, s48
v_and_b32_e64 v139, s49, v139
v_pk_mul_f16 v154, v155, v154
v_bfe_u32 v136, v137, 2, 14
v_pk_mul_f16 v151, v152, v151
v_bfe_u32 v138, v139, 2, 14
v_exp_f16 v153, v154
v_fmac_f32 v165, v192, v192
ds_read_b128 v[224:227], v249 offset:20480
ds_read_u16_d16 v136, v136
ds_read_u16_d16 v138, v138
v_mfma_f32_32x32x16_bf16 v[120:135], v[228:231], v[172:175], v[120:135]
v_lshrrev_b32 v137, 18, v137
v_fmac_f32 v165, v193, v193
v_exp_f16 v150, v151
v_fmac_f32 v165, v194, v194
v_lshrrev_b32 v139, 18, v139
v_and_b32 v141, s49, v141
v_fmac_f32_e64 v165, v195, v195
v_exp_f16_sdwa v153, v154 dst_sel:WORD_1 dst_unused:UNUSED_PRESERVE src0_sel:WORD_1
ds_read_b128 v[228:231], v249 offset:23552
ds_read_u16_d16_hi v137, v137
ds_read_u16_d16_hi v139, v139
v_mfma_f32_32x32x16_bf16 v[120:135], v[232:235], v[176:179], v[120:135]
v_fmac_f32 v165, v196, v196
v_and_b32 v143, s49, v143
v_bfe_u32 v140, v141, 2, 14
v_fmac_f32_e64 v165, v197, v197
v_exp_f16_sdwa v150, v151 dst_sel:WORD_1 dst_unused:UNUSED_PRESERVE src0_sel:WORD_1
v_fmac_f32_e64 v165, v198, v198
v_bfe_u32 v142, v143, 2, 14
v_pk_add_f16 v153, v153, 1.0 op_sel_hi:[1,0]
v_fmac_f32 v165, v199, v199
s_waitcnt lgkmcnt(5)
ds_read_b128 v[232:235], v248 offset:40960
ds_read_u16_d16 v140, v140
ds_read_u16_d16 v142, v142
v_mfma_f32_32x32x16_bf16 v[120:135], v[236:239], v[180:183], v[120:135]
v_lshrrev_b32_e64 v141, 18, v141
v_pk_add_f16 v150, v150, 1.0 op_sel_hi:[1,0]
v_fmac_f32 v165, v200, v200
v_lshrrev_b32 v143, 18, v143
v_rcp_f16 v154, v153
v_fmac_f32 v165, v201, v201
v_and_b32 v145, s49, v145
v_and_b32 v147, s49, v147
v_fmac_f32_e64 v165, v202, v202
ds_read_b128 v[236:239], v248 offset:44032
ds_read_u16_d16_hi v141, v141
ds_read_u16_d16_hi v143, v143
v_mfma_f32_32x32x16_bf16 v[120:135], v[224:227], v[184:187], v[120:135]
v_rcp_f16 v151, v150
v_fmac_f32 v165, v203, v203
v_bfe_u32 v144, v145, 2, 14
s_setprio 0
v_rcp_f16_sdwa v154, v153 dst_sel:WORD_1 dst_unused:UNUSED_PRESERVE src0_sel:WORD_1
v_fmac_f32 v165, v204, v204
v_bfe_u32 v146, v147, 2, 14
v_fmac_f32_e64 v165, v205, v205
v_lshrrev_b32 v145, 18, v145
s_waitcnt lgkmcnt(4)
ds_read_b128 v[224:227], v248 offset:41984
ds_read_u16_d16 v144, v144
ds_read_u16_d16 v146, v146
ds_read_u16_d16_hi v145, v145
v_mfma_f32_32x32x16_bf16 v[120:135], v[228:231], v[188:191], v[120:135]
v_rcp_f16_sdwa v151, v150 dst_sel:WORD_1 dst_unused:UNUSED_PRESERVE src0_sel:WORD_1
v_fmac_f32 v165, v206, v206
v_lshrrev_b32 v147, 18, v147
v_fmac_f32 v165, v207, v207
v_or_b32 v80, v136, v137
v_or_b32 v81, v138, v139
v_permlane32_swap_b32 v164, v165
s_waitcnt lgkmcnt(5)
v_or_b32 v82, v140, v141
s_waitcnt lgkmcnt(4)
v_or_b32 v83, v142, v143
s_waitcnt lgkmcnt(0)
v_or_b32 v84, v144, v145
ds_read_u16_d16_hi v147, v147
s_waitcnt lgkmcnt(0)
v_or_b32 v85, v146, v147
v_add_f32 v164, v164, v165
ds_write_b32 v255, v164 offset:8192
v_pk_mul_f16 v86, v155, v154
v_pk_mul_f16 v87, v152, v151
s_setprio 2
ds_read_b128 v[228:231], v248 offset:45056
v_mfma_f32_32x32x16_f16 v[192:207], v[80:83], v[240:243], 0
v_cvt_pkrtz_f16_f32 v137, v120, v121
v_cvt_pkrtz_f16_f32 v139, v122, v123
v_cvt_pkrtz_f16_f32 v141, v124, v125
v_cvt_pkrtz_f16_f32 v143, v126, v127
v_cvt_pkrtz_f16_f32 v145, v128, v129
v_mfma_f32_32x32x16_f16 v[192:207], v[84:87], v[244:247], v[192:207]
v_cvt_pk_f16_f32 v155, v130, v131
v_cvt_pk_f16_f32 v152, v132, v133
v_cvt_pk_f16_f32 v149, v134, v135
v_pk_fma_f16 v154, v155, v155, s48
v_and_b32_e64 v137, s49, v137
v_mfma_f32_32x32x16_bf16 v[120:135], v[232:235], v[96:99], 0
v_pk_fma_f16 v151, v152, v152, s48
v_and_b32_e64 v139, s49, v139
v_pk_fma_f16 v148, v149, v149, s48
v_pk_mul_f16 v154, v155, v154
v_bfe_u32 v136, v137, 2, 14
v_pk_mul_f16 v151, v152, v151
v_pk_mul_f16 v148, v149, v148
v_bfe_u32 v138, v139, 2, 14
v_fmac_f32 v166, v192, v192
v_exp_f16 v153, v154
ds_read_b128 v[232:235], v248 offset:43008
ds_read_u16_d16 v136, v136
ds_read_u16_d16 v138, v138
v_mfma_f32_32x32x16_bf16 v[120:135], v[236:239], v[100:103], v[120:135]
v_fmac_f32 v166, v193, v193
v_lshrrev_b32 v137, 18, v137
v_exp_f16 v150, v151
v_fmac_f32 v166, v194, v194
v_lshrrev_b32 v139, 18, v139
v_exp_f16 v147, v148
v_fmac_f32 v166, v195, v195
v_and_b32 v141, s49, v141
ds_read_b128 v[236:239], v248 offset:46080
ds_read_u16_d16_hi v137, v137
ds_read_u16_d16_hi v139, v139
v_mfma_f32_32x32x16_bf16 v[120:135], v[224:227], v[104:107], v[120:135]
v_and_b32_e64 v143, s49, v143
v_exp_f16_sdwa v153, v154 dst_sel:WORD_1 dst_unused:UNUSED_PRESERVE src0_sel:WORD_1
v_fmac_f32_e64 v166, v196, v196
v_bfe_u32 v140, v141, 2, 14
v_exp_f16_sdwa v150, v151 dst_sel:WORD_1 dst_unused:UNUSED_PRESERVE src0_sel:WORD_1
v_fmac_f32 v166, v197, v197
v_bfe_u32 v142, v143, 2, 14
v_exp_f16_sdwa v147, v148 dst_sel:WORD_1 dst_unused:UNUSED_PRESERVE src0_sel:WORD_1
s_waitcnt lgkmcnt(6)
ds_read_b128 v[224:227], v248 offset:47104
ds_read_u16_d16 v140, v140
ds_read_u16_d16 v142, v142
v_mfma_f32_32x32x16_bf16 v[120:135], v[228:231], v[108:111], v[120:135]
v_fmac_f32 v166, v198, v198
v_lshrrev_b32 v141, 18, v141
v_pk_add_f16 v153, v153, 1.0 op_sel_hi:[1,0]
v_fmac_f32 v166, v199, v199
v_lshrrev_b32 v143, 18, v143
v_pk_add_f16 v150, v150, 1.0 op_sel_hi:[1,0]
v_pk_add_f16 v147, v147, 1.0 op_sel_hi:[1,0]
v_fmac_f32_e64 v166, v200, v200
v_and_b32 v145, s49, v145
s_waitcnt lgkmcnt(4)
ds_read_b128 v[228:231], v248 offset:50176
ds_read_u16_d16_hi v141, v141
ds_read_u16_d16_hi v143, v143
v_mfma_f32_32x32x16_bf16 v[120:135], v[232:235], v[112:115], v[120:135]
v_rcp_f16 v154, v153
v_fmac_f32 v166, v201, v201
v_bfe_u32 v144, v145, 2, 14
v_rcp_f16 v151, v150
v_fmac_f32 v166, v202, v202
v_lshrrev_b32 v145, 18, v145
v_rcp_f16 v148, v147
v_fmac_f32 v166, v203, v203
v_or_b32 v88, v136, v137
ds_read_b128 v[232:235], v248 offset:48128
ds_read_u16_d16 v144, v144
ds_read_u16_d16_hi v145, v145
v_mfma_f32_32x32x16_bf16 v[120:135], v[236:239], v[116:119], v[120:135]
s_waitcnt lgkmcnt(6)
v_or_b32 v89, v138, v139
v_rcp_f16_sdwa v154, v153 dst_sel:WORD_1 dst_unused:UNUSED_PRESERVE src0_sel:WORD_1
v_fmac_f32 v166, v204, v204
s_waitcnt lgkmcnt(4)
v_or_b32_e64 v90, v140, v141
v_rcp_f16_sdwa v151, v150 dst_sel:WORD_1 dst_unused:UNUSED_PRESERVE src0_sel:WORD_1
v_fmac_f32 v166, v205, v205
s_waitcnt lgkmcnt(3)
v_or_b32_e64 v91, v142, v143
v_rcp_f16_sdwa v148, v147 dst_sel:WORD_1 dst_unused:UNUSED_PRESERVE src0_sel:WORD_1
v_fmac_f32 v166, v206, v206
s_waitcnt lgkmcnt(0)
v_or_b32_e64 v92, v144, v145
v_pk_mul_f16 v93, v155, v154
v_fmac_f32 v166, v207, v207
v_pk_mul_f16 v94, v152, v151
v_pk_mul_f16 v95, v149, v148
s_setprio 1
ds_read_b128 v[236:239], v248 offset:51200
v_mfma_f32_32x32x16_f16 v[192:207], v[88:91], v[240:243], 0
v_cvt_pkrtz_f16_f32 v137, v120, v121
v_cvt_pkrtz_f16_f32 v139, v122, v123
v_cvt_pkrtz_f16_f32 v141, v124, v125
v_cvt_pkrtz_f16_f32 v143, v126, v127
v_cvt_pkrtz_f16_f32 v145, v128, v129
v_mfma_f32_32x32x16_f16 v[192:207], v[92:95], v[244:247], v[192:207]
v_cvt_pk_f16_f32 v155, v130, v131
v_cvt_pk_f16_f32 v152, v132, v133
v_cvt_pk_f16_f32 v149, v134, v135
v_pk_fma_f16 v154, v155, v155, s48
v_and_b32_e64 v137, s49, v137
v_pk_fma_f16 v151, v152, v152, s48
v_mfma_f32_32x32x16_bf16 v[120:135], v[224:227], v[96:99], 0
v_and_b32_e64 v139, s49, v139
v_pk_fma_f16 v148, v149, v149, s48
v_pk_mul_f16 v154, v155, v154
v_bfe_u32 v136, v137, 2, 14
v_pk_mul_f16 v151, v152, v151
v_pk_mul_f16 v148, v149, v148
v_fmac_f32 v167, v192, v192
v_fmac_f32 v167, v193, v193
v_fmac_f32 v167, v194, v194
v_fmac_f32 v167, v195, v195
v_fmac_f32_e64 v167, v196, v196
ds_read_b128 v[224:227], v248 offset:49152
ds_read_u16_d16 v136, v136
v_mfma_f32_32x32x16_bf16 v[120:135], v[228:231], v[100:103], v[120:135]
v_fmac_f32 v167, v197, v197
v_fmac_f32 v167, v198, v198
v_fmac_f32 v167, v199, v199
v_fmac_f32 v167, v200, v200
v_fmac_f32 v167, v201, v201
v_fmac_f32 v167, v202, v202
v_fmac_f32 v167, v203, v203
v_fmac_f32 v167, v204, v204
v_fmac_f32 v167, v205, v205
v_fmac_f32 v167, v206, v206
v_fmac_f32_e64 v167, v207, v207
ds_read_b128 v[228:231], v248 offset:52224
v_mfma_f32_32x32x16_bf16 v[120:135], v[232:235], v[104:107], v[120:135]
v_permlane32_swap_b32 v166, v167
v_add_f32 v166, v166, v167
ds_write_b32 v255, v166 offset:8448
s_setprio 3
s_mov_b64 exec, 1
ds_add_rtn_u32 v242, v253, v254
s_mov_b64 exec, -1
s_waitcnt lgkmcnt(0)
v_readfirstlane_b32 s43, v242
s_nop 1
s_cmp_lg_u32 s43, 7
s_cbranch_scc1 Lnopub
v_min_u32 v243, 47, v251
v_lshlrev_b32 v244, 5, v243
v_add_u32 v244, 97280, v244
ds_read_b128 v[176:179], v244
ds_read_b128 v[180:183], v244 offset:16
ds_read_b128 v[184:187], v244 offset:9216
ds_read_b128 v[188:191], v244 offset:9232
ds_read_b128 v[192:195], v244 offset:18432
ds_read_b128 v[196:199], v244 offset:18448
ds_read_b128 v[200:203], v244 offset:27648
ds_read_b128 v[204:207], v244 offset:27664
ds_read_b128 v[156:159], v244 offset:36864
ds_read_b128 v[160:163], v244 offset:36880
v_lshlrev_b32_e64 v246, 13, v243
v_add_u32 v247, 4096, v246
s_waitcnt lgkmcnt(7)
v_add_f32 v176, v176, v184
v_add_f32 v177, v177, v185
v_add_f32 v178, v178, v186
v_add_f32 v179, v179, v187
s_waitcnt lgkmcnt(6)
v_add_f32 v180, v180, v188
v_add_f32 v181, v181, v189
v_add_f32 v182, v182, v190
v_add_f32 v183, v183, v191
ds_read_b128 v[184:187], v244 offset:46080
ds_read_b128 v[188:191], v244 offset:46096
s_waitcnt lgkmcnt(5)
v_add_f32 v192, v192, v200
v_add_f32 v193, v193, v201
v_add_f32 v194, v194, v202
v_add_f32 v195, v195, v203
s_waitcnt lgkmcnt(4)
v_add_f32 v196, v196, v204
v_add_f32 v197, v197, v205
v_add_f32 v198, v198, v206
v_add_f32 v199, v199, v207
ds_read_b128 v[200:203], v244 offset:55296
ds_read_b128 v[204:207], v244 offset:55312
v_add_f32 v176, v176, v192
v_add_f32 v177, v177, v193
v_add_f32 v178, v178, v194
v_add_f32 v179, v179, v195
v_add_f32 v180, v180, v196
v_add_f32 v181, v181, v197
v_add_f32 v182, v182, v198
v_add_f32 v183, v183, v199
ds_read_b128 v[192:195], v244 offset:64512
ds_read_b128 v[196:199], v244 offset:64528
s_waitcnt lgkmcnt(5)
v_add_f32 v156, v156, v184
v_add_f32 v157, v157, v185
v_add_f32 v158, v158, v186
v_add_f32 v159, v159, v187
s_waitcnt lgkmcnt(4)
v_add_f32 v160, v160, v188
v_add_f32 v161, v161, v189
v_add_f32 v162, v162, v190
v_add_f32 v163, v163, v191
s_waitcnt lgkmcnt(1)
v_add_f32 v200, v200, v192
v_add_f32 v201, v201, v193
v_add_f32 v202, v202, v194
v_add_f32 v203, v203, v195
s_waitcnt lgkmcnt(0)
v_add_f32 v204, v204, v196
v_add_f32 v205, v205, v197
v_add_f32 v206, v206, v198
v_add_f32 v207, v207, v199
v_add_f32 v156, v156, v200
v_add_f32 v157, v157, v201
v_add_f32 v158, v158, v202
v_add_f32 v159, v159, v203
v_add_f32 v160, v160, v204
v_add_f32 v161, v161, v205
v_add_f32 v162, v162, v206
v_add_f32 v163, v163, v207
v_add_f32 v176, v176, v156
v_add_f32 v177, v177, v157
v_add_f32 v178, v178, v158
v_add_f32 v179, v179, v159
v_add_f32 v180, v180, v160
v_add_f32 v181, v181, v161
v_add_f32 v182, v182, v162
v_add_f32 v183, v183, v163
v_min_u32 v184, -2, v176
v_min_u32 v185, -2, v177
v_min_u32 v186, -2, v178
v_min_u32 v187, -2, v179
v_min_u32 v188, -2, v180
v_min_u32 v189, -2, v181
v_min_u32_e64 v190, -2, v182
v_min_u32 v191, -2, v183
s_lshl_b32 s43, s2, 4
buffer_store_dwordx4 v[184:187], v246, s[32:35], s43 offen sc1
buffer_store_dwordx4 v[188:191], v247, s[32:35], s43 offen sc1
ds_write_b32 v253, v254 offset:4
s_nop 1
Lnopub:
s_mov_b32 s77, 0
s_cmp_lg_u32 s40, 0
s_cbranch_scc1 Lnorole
v_lshlrev_b32_e64 v247, 2, v251
buffer_load_dword v244, v247, s[24:27], 0 offen offset:0
buffer_load_dword v245, v247, s[24:27], 0 offen offset:256
buffer_load_dword v246, v247, s[24:27], 0 offen offset:512
s_cmp_lt_u32 s2, 96
s_cselect_b32 s77, 1, 2
s_waitcnt lgkmcnt(0)
v_mov_b32 v156, -1
v_mov_b32 v157, -1
v_mov_b32 v158, -1
v_mov_b32 v159, -1
v_mov_b32 v160, -1
v_mov_b32 v161, -1
v_mov_b32 v162, -1
v_mov_b32 v163, -1
v_mov_b32 v164, -1
v_mov_b32 v165, -1
v_mov_b32 v166, -1
v_mov_b32 v167, -1
v_mov_b32 v240, -1
v_mov_b32 v241, -1
v_mov_b32 v242, -1
v_mov_b32 v243, -1
s_call_b64 s[78:79], Lpoll1
Lnorole:
s_setprio 1
v_bfe_u32 v138, v139, 2, 14
v_exp_f16 v153, v154
v_lshrrev_b32 v137, 18, v137
v_exp_f16 v150, v151
v_lshrrev_b32 v139, 18, v139
ds_read_b128 v[232:235], v248 offset:53248
ds_read_u16_d16 v138, v138
ds_read_u16_d16_hi v137, v137
ds_read_u16_d16_hi v139, v139
v_mfma_f32_32x32x16_bf16 v[120:135], v[236:239], v[108:111], v[120:135]
v_exp_f16 v147, v148
v_and_b32 v141, s49, v141
v_and_b32_e64 v143, s49, v143
v_exp_f16_sdwa v153, v154 dst_sel:WORD_1 dst_unused:UNUSED_PRESERVE src0_sel:WORD_1
v_bfe_u32 v140, v141, 2, 14
v_exp_f16_sdwa v150, v151 dst_sel:WORD_1 dst_unused:UNUSED_PRESERVE src0_sel:WORD_1
v_bfe_u32 v142, v143, 2, 14
v_exp_f16_sdwa v147, v148 dst_sel:WORD_1 dst_unused:UNUSED_PRESERVE src0_sel:WORD_1
ds_read_b128 v[236:239], v248 offset:56320
ds_read_u16_d16 v140, v140
ds_read_u16_d16 v142, v142
v_mfma_f32_32x32x16_bf16 v[120:135], v[224:227], v[112:115], v[120:135]
v_lshrrev_b32_e64 v141, 18, v141
v_pk_add_f16 v153, v153, 1.0 op_sel_hi:[1,0]
v_lshrrev_b32 v143, 18, v143
v_pk_add_f16 v150, v150, 1.0 op_sel_hi:[1,0]
s_setprio 0
v_pk_add_f16 v147, v147, 1.0 op_sel_hi:[1,0]
v_and_b32 v145, s49, v145
v_rcp_f16 v154, v153
v_bfe_u32 v144, v145, 2, 14
v_rcp_f16_e64 v151, v150
ds_read_b128 v[224:227], v248 offset:54272
ds_read_u16_d16_hi v141, v141
ds_read_u16_d16_hi v143, v143
ds_read_u16_d16 v144, v144
v_mfma_f32_32x32x16_bf16 v[120:135], v[228:231], v[116:119], v[120:135]
v_lshrrev_b32 v145, 18, v145
v_rcp_f16 v148, v147
s_waitcnt lgkmcnt(7)
v_or_b32 v168, v136, v137
v_or_b32_e64 v169, v138, v139
v_rcp_f16_sdwa v154, v153 dst_sel:WORD_1 dst_unused:UNUSED_PRESERVE src0_sel:WORD_1
s_waitcnt lgkmcnt(2)
v_or_b32 v170, v140, v141
v_rcp_f16_sdwa v151, v150 dst_sel:WORD_1 dst_unused:UNUSED_PRESERVE src0_sel:WORD_1
s_waitcnt lgkmcnt(1)
v_or_b32 v171, v142, v143
v_rcp_f16_sdwa v148, v147 dst_sel:WORD_1 dst_unused:UNUSED_PRESERVE src0_sel:WORD_1
ds_read_u16_d16_hi v145, v145
s_waitcnt lgkmcnt(0)
v_or_b32 v172, v144, v145
v_pk_mul_f16 v173, v155, v154
v_pk_mul_f16 v174, v152, v151
v_pk_mul_f16 v175, v149, v148
s_cmp_eq_u32 s77, 0
s_cbranch_scc1 Lpp49
s_getreg_b32 s43, hwreg(HW_REG_IB_STS, 0, 4)
s_cmp_lg_u32 s43, 0
s_cbranch_scc1 Lpp49
s_call_b64 s[78:79], Lpoll
s_setprio 0
Lpp49:
s_setprio 2
v_cvt_pkrtz_f16_f32 v137, v120, v121
v_cvt_pkrtz_f16_f32 v139, v122, v123
v_cvt_pkrtz_f16_f32 v141, v124, v125
v_cvt_pkrtz_f16_f32 v143, v126, v127
v_cvt_pkrtz_f16_f32 v145, v128, v129
v_cvt_pk_f16_f32 v155, v130, v131
v_cvt_pk_f16_f32 v152, v132, v133
v_cvt_pk_f16_f32 v149, v134, v135
ds_read_b128 v[228:231], v248 offset:57344
v_mfma_f32_32x32x16_bf16 v[120:135], v[232:235], v[96:99], 0
v_pk_fma_f16 v154, v155, v155, s48
v_and_b32_e64 v137, s49, v137
v_pk_fma_f16 v151, v152, v152, s48
v_and_b32_e64 v139, s49, v139
v_pk_fma_f16 v148, v149, v149, s48
v_pk_mul_f16 v154, v155, v154
v_bfe_u32 v136, v137, 2, 14
v_pk_mul_f16 v151, v152, v151
ds_read_b128 v[232:235], v248 offset:55296
ds_read_u16_d16 v136, v136
v_mfma_f32_32x32x16_bf16 v[120:135], v[236:239], v[100:103], v[120:135]
v_pk_mul_f16 v148, v149, v148
v_bfe_u32 v138, v139, 2, 14
v_exp_f16 v153, v154
v_lshrrev_b32 v137, 18, v137
v_exp_f16 v150, v151
v_lshrrev_b32 v139, 18, v139
ds_read_b128 v[236:239], v248 offset:58368
ds_read_u16_d16 v138, v138
ds_read_u16_d16_hi v137, v137
ds_read_u16_d16_hi v139, v139
v_mfma_f32_32x32x16_bf16 v[120:135], v[224:227], v[104:107], v[120:135]
v_exp_f16 v147, v148
v_and_b32 v141, s49, v141
v_and_b32 v143, s49, v143
v_exp_f16_sdwa v153, v154 dst_sel:WORD_1 dst_unused:UNUSED_PRESERVE src0_sel:WORD_1
v_bfe_u32 v140, v141, 2, 14
v_exp_f16_sdwa v150, v151 dst_sel:WORD_1 dst_unused:UNUSED_PRESERVE src0_sel:WORD_1
s_waitcnt lgkmcnt(6)
ds_read_b128 v[224:227], v248 offset:59392
ds_read_u16_d16 v140, v140
v_mfma_f32_32x32x16_bf16 v[120:135], v[228:231], v[108:111], v[120:135]
v_bfe_u32 v142, v143, 2, 14
v_exp_f16_sdwa v147, v148 dst_sel:WORD_1 dst_unused:UNUSED_PRESERVE src0_sel:WORD_1
v_lshrrev_b32_e64 v141, 18, v141
v_pk_add_f16 v153, v153, 1.0 op_sel_hi:[1,0]
v_lshrrev_b32 v143, 18, v143
v_pk_add_f16 v150, v150, 1.0 op_sel_hi:[1,0]
v_pk_add_f16 v147, v147, 1.0 op_sel_hi:[1,0]
s_waitcnt lgkmcnt(6)
ds_read_b128 v[228:231], v248 offset:62464
ds_read_u16_d16 v142, v142
ds_read_u16_d16_hi v141, v141
ds_read_u16_d16_hi v143, v143
v_mfma_f32_32x32x16_bf16 v[120:135], v[232:235], v[112:115], v[120:135]
v_and_b32 v145, s49, v145
v_rcp_f16 v154, v153
v_bfe_u32 v144, v145, 2, 14
v_rcp_f16_e64 v151, v150
v_lshrrev_b32 v145, 18, v145
s_waitcnt lgkmcnt(6)
ds_read_b128 v[232:235], v248 offset:60416
ds_read_u16_d16 v144, v144
ds_read_u16_d16_hi v145, v145
v_mfma_f32_32x32x16_bf16 v[120:135], v[236:239], v[116:119], v[120:135]
v_rcp_f16 v148, v147
v_or_b32 v176, v136, v137
v_or_b32_e64 v177, v138, v139
v_rcp_f16_sdwa v154, v153 dst_sel:WORD_1 dst_unused:UNUSED_PRESERVE src0_sel:WORD_1
s_waitcnt lgkmcnt(4)
v_or_b32 v178, v140, v141
v_rcp_f16_sdwa v151, v150 dst_sel:WORD_1 dst_unused:UNUSED_PRESERVE src0_sel:WORD_1
s_waitcnt lgkmcnt(3)
v_or_b32 v179, v142, v143
v_rcp_f16_sdwa v148, v147 dst_sel:WORD_1 dst_unused:UNUSED_PRESERVE src0_sel:WORD_1
s_waitcnt lgkmcnt(0)
v_or_b32 v180, v144, v145
v_pk_mul_f16 v181, v155, v154
v_pk_mul_f16 v182, v152, v151
v_pk_mul_f16 v183, v149, v148
s_cmp_eq_u32 s77, 0
s_cbranch_scc1 Lpp50
s_getreg_b32 s43, hwreg(HW_REG_IB_STS, 0, 4)
s_cmp_lg_u32 s43, 0
s_cbranch_scc1 Lpp50
s_call_b64 s[78:79], Lpoll
s_setprio 2
Lpp50:
s_setprio 1
v_cvt_pkrtz_f16_f32 v137, v120, v121
v_cvt_pkrtz_f16_f32 v139, v122, v123
v_cvt_pkrtz_f16_f32 v141, v124, v125
v_cvt_pkrtz_f16_f32 v143, v126, v127
v_cvt_pkrtz_f16_f32 v145, v128, v129
v_cvt_pk_f16_f32 v155, v130, v131
v_cvt_pk_f16_f32 v152, v132, v133
v_cvt_pk_f16_f32 v149, v134, v135
ds_read_b128 v[236:239], v248 offset:63488
v_mfma_f32_32x32x16_bf16 v[120:135], v[224:227], v[96:99], 0
v_pk_fma_f16 v154, v155, v155, s48
v_and_b32_e64 v137, s49, v137
v_pk_fma_f16 v151, v152, v152, s48
v_and_b32_e64 v139, s49, v139
v_pk_fma_f16 v148, v149, v149, s48
v_pk_mul_f16 v154, v155, v154
v_bfe_u32 v136, v137, 2, 14
v_pk_mul_f16 v151, v152, v151
ds_read_b128 v[224:227], v248 offset:61440
ds_read_u16_d16 v136, v136
v_mfma_f32_32x32x16_bf16 v[120:135], v[228:231], v[100:103], v[120:135]
v_pk_mul_f16 v148, v149, v148
v_bfe_u32 v138, v139, 2, 14
v_exp_f16 v153, v154
v_lshrrev_b32 v137, 18, v137
v_exp_f16 v150, v151
v_lshrrev_b32 v139, 18, v139
ds_read_b128 v[228:231], v248 offset:64512
ds_read_u16_d16 v138, v138
ds_read_u16_d16_hi v137, v137
ds_read_u16_d16_hi v139, v139
v_mfma_f32_32x32x16_bf16 v[120:135], v[232:235], v[104:107], v[120:135]
v_exp_f16 v147, v148
v_and_b32 v141, s49, v141
v_and_b32 v143, s49, v143
v_exp_f16_sdwa v153, v154 dst_sel:WORD_1 dst_unused:UNUSED_PRESERVE src0_sel:WORD_1
v_bfe_u32 v140, v141, 2, 14
v_exp_f16_sdwa v150, v151 dst_sel:WORD_1 dst_unused:UNUSED_PRESERVE src0_sel:WORD_1
s_waitcnt lgkmcnt(6)
ds_read_b128 v[232:235], v249
ds_read_u16_d16 v140, v140
v_mfma_f32_32x32x16_bf16 v[120:135], v[236:239], v[108:111], v[120:135]
v_bfe_u32 v142, v143, 2, 14
v_exp_f16_sdwa v147, v148 dst_sel:WORD_1 dst_unused:UNUSED_PRESERVE src0_sel:WORD_1
v_lshrrev_b32_e64 v141, 18, v141
v_pk_add_f16 v153, v153, 1.0 op_sel_hi:[1,0]
v_lshrrev_b32 v143, 18, v143
v_pk_add_f16 v150, v150, 1.0 op_sel_hi:[1,0]
v_pk_add_f16 v147, v147, 1.0 op_sel_hi:[1,0]
s_waitcnt lgkmcnt(6)
ds_read_b128 v[236:239], v249 offset:3072
ds_read_u16_d16 v142, v142
ds_read_u16_d16_hi v141, v141
ds_read_u16_d16_hi v143, v143
v_mfma_f32_32x32x16_bf16 v[120:135], v[224:227], v[112:115], v[120:135]
v_and_b32 v145, s49, v145
v_rcp_f16 v154, v153
v_bfe_u32 v144, v145, 2, 14
s_setprio 0
v_rcp_f16 v151, v150
v_lshrrev_b32 v145, 18, v145
s_waitcnt lgkmcnt(6)
ds_read_b128 v[224:227], v249 offset:1024
ds_read_u16_d16 v144, v144
ds_read_u16_d16_hi v145, v145
v_mfma_f32_32x32x16_bf16 v[120:135], v[228:231], v[116:119], v[120:135]
v_rcp_f16 v148, v147
v_or_b32 v184, v136, v137
v_or_b32_e64 v185, v138, v139
v_rcp_f16_sdwa v154, v153 dst_sel:WORD_1 dst_unused:UNUSED_PRESERVE src0_sel:WORD_1
s_waitcnt lgkmcnt(4)
v_or_b32 v186, v140, v141
v_rcp_f16_sdwa v151, v150 dst_sel:WORD_1 dst_unused:UNUSED_PRESERVE src0_sel:WORD_1
s_waitcnt lgkmcnt(3)
v_or_b32 v187, v142, v143
v_rcp_f16_sdwa v148, v147 dst_sel:WORD_1 dst_unused:UNUSED_PRESERVE src0_sel:WORD_1
s_waitcnt lgkmcnt(0)
v_or_b32_e64 v188, v144, v145
v_pk_mul_f16 v189, v155, v154
v_pk_mul_f16 v190, v152, v151
v_pk_mul_f16 v191, v149, v148
s_cmp_eq_u32 s77, 0
s_cbranch_scc1 Lpp51
s_getreg_b32 s43, hwreg(HW_REG_IB_STS, 0, 4)
s_cmp_lg_u32 s43, 0
s_cbranch_scc1 Lpp51
s_call_b64 s[78:79], Lpoll
s_setprio 0
Lpp51:
v_mov_b32 v253, 16256
Lw2w:
ds_read_b32 v254, v253 offset:4
s_waitcnt lgkmcnt(0)
v_readfirstlane_b32 s43, v254
s_cmp_eq_u32 s76, 0
s_cbranch_scc1 Lw2x
s_sub_u32 s76, s76, 1
s_cmp_lt_u32 s43, 1
s_cbranch_scc0 Lw2x
s_sleep 2
s_branch Lw2w
Lw2x:
s_add_u32 m0, s72, 7168
s_add_u32 s43, s82, 6208
buffer_load_dwordx4 v252, s[16:19], s43 offen lds
s_add_u32 m0, s72, 8192
s_add_u32 s43, s82, 6272
buffer_load_dwordx4 v252, s[16:19], s43 offen lds
s_setprio 2
v_cvt_pkrtz_f16_f32 v137, v120, v121
v_cvt_pkrtz_f16_f32 v139, v122, v123
v_cvt_pkrtz_f16_f32 v141, v124, v125
v_cvt_pkrtz_f16_f32 v143, v126, v127
v_cvt_pkrtz_f16_f32 v145, v128, v129
v_cvt_pk_f16_f32 v155, v130, v131
v_cvt_pk_f16_f32 v152, v132, v133
v_cvt_pk_f16_f32 v149, v134, v135
ds_read_b128 v[228:231], v249 offset:4096
v_mfma_f32_32x32x16_bf16 v[120:135], v[232:235], v[96:99], 0
v_pk_fma_f16 v154, v155, v155, s48
v_and_b32_e64 v137, s49, v137
v_pk_fma_f16 v151, v152, v152, s48
v_and_b32_e64 v139, s49, v139
v_pk_fma_f16 v148, v149, v149, s48
v_pk_mul_f16 v154, v155, v154
v_bfe_u32 v136, v137, 2, 14
v_pk_mul_f16 v151, v152, v151
ds_read_b128 v[232:235], v249 offset:2048
ds_read_u16_d16 v136, v136
v_mfma_f32_32x32x16_bf16 v[120:135], v[236:239], v[100:103], v[120:135]
v_pk_mul_f16 v148, v149, v148
v_bfe_u32 v138, v139, 2, 14
v_exp_f16 v153, v154
v_lshrrev_b32 v137, 18, v137
v_exp_f16 v150, v151
v_lshrrev_b32 v139, 18, v139
ds_read_b128 v[236:239], v249 offset:5120
ds_read_u16_d16 v138, v138
ds_read_u16_d16_hi v137, v137
ds_read_u16_d16_hi v139, v139
v_mfma_f32_32x32x16_bf16 v[120:135], v[224:227], v[104:107], v[120:135]
v_exp_f16 v147, v148
v_and_b32 v141, s49, v141
v_and_b32 v143, s49, v143
v_exp_f16_sdwa v153, v154 dst_sel:WORD_1 dst_unused:UNUSED_PRESERVE src0_sel:WORD_1
v_bfe_u32 v140, v141, 2, 14
v_exp_f16_sdwa v150, v151 dst_sel:WORD_1 dst_unused:UNUSED_PRESERVE src0_sel:WORD_1
s_waitcnt lgkmcnt(6)
ds_read_b128 v[224:227], v249 offset:6144
ds_read_u16_d16 v140, v140
v_mfma_f32_32x32x16_bf16 v[120:135], v[228:231], v[108:111], v[120:135]
v_bfe_u32 v142, v143, 2, 14
v_exp_f16_sdwa v147, v148 dst_sel:WORD_1 dst_unused:UNUSED_PRESERVE src0_sel:WORD_1
v_lshrrev_b32_e64 v141, 18, v141
v_pk_add_f16 v153, v153, 1.0 op_sel_hi:[1,0]
v_lshrrev_b32 v143, 18, v143
v_pk_add_f16 v150, v150, 1.0 op_sel_hi:[1,0]
v_pk_add_f16 v147, v147, 1.0 op_sel_hi:[1,0]
s_waitcnt lgkmcnt(6)
ds_read_b128 v[228:231], v249 offset:9216
ds_read_u16_d16 v142, v142
ds_read_u16_d16_hi v141, v141
ds_read_u16_d16_hi v143, v143
v_mfma_f32_32x32x16_bf16 v[120:135], v[232:235], v[112:115], v[120:135]
v_and_b32 v145, s49, v145
v_rcp_f16 v154, v153
v_bfe_u32 v144, v145, 2, 14
v_rcp_f16_e64 v151, v150
v_lshrrev_b32 v145, 18, v145
s_waitcnt lgkmcnt(6)
ds_read_b128 v[232:235], v249 offset:7168
ds_read_u16_d16 v144, v144
ds_read_u16_d16_hi v145, v145
v_mfma_f32_32x32x16_bf16 v[120:135], v[236:239], v[116:119], v[120:135]
v_rcp_f16 v148, v147
v_or_b32 v192, v136, v137
v_or_b32_e64 v193, v138, v139
v_rcp_f16_sdwa v154, v153 dst_sel:WORD_1 dst_unused:UNUSED_PRESERVE src0_sel:WORD_1
s_waitcnt lgkmcnt(4)
v_or_b32 v194, v140, v141
v_rcp_f16_sdwa v151, v150 dst_sel:WORD_1 dst_unused:UNUSED_PRESERVE src0_sel:WORD_1
s_waitcnt lgkmcnt(3)
v_or_b32 v195, v142, v143
v_rcp_f16_sdwa v148, v147 dst_sel:WORD_1 dst_unused:UNUSED_PRESERVE src0_sel:WORD_1
s_waitcnt lgkmcnt(0)
v_or_b32 v196, v144, v145
v_pk_mul_f16 v197, v155, v154
v_pk_mul_f16 v198, v152, v151
v_pk_mul_f16 v199, v149, v148
s_cmp_eq_u32 s77, 0
s_cbranch_scc1 Lpp52
s_getreg_b32 s43, hwreg(HW_REG_IB_STS, 0, 4)
s_cmp_lg_u32 s43, 0
s_cbranch_scc1 Lpp52
s_call_b64 s[78:79], Lpoll
s_setprio 2
Lpp52:
s_setprio 1
v_cvt_pkrtz_f16_f32 v137, v120, v121
v_cvt_pkrtz_f16_f32 v139, v122, v123
v_cvt_pkrtz_f16_f32 v141, v124, v125
v_cvt_pkrtz_f16_f32 v143, v126, v127
v_cvt_pkrtz_f16_f32 v145, v128, v129
v_cvt_pk_f16_f32 v155, v130, v131
v_cvt_pk_f16_f32 v152, v132, v133
v_cvt_pk_f16_f32 v149, v134, v135
ds_read_b128 v[236:239], v249 offset:10240
v_mfma_f32_32x32x16_bf16 v[120:135], v[224:227], v[96:99], 0
v_pk_fma_f16 v154, v155, v155, s48
v_and_b32_e64 v137, s49, v137
v_pk_fma_f16 v151, v152, v152, s48
v_and_b32_e64 v139, s49, v139
v_pk_fma_f16 v148, v149, v149, s48
v_pk_mul_f16 v154, v155, v154
v_bfe_u32 v136, v137, 2, 14
v_pk_mul_f16 v151, v152, v151
ds_read_b128 v[224:227], v249 offset:8192
ds_read_u16_d16 v136, v136
v_mfma_f32_32x32x16_bf16 v[120:135], v[228:231], v[100:103], v[120:135]
v_pk_mul_f16 v148, v149, v148
v_bfe_u32 v138, v139, 2, 14
v_exp_f16 v153, v154
v_lshrrev_b32 v137, 18, v137
v_exp_f16 v150, v151
v_lshrrev_b32 v139, 18, v139
ds_read_b128 v[228:231], v249 offset:11264
ds_read_u16_d16 v138, v138
ds_read_u16_d16_hi v137, v137
ds_read_u16_d16_hi v139, v139
v_mfma_f32_32x32x16_bf16 v[120:135], v[232:235], v[104:107], v[120:135]
v_exp_f16 v147, v148
v_and_b32 v141, s49, v141
v_and_b32 v143, s49, v143
v_exp_f16_sdwa v153, v154 dst_sel:WORD_1 dst_unused:UNUSED_PRESERVE src0_sel:WORD_1
v_bfe_u32 v140, v141, 2, 14
v_exp_f16_sdwa v150, v151 dst_sel:WORD_1 dst_unused:UNUSED_PRESERVE src0_sel:WORD_1
s_waitcnt lgkmcnt(6)
ds_read_u16_d16 v140, v140
v_mfma_f32_32x32x16_bf16 v[120:135], v[236:239], v[108:111], v[120:135]
v_bfe_u32 v142, v143, 2, 14
v_exp_f16_sdwa v147, v148 dst_sel:WORD_1 dst_unused:UNUSED_PRESERVE src0_sel:WORD_1
v_lshrrev_b32_e64 v141, 18, v141
v_pk_add_f16 v153, v153, 1.0 op_sel_hi:[1,0]
v_lshrrev_b32 v143, 18, v143
v_pk_add_f16 v150, v150, 1.0 op_sel_hi:[1,0]
v_pk_add_f16 v147, v147, 1.0 op_sel_hi:[1,0]
s_waitcnt lgkmcnt(5)
ds_read_u16_d16 v142, v142
ds_read_u16_d16_hi v141, v141
ds_read_u16_d16_hi v143, v143
v_mfma_f32_32x32x16_bf16 v[120:135], v[224:227], v[112:115], v[120:135]
v_and_b32 v145, s49, v145
v_rcp_f16 v154, v153
v_bfe_u32 v144, v145, 2, 14
s_setprio 0
v_rcp_f16 v151, v150
v_lshrrev_b32 v145, 18, v145
s_waitcnt lgkmcnt(4)
ds_read_u16_d16 v144, v144
ds_read_u16_d16_hi v145, v145
v_mfma_f32_32x32x16_bf16 v[120:135], v[228:231], v[116:119], v[120:135]
v_rcp_f16 v148, v147
v_or_b32 v200, v136, v137
v_or_b32_e64 v201, v138, v139
v_rcp_f16_sdwa v154, v153 dst_sel:WORD_1 dst_unused:UNUSED_PRESERVE src0_sel:WORD_1
s_waitcnt lgkmcnt(3)
v_or_b32 v202, v140, v141
v_rcp_f16_sdwa v151, v150 dst_sel:WORD_1 dst_unused:UNUSED_PRESERVE src0_sel:WORD_1
s_waitcnt lgkmcnt(2)
v_or_b32 v203, v142, v143
v_rcp_f16_sdwa v148, v147 dst_sel:WORD_1 dst_unused:UNUSED_PRESERVE src0_sel:WORD_1
s_waitcnt lgkmcnt(0)
v_or_b32 v204, v144, v145
v_pk_mul_f16 v205, v155, v154
v_pk_mul_f16 v206, v152, v151
v_pk_mul_f16 v207, v149, v148
s_cmp_eq_u32 s77, 0
s_cbranch_scc1 Lpp53
s_getreg_b32 s43, hwreg(HW_REG_IB_STS, 0, 4)
s_cmp_lg_u32 s43, 0
s_cbranch_scc1 Lpp53
s_call_b64 s[78:79], Lpoll
s_setprio 0
Lpp53:
s_setprio 2
v_cvt_pkrtz_f16_f32 v137, v120, v121
v_cvt_pkrtz_f16_f32 v139, v122, v123
v_cvt_pkrtz_f16_f32 v141, v124, v125
v_cvt_pkrtz_f16_f32 v143, v126, v127
v_cvt_pkrtz_f16_f32 v145, v128, v129
v_cvt_pk_f16_f32 v155, v130, v131
v_cvt_pk_f16_f32 v152, v132, v133
v_cvt_pk_f16_f32 v149, v134, v135
v_pk_fma_f16 v154, v155, v155, s48
v_and_b32_e64 v137, s49, v137
v_pk_fma_f16 v151, v152, v152, s48
v_and_b32_e64 v139, s49, v139
v_pk_fma_f16 v148, v149, v149, s48
v_pk_mul_f16 v154, v155, v154
v_bfe_u32 v136, v137, 2, 14
v_pk_mul_f16 v151, v152, v151
v_pk_mul_f16 v148, v149, v148
v_bfe_u32 v138, v139, 2, 14
v_exp_f16 v153, v154
v_lshrrev_b32 v137, 18, v137
v_exp_f16 v150, v151
v_lshrrev_b32 v139, 18, v139
v_exp_f16 v147, v148
v_and_b32 v141, s49, v141
v_and_b32_e64 v143, s49, v143
ds_read_u16_d16 v136, v136
ds_read_u16_d16 v138, v138
ds_read_u16_d16_hi v137, v137
ds_read_u16_d16_hi v139, v139
v_exp_f16_sdwa v153, v154 dst_sel:WORD_1 dst_unused:UNUSED_PRESERVE src0_sel:WORD_1
v_bfe_u32 v140, v141, 2, 14
v_exp_f16_sdwa v150, v151 dst_sel:WORD_1 dst_unused:UNUSED_PRESERVE src0_sel:WORD_1
s_setprio 1
v_bfe_u32 v142, v143, 2, 14
v_exp_f16_sdwa v147, v148 dst_sel:WORD_1 dst_unused:UNUSED_PRESERVE src0_sel:WORD_1
v_lshrrev_b32 v141, 18, v141
v_pk_add_f16 v153, v153, 1.0 op_sel_hi:[1,0]
v_lshrrev_b32_e64 v143, 18, v143
v_pk_add_f16 v150, v150, 1.0 op_sel_hi:[1,0]
v_pk_add_f16 v147, v147, 1.0 op_sel_hi:[1,0]
v_and_b32 v145, s49, v145
v_rcp_f16 v154, v153
v_bfe_u32 v144, v145, 2, 14
v_rcp_f16 v151, v150
v_lshrrev_b32 v145, 18, v145
ds_read_u16_d16 v140, v140
ds_read_u16_d16 v142, v142
ds_read_u16_d16_hi v141, v141
ds_read_u16_d16_hi v143, v143
ds_read_u16_d16 v144, v144
ds_read_u16_d16_hi v145, v145
v_rcp_f16 v148, v147
s_waitcnt lgkmcnt(7)
v_or_b32 v232, v136, v137
s_waitcnt lgkmcnt(6)
v_or_b32 v233, v138, v139
v_rcp_f16_sdwa v154, v153 dst_sel:WORD_1 dst_unused:UNUSED_PRESERVE src0_sel:WORD_1
s_waitcnt lgkmcnt(3)
v_or_b32 v234, v140, v141
s_setprio 0
v_rcp_f16_sdwa v151, v150 dst_sel:WORD_1 dst_unused:UNUSED_PRESERVE src0_sel:WORD_1
s_waitcnt lgkmcnt(2)
v_or_b32 v235, v142, v143
v_rcp_f16_sdwa v148, v147 dst_sel:WORD_1 dst_unused:UNUSED_PRESERVE src0_sel:WORD_1
s_waitcnt lgkmcnt(0)
v_or_b32 v236, v144, v145
v_pk_mul_f16 v237, v155, v154
v_pk_mul_f16 v238, v152, v151
v_pk_mul_f16 v239, v149, v148
s_cmp_eq_u32 s77, 0
s_cbranch_scc1 Lpp54
s_getreg_b32 s43, hwreg(HW_REG_IB_STS, 0, 4)
s_cmp_lg_u32 s43, 0
s_cbranch_scc1 Lpp54
s_call_b64 s[78:79], Lpoll
s_setprio 0
Lpp54:
s_setprio 2
v_lshrrev_b32_e64 v225, 5, v251
v_lshl_add_u32 v224, v225, 9, s72
v_lshl_add_u32 v226, v225, 4, s72
v_and_b32 v225, 15, v251
v_lshl_add_u32 v224, v225, 4, v224
v_bfe_u32 v225, v251, 4, 1
v_lshl_add_u32 v224, v225, 3, v224
s_waitcnt vmcnt(0)
ds_read_b64_tr_b16 v[120:121], v224
ds_read_b64_tr_b16 v[122:123], v224 offset:256
ds_read_b64_tr_b16 v[124:125], v224 offset:1024
ds_read_b64_tr_b16 v[126:127], v224 offset:1280
ds_read_b64_tr_b16 v[128:129], v224 offset:2048
ds_read_b64_tr_b16 v[130:131], v224 offset:2304
ds_read_b64_tr_b16 v[132:133], v224 offset:3072
ds_read_b64_tr_b16 v[134:135], v224 offset:3328
ds_read_b64_tr_b16 v[136:137], v224 offset:4096
ds_read_b64_tr_b16 v[138:139], v224 offset:4352
ds_read_b64_tr_b16 v[140:141], v224 offset:5120
ds_read_b64_tr_b16 v[142:143], v224 offset:5376
ds_read_b64_tr_b16 v[144:145], v224 offset:6144
ds_read_b64_tr_b16 v[146:147], v224 offset:6400
ds_read_b64_tr_b16 v[148:149], v224 offset:7168
ds_read_b64_tr_b16 v[150:151], v224 offset:7424
ds_read_b64_tr_b16 v[152:153], v224 offset:8192
ds_read_b64_tr_b16 v[154:155], v224 offset:8448
v_lshrrev_b32 v225, 4, v251
v_and_b32 v227, 15, v251
v_mul_u32_u24 v252, 192, v227
v_lshl_add_u32 v252, v225, 4, v252
v_lshlrev_b32 v254, 5, v225
v_and_b32 v253, 47, v251
v_lshlrev_b32 v253, 4, v253
v_and_b32 v225, 1, v225
v_mul_u32_u24 v227, 3072, v225
v_add_u32_e64 v248, v227, v253
v_add_u32 v249, 65536, v248
v_add_u32 v250, 131072, v248
v_lshl_add_u32 v253, v225, 21, v253
v_mov_b32 v225, 16256
v_mov_b32_e64 v227, 1
v_permlane16_swap_b32 v0, v4
v_permlane16_swap_b32 v1, v5
v_permlane16_swap_b32 v2, v6
v_permlane16_swap_b32 v3, v7
v_permlane16_swap_b32 v8, v12
v_permlane16_swap_b32 v9, v13
v_permlane16_swap_b32 v10, v14
v_permlane16_swap_b32 v11, v15
s_waitcnt lgkmcnt(0)
s_mov_b64 exec, 1
ds_add_u32 v225, v227 offset:8
s_mov_b64 exec, -1
v_lshlrev_b32 v228, 16, v120
v_and_b32 v229, 4294901760, v120
v_cvt_pk_f16_f32 v120, v228, v229
v_lshlrev_b32_e64 v230, 16, v121
v_and_b32 v231, 4294901760, v121
v_cvt_pk_f16_f32 v121, v230, v231
v_lshlrev_b32_e64 v228, 16, v122
v_and_b32 v229, 4294901760, v122
v_cvt_pk_f16_f32 v122, v228, v229
v_lshlrev_b32_e64 v230, 16, v123
v_and_b32 v231, 4294901760, v123
v_cvt_pk_f16_f32 v123, v230, v231
v_lshlrev_b32_e64 v228, 16, v124
v_and_b32 v229, 4294901760, v124
v_cvt_pk_f16_f32 v124, v228, v229
v_lshlrev_b32_e64 v230, 16, v125
v_and_b32 v231, 4294901760, v125
v_cvt_pk_f16_f32 v125, v230, v231
v_lshlrev_b32_e64 v228, 16, v126
v_and_b32 v229, 4294901760, v126
v_cvt_pk_f16_f32 v126, v228, v229
v_lshlrev_b32_e64 v230, 16, v127
v_and_b32 v231, 4294901760, v127
v_cvt_pk_f16_f32 v127, v230, v231
v_lshlrev_b32_e64 v228, 16, v128
v_and_b32 v229, 4294901760, v128
v_cvt_pk_f16_f32 v128, v228, v229
v_lshlrev_b32_e64 v230, 16, v129
v_and_b32 v231, 4294901760, v129
v_cvt_pk_f16_f32 v129, v230, v231
v_lshlrev_b32_e64 v228, 16, v130
v_and_b32 v229, 4294901760, v130
v_cvt_pk_f16_f32 v130, v228, v229
v_lshlrev_b32_e64 v230, 16, v131
v_and_b32 v231, 4294901760, v131
v_cvt_pk_f16_f32 v131, v230, v231
s_cmp_eq_u32 s77, 0
s_cbranch_scc1 Lpp911
s_getreg_b32 s43, hwreg(HW_REG_IB_STS, 0, 4)
s_cmp_lg_u32 s43, 0
s_cbranch_scc1 Lpp911
s_call_b64 s[78:79], Lpoll
s_setprio 2
Lpp911:
v_lshlrev_b32 v228, 16, v132
v_and_b32 v229, 4294901760, v132
v_cvt_pk_f16_f32 v132, v228, v229
v_lshlrev_b32_e64 v230, 16, v133
v_and_b32 v231, 4294901760, v133
v_cvt_pk_f16_f32 v133, v230, v231
v_lshlrev_b32_e64 v228, 16, v134
v_and_b32 v229, 4294901760, v134
v_cvt_pk_f16_f32 v134, v228, v229
v_lshlrev_b32_e64 v230, 16, v135
v_and_b32 v231, 4294901760, v135
v_cvt_pk_f16_f32 v135, v230, v231
v_lshlrev_b32_e64 v228, 16, v136
v_and_b32 v229, 4294901760, v136
v_cvt_pk_f16_f32 v136, v228, v229
v_lshlrev_b32_e64 v230, 16, v137
v_and_b32 v231, 4294901760, v137
v_cvt_pk_f16_f32 v137, v230, v231
v_lshlrev_b32_e64 v228, 16, v138
v_and_b32 v229, 4294901760, v138
v_cvt_pk_f16_f32 v138, v228, v229
v_lshlrev_b32_e64 v230, 16, v139
v_and_b32 v231, 4294901760, v139
v_cvt_pk_f16_f32 v139, v230, v231
v_lshlrev_b32_e64 v228, 16, v140
v_and_b32 v229, 4294901760, v140
v_cvt_pk_f16_f32 v140, v228, v229
v_lshlrev_b32_e64 v230, 16, v141
v_and_b32 v231, 4294901760, v141
v_cvt_pk_f16_f32 v141, v230, v231
v_lshlrev_b32_e64 v228, 16, v142
v_and_b32 v229, 4294901760, v142
v_cvt_pk_f16_f32 v142, v228, v229
v_lshlrev_b32_e64 v230, 16, v143
v_and_b32 v231, 4294901760, v143
v_cvt_pk_f16_f32 v143, v230, v231
s_cmp_eq_u32 s77, 0
s_cbranch_scc1 Lpp923
s_getreg_b32 s43, hwreg(HW_REG_IB_STS, 0, 4)
s_cmp_lg_u32 s43, 0
s_cbranch_scc1 Lpp923
s_call_b64 s[78:79], Lpoll
s_setprio 2
Lpp923:
v_lshlrev_b32 v228, 16, v144
v_and_b32 v229, 4294901760, v144
v_cvt_pk_f16_f32 v144, v228, v229
v_lshlrev_b32_e64 v230, 16, v145
v_and_b32 v231, 4294901760, v145
v_cvt_pk_f16_f32 v145, v230, v231
v_lshlrev_b32_e64 v228, 16, v146
v_and_b32 v229, 4294901760, v146
v_cvt_pk_f16_f32 v146, v228, v229
v_lshlrev_b32_e64 v230, 16, v147
v_and_b32 v231, 4294901760, v147
v_cvt_pk_f16_f32 v147, v230, v231
v_lshlrev_b32_e64 v228, 16, v148
v_and_b32 v229, 4294901760, v148
v_cvt_pk_f16_f32 v148, v228, v229
v_lshlrev_b32_e64 v230, 16, v149
v_and_b32 v231, 4294901760, v149
v_cvt_pk_f16_f32 v149, v230, v231
v_lshlrev_b32_e64 v228, 16, v150
v_and_b32 v229, 4294901760, v150
v_cvt_pk_f16_f32 v150, v228, v229
v_lshlrev_b32_e64 v230, 16, v151
v_and_b32 v231, 4294901760, v151
v_cvt_pk_f16_f32 v151, v230, v231
v_lshlrev_b32_e64 v228, 16, v152
v_and_b32 v229, 4294901760, v152
v_cvt_pk_f16_f32 v152, v228, v229
v_lshlrev_b32_e64 v230, 16, v153
v_and_b32 v231, 4294901760, v153
v_cvt_pk_f16_f32 v153, v230, v231
v_lshlrev_b32_e64 v228, 16, v154
v_and_b32 v229, 4294901760, v154
v_cvt_pk_f16_f32 v154, v228, v229
v_lshlrev_b32_e64 v230, 16, v155
v_and_b32 v231, 4294901760, v155
v_cvt_pk_f16_f32 v155, v230, v231
s_cmp_eq_u32 s77, 0
s_cbranch_scc1 Lpp935
s_getreg_b32 s43, hwreg(HW_REG_IB_STS, 0, 4)
s_cmp_lg_u32 s43, 0
s_cbranch_scc1 Lpp935
s_call_b64 s[78:79], Lpoll
s_setprio 2
Lpp935:
v_lshl_add_u32 v224, v251, 4, s72
Lspin:
s_cmp_eq_u32 s77, 0
s_cbranch_scc1 Lspinx
s_cmp_eq_u32 s76, 0
s_cbranch_scc1 Lspinx
s_sub_u32 s76, s76, 1
s_call_b64 s[78:79], Lpoll
s_branch Lspin
Lspinx:
s_cmp_lg_u32 s40, 0
s_cbranch_scc1 Lnofin
v_add_u32_e64 v162, 0, v251
v_mul_u32_u24 v165, 2731, v162
v_lshrrev_b32_e64 v165, 16, v165
v_mul_u32_u24 v165, 9120, v165
v_lshl_add_u32 v162, v162, 2, v165
v_add_u32 v162, 90112, v162
v_add_u32_e64 v163, 64, v251
v_mul_u32_u24 v165, 2731, v163
v_lshrrev_b32_e64 v165, 16, v165
v_mul_u32_u24 v165, 9120, v165
v_lshl_add_u32 v163, v163, 2, v165
v_add_u32 v163, 90112, v163
v_add_u32 v164, 128, v251
v_mul_u32_u24 v165, 2731, v164
v_lshrrev_b32_e64 v165, 16, v165
v_mul_u32_u24 v165, 9120, v165
v_lshl_add_u32 v164, v164, 2, v165
v_add_u32 v164, 90112, v164
v_mov_b32 v165, 16256
Lrrw:
ds_read_b32 v166, v165 offset:8
s_waitcnt lgkmcnt(0)
v_readfirstlane_b32 s43, v166
s_cmp_eq_u32 s76, 0
s_cbranch_scc1 Lrrx
s_sub_u32 s76, s76, 1
s_cmp_lt_u32 s43, 8
s_cbranch_scc0 Lrrx
s_sleep 2
s_branch Lrrw
Lrrx:
ds_write_b32 v162, v244
ds_write_b32 v163, v245
ds_write_b32 v164, v246
Lnofin:
s_waitcnt lgkmcnt(0)
s_barrier
ds_read_b128 v[156:159], v226
ds_read_b128 v[160:163], v226 offset:32
ds_read_b128 v[164:167], v226 offset:64
s_waitcnt lgkmcnt(0)
v_pk_mul_f16 v120, v120, v156
v_pk_mul_f16 v121, v121, v157
v_pk_mul_f16 v122, v122, v158
v_pk_mul_f16 v123, v123, v159
ds_write_b128 v224, v[120:123]
v_pk_mul_f16 v124, v124, v156
v_pk_mul_f16 v125, v125, v157
v_pk_mul_f16 v126, v126, v158
v_pk_mul_f16 v127, v127, v159
ds_write_b128 v224, v[124:127] offset:1024
v_pk_mul_f16 v128, v128, v156
v_pk_mul_f16 v129, v129, v157
v_pk_mul_f16 v130, v130, v158
v_pk_mul_f16 v131, v131, v159
ds_write_b128 v224, v[128:131] offset:2048
v_pk_mul_f16 v132, v132, v160
v_pk_mul_f16 v133, v133, v161
v_pk_mul_f16 v134, v134, v162
v_pk_mul_f16 v135, v135, v163
ds_write_b128 v224, v[132:135] offset:3072
v_pk_mul_f16 v136, v136, v160
v_pk_mul_f16 v137, v137, v161
v_pk_mul_f16 v138, v138, v162
v_pk_mul_f16 v139, v139, v163
ds_write_b128 v224, v[136:139] offset:4096
v_pk_mul_f16 v140, v140, v160
v_pk_mul_f16 v141, v141, v161
v_pk_mul_f16 v142, v142, v162
v_pk_mul_f16 v143, v143, v163
ds_write_b128 v224, v[140:143] offset:5120
v_pk_mul_f16 v144, v144, v164
v_pk_mul_f16 v145, v145, v165
v_pk_mul_f16 v146, v146, v166
v_pk_mul_f16 v147, v147, v167
ds_write_b128 v224, v[144:147] offset:6144
v_pk_mul_f16 v148, v148, v164
v_pk_mul_f16 v149, v149, v165
v_pk_mul_f16 v150, v150, v166
v_pk_mul_f16 v151, v151, v167
ds_write_b128 v224, v[148:151] offset:7168
v_pk_mul_f16 v152, v152, v164
v_pk_mul_f16 v153, v153, v165
v_pk_mul_f16 v154, v154, v166
v_pk_mul_f16 v155, v155, v167
ds_write_b128 v224, v[152:155] offset:8192
s_waitcnt lgkmcnt(0)
s_barrier
s_setprio 3
ds_read_b128 v[224:227], v249 offset:24576
ds_read_b128 v[228:231], v254 offset:7936
ds_read_b128 v[240:243], v249 offset:24832
ds_read_b128 v[244:247], v254 offset:7952
s_waitcnt lgkmcnt(2)
v_mfma_f32_16x16x32_f16 v[120:123], v[224:227], v[0:3], v[228:231]
v_mfma_f32_16x16x32_f16 v[128:131], v[224:227], v[4:7], v[228:231]
v_permlane16_swap_b32 v16, v20
s_waitcnt lgkmcnt(0)
v_mfma_f32_16x16x32_f16 v[124:127], v[240:243], v[0:3], v[244:247]
ds_read_b128 v[224:227], v249 offset:25600
ds_read_b128 v[228:231], v254 offset:8064
v_mfma_f32_16x16x32_f16 v[132:135], v[240:243], v[4:7], v[244:247]
v_permlane16_swap_b32 v17, v21
s_waitcnt lgkmcnt(0)
v_mfma_f32_16x16x32_f16 v[136:139], v[224:227], v[0:3], v[228:231]
ds_read_b128 v[240:243], v249 offset:25856
ds_read_b128 v[244:247], v254 offset:8080
v_mfma_f32_16x16x32_f16 v[144:147], v[224:227], v[4:7], v[228:231]
v_permlane16_swap_b32 v18, v22
s_waitcnt lgkmcnt(0)
v_mfma_f32_16x16x32_f16 v[140:143], v[240:243], v[0:3], v[244:247]
ds_read_b128 v[224:227], v249 offset:26624
ds_read_b128 v[228:231], v254 offset:16128
v_mfma_f32_16x16x32_f16 v[148:151], v[240:243], v[4:7], v[244:247]
v_permlane16_swap_b32 v19, v23
s_waitcnt lgkmcnt(0)
v_mfma_f32_16x16x32_f16 v[152:155], v[224:227], v[0:3], v[228:231]
ds_read_b128 v[240:243], v249 offset:26880
ds_read_b128 v[244:247], v254 offset:16144
v_mfma_f32_16x16x32_f16 v[160:163], v[224:227], v[4:7], v[228:231]
v_permlane16_swap_b32 v24, v28
s_waitcnt lgkmcnt(0)
v_mfma_f32_16x16x32_f16 v[156:159], v[240:243], v[0:3], v[244:247]
ds_read_b128 v[224:227], v249 offset:30720
ds_read_b128 v[228:231], v249 offset:30976
v_mfma_f32_16x16x32_f16 v[164:167], v[240:243], v[4:7], v[244:247]
v_permlane16_swap_b32 v25, v29
s_waitcnt lgkmcnt(1)
v_mfma_f32_16x16x32_f16 v[120:123], v[224:227], v[8:11], v[120:123]
ds_read_b128 v[240:243], v249 offset:31744
ds_read_b128 v[244:247], v249 offset:32000
v_mfma_f32_16x16x32_f16 v[128:131], v[224:227], v[12:15], v[128:131]
v_permlane16_swap_b32 v26, v30
s_waitcnt lgkmcnt(2)
v_mfma_f32_16x16x32_f16 v[124:127], v[228:231], v[8:11], v[124:127]
ds_read_b128 v[224:227], v249 offset:32768
v_mfma_f32_16x16x32_f16 v[132:135], v[228:231], v[12:15], v[132:135]
v_permlane16_swap_b32 v27, v31
s_waitcnt lgkmcnt(2)
v_mfma_f32_16x16x32_f16 v[136:139], v[240:243], v[8:11], v[136:139]
ds_read_b128 v[228:231], v249 offset:33024
v_mfma_f32_16x16x32_f16 v[144:147], v[240:243], v[12:15], v[144:147]
v_permlane16_swap_b32 v96, v100
s_waitcnt lgkmcnt(2)
v_mfma_f32_16x16x32_f16 v[140:143], v[244:247], v[8:11], v[140:143]
ds_read_b128 v[240:243], v249 offset:36864
v_mfma_f32_16x16x32_f16 v[148:151], v[244:247], v[12:15], v[148:151]
v_permlane16_swap_b32 v97, v101
s_waitcnt lgkmcnt(2)
v_mfma_f32_16x16x32_f16 v[152:155], v[224:227], v[8:11], v[152:155]
ds_read_b128 v[244:247], v249 offset:37120
v_mfma_f32_16x16x32_f16 v[160:163], v[224:227], v[12:15], v[160:163]
v_permlane16_swap_b32 v98, v102
s_waitcnt lgkmcnt(2)
v_mfma_f32_16x16x32_f16 v[156:159], v[228:231], v[8:11], v[156:159]
ds_read_b128 v[224:227], v249 offset:37888
v_mfma_f32_16x16x32_f16 v[164:167], v[228:231], v[12:15], v[164:167]
v_permlane16_swap_b32 v99, v103
s_waitcnt lgkmcnt(2)
v_mfma_f32_16x16x32_f16 v[120:123], v[240:243], v[16:19], v[120:123]
buffer_load_dwordx4 v[12:15], v252, s[4:7], s71 offen
ds_read_b128 v[228:231], v249 offset:38144
v_mfma_f32_16x16x32_f16 v[128:131], v[240:243], v[20:23], v[128:131]
v_permlane16_swap_b32 v32, v36
s_waitcnt lgkmcnt(2)
v_mfma_f32_16x16x32_f16 v[124:127], v[244:247], v[16:19], v[124:127]
ds_read_b128 v[240:243], v249 offset:38912
v_mfma_f32_16x16x32_f16 v[132:135], v[244:247], v[20:23], v[132:135]
v_permlane16_swap_b32 v33, v37
s_waitcnt lgkmcnt(2)
v_mfma_f32_16x16x32_f16 v[136:139], v[224:227], v[16:19], v[136:139]
ds_read_b128 v[244:247], v249 offset:39168
v_mfma_f32_16x16x32_f16 v[144:147], v[224:227], v[20:23], v[144:147]
v_permlane16_swap_b32 v34, v38
s_waitcnt lgkmcnt(2)
v_mfma_f32_16x16x32_f16 v[140:143], v[228:231], v[16:19], v[140:143]
buffer_load_dwordx4 v[8:11], v252, s[4:7], s71 offen offset:64
ds_read_b128 v[224:227], v249 offset:43008
v_mfma_f32_16x16x32_f16 v[148:151], v[228:231], v[20:23], v[148:151]
v_permlane16_swap_b32 v35, v39
s_waitcnt lgkmcnt(2)
v_mfma_f32_16x16x32_f16 v[152:155], v[240:243], v[16:19], v[152:155]
ds_read_b128 v[228:231], v249 offset:43264
v_mfma_f32_16x16x32_f16 v[160:163], v[240:243], v[20:23], v[160:163]
v_permlane16_swap_b32 v40, v44
s_waitcnt lgkmcnt(2)
v_mfma_f32_16x16x32_f16 v[156:159], v[244:247], v[16:19], v[156:159]
ds_read_b128 v[240:243], v249 offset:44032
v_mfma_f32_16x16x32_f16 v[164:167], v[244:247], v[20:23], v[164:167]
v_permlane16_swap_b32 v41, v45
s_waitcnt lgkmcnt(2)
v_mfma_f32_16x16x32_f16 v[120:123], v[224:227], v[24:27], v[120:123]
buffer_load_dwordx4 v[4:7], v252, s[4:7], s71 offen offset:128
ds_read_b128 v[244:247], v249 offset:44288
v_mfma_f32_16x16x32_f16 v[128:131], v[224:227], v[28:31], v[128:131]
v_permlane16_swap_b32 v42, v46
s_waitcnt lgkmcnt(2)
v_mfma_f32_16x16x32_f16 v[124:127], v[228:231], v[24:27], v[124:127]
ds_read_b128 v[224:227], v249 offset:45056
v_mfma_f32_16x16x32_f16 v[132:135], v[228:231], v[28:31], v[132:135]
v_permlane16_swap_b32 v43, v47
s_waitcnt lgkmcnt(2)
v_mfma_f32_16x16x32_f16 v[136:139], v[240:243], v[24:27], v[136:139]
ds_read_b128 v[228:231], v249 offset:45312
v_mfma_f32_16x16x32_f16 v[144:147], v[240:243], v[28:31], v[144:147]
v_permlane16_swap_b32 v104, v108
s_waitcnt lgkmcnt(2)
v_mfma_f32_16x16x32_f16 v[140:143], v[244:247], v[24:27], v[140:143]
s_add_u32 s46, s71, 98304
buffer_load_dwordx4 v[0:3], v252, s[4:7], s46 offen
ds_read_b128 v[240:243], v249 offset:49152
v_mfma_f32_16x16x32_f16 v[148:151], v[244:247], v[28:31], v[148:151]
v_permlane16_swap_b32 v105, v109
s_waitcnt lgkmcnt(2)
v_mfma_f32_16x16x32_f16 v[152:155], v[224:227], v[24:27], v[152:155]
ds_read_b128 v[244:247], v249 offset:49408
v_mfma_f32_16x16x32_f16 v[160:163], v[224:227], v[28:31], v[160:163]
v_permlane16_swap_b32 v106, v110
s_waitcnt lgkmcnt(2)
v_mfma_f32_16x16x32_f16 v[156:159], v[228:231], v[24:27], v[156:159]
ds_read_b128 v[224:227], v249 offset:50176
v_mfma_f32_16x16x32_f16 v[164:167], v[228:231], v[28:31], v[164:167]
v_permlane16_swap_b32 v107, v111
s_waitcnt lgkmcnt(2)
v_mfma_f32_16x16x32_f16 v[120:123], v[240:243], v[32:35], v[120:123]
buffer_load_dwordx4 v[24:27], v253, s[32:35], s80 offen nt
ds_read_b128 v[228:231], v249 offset:50432
v_mfma_f32_16x16x32_f16 v[128:131], v[240:243], v[36:39], v[128:131]
v_permlane16_swap_b32 v48, v52
s_waitcnt lgkmcnt(2)
v_mfma_f32_16x16x32_f16 v[124:127], v[244:247], v[32:35], v[124:127]
ds_read_b128 v[240:243], v249 offset:51200
v_mfma_f32_16x16x32_f16 v[132:135], v[244:247], v[36:39], v[132:135]
v_permlane16_swap_b32 v49, v53
s_waitcnt lgkmcnt(2)
v_mfma_f32_16x16x32_f16 v[136:139], v[224:227], v[32:35], v[136:139]
ds_read_b128 v[244:247], v249 offset:51456
v_permlane16_swap_b32 v50, v54
v_mfma_f32_16x16x32_f16 v[144:147], v[224:227], v[36:39], v[144:147]
s_waitcnt lgkmcnt(2)
v_mfma_f32_16x16x32_f16 v[140:143], v[228:231], v[32:35], v[140:143]
ds_read_b128 v[224:227], v249 offset:55296
v_permlane16_swap_b32 v51, v55
v_mfma_f32_16x16x32_f16 v[148:151], v[228:231], v[36:39], v[148:151]
v_permlane16_swap_b32 v56, v60
s_waitcnt lgkmcnt(2)
v_mfma_f32_16x16x32_f16 v[152:155], v[240:243], v[32:35], v[152:155]
ds_read_b128 v[228:231], v249 offset:55552
v_mfma_f32_16x16x32_f16 v[160:163], v[240:243], v[36:39], v[160:163]
v_permlane16_swap_b32 v57, v61
s_waitcnt lgkmcnt(2)
v_mfma_f32_16x16x32_f16 v[156:159], v[244:247], v[32:35], v[156:159]
ds_read_b128 v[240:243], v249 offset:56320
v_permlane16_swap_b32 v58, v62
v_mfma_f32_16x16x32_f16 v[164:167], v[244:247], v[36:39], v[164:167]
s_waitcnt lgkmcnt(2)
v_mfma_f32_16x16x32_f16 v[120:123], v[224:227], v[40:43], v[120:123]
buffer_load_dwordx4 v[28:31], v253, s[32:35], s80 offen offset:256 nt
ds_read_b128 v[244:247], v249 offset:56576
v_permlane16_swap_b32 v59, v63
v_mfma_f32_16x16x32_f16 v[128:131], v[224:227], v[44:47], v[128:131]
v_and_b32_e64 v16, 1, v251
v_lshlrev_b32 v16, 4, v16
s_waitcnt lgkmcnt(2)
v_mfma_f32_16x16x32_f16 v[124:127], v[228:231], v[40:43], v[124:127]
ds_read_b128 v[224:227], v249 offset:57344
v_mov_b32 v17, 16256
v_mfma_f32_16x16x32_f16 v[132:135], v[228:231], v[44:47], v[132:135]
v_lshlrev_b32 v16, v16, v17
s_waitcnt lgkmcnt(2)
v_mfma_f32_16x16x32_f16 v[136:139], v[240:243], v[40:43], v[136:139]
ds_read_b128 v[228:231], v249 offset:57600
v_lshrrev_b32 v17, 2, v251
v_mfma_f32_16x16x32_f16 v[144:147], v[240:243], v[44:47], v[144:147]
v_xor_b32 v17, v17, v251
v_and_b32 v17, 12, v17
s_waitcnt lgkmcnt(2)
v_mfma_f32_16x16x32_f16 v[140:143], v[244:247], v[40:43], v[140:143]
ds_read_b128 v[240:243], v249 offset:61440
v_and_b32_e64 v20, 2, v251
v_mfma_f32_16x16x32_f16 v[148:151], v[244:247], v[44:47], v[148:151]
v_or_b32 v17, v17, v20
s_waitcnt lgkmcnt(2)
v_mfma_f32_16x16x32_f16 v[152:155], v[224:227], v[40:43], v[152:155]
ds_read_b128 v[244:247], v249 offset:61696
v_cmp_eq_u32 vcc, 0, v17
s_nop 1
v_cndmask_b32 v18, 0, v16, vcc
v_cmp_eq_u32 vcc, 2, v17
s_nop 1
v_cndmask_b32 v19, 0, v16, vcc
v_mfma_f32_16x16x32_f16 v[160:163], v[224:227], v[44:47], v[160:163]
v_mov_b32 v16, 0
s_waitcnt lgkmcnt(2)
v_mfma_f32_16x16x32_f16 v[156:159], v[228:231], v[40:43], v[156:159]
ds_read_b128 v[224:227], v249 offset:62464
v_mov_b32_e64 v17, 0
v_mfma_f32_16x16x32_f16 v[164:167], v[228:231], v[44:47], v[164:167]
v_mov_b32 v20, 0
v_mov_b32 v21, 0
s_waitcnt lgkmcnt(2)
v_mfma_f32_16x16x32_f16 v[120:123], v[240:243], v[48:51], v[120:123]
s_add_u32 s46, s80, 4194304
buffer_load_dwordx4 v[32:35], v253, s[32:35], s46 offen nt
ds_read_b128 v[228:231], v249 offset:62720
v_mfma_f32_16x16x32_f16 v[128:131], v[240:243], v[52:55], v[128:131]
s_waitcnt lgkmcnt(2)
v_mfma_f32_16x16x32_f16 v[124:127], v[244:247], v[48:51], v[124:127]
ds_read_b128 v[240:243], v249 offset:63488
v_permlane16_swap_b32 v64, v68
v_mfma_f32_16x16x32_f16 v[132:135], v[244:247], v[52:55], v[132:135]
s_waitcnt lgkmcnt(2)
v_mfma_f32_16x16x32_f16 v[136:139], v[224:227], v[48:51], v[136:139]
ds_read_b128 v[244:247], v249 offset:63744
v_permlane16_swap_b32 v65, v69
v_mfma_f32_16x16x32_f16 v[144:147], v[224:227], v[52:55], v[144:147]
s_waitcnt lgkmcnt(2)
v_mfma_f32_16x16x32_f16 v[140:143], v[228:231], v[48:51], v[140:143]
ds_read_b128 v[224:227], v250 offset:2048
v_permlane16_swap_b32 v66, v70
v_mfma_f32_16x16x32_f16 v[148:151], v[228:231], v[52:55], v[148:151]
s_waitcnt lgkmcnt(2)
v_mfma_f32_16x16x32_f16 v[152:155], v[240:243], v[48:51], v[152:155]
ds_read_b128 v[228:231], v250 offset:2304
v_mfma_f32_16x16x32_f16 v[160:163], v[240:243], v[52:55], v[160:163]
v_permlane16_swap_b32 v67, v71
s_waitcnt lgkmcnt(2)
v_mfma_f32_16x16x32_f16 v[156:159], v[244:247], v[48:51], v[156:159]
ds_read_b128 v[240:243], v250 offset:3072
v_mfma_f32_16x16x32_f16 v[164:167], v[244:247], v[52:55], v[164:167]
v_permlane16_swap_b32 v72, v76
s_waitcnt lgkmcnt(2)
v_mfma_f32_16x16x32_f16 v[120:123], v[224:227], v[56:59], v[120:123]
ds_read_b128 v[244:247], v250 offset:3328
v_mfma_f32_16x16x32_f16 v[128:131], v[224:227], v[60:63], v[128:131]
v_permlane16_swap_b32 v73, v77
s_waitcnt lgkmcnt(2)
v_mfma_f32_16x16x32_f16 v[124:127], v[228:231], v[56:59], v[124:127]
s_add_u32 s46, s80, 4194304
buffer_load_dwordx4 v[36:39], v253, s[32:35], s46 offen offset:256 nt
ds_read_b128 v[224:227], v250 offset:4096
v_mfma_f32_16x16x32_f16 v[132:135], v[228:231], v[60:63], v[132:135]
s_waitcnt lgkmcnt(2)
v_mfma_f32_16x16x32_f16 v[136:139], v[240:243], v[56:59], v[136:139]
ds_read_b128 v[228:231], v250 offset:4352
v_permlane16_swap_b32 v74, v78
v_mfma_f32_16x16x32_f16 v[144:147], v[240:243], v[60:63], v[144:147]
s_waitcnt lgkmcnt(2)
v_mfma_f32_16x16x32_f16 v[140:143], v[244:247], v[56:59], v[140:143]
ds_read_b128 v[240:243], v250 offset:8192
v_permlane16_swap_b32 v75, v79
v_mfma_f32_16x16x32_f16 v[148:151], v[244:247], v[60:63], v[148:151]
s_waitcnt lgkmcnt(2)
v_mfma_f32_16x16x32_f16 v[152:155], v[224:227], v[56:59], v[152:155]
ds_read_b128 v[244:247], v250 offset:8448
v_permlane16_swap_b32 v192, v196
v_mfma_f32_16x16x32_f16 v[160:163], v[224:227], v[60:63], v[160:163]
s_waitcnt lgkmcnt(2)
v_mfma_f32_16x16x32_f16 v[156:159], v[228:231], v[56:59], v[156:159]
ds_read_b128 v[224:227], v250 offset:9216
v_mfma_f32_16x16x32_f16 v[164:167], v[228:231], v[60:63], v[164:167]
v_permlane16_swap_b32 v193, v197
s_waitcnt vmcnt(7)
v_mfma_f32_16x16x32_bf16 v[120:123], v[18:21], v[12:15], v[120:123]
ds_read_b128 v[228:231], v250 offset:9472
v_mfma_f32_16x16x32_bf16 v[124:127], v[16:19], v[12:15], v[124:127]
v_permlane16_swap_b32 v194, v198
s_waitcnt vmcnt(6)
v_mfma_f32_16x16x32_bf16 v[136:139], v[18:21], v[8:11], v[136:139]
v_mfma_f32_16x16x32_bf16 v[140:143], v[16:19], v[8:11], v[140:143]
v_permlane16_swap_b32 v195, v199
s_waitcnt lgkmcnt(3)
v_mfma_f32_16x16x32_f16 v[120:123], v[240:243], v[64:67], v[120:123]
s_add_u32 s46, s80, 8388608
buffer_load_dwordx4 v[40:43], v253, s[32:35], s46 offen nt
v_mfma_f32_16x16x32_f16 v[128:131], v[240:243], v[68:71], v[128:131]
s_waitcnt lgkmcnt(2)
v_mfma_f32_16x16x32_f16 v[124:127], v[244:247], v[64:67], v[124:127]
ds_read_b128 v[240:243], v250 offset:10240
v_permlane16_swap_b32 v80, v84
v_mfma_f32_16x16x32_f16 v[132:135], v[244:247], v[68:71], v[132:135]
s_waitcnt lgkmcnt(2)
v_mfma_f32_16x16x32_f16 v[136:139], v[224:227], v[64:67], v[136:139]
ds_read_b128 v[244:247], v250 offset:10496
v_permlane16_swap_b32 v81, v85
v_mfma_f32_16x16x32_f16 v[144:147], v[224:227], v[68:71], v[144:147]
s_waitcnt lgkmcnt(2)
v_mfma_f32_16x16x32_f16 v[140:143], v[228:231], v[64:67], v[140:143]
ds_read_b128 v[224:227], v250 offset:14336
v_permlane16_swap_b32 v82, v86
v_mfma_f32_16x16x32_f16 v[148:151], v[228:231], v[68:71], v[148:151]
s_waitcnt lgkmcnt(2)
v_mfma_f32_16x16x32_f16 v[152:155], v[240:243], v[64:67], v[152:155]
s_add_u32 s46, s80, 8388608
buffer_load_dwordx4 v[44:47], v253, s[32:35], s46 offen offset:256 nt
ds_read_b128 v[228:231], v250 offset:14592
v_mfma_f32_16x16x32_f16 v[160:163], v[240:243], v[68:71], v[160:163]
v_permlane16_swap_b32 v83, v87
s_waitcnt lgkmcnt(2)
v_mfma_f32_16x16x32_f16 v[156:159], v[244:247], v[64:67], v[156:159]
ds_read_b128 v[240:243], v250 offset:15360
v_mfma_f32_16x16x32_f16 v[164:167], v[244:247], v[68:71], v[164:167]
v_permlane16_swap_b32 v88, v92
s_waitcnt lgkmcnt(2)
v_mfma_f32_16x16x32_f16 v[120:123], v[224:227], v[72:75], v[120:123]
ds_read_b128 v[244:247], v250 offset:15616
v_mfma_f32_16x16x32_f16 v[128:131], v[224:227], v[76:79], v[128:131]
v_permlane16_swap_b32 v89, v93
s_waitcnt lgkmcnt(2)
v_mfma_f32_16x16x32_f16 v[124:127], v[228:231], v[72:75], v[124:127]
s_add_u32 s46, s71, 98304
buffer_load_dwordx4 v[8:11], v252, s[4:7], s46 offen offset:64
ds_read_b128 v[224:227], v250 offset:16384
v_mfma_f32_16x16x32_f16 v[132:135], v[228:231], v[76:79], v[132:135]
s_waitcnt lgkmcnt(2)
v_mfma_f32_16x16x32_f16 v[136:139], v[240:243], v[72:75], v[136:139]
ds_read_b128 v[228:231], v250 offset:16640
v_permlane16_swap_b32 v90, v94
v_mfma_f32_16x16x32_f16 v[144:147], v[240:243], v[76:79], v[144:147]
s_waitcnt lgkmcnt(2)
v_mfma_f32_16x16x32_f16 v[140:143], v[244:247], v[72:75], v[140:143]
ds_read_b128 v[240:243], v250 offset:20480
v_permlane16_swap_b32 v91, v95
v_mfma_f32_16x16x32_f16 v[148:151], v[244:247], v[76:79], v[148:151]
s_waitcnt lgkmcnt(2)
v_mfma_f32_16x16x32_f16 v[152:155], v[224:227], v[72:75], v[152:155]
ds_read_b128 v[244:247], v250 offset:20736
v_permlane16_swap_b32 v184, v188
v_mfma_f32_16x16x32_f16 v[160:163], v[224:227], v[76:79], v[160:163]
s_waitcnt lgkmcnt(2)
v_mfma_f32_16x16x32_f16 v[156:159], v[228:231], v[72:75], v[156:159]
s_add_u32 s46, s71, 98304
buffer_load_dwordx4 v[12:15], v252, s[4:7], s46 offen offset:128
ds_read_b128 v[224:227], v250 offset:21504
v_mfma_f32_16x16x32_f16 v[164:167], v[228:231], v[76:79], v[164:167]
v_permlane16_swap_b32 v185, v189
s_waitcnt vmcnt(9)
v_mfma_f32_16x16x32_bf16 v[152:155], v[18:21], v[4:7], v[152:155]
ds_read_b128 v[228:231], v250 offset:21760
v_mfma_f32_16x16x32_bf16 v[156:159], v[16:19], v[4:7], v[156:159]
v_permlane16_swap_b32 v186, v190
s_waitcnt vmcnt(8)
v_mfma_f32_16x16x32_bf16 v[128:131], v[18:21], v[0:3], v[128:131]
v_mfma_f32_16x16x32_bf16 v[132:135], v[16:19], v[0:3], v[132:135]
v_permlane16_swap_b32 v187, v191
v_and_b32 v255, 1, v251
v_lshlrev_b32 v255, 7, v255
v_sub_u32 v255, v252, v255
s_mov_b32 s74, 1431655765
s_mov_b32 s75, 1431655765
s_waitcnt lgkmcnt(3)
v_mfma_f32_16x16x32_f16 v[120:123], v[240:243], v[80:83], v[120:123]
buffer_load_dwordx4 v[4:7], v252, s[4:7], s70 offen
v_mfma_f32_16x16x32_f16 v[128:131], v[240:243], v[84:87], v[128:131]
v_permlane16_swap_b32 v168, v172
s_waitcnt lgkmcnt(2)
v_mfma_f32_16x16x32_f16 v[124:127], v[244:247], v[80:83], v[124:127]
ds_read_b128 v[240:243], v250 offset:22528
v_mfma_f32_16x16x32_f16 v[132:135], v[244:247], v[84:87], v[132:135]
v_permlane16_swap_b32 v169, v173
s_waitcnt lgkmcnt(2)
v_mfma_f32_16x16x32_f16 v[136:139], v[224:227], v[80:83], v[136:139]
ds_read_b128 v[244:247], v250 offset:22784
v_mfma_f32_16x16x32_f16 v[144:147], v[224:227], v[84:87], v[144:147]
v_permlane16_swap_b32 v170, v174
s_waitcnt lgkmcnt(2)
v_mfma_f32_16x16x32_f16 v[140:143], v[228:231], v[80:83], v[140:143]
ds_read_b128 v[224:227], v250 offset:26624
v_mfma_f32_16x16x32_f16 v[148:151], v[228:231], v[84:87], v[148:151]
v_permlane16_swap_b32 v171, v175
s_waitcnt lgkmcnt(2)
v_mfma_f32_16x16x32_f16 v[152:155], v[240:243], v[80:83], v[152:155]
ds_read_b128 v[228:231], v250 offset:26880
v_mfma_f32_16x16x32_f16 v[160:163], v[240:243], v[84:87], v[160:163]
v_permlane16_swap_b32 v176, v180
s_waitcnt lgkmcnt(2)
v_mfma_f32_16x16x32_f16 v[156:159], v[244:247], v[80:83], v[156:159]
ds_read_b128 v[240:243], v250 offset:27648
v_mfma_f32_16x16x32_f16 v[164:167], v[244:247], v[84:87], v[164:167]
v_permlane16_swap_b32 v177, v181
s_waitcnt lgkmcnt(2)
v_mfma_f32_16x16x32_f16 v[120:123], v[224:227], v[88:91], v[120:123]
buffer_load_dwordx4 v[0:3], v252, s[4:7], s70 offen offset:64
ds_read_b128 v[244:247], v250 offset:27904
v_mfma_f32_16x16x32_f16 v[128:131], v[224:227], v[92:95], v[128:131]
v_permlane16_swap_b32 v178, v182
s_waitcnt lgkmcnt(2)
v_mfma_f32_16x16x32_f16 v[124:127], v[228:231], v[88:91], v[124:127]
ds_read_b128 v[224:227], v250 offset:28672
v_mfma_f32_16x16x32_f16 v[132:135], v[228:231], v[92:95], v[132:135]
v_permlane16_swap_b32 v179, v183
s_waitcnt lgkmcnt(2)
v_mfma_f32_16x16x32_f16 v[136:139], v[240:243], v[88:91], v[136:139]
ds_read_b128 v[228:231], v250 offset:28928
v_mfma_f32_16x16x32_f16 v[144:147], v[240:243], v[92:95], v[144:147]
v_permlane16_swap_b32 v112, v116
s_waitcnt lgkmcnt(2)
v_mfma_f32_16x16x32_f16 v[140:143], v[244:247], v[88:91], v[140:143]
ds_read_b128 v[240:243], v249 offset:49152
v_mfma_f32_16x16x32_f16 v[148:151], v[244:247], v[92:95], v[148:151]
v_permlane16_swap_b32 v113, v117
s_waitcnt lgkmcnt(2)
v_mfma_f32_16x16x32_f16 v[152:155], v[224:227], v[88:91], v[152:155]
ds_read_b128 v[244:247], v254 offset:7936
v_mfma_f32_16x16x32_f16 v[160:163], v[224:227], v[92:95], v[160:163]
v_permlane16_swap_b32 v114, v118
s_waitcnt lgkmcnt(2)
v_mfma_f32_16x16x32_f16 v[156:159], v[228:231], v[88:91], v[156:159]
ds_read_b128 v[224:227], v249 offset:49408
v_mfma_f32_16x16x32_f16 v[164:167], v[228:231], v[92:95], v[164:167]
v_permlane16_swap_b32 v115, v119
s_waitcnt lgkmcnt(1)
v_mfma_f32_16x16x32_f16 v[48:51], v[240:243], v[168:171], v[244:247]
ds_read_b128 v[228:231], v254 offset:7952
v_mfma_f32_16x16x32_f16 v[56:59], v[240:243], v[172:175], v[244:247]
s_waitcnt lgkmcnt(0)
v_mfma_f32_16x16x32_f16 v[52:55], v[224:227], v[168:171], v[228:231]
ds_read_b128 v[240:243], v249 offset:50176
ds_read_b128 v[244:247], v254 offset:8064
v_mfma_f32_16x16x32_f16 v[60:63], v[224:227], v[172:175], v[228:231]
s_waitcnt lgkmcnt(0)
v_mfma_f32_16x16x32_f16 v[64:67], v[240:243], v[168:171], v[244:247]
ds_read_b128 v[224:227], v249 offset:50432
ds_read_b128 v[228:231], v254 offset:8080
v_mfma_f32_16x16x32_f16 v[72:75], v[240:243], v[172:175], v[244:247]
s_waitcnt lgkmcnt(0)
v_mfma_f32_16x16x32_f16 v[68:71], v[224:227], v[168:171], v[228:231]
ds_read_b128 v[240:243], v249 offset:51200
ds_read_b128 v[244:247], v254 offset:16128
v_cvt_pk_bf16_f32 v136, v136, v137
v_mfma_f32_16x16x32_f16 v[76:79], v[224:227], v[172:175], v[228:231]
v_cvt_pk_bf16_f32 v137, v138, v139
s_waitcnt lgkmcnt(0)
v_mfma_f32_16x16x32_f16 v[80:83], v[240:243], v[168:171], v[244:247]
ds_read_b128 v[224:227], v249 offset:51456
ds_read_b128 v[228:231], v254 offset:16144
v_cvt_pk_bf16_f32 v138, v140, v141
v_mfma_f32_16x16x32_f16 v[88:91], v[240:243], v[172:175], v[244:247]
v_cvt_pk_bf16_f32 v139, v142, v143
s_waitcnt lgkmcnt(0)
v_mfma_f32_16x16x32_f16 v[84:87], v[224:227], v[168:171], v[228:231]
ds_read_b128 v[240:243], v249 offset:55296
ds_read_b128 v[244:247], v249 offset:55552
v_cvt_pk_bf16_f32 v120, v120, v121
v_mfma_f32_16x16x32_f16 v[92:95], v[224:227], v[172:175], v[228:231]
v_cvt_pk_bf16_f32 v121, v122, v123
s_waitcnt lgkmcnt(1)
v_mfma_f32_16x16x32_f16 v[48:51], v[240:243], v[176:179], v[48:51]
ds_read_b128 v[224:227], v249 offset:56320
ds_read_b128 v[228:231], v249 offset:56576
v_cvt_pk_bf16_f32 v122, v124, v125
v_mfma_f32_16x16x32_f16 v[56:59], v[240:243], v[180:183], v[56:59]
v_cvt_pk_bf16_f32 v123, v126, v127
s_waitcnt lgkmcnt(2)
v_mfma_f32_16x16x32_f16 v[52:55], v[244:247], v[176:179], v[52:55]
ds_read_b128 v[240:243], v249 offset:57344
v_cvt_pk_bf16_f32 v152, v152, v153
v_cvt_pk_bf16_f32 v153, v154, v155
v_mfma_f32_16x16x32_f16 v[60:63], v[244:247], v[180:183], v[60:63]
v_cvt_pk_bf16_f32 v154, v156, v157
s_waitcnt lgkmcnt(2)
v_mfma_f32_16x16x32_f16 v[64:67], v[224:227], v[176:179], v[64:67]
ds_read_b128 v[244:247], v249 offset:57600
v_cvt_pk_bf16_f32 v155, v158, v159
s_mov_b64 vcc, s[74:75]
v_mfma_f32_16x16x32_f16 v[72:75], v[224:227], v[180:183], v[72:75]
v_cndmask_b32 v140, v120, v152, vcc
s_waitcnt lgkmcnt(2)
v_mfma_f32_16x16x32_f16 v[68:71], v[228:231], v[176:179], v[68:71]
ds_read_b128 v[224:227], v249 offset:61440
v_cndmask_b32 v141, v121, v153, vcc
v_mfma_f32_16x16x32_f16 v[76:79], v[228:231], v[180:183], v[76:79]
v_cndmask_b32 v142, v122, v154, vcc
s_waitcnt lgkmcnt(2)
v_mfma_f32_16x16x32_f16 v[80:83], v[240:243], v[176:179], v[80:83]
ds_read_b128 v[228:231], v249 offset:61696
v_cndmask_b32 v143, v123, v155, vcc
v_mfma_f32_16x16x32_f16 v[88:91], v[240:243], v[180:183], v[88:91]
v_cndmask_b32_dpp v120, v136, v120, vcc quad_perm:[1,0,3,2] row_mask:0xf bank_mask:0xf
s_waitcnt lgkmcnt(2)
v_mfma_f32_16x16x32_f16 v[84:87], v[244:247], v[176:179], v[84:87]
ds_read_b128 v[240:243], v248 offset:16384
v_cndmask_b32_dpp v121, v137, v121, vcc quad_perm:[1,0,3,2] row_mask:0xf bank_mask:0xf
v_mfma_f32_16x16x32_f16 v[92:95], v[244:247], v[180:183], v[92:95]
v_cndmask_b32_dpp v122, v138, v122, vcc quad_perm:[1,0,3,2] row_mask:0xf bank_mask:0xf
s_waitcnt vmcnt(3)
v_mfma_f32_16x16x32_bf16 v[144:147], v[18:21], v[8:11], v[144:147]
ds_read_b128 v[244:247], v249 offset:62464
v_cndmask_b32_dpp v123, v139, v123, vcc quad_perm:[1,0,3,2] row_mask:0xf bank_mask:0xf
s_not_b64 vcc, s[74:75]
v_mfma_f32_16x16x32_bf16 v[148:151], v[16:19], v[8:11], v[148:151]
v_cndmask_b32_dpp v152, v136, v152, vcc quad_perm:[1,0,3,2] row_mask:0xf bank_mask:0xf
s_waitcnt vmcnt(2)
v_mfma_f32_16x16x32_bf16 v[160:163], v[18:21], v[12:15], v[160:163]
v_cndmask_b32_dpp v153, v137, v153, vcc quad_perm:[1,0,3,2] row_mask:0xf bank_mask:0xf
v_mfma_f32_16x16x32_bf16 v[164:167], v[16:19], v[12:15], v[164:167]
v_cndmask_b32_dpp v154, v138, v154, vcc quad_perm:[1,0,3,2] row_mask:0xf bank_mask:0xf
v_cndmask_b32_dpp v155, v139, v155, vcc quad_perm:[1,0,3,2] row_mask:0xf bank_mask:0xf
s_waitcnt lgkmcnt(3)
v_mfma_f32_16x16x32_f16 v[48:51], v[224:227], v[184:187], v[48:51]
buffer_load_dwordx4 v[8:11], v252, s[4:7], s70 offen offset:128
buffer_store_dwordx4 v[120:123], v255, s[8:11], s71 offen sc1
v_mfma_f32_16x16x32_f16 v[56:59], v[224:227], v[188:191], v[56:59]
s_waitcnt lgkmcnt(2)
v_mfma_f32_16x16x32_f16 v[52:55], v[228:231], v[184:187], v[52:55]
ds_read_b128 v[224:227], v249 offset:62720
v_permlane16_swap_b32 v200, v204
v_mfma_f32_16x16x32_f16 v[60:63], v[228:231], v[188:191], v[60:63]
s_waitcnt lgkmcnt(2)
v_mfma_f32_16x16x32_bf16 v[168:171], v[240:243], v[96:99], 0
ds_read_b128 v[228:231], v249 offset:63488
v_permlane16_swap_b32 v201, v205
v_mfma_f32_16x16x32_bf16 v[176:179], v[240:243], v[100:103], 0
s_waitcnt lgkmcnt(2)
v_mfma_f32_16x16x32_f16 v[64:67], v[244:247], v[184:187], v[64:67]
ds_read_b128 v[240:243], v249 offset:63744
v_mfma_f32_16x16x32_f16 v[72:75], v[244:247], v[188:191], v[72:75]
v_permlane16_swap_b32 v202, v206
s_waitcnt lgkmcnt(2)
v_mfma_f32_16x16x32_f16 v[68:71], v[224:227], v[184:187], v[68:71]
ds_read_b128 v[244:247], v248 offset:16640
v_mfma_f32_16x16x32_f16 v[76:79], v[224:227], v[188:191], v[76:79]
v_permlane16_swap_b32 v203, v207
s_waitcnt lgkmcnt(2)
v_mfma_f32_16x16x32_f16 v[80:83], v[228:231], v[184:187], v[80:83]
s_add_u32 s46, s70, 98304
buffer_load_dwordx4 v[12:15], v252, s[4:7], s46 offen
ds_read_b128 v[224:227], v250 offset:2048
v_mfma_f32_16x16x32_f16 v[88:91], v[228:231], v[188:191], v[88:91]
s_waitcnt lgkmcnt(2)
v_mfma_f32_16x16x32_f16 v[84:87], v[240:243], v[184:187], v[84:87]
ds_read_b128 v[228:231], v250 offset:2304
v_permlane16_swap_b32 v232, v236
v_mfma_f32_16x16x32_f16 v[92:95], v[240:243], v[188:191], v[92:95]
s_waitcnt lgkmcnt(2)
v_mfma_f32_16x16x32_bf16 v[172:175], v[244:247], v[96:99], 0
ds_read_b128 v[240:243], v250 offset:3072
v_permlane16_swap_b32 v233, v237
v_mfma_f32_16x16x32_bf16 v[180:183], v[244:247], v[100:103], 0
s_waitcnt lgkmcnt(2)
v_mfma_f32_16x16x32_f16 v[48:51], v[224:227], v[192:195], v[48:51]
ds_read_b128 v[244:247], v250 offset:3328
v_mfma_f32_16x16x32_f16 v[56:59], v[224:227], v[196:199], v[56:59]
v_permlane16_swap_b32 v234, v238
s_waitcnt lgkmcnt(2)
v_mfma_f32_16x16x32_f16 v[52:55], v[228:231], v[192:195], v[52:55]
ds_read_b128 v[224:227], v248 offset:17408
v_mfma_f32_16x16x32_f16 v[60:63], v[228:231], v[196:199], v[60:63]
v_permlane16_swap_b32 v235, v239
s_waitcnt lgkmcnt(2)
v_mfma_f32_16x16x32_f16 v[64:67], v[240:243], v[192:195], v[64:67]
buffer_store_dwordx4 v[140:143], v255, s[8:11], s71 offen offset:128 sc1
ds_read_b128 v[228:231], v250 offset:4096
v_mfma_f32_16x16x32_f16 v[72:75], v[240:243], v[196:199], v[72:75]
s_waitcnt lgkmcnt(2)
v_mfma_f32_16x16x32_f16 v[68:71], v[244:247], v[192:195], v[68:71]
ds_read_b128 v[240:243], v250 offset:4352
v_permlane16_swap_b32 v208, v212
v_mfma_f32_16x16x32_f16 v[76:79], v[244:247], v[196:199], v[76:79]
s_waitcnt lgkmcnt(2)
v_mfma_f32_16x16x32_bf16 v[168:171], v[224:227], v[104:107], v[168:171]
ds_read_b128 v[244:247], v250 offset:8192
v_permlane16_swap_b32 v209, v213
v_mfma_f32_16x16x32_bf16 v[176:179], v[224:227], v[108:111], v[176:179]
s_waitcnt lgkmcnt(2)
v_mfma_f32_16x16x32_f16 v[80:83], v[228:231], v[192:195], v[80:83]
ds_read_b128 v[224:227], v250 offset:8448
v_mfma_f32_16x16x32_f16 v[88:91], v[228:231], v[196:199], v[88:91]
v_permlane16_swap_b32 v210, v214
s_waitcnt lgkmcnt(2)
v_mfma_f32_16x16x32_f16 v[84:87], v[240:243], v[192:195], v[84:87]
ds_read_b128 v[228:231], v248 offset:17664
v_mfma_f32_16x16x32_f16 v[92:95], v[240:243], v[196:199], v[92:95]
v_permlane16_swap_b32 v211, v215
s_waitcnt lgkmcnt(2)
v_mfma_f32_16x16x32_f16 v[48:51], v[244:247], v[200:203], v[48:51]
buffer_store_dwordx4 v[152:155], v255, s[8:11], s71 offen offset:256 sc1
ds_read_b128 v[240:243], v250 offset:9216
v_mfma_f32_16x16x32_f16 v[56:59], v[244:247], v[204:207], v[56:59]
s_waitcnt lgkmcnt(2)
v_mfma_f32_16x16x32_f16 v[52:55], v[224:227], v[200:203], v[52:55]
ds_read_b128 v[244:247], v250 offset:9472
v_mfma_f32_16x16x32_f16 v[60:63], v[224:227], v[204:207], v[60:63]
s_waitcnt lgkmcnt(2)
v_mfma_f32_16x16x32_bf16 v[172:175], v[228:231], v[104:107], v[172:175]
ds_read_b128 v[224:227], v250 offset:10240
v_mfma_f32_16x16x32_bf16 v[180:183], v[228:231], v[108:111], v[180:183]
s_waitcnt lgkmcnt(2)
v_mfma_f32_16x16x32_f16 v[64:67], v[240:243], v[200:203], v[64:67]
ds_read_b128 v[228:231], v250 offset:10496
v_mfma_f32_16x16x32_f16 v[72:75], v[240:243], v[204:207], v[72:75]
s_waitcnt lgkmcnt(2)
v_mfma_f32_16x16x32_f16 v[68:71], v[244:247], v[200:203], v[68:71]
ds_read_b128 v[240:243], v248 offset:18432
v_mfma_f32_16x16x32_f16 v[76:79], v[244:247], v[204:207], v[76:79]
s_waitcnt lgkmcnt(2)
v_mfma_f32_16x16x32_f16 v[80:83], v[224:227], v[200:203], v[80:83]
ds_read_b128 v[244:247], v250 offset:14336
v_permlane16_swap_b32 v216, v220
v_mfma_f32_16x16x32_f16 v[88:91], v[224:227], v[204:207], v[88:91]
s_waitcnt lgkmcnt(2)
v_mfma_f32_16x16x32_f16 v[84:87], v[228:231], v[200:203], v[84:87]
ds_read_b128 v[224:227], v250 offset:14592
v_mfma_f32_16x16x32_f16 v[92:95], v[228:231], v[204:207], v[92:95]
s_waitcnt lgkmcnt(2)
v_mfma_f32_16x16x32_bf16 v[168:171], v[240:243], v[112:115], v[168:171]
ds_read_b128 v[228:231], v250 offset:15360
v_mfma_f32_16x16x32_bf16 v[176:179], v[240:243], v[116:119], v[176:179]
s_waitcnt lgkmcnt(2)
v_mfma_f32_16x16x32_f16 v[48:51], v[244:247], v[232:235], v[48:51]
ds_read_b128 v[240:243], v250 offset:15616
v_mfma_f32_16x16x32_f16 v[56:59], v[244:247], v[236:239], v[56:59]
s_waitcnt lgkmcnt(2)
v_mfma_f32_16x16x32_f16 v[52:55], v[224:227], v[232:235], v[52:55]
ds_read_b128 v[244:247], v248 offset:18688
v_mfma_f32_16x16x32_f16 v[60:63], v[224:227], v[236:239], v[60:63]
s_waitcnt lgkmcnt(2)
v_mfma_f32_16x16x32_f16 v[64:67], v[228:231], v[232:235], v[64:67]
ds_read_b128 v[224:227], v250 offset:16384
v_mfma_f32_16x16x32_f16 v[72:75], v[228:231], v[236:239], v[72:75]
v_permlane16_swap_b32 v217, v221
s_waitcnt lgkmcnt(2)
v_mfma_f32_16x16x32_f16 v[68:71], v[240:243], v[232:235], v[68:71]
ds_read_b128 v[228:231], v250 offset:16640
v_mfma_f32_16x16x32_f16 v[76:79], v[240:243], v[236:239], v[76:79]
s_waitcnt lgkmcnt(2)
v_mfma_f32_16x16x32_bf16 v[172:175], v[244:247], v[112:115], v[172:175]
ds_read_b128 v[240:243], v250 offset:20480
v_mfma_f32_16x16x32_bf16 v[180:183], v[244:247], v[116:119], v[180:183]
s_waitcnt lgkmcnt(2)
v_mfma_f32_16x16x32_f16 v[80:83], v[224:227], v[232:235], v[80:83]
ds_read_b128 v[244:247], v250 offset:20736
v_mfma_f32_16x16x32_f16 v[88:91], v[224:227], v[236:239], v[88:91]
s_waitcnt lgkmcnt(2)
v_mfma_f32_16x16x32_f16 v[84:87], v[228:231], v[232:235], v[84:87]
ds_read_b128 v[224:227], v250 offset:21504
v_mfma_f32_16x16x32_f16 v[92:95], v[228:231], v[236:239], v[92:95]
s_waitcnt lgkmcnt(2)
v_mfma_f32_16x16x32_f16 v[48:51], v[240:243], v[208:211], v[48:51]
ds_read_b128 v[228:231], v250 offset:21760
v_mfma_f32_16x16x32_f16 v[56:59], v[240:243], v[212:215], v[56:59]
v_permlane16_swap_b32 v218, v222
s_waitcnt lgkmcnt(2)
v_mfma_f32_16x16x32_f16 v[52:55], v[244:247], v[208:211], v[52:55]
ds_read_b128 v[240:243], v250 offset:22528
v_mfma_f32_16x16x32_f16 v[60:63], v[244:247], v[212:215], v[60:63]
s_waitcnt lgkmcnt(2)
v_mfma_f32_16x16x32_f16 v[64:67], v[224:227], v[208:211], v[64:67]
ds_read_b128 v[244:247], v250 offset:22784
v_mfma_f32_16x16x32_f16 v[72:75], v[224:227], v[212:215], v[72:75]
s_waitcnt lgkmcnt(2)
v_mfma_f32_16x16x32_f16 v[68:71], v[228:231], v[208:211], v[68:71]
ds_read_b128 v[224:227], v250 offset:26624
v_mfma_f32_16x16x32_f16 v[76:79], v[228:231], v[212:215], v[76:79]
s_waitcnt lgkmcnt(2)
v_mfma_f32_16x16x32_f16 v[80:83], v[240:243], v[208:211], v[80:83]
ds_read_b128 v[228:231], v250 offset:26880
v_mfma_f32_16x16x32_f16 v[88:91], v[240:243], v[212:215], v[88:91]
s_waitcnt lgkmcnt(2)
v_mfma_f32_16x16x32_f16 v[84:87], v[244:247], v[208:211], v[84:87]
ds_read_b128 v[240:243], v248 offset:22528
v_mfma_f32_16x16x32_f16 v[92:95], v[244:247], v[212:215], v[92:95]
v_permlane16_swap_b32 v219, v223
s_setprio 3
s_waitcnt lgkmcnt(2)
v_mfma_f32_16x16x32_f16 v[48:51], v[224:227], v[216:219], v[48:51]
s_add_u32 s46, s70, 98304
buffer_load_dwordx4 v[208:211], v252, s[4:7], s46 offen offset:64
ds_read_b128 v[244:247], v250 offset:27648
v_cvt_pkrtz_f16_f32 v185, v168, v169
v_cvt_pkrtz_f16_f32 v187, v170, v171
v_cvt_pkrtz_f16_f32 v189, v172, v173
v_mfma_f32_16x16x32_f16 v[56:59], v[224:227], v[220:223], v[56:59]
v_cvt_pkrtz_f16_f32 v191, v174, v175
v_cvt_pkrtz_f16_f32 v193, v176, v177
v_cvt_pkrtz_f16_f32 v195, v178, v179
s_waitcnt lgkmcnt(2)
v_mfma_f32_16x16x32_f16 v[52:55], v[228:231], v[216:219], v[52:55]
ds_read_b128 v[224:227], v248 offset:22784
v_cvt_pk_f16_f32 v203, v180, v181
v_cvt_pk_f16_f32 v200, v182, v183
v_pk_fma_f16 v202, v203, v203, s48
v_mfma_f32_16x16x32_f16 v[60:63], v[228:231], v[220:223], v[60:63]
v_cvt_pk_bf16_f32 v144, v144, v145
v_and_b32 v185, s49, v185
v_cvt_pk_bf16_f32 v145, v146, v147
s_waitcnt lgkmcnt(2)
v_mfma_f32_16x16x32_bf16 v[168:171], v[240:243], v[96:99], 0
ds_read_b128 v[228:231], v250 offset:27904
v_and_b32 v187, s49, v187
v_cvt_pk_bf16_f32 v146, v148, v149
v_pk_fma_f16 v199, v200, v200, s48
v_mfma_f32_16x16x32_bf16 v[176:179], v[240:243], v[100:103], 0
v_bfe_u32 v184, v185, 2, 14
v_cvt_pk_bf16_f32 v147, v150, v151
v_pk_mul_f16 v202, v203, v202
s_waitcnt lgkmcnt(2)
v_mfma_f32_16x16x32_f16 v[64:67], v[244:247], v[216:219], v[64:67]
ds_read_b128 v[240:243], v248 offset:23552
ds_read_u16_d16 v184, v184
v_cvt_pk_bf16_f32 v128, v128, v129
v_bfe_u32 v186, v187, 2, 14
v_pk_mul_f16 v199, v200, v199
v_mfma_f32_16x16x32_f16 v[72:75], v[244:247], v[220:223], v[72:75]
v_cvt_pk_bf16_f32 v129, v130, v131
v_lshrrev_b32 v185, 18, v185
v_cvt_pk_bf16_f32 v130, v132, v133
s_waitcnt lgkmcnt(3)
v_mfma_f32_16x16x32_bf16 v[172:175], v[224:227], v[96:99], 0
ds_read_b128 v[244:247], v250 offset:28672
ds_read_u16_d16 v186, v186
ds_read_u16_d16_hi v185, v185
v_exp_f16_e64 v201, v202
v_cvt_pk_bf16_f32 v131, v134, v135
v_mfma_f32_16x16x32_bf16 v[180:183], v[224:227], v[100:103], 0
v_lshrrev_b32_e64 v187, 18, v187
v_cvt_pk_bf16_f32 v160, v160, v161
v_and_b32 v189, s49, v189
s_waitcnt lgkmcnt(5)
v_mfma_f32_16x16x32_f16 v[68:71], v[228:231], v[216:219], v[68:71]
ds_read_b128 v[224:227], v250 offset:28928
ds_read_u16_d16_hi v187, v187
v_cvt_pk_bf16_f32 v161, v162, v163
v_exp_f16_e64 v198, v199
v_mfma_f32_16x16x32_f16 v[76:79], v[228:231], v[220:223], v[76:79]
v_cvt_pk_bf16_f32 v162, v164, v165
v_and_b32_e64 v191, s49, v191
v_cvt_pk_bf16_f32 v163, v166, v167
s_mov_b64 vcc, s[74:75]
s_waitcnt lgkmcnt(5)
v_mfma_f32_16x16x32_bf16 v[168:171], v[240:243], v[104:107], v[168:171]
s_add_u32 s46, s70, 98304
buffer_load_dwordx4 v[204:207], v252, s[4:7], s46 offen offset:128
ds_read_b128 v[228:231], v248 offset:23808
v_bfe_u32 v188, v189, 2, 14
v_exp_f16_sdwa v201, v202 dst_sel:WORD_1 dst_unused:UNUSED_PRESERVE src0_sel:WORD_1
v_mfma_f32_16x16x32_bf16 v[176:179], v[240:243], v[108:111], v[176:179]
v_cndmask_b32 v148, v128, v160, vcc
v_cndmask_b32 v149, v129, v161, vcc
v_bfe_u32 v190, v191, 2, 14
s_waitcnt lgkmcnt(3)
v_mfma_f32_16x16x32_f16 v[80:83], v[244:247], v[216:219], v[80:83]
ds_read_b128 v[240:243], v248 offset:24576
ds_read_u16_d16 v188, v188
ds_read_u16_d16 v190, v190
v_cndmask_b32 v150, v130, v162, vcc
v_lshrrev_b32 v189, 18, v189
v_lshrrev_b32 v191, 18, v191
v_mfma_f32_16x16x32_f16 v[88:91], v[244:247], v[220:223], v[88:91]
v_cndmask_b32 v151, v131, v163, vcc
v_exp_f16_sdwa v198, v199 dst_sel:WORD_1 dst_unused:UNUSED_PRESERVE src0_sel:WORD_1
s_waitcnt lgkmcnt(4)
v_mfma_f32_16x16x32_f16 v[84:87], v[224:227], v[216:219], v[84:87]
ds_read_b128 v[244:247], v248 offset:24832
ds_read_u16_d16_hi v189, v189
ds_read_u16_d16_hi v191, v191
v_cndmask_b32_dpp v128, v144, v128, vcc quad_perm:[1,0,3,2] row_mask:0xf bank_mask:0xf
v_and_b32_e64 v193, s49, v193
v_cndmask_b32_dpp v129, v145, v129, vcc quad_perm:[1,0,3,2] row_mask:0xf bank_mask:0xf
v_mfma_f32_16x16x32_f16 v[92:95], v[224:227], v[220:223], v[92:95]
v_and_b32_e64 v195, s49, v195
v_cndmask_b32_dpp v130, v146, v130, vcc quad_perm:[1,0,3,2] row_mask:0xf bank_mask:0xf
v_pk_add_f16 v201, v201, 1.0 op_sel_hi:[1,0]
s_waitcnt lgkmcnt(6)
v_mfma_f32_16x16x32_bf16 v[172:175], v[228:231], v[104:107], v[172:175]
ds_read_b128 v[224:227], v249 offset:24576
v_cndmask_b32_dpp v131, v147, v131, vcc quad_perm:[1,0,3,2] row_mask:0xf bank_mask:0xf
s_not_b64 vcc, s[74:75]
v_bfe_u32 v192, v193, 2, 14
v_pk_add_f16 v198, v198, 1.0 op_sel_hi:[1,0]
v_mfma_f32_16x16x32_bf16 v[180:183], v[228:231], v[108:111], v[180:183]
v_cndmask_b32_dpp v160, v144, v160, vcc quad_perm:[1,0,3,2] row_mask:0xf bank_mask:0xf
v_bfe_u32 v194, v195, 2, 14
v_cndmask_b32_dpp v161, v145, v161, vcc quad_perm:[1,0,3,2] row_mask:0xf bank_mask:0xf
s_waitcnt lgkmcnt(4)
v_mfma_f32_16x16x32_bf16 v[168:171], v[240:243], v[112:115], v[168:171]
ds_read_b128 v[228:231], v249 offset:24832
ds_read_u16_d16 v192, v192
ds_read_u16_d16 v194, v194
v_rcp_f16 v202, v201
v_cndmask_b32_dpp v162, v146, v162, vcc quad_perm:[1,0,3,2] row_mask:0xf bank_mask:0xf
v_mfma_f32_16x16x32_bf16 v[176:179], v[240:243], v[116:119], v[176:179]
v_lshrrev_b32_e64 v193, 18, v193
v_cndmask_b32_dpp v163, v147, v163, vcc quad_perm:[1,0,3,2] row_mask:0xf bank_mask:0xf
v_lshrrev_b32 v195, 18, v195
s_waitcnt lgkmcnt(4)
v_mfma_f32_16x16x32_bf16 v[172:175], v[244:247], v[112:115], v[172:175]
ds_read_b128 v[240:243], v248 offset:28672
ds_read_u16_d16_hi v193, v193
s_add_u32 s46, s71, 98304
buffer_store_dwordx4 v[128:131], v255, s[8:11], s46 offen sc1
ds_read_u16_d16_hi v195, v195
v_rcp_f16_e64 v199, v198
v_mfma_f32_16x16x32_bf16 v[180:183], v[244:247], v[116:119], v[180:183]
v_rcp_f16_sdwa v202, v201 dst_sel:WORD_1 dst_unused:UNUSED_PRESERVE src0_sel:WORD_1
v_or_b32 v232, v184, v185
v_or_b32 v233, v186, v187
v_or_b32_e64 v234, v188, v189
v_rcp_f16_sdwa v199, v198 dst_sel:WORD_1 dst_unused:UNUSED_PRESERVE src0_sel:WORD_1
v_or_b32 v235, v190, v191
s_waitcnt lgkmcnt(1)
v_or_b32 v236, v192, v193
s_waitcnt lgkmcnt(0)
v_or_b32_e64 v237, v194, v195
v_pk_mul_f16 v238, v203, v202
v_pk_mul_f16 v239, v200, v199
v_mfma_f32_16x16x32_f16 v[48:51], v[224:227], v[232:235], v[48:51]
s_add_u32 s46, s71, 98304
buffer_store_dwordx4 v[148:151], v255, s[8:11], s46 offen offset:128 sc1
ds_read_b128 v[244:247], v249 offset:25600
ds_read_b128 v[216:219], v248 offset:28928
ds_read_b128 v[220:223], v249 offset:25856
v_cvt_pkrtz_f16_f32 v185, v168, v169
v_cvt_pkrtz_f16_f32 v187, v170, v171
v_mfma_f32_16x16x32_f16 v[56:59], v[224:227], v[236:239], v[56:59]
v_cvt_pkrtz_f16_f32 v189, v172, v173
v_cvt_pkrtz_f16_f32 v191, v174, v175
v_mfma_f32_16x16x32_f16 v[52:55], v[228:231], v[232:235], v[52:55]
ds_read_b128 v[224:227], v248 offset:29696
v_cvt_pkrtz_f16_f32 v193, v176, v177
v_cvt_pk_f16_f32 v203, v178, v179
v_mfma_f32_16x16x32_f16 v[60:63], v[228:231], v[236:239], v[60:63]
v_cvt_pk_f16_f32 v200, v180, v181
v_cvt_pk_f16_f32 v197, v182, v183
v_mfma_f32_16x16x32_bf16 v[168:171], v[240:243], v[96:99], 0
ds_read_b128 v[228:231], v249 offset:26624
v_pk_fma_f16 v202, v203, v203, s48
v_and_b32_e64 v185, s49, v185
v_mfma_f32_16x16x32_bf16 v[176:179], v[240:243], v[100:103], 0
v_pk_fma_f16 v199, v200, v200, s48
v_and_b32 v187, s49, v187
s_waitcnt lgkmcnt(4)
v_mfma_f32_16x16x32_f16 v[64:67], v[244:247], v[232:235], v[64:67]
ds_read_b128 v[240:243], v249 offset:26880
v_pk_fma_f16 v196, v197, v197, s48
s_setprio 2
v_bfe_u32 v184, v185, 2, 14
v_pk_mul_f16 v202, v203, v202
v_mfma_f32_16x16x32_f16 v[72:75], v[244:247], v[236:239], v[72:75]
v_bfe_u32 v186, v187, 2, 14
v_pk_mul_f16 v199, v200, v199
s_waitcnt vmcnt(10)
v_mfma_f32_16x16x32_bf16 v[48:51], v[18:21], v[4:7], v[48:51]
ds_read_b128 v[244:247], v248 offset:29952
ds_read_u16_d16 v184, v184
ds_read_u16_d16 v186, v186
v_lshrrev_b32_e64 v185, 18, v185
v_pk_mul_f16 v196, v197, v196
v_mfma_f32_16x16x32_bf16 v[52:55], v[16:19], v[4:7], v[52:55]
v_lshrrev_b32 v187, 18, v187
s_waitcnt lgkmcnt(4)
v_mfma_f32_16x16x32_bf16 v[172:175], v[216:219], v[96:99], 0
ds_read_u16_d16_hi v185, v185
ds_read_u16_d16_hi v187, v187
v_exp_f16 v201, v202
v_and_b32 v189, s49, v189
v_mfma_f32_16x16x32_bf16 v[180:183], v[216:219], v[100:103], 0
v_and_b32_e64 v191, s49, v191
v_mfma_f32_16x16x32_f16 v[68:71], v[220:223], v[232:235], v[68:71]
ds_read_b128 v[216:219], v248 offset:30720
v_exp_f16_e64 v198, v199
v_bfe_u32 v188, v189, 2, 14
v_mfma_f32_16x16x32_f16 v[76:79], v[220:223], v[236:239], v[76:79]
v_bfe_u32 v190, v191, 2, 14
v_exp_f16_e64 v195, v196
v_mfma_f32_16x16x32_bf16 v[168:171], v[224:227], v[104:107], v[168:171]
ds_read_b128 v[220:223], v248 offset:30976
ds_read_u16_d16 v188, v188
ds_read_u16_d16 v190, v190
v_lshrrev_b32 v189, 18, v189
v_lshrrev_b32 v191, 18, v191
v_mfma_f32_16x16x32_bf16 v[176:179], v[224:227], v[108:111], v[176:179]
v_exp_f16_sdwa v201, v202 dst_sel:WORD_1 dst_unused:UNUSED_PRESERVE src0_sel:WORD_1
v_mfma_f32_16x16x32_f16 v[80:83], v[228:231], v[232:235], v[80:83]
ds_read_b128 v[224:227], v249 offset:30720
ds_read_u16_d16_hi v189, v189
ds_read_u16_d16_hi v191, v191
v_and_b32 v193, s49, v193
v_bfe_u32 v192, v193, 2, 14
v_mfma_f32_16x16x32_f16 v[88:91], v[228:231], v[236:239], v[88:91]
v_exp_f16_sdwa v198, v199 dst_sel:WORD_1 dst_unused:UNUSED_PRESERVE src0_sel:WORD_1
s_waitcnt lgkmcnt(7)
v_mfma_f32_16x16x32_f16 v[84:87], v[240:243], v[232:235], v[84:87]
ds_read_b128 v[228:231], v249 offset:30976
ds_read_u16_d16 v192, v192
v_lshrrev_b32_e64 v193, 18, v193
v_mfma_f32_16x16x32_f16 v[92:95], v[240:243], v[236:239], v[92:95]
v_exp_f16_sdwa v195, v196 dst_sel:WORD_1 dst_unused:UNUSED_PRESERVE src0_sel:WORD_1
v_pk_add_f16 v201, v201, 1.0 op_sel_hi:[1,0]
v_pk_add_f16 v198, v198, 1.0 op_sel_hi:[1,0]
v_mfma_f32_16x16x32_bf16 v[172:175], v[244:247], v[104:107], v[172:175]
ds_read_b128 v[240:243], v248 offset:34816
ds_read_u16_d16_hi v193, v193
v_pk_add_f16 v195, v195, 1.0 op_sel_hi:[1,0]
v_mfma_f32_16x16x32_bf16 v[180:183], v[244:247], v[108:111], v[180:183]
v_rcp_f16 v202, v201
s_waitcnt lgkmcnt(7)
v_mfma_f32_16x16x32_bf16 v[168:171], v[216:219], v[112:115], v[168:171]
ds_read_b128 v[244:247], v249 offset:31744
v_rcp_f16_e64 v199, v198
v_mfma_f32_16x16x32_bf16 v[176:179], v[216:219], v[116:119], v[176:179]
v_rcp_f16_e64 v196, v195
v_mfma_f32_16x16x32_bf16 v[172:175], v[220:223], v[112:115], v[172:175]
ds_read_b128 v[216:219], v248 offset:35072
v_rcp_f16_sdwa v202, v201 dst_sel:WORD_1 dst_unused:UNUSED_PRESERVE src0_sel:WORD_1
v_mfma_f32_16x16x32_bf16 v[180:183], v[220:223], v[116:119], v[180:183]
v_rcp_f16_sdwa v199, v198 dst_sel:WORD_1 dst_unused:UNUSED_PRESERVE src0_sel:WORD_1
v_or_b32 v232, v184, v185
v_or_b32 v233, v186, v187
s_waitcnt lgkmcnt(4)
v_or_b32 v234, v188, v189
v_rcp_f16_sdwa v196, v195 dst_sel:WORD_1 dst_unused:UNUSED_PRESERVE src0_sel:WORD_1
v_or_b32 v235, v190, v191
s_waitcnt lgkmcnt(2)
v_or_b32_e64 v236, v192, v193
v_pk_mul_f16 v237, v203, v202
v_pk_mul_f16 v238, v200, v199
v_pk_mul_f16 v239, v197, v196
v_mfma_f32_16x16x32_f16 v[48:51], v[224:227], v[232:235], v[48:51]
s_add_u32 s46, s71, 98304
buffer_store_dwordx4 v[160:163], v255, s[8:11], s46 offen offset:256 sc1
ds_read_b128 v[220:223], v249 offset:32000
v_cvt_pkrtz_f16_f32 v185, v168, v169
v_cvt_pkrtz_f16_f32 v187, v170, v171
v_mfma_f32_16x16x32_f16 v[56:59], v[224:227], v[236:239], v[56:59]
v_cvt_pkrtz_f16_f32 v189, v172, v173
v_cvt_pkrtz_f16_f32 v191, v174, v175
v_mfma_f32_16x16x32_f16 v[52:55], v[228:231], v[232:235], v[52:55]
ds_read_b128 v[224:227], v248 offset:35840
v_cvt_pkrtz_f16_f32 v193, v176, v177
v_cvt_pk_f16_f32 v203, v178, v179
v_mfma_f32_16x16x32_f16 v[60:63], v[228:231], v[236:239], v[60:63]
v_cvt_pk_f16_f32 v200, v180, v181
v_cvt_pk_f16_f32 v197, v182, v183
s_setprio 1
v_mfma_f32_16x16x32_bf16 v[168:171], v[240:243], v[96:99], 0
ds_read_b128 v[228:231], v249 offset:32768
v_pk_fma_f16 v202, v203, v203, s48
v_and_b32 v185, s49, v185
v_mfma_f32_16x16x32_bf16 v[176:179], v[240:243], v[100:103], 0
v_pk_fma_f16 v199, v200, v200, s48
v_and_b32 v187, s49, v187
s_waitcnt lgkmcnt(3)
v_mfma_f32_16x16x32_f16 v[64:67], v[244:247], v[232:235], v[64:67]
ds_read_b128 v[240:243], v249 offset:33024
v_pk_fma_f16 v196, v197, v197, s48
v_bfe_u32 v184, v185, 2, 14
v_pk_mul_f16 v202, v203, v202
v_mfma_f32_16x16x32_f16 v[72:75], v[244:247], v[236:239], v[72:75]
v_bfe_u32 v186, v187, 2, 14
v_pk_mul_f16 v199, v200, v199
s_waitcnt vmcnt(10)
v_mfma_f32_16x16x32_bf16 v[64:67], v[18:21], v[0:3], v[64:67]
ds_read_b128 v[244:247], v248 offset:36096
ds_read_u16_d16 v184, v184
ds_read_u16_d16 v186, v186
v_lshrrev_b32 v185, 18, v185
v_pk_mul_f16 v196, v197, v196
v_mfma_f32_16x16x32_bf16 v[68:71], v[16:19], v[0:3], v[68:71]
v_lshrrev_b32_e64 v187, 18, v187
v_mfma_f32_16x16x32_bf16 v[172:175], v[216:219], v[96:99], 0
ds_read_u16_d16_hi v185, v185
ds_read_u16_d16_hi v187, v187
v_exp_f16 v201, v202
v_and_b32 v189, s49, v189
v_mfma_f32_16x16x32_bf16 v[180:183], v[216:219], v[100:103], 0
v_and_b32 v191, s49, v191
s_waitcnt lgkmcnt(6)
v_mfma_f32_16x16x32_f16 v[68:71], v[220:223], v[232:235], v[68:71]
ds_read_b128 v[216:219], v248 offset:36864
v_exp_f16_e64 v198, v199
v_bfe_u32 v188, v189, 2, 14
v_mfma_f32_16x16x32_f16 v[76:79], v[220:223], v[236:239], v[76:79]
v_bfe_u32 v190, v191, 2, 14
v_exp_f16_e64 v195, v196
v_mfma_f32_16x16x32_bf16 v[168:171], v[224:227], v[104:107], v[168:171]
ds_read_b128 v[220:223], v248 offset:37120
ds_read_u16_d16 v188, v188
ds_read_u16_d16 v190, v190
v_lshrrev_b32 v189, 18, v189
v_lshrrev_b32 v191, 18, v191
v_mfma_f32_16x16x32_bf16 v[176:179], v[224:227], v[108:111], v[176:179]
v_exp_f16_sdwa v201, v202 dst_sel:WORD_1 dst_unused:UNUSED_PRESERVE src0_sel:WORD_1
v_mfma_f32_16x16x32_f16 v[80:83], v[228:231], v[232:235], v[80:83]
ds_read_b128 v[224:227], v249 offset:36864
ds_read_u16_d16_hi v189, v189
ds_read_u16_d16_hi v191, v191
v_and_b32 v193, s49, v193
v_bfe_u32 v192, v193, 2, 14
v_mfma_f32_16x16x32_f16 v[88:91], v[228:231], v[236:239], v[88:91]
v_exp_f16_sdwa v198, v199 dst_sel:WORD_1 dst_unused:UNUSED_PRESERVE src0_sel:WORD_1
s_waitcnt lgkmcnt(7)
v_mfma_f32_16x16x32_f16 v[84:87], v[240:243], v[232:235], v[84:87]
ds_read_b128 v[228:231], v249 offset:37120
ds_read_u16_d16 v192, v192
v_lshrrev_b32_e64 v193, 18, v193
v_mfma_f32_16x16x32_f16 v[92:95], v[240:243], v[236:239], v[92:95]
v_exp_f16_sdwa v195, v196 dst_sel:WORD_1 dst_unused:UNUSED_PRESERVE src0_sel:WORD_1
v_pk_add_f16 v201, v201, 1.0 op_sel_hi:[1,0]
v_pk_add_f16 v198, v198, 1.0 op_sel_hi:[1,0]
v_mfma_f32_16x16x32_bf16 v[172:175], v[244:247], v[104:107], v[172:175]
ds_read_b128 v[240:243], v248 offset:16384
ds_read_u16_d16_hi v193, v193
v_pk_add_f16 v195, v195, 1.0 op_sel_hi:[1,0]
v_mfma_f32_16x16x32_bf16 v[180:183], v[244:247], v[108:111], v[180:183]
v_rcp_f16_e64 v202, v201
s_setprio 0
s_waitcnt lgkmcnt(7)
v_mfma_f32_16x16x32_bf16 v[168:171], v[216:219], v[112:115], v[168:171]
ds_read_b128 v[244:247], v249 offset:37888
v_rcp_f16_e64 v199, v198
v_mfma_f32_16x16x32_bf16 v[176:179], v[216:219], v[116:119], v[176:179]
v_rcp_f16_e64 v196, v195
v_mfma_f32_16x16x32_bf16 v[172:175], v[220:223], v[112:115], v[172:175]
ds_read_b128 v[216:219], v248 offset:16640
v_rcp_f16_sdwa v202, v201 dst_sel:WORD_1 dst_unused:UNUSED_PRESERVE src0_sel:WORD_1
v_mfma_f32_16x16x32_bf16 v[180:183], v[220:223], v[116:119], v[180:183]
v_rcp_f16_sdwa v199, v198 dst_sel:WORD_1 dst_unused:UNUSED_PRESERVE src0_sel:WORD_1
v_or_b32 v232, v184, v185
v_or_b32 v233, v186, v187
s_waitcnt lgkmcnt(4)
v_or_b32 v234, v188, v189
v_rcp_f16_sdwa v196, v195 dst_sel:WORD_1 dst_unused:UNUSED_PRESERVE src0_sel:WORD_1
v_or_b32 v235, v190, v191
s_waitcnt lgkmcnt(2)
v_or_b32 v236, v192, v193
v_pk_mul_f16 v237, v203, v202
v_pk_mul_f16 v238, v200, v199
v_pk_mul_f16 v239, v197, v196
s_setprio 3
v_mfma_f32_16x16x32_f16 v[48:51], v[224:227], v[232:235], v[48:51]
s_add_u32 s46, s80, 12582912
buffer_load_dwordx4 v[96:99], v253, s[32:35], s46 offen nt
ds_read_b128 v[220:223], v249 offset:38144
v_cvt_pkrtz_f16_f32 v185, v168, v169
v_cvt_pkrtz_f16_f32 v187, v170, v171
v_mfma_f32_16x16x32_f16 v[56:59], v[224:227], v[236:239], v[56:59]
v_cvt_pkrtz_f16_f32 v189, v172, v173
v_cvt_pkrtz_f16_f32 v191, v174, v175
v_mfma_f32_16x16x32_f16 v[52:55], v[228:231], v[232:235], v[52:55]
ds_read_b128 v[224:227], v248 offset:17408
v_cvt_pkrtz_f16_f32 v193, v176, v177
v_cvt_pk_f16_f32 v203, v178, v179
v_mfma_f32_16x16x32_f16 v[60:63], v[228:231], v[236:239], v[60:63]
v_cvt_pk_f16_f32 v200, v180, v181
v_cvt_pk_f16_f32 v197, v182, v183
v_mfma_f32_16x16x32_bf16 v[168:171], v[240:243], v[24:27], 0
ds_read_b128 v[228:231], v249 offset:38912
v_pk_fma_f16 v202, v203, v203, s48
v_and_b32_e64 v185, s49, v185
v_mfma_f32_16x16x32_bf16 v[176:179], v[240:243], v[28:31], 0
v_pk_fma_f16 v199, v200, v200, s48
v_and_b32 v187, s49, v187
s_waitcnt lgkmcnt(3)
v_mfma_f32_16x16x32_f16 v[64:67], v[244:247], v[232:235], v[64:67]
ds_read_b128 v[240:243], v249 offset:39168
v_pk_fma_f16 v196, v197, v197, s48
v_bfe_u32 v184, v185, 2, 14
v_pk_mul_f16 v202, v203, v202
v_mfma_f32_16x16x32_f16 v[72:75], v[244:247], v[236:239], v[72:75]
v_bfe_u32 v186, v187, 2, 14
v_pk_mul_f16 v199, v200, v199
s_waitcnt vmcnt(10)
v_mfma_f32_16x16x32_bf16 v[80:83], v[18:21], v[8:11], v[80:83]
ds_read_b128 v[244:247], v248 offset:17664
ds_read_u16_d16 v184, v184
ds_read_u16_d16 v186, v186
v_lshrrev_b32 v185, 18, v185
v_pk_mul_f16 v196, v197, v196
v_mfma_f32_16x16x32_bf16 v[84:87], v[16:19], v[8:11], v[84:87]
v_lshrrev_b32_e64 v187, 18, v187
v_mfma_f32_16x16x32_bf16 v[172:175], v[216:219], v[24:27], 0
ds_read_u16_d16_hi v185, v185
ds_read_u16_d16_hi v187, v187
v_exp_f16 v201, v202
v_and_b32 v189, s49, v189
v_mfma_f32_16x16x32_bf16 v[180:183], v[216:219], v[28:31], 0
v_and_b32 v191, s49, v191
s_waitcnt lgkmcnt(6)
v_mfma_f32_16x16x32_f16 v[68:71], v[220:223], v[232:235], v[68:71]
ds_read_b128 v[216:219], v248 offset:18432
v_exp_f16_e64 v198, v199
v_bfe_u32 v188, v189, 2, 14
v_mfma_f32_16x16x32_f16 v[76:79], v[220:223], v[236:239], v[76:79]
v_bfe_u32 v190, v191, 2, 14
v_exp_f16_e64 v195, v196
v_mfma_f32_16x16x32_bf16 v[168:171], v[224:227], v[32:35], v[168:171]
ds_read_b128 v[220:223], v248 offset:18688
ds_read_u16_d16 v188, v188
ds_read_u16_d16 v190, v190
v_lshrrev_b32 v189, 18, v189
v_lshrrev_b32 v191, 18, v191
v_mfma_f32_16x16x32_bf16 v[176:179], v[224:227], v[36:39], v[176:179]
v_exp_f16_sdwa v201, v202 dst_sel:WORD_1 dst_unused:UNUSED_PRESERVE src0_sel:WORD_1
v_mfma_f32_16x16x32_f16 v[80:83], v[228:231], v[232:235], v[80:83]
ds_read_b128 v[224:227], v249 offset:43008
ds_read_u16_d16_hi v189, v189
ds_read_u16_d16_hi v191, v191
v_and_b32 v193, s49, v193
v_bfe_u32 v192, v193, 2, 14
v_mfma_f32_16x16x32_f16 v[88:91], v[228:231], v[236:239], v[88:91]
v_exp_f16_sdwa v198, v199 dst_sel:WORD_1 dst_unused:UNUSED_PRESERVE src0_sel:WORD_1
s_waitcnt lgkmcnt(7)
v_mfma_f32_16x16x32_f16 v[84:87], v[240:243], v[232:235], v[84:87]
ds_read_b128 v[228:231], v249 offset:43264
ds_read_u16_d16 v192, v192
v_lshrrev_b32_e64 v193, 18, v193
v_mfma_f32_16x16x32_f16 v[92:95], v[240:243], v[236:239], v[92:95]
v_exp_f16_sdwa v195, v196 dst_sel:WORD_1 dst_unused:UNUSED_PRESERVE src0_sel:WORD_1
v_pk_add_f16 v201, v201, 1.0 op_sel_hi:[1,0]
v_pk_add_f16 v198, v198, 1.0 op_sel_hi:[1,0]
v_mfma_f32_16x16x32_bf16 v[172:175], v[244:247], v[32:35], v[172:175]
ds_read_b128 v[240:243], v248 offset:22528
ds_read_u16_d16_hi v193, v193
v_pk_add_f16 v195, v195, 1.0 op_sel_hi:[1,0]
v_mfma_f32_16x16x32_bf16 v[180:183], v[244:247], v[36:39], v[180:183]
v_rcp_f16 v202, v201
s_waitcnt lgkmcnt(7)
v_mfma_f32_16x16x32_bf16 v[168:171], v[216:219], v[40:43], v[168:171]
ds_read_b128 v[244:247], v249 offset:44032
v_rcp_f16_e64 v199, v198
v_mfma_f32_16x16x32_bf16 v[176:179], v[216:219], v[44:47], v[176:179]
v_rcp_f16_e64 v196, v195
v_mfma_f32_16x16x32_bf16 v[172:175], v[220:223], v[40:43], v[172:175]
ds_read_b128 v[216:219], v248 offset:22784
v_rcp_f16_sdwa v202, v201 dst_sel:WORD_1 dst_unused:UNUSED_PRESERVE src0_sel:WORD_1
v_mfma_f32_16x16x32_bf16 v[180:183], v[220:223], v[44:47], v[180:183]
v_rcp_f16_sdwa v199, v198 dst_sel:WORD_1 dst_unused:UNUSED_PRESERVE src0_sel:WORD_1
v_or_b32 v232, v184, v185
v_or_b32 v233, v186, v187
s_waitcnt lgkmcnt(4)
v_or_b32 v234, v188, v189
v_rcp_f16_sdwa v196, v195 dst_sel:WORD_1 dst_unused:UNUSED_PRESERVE src0_sel:WORD_1
v_or_b32 v235, v190, v191
s_waitcnt lgkmcnt(2)
v_or_b32_e64 v236, v192, v193
v_pk_mul_f16 v237, v203, v202
v_pk_mul_f16 v238, v200, v199
v_pk_mul_f16 v239, v197, v196
v_mfma_f32_16x16x32_f16 v[48:51], v[224:227], v[232:235], v[48:51]
s_add_u32 s46, s80, 12582912
buffer_load_dwordx4 v[100:103], v253, s[32:35], s46 offen offset:256 nt
ds_read_b128 v[220:223], v249 offset:44288
v_cvt_pkrtz_f16_f32 v185, v168, v169
v_cvt_pkrtz_f16_f32 v187, v170, v171
v_mfma_f32_16x16x32_f16 v[56:59], v[224:227], v[236:239], v[56:59]
v_cvt_pkrtz_f16_f32 v189, v172, v173
v_cvt_pkrtz_f16_f32 v191, v174, v175
v_mfma_f32_16x16x32_f16 v[52:55], v[228:231], v[232:235], v[52:55]
ds_read_b128 v[224:227], v248 offset:23552
v_cvt_pkrtz_f16_f32 v193, v176, v177
v_cvt_pk_f16_f32 v203, v178, v179
v_mfma_f32_16x16x32_f16 v[60:63], v[228:231], v[236:239], v[60:63]
v_cvt_pk_f16_f32 v200, v180, v181
v_cvt_pk_f16_f32 v197, v182, v183
v_mfma_f32_16x16x32_bf16 v[168:171], v[240:243], v[24:27], 0
ds_read_b128 v[228:231], v249 offset:45056
v_pk_fma_f16 v202, v203, v203, s48
v_and_b32_e64 v185, s49, v185
v_mfma_f32_16x16x32_bf16 v[176:179], v[240:243], v[28:31], 0
v_pk_fma_f16 v199, v200, v200, s48
v_and_b32 v187, s49, v187
s_waitcnt lgkmcnt(3)
v_mfma_f32_16x16x32_f16 v[64:67], v[244:247], v[232:235], v[64:67]
ds_read_b128 v[240:243], v249 offset:45312
v_pk_fma_f16 v196, v197, v197, s48
s_setprio 2
v_bfe_u32 v184, v185, 2, 14
v_pk_mul_f16 v202, v203, v202
v_mfma_f32_16x16x32_f16 v[72:75], v[244:247], v[236:239], v[72:75]
v_bfe_u32 v186, v187, 2, 14
v_pk_mul_f16 v199, v200, v199
s_waitcnt vmcnt(9)
v_mfma_f32_16x16x32_bf16 v[56:59], v[18:21], v[12:15], v[56:59]
ds_read_b128 v[244:247], v248 offset:23808
ds_read_u16_d16 v184, v184
ds_read_u16_d16 v186, v186
v_lshrrev_b32_e64 v185, 18, v185
v_pk_mul_f16 v196, v197, v196
v_mfma_f32_16x16x32_bf16 v[60:63], v[16:19], v[12:15], v[60:63]
v_lshrrev_b32_e64 v187, 18, v187
v_mfma_f32_16x16x32_bf16 v[172:175], v[216:219], v[24:27], 0
ds_read_u16_d16_hi v185, v185
ds_read_u16_d16_hi v187, v187
v_exp_f16 v201, v202
v_and_b32 v189, s49, v189
v_mfma_f32_16x16x32_bf16 v[180:183], v[216:219], v[28:31], 0
v_and_b32 v191, s49, v191
s_waitcnt lgkmcnt(6)
v_mfma_f32_16x16x32_f16 v[68:71], v[220:223], v[232:235], v[68:71]
ds_read_b128 v[216:219], v248 offset:24576
v_exp_f16_e64 v198, v199
v_bfe_u32 v188, v189, 2, 14
v_mfma_f32_16x16x32_f16 v[76:79], v[220:223], v[236:239], v[76:79]
v_bfe_u32 v190, v191, 2, 14
v_exp_f16_e64 v195, v196
v_mfma_f32_16x16x32_bf16 v[168:171], v[224:227], v[32:35], v[168:171]
ds_read_b128 v[220:223], v248 offset:24832
ds_read_u16_d16 v188, v188
ds_read_u16_d16 v190, v190
v_lshrrev_b32 v189, 18, v189
v_lshrrev_b32 v191, 18, v191
v_mfma_f32_16x16x32_bf16 v[176:179], v[224:227], v[36:39], v[176:179]
v_exp_f16_sdwa v201, v202 dst_sel:WORD_1 dst_unused:UNUSED_PRESERVE src0_sel:WORD_1
v_mfma_f32_16x16x32_f16 v[80:83], v[228:231], v[232:235], v[80:83]
ds_read_b128 v[224:227], v249 offset:24576
ds_read_u16_d16_hi v189, v189
ds_read_u16_d16_hi v191, v191
v_and_b32 v193, s49, v193
v_bfe_u32 v192, v193, 2, 14
v_mfma_f32_16x16x32_f16 v[88:91], v[228:231], v[236:239], v[88:91]
v_exp_f16_sdwa v198, v199 dst_sel:WORD_1 dst_unused:UNUSED_PRESERVE src0_sel:WORD_1
s_waitcnt lgkmcnt(7)
v_mfma_f32_16x16x32_f16 v[84:87], v[240:243], v[232:235], v[84:87]
ds_read_b128 v[228:231], v254 offset:7936
ds_read_u16_d16 v192, v192
v_lshrrev_b32_e64 v193, 18, v193
v_mfma_f32_16x16x32_f16 v[92:95], v[240:243], v[236:239], v[92:95]
v_exp_f16_sdwa v195, v196 dst_sel:WORD_1 dst_unused:UNUSED_PRESERVE src0_sel:WORD_1
v_pk_add_f16 v201, v201, 1.0 op_sel_hi:[1,0]
v_pk_add_f16 v198, v198, 1.0 op_sel_hi:[1,0]
v_mfma_f32_16x16x32_bf16 v[172:175], v[244:247], v[32:35], v[172:175]
ds_read_b128 v[240:243], v249 offset:24832
ds_read_u16_d16_hi v193, v193
v_pk_add_f16 v195, v195, 1.0 op_sel_hi:[1,0]
v_mfma_f32_16x16x32_bf16 v[180:183], v[244:247], v[36:39], v[180:183]
v_rcp_f16 v202, v201
s_waitcnt lgkmcnt(7)
v_mfma_f32_16x16x32_bf16 v[168:171], v[216:219], v[40:43], v[168:171]
ds_read_b128 v[244:247], v254 offset:7952
v_rcp_f16_e64 v199, v198
v_mfma_f32_16x16x32_bf16 v[176:179], v[216:219], v[44:47], v[176:179]
v_rcp_f16_e64 v196, v195
v_mfma_f32_16x16x32_bf16 v[172:175], v[220:223], v[40:43], v[172:175]
ds_read_b128 v[216:219], v248 offset:28672
v_rcp_f16_sdwa v202, v201 dst_sel:WORD_1 dst_unused:UNUSED_PRESERVE src0_sel:WORD_1
v_mfma_f32_16x16x32_bf16 v[180:183], v[220:223], v[44:47], v[180:183]
v_rcp_f16_sdwa v199, v198 dst_sel:WORD_1 dst_unused:UNUSED_PRESERVE src0_sel:WORD_1
v_or_b32 v232, v184, v185
v_or_b32 v233, v186, v187
s_waitcnt lgkmcnt(4)
v_or_b32 v234, v188, v189
v_rcp_f16_sdwa v196, v195 dst_sel:WORD_1 dst_unused:UNUSED_PRESERVE src0_sel:WORD_1
v_or_b32 v235, v190, v191
s_waitcnt lgkmcnt(2)
v_or_b32_e64 v236, v192, v193
v_pk_mul_f16 v237, v203, v202
v_pk_mul_f16 v238, v200, v199
v_pk_mul_f16 v239, v197, v196
v_mfma_f32_16x16x32_f16 v[120:123], v[224:227], v[232:235], v[228:231]
s_add_u32 s46, s80, 16777216
buffer_load_dwordx4 v[104:107], v253, s[32:35], s46 offen nt
ds_read_b128 v[220:223], v249 offset:25600
v_cvt_pkrtz_f16_f32 v185, v168, v169
v_cvt_pkrtz_f16_f32 v187, v170, v171
v_mfma_f32_16x16x32_f16 v[128:131], v[224:227], v[236:239], v[228:231]
v_cvt_pkrtz_f16_f32 v189, v172, v173
v_cvt_pkrtz_f16_f32 v191, v174, v175
s_waitcnt lgkmcnt(2)
v_mfma_f32_16x16x32_f16 v[124:127], v[240:243], v[232:235], v[244:247]
ds_read_b128 v[224:227], v254 offset:8064
ds_read_b128 v[228:231], v248 offset:28928
v_cvt_pkrtz_f16_f32 v193, v176, v177
v_cvt_pk_f16_f32 v203, v178, v179
v_mfma_f32_16x16x32_f16 v[132:135], v[240:243], v[236:239], v[244:247]
v_cvt_pk_f16_f32 v200, v180, v181
v_cvt_pk_f16_f32 v197, v182, v183
s_setprio 1
s_waitcnt lgkmcnt(3)
v_mfma_f32_16x16x32_bf16 v[168:171], v[216:219], v[24:27], 0
ds_read_b128 v[240:243], v249 offset:25856
ds_read_b128 v[244:247], v254 offset:8080
v_pk_fma_f16 v202, v203, v203, s48
v_and_b32 v185, s49, v185
v_mfma_f32_16x16x32_bf16 v[176:179], v[216:219], v[28:31], 0
v_pk_fma_f16 v199, v200, v200, s48
v_and_b32 v187, s49, v187
s_waitcnt lgkmcnt(3)
v_mfma_f32_16x16x32_f16 v[136:139], v[220:223], v[232:235], v[224:227]
ds_read_b128 v[216:219], v248 offset:29696
v_pk_fma_f16 v196, v197, v197, s48
v_bfe_u32 v184, v185, 2, 14
v_pk_mul_f16 v202, v203, v202
v_mfma_f32_16x16x32_f16 v[144:147], v[220:223], v[236:239], v[224:227]
v_bfe_u32 v186, v187, 2, 14
v_pk_mul_f16 v199, v200, v199
s_waitcnt vmcnt(7)
v_mfma_f32_16x16x32_bf16 v[72:75], v[18:21], v[208:211], v[72:75]
ds_read_b128 v[220:223], v249 offset:26624
ds_read_b128 v[224:227], v254 offset:16128
ds_read_u16_d16 v184, v184
ds_read_u16_d16 v186, v186
v_lshrrev_b32 v185, 18, v185
v_pk_mul_f16 v196, v197, v196
v_mfma_f32_16x16x32_bf16 v[76:79], v[16:19], v[208:211], v[76:79]
v_lshrrev_b32 v187, 18, v187
s_waitcnt lgkmcnt(5)
v_mfma_f32_16x16x32_bf16 v[172:175], v[228:231], v[24:27], 0
ds_read_u16_d16_hi v185, v185
ds_read_u16_d16_hi v187, v187
v_exp_f16 v201, v202
v_and_b32 v189, s49, v189
v_mfma_f32_16x16x32_bf16 v[180:183], v[228:231], v[28:31], 0
v_and_b32_e64 v191, s49, v191
v_mfma_f32_16x16x32_f16 v[140:143], v[240:243], v[232:235], v[244:247]
ds_read_b128 v[228:231], v249 offset:26880
v_exp_f16_e64 v198, v199
v_bfe_u32 v188, v189, 2, 14
v_mfma_f32_16x16x32_f16 v[148:151], v[240:243], v[236:239], v[244:247]
v_bfe_u32 v190, v191, 2, 14
v_exp_f16 v195, v196
s_waitcnt lgkmcnt(7)
v_mfma_f32_16x16x32_bf16 v[168:171], v[216:219], v[32:35], v[168:171]
ds_read_b128 v[240:243], v254 offset:16144
ds_read_b128 v[244:247], v248 offset:29952
ds_read_u16_d16 v188, v188
ds_read_u16_d16 v190, v190
v_lshrrev_b32_e64 v189, 18, v189
v_lshrrev_b32 v191, 18, v191
v_mfma_f32_16x16x32_bf16 v[176:179], v[216:219], v[36:39], v[176:179]
v_exp_f16_sdwa v201, v202 dst_sel:WORD_1 dst_unused:UNUSED_PRESERVE src0_sel:WORD_1
s_waitcnt lgkmcnt(7)
v_mfma_f32_16x16x32_f16 v[152:155], v[220:223], v[232:235], v[224:227]
ds_read_b128 v[216:219], v248 offset:30720
ds_read_u16_d16_hi v189, v189
ds_read_u16_d16_hi v191, v191
v_and_b32 v193, s49, v193
v_bfe_u32 v192, v193, 2, 14
v_mfma_f32_16x16x32_f16 v[160:163], v[220:223], v[236:239], v[224:227]
v_exp_f16_sdwa v198, v199 dst_sel:WORD_1 dst_unused:UNUSED_PRESERVE src0_sel:WORD_1
s_waitcnt lgkmcnt(6)
v_mfma_f32_16x16x32_f16 v[156:159], v[228:231], v[232:235], v[240:243]
ds_read_b128 v[220:223], v248 offset:30976
ds_read_b128 v[224:227], v249 offset:30720
ds_read_u16_d16 v192, v192
v_lshrrev_b32 v193, 18, v193
v_mfma_f32_16x16x32_f16 v[164:167], v[228:231], v[236:239], v[240:243]
v_exp_f16_sdwa v195, v196 dst_sel:WORD_1 dst_unused:UNUSED_PRESERVE src0_sel:WORD_1
v_pk_add_f16 v201, v201, 1.0 op_sel_hi:[1,0]
v_pk_add_f16 v198, v198, 1.0 op_sel_hi:[1,0]
s_waitcnt lgkmcnt(7)
v_mfma_f32_16x16x32_bf16 v[172:175], v[244:247], v[32:35], v[172:175]
ds_read_b128 v[228:231], v249 offset:30976
ds_read_b128 v[240:243], v248 offset:40960
ds_read_u16_d16_hi v193, v193
v_pk_add_f16 v195, v195, 1.0 op_sel_hi:[1,0]
v_mfma_f32_16x16x32_bf16 v[180:183], v[244:247], v[36:39], v[180:183]
v_rcp_f16_e64 v202, v201
s_setprio 0
s_waitcnt lgkmcnt(7)
v_mfma_f32_16x16x32_bf16 v[168:171], v[216:219], v[40:43], v[168:171]
ds_read_b128 v[244:247], v249 offset:31744
v_rcp_f16_e64 v199, v198
v_mfma_f32_16x16x32_bf16 v[176:179], v[216:219], v[44:47], v[176:179]
v_rcp_f16 v196, v195
s_waitcnt lgkmcnt(6)
v_mfma_f32_16x16x32_bf16 v[172:175], v[220:223], v[40:43], v[172:175]
ds_read_b128 v[216:219], v248 offset:41216
v_rcp_f16_sdwa v202, v201 dst_sel:WORD_1 dst_unused:UNUSED_PRESERVE src0_sel:WORD_1
v_mfma_f32_16x16x32_bf16 v[180:183], v[220:223], v[44:47], v[180:183]
v_rcp_f16_sdwa v199, v198 dst_sel:WORD_1 dst_unused:UNUSED_PRESERVE src0_sel:WORD_1
v_or_b32 v232, v184, v185
v_or_b32 v233, v186, v187
v_or_b32_e64 v234, v188, v189
v_rcp_f16_sdwa v196, v195 dst_sel:WORD_1 dst_unused:UNUSED_PRESERVE src0_sel:WORD_1
v_or_b32 v235, v190, v191
s_waitcnt lgkmcnt(2)
v_or_b32 v236, v192, v193
v_pk_mul_f16 v237, v203, v202
v_pk_mul_f16 v238, v200, v199
v_pk_mul_f16 v239, v197, v196
s_setprio 3
v_mfma_f32_16x16x32_f16 v[120:123], v[224:227], v[232:235], v[120:123]
s_add_u32 s46, s80, 16777216
buffer_load_dwordx4 v[108:111], v253, s[32:35], s46 offen offset:256 nt
ds_read_b128 v[220:223], v249 offset:32000
v_cvt_pkrtz_f16_f32 v185, v168, v169
v_cvt_pkrtz_f16_f32 v187, v170, v171
v_mfma_f32_16x16x32_f16 v[128:131], v[224:227], v[236:239], v[128:131]
v_cvt_pkrtz_f16_f32 v189, v172, v173
v_cvt_pkrtz_f16_f32 v191, v174, v175
v_mfma_f32_16x16x32_f16 v[124:127], v[228:231], v[232:235], v[124:127]
ds_read_b128 v[224:227], v248 offset:41984
v_cvt_pkrtz_f16_f32 v193, v176, v177
v_cvt_pk_f16_f32 v203, v178, v179
v_mfma_f32_16x16x32_f16 v[132:135], v[228:231], v[236:239], v[132:135]
v_cvt_pk_f16_f32 v200, v180, v181
v_cvt_pk_f16_f32 v197, v182, v183
v_mfma_f32_16x16x32_bf16 v[168:171], v[240:243], v[24:27], 0
ds_read_b128 v[228:231], v249 offset:32768
v_pk_fma_f16 v202, v203, v203, s48
v_and_b32_e64 v185, s49, v185
v_mfma_f32_16x16x32_bf16 v[176:179], v[240:243], v[28:31], 0
v_pk_fma_f16 v199, v200, v200, s48
v_and_b32 v187, s49, v187
s_waitcnt lgkmcnt(3)
v_mfma_f32_16x16x32_f16 v[136:139], v[244:247], v[232:235], v[136:139]
ds_read_b128 v[240:243], v249 offset:33024
v_pk_fma_f16 v196, v197, v197, s48
v_bfe_u32 v184, v185, 2, 14
v_pk_mul_f16 v202, v203, v202
v_mfma_f32_16x16x32_f16 v[144:147], v[244:247], v[236:239], v[144:147]
v_bfe_u32 v186, v187, 2, 14
v_pk_mul_f16 v199, v200, v199
s_waitcnt vmcnt(7)
v_mfma_f32_16x16x32_bf16 v[88:91], v[18:21], v[204:207], v[88:91]
ds_read_b128 v[244:247], v248 offset:42240
ds_read_u16_d16 v184, v184
ds_read_u16_d16 v186, v186
v_lshrrev_b32 v185, 18, v185
v_pk_mul_f16 v196, v197, v196
v_mfma_f32_16x16x32_bf16 v[92:95], v[16:19], v[204:207], v[92:95]
v_lshrrev_b32_e64 v187, 18, v187
v_mfma_f32_16x16x32_bf16 v[172:175], v[216:219], v[24:27], 0
ds_read_u16_d16_hi v185, v185
ds_read_u16_d16_hi v187, v187
v_exp_f16 v201, v202
v_and_b32 v189, s49, v189
v_mfma_f32_16x16x32_bf16 v[180:183], v[216:219], v[28:31], 0
v_and_b32 v191, s49, v191
s_waitcnt lgkmcnt(6)
v_mfma_f32_16x16x32_f16 v[140:143], v[220:223], v[232:235], v[140:143]
ds_read_b128 v[216:219], v248 offset:43008
v_exp_f16_e64 v198, v199
v_bfe_u32 v188, v189, 2, 14
v_mfma_f32_16x16x32_f16 v[148:151], v[220:223], v[236:239], v[148:151]
v_bfe_u32 v190, v191, 2, 14
v_exp_f16_e64 v195, v196
v_mfma_f32_16x16x32_bf16 v[168:171], v[224:227], v[32:35], v[168:171]
ds_read_b128 v[220:223], v248 offset:43264
ds_read_u16_d16 v188, v188
ds_read_u16_d16 v190, v190
v_lshrrev_b32 v189, 18, v189
v_lshrrev_b32 v191, 18, v191
v_mfma_f32_16x16x32_bf16 v[176:179], v[224:227], v[36:39], v[176:179]
v_exp_f16_sdwa v201, v202 dst_sel:WORD_1 dst_unused:UNUSED_PRESERVE src0_sel:WORD_1
v_mfma_f32_16x16x32_f16 v[152:155], v[228:231], v[232:235], v[152:155]
ds_read_b128 v[224:227], v249 offset:36864
ds_read_u16_d16_hi v189, v189
ds_read_u16_d16_hi v191, v191
v_and_b32 v193, s49, v193
v_bfe_u32 v192, v193, 2, 14
v_mfma_f32_16x16x32_f16 v[160:163], v[228:231], v[236:239], v[160:163]
v_exp_f16_sdwa v198, v199 dst_sel:WORD_1 dst_unused:UNUSED_PRESERVE src0_sel:WORD_1
s_waitcnt lgkmcnt(7)
v_mfma_f32_16x16x32_f16 v[156:159], v[240:243], v[232:235], v[156:159]
ds_read_b128 v[228:231], v249 offset:37120
ds_read_u16_d16 v192, v192
v_lshrrev_b32_e64 v193, 18, v193
v_mfma_f32_16x16x32_f16 v[164:167], v[240:243], v[236:239], v[164:167]
v_exp_f16_sdwa v195, v196 dst_sel:WORD_1 dst_unused:UNUSED_PRESERVE src0_sel:WORD_1
v_pk_add_f16 v201, v201, 1.0 op_sel_hi:[1,0]
v_pk_add_f16 v198, v198, 1.0 op_sel_hi:[1,0]
v_mfma_f32_16x16x32_bf16 v[172:175], v[244:247], v[32:35], v[172:175]
ds_read_b128 v[240:243], v248 offset:34816
ds_read_u16_d16_hi v193, v193
v_pk_add_f16 v195, v195, 1.0 op_sel_hi:[1,0]
v_mfma_f32_16x16x32_bf16 v[180:183], v[244:247], v[36:39], v[180:183]
v_rcp_f16 v202, v201
s_waitcnt lgkmcnt(7)
v_mfma_f32_16x16x32_bf16 v[168:171], v[216:219], v[40:43], v[168:171]
ds_read_b128 v[244:247], v249 offset:37888
v_rcp_f16_e64 v199, v198
v_mfma_f32_16x16x32_bf16 v[176:179], v[216:219], v[44:47], v[176:179]
v_rcp_f16_e64 v196, v195
v_mfma_f32_16x16x32_bf16 v[172:175], v[220:223], v[40:43], v[172:175]
ds_read_b128 v[216:219], v248 offset:35072
v_rcp_f16_sdwa v202, v201 dst_sel:WORD_1 dst_unused:UNUSED_PRESERVE src0_sel:WORD_1
v_mfma_f32_16x16x32_bf16 v[180:183], v[220:223], v[44:47], v[180:183]
v_rcp_f16_sdwa v199, v198 dst_sel:WORD_1 dst_unused:UNUSED_PRESERVE src0_sel:WORD_1
v_or_b32 v232, v184, v185
v_or_b32 v233, v186, v187
s_waitcnt lgkmcnt(4)
v_or_b32 v234, v188, v189
v_rcp_f16_sdwa v196, v195 dst_sel:WORD_1 dst_unused:UNUSED_PRESERVE src0_sel:WORD_1
v_or_b32 v235, v190, v191
s_waitcnt lgkmcnt(2)
v_or_b32_e64 v236, v192, v193
v_pk_mul_f16 v237, v203, v202
v_pk_mul_f16 v238, v200, v199
v_pk_mul_f16 v239, v197, v196
v_mfma_f32_16x16x32_f16 v[120:123], v[224:227], v[232:235], v[120:123]
s_add_u32 s46, s80, 20971520
buffer_load_dwordx4 v[112:115], v253, s[32:35], s46 offen nt
ds_read_b128 v[220:223], v249 offset:38144
v_cvt_pkrtz_f16_f32 v185, v168, v169
v_cvt_pkrtz_f16_f32 v187, v170, v171
v_cvt_pkrtz_f16_f32 v189, v172, v173
v_mfma_f32_16x16x32_f16 v[128:131], v[224:227], v[236:239], v[128:131]
v_cvt_pkrtz_f16_f32 v191, v174, v175
v_cvt_pkrtz_f16_f32 v193, v176, v177
v_cvt_pkrtz_f16_f32 v195, v178, v179
v_mfma_f32_16x16x32_f16 v[124:127], v[228:231], v[232:235], v[124:127]
ds_read_b128 v[224:227], v248 offset:35840
v_cvt_pk_f16_f32 v203, v180, v181
v_cvt_pk_f16_f32 v200, v182, v183
v_pk_fma_f16 v202, v203, v203, s48
v_mfma_f32_16x16x32_f16 v[132:135], v[228:231], v[236:239], v[132:135]
v_cvt_pk_bf16_f32 v64, v64, v65
v_and_b32_e64 v185, s49, v185
v_cvt_pk_bf16_f32 v65, v66, v67
v_mfma_f32_16x16x32_bf16 v[168:171], v[240:243], v[24:27], 0
ds_read_b128 v[228:231], v249 offset:38912
v_and_b32_e64 v187, s49, v187
v_cvt_pk_bf16_f32 v66, v68, v69
v_pk_fma_f16 v199, v200, v200, s48
v_mfma_f32_16x16x32_bf16 v[176:179], v[240:243], v[28:31], 0
v_bfe_u32 v184, v185, 2, 14
v_cvt_pk_bf16_f32 v67, v70, v71
s_setprio 2
v_pk_mul_f16 v202, v203, v202
s_waitcnt lgkmcnt(2)
v_mfma_f32_16x16x32_f16 v[136:139], v[244:247], v[232:235], v[136:139]
ds_read_b128 v[240:243], v249 offset:39168
ds_read_u16_d16 v184, v184
v_cvt_pk_bf16_f32 v48, v48, v49
v_bfe_u32 v186, v187, 2, 14
v_cvt_pk_bf16_f32 v49, v50, v51
v_mfma_f32_16x16x32_f16 v[144:147], v[244:247], v[236:239], v[144:147]
v_pk_mul_f16 v199, v200, v199
v_lshrrev_b32_e64 v185, 18, v185
v_cvt_pk_bf16_f32 v50, v52, v53
v_mfma_f32_16x16x32_bf16 v[172:175], v[216:219], v[24:27], 0
ds_read_b128 v[244:247], v248 offset:36096
ds_read_u16_d16 v186, v186
ds_read_u16_d16_hi v185, v185
v_exp_f16_e64 v201, v202
v_cvt_pk_bf16_f32 v51, v54, v55
v_mfma_f32_16x16x32_bf16 v[180:183], v[216:219], v[28:31], 0
v_lshrrev_b32_e64 v187, 18, v187
v_cvt_pk_bf16_f32 v80, v80, v81
v_and_b32_e64 v189, s49, v189
v_mfma_f32_16x16x32_f16 v[140:143], v[220:223], v[232:235], v[140:143]
ds_read_b128 v[216:219], v248 offset:36864
ds_read_u16_d16_hi v187, v187
v_cvt_pk_bf16_f32 v81, v82, v83
v_exp_f16_e64 v198, v199
v_mfma_f32_16x16x32_f16 v[148:151], v[220:223], v[236:239], v[148:151]
v_cvt_pk_bf16_f32 v82, v84, v85
v_and_b32_e64 v191, s49, v191
v_cvt_pk_bf16_f32 v83, v86, v87
s_mov_b64 vcc, s[74:75]
s_waitcnt lgkmcnt(5)
v_mfma_f32_16x16x32_bf16 v[168:171], v[224:227], v[32:35], v[168:171]
ds_read_b128 v[220:223], v248 offset:37120
v_bfe_u32 v188, v189, 2, 14
v_cndmask_b32 v68, v48, v80, vcc
v_mfma_f32_16x16x32_bf16 v[176:179], v[224:227], v[36:39], v[176:179]
v_exp_f16_sdwa v201, v202 dst_sel:WORD_1 dst_unused:UNUSED_PRESERVE src0_sel:WORD_1
v_cndmask_b32 v69, v49, v81, vcc
v_bfe_u32 v190, v191, 2, 14
v_mfma_f32_16x16x32_f16 v[152:155], v[228:231], v[232:235], v[152:155]
ds_read_b128 v[224:227], v249 offset:49152
ds_read_u16_d16 v188, v188
ds_read_u16_d16 v190, v190
v_cndmask_b32 v70, v50, v82, vcc
v_lshrrev_b32 v189, 18, v189
v_cndmask_b32 v71, v51, v83, vcc
v_mfma_f32_16x16x32_f16 v[160:163], v[228:231], v[236:239], v[160:163]
v_lshrrev_b32 v191, 18, v191
v_exp_f16_sdwa v198, v199 dst_sel:WORD_1 dst_unused:UNUSED_PRESERVE src0_sel:WORD_1
v_mfma_f32_16x16x32_f16 v[156:159], v[240:243], v[232:235], v[156:159]
ds_read_b128 v[228:231], v249 offset:49408
ds_read_u16_d16_hi v189, v189
ds_read_u16_d16_hi v191, v191
v_cndmask_b32_dpp v48, v64, v48, vcc quad_perm:[1,0,3,2] row_mask:0xf bank_mask:0xf
v_cndmask_b32_dpp v49, v65, v49, vcc quad_perm:[1,0,3,2] row_mask:0xf bank_mask:0xf
v_and_b32_e64 v193, s49, v193
v_mfma_f32_16x16x32_f16 v[164:167], v[240:243], v[236:239], v[164:167]
v_cndmask_b32_dpp v50, v66, v50, vcc quad_perm:[1,0,3,2] row_mask:0xf bank_mask:0xf
v_and_b32_e64 v195, s49, v195
v_pk_add_f16 v201, v201, 1.0 op_sel_hi:[1,0]
s_waitcnt lgkmcnt(6)
v_mfma_f32_16x16x32_bf16 v[172:175], v[244:247], v[32:35], v[172:175]
ds_read_b128 v[240:243], v248 offset:47104
v_cndmask_b32_dpp v51, v67, v51, vcc quad_perm:[1,0,3,2] row_mask:0xf bank_mask:0xf
s_not_b64 vcc, s[74:75]
v_bfe_u32 v192, v193, 2, 14
v_cndmask_b32_dpp v80, v64, v80, vcc quad_perm:[1,0,3,2] row_mask:0xf bank_mask:0xf
v_mfma_f32_16x16x32_bf16 v[180:183], v[244:247], v[36:39], v[180:183]
v_pk_add_f16 v198, v198, 1.0 op_sel_hi:[1,0]
v_cndmask_b32_dpp v81, v65, v81, vcc quad_perm:[1,0,3,2] row_mask:0xf bank_mask:0xf
v_bfe_u32 v194, v195, 2, 14
v_mfma_f32_16x16x32_bf16 v[168:171], v[216:219], v[40:43], v[168:171]
ds_read_b128 v[244:247], v249 offset:50176
ds_read_u16_d16 v192, v192
ds_read_u16_d16 v194, v194
v_rcp_f16_e64 v202, v201
v_cndmask_b32_dpp v82, v66, v82, vcc quad_perm:[1,0,3,2] row_mask:0xf bank_mask:0xf
v_mfma_f32_16x16x32_bf16 v[176:179], v[216:219], v[44:47], v[176:179]
v_cndmask_b32_dpp v83, v67, v83, vcc quad_perm:[1,0,3,2] row_mask:0xf bank_mask:0xf
v_lshrrev_b32 v193, 18, v193
v_lshrrev_b32 v195, 18, v195
v_mfma_f32_16x16x32_bf16 v[172:175], v[220:223], v[40:43], v[172:175]
ds_read_b128 v[216:219], v248 offset:47360
buffer_store_dwordx4 v[48:51], v255, s[8:11], s70 offen sc1
ds_read_u16_d16_hi v193, v193
ds_read_u16_d16_hi v195, v195
v_rcp_f16_e64 v199, v198
v_mfma_f32_16x16x32_bf16 v[180:183], v[220:223], v[44:47], v[180:183]
v_rcp_f16_sdwa v202, v201 dst_sel:WORD_1 dst_unused:UNUSED_PRESERVE src0_sel:WORD_1
v_or_b32 v232, v184, v185
v_or_b32 v233, v186, v187
s_waitcnt lgkmcnt(6)
v_or_b32 v234, v188, v189
v_rcp_f16_sdwa v199, v198 dst_sel:WORD_1 dst_unused:UNUSED_PRESERVE src0_sel:WORD_1
v_or_b32 v235, v190, v191
s_waitcnt lgkmcnt(1)
v_or_b32 v236, v192, v193
s_waitcnt lgkmcnt(0)
v_or_b32_e64 v237, v194, v195
v_pk_mul_f16 v238, v203, v202
v_pk_mul_f16 v239, v200, v199
v_mfma_f32_16x16x32_f16 v[120:123], v[224:227], v[232:235], v[120:123]
buffer_store_dwordx4 v[68:71], v255, s[8:11], s70 offen offset:128 sc1
ds_read_b128 v[220:223], v249 offset:50432
v_cvt_pkrtz_f16_f32 v185, v168, v169
v_cvt_pkrtz_f16_f32 v187, v170, v171
v_mfma_f32_16x16x32_f16 v[128:131], v[224:227], v[236:239], v[128:131]
v_cvt_pkrtz_f16_f32 v189, v172, v173
v_cvt_pkrtz_f16_f32 v191, v174, v175
v_mfma_f32_16x16x32_f16 v[124:127], v[228:231], v[232:235], v[124:127]
ds_read_b128 v[224:227], v248 offset:48128
v_cvt_pkrtz_f16_f32 v193, v176, v177
v_cvt_pk_f16_f32 v203, v178, v179
v_cvt_pk_f16_f32 v200, v180, v181
v_mfma_f32_16x16x32_f16 v[132:135], v[228:231], v[236:239], v[132:135]
v_cvt_pk_f16_f32 v197, v182, v183
s_setprio 1
v_pk_fma_f16 v202, v203, v203, s48
v_mfma_f32_16x16x32_bf16 v[168:171], v[240:243], v[24:27], 0
ds_read_b128 v[228:231], v249 offset:51200
v_and_b32 v185, s49, v185
v_pk_fma_f16 v199, v200, v200, s48
v_mfma_f32_16x16x32_bf16 v[176:179], v[240:243], v[28:31], 0
v_and_b32_e64 v187, s49, v187
v_pk_fma_f16 v196, v197, v197, s48
v_bfe_u32 v184, v185, 2, 14
v_mfma_f32_16x16x32_f16 v[136:139], v[244:247], v[232:235], v[136:139]
ds_read_b128 v[240:243], v249 offset:51456
ds_read_u16_d16 v184, v184
v_pk_mul_f16 v202, v203, v202
v_bfe_u32 v186, v187, 2, 14
v_mfma_f32_16x16x32_f16 v[144:147], v[244:247], v[236:239], v[144:147]
v_pk_mul_f16 v199, v200, v199
v_lshrrev_b32_e64 v185, 18, v185
v_mfma_f32_16x16x32_bf16 v[172:175], v[216:219], v[24:27], 0
ds_read_b128 v[244:247], v248 offset:48384
ds_read_u16_d16 v186, v186
ds_read_u16_d16_hi v185, v185
v_pk_mul_f16 v196, v197, v196
v_lshrrev_b32_e64 v187, 18, v187
v_mfma_f32_16x16x32_bf16 v[180:183], v[216:219], v[28:31], 0
v_exp_f16_e64 v201, v202
v_and_b32 v189, s49, v189
s_waitcnt lgkmcnt(6)
v_mfma_f32_16x16x32_f16 v[140:143], v[220:223], v[232:235], v[140:143]
ds_read_b128 v[216:219], v248 offset:49152
ds_read_u16_d16_hi v187, v187
v_and_b32_e64 v191, s49, v191
v_mfma_f32_16x16x32_f16 v[148:151], v[220:223], v[236:239], v[148:151]
v_exp_f16_e64 v198, v199
v_bfe_u32 v188, v189, 2, 14
v_bfe_u32 v190, v191, 2, 14
v_mfma_f32_16x16x32_bf16 v[168:171], v[224:227], v[32:35], v[168:171]
s_add_u32 s46, s80, 20971520
buffer_load_dwordx4 v[116:119], v253, s[32:35], s46 offen offset:256 nt
ds_read_b128 v[220:223], v248 offset:49408
ds_read_u16_d16 v188, v188
ds_read_u16_d16 v190, v190
v_exp_f16_e64 v195, v196
v_mfma_f32_16x16x32_bf16 v[176:179], v[224:227], v[36:39], v[176:179]
v_lshrrev_b32_e64 v189, 18, v189
v_lshrrev_b32 v191, 18, v191
s_waitcnt lgkmcnt(5)
v_mfma_f32_16x16x32_f16 v[152:155], v[228:231], v[232:235], v[152:155]
ds_read_b128 v[224:227], v249 offset:43008
ds_read_u16_d16_hi v189, v189
ds_read_u16_d16_hi v191, v191
v_exp_f16_sdwa v201, v202 dst_sel:WORD_1 dst_unused:UNUSED_PRESERVE src0_sel:WORD_1
v_and_b32_e64 v193, s49, v193
v_mfma_f32_16x16x32_f16 v[160:163], v[228:231], v[236:239], v[160:163]
v_bfe_u32 v192, v193, 2, 14
v_mfma_f32_16x16x32_f16 v[156:159], v[240:243], v[232:235], v[156:159]
ds_read_b128 v[228:231], v249 offset:43264
ds_read_u16_d16 v192, v192
v_exp_f16_sdwa v198, v199 dst_sel:WORD_1 dst_unused:UNUSED_PRESERVE src0_sel:WORD_1
v_lshrrev_b32_e64 v193, 18, v193
v_mfma_f32_16x16x32_f16 v[164:167], v[240:243], v[236:239], v[164:167]
v_exp_f16_sdwa v195, v196 dst_sel:WORD_1 dst_unused:UNUSED_PRESERVE src0_sel:WORD_1
v_pk_add_f16 v201, v201, 1.0 op_sel_hi:[1,0]
v_mfma_f32_16x16x32_bf16 v[172:175], v[244:247], v[32:35], v[172:175]
ds_read_b128 v[240:243], v248 offset:53248
ds_read_u16_d16_hi v193, v193
v_pk_add_f16 v198, v198, 1.0 op_sel_hi:[1,0]
v_pk_add_f16 v195, v195, 1.0 op_sel_hi:[1,0]
v_mfma_f32_16x16x32_bf16 v[180:183], v[244:247], v[36:39], v[180:183]
v_rcp_f16_e64 v202, v201
s_setprio 0
s_waitcnt lgkmcnt(7)
v_mfma_f32_16x16x32_bf16 v[168:171], v[216:219], v[40:43], v[168:171]
ds_read_b128 v[244:247], v249 offset:44032
v_rcp_f16_e64 v199, v198
v_mfma_f32_16x16x32_bf16 v[176:179], v[216:219], v[44:47], v[176:179]
v_rcp_f16_e64 v196, v195
v_mfma_f32_16x16x32_bf16 v[172:175], v[220:223], v[40:43], v[172:175]
ds_read_b128 v[216:219], v248 offset:53504
v_rcp_f16_sdwa v202, v201 dst_sel:WORD_1 dst_unused:UNUSED_PRESERVE src0_sel:WORD_1
v_mfma_f32_16x16x32_bf16 v[180:183], v[220:223], v[44:47], v[180:183]
v_rcp_f16_sdwa v199, v198 dst_sel:WORD_1 dst_unused:UNUSED_PRESERVE src0_sel:WORD_1
v_or_b32 v232, v184, v185
v_or_b32 v233, v186, v187
s_waitcnt lgkmcnt(4)
v_or_b32 v234, v188, v189
v_rcp_f16_sdwa v196, v195 dst_sel:WORD_1 dst_unused:UNUSED_PRESERVE src0_sel:WORD_1
v_or_b32 v235, v190, v191
s_waitcnt lgkmcnt(2)
v_or_b32 v236, v192, v193
v_pk_mul_f16 v237, v203, v202
v_pk_mul_f16 v238, v200, v199
v_pk_mul_f16 v239, v197, v196
s_setprio 3
v_mfma_f32_16x16x32_f16 v[120:123], v[224:227], v[232:235], v[120:123]
ds_read_b128 v[220:223], v249 offset:44288
v_cvt_pkrtz_f16_f32 v185, v168, v169
v_cvt_pkrtz_f16_f32 v187, v170, v171
v_mfma_f32_16x16x32_f16 v[128:131], v[224:227], v[236:239], v[128:131]
v_cvt_pkrtz_f16_f32 v189, v172, v173
v_cvt_pkrtz_f16_f32 v191, v174, v175
v_mfma_f32_16x16x32_f16 v[124:127], v[228:231], v[232:235], v[124:127]
ds_read_b128 v[224:227], v248 offset:54272
v_cvt_pkrtz_f16_f32 v193, v176, v177
v_cvt_pk_f16_f32 v203, v178, v179
v_cvt_pk_f16_f32 v200, v180, v181
v_mfma_f32_16x16x32_f16 v[132:135], v[228:231], v[236:239], v[132:135]
v_cvt_pk_f16_f32 v197, v182, v183
v_pk_fma_f16 v202, v203, v203, s48
v_mfma_f32_16x16x32_bf16 v[168:171], v[240:243], v[24:27], 0
ds_read_b128 v[228:231], v249 offset:45056
v_and_b32_e64 v185, s49, v185
v_pk_fma_f16 v199, v200, v200, s48
v_mfma_f32_16x16x32_bf16 v[176:179], v[240:243], v[28:31], 0
v_and_b32 v187, s49, v187
v_pk_fma_f16 v196, v197, v197, s48
v_bfe_u32 v184, v185, 2, 14
s_waitcnt lgkmcnt(3)
v_mfma_f32_16x16x32_f16 v[136:139], v[244:247], v[232:235], v[136:139]
ds_read_b128 v[240:243], v249 offset:45312
ds_read_u16_d16 v184, v184
v_pk_mul_f16 v202, v203, v202
v_bfe_u32 v186, v187, 2, 14
v_mfma_f32_16x16x32_f16 v[144:147], v[244:247], v[236:239], v[144:147]
v_pk_mul_f16 v199, v200, v199
v_lshrrev_b32_e64 v185, 18, v185
v_mfma_f32_16x16x32_bf16 v[172:175], v[216:219], v[24:27], 0
ds_read_b128 v[244:247], v248 offset:54528
ds_read_u16_d16 v186, v186
ds_read_u16_d16_hi v185, v185
v_pk_mul_f16 v196, v197, v196
v_lshrrev_b32_e64 v187, 18, v187
v_mfma_f32_16x16x32_bf16 v[180:183], v[216:219], v[28:31], 0
v_exp_f16_e64 v201, v202
v_and_b32 v189, s49, v189
s_waitcnt lgkmcnt(5)
v_mfma_f32_16x16x32_f16 v[140:143], v[220:223], v[232:235], v[140:143]
ds_read_b128 v[216:219], v248 offset:55296
ds_read_u16_d16_hi v187, v187
v_and_b32_e64 v191, s49, v191
v_mfma_f32_16x16x32_f16 v[148:151], v[220:223], v[236:239], v[148:151]
v_exp_f16_e64 v198, v199
v_bfe_u32 v188, v189, 2, 14
v_bfe_u32 v190, v191, 2, 14
v_mfma_f32_16x16x32_bf16 v[168:171], v[224:227], v[32:35], v[168:171]
ds_read_b128 v[220:223], v248 offset:55552
ds_read_u16_d16 v188, v188
ds_read_u16_d16 v190, v190
v_exp_f16_e64 v195, v196
v_mfma_f32_16x16x32_bf16 v[176:179], v[224:227], v[36:39], v[176:179]
v_lshrrev_b32 v189, 18, v189
v_lshrrev_b32 v191, 18, v191
v_mfma_f32_16x16x32_f16 v[152:155], v[228:231], v[232:235], v[152:155]
ds_read_b128 v[224:227], v249 offset:55296
ds_read_u16_d16_hi v189, v189
ds_read_u16_d16_hi v191, v191
v_exp_f16_sdwa v201, v202 dst_sel:WORD_1 dst_unused:UNUSED_PRESERVE src0_sel:WORD_1
v_and_b32 v193, s49, v193
v_mfma_f32_16x16x32_f16 v[160:163], v[228:231], v[236:239], v[160:163]
v_bfe_u32 v192, v193, 2, 14
s_waitcnt lgkmcnt(8)
v_mfma_f32_16x16x32_f16 v[156:159], v[240:243], v[232:235], v[156:159]
ds_read_b128 v[228:231], v249 offset:55552
ds_read_u16_d16 v192, v192
v_exp_f16_sdwa v198, v199 dst_sel:WORD_1 dst_unused:UNUSED_PRESERVE src0_sel:WORD_1
v_lshrrev_b32_e64 v193, 18, v193
v_mfma_f32_16x16x32_f16 v[164:167], v[240:243], v[236:239], v[164:167]
v_exp_f16_sdwa v195, v196 dst_sel:WORD_1 dst_unused:UNUSED_PRESERVE src0_sel:WORD_1
v_pk_add_f16 v201, v201, 1.0 op_sel_hi:[1,0]
v_mfma_f32_16x16x32_bf16 v[172:175], v[244:247], v[32:35], v[172:175]
ds_read_b128 v[240:243], v248 offset:59392
ds_read_u16_d16_hi v193, v193
v_pk_add_f16 v198, v198, 1.0 op_sel_hi:[1,0]
v_pk_add_f16 v195, v195, 1.0 op_sel_hi:[1,0]
v_mfma_f32_16x16x32_bf16 v[180:183], v[244:247], v[36:39], v[180:183]
v_rcp_f16 v202, v201
s_waitcnt lgkmcnt(7)
v_mfma_f32_16x16x32_bf16 v[168:171], v[216:219], v[40:43], v[168:171]
ds_read_b128 v[244:247], v249 offset:56320
v_rcp_f16_e64 v199, v198
v_mfma_f32_16x16x32_bf16 v[176:179], v[216:219], v[44:47], v[176:179]
v_rcp_f16_e64 v196, v195
v_mfma_f32_16x16x32_bf16 v[172:175], v[220:223], v[40:43], v[172:175]
ds_read_b128 v[216:219], v248 offset:59648
v_rcp_f16_sdwa v202, v201 dst_sel:WORD_1 dst_unused:UNUSED_PRESERVE src0_sel:WORD_1
v_mfma_f32_16x16x32_bf16 v[180:183], v[220:223], v[44:47], v[180:183]
v_rcp_f16_sdwa v199, v198 dst_sel:WORD_1 dst_unused:UNUSED_PRESERVE src0_sel:WORD_1
v_or_b32 v232, v184, v185
v_or_b32 v233, v186, v187
s_waitcnt lgkmcnt(4)
v_or_b32 v234, v188, v189
v_rcp_f16_sdwa v196, v195 dst_sel:WORD_1 dst_unused:UNUSED_PRESERVE src0_sel:WORD_1
v_or_b32 v235, v190, v191
s_waitcnt lgkmcnt(2)
v_or_b32_e64 v236, v192, v193
v_pk_mul_f16 v237, v203, v202
v_pk_mul_f16 v238, v200, v199
v_pk_mul_f16 v239, v197, v196
v_mfma_f32_16x16x32_f16 v[120:123], v[224:227], v[232:235], v[120:123]
buffer_load_dwordx4 v[204:207], v252, s[4:7], s68 offen
ds_read_b128 v[220:223], v249 offset:56576
v_cvt_pkrtz_f16_f32 v185, v168, v169
v_cvt_pkrtz_f16_f32 v187, v170, v171
v_mfma_f32_16x16x32_f16 v[128:131], v[224:227], v[236:239], v[128:131]
v_cvt_pkrtz_f16_f32 v189, v172, v173
v_cvt_pkrtz_f16_f32 v191, v174, v175
v_mfma_f32_16x16x32_f16 v[124:127], v[228:231], v[232:235], v[124:127]
ds_read_b128 v[224:227], v248 offset:60416
v_cvt_pkrtz_f16_f32 v193, v176, v177
v_cvt_pk_f16_f32 v203, v178, v179
v_cvt_pk_f16_f32 v200, v180, v181
v_mfma_f32_16x16x32_f16 v[132:135], v[228:231], v[236:239], v[132:135]
v_cvt_pk_f16_f32 v197, v182, v183
v_pk_fma_f16 v202, v203, v203, s48
v_mfma_f32_16x16x32_bf16 v[168:171], v[240:243], v[24:27], 0
ds_read_b128 v[228:231], v249 offset:57344
v_and_b32_e64 v185, s49, v185
v_pk_fma_f16 v199, v200, v200, s48
v_mfma_f32_16x16x32_bf16 v[176:179], v[240:243], v[28:31], 0
v_and_b32_e64 v187, s49, v187
v_pk_fma_f16 v196, v197, v197, s48
s_setprio 2
v_bfe_u32 v184, v185, 2, 14
s_waitcnt lgkmcnt(3)
v_mfma_f32_16x16x32_f16 v[136:139], v[244:247], v[232:235], v[136:139]
ds_read_b128 v[240:243], v249 offset:57600
ds_read_u16_d16 v184, v184
v_pk_mul_f16 v202, v203, v202
v_bfe_u32 v186, v187, 2, 14
v_mfma_f32_16x16x32_f16 v[144:147], v[244:247], v[236:239], v[144:147]
v_pk_mul_f16 v199, v200, v199
v_lshrrev_b32_e64 v185, 18, v185
v_mfma_f32_16x16x32_bf16 v[172:175], v[216:219], v[24:27], 0
ds_read_b128 v[244:247], v248 offset:60672
ds_read_u16_d16 v186, v186
ds_read_u16_d16_hi v185, v185
v_pk_mul_f16 v196, v197, v196
v_lshrrev_b32_e64 v187, 18, v187
v_mfma_f32_16x16x32_bf16 v[180:183], v[216:219], v[28:31], 0
v_exp_f16_e64 v201, v202
v_and_b32 v189, s49, v189
s_waitcnt lgkmcnt(5)
v_mfma_f32_16x16x32_f16 v[140:143], v[220:223], v[232:235], v[140:143]
ds_read_b128 v[216:219], v248 offset:61440
ds_read_u16_d16_hi v187, v187
v_and_b32_e64 v191, s49, v191
v_mfma_f32_16x16x32_f16 v[148:151], v[220:223], v[236:239], v[148:151]
v_exp_f16_e64 v198, v199
v_bfe_u32 v188, v189, 2, 14
v_bfe_u32 v190, v191, 2, 14
v_mfma_f32_16x16x32_bf16 v[168:171], v[224:227], v[32:35], v[168:171]
buffer_store_dwordx4 v[80:83], v255, s[8:11], s70 offen offset:256 sc1
ds_read_b128 v[220:223], v248 offset:61696
ds_read_u16_d16 v188, v188
ds_read_u16_d16 v190, v190
v_exp_f16_e64 v195, v196
v_mfma_f32_16x16x32_bf16 v[176:179], v[224:227], v[36:39], v[176:179]
v_lshrrev_b32 v189, 18, v189
v_lshrrev_b32 v191, 18, v191
v_mfma_f32_16x16x32_f16 v[152:155], v[228:231], v[232:235], v[152:155]
ds_read_b128 v[224:227], v249 offset:61440
ds_read_u16_d16_hi v189, v189
ds_read_u16_d16_hi v191, v191
v_exp_f16_sdwa v201, v202 dst_sel:WORD_1 dst_unused:UNUSED_PRESERVE src0_sel:WORD_1
v_and_b32 v193, s49, v193
v_mfma_f32_16x16x32_f16 v[160:163], v[228:231], v[236:239], v[160:163]
v_bfe_u32 v192, v193, 2, 14
s_waitcnt lgkmcnt(8)
v_mfma_f32_16x16x32_f16 v[156:159], v[240:243], v[232:235], v[156:159]
ds_read_b128 v[228:231], v249 offset:61696
ds_read_u16_d16 v192, v192
v_exp_f16_sdwa v198, v199 dst_sel:WORD_1 dst_unused:UNUSED_PRESERVE src0_sel:WORD_1
v_lshrrev_b32_e64 v193, 18, v193
v_mfma_f32_16x16x32_f16 v[164:167], v[240:243], v[236:239], v[164:167]
v_exp_f16_sdwa v195, v196 dst_sel:WORD_1 dst_unused:UNUSED_PRESERVE src0_sel:WORD_1
v_pk_add_f16 v201, v201, 1.0 op_sel_hi:[1,0]
v_mfma_f32_16x16x32_bf16 v[172:175], v[244:247], v[32:35], v[172:175]
ds_read_b128 v[240:243], v249
ds_read_u16_d16_hi v193, v193
v_pk_add_f16 v198, v198, 1.0 op_sel_hi:[1,0]
v_pk_add_f16 v195, v195, 1.0 op_sel_hi:[1,0]
v_mfma_f32_16x16x32_bf16 v[180:183], v[244:247], v[36:39], v[180:183]
v_rcp_f16 v202, v201
s_waitcnt lgkmcnt(7)
v_mfma_f32_16x16x32_bf16 v[168:171], v[216:219], v[40:43], v[168:171]
ds_read_b128 v[244:247], v249 offset:62464
v_rcp_f16_e64 v199, v198
v_mfma_f32_16x16x32_bf16 v[176:179], v[216:219], v[44:47], v[176:179]
v_rcp_f16_e64 v196, v195
v_mfma_f32_16x16x32_bf16 v[172:175], v[220:223], v[40:43], v[172:175]
ds_read_b128 v[216:219], v249 offset:256
v_rcp_f16_sdwa v202, v201 dst_sel:WORD_1 dst_unused:UNUSED_PRESERVE src0_sel:WORD_1
v_mfma_f32_16x16x32_bf16 v[180:183], v[220:223], v[44:47], v[180:183]
v_rcp_f16_sdwa v199, v198 dst_sel:WORD_1 dst_unused:UNUSED_PRESERVE src0_sel:WORD_1
v_or_b32 v232, v184, v185
v_or_b32 v233, v186, v187
s_waitcnt lgkmcnt(4)
v_or_b32 v234, v188, v189
v_rcp_f16_sdwa v196, v195 dst_sel:WORD_1 dst_unused:UNUSED_PRESERVE src0_sel:WORD_1
v_or_b32 v235, v190, v191
s_waitcnt lgkmcnt(2)
v_or_b32_e64 v236, v192, v193
v_pk_mul_f16 v237, v203, v202
v_pk_mul_f16 v238, v200, v199
v_pk_mul_f16 v239, v197, v196
v_mfma_f32_16x16x32_f16 v[120:123], v[224:227], v[232:235], v[120:123]
buffer_load_dwordx4 v[208:211], v252, s[4:7], s68 offen offset:64
ds_read_b128 v[220:223], v249 offset:62720
v_cvt_pkrtz_f16_f32 v185, v168, v169
v_cvt_pkrtz_f16_f32 v187, v170, v171
v_mfma_f32_16x16x32_f16 v[128:131], v[224:227], v[236:239], v[128:131]
v_cvt_pkrtz_f16_f32 v189, v172, v173
v_cvt_pkrtz_f16_f32 v191, v174, v175
v_mfma_f32_16x16x32_f16 v[124:127], v[228:231], v[232:235], v[124:127]
ds_read_b128 v[224:227], v249 offset:1024
v_cvt_pkrtz_f16_f32 v193, v176, v177
v_cvt_pk_f16_f32 v203, v178, v179
v_cvt_pk_f16_f32 v200, v180, v181
v_mfma_f32_16x16x32_f16 v[132:135], v[228:231], v[236:239], v[132:135]
v_cvt_pk_f16_f32 v197, v182, v183
s_setprio 1
v_pk_fma_f16 v202, v203, v203, s48
v_mfma_f32_16x16x32_bf16 v[168:171], v[240:243], v[24:27], 0
ds_read_b128 v[228:231], v249 offset:63488
v_and_b32 v185, s49, v185
v_pk_fma_f16 v199, v200, v200, s48
v_mfma_f32_16x16x32_bf16 v[176:179], v[240:243], v[28:31], 0
v_and_b32 v187, s49, v187
v_pk_fma_f16 v196, v197, v197, s48
v_bfe_u32 v184, v185, 2, 14
s_waitcnt lgkmcnt(3)
v_mfma_f32_16x16x32_f16 v[136:139], v[244:247], v[232:235], v[136:139]
ds_read_b128 v[240:243], v249 offset:63744
ds_read_u16_d16 v184, v184
v_pk_mul_f16 v202, v203, v202
v_bfe_u32 v186, v187, 2, 14
v_mfma_f32_16x16x32_f16 v[144:147], v[244:247], v[236:239], v[144:147]
v_pk_mul_f16 v199, v200, v199
v_lshrrev_b32_e64 v185, 18, v185
v_mfma_f32_16x16x32_bf16 v[172:175], v[216:219], v[24:27], 0
ds_read_b128 v[244:247], v249 offset:1280
ds_read_u16_d16 v186, v186
ds_read_u16_d16_hi v185, v185
v_pk_mul_f16 v196, v197, v196
v_lshrrev_b32_e64 v187, 18, v187
v_mfma_f32_16x16x32_bf16 v[180:183], v[216:219], v[28:31], 0
v_exp_f16_e64 v201, v202
v_and_b32 v189, s49, v189
s_waitcnt lgkmcnt(5)
v_mfma_f32_16x16x32_f16 v[140:143], v[220:223], v[232:235], v[140:143]
ds_read_b128 v[216:219], v249 offset:2048
ds_read_u16_d16_hi v187, v187
v_and_b32_e64 v191, s49, v191
v_mfma_f32_16x16x32_f16 v[148:151], v[220:223], v[236:239], v[148:151]
v_exp_f16_e64 v198, v199
v_bfe_u32 v188, v189, 2, 14
v_bfe_u32 v190, v191, 2, 14
v_mfma_f32_16x16x32_bf16 v[168:171], v[224:227], v[32:35], v[168:171]
ds_read_b128 v[220:223], v249 offset:2304
ds_read_u16_d16 v188, v188
ds_read_u16_d16 v190, v190
v_exp_f16_e64 v195, v196
v_mfma_f32_16x16x32_bf16 v[176:179], v[224:227], v[36:39], v[176:179]
v_lshrrev_b32 v189, 18, v189
v_lshrrev_b32 v191, 18, v191
v_mfma_f32_16x16x32_f16 v[152:155], v[228:231], v[232:235], v[152:155]
ds_read_b128 v[224:227], v250 offset:2048
ds_read_u16_d16_hi v189, v189
ds_read_u16_d16_hi v191, v191
v_exp_f16_sdwa v201, v202 dst_sel:WORD_1 dst_unused:UNUSED_PRESERVE src0_sel:WORD_1
v_and_b32 v193, s49, v193
v_mfma_f32_16x16x32_f16 v[160:163], v[228:231], v[236:239], v[160:163]
v_bfe_u32 v192, v193, 2, 14
s_waitcnt lgkmcnt(8)
v_mfma_f32_16x16x32_f16 v[156:159], v[240:243], v[232:235], v[156:159]
ds_read_b128 v[228:231], v250 offset:2304
ds_read_u16_d16 v192, v192
v_exp_f16_sdwa v198, v199 dst_sel:WORD_1 dst_unused:UNUSED_PRESERVE src0_sel:WORD_1
v_lshrrev_b32_e64 v193, 18, v193
v_mfma_f32_16x16x32_f16 v[164:167], v[240:243], v[236:239], v[164:167]
v_exp_f16_sdwa v195, v196 dst_sel:WORD_1 dst_unused:UNUSED_PRESERVE src0_sel:WORD_1
v_pk_add_f16 v201, v201, 1.0 op_sel_hi:[1,0]
v_mfma_f32_16x16x32_bf16 v[172:175], v[244:247], v[32:35], v[172:175]
ds_read_b128 v[240:243], v249 offset:6144
ds_read_u16_d16_hi v193, v193
v_pk_add_f16 v198, v198, 1.0 op_sel_hi:[1,0]
v_pk_add_f16 v195, v195, 1.0 op_sel_hi:[1,0]
v_mfma_f32_16x16x32_bf16 v[180:183], v[244:247], v[36:39], v[180:183]
v_rcp_f16_e64 v202, v201
s_setprio 0
s_waitcnt lgkmcnt(7)
v_mfma_f32_16x16x32_bf16 v[168:171], v[216:219], v[40:43], v[168:171]
ds_read_b128 v[244:247], v250 offset:3072
v_rcp_f16_e64 v199, v198
v_mfma_f32_16x16x32_bf16 v[176:179], v[216:219], v[44:47], v[176:179]
v_rcp_f16_e64 v196, v195
v_mfma_f32_16x16x32_bf16 v[172:175], v[220:223], v[40:43], v[172:175]
ds_read_b128 v[216:219], v249 offset:6400
v_rcp_f16_sdwa v202, v201 dst_sel:WORD_1 dst_unused:UNUSED_PRESERVE src0_sel:WORD_1
v_mfma_f32_16x16x32_bf16 v[180:183], v[220:223], v[44:47], v[180:183]
v_rcp_f16_sdwa v199, v198 dst_sel:WORD_1 dst_unused:UNUSED_PRESERVE src0_sel:WORD_1
v_or_b32 v232, v184, v185
v_or_b32 v233, v186, v187
s_waitcnt lgkmcnt(4)
v_or_b32 v234, v188, v189
v_rcp_f16_sdwa v196, v195 dst_sel:WORD_1 dst_unused:UNUSED_PRESERVE src0_sel:WORD_1
v_or_b32 v235, v190, v191
s_waitcnt lgkmcnt(2)
v_or_b32 v236, v192, v193
v_pk_mul_f16 v237, v203, v202
v_pk_mul_f16 v238, v200, v199
v_pk_mul_f16 v239, v197, v196
s_setprio 3
v_mfma_f32_16x16x32_f16 v[120:123], v[224:227], v[232:235], v[120:123]
ds_read_b128 v[220:223], v250 offset:3328
v_cvt_pkrtz_f16_f32 v185, v168, v169
v_cvt_pkrtz_f16_f32 v187, v170, v171
v_cvt_pkrtz_f16_f32 v189, v172, v173
v_mfma_f32_16x16x32_f16 v[128:131], v[224:227], v[236:239], v[128:131]
v_cvt_pkrtz_f16_f32 v191, v174, v175
v_cvt_pkrtz_f16_f32 v193, v176, v177
v_cvt_pkrtz_f16_f32 v195, v178, v179
v_mfma_f32_16x16x32_f16 v[124:127], v[228:231], v[232:235], v[124:127]
ds_read_b128 v[224:227], v249 offset:7168
v_cvt_pk_f16_f32 v203, v180, v181
v_cvt_pk_f16_f32 v200, v182, v183
v_pk_fma_f16 v202, v203, v203, s48
v_mfma_f32_16x16x32_f16 v[132:135], v[228:231], v[236:239], v[132:135]
v_cvt_pk_bf16_f32 v72, v72, v73
v_and_b32_e64 v185, s49, v185
v_cvt_pk_bf16_f32 v73, v74, v75
v_mfma_f32_16x16x32_bf16 v[168:171], v[240:243], v[24:27], 0
ds_read_b128 v[228:231], v250 offset:4096
v_and_b32 v187, s49, v187
v_cvt_pk_bf16_f32 v74, v76, v77
v_pk_fma_f16 v199, v200, v200, s48
v_mfma_f32_16x16x32_bf16 v[176:179], v[240:243], v[28:31], 0
v_bfe_u32 v184, v185, 2, 14
v_cvt_pk_bf16_f32 v75, v78, v79
v_pk_mul_f16 v202, v203, v202
s_waitcnt lgkmcnt(2)
v_mfma_f32_16x16x32_f16 v[136:139], v[244:247], v[232:235], v[136:139]
ds_read_b128 v[240:243], v250 offset:4352
ds_read_u16_d16 v184, v184
v_cvt_pk_bf16_f32 v56, v56, v57
v_bfe_u32 v186, v187, 2, 14
v_cvt_pk_bf16_f32 v57, v58, v59
v_mfma_f32_16x16x32_f16 v[144:147], v[244:247], v[236:239], v[144:147]
v_pk_mul_f16 v199, v200, v199
v_lshrrev_b32_e64 v185, 18, v185
v_cvt_pk_bf16_f32 v58, v60, v61
v_mfma_f32_16x16x32_bf16 v[172:175], v[216:219], v[24:27], 0
ds_read_b128 v[244:247], v249 offset:7424
ds_read_u16_d16 v186, v186
ds_read_u16_d16_hi v185, v185
v_exp_f16_e64 v201, v202
v_cvt_pk_bf16_f32 v59, v62, v63
v_mfma_f32_16x16x32_bf16 v[180:183], v[216:219], v[28:31], 0
v_lshrrev_b32_e64 v187, 18, v187
v_cvt_pk_bf16_f32 v88, v88, v89
v_and_b32_e64 v189, s49, v189
v_mfma_f32_16x16x32_f16 v[140:143], v[220:223], v[232:235], v[140:143]
ds_read_b128 v[216:219], v249 offset:8192
ds_read_u16_d16_hi v187, v187
v_cvt_pk_bf16_f32 v89, v90, v91
v_exp_f16_e64 v198, v199
v_mfma_f32_16x16x32_f16 v[148:151], v[220:223], v[236:239], v[148:151]
v_cvt_pk_bf16_f32 v90, v92, v93
v_and_b32_e64 v191, s49, v191
v_cvt_pk_bf16_f32 v91, v94, v95
s_mov_b64 vcc, s[74:75]
s_waitcnt lgkmcnt(5)
v_mfma_f32_16x16x32_bf16 v[168:171], v[224:227], v[32:35], v[168:171]
ds_read_b128 v[220:223], v249 offset:8448
v_bfe_u32 v188, v189, 2, 14
v_cndmask_b32 v76, v56, v88, vcc
v_mfma_f32_16x16x32_bf16 v[176:179], v[224:227], v[36:39], v[176:179]
v_exp_f16_sdwa v201, v202 dst_sel:WORD_1 dst_unused:UNUSED_PRESERVE src0_sel:WORD_1
v_cndmask_b32 v77, v57, v89, vcc
v_bfe_u32 v190, v191, 2, 14
v_mfma_f32_16x16x32_f16 v[152:155], v[228:231], v[232:235], v[152:155]
ds_read_b128 v[224:227], v250 offset:8192
ds_read_u16_d16 v188, v188
ds_read_u16_d16 v190, v190
v_cndmask_b32 v78, v58, v90, vcc
v_lshrrev_b32 v189, 18, v189
v_cndmask_b32 v79, v59, v91, vcc
v_mfma_f32_16x16x32_f16 v[160:163], v[228:231], v[236:239], v[160:163]
v_lshrrev_b32 v191, 18, v191
v_exp_f16_sdwa v198, v199 dst_sel:WORD_1 dst_unused:UNUSED_PRESERVE src0_sel:WORD_1
v_mfma_f32_16x16x32_f16 v[156:159], v[240:243], v[232:235], v[156:159]
ds_read_b128 v[228:231], v250 offset:8448
ds_read_u16_d16_hi v189, v189
ds_read_u16_d16_hi v191, v191
v_cndmask_b32_dpp v56, v72, v56, vcc quad_perm:[1,0,3,2] row_mask:0xf bank_mask:0xf
v_cndmask_b32_dpp v57, v73, v57, vcc quad_perm:[1,0,3,2] row_mask:0xf bank_mask:0xf
v_and_b32_e64 v193, s49, v193
v_mfma_f32_16x16x32_f16 v[164:167], v[240:243], v[236:239], v[164:167]
v_cndmask_b32_dpp v58, v74, v58, vcc quad_perm:[1,0,3,2] row_mask:0xf bank_mask:0xf
v_and_b32_e64 v195, s49, v195
v_pk_add_f16 v201, v201, 1.0 op_sel_hi:[1,0]
s_waitcnt lgkmcnt(6)
v_mfma_f32_16x16x32_bf16 v[172:175], v[244:247], v[32:35], v[172:175]
ds_read_b128 v[240:243], v249 offset:12288
v_cndmask_b32_dpp v59, v75, v59, vcc quad_perm:[1,0,3,2] row_mask:0xf bank_mask:0xf
s_not_b64 vcc, s[74:75]
v_bfe_u32 v192, v193, 2, 14
v_cndmask_b32_dpp v88, v72, v88, vcc quad_perm:[1,0,3,2] row_mask:0xf bank_mask:0xf
v_mfma_f32_16x16x32_bf16 v[180:183], v[244:247], v[36:39], v[180:183]
v_pk_add_f16 v198, v198, 1.0 op_sel_hi:[1,0]
v_cndmask_b32_dpp v89, v73, v89, vcc quad_perm:[1,0,3,2] row_mask:0xf bank_mask:0xf
v_bfe_u32 v194, v195, 2, 14
v_mfma_f32_16x16x32_bf16 v[168:171], v[216:219], v[40:43], v[168:171]
ds_read_b128 v[244:247], v250 offset:9216
ds_read_u16_d16 v192, v192
ds_read_u16_d16 v194, v194
v_rcp_f16_e64 v202, v201
v_cndmask_b32_dpp v90, v74, v90, vcc quad_perm:[1,0,3,2] row_mask:0xf bank_mask:0xf
v_mfma_f32_16x16x32_bf16 v[176:179], v[216:219], v[44:47], v[176:179]
v_cndmask_b32_dpp v91, v75, v91, vcc quad_perm:[1,0,3,2] row_mask:0xf bank_mask:0xf
v_lshrrev_b32 v193, 18, v193
v_lshrrev_b32 v195, 18, v195
v_mfma_f32_16x16x32_bf16 v[172:175], v[220:223], v[40:43], v[172:175]
ds_read_b128 v[216:219], v249 offset:12544
s_add_u32 s46, s70, 98304
buffer_store_dwordx4 v[56:59], v255, s[8:11], s46 offen sc1
ds_read_u16_d16_hi v193, v193
ds_read_u16_d16_hi v195, v195
v_rcp_f16_e64 v199, v198
v_mfma_f32_16x16x32_bf16 v[180:183], v[220:223], v[44:47], v[180:183]
v_rcp_f16_sdwa v202, v201 dst_sel:WORD_1 dst_unused:UNUSED_PRESERVE src0_sel:WORD_1
v_or_b32 v232, v184, v185
v_or_b32 v233, v186, v187
s_waitcnt lgkmcnt(6)
v_or_b32 v234, v188, v189
v_rcp_f16_sdwa v199, v198 dst_sel:WORD_1 dst_unused:UNUSED_PRESERVE src0_sel:WORD_1
v_or_b32 v235, v190, v191
s_waitcnt lgkmcnt(1)
v_or_b32 v236, v192, v193
s_waitcnt lgkmcnt(0)
v_or_b32_e64 v237, v194, v195
v_pk_mul_f16 v238, v203, v202
v_pk_mul_f16 v239, v200, v199
v_mfma_f32_16x16x32_f16 v[120:123], v[224:227], v[232:235], v[120:123]
buffer_load_dwordx4 v[12:15], v252, s[4:7], s68 offen offset:128
ds_read_b128 v[220:223], v250 offset:9472
v_cvt_pkrtz_f16_f32 v185, v168, v169
v_cvt_pkrtz_f16_f32 v187, v170, v171
v_mfma_f32_16x16x32_f16 v[128:131], v[224:227], v[236:239], v[128:131]
v_cvt_pkrtz_f16_f32 v189, v172, v173
v_cvt_pkrtz_f16_f32 v191, v174, v175
v_mfma_f32_16x16x32_f16 v[124:127], v[228:231], v[232:235], v[124:127]
ds_read_b128 v[224:227], v249 offset:13312
v_cvt_pkrtz_f16_f32 v193, v176, v177
v_cvt_pk_f16_f32 v203, v178, v179
v_cvt_pk_f16_f32 v200, v180, v181
v_mfma_f32_16x16x32_f16 v[132:135], v[228:231], v[236:239], v[132:135]
v_cvt_pk_f16_f32 v197, v182, v183
v_pk_fma_f16 v202, v203, v203, s48
v_mfma_f32_16x16x32_bf16 v[168:171], v[240:243], v[24:27], 0
ds_read_b128 v[228:231], v250 offset:10240
v_and_b32_e64 v185, s49, v185
v_pk_fma_f16 v199, v200, v200, s48
v_mfma_f32_16x16x32_bf16 v[176:179], v[240:243], v[28:31], 0
v_and_b32 v187, s49, v187
v_pk_fma_f16 v196, v197, v197, s48
s_setprio 2
v_bfe_u32 v184, v185, 2, 14
v_mfma_f32_16x16x32_f16 v[136:139], v[244:247], v[232:235], v[136:139]
ds_read_b128 v[240:243], v250 offset:10496
ds_read_u16_d16 v184, v184
v_pk_mul_f16 v202, v203, v202
v_bfe_u32 v186, v187, 2, 14
v_mfma_f32_16x16x32_f16 v[144:147], v[244:247], v[236:239], v[144:147]
v_pk_mul_f16 v199, v200, v199
v_lshrrev_b32_e64 v185, 18, v185
v_mfma_f32_16x16x32_bf16 v[172:175], v[216:219], v[24:27], 0
ds_read_b128 v[244:247], v249 offset:13568
ds_read_u16_d16 v186, v186
ds_read_u16_d16_hi v185, v185
v_pk_mul_f16 v196, v197, v196
v_lshrrev_b32_e64 v187, 18, v187
v_mfma_f32_16x16x32_bf16 v[180:183], v[216:219], v[28:31], 0
v_exp_f16_e64 v201, v202
v_and_b32 v189, s49, v189
s_waitcnt lgkmcnt(5)
v_mfma_f32_16x16x32_f16 v[140:143], v[220:223], v[232:235], v[140:143]
ds_read_b128 v[216:219], v249 offset:14336
ds_read_u16_d16_hi v187, v187
v_and_b32_e64 v191, s49, v191
v_mfma_f32_16x16x32_f16 v[148:151], v[220:223], v[236:239], v[148:151]
v_exp_f16_e64 v198, v199
v_bfe_u32 v188, v189, 2, 14
v_bfe_u32 v190, v191, 2, 14
v_mfma_f32_16x16x32_bf16 v[168:171], v[224:227], v[32:35], v[168:171]
ds_read_b128 v[220:223], v249 offset:14592
ds_read_u16_d16 v188, v188
ds_read_u16_d16 v190, v190
v_exp_f16_e64 v195, v196
v_mfma_f32_16x16x32_bf16 v[176:179], v[224:227], v[36:39], v[176:179]
v_lshrrev_b32 v189, 18, v189
v_lshrrev_b32 v191, 18, v191
v_mfma_f32_16x16x32_f16 v[152:155], v[228:231], v[232:235], v[152:155]
ds_read_b128 v[224:227], v250 offset:14336
ds_read_u16_d16_hi v189, v189
ds_read_u16_d16_hi v191, v191
v_exp_f16_sdwa v201, v202 dst_sel:WORD_1 dst_unused:UNUSED_PRESERVE src0_sel:WORD_1
v_and_b32 v193, s49, v193
v_mfma_f32_16x16x32_f16 v[160:163], v[228:231], v[236:239], v[160:163]
v_bfe_u32 v192, v193, 2, 14
s_waitcnt lgkmcnt(8)
v_mfma_f32_16x16x32_f16 v[156:159], v[240:243], v[232:235], v[156:159]
ds_read_b128 v[228:231], v250 offset:14592
ds_read_u16_d16 v192, v192
v_exp_f16_sdwa v198, v199 dst_sel:WORD_1 dst_unused:UNUSED_PRESERVE src0_sel:WORD_1
v_lshrrev_b32_e64 v193, 18, v193
v_mfma_f32_16x16x32_f16 v[164:167], v[240:243], v[236:239], v[164:167]
v_exp_f16_sdwa v195, v196 dst_sel:WORD_1 dst_unused:UNUSED_PRESERVE src0_sel:WORD_1
v_pk_add_f16 v201, v201, 1.0 op_sel_hi:[1,0]
v_mfma_f32_16x16x32_bf16 v[172:175], v[244:247], v[32:35], v[172:175]
ds_read_b128 v[240:243], v249 offset:18432
ds_read_u16_d16_hi v193, v193
v_pk_add_f16 v198, v198, 1.0 op_sel_hi:[1,0]
v_pk_add_f16 v195, v195, 1.0 op_sel_hi:[1,0]
v_mfma_f32_16x16x32_bf16 v[180:183], v[244:247], v[36:39], v[180:183]
v_rcp_f16 v202, v201
s_waitcnt lgkmcnt(7)
v_mfma_f32_16x16x32_bf16 v[168:171], v[216:219], v[40:43], v[168:171]
ds_read_b128 v[244:247], v250 offset:15360
v_rcp_f16_e64 v199, v198
v_mfma_f32_16x16x32_bf16 v[176:179], v[216:219], v[44:47], v[176:179]
v_rcp_f16_e64 v196, v195
v_mfma_f32_16x16x32_bf16 v[172:175], v[220:223], v[40:43], v[172:175]
ds_read_b128 v[216:219], v249 offset:18688
v_rcp_f16_sdwa v202, v201 dst_sel:WORD_1 dst_unused:UNUSED_PRESERVE src0_sel:WORD_1
v_mfma_f32_16x16x32_bf16 v[180:183], v[220:223], v[44:47], v[180:183]
v_rcp_f16_sdwa v199, v198 dst_sel:WORD_1 dst_unused:UNUSED_PRESERVE src0_sel:WORD_1
v_or_b32 v232, v184, v185
v_or_b32 v233, v186, v187
s_waitcnt lgkmcnt(4)
v_or_b32 v234, v188, v189
v_rcp_f16_sdwa v196, v195 dst_sel:WORD_1 dst_unused:UNUSED_PRESERVE src0_sel:WORD_1
v_or_b32 v235, v190, v191
s_waitcnt lgkmcnt(2)
v_or_b32_e64 v236, v192, v193
v_pk_mul_f16 v237, v203, v202
v_pk_mul_f16 v238, v200, v199
v_pk_mul_f16 v239, v197, v196
v_mfma_f32_16x16x32_f16 v[120:123], v[224:227], v[232:235], v[120:123]
s_add_u32 s46, s68, 98304
buffer_load_dwordx4 v[8:11], v252, s[4:7], s46 offen
ds_read_b128 v[220:223], v250 offset:15616
v_cvt_pkrtz_f16_f32 v185, v168, v169
v_cvt_pkrtz_f16_f32 v187, v170, v171
v_mfma_f32_16x16x32_f16 v[128:131], v[224:227], v[236:239], v[128:131]
v_cvt_pkrtz_f16_f32 v189, v172, v173
v_cvt_pkrtz_f16_f32 v191, v174, v175
v_mfma_f32_16x16x32_f16 v[124:127], v[228:231], v[232:235], v[124:127]
ds_read_b128 v[224:227], v249 offset:19456
v_cvt_pkrtz_f16_f32 v193, v176, v177
v_cvt_pk_f16_f32 v203, v178, v179
v_cvt_pk_f16_f32 v200, v180, v181
v_mfma_f32_16x16x32_f16 v[132:135], v[228:231], v[236:239], v[132:135]
v_cvt_pk_f16_f32 v197, v182, v183
s_setprio 1
v_pk_fma_f16 v202, v203, v203, s48
v_mfma_f32_16x16x32_bf16 v[168:171], v[240:243], v[24:27], 0
ds_read_b128 v[228:231], v250 offset:16384
v_and_b32 v185, s49, v185
v_pk_fma_f16 v199, v200, v200, s48
v_mfma_f32_16x16x32_bf16 v[176:179], v[240:243], v[28:31], 0
v_and_b32 v187, s49, v187
v_pk_fma_f16 v196, v197, v197, s48
v_bfe_u32 v184, v185, 2, 14
s_waitcnt lgkmcnt(3)
v_mfma_f32_16x16x32_f16 v[136:139], v[244:247], v[232:235], v[136:139]
ds_read_b128 v[240:243], v250 offset:16640
ds_read_u16_d16 v184, v184
v_pk_mul_f16 v202, v203, v202
v_bfe_u32 v186, v187, 2, 14
v_mfma_f32_16x16x32_f16 v[144:147], v[244:247], v[236:239], v[144:147]
v_pk_mul_f16 v199, v200, v199
v_lshrrev_b32_e64 v185, 18, v185
v_mfma_f32_16x16x32_bf16 v[172:175], v[216:219], v[24:27], 0
ds_read_b128 v[244:247], v249 offset:19712
ds_read_u16_d16 v186, v186
ds_read_u16_d16_hi v185, v185
v_pk_mul_f16 v196, v197, v196
v_lshrrev_b32_e64 v187, 18, v187
v_mfma_f32_16x16x32_bf16 v[180:183], v[216:219], v[28:31], 0
v_exp_f16_e64 v201, v202
v_and_b32 v189, s49, v189
s_waitcnt lgkmcnt(5)
v_mfma_f32_16x16x32_f16 v[140:143], v[220:223], v[232:235], v[140:143]
ds_read_b128 v[216:219], v249 offset:20480
ds_read_u16_d16_hi v187, v187
v_and_b32_e64 v191, s49, v191
v_mfma_f32_16x16x32_f16 v[148:151], v[220:223], v[236:239], v[148:151]
v_exp_f16_e64 v198, v199
v_bfe_u32 v188, v189, 2, 14
v_bfe_u32 v190, v191, 2, 14
v_mfma_f32_16x16x32_bf16 v[168:171], v[224:227], v[32:35], v[168:171]
s_add_u32 s46, s70, 98304
buffer_store_dwordx4 v[76:79], v255, s[8:11], s46 offen offset:128 sc1
ds_read_b128 v[220:223], v249 offset:20736
ds_read_u16_d16 v188, v188
ds_read_u16_d16 v190, v190
v_exp_f16_e64 v195, v196
v_mfma_f32_16x16x32_bf16 v[176:179], v[224:227], v[36:39], v[176:179]
v_lshrrev_b32 v189, 18, v189
v_lshrrev_b32 v191, 18, v191
v_mfma_f32_16x16x32_f16 v[152:155], v[228:231], v[232:235], v[152:155]
ds_read_b128 v[224:227], v250 offset:20480
ds_read_u16_d16_hi v189, v189
ds_read_u16_d16_hi v191, v191
v_exp_f16_sdwa v201, v202 dst_sel:WORD_1 dst_unused:UNUSED_PRESERVE src0_sel:WORD_1
v_and_b32 v193, s49, v193
v_mfma_f32_16x16x32_f16 v[160:163], v[228:231], v[236:239], v[160:163]
v_bfe_u32 v192, v193, 2, 14
s_waitcnt lgkmcnt(7)
v_mfma_f32_16x16x32_f16 v[156:159], v[240:243], v[232:235], v[156:159]
ds_read_b128 v[228:231], v250 offset:20736
ds_read_u16_d16 v192, v192
v_exp_f16_sdwa v198, v199 dst_sel:WORD_1 dst_unused:UNUSED_PRESERVE src0_sel:WORD_1
v_lshrrev_b32_e64 v193, 18, v193
v_mfma_f32_16x16x32_f16 v[164:167], v[240:243], v[236:239], v[164:167]
v_exp_f16_sdwa v195, v196 dst_sel:WORD_1 dst_unused:UNUSED_PRESERVE src0_sel:WORD_1
v_pk_add_f16 v201, v201, 1.0 op_sel_hi:[1,0]
v_mfma_f32_16x16x32_bf16 v[172:175], v[244:247], v[32:35], v[172:175]
ds_read_b128 v[240:243], v248 offset:16384
ds_read_u16_d16_hi v193, v193
v_pk_add_f16 v198, v198, 1.0 op_sel_hi:[1,0]
v_pk_add_f16 v195, v195, 1.0 op_sel_hi:[1,0]
v_mfma_f32_16x16x32_bf16 v[180:183], v[244:247], v[36:39], v[180:183]
v_rcp_f16 v202, v201
s_setprio 0
v_mfma_f32_16x16x32_bf16 v[168:171], v[216:219], v[40:43], v[168:171]
ds_read_b128 v[244:247], v250 offset:21504
v_rcp_f16_e64 v199, v198
v_mfma_f32_16x16x32_bf16 v[176:179], v[216:219], v[44:47], v[176:179]
v_rcp_f16 v196, v195
s_waitcnt lgkmcnt(5)
v_mfma_f32_16x16x32_bf16 v[172:175], v[220:223], v[40:43], v[172:175]
ds_read_b128 v[216:219], v248 offset:16640
v_rcp_f16_sdwa v202, v201 dst_sel:WORD_1 dst_unused:UNUSED_PRESERVE src0_sel:WORD_1
v_mfma_f32_16x16x32_bf16 v[180:183], v[220:223], v[44:47], v[180:183]
v_rcp_f16_sdwa v199, v198 dst_sel:WORD_1 dst_unused:UNUSED_PRESERVE src0_sel:WORD_1
v_or_b32 v232, v184, v185
v_or_b32 v233, v186, v187
v_or_b32_e64 v234, v188, v189
v_rcp_f16_sdwa v196, v195 dst_sel:WORD_1 dst_unused:UNUSED_PRESERVE src0_sel:WORD_1
v_or_b32 v235, v190, v191
s_waitcnt lgkmcnt(2)
v_or_b32 v236, v192, v193
v_pk_mul_f16 v237, v203, v202
v_pk_mul_f16 v238, v200, v199
v_pk_mul_f16 v239, v197, v196
s_setprio 3
v_mfma_f32_16x16x32_f16 v[120:123], v[224:227], v[232:235], v[120:123]
ds_read_b128 v[220:223], v250 offset:21760
v_cvt_pkrtz_f16_f32 v185, v168, v169
v_cvt_pkrtz_f16_f32 v187, v170, v171
v_mfma_f32_16x16x32_f16 v[128:131], v[224:227], v[236:239], v[128:131]
v_cvt_pkrtz_f16_f32 v189, v172, v173
v_cvt_pkrtz_f16_f32 v191, v174, v175
v_mfma_f32_16x16x32_f16 v[124:127], v[228:231], v[232:235], v[124:127]
ds_read_b128 v[224:227], v248 offset:17408
v_cvt_pkrtz_f16_f32 v193, v176, v177
v_cvt_pk_f16_f32 v203, v178, v179
v_cvt_pk_f16_f32 v200, v180, v181
v_mfma_f32_16x16x32_f16 v[132:135], v[228:231], v[236:239], v[132:135]
v_cvt_pk_f16_f32 v197, v182, v183
v_pk_fma_f16 v202, v203, v203, s48
s_waitcnt vmcnt(14)
v_mfma_f32_16x16x32_bf16 v[168:171], v[240:243], v[96:99], 0
ds_read_b128 v[228:231], v250 offset:22528
v_and_b32_e64 v185, s49, v185
v_pk_fma_f16 v199, v200, v200, s48
s_waitcnt vmcnt(13)
v_mfma_f32_16x16x32_bf16 v[176:179], v[240:243], v[100:103], 0
v_and_b32 v187, s49, v187
v_pk_fma_f16 v196, v197, v197, s48
v_bfe_u32 v184, v185, 2, 14
s_waitcnt lgkmcnt(3)
v_mfma_f32_16x16x32_f16 v[136:139], v[244:247], v[232:235], v[136:139]
ds_read_b128 v[240:243], v250 offset:22784
ds_read_u16_d16 v184, v184
v_pk_mul_f16 v202, v203, v202
v_bfe_u32 v186, v187, 2, 14
v_mfma_f32_16x16x32_f16 v[144:147], v[244:247], v[236:239], v[144:147]
v_pk_mul_f16 v199, v200, v199
v_lshrrev_b32_e64 v185, 18, v185
v_mfma_f32_16x16x32_bf16 v[172:175], v[216:219], v[96:99], 0
ds_read_b128 v[244:247], v248 offset:17664
ds_read_u16_d16 v186, v186
ds_read_u16_d16_hi v185, v185
v_pk_mul_f16 v196, v197, v196
v_lshrrev_b32_e64 v187, 18, v187
v_mfma_f32_16x16x32_bf16 v[180:183], v[216:219], v[100:103], 0
v_exp_f16_e64 v201, v202
v_and_b32 v189, s49, v189
s_waitcnt lgkmcnt(5)
v_mfma_f32_16x16x32_f16 v[140:143], v[220:223], v[232:235], v[140:143]
ds_read_b128 v[216:219], v248 offset:18432
ds_read_u16_d16_hi v187, v187
v_and_b32_e64 v191, s49, v191
v_mfma_f32_16x16x32_f16 v[148:151], v[220:223], v[236:239], v[148:151]
v_exp_f16 v198, v199
v_bfe_u32 v188, v189, 2, 14
v_bfe_u32 v190, v191, 2, 14
s_waitcnt vmcnt(12)
v_mfma_f32_16x16x32_bf16 v[168:171], v[224:227], v[104:107], v[168:171]
ds_read_b128 v[220:223], v248 offset:18688
ds_read_u16_d16 v188, v188
ds_read_u16_d16 v190, v190
v_exp_f16 v195, v196
s_waitcnt vmcnt(11)
v_mfma_f32_16x16x32_bf16 v[176:179], v[224:227], v[108:111], v[176:179]
v_lshrrev_b32 v189, 18, v189
v_lshrrev_b32 v191, 18, v191
v_mfma_f32_16x16x32_f16 v[152:155], v[228:231], v[232:235], v[152:155]
ds_read_b128 v[224:227], v250 offset:26624
ds_read_u16_d16_hi v189, v189
ds_read_u16_d16_hi v191, v191
v_exp_f16_sdwa v201, v202 dst_sel:WORD_1 dst_unused:UNUSED_PRESERVE src0_sel:WORD_1
v_and_b32 v193, s49, v193
v_mfma_f32_16x16x32_f16 v[160:163], v[228:231], v[236:239], v[160:163]
v_bfe_u32 v192, v193, 2, 14
s_waitcnt lgkmcnt(7)
v_mfma_f32_16x16x32_f16 v[156:159], v[240:243], v[232:235], v[156:159]
ds_read_b128 v[228:231], v250 offset:26880
ds_read_u16_d16 v192, v192
v_exp_f16_sdwa v198, v199 dst_sel:WORD_1 dst_unused:UNUSED_PRESERVE src0_sel:WORD_1
v_lshrrev_b32_e64 v193, 18, v193
v_mfma_f32_16x16x32_f16 v[164:167], v[240:243], v[236:239], v[164:167]
v_exp_f16_sdwa v195, v196 dst_sel:WORD_1 dst_unused:UNUSED_PRESERVE src0_sel:WORD_1
v_pk_add_f16 v201, v201, 1.0 op_sel_hi:[1,0]
v_mfma_f32_16x16x32_bf16 v[172:175], v[244:247], v[104:107], v[172:175]
ds_read_b128 v[240:243], v248 offset:22528
ds_read_u16_d16_hi v193, v193
v_pk_add_f16 v198, v198, 1.0 op_sel_hi:[1,0]
v_pk_add_f16 v195, v195, 1.0 op_sel_hi:[1,0]
v_mfma_f32_16x16x32_bf16 v[180:183], v[244:247], v[108:111], v[180:183]
v_rcp_f16 v202, v201
s_waitcnt vmcnt(10)
v_mfma_f32_16x16x32_bf16 v[168:171], v[216:219], v[112:115], v[168:171]
ds_read_b128 v[244:247], v250 offset:27648
v_rcp_f16 v199, v198
s_waitcnt vmcnt(7)
v_mfma_f32_16x16x32_bf16 v[176:179], v[216:219], v[116:119], v[176:179]
v_rcp_f16 v196, v195
s_waitcnt lgkmcnt(5)
v_mfma_f32_16x16x32_bf16 v[172:175], v[220:223], v[112:115], v[172:175]
ds_read_b128 v[216:219], v248 offset:22784
v_rcp_f16_sdwa v202, v201 dst_sel:WORD_1 dst_unused:UNUSED_PRESERVE src0_sel:WORD_1
v_mfma_f32_16x16x32_bf16 v[180:183], v[220:223], v[116:119], v[180:183]
v_rcp_f16_sdwa v199, v198 dst_sel:WORD_1 dst_unused:UNUSED_PRESERVE src0_sel:WORD_1
v_or_b32 v232, v184, v185
v_or_b32 v233, v186, v187
v_or_b32_e64 v234, v188, v189
v_rcp_f16_sdwa v196, v195 dst_sel:WORD_1 dst_unused:UNUSED_PRESERVE src0_sel:WORD_1
v_or_b32 v235, v190, v191
s_waitcnt lgkmcnt(2)
v_or_b32_e64 v236, v192, v193
v_pk_mul_f16 v237, v203, v202
v_pk_mul_f16 v238, v200, v199
v_pk_mul_f16 v239, v197, v196
v_mfma_f32_16x16x32_f16 v[120:123], v[224:227], v[232:235], v[120:123]
s_add_u32 s46, s68, 98304
buffer_load_dwordx4 v[44:47], v252, s[4:7], s46 offen offset:64
ds_read_b128 v[220:223], v250 offset:27904
v_cvt_pkrtz_f16_f32 v185, v168, v169
v_cvt_pkrtz_f16_f32 v187, v170, v171
v_mfma_f32_16x16x32_f16 v[128:131], v[224:227], v[236:239], v[128:131]
v_cvt_pkrtz_f16_f32 v189, v172, v173
v_cvt_pkrtz_f16_f32 v191, v174, v175
v_mfma_f32_16x16x32_f16 v[124:127], v[228:231], v[232:235], v[124:127]
ds_read_b128 v[224:227], v248 offset:23552
v_cvt_pkrtz_f16_f32 v193, v176, v177
v_cvt_pk_f16_f32 v203, v178, v179
v_mfma_f32_16x16x32_f16 v[132:135], v[228:231], v[236:239], v[132:135]
v_cvt_pk_f16_f32 v200, v180, v181
v_cvt_pk_f16_f32 v197, v182, v183
v_mfma_f32_16x16x32_bf16 v[168:171], v[240:243], v[96:99], 0
ds_read_b128 v[228:231], v250 offset:28672
v_pk_fma_f16 v202, v203, v203, s48
v_and_b32_e64 v185, s49, v185
v_mfma_f32_16x16x32_bf16 v[176:179], v[240:243], v[100:103], 0
v_pk_fma_f16 v199, v200, v200, s48
v_and_b32 v187, s49, v187
s_waitcnt lgkmcnt(3)
v_mfma_f32_16x16x32_f16 v[136:139], v[244:247], v[232:235], v[136:139]
ds_read_b128 v[240:243], v250 offset:28928
v_pk_fma_f16 v196, v197, v197, s48
s_setprio 2
v_bfe_u32 v184, v185, 2, 14
v_pk_mul_f16 v202, v203, v202
v_mfma_f32_16x16x32_f16 v[144:147], v[244:247], v[236:239], v[144:147]
v_bfe_u32 v186, v187, 2, 14
v_pk_mul_f16 v199, v200, v199
s_waitcnt vmcnt(7)
v_mfma_f32_16x16x32_bf16 v[120:123], v[18:21], v[204:207], v[120:123]
ds_read_b128 v[244:247], v248 offset:23808
ds_read_u16_d16 v184, v184
ds_read_u16_d16 v186, v186
v_lshrrev_b32_e64 v185, 18, v185
v_pk_mul_f16 v196, v197, v196
v_mfma_f32_16x16x32_bf16 v[124:127], v[16:19], v[204:207], v[124:127]
v_lshrrev_b32_e64 v187, 18, v187
v_mfma_f32_16x16x32_bf16 v[172:175], v[216:219], v[96:99], 0
ds_read_u16_d16_hi v185, v185
ds_read_u16_d16_hi v187, v187
v_exp_f16 v201, v202
v_and_b32 v189, s49, v189
v_mfma_f32_16x16x32_bf16 v[180:183], v[216:219], v[100:103], 0
v_and_b32 v191, s49, v191
s_waitcnt lgkmcnt(6)
v_mfma_f32_16x16x32_f16 v[140:143], v[220:223], v[232:235], v[140:143]
ds_read_b128 v[216:219], v248 offset:24576
v_exp_f16_e64 v198, v199
v_bfe_u32 v188, v189, 2, 14
v_mfma_f32_16x16x32_f16 v[148:151], v[220:223], v[236:239], v[148:151]
v_bfe_u32 v190, v191, 2, 14
v_exp_f16_e64 v195, v196
v_mfma_f32_16x16x32_bf16 v[168:171], v[224:227], v[104:107], v[168:171]
s_add_u32 s46, s70, 98304
buffer_store_dwordx4 v[88:91], v255, s[8:11], s46 offen offset:256 sc1
ds_read_b128 v[220:223], v248 offset:24832
ds_read_u16_d16 v188, v188
ds_read_u16_d16 v190, v190
v_lshrrev_b32 v189, 18, v189
v_lshrrev_b32 v191, 18, v191
v_mfma_f32_16x16x32_bf16 v[176:179], v[224:227], v[108:111], v[176:179]
v_exp_f16_sdwa v201, v202 dst_sel:WORD_1 dst_unused:UNUSED_PRESERVE src0_sel:WORD_1
v_mfma_f32_16x16x32_f16 v[152:155], v[228:231], v[232:235], v[152:155]
ds_read_b128 v[224:227], v249 offset:24576
ds_read_u16_d16_hi v189, v189
ds_read_u16_d16_hi v191, v191
v_and_b32 v193, s49, v193
v_bfe_u32 v192, v193, 2, 14
v_mfma_f32_16x16x32_f16 v[160:163], v[228:231], v[236:239], v[160:163]
v_exp_f16_sdwa v198, v199 dst_sel:WORD_1 dst_unused:UNUSED_PRESERVE src0_sel:WORD_1
s_waitcnt lgkmcnt(7)
v_mfma_f32_16x16x32_f16 v[156:159], v[240:243], v[232:235], v[156:159]
ds_read_b128 v[228:231], v254 offset:7936
ds_read_u16_d16 v192, v192
v_lshrrev_b32_e64 v193, 18, v193
v_mfma_f32_16x16x32_f16 v[164:167], v[240:243], v[236:239], v[164:167]
v_exp_f16_sdwa v195, v196 dst_sel:WORD_1 dst_unused:UNUSED_PRESERVE src0_sel:WORD_1
v_pk_add_f16 v201, v201, 1.0 op_sel_hi:[1,0]
v_pk_add_f16 v198, v198, 1.0 op_sel_hi:[1,0]
v_mfma_f32_16x16x32_bf16 v[172:175], v[244:247], v[104:107], v[172:175]
ds_read_b128 v[240:243], v249 offset:24832
ds_read_u16_d16_hi v193, v193
v_pk_add_f16 v195, v195, 1.0 op_sel_hi:[1,0]
v_mfma_f32_16x16x32_bf16 v[180:183], v[244:247], v[108:111], v[180:183]
v_rcp_f16 v202, v201
s_waitcnt lgkmcnt(7)
v_mfma_f32_16x16x32_bf16 v[168:171], v[216:219], v[112:115], v[168:171]
ds_read_b128 v[244:247], v254 offset:7952
v_rcp_f16_e64 v199, v198
v_mfma_f32_16x16x32_bf16 v[176:179], v[216:219], v[116:119], v[176:179]
v_rcp_f16_e64 v196, v195
v_mfma_f32_16x16x32_bf16 v[172:175], v[220:223], v[112:115], v[172:175]
ds_read_b128 v[216:219], v248 offset:28672
v_rcp_f16_sdwa v202, v201 dst_sel:WORD_1 dst_unused:UNUSED_PRESERVE src0_sel:WORD_1
v_mfma_f32_16x16x32_bf16 v[180:183], v[220:223], v[116:119], v[180:183]
v_rcp_f16_sdwa v199, v198 dst_sel:WORD_1 dst_unused:UNUSED_PRESERVE src0_sel:WORD_1
v_or_b32 v232, v184, v185
v_or_b32 v233, v186, v187
s_waitcnt lgkmcnt(4)
v_or_b32 v234, v188, v189
v_rcp_f16_sdwa v196, v195 dst_sel:WORD_1 dst_unused:UNUSED_PRESERVE src0_sel:WORD_1
v_or_b32 v235, v190, v191
s_waitcnt lgkmcnt(2)
v_or_b32 v236, v192, v193
v_pk_mul_f16 v237, v203, v202
v_pk_mul_f16 v238, v200, v199
v_pk_mul_f16 v239, v197, v196
v_mfma_f32_16x16x32_f16 v[48:51], v[224:227], v[232:235], v[228:231]
ds_read_b128 v[220:223], v249 offset:25600
v_cvt_pkrtz_f16_f32 v185, v168, v169
v_cvt_pkrtz_f16_f32 v187, v170, v171
v_mfma_f32_16x16x32_f16 v[56:59], v[224:227], v[236:239], v[228:231]
v_cvt_pkrtz_f16_f32 v189, v172, v173
v_cvt_pkrtz_f16_f32 v191, v174, v175
s_waitcnt lgkmcnt(2)
v_mfma_f32_16x16x32_f16 v[52:55], v[240:243], v[232:235], v[244:247]
ds_read_b128 v[224:227], v254 offset:8064
ds_read_b128 v[228:231], v248 offset:28928
v_cvt_pkrtz_f16_f32 v193, v176, v177
v_cvt_pk_f16_f32 v203, v178, v179
v_mfma_f32_16x16x32_f16 v[60:63], v[240:243], v[236:239], v[244:247]
v_cvt_pk_f16_f32 v200, v180, v181
v_cvt_pk_f16_f32 v197, v182, v183
s_setprio 1
s_waitcnt lgkmcnt(3)
v_mfma_f32_16x16x32_bf16 v[168:171], v[216:219], v[96:99], 0
ds_read_b128 v[240:243], v249 offset:25856
ds_read_b128 v[244:247], v254 offset:8080
v_pk_fma_f16 v202, v203, v203, s48
v_and_b32_e64 v185, s49, v185
v_mfma_f32_16x16x32_bf16 v[176:179], v[216:219], v[100:103], 0
v_pk_fma_f16 v199, v200, v200, s48
v_and_b32 v187, s49, v187
s_waitcnt lgkmcnt(3)
v_mfma_f32_16x16x32_f16 v[64:67], v[220:223], v[232:235], v[224:227]
ds_read_b128 v[216:219], v248 offset:29696
v_pk_fma_f16 v196, v197, v197, s48
v_bfe_u32 v184, v185, 2, 14
v_pk_mul_f16 v202, v203, v202
v_mfma_f32_16x16x32_f16 v[72:75], v[220:223], v[236:239], v[224:227]
v_bfe_u32 v186, v187, 2, 14
v_pk_mul_f16 v199, v200, v199
s_waitcnt vmcnt(6)
v_mfma_f32_16x16x32_bf16 v[136:139], v[18:21], v[208:211], v[136:139]
ds_read_b128 v[220:223], v249 offset:26624
ds_read_b128 v[224:227], v254 offset:16128
ds_read_u16_d16 v184, v184
ds_read_u16_d16 v186, v186
v_lshrrev_b32 v185, 18, v185
v_pk_mul_f16 v196, v197, v196
v_mfma_f32_16x16x32_bf16 v[140:143], v[16:19], v[208:211], v[140:143]
v_lshrrev_b32 v187, 18, v187
s_waitcnt lgkmcnt(5)
v_mfma_f32_16x16x32_bf16 v[172:175], v[228:231], v[96:99], 0
ds_read_u16_d16_hi v185, v185
ds_read_u16_d16_hi v187, v187
v_exp_f16 v201, v202
v_and_b32 v189, s49, v189
v_mfma_f32_16x16x32_bf16 v[180:183], v[228:231], v[100:103], 0
v_and_b32_e64 v191, s49, v191
v_mfma_f32_16x16x32_f16 v[68:71], v[240:243], v[232:235], v[244:247]
ds_read_b128 v[228:231], v249 offset:26880
v_exp_f16_e64 v198, v199
v_bfe_u32 v188, v189, 2, 14
v_mfma_f32_16x16x32_f16 v[76:79], v[240:243], v[236:239], v[244:247]
v_bfe_u32 v190, v191, 2, 14
v_exp_f16 v195, v196
s_waitcnt lgkmcnt(7)
v_mfma_f32_16x16x32_bf16 v[168:171], v[216:219], v[104:107], v[168:171]
ds_read_b128 v[240:243], v254 offset:16144
ds_read_b128 v[244:247], v248 offset:29952
ds_read_u16_d16 v188, v188
ds_read_u16_d16 v190, v190
v_lshrrev_b32_e64 v189, 18, v189
v_lshrrev_b32 v191, 18, v191
v_mfma_f32_16x16x32_bf16 v[176:179], v[216:219], v[108:111], v[176:179]
v_exp_f16_sdwa v201, v202 dst_sel:WORD_1 dst_unused:UNUSED_PRESERVE src0_sel:WORD_1
s_waitcnt lgkmcnt(7)
v_mfma_f32_16x16x32_f16 v[80:83], v[220:223], v[232:235], v[224:227]
ds_read_b128 v[216:219], v248 offset:30720
ds_read_u16_d16_hi v189, v189
ds_read_u16_d16_hi v191, v191
v_and_b32 v193, s49, v193
v_bfe_u32 v192, v193, 2, 14
v_mfma_f32_16x16x32_f16 v[88:91], v[220:223], v[236:239], v[224:227]
v_exp_f16_sdwa v198, v199 dst_sel:WORD_1 dst_unused:UNUSED_PRESERVE src0_sel:WORD_1
s_waitcnt lgkmcnt(6)
v_mfma_f32_16x16x32_f16 v[84:87], v[228:231], v[232:235], v[240:243]
ds_read_b128 v[220:223], v248 offset:30976
ds_read_b128 v[224:227], v249 offset:30720
ds_read_u16_d16 v192, v192
v_lshrrev_b32 v193, 18, v193
v_mfma_f32_16x16x32_f16 v[92:95], v[228:231], v[236:239], v[240:243]
v_exp_f16_sdwa v195, v196 dst_sel:WORD_1 dst_unused:UNUSED_PRESERVE src0_sel:WORD_1
v_pk_add_f16 v201, v201, 1.0 op_sel_hi:[1,0]
v_pk_add_f16 v198, v198, 1.0 op_sel_hi:[1,0]
s_waitcnt lgkmcnt(7)
v_mfma_f32_16x16x32_bf16 v[172:175], v[244:247], v[104:107], v[172:175]
ds_read_b128 v[228:231], v249 offset:30976
ds_read_b128 v[240:243], v248 offset:34816
ds_read_u16_d16_hi v193, v193
v_pk_add_f16 v195, v195, 1.0 op_sel_hi:[1,0]
v_mfma_f32_16x16x32_bf16 v[180:183], v[244:247], v[108:111], v[180:183]
v_rcp_f16_e64 v202, v201
s_setprio 0
s_waitcnt lgkmcnt(7)
v_mfma_f32_16x16x32_bf16 v[168:171], v[216:219], v[112:115], v[168:171]
ds_read_b128 v[244:247], v249 offset:31744
v_rcp_f16_e64 v199, v198
v_mfma_f32_16x16x32_bf16 v[176:179], v[216:219], v[116:119], v[176:179]
v_rcp_f16 v196, v195
s_waitcnt lgkmcnt(6)
v_mfma_f32_16x16x32_bf16 v[172:175], v[220:223], v[112:115], v[172:175]
ds_read_b128 v[216:219], v248 offset:35072
v_rcp_f16_sdwa v202, v201 dst_sel:WORD_1 dst_unused:UNUSED_PRESERVE src0_sel:WORD_1
v_mfma_f32_16x16x32_bf16 v[180:183], v[220:223], v[116:119], v[180:183]
v_rcp_f16_sdwa v199, v198 dst_sel:WORD_1 dst_unused:UNUSED_PRESERVE src0_sel:WORD_1
v_or_b32 v232, v184, v185
v_or_b32 v233, v186, v187
v_or_b32_e64 v234, v188, v189
v_rcp_f16_sdwa v196, v195 dst_sel:WORD_1 dst_unused:UNUSED_PRESERVE src0_sel:WORD_1
v_or_b32 v235, v190, v191
s_waitcnt lgkmcnt(2)
v_or_b32 v236, v192, v193
v_pk_mul_f16 v237, v203, v202
v_pk_mul_f16 v238, v200, v199
v_pk_mul_f16 v239, v197, v196
s_setprio 3
v_mfma_f32_16x16x32_f16 v[48:51], v[224:227], v[232:235], v[48:51]
s_add_u32 s46, s68, 98304
buffer_load_dwordx4 v[208:211], v252, s[4:7], s46 offen offset:128
ds_read_b128 v[220:223], v249 offset:32000
v_cvt_pkrtz_f16_f32 v185, v168, v169
v_cvt_pkrtz_f16_f32 v187, v170, v171
v_mfma_f32_16x16x32_f16 v[56:59], v[224:227], v[236:239], v[56:59]
v_cvt_pkrtz_f16_f32 v189, v172, v173
v_cvt_pkrtz_f16_f32 v191, v174, v175
v_mfma_f32_16x16x32_f16 v[52:55], v[228:231], v[232:235], v[52:55]
ds_read_b128 v[224:227], v248 offset:35840
v_cvt_pkrtz_f16_f32 v193, v176, v177
v_cvt_pk_f16_f32 v203, v178, v179
v_mfma_f32_16x16x32_f16 v[60:63], v[228:231], v[236:239], v[60:63]
v_cvt_pk_f16_f32 v200, v180, v181
v_cvt_pk_f16_f32 v197, v182, v183
v_mfma_f32_16x16x32_bf16 v[168:171], v[240:243], v[96:99], 0
ds_read_b128 v[228:231], v249 offset:32768
v_pk_fma_f16 v202, v203, v203, s48
v_and_b32_e64 v185, s49, v185
v_mfma_f32_16x16x32_bf16 v[176:179], v[240:243], v[100:103], 0
v_pk_fma_f16 v199, v200, v200, s48
v_and_b32 v187, s49, v187
s_waitcnt lgkmcnt(3)
v_mfma_f32_16x16x32_f16 v[64:67], v[244:247], v[232:235], v[64:67]
ds_read_b128 v[240:243], v249 offset:33024
v_pk_fma_f16 v196, v197, v197, s48
v_bfe_u32 v184, v185, 2, 14
v_pk_mul_f16 v202, v203, v202
v_mfma_f32_16x16x32_f16 v[72:75], v[244:247], v[236:239], v[72:75]
v_bfe_u32 v186, v187, 2, 14
v_pk_mul_f16 v199, v200, v199
s_waitcnt vmcnt(5)
v_mfma_f32_16x16x32_bf16 v[152:155], v[18:21], v[12:15], v[152:155]
ds_read_b128 v[244:247], v248 offset:36096
ds_read_u16_d16 v184, v184
ds_read_u16_d16 v186, v186
v_lshrrev_b32 v185, 18, v185
v_pk_mul_f16 v196, v197, v196
v_mfma_f32_16x16x32_bf16 v[156:159], v[16:19], v[12:15], v[156:159]
v_lshrrev_b32_e64 v187, 18, v187
v_mfma_f32_16x16x32_bf16 v[172:175], v[216:219], v[96:99], 0
ds_read_u16_d16_hi v185, v185
ds_read_u16_d16_hi v187, v187
v_exp_f16 v201, v202
v_and_b32 v189, s49, v189
v_mfma_f32_16x16x32_bf16 v[180:183], v[216:219], v[100:103], 0
v_and_b32 v191, s49, v191
s_waitcnt lgkmcnt(6)
v_mfma_f32_16x16x32_f16 v[68:71], v[220:223], v[232:235], v[68:71]
ds_read_b128 v[216:219], v248 offset:36864
v_exp_f16_e64 v198, v199
v_bfe_u32 v188, v189, 2, 14
v_mfma_f32_16x16x32_f16 v[76:79], v[220:223], v[236:239], v[76:79]
v_bfe_u32 v190, v191, 2, 14
v_exp_f16_e64 v195, v196
v_mfma_f32_16x16x32_bf16 v[168:171], v[224:227], v[104:107], v[168:171]
ds_read_b128 v[220:223], v248 offset:37120
ds_read_u16_d16 v188, v188
ds_read_u16_d16 v190, v190
v_lshrrev_b32 v189, 18, v189
v_lshrrev_b32 v191, 18, v191
v_mfma_f32_16x16x32_bf16 v[176:179], v[224:227], v[108:111], v[176:179]
v_exp_f16_sdwa v201, v202 dst_sel:WORD_1 dst_unused:UNUSED_PRESERVE src0_sel:WORD_1
v_mfma_f32_16x16x32_f16 v[80:83], v[228:231], v[232:235], v[80:83]
ds_read_b128 v[224:227], v249 offset:36864
ds_read_u16_d16_hi v189, v189
ds_read_u16_d16_hi v191, v191
v_and_b32 v193, s49, v193
v_bfe_u32 v192, v193, 2, 14
v_mfma_f32_16x16x32_f16 v[88:91], v[228:231], v[236:239], v[88:91]
v_exp_f16_sdwa v198, v199 dst_sel:WORD_1 dst_unused:UNUSED_PRESERVE src0_sel:WORD_1
s_waitcnt lgkmcnt(7)
v_mfma_f32_16x16x32_f16 v[84:87], v[240:243], v[232:235], v[84:87]
ds_read_b128 v[228:231], v249 offset:37120
ds_read_u16_d16 v192, v192
v_lshrrev_b32_e64 v193, 18, v193
v_mfma_f32_16x16x32_f16 v[92:95], v[240:243], v[236:239], v[92:95]
v_exp_f16_sdwa v195, v196 dst_sel:WORD_1 dst_unused:UNUSED_PRESERVE src0_sel:WORD_1
v_pk_add_f16 v201, v201, 1.0 op_sel_hi:[1,0]
v_pk_add_f16 v198, v198, 1.0 op_sel_hi:[1,0]
v_mfma_f32_16x16x32_bf16 v[172:175], v[244:247], v[104:107], v[172:175]
ds_read_b128 v[240:243], v248 offset:40960
ds_read_u16_d16_hi v193, v193
v_pk_add_f16 v195, v195, 1.0 op_sel_hi:[1,0]
v_mfma_f32_16x16x32_bf16 v[180:183], v[244:247], v[108:111], v[180:183]
v_rcp_f16 v202, v201
s_waitcnt lgkmcnt(7)
v_mfma_f32_16x16x32_bf16 v[168:171], v[216:219], v[112:115], v[168:171]
ds_read_b128 v[244:247], v249 offset:37888
v_rcp_f16_e64 v199, v198
v_mfma_f32_16x16x32_bf16 v[176:179], v[216:219], v[116:119], v[176:179]
v_rcp_f16_e64 v196, v195
v_mfma_f32_16x16x32_bf16 v[172:175], v[220:223], v[112:115], v[172:175]
ds_read_b128 v[216:219], v248 offset:41216
v_rcp_f16_sdwa v202, v201 dst_sel:WORD_1 dst_unused:UNUSED_PRESERVE src0_sel:WORD_1
v_mfma_f32_16x16x32_bf16 v[180:183], v[220:223], v[116:119], v[180:183]
v_rcp_f16_sdwa v199, v198 dst_sel:WORD_1 dst_unused:UNUSED_PRESERVE src0_sel:WORD_1
v_or_b32 v232, v184, v185
v_or_b32 v233, v186, v187
s_waitcnt lgkmcnt(4)
v_or_b32 v234, v188, v189
v_rcp_f16_sdwa v196, v195 dst_sel:WORD_1 dst_unused:UNUSED_PRESERVE src0_sel:WORD_1
v_or_b32 v235, v190, v191
s_waitcnt lgkmcnt(2)
v_or_b32_e64 v236, v192, v193
v_pk_mul_f16 v237, v203, v202
v_pk_mul_f16 v238, v200, v199
v_pk_mul_f16 v239, v197, v196
v_mfma_f32_16x16x32_f16 v[48:51], v[224:227], v[232:235], v[48:51]
buffer_load_dwordx4 v[12:15], v252, s[4:7], s69 offen
ds_read_b128 v[220:223], v249 offset:38144
v_cvt_pkrtz_f16_f32 v185, v168, v169
v_cvt_pkrtz_f16_f32 v187, v170, v171
v_cvt_pkrtz_f16_f32 v189, v172, v173
v_mfma_f32_16x16x32_f16 v[56:59], v[224:227], v[236:239], v[56:59]
v_cvt_pkrtz_f16_f32 v191, v174, v175
v_cvt_pkrtz_f16_f32 v193, v176, v177
v_cvt_pkrtz_f16_f32 v195, v178, v179
v_mfma_f32_16x16x32_f16 v[52:55], v[228:231], v[232:235], v[52:55]
ds_read_b128 v[224:227], v248 offset:41984
v_cvt_pk_f16_f32 v203, v180, v181
v_cvt_pk_f16_f32 v200, v182, v183
v_pk_fma_f16 v202, v203, v203, s48
v_mfma_f32_16x16x32_f16 v[60:63], v[228:231], v[236:239], v[60:63]
v_cvt_pk_bf16_f32 v136, v136, v137
v_and_b32_e64 v185, s49, v185
v_cvt_pk_bf16_f32 v137, v138, v139
v_mfma_f32_16x16x32_bf16 v[168:171], v[240:243], v[96:99], 0
ds_read_b128 v[228:231], v249 offset:38912
v_and_b32_e64 v187, s49, v187
v_cvt_pk_bf16_f32 v138, v140, v141
v_pk_fma_f16 v199, v200, v200, s48
v_mfma_f32_16x16x32_bf16 v[176:179], v[240:243], v[100:103], 0
v_bfe_u32 v184, v185, 2, 14
s_setprio 2
v_cvt_pk_bf16_f32 v139, v142, v143
v_pk_mul_f16 v202, v203, v202
s_waitcnt lgkmcnt(2)
v_mfma_f32_16x16x32_f16 v[64:67], v[244:247], v[232:235], v[64:67]
ds_read_b128 v[240:243], v249 offset:39168
ds_read_u16_d16 v184, v184
v_cvt_pk_bf16_f32 v120, v120, v121
v_bfe_u32 v186, v187, 2, 14
v_cvt_pk_bf16_f32 v121, v122, v123
v_mfma_f32_16x16x32_f16 v[72:75], v[244:247], v[236:239], v[72:75]
v_pk_mul_f16 v199, v200, v199
v_lshrrev_b32_e64 v185, 18, v185
v_cvt_pk_bf16_f32 v122, v124, v125
v_mfma_f32_16x16x32_bf16 v[172:175], v[216:219], v[96:99], 0
ds_read_b128 v[244:247], v248 offset:42240
ds_read_u16_d16 v186, v186
ds_read_u16_d16_hi v185, v185
v_exp_f16_e64 v201, v202
v_cvt_pk_bf16_f32 v123, v126, v127
v_mfma_f32_16x16x32_bf16 v[180:183], v[216:219], v[100:103], 0
v_lshrrev_b32_e64 v187, 18, v187
v_cvt_pk_bf16_f32 v152, v152, v153
v_and_b32_e64 v189, s49, v189
v_mfma_f32_16x16x32_f16 v[68:71], v[220:223], v[232:235], v[68:71]
ds_read_b128 v[216:219], v248 offset:43008
ds_read_u16_d16_hi v187, v187
v_cvt_pk_bf16_f32 v153, v154, v155
v_exp_f16_e64 v198, v199
v_mfma_f32_16x16x32_f16 v[76:79], v[220:223], v[236:239], v[76:79]
v_cvt_pk_bf16_f32 v154, v156, v157
v_and_b32_e64 v191, s49, v191
v_cvt_pk_bf16_f32 v155, v158, v159
s_mov_b64 vcc, s[74:75]
s_waitcnt lgkmcnt(5)
v_mfma_f32_16x16x32_bf16 v[168:171], v[224:227], v[104:107], v[168:171]
ds_read_b128 v[220:223], v248 offset:43264
v_bfe_u32 v188, v189, 2, 14
v_cndmask_b32 v140, v120, v152, vcc
v_mfma_f32_16x16x32_bf16 v[176:179], v[224:227], v[108:111], v[176:179]
v_exp_f16_sdwa v201, v202 dst_sel:WORD_1 dst_unused:UNUSED_PRESERVE src0_sel:WORD_1
v_cndmask_b32 v141, v121, v153, vcc
v_bfe_u32 v190, v191, 2, 14
v_mfma_f32_16x16x32_f16 v[80:83], v[228:231], v[232:235], v[80:83]
ds_read_b128 v[224:227], v249 offset:43008
ds_read_u16_d16 v188, v188
ds_read_u16_d16 v190, v190
v_cndmask_b32 v142, v122, v154, vcc
v_lshrrev_b32 v189, 18, v189
v_cndmask_b32 v143, v123, v155, vcc
v_mfma_f32_16x16x32_f16 v[88:91], v[228:231], v[236:239], v[88:91]
v_lshrrev_b32 v191, 18, v191
v_exp_f16_sdwa v198, v199 dst_sel:WORD_1 dst_unused:UNUSED_PRESERVE src0_sel:WORD_1
v_mfma_f32_16x16x32_f16 v[84:87], v[240:243], v[232:235], v[84:87]
ds_read_b128 v[228:231], v249 offset:43264
ds_read_u16_d16_hi v189, v189
ds_read_u16_d16_hi v191, v191
v_cndmask_b32_dpp v120, v136, v120, vcc quad_perm:[1,0,3,2] row_mask:0xf bank_mask:0xf
v_cndmask_b32_dpp v121, v137, v121, vcc quad_perm:[1,0,3,2] row_mask:0xf bank_mask:0xf
v_and_b32_e64 v193, s49, v193
v_mfma_f32_16x16x32_f16 v[92:95], v[240:243], v[236:239], v[92:95]
v_cndmask_b32_dpp v122, v138, v122, vcc quad_perm:[1,0,3,2] row_mask:0xf bank_mask:0xf
v_and_b32_e64 v195, s49, v195
v_pk_add_f16 v201, v201, 1.0 op_sel_hi:[1,0]
s_waitcnt lgkmcnt(6)
v_mfma_f32_16x16x32_bf16 v[172:175], v[244:247], v[104:107], v[172:175]
ds_read_b128 v[240:243], v248 offset:47104
v_cndmask_b32_dpp v123, v139, v123, vcc quad_perm:[1,0,3,2] row_mask:0xf bank_mask:0xf
s_not_b64 vcc, s[74:75]
v_bfe_u32 v192, v193, 2, 14
v_cndmask_b32_dpp v152, v136, v152, vcc quad_perm:[1,0,3,2] row_mask:0xf bank_mask:0xf
v_mfma_f32_16x16x32_bf16 v[180:183], v[244:247], v[108:111], v[180:183]
v_pk_add_f16 v198, v198, 1.0 op_sel_hi:[1,0]
v_cndmask_b32_dpp v153, v137, v153, vcc quad_perm:[1,0,3,2] row_mask:0xf bank_mask:0xf
v_bfe_u32 v194, v195, 2, 14
v_mfma_f32_16x16x32_bf16 v[168:171], v[216:219], v[112:115], v[168:171]
ds_read_b128 v[244:247], v249 offset:44032
ds_read_u16_d16 v192, v192
ds_read_u16_d16 v194, v194
v_rcp_f16_e64 v202, v201
v_cndmask_b32_dpp v154, v138, v154, vcc quad_perm:[1,0,3,2] row_mask:0xf bank_mask:0xf
v_mfma_f32_16x16x32_bf16 v[176:179], v[216:219], v[116:119], v[176:179]
v_cndmask_b32_dpp v155, v139, v155, vcc quad_perm:[1,0,3,2] row_mask:0xf bank_mask:0xf
v_lshrrev_b32 v193, 18, v193
v_lshrrev_b32 v195, 18, v195
v_mfma_f32_16x16x32_bf16 v[172:175], v[220:223], v[112:115], v[172:175]
ds_read_b128 v[216:219], v248 offset:47360
buffer_store_dwordx4 v[120:123], v255, s[8:11], s68 offen sc1
ds_read_u16_d16_hi v193, v193
ds_read_u16_d16_hi v195, v195
v_rcp_f16_e64 v199, v198
v_mfma_f32_16x16x32_bf16 v[180:183], v[220:223], v[116:119], v[180:183]
v_rcp_f16_sdwa v202, v201 dst_sel:WORD_1 dst_unused:UNUSED_PRESERVE src0_sel:WORD_1
v_or_b32 v232, v184, v185
v_or_b32 v233, v186, v187
s_waitcnt lgkmcnt(6)
v_or_b32 v234, v188, v189
v_rcp_f16_sdwa v199, v198 dst_sel:WORD_1 dst_unused:UNUSED_PRESERVE src0_sel:WORD_1
v_or_b32 v235, v190, v191
s_waitcnt lgkmcnt(1)
v_or_b32 v236, v192, v193
s_waitcnt lgkmcnt(0)
v_or_b32_e64 v237, v194, v195
v_pk_mul_f16 v238, v203, v202
v_pk_mul_f16 v239, v200, v199
v_mfma_f32_16x16x32_f16 v[48:51], v[224:227], v[232:235], v[48:51]
buffer_load_dwordx4 v[204:207], v252, s[4:7], s69 offen offset:64
ds_read_b128 v[220:223], v249 offset:44288
v_cvt_pkrtz_f16_f32 v185, v168, v169
v_cvt_pkrtz_f16_f32 v187, v170, v171
v_mfma_f32_16x16x32_f16 v[56:59], v[224:227], v[236:239], v[56:59]
v_cvt_pkrtz_f16_f32 v189, v172, v173
v_cvt_pkrtz_f16_f32 v191, v174, v175
v_mfma_f32_16x16x32_f16 v[52:55], v[228:231], v[232:235], v[52:55]
ds_read_b128 v[224:227], v248 offset:48128
v_cvt_pkrtz_f16_f32 v193, v176, v177
v_cvt_pk_f16_f32 v203, v178, v179
v_mfma_f32_16x16x32_f16 v[60:63], v[228:231], v[236:239], v[60:63]
v_cvt_pk_f16_f32 v200, v180, v181
v_cvt_pk_f16_f32 v197, v182, v183
s_setprio 1
v_mfma_f32_16x16x32_bf16 v[168:171], v[240:243], v[96:99], 0
ds_read_b128 v[228:231], v249 offset:45056
v_pk_fma_f16 v202, v203, v203, s48
v_and_b32 v185, s49, v185
v_mfma_f32_16x16x32_bf16 v[176:179], v[240:243], v[100:103], 0
v_pk_fma_f16 v199, v200, v200, s48
v_and_b32_e64 v187, s49, v187
v_mfma_f32_16x16x32_f16 v[64:67], v[244:247], v[232:235], v[64:67]
ds_read_b128 v[240:243], v249 offset:45312
v_pk_fma_f16 v196, v197, v197, s48
v_bfe_u32 v184, v185, 2, 14
v_pk_mul_f16 v202, v203, v202
v_mfma_f32_16x16x32_f16 v[72:75], v[244:247], v[236:239], v[72:75]
v_bfe_u32 v186, v187, 2, 14
v_pk_mul_f16 v199, v200, v199
s_waitcnt vmcnt(7)
v_mfma_f32_16x16x32_bf16 v[128:131], v[18:21], v[8:11], v[128:131]
ds_read_b128 v[244:247], v248 offset:48384
ds_read_u16_d16 v184, v184
ds_read_u16_d16 v186, v186
v_lshrrev_b32 v185, 18, v185
v_pk_mul_f16 v196, v197, v196
v_mfma_f32_16x16x32_bf16 v[132:135], v[16:19], v[8:11], v[132:135]
v_lshrrev_b32_e64 v187, 18, v187
v_mfma_f32_16x16x32_bf16 v[172:175], v[216:219], v[96:99], 0
ds_read_u16_d16_hi v185, v185
ds_read_u16_d16_hi v187, v187
v_exp_f16 v201, v202
v_and_b32 v189, s49, v189
v_mfma_f32_16x16x32_bf16 v[180:183], v[216:219], v[100:103], 0
v_and_b32 v191, s49, v191
s_waitcnt lgkmcnt(6)
v_mfma_f32_16x16x32_f16 v[68:71], v[220:223], v[232:235], v[68:71]
ds_read_b128 v[216:219], v248 offset:49152
v_exp_f16_e64 v198, v199
v_bfe_u32 v188, v189, 2, 14
v_mfma_f32_16x16x32_f16 v[76:79], v[220:223], v[236:239], v[76:79]
v_bfe_u32 v190, v191, 2, 14
v_exp_f16_e64 v195, v196
v_mfma_f32_16x16x32_bf16 v[168:171], v[224:227], v[104:107], v[168:171]
buffer_store_dwordx4 v[140:143], v255, s[8:11], s68 offen offset:128 sc1
ds_read_b128 v[220:223], v248 offset:49408
ds_read_u16_d16 v188, v188
ds_read_u16_d16 v190, v190
v_lshrrev_b32 v189, 18, v189
v_lshrrev_b32 v191, 18, v191
v_mfma_f32_16x16x32_bf16 v[176:179], v[224:227], v[108:111], v[176:179]
v_exp_f16_sdwa v201, v202 dst_sel:WORD_1 dst_unused:UNUSED_PRESERVE src0_sel:WORD_1
v_mfma_f32_16x16x32_f16 v[80:83], v[228:231], v[232:235], v[80:83]
ds_read_b128 v[224:227], v249 offset:49152
ds_read_u16_d16_hi v189, v189
ds_read_u16_d16_hi v191, v191
v_and_b32 v193, s49, v193
v_bfe_u32 v192, v193, 2, 14
v_mfma_f32_16x16x32_f16 v[88:91], v[228:231], v[236:239], v[88:91]
v_exp_f16_sdwa v198, v199 dst_sel:WORD_1 dst_unused:UNUSED_PRESERVE src0_sel:WORD_1
s_waitcnt lgkmcnt(7)
v_mfma_f32_16x16x32_f16 v[84:87], v[240:243], v[232:235], v[84:87]
ds_read_b128 v[228:231], v249 offset:49408
ds_read_u16_d16 v192, v192
v_lshrrev_b32_e64 v193, 18, v193
v_mfma_f32_16x16x32_f16 v[92:95], v[240:243], v[236:239], v[92:95]
v_exp_f16_sdwa v195, v196 dst_sel:WORD_1 dst_unused:UNUSED_PRESERVE src0_sel:WORD_1
v_pk_add_f16 v201, v201, 1.0 op_sel_hi:[1,0]
v_pk_add_f16 v198, v198, 1.0 op_sel_hi:[1,0]
v_mfma_f32_16x16x32_bf16 v[172:175], v[244:247], v[104:107], v[172:175]
ds_read_b128 v[240:243], v248 offset:53248
ds_read_u16_d16_hi v193, v193
v_pk_add_f16 v195, v195, 1.0 op_sel_hi:[1,0]
v_mfma_f32_16x16x32_bf16 v[180:183], v[244:247], v[108:111], v[180:183]
v_rcp_f16_e64 v202, v201
s_setprio 0
s_waitcnt lgkmcnt(7)
v_mfma_f32_16x16x32_bf16 v[168:171], v[216:219], v[112:115], v[168:171]
ds_read_b128 v[244:247], v249 offset:50176
v_rcp_f16_e64 v199, v198
v_mfma_f32_16x16x32_bf16 v[176:179], v[216:219], v[116:119], v[176:179]
v_rcp_f16_e64 v196, v195
v_mfma_f32_16x16x32_bf16 v[172:175], v[220:223], v[112:115], v[172:175]
ds_read_b128 v[216:219], v248 offset:53504
v_rcp_f16_sdwa v202, v201 dst_sel:WORD_1 dst_unused:UNUSED_PRESERVE src0_sel:WORD_1
v_mfma_f32_16x16x32_bf16 v[180:183], v[220:223], v[116:119], v[180:183]
v_rcp_f16_sdwa v199, v198 dst_sel:WORD_1 dst_unused:UNUSED_PRESERVE src0_sel:WORD_1
v_or_b32 v232, v184, v185
v_or_b32 v233, v186, v187
s_waitcnt lgkmcnt(4)
v_or_b32 v234, v188, v189
v_rcp_f16_sdwa v196, v195 dst_sel:WORD_1 dst_unused:UNUSED_PRESERVE src0_sel:WORD_1
v_or_b32 v235, v190, v191
s_waitcnt lgkmcnt(2)
v_or_b32 v236, v192, v193
v_pk_mul_f16 v237, v203, v202
v_pk_mul_f16 v238, v200, v199
v_pk_mul_f16 v239, v197, v196
s_setprio 3
v_mfma_f32_16x16x32_f16 v[48:51], v[224:227], v[232:235], v[48:51]
buffer_load_dwordx4 v[8:11], v252, s[4:7], s69 offen offset:128
ds_read_b128 v[220:223], v249 offset:50432
v_cvt_pkrtz_f16_f32 v185, v168, v169
v_cvt_pkrtz_f16_f32 v187, v170, v171
v_mfma_f32_16x16x32_f16 v[56:59], v[224:227], v[236:239], v[56:59]
v_cvt_pkrtz_f16_f32 v189, v172, v173
v_cvt_pkrtz_f16_f32 v191, v174, v175
v_mfma_f32_16x16x32_f16 v[52:55], v[228:231], v[232:235], v[52:55]
ds_read_b128 v[224:227], v248 offset:54272
v_cvt_pkrtz_f16_f32 v193, v176, v177
v_cvt_pk_f16_f32 v203, v178, v179
v_mfma_f32_16x16x32_f16 v[60:63], v[228:231], v[236:239], v[60:63]
v_cvt_pk_f16_f32 v200, v180, v181
v_cvt_pk_f16_f32 v197, v182, v183
v_mfma_f32_16x16x32_bf16 v[168:171], v[240:243], v[96:99], 0
ds_read_b128 v[228:231], v249 offset:51200
v_pk_fma_f16 v202, v203, v203, s48
v_and_b32_e64 v185, s49, v185
v_mfma_f32_16x16x32_bf16 v[176:179], v[240:243], v[100:103], 0
v_pk_fma_f16 v199, v200, v200, s48
v_and_b32 v187, s49, v187
s_waitcnt lgkmcnt(3)
v_mfma_f32_16x16x32_f16 v[64:67], v[244:247], v[232:235], v[64:67]
ds_read_b128 v[240:243], v249 offset:51456
v_pk_fma_f16 v196, v197, v197, s48
v_bfe_u32 v184, v185, 2, 14
v_pk_mul_f16 v202, v203, v202
v_mfma_f32_16x16x32_f16 v[72:75], v[244:247], v[236:239], v[72:75]
v_bfe_u32 v186, v187, 2, 14
v_pk_mul_f16 v199, v200, v199
s_waitcnt vmcnt(7)
v_mfma_f32_16x16x32_bf16 v[144:147], v[18:21], v[44:47], v[144:147]
ds_read_b128 v[244:247], v248 offset:54528
ds_read_u16_d16 v184, v184
ds_read_u16_d16 v186, v186
v_lshrrev_b32 v185, 18, v185
v_pk_mul_f16 v196, v197, v196
v_mfma_f32_16x16x32_bf16 v[148:151], v[16:19], v[44:47], v[148:151]
v_lshrrev_b32_e64 v187, 18, v187
v_mfma_f32_16x16x32_bf16 v[172:175], v[216:219], v[96:99], 0
ds_read_u16_d16_hi v185, v185
ds_read_u16_d16_hi v187, v187
v_exp_f16 v201, v202
v_and_b32 v189, s49, v189
v_mfma_f32_16x16x32_bf16 v[180:183], v[216:219], v[100:103], 0
v_and_b32 v191, s49, v191
s_waitcnt lgkmcnt(6)
v_mfma_f32_16x16x32_f16 v[68:71], v[220:223], v[232:235], v[68:71]
ds_read_b128 v[216:219], v248 offset:55296
v_exp_f16_e64 v198, v199
v_bfe_u32 v188, v189, 2, 14
v_mfma_f32_16x16x32_f16 v[76:79], v[220:223], v[236:239], v[76:79]
v_bfe_u32 v190, v191, 2, 14
v_exp_f16_e64 v195, v196
v_mfma_f32_16x16x32_bf16 v[168:171], v[224:227], v[104:107], v[168:171]
ds_read_b128 v[220:223], v248 offset:55552
ds_read_u16_d16 v188, v188
ds_read_u16_d16 v190, v190
v_lshrrev_b32 v189, 18, v189
v_lshrrev_b32 v191, 18, v191
v_mfma_f32_16x16x32_bf16 v[176:179], v[224:227], v[108:111], v[176:179]
v_exp_f16_sdwa v201, v202 dst_sel:WORD_1 dst_unused:UNUSED_PRESERVE src0_sel:WORD_1
v_mfma_f32_16x16x32_f16 v[80:83], v[228:231], v[232:235], v[80:83]
ds_read_b128 v[224:227], v249 offset:55296
ds_read_u16_d16_hi v189, v189
ds_read_u16_d16_hi v191, v191
v_and_b32 v193, s49, v193
v_bfe_u32 v192, v193, 2, 14
v_mfma_f32_16x16x32_f16 v[88:91], v[228:231], v[236:239], v[88:91]
v_exp_f16_sdwa v198, v199 dst_sel:WORD_1 dst_unused:UNUSED_PRESERVE src0_sel:WORD_1
s_waitcnt lgkmcnt(7)
v_mfma_f32_16x16x32_f16 v[84:87], v[240:243], v[232:235], v[84:87]
ds_read_b128 v[228:231], v249 offset:55552
ds_read_u16_d16 v192, v192
v_lshrrev_b32_e64 v193, 18, v193
v_mfma_f32_16x16x32_f16 v[92:95], v[240:243], v[236:239], v[92:95]
v_exp_f16_sdwa v195, v196 dst_sel:WORD_1 dst_unused:UNUSED_PRESERVE src0_sel:WORD_1
v_pk_add_f16 v201, v201, 1.0 op_sel_hi:[1,0]
v_pk_add_f16 v198, v198, 1.0 op_sel_hi:[1,0]
v_mfma_f32_16x16x32_bf16 v[172:175], v[244:247], v[104:107], v[172:175]
ds_read_b128 v[240:243], v248 offset:59392
ds_read_u16_d16_hi v193, v193
v_pk_add_f16 v195, v195, 1.0 op_sel_hi:[1,0]
v_mfma_f32_16x16x32_bf16 v[180:183], v[244:247], v[108:111], v[180:183]
v_rcp_f16 v202, v201
s_waitcnt lgkmcnt(7)
v_mfma_f32_16x16x32_bf16 v[168:171], v[216:219], v[112:115], v[168:171]
ds_read_b128 v[244:247], v249 offset:56320
v_rcp_f16_e64 v199, v198
v_mfma_f32_16x16x32_bf16 v[176:179], v[216:219], v[116:119], v[176:179]
v_rcp_f16_e64 v196, v195
v_mfma_f32_16x16x32_bf16 v[172:175], v[220:223], v[112:115], v[172:175]
ds_read_b128 v[216:219], v248 offset:59648
v_rcp_f16_sdwa v202, v201 dst_sel:WORD_1 dst_unused:UNUSED_PRESERVE src0_sel:WORD_1
v_mfma_f32_16x16x32_bf16 v[180:183], v[220:223], v[116:119], v[180:183]
v_rcp_f16_sdwa v199, v198 dst_sel:WORD_1 dst_unused:UNUSED_PRESERVE src0_sel:WORD_1
v_or_b32 v232, v184, v185
v_or_b32 v233, v186, v187
s_waitcnt lgkmcnt(4)
v_or_b32 v234, v188, v189
v_rcp_f16_sdwa v196, v195 dst_sel:WORD_1 dst_unused:UNUSED_PRESERVE src0_sel:WORD_1
v_or_b32 v235, v190, v191
s_waitcnt lgkmcnt(2)
v_or_b32_e64 v236, v192, v193
v_pk_mul_f16 v237, v203, v202
v_pk_mul_f16 v238, v200, v199
v_pk_mul_f16 v239, v197, v196
v_mfma_f32_16x16x32_f16 v[48:51], v[224:227], v[232:235], v[48:51]
s_add_u32 s46, s69, 98304
buffer_load_dwordx4 v[44:47], v252, s[4:7], s46 offen
ds_read_b128 v[220:223], v249 offset:56576
v_cvt_pkrtz_f16_f32 v185, v168, v169
v_cvt_pkrtz_f16_f32 v187, v170, v171
v_mfma_f32_16x16x32_f16 v[56:59], v[224:227], v[236:239], v[56:59]
v_cvt_pkrtz_f16_f32 v189, v172, v173
v_cvt_pkrtz_f16_f32 v191, v174, v175
v_mfma_f32_16x16x32_f16 v[52:55], v[228:231], v[232:235], v[52:55]
ds_read_b128 v[224:227], v248 offset:60416
v_cvt_pkrtz_f16_f32 v193, v176, v177
v_cvt_pk_f16_f32 v203, v178, v179
v_cvt_pk_f16_f32 v200, v180, v181
v_mfma_f32_16x16x32_f16 v[60:63], v[228:231], v[236:239], v[60:63]
v_cvt_pk_f16_f32 v197, v182, v183
v_pk_fma_f16 v202, v203, v203, s48
v_mfma_f32_16x16x32_bf16 v[168:171], v[240:243], v[96:99], 0
ds_read_b128 v[228:231], v249 offset:57344
v_and_b32_e64 v185, s49, v185
v_pk_fma_f16 v199, v200, v200, s48
v_mfma_f32_16x16x32_bf16 v[176:179], v[240:243], v[100:103], 0
v_and_b32_e64 v187, s49, v187
v_pk_fma_f16 v196, v197, v197, s48
s_setprio 2
v_bfe_u32 v184, v185, 2, 14
s_waitcnt lgkmcnt(3)
v_mfma_f32_16x16x32_f16 v[64:67], v[244:247], v[232:235], v[64:67]
ds_read_b128 v[240:243], v249 offset:57600
ds_read_u16_d16 v184, v184
v_pk_mul_f16 v202, v203, v202
v_bfe_u32 v186, v187, 2, 14
v_mfma_f32_16x16x32_f16 v[72:75], v[244:247], v[236:239], v[72:75]
v_pk_mul_f16 v199, v200, v199
v_lshrrev_b32_e64 v185, 18, v185
v_mfma_f32_16x16x32_bf16 v[172:175], v[216:219], v[96:99], 0
ds_read_b128 v[244:247], v248 offset:60672
ds_read_u16_d16 v186, v186
ds_read_u16_d16_hi v185, v185
v_pk_mul_f16 v196, v197, v196
v_lshrrev_b32_e64 v187, 18, v187
v_mfma_f32_16x16x32_bf16 v[180:183], v[216:219], v[100:103], 0
v_exp_f16_e64 v201, v202
v_and_b32 v189, s49, v189
s_waitcnt lgkmcnt(5)
v_mfma_f32_16x16x32_f16 v[68:71], v[220:223], v[232:235], v[68:71]
ds_read_b128 v[216:219], v248 offset:61440
ds_read_u16_d16_hi v187, v187
v_and_b32_e64 v191, s49, v191
v_mfma_f32_16x16x32_f16 v[76:79], v[220:223], v[236:239], v[76:79]
v_exp_f16_e64 v198, v199
v_bfe_u32 v188, v189, 2, 14
v_bfe_u32 v190, v191, 2, 14
v_mfma_f32_16x16x32_bf16 v[168:171], v[224:227], v[104:107], v[168:171]
buffer_store_dwordx4 v[152:155], v255, s[8:11], s68 offen offset:256 sc1
ds_read_b128 v[220:223], v248 offset:61696
ds_read_u16_d16 v188, v188
ds_read_u16_d16 v190, v190
v_exp_f16_e64 v195, v196
v_mfma_f32_16x16x32_bf16 v[176:179], v[224:227], v[108:111], v[176:179]
v_lshrrev_b32 v189, 18, v189
v_lshrrev_b32 v191, 18, v191
v_mfma_f32_16x16x32_f16 v[80:83], v[228:231], v[232:235], v[80:83]
ds_read_b128 v[224:227], v249 offset:61440
ds_read_u16_d16_hi v189, v189
ds_read_u16_d16_hi v191, v191
v_exp_f16_sdwa v201, v202 dst_sel:WORD_1 dst_unused:UNUSED_PRESERVE src0_sel:WORD_1
v_and_b32 v193, s49, v193
v_mfma_f32_16x16x32_f16 v[88:91], v[228:231], v[236:239], v[88:91]
v_bfe_u32 v192, v193, 2, 14
s_waitcnt lgkmcnt(8)
v_mfma_f32_16x16x32_f16 v[84:87], v[240:243], v[232:235], v[84:87]
ds_read_b128 v[228:231], v249 offset:61696
ds_read_u16_d16 v192, v192
v_exp_f16_sdwa v198, v199 dst_sel:WORD_1 dst_unused:UNUSED_PRESERVE src0_sel:WORD_1
v_lshrrev_b32_e64 v193, 18, v193
v_mfma_f32_16x16x32_f16 v[92:95], v[240:243], v[236:239], v[92:95]
v_exp_f16_sdwa v195, v196 dst_sel:WORD_1 dst_unused:UNUSED_PRESERVE src0_sel:WORD_1
v_pk_add_f16 v201, v201, 1.0 op_sel_hi:[1,0]
v_mfma_f32_16x16x32_bf16 v[172:175], v[244:247], v[104:107], v[172:175]
ds_read_b128 v[240:243], v249
ds_read_u16_d16_hi v193, v193
v_pk_add_f16 v198, v198, 1.0 op_sel_hi:[1,0]
v_pk_add_f16 v195, v195, 1.0 op_sel_hi:[1,0]
v_mfma_f32_16x16x32_bf16 v[180:183], v[244:247], v[108:111], v[180:183]
v_rcp_f16 v202, v201
s_waitcnt lgkmcnt(7)
v_mfma_f32_16x16x32_bf16 v[168:171], v[216:219], v[112:115], v[168:171]
ds_read_b128 v[244:247], v249 offset:62464
v_rcp_f16_e64 v199, v198
v_mfma_f32_16x16x32_bf16 v[176:179], v[216:219], v[116:119], v[176:179]
v_rcp_f16_e64 v196, v195
v_mfma_f32_16x16x32_bf16 v[172:175], v[220:223], v[112:115], v[172:175]
ds_read_b128 v[216:219], v249 offset:256
v_rcp_f16_sdwa v202, v201 dst_sel:WORD_1 dst_unused:UNUSED_PRESERVE src0_sel:WORD_1
v_mfma_f32_16x16x32_bf16 v[180:183], v[220:223], v[116:119], v[180:183]
v_rcp_f16_sdwa v199, v198 dst_sel:WORD_1 dst_unused:UNUSED_PRESERVE src0_sel:WORD_1
v_or_b32 v232, v184, v185
v_or_b32 v233, v186, v187
s_waitcnt lgkmcnt(4)
v_or_b32 v234, v188, v189
v_rcp_f16_sdwa v196, v195 dst_sel:WORD_1 dst_unused:UNUSED_PRESERVE src0_sel:WORD_1
v_or_b32 v235, v190, v191
s_waitcnt lgkmcnt(2)
v_or_b32_e64 v236, v192, v193
v_pk_mul_f16 v237, v203, v202
v_pk_mul_f16 v238, v200, v199
v_pk_mul_f16 v239, v197, v196
v_mfma_f32_16x16x32_f16 v[48:51], v[224:227], v[232:235], v[48:51]
s_add_u32 s46, s69, 98304
buffer_load_dwordx4 v[40:43], v252, s[4:7], s46 offen offset:64
ds_read_b128 v[220:223], v249 offset:62720
v_cvt_pkrtz_f16_f32 v185, v168, v169
v_cvt_pkrtz_f16_f32 v187, v170, v171
v_mfma_f32_16x16x32_f16 v[56:59], v[224:227], v[236:239], v[56:59]
v_cvt_pkrtz_f16_f32 v189, v172, v173
v_cvt_pkrtz_f16_f32 v191, v174, v175
v_mfma_f32_16x16x32_f16 v[52:55], v[228:231], v[232:235], v[52:55]
ds_read_b128 v[224:227], v249 offset:1024
v_cvt_pkrtz_f16_f32 v193, v176, v177
v_cvt_pk_f16_f32 v203, v178, v179
v_mfma_f32_16x16x32_f16 v[60:63], v[228:231], v[236:239], v[60:63]
v_cvt_pk_f16_f32 v200, v180, v181
v_cvt_pk_f16_f32 v197, v182, v183
s_setprio 1
v_mfma_f32_16x16x32_bf16 v[168:171], v[240:243], v[96:99], 0
ds_read_b128 v[228:231], v249 offset:63488
v_pk_fma_f16 v202, v203, v203, s48
v_and_b32 v185, s49, v185
v_mfma_f32_16x16x32_bf16 v[176:179], v[240:243], v[100:103], 0
v_pk_fma_f16 v199, v200, v200, s48
v_and_b32 v187, s49, v187
s_waitcnt lgkmcnt(3)
v_mfma_f32_16x16x32_f16 v[64:67], v[244:247], v[232:235], v[64:67]
ds_read_b128 v[240:243], v249 offset:63744
v_pk_fma_f16 v196, v197, v197, s48
v_bfe_u32 v184, v185, 2, 14
v_mfma_f32_16x16x32_f16 v[72:75], v[244:247], v[236:239], v[72:75]
v_pk_mul_f16 v202, v203, v202
v_bfe_u32 v186, v187, 2, 14
s_waitcnt vmcnt(8)
v_mfma_f32_16x16x32_bf16 v[160:163], v[18:21], v[208:211], v[160:163]
ds_read_b128 v[244:247], v249 offset:1280
ds_read_u16_d16 v184, v184
ds_read_u16_d16 v186, v186
v_pk_mul_f16 v199, v200, v199
v_lshrrev_b32 v185, 18, v185
v_mfma_f32_16x16x32_bf16 v[164:167], v[16:19], v[208:211], v[164:167]
v_pk_mul_f16 v196, v197, v196
v_lshrrev_b32_e64 v187, 18, v187
v_mfma_f32_16x16x32_bf16 v[172:175], v[216:219], v[96:99], 0
ds_read_u16_d16_hi v185, v185
ds_read_u16_d16_hi v187, v187
v_exp_f16_e64 v201, v202
v_mfma_f32_16x16x32_bf16 v[180:183], v[216:219], v[100:103], 0
v_and_b32_e64 v189, s49, v189
v_and_b32 v191, s49, v191
s_waitcnt lgkmcnt(6)
v_mfma_f32_16x16x32_f16 v[68:71], v[220:223], v[232:235], v[68:71]
ds_read_b128 v[216:219], v249 offset:2048
v_exp_f16_e64 v198, v199
v_mfma_f32_16x16x32_f16 v[76:79], v[220:223], v[236:239], v[76:79]
v_bfe_u32 v188, v189, 2, 14
v_bfe_u32 v190, v191, 2, 14
v_mfma_f32_16x16x32_bf16 v[168:171], v[224:227], v[104:107], v[168:171]
ds_read_b128 v[220:223], v249 offset:2304
ds_read_u16_d16 v188, v188
ds_read_u16_d16 v190, v190
v_exp_f16_e64 v195, v196
v_mfma_f32_16x16x32_bf16 v[176:179], v[224:227], v[108:111], v[176:179]
v_lshrrev_b32 v189, 18, v189
v_lshrrev_b32 v191, 18, v191
v_mfma_f32_16x16x32_f16 v[80:83], v[228:231], v[232:235], v[80:83]
ds_read_b128 v[224:227], v250 offset:2048
ds_read_u16_d16_hi v189, v189
ds_read_u16_d16_hi v191, v191
v_exp_f16_sdwa v201, v202 dst_sel:WORD_1 dst_unused:UNUSED_PRESERVE src0_sel:WORD_1
v_mfma_f32_16x16x32_f16 v[88:91], v[228:231], v[236:239], v[88:91]
v_and_b32 v193, s49, v193
v_bfe_u32 v192, v193, 2, 14
s_waitcnt lgkmcnt(7)
v_mfma_f32_16x16x32_f16 v[84:87], v[240:243], v[232:235], v[84:87]
ds_read_b128 v[228:231], v250 offset:2304
ds_read_u16_d16 v192, v192
v_exp_f16_sdwa v198, v199 dst_sel:WORD_1 dst_unused:UNUSED_PRESERVE src0_sel:WORD_1
v_mfma_f32_16x16x32_f16 v[92:95], v[240:243], v[236:239], v[92:95]
v_lshrrev_b32 v193, 18, v193
s_waitcnt vmcnt(7)
v_mfma_f32_16x16x32_bf16 v[48:51], v[18:21], v[12:15], v[48:51]
ds_read_b128 v[240:243], v249 offset:6144
ds_read_u16_d16_hi v193, v193
v_exp_f16_sdwa v195, v196 dst_sel:WORD_1 dst_unused:UNUSED_PRESERVE src0_sel:WORD_1
v_pk_add_f16 v201, v201, 1.0 op_sel_hi:[1,0]
v_mfma_f32_16x16x32_bf16 v[52:55], v[16:19], v[12:15], v[52:55]
v_pk_add_f16 v198, v198, 1.0 op_sel_hi:[1,0]
v_pk_add_f16 v195, v195, 1.0 op_sel_hi:[1,0]
v_mfma_f32_16x16x32_bf16 v[172:175], v[244:247], v[104:107], v[172:175]
v_rcp_f16 v202, v201
s_setprio 0
v_mfma_f32_16x16x32_bf16 v[180:183], v[244:247], v[108:111], v[180:183]
v_rcp_f16 v199, v198
s_waitcnt lgkmcnt(4)
v_mfma_f32_16x16x32_bf16 v[168:171], v[216:219], v[112:115], v[168:171]
ds_read_b128 v[244:247], v250 offset:3072
v_rcp_f16_e64 v196, v195
v_mfma_f32_16x16x32_bf16 v[176:179], v[216:219], v[116:119], v[176:179]
v_rcp_f16_sdwa v202, v201 dst_sel:WORD_1 dst_unused:UNUSED_PRESERVE src0_sel:WORD_1
v_mfma_f32_16x16x32_bf16 v[172:175], v[220:223], v[112:115], v[172:175]
ds_read_b128 v[216:219], v249 offset:6400
v_rcp_f16_sdwa v199, v198 dst_sel:WORD_1 dst_unused:UNUSED_PRESERVE src0_sel:WORD_1
v_mfma_f32_16x16x32_bf16 v[180:183], v[220:223], v[116:119], v[180:183]
v_or_b32 v232, v184, v185
v_or_b32 v233, v186, v187
v_or_b32_e64 v234, v188, v189
v_rcp_f16_sdwa v196, v195 dst_sel:WORD_1 dst_unused:UNUSED_PRESERVE src0_sel:WORD_1
v_or_b32 v235, v190, v191
s_waitcnt lgkmcnt(2)
v_or_b32_e64 v236, v192, v193
v_pk_mul_f16 v237, v203, v202
v_pk_mul_f16 v238, v200, v199
v_pk_mul_f16 v239, v197, v196
v_mfma_f32_16x16x32_f16 v[48:51], v[224:227], v[232:235], v[48:51]
s_add_u32 s46, s69, 98304
buffer_load_dwordx4 v[208:211], v252, s[4:7], s46 offen offset:128
ds_read_b128 v[220:223], v250 offset:3328
v_cvt_pkrtz_f16_f32 v185, v168, v169
v_cvt_pkrtz_f16_f32 v187, v170, v171
v_mfma_f32_16x16x32_f16 v[56:59], v[224:227], v[236:239], v[56:59]
v_cvt_pkrtz_f16_f32 v189, v172, v173
v_cvt_pkrtz_f16_f32 v191, v174, v175
v_cvt_pkrtz_f16_f32 v193, v176, v177
v_mfma_f32_16x16x32_f16 v[52:55], v[228:231], v[232:235], v[52:55]
ds_read_b128 v[224:227], v249 offset:7168
v_cvt_pkrtz_f16_f32 v195, v178, v179
v_cvt_pk_f16_f32 v203, v180, v181
v_cvt_pk_f16_f32 v200, v182, v183
v_mfma_f32_16x16x32_f16 v[60:63], v[228:231], v[236:239], v[60:63]
v_pk_fma_f16 v202, v203, v203, s48
v_cvt_pk_bf16_f32 v144, v144, v145
v_and_b32_e64 v185, s49, v185
v_mfma_f32_16x16x32_bf16 v[168:171], v[240:243], v[96:99], 0
ds_read_b128 v[228:231], v250 offset:4096
v_cvt_pk_bf16_f32 v145, v146, v147
v_and_b32 v187, s49, v187
v_mfma_f32_16x16x32_bf16 v[176:179], v[240:243], v[100:103], 0
v_cvt_pk_bf16_f32 v146, v148, v149
v_pk_fma_f16 v199, v200, v200, s48
v_bfe_u32 v184, v185, 2, 14
s_waitcnt lgkmcnt(3)
v_mfma_f32_16x16x32_f16 v[64:67], v[244:247], v[232:235], v[64:67]
ds_read_b128 v[240:243], v250 offset:4352
ds_read_u16_d16 v184, v184
v_cvt_pk_bf16_f32 v147, v150, v151
v_pk_mul_f16 v202, v203, v202
v_cvt_pk_bf16_f32 v128, v128, v129
v_mfma_f32_16x16x32_f16 v[72:75], v[244:247], v[236:239], v[72:75]
v_bfe_u32 v186, v187, 2, 14
v_cvt_pk_bf16_f32 v129, v130, v131
v_pk_mul_f16 v199, v200, v199
s_waitcnt vmcnt(6)
v_mfma_f32_16x16x32_bf16 v[64:67], v[18:21], v[204:207], v[64:67]
ds_read_b128 v[244:247], v249 offset:7424
ds_read_u16_d16 v186, v186
v_lshrrev_b32 v185, 18, v185
v_cvt_pk_bf16_f32 v130, v132, v133
v_mfma_f32_16x16x32_bf16 v[68:71], v[16:19], v[204:207], v[68:71]
v_exp_f16_e64 v201, v202
v_cvt_pk_bf16_f32 v131, v134, v135
v_mfma_f32_16x16x32_bf16 v[172:175], v[216:219], v[96:99], 0
ds_read_u16_d16_hi v185, v185
v_lshrrev_b32_e64 v187, 18, v187
v_cvt_pk_bf16_f32 v160, v160, v161
v_and_b32_e64 v189, s49, v189
v_mfma_f32_16x16x32_bf16 v[180:183], v[216:219], v[100:103], 0
v_cvt_pk_bf16_f32 v161, v162, v163
v_exp_f16 v198, v199
s_waitcnt lgkmcnt(3)
v_mfma_f32_16x16x32_f16 v[68:71], v[220:223], v[232:235], v[68:71]
ds_read_b128 v[216:219], v249 offset:8192
ds_read_u16_d16_hi v187, v187
v_cvt_pk_bf16_f32 v162, v164, v165
v_and_b32_e64 v191, s49, v191
v_mfma_f32_16x16x32_f16 v[76:79], v[220:223], v[236:239], v[76:79]
v_cvt_pk_bf16_f32 v163, v166, v167
s_mov_b64 vcc, s[74:75]
v_bfe_u32 v188, v189, 2, 14
v_cndmask_b32 v148, v128, v160, vcc
v_mfma_f32_16x16x32_bf16 v[168:171], v[224:227], v[104:107], v[168:171]
ds_read_b128 v[220:223], v249 offset:8448
ds_read_u16_d16 v188, v188
v_exp_f16_sdwa v201, v202 dst_sel:WORD_1 dst_unused:UNUSED_PRESERVE src0_sel:WORD_1
v_cndmask_b32 v149, v129, v161, vcc
v_mfma_f32_16x16x32_bf16 v[176:179], v[224:227], v[108:111], v[176:179]
v_bfe_u32 v190, v191, 2, 14
v_cndmask_b32 v150, v130, v162, vcc
v_lshrrev_b32_e64 v189, 18, v189
v_mfma_f32_16x16x32_f16 v[80:83], v[228:231], v[232:235], v[80:83]
ds_read_b128 v[224:227], v250 offset:8192
ds_read_u16_d16 v190, v190
ds_read_u16_d16_hi v189, v189
v_cndmask_b32 v151, v131, v163, vcc
v_lshrrev_b32 v191, 18, v191
v_mfma_f32_16x16x32_f16 v[88:91], v[228:231], v[236:239], v[88:91]
v_exp_f16_sdwa v198, v199 dst_sel:WORD_1 dst_unused:UNUSED_PRESERVE src0_sel:WORD_1
v_cndmask_b32_dpp v128, v144, v128, vcc quad_perm:[1,0,3,2] row_mask:0xf bank_mask:0xf
v_mfma_f32_16x16x32_f16 v[84:87], v[240:243], v[232:235], v[84:87]
ds_read_b128 v[228:231], v250 offset:8448
ds_read_u16_d16_hi v191, v191
v_cndmask_b32_dpp v129, v145, v129, vcc quad_perm:[1,0,3,2] row_mask:0xf bank_mask:0xf
v_and_b32_e64 v193, s49, v193
v_cndmask_b32_dpp v130, v146, v130, vcc quad_perm:[1,0,3,2] row_mask:0xf bank_mask:0xf
v_mfma_f32_16x16x32_f16 v[92:95], v[240:243], v[236:239], v[92:95]
v_and_b32_e64 v195, s49, v195
v_pk_add_f16 v201, v201, 1.0 op_sel_hi:[1,0]
v_cndmask_b32_dpp v131, v147, v131, vcc quad_perm:[1,0,3,2] row_mask:0xf bank_mask:0xf
s_not_b64 vcc, s[74:75]
s_waitcnt lgkmcnt(5)
v_mfma_f32_16x16x32_bf16 v[172:175], v[244:247], v[104:107], v[172:175]
ds_read_b128 v[240:243], v249 offset:12288
v_bfe_u32 v192, v193, 2, 14
v_cndmask_b32_dpp v160, v144, v160, vcc quad_perm:[1,0,3,2] row_mask:0xf bank_mask:0xf
v_pk_add_f16 v198, v198, 1.0 op_sel_hi:[1,0]
v_mfma_f32_16x16x32_bf16 v[180:183], v[244:247], v[108:111], v[180:183]
v_cndmask_b32_dpp v161, v145, v161, vcc quad_perm:[1,0,3,2] row_mask:0xf bank_mask:0xf
v_bfe_u32 v194, v195, 2, 14
v_mfma_f32_16x16x32_bf16 v[168:171], v[216:219], v[112:115], v[168:171]
ds_read_b128 v[244:247], v250 offset:9216
ds_read_u16_d16 v192, v192
ds_read_u16_d16 v194, v194
v_rcp_f16_e64 v202, v201
v_cndmask_b32_dpp v162, v146, v162, vcc quad_perm:[1,0,3,2] row_mask:0xf bank_mask:0xf
v_mfma_f32_16x16x32_bf16 v[176:179], v[216:219], v[116:119], v[176:179]
v_cndmask_b32_dpp v163, v147, v163, vcc quad_perm:[1,0,3,2] row_mask:0xf bank_mask:0xf
v_lshrrev_b32 v193, 18, v193
v_lshrrev_b32 v195, 18, v195
v_mfma_f32_16x16x32_bf16 v[172:175], v[220:223], v[112:115], v[172:175]
ds_read_b128 v[216:219], v249 offset:12544
s_add_u32 s46, s68, 98304
buffer_store_dwordx4 v[128:131], v255, s[8:11], s46 offen sc1
ds_read_u16_d16_hi v193, v193
ds_read_u16_d16_hi v195, v195
v_rcp_f16_e64 v199, v198
v_mfma_f32_16x16x32_bf16 v[180:183], v[220:223], v[116:119], v[180:183]
v_rcp_f16_sdwa v202, v201 dst_sel:WORD_1 dst_unused:UNUSED_PRESERVE src0_sel:WORD_1
v_or_b32 v232, v184, v185
v_or_b32 v233, v186, v187
s_waitcnt lgkmcnt(6)
v_or_b32 v234, v188, v189
v_rcp_f16_sdwa v199, v198 dst_sel:WORD_1 dst_unused:UNUSED_PRESERVE src0_sel:WORD_1
v_or_b32 v235, v190, v191
s_waitcnt lgkmcnt(1)
v_or_b32 v236, v192, v193
s_waitcnt lgkmcnt(0)
v_or_b32_e64 v237, v194, v195
v_pk_mul_f16 v238, v203, v202
v_pk_mul_f16 v239, v200, v199
v_mfma_f32_16x16x32_f16 v[48:51], v[224:227], v[232:235], v[48:51]
s_add_u32 s46, s68, 98304
buffer_store_dwordx4 v[148:151], v255, s[8:11], s46 offen offset:128 sc1
ds_read_b128 v[220:223], v250 offset:9472
v_cvt_pkrtz_f16_f32 v185, v168, v169
v_cvt_pkrtz_f16_f32 v187, v170, v171
v_mfma_f32_16x16x32_f16 v[56:59], v[224:227], v[236:239], v[56:59]
v_cvt_pkrtz_f16_f32 v189, v172, v173
v_cvt_pkrtz_f16_f32 v191, v174, v175
v_mfma_f32_16x16x32_f16 v[52:55], v[228:231], v[232:235], v[52:55]
ds_read_b128 v[224:227], v249 offset:13312
v_cvt_pkrtz_f16_f32 v193, v176, v177
v_cvt_pk_f16_f32 v203, v178, v179
v_mfma_f32_16x16x32_f16 v[60:63], v[228:231], v[236:239], v[60:63]
v_cvt_pk_f16_f32 v200, v180, v181
v_cvt_pk_f16_f32 v197, v182, v183
v_mfma_f32_16x16x32_bf16 v[168:171], v[240:243], v[96:99], 0
ds_read_b128 v[228:231], v250 offset:10240
v_pk_fma_f16 v202, v203, v203, s48
v_and_b32_e64 v185, s49, v185
v_mfma_f32_16x16x32_bf16 v[176:179], v[240:243], v[100:103], 0
v_pk_fma_f16 v199, v200, v200, s48
v_and_b32_e64 v187, s49, v187
v_mfma_f32_16x16x32_f16 v[64:67], v[244:247], v[232:235], v[64:67]
ds_read_b128 v[240:243], v250 offset:10496
v_pk_fma_f16 v196, v197, v197, s48
v_bfe_u32 v184, v185, 2, 14
v_pk_mul_f16 v202, v203, v202
v_mfma_f32_16x16x32_f16 v[72:75], v[244:247], v[236:239], v[72:75]
v_bfe_u32 v186, v187, 2, 14
v_pk_mul_f16 v199, v200, v199
s_waitcnt vmcnt(6)
v_mfma_f32_16x16x32_bf16 v[80:83], v[18:21], v[8:11], v[80:83]
ds_read_b128 v[244:247], v249 offset:13568
ds_read_u16_d16 v184, v184
ds_read_u16_d16 v186, v186
v_lshrrev_b32 v185, 18, v185
v_pk_mul_f16 v196, v197, v196
v_mfma_f32_16x16x32_bf16 v[84:87], v[16:19], v[8:11], v[84:87]
v_lshrrev_b32_e64 v187, 18, v187
v_mfma_f32_16x16x32_bf16 v[172:175], v[216:219], v[96:99], 0
ds_read_u16_d16_hi v185, v185
ds_read_u16_d16_hi v187, v187
v_exp_f16 v201, v202
v_and_b32 v189, s49, v189
v_mfma_f32_16x16x32_bf16 v[180:183], v[216:219], v[100:103], 0
v_and_b32 v191, s49, v191
s_waitcnt lgkmcnt(6)
v_mfma_f32_16x16x32_f16 v[68:71], v[220:223], v[232:235], v[68:71]
ds_read_b128 v[216:219], v249 offset:14336
v_exp_f16_e64 v198, v199
v_bfe_u32 v188, v189, 2, 14
v_mfma_f32_16x16x32_f16 v[76:79], v[220:223], v[236:239], v[76:79]
v_bfe_u32 v190, v191, 2, 14
v_exp_f16_e64 v195, v196
v_mfma_f32_16x16x32_bf16 v[168:171], v[224:227], v[104:107], v[168:171]
ds_read_b128 v[220:223], v249 offset:14592
ds_read_u16_d16 v188, v188
ds_read_u16_d16 v190, v190
v_lshrrev_b32 v189, 18, v189
v_lshrrev_b32 v191, 18, v191
v_mfma_f32_16x16x32_bf16 v[176:179], v[224:227], v[108:111], v[176:179]
v_exp_f16_sdwa v201, v202 dst_sel:WORD_1 dst_unused:UNUSED_PRESERVE src0_sel:WORD_1
v_mfma_f32_16x16x32_f16 v[80:83], v[228:231], v[232:235], v[80:83]
ds_read_b128 v[224:227], v250 offset:14336
ds_read_u16_d16_hi v189, v189
ds_read_u16_d16_hi v191, v191
v_and_b32 v193, s49, v193
v_bfe_u32 v192, v193, 2, 14
v_mfma_f32_16x16x32_f16 v[88:91], v[228:231], v[236:239], v[88:91]
v_exp_f16_sdwa v198, v199 dst_sel:WORD_1 dst_unused:UNUSED_PRESERVE src0_sel:WORD_1
s_waitcnt lgkmcnt(7)
v_mfma_f32_16x16x32_f16 v[84:87], v[240:243], v[232:235], v[84:87]
ds_read_b128 v[228:231], v250 offset:14592
ds_read_u16_d16 v192, v192
v_lshrrev_b32_e64 v193, 18, v193
v_mfma_f32_16x16x32_f16 v[92:95], v[240:243], v[236:239], v[92:95]
v_exp_f16_sdwa v195, v196 dst_sel:WORD_1 dst_unused:UNUSED_PRESERVE src0_sel:WORD_1
v_pk_add_f16 v201, v201, 1.0 op_sel_hi:[1,0]
v_pk_add_f16 v198, v198, 1.0 op_sel_hi:[1,0]
v_mfma_f32_16x16x32_bf16 v[172:175], v[244:247], v[104:107], v[172:175]
ds_read_b128 v[240:243], v249 offset:18432
ds_read_u16_d16_hi v193, v193
v_pk_add_f16 v195, v195, 1.0 op_sel_hi:[1,0]
v_mfma_f32_16x16x32_bf16 v[180:183], v[244:247], v[108:111], v[180:183]
v_rcp_f16 v202, v201
s_waitcnt lgkmcnt(7)
v_mfma_f32_16x16x32_bf16 v[168:171], v[216:219], v[112:115], v[168:171]
ds_read_b128 v[244:247], v250 offset:15360
v_rcp_f16_e64 v199, v198
v_mfma_f32_16x16x32_bf16 v[176:179], v[216:219], v[116:119], v[176:179]
v_rcp_f16_e64 v196, v195
v_mfma_f32_16x16x32_bf16 v[172:175], v[220:223], v[112:115], v[172:175]
ds_read_b128 v[216:219], v249 offset:18688
v_rcp_f16_sdwa v202, v201 dst_sel:WORD_1 dst_unused:UNUSED_PRESERVE src0_sel:WORD_1
v_mfma_f32_16x16x32_bf16 v[180:183], v[220:223], v[116:119], v[180:183]
v_rcp_f16_sdwa v199, v198 dst_sel:WORD_1 dst_unused:UNUSED_PRESERVE src0_sel:WORD_1
v_or_b32 v232, v184, v185
v_or_b32 v233, v186, v187
s_waitcnt lgkmcnt(4)
v_or_b32 v234, v188, v189
v_rcp_f16_sdwa v196, v195 dst_sel:WORD_1 dst_unused:UNUSED_PRESERVE src0_sel:WORD_1
v_or_b32 v235, v190, v191
s_waitcnt lgkmcnt(2)
v_or_b32_e64 v236, v192, v193
v_pk_mul_f16 v237, v203, v202
v_pk_mul_f16 v238, v200, v199
v_pk_mul_f16 v239, v197, v196
v_mfma_f32_16x16x32_f16 v[48:51], v[224:227], v[232:235], v[48:51]
ds_read_b128 v[220:223], v250 offset:15616
v_cvt_pkrtz_f16_f32 v185, v168, v169
v_cvt_pkrtz_f16_f32 v187, v170, v171
v_mfma_f32_16x16x32_f16 v[56:59], v[224:227], v[236:239], v[56:59]
v_cvt_pkrtz_f16_f32 v189, v172, v173
v_cvt_pkrtz_f16_f32 v191, v174, v175
v_mfma_f32_16x16x32_f16 v[52:55], v[228:231], v[232:235], v[52:55]
ds_read_b128 v[224:227], v249 offset:19456
v_cvt_pkrtz_f16_f32 v193, v176, v177
v_cvt_pk_f16_f32 v203, v178, v179
v_mfma_f32_16x16x32_f16 v[60:63], v[228:231], v[236:239], v[60:63]
v_cvt_pk_f16_f32 v200, v180, v181
v_cvt_pk_f16_f32 v197, v182, v183
v_mfma_f32_16x16x32_bf16 v[168:171], v[240:243], v[96:99], 0
ds_read_b128 v[228:231], v250 offset:16384
v_pk_fma_f16 v202, v203, v203, s48
v_and_b32_e64 v185, s49, v185
v_mfma_f32_16x16x32_bf16 v[176:179], v[240:243], v[100:103], 0
v_pk_fma_f16 v199, v200, v200, s48
v_and_b32 v187, s49, v187
s_waitcnt lgkmcnt(3)
v_mfma_f32_16x16x32_f16 v[64:67], v[244:247], v[232:235], v[64:67]
ds_read_b128 v[240:243], v250 offset:16640
v_pk_fma_f16 v196, v197, v197, s48
v_bfe_u32 v184, v185, 2, 14
v_pk_mul_f16 v202, v203, v202
v_mfma_f32_16x16x32_f16 v[72:75], v[244:247], v[236:239], v[72:75]
v_bfe_u32 v186, v187, 2, 14
v_pk_mul_f16 v199, v200, v199
s_waitcnt vmcnt(5)
v_mfma_f32_16x16x32_bf16 v[56:59], v[18:21], v[44:47], v[56:59]
ds_read_b128 v[244:247], v249 offset:19712
ds_read_u16_d16 v184, v184
ds_read_u16_d16 v186, v186
v_lshrrev_b32 v185, 18, v185
v_pk_mul_f16 v196, v197, v196
v_mfma_f32_16x16x32_bf16 v[60:63], v[16:19], v[44:47], v[60:63]
v_lshrrev_b32_e64 v187, 18, v187
v_mfma_f32_16x16x32_bf16 v[172:175], v[216:219], v[96:99], 0
ds_read_u16_d16_hi v185, v185
ds_read_u16_d16_hi v187, v187
v_exp_f16 v201, v202
v_and_b32 v189, s49, v189
v_mfma_f32_16x16x32_bf16 v[180:183], v[216:219], v[100:103], 0
v_and_b32 v191, s49, v191
s_waitcnt lgkmcnt(6)
v_mfma_f32_16x16x32_f16 v[68:71], v[220:223], v[232:235], v[68:71]
ds_read_b128 v[216:219], v249 offset:20480
v_exp_f16_e64 v198, v199
v_bfe_u32 v188, v189, 2, 14
v_mfma_f32_16x16x32_f16 v[76:79], v[220:223], v[236:239], v[76:79]
v_bfe_u32 v190, v191, 2, 14
v_exp_f16_e64 v195, v196
v_mfma_f32_16x16x32_bf16 v[168:171], v[224:227], v[104:107], v[168:171]
ds_read_b128 v[220:223], v249 offset:20736
ds_read_u16_d16 v188, v188
ds_read_u16_d16 v190, v190
v_lshrrev_b32 v189, 18, v189
v_lshrrev_b32 v191, 18, v191
v_mfma_f32_16x16x32_bf16 v[176:179], v[224:227], v[108:111], v[176:179]
v_exp_f16_sdwa v201, v202 dst_sel:WORD_1 dst_unused:UNUSED_PRESERVE src0_sel:WORD_1
v_mfma_f32_16x16x32_f16 v[80:83], v[228:231], v[232:235], v[80:83]
ds_read_b128 v[224:227], v250 offset:20480
ds_read_u16_d16_hi v189, v189
ds_read_u16_d16_hi v191, v191
v_and_b32 v193, s49, v193
v_bfe_u32 v192, v193, 2, 14
v_mfma_f32_16x16x32_f16 v[88:91], v[228:231], v[236:239], v[88:91]
v_exp_f16_sdwa v198, v199 dst_sel:WORD_1 dst_unused:UNUSED_PRESERVE src0_sel:WORD_1
s_waitcnt lgkmcnt(7)
v_mfma_f32_16x16x32_f16 v[84:87], v[240:243], v[232:235], v[84:87]
ds_read_b128 v[228:231], v250 offset:20736
ds_read_u16_d16 v192, v192
v_lshrrev_b32_e64 v193, 18, v193
v_mfma_f32_16x16x32_f16 v[92:95], v[240:243], v[236:239], v[92:95]
v_exp_f16_sdwa v195, v196 dst_sel:WORD_1 dst_unused:UNUSED_PRESERVE src0_sel:WORD_1
v_pk_add_f16 v201, v201, 1.0 op_sel_hi:[1,0]
v_pk_add_f16 v198, v198, 1.0 op_sel_hi:[1,0]
v_mfma_f32_16x16x32_bf16 v[172:175], v[244:247], v[104:107], v[172:175]
ds_read_b128 v[240:243], v250 offset:21504
ds_read_u16_d16_hi v193, v193
v_pk_add_f16 v195, v195, 1.0 op_sel_hi:[1,0]
v_mfma_f32_16x16x32_bf16 v[180:183], v[244:247], v[108:111], v[180:183]
v_rcp_f16 v202, v201
s_waitcnt lgkmcnt(7)
v_mfma_f32_16x16x32_bf16 v[168:171], v[216:219], v[112:115], v[168:171]
ds_read_b128 v[244:247], v250 offset:21760
v_rcp_f16_e64 v199, v198
v_mfma_f32_16x16x32_bf16 v[176:179], v[216:219], v[116:119], v[176:179]
v_rcp_f16_e64 v196, v195
v_mfma_f32_16x16x32_bf16 v[172:175], v[220:223], v[112:115], v[172:175]
ds_read_b128 v[216:219], v250 offset:22528
v_rcp_f16_sdwa v202, v201 dst_sel:WORD_1 dst_unused:UNUSED_PRESERVE src0_sel:WORD_1
v_mfma_f32_16x16x32_bf16 v[180:183], v[220:223], v[116:119], v[180:183]
v_rcp_f16_sdwa v199, v198 dst_sel:WORD_1 dst_unused:UNUSED_PRESERVE src0_sel:WORD_1
v_or_b32 v232, v184, v185
v_or_b32 v233, v186, v187
s_waitcnt lgkmcnt(4)
v_or_b32 v234, v188, v189
v_rcp_f16_sdwa v196, v195 dst_sel:WORD_1 dst_unused:UNUSED_PRESERVE src0_sel:WORD_1
v_or_b32 v235, v190, v191
s_waitcnt lgkmcnt(2)
v_or_b32_e64 v236, v192, v193
v_pk_mul_f16 v237, v203, v202
v_pk_mul_f16 v238, v200, v199
v_pk_mul_f16 v239, v197, v196
v_mfma_f32_16x16x32_f16 v[48:51], v[224:227], v[232:235], v[48:51]
s_add_u32 s46, s68, 98304
buffer_store_dwordx4 v[160:163], v255, s[8:11], s46 offen offset:256 sc1
ds_read_b128 v[220:223], v250 offset:22784
v_cvt_pkrtz_f16_f32 v185, v168, v169
v_cvt_pkrtz_f16_f32 v187, v170, v171
v_cvt_pkrtz_f16_f32 v189, v172, v173
v_cvt_pkrtz_f16_f32 v191, v174, v175
v_mfma_f32_16x16x32_f16 v[56:59], v[224:227], v[236:239], v[56:59]
v_cvt_pkrtz_f16_f32 v193, v176, v177
v_cvt_pk_f16_f32 v203, v178, v179
v_cvt_pk_f16_f32 v200, v180, v181
v_cvt_pk_f16_f32 v197, v182, v183
v_mfma_f32_16x16x32_f16 v[52:55], v[228:231], v[232:235], v[52:55]
ds_read_b128 v[224:227], v250 offset:26624
v_pk_fma_f16 v202, v203, v203, s48
v_and_b32_e64 v185, s49, v185
v_pk_fma_f16 v199, v200, v200, s48
v_and_b32_e64 v187, s49, v187
v_mfma_f32_16x16x32_f16 v[60:63], v[228:231], v[236:239], v[60:63]
v_pk_fma_f16 v196, v197, v197, s48
v_bfe_u32 v184, v185, 2, 14
v_pk_mul_f16 v202, v203, v202
v_bfe_u32 v186, v187, 2, 14
v_mfma_f32_16x16x32_f16 v[64:67], v[240:243], v[232:235], v[64:67]
ds_read_b128 v[228:231], v250 offset:26880
ds_read_u16_d16 v184, v184
ds_read_u16_d16 v186, v186
v_pk_mul_f16 v199, v200, v199
v_lshrrev_b32_e64 v185, 18, v185
v_pk_mul_f16 v196, v197, v196
v_lshrrev_b32_e64 v187, 18, v187
v_mfma_f32_16x16x32_f16 v[72:75], v[240:243], v[236:239], v[72:75]
v_exp_f16 v201, v202
v_and_b32 v189, s49, v189
v_and_b32 v191, s49, v191
s_waitcnt vmcnt(4)
v_mfma_f32_16x16x32_bf16 v[72:75], v[18:21], v[40:43], v[72:75]
ds_read_b128 v[240:243], v250 offset:27648
ds_read_u16_d16_hi v185, v185
ds_read_u16_d16_hi v187, v187
v_exp_f16_e64 v198, v199
v_bfe_u32 v188, v189, 2, 14
v_bfe_u32 v190, v191, 2, 14
v_mfma_f32_16x16x32_bf16 v[76:79], v[16:19], v[40:43], v[76:79]
v_exp_f16 v195, v196
v_lshrrev_b32 v189, 18, v189
v_lshrrev_b32 v191, 18, v191
s_waitcnt lgkmcnt(6)
v_mfma_f32_16x16x32_f16 v[68:71], v[244:247], v[232:235], v[68:71]
ds_read_u16_d16 v188, v188
ds_read_u16_d16 v190, v190
ds_read_u16_d16_hi v189, v189
ds_read_u16_d16_hi v191, v191
v_exp_f16_sdwa v201, v202 dst_sel:WORD_1 dst_unused:UNUSED_PRESERVE src0_sel:WORD_1
v_and_b32_e64 v193, s49, v193
v_bfe_u32 v192, v193, 2, 14
v_mfma_f32_16x16x32_f16 v[76:79], v[244:247], v[236:239], v[76:79]
v_exp_f16_sdwa v198, v199 dst_sel:WORD_1 dst_unused:UNUSED_PRESERVE src0_sel:WORD_1
v_lshrrev_b32_e64 v193, 18, v193
v_mfma_f32_16x16x32_f16 v[80:83], v[216:219], v[232:235], v[80:83]
ds_read_b128 v[244:247], v250 offset:27904
ds_read_u16_d16 v192, v192
ds_read_u16_d16_hi v193, v193
v_exp_f16_sdwa v195, v196 dst_sel:WORD_1 dst_unused:UNUSED_PRESERVE src0_sel:WORD_1
v_pk_add_f16 v201, v201, 1.0 op_sel_hi:[1,0]
v_pk_add_f16 v198, v198, 1.0 op_sel_hi:[1,0]
v_pk_add_f16 v195, v195, 1.0 op_sel_hi:[1,0]
v_mfma_f32_16x16x32_f16 v[88:91], v[216:219], v[236:239], v[88:91]
v_rcp_f16 v202, v201
v_rcp_f16 v199, v198
v_mfma_f32_16x16x32_f16 v[84:87], v[220:223], v[232:235], v[84:87]
ds_read_b128 v[216:219], v250 offset:28672
v_rcp_f16_e64 v196, v195
v_rcp_f16_sdwa v202, v201 dst_sel:WORD_1 dst_unused:UNUSED_PRESERVE src0_sel:WORD_1
v_mfma_f32_16x16x32_f16 v[92:95], v[220:223], v[236:239], v[92:95]
v_rcp_f16_sdwa v199, v198 dst_sel:WORD_1 dst_unused:UNUSED_PRESERVE src0_sel:WORD_1
s_waitcnt lgkmcnt(5)
v_or_b32 v232, v184, v185
v_or_b32_e64 v233, v186, v187
v_or_b32 v234, v188, v189
v_rcp_f16_sdwa v196, v195 dst_sel:WORD_1 dst_unused:UNUSED_PRESERVE src0_sel:WORD_1
s_waitcnt lgkmcnt(4)
v_or_b32 v235, v190, v191
s_waitcnt lgkmcnt(1)
v_or_b32 v236, v192, v193
v_pk_mul_f16 v237, v203, v202
v_pk_mul_f16 v238, v200, v199
v_pk_mul_f16 v239, v197, v196
v_mfma_f32_16x16x32_f16 v[48:51], v[224:227], v[232:235], v[48:51]
ds_read_b128 v[220:223], v250 offset:28928
v_mfma_f32_16x16x32_f16 v[56:59], v[224:227], v[236:239], v[56:59]
v_mfma_f32_16x16x32_f16 v[52:55], v[228:231], v[232:235], v[52:55]
v_mfma_f32_16x16x32_f16 v[60:63], v[228:231], v[236:239], v[60:63]
v_mfma_f32_16x16x32_f16 v[64:67], v[240:243], v[232:235], v[64:67]
v_mfma_f32_16x16x32_f16 v[72:75], v[240:243], v[236:239], v[72:75]
s_waitcnt vmcnt(3)
v_mfma_f32_16x16x32_bf16 v[88:91], v[18:21], v[208:211], v[88:91]
v_mfma_f32_16x16x32_bf16 v[92:95], v[16:19], v[208:211], v[92:95]
v_mfma_f32_16x16x32_f16 v[68:71], v[244:247], v[232:235], v[68:71]
v_mfma_f32_16x16x32_f16 v[76:79], v[244:247], v[236:239], v[76:79]
s_waitcnt lgkmcnt(1)
v_mfma_f32_16x16x32_f16 v[80:83], v[216:219], v[232:235], v[80:83]
v_mfma_f32_16x16x32_f16 v[88:91], v[216:219], v[236:239], v[88:91]
s_waitcnt lgkmcnt(0)
v_mfma_f32_16x16x32_f16 v[84:87], v[220:223], v[232:235], v[84:87]
v_mfma_f32_16x16x32_f16 v[92:95], v[220:223], v[236:239], v[92:95]
v_cvt_pk_bf16_f32 v64, v64, v65
v_cvt_pk_bf16_f32 v65, v66, v67
v_cvt_pk_bf16_f32 v66, v68, v69
v_cvt_pk_bf16_f32 v67, v70, v71
v_cvt_pk_bf16_f32 v48, v48, v49
v_cvt_pk_bf16_f32 v49, v50, v51
v_cvt_pk_bf16_f32 v50, v52, v53
v_cvt_pk_bf16_f32 v51, v54, v55
v_cvt_pk_bf16_f32 v80, v80, v81
v_cvt_pk_bf16_f32 v81, v82, v83
v_cvt_pk_bf16_f32 v82, v84, v85
v_cvt_pk_bf16_f32 v83, v86, v87
s_mov_b64 vcc, s[74:75]
v_cndmask_b32 v68, v48, v80, vcc
v_cndmask_b32 v69, v49, v81, vcc
v_cndmask_b32 v70, v50, v82, vcc
v_cndmask_b32 v71, v51, v83, vcc
v_cndmask_b32_dpp v48, v64, v48, vcc quad_perm:[1,0,3,2] row_mask:0xf bank_mask:0xf
v_cndmask_b32_dpp v49, v65, v49, vcc quad_perm:[1,0,3,2] row_mask:0xf bank_mask:0xf
v_cndmask_b32_dpp v50, v66, v50, vcc quad_perm:[1,0,3,2] row_mask:0xf bank_mask:0xf
v_cndmask_b32_dpp v51, v67, v51, vcc quad_perm:[1,0,3,2] row_mask:0xf bank_mask:0xf
s_not_b64 vcc, s[74:75]
v_cndmask_b32_dpp v80, v64, v80, vcc quad_perm:[1,0,3,2] row_mask:0xf bank_mask:0xf
v_cndmask_b32_dpp v81, v65, v81, vcc quad_perm:[1,0,3,2] row_mask:0xf bank_mask:0xf
v_cndmask_b32_dpp v82, v66, v82, vcc quad_perm:[1,0,3,2] row_mask:0xf bank_mask:0xf
v_cndmask_b32_dpp v83, v67, v83, vcc quad_perm:[1,0,3,2] row_mask:0xf bank_mask:0xf
buffer_store_dwordx4 v[48:51], v255, s[8:11], s69 offen sc1
buffer_store_dwordx4 v[68:71], v255, s[8:11], s69 offen offset:128 sc1
buffer_store_dwordx4 v[80:83], v255, s[8:11], s69 offen offset:256 sc1
v_cvt_pk_bf16_f32 v72, v72, v73
v_cvt_pk_bf16_f32 v73, v74, v75
v_cvt_pk_bf16_f32 v74, v76, v77
v_cvt_pk_bf16_f32 v75, v78, v79
v_cvt_pk_bf16_f32 v56, v56, v57
v_cvt_pk_bf16_f32 v57, v58, v59
v_cvt_pk_bf16_f32 v58, v60, v61
v_cvt_pk_bf16_f32 v59, v62, v63
v_cvt_pk_bf16_f32 v88, v88, v89
v_cvt_pk_bf16_f32 v89, v90, v91
v_cvt_pk_bf16_f32 v90, v92, v93
v_cvt_pk_bf16_f32 v91, v94, v95
s_mov_b64 vcc, s[74:75]
v_cndmask_b32 v76, v56, v88, vcc
v_cndmask_b32 v77, v57, v89, vcc
v_cndmask_b32 v78, v58, v90, vcc
v_cndmask_b32 v79, v59, v91, vcc
v_cndmask_b32_dpp v56, v72, v56, vcc quad_perm:[1,0,3,2] row_mask:0xf bank_mask:0xf
v_cndmask_b32_dpp v57, v73, v57, vcc quad_perm:[1,0,3,2] row_mask:0xf bank_mask:0xf
v_cndmask_b32_dpp v58, v74, v58, vcc quad_perm:[1,0,3,2] row_mask:0xf bank_mask:0xf
v_cndmask_b32_dpp v59, v75, v59, vcc quad_perm:[1,0,3,2] row_mask:0xf bank_mask:0xf
s_not_b64 vcc, s[74:75]
v_cndmask_b32_dpp v88, v72, v88, vcc quad_perm:[1,0,3,2] row_mask:0xf bank_mask:0xf
v_cndmask_b32_dpp v89, v73, v89, vcc quad_perm:[1,0,3,2] row_mask:0xf bank_mask:0xf
v_cndmask_b32_dpp v90, v74, v90, vcc quad_perm:[1,0,3,2] row_mask:0xf bank_mask:0xf
v_cndmask_b32_dpp v91, v75, v91, vcc quad_perm:[1,0,3,2] row_mask:0xf bank_mask:0xf
s_add_u32 s46, s69, 98304
buffer_store_dwordx4 v[56:59], v255, s[8:11], s46 offen sc1
s_add_u32 s46, s69, 98304
buffer_store_dwordx4 v[76:79], v255, s[8:11], s46 offen offset:128 sc1
s_add_u32 s46, s69, 98304
buffer_store_dwordx4 v[88:91], v255, s[8:11], s46 offen offset:256 sc1
s_endpgm
Lpoll:
s_waitcnt vmcnt(0)
Lpoll1:
s_cmp_eq_u32 s77, 2
s_cbranch_scc1 LpollC
v_max_u32 v255, v156, v157
v_max3_u32 v255, v255, v158, v159
v_max3_u32 v255, v255, v160, v161
v_max3_u32 v255, v255, v162, v163
v_max3_u32 v255, v255, v164, v165
v_max3_u32 v255, v255, v166, v167
v_max3_u32 v255, v255, v240, v241
v_max3_u32 v255, v255, v242, v243
v_cmp_eq_u32 vcc, -1, v255
s_nop 4
s_cbranch_vccz LpollR
v_lshlrev_b32 v247, 4, v251
s_lshl_b32 s44, s2, 12
buffer_load_dwordx4 v[156:159], v247, s[32:35], s44 offen sc1
buffer_load_dwordx4 v[160:163], v247, s[32:35], s44 offen offset:1024 sc1
buffer_load_dwordx4 v[164:167], v247, s[32:35], s44 offen offset:2048 sc1
buffer_load_dwordx4 v[240:243], v247, s[32:35], s44 offen offset:3072 sc1
s_setpc_b64 s[78:79]
LpollR:
s_setprio 3
v_add_f32 v156, v156, v160
v_add_f32 v240, v164, v240
v_add_f32 v240, v156, v240
v_add_f32 v157, v157, v161
v_add_f32 v241, v165, v241
v_add_f32 v241, v157, v241
v_add_f32 v158, v158, v162
v_add_f32 v242, v166, v242
v_add_f32 v242, v158, v242
v_add_f32 v159, v159, v163
v_add_f32 v243, v167, v243
v_add_f32 v243, v159, v243
v_add_f32_dpp v240, v240, v240 row_ror:8 row_mask:0xf bank_mask:0xf
s_nop 1
v_add_f32_dpp v240, v240, v240 row_ror:4 row_mask:0xf bank_mask:0xf
s_nop 1
v_add_f32_dpp v240, v240, v240 row_ror:2 row_mask:0xf bank_mask:0xf
s_nop 1
v_add_f32_dpp v240, v240, v240 row_ror:1 row_mask:0xf bank_mask:0xf
v_mov_b32 v255, v240
s_nop 1
v_permlane16_swap_b32 v240, v255
v_add_f32 v240, v240, v255
v_mov_b32 v255, v240
s_nop 1
v_permlane32_swap_b32 v240, v255
v_add_f32 v240, v240, v255
v_min_u32 v240, -2, v240
v_add_f32_dpp v241, v241, v241 row_ror:8 row_mask:0xf bank_mask:0xf
s_nop 1
v_add_f32_dpp v241, v241, v241 row_ror:4 row_mask:0xf bank_mask:0xf
s_nop 1
v_add_f32_dpp v241, v241, v241 row_ror:2 row_mask:0xf bank_mask:0xf
s_nop 1
v_add_f32_dpp v241, v241, v241 row_ror:1 row_mask:0xf bank_mask:0xf
v_mov_b32 v255, v241
s_nop 1
v_permlane16_swap_b32 v241, v255
v_add_f32 v241, v241, v255
v_mov_b32 v255, v241
s_nop 1
v_permlane32_swap_b32 v241, v255
v_add_f32 v241, v241, v255
v_min_u32 v241, -2, v241
v_add_f32_dpp v242, v242, v242 row_ror:8 row_mask:0xf bank_mask:0xf
s_nop 1
v_add_f32_dpp v242, v242, v242 row_ror:4 row_mask:0xf bank_mask:0xf
s_nop 1
v_add_f32_dpp v242, v242, v242 row_ror:2 row_mask:0xf bank_mask:0xf
s_nop 1
v_add_f32_dpp v242, v242, v242 row_ror:1 row_mask:0xf bank_mask:0xf
v_mov_b32 v255, v242
s_nop 1
v_permlane16_swap_b32 v242, v255
v_add_f32 v242, v242, v255
v_mov_b32 v255, v242
s_nop 1
v_permlane32_swap_b32 v242, v255
v_add_f32 v242, v242, v255
v_min_u32 v242, -2, v242
v_add_f32_dpp v243, v243, v243 row_ror:8 row_mask:0xf bank_mask:0xf
s_nop 1
v_add_f32_dpp v243, v243, v243 row_ror:4 row_mask:0xf bank_mask:0xf
s_nop 1
v_add_f32_dpp v243, v243, v243 row_ror:2 row_mask:0xf bank_mask:0xf
s_nop 1
v_add_f32_dpp v243, v243, v243 row_ror:1 row_mask:0xf bank_mask:0xf
v_mov_b32 v255, v243
s_nop 1
v_permlane16_swap_b32 v243, v255
v_add_f32 v243, v243, v255
v_mov_b32 v255, v243
s_nop 1
v_permlane32_swap_b32 v243, v255
v_add_f32_e64 v243, v243, v255
v_min_u32 v243, -2, v243
s_lshl_b32 s44, s2, 4
s_add_u32 s44, s44, 393216
v_lshlrev_b32_e64 v255, 11, v251
s_mov_b64 exec, 0xff
buffer_store_dwordx4 v[240:243], v255, s[32:35], s44 offen sc1
s_mov_b64 exec, -1
s_cmp_eq_u32 s40, 0
s_cselect_b32 s77, 2, 0
s_cbranch_scc0 LpollRx
v_lshlrev_b32_e64 v247, 3, v251
s_and_b32 s44, s2, 7
s_lshl_b32 s44, s44, 11
s_add_u32 s44, s44, 393216
buffer_load_dwordx2 v[156:157], v247, s[32:35], s44 offen sc1
buffer_load_dwordx2 v[158:159], v247, s[32:35], s44 offen offset:512 sc1
buffer_load_dwordx2 v[160:161], v247, s[32:35], s44 offen offset:1024 sc1
LpollRx:
s_setpc_b64 s[78:79]
LpollC:
v_max3_u32 v255, v156, v157, v158
v_max3_u32 v255, v255, v159, v160
v_max_u32 v255, v255, v161
v_cmp_eq_u32 vcc, -1, v255
s_nop 4
s_cbranch_vccz LpollS
v_lshlrev_b32 v247, 3, v251
s_and_b32 s44, s2, 7
s_lshl_b32 s44, s44, 11
s_add_u32 s44, s44, 393216
buffer_load_dwordx2 v[156:157], v247, s[32:35], s44 offen sc1
buffer_load_dwordx2 v[158:159], v247, s[32:35], s44 offen offset:512 sc1
buffer_load_dwordx2 v[160:161], v247, s[32:35], s44 offen offset:1024 sc1
s_setpc_b64 s[78:79]
LpollS:
s_setprio 3
s_mov_b32 s43, 1083296634
v_mov_b32 v162, 897988541
v_fma_f32 v156, v156, s43, v162
v_fma_f32 v157, v157, s43, v162
v_fma_f32 v158, v158, s43, v162
v_fma_f32 v159, v159, s43, v162
v_fma_f32 v160, v160, s43, v162
v_fma_f32 v161, v161, s43, v162
v_sqrt_f32 v156, v156
v_sqrt_f32 v157, v157
v_sqrt_f32 v158, v158
v_sqrt_f32 v159, v159
v_sqrt_f32 v160, v160
v_sqrt_f32 v161, v161
v_add_f32 v163, v156, v157
v_add_f32 v163, v163, v158
v_add_f32 v163, v163, v159
v_add_f32 v163, v163, v160
v_add_f32 v163, v163, v161
s_nop 1
v_add_f32_dpp v163, v163, v163 row_ror:8 row_mask:0xf bank_mask:0xf
s_nop 1
v_add_f32_dpp v163, v163, v163 row_ror:4 row_mask:0xf bank_mask:0xf
s_nop 1
v_add_f32_dpp v163, v163, v163 row_ror:2 row_mask:0xf bank_mask:0xf
s_nop 1
v_add_f32_dpp v163, v163, v163 row_ror:1 row_mask:0xf bank_mask:0xf
v_mov_b32 v255, v163
s_nop 1
v_permlane16_swap_b32 v163, v255
v_add_f32 v163, v163, v255
v_mov_b32 v255, v163
s_nop 1
v_permlane32_swap_b32 v163, v255
v_add_f32_e64 v163, v163, v255
s_mov_b32 s43, 992651947
v_fma_f32 v163, v163, s43, v162
v_rcp_f32_e64 v163, v163
v_mov_b32 v162, 3221789604
v_mul_f32 v163, v163, v162
v_lshlrev_b32 v164, 16, v244
v_and_b32 v165, 4294901760, v244
v_mul_f32 v156, v156, v163
v_mul_f32 v157, v157, v163
v_fma_f32 v164, v164, v156, v162
v_fma_f32 v165, v165, v157, v162
v_cvt_pk_f16_f32 v244, v164, v165
v_lshlrev_b32_e64 v164, 16, v245
v_and_b32 v165, 4294901760, v245
v_mul_f32 v158, v158, v163
v_mul_f32 v159, v159, v163
v_fma_f32 v164, v164, v158, v162
v_fma_f32 v165, v165, v159, v162
v_cvt_pk_f16_f32 v245, v164, v165
v_lshlrev_b32_e64 v164, 16, v246
v_and_b32 v165, 4294901760, v246
v_mul_f32 v160, v160, v163
v_mul_f32 v161, v161, v163
v_fma_f32 v164, v164, v160, v162
v_fma_f32 v165, v165, v161, v162
v_cvt_pk_f16_f32 v246, v164, v165
s_mov_b32 s77, 0
s_setpc_b64 s[78:79]
Lend:
s_endpgm

.section .rodata,"a"
.p2align 6
.amdhsa_kernel standalone__modern_conv_block_convnext_v2__vision_kernel
  .amdhsa_next_free_vgpr 256
  .amdhsa_next_free_sgpr 102
  .amdhsa_accum_offset 256
  .amdhsa_group_segment_fixed_size 0
  .amdhsa_kernarg_size 72
  .amdhsa_user_sgpr_count 2
  .amdhsa_user_sgpr_kernarg_segment_ptr 1
  .amdhsa_system_sgpr_workgroup_id_x 1
.end_amdhsa_kernel
```

```asm
; @launch grid=(256,1,1) block=(512,1,1) lds=163840
.amdgcn_target "amdgcn-amd-amdhsa--gfx950"
.text
.globl standalone__modern_conv_block_convnext_v2__vision_kernel
.p2align 8
.type standalone__modern_conv_block_convnext_v2__vision_kernel,@function
standalone__modern_conv_block_convnext_v2__vision_kernel:
Lmain:
s_cmp_ge_u32 s2, 256
s_cbranch_scc1 Lend
s_load_dwordx16 s[80:95], s[0:1], 0
s_load_dwordx2 s[96:97], s[0:1], 64
s_getpc_b64 s[74:75]
Lpc0:
s_sub_u32 s74, s74, Lpc0-Lmain
s_subb_u32 s75, s75, 0
v_lshlrev_b32 v159, 7, v0
s_movk_i32 s43, 64
v_cmp_gt_u32 vcc, s43, v0
s_and_saveexec_b64 s[78:79], vcc
s_cbranch_execz Lpf0x
global_load_dword v255, v159, s[74:75]
Lpf0x:
s_mov_b64 exec, s[78:79]
v_mov_b32 v199, v0
v_and_b32 v251, 63, v0
v_lshrrev_b32 v120, 6, v0
s_nop 0
v_readfirstlane_b32 s40, v120
s_and_b32 s43, s2, 7
s_lshr_b32 s44, s2, 3
s_and_b32 s41, s43, 0
s_lshl_b32 s41, s41, 4
s_and_b32 s45, s44, 15
s_add_u32 s41, s41, s45
s_lshr_b32 s42, s43, 0
s_lshl_b32 s42, s42, 1
s_lshr_b32 s45, s44, 4
s_add_u32 s42, s42, s45
s_lshl_b32 s41, s41, 5
s_lshl_b32 s42, s42, 5
s_lshl_b32 s67, s40, 6
s_cmp_eq_u32 s40, 6
s_cselect_b32 s67, 352, s67
v_add_u32_e64 v125, s67, v251
v_mul_u32_u24 v121, 5462, v125
v_lshrrev_b32 v121, 16, v121
v_mul_u32_u24 v122, 12, v121
v_sub_u32 v122, v125, v122
v_bfe_u32 v123, v121, 2, 2
v_xor_b32 v122, v122, v123
v_add_u32 v123, s41, v121
v_subrev_u32 v123, 1, v123
v_mul_u32_u24 v124, 192, v123
v_lshl_add_u32 v124, v122, 4, v124
v_mov_b32 v240, 2147483648
s_movk_i32 s43, 512
v_cmp_gt_u32 vcc, s43, v123
s_nop 1
v_cndmask_b32 v124, v240, v124, vcc
v_cmp_gt_u32 vcc, 34, v121
s_nop 1
v_cndmask_b32 v240, v240, v124, vcc
s_add_i32 s43, s42, -1
s_mul_i32 s44, s43, 98304
s_cmp_lt_u32 s43, 512
s_cselect_b32 s46, s44, 1073741824
s_mul_i32 s66, s42, 98304
s_mov_b32 s6, 50331648
s_mov_b32 s7, 131072
s_lshl_b32 s67, s67, 4
s_add_u32 s67, s67, 90112
s_cmp_eq_u32 s40, 7
s_cselect_b32 s67, 163840, s67
v_lshlrev_b32 v130, 1, v199
v_add_u32 v155, 768, v199
v_min_u32 v155, 863, v155
v_lshlrev_b32_e64 v131, 1, v155
s_waitcnt lgkmcnt(0)
s_mov_b32 s4, s80
s_and_b32 s5, s81, 65535
s_cmp_ge_u32 s40, 4
s_cbranch_scc1 Lnodw
s_mov_b32 s20, s82
s_and_b32 s21, s83, 65535
s_mov_b32 s22, 1728
s_mov_b32 s23, 131072
buffer_load_ushort v126, v130, s[20:23], 0 offen offset:0
buffer_load_ushort v127, v130, s[20:23], 0 offen offset:512
buffer_load_ushort v128, v130, s[20:23], 0 offen offset:1024
buffer_load_ushort v129, v131, s[20:23], 0 offen offset:0
Lnodw:
s_cmp_eq_u32 s40, 7
s_cbranch_scc1 Lskipx0
s_add_u32 m0, s67, 0
s_nop 0
buffer_load_dwordx4 v240, s[4:7], s46 offen nt lds
s_add_u32 m0, s67, 6656
s_nop 0
buffer_load_dwordx4 v240, s[4:7], s66 offen nt lds
s_add_u32 m0, s67, 13312
s_add_u32 s45, s66, 98304
buffer_load_dwordx4 v240, s[4:7], s45 offen nt lds
s_add_u32 m0, s67, 19968
s_add_u32 s45, s66, 196608
buffer_load_dwordx4 v240, s[4:7], s45 offen nt lds
s_add_u32 m0, s67, 26624
s_add_u32 s45, s66, 294912
buffer_load_dwordx4 v240, s[4:7], s45 offen nt lds
s_add_u32 m0, s67, 33280
s_add_u32 s45, s66, 393216
buffer_load_dwordx4 v240, s[4:7], s45 offen nt lds
Lskipx0:
s_mov_b32 s12, s84
s_and_b32 s13, s85, 65535
s_mov_b32 s14, 73728
s_mov_b32 s15, 131072
v_lshrrev_b32 v189, 2, v251
v_mul_u32_u24 v189, 768, v189
v_and_b32_e64 v125, 3, v251
v_lshl_add_u32 v189, v125, 4, v189
s_and_b32 s43, s40, 3
s_lshl_b32 s3, s43, 6
s_mul_i32 s77, s43, 6144
s_add_u32 s77, s77, 16384
v_mov_b32 v253, 16256
v_mov_b32 v254, 1
s_add_u32 s43, s42, s40
s_add_u32 s43, s43, 1
s_lshl_b32 s43, s43, 9
s_add_u32 s43, s43, s41
s_mul_i32 s47, s43, 192
s_sub_u32 s47, s47, 256
s_and_b32 s43, s40, 1
s_lshl_b32 s46, s43, 4
s_add_u32 s41, s41, s46
s_and_b32 s43, s40, 6
s_add_u32 s42, s42, s43
s_mul_i32 s45, s43, 6656
s_add_u32 s45, s45, 90112
v_and_b32 v131, 15, v251
v_lshrrev_b32 v132, 4, v251
v_mul_u32_u24 v122, 6656, v132
v_add_u32 v122, s45, v122
v_add_u32 v121, s46, v131
v_mul_u32_u24 v123, 192, v121
v_bfe_u32 v124, v121, 2, 2
v_lshl_add_u32 v123, v124, 4, v123
v_add_u32 v242, v122, v123
v_add_u32 v121, 1, v121
v_mul_u32_u24 v123, 192, v121
v_bfe_u32 v124, v121, 2, 2
v_lshl_add_u32 v123, v124, 4, v123
v_add_u32 v243, v122, v123
v_add_u32 v121, 1, v121
v_mul_u32_u24 v123, 192, v121
v_bfe_u32 v124, v121, 2, 2
v_lshl_add_u32 v123, v124, 4, v123
v_add_u32_e64 v244, v122, v123
s_mul_i32 s72, s40, 9216
s_add_u32 s72, s72, 90112
v_bfe_u32 v133, v131, 2, 1
v_sub_u32 v133, v132, v133
v_lshrrev_b32 v134, 3, v131
v_and_b32_e64 v135, 3, v131
v_lshl_add_u32 v135, v134, 2, v135
v_lshlrev_b32_e64 v136, 7, v133
v_lshl_add_u32 v136, v135, 4, v136
v_add_u32 v136, 156672, v136
v_mov_b32 v135, 163840
v_cmp_gt_u32 vcc, 3, v133
s_nop 1
v_cndmask_b32 v245, v135, v136, vcc
v_and_b32 v135, 3, v131
v_mul_u32_u24 v246, 85, v135
s_mov_b32 s16, s86
s_and_b32 s17, s87, 65535
s_mov_b32 s18, 73728
s_mov_b32 s19, 131072
s_mov_b32 s24, s88
s_and_b32 s25, s89, 65535
s_mov_b32 s26, 768
s_mov_b32 s27, 131072
s_mov_b32 s28, s90
s_and_b32 s29, s91, 65535
s_mov_b32 s30, 768
s_mov_b32 s31, 131072
s_mov_b32 s8, s92
s_and_b32 s9, s93, 65535
s_mov_b32 s10, 50331648
s_mov_b32 s11, 131072
s_mov_b32 s36, s94
s_and_b32 s37, s95, 65535
s_mov_b32 s38, 256
s_mov_b32 s39, 131072
s_mov_b32 s32, s96
s_and_b32 s33, s97, 65535
s_mov_b32 s34, 83886080
s_mov_b32 s35, 131072
v_lshlrev_b32 v241, 4, v251
v_and_b32 v133, 35, v251
v_bfe_u32 v134, v251, 2, 2
v_lshl_add_u32 v133, v134, 3, v133
v_bfe_u32 v134, v251, 4, 1
v_lshl_add_u32 v133, v134, 2, v133
v_lshlrev_b32_e64 v248, 4, v133
v_add_u32 v249, 65536, v248
v_add_u32 v250, 131072, v248
s_lshl_b32 s73, s2, 3
s_add_u32 s73, s73, s40
s_lshl_b32 s80, s73, 10
s_add_u32 s80, s80, 4194304
s_mul_i32 s73, s73, 16
s_add_u32 s73, s73, 1048576
s_mul_i32 s46, s41, 192
s_add_u32 s43, s42, 0
s_mul_i32 s43, s43, 98304
s_add_u32 s68, s43, s46
s_add_u32 s43, s42, 8
s_mul_i32 s43, s43, 98304
s_add_u32 s69, s43, s46
s_add_u32 s43, s42, 16
s_mul_i32 s43, s43, 98304
s_add_u32 s70, s43, s46
s_add_u32 s43, s42, 24
s_mul_i32 s43, s43, 98304
s_add_u32 s71, s43, s46
s_mul_i32 s82, s40, 9216
s_mov_b32 s48, 1156203754
s_mov_b32 s49, 4294508536
s_mov_b32 s76, 400000
v_lshrrev_b32 v148, 5, v251
v_lshlrev_b32 v190, 8, v148
v_bfe_u32 v148, v251, 2, 2
v_lshl_add_u32 v190, v148, 6, v190
v_bfe_u32 v148, v251, 4, 1
v_lshl_add_u32 v190, v148, 5, v190
v_bfe_u32 v148, v251, 0, 1
v_lshl_add_u32 v190, v148, 4, v190
v_bfe_u32 v148, v251, 1, 1
v_lshl_add_u32 v190, v148, 3, v190
v_add_u32 v190, s77, v190
v_add_u32 v191, s77, v248
s_cmp_lt_u32 s40, 4
s_cbranch_scc1 Lnoy
v_lshlrev_b32_e64 v24, 6, v199
s_mov_b32 s43, 1065362610
v_mov_b32 v25, 1084047360
v_add_u32 v0, 32772, v24
v_add_u32 v1, 32780, v24
v_add_u32 v2, 32788, v24
v_add_u32 v3, 32796, v24
v_add_u32 v4, 32804, v24
v_add_u32 v5, 32812, v24
v_add_u32 v6, 32820, v24
v_add_u32 v7, 32828, v24
v_cvt_f32_f16 v0, v0
v_cvt_f32_f16 v1, v1
v_cvt_f32_f16 v2, v2
v_cvt_f32_f16 v3, v3
v_cvt_f32_f16 v4, v4
v_cvt_f32_f16 v5, v5
v_cvt_f32_f16 v6, v6
v_cvt_f32_f16 v7, v7
v_mul_f32 v8, v0, v0
v_mul_f32 v9, v1, v1
v_mul_f32 v10, v2, v2
v_mul_f32 v11, v3, v3
v_mul_f32 v12, v4, v4
v_mul_f32 v13, v5, v5
v_mul_f32 v14, v6, v6
v_mul_f32 v15, v7, v7
v_fma_f32 v8, v8, s43, v25
v_fma_f32 v9, v9, s43, v25
v_fma_f32 v10, v10, s43, v25
v_fma_f32 v11, v11, s43, v25
v_fma_f32 v12, v12, s43, v25
v_fma_f32 v13, v13, s43, v25
v_fma_f32 v14, v14, s43, v25
v_fma_f32 v15, v15, s43, v25
v_mul_f32 v8, v0, v8
v_mul_f32 v9, v1, v9
v_mul_f32 v10, v2, v10
v_mul_f32 v11, v3, v11
v_mul_f32 v12, v4, v12
v_mul_f32 v13, v5, v13
v_mul_f32 v14, v6, v14
v_mul_f32 v15, v7, v15
v_exp_f32 v8, v8
v_exp_f32 v9, v9
v_exp_f32 v10, v10
v_exp_f32 v11, v11
v_exp_f32 v12, v12
v_exp_f32 v13, v13
v_exp_f32 v14, v14
v_exp_f32 v15, v15
v_add_f32 v16, 1.0, v8
v_add_f32 v17, 1.0, v9
v_add_f32 v18, 1.0, v10
v_add_f32 v19, 1.0, v11
v_add_f32 v20, 1.0, v12
v_add_f32 v21, 1.0, v13
v_add_f32 v22, 1.0, v14
v_add_f32 v23, 1.0, v15
v_rcp_f32 v16, v16
v_rcp_f32 v17, v17
v_rcp_f32 v18, v18
v_rcp_f32 v19, v19
v_rcp_f32 v20, v20
v_rcp_f32 v21, v21
v_rcp_f32 v22, v22
v_rcp_f32 v23, v23
v_mul_f32 v0, v0, v16
v_mul_f32 v1, v1, v17
v_mul_f32 v2, v2, v18
v_mul_f32 v3, v3, v19
v_mul_f32 v4, v4, v20
v_mul_f32 v5, v5, v21
v_mul_f32 v6, v6, v22
v_mul_f32 v7, v7, v23
v_mul_f32 v8, v8, v0
v_mul_f32 v9, v9, v1
v_mul_f32 v10, v10, v2
v_mul_f32 v11, v11, v3
v_mul_f32 v12, v12, v4
v_mul_f32 v13, v13, v5
v_mul_f32 v14, v14, v6
v_mul_f32 v15, v15, v7
v_cvt_pk_f16_f32 v28, v0, v1
v_cvt_pk_f16_f32 v32, -v8, -v9
v_cvt_pk_f16_f32 v29, v2, v3
v_cvt_pk_f16_f32 v33, -v10, -v11
v_cvt_pk_f16_f32 v30, v4, v5
v_cvt_pk_f16_f32 v34, -v12, -v13
v_cvt_pk_f16_f32 v31, v6, v7
v_cvt_pk_f16_f32 v35, -v14, -v15
v_lshlrev_b32_e64 v24, 4, v199
v_mov_b32 v25, 163840
s_movk_i32 s43, 496
v_cmp_gt_u32 vcc, s43, v199
s_nop 1
v_cndmask_b32 v24, v25, v24, vcc
ds_write_b128 v24, v[32:35]
ds_write_b128 v24, v[28:31] offset:8192
Lnoy:
s_cmp_ge_u32 s40, 4
s_cbranch_scc1 Lnoo
v_add_u32_e64 v152, 0, v199
v_mul_u32_u24 v140, 683, v152
v_lshrrev_b32 v140, 16, v140
v_mul_u32_u24 v142, 11, v140
v_lshrrev_b32 v142, 5, v142
v_lshrrev_b32 v143, 5, v152
v_bfe_u32 v141, v152, 3, 2
v_bfe_u32 v144, v152, 4, 1
v_xor_b32 v141, v141, v144
v_sub_u32 v141, v141, v142
v_mul_i32_i24 v141, 9, v141
v_add_u32 v143, v143, v141
v_lshrrev_b32_e64 v141, 1, v143
v_mul_u32_u24 v141, 368, v141
v_lshl_add_u32 v143, v143, 3, v141
v_lshl_add_u32 v143, v142, 7, v143
v_and_b32_e64 v144, 7, v152
v_lshl_add_u32 v143, v144, 4, v143
v_add_u32 v156, 156672, v143
v_add_u32 v153, 256, v199
v_mul_u32_u24 v140, 683, v153
v_lshrrev_b32 v140, 16, v140
v_mul_u32_u24 v142, 11, v140
v_lshrrev_b32 v142, 5, v142
v_lshrrev_b32 v143, 5, v153
v_bfe_u32 v141, v153, 3, 2
v_bfe_u32 v144, v153, 4, 1
v_xor_b32 v141, v141, v144
v_sub_u32 v141, v141, v142
v_mul_i32_i24 v141, 9, v141
v_add_u32 v143, v143, v141
v_lshrrev_b32_e64 v141, 1, v143
v_mul_u32_u24 v141, 368, v141
v_lshl_add_u32 v143, v143, 3, v141
v_lshl_add_u32 v143, v142, 7, v143
v_and_b32_e64 v144, 7, v153
v_lshl_add_u32 v143, v144, 4, v143
v_add_u32 v157, 156672, v143
v_add_u32 v154, 512, v199
v_mul_u32_u24 v140, 683, v154
v_lshrrev_b32 v140, 16, v140
v_mul_u32_u24 v142, 11, v140
v_lshrrev_b32 v142, 5, v142
v_lshrrev_b32 v143, 5, v154
v_bfe_u32 v141, v154, 3, 2
v_bfe_u32 v144, v154, 4, 1
v_xor_b32 v141, v141, v144
v_sub_u32 v141, v141, v142
v_mul_i32_i24 v141, 9, v141
v_add_u32 v143, v143, v141
v_lshrrev_b32_e64 v141, 1, v143
v_mul_u32_u24 v141, 368, v141
v_lshl_add_u32 v143, v143, 3, v141
v_lshl_add_u32 v143, v142, 7, v143
v_and_b32_e64 v144, 7, v154
v_lshl_add_u32 v143, v144, 4, v143
v_add_u32 v158, 156672, v143
v_mul_u32_u24 v140, 683, v155
v_lshrrev_b32 v140, 16, v140
v_mul_u32_u24 v142, 11, v140
v_lshrrev_b32 v142, 5, v142
v_lshrrev_b32 v143, 5, v155
v_bfe_u32 v141, v155, 3, 2
v_bfe_u32 v144, v155, 4, 1
v_xor_b32 v141, v141, v144
v_sub_u32 v141, v141, v142
v_mul_i32_i24 v141, 9, v141
v_add_u32 v143, v143, v141
v_lshrrev_b32_e64 v141, 1, v143
v_mul_u32_u24 v141, 368, v141
v_lshl_add_u32 v143, v143, 3, v141
v_lshl_add_u32 v143, v142, 7, v143
v_and_b32_e64 v144, 7, v155
v_lshl_add_u32 v143, v144, 4, v143
v_add_u32 v159, 156672, v143
v_mov_b32 v160, 0
v_mov_b32 v161, 0
v_mov_b32_e64 v162, 0
v_mov_b32 v163, 0
s_mov_b64 exec, 1
ds_write_b128 v253, v[160:163]
ds_write_b128 v253, v[160:163] offset:16
s_mov_b64 exec, -1
s_waitcnt vmcnt(6)
v_and_b32_e64 v130, 4, v152
v_cmp_eq_u32 vcc, 0, v130
s_nop 1
v_cndmask_b32 v164, 0, v126, vcc
v_sub_u32 v165, v126, v164
ds_write_b64 v156, v[164:165]
v_and_b32_e64 v130, 4, v153
v_cmp_eq_u32 vcc, 0, v130
s_nop 1
v_cndmask_b32 v166, 0, v127, vcc
v_sub_u32 v167, v127, v166
ds_write_b64 v157, v[166:167]
v_and_b32_e64 v130, 4, v154
v_cmp_eq_u32 vcc, 0, v130
s_nop 1
v_cndmask_b32 v168, 0, v128, vcc
v_sub_u32 v169, v128, v168
ds_write_b64 v158, v[168:169]
v_and_b32_e64 v130, 4, v155
v_cmp_eq_u32 vcc, 0, v130
s_nop 1
v_cndmask_b32 v170, 0, v129, vcc
v_sub_u32 v171, v129, v170
ds_write_b64 v159, v[170:171]
s_waitcnt lgkmcnt(0)
Lnoo:
s_barrier
s_cmp_lt_u32 s40, 4
s_cbranch_scc1 Lnoy2
v_subrev_u32 v199, 256, v199
v_lshlrev_b32_e64 v24, 6, v199
s_mov_b32 s43, 1065362610
v_mov_b32 v25, 1084047360
v_add_u32 v0, 32772, v24
v_add_u32 v1, 32780, v24
v_add_u32 v2, 32788, v24
v_add_u32 v3, 32796, v24
v_add_u32 v4, 32804, v24
v_add_u32 v5, 32812, v24
v_add_u32 v6, 32820, v24
v_add_u32 v7, 32828, v24
v_cvt_f32_f16 v0, v0
v_cvt_f32_f16 v1, v1
v_cvt_f32_f16 v2, v2
v_cvt_f32_f16 v3, v3
v_cvt_f32_f16 v4, v4
v_cvt_f32_f16 v5, v5
v_cvt_f32_f16 v6, v6
v_cvt_f32_f16 v7, v7
v_mul_f32 v8, v0, v0
v_mul_f32 v9, v1, v1
v_mul_f32 v10, v2, v2
v_mul_f32 v11, v3, v3
v_mul_f32 v12, v4, v4
v_mul_f32 v13, v5, v5
v_mul_f32 v14, v6, v6
v_mul_f32 v15, v7, v7
v_fma_f32 v8, v8, s43, v25
v_fma_f32 v9, v9, s43, v25
v_fma_f32 v10, v10, s43, v25
v_fma_f32 v11, v11, s43, v25
v_fma_f32 v12, v12, s43, v25
v_fma_f32 v13, v13, s43, v25
v_fma_f32 v14, v14, s43, v25
v_fma_f32 v15, v15, s43, v25
v_mul_f32 v8, v0, v8
v_mul_f32 v9, v1, v9
v_mul_f32 v10, v2, v10
v_mul_f32 v11, v3, v11
v_mul_f32 v12, v4, v12
v_mul_f32 v13, v5, v13
v_mul_f32 v14, v6, v14
v_mul_f32 v15, v7, v15
v_exp_f32 v8, v8
v_exp_f32 v9, v9
v_exp_f32 v10, v10
v_exp_f32 v11, v11
v_exp_f32 v12, v12
v_exp_f32 v13, v13
v_exp_f32 v14, v14
v_exp_f32 v15, v15
v_add_f32 v16, 1.0, v8
v_add_f32 v17, 1.0, v9
v_add_f32 v18, 1.0, v10
v_add_f32 v19, 1.0, v11
v_add_f32 v20, 1.0, v12
v_add_f32 v21, 1.0, v13
v_add_f32 v22, 1.0, v14
v_add_f32 v23, 1.0, v15
v_rcp_f32 v16, v16
v_rcp_f32 v17, v17
v_rcp_f32 v18, v18
v_rcp_f32 v19, v19
v_rcp_f32 v20, v20
v_rcp_f32 v21, v21
v_rcp_f32 v22, v22
v_rcp_f32 v23, v23
v_mul_f32 v0, v0, v16
v_mul_f32 v1, v1, v17
v_mul_f32 v2, v2, v18
v_mul_f32 v3, v3, v19
v_mul_f32 v4, v4, v20
v_mul_f32 v5, v5, v21
v_mul_f32 v6, v6, v22
v_mul_f32 v7, v7, v23
v_mul_f32 v8, v8, v0
v_mul_f32 v9, v9, v1
v_mul_f32 v10, v10, v2
v_mul_f32 v11, v11, v3
v_mul_f32 v12, v12, v4
v_mul_f32 v13, v13, v5
v_mul_f32 v14, v14, v6
v_mul_f32 v15, v15, v7
v_cvt_pk_f16_f32 v28, v0, v1
v_cvt_pk_f16_f32 v32, -v8, -v9
v_cvt_pk_f16_f32 v29, v2, v3
v_cvt_pk_f16_f32 v33, -v10, -v11
v_cvt_pk_f16_f32 v30, v4, v5
v_cvt_pk_f16_f32 v34, -v12, -v13
v_cvt_pk_f16_f32 v31, v6, v7
v_cvt_pk_f16_f32 v35, -v14, -v15
v_lshlrev_b32_e64 v24, 4, v199
v_mov_b32 v25, 163840
s_movk_i32 s43, 496
v_cmp_gt_u32 vcc, s43, v199
s_nop 1
v_cndmask_b32 v24, v25, v24, vcc
ds_write_b128 v24, v[32:35]
ds_write_b128 v24, v[28:31] offset:8192
Lnoy2:
s_setprio 2
s_cmp_lt_u32 s40, 4
s_cbranch_scc0 Lsu0
s_call_b64 s[78:79], Lpre
s_call_b64 s[78:79], Lrb
s_waitcnt vmcnt(4)
s_mov_b64 exec, 1
ds_add_u32 v253, v254 offset:28
s_mov_b64 exec, -1
v_mov_b32 v253, 16256
Lsw288w:
ds_read_b32 v247, v253 offset:28
s_waitcnt lgkmcnt(0)
v_readfirstlane_b32 s43, v247
s_cmp_eq_u32 s76, 0
s_cbranch_scc1 Lsw288x
s_sub_u32 s76, s76, 1
s_cmp_lt_u32 s43, 8
s_cbranch_scc0 Lsw288x
s_sleep 2
s_branch Lsw288w
Lsw288x:
s_call_b64 s[78:79], Lconv0
s_mov_b64 exec, 1
ds_add_u32 v253, v254 offset:16
s_mov_b64 exec, -1
s_call_b64 s[78:79], Lln0
s_waitcnt vmcnt(0)
s_mov_b64 exec, 1
ds_add_u32 v253, v254 offset:12
s_mov_b64 exec, -1
s_call_b64 s[78:79], Lw1i
Lsu0:
s_cmp_ge_u32 s40, 4
s_cbranch_scc0 Lsu2
s_setprio 3
s_call_b64 s[78:79], Lw1f
s_waitcnt vmcnt(6)
s_mov_b64 exec, 1
ds_add_u32 v253, v254 offset:28
s_mov_b64 exec, -1
s_call_b64 s[78:79], Lrb
s_waitcnt vmcnt(4)
s_call_b64 s[78:79], Lw1a
s_mov_b64 exec, 1
ds_add_u32 v253, v254 offset:20
s_mov_b64 exec, -1
s_call_b64 s[78:79], Lpre
s_waitcnt vmcnt(0)
s_mov_b64 exec, 1
ds_add_u32 v253, v254 offset:12
s_mov_b64 exec, -1
v_mov_b32 v253, 16256
Lsw128w:
ds_read_b32 v247, v253 offset:12
s_waitcnt lgkmcnt(0)
v_readfirstlane_b32 s43, v247
s_cmp_eq_u32 s76, 0
s_cbranch_scc1 Lsw128x
s_sub_u32 s76, s76, 1
s_cmp_lt_u32 s43, 8
s_cbranch_scc0 Lsw128x
s_sleep 2
s_branch Lsw128w
Lsw128x:
s_call_b64 s[78:79], Lconv0
s_mov_b64 exec, 1
ds_add_u32 v253, v254 offset:16
s_mov_b64 exec, -1
s_call_b64 s[78:79], Lln0
Lsu2:
s_branch Lgo
Lconv0:
ds_read_b128 v[192:195], v242
ds_read_b128 v[196:199], v242 offset:64
ds_read_b128 v[200:203], v242 offset:128
ds_read_b128 v[204:207], v243
ds_read_b128 v[208:211], v243 offset:64
ds_read_b128 v[212:215], v243 offset:128
ds_read_b128 v[224:227], v244
ds_read_b128 v[228:231], v244 offset:64
ds_read_b128 v[232:235], v244 offset:128
v_xor_b32 v242, 16, v242
ds_read_b128 v[236:239], v242
ds_read_b128 v[216:219], v242 offset:64
ds_read_b128 v[220:223], v242 offset:128
s_waitcnt lgkmcnt(11)
v_smfmac_f32_16x16x32_bf16 v[0:3], v[48:49], v[192:195], v246
s_waitcnt lgkmcnt(10)
v_smfmac_f32_16x16x32_bf16 v[16:19], v[50:51], v[196:199], v246
s_waitcnt lgkmcnt(9)
v_smfmac_f32_16x16x32_bf16 v[32:35], v[52:53], v[200:203], v246
s_waitcnt lgkmcnt(8)
v_xor_b32 v243, 16, v243
ds_read_b128 v[192:195], v243
ds_read_b128 v[196:199], v243 offset:64
v_smfmac_f32_16x16x32_bf16 v[0:3], v[54:55], v[204:207], v246
s_waitcnt lgkmcnt(9)
v_smfmac_f32_16x16x32_bf16 v[16:19], v[56:57], v[208:211], v246
s_waitcnt lgkmcnt(8)
ds_read_b128 v[200:203], v243 offset:128
v_xor_b32 v244, 16, v244
ds_read_b128 v[204:207], v244
v_smfmac_f32_16x16x32_bf16 v[32:35], v[58:59], v[212:215], v246
s_waitcnt lgkmcnt(9)
v_smfmac_f32_16x16x32_bf16 v[0:3], v[60:61], v[224:227], v246
s_waitcnt lgkmcnt(8)
ds_read_b128 v[208:211], v244 offset:64
ds_read_b128 v[212:215], v244 offset:128
v_smfmac_f32_16x16x32_bf16 v[16:19], v[62:63], v[228:231], v246
s_waitcnt lgkmcnt(9)
v_smfmac_f32_16x16x32_bf16 v[32:35], v[64:65], v[232:235], v246
s_waitcnt lgkmcnt(8)
v_xor_b32 v242, 32, v242
ds_read_b128 v[224:227], v242
ds_read_b128 v[228:231], v242 offset:64
v_smfmac_f32_16x16x32_bf16 v[4:7], v[66:67], v[236:239], v246
s_waitcnt lgkmcnt(9)
v_smfmac_f32_16x16x32_bf16 v[20:23], v[68:69], v[216:219], v246
s_waitcnt lgkmcnt(8)
ds_read_b128 v[232:235], v242 offset:128
v_xor_b32 v243, 32, v243
ds_read_b128 v[236:239], v243
v_smfmac_f32_16x16x32_bf16 v[36:39], v[70:71], v[220:223], v246
s_waitcnt lgkmcnt(9)
v_smfmac_f32_16x16x32_bf16 v[4:7], v[72:73], v[192:195], v246
s_waitcnt lgkmcnt(8)
ds_read_b128 v[216:219], v243 offset:64
ds_read_b128 v[220:223], v243 offset:128
v_smfmac_f32_16x16x32_bf16 v[20:23], v[74:75], v[196:199], v246
s_waitcnt lgkmcnt(9)
v_smfmac_f32_16x16x32_bf16 v[36:39], v[76:77], v[200:203], v246
s_waitcnt lgkmcnt(8)
v_xor_b32 v244, 32, v244
ds_read_b128 v[192:195], v244
ds_read_b128 v[196:199], v244 offset:64
v_smfmac_f32_16x16x32_bf16 v[4:7], v[78:79], v[204:207], v246
s_waitcnt lgkmcnt(9)
v_smfmac_f32_16x16x32_bf16 v[20:23], v[80:81], v[208:211], v246
s_waitcnt lgkmcnt(8)
ds_read_b128 v[200:203], v244 offset:128
v_xor_b32 v242, 16, v242
ds_read_b128 v[204:207], v242
v_smfmac_f32_16x16x32_bf16 v[36:39], v[82:83], v[212:215], v246
s_waitcnt lgkmcnt(9)
v_smfmac_f32_16x16x32_bf16 v[12:15], v[84:85], v[224:227], v246
s_waitcnt lgkmcnt(8)
ds_read_b128 v[208:211], v242 offset:64
ds_read_b128 v[212:215], v242 offset:128
v_smfmac_f32_16x16x32_bf16 v[28:31], v[86:87], v[228:231], v246
s_waitcnt lgkmcnt(9)
v_smfmac_f32_16x16x32_bf16 v[44:47], v[88:89], v[232:235], v246
s_waitcnt lgkmcnt(8)
v_xor_b32 v243, 16, v243
ds_read_b128 v[224:227], v243
ds_read_b128 v[228:231], v243 offset:64
v_smfmac_f32_16x16x32_bf16 v[12:15], v[90:91], v[236:239], v246
s_waitcnt lgkmcnt(9)
v_smfmac_f32_16x16x32_bf16 v[28:31], v[92:93], v[216:219], v246
s_waitcnt lgkmcnt(8)
ds_read_b128 v[232:235], v243 offset:128
v_xor_b32 v244, 16, v244
ds_read_b128 v[236:239], v244
v_smfmac_f32_16x16x32_bf16 v[44:47], v[94:95], v[220:223], v246
s_waitcnt lgkmcnt(9)
v_smfmac_f32_16x16x32_bf16 v[12:15], v[96:97], v[192:195], v246
s_waitcnt lgkmcnt(8)
ds_read_b128 v[216:219], v244 offset:64
ds_read_b128 v[220:223], v244 offset:128
v_smfmac_f32_16x16x32_bf16 v[28:31], v[98:99], v[196:199], v246
s_waitcnt lgkmcnt(9)
v_smfmac_f32_16x16x32_bf16 v[44:47], v[100:101], v[200:203], v246
s_waitcnt lgkmcnt(8)
v_smfmac_f32_16x16x32_bf16 v[8:11], v[102:103], v[204:207], v246
s_waitcnt lgkmcnt(7)
v_smfmac_f32_16x16x32_bf16 v[24:27], v[104:105], v[208:211], v246
s_waitcnt lgkmcnt(6)
v_smfmac_f32_16x16x32_bf16 v[40:43], v[106:107], v[212:215], v246
s_waitcnt lgkmcnt(5)
v_smfmac_f32_16x16x32_bf16 v[8:11], v[108:109], v[224:227], v246
s_waitcnt lgkmcnt(4)
v_smfmac_f32_16x16x32_bf16 v[24:27], v[110:111], v[228:231], v246
s_waitcnt lgkmcnt(3)
v_smfmac_f32_16x16x32_bf16 v[40:43], v[112:113], v[232:235], v246
s_waitcnt lgkmcnt(2)
v_smfmac_f32_16x16x32_bf16 v[8:11], v[114:115], v[236:239], v246
s_waitcnt lgkmcnt(1)
v_smfmac_f32_16x16x32_bf16 v[24:27], v[116:117], v[216:219], v246
s_waitcnt lgkmcnt(0)
v_smfmac_f32_16x16x32_bf16 v[40:43], v[118:119], v[220:223], v246
s_nop 11
s_setpc_b64 s[78:79]
Lln0:
v_pk_add_f32 v[168:169], v[0:1], v[2:3]
v_pk_mul_f32 v[170:171], v[0:1], v[0:1]
v_pk_fma_f32 v[170:171], v[2:3], v[2:3], v[170:171]
v_pk_add_f32 v[168:169], v[168:169], v[4:5]
v_pk_fma_f32 v[170:171], v[4:5], v[4:5], v[170:171]
v_pk_add_f32 v[168:169], v[168:169], v[6:7]
v_pk_fma_f32 v[170:171], v[6:7], v[6:7], v[170:171]
v_pk_add_f32 v[168:169], v[168:169], v[8:9]
v_pk_fma_f32 v[170:171], v[8:9], v[8:9], v[170:171]
v_pk_add_f32 v[168:169], v[168:169], v[10:11]
v_pk_fma_f32 v[170:171], v[10:11], v[10:11], v[170:171]
v_pk_add_f32 v[168:169], v[168:169], v[12:13]
v_pk_fma_f32 v[170:171], v[12:13], v[12:13], v[170:171]
v_pk_add_f32 v[168:169], v[168:169], v[14:15]
v_pk_fma_f32 v[170:171], v[14:15], v[14:15], v[170:171]
v_pk_add_f32 v[168:169], v[168:169], v[16:17]
v_pk_fma_f32 v[170:171], v[16:17], v[16:17], v[170:171]
v_pk_add_f32 v[168:169], v[168:169], v[18:19]
v_pk_fma_f32 v[170:171], v[18:19], v[18:19], v[170:171]
v_pk_add_f32 v[168:169], v[168:169], v[20:21]
v_pk_fma_f32 v[170:171], v[20:21], v[20:21], v[170:171]
v_pk_add_f32 v[168:169], v[168:169], v[22:23]
v_pk_fma_f32 v[170:171], v[22:23], v[22:23], v[170:171]
v_pk_add_f32 v[168:169], v[168:169], v[24:25]
v_pk_fma_f32 v[170:171], v[24:25], v[24:25], v[170:171]
v_pk_add_f32 v[168:169], v[168:169], v[26:27]
v_pk_fma_f32 v[170:171], v[26:27], v[26:27], v[170:171]
v_pk_add_f32 v[168:169], v[168:169], v[28:29]
v_pk_fma_f32 v[170:171], v[28:29], v[28:29], v[170:171]
v_pk_add_f32 v[168:169], v[168:169], v[30:31]
v_pk_fma_f32 v[170:171], v[30:31], v[30:31], v[170:171]
v_pk_add_f32 v[168:169], v[168:169], v[32:33]
v_pk_fma_f32 v[170:171], v[32:33], v[32:33], v[170:171]
v_pk_add_f32 v[168:169], v[168:169], v[34:35]
v_pk_fma_f32 v[170:171], v[34:35], v[34:35], v[170:171]
v_pk_add_f32 v[168:169], v[168:169], v[36:37]
v_pk_fma_f32 v[170:171], v[36:37], v[36:37], v[170:171]
v_pk_add_f32 v[168:169], v[168:169], v[38:39]
v_pk_fma_f32 v[170:171], v[38:39], v[38:39], v[170:171]
v_pk_add_f32 v[168:169], v[168:169], v[40:41]
v_pk_fma_f32 v[170:171], v[40:41], v[40:41], v[170:171]
v_pk_add_f32 v[168:169], v[168:169], v[42:43]
v_pk_fma_f32 v[170:171], v[42:43], v[42:43], v[170:171]
v_pk_add_f32 v[168:169], v[168:169], v[44:45]
v_pk_fma_f32 v[170:171], v[44:45], v[44:45], v[170:171]
v_pk_add_f32 v[168:169], v[168:169], v[46:47]
v_pk_fma_f32 v[170:171], v[46:47], v[46:47], v[170:171]
v_add_f32 v168, v168, v169
v_add_f32 v170, v170, v171
s_nop 1
v_permlane32_swap_b32 v168, v170
v_add_f32_e64 v168, v168, v170
v_mul_f32 v168, 1009429163, v168
v_mov_b32_e64 v170, v168
s_nop 1
v_permlane32_swap_b32 v168, v170
v_fma_f32 v170, -v168, v168, v170
v_max_f32_e64 v170, 0, v170
v_add_f32 v170, 925353388, v170
v_rsq_f32 v170, v170
s_nop 0
v_mul_f32 v172, 3203391086, v170
v_mul_f32_e64 v173, v168, v172
v_pk_fma_f32 v[0:1], v[0:1], v[172:173], v[172:173] op_sel:[0,0,1] op_sel_hi:[1,0,1] neg_lo:[0,0,1] neg_hi:[0,0,1]
v_pk_fma_f32 v[2:3], v[2:3], v[172:173], v[172:173] op_sel:[0,0,1] op_sel_hi:[1,0,1] neg_lo:[0,0,1] neg_hi:[0,0,1]
v_pk_fma_f32 v[4:5], v[4:5], v[172:173], v[172:173] op_sel:[0,0,1] op_sel_hi:[1,0,1] neg_lo:[0,0,1] neg_hi:[0,0,1]
v_pk_fma_f32 v[6:7], v[6:7], v[172:173], v[172:173] op_sel:[0,0,1] op_sel_hi:[1,0,1] neg_lo:[0,0,1] neg_hi:[0,0,1]
v_pk_fma_f32 v[8:9], v[8:9], v[172:173], v[172:173] op_sel:[0,0,1] op_sel_hi:[1,0,1] neg_lo:[0,0,1] neg_hi:[0,0,1]
v_pk_fma_f32 v[10:11], v[10:11], v[172:173], v[172:173] op_sel:[0,0,1] op_sel_hi:[1,0,1] neg_lo:[0,0,1] neg_hi:[0,0,1]
v_pk_fma_f32 v[12:13], v[12:13], v[172:173], v[172:173] op_sel:[0,0,1] op_sel_hi:[1,0,1] neg_lo:[0,0,1] neg_hi:[0,0,1]
v_pk_fma_f32 v[14:15], v[14:15], v[172:173], v[172:173] op_sel:[0,0,1] op_sel_hi:[1,0,1] neg_lo:[0,0,1] neg_hi:[0,0,1]
v_pk_fma_f32 v[16:17], v[16:17], v[172:173], v[172:173] op_sel:[0,0,1] op_sel_hi:[1,0,1] neg_lo:[0,0,1] neg_hi:[0,0,1]
v_pk_fma_f32 v[18:19], v[18:19], v[172:173], v[172:173] op_sel:[0,0,1] op_sel_hi:[1,0,1] neg_lo:[0,0,1] neg_hi:[0,0,1]
v_pk_fma_f32 v[20:21], v[20:21], v[172:173], v[172:173] op_sel:[0,0,1] op_sel_hi:[1,0,1] neg_lo:[0,0,1] neg_hi:[0,0,1]
v_pk_fma_f32 v[22:23], v[22:23], v[172:173], v[172:173] op_sel:[0,0,1] op_sel_hi:[1,0,1] neg_lo:[0,0,1] neg_hi:[0,0,1]
v_pk_fma_f32 v[24:25], v[24:25], v[172:173], v[172:173] op_sel:[0,0,1] op_sel_hi:[1,0,1] neg_lo:[0,0,1] neg_hi:[0,0,1]
v_pk_fma_f32 v[26:27], v[26:27], v[172:173], v[172:173] op_sel:[0,0,1] op_sel_hi:[1,0,1] neg_lo:[0,0,1] neg_hi:[0,0,1]
v_pk_fma_f32 v[28:29], v[28:29], v[172:173], v[172:173] op_sel:[0,0,1] op_sel_hi:[1,0,1] neg_lo:[0,0,1] neg_hi:[0,0,1]
v_pk_fma_f32 v[30:31], v[30:31], v[172:173], v[172:173] op_sel:[0,0,1] op_sel_hi:[1,0,1] neg_lo:[0,0,1] neg_hi:[0,0,1]
v_pk_fma_f32 v[32:33], v[32:33], v[172:173], v[172:173] op_sel:[0,0,1] op_sel_hi:[1,0,1] neg_lo:[0,0,1] neg_hi:[0,0,1]
v_pk_fma_f32 v[34:35], v[34:35], v[172:173], v[172:173] op_sel:[0,0,1] op_sel_hi:[1,0,1] neg_lo:[0,0,1] neg_hi:[0,0,1]
v_pk_fma_f32 v[36:37], v[36:37], v[172:173], v[172:173] op_sel:[0,0,1] op_sel_hi:[1,0,1] neg_lo:[0,0,1] neg_hi:[0,0,1]
v_pk_fma_f32 v[38:39], v[38:39], v[172:173], v[172:173] op_sel:[0,0,1] op_sel_hi:[1,0,1] neg_lo:[0,0,1] neg_hi:[0,0,1]
v_pk_fma_f32 v[40:41], v[40:41], v[172:173], v[172:173] op_sel:[0,0,1] op_sel_hi:[1,0,1] neg_lo:[0,0,1] neg_hi:[0,0,1]
v_pk_fma_f32 v[42:43], v[42:43], v[172:173], v[172:173] op_sel:[0,0,1] op_sel_hi:[1,0,1] neg_lo:[0,0,1] neg_hi:[0,0,1]
v_pk_fma_f32 v[44:45], v[44:45], v[172:173], v[172:173] op_sel:[0,0,1] op_sel_hi:[1,0,1] neg_lo:[0,0,1] neg_hi:[0,0,1]
v_pk_fma_f32 v[46:47], v[46:47], v[172:173], v[172:173] op_sel:[0,0,1] op_sel_hi:[1,0,1] neg_lo:[0,0,1] neg_hi:[0,0,1]
v_cvt_pk_bf16_f32 v48, v0, v1
v_cvt_pk_bf16_f32 v49, v2, v3
v_cvt_pk_bf16_f32 v50, v4, v5
v_cvt_pk_bf16_f32 v51, v6, v7
v_cvt_pk_bf16_f32 v52, v8, v9
v_cvt_pk_bf16_f32 v53, v10, v11
v_cvt_pk_bf16_f32 v54, v12, v13
v_cvt_pk_bf16_f32 v55, v14, v15
v_cvt_pk_bf16_f32 v56, v16, v17
v_cvt_pk_bf16_f32 v57, v18, v19
v_cvt_pk_bf16_f32 v58, v20, v21
v_cvt_pk_bf16_f32 v59, v22, v23
v_cvt_pk_bf16_f32 v60, v24, v25
v_cvt_pk_bf16_f32 v61, v26, v27
v_cvt_pk_bf16_f32 v62, v28, v29
v_cvt_pk_bf16_f32 v63, v30, v31
v_cvt_pk_bf16_f32 v64, v32, v33
v_cvt_pk_bf16_f32 v65, v34, v35
v_cvt_pk_bf16_f32 v66, v36, v37
v_cvt_pk_bf16_f32 v67, v38, v39
v_cvt_pk_bf16_f32 v68, v40, v41
v_cvt_pk_bf16_f32 v69, v42, v43
v_cvt_pk_bf16_f32 v70, v44, v45
v_cvt_pk_bf16_f32 v71, v46, v47
s_nop 1
s_setpc_b64 s[78:79]
Lw1a:
ds_read_b64_tr_b16 v[148:149], v190
ds_read_b64_tr_b16 v[150:151], v190 offset:512
ds_read_b64_tr_b16 v[152:153], v190 offset:1024
ds_read_b64_tr_b16 v[154:155], v190 offset:1536
ds_read_b64_tr_b16 v[156:157], v190 offset:2048
ds_read_b64_tr_b16 v[158:159], v190 offset:2560
ds_read_b64_tr_b16 v[160:161], v190 offset:3072
ds_read_b64_tr_b16 v[162:163], v190 offset:3584
ds_read_b64_tr_b16 v[164:165], v190 offset:4096
ds_read_b64_tr_b16 v[166:167], v190 offset:4608
ds_read_b64_tr_b16 v[168:169], v190 offset:5120
ds_read_b64_tr_b16 v[170:171], v190 offset:5632
s_waitcnt lgkmcnt(10)
ds_write_b128 v191, v[148:151]
s_waitcnt lgkmcnt(9)
ds_write_b128 v191, v[152:155] offset:1024
s_waitcnt lgkmcnt(8)
ds_write_b128 v191, v[156:159] offset:2048
s_waitcnt lgkmcnt(7)
ds_write_b128 v191, v[160:163] offset:3072
s_waitcnt lgkmcnt(6)
ds_write_b128 v191, v[164:167] offset:4096
s_waitcnt lgkmcnt(5)
ds_write_b128 v191, v[168:171] offset:5120
s_waitcnt lgkmcnt(0)
s_setpc_b64 s[78:79]
Lw1i:
s_add_u32 m0, s77, 24576
s_add_u32 s43, s3, 256
buffer_load_dwordx4 v189, s[12:15], s43 offen lds
s_add_u32 m0, s77, 25600
s_add_u32 s43, s3, 24832
buffer_load_dwordx4 v189, s[12:15], s43 offen lds
s_add_u32 m0, s77, 26624
s_add_u32 s43, s3, 49408
buffer_load_dwordx4 v189, s[12:15], s43 offen lds
s_add_u32 m0, s77, 27648
s_add_u32 s43, s3, 12544
buffer_load_dwordx4 v189, s[12:15], s43 offen lds
s_add_u32 m0, s77, 28672
s_add_u32 s43, s3, 37120
buffer_load_dwordx4 v189, s[12:15], s43 offen lds
s_add_u32 m0, s77, 29696
s_add_u32 s43, s3, 61696
buffer_load_dwordx4 v189, s[12:15], s43 offen lds
s_add_u32 m0, s77, 49152
s_add_u32 s43, s3, 512
buffer_load_dwordx4 v189, s[12:15], s43 offen lds
s_add_u32 m0, s77, 50176
s_add_u32 s43, s3, 25088
buffer_load_dwordx4 v189, s[12:15], s43 offen lds
s_add_u32 m0, s77, 51200
s_add_u32 s43, s3, 49664
buffer_load_dwordx4 v189, s[12:15], s43 offen lds
s_add_u32 m0, s77, 52224
s_add_u32 s43, s3, 12800
buffer_load_dwordx4 v189, s[12:15], s43 offen lds
s_add_u32 m0, s77, 53248
s_add_u32 s43, s3, 37376
buffer_load_dwordx4 v189, s[12:15], s43 offen lds
s_add_u32 m0, s77, 54272
s_add_u32 s43, s3, 61952
buffer_load_dwordx4 v189, s[12:15], s43 offen lds
s_setpc_b64 s[78:79]
Lw1b:
ds_read_b64_tr_b16 v[72:73], v190 offset:24576
ds_read_b64_tr_b16 v[74:75], v190 offset:25088
ds_read_b64_tr_b16 v[76:77], v190 offset:25600
ds_read_b64_tr_b16 v[78:79], v190 offset:26112
ds_read_b64_tr_b16 v[80:81], v190 offset:26624
ds_read_b64_tr_b16 v[82:83], v190 offset:27136
ds_read_b64_tr_b16 v[84:85], v190 offset:27648
ds_read_b64_tr_b16 v[86:87], v190 offset:28160
ds_read_b64_tr_b16 v[88:89], v190 offset:28672
ds_read_b64_tr_b16 v[90:91], v190 offset:29184
ds_read_b64_tr_b16 v[92:93], v190 offset:29696
ds_read_b64_tr_b16 v[94:95], v190 offset:30208
s_waitcnt lgkmcnt(10)
ds_write_b128 v191, v[72:75] offset:24576
s_waitcnt lgkmcnt(9)
ds_write_b128 v191, v[76:79] offset:25600
s_waitcnt lgkmcnt(8)
ds_write_b128 v191, v[80:83] offset:26624
s_waitcnt lgkmcnt(7)
ds_write_b128 v191, v[84:87] offset:27648
s_waitcnt lgkmcnt(6)
ds_write_b128 v191, v[88:91] offset:28672
s_waitcnt lgkmcnt(5)
ds_write_b128 v191, v[92:95] offset:29696
s_waitcnt lgkmcnt(0)
s_setpc_b64 s[78:79]
Lw1c:
ds_read_b64_tr_b16 v[72:73], v190 offset:49152
ds_read_b64_tr_b16 v[74:75], v190 offset:49664
ds_read_b64_tr_b16 v[76:77], v190 offset:50176
ds_read_b64_tr_b16 v[78:79], v190 offset:50688
ds_read_b64_tr_b16 v[80:81], v190 offset:51200
ds_read_b64_tr_b16 v[82:83], v190 offset:51712
ds_read_b64_tr_b16 v[84:85], v190 offset:52224
ds_read_b64_tr_b16 v[86:87], v190 offset:52736
ds_read_b64_tr_b16 v[88:89], v190 offset:53248
ds_read_b64_tr_b16 v[90:91], v190 offset:53760
ds_read_b64_tr_b16 v[92:93], v190 offset:54272
ds_read_b64_tr_b16 v[94:95], v190 offset:54784
s_waitcnt lgkmcnt(10)
ds_write_b128 v191, v[72:75] offset:49152
s_waitcnt lgkmcnt(9)
ds_write_b128 v191, v[76:79] offset:50176
s_waitcnt lgkmcnt(8)
ds_write_b128 v191, v[80:83] offset:51200
s_waitcnt lgkmcnt(7)
ds_write_b128 v191, v[84:87] offset:52224
s_waitcnt lgkmcnt(6)
ds_write_b128 v191, v[88:91] offset:53248
s_waitcnt lgkmcnt(5)
ds_write_b128 v191, v[92:95] offset:54272
s_waitcnt lgkmcnt(0)
s_setpc_b64 s[78:79]
Lpre:
ds_read_b128 v[48:51], v245
ds_read_b128 v[52:55], v245 offset:384
ds_read_b128 v[56:59], v245 offset:768
ds_read_b128 v[60:63], v245 offset:1152
ds_read_b128 v[64:67], v245 offset:1536
ds_read_b128 v[68:71], v245 offset:1920
ds_read_b128 v[72:75], v245 offset:2304
ds_read_b128 v[76:79], v245 offset:2688
ds_read_b128 v[80:83], v245 offset:3072
ds_read_b128 v[84:87], v245 offset:3456
ds_read_b128 v[88:91], v245 offset:3840
ds_read_b128 v[92:95], v245 offset:4224
ds_read_b128 v[96:99], v245 offset:4608
ds_read_b128 v[100:103], v245 offset:4992
ds_read_b128 v[104:107], v245 offset:5376
ds_read_b128 v[108:111], v245 offset:5760
ds_read_b128 v[112:115], v245 offset:6144
ds_read_b128 v[116:119], v245 offset:6528
v_mov_b32 v0, 0
v_mov_b32 v1, 0
v_mov_b32 v2, 0
v_mov_b32 v3, 0
v_mov_b32 v4, 0
v_mov_b32 v5, 0
v_mov_b32 v6, 0
v_mov_b32 v7, 0
v_mov_b32 v8, 0
v_mov_b32 v9, 0
v_mov_b32 v10, 0
v_mov_b32 v11, 0
v_mov_b32 v12, 0
v_mov_b32 v13, 0
v_mov_b32 v14, 0
v_mov_b32 v15, 0
v_mov_b32 v16, 0
v_mov_b32 v17, 0
v_mov_b32 v18, 0
v_mov_b32 v19, 0
v_mov_b32 v20, 0
v_mov_b32 v21, 0
v_mov_b32 v22, 0
v_mov_b32 v23, 0
v_mov_b32 v24, 0
v_mov_b32 v25, 0
v_mov_b32 v26, 0
v_mov_b32 v27, 0
v_mov_b32 v28, 0
v_mov_b32 v29, 0
v_mov_b32 v30, 0
v_mov_b32 v31, 0
v_mov_b32 v32, 0
v_mov_b32 v33, 0
v_mov_b32 v34, 0
v_mov_b32 v35, 0
v_mov_b32 v36, 0
v_mov_b32 v37, 0
v_mov_b32 v38, 0
v_mov_b32 v39, 0
v_mov_b32 v40, 0
v_mov_b32 v41, 0
v_mov_b32 v42, 0
v_mov_b32 v43, 0
v_mov_b32 v44, 0
v_mov_b32 v45, 0
v_mov_b32 v46, 0
v_mov_b32 v47, 0
s_waitcnt lgkmcnt(0)
s_setpc_b64 s[78:79]
Lrb:
s_add_u32 m0, s67, 39936
s_add_u32 s45, s66, 491520
buffer_load_dwordx4 v240, s[4:7], s45 offen nt lds
s_add_u32 m0, s67, 46592
s_add_u32 s45, s66, 589824
buffer_load_dwordx4 v240, s[4:7], s45 offen nt lds
s_add_u32 m0, s67, 53248
s_add_u32 s45, s66, 688128
buffer_load_dwordx4 v240, s[4:7], s45 offen nt lds
s_add_u32 m0, s67, 59904
s_add_u32 s45, s66, 786432
buffer_load_dwordx4 v240, s[4:7], s45 offen nt lds
s_setpc_b64 s[78:79]
Lw1f:
s_add_u32 m0, s77, 0
s_add_u32 s43, s3, 0
buffer_load_dwordx4 v189, s[12:15], s43 offen lds
s_add_u32 m0, s77, 1024
s_add_u32 s43, s3, 24576
buffer_load_dwordx4 v189, s[12:15], s43 offen lds
s_add_u32 m0, s77, 2048
s_add_u32 s43, s3, 49152
buffer_load_dwordx4 v189, s[12:15], s43 offen lds
s_add_u32 m0, s77, 3072
s_add_u32 s43, s3, 12288
buffer_load_dwordx4 v189, s[12:15], s43 offen lds
s_add_u32 m0, s77, 4096
s_add_u32 s43, s3, 36864
buffer_load_dwordx4 v189, s[12:15], s43 offen lds
s_add_u32 m0, s77, 5120
s_add_u32 s43, s3, 61440
buffer_load_dwordx4 v189, s[12:15], s43 offen lds
s_setpc_b64 s[78:79]
Lgo:
v_mov_b32 v253, 16256
Lsw204w:
ds_read_b32 v247, v253 offset:20
s_waitcnt lgkmcnt(0)
v_readfirstlane_b32 s43, v247
s_cmp_eq_u32 s76, 0
s_cbranch_scc1 Lsw204x
s_sub_u32 s76, s76, 1
s_cmp_lt_u32 s43, 4
s_cbranch_scc0 Lsw204x
s_sleep 2
s_branch Lsw204w
Lsw204x:
s_cmp_lg_u32 s40, 7
s_cbranch_scc1 Lnopf
s_getpc_b64 s[74:75]
Lpc:
s_lshr_b32 s43, s2, 3
s_and_b32 s43, s43, 15
s_lshl_b32 s43, s43, 13
v_lshlrev_b32 v102, 7, v251
v_add_u32 v102, s43, v102
v_min_u32 v102, Lend-Lpc, v102
global_load_dword v255, v102, s[74:75]
Lnopf:
s_add_u32 s66, s66, 786432
ds_read_b128 v[224:227], v248 offset:16384
ds_read_b128 v[228:231], v248 offset:19456
ds_read_b128 v[232:235], v248 offset:17408
ds_read_b128 v[236:239], v248 offset:20480
ds_read_b128 v[216:219], v248 offset:18432
ds_read_b128 v[220:223], v248 offset:21504
s_setprio 2
s_waitcnt lgkmcnt(5)
v_mfma_f32_32x32x16_bf16 v[120:135], v[48:51], v[224:227], 0
s_waitcnt lgkmcnt(4)
ds_read_b128 v[224:227], v248 offset:22528
v_mfma_f32_32x32x16_bf16 v[120:135], v[52:55], v[228:231], v[120:135]
s_waitcnt lgkmcnt(4)
ds_read_b128 v[228:231], v248 offset:25600
v_mfma_f32_32x32x16_bf16 v[120:135], v[56:59], v[232:235], v[120:135]
s_waitcnt lgkmcnt(4)
ds_read_b128 v[232:235], v248 offset:23552
v_mfma_f32_32x32x16_bf16 v[120:135], v[60:63], v[236:239], v[120:135]
s_waitcnt lgkmcnt(4)
ds_read_b128 v[236:239], v248 offset:26624
v_mfma_f32_32x32x16_bf16 v[120:135], v[64:67], v[216:219], v[120:135]
s_waitcnt lgkmcnt(4)
ds_read_b128 v[216:219], v248 offset:24576
v_mfma_f32_32x32x16_bf16 v[120:135], v[68:71], v[220:223], v[120:135]
v_add_u32 v174, -36864, v242
v_subrev_u32 v175, 66560, v174
v_min_u32 v174, v174, v175
v_add_u32 v174, 90112, v174
v_sub_u32 v175, v174, v242
v_add_u32 v242, v175, v242
v_add_u32_e64 v243, v175, v243
v_add_u32 v244, v175, v244
s_nop 3
v_cvt_pkrtz_f16_f32 v137, v120, v121
v_cvt_pkrtz_f16_f32 v139, v122, v123
v_cvt_pkrtz_f16_f32 v141, v124, v125
v_cvt_pkrtz_f16_f32 v143, v126, v127
v_cvt_pkrtz_f16_f32 v177, v128, v129
v_cvt_pk_f16_f32 v155, v130, v131
v_cvt_pk_f16_f32 v152, v132, v133
v_cvt_pk_f16_f32 v149, v134, v135
s_waitcnt lgkmcnt(1)
ds_read_b128 v[220:223], v248 offset:27648
v_mfma_f32_32x32x16_bf16 v[120:135], v[48:51], v[224:227], 0
v_pk_fma_f16 v154, v155, v155, s48
v_and_b32 v137, s49, v137
v_pk_fma_f16 v151, v152, v152, s48
v_pk_fma_f16 v148, v149, v149, s48
v_bfe_u32 v136, v137, 2, 14
v_pk_mul_f16 v154, v155, v154
v_pk_mul_f16 v151, v152, v151
v_pk_mul_f16 v148, v149, v148
ds_read_b128 v[224:227], v248 offset:28672
ds_read_u16_d16 v136, v136
v_mfma_f32_32x32x16_bf16 v[120:135], v[52:55], v[228:231], v[120:135]
v_lshrrev_b32 v137, 18, v137
v_exp_f16 v153, v154
v_exp_f16 v150, v151
v_and_b32 v139, s49, v139
v_exp_f16_e64 v147, v148
v_bfe_u32 v138, v139, 2, 14
ds_read_b128 v[228:231], v248 offset:31744
ds_read_u16_d16_hi v137, v137
ds_read_u16_d16 v138, v138
v_mfma_f32_32x32x16_bf16 v[120:135], v[56:59], v[232:235], v[120:135]
v_exp_f16_sdwa v153, v154 dst_sel:WORD_1 dst_unused:UNUSED_PRESERVE src0_sel:WORD_1
v_lshrrev_b32_e64 v139, 18, v139
v_exp_f16_sdwa v150, v151 dst_sel:WORD_1 dst_unused:UNUSED_PRESERVE src0_sel:WORD_1
v_exp_f16_sdwa v147, v148 dst_sel:WORD_1 dst_unused:UNUSED_PRESERVE src0_sel:WORD_1
v_and_b32_e64 v141, s49, v141
ds_read_b128 v[232:235], v248 offset:29696
ds_read_u16_d16_hi v139, v139
v_mfma_f32_32x32x16_bf16 v[120:135], v[60:63], v[236:239], v[120:135]
v_pk_add_f16 v153, v153, 1.0 op_sel_hi:[1,0]
v_bfe_u32 v140, v141, 2, 14
v_pk_add_f16 v150, v150, 1.0 op_sel_hi:[1,0]
v_pk_add_f16 v147, v147, 1.0 op_sel_hi:[1,0]
v_rcp_f16 v154, v153
v_lshrrev_b32 v141, 18, v141
v_rcp_f16 v151, v150
s_waitcnt lgkmcnt(5)
ds_read_b128 v[236:239], v248 offset:32768
ds_read_u16_d16 v140, v140
ds_read_u16_d16_hi v141, v141
v_mfma_f32_32x32x16_bf16 v[120:135], v[64:67], v[216:219], v[120:135]
v_and_b32 v143, s49, v143
v_rcp_f16 v148, v147
v_bfe_u32 v142, v143, 2, 14
v_rcp_f16_sdwa v154, v153 dst_sel:WORD_1 dst_unused:UNUSED_PRESERVE src0_sel:WORD_1
v_rcp_f16_sdwa v151, v150 dst_sel:WORD_1 dst_unused:UNUSED_PRESERVE src0_sel:WORD_1
ds_read_b128 v[216:219], v248 offset:30720
ds_read_u16_d16 v142, v142
ds_read_b32 v247, v253 offset:16
v_mfma_f32_32x32x16_bf16 v[120:135], v[68:71], v[220:223], v[120:135]
v_lshrrev_b32_e64 v143, 18, v143
v_rcp_f16_sdwa v148, v147 dst_sel:WORD_1 dst_unused:UNUSED_PRESERVE src0_sel:WORD_1
v_and_b32_e64 v177, s49, v177
v_pk_mul_f16 v155, v155, v154
v_pk_mul_f16 v152, v152, v151
v_bfe_u32 v176, v177, 2, 14
v_pk_mul_f16 v149, v149, v148
v_fma_mix_f32 v156, v155, v155, 0 op_sel:[0,0,0] op_sel_hi:[1,1,0]
v_fma_mix_f32 v156, v155, v155, v156 op_sel:[1,1,0] op_sel_hi:[1,1,0]
v_lshrrev_b32_e64 v177, 18, v177
v_fma_mix_f32 v156, v152, v152, v156 op_sel:[0,0,0] op_sel_hi:[1,1,0]
v_fma_mix_f32 v156, v152, v152, v156 op_sel:[1,1,0] op_sel_hi:[1,1,0]
v_fma_mix_f32 v156, v149, v149, v156 op_sel:[0,0,0] op_sel_hi:[1,1,0]
v_fma_mix_f32 v156, v149, v149, v156 op_sel:[1,1,0] op_sel_hi:[1,1,0]
ds_read_u16_d16_hi v143, v143
ds_read_u16_d16 v176, v176
ds_read_u16_d16_hi v177, v177
s_waitcnt lgkmcnt(3)
v_readfirstlane_b32 s43, v247
s_nop 1
s_cmp_ge_u32 s43, 8
s_cbranch_scc1 Lev1
Lev1w:
s_sleep 1
ds_read_b32 v247, v253 offset:16
s_waitcnt lgkmcnt(0)
v_readfirstlane_b32 s43, v247
s_cmp_eq_u32 s76, 0
s_cbranch_scc1 Lev1
s_sub_u32 s76, s76, 1
s_cmp_lt_u32 s43, 8
s_cbranch_scc1 Lev1w
Lev1:
v_cvt_pkrtz_f16_f32 v179, v120, v121
v_cvt_pkrtz_f16_f32 v181, v122, v123
v_cvt_pkrtz_f16_f32 v183, v124, v125
v_cvt_pkrtz_f16_f32 v185, v126, v127
v_cvt_pkrtz_f16_f32 v187, v128, v129
v_cvt_pk_f16_f32 v155, v130, v131
v_cvt_pk_f16_f32 v152, v132, v133
v_cvt_pk_f16_f32 v149, v134, v135
s_add_u32 m0, s67, 0
s_add_u32 s66, s66, 98304
buffer_load_dwordx4 v240, s[4:7], s66 offen lds
ds_read_b128 v[220:223], v248 offset:33792
v_mfma_f32_32x32x16_bf16 v[120:135], v[48:51], v[224:227], 0
v_pk_fma_f16 v154, v155, v155, s48
v_and_b32_e64 v179, s49, v179
v_fma_mix_f32 v156, v136, v136, v156 op_sel:[0,0,0] op_sel_hi:[1,1,0]
v_pk_fma_f16 v151, v152, v152, s48
v_pk_fma_f16 v148, v149, v149, s48
v_bfe_u32 v178, v179, 2, 14
v_pk_mul_f16 v154, v155, v154
v_pk_mul_f16 v151, v152, v151
v_fma_mix_f32 v156, v137, v137, v156 op_sel:[1,1,0] op_sel_hi:[1,1,0]
v_lshrrev_b32_e64 v179, 18, v179
s_add_u32 m0, s67, 6656
s_add_u32 s66, s66, 98304
buffer_load_dwordx4 v240, s[4:7], s66 offen lds
ds_read_b128 v[224:227], v248 offset:34816
ds_read_u16_d16 v178, v178
ds_read_u16_d16_hi v179, v179
v_mfma_f32_32x32x16_bf16 v[120:135], v[52:55], v[228:231], v[120:135]
v_pk_mul_f16 v148, v149, v148
v_exp_f16 v153, v154
v_exp_f16 v150, v151
v_and_b32_e64 v181, s49, v181
v_fma_mix_f32 v156, v138, v138, v156 op_sel:[0,0,0] op_sel_hi:[1,1,0]
v_exp_f16_e64 v147, v148
v_bfe_u32 v180, v181, 2, 14
s_add_u32 m0, s67, 13312
s_add_u32 s66, s66, 98304
buffer_load_dwordx4 v240, s[4:7], s66 offen lds
ds_read_b128 v[228:231], v248 offset:37888
ds_read_u16_d16 v180, v180
v_mfma_f32_32x32x16_bf16 v[120:135], v[56:59], v[232:235], v[120:135]
v_exp_f16_sdwa v153, v154 dst_sel:WORD_1 dst_unused:UNUSED_PRESERVE src0_sel:WORD_1
v_lshrrev_b32_e64 v181, 18, v181
v_fma_mix_f32 v156, v139, v139, v156 op_sel:[1,1,0] op_sel_hi:[1,1,0]
v_exp_f16_sdwa v150, v151 dst_sel:WORD_1 dst_unused:UNUSED_PRESERVE src0_sel:WORD_1
v_exp_f16_sdwa v147, v148 dst_sel:WORD_1 dst_unused:UNUSED_PRESERVE src0_sel:WORD_1
v_and_b32_e64 v183, s49, v183
v_fma_mix_f32 v156, v140, v140, v156 op_sel:[0,0,0] op_sel_hi:[1,1,0]
s_add_u32 m0, s67, 19968
s_add_u32 s66, s66, 98304
buffer_load_dwordx4 v240, s[4:7], s66 offen lds
s_add_u32 m0, s67, 26624
s_add_u32 s66, s66, 98304
buffer_load_dwordx4 v240, s[4:7], s66 offen lds
ds_read_b128 v[232:235], v248 offset:35840
ds_read_u16_d16_hi v181, v181
v_mfma_f32_32x32x16_bf16 v[120:135], v[60:63], v[236:239], v[120:135]
v_pk_add_f16 v153, v153, 1.0 op_sel_hi:[1,0]
v_bfe_u32 v182, v183, 2, 14
v_pk_add_f16 v150, v150, 1.0 op_sel_hi:[1,0]
v_pk_add_f16 v147, v147, 1.0 op_sel_hi:[1,0]
v_rcp_f16 v154, v153
v_lshrrev_b32 v183, 18, v183
v_fma_mix_f32 v156, v141, v141, v156 op_sel:[1,1,0] op_sel_hi:[1,1,0]
v_rcp_f16_e64 v151, v150
s_add_u32 m0, s67, 33280
s_add_u32 s66, s66, 98304
buffer_load_dwordx4 v240, s[4:7], s66 offen lds
ds_read_b128 v[236:239], v248 offset:38912
ds_read_u16_d16 v182, v182
ds_read_u16_d16_hi v183, v183
v_mfma_f32_32x32x16_bf16 v[120:135], v[64:67], v[216:219], v[120:135]
v_and_b32 v185, s49, v185
v_rcp_f16 v148, v147
v_fma_mix_f32 v156, v142, v142, v156 op_sel:[0,0,0] op_sel_hi:[1,1,0]
v_bfe_u32 v184, v185, 2, 14
v_rcp_f16_sdwa v154, v153 dst_sel:WORD_1 dst_unused:UNUSED_PRESERVE src0_sel:WORD_1
v_rcp_f16_sdwa v151, v150 dst_sel:WORD_1 dst_unused:UNUSED_PRESERVE src0_sel:WORD_1
v_lshrrev_b32 v185, 18, v185
s_waitcnt lgkmcnt(4)
s_add_u32 m0, s67, 39936
s_add_u32 s66, s66, 98304
buffer_load_dwordx4 v240, s[4:7], s66 offen lds
ds_read_b128 v[216:219], v248 offset:36864
ds_read_u16_d16 v184, v184
ds_read_u16_d16_hi v185, v185
v_mfma_f32_32x32x16_bf16 v[120:135], v[68:71], v[220:223], v[120:135]
v_fma_mix_f32 v156, v143, v143, v156 op_sel:[1,1,0] op_sel_hi:[1,1,0]
v_rcp_f16_sdwa v148, v147 dst_sel:WORD_1 dst_unused:UNUSED_PRESERVE src0_sel:WORD_1
v_and_b32_e64 v187, s49, v187
v_pk_mul_f16 v155, v155, v154
v_fma_mix_f32 v156, v176, v176, v156 op_sel:[0,0,0] op_sel_hi:[1,1,0]
v_pk_mul_f16 v152, v152, v151
v_bfe_u32 v186, v187, 2, 14
v_pk_mul_f16 v149, v149, v148
v_fma_mix_f32 v157, v155, v155, 0 op_sel:[0,0,0] op_sel_hi:[1,1,0]
s_add_u32 m0, s67, 46592
s_add_u32 s66, s66, 98304
buffer_load_dwordx4 v240, s[4:7], s66 offen lds
v_fma_mix_f32 v157, v155, v155, v157 op_sel:[1,1,0] op_sel_hi:[1,1,0]
v_lshrrev_b32 v187, 18, v187
v_fma_mix_f32 v156, v177, v177, v156 op_sel:[1,1,0] op_sel_hi:[1,1,0]
v_fma_mix_f32 v157, v152, v152, v157 op_sel:[0,0,0] op_sel_hi:[1,1,0]
v_fma_mix_f32 v157, v152, v152, v157 op_sel:[1,1,0] op_sel_hi:[1,1,0]
v_fma_mix_f32 v157, v149, v149, v157 op_sel:[0,0,0] op_sel_hi:[1,1,0]
v_fma_mix_f32 v157, v149, v149, v157 op_sel:[1,1,0] op_sel_hi:[1,1,0]
s_cmp_lt_u32 s40, 4
s_cbranch_scc0 Lsu5
s_waitcnt vmcnt(14)
s_call_b64 s[78:79], Lw1b
s_mov_b64 exec, 1
ds_add_u32 v253, v254 offset:24
s_mov_b64 exec, -1
Lsu5:
s_setprio 1
v_cvt_pkrtz_f16_f32 v137, v120, v121
v_cvt_pkrtz_f16_f32 v139, v122, v123
v_cvt_pkrtz_f16_f32 v141, v124, v125
v_cvt_pkrtz_f16_f32 v143, v126, v127
v_cvt_pkrtz_f16_f32 v177, v128, v129
v_cvt_pk_f16_f32 v155, v130, v131
v_cvt_pk_f16_f32 v152, v132, v133
v_cvt_pk_f16_f32 v149, v134, v135
ds_read_b128 v[220:223], v248 offset:39936
ds_read_u16_d16 v186, v186
ds_read_u16_d16_hi v187, v187
v_mfma_f32_32x32x16_bf16 v[120:135], v[48:51], v[224:227], 0
v_pk_fma_f16 v154, v155, v155, s48
v_and_b32_e64 v137, s49, v137
v_fma_mix_f32 v157, v178, v178, v157 op_sel:[0,0,0] op_sel_hi:[1,1,0]
v_pk_fma_f16 v151, v152, v152, s48
v_pk_fma_f16 v148, v149, v149, s48
v_bfe_u32 v136, v137, 2, 14
v_pk_mul_f16 v154, v155, v154
v_pk_mul_f16 v151, v152, v151
v_fma_mix_f32 v157, v179, v179, v157 op_sel:[1,1,0] op_sel_hi:[1,1,0]
v_lshrrev_b32_e64 v137, 18, v137
ds_read_u16_d16 v136, v136
ds_read_b32 v247, v253 offset:24
ds_read_u16_d16_hi v137, v137
v_mfma_f32_32x32x16_bf16 v[120:135], v[52:55], v[228:231], v[120:135]
v_pk_mul_f16 v148, v149, v148
v_exp_f16 v153, v154
v_exp_f16 v150, v151
v_and_b32_e64 v139, s49, v139
v_fma_mix_f32 v157, v180, v180, v157 op_sel:[0,0,0] op_sel_hi:[1,1,0]
v_exp_f16_e64 v147, v148
v_bfe_u32 v138, v139, 2, 14
ds_read_u16_d16 v138, v138
v_mfma_f32_32x32x16_bf16 v[120:135], v[56:59], v[232:235], v[120:135]
v_exp_f16_sdwa v153, v154 dst_sel:WORD_1 dst_unused:UNUSED_PRESERVE src0_sel:WORD_1
v_lshrrev_b32 v139, 18, v139
s_waitcnt lgkmcnt(4)
v_fma_mix_f32 v157, v181, v181, v157 op_sel:[1,1,0] op_sel_hi:[1,1,0]
v_exp_f16_sdwa v150, v151 dst_sel:WORD_1 dst_unused:UNUSED_PRESERVE src0_sel:WORD_1
v_exp_f16_sdwa v147, v148 dst_sel:WORD_1 dst_unused:UNUSED_PRESERVE src0_sel:WORD_1
v_and_b32 v141, s49, v141
v_fma_mix_f32 v157, v182, v182, v157 op_sel:[0,0,0] op_sel_hi:[1,1,0]
ds_read_u16_d16_hi v139, v139
s_waitcnt lgkmcnt(3)
v_readfirstlane_b32 s43, v247
s_nop 1
s_cmp_ge_u32 s43, 4
s_cbranch_scc1 Lev2
Lev2w:
s_sleep 1
ds_read_b32 v247, v253 offset:24
s_waitcnt lgkmcnt(0)
v_readfirstlane_b32 s43, v247
s_cmp_eq_u32 s76, 0
s_cbranch_scc1 Lev2
s_sub_u32 s76, s76, 1
s_cmp_lt_u32 s43, 4
s_cbranch_scc1 Lev2w
Lev2:
ds_read_b128 v[224:227], v248 offset:40960
ds_read_b128 v[228:231], v248 offset:44032
ds_read_b128 v[232:235], v248 offset:41984
v_mfma_f32_32x32x16_bf16 v[120:135], v[60:63], v[236:239], v[120:135]
v_pk_add_f16 v153, v153, 1.0 op_sel_hi:[1,0]
v_bfe_u32 v140, v141, 2, 14
v_pk_add_f16 v150, v150, 1.0 op_sel_hi:[1,0]
v_pk_add_f16 v147, v147, 1.0 op_sel_hi:[1,0]
v_rcp_f16 v154, v153
v_lshrrev_b32 v141, 18, v141
v_fma_mix_f32 v157, v183, v183, v157 op_sel:[1,1,0] op_sel_hi:[1,1,0]
v_rcp_f16_e64 v151, v150
ds_read_b128 v[236:239], v248 offset:45056
ds_read_u16_d16 v140, v140
ds_read_u16_d16_hi v141, v141
v_mfma_f32_32x32x16_bf16 v[120:135], v[64:67], v[216:219], v[120:135]
v_and_b32 v143, s49, v143
v_rcp_f16 v148, v147
v_fma_mix_f32 v157, v184, v184, v157 op_sel:[0,0,0] op_sel_hi:[1,1,0]
v_bfe_u32 v142, v143, 2, 14
v_rcp_f16_sdwa v154, v153 dst_sel:WORD_1 dst_unused:UNUSED_PRESERVE src0_sel:WORD_1
v_rcp_f16_sdwa v151, v150 dst_sel:WORD_1 dst_unused:UNUSED_PRESERVE src0_sel:WORD_1
v_lshrrev_b32_e64 v143, 18, v143
ds_read_b128 v[216:219], v248 offset:43008
ds_read_u16_d16 v142, v142
ds_read_u16_d16_hi v143, v143
v_mfma_f32_32x32x16_bf16 v[120:135], v[68:71], v[220:223], v[120:135]
v_fma_mix_f32 v157, v185, v185, v157 op_sel:[1,1,0] op_sel_hi:[1,1,0]
v_rcp_f16_sdwa v148, v147 dst_sel:WORD_1 dst_unused:UNUSED_PRESERVE src0_sel:WORD_1
v_and_b32_e64 v177, s49, v177
v_pk_mul_f16 v155, v155, v154
v_fma_mix_f32 v157, v186, v186, v157 op_sel:[0,0,0] op_sel_hi:[1,1,0]
v_pk_mul_f16 v152, v152, v151
v_bfe_u32 v176, v177, 2, 14
v_pk_mul_f16 v149, v149, v148
v_fma_mix_f32 v158, v155, v155, 0 op_sel:[0,0,0] op_sel_hi:[1,1,0]
v_fma_mix_f32 v158, v155, v155, v158 op_sel:[1,1,0] op_sel_hi:[1,1,0]
v_lshrrev_b32_e64 v177, 18, v177
v_fma_mix_f32 v157, v187, v187, v157 op_sel:[1,1,0] op_sel_hi:[1,1,0]
v_fma_mix_f32 v158, v152, v152, v158 op_sel:[0,0,0] op_sel_hi:[1,1,0]
v_fma_mix_f32 v158, v152, v152, v158 op_sel:[1,1,0] op_sel_hi:[1,1,0]
v_fma_mix_f32 v158, v149, v149, v158 op_sel:[0,0,0] op_sel_hi:[1,1,0]
v_fma_mix_f32 v158, v149, v149, v158 op_sel:[1,1,0] op_sel_hi:[1,1,0]
v_cvt_pkrtz_f16_f32 v179, v120, v121
v_cvt_pkrtz_f16_f32 v181, v122, v123
v_cvt_pkrtz_f16_f32 v183, v124, v125
v_cvt_pkrtz_f16_f32 v185, v126, v127
v_cvt_pkrtz_f16_f32 v187, v128, v129
v_cvt_pk_f16_f32 v155, v130, v131
v_cvt_pk_f16_f32 v152, v132, v133
v_cvt_pk_f16_f32 v149, v134, v135
s_waitcnt lgkmcnt(0)
ds_read_b128 v[220:223], v248 offset:46080
ds_read_u16_d16 v176, v176
ds_read_u16_d16_hi v177, v177
v_mfma_f32_32x32x16_bf16 v[120:135], v[48:51], v[224:227], 0
v_pk_fma_f16 v154, v155, v155, s48
v_and_b32 v179, s49, v179
v_fma_mix_f32 v158, v136, v136, v158 op_sel:[0,0,0] op_sel_hi:[1,1,0]
v_pk_fma_f16 v151, v152, v152, s48
v_pk_fma_f16 v148, v149, v149, s48
v_bfe_u32 v178, v179, 2, 14
v_pk_mul_f16 v154, v155, v154
v_pk_mul_f16 v151, v152, v151
v_fma_mix_f32 v158, v137, v137, v158 op_sel:[1,1,0] op_sel_hi:[1,1,0]
v_lshrrev_b32_e64 v179, 18, v179
ds_read_b128 v[224:227], v248 offset:47104
ds_read_u16_d16 v178, v178
ds_read_u16_d16_hi v179, v179
v_mfma_f32_32x32x16_bf16 v[120:135], v[52:55], v[228:231], v[120:135]
v_pk_mul_f16 v148, v149, v148
v_exp_f16 v153, v154
v_exp_f16 v150, v151
v_and_b32_e64 v181, s49, v181
v_fma_mix_f32 v158, v138, v138, v158 op_sel:[0,0,0] op_sel_hi:[1,1,0]
v_exp_f16_e64 v147, v148
v_bfe_u32 v180, v181, 2, 14
ds_read_b128 v[228:231], v248 offset:50176
ds_read_u16_d16 v180, v180
v_mfma_f32_32x32x16_bf16 v[120:135], v[56:59], v[232:235], v[120:135]
v_exp_f16_sdwa v153, v154 dst_sel:WORD_1 dst_unused:UNUSED_PRESERVE src0_sel:WORD_1
v_lshrrev_b32_e64 v181, 18, v181
v_fma_mix_f32 v158, v139, v139, v158 op_sel:[1,1,0] op_sel_hi:[1,1,0]
v_exp_f16_sdwa v150, v151 dst_sel:WORD_1 dst_unused:UNUSED_PRESERVE src0_sel:WORD_1
v_exp_f16_sdwa v147, v148 dst_sel:WORD_1 dst_unused:UNUSED_PRESERVE src0_sel:WORD_1
v_and_b32_e64 v183, s49, v183
v_fma_mix_f32 v158, v140, v140, v158 op_sel:[0,0,0] op_sel_hi:[1,1,0]
ds_read_b128 v[232:235], v248 offset:48128
ds_read_u16_d16_hi v181, v181
v_mfma_f32_32x32x16_bf16 v[120:135], v[60:63], v[236:239], v[120:135]
v_pk_add_f16 v153, v153, 1.0 op_sel_hi:[1,0]
v_bfe_u32 v182, v183, 2, 14
v_pk_add_f16 v150, v150, 1.0 op_sel_hi:[1,0]
v_pk_add_f16 v147, v147, 1.0 op_sel_hi:[1,0]
v_rcp_f16 v154, v153
v_lshrrev_b32 v183, 18, v183
v_fma_mix_f32 v158, v141, v141, v158 op_sel:[1,1,0] op_sel_hi:[1,1,0]
v_rcp_f16_e64 v151, v150
ds_read_b128 v[236:239], v248 offset:51200
ds_read_u16_d16 v182, v182
ds_read_u16_d16_hi v183, v183
v_mfma_f32_32x32x16_bf16 v[120:135], v[64:67], v[216:219], v[120:135]
v_and_b32 v185, s49, v185
v_rcp_f16 v148, v147
v_fma_mix_f32 v158, v142, v142, v158 op_sel:[0,0,0] op_sel_hi:[1,1,0]
v_bfe_u32 v184, v185, 2, 14
v_rcp_f16_sdwa v154, v153 dst_sel:WORD_1 dst_unused:UNUSED_PRESERVE src0_sel:WORD_1
v_rcp_f16_sdwa v151, v150 dst_sel:WORD_1 dst_unused:UNUSED_PRESERVE src0_sel:WORD_1
v_lshrrev_b32 v185, 18, v185
s_waitcnt lgkmcnt(5)
ds_read_b128 v[216:219], v248 offset:49152
ds_read_u16_d16 v184, v184
ds_read_u16_d16_hi v185, v185
v_mfma_f32_32x32x16_bf16 v[120:135], v[68:71], v[220:223], v[120:135]
v_fma_mix_f32 v158, v143, v143, v158 op_sel:[1,1,0] op_sel_hi:[1,1,0]
v_rcp_f16_sdwa v148, v147 dst_sel:WORD_1 dst_unused:UNUSED_PRESERVE src0_sel:WORD_1
s_cmp_eq_u32 s40, 7
s_cbranch_scc1 Lrdy8
s_waitcnt vmcnt(0)
Lrdy8:
s_mov_b64 exec, 1
ds_add_u32 v253, v254 offset:12
s_mov_b64 exec, -1
v_and_b32 v187, s49, v187
v_pk_mul_f16 v155, v155, v154
v_fma_mix_f32 v158, v176, v176, v158 op_sel:[0,0,0] op_sel_hi:[1,1,0]
v_pk_mul_f16 v152, v152, v151
v_bfe_u32 v186, v187, 2, 14
v_pk_mul_f16 v149, v149, v148
v_fma_mix_f32 v159, v155, v155, 0 op_sel:[0,0,0] op_sel_hi:[1,1,0]
v_fma_mix_f32 v159, v155, v155, v159 op_sel:[1,1,0] op_sel_hi:[1,1,0]
v_lshrrev_b32_e64 v187, 18, v187
v_fma_mix_f32 v158, v177, v177, v158 op_sel:[1,1,0] op_sel_hi:[1,1,0]
v_fma_mix_f32 v159, v152, v152, v159 op_sel:[0,0,0] op_sel_hi:[1,1,0]
v_fma_mix_f32 v159, v152, v152, v159 op_sel:[1,1,0] op_sel_hi:[1,1,0]
v_fma_mix_f32 v159, v149, v149, v159 op_sel:[0,0,0] op_sel_hi:[1,1,0]
v_fma_mix_f32 v159, v149, v149, v159 op_sel:[1,1,0] op_sel_hi:[1,1,0]
s_cmp_lt_u32 s40, 4
s_cbranch_scc0 Lsu6
s_waitcnt vmcnt(8)
s_call_b64 s[78:79], Lw1c
s_mov_b64 exec, 1
ds_add_u32 v253, v254 offset:28
s_mov_b64 exec, -1
Lsu6:
v_cvt_pkrtz_f16_f32 v137, v120, v121
v_cvt_pkrtz_f16_f32 v139, v122, v123
v_cvt_pkrtz_f16_f32 v141, v124, v125
v_cvt_pkrtz_f16_f32 v143, v126, v127
v_cvt_pkrtz_f16_f32 v177, v128, v129
v_cvt_pk_f16_f32 v155, v130, v131
v_cvt_pk_f16_f32 v152, v132, v133
v_cvt_pk_f16_f32 v149, v134, v135
s_setprio 0
ds_read_b128 v[220:223], v248 offset:52224
ds_read_u16_d16 v186, v186
ds_read_u16_d16_hi v187, v187
v_mfma_f32_32x32x16_bf16 v[120:135], v[48:51], v[224:227], 0
v_pk_fma_f16 v154, v155, v155, s48
v_and_b32 v137, s49, v137
v_fma_mix_f32 v159, v178, v178, v159 op_sel:[0,0,0] op_sel_hi:[1,1,0]
v_pk_fma_f16 v151, v152, v152, s48
v_pk_fma_f16 v148, v149, v149, s48
v_bfe_u32 v136, v137, 2, 14
v_pk_mul_f16 v154, v155, v154
v_pk_mul_f16 v151, v152, v151
v_fma_mix_f32 v159, v179, v179, v159 op_sel:[1,1,0] op_sel_hi:[1,1,0]
v_lshrrev_b32_e64 v137, 18, v137
ds_read_b128 v[224:227], v250 offset:65520
ds_read_u16_d16 v136, v136
ds_read_u16_d16_hi v137, v137
v_mfma_f32_32x32x16_bf16 v[120:135], v[52:55], v[228:231], v[120:135]
v_pk_mul_f16 v148, v149, v148
v_exp_f16 v153, v154
v_exp_f16 v150, v151
v_and_b32_e64 v139, s49, v139
v_fma_mix_f32 v159, v180, v180, v159 op_sel:[0,0,0] op_sel_hi:[1,1,0]
v_exp_f16 v147, v148
v_bfe_u32 v138, v139, 2, 14
s_waitcnt lgkmcnt(7)
ds_read_b128 v[228:231], v248 offset:53248
ds_read_b32 v247, v253 offset:12
ds_read_u16_d16 v138, v138
v_mfma_f32_32x32x16_bf16 v[120:135], v[56:59], v[232:235], v[120:135]
v_exp_f16_sdwa v153, v154 dst_sel:WORD_1 dst_unused:UNUSED_PRESERVE src0_sel:WORD_1
v_lshrrev_b32_e64 v139, 18, v139
v_fma_mix_f32 v159, v181, v181, v159 op_sel:[1,1,0] op_sel_hi:[1,1,0]
v_exp_f16_sdwa v150, v151 dst_sel:WORD_1 dst_unused:UNUSED_PRESERVE src0_sel:WORD_1
v_exp_f16_sdwa v147, v148 dst_sel:WORD_1 dst_unused:UNUSED_PRESERVE src0_sel:WORD_1
v_and_b32_e64 v141, s49, v141
v_fma_mix_f32 v159, v182, v182, v159 op_sel:[0,0,0] op_sel_hi:[1,1,0]
ds_read_b128 v[232:235], v248 offset:56320
ds_read_u16_d16_hi v139, v139
v_mfma_f32_32x32x16_bf16 v[120:135], v[60:63], v[236:239], v[120:135]
v_pk_add_f16 v153, v153, 1.0 op_sel_hi:[1,0]
v_bfe_u32 v140, v141, 2, 14
v_pk_add_f16 v150, v150, 1.0 op_sel_hi:[1,0]
v_pk_add_f16 v147, v147, 1.0 op_sel_hi:[1,0]
v_rcp_f16 v154, v153
v_lshrrev_b32 v141, 18, v141
ds_read_u16_d16 v140, v140
ds_read_u16_d16_hi v141, v141
s_waitcnt lgkmcnt(5)
v_readfirstlane_b32 s43, v247
s_nop 1
s_cmp_ge_u32 s43, 16
s_cbranch_scc1 Lev3
Lev3w:
s_sleep 1
ds_read_b32 v247, v253 offset:12
s_waitcnt lgkmcnt(0)
v_readfirstlane_b32 s43, v247
s_cmp_eq_u32 s76, 0
s_cbranch_scc1 Lev3
s_sub_u32 s76, s76, 1
s_cmp_lt_u32 s43, 16
s_cbranch_scc1 Lev3w
Lev3:
v_fma_mix_f32 v159, v183, v183, v159 op_sel:[1,1,0] op_sel_hi:[1,1,0]
v_rcp_f16 v151, v150
ds_read_b128 v[236:239], v245 offset:6528
ds_read_b128 v[192:195], v244 offset:128
ds_read_b128 v[196:199], v244 offset:64
v_mfma_f32_32x32x16_bf16 v[120:135], v[64:67], v[216:219], v[120:135]
v_and_b32 v143, s49, v143
v_rcp_f16 v148, v147
v_fma_mix_f32 v159, v184, v184, v159 op_sel:[0,0,0] op_sel_hi:[1,1,0]
v_bfe_u32 v142, v143, 2, 14
v_rcp_f16_sdwa v154, v153 dst_sel:WORD_1 dst_unused:UNUSED_PRESERVE src0_sel:WORD_1
v_rcp_f16_sdwa v151, v150 dst_sel:WORD_1 dst_unused:UNUSED_PRESERVE src0_sel:WORD_1
v_lshrrev_b32_e64 v143, 18, v143
ds_read_b128 v[216:219], v248 offset:54272
ds_read_u16_d16 v142, v142
ds_read_u16_d16_hi v143, v143
v_mfma_f32_32x32x16_bf16 v[120:135], v[68:71], v[220:223], v[120:135]
v_fma_mix_f32 v159, v185, v185, v159 op_sel:[1,1,0] op_sel_hi:[1,1,0]
v_rcp_f16_sdwa v148, v147 dst_sel:WORD_1 dst_unused:UNUSED_PRESERVE src0_sel:WORD_1
v_and_b32_e64 v177, s49, v177
v_pk_mul_f16 v155, v155, v154
v_fma_mix_f32 v159, v186, v186, v159 op_sel:[0,0,0] op_sel_hi:[1,1,0]
v_pk_mul_f16 v152, v152, v151
v_bfe_u32 v176, v177, 2, 14
v_pk_mul_f16 v149, v149, v148
v_fma_mix_f32 v160, v155, v155, 0 op_sel:[0,0,0] op_sel_hi:[1,1,0]
v_fma_mix_f32 v160, v155, v155, v160 op_sel:[1,1,0] op_sel_hi:[1,1,0]
v_lshrrev_b32 v177, 18, v177
v_fma_mix_f32 v159, v187, v187, v159 op_sel:[1,1,0] op_sel_hi:[1,1,0]
v_fma_mix_f32 v160, v152, v152, v160 op_sel:[0,0,0] op_sel_hi:[1,1,0]
v_fma_mix_f32 v160, v152, v152, v160 op_sel:[1,1,0] op_sel_hi:[1,1,0]
v_fma_mix_f32 v160, v149, v149, v160 op_sel:[0,0,0] op_sel_hi:[1,1,0]
v_fma_mix_f32 v160, v149, v149, v160 op_sel:[1,1,0] op_sel_hi:[1,1,0]
s_setprio 2
v_mfma_f32_32x32x16_bf16 v[0:15], v[224:227], v[224:227], 0
ds_read_b128 v[220:223], v245 offset:6144
ds_read_b128 v[200:203], v244
ds_read_b128 v[204:207], v243 offset:128
ds_read_u16_d16 v176, v176
ds_read_u16_d16_hi v177, v177
v_cvt_pkrtz_f16_f32 v179, v120, v121
v_cvt_pkrtz_f16_f32 v181, v122, v123
v_cvt_pkrtz_f16_f32 v183, v124, v125
v_mfma_f32_32x32x16_bf16 v[16:31], v[224:227], v[224:227], 0
v_cvt_pkrtz_f16_f32 v185, v126, v127
v_cvt_pkrtz_f16_f32 v187, v128, v129
v_cvt_pk_f16_f32 v155, v130, v131
v_mfma_f32_32x32x16_bf16 v[32:47], v[224:227], v[224:227], 0
v_cvt_pk_f16_f32 v152, v132, v133
v_cvt_pk_f16_f32 v149, v134, v135
v_pk_fma_f16 v154, v155, v155, s48
v_mfma_f32_32x32x16_bf16 v[120:135], v[48:51], v[228:231], 0
ds_read_b128 v[224:227], v248 offset:57344
v_and_b32 v179, s49, v179
v_fma_mix_f32 v160, v136, v136, v160 op_sel:[0,0,0] op_sel_hi:[1,1,0]
v_pk_fma_f16 v151, v152, v152, s48
v_pk_fma_f16 v148, v149, v149, s48
v_bfe_u32 v178, v179, 2, 14
v_pk_mul_f16 v154, v155, v154
s_waitcnt lgkmcnt(6)
v_mfma_f32_32x32x16_bf16 v[120:135], v[52:55], v[232:235], v[120:135]
ds_read_b128 v[228:231], v245 offset:5760
ds_read_b128 v[208:211], v243 offset:64
ds_read_b128 v[212:215], v243
ds_read_u16_d16 v178, v178
v_pk_mul_f16 v151, v152, v151
v_fma_mix_f32 v160, v137, v137, v160 op_sel:[1,1,0] op_sel_hi:[1,1,0]
v_lshrrev_b32_e64 v179, 18, v179
v_pk_mul_f16 v148, v149, v148
v_exp_f16_e64 v153, v154
v_smfmac_f32_16x16x32_bf16 v[40:43], v[238:239], v[192:195], v246
ds_read_b128 v[232:235], v248 offset:55296
ds_read_u16_d16_hi v179, v179
v_exp_f16 v150, v151
v_and_b32 v181, s49, v181
v_smfmac_f32_16x16x32_bf16 v[24:27], v[236:237], v[196:199], v246
v_fma_mix_f32 v160, v138, v138, v160 op_sel:[0,0,0] op_sel_hi:[1,1,0]
v_exp_f16_e64 v147, v148
v_mfma_f32_32x32x16_bf16 v[120:135], v[56:59], v[216:219], v[120:135]
ds_read_b128 v[236:239], v245 offset:5376
ds_read_b128 v[192:195], v242 offset:128
ds_read_b128 v[196:199], v242 offset:64
v_bfe_u32 v180, v181, 2, 14
v_exp_f16_sdwa v153, v154 dst_sel:WORD_1 dst_unused:UNUSED_PRESERVE src0_sel:WORD_1
v_lshrrev_b32 v181, 18, v181
v_fma_mix_f32 v160, v139, v139, v160 op_sel:[1,1,0] op_sel_hi:[1,1,0]
s_waitcnt lgkmcnt(8)
v_smfmac_f32_16x16x32_bf16 v[8:11], v[222:223], v[200:203], v246
ds_read_b128 v[216:219], v248 offset:58368
ds_read_u16_d16 v180, v180
ds_read_u16_d16_hi v181, v181
v_exp_f16_sdwa v150, v151 dst_sel:WORD_1 dst_unused:UNUSED_PRESERVE src0_sel:WORD_1
v_exp_f16_sdwa v147, v148 dst_sel:WORD_1 dst_unused:UNUSED_PRESERVE src0_sel:WORD_1
v_smfmac_f32_16x16x32_bf16 v[40:43], v[220:221], v[204:207], v246
v_and_b32_e64 v183, s49, v183
v_fma_mix_f32 v160, v140, v140, v160 op_sel:[0,0,0] op_sel_hi:[1,1,0]
v_pk_add_f16 v153, v153, 1.0 op_sel_hi:[1,0]
v_mfma_f32_32x32x16_bf16 v[120:135], v[60:63], v[224:227], v[120:135]
ds_read_b128 v[220:223], v245 offset:4992
ds_read_b128 v[200:203], v242
v_xor_b32 v244, 16, v244
ds_read_b128 v[204:207], v244 offset:128
v_bfe_u32 v182, v183, 2, 14
v_pk_add_f16 v150, v150, 1.0 op_sel_hi:[1,0]
v_pk_add_f16 v147, v147, 1.0 op_sel_hi:[1,0]
v_rcp_f16 v154, v153
v_lshrrev_b32 v183, 18, v183
s_waitcnt lgkmcnt(6)
v_smfmac_f32_16x16x32_bf16 v[24:27], v[230:231], v[208:211], v246
ds_read_b128 v[224:227], v245 offset:4608
ds_read_u16_d16 v182, v182
ds_read_u16_d16_hi v183, v183
v_fma_mix_f32 v160, v141, v141, v160 op_sel:[1,1,0] op_sel_hi:[1,1,0]
v_rcp_f16_e64 v151, v150
v_smfmac_f32_16x16x32_bf16 v[8:11], v[228:229], v[212:215], v246
v_and_b32 v185, s49, v185
v_rcp_f16 v148, v147
v_mfma_f32_32x32x16_bf16 v[120:135], v[64:67], v[232:235], v[120:135]
ds_read_b128 v[208:211], v244 offset:64
ds_read_b128 v[212:215], v244
ds_read_b128 v[228:231], v248 offset:59392
v_fma_mix_f32 v160, v142, v142, v160 op_sel:[0,0,0] op_sel_hi:[1,1,0]
v_bfe_u32 v184, v185, 2, 14
v_rcp_f16_sdwa v154, v153 dst_sel:WORD_1 dst_unused:UNUSED_PRESERVE src0_sel:WORD_1
v_rcp_f16_sdwa v151, v150 dst_sel:WORD_1 dst_unused:UNUSED_PRESERVE src0_sel:WORD_1
v_smfmac_f32_16x16x32_bf16 v[40:43], v[238:239], v[192:195], v246
ds_read_b128 v[232:235], v248 offset:62464
ds_read_u16_d16 v184, v184
ds_read_b32 v247, v253 offset:28
v_lshrrev_b32_e64 v185, 18, v185
v_fma_mix_f32 v160, v143, v143, v160 op_sel:[1,1,0] op_sel_hi:[1,1,0]
v_smfmac_f32_16x16x32_bf16 v[24:27], v[236:237], v[196:199], v246
v_rcp_f16_sdwa v148, v147 dst_sel:WORD_1 dst_unused:UNUSED_PRESERVE src0_sel:WORD_1
v_and_b32 v187, s49, v187
v_pk_mul_f16 v155, v155, v154
s_waitcnt lgkmcnt(7)
v_mfma_f32_32x32x16_bf16 v[120:135], v[68:71], v[216:219], v[120:135]
ds_read_b128 v[236:239], v248 offset:60416
ds_read_u16_d16_hi v185, v185
v_fma_mix_f32 v160, v176, v176, v160 op_sel:[0,0,0] op_sel_hi:[1,1,0]
v_pk_mul_f16 v152, v152, v151
v_bfe_u32 v186, v187, 2, 14
v_pk_mul_f16 v149, v149, v148
v_fma_mix_f32 v161, v155, v155, 0 op_sel:[0,0,0] op_sel_hi:[1,1,0]
v_fma_mix_f32 v161, v155, v155, v161 op_sel:[1,1,0] op_sel_hi:[1,1,0]
v_smfmac_f32_16x16x32_bf16 v[8:11], v[222:223], v[200:203], v246
ds_read_b128 v[216:219], v245 offset:4224
v_xor_b32 v243, 16, v243
ds_read_b128 v[192:195], v243 offset:128
ds_read_b128 v[196:199], v243 offset:64
ds_read_u16_d16 v186, v186
v_lshrrev_b32 v187, 18, v187
v_fma_mix_f32 v160, v177, v177, v160 op_sel:[1,1,0] op_sel_hi:[1,1,0]
v_fma_mix_f32 v161, v152, v152, v161 op_sel:[0,0,0] op_sel_hi:[1,1,0]
v_smfmac_f32_16x16x32_bf16 v[44:47], v[220:221], v[204:207], v246
v_fma_mix_f32 v161, v152, v152, v161 op_sel:[1,1,0] op_sel_hi:[1,1,0]
v_fma_mix_f32 v161, v149, v149, v161 op_sel:[0,0,0] op_sel_hi:[1,1,0]
v_fma_mix_f32 v161, v149, v149, v161 op_sel:[1,1,0] op_sel_hi:[1,1,0]
s_cmp_lg_u32 s40, 7
s_cbranch_scc1 Lnosent
v_mov_b32 v104, -1
v_mov_b32 v105, -1
v_mov_b32 v106, -1
v_mov_b32 v107, -1
v_lshlrev_b32_e64 v100, 12, v251
v_add_u32 v101, 262144, v100
v_cmp_gt_u32 vcc, 32, v251
v_mov_b32 v102, 2147483648
s_nop 0
v_cndmask_b32 v101, v102, v101, vcc
s_lshl_b32 s43, s2, 4
buffer_store_dwordx4 v[104:107], v100, s[32:35], s43 offen sc1
buffer_store_dwordx4 v[104:107], v101, s[32:35], s43 offen sc1
s_add_u32 s43, s43, 393216
s_cmp_lt_u32 s2, 96
s_cselect_b32 s43, s43, 1073741824
v_lshlrev_b32_e64 v102, 11, v251
s_mov_b64 exec, 0xff
buffer_store_dwordx4 v[104:107], v102, s[32:35], s43 offen sc1
s_mov_b64 exec, -1
s_sub_u32 s43, s2, 96
s_cmp_lt_u32 s43, 96
s_cbranch_scc0 Lnobias
s_lshl_b32 s44, s43, 1
v_mul_u32_u24 v100, 192, v251
v_lshlrev_b32 v101, 1, v251
s_add_u32 s45, s44, 0
buffer_load_ushort v102, v100, s[16:19], s45 offen
buffer_load_ushort v108, v101, s[28:31], 0 offen offset:0
s_add_u32 s45, s44, 12288
buffer_load_ushort v103, v100, s[16:19], s45 offen
buffer_load_ushort v109, v101, s[28:31], 0 offen offset:128
s_add_u32 s45, s44, 24576
buffer_load_ushort v104, v100, s[16:19], s45 offen
buffer_load_ushort v110, v101, s[28:31], 0 offen offset:256
s_add_u32 s45, s44, 36864
buffer_load_ushort v105, v100, s[16:19], s45 offen
buffer_load_ushort v111, v101, s[28:31], 0 offen offset:384
s_add_u32 s45, s44, 49152
buffer_load_ushort v106, v100, s[16:19], s45 offen
buffer_load_ushort v112, v101, s[28:31], 0 offen offset:512
s_add_u32 s45, s44, 61440
buffer_load_ushort v107, v100, s[16:19], s45 offen
buffer_load_ushort v113, v101, s[28:31], 0 offen offset:640
Lnobias:
s_nop 1
Lnosent:
ds_read_u16_d16_hi v187, v187
s_waitcnt lgkmcnt(1)
v_readfirstlane_b32 s43, v247
s_nop 1
s_cmp_ge_u32 s43, 12
s_cbranch_scc1 Lev4
Lev4w:
s_sleep 1
ds_read_b32 v247, v253 offset:28
s_waitcnt lgkmcnt(0)
v_readfirstlane_b32 s43, v247
s_cmp_eq_u32 s76, 0
s_cbranch_scc1 Lev4
s_sub_u32 s76, s76, 1
s_cmp_lt_u32 s43, 12
s_cbranch_scc1 Lev4w
Lev4:
s_setprio 1
v_smfmac_f32_16x16x32_bf16 v[28:31], v[226:227], v[208:211], v246
ds_read_b128 v[220:223], v248 offset:63488
v_cvt_pkrtz_f16_f32 v137, v120, v121
v_cvt_pkrtz_f16_f32 v139, v122, v123
v_cvt_pkrtz_f16_f32 v141, v124, v125
v_cvt_pkrtz_f16_f32 v143, v126, v127
v_smfmac_f32_16x16x32_bf16 v[12:15], v[224:225], v[212:215], v246
v_cvt_pk_f16_f32 v155, v128, v129
v_cvt_pk_f16_f32 v152, v130, v131
v_cvt_pk_f16_f32 v149, v132, v133
v_cvt_pk_f16_f32 v146, v134, v135
v_mfma_f32_32x32x16_bf16 v[120:135], v[48:51], v[228:231], 0
ds_read_b128 v[224:227], v248 offset:61440
v_pk_fma_f16 v154, v155, v155, s48
v_and_b32 v137, s49, v137
v_fma_mix_f32 v161, v178, v178, v161 op_sel:[0,0,0] op_sel_hi:[1,1,0]
v_pk_fma_f16 v151, v152, v152, s48
v_pk_fma_f16 v148, v149, v149, s48
v_pk_fma_f16 v145, v146, v146, s48
v_pk_mul_f16 v154, v155, v154
v_bfe_u32 v136, v137, 2, 14
v_pk_mul_f16 v151, v152, v151
v_mfma_f32_32x32x16_bf16 v[120:135], v[52:55], v[232:235], v[120:135]
ds_read_b128 v[228:231], v245 offset:3840
ds_read_b128 v[200:203], v243
v_xor_b32 v242, 16, v242
ds_read_b128 v[204:207], v242 offset:128
ds_read_u16_d16 v136, v136
v_fma_mix_f32 v161, v179, v179, v161 op_sel:[1,1,0] op_sel_hi:[1,1,0]
v_pk_mul_f16 v148, v149, v148
v_pk_mul_f16 v145, v146, v145
v_exp_f16 v153, v154
v_lshrrev_b32 v137, 18, v137
v_exp_f16 v150, v151
v_mfma_f32_32x32x16_bf16 v[120:135], v[56:59], v[236:239], v[120:135]
ds_read_b128 v[232:235], v248 offset:64512
ds_read_u16_d16_hi v137, v137
v_fma_mix_f32 v161, v180, v180, v161 op_sel:[0,0,0] op_sel_hi:[1,1,0]
v_exp_f16 v147, v148
v_and_b32 v139, s49, v139
v_exp_f16_e64 v144, v145
v_exp_f16_sdwa v153, v154 dst_sel:WORD_1 dst_unused:UNUSED_PRESERVE src0_sel:WORD_1
v_fma_mix_f32 v161, v181, v181, v161 op_sel:[1,1,0] op_sel_hi:[1,1,0]
v_smfmac_f32_16x16x32_bf16 v[44:47], v[218:219], v[192:195], v246
ds_read_b128 v[236:239], v245 offset:3456
ds_read_b128 v[208:211], v242 offset:64
ds_read_b128 v[212:215], v242
v_bfe_u32 v138, v139, 2, 14
v_exp_f16_sdwa v150, v151 dst_sel:WORD_1 dst_unused:UNUSED_PRESERVE src0_sel:WORD_1
v_smfmac_f32_16x16x32_bf16 v[28:31], v[216:217], v[196:199], v246
v_exp_f16_sdwa v147, v148 dst_sel:WORD_1 dst_unused:UNUSED_PRESERVE src0_sel:WORD_1
v_exp_f16_sdwa v144, v145 dst_sel:WORD_1 dst_unused:UNUSED_PRESERVE src0_sel:WORD_1
v_lshrrev_b32_e64 v139, 18, v139
s_waitcnt lgkmcnt(5)
v_mfma_f32_32x32x16_bf16 v[120:135], v[60:63], v[220:223], v[120:135]
ds_read_b128 v[216:219], v245 offset:3072
v_xor_b32 v244, 32, v244
ds_read_b128 v[192:195], v244 offset:128
ds_read_b128 v[196:199], v244 offset:64
ds_read_u16_d16 v138, v138
ds_read_u16_d16_hi v139, v139
v_fma_mix_f32 v161, v182, v182, v161 op_sel:[0,0,0] op_sel_hi:[1,1,0]
v_pk_add_f16 v153, v153, 1.0 op_sel_hi:[1,0]
v_pk_add_f16 v150, v150, 1.0 op_sel_hi:[1,0]
v_pk_add_f16 v147, v147, 1.0 op_sel_hi:[1,0]
v_and_b32_e64 v141, s49, v141
v_pk_add_f16 v144, v144, 1.0 op_sel_hi:[1,0]
v_rcp_f16_e64 v154, v153
v_fma_mix_f32 v161, v183, v183, v161 op_sel:[1,1,0] op_sel_hi:[1,1,0]
v_mfma_f32_32x32x16_bf16 v[120:135], v[64:67], v[224:227], v[120:135]
ds_read_b128 v[220:223], v249
v_rcp_f16_e64 v151, v150
v_bfe_u32 v140, v141, 2, 14
v_rcp_f16_e64 v148, v147
v_fma_mix_f32 v161, v184, v184, v161 op_sel:[0,0,0] op_sel_hi:[1,1,0]
v_rcp_f16 v145, v144
v_lshrrev_b32 v141, 18, v141
v_smfmac_f32_16x16x32_bf16 v[12:15], v[230:231], v[200:203], v246
ds_read_b128 v[224:227], v249 offset:3072
ds_read_u16_d16 v140, v140
ds_read_u16_d16_hi v141, v141
v_rcp_f16_sdwa v154, v153 dst_sel:WORD_1 dst_unused:UNUSED_PRESERVE src0_sel:WORD_1
s_setprio 0
v_rcp_f16_sdwa v151, v150 dst_sel:WORD_1 dst_unused:UNUSED_PRESERVE src0_sel:WORD_1
v_smfmac_f32_16x16x32_bf16 v[44:47], v[228:229], v[204:207], v246
v_fma_mix_f32 v161, v185, v185, v161 op_sel:[1,1,0] op_sel_hi:[1,1,0]
v_and_b32 v143, s49, v143
v_rcp_f16_sdwa v148, v147 dst_sel:WORD_1 dst_unused:UNUSED_PRESERVE src0_sel:WORD_1
s_waitcnt lgkmcnt(4)
v_mfma_f32_32x32x16_bf16 v[120:135], v[68:71], v[232:235], v[120:135]
ds_read_b128 v[228:231], v245 offset:2688
ds_read_b128 v[200:203], v244
v_xor_b32 v243, 32, v243
ds_read_b128 v[204:207], v243 offset:128
v_rcp_f16_sdwa v145, v144 dst_sel:WORD_1 dst_unused:UNUSED_PRESERVE src0_sel:WORD_1
v_pk_mul_f16 v155, v155, v154
v_bfe_u32 v142, v143, 2, 14
v_fma_mix_f32 v161, v186, v186, v161 op_sel:[0,0,0] op_sel_hi:[1,1,0]
v_pk_mul_f16 v152, v152, v151
v_pk_mul_f16 v149, v149, v148
v_pk_mul_f16 v146, v146, v145
v_fma_mix_f32 v162, v155, v155, 0 op_sel:[0,0,0] op_sel_hi:[1,1,0]
v_smfmac_f32_16x16x32_bf16 v[28:31], v[238:239], v[208:211], v246
ds_read_b128 v[232:235], v249 offset:1024
ds_read_u16_d16 v142, v142
v_lshrrev_b32_e64 v143, 18, v143
v_fma_mix_f32 v162, v155, v155, v162 op_sel:[1,1,0] op_sel_hi:[1,1,0]
v_fma_mix_f32 v162, v152, v152, v162 op_sel:[0,0,0] op_sel_hi:[1,1,0]
v_fma_mix_f32 v161, v187, v187, v161 op_sel:[1,1,0] op_sel_hi:[1,1,0]
v_smfmac_f32_16x16x32_bf16 v[12:15], v[236:237], v[212:215], v246
v_fma_mix_f32 v162, v152, v152, v162 op_sel:[1,1,0] op_sel_hi:[1,1,0]
v_fma_mix_f32 v162, v149, v149, v162 op_sel:[0,0,0] op_sel_hi:[1,1,0]
v_fma_mix_f32 v162, v149, v149, v162 op_sel:[1,1,0] op_sel_hi:[1,1,0]
v_fma_mix_f32 v162, v146, v146, v162 op_sel:[0,0,0] op_sel_hi:[1,1,0]
v_fma_mix_f32 v162, v146, v146, v162 op_sel:[1,1,0] op_sel_hi:[1,1,0]
v_lshlrev_b32_e64 v252, 7, v251
s_add_u32 s46, s47, 1572864
s_mov_b32 exec_lo, 131071
s_mov_b32 exec_hi, 0
s_mov_b32 m0, 16288
s_nop 0
buffer_load_dword v252, s[4:7], s46 offen lds
s_mov_b64 exec, -1
s_setprio 2
v_smfmac_f32_16x16x32_bf16 v[36:39], v[218:219], v[192:195], v246
ds_read_b128 v[236:239], v249 offset:4096
ds_read_u16_d16_hi v143, v143
v_cvt_pkrtz_f16_f32 v179, v120, v121
v_cvt_pkrtz_f16_f32 v181, v122, v123
v_cvt_pkrtz_f16_f32 v183, v124, v125
v_smfmac_f32_16x16x32_bf16 v[20:23], v[216:217], v[196:199], v246
v_cvt_pkrtz_f16_f32 v185, v126, v127
v_cvt_pkrtz_f16_f32 v187, v128, v129
v_cvt_pk_f16_f32 v155, v130, v131
v_cvt_pk_f16_f32 v152, v132, v133
v_cvt_pk_f16_f32 v149, v134, v135
s_waitcnt lgkmcnt(2)
v_mfma_f32_32x32x16_bf16 v[120:135], v[48:51], v[220:223], 0
ds_read_b128 v[216:219], v245 offset:2304
ds_read_b128 v[208:211], v243 offset:64
ds_read_b128 v[212:215], v243
v_pk_fma_f16 v154, v155, v155, s48
v_and_b32 v179, s49, v179
v_fma_mix_f32 v162, v136, v136, v162 op_sel:[0,0,0] op_sel_hi:[1,1,0]
v_pk_fma_f16 v151, v152, v152, s48
v_pk_fma_f16 v148, v149, v149, s48
v_mfma_f32_32x32x16_bf16 v[120:135], v[52:55], v[224:227], v[120:135]
ds_read_b128 v[220:223], v249 offset:2048
v_bfe_u32 v178, v179, 2, 14
v_pk_mul_f16 v154, v155, v154
v_pk_mul_f16 v151, v152, v151
v_pk_mul_f16 v148, v149, v148
v_lshrrev_b32 v179, 18, v179
v_fma_mix_f32 v162, v137, v137, v162 op_sel:[1,1,0] op_sel_hi:[1,1,0]
v_smfmac_f32_16x16x32_bf16 v[4:7], v[230:231], v[200:203], v246
ds_read_b128 v[224:227], v245 offset:1920
v_xor_b32 v242, 32, v242
ds_read_b128 v[192:195], v242 offset:128
ds_read_b128 v[196:199], v242 offset:64
ds_read_u16_d16 v178, v178
ds_read_u16_d16_hi v179, v179
v_exp_f16 v153, v154
v_and_b32 v181, s49, v181
v_smfmac_f32_16x16x32_bf16 v[36:39], v[228:229], v[204:207], v246
v_exp_f16 v150, v151
v_exp_f16 v147, v148
v_mfma_f32_32x32x16_bf16 v[120:135], v[56:59], v[232:235], v[120:135]
ds_read_b128 v[228:231], v249 offset:5120
v_bfe_u32 v180, v181, 2, 14
v_fma_mix_f32 v162, v138, v138, v162 op_sel:[0,0,0] op_sel_hi:[1,1,0]
v_exp_f16_sdwa v153, v154 dst_sel:WORD_1 dst_unused:UNUSED_PRESERVE src0_sel:WORD_1
v_lshrrev_b32_e64 v181, 18, v181
v_exp_f16_sdwa v150, v151 dst_sel:WORD_1 dst_unused:UNUSED_PRESERVE src0_sel:WORD_1
s_waitcnt lgkmcnt(6)
v_mfma_f32_32x32x16_bf16 v[120:135], v[60:63], v[236:239], v[120:135]
ds_read_b128 v[232:235], v245 offset:1536
ds_read_b128 v[200:203], v242
v_xor_b32 v244, 16, v244
ds_read_b128 v[204:207], v244 offset:128
ds_read_u16_d16 v180, v180
ds_read_u16_d16_hi v181, v181
v_fma_mix_f32 v162, v139, v139, v162 op_sel:[1,1,0] op_sel_hi:[1,1,0]
v_and_b32_e64 v183, s49, v183
v_exp_f16_sdwa v147, v148 dst_sel:WORD_1 dst_unused:UNUSED_PRESERVE src0_sel:WORD_1
v_pk_add_f16 v153, v153, 1.0 op_sel_hi:[1,0]
v_bfe_u32 v182, v183, 2, 14
v_smfmac_f32_16x16x32_bf16 v[20:23], v[218:219], v[208:211], v246
ds_read_b128 v[236:239], v245 offset:1152
ds_read_u16_d16 v182, v182
v_pk_add_f16 v150, v150, 1.0 op_sel_hi:[1,0]
v_pk_add_f16 v147, v147, 1.0 op_sel_hi:[1,0]
v_rcp_f16_e64 v154, v153
v_smfmac_f32_16x16x32_bf16 v[4:7], v[216:217], v[212:215], v246
v_lshrrev_b32_e64 v183, 18, v183
v_fma_mix_f32 v162, v140, v140, v162 op_sel:[0,0,0] op_sel_hi:[1,1,0]
v_mfma_f32_32x32x16_bf16 v[120:135], v[64:67], v[220:223], v[120:135]
ds_read_b128 v[208:211], v244 offset:64
ds_read_b128 v[212:215], v244
ds_read_b128 v[216:219], v249 offset:6144
ds_read_u16_d16_hi v183, v183
v_rcp_f16 v151, v150
v_and_b32 v185, s49, v185
v_rcp_f16 v148, v147
v_fma_mix_f32 v162, v141, v141, v162 op_sel:[1,1,0] op_sel_hi:[1,1,0]
v_bfe_u32 v184, v185, 2, 14
s_waitcnt lgkmcnt(6)
v_smfmac_f32_16x16x32_bf16 v[36:39], v[226:227], v[192:195], v246
ds_read_b128 v[220:223], v249 offset:9216
ds_read_u16_d16 v184, v184
v_rcp_f16_sdwa v154, v153 dst_sel:WORD_1 dst_unused:UNUSED_PRESERVE src0_sel:WORD_1
v_rcp_f16_sdwa v151, v150 dst_sel:WORD_1 dst_unused:UNUSED_PRESERVE src0_sel:WORD_1
v_smfmac_f32_16x16x32_bf16 v[20:23], v[224:225], v[196:199], v246
v_lshrrev_b32_e64 v185, 18, v185
v_rcp_f16_sdwa v148, v147 dst_sel:WORD_1 dst_unused:UNUSED_PRESERVE src0_sel:WORD_1
v_mfma_f32_32x32x16_bf16 v[120:135], v[68:71], v[228:231], v[120:135]
ds_read_b128 v[224:227], v249 offset:7168
ds_read_u16_d16_hi v185, v185
v_and_b32_e64 v187, s49, v187
v_fma_mix_f32 v162, v142, v142, v162 op_sel:[0,0,0] op_sel_hi:[1,1,0]
v_pk_mul_f16 v155, v155, v154
v_pk_mul_f16 v152, v152, v151
v_bfe_u32 v186, v187, 2, 14
v_pk_mul_f16 v149, v149, v148
v_fma_mix_f32 v163, v155, v155, 0 op_sel:[0,0,0] op_sel_hi:[1,1,0]
v_smfmac_f32_16x16x32_bf16 v[4:7], v[234:235], v[200:203], v246
ds_read_b128 v[228:231], v245 offset:768
v_xor_b32 v243, 16, v243
ds_read_b128 v[192:195], v243 offset:128
ds_read_b128 v[196:199], v243 offset:64
ds_read_u16_d16 v186, v186
v_fma_mix_f32 v162, v143, v143, v162 op_sel:[1,1,0] op_sel_hi:[1,1,0]
v_lshrrev_b32 v187, 18, v187
v_fma_mix_f32 v163, v155, v155, v163 op_sel:[1,1,0] op_sel_hi:[1,1,0]
v_smfmac_f32_16x16x32_bf16 v[32:35], v[232:233], v[204:207], v246
v_fma_mix_f32 v163, v152, v152, v163 op_sel:[0,0,0] op_sel_hi:[1,1,0]
v_fma_mix_f32 v163, v152, v152, v163 op_sel:[1,1,0] op_sel_hi:[1,1,0]
v_fma_mix_f32 v163, v149, v149, v163 op_sel:[0,0,0] op_sel_hi:[1,1,0]
v_fma_mix_f32 v163, v149, v149, v163 op_sel:[1,1,0] op_sel_hi:[1,1,0]
v_lshlrev_b32 v252, 7, v251
s_add_u32 s46, s47, 1572864
s_mov_b32 exec_lo, 4294836224
s_mov_b32 exec_hi, 3
s_mov_b32 m0, 16220
s_nop 0
buffer_load_dword v252, s[4:7], s46 offen lds
s_mov_b64 exec, -1
s_setprio 1
s_waitcnt lgkmcnt(4)
v_smfmac_f32_16x16x32_bf16 v[16:19], v[238:239], v[208:211], v246
ds_read_b128 v[232:235], v249 offset:10240
ds_read_u16_d16_hi v187, v187
v_cvt_pkrtz_f16_f32 v137, v120, v121
v_cvt_pkrtz_f16_f32 v139, v122, v123
v_cvt_pkrtz_f16_f32 v141, v124, v125
v_smfmac_f32_16x16x32_bf16 v[0:3], v[236:237], v[212:215], v246
v_cvt_pkrtz_f16_f32 v143, v126, v127
v_cvt_pk_f16_f32 v155, v128, v129
v_cvt_pk_f16_f32 v152, v130, v131
v_cvt_pk_f16_f32 v149, v132, v133
v_cvt_pk_f16_f32 v146, v134, v135
v_mfma_f32_32x32x16_bf16 v[120:135], v[48:51], v[216:219], 0
ds_read_b128 v[236:239], v249 offset:8192
v_pk_fma_f16 v154, v155, v155, s48
v_and_b32_e64 v137, s49, v137
v_fma_mix_f32 v163, v178, v178, v163 op_sel:[0,0,0] op_sel_hi:[1,1,0]
v_pk_fma_f16 v151, v152, v152, s48
v_pk_fma_f16 v148, v149, v149, s48
v_pk_fma_f16 v145, v146, v146, s48
v_pk_mul_f16 v154, v155, v154
v_mfma_f32_32x32x16_bf16 v[120:135], v[52:55], v[220:223], v[120:135]
ds_read_b128 v[216:219], v245 offset:384
ds_read_b128 v[200:203], v243
v_xor_b32 v242, 16, v242
ds_read_b128 v[204:207], v242 offset:128
v_bfe_u32 v136, v137, 2, 14
v_pk_mul_f16 v151, v152, v151
v_fma_mix_f32 v163, v179, v179, v163 op_sel:[1,1,0] op_sel_hi:[1,1,0]
v_pk_mul_f16 v148, v149, v148
v_pk_mul_f16 v145, v146, v145
v_exp_f16 v153, v154
v_lshrrev_b32_e64 v137, 18, v137
v_mfma_f32_32x32x16_bf16 v[120:135], v[56:59], v[224:227], v[120:135]
ds_read_b128 v[220:223], v249 offset:11264
ds_read_u16_d16 v136, v136
ds_read_u16_d16_hi v137, v137
v_exp_f16_e64 v150, v151
v_fma_mix_f32 v163, v180, v180, v163 op_sel:[0,0,0] op_sel_hi:[1,1,0]
v_exp_f16 v147, v148
v_and_b32 v139, s49, v139
v_exp_f16 v144, v145
s_waitcnt lgkmcnt(6)
v_smfmac_f32_16x16x32_bf16 v[32:35], v[230:231], v[192:195], v246
ds_read_b128 v[224:227], v245
ds_read_b128 v[208:211], v242 offset:64
ds_read_b128 v[212:215], v242
v_exp_f16_sdwa v153, v154 dst_sel:WORD_1 dst_unused:UNUSED_PRESERVE src0_sel:WORD_1
v_fma_mix_f32 v163, v181, v181, v163 op_sel:[1,1,0] op_sel_hi:[1,1,0]
v_bfe_u32 v138, v139, 2, 14
v_smfmac_f32_16x16x32_bf16 v[16:19], v[228:229], v[196:199], v246
v_exp_f16_sdwa v150, v151 dst_sel:WORD_1 dst_unused:UNUSED_PRESERVE src0_sel:WORD_1
v_mfma_f32_32x32x16_bf16 v[120:135], v[60:63], v[232:235], v[120:135]
ds_read_b128 v[228:231], v249 offset:12288
ds_read_u16_d16 v138, v138
v_exp_f16_sdwa v147, v148 dst_sel:WORD_1 dst_unused:UNUSED_PRESERVE src0_sel:WORD_1
v_exp_f16_sdwa v144, v145 dst_sel:WORD_1 dst_unused:UNUSED_PRESERVE src0_sel:WORD_1
v_lshrrev_b32_e64 v139, 18, v139
v_fma_mix_f32 v163, v182, v182, v163 op_sel:[0,0,0] op_sel_hi:[1,1,0]
v_pk_add_f16 v153, v153, 1.0 op_sel_hi:[1,0]
v_pk_add_f16 v150, v150, 1.0 op_sel_hi:[1,0]
v_pk_add_f16 v147, v147, 1.0 op_sel_hi:[1,0]
v_mfma_f32_32x32x16_bf16 v[120:135], v[64:67], v[236:239], v[120:135]
ds_read_b128 v[232:235], v249 offset:15360
ds_read_u16_d16_hi v139, v139
v_and_b32_e64 v141, s49, v141
v_pk_add_f16 v144, v144, 1.0 op_sel_hi:[1,0]
v_rcp_f16_e64 v154, v153
v_fma_mix_f32 v163, v183, v183, v163 op_sel:[1,1,0] op_sel_hi:[1,1,0]
v_rcp_f16 v151, v150
v_bfe_u32 v140, v141, 2, 14
s_waitcnt lgkmcnt(4)
v_smfmac_f32_16x16x32_bf16 v[0:3], v[218:219], v[200:203], v246
ds_read_b128 v[236:239], v249 offset:13312
ds_read_u16_d16 v140, v140
v_rcp_f16_e64 v148, v147
v_fma_mix_f32 v163, v184, v184, v163 op_sel:[0,0,0] op_sel_hi:[1,1,0]
v_smfmac_f32_16x16x32_bf16 v[32:35], v[216:217], v[204:207], v246
v_rcp_f16_e64 v145, v144
v_lshrrev_b32 v141, 18, v141
v_rcp_f16_sdwa v154, v153 dst_sel:WORD_1 dst_unused:UNUSED_PRESERVE src0_sel:WORD_1
s_setprio 0
v_mfma_f32_32x32x16_bf16 v[120:135], v[68:71], v[220:223], v[120:135]
ds_read_b128 v[216:219], v249 offset:16384
ds_read_u16_d16_hi v141, v141
v_rcp_f16_sdwa v151, v150 dst_sel:WORD_1 dst_unused:UNUSED_PRESERVE src0_sel:WORD_1
v_fma_mix_f32 v163, v185, v185, v163 op_sel:[1,1,0] op_sel_hi:[1,1,0]
v_and_b32_e64 v143, s49, v143
v_rcp_f16_sdwa v148, v147 dst_sel:WORD_1 dst_unused:UNUSED_PRESERVE src0_sel:WORD_1
v_rcp_f16_sdwa v145, v144 dst_sel:WORD_1 dst_unused:UNUSED_PRESERVE src0_sel:WORD_1
v_smfmac_f32_16x16x32_bf16 v[16:19], v[226:227], v[208:211], v246
ds_read_b128 v[220:223], v249 offset:14336
v_pk_mul_f16 v155, v155, v154
v_bfe_u32 v142, v143, 2, 14
v_fma_mix_f32 v163, v186, v186, v163 op_sel:[0,0,0] op_sel_hi:[1,1,0]
v_pk_mul_f16 v152, v152, v151
v_smfmac_f32_16x16x32_bf16 v[0:3], v[224:225], v[212:215], v246
s_mov_b64 exec, 1
ds_add_u32 v253, v254 offset:16
s_mov_b64 exec, -1
v_pk_mul_f16 v149, v149, v148
v_pk_mul_f16 v146, v146, v145
v_fma_mix_f32 v164, v155, v155, 0 op_sel:[0,0,0] op_sel_hi:[1,1,0]
v_lshrrev_b32 v143, 18, v143
v_fma_mix_f32 v164, v155, v155, v164 op_sel:[1,1,0] op_sel_hi:[1,1,0]
v_fma_mix_f32 v164, v152, v152, v164 op_sel:[0,0,0] op_sel_hi:[1,1,0]
v_fma_mix_f32 v163, v187, v187, v163 op_sel:[1,1,0] op_sel_hi:[1,1,0]
v_fma_mix_f32 v164, v152, v152, v164 op_sel:[1,1,0] op_sel_hi:[1,1,0]
v_fma_mix_f32 v164, v149, v149, v164 op_sel:[0,0,0] op_sel_hi:[1,1,0]
v_fma_mix_f32 v164, v149, v149, v164 op_sel:[1,1,0] op_sel_hi:[1,1,0]
v_fma_mix_f32 v164, v146, v146, v164 op_sel:[0,0,0] op_sel_hi:[1,1,0]
v_fma_mix_f32 v164, v146, v146, v164 op_sel:[1,1,0] op_sel_hi:[1,1,0]
s_setprio 3
v_pk_add_f32 v[168:169], v[0:1], v[2:3]
v_pk_mul_f32 v[170:171], v[0:1], v[0:1]
v_pk_fma_f32 v[170:171], v[2:3], v[2:3], v[170:171]
v_pk_add_f32 v[168:169], v[168:169], v[4:5]
v_pk_fma_f32 v[170:171], v[4:5], v[4:5], v[170:171]
v_pk_add_f32 v[168:169], v[168:169], v[6:7]
v_pk_fma_f32 v[170:171], v[6:7], v[6:7], v[170:171]
v_pk_add_f32 v[168:169], v[168:169], v[8:9]
v_pk_fma_f32 v[170:171], v[8:9], v[8:9], v[170:171]
v_pk_add_f32 v[168:169], v[168:169], v[10:11]
v_pk_fma_f32 v[170:171], v[10:11], v[10:11], v[170:171]
v_pk_add_f32 v[168:169], v[168:169], v[12:13]
v_pk_fma_f32 v[170:171], v[12:13], v[12:13], v[170:171]
v_pk_add_f32 v[168:169], v[168:169], v[14:15]
v_pk_fma_f32 v[170:171], v[14:15], v[14:15], v[170:171]
v_pk_add_f32 v[168:169], v[168:169], v[16:17]
v_pk_fma_f32 v[170:171], v[16:17], v[16:17], v[170:171]
v_pk_add_f32 v[168:169], v[168:169], v[18:19]
v_pk_fma_f32 v[170:171], v[18:19], v[18:19], v[170:171]
v_pk_add_f32 v[168:169], v[168:169], v[20:21]
v_pk_fma_f32 v[170:171], v[20:21], v[20:21], v[170:171]
v_pk_add_f32 v[168:169], v[168:169], v[22:23]
v_pk_fma_f32 v[170:171], v[22:23], v[22:23], v[170:171]
v_pk_add_f32 v[168:169], v[168:169], v[24:25]
v_pk_fma_f32 v[170:171], v[24:25], v[24:25], v[170:171]
v_pk_add_f32 v[168:169], v[168:169], v[26:27]
v_pk_fma_f32 v[170:171], v[26:27], v[26:27], v[170:171]
v_pk_add_f32 v[168:169], v[168:169], v[28:29]
v_pk_fma_f32 v[170:171], v[28:29], v[28:29], v[170:171]
v_pk_add_f32 v[168:169], v[168:169], v[30:31]
v_pk_fma_f32 v[170:171], v[30:31], v[30:31], v[170:171]
v_pk_add_f32 v[168:169], v[168:169], v[32:33]
v_pk_fma_f32 v[170:171], v[32:33], v[32:33], v[170:171]
v_pk_add_f32 v[168:169], v[168:169], v[34:35]
v_pk_fma_f32 v[170:171], v[34:35], v[34:35], v[170:171]
v_pk_add_f32 v[168:169], v[168:169], v[36:37]
v_pk_fma_f32 v[170:171], v[36:37], v[36:37], v[170:171]
v_pk_add_f32 v[168:169], v[168:169], v[38:39]
v_pk_fma_f32 v[170:171], v[38:39], v[38:39], v[170:171]
v_pk_add_f32 v[168:169], v[168:169], v[40:41]
v_pk_fma_f32 v[170:171], v[40:41], v[40:41], v[170:171]
v_pk_add_f32 v[168:169], v[168:169], v[42:43]
v_pk_fma_f32 v[170:171], v[42:43], v[42:43], v[170:171]
v_pk_add_f32 v[168:169], v[168:169], v[44:45]
v_pk_fma_f32 v[170:171], v[44:45], v[44:45], v[170:171]
v_pk_add_f32 v[168:169], v[168:169], v[46:47]
v_pk_fma_f32 v[170:171], v[46:47], v[46:47], v[170:171]
s_setprio 0
v_add_u32 v174, -36864, v242
v_subrev_u32 v175, 66560, v174
v_min_u32 v174, v174, v175
v_add_u32 v174, 90112, v174
v_sub_u32 v175, v174, v242
v_add_u32 v242, v175, v242
v_add_u32 v243, v175, v243
v_add_u32 v244, v175, v244
v_lshlrev_b32_e64 v252, 7, v251
s_add_u32 s46, s47, 1572864
s_mov_b32 exec_lo, 0
s_mov_b32 exec_hi, 1048572
s_mov_b32 m0, 16152
s_nop 0
buffer_load_dword v252, s[4:7], s46 offen lds
s_mov_b64 exec, -1
s_setprio 2
v_cvt_pkrtz_f16_f32 v179, v120, v121
v_cvt_pkrtz_f16_f32 v181, v122, v123
v_cvt_pkrtz_f16_f32 v183, v124, v125
v_cvt_pkrtz_f16_f32 v185, v126, v127
v_cvt_pkrtz_f16_f32 v187, v128, v129
v_cvt_pkrtz_f16_f32 v189, v130, v131
v_cvt_pk_f16_f32 v155, v132, v133
v_cvt_pk_f16_f32 v152, v134, v135
s_waitcnt lgkmcnt(1)
ds_read_b128 v[224:227], v249 offset:17408
ds_read_u16_d16 v142, v142
ds_read_u16_d16_hi v143, v143
v_mfma_f32_32x32x16_bf16 v[120:135], v[48:51], v[228:231], 0
v_pk_fma_f16 v154, v155, v155, s48
v_add_f32 v168, v168, v169
v_and_b32_e64 v179, s49, v179
v_fma_mix_f32 v164, v136, v136, v164 op_sel:[0,0,0] op_sel_hi:[1,1,0]
v_bfe_u32 v178, v179, 2, 14
v_add_f32_e64 v170, v170, v171
v_pk_fma_f16 v151, v152, v152, s48
v_pk_mul_f16 v154, v155, v154
v_lshrrev_b32_e64 v179, 18, v179
v_pk_mul_f16 v151, v152, v151
ds_read_b128 v[228:231], v249 offset:18432
ds_read_u16_d16 v178, v178
ds_read_u16_d16_hi v179, v179
v_mfma_f32_32x32x16_bf16 v[120:135], v[52:55], v[232:235], v[120:135]
v_permlane32_swap_b32 v168, v170
v_fma_mix_f32 v164, v137, v137, v164 op_sel:[1,1,0] op_sel_hi:[1,1,0]
v_and_b32 v181, s49, v181
v_exp_f16 v153, v154
v_add_f32 v168, v168, v170
v_bfe_u32 v180, v181, 2, 14
v_exp_f16 v150, v151
v_lshrrev_b32 v181, 18, v181
ds_read_b128 v[232:235], v249 offset:21504
ds_read_u16_d16 v180, v180
ds_read_u16_d16_hi v181, v181
v_mfma_f32_32x32x16_bf16 v[120:135], v[56:59], v[236:239], v[120:135]
v_mul_f32 v168, 1009429163, v168
v_fma_mix_f32 v164, v138, v138, v164 op_sel:[0,0,0] op_sel_hi:[1,1,0]
v_exp_f16_sdwa v153, v154 dst_sel:WORD_1 dst_unused:UNUSED_PRESERVE src0_sel:WORD_1
v_and_b32 v183, s49, v183
v_mov_b32 v170, v168
v_exp_f16_sdwa v150, v151 dst_sel:WORD_1 dst_unused:UNUSED_PRESERVE src0_sel:WORD_1
v_bfe_u32 v182, v183, 2, 14
v_fma_mix_f32 v164, v139, v139, v164 op_sel:[1,1,0] op_sel_hi:[1,1,0]
v_permlane32_swap_b32 v168, v170
ds_read_b128 v[236:239], v249 offset:19456
ds_read_u16_d16 v182, v182
v_mfma_f32_32x32x16_bf16 v[120:135], v[60:63], v[216:219], v[120:135]
v_lshrrev_b32 v183, 18, v183
v_pk_add_f16 v153, v153, 1.0 op_sel_hi:[1,0]
v_pk_add_f16 v150, v150, 1.0 op_sel_hi:[1,0]
v_and_b32_e64 v185, s49, v185
v_fma_f32 v170, -v168, v168, v170
v_rcp_f16_e64 v154, v153
v_bfe_u32 v184, v185, 2, 14
v_max_f32_e64 v170, 0, v170
v_fma_mix_f32 v164, v140, v140, v164 op_sel:[0,0,0] op_sel_hi:[1,1,0]
ds_read_b128 v[216:219], v249 offset:22528
ds_read_u16_d16_hi v183, v183
ds_read_u16_d16 v184, v184
v_mfma_f32_32x32x16_bf16 v[120:135], v[64:67], v[220:223], v[120:135]
v_lshrrev_b32 v185, 18, v185
v_rcp_f16 v151, v150
v_add_f32 v170, 925353388, v170
v_and_b32_e64 v187, s49, v187
v_fma_mix_f32 v164, v141, v141, v164 op_sel:[1,1,0] op_sel_hi:[1,1,0]
v_rcp_f16_sdwa v154, v153 dst_sel:WORD_1 dst_unused:UNUSED_PRESERVE src0_sel:WORD_1
v_rsq_f32 v170, v170
s_waitcnt lgkmcnt(5)
ds_read_b128 v[220:223], v249 offset:20480
ds_read_u16_d16_hi v185, v185
ds_read_b32 v247, v253 offset:16
v_mfma_f32_32x32x16_bf16 v[120:135], v[68:71], v[224:227], v[120:135]
v_bfe_u32 v186, v187, 2, 14
v_rcp_f16_sdwa v151, v150 dst_sel:WORD_1 dst_unused:UNUSED_PRESERVE src0_sel:WORD_1
v_lshrrev_b32_e64 v187, 18, v187
v_fma_mix_f32 v164, v142, v142, v164 op_sel:[0,0,0] op_sel_hi:[1,1,0]
v_and_b32_e64 v189, s49, v189
v_pk_mul_f16 v155, v155, v154
v_pk_mul_f16 v152, v152, v151
v_mul_f32 v172, 3203391086, v170
v_bfe_u32 v188, v189, 2, 14
v_fma_mix_f32 v165, v155, v155, 0 op_sel:[0,0,0] op_sel_hi:[1,1,0]
v_fma_mix_f32 v164, v143, v143, v164 op_sel:[1,1,0] op_sel_hi:[1,1,0]
v_lshrrev_b32_e64 v189, 18, v189
v_mul_f32 v173, v168, v172
v_fma_mix_f32 v165, v155, v155, v165 op_sel:[1,1,0] op_sel_hi:[1,1,0]
v_fma_mix_f32 v165, v152, v152, v165 op_sel:[0,0,0] op_sel_hi:[1,1,0]
v_fma_mix_f32 v165, v152, v152, v165 op_sel:[1,1,0] op_sel_hi:[1,1,0]
s_setprio 3
v_pk_fma_f32 v[0:1], v[0:1], v[172:173], v[172:173] op_sel:[0,0,1] op_sel_hi:[1,0,1] neg_lo:[0,0,1] neg_hi:[0,0,1]
v_pk_fma_f32 v[2:3], v[2:3], v[172:173], v[172:173] op_sel:[0,0,1] op_sel_hi:[1,0,1] neg_lo:[0,0,1] neg_hi:[0,0,1]
v_pk_fma_f32 v[4:5], v[4:5], v[172:173], v[172:173] op_sel:[0,0,1] op_sel_hi:[1,0,1] neg_lo:[0,0,1] neg_hi:[0,0,1]
v_pk_fma_f32 v[6:7], v[6:7], v[172:173], v[172:173] op_sel:[0,0,1] op_sel_hi:[1,0,1] neg_lo:[0,0,1] neg_hi:[0,0,1]
v_pk_fma_f32 v[8:9], v[8:9], v[172:173], v[172:173] op_sel:[0,0,1] op_sel_hi:[1,0,1] neg_lo:[0,0,1] neg_hi:[0,0,1]
v_pk_fma_f32 v[10:11], v[10:11], v[172:173], v[172:173] op_sel:[0,0,1] op_sel_hi:[1,0,1] neg_lo:[0,0,1] neg_hi:[0,0,1]
v_pk_fma_f32 v[12:13], v[12:13], v[172:173], v[172:173] op_sel:[0,0,1] op_sel_hi:[1,0,1] neg_lo:[0,0,1] neg_hi:[0,0,1]
v_pk_fma_f32 v[14:15], v[14:15], v[172:173], v[172:173] op_sel:[0,0,1] op_sel_hi:[1,0,1] neg_lo:[0,0,1] neg_hi:[0,0,1]
v_pk_fma_f32 v[16:17], v[16:17], v[172:173], v[172:173] op_sel:[0,0,1] op_sel_hi:[1,0,1] neg_lo:[0,0,1] neg_hi:[0,0,1]
v_pk_fma_f32 v[18:19], v[18:19], v[172:173], v[172:173] op_sel:[0,0,1] op_sel_hi:[1,0,1] neg_lo:[0,0,1] neg_hi:[0,0,1]
v_pk_fma_f32 v[20:21], v[20:21], v[172:173], v[172:173] op_sel:[0,0,1] op_sel_hi:[1,0,1] neg_lo:[0,0,1] neg_hi:[0,0,1]
v_pk_fma_f32 v[22:23], v[22:23], v[172:173], v[172:173] op_sel:[0,0,1] op_sel_hi:[1,0,1] neg_lo:[0,0,1] neg_hi:[0,0,1]
v_pk_fma_f32 v[24:25], v[24:25], v[172:173], v[172:173] op_sel:[0,0,1] op_sel_hi:[1,0,1] neg_lo:[0,0,1] neg_hi:[0,0,1]
v_pk_fma_f32 v[26:27], v[26:27], v[172:173], v[172:173] op_sel:[0,0,1] op_sel_hi:[1,0,1] neg_lo:[0,0,1] neg_hi:[0,0,1]
v_pk_fma_f32 v[28:29], v[28:29], v[172:173], v[172:173] op_sel:[0,0,1] op_sel_hi:[1,0,1] neg_lo:[0,0,1] neg_hi:[0,0,1]
v_pk_fma_f32 v[30:31], v[30:31], v[172:173], v[172:173] op_sel:[0,0,1] op_sel_hi:[1,0,1] neg_lo:[0,0,1] neg_hi:[0,0,1]
v_pk_fma_f32 v[32:33], v[32:33], v[172:173], v[172:173] op_sel:[0,0,1] op_sel_hi:[1,0,1] neg_lo:[0,0,1] neg_hi:[0,0,1]
v_pk_fma_f32 v[34:35], v[34:35], v[172:173], v[172:173] op_sel:[0,0,1] op_sel_hi:[1,0,1] neg_lo:[0,0,1] neg_hi:[0,0,1]
v_pk_fma_f32 v[36:37], v[36:37], v[172:173], v[172:173] op_sel:[0,0,1] op_sel_hi:[1,0,1] neg_lo:[0,0,1] neg_hi:[0,0,1]
v_pk_fma_f32 v[38:39], v[38:39], v[172:173], v[172:173] op_sel:[0,0,1] op_sel_hi:[1,0,1] neg_lo:[0,0,1] neg_hi:[0,0,1]
v_pk_fma_f32 v[40:41], v[40:41], v[172:173], v[172:173] op_sel:[0,0,1] op_sel_hi:[1,0,1] neg_lo:[0,0,1] neg_hi:[0,0,1]
v_pk_fma_f32 v[42:43], v[42:43], v[172:173], v[172:173] op_sel:[0,0,1] op_sel_hi:[1,0,1] neg_lo:[0,0,1] neg_hi:[0,0,1]
v_pk_fma_f32 v[44:45], v[44:45], v[172:173], v[172:173] op_sel:[0,0,1] op_sel_hi:[1,0,1] neg_lo:[0,0,1] neg_hi:[0,0,1]
v_pk_fma_f32 v[46:47], v[46:47], v[172:173], v[172:173] op_sel:[0,0,1] op_sel_hi:[1,0,1] neg_lo:[0,0,1] neg_hi:[0,0,1]
s_setprio 2
ds_read_u16_d16 v186, v186
ds_read_u16_d16_hi v187, v187
ds_read_u16_d16 v188, v188
ds_read_u16_d16_hi v189, v189
s_waitcnt lgkmcnt(4)
v_readfirstlane_b32 s43, v247
s_nop 1
s_cmp_ge_u32 s43, 16
s_cbranch_scc1 Lev5
Lev5w:
s_sleep 1
ds_read_b32 v247, v253 offset:16
s_waitcnt lgkmcnt(0)
v_readfirstlane_b32 s43, v247
s_cmp_eq_u32 s76, 0
s_cbranch_scc1 Lev5
s_sub_u32 s76, s76, 1
s_cmp_lt_u32 s43, 16
s_cbranch_scc1 Lev5w
Lev5:
s_setprio 1
v_cvt_pkrtz_f16_f32 v137, v120, v121
v_cvt_pkrtz_f16_f32 v139, v122, v123
v_cvt_pkrtz_f16_f32 v141, v124, v125
v_cvt_pkrtz_f16_f32 v143, v126, v127
v_cvt_pkrtz_f16_f32 v177, v128, v129
v_cvt_pkrtz_f16_f32 v191, v130, v131
v_cvt_pk_f16_f32 v155, v132, v133
v_cvt_pk_f16_f32 v152, v134, v135
s_add_u32 m0, s67, 53248
s_add_u32 s66, s66, 98304
buffer_load_dwordx4 v240, s[4:7], s66 offen lds
ds_read_b128 v[224:227], v249 offset:23552
v_mfma_f32_32x32x16_bf16 v[120:135], v[48:51], v[228:231], 0
v_pk_fma_f16 v154, v155, v155, s48
v_cvt_pk_bf16_f32 v72, v0, v1
v_and_b32 v137, s49, v137
v_fma_mix_f32 v165, v178, v178, v165 op_sel:[0,0,0] op_sel_hi:[1,1,0]
v_cvt_pk_bf16_f32 v73, v2, v3
v_pk_fma_f16 v151, v152, v152, s48
v_bfe_u32 v136, v137, 2, 14
v_cvt_pk_bf16_f32 v74, v4, v5
v_pk_mul_f16 v154, v155, v154
v_fma_mix_f32 v165, v179, v179, v165 op_sel:[1,1,0] op_sel_hi:[1,1,0]
v_lshrrev_b32_e64 v137, 18, v137
v_cvt_pk_bf16_f32 v75, v6, v7
s_add_u32 m0, s67, 59904
s_add_u32 s66, s66, 98304
buffer_load_dwordx4 v240, s[4:7], s66 offen lds
ds_read_b128 v[228:231], v248 offset:16384
ds_read_u16_d16 v136, v136
ds_read_u16_d16_hi v137, v137
v_mfma_f32_32x32x16_bf16 v[120:135], v[52:55], v[232:235], v[120:135]
v_pk_mul_f16 v151, v152, v151
v_exp_f16_e64 v153, v154
v_cvt_pk_bf16_f32 v76, v8, v9
v_and_b32_e64 v139, s49, v139
v_fma_mix_f32 v165, v180, v180, v165 op_sel:[0,0,0] op_sel_hi:[1,1,0]
v_cvt_pk_bf16_f32 v77, v10, v11
v_bfe_u32 v138, v139, 2, 14
v_exp_f16_e64 v150, v151
v_cvt_pk_bf16_f32 v78, v12, v13
v_lshrrev_b32 v139, 18, v139
v_cvt_pk_bf16_f32 v79, v14, v15
s_add_u32 m0, s67, 0
s_add_u32 s66, s66, 98304
buffer_load_dwordx4 v240, s[4:7], s66 offen lds
ds_read_b128 v[232:235], v248 offset:19456
ds_read_u16_d16 v138, v138
ds_read_u16_d16_hi v139, v139
v_mfma_f32_32x32x16_bf16 v[120:135], v[56:59], v[236:239], v[120:135]
v_fma_mix_f32 v165, v181, v181, v165 op_sel:[1,1,0] op_sel_hi:[1,1,0]
v_exp_f16_sdwa v153, v154 dst_sel:WORD_1 dst_unused:UNUSED_PRESERVE src0_sel:WORD_1
v_cvt_pk_bf16_f32 v80, v16, v17
v_and_b32_e64 v141, s49, v141
v_fma_mix_f32 v165, v182, v182, v165 op_sel:[0,0,0] op_sel_hi:[1,1,0]
v_cvt_pk_bf16_f32 v81, v18, v19
v_bfe_u32 v140, v141, 2, 14
v_exp_f16_sdwa v150, v151 dst_sel:WORD_1 dst_unused:UNUSED_PRESERVE src0_sel:WORD_1
v_cvt_pk_bf16_f32 v82, v20, v21
v_lshrrev_b32_e64 v141, 18, v141
s_add_u32 m0, s67, 6656
s_add_u32 s66, s66, 98304
buffer_load_dwordx4 v240, s[4:7], s66 offen lds
s_add_u32 m0, s67, 13312
s_add_u32 s66, s66, 98304
buffer_load_dwordx4 v240, s[4:7], s66 offen lds
ds_read_b128 v[236:239], v248 offset:17408
ds_read_u16_d16 v140, v140
ds_read_u16_d16_hi v141, v141
v_mfma_f32_32x32x16_bf16 v[120:135], v[60:63], v[216:219], v[120:135]
v_fma_mix_f32 v165, v183, v183, v165 op_sel:[1,1,0] op_sel_hi:[1,1,0]
v_cvt_pk_bf16_f32 v83, v22, v23
v_pk_add_f16 v153, v153, 1.0 op_sel_hi:[1,0]
v_pk_add_f16 v150, v150, 1.0 op_sel_hi:[1,0]
v_and_b32_e64 v143, s49, v143
v_cvt_pk_bf16_f32 v84, v24, v25
v_rcp_f16_e64 v154, v153
v_cvt_pk_bf16_f32 v85, v26, v27
v_bfe_u32 v142, v143, 2, 14
v_fma_mix_f32 v165, v184, v184, v165 op_sel:[0,0,0] op_sel_hi:[1,1,0]
v_cvt_pk_bf16_f32 v86, v28, v29
s_add_u32 m0, s67, 19968
s_add_u32 s66, s66, 98304
buffer_load_dwordx4 v240, s[4:7], s66 offen lds
ds_read_b128 v[216:219], v248 offset:20480
ds_read_u16_d16 v142, v142
v_mfma_f32_32x32x16_bf16 v[120:135], v[64:67], v[220:223], v[120:135]
v_rcp_f16 v151, v150
v_lshrrev_b32 v143, 18, v143
v_cvt_pk_bf16_f32 v87, v30, v31
v_fma_mix_f32 v165, v185, v185, v165 op_sel:[1,1,0] op_sel_hi:[1,1,0]
v_and_b32_e64 v177, s49, v177
s_setprio 0
v_cvt_pk_bf16_f32 v88, v32, v33
v_rcp_f16_sdwa v154, v153 dst_sel:WORD_1 dst_unused:UNUSED_PRESERVE src0_sel:WORD_1
v_bfe_u32 v176, v177, 2, 14
v_cvt_pk_bf16_f32 v89, v34, v35
s_waitcnt lgkmcnt(2)
v_fma_mix_f32 v165, v186, v186, v165 op_sel:[0,0,0] op_sel_hi:[1,1,0]
v_rcp_f16_sdwa v151, v150 dst_sel:WORD_1 dst_unused:UNUSED_PRESERVE src0_sel:WORD_1
s_add_u32 m0, s67, 26624
s_add_u32 s66, s66, 98304
buffer_load_dwordx4 v240, s[4:7], s66 offen lds
ds_read_b128 v[220:223], v248 offset:18432
ds_read_u16_d16_hi v143, v143
ds_read_u16_d16 v176, v176
v_mfma_f32_32x32x16_bf16 v[120:135], v[68:71], v[224:227], v[120:135]
v_cvt_pk_bf16_f32 v90, v36, v37
v_lshrrev_b32_e64 v177, 18, v177
v_cvt_pk_bf16_f32 v91, v38, v39
v_fma_mix_f32 v165, v187, v187, v165 op_sel:[1,1,0] op_sel_hi:[1,1,0]
v_and_b32_e64 v191, s49, v191
v_pk_mul_f16 v155, v155, v154
v_cvt_pk_bf16_f32 v92, v40, v41
v_pk_mul_f16 v152, v152, v151
v_bfe_u32 v190, v191, 2, 14
v_cvt_pk_bf16_f32 v93, v42, v43
v_fma_mix_f32 v165, v188, v188, v165 op_sel:[0,0,0] op_sel_hi:[1,1,0]
v_fma_mix_f32 v166, v155, v155, 0 op_sel:[0,0,0] op_sel_hi:[1,1,0]
s_add_u32 m0, s67, 33280
s_add_u32 s66, s66, 98304
buffer_load_dwordx4 v240, s[4:7], s66 offen lds
v_lshrrev_b32 v191, 18, v191
v_cvt_pk_bf16_f32 v94, v44, v45
v_fma_mix_f32 v166, v155, v155, v166 op_sel:[1,1,0] op_sel_hi:[1,1,0]
v_fma_mix_f32 v165, v189, v189, v165 op_sel:[1,1,0] op_sel_hi:[1,1,0]
v_cvt_pk_bf16_f32 v95, v46, v47
v_fma_mix_f32 v166, v152, v152, v166 op_sel:[0,0,0] op_sel_hi:[1,1,0]
v_fma_mix_f32 v166, v152, v152, v166 op_sel:[1,1,0] op_sel_hi:[1,1,0]
s_setprio 2
v_cvt_pkrtz_f16_f32 v179, v120, v121
v_cvt_pkrtz_f16_f32 v181, v122, v123
v_cvt_pkrtz_f16_f32 v183, v124, v125
v_cvt_pkrtz_f16_f32 v185, v126, v127
v_cvt_pkrtz_f16_f32 v187, v128, v129
v_cvt_pk_f16_f32 v155, v130, v131
v_cvt_pk_f16_f32 v152, v132, v133
v_cvt_pk_f16_f32 v149, v134, v135
ds_read_b128 v[224:227], v248 offset:21504
ds_read_u16_d16_hi v177, v177
ds_read_u16_d16 v190, v190
ds_read_u16_d16_hi v191, v191
v_mfma_f32_32x32x16_bf16 v[120:135], v[72:75], v[228:231], 0
v_pk_fma_f16 v154, v155, v155, s48
v_and_b32_e64 v179, s49, v179
v_fma_mix_f32 v166, v136, v136, v166 op_sel:[0,0,0] op_sel_hi:[1,1,0]
v_pk_fma_f16 v151, v152, v152, s48
v_pk_fma_f16 v148, v149, v149, s48
v_bfe_u32 v178, v179, 2, 14
v_pk_mul_f16 v154, v155, v154
v_fma_mix_f32 v166, v137, v137, v166 op_sel:[1,1,0] op_sel_hi:[1,1,0]
v_pk_mul_f16 v151, v152, v151
v_lshrrev_b32_e64 v179, 18, v179
ds_read_b128 v[228:231], v248 offset:22528
ds_read_u16_d16 v178, v178
ds_read_u16_d16_hi v179, v179
v_mfma_f32_32x32x16_bf16 v[120:135], v[76:79], v[232:235], v[120:135]
v_pk_mul_f16 v148, v149, v148
v_exp_f16_e64 v153, v154
v_fma_mix_f32 v166, v138, v138, v166 op_sel:[0,0,0] op_sel_hi:[1,1,0]
v_and_b32 v181, s49, v181
v_exp_f16 v150, v151
v_exp_f16_e64 v147, v148
v_bfe_u32 v180, v181, 2, 14
v_fma_mix_f32 v166, v139, v139, v166 op_sel:[1,1,0] op_sel_hi:[1,1,0]
ds_read_b128 v[232:235], v248 offset:25600
ds_read_u16_d16 v180, v180
v_mfma_f32_32x32x16_bf16 v[120:135], v[80:83], v[236:239], v[120:135]
v_exp_f16_sdwa v153, v154 dst_sel:WORD_1 dst_unused:UNUSED_PRESERVE src0_sel:WORD_1
v_lshrrev_b32_e64 v181, 18, v181
v_exp_f16_sdwa v150, v151 dst_sel:WORD_1 dst_unused:UNUSED_PRESERVE src0_sel:WORD_1
v_fma_mix_f32 v166, v140, v140, v166 op_sel:[0,0,0] op_sel_hi:[1,1,0]
v_and_b32 v183, s49, v183
v_exp_f16_sdwa v147, v148 dst_sel:WORD_1 dst_unused:UNUSED_PRESERVE src0_sel:WORD_1
v_fma_mix_f32 v166, v141, v141, v166 op_sel:[1,1,0] op_sel_hi:[1,1,0]
s_waitcnt lgkmcnt(5)
ds_read_b128 v[236:239], v248 offset:23552
ds_read_u16_d16_hi v181, v181
v_mfma_f32_32x32x16_bf16 v[120:135], v[84:87], v[216:219], v[120:135]
v_pk_add_f16 v153, v153, 1.0 op_sel_hi:[1,0]
v_bfe_u32 v182, v183, 2, 14
v_pk_add_f16 v150, v150, 1.0 op_sel_hi:[1,0]
v_pk_add_f16 v147, v147, 1.0 op_sel_hi:[1,0]
v_rcp_f16 v154, v153
v_lshrrev_b32 v183, 18, v183
v_fma_mix_f32 v166, v142, v142, v166 op_sel:[0,0,0] op_sel_hi:[1,1,0]
v_rcp_f16 v151, v150
v_and_b32 v185, s49, v185
ds_read_b128 v[216:219], v248 offset:26624
ds_read_u16_d16 v182, v182
ds_read_u16_d16_hi v183, v183
v_mfma_f32_32x32x16_bf16 v[120:135], v[88:91], v[220:223], v[120:135]
v_fma_mix_f32 v166, v143, v143, v166 op_sel:[1,1,0] op_sel_hi:[1,1,0]
v_rcp_f16_e64 v148, v147
v_bfe_u32 v184, v185, 2, 14
v_rcp_f16_sdwa v154, v153 dst_sel:WORD_1 dst_unused:UNUSED_PRESERVE src0_sel:WORD_1
v_fma_mix_f32 v166, v176, v176, v166 op_sel:[0,0,0] op_sel_hi:[1,1,0]
v_rcp_f16_sdwa v151, v150 dst_sel:WORD_1 dst_unused:UNUSED_PRESERVE src0_sel:WORD_1
v_lshrrev_b32_e64 v185, 18, v185
ds_read_b128 v[220:223], v248 offset:24576
ds_read_u16_d16 v184, v184
ds_read_u16_d16_hi v185, v185
v_mfma_f32_32x32x16_bf16 v[120:135], v[92:95], v[224:227], v[120:135]
v_rcp_f16_sdwa v148, v147 dst_sel:WORD_1 dst_unused:UNUSED_PRESERVE src0_sel:WORD_1
s_cmp_eq_u32 s40, 7
s_cbranch_scc1 Lrdy16
s_waitcnt vmcnt(0)
Lrdy16:
s_mov_b64 exec, 1
ds_add_u32 v253, v254 offset:12
s_mov_b64 exec, -1
v_and_b32 v187, s49, v187
v_fma_mix_f32 v166, v177, v177, v166 op_sel:[1,1,0] op_sel_hi:[1,1,0]
v_pk_mul_f16 v155, v155, v154
v_pk_mul_f16 v152, v152, v151
v_pk_mul_f16 v149, v149, v148
v_bfe_u32 v186, v187, 2, 14
v_fma_mix_f32 v166, v190, v190, v166 op_sel:[0,0,0] op_sel_hi:[1,1,0]
v_fma_mix_f32 v167, v155, v155, 0 op_sel:[0,0,0] op_sel_hi:[1,1,0]
v_fma_mix_f32 v167, v155, v155, v167 op_sel:[1,1,0] op_sel_hi:[1,1,0]
v_lshrrev_b32_e64 v187, 18, v187
v_fma_mix_f32 v167, v152, v152, v167 op_sel:[0,0,0] op_sel_hi:[1,1,0]
v_fma_mix_f32 v166, v191, v191, v166 op_sel:[1,1,0] op_sel_hi:[1,1,0]
v_fma_mix_f32 v167, v152, v152, v167 op_sel:[1,1,0] op_sel_hi:[1,1,0]
v_fma_mix_f32 v167, v149, v149, v167 op_sel:[0,0,0] op_sel_hi:[1,1,0]
v_fma_mix_f32 v167, v149, v149, v167 op_sel:[1,1,0] op_sel_hi:[1,1,0]
s_setprio 1
v_cvt_pkrtz_f16_f32 v137, v120, v121
v_cvt_pkrtz_f16_f32 v139, v122, v123
v_cvt_pkrtz_f16_f32 v141, v124, v125
v_cvt_pkrtz_f16_f32 v143, v126, v127
v_cvt_pkrtz_f16_f32 v177, v128, v129
v_cvt_pk_f16_f32 v155, v130, v131
v_cvt_pk_f16_f32 v152, v132, v133
v_cvt_pk_f16_f32 v149, v134, v135
s_waitcnt lgkmcnt(1)
ds_read_b128 v[224:227], v248 offset:27648
ds_read_u16_d16 v186, v186
ds_read_u16_d16_hi v187, v187
v_mfma_f32_32x32x16_bf16 v[120:135], v[72:75], v[228:231], 0
v_pk_fma_f16 v154, v155, v155, s48
v_and_b32_e64 v137, s49, v137
v_fma_mix_f32 v167, v178, v178, v167 op_sel:[0,0,0] op_sel_hi:[1,1,0]
v_pk_fma_f16 v151, v152, v152, s48
v_pk_fma_f16 v148, v149, v149, s48
v_bfe_u32 v136, v137, 2, 14
v_pk_mul_f16 v154, v155, v154
v_pk_mul_f16 v151, v152, v151
v_fma_mix_f32 v167, v179, v179, v167 op_sel:[1,1,0] op_sel_hi:[1,1,0]
v_lshrrev_b32_e64 v137, 18, v137
ds_read_b128 v[228:231], v250 offset:65520
ds_read_u16_d16 v136, v136
ds_read_u16_d16_hi v137, v137
v_mfma_f32_32x32x16_bf16 v[120:135], v[76:79], v[232:235], v[120:135]
v_pk_mul_f16 v148, v149, v148
v_exp_f16 v153, v154
v_exp_f16 v150, v151
v_and_b32_e64 v139, s49, v139
v_fma_mix_f32 v167, v180, v180, v167 op_sel:[0,0,0] op_sel_hi:[1,1,0]
v_exp_f16_e64 v147, v148
v_bfe_u32 v138, v139, 2, 14
ds_read_b128 v[232:235], v248 offset:28672
ds_read_b32 v247, v253 offset:12
ds_read_u16_d16 v138, v138
v_mfma_f32_32x32x16_bf16 v[120:135], v[80:83], v[236:239], v[120:135]
v_exp_f16_sdwa v153, v154 dst_sel:WORD_1 dst_unused:UNUSED_PRESERVE src0_sel:WORD_1
v_lshrrev_b32_e64 v139, 18, v139
v_fma_mix_f32 v167, v181, v181, v167 op_sel:[1,1,0] op_sel_hi:[1,1,0]
v_exp_f16_sdwa v150, v151 dst_sel:WORD_1 dst_unused:UNUSED_PRESERVE src0_sel:WORD_1
v_exp_f16_sdwa v147, v148 dst_sel:WORD_1 dst_unused:UNUSED_PRESERVE src0_sel:WORD_1
v_and_b32_e64 v141, s49, v141
v_fma_mix_f32 v167, v182, v182, v167 op_sel:[0,0,0] op_sel_hi:[1,1,0]
ds_read_b128 v[236:239], v248 offset:31744
ds_read_u16_d16_hi v139, v139
v_mfma_f32_32x32x16_bf16 v[120:135], v[84:87], v[216:219], v[120:135]
v_pk_add_f16 v153, v153, 1.0 op_sel_hi:[1,0]
v_bfe_u32 v140, v141, 2, 14
v_pk_add_f16 v150, v150, 1.0 op_sel_hi:[1,0]
v_pk_add_f16 v147, v147, 1.0 op_sel_hi:[1,0]
v_rcp_f16 v154, v153
v_lshrrev_b32 v141, 18, v141
ds_read_u16_d16 v140, v140
ds_read_u16_d16_hi v141, v141
s_waitcnt lgkmcnt(5)
v_readfirstlane_b32 s43, v247
s_nop 1
s_cmp_ge_u32 s43, 24
s_cbranch_scc1 Lev6
Lev6w:
s_sleep 1
ds_read_b32 v247, v253 offset:12
s_waitcnt lgkmcnt(0)
v_readfirstlane_b32 s43, v247
s_cmp_eq_u32 s76, 0
s_cbranch_scc1 Lev6
s_sub_u32 s76, s76, 1
s_cmp_lt_u32 s43, 24
s_cbranch_scc1 Lev6w
Lev6:
v_fma_mix_f32 v167, v183, v183, v167 op_sel:[1,1,0] op_sel_hi:[1,1,0]
v_rcp_f16 v151, v150
ds_read_b128 v[216:219], v248 offset:29696
v_mfma_f32_32x32x16_bf16 v[120:135], v[88:91], v[220:223], v[120:135]
v_and_b32 v143, s49, v143
v_rcp_f16 v148, v147
v_fma_mix_f32 v167, v184, v184, v167 op_sel:[0,0,0] op_sel_hi:[1,1,0]
v_bfe_u32 v142, v143, 2, 14
s_setprio 0
v_rcp_f16_sdwa v154, v153 dst_sel:WORD_1 dst_unused:UNUSED_PRESERVE src0_sel:WORD_1
v_rcp_f16_sdwa v151, v150 dst_sel:WORD_1 dst_unused:UNUSED_PRESERVE src0_sel:WORD_1
v_lshrrev_b32 v143, 18, v143
ds_read_b128 v[220:223], v245
ds_read_b128 v[192:195], v242
ds_read_b128 v[196:199], v242 offset:64
ds_read_u16_d16 v142, v142
ds_read_u16_d16_hi v143, v143
v_mfma_f32_32x32x16_bf16 v[120:135], v[92:95], v[224:227], v[120:135]
v_fma_mix_f32 v167, v185, v185, v167 op_sel:[1,1,0] op_sel_hi:[1,1,0]
v_rcp_f16_sdwa v148, v147 dst_sel:WORD_1 dst_unused:UNUSED_PRESERVE src0_sel:WORD_1
v_and_b32_e64 v177, s49, v177
v_pk_mul_f16 v155, v155, v154
v_fma_mix_f32 v167, v186, v186, v167 op_sel:[0,0,0] op_sel_hi:[1,1,0]
v_pk_mul_f16 v152, v152, v151
v_bfe_u32 v176, v177, 2, 14
v_pk_mul_f16 v149, v149, v148
v_fma_mix_f32 v156, v155, v155, v156 op_sel:[0,0,0] op_sel_hi:[1,1,0]
v_fma_mix_f32 v156, v155, v155, v156 op_sel:[1,1,0] op_sel_hi:[1,1,0]
v_lshrrev_b32 v177, 18, v177
v_fma_mix_f32 v167, v187, v187, v167 op_sel:[1,1,0] op_sel_hi:[1,1,0]
v_fma_mix_f32 v156, v152, v152, v156 op_sel:[0,0,0] op_sel_hi:[1,1,0]
v_fma_mix_f32 v156, v152, v152, v156 op_sel:[1,1,0] op_sel_hi:[1,1,0]
v_fma_mix_f32 v156, v149, v149, v156 op_sel:[0,0,0] op_sel_hi:[1,1,0]
v_fma_mix_f32 v156, v149, v149, v156 op_sel:[1,1,0] op_sel_hi:[1,1,0]
s_setprio 2
v_mfma_f32_32x32x16_bf16 v[0:15], v[228:231], v[228:231], 0
s_add_u32 s46, s80, 4194304
buffer_store_dwordx4 v[56:59], v241, s[32:35], s46 offen sc1
ds_read_b128 v[224:227], v248 offset:32768
ds_read_u16_d16 v176, v176
ds_read_u16_d16_hi v177, v177
v_cvt_pkrtz_f16_f32 v179, v120, v121
v_cvt_pkrtz_f16_f32 v181, v122, v123
v_cvt_pkrtz_f16_f32 v183, v124, v125
v_mfma_f32_32x32x16_bf16 v[16:31], v[228:231], v[228:231], 0
v_cvt_pkrtz_f16_f32 v185, v126, v127
v_cvt_pkrtz_f16_f32 v187, v128, v129
v_cvt_pk_f16_f32 v155, v130, v131
v_cvt_pk_f16_f32 v152, v132, v133
v_mfma_f32_32x32x16_bf16 v[32:47], v[228:231], v[228:231], 0
v_cvt_pk_f16_f32 v149, v134, v135
v_pk_fma_f16 v154, v155, v155, s48
v_and_b32_e64 v179, s49, v179
v_mfma_f32_32x32x16_bf16 v[120:135], v[72:75], v[232:235], 0
ds_read_b128 v[228:231], v248 offset:30720
v_fma_mix_f32 v156, v136, v136, v156 op_sel:[0,0,0] op_sel_hi:[1,1,0]
v_pk_fma_f16 v151, v152, v152, s48
v_pk_fma_f16 v148, v149, v149, s48
v_bfe_u32 v178, v179, 2, 14
v_pk_mul_f16 v154, v155, v154
v_pk_mul_f16 v151, v152, v151
v_fma_mix_f32 v156, v137, v137, v156 op_sel:[1,1,0] op_sel_hi:[1,1,0]
s_waitcnt lgkmcnt(4)
v_mfma_f32_32x32x16_bf16 v[120:135], v[76:79], v[236:239], v[120:135]
ds_read_b128 v[232:235], v245 offset:384
ds_read_b128 v[200:203], v242 offset:128
ds_read_b128 v[204:207], v243
ds_read_u16_d16 v178, v178
v_lshrrev_b32 v179, 18, v179
v_pk_mul_f16 v148, v149, v148
v_exp_f16 v153, v154
v_exp_f16 v150, v151
v_and_b32_e64 v181, s49, v181
v_fma_mix_f32 v156, v138, v138, v156 op_sel:[0,0,0] op_sel_hi:[1,1,0]
v_mfma_f32_32x32x16_bf16 v[120:135], v[80:83], v[216:219], v[120:135]
ds_read_b128 v[236:239], v248 offset:33792
ds_read_u16_d16_hi v179, v179
v_exp_f16_e64 v147, v148
v_bfe_u32 v180, v181, 2, 14
v_exp_f16_sdwa v153, v154 dst_sel:WORD_1 dst_unused:UNUSED_PRESERVE src0_sel:WORD_1
v_lshrrev_b32_e64 v181, 18, v181
v_fma_mix_f32 v156, v139, v139, v156 op_sel:[1,1,0] op_sel_hi:[1,1,0]
v_smfmac_f32_16x16x32_bf16 v[0:3], v[220:221], v[192:195], v246
ds_read_b128 v[216:219], v245 offset:768
ds_read_b128 v[208:211], v243 offset:64
ds_read_b128 v[212:215], v243 offset:128
ds_read_u16_d16 v180, v180
ds_read_u16_d16_hi v181, v181
v_exp_f16_sdwa v150, v151 dst_sel:WORD_1 dst_unused:UNUSED_PRESERVE src0_sel:WORD_1
v_smfmac_f32_16x16x32_bf16 v[16:19], v[222:223], v[196:199], v246
v_exp_f16_sdwa v147, v148 dst_sel:WORD_1 dst_unused:UNUSED_PRESERVE src0_sel:WORD_1
v_and_b32 v183, s49, v183
v_fma_mix_f32 v156, v140, v140, v156 op_sel:[0,0,0] op_sel_hi:[1,1,0]
v_pk_add_f16 v153, v153, 1.0 op_sel_hi:[1,0]
s_waitcnt lgkmcnt(7)
v_mfma_f32_32x32x16_bf16 v[120:135], v[84:87], v[224:227], v[120:135]
ds_read_b128 v[220:223], v245 offset:1152
ds_read_b128 v[192:195], v244
ds_read_b128 v[196:199], v244 offset:64
v_bfe_u32 v182, v183, 2, 14
v_pk_add_f16 v150, v150, 1.0 op_sel_hi:[1,0]
v_pk_add_f16 v147, v147, 1.0 op_sel_hi:[1,0]
v_rcp_f16 v154, v153
v_lshrrev_b32 v183, 18, v183
v_fma_mix_f32 v156, v141, v141, v156 op_sel:[1,1,0] op_sel_hi:[1,1,0]
v_mfma_f32_32x32x16_bf16 v[120:135], v[88:91], v[228:231], v[120:135]
ds_read_b128 v[224:227], v248 offset:34816
ds_read_u16_d16 v182, v182
ds_read_u16_d16_hi v183, v183
v_rcp_f16 v151, v150
v_and_b32 v185, s49, v185
v_rcp_f16_e64 v148, v147
v_fma_mix_f32 v156, v142, v142, v156 op_sel:[0,0,0] op_sel_hi:[1,1,0]
v_bfe_u32 v184, v185, 2, 14
v_smfmac_f32_16x16x32_bf16 v[32:35], v[232:233], v[200:203], v246
ds_read_b128 v[228:231], v248 offset:37888
ds_read_u16_d16 v184, v184
v_rcp_f16_sdwa v154, v153 dst_sel:WORD_1 dst_unused:UNUSED_PRESERVE src0_sel:WORD_1
v_rcp_f16_sdwa v151, v150 dst_sel:WORD_1 dst_unused:UNUSED_PRESERVE src0_sel:WORD_1
v_smfmac_f32_16x16x32_bf16 v[0:3], v[234:235], v[204:207], v246
v_lshrrev_b32 v185, 18, v185
v_fma_mix_f32 v156, v143, v143, v156 op_sel:[1,1,0] op_sel_hi:[1,1,0]
s_waitcnt lgkmcnt(6)
v_mfma_f32_32x32x16_bf16 v[120:135], v[92:95], v[236:239], v[120:135]
ds_read_b128 v[232:235], v248 offset:35840
ds_read_u16_d16_hi v185, v185
v_rcp_f16_sdwa v148, v147 dst_sel:WORD_1 dst_unused:UNUSED_PRESERVE src0_sel:WORD_1
v_and_b32_e64 v187, s49, v187
v_pk_mul_f16 v155, v155, v154
v_fma_mix_f32 v156, v176, v176, v156 op_sel:[0,0,0] op_sel_hi:[1,1,0]
v_pk_mul_f16 v152, v152, v151
v_bfe_u32 v186, v187, 2, 14
v_pk_mul_f16 v149, v149, v148
v_smfmac_f32_16x16x32_bf16 v[16:19], v[216:217], v[208:211], v246
ds_read_b128 v[236:239], v248 offset:38912
ds_read_u16_d16 v186, v186
v_fma_mix_f32 v157, v155, v155, v157 op_sel:[0,0,0] op_sel_hi:[1,1,0]
v_fma_mix_f32 v157, v155, v155, v157 op_sel:[1,1,0] op_sel_hi:[1,1,0]
v_lshrrev_b32_e64 v187, 18, v187
v_fma_mix_f32 v156, v177, v177, v156 op_sel:[1,1,0] op_sel_hi:[1,1,0]
v_smfmac_f32_16x16x32_bf16 v[32:35], v[218:219], v[212:215], v246
v_fma_mix_f32 v157, v152, v152, v157 op_sel:[0,0,0] op_sel_hi:[1,1,0]
v_fma_mix_f32 v157, v152, v152, v157 op_sel:[1,1,0] op_sel_hi:[1,1,0]
v_fma_mix_f32 v157, v149, v149, v157 op_sel:[0,0,0] op_sel_hi:[1,1,0]
v_fma_mix_f32 v157, v149, v149, v157 op_sel:[1,1,0] op_sel_hi:[1,1,0]
s_setprio 1
v_smfmac_f32_16x16x32_bf16 v[0:3], v[220:221], v[192:195], v246
s_waitcnt lgkmcnt(4)
s_add_u32 s46, s80, 6291456
buffer_store_dwordx4 v[60:63], v241, s[32:35], s46 offen sc1
ds_read_b128 v[216:219], v248 offset:36864
ds_read_u16_d16_hi v187, v187
v_cvt_pkrtz_f16_f32 v137, v120, v121
v_cvt_pkrtz_f16_f32 v139, v122, v123
v_cvt_pkrtz_f16_f32 v141, v124, v125
v_cvt_pkrtz_f16_f32 v143, v126, v127
v_cvt_pk_f16_f32 v155, v128, v129
v_smfmac_f32_16x16x32_bf16 v[16:19], v[222:223], v[196:199], v246
v_cvt_pk_f16_f32 v152, v130, v131
v_cvt_pk_f16_f32 v149, v132, v133
v_cvt_pk_f16_f32 v146, v134, v135
v_pk_fma_f16 v154, v155, v155, s48
v_and_b32_e64 v137, s49, v137
v_mfma_f32_32x32x16_bf16 v[120:135], v[72:75], v[224:227], 0
ds_read_b128 v[220:223], v248 offset:39936
v_fma_mix_f32 v157, v178, v178, v157 op_sel:[0,0,0] op_sel_hi:[1,1,0]
v_pk_fma_f16 v151, v152, v152, s48
v_pk_fma_f16 v148, v149, v149, s48
v_pk_fma_f16 v145, v146, v146, s48
v_pk_mul_f16 v154, v155, v154
v_bfe_u32 v136, v137, 2, 14
v_pk_mul_f16 v151, v152, v151
v_fma_mix_f32 v157, v179, v179, v157 op_sel:[1,1,0] op_sel_hi:[1,1,0]
v_pk_mul_f16 v148, v149, v148
v_pk_mul_f16 v145, v146, v145
v_mfma_f32_32x32x16_bf16 v[120:135], v[76:79], v[228:231], v[120:135]
ds_read_b128 v[224:227], v245 offset:1536
ds_read_b128 v[200:203], v244 offset:128
v_xor_b32 v242, 16, v242
ds_read_b128 v[204:207], v242
ds_read_u16_d16 v136, v136
v_exp_f16 v153, v154
v_lshrrev_b32 v137, 18, v137
v_exp_f16 v150, v151
v_fma_mix_f32 v157, v180, v180, v157 op_sel:[0,0,0] op_sel_hi:[1,1,0]
v_exp_f16 v147, v148
v_and_b32 v139, s49, v139
v_exp_f16 v144, v145
s_waitcnt lgkmcnt(5)
v_mfma_f32_32x32x16_bf16 v[120:135], v[80:83], v[232:235], v[120:135]
ds_read_b128 v[228:231], v245 offset:1920
ds_read_b128 v[208:211], v242 offset:64
ds_read_b128 v[212:215], v242 offset:128
ds_read_u16_d16_hi v137, v137
v_exp_f16_sdwa v153, v154 dst_sel:WORD_1 dst_unused:UNUSED_PRESERVE src0_sel:WORD_1
v_fma_mix_f32 v157, v181, v181, v157 op_sel:[1,1,0] op_sel_hi:[1,1,0]
v_bfe_u32 v138, v139, 2, 14
v_exp_f16_sdwa v150, v151 dst_sel:WORD_1 dst_unused:UNUSED_PRESERVE src0_sel:WORD_1
v_exp_f16_sdwa v147, v148 dst_sel:WORD_1 dst_unused:UNUSED_PRESERVE src0_sel:WORD_1
v_exp_f16_sdwa v144, v145 dst_sel:WORD_1 dst_unused:UNUSED_PRESERVE src0_sel:WORD_1
v_lshrrev_b32_e64 v139, 18, v139
v_fma_mix_f32 v157, v182, v182, v157 op_sel:[0,0,0] op_sel_hi:[1,1,0]
v_mfma_f32_32x32x16_bf16 v[120:135], v[84:87], v[236:239], v[120:135]
ds_read_b128 v[232:235], v248 offset:40960
ds_read_u16_d16 v138, v138
ds_read_u16_d16_hi v139, v139
v_pk_add_f16 v153, v153, 1.0 op_sel_hi:[1,0]
v_pk_add_f16 v150, v150, 1.0 op_sel_hi:[1,0]
v_pk_add_f16 v147, v147, 1.0 op_sel_hi:[1,0]
v_and_b32_e64 v141, s49, v141
v_pk_add_f16 v144, v144, 1.0 op_sel_hi:[1,0]
v_rcp_f16_e64 v154, v153
v_fma_mix_f32 v157, v183, v183, v157 op_sel:[1,1,0] op_sel_hi:[1,1,0]
v_rcp_f16_e64 v151, v150
v_mfma_f32_32x32x16_bf16 v[120:135], v[88:91], v[216:219], v[120:135]
ds_read_b128 v[236:239], v248 offset:44032
v_bfe_u32 v140, v141, 2, 14
v_rcp_f16_e64 v148, v147
v_fma_mix_f32 v157, v184, v184, v157 op_sel:[0,0,0] op_sel_hi:[1,1,0]
v_rcp_f16 v145, v144
v_lshrrev_b32 v141, 18, v141
v_rcp_f16_sdwa v154, v153 dst_sel:WORD_1 dst_unused:UNUSED_PRESERVE src0_sel:WORD_1
s_setprio 0
v_rcp_f16_sdwa v151, v150 dst_sel:WORD_1 dst_unused:UNUSED_PRESERVE src0_sel:WORD_1
s_waitcnt lgkmcnt(4)
v_mfma_f32_32x32x16_bf16 v[120:135], v[92:95], v[220:223], v[120:135]
ds_read_b128 v[216:219], v248 offset:41984
ds_read_u16_d16 v140, v140
ds_read_u16_d16_hi v141, v141
v_fma_mix_f32 v157, v185, v185, v157 op_sel:[1,1,0] op_sel_hi:[1,1,0]
v_and_b32_e64 v143, s49, v143
v_rcp_f16_sdwa v148, v147 dst_sel:WORD_1 dst_unused:UNUSED_PRESERVE src0_sel:WORD_1
v_rcp_f16_sdwa v145, v144 dst_sel:WORD_1 dst_unused:UNUSED_PRESERVE src0_sel:WORD_1
v_pk_mul_f16 v155, v155, v154
v_bfe_u32 v142, v143, 2, 14
v_fma_mix_f32 v157, v186, v186, v157 op_sel:[0,0,0] op_sel_hi:[1,1,0]
v_pk_mul_f16 v152, v152, v151
v_pk_mul_f16 v149, v149, v148
v_smfmac_f32_16x16x32_bf16 v[32:35], v[224:225], v[200:203], v246
ds_read_b128 v[220:223], v248 offset:45056
ds_read_u16_d16 v142, v142
v_pk_mul_f16 v146, v146, v145
v_fma_mix_f32 v158, v155, v155, v158 op_sel:[0,0,0] op_sel_hi:[1,1,0]
v_lshrrev_b32 v143, 18, v143
v_fma_mix_f32 v158, v155, v155, v158 op_sel:[1,1,0] op_sel_hi:[1,1,0]
v_fma_mix_f32 v158, v152, v152, v158 op_sel:[0,0,0] op_sel_hi:[1,1,0]
v_smfmac_f32_16x16x32_bf16 v[4:7], v[226:227], v[204:207], v246
v_fma_mix_f32 v157, v187, v187, v157 op_sel:[1,1,0] op_sel_hi:[1,1,0]
v_fma_mix_f32 v158, v152, v152, v158 op_sel:[1,1,0] op_sel_hi:[1,1,0]
v_fma_mix_f32 v158, v149, v149, v158 op_sel:[0,0,0] op_sel_hi:[1,1,0]
v_fma_mix_f32 v158, v149, v149, v158 op_sel:[1,1,0] op_sel_hi:[1,1,0]
v_fma_mix_f32 v158, v146, v146, v158 op_sel:[0,0,0] op_sel_hi:[1,1,0]
v_fma_mix_f32 v158, v146, v146, v158 op_sel:[1,1,0] op_sel_hi:[1,1,0]
s_setprio 2
v_smfmac_f32_16x16x32_bf16 v[20:23], v[228:229], v[208:211], v246
s_add_u32 s46, s80, 8388608
buffer_store_dwordx4 v[64:67], v241, s[32:35], s46 offen sc1
ds_read_b128 v[224:227], v248 offset:43008
ds_read_u16_d16_hi v143, v143
v_cvt_pkrtz_f16_f32 v179, v120, v121
v_cvt_pkrtz_f16_f32 v181, v122, v123
v_cvt_pkrtz_f16_f32 v183, v124, v125
v_cvt_pkrtz_f16_f32 v185, v126, v127
v_smfmac_f32_16x16x32_bf16 v[36:39], v[230:231], v[212:215], v246
v_cvt_pkrtz_f16_f32 v187, v128, v129
v_cvt_pk_f16_f32 v155, v130, v131
v_cvt_pk_f16_f32 v152, v132, v133
v_cvt_pk_f16_f32 v149, v134, v135
v_pk_fma_f16 v154, v155, v155, s48
s_waitcnt lgkmcnt(2)
v_mfma_f32_32x32x16_bf16 v[120:135], v[72:75], v[232:235], 0
ds_read_b128 v[228:231], v248 offset:46080
v_and_b32 v179, s49, v179
v_fma_mix_f32 v158, v136, v136, v158 op_sel:[0,0,0] op_sel_hi:[1,1,0]
v_pk_fma_f16 v151, v152, v152, s48
v_pk_fma_f16 v148, v149, v149, s48
v_bfe_u32 v178, v179, 2, 14
v_pk_mul_f16 v154, v155, v154
v_pk_mul_f16 v151, v152, v151
v_pk_mul_f16 v148, v149, v148
v_lshrrev_b32 v179, 18, v179
v_mfma_f32_32x32x16_bf16 v[120:135], v[76:79], v[236:239], v[120:135]
ds_read_b128 v[232:235], v245 offset:2304
v_xor_b32 v243, 16, v243
ds_read_b128 v[192:195], v243
ds_read_b128 v[196:199], v243 offset:64
ds_read_u16_d16 v178, v178
ds_read_u16_d16_hi v179, v179
v_fma_mix_f32 v158, v137, v137, v158 op_sel:[1,1,0] op_sel_hi:[1,1,0]
v_exp_f16 v153, v154
v_and_b32 v181, s49, v181
v_exp_f16 v150, v151
v_exp_f16 v147, v148
v_bfe_u32 v180, v181, 2, 14
v_mfma_f32_32x32x16_bf16 v[120:135], v[80:83], v[216:219], v[120:135]
ds_read_b128 v[236:239], v245 offset:2688
ds_read_b128 v[200:203], v243 offset:128
v_xor_b32 v244, 16, v244
ds_read_b128 v[204:207], v244
ds_read_u16_d16 v180, v180
v_fma_mix_f32 v158, v138, v138, v158 op_sel:[0,0,0] op_sel_hi:[1,1,0]
v_exp_f16_sdwa v153, v154 dst_sel:WORD_1 dst_unused:UNUSED_PRESERVE src0_sel:WORD_1
v_lshrrev_b32 v181, 18, v181
v_exp_f16_sdwa v150, v151 dst_sel:WORD_1 dst_unused:UNUSED_PRESERVE src0_sel:WORD_1
v_fma_mix_f32 v158, v139, v139, v158 op_sel:[1,1,0] op_sel_hi:[1,1,0]
v_and_b32_e64 v183, s49, v183
v_mfma_f32_32x32x16_bf16 v[120:135], v[84:87], v[220:223], v[120:135]
ds_read_b128 v[216:219], v248 offset:47104
ds_read_u16_d16_hi v181, v181
v_exp_f16_sdwa v147, v148 dst_sel:WORD_1 dst_unused:UNUSED_PRESERVE src0_sel:WORD_1
v_pk_add_f16 v153, v153, 1.0 op_sel_hi:[1,0]
v_bfe_u32 v182, v183, 2, 14
v_pk_add_f16 v150, v150, 1.0 op_sel_hi:[1,0]
v_pk_add_f16 v147, v147, 1.0 op_sel_hi:[1,0]
v_rcp_f16_e64 v154, v153
v_lshrrev_b32 v183, 18, v183
v_fma_mix_f32 v158, v140, v140, v158 op_sel:[0,0,0] op_sel_hi:[1,1,0]
s_waitcnt lgkmcnt(6)
v_mfma_f32_32x32x16_bf16 v[120:135], v[88:91], v[224:227], v[120:135]
ds_read_b128 v[220:223], v248 offset:50176
ds_read_u16_d16 v182, v182
ds_read_u16_d16_hi v183, v183
v_rcp_f16 v151, v150
v_and_b32 v185, s49, v185
v_rcp_f16_e64 v148, v147
v_fma_mix_f32 v158, v141, v141, v158 op_sel:[1,1,0] op_sel_hi:[1,1,0]
v_bfe_u32 v184, v185, 2, 14
v_rcp_f16_sdwa v154, v153 dst_sel:WORD_1 dst_unused:UNUSED_PRESERVE src0_sel:WORD_1
v_mfma_f32_32x32x16_bf16 v[120:135], v[92:95], v[228:231], v[120:135]
ds_read_b128 v[224:227], v248 offset:48128
ds_read_u16_d16 v184, v184
v_rcp_f16_sdwa v151, v150 dst_sel:WORD_1 dst_unused:UNUSED_PRESERVE src0_sel:WORD_1
v_lshrrev_b32_e64 v185, 18, v185
v_rcp_f16_sdwa v148, v147 dst_sel:WORD_1 dst_unused:UNUSED_PRESERVE src0_sel:WORD_1
v_and_b32_e64 v187, s49, v187
v_fma_mix_f32 v158, v142, v142, v158 op_sel:[0,0,0] op_sel_hi:[1,1,0]
v_pk_mul_f16 v155, v155, v154
v_pk_mul_f16 v152, v152, v151
v_smfmac_f32_16x16x32_bf16 v[4:7], v[232:233], v[192:195], v246
ds_read_b128 v[228:231], v248 offset:51200
ds_read_u16_d16_hi v185, v185
v_bfe_u32 v186, v187, 2, 14
v_pk_mul_f16 v149, v149, v148
v_fma_mix_f32 v159, v155, v155, v159 op_sel:[0,0,0] op_sel_hi:[1,1,0]
v_fma_mix_f32 v158, v143, v143, v158 op_sel:[1,1,0] op_sel_hi:[1,1,0]
v_lshrrev_b32_e64 v187, 18, v187
v_smfmac_f32_16x16x32_bf16 v[20:23], v[234:235], v[196:199], v246
v_fma_mix_f32 v159, v155, v155, v159 op_sel:[1,1,0] op_sel_hi:[1,1,0]
v_fma_mix_f32 v159, v152, v152, v159 op_sel:[0,0,0] op_sel_hi:[1,1,0]
v_fma_mix_f32 v159, v152, v152, v159 op_sel:[1,1,0] op_sel_hi:[1,1,0]
v_fma_mix_f32 v159, v149, v149, v159 op_sel:[0,0,0] op_sel_hi:[1,1,0]
v_fma_mix_f32 v159, v149, v149, v159 op_sel:[1,1,0] op_sel_hi:[1,1,0]
s_setprio 1
s_waitcnt lgkmcnt(4)
v_smfmac_f32_16x16x32_bf16 v[36:39], v[236:237], v[200:203], v246
s_add_u32 s46, s80, 10485760
buffer_store_dwordx4 v[68:71], v241, s[32:35], s46 offen sc1
ds_read_b128 v[232:235], v248 offset:49152
ds_read_u16_d16 v186, v186
ds_read_u16_d16_hi v187, v187
v_cvt_pkrtz_f16_f32 v137, v120, v121
v_cvt_pkrtz_f16_f32 v139, v122, v123
v_cvt_pkrtz_f16_f32 v141, v124, v125
v_cvt_pkrtz_f16_f32 v143, v126, v127
v_cvt_pk_f16_f32 v155, v128, v129
v_smfmac_f32_16x16x32_bf16 v[4:7], v[238:239], v[204:207], v246
v_cvt_pk_f16_f32 v152, v130, v131
v_cvt_pk_f16_f32 v149, v132, v133
v_cvt_pk_f16_f32 v146, v134, v135
v_pk_fma_f16 v154, v155, v155, s48
v_and_b32_e64 v137, s49, v137
v_mfma_f32_32x32x16_bf16 v[120:135], v[72:75], v[216:219], 0
ds_read_b128 v[236:239], v248 offset:52224
v_fma_mix_f32 v159, v178, v178, v159 op_sel:[0,0,0] op_sel_hi:[1,1,0]
v_pk_fma_f16 v151, v152, v152, s48
v_pk_fma_f16 v148, v149, v149, s48
v_pk_fma_f16 v145, v146, v146, s48
v_pk_mul_f16 v154, v155, v154
v_bfe_u32 v136, v137, 2, 14
v_pk_mul_f16 v151, v152, v151
v_fma_mix_f32 v159, v179, v179, v159 op_sel:[1,1,0] op_sel_hi:[1,1,0]
v_pk_mul_f16 v148, v149, v148
v_pk_mul_f16 v145, v146, v145
v_mfma_f32_32x32x16_bf16 v[120:135], v[76:79], v[220:223], v[120:135]
ds_read_b128 v[216:219], v245 offset:3072
ds_read_b128 v[208:211], v244 offset:64
ds_read_b128 v[212:215], v244 offset:128
ds_read_u16_d16 v136, v136
v_exp_f16 v153, v154
v_lshrrev_b32 v137, 18, v137
v_exp_f16_e64 v150, v151
v_fma_mix_f32 v159, v180, v180, v159 op_sel:[0,0,0] op_sel_hi:[1,1,0]
v_exp_f16 v147, v148
v_and_b32 v139, s49, v139
v_exp_f16_e64 v144, v145
s_waitcnt lgkmcnt(5)
v_mfma_f32_32x32x16_bf16 v[120:135], v[80:83], v[224:227], v[120:135]
ds_read_b128 v[220:223], v245 offset:3456
v_xor_b32 v242, 32, v242
ds_read_b128 v[192:195], v242
ds_read_b128 v[196:199], v242 offset:64
ds_read_u16_d16_hi v137, v137
v_exp_f16_sdwa v153, v154 dst_sel:WORD_1 dst_unused:UNUSED_PRESERVE src0_sel:WORD_1
v_fma_mix_f32 v159, v181, v181, v159 op_sel:[1,1,0] op_sel_hi:[1,1,0]
v_bfe_u32 v138, v139, 2, 14
v_exp_f16_sdwa v150, v151 dst_sel:WORD_1 dst_unused:UNUSED_PRESERVE src0_sel:WORD_1
v_exp_f16_sdwa v147, v148 dst_sel:WORD_1 dst_unused:UNUSED_PRESERVE src0_sel:WORD_1
v_exp_f16_sdwa v144, v145 dst_sel:WORD_1 dst_unused:UNUSED_PRESERVE src0_sel:WORD_1
v_lshrrev_b32_e64 v139, 18, v139
v_fma_mix_f32 v159, v182, v182, v159 op_sel:[0,0,0] op_sel_hi:[1,1,0]
v_mfma_f32_32x32x16_bf16 v[120:135], v[84:87], v[228:231], v[120:135]
ds_read_b128 v[224:227], v248 offset:53248
ds_read_u16_d16 v138, v138
ds_read_u16_d16_hi v139, v139
v_pk_add_f16 v153, v153, 1.0 op_sel_hi:[1,0]
v_pk_add_f16 v150, v150, 1.0 op_sel_hi:[1,0]
v_pk_add_f16 v147, v147, 1.0 op_sel_hi:[1,0]
v_and_b32_e64 v141, s49, v141
v_pk_add_f16 v144, v144, 1.0 op_sel_hi:[1,0]
v_rcp_f16_e64 v154, v153
v_fma_mix_f32 v159, v183, v183, v159 op_sel:[1,1,0] op_sel_hi:[1,1,0]
v_rcp_f16_e64 v151, v150
v_mfma_f32_32x32x16_bf16 v[120:135], v[88:91], v[232:235], v[120:135]
ds_read_b128 v[228:231], v248 offset:56320
v_bfe_u32 v140, v141, 2, 14
v_rcp_f16_e64 v148, v147
v_fma_mix_f32 v159, v184, v184, v159 op_sel:[0,0,0] op_sel_hi:[1,1,0]
v_rcp_f16 v145, v144
v_lshrrev_b32 v141, 18, v141
v_rcp_f16_sdwa v154, v153 dst_sel:WORD_1 dst_unused:UNUSED_PRESERVE src0_sel:WORD_1
s_setprio 0
v_rcp_f16_sdwa v151, v150 dst_sel:WORD_1 dst_unused:UNUSED_PRESERVE src0_sel:WORD_1
s_waitcnt lgkmcnt(4)
v_mfma_f32_32x32x16_bf16 v[120:135], v[92:95], v[236:239], v[120:135]
ds_read_b128 v[232:235], v248 offset:54272
ds_read_u16_d16 v140, v140
ds_read_u16_d16_hi v141, v141
v_fma_mix_f32 v159, v185, v185, v159 op_sel:[1,1,0] op_sel_hi:[1,1,0]
v_and_b32_e64 v143, s49, v143
v_rcp_f16_sdwa v148, v147 dst_sel:WORD_1 dst_unused:UNUSED_PRESERVE src0_sel:WORD_1
v_rcp_f16_sdwa v145, v144 dst_sel:WORD_1 dst_unused:UNUSED_PRESERVE src0_sel:WORD_1
v_pk_mul_f16 v155, v155, v154
v_bfe_u32 v142, v143, 2, 14
v_fma_mix_f32 v159, v186, v186, v159 op_sel:[0,0,0] op_sel_hi:[1,1,0]
v_pk_mul_f16 v152, v152, v151
v_pk_mul_f16 v149, v149, v148
v_smfmac_f32_16x16x32_bf16 v[20:23], v[216:217], v[208:211], v246
ds_read_b128 v[236:239], v248 offset:57344
ds_read_u16_d16 v142, v142
v_pk_mul_f16 v146, v146, v145
v_fma_mix_f32 v160, v155, v155, v160 op_sel:[0,0,0] op_sel_hi:[1,1,0]
v_lshrrev_b32_e64 v143, 18, v143
v_fma_mix_f32 v160, v155, v155, v160 op_sel:[1,1,0] op_sel_hi:[1,1,0]
v_fma_mix_f32 v160, v152, v152, v160 op_sel:[0,0,0] op_sel_hi:[1,1,0]
v_smfmac_f32_16x16x32_bf16 v[36:39], v[218:219], v[212:215], v246
v_fma_mix_f32 v159, v187, v187, v159 op_sel:[1,1,0] op_sel_hi:[1,1,0]
v_fma_mix_f32 v160, v152, v152, v160 op_sel:[1,1,0] op_sel_hi:[1,1,0]
v_fma_mix_f32 v160, v149, v149, v160 op_sel:[0,0,0] op_sel_hi:[1,1,0]
v_fma_mix_f32 v160, v149, v149, v160 op_sel:[1,1,0] op_sel_hi:[1,1,0]
v_fma_mix_f32 v160, v146, v146, v160 op_sel:[0,0,0] op_sel_hi:[1,1,0]
v_fma_mix_f32 v160, v146, v146, v160 op_sel:[1,1,0] op_sel_hi:[1,1,0]
s_cmp_lg_u32 s40, 7
s_cbranch_scc1 Lnobias2
s_sub_u32 s43, s2, 96
s_cmp_lt_u32 s43, 96
s_cbranch_scc0 Lnobias2
s_waitcnt vmcnt(15)
v_lshlrev_b32 v102, 16, v102
v_lshlrev_b32 v103, 16, v103
v_lshlrev_b32 v104, 16, v104
v_lshlrev_b32 v105, 16, v105
v_lshlrev_b32 v106, 16, v106
v_lshlrev_b32 v107, 16, v107
v_lshlrev_b32 v108, 16, v108
v_lshlrev_b32 v109, 16, v109
v_lshlrev_b32 v110, 16, v110
v_lshlrev_b32 v111, 16, v111
v_lshlrev_b32 v112, 16, v112
v_lshlrev_b32 v113, 16, v113
v_mul_f32 v100, v102, v108
v_fmac_f32 v100, v103, v109
v_fmac_f32 v100, v104, v110
v_fmac_f32 v100, v105, v111
v_fmac_f32 v100, v106, v112
v_fmac_f32 v100, v107, v113
s_nop 1
v_add_f32_dpp v100, v100, v100 row_ror:8 row_mask:0xf bank_mask:0xf
s_nop 1
v_add_f32_dpp v100, v100, v100 row_ror:4 row_mask:0xf bank_mask:0xf
s_nop 1
v_add_f32_dpp v100, v100, v100 row_ror:2 row_mask:0xf bank_mask:0xf
s_nop 1
v_add_f32_dpp v100, v100, v100 row_ror:1 row_mask:0xf bank_mask:0xf
v_mov_b32 v101, v100
s_nop 1
v_permlane16_swap_b32 v100, v101
v_add_f32 v100, v100, v101
v_mov_b32_e64 v101, v100
s_nop 1
v_permlane32_swap_b32 v100, v101
v_add_f32 v100, v100, v101
s_lshl_b32 s44, s43, 2
s_add_u32 s44, s44, 394752
v_lshlrev_b32_e64 v115, 11, v251
s_mov_b64 exec, 0xff
buffer_store_dword v100, v115, s[32:35], s44 offen sc1
s_mov_b64 exec, -1
Lnobias2:
s_setprio 2
v_smfmac_f32_16x16x32_bf16 v[12:15], v[220:221], v[192:195], v246
ds_read_b128 v[216:219], v248 offset:55296
ds_read_u16_d16_hi v143, v143
v_cvt_pkrtz_f16_f32 v179, v120, v121
v_cvt_pkrtz_f16_f32 v181, v122, v123
v_cvt_pkrtz_f16_f32 v183, v124, v125
v_cvt_pkrtz_f16_f32 v185, v126, v127
v_smfmac_f32_16x16x32_bf16 v[28:31], v[222:223], v[196:199], v246
v_cvt_pkrtz_f16_f32 v187, v128, v129
v_cvt_pk_f16_f32 v155, v130, v131
v_cvt_pk_f16_f32 v152, v132, v133
v_cvt_pk_f16_f32 v149, v134, v135
s_waitcnt lgkmcnt(2)
v_mfma_f32_32x32x16_bf16 v[120:135], v[72:75], v[224:227], 0
ds_read_b128 v[220:223], v245 offset:3840
ds_read_b128 v[200:203], v242 offset:128
v_xor_b32 v243, 32, v243
ds_read_b128 v[204:207], v243
v_pk_fma_f16 v154, v155, v155, s48
v_and_b32_e64 v179, s49, v179
v_fma_mix_f32 v160, v136, v136, v160 op_sel:[0,0,0] op_sel_hi:[1,1,0]
v_pk_fma_f16 v151, v152, v152, s48
v_pk_fma_f16 v148, v149, v149, s48
v_bfe_u32 v178, v179, 2, 14
v_pk_mul_f16 v154, v155, v154
v_pk_mul_f16 v151, v152, v151
v_mfma_f32_32x32x16_bf16 v[120:135], v[76:79], v[228:231], v[120:135]
ds_read_b128 v[224:227], v248 offset:58368
ds_read_u16_d16 v178, v178
v_pk_mul_f16 v148, v149, v148
v_lshrrev_b32_e64 v179, 18, v179
v_fma_mix_f32 v160, v137, v137, v160 op_sel:[1,1,0] op_sel_hi:[1,1,0]
v_exp_f16 v153, v154
v_and_b32 v181, s49, v181
v_exp_f16_e64 v150, v151
v_mfma_f32_32x32x16_bf16 v[120:135], v[80:83], v[232:235], v[120:135]
ds_read_b128 v[228:231], v245 offset:4224
ds_read_b128 v[208:211], v243 offset:64
ds_read_b128 v[212:215], v243 offset:128
ds_read_u16_d16_hi v179, v179
v_exp_f16_e64 v147, v148
v_bfe_u32 v180, v181, 2, 14
v_fma_mix_f32 v160, v138, v138, v160 op_sel:[0,0,0] op_sel_hi:[1,1,0]
v_exp_f16_sdwa v153, v154 dst_sel:WORD_1 dst_unused:UNUSED_PRESERVE src0_sel:WORD_1
v_lshrrev_b32 v181, 18, v181
v_mfma_f32_32x32x16_bf16 v[120:135], v[84:87], v[236:239], v[120:135]
ds_read_b128 v[232:235], v245 offset:4608
v_xor_b32 v244, 32, v244
ds_read_b128 v[192:195], v244
ds_read_b128 v[196:199], v244 offset:64
ds_read_u16_d16 v180, v180
ds_read_u16_d16_hi v181, v181
v_exp_f16_sdwa v150, v151 dst_sel:WORD_1 dst_unused:UNUSED_PRESERVE src0_sel:WORD_1
v_fma_mix_f32 v160, v139, v139, v160 op_sel:[1,1,0] op_sel_hi:[1,1,0]
v_and_b32 v183, s49, v183
v_exp_f16_sdwa v147, v148 dst_sel:WORD_1 dst_unused:UNUSED_PRESERVE src0_sel:WORD_1
v_pk_add_f16 v153, v153, 1.0 op_sel_hi:[1,0]
v_bfe_u32 v182, v183, 2, 14
v_pk_add_f16 v150, v150, 1.0 op_sel_hi:[1,0]
s_waitcnt lgkmcnt(9)
v_mfma_f32_32x32x16_bf16 v[120:135], v[88:91], v[216:219], v[120:135]
ds_read_b128 v[236:239], v248 offset:59392
ds_read_u16_d16 v182, v182
v_pk_add_f16 v147, v147, 1.0 op_sel_hi:[1,0]
v_rcp_f16 v154, v153
v_lshrrev_b32 v183, 18, v183
v_fma_mix_f32 v160, v140, v140, v160 op_sel:[0,0,0] op_sel_hi:[1,1,0]
v_rcp_f16 v151, v150
v_and_b32 v185, s49, v185
v_smfmac_f32_16x16x32_bf16 v[44:47], v[220:221], v[200:203], v246
ds_read_b128 v[216:219], v248 offset:62464
ds_read_u16_d16_hi v183, v183
v_rcp_f16_e64 v148, v147
v_fma_mix_f32 v160, v141, v141, v160 op_sel:[1,1,0] op_sel_hi:[1,1,0]
v_bfe_u32 v184, v185, 2, 14
v_smfmac_f32_16x16x32_bf16 v[12:15], v[222:223], v[204:207], v246
v_rcp_f16_sdwa v154, v153 dst_sel:WORD_1 dst_unused:UNUSED_PRESERVE src0_sel:WORD_1
v_rcp_f16_sdwa v151, v150 dst_sel:WORD_1 dst_unused:UNUSED_PRESERVE src0_sel:WORD_1
v_mfma_f32_32x32x16_bf16 v[120:135], v[92:95], v[224:227], v[120:135]
ds_read_b128 v[220:223], v248 offset:60416
ds_read_u16_d16 v184, v184
v_lshrrev_b32_e64 v185, 18, v185
v_rcp_f16_sdwa v148, v147 dst_sel:WORD_1 dst_unused:UNUSED_PRESERVE src0_sel:WORD_1
v_and_b32 v187, s49, v187
v_fma_mix_f32 v160, v142, v142, v160 op_sel:[0,0,0] op_sel_hi:[1,1,0]
v_pk_mul_f16 v155, v155, v154
v_pk_mul_f16 v152, v152, v151
v_bfe_u32 v186, v187, 2, 14
s_waitcnt lgkmcnt(4)
v_smfmac_f32_16x16x32_bf16 v[28:31], v[228:229], v[208:211], v246
ds_read_b128 v[224:227], v248 offset:63488
ds_read_u16_d16_hi v185, v185
ds_read_u16_d16 v186, v186
v_pk_mul_f16 v149, v149, v148
v_fma_mix_f32 v161, v155, v155, v161 op_sel:[0,0,0] op_sel_hi:[1,1,0]
v_fma_mix_f32 v160, v143, v143, v160 op_sel:[1,1,0] op_sel_hi:[1,1,0]
v_lshrrev_b32_e64 v187, 18, v187
v_smfmac_f32_16x16x32_bf16 v[44:47], v[230:231], v[212:215], v246
v_fma_mix_f32 v161, v155, v155, v161 op_sel:[1,1,0] op_sel_hi:[1,1,0]
v_fma_mix_f32 v161, v152, v152, v161 op_sel:[0,0,0] op_sel_hi:[1,1,0]
v_fma_mix_f32 v161, v152, v152, v161 op_sel:[1,1,0] op_sel_hi:[1,1,0]
v_fma_mix_f32 v161, v149, v149, v161 op_sel:[0,0,0] op_sel_hi:[1,1,0]
v_fma_mix_f32 v161, v149, v149, v161 op_sel:[1,1,0] op_sel_hi:[1,1,0]
v_lshlrev_b32_e64 v252, 7, v251
s_add_u32 s46, s47, 2359296
s_mov_b32 exec_lo, 131071
s_mov_b32 exec_hi, 0
s_mov_b32 m0, 16288
s_nop 0
buffer_load_dword v252, s[4:7], s46 offen lds
s_mov_b64 exec, -1
s_setprio 1
v_smfmac_f32_16x16x32_bf16 v[12:15], v[232:233], v[192:195], v246
ds_read_b128 v[228:231], v248 offset:61440
ds_read_u16_d16_hi v187, v187
v_cvt_pkrtz_f16_f32 v137, v120, v121
v_cvt_pkrtz_f16_f32 v139, v122, v123
v_cvt_pkrtz_f16_f32 v141, v124, v125
v_cvt_pkrtz_f16_f32 v143, v126, v127
v_cvt_pk_f16_f32 v155, v128, v129
v_smfmac_f32_16x16x32_bf16 v[28:31], v[234:235], v[196:199], v246
v_cvt_pk_f16_f32 v152, v130, v131
v_cvt_pk_f16_f32 v149, v132, v133
v_cvt_pk_f16_f32 v146, v134, v135
v_pk_fma_f16 v154, v155, v155, s48
v_and_b32_e64 v137, s49, v137
v_mfma_f32_32x32x16_bf16 v[120:135], v[72:75], v[236:239], 0
ds_read_b128 v[232:235], v248 offset:64512
v_fma_mix_f32 v161, v178, v178, v161 op_sel:[0,0,0] op_sel_hi:[1,1,0]
v_pk_fma_f16 v151, v152, v152, s48
v_pk_fma_f16 v148, v149, v149, s48
v_pk_fma_f16 v145, v146, v146, s48
v_pk_mul_f16 v154, v155, v154
v_bfe_u32 v136, v137, 2, 14
v_pk_mul_f16 v151, v152, v151
v_fma_mix_f32 v161, v179, v179, v161 op_sel:[1,1,0] op_sel_hi:[1,1,0]
v_pk_mul_f16 v148, v149, v148
v_pk_mul_f16 v145, v146, v145
s_waitcnt lgkmcnt(2)
v_mfma_f32_32x32x16_bf16 v[120:135], v[76:79], v[216:219], v[120:135]
ds_read_b128 v[236:239], v245 offset:4992
ds_read_b128 v[200:203], v244 offset:128
v_xor_b32 v242, 16, v242
ds_read_b128 v[204:207], v242
ds_read_u16_d16 v136, v136
v_exp_f16 v153, v154
v_lshrrev_b32 v137, 18, v137
v_exp_f16_e64 v150, v151
v_fma_mix_f32 v161, v180, v180, v161 op_sel:[0,0,0] op_sel_hi:[1,1,0]
v_exp_f16 v147, v148
v_and_b32 v139, s49, v139
v_exp_f16_e64 v144, v145
v_mfma_f32_32x32x16_bf16 v[120:135], v[80:83], v[220:223], v[120:135]
ds_read_b128 v[216:219], v245 offset:5376
ds_read_b128 v[208:211], v242 offset:64
ds_read_b128 v[212:215], v242 offset:128
ds_read_u16_d16_hi v137, v137
v_exp_f16_sdwa v153, v154 dst_sel:WORD_1 dst_unused:UNUSED_PRESERVE src0_sel:WORD_1
v_fma_mix_f32 v161, v181, v181, v161 op_sel:[1,1,0] op_sel_hi:[1,1,0]
v_bfe_u32 v138, v139, 2, 14
v_exp_f16_sdwa v150, v151 dst_sel:WORD_1 dst_unused:UNUSED_PRESERVE src0_sel:WORD_1
v_exp_f16_sdwa v147, v148 dst_sel:WORD_1 dst_unused:UNUSED_PRESERVE src0_sel:WORD_1
v_exp_f16_sdwa v144, v145 dst_sel:WORD_1 dst_unused:UNUSED_PRESERVE src0_sel:WORD_1
v_lshrrev_b32_e64 v139, 18, v139
v_fma_mix_f32 v161, v182, v182, v161 op_sel:[0,0,0] op_sel_hi:[1,1,0]
v_mfma_f32_32x32x16_bf16 v[120:135], v[84:87], v[224:227], v[120:135]
ds_read_b128 v[220:223], v249
ds_read_u16_d16 v138, v138
ds_read_u16_d16_hi v139, v139
v_pk_add_f16 v153, v153, 1.0 op_sel_hi:[1,0]
v_pk_add_f16 v150, v150, 1.0 op_sel_hi:[1,0]
v_pk_add_f16 v147, v147, 1.0 op_sel_hi:[1,0]
v_and_b32_e64 v141, s49, v141
v_pk_add_f16 v144, v144, 1.0 op_sel_hi:[1,0]
v_rcp_f16_e64 v154, v153
v_fma_mix_f32 v161, v183, v183, v161 op_sel:[1,1,0] op_sel_hi:[1,1,0]
v_rcp_f16_e64 v151, v150
v_mfma_f32_32x32x16_bf16 v[120:135], v[88:91], v[228:231], v[120:135]
ds_read_b128 v[224:227], v249 offset:3072
v_bfe_u32 v140, v141, 2, 14
v_rcp_f16_e64 v148, v147
v_fma_mix_f32 v161, v184, v184, v161 op_sel:[0,0,0] op_sel_hi:[1,1,0]
v_rcp_f16 v145, v144
v_lshrrev_b32 v141, 18, v141
v_rcp_f16_sdwa v154, v153 dst_sel:WORD_1 dst_unused:UNUSED_PRESERVE src0_sel:WORD_1
s_setprio 0
v_rcp_f16_sdwa v151, v150 dst_sel:WORD_1 dst_unused:UNUSED_PRESERVE src0_sel:WORD_1
s_waitcnt lgkmcnt(4)
v_mfma_f32_32x32x16_bf16 v[120:135], v[92:95], v[232:235], v[120:135]
ds_read_b128 v[228:231], v249 offset:1024
ds_read_u16_d16 v140, v140
ds_read_u16_d16_hi v141, v141
v_fma_mix_f32 v161, v185, v185, v161 op_sel:[1,1,0] op_sel_hi:[1,1,0]
v_and_b32_e64 v143, s49, v143
v_rcp_f16_sdwa v148, v147 dst_sel:WORD_1 dst_unused:UNUSED_PRESERVE src0_sel:WORD_1
v_rcp_f16_sdwa v145, v144 dst_sel:WORD_1 dst_unused:UNUSED_PRESERVE src0_sel:WORD_1
v_pk_mul_f16 v155, v155, v154
v_bfe_u32 v142, v143, 2, 14
v_fma_mix_f32 v161, v186, v186, v161 op_sel:[0,0,0] op_sel_hi:[1,1,0]
v_pk_mul_f16 v152, v152, v151
v_pk_mul_f16 v149, v149, v148
v_smfmac_f32_16x16x32_bf16 v[44:47], v[236:237], v[200:203], v246
ds_read_b128 v[232:235], v249 offset:4096
ds_read_u16_d16 v142, v142
v_pk_mul_f16 v146, v146, v145
v_fma_mix_f32 v162, v155, v155, v162 op_sel:[0,0,0] op_sel_hi:[1,1,0]
v_lshrrev_b32_e64 v143, 18, v143
v_fma_mix_f32 v162, v155, v155, v162 op_sel:[1,1,0] op_sel_hi:[1,1,0]
v_fma_mix_f32 v162, v152, v152, v162 op_sel:[0,0,0] op_sel_hi:[1,1,0]
v_smfmac_f32_16x16x32_bf16 v[8:11], v[238:239], v[204:207], v246
v_fma_mix_f32 v161, v187, v187, v161 op_sel:[1,1,0] op_sel_hi:[1,1,0]
v_fma_mix_f32 v162, v152, v152, v162 op_sel:[1,1,0] op_sel_hi:[1,1,0]
v_fma_mix_f32 v162, v149, v149, v162 op_sel:[0,0,0] op_sel_hi:[1,1,0]
v_fma_mix_f32 v162, v149, v149, v162 op_sel:[1,1,0] op_sel_hi:[1,1,0]
v_fma_mix_f32 v162, v146, v146, v162 op_sel:[0,0,0] op_sel_hi:[1,1,0]
v_fma_mix_f32 v162, v146, v146, v162 op_sel:[1,1,0] op_sel_hi:[1,1,0]
v_lshlrev_b32_e64 v252, 7, v251
s_add_u32 s46, s47, 2359296
s_mov_b32 exec_lo, 4294836224
s_mov_b32 exec_hi, 3
s_mov_b32 m0, 16220
s_nop 0
buffer_load_dword v252, s[4:7], s46 offen lds
s_mov_b64 exec, -1
s_setprio 2
v_smfmac_f32_16x16x32_bf16 v[24:27], v[216:217], v[208:211], v246
ds_read_b128 v[236:239], v249 offset:2048
ds_read_u16_d16_hi v143, v143
v_cvt_pkrtz_f16_f32 v179, v120, v121
v_cvt_pkrtz_f16_f32 v181, v122, v123
v_cvt_pkrtz_f16_f32 v183, v124, v125
v_cvt_pkrtz_f16_f32 v185, v126, v127
v_smfmac_f32_16x16x32_bf16 v[40:43], v[218:219], v[212:215], v246
v_cvt_pkrtz_f16_f32 v187, v128, v129
v_cvt_pk_f16_f32 v155, v130, v131
v_cvt_pk_f16_f32 v152, v132, v133
v_cvt_pk_f16_f32 v149, v134, v135
v_pk_fma_f16 v154, v155, v155, s48
s_waitcnt lgkmcnt(2)
v_mfma_f32_32x32x16_bf16 v[120:135], v[72:75], v[220:223], 0
ds_read_b128 v[216:219], v249 offset:5120
v_and_b32 v179, s49, v179
v_fma_mix_f32 v162, v136, v136, v162 op_sel:[0,0,0] op_sel_hi:[1,1,0]
v_pk_fma_f16 v151, v152, v152, s48
v_pk_fma_f16 v148, v149, v149, s48
v_bfe_u32 v178, v179, 2, 14
v_pk_mul_f16 v154, v155, v154
v_pk_mul_f16 v151, v152, v151
v_pk_mul_f16 v148, v149, v148
v_lshrrev_b32 v179, 18, v179
v_mfma_f32_32x32x16_bf16 v[120:135], v[76:79], v[224:227], v[120:135]
ds_read_b128 v[220:223], v245 offset:5760
v_xor_b32 v243, 16, v243
ds_read_b128 v[192:195], v243
ds_read_b128 v[196:199], v243 offset:64
ds_read_u16_d16 v178, v178
ds_read_u16_d16_hi v179, v179
v_fma_mix_f32 v162, v137, v137, v162 op_sel:[1,1,0] op_sel_hi:[1,1,0]
v_exp_f16 v153, v154
v_and_b32 v181, s49, v181
v_exp_f16 v150, v151
v_exp_f16 v147, v148
v_bfe_u32 v180, v181, 2, 14
v_mfma_f32_32x32x16_bf16 v[120:135], v[80:83], v[228:231], v[120:135]
ds_read_b128 v[224:227], v245 offset:6144
ds_read_b128 v[200:203], v243 offset:128
v_xor_b32 v244, 16, v244
ds_read_b128 v[204:207], v244
ds_read_u16_d16 v180, v180
v_fma_mix_f32 v162, v138, v138, v162 op_sel:[0,0,0] op_sel_hi:[1,1,0]
v_exp_f16_sdwa v153, v154 dst_sel:WORD_1 dst_unused:UNUSED_PRESERVE src0_sel:WORD_1
v_lshrrev_b32 v181, 18, v181
v_exp_f16_sdwa v150, v151 dst_sel:WORD_1 dst_unused:UNUSED_PRESERVE src0_sel:WORD_1
v_fma_mix_f32 v162, v139, v139, v162 op_sel:[1,1,0] op_sel_hi:[1,1,0]
v_and_b32_e64 v183, s49, v183
v_mfma_f32_32x32x16_bf16 v[120:135], v[84:87], v[232:235], v[120:135]
ds_read_b128 v[228:231], v249 offset:6144
ds_read_u16_d16_hi v181, v181
v_exp_f16_sdwa v147, v148 dst_sel:WORD_1 dst_unused:UNUSED_PRESERVE src0_sel:WORD_1
v_pk_add_f16 v153, v153, 1.0 op_sel_hi:[1,0]
v_bfe_u32 v182, v183, 2, 14
v_pk_add_f16 v150, v150, 1.0 op_sel_hi:[1,0]
v_pk_add_f16 v147, v147, 1.0 op_sel_hi:[1,0]
v_rcp_f16_e64 v154, v153
v_lshrrev_b32 v183, 18, v183
v_fma_mix_f32 v162, v140, v140, v162 op_sel:[0,0,0] op_sel_hi:[1,1,0]
s_waitcnt lgkmcnt(6)
v_mfma_f32_32x32x16_bf16 v[120:135], v[88:91], v[236:239], v[120:135]
ds_read_b128 v[232:235], v249 offset:9216
ds_read_u16_d16 v182, v182
ds_read_u16_d16_hi v183, v183
v_rcp_f16 v151, v150
v_and_b32 v185, s49, v185
v_rcp_f16_e64 v148, v147
v_fma_mix_f32 v162, v141, v141, v162 op_sel:[1,1,0] op_sel_hi:[1,1,0]
v_bfe_u32 v184, v185, 2, 14
v_rcp_f16_sdwa v154, v153 dst_sel:WORD_1 dst_unused:UNUSED_PRESERVE src0_sel:WORD_1
v_mfma_f32_32x32x16_bf16 v[120:135], v[92:95], v[216:219], v[120:135]
ds_read_b128 v[236:239], v249 offset:7168
ds_read_u16_d16 v184, v184
v_rcp_f16_sdwa v151, v150 dst_sel:WORD_1 dst_unused:UNUSED_PRESERVE src0_sel:WORD_1
v_lshrrev_b32_e64 v185, 18, v185
v_rcp_f16_sdwa v148, v147 dst_sel:WORD_1 dst_unused:UNUSED_PRESERVE src0_sel:WORD_1
v_and_b32_e64 v187, s49, v187
v_fma_mix_f32 v162, v142, v142, v162 op_sel:[0,0,0] op_sel_hi:[1,1,0]
v_pk_mul_f16 v155, v155, v154
v_pk_mul_f16 v152, v152, v151
v_smfmac_f32_16x16x32_bf16 v[8:11], v[220:221], v[192:195], v246
ds_read_b128 v[216:219], v249 offset:10240
ds_read_u16_d16_hi v185, v185
v_bfe_u32 v186, v187, 2, 14
v_pk_mul_f16 v149, v149, v148
v_fma_mix_f32 v163, v155, v155, v163 op_sel:[0,0,0] op_sel_hi:[1,1,0]
v_fma_mix_f32 v162, v143, v143, v162 op_sel:[1,1,0] op_sel_hi:[1,1,0]
v_lshrrev_b32_e64 v187, 18, v187
v_smfmac_f32_16x16x32_bf16 v[24:27], v[222:223], v[196:199], v246
v_fma_mix_f32 v163, v155, v155, v163 op_sel:[1,1,0] op_sel_hi:[1,1,0]
v_fma_mix_f32 v163, v152, v152, v163 op_sel:[0,0,0] op_sel_hi:[1,1,0]
v_fma_mix_f32 v163, v152, v152, v163 op_sel:[1,1,0] op_sel_hi:[1,1,0]
v_fma_mix_f32 v163, v149, v149, v163 op_sel:[0,0,0] op_sel_hi:[1,1,0]
v_fma_mix_f32 v163, v149, v149, v163 op_sel:[1,1,0] op_sel_hi:[1,1,0]
v_lshlrev_b32 v252, 7, v251
s_add_u32 s46, s47, 2359296
s_mov_b32 exec_lo, 0
s_mov_b32 exec_hi, 1048572
s_mov_b32 m0, 16152
s_nop 0
buffer_load_dword v252, s[4:7], s46 offen lds
s_mov_b64 exec, -1
s_setprio 1
s_waitcnt lgkmcnt(2)
v_smfmac_f32_16x16x32_bf16 v[40:43], v[224:225], v[200:203], v246
ds_read_b128 v[220:223], v249 offset:8192
ds_read_u16_d16 v186, v186
ds_read_u16_d16_hi v187, v187
v_cvt_pkrtz_f16_f32 v137, v120, v121
v_cvt_pkrtz_f16_f32 v139, v122, v123
v_cvt_pkrtz_f16_f32 v141, v124, v125
v_cvt_pkrtz_f16_f32 v143, v126, v127
v_smfmac_f32_16x16x32_bf16 v[8:11], v[226:227], v[204:207], v246
v_cvt_pk_f16_f32 v155, v128, v129
v_cvt_pk_f16_f32 v152, v130, v131
v_cvt_pk_f16_f32 v149, v132, v133
v_cvt_pk_f16_f32 v146, v134, v135
v_pk_fma_f16 v154, v155, v155, s48
v_mfma_f32_32x32x16_bf16 v[120:135], v[72:75], v[228:231], 0
ds_read_b128 v[224:227], v249 offset:11264
v_and_b32_e64 v137, s49, v137
v_fma_mix_f32 v163, v178, v178, v163 op_sel:[0,0,0] op_sel_hi:[1,1,0]
v_pk_fma_f16 v151, v152, v152, s48
v_pk_fma_f16 v148, v149, v149, s48
v_pk_fma_f16 v145, v146, v146, s48
v_pk_mul_f16 v154, v155, v154
v_bfe_u32 v136, v137, 2, 14
v_pk_mul_f16 v151, v152, v151
v_fma_mix_f32 v163, v179, v179, v163 op_sel:[1,1,0] op_sel_hi:[1,1,0]
v_pk_mul_f16 v148, v149, v148
v_mfma_f32_32x32x16_bf16 v[120:135], v[76:79], v[232:235], v[120:135]
ds_read_b128 v[228:231], v245 offset:6528
ds_read_b128 v[208:211], v244 offset:64
ds_read_b128 v[212:215], v244 offset:128
ds_read_u16_d16 v136, v136
v_pk_mul_f16 v145, v146, v145
v_exp_f16 v153, v154
v_lshrrev_b32 v137, 18, v137
v_exp_f16_e64 v150, v151
v_fma_mix_f32 v163, v180, v180, v163 op_sel:[0,0,0] op_sel_hi:[1,1,0]
v_exp_f16 v147, v148
v_and_b32 v139, s49, v139
v_mfma_f32_32x32x16_bf16 v[120:135], v[80:83], v[236:239], v[120:135]
ds_read_b128 v[232:235], v249 offset:12288
ds_read_u16_d16_hi v137, v137
v_exp_f16_e64 v144, v145
v_exp_f16_sdwa v153, v154 dst_sel:WORD_1 dst_unused:UNUSED_PRESERVE src0_sel:WORD_1
v_fma_mix_f32 v163, v181, v181, v163 op_sel:[1,1,0] op_sel_hi:[1,1,0]
v_bfe_u32 v138, v139, 2, 14
v_exp_f16_sdwa v150, v151 dst_sel:WORD_1 dst_unused:UNUSED_PRESERVE src0_sel:WORD_1
v_exp_f16_sdwa v147, v148 dst_sel:WORD_1 dst_unused:UNUSED_PRESERVE src0_sel:WORD_1
s_waitcnt lgkmcnt(6)
v_mfma_f32_32x32x16_bf16 v[120:135], v[84:87], v[216:219], v[120:135]
ds_read_b128 v[236:239], v249 offset:15360
ds_read_u16_d16 v138, v138
v_exp_f16_sdwa v144, v145 dst_sel:WORD_1 dst_unused:UNUSED_PRESERVE src0_sel:WORD_1
v_lshrrev_b32 v139, 18, v139
v_fma_mix_f32 v163, v182, v182, v163 op_sel:[0,0,0] op_sel_hi:[1,1,0]
v_pk_add_f16 v153, v153, 1.0 op_sel_hi:[1,0]
v_pk_add_f16 v150, v150, 1.0 op_sel_hi:[1,0]
v_pk_add_f16 v147, v147, 1.0 op_sel_hi:[1,0]
v_and_b32_e64 v141, s49, v141
v_pk_add_f16 v144, v144, 1.0 op_sel_hi:[1,0]
v_mfma_f32_32x32x16_bf16 v[120:135], v[88:91], v[220:223], v[120:135]
ds_read_b128 v[216:219], v249 offset:13312
ds_read_u16_d16_hi v139, v139
v_rcp_f16_e64 v154, v153
v_fma_mix_f32 v163, v183, v183, v163 op_sel:[1,1,0] op_sel_hi:[1,1,0]
v_rcp_f16_e64 v151, v150
v_bfe_u32 v140, v141, 2, 14
v_rcp_f16_e64 v148, v147
v_fma_mix_f32 v163, v184, v184, v163 op_sel:[0,0,0] op_sel_hi:[1,1,0]
v_mfma_f32_32x32x16_bf16 v[120:135], v[92:95], v[224:227], v[120:135]
ds_read_b128 v[220:223], v249 offset:16384
ds_read_u16_d16 v140, v140
v_rcp_f16_e64 v145, v144
v_lshrrev_b32 v141, 18, v141
v_rcp_f16_sdwa v154, v153 dst_sel:WORD_1 dst_unused:UNUSED_PRESERVE src0_sel:WORD_1
s_setprio 0
v_rcp_f16_sdwa v151, v150 dst_sel:WORD_1 dst_unused:UNUSED_PRESERVE src0_sel:WORD_1
v_fma_mix_f32 v163, v185, v185, v163 op_sel:[1,1,0] op_sel_hi:[1,1,0]
v_and_b32 v143, s49, v143
v_rcp_f16_sdwa v148, v147 dst_sel:WORD_1 dst_unused:UNUSED_PRESERVE src0_sel:WORD_1
s_waitcnt lgkmcnt(4)
v_smfmac_f32_16x16x32_bf16 v[24:27], v[228:229], v[208:211], v246
ds_read_b128 v[224:227], v249 offset:14336
ds_read_u16_d16_hi v141, v141
v_rcp_f16_sdwa v145, v144 dst_sel:WORD_1 dst_unused:UNUSED_PRESERVE src0_sel:WORD_1
v_pk_mul_f16 v155, v155, v154
v_bfe_u32 v142, v143, 2, 14
v_fma_mix_f32 v163, v186, v186, v163 op_sel:[0,0,0] op_sel_hi:[1,1,0]
v_smfmac_f32_16x16x32_bf16 v[40:43], v[230:231], v[212:215], v246
s_mov_b64 exec, 1
ds_add_u32 v253, v254 offset:16
s_mov_b64 exec, -1
v_pk_mul_f16 v152, v152, v151
v_pk_mul_f16 v149, v149, v148
v_pk_mul_f16 v146, v146, v145
v_fma_mix_f32 v164, v155, v155, v164 op_sel:[0,0,0] op_sel_hi:[1,1,0]
v_lshrrev_b32 v143, 18, v143
v_fma_mix_f32 v164, v155, v155, v164 op_sel:[1,1,0] op_sel_hi:[1,1,0]
v_fma_mix_f32 v164, v152, v152, v164 op_sel:[0,0,0] op_sel_hi:[1,1,0]
v_fma_mix_f32 v163, v187, v187, v163 op_sel:[1,1,0] op_sel_hi:[1,1,0]
v_fma_mix_f32 v164, v152, v152, v164 op_sel:[1,1,0] op_sel_hi:[1,1,0]
v_fma_mix_f32 v164, v149, v149, v164 op_sel:[0,0,0] op_sel_hi:[1,1,0]
v_fma_mix_f32 v164, v149, v149, v164 op_sel:[1,1,0] op_sel_hi:[1,1,0]
v_fma_mix_f32 v164, v146, v146, v164 op_sel:[0,0,0] op_sel_hi:[1,1,0]
v_fma_mix_f32 v164, v146, v146, v164 op_sel:[1,1,0] op_sel_hi:[1,1,0]
s_setprio 3
v_pk_add_f32 v[168:169], v[0:1], v[2:3]
v_pk_mul_f32 v[170:171], v[0:1], v[0:1]
v_pk_fma_f32 v[170:171], v[2:3], v[2:3], v[170:171]
v_pk_add_f32 v[168:169], v[168:169], v[4:5]
v_pk_fma_f32 v[170:171], v[4:5], v[4:5], v[170:171]
v_pk_add_f32 v[168:169], v[168:169], v[6:7]
v_pk_fma_f32 v[170:171], v[6:7], v[6:7], v[170:171]
v_pk_add_f32 v[168:169], v[168:169], v[8:9]
v_pk_fma_f32 v[170:171], v[8:9], v[8:9], v[170:171]
v_pk_add_f32 v[168:169], v[168:169], v[10:11]
v_pk_fma_f32 v[170:171], v[10:11], v[10:11], v[170:171]
v_pk_add_f32 v[168:169], v[168:169], v[12:13]
v_pk_fma_f32 v[170:171], v[12:13], v[12:13], v[170:171]
v_pk_add_f32 v[168:169], v[168:169], v[14:15]
v_pk_fma_f32 v[170:171], v[14:15], v[14:15], v[170:171]
v_pk_add_f32 v[168:169], v[168:169], v[16:17]
v_pk_fma_f32 v[170:171], v[16:17], v[16:17], v[170:171]
v_pk_add_f32 v[168:169], v[168:169], v[18:19]
v_pk_fma_f32 v[170:171], v[18:19], v[18:19], v[170:171]
v_pk_add_f32 v[168:169], v[168:169], v[20:21]
v_pk_fma_f32 v[170:171], v[20:21], v[20:21], v[170:171]
v_pk_add_f32 v[168:169], v[168:169], v[22:23]
v_pk_fma_f32 v[170:171], v[22:23], v[22:23], v[170:171]
v_pk_add_f32 v[168:169], v[168:169], v[24:25]
v_pk_fma_f32 v[170:171], v[24:25], v[24:25], v[170:171]
v_pk_add_f32 v[168:169], v[168:169], v[26:27]
v_pk_fma_f32 v[170:171], v[26:27], v[26:27], v[170:171]
v_pk_add_f32 v[168:169], v[168:169], v[28:29]
v_pk_fma_f32 v[170:171], v[28:29], v[28:29], v[170:171]
v_pk_add_f32 v[168:169], v[168:169], v[30:31]
v_pk_fma_f32 v[170:171], v[30:31], v[30:31], v[170:171]
v_pk_add_f32 v[168:169], v[168:169], v[32:33]
v_pk_fma_f32 v[170:171], v[32:33], v[32:33], v[170:171]
v_pk_add_f32 v[168:169], v[168:169], v[34:35]
v_pk_fma_f32 v[170:171], v[34:35], v[34:35], v[170:171]
v_pk_add_f32 v[168:169], v[168:169], v[36:37]
v_pk_fma_f32 v[170:171], v[36:37], v[36:37], v[170:171]
v_pk_add_f32 v[168:169], v[168:169], v[38:39]
v_pk_fma_f32 v[170:171], v[38:39], v[38:39], v[170:171]
v_pk_add_f32 v[168:169], v[168:169], v[40:41]
v_pk_fma_f32 v[170:171], v[40:41], v[40:41], v[170:171]
v_pk_add_f32 v[168:169], v[168:169], v[42:43]
v_pk_fma_f32 v[170:171], v[42:43], v[42:43], v[170:171]
v_pk_add_f32 v[168:169], v[168:169], v[44:45]
v_pk_fma_f32 v[170:171], v[44:45], v[44:45], v[170:171]
v_pk_add_f32 v[168:169], v[168:169], v[46:47]
v_pk_fma_f32 v[170:171], v[46:47], v[46:47], v[170:171]
s_setprio 0
v_add_u32 v174, -36864, v242
v_subrev_u32 v175, 66560, v174
v_min_u32 v174, v174, v175
v_add_u32 v174, 90112, v174
v_sub_u32 v175, v174, v242
v_add_u32 v242, v175, v242
v_add_u32_e64 v243, v175, v243
v_add_u32 v244, v175, v244
s_setprio 2
v_cvt_pkrtz_f16_f32 v179, v120, v121
v_cvt_pkrtz_f16_f32 v181, v122, v123
v_cvt_pkrtz_f16_f32 v183, v124, v125
v_cvt_pkrtz_f16_f32 v185, v126, v127
v_cvt_pkrtz_f16_f32 v187, v128, v129
v_cvt_pkrtz_f16_f32 v189, v130, v131
v_cvt_pk_f16_f32 v155, v132, v133
v_cvt_pk_f16_f32 v152, v134, v135
ds_read_b128 v[228:231], v249 offset:17408
ds_read_u16_d16 v142, v142
ds_read_u16_d16_hi v143, v143
v_mfma_f32_32x32x16_bf16 v[120:135], v[72:75], v[232:235], 0
v_pk_fma_f16 v154, v155, v155, s48
v_add_f32 v168, v168, v169
v_and_b32 v179, s49, v179
v_fma_mix_f32 v164, v136, v136, v164 op_sel:[0,0,0] op_sel_hi:[1,1,0]
v_bfe_u32 v178, v179, 2, 14
v_add_f32_e64 v170, v170, v171
v_pk_fma_f16 v151, v152, v152, s48
v_pk_mul_f16 v154, v155, v154
v_lshrrev_b32_e64 v179, 18, v179
v_pk_mul_f16 v151, v152, v151
ds_read_b128 v[232:235], v249 offset:18432
ds_read_u16_d16 v178, v178
ds_read_u16_d16_hi v179, v179
v_mfma_f32_32x32x16_bf16 v[120:135], v[76:79], v[236:239], v[120:135]
v_permlane32_swap_b32 v168, v170
v_fma_mix_f32 v164, v137, v137, v164 op_sel:[1,1,0] op_sel_hi:[1,1,0]
v_and_b32 v181, s49, v181
v_exp_f16 v153, v154
v_add_f32 v168, v168, v170
v_bfe_u32 v180, v181, 2, 14
v_exp_f16_e64 v150, v151
v_lshrrev_b32 v181, 18, v181
s_waitcnt lgkmcnt(7)
ds_read_b128 v[236:239], v249 offset:21504
ds_read_u16_d16 v180, v180
ds_read_u16_d16_hi v181, v181
v_mfma_f32_32x32x16_bf16 v[120:135], v[80:83], v[216:219], v[120:135]
v_mul_f32 v168, 1009429163, v168
v_fma_mix_f32 v164, v138, v138, v164 op_sel:[0,0,0] op_sel_hi:[1,1,0]
v_exp_f16_sdwa v153, v154 dst_sel:WORD_1 dst_unused:UNUSED_PRESERVE src0_sel:WORD_1
v_and_b32 v183, s49, v183
v_mov_b32 v170, v168
v_exp_f16_sdwa v150, v151 dst_sel:WORD_1 dst_unused:UNUSED_PRESERVE src0_sel:WORD_1
v_bfe_u32 v182, v183, 2, 14
v_fma_mix_f32 v164, v139, v139, v164 op_sel:[1,1,0] op_sel_hi:[1,1,0]
v_permlane32_swap_b32 v168, v170
ds_read_b128 v[216:219], v249 offset:19456
ds_read_u16_d16 v182, v182
v_mfma_f32_32x32x16_bf16 v[120:135], v[84:87], v[220:223], v[120:135]
v_lshrrev_b32 v183, 18, v183
v_pk_add_f16 v153, v153, 1.0 op_sel_hi:[1,0]
v_pk_add_f16 v150, v150, 1.0 op_sel_hi:[1,0]
v_and_b32_e64 v185, s49, v185
v_fma_f32 v170, -v168, v168, v170
v_rcp_f16_e64 v154, v153
v_bfe_u32 v184, v185, 2, 14
v_max_f32_e64 v170, 0, v170
v_fma_mix_f32 v164, v140, v140, v164 op_sel:[0,0,0] op_sel_hi:[1,1,0]
ds_read_b128 v[220:223], v249 offset:22528
ds_read_u16_d16_hi v183, v183
ds_read_u16_d16 v184, v184
v_mfma_f32_32x32x16_bf16 v[120:135], v[88:91], v[224:227], v[120:135]
v_lshrrev_b32 v185, 18, v185
v_rcp_f16 v151, v150
v_add_f32 v170, 925353388, v170
v_and_b32_e64 v187, s49, v187
v_fma_mix_f32 v164, v141, v141, v164 op_sel:[1,1,0] op_sel_hi:[1,1,0]
v_rcp_f16_sdwa v154, v153 dst_sel:WORD_1 dst_unused:UNUSED_PRESERVE src0_sel:WORD_1
v_rsq_f32 v170, v170
s_waitcnt lgkmcnt(5)
ds_read_b128 v[224:227], v249 offset:20480
ds_read_u16_d16_hi v185, v185
ds_read_b32 v247, v253 offset:16
v_mfma_f32_32x32x16_bf16 v[120:135], v[92:95], v[228:231], v[120:135]
v_bfe_u32 v186, v187, 2, 14
v_rcp_f16_sdwa v151, v150 dst_sel:WORD_1 dst_unused:UNUSED_PRESERVE src0_sel:WORD_1
v_lshrrev_b32_e64 v187, 18, v187
v_fma_mix_f32 v164, v142, v142, v164 op_sel:[0,0,0] op_sel_hi:[1,1,0]
v_and_b32_e64 v189, s49, v189
v_pk_mul_f16 v155, v155, v154
v_pk_mul_f16 v152, v152, v151
v_mul_f32 v172, 3203391086, v170
v_bfe_u32 v188, v189, 2, 14
v_fma_mix_f32 v165, v155, v155, v165 op_sel:[0,0,0] op_sel_hi:[1,1,0]
v_fma_mix_f32 v164, v143, v143, v164 op_sel:[1,1,0] op_sel_hi:[1,1,0]
v_lshrrev_b32_e64 v189, 18, v189
v_mul_f32 v173, v168, v172
v_fma_mix_f32 v165, v155, v155, v165 op_sel:[1,1,0] op_sel_hi:[1,1,0]
v_fma_mix_f32 v165, v152, v152, v165 op_sel:[0,0,0] op_sel_hi:[1,1,0]
v_fma_mix_f32 v165, v152, v152, v165 op_sel:[1,1,0] op_sel_hi:[1,1,0]
s_setprio 3
v_pk_fma_f32 v[0:1], v[0:1], v[172:173], v[172:173] op_sel:[0,0,1] op_sel_hi:[1,0,1] neg_lo:[0,0,1] neg_hi:[0,0,1]
v_pk_fma_f32 v[2:3], v[2:3], v[172:173], v[172:173] op_sel:[0,0,1] op_sel_hi:[1,0,1] neg_lo:[0,0,1] neg_hi:[0,0,1]
v_pk_fma_f32 v[4:5], v[4:5], v[172:173], v[172:173] op_sel:[0,0,1] op_sel_hi:[1,0,1] neg_lo:[0,0,1] neg_hi:[0,0,1]
v_pk_fma_f32 v[6:7], v[6:7], v[172:173], v[172:173] op_sel:[0,0,1] op_sel_hi:[1,0,1] neg_lo:[0,0,1] neg_hi:[0,0,1]
v_pk_fma_f32 v[8:9], v[8:9], v[172:173], v[172:173] op_sel:[0,0,1] op_sel_hi:[1,0,1] neg_lo:[0,0,1] neg_hi:[0,0,1]
v_pk_fma_f32 v[10:11], v[10:11], v[172:173], v[172:173] op_sel:[0,0,1] op_sel_hi:[1,0,1] neg_lo:[0,0,1] neg_hi:[0,0,1]
v_pk_fma_f32 v[12:13], v[12:13], v[172:173], v[172:173] op_sel:[0,0,1] op_sel_hi:[1,0,1] neg_lo:[0,0,1] neg_hi:[0,0,1]
v_pk_fma_f32 v[14:15], v[14:15], v[172:173], v[172:173] op_sel:[0,0,1] op_sel_hi:[1,0,1] neg_lo:[0,0,1] neg_hi:[0,0,1]
v_pk_fma_f32 v[16:17], v[16:17], v[172:173], v[172:173] op_sel:[0,0,1] op_sel_hi:[1,0,1] neg_lo:[0,0,1] neg_hi:[0,0,1]
v_pk_fma_f32 v[18:19], v[18:19], v[172:173], v[172:173] op_sel:[0,0,1] op_sel_hi:[1,0,1] neg_lo:[0,0,1] neg_hi:[0,0,1]
v_pk_fma_f32 v[20:21], v[20:21], v[172:173], v[172:173] op_sel:[0,0,1] op_sel_hi:[1,0,1] neg_lo:[0,0,1] neg_hi:[0,0,1]
v_pk_fma_f32 v[22:23], v[22:23], v[172:173], v[172:173] op_sel:[0,0,1] op_sel_hi:[1,0,1] neg_lo:[0,0,1] neg_hi:[0,0,1]
v_pk_fma_f32 v[24:25], v[24:25], v[172:173], v[172:173] op_sel:[0,0,1] op_sel_hi:[1,0,1] neg_lo:[0,0,1] neg_hi:[0,0,1]
v_pk_fma_f32 v[26:27], v[26:27], v[172:173], v[172:173] op_sel:[0,0,1] op_sel_hi:[1,0,1] neg_lo:[0,0,1] neg_hi:[0,0,1]
v_pk_fma_f32 v[28:29], v[28:29], v[172:173], v[172:173] op_sel:[0,0,1] op_sel_hi:[1,0,1] neg_lo:[0,0,1] neg_hi:[0,0,1]
v_pk_fma_f32 v[30:31], v[30:31], v[172:173], v[172:173] op_sel:[0,0,1] op_sel_hi:[1,0,1] neg_lo:[0,0,1] neg_hi:[0,0,1]
v_pk_fma_f32 v[32:33], v[32:33], v[172:173], v[172:173] op_sel:[0,0,1] op_sel_hi:[1,0,1] neg_lo:[0,0,1] neg_hi:[0,0,1]
v_pk_fma_f32 v[34:35], v[34:35], v[172:173], v[172:173] op_sel:[0,0,1] op_sel_hi:[1,0,1] neg_lo:[0,0,1] neg_hi:[0,0,1]
v_pk_fma_f32 v[36:37], v[36:37], v[172:173], v[172:173] op_sel:[0,0,1] op_sel_hi:[1,0,1] neg_lo:[0,0,1] neg_hi:[0,0,1]
v_pk_fma_f32 v[38:39], v[38:39], v[172:173], v[172:173] op_sel:[0,0,1] op_sel_hi:[1,0,1] neg_lo:[0,0,1] neg_hi:[0,0,1]
v_pk_fma_f32 v[40:41], v[40:41], v[172:173], v[172:173] op_sel:[0,0,1] op_sel_hi:[1,0,1] neg_lo:[0,0,1] neg_hi:[0,0,1]
v_pk_fma_f32 v[42:43], v[42:43], v[172:173], v[172:173] op_sel:[0,0,1] op_sel_hi:[1,0,1] neg_lo:[0,0,1] neg_hi:[0,0,1]
v_pk_fma_f32 v[44:45], v[44:45], v[172:173], v[172:173] op_sel:[0,0,1] op_sel_hi:[1,0,1] neg_lo:[0,0,1] neg_hi:[0,0,1]
v_pk_fma_f32 v[46:47], v[46:47], v[172:173], v[172:173] op_sel:[0,0,1] op_sel_hi:[1,0,1] neg_lo:[0,0,1] neg_hi:[0,0,1]
s_setprio 2
ds_read_u16_d16 v186, v186
ds_read_u16_d16_hi v187, v187
ds_read_u16_d16 v188, v188
ds_read_u16_d16_hi v189, v189
s_waitcnt lgkmcnt(4)
v_readfirstlane_b32 s43, v247
s_nop 1
s_cmp_ge_u32 s43, 24
s_cbranch_scc1 Lev7
Lev7w:
s_sleep 1
ds_read_b32 v247, v253 offset:16
s_waitcnt lgkmcnt(0)
v_readfirstlane_b32 s43, v247
s_cmp_eq_u32 s76, 0
s_cbranch_scc1 Lev7
s_sub_u32 s76, s76, 1
s_cmp_lt_u32 s43, 24
s_cbranch_scc1 Lev7w
Lev7:
s_setprio 1
v_cvt_pkrtz_f16_f32 v137, v120, v121
v_cvt_pkrtz_f16_f32 v139, v122, v123
v_cvt_pkrtz_f16_f32 v141, v124, v125
v_cvt_pkrtz_f16_f32 v143, v126, v127
v_cvt_pkrtz_f16_f32 v177, v128, v129
v_cvt_pkrtz_f16_f32 v191, v130, v131
v_cvt_pk_f16_f32 v155, v132, v133
v_cvt_pk_f16_f32 v152, v134, v135
s_add_u32 m0, s67, 39936
s_add_u32 s66, s66, 98304
buffer_load_dwordx4 v240, s[4:7], s66 offen lds
ds_read_b128 v[228:231], v249 offset:23552
v_mfma_f32_32x32x16_bf16 v[120:135], v[72:75], v[232:235], 0
v_pk_fma_f16 v154, v155, v155, s48
v_cvt_pk_bf16_f32 v96, v0, v1
v_and_b32 v137, s49, v137
v_fma_mix_f32 v165, v178, v178, v165 op_sel:[0,0,0] op_sel_hi:[1,1,0]
v_cvt_pk_bf16_f32 v97, v2, v3
v_pk_fma_f16 v151, v152, v152, s48
v_bfe_u32 v136, v137, 2, 14
v_cvt_pk_bf16_f32 v98, v4, v5
v_pk_mul_f16 v154, v155, v154
v_fma_mix_f32 v165, v179, v179, v165 op_sel:[1,1,0] op_sel_hi:[1,1,0]
v_lshrrev_b32_e64 v137, 18, v137
v_cvt_pk_bf16_f32 v99, v6, v7
s_add_u32 m0, s67, 46592
s_add_u32 s66, s66, 98304
buffer_load_dwordx4 v240, s[4:7], s66 offen lds
ds_read_b128 v[232:235], v248 offset:16384
ds_read_u16_d16 v136, v136
ds_read_u16_d16_hi v137, v137
v_mfma_f32_32x32x16_bf16 v[120:135], v[76:79], v[236:239], v[120:135]
v_pk_mul_f16 v151, v152, v151
v_exp_f16_e64 v153, v154
v_cvt_pk_bf16_f32 v100, v8, v9
v_and_b32_e64 v139, s49, v139
v_fma_mix_f32 v165, v180, v180, v165 op_sel:[0,0,0] op_sel_hi:[1,1,0]
v_cvt_pk_bf16_f32 v101, v10, v11
v_bfe_u32 v138, v139, 2, 14
v_exp_f16_e64 v150, v151
v_cvt_pk_bf16_f32 v102, v12, v13
v_lshrrev_b32_e64 v139, 18, v139
v_cvt_pk_bf16_f32 v103, v14, v15
s_add_u32 m0, s67, 53248
s_add_u32 s66, s66, 98304
buffer_load_dwordx4 v240, s[4:7], s66 offen lds
ds_read_b128 v[236:239], v248 offset:19456
ds_read_u16_d16 v138, v138
ds_read_u16_d16_hi v139, v139
v_mfma_f32_32x32x16_bf16 v[120:135], v[80:83], v[216:219], v[120:135]
v_fma_mix_f32 v165, v181, v181, v165 op_sel:[1,1,0] op_sel_hi:[1,1,0]
v_exp_f16_sdwa v153, v154 dst_sel:WORD_1 dst_unused:UNUSED_PRESERVE src0_sel:WORD_1
v_cvt_pk_bf16_f32 v104, v16, v17
v_and_b32_e64 v141, s49, v141
v_fma_mix_f32 v165, v182, v182, v165 op_sel:[0,0,0] op_sel_hi:[1,1,0]
v_cvt_pk_bf16_f32 v105, v18, v19
v_bfe_u32 v140, v141, 2, 14
v_exp_f16_sdwa v150, v151 dst_sel:WORD_1 dst_unused:UNUSED_PRESERVE src0_sel:WORD_1
v_cvt_pk_bf16_f32 v106, v20, v21
v_lshrrev_b32 v141, 18, v141
s_add_u32 m0, s67, 59904
s_add_u32 s66, s66, 98304
buffer_load_dwordx4 v240, s[4:7], s66 offen lds
s_add_u32 m0, s67, 0
s_add_u32 s66, s66, 98304
buffer_load_dwordx4 v240, s[4:7], s66 offen lds
ds_read_b128 v[216:219], v248 offset:17408
ds_read_u16_d16 v140, v140
ds_read_u16_d16_hi v141, v141
v_mfma_f32_32x32x16_bf16 v[120:135], v[84:87], v[220:223], v[120:135]
v_fma_mix_f32 v165, v183, v183, v165 op_sel:[1,1,0] op_sel_hi:[1,1,0]
v_cvt_pk_bf16_f32 v107, v22, v23
v_pk_add_f16 v153, v153, 1.0 op_sel_hi:[1,0]
v_pk_add_f16 v150, v150, 1.0 op_sel_hi:[1,0]
v_and_b32_e64 v143, s49, v143
v_cvt_pk_bf16_f32 v108, v24, v25
v_rcp_f16_e64 v154, v153
v_cvt_pk_bf16_f32 v109, v26, v27
v_bfe_u32 v142, v143, 2, 14
v_fma_mix_f32 v165, v184, v184, v165 op_sel:[0,0,0] op_sel_hi:[1,1,0]
v_cvt_pk_bf16_f32 v110, v28, v29
s_add_u32 m0, s67, 6656
s_add_u32 s66, s66, 98304
buffer_load_dwordx4 v240, s[4:7], s66 offen lds
ds_read_b128 v[220:223], v248 offset:20480
ds_read_u16_d16 v142, v142
v_mfma_f32_32x32x16_bf16 v[120:135], v[88:91], v[224:227], v[120:135]
v_rcp_f16 v151, v150
v_lshrrev_b32 v143, 18, v143
v_cvt_pk_bf16_f32 v111, v30, v31
v_fma_mix_f32 v165, v185, v185, v165 op_sel:[1,1,0] op_sel_hi:[1,1,0]
v_and_b32_e64 v177, s49, v177
s_setprio 0
v_cvt_pk_bf16_f32 v112, v32, v33
v_rcp_f16_sdwa v154, v153 dst_sel:WORD_1 dst_unused:UNUSED_PRESERVE src0_sel:WORD_1
v_bfe_u32 v176, v177, 2, 14
v_cvt_pk_bf16_f32 v113, v34, v35
s_waitcnt lgkmcnt(2)
v_fma_mix_f32 v165, v186, v186, v165 op_sel:[0,0,0] op_sel_hi:[1,1,0]
v_rcp_f16_sdwa v151, v150 dst_sel:WORD_1 dst_unused:UNUSED_PRESERVE src0_sel:WORD_1
s_add_u32 m0, s67, 13312
s_add_u32 s66, s66, 98304
buffer_load_dwordx4 v240, s[4:7], s66 offen lds
ds_read_b128 v[224:227], v248 offset:18432
ds_read_u16_d16_hi v143, v143
ds_read_u16_d16 v176, v176
v_mfma_f32_32x32x16_bf16 v[120:135], v[92:95], v[228:231], v[120:135]
v_cvt_pk_bf16_f32 v114, v36, v37
v_lshrrev_b32_e64 v177, 18, v177
v_cvt_pk_bf16_f32 v115, v38, v39
v_fma_mix_f32 v165, v187, v187, v165 op_sel:[1,1,0] op_sel_hi:[1,1,0]
v_and_b32_e64 v191, s49, v191
v_pk_mul_f16 v155, v155, v154
v_cvt_pk_bf16_f32 v116, v40, v41
v_pk_mul_f16 v152, v152, v151
v_bfe_u32 v190, v191, 2, 14
v_cvt_pk_bf16_f32 v117, v42, v43
v_fma_mix_f32 v165, v188, v188, v165 op_sel:[0,0,0] op_sel_hi:[1,1,0]
v_fma_mix_f32 v166, v155, v155, v166 op_sel:[0,0,0] op_sel_hi:[1,1,0]
s_add_u32 m0, s67, 19968
s_add_u32 s66, s66, 98304
buffer_load_dwordx4 v240, s[4:7], s66 offen lds
v_lshrrev_b32 v191, 18, v191
v_cvt_pk_bf16_f32 v118, v44, v45
v_fma_mix_f32 v166, v155, v155, v166 op_sel:[1,1,0] op_sel_hi:[1,1,0]
v_fma_mix_f32 v165, v189, v189, v165 op_sel:[1,1,0] op_sel_hi:[1,1,0]
v_cvt_pk_bf16_f32 v119, v46, v47
v_fma_mix_f32 v166, v152, v152, v166 op_sel:[0,0,0] op_sel_hi:[1,1,0]
v_fma_mix_f32 v166, v152, v152, v166 op_sel:[1,1,0] op_sel_hi:[1,1,0]
s_setprio 2
v_cvt_pkrtz_f16_f32 v179, v120, v121
v_cvt_pkrtz_f16_f32 v181, v122, v123
v_cvt_pkrtz_f16_f32 v183, v124, v125
v_cvt_pkrtz_f16_f32 v185, v126, v127
v_cvt_pkrtz_f16_f32 v187, v128, v129
v_cvt_pk_f16_f32 v155, v130, v131
v_cvt_pk_f16_f32 v152, v132, v133
v_cvt_pk_f16_f32 v149, v134, v135
ds_read_b128 v[228:231], v248 offset:21504
ds_read_u16_d16_hi v177, v177
ds_read_u16_d16 v190, v190
ds_read_u16_d16_hi v191, v191
v_mfma_f32_32x32x16_bf16 v[120:135], v[96:99], v[232:235], 0
v_pk_fma_f16 v154, v155, v155, s48
v_and_b32_e64 v179, s49, v179
v_fma_mix_f32 v166, v136, v136, v166 op_sel:[0,0,0] op_sel_hi:[1,1,0]
v_pk_fma_f16 v151, v152, v152, s48
v_pk_fma_f16 v148, v149, v149, s48
v_bfe_u32 v178, v179, 2, 14
v_pk_mul_f16 v154, v155, v154
v_fma_mix_f32 v166, v137, v137, v166 op_sel:[1,1,0] op_sel_hi:[1,1,0]
v_pk_mul_f16 v151, v152, v151
v_lshrrev_b32_e64 v179, 18, v179
ds_read_b128 v[232:235], v248 offset:22528
ds_read_u16_d16 v178, v178
ds_read_u16_d16_hi v179, v179
v_mfma_f32_32x32x16_bf16 v[120:135], v[100:103], v[236:239], v[120:135]
v_pk_mul_f16 v148, v149, v148
v_exp_f16_e64 v153, v154
v_fma_mix_f32 v166, v138, v138, v166 op_sel:[0,0,0] op_sel_hi:[1,1,0]
v_and_b32 v181, s49, v181
v_exp_f16 v150, v151
v_exp_f16_e64 v147, v148
v_bfe_u32 v180, v181, 2, 14
v_fma_mix_f32 v166, v139, v139, v166 op_sel:[1,1,0] op_sel_hi:[1,1,0]
ds_read_b128 v[236:239], v248 offset:25600
ds_read_u16_d16 v180, v180
v_mfma_f32_32x32x16_bf16 v[120:135], v[104:107], v[216:219], v[120:135]
v_exp_f16_sdwa v153, v154 dst_sel:WORD_1 dst_unused:UNUSED_PRESERVE src0_sel:WORD_1
v_lshrrev_b32_e64 v181, 18, v181
v_exp_f16_sdwa v150, v151 dst_sel:WORD_1 dst_unused:UNUSED_PRESERVE src0_sel:WORD_1
v_fma_mix_f32 v166, v140, v140, v166 op_sel:[0,0,0] op_sel_hi:[1,1,0]
v_and_b32 v183, s49, v183
v_exp_f16_sdwa v147, v148 dst_sel:WORD_1 dst_unused:UNUSED_PRESERVE src0_sel:WORD_1
v_fma_mix_f32 v166, v141, v141, v166 op_sel:[1,1,0] op_sel_hi:[1,1,0]
s_waitcnt lgkmcnt(5)
ds_read_b128 v[216:219], v248 offset:23552
ds_read_u16_d16_hi v181, v181
v_mfma_f32_32x32x16_bf16 v[120:135], v[108:111], v[220:223], v[120:135]
v_pk_add_f16 v153, v153, 1.0 op_sel_hi:[1,0]
v_bfe_u32 v182, v183, 2, 14
v_pk_add_f16 v150, v150, 1.0 op_sel_hi:[1,0]
v_pk_add_f16 v147, v147, 1.0 op_sel_hi:[1,0]
v_rcp_f16 v154, v153
v_lshrrev_b32 v183, 18, v183
v_fma_mix_f32 v166, v142, v142, v166 op_sel:[0,0,0] op_sel_hi:[1,1,0]
v_rcp_f16 v151, v150
v_and_b32 v185, s49, v185
ds_read_b128 v[220:223], v248 offset:26624
ds_read_u16_d16 v182, v182
ds_read_u16_d16_hi v183, v183
v_mfma_f32_32x32x16_bf16 v[120:135], v[112:115], v[224:227], v[120:135]
v_fma_mix_f32 v166, v143, v143, v166 op_sel:[1,1,0] op_sel_hi:[1,1,0]
v_rcp_f16_e64 v148, v147
v_bfe_u32 v184, v185, 2, 14
v_rcp_f16_sdwa v154, v153 dst_sel:WORD_1 dst_unused:UNUSED_PRESERVE src0_sel:WORD_1
v_fma_mix_f32 v166, v176, v176, v166 op_sel:[0,0,0] op_sel_hi:[1,1,0]
v_rcp_f16_sdwa v151, v150 dst_sel:WORD_1 dst_unused:UNUSED_PRESERVE src0_sel:WORD_1
v_lshrrev_b32_e64 v185, 18, v185
ds_read_b128 v[224:227], v248 offset:24576
ds_read_u16_d16 v184, v184
ds_read_u16_d16_hi v185, v185
v_mfma_f32_32x32x16_bf16 v[120:135], v[116:119], v[228:231], v[120:135]
v_rcp_f16_sdwa v148, v147 dst_sel:WORD_1 dst_unused:UNUSED_PRESERVE src0_sel:WORD_1
s_cmp_eq_u32 s40, 7
s_cbranch_scc1 Lrdy24
s_waitcnt vmcnt(0)
Lrdy24:
s_mov_b64 exec, 1
ds_add_u32 v253, v254 offset:12
s_mov_b64 exec, -1
v_and_b32 v187, s49, v187
v_fma_mix_f32 v166, v177, v177, v166 op_sel:[1,1,0] op_sel_hi:[1,1,0]
v_pk_mul_f16 v155, v155, v154
v_pk_mul_f16 v152, v152, v151
v_pk_mul_f16 v149, v149, v148
v_bfe_u32 v186, v187, 2, 14
v_fma_mix_f32 v166, v190, v190, v166 op_sel:[0,0,0] op_sel_hi:[1,1,0]
v_fma_mix_f32 v167, v155, v155, v167 op_sel:[0,0,0] op_sel_hi:[1,1,0]
v_fma_mix_f32 v167, v155, v155, v167 op_sel:[1,1,0] op_sel_hi:[1,1,0]
v_lshrrev_b32_e64 v187, 18, v187
v_fma_mix_f32 v167, v152, v152, v167 op_sel:[0,0,0] op_sel_hi:[1,1,0]
v_fma_mix_f32 v166, v191, v191, v166 op_sel:[1,1,0] op_sel_hi:[1,1,0]
v_fma_mix_f32 v167, v152, v152, v167 op_sel:[1,1,0] op_sel_hi:[1,1,0]
v_fma_mix_f32 v167, v149, v149, v167 op_sel:[0,0,0] op_sel_hi:[1,1,0]
v_fma_mix_f32 v167, v149, v149, v167 op_sel:[1,1,0] op_sel_hi:[1,1,0]
s_cmp_lg_u32 s40, 7
s_cbranch_scc1 Lnoinit
s_waitcnt vmcnt(11)
v_mov_b32_e64 v255, 1
s_mov_b64 exec, 1
buffer_atomic_add v255, v241, s[36:39], 0 offen
s_mov_b64 exec, -1
Lnoinit:
s_setprio 1
v_cvt_pkrtz_f16_f32 v137, v120, v121
v_cvt_pkrtz_f16_f32 v139, v122, v123
v_cvt_pkrtz_f16_f32 v141, v124, v125
v_cvt_pkrtz_f16_f32 v143, v126, v127
v_cvt_pkrtz_f16_f32 v177, v128, v129
v_cvt_pk_f16_f32 v155, v130, v131
v_cvt_pk_f16_f32 v152, v132, v133
v_cvt_pk_f16_f32 v149, v134, v135
s_waitcnt lgkmcnt(1)
s_add_u32 s46, s80, 12582912
buffer_store_dwordx4 v[72:75], v241, s[32:35], s46 offen sc1
ds_read_b128 v[228:231], v248 offset:27648
ds_read_u16_d16 v186, v186
ds_read_u16_d16_hi v187, v187
v_mfma_f32_32x32x16_bf16 v[120:135], v[96:99], v[232:235], 0
v_pk_fma_f16 v154, v155, v155, s48
v_and_b32 v137, s49, v137
v_fma_mix_f32 v167, v178, v178, v167 op_sel:[0,0,0] op_sel_hi:[1,1,0]
v_pk_fma_f16 v151, v152, v152, s48
v_pk_fma_f16 v148, v149, v149, s48
v_bfe_u32 v136, v137, 2, 14
v_pk_mul_f16 v154, v155, v154
v_pk_mul_f16 v151, v152, v151
v_fma_mix_f32 v167, v179, v179, v167 op_sel:[1,1,0] op_sel_hi:[1,1,0]
v_lshrrev_b32_e64 v137, 18, v137
ds_read_b128 v[232:235], v250 offset:65520
ds_read_u16_d16 v136, v136
ds_read_u16_d16_hi v137, v137
v_mfma_f32_32x32x16_bf16 v[120:135], v[100:103], v[236:239], v[120:135]
v_pk_mul_f16 v148, v149, v148
v_exp_f16 v153, v154
v_exp_f16 v150, v151
v_and_b32_e64 v139, s49, v139
v_fma_mix_f32 v167, v180, v180, v167 op_sel:[0,0,0] op_sel_hi:[1,1,0]
v_exp_f16_e64 v147, v148
v_bfe_u32 v138, v139, 2, 14
ds_read_b128 v[236:239], v248 offset:28672
ds_read_b32 v247, v253 offset:12
ds_read_u16_d16 v138, v138
v_mfma_f32_32x32x16_bf16 v[120:135], v[104:107], v[216:219], v[120:135]
v_exp_f16_sdwa v153, v154 dst_sel:WORD_1 dst_unused:UNUSED_PRESERVE src0_sel:WORD_1
v_lshrrev_b32_e64 v139, 18, v139
v_fma_mix_f32 v167, v181, v181, v167 op_sel:[1,1,0] op_sel_hi:[1,1,0]
v_exp_f16_sdwa v150, v151 dst_sel:WORD_1 dst_unused:UNUSED_PRESERVE src0_sel:WORD_1
v_exp_f16_sdwa v147, v148 dst_sel:WORD_1 dst_unused:UNUSED_PRESERVE src0_sel:WORD_1
v_and_b32_e64 v141, s49, v141
v_fma_mix_f32 v167, v182, v182, v167 op_sel:[0,0,0] op_sel_hi:[1,1,0]
ds_read_b128 v[216:219], v248 offset:31744
ds_read_u16_d16_hi v139, v139
v_mfma_f32_32x32x16_bf16 v[120:135], v[108:111], v[220:223], v[120:135]
v_pk_add_f16 v153, v153, 1.0 op_sel_hi:[1,0]
v_bfe_u32 v140, v141, 2, 14
v_pk_add_f16 v150, v150, 1.0 op_sel_hi:[1,0]
v_pk_add_f16 v147, v147, 1.0 op_sel_hi:[1,0]
v_rcp_f16 v154, v153
v_lshrrev_b32 v141, 18, v141
v_fma_mix_f32 v167, v183, v183, v167 op_sel:[1,1,0] op_sel_hi:[1,1,0]
ds_read_u16_d16 v140, v140
ds_read_u16_d16_hi v141, v141
s_waitcnt lgkmcnt(5)
v_readfirstlane_b32 s43, v247
s_nop 1
s_cmp_ge_u32 s43, 32
s_cbranch_scc1 Lev8
Lev8w:
s_sleep 1
ds_read_b32 v247, v253 offset:12
s_waitcnt lgkmcnt(0)
v_readfirstlane_b32 s43, v247
s_cmp_eq_u32 s76, 0
s_cbranch_scc1 Lev8
s_sub_u32 s76, s76, 1
s_cmp_lt_u32 s43, 32
s_cbranch_scc1 Lev8w
Lev8:
v_rcp_f16 v151, v150
ds_read_b128 v[220:223], v248 offset:29696
v_mfma_f32_32x32x16_bf16 v[120:135], v[112:115], v[224:227], v[120:135]
v_and_b32 v143, s49, v143
v_rcp_f16 v148, v147
v_fma_mix_f32 v167, v184, v184, v167 op_sel:[0,0,0] op_sel_hi:[1,1,0]
v_bfe_u32 v142, v143, 2, 14
s_setprio 0
v_rcp_f16_sdwa v154, v153 dst_sel:WORD_1 dst_unused:UNUSED_PRESERVE src0_sel:WORD_1
v_rcp_f16_sdwa v151, v150 dst_sel:WORD_1 dst_unused:UNUSED_PRESERVE src0_sel:WORD_1
v_lshrrev_b32 v143, 18, v143
ds_read_b128 v[224:227], v245 offset:6528
ds_read_b128 v[192:195], v244 offset:128
ds_read_b128 v[196:199], v244 offset:64
ds_read_u16_d16 v142, v142
ds_read_u16_d16_hi v143, v143
v_mfma_f32_32x32x16_bf16 v[120:135], v[116:119], v[228:231], v[120:135]
v_fma_mix_f32 v167, v185, v185, v167 op_sel:[1,1,0] op_sel_hi:[1,1,0]
v_rcp_f16_sdwa v148, v147 dst_sel:WORD_1 dst_unused:UNUSED_PRESERVE src0_sel:WORD_1
v_and_b32_e64 v177, s49, v177
v_pk_mul_f16 v155, v155, v154
v_fma_mix_f32 v167, v186, v186, v167 op_sel:[0,0,0] op_sel_hi:[1,1,0]
v_pk_mul_f16 v152, v152, v151
v_bfe_u32 v176, v177, 2, 14
v_pk_mul_f16 v149, v149, v148
v_fma_mix_f32 v156, v155, v155, v156 op_sel:[0,0,0] op_sel_hi:[1,1,0]
v_fma_mix_f32 v156, v155, v155, v156 op_sel:[1,1,0] op_sel_hi:[1,1,0]
v_lshrrev_b32 v177, 18, v177
v_fma_mix_f32 v167, v187, v187, v167 op_sel:[1,1,0] op_sel_hi:[1,1,0]
v_fma_mix_f32 v156, v152, v152, v156 op_sel:[0,0,0] op_sel_hi:[1,1,0]
v_fma_mix_f32 v156, v152, v152, v156 op_sel:[1,1,0] op_sel_hi:[1,1,0]
v_fma_mix_f32 v156, v149, v149, v156 op_sel:[0,0,0] op_sel_hi:[1,1,0]
v_fma_mix_f32 v156, v149, v149, v156 op_sel:[1,1,0] op_sel_hi:[1,1,0]
s_setprio 2
v_mfma_f32_32x32x16_bf16 v[0:15], v[232:235], v[232:235], 0
s_add_u32 s46, s80, 14680064
buffer_store_dwordx4 v[76:79], v241, s[32:35], s46 offen sc1
ds_read_b128 v[228:231], v248 offset:32768
ds_read_u16_d16 v176, v176
ds_read_u16_d16_hi v177, v177
v_cvt_pkrtz_f16_f32 v179, v120, v121
v_cvt_pkrtz_f16_f32 v181, v122, v123
v_cvt_pkrtz_f16_f32 v183, v124, v125
v_mfma_f32_32x32x16_bf16 v[16:31], v[232:235], v[232:235], 0
v_cvt_pkrtz_f16_f32 v185, v126, v127
v_cvt_pkrtz_f16_f32 v187, v128, v129
v_cvt_pk_f16_f32 v155, v130, v131
v_cvt_pk_f16_f32 v152, v132, v133
v_mfma_f32_32x32x16_bf16 v[32:47], v[232:235], v[232:235], 0
v_cvt_pk_f16_f32 v149, v134, v135
v_pk_fma_f16 v154, v155, v155, s48
v_and_b32_e64 v179, s49, v179
v_mfma_f32_32x32x16_bf16 v[120:135], v[96:99], v[236:239], 0
ds_read_b128 v[232:235], v248 offset:30720
v_fma_mix_f32 v156, v136, v136, v156 op_sel:[0,0,0] op_sel_hi:[1,1,0]
v_pk_fma_f16 v151, v152, v152, s48
v_pk_fma_f16 v148, v149, v149, s48
v_bfe_u32 v178, v179, 2, 14
v_pk_mul_f16 v154, v155, v154
v_pk_mul_f16 v151, v152, v151
v_fma_mix_f32 v156, v137, v137, v156 op_sel:[1,1,0] op_sel_hi:[1,1,0]
s_waitcnt lgkmcnt(4)
v_mfma_f32_32x32x16_bf16 v[120:135], v[100:103], v[216:219], v[120:135]
ds_read_b128 v[236:239], v245 offset:6144
ds_read_b128 v[200:203], v244
ds_read_b128 v[204:207], v243 offset:128
ds_read_u16_d16 v178, v178
v_lshrrev_b32 v179, 18, v179
v_pk_mul_f16 v148, v149, v148
v_exp_f16 v153, v154
v_exp_f16 v150, v151
v_and_b32_e64 v181, s49, v181
v_fma_mix_f32 v156, v138, v138, v156 op_sel:[0,0,0] op_sel_hi:[1,1,0]
v_mfma_f32_32x32x16_bf16 v[120:135], v[104:107], v[220:223], v[120:135]
ds_read_b128 v[216:219], v248 offset:33792
ds_read_u16_d16_hi v179, v179
v_exp_f16_e64 v147, v148
v_bfe_u32 v180, v181, 2, 14
v_exp_f16_sdwa v153, v154 dst_sel:WORD_1 dst_unused:UNUSED_PRESERVE src0_sel:WORD_1
v_lshrrev_b32_e64 v181, 18, v181
v_fma_mix_f32 v156, v139, v139, v156 op_sel:[1,1,0] op_sel_hi:[1,1,0]
v_smfmac_f32_16x16x32_bf16 v[40:43], v[226:227], v[192:195], v246
ds_read_b128 v[220:223], v245 offset:5760
ds_read_b128 v[208:211], v243 offset:64
ds_read_b128 v[212:215], v243
ds_read_u16_d16 v180, v180
ds_read_u16_d16_hi v181, v181
v_exp_f16_sdwa v150, v151 dst_sel:WORD_1 dst_unused:UNUSED_PRESERVE src0_sel:WORD_1
v_smfmac_f32_16x16x32_bf16 v[24:27], v[224:225], v[196:199], v246
v_exp_f16_sdwa v147, v148 dst_sel:WORD_1 dst_unused:UNUSED_PRESERVE src0_sel:WORD_1
v_and_b32 v183, s49, v183
v_fma_mix_f32 v156, v140, v140, v156 op_sel:[0,0,0] op_sel_hi:[1,1,0]
v_pk_add_f16 v153, v153, 1.0 op_sel_hi:[1,0]
s_waitcnt lgkmcnt(7)
v_mfma_f32_32x32x16_bf16 v[120:135], v[108:111], v[228:231], v[120:135]
ds_read_b128 v[224:227], v245 offset:5376
ds_read_b128 v[192:195], v242 offset:128
ds_read_b128 v[196:199], v242 offset:64
v_bfe_u32 v182, v183, 2, 14
v_pk_add_f16 v150, v150, 1.0 op_sel_hi:[1,0]
v_pk_add_f16 v147, v147, 1.0 op_sel_hi:[1,0]
v_rcp_f16 v154, v153
v_lshrrev_b32 v183, 18, v183
v_fma_mix_f32 v156, v141, v141, v156 op_sel:[1,1,0] op_sel_hi:[1,1,0]
v_mfma_f32_32x32x16_bf16 v[120:135], v[112:115], v[232:235], v[120:135]
ds_read_b128 v[228:231], v248 offset:34816
ds_read_u16_d16 v182, v182
ds_read_u16_d16_hi v183, v183
v_rcp_f16 v151, v150
v_and_b32 v185, s49, v185
v_rcp_f16_e64 v148, v147
v_fma_mix_f32 v156, v142, v142, v156 op_sel:[0,0,0] op_sel_hi:[1,1,0]
v_bfe_u32 v184, v185, 2, 14
v_smfmac_f32_16x16x32_bf16 v[8:11], v[238:239], v[200:203], v246
ds_read_b128 v[232:235], v248 offset:37888
ds_read_u16_d16 v184, v184
v_rcp_f16_sdwa v154, v153 dst_sel:WORD_1 dst_unused:UNUSED_PRESERVE src0_sel:WORD_1
v_rcp_f16_sdwa v151, v150 dst_sel:WORD_1 dst_unused:UNUSED_PRESERVE src0_sel:WORD_1
v_smfmac_f32_16x16x32_bf16 v[40:43], v[236:237], v[204:207], v246
v_lshrrev_b32 v185, 18, v185
v_fma_mix_f32 v156, v143, v143, v156 op_sel:[1,1,0] op_sel_hi:[1,1,0]
s_waitcnt lgkmcnt(6)
v_mfma_f32_32x32x16_bf16 v[120:135], v[116:119], v[216:219], v[120:135]
ds_read_b128 v[236:239], v248 offset:35840
ds_read_u16_d16_hi v185, v185
v_rcp_f16_sdwa v148, v147 dst_sel:WORD_1 dst_unused:UNUSED_PRESERVE src0_sel:WORD_1
v_and_b32_e64 v187, s49, v187
v_pk_mul_f16 v155, v155, v154
v_fma_mix_f32 v156, v176, v176, v156 op_sel:[0,0,0] op_sel_hi:[1,1,0]
v_pk_mul_f16 v152, v152, v151
v_bfe_u32 v186, v187, 2, 14
v_pk_mul_f16 v149, v149, v148
v_smfmac_f32_16x16x32_bf16 v[24:27], v[222:223], v[208:211], v246
ds_read_b128 v[216:219], v248 offset:38912
ds_read_u16_d16 v186, v186
v_fma_mix_f32 v157, v155, v155, v157 op_sel:[0,0,0] op_sel_hi:[1,1,0]
v_fma_mix_f32 v157, v155, v155, v157 op_sel:[1,1,0] op_sel_hi:[1,1,0]
v_lshrrev_b32_e64 v187, 18, v187
v_fma_mix_f32 v156, v177, v177, v156 op_sel:[1,1,0] op_sel_hi:[1,1,0]
v_smfmac_f32_16x16x32_bf16 v[8:11], v[220:221], v[212:215], v246
v_fma_mix_f32 v157, v152, v152, v157 op_sel:[0,0,0] op_sel_hi:[1,1,0]
v_fma_mix_f32 v157, v152, v152, v157 op_sel:[1,1,0] op_sel_hi:[1,1,0]
v_fma_mix_f32 v157, v149, v149, v157 op_sel:[0,0,0] op_sel_hi:[1,1,0]
v_fma_mix_f32 v157, v149, v149, v157 op_sel:[1,1,0] op_sel_hi:[1,1,0]
s_setprio 1
v_smfmac_f32_16x16x32_bf16 v[40:43], v[226:227], v[192:195], v246
s_waitcnt lgkmcnt(4)
s_add_u32 s46, s80, 16777216
buffer_store_dwordx4 v[80:83], v241, s[32:35], s46 offen sc1
ds_read_b128 v[220:223], v248 offset:36864
ds_read_u16_d16_hi v187, v187
v_cvt_pkrtz_f16_f32 v137, v120, v121
v_cvt_pkrtz_f16_f32 v139, v122, v123
v_cvt_pkrtz_f16_f32 v141, v124, v125
v_cvt_pkrtz_f16_f32 v143, v126, v127
v_cvt_pk_f16_f32 v155, v128, v129
v_smfmac_f32_16x16x32_bf16 v[24:27], v[224:225], v[196:199], v246
v_cvt_pk_f16_f32 v152, v130, v131
v_cvt_pk_f16_f32 v149, v132, v133
v_cvt_pk_f16_f32 v146, v134, v135
v_pk_fma_f16 v154, v155, v155, s48
v_and_b32_e64 v137, s49, v137
v_mfma_f32_32x32x16_bf16 v[120:135], v[96:99], v[228:231], 0
ds_read_b128 v[224:227], v248 offset:39936
v_fma_mix_f32 v157, v178, v178, v157 op_sel:[0,0,0] op_sel_hi:[1,1,0]
v_pk_fma_f16 v151, v152, v152, s48
v_pk_fma_f16 v148, v149, v149, s48
v_pk_fma_f16 v145, v146, v146, s48
v_pk_mul_f16 v154, v155, v154
v_bfe_u32 v136, v137, 2, 14
v_pk_mul_f16 v151, v152, v151
v_fma_mix_f32 v157, v179, v179, v157 op_sel:[1,1,0] op_sel_hi:[1,1,0]
v_pk_mul_f16 v148, v149, v148
v_pk_mul_f16 v145, v146, v145
v_mfma_f32_32x32x16_bf16 v[120:135], v[100:103], v[232:235], v[120:135]
ds_read_b128 v[228:231], v245 offset:4992
ds_read_b128 v[200:203], v242
v_xor_b32 v244, 16, v244
ds_read_b128 v[204:207], v244 offset:128
ds_read_u16_d16 v136, v136
v_exp_f16 v153, v154
v_lshrrev_b32 v137, 18, v137
v_exp_f16 v150, v151
v_fma_mix_f32 v157, v180, v180, v157 op_sel:[0,0,0] op_sel_hi:[1,1,0]
v_exp_f16 v147, v148
v_and_b32 v139, s49, v139
v_exp_f16 v144, v145
s_waitcnt lgkmcnt(5)
v_mfma_f32_32x32x16_bf16 v[120:135], v[104:107], v[236:239], v[120:135]
ds_read_b128 v[232:235], v245 offset:4608
ds_read_b128 v[208:211], v244 offset:64
ds_read_b128 v[212:215], v244
ds_read_u16_d16_hi v137, v137
v_exp_f16_sdwa v153, v154 dst_sel:WORD_1 dst_unused:UNUSED_PRESERVE src0_sel:WORD_1
v_fma_mix_f32 v157, v181, v181, v157 op_sel:[1,1,0] op_sel_hi:[1,1,0]
v_bfe_u32 v138, v139, 2, 14
v_exp_f16_sdwa v150, v151 dst_sel:WORD_1 dst_unused:UNUSED_PRESERVE src0_sel:WORD_1
v_exp_f16_sdwa v147, v148 dst_sel:WORD_1 dst_unused:UNUSED_PRESERVE src0_sel:WORD_1
v_exp_f16_sdwa v144, v145 dst_sel:WORD_1 dst_unused:UNUSED_PRESERVE src0_sel:WORD_1
v_lshrrev_b32_e64 v139, 18, v139
v_fma_mix_f32 v157, v182, v182, v157 op_sel:[0,0,0] op_sel_hi:[1,1,0]
v_mfma_f32_32x32x16_bf16 v[120:135], v[108:111], v[216:219], v[120:135]
ds_read_b128 v[236:239], v248 offset:40960
ds_read_u16_d16 v138, v138
ds_read_u16_d16_hi v139, v139
v_pk_add_f16 v153, v153, 1.0 op_sel_hi:[1,0]
v_pk_add_f16 v150, v150, 1.0 op_sel_hi:[1,0]
v_pk_add_f16 v147, v147, 1.0 op_sel_hi:[1,0]
v_and_b32_e64 v141, s49, v141
v_pk_add_f16 v144, v144, 1.0 op_sel_hi:[1,0]
v_rcp_f16_e64 v154, v153
v_fma_mix_f32 v157, v183, v183, v157 op_sel:[1,1,0] op_sel_hi:[1,1,0]
v_rcp_f16_e64 v151, v150
v_mfma_f32_32x32x16_bf16 v[120:135], v[112:115], v[220:223], v[120:135]
ds_read_b128 v[216:219], v248 offset:44032
v_bfe_u32 v140, v141, 2, 14
v_rcp_f16_e64 v148, v147
v_fma_mix_f32 v157, v184, v184, v157 op_sel:[0,0,0] op_sel_hi:[1,1,0]
v_rcp_f16 v145, v144
v_lshrrev_b32 v141, 18, v141
v_rcp_f16_sdwa v154, v153 dst_sel:WORD_1 dst_unused:UNUSED_PRESERVE src0_sel:WORD_1
s_setprio 0
v_rcp_f16_sdwa v151, v150 dst_sel:WORD_1 dst_unused:UNUSED_PRESERVE src0_sel:WORD_1
s_waitcnt lgkmcnt(4)
v_mfma_f32_32x32x16_bf16 v[120:135], v[116:119], v[224:227], v[120:135]
ds_read_b128 v[220:223], v248 offset:41984
ds_read_u16_d16 v140, v140
ds_read_u16_d16_hi v141, v141
v_fma_mix_f32 v157, v185, v185, v157 op_sel:[1,1,0] op_sel_hi:[1,1,0]
v_and_b32_e64 v143, s49, v143
v_rcp_f16_sdwa v148, v147 dst_sel:WORD_1 dst_unused:UNUSED_PRESERVE src0_sel:WORD_1
v_rcp_f16_sdwa v145, v144 dst_sel:WORD_1 dst_unused:UNUSED_PRESERVE src0_sel:WORD_1
v_pk_mul_f16 v155, v155, v154
v_bfe_u32 v142, v143, 2, 14
v_fma_mix_f32 v157, v186, v186, v157 op_sel:[0,0,0] op_sel_hi:[1,1,0]
v_pk_mul_f16 v152, v152, v151
v_pk_mul_f16 v149, v149, v148
v_smfmac_f32_16x16x32_bf16 v[8:11], v[230:231], v[200:203], v246
ds_read_b128 v[224:227], v248 offset:45056
ds_read_u16_d16 v142, v142
v_pk_mul_f16 v146, v146, v145
v_fma_mix_f32 v158, v155, v155, v158 op_sel:[0,0,0] op_sel_hi:[1,1,0]
v_lshrrev_b32 v143, 18, v143
v_fma_mix_f32 v158, v155, v155, v158 op_sel:[1,1,0] op_sel_hi:[1,1,0]
v_fma_mix_f32 v158, v152, v152, v158 op_sel:[0,0,0] op_sel_hi:[1,1,0]
v_smfmac_f32_16x16x32_bf16 v[44:47], v[228:229], v[204:207], v246
v_fma_mix_f32 v157, v187, v187, v157 op_sel:[1,1,0] op_sel_hi:[1,1,0]
v_fma_mix_f32 v158, v152, v152, v158 op_sel:[1,1,0] op_sel_hi:[1,1,0]
v_fma_mix_f32 v158, v149, v149, v158 op_sel:[0,0,0] op_sel_hi:[1,1,0]
v_fma_mix_f32 v158, v149, v149, v158 op_sel:[1,1,0] op_sel_hi:[1,1,0]
v_fma_mix_f32 v158, v146, v146, v158 op_sel:[0,0,0] op_sel_hi:[1,1,0]
v_fma_mix_f32 v158, v146, v146, v158 op_sel:[1,1,0] op_sel_hi:[1,1,0]
s_setprio 2
v_smfmac_f32_16x16x32_bf16 v[28:31], v[234:235], v[208:211], v246
s_add_u32 s46, s80, 18874368
buffer_store_dwordx4 v[84:87], v241, s[32:35], s46 offen sc1
ds_read_b128 v[228:231], v248 offset:43008
ds_read_u16_d16_hi v143, v143
v_cvt_pkrtz_f16_f32 v179, v120, v121
v_cvt_pkrtz_f16_f32 v181, v122, v123
v_cvt_pkrtz_f16_f32 v183, v124, v125
v_cvt_pkrtz_f16_f32 v185, v126, v127
v_smfmac_f32_16x16x32_bf16 v[12:15], v[232:233], v[212:215], v246
v_cvt_pkrtz_f16_f32 v187, v128, v129
v_cvt_pk_f16_f32 v155, v130, v131
v_cvt_pk_f16_f32 v152, v132, v133
v_cvt_pk_f16_f32 v149, v134, v135
v_pk_fma_f16 v154, v155, v155, s48
s_waitcnt lgkmcnt(2)
v_mfma_f32_32x32x16_bf16 v[120:135], v[96:99], v[236:239], 0
ds_read_b128 v[232:235], v248 offset:46080
v_and_b32 v179, s49, v179
v_fma_mix_f32 v158, v136, v136, v158 op_sel:[0,0,0] op_sel_hi:[1,1,0]
v_pk_fma_f16 v151, v152, v152, s48
v_pk_fma_f16 v148, v149, v149, s48
v_bfe_u32 v178, v179, 2, 14
v_pk_mul_f16 v154, v155, v154
v_pk_mul_f16 v151, v152, v151
v_pk_mul_f16 v148, v149, v148
v_lshrrev_b32 v179, 18, v179
v_mfma_f32_32x32x16_bf16 v[120:135], v[100:103], v[216:219], v[120:135]
ds_read_b128 v[236:239], v245 offset:4224
v_xor_b32 v243, 16, v243
ds_read_b128 v[192:195], v243 offset:128
ds_read_b128 v[196:199], v243 offset:64
ds_read_u16_d16 v178, v178
ds_read_u16_d16_hi v179, v179
v_fma_mix_f32 v158, v137, v137, v158 op_sel:[1,1,0] op_sel_hi:[1,1,0]
v_exp_f16 v153, v154
v_and_b32 v181, s49, v181
v_exp_f16 v150, v151
v_exp_f16 v147, v148
v_bfe_u32 v180, v181, 2, 14
v_mfma_f32_32x32x16_bf16 v[120:135], v[104:107], v[220:223], v[120:135]
ds_read_b128 v[216:219], v245 offset:3840
ds_read_b128 v[200:203], v243
v_xor_b32 v242, 16, v242
ds_read_b128 v[204:207], v242 offset:128
ds_read_u16_d16 v180, v180
v_fma_mix_f32 v158, v138, v138, v158 op_sel:[0,0,0] op_sel_hi:[1,1,0]
v_exp_f16_sdwa v153, v154 dst_sel:WORD_1 dst_unused:UNUSED_PRESERVE src0_sel:WORD_1
v_lshrrev_b32 v181, 18, v181
v_exp_f16_sdwa v150, v151 dst_sel:WORD_1 dst_unused:UNUSED_PRESERVE src0_sel:WORD_1
v_fma_mix_f32 v158, v139, v139, v158 op_sel:[1,1,0] op_sel_hi:[1,1,0]
v_and_b32_e64 v183, s49, v183
v_mfma_f32_32x32x16_bf16 v[120:135], v[108:111], v[224:227], v[120:135]
ds_read_b128 v[220:223], v248 offset:47104
ds_read_u16_d16_hi v181, v181
v_exp_f16_sdwa v147, v148 dst_sel:WORD_1 dst_unused:UNUSED_PRESERVE src0_sel:WORD_1
v_pk_add_f16 v153, v153, 1.0 op_sel_hi:[1,0]
v_bfe_u32 v182, v183, 2, 14
v_pk_add_f16 v150, v150, 1.0 op_sel_hi:[1,0]
v_pk_add_f16 v147, v147, 1.0 op_sel_hi:[1,0]
v_rcp_f16_e64 v154, v153
v_lshrrev_b32 v183, 18, v183
v_fma_mix_f32 v158, v140, v140, v158 op_sel:[0,0,0] op_sel_hi:[1,1,0]
s_waitcnt lgkmcnt(6)
v_mfma_f32_32x32x16_bf16 v[120:135], v[112:115], v[228:231], v[120:135]
ds_read_b128 v[224:227], v248 offset:50176
ds_read_u16_d16 v182, v182
ds_read_u16_d16_hi v183, v183
v_rcp_f16 v151, v150
v_and_b32 v185, s49, v185
v_rcp_f16_e64 v148, v147
v_fma_mix_f32 v158, v141, v141, v158 op_sel:[1,1,0] op_sel_hi:[1,1,0]
v_bfe_u32 v184, v185, 2, 14
v_rcp_f16_sdwa v154, v153 dst_sel:WORD_1 dst_unused:UNUSED_PRESERVE src0_sel:WORD_1
v_mfma_f32_32x32x16_bf16 v[120:135], v[116:119], v[232:235], v[120:135]
ds_read_b128 v[228:231], v248 offset:48128
ds_read_u16_d16 v184, v184
v_rcp_f16_sdwa v151, v150 dst_sel:WORD_1 dst_unused:UNUSED_PRESERVE src0_sel:WORD_1
v_lshrrev_b32_e64 v185, 18, v185
v_rcp_f16_sdwa v148, v147 dst_sel:WORD_1 dst_unused:UNUSED_PRESERVE src0_sel:WORD_1
v_and_b32_e64 v187, s49, v187
v_fma_mix_f32 v158, v142, v142, v158 op_sel:[0,0,0] op_sel_hi:[1,1,0]
v_pk_mul_f16 v155, v155, v154
v_pk_mul_f16 v152, v152, v151
v_smfmac_f32_16x16x32_bf16 v[44:47], v[238:239], v[192:195], v246
ds_read_b128 v[232:235], v248 offset:51200
ds_read_u16_d16_hi v185, v185
v_bfe_u32 v186, v187, 2, 14
v_pk_mul_f16 v149, v149, v148
v_fma_mix_f32 v159, v155, v155, v159 op_sel:[0,0,0] op_sel_hi:[1,1,0]
v_fma_mix_f32 v158, v143, v143, v158 op_sel:[1,1,0] op_sel_hi:[1,1,0]
v_lshrrev_b32_e64 v187, 18, v187
v_smfmac_f32_16x16x32_bf16 v[28:31], v[236:237], v[196:199], v246
v_fma_mix_f32 v159, v155, v155, v159 op_sel:[1,1,0] op_sel_hi:[1,1,0]
v_fma_mix_f32 v159, v152, v152, v159 op_sel:[0,0,0] op_sel_hi:[1,1,0]
v_fma_mix_f32 v159, v152, v152, v159 op_sel:[1,1,0] op_sel_hi:[1,1,0]
v_fma_mix_f32 v159, v149, v149, v159 op_sel:[0,0,0] op_sel_hi:[1,1,0]
v_fma_mix_f32 v159, v149, v149, v159 op_sel:[1,1,0] op_sel_hi:[1,1,0]
s_setprio 1
s_waitcnt lgkmcnt(4)
v_smfmac_f32_16x16x32_bf16 v[12:15], v[218:219], v[200:203], v246
s_add_u32 s46, s80, 20971520
buffer_store_dwordx4 v[88:91], v241, s[32:35], s46 offen sc1
ds_read_b128 v[236:239], v248 offset:49152
ds_read_u16_d16 v186, v186
ds_read_u16_d16_hi v187, v187
v_cvt_pkrtz_f16_f32 v137, v120, v121
v_cvt_pkrtz_f16_f32 v139, v122, v123
v_cvt_pkrtz_f16_f32 v141, v124, v125
v_cvt_pkrtz_f16_f32 v143, v126, v127
v_cvt_pk_f16_f32 v155, v128, v129
v_smfmac_f32_16x16x32_bf16 v[44:47], v[216:217], v[204:207], v246
v_cvt_pk_f16_f32 v152, v130, v131
v_cvt_pk_f16_f32 v149, v132, v133
v_cvt_pk_f16_f32 v146, v134, v135
v_pk_fma_f16 v154, v155, v155, s48
v_and_b32_e64 v137, s49, v137
v_mfma_f32_32x32x16_bf16 v[120:135], v[96:99], v[220:223], 0
ds_read_b128 v[216:219], v248 offset:52224
v_fma_mix_f32 v159, v178, v178, v159 op_sel:[0,0,0] op_sel_hi:[1,1,0]
v_pk_fma_f16 v151, v152, v152, s48
v_pk_fma_f16 v148, v149, v149, s48
v_pk_fma_f16 v145, v146, v146, s48
v_pk_mul_f16 v154, v155, v154
v_bfe_u32 v136, v137, 2, 14
v_pk_mul_f16 v151, v152, v151
v_fma_mix_f32 v159, v179, v179, v159 op_sel:[1,1,0] op_sel_hi:[1,1,0]
v_pk_mul_f16 v148, v149, v148
v_pk_mul_f16 v145, v146, v145
v_mfma_f32_32x32x16_bf16 v[120:135], v[100:103], v[224:227], v[120:135]
ds_read_b128 v[220:223], v245 offset:3456
ds_read_b128 v[208:211], v242 offset:64
ds_read_b128 v[212:215], v242
ds_read_u16_d16 v136, v136
v_exp_f16 v153, v154
v_lshrrev_b32 v137, 18, v137
v_exp_f16_e64 v150, v151
v_fma_mix_f32 v159, v180, v180, v159 op_sel:[0,0,0] op_sel_hi:[1,1,0]
v_exp_f16 v147, v148
v_and_b32 v139, s49, v139
v_exp_f16_e64 v144, v145
s_waitcnt lgkmcnt(5)
v_mfma_f32_32x32x16_bf16 v[120:135], v[104:107], v[228:231], v[120:135]
ds_read_b128 v[224:227], v245 offset:3072
v_xor_b32 v244, 32, v244
ds_read_b128 v[192:195], v244 offset:128
ds_read_b128 v[196:199], v244 offset:64
ds_read_u16_d16_hi v137, v137
v_exp_f16_sdwa v153, v154 dst_sel:WORD_1 dst_unused:UNUSED_PRESERVE src0_sel:WORD_1
v_fma_mix_f32 v159, v181, v181, v159 op_sel:[1,1,0] op_sel_hi:[1,1,0]
v_bfe_u32 v138, v139, 2, 14
v_exp_f16_sdwa v150, v151 dst_sel:WORD_1 dst_unused:UNUSED_PRESERVE src0_sel:WORD_1
v_exp_f16_sdwa v147, v148 dst_sel:WORD_1 dst_unused:UNUSED_PRESERVE src0_sel:WORD_1
v_exp_f16_sdwa v144, v145 dst_sel:WORD_1 dst_unused:UNUSED_PRESERVE src0_sel:WORD_1
v_lshrrev_b32_e64 v139, 18, v139
v_fma_mix_f32 v159, v182, v182, v159 op_sel:[0,0,0] op_sel_hi:[1,1,0]
v_mfma_f32_32x32x16_bf16 v[120:135], v[108:111], v[232:235], v[120:135]
ds_read_b128 v[228:231], v248 offset:53248
ds_read_u16_d16 v138, v138
ds_read_u16_d16_hi v139, v139
v_pk_add_f16 v153, v153, 1.0 op_sel_hi:[1,0]
v_pk_add_f16 v150, v150, 1.0 op_sel_hi:[1,0]
v_pk_add_f16 v147, v147, 1.0 op_sel_hi:[1,0]
v_and_b32_e64 v141, s49, v141
v_pk_add_f16 v144, v144, 1.0 op_sel_hi:[1,0]
v_rcp_f16_e64 v154, v153
v_fma_mix_f32 v159, v183, v183, v159 op_sel:[1,1,0] op_sel_hi:[1,1,0]
v_rcp_f16_e64 v151, v150
v_mfma_f32_32x32x16_bf16 v[120:135], v[112:115], v[236:239], v[120:135]
ds_read_b128 v[232:235], v248 offset:56320
v_bfe_u32 v140, v141, 2, 14
v_rcp_f16_e64 v148, v147
v_fma_mix_f32 v159, v184, v184, v159 op_sel:[0,0,0] op_sel_hi:[1,1,0]
v_rcp_f16 v145, v144
v_lshrrev_b32 v141, 18, v141
v_rcp_f16_sdwa v154, v153 dst_sel:WORD_1 dst_unused:UNUSED_PRESERVE src0_sel:WORD_1
s_setprio 0
v_rcp_f16_sdwa v151, v150 dst_sel:WORD_1 dst_unused:UNUSED_PRESERVE src0_sel:WORD_1
s_waitcnt lgkmcnt(4)
v_mfma_f32_32x32x16_bf16 v[120:135], v[116:119], v[216:219], v[120:135]
ds_read_b128 v[236:239], v248 offset:54272
ds_read_u16_d16 v140, v140
ds_read_u16_d16_hi v141, v141
v_fma_mix_f32 v159, v185, v185, v159 op_sel:[1,1,0] op_sel_hi:[1,1,0]
v_and_b32_e64 v143, s49, v143
v_rcp_f16_sdwa v148, v147 dst_sel:WORD_1 dst_unused:UNUSED_PRESERVE src0_sel:WORD_1
v_rcp_f16_sdwa v145, v144 dst_sel:WORD_1 dst_unused:UNUSED_PRESERVE src0_sel:WORD_1
v_pk_mul_f16 v155, v155, v154
v_bfe_u32 v142, v143, 2, 14
v_fma_mix_f32 v159, v186, v186, v159 op_sel:[0,0,0] op_sel_hi:[1,1,0]
v_pk_mul_f16 v152, v152, v151
v_pk_mul_f16 v149, v149, v148
v_smfmac_f32_16x16x32_bf16 v[28:31], v[222:223], v[208:211], v246
ds_read_b128 v[216:219], v248 offset:57344
ds_read_u16_d16 v142, v142
v_pk_mul_f16 v146, v146, v145
v_fma_mix_f32 v160, v155, v155, v160 op_sel:[0,0,0] op_sel_hi:[1,1,0]
v_lshrrev_b32 v143, 18, v143
v_fma_mix_f32 v160, v155, v155, v160 op_sel:[1,1,0] op_sel_hi:[1,1,0]
v_fma_mix_f32 v160, v152, v152, v160 op_sel:[0,0,0] op_sel_hi:[1,1,0]
v_smfmac_f32_16x16x32_bf16 v[12:15], v[220:221], v[212:215], v246
v_fma_mix_f32 v159, v187, v187, v159 op_sel:[1,1,0] op_sel_hi:[1,1,0]
v_fma_mix_f32 v160, v152, v152, v160 op_sel:[1,1,0] op_sel_hi:[1,1,0]
v_fma_mix_f32 v160, v149, v149, v160 op_sel:[0,0,0] op_sel_hi:[1,1,0]
v_fma_mix_f32 v160, v149, v149, v160 op_sel:[1,1,0] op_sel_hi:[1,1,0]
v_fma_mix_f32 v160, v146, v146, v160 op_sel:[0,0,0] op_sel_hi:[1,1,0]
v_fma_mix_f32 v160, v146, v146, v160 op_sel:[1,1,0] op_sel_hi:[1,1,0]
s_setprio 2
v_smfmac_f32_16x16x32_bf16 v[36:39], v[226:227], v[192:195], v246
s_add_u32 s46, s80, 23068672
buffer_store_dwordx4 v[92:95], v241, s[32:35], s46 offen sc1
ds_read_b128 v[220:223], v248 offset:55296
ds_read_u16_d16_hi v143, v143
v_cvt_pkrtz_f16_f32 v179, v120, v121
v_cvt_pkrtz_f16_f32 v181, v122, v123
v_cvt_pkrtz_f16_f32 v183, v124, v125
v_cvt_pkrtz_f16_f32 v185, v126, v127
v_smfmac_f32_16x16x32_bf16 v[20:23], v[224:225], v[196:199], v246
v_cvt_pkrtz_f16_f32 v187, v128, v129
v_cvt_pk_f16_f32 v155, v130, v131
v_cvt_pk_f16_f32 v152, v132, v133
v_cvt_pk_f16_f32 v149, v134, v135
s_waitcnt lgkmcnt(2)
v_mfma_f32_32x32x16_bf16 v[120:135], v[96:99], v[228:231], 0
ds_read_b128 v[224:227], v245 offset:2688
ds_read_b128 v[200:203], v244
v_xor_b32 v243, 32, v243
ds_read_b128 v[204:207], v243 offset:128
v_pk_fma_f16 v154, v155, v155, s48
v_and_b32_e64 v179, s49, v179
v_fma_mix_f32 v160, v136, v136, v160 op_sel:[0,0,0] op_sel_hi:[1,1,0]
v_pk_fma_f16 v151, v152, v152, s48
v_pk_fma_f16 v148, v149, v149, s48
v_bfe_u32 v178, v179, 2, 14
v_pk_mul_f16 v154, v155, v154
v_pk_mul_f16 v151, v152, v151
v_mfma_f32_32x32x16_bf16 v[120:135], v[100:103], v[232:235], v[120:135]
ds_read_b128 v[228:231], v248 offset:58368
ds_read_u16_d16 v178, v178
v_pk_mul_f16 v148, v149, v148
v_lshrrev_b32_e64 v179, 18, v179
v_fma_mix_f32 v160, v137, v137, v160 op_sel:[1,1,0] op_sel_hi:[1,1,0]
v_exp_f16 v153, v154
v_and_b32 v181, s49, v181
v_exp_f16_e64 v150, v151
v_mfma_f32_32x32x16_bf16 v[120:135], v[104:107], v[236:239], v[120:135]
ds_read_b128 v[232:235], v245 offset:2304
ds_read_b128 v[208:211], v243 offset:64
ds_read_b128 v[212:215], v243
ds_read_u16_d16_hi v179, v179
v_exp_f16_e64 v147, v148
v_bfe_u32 v180, v181, 2, 14
v_fma_mix_f32 v160, v138, v138, v160 op_sel:[0,0,0] op_sel_hi:[1,1,0]
v_exp_f16_sdwa v153, v154 dst_sel:WORD_1 dst_unused:UNUSED_PRESERVE src0_sel:WORD_1
v_lshrrev_b32 v181, 18, v181
v_mfma_f32_32x32x16_bf16 v[120:135], v[108:111], v[216:219], v[120:135]
ds_read_b128 v[236:239], v245 offset:1920
v_xor_b32 v242, 32, v242
ds_read_b128 v[192:195], v242 offset:128
ds_read_b128 v[196:199], v242 offset:64
ds_read_u16_d16 v180, v180
ds_read_u16_d16_hi v181, v181
v_exp_f16_sdwa v150, v151 dst_sel:WORD_1 dst_unused:UNUSED_PRESERVE src0_sel:WORD_1
v_fma_mix_f32 v160, v139, v139, v160 op_sel:[1,1,0] op_sel_hi:[1,1,0]
v_and_b32 v183, s49, v183
v_exp_f16_sdwa v147, v148 dst_sel:WORD_1 dst_unused:UNUSED_PRESERVE src0_sel:WORD_1
v_pk_add_f16 v153, v153, 1.0 op_sel_hi:[1,0]
v_bfe_u32 v182, v183, 2, 14
v_pk_add_f16 v150, v150, 1.0 op_sel_hi:[1,0]
s_waitcnt lgkmcnt(9)
v_mfma_f32_32x32x16_bf16 v[120:135], v[112:115], v[220:223], v[120:135]
ds_read_b128 v[216:219], v248 offset:59392
ds_read_u16_d16 v182, v182
v_pk_add_f16 v147, v147, 1.0 op_sel_hi:[1,0]
v_rcp_f16 v154, v153
v_lshrrev_b32 v183, 18, v183
v_fma_mix_f32 v160, v140, v140, v160 op_sel:[0,0,0] op_sel_hi:[1,1,0]
v_rcp_f16 v151, v150
v_and_b32 v185, s49, v185
v_smfmac_f32_16x16x32_bf16 v[4:7], v[226:227], v[200:203], v246
ds_read_b128 v[220:223], v248 offset:62464
ds_read_u16_d16_hi v183, v183
v_rcp_f16_e64 v148, v147
v_fma_mix_f32 v160, v141, v141, v160 op_sel:[1,1,0] op_sel_hi:[1,1,0]
v_bfe_u32 v184, v185, 2, 14
v_smfmac_f32_16x16x32_bf16 v[36:39], v[224:225], v[204:207], v246
v_rcp_f16_sdwa v154, v153 dst_sel:WORD_1 dst_unused:UNUSED_PRESERVE src0_sel:WORD_1
v_rcp_f16_sdwa v151, v150 dst_sel:WORD_1 dst_unused:UNUSED_PRESERVE src0_sel:WORD_1
v_mfma_f32_32x32x16_bf16 v[120:135], v[116:119], v[228:231], v[120:135]
ds_read_b128 v[224:227], v248 offset:60416
ds_read_u16_d16 v184, v184
v_lshrrev_b32_e64 v185, 18, v185
v_rcp_f16_sdwa v148, v147 dst_sel:WORD_1 dst_unused:UNUSED_PRESERVE src0_sel:WORD_1
v_and_b32 v187, s49, v187
v_fma_mix_f32 v160, v142, v142, v160 op_sel:[0,0,0] op_sel_hi:[1,1,0]
v_pk_mul_f16 v155, v155, v154
v_pk_mul_f16 v152, v152, v151
v_bfe_u32 v186, v187, 2, 14
s_waitcnt lgkmcnt(4)
v_smfmac_f32_16x16x32_bf16 v[20:23], v[234:235], v[208:211], v246
ds_read_b128 v[228:231], v248 offset:63488
ds_read_u16_d16_hi v185, v185
ds_read_u16_d16 v186, v186
v_pk_mul_f16 v149, v149, v148
v_fma_mix_f32 v161, v155, v155, v161 op_sel:[0,0,0] op_sel_hi:[1,1,0]
v_fma_mix_f32 v160, v143, v143, v160 op_sel:[1,1,0] op_sel_hi:[1,1,0]
v_lshrrev_b32 v187, 18, v187
v_smfmac_f32_16x16x32_bf16 v[4:7], v[232:233], v[212:215], v246
v_fma_mix_f32 v161, v155, v155, v161 op_sel:[1,1,0] op_sel_hi:[1,1,0]
v_fma_mix_f32 v161, v152, v152, v161 op_sel:[0,0,0] op_sel_hi:[1,1,0]
v_fma_mix_f32 v161, v152, v152, v161 op_sel:[1,1,0] op_sel_hi:[1,1,0]
v_fma_mix_f32 v161, v149, v149, v161 op_sel:[0,0,0] op_sel_hi:[1,1,0]
v_fma_mix_f32 v161, v149, v149, v161 op_sel:[1,1,0] op_sel_hi:[1,1,0]
s_setprio 1
v_smfmac_f32_16x16x32_bf16 v[36:39], v[238:239], v[192:195], v246
ds_read_b128 v[232:235], v248 offset:61440
ds_read_u16_d16_hi v187, v187
v_cvt_pkrtz_f16_f32 v137, v120, v121
v_cvt_pkrtz_f16_f32 v139, v122, v123
v_cvt_pkrtz_f16_f32 v141, v124, v125
v_cvt_pkrtz_f16_f32 v143, v126, v127
v_cvt_pk_f16_f32 v155, v128, v129
v_smfmac_f32_16x16x32_bf16 v[20:23], v[236:237], v[196:199], v246
v_cvt_pk_f16_f32 v152, v130, v131
v_cvt_pk_f16_f32 v149, v132, v133
v_cvt_pk_f16_f32 v146, v134, v135
v_pk_fma_f16 v154, v155, v155, s48
v_and_b32_e64 v137, s49, v137
v_mfma_f32_32x32x16_bf16 v[120:135], v[96:99], v[216:219], 0
ds_read_b128 v[236:239], v248 offset:64512
v_fma_mix_f32 v161, v178, v178, v161 op_sel:[0,0,0] op_sel_hi:[1,1,0]
v_pk_fma_f16 v151, v152, v152, s48
v_pk_fma_f16 v148, v149, v149, s48
v_pk_fma_f16 v145, v146, v146, s48
v_pk_mul_f16 v154, v155, v154
v_bfe_u32 v136, v137, 2, 14
v_pk_mul_f16 v151, v152, v151
v_fma_mix_f32 v161, v179, v179, v161 op_sel:[1,1,0] op_sel_hi:[1,1,0]
v_pk_mul_f16 v148, v149, v148
v_pk_mul_f16 v145, v146, v145
s_waitcnt lgkmcnt(2)
v_mfma_f32_32x32x16_bf16 v[120:135], v[100:103], v[220:223], v[120:135]
ds_read_b128 v[216:219], v245 offset:1536
ds_read_b128 v[200:203], v242
v_xor_b32 v244, 16, v244
ds_read_b128 v[204:207], v244 offset:128
ds_read_u16_d16 v136, v136
v_exp_f16 v153, v154
v_lshrrev_b32 v137, 18, v137
v_exp_f16_e64 v150, v151
v_fma_mix_f32 v161, v180, v180, v161 op_sel:[0,0,0] op_sel_hi:[1,1,0]
v_exp_f16 v147, v148
v_and_b32 v139, s49, v139
v_exp_f16_e64 v144, v145
v_mfma_f32_32x32x16_bf16 v[120:135], v[104:107], v[224:227], v[120:135]
ds_read_b128 v[220:223], v245 offset:1152
ds_read_b128 v[208:211], v244 offset:64
ds_read_b128 v[212:215], v244
ds_read_u16_d16_hi v137, v137
v_exp_f16_sdwa v153, v154 dst_sel:WORD_1 dst_unused:UNUSED_PRESERVE src0_sel:WORD_1
v_fma_mix_f32 v161, v181, v181, v161 op_sel:[1,1,0] op_sel_hi:[1,1,0]
v_bfe_u32 v138, v139, 2, 14
v_exp_f16_sdwa v150, v151 dst_sel:WORD_1 dst_unused:UNUSED_PRESERVE src0_sel:WORD_1
v_exp_f16_sdwa v147, v148 dst_sel:WORD_1 dst_unused:UNUSED_PRESERVE src0_sel:WORD_1
v_exp_f16_sdwa v144, v145 dst_sel:WORD_1 dst_unused:UNUSED_PRESERVE src0_sel:WORD_1
v_lshrrev_b32_e64 v139, 18, v139
v_fma_mix_f32 v161, v182, v182, v161 op_sel:[0,0,0] op_sel_hi:[1,1,0]
v_mfma_f32_32x32x16_bf16 v[120:135], v[108:111], v[228:231], v[120:135]
ds_read_b128 v[224:227], v249
ds_read_u16_d16 v138, v138
ds_read_u16_d16_hi v139, v139
v_pk_add_f16 v153, v153, 1.0 op_sel_hi:[1,0]
v_pk_add_f16 v150, v150, 1.0 op_sel_hi:[1,0]
v_pk_add_f16 v147, v147, 1.0 op_sel_hi:[1,0]
v_and_b32_e64 v141, s49, v141
v_pk_add_f16 v144, v144, 1.0 op_sel_hi:[1,0]
v_rcp_f16_e64 v154, v153
v_fma_mix_f32 v161, v183, v183, v161 op_sel:[1,1,0] op_sel_hi:[1,1,0]
v_rcp_f16_e64 v151, v150
v_mfma_f32_32x32x16_bf16 v[120:135], v[112:115], v[232:235], v[120:135]
ds_read_b128 v[228:231], v249 offset:3072
v_bfe_u32 v140, v141, 2, 14
v_rcp_f16_e64 v148, v147
v_fma_mix_f32 v161, v184, v184, v161 op_sel:[0,0,0] op_sel_hi:[1,1,0]
v_rcp_f16 v145, v144
v_lshrrev_b32 v141, 18, v141
v_rcp_f16_sdwa v154, v153 dst_sel:WORD_1 dst_unused:UNUSED_PRESERVE src0_sel:WORD_1
s_setprio 0
v_rcp_f16_sdwa v151, v150 dst_sel:WORD_1 dst_unused:UNUSED_PRESERVE src0_sel:WORD_1
s_waitcnt lgkmcnt(4)
v_mfma_f32_32x32x16_bf16 v[120:135], v[116:119], v[236:239], v[120:135]
ds_read_b128 v[232:235], v249 offset:1024
ds_read_u16_d16 v140, v140
ds_read_u16_d16_hi v141, v141
v_fma_mix_f32 v161, v185, v185, v161 op_sel:[1,1,0] op_sel_hi:[1,1,0]
v_and_b32_e64 v143, s49, v143
v_rcp_f16_sdwa v148, v147 dst_sel:WORD_1 dst_unused:UNUSED_PRESERVE src0_sel:WORD_1
v_rcp_f16_sdwa v145, v144 dst_sel:WORD_1 dst_unused:UNUSED_PRESERVE src0_sel:WORD_1
v_pk_mul_f16 v155, v155, v154
v_bfe_u32 v142, v143, 2, 14
v_fma_mix_f32 v161, v186, v186, v161 op_sel:[0,0,0] op_sel_hi:[1,1,0]
v_pk_mul_f16 v152, v152, v151
v_pk_mul_f16 v149, v149, v148
v_smfmac_f32_16x16x32_bf16 v[4:7], v[218:219], v[200:203], v246
ds_read_b128 v[236:239], v249 offset:4096
ds_read_u16_d16 v142, v142
v_pk_mul_f16 v146, v146, v145
v_fma_mix_f32 v162, v155, v155, v162 op_sel:[0,0,0] op_sel_hi:[1,1,0]
v_lshrrev_b32 v143, 18, v143
v_fma_mix_f32 v162, v155, v155, v162 op_sel:[1,1,0] op_sel_hi:[1,1,0]
v_fma_mix_f32 v162, v152, v152, v162 op_sel:[0,0,0] op_sel_hi:[1,1,0]
v_smfmac_f32_16x16x32_bf16 v[32:35], v[216:217], v[204:207], v246
v_fma_mix_f32 v161, v187, v187, v161 op_sel:[1,1,0] op_sel_hi:[1,1,0]
v_fma_mix_f32 v162, v152, v152, v162 op_sel:[1,1,0] op_sel_hi:[1,1,0]
v_fma_mix_f32 v162, v149, v149, v162 op_sel:[0,0,0] op_sel_hi:[1,1,0]
v_fma_mix_f32 v162, v149, v149, v162 op_sel:[1,1,0] op_sel_hi:[1,1,0]
v_fma_mix_f32 v162, v146, v146, v162 op_sel:[0,0,0] op_sel_hi:[1,1,0]
v_fma_mix_f32 v162, v146, v146, v162 op_sel:[1,1,0] op_sel_hi:[1,1,0]
s_setprio 2
v_smfmac_f32_16x16x32_bf16 v[16:19], v[222:223], v[208:211], v246
ds_read_b128 v[216:219], v249 offset:2048
ds_read_u16_d16_hi v143, v143
v_cvt_pkrtz_f16_f32 v179, v120, v121
v_cvt_pkrtz_f16_f32 v181, v122, v123
v_cvt_pkrtz_f16_f32 v183, v124, v125
v_cvt_pkrtz_f16_f32 v185, v126, v127
v_smfmac_f32_16x16x32_bf16 v[0:3], v[220:221], v[212:215], v246
v_cvt_pkrtz_f16_f32 v187, v128, v129
v_cvt_pk_f16_f32 v155, v130, v131
v_cvt_pk_f16_f32 v152, v132, v133
v_cvt_pk_f16_f32 v149, v134, v135
v_pk_fma_f16 v154, v155, v155, s48
s_waitcnt lgkmcnt(2)
v_mfma_f32_32x32x16_bf16 v[120:135], v[96:99], v[224:227], 0
ds_read_b128 v[220:223], v249 offset:5120
v_and_b32 v179, s49, v179
v_fma_mix_f32 v162, v136, v136, v162 op_sel:[0,0,0] op_sel_hi:[1,1,0]
v_pk_fma_f16 v151, v152, v152, s48
v_pk_fma_f16 v148, v149, v149, s48
v_bfe_u32 v178, v179, 2, 14
v_pk_mul_f16 v154, v155, v154
v_pk_mul_f16 v151, v152, v151
v_pk_mul_f16 v148, v149, v148
v_lshrrev_b32 v179, 18, v179
v_mfma_f32_32x32x16_bf16 v[120:135], v[100:103], v[228:231], v[120:135]
ds_read_b128 v[224:227], v245 offset:768
v_xor_b32 v243, 16, v243
ds_read_b128 v[192:195], v243 offset:128
ds_read_b128 v[196:199], v243 offset:64
ds_read_u16_d16 v178, v178
ds_read_u16_d16_hi v179, v179
v_fma_mix_f32 v162, v137, v137, v162 op_sel:[1,1,0] op_sel_hi:[1,1,0]
v_exp_f16 v153, v154
v_and_b32 v181, s49, v181
v_exp_f16 v150, v151
v_exp_f16 v147, v148
v_bfe_u32 v180, v181, 2, 14
v_mfma_f32_32x32x16_bf16 v[120:135], v[104:107], v[232:235], v[120:135]
ds_read_b128 v[228:231], v245 offset:384
ds_read_b128 v[200:203], v243
v_xor_b32 v242, 16, v242
ds_read_b128 v[204:207], v242 offset:128
ds_read_u16_d16 v180, v180
v_fma_mix_f32 v162, v138, v138, v162 op_sel:[0,0,0] op_sel_hi:[1,1,0]
v_exp_f16_sdwa v153, v154 dst_sel:WORD_1 dst_unused:UNUSED_PRESERVE src0_sel:WORD_1
v_lshrrev_b32 v181, 18, v181
v_exp_f16_sdwa v150, v151 dst_sel:WORD_1 dst_unused:UNUSED_PRESERVE src0_sel:WORD_1
v_fma_mix_f32 v162, v139, v139, v162 op_sel:[1,1,0] op_sel_hi:[1,1,0]
v_and_b32_e64 v183, s49, v183
v_mfma_f32_32x32x16_bf16 v[120:135], v[108:111], v[236:239], v[120:135]
ds_read_b128 v[232:235], v249 offset:6144
ds_read_u16_d16_hi v181, v181
v_exp_f16_sdwa v147, v148 dst_sel:WORD_1 dst_unused:UNUSED_PRESERVE src0_sel:WORD_1
v_pk_add_f16 v153, v153, 1.0 op_sel_hi:[1,0]
v_bfe_u32 v182, v183, 2, 14
v_pk_add_f16 v150, v150, 1.0 op_sel_hi:[1,0]
v_pk_add_f16 v147, v147, 1.0 op_sel_hi:[1,0]
v_rcp_f16_e64 v154, v153
v_lshrrev_b32 v183, 18, v183
v_fma_mix_f32 v162, v140, v140, v162 op_sel:[0,0,0] op_sel_hi:[1,1,0]
s_waitcnt lgkmcnt(6)
v_mfma_f32_32x32x16_bf16 v[120:135], v[112:115], v[216:219], v[120:135]
ds_read_b128 v[236:239], v249 offset:9216
ds_read_u16_d16 v182, v182
ds_read_u16_d16_hi v183, v183
v_rcp_f16 v151, v150
v_and_b32 v185, s49, v185
v_rcp_f16_e64 v148, v147
v_fma_mix_f32 v162, v141, v141, v162 op_sel:[1,1,0] op_sel_hi:[1,1,0]
v_bfe_u32 v184, v185, 2, 14
v_rcp_f16_sdwa v154, v153 dst_sel:WORD_1 dst_unused:UNUSED_PRESERVE src0_sel:WORD_1
v_mfma_f32_32x32x16_bf16 v[120:135], v[116:119], v[220:223], v[120:135]
ds_read_b128 v[216:219], v249 offset:7168
ds_read_u16_d16 v184, v184
v_rcp_f16_sdwa v151, v150 dst_sel:WORD_1 dst_unused:UNUSED_PRESERVE src0_sel:WORD_1
v_lshrrev_b32_e64 v185, 18, v185
v_rcp_f16_sdwa v148, v147 dst_sel:WORD_1 dst_unused:UNUSED_PRESERVE src0_sel:WORD_1
v_and_b32_e64 v187, s49, v187
v_fma_mix_f32 v162, v142, v142, v162 op_sel:[0,0,0] op_sel_hi:[1,1,0]
v_pk_mul_f16 v155, v155, v154
v_pk_mul_f16 v152, v152, v151
v_smfmac_f32_16x16x32_bf16 v[32:35], v[226:227], v[192:195], v246
ds_read_b128 v[220:223], v249 offset:10240
ds_read_u16_d16_hi v185, v185
v_bfe_u32 v186, v187, 2, 14
v_pk_mul_f16 v149, v149, v148
v_fma_mix_f32 v163, v155, v155, v163 op_sel:[0,0,0] op_sel_hi:[1,1,0]
v_fma_mix_f32 v162, v143, v143, v162 op_sel:[1,1,0] op_sel_hi:[1,1,0]
v_lshrrev_b32_e64 v187, 18, v187
v_smfmac_f32_16x16x32_bf16 v[16:19], v[224:225], v[196:199], v246
v_fma_mix_f32 v163, v155, v155, v163 op_sel:[1,1,0] op_sel_hi:[1,1,0]
v_fma_mix_f32 v163, v152, v152, v163 op_sel:[0,0,0] op_sel_hi:[1,1,0]
v_fma_mix_f32 v163, v152, v152, v163 op_sel:[1,1,0] op_sel_hi:[1,1,0]
v_fma_mix_f32 v163, v149, v149, v163 op_sel:[0,0,0] op_sel_hi:[1,1,0]
v_fma_mix_f32 v163, v149, v149, v163 op_sel:[1,1,0] op_sel_hi:[1,1,0]
s_setprio 1
s_waitcnt lgkmcnt(4)
v_smfmac_f32_16x16x32_bf16 v[0:3], v[230:231], v[200:203], v246
ds_read_b128 v[224:227], v249 offset:8192
ds_read_u16_d16 v186, v186
ds_read_u16_d16_hi v187, v187
v_cvt_pkrtz_f16_f32 v137, v120, v121
v_cvt_pkrtz_f16_f32 v139, v122, v123
v_cvt_pkrtz_f16_f32 v141, v124, v125
v_cvt_pkrtz_f16_f32 v143, v126, v127
v_smfmac_f32_16x16x32_bf16 v[32:35], v[228:229], v[204:207], v246
v_cvt_pk_f16_f32 v155, v128, v129
v_cvt_pk_f16_f32 v152, v130, v131
v_cvt_pk_f16_f32 v149, v132, v133
v_cvt_pk_f16_f32 v146, v134, v135
v_pk_fma_f16 v154, v155, v155, s48
v_mfma_f32_32x32x16_bf16 v[120:135], v[96:99], v[232:235], 0
ds_read_b128 v[228:231], v249 offset:11264
v_and_b32_e64 v137, s49, v137
v_fma_mix_f32 v163, v178, v178, v163 op_sel:[0,0,0] op_sel_hi:[1,1,0]
v_pk_fma_f16 v151, v152, v152, s48
v_pk_fma_f16 v148, v149, v149, s48
v_pk_fma_f16 v145, v146, v146, s48
v_pk_mul_f16 v154, v155, v154
v_bfe_u32 v136, v137, 2, 14
v_pk_mul_f16 v151, v152, v151
v_fma_mix_f32 v163, v179, v179, v163 op_sel:[1,1,0] op_sel_hi:[1,1,0]
v_pk_mul_f16 v148, v149, v148
v_mfma_f32_32x32x16_bf16 v[120:135], v[100:103], v[236:239], v[120:135]
ds_read_b128 v[232:235], v245
ds_read_b128 v[208:211], v242 offset:64
ds_read_b128 v[212:215], v242
ds_read_u16_d16 v136, v136
v_pk_mul_f16 v145, v146, v145
v_exp_f16 v153, v154
v_lshrrev_b32 v137, 18, v137
v_exp_f16_e64 v150, v151
v_fma_mix_f32 v163, v180, v180, v163 op_sel:[0,0,0] op_sel_hi:[1,1,0]
v_exp_f16_e64 v147, v148
v_and_b32 v139, s49, v139
s_waitcnt lgkmcnt(5)
v_mfma_f32_32x32x16_bf16 v[120:135], v[104:107], v[216:219], v[120:135]
ds_read_b128 v[236:239], v249 offset:12288
ds_read_u16_d16_hi v137, v137
v_exp_f16_e64 v144, v145
v_exp_f16_sdwa v153, v154 dst_sel:WORD_1 dst_unused:UNUSED_PRESERVE src0_sel:WORD_1
v_fma_mix_f32 v163, v181, v181, v163 op_sel:[1,1,0] op_sel_hi:[1,1,0]
v_bfe_u32 v138, v139, 2, 14
v_exp_f16_sdwa v150, v151 dst_sel:WORD_1 dst_unused:UNUSED_PRESERVE src0_sel:WORD_1
v_exp_f16_sdwa v147, v148 dst_sel:WORD_1 dst_unused:UNUSED_PRESERVE src0_sel:WORD_1
v_mfma_f32_32x32x16_bf16 v[120:135], v[108:111], v[220:223], v[120:135]
ds_read_b128 v[216:219], v249 offset:15360
ds_read_u16_d16 v138, v138
v_exp_f16_sdwa v144, v145 dst_sel:WORD_1 dst_unused:UNUSED_PRESERVE src0_sel:WORD_1
v_lshrrev_b32_e64 v139, 18, v139
v_fma_mix_f32 v163, v182, v182, v163 op_sel:[0,0,0] op_sel_hi:[1,1,0]
v_pk_add_f16 v153, v153, 1.0 op_sel_hi:[1,0]
v_pk_add_f16 v150, v150, 1.0 op_sel_hi:[1,0]
v_pk_add_f16 v147, v147, 1.0 op_sel_hi:[1,0]
v_and_b32_e64 v141, s49, v141
v_pk_add_f16 v144, v144, 1.0 op_sel_hi:[1,0]
v_mfma_f32_32x32x16_bf16 v[120:135], v[112:115], v[224:227], v[120:135]
ds_read_b128 v[220:223], v249 offset:13312
ds_read_u16_d16_hi v139, v139
v_rcp_f16_e64 v154, v153
v_fma_mix_f32 v163, v183, v183, v163 op_sel:[1,1,0] op_sel_hi:[1,1,0]
v_rcp_f16_e64 v151, v150
v_bfe_u32 v140, v141, 2, 14
v_rcp_f16 v148, v147
v_fma_mix_f32 v163, v184, v184, v163 op_sel:[0,0,0] op_sel_hi:[1,1,0]
s_waitcnt lgkmcnt(4)
v_mfma_f32_32x32x16_bf16 v[120:135], v[116:119], v[228:231], v[120:135]
ds_read_b128 v[224:227], v249 offset:16384
ds_read_u16_d16 v140, v140
v_rcp_f16_e64 v145, v144
v_lshrrev_b32 v141, 18, v141
v_rcp_f16_sdwa v154, v153 dst_sel:WORD_1 dst_unused:UNUSED_PRESERVE src0_sel:WORD_1
s_setprio 0
v_rcp_f16_sdwa v151, v150 dst_sel:WORD_1 dst_unused:UNUSED_PRESERVE src0_sel:WORD_1
v_fma_mix_f32 v163, v185, v185, v163 op_sel:[1,1,0] op_sel_hi:[1,1,0]
v_and_b32_e64 v143, s49, v143
v_rcp_f16_sdwa v148, v147 dst_sel:WORD_1 dst_unused:UNUSED_PRESERVE src0_sel:WORD_1
v_smfmac_f32_16x16x32_bf16 v[16:19], v[234:235], v[208:211], v246
ds_read_b128 v[228:231], v249 offset:14336
ds_read_u16_d16_hi v141, v141
v_rcp_f16_sdwa v145, v144 dst_sel:WORD_1 dst_unused:UNUSED_PRESERVE src0_sel:WORD_1
v_pk_mul_f16 v155, v155, v154
v_bfe_u32 v142, v143, 2, 14
v_fma_mix_f32 v163, v186, v186, v163 op_sel:[0,0,0] op_sel_hi:[1,1,0]
v_smfmac_f32_16x16x32_bf16 v[0:3], v[232:233], v[212:215], v246
s_mov_b64 exec, 1
ds_add_u32 v253, v254 offset:16
s_mov_b64 exec, -1
v_pk_mul_f16 v152, v152, v151
v_pk_mul_f16 v149, v149, v148
v_pk_mul_f16 v146, v146, v145
v_fma_mix_f32 v164, v155, v155, v164 op_sel:[0,0,0] op_sel_hi:[1,1,0]
v_lshrrev_b32 v143, 18, v143
v_fma_mix_f32 v164, v155, v155, v164 op_sel:[1,1,0] op_sel_hi:[1,1,0]
v_fma_mix_f32 v164, v152, v152, v164 op_sel:[0,0,0] op_sel_hi:[1,1,0]
v_fma_mix_f32 v163, v187, v187, v163 op_sel:[1,1,0] op_sel_hi:[1,1,0]
v_fma_mix_f32 v164, v152, v152, v164 op_sel:[1,1,0] op_sel_hi:[1,1,0]
v_fma_mix_f32 v164, v149, v149, v164 op_sel:[0,0,0] op_sel_hi:[1,1,0]
v_fma_mix_f32 v164, v149, v149, v164 op_sel:[1,1,0] op_sel_hi:[1,1,0]
v_fma_mix_f32 v164, v146, v146, v164 op_sel:[0,0,0] op_sel_hi:[1,1,0]
v_fma_mix_f32 v164, v146, v146, v164 op_sel:[1,1,0] op_sel_hi:[1,1,0]
s_setprio 3
v_pk_add_f32 v[168:169], v[0:1], v[2:3]
v_pk_mul_f32 v[170:171], v[0:1], v[0:1]
v_pk_fma_f32 v[170:171], v[2:3], v[2:3], v[170:171]
v_pk_add_f32 v[168:169], v[168:169], v[4:5]
v_pk_fma_f32 v[170:171], v[4:5], v[4:5], v[170:171]
v_pk_add_f32 v[168:169], v[168:169], v[6:7]
v_pk_fma_f32 v[170:171], v[6:7], v[6:7], v[170:171]
v_pk_add_f32 v[168:169], v[168:169], v[8:9]
v_pk_fma_f32 v[170:171], v[8:9], v[8:9], v[170:171]
v_pk_add_f32 v[168:169], v[168:169], v[10:11]
v_pk_fma_f32 v[170:171], v[10:11], v[10:11], v[170:171]
v_pk_add_f32 v[168:169], v[168:169], v[12:13]
v_pk_fma_f32 v[170:171], v[12:13], v[12:13], v[170:171]
v_pk_add_f32 v[168:169], v[168:169], v[14:15]
v_pk_fma_f32 v[170:171], v[14:15], v[14:15], v[170:171]
v_pk_add_f32 v[168:169], v[168:169], v[16:17]
v_pk_fma_f32 v[170:171], v[16:17], v[16:17], v[170:171]
v_pk_add_f32 v[168:169], v[168:169], v[18:19]
v_pk_fma_f32 v[170:171], v[18:19], v[18:19], v[170:171]
v_pk_add_f32 v[168:169], v[168:169], v[20:21]
v_pk_fma_f32 v[170:171], v[20:21], v[20:21], v[170:171]
v_pk_add_f32 v[168:169], v[168:169], v[22:23]
v_pk_fma_f32 v[170:171], v[22:23], v[22:23], v[170:171]
v_pk_add_f32 v[168:169], v[168:169], v[24:25]
v_pk_fma_f32 v[170:171], v[24:25], v[24:25], v[170:171]
v_pk_add_f32 v[168:169], v[168:169], v[26:27]
v_pk_fma_f32 v[170:171], v[26:27], v[26:27], v[170:171]
v_pk_add_f32 v[168:169], v[168:169], v[28:29]
v_pk_fma_f32 v[170:171], v[28:29], v[28:29], v[170:171]
v_pk_add_f32 v[168:169], v[168:169], v[30:31]
v_pk_fma_f32 v[170:171], v[30:31], v[30:31], v[170:171]
v_pk_add_f32 v[168:169], v[168:169], v[32:33]
v_pk_fma_f32 v[170:171], v[32:33], v[32:33], v[170:171]
v_pk_add_f32 v[168:169], v[168:169], v[34:35]
v_pk_fma_f32 v[170:171], v[34:35], v[34:35], v[170:171]
v_pk_add_f32 v[168:169], v[168:169], v[36:37]
v_pk_fma_f32 v[170:171], v[36:37], v[36:37], v[170:171]
v_pk_add_f32 v[168:169], v[168:169], v[38:39]
v_pk_fma_f32 v[170:171], v[38:39], v[38:39], v[170:171]
v_pk_add_f32 v[168:169], v[168:169], v[40:41]
v_pk_fma_f32 v[170:171], v[40:41], v[40:41], v[170:171]
v_pk_add_f32 v[168:169], v[168:169], v[42:43]
v_pk_fma_f32 v[170:171], v[42:43], v[42:43], v[170:171]
v_pk_add_f32 v[168:169], v[168:169], v[44:45]
v_pk_fma_f32 v[170:171], v[44:45], v[44:45], v[170:171]
v_pk_add_f32 v[168:169], v[168:169], v[46:47]
v_pk_fma_f32 v[170:171], v[46:47], v[46:47], v[170:171]
s_setprio 0
v_lshrrev_b32 v252, 2, v251
v_mul_u32_u24 v252, 192, v252
v_and_b32 v240, 3, v251
v_lshl_add_u32 v252, v240, 4, v252
s_setprio 2
v_cvt_pkrtz_f16_f32 v179, v120, v121
v_cvt_pkrtz_f16_f32 v181, v122, v123
v_cvt_pkrtz_f16_f32 v183, v124, v125
v_cvt_pkrtz_f16_f32 v185, v126, v127
v_cvt_pkrtz_f16_f32 v187, v128, v129
v_cvt_pkrtz_f16_f32 v189, v130, v131
v_cvt_pk_f16_f32 v155, v132, v133
v_cvt_pk_f16_f32 v152, v134, v135
ds_read_b128 v[232:235], v249 offset:17408
ds_read_u16_d16 v142, v142
ds_read_u16_d16_hi v143, v143
v_mfma_f32_32x32x16_bf16 v[120:135], v[96:99], v[236:239], 0
v_pk_fma_f16 v154, v155, v155, s48
v_add_f32 v168, v168, v169
v_and_b32 v179, s49, v179
v_fma_mix_f32 v164, v136, v136, v164 op_sel:[0,0,0] op_sel_hi:[1,1,0]
v_bfe_u32 v178, v179, 2, 14
v_pk_fma_f16 v151, v152, v152, s48
v_add_f32_e64 v170, v170, v171
v_pk_mul_f16 v154, v155, v154
v_lshrrev_b32_e64 v179, 18, v179
v_pk_mul_f16 v151, v152, v151
v_fma_mix_f32 v164, v137, v137, v164 op_sel:[1,1,0] op_sel_hi:[1,1,0]
v_and_b32 v181, s49, v181
s_waitcnt lgkmcnt(4)
ds_read_u16_d16 v178, v178
ds_read_u16_d16_hi v179, v179
v_mfma_f32_32x32x16_bf16 v[120:135], v[100:103], v[216:219], v[120:135]
v_permlane32_swap_b32 v168, v170
v_exp_f16 v153, v154
v_bfe_u32 v180, v181, 2, 14
v_exp_f16 v150, v151
v_add_f32 v168, v168, v170
v_lshrrev_b32_e64 v181, 18, v181
v_fma_mix_f32 v164, v138, v138, v164 op_sel:[0,0,0] op_sel_hi:[1,1,0]
v_and_b32_e64 v183, s49, v183
v_exp_f16_sdwa v153, v154 dst_sel:WORD_1 dst_unused:UNUSED_PRESERVE src0_sel:WORD_1
ds_read_u16_d16 v180, v180
ds_read_u16_d16_hi v181, v181
v_mfma_f32_32x32x16_bf16 v[120:135], v[104:107], v[220:223], v[120:135]
v_mul_f32 v168, 1009429163, v168
v_bfe_u32 v182, v183, 2, 14
v_fma_mix_f32 v164, v139, v139, v164 op_sel:[1,1,0] op_sel_hi:[1,1,0]
v_exp_f16_sdwa v150, v151 dst_sel:WORD_1 dst_unused:UNUSED_PRESERVE src0_sel:WORD_1
v_mov_b32 v170, v168
v_lshrrev_b32 v183, 18, v183
v_pk_add_f16 v153, v153, 1.0 op_sel_hi:[1,0]
v_and_b32 v185, s49, v185
v_fma_mix_f32 v164, v140, v140, v164 op_sel:[0,0,0] op_sel_hi:[1,1,0]
v_bfe_u32 v184, v185, 2, 14
v_permlane32_swap_b32 v168, v170
v_pk_add_f16 v150, v150, 1.0 op_sel_hi:[1,0]
ds_read_u16_d16 v182, v182
ds_read_u16_d16_hi v183, v183
ds_read_u16_d16 v184, v184
v_mfma_f32_32x32x16_bf16 v[120:135], v[108:111], v[224:227], v[120:135]
v_rcp_f16 v154, v153
v_lshrrev_b32 v185, 18, v185
v_fma_mix_f32 v164, v141, v141, v164 op_sel:[1,1,0] op_sel_hi:[1,1,0]
v_fma_f32 v170, -v168, v168, v170
v_and_b32 v187, s49, v187
v_rcp_f16 v151, v150
v_bfe_u32 v186, v187, 2, 14
v_max_f32_e64 v170, 0, v170
v_rcp_f16_sdwa v154, v153 dst_sel:WORD_1 dst_unused:UNUSED_PRESERVE src0_sel:WORD_1
ds_read_b128 v[224:227], v249 offset:18432
ds_read_u16_d16_hi v185, v185
ds_read_u16_d16 v186, v186
v_mfma_f32_32x32x16_bf16 v[120:135], v[112:115], v[228:231], v[120:135]
v_lshrrev_b32 v187, 18, v187
s_waitcnt lgkmcnt(6)
v_fma_mix_f32 v164, v142, v142, v164 op_sel:[0,0,0] op_sel_hi:[1,1,0]
v_and_b32_e64 v189, s49, v189
v_add_f32 v170, 925353388, v170
v_rcp_f16_sdwa v151, v150 dst_sel:WORD_1 dst_unused:UNUSED_PRESERVE src0_sel:WORD_1
v_bfe_u32 v188, v189, 2, 14
v_fma_mix_f32 v164, v143, v143, v164 op_sel:[1,1,0] op_sel_hi:[1,1,0]
v_pk_mul_f16 v155, v155, v154
v_rsq_f32 v170, v170
v_lshrrev_b32 v189, 18, v189
ds_read_b128 v[228:231], v249 offset:21504
ds_read_u16_d16_hi v187, v187
ds_read_b32 v247, v253 offset:16
ds_read_u16_d16 v188, v188
ds_read_u16_d16_hi v189, v189
v_mfma_f32_32x32x16_bf16 v[120:135], v[116:119], v[232:235], v[120:135]
v_pk_mul_f16 v152, v152, v151
v_fma_mix_f32 v165, v155, v155, v165 op_sel:[0,0,0] op_sel_hi:[1,1,0]
v_fma_mix_f32 v165, v178, v178, v165 op_sel:[0,0,0] op_sel_hi:[1,1,0]
v_fma_mix_f32 v165, v179, v179, v165 op_sel:[1,1,0] op_sel_hi:[1,1,0]
v_fma_mix_f32 v165, v180, v180, v165 op_sel:[0,0,0] op_sel_hi:[1,1,0]
v_fma_mix_f32 v165, v155, v155, v165 op_sel:[1,1,0] op_sel_hi:[1,1,0]
v_fma_mix_f32 v165, v181, v181, v165 op_sel:[1,1,0] op_sel_hi:[1,1,0]
s_waitcnt lgkmcnt(5)
v_fma_mix_f32 v165, v182, v182, v165 op_sel:[0,0,0] op_sel_hi:[1,1,0]
v_mul_f32 v172, 3203391086, v170
v_fma_mix_f32 v165, v183, v183, v165 op_sel:[1,1,0] op_sel_hi:[1,1,0]
v_fma_mix_f32 v165, v152, v152, v165 op_sel:[0,0,0] op_sel_hi:[1,1,0]
v_fma_mix_f32 v165, v184, v184, v165 op_sel:[0,0,0] op_sel_hi:[1,1,0]
v_fma_mix_f32 v165, v185, v185, v165 op_sel:[1,1,0] op_sel_hi:[1,1,0]
v_fma_mix_f32 v165, v186, v186, v165 op_sel:[0,0,0] op_sel_hi:[1,1,0]
v_mul_f32 v173, v168, v172
v_fma_mix_f32 v165, v152, v152, v165 op_sel:[1,1,0] op_sel_hi:[1,1,0]
s_waitcnt lgkmcnt(3)
v_fma_mix_f32 v165, v187, v187, v165 op_sel:[1,1,0] op_sel_hi:[1,1,0]
s_waitcnt lgkmcnt(1)
v_fma_mix_f32 v165, v188, v188, v165 op_sel:[0,0,0] op_sel_hi:[1,1,0]
s_waitcnt lgkmcnt(0)
v_fma_mix_f32 v165, v189, v189, v165 op_sel:[1,1,0] op_sel_hi:[1,1,0]
s_setprio 3
v_pk_fma_f32 v[0:1], v[0:1], v[172:173], v[172:173] op_sel:[0,0,1] op_sel_hi:[1,0,1] neg_lo:[0,0,1] neg_hi:[0,0,1]
v_pk_fma_f32 v[2:3], v[2:3], v[172:173], v[172:173] op_sel:[0,0,1] op_sel_hi:[1,0,1] neg_lo:[0,0,1] neg_hi:[0,0,1]
v_pk_fma_f32 v[4:5], v[4:5], v[172:173], v[172:173] op_sel:[0,0,1] op_sel_hi:[1,0,1] neg_lo:[0,0,1] neg_hi:[0,0,1]
v_pk_fma_f32 v[6:7], v[6:7], v[172:173], v[172:173] op_sel:[0,0,1] op_sel_hi:[1,0,1] neg_lo:[0,0,1] neg_hi:[0,0,1]
v_pk_fma_f32 v[8:9], v[8:9], v[172:173], v[172:173] op_sel:[0,0,1] op_sel_hi:[1,0,1] neg_lo:[0,0,1] neg_hi:[0,0,1]
v_pk_fma_f32 v[10:11], v[10:11], v[172:173], v[172:173] op_sel:[0,0,1] op_sel_hi:[1,0,1] neg_lo:[0,0,1] neg_hi:[0,0,1]
v_pk_fma_f32 v[12:13], v[12:13], v[172:173], v[172:173] op_sel:[0,0,1] op_sel_hi:[1,0,1] neg_lo:[0,0,1] neg_hi:[0,0,1]
v_pk_fma_f32 v[14:15], v[14:15], v[172:173], v[172:173] op_sel:[0,0,1] op_sel_hi:[1,0,1] neg_lo:[0,0,1] neg_hi:[0,0,1]
v_pk_fma_f32 v[16:17], v[16:17], v[172:173], v[172:173] op_sel:[0,0,1] op_sel_hi:[1,0,1] neg_lo:[0,0,1] neg_hi:[0,0,1]
v_pk_fma_f32 v[18:19], v[18:19], v[172:173], v[172:173] op_sel:[0,0,1] op_sel_hi:[1,0,1] neg_lo:[0,0,1] neg_hi:[0,0,1]
v_pk_fma_f32 v[20:21], v[20:21], v[172:173], v[172:173] op_sel:[0,0,1] op_sel_hi:[1,0,1] neg_lo:[0,0,1] neg_hi:[0,0,1]
v_pk_fma_f32 v[22:23], v[22:23], v[172:173], v[172:173] op_sel:[0,0,1] op_sel_hi:[1,0,1] neg_lo:[0,0,1] neg_hi:[0,0,1]
v_pk_fma_f32 v[24:25], v[24:25], v[172:173], v[172:173] op_sel:[0,0,1] op_sel_hi:[1,0,1] neg_lo:[0,0,1] neg_hi:[0,0,1]
v_pk_fma_f32 v[26:27], v[26:27], v[172:173], v[172:173] op_sel:[0,0,1] op_sel_hi:[1,0,1] neg_lo:[0,0,1] neg_hi:[0,0,1]
v_pk_fma_f32 v[28:29], v[28:29], v[172:173], v[172:173] op_sel:[0,0,1] op_sel_hi:[1,0,1] neg_lo:[0,0,1] neg_hi:[0,0,1]
v_pk_fma_f32 v[30:31], v[30:31], v[172:173], v[172:173] op_sel:[0,0,1] op_sel_hi:[1,0,1] neg_lo:[0,0,1] neg_hi:[0,0,1]
v_pk_fma_f32 v[32:33], v[32:33], v[172:173], v[172:173] op_sel:[0,0,1] op_sel_hi:[1,0,1] neg_lo:[0,0,1] neg_hi:[0,0,1]
v_pk_fma_f32 v[34:35], v[34:35], v[172:173], v[172:173] op_sel:[0,0,1] op_sel_hi:[1,0,1] neg_lo:[0,0,1] neg_hi:[0,0,1]
v_pk_fma_f32 v[36:37], v[36:37], v[172:173], v[172:173] op_sel:[0,0,1] op_sel_hi:[1,0,1] neg_lo:[0,0,1] neg_hi:[0,0,1]
v_pk_fma_f32 v[38:39], v[38:39], v[172:173], v[172:173] op_sel:[0,0,1] op_sel_hi:[1,0,1] neg_lo:[0,0,1] neg_hi:[0,0,1]
v_pk_fma_f32 v[40:41], v[40:41], v[172:173], v[172:173] op_sel:[0,0,1] op_sel_hi:[1,0,1] neg_lo:[0,0,1] neg_hi:[0,0,1]
v_pk_fma_f32 v[42:43], v[42:43], v[172:173], v[172:173] op_sel:[0,0,1] op_sel_hi:[1,0,1] neg_lo:[0,0,1] neg_hi:[0,0,1]
v_pk_fma_f32 v[44:45], v[44:45], v[172:173], v[172:173] op_sel:[0,0,1] op_sel_hi:[1,0,1] neg_lo:[0,0,1] neg_hi:[0,0,1]
v_pk_fma_f32 v[46:47], v[46:47], v[172:173], v[172:173] op_sel:[0,0,1] op_sel_hi:[1,0,1] neg_lo:[0,0,1] neg_hi:[0,0,1]
s_setprio 2
v_readfirstlane_b32 s43, v247
s_nop 1
s_cmp_ge_u32 s43, 32
s_cbranch_scc1 Lev9
Lev9w:
s_sleep 1
ds_read_b32 v247, v253 offset:16
s_waitcnt lgkmcnt(0)
v_readfirstlane_b32 s43, v247
s_cmp_eq_u32 s76, 0
s_cbranch_scc1 Lev9
s_sub_u32 s76, s76, 1
s_cmp_lt_u32 s43, 32
s_cbranch_scc1 Lev9w
Lev9:
s_setprio 1
v_cvt_pkrtz_f16_f32 v137, v120, v121
v_cvt_pkrtz_f16_f32 v139, v122, v123
v_cvt_pkrtz_f16_f32 v141, v124, v125
v_cvt_pkrtz_f16_f32 v143, v126, v127
v_cvt_pkrtz_f16_f32 v145, v128, v129
v_cvt_pkrtz_f16_f32 v147, v130, v131
v_cvt_pk_f16_f32 v155, v132, v133
v_cvt_pk_f16_f32 v152, v134, v135
s_add_u32 m0, s72, 0
s_add_u32 s43, s82, 0
buffer_load_dwordx4 v252, s[16:19], s43 offen lds
ds_read_b128 v[232:235], v249 offset:19456
ds_read_b128 v[236:239], v249 offset:22528
v_mfma_f32_32x32x16_bf16 v[120:135], v[224:227], v[96:99], 0
v_pk_fma_f16 v154, v155, v155, s48
v_and_b32_e64 v192, 1, v251
v_cvt_pk_bf16_f32 v168, v0, v1
v_and_b32_e64 v137, s49, v137
v_pk_fma_f16 v151, v152, v152, s48
v_cvt_pk_bf16_f32 v169, v2, v3
v_lshlrev_b32 v192, 4, v192
v_and_b32 v139, s49, v139
v_pk_mul_f16 v154, v155, v154
v_cvt_pk_bf16_f32 v170, v4, v5
v_bfe_u32 v136, v137, 2, 14
v_mov_b32 v193, 15360
v_pk_mul_f16 v151, v152, v151
v_bfe_u32 v138, v139, 2, 14
v_cvt_pk_bf16_f32 v171, v6, v7
ds_read_b128 v[224:227], v249 offset:20480
ds_read_u16_d16 v136, v136
ds_read_u16_d16 v138, v138
v_mfma_f32_32x32x16_bf16 v[120:135], v[228:231], v[100:103], v[120:135]
v_exp_f16 v153, v154
v_lshlrev_b32 v192, v192, v193
v_cvt_pk_bf16_f32 v172, v8, v9
v_lshrrev_b32 v137, 18, v137
v_exp_f16 v150, v151
v_lshrrev_b32_e64 v193, 3, v251
v_cvt_pk_bf16_f32 v173, v10, v11
v_lshrrev_b32_e64 v139, 18, v139
v_and_b32 v141, s49, v141
v_xor_b32 v193, v193, v251
v_cvt_pk_bf16_f32 v174, v12, v13
v_exp_f16_sdwa v153, v154 dst_sel:WORD_1 dst_unused:UNUSED_PRESERVE src0_sel:WORD_1
v_cvt_pk_bf16_f32 v175, v14, v15
v_and_b32_e64 v193, 4, v193
s_waitcnt lgkmcnt(3)
s_add_u32 m0, s72, 1024
s_add_u32 s43, s82, 64
buffer_load_dwordx4 v252, s[16:19], s43 offen lds
ds_read_b128 v[228:231], v249 offset:23552
ds_read_u16_d16_hi v137, v137
ds_read_u16_d16_hi v139, v139
v_mfma_f32_32x32x16_bf16 v[120:135], v[232:235], v[104:107], v[120:135]
v_and_b32_e64 v143, s49, v143
v_bfe_u32 v140, v141, 2, 14
v_exp_f16_sdwa v150, v151 dst_sel:WORD_1 dst_unused:UNUSED_PRESERVE src0_sel:WORD_1
v_bfe_u32 v194, v251, 3, 2
v_cvt_pk_bf16_f32 v176, v16, v17
v_bfe_u32 v142, v143, 2, 14
v_cvt_pk_bf16_f32 v177, v18, v19
v_pk_add_f16 v153, v153, 1.0 op_sel_hi:[1,0]
v_lshl_add_u32 v193, v193, 1, 0
v_lshrrev_b32_e64 v141, 18, v141
v_pk_add_f16 v150, v150, 1.0 op_sel_hi:[1,0]
v_cvt_pk_bf16_f32 v178, v20, v21
v_lshrrev_b32_e64 v143, 18, v143
v_lshl_add_u32 v193, v194, 1, v193
ds_read_b128 v[232:235], v248 offset:16384
ds_read_u16_d16 v140, v140
ds_read_u16_d16 v142, v142
ds_read_u16_d16_hi v141, v141
ds_read_u16_d16_hi v143, v143
v_mfma_f32_32x32x16_bf16 v[120:135], v[236:239], v[108:111], v[120:135]
v_rcp_f16_e64 v154, v153
v_cvt_pk_bf16_f32 v179, v22, v23
v_and_b32 v145, s49, v145
v_and_b32 v147, s49, v147
v_bfe_u32 v194, v251, 1, 1
v_cvt_pk_bf16_f32 v180, v24, v25
v_rcp_f16_e64 v151, v150
v_cvt_pk_bf16_f32 v181, v26, v27
v_add_u32_e64 v193, v193, v194
v_bfe_u32 v144, v145, 2, 14
v_rcp_f16_sdwa v154, v153 dst_sel:WORD_1 dst_unused:UNUSED_PRESERVE src0_sel:WORD_1
v_cvt_pk_bf16_f32 v182, v28, v29
v_cmp_eq_u32 vcc, 0, v193
s_nop 1
v_cndmask_b32 v240, 0, v192, vcc
v_bfe_u32 v146, v147, 2, 14
s_waitcnt lgkmcnt(5)
s_add_u32 m0, s72, 2048
s_add_u32 s43, s82, 128
buffer_load_dwordx4 v252, s[16:19], s43 offen lds
ds_read_b128 v[236:239], v248 offset:19456
ds_read_u16_d16 v144, v144
ds_read_u16_d16 v146, v146
v_mfma_f32_32x32x16_bf16 v[120:135], v[224:227], v[112:115], v[120:135]
v_lshrrev_b32_e64 v145, 18, v145
v_cvt_pk_bf16_f32 v183, v30, v31
v_rcp_f16_sdwa v151, v150 dst_sel:WORD_1 dst_unused:UNUSED_PRESERVE src0_sel:WORD_1
v_cmp_eq_u32 vcc, 1, v193
s_nop 1
v_cndmask_b32 v241, 0, v192, vcc
v_cvt_pk_bf16_f32 v184, v32, v33
s_setprio 0
v_lshrrev_b32 v147, 18, v147
v_pk_mul_f16 v155, v155, v154
v_cmp_eq_u32 vcc, 2, v193
s_nop 1
v_cndmask_b32 v242, 0, v192, vcc
v_fma_mix_f32 v166, v136, v136, v166 op_sel:[0,0,0] op_sel_hi:[1,1,0]
v_cvt_pk_bf16_f32 v185, v34, v35
v_fma_mix_f32 v166, v137, v137, v166 op_sel:[1,1,0] op_sel_hi:[1,1,0]
v_pk_mul_f16 v152, v152, v151
v_cmp_eq_u32 vcc, 3, v193
s_nop 1
v_cndmask_b32 v243, 0, v192, vcc
v_cvt_pk_bf16_f32 v186, v36, v37
v_fma_mix_f32 v166, v138, v138, v166 op_sel:[0,0,0] op_sel_hi:[1,1,0]
ds_read_b128 v[224:227], v248 offset:17408
ds_read_u16_d16_hi v145, v145
ds_read_u16_d16_hi v147, v147
v_mfma_f32_32x32x16_bf16 v[120:135], v[228:231], v[116:119], v[120:135]
v_fma_mix_f32 v166, v139, v139, v166 op_sel:[1,1,0] op_sel_hi:[1,1,0]
v_cvt_pk_bf16_f32 v187, v38, v39
v_cmp_eq_u32 vcc, 4, v193
s_nop 1
v_cndmask_b32 v244, 0, v192, vcc
v_fma_mix_f32 v166, v155, v155, v166 op_sel:[0,0,0] op_sel_hi:[1,1,0]
s_waitcnt lgkmcnt(3)
v_fma_mix_f32 v166, v140, v140, v166 op_sel:[0,0,0] op_sel_hi:[1,1,0]
v_fma_mix_f32 v166, v141, v141, v166 op_sel:[1,1,0] op_sel_hi:[1,1,0]
v_cvt_pk_bf16_f32 v188, v40, v41
v_cmp_eq_u32 vcc, 5, v193
s_nop 1
v_cndmask_b32 v245, 0, v192, vcc
v_fma_mix_f32 v166, v155, v155, v166 op_sel:[1,1,0] op_sel_hi:[1,1,0]
v_fma_mix_f32 v166, v142, v142, v166 op_sel:[0,0,0] op_sel_hi:[1,1,0]
v_cvt_pk_bf16_f32 v189, v42, v43
v_fma_mix_f32 v166, v143, v143, v166 op_sel:[1,1,0] op_sel_hi:[1,1,0]
v_cmp_eq_u32 vcc, 6, v193
s_nop 1
v_cndmask_b32 v246, 0, v192, vcc
v_fma_mix_f32 v166, v152, v152, v166 op_sel:[0,0,0] op_sel_hi:[1,1,0]
v_fma_mix_f32 v166, v144, v144, v166 op_sel:[0,0,0] op_sel_hi:[1,1,0]
v_cvt_pk_bf16_f32 v190, v44, v45
s_waitcnt lgkmcnt(0)
v_fma_mix_f32 v166, v145, v145, v166 op_sel:[1,1,0] op_sel_hi:[1,1,0]
v_cmp_eq_u32 vcc, 7, v193
s_nop 1
v_cndmask_b32 v247, 0, v192, vcc
v_fma_mix_f32 v166, v152, v152, v166 op_sel:[1,1,0] op_sel_hi:[1,1,0]
v_cvt_pk_bf16_f32 v191, v46, v47
v_fma_mix_f32 v166, v146, v146, v166 op_sel:[0,0,0] op_sel_hi:[1,1,0]
v_fma_mix_f32 v166, v147, v147, v166 op_sel:[1,1,0] op_sel_hi:[1,1,0]
s_setprio 2
v_cvt_pkrtz_f16_f32 v137, v120, v121
v_cvt_pkrtz_f16_f32 v139, v122, v123
v_cvt_pkrtz_f16_f32 v141, v124, v125
v_cvt_pkrtz_f16_f32 v143, v126, v127
v_cvt_pkrtz_f16_f32 v145, v128, v129
v_cvt_pk_f16_f32 v155, v130, v131
v_cvt_pk_f16_f32 v152, v132, v133
v_cvt_pk_f16_f32 v149, v134, v135
s_add_u32 m0, s72, 3072
s_add_u32 s43, s82, 3072
buffer_load_dwordx4 v252, s[16:19], s43 offen lds
ds_read_b128 v[228:231], v248 offset:20480
v_mfma_f32_32x32x16_bf16 v[120:135], v[232:235], v[168:171], 0
v_pk_fma_f16 v154, v155, v155, s48
v_mov_b32 v208, v48
v_and_b32 v137, s49, v137
v_pk_fma_f16 v151, v152, v152, s48
v_and_b32_e64 v139, s49, v139
v_pk_fma_f16 v148, v149, v149, s48
v_pk_mul_f16 v154, v155, v154
v_bfe_u32 v136, v137, 2, 14
v_pk_mul_f16 v151, v152, v151
ds_read_b128 v[232:235], v248 offset:18432
ds_read_u16_d16 v136, v136
v_mfma_f32_32x32x16_bf16 v[120:135], v[236:239], v[172:175], v[120:135]
v_mov_b32_e64 v209, v49
v_pk_mul_f16 v148, v149, v148
v_bfe_u32 v138, v139, 2, 14
v_exp_f16 v153, v154
v_lshrrev_b32 v137, 18, v137
v_exp_f16 v150, v151
v_mov_b32 v210, v50
v_lshrrev_b32_e64 v139, 18, v139
s_add_u32 m0, s72, 4096
s_add_u32 s43, s82, 3136
buffer_load_dwordx4 v252, s[16:19], s43 offen lds
ds_read_b128 v[236:239], v248 offset:21504
ds_read_u16_d16 v138, v138
ds_read_u16_d16_hi v137, v137
ds_read_u16_d16_hi v139, v139
v_mfma_f32_32x32x16_bf16 v[120:135], v[224:227], v[176:179], v[120:135]
v_exp_f16 v147, v148
v_and_b32 v141, s49, v141
v_and_b32_e64 v143, s49, v143
v_exp_f16_sdwa v153, v154 dst_sel:WORD_1 dst_unused:UNUSED_PRESERVE src0_sel:WORD_1
v_mov_b32 v211, v51
v_bfe_u32 v140, v141, 2, 14
s_waitcnt lgkmcnt(5)
ds_read_b128 v[224:227], v248 offset:22528
ds_read_u16_d16 v140, v140
v_mfma_f32_32x32x16_bf16 v[120:135], v[228:231], v[180:183], v[120:135]
v_exp_f16_sdwa v150, v151 dst_sel:WORD_1 dst_unused:UNUSED_PRESERVE src0_sel:WORD_1
v_bfe_u32 v142, v143, 2, 14
v_exp_f16_sdwa v147, v148 dst_sel:WORD_1 dst_unused:UNUSED_PRESERVE src0_sel:WORD_1
v_lshrrev_b32 v141, 18, v141
v_mov_b32 v212, v52
v_pk_add_f16 v153, v153, 1.0 op_sel_hi:[1,0]
v_lshrrev_b32_e64 v143, 18, v143
v_pk_add_f16 v150, v150, 1.0 op_sel_hi:[1,0]
v_pk_add_f16 v147, v147, 1.0 op_sel_hi:[1,0]
s_add_u32 m0, s72, 5120
s_add_u32 s43, s82, 3200
buffer_load_dwordx4 v252, s[16:19], s43 offen lds
ds_read_b128 v[228:231], v248 offset:25600
ds_read_u16_d16 v142, v142
ds_read_u16_d16_hi v141, v141
ds_read_u16_d16_hi v143, v143
v_mfma_f32_32x32x16_bf16 v[120:135], v[232:235], v[184:187], v[120:135]
v_and_b32 v145, s49, v145
v_rcp_f16 v154, v153
v_mov_b32_e64 v213, v53
v_bfe_u32 v144, v145, 2, 14
v_rcp_f16 v151, v150
v_lshrrev_b32 v145, 18, v145
v_rcp_f16 v148, v147
s_waitcnt lgkmcnt(4)
ds_read_b128 v[232:235], v248 offset:23552
ds_read_u16_d16 v144, v144
ds_read_u16_d16_hi v145, v145
v_mfma_f32_32x32x16_bf16 v[120:135], v[236:239], v[188:191], v[120:135]
v_or_b32 v216, v136, v137
v_mov_b32 v214, v54
v_or_b32_e64 v217, v138, v139
v_rcp_f16_sdwa v154, v153 dst_sel:WORD_1 dst_unused:UNUSED_PRESERVE src0_sel:WORD_1
s_waitcnt lgkmcnt(4)
v_or_b32 v218, v140, v141
v_rcp_f16_sdwa v151, v150 dst_sel:WORD_1 dst_unused:UNUSED_PRESERVE src0_sel:WORD_1
s_waitcnt lgkmcnt(3)
v_or_b32 v219, v142, v143
v_mov_b32_e64 v215, v55
v_rcp_f16_sdwa v148, v147 dst_sel:WORD_1 dst_unused:UNUSED_PRESERVE src0_sel:WORD_1
s_waitcnt lgkmcnt(0)
v_or_b32 v220, v144, v145
v_pk_mul_f16 v221, v155, v154
v_pk_mul_f16 v222, v152, v151
v_pk_mul_f16 v223, v149, v148
s_cmp_lg_u32 s40, 0
s_cbranch_scc1 Lrs0
v_mov_b32 v90, 0
buffer_load_dword v91, v90, s[36:39], 0 offen sc1
Lrs0:
s_setprio 1
s_add_u32 m0, s72, 6144
s_add_u32 s43, s82, 6144
buffer_load_dwordx4 v252, s[16:19], s43 offen lds
ds_read_b128 v[236:239], v248 offset:26624
v_mfma_f32_32x32x16_f16 v[192:207], v[216:219], v[240:243], 0
v_cvt_pkrtz_f16_f32 v137, v120, v121
v_cvt_pkrtz_f16_f32 v139, v122, v123
v_cvt_pkrtz_f16_f32 v141, v124, v125
v_cvt_pkrtz_f16_f32 v143, v126, v127
v_cvt_pkrtz_f16_f32 v145, v128, v129
v_mfma_f32_32x32x16_f16 v[192:207], v[220:223], v[244:247], v[192:207]
v_cvt_pkrtz_f16_f32 v147, v130, v131
v_cvt_pk_f16_f32 v155, v132, v133
v_cvt_pk_f16_f32 v152, v134, v135
v_pk_fma_f16 v154, v155, v155, s48
v_and_b32_e64 v255, 51, v251
v_mfma_f32_32x32x16_bf16 v[120:135], v[224:227], v[168:171], 0
v_and_b32_e64 v137, s49, v137
v_pk_fma_f16 v151, v152, v152, s48
v_and_b32_e64 v139, s49, v139
v_pk_mul_f16 v154, v155, v154
v_bfe_u32 v136, v137, 2, 14
v_pk_mul_f16 v151, v152, v151
v_bfe_u32 v138, v139, 2, 14
v_exp_f16 v153, v154
v_fmac_f32 v167, v192, v192
ds_read_b128 v[224:227], v248 offset:24576
ds_read_u16_d16 v136, v136
ds_read_u16_d16 v138, v138
v_mfma_f32_32x32x16_bf16 v[120:135], v[228:231], v[172:175], v[120:135]
v_bfe_u32 v95, v251, 2, 1
v_lshrrev_b32 v137, 18, v137
v_fmac_f32 v167, v193, v193
v_exp_f16 v150, v151
v_lshrrev_b32 v139, 18, v139
v_fmac_f32 v167, v194, v194
v_and_b32 v141, s49, v141
v_exp_f16_sdwa v153, v154 dst_sel:WORD_1 dst_unused:UNUSED_PRESERVE src0_sel:WORD_1
ds_read_b128 v[228:231], v248 offset:27648
ds_read_u16_d16_hi v137, v137
ds_read_u16_d16_hi v139, v139
v_mfma_f32_32x32x16_bf16 v[120:135], v[232:235], v[176:179], v[120:135]
v_fmac_f32 v167, v195, v195
v_and_b32 v143, s49, v143
v_lshl_add_u32 v255, v95, 3, v255
v_bfe_u32 v140, v141, 2, 14
v_fmac_f32_e64 v167, v196, v196
v_exp_f16_sdwa v150, v151 dst_sel:WORD_1 dst_unused:UNUSED_PRESERVE src0_sel:WORD_1
v_fmac_f32_e64 v167, v197, v197
v_bfe_u32 v142, v143, 2, 14
v_pk_add_f16 v153, v153, 1.0 op_sel_hi:[1,0]
v_lshrrev_b32 v141, 18, v141
s_waitcnt lgkmcnt(4)
ds_read_b128 v[232:235], v248 offset:28672
ds_read_u16_d16 v140, v140
ds_read_u16_d16 v142, v142
ds_read_u16_d16_hi v141, v141
v_mfma_f32_32x32x16_bf16 v[120:135], v[236:239], v[180:183], v[120:135]
v_fmac_f32_e64 v167, v198, v198
v_pk_add_f16 v150, v150, 1.0 op_sel_hi:[1,0]
v_lshrrev_b32_e64 v143, 18, v143
v_bfe_u32 v95, v251, 3, 1
v_fmac_f32 v167, v199, v199
v_rcp_f16 v154, v153
v_and_b32 v145, s49, v145
v_fmac_f32 v167, v200, v200
v_and_b32_e64 v147, s49, v147
ds_read_b128 v[236:239], v248 offset:31744
ds_read_u16_d16_hi v143, v143
v_mfma_f32_32x32x16_bf16 v[120:135], v[224:227], v[184:187], v[120:135]
v_rcp_f16_e64 v151, v150
v_fmac_f32 v167, v201, v201
v_bfe_u32 v144, v145, 2, 14
s_setprio 0
v_lshl_add_u32 v255, v95, 2, v255
v_rcp_f16_sdwa v154, v153 dst_sel:WORD_1 dst_unused:UNUSED_PRESERVE src0_sel:WORD_1
v_fmac_f32_e64 v167, v202, v202
v_bfe_u32 v146, v147, 2, 14
v_fmac_f32 v167, v203, v203
s_waitcnt lgkmcnt(4)
ds_read_b128 v[224:227], v248 offset:29696
ds_read_u16_d16 v144, v144
ds_read_u16_d16 v146, v146
v_mfma_f32_32x32x16_bf16 v[120:135], v[228:231], v[188:191], v[120:135]
v_lshrrev_b32_e64 v145, 18, v145
v_rcp_f16_sdwa v151, v150 dst_sel:WORD_1 dst_unused:UNUSED_PRESERVE src0_sel:WORD_1
v_fmac_f32 v167, v204, v204
v_lshrrev_b32 v147, 18, v147
v_or_b32_e64 v0, v136, v137
v_lshl_add_u32 v255, v255, 2, s72
v_fmac_f32 v167, v205, v205
v_or_b32 v1, v138, v139
s_waitcnt lgkmcnt(4)
v_or_b32 v2, v140, v141
s_waitcnt lgkmcnt(3)
v_or_b32 v3, v142, v143
v_fmac_f32_e64 v167, v206, v206
ds_read_u16_d16_hi v145, v145
ds_read_u16_d16_hi v147, v147
s_waitcnt lgkmcnt(1)
v_or_b32 v4, v144, v145
s_waitcnt lgkmcnt(0)
v_or_b32 v5, v146, v147
v_fmac_f32 v167, v207, v207
v_pk_mul_f16 v6, v155, v154
v_pk_mul_f16 v7, v152, v151
s_setprio 2
ds_read_b128 v[228:231], v248 offset:32768
v_mfma_f32_32x32x16_f16 v[192:207], v[0:3], v[240:243], 0
v_cvt_pkrtz_f16_f32 v137, v120, v121
v_cvt_pkrtz_f16_f32 v139, v122, v123
v_cvt_pkrtz_f16_f32 v141, v124, v125
v_cvt_pkrtz_f16_f32 v143, v126, v127
v_cvt_pkrtz_f16_f32 v145, v128, v129
v_mfma_f32_32x32x16_f16 v[192:207], v[4:7], v[244:247], v[192:207]
v_cvt_pk_f16_f32 v155, v130, v131
v_cvt_pk_f16_f32 v152, v132, v133
v_cvt_pk_f16_f32 v149, v134, v135
v_pk_fma_f16 v154, v155, v155, s48
v_and_b32_e64 v137, s49, v137
v_mfma_f32_32x32x16_bf16 v[120:135], v[232:235], v[168:171], 0
v_pk_fma_f16 v151, v152, v152, s48
v_and_b32_e64 v139, s49, v139
v_pk_fma_f16 v148, v149, v149, s48
v_pk_mul_f16 v154, v155, v154
v_bfe_u32 v136, v137, 2, 14
v_pk_mul_f16 v151, v152, v151
v_pk_mul_f16 v148, v149, v148
v_bfe_u32 v138, v139, 2, 14
v_fmac_f32 v156, v192, v192
v_exp_f16 v153, v154
ds_read_b128 v[232:235], v248 offset:30720
ds_read_u16_d16 v136, v136
ds_read_u16_d16 v138, v138
v_mfma_f32_32x32x16_bf16 v[120:135], v[236:239], v[172:175], v[120:135]
v_fmac_f32 v156, v193, v193
v_lshrrev_b32 v137, 18, v137
v_exp_f16 v150, v151
v_fmac_f32 v156, v194, v194
v_lshrrev_b32 v139, 18, v139
v_exp_f16 v147, v148
v_fmac_f32 v156, v195, v195
v_and_b32 v141, s49, v141
ds_read_b128 v[236:239], v248 offset:33792
ds_read_u16_d16_hi v137, v137
ds_read_u16_d16_hi v139, v139
v_mfma_f32_32x32x16_bf16 v[120:135], v[224:227], v[176:179], v[120:135]
v_and_b32_e64 v143, s49, v143
v_exp_f16_sdwa v153, v154 dst_sel:WORD_1 dst_unused:UNUSED_PRESERVE src0_sel:WORD_1
v_fmac_f32_e64 v156, v196, v196
v_bfe_u32 v140, v141, 2, 14
v_exp_f16_sdwa v150, v151 dst_sel:WORD_1 dst_unused:UNUSED_PRESERVE src0_sel:WORD_1
v_fmac_f32 v156, v197, v197
v_bfe_u32 v142, v143, 2, 14
v_exp_f16_sdwa v147, v148 dst_sel:WORD_1 dst_unused:UNUSED_PRESERVE src0_sel:WORD_1
s_waitcnt lgkmcnt(6)
ds_read_b128 v[224:227], v248 offset:34816
ds_read_u16_d16 v140, v140
ds_read_u16_d16 v142, v142
v_mfma_f32_32x32x16_bf16 v[120:135], v[228:231], v[180:183], v[120:135]
v_fmac_f32 v156, v198, v198
v_lshrrev_b32 v141, 18, v141
v_pk_add_f16 v153, v153, 1.0 op_sel_hi:[1,0]
v_fmac_f32 v156, v199, v199
v_lshrrev_b32 v143, 18, v143
v_pk_add_f16 v150, v150, 1.0 op_sel_hi:[1,0]
v_pk_add_f16 v147, v147, 1.0 op_sel_hi:[1,0]
v_fmac_f32_e64 v156, v200, v200
v_and_b32 v145, s49, v145
s_waitcnt lgkmcnt(4)
ds_read_b128 v[228:231], v248 offset:37888
ds_read_u16_d16_hi v141, v141
ds_read_u16_d16_hi v143, v143
v_mfma_f32_32x32x16_bf16 v[120:135], v[232:235], v[184:187], v[120:135]
v_rcp_f16 v154, v153
v_fmac_f32 v156, v201, v201
v_bfe_u32 v144, v145, 2, 14
v_rcp_f16 v151, v150
v_fmac_f32 v156, v202, v202
v_lshrrev_b32 v145, 18, v145
v_rcp_f16 v148, v147
v_fmac_f32 v156, v203, v203
v_or_b32 v8, v136, v137
ds_read_b128 v[232:235], v248 offset:35840
ds_read_u16_d16 v144, v144
ds_read_u16_d16_hi v145, v145
v_mfma_f32_32x32x16_bf16 v[120:135], v[236:239], v[188:191], v[120:135]
s_waitcnt lgkmcnt(6)
v_or_b32 v9, v138, v139
v_rcp_f16_sdwa v154, v153 dst_sel:WORD_1 dst_unused:UNUSED_PRESERVE src0_sel:WORD_1
v_fmac_f32 v156, v204, v204
s_waitcnt lgkmcnt(4)
v_or_b32_e64 v10, v140, v141
v_rcp_f16_sdwa v151, v150 dst_sel:WORD_1 dst_unused:UNUSED_PRESERVE src0_sel:WORD_1
v_fmac_f32 v156, v205, v205
s_waitcnt lgkmcnt(3)
v_or_b32_e64 v11, v142, v143
v_rcp_f16_sdwa v148, v147 dst_sel:WORD_1 dst_unused:UNUSED_PRESERVE src0_sel:WORD_1
v_fmac_f32 v156, v206, v206
s_waitcnt lgkmcnt(0)
v_or_b32_e64 v12, v144, v145
v_pk_mul_f16 v13, v155, v154
v_fmac_f32 v156, v207, v207
v_pk_mul_f16 v14, v152, v151
v_pk_mul_f16 v15, v149, v148
s_setprio 1
ds_read_b128 v[236:239], v248 offset:38912
v_mfma_f32_32x32x16_f16 v[192:207], v[8:11], v[240:243], 0
v_cvt_pkrtz_f16_f32 v137, v120, v121
v_cvt_pkrtz_f16_f32 v139, v122, v123
v_cvt_pkrtz_f16_f32 v141, v124, v125
v_cvt_pkrtz_f16_f32 v143, v126, v127
v_mfma_f32_32x32x16_f16 v[192:207], v[12:15], v[244:247], v[192:207]
v_cvt_pkrtz_f16_f32 v145, v128, v129
v_cvt_pkrtz_f16_f32 v147, v130, v131
v_cvt_pk_f16_f32 v155, v132, v133
v_cvt_pk_f16_f32 v152, v134, v135
v_pk_fma_f16 v154, v155, v155, s48
v_mfma_f32_32x32x16_bf16 v[120:135], v[224:227], v[168:171], 0
v_and_b32_e64 v137, s49, v137
v_pk_fma_f16 v151, v152, v152, s48
v_and_b32_e64 v139, s49, v139
v_pk_mul_f16 v154, v155, v154
v_bfe_u32 v136, v137, 2, 14
v_pk_mul_f16 v151, v152, v151
v_bfe_u32 v138, v139, 2, 14
v_exp_f16 v153, v154
v_fmac_f32 v157, v192, v192
ds_read_b128 v[224:227], v248 offset:36864
ds_read_u16_d16 v136, v136
ds_read_u16_d16 v138, v138
v_mfma_f32_32x32x16_bf16 v[120:135], v[228:231], v[172:175], v[120:135]
v_lshrrev_b32 v137, 18, v137
v_fmac_f32 v157, v193, v193
v_exp_f16 v150, v151
v_fmac_f32 v157, v194, v194
v_lshrrev_b32 v139, 18, v139
v_and_b32 v141, s49, v141
v_fmac_f32_e64 v157, v195, v195
v_exp_f16_sdwa v153, v154 dst_sel:WORD_1 dst_unused:UNUSED_PRESERVE src0_sel:WORD_1
ds_read_b128 v[228:231], v248 offset:39936
ds_read_u16_d16_hi v137, v137
ds_read_u16_d16_hi v139, v139
v_mfma_f32_32x32x16_bf16 v[120:135], v[232:235], v[176:179], v[120:135]
v_fmac_f32 v157, v196, v196
v_and_b32 v143, s49, v143
v_bfe_u32 v140, v141, 2, 14
v_fmac_f32_e64 v157, v197, v197
v_exp_f16_sdwa v150, v151 dst_sel:WORD_1 dst_unused:UNUSED_PRESERVE src0_sel:WORD_1
v_fmac_f32_e64 v157, v198, v198
v_bfe_u32 v142, v143, 2, 14
v_pk_add_f16 v153, v153, 1.0 op_sel_hi:[1,0]
v_fmac_f32 v157, v199, v199
s_waitcnt lgkmcnt(5)
ds_read_b128 v[232:235], v248 offset:40960
ds_read_u16_d16 v140, v140
ds_read_u16_d16 v142, v142
v_mfma_f32_32x32x16_bf16 v[120:135], v[236:239], v[180:183], v[120:135]
v_lshrrev_b32_e64 v141, 18, v141
v_pk_add_f16 v150, v150, 1.0 op_sel_hi:[1,0]
v_fmac_f32 v157, v200, v200
v_lshrrev_b32 v143, 18, v143
v_rcp_f16 v154, v153
v_fmac_f32 v157, v201, v201
v_and_b32 v145, s49, v145
v_and_b32 v147, s49, v147
v_fmac_f32_e64 v157, v202, v202
ds_read_b128 v[236:239], v248 offset:44032
ds_read_u16_d16_hi v141, v141
ds_read_u16_d16_hi v143, v143
v_mfma_f32_32x32x16_bf16 v[120:135], v[224:227], v[184:187], v[120:135]
v_rcp_f16 v151, v150
v_fmac_f32 v157, v203, v203
v_bfe_u32 v144, v145, 2, 14
s_setprio 0
v_rcp_f16_sdwa v154, v153 dst_sel:WORD_1 dst_unused:UNUSED_PRESERVE src0_sel:WORD_1
v_fmac_f32 v157, v204, v204
v_bfe_u32 v146, v147, 2, 14
v_fmac_f32_e64 v157, v205, v205
v_lshrrev_b32 v145, 18, v145
s_waitcnt lgkmcnt(4)
ds_read_b128 v[224:227], v248 offset:41984
ds_read_u16_d16 v144, v144
ds_read_u16_d16 v146, v146
ds_read_u16_d16_hi v145, v145
v_mfma_f32_32x32x16_bf16 v[120:135], v[228:231], v[188:191], v[120:135]
v_rcp_f16_sdwa v151, v150 dst_sel:WORD_1 dst_unused:UNUSED_PRESERVE src0_sel:WORD_1
v_fmac_f32 v157, v206, v206
v_lshrrev_b32 v147, 18, v147
v_fmac_f32 v157, v207, v207
v_or_b32 v16, v136, v137
v_or_b32 v17, v138, v139
v_permlane32_swap_b32 v156, v157
s_waitcnt lgkmcnt(5)
v_or_b32 v18, v140, v141
s_waitcnt lgkmcnt(4)
v_or_b32 v19, v142, v143
s_waitcnt lgkmcnt(0)
v_or_b32 v20, v144, v145
ds_read_u16_d16_hi v147, v147
s_waitcnt lgkmcnt(0)
v_or_b32 v21, v146, v147
v_add_f32_e64 v156, v156, v157
ds_write_b32 v255, v156 offset:7168
v_pk_mul_f16 v22, v155, v154
v_pk_mul_f16 v23, v152, v151
s_cmp_lg_u32 s40, 0
s_cbranch_scc1 Lrs1
v_mov_b32 v90, 0
Lpi:
s_waitcnt vmcnt(0)
v_readfirstlane_b32 s43, v91
s_cmp_eq_u32 s76, 0
s_cbranch_scc1 Lpix
s_sub_u32 s76, s76, 1
s_cmp_ge_u32 s43, 256
s_cbranch_scc1 Lpix
buffer_load_dword v91, v90, s[36:39], 0 offen sc1
s_branch Lpi
Lpix:
v_min_u32_e64 v88, 47, v251
v_lshlrev_b32 v88, 3, v88
s_and_b32 s44, s2, 7
s_lshl_b32 s44, s44, 11
s_add_u32 s44, s44, 394752
buffer_load_dwordx2 v[92:93], v88, s[32:35], s44 offen sc1
Lrs1:
s_setprio 2
ds_read_b128 v[228:231], v248 offset:45056
v_mfma_f32_32x32x16_f16 v[192:207], v[16:19], v[240:243], 0
v_cvt_pkrtz_f16_f32 v137, v120, v121
v_cvt_pkrtz_f16_f32 v139, v122, v123
v_cvt_pkrtz_f16_f32 v141, v124, v125
v_cvt_pkrtz_f16_f32 v143, v126, v127
v_cvt_pkrtz_f16_f32 v145, v128, v129
v_mfma_f32_32x32x16_f16 v[192:207], v[20:23], v[244:247], v[192:207]
v_cvt_pk_f16_f32 v155, v130, v131
v_cvt_pk_f16_f32 v152, v132, v133
v_cvt_pk_f16_f32 v149, v134, v135
v_pk_fma_f16 v154, v155, v155, s48
v_and_b32_e64 v137, s49, v137
v_mfma_f32_32x32x16_bf16 v[120:135], v[232:235], v[168:171], 0
v_pk_fma_f16 v151, v152, v152, s48
v_and_b32_e64 v139, s49, v139
v_pk_fma_f16 v148, v149, v149, s48
v_pk_mul_f16 v154, v155, v154
v_bfe_u32 v136, v137, 2, 14
v_pk_mul_f16 v151, v152, v151
v_pk_mul_f16 v148, v149, v148
v_bfe_u32 v138, v139, 2, 14
v_fmac_f32 v158, v192, v192
v_exp_f16 v153, v154
ds_read_b128 v[232:235], v248 offset:43008
ds_read_u16_d16 v136, v136
ds_read_u16_d16 v138, v138
v_mfma_f32_32x32x16_bf16 v[120:135], v[236:239], v[172:175], v[120:135]
v_fmac_f32 v158, v193, v193
v_lshrrev_b32 v137, 18, v137
v_exp_f16 v150, v151
v_fmac_f32 v158, v194, v194
v_lshrrev_b32 v139, 18, v139
v_exp_f16 v147, v148
v_fmac_f32 v158, v195, v195
v_and_b32 v141, s49, v141
ds_read_b128 v[236:239], v248 offset:46080
ds_read_u16_d16_hi v137, v137
ds_read_u16_d16_hi v139, v139
v_mfma_f32_32x32x16_bf16 v[120:135], v[224:227], v[176:179], v[120:135]
v_and_b32_e64 v143, s49, v143
v_exp_f16_sdwa v153, v154 dst_sel:WORD_1 dst_unused:UNUSED_PRESERVE src0_sel:WORD_1
v_fmac_f32_e64 v158, v196, v196
v_bfe_u32 v140, v141, 2, 14
v_exp_f16_sdwa v150, v151 dst_sel:WORD_1 dst_unused:UNUSED_PRESERVE src0_sel:WORD_1
v_fmac_f32 v158, v197, v197
v_bfe_u32 v142, v143, 2, 14
v_exp_f16_sdwa v147, v148 dst_sel:WORD_1 dst_unused:UNUSED_PRESERVE src0_sel:WORD_1
s_waitcnt lgkmcnt(6)
ds_read_b128 v[224:227], v248 offset:47104
ds_read_u16_d16 v140, v140
ds_read_u16_d16 v142, v142
v_mfma_f32_32x32x16_bf16 v[120:135], v[228:231], v[180:183], v[120:135]
v_fmac_f32 v158, v198, v198
v_lshrrev_b32 v141, 18, v141
v_pk_add_f16 v153, v153, 1.0 op_sel_hi:[1,0]
v_fmac_f32 v158, v199, v199
v_lshrrev_b32 v143, 18, v143
v_pk_add_f16 v150, v150, 1.0 op_sel_hi:[1,0]
v_pk_add_f16 v147, v147, 1.0 op_sel_hi:[1,0]
v_fmac_f32_e64 v158, v200, v200
v_and_b32 v145, s49, v145
s_waitcnt lgkmcnt(4)
ds_read_b128 v[228:231], v248 offset:50176
ds_read_u16_d16_hi v141, v141
ds_read_u16_d16_hi v143, v143
v_mfma_f32_32x32x16_bf16 v[120:135], v[232:235], v[184:187], v[120:135]
v_rcp_f16 v154, v153
v_fmac_f32 v158, v201, v201
v_bfe_u32 v144, v145, 2, 14
v_rcp_f16 v151, v150
v_fmac_f32 v158, v202, v202
v_lshrrev_b32 v145, 18, v145
v_rcp_f16 v148, v147
v_fmac_f32 v158, v203, v203
v_or_b32 v24, v136, v137
ds_read_b128 v[232:235], v248 offset:48128
ds_read_u16_d16 v144, v144
ds_read_u16_d16_hi v145, v145
v_mfma_f32_32x32x16_bf16 v[120:135], v[236:239], v[188:191], v[120:135]
s_waitcnt lgkmcnt(6)
v_or_b32 v25, v138, v139
v_rcp_f16_sdwa v154, v153 dst_sel:WORD_1 dst_unused:UNUSED_PRESERVE src0_sel:WORD_1
v_fmac_f32 v158, v204, v204
s_waitcnt lgkmcnt(4)
v_or_b32_e64 v26, v140, v141
v_rcp_f16_sdwa v151, v150 dst_sel:WORD_1 dst_unused:UNUSED_PRESERVE src0_sel:WORD_1
v_fmac_f32 v158, v205, v205
s_waitcnt lgkmcnt(3)
v_or_b32_e64 v27, v142, v143
v_rcp_f16_sdwa v148, v147 dst_sel:WORD_1 dst_unused:UNUSED_PRESERVE src0_sel:WORD_1
v_fmac_f32 v158, v206, v206
s_waitcnt lgkmcnt(0)
v_or_b32_e64 v28, v144, v145
v_pk_mul_f16 v29, v155, v154
v_fmac_f32 v158, v207, v207
v_pk_mul_f16 v30, v152, v151
v_pk_mul_f16 v31, v149, v148
s_setprio 1
ds_read_b128 v[236:239], v248 offset:51200
v_mfma_f32_32x32x16_f16 v[192:207], v[24:27], v[240:243], 0
v_cvt_pkrtz_f16_f32 v137, v120, v121
v_cvt_pkrtz_f16_f32 v139, v122, v123
v_cvt_pkrtz_f16_f32 v141, v124, v125
v_cvt_pkrtz_f16_f32 v143, v126, v127
v_mfma_f32_32x32x16_f16 v[192:207], v[28:31], v[244:247], v[192:207]
v_cvt_pkrtz_f16_f32 v145, v128, v129
v_cvt_pkrtz_f16_f32 v147, v130, v131
v_cvt_pk_f16_f32 v155, v132, v133
v_cvt_pk_f16_f32 v152, v134, v135
v_pk_fma_f16 v154, v155, v155, s48
v_mfma_f32_32x32x16_bf16 v[120:135], v[224:227], v[168:171], 0
v_and_b32_e64 v137, s49, v137
v_pk_fma_f16 v151, v152, v152, s48
v_and_b32_e64 v139, s49, v139
v_pk_mul_f16 v154, v155, v154
v_bfe_u32 v136, v137, 2, 14
v_pk_mul_f16 v151, v152, v151
v_bfe_u32 v138, v139, 2, 14
v_exp_f16 v153, v154
v_fmac_f32 v159, v192, v192
ds_read_b128 v[224:227], v248 offset:49152
ds_read_u16_d16 v136, v136
ds_read_u16_d16 v138, v138
v_mfma_f32_32x32x16_bf16 v[120:135], v[228:231], v[172:175], v[120:135]
v_lshrrev_b32 v137, 18, v137
v_fmac_f32 v159, v193, v193
v_exp_f16 v150, v151
v_fmac_f32 v159, v194, v194
v_lshrrev_b32 v139, 18, v139
v_and_b32 v141, s49, v141
v_fmac_f32_e64 v159, v195, v195
v_exp_f16_sdwa v153, v154 dst_sel:WORD_1 dst_unused:UNUSED_PRESERVE src0_sel:WORD_1
ds_read_b128 v[228:231], v248 offset:52224
ds_read_u16_d16_hi v137, v137
ds_read_u16_d16_hi v139, v139
v_mfma_f32_32x32x16_bf16 v[120:135], v[232:235], v[176:179], v[120:135]
v_fmac_f32 v159, v196, v196
v_and_b32 v143, s49, v143
v_bfe_u32 v140, v141, 2, 14
v_fmac_f32_e64 v159, v197, v197
v_exp_f16_sdwa v150, v151 dst_sel:WORD_1 dst_unused:UNUSED_PRESERVE src0_sel:WORD_1
v_fmac_f32_e64 v159, v198, v198
v_bfe_u32 v142, v143, 2, 14
v_pk_add_f16 v153, v153, 1.0 op_sel_hi:[1,0]
v_fmac_f32 v159, v199, v199
s_waitcnt lgkmcnt(5)
ds_read_b128 v[232:235], v248 offset:53248
ds_read_u16_d16 v140, v140
ds_read_u16_d16 v142, v142
v_mfma_f32_32x32x16_bf16 v[120:135], v[236:239], v[180:183], v[120:135]
v_lshrrev_b32_e64 v141, 18, v141
v_pk_add_f16 v150, v150, 1.0 op_sel_hi:[1,0]
v_fmac_f32 v159, v200, v200
v_lshrrev_b32 v143, 18, v143
v_rcp_f16 v154, v153
v_fmac_f32 v159, v201, v201
v_and_b32 v145, s49, v145
v_and_b32 v147, s49, v147
v_fmac_f32_e64 v159, v202, v202
ds_read_b128 v[236:239], v248 offset:56320
ds_read_u16_d16_hi v141, v141
ds_read_u16_d16_hi v143, v143
v_mfma_f32_32x32x16_bf16 v[120:135], v[224:227], v[184:187], v[120:135]
v_rcp_f16 v151, v150
v_fmac_f32 v159, v203, v203
v_bfe_u32 v144, v145, 2, 14
s_setprio 0
v_rcp_f16_sdwa v154, v153 dst_sel:WORD_1 dst_unused:UNUSED_PRESERVE src0_sel:WORD_1
v_fmac_f32 v159, v204, v204
v_bfe_u32 v146, v147, 2, 14
v_fmac_f32_e64 v159, v205, v205
v_lshrrev_b32 v145, 18, v145
s_waitcnt lgkmcnt(4)
ds_read_b128 v[224:227], v248 offset:54272
ds_read_u16_d16 v144, v144
ds_read_u16_d16 v146, v146
ds_read_u16_d16_hi v145, v145
v_mfma_f32_32x32x16_bf16 v[120:135], v[228:231], v[188:191], v[120:135]
v_rcp_f16_sdwa v151, v150 dst_sel:WORD_1 dst_unused:UNUSED_PRESERVE src0_sel:WORD_1
v_fmac_f32 v159, v206, v206
v_lshrrev_b32 v147, 18, v147
v_fmac_f32 v159, v207, v207
v_or_b32 v32, v136, v137
v_or_b32 v33, v138, v139
v_permlane32_swap_b32 v158, v159
s_waitcnt lgkmcnt(5)
v_or_b32 v34, v140, v141
s_waitcnt lgkmcnt(4)
v_or_b32 v35, v142, v143
s_waitcnt lgkmcnt(0)
v_or_b32 v36, v144, v145
ds_read_u16_d16_hi v147, v147
s_waitcnt lgkmcnt(0)
v_or_b32 v37, v146, v147
v_add_f32 v158, v158, v159
ds_write_b32 v255, v158 offset:7424
v_pk_mul_f16 v38, v155, v154
v_pk_mul_f16 v39, v152, v151
s_setprio 2
ds_read_b128 v[228:231], v248 offset:57344
v_mfma_f32_32x32x16_f16 v[192:207], v[32:35], v[240:243], 0
v_cvt_pkrtz_f16_f32 v137, v120, v121
v_cvt_pkrtz_f16_f32 v139, v122, v123
v_cvt_pkrtz_f16_f32 v141, v124, v125
v_cvt_pkrtz_f16_f32 v143, v126, v127
v_cvt_pkrtz_f16_f32 v145, v128, v129
v_mfma_f32_32x32x16_f16 v[192:207], v[36:39], v[244:247], v[192:207]
v_cvt_pk_f16_f32 v155, v130, v131
v_cvt_pk_f16_f32 v152, v132, v133
v_cvt_pk_f16_f32 v149, v134, v135
v_pk_fma_f16 v154, v155, v155, s48
v_and_b32_e64 v137, s49, v137
v_mfma_f32_32x32x16_bf16 v[120:135], v[232:235], v[168:171], 0
v_pk_fma_f16 v151, v152, v152, s48
v_and_b32_e64 v139, s49, v139
v_pk_fma_f16 v148, v149, v149, s48
v_pk_mul_f16 v154, v155, v154
v_bfe_u32 v136, v137, 2, 14
v_pk_mul_f16 v151, v152, v151
v_pk_mul_f16 v148, v149, v148
v_bfe_u32 v138, v139, 2, 14
v_fmac_f32 v160, v192, v192
v_exp_f16 v153, v154
ds_read_b128 v[232:235], v248 offset:55296
ds_read_u16_d16 v136, v136
ds_read_u16_d16 v138, v138
v_mfma_f32_32x32x16_bf16 v[120:135], v[236:239], v[172:175], v[120:135]
v_fmac_f32 v160, v193, v193
v_lshrrev_b32 v137, 18, v137
v_exp_f16 v150, v151
v_fmac_f32 v160, v194, v194
v_lshrrev_b32 v139, 18, v139
v_exp_f16 v147, v148
v_fmac_f32 v160, v195, v195
v_and_b32 v141, s49, v141
ds_read_b128 v[236:239], v248 offset:58368
ds_read_u16_d16_hi v137, v137
ds_read_u16_d16_hi v139, v139
v_mfma_f32_32x32x16_bf16 v[120:135], v[224:227], v[176:179], v[120:135]
v_and_b32_e64 v143, s49, v143
v_exp_f16_sdwa v153, v154 dst_sel:WORD_1 dst_unused:UNUSED_PRESERVE src0_sel:WORD_1
v_fmac_f32_e64 v160, v196, v196
v_bfe_u32 v140, v141, 2, 14
v_exp_f16_sdwa v150, v151 dst_sel:WORD_1 dst_unused:UNUSED_PRESERVE src0_sel:WORD_1
v_fmac_f32 v160, v197, v197
v_bfe_u32 v142, v143, 2, 14
v_exp_f16_sdwa v147, v148 dst_sel:WORD_1 dst_unused:UNUSED_PRESERVE src0_sel:WORD_1
s_waitcnt lgkmcnt(6)
ds_read_b128 v[224:227], v248 offset:59392
ds_read_u16_d16 v140, v140
ds_read_u16_d16 v142, v142
v_mfma_f32_32x32x16_bf16 v[120:135], v[228:231], v[180:183], v[120:135]
v_fmac_f32 v160, v198, v198
v_lshrrev_b32 v141, 18, v141
v_pk_add_f16 v153, v153, 1.0 op_sel_hi:[1,0]
v_fmac_f32 v160, v199, v199
v_lshrrev_b32 v143, 18, v143
v_pk_add_f16 v150, v150, 1.0 op_sel_hi:[1,0]
v_pk_add_f16 v147, v147, 1.0 op_sel_hi:[1,0]
v_fmac_f32_e64 v160, v200, v200
v_and_b32 v145, s49, v145
s_waitcnt lgkmcnt(4)
ds_read_b128 v[228:231], v248 offset:62464
ds_read_u16_d16_hi v141, v141
ds_read_u16_d16_hi v143, v143
v_mfma_f32_32x32x16_bf16 v[120:135], v[232:235], v[184:187], v[120:135]
v_rcp_f16 v154, v153
v_fmac_f32 v160, v201, v201
v_bfe_u32 v144, v145, 2, 14
v_rcp_f16 v151, v150
v_fmac_f32 v160, v202, v202
v_lshrrev_b32 v145, 18, v145
v_rcp_f16 v148, v147
v_fmac_f32 v160, v203, v203
v_or_b32 v40, v136, v137
ds_read_b128 v[232:235], v248 offset:60416
ds_read_u16_d16 v144, v144
ds_read_u16_d16_hi v145, v145
v_mfma_f32_32x32x16_bf16 v[120:135], v[236:239], v[188:191], v[120:135]
s_waitcnt lgkmcnt(6)
v_or_b32 v41, v138, v139
v_rcp_f16_sdwa v154, v153 dst_sel:WORD_1 dst_unused:UNUSED_PRESERVE src0_sel:WORD_1
v_fmac_f32 v160, v204, v204
s_waitcnt lgkmcnt(4)
v_or_b32_e64 v42, v140, v141
v_rcp_f16_sdwa v151, v150 dst_sel:WORD_1 dst_unused:UNUSED_PRESERVE src0_sel:WORD_1
v_fmac_f32 v160, v205, v205
s_waitcnt lgkmcnt(3)
v_or_b32_e64 v43, v142, v143
v_rcp_f16_sdwa v148, v147 dst_sel:WORD_1 dst_unused:UNUSED_PRESERVE src0_sel:WORD_1
v_fmac_f32 v160, v206, v206
s_waitcnt lgkmcnt(0)
v_or_b32_e64 v44, v144, v145
v_pk_mul_f16 v45, v155, v154
v_fmac_f32_e64 v160, v207, v207
v_pk_mul_f16 v46, v152, v151
v_pk_mul_f16 v47, v149, v148
s_cmp_lg_u32 s40, 0
s_cbranch_scc1 Lrs2
v_min_u32 v88, 47, v251
v_lshlrev_b32 v88, 3, v88
v_add_u32 v89, 7936, v88
v_add_u32 v88, 15872, v88
v_cmp_gt_u32 vcc, 32, v251
s_nop 1
v_cndmask_b32 v88, v88, v89, vcc
s_waitcnt vmcnt(0)
ds_write_b64 v88, v[92:93]
Lrs2:
s_setprio 1
ds_read_b128 v[236:239], v248 offset:63488
v_mfma_f32_32x32x16_f16 v[192:207], v[40:43], v[240:243], 0
v_cvt_pkrtz_f16_f32 v137, v120, v121
v_cvt_pkrtz_f16_f32 v139, v122, v123
v_cvt_pkrtz_f16_f32 v141, v124, v125
v_cvt_pkrtz_f16_f32 v143, v126, v127
v_mfma_f32_32x32x16_f16 v[192:207], v[44:47], v[244:247], v[192:207]
s_waitcnt lgkmcnt(1)
v_cvt_pkrtz_f16_f32 v145, v128, v129
v_cvt_pkrtz_f16_f32 v147, v130, v131
v_cvt_pk_f16_f32 v155, v132, v133
v_cvt_pk_f16_f32 v152, v134, v135
v_pk_fma_f16 v154, v155, v155, s48
v_mfma_f32_32x32x16_bf16 v[120:135], v[224:227], v[168:171], 0
v_and_b32_e64 v137, s49, v137
v_pk_fma_f16 v151, v152, v152, s48
v_and_b32_e64 v139, s49, v139
v_pk_mul_f16 v154, v155, v154
v_bfe_u32 v136, v137, 2, 14
v_pk_mul_f16 v151, v152, v151
v_bfe_u32 v138, v139, 2, 14
v_exp_f16 v153, v154
v_fmac_f32 v161, v192, v192
ds_read_b128 v[224:227], v248 offset:61440
ds_read_u16_d16 v136, v136
ds_read_u16_d16 v138, v138
v_mfma_f32_32x32x16_bf16 v[120:135], v[228:231], v[172:175], v[120:135]
v_lshrrev_b32 v137, 18, v137
v_fmac_f32 v161, v193, v193
v_exp_f16 v150, v151
v_fmac_f32 v161, v194, v194
v_lshrrev_b32 v139, 18, v139
v_and_b32 v141, s49, v141
v_fmac_f32_e64 v161, v195, v195
v_exp_f16_sdwa v153, v154 dst_sel:WORD_1 dst_unused:UNUSED_PRESERVE src0_sel:WORD_1
ds_read_b128 v[228:231], v248 offset:64512
ds_read_u16_d16_hi v137, v137
ds_read_u16_d16_hi v139, v139
v_mfma_f32_32x32x16_bf16 v[120:135], v[232:235], v[176:179], v[120:135]
v_fmac_f32 v161, v196, v196
v_and_b32 v143, s49, v143
v_bfe_u32 v140, v141, 2, 14
v_fmac_f32_e64 v161, v197, v197
v_exp_f16_sdwa v150, v151 dst_sel:WORD_1 dst_unused:UNUSED_PRESERVE src0_sel:WORD_1
v_fmac_f32_e64 v161, v198, v198
v_bfe_u32 v142, v143, 2, 14
v_pk_add_f16 v153, v153, 1.0 op_sel_hi:[1,0]
v_fmac_f32 v161, v199, v199
s_waitcnt lgkmcnt(5)
ds_read_b128 v[232:235], v249
ds_read_u16_d16 v140, v140
ds_read_u16_d16 v142, v142
v_mfma_f32_32x32x16_bf16 v[120:135], v[236:239], v[180:183], v[120:135]
v_lshrrev_b32_e64 v141, 18, v141
v_pk_add_f16 v150, v150, 1.0 op_sel_hi:[1,0]
v_fmac_f32 v161, v200, v200
v_lshrrev_b32 v143, 18, v143
v_rcp_f16 v154, v153
v_fmac_f32 v161, v201, v201
v_and_b32 v145, s49, v145
v_and_b32 v147, s49, v147
v_fmac_f32_e64 v161, v202, v202
ds_read_b128 v[236:239], v249 offset:3072
ds_read_u16_d16_hi v141, v141
ds_read_u16_d16_hi v143, v143
v_mfma_f32_32x32x16_bf16 v[120:135], v[224:227], v[184:187], v[120:135]
v_rcp_f16 v151, v150
v_fmac_f32 v161, v203, v203
v_bfe_u32 v144, v145, 2, 14
s_setprio 0
v_rcp_f16_sdwa v154, v153 dst_sel:WORD_1 dst_unused:UNUSED_PRESERVE src0_sel:WORD_1
v_fmac_f32 v161, v204, v204
v_bfe_u32 v146, v147, 2, 14
v_fmac_f32_e64 v161, v205, v205
v_lshrrev_b32 v145, 18, v145
s_waitcnt lgkmcnt(4)
ds_read_b128 v[224:227], v249 offset:1024
ds_read_u16_d16 v144, v144
ds_read_u16_d16 v146, v146
ds_read_u16_d16_hi v145, v145
v_mfma_f32_32x32x16_bf16 v[120:135], v[228:231], v[188:191], v[120:135]
v_rcp_f16_sdwa v151, v150 dst_sel:WORD_1 dst_unused:UNUSED_PRESERVE src0_sel:WORD_1
v_fmac_f32 v161, v206, v206
v_lshrrev_b32 v147, 18, v147
v_fmac_f32 v161, v207, v207
v_or_b32 v48, v136, v137
v_or_b32 v49, v138, v139
v_permlane32_swap_b32 v160, v161
s_waitcnt lgkmcnt(5)
v_or_b32 v50, v140, v141
s_waitcnt lgkmcnt(4)
v_or_b32 v51, v142, v143
s_waitcnt lgkmcnt(0)
v_or_b32 v52, v144, v145
ds_read_u16_d16_hi v147, v147
s_waitcnt lgkmcnt(0)
v_or_b32 v53, v146, v147
v_add_f32 v160, v160, v161
ds_write_b32 v255, v160 offset:7680
v_pk_mul_f16 v54, v155, v154
v_pk_mul_f16 v55, v152, v151
s_setprio 2
ds_read_b128 v[228:231], v249 offset:4096
v_mfma_f32_32x32x16_f16 v[192:207], v[48:51], v[240:243], 0
v_cvt_pkrtz_f16_f32 v137, v120, v121
v_cvt_pkrtz_f16_f32 v139, v122, v123
v_cvt_pkrtz_f16_f32 v141, v124, v125
v_cvt_pkrtz_f16_f32 v143, v126, v127
v_cvt_pkrtz_f16_f32 v145, v128, v129
v_mfma_f32_32x32x16_f16 v[192:207], v[52:55], v[244:247], v[192:207]
v_cvt_pk_f16_f32 v155, v130, v131
v_cvt_pk_f16_f32 v152, v132, v133
v_cvt_pk_f16_f32 v149, v134, v135
v_pk_fma_f16 v154, v155, v155, s48
v_and_b32_e64 v137, s49, v137
v_mfma_f32_32x32x16_bf16 v[120:135], v[232:235], v[168:171], 0
v_pk_fma_f16 v151, v152, v152, s48
v_and_b32_e64 v139, s49, v139
v_pk_fma_f16 v148, v149, v149, s48
v_pk_mul_f16 v154, v155, v154
v_bfe_u32 v136, v137, 2, 14
v_pk_mul_f16 v151, v152, v151
v_pk_mul_f16 v148, v149, v148
v_bfe_u32 v138, v139, 2, 14
v_fmac_f32 v162, v192, v192
v_exp_f16 v153, v154
ds_read_b128 v[232:235], v249 offset:2048
ds_read_u16_d16 v136, v136
ds_read_u16_d16 v138, v138
v_mfma_f32_32x32x16_bf16 v[120:135], v[236:239], v[172:175], v[120:135]
v_fmac_f32 v162, v193, v193
v_lshrrev_b32 v137, 18, v137
v_exp_f16 v150, v151
v_fmac_f32 v162, v194, v194
v_lshrrev_b32 v139, 18, v139
v_exp_f16 v147, v148
v_fmac_f32 v162, v195, v195
v_and_b32 v141, s49, v141
ds_read_b128 v[236:239], v249 offset:5120
ds_read_u16_d16_hi v137, v137
ds_read_u16_d16_hi v139, v139
v_mfma_f32_32x32x16_bf16 v[120:135], v[224:227], v[176:179], v[120:135]
v_and_b32_e64 v143, s49, v143
v_exp_f16_sdwa v153, v154 dst_sel:WORD_1 dst_unused:UNUSED_PRESERVE src0_sel:WORD_1
v_fmac_f32_e64 v162, v196, v196
v_bfe_u32 v140, v141, 2, 14
v_exp_f16_sdwa v150, v151 dst_sel:WORD_1 dst_unused:UNUSED_PRESERVE src0_sel:WORD_1
v_fmac_f32 v162, v197, v197
v_bfe_u32 v142, v143, 2, 14
v_exp_f16_sdwa v147, v148 dst_sel:WORD_1 dst_unused:UNUSED_PRESERVE src0_sel:WORD_1
s_waitcnt lgkmcnt(6)
ds_read_b128 v[224:227], v249 offset:6144
ds_read_u16_d16 v140, v140
ds_read_u16_d16 v142, v142
v_mfma_f32_32x32x16_bf16 v[120:135], v[228:231], v[180:183], v[120:135]
v_fmac_f32 v162, v198, v198
v_lshrrev_b32 v141, 18, v141
v_pk_add_f16 v153, v153, 1.0 op_sel_hi:[1,0]
v_fmac_f32 v162, v199, v199
v_lshrrev_b32 v143, 18, v143
v_pk_add_f16 v150, v150, 1.0 op_sel_hi:[1,0]
v_pk_add_f16 v147, v147, 1.0 op_sel_hi:[1,0]
v_fmac_f32_e64 v162, v200, v200
v_and_b32 v145, s49, v145
s_waitcnt lgkmcnt(4)
ds_read_b128 v[228:231], v249 offset:9216
ds_read_u16_d16_hi v141, v141
ds_read_u16_d16_hi v143, v143
v_mfma_f32_32x32x16_bf16 v[120:135], v[232:235], v[184:187], v[120:135]
v_rcp_f16 v154, v153
v_fmac_f32 v162, v201, v201
v_bfe_u32 v144, v145, 2, 14
v_rcp_f16 v151, v150
v_fmac_f32 v162, v202, v202
v_lshrrev_b32 v145, 18, v145
v_rcp_f16 v148, v147
v_fmac_f32 v162, v203, v203
v_or_b32 v56, v136, v137
ds_read_b128 v[232:235], v249 offset:7168
ds_read_u16_d16 v144, v144
ds_read_u16_d16_hi v145, v145
v_mfma_f32_32x32x16_bf16 v[120:135], v[236:239], v[188:191], v[120:135]
s_waitcnt lgkmcnt(6)
v_or_b32 v57, v138, v139
v_rcp_f16_sdwa v154, v153 dst_sel:WORD_1 dst_unused:UNUSED_PRESERVE src0_sel:WORD_1
v_fmac_f32 v162, v204, v204
s_waitcnt lgkmcnt(4)
v_or_b32_e64 v58, v140, v141
v_rcp_f16_sdwa v151, v150 dst_sel:WORD_1 dst_unused:UNUSED_PRESERVE src0_sel:WORD_1
v_fmac_f32 v162, v205, v205
s_waitcnt lgkmcnt(3)
v_or_b32_e64 v59, v142, v143
v_rcp_f16_sdwa v148, v147 dst_sel:WORD_1 dst_unused:UNUSED_PRESERVE src0_sel:WORD_1
v_fmac_f32 v162, v206, v206
s_waitcnt lgkmcnt(0)
v_or_b32_e64 v60, v144, v145
v_pk_mul_f16 v61, v155, v154
v_fmac_f32 v162, v207, v207
v_pk_mul_f16 v62, v152, v151
v_pk_mul_f16 v63, v149, v148
s_setprio 1
ds_read_b128 v[236:239], v249 offset:10240
v_mfma_f32_32x32x16_f16 v[192:207], v[56:59], v[240:243], 0
v_cvt_pkrtz_f16_f32 v137, v120, v121
v_cvt_pkrtz_f16_f32 v139, v122, v123
v_cvt_pkrtz_f16_f32 v141, v124, v125
v_cvt_pkrtz_f16_f32 v143, v126, v127
v_mfma_f32_32x32x16_f16 v[192:207], v[60:63], v[244:247], v[192:207]
v_cvt_pkrtz_f16_f32 v145, v128, v129
v_cvt_pkrtz_f16_f32 v147, v130, v131
v_cvt_pk_f16_f32 v155, v132, v133
v_cvt_pk_f16_f32 v152, v134, v135
v_pk_fma_f16 v154, v155, v155, s48
v_mfma_f32_32x32x16_bf16 v[120:135], v[224:227], v[168:171], 0
v_and_b32_e64 v137, s49, v137
v_pk_fma_f16 v151, v152, v152, s48
v_and_b32_e64 v139, s49, v139
v_pk_mul_f16 v154, v155, v154
v_bfe_u32 v136, v137, 2, 14
v_pk_mul_f16 v151, v152, v151
v_bfe_u32 v138, v139, 2, 14
v_exp_f16 v153, v154
v_fmac_f32 v163, v192, v192
ds_read_b128 v[224:227], v249 offset:8192
ds_read_u16_d16 v136, v136
ds_read_u16_d16 v138, v138
v_mfma_f32_32x32x16_bf16 v[120:135], v[228:231], v[172:175], v[120:135]
v_lshrrev_b32 v137, 18, v137
v_fmac_f32 v163, v193, v193
v_exp_f16 v150, v151
v_fmac_f32 v163, v194, v194
v_lshrrev_b32 v139, 18, v139
v_and_b32 v141, s49, v141
v_fmac_f32_e64 v163, v195, v195
v_exp_f16_sdwa v153, v154 dst_sel:WORD_1 dst_unused:UNUSED_PRESERVE src0_sel:WORD_1
ds_read_b128 v[228:231], v249 offset:11264
ds_read_u16_d16_hi v137, v137
ds_read_u16_d16_hi v139, v139
v_mfma_f32_32x32x16_bf16 v[120:135], v[232:235], v[176:179], v[120:135]
v_fmac_f32 v163, v196, v196
v_and_b32 v143, s49, v143
v_bfe_u32 v140, v141, 2, 14
v_fmac_f32_e64 v163, v197, v197
v_exp_f16_sdwa v150, v151 dst_sel:WORD_1 dst_unused:UNUSED_PRESERVE src0_sel:WORD_1
v_fmac_f32_e64 v163, v198, v198
v_bfe_u32 v142, v143, 2, 14
v_pk_add_f16 v153, v153, 1.0 op_sel_hi:[1,0]
v_fmac_f32 v163, v199, v199
s_waitcnt lgkmcnt(5)
ds_read_b128 v[232:235], v249 offset:12288
ds_read_u16_d16 v140, v140
ds_read_u16_d16 v142, v142
v_mfma_f32_32x32x16_bf16 v[120:135], v[236:239], v[180:183], v[120:135]
v_lshrrev_b32_e64 v141, 18, v141
v_pk_add_f16 v150, v150, 1.0 op_sel_hi:[1,0]
v_fmac_f32 v163, v200, v200
v_lshrrev_b32 v143, 18, v143
v_rcp_f16 v154, v153
v_fmac_f32 v163, v201, v201
v_and_b32 v145, s49, v145
v_and_b32 v147, s49, v147
v_fmac_f32_e64 v163, v202, v202
ds_read_b128 v[236:239], v249 offset:15360
ds_read_u16_d16_hi v141, v141
ds_read_u16_d16_hi v143, v143
v_mfma_f32_32x32x16_bf16 v[120:135], v[224:227], v[184:187], v[120:135]
v_rcp_f16 v151, v150
v_fmac_f32 v163, v203, v203
v_bfe_u32 v144, v145, 2, 14
s_setprio 0
v_rcp_f16_sdwa v154, v153 dst_sel:WORD_1 dst_unused:UNUSED_PRESERVE src0_sel:WORD_1
v_fmac_f32 v163, v204, v204
v_bfe_u32 v146, v147, 2, 14
v_fmac_f32_e64 v163, v205, v205
v_lshrrev_b32 v145, 18, v145
s_waitcnt lgkmcnt(4)
ds_read_b128 v[224:227], v249 offset:13312
ds_read_u16_d16 v144, v144
ds_read_u16_d16 v146, v146
ds_read_u16_d16_hi v145, v145
v_mfma_f32_32x32x16_bf16 v[120:135], v[228:231], v[188:191], v[120:135]
v_rcp_f16_sdwa v151, v150 dst_sel:WORD_1 dst_unused:UNUSED_PRESERVE src0_sel:WORD_1
v_fmac_f32 v163, v206, v206
v_lshrrev_b32 v147, 18, v147
v_fmac_f32 v163, v207, v207
v_or_b32 v64, v136, v137
v_or_b32 v65, v138, v139
v_permlane32_swap_b32 v162, v163
s_waitcnt lgkmcnt(5)
v_or_b32 v66, v140, v141
s_waitcnt lgkmcnt(4)
v_or_b32 v67, v142, v143
s_waitcnt lgkmcnt(0)
v_or_b32 v68, v144, v145
ds_read_u16_d16_hi v147, v147
s_waitcnt lgkmcnt(0)
v_or_b32 v69, v146, v147
v_add_f32 v162, v162, v163
ds_write_b32 v255, v162 offset:7936
v_pk_mul_f16 v70, v155, v154
v_pk_mul_f16 v71, v152, v151
s_setprio 2
ds_read_b128 v[228:231], v249 offset:16384
v_mfma_f32_32x32x16_f16 v[192:207], v[64:67], v[240:243], 0
v_cvt_pkrtz_f16_f32 v137, v120, v121
v_cvt_pkrtz_f16_f32 v139, v122, v123
v_cvt_pkrtz_f16_f32 v141, v124, v125
v_cvt_pkrtz_f16_f32 v143, v126, v127
v_cvt_pkrtz_f16_f32 v145, v128, v129
v_mfma_f32_32x32x16_f16 v[192:207], v[68:71], v[244:247], v[192:207]
v_cvt_pk_f16_f32 v155, v130, v131
v_cvt_pk_f16_f32 v152, v132, v133
v_cvt_pk_f16_f32 v149, v134, v135
v_pk_fma_f16 v154, v155, v155, s48
v_and_b32_e64 v137, s49, v137
v_mfma_f32_32x32x16_bf16 v[120:135], v[232:235], v[168:171], 0
v_pk_fma_f16 v151, v152, v152, s48
v_and_b32_e64 v139, s49, v139
v_pk_fma_f16 v148, v149, v149, s48
v_pk_mul_f16 v154, v155, v154
v_bfe_u32 v136, v137, 2, 14
v_pk_mul_f16 v151, v152, v151
v_pk_mul_f16 v148, v149, v148
v_bfe_u32 v138, v139, 2, 14
v_fmac_f32 v164, v192, v192
v_exp_f16 v153, v154
ds_read_b128 v[232:235], v249 offset:14336
ds_read_u16_d16 v136, v136
ds_read_u16_d16 v138, v138
v_mfma_f32_32x32x16_bf16 v[120:135], v[236:239], v[172:175], v[120:135]
v_fmac_f32 v164, v193, v193
v_lshrrev_b32 v137, 18, v137
v_exp_f16 v150, v151
v_fmac_f32 v164, v194, v194
v_lshrrev_b32 v139, 18, v139
v_exp_f16 v147, v148
v_fmac_f32 v164, v195, v195
v_and_b32 v141, s49, v141
ds_read_b128 v[236:239], v249 offset:17408
ds_read_u16_d16_hi v137, v137
ds_read_u16_d16_hi v139, v139
v_mfma_f32_32x32x16_bf16 v[120:135], v[224:227], v[176:179], v[120:135]
v_and_b32_e64 v143, s49, v143
v_exp_f16_sdwa v153, v154 dst_sel:WORD_1 dst_unused:UNUSED_PRESERVE src0_sel:WORD_1
v_fmac_f32_e64 v164, v196, v196
v_bfe_u32 v140, v141, 2, 14
v_exp_f16_sdwa v150, v151 dst_sel:WORD_1 dst_unused:UNUSED_PRESERVE src0_sel:WORD_1
v_fmac_f32 v164, v197, v197
v_bfe_u32 v142, v143, 2, 14
v_exp_f16_sdwa v147, v148 dst_sel:WORD_1 dst_unused:UNUSED_PRESERVE src0_sel:WORD_1
s_waitcnt lgkmcnt(6)
ds_read_b128 v[224:227], v249 offset:18432
ds_read_u16_d16 v140, v140
ds_read_u16_d16 v142, v142
v_mfma_f32_32x32x16_bf16 v[120:135], v[228:231], v[180:183], v[120:135]
v_fmac_f32 v164, v198, v198
v_lshrrev_b32 v141, 18, v141
v_pk_add_f16 v153, v153, 1.0 op_sel_hi:[1,0]
v_fmac_f32 v164, v199, v199
v_lshrrev_b32 v143, 18, v143
v_pk_add_f16 v150, v150, 1.0 op_sel_hi:[1,0]
v_pk_add_f16 v147, v147, 1.0 op_sel_hi:[1,0]
v_fmac_f32_e64 v164, v200, v200
v_and_b32 v145, s49, v145
s_waitcnt lgkmcnt(4)
ds_read_b128 v[228:231], v249 offset:21504
ds_read_u16_d16_hi v141, v141
ds_read_u16_d16_hi v143, v143
v_mfma_f32_32x32x16_bf16 v[120:135], v[232:235], v[184:187], v[120:135]
v_rcp_f16 v154, v153
v_fmac_f32 v164, v201, v201
v_bfe_u32 v144, v145, 2, 14
v_rcp_f16 v151, v150
v_fmac_f32 v164, v202, v202
v_lshrrev_b32 v145, 18, v145
v_rcp_f16 v148, v147
v_fmac_f32 v164, v203, v203
v_or_b32 v72, v136, v137
ds_read_b128 v[232:235], v249 offset:19456
ds_read_u16_d16 v144, v144
ds_read_u16_d16_hi v145, v145
v_mfma_f32_32x32x16_bf16 v[120:135], v[236:239], v[188:191], v[120:135]
s_waitcnt lgkmcnt(6)
v_or_b32 v73, v138, v139
v_rcp_f16_sdwa v154, v153 dst_sel:WORD_1 dst_unused:UNUSED_PRESERVE src0_sel:WORD_1
v_fmac_f32 v164, v204, v204
s_waitcnt lgkmcnt(4)
v_or_b32_e64 v74, v140, v141
v_rcp_f16_sdwa v151, v150 dst_sel:WORD_1 dst_unused:UNUSED_PRESERVE src0_sel:WORD_1
v_fmac_f32 v164, v205, v205
s_waitcnt lgkmcnt(3)
v_or_b32_e64 v75, v142, v143
v_rcp_f16_sdwa v148, v147 dst_sel:WORD_1 dst_unused:UNUSED_PRESERVE src0_sel:WORD_1
v_fmac_f32 v164, v206, v206
s_waitcnt lgkmcnt(0)
v_or_b32_e64 v76, v144, v145
v_pk_mul_f16 v77, v155, v154
v_fmac_f32 v164, v207, v207
v_pk_mul_f16 v78, v152, v151
v_pk_mul_f16 v79, v149, v148
s_setprio 1
ds_read_b128 v[236:239], v249 offset:22528
v_mfma_f32_32x32x16_f16 v[192:207], v[72:75], v[240:243], 0
v_cvt_pkrtz_f16_f32 v137, v120, v121
v_cvt_pkrtz_f16_f32 v139, v122, v123
v_cvt_pkrtz_f16_f32 v141, v124, v125
v_cvt_pkrtz_f16_f32 v143, v126, v127
v_mfma_f32_32x32x16_f16 v[192:207], v[76:79], v[244:247], v[192:207]
v_cvt_pkrtz_f16_f32 v145, v128, v129
v_cvt_pkrtz_f16_f32 v147, v130, v131
v_cvt_pk_f16_f32 v155, v132, v133
v_cvt_pk_f16_f32 v152, v134, v135
v_pk_fma_f16 v154, v155, v155, s48
v_mfma_f32_32x32x16_bf16 v[120:135], v[224:227], v[168:171], 0
v_and_b32_e64 v137, s49, v137
v_pk_fma_f16 v151, v152, v152, s48
v_and_b32_e64 v139, s49, v139
v_pk_mul_f16 v154, v155, v154
v_bfe_u32 v136, v137, 2, 14
v_pk_mul_f16 v151, v152, v151
v_bfe_u32 v138, v139, 2, 14
v_exp_f16 v153, v154
v_fmac_f32 v165, v192, v192
ds_read_b128 v[224:227], v249 offset:20480
ds_read_u16_d16 v136, v136
ds_read_u16_d16 v138, v138
v_mfma_f32_32x32x16_bf16 v[120:135], v[228:231], v[172:175], v[120:135]
v_lshrrev_b32 v137, 18, v137
v_fmac_f32 v165, v193, v193
v_exp_f16 v150, v151
v_fmac_f32 v165, v194, v194
v_lshrrev_b32 v139, 18, v139
v_and_b32 v141, s49, v141
v_fmac_f32_e64 v165, v195, v195
v_exp_f16_sdwa v153, v154 dst_sel:WORD_1 dst_unused:UNUSED_PRESERVE src0_sel:WORD_1
ds_read_b128 v[228:231], v249 offset:23552
ds_read_u16_d16_hi v137, v137
ds_read_u16_d16_hi v139, v139
v_mfma_f32_32x32x16_bf16 v[120:135], v[232:235], v[176:179], v[120:135]
v_fmac_f32 v165, v196, v196
v_and_b32 v143, s49, v143
v_bfe_u32 v140, v141, 2, 14
v_fmac_f32_e64 v165, v197, v197
v_exp_f16_sdwa v150, v151 dst_sel:WORD_1 dst_unused:UNUSED_PRESERVE src0_sel:WORD_1
v_fmac_f32_e64 v165, v198, v198
v_bfe_u32 v142, v143, 2, 14
v_pk_add_f16 v153, v153, 1.0 op_sel_hi:[1,0]
v_fmac_f32 v165, v199, v199
s_waitcnt lgkmcnt(5)
ds_read_b128 v[232:235], v248 offset:40960
ds_read_u16_d16 v140, v140
ds_read_u16_d16 v142, v142
v_mfma_f32_32x32x16_bf16 v[120:135], v[236:239], v[180:183], v[120:135]
v_lshrrev_b32_e64 v141, 18, v141
v_pk_add_f16 v150, v150, 1.0 op_sel_hi:[1,0]
v_fmac_f32 v165, v200, v200
v_lshrrev_b32 v143, 18, v143
v_rcp_f16 v154, v153
v_fmac_f32 v165, v201, v201
v_and_b32 v145, s49, v145
v_and_b32 v147, s49, v147
v_fmac_f32_e64 v165, v202, v202
ds_read_b128 v[236:239], v248 offset:44032
ds_read_u16_d16_hi v141, v141
ds_read_u16_d16_hi v143, v143
v_mfma_f32_32x32x16_bf16 v[120:135], v[224:227], v[184:187], v[120:135]
v_rcp_f16 v151, v150
v_fmac_f32 v165, v203, v203
v_bfe_u32 v144, v145, 2, 14
s_setprio 0
v_rcp_f16_sdwa v154, v153 dst_sel:WORD_1 dst_unused:UNUSED_PRESERVE src0_sel:WORD_1
v_fmac_f32 v165, v204, v204
v_bfe_u32 v146, v147, 2, 14
v_fmac_f32_e64 v165, v205, v205
v_lshrrev_b32 v145, 18, v145
s_waitcnt lgkmcnt(4)
ds_read_b128 v[224:227], v248 offset:41984
ds_read_u16_d16 v144, v144
ds_read_u16_d16 v146, v146
ds_read_u16_d16_hi v145, v145
v_mfma_f32_32x32x16_bf16 v[120:135], v[228:231], v[188:191], v[120:135]
v_rcp_f16_sdwa v151, v150 dst_sel:WORD_1 dst_unused:UNUSED_PRESERVE src0_sel:WORD_1
v_fmac_f32 v165, v206, v206
v_lshrrev_b32 v147, 18, v147
v_fmac_f32 v165, v207, v207
v_or_b32 v80, v136, v137
v_or_b32 v81, v138, v139
v_permlane32_swap_b32 v164, v165
s_waitcnt lgkmcnt(5)
v_or_b32 v82, v140, v141
s_waitcnt lgkmcnt(4)
v_or_b32 v83, v142, v143
s_waitcnt lgkmcnt(0)
v_or_b32 v84, v144, v145
ds_read_u16_d16_hi v147, v147
s_waitcnt lgkmcnt(0)
v_or_b32 v85, v146, v147
v_add_f32 v164, v164, v165
ds_write_b32 v255, v164 offset:8192
v_pk_mul_f16 v86, v155, v154
v_pk_mul_f16 v87, v152, v151
s_setprio 2
ds_read_b128 v[228:231], v248 offset:45056
v_mfma_f32_32x32x16_f16 v[192:207], v[80:83], v[240:243], 0
v_cvt_pkrtz_f16_f32 v137, v120, v121
v_cvt_pkrtz_f16_f32 v139, v122, v123
v_cvt_pkrtz_f16_f32 v141, v124, v125
v_cvt_pkrtz_f16_f32 v143, v126, v127
v_cvt_pkrtz_f16_f32 v145, v128, v129
v_mfma_f32_32x32x16_f16 v[192:207], v[84:87], v[244:247], v[192:207]
v_cvt_pk_f16_f32 v155, v130, v131
v_cvt_pk_f16_f32 v152, v132, v133
v_cvt_pk_f16_f32 v149, v134, v135
v_pk_fma_f16 v154, v155, v155, s48
v_and_b32_e64 v137, s49, v137
v_mfma_f32_32x32x16_bf16 v[120:135], v[232:235], v[96:99], 0
v_pk_fma_f16 v151, v152, v152, s48
v_and_b32_e64 v139, s49, v139
v_pk_fma_f16 v148, v149, v149, s48
v_pk_mul_f16 v154, v155, v154
v_bfe_u32 v136, v137, 2, 14
v_pk_mul_f16 v151, v152, v151
v_pk_mul_f16 v148, v149, v148
v_bfe_u32 v138, v139, 2, 14
v_fmac_f32 v166, v192, v192
v_exp_f16 v153, v154
ds_read_b128 v[232:235], v248 offset:43008
ds_read_u16_d16 v136, v136
ds_read_u16_d16 v138, v138
v_mfma_f32_32x32x16_bf16 v[120:135], v[236:239], v[100:103], v[120:135]
v_fmac_f32 v166, v193, v193
v_lshrrev_b32 v137, 18, v137
v_exp_f16 v150, v151
v_fmac_f32 v166, v194, v194
v_lshrrev_b32 v139, 18, v139
v_exp_f16 v147, v148
v_fmac_f32 v166, v195, v195
v_and_b32 v141, s49, v141
ds_read_b128 v[236:239], v248 offset:46080
ds_read_u16_d16_hi v137, v137
ds_read_u16_d16_hi v139, v139
v_mfma_f32_32x32x16_bf16 v[120:135], v[224:227], v[104:107], v[120:135]
v_and_b32_e64 v143, s49, v143
v_exp_f16_sdwa v153, v154 dst_sel:WORD_1 dst_unused:UNUSED_PRESERVE src0_sel:WORD_1
v_fmac_f32_e64 v166, v196, v196
v_bfe_u32 v140, v141, 2, 14
v_exp_f16_sdwa v150, v151 dst_sel:WORD_1 dst_unused:UNUSED_PRESERVE src0_sel:WORD_1
v_fmac_f32 v166, v197, v197
v_bfe_u32 v142, v143, 2, 14
v_exp_f16_sdwa v147, v148 dst_sel:WORD_1 dst_unused:UNUSED_PRESERVE src0_sel:WORD_1
s_waitcnt lgkmcnt(6)
ds_read_b128 v[224:227], v248 offset:47104
ds_read_u16_d16 v140, v140
ds_read_u16_d16 v142, v142
v_mfma_f32_32x32x16_bf16 v[120:135], v[228:231], v[108:111], v[120:135]
v_fmac_f32 v166, v198, v198
v_lshrrev_b32 v141, 18, v141
v_pk_add_f16 v153, v153, 1.0 op_sel_hi:[1,0]
v_fmac_f32 v166, v199, v199
v_lshrrev_b32 v143, 18, v143
v_pk_add_f16 v150, v150, 1.0 op_sel_hi:[1,0]
v_pk_add_f16 v147, v147, 1.0 op_sel_hi:[1,0]
v_fmac_f32_e64 v166, v200, v200
v_and_b32 v145, s49, v145
s_waitcnt lgkmcnt(4)
ds_read_b128 v[228:231], v248 offset:50176
ds_read_u16_d16_hi v141, v141
ds_read_u16_d16_hi v143, v143
v_mfma_f32_32x32x16_bf16 v[120:135], v[232:235], v[112:115], v[120:135]
v_rcp_f16 v154, v153
v_fmac_f32 v166, v201, v201
v_bfe_u32 v144, v145, 2, 14
v_rcp_f16 v151, v150
v_fmac_f32 v166, v202, v202
v_lshrrev_b32 v145, 18, v145
v_rcp_f16 v148, v147
v_fmac_f32 v166, v203, v203
v_or_b32 v88, v136, v137
ds_read_b128 v[232:235], v248 offset:48128
ds_read_u16_d16 v144, v144
ds_read_u16_d16_hi v145, v145
v_mfma_f32_32x32x16_bf16 v[120:135], v[236:239], v[116:119], v[120:135]
s_waitcnt lgkmcnt(6)
v_or_b32 v89, v138, v139
v_rcp_f16_sdwa v154, v153 dst_sel:WORD_1 dst_unused:UNUSED_PRESERVE src0_sel:WORD_1
v_fmac_f32 v166, v204, v204
s_waitcnt lgkmcnt(4)
v_or_b32_e64 v90, v140, v141
v_rcp_f16_sdwa v151, v150 dst_sel:WORD_1 dst_unused:UNUSED_PRESERVE src0_sel:WORD_1
v_fmac_f32 v166, v205, v205
s_waitcnt lgkmcnt(3)
v_or_b32_e64 v91, v142, v143
v_rcp_f16_sdwa v148, v147 dst_sel:WORD_1 dst_unused:UNUSED_PRESERVE src0_sel:WORD_1
v_fmac_f32 v166, v206, v206
s_waitcnt lgkmcnt(0)
v_or_b32_e64 v92, v144, v145
v_pk_mul_f16 v93, v155, v154
v_fmac_f32 v166, v207, v207
v_pk_mul_f16 v94, v152, v151
v_pk_mul_f16 v95, v149, v148
s_setprio 1
ds_read_b128 v[236:239], v248 offset:51200
v_mfma_f32_32x32x16_f16 v[192:207], v[88:91], v[240:243], 0
v_cvt_pkrtz_f16_f32 v137, v120, v121
v_cvt_pkrtz_f16_f32 v139, v122, v123
v_cvt_pkrtz_f16_f32 v141, v124, v125
v_cvt_pkrtz_f16_f32 v143, v126, v127
v_cvt_pkrtz_f16_f32 v145, v128, v129
v_mfma_f32_32x32x16_f16 v[192:207], v[92:95], v[244:247], v[192:207]
v_cvt_pk_f16_f32 v155, v130, v131
v_cvt_pk_f16_f32 v152, v132, v133
v_cvt_pk_f16_f32 v149, v134, v135
v_pk_fma_f16 v154, v155, v155, s48
v_and_b32_e64 v137, s49, v137
v_pk_fma_f16 v151, v152, v152, s48
v_mfma_f32_32x32x16_bf16 v[120:135], v[224:227], v[96:99], 0
v_and_b32_e64 v139, s49, v139
v_pk_fma_f16 v148, v149, v149, s48
v_pk_mul_f16 v154, v155, v154
v_bfe_u32 v136, v137, 2, 14
v_pk_mul_f16 v151, v152, v151
v_pk_mul_f16 v148, v149, v148
v_fmac_f32 v167, v192, v192
v_fmac_f32 v167, v193, v193
v_fmac_f32 v167, v194, v194
v_fmac_f32 v167, v195, v195
v_fmac_f32_e64 v167, v196, v196
ds_read_b128 v[224:227], v248 offset:49152
ds_read_u16_d16 v136, v136
v_mfma_f32_32x32x16_bf16 v[120:135], v[228:231], v[100:103], v[120:135]
v_fmac_f32 v167, v197, v197
v_fmac_f32 v167, v198, v198
v_fmac_f32 v167, v199, v199
v_fmac_f32 v167, v200, v200
v_fmac_f32 v167, v201, v201
v_fmac_f32 v167, v202, v202
v_fmac_f32 v167, v203, v203
v_fmac_f32 v167, v204, v204
v_fmac_f32 v167, v205, v205
v_fmac_f32 v167, v206, v206
v_fmac_f32_e64 v167, v207, v207
ds_read_b128 v[228:231], v248 offset:52224
v_mfma_f32_32x32x16_bf16 v[120:135], v[232:235], v[104:107], v[120:135]
v_permlane32_swap_b32 v166, v167
v_add_f32 v166, v166, v167
ds_write_b32 v255, v166 offset:8448
s_setprio 3
s_mov_b64 exec, 1
ds_add_rtn_u32 v242, v253, v254
s_mov_b64 exec, -1
s_waitcnt lgkmcnt(0)
v_readfirstlane_b32 s43, v242
s_nop 1
s_cmp_lg_u32 s43, 7
s_cbranch_scc1 Lnopub
v_min_u32 v243, 47, v251
v_lshlrev_b32 v244, 5, v243
v_add_u32 v244, 97280, v244
ds_read_b128 v[176:179], v244
ds_read_b128 v[180:183], v244 offset:16
ds_read_b128 v[184:187], v244 offset:9216
ds_read_b128 v[188:191], v244 offset:9232
ds_read_b128 v[192:195], v244 offset:18432
ds_read_b128 v[196:199], v244 offset:18448
ds_read_b128 v[200:203], v244 offset:27648
ds_read_b128 v[204:207], v244 offset:27664
ds_read_b128 v[156:159], v244 offset:36864
ds_read_b128 v[160:163], v244 offset:36880
v_lshlrev_b32_e64 v246, 13, v243
v_add_u32 v247, 4096, v246
s_waitcnt lgkmcnt(7)
v_add_f32 v176, v176, v184
v_add_f32 v177, v177, v185
v_add_f32 v178, v178, v186
v_add_f32 v179, v179, v187
s_waitcnt lgkmcnt(6)
v_add_f32 v180, v180, v188
v_add_f32 v181, v181, v189
v_add_f32 v182, v182, v190
v_add_f32 v183, v183, v191
ds_read_b128 v[184:187], v244 offset:46080
ds_read_b128 v[188:191], v244 offset:46096
s_waitcnt lgkmcnt(5)
v_add_f32 v192, v192, v200
v_add_f32 v193, v193, v201
v_add_f32 v194, v194, v202
v_add_f32 v195, v195, v203
s_waitcnt lgkmcnt(4)
v_add_f32 v196, v196, v204
v_add_f32 v197, v197, v205
v_add_f32 v198, v198, v206
v_add_f32 v199, v199, v207
ds_read_b128 v[200:203], v244 offset:55296
ds_read_b128 v[204:207], v244 offset:55312
v_add_f32 v176, v176, v192
v_add_f32 v177, v177, v193
v_add_f32 v178, v178, v194
v_add_f32 v179, v179, v195
v_add_f32 v180, v180, v196
v_add_f32 v181, v181, v197
v_add_f32 v182, v182, v198
v_add_f32 v183, v183, v199
ds_read_b128 v[192:195], v244 offset:64512
ds_read_b128 v[196:199], v244 offset:64528
s_waitcnt lgkmcnt(5)
v_add_f32 v156, v156, v184
v_add_f32 v157, v157, v185
v_add_f32 v158, v158, v186
v_add_f32 v159, v159, v187
s_waitcnt lgkmcnt(4)
v_add_f32 v160, v160, v188
v_add_f32 v161, v161, v189
v_add_f32 v162, v162, v190
v_add_f32 v163, v163, v191
s_waitcnt lgkmcnt(1)
v_add_f32 v200, v200, v192
v_add_f32 v201, v201, v193
v_add_f32 v202, v202, v194
v_add_f32 v203, v203, v195
s_waitcnt lgkmcnt(0)
v_add_f32 v204, v204, v196
v_add_f32 v205, v205, v197
v_add_f32 v206, v206, v198
v_add_f32 v207, v207, v199
v_add_f32 v156, v156, v200
v_add_f32 v157, v157, v201
v_add_f32 v158, v158, v202
v_add_f32 v159, v159, v203
v_add_f32 v160, v160, v204
v_add_f32 v161, v161, v205
v_add_f32 v162, v162, v206
v_add_f32 v163, v163, v207
v_add_f32 v176, v176, v156
v_add_f32 v177, v177, v157
v_add_f32 v178, v178, v158
v_add_f32 v179, v179, v159
v_add_f32 v180, v180, v160
v_add_f32 v181, v181, v161
v_add_f32 v182, v182, v162
v_add_f32 v183, v183, v163
v_min_u32 v184, -2, v176
v_min_u32 v185, -2, v177
v_min_u32 v186, -2, v178
v_min_u32 v187, -2, v179
v_min_u32 v188, -2, v180
v_min_u32 v189, -2, v181
v_min_u32_e64 v190, -2, v182
v_min_u32 v191, -2, v183
s_lshl_b32 s43, s2, 4
buffer_store_dwordx4 v[184:187], v246, s[32:35], s43 offen sc1
buffer_store_dwordx4 v[188:191], v247, s[32:35], s43 offen sc1
ds_write_b32 v253, v254 offset:4
s_nop 1
Lnopub:
s_mov_b32 s77, 0
s_cmp_lg_u32 s40, 0
s_cbranch_scc1 Lnorole
v_lshlrev_b32_e64 v247, 2, v251
buffer_load_dword v244, v247, s[24:27], 0 offen offset:0
buffer_load_dword v245, v247, s[24:27], 0 offen offset:256
buffer_load_dword v246, v247, s[24:27], 0 offen offset:512
s_cmp_lt_u32 s2, 96
s_cselect_b32 s77, 1, 2
s_waitcnt lgkmcnt(0)
v_mov_b32 v156, -1
v_mov_b32 v157, -1
v_mov_b32 v158, -1
v_mov_b32 v159, -1
v_mov_b32 v160, -1
v_mov_b32 v161, -1
v_mov_b32 v162, -1
v_mov_b32 v163, -1
v_mov_b32 v164, -1
v_mov_b32 v165, -1
v_mov_b32 v166, -1
v_mov_b32 v167, -1
v_mov_b32 v240, -1
v_mov_b32 v241, -1
v_mov_b32 v242, -1
v_mov_b32 v243, -1
s_call_b64 s[78:79], Lpoll1
Lnorole:
s_setprio 1
v_bfe_u32 v138, v139, 2, 14
v_exp_f16 v153, v154
v_lshrrev_b32 v137, 18, v137
v_exp_f16 v150, v151
v_lshrrev_b32 v139, 18, v139
ds_read_b128 v[232:235], v248 offset:53248
ds_read_u16_d16 v138, v138
ds_read_u16_d16_hi v137, v137
ds_read_u16_d16_hi v139, v139
v_mfma_f32_32x32x16_bf16 v[120:135], v[236:239], v[108:111], v[120:135]
v_exp_f16 v147, v148
v_and_b32 v141, s49, v141
v_and_b32_e64 v143, s49, v143
v_exp_f16_sdwa v153, v154 dst_sel:WORD_1 dst_unused:UNUSED_PRESERVE src0_sel:WORD_1
v_bfe_u32 v140, v141, 2, 14
v_exp_f16_sdwa v150, v151 dst_sel:WORD_1 dst_unused:UNUSED_PRESERVE src0_sel:WORD_1
v_bfe_u32 v142, v143, 2, 14
v_exp_f16_sdwa v147, v148 dst_sel:WORD_1 dst_unused:UNUSED_PRESERVE src0_sel:WORD_1
ds_read_b128 v[236:239], v248 offset:56320
ds_read_u16_d16 v140, v140
ds_read_u16_d16 v142, v142
v_mfma_f32_32x32x16_bf16 v[120:135], v[224:227], v[112:115], v[120:135]
v_lshrrev_b32_e64 v141, 18, v141
v_pk_add_f16 v153, v153, 1.0 op_sel_hi:[1,0]
v_lshrrev_b32 v143, 18, v143
v_pk_add_f16 v150, v150, 1.0 op_sel_hi:[1,0]
s_setprio 0
v_pk_add_f16 v147, v147, 1.0 op_sel_hi:[1,0]
v_and_b32 v145, s49, v145
v_rcp_f16 v154, v153
v_bfe_u32 v144, v145, 2, 14
v_rcp_f16_e64 v151, v150
ds_read_b128 v[224:227], v248 offset:54272
ds_read_u16_d16_hi v141, v141
ds_read_u16_d16_hi v143, v143
ds_read_u16_d16 v144, v144
v_mfma_f32_32x32x16_bf16 v[120:135], v[228:231], v[116:119], v[120:135]
v_lshrrev_b32 v145, 18, v145
v_rcp_f16 v148, v147
s_waitcnt lgkmcnt(7)
v_or_b32 v168, v136, v137
v_or_b32_e64 v169, v138, v139
v_rcp_f16_sdwa v154, v153 dst_sel:WORD_1 dst_unused:UNUSED_PRESERVE src0_sel:WORD_1
s_waitcnt lgkmcnt(2)
v_or_b32 v170, v140, v141
v_rcp_f16_sdwa v151, v150 dst_sel:WORD_1 dst_unused:UNUSED_PRESERVE src0_sel:WORD_1
s_waitcnt lgkmcnt(1)
v_or_b32 v171, v142, v143
v_rcp_f16_sdwa v148, v147 dst_sel:WORD_1 dst_unused:UNUSED_PRESERVE src0_sel:WORD_1
ds_read_u16_d16_hi v145, v145
s_waitcnt lgkmcnt(0)
v_or_b32 v172, v144, v145
v_pk_mul_f16 v173, v155, v154
v_pk_mul_f16 v174, v152, v151
v_pk_mul_f16 v175, v149, v148
s_cmp_eq_u32 s77, 0
s_cbranch_scc1 Lpp49
s_getreg_b32 s43, hwreg(HW_REG_IB_STS, 0, 4)
s_cmp_lg_u32 s43, 0
s_cbranch_scc1 Lpp49
s_call_b64 s[78:79], Lpoll
s_setprio 0
Lpp49:
s_setprio 2
v_cvt_pkrtz_f16_f32 v137, v120, v121
v_cvt_pkrtz_f16_f32 v139, v122, v123
v_cvt_pkrtz_f16_f32 v141, v124, v125
v_cvt_pkrtz_f16_f32 v143, v126, v127
v_cvt_pkrtz_f16_f32 v145, v128, v129
v_cvt_pk_f16_f32 v155, v130, v131
v_cvt_pk_f16_f32 v152, v132, v133
v_cvt_pk_f16_f32 v149, v134, v135
ds_read_b128 v[228:231], v248 offset:57344
v_mfma_f32_32x32x16_bf16 v[120:135], v[232:235], v[96:99], 0
v_pk_fma_f16 v154, v155, v155, s48
v_and_b32_e64 v137, s49, v137
v_pk_fma_f16 v151, v152, v152, s48
v_and_b32_e64 v139, s49, v139
v_pk_fma_f16 v148, v149, v149, s48
v_pk_mul_f16 v154, v155, v154
v_bfe_u32 v136, v137, 2, 14
v_pk_mul_f16 v151, v152, v151
ds_read_b128 v[232:235], v248 offset:55296
ds_read_u16_d16 v136, v136
v_mfma_f32_32x32x16_bf16 v[120:135], v[236:239], v[100:103], v[120:135]
v_pk_mul_f16 v148, v149, v148
v_bfe_u32 v138, v139, 2, 14
v_exp_f16 v153, v154
v_lshrrev_b32 v137, 18, v137
v_exp_f16 v150, v151
v_lshrrev_b32 v139, 18, v139
ds_read_b128 v[236:239], v248 offset:58368
ds_read_u16_d16 v138, v138
ds_read_u16_d16_hi v137, v137
ds_read_u16_d16_hi v139, v139
v_mfma_f32_32x32x16_bf16 v[120:135], v[224:227], v[104:107], v[120:135]
v_exp_f16 v147, v148
v_and_b32 v141, s49, v141
v_and_b32 v143, s49, v143
v_exp_f16_sdwa v153, v154 dst_sel:WORD_1 dst_unused:UNUSED_PRESERVE src0_sel:WORD_1
v_bfe_u32 v140, v141, 2, 14
v_exp_f16_sdwa v150, v151 dst_sel:WORD_1 dst_unused:UNUSED_PRESERVE src0_sel:WORD_1
s_waitcnt lgkmcnt(6)
ds_read_b128 v[224:227], v248 offset:59392
ds_read_u16_d16 v140, v140
v_mfma_f32_32x32x16_bf16 v[120:135], v[228:231], v[108:111], v[120:135]
v_bfe_u32 v142, v143, 2, 14
v_exp_f16_sdwa v147, v148 dst_sel:WORD_1 dst_unused:UNUSED_PRESERVE src0_sel:WORD_1
v_lshrrev_b32_e64 v141, 18, v141
v_pk_add_f16 v153, v153, 1.0 op_sel_hi:[1,0]
v_lshrrev_b32 v143, 18, v143
v_pk_add_f16 v150, v150, 1.0 op_sel_hi:[1,0]
v_pk_add_f16 v147, v147, 1.0 op_sel_hi:[1,0]
s_waitcnt lgkmcnt(6)
ds_read_b128 v[228:231], v248 offset:62464
ds_read_u16_d16 v142, v142
ds_read_u16_d16_hi v141, v141
ds_read_u16_d16_hi v143, v143
v_mfma_f32_32x32x16_bf16 v[120:135], v[232:235], v[112:115], v[120:135]
v_and_b32 v145, s49, v145
v_rcp_f16 v154, v153
v_bfe_u32 v144, v145, 2, 14
v_rcp_f16_e64 v151, v150
v_lshrrev_b32 v145, 18, v145
s_waitcnt lgkmcnt(6)
ds_read_b128 v[232:235], v248 offset:60416
ds_read_u16_d16 v144, v144
ds_read_u16_d16_hi v145, v145
v_mfma_f32_32x32x16_bf16 v[120:135], v[236:239], v[116:119], v[120:135]
v_rcp_f16 v148, v147
v_or_b32 v176, v136, v137
v_or_b32_e64 v177, v138, v139
v_rcp_f16_sdwa v154, v153 dst_sel:WORD_1 dst_unused:UNUSED_PRESERVE src0_sel:WORD_1
s_waitcnt lgkmcnt(4)
v_or_b32 v178, v140, v141
v_rcp_f16_sdwa v151, v150 dst_sel:WORD_1 dst_unused:UNUSED_PRESERVE src0_sel:WORD_1
s_waitcnt lgkmcnt(3)
v_or_b32 v179, v142, v143
v_rcp_f16_sdwa v148, v147 dst_sel:WORD_1 dst_unused:UNUSED_PRESERVE src0_sel:WORD_1
s_waitcnt lgkmcnt(0)
v_or_b32 v180, v144, v145
v_pk_mul_f16 v181, v155, v154
v_pk_mul_f16 v182, v152, v151
v_pk_mul_f16 v183, v149, v148
s_cmp_eq_u32 s77, 0
s_cbranch_scc1 Lpp50
s_getreg_b32 s43, hwreg(HW_REG_IB_STS, 0, 4)
s_cmp_lg_u32 s43, 0
s_cbranch_scc1 Lpp50
s_call_b64 s[78:79], Lpoll
s_setprio 2
Lpp50:
s_setprio 1
v_cvt_pkrtz_f16_f32 v137, v120, v121
v_cvt_pkrtz_f16_f32 v139, v122, v123
v_cvt_pkrtz_f16_f32 v141, v124, v125
v_cvt_pkrtz_f16_f32 v143, v126, v127
v_cvt_pkrtz_f16_f32 v145, v128, v129
v_cvt_pk_f16_f32 v155, v130, v131
v_cvt_pk_f16_f32 v152, v132, v133
v_cvt_pk_f16_f32 v149, v134, v135
ds_read_b128 v[236:239], v248 offset:63488
v_mfma_f32_32x32x16_bf16 v[120:135], v[224:227], v[96:99], 0
v_pk_fma_f16 v154, v155, v155, s48
v_and_b32_e64 v137, s49, v137
v_pk_fma_f16 v151, v152, v152, s48
v_and_b32_e64 v139, s49, v139
v_pk_fma_f16 v148, v149, v149, s48
v_pk_mul_f16 v154, v155, v154
v_bfe_u32 v136, v137, 2, 14
v_pk_mul_f16 v151, v152, v151
ds_read_b128 v[224:227], v248 offset:61440
ds_read_u16_d16 v136, v136
v_mfma_f32_32x32x16_bf16 v[120:135], v[228:231], v[100:103], v[120:135]
v_pk_mul_f16 v148, v149, v148
v_bfe_u32 v138, v139, 2, 14
v_exp_f16 v153, v154
v_lshrrev_b32 v137, 18, v137
v_exp_f16 v150, v151
v_lshrrev_b32 v139, 18, v139
ds_read_b128 v[228:231], v248 offset:64512
ds_read_u16_d16 v138, v138
ds_read_u16_d16_hi v137, v137
ds_read_u16_d16_hi v139, v139
v_mfma_f32_32x32x16_bf16 v[120:135], v[232:235], v[104:107], v[120:135]
v_exp_f16 v147, v148
v_and_b32 v141, s49, v141
v_and_b32 v143, s49, v143
v_exp_f16_sdwa v153, v154 dst_sel:WORD_1 dst_unused:UNUSED_PRESERVE src0_sel:WORD_1
v_bfe_u32 v140, v141, 2, 14
v_exp_f16_sdwa v150, v151 dst_sel:WORD_1 dst_unused:UNUSED_PRESERVE src0_sel:WORD_1
s_waitcnt lgkmcnt(6)
ds_read_b128 v[232:235], v249
ds_read_u16_d16 v140, v140
v_mfma_f32_32x32x16_bf16 v[120:135], v[236:239], v[108:111], v[120:135]
v_bfe_u32 v142, v143, 2, 14
v_exp_f16_sdwa v147, v148 dst_sel:WORD_1 dst_unused:UNUSED_PRESERVE src0_sel:WORD_1
v_lshrrev_b32_e64 v141, 18, v141
v_pk_add_f16 v153, v153, 1.0 op_sel_hi:[1,0]
v_lshrrev_b32 v143, 18, v143
v_pk_add_f16 v150, v150, 1.0 op_sel_hi:[1,0]
v_pk_add_f16 v147, v147, 1.0 op_sel_hi:[1,0]
s_waitcnt lgkmcnt(6)
ds_read_b128 v[236:239], v249 offset:3072
ds_read_u16_d16 v142, v142
ds_read_u16_d16_hi v141, v141
ds_read_u16_d16_hi v143, v143
v_mfma_f32_32x32x16_bf16 v[120:135], v[224:227], v[112:115], v[120:135]
v_and_b32 v145, s49, v145
v_rcp_f16 v154, v153
v_bfe_u32 v144, v145, 2, 14
s_setprio 0
v_rcp_f16 v151, v150
v_lshrrev_b32 v145, 18, v145
s_waitcnt lgkmcnt(6)
ds_read_b128 v[224:227], v249 offset:1024
ds_read_u16_d16 v144, v144
ds_read_u16_d16_hi v145, v145
v_mfma_f32_32x32x16_bf16 v[120:135], v[228:231], v[116:119], v[120:135]
v_rcp_f16 v148, v147
v_or_b32 v184, v136, v137
v_or_b32_e64 v185, v138, v139
v_rcp_f16_sdwa v154, v153 dst_sel:WORD_1 dst_unused:UNUSED_PRESERVE src0_sel:WORD_1
s_waitcnt lgkmcnt(4)
v_or_b32 v186, v140, v141
v_rcp_f16_sdwa v151, v150 dst_sel:WORD_1 dst_unused:UNUSED_PRESERVE src0_sel:WORD_1
s_waitcnt lgkmcnt(3)
v_or_b32 v187, v142, v143
v_rcp_f16_sdwa v148, v147 dst_sel:WORD_1 dst_unused:UNUSED_PRESERVE src0_sel:WORD_1
s_waitcnt lgkmcnt(0)
v_or_b32_e64 v188, v144, v145
v_pk_mul_f16 v189, v155, v154
v_pk_mul_f16 v190, v152, v151
v_pk_mul_f16 v191, v149, v148
s_cmp_eq_u32 s77, 0
s_cbranch_scc1 Lpp51
s_getreg_b32 s43, hwreg(HW_REG_IB_STS, 0, 4)
s_cmp_lg_u32 s43, 0
s_cbranch_scc1 Lpp51
s_call_b64 s[78:79], Lpoll
s_setprio 0
Lpp51:
v_mov_b32 v253, 16256
Lw2w:
ds_read_b32 v254, v253 offset:4
s_waitcnt lgkmcnt(0)
v_readfirstlane_b32 s43, v254
s_cmp_eq_u32 s76, 0
s_cbranch_scc1 Lw2x
s_sub_u32 s76, s76, 1
s_cmp_lt_u32 s43, 1
s_cbranch_scc0 Lw2x
s_sleep 2
s_branch Lw2w
Lw2x:
s_add_u32 m0, s72, 7168
s_add_u32 s43, s82, 6208
buffer_load_dwordx4 v252, s[16:19], s43 offen lds
s_add_u32 m0, s72, 8192
s_add_u32 s43, s82, 6272
buffer_load_dwordx4 v252, s[16:19], s43 offen lds
s_setprio 2
v_cvt_pkrtz_f16_f32 v137, v120, v121
v_cvt_pkrtz_f16_f32 v139, v122, v123
v_cvt_pkrtz_f16_f32 v141, v124, v125
v_cvt_pkrtz_f16_f32 v143, v126, v127
v_cvt_pkrtz_f16_f32 v145, v128, v129
v_cvt_pk_f16_f32 v155, v130, v131
v_cvt_pk_f16_f32 v152, v132, v133
v_cvt_pk_f16_f32 v149, v134, v135
ds_read_b128 v[228:231], v249 offset:4096
v_mfma_f32_32x32x16_bf16 v[120:135], v[232:235], v[96:99], 0
v_pk_fma_f16 v154, v155, v155, s48
v_and_b32_e64 v137, s49, v137
v_pk_fma_f16 v151, v152, v152, s48
v_and_b32_e64 v139, s49, v139
v_pk_fma_f16 v148, v149, v149, s48
v_pk_mul_f16 v154, v155, v154
v_bfe_u32 v136, v137, 2, 14
v_pk_mul_f16 v151, v152, v151
ds_read_b128 v[232:235], v249 offset:2048
ds_read_u16_d16 v136, v136
v_mfma_f32_32x32x16_bf16 v[120:135], v[236:239], v[100:103], v[120:135]
v_pk_mul_f16 v148, v149, v148
v_bfe_u32 v138, v139, 2, 14
v_exp_f16 v153, v154
v_lshrrev_b32 v137, 18, v137
v_exp_f16 v150, v151
v_lshrrev_b32 v139, 18, v139
ds_read_b128 v[236:239], v249 offset:5120
ds_read_u16_d16 v138, v138
ds_read_u16_d16_hi v137, v137
ds_read_u16_d16_hi v139, v139
v_mfma_f32_32x32x16_bf16 v[120:135], v[224:227], v[104:107], v[120:135]
v_exp_f16 v147, v148
v_and_b32 v141, s49, v141
v_and_b32 v143, s49, v143
v_exp_f16_sdwa v153, v154 dst_sel:WORD_1 dst_unused:UNUSED_PRESERVE src0_sel:WORD_1
v_bfe_u32 v140, v141, 2, 14
v_exp_f16_sdwa v150, v151 dst_sel:WORD_1 dst_unused:UNUSED_PRESERVE src0_sel:WORD_1
s_waitcnt lgkmcnt(6)
ds_read_b128 v[224:227], v249 offset:6144
ds_read_u16_d16 v140, v140
v_mfma_f32_32x32x16_bf16 v[120:135], v[228:231], v[108:111], v[120:135]
v_bfe_u32 v142, v143, 2, 14
v_exp_f16_sdwa v147, v148 dst_sel:WORD_1 dst_unused:UNUSED_PRESERVE src0_sel:WORD_1
v_lshrrev_b32_e64 v141, 18, v141
v_pk_add_f16 v153, v153, 1.0 op_sel_hi:[1,0]
v_lshrrev_b32 v143, 18, v143
v_pk_add_f16 v150, v150, 1.0 op_sel_hi:[1,0]
v_pk_add_f16 v147, v147, 1.0 op_sel_hi:[1,0]
s_waitcnt lgkmcnt(6)
ds_read_b128 v[228:231], v249 offset:9216
ds_read_u16_d16 v142, v142
ds_read_u16_d16_hi v141, v141
ds_read_u16_d16_hi v143, v143
v_mfma_f32_32x32x16_bf16 v[120:135], v[232:235], v[112:115], v[120:135]
v_and_b32 v145, s49, v145
v_rcp_f16 v154, v153
v_bfe_u32 v144, v145, 2, 14
v_rcp_f16_e64 v151, v150
v_lshrrev_b32 v145, 18, v145
s_waitcnt lgkmcnt(6)
ds_read_b128 v[232:235], v249 offset:7168
ds_read_u16_d16 v144, v144
ds_read_u16_d16_hi v145, v145
v_mfma_f32_32x32x16_bf16 v[120:135], v[236:239], v[116:119], v[120:135]
v_rcp_f16 v148, v147
v_or_b32 v192, v136, v137
v_or_b32_e64 v193, v138, v139
v_rcp_f16_sdwa v154, v153 dst_sel:WORD_1 dst_unused:UNUSED_PRESERVE src0_sel:WORD_1
s_waitcnt lgkmcnt(4)
v_or_b32 v194, v140, v141
v_rcp_f16_sdwa v151, v150 dst_sel:WORD_1 dst_unused:UNUSED_PRESERVE src0_sel:WORD_1
s_waitcnt lgkmcnt(3)
v_or_b32 v195, v142, v143
v_rcp_f16_sdwa v148, v147 dst_sel:WORD_1 dst_unused:UNUSED_PRESERVE src0_sel:WORD_1
s_waitcnt lgkmcnt(0)
v_or_b32 v196, v144, v145
v_pk_mul_f16 v197, v155, v154
v_pk_mul_f16 v198, v152, v151
v_pk_mul_f16 v199, v149, v148
s_cmp_eq_u32 s77, 0
s_cbranch_scc1 Lpp52
s_getreg_b32 s43, hwreg(HW_REG_IB_STS, 0, 4)
s_cmp_lg_u32 s43, 0
s_cbranch_scc1 Lpp52
s_call_b64 s[78:79], Lpoll
s_setprio 2
Lpp52:
s_setprio 1
v_cvt_pkrtz_f16_f32 v137, v120, v121
v_cvt_pkrtz_f16_f32 v139, v122, v123
v_cvt_pkrtz_f16_f32 v141, v124, v125
v_cvt_pkrtz_f16_f32 v143, v126, v127
v_cvt_pkrtz_f16_f32 v145, v128, v129
v_cvt_pk_f16_f32 v155, v130, v131
v_cvt_pk_f16_f32 v152, v132, v133
v_cvt_pk_f16_f32 v149, v134, v135
ds_read_b128 v[236:239], v249 offset:10240
v_mfma_f32_32x32x16_bf16 v[120:135], v[224:227], v[96:99], 0
v_pk_fma_f16 v154, v155, v155, s48
v_and_b32_e64 v137, s49, v137
v_pk_fma_f16 v151, v152, v152, s48
v_and_b32_e64 v139, s49, v139
v_pk_fma_f16 v148, v149, v149, s48
v_pk_mul_f16 v154, v155, v154
v_bfe_u32 v136, v137, 2, 14
v_pk_mul_f16 v151, v152, v151
ds_read_b128 v[224:227], v249 offset:8192
ds_read_u16_d16 v136, v136
v_mfma_f32_32x32x16_bf16 v[120:135], v[228:231], v[100:103], v[120:135]
v_pk_mul_f16 v148, v149, v148
v_bfe_u32 v138, v139, 2, 14
v_exp_f16 v153, v154
v_lshrrev_b32 v137, 18, v137
v_exp_f16 v150, v151
v_lshrrev_b32 v139, 18, v139
ds_read_b128 v[228:231], v249 offset:11264
ds_read_u16_d16 v138, v138
ds_read_u16_d16_hi v137, v137
ds_read_u16_d16_hi v139, v139
v_mfma_f32_32x32x16_bf16 v[120:135], v[232:235], v[104:107], v[120:135]
v_exp_f16 v147, v148
v_and_b32 v141, s49, v141
v_and_b32 v143, s49, v143
v_exp_f16_sdwa v153, v154 dst_sel:WORD_1 dst_unused:UNUSED_PRESERVE src0_sel:WORD_1
v_bfe_u32 v140, v141, 2, 14
v_exp_f16_sdwa v150, v151 dst_sel:WORD_1 dst_unused:UNUSED_PRESERVE src0_sel:WORD_1
s_waitcnt lgkmcnt(6)
ds_read_u16_d16 v140, v140
v_mfma_f32_32x32x16_bf16 v[120:135], v[236:239], v[108:111], v[120:135]
v_bfe_u32 v142, v143, 2, 14
v_exp_f16_sdwa v147, v148 dst_sel:WORD_1 dst_unused:UNUSED_PRESERVE src0_sel:WORD_1
v_lshrrev_b32_e64 v141, 18, v141
v_pk_add_f16 v153, v153, 1.0 op_sel_hi:[1,0]
v_lshrrev_b32 v143, 18, v143
v_pk_add_f16 v150, v150, 1.0 op_sel_hi:[1,0]
v_pk_add_f16 v147, v147, 1.0 op_sel_hi:[1,0]
s_waitcnt lgkmcnt(5)
ds_read_u16_d16 v142, v142
ds_read_u16_d16_hi v141, v141
ds_read_u16_d16_hi v143, v143
v_mfma_f32_32x32x16_bf16 v[120:135], v[224:227], v[112:115], v[120:135]
v_and_b32 v145, s49, v145
v_rcp_f16 v154, v153
v_bfe_u32 v144, v145, 2, 14
s_setprio 0
v_rcp_f16 v151, v150
v_lshrrev_b32 v145, 18, v145
s_waitcnt lgkmcnt(4)
ds_read_u16_d16 v144, v144
ds_read_u16_d16_hi v145, v145
v_mfma_f32_32x32x16_bf16 v[120:135], v[228:231], v[116:119], v[120:135]
v_rcp_f16 v148, v147
v_or_b32 v200, v136, v137
v_or_b32_e64 v201, v138, v139
v_rcp_f16_sdwa v154, v153 dst_sel:WORD_1 dst_unused:UNUSED_PRESERVE src0_sel:WORD_1
s_waitcnt lgkmcnt(3)
v_or_b32 v202, v140, v141
v_rcp_f16_sdwa v151, v150 dst_sel:WORD_1 dst_unused:UNUSED_PRESERVE src0_sel:WORD_1
s_waitcnt lgkmcnt(2)
v_or_b32 v203, v142, v143
v_rcp_f16_sdwa v148, v147 dst_sel:WORD_1 dst_unused:UNUSED_PRESERVE src0_sel:WORD_1
s_waitcnt lgkmcnt(0)
v_or_b32 v204, v144, v145
v_pk_mul_f16 v205, v155, v154
v_pk_mul_f16 v206, v152, v151
v_pk_mul_f16 v207, v149, v148
s_cmp_eq_u32 s77, 0
s_cbranch_scc1 Lpp53
s_getreg_b32 s43, hwreg(HW_REG_IB_STS, 0, 4)
s_cmp_lg_u32 s43, 0
s_cbranch_scc1 Lpp53
s_call_b64 s[78:79], Lpoll
s_setprio 0
Lpp53:
s_setprio 2
v_cvt_pkrtz_f16_f32 v137, v120, v121
v_cvt_pkrtz_f16_f32 v139, v122, v123
v_cvt_pkrtz_f16_f32 v141, v124, v125
v_cvt_pkrtz_f16_f32 v143, v126, v127
v_cvt_pkrtz_f16_f32 v145, v128, v129
v_cvt_pk_f16_f32 v155, v130, v131
v_cvt_pk_f16_f32 v152, v132, v133
v_cvt_pk_f16_f32 v149, v134, v135
v_pk_fma_f16 v154, v155, v155, s48
v_and_b32_e64 v137, s49, v137
v_pk_fma_f16 v151, v152, v152, s48
v_and_b32_e64 v139, s49, v139
v_pk_fma_f16 v148, v149, v149, s48
v_pk_mul_f16 v154, v155, v154
v_bfe_u32 v136, v137, 2, 14
v_pk_mul_f16 v151, v152, v151
v_pk_mul_f16 v148, v149, v148
v_bfe_u32 v138, v139, 2, 14
v_exp_f16 v153, v154
v_lshrrev_b32 v137, 18, v137
v_exp_f16 v150, v151
v_lshrrev_b32 v139, 18, v139
v_exp_f16 v147, v148
v_and_b32 v141, s49, v141
v_and_b32_e64 v143, s49, v143
ds_read_u16_d16 v136, v136
ds_read_u16_d16 v138, v138
ds_read_u16_d16_hi v137, v137
ds_read_u16_d16_hi v139, v139
v_exp_f16_sdwa v153, v154 dst_sel:WORD_1 dst_unused:UNUSED_PRESERVE src0_sel:WORD_1
v_bfe_u32 v140, v141, 2, 14
v_exp_f16_sdwa v150, v151 dst_sel:WORD_1 dst_unused:UNUSED_PRESERVE src0_sel:WORD_1
s_setprio 1
v_bfe_u32 v142, v143, 2, 14
v_exp_f16_sdwa v147, v148 dst_sel:WORD_1 dst_unused:UNUSED_PRESERVE src0_sel:WORD_1
v_lshrrev_b32 v141, 18, v141
v_pk_add_f16 v153, v153, 1.0 op_sel_hi:[1,0]
v_lshrrev_b32_e64 v143, 18, v143
v_pk_add_f16 v150, v150, 1.0 op_sel_hi:[1,0]
v_pk_add_f16 v147, v147, 1.0 op_sel_hi:[1,0]
v_and_b32 v145, s49, v145
v_rcp_f16 v154, v153
v_bfe_u32 v144, v145, 2, 14
v_rcp_f16 v151, v150
v_lshrrev_b32 v145, 18, v145
ds_read_u16_d16 v140, v140
ds_read_u16_d16 v142, v142
ds_read_u16_d16_hi v141, v141
ds_read_u16_d16_hi v143, v143
ds_read_u16_d16 v144, v144
ds_read_u16_d16_hi v145, v145
v_rcp_f16 v148, v147
s_waitcnt lgkmcnt(7)
v_or_b32 v232, v136, v137
s_waitcnt lgkmcnt(6)
v_or_b32 v233, v138, v139
v_rcp_f16_sdwa v154, v153 dst_sel:WORD_1 dst_unused:UNUSED_PRESERVE src0_sel:WORD_1
s_waitcnt lgkmcnt(3)
v_or_b32 v234, v140, v141
s_setprio 0
v_rcp_f16_sdwa v151, v150 dst_sel:WORD_1 dst_unused:UNUSED_PRESERVE src0_sel:WORD_1
s_waitcnt lgkmcnt(2)
v_or_b32 v235, v142, v143
v_rcp_f16_sdwa v148, v147 dst_sel:WORD_1 dst_unused:UNUSED_PRESERVE src0_sel:WORD_1
s_waitcnt lgkmcnt(0)
v_or_b32 v236, v144, v145
v_pk_mul_f16 v237, v155, v154
v_pk_mul_f16 v238, v152, v151
v_pk_mul_f16 v239, v149, v148
s_cmp_eq_u32 s77, 0
s_cbranch_scc1 Lpp54
s_getreg_b32 s43, hwreg(HW_REG_IB_STS, 0, 4)
s_cmp_lg_u32 s43, 0
s_cbranch_scc1 Lpp54
s_call_b64 s[78:79], Lpoll
s_setprio 0
Lpp54:
s_setprio 2
v_lshrrev_b32_e64 v225, 5, v251
v_lshl_add_u32 v224, v225, 9, s72
v_lshl_add_u32 v226, v225, 4, s72
v_and_b32 v225, 15, v251
v_lshl_add_u32 v224, v225, 4, v224
v_bfe_u32 v225, v251, 4, 1
v_lshl_add_u32 v224, v225, 3, v224
s_waitcnt vmcnt(0)
ds_read_b64_tr_b16 v[120:121], v224
ds_read_b64_tr_b16 v[122:123], v224 offset:256
ds_read_b64_tr_b16 v[124:125], v224 offset:1024
ds_read_b64_tr_b16 v[126:127], v224 offset:1280
ds_read_b64_tr_b16 v[128:129], v224 offset:2048
ds_read_b64_tr_b16 v[130:131], v224 offset:2304
ds_read_b64_tr_b16 v[132:133], v224 offset:3072
ds_read_b64_tr_b16 v[134:135], v224 offset:3328
ds_read_b64_tr_b16 v[136:137], v224 offset:4096
ds_read_b64_tr_b16 v[138:139], v224 offset:4352
ds_read_b64_tr_b16 v[140:141], v224 offset:5120
ds_read_b64_tr_b16 v[142:143], v224 offset:5376
ds_read_b64_tr_b16 v[144:145], v224 offset:6144
ds_read_b64_tr_b16 v[146:147], v224 offset:6400
ds_read_b64_tr_b16 v[148:149], v224 offset:7168
ds_read_b64_tr_b16 v[150:151], v224 offset:7424
ds_read_b64_tr_b16 v[152:153], v224 offset:8192
ds_read_b64_tr_b16 v[154:155], v224 offset:8448
v_lshrrev_b32 v225, 4, v251
v_and_b32 v227, 15, v251
v_mul_u32_u24 v252, 192, v227
v_lshl_add_u32 v252, v225, 4, v252
v_lshlrev_b32 v254, 5, v225
v_and_b32 v253, 47, v251
v_lshlrev_b32 v253, 4, v253
v_and_b32 v225, 1, v225
v_mul_u32_u24 v227, 3072, v225
v_add_u32_e64 v248, v227, v253
v_add_u32 v249, 65536, v248
v_add_u32 v250, 131072, v248
v_lshl_add_u32 v253, v225, 21, v253
v_mov_b32 v225, 16256
v_mov_b32_e64 v227, 1
v_permlane16_swap_b32 v0, v4
v_permlane16_swap_b32 v1, v5
v_permlane16_swap_b32 v2, v6
v_permlane16_swap_b32 v3, v7
v_permlane16_swap_b32 v8, v12
v_permlane16_swap_b32 v9, v13
v_permlane16_swap_b32 v10, v14
v_permlane16_swap_b32 v11, v15
s_waitcnt lgkmcnt(0)
s_mov_b64 exec, 1
ds_add_u32 v225, v227 offset:8
s_mov_b64 exec, -1
v_lshlrev_b32 v228, 16, v120
v_and_b32 v229, 4294901760, v120
v_cvt_pk_f16_f32 v120, v228, v229
v_lshlrev_b32_e64 v230, 16, v121
v_and_b32 v231, 4294901760, v121
v_cvt_pk_f16_f32 v121, v230, v231
v_lshlrev_b32_e64 v228, 16, v122
v_and_b32 v229, 4294901760, v122
v_cvt_pk_f16_f32 v122, v228, v229
v_lshlrev_b32_e64 v230, 16, v123
v_and_b32 v231, 4294901760, v123
v_cvt_pk_f16_f32 v123, v230, v231
v_lshlrev_b32_e64 v228, 16, v124
v_and_b32 v229, 4294901760, v124
v_cvt_pk_f16_f32 v124, v228, v229
v_lshlrev_b32_e64 v230, 16, v125
v_and_b32 v231, 4294901760, v125
v_cvt_pk_f16_f32 v125, v230, v231
v_lshlrev_b32_e64 v228, 16, v126
v_and_b32 v229, 4294901760, v126
v_cvt_pk_f16_f32 v126, v228, v229
v_lshlrev_b32_e64 v230, 16, v127
v_and_b32 v231, 4294901760, v127
v_cvt_pk_f16_f32 v127, v230, v231
v_lshlrev_b32_e64 v228, 16, v128
v_and_b32 v229, 4294901760, v128
v_cvt_pk_f16_f32 v128, v228, v229
v_lshlrev_b32_e64 v230, 16, v129
v_and_b32 v231, 4294901760, v129
v_cvt_pk_f16_f32 v129, v230, v231
v_lshlrev_b32_e64 v228, 16, v130
v_and_b32 v229, 4294901760, v130
v_cvt_pk_f16_f32 v130, v228, v229
v_lshlrev_b32_e64 v230, 16, v131
v_and_b32 v231, 4294901760, v131
v_cvt_pk_f16_f32 v131, v230, v231
s_cmp_eq_u32 s77, 0
s_cbranch_scc1 Lpp911
s_getreg_b32 s43, hwreg(HW_REG_IB_STS, 0, 4)
s_cmp_lg_u32 s43, 0
s_cbranch_scc1 Lpp911
s_call_b64 s[78:79], Lpoll
s_setprio 2
Lpp911:
v_lshlrev_b32 v228, 16, v132
v_and_b32 v229, 4294901760, v132
v_cvt_pk_f16_f32 v132, v228, v229
v_lshlrev_b32_e64 v230, 16, v133
v_and_b32 v231, 4294901760, v133
v_cvt_pk_f16_f32 v133, v230, v231
v_lshlrev_b32_e64 v228, 16, v134
v_and_b32 v229, 4294901760, v134
v_cvt_pk_f16_f32 v134, v228, v229
v_lshlrev_b32_e64 v230, 16, v135
v_and_b32 v231, 4294901760, v135
v_cvt_pk_f16_f32 v135, v230, v231
v_lshlrev_b32_e64 v228, 16, v136
v_and_b32 v229, 4294901760, v136
v_cvt_pk_f16_f32 v136, v228, v229
v_lshlrev_b32_e64 v230, 16, v137
v_and_b32 v231, 4294901760, v137
v_cvt_pk_f16_f32 v137, v230, v231
v_lshlrev_b32_e64 v228, 16, v138
v_and_b32 v229, 4294901760, v138
v_cvt_pk_f16_f32 v138, v228, v229
v_lshlrev_b32_e64 v230, 16, v139
v_and_b32 v231, 4294901760, v139
v_cvt_pk_f16_f32 v139, v230, v231
v_lshlrev_b32_e64 v228, 16, v140
v_and_b32 v229, 4294901760, v140
v_cvt_pk_f16_f32 v140, v228, v229
v_lshlrev_b32_e64 v230, 16, v141
v_and_b32 v231, 4294901760, v141
v_cvt_pk_f16_f32 v141, v230, v231
v_lshlrev_b32_e64 v228, 16, v142
v_and_b32 v229, 4294901760, v142
v_cvt_pk_f16_f32 v142, v228, v229
v_lshlrev_b32_e64 v230, 16, v143
v_and_b32 v231, 4294901760, v143
v_cvt_pk_f16_f32 v143, v230, v231
s_cmp_eq_u32 s77, 0
s_cbranch_scc1 Lpp923
s_getreg_b32 s43, hwreg(HW_REG_IB_STS, 0, 4)
s_cmp_lg_u32 s43, 0
s_cbranch_scc1 Lpp923
s_call_b64 s[78:79], Lpoll
s_setprio 2
Lpp923:
v_lshlrev_b32 v228, 16, v144
v_and_b32 v229, 4294901760, v144
v_cvt_pk_f16_f32 v144, v228, v229
v_lshlrev_b32_e64 v230, 16, v145
v_and_b32 v231, 4294901760, v145
v_cvt_pk_f16_f32 v145, v230, v231
v_lshlrev_b32_e64 v228, 16, v146
v_and_b32 v229, 4294901760, v146
v_cvt_pk_f16_f32 v146, v228, v229
v_lshlrev_b32_e64 v230, 16, v147
v_and_b32 v231, 4294901760, v147
v_cvt_pk_f16_f32 v147, v230, v231
v_lshlrev_b32_e64 v228, 16, v148
v_and_b32 v229, 4294901760, v148
v_cvt_pk_f16_f32 v148, v228, v229
v_lshlrev_b32_e64 v230, 16, v149
v_and_b32 v231, 4294901760, v149
v_cvt_pk_f16_f32 v149, v230, v231
v_lshlrev_b32_e64 v228, 16, v150
v_and_b32 v229, 4294901760, v150
v_cvt_pk_f16_f32 v150, v228, v229
v_lshlrev_b32_e64 v230, 16, v151
v_and_b32 v231, 4294901760, v151
v_cvt_pk_f16_f32 v151, v230, v231
v_lshlrev_b32_e64 v228, 16, v152
v_and_b32 v229, 4294901760, v152
v_cvt_pk_f16_f32 v152, v228, v229
v_lshlrev_b32_e64 v230, 16, v153
v_and_b32 v231, 4294901760, v153
v_cvt_pk_f16_f32 v153, v230, v231
v_lshlrev_b32_e64 v228, 16, v154
v_and_b32 v229, 4294901760, v154
v_cvt_pk_f16_f32 v154, v228, v229
v_lshlrev_b32_e64 v230, 16, v155
v_and_b32 v231, 4294901760, v155
v_cvt_pk_f16_f32 v155, v230, v231
s_cmp_eq_u32 s77, 0
s_cbranch_scc1 Lpp935
s_getreg_b32 s43, hwreg(HW_REG_IB_STS, 0, 4)
s_cmp_lg_u32 s43, 0
s_cbranch_scc1 Lpp935
s_call_b64 s[78:79], Lpoll
s_setprio 2
Lpp935:
v_lshl_add_u32 v224, v251, 4, s72
v_add_u32 v228, 0, v251
v_mul_u32_u24 v231, 2731, v228
v_lshrrev_b32_e64 v231, 16, v231
v_mul_u32_u24 v231, 9120, v231
v_lshl_add_u32 v228, v228, 2, v231
v_add_u32 v228, 90112, v228
v_add_u32_e64 v229, 64, v251
v_mul_u32_u24 v231, 2731, v229
v_lshrrev_b32_e64 v231, 16, v231
v_mul_u32_u24 v231, 9120, v231
v_lshl_add_u32 v229, v229, 2, v231
v_add_u32 v229, 90112, v229
v_add_u32 v230, 128, v251
v_mul_u32_u24 v231, 2731, v230
v_lshrrev_b32 v231, 16, v231
v_mul_u32_u24 v231, 9120, v231
v_lshl_add_u32 v230, v230, 2, v231
v_add_u32 v230, 90112, v230
Lspin:
s_cmp_eq_u32 s77, 0
s_cbranch_scc1 Lspinx
s_cmp_eq_u32 s76, 0
s_cbranch_scc1 Lspinx
s_sub_u32 s76, s76, 1
s_call_b64 s[78:79], Lpoll
s_branch Lspin
Lspinx:
s_cmp_lg_u32 s40, 0
s_cbranch_scc1 Lnofin
v_mov_b32 v165, 16256
Lrrw:
ds_read_b32 v166, v165 offset:8
s_waitcnt lgkmcnt(0)
v_readfirstlane_b32 s43, v166
s_cmp_eq_u32 s76, 0
s_cbranch_scc1 Lrrx
s_sub_u32 s76, s76, 1
s_cmp_lt_u32 s43, 8
s_cbranch_scc0 Lrrx
s_sleep 2
s_branch Lrrw
Lrrx:
ds_write_b32 v228, v244
ds_write_b32 v229, v245
ds_write_b32 v230, v246
Lnofin:
s_waitcnt lgkmcnt(0)
s_barrier
ds_read_b128 v[156:159], v226
ds_read_b128 v[160:163], v226 offset:32
ds_read_b128 v[164:167], v226 offset:64
s_waitcnt lgkmcnt(0)
v_pk_mul_f16 v120, v120, v156
v_pk_mul_f16 v121, v121, v157
v_pk_mul_f16 v122, v122, v158
v_pk_mul_f16 v123, v123, v159
ds_write_b128 v224, v[120:123]
v_pk_mul_f16 v124, v124, v156
v_pk_mul_f16 v125, v125, v157
v_pk_mul_f16 v126, v126, v158
v_pk_mul_f16 v127, v127, v159
ds_write_b128 v224, v[124:127] offset:1024
v_pk_mul_f16 v128, v128, v156
v_pk_mul_f16 v129, v129, v157
v_pk_mul_f16 v130, v130, v158
v_pk_mul_f16 v131, v131, v159
ds_write_b128 v224, v[128:131] offset:2048
v_pk_mul_f16 v132, v132, v160
v_pk_mul_f16 v133, v133, v161
v_pk_mul_f16 v134, v134, v162
v_pk_mul_f16 v135, v135, v163
ds_write_b128 v224, v[132:135] offset:3072
v_pk_mul_f16 v136, v136, v160
v_pk_mul_f16 v137, v137, v161
v_pk_mul_f16 v138, v138, v162
v_pk_mul_f16 v139, v139, v163
ds_write_b128 v224, v[136:139] offset:4096
v_pk_mul_f16 v140, v140, v160
v_pk_mul_f16 v141, v141, v161
v_pk_mul_f16 v142, v142, v162
v_pk_mul_f16 v143, v143, v163
ds_write_b128 v224, v[140:143] offset:5120
v_pk_mul_f16 v144, v144, v164
v_pk_mul_f16 v145, v145, v165
v_pk_mul_f16 v146, v146, v166
v_pk_mul_f16 v147, v147, v167
ds_write_b128 v224, v[144:147] offset:6144
v_pk_mul_f16 v148, v148, v164
v_pk_mul_f16 v149, v149, v165
v_pk_mul_f16 v150, v150, v166
v_pk_mul_f16 v151, v151, v167
ds_write_b128 v224, v[148:151] offset:7168
v_pk_mul_f16 v152, v152, v164
v_pk_mul_f16 v153, v153, v165
v_pk_mul_f16 v154, v154, v166
v_pk_mul_f16 v155, v155, v167
ds_write_b128 v224, v[152:155] offset:8192
s_waitcnt lgkmcnt(0)
s_barrier
s_setprio 3
ds_read_b128 v[224:227], v249 offset:24576
ds_read_b128 v[228:231], v254 offset:7936
ds_read_b128 v[240:243], v249 offset:24832
ds_read_b128 v[244:247], v254 offset:7952
s_waitcnt lgkmcnt(2)
v_mfma_f32_16x16x32_f16 v[120:123], v[224:227], v[0:3], v[228:231]
v_mfma_f32_16x16x32_f16 v[128:131], v[224:227], v[4:7], v[228:231]
v_permlane16_swap_b32 v16, v20
s_waitcnt lgkmcnt(0)
v_mfma_f32_16x16x32_f16 v[124:127], v[240:243], v[0:3], v[244:247]
ds_read_b128 v[224:227], v249 offset:25600
ds_read_b128 v[228:231], v254 offset:8064
v_mfma_f32_16x16x32_f16 v[132:135], v[240:243], v[4:7], v[244:247]
v_permlane16_swap_b32 v17, v21
s_waitcnt lgkmcnt(0)
v_mfma_f32_16x16x32_f16 v[136:139], v[224:227], v[0:3], v[228:231]
ds_read_b128 v[240:243], v249 offset:25856
ds_read_b128 v[244:247], v254 offset:8080
v_mfma_f32_16x16x32_f16 v[144:147], v[224:227], v[4:7], v[228:231]
v_permlane16_swap_b32 v18, v22
s_waitcnt lgkmcnt(0)
v_mfma_f32_16x16x32_f16 v[140:143], v[240:243], v[0:3], v[244:247]
ds_read_b128 v[224:227], v249 offset:26624
ds_read_b128 v[228:231], v254 offset:16128
v_mfma_f32_16x16x32_f16 v[148:151], v[240:243], v[4:7], v[244:247]
v_permlane16_swap_b32 v19, v23
s_waitcnt lgkmcnt(0)
v_mfma_f32_16x16x32_f16 v[152:155], v[224:227], v[0:3], v[228:231]
ds_read_b128 v[240:243], v249 offset:26880
ds_read_b128 v[244:247], v254 offset:16144
v_mfma_f32_16x16x32_f16 v[160:163], v[224:227], v[4:7], v[228:231]
v_permlane16_swap_b32 v24, v28
s_waitcnt lgkmcnt(0)
v_mfma_f32_16x16x32_f16 v[156:159], v[240:243], v[0:3], v[244:247]
ds_read_b128 v[224:227], v249 offset:30720
ds_read_b128 v[228:231], v249 offset:30976
v_mfma_f32_16x16x32_f16 v[164:167], v[240:243], v[4:7], v[244:247]
v_permlane16_swap_b32 v25, v29
s_waitcnt lgkmcnt(1)
v_mfma_f32_16x16x32_f16 v[120:123], v[224:227], v[8:11], v[120:123]
ds_read_b128 v[240:243], v249 offset:31744
ds_read_b128 v[244:247], v249 offset:32000
v_mfma_f32_16x16x32_f16 v[128:131], v[224:227], v[12:15], v[128:131]
v_permlane16_swap_b32 v26, v30
s_waitcnt lgkmcnt(2)
v_mfma_f32_16x16x32_f16 v[124:127], v[228:231], v[8:11], v[124:127]
ds_read_b128 v[224:227], v249 offset:32768
v_mfma_f32_16x16x32_f16 v[132:135], v[228:231], v[12:15], v[132:135]
v_permlane16_swap_b32 v27, v31
s_waitcnt lgkmcnt(2)
v_mfma_f32_16x16x32_f16 v[136:139], v[240:243], v[8:11], v[136:139]
ds_read_b128 v[228:231], v249 offset:33024
v_mfma_f32_16x16x32_f16 v[144:147], v[240:243], v[12:15], v[144:147]
v_permlane16_swap_b32 v96, v100
s_waitcnt lgkmcnt(2)
v_mfma_f32_16x16x32_f16 v[140:143], v[244:247], v[8:11], v[140:143]
ds_read_b128 v[240:243], v249 offset:36864
v_mfma_f32_16x16x32_f16 v[148:151], v[244:247], v[12:15], v[148:151]
v_permlane16_swap_b32 v97, v101
s_waitcnt lgkmcnt(2)
v_mfma_f32_16x16x32_f16 v[152:155], v[224:227], v[8:11], v[152:155]
ds_read_b128 v[244:247], v249 offset:37120
v_mfma_f32_16x16x32_f16 v[160:163], v[224:227], v[12:15], v[160:163]
v_permlane16_swap_b32 v98, v102
s_waitcnt lgkmcnt(2)
v_mfma_f32_16x16x32_f16 v[156:159], v[228:231], v[8:11], v[156:159]
ds_read_b128 v[224:227], v249 offset:37888
v_mfma_f32_16x16x32_f16 v[164:167], v[228:231], v[12:15], v[164:167]
v_permlane16_swap_b32 v99, v103
s_waitcnt lgkmcnt(2)
v_mfma_f32_16x16x32_f16 v[120:123], v[240:243], v[16:19], v[120:123]
buffer_load_dwordx4 v[12:15], v252, s[4:7], s71 offen
ds_read_b128 v[228:231], v249 offset:38144
v_mfma_f32_16x16x32_f16 v[128:131], v[240:243], v[20:23], v[128:131]
v_permlane16_swap_b32 v32, v36
s_waitcnt lgkmcnt(2)
v_mfma_f32_16x16x32_f16 v[124:127], v[244:247], v[16:19], v[124:127]
ds_read_b128 v[240:243], v249 offset:38912
v_mfma_f32_16x16x32_f16 v[132:135], v[244:247], v[20:23], v[132:135]
v_permlane16_swap_b32 v33, v37
s_waitcnt lgkmcnt(2)
v_mfma_f32_16x16x32_f16 v[136:139], v[224:227], v[16:19], v[136:139]
ds_read_b128 v[244:247], v249 offset:39168
v_mfma_f32_16x16x32_f16 v[144:147], v[224:227], v[20:23], v[144:147]
v_permlane16_swap_b32 v34, v38
s_waitcnt lgkmcnt(2)
v_mfma_f32_16x16x32_f16 v[140:143], v[228:231], v[16:19], v[140:143]
buffer_load_dwordx4 v[8:11], v252, s[4:7], s71 offen offset:64
ds_read_b128 v[224:227], v249 offset:43008
v_mfma_f32_16x16x32_f16 v[148:151], v[228:231], v[20:23], v[148:151]
v_permlane16_swap_b32 v35, v39
s_waitcnt lgkmcnt(2)
v_mfma_f32_16x16x32_f16 v[152:155], v[240:243], v[16:19], v[152:155]
ds_read_b128 v[228:231], v249 offset:43264
v_mfma_f32_16x16x32_f16 v[160:163], v[240:243], v[20:23], v[160:163]
v_permlane16_swap_b32 v40, v44
s_waitcnt lgkmcnt(2)
v_mfma_f32_16x16x32_f16 v[156:159], v[244:247], v[16:19], v[156:159]
ds_read_b128 v[240:243], v249 offset:44032
v_mfma_f32_16x16x32_f16 v[164:167], v[244:247], v[20:23], v[164:167]
v_permlane16_swap_b32 v41, v45
s_waitcnt lgkmcnt(2)
v_mfma_f32_16x16x32_f16 v[120:123], v[224:227], v[24:27], v[120:123]
buffer_load_dwordx4 v[4:7], v252, s[4:7], s71 offen offset:128
ds_read_b128 v[244:247], v249 offset:44288
v_mfma_f32_16x16x32_f16 v[128:131], v[224:227], v[28:31], v[128:131]
v_permlane16_swap_b32 v42, v46
s_waitcnt lgkmcnt(2)
v_mfma_f32_16x16x32_f16 v[124:127], v[228:231], v[24:27], v[124:127]
ds_read_b128 v[224:227], v249 offset:45056
v_mfma_f32_16x16x32_f16 v[132:135], v[228:231], v[28:31], v[132:135]
v_permlane16_swap_b32 v43, v47
s_waitcnt lgkmcnt(2)
v_mfma_f32_16x16x32_f16 v[136:139], v[240:243], v[24:27], v[136:139]
ds_read_b128 v[228:231], v249 offset:45312
v_mfma_f32_16x16x32_f16 v[144:147], v[240:243], v[28:31], v[144:147]
v_permlane16_swap_b32 v104, v108
s_waitcnt lgkmcnt(2)
v_mfma_f32_16x16x32_f16 v[140:143], v[244:247], v[24:27], v[140:143]
s_add_u32 s46, s71, 98304
buffer_load_dwordx4 v[0:3], v252, s[4:7], s46 offen
ds_read_b128 v[240:243], v249 offset:49152
v_mfma_f32_16x16x32_f16 v[148:151], v[244:247], v[28:31], v[148:151]
v_permlane16_swap_b32 v105, v109
s_waitcnt lgkmcnt(2)
v_mfma_f32_16x16x32_f16 v[152:155], v[224:227], v[24:27], v[152:155]
ds_read_b128 v[244:247], v249 offset:49408
v_mfma_f32_16x16x32_f16 v[160:163], v[224:227], v[28:31], v[160:163]
v_permlane16_swap_b32 v106, v110
s_waitcnt lgkmcnt(2)
v_mfma_f32_16x16x32_f16 v[156:159], v[228:231], v[24:27], v[156:159]
ds_read_b128 v[224:227], v249 offset:50176
v_mfma_f32_16x16x32_f16 v[164:167], v[228:231], v[28:31], v[164:167]
v_permlane16_swap_b32 v107, v111
s_waitcnt lgkmcnt(2)
v_mfma_f32_16x16x32_f16 v[120:123], v[240:243], v[32:35], v[120:123]
s_add_u32 s46, s80, 4194304
buffer_load_dwordx4 v[24:27], v253, s[32:35], s46 offen nt
ds_read_b128 v[228:231], v249 offset:50432
v_mfma_f32_16x16x32_f16 v[128:131], v[240:243], v[36:39], v[128:131]
v_permlane16_swap_b32 v48, v52
s_waitcnt lgkmcnt(2)
v_mfma_f32_16x16x32_f16 v[124:127], v[244:247], v[32:35], v[124:127]
ds_read_b128 v[240:243], v249 offset:51200
v_mfma_f32_16x16x32_f16 v[132:135], v[244:247], v[36:39], v[132:135]
v_permlane16_swap_b32 v49, v53
s_waitcnt lgkmcnt(2)
v_mfma_f32_16x16x32_f16 v[136:139], v[224:227], v[32:35], v[136:139]
ds_read_b128 v[244:247], v249 offset:51456
v_permlane16_swap_b32 v50, v54
v_mfma_f32_16x16x32_f16 v[144:147], v[224:227], v[36:39], v[144:147]
s_waitcnt lgkmcnt(2)
v_mfma_f32_16x16x32_f16 v[140:143], v[228:231], v[32:35], v[140:143]
ds_read_b128 v[224:227], v249 offset:55296
v_permlane16_swap_b32 v51, v55
v_mfma_f32_16x16x32_f16 v[148:151], v[228:231], v[36:39], v[148:151]
v_permlane16_swap_b32 v56, v60
s_waitcnt lgkmcnt(2)
v_mfma_f32_16x16x32_f16 v[152:155], v[240:243], v[32:35], v[152:155]
ds_read_b128 v[228:231], v249 offset:55552
v_mfma_f32_16x16x32_f16 v[160:163], v[240:243], v[36:39], v[160:163]
v_permlane16_swap_b32 v57, v61
s_waitcnt lgkmcnt(2)
v_mfma_f32_16x16x32_f16 v[156:159], v[244:247], v[32:35], v[156:159]
ds_read_b128 v[240:243], v249 offset:56320
v_permlane16_swap_b32 v58, v62
v_mfma_f32_16x16x32_f16 v[164:167], v[244:247], v[36:39], v[164:167]
s_waitcnt lgkmcnt(2)
v_mfma_f32_16x16x32_f16 v[120:123], v[224:227], v[40:43], v[120:123]
s_add_u32 s46, s80, 4194304
buffer_load_dwordx4 v[28:31], v253, s[32:35], s46 offen offset:256 nt
ds_read_b128 v[244:247], v249 offset:56576
v_permlane16_swap_b32 v59, v63
v_mfma_f32_16x16x32_f16 v[128:131], v[224:227], v[44:47], v[128:131]
v_and_b32_e64 v16, 1, v251
v_lshlrev_b32 v16, 4, v16
s_waitcnt lgkmcnt(2)
v_mfma_f32_16x16x32_f16 v[124:127], v[228:231], v[40:43], v[124:127]
ds_read_b128 v[224:227], v249 offset:57344
v_mov_b32 v17, 16256
v_mfma_f32_16x16x32_f16 v[132:135], v[228:231], v[44:47], v[132:135]
v_lshlrev_b32 v16, v16, v17
s_waitcnt lgkmcnt(2)
v_mfma_f32_16x16x32_f16 v[136:139], v[240:243], v[40:43], v[136:139]
ds_read_b128 v[228:231], v249 offset:57600
v_lshrrev_b32 v17, 2, v251
v_mfma_f32_16x16x32_f16 v[144:147], v[240:243], v[44:47], v[144:147]
v_xor_b32 v17, v17, v251
v_and_b32 v17, 12, v17
s_waitcnt lgkmcnt(2)
v_mfma_f32_16x16x32_f16 v[140:143], v[244:247], v[40:43], v[140:143]
ds_read_b128 v[240:243], v249 offset:61440
v_and_b32_e64 v20, 2, v251
v_mfma_f32_16x16x32_f16 v[148:151], v[244:247], v[44:47], v[148:151]
v_or_b32 v17, v17, v20
s_waitcnt lgkmcnt(2)
v_mfma_f32_16x16x32_f16 v[152:155], v[224:227], v[40:43], v[152:155]
ds_read_b128 v[244:247], v249 offset:61696
v_cmp_eq_u32 vcc, 0, v17
s_nop 1
v_cndmask_b32 v18, 0, v16, vcc
v_cmp_eq_u32 vcc, 2, v17
s_nop 1
v_cndmask_b32 v19, 0, v16, vcc
v_mfma_f32_16x16x32_f16 v[160:163], v[224:227], v[44:47], v[160:163]
v_mov_b32 v16, 0
s_waitcnt lgkmcnt(2)
v_mfma_f32_16x16x32_f16 v[156:159], v[228:231], v[40:43], v[156:159]
ds_read_b128 v[224:227], v249 offset:62464
v_mov_b32_e64 v17, 0
v_mfma_f32_16x16x32_f16 v[164:167], v[228:231], v[44:47], v[164:167]
v_mov_b32 v20, 0
v_mov_b32 v21, 0
s_waitcnt lgkmcnt(2)
v_mfma_f32_16x16x32_f16 v[120:123], v[240:243], v[48:51], v[120:123]
s_add_u32 s46, s80, 8388608
buffer_load_dwordx4 v[32:35], v253, s[32:35], s46 offen nt
ds_read_b128 v[228:231], v249 offset:62720
v_mfma_f32_16x16x32_f16 v[128:131], v[240:243], v[52:55], v[128:131]
s_waitcnt lgkmcnt(2)
v_mfma_f32_16x16x32_f16 v[124:127], v[244:247], v[48:51], v[124:127]
ds_read_b128 v[240:243], v249 offset:63488
v_permlane16_swap_b32 v64, v68
v_mfma_f32_16x16x32_f16 v[132:135], v[244:247], v[52:55], v[132:135]
s_waitcnt lgkmcnt(2)
v_mfma_f32_16x16x32_f16 v[136:139], v[224:227], v[48:51], v[136:139]
ds_read_b128 v[244:247], v249 offset:63744
v_permlane16_swap_b32 v65, v69
v_mfma_f32_16x16x32_f16 v[144:147], v[224:227], v[52:55], v[144:147]
s_waitcnt lgkmcnt(2)
v_mfma_f32_16x16x32_f16 v[140:143], v[228:231], v[48:51], v[140:143]
ds_read_b128 v[224:227], v250 offset:2048
v_permlane16_swap_b32 v66, v70
v_mfma_f32_16x16x32_f16 v[148:151], v[228:231], v[52:55], v[148:151]
s_waitcnt lgkmcnt(2)
v_mfma_f32_16x16x32_f16 v[152:155], v[240:243], v[48:51], v[152:155]
ds_read_b128 v[228:231], v250 offset:2304
v_mfma_f32_16x16x32_f16 v[160:163], v[240:243], v[52:55], v[160:163]
v_permlane16_swap_b32 v67, v71
s_waitcnt lgkmcnt(2)
v_mfma_f32_16x16x32_f16 v[156:159], v[244:247], v[48:51], v[156:159]
ds_read_b128 v[240:243], v250 offset:3072
v_mfma_f32_16x16x32_f16 v[164:167], v[244:247], v[52:55], v[164:167]
v_permlane16_swap_b32 v72, v76
s_waitcnt lgkmcnt(2)
v_mfma_f32_16x16x32_f16 v[120:123], v[224:227], v[56:59], v[120:123]
ds_read_b128 v[244:247], v250 offset:3328
v_mfma_f32_16x16x32_f16 v[128:131], v[224:227], v[60:63], v[128:131]
v_permlane16_swap_b32 v73, v77
s_waitcnt lgkmcnt(2)
v_mfma_f32_16x16x32_f16 v[124:127], v[228:231], v[56:59], v[124:127]
s_add_u32 s46, s80, 8388608
buffer_load_dwordx4 v[36:39], v253, s[32:35], s46 offen offset:256 nt
ds_read_b128 v[224:227], v250 offset:4096
v_mfma_f32_16x16x32_f16 v[132:135], v[228:231], v[60:63], v[132:135]
s_waitcnt lgkmcnt(2)
v_mfma_f32_16x16x32_f16 v[136:139], v[240:243], v[56:59], v[136:139]
ds_read_b128 v[228:231], v250 offset:4352
v_permlane16_swap_b32 v74, v78
v_mfma_f32_16x16x32_f16 v[144:147], v[240:243], v[60:63], v[144:147]
s_waitcnt lgkmcnt(2)
v_mfma_f32_16x16x32_f16 v[140:143], v[244:247], v[56:59], v[140:143]
ds_read_b128 v[240:243], v250 offset:8192
v_permlane16_swap_b32 v75, v79
v_mfma_f32_16x16x32_f16 v[148:151], v[244:247], v[60:63], v[148:151]
s_waitcnt lgkmcnt(2)
v_mfma_f32_16x16x32_f16 v[152:155], v[224:227], v[56:59], v[152:155]
ds_read_b128 v[244:247], v250 offset:8448
v_permlane16_swap_b32 v192, v196
v_mfma_f32_16x16x32_f16 v[160:163], v[224:227], v[60:63], v[160:163]
s_waitcnt lgkmcnt(2)
v_mfma_f32_16x16x32_f16 v[156:159], v[228:231], v[56:59], v[156:159]
ds_read_b128 v[224:227], v250 offset:9216
v_mfma_f32_16x16x32_f16 v[164:167], v[228:231], v[60:63], v[164:167]
v_permlane16_swap_b32 v193, v197
s_waitcnt vmcnt(7)
v_mfma_f32_16x16x32_bf16 v[120:123], v[18:21], v[12:15], v[120:123]
ds_read_b128 v[228:231], v250 offset:9472
v_mfma_f32_16x16x32_bf16 v[124:127], v[16:19], v[12:15], v[124:127]
v_permlane16_swap_b32 v194, v198
s_waitcnt vmcnt(6)
v_mfma_f32_16x16x32_bf16 v[136:139], v[18:21], v[8:11], v[136:139]
v_mfma_f32_16x16x32_bf16 v[140:143], v[16:19], v[8:11], v[140:143]
v_permlane16_swap_b32 v195, v199
s_waitcnt lgkmcnt(3)
v_mfma_f32_16x16x32_f16 v[120:123], v[240:243], v[64:67], v[120:123]
s_add_u32 s46, s71, 98304
buffer_load_dwordx4 v[8:11], v252, s[4:7], s46 offen offset:64
v_mfma_f32_16x16x32_f16 v[128:131], v[240:243], v[68:71], v[128:131]
s_waitcnt lgkmcnt(2)
v_mfma_f32_16x16x32_f16 v[124:127], v[244:247], v[64:67], v[124:127]
ds_read_b128 v[240:243], v250 offset:10240
v_permlane16_swap_b32 v80, v84
v_mfma_f32_16x16x32_f16 v[132:135], v[244:247], v[68:71], v[132:135]
s_waitcnt lgkmcnt(2)
v_mfma_f32_16x16x32_f16 v[136:139], v[224:227], v[64:67], v[136:139]
ds_read_b128 v[244:247], v250 offset:10496
v_permlane16_swap_b32 v81, v85
v_mfma_f32_16x16x32_f16 v[144:147], v[224:227], v[68:71], v[144:147]
s_waitcnt lgkmcnt(2)
v_mfma_f32_16x16x32_f16 v[140:143], v[228:231], v[64:67], v[140:143]
ds_read_b128 v[224:227], v250 offset:14336
v_permlane16_swap_b32 v82, v86
v_mfma_f32_16x16x32_f16 v[148:151], v[228:231], v[68:71], v[148:151]
s_waitcnt lgkmcnt(2)
v_mfma_f32_16x16x32_f16 v[152:155], v[240:243], v[64:67], v[152:155]
ds_read_b128 v[228:231], v250 offset:14592
v_mfma_f32_16x16x32_f16 v[160:163], v[240:243], v[68:71], v[160:163]
v_permlane16_swap_b32 v83, v87
s_waitcnt lgkmcnt(2)
v_mfma_f32_16x16x32_f16 v[156:159], v[244:247], v[64:67], v[156:159]
ds_read_b128 v[240:243], v250 offset:15360
v_mfma_f32_16x16x32_f16 v[164:167], v[244:247], v[68:71], v[164:167]
v_permlane16_swap_b32 v88, v92
s_waitcnt lgkmcnt(2)
v_mfma_f32_16x16x32_f16 v[120:123], v[224:227], v[72:75], v[120:123]
ds_read_b128 v[244:247], v250 offset:15616
v_mfma_f32_16x16x32_f16 v[128:131], v[224:227], v[76:79], v[128:131]
v_permlane16_swap_b32 v89, v93
s_waitcnt lgkmcnt(2)
v_mfma_f32_16x16x32_f16 v[124:127], v[228:231], v[72:75], v[124:127]
s_add_u32 s46, s71, 98304
buffer_load_dwordx4 v[12:15], v252, s[4:7], s46 offen offset:128
ds_read_b128 v[224:227], v250 offset:16384
v_mfma_f32_16x16x32_f16 v[132:135], v[228:231], v[76:79], v[132:135]
s_waitcnt lgkmcnt(2)
v_mfma_f32_16x16x32_f16 v[136:139], v[240:243], v[72:75], v[136:139]
ds_read_b128 v[228:231], v250 offset:16640
v_permlane16_swap_b32 v90, v94
v_mfma_f32_16x16x32_f16 v[144:147], v[240:243], v[76:79], v[144:147]
s_waitcnt lgkmcnt(2)
v_mfma_f32_16x16x32_f16 v[140:143], v[244:247], v[72:75], v[140:143]
ds_read_b128 v[240:243], v250 offset:20480
v_permlane16_swap_b32 v91, v95
v_mfma_f32_16x16x32_f16 v[148:151], v[244:247], v[76:79], v[148:151]
s_waitcnt lgkmcnt(2)
v_mfma_f32_16x16x32_f16 v[152:155], v[224:227], v[72:75], v[152:155]
ds_read_b128 v[244:247], v250 offset:20736
v_permlane16_swap_b32 v184, v188
v_mfma_f32_16x16x32_f16 v[160:163], v[224:227], v[76:79], v[160:163]
s_waitcnt lgkmcnt(2)
v_mfma_f32_16x16x32_f16 v[156:159], v[228:231], v[72:75], v[156:159]
ds_read_b128 v[224:227], v250 offset:21504
v_mfma_f32_16x16x32_f16 v[164:167], v[228:231], v[76:79], v[164:167]
v_permlane16_swap_b32 v185, v189
s_waitcnt vmcnt(7)
v_mfma_f32_16x16x32_bf16 v[152:155], v[18:21], v[4:7], v[152:155]
ds_read_b128 v[228:231], v250 offset:21760
v_mfma_f32_16x16x32_bf16 v[156:159], v[16:19], v[4:7], v[156:159]
v_permlane16_swap_b32 v186, v190
s_waitcnt vmcnt(6)
v_mfma_f32_16x16x32_bf16 v[128:131], v[18:21], v[0:3], v[128:131]
v_mfma_f32_16x16x32_bf16 v[132:135], v[16:19], v[0:3], v[132:135]
v_permlane16_swap_b32 v187, v191
v_and_b32 v255, 1, v251
v_lshlrev_b32 v255, 7, v255
v_sub_u32 v255, v252, v255
s_mov_b32 s74, 1431655765
s_mov_b32 s75, 1431655765
s_waitcnt lgkmcnt(3)
v_mfma_f32_16x16x32_f16 v[120:123], v[240:243], v[80:83], v[120:123]
buffer_load_dwordx4 v[4:7], v252, s[4:7], s70 offen
v_mfma_f32_16x16x32_f16 v[128:131], v[240:243], v[84:87], v[128:131]
v_permlane16_swap_b32 v168, v172
s_waitcnt lgkmcnt(2)
v_mfma_f32_16x16x32_f16 v[124:127], v[244:247], v[80:83], v[124:127]
ds_read_b128 v[240:243], v250 offset:22528
v_mfma_f32_16x16x32_f16 v[132:135], v[244:247], v[84:87], v[132:135]
v_permlane16_swap_b32 v169, v173
s_waitcnt lgkmcnt(2)
v_mfma_f32_16x16x32_f16 v[136:139], v[224:227], v[80:83], v[136:139]
ds_read_b128 v[244:247], v250 offset:22784
v_mfma_f32_16x16x32_f16 v[144:147], v[224:227], v[84:87], v[144:147]
v_permlane16_swap_b32 v170, v174
s_waitcnt lgkmcnt(2)
v_mfma_f32_16x16x32_f16 v[140:143], v[228:231], v[80:83], v[140:143]
ds_read_b128 v[224:227], v250 offset:26624
v_mfma_f32_16x16x32_f16 v[148:151], v[228:231], v[84:87], v[148:151]
v_permlane16_swap_b32 v171, v175
s_waitcnt lgkmcnt(2)
v_mfma_f32_16x16x32_f16 v[152:155], v[240:243], v[80:83], v[152:155]
ds_read_b128 v[228:231], v250 offset:26880
v_mfma_f32_16x16x32_f16 v[160:163], v[240:243], v[84:87], v[160:163]
v_permlane16_swap_b32 v176, v180
s_waitcnt lgkmcnt(2)
v_mfma_f32_16x16x32_f16 v[156:159], v[244:247], v[80:83], v[156:159]
ds_read_b128 v[240:243], v250 offset:27648
v_mfma_f32_16x16x32_f16 v[164:167], v[244:247], v[84:87], v[164:167]
v_permlane16_swap_b32 v177, v181
s_waitcnt lgkmcnt(2)
v_mfma_f32_16x16x32_f16 v[120:123], v[224:227], v[88:91], v[120:123]
buffer_load_dwordx4 v[0:3], v252, s[4:7], s70 offen offset:64
ds_read_b128 v[244:247], v250 offset:27904
v_mfma_f32_16x16x32_f16 v[128:131], v[224:227], v[92:95], v[128:131]
v_permlane16_swap_b32 v178, v182
s_waitcnt lgkmcnt(2)
v_mfma_f32_16x16x32_f16 v[124:127], v[228:231], v[88:91], v[124:127]
ds_read_b128 v[224:227], v250 offset:28672
v_mfma_f32_16x16x32_f16 v[132:135], v[228:231], v[92:95], v[132:135]
v_permlane16_swap_b32 v179, v183
s_waitcnt lgkmcnt(2)
v_mfma_f32_16x16x32_f16 v[136:139], v[240:243], v[88:91], v[136:139]
ds_read_b128 v[228:231], v250 offset:28928
v_mfma_f32_16x16x32_f16 v[144:147], v[240:243], v[92:95], v[144:147]
v_permlane16_swap_b32 v112, v116
s_waitcnt lgkmcnt(2)
v_mfma_f32_16x16x32_f16 v[140:143], v[244:247], v[88:91], v[140:143]
ds_read_b128 v[240:243], v249 offset:49152
v_mfma_f32_16x16x32_f16 v[148:151], v[244:247], v[92:95], v[148:151]
v_permlane16_swap_b32 v113, v117
s_waitcnt lgkmcnt(2)
v_mfma_f32_16x16x32_f16 v[152:155], v[224:227], v[88:91], v[152:155]
ds_read_b128 v[244:247], v254 offset:7936
v_mfma_f32_16x16x32_f16 v[160:163], v[224:227], v[92:95], v[160:163]
v_permlane16_swap_b32 v114, v118
s_waitcnt lgkmcnt(2)
v_mfma_f32_16x16x32_f16 v[156:159], v[228:231], v[88:91], v[156:159]
ds_read_b128 v[224:227], v249 offset:49408
v_mfma_f32_16x16x32_f16 v[164:167], v[228:231], v[92:95], v[164:167]
v_permlane16_swap_b32 v115, v119
s_waitcnt lgkmcnt(1)
v_mfma_f32_16x16x32_f16 v[48:51], v[240:243], v[168:171], v[244:247]
ds_read_b128 v[228:231], v254 offset:7952
v_mfma_f32_16x16x32_f16 v[56:59], v[240:243], v[172:175], v[244:247]
s_waitcnt lgkmcnt(0)
v_mfma_f32_16x16x32_f16 v[52:55], v[224:227], v[168:171], v[228:231]
ds_read_b128 v[240:243], v249 offset:50176
ds_read_b128 v[244:247], v254 offset:8064
v_mfma_f32_16x16x32_f16 v[60:63], v[224:227], v[172:175], v[228:231]
s_waitcnt lgkmcnt(0)
v_mfma_f32_16x16x32_f16 v[64:67], v[240:243], v[168:171], v[244:247]
ds_read_b128 v[224:227], v249 offset:50432
ds_read_b128 v[228:231], v254 offset:8080
v_mfma_f32_16x16x32_f16 v[72:75], v[240:243], v[172:175], v[244:247]
v_permlane16_swap_b32 v208, v212
s_waitcnt lgkmcnt(0)
v_mfma_f32_16x16x32_f16 v[68:71], v[224:227], v[168:171], v[228:231]
ds_read_b128 v[240:243], v249 offset:51200
ds_read_b128 v[244:247], v254 offset:16128
v_mfma_f32_16x16x32_f16 v[76:79], v[224:227], v[172:175], v[228:231]
v_permlane16_swap_b32 v209, v213
s_waitcnt lgkmcnt(0)
v_mfma_f32_16x16x32_f16 v[80:83], v[240:243], v[168:171], v[244:247]
ds_read_b128 v[224:227], v249 offset:51456
ds_read_b128 v[228:231], v254 offset:16144
v_permlane16_swap_b32 v210, v214
v_mfma_f32_16x16x32_f16 v[88:91], v[240:243], v[172:175], v[244:247]
s_waitcnt lgkmcnt(0)
v_mfma_f32_16x16x32_f16 v[84:87], v[224:227], v[168:171], v[228:231]
ds_read_b128 v[240:243], v249 offset:55296
ds_read_b128 v[244:247], v249 offset:55552
v_permlane16_swap_b32 v211, v215
v_mfma_f32_16x16x32_f16 v[92:95], v[224:227], v[172:175], v[228:231]
v_cvt_pk_bf16_f32 v136, v136, v137
v_cvt_pk_bf16_f32 v137, v138, v139
s_waitcnt lgkmcnt(1)
v_mfma_f32_16x16x32_f16 v[48:51], v[240:243], v[176:179], v[48:51]
ds_read_b128 v[224:227], v249 offset:56320
ds_read_b128 v[228:231], v249 offset:56576
v_cvt_pk_bf16_f32 v138, v140, v141
v_mfma_f32_16x16x32_f16 v[56:59], v[240:243], v[180:183], v[56:59]
v_cvt_pk_bf16_f32 v139, v142, v143
v_cvt_pk_bf16_f32 v120, v120, v121
s_waitcnt lgkmcnt(2)
v_mfma_f32_16x16x32_f16 v[52:55], v[244:247], v[176:179], v[52:55]
ds_read_b128 v[240:243], v249 offset:57344
v_cvt_pk_bf16_f32 v121, v122, v123
v_mfma_f32_16x16x32_f16 v[60:63], v[244:247], v[180:183], v[60:63]
v_cvt_pk_bf16_f32 v122, v124, v125
s_waitcnt lgkmcnt(2)
v_mfma_f32_16x16x32_f16 v[64:67], v[224:227], v[176:179], v[64:67]
ds_read_b128 v[244:247], v249 offset:57600
v_cvt_pk_bf16_f32 v123, v126, v127
v_cvt_pk_bf16_f32 v152, v152, v153
v_mfma_f32_16x16x32_f16 v[72:75], v[224:227], v[180:183], v[72:75]
v_cvt_pk_bf16_f32 v153, v154, v155
s_waitcnt lgkmcnt(2)
v_mfma_f32_16x16x32_f16 v[68:71], v[228:231], v[176:179], v[68:71]
ds_read_b128 v[224:227], v249 offset:61440
v_cvt_pk_bf16_f32 v154, v156, v157
v_mfma_f32_16x16x32_f16 v[76:79], v[228:231], v[180:183], v[76:79]
v_cvt_pk_bf16_f32 v155, v158, v159
s_mov_b64 vcc, s[74:75]
v_cndmask_b32 v140, v120, v152, vcc
s_waitcnt lgkmcnt(2)
v_mfma_f32_16x16x32_f16 v[80:83], v[240:243], v[176:179], v[80:83]
ds_read_b128 v[228:231], v249 offset:61696
v_cndmask_b32 v141, v121, v153, vcc
v_mfma_f32_16x16x32_f16 v[88:91], v[240:243], v[180:183], v[88:91]
v_cndmask_b32 v142, v122, v154, vcc
s_waitcnt lgkmcnt(2)
v_mfma_f32_16x16x32_f16 v[84:87], v[244:247], v[176:179], v[84:87]
ds_read_b128 v[240:243], v248 offset:16384
v_cndmask_b32 v143, v123, v155, vcc
v_cndmask_b32_dpp v120, v136, v120, vcc quad_perm:[1,0,3,2] row_mask:0xf bank_mask:0xf
v_mfma_f32_16x16x32_f16 v[92:95], v[244:247], v[180:183], v[92:95]
v_cndmask_b32_dpp v121, v137, v121, vcc quad_perm:[1,0,3,2] row_mask:0xf bank_mask:0xf
s_waitcnt vmcnt(3)
v_mfma_f32_16x16x32_bf16 v[144:147], v[18:21], v[8:11], v[144:147]
ds_read_b128 v[244:247], v249 offset:62464
v_cndmask_b32_dpp v122, v138, v122, vcc quad_perm:[1,0,3,2] row_mask:0xf bank_mask:0xf
v_mfma_f32_16x16x32_bf16 v[148:151], v[16:19], v[8:11], v[148:151]
v_cndmask_b32_dpp v123, v139, v123, vcc quad_perm:[1,0,3,2] row_mask:0xf bank_mask:0xf
s_not_b64 vcc, s[74:75]
v_cndmask_b32_dpp v152, v136, v152, vcc quad_perm:[1,0,3,2] row_mask:0xf bank_mask:0xf
s_waitcnt vmcnt(2)
v_mfma_f32_16x16x32_bf16 v[160:163], v[18:21], v[12:15], v[160:163]
v_cndmask_b32_dpp v153, v137, v153, vcc quad_perm:[1,0,3,2] row_mask:0xf bank_mask:0xf
v_mfma_f32_16x16x32_bf16 v[164:167], v[16:19], v[12:15], v[164:167]
v_cndmask_b32_dpp v154, v138, v154, vcc quad_perm:[1,0,3,2] row_mask:0xf bank_mask:0xf
v_cndmask_b32_dpp v155, v139, v155, vcc quad_perm:[1,0,3,2] row_mask:0xf bank_mask:0xf
s_waitcnt lgkmcnt(2)
v_mfma_f32_16x16x32_f16 v[48:51], v[224:227], v[184:187], v[48:51]
buffer_load_dwordx4 v[8:11], v252, s[4:7], s70 offen offset:128
buffer_store_dwordx4 v[120:123], v255, s[8:11], s71 offen sc1
v_mfma_f32_16x16x32_f16 v[56:59], v[224:227], v[188:191], v[56:59]
v_mfma_f32_16x16x32_f16 v[52:55], v[228:231], v[184:187], v[52:55]
ds_read_b128 v[224:227], v249 offset:62720
v_permlane16_swap_b32 v200, v204
v_mfma_f32_16x16x32_f16 v[60:63], v[228:231], v[188:191], v[60:63]
s_waitcnt lgkmcnt(2)
v_mfma_f32_16x16x32_bf16 v[168:171], v[240:243], v[96:99], 0
ds_read_b128 v[228:231], v249 offset:63488
v_permlane16_swap_b32 v201, v205
v_mfma_f32_16x16x32_bf16 v[176:179], v[240:243], v[100:103], 0
s_waitcnt lgkmcnt(2)
v_mfma_f32_16x16x32_f16 v[64:67], v[244:247], v[184:187], v[64:67]
ds_read_b128 v[240:243], v249 offset:63744
v_mfma_f32_16x16x32_f16 v[72:75], v[244:247], v[188:191], v[72:75]
v_permlane16_swap_b32 v202, v206
s_waitcnt lgkmcnt(2)
v_mfma_f32_16x16x32_f16 v[68:71], v[224:227], v[184:187], v[68:71]
ds_read_b128 v[244:247], v248 offset:16640
v_mfma_f32_16x16x32_f16 v[76:79], v[224:227], v[188:191], v[76:79]
v_permlane16_swap_b32 v203, v207
s_waitcnt lgkmcnt(2)
v_mfma_f32_16x16x32_f16 v[80:83], v[228:231], v[184:187], v[80:83]
s_add_u32 s46, s70, 98304
buffer_load_dwordx4 v[12:15], v252, s[4:7], s46 offen
ds_read_b128 v[224:227], v250 offset:2048
v_mfma_f32_16x16x32_f16 v[88:91], v[228:231], v[188:191], v[88:91]
s_waitcnt lgkmcnt(2)
v_mfma_f32_16x16x32_f16 v[84:87], v[240:243], v[184:187], v[84:87]
ds_read_b128 v[228:231], v250 offset:2304
v_permlane16_swap_b32 v232, v236
v_mfma_f32_16x16x32_f16 v[92:95], v[240:243], v[188:191], v[92:95]
s_waitcnt lgkmcnt(2)
v_mfma_f32_16x16x32_bf16 v[172:175], v[244:247], v[96:99], 0
ds_read_b128 v[240:243], v250 offset:3072
v_permlane16_swap_b32 v233, v237
v_mfma_f32_16x16x32_bf16 v[180:183], v[244:247], v[100:103], 0
s_waitcnt lgkmcnt(2)
v_mfma_f32_16x16x32_f16 v[48:51], v[224:227], v[192:195], v[48:51]
ds_read_b128 v[244:247], v250 offset:3328
v_mfma_f32_16x16x32_f16 v[56:59], v[224:227], v[196:199], v[56:59]
v_permlane16_swap_b32 v234, v238
s_waitcnt lgkmcnt(2)
v_mfma_f32_16x16x32_f16 v[52:55], v[228:231], v[192:195], v[52:55]
ds_read_b128 v[224:227], v248 offset:17408
v_mfma_f32_16x16x32_f16 v[60:63], v[228:231], v[196:199], v[60:63]
v_permlane16_swap_b32 v235, v239
s_waitcnt lgkmcnt(2)
v_mfma_f32_16x16x32_f16 v[64:67], v[240:243], v[192:195], v[64:67]
buffer_store_dwordx4 v[140:143], v255, s[8:11], s71 offen offset:128 sc1
ds_read_b128 v[228:231], v250 offset:4096
v_mfma_f32_16x16x32_f16 v[72:75], v[240:243], v[196:199], v[72:75]
s_waitcnt lgkmcnt(2)
v_mfma_f32_16x16x32_f16 v[68:71], v[244:247], v[192:195], v[68:71]
ds_read_b128 v[240:243], v250 offset:4352
v_permlane16_swap_b32 v216, v220
v_mfma_f32_16x16x32_f16 v[76:79], v[244:247], v[196:199], v[76:79]
s_waitcnt lgkmcnt(2)
v_mfma_f32_16x16x32_bf16 v[168:171], v[224:227], v[104:107], v[168:171]
ds_read_b128 v[244:247], v250 offset:8192
v_permlane16_swap_b32 v217, v221
v_mfma_f32_16x16x32_bf16 v[176:179], v[224:227], v[108:111], v[176:179]
s_waitcnt lgkmcnt(2)
v_mfma_f32_16x16x32_f16 v[80:83], v[228:231], v[192:195], v[80:83]
ds_read_b128 v[224:227], v250 offset:8448
v_mfma_f32_16x16x32_f16 v[88:91], v[228:231], v[196:199], v[88:91]
v_permlane16_swap_b32 v218, v222
s_waitcnt lgkmcnt(2)
v_mfma_f32_16x16x32_f16 v[84:87], v[240:243], v[192:195], v[84:87]
ds_read_b128 v[228:231], v248 offset:17664
v_mfma_f32_16x16x32_f16 v[92:95], v[240:243], v[196:199], v[92:95]
v_permlane16_swap_b32 v219, v223
s_waitcnt lgkmcnt(2)
v_mfma_f32_16x16x32_f16 v[48:51], v[244:247], v[200:203], v[48:51]
buffer_store_dwordx4 v[152:155], v255, s[8:11], s71 offen offset:256 sc1
ds_read_b128 v[240:243], v250 offset:9216
v_mfma_f32_16x16x32_f16 v[56:59], v[244:247], v[204:207], v[56:59]
s_waitcnt lgkmcnt(2)
v_mfma_f32_16x16x32_f16 v[52:55], v[224:227], v[200:203], v[52:55]
ds_read_b128 v[244:247], v250 offset:9472
v_mfma_f32_16x16x32_f16 v[60:63], v[224:227], v[204:207], v[60:63]
s_waitcnt lgkmcnt(2)
v_mfma_f32_16x16x32_bf16 v[172:175], v[228:231], v[104:107], v[172:175]
ds_read_b128 v[224:227], v250 offset:10240
v_mfma_f32_16x16x32_bf16 v[180:183], v[228:231], v[108:111], v[180:183]
s_waitcnt lgkmcnt(2)
v_mfma_f32_16x16x32_f16 v[64:67], v[240:243], v[200:203], v[64:67]
ds_read_b128 v[228:231], v250 offset:10496
v_mfma_f32_16x16x32_f16 v[72:75], v[240:243], v[204:207], v[72:75]
s_waitcnt lgkmcnt(2)
v_mfma_f32_16x16x32_f16 v[68:71], v[244:247], v[200:203], v[68:71]
ds_read_b128 v[240:243], v248 offset:18432
v_mfma_f32_16x16x32_f16 v[76:79], v[244:247], v[204:207], v[76:79]
s_waitcnt lgkmcnt(2)
v_mfma_f32_16x16x32_f16 v[80:83], v[224:227], v[200:203], v[80:83]
ds_read_b128 v[244:247], v250 offset:14336
v_mfma_f32_16x16x32_f16 v[88:91], v[224:227], v[204:207], v[88:91]
s_waitcnt lgkmcnt(2)
v_mfma_f32_16x16x32_f16 v[84:87], v[228:231], v[200:203], v[84:87]
ds_read_b128 v[224:227], v250 offset:14592
v_mfma_f32_16x16x32_f16 v[92:95], v[228:231], v[204:207], v[92:95]
s_waitcnt lgkmcnt(2)
v_mfma_f32_16x16x32_bf16 v[168:171], v[240:243], v[112:115], v[168:171]
ds_read_b128 v[228:231], v250 offset:15360
v_mfma_f32_16x16x32_bf16 v[176:179], v[240:243], v[116:119], v[176:179]
s_waitcnt lgkmcnt(2)
v_mfma_f32_16x16x32_f16 v[48:51], v[244:247], v[232:235], v[48:51]
ds_read_b128 v[240:243], v250 offset:15616
v_mfma_f32_16x16x32_f16 v[56:59], v[244:247], v[236:239], v[56:59]
s_waitcnt lgkmcnt(2)
v_mfma_f32_16x16x32_f16 v[52:55], v[224:227], v[232:235], v[52:55]
ds_read_b128 v[244:247], v248 offset:18688
v_mfma_f32_16x16x32_f16 v[60:63], v[224:227], v[236:239], v[60:63]
s_waitcnt lgkmcnt(2)
v_mfma_f32_16x16x32_f16 v[64:67], v[228:231], v[232:235], v[64:67]
ds_read_b128 v[224:227], v250 offset:16384
v_mfma_f32_16x16x32_f16 v[72:75], v[228:231], v[236:239], v[72:75]
s_waitcnt lgkmcnt(2)
v_mfma_f32_16x16x32_f16 v[68:71], v[240:243], v[232:235], v[68:71]
ds_read_b128 v[228:231], v250 offset:16640
v_mfma_f32_16x16x32_f16 v[76:79], v[240:243], v[236:239], v[76:79]
s_waitcnt lgkmcnt(2)
v_mfma_f32_16x16x32_bf16 v[172:175], v[244:247], v[112:115], v[172:175]
ds_read_b128 v[240:243], v250 offset:26624
v_mfma_f32_16x16x32_bf16 v[180:183], v[244:247], v[116:119], v[180:183]
s_waitcnt lgkmcnt(2)
v_mfma_f32_16x16x32_f16 v[80:83], v[224:227], v[232:235], v[80:83]
ds_read_b128 v[244:247], v250 offset:26880
v_mfma_f32_16x16x32_f16 v[88:91], v[224:227], v[236:239], v[88:91]
s_waitcnt lgkmcnt(2)
v_mfma_f32_16x16x32_f16 v[84:87], v[228:231], v[232:235], v[84:87]
ds_read_b128 v[224:227], v250 offset:27648
v_mfma_f32_16x16x32_f16 v[92:95], v[228:231], v[236:239], v[92:95]
s_waitcnt lgkmcnt(2)
v_mfma_f32_16x16x32_f16 v[48:51], v[240:243], v[216:219], v[48:51]
ds_read_b128 v[228:231], v250 offset:27904
v_mfma_f32_16x16x32_f16 v[56:59], v[240:243], v[220:223], v[56:59]
s_waitcnt lgkmcnt(2)
v_mfma_f32_16x16x32_f16 v[52:55], v[244:247], v[216:219], v[52:55]
ds_read_b128 v[240:243], v250 offset:28672
v_mfma_f32_16x16x32_f16 v[60:63], v[244:247], v[220:223], v[60:63]
s_waitcnt lgkmcnt(2)
v_mfma_f32_16x16x32_f16 v[64:67], v[224:227], v[216:219], v[64:67]
ds_read_b128 v[244:247], v250 offset:28928
v_mfma_f32_16x16x32_f16 v[72:75], v[224:227], v[220:223], v[72:75]
s_waitcnt lgkmcnt(2)
v_mfma_f32_16x16x32_f16 v[68:71], v[228:231], v[216:219], v[68:71]
ds_read_b128 v[224:227], v248 offset:22528
v_mfma_f32_16x16x32_f16 v[76:79], v[228:231], v[220:223], v[76:79]
s_waitcnt lgkmcnt(2)
v_mfma_f32_16x16x32_f16 v[80:83], v[240:243], v[216:219], v[80:83]
ds_read_b128 v[228:231], v248 offset:22784
v_mfma_f32_16x16x32_f16 v[88:91], v[240:243], v[220:223], v[88:91]
s_waitcnt lgkmcnt(2)
v_mfma_f32_16x16x32_f16 v[84:87], v[244:247], v[216:219], v[84:87]
ds_read_b128 v[240:243], v248 offset:23552
v_mfma_f32_16x16x32_f16 v[92:95], v[244:247], v[220:223], v[92:95]
s_setprio 3
v_cvt_pkrtz_f16_f32 v185, v168, v169
v_cvt_pkrtz_f16_f32 v187, v170, v171
v_cvt_pkrtz_f16_f32 v189, v172, v173
v_cvt_pkrtz_f16_f32 v191, v174, v175
v_cvt_pkrtz_f16_f32 v193, v176, v177
v_cvt_pkrtz_f16_f32 v195, v178, v179
v_cvt_pk_f16_f32 v203, v180, v181
v_cvt_pk_f16_f32 v200, v182, v183
s_waitcnt lgkmcnt(2)
v_mfma_f32_16x16x32_bf16 v[168:171], v[224:227], v[96:99], 0
s_add_u32 s46, s70, 98304
buffer_load_dwordx4 v[216:219], v252, s[4:7], s46 offen offset:64
ds_read_b128 v[244:247], v248 offset:23808
v_mfma_f32_16x16x32_bf16 v[176:179], v[224:227], v[100:103], 0
v_pk_fma_f16 v202, v203, v203, s48
v_cvt_pk_bf16_f32 v144, v144, v145
v_and_b32 v185, s49, v185
v_cvt_pk_bf16_f32 v145, v146, v147
s_waitcnt lgkmcnt(2)
v_mfma_f32_16x16x32_bf16 v[172:175], v[228:231], v[96:99], 0
ds_read_b128 v[224:227], v248 offset:24576
v_and_b32_e64 v187, s49, v187
v_cvt_pk_bf16_f32 v146, v148, v149
v_pk_fma_f16 v199, v200, v200, s48
v_bfe_u32 v184, v185, 2, 14
v_cvt_pk_bf16_f32 v147, v150, v151
v_pk_mul_f16 v202, v203, v202
v_mfma_f32_16x16x32_bf16 v[180:183], v[228:231], v[100:103], 0
v_cvt_pk_bf16_f32 v128, v128, v129
v_bfe_u32 v186, v187, 2, 14
v_pk_mul_f16 v199, v200, v199
v_cvt_pk_bf16_f32 v129, v130, v131
v_lshrrev_b32 v185, 18, v185
v_cvt_pk_bf16_f32 v130, v132, v133
s_waitcnt lgkmcnt(2)
v_mfma_f32_16x16x32_bf16 v[168:171], v[240:243], v[104:107], v[168:171]
ds_read_b128 v[228:231], v248 offset:24832
ds_read_u16_d16 v184, v184
ds_read_u16_d16 v186, v186
ds_read_u16_d16_hi v185, v185
v_exp_f16_e64 v201, v202
v_cvt_pk_bf16_f32 v131, v134, v135
v_lshrrev_b32_e64 v187, 18, v187
v_cvt_pk_bf16_f32 v160, v160, v161
v_and_b32_e64 v189, s49, v189
v_mfma_f32_16x16x32_bf16 v[176:179], v[240:243], v[108:111], v[176:179]
v_cvt_pk_bf16_f32 v161, v162, v163
v_exp_f16_e64 v198, v199
v_cvt_pk_bf16_f32 v162, v164, v165
v_and_b32_e64 v191, s49, v191
v_cvt_pk_bf16_f32 v163, v166, v167
s_mov_b64 vcc, s[74:75]
s_waitcnt lgkmcnt(4)
v_mfma_f32_16x16x32_bf16 v[172:175], v[244:247], v[104:107], v[172:175]
s_add_u32 s46, s70, 98304
buffer_load_dwordx4 v[204:207], v252, s[4:7], s46 offen offset:128
ds_read_u16_d16_hi v187, v187
v_bfe_u32 v188, v189, 2, 14
v_exp_f16_sdwa v201, v202 dst_sel:WORD_1 dst_unused:UNUSED_PRESERVE src0_sel:WORD_1
v_cndmask_b32 v148, v128, v160, vcc
v_cndmask_b32 v149, v129, v161, vcc
v_bfe_u32 v190, v191, 2, 14
v_mfma_f32_16x16x32_bf16 v[180:183], v[244:247], v[108:111], v[180:183]
v_cndmask_b32 v150, v130, v162, vcc
v_lshrrev_b32 v189, 18, v189
v_lshrrev_b32 v191, 18, v191
v_cndmask_b32 v151, v131, v163, vcc
v_exp_f16_sdwa v198, v199 dst_sel:WORD_1 dst_unused:UNUSED_PRESERVE src0_sel:WORD_1
v_mfma_f32_16x16x32_bf16 v[168:171], v[224:227], v[112:115], v[168:171]
ds_read_u16_d16 v188, v188
ds_read_u16_d16 v190, v190
ds_read_u16_d16_hi v189, v189
ds_read_u16_d16_hi v191, v191
v_cndmask_b32_dpp v128, v144, v128, vcc quad_perm:[1,0,3,2] row_mask:0xf bank_mask:0xf
v_and_b32_e64 v193, s49, v193
v_cndmask_b32_dpp v129, v145, v129, vcc quad_perm:[1,0,3,2] row_mask:0xf bank_mask:0xf
v_and_b32_e64 v195, s49, v195
v_cndmask_b32_dpp v130, v146, v130, vcc quad_perm:[1,0,3,2] row_mask:0xf bank_mask:0xf
v_pk_add_f16 v201, v201, 1.0 op_sel_hi:[1,0]
v_mfma_f32_16x16x32_bf16 v[176:179], v[224:227], v[116:119], v[176:179]
v_cndmask_b32_dpp v131, v147, v131, vcc quad_perm:[1,0,3,2] row_mask:0xf bank_mask:0xf
s_not_b64 vcc, s[74:75]
v_bfe_u32 v192, v193, 2, 14
v_pk_add_f16 v198, v198, 1.0 op_sel_hi:[1,0]
v_cndmask_b32_dpp v160, v144, v160, vcc quad_perm:[1,0,3,2] row_mask:0xf bank_mask:0xf
v_bfe_u32 v194, v195, 2, 14
v_cndmask_b32_dpp v161, v145, v161, vcc quad_perm:[1,0,3,2] row_mask:0xf bank_mask:0xf
s_waitcnt lgkmcnt(4)
v_mfma_f32_16x16x32_bf16 v[172:175], v[228:231], v[112:115], v[172:175]
ds_read_b128 v[224:227], v249 offset:24576
ds_read_u16_d16 v192, v192
ds_read_u16_d16 v194, v194
v_rcp_f16_e64 v202, v201
v_cndmask_b32_dpp v162, v146, v162, vcc quad_perm:[1,0,3,2] row_mask:0xf bank_mask:0xf
v_lshrrev_b32_e64 v193, 18, v193
v_cndmask_b32_dpp v163, v147, v163, vcc quad_perm:[1,0,3,2] row_mask:0xf bank_mask:0xf
v_lshrrev_b32_e64 v195, 18, v195
v_mfma_f32_16x16x32_bf16 v[180:183], v[228:231], v[116:119], v[180:183]
v_rcp_f16_e64 v199, v198
v_rcp_f16_sdwa v202, v201 dst_sel:WORD_1 dst_unused:UNUSED_PRESERVE src0_sel:WORD_1
v_or_b32 v232, v184, v185
v_or_b32 v233, v186, v187
s_waitcnt lgkmcnt(3)
v_or_b32 v234, v188, v189
v_rcp_f16_sdwa v199, v198 dst_sel:WORD_1 dst_unused:UNUSED_PRESERVE src0_sel:WORD_1
v_or_b32_e64 v235, v190, v191
ds_read_u16_d16_hi v193, v193
s_add_u32 s46, s71, 98304
buffer_store_dwordx4 v[128:131], v255, s[8:11], s46 offen sc1
ds_read_u16_d16_hi v195, v195
s_waitcnt lgkmcnt(1)
v_or_b32 v236, v192, v193
s_waitcnt lgkmcnt(0)
v_or_b32 v237, v194, v195
v_pk_mul_f16 v238, v203, v202
v_pk_mul_f16 v239, v200, v199
v_mfma_f32_16x16x32_f16 v[48:51], v[224:227], v[232:235], v[48:51]
s_add_u32 s46, s71, 98304
buffer_store_dwordx4 v[148:151], v255, s[8:11], s46 offen offset:128 sc1
ds_read_b128 v[228:231], v249 offset:24832
ds_read_b128 v[240:243], v248 offset:28672
ds_read_b128 v[244:247], v249 offset:25600
ds_read_b128 v[40:43], v248 offset:28928
ds_read_b128 v[44:47], v249 offset:25856
v_cvt_pkrtz_f16_f32 v185, v168, v169
v_cvt_pkrtz_f16_f32 v187, v170, v171
v_mfma_f32_16x16x32_f16 v[56:59], v[224:227], v[236:239], v[56:59]
v_cvt_pkrtz_f16_f32 v189, v172, v173
v_cvt_pkrtz_f16_f32 v191, v174, v175
s_waitcnt lgkmcnt(4)
v_mfma_f32_16x16x32_f16 v[52:55], v[228:231], v[232:235], v[52:55]
ds_read_b128 v[224:227], v248 offset:29696
v_cvt_pkrtz_f16_f32 v193, v176, v177
v_cvt_pk_f16_f32 v203, v178, v179
v_cvt_pk_f16_f32 v200, v180, v181
v_mfma_f32_16x16x32_f16 v[60:63], v[228:231], v[236:239], v[60:63]
v_cvt_pk_f16_f32 v197, v182, v183
v_pk_fma_f16 v202, v203, v203, s48
s_waitcnt lgkmcnt(4)
v_mfma_f32_16x16x32_bf16 v[168:171], v[240:243], v[96:99], 0
ds_read_b128 v[228:231], v249 offset:26624
v_and_b32_e64 v185, s49, v185
v_pk_fma_f16 v199, v200, v200, s48
v_mfma_f32_16x16x32_bf16 v[176:179], v[240:243], v[100:103], 0
v_and_b32_e64 v187, s49, v187
v_pk_fma_f16 v196, v197, v197, s48
s_setprio 2
v_bfe_u32 v184, v185, 2, 14
s_waitcnt lgkmcnt(2)
v_mfma_f32_16x16x32_f16 v[64:67], v[244:247], v[232:235], v[64:67]
ds_read_b128 v[240:243], v249 offset:26880
ds_read_u16_d16 v184, v184
v_pk_mul_f16 v202, v203, v202
v_bfe_u32 v186, v187, 2, 14
v_mfma_f32_16x16x32_f16 v[72:75], v[244:247], v[236:239], v[72:75]
v_pk_mul_f16 v199, v200, v199
v_lshrrev_b32_e64 v185, 18, v185
v_mfma_f32_16x16x32_bf16 v[172:175], v[40:43], v[96:99], 0
ds_read_b128 v[244:247], v248 offset:29952
ds_read_u16_d16 v186, v186
ds_read_u16_d16_hi v185, v185
v_pk_mul_f16 v196, v197, v196
v_lshrrev_b32_e64 v187, 18, v187
v_mfma_f32_16x16x32_bf16 v[180:183], v[40:43], v[100:103], 0
v_exp_f16 v201, v202
v_and_b32 v189, s49, v189
v_mfma_f32_16x16x32_f16 v[68:71], v[44:47], v[232:235], v[68:71]
ds_read_b128 v[40:43], v248 offset:30720
ds_read_u16_d16_hi v187, v187
v_and_b32_e64 v191, s49, v191
v_mfma_f32_16x16x32_f16 v[76:79], v[44:47], v[236:239], v[76:79]
v_exp_f16 v198, v199
v_bfe_u32 v188, v189, 2, 14
v_bfe_u32 v190, v191, 2, 14
s_waitcnt lgkmcnt(7)
v_mfma_f32_16x16x32_bf16 v[168:171], v[224:227], v[104:107], v[168:171]
ds_read_b128 v[44:47], v248 offset:30976
ds_read_u16_d16 v188, v188
ds_read_u16_d16 v190, v190
v_exp_f16_e64 v195, v196
v_mfma_f32_16x16x32_bf16 v[176:179], v[224:227], v[108:111], v[176:179]
v_lshrrev_b32 v189, 18, v189
v_lshrrev_b32 v191, 18, v191
v_mfma_f32_16x16x32_f16 v[80:83], v[228:231], v[232:235], v[80:83]
ds_read_b128 v[224:227], v249 offset:30720
ds_read_u16_d16_hi v189, v189
ds_read_u16_d16_hi v191, v191
v_exp_f16_sdwa v201, v202 dst_sel:WORD_1 dst_unused:UNUSED_PRESERVE src0_sel:WORD_1
v_and_b32 v193, s49, v193
v_mfma_f32_16x16x32_f16 v[88:91], v[228:231], v[236:239], v[88:91]
v_bfe_u32 v192, v193, 2, 14
s_waitcnt lgkmcnt(8)
v_mfma_f32_16x16x32_f16 v[84:87], v[240:243], v[232:235], v[84:87]
ds_read_b128 v[228:231], v249 offset:30976
ds_read_u16_d16 v192, v192
v_exp_f16_sdwa v198, v199 dst_sel:WORD_1 dst_unused:UNUSED_PRESERVE src0_sel:WORD_1
v_lshrrev_b32_e64 v193, 18, v193
v_mfma_f32_16x16x32_f16 v[92:95], v[240:243], v[236:239], v[92:95]
v_exp_f16_sdwa v195, v196 dst_sel:WORD_1 dst_unused:UNUSED_PRESERVE src0_sel:WORD_1
v_pk_add_f16 v201, v201, 1.0 op_sel_hi:[1,0]
v_mfma_f32_16x16x32_bf16 v[172:175], v[244:247], v[104:107], v[172:175]
ds_read_b128 v[240:243], v248 offset:34816
ds_read_u16_d16_hi v193, v193
v_pk_add_f16 v198, v198, 1.0 op_sel_hi:[1,0]
v_pk_add_f16 v195, v195, 1.0 op_sel_hi:[1,0]
v_mfma_f32_16x16x32_bf16 v[180:183], v[244:247], v[108:111], v[180:183]
v_rcp_f16 v202, v201
s_waitcnt lgkmcnt(7)
v_mfma_f32_16x16x32_bf16 v[168:171], v[40:43], v[112:115], v[168:171]
ds_read_b128 v[244:247], v249 offset:31744
v_rcp_f16_e64 v199, v198
v_mfma_f32_16x16x32_bf16 v[176:179], v[40:43], v[116:119], v[176:179]
v_rcp_f16_e64 v196, v195
v_mfma_f32_16x16x32_bf16 v[172:175], v[44:47], v[112:115], v[172:175]
ds_read_b128 v[40:43], v248 offset:35072
v_rcp_f16_sdwa v202, v201 dst_sel:WORD_1 dst_unused:UNUSED_PRESERVE src0_sel:WORD_1
v_mfma_f32_16x16x32_bf16 v[180:183], v[44:47], v[116:119], v[180:183]
v_rcp_f16_sdwa v199, v198 dst_sel:WORD_1 dst_unused:UNUSED_PRESERVE src0_sel:WORD_1
v_or_b32 v232, v184, v185
v_or_b32 v233, v186, v187
s_waitcnt lgkmcnt(4)
v_or_b32 v234, v188, v189
v_rcp_f16_sdwa v196, v195 dst_sel:WORD_1 dst_unused:UNUSED_PRESERVE src0_sel:WORD_1
v_or_b32 v235, v190, v191
s_waitcnt lgkmcnt(2)
v_or_b32_e64 v236, v192, v193
v_pk_mul_f16 v237, v203, v202
v_pk_mul_f16 v238, v200, v199
v_pk_mul_f16 v239, v197, v196
v_mfma_f32_16x16x32_f16 v[48:51], v[224:227], v[232:235], v[48:51]
s_add_u32 s46, s71, 98304
buffer_store_dwordx4 v[160:163], v255, s[8:11], s46 offen offset:256 sc1
ds_read_b128 v[44:47], v249 offset:32000
v_cvt_pkrtz_f16_f32 v185, v168, v169
v_cvt_pkrtz_f16_f32 v187, v170, v171
v_mfma_f32_16x16x32_f16 v[56:59], v[224:227], v[236:239], v[56:59]
v_cvt_pkrtz_f16_f32 v189, v172, v173
v_cvt_pkrtz_f16_f32 v191, v174, v175
v_mfma_f32_16x16x32_f16 v[52:55], v[228:231], v[232:235], v[52:55]
ds_read_b128 v[224:227], v248 offset:35840
v_cvt_pkrtz_f16_f32 v193, v176, v177
v_cvt_pk_f16_f32 v203, v178, v179
v_mfma_f32_16x16x32_f16 v[60:63], v[228:231], v[236:239], v[60:63]
v_cvt_pk_f16_f32 v200, v180, v181
v_cvt_pk_f16_f32 v197, v182, v183
s_setprio 1
v_mfma_f32_16x16x32_bf16 v[168:171], v[240:243], v[96:99], 0
ds_read_b128 v[228:231], v249 offset:32768
v_pk_fma_f16 v202, v203, v203, s48
v_and_b32 v185, s49, v185
v_mfma_f32_16x16x32_bf16 v[176:179], v[240:243], v[100:103], 0
v_pk_fma_f16 v199, v200, v200, s48
v_and_b32 v187, s49, v187
s_waitcnt lgkmcnt(3)
v_mfma_f32_16x16x32_f16 v[64:67], v[244:247], v[232:235], v[64:67]
ds_read_b128 v[240:243], v249 offset:33024
v_pk_fma_f16 v196, v197, v197, s48
v_bfe_u32 v184, v185, 2, 14
v_pk_mul_f16 v202, v203, v202
v_mfma_f32_16x16x32_f16 v[72:75], v[244:247], v[236:239], v[72:75]
v_bfe_u32 v186, v187, 2, 14
v_pk_mul_f16 v199, v200, v199
s_waitcnt vmcnt(11)
v_mfma_f32_16x16x32_bf16 v[48:51], v[18:21], v[4:7], v[48:51]
ds_read_b128 v[244:247], v248 offset:36096
ds_read_u16_d16 v184, v184
ds_read_u16_d16 v186, v186
v_lshrrev_b32 v185, 18, v185
v_pk_mul_f16 v196, v197, v196
v_mfma_f32_16x16x32_bf16 v[52:55], v[16:19], v[4:7], v[52:55]
v_lshrrev_b32_e64 v187, 18, v187
v_mfma_f32_16x16x32_bf16 v[172:175], v[40:43], v[96:99], 0
ds_read_u16_d16_hi v185, v185
ds_read_u16_d16_hi v187, v187
v_exp_f16 v201, v202
v_and_b32 v189, s49, v189
v_mfma_f32_16x16x32_bf16 v[180:183], v[40:43], v[100:103], 0
v_and_b32 v191, s49, v191
s_waitcnt lgkmcnt(6)
v_mfma_f32_16x16x32_f16 v[68:71], v[44:47], v[232:235], v[68:71]
ds_read_b128 v[40:43], v248 offset:36864
v_exp_f16_e64 v198, v199
v_bfe_u32 v188, v189, 2, 14
v_mfma_f32_16x16x32_f16 v[76:79], v[44:47], v[236:239], v[76:79]
v_bfe_u32 v190, v191, 2, 14
v_exp_f16_e64 v195, v196
v_mfma_f32_16x16x32_bf16 v[168:171], v[224:227], v[104:107], v[168:171]
ds_read_b128 v[44:47], v248 offset:37120
ds_read_u16_d16 v188, v188
ds_read_u16_d16 v190, v190
v_lshrrev_b32 v189, 18, v189
v_lshrrev_b32 v191, 18, v191
v_mfma_f32_16x16x32_bf16 v[176:179], v[224:227], v[108:111], v[176:179]
v_exp_f16_sdwa v201, v202 dst_sel:WORD_1 dst_unused:UNUSED_PRESERVE src0_sel:WORD_1
v_mfma_f32_16x16x32_f16 v[80:83], v[228:231], v[232:235], v[80:83]
ds_read_b128 v[224:227], v249 offset:36864
ds_read_u16_d16_hi v189, v189
ds_read_u16_d16_hi v191, v191
v_and_b32 v193, s49, v193
v_bfe_u32 v192, v193, 2, 14
v_mfma_f32_16x16x32_f16 v[88:91], v[228:231], v[236:239], v[88:91]
v_exp_f16_sdwa v198, v199 dst_sel:WORD_1 dst_unused:UNUSED_PRESERVE src0_sel:WORD_1
s_waitcnt lgkmcnt(7)
v_mfma_f32_16x16x32_f16 v[84:87], v[240:243], v[232:235], v[84:87]
ds_read_b128 v[228:231], v249 offset:37120
ds_read_u16_d16 v192, v192
v_lshrrev_b32_e64 v193, 18, v193
v_mfma_f32_16x16x32_f16 v[92:95], v[240:243], v[236:239], v[92:95]
v_exp_f16_sdwa v195, v196 dst_sel:WORD_1 dst_unused:UNUSED_PRESERVE src0_sel:WORD_1
v_pk_add_f16 v201, v201, 1.0 op_sel_hi:[1,0]
v_pk_add_f16 v198, v198, 1.0 op_sel_hi:[1,0]
v_mfma_f32_16x16x32_bf16 v[172:175], v[244:247], v[104:107], v[172:175]
ds_read_b128 v[240:243], v249 offset:12288
ds_read_u16_d16_hi v193, v193
v_pk_add_f16 v195, v195, 1.0 op_sel_hi:[1,0]
v_mfma_f32_16x16x32_bf16 v[180:183], v[244:247], v[108:111], v[180:183]
v_rcp_f16_e64 v202, v201
s_setprio 0
s_waitcnt lgkmcnt(7)
v_mfma_f32_16x16x32_bf16 v[168:171], v[40:43], v[112:115], v[168:171]
ds_read_b128 v[244:247], v249 offset:37888
v_rcp_f16_e64 v199, v198
v_mfma_f32_16x16x32_bf16 v[176:179], v[40:43], v[116:119], v[176:179]
v_rcp_f16_e64 v196, v195
v_mfma_f32_16x16x32_bf16 v[172:175], v[44:47], v[112:115], v[172:175]
ds_read_b128 v[40:43], v249 offset:12544
v_rcp_f16_sdwa v202, v201 dst_sel:WORD_1 dst_unused:UNUSED_PRESERVE src0_sel:WORD_1
v_mfma_f32_16x16x32_bf16 v[180:183], v[44:47], v[116:119], v[180:183]
v_rcp_f16_sdwa v199, v198 dst_sel:WORD_1 dst_unused:UNUSED_PRESERVE src0_sel:WORD_1
v_or_b32 v232, v184, v185
v_or_b32 v233, v186, v187
s_waitcnt lgkmcnt(4)
v_or_b32 v234, v188, v189
v_rcp_f16_sdwa v196, v195 dst_sel:WORD_1 dst_unused:UNUSED_PRESERVE src0_sel:WORD_1
v_or_b32 v235, v190, v191
s_waitcnt lgkmcnt(2)
v_or_b32 v236, v192, v193
v_pk_mul_f16 v237, v203, v202
v_pk_mul_f16 v238, v200, v199
v_pk_mul_f16 v239, v197, v196
s_setprio 3
v_mfma_f32_16x16x32_f16 v[48:51], v[224:227], v[232:235], v[48:51]
ds_read_b128 v[44:47], v249 offset:38144
v_cvt_pkrtz_f16_f32 v185, v168, v169
v_cvt_pkrtz_f16_f32 v187, v170, v171
v_mfma_f32_16x16x32_f16 v[56:59], v[224:227], v[236:239], v[56:59]
v_cvt_pkrtz_f16_f32 v189, v172, v173
v_cvt_pkrtz_f16_f32 v191, v174, v175
v_mfma_f32_16x16x32_f16 v[52:55], v[228:231], v[232:235], v[52:55]
ds_read_b128 v[224:227], v249 offset:13312
v_cvt_pkrtz_f16_f32 v193, v176, v177
v_cvt_pk_f16_f32 v203, v178, v179
v_mfma_f32_16x16x32_f16 v[60:63], v[228:231], v[236:239], v[60:63]
v_cvt_pk_f16_f32 v200, v180, v181
v_cvt_pk_f16_f32 v197, v182, v183
v_mfma_f32_16x16x32_bf16 v[168:171], v[240:243], v[96:99], 0
ds_read_b128 v[228:231], v249 offset:38912
v_pk_fma_f16 v202, v203, v203, s48
v_and_b32_e64 v185, s49, v185
v_mfma_f32_16x16x32_bf16 v[176:179], v[240:243], v[100:103], 0
v_pk_fma_f16 v199, v200, v200, s48
v_and_b32 v187, s49, v187
s_waitcnt lgkmcnt(3)
v_mfma_f32_16x16x32_f16 v[64:67], v[244:247], v[232:235], v[64:67]
ds_read_b128 v[240:243], v249 offset:39168
v_pk_fma_f16 v196, v197, v197, s48
v_bfe_u32 v184, v185, 2, 14
v_pk_mul_f16 v202, v203, v202
v_mfma_f32_16x16x32_f16 v[72:75], v[244:247], v[236:239], v[72:75]
v_bfe_u32 v186, v187, 2, 14
v_pk_mul_f16 v199, v200, v199
s_waitcnt vmcnt(10)
v_mfma_f32_16x16x32_bf16 v[64:67], v[18:21], v[0:3], v[64:67]
ds_read_b128 v[244:247], v249 offset:13568
ds_read_u16_d16 v184, v184
ds_read_u16_d16 v186, v186
v_lshrrev_b32 v185, 18, v185
v_pk_mul_f16 v196, v197, v196
v_mfma_f32_16x16x32_bf16 v[68:71], v[16:19], v[0:3], v[68:71]
v_lshrrev_b32_e64 v187, 18, v187
v_mfma_f32_16x16x32_bf16 v[172:175], v[40:43], v[96:99], 0
ds_read_u16_d16_hi v185, v185
ds_read_u16_d16_hi v187, v187
v_exp_f16 v201, v202
v_and_b32 v189, s49, v189
v_mfma_f32_16x16x32_bf16 v[180:183], v[40:43], v[100:103], 0
v_and_b32 v191, s49, v191
s_waitcnt lgkmcnt(6)
v_mfma_f32_16x16x32_f16 v[68:71], v[44:47], v[232:235], v[68:71]
ds_read_b128 v[40:43], v249 offset:14336
v_exp_f16_e64 v198, v199
v_bfe_u32 v188, v189, 2, 14
v_mfma_f32_16x16x32_f16 v[76:79], v[44:47], v[236:239], v[76:79]
v_bfe_u32 v190, v191, 2, 14
v_exp_f16_e64 v195, v196
v_mfma_f32_16x16x32_bf16 v[168:171], v[224:227], v[104:107], v[168:171]
ds_read_b128 v[44:47], v249 offset:14592
ds_read_u16_d16 v188, v188
ds_read_u16_d16 v190, v190
v_lshrrev_b32 v189, 18, v189
v_lshrrev_b32 v191, 18, v191
v_mfma_f32_16x16x32_bf16 v[176:179], v[224:227], v[108:111], v[176:179]
v_exp_f16_sdwa v201, v202 dst_sel:WORD_1 dst_unused:UNUSED_PRESERVE src0_sel:WORD_1
v_mfma_f32_16x16x32_f16 v[80:83], v[228:231], v[232:235], v[80:83]
ds_read_b128 v[224:227], v249 offset:43008
ds_read_u16_d16_hi v189, v189
ds_read_u16_d16_hi v191, v191
v_and_b32 v193, s49, v193
v_bfe_u32 v192, v193, 2, 14
v_mfma_f32_16x16x32_f16 v[88:91], v[228:231], v[236:239], v[88:91]
v_exp_f16_sdwa v198, v199 dst_sel:WORD_1 dst_unused:UNUSED_PRESERVE src0_sel:WORD_1
s_waitcnt lgkmcnt(7)
v_mfma_f32_16x16x32_f16 v[84:87], v[240:243], v[232:235], v[84:87]
ds_read_b128 v[228:231], v249 offset:43264
ds_read_u16_d16 v192, v192
v_lshrrev_b32_e64 v193, 18, v193
v_mfma_f32_16x16x32_f16 v[92:95], v[240:243], v[236:239], v[92:95]
v_exp_f16_sdwa v195, v196 dst_sel:WORD_1 dst_unused:UNUSED_PRESERVE src0_sel:WORD_1
v_pk_add_f16 v201, v201, 1.0 op_sel_hi:[1,0]
v_pk_add_f16 v198, v198, 1.0 op_sel_hi:[1,0]
v_mfma_f32_16x16x32_bf16 v[172:175], v[244:247], v[104:107], v[172:175]
ds_read_b128 v[240:243], v248 offset:16384
ds_read_u16_d16_hi v193, v193
v_pk_add_f16 v195, v195, 1.0 op_sel_hi:[1,0]
v_mfma_f32_16x16x32_bf16 v[180:183], v[244:247], v[108:111], v[180:183]
v_rcp_f16 v202, v201
s_waitcnt lgkmcnt(7)
v_mfma_f32_16x16x32_bf16 v[168:171], v[40:43], v[112:115], v[168:171]
ds_read_b128 v[244:247], v249 offset:44032
v_rcp_f16_e64 v199, v198
v_mfma_f32_16x16x32_bf16 v[176:179], v[40:43], v[116:119], v[176:179]
v_rcp_f16_e64 v196, v195
v_mfma_f32_16x16x32_bf16 v[172:175], v[44:47], v[112:115], v[172:175]
ds_read_b128 v[40:43], v248 offset:16640
v_rcp_f16_sdwa v202, v201 dst_sel:WORD_1 dst_unused:UNUSED_PRESERVE src0_sel:WORD_1
v_mfma_f32_16x16x32_bf16 v[180:183], v[44:47], v[116:119], v[180:183]
v_rcp_f16_sdwa v199, v198 dst_sel:WORD_1 dst_unused:UNUSED_PRESERVE src0_sel:WORD_1
v_or_b32 v232, v184, v185
v_or_b32 v233, v186, v187
s_waitcnt lgkmcnt(4)
v_or_b32 v234, v188, v189
v_rcp_f16_sdwa v196, v195 dst_sel:WORD_1 dst_unused:UNUSED_PRESERVE src0_sel:WORD_1
v_or_b32 v235, v190, v191
s_waitcnt lgkmcnt(2)
v_or_b32_e64 v236, v192, v193
v_pk_mul_f16 v237, v203, v202
v_pk_mul_f16 v238, v200, v199
v_pk_mul_f16 v239, v197, v196
v_mfma_f32_16x16x32_f16 v[48:51], v[224:227], v[232:235], v[48:51]
s_add_u32 s46, s80, 12582912
buffer_load_dwordx4 v[96:99], v253, s[32:35], s46 offen nt
ds_read_b128 v[44:47], v249 offset:44288
v_cvt_pkrtz_f16_f32 v185, v168, v169
v_cvt_pkrtz_f16_f32 v187, v170, v171
v_mfma_f32_16x16x32_f16 v[56:59], v[224:227], v[236:239], v[56:59]
v_cvt_pkrtz_f16_f32 v189, v172, v173
v_cvt_pkrtz_f16_f32 v191, v174, v175
v_mfma_f32_16x16x32_f16 v[52:55], v[228:231], v[232:235], v[52:55]
ds_read_b128 v[224:227], v248 offset:17408
v_cvt_pkrtz_f16_f32 v193, v176, v177
v_cvt_pk_f16_f32 v203, v178, v179
v_mfma_f32_16x16x32_f16 v[60:63], v[228:231], v[236:239], v[60:63]
v_cvt_pk_f16_f32 v200, v180, v181
v_cvt_pk_f16_f32 v197, v182, v183
v_mfma_f32_16x16x32_bf16 v[168:171], v[240:243], v[208:211], 0
ds_read_b128 v[228:231], v249 offset:45056
v_pk_fma_f16 v202, v203, v203, s48
v_and_b32_e64 v185, s49, v185
v_mfma_f32_16x16x32_bf16 v[176:179], v[240:243], v[212:215], 0
v_pk_fma_f16 v199, v200, v200, s48
v_and_b32 v187, s49, v187
s_waitcnt lgkmcnt(3)
v_mfma_f32_16x16x32_f16 v[64:67], v[244:247], v[232:235], v[64:67]
ds_read_b128 v[240:243], v249 offset:45312
v_pk_fma_f16 v196, v197, v197, s48
s_setprio 2
v_bfe_u32 v184, v185, 2, 14
v_pk_mul_f16 v202, v203, v202
v_mfma_f32_16x16x32_f16 v[72:75], v[244:247], v[236:239], v[72:75]
v_bfe_u32 v186, v187, 2, 14
v_pk_mul_f16 v199, v200, v199
s_waitcnt vmcnt(10)
v_mfma_f32_16x16x32_bf16 v[80:83], v[18:21], v[8:11], v[80:83]
ds_read_b128 v[244:247], v248 offset:17664
ds_read_u16_d16 v184, v184
ds_read_u16_d16 v186, v186
v_lshrrev_b32_e64 v185, 18, v185
v_pk_mul_f16 v196, v197, v196
v_mfma_f32_16x16x32_bf16 v[84:87], v[16:19], v[8:11], v[84:87]
v_lshrrev_b32_e64 v187, 18, v187
v_mfma_f32_16x16x32_bf16 v[172:175], v[40:43], v[208:211], 0
ds_read_u16_d16_hi v185, v185
ds_read_u16_d16_hi v187, v187
v_exp_f16 v201, v202
v_and_b32 v189, s49, v189
v_mfma_f32_16x16x32_bf16 v[180:183], v[40:43], v[212:215], 0
v_and_b32 v191, s49, v191
s_waitcnt lgkmcnt(6)
v_mfma_f32_16x16x32_f16 v[68:71], v[44:47], v[232:235], v[68:71]
ds_read_b128 v[40:43], v248 offset:18432
v_exp_f16_e64 v198, v199
v_bfe_u32 v188, v189, 2, 14
v_mfma_f32_16x16x32_f16 v[76:79], v[44:47], v[236:239], v[76:79]
v_bfe_u32 v190, v191, 2, 14
v_exp_f16_e64 v195, v196
v_mfma_f32_16x16x32_bf16 v[168:171], v[224:227], v[24:27], v[168:171]
ds_read_b128 v[44:47], v248 offset:18688
ds_read_u16_d16 v188, v188
ds_read_u16_d16 v190, v190
v_lshrrev_b32 v189, 18, v189
v_lshrrev_b32 v191, 18, v191
v_mfma_f32_16x16x32_bf16 v[176:179], v[224:227], v[28:31], v[176:179]
v_exp_f16_sdwa v201, v202 dst_sel:WORD_1 dst_unused:UNUSED_PRESERVE src0_sel:WORD_1
v_mfma_f32_16x16x32_f16 v[80:83], v[228:231], v[232:235], v[80:83]
ds_read_b128 v[224:227], v250 offset:20480
ds_read_u16_d16_hi v189, v189
ds_read_u16_d16_hi v191, v191
v_and_b32 v193, s49, v193
v_bfe_u32 v192, v193, 2, 14
v_mfma_f32_16x16x32_f16 v[88:91], v[228:231], v[236:239], v[88:91]
v_exp_f16_sdwa v198, v199 dst_sel:WORD_1 dst_unused:UNUSED_PRESERVE src0_sel:WORD_1
s_waitcnt lgkmcnt(7)
v_mfma_f32_16x16x32_f16 v[84:87], v[240:243], v[232:235], v[84:87]
ds_read_b128 v[228:231], v250 offset:20736
ds_read_u16_d16 v192, v192
v_lshrrev_b32_e64 v193, 18, v193
v_mfma_f32_16x16x32_f16 v[92:95], v[240:243], v[236:239], v[92:95]
v_exp_f16_sdwa v195, v196 dst_sel:WORD_1 dst_unused:UNUSED_PRESERVE src0_sel:WORD_1
v_pk_add_f16 v201, v201, 1.0 op_sel_hi:[1,0]
v_pk_add_f16 v198, v198, 1.0 op_sel_hi:[1,0]
v_mfma_f32_16x16x32_bf16 v[172:175], v[244:247], v[24:27], v[172:175]
ds_read_b128 v[240:243], v248 offset:22528
ds_read_u16_d16_hi v193, v193
v_pk_add_f16 v195, v195, 1.0 op_sel_hi:[1,0]
v_mfma_f32_16x16x32_bf16 v[180:183], v[244:247], v[28:31], v[180:183]
v_rcp_f16 v202, v201
s_waitcnt lgkmcnt(7)
v_mfma_f32_16x16x32_bf16 v[168:171], v[40:43], v[32:35], v[168:171]
ds_read_b128 v[244:247], v250 offset:21504
v_rcp_f16_e64 v199, v198
v_mfma_f32_16x16x32_bf16 v[176:179], v[40:43], v[36:39], v[176:179]
v_rcp_f16_e64 v196, v195
v_mfma_f32_16x16x32_bf16 v[172:175], v[44:47], v[32:35], v[172:175]
ds_read_b128 v[40:43], v248 offset:22784
v_rcp_f16_sdwa v202, v201 dst_sel:WORD_1 dst_unused:UNUSED_PRESERVE src0_sel:WORD_1
v_mfma_f32_16x16x32_bf16 v[180:183], v[44:47], v[36:39], v[180:183]
v_rcp_f16_sdwa v199, v198 dst_sel:WORD_1 dst_unused:UNUSED_PRESERVE src0_sel:WORD_1
v_or_b32 v232, v184, v185
v_or_b32 v233, v186, v187
s_waitcnt lgkmcnt(4)
v_or_b32 v234, v188, v189
v_rcp_f16_sdwa v196, v195 dst_sel:WORD_1 dst_unused:UNUSED_PRESERVE src0_sel:WORD_1
v_or_b32 v235, v190, v191
s_waitcnt lgkmcnt(2)
v_or_b32_e64 v236, v192, v193
v_pk_mul_f16 v237, v203, v202
v_pk_mul_f16 v238, v200, v199
v_pk_mul_f16 v239, v197, v196
v_mfma_f32_16x16x32_f16 v[48:51], v[224:227], v[232:235], v[48:51]
s_add_u32 s46, s80, 12582912
buffer_load_dwordx4 v[100:103], v253, s[32:35], s46 offen offset:256 nt
ds_read_b128 v[44:47], v250 offset:21760
v_cvt_pkrtz_f16_f32 v185, v168, v169
v_cvt_pkrtz_f16_f32 v187, v170, v171
v_mfma_f32_16x16x32_f16 v[56:59], v[224:227], v[236:239], v[56:59]
v_cvt_pkrtz_f16_f32 v189, v172, v173
v_cvt_pkrtz_f16_f32 v191, v174, v175
v_mfma_f32_16x16x32_f16 v[52:55], v[228:231], v[232:235], v[52:55]
ds_read_b128 v[224:227], v248 offset:23552
v_cvt_pkrtz_f16_f32 v193, v176, v177
v_cvt_pk_f16_f32 v203, v178, v179
v_mfma_f32_16x16x32_f16 v[60:63], v[228:231], v[236:239], v[60:63]
v_cvt_pk_f16_f32 v200, v180, v181
v_cvt_pk_f16_f32 v197, v182, v183
s_setprio 1
v_mfma_f32_16x16x32_bf16 v[168:171], v[240:243], v[208:211], 0
ds_read_b128 v[228:231], v250 offset:22528
v_pk_fma_f16 v202, v203, v203, s48
v_and_b32 v185, s49, v185
v_mfma_f32_16x16x32_bf16 v[176:179], v[240:243], v[212:215], 0
v_pk_fma_f16 v199, v200, v200, s48
v_and_b32 v187, s49, v187
s_waitcnt lgkmcnt(3)
v_mfma_f32_16x16x32_f16 v[64:67], v[244:247], v[232:235], v[64:67]
ds_read_b128 v[240:243], v250 offset:22784
v_pk_fma_f16 v196, v197, v197, s48
v_bfe_u32 v184, v185, 2, 14
v_pk_mul_f16 v202, v203, v202
v_mfma_f32_16x16x32_f16 v[72:75], v[244:247], v[236:239], v[72:75]
v_bfe_u32 v186, v187, 2, 14
v_pk_mul_f16 v199, v200, v199
s_waitcnt vmcnt(9)
v_mfma_f32_16x16x32_bf16 v[56:59], v[18:21], v[12:15], v[56:59]
ds_read_b128 v[244:247], v248 offset:23808
ds_read_u16_d16 v184, v184
ds_read_u16_d16 v186, v186
v_lshrrev_b32 v185, 18, v185
v_pk_mul_f16 v196, v197, v196
v_mfma_f32_16x16x32_bf16 v[60:63], v[16:19], v[12:15], v[60:63]
v_lshrrev_b32_e64 v187, 18, v187
v_mfma_f32_16x16x32_bf16 v[172:175], v[40:43], v[208:211], 0
ds_read_u16_d16_hi v185, v185
ds_read_u16_d16_hi v187, v187
v_exp_f16 v201, v202
v_and_b32 v189, s49, v189
v_mfma_f32_16x16x32_bf16 v[180:183], v[40:43], v[212:215], 0
v_and_b32 v191, s49, v191
s_waitcnt lgkmcnt(6)
v_mfma_f32_16x16x32_f16 v[68:71], v[44:47], v[232:235], v[68:71]
ds_read_b128 v[40:43], v248 offset:24576
v_exp_f16_e64 v198, v199
v_bfe_u32 v188, v189, 2, 14
v_mfma_f32_16x16x32_f16 v[76:79], v[44:47], v[236:239], v[76:79]
v_bfe_u32 v190, v191, 2, 14
v_exp_f16_e64 v195, v196
v_mfma_f32_16x16x32_bf16 v[168:171], v[224:227], v[24:27], v[168:171]
ds_read_b128 v[44:47], v248 offset:24832
ds_read_u16_d16 v188, v188
ds_read_u16_d16 v190, v190
v_lshrrev_b32 v189, 18, v189
v_lshrrev_b32 v191, 18, v191
v_mfma_f32_16x16x32_bf16 v[176:179], v[224:227], v[28:31], v[176:179]
v_exp_f16_sdwa v201, v202 dst_sel:WORD_1 dst_unused:UNUSED_PRESERVE src0_sel:WORD_1
v_mfma_f32_16x16x32_f16 v[80:83], v[228:231], v[232:235], v[80:83]
ds_read_b128 v[224:227], v249 offset:24576
ds_read_u16_d16_hi v189, v189
ds_read_u16_d16_hi v191, v191
v_and_b32_e64 v193, s49, v193
v_bfe_u32 v192, v193, 2, 14
v_mfma_f32_16x16x32_f16 v[88:91], v[228:231], v[236:239], v[88:91]
v_exp_f16_sdwa v198, v199 dst_sel:WORD_1 dst_unused:UNUSED_PRESERVE src0_sel:WORD_1
s_waitcnt lgkmcnt(7)
v_mfma_f32_16x16x32_f16 v[84:87], v[240:243], v[232:235], v[84:87]
ds_read_b128 v[228:231], v254 offset:7936
ds_read_u16_d16 v192, v192
v_lshrrev_b32 v193, 18, v193
v_mfma_f32_16x16x32_f16 v[92:95], v[240:243], v[236:239], v[92:95]
v_exp_f16_sdwa v195, v196 dst_sel:WORD_1 dst_unused:UNUSED_PRESERVE src0_sel:WORD_1
v_pk_add_f16 v201, v201, 1.0 op_sel_hi:[1,0]
v_pk_add_f16 v198, v198, 1.0 op_sel_hi:[1,0]
v_mfma_f32_16x16x32_bf16 v[172:175], v[244:247], v[24:27], v[172:175]
ds_read_b128 v[240:243], v249 offset:24832
ds_read_u16_d16_hi v193, v193
v_pk_add_f16 v195, v195, 1.0 op_sel_hi:[1,0]
v_mfma_f32_16x16x32_bf16 v[180:183], v[244:247], v[28:31], v[180:183]
v_rcp_f16_e64 v202, v201
s_setprio 0
s_waitcnt lgkmcnt(7)
v_mfma_f32_16x16x32_bf16 v[168:171], v[40:43], v[32:35], v[168:171]
ds_read_b128 v[244:247], v254 offset:7952
v_rcp_f16_e64 v199, v198
v_mfma_f32_16x16x32_bf16 v[176:179], v[40:43], v[36:39], v[176:179]
v_rcp_f16_e64 v196, v195
v_mfma_f32_16x16x32_bf16 v[172:175], v[44:47], v[32:35], v[172:175]
ds_read_b128 v[40:43], v248 offset:28672
v_rcp_f16_sdwa v202, v201 dst_sel:WORD_1 dst_unused:UNUSED_PRESERVE src0_sel:WORD_1
v_mfma_f32_16x16x32_bf16 v[180:183], v[44:47], v[36:39], v[180:183]
v_rcp_f16_sdwa v199, v198 dst_sel:WORD_1 dst_unused:UNUSED_PRESERVE src0_sel:WORD_1
v_or_b32 v232, v184, v185
v_or_b32 v233, v186, v187
s_waitcnt lgkmcnt(4)
v_or_b32 v234, v188, v189
v_rcp_f16_sdwa v196, v195 dst_sel:WORD_1 dst_unused:UNUSED_PRESERVE src0_sel:WORD_1
v_or_b32 v235, v190, v191
s_waitcnt lgkmcnt(2)
v_or_b32_e64 v236, v192, v193
v_pk_mul_f16 v237, v203, v202
v_pk_mul_f16 v238, v200, v199
v_pk_mul_f16 v239, v197, v196
s_setprio 3
v_mfma_f32_16x16x32_f16 v[120:123], v[224:227], v[232:235], v[228:231]
s_add_u32 s46, s80, 16777216
buffer_load_dwordx4 v[104:107], v253, s[32:35], s46 offen nt
ds_read_b128 v[44:47], v249 offset:25600
v_cvt_pkrtz_f16_f32 v185, v168, v169
v_cvt_pkrtz_f16_f32 v187, v170, v171
v_mfma_f32_16x16x32_f16 v[128:131], v[224:227], v[236:239], v[228:231]
v_cvt_pkrtz_f16_f32 v189, v172, v173
v_cvt_pkrtz_f16_f32 v191, v174, v175
s_waitcnt lgkmcnt(1)
v_mfma_f32_16x16x32_f16 v[124:127], v[240:243], v[232:235], v[244:247]
ds_read_b128 v[224:227], v254 offset:8064
ds_read_b128 v[228:231], v248 offset:28928
v_cvt_pkrtz_f16_f32 v193, v176, v177
v_cvt_pk_f16_f32 v203, v178, v179
v_mfma_f32_16x16x32_f16 v[132:135], v[240:243], v[236:239], v[244:247]
v_cvt_pk_f16_f32 v200, v180, v181
v_cvt_pk_f16_f32 v197, v182, v183
v_mfma_f32_16x16x32_bf16 v[168:171], v[40:43], v[208:211], 0
ds_read_b128 v[240:243], v249 offset:25856
ds_read_b128 v[244:247], v254 offset:8080
v_pk_fma_f16 v202, v203, v203, s48
v_and_b32_e64 v185, s49, v185
v_mfma_f32_16x16x32_bf16 v[176:179], v[40:43], v[212:215], 0
v_pk_fma_f16 v199, v200, v200, s48
v_and_b32 v187, s49, v187
s_waitcnt lgkmcnt(3)
v_mfma_f32_16x16x32_f16 v[136:139], v[44:47], v[232:235], v[224:227]
ds_read_b128 v[40:43], v248 offset:29696
v_pk_fma_f16 v196, v197, v197, s48
v_bfe_u32 v184, v185, 2, 14
v_pk_mul_f16 v202, v203, v202
v_mfma_f32_16x16x32_f16 v[144:147], v[44:47], v[236:239], v[224:227]
v_bfe_u32 v186, v187, 2, 14
v_pk_mul_f16 v199, v200, v199
s_waitcnt vmcnt(7)
v_mfma_f32_16x16x32_bf16 v[72:75], v[18:21], v[216:219], v[72:75]
ds_read_b128 v[44:47], v249 offset:26624
ds_read_b128 v[224:227], v254 offset:16128
ds_read_u16_d16 v184, v184
ds_read_u16_d16 v186, v186
v_lshrrev_b32 v185, 18, v185
v_pk_mul_f16 v196, v197, v196
v_mfma_f32_16x16x32_bf16 v[76:79], v[16:19], v[216:219], v[76:79]
v_lshrrev_b32 v187, 18, v187
s_waitcnt lgkmcnt(5)
v_mfma_f32_16x16x32_bf16 v[172:175], v[228:231], v[208:211], 0
ds_read_u16_d16_hi v185, v185
ds_read_u16_d16_hi v187, v187
v_exp_f16 v201, v202
v_and_b32 v189, s49, v189
v_mfma_f32_16x16x32_bf16 v[180:183], v[228:231], v[212:215], 0
v_and_b32_e64 v191, s49, v191
v_mfma_f32_16x16x32_f16 v[140:143], v[240:243], v[232:235], v[244:247]
ds_read_b128 v[228:231], v249 offset:26880
v_exp_f16_e64 v198, v199
v_bfe_u32 v188, v189, 2, 14
v_mfma_f32_16x16x32_f16 v[148:151], v[240:243], v[236:239], v[244:247]
v_bfe_u32 v190, v191, 2, 14
v_exp_f16 v195, v196
s_waitcnt lgkmcnt(7)
v_mfma_f32_16x16x32_bf16 v[168:171], v[40:43], v[24:27], v[168:171]
ds_read_b128 v[240:243], v254 offset:16144
ds_read_b128 v[244:247], v248 offset:29952
ds_read_u16_d16 v188, v188
ds_read_u16_d16 v190, v190
v_lshrrev_b32_e64 v189, 18, v189
v_lshrrev_b32 v191, 18, v191
v_mfma_f32_16x16x32_bf16 v[176:179], v[40:43], v[28:31], v[176:179]
v_exp_f16_sdwa v201, v202 dst_sel:WORD_1 dst_unused:UNUSED_PRESERVE src0_sel:WORD_1
s_waitcnt lgkmcnt(7)
v_mfma_f32_16x16x32_f16 v[152:155], v[44:47], v[232:235], v[224:227]
ds_read_b128 v[40:43], v248 offset:30720
ds_read_u16_d16_hi v189, v189
ds_read_u16_d16_hi v191, v191
v_and_b32 v193, s49, v193
v_bfe_u32 v192, v193, 2, 14
v_mfma_f32_16x16x32_f16 v[160:163], v[44:47], v[236:239], v[224:227]
v_exp_f16_sdwa v198, v199 dst_sel:WORD_1 dst_unused:UNUSED_PRESERVE src0_sel:WORD_1
s_waitcnt lgkmcnt(6)
v_mfma_f32_16x16x32_f16 v[156:159], v[228:231], v[232:235], v[240:243]
ds_read_b128 v[44:47], v248 offset:30976
ds_read_b128 v[224:227], v249 offset:30720
ds_read_u16_d16 v192, v192
v_lshrrev_b32 v193, 18, v193
v_mfma_f32_16x16x32_f16 v[164:167], v[228:231], v[236:239], v[240:243]
v_exp_f16_sdwa v195, v196 dst_sel:WORD_1 dst_unused:UNUSED_PRESERVE src0_sel:WORD_1
v_pk_add_f16 v201, v201, 1.0 op_sel_hi:[1,0]
v_pk_add_f16 v198, v198, 1.0 op_sel_hi:[1,0]
s_waitcnt lgkmcnt(7)
v_mfma_f32_16x16x32_bf16 v[172:175], v[244:247], v[24:27], v[172:175]
ds_read_b128 v[228:231], v249 offset:30976
ds_read_b128 v[240:243], v248 offset:40960
ds_read_u16_d16_hi v193, v193
v_pk_add_f16 v195, v195, 1.0 op_sel_hi:[1,0]
v_mfma_f32_16x16x32_bf16 v[180:183], v[244:247], v[28:31], v[180:183]
v_rcp_f16 v202, v201
s_waitcnt lgkmcnt(8)
v_mfma_f32_16x16x32_bf16 v[168:171], v[40:43], v[32:35], v[168:171]
ds_read_b128 v[244:247], v249 offset:31744
v_rcp_f16_e64 v199, v198
v_mfma_f32_16x16x32_bf16 v[176:179], v[40:43], v[36:39], v[176:179]
v_rcp_f16 v196, v195
s_waitcnt lgkmcnt(6)
v_mfma_f32_16x16x32_bf16 v[172:175], v[44:47], v[32:35], v[172:175]
ds_read_b128 v[40:43], v248 offset:41216
v_rcp_f16_sdwa v202, v201 dst_sel:WORD_1 dst_unused:UNUSED_PRESERVE src0_sel:WORD_1
v_mfma_f32_16x16x32_bf16 v[180:183], v[44:47], v[36:39], v[180:183]
v_rcp_f16_sdwa v199, v198 dst_sel:WORD_1 dst_unused:UNUSED_PRESERVE src0_sel:WORD_1
v_or_b32 v232, v184, v185
v_or_b32 v233, v186, v187
v_or_b32_e64 v234, v188, v189
v_rcp_f16_sdwa v196, v195 dst_sel:WORD_1 dst_unused:UNUSED_PRESERVE src0_sel:WORD_1
v_or_b32 v235, v190, v191
s_waitcnt lgkmcnt(2)
v_or_b32_e64 v236, v192, v193
v_pk_mul_f16 v237, v203, v202
v_pk_mul_f16 v238, v200, v199
v_pk_mul_f16 v239, v197, v196
v_mfma_f32_16x16x32_f16 v[120:123], v[224:227], v[232:235], v[120:123]
s_add_u32 s46, s80, 16777216
buffer_load_dwordx4 v[108:111], v253, s[32:35], s46 offen offset:256 nt
ds_read_b128 v[44:47], v249 offset:32000
v_cvt_pkrtz_f16_f32 v185, v168, v169
v_cvt_pkrtz_f16_f32 v187, v170, v171
v_mfma_f32_16x16x32_f16 v[128:131], v[224:227], v[236:239], v[128:131]
v_cvt_pkrtz_f16_f32 v189, v172, v173
v_cvt_pkrtz_f16_f32 v191, v174, v175
v_mfma_f32_16x16x32_f16 v[124:127], v[228:231], v[232:235], v[124:127]
ds_read_b128 v[224:227], v248 offset:41984
v_cvt_pkrtz_f16_f32 v193, v176, v177
v_cvt_pk_f16_f32 v203, v178, v179
v_mfma_f32_16x16x32_f16 v[132:135], v[228:231], v[236:239], v[132:135]
v_cvt_pk_f16_f32 v200, v180, v181
v_cvt_pk_f16_f32 v197, v182, v183
v_mfma_f32_16x16x32_bf16 v[168:171], v[240:243], v[208:211], 0
ds_read_b128 v[228:231], v249 offset:32768
v_pk_fma_f16 v202, v203, v203, s48
v_and_b32_e64 v185, s49, v185
v_mfma_f32_16x16x32_bf16 v[176:179], v[240:243], v[212:215], 0
v_pk_fma_f16 v199, v200, v200, s48
v_and_b32 v187, s49, v187
s_waitcnt lgkmcnt(3)
v_mfma_f32_16x16x32_f16 v[136:139], v[244:247], v[232:235], v[136:139]
ds_read_b128 v[240:243], v249 offset:33024
v_pk_fma_f16 v196, v197, v197, s48
s_setprio 2
v_bfe_u32 v184, v185, 2, 14
v_pk_mul_f16 v202, v203, v202
v_mfma_f32_16x16x32_f16 v[144:147], v[244:247], v[236:239], v[144:147]
v_bfe_u32 v186, v187, 2, 14
v_pk_mul_f16 v199, v200, v199
s_waitcnt vmcnt(7)
v_mfma_f32_16x16x32_bf16 v[88:91], v[18:21], v[204:207], v[88:91]
ds_read_b128 v[244:247], v248 offset:42240
ds_read_u16_d16 v184, v184
ds_read_u16_d16 v186, v186
v_lshrrev_b32_e64 v185, 18, v185
v_pk_mul_f16 v196, v197, v196
v_mfma_f32_16x16x32_bf16 v[92:95], v[16:19], v[204:207], v[92:95]
v_lshrrev_b32_e64 v187, 18, v187
v_mfma_f32_16x16x32_bf16 v[172:175], v[40:43], v[208:211], 0
ds_read_u16_d16_hi v185, v185
ds_read_u16_d16_hi v187, v187
v_exp_f16 v201, v202
v_and_b32 v189, s49, v189
v_mfma_f32_16x16x32_bf16 v[180:183], v[40:43], v[212:215], 0
v_and_b32 v191, s49, v191
s_waitcnt lgkmcnt(6)
v_mfma_f32_16x16x32_f16 v[140:143], v[44:47], v[232:235], v[140:143]
ds_read_b128 v[40:43], v248 offset:43008
v_exp_f16_e64 v198, v199
v_bfe_u32 v188, v189, 2, 14
v_mfma_f32_16x16x32_f16 v[148:151], v[44:47], v[236:239], v[148:151]
v_bfe_u32 v190, v191, 2, 14
v_exp_f16_e64 v195, v196
v_mfma_f32_16x16x32_bf16 v[168:171], v[224:227], v[24:27], v[168:171]
ds_read_b128 v[44:47], v248 offset:43264
ds_read_u16_d16 v188, v188
ds_read_u16_d16 v190, v190
v_lshrrev_b32 v189, 18, v189
v_lshrrev_b32 v191, 18, v191
v_mfma_f32_16x16x32_bf16 v[176:179], v[224:227], v[28:31], v[176:179]
v_exp_f16_sdwa v201, v202 dst_sel:WORD_1 dst_unused:UNUSED_PRESERVE src0_sel:WORD_1
v_mfma_f32_16x16x32_f16 v[152:155], v[228:231], v[232:235], v[152:155]
ds_read_b128 v[224:227], v249 offset:36864
ds_read_u16_d16_hi v189, v189
ds_read_u16_d16_hi v191, v191
v_and_b32 v193, s49, v193
v_bfe_u32 v192, v193, 2, 14
v_mfma_f32_16x16x32_f16 v[160:163], v[228:231], v[236:239], v[160:163]
v_exp_f16_sdwa v198, v199 dst_sel:WORD_1 dst_unused:UNUSED_PRESERVE src0_sel:WORD_1
s_waitcnt lgkmcnt(7)
v_mfma_f32_16x16x32_f16 v[156:159], v[240:243], v[232:235], v[156:159]
ds_read_b128 v[228:231], v249 offset:37120
ds_read_u16_d16 v192, v192
v_lshrrev_b32_e64 v193, 18, v193
v_mfma_f32_16x16x32_f16 v[164:167], v[240:243], v[236:239], v[164:167]
v_exp_f16_sdwa v195, v196 dst_sel:WORD_1 dst_unused:UNUSED_PRESERVE src0_sel:WORD_1
v_pk_add_f16 v201, v201, 1.0 op_sel_hi:[1,0]
v_pk_add_f16 v198, v198, 1.0 op_sel_hi:[1,0]
v_mfma_f32_16x16x32_bf16 v[172:175], v[244:247], v[24:27], v[172:175]
ds_read_b128 v[240:243], v248 offset:34816
ds_read_u16_d16_hi v193, v193
v_pk_add_f16 v195, v195, 1.0 op_sel_hi:[1,0]
v_mfma_f32_16x16x32_bf16 v[180:183], v[244:247], v[28:31], v[180:183]
v_rcp_f16 v202, v201
s_waitcnt lgkmcnt(7)
v_mfma_f32_16x16x32_bf16 v[168:171], v[40:43], v[32:35], v[168:171]
ds_read_b128 v[244:247], v249 offset:37888
v_rcp_f16_e64 v199, v198
v_mfma_f32_16x16x32_bf16 v[176:179], v[40:43], v[36:39], v[176:179]
v_rcp_f16_e64 v196, v195
v_mfma_f32_16x16x32_bf16 v[172:175], v[44:47], v[32:35], v[172:175]
ds_read_b128 v[40:43], v248 offset:35072
v_rcp_f16_sdwa v202, v201 dst_sel:WORD_1 dst_unused:UNUSED_PRESERVE src0_sel:WORD_1
v_mfma_f32_16x16x32_bf16 v[180:183], v[44:47], v[36:39], v[180:183]
v_rcp_f16_sdwa v199, v198 dst_sel:WORD_1 dst_unused:UNUSED_PRESERVE src0_sel:WORD_1
v_or_b32 v232, v184, v185
v_or_b32 v233, v186, v187
s_waitcnt lgkmcnt(4)
v_or_b32 v234, v188, v189
v_rcp_f16_sdwa v196, v195 dst_sel:WORD_1 dst_unused:UNUSED_PRESERVE src0_sel:WORD_1
v_or_b32 v235, v190, v191
s_waitcnt lgkmcnt(2)
v_or_b32_e64 v236, v192, v193
v_pk_mul_f16 v237, v203, v202
v_pk_mul_f16 v238, v200, v199
v_pk_mul_f16 v239, v197, v196
v_mfma_f32_16x16x32_f16 v[120:123], v[224:227], v[232:235], v[120:123]
s_add_u32 s46, s80, 20971520
buffer_load_dwordx4 v[112:115], v253, s[32:35], s46 offen nt
ds_read_b128 v[44:47], v249 offset:38144
v_cvt_pkrtz_f16_f32 v185, v168, v169
v_cvt_pkrtz_f16_f32 v187, v170, v171
v_cvt_pkrtz_f16_f32 v189, v172, v173
v_mfma_f32_16x16x32_f16 v[128:131], v[224:227], v[236:239], v[128:131]
v_cvt_pkrtz_f16_f32 v191, v174, v175
v_cvt_pkrtz_f16_f32 v193, v176, v177
v_cvt_pkrtz_f16_f32 v195, v178, v179
v_mfma_f32_16x16x32_f16 v[124:127], v[228:231], v[232:235], v[124:127]
ds_read_b128 v[224:227], v248 offset:35840
v_cvt_pk_f16_f32 v203, v180, v181
v_cvt_pk_f16_f32 v200, v182, v183
s_setprio 1
v_pk_fma_f16 v202, v203, v203, s48
v_mfma_f32_16x16x32_f16 v[132:135], v[228:231], v[236:239], v[132:135]
v_cvt_pk_bf16_f32 v64, v64, v65
v_and_b32 v185, s49, v185
v_cvt_pk_bf16_f32 v65, v66, v67
v_mfma_f32_16x16x32_bf16 v[168:171], v[240:243], v[208:211], 0
ds_read_b128 v[228:231], v249 offset:38912
v_and_b32 v187, s49, v187
v_cvt_pk_bf16_f32 v66, v68, v69
v_pk_fma_f16 v199, v200, v200, s48
v_mfma_f32_16x16x32_bf16 v[176:179], v[240:243], v[212:215], 0
v_bfe_u32 v184, v185, 2, 14
v_cvt_pk_bf16_f32 v67, v70, v71
v_pk_mul_f16 v202, v203, v202
s_waitcnt lgkmcnt(2)
v_mfma_f32_16x16x32_f16 v[136:139], v[244:247], v[232:235], v[136:139]
ds_read_b128 v[240:243], v249 offset:39168
ds_read_u16_d16 v184, v184
v_cvt_pk_bf16_f32 v48, v48, v49
v_bfe_u32 v186, v187, 2, 14
v_cvt_pk_bf16_f32 v49, v50, v51
v_mfma_f32_16x16x32_f16 v[144:147], v[244:247], v[236:239], v[144:147]
v_pk_mul_f16 v199, v200, v199
v_lshrrev_b32_e64 v185, 18, v185
v_cvt_pk_bf16_f32 v50, v52, v53
v_mfma_f32_16x16x32_bf16 v[172:175], v[40:43], v[208:211], 0
ds_read_b128 v[244:247], v248 offset:36096
ds_read_u16_d16 v186, v186
ds_read_u16_d16_hi v185, v185
v_exp_f16_e64 v201, v202
v_cvt_pk_bf16_f32 v51, v54, v55
v_mfma_f32_16x16x32_bf16 v[180:183], v[40:43], v[212:215], 0
v_lshrrev_b32_e64 v187, 18, v187
v_cvt_pk_bf16_f32 v80, v80, v81
v_and_b32_e64 v189, s49, v189
v_mfma_f32_16x16x32_f16 v[140:143], v[44:47], v[232:235], v[140:143]
ds_read_b128 v[40:43], v248 offset:36864
ds_read_u16_d16_hi v187, v187
v_cvt_pk_bf16_f32 v81, v82, v83
v_exp_f16_e64 v198, v199
v_mfma_f32_16x16x32_f16 v[148:151], v[44:47], v[236:239], v[148:151]
v_cvt_pk_bf16_f32 v82, v84, v85
v_and_b32_e64 v191, s49, v191
v_cvt_pk_bf16_f32 v83, v86, v87
s_mov_b64 vcc, s[74:75]
s_waitcnt lgkmcnt(5)
v_mfma_f32_16x16x32_bf16 v[168:171], v[224:227], v[24:27], v[168:171]
ds_read_b128 v[44:47], v248 offset:37120
v_bfe_u32 v188, v189, 2, 14
v_cndmask_b32 v68, v48, v80, vcc
v_mfma_f32_16x16x32_bf16 v[176:179], v[224:227], v[28:31], v[176:179]
v_exp_f16_sdwa v201, v202 dst_sel:WORD_1 dst_unused:UNUSED_PRESERVE src0_sel:WORD_1
v_cndmask_b32 v69, v49, v81, vcc
v_bfe_u32 v190, v191, 2, 14
v_mfma_f32_16x16x32_f16 v[152:155], v[228:231], v[232:235], v[152:155]
ds_read_b128 v[224:227], v249 offset:49152
ds_read_u16_d16 v188, v188
ds_read_u16_d16 v190, v190
v_cndmask_b32 v70, v50, v82, vcc
v_lshrrev_b32 v189, 18, v189
v_cndmask_b32 v71, v51, v83, vcc
v_mfma_f32_16x16x32_f16 v[160:163], v[228:231], v[236:239], v[160:163]
v_lshrrev_b32 v191, 18, v191
v_exp_f16_sdwa v198, v199 dst_sel:WORD_1 dst_unused:UNUSED_PRESERVE src0_sel:WORD_1
v_mfma_f32_16x16x32_f16 v[156:159], v[240:243], v[232:235], v[156:159]
ds_read_b128 v[228:231], v249 offset:49408
ds_read_u16_d16_hi v189, v189
ds_read_u16_d16_hi v191, v191
v_cndmask_b32_dpp v48, v64, v48, vcc quad_perm:[1,0,3,2] row_mask:0xf bank_mask:0xf
v_cndmask_b32_dpp v49, v65, v49, vcc quad_perm:[1,0,3,2] row_mask:0xf bank_mask:0xf
v_and_b32_e64 v193, s49, v193
v_mfma_f32_16x16x32_f16 v[164:167], v[240:243], v[236:239], v[164:167]
v_cndmask_b32_dpp v50, v66, v50, vcc quad_perm:[1,0,3,2] row_mask:0xf bank_mask:0xf
v_and_b32 v195, s49, v195
v_pk_add_f16 v201, v201, 1.0 op_sel_hi:[1,0]
s_waitcnt lgkmcnt(6)
v_mfma_f32_16x16x32_bf16 v[172:175], v[244:247], v[24:27], v[172:175]
ds_read_b128 v[240:243], v248 offset:47104
v_cndmask_b32_dpp v51, v67, v51, vcc quad_perm:[1,0,3,2] row_mask:0xf bank_mask:0xf
s_not_b64 vcc, s[74:75]
v_bfe_u32 v192, v193, 2, 14
s_setprio 0
v_cndmask_b32_dpp v80, v64, v80, vcc quad_perm:[1,0,3,2] row_mask:0xf bank_mask:0xf
v_mfma_f32_16x16x32_bf16 v[180:183], v[244:247], v[28:31], v[180:183]
v_pk_add_f16 v198, v198, 1.0 op_sel_hi:[1,0]
v_cndmask_b32_dpp v81, v65, v81, vcc quad_perm:[1,0,3,2] row_mask:0xf bank_mask:0xf
v_bfe_u32 v194, v195, 2, 14
v_mfma_f32_16x16x32_bf16 v[168:171], v[40:43], v[32:35], v[168:171]
ds_read_b128 v[244:247], v249 offset:50176
ds_read_u16_d16 v192, v192
ds_read_u16_d16 v194, v194
v_rcp_f16_e64 v202, v201
v_cndmask_b32_dpp v82, v66, v82, vcc quad_perm:[1,0,3,2] row_mask:0xf bank_mask:0xf
v_mfma_f32_16x16x32_bf16 v[176:179], v[40:43], v[36:39], v[176:179]
v_cndmask_b32_dpp v83, v67, v83, vcc quad_perm:[1,0,3,2] row_mask:0xf bank_mask:0xf
v_lshrrev_b32 v193, 18, v193
v_lshrrev_b32 v195, 18, v195
v_mfma_f32_16x16x32_bf16 v[172:175], v[44:47], v[32:35], v[172:175]
ds_read_b128 v[40:43], v248 offset:47360
buffer_store_dwordx4 v[48:51], v255, s[8:11], s70 offen sc1
ds_read_u16_d16_hi v193, v193
ds_read_u16_d16_hi v195, v195
v_rcp_f16_e64 v199, v198
v_mfma_f32_16x16x32_bf16 v[180:183], v[44:47], v[36:39], v[180:183]
v_rcp_f16_sdwa v202, v201 dst_sel:WORD_1 dst_unused:UNUSED_PRESERVE src0_sel:WORD_1
v_or_b32 v232, v184, v185
v_or_b32 v233, v186, v187
s_waitcnt lgkmcnt(6)
v_or_b32 v234, v188, v189
v_rcp_f16_sdwa v199, v198 dst_sel:WORD_1 dst_unused:UNUSED_PRESERVE src0_sel:WORD_1
v_or_b32 v235, v190, v191
s_waitcnt lgkmcnt(1)
v_or_b32 v236, v192, v193
s_waitcnt lgkmcnt(0)
v_or_b32 v237, v194, v195
v_pk_mul_f16 v238, v203, v202
v_pk_mul_f16 v239, v200, v199
s_setprio 3
v_mfma_f32_16x16x32_f16 v[120:123], v[224:227], v[232:235], v[120:123]
buffer_store_dwordx4 v[68:71], v255, s[8:11], s70 offen offset:128 sc1
ds_read_b128 v[44:47], v249 offset:50432
v_cvt_pkrtz_f16_f32 v185, v168, v169
v_cvt_pkrtz_f16_f32 v187, v170, v171
v_mfma_f32_16x16x32_f16 v[128:131], v[224:227], v[236:239], v[128:131]
v_cvt_pkrtz_f16_f32 v189, v172, v173
v_cvt_pkrtz_f16_f32 v191, v174, v175
v_mfma_f32_16x16x32_f16 v[124:127], v[228:231], v[232:235], v[124:127]
ds_read_b128 v[224:227], v248 offset:48128
v_cvt_pkrtz_f16_f32 v193, v176, v177
v_cvt_pk_f16_f32 v203, v178, v179
v_cvt_pk_f16_f32 v200, v180, v181
v_mfma_f32_16x16x32_f16 v[132:135], v[228:231], v[236:239], v[132:135]
v_cvt_pk_f16_f32 v197, v182, v183
v_pk_fma_f16 v202, v203, v203, s48
v_mfma_f32_16x16x32_bf16 v[168:171], v[240:243], v[208:211], 0
ds_read_b128 v[228:231], v249 offset:51200
v_and_b32_e64 v185, s49, v185
v_pk_fma_f16 v199, v200, v200, s48
v_mfma_f32_16x16x32_bf16 v[176:179], v[240:243], v[212:215], 0
v_and_b32_e64 v187, s49, v187
v_pk_fma_f16 v196, v197, v197, s48
v_bfe_u32 v184, v185, 2, 14
v_mfma_f32_16x16x32_f16 v[136:139], v[244:247], v[232:235], v[136:139]
ds_read_b128 v[240:243], v249 offset:51456
ds_read_u16_d16 v184, v184
v_pk_mul_f16 v202, v203, v202
v_bfe_u32 v186, v187, 2, 14
v_mfma_f32_16x16x32_f16 v[144:147], v[244:247], v[236:239], v[144:147]
v_pk_mul_f16 v199, v200, v199
v_lshrrev_b32_e64 v185, 18, v185
v_mfma_f32_16x16x32_bf16 v[172:175], v[40:43], v[208:211], 0
ds_read_b128 v[244:247], v248 offset:48384
ds_read_u16_d16 v186, v186
ds_read_u16_d16_hi v185, v185
v_pk_mul_f16 v196, v197, v196
v_lshrrev_b32_e64 v187, 18, v187
v_mfma_f32_16x16x32_bf16 v[180:183], v[40:43], v[212:215], 0
v_exp_f16_e64 v201, v202
v_and_b32 v189, s49, v189
s_waitcnt lgkmcnt(6)
v_mfma_f32_16x16x32_f16 v[140:143], v[44:47], v[232:235], v[140:143]
ds_read_b128 v[40:43], v248 offset:49152
ds_read_u16_d16_hi v187, v187
v_and_b32_e64 v191, s49, v191
v_mfma_f32_16x16x32_f16 v[148:151], v[44:47], v[236:239], v[148:151]
v_exp_f16_e64 v198, v199
v_bfe_u32 v188, v189, 2, 14
v_bfe_u32 v190, v191, 2, 14
v_mfma_f32_16x16x32_bf16 v[168:171], v[224:227], v[24:27], v[168:171]
s_add_u32 s46, s80, 20971520
buffer_load_dwordx4 v[116:119], v253, s[32:35], s46 offen offset:256 nt
ds_read_b128 v[44:47], v248 offset:49408
ds_read_u16_d16 v188, v188
ds_read_u16_d16 v190, v190
v_exp_f16_e64 v195, v196
v_mfma_f32_16x16x32_bf16 v[176:179], v[224:227], v[28:31], v[176:179]
v_lshrrev_b32_e64 v189, 18, v189
v_lshrrev_b32 v191, 18, v191
s_waitcnt lgkmcnt(5)
v_mfma_f32_16x16x32_f16 v[152:155], v[228:231], v[232:235], v[152:155]
ds_read_b128 v[224:227], v249 offset:43008
ds_read_u16_d16_hi v189, v189
ds_read_u16_d16_hi v191, v191
v_exp_f16_sdwa v201, v202 dst_sel:WORD_1 dst_unused:UNUSED_PRESERVE src0_sel:WORD_1
v_and_b32_e64 v193, s49, v193
v_mfma_f32_16x16x32_f16 v[160:163], v[228:231], v[236:239], v[160:163]
v_bfe_u32 v192, v193, 2, 14
v_mfma_f32_16x16x32_f16 v[156:159], v[240:243], v[232:235], v[156:159]
ds_read_b128 v[228:231], v249 offset:43264
ds_read_u16_d16 v192, v192
v_exp_f16_sdwa v198, v199 dst_sel:WORD_1 dst_unused:UNUSED_PRESERVE src0_sel:WORD_1
v_lshrrev_b32_e64 v193, 18, v193
v_mfma_f32_16x16x32_f16 v[164:167], v[240:243], v[236:239], v[164:167]
v_exp_f16_sdwa v195, v196 dst_sel:WORD_1 dst_unused:UNUSED_PRESERVE src0_sel:WORD_1
v_pk_add_f16 v201, v201, 1.0 op_sel_hi:[1,0]
v_mfma_f32_16x16x32_bf16 v[172:175], v[244:247], v[24:27], v[172:175]
ds_read_b128 v[240:243], v248 offset:53248
ds_read_u16_d16_hi v193, v193
v_pk_add_f16 v198, v198, 1.0 op_sel_hi:[1,0]
v_pk_add_f16 v195, v195, 1.0 op_sel_hi:[1,0]
v_mfma_f32_16x16x32_bf16 v[180:183], v[244:247], v[28:31], v[180:183]
v_rcp_f16 v202, v201
s_waitcnt lgkmcnt(7)
v_mfma_f32_16x16x32_bf16 v[168:171], v[40:43], v[32:35], v[168:171]
ds_read_b128 v[244:247], v249 offset:44032
v_rcp_f16_e64 v199, v198
v_mfma_f32_16x16x32_bf16 v[176:179], v[40:43], v[36:39], v[176:179]
v_rcp_f16_e64 v196, v195
v_mfma_f32_16x16x32_bf16 v[172:175], v[44:47], v[32:35], v[172:175]
ds_read_b128 v[40:43], v248 offset:53504
v_rcp_f16_sdwa v202, v201 dst_sel:WORD_1 dst_unused:UNUSED_PRESERVE src0_sel:WORD_1
v_mfma_f32_16x16x32_bf16 v[180:183], v[44:47], v[36:39], v[180:183]
v_rcp_f16_sdwa v199, v198 dst_sel:WORD_1 dst_unused:UNUSED_PRESERVE src0_sel:WORD_1
v_or_b32 v232, v184, v185
v_or_b32 v233, v186, v187
s_waitcnt lgkmcnt(4)
v_or_b32 v234, v188, v189
v_rcp_f16_sdwa v196, v195 dst_sel:WORD_1 dst_unused:UNUSED_PRESERVE src0_sel:WORD_1
v_or_b32 v235, v190, v191
s_waitcnt lgkmcnt(2)
v_or_b32_e64 v236, v192, v193
v_pk_mul_f16 v237, v203, v202
v_pk_mul_f16 v238, v200, v199
v_pk_mul_f16 v239, v197, v196
v_mfma_f32_16x16x32_f16 v[120:123], v[224:227], v[232:235], v[120:123]
ds_read_b128 v[44:47], v249 offset:44288
v_cvt_pkrtz_f16_f32 v185, v168, v169
v_cvt_pkrtz_f16_f32 v187, v170, v171
v_mfma_f32_16x16x32_f16 v[128:131], v[224:227], v[236:239], v[128:131]
v_cvt_pkrtz_f16_f32 v189, v172, v173
v_cvt_pkrtz_f16_f32 v191, v174, v175
v_mfma_f32_16x16x32_f16 v[124:127], v[228:231], v[232:235], v[124:127]
ds_read_b128 v[224:227], v248 offset:54272
v_cvt_pkrtz_f16_f32 v193, v176, v177
v_cvt_pk_f16_f32 v203, v178, v179
v_cvt_pk_f16_f32 v200, v180, v181
v_mfma_f32_16x16x32_f16 v[132:135], v[228:231], v[236:239], v[132:135]
v_cvt_pk_f16_f32 v197, v182, v183
v_pk_fma_f16 v202, v203, v203, s48
v_mfma_f32_16x16x32_bf16 v[168:171], v[240:243], v[208:211], 0
ds_read_b128 v[228:231], v249 offset:45056
v_and_b32_e64 v185, s49, v185
v_pk_fma_f16 v199, v200, v200, s48
v_mfma_f32_16x16x32_bf16 v[176:179], v[240:243], v[212:215], 0
v_and_b32_e64 v187, s49, v187
v_pk_fma_f16 v196, v197, v197, s48
s_setprio 2
v_bfe_u32 v184, v185, 2, 14
s_waitcnt lgkmcnt(3)
v_mfma_f32_16x16x32_f16 v[136:139], v[244:247], v[232:235], v[136:139]
ds_read_b128 v[240:243], v249 offset:45312
ds_read_u16_d16 v184, v184
v_pk_mul_f16 v202, v203, v202
v_bfe_u32 v186, v187, 2, 14
v_mfma_f32_16x16x32_f16 v[144:147], v[244:247], v[236:239], v[144:147]
v_pk_mul_f16 v199, v200, v199
v_lshrrev_b32_e64 v185, 18, v185
v_mfma_f32_16x16x32_bf16 v[172:175], v[40:43], v[208:211], 0
ds_read_b128 v[244:247], v248 offset:54528
ds_read_u16_d16 v186, v186
ds_read_u16_d16_hi v185, v185
v_pk_mul_f16 v196, v197, v196
v_lshrrev_b32_e64 v187, 18, v187
v_mfma_f32_16x16x32_bf16 v[180:183], v[40:43], v[212:215], 0
v_exp_f16_e64 v201, v202
v_and_b32 v189, s49, v189
s_waitcnt lgkmcnt(5)
v_mfma_f32_16x16x32_f16 v[140:143], v[44:47], v[232:235], v[140:143]
ds_read_b128 v[40:43], v248 offset:55296
ds_read_u16_d16_hi v187, v187
v_and_b32_e64 v191, s49, v191
v_mfma_f32_16x16x32_f16 v[148:151], v[44:47], v[236:239], v[148:151]
v_exp_f16_e64 v198, v199
v_bfe_u32 v188, v189, 2, 14
v_bfe_u32 v190, v191, 2, 14
v_mfma_f32_16x16x32_bf16 v[168:171], v[224:227], v[24:27], v[168:171]
ds_read_b128 v[44:47], v248 offset:55552
ds_read_u16_d16 v188, v188
ds_read_u16_d16 v190, v190
v_exp_f16_e64 v195, v196
v_mfma_f32_16x16x32_bf16 v[176:179], v[224:227], v[28:31], v[176:179]
v_lshrrev_b32 v189, 18, v189
v_lshrrev_b32 v191, 18, v191
v_mfma_f32_16x16x32_f16 v[152:155], v[228:231], v[232:235], v[152:155]
ds_read_b128 v[224:227], v249 offset:55296
ds_read_u16_d16_hi v189, v189
ds_read_u16_d16_hi v191, v191
v_exp_f16_sdwa v201, v202 dst_sel:WORD_1 dst_unused:UNUSED_PRESERVE src0_sel:WORD_1
v_and_b32 v193, s49, v193
v_mfma_f32_16x16x32_f16 v[160:163], v[228:231], v[236:239], v[160:163]
v_bfe_u32 v192, v193, 2, 14
s_waitcnt lgkmcnt(8)
v_mfma_f32_16x16x32_f16 v[156:159], v[240:243], v[232:235], v[156:159]
ds_read_b128 v[228:231], v249 offset:55552
ds_read_u16_d16 v192, v192
v_exp_f16_sdwa v198, v199 dst_sel:WORD_1 dst_unused:UNUSED_PRESERVE src0_sel:WORD_1
v_lshrrev_b32_e64 v193, 18, v193
v_mfma_f32_16x16x32_f16 v[164:167], v[240:243], v[236:239], v[164:167]
v_exp_f16_sdwa v195, v196 dst_sel:WORD_1 dst_unused:UNUSED_PRESERVE src0_sel:WORD_1
v_pk_add_f16 v201, v201, 1.0 op_sel_hi:[1,0]
v_mfma_f32_16x16x32_bf16 v[172:175], v[244:247], v[24:27], v[172:175]
ds_read_b128 v[240:243], v248 offset:59392
ds_read_u16_d16_hi v193, v193
v_pk_add_f16 v198, v198, 1.0 op_sel_hi:[1,0]
v_pk_add_f16 v195, v195, 1.0 op_sel_hi:[1,0]
v_mfma_f32_16x16x32_bf16 v[180:183], v[244:247], v[28:31], v[180:183]
v_rcp_f16 v202, v201
s_waitcnt lgkmcnt(7)
v_mfma_f32_16x16x32_bf16 v[168:171], v[40:43], v[32:35], v[168:171]
ds_read_b128 v[244:247], v249 offset:56320
v_rcp_f16_e64 v199, v198
v_mfma_f32_16x16x32_bf16 v[176:179], v[40:43], v[36:39], v[176:179]
v_rcp_f16_e64 v196, v195
v_mfma_f32_16x16x32_bf16 v[172:175], v[44:47], v[32:35], v[172:175]
ds_read_b128 v[40:43], v248 offset:59648
v_rcp_f16_sdwa v202, v201 dst_sel:WORD_1 dst_unused:UNUSED_PRESERVE src0_sel:WORD_1
v_mfma_f32_16x16x32_bf16 v[180:183], v[44:47], v[36:39], v[180:183]
v_rcp_f16_sdwa v199, v198 dst_sel:WORD_1 dst_unused:UNUSED_PRESERVE src0_sel:WORD_1
v_or_b32 v232, v184, v185
v_or_b32 v233, v186, v187
s_waitcnt lgkmcnt(4)
v_or_b32 v234, v188, v189
v_rcp_f16_sdwa v196, v195 dst_sel:WORD_1 dst_unused:UNUSED_PRESERVE src0_sel:WORD_1
v_or_b32 v235, v190, v191
s_waitcnt lgkmcnt(2)
v_or_b32_e64 v236, v192, v193
v_pk_mul_f16 v237, v203, v202
v_pk_mul_f16 v238, v200, v199
v_pk_mul_f16 v239, v197, v196
v_mfma_f32_16x16x32_f16 v[120:123], v[224:227], v[232:235], v[120:123]
buffer_load_dwordx4 v[204:207], v252, s[4:7], s68 offen
ds_read_b128 v[44:47], v249 offset:56576
v_cvt_pkrtz_f16_f32 v185, v168, v169
v_cvt_pkrtz_f16_f32 v187, v170, v171
v_mfma_f32_16x16x32_f16 v[128:131], v[224:227], v[236:239], v[128:131]
v_cvt_pkrtz_f16_f32 v189, v172, v173
v_cvt_pkrtz_f16_f32 v191, v174, v175
v_mfma_f32_16x16x32_f16 v[124:127], v[228:231], v[232:235], v[124:127]
ds_read_b128 v[224:227], v248 offset:60416
v_cvt_pkrtz_f16_f32 v193, v176, v177
v_cvt_pk_f16_f32 v203, v178, v179
v_cvt_pk_f16_f32 v200, v180, v181
v_mfma_f32_16x16x32_f16 v[132:135], v[228:231], v[236:239], v[132:135]
v_cvt_pk_f16_f32 v197, v182, v183
s_setprio 1
v_pk_fma_f16 v202, v203, v203, s48
v_mfma_f32_16x16x32_bf16 v[168:171], v[240:243], v[208:211], 0
ds_read_b128 v[228:231], v249 offset:57344
v_and_b32 v185, s49, v185
v_pk_fma_f16 v199, v200, v200, s48
v_mfma_f32_16x16x32_bf16 v[176:179], v[240:243], v[212:215], 0
v_and_b32 v187, s49, v187
v_pk_fma_f16 v196, v197, v197, s48
v_bfe_u32 v184, v185, 2, 14
s_waitcnt lgkmcnt(3)
v_mfma_f32_16x16x32_f16 v[136:139], v[244:247], v[232:235], v[136:139]
ds_read_b128 v[240:243], v249 offset:57600
ds_read_u16_d16 v184, v184
v_pk_mul_f16 v202, v203, v202
v_bfe_u32 v186, v187, 2, 14
v_mfma_f32_16x16x32_f16 v[144:147], v[244:247], v[236:239], v[144:147]
v_pk_mul_f16 v199, v200, v199
v_lshrrev_b32_e64 v185, 18, v185
v_mfma_f32_16x16x32_bf16 v[172:175], v[40:43], v[208:211], 0
ds_read_b128 v[244:247], v248 offset:60672
ds_read_u16_d16 v186, v186
ds_read_u16_d16_hi v185, v185
v_pk_mul_f16 v196, v197, v196
v_lshrrev_b32_e64 v187, 18, v187
v_mfma_f32_16x16x32_bf16 v[180:183], v[40:43], v[212:215], 0
v_exp_f16_e64 v201, v202
v_and_b32 v189, s49, v189
s_waitcnt lgkmcnt(5)
v_mfma_f32_16x16x32_f16 v[140:143], v[44:47], v[232:235], v[140:143]
ds_read_b128 v[40:43], v248 offset:61440
ds_read_u16_d16_hi v187, v187
v_and_b32_e64 v191, s49, v191
v_mfma_f32_16x16x32_f16 v[148:151], v[44:47], v[236:239], v[148:151]
v_exp_f16_e64 v198, v199
v_bfe_u32 v188, v189, 2, 14
v_bfe_u32 v190, v191, 2, 14
v_mfma_f32_16x16x32_bf16 v[168:171], v[224:227], v[24:27], v[168:171]
buffer_store_dwordx4 v[80:83], v255, s[8:11], s70 offen offset:256 sc1
ds_read_b128 v[44:47], v248 offset:61696
ds_read_u16_d16 v188, v188
ds_read_u16_d16 v190, v190
v_exp_f16_e64 v195, v196
v_mfma_f32_16x16x32_bf16 v[176:179], v[224:227], v[28:31], v[176:179]
v_lshrrev_b32 v189, 18, v189
v_lshrrev_b32 v191, 18, v191
v_mfma_f32_16x16x32_f16 v[152:155], v[228:231], v[232:235], v[152:155]
ds_read_b128 v[224:227], v249 offset:61440
ds_read_u16_d16_hi v189, v189
ds_read_u16_d16_hi v191, v191
v_exp_f16_sdwa v201, v202 dst_sel:WORD_1 dst_unused:UNUSED_PRESERVE src0_sel:WORD_1
v_and_b32 v193, s49, v193
v_mfma_f32_16x16x32_f16 v[160:163], v[228:231], v[236:239], v[160:163]
v_bfe_u32 v192, v193, 2, 14
s_waitcnt lgkmcnt(8)
v_mfma_f32_16x16x32_f16 v[156:159], v[240:243], v[232:235], v[156:159]
ds_read_b128 v[228:231], v249 offset:61696
ds_read_u16_d16 v192, v192
v_exp_f16_sdwa v198, v199 dst_sel:WORD_1 dst_unused:UNUSED_PRESERVE src0_sel:WORD_1
v_lshrrev_b32_e64 v193, 18, v193
v_mfma_f32_16x16x32_f16 v[164:167], v[240:243], v[236:239], v[164:167]
v_exp_f16_sdwa v195, v196 dst_sel:WORD_1 dst_unused:UNUSED_PRESERVE src0_sel:WORD_1
v_pk_add_f16 v201, v201, 1.0 op_sel_hi:[1,0]
v_mfma_f32_16x16x32_bf16 v[172:175], v[244:247], v[24:27], v[172:175]
ds_read_b128 v[240:243], v249
ds_read_u16_d16_hi v193, v193
v_pk_add_f16 v198, v198, 1.0 op_sel_hi:[1,0]
v_pk_add_f16 v195, v195, 1.0 op_sel_hi:[1,0]
v_mfma_f32_16x16x32_bf16 v[180:183], v[244:247], v[28:31], v[180:183]
v_rcp_f16_e64 v202, v201
s_setprio 0
s_waitcnt lgkmcnt(7)
v_mfma_f32_16x16x32_bf16 v[168:171], v[40:43], v[32:35], v[168:171]
ds_read_b128 v[244:247], v249 offset:62464
v_rcp_f16_e64 v199, v198
v_mfma_f32_16x16x32_bf16 v[176:179], v[40:43], v[36:39], v[176:179]
v_rcp_f16_e64 v196, v195
v_mfma_f32_16x16x32_bf16 v[172:175], v[44:47], v[32:35], v[172:175]
ds_read_b128 v[40:43], v249 offset:256
v_rcp_f16_sdwa v202, v201 dst_sel:WORD_1 dst_unused:UNUSED_PRESERVE src0_sel:WORD_1
v_mfma_f32_16x16x32_bf16 v[180:183], v[44:47], v[36:39], v[180:183]
v_rcp_f16_sdwa v199, v198 dst_sel:WORD_1 dst_unused:UNUSED_PRESERVE src0_sel:WORD_1
v_or_b32 v232, v184, v185
v_or_b32 v233, v186, v187
s_waitcnt lgkmcnt(4)
v_or_b32 v234, v188, v189
v_rcp_f16_sdwa v196, v195 dst_sel:WORD_1 dst_unused:UNUSED_PRESERVE src0_sel:WORD_1
v_or_b32 v235, v190, v191
s_waitcnt lgkmcnt(2)
v_or_b32 v236, v192, v193
v_pk_mul_f16 v237, v203, v202
v_pk_mul_f16 v238, v200, v199
v_pk_mul_f16 v239, v197, v196
s_setprio 3
v_mfma_f32_16x16x32_f16 v[120:123], v[224:227], v[232:235], v[120:123]
buffer_load_dwordx4 v[216:219], v252, s[4:7], s68 offen offset:64
ds_read_b128 v[44:47], v249 offset:62720
v_cvt_pkrtz_f16_f32 v185, v168, v169
v_cvt_pkrtz_f16_f32 v187, v170, v171
v_mfma_f32_16x16x32_f16 v[128:131], v[224:227], v[236:239], v[128:131]
v_cvt_pkrtz_f16_f32 v189, v172, v173
v_cvt_pkrtz_f16_f32 v191, v174, v175
v_mfma_f32_16x16x32_f16 v[124:127], v[228:231], v[232:235], v[124:127]
ds_read_b128 v[224:227], v249 offset:1024
v_cvt_pkrtz_f16_f32 v193, v176, v177
v_cvt_pk_f16_f32 v203, v178, v179
v_cvt_pk_f16_f32 v200, v180, v181
v_mfma_f32_16x16x32_f16 v[132:135], v[228:231], v[236:239], v[132:135]
v_cvt_pk_f16_f32 v197, v182, v183
v_pk_fma_f16 v202, v203, v203, s48
v_mfma_f32_16x16x32_bf16 v[168:171], v[240:243], v[208:211], 0
ds_read_b128 v[228:231], v249 offset:63488
v_and_b32_e64 v185, s49, v185
v_pk_fma_f16 v199, v200, v200, s48
v_mfma_f32_16x16x32_bf16 v[176:179], v[240:243], v[212:215], 0
v_and_b32 v187, s49, v187
v_pk_fma_f16 v196, v197, v197, s48
v_bfe_u32 v184, v185, 2, 14
s_waitcnt lgkmcnt(3)
v_mfma_f32_16x16x32_f16 v[136:139], v[244:247], v[232:235], v[136:139]
ds_read_b128 v[240:243], v249 offset:63744
ds_read_u16_d16 v184, v184
v_pk_mul_f16 v202, v203, v202
v_bfe_u32 v186, v187, 2, 14
v_mfma_f32_16x16x32_f16 v[144:147], v[244:247], v[236:239], v[144:147]
v_pk_mul_f16 v199, v200, v199
v_lshrrev_b32_e64 v185, 18, v185
v_mfma_f32_16x16x32_bf16 v[172:175], v[40:43], v[208:211], 0
ds_read_b128 v[244:247], v249 offset:1280
ds_read_u16_d16 v186, v186
ds_read_u16_d16_hi v185, v185
v_pk_mul_f16 v196, v197, v196
v_lshrrev_b32_e64 v187, 18, v187
v_mfma_f32_16x16x32_bf16 v[180:183], v[40:43], v[212:215], 0
v_exp_f16_e64 v201, v202
v_and_b32 v189, s49, v189
s_waitcnt lgkmcnt(5)
v_mfma_f32_16x16x32_f16 v[140:143], v[44:47], v[232:235], v[140:143]
ds_read_b128 v[40:43], v249 offset:2048
ds_read_u16_d16_hi v187, v187
v_and_b32_e64 v191, s49, v191
v_mfma_f32_16x16x32_f16 v[148:151], v[44:47], v[236:239], v[148:151]
v_exp_f16_e64 v198, v199
v_bfe_u32 v188, v189, 2, 14
v_bfe_u32 v190, v191, 2, 14
v_mfma_f32_16x16x32_bf16 v[168:171], v[224:227], v[24:27], v[168:171]
ds_read_b128 v[44:47], v249 offset:2304
ds_read_u16_d16 v188, v188
ds_read_u16_d16 v190, v190
v_exp_f16_e64 v195, v196
v_mfma_f32_16x16x32_bf16 v[176:179], v[224:227], v[28:31], v[176:179]
v_lshrrev_b32 v189, 18, v189
v_lshrrev_b32 v191, 18, v191
v_mfma_f32_16x16x32_f16 v[152:155], v[228:231], v[232:235], v[152:155]
ds_read_b128 v[224:227], v250 offset:2048
ds_read_u16_d16_hi v189, v189
ds_read_u16_d16_hi v191, v191
v_exp_f16_sdwa v201, v202 dst_sel:WORD_1 dst_unused:UNUSED_PRESERVE src0_sel:WORD_1
v_and_b32 v193, s49, v193
v_mfma_f32_16x16x32_f16 v[160:163], v[228:231], v[236:239], v[160:163]
v_bfe_u32 v192, v193, 2, 14
s_waitcnt lgkmcnt(8)
v_mfma_f32_16x16x32_f16 v[156:159], v[240:243], v[232:235], v[156:159]
ds_read_b128 v[228:231], v250 offset:2304
ds_read_u16_d16 v192, v192
v_exp_f16_sdwa v198, v199 dst_sel:WORD_1 dst_unused:UNUSED_PRESERVE src0_sel:WORD_1
v_lshrrev_b32_e64 v193, 18, v193
v_mfma_f32_16x16x32_f16 v[164:167], v[240:243], v[236:239], v[164:167]
v_exp_f16_sdwa v195, v196 dst_sel:WORD_1 dst_unused:UNUSED_PRESERVE src0_sel:WORD_1
v_pk_add_f16 v201, v201, 1.0 op_sel_hi:[1,0]
v_mfma_f32_16x16x32_bf16 v[172:175], v[244:247], v[24:27], v[172:175]
ds_read_b128 v[240:243], v249 offset:6144
ds_read_u16_d16_hi v193, v193
v_pk_add_f16 v198, v198, 1.0 op_sel_hi:[1,0]
v_pk_add_f16 v195, v195, 1.0 op_sel_hi:[1,0]
v_mfma_f32_16x16x32_bf16 v[180:183], v[244:247], v[28:31], v[180:183]
v_rcp_f16 v202, v201
s_waitcnt lgkmcnt(7)
v_mfma_f32_16x16x32_bf16 v[168:171], v[40:43], v[32:35], v[168:171]
ds_read_b128 v[244:247], v250 offset:3072
v_rcp_f16_e64 v199, v198
v_mfma_f32_16x16x32_bf16 v[176:179], v[40:43], v[36:39], v[176:179]
v_rcp_f16_e64 v196, v195
v_mfma_f32_16x16x32_bf16 v[172:175], v[44:47], v[32:35], v[172:175]
ds_read_b128 v[40:43], v249 offset:6400
v_rcp_f16_sdwa v202, v201 dst_sel:WORD_1 dst_unused:UNUSED_PRESERVE src0_sel:WORD_1
v_mfma_f32_16x16x32_bf16 v[180:183], v[44:47], v[36:39], v[180:183]
v_rcp_f16_sdwa v199, v198 dst_sel:WORD_1 dst_unused:UNUSED_PRESERVE src0_sel:WORD_1
v_or_b32 v232, v184, v185
v_or_b32 v233, v186, v187
s_waitcnt lgkmcnt(4)
v_or_b32 v234, v188, v189
v_rcp_f16_sdwa v196, v195 dst_sel:WORD_1 dst_unused:UNUSED_PRESERVE src0_sel:WORD_1
v_or_b32 v235, v190, v191
s_waitcnt lgkmcnt(2)
v_or_b32_e64 v236, v192, v193
v_pk_mul_f16 v237, v203, v202
v_pk_mul_f16 v238, v200, v199
v_pk_mul_f16 v239, v197, v196
v_mfma_f32_16x16x32_f16 v[120:123], v[224:227], v[232:235], v[120:123]
ds_read_b128 v[44:47], v250 offset:3328
v_cvt_pkrtz_f16_f32 v185, v168, v169
v_cvt_pkrtz_f16_f32 v187, v170, v171
v_cvt_pkrtz_f16_f32 v189, v172, v173
v_mfma_f32_16x16x32_f16 v[128:131], v[224:227], v[236:239], v[128:131]
v_cvt_pkrtz_f16_f32 v191, v174, v175
v_cvt_pkrtz_f16_f32 v193, v176, v177
v_cvt_pkrtz_f16_f32 v195, v178, v179
v_mfma_f32_16x16x32_f16 v[124:127], v[228:231], v[232:235], v[124:127]
ds_read_b128 v[224:227], v249 offset:7168
v_cvt_pk_f16_f32 v203, v180, v181
v_cvt_pk_f16_f32 v200, v182, v183
v_pk_fma_f16 v202, v203, v203, s48
v_mfma_f32_16x16x32_f16 v[132:135], v[228:231], v[236:239], v[132:135]
v_cvt_pk_bf16_f32 v72, v72, v73
v_and_b32_e64 v185, s49, v185
v_cvt_pk_bf16_f32 v73, v74, v75
v_mfma_f32_16x16x32_bf16 v[168:171], v[240:243], v[208:211], 0
ds_read_b128 v[228:231], v250 offset:4096
v_and_b32_e64 v187, s49, v187
v_cvt_pk_bf16_f32 v74, v76, v77
v_pk_fma_f16 v199, v200, v200, s48
v_mfma_f32_16x16x32_bf16 v[176:179], v[240:243], v[212:215], 0
v_bfe_u32 v184, v185, 2, 14
s_setprio 2
v_cvt_pk_bf16_f32 v75, v78, v79
v_pk_mul_f16 v202, v203, v202
s_waitcnt lgkmcnt(2)
v_mfma_f32_16x16x32_f16 v[136:139], v[244:247], v[232:235], v[136:139]
ds_read_b128 v[240:243], v250 offset:4352
ds_read_u16_d16 v184, v184
v_cvt_pk_bf16_f32 v56, v56, v57
v_bfe_u32 v186, v187, 2, 14
v_cvt_pk_bf16_f32 v57, v58, v59
v_mfma_f32_16x16x32_f16 v[144:147], v[244:247], v[236:239], v[144:147]
v_pk_mul_f16 v199, v200, v199
v_lshrrev_b32_e64 v185, 18, v185
v_cvt_pk_bf16_f32 v58, v60, v61
v_mfma_f32_16x16x32_bf16 v[172:175], v[40:43], v[208:211], 0
ds_read_b128 v[244:247], v249 offset:7424
ds_read_u16_d16 v186, v186
ds_read_u16_d16_hi v185, v185
v_exp_f16_e64 v201, v202
v_cvt_pk_bf16_f32 v59, v62, v63
v_mfma_f32_16x16x32_bf16 v[180:183], v[40:43], v[212:215], 0
v_lshrrev_b32_e64 v187, 18, v187
v_cvt_pk_bf16_f32 v88, v88, v89
v_and_b32_e64 v189, s49, v189
v_mfma_f32_16x16x32_f16 v[140:143], v[44:47], v[232:235], v[140:143]
ds_read_b128 v[40:43], v249 offset:8192
ds_read_u16_d16_hi v187, v187
v_cvt_pk_bf16_f32 v89, v90, v91
v_exp_f16_e64 v198, v199
v_mfma_f32_16x16x32_f16 v[148:151], v[44:47], v[236:239], v[148:151]
v_cvt_pk_bf16_f32 v90, v92, v93
v_and_b32_e64 v191, s49, v191
v_cvt_pk_bf16_f32 v91, v94, v95
s_mov_b64 vcc, s[74:75]
s_waitcnt lgkmcnt(5)
v_mfma_f32_16x16x32_bf16 v[168:171], v[224:227], v[24:27], v[168:171]
ds_read_b128 v[44:47], v249 offset:8448
v_bfe_u32 v188, v189, 2, 14
v_cndmask_b32 v76, v56, v88, vcc
v_mfma_f32_16x16x32_bf16 v[176:179], v[224:227], v[28:31], v[176:179]
v_exp_f16_sdwa v201, v202 dst_sel:WORD_1 dst_unused:UNUSED_PRESERVE src0_sel:WORD_1
v_cndmask_b32 v77, v57, v89, vcc
v_bfe_u32 v190, v191, 2, 14
v_mfma_f32_16x16x32_f16 v[152:155], v[228:231], v[232:235], v[152:155]
ds_read_b128 v[224:227], v250 offset:8192
ds_read_u16_d16 v188, v188
ds_read_u16_d16 v190, v190
v_cndmask_b32 v78, v58, v90, vcc
v_lshrrev_b32 v189, 18, v189
v_cndmask_b32 v79, v59, v91, vcc
v_mfma_f32_16x16x32_f16 v[160:163], v[228:231], v[236:239], v[160:163]
v_lshrrev_b32 v191, 18, v191
v_exp_f16_sdwa v198, v199 dst_sel:WORD_1 dst_unused:UNUSED_PRESERVE src0_sel:WORD_1
v_mfma_f32_16x16x32_f16 v[156:159], v[240:243], v[232:235], v[156:159]
ds_read_b128 v[228:231], v250 offset:8448
ds_read_u16_d16_hi v189, v189
ds_read_u16_d16_hi v191, v191
v_cndmask_b32_dpp v56, v72, v56, vcc quad_perm:[1,0,3,2] row_mask:0xf bank_mask:0xf
v_cndmask_b32_dpp v57, v73, v57, vcc quad_perm:[1,0,3,2] row_mask:0xf bank_mask:0xf
v_and_b32_e64 v193, s49, v193
v_mfma_f32_16x16x32_f16 v[164:167], v[240:243], v[236:239], v[164:167]
v_cndmask_b32_dpp v58, v74, v58, vcc quad_perm:[1,0,3,2] row_mask:0xf bank_mask:0xf
v_and_b32_e64 v195, s49, v195
v_pk_add_f16 v201, v201, 1.0 op_sel_hi:[1,0]
s_waitcnt lgkmcnt(6)
v_mfma_f32_16x16x32_bf16 v[172:175], v[244:247], v[24:27], v[172:175]
ds_read_b128 v[240:243], v249 offset:12288
v_cndmask_b32_dpp v59, v75, v59, vcc quad_perm:[1,0,3,2] row_mask:0xf bank_mask:0xf
s_not_b64 vcc, s[74:75]
v_bfe_u32 v192, v193, 2, 14
v_cndmask_b32_dpp v88, v72, v88, vcc quad_perm:[1,0,3,2] row_mask:0xf bank_mask:0xf
v_mfma_f32_16x16x32_bf16 v[180:183], v[244:247], v[28:31], v[180:183]
v_pk_add_f16 v198, v198, 1.0 op_sel_hi:[1,0]
v_cndmask_b32_dpp v89, v73, v89, vcc quad_perm:[1,0,3,2] row_mask:0xf bank_mask:0xf
v_bfe_u32 v194, v195, 2, 14
v_mfma_f32_16x16x32_bf16 v[168:171], v[40:43], v[32:35], v[168:171]
ds_read_b128 v[244:247], v250 offset:9216
ds_read_u16_d16 v192, v192
ds_read_u16_d16 v194, v194
v_rcp_f16_e64 v202, v201
v_cndmask_b32_dpp v90, v74, v90, vcc quad_perm:[1,0,3,2] row_mask:0xf bank_mask:0xf
v_mfma_f32_16x16x32_bf16 v[176:179], v[40:43], v[36:39], v[176:179]
v_cndmask_b32_dpp v91, v75, v91, vcc quad_perm:[1,0,3,2] row_mask:0xf bank_mask:0xf
v_lshrrev_b32 v193, 18, v193
v_lshrrev_b32 v195, 18, v195
v_mfma_f32_16x16x32_bf16 v[172:175], v[44:47], v[32:35], v[172:175]
ds_read_b128 v[40:43], v249 offset:12544
s_add_u32 s46, s70, 98304
buffer_store_dwordx4 v[56:59], v255, s[8:11], s46 offen sc1
ds_read_u16_d16_hi v193, v193
ds_read_u16_d16_hi v195, v195
v_rcp_f16_e64 v199, v198
v_mfma_f32_16x16x32_bf16 v[180:183], v[44:47], v[36:39], v[180:183]
v_rcp_f16_sdwa v202, v201 dst_sel:WORD_1 dst_unused:UNUSED_PRESERVE src0_sel:WORD_1
v_or_b32 v232, v184, v185
v_or_b32 v233, v186, v187
s_waitcnt lgkmcnt(6)
v_or_b32 v234, v188, v189
v_rcp_f16_sdwa v199, v198 dst_sel:WORD_1 dst_unused:UNUSED_PRESERVE src0_sel:WORD_1
v_or_b32 v235, v190, v191
s_waitcnt lgkmcnt(1)
v_or_b32 v236, v192, v193
s_waitcnt lgkmcnt(0)
v_or_b32_e64 v237, v194, v195
v_pk_mul_f16 v238, v203, v202
v_pk_mul_f16 v239, v200, v199
v_mfma_f32_16x16x32_f16 v[120:123], v[224:227], v[232:235], v[120:123]
buffer_load_dwordx4 v[12:15], v252, s[4:7], s68 offen offset:128
ds_read_b128 v[44:47], v250 offset:9472
v_cvt_pkrtz_f16_f32 v185, v168, v169
v_cvt_pkrtz_f16_f32 v187, v170, v171
v_mfma_f32_16x16x32_f16 v[128:131], v[224:227], v[236:239], v[128:131]
v_cvt_pkrtz_f16_f32 v189, v172, v173
v_cvt_pkrtz_f16_f32 v191, v174, v175
v_mfma_f32_16x16x32_f16 v[124:127], v[228:231], v[232:235], v[124:127]
ds_read_b128 v[224:227], v249 offset:13312
v_cvt_pkrtz_f16_f32 v193, v176, v177
v_cvt_pk_f16_f32 v203, v178, v179
v_cvt_pk_f16_f32 v200, v180, v181
v_mfma_f32_16x16x32_f16 v[132:135], v[228:231], v[236:239], v[132:135]
v_cvt_pk_f16_f32 v197, v182, v183
s_setprio 1
v_pk_fma_f16 v202, v203, v203, s48
v_mfma_f32_16x16x32_bf16 v[168:171], v[240:243], v[208:211], 0
ds_read_b128 v[228:231], v250 offset:10240
v_and_b32 v185, s49, v185
v_pk_fma_f16 v199, v200, v200, s48
v_mfma_f32_16x16x32_bf16 v[176:179], v[240:243], v[212:215], 0
v_and_b32_e64 v187, s49, v187
v_pk_fma_f16 v196, v197, v197, s48
v_bfe_u32 v184, v185, 2, 14
v_mfma_f32_16x16x32_f16 v[136:139], v[244:247], v[232:235], v[136:139]
ds_read_b128 v[240:243], v250 offset:10496
ds_read_u16_d16 v184, v184
v_pk_mul_f16 v202, v203, v202
v_bfe_u32 v186, v187, 2, 14
v_mfma_f32_16x16x32_f16 v[144:147], v[244:247], v[236:239], v[144:147]
v_pk_mul_f16 v199, v200, v199
v_lshrrev_b32_e64 v185, 18, v185
v_mfma_f32_16x16x32_bf16 v[172:175], v[40:43], v[208:211], 0
ds_read_b128 v[244:247], v249 offset:13568
ds_read_u16_d16 v186, v186
ds_read_u16_d16_hi v185, v185
v_pk_mul_f16 v196, v197, v196
v_lshrrev_b32_e64 v187, 18, v187
v_mfma_f32_16x16x32_bf16 v[180:183], v[40:43], v[212:215], 0
v_exp_f16_e64 v201, v202
v_and_b32 v189, s49, v189
s_waitcnt lgkmcnt(6)
v_mfma_f32_16x16x32_f16 v[140:143], v[44:47], v[232:235], v[140:143]
ds_read_b128 v[40:43], v249 offset:14336
ds_read_u16_d16_hi v187, v187
v_and_b32_e64 v191, s49, v191
v_mfma_f32_16x16x32_f16 v[148:151], v[44:47], v[236:239], v[148:151]
v_exp_f16_e64 v198, v199
v_bfe_u32 v188, v189, 2, 14
v_bfe_u32 v190, v191, 2, 14
v_mfma_f32_16x16x32_bf16 v[168:171], v[224:227], v[24:27], v[168:171]
ds_read_b128 v[44:47], v249 offset:14592
ds_read_u16_d16 v188, v188
ds_read_u16_d16 v190, v190
v_exp_f16_e64 v195, v196
v_mfma_f32_16x16x32_bf16 v[176:179], v[224:227], v[28:31], v[176:179]
v_lshrrev_b32_e64 v189, 18, v189
v_lshrrev_b32 v191, 18, v191
s_waitcnt lgkmcnt(7)
v_mfma_f32_16x16x32_f16 v[152:155], v[228:231], v[232:235], v[152:155]
ds_read_b128 v[224:227], v250 offset:14336
ds_read_u16_d16_hi v189, v189
ds_read_u16_d16_hi v191, v191
v_exp_f16_sdwa v201, v202 dst_sel:WORD_1 dst_unused:UNUSED_PRESERVE src0_sel:WORD_1
v_and_b32_e64 v193, s49, v193
v_mfma_f32_16x16x32_f16 v[160:163], v[228:231], v[236:239], v[160:163]
v_bfe_u32 v192, v193, 2, 14
v_mfma_f32_16x16x32_f16 v[156:159], v[240:243], v[232:235], v[156:159]
ds_read_b128 v[228:231], v250 offset:14592
ds_read_u16_d16 v192, v192
v_exp_f16_sdwa v198, v199 dst_sel:WORD_1 dst_unused:UNUSED_PRESERVE src0_sel:WORD_1
v_lshrrev_b32_e64 v193, 18, v193
v_mfma_f32_16x16x32_f16 v[164:167], v[240:243], v[236:239], v[164:167]
v_exp_f16_sdwa v195, v196 dst_sel:WORD_1 dst_unused:UNUSED_PRESERVE src0_sel:WORD_1
v_pk_add_f16 v201, v201, 1.0 op_sel_hi:[1,0]
v_mfma_f32_16x16x32_bf16 v[172:175], v[244:247], v[24:27], v[172:175]
ds_read_b128 v[240:243], v249 offset:18432
ds_read_u16_d16_hi v193, v193
v_pk_add_f16 v198, v198, 1.0 op_sel_hi:[1,0]
v_pk_add_f16 v195, v195, 1.0 op_sel_hi:[1,0]
v_mfma_f32_16x16x32_bf16 v[180:183], v[244:247], v[28:31], v[180:183]
v_rcp_f16_e64 v202, v201
s_setprio 0
s_waitcnt lgkmcnt(7)
v_mfma_f32_16x16x32_bf16 v[168:171], v[40:43], v[32:35], v[168:171]
ds_read_b128 v[244:247], v250 offset:15360
v_rcp_f16_e64 v199, v198
v_mfma_f32_16x16x32_bf16 v[176:179], v[40:43], v[36:39], v[176:179]
v_rcp_f16_e64 v196, v195
v_mfma_f32_16x16x32_bf16 v[172:175], v[44:47], v[32:35], v[172:175]
ds_read_b128 v[40:43], v249 offset:18688
v_rcp_f16_sdwa v202, v201 dst_sel:WORD_1 dst_unused:UNUSED_PRESERVE src0_sel:WORD_1
v_mfma_f32_16x16x32_bf16 v[180:183], v[44:47], v[36:39], v[180:183]
v_rcp_f16_sdwa v199, v198 dst_sel:WORD_1 dst_unused:UNUSED_PRESERVE src0_sel:WORD_1
v_or_b32 v232, v184, v185
v_or_b32 v233, v186, v187
s_waitcnt lgkmcnt(4)
v_or_b32 v234, v188, v189
v_rcp_f16_sdwa v196, v195 dst_sel:WORD_1 dst_unused:UNUSED_PRESERVE src0_sel:WORD_1
v_or_b32 v235, v190, v191
s_waitcnt lgkmcnt(2)
v_or_b32 v236, v192, v193
v_pk_mul_f16 v237, v203, v202
v_pk_mul_f16 v238, v200, v199
v_pk_mul_f16 v239, v197, v196
s_setprio 3
v_mfma_f32_16x16x32_f16 v[120:123], v[224:227], v[232:235], v[120:123]
s_add_u32 s46, s68, 98304
buffer_load_dwordx4 v[8:11], v252, s[4:7], s46 offen
ds_read_b128 v[44:47], v250 offset:15616
v_cvt_pkrtz_f16_f32 v185, v168, v169
v_cvt_pkrtz_f16_f32 v187, v170, v171
v_mfma_f32_16x16x32_f16 v[128:131], v[224:227], v[236:239], v[128:131]
v_cvt_pkrtz_f16_f32 v189, v172, v173
v_cvt_pkrtz_f16_f32 v191, v174, v175
v_mfma_f32_16x16x32_f16 v[124:127], v[228:231], v[232:235], v[124:127]
ds_read_b128 v[224:227], v249 offset:19456
v_cvt_pkrtz_f16_f32 v193, v176, v177
v_cvt_pk_f16_f32 v203, v178, v179
v_cvt_pk_f16_f32 v200, v180, v181
v_mfma_f32_16x16x32_f16 v[132:135], v[228:231], v[236:239], v[132:135]
v_cvt_pk_f16_f32 v197, v182, v183
v_pk_fma_f16 v202, v203, v203, s48
v_mfma_f32_16x16x32_bf16 v[168:171], v[240:243], v[208:211], 0
ds_read_b128 v[228:231], v250 offset:16384
v_and_b32_e64 v185, s49, v185
v_pk_fma_f16 v199, v200, v200, s48
v_mfma_f32_16x16x32_bf16 v[176:179], v[240:243], v[212:215], 0
v_and_b32 v187, s49, v187
v_pk_fma_f16 v196, v197, v197, s48
v_bfe_u32 v184, v185, 2, 14
s_waitcnt lgkmcnt(3)
v_mfma_f32_16x16x32_f16 v[136:139], v[244:247], v[232:235], v[136:139]
ds_read_b128 v[240:243], v250 offset:16640
ds_read_u16_d16 v184, v184
v_pk_mul_f16 v202, v203, v202
v_bfe_u32 v186, v187, 2, 14
v_mfma_f32_16x16x32_f16 v[144:147], v[244:247], v[236:239], v[144:147]
v_pk_mul_f16 v199, v200, v199
v_lshrrev_b32_e64 v185, 18, v185
v_mfma_f32_16x16x32_bf16 v[172:175], v[40:43], v[208:211], 0
ds_read_b128 v[244:247], v249 offset:19712
ds_read_u16_d16 v186, v186
ds_read_u16_d16_hi v185, v185
v_pk_mul_f16 v196, v197, v196
v_lshrrev_b32_e64 v187, 18, v187
v_mfma_f32_16x16x32_bf16 v[180:183], v[40:43], v[212:215], 0
v_exp_f16_e64 v201, v202
v_and_b32 v189, s49, v189
s_waitcnt lgkmcnt(5)
v_mfma_f32_16x16x32_f16 v[140:143], v[44:47], v[232:235], v[140:143]
ds_read_b128 v[40:43], v249 offset:20480
ds_read_u16_d16_hi v187, v187
v_and_b32_e64 v191, s49, v191
v_mfma_f32_16x16x32_f16 v[148:151], v[44:47], v[236:239], v[148:151]
v_exp_f16_e64 v198, v199
v_bfe_u32 v188, v189, 2, 14
v_bfe_u32 v190, v191, 2, 14
v_mfma_f32_16x16x32_bf16 v[168:171], v[224:227], v[24:27], v[168:171]
s_add_u32 s46, s70, 98304
buffer_store_dwordx4 v[76:79], v255, s[8:11], s46 offen offset:128 sc1
ds_read_b128 v[44:47], v249 offset:20736
ds_read_u16_d16 v188, v188
ds_read_u16_d16 v190, v190
v_exp_f16_e64 v195, v196
v_mfma_f32_16x16x32_bf16 v[176:179], v[224:227], v[28:31], v[176:179]
v_lshrrev_b32 v189, 18, v189
v_lshrrev_b32 v191, 18, v191
v_mfma_f32_16x16x32_f16 v[152:155], v[228:231], v[232:235], v[152:155]
ds_read_b128 v[224:227], v250 offset:20480
ds_read_u16_d16_hi v189, v189
ds_read_u16_d16_hi v191, v191
v_exp_f16_sdwa v201, v202 dst_sel:WORD_1 dst_unused:UNUSED_PRESERVE src0_sel:WORD_1
v_and_b32 v193, s49, v193
v_mfma_f32_16x16x32_f16 v[160:163], v[228:231], v[236:239], v[160:163]
v_bfe_u32 v192, v193, 2, 14
s_waitcnt lgkmcnt(7)
v_mfma_f32_16x16x32_f16 v[156:159], v[240:243], v[232:235], v[156:159]
ds_read_b128 v[228:231], v250 offset:20736
ds_read_u16_d16 v192, v192
v_exp_f16_sdwa v198, v199 dst_sel:WORD_1 dst_unused:UNUSED_PRESERVE src0_sel:WORD_1
v_lshrrev_b32_e64 v193, 18, v193
v_mfma_f32_16x16x32_f16 v[164:167], v[240:243], v[236:239], v[164:167]
v_exp_f16_sdwa v195, v196 dst_sel:WORD_1 dst_unused:UNUSED_PRESERVE src0_sel:WORD_1
v_pk_add_f16 v201, v201, 1.0 op_sel_hi:[1,0]
v_mfma_f32_16x16x32_bf16 v[172:175], v[244:247], v[24:27], v[172:175]
ds_read_b128 v[240:243], v248 offset:16384
ds_read_u16_d16_hi v193, v193
v_pk_add_f16 v198, v198, 1.0 op_sel_hi:[1,0]
v_pk_add_f16 v195, v195, 1.0 op_sel_hi:[1,0]
v_mfma_f32_16x16x32_bf16 v[180:183], v[244:247], v[28:31], v[180:183]
v_rcp_f16_e64 v202, v201
v_mfma_f32_16x16x32_bf16 v[168:171], v[40:43], v[32:35], v[168:171]
ds_read_b128 v[244:247], v250 offset:21504
v_rcp_f16_e64 v199, v198
v_mfma_f32_16x16x32_bf16 v[176:179], v[40:43], v[36:39], v[176:179]
v_rcp_f16 v196, v195
s_waitcnt lgkmcnt(5)
v_mfma_f32_16x16x32_bf16 v[172:175], v[44:47], v[32:35], v[172:175]
ds_read_b128 v[40:43], v248 offset:16640
v_rcp_f16_sdwa v202, v201 dst_sel:WORD_1 dst_unused:UNUSED_PRESERVE src0_sel:WORD_1
v_mfma_f32_16x16x32_bf16 v[180:183], v[44:47], v[36:39], v[180:183]
v_rcp_f16_sdwa v199, v198 dst_sel:WORD_1 dst_unused:UNUSED_PRESERVE src0_sel:WORD_1
v_or_b32 v232, v184, v185
v_or_b32 v233, v186, v187
v_or_b32_e64 v234, v188, v189
v_rcp_f16_sdwa v196, v195 dst_sel:WORD_1 dst_unused:UNUSED_PRESERVE src0_sel:WORD_1
v_or_b32 v235, v190, v191
s_waitcnt lgkmcnt(2)
v_or_b32_e64 v236, v192, v193
v_pk_mul_f16 v237, v203, v202
v_pk_mul_f16 v238, v200, v199
v_pk_mul_f16 v239, v197, v196
v_mfma_f32_16x16x32_f16 v[120:123], v[224:227], v[232:235], v[120:123]
ds_read_b128 v[44:47], v250 offset:21760
v_cvt_pkrtz_f16_f32 v185, v168, v169
v_cvt_pkrtz_f16_f32 v187, v170, v171
v_mfma_f32_16x16x32_f16 v[128:131], v[224:227], v[236:239], v[128:131]
v_cvt_pkrtz_f16_f32 v189, v172, v173
v_cvt_pkrtz_f16_f32 v191, v174, v175
v_mfma_f32_16x16x32_f16 v[124:127], v[228:231], v[232:235], v[124:127]
ds_read_b128 v[224:227], v248 offset:17408
v_cvt_pkrtz_f16_f32 v193, v176, v177
v_cvt_pk_f16_f32 v203, v178, v179
v_cvt_pk_f16_f32 v200, v180, v181
v_mfma_f32_16x16x32_f16 v[132:135], v[228:231], v[236:239], v[132:135]
v_cvt_pk_f16_f32 v197, v182, v183
v_pk_fma_f16 v202, v203, v203, s48
s_waitcnt vmcnt(14)
v_mfma_f32_16x16x32_bf16 v[168:171], v[240:243], v[96:99], 0
ds_read_b128 v[228:231], v250 offset:22528
v_and_b32 v185, s49, v185
v_pk_fma_f16 v199, v200, v200, s48
s_waitcnt vmcnt(13)
v_mfma_f32_16x16x32_bf16 v[176:179], v[240:243], v[100:103], 0
v_and_b32 v187, s49, v187
v_pk_fma_f16 v196, v197, v197, s48
s_setprio 2
v_bfe_u32 v184, v185, 2, 14
s_waitcnt lgkmcnt(2)
v_mfma_f32_16x16x32_f16 v[136:139], v[244:247], v[232:235], v[136:139]
ds_read_b128 v[240:243], v250 offset:22784
ds_read_u16_d16 v184, v184
v_pk_mul_f16 v202, v203, v202
v_bfe_u32 v186, v187, 2, 14
v_mfma_f32_16x16x32_f16 v[144:147], v[244:247], v[236:239], v[144:147]
v_pk_mul_f16 v199, v200, v199
v_lshrrev_b32_e64 v185, 18, v185
v_mfma_f32_16x16x32_bf16 v[172:175], v[40:43], v[96:99], 0
ds_read_b128 v[244:247], v248 offset:17664
ds_read_u16_d16 v186, v186
ds_read_u16_d16_hi v185, v185
v_pk_mul_f16 v196, v197, v196
v_lshrrev_b32_e64 v187, 18, v187
v_mfma_f32_16x16x32_bf16 v[180:183], v[40:43], v[100:103], 0
v_exp_f16 v201, v202
v_and_b32 v189, s49, v189
v_mfma_f32_16x16x32_f16 v[140:143], v[44:47], v[232:235], v[140:143]
ds_read_b128 v[40:43], v248 offset:18432
ds_read_u16_d16_hi v187, v187
v_and_b32_e64 v191, s49, v191
v_mfma_f32_16x16x32_f16 v[148:151], v[44:47], v[236:239], v[148:151]
v_exp_f16 v198, v199
v_bfe_u32 v188, v189, 2, 14
v_bfe_u32 v190, v191, 2, 14
s_waitcnt vmcnt(12) lgkmcnt(7)
v_mfma_f32_16x16x32_bf16 v[168:171], v[224:227], v[104:107], v[168:171]
ds_read_b128 v[44:47], v248 offset:18688
ds_read_u16_d16 v188, v188
ds_read_u16_d16 v190, v190
v_exp_f16 v195, v196
s_waitcnt vmcnt(11)
v_mfma_f32_16x16x32_bf16 v[176:179], v[224:227], v[108:111], v[176:179]
v_lshrrev_b32 v189, 18, v189
v_lshrrev_b32 v191, 18, v191
v_mfma_f32_16x16x32_f16 v[152:155], v[228:231], v[232:235], v[152:155]
ds_read_b128 v[224:227], v250 offset:26624
ds_read_u16_d16_hi v189, v189
ds_read_u16_d16_hi v191, v191
v_exp_f16_sdwa v201, v202 dst_sel:WORD_1 dst_unused:UNUSED_PRESERVE src0_sel:WORD_1
v_and_b32 v193, s49, v193
v_mfma_f32_16x16x32_f16 v[160:163], v[228:231], v[236:239], v[160:163]
v_bfe_u32 v192, v193, 2, 14
s_waitcnt lgkmcnt(7)
v_mfma_f32_16x16x32_f16 v[156:159], v[240:243], v[232:235], v[156:159]
ds_read_b128 v[228:231], v250 offset:26880
ds_read_u16_d16 v192, v192
v_exp_f16_sdwa v198, v199 dst_sel:WORD_1 dst_unused:UNUSED_PRESERVE src0_sel:WORD_1
v_lshrrev_b32_e64 v193, 18, v193
v_mfma_f32_16x16x32_f16 v[164:167], v[240:243], v[236:239], v[164:167]
v_exp_f16_sdwa v195, v196 dst_sel:WORD_1 dst_unused:UNUSED_PRESERVE src0_sel:WORD_1
v_pk_add_f16 v201, v201, 1.0 op_sel_hi:[1,0]
v_mfma_f32_16x16x32_bf16 v[172:175], v[244:247], v[104:107], v[172:175]
ds_read_b128 v[240:243], v248 offset:22528
ds_read_u16_d16_hi v193, v193
v_pk_add_f16 v198, v198, 1.0 op_sel_hi:[1,0]
v_pk_add_f16 v195, v195, 1.0 op_sel_hi:[1,0]
v_mfma_f32_16x16x32_bf16 v[180:183], v[244:247], v[108:111], v[180:183]
v_rcp_f16 v202, v201
s_waitcnt vmcnt(10)
v_mfma_f32_16x16x32_bf16 v[168:171], v[40:43], v[112:115], v[168:171]
ds_read_b128 v[244:247], v250 offset:27648
v_rcp_f16 v199, v198
s_waitcnt vmcnt(7)
v_mfma_f32_16x16x32_bf16 v[176:179], v[40:43], v[116:119], v[176:179]
v_rcp_f16 v196, v195
s_waitcnt lgkmcnt(5)
v_mfma_f32_16x16x32_bf16 v[172:175], v[44:47], v[112:115], v[172:175]
ds_read_b128 v[40:43], v248 offset:22784
v_rcp_f16_sdwa v202, v201 dst_sel:WORD_1 dst_unused:UNUSED_PRESERVE src0_sel:WORD_1
v_mfma_f32_16x16x32_bf16 v[180:183], v[44:47], v[116:119], v[180:183]
v_rcp_f16_sdwa v199, v198 dst_sel:WORD_1 dst_unused:UNUSED_PRESERVE src0_sel:WORD_1
v_or_b32 v232, v184, v185
v_or_b32 v233, v186, v187
v_or_b32_e64 v234, v188, v189
v_rcp_f16_sdwa v196, v195 dst_sel:WORD_1 dst_unused:UNUSED_PRESERVE src0_sel:WORD_1
v_or_b32 v235, v190, v191
s_waitcnt lgkmcnt(2)
v_or_b32_e64 v236, v192, v193
v_pk_mul_f16 v237, v203, v202
v_pk_mul_f16 v238, v200, v199
v_pk_mul_f16 v239, v197, v196
v_mfma_f32_16x16x32_f16 v[120:123], v[224:227], v[232:235], v[120:123]
s_add_u32 s46, s68, 98304
buffer_load_dwordx4 v[36:39], v252, s[4:7], s46 offen offset:64
ds_read_b128 v[44:47], v250 offset:27904
v_cvt_pkrtz_f16_f32 v185, v168, v169
v_cvt_pkrtz_f16_f32 v187, v170, v171
v_mfma_f32_16x16x32_f16 v[128:131], v[224:227], v[236:239], v[128:131]
v_cvt_pkrtz_f16_f32 v189, v172, v173
v_cvt_pkrtz_f16_f32 v191, v174, v175
v_mfma_f32_16x16x32_f16 v[124:127], v[228:231], v[232:235], v[124:127]
ds_read_b128 v[224:227], v248 offset:23552
v_cvt_pkrtz_f16_f32 v193, v176, v177
v_cvt_pk_f16_f32 v203, v178, v179
v_mfma_f32_16x16x32_f16 v[132:135], v[228:231], v[236:239], v[132:135]
v_cvt_pk_f16_f32 v200, v180, v181
v_cvt_pk_f16_f32 v197, v182, v183
s_setprio 1
v_mfma_f32_16x16x32_bf16 v[168:171], v[240:243], v[96:99], 0
ds_read_b128 v[228:231], v250 offset:28672
v_pk_fma_f16 v202, v203, v203, s48
v_and_b32 v185, s49, v185
v_mfma_f32_16x16x32_bf16 v[176:179], v[240:243], v[100:103], 0
v_pk_fma_f16 v199, v200, v200, s48
v_and_b32 v187, s49, v187
s_waitcnt lgkmcnt(3)
v_mfma_f32_16x16x32_f16 v[136:139], v[244:247], v[232:235], v[136:139]
ds_read_b128 v[240:243], v250 offset:28928
v_pk_fma_f16 v196, v197, v197, s48
v_bfe_u32 v184, v185, 2, 14
v_pk_mul_f16 v202, v203, v202
v_mfma_f32_16x16x32_f16 v[144:147], v[244:247], v[236:239], v[144:147]
v_bfe_u32 v186, v187, 2, 14
v_pk_mul_f16 v199, v200, v199
s_waitcnt vmcnt(7)
v_mfma_f32_16x16x32_bf16 v[120:123], v[18:21], v[204:207], v[120:123]
ds_read_b128 v[244:247], v248 offset:23808
ds_read_u16_d16 v184, v184
ds_read_u16_d16 v186, v186
v_lshrrev_b32 v185, 18, v185
v_pk_mul_f16 v196, v197, v196
v_mfma_f32_16x16x32_bf16 v[124:127], v[16:19], v[204:207], v[124:127]
v_lshrrev_b32_e64 v187, 18, v187
v_mfma_f32_16x16x32_bf16 v[172:175], v[40:43], v[96:99], 0
ds_read_u16_d16_hi v185, v185
ds_read_u16_d16_hi v187, v187
v_exp_f16 v201, v202
v_and_b32 v189, s49, v189
v_mfma_f32_16x16x32_bf16 v[180:183], v[40:43], v[100:103], 0
v_and_b32 v191, s49, v191
s_waitcnt lgkmcnt(6)
v_mfma_f32_16x16x32_f16 v[140:143], v[44:47], v[232:235], v[140:143]
ds_read_b128 v[40:43], v248 offset:24576
v_exp_f16_e64 v198, v199
v_bfe_u32 v188, v189, 2, 14
v_mfma_f32_16x16x32_f16 v[148:151], v[44:47], v[236:239], v[148:151]
v_bfe_u32 v190, v191, 2, 14
v_exp_f16_e64 v195, v196
v_mfma_f32_16x16x32_bf16 v[168:171], v[224:227], v[104:107], v[168:171]
s_add_u32 s46, s70, 98304
buffer_store_dwordx4 v[88:91], v255, s[8:11], s46 offen offset:256 sc1
ds_read_b128 v[44:47], v248 offset:24832
ds_read_u16_d16 v188, v188
ds_read_u16_d16 v190, v190
v_lshrrev_b32 v189, 18, v189
v_lshrrev_b32 v191, 18, v191
v_mfma_f32_16x16x32_bf16 v[176:179], v[224:227], v[108:111], v[176:179]
v_exp_f16_sdwa v201, v202 dst_sel:WORD_1 dst_unused:UNUSED_PRESERVE src0_sel:WORD_1
v_mfma_f32_16x16x32_f16 v[152:155], v[228:231], v[232:235], v[152:155]
ds_read_b128 v[224:227], v249 offset:24576
ds_read_u16_d16_hi v189, v189
ds_read_u16_d16_hi v191, v191
v_and_b32 v193, s49, v193
v_bfe_u32 v192, v193, 2, 14
v_mfma_f32_16x16x32_f16 v[160:163], v[228:231], v[236:239], v[160:163]
v_exp_f16_sdwa v198, v199 dst_sel:WORD_1 dst_unused:UNUSED_PRESERVE src0_sel:WORD_1
s_waitcnt lgkmcnt(7)
v_mfma_f32_16x16x32_f16 v[156:159], v[240:243], v[232:235], v[156:159]
ds_read_b128 v[228:231], v254 offset:7936
ds_read_u16_d16 v192, v192
v_lshrrev_b32_e64 v193, 18, v193
v_mfma_f32_16x16x32_f16 v[164:167], v[240:243], v[236:239], v[164:167]
v_exp_f16_sdwa v195, v196 dst_sel:WORD_1 dst_unused:UNUSED_PRESERVE src0_sel:WORD_1
v_pk_add_f16 v201, v201, 1.0 op_sel_hi:[1,0]
v_pk_add_f16 v198, v198, 1.0 op_sel_hi:[1,0]
v_mfma_f32_16x16x32_bf16 v[172:175], v[244:247], v[104:107], v[172:175]
ds_read_b128 v[240:243], v249 offset:24832
ds_read_u16_d16_hi v193, v193
v_pk_add_f16 v195, v195, 1.0 op_sel_hi:[1,0]
v_mfma_f32_16x16x32_bf16 v[180:183], v[244:247], v[108:111], v[180:183]
v_rcp_f16_e64 v202, v201
s_setprio 0
s_waitcnt lgkmcnt(7)
v_mfma_f32_16x16x32_bf16 v[168:171], v[40:43], v[112:115], v[168:171]
ds_read_b128 v[244:247], v254 offset:7952
v_rcp_f16_e64 v199, v198
v_mfma_f32_16x16x32_bf16 v[176:179], v[40:43], v[116:119], v[176:179]
v_rcp_f16_e64 v196, v195
v_mfma_f32_16x16x32_bf16 v[172:175], v[44:47], v[112:115], v[172:175]
ds_read_b128 v[40:43], v248 offset:28672
v_rcp_f16_sdwa v202, v201 dst_sel:WORD_1 dst_unused:UNUSED_PRESERVE src0_sel:WORD_1
v_mfma_f32_16x16x32_bf16 v[180:183], v[44:47], v[116:119], v[180:183]
v_rcp_f16_sdwa v199, v198 dst_sel:WORD_1 dst_unused:UNUSED_PRESERVE src0_sel:WORD_1
v_or_b32 v232, v184, v185
v_or_b32 v233, v186, v187
s_waitcnt lgkmcnt(4)
v_or_b32 v234, v188, v189
v_rcp_f16_sdwa v196, v195 dst_sel:WORD_1 dst_unused:UNUSED_PRESERVE src0_sel:WORD_1
v_or_b32 v235, v190, v191
s_waitcnt lgkmcnt(2)
v_or_b32 v236, v192, v193
v_pk_mul_f16 v237, v203, v202
v_pk_mul_f16 v238, v200, v199
v_pk_mul_f16 v239, v197, v196
s_setprio 3
v_mfma_f32_16x16x32_f16 v[48:51], v[224:227], v[232:235], v[228:231]
ds_read_b128 v[44:47], v249 offset:25600
v_cvt_pkrtz_f16_f32 v185, v168, v169
v_cvt_pkrtz_f16_f32 v187, v170, v171
v_mfma_f32_16x16x32_f16 v[56:59], v[224:227], v[236:239], v[228:231]
v_cvt_pkrtz_f16_f32 v189, v172, v173
v_cvt_pkrtz_f16_f32 v191, v174, v175
s_waitcnt lgkmcnt(2)
v_mfma_f32_16x16x32_f16 v[52:55], v[240:243], v[232:235], v[244:247]
ds_read_b128 v[224:227], v254 offset:8064
ds_read_b128 v[228:231], v248 offset:28928
v_cvt_pkrtz_f16_f32 v193, v176, v177
v_cvt_pk_f16_f32 v203, v178, v179
v_mfma_f32_16x16x32_f16 v[60:63], v[240:243], v[236:239], v[244:247]
v_cvt_pk_f16_f32 v200, v180, v181
v_cvt_pk_f16_f32 v197, v182, v183
s_waitcnt lgkmcnt(3)
v_mfma_f32_16x16x32_bf16 v[168:171], v[40:43], v[96:99], 0
ds_read_b128 v[240:243], v249 offset:25856
ds_read_b128 v[244:247], v254 offset:8080
v_pk_fma_f16 v202, v203, v203, s48
v_and_b32_e64 v185, s49, v185
v_mfma_f32_16x16x32_bf16 v[176:179], v[40:43], v[100:103], 0
v_pk_fma_f16 v199, v200, v200, s48
v_and_b32 v187, s49, v187
s_waitcnt lgkmcnt(3)
v_mfma_f32_16x16x32_f16 v[64:67], v[44:47], v[232:235], v[224:227]
ds_read_b128 v[40:43], v248 offset:29696
v_pk_fma_f16 v196, v197, v197, s48
v_bfe_u32 v184, v185, 2, 14
v_pk_mul_f16 v202, v203, v202
v_mfma_f32_16x16x32_f16 v[72:75], v[44:47], v[236:239], v[224:227]
v_bfe_u32 v186, v187, 2, 14
v_pk_mul_f16 v199, v200, v199
s_waitcnt vmcnt(6)
v_mfma_f32_16x16x32_bf16 v[136:139], v[18:21], v[216:219], v[136:139]
ds_read_b128 v[44:47], v249 offset:26624
ds_read_b128 v[224:227], v254 offset:16128
ds_read_u16_d16 v184, v184
ds_read_u16_d16 v186, v186
v_lshrrev_b32 v185, 18, v185
v_pk_mul_f16 v196, v197, v196
v_mfma_f32_16x16x32_bf16 v[140:143], v[16:19], v[216:219], v[140:143]
v_lshrrev_b32 v187, 18, v187
s_waitcnt lgkmcnt(5)
v_mfma_f32_16x16x32_bf16 v[172:175], v[228:231], v[96:99], 0
ds_read_u16_d16_hi v185, v185
ds_read_u16_d16_hi v187, v187
v_exp_f16 v201, v202
v_and_b32 v189, s49, v189
v_mfma_f32_16x16x32_bf16 v[180:183], v[228:231], v[100:103], 0
v_and_b32_e64 v191, s49, v191
v_mfma_f32_16x16x32_f16 v[68:71], v[240:243], v[232:235], v[244:247]
ds_read_b128 v[228:231], v249 offset:26880
v_exp_f16_e64 v198, v199
v_bfe_u32 v188, v189, 2, 14
v_mfma_f32_16x16x32_f16 v[76:79], v[240:243], v[236:239], v[244:247]
v_bfe_u32 v190, v191, 2, 14
v_exp_f16 v195, v196
s_waitcnt lgkmcnt(7)
v_mfma_f32_16x16x32_bf16 v[168:171], v[40:43], v[104:107], v[168:171]
ds_read_b128 v[240:243], v254 offset:16144
ds_read_b128 v[244:247], v248 offset:29952
ds_read_u16_d16 v188, v188
ds_read_u16_d16 v190, v190
v_lshrrev_b32_e64 v189, 18, v189
v_lshrrev_b32 v191, 18, v191
v_mfma_f32_16x16x32_bf16 v[176:179], v[40:43], v[108:111], v[176:179]
v_exp_f16_sdwa v201, v202 dst_sel:WORD_1 dst_unused:UNUSED_PRESERVE src0_sel:WORD_1
s_waitcnt lgkmcnt(7)
v_mfma_f32_16x16x32_f16 v[80:83], v[44:47], v[232:235], v[224:227]
ds_read_b128 v[40:43], v248 offset:30720
ds_read_u16_d16_hi v189, v189
ds_read_u16_d16_hi v191, v191
v_and_b32 v193, s49, v193
v_bfe_u32 v192, v193, 2, 14
v_mfma_f32_16x16x32_f16 v[88:91], v[44:47], v[236:239], v[224:227]
v_exp_f16_sdwa v198, v199 dst_sel:WORD_1 dst_unused:UNUSED_PRESERVE src0_sel:WORD_1
s_waitcnt lgkmcnt(6)
v_mfma_f32_16x16x32_f16 v[84:87], v[228:231], v[232:235], v[240:243]
ds_read_b128 v[44:47], v248 offset:30976
ds_read_b128 v[224:227], v249 offset:30720
ds_read_u16_d16 v192, v192
v_lshrrev_b32 v193, 18, v193
v_mfma_f32_16x16x32_f16 v[92:95], v[228:231], v[236:239], v[240:243]
v_exp_f16_sdwa v195, v196 dst_sel:WORD_1 dst_unused:UNUSED_PRESERVE src0_sel:WORD_1
v_pk_add_f16 v201, v201, 1.0 op_sel_hi:[1,0]
v_pk_add_f16 v198, v198, 1.0 op_sel_hi:[1,0]
s_waitcnt lgkmcnt(7)
v_mfma_f32_16x16x32_bf16 v[172:175], v[244:247], v[104:107], v[172:175]
ds_read_b128 v[228:231], v249 offset:30976
ds_read_b128 v[240:243], v248 offset:34816
ds_read_u16_d16_hi v193, v193
v_pk_add_f16 v195, v195, 1.0 op_sel_hi:[1,0]
v_mfma_f32_16x16x32_bf16 v[180:183], v[244:247], v[108:111], v[180:183]
v_rcp_f16 v202, v201
s_waitcnt lgkmcnt(8)
v_mfma_f32_16x16x32_bf16 v[168:171], v[40:43], v[112:115], v[168:171]
ds_read_b128 v[244:247], v249 offset:31744
v_rcp_f16_e64 v199, v198
v_mfma_f32_16x16x32_bf16 v[176:179], v[40:43], v[116:119], v[176:179]
v_rcp_f16 v196, v195
s_waitcnt lgkmcnt(6)
v_mfma_f32_16x16x32_bf16 v[172:175], v[44:47], v[112:115], v[172:175]
ds_read_b128 v[40:43], v248 offset:35072
v_rcp_f16_sdwa v202, v201 dst_sel:WORD_1 dst_unused:UNUSED_PRESERVE src0_sel:WORD_1
v_mfma_f32_16x16x32_bf16 v[180:183], v[44:47], v[116:119], v[180:183]
v_rcp_f16_sdwa v199, v198 dst_sel:WORD_1 dst_unused:UNUSED_PRESERVE src0_sel:WORD_1
v_or_b32 v232, v184, v185
v_or_b32 v233, v186, v187
v_or_b32_e64 v234, v188, v189
v_rcp_f16_sdwa v196, v195 dst_sel:WORD_1 dst_unused:UNUSED_PRESERVE src0_sel:WORD_1
v_or_b32 v235, v190, v191
s_waitcnt lgkmcnt(2)
v_or_b32_e64 v236, v192, v193
v_pk_mul_f16 v237, v203, v202
v_pk_mul_f16 v238, v200, v199
v_pk_mul_f16 v239, v197, v196
v_mfma_f32_16x16x32_f16 v[48:51], v[224:227], v[232:235], v[48:51]
s_add_u32 s46, s68, 98304
buffer_load_dwordx4 v[216:219], v252, s[4:7], s46 offen offset:128
ds_read_b128 v[44:47], v249 offset:32000
v_cvt_pkrtz_f16_f32 v185, v168, v169
v_cvt_pkrtz_f16_f32 v187, v170, v171
v_mfma_f32_16x16x32_f16 v[56:59], v[224:227], v[236:239], v[56:59]
v_cvt_pkrtz_f16_f32 v189, v172, v173
v_cvt_pkrtz_f16_f32 v191, v174, v175
v_mfma_f32_16x16x32_f16 v[52:55], v[228:231], v[232:235], v[52:55]
ds_read_b128 v[224:227], v248 offset:35840
v_cvt_pkrtz_f16_f32 v193, v176, v177
v_cvt_pk_f16_f32 v203, v178, v179
v_mfma_f32_16x16x32_f16 v[60:63], v[228:231], v[236:239], v[60:63]
v_cvt_pk_f16_f32 v200, v180, v181
v_cvt_pk_f16_f32 v197, v182, v183
v_mfma_f32_16x16x32_bf16 v[168:171], v[240:243], v[96:99], 0
ds_read_b128 v[228:231], v249 offset:32768
v_pk_fma_f16 v202, v203, v203, s48
v_and_b32_e64 v185, s49, v185
v_mfma_f32_16x16x32_bf16 v[176:179], v[240:243], v[100:103], 0
v_pk_fma_f16 v199, v200, v200, s48
v_and_b32 v187, s49, v187
s_waitcnt lgkmcnt(3)
v_mfma_f32_16x16x32_f16 v[64:67], v[244:247], v[232:235], v[64:67]
ds_read_b128 v[240:243], v249 offset:33024
v_pk_fma_f16 v196, v197, v197, s48
s_setprio 2
v_bfe_u32 v184, v185, 2, 14
v_pk_mul_f16 v202, v203, v202
v_mfma_f32_16x16x32_f16 v[72:75], v[244:247], v[236:239], v[72:75]
v_bfe_u32 v186, v187, 2, 14
v_pk_mul_f16 v199, v200, v199
s_waitcnt vmcnt(5)
v_mfma_f32_16x16x32_bf16 v[152:155], v[18:21], v[12:15], v[152:155]
ds_read_b128 v[244:247], v248 offset:36096
ds_read_u16_d16 v184, v184
ds_read_u16_d16 v186, v186
v_lshrrev_b32_e64 v185, 18, v185
v_pk_mul_f16 v196, v197, v196
v_mfma_f32_16x16x32_bf16 v[156:159], v[16:19], v[12:15], v[156:159]
v_lshrrev_b32_e64 v187, 18, v187
v_mfma_f32_16x16x32_bf16 v[172:175], v[40:43], v[96:99], 0
ds_read_u16_d16_hi v185, v185
ds_read_u16_d16_hi v187, v187
v_exp_f16 v201, v202
v_and_b32 v189, s49, v189
v_mfma_f32_16x16x32_bf16 v[180:183], v[40:43], v[100:103], 0
v_and_b32 v191, s49, v191
s_waitcnt lgkmcnt(6)
v_mfma_f32_16x16x32_f16 v[68:71], v[44:47], v[232:235], v[68:71]
ds_read_b128 v[40:43], v248 offset:36864
v_exp_f16_e64 v198, v199
v_bfe_u32 v188, v189, 2, 14
v_mfma_f32_16x16x32_f16 v[76:79], v[44:47], v[236:239], v[76:79]
v_bfe_u32 v190, v191, 2, 14
v_exp_f16_e64 v195, v196
v_mfma_f32_16x16x32_bf16 v[168:171], v[224:227], v[104:107], v[168:171]
ds_read_b128 v[44:47], v248 offset:37120
ds_read_u16_d16 v188, v188
ds_read_u16_d16 v190, v190
v_lshrrev_b32 v189, 18, v189
v_lshrrev_b32 v191, 18, v191
v_mfma_f32_16x16x32_bf16 v[176:179], v[224:227], v[108:111], v[176:179]
v_exp_f16_sdwa v201, v202 dst_sel:WORD_1 dst_unused:UNUSED_PRESERVE src0_sel:WORD_1
v_mfma_f32_16x16x32_f16 v[80:83], v[228:231], v[232:235], v[80:83]
ds_read_b128 v[224:227], v249 offset:36864
ds_read_u16_d16_hi v189, v189
ds_read_u16_d16_hi v191, v191
v_and_b32 v193, s49, v193
v_bfe_u32 v192, v193, 2, 14
v_mfma_f32_16x16x32_f16 v[88:91], v[228:231], v[236:239], v[88:91]
v_exp_f16_sdwa v198, v199 dst_sel:WORD_1 dst_unused:UNUSED_PRESERVE src0_sel:WORD_1
s_waitcnt lgkmcnt(7)
v_mfma_f32_16x16x32_f16 v[84:87], v[240:243], v[232:235], v[84:87]
ds_read_b128 v[228:231], v249 offset:37120
ds_read_u16_d16 v192, v192
v_lshrrev_b32_e64 v193, 18, v193
v_mfma_f32_16x16x32_f16 v[92:95], v[240:243], v[236:239], v[92:95]
v_exp_f16_sdwa v195, v196 dst_sel:WORD_1 dst_unused:UNUSED_PRESERVE src0_sel:WORD_1
v_pk_add_f16 v201, v201, 1.0 op_sel_hi:[1,0]
v_pk_add_f16 v198, v198, 1.0 op_sel_hi:[1,0]
v_mfma_f32_16x16x32_bf16 v[172:175], v[244:247], v[104:107], v[172:175]
ds_read_b128 v[240:243], v248 offset:40960
ds_read_u16_d16_hi v193, v193
v_pk_add_f16 v195, v195, 1.0 op_sel_hi:[1,0]
v_mfma_f32_16x16x32_bf16 v[180:183], v[244:247], v[108:111], v[180:183]
v_rcp_f16 v202, v201
s_waitcnt lgkmcnt(7)
v_mfma_f32_16x16x32_bf16 v[168:171], v[40:43], v[112:115], v[168:171]
ds_read_b128 v[244:247], v249 offset:37888
v_rcp_f16_e64 v199, v198
v_mfma_f32_16x16x32_bf16 v[176:179], v[40:43], v[116:119], v[176:179]
v_rcp_f16_e64 v196, v195
v_mfma_f32_16x16x32_bf16 v[172:175], v[44:47], v[112:115], v[172:175]
ds_read_b128 v[40:43], v248 offset:41216
v_rcp_f16_sdwa v202, v201 dst_sel:WORD_1 dst_unused:UNUSED_PRESERVE src0_sel:WORD_1
v_mfma_f32_16x16x32_bf16 v[180:183], v[44:47], v[116:119], v[180:183]
v_rcp_f16_sdwa v199, v198 dst_sel:WORD_1 dst_unused:UNUSED_PRESERVE src0_sel:WORD_1
v_or_b32 v232, v184, v185
v_or_b32 v233, v186, v187
s_waitcnt lgkmcnt(4)
v_or_b32 v234, v188, v189
v_rcp_f16_sdwa v196, v195 dst_sel:WORD_1 dst_unused:UNUSED_PRESERVE src0_sel:WORD_1
v_or_b32 v235, v190, v191
s_waitcnt lgkmcnt(2)
v_or_b32_e64 v236, v192, v193
v_pk_mul_f16 v237, v203, v202
v_pk_mul_f16 v238, v200, v199
v_pk_mul_f16 v239, v197, v196
v_mfma_f32_16x16x32_f16 v[48:51], v[224:227], v[232:235], v[48:51]
buffer_load_dwordx4 v[12:15], v252, s[4:7], s69 offen
ds_read_b128 v[44:47], v249 offset:38144
v_cvt_pkrtz_f16_f32 v185, v168, v169
v_cvt_pkrtz_f16_f32 v187, v170, v171
v_cvt_pkrtz_f16_f32 v189, v172, v173
v_mfma_f32_16x16x32_f16 v[56:59], v[224:227], v[236:239], v[56:59]
v_cvt_pkrtz_f16_f32 v191, v174, v175
v_cvt_pkrtz_f16_f32 v193, v176, v177
v_cvt_pkrtz_f16_f32 v195, v178, v179
v_mfma_f32_16x16x32_f16 v[52:55], v[228:231], v[232:235], v[52:55]
ds_read_b128 v[224:227], v248 offset:41984
v_cvt_pk_f16_f32 v203, v180, v181
v_cvt_pk_f16_f32 v200, v182, v183
v_pk_fma_f16 v202, v203, v203, s48
s_setprio 1
v_mfma_f32_16x16x32_f16 v[60:63], v[228:231], v[236:239], v[60:63]
v_cvt_pk_bf16_f32 v136, v136, v137
v_and_b32 v185, s49, v185
v_cvt_pk_bf16_f32 v137, v138, v139
v_mfma_f32_16x16x32_bf16 v[168:171], v[240:243], v[96:99], 0
ds_read_b128 v[228:231], v249 offset:38912
v_and_b32 v187, s49, v187
v_cvt_pk_bf16_f32 v138, v140, v141
v_pk_fma_f16 v199, v200, v200, s48
v_mfma_f32_16x16x32_bf16 v[176:179], v[240:243], v[100:103], 0
v_bfe_u32 v184, v185, 2, 14
v_cvt_pk_bf16_f32 v139, v142, v143
v_pk_mul_f16 v202, v203, v202
s_waitcnt lgkmcnt(2)
v_mfma_f32_16x16x32_f16 v[64:67], v[244:247], v[232:235], v[64:67]
ds_read_b128 v[240:243], v249 offset:39168
ds_read_u16_d16 v184, v184
v_cvt_pk_bf16_f32 v120, v120, v121
v_bfe_u32 v186, v187, 2, 14
v_cvt_pk_bf16_f32 v121, v122, v123
v_mfma_f32_16x16x32_f16 v[72:75], v[244:247], v[236:239], v[72:75]
v_pk_mul_f16 v199, v200, v199
v_lshrrev_b32_e64 v185, 18, v185
v_cvt_pk_bf16_f32 v122, v124, v125
v_mfma_f32_16x16x32_bf16 v[172:175], v[40:43], v[96:99], 0
ds_read_b128 v[244:247], v248 offset:42240
ds_read_u16_d16 v186, v186
ds_read_u16_d16_hi v185, v185
v_exp_f16_e64 v201, v202
v_cvt_pk_bf16_f32 v123, v126, v127
v_mfma_f32_16x16x32_bf16 v[180:183], v[40:43], v[100:103], 0
v_lshrrev_b32_e64 v187, 18, v187
v_cvt_pk_bf16_f32 v152, v152, v153
v_and_b32_e64 v189, s49, v189
v_mfma_f32_16x16x32_f16 v[68:71], v[44:47], v[232:235], v[68:71]
ds_read_b128 v[40:43], v248 offset:43008
ds_read_u16_d16_hi v187, v187
v_cvt_pk_bf16_f32 v153, v154, v155
v_exp_f16_e64 v198, v199
v_mfma_f32_16x16x32_f16 v[76:79], v[44:47], v[236:239], v[76:79]
v_cvt_pk_bf16_f32 v154, v156, v157
v_and_b32_e64 v191, s49, v191
v_cvt_pk_bf16_f32 v155, v158, v159
s_mov_b64 vcc, s[74:75]
s_waitcnt lgkmcnt(5)
v_mfma_f32_16x16x32_bf16 v[168:171], v[224:227], v[104:107], v[168:171]
ds_read_b128 v[44:47], v248 offset:43264
v_bfe_u32 v188, v189, 2, 14
v_cndmask_b32 v140, v120, v152, vcc
v_mfma_f32_16x16x32_bf16 v[176:179], v[224:227], v[108:111], v[176:179]
v_exp_f16_sdwa v201, v202 dst_sel:WORD_1 dst_unused:UNUSED_PRESERVE src0_sel:WORD_1
v_cndmask_b32 v141, v121, v153, vcc
v_bfe_u32 v190, v191, 2, 14
v_mfma_f32_16x16x32_f16 v[80:83], v[228:231], v[232:235], v[80:83]
ds_read_b128 v[224:227], v249 offset:43008
ds_read_u16_d16 v188, v188
ds_read_u16_d16 v190, v190
v_cndmask_b32 v142, v122, v154, vcc
v_lshrrev_b32 v189, 18, v189
v_cndmask_b32 v143, v123, v155, vcc
v_mfma_f32_16x16x32_f16 v[88:91], v[228:231], v[236:239], v[88:91]
v_lshrrev_b32 v191, 18, v191
v_exp_f16_sdwa v198, v199 dst_sel:WORD_1 dst_unused:UNUSED_PRESERVE src0_sel:WORD_1
v_mfma_f32_16x16x32_f16 v[84:87], v[240:243], v[232:235], v[84:87]
ds_read_b128 v[228:231], v249 offset:43264
ds_read_u16_d16_hi v189, v189
ds_read_u16_d16_hi v191, v191
v_cndmask_b32_dpp v120, v136, v120, vcc quad_perm:[1,0,3,2] row_mask:0xf bank_mask:0xf
v_cndmask_b32_dpp v121, v137, v121, vcc quad_perm:[1,0,3,2] row_mask:0xf bank_mask:0xf
v_and_b32_e64 v193, s49, v193
v_mfma_f32_16x16x32_f16 v[92:95], v[240:243], v[236:239], v[92:95]
v_cndmask_b32_dpp v122, v138, v122, vcc quad_perm:[1,0,3,2] row_mask:0xf bank_mask:0xf
v_and_b32 v195, s49, v195
v_pk_add_f16 v201, v201, 1.0 op_sel_hi:[1,0]
s_waitcnt lgkmcnt(6)
v_mfma_f32_16x16x32_bf16 v[172:175], v[244:247], v[104:107], v[172:175]
ds_read_b128 v[240:243], v248 offset:47104
v_cndmask_b32_dpp v123, v139, v123, vcc quad_perm:[1,0,3,2] row_mask:0xf bank_mask:0xf
s_not_b64 vcc, s[74:75]
v_bfe_u32 v192, v193, 2, 14
s_setprio 0
v_cndmask_b32_dpp v152, v136, v152, vcc quad_perm:[1,0,3,2] row_mask:0xf bank_mask:0xf
v_mfma_f32_16x16x32_bf16 v[180:183], v[244:247], v[108:111], v[180:183]
v_pk_add_f16 v198, v198, 1.0 op_sel_hi:[1,0]
v_cndmask_b32_dpp v153, v137, v153, vcc quad_perm:[1,0,3,2] row_mask:0xf bank_mask:0xf
v_bfe_u32 v194, v195, 2, 14
v_mfma_f32_16x16x32_bf16 v[168:171], v[40:43], v[112:115], v[168:171]
ds_read_b128 v[244:247], v249 offset:44032
ds_read_u16_d16 v192, v192
ds_read_u16_d16 v194, v194
v_rcp_f16_e64 v202, v201
v_cndmask_b32_dpp v154, v138, v154, vcc quad_perm:[1,0,3,2] row_mask:0xf bank_mask:0xf
v_mfma_f32_16x16x32_bf16 v[176:179], v[40:43], v[116:119], v[176:179]
v_cndmask_b32_dpp v155, v139, v155, vcc quad_perm:[1,0,3,2] row_mask:0xf bank_mask:0xf
v_lshrrev_b32 v193, 18, v193
v_lshrrev_b32 v195, 18, v195
v_mfma_f32_16x16x32_bf16 v[172:175], v[44:47], v[112:115], v[172:175]
ds_read_b128 v[40:43], v248 offset:47360
buffer_store_dwordx4 v[120:123], v255, s[8:11], s68 offen sc1
ds_read_u16_d16_hi v193, v193
ds_read_u16_d16_hi v195, v195
v_rcp_f16_e64 v199, v198
v_mfma_f32_16x16x32_bf16 v[180:183], v[44:47], v[116:119], v[180:183]
v_rcp_f16_sdwa v202, v201 dst_sel:WORD_1 dst_unused:UNUSED_PRESERVE src0_sel:WORD_1
v_or_b32 v232, v184, v185
v_or_b32 v233, v186, v187
s_waitcnt lgkmcnt(6)
v_or_b32 v234, v188, v189
v_rcp_f16_sdwa v199, v198 dst_sel:WORD_1 dst_unused:UNUSED_PRESERVE src0_sel:WORD_1
v_or_b32 v235, v190, v191
s_waitcnt lgkmcnt(1)
v_or_b32 v236, v192, v193
s_waitcnt lgkmcnt(0)
v_or_b32 v237, v194, v195
v_pk_mul_f16 v238, v203, v202
v_pk_mul_f16 v239, v200, v199
s_setprio 3
v_mfma_f32_16x16x32_f16 v[48:51], v[224:227], v[232:235], v[48:51]
buffer_load_dwordx4 v[204:207], v252, s[4:7], s69 offen offset:64
ds_read_b128 v[44:47], v249 offset:44288
v_cvt_pkrtz_f16_f32 v185, v168, v169
v_cvt_pkrtz_f16_f32 v187, v170, v171
v_mfma_f32_16x16x32_f16 v[56:59], v[224:227], v[236:239], v[56:59]
v_cvt_pkrtz_f16_f32 v189, v172, v173
v_cvt_pkrtz_f16_f32 v191, v174, v175
v_mfma_f32_16x16x32_f16 v[52:55], v[228:231], v[232:235], v[52:55]
ds_read_b128 v[224:227], v248 offset:48128
v_cvt_pkrtz_f16_f32 v193, v176, v177
v_cvt_pk_f16_f32 v203, v178, v179
v_mfma_f32_16x16x32_f16 v[60:63], v[228:231], v[236:239], v[60:63]
v_cvt_pk_f16_f32 v200, v180, v181
v_cvt_pk_f16_f32 v197, v182, v183
v_mfma_f32_16x16x32_bf16 v[168:171], v[240:243], v[96:99], 0
ds_read_b128 v[228:231], v249 offset:45056
v_pk_fma_f16 v202, v203, v203, s48
v_and_b32_e64 v185, s49, v185
v_mfma_f32_16x16x32_bf16 v[176:179], v[240:243], v[100:103], 0
v_pk_fma_f16 v199, v200, v200, s48
v_and_b32_e64 v187, s49, v187
v_mfma_f32_16x16x32_f16 v[64:67], v[244:247], v[232:235], v[64:67]
ds_read_b128 v[240:243], v249 offset:45312
v_pk_fma_f16 v196, v197, v197, s48
v_bfe_u32 v184, v185, 2, 14
v_pk_mul_f16 v202, v203, v202
v_mfma_f32_16x16x32_f16 v[72:75], v[244:247], v[236:239], v[72:75]
v_bfe_u32 v186, v187, 2, 14
v_pk_mul_f16 v199, v200, v199
s_waitcnt vmcnt(7)
v_mfma_f32_16x16x32_bf16 v[128:131], v[18:21], v[8:11], v[128:131]
ds_read_b128 v[244:247], v248 offset:48384
ds_read_u16_d16 v184, v184
ds_read_u16_d16 v186, v186
v_lshrrev_b32 v185, 18, v185
v_pk_mul_f16 v196, v197, v196
v_mfma_f32_16x16x32_bf16 v[132:135], v[16:19], v[8:11], v[132:135]
v_lshrrev_b32_e64 v187, 18, v187
v_mfma_f32_16x16x32_bf16 v[172:175], v[40:43], v[96:99], 0
ds_read_u16_d16_hi v185, v185
ds_read_u16_d16_hi v187, v187
v_exp_f16 v201, v202
v_and_b32 v189, s49, v189
v_mfma_f32_16x16x32_bf16 v[180:183], v[40:43], v[100:103], 0
v_and_b32 v191, s49, v191
s_waitcnt lgkmcnt(6)
v_mfma_f32_16x16x32_f16 v[68:71], v[44:47], v[232:235], v[68:71]
ds_read_b128 v[40:43], v248 offset:49152
v_exp_f16_e64 v198, v199
v_bfe_u32 v188, v189, 2, 14
v_mfma_f32_16x16x32_f16 v[76:79], v[44:47], v[236:239], v[76:79]
v_bfe_u32 v190, v191, 2, 14
v_exp_f16_e64 v195, v196
v_mfma_f32_16x16x32_bf16 v[168:171], v[224:227], v[104:107], v[168:171]
buffer_store_dwordx4 v[140:143], v255, s[8:11], s68 offen offset:128 sc1
ds_read_b128 v[44:47], v248 offset:49408
ds_read_u16_d16 v188, v188
ds_read_u16_d16 v190, v190
v_lshrrev_b32 v189, 18, v189
v_lshrrev_b32 v191, 18, v191
v_mfma_f32_16x16x32_bf16 v[176:179], v[224:227], v[108:111], v[176:179]
v_exp_f16_sdwa v201, v202 dst_sel:WORD_1 dst_unused:UNUSED_PRESERVE src0_sel:WORD_1
v_mfma_f32_16x16x32_f16 v[80:83], v[228:231], v[232:235], v[80:83]
ds_read_b128 v[224:227], v249 offset:49152
ds_read_u16_d16_hi v189, v189
ds_read_u16_d16_hi v191, v191
v_and_b32 v193, s49, v193
v_bfe_u32 v192, v193, 2, 14
v_mfma_f32_16x16x32_f16 v[88:91], v[228:231], v[236:239], v[88:91]
v_exp_f16_sdwa v198, v199 dst_sel:WORD_1 dst_unused:UNUSED_PRESERVE src0_sel:WORD_1
s_waitcnt lgkmcnt(7)
v_mfma_f32_16x16x32_f16 v[84:87], v[240:243], v[232:235], v[84:87]
ds_read_b128 v[228:231], v249 offset:49408
ds_read_u16_d16 v192, v192
v_lshrrev_b32_e64 v193, 18, v193
v_mfma_f32_16x16x32_f16 v[92:95], v[240:243], v[236:239], v[92:95]
v_exp_f16_sdwa v195, v196 dst_sel:WORD_1 dst_unused:UNUSED_PRESERVE src0_sel:WORD_1
v_pk_add_f16 v201, v201, 1.0 op_sel_hi:[1,0]
v_pk_add_f16 v198, v198, 1.0 op_sel_hi:[1,0]
v_mfma_f32_16x16x32_bf16 v[172:175], v[244:247], v[104:107], v[172:175]
ds_read_b128 v[240:243], v248 offset:53248
ds_read_u16_d16_hi v193, v193
v_pk_add_f16 v195, v195, 1.0 op_sel_hi:[1,0]
v_mfma_f32_16x16x32_bf16 v[180:183], v[244:247], v[108:111], v[180:183]
v_rcp_f16 v202, v201
s_waitcnt lgkmcnt(7)
v_mfma_f32_16x16x32_bf16 v[168:171], v[40:43], v[112:115], v[168:171]
ds_read_b128 v[244:247], v249 offset:50176
v_rcp_f16_e64 v199, v198
v_mfma_f32_16x16x32_bf16 v[176:179], v[40:43], v[116:119], v[176:179]
v_rcp_f16_e64 v196, v195
v_mfma_f32_16x16x32_bf16 v[172:175], v[44:47], v[112:115], v[172:175]
ds_read_b128 v[40:43], v248 offset:53504
v_rcp_f16_sdwa v202, v201 dst_sel:WORD_1 dst_unused:UNUSED_PRESERVE src0_sel:WORD_1
v_mfma_f32_16x16x32_bf16 v[180:183], v[44:47], v[116:119], v[180:183]
v_rcp_f16_sdwa v199, v198 dst_sel:WORD_1 dst_unused:UNUSED_PRESERVE src0_sel:WORD_1
v_or_b32 v232, v184, v185
v_or_b32 v233, v186, v187
s_waitcnt lgkmcnt(4)
v_or_b32 v234, v188, v189
v_rcp_f16_sdwa v196, v195 dst_sel:WORD_1 dst_unused:UNUSED_PRESERVE src0_sel:WORD_1
v_or_b32 v235, v190, v191
s_waitcnt lgkmcnt(2)
v_or_b32_e64 v236, v192, v193
v_pk_mul_f16 v237, v203, v202
v_pk_mul_f16 v238, v200, v199
v_pk_mul_f16 v239, v197, v196
v_mfma_f32_16x16x32_f16 v[48:51], v[224:227], v[232:235], v[48:51]
buffer_load_dwordx4 v[8:11], v252, s[4:7], s69 offen offset:128
ds_read_b128 v[44:47], v249 offset:50432
v_cvt_pkrtz_f16_f32 v185, v168, v169
v_cvt_pkrtz_f16_f32 v187, v170, v171
v_mfma_f32_16x16x32_f16 v[56:59], v[224:227], v[236:239], v[56:59]
v_cvt_pkrtz_f16_f32 v189, v172, v173
v_cvt_pkrtz_f16_f32 v191, v174, v175
v_mfma_f32_16x16x32_f16 v[52:55], v[228:231], v[232:235], v[52:55]
ds_read_b128 v[224:227], v248 offset:54272
v_cvt_pkrtz_f16_f32 v193, v176, v177
v_cvt_pk_f16_f32 v203, v178, v179
v_mfma_f32_16x16x32_f16 v[60:63], v[228:231], v[236:239], v[60:63]
v_cvt_pk_f16_f32 v200, v180, v181
v_cvt_pk_f16_f32 v197, v182, v183
v_mfma_f32_16x16x32_bf16 v[168:171], v[240:243], v[96:99], 0
ds_read_b128 v[228:231], v249 offset:51200
v_pk_fma_f16 v202, v203, v203, s48
v_and_b32_e64 v185, s49, v185
v_mfma_f32_16x16x32_bf16 v[176:179], v[240:243], v[100:103], 0
v_pk_fma_f16 v199, v200, v200, s48
v_and_b32 v187, s49, v187
s_waitcnt lgkmcnt(3)
v_mfma_f32_16x16x32_f16 v[64:67], v[244:247], v[232:235], v[64:67]
ds_read_b128 v[240:243], v249 offset:51456
v_pk_fma_f16 v196, v197, v197, s48
s_setprio 2
v_bfe_u32 v184, v185, 2, 14
v_pk_mul_f16 v202, v203, v202
v_mfma_f32_16x16x32_f16 v[72:75], v[244:247], v[236:239], v[72:75]
v_bfe_u32 v186, v187, 2, 14
v_pk_mul_f16 v199, v200, v199
s_waitcnt vmcnt(7)
v_mfma_f32_16x16x32_bf16 v[144:147], v[18:21], v[36:39], v[144:147]
ds_read_b128 v[244:247], v248 offset:54528
ds_read_u16_d16 v184, v184
ds_read_u16_d16 v186, v186
v_lshrrev_b32_e64 v185, 18, v185
v_pk_mul_f16 v196, v197, v196
v_mfma_f32_16x16x32_bf16 v[148:151], v[16:19], v[36:39], v[148:151]
v_lshrrev_b32_e64 v187, 18, v187
v_mfma_f32_16x16x32_bf16 v[172:175], v[40:43], v[96:99], 0
ds_read_u16_d16_hi v185, v185
ds_read_u16_d16_hi v187, v187
v_exp_f16 v201, v202
v_and_b32 v189, s49, v189
v_mfma_f32_16x16x32_bf16 v[180:183], v[40:43], v[100:103], 0
v_and_b32 v191, s49, v191
s_waitcnt lgkmcnt(6)
v_mfma_f32_16x16x32_f16 v[68:71], v[44:47], v[232:235], v[68:71]
ds_read_b128 v[40:43], v248 offset:55296
v_exp_f16_e64 v198, v199
v_bfe_u32 v188, v189, 2, 14
v_mfma_f32_16x16x32_f16 v[76:79], v[44:47], v[236:239], v[76:79]
v_bfe_u32 v190, v191, 2, 14
v_exp_f16_e64 v195, v196
v_mfma_f32_16x16x32_bf16 v[168:171], v[224:227], v[104:107], v[168:171]
ds_read_b128 v[44:47], v248 offset:55552
ds_read_u16_d16 v188, v188
ds_read_u16_d16 v190, v190
v_lshrrev_b32 v189, 18, v189
v_lshrrev_b32 v191, 18, v191
v_mfma_f32_16x16x32_bf16 v[176:179], v[224:227], v[108:111], v[176:179]
v_exp_f16_sdwa v201, v202 dst_sel:WORD_1 dst_unused:UNUSED_PRESERVE src0_sel:WORD_1
v_mfma_f32_16x16x32_f16 v[80:83], v[228:231], v[232:235], v[80:83]
ds_read_b128 v[224:227], v249 offset:55296
ds_read_u16_d16_hi v189, v189
ds_read_u16_d16_hi v191, v191
v_and_b32 v193, s49, v193
v_bfe_u32 v192, v193, 2, 14
v_mfma_f32_16x16x32_f16 v[88:91], v[228:231], v[236:239], v[88:91]
v_exp_f16_sdwa v198, v199 dst_sel:WORD_1 dst_unused:UNUSED_PRESERVE src0_sel:WORD_1
s_waitcnt lgkmcnt(7)
v_mfma_f32_16x16x32_f16 v[84:87], v[240:243], v[232:235], v[84:87]
ds_read_b128 v[228:231], v249 offset:55552
ds_read_u16_d16 v192, v192
v_lshrrev_b32_e64 v193, 18, v193
v_mfma_f32_16x16x32_f16 v[92:95], v[240:243], v[236:239], v[92:95]
v_exp_f16_sdwa v195, v196 dst_sel:WORD_1 dst_unused:UNUSED_PRESERVE src0_sel:WORD_1
v_pk_add_f16 v201, v201, 1.0 op_sel_hi:[1,0]
v_pk_add_f16 v198, v198, 1.0 op_sel_hi:[1,0]
v_mfma_f32_16x16x32_bf16 v[172:175], v[244:247], v[104:107], v[172:175]
ds_read_b128 v[240:243], v248 offset:59392
ds_read_u16_d16_hi v193, v193
v_pk_add_f16 v195, v195, 1.0 op_sel_hi:[1,0]
v_mfma_f32_16x16x32_bf16 v[180:183], v[244:247], v[108:111], v[180:183]
v_rcp_f16 v202, v201
s_waitcnt lgkmcnt(7)
v_mfma_f32_16x16x32_bf16 v[168:171], v[40:43], v[112:115], v[168:171]
ds_read_b128 v[244:247], v249 offset:56320
v_rcp_f16_e64 v199, v198
v_mfma_f32_16x16x32_bf16 v[176:179], v[40:43], v[116:119], v[176:179]
v_rcp_f16_e64 v196, v195
v_mfma_f32_16x16x32_bf16 v[172:175], v[44:47], v[112:115], v[172:175]
ds_read_b128 v[40:43], v248 offset:59648
v_rcp_f16_sdwa v202, v201 dst_sel:WORD_1 dst_unused:UNUSED_PRESERVE src0_sel:WORD_1
v_mfma_f32_16x16x32_bf16 v[180:183], v[44:47], v[116:119], v[180:183]
v_rcp_f16_sdwa v199, v198 dst_sel:WORD_1 dst_unused:UNUSED_PRESERVE src0_sel:WORD_1
v_or_b32 v232, v184, v185
v_or_b32 v233, v186, v187
s_waitcnt lgkmcnt(4)
v_or_b32 v234, v188, v189
v_rcp_f16_sdwa v196, v195 dst_sel:WORD_1 dst_unused:UNUSED_PRESERVE src0_sel:WORD_1
v_or_b32 v235, v190, v191
s_waitcnt lgkmcnt(2)
v_or_b32_e64 v236, v192, v193
v_pk_mul_f16 v237, v203, v202
v_pk_mul_f16 v238, v200, v199
v_pk_mul_f16 v239, v197, v196
v_mfma_f32_16x16x32_f16 v[48:51], v[224:227], v[232:235], v[48:51]
s_add_u32 s46, s69, 98304
buffer_load_dwordx4 v[36:39], v252, s[4:7], s46 offen
ds_read_b128 v[44:47], v249 offset:56576
v_cvt_pkrtz_f16_f32 v185, v168, v169
v_cvt_pkrtz_f16_f32 v187, v170, v171
v_mfma_f32_16x16x32_f16 v[56:59], v[224:227], v[236:239], v[56:59]
v_cvt_pkrtz_f16_f32 v189, v172, v173
v_cvt_pkrtz_f16_f32 v191, v174, v175
v_mfma_f32_16x16x32_f16 v[52:55], v[228:231], v[232:235], v[52:55]
ds_read_b128 v[224:227], v248 offset:60416
v_cvt_pkrtz_f16_f32 v193, v176, v177
v_cvt_pk_f16_f32 v203, v178, v179
v_cvt_pk_f16_f32 v200, v180, v181
v_mfma_f32_16x16x32_f16 v[60:63], v[228:231], v[236:239], v[60:63]
v_cvt_pk_f16_f32 v197, v182, v183
s_setprio 1
v_pk_fma_f16 v202, v203, v203, s48
v_mfma_f32_16x16x32_bf16 v[168:171], v[240:243], v[96:99], 0
ds_read_b128 v[228:231], v249 offset:57344
v_and_b32 v185, s49, v185
v_pk_fma_f16 v199, v200, v200, s48
v_mfma_f32_16x16x32_bf16 v[176:179], v[240:243], v[100:103], 0
v_and_b32 v187, s49, v187
v_pk_fma_f16 v196, v197, v197, s48
v_bfe_u32 v184, v185, 2, 14
s_waitcnt lgkmcnt(3)
v_mfma_f32_16x16x32_f16 v[64:67], v[244:247], v[232:235], v[64:67]
ds_read_b128 v[240:243], v249 offset:57600
ds_read_u16_d16 v184, v184
v_pk_mul_f16 v202, v203, v202
v_bfe_u32 v186, v187, 2, 14
v_mfma_f32_16x16x32_f16 v[72:75], v[244:247], v[236:239], v[72:75]
v_pk_mul_f16 v199, v200, v199
v_lshrrev_b32_e64 v185, 18, v185
v_mfma_f32_16x16x32_bf16 v[172:175], v[40:43], v[96:99], 0
ds_read_b128 v[244:247], v248 offset:60672
ds_read_u16_d16 v186, v186
ds_read_u16_d16_hi v185, v185
v_pk_mul_f16 v196, v197, v196
v_lshrrev_b32_e64 v187, 18, v187
v_mfma_f32_16x16x32_bf16 v[180:183], v[40:43], v[100:103], 0
v_exp_f16_e64 v201, v202
v_and_b32 v189, s49, v189
s_waitcnt lgkmcnt(5)
v_mfma_f32_16x16x32_f16 v[68:71], v[44:47], v[232:235], v[68:71]
ds_read_b128 v[40:43], v248 offset:61440
ds_read_u16_d16_hi v187, v187
v_and_b32_e64 v191, s49, v191
v_mfma_f32_16x16x32_f16 v[76:79], v[44:47], v[236:239], v[76:79]
v_exp_f16_e64 v198, v199
v_bfe_u32 v188, v189, 2, 14
v_bfe_u32 v190, v191, 2, 14
v_mfma_f32_16x16x32_bf16 v[168:171], v[224:227], v[104:107], v[168:171]
buffer_store_dwordx4 v[152:155], v255, s[8:11], s68 offen offset:256 sc1
ds_read_b128 v[44:47], v248 offset:61696
ds_read_u16_d16 v188, v188
ds_read_u16_d16 v190, v190
v_exp_f16_e64 v195, v196
v_mfma_f32_16x16x32_bf16 v[176:179], v[224:227], v[108:111], v[176:179]
v_lshrrev_b32 v189, 18, v189
v_lshrrev_b32 v191, 18, v191
v_mfma_f32_16x16x32_f16 v[80:83], v[228:231], v[232:235], v[80:83]
ds_read_b128 v[224:227], v249 offset:61440
ds_read_u16_d16_hi v189, v189
ds_read_u16_d16_hi v191, v191
v_exp_f16_sdwa v201, v202 dst_sel:WORD_1 dst_unused:UNUSED_PRESERVE src0_sel:WORD_1
v_and_b32 v193, s49, v193
v_mfma_f32_16x16x32_f16 v[88:91], v[228:231], v[236:239], v[88:91]
v_bfe_u32 v192, v193, 2, 14
s_waitcnt lgkmcnt(8)
v_mfma_f32_16x16x32_f16 v[84:87], v[240:243], v[232:235], v[84:87]
ds_read_b128 v[228:231], v249 offset:61696
ds_read_u16_d16 v192, v192
v_exp_f16_sdwa v198, v199 dst_sel:WORD_1 dst_unused:UNUSED_PRESERVE src0_sel:WORD_1
v_lshrrev_b32_e64 v193, 18, v193
v_mfma_f32_16x16x32_f16 v[92:95], v[240:243], v[236:239], v[92:95]
v_exp_f16_sdwa v195, v196 dst_sel:WORD_1 dst_unused:UNUSED_PRESERVE src0_sel:WORD_1
v_pk_add_f16 v201, v201, 1.0 op_sel_hi:[1,0]
v_mfma_f32_16x16x32_bf16 v[172:175], v[244:247], v[104:107], v[172:175]
ds_read_b128 v[240:243], v249
ds_read_u16_d16_hi v193, v193
v_pk_add_f16 v198, v198, 1.0 op_sel_hi:[1,0]
v_pk_add_f16 v195, v195, 1.0 op_sel_hi:[1,0]
v_mfma_f32_16x16x32_bf16 v[180:183], v[244:247], v[108:111], v[180:183]
v_rcp_f16_e64 v202, v201
s_setprio 0
s_waitcnt lgkmcnt(7)
v_mfma_f32_16x16x32_bf16 v[168:171], v[40:43], v[112:115], v[168:171]
ds_read_b128 v[244:247], v249 offset:62464
v_rcp_f16_e64 v199, v198
v_mfma_f32_16x16x32_bf16 v[176:179], v[40:43], v[116:119], v[176:179]
v_rcp_f16_e64 v196, v195
v_mfma_f32_16x16x32_bf16 v[172:175], v[44:47], v[112:115], v[172:175]
ds_read_b128 v[40:43], v249 offset:256
v_rcp_f16_sdwa v202, v201 dst_sel:WORD_1 dst_unused:UNUSED_PRESERVE src0_sel:WORD_1
v_mfma_f32_16x16x32_bf16 v[180:183], v[44:47], v[116:119], v[180:183]
v_rcp_f16_sdwa v199, v198 dst_sel:WORD_1 dst_unused:UNUSED_PRESERVE src0_sel:WORD_1
v_or_b32 v232, v184, v185
v_or_b32 v233, v186, v187
s_waitcnt lgkmcnt(4)
v_or_b32 v234, v188, v189
v_rcp_f16_sdwa v196, v195 dst_sel:WORD_1 dst_unused:UNUSED_PRESERVE src0_sel:WORD_1
v_or_b32 v235, v190, v191
s_waitcnt lgkmcnt(2)
v_or_b32_e64 v236, v192, v193
v_pk_mul_f16 v237, v203, v202
v_pk_mul_f16 v238, v200, v199
v_pk_mul_f16 v239, v197, v196
v_mfma_f32_16x16x32_f16 v[48:51], v[224:227], v[232:235], v[48:51]
s_add_u32 s46, s69, 98304
buffer_load_dwordx4 v[32:35], v252, s[4:7], s46 offen offset:64
ds_read_b128 v[44:47], v249 offset:62720
v_cvt_pkrtz_f16_f32 v185, v168, v169
v_cvt_pkrtz_f16_f32 v187, v170, v171
v_mfma_f32_16x16x32_f16 v[56:59], v[224:227], v[236:239], v[56:59]
v_cvt_pkrtz_f16_f32 v189, v172, v173
v_cvt_pkrtz_f16_f32 v191, v174, v175
v_mfma_f32_16x16x32_f16 v[52:55], v[228:231], v[232:235], v[52:55]
ds_read_b128 v[224:227], v249 offset:1024
v_cvt_pkrtz_f16_f32 v193, v176, v177
v_cvt_pk_f16_f32 v203, v178, v179
v_mfma_f32_16x16x32_f16 v[60:63], v[228:231], v[236:239], v[60:63]
v_cvt_pk_f16_f32 v200, v180, v181
v_cvt_pk_f16_f32 v197, v182, v183
v_mfma_f32_16x16x32_bf16 v[168:171], v[240:243], v[96:99], 0
ds_read_b128 v[228:231], v249 offset:63488
v_pk_fma_f16 v202, v203, v203, s48
v_and_b32_e64 v185, s49, v185
v_mfma_f32_16x16x32_bf16 v[176:179], v[240:243], v[100:103], 0
v_pk_fma_f16 v199, v200, v200, s48
v_and_b32 v187, s49, v187
s_waitcnt lgkmcnt(3)
v_mfma_f32_16x16x32_f16 v[64:67], v[244:247], v[232:235], v[64:67]
ds_read_b128 v[240:243], v249 offset:63744
v_pk_fma_f16 v196, v197, v197, s48
v_bfe_u32 v184, v185, 2, 14
v_mfma_f32_16x16x32_f16 v[72:75], v[244:247], v[236:239], v[72:75]
v_pk_mul_f16 v202, v203, v202
v_bfe_u32 v186, v187, 2, 14
s_waitcnt vmcnt(8)
v_mfma_f32_16x16x32_bf16 v[160:163], v[18:21], v[216:219], v[160:163]
ds_read_b128 v[244:247], v249 offset:1280
ds_read_u16_d16 v184, v184
ds_read_u16_d16 v186, v186
v_pk_mul_f16 v199, v200, v199
v_lshrrev_b32 v185, 18, v185
v_mfma_f32_16x16x32_bf16 v[164:167], v[16:19], v[216:219], v[164:167]
v_pk_mul_f16 v196, v197, v196
v_lshrrev_b32_e64 v187, 18, v187
v_mfma_f32_16x16x32_bf16 v[172:175], v[40:43], v[96:99], 0
ds_read_u16_d16_hi v185, v185
ds_read_u16_d16_hi v187, v187
v_exp_f16_e64 v201, v202
v_mfma_f32_16x16x32_bf16 v[180:183], v[40:43], v[100:103], 0
v_and_b32_e64 v189, s49, v189
v_and_b32 v191, s49, v191
s_waitcnt lgkmcnt(6)
v_mfma_f32_16x16x32_f16 v[68:71], v[44:47], v[232:235], v[68:71]
ds_read_b128 v[40:43], v249 offset:2048
v_exp_f16_e64 v198, v199
v_mfma_f32_16x16x32_f16 v[76:79], v[44:47], v[236:239], v[76:79]
v_bfe_u32 v188, v189, 2, 14
v_bfe_u32 v190, v191, 2, 14
v_mfma_f32_16x16x32_bf16 v[168:171], v[224:227], v[104:107], v[168:171]
ds_read_b128 v[44:47], v249 offset:2304
ds_read_u16_d16 v188, v188
ds_read_u16_d16 v190, v190
v_exp_f16_e64 v195, v196
v_mfma_f32_16x16x32_bf16 v[176:179], v[224:227], v[108:111], v[176:179]
v_lshrrev_b32 v189, 18, v189
v_lshrrev_b32 v191, 18, v191
v_mfma_f32_16x16x32_f16 v[80:83], v[228:231], v[232:235], v[80:83]
ds_read_b128 v[224:227], v250 offset:2048
ds_read_u16_d16_hi v189, v189
ds_read_u16_d16_hi v191, v191
v_exp_f16_sdwa v201, v202 dst_sel:WORD_1 dst_unused:UNUSED_PRESERVE src0_sel:WORD_1
v_mfma_f32_16x16x32_f16 v[88:91], v[228:231], v[236:239], v[88:91]
v_and_b32 v193, s49, v193
v_bfe_u32 v192, v193, 2, 14
s_waitcnt lgkmcnt(7)
v_mfma_f32_16x16x32_f16 v[84:87], v[240:243], v[232:235], v[84:87]
ds_read_b128 v[228:231], v250 offset:2304
ds_read_u16_d16 v192, v192
v_exp_f16_sdwa v198, v199 dst_sel:WORD_1 dst_unused:UNUSED_PRESERVE src0_sel:WORD_1
v_mfma_f32_16x16x32_f16 v[92:95], v[240:243], v[236:239], v[92:95]
v_lshrrev_b32 v193, 18, v193
s_waitcnt vmcnt(7)
v_mfma_f32_16x16x32_bf16 v[48:51], v[18:21], v[12:15], v[48:51]
ds_read_b128 v[240:243], v249 offset:6144
ds_read_u16_d16_hi v193, v193
v_exp_f16_sdwa v195, v196 dst_sel:WORD_1 dst_unused:UNUSED_PRESERVE src0_sel:WORD_1
v_pk_add_f16 v201, v201, 1.0 op_sel_hi:[1,0]
v_mfma_f32_16x16x32_bf16 v[52:55], v[16:19], v[12:15], v[52:55]
v_pk_add_f16 v198, v198, 1.0 op_sel_hi:[1,0]
v_pk_add_f16 v195, v195, 1.0 op_sel_hi:[1,0]
v_mfma_f32_16x16x32_bf16 v[172:175], v[244:247], v[104:107], v[172:175]
v_rcp_f16_e64 v202, v201
v_mfma_f32_16x16x32_bf16 v[180:183], v[244:247], v[108:111], v[180:183]
v_rcp_f16 v199, v198
s_waitcnt lgkmcnt(4)
v_mfma_f32_16x16x32_bf16 v[168:171], v[40:43], v[112:115], v[168:171]
ds_read_b128 v[244:247], v250 offset:3072
v_rcp_f16_e64 v196, v195
v_mfma_f32_16x16x32_bf16 v[176:179], v[40:43], v[116:119], v[176:179]
v_rcp_f16_sdwa v202, v201 dst_sel:WORD_1 dst_unused:UNUSED_PRESERVE src0_sel:WORD_1
v_mfma_f32_16x16x32_bf16 v[172:175], v[44:47], v[112:115], v[172:175]
ds_read_b128 v[40:43], v249 offset:6400
v_rcp_f16_sdwa v199, v198 dst_sel:WORD_1 dst_unused:UNUSED_PRESERVE src0_sel:WORD_1
v_mfma_f32_16x16x32_bf16 v[180:183], v[44:47], v[116:119], v[180:183]
v_or_b32 v232, v184, v185
v_or_b32 v233, v186, v187
v_or_b32_e64 v234, v188, v189
v_rcp_f16_sdwa v196, v195 dst_sel:WORD_1 dst_unused:UNUSED_PRESERVE src0_sel:WORD_1
v_or_b32 v235, v190, v191
s_waitcnt lgkmcnt(2)
v_or_b32_e64 v236, v192, v193
v_pk_mul_f16 v237, v203, v202
v_pk_mul_f16 v238, v200, v199
v_pk_mul_f16 v239, v197, v196
v_mfma_f32_16x16x32_f16 v[48:51], v[224:227], v[232:235], v[48:51]
s_add_u32 s46, s69, 98304
buffer_load_dwordx4 v[216:219], v252, s[4:7], s46 offen offset:128
ds_read_b128 v[44:47], v250 offset:3328
v_cvt_pkrtz_f16_f32 v185, v168, v169
v_cvt_pkrtz_f16_f32 v187, v170, v171
v_mfma_f32_16x16x32_f16 v[56:59], v[224:227], v[236:239], v[56:59]
v_cvt_pkrtz_f16_f32 v189, v172, v173
v_cvt_pkrtz_f16_f32 v191, v174, v175
v_cvt_pkrtz_f16_f32 v193, v176, v177
v_mfma_f32_16x16x32_f16 v[52:55], v[228:231], v[232:235], v[52:55]
ds_read_b128 v[224:227], v249 offset:7168
v_cvt_pkrtz_f16_f32 v195, v178, v179
v_cvt_pk_f16_f32 v203, v180, v181
v_cvt_pk_f16_f32 v200, v182, v183
v_mfma_f32_16x16x32_f16 v[60:63], v[228:231], v[236:239], v[60:63]
v_pk_fma_f16 v202, v203, v203, s48
v_cvt_pk_bf16_f32 v144, v144, v145
v_and_b32_e64 v185, s49, v185
v_mfma_f32_16x16x32_bf16 v[168:171], v[240:243], v[96:99], 0
ds_read_b128 v[228:231], v250 offset:4096
v_cvt_pk_bf16_f32 v145, v146, v147
v_and_b32 v187, s49, v187
v_mfma_f32_16x16x32_bf16 v[176:179], v[240:243], v[100:103], 0
v_cvt_pk_bf16_f32 v146, v148, v149
v_pk_fma_f16 v199, v200, v200, s48
v_bfe_u32 v184, v185, 2, 14
s_waitcnt lgkmcnt(3)
v_mfma_f32_16x16x32_f16 v[64:67], v[244:247], v[232:235], v[64:67]
ds_read_b128 v[240:243], v250 offset:4352
ds_read_u16_d16 v184, v184
v_cvt_pk_bf16_f32 v147, v150, v151
v_pk_mul_f16 v202, v203, v202
v_cvt_pk_bf16_f32 v128, v128, v129
v_mfma_f32_16x16x32_f16 v[72:75], v[244:247], v[236:239], v[72:75]
v_bfe_u32 v186, v187, 2, 14
v_cvt_pk_bf16_f32 v129, v130, v131
v_pk_mul_f16 v199, v200, v199
s_waitcnt vmcnt(6)
v_mfma_f32_16x16x32_bf16 v[64:67], v[18:21], v[204:207], v[64:67]
ds_read_b128 v[244:247], v249 offset:7424
ds_read_u16_d16 v186, v186
v_lshrrev_b32 v185, 18, v185
v_cvt_pk_bf16_f32 v130, v132, v133
v_mfma_f32_16x16x32_bf16 v[68:71], v[16:19], v[204:207], v[68:71]
v_exp_f16_e64 v201, v202
v_cvt_pk_bf16_f32 v131, v134, v135
v_mfma_f32_16x16x32_bf16 v[172:175], v[40:43], v[96:99], 0
ds_read_u16_d16_hi v185, v185
v_lshrrev_b32_e64 v187, 18, v187
v_cvt_pk_bf16_f32 v160, v160, v161
v_and_b32_e64 v189, s49, v189
v_mfma_f32_16x16x32_bf16 v[180:183], v[40:43], v[100:103], 0
v_cvt_pk_bf16_f32 v161, v162, v163
v_exp_f16 v198, v199
s_waitcnt lgkmcnt(3)
v_mfma_f32_16x16x32_f16 v[68:71], v[44:47], v[232:235], v[68:71]
ds_read_b128 v[40:43], v249 offset:8192
ds_read_u16_d16_hi v187, v187
v_cvt_pk_bf16_f32 v162, v164, v165
v_and_b32_e64 v191, s49, v191
v_mfma_f32_16x16x32_f16 v[76:79], v[44:47], v[236:239], v[76:79]
v_cvt_pk_bf16_f32 v163, v166, v167
s_mov_b64 vcc, s[74:75]
v_bfe_u32 v188, v189, 2, 14
v_cndmask_b32 v148, v128, v160, vcc
v_mfma_f32_16x16x32_bf16 v[168:171], v[224:227], v[104:107], v[168:171]
ds_read_b128 v[44:47], v249 offset:8448
ds_read_u16_d16 v188, v188
v_exp_f16_sdwa v201, v202 dst_sel:WORD_1 dst_unused:UNUSED_PRESERVE src0_sel:WORD_1
v_cndmask_b32 v149, v129, v161, vcc
v_mfma_f32_16x16x32_bf16 v[176:179], v[224:227], v[108:111], v[176:179]
v_bfe_u32 v190, v191, 2, 14
v_cndmask_b32 v150, v130, v162, vcc
v_lshrrev_b32_e64 v189, 18, v189
v_mfma_f32_16x16x32_f16 v[80:83], v[228:231], v[232:235], v[80:83]
ds_read_b128 v[224:227], v250 offset:8192
ds_read_u16_d16 v190, v190
ds_read_u16_d16_hi v189, v189
v_cndmask_b32 v151, v131, v163, vcc
v_lshrrev_b32 v191, 18, v191
v_mfma_f32_16x16x32_f16 v[88:91], v[228:231], v[236:239], v[88:91]
v_exp_f16_sdwa v198, v199 dst_sel:WORD_1 dst_unused:UNUSED_PRESERVE src0_sel:WORD_1
v_cndmask_b32_dpp v128, v144, v128, vcc quad_perm:[1,0,3,2] row_mask:0xf bank_mask:0xf
v_mfma_f32_16x16x32_f16 v[84:87], v[240:243], v[232:235], v[84:87]
ds_read_b128 v[228:231], v250 offset:8448
ds_read_u16_d16_hi v191, v191
v_cndmask_b32_dpp v129, v145, v129, vcc quad_perm:[1,0,3,2] row_mask:0xf bank_mask:0xf
v_and_b32_e64 v193, s49, v193
v_cndmask_b32_dpp v130, v146, v130, vcc quad_perm:[1,0,3,2] row_mask:0xf bank_mask:0xf
v_mfma_f32_16x16x32_f16 v[92:95], v[240:243], v[236:239], v[92:95]
v_and_b32_e64 v195, s49, v195
v_pk_add_f16 v201, v201, 1.0 op_sel_hi:[1,0]
v_cndmask_b32_dpp v131, v147, v131, vcc quad_perm:[1,0,3,2] row_mask:0xf bank_mask:0xf
s_not_b64 vcc, s[74:75]
s_waitcnt lgkmcnt(5)
v_mfma_f32_16x16x32_bf16 v[172:175], v[244:247], v[104:107], v[172:175]
ds_read_b128 v[240:243], v249 offset:12288
v_bfe_u32 v192, v193, 2, 14
v_cndmask_b32_dpp v160, v144, v160, vcc quad_perm:[1,0,3,2] row_mask:0xf bank_mask:0xf
v_pk_add_f16 v198, v198, 1.0 op_sel_hi:[1,0]
v_mfma_f32_16x16x32_bf16 v[180:183], v[244:247], v[108:111], v[180:183]
v_cndmask_b32_dpp v161, v145, v161, vcc quad_perm:[1,0,3,2] row_mask:0xf bank_mask:0xf
v_bfe_u32 v194, v195, 2, 14
v_mfma_f32_16x16x32_bf16 v[168:171], v[40:43], v[112:115], v[168:171]
ds_read_b128 v[244:247], v250 offset:9216
ds_read_u16_d16 v192, v192
ds_read_u16_d16 v194, v194
v_rcp_f16_e64 v202, v201
v_cndmask_b32_dpp v162, v146, v162, vcc quad_perm:[1,0,3,2] row_mask:0xf bank_mask:0xf
v_mfma_f32_16x16x32_bf16 v[176:179], v[40:43], v[116:119], v[176:179]
v_cndmask_b32_dpp v163, v147, v163, vcc quad_perm:[1,0,3,2] row_mask:0xf bank_mask:0xf
v_lshrrev_b32 v193, 18, v193
v_lshrrev_b32 v195, 18, v195
v_mfma_f32_16x16x32_bf16 v[172:175], v[44:47], v[112:115], v[172:175]
ds_read_b128 v[40:43], v249 offset:12544
s_add_u32 s46, s68, 98304
buffer_store_dwordx4 v[128:131], v255, s[8:11], s46 offen sc1
ds_read_u16_d16_hi v193, v193
ds_read_u16_d16_hi v195, v195
v_rcp_f16_e64 v199, v198
v_mfma_f32_16x16x32_bf16 v[180:183], v[44:47], v[116:119], v[180:183]
v_rcp_f16_sdwa v202, v201 dst_sel:WORD_1 dst_unused:UNUSED_PRESERVE src0_sel:WORD_1
v_or_b32 v232, v184, v185
v_or_b32 v233, v186, v187
s_waitcnt lgkmcnt(6)
v_or_b32 v234, v188, v189
v_rcp_f16_sdwa v199, v198 dst_sel:WORD_1 dst_unused:UNUSED_PRESERVE src0_sel:WORD_1
v_or_b32 v235, v190, v191
s_waitcnt lgkmcnt(1)
v_or_b32 v236, v192, v193
s_waitcnt lgkmcnt(0)
v_or_b32_e64 v237, v194, v195
v_pk_mul_f16 v238, v203, v202
v_pk_mul_f16 v239, v200, v199
v_mfma_f32_16x16x32_f16 v[48:51], v[224:227], v[232:235], v[48:51]
s_add_u32 s46, s68, 98304
buffer_store_dwordx4 v[148:151], v255, s[8:11], s46 offen offset:128 sc1
ds_read_b128 v[44:47], v250 offset:9472
v_cvt_pkrtz_f16_f32 v185, v168, v169
v_cvt_pkrtz_f16_f32 v187, v170, v171
v_mfma_f32_16x16x32_f16 v[56:59], v[224:227], v[236:239], v[56:59]
v_cvt_pkrtz_f16_f32 v189, v172, v173
v_cvt_pkrtz_f16_f32 v191, v174, v175
v_mfma_f32_16x16x32_f16 v[52:55], v[228:231], v[232:235], v[52:55]
ds_read_b128 v[224:227], v249 offset:13312
v_cvt_pkrtz_f16_f32 v193, v176, v177
v_cvt_pk_f16_f32 v203, v178, v179
v_mfma_f32_16x16x32_f16 v[60:63], v[228:231], v[236:239], v[60:63]
v_cvt_pk_f16_f32 v200, v180, v181
v_cvt_pk_f16_f32 v197, v182, v183
v_mfma_f32_16x16x32_bf16 v[168:171], v[240:243], v[96:99], 0
ds_read_b128 v[228:231], v250 offset:10240
v_pk_fma_f16 v202, v203, v203, s48
v_and_b32_e64 v185, s49, v185
v_mfma_f32_16x16x32_bf16 v[176:179], v[240:243], v[100:103], 0
v_pk_fma_f16 v199, v200, v200, s48
v_and_b32_e64 v187, s49, v187
v_mfma_f32_16x16x32_f16 v[64:67], v[244:247], v[232:235], v[64:67]
ds_read_b128 v[240:243], v250 offset:10496
v_pk_fma_f16 v196, v197, v197, s48
v_bfe_u32 v184, v185, 2, 14
v_pk_mul_f16 v202, v203, v202
v_mfma_f32_16x16x32_f16 v[72:75], v[244:247], v[236:239], v[72:75]
v_bfe_u32 v186, v187, 2, 14
v_pk_mul_f16 v199, v200, v199
s_waitcnt vmcnt(6)
v_mfma_f32_16x16x32_bf16 v[80:83], v[18:21], v[8:11], v[80:83]
ds_read_b128 v[244:247], v249 offset:13568
ds_read_u16_d16 v184, v184
ds_read_u16_d16 v186, v186
v_lshrrev_b32 v185, 18, v185
v_pk_mul_f16 v196, v197, v196
v_mfma_f32_16x16x32_bf16 v[84:87], v[16:19], v[8:11], v[84:87]
v_lshrrev_b32_e64 v187, 18, v187
v_mfma_f32_16x16x32_bf16 v[172:175], v[40:43], v[96:99], 0
ds_read_u16_d16_hi v185, v185
ds_read_u16_d16_hi v187, v187
v_exp_f16 v201, v202
v_and_b32 v189, s49, v189
v_mfma_f32_16x16x32_bf16 v[180:183], v[40:43], v[100:103], 0
v_and_b32 v191, s49, v191
s_waitcnt lgkmcnt(6)
v_mfma_f32_16x16x32_f16 v[68:71], v[44:47], v[232:235], v[68:71]
ds_read_b128 v[40:43], v249 offset:14336
v_exp_f16_e64 v198, v199
v_bfe_u32 v188, v189, 2, 14
v_mfma_f32_16x16x32_f16 v[76:79], v[44:47], v[236:239], v[76:79]
v_bfe_u32 v190, v191, 2, 14
v_exp_f16_e64 v195, v196
v_mfma_f32_16x16x32_bf16 v[168:171], v[224:227], v[104:107], v[168:171]
ds_read_b128 v[44:47], v249 offset:14592
ds_read_u16_d16 v188, v188
ds_read_u16_d16 v190, v190
v_lshrrev_b32 v189, 18, v189
v_lshrrev_b32 v191, 18, v191
v_mfma_f32_16x16x32_bf16 v[176:179], v[224:227], v[108:111], v[176:179]
v_exp_f16_sdwa v201, v202 dst_sel:WORD_1 dst_unused:UNUSED_PRESERVE src0_sel:WORD_1
v_mfma_f32_16x16x32_f16 v[80:83], v[228:231], v[232:235], v[80:83]
ds_read_b128 v[224:227], v250 offset:14336
ds_read_u16_d16_hi v189, v189
ds_read_u16_d16_hi v191, v191
v_and_b32 v193, s49, v193
v_bfe_u32 v192, v193, 2, 14
v_mfma_f32_16x16x32_f16 v[88:91], v[228:231], v[236:239], v[88:91]
v_exp_f16_sdwa v198, v199 dst_sel:WORD_1 dst_unused:UNUSED_PRESERVE src0_sel:WORD_1
s_waitcnt lgkmcnt(7)
v_mfma_f32_16x16x32_f16 v[84:87], v[240:243], v[232:235], v[84:87]
ds_read_b128 v[228:231], v250 offset:14592
ds_read_u16_d16 v192, v192
v_lshrrev_b32_e64 v193, 18, v193
v_mfma_f32_16x16x32_f16 v[92:95], v[240:243], v[236:239], v[92:95]
v_exp_f16_sdwa v195, v196 dst_sel:WORD_1 dst_unused:UNUSED_PRESERVE src0_sel:WORD_1
v_pk_add_f16 v201, v201, 1.0 op_sel_hi:[1,0]
v_pk_add_f16 v198, v198, 1.0 op_sel_hi:[1,0]
v_mfma_f32_16x16x32_bf16 v[172:175], v[244:247], v[104:107], v[172:175]
ds_read_b128 v[240:243], v249 offset:18432
ds_read_u16_d16_hi v193, v193
v_pk_add_f16 v195, v195, 1.0 op_sel_hi:[1,0]
v_mfma_f32_16x16x32_bf16 v[180:183], v[244:247], v[108:111], v[180:183]
v_rcp_f16 v202, v201
s_waitcnt lgkmcnt(7)
v_mfma_f32_16x16x32_bf16 v[168:171], v[40:43], v[112:115], v[168:171]
ds_read_b128 v[244:247], v250 offset:15360
v_rcp_f16_e64 v199, v198
v_mfma_f32_16x16x32_bf16 v[176:179], v[40:43], v[116:119], v[176:179]
v_rcp_f16_e64 v196, v195
v_mfma_f32_16x16x32_bf16 v[172:175], v[44:47], v[112:115], v[172:175]
ds_read_b128 v[40:43], v249 offset:18688
v_rcp_f16_sdwa v202, v201 dst_sel:WORD_1 dst_unused:UNUSED_PRESERVE src0_sel:WORD_1
v_mfma_f32_16x16x32_bf16 v[180:183], v[44:47], v[116:119], v[180:183]
v_rcp_f16_sdwa v199, v198 dst_sel:WORD_1 dst_unused:UNUSED_PRESERVE src0_sel:WORD_1
v_or_b32 v232, v184, v185
v_or_b32 v233, v186, v187
s_waitcnt lgkmcnt(4)
v_or_b32 v234, v188, v189
v_rcp_f16_sdwa v196, v195 dst_sel:WORD_1 dst_unused:UNUSED_PRESERVE src0_sel:WORD_1
v_or_b32 v235, v190, v191
s_waitcnt lgkmcnt(2)
v_or_b32_e64 v236, v192, v193
v_pk_mul_f16 v237, v203, v202
v_pk_mul_f16 v238, v200, v199
v_pk_mul_f16 v239, v197, v196
v_mfma_f32_16x16x32_f16 v[48:51], v[224:227], v[232:235], v[48:51]
ds_read_b128 v[44:47], v250 offset:15616
v_cvt_pkrtz_f16_f32 v185, v168, v169
v_cvt_pkrtz_f16_f32 v187, v170, v171
v_mfma_f32_16x16x32_f16 v[56:59], v[224:227], v[236:239], v[56:59]
v_cvt_pkrtz_f16_f32 v189, v172, v173
v_cvt_pkrtz_f16_f32 v191, v174, v175
v_mfma_f32_16x16x32_f16 v[52:55], v[228:231], v[232:235], v[52:55]
ds_read_b128 v[224:227], v249 offset:19456
v_cvt_pkrtz_f16_f32 v193, v176, v177
v_cvt_pk_f16_f32 v203, v178, v179
v_mfma_f32_16x16x32_f16 v[60:63], v[228:231], v[236:239], v[60:63]
v_cvt_pk_f16_f32 v200, v180, v181
v_cvt_pk_f16_f32 v197, v182, v183
v_mfma_f32_16x16x32_bf16 v[168:171], v[240:243], v[96:99], 0
ds_read_b128 v[228:231], v250 offset:16384
v_pk_fma_f16 v202, v203, v203, s48
v_and_b32_e64 v185, s49, v185
v_mfma_f32_16x16x32_bf16 v[176:179], v[240:243], v[100:103], 0
v_pk_fma_f16 v199, v200, v200, s48
v_and_b32 v187, s49, v187
s_waitcnt lgkmcnt(3)
v_mfma_f32_16x16x32_f16 v[64:67], v[244:247], v[232:235], v[64:67]
ds_read_b128 v[240:243], v250 offset:16640
v_pk_fma_f16 v196, v197, v197, s48
v_bfe_u32 v184, v185, 2, 14
v_pk_mul_f16 v202, v203, v202
v_mfma_f32_16x16x32_f16 v[72:75], v[244:247], v[236:239], v[72:75]
v_bfe_u32 v186, v187, 2, 14
v_pk_mul_f16 v199, v200, v199
s_waitcnt vmcnt(5)
v_mfma_f32_16x16x32_bf16 v[56:59], v[18:21], v[36:39], v[56:59]
ds_read_b128 v[244:247], v249 offset:19712
ds_read_u16_d16 v184, v184
ds_read_u16_d16 v186, v186
v_lshrrev_b32 v185, 18, v185
v_pk_mul_f16 v196, v197, v196
v_mfma_f32_16x16x32_bf16 v[60:63], v[16:19], v[36:39], v[60:63]
v_lshrrev_b32_e64 v187, 18, v187
v_mfma_f32_16x16x32_bf16 v[172:175], v[40:43], v[96:99], 0
ds_read_u16_d16_hi v185, v185
ds_read_u16_d16_hi v187, v187
v_exp_f16 v201, v202
v_and_b32 v189, s49, v189
v_mfma_f32_16x16x32_bf16 v[180:183], v[40:43], v[100:103], 0
v_and_b32 v191, s49, v191
s_waitcnt lgkmcnt(6)
v_mfma_f32_16x16x32_f16 v[68:71], v[44:47], v[232:235], v[68:71]
ds_read_b128 v[40:43], v249 offset:20480
v_exp_f16_e64 v198, v199
v_bfe_u32 v188, v189, 2, 14
v_mfma_f32_16x16x32_f16 v[76:79], v[44:47], v[236:239], v[76:79]
v_bfe_u32 v190, v191, 2, 14
v_exp_f16_e64 v195, v196
v_mfma_f32_16x16x32_bf16 v[168:171], v[224:227], v[104:107], v[168:171]
ds_read_b128 v[44:47], v249 offset:20736
ds_read_u16_d16 v188, v188
ds_read_u16_d16 v190, v190
v_lshrrev_b32 v189, 18, v189
v_lshrrev_b32 v191, 18, v191
v_mfma_f32_16x16x32_bf16 v[176:179], v[224:227], v[108:111], v[176:179]
v_exp_f16_sdwa v201, v202 dst_sel:WORD_1 dst_unused:UNUSED_PRESERVE src0_sel:WORD_1
v_mfma_f32_16x16x32_f16 v[80:83], v[228:231], v[232:235], v[80:83]
ds_read_b128 v[224:227], v250 offset:20480
ds_read_u16_d16_hi v189, v189
ds_read_u16_d16_hi v191, v191
v_and_b32 v193, s49, v193
v_bfe_u32 v192, v193, 2, 14
v_mfma_f32_16x16x32_f16 v[88:91], v[228:231], v[236:239], v[88:91]
v_exp_f16_sdwa v198, v199 dst_sel:WORD_1 dst_unused:UNUSED_PRESERVE src0_sel:WORD_1
s_waitcnt lgkmcnt(7)
v_mfma_f32_16x16x32_f16 v[84:87], v[240:243], v[232:235], v[84:87]
ds_read_b128 v[228:231], v250 offset:20736
ds_read_u16_d16 v192, v192
v_lshrrev_b32_e64 v193, 18, v193
v_mfma_f32_16x16x32_f16 v[92:95], v[240:243], v[236:239], v[92:95]
v_exp_f16_sdwa v195, v196 dst_sel:WORD_1 dst_unused:UNUSED_PRESERVE src0_sel:WORD_1
v_pk_add_f16 v201, v201, 1.0 op_sel_hi:[1,0]
v_pk_add_f16 v198, v198, 1.0 op_sel_hi:[1,0]
v_mfma_f32_16x16x32_bf16 v[172:175], v[244:247], v[104:107], v[172:175]
ds_read_b128 v[240:243], v250 offset:21504
ds_read_u16_d16_hi v193, v193
v_pk_add_f16 v195, v195, 1.0 op_sel_hi:[1,0]
v_mfma_f32_16x16x32_bf16 v[180:183], v[244:247], v[108:111], v[180:183]
v_rcp_f16 v202, v201
s_waitcnt lgkmcnt(7)
v_mfma_f32_16x16x32_bf16 v[168:171], v[40:43], v[112:115], v[168:171]
ds_read_b128 v[244:247], v250 offset:21760
v_rcp_f16_e64 v199, v198
v_mfma_f32_16x16x32_bf16 v[176:179], v[40:43], v[116:119], v[176:179]
v_rcp_f16_e64 v196, v195
v_mfma_f32_16x16x32_bf16 v[172:175], v[44:47], v[112:115], v[172:175]
ds_read_b128 v[40:43], v250 offset:22528
v_rcp_f16_sdwa v202, v201 dst_sel:WORD_1 dst_unused:UNUSED_PRESERVE src0_sel:WORD_1
v_mfma_f32_16x16x32_bf16 v[180:183], v[44:47], v[116:119], v[180:183]
v_rcp_f16_sdwa v199, v198 dst_sel:WORD_1 dst_unused:UNUSED_PRESERVE src0_sel:WORD_1
v_or_b32 v232, v184, v185
v_or_b32 v233, v186, v187
s_waitcnt lgkmcnt(4)
v_or_b32 v234, v188, v189
v_rcp_f16_sdwa v196, v195 dst_sel:WORD_1 dst_unused:UNUSED_PRESERVE src0_sel:WORD_1
v_or_b32 v235, v190, v191
s_waitcnt lgkmcnt(2)
v_or_b32_e64 v236, v192, v193
v_pk_mul_f16 v237, v203, v202
v_pk_mul_f16 v238, v200, v199
v_pk_mul_f16 v239, v197, v196
v_mfma_f32_16x16x32_f16 v[48:51], v[224:227], v[232:235], v[48:51]
s_add_u32 s46, s68, 98304
buffer_store_dwordx4 v[160:163], v255, s[8:11], s46 offen offset:256 sc1
ds_read_b128 v[44:47], v250 offset:22784
v_cvt_pkrtz_f16_f32 v185, v168, v169
v_cvt_pkrtz_f16_f32 v187, v170, v171
v_cvt_pkrtz_f16_f32 v189, v172, v173
v_cvt_pkrtz_f16_f32 v191, v174, v175
v_mfma_f32_16x16x32_f16 v[56:59], v[224:227], v[236:239], v[56:59]
v_cvt_pkrtz_f16_f32 v193, v176, v177
v_cvt_pk_f16_f32 v203, v178, v179
v_cvt_pk_f16_f32 v200, v180, v181
v_cvt_pk_f16_f32 v197, v182, v183
v_mfma_f32_16x16x32_f16 v[52:55], v[228:231], v[232:235], v[52:55]
ds_read_b128 v[224:227], v250 offset:26624
v_pk_fma_f16 v202, v203, v203, s48
v_and_b32_e64 v185, s49, v185
v_pk_fma_f16 v199, v200, v200, s48
v_and_b32_e64 v187, s49, v187
v_mfma_f32_16x16x32_f16 v[60:63], v[228:231], v[236:239], v[60:63]
v_pk_fma_f16 v196, v197, v197, s48
v_bfe_u32 v184, v185, 2, 14
v_pk_mul_f16 v202, v203, v202
v_bfe_u32 v186, v187, 2, 14
v_mfma_f32_16x16x32_f16 v[64:67], v[240:243], v[232:235], v[64:67]
ds_read_b128 v[228:231], v250 offset:26880
ds_read_u16_d16 v184, v184
ds_read_u16_d16 v186, v186
v_pk_mul_f16 v199, v200, v199
v_lshrrev_b32_e64 v185, 18, v185
v_pk_mul_f16 v196, v197, v196
v_lshrrev_b32_e64 v187, 18, v187
v_mfma_f32_16x16x32_f16 v[72:75], v[240:243], v[236:239], v[72:75]
v_exp_f16 v201, v202
v_and_b32 v189, s49, v189
v_and_b32 v191, s49, v191
s_waitcnt vmcnt(4)
v_mfma_f32_16x16x32_bf16 v[72:75], v[18:21], v[32:35], v[72:75]
ds_read_b128 v[240:243], v250 offset:27648
ds_read_u16_d16_hi v185, v185
ds_read_u16_d16_hi v187, v187
v_exp_f16_e64 v198, v199
v_bfe_u32 v188, v189, 2, 14
v_bfe_u32 v190, v191, 2, 14
v_mfma_f32_16x16x32_bf16 v[76:79], v[16:19], v[32:35], v[76:79]
v_exp_f16 v195, v196
v_lshrrev_b32 v189, 18, v189
v_lshrrev_b32 v191, 18, v191
s_waitcnt lgkmcnt(6)
v_mfma_f32_16x16x32_f16 v[68:71], v[244:247], v[232:235], v[68:71]
ds_read_u16_d16 v188, v188
ds_read_u16_d16 v190, v190
ds_read_u16_d16_hi v189, v189
ds_read_u16_d16_hi v191, v191
v_exp_f16_sdwa v201, v202 dst_sel:WORD_1 dst_unused:UNUSED_PRESERVE src0_sel:WORD_1
v_and_b32_e64 v193, s49, v193
v_bfe_u32 v192, v193, 2, 14
v_mfma_f32_16x16x32_f16 v[76:79], v[244:247], v[236:239], v[76:79]
v_exp_f16_sdwa v198, v199 dst_sel:WORD_1 dst_unused:UNUSED_PRESERVE src0_sel:WORD_1
v_lshrrev_b32_e64 v193, 18, v193
v_mfma_f32_16x16x32_f16 v[80:83], v[40:43], v[232:235], v[80:83]
ds_read_b128 v[244:247], v250 offset:27904
ds_read_u16_d16 v192, v192
ds_read_u16_d16_hi v193, v193
v_exp_f16_sdwa v195, v196 dst_sel:WORD_1 dst_unused:UNUSED_PRESERVE src0_sel:WORD_1
v_pk_add_f16 v201, v201, 1.0 op_sel_hi:[1,0]
v_pk_add_f16 v198, v198, 1.0 op_sel_hi:[1,0]
v_pk_add_f16 v195, v195, 1.0 op_sel_hi:[1,0]
v_mfma_f32_16x16x32_f16 v[88:91], v[40:43], v[236:239], v[88:91]
v_rcp_f16 v202, v201
v_rcp_f16 v199, v198
v_mfma_f32_16x16x32_f16 v[84:87], v[44:47], v[232:235], v[84:87]
ds_read_b128 v[40:43], v250 offset:28672
v_rcp_f16_e64 v196, v195
v_rcp_f16_sdwa v202, v201 dst_sel:WORD_1 dst_unused:UNUSED_PRESERVE src0_sel:WORD_1
v_mfma_f32_16x16x32_f16 v[92:95], v[44:47], v[236:239], v[92:95]
v_rcp_f16_sdwa v199, v198 dst_sel:WORD_1 dst_unused:UNUSED_PRESERVE src0_sel:WORD_1
s_waitcnt lgkmcnt(5)
v_or_b32 v232, v184, v185
v_or_b32_e64 v233, v186, v187
v_or_b32 v234, v188, v189
v_rcp_f16_sdwa v196, v195 dst_sel:WORD_1 dst_unused:UNUSED_PRESERVE src0_sel:WORD_1
s_waitcnt lgkmcnt(4)
v_or_b32 v235, v190, v191
s_waitcnt lgkmcnt(1)
v_or_b32 v236, v192, v193
v_pk_mul_f16 v237, v203, v202
v_pk_mul_f16 v238, v200, v199
v_pk_mul_f16 v239, v197, v196
s_waitcnt vmcnt(3)
v_mfma_f32_16x16x32_bf16 v[88:91], v[18:21], v[216:219], v[88:91]
ds_read_b128 v[44:47], v250 offset:28928
v_mfma_f32_16x16x32_bf16 v[92:95], v[16:19], v[216:219], v[92:95]
v_mfma_f32_16x16x32_f16 v[48:51], v[224:227], v[232:235], v[48:51]
s_waitcnt lgkmcnt(0)
v_mfma_f32_16x16x32_f16 v[52:55], v[228:231], v[232:235], v[52:55]
v_mfma_f32_16x16x32_f16 v[64:67], v[240:243], v[232:235], v[64:67]
v_mfma_f32_16x16x32_f16 v[68:71], v[244:247], v[232:235], v[68:71]
v_mfma_f32_16x16x32_f16 v[80:83], v[40:43], v[232:235], v[80:83]
v_mfma_f32_16x16x32_f16 v[84:87], v[44:47], v[232:235], v[84:87]
s_nop 4
v_cvt_pk_bf16_f32 v64, v64, v65
v_cvt_pk_bf16_f32 v65, v66, v67
v_cvt_pk_bf16_f32 v66, v68, v69
v_cvt_pk_bf16_f32 v67, v70, v71
v_cvt_pk_bf16_f32 v48, v48, v49
v_cvt_pk_bf16_f32 v49, v50, v51
v_cvt_pk_bf16_f32 v50, v52, v53
v_cvt_pk_bf16_f32 v51, v54, v55
v_cvt_pk_bf16_f32 v80, v80, v81
v_cvt_pk_bf16_f32 v81, v82, v83
v_cvt_pk_bf16_f32 v82, v84, v85
v_cvt_pk_bf16_f32 v83, v86, v87
s_mov_b64 vcc, s[74:75]
v_cndmask_b32 v68, v48, v80, vcc
v_mfma_f32_16x16x32_f16 v[56:59], v[224:227], v[236:239], v[56:59]
v_cndmask_b32 v69, v49, v81, vcc
v_cndmask_b32 v70, v50, v82, vcc
v_mfma_f32_16x16x32_f16 v[60:63], v[228:231], v[236:239], v[60:63]
v_cndmask_b32 v71, v51, v83, vcc
v_cndmask_b32_dpp v48, v64, v48, vcc quad_perm:[1,0,3,2] row_mask:0xf bank_mask:0xf
v_mfma_f32_16x16x32_f16 v[72:75], v[240:243], v[236:239], v[72:75]
v_cndmask_b32_dpp v49, v65, v49, vcc quad_perm:[1,0,3,2] row_mask:0xf bank_mask:0xf
v_mfma_f32_16x16x32_f16 v[76:79], v[244:247], v[236:239], v[76:79]
v_cndmask_b32_dpp v50, v66, v50, vcc quad_perm:[1,0,3,2] row_mask:0xf bank_mask:0xf
v_cndmask_b32_dpp v51, v67, v51, vcc quad_perm:[1,0,3,2] row_mask:0xf bank_mask:0xf
s_not_b64 vcc, s[74:75]
v_mfma_f32_16x16x32_f16 v[88:91], v[40:43], v[236:239], v[88:91]
v_cndmask_b32_dpp v80, v64, v80, vcc quad_perm:[1,0,3,2] row_mask:0xf bank_mask:0xf
v_cndmask_b32_dpp v81, v65, v81, vcc quad_perm:[1,0,3,2] row_mask:0xf bank_mask:0xf
v_mfma_f32_16x16x32_f16 v[92:95], v[44:47], v[236:239], v[92:95]
v_cndmask_b32_dpp v82, v66, v82, vcc quad_perm:[1,0,3,2] row_mask:0xf bank_mask:0xf
v_cndmask_b32_dpp v83, v67, v83, vcc quad_perm:[1,0,3,2] row_mask:0xf bank_mask:0xf
buffer_store_dwordx4 v[48:51], v255, s[8:11], s69 offen sc1
buffer_store_dwordx4 v[68:71], v255, s[8:11], s69 offen offset:128 sc1
buffer_store_dwordx4 v[80:83], v255, s[8:11], s69 offen offset:256 sc1
v_cvt_pk_bf16_f32 v72, v72, v73
v_cvt_pk_bf16_f32 v73, v74, v75
v_cvt_pk_bf16_f32 v74, v76, v77
v_cvt_pk_bf16_f32 v75, v78, v79
v_cvt_pk_bf16_f32 v56, v56, v57
v_cvt_pk_bf16_f32 v57, v58, v59
v_cvt_pk_bf16_f32 v58, v60, v61
v_cvt_pk_bf16_f32 v59, v62, v63
v_cvt_pk_bf16_f32 v88, v88, v89
v_cvt_pk_bf16_f32 v89, v90, v91
v_cvt_pk_bf16_f32 v90, v92, v93
v_cvt_pk_bf16_f32 v91, v94, v95
s_mov_b64 vcc, s[74:75]
v_cndmask_b32 v76, v56, v88, vcc
v_cndmask_b32 v77, v57, v89, vcc
v_cndmask_b32 v78, v58, v90, vcc
v_cndmask_b32 v79, v59, v91, vcc
v_cndmask_b32_dpp v56, v72, v56, vcc quad_perm:[1,0,3,2] row_mask:0xf bank_mask:0xf
v_cndmask_b32_dpp v57, v73, v57, vcc quad_perm:[1,0,3,2] row_mask:0xf bank_mask:0xf
v_cndmask_b32_dpp v58, v74, v58, vcc quad_perm:[1,0,3,2] row_mask:0xf bank_mask:0xf
v_cndmask_b32_dpp v59, v75, v59, vcc quad_perm:[1,0,3,2] row_mask:0xf bank_mask:0xf
s_not_b64 vcc, s[74:75]
v_cndmask_b32_dpp v88, v72, v88, vcc quad_perm:[1,0,3,2] row_mask:0xf bank_mask:0xf
v_cndmask_b32_dpp v89, v73, v89, vcc quad_perm:[1,0,3,2] row_mask:0xf bank_mask:0xf
v_cndmask_b32_dpp v90, v74, v90, vcc quad_perm:[1,0,3,2] row_mask:0xf bank_mask:0xf
v_cndmask_b32_dpp v91, v75, v91, vcc quad_perm:[1,0,3,2] row_mask:0xf bank_mask:0xf
s_add_u32 s46, s69, 98304
buffer_store_dwordx4 v[56:59], v255, s[8:11], s46 offen sc1
s_add_u32 s46, s69, 98304
buffer_store_dwordx4 v[76:79], v255, s[8:11], s46 offen offset:128 sc1
s_add_u32 s46, s69, 98304
buffer_store_dwordx4 v[88:91], v255, s[8:11], s46 offen offset:256 sc1
s_endpgm
Lpoll:
s_waitcnt vmcnt(0)
Lpoll1:
s_cmp_eq_u32 s77, 2
s_cbranch_scc1 LpollC
v_max_u32 v255, v156, v157
v_max3_u32 v255, v255, v158, v159
v_max3_u32 v255, v255, v160, v161
v_max3_u32 v255, v255, v162, v163
v_max3_u32 v255, v255, v164, v165
v_max3_u32 v255, v255, v166, v167
v_max3_u32 v255, v255, v240, v241
v_max3_u32 v255, v255, v242, v243
v_cmp_eq_u32 vcc, -1, v255
s_nop 4
s_cbranch_vccz LpollR
v_lshlrev_b32 v247, 4, v251
s_lshl_b32 s44, s2, 12
buffer_load_dwordx4 v[156:159], v247, s[32:35], s44 offen sc1
buffer_load_dwordx4 v[160:163], v247, s[32:35], s44 offen offset:1024 sc1
buffer_load_dwordx4 v[164:167], v247, s[32:35], s44 offen offset:2048 sc1
buffer_load_dwordx4 v[240:243], v247, s[32:35], s44 offen offset:3072 sc1
s_setpc_b64 s[78:79]
LpollR:
s_setprio 3
v_add_f32 v156, v156, v160
v_add_f32 v240, v164, v240
v_add_f32 v240, v156, v240
v_add_f32 v157, v157, v161
v_add_f32 v241, v165, v241
v_add_f32 v241, v157, v241
v_add_f32 v158, v158, v162
v_add_f32 v242, v166, v242
v_add_f32 v242, v158, v242
v_add_f32 v159, v159, v163
v_add_f32 v243, v167, v243
v_add_f32 v243, v159, v243
v_add_f32_dpp v240, v240, v240 row_ror:8 row_mask:0xf bank_mask:0xf
v_add_f32_dpp v241, v241, v241 row_ror:8 row_mask:0xf bank_mask:0xf
v_add_f32_dpp v242, v242, v242 row_ror:8 row_mask:0xf bank_mask:0xf
v_add_f32_dpp v243, v243, v243 row_ror:8 row_mask:0xf bank_mask:0xf
v_add_f32_dpp v240, v240, v240 row_ror:4 row_mask:0xf bank_mask:0xf
v_add_f32_dpp v241, v241, v241 row_ror:4 row_mask:0xf bank_mask:0xf
v_add_f32_dpp v242, v242, v242 row_ror:4 row_mask:0xf bank_mask:0xf
v_add_f32_dpp v243, v243, v243 row_ror:4 row_mask:0xf bank_mask:0xf
v_add_f32_dpp v240, v240, v240 row_ror:2 row_mask:0xf bank_mask:0xf
v_add_f32_dpp v241, v241, v241 row_ror:2 row_mask:0xf bank_mask:0xf
v_add_f32_dpp v242, v242, v242 row_ror:2 row_mask:0xf bank_mask:0xf
v_add_f32_dpp v243, v243, v243 row_ror:2 row_mask:0xf bank_mask:0xf
v_add_f32_dpp v240, v240, v240 row_ror:1 row_mask:0xf bank_mask:0xf
v_add_f32_dpp v241, v241, v241 row_ror:1 row_mask:0xf bank_mask:0xf
v_add_f32_dpp v242, v242, v242 row_ror:1 row_mask:0xf bank_mask:0xf
v_add_f32_dpp v243, v243, v243 row_ror:1 row_mask:0xf bank_mask:0xf
v_mov_b32 v156, v240
v_mov_b32 v157, v241
v_mov_b32 v158, v242
v_mov_b32 v159, v243
v_permlane16_swap_b32 v240, v156
v_permlane16_swap_b32 v241, v157
v_permlane16_swap_b32 v242, v158
v_permlane16_swap_b32 v243, v159
v_add_f32 v240, v240, v156
v_add_f32 v241, v241, v157
v_add_f32 v242, v242, v158
v_add_f32 v243, v243, v159
v_mov_b32 v156, v240
v_mov_b32 v157, v241
v_mov_b32 v158, v242
v_mov_b32 v159, v243
v_permlane32_swap_b32 v240, v156
v_permlane32_swap_b32 v241, v157
v_permlane32_swap_b32 v242, v158
v_permlane32_swap_b32 v243, v159
v_add_f32 v240, v240, v156
v_add_f32 v241, v241, v157
v_add_f32 v242, v242, v158
v_add_f32 v243, v243, v159
v_min_u32 v240, -2, v240
v_min_u32 v241, -2, v241
v_min_u32_e64 v242, -2, v242
v_min_u32 v243, -2, v243
s_lshl_b32 s44, s2, 4
s_add_u32 s44, s44, 393216
v_lshlrev_b32_e64 v255, 11, v251
s_mov_b64 exec, 0xff
buffer_store_dwordx4 v[240:243], v255, s[32:35], s44 offen sc1
s_mov_b64 exec, -1
s_cmp_eq_u32 s40, 0
s_cselect_b32 s77, 2, 0
s_cbranch_scc0 LpollRx
v_lshlrev_b32_e64 v247, 3, v251
s_and_b32 s44, s2, 7
s_lshl_b32 s44, s44, 11
s_add_u32 s44, s44, 393216
buffer_load_dwordx2 v[156:157], v247, s[32:35], s44 offen sc1
buffer_load_dwordx2 v[158:159], v247, s[32:35], s44 offen offset:512 sc1
buffer_load_dwordx2 v[160:161], v247, s[32:35], s44 offen offset:1024 sc1
LpollRx:
s_setpc_b64 s[78:79]
LpollC:
v_max3_u32 v255, v156, v157, v158
v_max3_u32 v255, v255, v159, v160
v_max_u32 v255, v255, v161
v_cmp_eq_u32 vcc, -1, v255
s_nop 4
s_cbranch_vccz LpollS
v_lshlrev_b32 v247, 3, v251
s_and_b32 s44, s2, 7
s_lshl_b32 s44, s44, 11
s_add_u32 s44, s44, 393216
buffer_load_dwordx2 v[156:157], v247, s[32:35], s44 offen sc1
buffer_load_dwordx2 v[158:159], v247, s[32:35], s44 offen offset:512 sc1
buffer_load_dwordx2 v[160:161], v247, s[32:35], s44 offen offset:1024 sc1
s_setpc_b64 s[78:79]
LpollS:
s_setprio 3
s_mov_b32 s43, 1083296634
v_mov_b32 v162, 897988541
v_fma_f32 v156, v156, s43, v162
v_fma_f32 v157, v157, s43, v162
v_fma_f32 v158, v158, s43, v162
v_fma_f32 v159, v159, s43, v162
v_fma_f32 v160, v160, s43, v162
v_fma_f32 v161, v161, s43, v162
v_sqrt_f32 v156, v156
v_sqrt_f32 v157, v157
v_sqrt_f32 v158, v158
v_sqrt_f32 v159, v159
v_sqrt_f32 v160, v160
v_sqrt_f32 v161, v161
v_add_f32 v163, v156, v157
v_add_f32 v163, v163, v158
v_add_f32 v163, v163, v159
v_add_f32 v163, v163, v160
v_add_f32 v163, v163, v161
s_nop 1
v_add_f32_dpp v163, v163, v163 row_ror:8 row_mask:0xf bank_mask:0xf
s_nop 1
v_add_f32_dpp v163, v163, v163 row_ror:4 row_mask:0xf bank_mask:0xf
s_nop 1
v_add_f32_dpp v163, v163, v163 row_ror:2 row_mask:0xf bank_mask:0xf
s_nop 1
v_add_f32_dpp v163, v163, v163 row_ror:1 row_mask:0xf bank_mask:0xf
v_mov_b32 v255, v163
s_nop 1
v_permlane16_swap_b32 v163, v255
v_add_f32 v163, v163, v255
v_mov_b32 v255, v163
s_nop 1
v_permlane32_swap_b32 v163, v255
v_add_f32_e64 v163, v163, v255
s_mov_b32 s43, 992651947
v_fma_f32 v163, v163, s43, v162
v_rcp_f32_e64 v163, v163
v_mov_b32 v162, 3221789604
v_mul_f32 v163, v163, v162
v_lshlrev_b32 v164, 16, v244
v_and_b32 v165, 4294901760, v244
v_mul_f32 v156, v156, v163
v_mul_f32 v157, v157, v163
v_fma_f32 v164, v164, v156, v162
v_fma_f32 v165, v165, v157, v162
v_cvt_pk_f16_f32 v244, v164, v165
v_lshlrev_b32_e64 v164, 16, v245
v_and_b32 v165, 4294901760, v245
v_mul_f32 v158, v158, v163
v_mul_f32 v159, v159, v163
v_fma_f32 v164, v164, v158, v162
v_fma_f32 v165, v165, v159, v162
v_cvt_pk_f16_f32 v245, v164, v165
v_lshlrev_b32_e64 v164, 16, v246
v_and_b32 v165, 4294901760, v246
v_mul_f32 v160, v160, v163
v_mul_f32 v161, v161, v163
v_fma_f32 v164, v164, v160, v162
v_fma_f32 v165, v165, v161, v162
v_cvt_pk_f16_f32 v246, v164, v165
s_mov_b32 s77, 0
s_setpc_b64 s[78:79]
Lend:
s_endpgm

.section .rodata,"a"
.p2align 6
.amdhsa_kernel standalone__modern_conv_block_convnext_v2__vision_kernel
  .amdhsa_next_free_vgpr 256
  .amdhsa_next_free_sgpr 102
  .amdhsa_accum_offset 256
  .amdhsa_group_segment_fixed_size 0
  .amdhsa_kernarg_size 72
  .amdhsa_user_sgpr_count 2
  .amdhsa_user_sgpr_kernarg_segment_ptr 1
  .amdhsa_system_sgpr_workgroup_id_x 1
.end_amdhsa_kernel
```

```asm
; @launch grid=(256,1,1) block=(512,1,1) lds=163840
.amdgcn_target "amdgcn-amd-amdhsa--gfx950"
.text
.globl standalone__modern_conv_block_convnext_v2__vision_kernel
.p2align 8
.type standalone__modern_conv_block_convnext_v2__vision_kernel,@function
standalone__modern_conv_block_convnext_v2__vision_kernel:
Lmain:
s_cmp_ge_u32 s2, 256
s_cbranch_scc1 Lend
s_load_dwordx16 s[80:95], s[0:1], 0
s_load_dwordx2 s[96:97], s[0:1], 64
s_getpc_b64 s[74:75]
Lpc0:
s_sub_u32 s74, s74, Lpc0-Lmain
s_subb_u32 s75, s75, 0
v_lshlrev_b32 v159, 7, v0
s_movk_i32 s43, 64
v_cmp_gt_u32 vcc, s43, v0
s_and_saveexec_b64 s[78:79], vcc
s_cbranch_execz Lpf0x
global_load_dword v255, v159, s[74:75]
Lpf0x:
s_mov_b64 exec, s[78:79]
v_mov_b32 v199, v0
v_and_b32 v251, 63, v0
v_lshrrev_b32 v120, 6, v0
s_nop 0
v_readfirstlane_b32 s40, v120
s_and_b32 s43, s2, 7
s_lshr_b32 s44, s2, 3
s_and_b32 s41, s43, 0
s_lshl_b32 s41, s41, 4
s_and_b32 s45, s44, 15
s_add_u32 s41, s41, s45
s_lshr_b32 s42, s43, 0
s_lshl_b32 s42, s42, 1
s_lshr_b32 s45, s44, 4
s_add_u32 s42, s42, s45
s_lshl_b32 s41, s41, 5
s_lshl_b32 s42, s42, 5
s_lshl_b32 s67, s40, 6
s_cmp_eq_u32 s40, 6
s_cselect_b32 s67, 352, s67
v_add_u32_e64 v125, s67, v251
v_mul_u32_u24 v121, 5462, v125
v_lshrrev_b32 v121, 16, v121
v_mul_u32_u24 v122, 12, v121
v_sub_u32 v122, v125, v122
v_bfe_u32 v123, v121, 2, 2
v_xor_b32 v122, v122, v123
v_add_u32 v123, s41, v121
v_subrev_u32 v123, 1, v123
v_mul_u32_u24 v124, 192, v123
v_lshl_add_u32 v124, v122, 4, v124
v_mov_b32 v240, 2147483648
s_movk_i32 s43, 512
v_cmp_gt_u32 vcc, s43, v123
s_nop 1
v_cndmask_b32 v124, v240, v124, vcc
v_cmp_gt_u32 vcc, 34, v121
s_nop 1
v_cndmask_b32 v240, v240, v124, vcc
s_add_i32 s43, s42, -1
s_mul_i32 s44, s43, 98304
s_cmp_lt_u32 s43, 512
s_cselect_b32 s46, s44, 1073741824
s_mul_i32 s66, s42, 98304
s_mov_b32 s6, 50331648
s_mov_b32 s7, 131072
s_lshl_b32 s67, s67, 4
s_add_u32 s67, s67, 90112
s_cmp_eq_u32 s40, 7
s_cselect_b32 s67, 163840, s67
v_lshlrev_b32 v130, 1, v199
v_add_u32 v155, 768, v199
v_min_u32 v155, 863, v155
v_lshlrev_b32_e64 v131, 1, v155
s_waitcnt lgkmcnt(0)
s_mov_b32 s4, s80
s_and_b32 s5, s81, 65535
s_cmp_ge_u32 s40, 4
s_cbranch_scc1 Lnodw
s_mov_b32 s20, s82
s_and_b32 s21, s83, 65535
s_mov_b32 s22, 1728
s_mov_b32 s23, 131072
buffer_load_ushort v126, v130, s[20:23], 0 offen offset:0
buffer_load_ushort v127, v130, s[20:23], 0 offen offset:512
buffer_load_ushort v128, v130, s[20:23], 0 offen offset:1024
buffer_load_ushort v129, v131, s[20:23], 0 offen offset:0
Lnodw:
s_cmp_eq_u32 s40, 7
s_cbranch_scc1 Lskipx0
s_add_u32 m0, s67, 0
s_nop 0
buffer_load_dwordx4 v240, s[4:7], s46 offen nt lds
s_add_u32 m0, s67, 6656
s_nop 0
buffer_load_dwordx4 v240, s[4:7], s66 offen nt lds
s_add_u32 m0, s67, 13312
s_add_u32 s45, s66, 98304
buffer_load_dwordx4 v240, s[4:7], s45 offen nt lds
s_add_u32 m0, s67, 19968
s_add_u32 s45, s66, 196608
buffer_load_dwordx4 v240, s[4:7], s45 offen nt lds
s_add_u32 m0, s67, 26624
s_add_u32 s45, s66, 294912
buffer_load_dwordx4 v240, s[4:7], s45 offen nt lds
s_add_u32 m0, s67, 33280
s_add_u32 s45, s66, 393216
buffer_load_dwordx4 v240, s[4:7], s45 offen nt lds
Lskipx0:
s_mov_b32 s12, s84
s_and_b32 s13, s85, 65535
s_mov_b32 s14, 73728
s_mov_b32 s15, 131072
v_lshrrev_b32 v189, 2, v251
v_mul_u32_u24 v189, 768, v189
v_and_b32_e64 v125, 3, v251
v_lshl_add_u32 v189, v125, 4, v189
s_and_b32 s43, s40, 3
s_lshl_b32 s3, s43, 6
s_mul_i32 s77, s43, 6144
s_add_u32 s77, s77, 16384
v_mov_b32 v253, 16256
v_mov_b32 v254, 1
s_add_u32 s43, s42, s40
s_add_u32 s43, s43, 1
s_lshl_b32 s43, s43, 9
s_add_u32 s43, s43, s41
s_mul_i32 s47, s43, 192
s_sub_u32 s47, s47, 256
s_and_b32 s43, s40, 1
s_lshl_b32 s46, s43, 4
s_add_u32 s41, s41, s46
s_and_b32 s43, s40, 6
s_add_u32 s42, s42, s43
s_mul_i32 s45, s43, 6656
s_add_u32 s45, s45, 90112
v_and_b32 v131, 15, v251
v_lshrrev_b32 v132, 4, v251
v_mul_u32_u24 v122, 6656, v132
v_add_u32 v122, s45, v122
v_add_u32 v121, s46, v131
v_mul_u32_u24 v123, 192, v121
v_bfe_u32 v124, v121, 2, 2
v_lshl_add_u32 v123, v124, 4, v123
v_add_u32 v242, v122, v123
v_add_u32 v121, 1, v121
v_mul_u32_u24 v123, 192, v121
v_bfe_u32 v124, v121, 2, 2
v_lshl_add_u32 v123, v124, 4, v123
v_add_u32 v243, v122, v123
v_add_u32 v121, 1, v121
v_mul_u32_u24 v123, 192, v121
v_bfe_u32 v124, v121, 2, 2
v_lshl_add_u32 v123, v124, 4, v123
v_add_u32_e64 v244, v122, v123
s_mul_i32 s72, s40, 9216
s_add_u32 s72, s72, 90112
v_bfe_u32 v133, v131, 2, 1
v_sub_u32 v133, v132, v133
v_lshrrev_b32 v134, 3, v131
v_and_b32_e64 v135, 3, v131
v_lshl_add_u32 v135, v134, 2, v135
v_lshlrev_b32_e64 v136, 7, v133
v_lshl_add_u32 v136, v135, 4, v136
v_add_u32 v136, 156672, v136
v_mov_b32 v135, 163840
v_cmp_gt_u32 vcc, 3, v133
s_nop 1
v_cndmask_b32 v245, v135, v136, vcc
v_and_b32 v135, 3, v131
v_mul_u32_u24 v246, 85, v135
s_mov_b32 s16, s86
s_and_b32 s17, s87, 65535
s_mov_b32 s18, 73728
s_mov_b32 s19, 131072
s_mov_b32 s24, s88
s_and_b32 s25, s89, 65535
s_mov_b32 s26, 768
s_mov_b32 s27, 131072
s_mov_b32 s28, s90
s_and_b32 s29, s91, 65535
s_mov_b32 s30, 768
s_mov_b32 s31, 131072
s_mov_b32 s8, s92
s_and_b32 s9, s93, 65535
s_mov_b32 s10, 50331648
s_mov_b32 s11, 131072
s_mov_b32 s36, s94
s_and_b32 s37, s95, 65535
s_mov_b32 s38, 256
s_mov_b32 s39, 131072
s_mov_b32 s32, s96
s_and_b32 s33, s97, 65535
s_mov_b32 s34, 83886080
s_mov_b32 s35, 131072
v_lshlrev_b32 v241, 4, v251
v_and_b32 v133, 35, v251
v_bfe_u32 v134, v251, 2, 2
v_lshl_add_u32 v133, v134, 3, v133
v_bfe_u32 v134, v251, 4, 1
v_lshl_add_u32 v133, v134, 2, v133
v_lshlrev_b32_e64 v248, 4, v133
v_add_u32 v249, 65536, v248
v_add_u32 v250, 131072, v248
s_lshl_b32 s73, s2, 3
s_add_u32 s73, s73, s40
s_lshl_b32 s80, s73, 10
s_add_u32 s80, s80, 4194304
s_mul_i32 s73, s73, 16
s_add_u32 s73, s73, 1048576
s_mul_i32 s46, s41, 192
s_add_u32 s43, s42, 0
s_mul_i32 s43, s43, 98304
s_add_u32 s68, s43, s46
s_add_u32 s43, s42, 8
s_mul_i32 s43, s43, 98304
s_add_u32 s69, s43, s46
s_add_u32 s43, s42, 16
s_mul_i32 s43, s43, 98304
s_add_u32 s70, s43, s46
s_add_u32 s43, s42, 24
s_mul_i32 s43, s43, 98304
s_add_u32 s71, s43, s46
s_mul_i32 s82, s40, 9216
s_mov_b32 s48, 1156203754
s_mov_b32 s49, 4294508536
s_mov_b32 s76, 400000
v_lshrrev_b32 v148, 5, v251
v_lshlrev_b32 v190, 8, v148
v_bfe_u32 v148, v251, 2, 2
v_lshl_add_u32 v190, v148, 6, v190
v_bfe_u32 v148, v251, 4, 1
v_lshl_add_u32 v190, v148, 5, v190
v_bfe_u32 v148, v251, 0, 1
v_lshl_add_u32 v190, v148, 4, v190
v_bfe_u32 v148, v251, 1, 1
v_lshl_add_u32 v190, v148, 3, v190
v_add_u32 v190, s77, v190
v_add_u32 v191, s77, v248
s_cmp_lt_u32 s40, 4
s_cbranch_scc1 Lnoy
v_lshlrev_b32_e64 v24, 6, v199
s_mov_b32 s43, 1065362610
v_mov_b32 v25, 1084047360
v_add_u32 v0, 32772, v24
v_add_u32 v1, 32780, v24
v_add_u32 v2, 32788, v24
v_add_u32 v3, 32796, v24
v_add_u32 v4, 32804, v24
v_add_u32 v5, 32812, v24
v_add_u32 v6, 32820, v24
v_add_u32 v7, 32828, v24
v_cvt_f32_f16 v0, v0
v_cvt_f32_f16 v1, v1
v_cvt_f32_f16 v2, v2
v_cvt_f32_f16 v3, v3
v_cvt_f32_f16 v4, v4
v_cvt_f32_f16 v5, v5
v_cvt_f32_f16 v6, v6
v_cvt_f32_f16 v7, v7
v_mul_f32 v8, v0, v0
v_mul_f32 v9, v1, v1
v_mul_f32 v10, v2, v2
v_mul_f32 v11, v3, v3
v_mul_f32 v12, v4, v4
v_mul_f32 v13, v5, v5
v_mul_f32 v14, v6, v6
v_mul_f32 v15, v7, v7
v_fma_f32 v8, v8, s43, v25
v_fma_f32 v9, v9, s43, v25
v_fma_f32 v10, v10, s43, v25
v_fma_f32 v11, v11, s43, v25
v_fma_f32 v12, v12, s43, v25
v_fma_f32 v13, v13, s43, v25
v_fma_f32 v14, v14, s43, v25
v_fma_f32 v15, v15, s43, v25
v_mul_f32 v8, v0, v8
v_mul_f32 v9, v1, v9
v_mul_f32 v10, v2, v10
v_mul_f32 v11, v3, v11
v_mul_f32 v12, v4, v12
v_mul_f32 v13, v5, v13
v_mul_f32 v14, v6, v14
v_mul_f32 v15, v7, v15
v_exp_f32 v8, v8
v_exp_f32 v9, v9
v_exp_f32 v10, v10
v_exp_f32 v11, v11
v_exp_f32 v12, v12
v_exp_f32 v13, v13
v_exp_f32 v14, v14
v_exp_f32 v15, v15
v_add_f32 v16, 1.0, v8
v_add_f32 v17, 1.0, v9
v_add_f32 v18, 1.0, v10
v_add_f32 v19, 1.0, v11
v_add_f32 v20, 1.0, v12
v_add_f32 v21, 1.0, v13
v_add_f32 v22, 1.0, v14
v_add_f32 v23, 1.0, v15
v_rcp_f32 v16, v16
v_rcp_f32 v17, v17
v_rcp_f32 v18, v18
v_rcp_f32 v19, v19
v_rcp_f32 v20, v20
v_rcp_f32 v21, v21
v_rcp_f32 v22, v22
v_rcp_f32 v23, v23
v_mul_f32 v0, v0, v16
v_mul_f32 v1, v1, v17
v_mul_f32 v2, v2, v18
v_mul_f32 v3, v3, v19
v_mul_f32 v4, v4, v20
v_mul_f32 v5, v5, v21
v_mul_f32 v6, v6, v22
v_mul_f32 v7, v7, v23
v_mul_f32 v8, v8, v0
v_mul_f32 v9, v9, v1
v_mul_f32 v10, v10, v2
v_mul_f32 v11, v11, v3
v_mul_f32 v12, v12, v4
v_mul_f32 v13, v13, v5
v_mul_f32 v14, v14, v6
v_mul_f32 v15, v15, v7
v_cvt_pk_f16_f32 v28, v0, v1
v_cvt_pk_f16_f32 v32, -v8, -v9
v_cvt_pk_f16_f32 v29, v2, v3
v_cvt_pk_f16_f32 v33, -v10, -v11
v_cvt_pk_f16_f32 v30, v4, v5
v_cvt_pk_f16_f32 v34, -v12, -v13
v_cvt_pk_f16_f32 v31, v6, v7
v_cvt_pk_f16_f32 v35, -v14, -v15
v_lshlrev_b32_e64 v24, 4, v199
v_mov_b32 v25, 163840
s_movk_i32 s43, 496
v_cmp_gt_u32 vcc, s43, v199
s_nop 1
v_cndmask_b32 v24, v25, v24, vcc
ds_write_b128 v24, v[32:35]
ds_write_b128 v24, v[28:31] offset:8192
Lnoy:
s_cmp_ge_u32 s40, 4
s_cbranch_scc1 Lnoo
v_add_u32_e64 v152, 0, v199
v_mul_u32_u24 v140, 683, v152
v_lshrrev_b32 v140, 16, v140
v_mul_u32_u24 v142, 11, v140
v_lshrrev_b32 v142, 5, v142
v_lshrrev_b32 v143, 5, v152
v_bfe_u32 v141, v152, 3, 2
v_bfe_u32 v144, v152, 4, 1
v_xor_b32 v141, v141, v144
v_sub_u32 v141, v141, v142
v_mul_i32_i24 v141, 9, v141
v_add_u32 v143, v143, v141
v_lshrrev_b32_e64 v141, 1, v143
v_mul_u32_u24 v141, 368, v141
v_lshl_add_u32 v143, v143, 3, v141
v_lshl_add_u32 v143, v142, 7, v143
v_and_b32_e64 v144, 7, v152
v_lshl_add_u32 v143, v144, 4, v143
v_add_u32 v156, 156672, v143
v_add_u32 v153, 256, v199
v_mul_u32_u24 v140, 683, v153
v_lshrrev_b32 v140, 16, v140
v_mul_u32_u24 v142, 11, v140
v_lshrrev_b32 v142, 5, v142
v_lshrrev_b32 v143, 5, v153
v_bfe_u32 v141, v153, 3, 2
v_bfe_u32 v144, v153, 4, 1
v_xor_b32 v141, v141, v144
v_sub_u32 v141, v141, v142
v_mul_i32_i24 v141, 9, v141
v_add_u32 v143, v143, v141
v_lshrrev_b32_e64 v141, 1, v143
v_mul_u32_u24 v141, 368, v141
v_lshl_add_u32 v143, v143, 3, v141
v_lshl_add_u32 v143, v142, 7, v143
v_and_b32_e64 v144, 7, v153
v_lshl_add_u32 v143, v144, 4, v143
v_add_u32 v157, 156672, v143
v_add_u32 v154, 512, v199
v_mul_u32_u24 v140, 683, v154
v_lshrrev_b32 v140, 16, v140
v_mul_u32_u24 v142, 11, v140
v_lshrrev_b32 v142, 5, v142
v_lshrrev_b32 v143, 5, v154
v_bfe_u32 v141, v154, 3, 2
v_bfe_u32 v144, v154, 4, 1
v_xor_b32 v141, v141, v144
v_sub_u32 v141, v141, v142
v_mul_i32_i24 v141, 9, v141
v_add_u32 v143, v143, v141
v_lshrrev_b32_e64 v141, 1, v143
v_mul_u32_u24 v141, 368, v141
v_lshl_add_u32 v143, v143, 3, v141
v_lshl_add_u32 v143, v142, 7, v143
v_and_b32_e64 v144, 7, v154
v_lshl_add_u32 v143, v144, 4, v143
v_add_u32 v158, 156672, v143
v_mul_u32_u24 v140, 683, v155
v_lshrrev_b32 v140, 16, v140
v_mul_u32_u24 v142, 11, v140
v_lshrrev_b32 v142, 5, v142
v_lshrrev_b32 v143, 5, v155
v_bfe_u32 v141, v155, 3, 2
v_bfe_u32 v144, v155, 4, 1
v_xor_b32 v141, v141, v144
v_sub_u32 v141, v141, v142
v_mul_i32_i24 v141, 9, v141
v_add_u32 v143, v143, v141
v_lshrrev_b32_e64 v141, 1, v143
v_mul_u32_u24 v141, 368, v141
v_lshl_add_u32 v143, v143, 3, v141
v_lshl_add_u32 v143, v142, 7, v143
v_and_b32_e64 v144, 7, v155
v_lshl_add_u32 v143, v144, 4, v143
v_add_u32 v159, 156672, v143
v_mov_b32 v160, 0
v_mov_b32 v161, 0
v_mov_b32_e64 v162, 0
v_mov_b32 v163, 0
s_mov_b64 exec, 1
ds_write_b128 v253, v[160:163]
ds_write_b128 v253, v[160:163] offset:16
s_mov_b64 exec, -1
s_waitcnt vmcnt(6)
v_and_b32_e64 v130, 4, v152
v_cmp_eq_u32 vcc, 0, v130
s_nop 1
v_cndmask_b32 v164, 0, v126, vcc
v_sub_u32 v165, v126, v164
ds_write_b64 v156, v[164:165]
v_and_b32_e64 v130, 4, v153
v_cmp_eq_u32 vcc, 0, v130
s_nop 1
v_cndmask_b32 v166, 0, v127, vcc
v_sub_u32 v167, v127, v166
ds_write_b64 v157, v[166:167]
v_and_b32_e64 v130, 4, v154
v_cmp_eq_u32 vcc, 0, v130
s_nop 1
v_cndmask_b32 v168, 0, v128, vcc
v_sub_u32 v169, v128, v168
ds_write_b64 v158, v[168:169]
v_and_b32_e64 v130, 4, v155
v_cmp_eq_u32 vcc, 0, v130
s_nop 1
v_cndmask_b32 v170, 0, v129, vcc
v_sub_u32 v171, v129, v170
ds_write_b64 v159, v[170:171]
s_waitcnt lgkmcnt(0)
Lnoo:
s_barrier
s_cmp_lt_u32 s40, 4
s_cbranch_scc1 Lnoy2
v_subrev_u32 v199, 256, v199
v_lshlrev_b32_e64 v24, 6, v199
s_mov_b32 s43, 1065362610
v_mov_b32 v25, 1084047360
v_add_u32 v0, 32772, v24
v_add_u32 v1, 32780, v24
v_add_u32 v2, 32788, v24
v_add_u32 v3, 32796, v24
v_add_u32 v4, 32804, v24
v_add_u32 v5, 32812, v24
v_add_u32 v6, 32820, v24
v_add_u32 v7, 32828, v24
v_cvt_f32_f16 v0, v0
v_cvt_f32_f16 v1, v1
v_cvt_f32_f16 v2, v2
v_cvt_f32_f16 v3, v3
v_cvt_f32_f16 v4, v4
v_cvt_f32_f16 v5, v5
v_cvt_f32_f16 v6, v6
v_cvt_f32_f16 v7, v7
v_mul_f32 v8, v0, v0
v_mul_f32 v9, v1, v1
v_mul_f32 v10, v2, v2
v_mul_f32 v11, v3, v3
v_mul_f32 v12, v4, v4
v_mul_f32 v13, v5, v5
v_mul_f32 v14, v6, v6
v_mul_f32 v15, v7, v7
v_fma_f32 v8, v8, s43, v25
v_fma_f32 v9, v9, s43, v25
v_fma_f32 v10, v10, s43, v25
v_fma_f32 v11, v11, s43, v25
v_fma_f32 v12, v12, s43, v25
v_fma_f32 v13, v13, s43, v25
v_fma_f32 v14, v14, s43, v25
v_fma_f32 v15, v15, s43, v25
v_mul_f32 v8, v0, v8
v_mul_f32 v9, v1, v9
v_mul_f32 v10, v2, v10
v_mul_f32 v11, v3, v11
v_mul_f32 v12, v4, v12
v_mul_f32 v13, v5, v13
v_mul_f32 v14, v6, v14
v_mul_f32 v15, v7, v15
v_exp_f32 v8, v8
v_exp_f32 v9, v9
v_exp_f32 v10, v10
v_exp_f32 v11, v11
v_exp_f32 v12, v12
v_exp_f32 v13, v13
v_exp_f32 v14, v14
v_exp_f32 v15, v15
v_add_f32 v16, 1.0, v8
v_add_f32 v17, 1.0, v9
v_add_f32 v18, 1.0, v10
v_add_f32 v19, 1.0, v11
v_add_f32 v20, 1.0, v12
v_add_f32 v21, 1.0, v13
v_add_f32 v22, 1.0, v14
v_add_f32 v23, 1.0, v15
v_rcp_f32 v16, v16
v_rcp_f32 v17, v17
v_rcp_f32 v18, v18
v_rcp_f32 v19, v19
v_rcp_f32 v20, v20
v_rcp_f32 v21, v21
v_rcp_f32 v22, v22
v_rcp_f32 v23, v23
v_mul_f32 v0, v0, v16
v_mul_f32 v1, v1, v17
v_mul_f32 v2, v2, v18
v_mul_f32 v3, v3, v19
v_mul_f32 v4, v4, v20
v_mul_f32 v5, v5, v21
v_mul_f32 v6, v6, v22
v_mul_f32 v7, v7, v23
v_mul_f32 v8, v8, v0
v_mul_f32 v9, v9, v1
v_mul_f32 v10, v10, v2
v_mul_f32 v11, v11, v3
v_mul_f32 v12, v12, v4
v_mul_f32 v13, v13, v5
v_mul_f32 v14, v14, v6
v_mul_f32 v15, v15, v7
v_cvt_pk_f16_f32 v28, v0, v1
v_cvt_pk_f16_f32 v32, -v8, -v9
v_cvt_pk_f16_f32 v29, v2, v3
v_cvt_pk_f16_f32 v33, -v10, -v11
v_cvt_pk_f16_f32 v30, v4, v5
v_cvt_pk_f16_f32 v34, -v12, -v13
v_cvt_pk_f16_f32 v31, v6, v7
v_cvt_pk_f16_f32 v35, -v14, -v15
v_lshlrev_b32_e64 v24, 4, v199
v_mov_b32 v25, 163840
s_movk_i32 s43, 496
v_cmp_gt_u32 vcc, s43, v199
s_nop 1
v_cndmask_b32 v24, v25, v24, vcc
ds_write_b128 v24, v[32:35]
ds_write_b128 v24, v[28:31] offset:8192
Lnoy2:
s_setprio 2
s_cmp_lt_u32 s40, 4
s_cbranch_scc0 Lsu0
s_call_b64 s[78:79], Lpre
s_call_b64 s[78:79], Lrb
s_waitcnt vmcnt(4)
s_mov_b64 exec, 1
ds_add_u32 v253, v254 offset:28
s_mov_b64 exec, -1
v_mov_b32 v253, 16256
Lsw288w:
ds_read_b32 v247, v253 offset:28
s_waitcnt lgkmcnt(0)
v_readfirstlane_b32 s43, v247
s_cmp_eq_u32 s76, 0
s_cbranch_scc1 Lsw288x
s_sub_u32 s76, s76, 1
s_cmp_lt_u32 s43, 8
s_cbranch_scc0 Lsw288x
s_sleep 2
s_branch Lsw288w
Lsw288x:
s_call_b64 s[78:79], Lconv0
s_mov_b64 exec, 1
ds_add_u32 v253, v254 offset:16
s_mov_b64 exec, -1
s_call_b64 s[78:79], Lln0
s_waitcnt vmcnt(0)
s_mov_b64 exec, 1
ds_add_u32 v253, v254 offset:12
s_mov_b64 exec, -1
s_call_b64 s[78:79], Lw1i
Lsu0:
s_cmp_ge_u32 s40, 4
s_cbranch_scc0 Lsu2
s_setprio 3
s_call_b64 s[78:79], Lw1f
s_waitcnt vmcnt(6)
s_mov_b64 exec, 1
ds_add_u32 v253, v254 offset:28
s_mov_b64 exec, -1
s_call_b64 s[78:79], Lrb
s_waitcnt vmcnt(4)
s_call_b64 s[78:79], Lw1a
s_mov_b64 exec, 1
ds_add_u32 v253, v254 offset:20
s_mov_b64 exec, -1
s_call_b64 s[78:79], Lpre
s_waitcnt vmcnt(0)
s_mov_b64 exec, 1
ds_add_u32 v253, v254 offset:12
s_mov_b64 exec, -1
v_mov_b32 v253, 16256
Lsw128w:
ds_read_b32 v247, v253 offset:12
s_waitcnt lgkmcnt(0)
v_readfirstlane_b32 s43, v247
s_cmp_eq_u32 s76, 0
s_cbranch_scc1 Lsw128x
s_sub_u32 s76, s76, 1
s_cmp_lt_u32 s43, 8
s_cbranch_scc0 Lsw128x
s_sleep 2
s_branch Lsw128w
Lsw128x:
s_call_b64 s[78:79], Lconv0
s_mov_b64 exec, 1
ds_add_u32 v253, v254 offset:16
s_mov_b64 exec, -1
s_call_b64 s[78:79], Lln0
Lsu2:
s_branch Lgo
Lconv0:
ds_read_b128 v[192:195], v242
ds_read_b128 v[196:199], v242 offset:64
ds_read_b128 v[200:203], v242 offset:128
ds_read_b128 v[204:207], v243
ds_read_b128 v[208:211], v243 offset:64
ds_read_b128 v[212:215], v243 offset:128
ds_read_b128 v[224:227], v244
ds_read_b128 v[228:231], v244 offset:64
ds_read_b128 v[232:235], v244 offset:128
v_xor_b32 v242, 16, v242
ds_read_b128 v[236:239], v242
ds_read_b128 v[216:219], v242 offset:64
ds_read_b128 v[220:223], v242 offset:128
s_waitcnt lgkmcnt(11)
v_smfmac_f32_16x16x32_bf16 v[0:3], v[48:49], v[192:195], v246
s_waitcnt lgkmcnt(10)
v_smfmac_f32_16x16x32_bf16 v[16:19], v[50:51], v[196:199], v246
s_waitcnt lgkmcnt(9)
v_smfmac_f32_16x16x32_bf16 v[32:35], v[52:53], v[200:203], v246
s_waitcnt lgkmcnt(8)
v_xor_b32 v243, 16, v243
ds_read_b128 v[192:195], v243
ds_read_b128 v[196:199], v243 offset:64
v_smfmac_f32_16x16x32_bf16 v[0:3], v[54:55], v[204:207], v246
s_waitcnt lgkmcnt(9)
v_smfmac_f32_16x16x32_bf16 v[16:19], v[56:57], v[208:211], v246
s_waitcnt lgkmcnt(8)
ds_read_b128 v[200:203], v243 offset:128
v_xor_b32 v244, 16, v244
ds_read_b128 v[204:207], v244
v_smfmac_f32_16x16x32_bf16 v[32:35], v[58:59], v[212:215], v246
s_waitcnt lgkmcnt(9)
v_smfmac_f32_16x16x32_bf16 v[0:3], v[60:61], v[224:227], v246
s_waitcnt lgkmcnt(8)
ds_read_b128 v[208:211], v244 offset:64
ds_read_b128 v[212:215], v244 offset:128
v_smfmac_f32_16x16x32_bf16 v[16:19], v[62:63], v[228:231], v246
s_waitcnt lgkmcnt(9)
v_smfmac_f32_16x16x32_bf16 v[32:35], v[64:65], v[232:235], v246
s_waitcnt lgkmcnt(8)
v_xor_b32 v242, 32, v242
ds_read_b128 v[224:227], v242
ds_read_b128 v[228:231], v242 offset:64
v_smfmac_f32_16x16x32_bf16 v[4:7], v[66:67], v[236:239], v246
s_waitcnt lgkmcnt(9)
v_smfmac_f32_16x16x32_bf16 v[20:23], v[68:69], v[216:219], v246
s_waitcnt lgkmcnt(8)
ds_read_b128 v[232:235], v242 offset:128
v_xor_b32 v243, 32, v243
ds_read_b128 v[236:239], v243
v_smfmac_f32_16x16x32_bf16 v[36:39], v[70:71], v[220:223], v246
s_waitcnt lgkmcnt(9)
v_smfmac_f32_16x16x32_bf16 v[4:7], v[72:73], v[192:195], v246
s_waitcnt lgkmcnt(8)
ds_read_b128 v[216:219], v243 offset:64
ds_read_b128 v[220:223], v243 offset:128
v_smfmac_f32_16x16x32_bf16 v[20:23], v[74:75], v[196:199], v246
s_waitcnt lgkmcnt(9)
v_smfmac_f32_16x16x32_bf16 v[36:39], v[76:77], v[200:203], v246
s_waitcnt lgkmcnt(8)
v_xor_b32 v244, 32, v244
ds_read_b128 v[192:195], v244
ds_read_b128 v[196:199], v244 offset:64
v_smfmac_f32_16x16x32_bf16 v[4:7], v[78:79], v[204:207], v246
s_waitcnt lgkmcnt(9)
v_smfmac_f32_16x16x32_bf16 v[20:23], v[80:81], v[208:211], v246
s_waitcnt lgkmcnt(8)
ds_read_b128 v[200:203], v244 offset:128
v_xor_b32 v242, 16, v242
ds_read_b128 v[204:207], v242
v_smfmac_f32_16x16x32_bf16 v[36:39], v[82:83], v[212:215], v246
s_waitcnt lgkmcnt(9)
v_smfmac_f32_16x16x32_bf16 v[12:15], v[84:85], v[224:227], v246
s_waitcnt lgkmcnt(8)
ds_read_b128 v[208:211], v242 offset:64
ds_read_b128 v[212:215], v242 offset:128
v_smfmac_f32_16x16x32_bf16 v[28:31], v[86:87], v[228:231], v246
s_waitcnt lgkmcnt(9)
v_smfmac_f32_16x16x32_bf16 v[44:47], v[88:89], v[232:235], v246
s_waitcnt lgkmcnt(8)
v_xor_b32 v243, 16, v243
ds_read_b128 v[224:227], v243
ds_read_b128 v[228:231], v243 offset:64
v_smfmac_f32_16x16x32_bf16 v[12:15], v[90:91], v[236:239], v246
s_waitcnt lgkmcnt(9)
v_smfmac_f32_16x16x32_bf16 v[28:31], v[92:93], v[216:219], v246
s_waitcnt lgkmcnt(8)
ds_read_b128 v[232:235], v243 offset:128
v_xor_b32 v244, 16, v244
ds_read_b128 v[236:239], v244
v_smfmac_f32_16x16x32_bf16 v[44:47], v[94:95], v[220:223], v246
s_waitcnt lgkmcnt(9)
v_smfmac_f32_16x16x32_bf16 v[12:15], v[96:97], v[192:195], v246
s_waitcnt lgkmcnt(8)
ds_read_b128 v[216:219], v244 offset:64
ds_read_b128 v[220:223], v244 offset:128
v_smfmac_f32_16x16x32_bf16 v[28:31], v[98:99], v[196:199], v246
s_waitcnt lgkmcnt(9)
v_smfmac_f32_16x16x32_bf16 v[44:47], v[100:101], v[200:203], v246
s_waitcnt lgkmcnt(8)
v_smfmac_f32_16x16x32_bf16 v[8:11], v[102:103], v[204:207], v246
s_waitcnt lgkmcnt(7)
v_smfmac_f32_16x16x32_bf16 v[24:27], v[104:105], v[208:211], v246
s_waitcnt lgkmcnt(6)
v_smfmac_f32_16x16x32_bf16 v[40:43], v[106:107], v[212:215], v246
s_waitcnt lgkmcnt(5)
v_smfmac_f32_16x16x32_bf16 v[8:11], v[108:109], v[224:227], v246
s_waitcnt lgkmcnt(4)
v_smfmac_f32_16x16x32_bf16 v[24:27], v[110:111], v[228:231], v246
s_waitcnt lgkmcnt(3)
v_smfmac_f32_16x16x32_bf16 v[40:43], v[112:113], v[232:235], v246
s_waitcnt lgkmcnt(2)
v_smfmac_f32_16x16x32_bf16 v[8:11], v[114:115], v[236:239], v246
s_waitcnt lgkmcnt(1)
v_smfmac_f32_16x16x32_bf16 v[24:27], v[116:117], v[216:219], v246
s_waitcnt lgkmcnt(0)
v_smfmac_f32_16x16x32_bf16 v[40:43], v[118:119], v[220:223], v246
s_nop 11
s_setpc_b64 s[78:79]
Lln0:
v_pk_add_f32 v[168:169], v[0:1], v[2:3]
v_pk_mul_f32 v[170:171], v[0:1], v[0:1]
v_pk_fma_f32 v[170:171], v[2:3], v[2:3], v[170:171]
v_pk_add_f32 v[168:169], v[168:169], v[4:5]
v_pk_fma_f32 v[170:171], v[4:5], v[4:5], v[170:171]
v_pk_add_f32 v[168:169], v[168:169], v[6:7]
v_pk_fma_f32 v[170:171], v[6:7], v[6:7], v[170:171]
v_pk_add_f32 v[168:169], v[168:169], v[8:9]
v_pk_fma_f32 v[170:171], v[8:9], v[8:9], v[170:171]
v_pk_add_f32 v[168:169], v[168:169], v[10:11]
v_pk_fma_f32 v[170:171], v[10:11], v[10:11], v[170:171]
v_pk_add_f32 v[168:169], v[168:169], v[12:13]
v_pk_fma_f32 v[170:171], v[12:13], v[12:13], v[170:171]
v_pk_add_f32 v[168:169], v[168:169], v[14:15]
v_pk_fma_f32 v[170:171], v[14:15], v[14:15], v[170:171]
v_pk_add_f32 v[168:169], v[168:169], v[16:17]
v_pk_fma_f32 v[170:171], v[16:17], v[16:17], v[170:171]
v_pk_add_f32 v[168:169], v[168:169], v[18:19]
v_pk_fma_f32 v[170:171], v[18:19], v[18:19], v[170:171]
v_pk_add_f32 v[168:169], v[168:169], v[20:21]
v_pk_fma_f32 v[170:171], v[20:21], v[20:21], v[170:171]
v_pk_add_f32 v[168:169], v[168:169], v[22:23]
v_pk_fma_f32 v[170:171], v[22:23], v[22:23], v[170:171]
v_pk_add_f32 v[168:169], v[168:169], v[24:25]
v_pk_fma_f32 v[170:171], v[24:25], v[24:25], v[170:171]
v_pk_add_f32 v[168:169], v[168:169], v[26:27]
v_pk_fma_f32 v[170:171], v[26:27], v[26:27], v[170:171]
v_pk_add_f32 v[168:169], v[168:169], v[28:29]
v_pk_fma_f32 v[170:171], v[28:29], v[28:29], v[170:171]
v_pk_add_f32 v[168:169], v[168:169], v[30:31]
v_pk_fma_f32 v[170:171], v[30:31], v[30:31], v[170:171]
v_pk_add_f32 v[168:169], v[168:169], v[32:33]
v_pk_fma_f32 v[170:171], v[32:33], v[32:33], v[170:171]
v_pk_add_f32 v[168:169], v[168:169], v[34:35]
v_pk_fma_f32 v[170:171], v[34:35], v[34:35], v[170:171]
v_pk_add_f32 v[168:169], v[168:169], v[36:37]
v_pk_fma_f32 v[170:171], v[36:37], v[36:37], v[170:171]
v_pk_add_f32 v[168:169], v[168:169], v[38:39]
v_pk_fma_f32 v[170:171], v[38:39], v[38:39], v[170:171]
v_pk_add_f32 v[168:169], v[168:169], v[40:41]
v_pk_fma_f32 v[170:171], v[40:41], v[40:41], v[170:171]
v_pk_add_f32 v[168:169], v[168:169], v[42:43]
v_pk_fma_f32 v[170:171], v[42:43], v[42:43], v[170:171]
v_pk_add_f32 v[168:169], v[168:169], v[44:45]
v_pk_fma_f32 v[170:171], v[44:45], v[44:45], v[170:171]
v_pk_add_f32 v[168:169], v[168:169], v[46:47]
v_pk_fma_f32 v[170:171], v[46:47], v[46:47], v[170:171]
v_add_f32 v168, v168, v169
v_add_f32 v170, v170, v171
s_nop 1
v_permlane32_swap_b32 v168, v170
v_add_f32_e64 v168, v168, v170
v_mul_f32 v168, 1009429163, v168
v_mov_b32_e64 v170, v168
s_nop 1
v_permlane32_swap_b32 v168, v170
v_fma_f32 v170, -v168, v168, v170
v_max_f32_e64 v170, 0, v170
v_add_f32 v170, 925353388, v170
v_rsq_f32 v170, v170
s_nop 0
v_mul_f32 v172, 3203391086, v170
v_mul_f32_e64 v173, v168, v172
v_pk_fma_f32 v[0:1], v[0:1], v[172:173], v[172:173] op_sel:[0,0,1] op_sel_hi:[1,0,1] neg_lo:[0,0,1] neg_hi:[0,0,1]
v_pk_fma_f32 v[2:3], v[2:3], v[172:173], v[172:173] op_sel:[0,0,1] op_sel_hi:[1,0,1] neg_lo:[0,0,1] neg_hi:[0,0,1]
v_pk_fma_f32 v[4:5], v[4:5], v[172:173], v[172:173] op_sel:[0,0,1] op_sel_hi:[1,0,1] neg_lo:[0,0,1] neg_hi:[0,0,1]
v_pk_fma_f32 v[6:7], v[6:7], v[172:173], v[172:173] op_sel:[0,0,1] op_sel_hi:[1,0,1] neg_lo:[0,0,1] neg_hi:[0,0,1]
v_pk_fma_f32 v[8:9], v[8:9], v[172:173], v[172:173] op_sel:[0,0,1] op_sel_hi:[1,0,1] neg_lo:[0,0,1] neg_hi:[0,0,1]
v_pk_fma_f32 v[10:11], v[10:11], v[172:173], v[172:173] op_sel:[0,0,1] op_sel_hi:[1,0,1] neg_lo:[0,0,1] neg_hi:[0,0,1]
v_pk_fma_f32 v[12:13], v[12:13], v[172:173], v[172:173] op_sel:[0,0,1] op_sel_hi:[1,0,1] neg_lo:[0,0,1] neg_hi:[0,0,1]
v_pk_fma_f32 v[14:15], v[14:15], v[172:173], v[172:173] op_sel:[0,0,1] op_sel_hi:[1,0,1] neg_lo:[0,0,1] neg_hi:[0,0,1]
v_pk_fma_f32 v[16:17], v[16:17], v[172:173], v[172:173] op_sel:[0,0,1] op_sel_hi:[1,0,1] neg_lo:[0,0,1] neg_hi:[0,0,1]
v_pk_fma_f32 v[18:19], v[18:19], v[172:173], v[172:173] op_sel:[0,0,1] op_sel_hi:[1,0,1] neg_lo:[0,0,1] neg_hi:[0,0,1]
v_pk_fma_f32 v[20:21], v[20:21], v[172:173], v[172:173] op_sel:[0,0,1] op_sel_hi:[1,0,1] neg_lo:[0,0,1] neg_hi:[0,0,1]
v_pk_fma_f32 v[22:23], v[22:23], v[172:173], v[172:173] op_sel:[0,0,1] op_sel_hi:[1,0,1] neg_lo:[0,0,1] neg_hi:[0,0,1]
v_pk_fma_f32 v[24:25], v[24:25], v[172:173], v[172:173] op_sel:[0,0,1] op_sel_hi:[1,0,1] neg_lo:[0,0,1] neg_hi:[0,0,1]
v_pk_fma_f32 v[26:27], v[26:27], v[172:173], v[172:173] op_sel:[0,0,1] op_sel_hi:[1,0,1] neg_lo:[0,0,1] neg_hi:[0,0,1]
v_pk_fma_f32 v[28:29], v[28:29], v[172:173], v[172:173] op_sel:[0,0,1] op_sel_hi:[1,0,1] neg_lo:[0,0,1] neg_hi:[0,0,1]
v_pk_fma_f32 v[30:31], v[30:31], v[172:173], v[172:173] op_sel:[0,0,1] op_sel_hi:[1,0,1] neg_lo:[0,0,1] neg_hi:[0,0,1]
v_pk_fma_f32 v[32:33], v[32:33], v[172:173], v[172:173] op_sel:[0,0,1] op_sel_hi:[1,0,1] neg_lo:[0,0,1] neg_hi:[0,0,1]
v_pk_fma_f32 v[34:35], v[34:35], v[172:173], v[172:173] op_sel:[0,0,1] op_sel_hi:[1,0,1] neg_lo:[0,0,1] neg_hi:[0,0,1]
v_pk_fma_f32 v[36:37], v[36:37], v[172:173], v[172:173] op_sel:[0,0,1] op_sel_hi:[1,0,1] neg_lo:[0,0,1] neg_hi:[0,0,1]
v_pk_fma_f32 v[38:39], v[38:39], v[172:173], v[172:173] op_sel:[0,0,1] op_sel_hi:[1,0,1] neg_lo:[0,0,1] neg_hi:[0,0,1]
v_pk_fma_f32 v[40:41], v[40:41], v[172:173], v[172:173] op_sel:[0,0,1] op_sel_hi:[1,0,1] neg_lo:[0,0,1] neg_hi:[0,0,1]
v_pk_fma_f32 v[42:43], v[42:43], v[172:173], v[172:173] op_sel:[0,0,1] op_sel_hi:[1,0,1] neg_lo:[0,0,1] neg_hi:[0,0,1]
v_pk_fma_f32 v[44:45], v[44:45], v[172:173], v[172:173] op_sel:[0,0,1] op_sel_hi:[1,0,1] neg_lo:[0,0,1] neg_hi:[0,0,1]
v_pk_fma_f32 v[46:47], v[46:47], v[172:173], v[172:173] op_sel:[0,0,1] op_sel_hi:[1,0,1] neg_lo:[0,0,1] neg_hi:[0,0,1]
v_cvt_pk_bf16_f32 v48, v0, v1
v_cvt_pk_bf16_f32 v49, v2, v3
v_cvt_pk_bf16_f32 v50, v4, v5
v_cvt_pk_bf16_f32 v51, v6, v7
v_cvt_pk_bf16_f32 v52, v8, v9
v_cvt_pk_bf16_f32 v53, v10, v11
v_cvt_pk_bf16_f32 v54, v12, v13
v_cvt_pk_bf16_f32 v55, v14, v15
v_cvt_pk_bf16_f32 v56, v16, v17
v_cvt_pk_bf16_f32 v57, v18, v19
v_cvt_pk_bf16_f32 v58, v20, v21
v_cvt_pk_bf16_f32 v59, v22, v23
v_cvt_pk_bf16_f32 v60, v24, v25
v_cvt_pk_bf16_f32 v61, v26, v27
v_cvt_pk_bf16_f32 v62, v28, v29
v_cvt_pk_bf16_f32 v63, v30, v31
v_cvt_pk_bf16_f32 v64, v32, v33
v_cvt_pk_bf16_f32 v65, v34, v35
v_cvt_pk_bf16_f32 v66, v36, v37
v_cvt_pk_bf16_f32 v67, v38, v39
v_cvt_pk_bf16_f32 v68, v40, v41
v_cvt_pk_bf16_f32 v69, v42, v43
v_cvt_pk_bf16_f32 v70, v44, v45
v_cvt_pk_bf16_f32 v71, v46, v47
s_nop 1
s_setpc_b64 s[78:79]
Lw1a:
ds_read_b64_tr_b16 v[148:149], v190
ds_read_b64_tr_b16 v[150:151], v190 offset:512
ds_read_b64_tr_b16 v[152:153], v190 offset:1024
ds_read_b64_tr_b16 v[154:155], v190 offset:1536
ds_read_b64_tr_b16 v[156:157], v190 offset:2048
ds_read_b64_tr_b16 v[158:159], v190 offset:2560
ds_read_b64_tr_b16 v[160:161], v190 offset:3072
ds_read_b64_tr_b16 v[162:163], v190 offset:3584
ds_read_b64_tr_b16 v[164:165], v190 offset:4096
ds_read_b64_tr_b16 v[166:167], v190 offset:4608
ds_read_b64_tr_b16 v[168:169], v190 offset:5120
ds_read_b64_tr_b16 v[170:171], v190 offset:5632
s_waitcnt lgkmcnt(10)
ds_write_b128 v191, v[148:151]
s_waitcnt lgkmcnt(9)
ds_write_b128 v191, v[152:155] offset:1024
s_waitcnt lgkmcnt(8)
ds_write_b128 v191, v[156:159] offset:2048
s_waitcnt lgkmcnt(7)
ds_write_b128 v191, v[160:163] offset:3072
s_waitcnt lgkmcnt(6)
ds_write_b128 v191, v[164:167] offset:4096
s_waitcnt lgkmcnt(5)
ds_write_b128 v191, v[168:171] offset:5120
s_waitcnt lgkmcnt(0)
s_setpc_b64 s[78:79]
Lw1i:
s_add_u32 m0, s77, 24576
s_add_u32 s43, s3, 256
buffer_load_dwordx4 v189, s[12:15], s43 offen lds
s_add_u32 m0, s77, 25600
s_add_u32 s43, s3, 24832
buffer_load_dwordx4 v189, s[12:15], s43 offen lds
s_add_u32 m0, s77, 26624
s_add_u32 s43, s3, 49408
buffer_load_dwordx4 v189, s[12:15], s43 offen lds
s_add_u32 m0, s77, 27648
s_add_u32 s43, s3, 12544
buffer_load_dwordx4 v189, s[12:15], s43 offen lds
s_add_u32 m0, s77, 28672
s_add_u32 s43, s3, 37120
buffer_load_dwordx4 v189, s[12:15], s43 offen lds
s_add_u32 m0, s77, 29696
s_add_u32 s43, s3, 61696
buffer_load_dwordx4 v189, s[12:15], s43 offen lds
s_add_u32 m0, s77, 49152
s_add_u32 s43, s3, 512
buffer_load_dwordx4 v189, s[12:15], s43 offen lds
s_add_u32 m0, s77, 50176
s_add_u32 s43, s3, 25088
buffer_load_dwordx4 v189, s[12:15], s43 offen lds
s_add_u32 m0, s77, 51200
s_add_u32 s43, s3, 49664
buffer_load_dwordx4 v189, s[12:15], s43 offen lds
s_add_u32 m0, s77, 52224
s_add_u32 s43, s3, 12800
buffer_load_dwordx4 v189, s[12:15], s43 offen lds
s_add_u32 m0, s77, 53248
s_add_u32 s43, s3, 37376
buffer_load_dwordx4 v189, s[12:15], s43 offen lds
s_add_u32 m0, s77, 54272
s_add_u32 s43, s3, 61952
buffer_load_dwordx4 v189, s[12:15], s43 offen lds
s_setpc_b64 s[78:79]
Lw1b:
ds_read_b64_tr_b16 v[72:73], v190 offset:24576
ds_read_b64_tr_b16 v[74:75], v190 offset:25088
ds_read_b64_tr_b16 v[76:77], v190 offset:25600
ds_read_b64_tr_b16 v[78:79], v190 offset:26112
ds_read_b64_tr_b16 v[80:81], v190 offset:26624
ds_read_b64_tr_b16 v[82:83], v190 offset:27136
ds_read_b64_tr_b16 v[84:85], v190 offset:27648
ds_read_b64_tr_b16 v[86:87], v190 offset:28160
ds_read_b64_tr_b16 v[88:89], v190 offset:28672
ds_read_b64_tr_b16 v[90:91], v190 offset:29184
ds_read_b64_tr_b16 v[92:93], v190 offset:29696
ds_read_b64_tr_b16 v[94:95], v190 offset:30208
s_waitcnt lgkmcnt(10)
ds_write_b128 v191, v[72:75] offset:24576
s_waitcnt lgkmcnt(9)
ds_write_b128 v191, v[76:79] offset:25600
s_waitcnt lgkmcnt(8)
ds_write_b128 v191, v[80:83] offset:26624
s_waitcnt lgkmcnt(7)
ds_write_b128 v191, v[84:87] offset:27648
s_waitcnt lgkmcnt(6)
ds_write_b128 v191, v[88:91] offset:28672
s_waitcnt lgkmcnt(5)
ds_write_b128 v191, v[92:95] offset:29696
s_waitcnt lgkmcnt(0)
s_setpc_b64 s[78:79]
Lw1c:
ds_read_b64_tr_b16 v[72:73], v190 offset:49152
ds_read_b64_tr_b16 v[74:75], v190 offset:49664
ds_read_b64_tr_b16 v[76:77], v190 offset:50176
ds_read_b64_tr_b16 v[78:79], v190 offset:50688
ds_read_b64_tr_b16 v[80:81], v190 offset:51200
ds_read_b64_tr_b16 v[82:83], v190 offset:51712
ds_read_b64_tr_b16 v[84:85], v190 offset:52224
ds_read_b64_tr_b16 v[86:87], v190 offset:52736
ds_read_b64_tr_b16 v[88:89], v190 offset:53248
ds_read_b64_tr_b16 v[90:91], v190 offset:53760
ds_read_b64_tr_b16 v[92:93], v190 offset:54272
ds_read_b64_tr_b16 v[94:95], v190 offset:54784
s_waitcnt lgkmcnt(10)
ds_write_b128 v191, v[72:75] offset:49152
s_waitcnt lgkmcnt(9)
ds_write_b128 v191, v[76:79] offset:50176
s_waitcnt lgkmcnt(8)
ds_write_b128 v191, v[80:83] offset:51200
s_waitcnt lgkmcnt(7)
ds_write_b128 v191, v[84:87] offset:52224
s_waitcnt lgkmcnt(6)
ds_write_b128 v191, v[88:91] offset:53248
s_waitcnt lgkmcnt(5)
ds_write_b128 v191, v[92:95] offset:54272
s_waitcnt lgkmcnt(0)
s_setpc_b64 s[78:79]
Lpre:
ds_read_b128 v[48:51], v245
ds_read_b128 v[52:55], v245 offset:384
ds_read_b128 v[56:59], v245 offset:768
ds_read_b128 v[60:63], v245 offset:1152
ds_read_b128 v[64:67], v245 offset:1536
ds_read_b128 v[68:71], v245 offset:1920
ds_read_b128 v[72:75], v245 offset:2304
ds_read_b128 v[76:79], v245 offset:2688
ds_read_b128 v[80:83], v245 offset:3072
ds_read_b128 v[84:87], v245 offset:3456
ds_read_b128 v[88:91], v245 offset:3840
ds_read_b128 v[92:95], v245 offset:4224
ds_read_b128 v[96:99], v245 offset:4608
ds_read_b128 v[100:103], v245 offset:4992
ds_read_b128 v[104:107], v245 offset:5376
ds_read_b128 v[108:111], v245 offset:5760
ds_read_b128 v[112:115], v245 offset:6144
ds_read_b128 v[116:119], v245 offset:6528
v_mov_b32 v0, 0
v_mov_b32 v1, 0
v_mov_b32 v2, 0
v_mov_b32 v3, 0
v_mov_b32 v4, 0
v_mov_b32 v5, 0
v_mov_b32 v6, 0
v_mov_b32 v7, 0
v_mov_b32 v8, 0
v_mov_b32 v9, 0
v_mov_b32 v10, 0
v_mov_b32 v11, 0
v_mov_b32 v12, 0
v_mov_b32 v13, 0
v_mov_b32 v14, 0
v_mov_b32 v15, 0
v_mov_b32 v16, 0
v_mov_b32 v17, 0
v_mov_b32 v18, 0
v_mov_b32 v19, 0
v_mov_b32 v20, 0
v_mov_b32 v21, 0
v_mov_b32 v22, 0
v_mov_b32 v23, 0
v_mov_b32 v24, 0
v_mov_b32 v25, 0
v_mov_b32 v26, 0
v_mov_b32 v27, 0
v_mov_b32 v28, 0
v_mov_b32 v29, 0
v_mov_b32 v30, 0
v_mov_b32 v31, 0
v_mov_b32 v32, 0
v_mov_b32 v33, 0
v_mov_b32 v34, 0
v_mov_b32 v35, 0
v_mov_b32 v36, 0
v_mov_b32 v37, 0
v_mov_b32 v38, 0
v_mov_b32 v39, 0
v_mov_b32 v40, 0
v_mov_b32 v41, 0
v_mov_b32 v42, 0
v_mov_b32 v43, 0
v_mov_b32 v44, 0
v_mov_b32 v45, 0
v_mov_b32 v46, 0
v_mov_b32 v47, 0
s_waitcnt lgkmcnt(0)
s_setpc_b64 s[78:79]
Lrb:
s_add_u32 m0, s67, 39936
s_add_u32 s45, s66, 491520
buffer_load_dwordx4 v240, s[4:7], s45 offen nt lds
s_add_u32 m0, s67, 46592
s_add_u32 s45, s66, 589824
buffer_load_dwordx4 v240, s[4:7], s45 offen nt lds
s_add_u32 m0, s67, 53248
s_add_u32 s45, s66, 688128
buffer_load_dwordx4 v240, s[4:7], s45 offen nt lds
s_add_u32 m0, s67, 59904
s_add_u32 s45, s66, 786432
buffer_load_dwordx4 v240, s[4:7], s45 offen nt lds
s_setpc_b64 s[78:79]
Lw1f:
s_add_u32 m0, s77, 0
s_add_u32 s43, s3, 0
buffer_load_dwordx4 v189, s[12:15], s43 offen lds
s_add_u32 m0, s77, 1024
s_add_u32 s43, s3, 24576
buffer_load_dwordx4 v189, s[12:15], s43 offen lds
s_add_u32 m0, s77, 2048
s_add_u32 s43, s3, 49152
buffer_load_dwordx4 v189, s[12:15], s43 offen lds
s_add_u32 m0, s77, 3072
s_add_u32 s43, s3, 12288
buffer_load_dwordx4 v189, s[12:15], s43 offen lds
s_add_u32 m0, s77, 4096
s_add_u32 s43, s3, 36864
buffer_load_dwordx4 v189, s[12:15], s43 offen lds
s_add_u32 m0, s77, 5120
s_add_u32 s43, s3, 61440
buffer_load_dwordx4 v189, s[12:15], s43 offen lds
s_setpc_b64 s[78:79]
Lgo:
v_mov_b32 v253, 16256
Lsw204w:
ds_read_b32 v247, v253 offset:20
s_waitcnt lgkmcnt(0)
v_readfirstlane_b32 s43, v247
s_cmp_eq_u32 s76, 0
s_cbranch_scc1 Lsw204x
s_sub_u32 s76, s76, 1
s_cmp_lt_u32 s43, 4
s_cbranch_scc0 Lsw204x
s_sleep 2
s_branch Lsw204w
Lsw204x:
s_cmp_lg_u32 s40, 7
s_cbranch_scc1 Lnopf
s_getpc_b64 s[74:75]
Lpc:
s_lshr_b32 s43, s2, 3
s_and_b32 s43, s43, 15
s_lshl_b32 s43, s43, 13
v_lshlrev_b32 v102, 7, v251
v_add_u32 v102, s43, v102
v_min_u32 v102, Lend-Lpc, v102
global_load_dword v255, v102, s[74:75]
Lnopf:
s_add_u32 s66, s66, 786432
ds_read_b128 v[224:227], v248 offset:16384
ds_read_b128 v[228:231], v248 offset:19456
ds_read_b128 v[232:235], v248 offset:17408
ds_read_b128 v[236:239], v248 offset:20480
ds_read_b128 v[216:219], v248 offset:18432
ds_read_b128 v[220:223], v248 offset:21504
s_setprio 2
s_waitcnt lgkmcnt(5)
v_mfma_f32_32x32x16_bf16 v[120:135], v[48:51], v[224:227], 0
s_waitcnt lgkmcnt(4)
ds_read_b128 v[224:227], v248 offset:22528
v_mfma_f32_32x32x16_bf16 v[120:135], v[52:55], v[228:231], v[120:135]
s_waitcnt lgkmcnt(4)
ds_read_b128 v[228:231], v248 offset:25600
v_mfma_f32_32x32x16_bf16 v[120:135], v[56:59], v[232:235], v[120:135]
s_waitcnt lgkmcnt(4)
ds_read_b128 v[232:235], v248 offset:23552
v_mfma_f32_32x32x16_bf16 v[120:135], v[60:63], v[236:239], v[120:135]
s_waitcnt lgkmcnt(4)
ds_read_b128 v[236:239], v248 offset:26624
v_mfma_f32_32x32x16_bf16 v[120:135], v[64:67], v[216:219], v[120:135]
s_waitcnt lgkmcnt(4)
ds_read_b128 v[216:219], v248 offset:24576
v_mfma_f32_32x32x16_bf16 v[120:135], v[68:71], v[220:223], v[120:135]
v_add_u32 v174, -36864, v242
v_subrev_u32 v175, 66560, v174
v_min_u32 v174, v174, v175
v_add_u32 v174, 90112, v174
v_sub_u32 v175, v174, v242
v_add_u32 v242, v175, v242
v_add_u32_e64 v243, v175, v243
v_add_u32 v244, v175, v244
s_nop 3
v_cvt_pkrtz_f16_f32 v137, v120, v121
v_cvt_pkrtz_f16_f32 v139, v122, v123
v_cvt_pkrtz_f16_f32 v141, v124, v125
v_cvt_pkrtz_f16_f32 v143, v126, v127
v_cvt_pkrtz_f16_f32 v177, v128, v129
v_cvt_pk_f16_f32 v155, v130, v131
v_cvt_pk_f16_f32 v152, v132, v133
v_cvt_pk_f16_f32 v149, v134, v135
s_waitcnt lgkmcnt(1)
ds_read_b128 v[220:223], v248 offset:27648
v_mfma_f32_32x32x16_bf16 v[120:135], v[48:51], v[224:227], 0
v_pk_fma_f16 v154, v155, v155, s48
v_and_b32 v137, s49, v137
v_pk_fma_f16 v151, v152, v152, s48
v_pk_fma_f16 v148, v149, v149, s48
v_bfe_u32 v136, v137, 2, 14
v_pk_mul_f16 v154, v155, v154
v_pk_mul_f16 v151, v152, v151
v_pk_mul_f16 v148, v149, v148
ds_read_b128 v[224:227], v248 offset:28672
ds_read_u16_d16 v136, v136
v_mfma_f32_32x32x16_bf16 v[120:135], v[52:55], v[228:231], v[120:135]
v_lshrrev_b32 v137, 18, v137
v_exp_f16 v153, v154
v_exp_f16 v150, v151
v_and_b32 v139, s49, v139
v_exp_f16_e64 v147, v148
v_bfe_u32 v138, v139, 2, 14
ds_read_b128 v[228:231], v248 offset:31744
ds_read_u16_d16_hi v137, v137
ds_read_u16_d16 v138, v138
v_mfma_f32_32x32x16_bf16 v[120:135], v[56:59], v[232:235], v[120:135]
v_exp_f16_sdwa v153, v154 dst_sel:WORD_1 dst_unused:UNUSED_PRESERVE src0_sel:WORD_1
v_lshrrev_b32_e64 v139, 18, v139
v_exp_f16_sdwa v150, v151 dst_sel:WORD_1 dst_unused:UNUSED_PRESERVE src0_sel:WORD_1
v_exp_f16_sdwa v147, v148 dst_sel:WORD_1 dst_unused:UNUSED_PRESERVE src0_sel:WORD_1
v_and_b32_e64 v141, s49, v141
ds_read_b128 v[232:235], v248 offset:29696
ds_read_u16_d16_hi v139, v139
v_mfma_f32_32x32x16_bf16 v[120:135], v[60:63], v[236:239], v[120:135]
v_pk_add_f16 v153, v153, 1.0 op_sel_hi:[1,0]
v_bfe_u32 v140, v141, 2, 14
v_pk_add_f16 v150, v150, 1.0 op_sel_hi:[1,0]
v_pk_add_f16 v147, v147, 1.0 op_sel_hi:[1,0]
v_rcp_f16 v154, v153
v_lshrrev_b32 v141, 18, v141
v_rcp_f16 v151, v150
s_waitcnt lgkmcnt(5)
ds_read_b128 v[236:239], v248 offset:32768
ds_read_u16_d16 v140, v140
ds_read_u16_d16_hi v141, v141
v_mfma_f32_32x32x16_bf16 v[120:135], v[64:67], v[216:219], v[120:135]
v_and_b32 v143, s49, v143
v_rcp_f16 v148, v147
v_bfe_u32 v142, v143, 2, 14
v_rcp_f16_sdwa v154, v153 dst_sel:WORD_1 dst_unused:UNUSED_PRESERVE src0_sel:WORD_1
v_rcp_f16_sdwa v151, v150 dst_sel:WORD_1 dst_unused:UNUSED_PRESERVE src0_sel:WORD_1
ds_read_b128 v[216:219], v248 offset:30720
ds_read_u16_d16 v142, v142
ds_read_b32 v247, v253 offset:16
v_mfma_f32_32x32x16_bf16 v[120:135], v[68:71], v[220:223], v[120:135]
v_lshrrev_b32_e64 v143, 18, v143
v_rcp_f16_sdwa v148, v147 dst_sel:WORD_1 dst_unused:UNUSED_PRESERVE src0_sel:WORD_1
v_and_b32_e64 v177, s49, v177
v_pk_mul_f16 v155, v155, v154
v_pk_mul_f16 v152, v152, v151
v_bfe_u32 v176, v177, 2, 14
v_pk_mul_f16 v149, v149, v148
v_fma_mix_f32 v156, v155, v155, 0 op_sel:[0,0,0] op_sel_hi:[1,1,0]
v_fma_mix_f32 v156, v155, v155, v156 op_sel:[1,1,0] op_sel_hi:[1,1,0]
v_lshrrev_b32_e64 v177, 18, v177
v_fma_mix_f32 v156, v152, v152, v156 op_sel:[0,0,0] op_sel_hi:[1,1,0]
v_fma_mix_f32 v156, v152, v152, v156 op_sel:[1,1,0] op_sel_hi:[1,1,0]
v_fma_mix_f32 v156, v149, v149, v156 op_sel:[0,0,0] op_sel_hi:[1,1,0]
v_fma_mix_f32 v156, v149, v149, v156 op_sel:[1,1,0] op_sel_hi:[1,1,0]
ds_read_u16_d16_hi v143, v143
ds_read_u16_d16 v176, v176
ds_read_u16_d16_hi v177, v177
s_waitcnt lgkmcnt(3)
v_readfirstlane_b32 s43, v247
s_nop 1
s_cmp_ge_u32 s43, 8
s_cbranch_scc1 Lev1
Lev1w:
s_sleep 1
ds_read_b32 v247, v253 offset:16
s_waitcnt lgkmcnt(0)
v_readfirstlane_b32 s43, v247
s_cmp_eq_u32 s76, 0
s_cbranch_scc1 Lev1
s_sub_u32 s76, s76, 1
s_cmp_lt_u32 s43, 8
s_cbranch_scc1 Lev1w
Lev1:
v_cvt_pkrtz_f16_f32 v179, v120, v121
v_cvt_pkrtz_f16_f32 v181, v122, v123
v_cvt_pkrtz_f16_f32 v183, v124, v125
v_cvt_pkrtz_f16_f32 v185, v126, v127
v_cvt_pkrtz_f16_f32 v187, v128, v129
v_cvt_pk_f16_f32 v155, v130, v131
v_cvt_pk_f16_f32 v152, v132, v133
v_cvt_pk_f16_f32 v149, v134, v135
s_add_u32 m0, s67, 0
s_add_u32 s66, s66, 98304
buffer_load_dwordx4 v240, s[4:7], s66 offen lds
ds_read_b128 v[220:223], v248 offset:33792
v_mfma_f32_32x32x16_bf16 v[120:135], v[48:51], v[224:227], 0
v_pk_fma_f16 v154, v155, v155, s48
v_and_b32_e64 v179, s49, v179
v_fma_mix_f32 v156, v136, v136, v156 op_sel:[0,0,0] op_sel_hi:[1,1,0]
v_pk_fma_f16 v151, v152, v152, s48
v_pk_fma_f16 v148, v149, v149, s48
v_bfe_u32 v178, v179, 2, 14
v_pk_mul_f16 v154, v155, v154
v_pk_mul_f16 v151, v152, v151
v_fma_mix_f32 v156, v137, v137, v156 op_sel:[1,1,0] op_sel_hi:[1,1,0]
v_lshrrev_b32_e64 v179, 18, v179
s_add_u32 m0, s67, 6656
s_add_u32 s66, s66, 98304
buffer_load_dwordx4 v240, s[4:7], s66 offen lds
ds_read_b128 v[224:227], v248 offset:34816
ds_read_u16_d16 v178, v178
ds_read_u16_d16_hi v179, v179
v_mfma_f32_32x32x16_bf16 v[120:135], v[52:55], v[228:231], v[120:135]
v_pk_mul_f16 v148, v149, v148
v_exp_f16 v153, v154
v_exp_f16 v150, v151
v_and_b32_e64 v181, s49, v181
v_fma_mix_f32 v156, v138, v138, v156 op_sel:[0,0,0] op_sel_hi:[1,1,0]
v_exp_f16_e64 v147, v148
v_bfe_u32 v180, v181, 2, 14
s_add_u32 m0, s67, 13312
s_add_u32 s66, s66, 98304
buffer_load_dwordx4 v240, s[4:7], s66 offen lds
ds_read_b128 v[228:231], v248 offset:37888
ds_read_u16_d16 v180, v180
v_mfma_f32_32x32x16_bf16 v[120:135], v[56:59], v[232:235], v[120:135]
v_exp_f16_sdwa v153, v154 dst_sel:WORD_1 dst_unused:UNUSED_PRESERVE src0_sel:WORD_1
v_lshrrev_b32_e64 v181, 18, v181
v_fma_mix_f32 v156, v139, v139, v156 op_sel:[1,1,0] op_sel_hi:[1,1,0]
v_exp_f16_sdwa v150, v151 dst_sel:WORD_1 dst_unused:UNUSED_PRESERVE src0_sel:WORD_1
v_exp_f16_sdwa v147, v148 dst_sel:WORD_1 dst_unused:UNUSED_PRESERVE src0_sel:WORD_1
v_and_b32_e64 v183, s49, v183
v_fma_mix_f32 v156, v140, v140, v156 op_sel:[0,0,0] op_sel_hi:[1,1,0]
s_add_u32 m0, s67, 19968
s_add_u32 s66, s66, 98304
buffer_load_dwordx4 v240, s[4:7], s66 offen lds
s_add_u32 m0, s67, 26624
s_add_u32 s66, s66, 98304
buffer_load_dwordx4 v240, s[4:7], s66 offen lds
ds_read_b128 v[232:235], v248 offset:35840
ds_read_u16_d16_hi v181, v181
v_mfma_f32_32x32x16_bf16 v[120:135], v[60:63], v[236:239], v[120:135]
v_pk_add_f16 v153, v153, 1.0 op_sel_hi:[1,0]
v_bfe_u32 v182, v183, 2, 14
v_pk_add_f16 v150, v150, 1.0 op_sel_hi:[1,0]
v_pk_add_f16 v147, v147, 1.0 op_sel_hi:[1,0]
v_rcp_f16 v154, v153
v_lshrrev_b32 v183, 18, v183
v_fma_mix_f32 v156, v141, v141, v156 op_sel:[1,1,0] op_sel_hi:[1,1,0]
v_rcp_f16_e64 v151, v150
s_add_u32 m0, s67, 33280
s_add_u32 s66, s66, 98304
buffer_load_dwordx4 v240, s[4:7], s66 offen lds
ds_read_b128 v[236:239], v248 offset:38912
ds_read_u16_d16 v182, v182
ds_read_u16_d16_hi v183, v183
v_mfma_f32_32x32x16_bf16 v[120:135], v[64:67], v[216:219], v[120:135]
v_and_b32 v185, s49, v185
v_rcp_f16 v148, v147
v_fma_mix_f32 v156, v142, v142, v156 op_sel:[0,0,0] op_sel_hi:[1,1,0]
v_bfe_u32 v184, v185, 2, 14
v_rcp_f16_sdwa v154, v153 dst_sel:WORD_1 dst_unused:UNUSED_PRESERVE src0_sel:WORD_1
v_rcp_f16_sdwa v151, v150 dst_sel:WORD_1 dst_unused:UNUSED_PRESERVE src0_sel:WORD_1
v_lshrrev_b32 v185, 18, v185
s_waitcnt lgkmcnt(4)
s_add_u32 m0, s67, 39936
s_add_u32 s66, s66, 98304
buffer_load_dwordx4 v240, s[4:7], s66 offen lds
ds_read_b128 v[216:219], v248 offset:36864
ds_read_u16_d16 v184, v184
ds_read_u16_d16_hi v185, v185
v_mfma_f32_32x32x16_bf16 v[120:135], v[68:71], v[220:223], v[120:135]
v_fma_mix_f32 v156, v143, v143, v156 op_sel:[1,1,0] op_sel_hi:[1,1,0]
v_rcp_f16_sdwa v148, v147 dst_sel:WORD_1 dst_unused:UNUSED_PRESERVE src0_sel:WORD_1
v_and_b32_e64 v187, s49, v187
v_pk_mul_f16 v155, v155, v154
v_fma_mix_f32 v156, v176, v176, v156 op_sel:[0,0,0] op_sel_hi:[1,1,0]
v_pk_mul_f16 v152, v152, v151
v_bfe_u32 v186, v187, 2, 14
v_pk_mul_f16 v149, v149, v148
v_fma_mix_f32 v157, v155, v155, 0 op_sel:[0,0,0] op_sel_hi:[1,1,0]
s_add_u32 m0, s67, 46592
s_add_u32 s66, s66, 98304
buffer_load_dwordx4 v240, s[4:7], s66 offen lds
v_fma_mix_f32 v157, v155, v155, v157 op_sel:[1,1,0] op_sel_hi:[1,1,0]
v_lshrrev_b32 v187, 18, v187
v_fma_mix_f32 v156, v177, v177, v156 op_sel:[1,1,0] op_sel_hi:[1,1,0]
v_fma_mix_f32 v157, v152, v152, v157 op_sel:[0,0,0] op_sel_hi:[1,1,0]
v_fma_mix_f32 v157, v152, v152, v157 op_sel:[1,1,0] op_sel_hi:[1,1,0]
v_fma_mix_f32 v157, v149, v149, v157 op_sel:[0,0,0] op_sel_hi:[1,1,0]
v_fma_mix_f32 v157, v149, v149, v157 op_sel:[1,1,0] op_sel_hi:[1,1,0]
s_cmp_lt_u32 s40, 4
s_cbranch_scc0 Lsu5
s_waitcnt vmcnt(14)
s_call_b64 s[78:79], Lw1b
s_mov_b64 exec, 1
ds_add_u32 v253, v254 offset:24
s_mov_b64 exec, -1
Lsu5:
s_setprio 1
v_cvt_pkrtz_f16_f32 v137, v120, v121
v_cvt_pkrtz_f16_f32 v139, v122, v123
v_cvt_pkrtz_f16_f32 v141, v124, v125
v_cvt_pkrtz_f16_f32 v143, v126, v127
v_cvt_pkrtz_f16_f32 v177, v128, v129
v_cvt_pk_f16_f32 v155, v130, v131
v_cvt_pk_f16_f32 v152, v132, v133
v_cvt_pk_f16_f32 v149, v134, v135
ds_read_b128 v[220:223], v248 offset:39936
ds_read_u16_d16 v186, v186
ds_read_u16_d16_hi v187, v187
v_mfma_f32_32x32x16_bf16 v[120:135], v[48:51], v[224:227], 0
v_pk_fma_f16 v154, v155, v155, s48
v_and_b32_e64 v137, s49, v137
v_fma_mix_f32 v157, v178, v178, v157 op_sel:[0,0,0] op_sel_hi:[1,1,0]
v_pk_fma_f16 v151, v152, v152, s48
v_pk_fma_f16 v148, v149, v149, s48
v_bfe_u32 v136, v137, 2, 14
v_pk_mul_f16 v154, v155, v154
v_pk_mul_f16 v151, v152, v151
v_fma_mix_f32 v157, v179, v179, v157 op_sel:[1,1,0] op_sel_hi:[1,1,0]
v_lshrrev_b32_e64 v137, 18, v137
ds_read_u16_d16 v136, v136
ds_read_b32 v247, v253 offset:24
ds_read_u16_d16_hi v137, v137
v_mfma_f32_32x32x16_bf16 v[120:135], v[52:55], v[228:231], v[120:135]
v_pk_mul_f16 v148, v149, v148
v_exp_f16 v153, v154
v_exp_f16 v150, v151
v_and_b32_e64 v139, s49, v139
v_fma_mix_f32 v157, v180, v180, v157 op_sel:[0,0,0] op_sel_hi:[1,1,0]
v_exp_f16_e64 v147, v148
v_bfe_u32 v138, v139, 2, 14
ds_read_u16_d16 v138, v138
v_mfma_f32_32x32x16_bf16 v[120:135], v[56:59], v[232:235], v[120:135]
v_exp_f16_sdwa v153, v154 dst_sel:WORD_1 dst_unused:UNUSED_PRESERVE src0_sel:WORD_1
v_lshrrev_b32 v139, 18, v139
s_waitcnt lgkmcnt(4)
v_fma_mix_f32 v157, v181, v181, v157 op_sel:[1,1,0] op_sel_hi:[1,1,0]
v_exp_f16_sdwa v150, v151 dst_sel:WORD_1 dst_unused:UNUSED_PRESERVE src0_sel:WORD_1
v_exp_f16_sdwa v147, v148 dst_sel:WORD_1 dst_unused:UNUSED_PRESERVE src0_sel:WORD_1
v_and_b32 v141, s49, v141
v_fma_mix_f32 v157, v182, v182, v157 op_sel:[0,0,0] op_sel_hi:[1,1,0]
ds_read_u16_d16_hi v139, v139
s_waitcnt lgkmcnt(3)
v_readfirstlane_b32 s43, v247
s_nop 1
s_cmp_ge_u32 s43, 4
s_cbranch_scc1 Lev2
Lev2w:
s_sleep 1
ds_read_b32 v247, v253 offset:24
s_waitcnt lgkmcnt(0)
v_readfirstlane_b32 s43, v247
s_cmp_eq_u32 s76, 0
s_cbranch_scc1 Lev2
s_sub_u32 s76, s76, 1
s_cmp_lt_u32 s43, 4
s_cbranch_scc1 Lev2w
Lev2:
ds_read_b128 v[224:227], v248 offset:40960
ds_read_b128 v[228:231], v248 offset:44032
ds_read_b128 v[232:235], v248 offset:41984
v_mfma_f32_32x32x16_bf16 v[120:135], v[60:63], v[236:239], v[120:135]
v_pk_add_f16 v153, v153, 1.0 op_sel_hi:[1,0]
v_bfe_u32 v140, v141, 2, 14
v_pk_add_f16 v150, v150, 1.0 op_sel_hi:[1,0]
v_pk_add_f16 v147, v147, 1.0 op_sel_hi:[1,0]
v_rcp_f16 v154, v153
v_lshrrev_b32 v141, 18, v141
v_fma_mix_f32 v157, v183, v183, v157 op_sel:[1,1,0] op_sel_hi:[1,1,0]
v_rcp_f16_e64 v151, v150
ds_read_b128 v[236:239], v248 offset:45056
ds_read_u16_d16 v140, v140
ds_read_u16_d16_hi v141, v141
v_mfma_f32_32x32x16_bf16 v[120:135], v[64:67], v[216:219], v[120:135]
v_and_b32 v143, s49, v143
v_rcp_f16 v148, v147
v_fma_mix_f32 v157, v184, v184, v157 op_sel:[0,0,0] op_sel_hi:[1,1,0]
v_bfe_u32 v142, v143, 2, 14
v_rcp_f16_sdwa v154, v153 dst_sel:WORD_1 dst_unused:UNUSED_PRESERVE src0_sel:WORD_1
v_rcp_f16_sdwa v151, v150 dst_sel:WORD_1 dst_unused:UNUSED_PRESERVE src0_sel:WORD_1
v_lshrrev_b32_e64 v143, 18, v143
ds_read_b128 v[216:219], v248 offset:43008
ds_read_u16_d16 v142, v142
ds_read_u16_d16_hi v143, v143
v_mfma_f32_32x32x16_bf16 v[120:135], v[68:71], v[220:223], v[120:135]
v_fma_mix_f32 v157, v185, v185, v157 op_sel:[1,1,0] op_sel_hi:[1,1,0]
v_rcp_f16_sdwa v148, v147 dst_sel:WORD_1 dst_unused:UNUSED_PRESERVE src0_sel:WORD_1
v_and_b32_e64 v177, s49, v177
v_pk_mul_f16 v155, v155, v154
v_fma_mix_f32 v157, v186, v186, v157 op_sel:[0,0,0] op_sel_hi:[1,1,0]
v_pk_mul_f16 v152, v152, v151
v_bfe_u32 v176, v177, 2, 14
v_pk_mul_f16 v149, v149, v148
v_fma_mix_f32 v158, v155, v155, 0 op_sel:[0,0,0] op_sel_hi:[1,1,0]
v_fma_mix_f32 v158, v155, v155, v158 op_sel:[1,1,0] op_sel_hi:[1,1,0]
v_lshrrev_b32_e64 v177, 18, v177
v_fma_mix_f32 v157, v187, v187, v157 op_sel:[1,1,0] op_sel_hi:[1,1,0]
v_fma_mix_f32 v158, v152, v152, v158 op_sel:[0,0,0] op_sel_hi:[1,1,0]
v_fma_mix_f32 v158, v152, v152, v158 op_sel:[1,1,0] op_sel_hi:[1,1,0]
v_fma_mix_f32 v158, v149, v149, v158 op_sel:[0,0,0] op_sel_hi:[1,1,0]
v_fma_mix_f32 v158, v149, v149, v158 op_sel:[1,1,0] op_sel_hi:[1,1,0]
v_cvt_pkrtz_f16_f32 v179, v120, v121
v_cvt_pkrtz_f16_f32 v181, v122, v123
v_cvt_pkrtz_f16_f32 v183, v124, v125
v_cvt_pkrtz_f16_f32 v185, v126, v127
v_cvt_pkrtz_f16_f32 v187, v128, v129
v_cvt_pk_f16_f32 v155, v130, v131
v_cvt_pk_f16_f32 v152, v132, v133
v_cvt_pk_f16_f32 v149, v134, v135
s_waitcnt lgkmcnt(0)
ds_read_b128 v[220:223], v248 offset:46080
ds_read_u16_d16 v176, v176
ds_read_u16_d16_hi v177, v177
v_mfma_f32_32x32x16_bf16 v[120:135], v[48:51], v[224:227], 0
v_pk_fma_f16 v154, v155, v155, s48
v_and_b32 v179, s49, v179
v_fma_mix_f32 v158, v136, v136, v158 op_sel:[0,0,0] op_sel_hi:[1,1,0]
v_pk_fma_f16 v151, v152, v152, s48
v_pk_fma_f16 v148, v149, v149, s48
v_bfe_u32 v178, v179, 2, 14
v_pk_mul_f16 v154, v155, v154
v_pk_mul_f16 v151, v152, v151
v_fma_mix_f32 v158, v137, v137, v158 op_sel:[1,1,0] op_sel_hi:[1,1,0]
v_lshrrev_b32_e64 v179, 18, v179
ds_read_b128 v[224:227], v248 offset:47104
ds_read_u16_d16 v178, v178
ds_read_u16_d16_hi v179, v179
v_mfma_f32_32x32x16_bf16 v[120:135], v[52:55], v[228:231], v[120:135]
v_pk_mul_f16 v148, v149, v148
v_exp_f16 v153, v154
v_exp_f16 v150, v151
v_and_b32_e64 v181, s49, v181
v_fma_mix_f32 v158, v138, v138, v158 op_sel:[0,0,0] op_sel_hi:[1,1,0]
v_exp_f16_e64 v147, v148
v_bfe_u32 v180, v181, 2, 14
ds_read_b128 v[228:231], v248 offset:50176
ds_read_u16_d16 v180, v180
v_mfma_f32_32x32x16_bf16 v[120:135], v[56:59], v[232:235], v[120:135]
v_exp_f16_sdwa v153, v154 dst_sel:WORD_1 dst_unused:UNUSED_PRESERVE src0_sel:WORD_1
v_lshrrev_b32_e64 v181, 18, v181
v_fma_mix_f32 v158, v139, v139, v158 op_sel:[1,1,0] op_sel_hi:[1,1,0]
v_exp_f16_sdwa v150, v151 dst_sel:WORD_1 dst_unused:UNUSED_PRESERVE src0_sel:WORD_1
v_exp_f16_sdwa v147, v148 dst_sel:WORD_1 dst_unused:UNUSED_PRESERVE src0_sel:WORD_1
v_and_b32_e64 v183, s49, v183
v_fma_mix_f32 v158, v140, v140, v158 op_sel:[0,0,0] op_sel_hi:[1,1,0]
ds_read_b128 v[232:235], v248 offset:48128
ds_read_u16_d16_hi v181, v181
v_mfma_f32_32x32x16_bf16 v[120:135], v[60:63], v[236:239], v[120:135]
v_pk_add_f16 v153, v153, 1.0 op_sel_hi:[1,0]
v_bfe_u32 v182, v183, 2, 14
v_pk_add_f16 v150, v150, 1.0 op_sel_hi:[1,0]
v_pk_add_f16 v147, v147, 1.0 op_sel_hi:[1,0]
v_rcp_f16 v154, v153
v_lshrrev_b32 v183, 18, v183
v_fma_mix_f32 v158, v141, v141, v158 op_sel:[1,1,0] op_sel_hi:[1,1,0]
v_rcp_f16_e64 v151, v150
ds_read_b128 v[236:239], v248 offset:51200
ds_read_u16_d16 v182, v182
ds_read_u16_d16_hi v183, v183
v_mfma_f32_32x32x16_bf16 v[120:135], v[64:67], v[216:219], v[120:135]
v_and_b32 v185, s49, v185
v_rcp_f16 v148, v147
v_fma_mix_f32 v158, v142, v142, v158 op_sel:[0,0,0] op_sel_hi:[1,1,0]
v_bfe_u32 v184, v185, 2, 14
v_rcp_f16_sdwa v154, v153 dst_sel:WORD_1 dst_unused:UNUSED_PRESERVE src0_sel:WORD_1
v_rcp_f16_sdwa v151, v150 dst_sel:WORD_1 dst_unused:UNUSED_PRESERVE src0_sel:WORD_1
v_lshrrev_b32 v185, 18, v185
s_waitcnt lgkmcnt(5)
ds_read_b128 v[216:219], v248 offset:49152
ds_read_u16_d16 v184, v184
ds_read_u16_d16_hi v185, v185
v_mfma_f32_32x32x16_bf16 v[120:135], v[68:71], v[220:223], v[120:135]
v_fma_mix_f32 v158, v143, v143, v158 op_sel:[1,1,0] op_sel_hi:[1,1,0]
v_rcp_f16_sdwa v148, v147 dst_sel:WORD_1 dst_unused:UNUSED_PRESERVE src0_sel:WORD_1
s_cmp_eq_u32 s40, 7
s_cbranch_scc1 Lrdy8
s_waitcnt vmcnt(0)
Lrdy8:
s_mov_b64 exec, 1
ds_add_u32 v253, v254 offset:12
s_mov_b64 exec, -1
v_and_b32 v187, s49, v187
v_pk_mul_f16 v155, v155, v154
v_fma_mix_f32 v158, v176, v176, v158 op_sel:[0,0,0] op_sel_hi:[1,1,0]
v_pk_mul_f16 v152, v152, v151
v_bfe_u32 v186, v187, 2, 14
v_pk_mul_f16 v149, v149, v148
v_fma_mix_f32 v159, v155, v155, 0 op_sel:[0,0,0] op_sel_hi:[1,1,0]
v_fma_mix_f32 v159, v155, v155, v159 op_sel:[1,1,0] op_sel_hi:[1,1,0]
v_lshrrev_b32_e64 v187, 18, v187
v_fma_mix_f32 v158, v177, v177, v158 op_sel:[1,1,0] op_sel_hi:[1,1,0]
v_fma_mix_f32 v159, v152, v152, v159 op_sel:[0,0,0] op_sel_hi:[1,1,0]
v_fma_mix_f32 v159, v152, v152, v159 op_sel:[1,1,0] op_sel_hi:[1,1,0]
v_fma_mix_f32 v159, v149, v149, v159 op_sel:[0,0,0] op_sel_hi:[1,1,0]
v_fma_mix_f32 v159, v149, v149, v159 op_sel:[1,1,0] op_sel_hi:[1,1,0]
s_cmp_lt_u32 s40, 4
s_cbranch_scc0 Lsu6
s_waitcnt vmcnt(8)
s_call_b64 s[78:79], Lw1c
s_mov_b64 exec, 1
ds_add_u32 v253, v254 offset:28
s_mov_b64 exec, -1
Lsu6:
v_cvt_pkrtz_f16_f32 v137, v120, v121
v_cvt_pkrtz_f16_f32 v139, v122, v123
v_cvt_pkrtz_f16_f32 v141, v124, v125
v_cvt_pkrtz_f16_f32 v143, v126, v127
v_cvt_pkrtz_f16_f32 v177, v128, v129
v_cvt_pk_f16_f32 v155, v130, v131
v_cvt_pk_f16_f32 v152, v132, v133
v_cvt_pk_f16_f32 v149, v134, v135
s_setprio 0
ds_read_b128 v[220:223], v248 offset:52224
ds_read_u16_d16 v186, v186
ds_read_u16_d16_hi v187, v187
v_mfma_f32_32x32x16_bf16 v[120:135], v[48:51], v[224:227], 0
v_pk_fma_f16 v154, v155, v155, s48
v_and_b32 v137, s49, v137
v_fma_mix_f32 v159, v178, v178, v159 op_sel:[0,0,0] op_sel_hi:[1,1,0]
v_pk_fma_f16 v151, v152, v152, s48
v_pk_fma_f16 v148, v149, v149, s48
v_bfe_u32 v136, v137, 2, 14
v_pk_mul_f16 v154, v155, v154
v_pk_mul_f16 v151, v152, v151
v_fma_mix_f32 v159, v179, v179, v159 op_sel:[1,1,0] op_sel_hi:[1,1,0]
v_lshrrev_b32_e64 v137, 18, v137
ds_read_b128 v[224:227], v250 offset:65520
ds_read_u16_d16 v136, v136
ds_read_u16_d16_hi v137, v137
v_mfma_f32_32x32x16_bf16 v[120:135], v[52:55], v[228:231], v[120:135]
v_pk_mul_f16 v148, v149, v148
v_exp_f16 v153, v154
v_exp_f16 v150, v151
v_and_b32_e64 v139, s49, v139
v_fma_mix_f32 v159, v180, v180, v159 op_sel:[0,0,0] op_sel_hi:[1,1,0]
v_exp_f16 v147, v148
v_bfe_u32 v138, v139, 2, 14
s_waitcnt lgkmcnt(7)
ds_read_b128 v[228:231], v248 offset:53248
ds_read_b32 v247, v253 offset:12
ds_read_u16_d16 v138, v138
v_mfma_f32_32x32x16_bf16 v[120:135], v[56:59], v[232:235], v[120:135]
v_exp_f16_sdwa v153, v154 dst_sel:WORD_1 dst_unused:UNUSED_PRESERVE src0_sel:WORD_1
v_lshrrev_b32_e64 v139, 18, v139
v_fma_mix_f32 v159, v181, v181, v159 op_sel:[1,1,0] op_sel_hi:[1,1,0]
v_exp_f16_sdwa v150, v151 dst_sel:WORD_1 dst_unused:UNUSED_PRESERVE src0_sel:WORD_1
v_exp_f16_sdwa v147, v148 dst_sel:WORD_1 dst_unused:UNUSED_PRESERVE src0_sel:WORD_1
v_and_b32_e64 v141, s49, v141
v_fma_mix_f32 v159, v182, v182, v159 op_sel:[0,0,0] op_sel_hi:[1,1,0]
ds_read_b128 v[232:235], v248 offset:56320
ds_read_u16_d16_hi v139, v139
v_mfma_f32_32x32x16_bf16 v[120:135], v[60:63], v[236:239], v[120:135]
v_pk_add_f16 v153, v153, 1.0 op_sel_hi:[1,0]
v_bfe_u32 v140, v141, 2, 14
v_pk_add_f16 v150, v150, 1.0 op_sel_hi:[1,0]
v_pk_add_f16 v147, v147, 1.0 op_sel_hi:[1,0]
v_rcp_f16 v154, v153
v_lshrrev_b32 v141, 18, v141
ds_read_u16_d16 v140, v140
ds_read_u16_d16_hi v141, v141
s_waitcnt lgkmcnt(5)
v_readfirstlane_b32 s43, v247
s_nop 1
s_cmp_ge_u32 s43, 16
s_cbranch_scc1 Lev3
Lev3w:
s_sleep 1
ds_read_b32 v247, v253 offset:12
s_waitcnt lgkmcnt(0)
v_readfirstlane_b32 s43, v247
s_cmp_eq_u32 s76, 0
s_cbranch_scc1 Lev3
s_sub_u32 s76, s76, 1
s_cmp_lt_u32 s43, 16
s_cbranch_scc1 Lev3w
Lev3:
v_fma_mix_f32 v159, v183, v183, v159 op_sel:[1,1,0] op_sel_hi:[1,1,0]
v_rcp_f16 v151, v150
ds_read_b128 v[236:239], v245 offset:6528
ds_read_b128 v[192:195], v244 offset:128
ds_read_b128 v[196:199], v244 offset:64
v_mfma_f32_32x32x16_bf16 v[120:135], v[64:67], v[216:219], v[120:135]
v_and_b32 v143, s49, v143
v_rcp_f16 v148, v147
v_fma_mix_f32 v159, v184, v184, v159 op_sel:[0,0,0] op_sel_hi:[1,1,0]
v_bfe_u32 v142, v143, 2, 14
v_rcp_f16_sdwa v154, v153 dst_sel:WORD_1 dst_unused:UNUSED_PRESERVE src0_sel:WORD_1
v_rcp_f16_sdwa v151, v150 dst_sel:WORD_1 dst_unused:UNUSED_PRESERVE src0_sel:WORD_1
v_lshrrev_b32_e64 v143, 18, v143
ds_read_b128 v[216:219], v248 offset:54272
ds_read_u16_d16 v142, v142
ds_read_u16_d16_hi v143, v143
v_mfma_f32_32x32x16_bf16 v[120:135], v[68:71], v[220:223], v[120:135]
v_fma_mix_f32 v159, v185, v185, v159 op_sel:[1,1,0] op_sel_hi:[1,1,0]
v_rcp_f16_sdwa v148, v147 dst_sel:WORD_1 dst_unused:UNUSED_PRESERVE src0_sel:WORD_1
v_and_b32_e64 v177, s49, v177
v_pk_mul_f16 v155, v155, v154
v_fma_mix_f32 v159, v186, v186, v159 op_sel:[0,0,0] op_sel_hi:[1,1,0]
v_pk_mul_f16 v152, v152, v151
v_bfe_u32 v176, v177, 2, 14
v_pk_mul_f16 v149, v149, v148
v_fma_mix_f32 v160, v155, v155, 0 op_sel:[0,0,0] op_sel_hi:[1,1,0]
v_fma_mix_f32 v160, v155, v155, v160 op_sel:[1,1,0] op_sel_hi:[1,1,0]
v_lshrrev_b32 v177, 18, v177
v_fma_mix_f32 v159, v187, v187, v159 op_sel:[1,1,0] op_sel_hi:[1,1,0]
v_fma_mix_f32 v160, v152, v152, v160 op_sel:[0,0,0] op_sel_hi:[1,1,0]
v_fma_mix_f32 v160, v152, v152, v160 op_sel:[1,1,0] op_sel_hi:[1,1,0]
v_fma_mix_f32 v160, v149, v149, v160 op_sel:[0,0,0] op_sel_hi:[1,1,0]
v_fma_mix_f32 v160, v149, v149, v160 op_sel:[1,1,0] op_sel_hi:[1,1,0]
s_setprio 2
v_mfma_f32_32x32x16_bf16 v[0:15], v[224:227], v[224:227], 0
ds_read_b128 v[220:223], v245 offset:6144
ds_read_b128 v[200:203], v244
ds_read_b128 v[204:207], v243 offset:128
ds_read_u16_d16 v176, v176
ds_read_u16_d16_hi v177, v177
v_cvt_pkrtz_f16_f32 v179, v120, v121
v_cvt_pkrtz_f16_f32 v181, v122, v123
v_cvt_pkrtz_f16_f32 v183, v124, v125
v_mfma_f32_32x32x16_bf16 v[16:31], v[224:227], v[224:227], 0
v_cvt_pkrtz_f16_f32 v185, v126, v127
v_cvt_pkrtz_f16_f32 v187, v128, v129
v_cvt_pk_f16_f32 v155, v130, v131
v_mfma_f32_32x32x16_bf16 v[32:47], v[224:227], v[224:227], 0
v_cvt_pk_f16_f32 v152, v132, v133
v_cvt_pk_f16_f32 v149, v134, v135
v_pk_fma_f16 v154, v155, v155, s48
v_mfma_f32_32x32x16_bf16 v[120:135], v[48:51], v[228:231], 0
ds_read_b128 v[224:227], v248 offset:57344
v_and_b32 v179, s49, v179
v_fma_mix_f32 v160, v136, v136, v160 op_sel:[0,0,0] op_sel_hi:[1,1,0]
v_pk_fma_f16 v151, v152, v152, s48
v_pk_fma_f16 v148, v149, v149, s48
v_bfe_u32 v178, v179, 2, 14
v_pk_mul_f16 v154, v155, v154
s_waitcnt lgkmcnt(6)
v_mfma_f32_32x32x16_bf16 v[120:135], v[52:55], v[232:235], v[120:135]
ds_read_b128 v[228:231], v245 offset:5760
ds_read_b128 v[208:211], v243 offset:64
ds_read_b128 v[212:215], v243
ds_read_u16_d16 v178, v178
v_pk_mul_f16 v151, v152, v151
v_fma_mix_f32 v160, v137, v137, v160 op_sel:[1,1,0] op_sel_hi:[1,1,0]
v_lshrrev_b32_e64 v179, 18, v179
v_pk_mul_f16 v148, v149, v148
v_exp_f16_e64 v153, v154
v_smfmac_f32_16x16x32_bf16 v[40:43], v[238:239], v[192:195], v246
ds_read_b128 v[232:235], v248 offset:55296
ds_read_u16_d16_hi v179, v179
v_exp_f16 v150, v151
v_and_b32 v181, s49, v181
v_smfmac_f32_16x16x32_bf16 v[24:27], v[236:237], v[196:199], v246
v_fma_mix_f32 v160, v138, v138, v160 op_sel:[0,0,0] op_sel_hi:[1,1,0]
v_exp_f16_e64 v147, v148
v_mfma_f32_32x32x16_bf16 v[120:135], v[56:59], v[216:219], v[120:135]
ds_read_b128 v[236:239], v245 offset:5376
ds_read_b128 v[192:195], v242 offset:128
ds_read_b128 v[196:199], v242 offset:64
v_bfe_u32 v180, v181, 2, 14
v_exp_f16_sdwa v153, v154 dst_sel:WORD_1 dst_unused:UNUSED_PRESERVE src0_sel:WORD_1
v_lshrrev_b32 v181, 18, v181
v_fma_mix_f32 v160, v139, v139, v160 op_sel:[1,1,0] op_sel_hi:[1,1,0]
s_waitcnt lgkmcnt(8)
v_smfmac_f32_16x16x32_bf16 v[8:11], v[222:223], v[200:203], v246
ds_read_b128 v[216:219], v248 offset:58368
ds_read_u16_d16 v180, v180
ds_read_u16_d16_hi v181, v181
v_exp_f16_sdwa v150, v151 dst_sel:WORD_1 dst_unused:UNUSED_PRESERVE src0_sel:WORD_1
v_exp_f16_sdwa v147, v148 dst_sel:WORD_1 dst_unused:UNUSED_PRESERVE src0_sel:WORD_1
v_smfmac_f32_16x16x32_bf16 v[40:43], v[220:221], v[204:207], v246
v_and_b32_e64 v183, s49, v183
v_fma_mix_f32 v160, v140, v140, v160 op_sel:[0,0,0] op_sel_hi:[1,1,0]
v_pk_add_f16 v153, v153, 1.0 op_sel_hi:[1,0]
v_mfma_f32_32x32x16_bf16 v[120:135], v[60:63], v[224:227], v[120:135]
ds_read_b128 v[220:223], v245 offset:4992
ds_read_b128 v[200:203], v242
v_xor_b32 v244, 16, v244
ds_read_b128 v[204:207], v244 offset:128
v_bfe_u32 v182, v183, 2, 14
v_pk_add_f16 v150, v150, 1.0 op_sel_hi:[1,0]
v_pk_add_f16 v147, v147, 1.0 op_sel_hi:[1,0]
v_rcp_f16 v154, v153
v_lshrrev_b32 v183, 18, v183
s_waitcnt lgkmcnt(6)
v_smfmac_f32_16x16x32_bf16 v[24:27], v[230:231], v[208:211], v246
ds_read_b128 v[224:227], v245 offset:4608
ds_read_u16_d16 v182, v182
ds_read_u16_d16_hi v183, v183
v_fma_mix_f32 v160, v141, v141, v160 op_sel:[1,1,0] op_sel_hi:[1,1,0]
v_rcp_f16_e64 v151, v150
v_smfmac_f32_16x16x32_bf16 v[8:11], v[228:229], v[212:215], v246
v_and_b32 v185, s49, v185
v_rcp_f16 v148, v147
v_mfma_f32_32x32x16_bf16 v[120:135], v[64:67], v[232:235], v[120:135]
ds_read_b128 v[208:211], v244 offset:64
ds_read_b128 v[212:215], v244
ds_read_b128 v[228:231], v248 offset:59392
v_fma_mix_f32 v160, v142, v142, v160 op_sel:[0,0,0] op_sel_hi:[1,1,0]
v_bfe_u32 v184, v185, 2, 14
v_rcp_f16_sdwa v154, v153 dst_sel:WORD_1 dst_unused:UNUSED_PRESERVE src0_sel:WORD_1
v_rcp_f16_sdwa v151, v150 dst_sel:WORD_1 dst_unused:UNUSED_PRESERVE src0_sel:WORD_1
v_smfmac_f32_16x16x32_bf16 v[40:43], v[238:239], v[192:195], v246
ds_read_b128 v[232:235], v248 offset:62464
ds_read_u16_d16 v184, v184
ds_read_b32 v247, v253 offset:28
v_lshrrev_b32_e64 v185, 18, v185
v_fma_mix_f32 v160, v143, v143, v160 op_sel:[1,1,0] op_sel_hi:[1,1,0]
v_smfmac_f32_16x16x32_bf16 v[24:27], v[236:237], v[196:199], v246
v_rcp_f16_sdwa v148, v147 dst_sel:WORD_1 dst_unused:UNUSED_PRESERVE src0_sel:WORD_1
v_and_b32 v187, s49, v187
v_pk_mul_f16 v155, v155, v154
s_waitcnt lgkmcnt(7)
v_mfma_f32_32x32x16_bf16 v[120:135], v[68:71], v[216:219], v[120:135]
ds_read_b128 v[236:239], v248 offset:60416
ds_read_u16_d16_hi v185, v185
v_fma_mix_f32 v160, v176, v176, v160 op_sel:[0,0,0] op_sel_hi:[1,1,0]
v_pk_mul_f16 v152, v152, v151
v_bfe_u32 v186, v187, 2, 14
v_pk_mul_f16 v149, v149, v148
v_fma_mix_f32 v161, v155, v155, 0 op_sel:[0,0,0] op_sel_hi:[1,1,0]
v_fma_mix_f32 v161, v155, v155, v161 op_sel:[1,1,0] op_sel_hi:[1,1,0]
v_smfmac_f32_16x16x32_bf16 v[8:11], v[222:223], v[200:203], v246
ds_read_b128 v[216:219], v245 offset:4224
v_xor_b32 v243, 16, v243
ds_read_b128 v[192:195], v243 offset:128
ds_read_b128 v[196:199], v243 offset:64
ds_read_u16_d16 v186, v186
v_lshrrev_b32 v187, 18, v187
v_fma_mix_f32 v160, v177, v177, v160 op_sel:[1,1,0] op_sel_hi:[1,1,0]
v_fma_mix_f32 v161, v152, v152, v161 op_sel:[0,0,0] op_sel_hi:[1,1,0]
v_smfmac_f32_16x16x32_bf16 v[44:47], v[220:221], v[204:207], v246
v_fma_mix_f32 v161, v152, v152, v161 op_sel:[1,1,0] op_sel_hi:[1,1,0]
v_fma_mix_f32 v161, v149, v149, v161 op_sel:[0,0,0] op_sel_hi:[1,1,0]
v_fma_mix_f32 v161, v149, v149, v161 op_sel:[1,1,0] op_sel_hi:[1,1,0]
s_cmp_lg_u32 s40, 7
s_cbranch_scc1 Lnosent
v_mov_b32 v104, -1
v_mov_b32 v105, -1
v_mov_b32 v106, -1
v_mov_b32 v107, -1
v_lshlrev_b32_e64 v100, 12, v251
v_add_u32 v101, 262144, v100
v_cmp_gt_u32 vcc, 32, v251
v_mov_b32 v102, 2147483648
s_nop 0
v_cndmask_b32 v101, v102, v101, vcc
s_lshl_b32 s43, s2, 4
buffer_store_dwordx4 v[104:107], v100, s[32:35], s43 offen sc1
buffer_store_dwordx4 v[104:107], v101, s[32:35], s43 offen sc1
s_add_u32 s43, s43, 393216
s_cmp_lt_u32 s2, 96
s_cselect_b32 s43, s43, 1073741824
v_lshlrev_b32_e64 v102, 11, v251
s_mov_b64 exec, 0xff
buffer_store_dwordx4 v[104:107], v102, s[32:35], s43 offen sc1
s_mov_b64 exec, -1
s_sub_u32 s43, s2, 96
s_cmp_lt_u32 s43, 96
s_cbranch_scc0 Lnobias
s_lshl_b32 s44, s43, 1
v_mul_u32_u24 v100, 192, v251
v_lshlrev_b32 v101, 1, v251
s_add_u32 s45, s44, 0
buffer_load_ushort v102, v100, s[16:19], s45 offen
buffer_load_ushort v108, v101, s[28:31], 0 offen offset:0
s_add_u32 s45, s44, 12288
buffer_load_ushort v103, v100, s[16:19], s45 offen
buffer_load_ushort v109, v101, s[28:31], 0 offen offset:128
s_add_u32 s45, s44, 24576
buffer_load_ushort v104, v100, s[16:19], s45 offen
buffer_load_ushort v110, v101, s[28:31], 0 offen offset:256
s_add_u32 s45, s44, 36864
buffer_load_ushort v105, v100, s[16:19], s45 offen
buffer_load_ushort v111, v101, s[28:31], 0 offen offset:384
s_add_u32 s45, s44, 49152
buffer_load_ushort v106, v100, s[16:19], s45 offen
buffer_load_ushort v112, v101, s[28:31], 0 offen offset:512
s_add_u32 s45, s44, 61440
buffer_load_ushort v107, v100, s[16:19], s45 offen
buffer_load_ushort v113, v101, s[28:31], 0 offen offset:640
Lnobias:
s_nop 1
Lnosent:
ds_read_u16_d16_hi v187, v187
s_waitcnt lgkmcnt(1)
v_readfirstlane_b32 s43, v247
s_nop 1
s_cmp_ge_u32 s43, 12
s_cbranch_scc1 Lev4
Lev4w:
s_sleep 1
ds_read_b32 v247, v253 offset:28
s_waitcnt lgkmcnt(0)
v_readfirstlane_b32 s43, v247
s_cmp_eq_u32 s76, 0
s_cbranch_scc1 Lev4
s_sub_u32 s76, s76, 1
s_cmp_lt_u32 s43, 12
s_cbranch_scc1 Lev4w
Lev4:
s_setprio 1
v_smfmac_f32_16x16x32_bf16 v[28:31], v[226:227], v[208:211], v246
ds_read_b128 v[220:223], v248 offset:63488
v_cvt_pkrtz_f16_f32 v137, v120, v121
v_cvt_pkrtz_f16_f32 v139, v122, v123
v_cvt_pkrtz_f16_f32 v141, v124, v125
v_cvt_pkrtz_f16_f32 v143, v126, v127
v_smfmac_f32_16x16x32_bf16 v[12:15], v[224:225], v[212:215], v246
v_cvt_pk_f16_f32 v155, v128, v129
v_cvt_pk_f16_f32 v152, v130, v131
v_cvt_pk_f16_f32 v149, v132, v133
v_cvt_pk_f16_f32 v146, v134, v135
v_mfma_f32_32x32x16_bf16 v[120:135], v[48:51], v[228:231], 0
ds_read_b128 v[224:227], v248 offset:61440
v_pk_fma_f16 v154, v155, v155, s48
v_and_b32 v137, s49, v137
v_fma_mix_f32 v161, v178, v178, v161 op_sel:[0,0,0] op_sel_hi:[1,1,0]
v_pk_fma_f16 v151, v152, v152, s48
v_pk_fma_f16 v148, v149, v149, s48
v_pk_fma_f16 v145, v146, v146, s48
v_pk_mul_f16 v154, v155, v154
v_bfe_u32 v136, v137, 2, 14
v_pk_mul_f16 v151, v152, v151
v_mfma_f32_32x32x16_bf16 v[120:135], v[52:55], v[232:235], v[120:135]
ds_read_b128 v[228:231], v245 offset:3840
ds_read_b128 v[200:203], v243
v_xor_b32 v242, 16, v242
ds_read_b128 v[204:207], v242 offset:128
ds_read_u16_d16 v136, v136
v_fma_mix_f32 v161, v179, v179, v161 op_sel:[1,1,0] op_sel_hi:[1,1,0]
v_pk_mul_f16 v148, v149, v148
v_pk_mul_f16 v145, v146, v145
v_exp_f16 v153, v154
v_lshrrev_b32 v137, 18, v137
v_exp_f16 v150, v151
v_mfma_f32_32x32x16_bf16 v[120:135], v[56:59], v[236:239], v[120:135]
ds_read_b128 v[232:235], v248 offset:64512
ds_read_u16_d16_hi v137, v137
v_fma_mix_f32 v161, v180, v180, v161 op_sel:[0,0,0] op_sel_hi:[1,1,0]
v_exp_f16 v147, v148
v_and_b32 v139, s49, v139
v_exp_f16_e64 v144, v145
v_exp_f16_sdwa v153, v154 dst_sel:WORD_1 dst_unused:UNUSED_PRESERVE src0_sel:WORD_1
v_fma_mix_f32 v161, v181, v181, v161 op_sel:[1,1,0] op_sel_hi:[1,1,0]
v_smfmac_f32_16x16x32_bf16 v[44:47], v[218:219], v[192:195], v246
ds_read_b128 v[236:239], v245 offset:3456
ds_read_b128 v[208:211], v242 offset:64
ds_read_b128 v[212:215], v242
v_bfe_u32 v138, v139, 2, 14
v_exp_f16_sdwa v150, v151 dst_sel:WORD_1 dst_unused:UNUSED_PRESERVE src0_sel:WORD_1
v_smfmac_f32_16x16x32_bf16 v[28:31], v[216:217], v[196:199], v246
v_exp_f16_sdwa v147, v148 dst_sel:WORD_1 dst_unused:UNUSED_PRESERVE src0_sel:WORD_1
v_exp_f16_sdwa v144, v145 dst_sel:WORD_1 dst_unused:UNUSED_PRESERVE src0_sel:WORD_1
v_lshrrev_b32_e64 v139, 18, v139
s_waitcnt lgkmcnt(5)
v_mfma_f32_32x32x16_bf16 v[120:135], v[60:63], v[220:223], v[120:135]
ds_read_b128 v[216:219], v245 offset:3072
v_xor_b32 v244, 32, v244
ds_read_b128 v[192:195], v244 offset:128
ds_read_b128 v[196:199], v244 offset:64
ds_read_u16_d16 v138, v138
ds_read_u16_d16_hi v139, v139
v_fma_mix_f32 v161, v182, v182, v161 op_sel:[0,0,0] op_sel_hi:[1,1,0]
v_pk_add_f16 v153, v153, 1.0 op_sel_hi:[1,0]
v_pk_add_f16 v150, v150, 1.0 op_sel_hi:[1,0]
v_pk_add_f16 v147, v147, 1.0 op_sel_hi:[1,0]
v_and_b32_e64 v141, s49, v141
v_pk_add_f16 v144, v144, 1.0 op_sel_hi:[1,0]
v_rcp_f16_e64 v154, v153
v_fma_mix_f32 v161, v183, v183, v161 op_sel:[1,1,0] op_sel_hi:[1,1,0]
v_mfma_f32_32x32x16_bf16 v[120:135], v[64:67], v[224:227], v[120:135]
ds_read_b128 v[220:223], v249
v_rcp_f16_e64 v151, v150
v_bfe_u32 v140, v141, 2, 14
v_rcp_f16_e64 v148, v147
v_fma_mix_f32 v161, v184, v184, v161 op_sel:[0,0,0] op_sel_hi:[1,1,0]
v_rcp_f16 v145, v144
v_lshrrev_b32 v141, 18, v141
v_smfmac_f32_16x16x32_bf16 v[12:15], v[230:231], v[200:203], v246
ds_read_b128 v[224:227], v249 offset:3072
ds_read_u16_d16 v140, v140
ds_read_u16_d16_hi v141, v141
v_rcp_f16_sdwa v154, v153 dst_sel:WORD_1 dst_unused:UNUSED_PRESERVE src0_sel:WORD_1
s_setprio 0
v_rcp_f16_sdwa v151, v150 dst_sel:WORD_1 dst_unused:UNUSED_PRESERVE src0_sel:WORD_1
v_smfmac_f32_16x16x32_bf16 v[44:47], v[228:229], v[204:207], v246
v_fma_mix_f32 v161, v185, v185, v161 op_sel:[1,1,0] op_sel_hi:[1,1,0]
v_and_b32 v143, s49, v143
v_rcp_f16_sdwa v148, v147 dst_sel:WORD_1 dst_unused:UNUSED_PRESERVE src0_sel:WORD_1
s_waitcnt lgkmcnt(4)
v_mfma_f32_32x32x16_bf16 v[120:135], v[68:71], v[232:235], v[120:135]
ds_read_b128 v[228:231], v245 offset:2688
ds_read_b128 v[200:203], v244
v_xor_b32 v243, 32, v243
ds_read_b128 v[204:207], v243 offset:128
v_rcp_f16_sdwa v145, v144 dst_sel:WORD_1 dst_unused:UNUSED_PRESERVE src0_sel:WORD_1
v_pk_mul_f16 v155, v155, v154
v_bfe_u32 v142, v143, 2, 14
v_fma_mix_f32 v161, v186, v186, v161 op_sel:[0,0,0] op_sel_hi:[1,1,0]
v_pk_mul_f16 v152, v152, v151
v_pk_mul_f16 v149, v149, v148
v_pk_mul_f16 v146, v146, v145
v_fma_mix_f32 v162, v155, v155, 0 op_sel:[0,0,0] op_sel_hi:[1,1,0]
v_smfmac_f32_16x16x32_bf16 v[28:31], v[238:239], v[208:211], v246
ds_read_b128 v[232:235], v249 offset:1024
ds_read_u16_d16 v142, v142
v_lshrrev_b32_e64 v143, 18, v143
v_fma_mix_f32 v162, v155, v155, v162 op_sel:[1,1,0] op_sel_hi:[1,1,0]
v_fma_mix_f32 v162, v152, v152, v162 op_sel:[0,0,0] op_sel_hi:[1,1,0]
v_fma_mix_f32 v161, v187, v187, v161 op_sel:[1,1,0] op_sel_hi:[1,1,0]
v_smfmac_f32_16x16x32_bf16 v[12:15], v[236:237], v[212:215], v246
v_fma_mix_f32 v162, v152, v152, v162 op_sel:[1,1,0] op_sel_hi:[1,1,0]
v_fma_mix_f32 v162, v149, v149, v162 op_sel:[0,0,0] op_sel_hi:[1,1,0]
v_fma_mix_f32 v162, v149, v149, v162 op_sel:[1,1,0] op_sel_hi:[1,1,0]
v_fma_mix_f32 v162, v146, v146, v162 op_sel:[0,0,0] op_sel_hi:[1,1,0]
v_fma_mix_f32 v162, v146, v146, v162 op_sel:[1,1,0] op_sel_hi:[1,1,0]
v_lshlrev_b32_e64 v252, 7, v251
s_add_u32 s46, s47, 1572864
s_mov_b32 exec_lo, 131071
s_mov_b32 exec_hi, 0
s_mov_b32 m0, 16288
s_nop 0
buffer_load_dword v252, s[4:7], s46 offen lds
s_mov_b64 exec, -1
s_setprio 2
v_smfmac_f32_16x16x32_bf16 v[36:39], v[218:219], v[192:195], v246
ds_read_b128 v[236:239], v249 offset:4096
ds_read_u16_d16_hi v143, v143
v_cvt_pkrtz_f16_f32 v179, v120, v121
v_cvt_pkrtz_f16_f32 v181, v122, v123
v_cvt_pkrtz_f16_f32 v183, v124, v125
v_smfmac_f32_16x16x32_bf16 v[20:23], v[216:217], v[196:199], v246
v_cvt_pkrtz_f16_f32 v185, v126, v127
v_cvt_pkrtz_f16_f32 v187, v128, v129
v_cvt_pk_f16_f32 v155, v130, v131
v_cvt_pk_f16_f32 v152, v132, v133
v_cvt_pk_f16_f32 v149, v134, v135
s_waitcnt lgkmcnt(2)
v_mfma_f32_32x32x16_bf16 v[120:135], v[48:51], v[220:223], 0
ds_read_b128 v[216:219], v245 offset:2304
ds_read_b128 v[208:211], v243 offset:64
ds_read_b128 v[212:215], v243
v_pk_fma_f16 v154, v155, v155, s48
v_and_b32 v179, s49, v179
v_fma_mix_f32 v162, v136, v136, v162 op_sel:[0,0,0] op_sel_hi:[1,1,0]
v_pk_fma_f16 v151, v152, v152, s48
v_pk_fma_f16 v148, v149, v149, s48
v_mfma_f32_32x32x16_bf16 v[120:135], v[52:55], v[224:227], v[120:135]
ds_read_b128 v[220:223], v249 offset:2048
v_bfe_u32 v178, v179, 2, 14
v_pk_mul_f16 v154, v155, v154
v_pk_mul_f16 v151, v152, v151
v_pk_mul_f16 v148, v149, v148
v_lshrrev_b32 v179, 18, v179
v_fma_mix_f32 v162, v137, v137, v162 op_sel:[1,1,0] op_sel_hi:[1,1,0]
v_smfmac_f32_16x16x32_bf16 v[4:7], v[230:231], v[200:203], v246
ds_read_b128 v[224:227], v245 offset:1920
v_xor_b32 v242, 32, v242
ds_read_b128 v[192:195], v242 offset:128
ds_read_b128 v[196:199], v242 offset:64
ds_read_u16_d16 v178, v178
ds_read_u16_d16_hi v179, v179
v_exp_f16 v153, v154
v_and_b32 v181, s49, v181
v_smfmac_f32_16x16x32_bf16 v[36:39], v[228:229], v[204:207], v246
v_exp_f16 v150, v151
v_exp_f16 v147, v148
v_mfma_f32_32x32x16_bf16 v[120:135], v[56:59], v[232:235], v[120:135]
ds_read_b128 v[228:231], v249 offset:5120
v_bfe_u32 v180, v181, 2, 14
v_fma_mix_f32 v162, v138, v138, v162 op_sel:[0,0,0] op_sel_hi:[1,1,0]
v_exp_f16_sdwa v153, v154 dst_sel:WORD_1 dst_unused:UNUSED_PRESERVE src0_sel:WORD_1
v_lshrrev_b32_e64 v181, 18, v181
v_exp_f16_sdwa v150, v151 dst_sel:WORD_1 dst_unused:UNUSED_PRESERVE src0_sel:WORD_1
s_waitcnt lgkmcnt(6)
v_mfma_f32_32x32x16_bf16 v[120:135], v[60:63], v[236:239], v[120:135]
ds_read_b128 v[232:235], v245 offset:1536
ds_read_b128 v[200:203], v242
v_xor_b32 v244, 16, v244
ds_read_b128 v[204:207], v244 offset:128
ds_read_u16_d16 v180, v180
ds_read_u16_d16_hi v181, v181
v_fma_mix_f32 v162, v139, v139, v162 op_sel:[1,1,0] op_sel_hi:[1,1,0]
v_and_b32_e64 v183, s49, v183
v_exp_f16_sdwa v147, v148 dst_sel:WORD_1 dst_unused:UNUSED_PRESERVE src0_sel:WORD_1
v_pk_add_f16 v153, v153, 1.0 op_sel_hi:[1,0]
v_bfe_u32 v182, v183, 2, 14
v_smfmac_f32_16x16x32_bf16 v[20:23], v[218:219], v[208:211], v246
ds_read_b128 v[236:239], v245 offset:1152
ds_read_u16_d16 v182, v182
v_pk_add_f16 v150, v150, 1.0 op_sel_hi:[1,0]
v_pk_add_f16 v147, v147, 1.0 op_sel_hi:[1,0]
v_rcp_f16_e64 v154, v153
v_smfmac_f32_16x16x32_bf16 v[4:7], v[216:217], v[212:215], v246
v_lshrrev_b32_e64 v183, 18, v183
v_fma_mix_f32 v162, v140, v140, v162 op_sel:[0,0,0] op_sel_hi:[1,1,0]
v_mfma_f32_32x32x16_bf16 v[120:135], v[64:67], v[220:223], v[120:135]
ds_read_b128 v[208:211], v244 offset:64
ds_read_b128 v[212:215], v244
ds_read_b128 v[216:219], v249 offset:6144
ds_read_u16_d16_hi v183, v183
v_rcp_f16 v151, v150
v_and_b32 v185, s49, v185
v_rcp_f16 v148, v147
v_fma_mix_f32 v162, v141, v141, v162 op_sel:[1,1,0] op_sel_hi:[1,1,0]
v_bfe_u32 v184, v185, 2, 14
s_waitcnt lgkmcnt(6)
v_smfmac_f32_16x16x32_bf16 v[36:39], v[226:227], v[192:195], v246
ds_read_b128 v[220:223], v249 offset:9216
ds_read_u16_d16 v184, v184
v_rcp_f16_sdwa v154, v153 dst_sel:WORD_1 dst_unused:UNUSED_PRESERVE src0_sel:WORD_1
v_rcp_f16_sdwa v151, v150 dst_sel:WORD_1 dst_unused:UNUSED_PRESERVE src0_sel:WORD_1
v_smfmac_f32_16x16x32_bf16 v[20:23], v[224:225], v[196:199], v246
v_lshrrev_b32_e64 v185, 18, v185
v_rcp_f16_sdwa v148, v147 dst_sel:WORD_1 dst_unused:UNUSED_PRESERVE src0_sel:WORD_1
v_mfma_f32_32x32x16_bf16 v[120:135], v[68:71], v[228:231], v[120:135]
ds_read_b128 v[224:227], v249 offset:7168
ds_read_u16_d16_hi v185, v185
v_and_b32_e64 v187, s49, v187
v_fma_mix_f32 v162, v142, v142, v162 op_sel:[0,0,0] op_sel_hi:[1,1,0]
v_pk_mul_f16 v155, v155, v154
v_pk_mul_f16 v152, v152, v151
v_bfe_u32 v186, v187, 2, 14
v_pk_mul_f16 v149, v149, v148
v_fma_mix_f32 v163, v155, v155, 0 op_sel:[0,0,0] op_sel_hi:[1,1,0]
v_smfmac_f32_16x16x32_bf16 v[4:7], v[234:235], v[200:203], v246
ds_read_b128 v[228:231], v245 offset:768
v_xor_b32 v243, 16, v243
ds_read_b128 v[192:195], v243 offset:128
ds_read_b128 v[196:199], v243 offset:64
ds_read_u16_d16 v186, v186
v_fma_mix_f32 v162, v143, v143, v162 op_sel:[1,1,0] op_sel_hi:[1,1,0]
v_lshrrev_b32 v187, 18, v187
v_fma_mix_f32 v163, v155, v155, v163 op_sel:[1,1,0] op_sel_hi:[1,1,0]
v_smfmac_f32_16x16x32_bf16 v[32:35], v[232:233], v[204:207], v246
v_fma_mix_f32 v163, v152, v152, v163 op_sel:[0,0,0] op_sel_hi:[1,1,0]
v_fma_mix_f32 v163, v152, v152, v163 op_sel:[1,1,0] op_sel_hi:[1,1,0]
v_fma_mix_f32 v163, v149, v149, v163 op_sel:[0,0,0] op_sel_hi:[1,1,0]
v_fma_mix_f32 v163, v149, v149, v163 op_sel:[1,1,0] op_sel_hi:[1,1,0]
v_lshlrev_b32 v252, 7, v251
s_add_u32 s46, s47, 1572864
s_mov_b32 exec_lo, 4294836224
s_mov_b32 exec_hi, 3
s_mov_b32 m0, 16220
s_nop 0
buffer_load_dword v252, s[4:7], s46 offen lds
s_mov_b64 exec, -1
s_setprio 1
s_waitcnt lgkmcnt(4)
v_smfmac_f32_16x16x32_bf16 v[16:19], v[238:239], v[208:211], v246
ds_read_b128 v[232:235], v249 offset:10240
ds_read_u16_d16_hi v187, v187
v_cvt_pkrtz_f16_f32 v137, v120, v121
v_cvt_pkrtz_f16_f32 v139, v122, v123
v_cvt_pkrtz_f16_f32 v141, v124, v125
v_smfmac_f32_16x16x32_bf16 v[0:3], v[236:237], v[212:215], v246
v_cvt_pkrtz_f16_f32 v143, v126, v127
v_cvt_pk_f16_f32 v155, v128, v129
v_cvt_pk_f16_f32 v152, v130, v131
v_cvt_pk_f16_f32 v149, v132, v133
v_cvt_pk_f16_f32 v146, v134, v135
v_mfma_f32_32x32x16_bf16 v[120:135], v[48:51], v[216:219], 0
ds_read_b128 v[236:239], v249 offset:8192
v_pk_fma_f16 v154, v155, v155, s48
v_and_b32_e64 v137, s49, v137
v_fma_mix_f32 v163, v178, v178, v163 op_sel:[0,0,0] op_sel_hi:[1,1,0]
v_pk_fma_f16 v151, v152, v152, s48
v_pk_fma_f16 v148, v149, v149, s48
v_pk_fma_f16 v145, v146, v146, s48
v_pk_mul_f16 v154, v155, v154
v_mfma_f32_32x32x16_bf16 v[120:135], v[52:55], v[220:223], v[120:135]
ds_read_b128 v[216:219], v245 offset:384
ds_read_b128 v[200:203], v243
v_xor_b32 v242, 16, v242
ds_read_b128 v[204:207], v242 offset:128
v_bfe_u32 v136, v137, 2, 14
v_pk_mul_f16 v151, v152, v151
v_fma_mix_f32 v163, v179, v179, v163 op_sel:[1,1,0] op_sel_hi:[1,1,0]
v_pk_mul_f16 v148, v149, v148
v_pk_mul_f16 v145, v146, v145
v_exp_f16 v153, v154
v_lshrrev_b32_e64 v137, 18, v137
v_mfma_f32_32x32x16_bf16 v[120:135], v[56:59], v[224:227], v[120:135]
ds_read_b128 v[220:223], v249 offset:11264
ds_read_u16_d16 v136, v136
ds_read_u16_d16_hi v137, v137
v_exp_f16_e64 v150, v151
v_fma_mix_f32 v163, v180, v180, v163 op_sel:[0,0,0] op_sel_hi:[1,1,0]
v_exp_f16 v147, v148
v_and_b32 v139, s49, v139
v_exp_f16 v144, v145
s_waitcnt lgkmcnt(6)
v_smfmac_f32_16x16x32_bf16 v[32:35], v[230:231], v[192:195], v246
ds_read_b128 v[224:227], v245
ds_read_b128 v[208:211], v242 offset:64
ds_read_b128 v[212:215], v242
v_exp_f16_sdwa v153, v154 dst_sel:WORD_1 dst_unused:UNUSED_PRESERVE src0_sel:WORD_1
v_fma_mix_f32 v163, v181, v181, v163 op_sel:[1,1,0] op_sel_hi:[1,1,0]
v_bfe_u32 v138, v139, 2, 14
v_smfmac_f32_16x16x32_bf16 v[16:19], v[228:229], v[196:199], v246
v_exp_f16_sdwa v150, v151 dst_sel:WORD_1 dst_unused:UNUSED_PRESERVE src0_sel:WORD_1
v_mfma_f32_32x32x16_bf16 v[120:135], v[60:63], v[232:235], v[120:135]
ds_read_b128 v[228:231], v249 offset:12288
ds_read_u16_d16 v138, v138
v_exp_f16_sdwa v147, v148 dst_sel:WORD_1 dst_unused:UNUSED_PRESERVE src0_sel:WORD_1
v_exp_f16_sdwa v144, v145 dst_sel:WORD_1 dst_unused:UNUSED_PRESERVE src0_sel:WORD_1
v_lshrrev_b32_e64 v139, 18, v139
v_fma_mix_f32 v163, v182, v182, v163 op_sel:[0,0,0] op_sel_hi:[1,1,0]
v_pk_add_f16 v153, v153, 1.0 op_sel_hi:[1,0]
v_pk_add_f16 v150, v150, 1.0 op_sel_hi:[1,0]
v_pk_add_f16 v147, v147, 1.0 op_sel_hi:[1,0]
v_mfma_f32_32x32x16_bf16 v[120:135], v[64:67], v[236:239], v[120:135]
ds_read_b128 v[232:235], v249 offset:15360
ds_read_u16_d16_hi v139, v139
v_and_b32_e64 v141, s49, v141
v_pk_add_f16 v144, v144, 1.0 op_sel_hi:[1,0]
v_rcp_f16_e64 v154, v153
v_fma_mix_f32 v163, v183, v183, v163 op_sel:[1,1,0] op_sel_hi:[1,1,0]
v_rcp_f16 v151, v150
v_bfe_u32 v140, v141, 2, 14
s_waitcnt lgkmcnt(4)
v_smfmac_f32_16x16x32_bf16 v[0:3], v[218:219], v[200:203], v246
ds_read_b128 v[236:239], v249 offset:13312
ds_read_u16_d16 v140, v140
v_rcp_f16_e64 v148, v147
v_fma_mix_f32 v163, v184, v184, v163 op_sel:[0,0,0] op_sel_hi:[1,1,0]
v_smfmac_f32_16x16x32_bf16 v[32:35], v[216:217], v[204:207], v246
v_rcp_f16_e64 v145, v144
v_lshrrev_b32 v141, 18, v141
v_rcp_f16_sdwa v154, v153 dst_sel:WORD_1 dst_unused:UNUSED_PRESERVE src0_sel:WORD_1
s_setprio 0
v_mfma_f32_32x32x16_bf16 v[120:135], v[68:71], v[220:223], v[120:135]
ds_read_b128 v[216:219], v249 offset:16384
ds_read_u16_d16_hi v141, v141
v_rcp_f16_sdwa v151, v150 dst_sel:WORD_1 dst_unused:UNUSED_PRESERVE src0_sel:WORD_1
v_fma_mix_f32 v163, v185, v185, v163 op_sel:[1,1,0] op_sel_hi:[1,1,0]
v_and_b32_e64 v143, s49, v143
v_rcp_f16_sdwa v148, v147 dst_sel:WORD_1 dst_unused:UNUSED_PRESERVE src0_sel:WORD_1
v_rcp_f16_sdwa v145, v144 dst_sel:WORD_1 dst_unused:UNUSED_PRESERVE src0_sel:WORD_1
v_smfmac_f32_16x16x32_bf16 v[16:19], v[226:227], v[208:211], v246
ds_read_b128 v[220:223], v249 offset:14336
v_pk_mul_f16 v155, v155, v154
v_bfe_u32 v142, v143, 2, 14
v_fma_mix_f32 v163, v186, v186, v163 op_sel:[0,0,0] op_sel_hi:[1,1,0]
v_pk_mul_f16 v152, v152, v151
v_smfmac_f32_16x16x32_bf16 v[0:3], v[224:225], v[212:215], v246
s_mov_b64 exec, 1
ds_add_u32 v253, v254 offset:16
s_mov_b64 exec, -1
v_pk_mul_f16 v149, v149, v148
v_pk_mul_f16 v146, v146, v145
v_fma_mix_f32 v164, v155, v155, 0 op_sel:[0,0,0] op_sel_hi:[1,1,0]
v_lshrrev_b32 v143, 18, v143
v_fma_mix_f32 v164, v155, v155, v164 op_sel:[1,1,0] op_sel_hi:[1,1,0]
v_fma_mix_f32 v164, v152, v152, v164 op_sel:[0,0,0] op_sel_hi:[1,1,0]
v_fma_mix_f32 v163, v187, v187, v163 op_sel:[1,1,0] op_sel_hi:[1,1,0]
v_fma_mix_f32 v164, v152, v152, v164 op_sel:[1,1,0] op_sel_hi:[1,1,0]
v_fma_mix_f32 v164, v149, v149, v164 op_sel:[0,0,0] op_sel_hi:[1,1,0]
v_fma_mix_f32 v164, v149, v149, v164 op_sel:[1,1,0] op_sel_hi:[1,1,0]
v_fma_mix_f32 v164, v146, v146, v164 op_sel:[0,0,0] op_sel_hi:[1,1,0]
v_fma_mix_f32 v164, v146, v146, v164 op_sel:[1,1,0] op_sel_hi:[1,1,0]
s_setprio 3
v_pk_add_f32 v[168:169], v[0:1], v[2:3]
v_pk_mul_f32 v[170:171], v[0:1], v[0:1]
v_pk_fma_f32 v[170:171], v[2:3], v[2:3], v[170:171]
v_pk_add_f32 v[168:169], v[168:169], v[4:5]
v_pk_fma_f32 v[170:171], v[4:5], v[4:5], v[170:171]
v_pk_add_f32 v[168:169], v[168:169], v[6:7]
v_pk_fma_f32 v[170:171], v[6:7], v[6:7], v[170:171]
v_pk_add_f32 v[168:169], v[168:169], v[8:9]
v_pk_fma_f32 v[170:171], v[8:9], v[8:9], v[170:171]
v_pk_add_f32 v[168:169], v[168:169], v[10:11]
v_pk_fma_f32 v[170:171], v[10:11], v[10:11], v[170:171]
v_pk_add_f32 v[168:169], v[168:169], v[12:13]
v_pk_fma_f32 v[170:171], v[12:13], v[12:13], v[170:171]
v_pk_add_f32 v[168:169], v[168:169], v[14:15]
v_pk_fma_f32 v[170:171], v[14:15], v[14:15], v[170:171]
v_pk_add_f32 v[168:169], v[168:169], v[16:17]
v_pk_fma_f32 v[170:171], v[16:17], v[16:17], v[170:171]
v_pk_add_f32 v[168:169], v[168:169], v[18:19]
v_pk_fma_f32 v[170:171], v[18:19], v[18:19], v[170:171]
v_pk_add_f32 v[168:169], v[168:169], v[20:21]
v_pk_fma_f32 v[170:171], v[20:21], v[20:21], v[170:171]
v_pk_add_f32 v[168:169], v[168:169], v[22:23]
v_pk_fma_f32 v[170:171], v[22:23], v[22:23], v[170:171]
v_pk_add_f32 v[168:169], v[168:169], v[24:25]
v_pk_fma_f32 v[170:171], v[24:25], v[24:25], v[170:171]
v_pk_add_f32 v[168:169], v[168:169], v[26:27]
v_pk_fma_f32 v[170:171], v[26:27], v[26:27], v[170:171]
v_pk_add_f32 v[168:169], v[168:169], v[28:29]
v_pk_fma_f32 v[170:171], v[28:29], v[28:29], v[170:171]
v_pk_add_f32 v[168:169], v[168:169], v[30:31]
v_pk_fma_f32 v[170:171], v[30:31], v[30:31], v[170:171]
v_pk_add_f32 v[168:169], v[168:169], v[32:33]
v_pk_fma_f32 v[170:171], v[32:33], v[32:33], v[170:171]
v_pk_add_f32 v[168:169], v[168:169], v[34:35]
v_pk_fma_f32 v[170:171], v[34:35], v[34:35], v[170:171]
v_pk_add_f32 v[168:169], v[168:169], v[36:37]
v_pk_fma_f32 v[170:171], v[36:37], v[36:37], v[170:171]
v_pk_add_f32 v[168:169], v[168:169], v[38:39]
v_pk_fma_f32 v[170:171], v[38:39], v[38:39], v[170:171]
v_pk_add_f32 v[168:169], v[168:169], v[40:41]
v_pk_fma_f32 v[170:171], v[40:41], v[40:41], v[170:171]
v_pk_add_f32 v[168:169], v[168:169], v[42:43]
v_pk_fma_f32 v[170:171], v[42:43], v[42:43], v[170:171]
v_pk_add_f32 v[168:169], v[168:169], v[44:45]
v_pk_fma_f32 v[170:171], v[44:45], v[44:45], v[170:171]
v_pk_add_f32 v[168:169], v[168:169], v[46:47]
v_pk_fma_f32 v[170:171], v[46:47], v[46:47], v[170:171]
s_setprio 0
v_add_u32 v174, -36864, v242
v_subrev_u32 v175, 66560, v174
v_min_u32 v174, v174, v175
v_add_u32 v174, 90112, v174
v_sub_u32 v175, v174, v242
v_add_u32 v242, v175, v242
v_add_u32 v243, v175, v243
v_add_u32 v244, v175, v244
v_lshlrev_b32_e64 v252, 7, v251
s_add_u32 s46, s47, 1572864
s_mov_b32 exec_lo, 0
s_mov_b32 exec_hi, 1048572
s_mov_b32 m0, 16152
s_nop 0
buffer_load_dword v252, s[4:7], s46 offen lds
s_mov_b64 exec, -1
s_setprio 2
v_cvt_pkrtz_f16_f32 v179, v120, v121
v_cvt_pkrtz_f16_f32 v181, v122, v123
v_cvt_pkrtz_f16_f32 v183, v124, v125
v_cvt_pkrtz_f16_f32 v185, v126, v127
v_cvt_pkrtz_f16_f32 v187, v128, v129
v_cvt_pkrtz_f16_f32 v189, v130, v131
v_cvt_pk_f16_f32 v155, v132, v133
v_cvt_pk_f16_f32 v152, v134, v135
s_waitcnt lgkmcnt(1)
ds_read_b128 v[224:227], v249 offset:17408
ds_read_u16_d16 v142, v142
ds_read_u16_d16_hi v143, v143
v_mfma_f32_32x32x16_bf16 v[120:135], v[48:51], v[228:231], 0
v_pk_fma_f16 v154, v155, v155, s48
v_add_f32 v168, v168, v169
v_and_b32_e64 v179, s49, v179
v_fma_mix_f32 v164, v136, v136, v164 op_sel:[0,0,0] op_sel_hi:[1,1,0]
v_bfe_u32 v178, v179, 2, 14
v_add_f32_e64 v170, v170, v171
v_pk_fma_f16 v151, v152, v152, s48
v_pk_mul_f16 v154, v155, v154
v_lshrrev_b32_e64 v179, 18, v179
v_pk_mul_f16 v151, v152, v151
ds_read_b128 v[228:231], v249 offset:18432
ds_read_u16_d16 v178, v178
ds_read_u16_d16_hi v179, v179
v_mfma_f32_32x32x16_bf16 v[120:135], v[52:55], v[232:235], v[120:135]
v_permlane32_swap_b32 v168, v170
v_fma_mix_f32 v164, v137, v137, v164 op_sel:[1,1,0] op_sel_hi:[1,1,0]
v_and_b32 v181, s49, v181
v_exp_f16 v153, v154
v_add_f32 v168, v168, v170
v_bfe_u32 v180, v181, 2, 14
v_exp_f16 v150, v151
v_lshrrev_b32 v181, 18, v181
ds_read_b128 v[232:235], v249 offset:21504
ds_read_u16_d16 v180, v180
ds_read_u16_d16_hi v181, v181
v_mfma_f32_32x32x16_bf16 v[120:135], v[56:59], v[236:239], v[120:135]
v_mul_f32 v168, 1009429163, v168
v_fma_mix_f32 v164, v138, v138, v164 op_sel:[0,0,0] op_sel_hi:[1,1,0]
v_exp_f16_sdwa v153, v154 dst_sel:WORD_1 dst_unused:UNUSED_PRESERVE src0_sel:WORD_1
v_and_b32 v183, s49, v183
v_mov_b32 v170, v168
v_exp_f16_sdwa v150, v151 dst_sel:WORD_1 dst_unused:UNUSED_PRESERVE src0_sel:WORD_1
v_bfe_u32 v182, v183, 2, 14
v_fma_mix_f32 v164, v139, v139, v164 op_sel:[1,1,0] op_sel_hi:[1,1,0]
v_permlane32_swap_b32 v168, v170
ds_read_b128 v[236:239], v249 offset:19456
ds_read_u16_d16 v182, v182
v_mfma_f32_32x32x16_bf16 v[120:135], v[60:63], v[216:219], v[120:135]
v_lshrrev_b32 v183, 18, v183
v_pk_add_f16 v153, v153, 1.0 op_sel_hi:[1,0]
v_pk_add_f16 v150, v150, 1.0 op_sel_hi:[1,0]
v_and_b32_e64 v185, s49, v185
v_fma_f32 v170, -v168, v168, v170
v_rcp_f16_e64 v154, v153
v_bfe_u32 v184, v185, 2, 14
v_max_f32_e64 v170, 0, v170
v_fma_mix_f32 v164, v140, v140, v164 op_sel:[0,0,0] op_sel_hi:[1,1,0]
ds_read_b128 v[216:219], v249 offset:22528
ds_read_u16_d16_hi v183, v183
ds_read_u16_d16 v184, v184
v_mfma_f32_32x32x16_bf16 v[120:135], v[64:67], v[220:223], v[120:135]
v_lshrrev_b32 v185, 18, v185
v_rcp_f16 v151, v150
v_add_f32 v170, 925353388, v170
v_and_b32_e64 v187, s49, v187
v_fma_mix_f32 v164, v141, v141, v164 op_sel:[1,1,0] op_sel_hi:[1,1,0]
v_rcp_f16_sdwa v154, v153 dst_sel:WORD_1 dst_unused:UNUSED_PRESERVE src0_sel:WORD_1
v_rsq_f32 v170, v170
s_waitcnt lgkmcnt(5)
ds_read_b128 v[220:223], v249 offset:20480
ds_read_u16_d16_hi v185, v185
ds_read_b32 v247, v253 offset:16
v_mfma_f32_32x32x16_bf16 v[120:135], v[68:71], v[224:227], v[120:135]
v_bfe_u32 v186, v187, 2, 14
v_rcp_f16_sdwa v151, v150 dst_sel:WORD_1 dst_unused:UNUSED_PRESERVE src0_sel:WORD_1
v_lshrrev_b32_e64 v187, 18, v187
v_fma_mix_f32 v164, v142, v142, v164 op_sel:[0,0,0] op_sel_hi:[1,1,0]
v_and_b32_e64 v189, s49, v189
v_pk_mul_f16 v155, v155, v154
v_pk_mul_f16 v152, v152, v151
v_mul_f32 v172, 3203391086, v170
v_bfe_u32 v188, v189, 2, 14
v_fma_mix_f32 v165, v155, v155, 0 op_sel:[0,0,0] op_sel_hi:[1,1,0]
v_fma_mix_f32 v164, v143, v143, v164 op_sel:[1,1,0] op_sel_hi:[1,1,0]
v_lshrrev_b32_e64 v189, 18, v189
v_mul_f32 v173, v168, v172
v_fma_mix_f32 v165, v155, v155, v165 op_sel:[1,1,0] op_sel_hi:[1,1,0]
v_fma_mix_f32 v165, v152, v152, v165 op_sel:[0,0,0] op_sel_hi:[1,1,0]
v_fma_mix_f32 v165, v152, v152, v165 op_sel:[1,1,0] op_sel_hi:[1,1,0]
s_setprio 3
v_pk_fma_f32 v[0:1], v[0:1], v[172:173], v[172:173] op_sel:[0,0,1] op_sel_hi:[1,0,1] neg_lo:[0,0,1] neg_hi:[0,0,1]
v_pk_fma_f32 v[2:3], v[2:3], v[172:173], v[172:173] op_sel:[0,0,1] op_sel_hi:[1,0,1] neg_lo:[0,0,1] neg_hi:[0,0,1]
v_pk_fma_f32 v[4:5], v[4:5], v[172:173], v[172:173] op_sel:[0,0,1] op_sel_hi:[1,0,1] neg_lo:[0,0,1] neg_hi:[0,0,1]
v_pk_fma_f32 v[6:7], v[6:7], v[172:173], v[172:173] op_sel:[0,0,1] op_sel_hi:[1,0,1] neg_lo:[0,0,1] neg_hi:[0,0,1]
v_pk_fma_f32 v[8:9], v[8:9], v[172:173], v[172:173] op_sel:[0,0,1] op_sel_hi:[1,0,1] neg_lo:[0,0,1] neg_hi:[0,0,1]
v_pk_fma_f32 v[10:11], v[10:11], v[172:173], v[172:173] op_sel:[0,0,1] op_sel_hi:[1,0,1] neg_lo:[0,0,1] neg_hi:[0,0,1]
v_pk_fma_f32 v[12:13], v[12:13], v[172:173], v[172:173] op_sel:[0,0,1] op_sel_hi:[1,0,1] neg_lo:[0,0,1] neg_hi:[0,0,1]
v_pk_fma_f32 v[14:15], v[14:15], v[172:173], v[172:173] op_sel:[0,0,1] op_sel_hi:[1,0,1] neg_lo:[0,0,1] neg_hi:[0,0,1]
v_pk_fma_f32 v[16:17], v[16:17], v[172:173], v[172:173] op_sel:[0,0,1] op_sel_hi:[1,0,1] neg_lo:[0,0,1] neg_hi:[0,0,1]
v_pk_fma_f32 v[18:19], v[18:19], v[172:173], v[172:173] op_sel:[0,0,1] op_sel_hi:[1,0,1] neg_lo:[0,0,1] neg_hi:[0,0,1]
v_pk_fma_f32 v[20:21], v[20:21], v[172:173], v[172:173] op_sel:[0,0,1] op_sel_hi:[1,0,1] neg_lo:[0,0,1] neg_hi:[0,0,1]
v_pk_fma_f32 v[22:23], v[22:23], v[172:173], v[172:173] op_sel:[0,0,1] op_sel_hi:[1,0,1] neg_lo:[0,0,1] neg_hi:[0,0,1]
v_pk_fma_f32 v[24:25], v[24:25], v[172:173], v[172:173] op_sel:[0,0,1] op_sel_hi:[1,0,1] neg_lo:[0,0,1] neg_hi:[0,0,1]
v_pk_fma_f32 v[26:27], v[26:27], v[172:173], v[172:173] op_sel:[0,0,1] op_sel_hi:[1,0,1] neg_lo:[0,0,1] neg_hi:[0,0,1]
v_pk_fma_f32 v[28:29], v[28:29], v[172:173], v[172:173] op_sel:[0,0,1] op_sel_hi:[1,0,1] neg_lo:[0,0,1] neg_hi:[0,0,1]
v_pk_fma_f32 v[30:31], v[30:31], v[172:173], v[172:173] op_sel:[0,0,1] op_sel_hi:[1,0,1] neg_lo:[0,0,1] neg_hi:[0,0,1]
v_pk_fma_f32 v[32:33], v[32:33], v[172:173], v[172:173] op_sel:[0,0,1] op_sel_hi:[1,0,1] neg_lo:[0,0,1] neg_hi:[0,0,1]
v_pk_fma_f32 v[34:35], v[34:35], v[172:173], v[172:173] op_sel:[0,0,1] op_sel_hi:[1,0,1] neg_lo:[0,0,1] neg_hi:[0,0,1]
v_pk_fma_f32 v[36:37], v[36:37], v[172:173], v[172:173] op_sel:[0,0,1] op_sel_hi:[1,0,1] neg_lo:[0,0,1] neg_hi:[0,0,1]
v_pk_fma_f32 v[38:39], v[38:39], v[172:173], v[172:173] op_sel:[0,0,1] op_sel_hi:[1,0,1] neg_lo:[0,0,1] neg_hi:[0,0,1]
v_pk_fma_f32 v[40:41], v[40:41], v[172:173], v[172:173] op_sel:[0,0,1] op_sel_hi:[1,0,1] neg_lo:[0,0,1] neg_hi:[0,0,1]
v_pk_fma_f32 v[42:43], v[42:43], v[172:173], v[172:173] op_sel:[0,0,1] op_sel_hi:[1,0,1] neg_lo:[0,0,1] neg_hi:[0,0,1]
v_pk_fma_f32 v[44:45], v[44:45], v[172:173], v[172:173] op_sel:[0,0,1] op_sel_hi:[1,0,1] neg_lo:[0,0,1] neg_hi:[0,0,1]
v_pk_fma_f32 v[46:47], v[46:47], v[172:173], v[172:173] op_sel:[0,0,1] op_sel_hi:[1,0,1] neg_lo:[0,0,1] neg_hi:[0,0,1]
s_setprio 2
ds_read_u16_d16 v186, v186
ds_read_u16_d16_hi v187, v187
ds_read_u16_d16 v188, v188
ds_read_u16_d16_hi v189, v189
s_waitcnt lgkmcnt(4)
v_readfirstlane_b32 s43, v247
s_nop 1
s_cmp_ge_u32 s43, 16
s_cbranch_scc1 Lev5
Lev5w:
s_sleep 1
ds_read_b32 v247, v253 offset:16
s_waitcnt lgkmcnt(0)
v_readfirstlane_b32 s43, v247
s_cmp_eq_u32 s76, 0
s_cbranch_scc1 Lev5
s_sub_u32 s76, s76, 1
s_cmp_lt_u32 s43, 16
s_cbranch_scc1 Lev5w
Lev5:
s_setprio 1
v_cvt_pkrtz_f16_f32 v137, v120, v121
v_cvt_pkrtz_f16_f32 v139, v122, v123
v_cvt_pkrtz_f16_f32 v141, v124, v125
v_cvt_pkrtz_f16_f32 v143, v126, v127
v_cvt_pkrtz_f16_f32 v177, v128, v129
v_cvt_pkrtz_f16_f32 v191, v130, v131
v_cvt_pk_f16_f32 v155, v132, v133
v_cvt_pk_f16_f32 v152, v134, v135
s_add_u32 m0, s67, 53248
s_add_u32 s66, s66, 98304
buffer_load_dwordx4 v240, s[4:7], s66 offen lds
ds_read_b128 v[224:227], v249 offset:23552
v_mfma_f32_32x32x16_bf16 v[120:135], v[48:51], v[228:231], 0
v_pk_fma_f16 v154, v155, v155, s48
v_cvt_pk_bf16_f32 v72, v0, v1
v_and_b32 v137, s49, v137
v_fma_mix_f32 v165, v178, v178, v165 op_sel:[0,0,0] op_sel_hi:[1,1,0]
v_cvt_pk_bf16_f32 v73, v2, v3
v_pk_fma_f16 v151, v152, v152, s48
v_bfe_u32 v136, v137, 2, 14
v_cvt_pk_bf16_f32 v74, v4, v5
v_pk_mul_f16 v154, v155, v154
v_fma_mix_f32 v165, v179, v179, v165 op_sel:[1,1,0] op_sel_hi:[1,1,0]
v_lshrrev_b32_e64 v137, 18, v137
v_cvt_pk_bf16_f32 v75, v6, v7
s_add_u32 m0, s67, 59904
s_add_u32 s66, s66, 98304
buffer_load_dwordx4 v240, s[4:7], s66 offen lds
ds_read_b128 v[228:231], v248 offset:16384
ds_read_u16_d16 v136, v136
ds_read_u16_d16_hi v137, v137
v_mfma_f32_32x32x16_bf16 v[120:135], v[52:55], v[232:235], v[120:135]
v_pk_mul_f16 v151, v152, v151
v_exp_f16_e64 v153, v154
v_cvt_pk_bf16_f32 v76, v8, v9
v_and_b32_e64 v139, s49, v139
v_fma_mix_f32 v165, v180, v180, v165 op_sel:[0,0,0] op_sel_hi:[1,1,0]
v_cvt_pk_bf16_f32 v77, v10, v11
v_bfe_u32 v138, v139, 2, 14
v_exp_f16_e64 v150, v151
v_cvt_pk_bf16_f32 v78, v12, v13
v_lshrrev_b32 v139, 18, v139
v_cvt_pk_bf16_f32 v79, v14, v15
s_add_u32 m0, s67, 0
s_add_u32 s66, s66, 98304
buffer_load_dwordx4 v240, s[4:7], s66 offen lds
ds_read_b128 v[232:235], v248 offset:19456
ds_read_u16_d16 v138, v138
ds_read_u16_d16_hi v139, v139
v_mfma_f32_32x32x16_bf16 v[120:135], v[56:59], v[236:239], v[120:135]
v_fma_mix_f32 v165, v181, v181, v165 op_sel:[1,1,0] op_sel_hi:[1,1,0]
v_exp_f16_sdwa v153, v154 dst_sel:WORD_1 dst_unused:UNUSED_PRESERVE src0_sel:WORD_1
v_cvt_pk_bf16_f32 v80, v16, v17
v_and_b32_e64 v141, s49, v141
v_fma_mix_f32 v165, v182, v182, v165 op_sel:[0,0,0] op_sel_hi:[1,1,0]
v_cvt_pk_bf16_f32 v81, v18, v19
v_bfe_u32 v140, v141, 2, 14
v_exp_f16_sdwa v150, v151 dst_sel:WORD_1 dst_unused:UNUSED_PRESERVE src0_sel:WORD_1
v_cvt_pk_bf16_f32 v82, v20, v21
v_lshrrev_b32_e64 v141, 18, v141
s_add_u32 m0, s67, 6656
s_add_u32 s66, s66, 98304
buffer_load_dwordx4 v240, s[4:7], s66 offen lds
s_add_u32 m0, s67, 13312
s_add_u32 s66, s66, 98304
buffer_load_dwordx4 v240, s[4:7], s66 offen lds
ds_read_b128 v[236:239], v248 offset:17408
ds_read_u16_d16 v140, v140
ds_read_u16_d16_hi v141, v141
v_mfma_f32_32x32x16_bf16 v[120:135], v[60:63], v[216:219], v[120:135]
v_fma_mix_f32 v165, v183, v183, v165 op_sel:[1,1,0] op_sel_hi:[1,1,0]
v_cvt_pk_bf16_f32 v83, v22, v23
v_pk_add_f16 v153, v153, 1.0 op_sel_hi:[1,0]
v_pk_add_f16 v150, v150, 1.0 op_sel_hi:[1,0]
v_and_b32_e64 v143, s49, v143
v_cvt_pk_bf16_f32 v84, v24, v25
v_rcp_f16_e64 v154, v153
v_cvt_pk_bf16_f32 v85, v26, v27
v_bfe_u32 v142, v143, 2, 14
v_fma_mix_f32 v165, v184, v184, v165 op_sel:[0,0,0] op_sel_hi:[1,1,0]
v_cvt_pk_bf16_f32 v86, v28, v29
s_add_u32 m0, s67, 19968
s_add_u32 s66, s66, 98304
buffer_load_dwordx4 v240, s[4:7], s66 offen lds
ds_read_b128 v[216:219], v248 offset:20480
ds_read_u16_d16 v142, v142
v_mfma_f32_32x32x16_bf16 v[120:135], v[64:67], v[220:223], v[120:135]
v_rcp_f16 v151, v150
v_lshrrev_b32 v143, 18, v143
v_cvt_pk_bf16_f32 v87, v30, v31
v_fma_mix_f32 v165, v185, v185, v165 op_sel:[1,1,0] op_sel_hi:[1,1,0]
v_and_b32_e64 v177, s49, v177
s_setprio 0
v_cvt_pk_bf16_f32 v88, v32, v33
v_rcp_f16_sdwa v154, v153 dst_sel:WORD_1 dst_unused:UNUSED_PRESERVE src0_sel:WORD_1
v_bfe_u32 v176, v177, 2, 14
v_cvt_pk_bf16_f32 v89, v34, v35
s_waitcnt lgkmcnt(2)
v_fma_mix_f32 v165, v186, v186, v165 op_sel:[0,0,0] op_sel_hi:[1,1,0]
v_rcp_f16_sdwa v151, v150 dst_sel:WORD_1 dst_unused:UNUSED_PRESERVE src0_sel:WORD_1
s_add_u32 m0, s67, 26624
s_add_u32 s66, s66, 98304
buffer_load_dwordx4 v240, s[4:7], s66 offen lds
ds_read_b128 v[220:223], v248 offset:18432
ds_read_u16_d16_hi v143, v143
ds_read_u16_d16 v176, v176
v_mfma_f32_32x32x16_bf16 v[120:135], v[68:71], v[224:227], v[120:135]
v_cvt_pk_bf16_f32 v90, v36, v37
v_lshrrev_b32_e64 v177, 18, v177
v_cvt_pk_bf16_f32 v91, v38, v39
v_fma_mix_f32 v165, v187, v187, v165 op_sel:[1,1,0] op_sel_hi:[1,1,0]
v_and_b32_e64 v191, s49, v191
v_pk_mul_f16 v155, v155, v154
v_cvt_pk_bf16_f32 v92, v40, v41
v_pk_mul_f16 v152, v152, v151
v_bfe_u32 v190, v191, 2, 14
v_cvt_pk_bf16_f32 v93, v42, v43
v_fma_mix_f32 v165, v188, v188, v165 op_sel:[0,0,0] op_sel_hi:[1,1,0]
v_fma_mix_f32 v166, v155, v155, 0 op_sel:[0,0,0] op_sel_hi:[1,1,0]
s_add_u32 m0, s67, 33280
s_add_u32 s66, s66, 98304
buffer_load_dwordx4 v240, s[4:7], s66 offen lds
v_lshrrev_b32 v191, 18, v191
v_cvt_pk_bf16_f32 v94, v44, v45
v_fma_mix_f32 v166, v155, v155, v166 op_sel:[1,1,0] op_sel_hi:[1,1,0]
v_fma_mix_f32 v165, v189, v189, v165 op_sel:[1,1,0] op_sel_hi:[1,1,0]
v_cvt_pk_bf16_f32 v95, v46, v47
v_fma_mix_f32 v166, v152, v152, v166 op_sel:[0,0,0] op_sel_hi:[1,1,0]
v_fma_mix_f32 v166, v152, v152, v166 op_sel:[1,1,0] op_sel_hi:[1,1,0]
s_setprio 2
v_cvt_pkrtz_f16_f32 v179, v120, v121
v_cvt_pkrtz_f16_f32 v181, v122, v123
v_cvt_pkrtz_f16_f32 v183, v124, v125
v_cvt_pkrtz_f16_f32 v185, v126, v127
v_cvt_pkrtz_f16_f32 v187, v128, v129
v_cvt_pk_f16_f32 v155, v130, v131
v_cvt_pk_f16_f32 v152, v132, v133
v_cvt_pk_f16_f32 v149, v134, v135
ds_read_b128 v[224:227], v248 offset:21504
ds_read_u16_d16_hi v177, v177
ds_read_u16_d16 v190, v190
ds_read_u16_d16_hi v191, v191
v_mfma_f32_32x32x16_bf16 v[120:135], v[72:75], v[228:231], 0
v_pk_fma_f16 v154, v155, v155, s48
v_and_b32_e64 v179, s49, v179
v_fma_mix_f32 v166, v136, v136, v166 op_sel:[0,0,0] op_sel_hi:[1,1,0]
v_pk_fma_f16 v151, v152, v152, s48
v_pk_fma_f16 v148, v149, v149, s48
v_bfe_u32 v178, v179, 2, 14
v_pk_mul_f16 v154, v155, v154
v_fma_mix_f32 v166, v137, v137, v166 op_sel:[1,1,0] op_sel_hi:[1,1,0]
v_pk_mul_f16 v151, v152, v151
v_lshrrev_b32_e64 v179, 18, v179
ds_read_b128 v[228:231], v248 offset:22528
ds_read_u16_d16 v178, v178
ds_read_u16_d16_hi v179, v179
v_mfma_f32_32x32x16_bf16 v[120:135], v[76:79], v[232:235], v[120:135]
v_pk_mul_f16 v148, v149, v148
v_exp_f16_e64 v153, v154
v_fma_mix_f32 v166, v138, v138, v166 op_sel:[0,0,0] op_sel_hi:[1,1,0]
v_and_b32 v181, s49, v181
v_exp_f16 v150, v151
v_exp_f16_e64 v147, v148
v_bfe_u32 v180, v181, 2, 14
v_fma_mix_f32 v166, v139, v139, v166 op_sel:[1,1,0] op_sel_hi:[1,1,0]
ds_read_b128 v[232:235], v248 offset:25600
ds_read_u16_d16 v180, v180
v_mfma_f32_32x32x16_bf16 v[120:135], v[80:83], v[236:239], v[120:135]
v_exp_f16_sdwa v153, v154 dst_sel:WORD_1 dst_unused:UNUSED_PRESERVE src0_sel:WORD_1
v_lshrrev_b32_e64 v181, 18, v181
v_exp_f16_sdwa v150, v151 dst_sel:WORD_1 dst_unused:UNUSED_PRESERVE src0_sel:WORD_1
v_fma_mix_f32 v166, v140, v140, v166 op_sel:[0,0,0] op_sel_hi:[1,1,0]
v_and_b32 v183, s49, v183
v_exp_f16_sdwa v147, v148 dst_sel:WORD_1 dst_unused:UNUSED_PRESERVE src0_sel:WORD_1
v_fma_mix_f32 v166, v141, v141, v166 op_sel:[1,1,0] op_sel_hi:[1,1,0]
s_waitcnt lgkmcnt(5)
ds_read_b128 v[236:239], v248 offset:23552
ds_read_u16_d16_hi v181, v181
v_mfma_f32_32x32x16_bf16 v[120:135], v[84:87], v[216:219], v[120:135]
v_pk_add_f16 v153, v153, 1.0 op_sel_hi:[1,0]
v_bfe_u32 v182, v183, 2, 14
v_pk_add_f16 v150, v150, 1.0 op_sel_hi:[1,0]
v_pk_add_f16 v147, v147, 1.0 op_sel_hi:[1,0]
v_rcp_f16 v154, v153
v_lshrrev_b32 v183, 18, v183
v_fma_mix_f32 v166, v142, v142, v166 op_sel:[0,0,0] op_sel_hi:[1,1,0]
v_rcp_f16 v151, v150
v_and_b32 v185, s49, v185
ds_read_b128 v[216:219], v248 offset:26624
ds_read_u16_d16 v182, v182
ds_read_u16_d16_hi v183, v183
v_mfma_f32_32x32x16_bf16 v[120:135], v[88:91], v[220:223], v[120:135]
v_fma_mix_f32 v166, v143, v143, v166 op_sel:[1,1,0] op_sel_hi:[1,1,0]
v_rcp_f16_e64 v148, v147
v_bfe_u32 v184, v185, 2, 14
v_rcp_f16_sdwa v154, v153 dst_sel:WORD_1 dst_unused:UNUSED_PRESERVE src0_sel:WORD_1
v_fma_mix_f32 v166, v176, v176, v166 op_sel:[0,0,0] op_sel_hi:[1,1,0]
v_rcp_f16_sdwa v151, v150 dst_sel:WORD_1 dst_unused:UNUSED_PRESERVE src0_sel:WORD_1
v_lshrrev_b32_e64 v185, 18, v185
ds_read_b128 v[220:223], v248 offset:24576
ds_read_u16_d16 v184, v184
ds_read_u16_d16_hi v185, v185
v_mfma_f32_32x32x16_bf16 v[120:135], v[92:95], v[224:227], v[120:135]
v_rcp_f16_sdwa v148, v147 dst_sel:WORD_1 dst_unused:UNUSED_PRESERVE src0_sel:WORD_1
s_cmp_eq_u32 s40, 7
s_cbranch_scc1 Lrdy16
s_waitcnt vmcnt(0)
Lrdy16:
s_mov_b64 exec, 1
ds_add_u32 v253, v254 offset:12
s_mov_b64 exec, -1
v_and_b32 v187, s49, v187
v_fma_mix_f32 v166, v177, v177, v166 op_sel:[1,1,0] op_sel_hi:[1,1,0]
v_pk_mul_f16 v155, v155, v154
v_pk_mul_f16 v152, v152, v151
v_pk_mul_f16 v149, v149, v148
v_bfe_u32 v186, v187, 2, 14
v_fma_mix_f32 v166, v190, v190, v166 op_sel:[0,0,0] op_sel_hi:[1,1,0]
v_fma_mix_f32 v167, v155, v155, 0 op_sel:[0,0,0] op_sel_hi:[1,1,0]
v_fma_mix_f32 v167, v155, v155, v167 op_sel:[1,1,0] op_sel_hi:[1,1,0]
v_lshrrev_b32_e64 v187, 18, v187
v_fma_mix_f32 v167, v152, v152, v167 op_sel:[0,0,0] op_sel_hi:[1,1,0]
v_fma_mix_f32 v166, v191, v191, v166 op_sel:[1,1,0] op_sel_hi:[1,1,0]
v_fma_mix_f32 v167, v152, v152, v167 op_sel:[1,1,0] op_sel_hi:[1,1,0]
v_fma_mix_f32 v167, v149, v149, v167 op_sel:[0,0,0] op_sel_hi:[1,1,0]
v_fma_mix_f32 v167, v149, v149, v167 op_sel:[1,1,0] op_sel_hi:[1,1,0]
s_setprio 1
v_cvt_pkrtz_f16_f32 v137, v120, v121
v_cvt_pkrtz_f16_f32 v139, v122, v123
v_cvt_pkrtz_f16_f32 v141, v124, v125
v_cvt_pkrtz_f16_f32 v143, v126, v127
v_cvt_pkrtz_f16_f32 v177, v128, v129
v_cvt_pk_f16_f32 v155, v130, v131
v_cvt_pk_f16_f32 v152, v132, v133
v_cvt_pk_f16_f32 v149, v134, v135
s_waitcnt lgkmcnt(1)
ds_read_b128 v[224:227], v248 offset:27648
ds_read_u16_d16 v186, v186
ds_read_u16_d16_hi v187, v187
v_mfma_f32_32x32x16_bf16 v[120:135], v[72:75], v[228:231], 0
v_pk_fma_f16 v154, v155, v155, s48
v_and_b32_e64 v137, s49, v137
v_fma_mix_f32 v167, v178, v178, v167 op_sel:[0,0,0] op_sel_hi:[1,1,0]
v_pk_fma_f16 v151, v152, v152, s48
v_pk_fma_f16 v148, v149, v149, s48
v_bfe_u32 v136, v137, 2, 14
v_pk_mul_f16 v154, v155, v154
v_pk_mul_f16 v151, v152, v151
v_fma_mix_f32 v167, v179, v179, v167 op_sel:[1,1,0] op_sel_hi:[1,1,0]
v_lshrrev_b32_e64 v137, 18, v137
ds_read_b128 v[228:231], v250 offset:65520
ds_read_u16_d16 v136, v136
ds_read_u16_d16_hi v137, v137
v_mfma_f32_32x32x16_bf16 v[120:135], v[76:79], v[232:235], v[120:135]
v_pk_mul_f16 v148, v149, v148
v_exp_f16 v153, v154
v_exp_f16 v150, v151
v_and_b32_e64 v139, s49, v139
v_fma_mix_f32 v167, v180, v180, v167 op_sel:[0,0,0] op_sel_hi:[1,1,0]
v_exp_f16_e64 v147, v148
v_bfe_u32 v138, v139, 2, 14
ds_read_b128 v[232:235], v248 offset:28672
ds_read_b32 v247, v253 offset:12
ds_read_u16_d16 v138, v138
v_mfma_f32_32x32x16_bf16 v[120:135], v[80:83], v[236:239], v[120:135]
v_exp_f16_sdwa v153, v154 dst_sel:WORD_1 dst_unused:UNUSED_PRESERVE src0_sel:WORD_1
v_lshrrev_b32_e64 v139, 18, v139
v_fma_mix_f32 v167, v181, v181, v167 op_sel:[1,1,0] op_sel_hi:[1,1,0]
v_exp_f16_sdwa v150, v151 dst_sel:WORD_1 dst_unused:UNUSED_PRESERVE src0_sel:WORD_1
v_exp_f16_sdwa v147, v148 dst_sel:WORD_1 dst_unused:UNUSED_PRESERVE src0_sel:WORD_1
v_and_b32_e64 v141, s49, v141
v_fma_mix_f32 v167, v182, v182, v167 op_sel:[0,0,0] op_sel_hi:[1,1,0]
ds_read_b128 v[236:239], v248 offset:31744
ds_read_u16_d16_hi v139, v139
v_mfma_f32_32x32x16_bf16 v[120:135], v[84:87], v[216:219], v[120:135]
v_pk_add_f16 v153, v153, 1.0 op_sel_hi:[1,0]
v_bfe_u32 v140, v141, 2, 14
v_pk_add_f16 v150, v150, 1.0 op_sel_hi:[1,0]
v_pk_add_f16 v147, v147, 1.0 op_sel_hi:[1,0]
v_rcp_f16 v154, v153
v_lshrrev_b32 v141, 18, v141
ds_read_u16_d16 v140, v140
ds_read_u16_d16_hi v141, v141
s_waitcnt lgkmcnt(5)
v_readfirstlane_b32 s43, v247
s_nop 1
s_cmp_ge_u32 s43, 24
s_cbranch_scc1 Lev6
Lev6w:
s_sleep 1
ds_read_b32 v247, v253 offset:12
s_waitcnt lgkmcnt(0)
v_readfirstlane_b32 s43, v247
s_cmp_eq_u32 s76, 0
s_cbranch_scc1 Lev6
s_sub_u32 s76, s76, 1
s_cmp_lt_u32 s43, 24
s_cbranch_scc1 Lev6w
Lev6:
v_fma_mix_f32 v167, v183, v183, v167 op_sel:[1,1,0] op_sel_hi:[1,1,0]
v_rcp_f16 v151, v150
ds_read_b128 v[216:219], v248 offset:29696
v_mfma_f32_32x32x16_bf16 v[120:135], v[88:91], v[220:223], v[120:135]
v_and_b32 v143, s49, v143
v_rcp_f16 v148, v147
v_fma_mix_f32 v167, v184, v184, v167 op_sel:[0,0,0] op_sel_hi:[1,1,0]
v_bfe_u32 v142, v143, 2, 14
s_setprio 0
v_rcp_f16_sdwa v154, v153 dst_sel:WORD_1 dst_unused:UNUSED_PRESERVE src0_sel:WORD_1
v_rcp_f16_sdwa v151, v150 dst_sel:WORD_1 dst_unused:UNUSED_PRESERVE src0_sel:WORD_1
v_lshrrev_b32 v143, 18, v143
ds_read_b128 v[220:223], v245
ds_read_b128 v[192:195], v242
ds_read_b128 v[196:199], v242 offset:64
ds_read_u16_d16 v142, v142
ds_read_u16_d16_hi v143, v143
v_mfma_f32_32x32x16_bf16 v[120:135], v[92:95], v[224:227], v[120:135]
v_fma_mix_f32 v167, v185, v185, v167 op_sel:[1,1,0] op_sel_hi:[1,1,0]
v_rcp_f16_sdwa v148, v147 dst_sel:WORD_1 dst_unused:UNUSED_PRESERVE src0_sel:WORD_1
v_and_b32_e64 v177, s49, v177
v_pk_mul_f16 v155, v155, v154
v_fma_mix_f32 v167, v186, v186, v167 op_sel:[0,0,0] op_sel_hi:[1,1,0]
v_pk_mul_f16 v152, v152, v151
v_bfe_u32 v176, v177, 2, 14
v_pk_mul_f16 v149, v149, v148
v_fma_mix_f32 v156, v155, v155, v156 op_sel:[0,0,0] op_sel_hi:[1,1,0]
v_fma_mix_f32 v156, v155, v155, v156 op_sel:[1,1,0] op_sel_hi:[1,1,0]
v_lshrrev_b32 v177, 18, v177
v_fma_mix_f32 v167, v187, v187, v167 op_sel:[1,1,0] op_sel_hi:[1,1,0]
v_fma_mix_f32 v156, v152, v152, v156 op_sel:[0,0,0] op_sel_hi:[1,1,0]
v_fma_mix_f32 v156, v152, v152, v156 op_sel:[1,1,0] op_sel_hi:[1,1,0]
v_fma_mix_f32 v156, v149, v149, v156 op_sel:[0,0,0] op_sel_hi:[1,1,0]
v_fma_mix_f32 v156, v149, v149, v156 op_sel:[1,1,0] op_sel_hi:[1,1,0]
s_setprio 2
v_mfma_f32_32x32x16_bf16 v[0:15], v[228:231], v[228:231], 0
s_add_u32 s46, s80, 8388608
buffer_store_dwordx4 v[64:67], v241, s[32:35], s46 offen sc1
ds_read_b128 v[224:227], v248 offset:32768
ds_read_u16_d16 v176, v176
ds_read_u16_d16_hi v177, v177
v_cvt_pkrtz_f16_f32 v179, v120, v121
v_cvt_pkrtz_f16_f32 v181, v122, v123
v_cvt_pkrtz_f16_f32 v183, v124, v125
v_mfma_f32_32x32x16_bf16 v[16:31], v[228:231], v[228:231], 0
v_cvt_pkrtz_f16_f32 v185, v126, v127
v_cvt_pkrtz_f16_f32 v187, v128, v129
v_cvt_pk_f16_f32 v155, v130, v131
v_cvt_pk_f16_f32 v152, v132, v133
v_mfma_f32_32x32x16_bf16 v[32:47], v[228:231], v[228:231], 0
v_cvt_pk_f16_f32 v149, v134, v135
v_pk_fma_f16 v154, v155, v155, s48
v_and_b32_e64 v179, s49, v179
v_mfma_f32_32x32x16_bf16 v[120:135], v[72:75], v[232:235], 0
ds_read_b128 v[228:231], v248 offset:30720
v_fma_mix_f32 v156, v136, v136, v156 op_sel:[0,0,0] op_sel_hi:[1,1,0]
v_pk_fma_f16 v151, v152, v152, s48
v_pk_fma_f16 v148, v149, v149, s48
v_bfe_u32 v178, v179, 2, 14
v_pk_mul_f16 v154, v155, v154
v_pk_mul_f16 v151, v152, v151
v_fma_mix_f32 v156, v137, v137, v156 op_sel:[1,1,0] op_sel_hi:[1,1,0]
s_waitcnt lgkmcnt(4)
v_mfma_f32_32x32x16_bf16 v[120:135], v[76:79], v[236:239], v[120:135]
ds_read_b128 v[232:235], v245 offset:384
ds_read_b128 v[200:203], v242 offset:128
ds_read_b128 v[204:207], v243
ds_read_u16_d16 v178, v178
v_lshrrev_b32 v179, 18, v179
v_pk_mul_f16 v148, v149, v148
v_exp_f16 v153, v154
v_exp_f16 v150, v151
v_and_b32_e64 v181, s49, v181
v_fma_mix_f32 v156, v138, v138, v156 op_sel:[0,0,0] op_sel_hi:[1,1,0]
v_mfma_f32_32x32x16_bf16 v[120:135], v[80:83], v[216:219], v[120:135]
ds_read_b128 v[236:239], v248 offset:33792
ds_read_u16_d16_hi v179, v179
v_exp_f16_e64 v147, v148
v_bfe_u32 v180, v181, 2, 14
v_exp_f16_sdwa v153, v154 dst_sel:WORD_1 dst_unused:UNUSED_PRESERVE src0_sel:WORD_1
v_lshrrev_b32_e64 v181, 18, v181
v_fma_mix_f32 v156, v139, v139, v156 op_sel:[1,1,0] op_sel_hi:[1,1,0]
v_smfmac_f32_16x16x32_bf16 v[0:3], v[220:221], v[192:195], v246
ds_read_b128 v[216:219], v245 offset:768
ds_read_b128 v[208:211], v243 offset:64
ds_read_b128 v[212:215], v243 offset:128
ds_read_u16_d16 v180, v180
ds_read_u16_d16_hi v181, v181
v_exp_f16_sdwa v150, v151 dst_sel:WORD_1 dst_unused:UNUSED_PRESERVE src0_sel:WORD_1
v_smfmac_f32_16x16x32_bf16 v[16:19], v[222:223], v[196:199], v246
v_exp_f16_sdwa v147, v148 dst_sel:WORD_1 dst_unused:UNUSED_PRESERVE src0_sel:WORD_1
v_and_b32 v183, s49, v183
v_fma_mix_f32 v156, v140, v140, v156 op_sel:[0,0,0] op_sel_hi:[1,1,0]
v_pk_add_f16 v153, v153, 1.0 op_sel_hi:[1,0]
s_waitcnt lgkmcnt(7)
v_mfma_f32_32x32x16_bf16 v[120:135], v[84:87], v[224:227], v[120:135]
ds_read_b128 v[220:223], v245 offset:1152
ds_read_b128 v[192:195], v244
ds_read_b128 v[196:199], v244 offset:64
v_bfe_u32 v182, v183, 2, 14
v_pk_add_f16 v150, v150, 1.0 op_sel_hi:[1,0]
v_pk_add_f16 v147, v147, 1.0 op_sel_hi:[1,0]
v_rcp_f16 v154, v153
v_lshrrev_b32 v183, 18, v183
v_fma_mix_f32 v156, v141, v141, v156 op_sel:[1,1,0] op_sel_hi:[1,1,0]
v_mfma_f32_32x32x16_bf16 v[120:135], v[88:91], v[228:231], v[120:135]
ds_read_b128 v[224:227], v248 offset:34816
ds_read_u16_d16 v182, v182
ds_read_u16_d16_hi v183, v183
v_rcp_f16 v151, v150
v_and_b32 v185, s49, v185
v_rcp_f16_e64 v148, v147
v_fma_mix_f32 v156, v142, v142, v156 op_sel:[0,0,0] op_sel_hi:[1,1,0]
v_bfe_u32 v184, v185, 2, 14
v_smfmac_f32_16x16x32_bf16 v[32:35], v[232:233], v[200:203], v246
ds_read_b128 v[228:231], v248 offset:37888
ds_read_u16_d16 v184, v184
v_rcp_f16_sdwa v154, v153 dst_sel:WORD_1 dst_unused:UNUSED_PRESERVE src0_sel:WORD_1
v_rcp_f16_sdwa v151, v150 dst_sel:WORD_1 dst_unused:UNUSED_PRESERVE src0_sel:WORD_1
v_smfmac_f32_16x16x32_bf16 v[0:3], v[234:235], v[204:207], v246
v_lshrrev_b32 v185, 18, v185
v_fma_mix_f32 v156, v143, v143, v156 op_sel:[1,1,0] op_sel_hi:[1,1,0]
s_waitcnt lgkmcnt(6)
v_mfma_f32_32x32x16_bf16 v[120:135], v[92:95], v[236:239], v[120:135]
ds_read_b128 v[232:235], v248 offset:35840
ds_read_u16_d16_hi v185, v185
v_rcp_f16_sdwa v148, v147 dst_sel:WORD_1 dst_unused:UNUSED_PRESERVE src0_sel:WORD_1
v_and_b32_e64 v187, s49, v187
v_pk_mul_f16 v155, v155, v154
v_fma_mix_f32 v156, v176, v176, v156 op_sel:[0,0,0] op_sel_hi:[1,1,0]
v_pk_mul_f16 v152, v152, v151
v_bfe_u32 v186, v187, 2, 14
v_pk_mul_f16 v149, v149, v148
v_smfmac_f32_16x16x32_bf16 v[16:19], v[216:217], v[208:211], v246
ds_read_b128 v[236:239], v248 offset:38912
ds_read_u16_d16 v186, v186
v_fma_mix_f32 v157, v155, v155, v157 op_sel:[0,0,0] op_sel_hi:[1,1,0]
v_fma_mix_f32 v157, v155, v155, v157 op_sel:[1,1,0] op_sel_hi:[1,1,0]
v_lshrrev_b32_e64 v187, 18, v187
v_fma_mix_f32 v156, v177, v177, v156 op_sel:[1,1,0] op_sel_hi:[1,1,0]
v_smfmac_f32_16x16x32_bf16 v[32:35], v[218:219], v[212:215], v246
v_fma_mix_f32 v157, v152, v152, v157 op_sel:[0,0,0] op_sel_hi:[1,1,0]
v_fma_mix_f32 v157, v152, v152, v157 op_sel:[1,1,0] op_sel_hi:[1,1,0]
v_fma_mix_f32 v157, v149, v149, v157 op_sel:[0,0,0] op_sel_hi:[1,1,0]
v_fma_mix_f32 v157, v149, v149, v157 op_sel:[1,1,0] op_sel_hi:[1,1,0]
s_setprio 1
v_smfmac_f32_16x16x32_bf16 v[0:3], v[220:221], v[192:195], v246
s_waitcnt lgkmcnt(4)
s_add_u32 s46, s80, 10485760
buffer_store_dwordx4 v[68:71], v241, s[32:35], s46 offen sc1
ds_read_b128 v[216:219], v248 offset:36864
ds_read_u16_d16_hi v187, v187
v_cvt_pkrtz_f16_f32 v137, v120, v121
v_cvt_pkrtz_f16_f32 v139, v122, v123
v_cvt_pkrtz_f16_f32 v141, v124, v125
v_cvt_pkrtz_f16_f32 v143, v126, v127
v_cvt_pk_f16_f32 v155, v128, v129
v_smfmac_f32_16x16x32_bf16 v[16:19], v[222:223], v[196:199], v246
v_cvt_pk_f16_f32 v152, v130, v131
v_cvt_pk_f16_f32 v149, v132, v133
v_cvt_pk_f16_f32 v146, v134, v135
v_pk_fma_f16 v154, v155, v155, s48
v_and_b32_e64 v137, s49, v137
v_mfma_f32_32x32x16_bf16 v[120:135], v[72:75], v[224:227], 0
ds_read_b128 v[220:223], v248 offset:39936
v_fma_mix_f32 v157, v178, v178, v157 op_sel:[0,0,0] op_sel_hi:[1,1,0]
v_pk_fma_f16 v151, v152, v152, s48
v_pk_fma_f16 v148, v149, v149, s48
v_pk_fma_f16 v145, v146, v146, s48
v_pk_mul_f16 v154, v155, v154
v_bfe_u32 v136, v137, 2, 14
v_pk_mul_f16 v151, v152, v151
v_fma_mix_f32 v157, v179, v179, v157 op_sel:[1,1,0] op_sel_hi:[1,1,0]
v_pk_mul_f16 v148, v149, v148
v_pk_mul_f16 v145, v146, v145
v_mfma_f32_32x32x16_bf16 v[120:135], v[76:79], v[228:231], v[120:135]
ds_read_b128 v[224:227], v245 offset:1536
ds_read_b128 v[200:203], v244 offset:128
v_xor_b32 v242, 16, v242
ds_read_b128 v[204:207], v242
ds_read_u16_d16 v136, v136
v_exp_f16 v153, v154
v_lshrrev_b32 v137, 18, v137
v_exp_f16 v150, v151
v_fma_mix_f32 v157, v180, v180, v157 op_sel:[0,0,0] op_sel_hi:[1,1,0]
v_exp_f16 v147, v148
v_and_b32 v139, s49, v139
v_exp_f16 v144, v145
s_waitcnt lgkmcnt(5)
v_mfma_f32_32x32x16_bf16 v[120:135], v[80:83], v[232:235], v[120:135]
ds_read_b128 v[228:231], v245 offset:1920
ds_read_b128 v[208:211], v242 offset:64
ds_read_b128 v[212:215], v242 offset:128
ds_read_u16_d16_hi v137, v137
v_exp_f16_sdwa v153, v154 dst_sel:WORD_1 dst_unused:UNUSED_PRESERVE src0_sel:WORD_1
v_fma_mix_f32 v157, v181, v181, v157 op_sel:[1,1,0] op_sel_hi:[1,1,0]
v_bfe_u32 v138, v139, 2, 14
v_exp_f16_sdwa v150, v151 dst_sel:WORD_1 dst_unused:UNUSED_PRESERVE src0_sel:WORD_1
v_exp_f16_sdwa v147, v148 dst_sel:WORD_1 dst_unused:UNUSED_PRESERVE src0_sel:WORD_1
v_exp_f16_sdwa v144, v145 dst_sel:WORD_1 dst_unused:UNUSED_PRESERVE src0_sel:WORD_1
v_lshrrev_b32_e64 v139, 18, v139
v_fma_mix_f32 v157, v182, v182, v157 op_sel:[0,0,0] op_sel_hi:[1,1,0]
v_mfma_f32_32x32x16_bf16 v[120:135], v[84:87], v[236:239], v[120:135]
ds_read_b128 v[232:235], v248 offset:40960
ds_read_u16_d16 v138, v138
ds_read_u16_d16_hi v139, v139
v_pk_add_f16 v153, v153, 1.0 op_sel_hi:[1,0]
v_pk_add_f16 v150, v150, 1.0 op_sel_hi:[1,0]
v_pk_add_f16 v147, v147, 1.0 op_sel_hi:[1,0]
v_and_b32_e64 v141, s49, v141
v_pk_add_f16 v144, v144, 1.0 op_sel_hi:[1,0]
v_rcp_f16_e64 v154, v153
v_fma_mix_f32 v157, v183, v183, v157 op_sel:[1,1,0] op_sel_hi:[1,1,0]
v_rcp_f16_e64 v151, v150
v_mfma_f32_32x32x16_bf16 v[120:135], v[88:91], v[216:219], v[120:135]
ds_read_b128 v[236:239], v248 offset:44032
v_bfe_u32 v140, v141, 2, 14
v_rcp_f16_e64 v148, v147
v_fma_mix_f32 v157, v184, v184, v157 op_sel:[0,0,0] op_sel_hi:[1,1,0]
v_rcp_f16 v145, v144
v_lshrrev_b32 v141, 18, v141
v_rcp_f16_sdwa v154, v153 dst_sel:WORD_1 dst_unused:UNUSED_PRESERVE src0_sel:WORD_1
s_setprio 0
v_rcp_f16_sdwa v151, v150 dst_sel:WORD_1 dst_unused:UNUSED_PRESERVE src0_sel:WORD_1
s_waitcnt lgkmcnt(4)
v_mfma_f32_32x32x16_bf16 v[120:135], v[92:95], v[220:223], v[120:135]
ds_read_b128 v[216:219], v248 offset:41984
ds_read_u16_d16 v140, v140
ds_read_u16_d16_hi v141, v141
v_fma_mix_f32 v157, v185, v185, v157 op_sel:[1,1,0] op_sel_hi:[1,1,0]
v_and_b32_e64 v143, s49, v143
v_rcp_f16_sdwa v148, v147 dst_sel:WORD_1 dst_unused:UNUSED_PRESERVE src0_sel:WORD_1
v_rcp_f16_sdwa v145, v144 dst_sel:WORD_1 dst_unused:UNUSED_PRESERVE src0_sel:WORD_1
v_pk_mul_f16 v155, v155, v154
v_bfe_u32 v142, v143, 2, 14
v_fma_mix_f32 v157, v186, v186, v157 op_sel:[0,0,0] op_sel_hi:[1,1,0]
v_pk_mul_f16 v152, v152, v151
v_pk_mul_f16 v149, v149, v148
v_smfmac_f32_16x16x32_bf16 v[32:35], v[224:225], v[200:203], v246
ds_read_b128 v[220:223], v248 offset:45056
ds_read_u16_d16 v142, v142
v_pk_mul_f16 v146, v146, v145
v_fma_mix_f32 v158, v155, v155, v158 op_sel:[0,0,0] op_sel_hi:[1,1,0]
v_lshrrev_b32 v143, 18, v143
v_fma_mix_f32 v158, v155, v155, v158 op_sel:[1,1,0] op_sel_hi:[1,1,0]
v_fma_mix_f32 v158, v152, v152, v158 op_sel:[0,0,0] op_sel_hi:[1,1,0]
v_smfmac_f32_16x16x32_bf16 v[4:7], v[226:227], v[204:207], v246
v_fma_mix_f32 v157, v187, v187, v157 op_sel:[1,1,0] op_sel_hi:[1,1,0]
v_fma_mix_f32 v158, v152, v152, v158 op_sel:[1,1,0] op_sel_hi:[1,1,0]
v_fma_mix_f32 v158, v149, v149, v158 op_sel:[0,0,0] op_sel_hi:[1,1,0]
v_fma_mix_f32 v158, v149, v149, v158 op_sel:[1,1,0] op_sel_hi:[1,1,0]
v_fma_mix_f32 v158, v146, v146, v158 op_sel:[0,0,0] op_sel_hi:[1,1,0]
v_fma_mix_f32 v158, v146, v146, v158 op_sel:[1,1,0] op_sel_hi:[1,1,0]
s_setprio 2
v_smfmac_f32_16x16x32_bf16 v[20:23], v[228:229], v[208:211], v246
ds_read_b128 v[224:227], v248 offset:43008
ds_read_u16_d16_hi v143, v143
v_cvt_pkrtz_f16_f32 v179, v120, v121
v_cvt_pkrtz_f16_f32 v181, v122, v123
v_cvt_pkrtz_f16_f32 v183, v124, v125
v_cvt_pkrtz_f16_f32 v185, v126, v127
v_smfmac_f32_16x16x32_bf16 v[36:39], v[230:231], v[212:215], v246
v_cvt_pkrtz_f16_f32 v187, v128, v129
v_cvt_pk_f16_f32 v155, v130, v131
v_cvt_pk_f16_f32 v152, v132, v133
v_cvt_pk_f16_f32 v149, v134, v135
v_pk_fma_f16 v154, v155, v155, s48
s_waitcnt lgkmcnt(2)
v_mfma_f32_32x32x16_bf16 v[120:135], v[72:75], v[232:235], 0
ds_read_b128 v[228:231], v248 offset:46080
v_and_b32 v179, s49, v179
v_fma_mix_f32 v158, v136, v136, v158 op_sel:[0,0,0] op_sel_hi:[1,1,0]
v_pk_fma_f16 v151, v152, v152, s48
v_pk_fma_f16 v148, v149, v149, s48
v_bfe_u32 v178, v179, 2, 14
v_pk_mul_f16 v154, v155, v154
v_pk_mul_f16 v151, v152, v151
v_pk_mul_f16 v148, v149, v148
v_lshrrev_b32 v179, 18, v179
v_mfma_f32_32x32x16_bf16 v[120:135], v[76:79], v[236:239], v[120:135]
ds_read_b128 v[232:235], v245 offset:2304
v_xor_b32 v243, 16, v243
ds_read_b128 v[192:195], v243
ds_read_b128 v[196:199], v243 offset:64
ds_read_u16_d16 v178, v178
ds_read_u16_d16_hi v179, v179
v_fma_mix_f32 v158, v137, v137, v158 op_sel:[1,1,0] op_sel_hi:[1,1,0]
v_exp_f16 v153, v154
v_and_b32 v181, s49, v181
v_exp_f16 v150, v151
v_exp_f16 v147, v148
v_bfe_u32 v180, v181, 2, 14
v_mfma_f32_32x32x16_bf16 v[120:135], v[80:83], v[216:219], v[120:135]
ds_read_b128 v[236:239], v245 offset:2688
ds_read_b128 v[200:203], v243 offset:128
v_xor_b32 v244, 16, v244
ds_read_b128 v[204:207], v244
ds_read_u16_d16 v180, v180
v_fma_mix_f32 v158, v138, v138, v158 op_sel:[0,0,0] op_sel_hi:[1,1,0]
v_exp_f16_sdwa v153, v154 dst_sel:WORD_1 dst_unused:UNUSED_PRESERVE src0_sel:WORD_1
v_lshrrev_b32 v181, 18, v181
v_exp_f16_sdwa v150, v151 dst_sel:WORD_1 dst_unused:UNUSED_PRESERVE src0_sel:WORD_1
v_fma_mix_f32 v158, v139, v139, v158 op_sel:[1,1,0] op_sel_hi:[1,1,0]
v_and_b32_e64 v183, s49, v183
v_mfma_f32_32x32x16_bf16 v[120:135], v[84:87], v[220:223], v[120:135]
ds_read_b128 v[216:219], v248 offset:47104
ds_read_u16_d16_hi v181, v181
v_exp_f16_sdwa v147, v148 dst_sel:WORD_1 dst_unused:UNUSED_PRESERVE src0_sel:WORD_1
v_pk_add_f16 v153, v153, 1.0 op_sel_hi:[1,0]
v_bfe_u32 v182, v183, 2, 14
v_pk_add_f16 v150, v150, 1.0 op_sel_hi:[1,0]
v_pk_add_f16 v147, v147, 1.0 op_sel_hi:[1,0]
v_rcp_f16_e64 v154, v153
v_lshrrev_b32 v183, 18, v183
v_fma_mix_f32 v158, v140, v140, v158 op_sel:[0,0,0] op_sel_hi:[1,1,0]
s_waitcnt lgkmcnt(6)
v_mfma_f32_32x32x16_bf16 v[120:135], v[88:91], v[224:227], v[120:135]
ds_read_b128 v[220:223], v248 offset:50176
ds_read_u16_d16 v182, v182
ds_read_u16_d16_hi v183, v183
v_rcp_f16 v151, v150
v_and_b32 v185, s49, v185
v_rcp_f16_e64 v148, v147
v_fma_mix_f32 v158, v141, v141, v158 op_sel:[1,1,0] op_sel_hi:[1,1,0]
v_bfe_u32 v184, v185, 2, 14
v_rcp_f16_sdwa v154, v153 dst_sel:WORD_1 dst_unused:UNUSED_PRESERVE src0_sel:WORD_1
v_mfma_f32_32x32x16_bf16 v[120:135], v[92:95], v[228:231], v[120:135]
ds_read_b128 v[224:227], v248 offset:48128
ds_read_u16_d16 v184, v184
v_rcp_f16_sdwa v151, v150 dst_sel:WORD_1 dst_unused:UNUSED_PRESERVE src0_sel:WORD_1
v_lshrrev_b32_e64 v185, 18, v185
v_rcp_f16_sdwa v148, v147 dst_sel:WORD_1 dst_unused:UNUSED_PRESERVE src0_sel:WORD_1
v_and_b32_e64 v187, s49, v187
v_fma_mix_f32 v158, v142, v142, v158 op_sel:[0,0,0] op_sel_hi:[1,1,0]
v_pk_mul_f16 v155, v155, v154
v_pk_mul_f16 v152, v152, v151
v_smfmac_f32_16x16x32_bf16 v[4:7], v[232:233], v[192:195], v246
ds_read_b128 v[228:231], v248 offset:51200
ds_read_u16_d16_hi v185, v185
v_bfe_u32 v186, v187, 2, 14
v_pk_mul_f16 v149, v149, v148
v_fma_mix_f32 v159, v155, v155, v159 op_sel:[0,0,0] op_sel_hi:[1,1,0]
v_fma_mix_f32 v158, v143, v143, v158 op_sel:[1,1,0] op_sel_hi:[1,1,0]
v_lshrrev_b32_e64 v187, 18, v187
v_smfmac_f32_16x16x32_bf16 v[20:23], v[234:235], v[196:199], v246
v_fma_mix_f32 v159, v155, v155, v159 op_sel:[1,1,0] op_sel_hi:[1,1,0]
v_fma_mix_f32 v159, v152, v152, v159 op_sel:[0,0,0] op_sel_hi:[1,1,0]
v_fma_mix_f32 v159, v152, v152, v159 op_sel:[1,1,0] op_sel_hi:[1,1,0]
v_fma_mix_f32 v159, v149, v149, v159 op_sel:[0,0,0] op_sel_hi:[1,1,0]
v_fma_mix_f32 v159, v149, v149, v159 op_sel:[1,1,0] op_sel_hi:[1,1,0]
s_setprio 1
s_waitcnt lgkmcnt(4)
v_smfmac_f32_16x16x32_bf16 v[36:39], v[236:237], v[200:203], v246
ds_read_b128 v[232:235], v248 offset:49152
ds_read_u16_d16 v186, v186
ds_read_u16_d16_hi v187, v187
v_cvt_pkrtz_f16_f32 v137, v120, v121
v_cvt_pkrtz_f16_f32 v139, v122, v123
v_cvt_pkrtz_f16_f32 v141, v124, v125
v_cvt_pkrtz_f16_f32 v143, v126, v127
v_cvt_pk_f16_f32 v155, v128, v129
v_smfmac_f32_16x16x32_bf16 v[4:7], v[238:239], v[204:207], v246
v_cvt_pk_f16_f32 v152, v130, v131
v_cvt_pk_f16_f32 v149, v132, v133
v_cvt_pk_f16_f32 v146, v134, v135
v_pk_fma_f16 v154, v155, v155, s48
v_and_b32_e64 v137, s49, v137
v_mfma_f32_32x32x16_bf16 v[120:135], v[72:75], v[216:219], 0
ds_read_b128 v[236:239], v248 offset:52224
v_fma_mix_f32 v159, v178, v178, v159 op_sel:[0,0,0] op_sel_hi:[1,1,0]
v_pk_fma_f16 v151, v152, v152, s48
v_pk_fma_f16 v148, v149, v149, s48
v_pk_fma_f16 v145, v146, v146, s48
v_pk_mul_f16 v154, v155, v154
v_bfe_u32 v136, v137, 2, 14
v_pk_mul_f16 v151, v152, v151
v_fma_mix_f32 v159, v179, v179, v159 op_sel:[1,1,0] op_sel_hi:[1,1,0]
v_pk_mul_f16 v148, v149, v148
v_pk_mul_f16 v145, v146, v145
v_mfma_f32_32x32x16_bf16 v[120:135], v[76:79], v[220:223], v[120:135]
ds_read_b128 v[216:219], v245 offset:3072
ds_read_b128 v[208:211], v244 offset:64
ds_read_b128 v[212:215], v244 offset:128
ds_read_u16_d16 v136, v136
v_exp_f16 v153, v154
v_lshrrev_b32 v137, 18, v137
v_exp_f16_e64 v150, v151
v_fma_mix_f32 v159, v180, v180, v159 op_sel:[0,0,0] op_sel_hi:[1,1,0]
v_exp_f16 v147, v148
v_and_b32 v139, s49, v139
v_exp_f16_e64 v144, v145
s_waitcnt lgkmcnt(5)
v_mfma_f32_32x32x16_bf16 v[120:135], v[80:83], v[224:227], v[120:135]
ds_read_b128 v[220:223], v245 offset:3456
v_xor_b32 v242, 32, v242
ds_read_b128 v[192:195], v242
ds_read_b128 v[196:199], v242 offset:64
ds_read_u16_d16_hi v137, v137
v_exp_f16_sdwa v153, v154 dst_sel:WORD_1 dst_unused:UNUSED_PRESERVE src0_sel:WORD_1
v_fma_mix_f32 v159, v181, v181, v159 op_sel:[1,1,0] op_sel_hi:[1,1,0]
v_bfe_u32 v138, v139, 2, 14
v_exp_f16_sdwa v150, v151 dst_sel:WORD_1 dst_unused:UNUSED_PRESERVE src0_sel:WORD_1
v_exp_f16_sdwa v147, v148 dst_sel:WORD_1 dst_unused:UNUSED_PRESERVE src0_sel:WORD_1
v_exp_f16_sdwa v144, v145 dst_sel:WORD_1 dst_unused:UNUSED_PRESERVE src0_sel:WORD_1
v_lshrrev_b32_e64 v139, 18, v139
v_fma_mix_f32 v159, v182, v182, v159 op_sel:[0,0,0] op_sel_hi:[1,1,0]
v_mfma_f32_32x32x16_bf16 v[120:135], v[84:87], v[228:231], v[120:135]
ds_read_b128 v[224:227], v248 offset:53248
ds_read_u16_d16 v138, v138
ds_read_u16_d16_hi v139, v139
v_pk_add_f16 v153, v153, 1.0 op_sel_hi:[1,0]
v_pk_add_f16 v150, v150, 1.0 op_sel_hi:[1,0]
v_pk_add_f16 v147, v147, 1.0 op_sel_hi:[1,0]
v_and_b32_e64 v141, s49, v141
v_pk_add_f16 v144, v144, 1.0 op_sel_hi:[1,0]
v_rcp_f16_e64 v154, v153
v_fma_mix_f32 v159, v183, v183, v159 op_sel:[1,1,0] op_sel_hi:[1,1,0]
v_rcp_f16_e64 v151, v150
v_mfma_f32_32x32x16_bf16 v[120:135], v[88:91], v[232:235], v[120:135]
ds_read_b128 v[228:231], v248 offset:56320
v_bfe_u32 v140, v141, 2, 14
v_rcp_f16_e64 v148, v147
v_fma_mix_f32 v159, v184, v184, v159 op_sel:[0,0,0] op_sel_hi:[1,1,0]
v_rcp_f16 v145, v144
v_lshrrev_b32 v141, 18, v141
v_rcp_f16_sdwa v154, v153 dst_sel:WORD_1 dst_unused:UNUSED_PRESERVE src0_sel:WORD_1
s_setprio 0
v_rcp_f16_sdwa v151, v150 dst_sel:WORD_1 dst_unused:UNUSED_PRESERVE src0_sel:WORD_1
s_waitcnt lgkmcnt(4)
v_mfma_f32_32x32x16_bf16 v[120:135], v[92:95], v[236:239], v[120:135]
ds_read_b128 v[232:235], v248 offset:54272
ds_read_u16_d16 v140, v140
ds_read_u16_d16_hi v141, v141
v_fma_mix_f32 v159, v185, v185, v159 op_sel:[1,1,0] op_sel_hi:[1,1,0]
v_and_b32_e64 v143, s49, v143
v_rcp_f16_sdwa v148, v147 dst_sel:WORD_1 dst_unused:UNUSED_PRESERVE src0_sel:WORD_1
v_rcp_f16_sdwa v145, v144 dst_sel:WORD_1 dst_unused:UNUSED_PRESERVE src0_sel:WORD_1
v_pk_mul_f16 v155, v155, v154
v_bfe_u32 v142, v143, 2, 14
v_fma_mix_f32 v159, v186, v186, v159 op_sel:[0,0,0] op_sel_hi:[1,1,0]
v_pk_mul_f16 v152, v152, v151
v_pk_mul_f16 v149, v149, v148
v_smfmac_f32_16x16x32_bf16 v[20:23], v[216:217], v[208:211], v246
ds_read_b128 v[236:239], v248 offset:57344
ds_read_u16_d16 v142, v142
v_pk_mul_f16 v146, v146, v145
v_fma_mix_f32 v160, v155, v155, v160 op_sel:[0,0,0] op_sel_hi:[1,1,0]
v_lshrrev_b32_e64 v143, 18, v143
v_fma_mix_f32 v160, v155, v155, v160 op_sel:[1,1,0] op_sel_hi:[1,1,0]
v_fma_mix_f32 v160, v152, v152, v160 op_sel:[0,0,0] op_sel_hi:[1,1,0]
v_smfmac_f32_16x16x32_bf16 v[36:39], v[218:219], v[212:215], v246
v_fma_mix_f32 v159, v187, v187, v159 op_sel:[1,1,0] op_sel_hi:[1,1,0]
v_fma_mix_f32 v160, v152, v152, v160 op_sel:[1,1,0] op_sel_hi:[1,1,0]
v_fma_mix_f32 v160, v149, v149, v160 op_sel:[0,0,0] op_sel_hi:[1,1,0]
v_fma_mix_f32 v160, v149, v149, v160 op_sel:[1,1,0] op_sel_hi:[1,1,0]
v_fma_mix_f32 v160, v146, v146, v160 op_sel:[0,0,0] op_sel_hi:[1,1,0]
v_fma_mix_f32 v160, v146, v146, v160 op_sel:[1,1,0] op_sel_hi:[1,1,0]
s_cmp_lg_u32 s40, 7
s_cbranch_scc1 Lnobias2
s_sub_u32 s43, s2, 96
s_cmp_lt_u32 s43, 96
s_cbranch_scc0 Lnobias2
s_waitcnt vmcnt(13)
v_lshlrev_b32 v102, 16, v102
v_lshlrev_b32 v103, 16, v103
v_lshlrev_b32 v104, 16, v104
v_lshlrev_b32 v105, 16, v105
v_lshlrev_b32 v106, 16, v106
v_lshlrev_b32 v107, 16, v107
v_lshlrev_b32 v108, 16, v108
v_lshlrev_b32 v109, 16, v109
v_lshlrev_b32 v110, 16, v110
v_lshlrev_b32 v111, 16, v111
v_lshlrev_b32 v112, 16, v112
v_lshlrev_b32 v113, 16, v113
v_mul_f32 v100, v102, v108
v_fmac_f32 v100, v103, v109
v_fmac_f32 v100, v104, v110
v_fmac_f32 v100, v105, v111
v_fmac_f32 v100, v106, v112
v_fmac_f32 v100, v107, v113
s_nop 1
v_add_f32_dpp v100, v100, v100 row_ror:8 row_mask:0xf bank_mask:0xf
s_nop 1
v_add_f32_dpp v100, v100, v100 row_ror:4 row_mask:0xf bank_mask:0xf
s_nop 1
v_add_f32_dpp v100, v100, v100 row_ror:2 row_mask:0xf bank_mask:0xf
s_nop 1
v_add_f32_dpp v100, v100, v100 row_ror:1 row_mask:0xf bank_mask:0xf
v_mov_b32 v101, v100
s_nop 1
v_permlane16_swap_b32 v100, v101
v_add_f32 v100, v100, v101
v_mov_b32_e64 v101, v100
s_nop 1
v_permlane32_swap_b32 v100, v101
v_add_f32 v100, v100, v101
s_lshl_b32 s44, s43, 2
s_add_u32 s44, s44, 394752
v_lshlrev_b32_e64 v115, 11, v251
s_mov_b64 exec, 0xff
buffer_store_dword v100, v115, s[32:35], s44 offen sc1
s_mov_b64 exec, -1
Lnobias2:
s_setprio 2
v_smfmac_f32_16x16x32_bf16 v[12:15], v[220:221], v[192:195], v246
ds_read_b128 v[216:219], v248 offset:55296
ds_read_u16_d16_hi v143, v143
v_cvt_pkrtz_f16_f32 v179, v120, v121
v_cvt_pkrtz_f16_f32 v181, v122, v123
v_cvt_pkrtz_f16_f32 v183, v124, v125
v_cvt_pkrtz_f16_f32 v185, v126, v127
v_smfmac_f32_16x16x32_bf16 v[28:31], v[222:223], v[196:199], v246
v_cvt_pkrtz_f16_f32 v187, v128, v129
v_cvt_pk_f16_f32 v155, v130, v131
v_cvt_pk_f16_f32 v152, v132, v133
v_cvt_pk_f16_f32 v149, v134, v135
s_waitcnt lgkmcnt(2)
v_mfma_f32_32x32x16_bf16 v[120:135], v[72:75], v[224:227], 0
ds_read_b128 v[220:223], v245 offset:3840
ds_read_b128 v[200:203], v242 offset:128
v_xor_b32 v243, 32, v243
ds_read_b128 v[204:207], v243
v_pk_fma_f16 v154, v155, v155, s48
v_and_b32_e64 v179, s49, v179
v_fma_mix_f32 v160, v136, v136, v160 op_sel:[0,0,0] op_sel_hi:[1,1,0]
v_pk_fma_f16 v151, v152, v152, s48
v_pk_fma_f16 v148, v149, v149, s48
v_bfe_u32 v178, v179, 2, 14
v_pk_mul_f16 v154, v155, v154
v_pk_mul_f16 v151, v152, v151
v_mfma_f32_32x32x16_bf16 v[120:135], v[76:79], v[228:231], v[120:135]
ds_read_b128 v[224:227], v248 offset:58368
ds_read_u16_d16 v178, v178
v_pk_mul_f16 v148, v149, v148
v_lshrrev_b32_e64 v179, 18, v179
v_fma_mix_f32 v160, v137, v137, v160 op_sel:[1,1,0] op_sel_hi:[1,1,0]
v_exp_f16 v153, v154
v_and_b32 v181, s49, v181
v_exp_f16_e64 v150, v151
v_mfma_f32_32x32x16_bf16 v[120:135], v[80:83], v[232:235], v[120:135]
ds_read_b128 v[228:231], v245 offset:4224
ds_read_b128 v[208:211], v243 offset:64
ds_read_b128 v[212:215], v243 offset:128
ds_read_u16_d16_hi v179, v179
v_exp_f16_e64 v147, v148
v_bfe_u32 v180, v181, 2, 14
v_fma_mix_f32 v160, v138, v138, v160 op_sel:[0,0,0] op_sel_hi:[1,1,0]
v_exp_f16_sdwa v153, v154 dst_sel:WORD_1 dst_unused:UNUSED_PRESERVE src0_sel:WORD_1
v_lshrrev_b32 v181, 18, v181
v_mfma_f32_32x32x16_bf16 v[120:135], v[84:87], v[236:239], v[120:135]
ds_read_b128 v[232:235], v245 offset:4608
v_xor_b32 v244, 32, v244
ds_read_b128 v[192:195], v244
ds_read_b128 v[196:199], v244 offset:64
ds_read_u16_d16 v180, v180
ds_read_u16_d16_hi v181, v181
v_exp_f16_sdwa v150, v151 dst_sel:WORD_1 dst_unused:UNUSED_PRESERVE src0_sel:WORD_1
v_fma_mix_f32 v160, v139, v139, v160 op_sel:[1,1,0] op_sel_hi:[1,1,0]
v_and_b32 v183, s49, v183
v_exp_f16_sdwa v147, v148 dst_sel:WORD_1 dst_unused:UNUSED_PRESERVE src0_sel:WORD_1
v_pk_add_f16 v153, v153, 1.0 op_sel_hi:[1,0]
v_bfe_u32 v182, v183, 2, 14
v_pk_add_f16 v150, v150, 1.0 op_sel_hi:[1,0]
s_waitcnt lgkmcnt(9)
v_mfma_f32_32x32x16_bf16 v[120:135], v[88:91], v[216:219], v[120:135]
ds_read_b128 v[236:239], v248 offset:59392
ds_read_u16_d16 v182, v182
v_pk_add_f16 v147, v147, 1.0 op_sel_hi:[1,0]
v_rcp_f16 v154, v153
v_lshrrev_b32 v183, 18, v183
v_fma_mix_f32 v160, v140, v140, v160 op_sel:[0,0,0] op_sel_hi:[1,1,0]
v_rcp_f16 v151, v150
v_and_b32 v185, s49, v185
v_smfmac_f32_16x16x32_bf16 v[44:47], v[220:221], v[200:203], v246
ds_read_b128 v[216:219], v248 offset:62464
ds_read_u16_d16_hi v183, v183
v_rcp_f16_e64 v148, v147
v_fma_mix_f32 v160, v141, v141, v160 op_sel:[1,1,0] op_sel_hi:[1,1,0]
v_bfe_u32 v184, v185, 2, 14
v_smfmac_f32_16x16x32_bf16 v[12:15], v[222:223], v[204:207], v246
v_rcp_f16_sdwa v154, v153 dst_sel:WORD_1 dst_unused:UNUSED_PRESERVE src0_sel:WORD_1
v_rcp_f16_sdwa v151, v150 dst_sel:WORD_1 dst_unused:UNUSED_PRESERVE src0_sel:WORD_1
v_mfma_f32_32x32x16_bf16 v[120:135], v[92:95], v[224:227], v[120:135]
ds_read_b128 v[220:223], v248 offset:60416
ds_read_u16_d16 v184, v184
v_lshrrev_b32_e64 v185, 18, v185
v_rcp_f16_sdwa v148, v147 dst_sel:WORD_1 dst_unused:UNUSED_PRESERVE src0_sel:WORD_1
v_and_b32 v187, s49, v187
v_fma_mix_f32 v160, v142, v142, v160 op_sel:[0,0,0] op_sel_hi:[1,1,0]
v_pk_mul_f16 v155, v155, v154
v_pk_mul_f16 v152, v152, v151
v_bfe_u32 v186, v187, 2, 14
s_waitcnt lgkmcnt(4)
v_smfmac_f32_16x16x32_bf16 v[28:31], v[228:229], v[208:211], v246
ds_read_b128 v[224:227], v248 offset:63488
ds_read_u16_d16_hi v185, v185
ds_read_u16_d16 v186, v186
v_pk_mul_f16 v149, v149, v148
v_fma_mix_f32 v161, v155, v155, v161 op_sel:[0,0,0] op_sel_hi:[1,1,0]
v_fma_mix_f32 v160, v143, v143, v160 op_sel:[1,1,0] op_sel_hi:[1,1,0]
v_lshrrev_b32_e64 v187, 18, v187
v_smfmac_f32_16x16x32_bf16 v[44:47], v[230:231], v[212:215], v246
v_fma_mix_f32 v161, v155, v155, v161 op_sel:[1,1,0] op_sel_hi:[1,1,0]
v_fma_mix_f32 v161, v152, v152, v161 op_sel:[0,0,0] op_sel_hi:[1,1,0]
v_fma_mix_f32 v161, v152, v152, v161 op_sel:[1,1,0] op_sel_hi:[1,1,0]
v_fma_mix_f32 v161, v149, v149, v161 op_sel:[0,0,0] op_sel_hi:[1,1,0]
v_fma_mix_f32 v161, v149, v149, v161 op_sel:[1,1,0] op_sel_hi:[1,1,0]
v_lshlrev_b32_e64 v252, 7, v251
s_add_u32 s46, s47, 2359296
s_mov_b32 exec_lo, 131071
s_mov_b32 exec_hi, 0
s_mov_b32 m0, 16288
s_nop 0
buffer_load_dword v252, s[4:7], s46 offen lds
s_mov_b64 exec, -1
s_setprio 1
v_smfmac_f32_16x16x32_bf16 v[12:15], v[232:233], v[192:195], v246
ds_read_b128 v[228:231], v248 offset:61440
ds_read_u16_d16_hi v187, v187
v_cvt_pkrtz_f16_f32 v137, v120, v121
v_cvt_pkrtz_f16_f32 v139, v122, v123
v_cvt_pkrtz_f16_f32 v141, v124, v125
v_cvt_pkrtz_f16_f32 v143, v126, v127
v_cvt_pk_f16_f32 v155, v128, v129
v_smfmac_f32_16x16x32_bf16 v[28:31], v[234:235], v[196:199], v246
v_cvt_pk_f16_f32 v152, v130, v131
v_cvt_pk_f16_f32 v149, v132, v133
v_cvt_pk_f16_f32 v146, v134, v135
v_pk_fma_f16 v154, v155, v155, s48
v_and_b32_e64 v137, s49, v137
v_mfma_f32_32x32x16_bf16 v[120:135], v[72:75], v[236:239], 0
ds_read_b128 v[232:235], v248 offset:64512
v_fma_mix_f32 v161, v178, v178, v161 op_sel:[0,0,0] op_sel_hi:[1,1,0]
v_pk_fma_f16 v151, v152, v152, s48
v_pk_fma_f16 v148, v149, v149, s48
v_pk_fma_f16 v145, v146, v146, s48
v_pk_mul_f16 v154, v155, v154
v_bfe_u32 v136, v137, 2, 14
v_pk_mul_f16 v151, v152, v151
v_fma_mix_f32 v161, v179, v179, v161 op_sel:[1,1,0] op_sel_hi:[1,1,0]
v_pk_mul_f16 v148, v149, v148
v_pk_mul_f16 v145, v146, v145
s_waitcnt lgkmcnt(2)
v_mfma_f32_32x32x16_bf16 v[120:135], v[76:79], v[216:219], v[120:135]
ds_read_b128 v[236:239], v245 offset:4992
ds_read_b128 v[200:203], v244 offset:128
v_xor_b32 v242, 16, v242
ds_read_b128 v[204:207], v242
ds_read_u16_d16 v136, v136
v_exp_f16 v153, v154
v_lshrrev_b32 v137, 18, v137
v_exp_f16_e64 v150, v151
v_fma_mix_f32 v161, v180, v180, v161 op_sel:[0,0,0] op_sel_hi:[1,1,0]
v_exp_f16 v147, v148
v_and_b32 v139, s49, v139
v_exp_f16_e64 v144, v145
v_mfma_f32_32x32x16_bf16 v[120:135], v[80:83], v[220:223], v[120:135]
ds_read_b128 v[216:219], v245 offset:5376
ds_read_b128 v[208:211], v242 offset:64
ds_read_b128 v[212:215], v242 offset:128
ds_read_u16_d16_hi v137, v137
v_exp_f16_sdwa v153, v154 dst_sel:WORD_1 dst_unused:UNUSED_PRESERVE src0_sel:WORD_1
v_fma_mix_f32 v161, v181, v181, v161 op_sel:[1,1,0] op_sel_hi:[1,1,0]
v_bfe_u32 v138, v139, 2, 14
v_exp_f16_sdwa v150, v151 dst_sel:WORD_1 dst_unused:UNUSED_PRESERVE src0_sel:WORD_1
v_exp_f16_sdwa v147, v148 dst_sel:WORD_1 dst_unused:UNUSED_PRESERVE src0_sel:WORD_1
v_exp_f16_sdwa v144, v145 dst_sel:WORD_1 dst_unused:UNUSED_PRESERVE src0_sel:WORD_1
v_lshrrev_b32_e64 v139, 18, v139
v_fma_mix_f32 v161, v182, v182, v161 op_sel:[0,0,0] op_sel_hi:[1,1,0]
v_mfma_f32_32x32x16_bf16 v[120:135], v[84:87], v[224:227], v[120:135]
ds_read_b128 v[220:223], v249
ds_read_u16_d16 v138, v138
ds_read_u16_d16_hi v139, v139
v_pk_add_f16 v153, v153, 1.0 op_sel_hi:[1,0]
v_pk_add_f16 v150, v150, 1.0 op_sel_hi:[1,0]
v_pk_add_f16 v147, v147, 1.0 op_sel_hi:[1,0]
v_and_b32_e64 v141, s49, v141
v_pk_add_f16 v144, v144, 1.0 op_sel_hi:[1,0]
v_rcp_f16_e64 v154, v153
v_fma_mix_f32 v161, v183, v183, v161 op_sel:[1,1,0] op_sel_hi:[1,1,0]
v_rcp_f16_e64 v151, v150
v_mfma_f32_32x32x16_bf16 v[120:135], v[88:91], v[228:231], v[120:135]
ds_read_b128 v[224:227], v249 offset:3072
v_bfe_u32 v140, v141, 2, 14
v_rcp_f16_e64 v148, v147
v_fma_mix_f32 v161, v184, v184, v161 op_sel:[0,0,0] op_sel_hi:[1,1,0]
v_rcp_f16 v145, v144
v_lshrrev_b32 v141, 18, v141
v_rcp_f16_sdwa v154, v153 dst_sel:WORD_1 dst_unused:UNUSED_PRESERVE src0_sel:WORD_1
s_setprio 0
v_rcp_f16_sdwa v151, v150 dst_sel:WORD_1 dst_unused:UNUSED_PRESERVE src0_sel:WORD_1
s_waitcnt lgkmcnt(4)
v_mfma_f32_32x32x16_bf16 v[120:135], v[92:95], v[232:235], v[120:135]
ds_read_b128 v[228:231], v249 offset:1024
ds_read_u16_d16 v140, v140
ds_read_u16_d16_hi v141, v141
v_fma_mix_f32 v161, v185, v185, v161 op_sel:[1,1,0] op_sel_hi:[1,1,0]
v_and_b32_e64 v143, s49, v143
v_rcp_f16_sdwa v148, v147 dst_sel:WORD_1 dst_unused:UNUSED_PRESERVE src0_sel:WORD_1
v_rcp_f16_sdwa v145, v144 dst_sel:WORD_1 dst_unused:UNUSED_PRESERVE src0_sel:WORD_1
v_pk_mul_f16 v155, v155, v154
v_bfe_u32 v142, v143, 2, 14
v_fma_mix_f32 v161, v186, v186, v161 op_sel:[0,0,0] op_sel_hi:[1,1,0]
v_pk_mul_f16 v152, v152, v151
v_pk_mul_f16 v149, v149, v148
v_smfmac_f32_16x16x32_bf16 v[44:47], v[236:237], v[200:203], v246
ds_read_b128 v[232:235], v249 offset:4096
ds_read_u16_d16 v142, v142
v_pk_mul_f16 v146, v146, v145
v_fma_mix_f32 v162, v155, v155, v162 op_sel:[0,0,0] op_sel_hi:[1,1,0]
v_lshrrev_b32_e64 v143, 18, v143
v_fma_mix_f32 v162, v155, v155, v162 op_sel:[1,1,0] op_sel_hi:[1,1,0]
v_fma_mix_f32 v162, v152, v152, v162 op_sel:[0,0,0] op_sel_hi:[1,1,0]
v_smfmac_f32_16x16x32_bf16 v[8:11], v[238:239], v[204:207], v246
v_fma_mix_f32 v161, v187, v187, v161 op_sel:[1,1,0] op_sel_hi:[1,1,0]
v_fma_mix_f32 v162, v152, v152, v162 op_sel:[1,1,0] op_sel_hi:[1,1,0]
v_fma_mix_f32 v162, v149, v149, v162 op_sel:[0,0,0] op_sel_hi:[1,1,0]
v_fma_mix_f32 v162, v149, v149, v162 op_sel:[1,1,0] op_sel_hi:[1,1,0]
v_fma_mix_f32 v162, v146, v146, v162 op_sel:[0,0,0] op_sel_hi:[1,1,0]
v_fma_mix_f32 v162, v146, v146, v162 op_sel:[1,1,0] op_sel_hi:[1,1,0]
v_lshlrev_b32_e64 v252, 7, v251
s_add_u32 s46, s47, 2359296
s_mov_b32 exec_lo, 4294836224
s_mov_b32 exec_hi, 3
s_mov_b32 m0, 16220
s_nop 0
buffer_load_dword v252, s[4:7], s46 offen lds
s_mov_b64 exec, -1
s_setprio 2
v_smfmac_f32_16x16x32_bf16 v[24:27], v[216:217], v[208:211], v246
ds_read_b128 v[236:239], v249 offset:2048
ds_read_u16_d16_hi v143, v143
v_cvt_pkrtz_f16_f32 v179, v120, v121
v_cvt_pkrtz_f16_f32 v181, v122, v123
v_cvt_pkrtz_f16_f32 v183, v124, v125
v_cvt_pkrtz_f16_f32 v185, v126, v127
v_smfmac_f32_16x16x32_bf16 v[40:43], v[218:219], v[212:215], v246
v_cvt_pkrtz_f16_f32 v187, v128, v129
v_cvt_pk_f16_f32 v155, v130, v131
v_cvt_pk_f16_f32 v152, v132, v133
v_cvt_pk_f16_f32 v149, v134, v135
v_pk_fma_f16 v154, v155, v155, s48
s_waitcnt lgkmcnt(2)
v_mfma_f32_32x32x16_bf16 v[120:135], v[72:75], v[220:223], 0
ds_read_b128 v[216:219], v249 offset:5120
v_and_b32 v179, s49, v179
v_fma_mix_f32 v162, v136, v136, v162 op_sel:[0,0,0] op_sel_hi:[1,1,0]
v_pk_fma_f16 v151, v152, v152, s48
v_pk_fma_f16 v148, v149, v149, s48
v_bfe_u32 v178, v179, 2, 14
v_pk_mul_f16 v154, v155, v154
v_pk_mul_f16 v151, v152, v151
v_pk_mul_f16 v148, v149, v148
v_lshrrev_b32 v179, 18, v179
v_mfma_f32_32x32x16_bf16 v[120:135], v[76:79], v[224:227], v[120:135]
ds_read_b128 v[220:223], v245 offset:5760
v_xor_b32 v243, 16, v243
ds_read_b128 v[192:195], v243
ds_read_b128 v[196:199], v243 offset:64
ds_read_u16_d16 v178, v178
ds_read_u16_d16_hi v179, v179
v_fma_mix_f32 v162, v137, v137, v162 op_sel:[1,1,0] op_sel_hi:[1,1,0]
v_exp_f16 v153, v154
v_and_b32 v181, s49, v181
v_exp_f16 v150, v151
v_exp_f16 v147, v148
v_bfe_u32 v180, v181, 2, 14
v_mfma_f32_32x32x16_bf16 v[120:135], v[80:83], v[228:231], v[120:135]
ds_read_b128 v[224:227], v245 offset:6144
ds_read_b128 v[200:203], v243 offset:128
v_xor_b32 v244, 16, v244
ds_read_b128 v[204:207], v244
ds_read_u16_d16 v180, v180
v_fma_mix_f32 v162, v138, v138, v162 op_sel:[0,0,0] op_sel_hi:[1,1,0]
v_exp_f16_sdwa v153, v154 dst_sel:WORD_1 dst_unused:UNUSED_PRESERVE src0_sel:WORD_1
v_lshrrev_b32 v181, 18, v181
v_exp_f16_sdwa v150, v151 dst_sel:WORD_1 dst_unused:UNUSED_PRESERVE src0_sel:WORD_1
v_fma_mix_f32 v162, v139, v139, v162 op_sel:[1,1,0] op_sel_hi:[1,1,0]
v_and_b32_e64 v183, s49, v183
v_mfma_f32_32x32x16_bf16 v[120:135], v[84:87], v[232:235], v[120:135]
ds_read_b128 v[228:231], v249 offset:6144
ds_read_u16_d16_hi v181, v181
v_exp_f16_sdwa v147, v148 dst_sel:WORD_1 dst_unused:UNUSED_PRESERVE src0_sel:WORD_1
v_pk_add_f16 v153, v153, 1.0 op_sel_hi:[1,0]
v_bfe_u32 v182, v183, 2, 14
v_pk_add_f16 v150, v150, 1.0 op_sel_hi:[1,0]
v_pk_add_f16 v147, v147, 1.0 op_sel_hi:[1,0]
v_rcp_f16_e64 v154, v153
v_lshrrev_b32 v183, 18, v183
v_fma_mix_f32 v162, v140, v140, v162 op_sel:[0,0,0] op_sel_hi:[1,1,0]
s_waitcnt lgkmcnt(6)
v_mfma_f32_32x32x16_bf16 v[120:135], v[88:91], v[236:239], v[120:135]
ds_read_b128 v[232:235], v249 offset:9216
ds_read_u16_d16 v182, v182
ds_read_u16_d16_hi v183, v183
v_rcp_f16 v151, v150
v_and_b32 v185, s49, v185
v_rcp_f16_e64 v148, v147
v_fma_mix_f32 v162, v141, v141, v162 op_sel:[1,1,0] op_sel_hi:[1,1,0]
v_bfe_u32 v184, v185, 2, 14
v_rcp_f16_sdwa v154, v153 dst_sel:WORD_1 dst_unused:UNUSED_PRESERVE src0_sel:WORD_1
v_mfma_f32_32x32x16_bf16 v[120:135], v[92:95], v[216:219], v[120:135]
ds_read_b128 v[236:239], v249 offset:7168
ds_read_u16_d16 v184, v184
v_rcp_f16_sdwa v151, v150 dst_sel:WORD_1 dst_unused:UNUSED_PRESERVE src0_sel:WORD_1
v_lshrrev_b32_e64 v185, 18, v185
v_rcp_f16_sdwa v148, v147 dst_sel:WORD_1 dst_unused:UNUSED_PRESERVE src0_sel:WORD_1
v_and_b32_e64 v187, s49, v187
v_fma_mix_f32 v162, v142, v142, v162 op_sel:[0,0,0] op_sel_hi:[1,1,0]
v_pk_mul_f16 v155, v155, v154
v_pk_mul_f16 v152, v152, v151
v_smfmac_f32_16x16x32_bf16 v[8:11], v[220:221], v[192:195], v246
ds_read_b128 v[216:219], v249 offset:10240
ds_read_u16_d16_hi v185, v185
v_bfe_u32 v186, v187, 2, 14
v_pk_mul_f16 v149, v149, v148
v_fma_mix_f32 v163, v155, v155, v163 op_sel:[0,0,0] op_sel_hi:[1,1,0]
v_fma_mix_f32 v162, v143, v143, v162 op_sel:[1,1,0] op_sel_hi:[1,1,0]
v_lshrrev_b32_e64 v187, 18, v187
v_smfmac_f32_16x16x32_bf16 v[24:27], v[222:223], v[196:199], v246
v_fma_mix_f32 v163, v155, v155, v163 op_sel:[1,1,0] op_sel_hi:[1,1,0]
v_fma_mix_f32 v163, v152, v152, v163 op_sel:[0,0,0] op_sel_hi:[1,1,0]
v_fma_mix_f32 v163, v152, v152, v163 op_sel:[1,1,0] op_sel_hi:[1,1,0]
v_fma_mix_f32 v163, v149, v149, v163 op_sel:[0,0,0] op_sel_hi:[1,1,0]
v_fma_mix_f32 v163, v149, v149, v163 op_sel:[1,1,0] op_sel_hi:[1,1,0]
v_lshlrev_b32 v252, 7, v251
s_add_u32 s46, s47, 2359296
s_mov_b32 exec_lo, 0
s_mov_b32 exec_hi, 1048572
s_mov_b32 m0, 16152
s_nop 0
buffer_load_dword v252, s[4:7], s46 offen lds
s_mov_b64 exec, -1
s_setprio 1
s_waitcnt lgkmcnt(2)
v_smfmac_f32_16x16x32_bf16 v[40:43], v[224:225], v[200:203], v246
ds_read_b128 v[220:223], v249 offset:8192
ds_read_u16_d16 v186, v186
ds_read_u16_d16_hi v187, v187
v_cvt_pkrtz_f16_f32 v137, v120, v121
v_cvt_pkrtz_f16_f32 v139, v122, v123
v_cvt_pkrtz_f16_f32 v141, v124, v125
v_cvt_pkrtz_f16_f32 v143, v126, v127
v_smfmac_f32_16x16x32_bf16 v[8:11], v[226:227], v[204:207], v246
v_cvt_pk_f16_f32 v155, v128, v129
v_cvt_pk_f16_f32 v152, v130, v131
v_cvt_pk_f16_f32 v149, v132, v133
v_cvt_pk_f16_f32 v146, v134, v135
v_pk_fma_f16 v154, v155, v155, s48
v_mfma_f32_32x32x16_bf16 v[120:135], v[72:75], v[228:231], 0
ds_read_b128 v[224:227], v249 offset:11264
v_and_b32_e64 v137, s49, v137
v_fma_mix_f32 v163, v178, v178, v163 op_sel:[0,0,0] op_sel_hi:[1,1,0]
v_pk_fma_f16 v151, v152, v152, s48
v_pk_fma_f16 v148, v149, v149, s48
v_pk_fma_f16 v145, v146, v146, s48
v_pk_mul_f16 v154, v155, v154
v_bfe_u32 v136, v137, 2, 14
v_pk_mul_f16 v151, v152, v151
v_fma_mix_f32 v163, v179, v179, v163 op_sel:[1,1,0] op_sel_hi:[1,1,0]
v_pk_mul_f16 v148, v149, v148
v_mfma_f32_32x32x16_bf16 v[120:135], v[76:79], v[232:235], v[120:135]
ds_read_b128 v[228:231], v245 offset:6528
ds_read_b128 v[208:211], v244 offset:64
ds_read_b128 v[212:215], v244 offset:128
ds_read_u16_d16 v136, v136
v_pk_mul_f16 v145, v146, v145
v_exp_f16 v153, v154
v_lshrrev_b32 v137, 18, v137
v_exp_f16_e64 v150, v151
v_fma_mix_f32 v163, v180, v180, v163 op_sel:[0,0,0] op_sel_hi:[1,1,0]
v_exp_f16 v147, v148
v_and_b32 v139, s49, v139
v_mfma_f32_32x32x16_bf16 v[120:135], v[80:83], v[236:239], v[120:135]
ds_read_b128 v[232:235], v249 offset:12288
ds_read_u16_d16_hi v137, v137
v_exp_f16_e64 v144, v145
v_exp_f16_sdwa v153, v154 dst_sel:WORD_1 dst_unused:UNUSED_PRESERVE src0_sel:WORD_1
v_fma_mix_f32 v163, v181, v181, v163 op_sel:[1,1,0] op_sel_hi:[1,1,0]
v_bfe_u32 v138, v139, 2, 14
v_exp_f16_sdwa v150, v151 dst_sel:WORD_1 dst_unused:UNUSED_PRESERVE src0_sel:WORD_1
v_exp_f16_sdwa v147, v148 dst_sel:WORD_1 dst_unused:UNUSED_PRESERVE src0_sel:WORD_1
s_waitcnt lgkmcnt(6)
v_mfma_f32_32x32x16_bf16 v[120:135], v[84:87], v[216:219], v[120:135]
ds_read_b128 v[236:239], v249 offset:15360
ds_read_u16_d16 v138, v138
v_exp_f16_sdwa v144, v145 dst_sel:WORD_1 dst_unused:UNUSED_PRESERVE src0_sel:WORD_1
v_lshrrev_b32 v139, 18, v139
v_fma_mix_f32 v163, v182, v182, v163 op_sel:[0,0,0] op_sel_hi:[1,1,0]
v_pk_add_f16 v153, v153, 1.0 op_sel_hi:[1,0]
v_pk_add_f16 v150, v150, 1.0 op_sel_hi:[1,0]
v_pk_add_f16 v147, v147, 1.0 op_sel_hi:[1,0]
v_and_b32_e64 v141, s49, v141
v_pk_add_f16 v144, v144, 1.0 op_sel_hi:[1,0]
v_mfma_f32_32x32x16_bf16 v[120:135], v[88:91], v[220:223], v[120:135]
ds_read_b128 v[216:219], v249 offset:13312
ds_read_u16_d16_hi v139, v139
v_rcp_f16_e64 v154, v153
v_fma_mix_f32 v163, v183, v183, v163 op_sel:[1,1,0] op_sel_hi:[1,1,0]
v_rcp_f16_e64 v151, v150
v_bfe_u32 v140, v141, 2, 14
v_rcp_f16_e64 v148, v147
v_fma_mix_f32 v163, v184, v184, v163 op_sel:[0,0,0] op_sel_hi:[1,1,0]
v_mfma_f32_32x32x16_bf16 v[120:135], v[92:95], v[224:227], v[120:135]
ds_read_b128 v[220:223], v249 offset:16384
ds_read_u16_d16 v140, v140
v_rcp_f16_e64 v145, v144
v_lshrrev_b32 v141, 18, v141
v_rcp_f16_sdwa v154, v153 dst_sel:WORD_1 dst_unused:UNUSED_PRESERVE src0_sel:WORD_1
s_setprio 0
v_rcp_f16_sdwa v151, v150 dst_sel:WORD_1 dst_unused:UNUSED_PRESERVE src0_sel:WORD_1
v_fma_mix_f32 v163, v185, v185, v163 op_sel:[1,1,0] op_sel_hi:[1,1,0]
v_and_b32 v143, s49, v143
v_rcp_f16_sdwa v148, v147 dst_sel:WORD_1 dst_unused:UNUSED_PRESERVE src0_sel:WORD_1
s_waitcnt lgkmcnt(4)
v_smfmac_f32_16x16x32_bf16 v[24:27], v[228:229], v[208:211], v246
ds_read_b128 v[224:227], v249 offset:14336
ds_read_u16_d16_hi v141, v141
v_rcp_f16_sdwa v145, v144 dst_sel:WORD_1 dst_unused:UNUSED_PRESERVE src0_sel:WORD_1
v_pk_mul_f16 v155, v155, v154
v_bfe_u32 v142, v143, 2, 14
v_fma_mix_f32 v163, v186, v186, v163 op_sel:[0,0,0] op_sel_hi:[1,1,0]
v_smfmac_f32_16x16x32_bf16 v[40:43], v[230:231], v[212:215], v246
s_mov_b64 exec, 1
ds_add_u32 v253, v254 offset:16
s_mov_b64 exec, -1
v_pk_mul_f16 v152, v152, v151
v_pk_mul_f16 v149, v149, v148
v_pk_mul_f16 v146, v146, v145
v_fma_mix_f32 v164, v155, v155, v164 op_sel:[0,0,0] op_sel_hi:[1,1,0]
v_lshrrev_b32 v143, 18, v143
v_fma_mix_f32 v164, v155, v155, v164 op_sel:[1,1,0] op_sel_hi:[1,1,0]
v_fma_mix_f32 v164, v152, v152, v164 op_sel:[0,0,0] op_sel_hi:[1,1,0]
v_fma_mix_f32 v163, v187, v187, v163 op_sel:[1,1,0] op_sel_hi:[1,1,0]
v_fma_mix_f32 v164, v152, v152, v164 op_sel:[1,1,0] op_sel_hi:[1,1,0]
v_fma_mix_f32 v164, v149, v149, v164 op_sel:[0,0,0] op_sel_hi:[1,1,0]
v_fma_mix_f32 v164, v149, v149, v164 op_sel:[1,1,0] op_sel_hi:[1,1,0]
v_fma_mix_f32 v164, v146, v146, v164 op_sel:[0,0,0] op_sel_hi:[1,1,0]
v_fma_mix_f32 v164, v146, v146, v164 op_sel:[1,1,0] op_sel_hi:[1,1,0]
s_setprio 3
v_pk_add_f32 v[168:169], v[0:1], v[2:3]
v_pk_mul_f32 v[170:171], v[0:1], v[0:1]
v_pk_fma_f32 v[170:171], v[2:3], v[2:3], v[170:171]
v_pk_add_f32 v[168:169], v[168:169], v[4:5]
v_pk_fma_f32 v[170:171], v[4:5], v[4:5], v[170:171]
v_pk_add_f32 v[168:169], v[168:169], v[6:7]
v_pk_fma_f32 v[170:171], v[6:7], v[6:7], v[170:171]
v_pk_add_f32 v[168:169], v[168:169], v[8:9]
v_pk_fma_f32 v[170:171], v[8:9], v[8:9], v[170:171]
v_pk_add_f32 v[168:169], v[168:169], v[10:11]
v_pk_fma_f32 v[170:171], v[10:11], v[10:11], v[170:171]
v_pk_add_f32 v[168:169], v[168:169], v[12:13]
v_pk_fma_f32 v[170:171], v[12:13], v[12:13], v[170:171]
v_pk_add_f32 v[168:169], v[168:169], v[14:15]
v_pk_fma_f32 v[170:171], v[14:15], v[14:15], v[170:171]
v_pk_add_f32 v[168:169], v[168:169], v[16:17]
v_pk_fma_f32 v[170:171], v[16:17], v[16:17], v[170:171]
v_pk_add_f32 v[168:169], v[168:169], v[18:19]
v_pk_fma_f32 v[170:171], v[18:19], v[18:19], v[170:171]
v_pk_add_f32 v[168:169], v[168:169], v[20:21]
v_pk_fma_f32 v[170:171], v[20:21], v[20:21], v[170:171]
v_pk_add_f32 v[168:169], v[168:169], v[22:23]
v_pk_fma_f32 v[170:171], v[22:23], v[22:23], v[170:171]
v_pk_add_f32 v[168:169], v[168:169], v[24:25]
v_pk_fma_f32 v[170:171], v[24:25], v[24:25], v[170:171]
v_pk_add_f32 v[168:169], v[168:169], v[26:27]
v_pk_fma_f32 v[170:171], v[26:27], v[26:27], v[170:171]
v_pk_add_f32 v[168:169], v[168:169], v[28:29]
v_pk_fma_f32 v[170:171], v[28:29], v[28:29], v[170:171]
v_pk_add_f32 v[168:169], v[168:169], v[30:31]
v_pk_fma_f32 v[170:171], v[30:31], v[30:31], v[170:171]
v_pk_add_f32 v[168:169], v[168:169], v[32:33]
v_pk_fma_f32 v[170:171], v[32:33], v[32:33], v[170:171]
v_pk_add_f32 v[168:169], v[168:169], v[34:35]
v_pk_fma_f32 v[170:171], v[34:35], v[34:35], v[170:171]
v_pk_add_f32 v[168:169], v[168:169], v[36:37]
v_pk_fma_f32 v[170:171], v[36:37], v[36:37], v[170:171]
v_pk_add_f32 v[168:169], v[168:169], v[38:39]
v_pk_fma_f32 v[170:171], v[38:39], v[38:39], v[170:171]
v_pk_add_f32 v[168:169], v[168:169], v[40:41]
v_pk_fma_f32 v[170:171], v[40:41], v[40:41], v[170:171]
v_pk_add_f32 v[168:169], v[168:169], v[42:43]
v_pk_fma_f32 v[170:171], v[42:43], v[42:43], v[170:171]
v_pk_add_f32 v[168:169], v[168:169], v[44:45]
v_pk_fma_f32 v[170:171], v[44:45], v[44:45], v[170:171]
v_pk_add_f32 v[168:169], v[168:169], v[46:47]
v_pk_fma_f32 v[170:171], v[46:47], v[46:47], v[170:171]
s_setprio 0
v_add_u32 v174, -36864, v242
v_subrev_u32 v175, 66560, v174
v_min_u32 v174, v174, v175
v_add_u32 v174, 90112, v174
v_sub_u32 v175, v174, v242
v_add_u32 v242, v175, v242
v_add_u32_e64 v243, v175, v243
v_add_u32 v244, v175, v244
s_setprio 2
v_cvt_pkrtz_f16_f32 v179, v120, v121
v_cvt_pkrtz_f16_f32 v181, v122, v123
v_cvt_pkrtz_f16_f32 v183, v124, v125
v_cvt_pkrtz_f16_f32 v185, v126, v127
v_cvt_pkrtz_f16_f32 v187, v128, v129
v_cvt_pkrtz_f16_f32 v189, v130, v131
v_cvt_pk_f16_f32 v155, v132, v133
v_cvt_pk_f16_f32 v152, v134, v135
ds_read_b128 v[228:231], v249 offset:17408
ds_read_u16_d16 v142, v142
ds_read_u16_d16_hi v143, v143
v_mfma_f32_32x32x16_bf16 v[120:135], v[72:75], v[232:235], 0
v_pk_fma_f16 v154, v155, v155, s48
v_add_f32 v168, v168, v169
v_and_b32 v179, s49, v179
v_fma_mix_f32 v164, v136, v136, v164 op_sel:[0,0,0] op_sel_hi:[1,1,0]
v_bfe_u32 v178, v179, 2, 14
v_add_f32_e64 v170, v170, v171
v_pk_fma_f16 v151, v152, v152, s48
v_pk_mul_f16 v154, v155, v154
v_lshrrev_b32_e64 v179, 18, v179
v_pk_mul_f16 v151, v152, v151
ds_read_b128 v[232:235], v249 offset:18432
ds_read_u16_d16 v178, v178
ds_read_u16_d16_hi v179, v179
v_mfma_f32_32x32x16_bf16 v[120:135], v[76:79], v[236:239], v[120:135]
v_permlane32_swap_b32 v168, v170
v_fma_mix_f32 v164, v137, v137, v164 op_sel:[1,1,0] op_sel_hi:[1,1,0]
v_and_b32 v181, s49, v181
v_exp_f16 v153, v154
v_add_f32 v168, v168, v170
v_bfe_u32 v180, v181, 2, 14
v_exp_f16_e64 v150, v151
v_lshrrev_b32 v181, 18, v181
s_waitcnt lgkmcnt(7)
ds_read_b128 v[236:239], v249 offset:21504
ds_read_u16_d16 v180, v180
ds_read_u16_d16_hi v181, v181
v_mfma_f32_32x32x16_bf16 v[120:135], v[80:83], v[216:219], v[120:135]
v_mul_f32 v168, 1009429163, v168
v_fma_mix_f32 v164, v138, v138, v164 op_sel:[0,0,0] op_sel_hi:[1,1,0]
v_exp_f16_sdwa v153, v154 dst_sel:WORD_1 dst_unused:UNUSED_PRESERVE src0_sel:WORD_1
v_and_b32 v183, s49, v183
v_mov_b32 v170, v168
v_exp_f16_sdwa v150, v151 dst_sel:WORD_1 dst_unused:UNUSED_PRESERVE src0_sel:WORD_1
v_bfe_u32 v182, v183, 2, 14
v_fma_mix_f32 v164, v139, v139, v164 op_sel:[1,1,0] op_sel_hi:[1,1,0]
v_permlane32_swap_b32 v168, v170
ds_read_b128 v[216:219], v249 offset:19456
ds_read_u16_d16 v182, v182
v_mfma_f32_32x32x16_bf16 v[120:135], v[84:87], v[220:223], v[120:135]
v_lshrrev_b32 v183, 18, v183
v_pk_add_f16 v153, v153, 1.0 op_sel_hi:[1,0]
v_pk_add_f16 v150, v150, 1.0 op_sel_hi:[1,0]
v_and_b32_e64 v185, s49, v185
v_fma_f32 v170, -v168, v168, v170
v_rcp_f16_e64 v154, v153
v_bfe_u32 v184, v185, 2, 14
v_max_f32_e64 v170, 0, v170
v_fma_mix_f32 v164, v140, v140, v164 op_sel:[0,0,0] op_sel_hi:[1,1,0]
ds_read_b128 v[220:223], v249 offset:22528
ds_read_u16_d16_hi v183, v183
ds_read_u16_d16 v184, v184
v_mfma_f32_32x32x16_bf16 v[120:135], v[88:91], v[224:227], v[120:135]
v_lshrrev_b32 v185, 18, v185
v_rcp_f16 v151, v150
v_add_f32 v170, 925353388, v170
v_and_b32_e64 v187, s49, v187
v_fma_mix_f32 v164, v141, v141, v164 op_sel:[1,1,0] op_sel_hi:[1,1,0]
v_rcp_f16_sdwa v154, v153 dst_sel:WORD_1 dst_unused:UNUSED_PRESERVE src0_sel:WORD_1
v_rsq_f32 v170, v170
s_waitcnt lgkmcnt(5)
ds_read_b128 v[224:227], v249 offset:20480
ds_read_u16_d16_hi v185, v185
ds_read_b32 v247, v253 offset:16
v_mfma_f32_32x32x16_bf16 v[120:135], v[92:95], v[228:231], v[120:135]
v_bfe_u32 v186, v187, 2, 14
v_rcp_f16_sdwa v151, v150 dst_sel:WORD_1 dst_unused:UNUSED_PRESERVE src0_sel:WORD_1
v_lshrrev_b32_e64 v187, 18, v187
v_fma_mix_f32 v164, v142, v142, v164 op_sel:[0,0,0] op_sel_hi:[1,1,0]
v_and_b32_e64 v189, s49, v189
v_pk_mul_f16 v155, v155, v154
v_pk_mul_f16 v152, v152, v151
v_mul_f32 v172, 3203391086, v170
v_bfe_u32 v188, v189, 2, 14
v_fma_mix_f32 v165, v155, v155, v165 op_sel:[0,0,0] op_sel_hi:[1,1,0]
v_fma_mix_f32 v164, v143, v143, v164 op_sel:[1,1,0] op_sel_hi:[1,1,0]
v_lshrrev_b32_e64 v189, 18, v189
v_mul_f32 v173, v168, v172
v_fma_mix_f32 v165, v155, v155, v165 op_sel:[1,1,0] op_sel_hi:[1,1,0]
v_fma_mix_f32 v165, v152, v152, v165 op_sel:[0,0,0] op_sel_hi:[1,1,0]
v_fma_mix_f32 v165, v152, v152, v165 op_sel:[1,1,0] op_sel_hi:[1,1,0]
s_setprio 3
v_pk_fma_f32 v[0:1], v[0:1], v[172:173], v[172:173] op_sel:[0,0,1] op_sel_hi:[1,0,1] neg_lo:[0,0,1] neg_hi:[0,0,1]
v_pk_fma_f32 v[2:3], v[2:3], v[172:173], v[172:173] op_sel:[0,0,1] op_sel_hi:[1,0,1] neg_lo:[0,0,1] neg_hi:[0,0,1]
v_pk_fma_f32 v[4:5], v[4:5], v[172:173], v[172:173] op_sel:[0,0,1] op_sel_hi:[1,0,1] neg_lo:[0,0,1] neg_hi:[0,0,1]
v_pk_fma_f32 v[6:7], v[6:7], v[172:173], v[172:173] op_sel:[0,0,1] op_sel_hi:[1,0,1] neg_lo:[0,0,1] neg_hi:[0,0,1]
v_pk_fma_f32 v[8:9], v[8:9], v[172:173], v[172:173] op_sel:[0,0,1] op_sel_hi:[1,0,1] neg_lo:[0,0,1] neg_hi:[0,0,1]
v_pk_fma_f32 v[10:11], v[10:11], v[172:173], v[172:173] op_sel:[0,0,1] op_sel_hi:[1,0,1] neg_lo:[0,0,1] neg_hi:[0,0,1]
v_pk_fma_f32 v[12:13], v[12:13], v[172:173], v[172:173] op_sel:[0,0,1] op_sel_hi:[1,0,1] neg_lo:[0,0,1] neg_hi:[0,0,1]
v_pk_fma_f32 v[14:15], v[14:15], v[172:173], v[172:173] op_sel:[0,0,1] op_sel_hi:[1,0,1] neg_lo:[0,0,1] neg_hi:[0,0,1]
v_pk_fma_f32 v[16:17], v[16:17], v[172:173], v[172:173] op_sel:[0,0,1] op_sel_hi:[1,0,1] neg_lo:[0,0,1] neg_hi:[0,0,1]
v_pk_fma_f32 v[18:19], v[18:19], v[172:173], v[172:173] op_sel:[0,0,1] op_sel_hi:[1,0,1] neg_lo:[0,0,1] neg_hi:[0,0,1]
v_pk_fma_f32 v[20:21], v[20:21], v[172:173], v[172:173] op_sel:[0,0,1] op_sel_hi:[1,0,1] neg_lo:[0,0,1] neg_hi:[0,0,1]
v_pk_fma_f32 v[22:23], v[22:23], v[172:173], v[172:173] op_sel:[0,0,1] op_sel_hi:[1,0,1] neg_lo:[0,0,1] neg_hi:[0,0,1]
v_pk_fma_f32 v[24:25], v[24:25], v[172:173], v[172:173] op_sel:[0,0,1] op_sel_hi:[1,0,1] neg_lo:[0,0,1] neg_hi:[0,0,1]
v_pk_fma_f32 v[26:27], v[26:27], v[172:173], v[172:173] op_sel:[0,0,1] op_sel_hi:[1,0,1] neg_lo:[0,0,1] neg_hi:[0,0,1]
v_pk_fma_f32 v[28:29], v[28:29], v[172:173], v[172:173] op_sel:[0,0,1] op_sel_hi:[1,0,1] neg_lo:[0,0,1] neg_hi:[0,0,1]
v_pk_fma_f32 v[30:31], v[30:31], v[172:173], v[172:173] op_sel:[0,0,1] op_sel_hi:[1,0,1] neg_lo:[0,0,1] neg_hi:[0,0,1]
v_pk_fma_f32 v[32:33], v[32:33], v[172:173], v[172:173] op_sel:[0,0,1] op_sel_hi:[1,0,1] neg_lo:[0,0,1] neg_hi:[0,0,1]
v_pk_fma_f32 v[34:35], v[34:35], v[172:173], v[172:173] op_sel:[0,0,1] op_sel_hi:[1,0,1] neg_lo:[0,0,1] neg_hi:[0,0,1]
v_pk_fma_f32 v[36:37], v[36:37], v[172:173], v[172:173] op_sel:[0,0,1] op_sel_hi:[1,0,1] neg_lo:[0,0,1] neg_hi:[0,0,1]
v_pk_fma_f32 v[38:39], v[38:39], v[172:173], v[172:173] op_sel:[0,0,1] op_sel_hi:[1,0,1] neg_lo:[0,0,1] neg_hi:[0,0,1]
v_pk_fma_f32 v[40:41], v[40:41], v[172:173], v[172:173] op_sel:[0,0,1] op_sel_hi:[1,0,1] neg_lo:[0,0,1] neg_hi:[0,0,1]
v_pk_fma_f32 v[42:43], v[42:43], v[172:173], v[172:173] op_sel:[0,0,1] op_sel_hi:[1,0,1] neg_lo:[0,0,1] neg_hi:[0,0,1]
v_pk_fma_f32 v[44:45], v[44:45], v[172:173], v[172:173] op_sel:[0,0,1] op_sel_hi:[1,0,1] neg_lo:[0,0,1] neg_hi:[0,0,1]
v_pk_fma_f32 v[46:47], v[46:47], v[172:173], v[172:173] op_sel:[0,0,1] op_sel_hi:[1,0,1] neg_lo:[0,0,1] neg_hi:[0,0,1]
s_setprio 2
ds_read_u16_d16 v186, v186
ds_read_u16_d16_hi v187, v187
ds_read_u16_d16 v188, v188
ds_read_u16_d16_hi v189, v189
s_waitcnt lgkmcnt(4)
v_readfirstlane_b32 s43, v247
s_nop 1
s_cmp_ge_u32 s43, 24
s_cbranch_scc1 Lev7
Lev7w:
s_sleep 1
ds_read_b32 v247, v253 offset:16
s_waitcnt lgkmcnt(0)
v_readfirstlane_b32 s43, v247
s_cmp_eq_u32 s76, 0
s_cbranch_scc1 Lev7
s_sub_u32 s76, s76, 1
s_cmp_lt_u32 s43, 24
s_cbranch_scc1 Lev7w
Lev7:
s_setprio 1
v_cvt_pkrtz_f16_f32 v137, v120, v121
v_cvt_pkrtz_f16_f32 v139, v122, v123
v_cvt_pkrtz_f16_f32 v141, v124, v125
v_cvt_pkrtz_f16_f32 v143, v126, v127
v_cvt_pkrtz_f16_f32 v177, v128, v129
v_cvt_pkrtz_f16_f32 v191, v130, v131
v_cvt_pk_f16_f32 v155, v132, v133
v_cvt_pk_f16_f32 v152, v134, v135
s_add_u32 m0, s67, 39936
s_add_u32 s66, s66, 98304
buffer_load_dwordx4 v240, s[4:7], s66 offen lds
ds_read_b128 v[228:231], v249 offset:23552
v_mfma_f32_32x32x16_bf16 v[120:135], v[72:75], v[232:235], 0
v_pk_fma_f16 v154, v155, v155, s48
v_cvt_pk_bf16_f32 v96, v0, v1
v_and_b32 v137, s49, v137
v_fma_mix_f32 v165, v178, v178, v165 op_sel:[0,0,0] op_sel_hi:[1,1,0]
v_cvt_pk_bf16_f32 v97, v2, v3
v_pk_fma_f16 v151, v152, v152, s48
v_bfe_u32 v136, v137, 2, 14
v_cvt_pk_bf16_f32 v98, v4, v5
v_pk_mul_f16 v154, v155, v154
v_fma_mix_f32 v165, v179, v179, v165 op_sel:[1,1,0] op_sel_hi:[1,1,0]
v_lshrrev_b32_e64 v137, 18, v137
v_cvt_pk_bf16_f32 v99, v6, v7
s_add_u32 m0, s67, 46592
s_add_u32 s66, s66, 98304
buffer_load_dwordx4 v240, s[4:7], s66 offen lds
ds_read_b128 v[232:235], v248 offset:16384
ds_read_u16_d16 v136, v136
ds_read_u16_d16_hi v137, v137
v_mfma_f32_32x32x16_bf16 v[120:135], v[76:79], v[236:239], v[120:135]
v_pk_mul_f16 v151, v152, v151
v_exp_f16_e64 v153, v154
v_cvt_pk_bf16_f32 v100, v8, v9
v_and_b32_e64 v139, s49, v139
v_fma_mix_f32 v165, v180, v180, v165 op_sel:[0,0,0] op_sel_hi:[1,1,0]
v_cvt_pk_bf16_f32 v101, v10, v11
v_bfe_u32 v138, v139, 2, 14
v_exp_f16_e64 v150, v151
v_cvt_pk_bf16_f32 v102, v12, v13
v_lshrrev_b32_e64 v139, 18, v139
v_cvt_pk_bf16_f32 v103, v14, v15
s_add_u32 m0, s67, 53248
s_add_u32 s66, s66, 98304
buffer_load_dwordx4 v240, s[4:7], s66 offen lds
ds_read_b128 v[236:239], v248 offset:19456
ds_read_u16_d16 v138, v138
ds_read_u16_d16_hi v139, v139
v_mfma_f32_32x32x16_bf16 v[120:135], v[80:83], v[216:219], v[120:135]
v_fma_mix_f32 v165, v181, v181, v165 op_sel:[1,1,0] op_sel_hi:[1,1,0]
v_exp_f16_sdwa v153, v154 dst_sel:WORD_1 dst_unused:UNUSED_PRESERVE src0_sel:WORD_1
v_cvt_pk_bf16_f32 v104, v16, v17
v_and_b32_e64 v141, s49, v141
v_fma_mix_f32 v165, v182, v182, v165 op_sel:[0,0,0] op_sel_hi:[1,1,0]
v_cvt_pk_bf16_f32 v105, v18, v19
v_bfe_u32 v140, v141, 2, 14
v_exp_f16_sdwa v150, v151 dst_sel:WORD_1 dst_unused:UNUSED_PRESERVE src0_sel:WORD_1
v_cvt_pk_bf16_f32 v106, v20, v21
v_lshrrev_b32 v141, 18, v141
s_add_u32 m0, s67, 59904
s_add_u32 s66, s66, 98304
buffer_load_dwordx4 v240, s[4:7], s66 offen lds
s_add_u32 m0, s67, 0
s_add_u32 s66, s66, 98304
buffer_load_dwordx4 v240, s[4:7], s66 offen lds
ds_read_b128 v[216:219], v248 offset:17408
ds_read_u16_d16 v140, v140
ds_read_u16_d16_hi v141, v141
v_mfma_f32_32x32x16_bf16 v[120:135], v[84:87], v[220:223], v[120:135]
v_fma_mix_f32 v165, v183, v183, v165 op_sel:[1,1,0] op_sel_hi:[1,1,0]
v_cvt_pk_bf16_f32 v107, v22, v23
v_pk_add_f16 v153, v153, 1.0 op_sel_hi:[1,0]
v_pk_add_f16 v150, v150, 1.0 op_sel_hi:[1,0]
v_and_b32_e64 v143, s49, v143
v_cvt_pk_bf16_f32 v108, v24, v25
v_rcp_f16_e64 v154, v153
v_cvt_pk_bf16_f32 v109, v26, v27
v_bfe_u32 v142, v143, 2, 14
v_fma_mix_f32 v165, v184, v184, v165 op_sel:[0,0,0] op_sel_hi:[1,1,0]
v_cvt_pk_bf16_f32 v110, v28, v29
s_add_u32 m0, s67, 6656
s_add_u32 s66, s66, 98304
buffer_load_dwordx4 v240, s[4:7], s66 offen lds
ds_read_b128 v[220:223], v248 offset:20480
ds_read_u16_d16 v142, v142
v_mfma_f32_32x32x16_bf16 v[120:135], v[88:91], v[224:227], v[120:135]
v_rcp_f16 v151, v150
v_lshrrev_b32 v143, 18, v143
v_cvt_pk_bf16_f32 v111, v30, v31
v_fma_mix_f32 v165, v185, v185, v165 op_sel:[1,1,0] op_sel_hi:[1,1,0]
v_and_b32_e64 v177, s49, v177
s_setprio 0
v_cvt_pk_bf16_f32 v112, v32, v33
v_rcp_f16_sdwa v154, v153 dst_sel:WORD_1 dst_unused:UNUSED_PRESERVE src0_sel:WORD_1
v_bfe_u32 v176, v177, 2, 14
v_cvt_pk_bf16_f32 v113, v34, v35
s_waitcnt lgkmcnt(2)
v_fma_mix_f32 v165, v186, v186, v165 op_sel:[0,0,0] op_sel_hi:[1,1,0]
v_rcp_f16_sdwa v151, v150 dst_sel:WORD_1 dst_unused:UNUSED_PRESERVE src0_sel:WORD_1
s_add_u32 m0, s67, 13312
s_add_u32 s66, s66, 98304
buffer_load_dwordx4 v240, s[4:7], s66 offen lds
ds_read_b128 v[224:227], v248 offset:18432
ds_read_u16_d16_hi v143, v143
ds_read_u16_d16 v176, v176
v_mfma_f32_32x32x16_bf16 v[120:135], v[92:95], v[228:231], v[120:135]
v_cvt_pk_bf16_f32 v114, v36, v37
v_lshrrev_b32_e64 v177, 18, v177
v_cvt_pk_bf16_f32 v115, v38, v39
v_fma_mix_f32 v165, v187, v187, v165 op_sel:[1,1,0] op_sel_hi:[1,1,0]
v_and_b32_e64 v191, s49, v191
v_pk_mul_f16 v155, v155, v154
v_cvt_pk_bf16_f32 v116, v40, v41
v_pk_mul_f16 v152, v152, v151
v_bfe_u32 v190, v191, 2, 14
v_cvt_pk_bf16_f32 v117, v42, v43
v_fma_mix_f32 v165, v188, v188, v165 op_sel:[0,0,0] op_sel_hi:[1,1,0]
v_fma_mix_f32 v166, v155, v155, v166 op_sel:[0,0,0] op_sel_hi:[1,1,0]
s_add_u32 m0, s67, 19968
s_add_u32 s66, s66, 98304
buffer_load_dwordx4 v240, s[4:7], s66 offen lds
v_lshrrev_b32 v191, 18, v191
v_cvt_pk_bf16_f32 v118, v44, v45
v_fma_mix_f32 v166, v155, v155, v166 op_sel:[1,1,0] op_sel_hi:[1,1,0]
v_fma_mix_f32 v165, v189, v189, v165 op_sel:[1,1,0] op_sel_hi:[1,1,0]
v_cvt_pk_bf16_f32 v119, v46, v47
v_fma_mix_f32 v166, v152, v152, v166 op_sel:[0,0,0] op_sel_hi:[1,1,0]
v_fma_mix_f32 v166, v152, v152, v166 op_sel:[1,1,0] op_sel_hi:[1,1,0]
s_setprio 2
v_cvt_pkrtz_f16_f32 v179, v120, v121
v_cvt_pkrtz_f16_f32 v181, v122, v123
v_cvt_pkrtz_f16_f32 v183, v124, v125
v_cvt_pkrtz_f16_f32 v185, v126, v127
v_cvt_pkrtz_f16_f32 v187, v128, v129
v_cvt_pk_f16_f32 v155, v130, v131
v_cvt_pk_f16_f32 v152, v132, v133
v_cvt_pk_f16_f32 v149, v134, v135
ds_read_b128 v[228:231], v248 offset:21504
ds_read_u16_d16_hi v177, v177
ds_read_u16_d16 v190, v190
ds_read_u16_d16_hi v191, v191
v_mfma_f32_32x32x16_bf16 v[120:135], v[96:99], v[232:235], 0
v_pk_fma_f16 v154, v155, v155, s48
v_and_b32_e64 v179, s49, v179
v_fma_mix_f32 v166, v136, v136, v166 op_sel:[0,0,0] op_sel_hi:[1,1,0]
v_pk_fma_f16 v151, v152, v152, s48
v_pk_fma_f16 v148, v149, v149, s48
v_bfe_u32 v178, v179, 2, 14
v_pk_mul_f16 v154, v155, v154
v_fma_mix_f32 v166, v137, v137, v166 op_sel:[1,1,0] op_sel_hi:[1,1,0]
v_pk_mul_f16 v151, v152, v151
v_lshrrev_b32_e64 v179, 18, v179
ds_read_b128 v[232:235], v248 offset:22528
ds_read_u16_d16 v178, v178
ds_read_u16_d16_hi v179, v179
v_mfma_f32_32x32x16_bf16 v[120:135], v[100:103], v[236:239], v[120:135]
v_pk_mul_f16 v148, v149, v148
v_exp_f16_e64 v153, v154
v_fma_mix_f32 v166, v138, v138, v166 op_sel:[0,0,0] op_sel_hi:[1,1,0]
v_and_b32 v181, s49, v181
v_exp_f16 v150, v151
v_exp_f16_e64 v147, v148
v_bfe_u32 v180, v181, 2, 14
v_fma_mix_f32 v166, v139, v139, v166 op_sel:[1,1,0] op_sel_hi:[1,1,0]
ds_read_b128 v[236:239], v248 offset:25600
ds_read_u16_d16 v180, v180
v_mfma_f32_32x32x16_bf16 v[120:135], v[104:107], v[216:219], v[120:135]
v_exp_f16_sdwa v153, v154 dst_sel:WORD_1 dst_unused:UNUSED_PRESERVE src0_sel:WORD_1
v_lshrrev_b32_e64 v181, 18, v181
v_exp_f16_sdwa v150, v151 dst_sel:WORD_1 dst_unused:UNUSED_PRESERVE src0_sel:WORD_1
v_fma_mix_f32 v166, v140, v140, v166 op_sel:[0,0,0] op_sel_hi:[1,1,0]
v_and_b32 v183, s49, v183
v_exp_f16_sdwa v147, v148 dst_sel:WORD_1 dst_unused:UNUSED_PRESERVE src0_sel:WORD_1
v_fma_mix_f32 v166, v141, v141, v166 op_sel:[1,1,0] op_sel_hi:[1,1,0]
s_waitcnt lgkmcnt(5)
ds_read_b128 v[216:219], v248 offset:23552
ds_read_u16_d16_hi v181, v181
v_mfma_f32_32x32x16_bf16 v[120:135], v[108:111], v[220:223], v[120:135]
v_pk_add_f16 v153, v153, 1.0 op_sel_hi:[1,0]
v_bfe_u32 v182, v183, 2, 14
v_pk_add_f16 v150, v150, 1.0 op_sel_hi:[1,0]
v_pk_add_f16 v147, v147, 1.0 op_sel_hi:[1,0]
v_rcp_f16 v154, v153
v_lshrrev_b32 v183, 18, v183
v_fma_mix_f32 v166, v142, v142, v166 op_sel:[0,0,0] op_sel_hi:[1,1,0]
v_rcp_f16 v151, v150
v_and_b32 v185, s49, v185
ds_read_b128 v[220:223], v248 offset:26624
ds_read_u16_d16 v182, v182
ds_read_u16_d16_hi v183, v183
v_mfma_f32_32x32x16_bf16 v[120:135], v[112:115], v[224:227], v[120:135]
v_fma_mix_f32 v166, v143, v143, v166 op_sel:[1,1,0] op_sel_hi:[1,1,0]
v_rcp_f16_e64 v148, v147
v_bfe_u32 v184, v185, 2, 14
v_rcp_f16_sdwa v154, v153 dst_sel:WORD_1 dst_unused:UNUSED_PRESERVE src0_sel:WORD_1
v_fma_mix_f32 v166, v176, v176, v166 op_sel:[0,0,0] op_sel_hi:[1,1,0]
v_rcp_f16_sdwa v151, v150 dst_sel:WORD_1 dst_unused:UNUSED_PRESERVE src0_sel:WORD_1
v_lshrrev_b32_e64 v185, 18, v185
ds_read_b128 v[224:227], v248 offset:24576
ds_read_u16_d16 v184, v184
ds_read_u16_d16_hi v185, v185
v_mfma_f32_32x32x16_bf16 v[120:135], v[116:119], v[228:231], v[120:135]
v_rcp_f16_sdwa v148, v147 dst_sel:WORD_1 dst_unused:UNUSED_PRESERVE src0_sel:WORD_1
s_cmp_eq_u32 s40, 7
s_cbranch_scc1 Lrdy24
s_waitcnt vmcnt(0)
Lrdy24:
s_mov_b64 exec, 1
ds_add_u32 v253, v254 offset:12
s_mov_b64 exec, -1
v_and_b32 v187, s49, v187
v_fma_mix_f32 v166, v177, v177, v166 op_sel:[1,1,0] op_sel_hi:[1,1,0]
v_pk_mul_f16 v155, v155, v154
v_pk_mul_f16 v152, v152, v151
v_pk_mul_f16 v149, v149, v148
v_bfe_u32 v186, v187, 2, 14
v_fma_mix_f32 v166, v190, v190, v166 op_sel:[0,0,0] op_sel_hi:[1,1,0]
v_fma_mix_f32 v167, v155, v155, v167 op_sel:[0,0,0] op_sel_hi:[1,1,0]
v_fma_mix_f32 v167, v155, v155, v167 op_sel:[1,1,0] op_sel_hi:[1,1,0]
v_lshrrev_b32_e64 v187, 18, v187
v_fma_mix_f32 v167, v152, v152, v167 op_sel:[0,0,0] op_sel_hi:[1,1,0]
v_fma_mix_f32 v166, v191, v191, v166 op_sel:[1,1,0] op_sel_hi:[1,1,0]
v_fma_mix_f32 v167, v152, v152, v167 op_sel:[1,1,0] op_sel_hi:[1,1,0]
v_fma_mix_f32 v167, v149, v149, v167 op_sel:[0,0,0] op_sel_hi:[1,1,0]
v_fma_mix_f32 v167, v149, v149, v167 op_sel:[1,1,0] op_sel_hi:[1,1,0]
s_cmp_lg_u32 s40, 7
s_cbranch_scc1 Lnoinit
s_waitcnt vmcnt(11)
v_mov_b32_e64 v255, 1
s_mov_b64 exec, 1
buffer_atomic_add v255, v241, s[36:39], 0 offen
s_mov_b64 exec, -1
Lnoinit:
s_setprio 1
v_cvt_pkrtz_f16_f32 v137, v120, v121
v_cvt_pkrtz_f16_f32 v139, v122, v123
v_cvt_pkrtz_f16_f32 v141, v124, v125
v_cvt_pkrtz_f16_f32 v143, v126, v127
v_cvt_pkrtz_f16_f32 v177, v128, v129
v_cvt_pk_f16_f32 v155, v130, v131
v_cvt_pk_f16_f32 v152, v132, v133
v_cvt_pk_f16_f32 v149, v134, v135
s_waitcnt lgkmcnt(1)
s_add_u32 s46, s80, 12582912
buffer_store_dwordx4 v[72:75], v241, s[32:35], s46 offen sc1
ds_read_b128 v[228:231], v248 offset:27648
ds_read_u16_d16 v186, v186
ds_read_u16_d16_hi v187, v187
v_mfma_f32_32x32x16_bf16 v[120:135], v[96:99], v[232:235], 0
v_pk_fma_f16 v154, v155, v155, s48
v_and_b32 v137, s49, v137
v_fma_mix_f32 v167, v178, v178, v167 op_sel:[0,0,0] op_sel_hi:[1,1,0]
v_pk_fma_f16 v151, v152, v152, s48
v_pk_fma_f16 v148, v149, v149, s48
v_bfe_u32 v136, v137, 2, 14
v_pk_mul_f16 v154, v155, v154
v_pk_mul_f16 v151, v152, v151
v_fma_mix_f32 v167, v179, v179, v167 op_sel:[1,1,0] op_sel_hi:[1,1,0]
v_lshrrev_b32_e64 v137, 18, v137
ds_read_b128 v[232:235], v250 offset:65520
ds_read_u16_d16 v136, v136
ds_read_u16_d16_hi v137, v137
v_mfma_f32_32x32x16_bf16 v[120:135], v[100:103], v[236:239], v[120:135]
v_pk_mul_f16 v148, v149, v148
v_exp_f16 v153, v154
v_exp_f16 v150, v151
v_and_b32_e64 v139, s49, v139
v_fma_mix_f32 v167, v180, v180, v167 op_sel:[0,0,0] op_sel_hi:[1,1,0]
v_exp_f16_e64 v147, v148
v_bfe_u32 v138, v139, 2, 14
ds_read_b128 v[236:239], v248 offset:28672
ds_read_b32 v247, v253 offset:12
ds_read_u16_d16 v138, v138
v_mfma_f32_32x32x16_bf16 v[120:135], v[104:107], v[216:219], v[120:135]
v_exp_f16_sdwa v153, v154 dst_sel:WORD_1 dst_unused:UNUSED_PRESERVE src0_sel:WORD_1
v_lshrrev_b32_e64 v139, 18, v139
v_fma_mix_f32 v167, v181, v181, v167 op_sel:[1,1,0] op_sel_hi:[1,1,0]
v_exp_f16_sdwa v150, v151 dst_sel:WORD_1 dst_unused:UNUSED_PRESERVE src0_sel:WORD_1
v_exp_f16_sdwa v147, v148 dst_sel:WORD_1 dst_unused:UNUSED_PRESERVE src0_sel:WORD_1
v_and_b32_e64 v141, s49, v141
v_fma_mix_f32 v167, v182, v182, v167 op_sel:[0,0,0] op_sel_hi:[1,1,0]
ds_read_b128 v[216:219], v248 offset:31744
ds_read_u16_d16_hi v139, v139
v_mfma_f32_32x32x16_bf16 v[120:135], v[108:111], v[220:223], v[120:135]
v_pk_add_f16 v153, v153, 1.0 op_sel_hi:[1,0]
v_bfe_u32 v140, v141, 2, 14
v_pk_add_f16 v150, v150, 1.0 op_sel_hi:[1,0]
v_pk_add_f16 v147, v147, 1.0 op_sel_hi:[1,0]
v_rcp_f16 v154, v153
v_lshrrev_b32 v141, 18, v141
v_fma_mix_f32 v167, v183, v183, v167 op_sel:[1,1,0] op_sel_hi:[1,1,0]
ds_read_u16_d16 v140, v140
ds_read_u16_d16_hi v141, v141
s_waitcnt lgkmcnt(5)
v_readfirstlane_b32 s43, v247
s_nop 1
s_cmp_ge_u32 s43, 32
s_cbranch_scc1 Lev8
Lev8w:
s_sleep 1
ds_read_b32 v247, v253 offset:12
s_waitcnt lgkmcnt(0)
v_readfirstlane_b32 s43, v247
s_cmp_eq_u32 s76, 0
s_cbranch_scc1 Lev8
s_sub_u32 s76, s76, 1
s_cmp_lt_u32 s43, 32
s_cbranch_scc1 Lev8w
Lev8:
v_rcp_f16 v151, v150
ds_read_b128 v[220:223], v248 offset:29696
v_mfma_f32_32x32x16_bf16 v[120:135], v[112:115], v[224:227], v[120:135]
v_and_b32 v143, s49, v143
v_rcp_f16 v148, v147
v_fma_mix_f32 v167, v184, v184, v167 op_sel:[0,0,0] op_sel_hi:[1,1,0]
v_bfe_u32 v142, v143, 2, 14
s_setprio 0
v_rcp_f16_sdwa v154, v153 dst_sel:WORD_1 dst_unused:UNUSED_PRESERVE src0_sel:WORD_1
v_rcp_f16_sdwa v151, v150 dst_sel:WORD_1 dst_unused:UNUSED_PRESERVE src0_sel:WORD_1
v_lshrrev_b32 v143, 18, v143
ds_read_b128 v[224:227], v245 offset:6528
ds_read_b128 v[192:195], v244 offset:128
ds_read_b128 v[196:199], v244 offset:64
ds_read_u16_d16 v142, v142
ds_read_u16_d16_hi v143, v143
v_mfma_f32_32x32x16_bf16 v[120:135], v[116:119], v[228:231], v[120:135]
v_fma_mix_f32 v167, v185, v185, v167 op_sel:[1,1,0] op_sel_hi:[1,1,0]
v_rcp_f16_sdwa v148, v147 dst_sel:WORD_1 dst_unused:UNUSED_PRESERVE src0_sel:WORD_1
v_and_b32_e64 v177, s49, v177
v_pk_mul_f16 v155, v155, v154
v_fma_mix_f32 v167, v186, v186, v167 op_sel:[0,0,0] op_sel_hi:[1,1,0]
v_pk_mul_f16 v152, v152, v151
v_bfe_u32 v176, v177, 2, 14
v_pk_mul_f16 v149, v149, v148
v_fma_mix_f32 v156, v155, v155, v156 op_sel:[0,0,0] op_sel_hi:[1,1,0]
v_fma_mix_f32 v156, v155, v155, v156 op_sel:[1,1,0] op_sel_hi:[1,1,0]
v_lshrrev_b32 v177, 18, v177
v_fma_mix_f32 v167, v187, v187, v167 op_sel:[1,1,0] op_sel_hi:[1,1,0]
v_fma_mix_f32 v156, v152, v152, v156 op_sel:[0,0,0] op_sel_hi:[1,1,0]
v_fma_mix_f32 v156, v152, v152, v156 op_sel:[1,1,0] op_sel_hi:[1,1,0]
v_fma_mix_f32 v156, v149, v149, v156 op_sel:[0,0,0] op_sel_hi:[1,1,0]
v_fma_mix_f32 v156, v149, v149, v156 op_sel:[1,1,0] op_sel_hi:[1,1,0]
s_setprio 2
v_mfma_f32_32x32x16_bf16 v[0:15], v[232:235], v[232:235], 0
s_add_u32 s46, s80, 14680064
buffer_store_dwordx4 v[76:79], v241, s[32:35], s46 offen sc1
ds_read_b128 v[228:231], v248 offset:32768
ds_read_u16_d16 v176, v176
ds_read_u16_d16_hi v177, v177
v_cvt_pkrtz_f16_f32 v179, v120, v121
v_cvt_pkrtz_f16_f32 v181, v122, v123
v_cvt_pkrtz_f16_f32 v183, v124, v125
v_mfma_f32_32x32x16_bf16 v[16:31], v[232:235], v[232:235], 0
v_cvt_pkrtz_f16_f32 v185, v126, v127
v_cvt_pkrtz_f16_f32 v187, v128, v129
v_cvt_pk_f16_f32 v155, v130, v131
v_cvt_pk_f16_f32 v152, v132, v133
v_mfma_f32_32x32x16_bf16 v[32:47], v[232:235], v[232:235], 0
v_cvt_pk_f16_f32 v149, v134, v135
v_pk_fma_f16 v154, v155, v155, s48
v_and_b32_e64 v179, s49, v179
v_mfma_f32_32x32x16_bf16 v[120:135], v[96:99], v[236:239], 0
ds_read_b128 v[232:235], v248 offset:30720
v_fma_mix_f32 v156, v136, v136, v156 op_sel:[0,0,0] op_sel_hi:[1,1,0]
v_pk_fma_f16 v151, v152, v152, s48
v_pk_fma_f16 v148, v149, v149, s48
v_bfe_u32 v178, v179, 2, 14
v_pk_mul_f16 v154, v155, v154
v_pk_mul_f16 v151, v152, v151
v_fma_mix_f32 v156, v137, v137, v156 op_sel:[1,1,0] op_sel_hi:[1,1,0]
s_waitcnt lgkmcnt(4)
v_mfma_f32_32x32x16_bf16 v[120:135], v[100:103], v[216:219], v[120:135]
ds_read_b128 v[236:239], v245 offset:6144
ds_read_b128 v[200:203], v244
ds_read_b128 v[204:207], v243 offset:128
ds_read_u16_d16 v178, v178
v_lshrrev_b32 v179, 18, v179
v_pk_mul_f16 v148, v149, v148
v_exp_f16 v153, v154
v_exp_f16 v150, v151
v_and_b32_e64 v181, s49, v181
v_fma_mix_f32 v156, v138, v138, v156 op_sel:[0,0,0] op_sel_hi:[1,1,0]
v_mfma_f32_32x32x16_bf16 v[120:135], v[104:107], v[220:223], v[120:135]
ds_read_b128 v[216:219], v248 offset:33792
ds_read_u16_d16_hi v179, v179
v_exp_f16_e64 v147, v148
v_bfe_u32 v180, v181, 2, 14
v_exp_f16_sdwa v153, v154 dst_sel:WORD_1 dst_unused:UNUSED_PRESERVE src0_sel:WORD_1
v_lshrrev_b32_e64 v181, 18, v181
v_fma_mix_f32 v156, v139, v139, v156 op_sel:[1,1,0] op_sel_hi:[1,1,0]
v_smfmac_f32_16x16x32_bf16 v[40:43], v[226:227], v[192:195], v246
ds_read_b128 v[220:223], v245 offset:5760
ds_read_b128 v[208:211], v243 offset:64
ds_read_b128 v[212:215], v243
ds_read_u16_d16 v180, v180
ds_read_u16_d16_hi v181, v181
v_exp_f16_sdwa v150, v151 dst_sel:WORD_1 dst_unused:UNUSED_PRESERVE src0_sel:WORD_1
v_smfmac_f32_16x16x32_bf16 v[24:27], v[224:225], v[196:199], v246
v_exp_f16_sdwa v147, v148 dst_sel:WORD_1 dst_unused:UNUSED_PRESERVE src0_sel:WORD_1
v_and_b32 v183, s49, v183
v_fma_mix_f32 v156, v140, v140, v156 op_sel:[0,0,0] op_sel_hi:[1,1,0]
v_pk_add_f16 v153, v153, 1.0 op_sel_hi:[1,0]
s_waitcnt lgkmcnt(7)
v_mfma_f32_32x32x16_bf16 v[120:135], v[108:111], v[228:231], v[120:135]
ds_read_b128 v[224:227], v245 offset:5376
ds_read_b128 v[192:195], v242 offset:128
ds_read_b128 v[196:199], v242 offset:64
v_bfe_u32 v182, v183, 2, 14
v_pk_add_f16 v150, v150, 1.0 op_sel_hi:[1,0]
v_pk_add_f16 v147, v147, 1.0 op_sel_hi:[1,0]
v_rcp_f16 v154, v153
v_lshrrev_b32 v183, 18, v183
v_fma_mix_f32 v156, v141, v141, v156 op_sel:[1,1,0] op_sel_hi:[1,1,0]
v_mfma_f32_32x32x16_bf16 v[120:135], v[112:115], v[232:235], v[120:135]
ds_read_b128 v[228:231], v248 offset:34816
ds_read_u16_d16 v182, v182
ds_read_u16_d16_hi v183, v183
v_rcp_f16 v151, v150
v_and_b32 v185, s49, v185
v_rcp_f16_e64 v148, v147
v_fma_mix_f32 v156, v142, v142, v156 op_sel:[0,0,0] op_sel_hi:[1,1,0]
v_bfe_u32 v184, v185, 2, 14
v_smfmac_f32_16x16x32_bf16 v[8:11], v[238:239], v[200:203], v246
ds_read_b128 v[232:235], v248 offset:37888
ds_read_u16_d16 v184, v184
v_rcp_f16_sdwa v154, v153 dst_sel:WORD_1 dst_unused:UNUSED_PRESERVE src0_sel:WORD_1
v_rcp_f16_sdwa v151, v150 dst_sel:WORD_1 dst_unused:UNUSED_PRESERVE src0_sel:WORD_1
v_smfmac_f32_16x16x32_bf16 v[40:43], v[236:237], v[204:207], v246
v_lshrrev_b32 v185, 18, v185
v_fma_mix_f32 v156, v143, v143, v156 op_sel:[1,1,0] op_sel_hi:[1,1,0]
s_waitcnt lgkmcnt(6)
v_mfma_f32_32x32x16_bf16 v[120:135], v[116:119], v[216:219], v[120:135]
ds_read_b128 v[236:239], v248 offset:35840
ds_read_u16_d16_hi v185, v185
v_rcp_f16_sdwa v148, v147 dst_sel:WORD_1 dst_unused:UNUSED_PRESERVE src0_sel:WORD_1
v_and_b32_e64 v187, s49, v187
v_pk_mul_f16 v155, v155, v154
v_fma_mix_f32 v156, v176, v176, v156 op_sel:[0,0,0] op_sel_hi:[1,1,0]
v_pk_mul_f16 v152, v152, v151
v_bfe_u32 v186, v187, 2, 14
v_pk_mul_f16 v149, v149, v148
v_smfmac_f32_16x16x32_bf16 v[24:27], v[222:223], v[208:211], v246
ds_read_b128 v[216:219], v248 offset:38912
ds_read_u16_d16 v186, v186
v_fma_mix_f32 v157, v155, v155, v157 op_sel:[0,0,0] op_sel_hi:[1,1,0]
v_fma_mix_f32 v157, v155, v155, v157 op_sel:[1,1,0] op_sel_hi:[1,1,0]
v_lshrrev_b32_e64 v187, 18, v187
v_fma_mix_f32 v156, v177, v177, v156 op_sel:[1,1,0] op_sel_hi:[1,1,0]
v_smfmac_f32_16x16x32_bf16 v[8:11], v[220:221], v[212:215], v246
v_fma_mix_f32 v157, v152, v152, v157 op_sel:[0,0,0] op_sel_hi:[1,1,0]
v_fma_mix_f32 v157, v152, v152, v157 op_sel:[1,1,0] op_sel_hi:[1,1,0]
v_fma_mix_f32 v157, v149, v149, v157 op_sel:[0,0,0] op_sel_hi:[1,1,0]
v_fma_mix_f32 v157, v149, v149, v157 op_sel:[1,1,0] op_sel_hi:[1,1,0]
s_setprio 1
v_smfmac_f32_16x16x32_bf16 v[40:43], v[226:227], v[192:195], v246
s_waitcnt lgkmcnt(4)
s_add_u32 s46, s80, 16777216
buffer_store_dwordx4 v[80:83], v241, s[32:35], s46 offen sc1
ds_read_b128 v[220:223], v248 offset:36864
ds_read_u16_d16_hi v187, v187
v_cvt_pkrtz_f16_f32 v137, v120, v121
v_cvt_pkrtz_f16_f32 v139, v122, v123
v_cvt_pkrtz_f16_f32 v141, v124, v125
v_cvt_pkrtz_f16_f32 v143, v126, v127
v_cvt_pk_f16_f32 v155, v128, v129
v_smfmac_f32_16x16x32_bf16 v[24:27], v[224:225], v[196:199], v246
v_cvt_pk_f16_f32 v152, v130, v131
v_cvt_pk_f16_f32 v149, v132, v133
v_cvt_pk_f16_f32 v146, v134, v135
v_pk_fma_f16 v154, v155, v155, s48
v_and_b32_e64 v137, s49, v137
v_mfma_f32_32x32x16_bf16 v[120:135], v[96:99], v[228:231], 0
ds_read_b128 v[224:227], v248 offset:39936
v_fma_mix_f32 v157, v178, v178, v157 op_sel:[0,0,0] op_sel_hi:[1,1,0]
v_pk_fma_f16 v151, v152, v152, s48
v_pk_fma_f16 v148, v149, v149, s48
v_pk_fma_f16 v145, v146, v146, s48
v_pk_mul_f16 v154, v155, v154
v_bfe_u32 v136, v137, 2, 14
v_pk_mul_f16 v151, v152, v151
v_fma_mix_f32 v157, v179, v179, v157 op_sel:[1,1,0] op_sel_hi:[1,1,0]
v_pk_mul_f16 v148, v149, v148
v_pk_mul_f16 v145, v146, v145
v_mfma_f32_32x32x16_bf16 v[120:135], v[100:103], v[232:235], v[120:135]
ds_read_b128 v[228:231], v245 offset:4992
ds_read_b128 v[200:203], v242
v_xor_b32 v244, 16, v244
ds_read_b128 v[204:207], v244 offset:128
ds_read_u16_d16 v136, v136
v_exp_f16 v153, v154
v_lshrrev_b32 v137, 18, v137
v_exp_f16 v150, v151
v_fma_mix_f32 v157, v180, v180, v157 op_sel:[0,0,0] op_sel_hi:[1,1,0]
v_exp_f16 v147, v148
v_and_b32 v139, s49, v139
v_exp_f16 v144, v145
s_waitcnt lgkmcnt(5)
v_mfma_f32_32x32x16_bf16 v[120:135], v[104:107], v[236:239], v[120:135]
ds_read_b128 v[232:235], v245 offset:4608
ds_read_b128 v[208:211], v244 offset:64
ds_read_b128 v[212:215], v244
ds_read_u16_d16_hi v137, v137
v_exp_f16_sdwa v153, v154 dst_sel:WORD_1 dst_unused:UNUSED_PRESERVE src0_sel:WORD_1
v_fma_mix_f32 v157, v181, v181, v157 op_sel:[1,1,0] op_sel_hi:[1,1,0]
v_bfe_u32 v138, v139, 2, 14
v_exp_f16_sdwa v150, v151 dst_sel:WORD_1 dst_unused:UNUSED_PRESERVE src0_sel:WORD_1
v_exp_f16_sdwa v147, v148 dst_sel:WORD_1 dst_unused:UNUSED_PRESERVE src0_sel:WORD_1
v_exp_f16_sdwa v144, v145 dst_sel:WORD_1 dst_unused:UNUSED_PRESERVE src0_sel:WORD_1
v_lshrrev_b32_e64 v139, 18, v139
v_fma_mix_f32 v157, v182, v182, v157 op_sel:[0,0,0] op_sel_hi:[1,1,0]
v_mfma_f32_32x32x16_bf16 v[120:135], v[108:111], v[216:219], v[120:135]
ds_read_b128 v[236:239], v248 offset:40960
ds_read_u16_d16 v138, v138
ds_read_u16_d16_hi v139, v139
v_pk_add_f16 v153, v153, 1.0 op_sel_hi:[1,0]
v_pk_add_f16 v150, v150, 1.0 op_sel_hi:[1,0]
v_pk_add_f16 v147, v147, 1.0 op_sel_hi:[1,0]
v_and_b32_e64 v141, s49, v141
v_pk_add_f16 v144, v144, 1.0 op_sel_hi:[1,0]
v_rcp_f16_e64 v154, v153
v_fma_mix_f32 v157, v183, v183, v157 op_sel:[1,1,0] op_sel_hi:[1,1,0]
v_rcp_f16_e64 v151, v150
v_mfma_f32_32x32x16_bf16 v[120:135], v[112:115], v[220:223], v[120:135]
ds_read_b128 v[216:219], v248 offset:44032
v_bfe_u32 v140, v141, 2, 14
v_rcp_f16_e64 v148, v147
v_fma_mix_f32 v157, v184, v184, v157 op_sel:[0,0,0] op_sel_hi:[1,1,0]
v_rcp_f16 v145, v144
v_lshrrev_b32 v141, 18, v141
v_rcp_f16_sdwa v154, v153 dst_sel:WORD_1 dst_unused:UNUSED_PRESERVE src0_sel:WORD_1
s_setprio 0
v_rcp_f16_sdwa v151, v150 dst_sel:WORD_1 dst_unused:UNUSED_PRESERVE src0_sel:WORD_1
s_waitcnt lgkmcnt(4)
v_mfma_f32_32x32x16_bf16 v[120:135], v[116:119], v[224:227], v[120:135]
ds_read_b128 v[220:223], v248 offset:41984
ds_read_u16_d16 v140, v140
ds_read_u16_d16_hi v141, v141
v_fma_mix_f32 v157, v185, v185, v157 op_sel:[1,1,0] op_sel_hi:[1,1,0]
v_and_b32_e64 v143, s49, v143
v_rcp_f16_sdwa v148, v147 dst_sel:WORD_1 dst_unused:UNUSED_PRESERVE src0_sel:WORD_1
v_rcp_f16_sdwa v145, v144 dst_sel:WORD_1 dst_unused:UNUSED_PRESERVE src0_sel:WORD_1
v_pk_mul_f16 v155, v155, v154
v_bfe_u32 v142, v143, 2, 14
v_fma_mix_f32 v157, v186, v186, v157 op_sel:[0,0,0] op_sel_hi:[1,1,0]
v_pk_mul_f16 v152, v152, v151
v_pk_mul_f16 v149, v149, v148
v_smfmac_f32_16x16x32_bf16 v[8:11], v[230:231], v[200:203], v246
ds_read_b128 v[224:227], v248 offset:45056
ds_read_u16_d16 v142, v142
v_pk_mul_f16 v146, v146, v145
v_fma_mix_f32 v158, v155, v155, v158 op_sel:[0,0,0] op_sel_hi:[1,1,0]
v_lshrrev_b32 v143, 18, v143
v_fma_mix_f32 v158, v155, v155, v158 op_sel:[1,1,0] op_sel_hi:[1,1,0]
v_fma_mix_f32 v158, v152, v152, v158 op_sel:[0,0,0] op_sel_hi:[1,1,0]
v_smfmac_f32_16x16x32_bf16 v[44:47], v[228:229], v[204:207], v246
v_fma_mix_f32 v157, v187, v187, v157 op_sel:[1,1,0] op_sel_hi:[1,1,0]
v_fma_mix_f32 v158, v152, v152, v158 op_sel:[1,1,0] op_sel_hi:[1,1,0]
v_fma_mix_f32 v158, v149, v149, v158 op_sel:[0,0,0] op_sel_hi:[1,1,0]
v_fma_mix_f32 v158, v149, v149, v158 op_sel:[1,1,0] op_sel_hi:[1,1,0]
v_fma_mix_f32 v158, v146, v146, v158 op_sel:[0,0,0] op_sel_hi:[1,1,0]
v_fma_mix_f32 v158, v146, v146, v158 op_sel:[1,1,0] op_sel_hi:[1,1,0]
s_setprio 2
v_smfmac_f32_16x16x32_bf16 v[28:31], v[234:235], v[208:211], v246
s_add_u32 s46, s80, 18874368
buffer_store_dwordx4 v[84:87], v241, s[32:35], s46 offen sc1
ds_read_b128 v[228:231], v248 offset:43008
ds_read_u16_d16_hi v143, v143
v_cvt_pkrtz_f16_f32 v179, v120, v121
v_cvt_pkrtz_f16_f32 v181, v122, v123
v_cvt_pkrtz_f16_f32 v183, v124, v125
v_cvt_pkrtz_f16_f32 v185, v126, v127
v_smfmac_f32_16x16x32_bf16 v[12:15], v[232:233], v[212:215], v246
v_cvt_pkrtz_f16_f32 v187, v128, v129
v_cvt_pk_f16_f32 v155, v130, v131
v_cvt_pk_f16_f32 v152, v132, v133
v_cvt_pk_f16_f32 v149, v134, v135
v_pk_fma_f16 v154, v155, v155, s48
s_waitcnt lgkmcnt(2)
v_mfma_f32_32x32x16_bf16 v[120:135], v[96:99], v[236:239], 0
ds_read_b128 v[232:235], v248 offset:46080
v_and_b32 v179, s49, v179
v_fma_mix_f32 v158, v136, v136, v158 op_sel:[0,0,0] op_sel_hi:[1,1,0]
v_pk_fma_f16 v151, v152, v152, s48
v_pk_fma_f16 v148, v149, v149, s48
v_bfe_u32 v178, v179, 2, 14
v_pk_mul_f16 v154, v155, v154
v_pk_mul_f16 v151, v152, v151
v_pk_mul_f16 v148, v149, v148
v_lshrrev_b32 v179, 18, v179
v_mfma_f32_32x32x16_bf16 v[120:135], v[100:103], v[216:219], v[120:135]
ds_read_b128 v[236:239], v245 offset:4224
v_xor_b32 v243, 16, v243
ds_read_b128 v[192:195], v243 offset:128
ds_read_b128 v[196:199], v243 offset:64
ds_read_u16_d16 v178, v178
ds_read_u16_d16_hi v179, v179
v_fma_mix_f32 v158, v137, v137, v158 op_sel:[1,1,0] op_sel_hi:[1,1,0]
v_exp_f16 v153, v154
v_and_b32 v181, s49, v181
v_exp_f16 v150, v151
v_exp_f16 v147, v148
v_bfe_u32 v180, v181, 2, 14
v_mfma_f32_32x32x16_bf16 v[120:135], v[104:107], v[220:223], v[120:135]
ds_read_b128 v[216:219], v245 offset:3840
ds_read_b128 v[200:203], v243
v_xor_b32 v242, 16, v242
ds_read_b128 v[204:207], v242 offset:128
ds_read_u16_d16 v180, v180
v_fma_mix_f32 v158, v138, v138, v158 op_sel:[0,0,0] op_sel_hi:[1,1,0]
v_exp_f16_sdwa v153, v154 dst_sel:WORD_1 dst_unused:UNUSED_PRESERVE src0_sel:WORD_1
v_lshrrev_b32 v181, 18, v181
v_exp_f16_sdwa v150, v151 dst_sel:WORD_1 dst_unused:UNUSED_PRESERVE src0_sel:WORD_1
v_fma_mix_f32 v158, v139, v139, v158 op_sel:[1,1,0] op_sel_hi:[1,1,0]
v_and_b32_e64 v183, s49, v183
v_mfma_f32_32x32x16_bf16 v[120:135], v[108:111], v[224:227], v[120:135]
ds_read_b128 v[220:223], v248 offset:47104
ds_read_u16_d16_hi v181, v181
v_exp_f16_sdwa v147, v148 dst_sel:WORD_1 dst_unused:UNUSED_PRESERVE src0_sel:WORD_1
v_pk_add_f16 v153, v153, 1.0 op_sel_hi:[1,0]
v_bfe_u32 v182, v183, 2, 14
v_pk_add_f16 v150, v150, 1.0 op_sel_hi:[1,0]
v_pk_add_f16 v147, v147, 1.0 op_sel_hi:[1,0]
v_rcp_f16_e64 v154, v153
v_lshrrev_b32 v183, 18, v183
v_fma_mix_f32 v158, v140, v140, v158 op_sel:[0,0,0] op_sel_hi:[1,1,0]
s_waitcnt lgkmcnt(6)
v_mfma_f32_32x32x16_bf16 v[120:135], v[112:115], v[228:231], v[120:135]
ds_read_b128 v[224:227], v248 offset:50176
ds_read_u16_d16 v182, v182
ds_read_u16_d16_hi v183, v183
v_rcp_f16 v151, v150
v_and_b32 v185, s49, v185
v_rcp_f16_e64 v148, v147
v_fma_mix_f32 v158, v141, v141, v158 op_sel:[1,1,0] op_sel_hi:[1,1,0]
v_bfe_u32 v184, v185, 2, 14
v_rcp_f16_sdwa v154, v153 dst_sel:WORD_1 dst_unused:UNUSED_PRESERVE src0_sel:WORD_1
v_mfma_f32_32x32x16_bf16 v[120:135], v[116:119], v[232:235], v[120:135]
ds_read_b128 v[228:231], v248 offset:48128
ds_read_u16_d16 v184, v184
v_rcp_f16_sdwa v151, v150 dst_sel:WORD_1 dst_unused:UNUSED_PRESERVE src0_sel:WORD_1
v_lshrrev_b32_e64 v185, 18, v185
v_rcp_f16_sdwa v148, v147 dst_sel:WORD_1 dst_unused:UNUSED_PRESERVE src0_sel:WORD_1
v_and_b32_e64 v187, s49, v187
v_fma_mix_f32 v158, v142, v142, v158 op_sel:[0,0,0] op_sel_hi:[1,1,0]
v_pk_mul_f16 v155, v155, v154
v_pk_mul_f16 v152, v152, v151
v_smfmac_f32_16x16x32_bf16 v[44:47], v[238:239], v[192:195], v246
ds_read_b128 v[232:235], v248 offset:51200
ds_read_u16_d16_hi v185, v185
v_bfe_u32 v186, v187, 2, 14
v_pk_mul_f16 v149, v149, v148
v_fma_mix_f32 v159, v155, v155, v159 op_sel:[0,0,0] op_sel_hi:[1,1,0]
v_fma_mix_f32 v158, v143, v143, v158 op_sel:[1,1,0] op_sel_hi:[1,1,0]
v_lshrrev_b32_e64 v187, 18, v187
v_smfmac_f32_16x16x32_bf16 v[28:31], v[236:237], v[196:199], v246
v_fma_mix_f32 v159, v155, v155, v159 op_sel:[1,1,0] op_sel_hi:[1,1,0]
v_fma_mix_f32 v159, v152, v152, v159 op_sel:[0,0,0] op_sel_hi:[1,1,0]
v_fma_mix_f32 v159, v152, v152, v159 op_sel:[1,1,0] op_sel_hi:[1,1,0]
v_fma_mix_f32 v159, v149, v149, v159 op_sel:[0,0,0] op_sel_hi:[1,1,0]
v_fma_mix_f32 v159, v149, v149, v159 op_sel:[1,1,0] op_sel_hi:[1,1,0]
s_setprio 1
s_waitcnt lgkmcnt(4)
v_smfmac_f32_16x16x32_bf16 v[12:15], v[218:219], v[200:203], v246
s_add_u32 s46, s80, 20971520
buffer_store_dwordx4 v[88:91], v241, s[32:35], s46 offen sc1
ds_read_b128 v[236:239], v248 offset:49152
ds_read_u16_d16 v186, v186
ds_read_u16_d16_hi v187, v187
v_cvt_pkrtz_f16_f32 v137, v120, v121
v_cvt_pkrtz_f16_f32 v139, v122, v123
v_cvt_pkrtz_f16_f32 v141, v124, v125
v_cvt_pkrtz_f16_f32 v143, v126, v127
v_cvt_pk_f16_f32 v155, v128, v129
v_smfmac_f32_16x16x32_bf16 v[44:47], v[216:217], v[204:207], v246
v_cvt_pk_f16_f32 v152, v130, v131
v_cvt_pk_f16_f32 v149, v132, v133
v_cvt_pk_f16_f32 v146, v134, v135
v_pk_fma_f16 v154, v155, v155, s48
v_and_b32_e64 v137, s49, v137
v_mfma_f32_32x32x16_bf16 v[120:135], v[96:99], v[220:223], 0
ds_read_b128 v[216:219], v248 offset:52224
v_fma_mix_f32 v159, v178, v178, v159 op_sel:[0,0,0] op_sel_hi:[1,1,0]
v_pk_fma_f16 v151, v152, v152, s48
v_pk_fma_f16 v148, v149, v149, s48
v_pk_fma_f16 v145, v146, v146, s48
v_pk_mul_f16 v154, v155, v154
v_bfe_u32 v136, v137, 2, 14
v_pk_mul_f16 v151, v152, v151
v_fma_mix_f32 v159, v179, v179, v159 op_sel:[1,1,0] op_sel_hi:[1,1,0]
v_pk_mul_f16 v148, v149, v148
v_pk_mul_f16 v145, v146, v145
v_mfma_f32_32x32x16_bf16 v[120:135], v[100:103], v[224:227], v[120:135]
ds_read_b128 v[220:223], v245 offset:3456
ds_read_b128 v[208:211], v242 offset:64
ds_read_b128 v[212:215], v242
ds_read_u16_d16 v136, v136
v_exp_f16 v153, v154
v_lshrrev_b32 v137, 18, v137
v_exp_f16_e64 v150, v151
v_fma_mix_f32 v159, v180, v180, v159 op_sel:[0,0,0] op_sel_hi:[1,1,0]
v_exp_f16 v147, v148
v_and_b32 v139, s49, v139
v_exp_f16_e64 v144, v145
s_waitcnt lgkmcnt(5)
v_mfma_f32_32x32x16_bf16 v[120:135], v[104:107], v[228:231], v[120:135]
ds_read_b128 v[224:227], v245 offset:3072
v_xor_b32 v244, 32, v244
ds_read_b128 v[192:195], v244 offset:128
ds_read_b128 v[196:199], v244 offset:64
ds_read_u16_d16_hi v137, v137
v_exp_f16_sdwa v153, v154 dst_sel:WORD_1 dst_unused:UNUSED_PRESERVE src0_sel:WORD_1
v_fma_mix_f32 v159, v181, v181, v159 op_sel:[1,1,0] op_sel_hi:[1,1,0]
v_bfe_u32 v138, v139, 2, 14
v_exp_f16_sdwa v150, v151 dst_sel:WORD_1 dst_unused:UNUSED_PRESERVE src0_sel:WORD_1
v_exp_f16_sdwa v147, v148 dst_sel:WORD_1 dst_unused:UNUSED_PRESERVE src0_sel:WORD_1
v_exp_f16_sdwa v144, v145 dst_sel:WORD_1 dst_unused:UNUSED_PRESERVE src0_sel:WORD_1
v_lshrrev_b32_e64 v139, 18, v139
v_fma_mix_f32 v159, v182, v182, v159 op_sel:[0,0,0] op_sel_hi:[1,1,0]
v_mfma_f32_32x32x16_bf16 v[120:135], v[108:111], v[232:235], v[120:135]
ds_read_b128 v[228:231], v248 offset:53248
ds_read_u16_d16 v138, v138
ds_read_u16_d16_hi v139, v139
v_pk_add_f16 v153, v153, 1.0 op_sel_hi:[1,0]
v_pk_add_f16 v150, v150, 1.0 op_sel_hi:[1,0]
v_pk_add_f16 v147, v147, 1.0 op_sel_hi:[1,0]
v_and_b32_e64 v141, s49, v141
v_pk_add_f16 v144, v144, 1.0 op_sel_hi:[1,0]
v_rcp_f16_e64 v154, v153
v_fma_mix_f32 v159, v183, v183, v159 op_sel:[1,1,0] op_sel_hi:[1,1,0]
v_rcp_f16_e64 v151, v150
v_mfma_f32_32x32x16_bf16 v[120:135], v[112:115], v[236:239], v[120:135]
ds_read_b128 v[232:235], v248 offset:56320
v_bfe_u32 v140, v141, 2, 14
v_rcp_f16_e64 v148, v147
v_fma_mix_f32 v159, v184, v184, v159 op_sel:[0,0,0] op_sel_hi:[1,1,0]
v_rcp_f16 v145, v144
v_lshrrev_b32 v141, 18, v141
v_rcp_f16_sdwa v154, v153 dst_sel:WORD_1 dst_unused:UNUSED_PRESERVE src0_sel:WORD_1
s_setprio 0
v_rcp_f16_sdwa v151, v150 dst_sel:WORD_1 dst_unused:UNUSED_PRESERVE src0_sel:WORD_1
s_waitcnt lgkmcnt(4)
v_mfma_f32_32x32x16_bf16 v[120:135], v[116:119], v[216:219], v[120:135]
ds_read_b128 v[236:239], v248 offset:54272
ds_read_u16_d16 v140, v140
ds_read_u16_d16_hi v141, v141
v_fma_mix_f32 v159, v185, v185, v159 op_sel:[1,1,0] op_sel_hi:[1,1,0]
v_and_b32_e64 v143, s49, v143
v_rcp_f16_sdwa v148, v147 dst_sel:WORD_1 dst_unused:UNUSED_PRESERVE src0_sel:WORD_1
v_rcp_f16_sdwa v145, v144 dst_sel:WORD_1 dst_unused:UNUSED_PRESERVE src0_sel:WORD_1
v_pk_mul_f16 v155, v155, v154
v_bfe_u32 v142, v143, 2, 14
v_fma_mix_f32 v159, v186, v186, v159 op_sel:[0,0,0] op_sel_hi:[1,1,0]
v_pk_mul_f16 v152, v152, v151
v_pk_mul_f16 v149, v149, v148
v_smfmac_f32_16x16x32_bf16 v[28:31], v[222:223], v[208:211], v246
ds_read_b128 v[216:219], v248 offset:57344
ds_read_u16_d16 v142, v142
v_pk_mul_f16 v146, v146, v145
v_fma_mix_f32 v160, v155, v155, v160 op_sel:[0,0,0] op_sel_hi:[1,1,0]
v_lshrrev_b32 v143, 18, v143
v_fma_mix_f32 v160, v155, v155, v160 op_sel:[1,1,0] op_sel_hi:[1,1,0]
v_fma_mix_f32 v160, v152, v152, v160 op_sel:[0,0,0] op_sel_hi:[1,1,0]
v_smfmac_f32_16x16x32_bf16 v[12:15], v[220:221], v[212:215], v246
v_fma_mix_f32 v159, v187, v187, v159 op_sel:[1,1,0] op_sel_hi:[1,1,0]
v_fma_mix_f32 v160, v152, v152, v160 op_sel:[1,1,0] op_sel_hi:[1,1,0]
v_fma_mix_f32 v160, v149, v149, v160 op_sel:[0,0,0] op_sel_hi:[1,1,0]
v_fma_mix_f32 v160, v149, v149, v160 op_sel:[1,1,0] op_sel_hi:[1,1,0]
v_fma_mix_f32 v160, v146, v146, v160 op_sel:[0,0,0] op_sel_hi:[1,1,0]
v_fma_mix_f32 v160, v146, v146, v160 op_sel:[1,1,0] op_sel_hi:[1,1,0]
s_setprio 2
v_smfmac_f32_16x16x32_bf16 v[36:39], v[226:227], v[192:195], v246
s_add_u32 s46, s80, 23068672
buffer_store_dwordx4 v[92:95], v241, s[32:35], s46 offen sc1
ds_read_b128 v[220:223], v248 offset:55296
ds_read_u16_d16_hi v143, v143
v_cvt_pkrtz_f16_f32 v179, v120, v121
v_cvt_pkrtz_f16_f32 v181, v122, v123
v_cvt_pkrtz_f16_f32 v183, v124, v125
v_cvt_pkrtz_f16_f32 v185, v126, v127
v_smfmac_f32_16x16x32_bf16 v[20:23], v[224:225], v[196:199], v246
v_cvt_pkrtz_f16_f32 v187, v128, v129
v_cvt_pk_f16_f32 v155, v130, v131
v_cvt_pk_f16_f32 v152, v132, v133
v_cvt_pk_f16_f32 v149, v134, v135
s_waitcnt lgkmcnt(2)
v_mfma_f32_32x32x16_bf16 v[120:135], v[96:99], v[228:231], 0
ds_read_b128 v[224:227], v245 offset:2688
ds_read_b128 v[200:203], v244
v_xor_b32 v243, 32, v243
ds_read_b128 v[204:207], v243 offset:128
v_pk_fma_f16 v154, v155, v155, s48
v_and_b32_e64 v179, s49, v179
v_fma_mix_f32 v160, v136, v136, v160 op_sel:[0,0,0] op_sel_hi:[1,1,0]
v_pk_fma_f16 v151, v152, v152, s48
v_pk_fma_f16 v148, v149, v149, s48
v_bfe_u32 v178, v179, 2, 14
v_pk_mul_f16 v154, v155, v154
v_pk_mul_f16 v151, v152, v151
v_mfma_f32_32x32x16_bf16 v[120:135], v[100:103], v[232:235], v[120:135]
ds_read_b128 v[228:231], v248 offset:58368
ds_read_u16_d16 v178, v178
v_pk_mul_f16 v148, v149, v148
v_lshrrev_b32_e64 v179, 18, v179
v_fma_mix_f32 v160, v137, v137, v160 op_sel:[1,1,0] op_sel_hi:[1,1,0]
v_exp_f16 v153, v154
v_and_b32 v181, s49, v181
v_exp_f16_e64 v150, v151
v_mfma_f32_32x32x16_bf16 v[120:135], v[104:107], v[236:239], v[120:135]
ds_read_b128 v[232:235], v245 offset:2304
ds_read_b128 v[208:211], v243 offset:64
ds_read_b128 v[212:215], v243
ds_read_u16_d16_hi v179, v179
v_exp_f16_e64 v147, v148
v_bfe_u32 v180, v181, 2, 14
v_fma_mix_f32 v160, v138, v138, v160 op_sel:[0,0,0] op_sel_hi:[1,1,0]
v_exp_f16_sdwa v153, v154 dst_sel:WORD_1 dst_unused:UNUSED_PRESERVE src0_sel:WORD_1
v_lshrrev_b32 v181, 18, v181
v_mfma_f32_32x32x16_bf16 v[120:135], v[108:111], v[216:219], v[120:135]
ds_read_b128 v[236:239], v245 offset:1920
v_xor_b32 v242, 32, v242
ds_read_b128 v[192:195], v242 offset:128
ds_read_b128 v[196:199], v242 offset:64
ds_read_u16_d16 v180, v180
ds_read_u16_d16_hi v181, v181
v_exp_f16_sdwa v150, v151 dst_sel:WORD_1 dst_unused:UNUSED_PRESERVE src0_sel:WORD_1
v_fma_mix_f32 v160, v139, v139, v160 op_sel:[1,1,0] op_sel_hi:[1,1,0]
v_and_b32 v183, s49, v183
v_exp_f16_sdwa v147, v148 dst_sel:WORD_1 dst_unused:UNUSED_PRESERVE src0_sel:WORD_1
v_pk_add_f16 v153, v153, 1.0 op_sel_hi:[1,0]
v_bfe_u32 v182, v183, 2, 14
v_pk_add_f16 v150, v150, 1.0 op_sel_hi:[1,0]
s_waitcnt lgkmcnt(9)
v_mfma_f32_32x32x16_bf16 v[120:135], v[112:115], v[220:223], v[120:135]
ds_read_b128 v[216:219], v248 offset:59392
ds_read_u16_d16 v182, v182
v_pk_add_f16 v147, v147, 1.0 op_sel_hi:[1,0]
v_rcp_f16 v154, v153
v_lshrrev_b32 v183, 18, v183
v_fma_mix_f32 v160, v140, v140, v160 op_sel:[0,0,0] op_sel_hi:[1,1,0]
v_rcp_f16 v151, v150
v_and_b32 v185, s49, v185
v_smfmac_f32_16x16x32_bf16 v[4:7], v[226:227], v[200:203], v246
ds_read_b128 v[220:223], v248 offset:62464
ds_read_u16_d16_hi v183, v183
v_rcp_f16_e64 v148, v147
v_fma_mix_f32 v160, v141, v141, v160 op_sel:[1,1,0] op_sel_hi:[1,1,0]
v_bfe_u32 v184, v185, 2, 14
v_smfmac_f32_16x16x32_bf16 v[36:39], v[224:225], v[204:207], v246
v_rcp_f16_sdwa v154, v153 dst_sel:WORD_1 dst_unused:UNUSED_PRESERVE src0_sel:WORD_1
v_rcp_f16_sdwa v151, v150 dst_sel:WORD_1 dst_unused:UNUSED_PRESERVE src0_sel:WORD_1
v_mfma_f32_32x32x16_bf16 v[120:135], v[116:119], v[228:231], v[120:135]
ds_read_b128 v[224:227], v248 offset:60416
ds_read_u16_d16 v184, v184
v_lshrrev_b32_e64 v185, 18, v185
v_rcp_f16_sdwa v148, v147 dst_sel:WORD_1 dst_unused:UNUSED_PRESERVE src0_sel:WORD_1
v_and_b32 v187, s49, v187
v_fma_mix_f32 v160, v142, v142, v160 op_sel:[0,0,0] op_sel_hi:[1,1,0]
v_pk_mul_f16 v155, v155, v154
v_pk_mul_f16 v152, v152, v151
v_bfe_u32 v186, v187, 2, 14
s_waitcnt lgkmcnt(4)
v_smfmac_f32_16x16x32_bf16 v[20:23], v[234:235], v[208:211], v246
ds_read_b128 v[228:231], v248 offset:63488
ds_read_u16_d16_hi v185, v185
ds_read_u16_d16 v186, v186
v_pk_mul_f16 v149, v149, v148
v_fma_mix_f32 v161, v155, v155, v161 op_sel:[0,0,0] op_sel_hi:[1,1,0]
v_fma_mix_f32 v160, v143, v143, v160 op_sel:[1,1,0] op_sel_hi:[1,1,0]
v_lshrrev_b32 v187, 18, v187
v_smfmac_f32_16x16x32_bf16 v[4:7], v[232:233], v[212:215], v246
v_fma_mix_f32 v161, v155, v155, v161 op_sel:[1,1,0] op_sel_hi:[1,1,0]
v_fma_mix_f32 v161, v152, v152, v161 op_sel:[0,0,0] op_sel_hi:[1,1,0]
v_fma_mix_f32 v161, v152, v152, v161 op_sel:[1,1,0] op_sel_hi:[1,1,0]
v_fma_mix_f32 v161, v149, v149, v161 op_sel:[0,0,0] op_sel_hi:[1,1,0]
v_fma_mix_f32 v161, v149, v149, v161 op_sel:[1,1,0] op_sel_hi:[1,1,0]
s_setprio 1
v_smfmac_f32_16x16x32_bf16 v[36:39], v[238:239], v[192:195], v246
ds_read_b128 v[232:235], v248 offset:61440
ds_read_u16_d16_hi v187, v187
v_cvt_pkrtz_f16_f32 v137, v120, v121
v_cvt_pkrtz_f16_f32 v139, v122, v123
v_cvt_pkrtz_f16_f32 v141, v124, v125
v_cvt_pkrtz_f16_f32 v143, v126, v127
v_cvt_pk_f16_f32 v155, v128, v129
v_smfmac_f32_16x16x32_bf16 v[20:23], v[236:237], v[196:199], v246
v_cvt_pk_f16_f32 v152, v130, v131
v_cvt_pk_f16_f32 v149, v132, v133
v_cvt_pk_f16_f32 v146, v134, v135
v_pk_fma_f16 v154, v155, v155, s48
v_and_b32_e64 v137, s49, v137
v_mfma_f32_32x32x16_bf16 v[120:135], v[96:99], v[216:219], 0
ds_read_b128 v[236:239], v248 offset:64512
v_fma_mix_f32 v161, v178, v178, v161 op_sel:[0,0,0] op_sel_hi:[1,1,0]
v_pk_fma_f16 v151, v152, v152, s48
v_pk_fma_f16 v148, v149, v149, s48
v_pk_fma_f16 v145, v146, v146, s48
v_pk_mul_f16 v154, v155, v154
v_bfe_u32 v136, v137, 2, 14
v_pk_mul_f16 v151, v152, v151
v_fma_mix_f32 v161, v179, v179, v161 op_sel:[1,1,0] op_sel_hi:[1,1,0]
v_pk_mul_f16 v148, v149, v148
v_pk_mul_f16 v145, v146, v145
s_waitcnt lgkmcnt(2)
v_mfma_f32_32x32x16_bf16 v[120:135], v[100:103], v[220:223], v[120:135]
ds_read_b128 v[216:219], v245 offset:1536
ds_read_b128 v[200:203], v242
v_xor_b32 v244, 16, v244
ds_read_b128 v[204:207], v244 offset:128
ds_read_u16_d16 v136, v136
v_exp_f16 v153, v154
v_lshrrev_b32 v137, 18, v137
v_exp_f16_e64 v150, v151
v_fma_mix_f32 v161, v180, v180, v161 op_sel:[0,0,0] op_sel_hi:[1,1,0]
v_exp_f16 v147, v148
v_and_b32 v139, s49, v139
v_exp_f16_e64 v144, v145
v_mfma_f32_32x32x16_bf16 v[120:135], v[104:107], v[224:227], v[120:135]
ds_read_b128 v[220:223], v245 offset:1152
ds_read_b128 v[208:211], v244 offset:64
ds_read_b128 v[212:215], v244
ds_read_u16_d16_hi v137, v137
v_exp_f16_sdwa v153, v154 dst_sel:WORD_1 dst_unused:UNUSED_PRESERVE src0_sel:WORD_1
v_fma_mix_f32 v161, v181, v181, v161 op_sel:[1,1,0] op_sel_hi:[1,1,0]
v_bfe_u32 v138, v139, 2, 14
v_exp_f16_sdwa v150, v151 dst_sel:WORD_1 dst_unused:UNUSED_PRESERVE src0_sel:WORD_1
v_exp_f16_sdwa v147, v148 dst_sel:WORD_1 dst_unused:UNUSED_PRESERVE src0_sel:WORD_1
v_exp_f16_sdwa v144, v145 dst_sel:WORD_1 dst_unused:UNUSED_PRESERVE src0_sel:WORD_1
v_lshrrev_b32_e64 v139, 18, v139
v_fma_mix_f32 v161, v182, v182, v161 op_sel:[0,0,0] op_sel_hi:[1,1,0]
v_mfma_f32_32x32x16_bf16 v[120:135], v[108:111], v[228:231], v[120:135]
ds_read_b128 v[224:227], v249
ds_read_u16_d16 v138, v138
ds_read_u16_d16_hi v139, v139
v_pk_add_f16 v153, v153, 1.0 op_sel_hi:[1,0]
v_pk_add_f16 v150, v150, 1.0 op_sel_hi:[1,0]
v_pk_add_f16 v147, v147, 1.0 op_sel_hi:[1,0]
v_and_b32_e64 v141, s49, v141
v_pk_add_f16 v144, v144, 1.0 op_sel_hi:[1,0]
v_rcp_f16_e64 v154, v153
v_fma_mix_f32 v161, v183, v183, v161 op_sel:[1,1,0] op_sel_hi:[1,1,0]
v_rcp_f16_e64 v151, v150
v_mfma_f32_32x32x16_bf16 v[120:135], v[112:115], v[232:235], v[120:135]
ds_read_b128 v[228:231], v249 offset:3072
v_bfe_u32 v140, v141, 2, 14
v_rcp_f16_e64 v148, v147
v_fma_mix_f32 v161, v184, v184, v161 op_sel:[0,0,0] op_sel_hi:[1,1,0]
v_rcp_f16 v145, v144
v_lshrrev_b32 v141, 18, v141
v_rcp_f16_sdwa v154, v153 dst_sel:WORD_1 dst_unused:UNUSED_PRESERVE src0_sel:WORD_1
s_setprio 0
v_rcp_f16_sdwa v151, v150 dst_sel:WORD_1 dst_unused:UNUSED_PRESERVE src0_sel:WORD_1
s_waitcnt lgkmcnt(4)
v_mfma_f32_32x32x16_bf16 v[120:135], v[116:119], v[236:239], v[120:135]
ds_read_b128 v[232:235], v249 offset:1024
ds_read_u16_d16 v140, v140
ds_read_u16_d16_hi v141, v141
v_fma_mix_f32 v161, v185, v185, v161 op_sel:[1,1,0] op_sel_hi:[1,1,0]
v_and_b32_e64 v143, s49, v143
v_rcp_f16_sdwa v148, v147 dst_sel:WORD_1 dst_unused:UNUSED_PRESERVE src0_sel:WORD_1
v_rcp_f16_sdwa v145, v144 dst_sel:WORD_1 dst_unused:UNUSED_PRESERVE src0_sel:WORD_1
v_pk_mul_f16 v155, v155, v154
v_bfe_u32 v142, v143, 2, 14
v_fma_mix_f32 v161, v186, v186, v161 op_sel:[0,0,0] op_sel_hi:[1,1,0]
v_pk_mul_f16 v152, v152, v151
v_pk_mul_f16 v149, v149, v148
v_smfmac_f32_16x16x32_bf16 v[4:7], v[218:219], v[200:203], v246
ds_read_b128 v[236:239], v249 offset:4096
ds_read_u16_d16 v142, v142
v_pk_mul_f16 v146, v146, v145
v_fma_mix_f32 v162, v155, v155, v162 op_sel:[0,0,0] op_sel_hi:[1,1,0]
v_lshrrev_b32 v143, 18, v143
v_fma_mix_f32 v162, v155, v155, v162 op_sel:[1,1,0] op_sel_hi:[1,1,0]
v_fma_mix_f32 v162, v152, v152, v162 op_sel:[0,0,0] op_sel_hi:[1,1,0]
v_smfmac_f32_16x16x32_bf16 v[32:35], v[216:217], v[204:207], v246
v_fma_mix_f32 v161, v187, v187, v161 op_sel:[1,1,0] op_sel_hi:[1,1,0]
v_fma_mix_f32 v162, v152, v152, v162 op_sel:[1,1,0] op_sel_hi:[1,1,0]
v_fma_mix_f32 v162, v149, v149, v162 op_sel:[0,0,0] op_sel_hi:[1,1,0]
v_fma_mix_f32 v162, v149, v149, v162 op_sel:[1,1,0] op_sel_hi:[1,1,0]
v_fma_mix_f32 v162, v146, v146, v162 op_sel:[0,0,0] op_sel_hi:[1,1,0]
v_fma_mix_f32 v162, v146, v146, v162 op_sel:[1,1,0] op_sel_hi:[1,1,0]
s_setprio 2
v_smfmac_f32_16x16x32_bf16 v[16:19], v[222:223], v[208:211], v246
ds_read_b128 v[216:219], v249 offset:2048
ds_read_u16_d16_hi v143, v143
v_cvt_pkrtz_f16_f32 v179, v120, v121
v_cvt_pkrtz_f16_f32 v181, v122, v123
v_cvt_pkrtz_f16_f32 v183, v124, v125
v_cvt_pkrtz_f16_f32 v185, v126, v127
v_smfmac_f32_16x16x32_bf16 v[0:3], v[220:221], v[212:215], v246
v_cvt_pkrtz_f16_f32 v187, v128, v129
v_cvt_pk_f16_f32 v155, v130, v131
v_cvt_pk_f16_f32 v152, v132, v133
v_cvt_pk_f16_f32 v149, v134, v135
v_pk_fma_f16 v154, v155, v155, s48
s_waitcnt lgkmcnt(2)
v_mfma_f32_32x32x16_bf16 v[120:135], v[96:99], v[224:227], 0
ds_read_b128 v[220:223], v249 offset:5120
v_and_b32 v179, s49, v179
v_fma_mix_f32 v162, v136, v136, v162 op_sel:[0,0,0] op_sel_hi:[1,1,0]
v_pk_fma_f16 v151, v152, v152, s48
v_pk_fma_f16 v148, v149, v149, s48
v_bfe_u32 v178, v179, 2, 14
v_pk_mul_f16 v154, v155, v154
v_pk_mul_f16 v151, v152, v151
v_pk_mul_f16 v148, v149, v148
v_lshrrev_b32 v179, 18, v179
v_mfma_f32_32x32x16_bf16 v[120:135], v[100:103], v[228:231], v[120:135]
ds_read_b128 v[224:227], v245 offset:768
v_xor_b32 v243, 16, v243
ds_read_b128 v[192:195], v243 offset:128
ds_read_b128 v[196:199], v243 offset:64
ds_read_u16_d16 v178, v178
ds_read_u16_d16_hi v179, v179
v_fma_mix_f32 v162, v137, v137, v162 op_sel:[1,1,0] op_sel_hi:[1,1,0]
v_exp_f16 v153, v154
v_and_b32 v181, s49, v181
v_exp_f16 v150, v151
v_exp_f16 v147, v148
v_bfe_u32 v180, v181, 2, 14
v_mfma_f32_32x32x16_bf16 v[120:135], v[104:107], v[232:235], v[120:135]
ds_read_b128 v[228:231], v245 offset:384
ds_read_b128 v[200:203], v243
v_xor_b32 v242, 16, v242
ds_read_b128 v[204:207], v242 offset:128
ds_read_u16_d16 v180, v180
v_fma_mix_f32 v162, v138, v138, v162 op_sel:[0,0,0] op_sel_hi:[1,1,0]
v_exp_f16_sdwa v153, v154 dst_sel:WORD_1 dst_unused:UNUSED_PRESERVE src0_sel:WORD_1
v_lshrrev_b32 v181, 18, v181
v_exp_f16_sdwa v150, v151 dst_sel:WORD_1 dst_unused:UNUSED_PRESERVE src0_sel:WORD_1
v_fma_mix_f32 v162, v139, v139, v162 op_sel:[1,1,0] op_sel_hi:[1,1,0]
v_and_b32_e64 v183, s49, v183
v_mfma_f32_32x32x16_bf16 v[120:135], v[108:111], v[236:239], v[120:135]
ds_read_b128 v[232:235], v249 offset:6144
ds_read_u16_d16_hi v181, v181
v_exp_f16_sdwa v147, v148 dst_sel:WORD_1 dst_unused:UNUSED_PRESERVE src0_sel:WORD_1
v_pk_add_f16 v153, v153, 1.0 op_sel_hi:[1,0]
v_bfe_u32 v182, v183, 2, 14
v_pk_add_f16 v150, v150, 1.0 op_sel_hi:[1,0]
v_pk_add_f16 v147, v147, 1.0 op_sel_hi:[1,0]
v_rcp_f16_e64 v154, v153
v_lshrrev_b32 v183, 18, v183
v_fma_mix_f32 v162, v140, v140, v162 op_sel:[0,0,0] op_sel_hi:[1,1,0]
s_waitcnt lgkmcnt(6)
v_mfma_f32_32x32x16_bf16 v[120:135], v[112:115], v[216:219], v[120:135]
ds_read_b128 v[236:239], v249 offset:9216
ds_read_u16_d16 v182, v182
ds_read_u16_d16_hi v183, v183
v_rcp_f16 v151, v150
v_and_b32 v185, s49, v185
v_rcp_f16_e64 v148, v147
v_fma_mix_f32 v162, v141, v141, v162 op_sel:[1,1,0] op_sel_hi:[1,1,0]
v_bfe_u32 v184, v185, 2, 14
v_rcp_f16_sdwa v154, v153 dst_sel:WORD_1 dst_unused:UNUSED_PRESERVE src0_sel:WORD_1
v_mfma_f32_32x32x16_bf16 v[120:135], v[116:119], v[220:223], v[120:135]
ds_read_b128 v[216:219], v249 offset:7168
ds_read_u16_d16 v184, v184
v_rcp_f16_sdwa v151, v150 dst_sel:WORD_1 dst_unused:UNUSED_PRESERVE src0_sel:WORD_1
v_lshrrev_b32_e64 v185, 18, v185
v_rcp_f16_sdwa v148, v147 dst_sel:WORD_1 dst_unused:UNUSED_PRESERVE src0_sel:WORD_1
v_and_b32_e64 v187, s49, v187
v_fma_mix_f32 v162, v142, v142, v162 op_sel:[0,0,0] op_sel_hi:[1,1,0]
v_pk_mul_f16 v155, v155, v154
v_pk_mul_f16 v152, v152, v151
v_smfmac_f32_16x16x32_bf16 v[32:35], v[226:227], v[192:195], v246
ds_read_b128 v[220:223], v249 offset:10240
ds_read_u16_d16_hi v185, v185
v_bfe_u32 v186, v187, 2, 14
v_pk_mul_f16 v149, v149, v148
v_fma_mix_f32 v163, v155, v155, v163 op_sel:[0,0,0] op_sel_hi:[1,1,0]
v_fma_mix_f32 v162, v143, v143, v162 op_sel:[1,1,0] op_sel_hi:[1,1,0]
v_lshrrev_b32_e64 v187, 18, v187
v_smfmac_f32_16x16x32_bf16 v[16:19], v[224:225], v[196:199], v246
v_fma_mix_f32 v163, v155, v155, v163 op_sel:[1,1,0] op_sel_hi:[1,1,0]
v_fma_mix_f32 v163, v152, v152, v163 op_sel:[0,0,0] op_sel_hi:[1,1,0]
v_fma_mix_f32 v163, v152, v152, v163 op_sel:[1,1,0] op_sel_hi:[1,1,0]
v_fma_mix_f32 v163, v149, v149, v163 op_sel:[0,0,0] op_sel_hi:[1,1,0]
v_fma_mix_f32 v163, v149, v149, v163 op_sel:[1,1,0] op_sel_hi:[1,1,0]
s_setprio 1
s_waitcnt lgkmcnt(4)
v_smfmac_f32_16x16x32_bf16 v[0:3], v[230:231], v[200:203], v246
ds_read_b128 v[224:227], v249 offset:8192
ds_read_u16_d16 v186, v186
ds_read_u16_d16_hi v187, v187
v_cvt_pkrtz_f16_f32 v137, v120, v121
v_cvt_pkrtz_f16_f32 v139, v122, v123
v_cvt_pkrtz_f16_f32 v141, v124, v125
v_cvt_pkrtz_f16_f32 v143, v126, v127
v_smfmac_f32_16x16x32_bf16 v[32:35], v[228:229], v[204:207], v246
v_cvt_pk_f16_f32 v155, v128, v129
v_cvt_pk_f16_f32 v152, v130, v131
v_cvt_pk_f16_f32 v149, v132, v133
v_cvt_pk_f16_f32 v146, v134, v135
v_pk_fma_f16 v154, v155, v155, s48
v_mfma_f32_32x32x16_bf16 v[120:135], v[96:99], v[232:235], 0
ds_read_b128 v[228:231], v249 offset:11264
v_and_b32_e64 v137, s49, v137
v_fma_mix_f32 v163, v178, v178, v163 op_sel:[0,0,0] op_sel_hi:[1,1,0]
v_pk_fma_f16 v151, v152, v152, s48
v_pk_fma_f16 v148, v149, v149, s48
v_pk_fma_f16 v145, v146, v146, s48
v_pk_mul_f16 v154, v155, v154
v_bfe_u32 v136, v137, 2, 14
v_pk_mul_f16 v151, v152, v151
v_fma_mix_f32 v163, v179, v179, v163 op_sel:[1,1,0] op_sel_hi:[1,1,0]
v_pk_mul_f16 v148, v149, v148
v_mfma_f32_32x32x16_bf16 v[120:135], v[100:103], v[236:239], v[120:135]
ds_read_b128 v[232:235], v245
ds_read_b128 v[208:211], v242 offset:64
ds_read_b128 v[212:215], v242
ds_read_u16_d16 v136, v136
v_pk_mul_f16 v145, v146, v145
v_exp_f16 v153, v154
v_lshrrev_b32 v137, 18, v137
v_exp_f16_e64 v150, v151
v_fma_mix_f32 v163, v180, v180, v163 op_sel:[0,0,0] op_sel_hi:[1,1,0]
v_exp_f16_e64 v147, v148
v_and_b32 v139, s49, v139
s_waitcnt lgkmcnt(5)
v_mfma_f32_32x32x16_bf16 v[120:135], v[104:107], v[216:219], v[120:135]
ds_read_b128 v[236:239], v249 offset:12288
ds_read_u16_d16_hi v137, v137
v_exp_f16_e64 v144, v145
v_exp_f16_sdwa v153, v154 dst_sel:WORD_1 dst_unused:UNUSED_PRESERVE src0_sel:WORD_1
v_fma_mix_f32 v163, v181, v181, v163 op_sel:[1,1,0] op_sel_hi:[1,1,0]
v_bfe_u32 v138, v139, 2, 14
v_exp_f16_sdwa v150, v151 dst_sel:WORD_1 dst_unused:UNUSED_PRESERVE src0_sel:WORD_1
v_exp_f16_sdwa v147, v148 dst_sel:WORD_1 dst_unused:UNUSED_PRESERVE src0_sel:WORD_1
v_mfma_f32_32x32x16_bf16 v[120:135], v[108:111], v[220:223], v[120:135]
ds_read_b128 v[216:219], v249 offset:15360
ds_read_u16_d16 v138, v138
v_exp_f16_sdwa v144, v145 dst_sel:WORD_1 dst_unused:UNUSED_PRESERVE src0_sel:WORD_1
v_lshrrev_b32_e64 v139, 18, v139
v_fma_mix_f32 v163, v182, v182, v163 op_sel:[0,0,0] op_sel_hi:[1,1,0]
v_pk_add_f16 v153, v153, 1.0 op_sel_hi:[1,0]
v_pk_add_f16 v150, v150, 1.0 op_sel_hi:[1,0]
v_pk_add_f16 v147, v147, 1.0 op_sel_hi:[1,0]
v_and_b32_e64 v141, s49, v141
v_pk_add_f16 v144, v144, 1.0 op_sel_hi:[1,0]
v_mfma_f32_32x32x16_bf16 v[120:135], v[112:115], v[224:227], v[120:135]
ds_read_b128 v[220:223], v249 offset:13312
ds_read_u16_d16_hi v139, v139
v_rcp_f16_e64 v154, v153
v_fma_mix_f32 v163, v183, v183, v163 op_sel:[1,1,0] op_sel_hi:[1,1,0]
v_rcp_f16_e64 v151, v150
v_bfe_u32 v140, v141, 2, 14
v_rcp_f16 v148, v147
v_fma_mix_f32 v163, v184, v184, v163 op_sel:[0,0,0] op_sel_hi:[1,1,0]
s_waitcnt lgkmcnt(4)
v_mfma_f32_32x32x16_bf16 v[120:135], v[116:119], v[228:231], v[120:135]
ds_read_b128 v[224:227], v249 offset:16384
ds_read_u16_d16 v140, v140
v_rcp_f16_e64 v145, v144
v_lshrrev_b32 v141, 18, v141
v_rcp_f16_sdwa v154, v153 dst_sel:WORD_1 dst_unused:UNUSED_PRESERVE src0_sel:WORD_1
s_setprio 0
v_rcp_f16_sdwa v151, v150 dst_sel:WORD_1 dst_unused:UNUSED_PRESERVE src0_sel:WORD_1
v_fma_mix_f32 v163, v185, v185, v163 op_sel:[1,1,0] op_sel_hi:[1,1,0]
v_and_b32_e64 v143, s49, v143
v_rcp_f16_sdwa v148, v147 dst_sel:WORD_1 dst_unused:UNUSED_PRESERVE src0_sel:WORD_1
v_smfmac_f32_16x16x32_bf16 v[16:19], v[234:235], v[208:211], v246
ds_read_b128 v[228:231], v249 offset:14336
ds_read_u16_d16_hi v141, v141
v_rcp_f16_sdwa v145, v144 dst_sel:WORD_1 dst_unused:UNUSED_PRESERVE src0_sel:WORD_1
v_pk_mul_f16 v155, v155, v154
v_bfe_u32 v142, v143, 2, 14
v_fma_mix_f32 v163, v186, v186, v163 op_sel:[0,0,0] op_sel_hi:[1,1,0]
v_smfmac_f32_16x16x32_bf16 v[0:3], v[232:233], v[212:215], v246
s_mov_b64 exec, 1
ds_add_u32 v253, v254 offset:16
s_mov_b64 exec, -1
v_pk_mul_f16 v152, v152, v151
v_pk_mul_f16 v149, v149, v148
v_pk_mul_f16 v146, v146, v145
v_fma_mix_f32 v164, v155, v155, v164 op_sel:[0,0,0] op_sel_hi:[1,1,0]
v_lshrrev_b32 v143, 18, v143
v_fma_mix_f32 v164, v155, v155, v164 op_sel:[1,1,0] op_sel_hi:[1,1,0]
v_fma_mix_f32 v164, v152, v152, v164 op_sel:[0,0,0] op_sel_hi:[1,1,0]
v_fma_mix_f32 v163, v187, v187, v163 op_sel:[1,1,0] op_sel_hi:[1,1,0]
v_fma_mix_f32 v164, v152, v152, v164 op_sel:[1,1,0] op_sel_hi:[1,1,0]
v_fma_mix_f32 v164, v149, v149, v164 op_sel:[0,0,0] op_sel_hi:[1,1,0]
v_fma_mix_f32 v164, v149, v149, v164 op_sel:[1,1,0] op_sel_hi:[1,1,0]
v_fma_mix_f32 v164, v146, v146, v164 op_sel:[0,0,0] op_sel_hi:[1,1,0]
v_fma_mix_f32 v164, v146, v146, v164 op_sel:[1,1,0] op_sel_hi:[1,1,0]
s_setprio 3
v_pk_add_f32 v[168:169], v[0:1], v[2:3]
v_pk_mul_f32 v[170:171], v[0:1], v[0:1]
v_pk_fma_f32 v[170:171], v[2:3], v[2:3], v[170:171]
v_pk_add_f32 v[168:169], v[168:169], v[4:5]
v_pk_fma_f32 v[170:171], v[4:5], v[4:5], v[170:171]
v_pk_add_f32 v[168:169], v[168:169], v[6:7]
v_pk_fma_f32 v[170:171], v[6:7], v[6:7], v[170:171]
v_pk_add_f32 v[168:169], v[168:169], v[8:9]
v_pk_fma_f32 v[170:171], v[8:9], v[8:9], v[170:171]
v_pk_add_f32 v[168:169], v[168:169], v[10:11]
v_pk_fma_f32 v[170:171], v[10:11], v[10:11], v[170:171]
v_pk_add_f32 v[168:169], v[168:169], v[12:13]
v_pk_fma_f32 v[170:171], v[12:13], v[12:13], v[170:171]
v_pk_add_f32 v[168:169], v[168:169], v[14:15]
v_pk_fma_f32 v[170:171], v[14:15], v[14:15], v[170:171]
v_pk_add_f32 v[168:169], v[168:169], v[16:17]
v_pk_fma_f32 v[170:171], v[16:17], v[16:17], v[170:171]
v_pk_add_f32 v[168:169], v[168:169], v[18:19]
v_pk_fma_f32 v[170:171], v[18:19], v[18:19], v[170:171]
v_pk_add_f32 v[168:169], v[168:169], v[20:21]
v_pk_fma_f32 v[170:171], v[20:21], v[20:21], v[170:171]
v_pk_add_f32 v[168:169], v[168:169], v[22:23]
v_pk_fma_f32 v[170:171], v[22:23], v[22:23], v[170:171]
v_pk_add_f32 v[168:169], v[168:169], v[24:25]
v_pk_fma_f32 v[170:171], v[24:25], v[24:25], v[170:171]
v_pk_add_f32 v[168:169], v[168:169], v[26:27]
v_pk_fma_f32 v[170:171], v[26:27], v[26:27], v[170:171]
v_pk_add_f32 v[168:169], v[168:169], v[28:29]
v_pk_fma_f32 v[170:171], v[28:29], v[28:29], v[170:171]
v_pk_add_f32 v[168:169], v[168:169], v[30:31]
v_pk_fma_f32 v[170:171], v[30:31], v[30:31], v[170:171]
v_pk_add_f32 v[168:169], v[168:169], v[32:33]
v_pk_fma_f32 v[170:171], v[32:33], v[32:33], v[170:171]
v_pk_add_f32 v[168:169], v[168:169], v[34:35]
v_pk_fma_f32 v[170:171], v[34:35], v[34:35], v[170:171]
v_pk_add_f32 v[168:169], v[168:169], v[36:37]
v_pk_fma_f32 v[170:171], v[36:37], v[36:37], v[170:171]
v_pk_add_f32 v[168:169], v[168:169], v[38:39]
v_pk_fma_f32 v[170:171], v[38:39], v[38:39], v[170:171]
v_pk_add_f32 v[168:169], v[168:169], v[40:41]
v_pk_fma_f32 v[170:171], v[40:41], v[40:41], v[170:171]
v_pk_add_f32 v[168:169], v[168:169], v[42:43]
v_pk_fma_f32 v[170:171], v[42:43], v[42:43], v[170:171]
v_pk_add_f32 v[168:169], v[168:169], v[44:45]
v_pk_fma_f32 v[170:171], v[44:45], v[44:45], v[170:171]
v_pk_add_f32 v[168:169], v[168:169], v[46:47]
v_pk_fma_f32 v[170:171], v[46:47], v[46:47], v[170:171]
s_setprio 0
v_lshrrev_b32 v252, 2, v251
v_mul_u32_u24 v252, 192, v252
v_and_b32 v240, 3, v251
v_lshl_add_u32 v252, v240, 4, v252
s_setprio 2
v_cvt_pkrtz_f16_f32 v179, v120, v121
v_cvt_pkrtz_f16_f32 v181, v122, v123
v_cvt_pkrtz_f16_f32 v183, v124, v125
v_cvt_pkrtz_f16_f32 v185, v126, v127
v_cvt_pkrtz_f16_f32 v187, v128, v129
v_cvt_pkrtz_f16_f32 v189, v130, v131
v_cvt_pk_f16_f32 v155, v132, v133
v_cvt_pk_f16_f32 v152, v134, v135
ds_read_b128 v[232:235], v249 offset:17408
ds_read_u16_d16 v142, v142
ds_read_u16_d16_hi v143, v143
v_mfma_f32_32x32x16_bf16 v[120:135], v[96:99], v[236:239], 0
v_pk_fma_f16 v154, v155, v155, s48
v_add_f32 v168, v168, v169
v_and_b32 v179, s49, v179
v_fma_mix_f32 v164, v136, v136, v164 op_sel:[0,0,0] op_sel_hi:[1,1,0]
v_bfe_u32 v178, v179, 2, 14
v_pk_fma_f16 v151, v152, v152, s48
v_add_f32_e64 v170, v170, v171
v_pk_mul_f16 v154, v155, v154
v_lshrrev_b32_e64 v179, 18, v179
v_pk_mul_f16 v151, v152, v151
v_fma_mix_f32 v164, v137, v137, v164 op_sel:[1,1,0] op_sel_hi:[1,1,0]
v_and_b32 v181, s49, v181
s_waitcnt lgkmcnt(4)
ds_read_u16_d16 v178, v178
ds_read_u16_d16_hi v179, v179
v_mfma_f32_32x32x16_bf16 v[120:135], v[100:103], v[216:219], v[120:135]
v_permlane32_swap_b32 v168, v170
v_exp_f16 v153, v154
v_bfe_u32 v180, v181, 2, 14
v_exp_f16 v150, v151
v_add_f32 v168, v168, v170
v_lshrrev_b32_e64 v181, 18, v181
v_fma_mix_f32 v164, v138, v138, v164 op_sel:[0,0,0] op_sel_hi:[1,1,0]
v_and_b32_e64 v183, s49, v183
v_exp_f16_sdwa v153, v154 dst_sel:WORD_1 dst_unused:UNUSED_PRESERVE src0_sel:WORD_1
ds_read_u16_d16 v180, v180
ds_read_u16_d16_hi v181, v181
v_mfma_f32_32x32x16_bf16 v[120:135], v[104:107], v[220:223], v[120:135]
v_mul_f32 v168, 1009429163, v168
v_bfe_u32 v182, v183, 2, 14
v_fma_mix_f32 v164, v139, v139, v164 op_sel:[1,1,0] op_sel_hi:[1,1,0]
v_exp_f16_sdwa v150, v151 dst_sel:WORD_1 dst_unused:UNUSED_PRESERVE src0_sel:WORD_1
v_mov_b32 v170, v168
v_lshrrev_b32 v183, 18, v183
v_pk_add_f16 v153, v153, 1.0 op_sel_hi:[1,0]
v_and_b32 v185, s49, v185
v_fma_mix_f32 v164, v140, v140, v164 op_sel:[0,0,0] op_sel_hi:[1,1,0]
v_bfe_u32 v184, v185, 2, 14
v_permlane32_swap_b32 v168, v170
v_pk_add_f16 v150, v150, 1.0 op_sel_hi:[1,0]
ds_read_u16_d16 v182, v182
ds_read_u16_d16_hi v183, v183
ds_read_u16_d16 v184, v184
v_mfma_f32_32x32x16_bf16 v[120:135], v[108:111], v[224:227], v[120:135]
v_rcp_f16 v154, v153
v_lshrrev_b32 v185, 18, v185
v_fma_mix_f32 v164, v141, v141, v164 op_sel:[1,1,0] op_sel_hi:[1,1,0]
v_fma_f32 v170, -v168, v168, v170
v_and_b32 v187, s49, v187
v_rcp_f16 v151, v150
v_bfe_u32 v186, v187, 2, 14
v_max_f32_e64 v170, 0, v170
v_rcp_f16_sdwa v154, v153 dst_sel:WORD_1 dst_unused:UNUSED_PRESERVE src0_sel:WORD_1
ds_read_b128 v[224:227], v249 offset:18432
ds_read_u16_d16_hi v185, v185
ds_read_u16_d16 v186, v186
v_mfma_f32_32x32x16_bf16 v[120:135], v[112:115], v[228:231], v[120:135]
v_lshrrev_b32 v187, 18, v187
s_waitcnt lgkmcnt(6)
v_fma_mix_f32 v164, v142, v142, v164 op_sel:[0,0,0] op_sel_hi:[1,1,0]
v_and_b32_e64 v189, s49, v189
v_add_f32 v170, 925353388, v170
v_rcp_f16_sdwa v151, v150 dst_sel:WORD_1 dst_unused:UNUSED_PRESERVE src0_sel:WORD_1
v_bfe_u32 v188, v189, 2, 14
v_fma_mix_f32 v164, v143, v143, v164 op_sel:[1,1,0] op_sel_hi:[1,1,0]
v_pk_mul_f16 v155, v155, v154
v_rsq_f32 v170, v170
v_lshrrev_b32 v189, 18, v189
ds_read_b128 v[228:231], v249 offset:21504
ds_read_u16_d16_hi v187, v187
ds_read_b32 v247, v253 offset:16
ds_read_u16_d16 v188, v188
ds_read_u16_d16_hi v189, v189
v_mfma_f32_32x32x16_bf16 v[120:135], v[116:119], v[232:235], v[120:135]
v_pk_mul_f16 v152, v152, v151
v_fma_mix_f32 v165, v155, v155, v165 op_sel:[0,0,0] op_sel_hi:[1,1,0]
v_fma_mix_f32 v165, v178, v178, v165 op_sel:[0,0,0] op_sel_hi:[1,1,0]
v_fma_mix_f32 v165, v179, v179, v165 op_sel:[1,1,0] op_sel_hi:[1,1,0]
v_fma_mix_f32 v165, v180, v180, v165 op_sel:[0,0,0] op_sel_hi:[1,1,0]
v_fma_mix_f32 v165, v155, v155, v165 op_sel:[1,1,0] op_sel_hi:[1,1,0]
v_fma_mix_f32 v165, v181, v181, v165 op_sel:[1,1,0] op_sel_hi:[1,1,0]
s_waitcnt lgkmcnt(5)
v_fma_mix_f32 v165, v182, v182, v165 op_sel:[0,0,0] op_sel_hi:[1,1,0]
v_mul_f32 v172, 3203391086, v170
v_fma_mix_f32 v165, v183, v183, v165 op_sel:[1,1,0] op_sel_hi:[1,1,0]
v_fma_mix_f32 v165, v152, v152, v165 op_sel:[0,0,0] op_sel_hi:[1,1,0]
v_fma_mix_f32 v165, v184, v184, v165 op_sel:[0,0,0] op_sel_hi:[1,1,0]
v_fma_mix_f32 v165, v185, v185, v165 op_sel:[1,1,0] op_sel_hi:[1,1,0]
v_fma_mix_f32 v165, v186, v186, v165 op_sel:[0,0,0] op_sel_hi:[1,1,0]
v_mul_f32 v173, v168, v172
v_fma_mix_f32 v165, v152, v152, v165 op_sel:[1,1,0] op_sel_hi:[1,1,0]
s_waitcnt lgkmcnt(3)
v_fma_mix_f32 v165, v187, v187, v165 op_sel:[1,1,0] op_sel_hi:[1,1,0]
s_waitcnt lgkmcnt(1)
v_fma_mix_f32 v165, v188, v188, v165 op_sel:[0,0,0] op_sel_hi:[1,1,0]
s_waitcnt lgkmcnt(0)
v_fma_mix_f32 v165, v189, v189, v165 op_sel:[1,1,0] op_sel_hi:[1,1,0]
s_setprio 3
v_pk_fma_f32 v[0:1], v[0:1], v[172:173], v[172:173] op_sel:[0,0,1] op_sel_hi:[1,0,1] neg_lo:[0,0,1] neg_hi:[0,0,1]
v_pk_fma_f32 v[2:3], v[2:3], v[172:173], v[172:173] op_sel:[0,0,1] op_sel_hi:[1,0,1] neg_lo:[0,0,1] neg_hi:[0,0,1]
v_pk_fma_f32 v[4:5], v[4:5], v[172:173], v[172:173] op_sel:[0,0,1] op_sel_hi:[1,0,1] neg_lo:[0,0,1] neg_hi:[0,0,1]
v_pk_fma_f32 v[6:7], v[6:7], v[172:173], v[172:173] op_sel:[0,0,1] op_sel_hi:[1,0,1] neg_lo:[0,0,1] neg_hi:[0,0,1]
v_pk_fma_f32 v[8:9], v[8:9], v[172:173], v[172:173] op_sel:[0,0,1] op_sel_hi:[1,0,1] neg_lo:[0,0,1] neg_hi:[0,0,1]
v_pk_fma_f32 v[10:11], v[10:11], v[172:173], v[172:173] op_sel:[0,0,1] op_sel_hi:[1,0,1] neg_lo:[0,0,1] neg_hi:[0,0,1]
v_pk_fma_f32 v[12:13], v[12:13], v[172:173], v[172:173] op_sel:[0,0,1] op_sel_hi:[1,0,1] neg_lo:[0,0,1] neg_hi:[0,0,1]
v_pk_fma_f32 v[14:15], v[14:15], v[172:173], v[172:173] op_sel:[0,0,1] op_sel_hi:[1,0,1] neg_lo:[0,0,1] neg_hi:[0,0,1]
v_pk_fma_f32 v[16:17], v[16:17], v[172:173], v[172:173] op_sel:[0,0,1] op_sel_hi:[1,0,1] neg_lo:[0,0,1] neg_hi:[0,0,1]
v_pk_fma_f32 v[18:19], v[18:19], v[172:173], v[172:173] op_sel:[0,0,1] op_sel_hi:[1,0,1] neg_lo:[0,0,1] neg_hi:[0,0,1]
v_pk_fma_f32 v[20:21], v[20:21], v[172:173], v[172:173] op_sel:[0,0,1] op_sel_hi:[1,0,1] neg_lo:[0,0,1] neg_hi:[0,0,1]
v_pk_fma_f32 v[22:23], v[22:23], v[172:173], v[172:173] op_sel:[0,0,1] op_sel_hi:[1,0,1] neg_lo:[0,0,1] neg_hi:[0,0,1]
v_pk_fma_f32 v[24:25], v[24:25], v[172:173], v[172:173] op_sel:[0,0,1] op_sel_hi:[1,0,1] neg_lo:[0,0,1] neg_hi:[0,0,1]
v_pk_fma_f32 v[26:27], v[26:27], v[172:173], v[172:173] op_sel:[0,0,1] op_sel_hi:[1,0,1] neg_lo:[0,0,1] neg_hi:[0,0,1]
v_pk_fma_f32 v[28:29], v[28:29], v[172:173], v[172:173] op_sel:[0,0,1] op_sel_hi:[1,0,1] neg_lo:[0,0,1] neg_hi:[0,0,1]
v_pk_fma_f32 v[30:31], v[30:31], v[172:173], v[172:173] op_sel:[0,0,1] op_sel_hi:[1,0,1] neg_lo:[0,0,1] neg_hi:[0,0,1]
v_pk_fma_f32 v[32:33], v[32:33], v[172:173], v[172:173] op_sel:[0,0,1] op_sel_hi:[1,0,1] neg_lo:[0,0,1] neg_hi:[0,0,1]
v_pk_fma_f32 v[34:35], v[34:35], v[172:173], v[172:173] op_sel:[0,0,1] op_sel_hi:[1,0,1] neg_lo:[0,0,1] neg_hi:[0,0,1]
v_pk_fma_f32 v[36:37], v[36:37], v[172:173], v[172:173] op_sel:[0,0,1] op_sel_hi:[1,0,1] neg_lo:[0,0,1] neg_hi:[0,0,1]
v_pk_fma_f32 v[38:39], v[38:39], v[172:173], v[172:173] op_sel:[0,0,1] op_sel_hi:[1,0,1] neg_lo:[0,0,1] neg_hi:[0,0,1]
v_pk_fma_f32 v[40:41], v[40:41], v[172:173], v[172:173] op_sel:[0,0,1] op_sel_hi:[1,0,1] neg_lo:[0,0,1] neg_hi:[0,0,1]
v_pk_fma_f32 v[42:43], v[42:43], v[172:173], v[172:173] op_sel:[0,0,1] op_sel_hi:[1,0,1] neg_lo:[0,0,1] neg_hi:[0,0,1]
v_pk_fma_f32 v[44:45], v[44:45], v[172:173], v[172:173] op_sel:[0,0,1] op_sel_hi:[1,0,1] neg_lo:[0,0,1] neg_hi:[0,0,1]
v_pk_fma_f32 v[46:47], v[46:47], v[172:173], v[172:173] op_sel:[0,0,1] op_sel_hi:[1,0,1] neg_lo:[0,0,1] neg_hi:[0,0,1]
s_setprio 2
v_readfirstlane_b32 s43, v247
s_nop 1
s_cmp_ge_u32 s43, 32
s_cbranch_scc1 Lev9
Lev9w:
s_sleep 1
ds_read_b32 v247, v253 offset:16
s_waitcnt lgkmcnt(0)
v_readfirstlane_b32 s43, v247
s_cmp_eq_u32 s76, 0
s_cbranch_scc1 Lev9
s_sub_u32 s76, s76, 1
s_cmp_lt_u32 s43, 32
s_cbranch_scc1 Lev9w
Lev9:
s_setprio 1
v_cvt_pkrtz_f16_f32 v137, v120, v121
v_cvt_pkrtz_f16_f32 v139, v122, v123
v_cvt_pkrtz_f16_f32 v141, v124, v125
v_cvt_pkrtz_f16_f32 v143, v126, v127
v_cvt_pkrtz_f16_f32 v145, v128, v129
v_cvt_pkrtz_f16_f32 v147, v130, v131
v_cvt_pk_f16_f32 v155, v132, v133
v_cvt_pk_f16_f32 v152, v134, v135
s_add_u32 m0, s72, 0
s_add_u32 s43, s82, 0
buffer_load_dwordx4 v252, s[16:19], s43 offen lds
ds_read_b128 v[232:235], v249 offset:19456
ds_read_b128 v[236:239], v249 offset:22528
v_mfma_f32_32x32x16_bf16 v[120:135], v[224:227], v[96:99], 0
v_pk_fma_f16 v154, v155, v155, s48
v_and_b32_e64 v192, 1, v251
v_cvt_pk_bf16_f32 v168, v0, v1
v_and_b32_e64 v137, s49, v137
v_pk_fma_f16 v151, v152, v152, s48
v_cvt_pk_bf16_f32 v169, v2, v3
v_lshlrev_b32 v192, 4, v192
v_and_b32 v139, s49, v139
v_pk_mul_f16 v154, v155, v154
v_cvt_pk_bf16_f32 v170, v4, v5
v_bfe_u32 v136, v137, 2, 14
v_mov_b32 v193, 15360
v_pk_mul_f16 v151, v152, v151
v_bfe_u32 v138, v139, 2, 14
v_cvt_pk_bf16_f32 v171, v6, v7
ds_read_b128 v[224:227], v249 offset:20480
ds_read_u16_d16 v136, v136
ds_read_u16_d16 v138, v138
v_mfma_f32_32x32x16_bf16 v[120:135], v[228:231], v[100:103], v[120:135]
v_exp_f16 v153, v154
v_lshlrev_b32 v192, v192, v193
v_cvt_pk_bf16_f32 v172, v8, v9
v_lshrrev_b32 v137, 18, v137
v_exp_f16 v150, v151
v_lshrrev_b32_e64 v193, 3, v251
v_cvt_pk_bf16_f32 v173, v10, v11
v_lshrrev_b32_e64 v139, 18, v139
v_and_b32 v141, s49, v141
v_xor_b32 v193, v193, v251
v_cvt_pk_bf16_f32 v174, v12, v13
v_exp_f16_sdwa v153, v154 dst_sel:WORD_1 dst_unused:UNUSED_PRESERVE src0_sel:WORD_1
v_cvt_pk_bf16_f32 v175, v14, v15
v_and_b32_e64 v193, 4, v193
s_waitcnt lgkmcnt(3)
s_add_u32 m0, s72, 1024
s_add_u32 s43, s82, 64
buffer_load_dwordx4 v252, s[16:19], s43 offen lds
ds_read_b128 v[228:231], v249 offset:23552
ds_read_u16_d16_hi v137, v137
ds_read_u16_d16_hi v139, v139
v_mfma_f32_32x32x16_bf16 v[120:135], v[232:235], v[104:107], v[120:135]
v_and_b32_e64 v143, s49, v143
v_bfe_u32 v140, v141, 2, 14
v_exp_f16_sdwa v150, v151 dst_sel:WORD_1 dst_unused:UNUSED_PRESERVE src0_sel:WORD_1
v_bfe_u32 v194, v251, 3, 2
v_cvt_pk_bf16_f32 v176, v16, v17
v_bfe_u32 v142, v143, 2, 14
v_cvt_pk_bf16_f32 v177, v18, v19
v_pk_add_f16 v153, v153, 1.0 op_sel_hi:[1,0]
v_lshl_add_u32 v193, v193, 1, 0
v_lshrrev_b32_e64 v141, 18, v141
v_pk_add_f16 v150, v150, 1.0 op_sel_hi:[1,0]
v_cvt_pk_bf16_f32 v178, v20, v21
v_lshrrev_b32_e64 v143, 18, v143
v_lshl_add_u32 v193, v194, 1, v193
ds_read_b128 v[232:235], v248 offset:16384
ds_read_u16_d16 v140, v140
ds_read_u16_d16 v142, v142
ds_read_u16_d16_hi v141, v141
ds_read_u16_d16_hi v143, v143
v_mfma_f32_32x32x16_bf16 v[120:135], v[236:239], v[108:111], v[120:135]
v_rcp_f16_e64 v154, v153
v_cvt_pk_bf16_f32 v179, v22, v23
v_and_b32 v145, s49, v145
v_and_b32 v147, s49, v147
v_bfe_u32 v194, v251, 1, 1
v_cvt_pk_bf16_f32 v180, v24, v25
v_rcp_f16_e64 v151, v150
v_cvt_pk_bf16_f32 v181, v26, v27
v_add_u32_e64 v193, v193, v194
v_bfe_u32 v144, v145, 2, 14
v_rcp_f16_sdwa v154, v153 dst_sel:WORD_1 dst_unused:UNUSED_PRESERVE src0_sel:WORD_1
v_cvt_pk_bf16_f32 v182, v28, v29
v_cmp_eq_u32 vcc, 0, v193
s_nop 1
v_cndmask_b32 v240, 0, v192, vcc
v_bfe_u32 v146, v147, 2, 14
s_waitcnt lgkmcnt(5)
s_add_u32 m0, s72, 2048
s_add_u32 s43, s82, 128
buffer_load_dwordx4 v252, s[16:19], s43 offen lds
ds_read_b128 v[236:239], v248 offset:19456
ds_read_u16_d16 v144, v144
ds_read_u16_d16 v146, v146
v_mfma_f32_32x32x16_bf16 v[120:135], v[224:227], v[112:115], v[120:135]
v_lshrrev_b32_e64 v145, 18, v145
v_cvt_pk_bf16_f32 v183, v30, v31
v_rcp_f16_sdwa v151, v150 dst_sel:WORD_1 dst_unused:UNUSED_PRESERVE src0_sel:WORD_1
v_cmp_eq_u32 vcc, 1, v193
s_nop 1
v_cndmask_b32 v241, 0, v192, vcc
v_cvt_pk_bf16_f32 v184, v32, v33
s_setprio 0
v_lshrrev_b32 v147, 18, v147
v_pk_mul_f16 v155, v155, v154
v_cmp_eq_u32 vcc, 2, v193
s_nop 1
v_cndmask_b32 v242, 0, v192, vcc
v_fma_mix_f32 v166, v136, v136, v166 op_sel:[0,0,0] op_sel_hi:[1,1,0]
v_cvt_pk_bf16_f32 v185, v34, v35
v_fma_mix_f32 v166, v137, v137, v166 op_sel:[1,1,0] op_sel_hi:[1,1,0]
v_pk_mul_f16 v152, v152, v151
v_cmp_eq_u32 vcc, 3, v193
s_nop 1
v_cndmask_b32 v243, 0, v192, vcc
v_cvt_pk_bf16_f32 v186, v36, v37
v_fma_mix_f32 v166, v138, v138, v166 op_sel:[0,0,0] op_sel_hi:[1,1,0]
ds_read_b128 v[224:227], v248 offset:17408
ds_read_u16_d16_hi v145, v145
ds_read_u16_d16_hi v147, v147
v_mfma_f32_32x32x16_bf16 v[120:135], v[228:231], v[116:119], v[120:135]
v_fma_mix_f32 v166, v139, v139, v166 op_sel:[1,1,0] op_sel_hi:[1,1,0]
v_cvt_pk_bf16_f32 v187, v38, v39
v_cmp_eq_u32 vcc, 4, v193
s_nop 1
v_cndmask_b32 v244, 0, v192, vcc
v_fma_mix_f32 v166, v155, v155, v166 op_sel:[0,0,0] op_sel_hi:[1,1,0]
s_waitcnt lgkmcnt(3)
v_fma_mix_f32 v166, v140, v140, v166 op_sel:[0,0,0] op_sel_hi:[1,1,0]
v_fma_mix_f32 v166, v141, v141, v166 op_sel:[1,1,0] op_sel_hi:[1,1,0]
v_cvt_pk_bf16_f32 v188, v40, v41
v_cmp_eq_u32 vcc, 5, v193
s_nop 1
v_cndmask_b32 v245, 0, v192, vcc
v_fma_mix_f32 v166, v155, v155, v166 op_sel:[1,1,0] op_sel_hi:[1,1,0]
v_fma_mix_f32 v166, v142, v142, v166 op_sel:[0,0,0] op_sel_hi:[1,1,0]
v_cvt_pk_bf16_f32 v189, v42, v43
v_fma_mix_f32 v166, v143, v143, v166 op_sel:[1,1,0] op_sel_hi:[1,1,0]
v_cmp_eq_u32 vcc, 6, v193
s_nop 1
v_cndmask_b32 v246, 0, v192, vcc
v_fma_mix_f32 v166, v152, v152, v166 op_sel:[0,0,0] op_sel_hi:[1,1,0]
v_fma_mix_f32 v166, v144, v144, v166 op_sel:[0,0,0] op_sel_hi:[1,1,0]
v_cvt_pk_bf16_f32 v190, v44, v45
s_waitcnt lgkmcnt(0)
v_fma_mix_f32 v166, v145, v145, v166 op_sel:[1,1,0] op_sel_hi:[1,1,0]
v_cmp_eq_u32 vcc, 7, v193
s_nop 1
v_cndmask_b32 v247, 0, v192, vcc
v_fma_mix_f32 v166, v152, v152, v166 op_sel:[1,1,0] op_sel_hi:[1,1,0]
v_cvt_pk_bf16_f32 v191, v46, v47
v_fma_mix_f32 v166, v146, v146, v166 op_sel:[0,0,0] op_sel_hi:[1,1,0]
v_fma_mix_f32 v166, v147, v147, v166 op_sel:[1,1,0] op_sel_hi:[1,1,0]
s_setprio 2
v_cvt_pkrtz_f16_f32 v137, v120, v121
v_cvt_pkrtz_f16_f32 v139, v122, v123
v_cvt_pkrtz_f16_f32 v141, v124, v125
v_cvt_pkrtz_f16_f32 v143, v126, v127
v_cvt_pkrtz_f16_f32 v145, v128, v129
v_cvt_pk_f16_f32 v155, v130, v131
v_cvt_pk_f16_f32 v152, v132, v133
v_cvt_pk_f16_f32 v149, v134, v135
s_add_u32 m0, s72, 3072
s_add_u32 s43, s82, 3072
buffer_load_dwordx4 v252, s[16:19], s43 offen lds
ds_read_b128 v[228:231], v248 offset:20480
v_mfma_f32_32x32x16_bf16 v[120:135], v[232:235], v[168:171], 0
v_pk_fma_f16 v154, v155, v155, s48
v_mov_b32 v88, v48
v_and_b32 v137, s49, v137
v_pk_fma_f16 v151, v152, v152, s48
v_and_b32_e64 v139, s49, v139
v_pk_fma_f16 v148, v149, v149, s48
v_pk_mul_f16 v154, v155, v154
v_bfe_u32 v136, v137, 2, 14
v_pk_mul_f16 v151, v152, v151
ds_read_b128 v[232:235], v248 offset:18432
ds_read_u16_d16 v136, v136
v_mfma_f32_32x32x16_bf16 v[120:135], v[236:239], v[172:175], v[120:135]
v_mov_b32_e64 v89, v49
v_pk_mul_f16 v148, v149, v148
v_bfe_u32 v138, v139, 2, 14
v_exp_f16 v153, v154
v_lshrrev_b32 v137, 18, v137
v_exp_f16 v150, v151
v_mov_b32 v90, v50
v_lshrrev_b32_e64 v139, 18, v139
s_add_u32 m0, s72, 4096
s_add_u32 s43, s82, 3136
buffer_load_dwordx4 v252, s[16:19], s43 offen lds
ds_read_b128 v[236:239], v248 offset:21504
ds_read_u16_d16 v138, v138
ds_read_u16_d16_hi v137, v137
ds_read_u16_d16_hi v139, v139
v_mfma_f32_32x32x16_bf16 v[120:135], v[224:227], v[176:179], v[120:135]
v_exp_f16 v147, v148
v_and_b32 v141, s49, v141
v_and_b32_e64 v143, s49, v143
v_exp_f16_sdwa v153, v154 dst_sel:WORD_1 dst_unused:UNUSED_PRESERVE src0_sel:WORD_1
v_mov_b32 v91, v51
v_bfe_u32 v140, v141, 2, 14
s_waitcnt lgkmcnt(5)
ds_read_b128 v[224:227], v248 offset:22528
ds_read_u16_d16 v140, v140
v_mfma_f32_32x32x16_bf16 v[120:135], v[228:231], v[180:183], v[120:135]
v_exp_f16_sdwa v150, v151 dst_sel:WORD_1 dst_unused:UNUSED_PRESERVE src0_sel:WORD_1
v_bfe_u32 v142, v143, 2, 14
v_exp_f16_sdwa v147, v148 dst_sel:WORD_1 dst_unused:UNUSED_PRESERVE src0_sel:WORD_1
v_lshrrev_b32 v141, 18, v141
v_mov_b32 v92, v52
v_pk_add_f16 v153, v153, 1.0 op_sel_hi:[1,0]
v_lshrrev_b32_e64 v143, 18, v143
v_pk_add_f16 v150, v150, 1.0 op_sel_hi:[1,0]
v_pk_add_f16 v147, v147, 1.0 op_sel_hi:[1,0]
s_add_u32 m0, s72, 5120
s_add_u32 s43, s82, 3200
buffer_load_dwordx4 v252, s[16:19], s43 offen lds
ds_read_b128 v[228:231], v248 offset:25600
ds_read_u16_d16 v142, v142
ds_read_u16_d16_hi v141, v141
ds_read_u16_d16_hi v143, v143
v_mfma_f32_32x32x16_bf16 v[120:135], v[232:235], v[184:187], v[120:135]
v_and_b32 v145, s49, v145
v_rcp_f16 v154, v153
v_mov_b32_e64 v93, v53
v_bfe_u32 v144, v145, 2, 14
v_rcp_f16 v151, v150
v_lshrrev_b32 v145, 18, v145
v_rcp_f16 v148, v147
s_waitcnt lgkmcnt(4)
ds_read_b128 v[232:235], v248 offset:23552
ds_read_u16_d16 v144, v144
ds_read_u16_d16_hi v145, v145
v_mfma_f32_32x32x16_bf16 v[120:135], v[236:239], v[188:191], v[120:135]
v_or_b32 v216, v136, v137
v_mov_b32 v94, v54
v_or_b32_e64 v217, v138, v139
v_rcp_f16_sdwa v154, v153 dst_sel:WORD_1 dst_unused:UNUSED_PRESERVE src0_sel:WORD_1
s_waitcnt lgkmcnt(4)
v_or_b32 v218, v140, v141
v_rcp_f16_sdwa v151, v150 dst_sel:WORD_1 dst_unused:UNUSED_PRESERVE src0_sel:WORD_1
s_waitcnt lgkmcnt(3)
v_or_b32 v219, v142, v143
v_mov_b32_e64 v95, v55
v_rcp_f16_sdwa v148, v147 dst_sel:WORD_1 dst_unused:UNUSED_PRESERVE src0_sel:WORD_1
s_waitcnt lgkmcnt(0)
v_or_b32 v220, v144, v145
v_pk_mul_f16 v221, v155, v154
v_pk_mul_f16 v222, v152, v151
v_pk_mul_f16 v223, v149, v148
s_cmp_lg_u32 s40, 0
s_cbranch_scc1 Lrs0
v_mov_b32 v82, 0
buffer_load_dword v83, v82, s[36:39], 0 offen sc1
Lrs0:
s_setprio 1
s_add_u32 m0, s72, 6144
s_add_u32 s43, s82, 6144
buffer_load_dwordx4 v252, s[16:19], s43 offen lds
ds_read_b128 v[236:239], v248 offset:26624
v_mfma_f32_32x32x16_f16 v[192:207], v[216:219], v[240:243], 0
v_cvt_pkrtz_f16_f32 v137, v120, v121
v_cvt_pkrtz_f16_f32 v139, v122, v123
v_cvt_pkrtz_f16_f32 v141, v124, v125
v_cvt_pkrtz_f16_f32 v143, v126, v127
v_cvt_pkrtz_f16_f32 v145, v128, v129
v_mfma_f32_32x32x16_f16 v[192:207], v[220:223], v[244:247], v[192:207]
v_cvt_pkrtz_f16_f32 v147, v130, v131
v_cvt_pk_f16_f32 v155, v132, v133
v_cvt_pk_f16_f32 v152, v134, v135
v_pk_fma_f16 v154, v155, v155, s48
v_mov_b32 v208, v56
v_and_b32 v255, 51, v251
v_mfma_f32_32x32x16_bf16 v[120:135], v[224:227], v[168:171], 0
v_and_b32_e64 v137, s49, v137
v_pk_fma_f16 v151, v152, v152, s48
v_and_b32_e64 v139, s49, v139
v_pk_mul_f16 v154, v155, v154
v_bfe_u32 v136, v137, 2, 14
v_pk_mul_f16 v151, v152, v151
v_bfe_u32 v138, v139, 2, 14
v_mov_b32 v209, v57
v_exp_f16 v153, v154
v_fmac_f32_e64 v167, v192, v192
ds_read_b128 v[224:227], v248 offset:24576
ds_read_u16_d16 v136, v136
ds_read_u16_d16 v138, v138
v_mfma_f32_32x32x16_bf16 v[120:135], v[228:231], v[172:175], v[120:135]
v_bfe_u32 v87, v251, 2, 1
v_lshrrev_b32 v137, 18, v137
v_fmac_f32 v167, v193, v193
v_exp_f16 v150, v151
v_lshrrev_b32 v139, 18, v139
v_mov_b32 v210, v58
v_fmac_f32 v167, v194, v194
v_and_b32_e64 v141, s49, v141
v_exp_f16_sdwa v153, v154 dst_sel:WORD_1 dst_unused:UNUSED_PRESERVE src0_sel:WORD_1
v_fmac_f32_e64 v167, v195, v195
ds_read_b128 v[228:231], v248 offset:27648
ds_read_u16_d16_hi v137, v137
ds_read_u16_d16_hi v139, v139
v_mfma_f32_32x32x16_bf16 v[120:135], v[232:235], v[176:179], v[120:135]
v_and_b32_e64 v143, s49, v143
v_lshl_add_u32 v255, v87, 3, v255
v_bfe_u32 v140, v141, 2, 14
v_fmac_f32 v167, v196, v196
v_mov_b32 v211, v59
v_exp_f16_sdwa v150, v151 dst_sel:WORD_1 dst_unused:UNUSED_PRESERVE src0_sel:WORD_1
v_fmac_f32_e64 v167, v197, v197
v_bfe_u32 v142, v143, 2, 14
v_pk_add_f16 v153, v153, 1.0 op_sel_hi:[1,0]
v_lshrrev_b32 v141, 18, v141
s_waitcnt lgkmcnt(3)
ds_read_b128 v[232:235], v248 offset:28672
ds_read_u16_d16 v140, v140
ds_read_u16_d16 v142, v142
ds_read_u16_d16_hi v141, v141
v_mfma_f32_32x32x16_bf16 v[120:135], v[236:239], v[180:183], v[120:135]
v_fmac_f32_e64 v167, v198, v198
v_pk_add_f16 v150, v150, 1.0 op_sel_hi:[1,0]
v_lshrrev_b32 v143, 18, v143
v_mov_b32 v212, v60
v_bfe_u32 v87, v251, 3, 1
v_fmac_f32 v167, v199, v199
v_rcp_f16 v154, v153
v_and_b32 v145, s49, v145
v_fmac_f32 v167, v200, v200
v_and_b32_e64 v147, s49, v147
ds_read_b128 v[236:239], v248 offset:31744
ds_read_u16_d16_hi v143, v143
v_mfma_f32_32x32x16_bf16 v[120:135], v[224:227], v[184:187], v[120:135]
v_rcp_f16 v151, v150
v_mov_b32 v213, v61
v_fmac_f32 v167, v201, v201
v_bfe_u32 v144, v145, 2, 14
s_setprio 0
v_lshl_add_u32 v255, v87, 2, v255
v_rcp_f16_sdwa v154, v153 dst_sel:WORD_1 dst_unused:UNUSED_PRESERVE src0_sel:WORD_1
v_fmac_f32_e64 v167, v202, v202
v_bfe_u32 v146, v147, 2, 14
v_fmac_f32_e64 v167, v203, v203
v_mov_b32 v214, v62
s_waitcnt lgkmcnt(2)
ds_read_b128 v[224:227], v248 offset:29696
ds_read_u16_d16 v144, v144
ds_read_u16_d16 v146, v146
v_mfma_f32_32x32x16_bf16 v[120:135], v[228:231], v[188:191], v[120:135]
v_lshrrev_b32_e64 v145, 18, v145
v_rcp_f16_sdwa v151, v150 dst_sel:WORD_1 dst_unused:UNUSED_PRESERVE src0_sel:WORD_1
v_fmac_f32 v167, v204, v204
v_lshrrev_b32 v147, 18, v147
v_or_b32_e64 v0, v136, v137
v_lshl_add_u32 v255, v255, 2, s72
v_fmac_f32 v167, v205, v205
v_or_b32 v1, v138, v139
v_mov_b32 v215, v63
v_or_b32 v2, v140, v141
s_waitcnt lgkmcnt(3)
v_or_b32 v3, v142, v143
v_fmac_f32_e64 v167, v206, v206
ds_read_u16_d16_hi v145, v145
ds_read_u16_d16_hi v147, v147
s_waitcnt lgkmcnt(1)
v_or_b32 v4, v144, v145
s_waitcnt lgkmcnt(0)
v_or_b32 v5, v146, v147
v_fmac_f32 v167, v207, v207
v_pk_mul_f16 v6, v155, v154
v_pk_mul_f16 v7, v152, v151
s_setprio 2
ds_read_b128 v[228:231], v248 offset:32768
v_mfma_f32_32x32x16_f16 v[192:207], v[0:3], v[240:243], 0
v_cvt_pkrtz_f16_f32 v137, v120, v121
v_cvt_pkrtz_f16_f32 v139, v122, v123
v_cvt_pkrtz_f16_f32 v141, v124, v125
v_cvt_pkrtz_f16_f32 v143, v126, v127
v_cvt_pkrtz_f16_f32 v145, v128, v129
v_mfma_f32_32x32x16_f16 v[192:207], v[4:7], v[244:247], v[192:207]
v_cvt_pk_f16_f32 v155, v130, v131
v_cvt_pk_f16_f32 v152, v132, v133
v_cvt_pk_f16_f32 v149, v134, v135
v_pk_fma_f16 v154, v155, v155, s48
v_and_b32_e64 v137, s49, v137
v_mfma_f32_32x32x16_bf16 v[120:135], v[232:235], v[168:171], 0
v_pk_fma_f16 v151, v152, v152, s48
v_and_b32_e64 v139, s49, v139
v_pk_fma_f16 v148, v149, v149, s48
v_pk_mul_f16 v154, v155, v154
v_bfe_u32 v136, v137, 2, 14
v_pk_mul_f16 v151, v152, v151
v_pk_mul_f16 v148, v149, v148
v_bfe_u32 v138, v139, 2, 14
v_fmac_f32 v156, v192, v192
v_exp_f16 v153, v154
ds_read_b128 v[232:235], v248 offset:30720
ds_read_u16_d16 v136, v136
ds_read_u16_d16 v138, v138
v_mfma_f32_32x32x16_bf16 v[120:135], v[236:239], v[172:175], v[120:135]
v_fmac_f32 v156, v193, v193
v_lshrrev_b32 v137, 18, v137
v_exp_f16 v150, v151
v_fmac_f32 v156, v194, v194
v_lshrrev_b32 v139, 18, v139
v_exp_f16 v147, v148
v_fmac_f32 v156, v195, v195
v_and_b32 v141, s49, v141
ds_read_b128 v[236:239], v248 offset:33792
ds_read_u16_d16_hi v137, v137
ds_read_u16_d16_hi v139, v139
v_mfma_f32_32x32x16_bf16 v[120:135], v[224:227], v[176:179], v[120:135]
v_and_b32_e64 v143, s49, v143
v_exp_f16_sdwa v153, v154 dst_sel:WORD_1 dst_unused:UNUSED_PRESERVE src0_sel:WORD_1
v_fmac_f32_e64 v156, v196, v196
v_bfe_u32 v140, v141, 2, 14
v_exp_f16_sdwa v150, v151 dst_sel:WORD_1 dst_unused:UNUSED_PRESERVE src0_sel:WORD_1
v_fmac_f32 v156, v197, v197
v_bfe_u32 v142, v143, 2, 14
v_exp_f16_sdwa v147, v148 dst_sel:WORD_1 dst_unused:UNUSED_PRESERVE src0_sel:WORD_1
s_waitcnt lgkmcnt(6)
ds_read_b128 v[224:227], v248 offset:34816
ds_read_u16_d16 v140, v140
ds_read_u16_d16 v142, v142
v_mfma_f32_32x32x16_bf16 v[120:135], v[228:231], v[180:183], v[120:135]
v_fmac_f32 v156, v198, v198
v_lshrrev_b32 v141, 18, v141
v_pk_add_f16 v153, v153, 1.0 op_sel_hi:[1,0]
v_fmac_f32 v156, v199, v199
v_lshrrev_b32 v143, 18, v143
v_pk_add_f16 v150, v150, 1.0 op_sel_hi:[1,0]
v_pk_add_f16 v147, v147, 1.0 op_sel_hi:[1,0]
v_fmac_f32_e64 v156, v200, v200
v_and_b32 v145, s49, v145
s_waitcnt lgkmcnt(4)
ds_read_b128 v[228:231], v248 offset:37888
ds_read_u16_d16_hi v141, v141
ds_read_u16_d16_hi v143, v143
v_mfma_f32_32x32x16_bf16 v[120:135], v[232:235], v[184:187], v[120:135]
v_rcp_f16 v154, v153
v_fmac_f32 v156, v201, v201
v_bfe_u32 v144, v145, 2, 14
v_rcp_f16 v151, v150
v_fmac_f32 v156, v202, v202
v_lshrrev_b32 v145, 18, v145
v_rcp_f16 v148, v147
v_fmac_f32 v156, v203, v203
v_or_b32 v8, v136, v137
ds_read_b128 v[232:235], v248 offset:35840
ds_read_u16_d16 v144, v144
ds_read_u16_d16_hi v145, v145
v_mfma_f32_32x32x16_bf16 v[120:135], v[236:239], v[188:191], v[120:135]
s_waitcnt lgkmcnt(6)
v_or_b32 v9, v138, v139
v_rcp_f16_sdwa v154, v153 dst_sel:WORD_1 dst_unused:UNUSED_PRESERVE src0_sel:WORD_1
v_fmac_f32 v156, v204, v204
s_waitcnt lgkmcnt(4)
v_or_b32_e64 v10, v140, v141
v_rcp_f16_sdwa v151, v150 dst_sel:WORD_1 dst_unused:UNUSED_PRESERVE src0_sel:WORD_1
v_fmac_f32 v156, v205, v205
s_waitcnt lgkmcnt(3)
v_or_b32_e64 v11, v142, v143
v_rcp_f16_sdwa v148, v147 dst_sel:WORD_1 dst_unused:UNUSED_PRESERVE src0_sel:WORD_1
v_fmac_f32 v156, v206, v206
s_waitcnt lgkmcnt(0)
v_or_b32_e64 v12, v144, v145
v_pk_mul_f16 v13, v155, v154
v_fmac_f32 v156, v207, v207
v_pk_mul_f16 v14, v152, v151
v_pk_mul_f16 v15, v149, v148
s_setprio 1
ds_read_b128 v[236:239], v248 offset:38912
v_mfma_f32_32x32x16_f16 v[192:207], v[8:11], v[240:243], 0
v_cvt_pkrtz_f16_f32 v137, v120, v121
v_cvt_pkrtz_f16_f32 v139, v122, v123
v_cvt_pkrtz_f16_f32 v141, v124, v125
v_cvt_pkrtz_f16_f32 v143, v126, v127
v_mfma_f32_32x32x16_f16 v[192:207], v[12:15], v[244:247], v[192:207]
v_cvt_pkrtz_f16_f32 v145, v128, v129
v_cvt_pkrtz_f16_f32 v147, v130, v131
v_cvt_pk_f16_f32 v155, v132, v133
v_cvt_pk_f16_f32 v152, v134, v135
v_pk_fma_f16 v154, v155, v155, s48
v_mfma_f32_32x32x16_bf16 v[120:135], v[224:227], v[168:171], 0
v_and_b32_e64 v137, s49, v137
v_pk_fma_f16 v151, v152, v152, s48
v_and_b32_e64 v139, s49, v139
v_pk_mul_f16 v154, v155, v154
v_bfe_u32 v136, v137, 2, 14
v_pk_mul_f16 v151, v152, v151
v_bfe_u32 v138, v139, 2, 14
v_exp_f16 v153, v154
v_fmac_f32 v157, v192, v192
ds_read_b128 v[224:227], v248 offset:36864
ds_read_u16_d16 v136, v136
ds_read_u16_d16 v138, v138
v_mfma_f32_32x32x16_bf16 v[120:135], v[228:231], v[172:175], v[120:135]
v_lshrrev_b32 v137, 18, v137
v_fmac_f32 v157, v193, v193
v_exp_f16 v150, v151
v_fmac_f32 v157, v194, v194
v_lshrrev_b32 v139, 18, v139
v_and_b32 v141, s49, v141
v_fmac_f32_e64 v157, v195, v195
v_exp_f16_sdwa v153, v154 dst_sel:WORD_1 dst_unused:UNUSED_PRESERVE src0_sel:WORD_1
ds_read_b128 v[228:231], v248 offset:39936
ds_read_u16_d16_hi v137, v137
ds_read_u16_d16_hi v139, v139
v_mfma_f32_32x32x16_bf16 v[120:135], v[232:235], v[176:179], v[120:135]
v_fmac_f32 v157, v196, v196
v_and_b32 v143, s49, v143
v_bfe_u32 v140, v141, 2, 14
v_fmac_f32_e64 v157, v197, v197
v_exp_f16_sdwa v150, v151 dst_sel:WORD_1 dst_unused:UNUSED_PRESERVE src0_sel:WORD_1
v_fmac_f32_e64 v157, v198, v198
v_bfe_u32 v142, v143, 2, 14
v_pk_add_f16 v153, v153, 1.0 op_sel_hi:[1,0]
v_fmac_f32 v157, v199, v199
s_waitcnt lgkmcnt(5)
ds_read_b128 v[232:235], v248 offset:40960
ds_read_u16_d16 v140, v140
ds_read_u16_d16 v142, v142
v_mfma_f32_32x32x16_bf16 v[120:135], v[236:239], v[180:183], v[120:135]
v_lshrrev_b32_e64 v141, 18, v141
v_pk_add_f16 v150, v150, 1.0 op_sel_hi:[1,0]
v_fmac_f32 v157, v200, v200
v_lshrrev_b32 v143, 18, v143
v_rcp_f16 v154, v153
v_fmac_f32 v157, v201, v201
v_and_b32 v145, s49, v145
v_and_b32 v147, s49, v147
v_fmac_f32_e64 v157, v202, v202
ds_read_b128 v[236:239], v248 offset:44032
ds_read_u16_d16_hi v141, v141
ds_read_u16_d16_hi v143, v143
v_mfma_f32_32x32x16_bf16 v[120:135], v[224:227], v[184:187], v[120:135]
v_rcp_f16 v151, v150
v_fmac_f32 v157, v203, v203
v_bfe_u32 v144, v145, 2, 14
s_setprio 0
v_rcp_f16_sdwa v154, v153 dst_sel:WORD_1 dst_unused:UNUSED_PRESERVE src0_sel:WORD_1
v_fmac_f32 v157, v204, v204
v_bfe_u32 v146, v147, 2, 14
v_fmac_f32_e64 v157, v205, v205
v_lshrrev_b32 v145, 18, v145
s_waitcnt lgkmcnt(4)
ds_read_b128 v[224:227], v248 offset:41984
ds_read_u16_d16 v144, v144
ds_read_u16_d16 v146, v146
ds_read_u16_d16_hi v145, v145
v_mfma_f32_32x32x16_bf16 v[120:135], v[228:231], v[188:191], v[120:135]
v_rcp_f16_sdwa v151, v150 dst_sel:WORD_1 dst_unused:UNUSED_PRESERVE src0_sel:WORD_1
v_fmac_f32 v157, v206, v206
v_lshrrev_b32 v147, 18, v147
v_fmac_f32 v157, v207, v207
v_or_b32 v16, v136, v137
v_or_b32 v17, v138, v139
v_permlane32_swap_b32 v156, v157
s_waitcnt lgkmcnt(5)
v_or_b32 v18, v140, v141
s_waitcnt lgkmcnt(4)
v_or_b32 v19, v142, v143
s_waitcnt lgkmcnt(0)
v_or_b32 v20, v144, v145
ds_read_u16_d16_hi v147, v147
s_waitcnt lgkmcnt(0)
v_or_b32 v21, v146, v147
v_add_f32_e64 v156, v156, v157
ds_write_b32 v255, v156 offset:7168
v_pk_mul_f16 v22, v155, v154
v_pk_mul_f16 v23, v152, v151
s_cmp_lg_u32 s40, 0
s_cbranch_scc1 Lrs1
v_mov_b32 v82, 0
Lpi:
s_waitcnt vmcnt(0)
v_readfirstlane_b32 s43, v83
s_cmp_eq_u32 s76, 0
s_cbranch_scc1 Lpix
s_sub_u32 s76, s76, 1
s_cmp_ge_u32 s43, 256
s_cbranch_scc1 Lpix
buffer_load_dword v83, v82, s[36:39], 0 offen sc1
s_branch Lpi
Lpix:
v_min_u32_e64 v80, 47, v251
v_lshlrev_b32 v80, 3, v80
s_and_b32 s44, s2, 7
s_lshl_b32 s44, s44, 11
s_add_u32 s44, s44, 394752
buffer_load_dwordx2 v[84:85], v80, s[32:35], s44 offen sc1
Lrs1:
s_setprio 2
ds_read_b128 v[228:231], v248 offset:45056
v_mfma_f32_32x32x16_f16 v[192:207], v[16:19], v[240:243], 0
v_cvt_pkrtz_f16_f32 v137, v120, v121
v_cvt_pkrtz_f16_f32 v139, v122, v123
v_cvt_pkrtz_f16_f32 v141, v124, v125
v_cvt_pkrtz_f16_f32 v143, v126, v127
v_cvt_pkrtz_f16_f32 v145, v128, v129
v_mfma_f32_32x32x16_f16 v[192:207], v[20:23], v[244:247], v[192:207]
v_cvt_pk_f16_f32 v155, v130, v131
v_cvt_pk_f16_f32 v152, v132, v133
v_cvt_pk_f16_f32 v149, v134, v135
v_pk_fma_f16 v154, v155, v155, s48
v_and_b32_e64 v137, s49, v137
v_mfma_f32_32x32x16_bf16 v[120:135], v[232:235], v[168:171], 0
v_pk_fma_f16 v151, v152, v152, s48
v_and_b32_e64 v139, s49, v139
v_pk_fma_f16 v148, v149, v149, s48
v_pk_mul_f16 v154, v155, v154
v_bfe_u32 v136, v137, 2, 14
v_pk_mul_f16 v151, v152, v151
v_pk_mul_f16 v148, v149, v148
v_bfe_u32 v138, v139, 2, 14
v_fmac_f32 v158, v192, v192
v_exp_f16 v153, v154
ds_read_b128 v[232:235], v248 offset:43008
ds_read_u16_d16 v136, v136
ds_read_u16_d16 v138, v138
v_mfma_f32_32x32x16_bf16 v[120:135], v[236:239], v[172:175], v[120:135]
v_fmac_f32 v158, v193, v193
v_lshrrev_b32 v137, 18, v137
v_exp_f16 v150, v151
v_fmac_f32 v158, v194, v194
v_lshrrev_b32 v139, 18, v139
v_exp_f16 v147, v148
v_fmac_f32 v158, v195, v195
v_and_b32 v141, s49, v141
ds_read_b128 v[236:239], v248 offset:46080
ds_read_u16_d16_hi v137, v137
ds_read_u16_d16_hi v139, v139
v_mfma_f32_32x32x16_bf16 v[120:135], v[224:227], v[176:179], v[120:135]
v_and_b32_e64 v143, s49, v143
v_exp_f16_sdwa v153, v154 dst_sel:WORD_1 dst_unused:UNUSED_PRESERVE src0_sel:WORD_1
v_fmac_f32_e64 v158, v196, v196
v_bfe_u32 v140, v141, 2, 14
v_exp_f16_sdwa v150, v151 dst_sel:WORD_1 dst_unused:UNUSED_PRESERVE src0_sel:WORD_1
v_fmac_f32 v158, v197, v197
v_bfe_u32 v142, v143, 2, 14
v_exp_f16_sdwa v147, v148 dst_sel:WORD_1 dst_unused:UNUSED_PRESERVE src0_sel:WORD_1
s_waitcnt lgkmcnt(6)
ds_read_b128 v[224:227], v248 offset:47104
ds_read_u16_d16 v140, v140
ds_read_u16_d16 v142, v142
v_mfma_f32_32x32x16_bf16 v[120:135], v[228:231], v[180:183], v[120:135]
v_fmac_f32 v158, v198, v198
v_lshrrev_b32 v141, 18, v141
v_pk_add_f16 v153, v153, 1.0 op_sel_hi:[1,0]
v_fmac_f32 v158, v199, v199
v_lshrrev_b32 v143, 18, v143
v_pk_add_f16 v150, v150, 1.0 op_sel_hi:[1,0]
v_pk_add_f16 v147, v147, 1.0 op_sel_hi:[1,0]
v_fmac_f32_e64 v158, v200, v200
v_and_b32 v145, s49, v145
s_waitcnt lgkmcnt(4)
ds_read_b128 v[228:231], v248 offset:50176
ds_read_u16_d16_hi v141, v141
ds_read_u16_d16_hi v143, v143
v_mfma_f32_32x32x16_bf16 v[120:135], v[232:235], v[184:187], v[120:135]
v_rcp_f16 v154, v153
v_fmac_f32 v158, v201, v201
v_bfe_u32 v144, v145, 2, 14
v_rcp_f16 v151, v150
v_fmac_f32 v158, v202, v202
v_lshrrev_b32 v145, 18, v145
v_rcp_f16 v148, v147
v_fmac_f32 v158, v203, v203
v_or_b32 v24, v136, v137
ds_read_b128 v[232:235], v248 offset:48128
ds_read_u16_d16 v144, v144
ds_read_u16_d16_hi v145, v145
v_mfma_f32_32x32x16_bf16 v[120:135], v[236:239], v[188:191], v[120:135]
s_waitcnt lgkmcnt(6)
v_or_b32 v25, v138, v139
v_rcp_f16_sdwa v154, v153 dst_sel:WORD_1 dst_unused:UNUSED_PRESERVE src0_sel:WORD_1
v_fmac_f32 v158, v204, v204
s_waitcnt lgkmcnt(4)
v_or_b32_e64 v26, v140, v141
v_rcp_f16_sdwa v151, v150 dst_sel:WORD_1 dst_unused:UNUSED_PRESERVE src0_sel:WORD_1
v_fmac_f32 v158, v205, v205
s_waitcnt lgkmcnt(3)
v_or_b32_e64 v27, v142, v143
v_rcp_f16_sdwa v148, v147 dst_sel:WORD_1 dst_unused:UNUSED_PRESERVE src0_sel:WORD_1
v_fmac_f32 v158, v206, v206
s_waitcnt lgkmcnt(0)
v_or_b32_e64 v28, v144, v145
v_pk_mul_f16 v29, v155, v154
v_fmac_f32 v158, v207, v207
v_pk_mul_f16 v30, v152, v151
v_pk_mul_f16 v31, v149, v148
s_setprio 1
ds_read_b128 v[236:239], v248 offset:51200
v_mfma_f32_32x32x16_f16 v[192:207], v[24:27], v[240:243], 0
v_cvt_pkrtz_f16_f32 v137, v120, v121
v_cvt_pkrtz_f16_f32 v139, v122, v123
v_cvt_pkrtz_f16_f32 v141, v124, v125
v_cvt_pkrtz_f16_f32 v143, v126, v127
v_mfma_f32_32x32x16_f16 v[192:207], v[28:31], v[244:247], v[192:207]
v_cvt_pkrtz_f16_f32 v145, v128, v129
v_cvt_pkrtz_f16_f32 v147, v130, v131
v_cvt_pk_f16_f32 v155, v132, v133
v_cvt_pk_f16_f32 v152, v134, v135
v_pk_fma_f16 v154, v155, v155, s48
v_mfma_f32_32x32x16_bf16 v[120:135], v[224:227], v[168:171], 0
v_and_b32_e64 v137, s49, v137
v_pk_fma_f16 v151, v152, v152, s48
v_and_b32_e64 v139, s49, v139
v_pk_mul_f16 v154, v155, v154
v_bfe_u32 v136, v137, 2, 14
v_pk_mul_f16 v151, v152, v151
v_bfe_u32 v138, v139, 2, 14
v_exp_f16 v153, v154
v_fmac_f32 v159, v192, v192
ds_read_b128 v[224:227], v248 offset:49152
ds_read_u16_d16 v136, v136
ds_read_u16_d16 v138, v138
v_mfma_f32_32x32x16_bf16 v[120:135], v[228:231], v[172:175], v[120:135]
v_lshrrev_b32 v137, 18, v137
v_fmac_f32 v159, v193, v193
v_exp_f16 v150, v151
v_fmac_f32 v159, v194, v194
v_lshrrev_b32 v139, 18, v139
v_and_b32 v141, s49, v141
v_fmac_f32_e64 v159, v195, v195
v_exp_f16_sdwa v153, v154 dst_sel:WORD_1 dst_unused:UNUSED_PRESERVE src0_sel:WORD_1
ds_read_b128 v[228:231], v248 offset:52224
ds_read_u16_d16_hi v137, v137
ds_read_u16_d16_hi v139, v139
v_mfma_f32_32x32x16_bf16 v[120:135], v[232:235], v[176:179], v[120:135]
v_fmac_f32 v159, v196, v196
v_and_b32 v143, s49, v143
v_bfe_u32 v140, v141, 2, 14
v_fmac_f32_e64 v159, v197, v197
v_exp_f16_sdwa v150, v151 dst_sel:WORD_1 dst_unused:UNUSED_PRESERVE src0_sel:WORD_1
v_fmac_f32_e64 v159, v198, v198
v_bfe_u32 v142, v143, 2, 14
v_pk_add_f16 v153, v153, 1.0 op_sel_hi:[1,0]
v_fmac_f32 v159, v199, v199
s_waitcnt lgkmcnt(5)
ds_read_b128 v[232:235], v248 offset:53248
ds_read_u16_d16 v140, v140
ds_read_u16_d16 v142, v142
v_mfma_f32_32x32x16_bf16 v[120:135], v[236:239], v[180:183], v[120:135]
v_lshrrev_b32_e64 v141, 18, v141
v_pk_add_f16 v150, v150, 1.0 op_sel_hi:[1,0]
v_fmac_f32 v159, v200, v200
v_lshrrev_b32 v143, 18, v143
v_rcp_f16 v154, v153
v_fmac_f32 v159, v201, v201
v_and_b32 v145, s49, v145
v_and_b32 v147, s49, v147
v_fmac_f32_e64 v159, v202, v202
ds_read_b128 v[236:239], v248 offset:56320
ds_read_u16_d16_hi v141, v141
ds_read_u16_d16_hi v143, v143
v_mfma_f32_32x32x16_bf16 v[120:135], v[224:227], v[184:187], v[120:135]
v_rcp_f16 v151, v150
v_fmac_f32 v159, v203, v203
v_bfe_u32 v144, v145, 2, 14
s_setprio 0
v_rcp_f16_sdwa v154, v153 dst_sel:WORD_1 dst_unused:UNUSED_PRESERVE src0_sel:WORD_1
v_fmac_f32 v159, v204, v204
v_bfe_u32 v146, v147, 2, 14
v_fmac_f32_e64 v159, v205, v205
v_lshrrev_b32 v145, 18, v145
s_waitcnt lgkmcnt(4)
ds_read_b128 v[224:227], v248 offset:54272
ds_read_u16_d16 v144, v144
ds_read_u16_d16 v146, v146
ds_read_u16_d16_hi v145, v145
v_mfma_f32_32x32x16_bf16 v[120:135], v[228:231], v[188:191], v[120:135]
v_rcp_f16_sdwa v151, v150 dst_sel:WORD_1 dst_unused:UNUSED_PRESERVE src0_sel:WORD_1
v_fmac_f32 v159, v206, v206
v_lshrrev_b32 v147, 18, v147
v_fmac_f32 v159, v207, v207
v_or_b32 v32, v136, v137
v_or_b32 v33, v138, v139
v_permlane32_swap_b32 v158, v159
s_waitcnt lgkmcnt(5)
v_or_b32 v34, v140, v141
s_waitcnt lgkmcnt(4)
v_or_b32 v35, v142, v143
s_waitcnt lgkmcnt(0)
v_or_b32 v36, v144, v145
ds_read_u16_d16_hi v147, v147
s_waitcnt lgkmcnt(0)
v_or_b32 v37, v146, v147
v_add_f32 v158, v158, v159
ds_write_b32 v255, v158 offset:7424
v_pk_mul_f16 v38, v155, v154
v_pk_mul_f16 v39, v152, v151
s_setprio 2
ds_read_b128 v[228:231], v248 offset:57344
v_mfma_f32_32x32x16_f16 v[192:207], v[32:35], v[240:243], 0
v_cvt_pkrtz_f16_f32 v137, v120, v121
v_cvt_pkrtz_f16_f32 v139, v122, v123
v_cvt_pkrtz_f16_f32 v141, v124, v125
v_cvt_pkrtz_f16_f32 v143, v126, v127
v_cvt_pkrtz_f16_f32 v145, v128, v129
v_mfma_f32_32x32x16_f16 v[192:207], v[36:39], v[244:247], v[192:207]
v_cvt_pk_f16_f32 v155, v130, v131
v_cvt_pk_f16_f32 v152, v132, v133
v_cvt_pk_f16_f32 v149, v134, v135
v_pk_fma_f16 v154, v155, v155, s48
v_and_b32_e64 v137, s49, v137
v_mfma_f32_32x32x16_bf16 v[120:135], v[232:235], v[168:171], 0
v_pk_fma_f16 v151, v152, v152, s48
v_and_b32_e64 v139, s49, v139
v_pk_fma_f16 v148, v149, v149, s48
v_pk_mul_f16 v154, v155, v154
v_bfe_u32 v136, v137, 2, 14
v_pk_mul_f16 v151, v152, v151
v_pk_mul_f16 v148, v149, v148
v_bfe_u32 v138, v139, 2, 14
v_fmac_f32 v160, v192, v192
v_exp_f16 v153, v154
ds_read_b128 v[232:235], v248 offset:55296
ds_read_u16_d16 v136, v136
ds_read_u16_d16 v138, v138
v_mfma_f32_32x32x16_bf16 v[120:135], v[236:239], v[172:175], v[120:135]
v_fmac_f32 v160, v193, v193
v_lshrrev_b32 v137, 18, v137
v_exp_f16 v150, v151
v_fmac_f32 v160, v194, v194
v_lshrrev_b32 v139, 18, v139
v_exp_f16 v147, v148
v_fmac_f32 v160, v195, v195
v_and_b32 v141, s49, v141
ds_read_b128 v[236:239], v248 offset:58368
ds_read_u16_d16_hi v137, v137
ds_read_u16_d16_hi v139, v139
v_mfma_f32_32x32x16_bf16 v[120:135], v[224:227], v[176:179], v[120:135]
v_and_b32_e64 v143, s49, v143
v_exp_f16_sdwa v153, v154 dst_sel:WORD_1 dst_unused:UNUSED_PRESERVE src0_sel:WORD_1
v_fmac_f32_e64 v160, v196, v196
v_bfe_u32 v140, v141, 2, 14
v_exp_f16_sdwa v150, v151 dst_sel:WORD_1 dst_unused:UNUSED_PRESERVE src0_sel:WORD_1
v_fmac_f32 v160, v197, v197
v_bfe_u32 v142, v143, 2, 14
v_exp_f16_sdwa v147, v148 dst_sel:WORD_1 dst_unused:UNUSED_PRESERVE src0_sel:WORD_1
s_waitcnt lgkmcnt(6)
ds_read_b128 v[224:227], v248 offset:59392
ds_read_u16_d16 v140, v140
ds_read_u16_d16 v142, v142
v_mfma_f32_32x32x16_bf16 v[120:135], v[228:231], v[180:183], v[120:135]
v_fmac_f32 v160, v198, v198
v_lshrrev_b32 v141, 18, v141
v_pk_add_f16 v153, v153, 1.0 op_sel_hi:[1,0]
v_fmac_f32 v160, v199, v199
v_lshrrev_b32 v143, 18, v143
v_pk_add_f16 v150, v150, 1.0 op_sel_hi:[1,0]
v_pk_add_f16 v147, v147, 1.0 op_sel_hi:[1,0]
v_fmac_f32_e64 v160, v200, v200
v_and_b32 v145, s49, v145
s_waitcnt lgkmcnt(4)
ds_read_b128 v[228:231], v248 offset:62464
ds_read_u16_d16_hi v141, v141
ds_read_u16_d16_hi v143, v143
v_mfma_f32_32x32x16_bf16 v[120:135], v[232:235], v[184:187], v[120:135]
v_rcp_f16 v154, v153
v_fmac_f32 v160, v201, v201
v_bfe_u32 v144, v145, 2, 14
v_rcp_f16 v151, v150
v_fmac_f32 v160, v202, v202
v_lshrrev_b32 v145, 18, v145
v_rcp_f16 v148, v147
v_fmac_f32 v160, v203, v203
v_or_b32 v40, v136, v137
ds_read_b128 v[232:235], v248 offset:60416
ds_read_u16_d16 v144, v144
ds_read_u16_d16_hi v145, v145
v_mfma_f32_32x32x16_bf16 v[120:135], v[236:239], v[188:191], v[120:135]
s_waitcnt lgkmcnt(6)
v_or_b32 v41, v138, v139
v_rcp_f16_sdwa v154, v153 dst_sel:WORD_1 dst_unused:UNUSED_PRESERVE src0_sel:WORD_1
v_fmac_f32 v160, v204, v204
s_waitcnt lgkmcnt(4)
v_or_b32_e64 v42, v140, v141
v_rcp_f16_sdwa v151, v150 dst_sel:WORD_1 dst_unused:UNUSED_PRESERVE src0_sel:WORD_1
v_fmac_f32 v160, v205, v205
s_waitcnt lgkmcnt(3)
v_or_b32_e64 v43, v142, v143
v_rcp_f16_sdwa v148, v147 dst_sel:WORD_1 dst_unused:UNUSED_PRESERVE src0_sel:WORD_1
v_fmac_f32 v160, v206, v206
s_waitcnt lgkmcnt(0)
v_or_b32_e64 v44, v144, v145
v_pk_mul_f16 v45, v155, v154
v_fmac_f32_e64 v160, v207, v207
v_pk_mul_f16 v46, v152, v151
v_pk_mul_f16 v47, v149, v148
s_cmp_lg_u32 s40, 0
s_cbranch_scc1 Lrs2
v_min_u32 v80, 47, v251
v_lshlrev_b32 v80, 3, v80
v_add_u32 v81, 7936, v80
v_add_u32 v80, 15872, v80
v_cmp_gt_u32 vcc, 32, v251
s_nop 1
v_cndmask_b32 v80, v80, v81, vcc
s_waitcnt vmcnt(0)
ds_write_b64 v80, v[84:85]
Lrs2:
s_setprio 1
ds_read_b128 v[236:239], v248 offset:63488
v_mfma_f32_32x32x16_f16 v[192:207], v[40:43], v[240:243], 0
v_cvt_pkrtz_f16_f32 v137, v120, v121
v_cvt_pkrtz_f16_f32 v139, v122, v123
v_cvt_pkrtz_f16_f32 v141, v124, v125
v_cvt_pkrtz_f16_f32 v143, v126, v127
v_mfma_f32_32x32x16_f16 v[192:207], v[44:47], v[244:247], v[192:207]
s_waitcnt lgkmcnt(1)
v_cvt_pkrtz_f16_f32 v145, v128, v129
v_cvt_pkrtz_f16_f32 v147, v130, v131
v_cvt_pk_f16_f32 v155, v132, v133
v_cvt_pk_f16_f32 v152, v134, v135
v_pk_fma_f16 v154, v155, v155, s48
v_mfma_f32_32x32x16_bf16 v[120:135], v[224:227], v[168:171], 0
v_and_b32_e64 v137, s49, v137
v_pk_fma_f16 v151, v152, v152, s48
v_and_b32_e64 v139, s49, v139
v_pk_mul_f16 v154, v155, v154
v_bfe_u32 v136, v137, 2, 14
v_pk_mul_f16 v151, v152, v151
v_bfe_u32 v138, v139, 2, 14
v_exp_f16 v153, v154
v_fmac_f32 v161, v192, v192
ds_read_b128 v[224:227], v248 offset:61440
ds_read_u16_d16 v136, v136
ds_read_u16_d16 v138, v138
v_mfma_f32_32x32x16_bf16 v[120:135], v[228:231], v[172:175], v[120:135]
v_lshrrev_b32 v137, 18, v137
v_fmac_f32 v161, v193, v193
v_exp_f16 v150, v151
v_fmac_f32 v161, v194, v194
v_lshrrev_b32 v139, 18, v139
v_and_b32 v141, s49, v141
v_fmac_f32_e64 v161, v195, v195
v_exp_f16_sdwa v153, v154 dst_sel:WORD_1 dst_unused:UNUSED_PRESERVE src0_sel:WORD_1
ds_read_b128 v[228:231], v248 offset:64512
ds_read_u16_d16_hi v137, v137
ds_read_u16_d16_hi v139, v139
v_mfma_f32_32x32x16_bf16 v[120:135], v[232:235], v[176:179], v[120:135]
v_fmac_f32 v161, v196, v196
v_and_b32 v143, s49, v143
v_bfe_u32 v140, v141, 2, 14
v_fmac_f32_e64 v161, v197, v197
v_exp_f16_sdwa v150, v151 dst_sel:WORD_1 dst_unused:UNUSED_PRESERVE src0_sel:WORD_1
v_fmac_f32_e64 v161, v198, v198
v_bfe_u32 v142, v143, 2, 14
v_pk_add_f16 v153, v153, 1.0 op_sel_hi:[1,0]
v_fmac_f32 v161, v199, v199
s_waitcnt lgkmcnt(5)
ds_read_b128 v[232:235], v249
ds_read_u16_d16 v140, v140
ds_read_u16_d16 v142, v142
v_mfma_f32_32x32x16_bf16 v[120:135], v[236:239], v[180:183], v[120:135]
v_lshrrev_b32_e64 v141, 18, v141
v_pk_add_f16 v150, v150, 1.0 op_sel_hi:[1,0]
v_fmac_f32 v161, v200, v200
v_lshrrev_b32 v143, 18, v143
v_rcp_f16 v154, v153
v_fmac_f32 v161, v201, v201
v_and_b32 v145, s49, v145
v_and_b32 v147, s49, v147
v_fmac_f32_e64 v161, v202, v202
ds_read_b128 v[236:239], v249 offset:3072
ds_read_u16_d16_hi v141, v141
ds_read_u16_d16_hi v143, v143
v_mfma_f32_32x32x16_bf16 v[120:135], v[224:227], v[184:187], v[120:135]
v_rcp_f16 v151, v150
v_fmac_f32 v161, v203, v203
v_bfe_u32 v144, v145, 2, 14
s_setprio 0
v_rcp_f16_sdwa v154, v153 dst_sel:WORD_1 dst_unused:UNUSED_PRESERVE src0_sel:WORD_1
v_fmac_f32 v161, v204, v204
v_bfe_u32 v146, v147, 2, 14
v_fmac_f32_e64 v161, v205, v205
v_lshrrev_b32 v145, 18, v145
s_waitcnt lgkmcnt(4)
ds_read_b128 v[224:227], v249 offset:1024
ds_read_u16_d16 v144, v144
ds_read_u16_d16 v146, v146
ds_read_u16_d16_hi v145, v145
v_mfma_f32_32x32x16_bf16 v[120:135], v[228:231], v[188:191], v[120:135]
v_rcp_f16_sdwa v151, v150 dst_sel:WORD_1 dst_unused:UNUSED_PRESERVE src0_sel:WORD_1
v_fmac_f32 v161, v206, v206
v_lshrrev_b32 v147, 18, v147
v_fmac_f32 v161, v207, v207
v_or_b32 v48, v136, v137
v_or_b32 v49, v138, v139
v_permlane32_swap_b32 v160, v161
s_waitcnt lgkmcnt(5)
v_or_b32 v50, v140, v141
s_waitcnt lgkmcnt(4)
v_or_b32 v51, v142, v143
s_waitcnt lgkmcnt(0)
v_or_b32 v52, v144, v145
ds_read_u16_d16_hi v147, v147
s_waitcnt lgkmcnt(0)
v_or_b32 v53, v146, v147
v_add_f32 v160, v160, v161
ds_write_b32 v255, v160 offset:7680
v_pk_mul_f16 v54, v155, v154
v_pk_mul_f16 v55, v152, v151
s_setprio 2
ds_read_b128 v[228:231], v249 offset:4096
v_mfma_f32_32x32x16_f16 v[192:207], v[48:51], v[240:243], 0
v_cvt_pkrtz_f16_f32 v137, v120, v121
v_cvt_pkrtz_f16_f32 v139, v122, v123
v_cvt_pkrtz_f16_f32 v141, v124, v125
v_cvt_pkrtz_f16_f32 v143, v126, v127
v_cvt_pkrtz_f16_f32 v145, v128, v129
v_mfma_f32_32x32x16_f16 v[192:207], v[52:55], v[244:247], v[192:207]
v_cvt_pk_f16_f32 v155, v130, v131
v_cvt_pk_f16_f32 v152, v132, v133
v_cvt_pk_f16_f32 v149, v134, v135
v_pk_fma_f16 v154, v155, v155, s48
v_and_b32_e64 v137, s49, v137
v_mfma_f32_32x32x16_bf16 v[120:135], v[232:235], v[168:171], 0
v_pk_fma_f16 v151, v152, v152, s48
v_and_b32_e64 v139, s49, v139
v_pk_fma_f16 v148, v149, v149, s48
v_pk_mul_f16 v154, v155, v154
v_bfe_u32 v136, v137, 2, 14
v_pk_mul_f16 v151, v152, v151
v_pk_mul_f16 v148, v149, v148
v_bfe_u32 v138, v139, 2, 14
v_fmac_f32 v162, v192, v192
v_exp_f16 v153, v154
ds_read_b128 v[232:235], v249 offset:2048
ds_read_u16_d16 v136, v136
ds_read_u16_d16 v138, v138
v_mfma_f32_32x32x16_bf16 v[120:135], v[236:239], v[172:175], v[120:135]
v_fmac_f32 v162, v193, v193
v_lshrrev_b32 v137, 18, v137
v_exp_f16 v150, v151
v_fmac_f32 v162, v194, v194
v_lshrrev_b32 v139, 18, v139
v_exp_f16 v147, v148
v_fmac_f32 v162, v195, v195
v_and_b32 v141, s49, v141
ds_read_b128 v[236:239], v249 offset:5120
ds_read_u16_d16_hi v137, v137
ds_read_u16_d16_hi v139, v139
v_mfma_f32_32x32x16_bf16 v[120:135], v[224:227], v[176:179], v[120:135]
v_and_b32_e64 v143, s49, v143
v_exp_f16_sdwa v153, v154 dst_sel:WORD_1 dst_unused:UNUSED_PRESERVE src0_sel:WORD_1
v_fmac_f32_e64 v162, v196, v196
v_bfe_u32 v140, v141, 2, 14
v_exp_f16_sdwa v150, v151 dst_sel:WORD_1 dst_unused:UNUSED_PRESERVE src0_sel:WORD_1
v_fmac_f32 v162, v197, v197
v_bfe_u32 v142, v143, 2, 14
v_exp_f16_sdwa v147, v148 dst_sel:WORD_1 dst_unused:UNUSED_PRESERVE src0_sel:WORD_1
s_waitcnt lgkmcnt(6)
ds_read_b128 v[224:227], v249 offset:6144
ds_read_u16_d16 v140, v140
ds_read_u16_d16 v142, v142
v_mfma_f32_32x32x16_bf16 v[120:135], v[228:231], v[180:183], v[120:135]
v_fmac_f32 v162, v198, v198
v_lshrrev_b32 v141, 18, v141
v_pk_add_f16 v153, v153, 1.0 op_sel_hi:[1,0]
v_fmac_f32 v162, v199, v199
v_lshrrev_b32 v143, 18, v143
v_pk_add_f16 v150, v150, 1.0 op_sel_hi:[1,0]
v_pk_add_f16 v147, v147, 1.0 op_sel_hi:[1,0]
v_fmac_f32_e64 v162, v200, v200
v_and_b32 v145, s49, v145
s_waitcnt lgkmcnt(4)
ds_read_b128 v[228:231], v249 offset:9216
ds_read_u16_d16_hi v141, v141
ds_read_u16_d16_hi v143, v143
v_mfma_f32_32x32x16_bf16 v[120:135], v[232:235], v[184:187], v[120:135]
v_rcp_f16 v154, v153
v_fmac_f32 v162, v201, v201
v_bfe_u32 v144, v145, 2, 14
v_rcp_f16 v151, v150
v_fmac_f32 v162, v202, v202
v_lshrrev_b32 v145, 18, v145
v_rcp_f16 v148, v147
v_fmac_f32 v162, v203, v203
v_or_b32 v56, v136, v137
ds_read_b128 v[232:235], v249 offset:7168
ds_read_u16_d16 v144, v144
ds_read_u16_d16_hi v145, v145
v_mfma_f32_32x32x16_bf16 v[120:135], v[236:239], v[188:191], v[120:135]
s_waitcnt lgkmcnt(6)
v_or_b32 v57, v138, v139
v_rcp_f16_sdwa v154, v153 dst_sel:WORD_1 dst_unused:UNUSED_PRESERVE src0_sel:WORD_1
v_fmac_f32 v162, v204, v204
s_waitcnt lgkmcnt(4)
v_or_b32_e64 v58, v140, v141
v_rcp_f16_sdwa v151, v150 dst_sel:WORD_1 dst_unused:UNUSED_PRESERVE src0_sel:WORD_1
v_fmac_f32 v162, v205, v205
s_waitcnt lgkmcnt(3)
v_or_b32_e64 v59, v142, v143
v_rcp_f16_sdwa v148, v147 dst_sel:WORD_1 dst_unused:UNUSED_PRESERVE src0_sel:WORD_1
v_fmac_f32 v162, v206, v206
s_waitcnt lgkmcnt(0)
v_or_b32_e64 v60, v144, v145
v_pk_mul_f16 v61, v155, v154
v_fmac_f32 v162, v207, v207
v_pk_mul_f16 v62, v152, v151
v_pk_mul_f16 v63, v149, v148
s_setprio 1
ds_read_b128 v[236:239], v249 offset:10240
v_mfma_f32_32x32x16_f16 v[192:207], v[56:59], v[240:243], 0
v_cvt_pkrtz_f16_f32 v137, v120, v121
v_cvt_pkrtz_f16_f32 v139, v122, v123
v_cvt_pkrtz_f16_f32 v141, v124, v125
v_cvt_pkrtz_f16_f32 v143, v126, v127
v_mfma_f32_32x32x16_f16 v[192:207], v[60:63], v[244:247], v[192:207]
v_cvt_pkrtz_f16_f32 v145, v128, v129
v_cvt_pkrtz_f16_f32 v147, v130, v131
v_cvt_pk_f16_f32 v155, v132, v133
v_cvt_pk_f16_f32 v152, v134, v135
v_pk_fma_f16 v154, v155, v155, s48
v_mfma_f32_32x32x16_bf16 v[120:135], v[224:227], v[168:171], 0
v_and_b32_e64 v137, s49, v137
v_pk_fma_f16 v151, v152, v152, s48
v_and_b32_e64 v139, s49, v139
v_pk_mul_f16 v154, v155, v154
v_bfe_u32 v136, v137, 2, 14
v_pk_mul_f16 v151, v152, v151
v_bfe_u32 v138, v139, 2, 14
v_exp_f16 v153, v154
v_fmac_f32 v163, v192, v192
ds_read_b128 v[224:227], v249 offset:8192
ds_read_u16_d16 v136, v136
ds_read_u16_d16 v138, v138
v_mfma_f32_32x32x16_bf16 v[120:135], v[228:231], v[172:175], v[120:135]
v_lshrrev_b32 v137, 18, v137
v_fmac_f32 v163, v193, v193
v_exp_f16 v150, v151
v_fmac_f32 v163, v194, v194
v_lshrrev_b32 v139, 18, v139
v_and_b32 v141, s49, v141
v_fmac_f32_e64 v163, v195, v195
v_exp_f16_sdwa v153, v154 dst_sel:WORD_1 dst_unused:UNUSED_PRESERVE src0_sel:WORD_1
ds_read_b128 v[228:231], v249 offset:11264
ds_read_u16_d16_hi v137, v137
ds_read_u16_d16_hi v139, v139
v_mfma_f32_32x32x16_bf16 v[120:135], v[232:235], v[176:179], v[120:135]
v_fmac_f32 v163, v196, v196
v_and_b32 v143, s49, v143
v_bfe_u32 v140, v141, 2, 14
v_fmac_f32_e64 v163, v197, v197
v_exp_f16_sdwa v150, v151 dst_sel:WORD_1 dst_unused:UNUSED_PRESERVE src0_sel:WORD_1
v_fmac_f32_e64 v163, v198, v198
v_bfe_u32 v142, v143, 2, 14
v_pk_add_f16 v153, v153, 1.0 op_sel_hi:[1,0]
v_fmac_f32 v163, v199, v199
s_waitcnt lgkmcnt(5)
ds_read_b128 v[232:235], v249 offset:12288
ds_read_u16_d16 v140, v140
ds_read_u16_d16 v142, v142
v_mfma_f32_32x32x16_bf16 v[120:135], v[236:239], v[180:183], v[120:135]
v_lshrrev_b32_e64 v141, 18, v141
v_pk_add_f16 v150, v150, 1.0 op_sel_hi:[1,0]
v_fmac_f32 v163, v200, v200
v_lshrrev_b32 v143, 18, v143
v_rcp_f16 v154, v153
v_fmac_f32 v163, v201, v201
v_and_b32 v145, s49, v145
v_and_b32 v147, s49, v147
v_fmac_f32_e64 v163, v202, v202
ds_read_b128 v[236:239], v249 offset:15360
ds_read_u16_d16_hi v141, v141
ds_read_u16_d16_hi v143, v143
v_mfma_f32_32x32x16_bf16 v[120:135], v[224:227], v[184:187], v[120:135]
v_rcp_f16 v151, v150
v_fmac_f32 v163, v203, v203
v_bfe_u32 v144, v145, 2, 14
s_setprio 0
v_rcp_f16_sdwa v154, v153 dst_sel:WORD_1 dst_unused:UNUSED_PRESERVE src0_sel:WORD_1
v_fmac_f32 v163, v204, v204
v_bfe_u32 v146, v147, 2, 14
v_fmac_f32_e64 v163, v205, v205
v_lshrrev_b32 v145, 18, v145
s_waitcnt lgkmcnt(4)
ds_read_b128 v[224:227], v249 offset:13312
ds_read_u16_d16 v144, v144
ds_read_u16_d16 v146, v146
ds_read_u16_d16_hi v145, v145
v_mfma_f32_32x32x16_bf16 v[120:135], v[228:231], v[188:191], v[120:135]
v_rcp_f16_sdwa v151, v150 dst_sel:WORD_1 dst_unused:UNUSED_PRESERVE src0_sel:WORD_1
v_fmac_f32 v163, v206, v206
v_lshrrev_b32 v147, 18, v147
v_fmac_f32 v163, v207, v207
v_or_b32 v64, v136, v137
v_or_b32 v65, v138, v139
v_permlane32_swap_b32 v162, v163
s_waitcnt lgkmcnt(5)
v_or_b32 v66, v140, v141
s_waitcnt lgkmcnt(4)
v_or_b32 v67, v142, v143
s_waitcnt lgkmcnt(0)
v_or_b32 v68, v144, v145
ds_read_u16_d16_hi v147, v147
s_waitcnt lgkmcnt(0)
v_or_b32 v69, v146, v147
v_add_f32 v162, v162, v163
ds_write_b32 v255, v162 offset:7936
v_pk_mul_f16 v70, v155, v154
v_pk_mul_f16 v71, v152, v151
s_setprio 2
ds_read_b128 v[228:231], v249 offset:16384
v_mfma_f32_32x32x16_f16 v[192:207], v[64:67], v[240:243], 0
v_cvt_pkrtz_f16_f32 v137, v120, v121
v_cvt_pkrtz_f16_f32 v139, v122, v123
v_cvt_pkrtz_f16_f32 v141, v124, v125
v_cvt_pkrtz_f16_f32 v143, v126, v127
v_cvt_pkrtz_f16_f32 v145, v128, v129
v_mfma_f32_32x32x16_f16 v[192:207], v[68:71], v[244:247], v[192:207]
v_cvt_pk_f16_f32 v155, v130, v131
v_cvt_pk_f16_f32 v152, v132, v133
v_cvt_pk_f16_f32 v149, v134, v135
v_pk_fma_f16 v154, v155, v155, s48
v_and_b32_e64 v137, s49, v137
v_mfma_f32_32x32x16_bf16 v[120:135], v[232:235], v[168:171], 0
v_pk_fma_f16 v151, v152, v152, s48
v_and_b32_e64 v139, s49, v139
v_pk_fma_f16 v148, v149, v149, s48
v_pk_mul_f16 v154, v155, v154
v_bfe_u32 v136, v137, 2, 14
v_pk_mul_f16 v151, v152, v151
v_pk_mul_f16 v148, v149, v148
v_bfe_u32 v138, v139, 2, 14
v_fmac_f32 v164, v192, v192
v_exp_f16 v153, v154
ds_read_b128 v[232:235], v249 offset:14336
ds_read_u16_d16 v136, v136
ds_read_u16_d16 v138, v138
v_mfma_f32_32x32x16_bf16 v[120:135], v[236:239], v[172:175], v[120:135]
v_fmac_f32 v164, v193, v193
v_lshrrev_b32 v137, 18, v137
v_exp_f16 v150, v151
v_fmac_f32 v164, v194, v194
v_lshrrev_b32 v139, 18, v139
v_exp_f16 v147, v148
v_fmac_f32 v164, v195, v195
v_and_b32 v141, s49, v141
ds_read_b128 v[236:239], v249 offset:17408
ds_read_u16_d16_hi v137, v137
ds_read_u16_d16_hi v139, v139
v_mfma_f32_32x32x16_bf16 v[120:135], v[224:227], v[176:179], v[120:135]
v_and_b32_e64 v143, s49, v143
v_exp_f16_sdwa v153, v154 dst_sel:WORD_1 dst_unused:UNUSED_PRESERVE src0_sel:WORD_1
v_fmac_f32_e64 v164, v196, v196
v_bfe_u32 v140, v141, 2, 14
v_exp_f16_sdwa v150, v151 dst_sel:WORD_1 dst_unused:UNUSED_PRESERVE src0_sel:WORD_1
v_fmac_f32 v164, v197, v197
v_bfe_u32 v142, v143, 2, 14
v_exp_f16_sdwa v147, v148 dst_sel:WORD_1 dst_unused:UNUSED_PRESERVE src0_sel:WORD_1
s_waitcnt lgkmcnt(6)
ds_read_b128 v[224:227], v249 offset:18432
ds_read_u16_d16 v140, v140
ds_read_u16_d16 v142, v142
v_mfma_f32_32x32x16_bf16 v[120:135], v[228:231], v[180:183], v[120:135]
v_fmac_f32 v164, v198, v198
v_lshrrev_b32 v141, 18, v141
v_pk_add_f16 v153, v153, 1.0 op_sel_hi:[1,0]
v_fmac_f32 v164, v199, v199
v_lshrrev_b32 v143, 18, v143
v_pk_add_f16 v150, v150, 1.0 op_sel_hi:[1,0]
v_pk_add_f16 v147, v147, 1.0 op_sel_hi:[1,0]
v_fmac_f32_e64 v164, v200, v200
v_and_b32 v145, s49, v145
s_waitcnt lgkmcnt(4)
ds_read_b128 v[228:231], v249 offset:21504
ds_read_u16_d16_hi v141, v141
ds_read_u16_d16_hi v143, v143
v_mfma_f32_32x32x16_bf16 v[120:135], v[232:235], v[184:187], v[120:135]
v_rcp_f16 v154, v153
v_fmac_f32 v164, v201, v201
v_bfe_u32 v144, v145, 2, 14
v_rcp_f16 v151, v150
v_fmac_f32 v164, v202, v202
v_lshrrev_b32 v145, 18, v145
v_rcp_f16 v148, v147
v_fmac_f32 v164, v203, v203
v_or_b32 v72, v136, v137
ds_read_b128 v[232:235], v249 offset:19456
ds_read_u16_d16 v144, v144
ds_read_u16_d16_hi v145, v145
v_mfma_f32_32x32x16_bf16 v[120:135], v[236:239], v[188:191], v[120:135]
s_waitcnt lgkmcnt(6)
v_or_b32 v73, v138, v139
v_rcp_f16_sdwa v154, v153 dst_sel:WORD_1 dst_unused:UNUSED_PRESERVE src0_sel:WORD_1
v_fmac_f32 v164, v204, v204
s_waitcnt lgkmcnt(4)
v_or_b32_e64 v74, v140, v141
v_rcp_f16_sdwa v151, v150 dst_sel:WORD_1 dst_unused:UNUSED_PRESERVE src0_sel:WORD_1
v_fmac_f32 v164, v205, v205
s_waitcnt lgkmcnt(3)
v_or_b32_e64 v75, v142, v143
v_rcp_f16_sdwa v148, v147 dst_sel:WORD_1 dst_unused:UNUSED_PRESERVE src0_sel:WORD_1
v_fmac_f32 v164, v206, v206
s_waitcnt lgkmcnt(0)
v_or_b32_e64 v76, v144, v145
v_pk_mul_f16 v77, v155, v154
v_fmac_f32 v164, v207, v207
v_pk_mul_f16 v78, v152, v151
v_pk_mul_f16 v79, v149, v148
s_setprio 1
ds_read_b128 v[236:239], v249 offset:22528
v_mfma_f32_32x32x16_f16 v[192:207], v[72:75], v[240:243], 0
v_cvt_pkrtz_f16_f32 v137, v120, v121
v_cvt_pkrtz_f16_f32 v139, v122, v123
v_cvt_pkrtz_f16_f32 v141, v124, v125
v_cvt_pkrtz_f16_f32 v143, v126, v127
v_mfma_f32_32x32x16_f16 v[192:207], v[76:79], v[244:247], v[192:207]
v_cvt_pkrtz_f16_f32 v145, v128, v129
v_cvt_pkrtz_f16_f32 v147, v130, v131
v_cvt_pk_f16_f32 v155, v132, v133
v_cvt_pk_f16_f32 v152, v134, v135
v_pk_fma_f16 v154, v155, v155, s48
v_mfma_f32_32x32x16_bf16 v[120:135], v[224:227], v[168:171], 0
v_and_b32_e64 v137, s49, v137
v_pk_fma_f16 v151, v152, v152, s48
v_and_b32_e64 v139, s49, v139
v_pk_mul_f16 v154, v155, v154
v_bfe_u32 v136, v137, 2, 14
v_pk_mul_f16 v151, v152, v151
v_bfe_u32 v138, v139, 2, 14
v_exp_f16 v153, v154
v_fmac_f32 v165, v192, v192
ds_read_b128 v[224:227], v249 offset:20480
ds_read_u16_d16 v136, v136
ds_read_u16_d16 v138, v138
v_mfma_f32_32x32x16_bf16 v[120:135], v[228:231], v[172:175], v[120:135]
v_lshrrev_b32 v137, 18, v137
v_fmac_f32 v165, v193, v193
v_exp_f16 v150, v151
v_fmac_f32 v165, v194, v194
v_lshrrev_b32 v139, 18, v139
v_and_b32 v141, s49, v141
v_fmac_f32_e64 v165, v195, v195
v_exp_f16_sdwa v153, v154 dst_sel:WORD_1 dst_unused:UNUSED_PRESERVE src0_sel:WORD_1
ds_read_b128 v[228:231], v249 offset:23552
ds_read_u16_d16_hi v137, v137
ds_read_u16_d16_hi v139, v139
v_mfma_f32_32x32x16_bf16 v[120:135], v[232:235], v[176:179], v[120:135]
v_fmac_f32 v165, v196, v196
v_and_b32 v143, s49, v143
v_bfe_u32 v140, v141, 2, 14
v_fmac_f32_e64 v165, v197, v197
v_exp_f16_sdwa v150, v151 dst_sel:WORD_1 dst_unused:UNUSED_PRESERVE src0_sel:WORD_1
v_fmac_f32_e64 v165, v198, v198
v_bfe_u32 v142, v143, 2, 14
v_pk_add_f16 v153, v153, 1.0 op_sel_hi:[1,0]
v_fmac_f32 v165, v199, v199
s_waitcnt lgkmcnt(5)
ds_read_b128 v[232:235], v248 offset:47104
ds_read_u16_d16 v140, v140
ds_read_u16_d16 v142, v142
v_mfma_f32_32x32x16_bf16 v[120:135], v[236:239], v[180:183], v[120:135]
v_lshrrev_b32_e64 v141, 18, v141
v_pk_add_f16 v150, v150, 1.0 op_sel_hi:[1,0]
v_fmac_f32 v165, v200, v200
v_lshrrev_b32 v143, 18, v143
v_rcp_f16 v154, v153
v_fmac_f32 v165, v201, v201
v_and_b32 v145, s49, v145
v_and_b32 v147, s49, v147
v_fmac_f32_e64 v165, v202, v202
ds_read_b128 v[236:239], v248 offset:50176
ds_read_u16_d16_hi v141, v141
ds_read_u16_d16_hi v143, v143
v_mfma_f32_32x32x16_bf16 v[120:135], v[224:227], v[184:187], v[120:135]
v_rcp_f16 v151, v150
v_fmac_f32 v165, v203, v203
v_bfe_u32 v144, v145, 2, 14
s_setprio 0
v_rcp_f16_sdwa v154, v153 dst_sel:WORD_1 dst_unused:UNUSED_PRESERVE src0_sel:WORD_1
v_fmac_f32 v165, v204, v204
v_bfe_u32 v146, v147, 2, 14
v_fmac_f32_e64 v165, v205, v205
v_lshrrev_b32 v145, 18, v145
s_waitcnt lgkmcnt(4)
ds_read_b128 v[224:227], v248 offset:48128
ds_read_u16_d16 v144, v144
ds_read_u16_d16 v146, v146
ds_read_u16_d16_hi v145, v145
v_mfma_f32_32x32x16_bf16 v[120:135], v[228:231], v[188:191], v[120:135]
v_rcp_f16_sdwa v151, v150 dst_sel:WORD_1 dst_unused:UNUSED_PRESERVE src0_sel:WORD_1
v_fmac_f32 v165, v206, v206
v_lshrrev_b32 v147, 18, v147
v_fmac_f32 v165, v207, v207
v_or_b32 v80, v136, v137
v_or_b32 v81, v138, v139
v_permlane32_swap_b32 v164, v165
s_waitcnt lgkmcnt(5)
v_or_b32 v82, v140, v141
s_waitcnt lgkmcnt(4)
v_or_b32 v83, v142, v143
s_waitcnt lgkmcnt(0)
v_or_b32 v84, v144, v145
ds_read_u16_d16_hi v147, v147
s_waitcnt lgkmcnt(0)
v_or_b32 v85, v146, v147
v_add_f32 v164, v164, v165
ds_write_b32 v255, v164 offset:8192
v_pk_mul_f16 v86, v155, v154
v_pk_mul_f16 v87, v152, v151
s_setprio 2
ds_read_b128 v[228:231], v248 offset:51200
v_mfma_f32_32x32x16_f16 v[192:207], v[80:83], v[240:243], 0
v_cvt_pkrtz_f16_f32 v137, v120, v121
v_cvt_pkrtz_f16_f32 v139, v122, v123
v_cvt_pkrtz_f16_f32 v141, v124, v125
v_cvt_pkrtz_f16_f32 v143, v126, v127
v_cvt_pkrtz_f16_f32 v145, v128, v129
v_mfma_f32_32x32x16_f16 v[192:207], v[84:87], v[244:247], v[192:207]
v_cvt_pk_f16_f32 v155, v130, v131
v_cvt_pk_f16_f32 v152, v132, v133
v_cvt_pk_f16_f32 v149, v134, v135
v_pk_fma_f16 v154, v155, v155, s48
v_and_b32_e64 v137, s49, v137
v_mfma_f32_32x32x16_bf16 v[120:135], v[232:235], v[96:99], 0
v_pk_fma_f16 v151, v152, v152, s48
v_and_b32_e64 v139, s49, v139
v_pk_fma_f16 v148, v149, v149, s48
v_pk_mul_f16 v154, v155, v154
v_bfe_u32 v136, v137, 2, 14
v_pk_mul_f16 v151, v152, v151
v_pk_mul_f16 v148, v149, v148
v_bfe_u32 v138, v139, 2, 14
v_fmac_f32 v166, v192, v192
v_exp_f16 v153, v154
ds_read_b128 v[232:235], v248 offset:49152
ds_read_u16_d16 v136, v136
ds_read_u16_d16 v138, v138
v_mfma_f32_32x32x16_bf16 v[120:135], v[236:239], v[100:103], v[120:135]
v_fmac_f32 v166, v193, v193
v_lshrrev_b32 v137, 18, v137
v_exp_f16 v150, v151
v_fmac_f32 v166, v194, v194
v_lshrrev_b32 v139, 18, v139
v_exp_f16 v147, v148
v_fmac_f32 v166, v195, v195
v_and_b32 v141, s49, v141
ds_read_b128 v[236:239], v248 offset:52224
ds_read_u16_d16_hi v137, v137
ds_read_u16_d16_hi v139, v139
v_mfma_f32_32x32x16_bf16 v[120:135], v[224:227], v[104:107], v[120:135]
v_and_b32_e64 v143, s49, v143
v_exp_f16_sdwa v153, v154 dst_sel:WORD_1 dst_unused:UNUSED_PRESERVE src0_sel:WORD_1
v_fmac_f32_e64 v166, v196, v196
v_bfe_u32 v140, v141, 2, 14
v_exp_f16_sdwa v150, v151 dst_sel:WORD_1 dst_unused:UNUSED_PRESERVE src0_sel:WORD_1
v_fmac_f32 v166, v197, v197
v_bfe_u32 v142, v143, 2, 14
v_exp_f16_sdwa v147, v148 dst_sel:WORD_1 dst_unused:UNUSED_PRESERVE src0_sel:WORD_1
s_waitcnt lgkmcnt(6)
ds_read_b128 v[224:227], v248 offset:53248
ds_read_u16_d16 v140, v140
ds_read_u16_d16 v142, v142
v_mfma_f32_32x32x16_bf16 v[120:135], v[228:231], v[108:111], v[120:135]
v_fmac_f32 v166, v198, v198
v_lshrrev_b32 v141, 18, v141
v_pk_add_f16 v153, v153, 1.0 op_sel_hi:[1,0]
v_fmac_f32 v166, v199, v199
v_lshrrev_b32 v143, 18, v143
v_pk_add_f16 v150, v150, 1.0 op_sel_hi:[1,0]
v_pk_add_f16 v147, v147, 1.0 op_sel_hi:[1,0]
v_fmac_f32_e64 v166, v200, v200
v_and_b32 v145, s49, v145
s_waitcnt lgkmcnt(4)
ds_read_b128 v[228:231], v248 offset:56320
ds_read_u16_d16_hi v141, v141
ds_read_u16_d16_hi v143, v143
v_mfma_f32_32x32x16_bf16 v[120:135], v[232:235], v[112:115], v[120:135]
v_rcp_f16 v154, v153
v_fmac_f32 v166, v201, v201
v_bfe_u32 v144, v145, 2, 14
v_rcp_f16 v151, v150
v_fmac_f32 v166, v202, v202
v_lshrrev_b32 v145, 18, v145
v_rcp_f16 v148, v147
v_fmac_f32 v166, v203, v203
v_or_b32 v168, v136, v137
ds_read_b128 v[232:235], v248 offset:54272
ds_read_u16_d16 v144, v144
ds_read_u16_d16_hi v145, v145
v_mfma_f32_32x32x16_bf16 v[120:135], v[236:239], v[116:119], v[120:135]
s_waitcnt lgkmcnt(6)
v_or_b32 v169, v138, v139
v_rcp_f16_sdwa v154, v153 dst_sel:WORD_1 dst_unused:UNUSED_PRESERVE src0_sel:WORD_1
v_fmac_f32 v166, v204, v204
s_waitcnt lgkmcnt(4)
v_or_b32_e64 v170, v140, v141
v_rcp_f16_sdwa v151, v150 dst_sel:WORD_1 dst_unused:UNUSED_PRESERVE src0_sel:WORD_1
v_fmac_f32 v166, v205, v205
s_waitcnt lgkmcnt(3)
v_or_b32_e64 v171, v142, v143
v_rcp_f16_sdwa v148, v147 dst_sel:WORD_1 dst_unused:UNUSED_PRESERVE src0_sel:WORD_1
v_fmac_f32 v166, v206, v206
s_waitcnt lgkmcnt(0)
v_or_b32_e64 v172, v144, v145
v_pk_mul_f16 v173, v155, v154
v_fmac_f32 v166, v207, v207
v_pk_mul_f16 v174, v152, v151
v_pk_mul_f16 v175, v149, v148
s_setprio 1
ds_read_b128 v[236:239], v248 offset:57344
v_mfma_f32_32x32x16_f16 v[192:207], v[168:171], v[240:243], 0
v_cvt_pkrtz_f16_f32 v137, v120, v121
v_cvt_pkrtz_f16_f32 v139, v122, v123
v_cvt_pkrtz_f16_f32 v141, v124, v125
v_cvt_pkrtz_f16_f32 v143, v126, v127
v_cvt_pkrtz_f16_f32 v145, v128, v129
v_mfma_f32_32x32x16_f16 v[192:207], v[172:175], v[244:247], v[192:207]
v_cvt_pk_f16_f32 v155, v130, v131
v_cvt_pk_f16_f32 v152, v132, v133
v_cvt_pk_f16_f32 v149, v134, v135
v_pk_fma_f16 v154, v155, v155, s48
v_and_b32_e64 v137, s49, v137
v_pk_fma_f16 v151, v152, v152, s48
v_mfma_f32_32x32x16_bf16 v[120:135], v[224:227], v[96:99], 0
v_and_b32_e64 v139, s49, v139
v_pk_fma_f16 v148, v149, v149, s48
v_pk_mul_f16 v154, v155, v154
v_bfe_u32 v136, v137, 2, 14
v_pk_mul_f16 v151, v152, v151
v_pk_mul_f16 v148, v149, v148
v_fmac_f32 v167, v192, v192
v_fmac_f32 v167, v193, v193
v_fmac_f32 v167, v194, v194
v_fmac_f32 v167, v195, v195
v_fmac_f32_e64 v167, v196, v196
ds_read_b128 v[224:227], v248 offset:55296
ds_read_u16_d16 v136, v136
v_mfma_f32_32x32x16_bf16 v[120:135], v[228:231], v[100:103], v[120:135]
v_fmac_f32 v167, v197, v197
v_fmac_f32 v167, v198, v198
v_fmac_f32 v167, v199, v199
v_fmac_f32 v167, v200, v200
v_fmac_f32 v167, v201, v201
v_fmac_f32 v167, v202, v202
v_fmac_f32 v167, v203, v203
v_fmac_f32 v167, v204, v204
v_fmac_f32 v167, v205, v205
v_fmac_f32 v167, v206, v206
v_fmac_f32_e64 v167, v207, v207
ds_read_b128 v[228:231], v248 offset:58368
v_mfma_f32_32x32x16_bf16 v[120:135], v[232:235], v[104:107], v[120:135]
v_permlane32_swap_b32 v166, v167
v_add_f32 v166, v166, v167
ds_write_b32 v255, v166 offset:8448
s_setprio 3
s_mov_b64 exec, 1
ds_add_rtn_u32 v242, v253, v254
s_mov_b64 exec, -1
s_waitcnt lgkmcnt(0)
v_readfirstlane_b32 s43, v242
s_nop 1
s_cmp_lg_u32 s43, 7
s_cbranch_scc1 Lnopub
v_min_u32 v243, 47, v251
v_lshlrev_b32 v244, 5, v243
v_add_u32 v244, 97280, v244
ds_read_b128 v[176:179], v244
ds_read_b128 v[180:183], v244 offset:16
ds_read_b128 v[184:187], v244 offset:9216
ds_read_b128 v[188:191], v244 offset:9232
ds_read_b128 v[192:195], v244 offset:18432
ds_read_b128 v[196:199], v244 offset:18448
ds_read_b128 v[200:203], v244 offset:27648
ds_read_b128 v[204:207], v244 offset:27664
ds_read_b128 v[156:159], v244 offset:36864
ds_read_b128 v[160:163], v244 offset:36880
v_lshlrev_b32_e64 v246, 13, v243
v_add_u32 v247, 4096, v246
s_waitcnt lgkmcnt(7)
v_add_f32 v176, v176, v184
v_add_f32 v177, v177, v185
v_add_f32 v178, v178, v186
v_add_f32 v179, v179, v187
s_waitcnt lgkmcnt(6)
v_add_f32 v180, v180, v188
v_add_f32 v181, v181, v189
v_add_f32 v182, v182, v190
v_add_f32 v183, v183, v191
ds_read_b128 v[184:187], v244 offset:46080
ds_read_b128 v[188:191], v244 offset:46096
s_waitcnt lgkmcnt(5)
v_add_f32 v192, v192, v200
v_add_f32 v193, v193, v201
v_add_f32 v194, v194, v202
v_add_f32 v195, v195, v203
s_waitcnt lgkmcnt(4)
v_add_f32 v196, v196, v204
v_add_f32 v197, v197, v205
v_add_f32 v198, v198, v206
v_add_f32 v199, v199, v207
ds_read_b128 v[200:203], v244 offset:55296
ds_read_b128 v[204:207], v244 offset:55312
v_add_f32 v176, v176, v192
v_add_f32 v177, v177, v193
v_add_f32 v178, v178, v194
v_add_f32 v179, v179, v195
v_add_f32 v180, v180, v196
v_add_f32 v181, v181, v197
v_add_f32 v182, v182, v198
v_add_f32 v183, v183, v199
ds_read_b128 v[192:195], v244 offset:64512
ds_read_b128 v[196:199], v244 offset:64528
s_waitcnt lgkmcnt(5)
v_add_f32 v156, v156, v184
v_add_f32 v157, v157, v185
v_add_f32 v158, v158, v186
v_add_f32 v159, v159, v187
s_waitcnt lgkmcnt(4)
v_add_f32 v160, v160, v188
v_add_f32 v161, v161, v189
v_add_f32 v162, v162, v190
v_add_f32 v163, v163, v191
s_waitcnt lgkmcnt(1)
v_add_f32 v200, v200, v192
v_add_f32 v201, v201, v193
v_add_f32 v202, v202, v194
v_add_f32 v203, v203, v195
s_waitcnt lgkmcnt(0)
v_add_f32 v204, v204, v196
v_add_f32 v205, v205, v197
v_add_f32 v206, v206, v198
v_add_f32 v207, v207, v199
v_add_f32 v156, v156, v200
v_add_f32 v157, v157, v201
v_add_f32 v158, v158, v202
v_add_f32 v159, v159, v203
v_add_f32 v160, v160, v204
v_add_f32 v161, v161, v205
v_add_f32 v162, v162, v206
v_add_f32 v163, v163, v207
v_add_f32 v176, v176, v156
v_add_f32 v177, v177, v157
v_add_f32 v178, v178, v158
v_add_f32 v179, v179, v159
v_add_f32 v180, v180, v160
v_add_f32 v181, v181, v161
v_add_f32 v182, v182, v162
v_add_f32 v183, v183, v163
v_min_u32 v184, -2, v176
v_min_u32 v185, -2, v177
v_min_u32 v186, -2, v178
v_min_u32 v187, -2, v179
v_min_u32 v188, -2, v180
v_min_u32 v189, -2, v181
v_min_u32_e64 v190, -2, v182
v_min_u32 v191, -2, v183
s_lshl_b32 s43, s2, 4
buffer_store_dwordx4 v[184:187], v246, s[32:35], s43 offen sc1
buffer_store_dwordx4 v[188:191], v247, s[32:35], s43 offen sc1
ds_write_b32 v253, v254 offset:4
s_nop 1
Lnopub:
s_mov_b32 s77, 0
s_cmp_lg_u32 s40, 0
s_cbranch_scc1 Lnorole
s_cmp_lt_u32 s2, 96
s_cselect_b32 s77, 1, 2
s_waitcnt lgkmcnt(0)
v_mov_b32 v156, -1
v_mov_b32 v157, -1
v_mov_b32 v158, -1
v_mov_b32 v159, -1
v_mov_b32 v160, -1
v_mov_b32 v161, -1
v_mov_b32 v162, -1
v_mov_b32 v163, -1
v_mov_b32 v164, -1
v_mov_b32 v165, -1
v_mov_b32 v166, -1
v_mov_b32 v167, -1
v_mov_b32 v252, -1
v_mov_b32 v253, -1
v_mov_b32 v254, -1
v_mov_b32 v255, -1
s_call_b64 s[78:79], Lpoll1
Lnorole:
s_setprio 1
v_bfe_u32 v138, v139, 2, 14
v_exp_f16 v153, v154
v_lshrrev_b32 v137, 18, v137
v_exp_f16 v150, v151
v_lshrrev_b32 v139, 18, v139
ds_read_b128 v[232:235], v248 offset:59392
ds_read_u16_d16 v138, v138
ds_read_u16_d16_hi v137, v137
ds_read_u16_d16_hi v139, v139
v_mfma_f32_32x32x16_bf16 v[120:135], v[236:239], v[108:111], v[120:135]
v_exp_f16 v147, v148
v_and_b32 v141, s49, v141
v_and_b32_e64 v143, s49, v143
v_exp_f16_sdwa v153, v154 dst_sel:WORD_1 dst_unused:UNUSED_PRESERVE src0_sel:WORD_1
v_bfe_u32 v140, v141, 2, 14
v_exp_f16_sdwa v150, v151 dst_sel:WORD_1 dst_unused:UNUSED_PRESERVE src0_sel:WORD_1
v_bfe_u32 v142, v143, 2, 14
v_exp_f16_sdwa v147, v148 dst_sel:WORD_1 dst_unused:UNUSED_PRESERVE src0_sel:WORD_1
ds_read_b128 v[236:239], v248 offset:62464
ds_read_u16_d16 v140, v140
ds_read_u16_d16 v142, v142
v_mfma_f32_32x32x16_bf16 v[120:135], v[224:227], v[112:115], v[120:135]
v_lshrrev_b32_e64 v141, 18, v141
v_pk_add_f16 v153, v153, 1.0 op_sel_hi:[1,0]
v_lshrrev_b32 v143, 18, v143
v_pk_add_f16 v150, v150, 1.0 op_sel_hi:[1,0]
s_setprio 0
v_pk_add_f16 v147, v147, 1.0 op_sel_hi:[1,0]
v_and_b32 v145, s49, v145
v_rcp_f16 v154, v153
v_bfe_u32 v144, v145, 2, 14
v_rcp_f16_e64 v151, v150
ds_read_b128 v[224:227], v248 offset:60416
ds_read_u16_d16_hi v141, v141
ds_read_u16_d16_hi v143, v143
ds_read_u16_d16 v144, v144
v_mfma_f32_32x32x16_bf16 v[120:135], v[228:231], v[116:119], v[120:135]
v_lshrrev_b32 v145, 18, v145
v_rcp_f16 v148, v147
s_waitcnt lgkmcnt(7)
v_or_b32 v176, v136, v137
v_or_b32_e64 v177, v138, v139
v_rcp_f16_sdwa v154, v153 dst_sel:WORD_1 dst_unused:UNUSED_PRESERVE src0_sel:WORD_1
s_waitcnt lgkmcnt(2)
v_or_b32 v178, v140, v141
v_rcp_f16_sdwa v151, v150 dst_sel:WORD_1 dst_unused:UNUSED_PRESERVE src0_sel:WORD_1
s_waitcnt lgkmcnt(1)
v_or_b32 v179, v142, v143
v_rcp_f16_sdwa v148, v147 dst_sel:WORD_1 dst_unused:UNUSED_PRESERVE src0_sel:WORD_1
ds_read_u16_d16_hi v145, v145
s_waitcnt lgkmcnt(0)
v_or_b32 v180, v144, v145
v_pk_mul_f16 v181, v155, v154
v_pk_mul_f16 v182, v152, v151
v_pk_mul_f16 v183, v149, v148
s_cmp_eq_u32 s77, 0
s_cbranch_scc1 Lpp49
s_getreg_b32 s43, hwreg(HW_REG_IB_STS, 0, 4)
s_cmp_lg_u32 s43, 0
s_cbranch_scc1 Lpp49
s_call_b64 s[78:79], Lpoll
s_setprio 0
Lpp49:
s_setprio 2
v_cvt_pkrtz_f16_f32 v137, v120, v121
v_cvt_pkrtz_f16_f32 v139, v122, v123
v_cvt_pkrtz_f16_f32 v141, v124, v125
v_cvt_pkrtz_f16_f32 v143, v126, v127
v_cvt_pkrtz_f16_f32 v145, v128, v129
v_cvt_pk_f16_f32 v155, v130, v131
v_cvt_pk_f16_f32 v152, v132, v133
v_cvt_pk_f16_f32 v149, v134, v135
ds_read_b128 v[228:231], v248 offset:63488
v_mfma_f32_32x32x16_bf16 v[120:135], v[232:235], v[96:99], 0
v_pk_fma_f16 v154, v155, v155, s48
v_and_b32_e64 v137, s49, v137
v_pk_fma_f16 v151, v152, v152, s48
v_and_b32_e64 v139, s49, v139
v_pk_fma_f16 v148, v149, v149, s48
v_pk_mul_f16 v154, v155, v154
v_bfe_u32 v136, v137, 2, 14
v_pk_mul_f16 v151, v152, v151
ds_read_b128 v[232:235], v248 offset:61440
ds_read_u16_d16 v136, v136
v_mfma_f32_32x32x16_bf16 v[120:135], v[236:239], v[100:103], v[120:135]
v_pk_mul_f16 v148, v149, v148
v_bfe_u32 v138, v139, 2, 14
v_exp_f16 v153, v154
v_lshrrev_b32 v137, 18, v137
v_exp_f16 v150, v151
v_lshrrev_b32 v139, 18, v139
ds_read_b128 v[236:239], v248 offset:64512
ds_read_u16_d16 v138, v138
ds_read_u16_d16_hi v137, v137
ds_read_u16_d16_hi v139, v139
v_mfma_f32_32x32x16_bf16 v[120:135], v[224:227], v[104:107], v[120:135]
v_exp_f16 v147, v148
v_and_b32 v141, s49, v141
v_and_b32 v143, s49, v143
v_exp_f16_sdwa v153, v154 dst_sel:WORD_1 dst_unused:UNUSED_PRESERVE src0_sel:WORD_1
v_bfe_u32 v140, v141, 2, 14
v_exp_f16_sdwa v150, v151 dst_sel:WORD_1 dst_unused:UNUSED_PRESERVE src0_sel:WORD_1
s_waitcnt lgkmcnt(6)
ds_read_b128 v[224:227], v249
ds_read_u16_d16 v140, v140
v_mfma_f32_32x32x16_bf16 v[120:135], v[228:231], v[108:111], v[120:135]
v_bfe_u32 v142, v143, 2, 14
v_exp_f16_sdwa v147, v148 dst_sel:WORD_1 dst_unused:UNUSED_PRESERVE src0_sel:WORD_1
v_lshrrev_b32_e64 v141, 18, v141
v_pk_add_f16 v153, v153, 1.0 op_sel_hi:[1,0]
v_lshrrev_b32 v143, 18, v143
v_pk_add_f16 v150, v150, 1.0 op_sel_hi:[1,0]
v_pk_add_f16 v147, v147, 1.0 op_sel_hi:[1,0]
s_waitcnt lgkmcnt(6)
ds_read_b128 v[228:231], v249 offset:3072
ds_read_u16_d16 v142, v142
ds_read_u16_d16_hi v141, v141
ds_read_u16_d16_hi v143, v143
v_mfma_f32_32x32x16_bf16 v[120:135], v[232:235], v[112:115], v[120:135]
v_and_b32 v145, s49, v145
v_rcp_f16 v154, v153
v_bfe_u32 v144, v145, 2, 14
v_rcp_f16_e64 v151, v150
v_lshrrev_b32 v145, 18, v145
s_waitcnt lgkmcnt(6)
ds_read_b128 v[232:235], v249 offset:1024
ds_read_u16_d16 v144, v144
ds_read_u16_d16_hi v145, v145
v_mfma_f32_32x32x16_bf16 v[120:135], v[236:239], v[116:119], v[120:135]
v_rcp_f16 v148, v147
v_or_b32 v184, v136, v137
v_or_b32_e64 v185, v138, v139
v_rcp_f16_sdwa v154, v153 dst_sel:WORD_1 dst_unused:UNUSED_PRESERVE src0_sel:WORD_1
s_waitcnt lgkmcnt(4)
v_or_b32 v186, v140, v141
v_rcp_f16_sdwa v151, v150 dst_sel:WORD_1 dst_unused:UNUSED_PRESERVE src0_sel:WORD_1
s_waitcnt lgkmcnt(3)
v_or_b32 v187, v142, v143
v_rcp_f16_sdwa v148, v147 dst_sel:WORD_1 dst_unused:UNUSED_PRESERVE src0_sel:WORD_1
s_waitcnt lgkmcnt(0)
v_or_b32 v188, v144, v145
v_pk_mul_f16 v189, v155, v154
v_pk_mul_f16 v190, v152, v151
v_pk_mul_f16 v191, v149, v148
s_cmp_eq_u32 s77, 0
s_cbranch_scc1 Lpp50
s_getreg_b32 s43, hwreg(HW_REG_IB_STS, 0, 4)
s_cmp_lg_u32 s43, 0
s_cbranch_scc1 Lpp50
s_call_b64 s[78:79], Lpoll
s_setprio 2
Lpp50:
s_setprio 1
v_cvt_pkrtz_f16_f32 v137, v120, v121
v_cvt_pkrtz_f16_f32 v139, v122, v123
v_cvt_pkrtz_f16_f32 v141, v124, v125
v_cvt_pkrtz_f16_f32 v143, v126, v127
v_cvt_pkrtz_f16_f32 v145, v128, v129
v_cvt_pk_f16_f32 v155, v130, v131
v_cvt_pk_f16_f32 v152, v132, v133
v_cvt_pk_f16_f32 v149, v134, v135
ds_read_b128 v[236:239], v249 offset:4096
v_mfma_f32_32x32x16_bf16 v[120:135], v[224:227], v[96:99], 0
v_pk_fma_f16 v154, v155, v155, s48
v_and_b32_e64 v137, s49, v137
v_pk_fma_f16 v151, v152, v152, s48
v_and_b32_e64 v139, s49, v139
v_pk_fma_f16 v148, v149, v149, s48
v_pk_mul_f16 v154, v155, v154
v_bfe_u32 v136, v137, 2, 14
v_pk_mul_f16 v151, v152, v151
ds_read_b128 v[224:227], v249 offset:2048
ds_read_u16_d16 v136, v136
v_mfma_f32_32x32x16_bf16 v[120:135], v[228:231], v[100:103], v[120:135]
v_pk_mul_f16 v148, v149, v148
v_bfe_u32 v138, v139, 2, 14
v_exp_f16 v153, v154
v_lshrrev_b32 v137, 18, v137
v_exp_f16 v150, v151
v_lshrrev_b32 v139, 18, v139
ds_read_b128 v[228:231], v249 offset:5120
ds_read_u16_d16 v138, v138
ds_read_u16_d16_hi v137, v137
ds_read_u16_d16_hi v139, v139
v_mfma_f32_32x32x16_bf16 v[120:135], v[232:235], v[104:107], v[120:135]
v_exp_f16 v147, v148
v_and_b32 v141, s49, v141
v_and_b32 v143, s49, v143
v_exp_f16_sdwa v153, v154 dst_sel:WORD_1 dst_unused:UNUSED_PRESERVE src0_sel:WORD_1
v_bfe_u32 v140, v141, 2, 14
v_exp_f16_sdwa v150, v151 dst_sel:WORD_1 dst_unused:UNUSED_PRESERVE src0_sel:WORD_1
s_waitcnt lgkmcnt(6)
ds_read_b128 v[232:235], v249 offset:6144
ds_read_u16_d16 v140, v140
v_mfma_f32_32x32x16_bf16 v[120:135], v[236:239], v[108:111], v[120:135]
v_bfe_u32 v142, v143, 2, 14
v_exp_f16_sdwa v147, v148 dst_sel:WORD_1 dst_unused:UNUSED_PRESERVE src0_sel:WORD_1
v_lshrrev_b32_e64 v141, 18, v141
v_pk_add_f16 v153, v153, 1.0 op_sel_hi:[1,0]
v_lshrrev_b32 v143, 18, v143
v_pk_add_f16 v150, v150, 1.0 op_sel_hi:[1,0]
v_pk_add_f16 v147, v147, 1.0 op_sel_hi:[1,0]
s_waitcnt lgkmcnt(6)
ds_read_b128 v[236:239], v249 offset:9216
ds_read_u16_d16 v142, v142
ds_read_u16_d16_hi v141, v141
ds_read_u16_d16_hi v143, v143
v_mfma_f32_32x32x16_bf16 v[120:135], v[224:227], v[112:115], v[120:135]
v_and_b32 v145, s49, v145
v_rcp_f16 v154, v153
v_bfe_u32 v144, v145, 2, 14
s_setprio 0
v_rcp_f16 v151, v150
v_lshrrev_b32 v145, 18, v145
s_waitcnt lgkmcnt(6)
ds_read_b128 v[224:227], v249 offset:7168
ds_read_u16_d16 v144, v144
ds_read_u16_d16_hi v145, v145
v_mfma_f32_32x32x16_bf16 v[120:135], v[228:231], v[116:119], v[120:135]
v_rcp_f16 v148, v147
v_or_b32 v192, v136, v137
v_or_b32_e64 v193, v138, v139
v_rcp_f16_sdwa v154, v153 dst_sel:WORD_1 dst_unused:UNUSED_PRESERVE src0_sel:WORD_1
s_waitcnt lgkmcnt(4)
v_or_b32 v194, v140, v141
v_rcp_f16_sdwa v151, v150 dst_sel:WORD_1 dst_unused:UNUSED_PRESERVE src0_sel:WORD_1
s_waitcnt lgkmcnt(3)
v_or_b32 v195, v142, v143
v_rcp_f16_sdwa v148, v147 dst_sel:WORD_1 dst_unused:UNUSED_PRESERVE src0_sel:WORD_1
s_waitcnt lgkmcnt(0)
v_or_b32 v196, v144, v145
v_pk_mul_f16 v197, v155, v154
v_pk_mul_f16 v198, v152, v151
v_pk_mul_f16 v199, v149, v148
s_cmp_eq_u32 s77, 0
s_cbranch_scc1 Lpp51
s_getreg_b32 s43, hwreg(HW_REG_IB_STS, 0, 4)
s_cmp_lg_u32 s43, 0
s_cbranch_scc1 Lpp51
s_call_b64 s[78:79], Lpoll
s_setprio 0
Lpp51:
v_mov_b32 v136, 16256
Lw2w:
ds_read_b32 v137, v136 offset:4
s_waitcnt lgkmcnt(0)
v_readfirstlane_b32 s43, v137
s_cmp_eq_u32 s76, 0
s_cbranch_scc1 Lw2x
s_sub_u32 s76, s76, 1
s_cmp_lt_u32 s43, 1
s_cbranch_scc0 Lw2x
s_sleep 2
s_branch Lw2w
Lw2x:
v_lshrrev_b32_e64 v136, 2, v251
v_mul_u32_u24 v136, 192, v136
v_and_b32 v137, 3, v251
v_lshl_add_u32 v136, v137, 4, v136
s_add_u32 m0, s72, 7168
s_add_u32 s43, s82, 6208
buffer_load_dwordx4 v136, s[16:19], s43 offen lds
s_add_u32 m0, s72, 8192
s_add_u32 s43, s82, 6272
buffer_load_dwordx4 v136, s[16:19], s43 offen lds
s_setprio 2
v_cvt_pkrtz_f16_f32 v137, v120, v121
v_cvt_pkrtz_f16_f32 v139, v122, v123
v_cvt_pkrtz_f16_f32 v141, v124, v125
v_cvt_pkrtz_f16_f32 v143, v126, v127
v_cvt_pkrtz_f16_f32 v145, v128, v129
v_cvt_pk_f16_f32 v155, v130, v131
v_cvt_pk_f16_f32 v152, v132, v133
v_cvt_pk_f16_f32 v149, v134, v135
ds_read_b128 v[228:231], v249 offset:10240
v_mfma_f32_32x32x16_bf16 v[120:135], v[232:235], v[96:99], 0
v_pk_fma_f16 v154, v155, v155, s48
v_and_b32_e64 v137, s49, v137
v_pk_fma_f16 v151, v152, v152, s48
v_and_b32_e64 v139, s49, v139
v_pk_fma_f16 v148, v149, v149, s48
v_pk_mul_f16 v154, v155, v154
v_bfe_u32 v136, v137, 2, 14
v_pk_mul_f16 v151, v152, v151
ds_read_b128 v[232:235], v249 offset:8192
ds_read_u16_d16 v136, v136
v_mfma_f32_32x32x16_bf16 v[120:135], v[236:239], v[100:103], v[120:135]
v_pk_mul_f16 v148, v149, v148
v_bfe_u32 v138, v139, 2, 14
v_exp_f16 v153, v154
v_lshrrev_b32 v137, 18, v137
v_exp_f16 v150, v151
v_lshrrev_b32 v139, 18, v139
ds_read_b128 v[236:239], v249 offset:11264
ds_read_u16_d16 v138, v138
ds_read_u16_d16_hi v137, v137
ds_read_u16_d16_hi v139, v139
v_mfma_f32_32x32x16_bf16 v[120:135], v[224:227], v[104:107], v[120:135]
v_exp_f16 v147, v148
v_and_b32 v141, s49, v141
v_and_b32 v143, s49, v143
v_exp_f16_sdwa v153, v154 dst_sel:WORD_1 dst_unused:UNUSED_PRESERVE src0_sel:WORD_1
v_bfe_u32 v140, v141, 2, 14
v_exp_f16_sdwa v150, v151 dst_sel:WORD_1 dst_unused:UNUSED_PRESERVE src0_sel:WORD_1
s_waitcnt lgkmcnt(6)
ds_read_b128 v[224:227], v249 offset:12288
ds_read_u16_d16 v140, v140
v_mfma_f32_32x32x16_bf16 v[120:135], v[228:231], v[108:111], v[120:135]
v_bfe_u32 v142, v143, 2, 14
v_exp_f16_sdwa v147, v148 dst_sel:WORD_1 dst_unused:UNUSED_PRESERVE src0_sel:WORD_1
v_lshrrev_b32_e64 v141, 18, v141
v_pk_add_f16 v153, v153, 1.0 op_sel_hi:[1,0]
v_lshrrev_b32 v143, 18, v143
v_pk_add_f16 v150, v150, 1.0 op_sel_hi:[1,0]
v_pk_add_f16 v147, v147, 1.0 op_sel_hi:[1,0]
s_waitcnt lgkmcnt(6)
ds_read_b128 v[228:231], v249 offset:15360
ds_read_u16_d16 v142, v142
ds_read_u16_d16_hi v141, v141
ds_read_u16_d16_hi v143, v143
v_mfma_f32_32x32x16_bf16 v[120:135], v[232:235], v[112:115], v[120:135]
v_and_b32 v145, s49, v145
v_rcp_f16 v154, v153
v_bfe_u32 v144, v145, 2, 14
v_rcp_f16_e64 v151, v150
v_lshrrev_b32 v145, 18, v145
s_waitcnt lgkmcnt(6)
ds_read_b128 v[232:235], v249 offset:13312
ds_read_u16_d16 v144, v144
ds_read_u16_d16_hi v145, v145
v_mfma_f32_32x32x16_bf16 v[120:135], v[236:239], v[116:119], v[120:135]
v_rcp_f16 v148, v147
v_or_b32 v200, v136, v137
v_or_b32_e64 v201, v138, v139
v_rcp_f16_sdwa v154, v153 dst_sel:WORD_1 dst_unused:UNUSED_PRESERVE src0_sel:WORD_1
s_waitcnt lgkmcnt(4)
v_or_b32 v202, v140, v141
v_rcp_f16_sdwa v151, v150 dst_sel:WORD_1 dst_unused:UNUSED_PRESERVE src0_sel:WORD_1
s_waitcnt lgkmcnt(3)
v_or_b32 v203, v142, v143
v_rcp_f16_sdwa v148, v147 dst_sel:WORD_1 dst_unused:UNUSED_PRESERVE src0_sel:WORD_1
s_waitcnt lgkmcnt(0)
v_or_b32 v204, v144, v145
v_pk_mul_f16 v205, v155, v154
v_pk_mul_f16 v206, v152, v151
v_pk_mul_f16 v207, v149, v148
s_cmp_eq_u32 s77, 0
s_cbranch_scc1 Lpp52
s_getreg_b32 s43, hwreg(HW_REG_IB_STS, 0, 4)
s_cmp_lg_u32 s43, 0
s_cbranch_scc1 Lpp52
s_call_b64 s[78:79], Lpoll
s_setprio 2
Lpp52:
s_setprio 1
v_cvt_pkrtz_f16_f32 v137, v120, v121
v_cvt_pkrtz_f16_f32 v139, v122, v123
v_cvt_pkrtz_f16_f32 v141, v124, v125
v_cvt_pkrtz_f16_f32 v143, v126, v127
v_cvt_pkrtz_f16_f32 v145, v128, v129
v_cvt_pk_f16_f32 v155, v130, v131
v_cvt_pk_f16_f32 v152, v132, v133
v_cvt_pk_f16_f32 v149, v134, v135
ds_read_b128 v[236:239], v249 offset:16384
v_mfma_f32_32x32x16_bf16 v[120:135], v[224:227], v[96:99], 0
v_pk_fma_f16 v154, v155, v155, s48
v_and_b32_e64 v137, s49, v137
v_pk_fma_f16 v151, v152, v152, s48
v_and_b32_e64 v139, s49, v139
v_pk_fma_f16 v148, v149, v149, s48
v_pk_mul_f16 v154, v155, v154
v_bfe_u32 v136, v137, 2, 14
v_pk_mul_f16 v151, v152, v151
ds_read_b128 v[224:227], v249 offset:14336
ds_read_u16_d16 v136, v136
v_mfma_f32_32x32x16_bf16 v[120:135], v[228:231], v[100:103], v[120:135]
v_pk_mul_f16 v148, v149, v148
v_bfe_u32 v138, v139, 2, 14
v_exp_f16 v153, v154
v_lshrrev_b32 v137, 18, v137
v_exp_f16 v150, v151
v_lshrrev_b32 v139, 18, v139
ds_read_b128 v[228:231], v249 offset:17408
ds_read_u16_d16 v138, v138
ds_read_u16_d16_hi v137, v137
ds_read_u16_d16_hi v139, v139
v_mfma_f32_32x32x16_bf16 v[120:135], v[232:235], v[104:107], v[120:135]
v_exp_f16 v147, v148
v_and_b32 v141, s49, v141
v_and_b32 v143, s49, v143
v_exp_f16_sdwa v153, v154 dst_sel:WORD_1 dst_unused:UNUSED_PRESERVE src0_sel:WORD_1
v_bfe_u32 v140, v141, 2, 14
v_exp_f16_sdwa v150, v151 dst_sel:WORD_1 dst_unused:UNUSED_PRESERVE src0_sel:WORD_1
s_waitcnt lgkmcnt(6)
ds_read_u16_d16 v140, v140
v_mfma_f32_32x32x16_bf16 v[120:135], v[236:239], v[108:111], v[120:135]
v_bfe_u32 v142, v143, 2, 14
v_exp_f16_sdwa v147, v148 dst_sel:WORD_1 dst_unused:UNUSED_PRESERVE src0_sel:WORD_1
v_lshrrev_b32_e64 v141, 18, v141
v_pk_add_f16 v153, v153, 1.0 op_sel_hi:[1,0]
v_lshrrev_b32 v143, 18, v143
v_pk_add_f16 v150, v150, 1.0 op_sel_hi:[1,0]
v_pk_add_f16 v147, v147, 1.0 op_sel_hi:[1,0]
s_waitcnt lgkmcnt(5)
ds_read_u16_d16 v142, v142
ds_read_u16_d16_hi v141, v141
ds_read_u16_d16_hi v143, v143
v_mfma_f32_32x32x16_bf16 v[120:135], v[224:227], v[112:115], v[120:135]
v_and_b32 v145, s49, v145
v_rcp_f16 v154, v153
v_bfe_u32 v144, v145, 2, 14
s_setprio 0
v_rcp_f16 v151, v150
v_lshrrev_b32 v145, 18, v145
s_waitcnt lgkmcnt(4)
ds_read_u16_d16 v144, v144
ds_read_u16_d16_hi v145, v145
v_mfma_f32_32x32x16_bf16 v[120:135], v[228:231], v[116:119], v[120:135]
v_rcp_f16 v148, v147
v_or_b32 v240, v136, v137
v_or_b32_e64 v241, v138, v139
v_rcp_f16_sdwa v154, v153 dst_sel:WORD_1 dst_unused:UNUSED_PRESERVE src0_sel:WORD_1
s_waitcnt lgkmcnt(3)
v_or_b32 v242, v140, v141
v_rcp_f16_sdwa v151, v150 dst_sel:WORD_1 dst_unused:UNUSED_PRESERVE src0_sel:WORD_1
s_waitcnt lgkmcnt(2)
v_or_b32 v243, v142, v143
v_rcp_f16_sdwa v148, v147 dst_sel:WORD_1 dst_unused:UNUSED_PRESERVE src0_sel:WORD_1
s_waitcnt lgkmcnt(0)
v_or_b32 v244, v144, v145
v_pk_mul_f16 v245, v155, v154
v_pk_mul_f16 v246, v152, v151
v_pk_mul_f16 v247, v149, v148
s_cmp_eq_u32 s77, 0
s_cbranch_scc1 Lpp53
s_getreg_b32 s43, hwreg(HW_REG_IB_STS, 0, 4)
s_cmp_lg_u32 s43, 0
s_cbranch_scc1 Lpp53
s_call_b64 s[78:79], Lpoll
s_setprio 0
Lpp53:
s_setprio 2
v_cvt_pkrtz_f16_f32 v137, v120, v121
v_cvt_pkrtz_f16_f32 v139, v122, v123
v_cvt_pkrtz_f16_f32 v141, v124, v125
v_cvt_pkrtz_f16_f32 v143, v126, v127
v_cvt_pkrtz_f16_f32 v145, v128, v129
v_cvt_pk_f16_f32 v155, v130, v131
v_cvt_pk_f16_f32 v152, v132, v133
v_cvt_pk_f16_f32 v149, v134, v135
v_pk_fma_f16 v154, v155, v155, s48
v_and_b32_e64 v137, s49, v137
v_pk_fma_f16 v151, v152, v152, s48
v_and_b32_e64 v139, s49, v139
v_pk_fma_f16 v148, v149, v149, s48
v_pk_mul_f16 v154, v155, v154
v_bfe_u32 v136, v137, 2, 14
v_pk_mul_f16 v151, v152, v151
v_pk_mul_f16 v148, v149, v148
v_bfe_u32 v138, v139, 2, 14
v_exp_f16 v153, v154
v_lshrrev_b32 v137, 18, v137
v_exp_f16 v150, v151
v_lshrrev_b32 v139, 18, v139
v_exp_f16 v147, v148
v_and_b32 v141, s49, v141
v_and_b32_e64 v143, s49, v143
ds_read_u16_d16 v136, v136
ds_read_u16_d16 v138, v138
ds_read_u16_d16_hi v137, v137
ds_read_u16_d16_hi v139, v139
v_exp_f16_sdwa v153, v154 dst_sel:WORD_1 dst_unused:UNUSED_PRESERVE src0_sel:WORD_1
v_bfe_u32 v140, v141, 2, 14
v_exp_f16_sdwa v150, v151 dst_sel:WORD_1 dst_unused:UNUSED_PRESERVE src0_sel:WORD_1
s_setprio 1
v_bfe_u32 v142, v143, 2, 14
v_exp_f16_sdwa v147, v148 dst_sel:WORD_1 dst_unused:UNUSED_PRESERVE src0_sel:WORD_1
v_lshrrev_b32 v141, 18, v141
v_pk_add_f16 v153, v153, 1.0 op_sel_hi:[1,0]
v_lshrrev_b32_e64 v143, 18, v143
v_pk_add_f16 v150, v150, 1.0 op_sel_hi:[1,0]
v_pk_add_f16 v147, v147, 1.0 op_sel_hi:[1,0]
v_and_b32 v145, s49, v145
v_rcp_f16 v154, v153
v_bfe_u32 v144, v145, 2, 14
v_rcp_f16 v151, v150
v_lshrrev_b32 v145, 18, v145
ds_read_u16_d16 v140, v140
ds_read_u16_d16 v142, v142
ds_read_u16_d16_hi v141, v141
ds_read_u16_d16_hi v143, v143
ds_read_u16_d16 v144, v144
ds_read_u16_d16_hi v145, v145
v_rcp_f16 v148, v147
s_waitcnt lgkmcnt(7)
v_or_b32 v232, v136, v137
s_waitcnt lgkmcnt(6)
v_or_b32 v233, v138, v139
v_rcp_f16_sdwa v154, v153 dst_sel:WORD_1 dst_unused:UNUSED_PRESERVE src0_sel:WORD_1
s_waitcnt lgkmcnt(3)
v_or_b32 v234, v140, v141
s_setprio 0
v_rcp_f16_sdwa v151, v150 dst_sel:WORD_1 dst_unused:UNUSED_PRESERVE src0_sel:WORD_1
s_waitcnt lgkmcnt(2)
v_or_b32 v235, v142, v143
v_rcp_f16_sdwa v148, v147 dst_sel:WORD_1 dst_unused:UNUSED_PRESERVE src0_sel:WORD_1
s_waitcnt lgkmcnt(0)
v_or_b32 v236, v144, v145
v_pk_mul_f16 v237, v155, v154
v_pk_mul_f16 v238, v152, v151
v_pk_mul_f16 v239, v149, v148
s_cmp_eq_u32 s77, 0
s_cbranch_scc1 Lpp54
s_getreg_b32 s43, hwreg(HW_REG_IB_STS, 0, 4)
s_cmp_lg_u32 s43, 0
s_cbranch_scc1 Lpp54
s_call_b64 s[78:79], Lpoll
s_setprio 0
Lpp54:
s_setprio 2
v_lshrrev_b32_e64 v225, 5, v251
v_lshl_add_u32 v224, v225, 9, s72
v_lshl_add_u32 v226, v225, 4, s72
v_and_b32 v225, 15, v251
v_lshl_add_u32 v224, v225, 4, v224
v_bfe_u32 v225, v251, 4, 1
v_lshl_add_u32 v224, v225, 3, v224
s_waitcnt vmcnt(0)
ds_read_b64_tr_b16 v[120:121], v224
ds_read_b64_tr_b16 v[122:123], v224 offset:256
ds_read_b64_tr_b16 v[124:125], v224 offset:1024
ds_read_b64_tr_b16 v[126:127], v224 offset:1280
ds_read_b64_tr_b16 v[128:129], v224 offset:2048
ds_read_b64_tr_b16 v[130:131], v224 offset:2304
ds_read_b64_tr_b16 v[132:133], v224 offset:3072
ds_read_b64_tr_b16 v[134:135], v224 offset:3328
ds_read_b64_tr_b16 v[136:137], v224 offset:4096
ds_read_b64_tr_b16 v[138:139], v224 offset:4352
ds_read_b64_tr_b16 v[140:141], v224 offset:5120
ds_read_b64_tr_b16 v[142:143], v224 offset:5376
ds_read_b64_tr_b16 v[144:145], v224 offset:6144
ds_read_b64_tr_b16 v[146:147], v224 offset:6400
ds_read_b64_tr_b16 v[148:149], v224 offset:7168
ds_read_b64_tr_b16 v[150:151], v224 offset:7424
ds_read_b64_tr_b16 v[152:153], v224 offset:8192
ds_read_b64_tr_b16 v[154:155], v224 offset:8448
v_mov_b32 v225, 16256
v_mov_b32_e64 v227, 1
v_permlane16_swap_b32 v0, v4
v_permlane16_swap_b32 v1, v5
v_permlane16_swap_b32 v2, v6
v_permlane16_swap_b32 v3, v7
v_permlane16_swap_b32 v8, v12
v_permlane16_swap_b32 v9, v13
v_permlane16_swap_b32 v10, v14
v_permlane16_swap_b32 v11, v15
s_waitcnt lgkmcnt(0)
s_mov_b64 exec, 1
ds_add_u32 v225, v227 offset:8
s_mov_b64 exec, -1
v_lshlrev_b32 v228, 16, v120
v_and_b32 v229, 4294901760, v120
v_cvt_pk_f16_f32 v120, v228, v229
v_lshlrev_b32_e64 v230, 16, v121
v_and_b32 v231, 4294901760, v121
v_cvt_pk_f16_f32 v121, v230, v231
v_lshlrev_b32_e64 v228, 16, v122
v_and_b32 v229, 4294901760, v122
v_cvt_pk_f16_f32 v122, v228, v229
v_lshlrev_b32_e64 v230, 16, v123
v_and_b32 v231, 4294901760, v123
v_cvt_pk_f16_f32 v123, v230, v231
v_lshlrev_b32_e64 v228, 16, v124
v_and_b32 v229, 4294901760, v124
v_cvt_pk_f16_f32 v124, v228, v229
v_lshlrev_b32_e64 v230, 16, v125
v_and_b32 v231, 4294901760, v125
v_cvt_pk_f16_f32 v125, v230, v231
v_lshlrev_b32_e64 v228, 16, v126
v_and_b32 v229, 4294901760, v126
v_cvt_pk_f16_f32 v126, v228, v229
v_lshlrev_b32_e64 v230, 16, v127
v_and_b32 v231, 4294901760, v127
v_cvt_pk_f16_f32 v127, v230, v231
v_lshlrev_b32_e64 v228, 16, v128
v_and_b32 v229, 4294901760, v128
v_cvt_pk_f16_f32 v128, v228, v229
v_lshlrev_b32_e64 v230, 16, v129
v_and_b32 v231, 4294901760, v129
v_cvt_pk_f16_f32 v129, v230, v231
v_lshlrev_b32_e64 v228, 16, v130
v_and_b32 v229, 4294901760, v130
v_cvt_pk_f16_f32 v130, v228, v229
v_lshlrev_b32_e64 v230, 16, v131
v_and_b32 v231, 4294901760, v131
v_cvt_pk_f16_f32 v131, v230, v231
s_cmp_eq_u32 s77, 0
s_cbranch_scc1 Lpp911
s_getreg_b32 s43, hwreg(HW_REG_IB_STS, 0, 4)
s_cmp_lg_u32 s43, 0
s_cbranch_scc1 Lpp911
s_call_b64 s[78:79], Lpoll
s_setprio 2
Lpp911:
v_lshlrev_b32 v228, 16, v132
v_and_b32 v229, 4294901760, v132
v_cvt_pk_f16_f32 v132, v228, v229
v_lshlrev_b32_e64 v230, 16, v133
v_and_b32 v231, 4294901760, v133
v_cvt_pk_f16_f32 v133, v230, v231
v_lshlrev_b32_e64 v228, 16, v134
v_and_b32 v229, 4294901760, v134
v_cvt_pk_f16_f32 v134, v228, v229
v_lshlrev_b32_e64 v230, 16, v135
v_and_b32 v231, 4294901760, v135
v_cvt_pk_f16_f32 v135, v230, v231
v_lshlrev_b32_e64 v228, 16, v136
v_and_b32 v229, 4294901760, v136
v_cvt_pk_f16_f32 v136, v228, v229
v_lshlrev_b32_e64 v230, 16, v137
v_and_b32 v231, 4294901760, v137
v_cvt_pk_f16_f32 v137, v230, v231
v_lshlrev_b32_e64 v228, 16, v138
v_and_b32 v229, 4294901760, v138
v_cvt_pk_f16_f32 v138, v228, v229
v_lshlrev_b32_e64 v230, 16, v139
v_and_b32 v231, 4294901760, v139
v_cvt_pk_f16_f32 v139, v230, v231
v_lshlrev_b32_e64 v228, 16, v140
v_and_b32 v229, 4294901760, v140
v_cvt_pk_f16_f32 v140, v228, v229
v_lshlrev_b32_e64 v230, 16, v141
v_and_b32 v231, 4294901760, v141
v_cvt_pk_f16_f32 v141, v230, v231
v_lshlrev_b32_e64 v228, 16, v142
v_and_b32 v229, 4294901760, v142
v_cvt_pk_f16_f32 v142, v228, v229
v_lshlrev_b32_e64 v230, 16, v143
v_and_b32 v231, 4294901760, v143
v_cvt_pk_f16_f32 v143, v230, v231
s_cmp_eq_u32 s77, 0
s_cbranch_scc1 Lpp923
s_getreg_b32 s43, hwreg(HW_REG_IB_STS, 0, 4)
s_cmp_lg_u32 s43, 0
s_cbranch_scc1 Lpp923
s_call_b64 s[78:79], Lpoll
s_setprio 2
Lpp923:
v_lshlrev_b32 v228, 16, v144
v_and_b32 v229, 4294901760, v144
v_cvt_pk_f16_f32 v144, v228, v229
v_lshlrev_b32_e64 v230, 16, v145
v_and_b32 v231, 4294901760, v145
v_cvt_pk_f16_f32 v145, v230, v231
v_lshlrev_b32_e64 v228, 16, v146
v_and_b32 v229, 4294901760, v146
v_cvt_pk_f16_f32 v146, v228, v229
v_lshlrev_b32_e64 v230, 16, v147
v_and_b32 v231, 4294901760, v147
v_cvt_pk_f16_f32 v147, v230, v231
v_lshlrev_b32_e64 v228, 16, v148
v_and_b32 v229, 4294901760, v148
v_cvt_pk_f16_f32 v148, v228, v229
v_lshlrev_b32_e64 v230, 16, v149
v_and_b32 v231, 4294901760, v149
v_cvt_pk_f16_f32 v149, v230, v231
v_lshlrev_b32_e64 v228, 16, v150
v_and_b32 v229, 4294901760, v150
v_cvt_pk_f16_f32 v150, v228, v229
v_lshlrev_b32_e64 v230, 16, v151
v_and_b32 v231, 4294901760, v151
v_cvt_pk_f16_f32 v151, v230, v231
v_lshlrev_b32_e64 v228, 16, v152
v_and_b32 v229, 4294901760, v152
v_cvt_pk_f16_f32 v152, v228, v229
v_lshlrev_b32_e64 v230, 16, v153
v_and_b32 v231, 4294901760, v153
v_cvt_pk_f16_f32 v153, v230, v231
v_lshlrev_b32_e64 v228, 16, v154
v_and_b32 v229, 4294901760, v154
v_cvt_pk_f16_f32 v154, v228, v229
v_lshlrev_b32_e64 v230, 16, v155
v_and_b32 v231, 4294901760, v155
v_cvt_pk_f16_f32 v155, v230, v231
s_cmp_eq_u32 s77, 0
s_cbranch_scc1 Lpp935
s_getreg_b32 s43, hwreg(HW_REG_IB_STS, 0, 4)
s_cmp_lg_u32 s43, 0
s_cbranch_scc1 Lpp935
s_call_b64 s[78:79], Lpoll
s_setprio 2
Lpp935:
v_lshl_add_u32 v224, v251, 4, s72
v_add_u32 v228, 0, v251
v_mul_u32_u24 v231, 2731, v228
v_lshrrev_b32_e64 v231, 16, v231
v_mul_u32_u24 v231, 9120, v231
v_lshl_add_u32 v228, v228, 2, v231
v_add_u32 v228, 90112, v228
v_add_u32_e64 v229, 64, v251
v_mul_u32_u24 v231, 2731, v229
v_lshrrev_b32_e64 v231, 16, v231
v_mul_u32_u24 v231, 9120, v231
v_lshl_add_u32 v229, v229, 2, v231
v_add_u32 v229, 90112, v229
v_add_u32 v230, 128, v251
v_mul_u32_u24 v231, 2731, v230
v_lshrrev_b32_e64 v231, 16, v231
v_mul_u32_u24 v231, 9120, v231
v_lshl_add_u32 v230, v230, 2, v231
v_add_u32 v230, 90112, v230
Lspin:
s_cmp_eq_u32 s77, 0
s_cbranch_scc1 Lspinx
s_cmp_eq_u32 s76, 0
s_cbranch_scc1 Lspinx
s_sub_u32 s76, s76, 1
s_call_b64 s[78:79], Lpoll
s_branch Lspin
Lspinx:
s_cmp_lg_u32 s40, 0
s_cbranch_scc1 Lnofin
v_mov_b32 v252, 16256
Lrrw:
ds_read_b32 v253, v252 offset:8
s_waitcnt lgkmcnt(0)
v_readfirstlane_b32 s43, v253
s_cmp_eq_u32 s76, 0
s_cbranch_scc1 Lrrx
s_sub_u32 s76, s76, 1
s_cmp_lt_u32 s43, 8
s_cbranch_scc0 Lrrx
s_sleep 2
s_branch Lrrw
Lrrx:
ds_write_b32 v228, v162
ds_write_b32 v229, v163
ds_write_b32 v230, v164
Lnofin:
s_waitcnt lgkmcnt(0)
s_barrier
ds_read_b128 v[156:159], v226
ds_read_b128 v[160:163], v226 offset:32
ds_read_b128 v[164:167], v226 offset:64
v_lshrrev_b32 v225, 4, v251
v_and_b32 v227, 15, v251
v_mul_u32_u24 v252, 192, v227
v_lshl_add_u32 v252, v225, 4, v252
v_lshlrev_b32 v254, 5, v225
v_and_b32 v253, 47, v251
v_lshlrev_b32 v253, 4, v253
v_and_b32 v225, 1, v225
v_mul_u32_u24 v227, 3072, v225
v_add_u32 v248, v227, v253
v_add_u32 v249, 65536, v248
v_add_u32 v250, 131072, v248
v_lshl_add_u32 v253, v225, 21, v253
s_waitcnt lgkmcnt(0)
v_pk_mul_f16 v120, v120, v156
v_pk_mul_f16 v121, v121, v157
v_pk_mul_f16 v122, v122, v158
v_pk_mul_f16 v123, v123, v159
ds_write_b128 v224, v[120:123]
v_pk_mul_f16 v124, v124, v156
v_pk_mul_f16 v125, v125, v157
v_pk_mul_f16 v126, v126, v158
v_pk_mul_f16 v127, v127, v159
ds_write_b128 v224, v[124:127] offset:1024
v_pk_mul_f16 v128, v128, v156
v_pk_mul_f16 v129, v129, v157
v_pk_mul_f16 v130, v130, v158
v_pk_mul_f16 v131, v131, v159
ds_write_b128 v224, v[128:131] offset:2048
v_pk_mul_f16 v132, v132, v160
v_pk_mul_f16 v133, v133, v161
v_pk_mul_f16 v134, v134, v162
v_pk_mul_f16 v135, v135, v163
ds_write_b128 v224, v[132:135] offset:3072
v_pk_mul_f16 v136, v136, v160
v_pk_mul_f16 v137, v137, v161
v_pk_mul_f16 v138, v138, v162
v_pk_mul_f16 v139, v139, v163
ds_write_b128 v224, v[136:139] offset:4096
v_pk_mul_f16 v140, v140, v160
v_pk_mul_f16 v141, v141, v161
v_pk_mul_f16 v142, v142, v162
v_pk_mul_f16 v143, v143, v163
ds_write_b128 v224, v[140:143] offset:5120
v_pk_mul_f16 v144, v144, v164
v_pk_mul_f16 v145, v145, v165
v_pk_mul_f16 v146, v146, v166
v_pk_mul_f16 v147, v147, v167
ds_write_b128 v224, v[144:147] offset:6144
v_pk_mul_f16 v148, v148, v164
v_pk_mul_f16 v149, v149, v165
v_pk_mul_f16 v150, v150, v166
v_pk_mul_f16 v151, v151, v167
ds_write_b128 v224, v[148:151] offset:7168
v_pk_mul_f16 v152, v152, v164
v_pk_mul_f16 v153, v153, v165
v_pk_mul_f16 v154, v154, v166
v_pk_mul_f16 v155, v155, v167
ds_write_b128 v224, v[152:155] offset:8192
ds_read_b128 v[120:123], v254 offset:7936
ds_read_b128 v[124:127], v254 offset:7952
ds_read_b128 v[128:131], v254 offset:7936
ds_read_b128 v[132:135], v254 offset:7952
ds_read_b128 v[136:139], v254 offset:8064
ds_read_b128 v[140:143], v254 offset:8080
ds_read_b128 v[144:147], v254 offset:8064
ds_read_b128 v[148:151], v254 offset:8080
ds_read_b128 v[152:155], v254 offset:16128
ds_read_b128 v[156:159], v254 offset:16144
ds_read_b128 v[160:163], v254 offset:16128
ds_read_b128 v[164:167], v254 offset:16144
s_waitcnt lgkmcnt(12)
s_barrier
s_setprio 3
ds_read_b128 v[224:227], v249 offset:24576
ds_read_b128 v[228:231], v249 offset:24832
s_waitcnt lgkmcnt(1)
v_mfma_f32_16x16x32_f16 v[120:123], v[224:227], v[0:3], v[120:123]
v_mfma_f32_16x16x32_f16 v[128:131], v[224:227], v[4:7], v[128:131]
v_permlane16_swap_b32 v16, v20
s_waitcnt lgkmcnt(0)
v_mfma_f32_16x16x32_f16 v[124:127], v[228:231], v[0:3], v[124:127]
ds_read_b128 v[224:227], v249 offset:25600
v_mfma_f32_16x16x32_f16 v[132:135], v[228:231], v[4:7], v[132:135]
v_permlane16_swap_b32 v17, v21
s_waitcnt lgkmcnt(0)
v_mfma_f32_16x16x32_f16 v[136:139], v[224:227], v[0:3], v[136:139]
ds_read_b128 v[228:231], v249 offset:25856
v_mfma_f32_16x16x32_f16 v[144:147], v[224:227], v[4:7], v[144:147]
v_permlane16_swap_b32 v18, v22
s_waitcnt lgkmcnt(0)
v_mfma_f32_16x16x32_f16 v[140:143], v[228:231], v[0:3], v[140:143]
ds_read_b128 v[224:227], v249 offset:26624
v_mfma_f32_16x16x32_f16 v[148:151], v[228:231], v[4:7], v[148:151]
v_permlane16_swap_b32 v19, v23
s_waitcnt lgkmcnt(0)
v_mfma_f32_16x16x32_f16 v[152:155], v[224:227], v[0:3], v[152:155]
ds_read_b128 v[228:231], v249 offset:26880
v_mfma_f32_16x16x32_f16 v[160:163], v[224:227], v[4:7], v[160:163]
v_permlane16_swap_b32 v24, v28
s_waitcnt lgkmcnt(0)
v_mfma_f32_16x16x32_f16 v[156:159], v[228:231], v[0:3], v[156:159]
ds_read_b128 v[224:227], v249 offset:30720
v_mfma_f32_16x16x32_f16 v[164:167], v[228:231], v[4:7], v[164:167]
v_permlane16_swap_b32 v25, v29
s_waitcnt lgkmcnt(0)
v_mfma_f32_16x16x32_f16 v[120:123], v[224:227], v[8:11], v[120:123]
ds_read_b128 v[228:231], v249 offset:30976
ds_read_b128 v[0:3], v249 offset:31744
ds_read_b128 v[4:7], v249 offset:32000
v_mfma_f32_16x16x32_f16 v[128:131], v[224:227], v[12:15], v[128:131]
v_permlane16_swap_b32 v26, v30
s_waitcnt lgkmcnt(2)
v_mfma_f32_16x16x32_f16 v[124:127], v[228:231], v[8:11], v[124:127]
ds_read_b128 v[224:227], v249 offset:32768
v_mfma_f32_16x16x32_f16 v[132:135], v[228:231], v[12:15], v[132:135]
v_permlane16_swap_b32 v27, v31
s_waitcnt lgkmcnt(2)
v_mfma_f32_16x16x32_f16 v[136:139], v[0:3], v[8:11], v[136:139]
ds_read_b128 v[228:231], v249 offset:33024
v_mfma_f32_16x16x32_f16 v[144:147], v[0:3], v[12:15], v[144:147]
v_permlane16_swap_b32 v96, v100
s_waitcnt lgkmcnt(2)
v_mfma_f32_16x16x32_f16 v[140:143], v[4:7], v[8:11], v[140:143]
ds_read_b128 v[0:3], v249 offset:36864
v_mfma_f32_16x16x32_f16 v[148:151], v[4:7], v[12:15], v[148:151]
v_permlane16_swap_b32 v97, v101
s_waitcnt lgkmcnt(2)
v_mfma_f32_16x16x32_f16 v[152:155], v[224:227], v[8:11], v[152:155]
ds_read_b128 v[4:7], v249 offset:37120
v_mfma_f32_16x16x32_f16 v[160:163], v[224:227], v[12:15], v[160:163]
v_permlane16_swap_b32 v98, v102
s_waitcnt lgkmcnt(2)
v_mfma_f32_16x16x32_f16 v[156:159], v[228:231], v[8:11], v[156:159]
ds_read_b128 v[224:227], v249 offset:37888
v_mfma_f32_16x16x32_f16 v[164:167], v[228:231], v[12:15], v[164:167]
v_permlane16_swap_b32 v99, v103
s_waitcnt lgkmcnt(2)
v_mfma_f32_16x16x32_f16 v[120:123], v[0:3], v[16:19], v[120:123]
buffer_load_dwordx4 v[12:15], v252, s[4:7], s71 offen
ds_read_b128 v[228:231], v249 offset:38144
v_mfma_f32_16x16x32_f16 v[128:131], v[0:3], v[20:23], v[128:131]
v_permlane16_swap_b32 v32, v36
s_waitcnt lgkmcnt(2)
v_mfma_f32_16x16x32_f16 v[124:127], v[4:7], v[16:19], v[124:127]
ds_read_b128 v[0:3], v249 offset:38912
v_mfma_f32_16x16x32_f16 v[132:135], v[4:7], v[20:23], v[132:135]
v_permlane16_swap_b32 v33, v37
s_waitcnt lgkmcnt(2)
v_mfma_f32_16x16x32_f16 v[136:139], v[224:227], v[16:19], v[136:139]
ds_read_b128 v[4:7], v249 offset:39168
v_mfma_f32_16x16x32_f16 v[144:147], v[224:227], v[20:23], v[144:147]
v_permlane16_swap_b32 v34, v38
s_waitcnt lgkmcnt(2)
v_mfma_f32_16x16x32_f16 v[140:143], v[228:231], v[16:19], v[140:143]
ds_read_b128 v[224:227], v249 offset:43008
v_mfma_f32_16x16x32_f16 v[148:151], v[228:231], v[20:23], v[148:151]
v_permlane16_swap_b32 v35, v39
s_waitcnt lgkmcnt(2)
v_mfma_f32_16x16x32_f16 v[152:155], v[0:3], v[16:19], v[152:155]
ds_read_b128 v[228:231], v249 offset:43264
v_mfma_f32_16x16x32_f16 v[160:163], v[0:3], v[20:23], v[160:163]
v_permlane16_swap_b32 v40, v44
s_waitcnt lgkmcnt(2)
v_mfma_f32_16x16x32_f16 v[156:159], v[4:7], v[16:19], v[156:159]
ds_read_b128 v[0:3], v249 offset:44032
v_mfma_f32_16x16x32_f16 v[164:167], v[4:7], v[20:23], v[164:167]
v_permlane16_swap_b32 v41, v45
s_waitcnt lgkmcnt(2)
v_mfma_f32_16x16x32_f16 v[120:123], v[224:227], v[24:27], v[120:123]
buffer_load_dwordx4 v[8:11], v252, s[4:7], s71 offen offset:64
ds_read_b128 v[4:7], v249 offset:44288
v_mfma_f32_16x16x32_f16 v[128:131], v[224:227], v[28:31], v[128:131]
v_permlane16_swap_b32 v42, v46
s_waitcnt lgkmcnt(2)
v_mfma_f32_16x16x32_f16 v[124:127], v[228:231], v[24:27], v[124:127]
ds_read_b128 v[224:227], v249 offset:45056
v_mfma_f32_16x16x32_f16 v[132:135], v[228:231], v[28:31], v[132:135]
v_permlane16_swap_b32 v43, v47
s_waitcnt lgkmcnt(2)
v_mfma_f32_16x16x32_f16 v[136:139], v[0:3], v[24:27], v[136:139]
ds_read_b128 v[228:231], v249 offset:45312
v_mfma_f32_16x16x32_f16 v[144:147], v[0:3], v[28:31], v[144:147]
v_permlane16_swap_b32 v104, v108
s_waitcnt lgkmcnt(2)
v_mfma_f32_16x16x32_f16 v[140:143], v[4:7], v[24:27], v[140:143]
ds_read_b128 v[0:3], v249 offset:49152
v_mfma_f32_16x16x32_f16 v[148:151], v[4:7], v[28:31], v[148:151]
v_permlane16_swap_b32 v105, v109
s_waitcnt lgkmcnt(2)
v_mfma_f32_16x16x32_f16 v[152:155], v[224:227], v[24:27], v[152:155]
ds_read_b128 v[4:7], v249 offset:49408
v_mfma_f32_16x16x32_f16 v[160:163], v[224:227], v[28:31], v[160:163]
v_permlane16_swap_b32 v106, v110
s_waitcnt lgkmcnt(2)
v_mfma_f32_16x16x32_f16 v[156:159], v[228:231], v[24:27], v[156:159]
ds_read_b128 v[224:227], v249 offset:50176
v_mfma_f32_16x16x32_f16 v[164:167], v[228:231], v[28:31], v[164:167]
v_permlane16_swap_b32 v107, v111
s_waitcnt lgkmcnt(2)
v_mfma_f32_16x16x32_f16 v[120:123], v[0:3], v[32:35], v[120:123]
buffer_load_dwordx4 v[16:19], v252, s[4:7], s71 offen offset:128
ds_read_b128 v[228:231], v249 offset:50432
v_mfma_f32_16x16x32_f16 v[128:131], v[0:3], v[36:39], v[128:131]
v_permlane16_swap_b32 v48, v52
s_waitcnt lgkmcnt(2)
v_mfma_f32_16x16x32_f16 v[124:127], v[4:7], v[32:35], v[124:127]
ds_read_b128 v[0:3], v249 offset:51200
v_mfma_f32_16x16x32_f16 v[132:135], v[4:7], v[36:39], v[132:135]
v_permlane16_swap_b32 v49, v53
s_waitcnt lgkmcnt(2)
v_mfma_f32_16x16x32_f16 v[136:139], v[224:227], v[32:35], v[136:139]
ds_read_b128 v[4:7], v249 offset:51456
v_permlane16_swap_b32 v50, v54
v_mfma_f32_16x16x32_f16 v[144:147], v[224:227], v[36:39], v[144:147]
s_waitcnt lgkmcnt(2)
v_mfma_f32_16x16x32_f16 v[140:143], v[228:231], v[32:35], v[140:143]
ds_read_b128 v[224:227], v249 offset:55296
v_permlane16_swap_b32 v51, v55
v_mfma_f32_16x16x32_f16 v[148:151], v[228:231], v[36:39], v[148:151]
v_permlane16_swap_b32 v56, v60
s_waitcnt lgkmcnt(2)
v_mfma_f32_16x16x32_f16 v[152:155], v[0:3], v[32:35], v[152:155]
ds_read_b128 v[228:231], v249 offset:55552
v_mfma_f32_16x16x32_f16 v[160:163], v[0:3], v[36:39], v[160:163]
v_permlane16_swap_b32 v57, v61
s_waitcnt lgkmcnt(2)
v_mfma_f32_16x16x32_f16 v[156:159], v[4:7], v[32:35], v[156:159]
ds_read_b128 v[0:3], v249 offset:56320
v_permlane16_swap_b32 v58, v62
v_mfma_f32_16x16x32_f16 v[164:167], v[4:7], v[36:39], v[164:167]
s_waitcnt lgkmcnt(2)
v_mfma_f32_16x16x32_f16 v[120:123], v[224:227], v[40:43], v[120:123]
s_add_u32 s46, s71, 98304
buffer_load_dwordx4 v[20:23], v252, s[4:7], s46 offen
ds_read_b128 v[4:7], v249 offset:56576
v_permlane16_swap_b32 v59, v63
v_mfma_f32_16x16x32_f16 v[128:131], v[224:227], v[44:47], v[128:131]
v_and_b32_e64 v24, 1, v251
v_lshlrev_b32 v24, 4, v24
s_waitcnt lgkmcnt(2)
v_mfma_f32_16x16x32_f16 v[124:127], v[228:231], v[40:43], v[124:127]
ds_read_b128 v[224:227], v249 offset:57344
v_mov_b32 v25, 16256
v_mfma_f32_16x16x32_f16 v[132:135], v[228:231], v[44:47], v[132:135]
v_lshlrev_b32 v24, v24, v25
s_waitcnt lgkmcnt(2)
v_mfma_f32_16x16x32_f16 v[136:139], v[0:3], v[40:43], v[136:139]
ds_read_b128 v[228:231], v249 offset:57600
v_lshrrev_b32 v25, 2, v251
v_mfma_f32_16x16x32_f16 v[144:147], v[0:3], v[44:47], v[144:147]
v_xor_b32 v25, v25, v251
v_and_b32 v25, 12, v25
s_waitcnt lgkmcnt(2)
v_mfma_f32_16x16x32_f16 v[140:143], v[4:7], v[40:43], v[140:143]
ds_read_b128 v[0:3], v249 offset:61440
v_and_b32_e64 v28, 2, v251
v_mfma_f32_16x16x32_f16 v[148:151], v[4:7], v[44:47], v[148:151]
v_or_b32 v25, v25, v28
s_waitcnt lgkmcnt(2)
v_mfma_f32_16x16x32_f16 v[152:155], v[224:227], v[40:43], v[152:155]
ds_read_b128 v[4:7], v249 offset:61696
v_cmp_eq_u32 vcc, 0, v25
s_nop 1
v_cndmask_b32 v26, 0, v24, vcc
v_cmp_eq_u32 vcc, 2, v25
s_nop 1
v_cndmask_b32 v27, 0, v24, vcc
v_mfma_f32_16x16x32_f16 v[160:163], v[224:227], v[44:47], v[160:163]
v_mov_b32 v24, 0
s_waitcnt lgkmcnt(2)
v_mfma_f32_16x16x32_f16 v[156:159], v[228:231], v[40:43], v[156:159]
ds_read_b128 v[224:227], v249 offset:62464
v_mov_b32_e64 v25, 0
v_mfma_f32_16x16x32_f16 v[164:167], v[228:231], v[44:47], v[164:167]
v_mov_b32 v28, 0
v_mov_b32 v29, 0
s_waitcnt lgkmcnt(2)
v_mfma_f32_16x16x32_f16 v[120:123], v[0:3], v[48:51], v[120:123]
s_add_u32 s46, s80, 8388608
buffer_load_dwordx4 v[32:35], v253, s[32:35], s46 offen nt
ds_read_b128 v[228:231], v249 offset:62720
v_mfma_f32_16x16x32_f16 v[128:131], v[0:3], v[52:55], v[128:131]
s_waitcnt lgkmcnt(2)
v_mfma_f32_16x16x32_f16 v[124:127], v[4:7], v[48:51], v[124:127]
ds_read_b128 v[0:3], v249 offset:63488
v_permlane16_swap_b32 v64, v68
v_mfma_f32_16x16x32_f16 v[132:135], v[4:7], v[52:55], v[132:135]
s_waitcnt lgkmcnt(2)
v_mfma_f32_16x16x32_f16 v[136:139], v[224:227], v[48:51], v[136:139]
ds_read_b128 v[4:7], v249 offset:63744
v_permlane16_swap_b32 v65, v69
v_mfma_f32_16x16x32_f16 v[144:147], v[224:227], v[52:55], v[144:147]
s_waitcnt lgkmcnt(2)
v_mfma_f32_16x16x32_f16 v[140:143], v[228:231], v[48:51], v[140:143]
ds_read_b128 v[224:227], v250 offset:2048
v_permlane16_swap_b32 v66, v70
v_mfma_f32_16x16x32_f16 v[148:151], v[228:231], v[52:55], v[148:151]
s_waitcnt lgkmcnt(2)
v_mfma_f32_16x16x32_f16 v[152:155], v[0:3], v[48:51], v[152:155]
ds_read_b128 v[228:231], v250 offset:2304
v_mfma_f32_16x16x32_f16 v[160:163], v[0:3], v[52:55], v[160:163]
v_permlane16_swap_b32 v67, v71
s_waitcnt lgkmcnt(2)
v_mfma_f32_16x16x32_f16 v[156:159], v[4:7], v[48:51], v[156:159]
ds_read_b128 v[0:3], v250 offset:3072
v_mfma_f32_16x16x32_f16 v[164:167], v[4:7], v[52:55], v[164:167]
v_permlane16_swap_b32 v72, v76
s_waitcnt lgkmcnt(2)
v_mfma_f32_16x16x32_f16 v[120:123], v[224:227], v[56:59], v[120:123]
ds_read_b128 v[4:7], v250 offset:3328
v_mfma_f32_16x16x32_f16 v[128:131], v[224:227], v[60:63], v[128:131]
v_permlane16_swap_b32 v73, v77
s_waitcnt lgkmcnt(2)
v_mfma_f32_16x16x32_f16 v[124:127], v[228:231], v[56:59], v[124:127]
s_add_u32 s46, s80, 8388608
buffer_load_dwordx4 v[36:39], v253, s[32:35], s46 offen offset:256 nt
ds_read_b128 v[224:227], v250 offset:4096
v_mfma_f32_16x16x32_f16 v[132:135], v[228:231], v[60:63], v[132:135]
s_waitcnt lgkmcnt(2)
v_mfma_f32_16x16x32_f16 v[136:139], v[0:3], v[56:59], v[136:139]
ds_read_b128 v[228:231], v250 offset:4352
v_permlane16_swap_b32 v74, v78
v_mfma_f32_16x16x32_f16 v[144:147], v[0:3], v[60:63], v[144:147]
s_waitcnt lgkmcnt(2)
v_mfma_f32_16x16x32_f16 v[140:143], v[4:7], v[56:59], v[140:143]
ds_read_b128 v[0:3], v250 offset:8192
v_permlane16_swap_b32 v75, v79
v_mfma_f32_16x16x32_f16 v[148:151], v[4:7], v[60:63], v[148:151]
s_waitcnt lgkmcnt(2)
v_mfma_f32_16x16x32_f16 v[152:155], v[224:227], v[56:59], v[152:155]
ds_read_b128 v[4:7], v250 offset:8448
v_permlane16_swap_b32 v200, v204
v_mfma_f32_16x16x32_f16 v[160:163], v[224:227], v[60:63], v[160:163]
s_waitcnt lgkmcnt(2)
v_mfma_f32_16x16x32_f16 v[156:159], v[228:231], v[56:59], v[156:159]
ds_read_b128 v[224:227], v250 offset:9216
v_mfma_f32_16x16x32_f16 v[164:167], v[228:231], v[60:63], v[164:167]
v_permlane16_swap_b32 v201, v205
s_waitcnt vmcnt(5)
v_mfma_f32_16x16x32_bf16 v[120:123], v[26:29], v[12:15], v[120:123]
ds_read_b128 v[228:231], v250 offset:9472
v_mfma_f32_16x16x32_bf16 v[124:127], v[24:27], v[12:15], v[124:127]
v_permlane16_swap_b32 v202, v206
s_waitcnt vmcnt(4)
v_mfma_f32_16x16x32_bf16 v[136:139], v[26:29], v[8:11], v[136:139]
v_mfma_f32_16x16x32_bf16 v[140:143], v[24:27], v[8:11], v[140:143]
v_permlane16_swap_b32 v203, v207
s_waitcnt lgkmcnt(3)
v_mfma_f32_16x16x32_f16 v[120:123], v[0:3], v[64:67], v[120:123]
s_add_u32 s46, s71, 98304
buffer_load_dwordx4 v[8:11], v252, s[4:7], s46 offen offset:64
v_mfma_f32_16x16x32_f16 v[128:131], v[0:3], v[68:71], v[128:131]
s_waitcnt lgkmcnt(2)
v_mfma_f32_16x16x32_f16 v[124:127], v[4:7], v[64:67], v[124:127]
ds_read_b128 v[0:3], v250 offset:10240
v_permlane16_swap_b32 v80, v84
v_mfma_f32_16x16x32_f16 v[132:135], v[4:7], v[68:71], v[132:135]
s_waitcnt lgkmcnt(2)
v_mfma_f32_16x16x32_f16 v[136:139], v[224:227], v[64:67], v[136:139]
ds_read_b128 v[4:7], v250 offset:10496
v_permlane16_swap_b32 v81, v85
v_mfma_f32_16x16x32_f16 v[144:147], v[224:227], v[68:71], v[144:147]
s_waitcnt lgkmcnt(2)
v_mfma_f32_16x16x32_f16 v[140:143], v[228:231], v[64:67], v[140:143]
ds_read_b128 v[224:227], v250 offset:14336
v_permlane16_swap_b32 v82, v86
v_mfma_f32_16x16x32_f16 v[148:151], v[228:231], v[68:71], v[148:151]
s_waitcnt lgkmcnt(2)
v_mfma_f32_16x16x32_f16 v[152:155], v[0:3], v[64:67], v[152:155]
ds_read_b128 v[228:231], v250 offset:14592
v_mfma_f32_16x16x32_f16 v[160:163], v[0:3], v[68:71], v[160:163]
v_permlane16_swap_b32 v83, v87
s_waitcnt lgkmcnt(2)
v_mfma_f32_16x16x32_f16 v[156:159], v[4:7], v[64:67], v[156:159]
ds_read_b128 v[0:3], v250 offset:15360
v_mfma_f32_16x16x32_f16 v[164:167], v[4:7], v[68:71], v[164:167]
v_permlane16_swap_b32 v168, v172
s_waitcnt lgkmcnt(2)
v_mfma_f32_16x16x32_f16 v[120:123], v[224:227], v[72:75], v[120:123]
ds_read_b128 v[4:7], v250 offset:15616
v_mfma_f32_16x16x32_f16 v[128:131], v[224:227], v[76:79], v[128:131]
v_permlane16_swap_b32 v169, v173
s_waitcnt lgkmcnt(2)
v_mfma_f32_16x16x32_f16 v[124:127], v[228:231], v[72:75], v[124:127]
s_add_u32 s46, s71, 98304
buffer_load_dwordx4 v[12:15], v252, s[4:7], s46 offen offset:128
ds_read_b128 v[224:227], v250 offset:16384
v_mfma_f32_16x16x32_f16 v[132:135], v[228:231], v[76:79], v[132:135]
s_waitcnt lgkmcnt(2)
v_mfma_f32_16x16x32_f16 v[136:139], v[0:3], v[72:75], v[136:139]
ds_read_b128 v[228:231], v250 offset:16640
v_permlane16_swap_b32 v170, v174
v_mfma_f32_16x16x32_f16 v[144:147], v[0:3], v[76:79], v[144:147]
s_waitcnt lgkmcnt(2)
v_mfma_f32_16x16x32_f16 v[140:143], v[4:7], v[72:75], v[140:143]
ds_read_b128 v[0:3], v250 offset:20480
v_permlane16_swap_b32 v171, v175
v_mfma_f32_16x16x32_f16 v[148:151], v[4:7], v[76:79], v[148:151]
s_waitcnt lgkmcnt(2)
v_mfma_f32_16x16x32_f16 v[152:155], v[224:227], v[72:75], v[152:155]
ds_read_b128 v[4:7], v250 offset:20736
v_permlane16_swap_b32 v192, v196
v_mfma_f32_16x16x32_f16 v[160:163], v[224:227], v[76:79], v[160:163]
s_waitcnt lgkmcnt(2)
v_mfma_f32_16x16x32_f16 v[156:159], v[228:231], v[72:75], v[156:159]
ds_read_b128 v[224:227], v250 offset:21504
v_mfma_f32_16x16x32_f16 v[164:167], v[228:231], v[76:79], v[164:167]
v_permlane16_swap_b32 v193, v197
s_waitcnt vmcnt(5)
v_mfma_f32_16x16x32_bf16 v[152:155], v[26:29], v[16:19], v[152:155]
ds_read_b128 v[228:231], v250 offset:21760
v_mfma_f32_16x16x32_bf16 v[156:159], v[24:27], v[16:19], v[156:159]
v_permlane16_swap_b32 v194, v198
s_waitcnt vmcnt(4)
v_mfma_f32_16x16x32_bf16 v[128:131], v[26:29], v[20:23], v[128:131]
v_mfma_f32_16x16x32_bf16 v[132:135], v[24:27], v[20:23], v[132:135]
v_permlane16_swap_b32 v195, v199
v_and_b32 v255, 1, v251
v_lshlrev_b32 v255, 7, v255
v_sub_u32 v255, v252, v255
s_mov_b32 s74, 1431655765
s_mov_b32 s75, 1431655765
s_waitcnt lgkmcnt(3)
v_mfma_f32_16x16x32_f16 v[120:123], v[0:3], v[80:83], v[120:123]
buffer_load_dwordx4 v[20:23], v252, s[4:7], s70 offen
v_mfma_f32_16x16x32_f16 v[128:131], v[0:3], v[84:87], v[128:131]
v_permlane16_swap_b32 v176, v180
s_waitcnt lgkmcnt(2)
v_mfma_f32_16x16x32_f16 v[124:127], v[4:7], v[80:83], v[124:127]
ds_read_b128 v[0:3], v250 offset:22528
v_mfma_f32_16x16x32_f16 v[132:135], v[4:7], v[84:87], v[132:135]
v_permlane16_swap_b32 v177, v181
s_waitcnt lgkmcnt(2)
v_mfma_f32_16x16x32_f16 v[136:139], v[224:227], v[80:83], v[136:139]
ds_read_b128 v[4:7], v250 offset:22784
v_mfma_f32_16x16x32_f16 v[144:147], v[224:227], v[84:87], v[144:147]
v_permlane16_swap_b32 v178, v182
s_waitcnt lgkmcnt(2)
v_mfma_f32_16x16x32_f16 v[140:143], v[228:231], v[80:83], v[140:143]
ds_read_b128 v[224:227], v250 offset:26624
v_mfma_f32_16x16x32_f16 v[148:151], v[228:231], v[84:87], v[148:151]
v_permlane16_swap_b32 v179, v183
s_waitcnt lgkmcnt(2)
v_mfma_f32_16x16x32_f16 v[152:155], v[0:3], v[80:83], v[152:155]
ds_read_b128 v[228:231], v250 offset:26880
v_mfma_f32_16x16x32_f16 v[160:163], v[0:3], v[84:87], v[160:163]
v_permlane16_swap_b32 v184, v188
s_waitcnt lgkmcnt(2)
v_mfma_f32_16x16x32_f16 v[156:159], v[4:7], v[80:83], v[156:159]
ds_read_b128 v[0:3], v250 offset:27648
v_mfma_f32_16x16x32_f16 v[164:167], v[4:7], v[84:87], v[164:167]
v_permlane16_swap_b32 v185, v189
s_waitcnt lgkmcnt(2)
v_mfma_f32_16x16x32_f16 v[120:123], v[224:227], v[168:171], v[120:123]
buffer_load_dwordx4 v[16:19], v252, s[4:7], s70 offen offset:64
ds_read_b128 v[4:7], v250 offset:27904
v_mfma_f32_16x16x32_f16 v[128:131], v[224:227], v[172:175], v[128:131]
v_permlane16_swap_b32 v186, v190
s_waitcnt lgkmcnt(2)
v_mfma_f32_16x16x32_f16 v[124:127], v[228:231], v[168:171], v[124:127]
ds_read_b128 v[224:227], v250 offset:28672
v_mfma_f32_16x16x32_f16 v[132:135], v[228:231], v[172:175], v[132:135]
v_permlane16_swap_b32 v187, v191
s_waitcnt lgkmcnt(2)
v_mfma_f32_16x16x32_f16 v[136:139], v[0:3], v[168:171], v[136:139]
ds_read_b128 v[228:231], v250 offset:28928
v_mfma_f32_16x16x32_f16 v[144:147], v[0:3], v[172:175], v[144:147]
v_permlane16_swap_b32 v112, v116
s_waitcnt lgkmcnt(2)
v_mfma_f32_16x16x32_f16 v[140:143], v[4:7], v[168:171], v[140:143]
ds_read_b128 v[0:3], v249 offset:55296
v_mfma_f32_16x16x32_f16 v[148:151], v[4:7], v[172:175], v[148:151]
v_permlane16_swap_b32 v113, v117
s_waitcnt lgkmcnt(2)
v_mfma_f32_16x16x32_f16 v[152:155], v[224:227], v[168:171], v[152:155]
ds_read_b128 v[4:7], v254 offset:7936
v_mfma_f32_16x16x32_f16 v[160:163], v[224:227], v[172:175], v[160:163]
v_permlane16_swap_b32 v114, v118
s_waitcnt lgkmcnt(2)
v_mfma_f32_16x16x32_f16 v[156:159], v[228:231], v[168:171], v[156:159]
ds_read_b128 v[224:227], v249 offset:55552
v_mfma_f32_16x16x32_f16 v[164:167], v[228:231], v[172:175], v[164:167]
v_permlane16_swap_b32 v115, v119
s_waitcnt lgkmcnt(1)
v_mfma_f32_16x16x32_f16 v[48:51], v[0:3], v[176:179], v[4:7]
ds_read_b128 v[228:231], v254 offset:7952
v_mfma_f32_16x16x32_f16 v[56:59], v[0:3], v[180:183], v[4:7]
s_waitcnt lgkmcnt(0)
v_mfma_f32_16x16x32_f16 v[52:55], v[224:227], v[176:179], v[228:231]
ds_read_b128 v[0:3], v249 offset:56320
ds_read_b128 v[4:7], v254 offset:8064
v_mfma_f32_16x16x32_f16 v[60:63], v[224:227], v[180:183], v[228:231]
s_waitcnt lgkmcnt(0)
v_mfma_f32_16x16x32_f16 v[64:67], v[0:3], v[176:179], v[4:7]
ds_read_b128 v[224:227], v249 offset:56576
ds_read_b128 v[228:231], v254 offset:8080
v_mfma_f32_16x16x32_f16 v[72:75], v[0:3], v[180:183], v[4:7]
v_permlane16_swap_b32 v88, v92
s_waitcnt lgkmcnt(0)
v_mfma_f32_16x16x32_f16 v[68:71], v[224:227], v[176:179], v[228:231]
ds_read_b128 v[0:3], v249 offset:57344
ds_read_b128 v[4:7], v254 offset:16128
v_mfma_f32_16x16x32_f16 v[76:79], v[224:227], v[180:183], v[228:231]
v_permlane16_swap_b32 v89, v93
s_waitcnt lgkmcnt(0)
v_mfma_f32_16x16x32_f16 v[80:83], v[0:3], v[176:179], v[4:7]
ds_read_b128 v[224:227], v249 offset:57600
ds_read_b128 v[228:231], v254 offset:16144
v_permlane16_swap_b32 v90, v94
v_mfma_f32_16x16x32_f16 v[168:171], v[0:3], v[180:183], v[4:7]
s_waitcnt lgkmcnt(0)
v_mfma_f32_16x16x32_f16 v[84:87], v[224:227], v[176:179], v[228:231]
ds_read_b128 v[0:3], v249 offset:61440
ds_read_b128 v[4:7], v249 offset:61696
v_permlane16_swap_b32 v91, v95
v_mfma_f32_16x16x32_f16 v[172:175], v[224:227], v[180:183], v[228:231]
v_cvt_pk_bf16_f32 v136, v136, v137
v_cvt_pk_bf16_f32 v137, v138, v139
s_waitcnt lgkmcnt(1)
v_mfma_f32_16x16x32_f16 v[48:51], v[0:3], v[184:187], v[48:51]
ds_read_b128 v[224:227], v249 offset:62464
ds_read_b128 v[228:231], v249 offset:62720
v_cvt_pk_bf16_f32 v138, v140, v141
v_mfma_f32_16x16x32_f16 v[56:59], v[0:3], v[188:191], v[56:59]
v_cvt_pk_bf16_f32 v139, v142, v143
v_cvt_pk_bf16_f32 v120, v120, v121
s_waitcnt lgkmcnt(2)
v_mfma_f32_16x16x32_f16 v[52:55], v[4:7], v[184:187], v[52:55]
ds_read_b128 v[0:3], v249 offset:63488
v_cvt_pk_bf16_f32 v121, v122, v123
v_mfma_f32_16x16x32_f16 v[60:63], v[4:7], v[188:191], v[60:63]
v_cvt_pk_bf16_f32 v122, v124, v125
s_waitcnt lgkmcnt(2)
v_mfma_f32_16x16x32_f16 v[64:67], v[224:227], v[184:187], v[64:67]
ds_read_b128 v[4:7], v249 offset:63744
v_cvt_pk_bf16_f32 v123, v126, v127
v_cvt_pk_bf16_f32 v152, v152, v153
v_mfma_f32_16x16x32_f16 v[72:75], v[224:227], v[188:191], v[72:75]
v_cvt_pk_bf16_f32 v153, v154, v155
s_waitcnt lgkmcnt(2)
v_mfma_f32_16x16x32_f16 v[68:71], v[228:231], v[184:187], v[68:71]
ds_read_b128 v[224:227], v250 offset:2048
v_cvt_pk_bf16_f32 v154, v156, v157
v_mfma_f32_16x16x32_f16 v[76:79], v[228:231], v[188:191], v[76:79]
v_cvt_pk_bf16_f32 v155, v158, v159
s_mov_b64 vcc, s[74:75]
v_cndmask_b32 v140, v120, v152, vcc
s_waitcnt lgkmcnt(2)
v_mfma_f32_16x16x32_f16 v[80:83], v[0:3], v[184:187], v[80:83]
ds_read_b128 v[228:231], v250 offset:2304
v_cndmask_b32 v141, v121, v153, vcc
v_mfma_f32_16x16x32_f16 v[168:171], v[0:3], v[188:191], v[168:171]
v_cndmask_b32 v142, v122, v154, vcc
s_waitcnt lgkmcnt(2)
v_mfma_f32_16x16x32_f16 v[84:87], v[4:7], v[184:187], v[84:87]
ds_read_b128 v[0:3], v248 offset:16384
v_cndmask_b32 v143, v123, v155, vcc
v_cndmask_b32_dpp v120, v136, v120, vcc quad_perm:[1,0,3,2] row_mask:0xf bank_mask:0xf
v_mfma_f32_16x16x32_f16 v[172:175], v[4:7], v[188:191], v[172:175]
v_cndmask_b32_dpp v121, v137, v121, vcc quad_perm:[1,0,3,2] row_mask:0xf bank_mask:0xf
s_waitcnt vmcnt(3)
v_mfma_f32_16x16x32_bf16 v[144:147], v[26:29], v[8:11], v[144:147]
ds_read_b128 v[4:7], v250 offset:3072
v_cndmask_b32_dpp v122, v138, v122, vcc quad_perm:[1,0,3,2] row_mask:0xf bank_mask:0xf
v_mfma_f32_16x16x32_bf16 v[148:151], v[24:27], v[8:11], v[148:151]
v_cndmask_b32_dpp v123, v139, v123, vcc quad_perm:[1,0,3,2] row_mask:0xf bank_mask:0xf
s_not_b64 vcc, s[74:75]
v_cndmask_b32_dpp v152, v136, v152, vcc quad_perm:[1,0,3,2] row_mask:0xf bank_mask:0xf
s_waitcnt vmcnt(2)
v_mfma_f32_16x16x32_bf16 v[160:163], v[26:29], v[12:15], v[160:163]
v_cndmask_b32_dpp v153, v137, v153, vcc quad_perm:[1,0,3,2] row_mask:0xf bank_mask:0xf
v_mfma_f32_16x16x32_bf16 v[164:167], v[24:27], v[12:15], v[164:167]
v_cndmask_b32_dpp v154, v138, v154, vcc quad_perm:[1,0,3,2] row_mask:0xf bank_mask:0xf
v_cndmask_b32_dpp v155, v139, v155, vcc quad_perm:[1,0,3,2] row_mask:0xf bank_mask:0xf
s_waitcnt lgkmcnt(2)
v_mfma_f32_16x16x32_f16 v[48:51], v[224:227], v[192:195], v[48:51]
buffer_load_dwordx4 v[8:11], v252, s[4:7], s70 offen offset:128
buffer_store_dwordx4 v[120:123], v255, s[8:11], s71 offen sc1
v_mfma_f32_16x16x32_f16 v[56:59], v[224:227], v[196:199], v[56:59]
v_mfma_f32_16x16x32_f16 v[52:55], v[228:231], v[192:195], v[52:55]
ds_read_b128 v[224:227], v250 offset:3328
v_permlane16_swap_b32 v240, v244
v_mfma_f32_16x16x32_f16 v[60:63], v[228:231], v[196:199], v[60:63]
s_waitcnt lgkmcnt(2)
v_mfma_f32_16x16x32_bf16 v[176:179], v[0:3], v[96:99], 0
ds_read_b128 v[228:231], v250 offset:4096
v_permlane16_swap_b32 v241, v245
v_mfma_f32_16x16x32_bf16 v[184:187], v[0:3], v[100:103], 0
s_waitcnt lgkmcnt(2)
v_mfma_f32_16x16x32_f16 v[64:67], v[4:7], v[192:195], v[64:67]
ds_read_b128 v[0:3], v250 offset:4352
v_mfma_f32_16x16x32_f16 v[72:75], v[4:7], v[196:199], v[72:75]
v_permlane16_swap_b32 v242, v246
s_waitcnt lgkmcnt(2)
v_mfma_f32_16x16x32_f16 v[68:71], v[224:227], v[192:195], v[68:71]
ds_read_b128 v[4:7], v248 offset:16640
v_mfma_f32_16x16x32_f16 v[76:79], v[224:227], v[196:199], v[76:79]
v_permlane16_swap_b32 v243, v247
s_waitcnt lgkmcnt(2)
v_mfma_f32_16x16x32_f16 v[80:83], v[228:231], v[192:195], v[80:83]
s_add_u32 s46, s70, 98304
buffer_load_dwordx4 v[12:15], v252, s[4:7], s46 offen
ds_read_b128 v[224:227], v250 offset:8192
v_mfma_f32_16x16x32_f16 v[168:171], v[228:231], v[196:199], v[168:171]
s_waitcnt lgkmcnt(2)
v_mfma_f32_16x16x32_f16 v[84:87], v[0:3], v[192:195], v[84:87]
ds_read_b128 v[228:231], v250 offset:8448
v_permlane16_swap_b32 v232, v236
v_mfma_f32_16x16x32_f16 v[172:175], v[0:3], v[196:199], v[172:175]
s_waitcnt lgkmcnt(2)
v_mfma_f32_16x16x32_bf16 v[180:183], v[4:7], v[96:99], 0
ds_read_b128 v[0:3], v250 offset:9216
v_permlane16_swap_b32 v233, v237
v_mfma_f32_16x16x32_bf16 v[188:191], v[4:7], v[100:103], 0
s_waitcnt lgkmcnt(2)
v_mfma_f32_16x16x32_f16 v[48:51], v[224:227], v[200:203], v[48:51]
ds_read_b128 v[4:7], v250 offset:9472
v_mfma_f32_16x16x32_f16 v[56:59], v[224:227], v[204:207], v[56:59]
v_permlane16_swap_b32 v234, v238
s_waitcnt lgkmcnt(2)
v_mfma_f32_16x16x32_f16 v[52:55], v[228:231], v[200:203], v[52:55]
ds_read_b128 v[224:227], v248 offset:17408
v_mfma_f32_16x16x32_f16 v[60:63], v[228:231], v[204:207], v[60:63]
v_permlane16_swap_b32 v235, v239
s_waitcnt lgkmcnt(2)
v_mfma_f32_16x16x32_f16 v[64:67], v[0:3], v[200:203], v[64:67]
buffer_store_dwordx4 v[140:143], v255, s[8:11], s71 offen offset:128 sc1
ds_read_b128 v[228:231], v250 offset:10240
v_mfma_f32_16x16x32_f16 v[72:75], v[0:3], v[204:207], v[72:75]
s_waitcnt lgkmcnt(2)
v_mfma_f32_16x16x32_f16 v[68:71], v[4:7], v[200:203], v[68:71]
ds_read_b128 v[0:3], v250 offset:10496
v_permlane16_swap_b32 v216, v220
v_mfma_f32_16x16x32_f16 v[76:79], v[4:7], v[204:207], v[76:79]
s_waitcnt lgkmcnt(2)
v_mfma_f32_16x16x32_bf16 v[176:179], v[224:227], v[104:107], v[176:179]
ds_read_b128 v[4:7], v250 offset:14336
v_permlane16_swap_b32 v217, v221
v_mfma_f32_16x16x32_bf16 v[184:187], v[224:227], v[108:111], v[184:187]
s_waitcnt lgkmcnt(2)
v_mfma_f32_16x16x32_f16 v[80:83], v[228:231], v[200:203], v[80:83]
ds_read_b128 v[224:227], v250 offset:14592
v_mfma_f32_16x16x32_f16 v[168:171], v[228:231], v[204:207], v[168:171]
v_permlane16_swap_b32 v218, v222
s_waitcnt lgkmcnt(2)
v_mfma_f32_16x16x32_f16 v[84:87], v[0:3], v[200:203], v[84:87]
ds_read_b128 v[228:231], v248 offset:17664
v_mfma_f32_16x16x32_f16 v[172:175], v[0:3], v[204:207], v[172:175]
v_permlane16_swap_b32 v219, v223
s_waitcnt lgkmcnt(2)
v_mfma_f32_16x16x32_f16 v[48:51], v[4:7], v[240:243], v[48:51]
buffer_store_dwordx4 v[152:155], v255, s[8:11], s71 offen offset:256 sc1
ds_read_b128 v[0:3], v250 offset:15360
v_mfma_f32_16x16x32_f16 v[56:59], v[4:7], v[244:247], v[56:59]
s_waitcnt lgkmcnt(2)
v_mfma_f32_16x16x32_f16 v[52:55], v[224:227], v[240:243], v[52:55]
ds_read_b128 v[4:7], v250 offset:15616
v_mfma_f32_16x16x32_f16 v[60:63], v[224:227], v[244:247], v[60:63]
s_waitcnt lgkmcnt(2)
v_mfma_f32_16x16x32_bf16 v[180:183], v[228:231], v[104:107], v[180:183]
ds_read_b128 v[224:227], v250 offset:16384
v_mfma_f32_16x16x32_bf16 v[188:191], v[228:231], v[108:111], v[188:191]
s_waitcnt lgkmcnt(2)
v_mfma_f32_16x16x32_f16 v[64:67], v[0:3], v[240:243], v[64:67]
ds_read_b128 v[228:231], v250 offset:16640
v_mfma_f32_16x16x32_f16 v[72:75], v[0:3], v[244:247], v[72:75]
s_waitcnt lgkmcnt(2)
v_mfma_f32_16x16x32_f16 v[68:71], v[4:7], v[240:243], v[68:71]
ds_read_b128 v[0:3], v248 offset:18432
v_mfma_f32_16x16x32_f16 v[76:79], v[4:7], v[244:247], v[76:79]
s_waitcnt lgkmcnt(2)
v_mfma_f32_16x16x32_f16 v[80:83], v[224:227], v[240:243], v[80:83]
ds_read_b128 v[4:7], v250 offset:20480
v_permlane16_swap_b32 v208, v212
v_mfma_f32_16x16x32_f16 v[168:171], v[224:227], v[244:247], v[168:171]
s_waitcnt lgkmcnt(2)
v_mfma_f32_16x16x32_f16 v[84:87], v[228:231], v[240:243], v[84:87]
ds_read_b128 v[224:227], v250 offset:20736
v_mfma_f32_16x16x32_f16 v[172:175], v[228:231], v[244:247], v[172:175]
s_waitcnt lgkmcnt(2)
v_mfma_f32_16x16x32_bf16 v[176:179], v[0:3], v[112:115], v[176:179]
ds_read_b128 v[228:231], v250 offset:21504
v_mfma_f32_16x16x32_bf16 v[184:187], v[0:3], v[116:119], v[184:187]
s_waitcnt lgkmcnt(2)
v_mfma_f32_16x16x32_f16 v[48:51], v[4:7], v[232:235], v[48:51]
ds_read_b128 v[0:3], v250 offset:21760
v_mfma_f32_16x16x32_f16 v[56:59], v[4:7], v[236:239], v[56:59]
s_waitcnt lgkmcnt(2)
v_mfma_f32_16x16x32_f16 v[52:55], v[224:227], v[232:235], v[52:55]
ds_read_b128 v[4:7], v248 offset:18688
v_mfma_f32_16x16x32_f16 v[60:63], v[224:227], v[236:239], v[60:63]
s_waitcnt lgkmcnt(2)
v_mfma_f32_16x16x32_f16 v[64:67], v[228:231], v[232:235], v[64:67]
ds_read_b128 v[224:227], v250 offset:22528
v_mfma_f32_16x16x32_f16 v[72:75], v[228:231], v[236:239], v[72:75]
v_permlane16_swap_b32 v209, v213
s_waitcnt lgkmcnt(2)
v_mfma_f32_16x16x32_f16 v[68:71], v[0:3], v[232:235], v[68:71]
ds_read_b128 v[228:231], v250 offset:22784
v_mfma_f32_16x16x32_f16 v[76:79], v[0:3], v[236:239], v[76:79]
s_waitcnt lgkmcnt(2)
v_mfma_f32_16x16x32_bf16 v[180:183], v[4:7], v[112:115], v[180:183]
ds_read_b128 v[0:3], v250 offset:26624
v_mfma_f32_16x16x32_bf16 v[188:191], v[4:7], v[116:119], v[188:191]
s_waitcnt lgkmcnt(2)
v_mfma_f32_16x16x32_f16 v[80:83], v[224:227], v[232:235], v[80:83]
ds_read_b128 v[4:7], v250 offset:26880
v_mfma_f32_16x16x32_f16 v[168:171], v[224:227], v[236:239], v[168:171]
s_waitcnt lgkmcnt(2)
v_mfma_f32_16x16x32_f16 v[84:87], v[228:231], v[232:235], v[84:87]
ds_read_b128 v[224:227], v250 offset:27648
v_mfma_f32_16x16x32_f16 v[172:175], v[228:231], v[236:239], v[172:175]
s_waitcnt lgkmcnt(2)
v_mfma_f32_16x16x32_f16 v[48:51], v[0:3], v[216:219], v[48:51]
ds_read_b128 v[228:231], v250 offset:27904
v_mfma_f32_16x16x32_f16 v[56:59], v[0:3], v[220:223], v[56:59]
v_permlane16_swap_b32 v210, v214
s_waitcnt lgkmcnt(2)
v_mfma_f32_16x16x32_f16 v[52:55], v[4:7], v[216:219], v[52:55]
ds_read_b128 v[0:3], v250 offset:28672
v_mfma_f32_16x16x32_f16 v[60:63], v[4:7], v[220:223], v[60:63]
s_waitcnt lgkmcnt(2)
v_mfma_f32_16x16x32_f16 v[64:67], v[224:227], v[216:219], v[64:67]
ds_read_b128 v[4:7], v250 offset:28928
v_mfma_f32_16x16x32_f16 v[72:75], v[224:227], v[220:223], v[72:75]
s_waitcnt lgkmcnt(2)
v_mfma_f32_16x16x32_f16 v[68:71], v[228:231], v[216:219], v[68:71]
ds_read_b128 v[224:227], v248 offset:22528
v_mfma_f32_16x16x32_f16 v[76:79], v[228:231], v[220:223], v[76:79]
s_waitcnt lgkmcnt(2)
v_mfma_f32_16x16x32_f16 v[80:83], v[0:3], v[216:219], v[80:83]
ds_read_b128 v[228:231], v248 offset:22784
v_mfma_f32_16x16x32_f16 v[168:171], v[0:3], v[220:223], v[168:171]
s_waitcnt lgkmcnt(2)
v_mfma_f32_16x16x32_f16 v[84:87], v[4:7], v[216:219], v[84:87]
ds_read_b128 v[0:3], v248 offset:23552
v_mfma_f32_16x16x32_f16 v[172:175], v[4:7], v[220:223], v[172:175]
v_permlane16_swap_b32 v211, v215
s_setprio 3
v_cvt_pkrtz_f16_f32 v193, v176, v177
v_cvt_pkrtz_f16_f32 v195, v178, v179
v_cvt_pkrtz_f16_f32 v197, v180, v181
v_cvt_pkrtz_f16_f32 v199, v182, v183
v_cvt_pkrtz_f16_f32 v201, v184, v185
v_cvt_pkrtz_f16_f32 v203, v186, v187
v_cvt_pk_f16_f32 v243, v188, v189
v_cvt_pk_f16_f32 v240, v190, v191
s_waitcnt lgkmcnt(2)
v_mfma_f32_16x16x32_bf16 v[176:179], v[224:227], v[96:99], 0
s_add_u32 s46, s70, 98304
buffer_load_dwordx4 v[216:219], v252, s[4:7], s46 offen offset:64
ds_read_b128 v[4:7], v248 offset:23808
v_mfma_f32_16x16x32_bf16 v[184:187], v[224:227], v[100:103], 0
v_pk_fma_f16 v242, v243, v243, s48
v_cvt_pk_bf16_f32 v144, v144, v145
v_and_b32 v193, s49, v193
v_cvt_pk_bf16_f32 v145, v146, v147
s_waitcnt lgkmcnt(2)
v_mfma_f32_16x16x32_bf16 v[180:183], v[228:231], v[96:99], 0
ds_read_b128 v[224:227], v248 offset:24576
v_and_b32_e64 v195, s49, v195
v_cvt_pk_bf16_f32 v146, v148, v149
v_pk_fma_f16 v207, v240, v240, s48
v_bfe_u32 v192, v193, 2, 14
v_cvt_pk_bf16_f32 v147, v150, v151
v_pk_mul_f16 v242, v243, v242
v_mfma_f32_16x16x32_bf16 v[188:191], v[228:231], v[100:103], 0
v_cvt_pk_bf16_f32 v128, v128, v129
v_bfe_u32 v194, v195, 2, 14
v_pk_mul_f16 v207, v240, v207
v_cvt_pk_bf16_f32 v129, v130, v131
v_lshrrev_b32 v193, 18, v193
v_cvt_pk_bf16_f32 v130, v132, v133
s_waitcnt lgkmcnt(2)
v_mfma_f32_16x16x32_bf16 v[176:179], v[0:3], v[104:107], v[176:179]
ds_read_b128 v[228:231], v248 offset:24832
ds_read_u16_d16 v192, v192
ds_read_u16_d16 v194, v194
ds_read_u16_d16_hi v193, v193
v_exp_f16_e64 v241, v242
v_cvt_pk_bf16_f32 v131, v134, v135
v_lshrrev_b32_e64 v195, 18, v195
v_cvt_pk_bf16_f32 v160, v160, v161
v_and_b32_e64 v197, s49, v197
v_mfma_f32_16x16x32_bf16 v[184:187], v[0:3], v[108:111], v[184:187]
v_cvt_pk_bf16_f32 v161, v162, v163
v_exp_f16_e64 v206, v207
v_cvt_pk_bf16_f32 v162, v164, v165
v_and_b32_e64 v199, s49, v199
v_cvt_pk_bf16_f32 v163, v166, v167
s_mov_b64 vcc, s[74:75]
s_waitcnt lgkmcnt(4)
v_mfma_f32_16x16x32_bf16 v[180:183], v[4:7], v[104:107], v[180:183]
s_add_u32 s46, s70, 98304
buffer_load_dwordx4 v[244:247], v252, s[4:7], s46 offen offset:128
ds_read_u16_d16_hi v195, v195
v_bfe_u32 v196, v197, 2, 14
v_exp_f16_sdwa v241, v242 dst_sel:WORD_1 dst_unused:UNUSED_PRESERVE src0_sel:WORD_1
v_cndmask_b32 v148, v128, v160, vcc
v_cndmask_b32 v149, v129, v161, vcc
v_bfe_u32 v198, v199, 2, 14
v_mfma_f32_16x16x32_bf16 v[188:191], v[4:7], v[108:111], v[188:191]
v_cndmask_b32 v150, v130, v162, vcc
v_lshrrev_b32 v197, 18, v197
v_lshrrev_b32 v199, 18, v199
v_cndmask_b32 v151, v131, v163, vcc
v_exp_f16_sdwa v206, v207 dst_sel:WORD_1 dst_unused:UNUSED_PRESERVE src0_sel:WORD_1
v_mfma_f32_16x16x32_bf16 v[176:179], v[224:227], v[112:115], v[176:179]
ds_read_u16_d16 v196, v196
ds_read_u16_d16 v198, v198
ds_read_u16_d16_hi v197, v197
ds_read_u16_d16_hi v199, v199
v_cndmask_b32_dpp v128, v144, v128, vcc quad_perm:[1,0,3,2] row_mask:0xf bank_mask:0xf
v_and_b32_e64 v201, s49, v201
v_cndmask_b32_dpp v129, v145, v129, vcc quad_perm:[1,0,3,2] row_mask:0xf bank_mask:0xf
v_and_b32_e64 v203, s49, v203
v_cndmask_b32_dpp v130, v146, v130, vcc quad_perm:[1,0,3,2] row_mask:0xf bank_mask:0xf
v_pk_add_f16 v241, v241, 1.0 op_sel_hi:[1,0]
v_mfma_f32_16x16x32_bf16 v[184:187], v[224:227], v[116:119], v[184:187]
v_cndmask_b32_dpp v131, v147, v131, vcc quad_perm:[1,0,3,2] row_mask:0xf bank_mask:0xf
s_not_b64 vcc, s[74:75]
v_bfe_u32 v200, v201, 2, 14
v_pk_add_f16 v206, v206, 1.0 op_sel_hi:[1,0]
v_cndmask_b32_dpp v160, v144, v160, vcc quad_perm:[1,0,3,2] row_mask:0xf bank_mask:0xf
v_bfe_u32 v202, v203, 2, 14
v_cndmask_b32_dpp v161, v145, v161, vcc quad_perm:[1,0,3,2] row_mask:0xf bank_mask:0xf
s_waitcnt lgkmcnt(4)
v_mfma_f32_16x16x32_bf16 v[180:183], v[228:231], v[112:115], v[180:183]
ds_read_b128 v[224:227], v249 offset:24576
ds_read_u16_d16 v200, v200
ds_read_u16_d16 v202, v202
v_rcp_f16_e64 v242, v241
v_cndmask_b32_dpp v162, v146, v162, vcc quad_perm:[1,0,3,2] row_mask:0xf bank_mask:0xf
v_lshrrev_b32_e64 v201, 18, v201
v_cndmask_b32_dpp v163, v147, v163, vcc quad_perm:[1,0,3,2] row_mask:0xf bank_mask:0xf
v_lshrrev_b32_e64 v203, 18, v203
v_mfma_f32_16x16x32_bf16 v[188:191], v[228:231], v[116:119], v[188:191]
v_rcp_f16_e64 v207, v206
v_rcp_f16_sdwa v242, v241 dst_sel:WORD_1 dst_unused:UNUSED_PRESERVE src0_sel:WORD_1
v_or_b32 v232, v192, v193
v_or_b32 v233, v194, v195
s_waitcnt lgkmcnt(3)
v_or_b32 v234, v196, v197
v_rcp_f16_sdwa v207, v206 dst_sel:WORD_1 dst_unused:UNUSED_PRESERVE src0_sel:WORD_1
v_or_b32_e64 v235, v198, v199
ds_read_u16_d16_hi v201, v201
s_add_u32 s46, s71, 98304
buffer_store_dwordx4 v[128:131], v255, s[8:11], s46 offen sc1
ds_read_u16_d16_hi v203, v203
s_waitcnt lgkmcnt(1)
v_or_b32 v236, v200, v201
s_waitcnt lgkmcnt(0)
v_or_b32 v237, v202, v203
v_pk_mul_f16 v238, v243, v242
v_pk_mul_f16 v239, v240, v207
v_mfma_f32_16x16x32_f16 v[48:51], v[224:227], v[232:235], v[48:51]
s_add_u32 s46, s71, 98304
buffer_store_dwordx4 v[148:151], v255, s[8:11], s46 offen offset:128 sc1
ds_read_b128 v[228:231], v249 offset:24832
ds_read_b128 v[0:3], v248 offset:28672
ds_read_b128 v[4:7], v249 offset:25600
ds_read_b128 v[40:43], v248 offset:28928
ds_read_b128 v[44:47], v249 offset:25856
v_cvt_pkrtz_f16_f32 v193, v176, v177
v_cvt_pkrtz_f16_f32 v195, v178, v179
v_mfma_f32_16x16x32_f16 v[56:59], v[224:227], v[236:239], v[56:59]
v_cvt_pkrtz_f16_f32 v197, v180, v181
v_cvt_pkrtz_f16_f32 v199, v182, v183
s_waitcnt lgkmcnt(4)
v_mfma_f32_16x16x32_f16 v[52:55], v[228:231], v[232:235], v[52:55]
ds_read_b128 v[224:227], v248 offset:29696
v_cvt_pkrtz_f16_f32 v201, v184, v185
v_cvt_pk_f16_f32 v243, v186, v187
v_cvt_pk_f16_f32 v240, v188, v189
v_mfma_f32_16x16x32_f16 v[60:63], v[228:231], v[236:239], v[60:63]
v_cvt_pk_f16_f32 v205, v190, v191
v_pk_fma_f16 v242, v243, v243, s48
s_waitcnt lgkmcnt(4)
v_mfma_f32_16x16x32_bf16 v[176:179], v[0:3], v[96:99], 0
ds_read_b128 v[228:231], v249 offset:26624
v_and_b32_e64 v193, s49, v193
v_pk_fma_f16 v207, v240, v240, s48
v_mfma_f32_16x16x32_bf16 v[184:187], v[0:3], v[100:103], 0
v_and_b32_e64 v195, s49, v195
v_pk_fma_f16 v204, v205, v205, s48
s_setprio 2
v_bfe_u32 v192, v193, 2, 14
s_waitcnt lgkmcnt(2)
v_mfma_f32_16x16x32_f16 v[64:67], v[4:7], v[232:235], v[64:67]
ds_read_b128 v[0:3], v249 offset:26880
ds_read_u16_d16 v192, v192
v_pk_mul_f16 v242, v243, v242
v_bfe_u32 v194, v195, 2, 14
v_mfma_f32_16x16x32_f16 v[72:75], v[4:7], v[236:239], v[72:75]
v_pk_mul_f16 v207, v240, v207
v_lshrrev_b32_e64 v193, 18, v193
v_mfma_f32_16x16x32_bf16 v[180:183], v[40:43], v[96:99], 0
ds_read_b128 v[4:7], v248 offset:29952
ds_read_u16_d16 v194, v194
ds_read_u16_d16_hi v193, v193
v_pk_mul_f16 v204, v205, v204
v_lshrrev_b32_e64 v195, 18, v195
v_mfma_f32_16x16x32_bf16 v[188:191], v[40:43], v[100:103], 0
v_exp_f16 v241, v242
v_and_b32 v197, s49, v197
v_mfma_f32_16x16x32_f16 v[68:71], v[44:47], v[232:235], v[68:71]
ds_read_b128 v[40:43], v248 offset:30720
ds_read_u16_d16_hi v195, v195
v_and_b32_e64 v199, s49, v199
v_mfma_f32_16x16x32_f16 v[76:79], v[44:47], v[236:239], v[76:79]
v_exp_f16 v206, v207
v_bfe_u32 v196, v197, 2, 14
v_bfe_u32 v198, v199, 2, 14
s_waitcnt lgkmcnt(7)
v_mfma_f32_16x16x32_bf16 v[176:179], v[224:227], v[104:107], v[176:179]
ds_read_b128 v[44:47], v248 offset:30976
ds_read_u16_d16 v196, v196
ds_read_u16_d16 v198, v198
v_exp_f16_e64 v203, v204
v_mfma_f32_16x16x32_bf16 v[184:187], v[224:227], v[108:111], v[184:187]
v_lshrrev_b32 v197, 18, v197
v_lshrrev_b32 v199, 18, v199
v_mfma_f32_16x16x32_f16 v[80:83], v[228:231], v[232:235], v[80:83]
ds_read_b128 v[224:227], v249 offset:30720
ds_read_u16_d16_hi v197, v197
ds_read_u16_d16_hi v199, v199
v_exp_f16_sdwa v241, v242 dst_sel:WORD_1 dst_unused:UNUSED_PRESERVE src0_sel:WORD_1
v_and_b32 v201, s49, v201
v_mfma_f32_16x16x32_f16 v[168:171], v[228:231], v[236:239], v[168:171]
v_bfe_u32 v200, v201, 2, 14
s_waitcnt lgkmcnt(8)
v_mfma_f32_16x16x32_f16 v[84:87], v[0:3], v[232:235], v[84:87]
ds_read_b128 v[228:231], v249 offset:30976
ds_read_u16_d16 v200, v200
v_exp_f16_sdwa v206, v207 dst_sel:WORD_1 dst_unused:UNUSED_PRESERVE src0_sel:WORD_1
v_lshrrev_b32_e64 v201, 18, v201
v_mfma_f32_16x16x32_f16 v[172:175], v[0:3], v[236:239], v[172:175]
v_exp_f16_sdwa v203, v204 dst_sel:WORD_1 dst_unused:UNUSED_PRESERVE src0_sel:WORD_1
v_pk_add_f16 v241, v241, 1.0 op_sel_hi:[1,0]
v_mfma_f32_16x16x32_bf16 v[180:183], v[4:7], v[104:107], v[180:183]
ds_read_b128 v[0:3], v248 offset:34816
ds_read_u16_d16_hi v201, v201
v_pk_add_f16 v206, v206, 1.0 op_sel_hi:[1,0]
v_pk_add_f16 v203, v203, 1.0 op_sel_hi:[1,0]
v_mfma_f32_16x16x32_bf16 v[188:191], v[4:7], v[108:111], v[188:191]
v_rcp_f16 v242, v241
s_waitcnt lgkmcnt(7)
v_mfma_f32_16x16x32_bf16 v[176:179], v[40:43], v[112:115], v[176:179]
ds_read_b128 v[4:7], v249 offset:31744
v_rcp_f16_e64 v207, v206
v_mfma_f32_16x16x32_bf16 v[184:187], v[40:43], v[116:119], v[184:187]
v_rcp_f16_e64 v204, v203
v_mfma_f32_16x16x32_bf16 v[180:183], v[44:47], v[112:115], v[180:183]
ds_read_b128 v[40:43], v248 offset:35072
v_rcp_f16_sdwa v242, v241 dst_sel:WORD_1 dst_unused:UNUSED_PRESERVE src0_sel:WORD_1
v_mfma_f32_16x16x32_bf16 v[188:191], v[44:47], v[116:119], v[188:191]
v_rcp_f16_sdwa v207, v206 dst_sel:WORD_1 dst_unused:UNUSED_PRESERVE src0_sel:WORD_1
v_or_b32 v232, v192, v193
v_or_b32 v233, v194, v195
s_waitcnt lgkmcnt(4)
v_or_b32 v234, v196, v197
v_rcp_f16_sdwa v204, v203 dst_sel:WORD_1 dst_unused:UNUSED_PRESERVE src0_sel:WORD_1
v_or_b32 v235, v198, v199
s_waitcnt lgkmcnt(2)
v_or_b32_e64 v236, v200, v201
v_pk_mul_f16 v237, v243, v242
v_pk_mul_f16 v238, v240, v207
v_pk_mul_f16 v239, v205, v204
v_mfma_f32_16x16x32_f16 v[48:51], v[224:227], v[232:235], v[48:51]
s_add_u32 s46, s71, 98304
buffer_store_dwordx4 v[160:163], v255, s[8:11], s46 offen offset:256 sc1
ds_read_b128 v[44:47], v249 offset:32000
v_cvt_pkrtz_f16_f32 v193, v176, v177
v_cvt_pkrtz_f16_f32 v195, v178, v179
v_mfma_f32_16x16x32_f16 v[56:59], v[224:227], v[236:239], v[56:59]
v_cvt_pkrtz_f16_f32 v197, v180, v181
v_cvt_pkrtz_f16_f32 v199, v182, v183
v_mfma_f32_16x16x32_f16 v[52:55], v[228:231], v[232:235], v[52:55]
ds_read_b128 v[224:227], v248 offset:35840
v_cvt_pkrtz_f16_f32 v201, v184, v185
v_cvt_pk_f16_f32 v243, v186, v187
v_mfma_f32_16x16x32_f16 v[60:63], v[228:231], v[236:239], v[60:63]
v_cvt_pk_f16_f32 v240, v188, v189
v_cvt_pk_f16_f32 v205, v190, v191
s_setprio 1
v_mfma_f32_16x16x32_bf16 v[176:179], v[0:3], v[96:99], 0
ds_read_b128 v[228:231], v249 offset:32768
v_pk_fma_f16 v242, v243, v243, s48
v_and_b32 v193, s49, v193
v_mfma_f32_16x16x32_bf16 v[184:187], v[0:3], v[100:103], 0
v_pk_fma_f16 v207, v240, v240, s48
v_and_b32 v195, s49, v195
s_waitcnt lgkmcnt(3)
v_mfma_f32_16x16x32_f16 v[64:67], v[4:7], v[232:235], v[64:67]
ds_read_b128 v[0:3], v249 offset:33024
v_pk_fma_f16 v204, v205, v205, s48
v_bfe_u32 v192, v193, 2, 14
v_pk_mul_f16 v242, v243, v242
v_mfma_f32_16x16x32_f16 v[72:75], v[4:7], v[236:239], v[72:75]
v_bfe_u32 v194, v195, 2, 14
v_pk_mul_f16 v207, v240, v207
s_waitcnt vmcnt(11)
v_mfma_f32_16x16x32_bf16 v[48:51], v[26:29], v[20:23], v[48:51]
ds_read_b128 v[4:7], v248 offset:36096
ds_read_u16_d16 v192, v192
ds_read_u16_d16 v194, v194
v_lshrrev_b32 v193, 18, v193
v_pk_mul_f16 v204, v205, v204
v_mfma_f32_16x16x32_bf16 v[52:55], v[24:27], v[20:23], v[52:55]
v_lshrrev_b32_e64 v195, 18, v195
v_mfma_f32_16x16x32_bf16 v[180:183], v[40:43], v[96:99], 0
ds_read_u16_d16_hi v193, v193
ds_read_u16_d16_hi v195, v195
v_exp_f16 v241, v242
v_and_b32 v197, s49, v197
v_mfma_f32_16x16x32_bf16 v[188:191], v[40:43], v[100:103], 0
v_and_b32 v199, s49, v199
s_waitcnt lgkmcnt(6)
v_mfma_f32_16x16x32_f16 v[68:71], v[44:47], v[232:235], v[68:71]
ds_read_b128 v[40:43], v248 offset:36864
v_exp_f16_e64 v206, v207
v_bfe_u32 v196, v197, 2, 14
v_mfma_f32_16x16x32_f16 v[76:79], v[44:47], v[236:239], v[76:79]
v_bfe_u32 v198, v199, 2, 14
v_exp_f16_e64 v203, v204
v_mfma_f32_16x16x32_bf16 v[176:179], v[224:227], v[104:107], v[176:179]
ds_read_b128 v[44:47], v248 offset:37120
ds_read_u16_d16 v196, v196
ds_read_u16_d16 v198, v198
v_lshrrev_b32 v197, 18, v197
v_lshrrev_b32 v199, 18, v199
v_mfma_f32_16x16x32_bf16 v[184:187], v[224:227], v[108:111], v[184:187]
v_exp_f16_sdwa v241, v242 dst_sel:WORD_1 dst_unused:UNUSED_PRESERVE src0_sel:WORD_1
v_mfma_f32_16x16x32_f16 v[80:83], v[228:231], v[232:235], v[80:83]
ds_read_b128 v[224:227], v249 offset:36864
ds_read_u16_d16_hi v197, v197
ds_read_u16_d16_hi v199, v199
v_and_b32 v201, s49, v201
v_bfe_u32 v200, v201, 2, 14
v_mfma_f32_16x16x32_f16 v[168:171], v[228:231], v[236:239], v[168:171]
v_exp_f16_sdwa v206, v207 dst_sel:WORD_1 dst_unused:UNUSED_PRESERVE src0_sel:WORD_1
s_waitcnt lgkmcnt(7)
v_mfma_f32_16x16x32_f16 v[84:87], v[0:3], v[232:235], v[84:87]
ds_read_b128 v[228:231], v249 offset:37120
ds_read_u16_d16 v200, v200
v_lshrrev_b32_e64 v201, 18, v201
v_mfma_f32_16x16x32_f16 v[172:175], v[0:3], v[236:239], v[172:175]
v_exp_f16_sdwa v203, v204 dst_sel:WORD_1 dst_unused:UNUSED_PRESERVE src0_sel:WORD_1
v_pk_add_f16 v241, v241, 1.0 op_sel_hi:[1,0]
v_pk_add_f16 v206, v206, 1.0 op_sel_hi:[1,0]
v_mfma_f32_16x16x32_bf16 v[180:183], v[4:7], v[104:107], v[180:183]
ds_read_b128 v[0:3], v248 offset:40960
ds_read_u16_d16_hi v201, v201
v_pk_add_f16 v203, v203, 1.0 op_sel_hi:[1,0]
v_mfma_f32_16x16x32_bf16 v[188:191], v[4:7], v[108:111], v[188:191]
v_rcp_f16_e64 v242, v241
s_setprio 0
s_waitcnt lgkmcnt(7)
v_mfma_f32_16x16x32_bf16 v[176:179], v[40:43], v[112:115], v[176:179]
ds_read_b128 v[4:7], v249 offset:37888
v_rcp_f16_e64 v207, v206
v_mfma_f32_16x16x32_bf16 v[184:187], v[40:43], v[116:119], v[184:187]
v_rcp_f16_e64 v204, v203
v_mfma_f32_16x16x32_bf16 v[180:183], v[44:47], v[112:115], v[180:183]
ds_read_b128 v[40:43], v248 offset:41216
v_rcp_f16_sdwa v242, v241 dst_sel:WORD_1 dst_unused:UNUSED_PRESERVE src0_sel:WORD_1
v_mfma_f32_16x16x32_bf16 v[188:191], v[44:47], v[116:119], v[188:191]
v_rcp_f16_sdwa v207, v206 dst_sel:WORD_1 dst_unused:UNUSED_PRESERVE src0_sel:WORD_1
v_or_b32 v232, v192, v193
v_or_b32 v233, v194, v195
s_waitcnt lgkmcnt(4)
v_or_b32 v234, v196, v197
v_rcp_f16_sdwa v204, v203 dst_sel:WORD_1 dst_unused:UNUSED_PRESERVE src0_sel:WORD_1
v_or_b32 v235, v198, v199
s_waitcnt lgkmcnt(2)
v_or_b32 v236, v200, v201
v_pk_mul_f16 v237, v243, v242
v_pk_mul_f16 v238, v240, v207
v_pk_mul_f16 v239, v205, v204
s_setprio 3
v_mfma_f32_16x16x32_f16 v[48:51], v[224:227], v[232:235], v[48:51]
ds_read_b128 v[44:47], v249 offset:38144
v_cvt_pkrtz_f16_f32 v193, v176, v177
v_cvt_pkrtz_f16_f32 v195, v178, v179
v_mfma_f32_16x16x32_f16 v[56:59], v[224:227], v[236:239], v[56:59]
v_cvt_pkrtz_f16_f32 v197, v180, v181
v_cvt_pkrtz_f16_f32 v199, v182, v183
v_mfma_f32_16x16x32_f16 v[52:55], v[228:231], v[232:235], v[52:55]
ds_read_b128 v[224:227], v248 offset:41984
v_cvt_pkrtz_f16_f32 v201, v184, v185
v_cvt_pk_f16_f32 v243, v186, v187
v_mfma_f32_16x16x32_f16 v[60:63], v[228:231], v[236:239], v[60:63]
v_cvt_pk_f16_f32 v240, v188, v189
v_cvt_pk_f16_f32 v205, v190, v191
v_mfma_f32_16x16x32_bf16 v[176:179], v[0:3], v[96:99], 0
ds_read_b128 v[228:231], v249 offset:38912
v_pk_fma_f16 v242, v243, v243, s48
v_and_b32_e64 v193, s49, v193
v_mfma_f32_16x16x32_bf16 v[184:187], v[0:3], v[100:103], 0
v_pk_fma_f16 v207, v240, v240, s48
v_and_b32 v195, s49, v195
s_waitcnt lgkmcnt(3)
v_mfma_f32_16x16x32_f16 v[64:67], v[4:7], v[232:235], v[64:67]
ds_read_b128 v[0:3], v249 offset:39168
v_pk_fma_f16 v204, v205, v205, s48
v_bfe_u32 v192, v193, 2, 14
v_pk_mul_f16 v242, v243, v242
v_mfma_f32_16x16x32_f16 v[72:75], v[4:7], v[236:239], v[72:75]
v_bfe_u32 v194, v195, 2, 14
v_pk_mul_f16 v207, v240, v207
s_waitcnt vmcnt(10)
v_mfma_f32_16x16x32_bf16 v[64:67], v[26:29], v[16:19], v[64:67]
ds_read_b128 v[4:7], v248 offset:42240
ds_read_u16_d16 v192, v192
ds_read_u16_d16 v194, v194
v_lshrrev_b32 v193, 18, v193
v_pk_mul_f16 v204, v205, v204
v_mfma_f32_16x16x32_bf16 v[68:71], v[24:27], v[16:19], v[68:71]
v_lshrrev_b32_e64 v195, 18, v195
v_mfma_f32_16x16x32_bf16 v[180:183], v[40:43], v[96:99], 0
ds_read_u16_d16_hi v193, v193
ds_read_u16_d16_hi v195, v195
v_exp_f16 v241, v242
v_and_b32 v197, s49, v197
v_mfma_f32_16x16x32_bf16 v[188:191], v[40:43], v[100:103], 0
v_and_b32 v199, s49, v199
s_waitcnt lgkmcnt(6)
v_mfma_f32_16x16x32_f16 v[68:71], v[44:47], v[232:235], v[68:71]
ds_read_b128 v[40:43], v248 offset:43008
v_exp_f16_e64 v206, v207
v_bfe_u32 v196, v197, 2, 14
v_mfma_f32_16x16x32_f16 v[76:79], v[44:47], v[236:239], v[76:79]
v_bfe_u32 v198, v199, 2, 14
v_exp_f16_e64 v203, v204
v_mfma_f32_16x16x32_bf16 v[176:179], v[224:227], v[104:107], v[176:179]
ds_read_b128 v[44:47], v248 offset:43264
ds_read_u16_d16 v196, v196
ds_read_u16_d16 v198, v198
v_lshrrev_b32 v197, 18, v197
v_lshrrev_b32 v199, 18, v199
v_mfma_f32_16x16x32_bf16 v[184:187], v[224:227], v[108:111], v[184:187]
v_exp_f16_sdwa v241, v242 dst_sel:WORD_1 dst_unused:UNUSED_PRESERVE src0_sel:WORD_1
v_mfma_f32_16x16x32_f16 v[80:83], v[228:231], v[232:235], v[80:83]
ds_read_b128 v[224:227], v249 offset:43008
ds_read_u16_d16_hi v197, v197
ds_read_u16_d16_hi v199, v199
v_and_b32 v201, s49, v201
v_bfe_u32 v200, v201, 2, 14
v_mfma_f32_16x16x32_f16 v[168:171], v[228:231], v[236:239], v[168:171]
v_exp_f16_sdwa v206, v207 dst_sel:WORD_1 dst_unused:UNUSED_PRESERVE src0_sel:WORD_1
s_waitcnt lgkmcnt(7)
v_mfma_f32_16x16x32_f16 v[84:87], v[0:3], v[232:235], v[84:87]
ds_read_b128 v[228:231], v249 offset:43264
ds_read_u16_d16 v200, v200
v_lshrrev_b32_e64 v201, 18, v201
v_mfma_f32_16x16x32_f16 v[172:175], v[0:3], v[236:239], v[172:175]
v_exp_f16_sdwa v203, v204 dst_sel:WORD_1 dst_unused:UNUSED_PRESERVE src0_sel:WORD_1
v_pk_add_f16 v241, v241, 1.0 op_sel_hi:[1,0]
v_pk_add_f16 v206, v206, 1.0 op_sel_hi:[1,0]
v_mfma_f32_16x16x32_bf16 v[180:183], v[4:7], v[104:107], v[180:183]
ds_read_b128 v[0:3], v248 offset:16384
ds_read_u16_d16_hi v201, v201
v_pk_add_f16 v203, v203, 1.0 op_sel_hi:[1,0]
v_mfma_f32_16x16x32_bf16 v[188:191], v[4:7], v[108:111], v[188:191]
v_rcp_f16 v242, v241
s_waitcnt lgkmcnt(7)
v_mfma_f32_16x16x32_bf16 v[176:179], v[40:43], v[112:115], v[176:179]
ds_read_b128 v[4:7], v249 offset:44032
v_rcp_f16_e64 v207, v206
v_mfma_f32_16x16x32_bf16 v[184:187], v[40:43], v[116:119], v[184:187]
v_rcp_f16_e64 v204, v203
v_mfma_f32_16x16x32_bf16 v[180:183], v[44:47], v[112:115], v[180:183]
ds_read_b128 v[40:43], v248 offset:16640
v_rcp_f16_sdwa v242, v241 dst_sel:WORD_1 dst_unused:UNUSED_PRESERVE src0_sel:WORD_1
v_mfma_f32_16x16x32_bf16 v[188:191], v[44:47], v[116:119], v[188:191]
v_rcp_f16_sdwa v207, v206 dst_sel:WORD_1 dst_unused:UNUSED_PRESERVE src0_sel:WORD_1
v_or_b32 v232, v192, v193
v_or_b32 v233, v194, v195
s_waitcnt lgkmcnt(4)
v_or_b32 v234, v196, v197
v_rcp_f16_sdwa v204, v203 dst_sel:WORD_1 dst_unused:UNUSED_PRESERVE src0_sel:WORD_1
v_or_b32 v235, v198, v199
s_waitcnt lgkmcnt(2)
v_or_b32_e64 v236, v200, v201
v_pk_mul_f16 v237, v243, v242
v_pk_mul_f16 v238, v240, v207
v_pk_mul_f16 v239, v205, v204
v_mfma_f32_16x16x32_f16 v[48:51], v[224:227], v[232:235], v[48:51]
s_add_u32 s46, s80, 12582912
buffer_load_dwordx4 v[96:99], v253, s[32:35], s46 offen nt
ds_read_b128 v[44:47], v249 offset:44288
v_cvt_pkrtz_f16_f32 v193, v176, v177
v_cvt_pkrtz_f16_f32 v195, v178, v179
v_mfma_f32_16x16x32_f16 v[56:59], v[224:227], v[236:239], v[56:59]
v_cvt_pkrtz_f16_f32 v197, v180, v181
v_cvt_pkrtz_f16_f32 v199, v182, v183
v_mfma_f32_16x16x32_f16 v[52:55], v[228:231], v[232:235], v[52:55]
ds_read_b128 v[224:227], v248 offset:17408
v_cvt_pkrtz_f16_f32 v201, v184, v185
v_cvt_pk_f16_f32 v243, v186, v187
v_mfma_f32_16x16x32_f16 v[60:63], v[228:231], v[236:239], v[60:63]
v_cvt_pk_f16_f32 v240, v188, v189
v_cvt_pk_f16_f32 v205, v190, v191
v_mfma_f32_16x16x32_bf16 v[176:179], v[0:3], v[88:91], 0
ds_read_b128 v[228:231], v249 offset:45056
v_pk_fma_f16 v242, v243, v243, s48
v_and_b32_e64 v193, s49, v193
v_mfma_f32_16x16x32_bf16 v[184:187], v[0:3], v[92:95], 0
v_pk_fma_f16 v207, v240, v240, s48
v_and_b32 v195, s49, v195
s_waitcnt lgkmcnt(3)
v_mfma_f32_16x16x32_f16 v[64:67], v[4:7], v[232:235], v[64:67]
ds_read_b128 v[0:3], v249 offset:45312
v_pk_fma_f16 v204, v205, v205, s48
s_setprio 2
v_bfe_u32 v192, v193, 2, 14
v_pk_mul_f16 v242, v243, v242
v_mfma_f32_16x16x32_f16 v[72:75], v[4:7], v[236:239], v[72:75]
v_bfe_u32 v194, v195, 2, 14
v_pk_mul_f16 v207, v240, v207
s_waitcnt vmcnt(10)
v_mfma_f32_16x16x32_bf16 v[80:83], v[26:29], v[8:11], v[80:83]
ds_read_b128 v[4:7], v248 offset:17664
ds_read_u16_d16 v192, v192
ds_read_u16_d16 v194, v194
v_lshrrev_b32_e64 v193, 18, v193
v_pk_mul_f16 v204, v205, v204
v_mfma_f32_16x16x32_bf16 v[84:87], v[24:27], v[8:11], v[84:87]
v_lshrrev_b32_e64 v195, 18, v195
v_mfma_f32_16x16x32_bf16 v[180:183], v[40:43], v[88:91], 0
ds_read_u16_d16_hi v193, v193
ds_read_u16_d16_hi v195, v195
v_exp_f16 v241, v242
v_and_b32 v197, s49, v197
v_mfma_f32_16x16x32_bf16 v[188:191], v[40:43], v[92:95], 0
v_and_b32 v199, s49, v199
s_waitcnt lgkmcnt(6)
v_mfma_f32_16x16x32_f16 v[68:71], v[44:47], v[232:235], v[68:71]
ds_read_b128 v[40:43], v248 offset:18432
v_exp_f16_e64 v206, v207
v_bfe_u32 v196, v197, 2, 14
v_mfma_f32_16x16x32_f16 v[76:79], v[44:47], v[236:239], v[76:79]
v_bfe_u32 v198, v199, 2, 14
v_exp_f16_e64 v203, v204
v_mfma_f32_16x16x32_bf16 v[176:179], v[224:227], v[208:211], v[176:179]
ds_read_b128 v[44:47], v248 offset:18688
ds_read_u16_d16 v196, v196
ds_read_u16_d16 v198, v198
v_lshrrev_b32 v197, 18, v197
v_lshrrev_b32 v199, 18, v199
v_mfma_f32_16x16x32_bf16 v[184:187], v[224:227], v[212:215], v[184:187]
v_exp_f16_sdwa v241, v242 dst_sel:WORD_1 dst_unused:UNUSED_PRESERVE src0_sel:WORD_1
v_mfma_f32_16x16x32_f16 v[80:83], v[228:231], v[232:235], v[80:83]
ds_read_b128 v[224:227], v249 offset:49152
ds_read_u16_d16_hi v197, v197
ds_read_u16_d16_hi v199, v199
v_and_b32 v201, s49, v201
v_bfe_u32 v200, v201, 2, 14
v_mfma_f32_16x16x32_f16 v[168:171], v[228:231], v[236:239], v[168:171]
v_exp_f16_sdwa v206, v207 dst_sel:WORD_1 dst_unused:UNUSED_PRESERVE src0_sel:WORD_1
s_waitcnt lgkmcnt(7)
v_mfma_f32_16x16x32_f16 v[84:87], v[0:3], v[232:235], v[84:87]
ds_read_b128 v[228:231], v249 offset:49408
ds_read_u16_d16 v200, v200
v_lshrrev_b32_e64 v201, 18, v201
v_mfma_f32_16x16x32_f16 v[172:175], v[0:3], v[236:239], v[172:175]
v_exp_f16_sdwa v203, v204 dst_sel:WORD_1 dst_unused:UNUSED_PRESERVE src0_sel:WORD_1
v_pk_add_f16 v241, v241, 1.0 op_sel_hi:[1,0]
v_pk_add_f16 v206, v206, 1.0 op_sel_hi:[1,0]
v_mfma_f32_16x16x32_bf16 v[180:183], v[4:7], v[208:211], v[180:183]
ds_read_b128 v[0:3], v248 offset:22528
ds_read_u16_d16_hi v201, v201
v_pk_add_f16 v203, v203, 1.0 op_sel_hi:[1,0]
v_mfma_f32_16x16x32_bf16 v[188:191], v[4:7], v[212:215], v[188:191]
v_rcp_f16 v242, v241
s_waitcnt lgkmcnt(7)
v_mfma_f32_16x16x32_bf16 v[176:179], v[40:43], v[32:35], v[176:179]
ds_read_b128 v[4:7], v249 offset:50176
v_rcp_f16_e64 v207, v206
v_mfma_f32_16x16x32_bf16 v[184:187], v[40:43], v[36:39], v[184:187]
v_rcp_f16_e64 v204, v203
v_mfma_f32_16x16x32_bf16 v[180:183], v[44:47], v[32:35], v[180:183]
ds_read_b128 v[40:43], v248 offset:22784
v_rcp_f16_sdwa v242, v241 dst_sel:WORD_1 dst_unused:UNUSED_PRESERVE src0_sel:WORD_1
v_mfma_f32_16x16x32_bf16 v[188:191], v[44:47], v[36:39], v[188:191]
v_rcp_f16_sdwa v207, v206 dst_sel:WORD_1 dst_unused:UNUSED_PRESERVE src0_sel:WORD_1
v_or_b32 v232, v192, v193
v_or_b32 v233, v194, v195
s_waitcnt lgkmcnt(4)
v_or_b32 v234, v196, v197
v_rcp_f16_sdwa v204, v203 dst_sel:WORD_1 dst_unused:UNUSED_PRESERVE src0_sel:WORD_1
v_or_b32 v235, v198, v199
s_waitcnt lgkmcnt(2)
v_or_b32_e64 v236, v200, v201
v_pk_mul_f16 v237, v243, v242
v_pk_mul_f16 v238, v240, v207
v_pk_mul_f16 v239, v205, v204
v_mfma_f32_16x16x32_f16 v[48:51], v[224:227], v[232:235], v[48:51]
s_add_u32 s46, s80, 12582912
buffer_load_dwordx4 v[100:103], v253, s[32:35], s46 offen offset:256 nt
ds_read_b128 v[44:47], v249 offset:50432
v_cvt_pkrtz_f16_f32 v193, v176, v177
v_cvt_pkrtz_f16_f32 v195, v178, v179
v_mfma_f32_16x16x32_f16 v[56:59], v[224:227], v[236:239], v[56:59]
v_cvt_pkrtz_f16_f32 v197, v180, v181
v_cvt_pkrtz_f16_f32 v199, v182, v183
v_mfma_f32_16x16x32_f16 v[52:55], v[228:231], v[232:235], v[52:55]
ds_read_b128 v[224:227], v248 offset:23552
v_cvt_pkrtz_f16_f32 v201, v184, v185
v_cvt_pk_f16_f32 v243, v186, v187
v_mfma_f32_16x16x32_f16 v[60:63], v[228:231], v[236:239], v[60:63]
v_cvt_pk_f16_f32 v240, v188, v189
v_cvt_pk_f16_f32 v205, v190, v191
s_setprio 1
v_mfma_f32_16x16x32_bf16 v[176:179], v[0:3], v[88:91], 0
ds_read_b128 v[228:231], v249 offset:51200
v_pk_fma_f16 v242, v243, v243, s48
v_and_b32 v193, s49, v193
v_mfma_f32_16x16x32_bf16 v[184:187], v[0:3], v[92:95], 0
v_pk_fma_f16 v207, v240, v240, s48
v_and_b32 v195, s49, v195
s_waitcnt lgkmcnt(3)
v_mfma_f32_16x16x32_f16 v[64:67], v[4:7], v[232:235], v[64:67]
ds_read_b128 v[0:3], v249 offset:51456
v_pk_fma_f16 v204, v205, v205, s48
v_bfe_u32 v192, v193, 2, 14
v_pk_mul_f16 v242, v243, v242
v_mfma_f32_16x16x32_f16 v[72:75], v[4:7], v[236:239], v[72:75]
v_bfe_u32 v194, v195, 2, 14
v_pk_mul_f16 v207, v240, v207
s_waitcnt vmcnt(9)
v_mfma_f32_16x16x32_bf16 v[56:59], v[26:29], v[12:15], v[56:59]
ds_read_b128 v[4:7], v248 offset:23808
ds_read_u16_d16 v192, v192
ds_read_u16_d16 v194, v194
v_lshrrev_b32 v193, 18, v193
v_pk_mul_f16 v204, v205, v204
v_mfma_f32_16x16x32_bf16 v[60:63], v[24:27], v[12:15], v[60:63]
v_lshrrev_b32_e64 v195, 18, v195
v_mfma_f32_16x16x32_bf16 v[180:183], v[40:43], v[88:91], 0
ds_read_u16_d16_hi v193, v193
ds_read_u16_d16_hi v195, v195
v_exp_f16 v241, v242
v_and_b32 v197, s49, v197
v_mfma_f32_16x16x32_bf16 v[188:191], v[40:43], v[92:95], 0
v_and_b32 v199, s49, v199
s_waitcnt lgkmcnt(6)
v_mfma_f32_16x16x32_f16 v[68:71], v[44:47], v[232:235], v[68:71]
ds_read_b128 v[40:43], v248 offset:24576
v_exp_f16_e64 v206, v207
v_bfe_u32 v196, v197, 2, 14
v_mfma_f32_16x16x32_f16 v[76:79], v[44:47], v[236:239], v[76:79]
v_bfe_u32 v198, v199, 2, 14
v_exp_f16_e64 v203, v204
v_mfma_f32_16x16x32_bf16 v[176:179], v[224:227], v[208:211], v[176:179]
ds_read_b128 v[44:47], v248 offset:24832
ds_read_u16_d16 v196, v196
ds_read_u16_d16 v198, v198
v_lshrrev_b32 v197, 18, v197
v_lshrrev_b32 v199, 18, v199
v_mfma_f32_16x16x32_bf16 v[184:187], v[224:227], v[212:215], v[184:187]
v_exp_f16_sdwa v241, v242 dst_sel:WORD_1 dst_unused:UNUSED_PRESERVE src0_sel:WORD_1
v_mfma_f32_16x16x32_f16 v[80:83], v[228:231], v[232:235], v[80:83]
ds_read_b128 v[224:227], v249 offset:24576
ds_read_u16_d16_hi v197, v197
ds_read_u16_d16_hi v199, v199
v_and_b32 v201, s49, v201
v_bfe_u32 v200, v201, 2, 14
v_mfma_f32_16x16x32_f16 v[168:171], v[228:231], v[236:239], v[168:171]
v_exp_f16_sdwa v206, v207 dst_sel:WORD_1 dst_unused:UNUSED_PRESERVE src0_sel:WORD_1
s_waitcnt lgkmcnt(7)
v_mfma_f32_16x16x32_f16 v[84:87], v[0:3], v[232:235], v[84:87]
ds_read_b128 v[228:231], v254 offset:7936
ds_read_u16_d16 v200, v200
v_lshrrev_b32_e64 v201, 18, v201
v_mfma_f32_16x16x32_f16 v[172:175], v[0:3], v[236:239], v[172:175]
v_exp_f16_sdwa v203, v204 dst_sel:WORD_1 dst_unused:UNUSED_PRESERVE src0_sel:WORD_1
v_pk_add_f16 v241, v241, 1.0 op_sel_hi:[1,0]
v_pk_add_f16 v206, v206, 1.0 op_sel_hi:[1,0]
v_mfma_f32_16x16x32_bf16 v[180:183], v[4:7], v[208:211], v[180:183]
ds_read_b128 v[0:3], v249 offset:24832
ds_read_u16_d16_hi v201, v201
v_pk_add_f16 v203, v203, 1.0 op_sel_hi:[1,0]
v_mfma_f32_16x16x32_bf16 v[188:191], v[4:7], v[212:215], v[188:191]
v_rcp_f16_e64 v242, v241
s_setprio 0
s_waitcnt lgkmcnt(7)
v_mfma_f32_16x16x32_bf16 v[176:179], v[40:43], v[32:35], v[176:179]
ds_read_b128 v[4:7], v254 offset:7952
v_rcp_f16_e64 v207, v206
v_mfma_f32_16x16x32_bf16 v[184:187], v[40:43], v[36:39], v[184:187]
v_rcp_f16_e64 v204, v203
v_mfma_f32_16x16x32_bf16 v[180:183], v[44:47], v[32:35], v[180:183]
ds_read_b128 v[40:43], v248 offset:28672
v_rcp_f16_sdwa v242, v241 dst_sel:WORD_1 dst_unused:UNUSED_PRESERVE src0_sel:WORD_1
v_mfma_f32_16x16x32_bf16 v[188:191], v[44:47], v[36:39], v[188:191]
v_rcp_f16_sdwa v207, v206 dst_sel:WORD_1 dst_unused:UNUSED_PRESERVE src0_sel:WORD_1
v_or_b32 v232, v192, v193
v_or_b32 v233, v194, v195
s_waitcnt lgkmcnt(4)
v_or_b32 v234, v196, v197
v_rcp_f16_sdwa v204, v203 dst_sel:WORD_1 dst_unused:UNUSED_PRESERVE src0_sel:WORD_1
v_or_b32 v235, v198, v199
s_waitcnt lgkmcnt(2)
v_or_b32_e64 v236, v200, v201
v_pk_mul_f16 v237, v243, v242
v_pk_mul_f16 v238, v240, v207
v_pk_mul_f16 v239, v205, v204
s_setprio 3
v_mfma_f32_16x16x32_f16 v[120:123], v[224:227], v[232:235], v[228:231]
s_add_u32 s46, s80, 16777216
buffer_load_dwordx4 v[104:107], v253, s[32:35], s46 offen nt
ds_read_b128 v[44:47], v249 offset:25600
v_cvt_pkrtz_f16_f32 v193, v176, v177
v_cvt_pkrtz_f16_f32 v195, v178, v179
v_mfma_f32_16x16x32_f16 v[128:131], v[224:227], v[236:239], v[228:231]
v_cvt_pkrtz_f16_f32 v197, v180, v181
v_cvt_pkrtz_f16_f32 v199, v182, v183
s_waitcnt lgkmcnt(1)
v_mfma_f32_16x16x32_f16 v[124:127], v[0:3], v[232:235], v[4:7]
ds_read_b128 v[224:227], v254 offset:8064
ds_read_b128 v[228:231], v248 offset:28928
v_cvt_pkrtz_f16_f32 v201, v184, v185
v_cvt_pk_f16_f32 v243, v186, v187
v_mfma_f32_16x16x32_f16 v[132:135], v[0:3], v[236:239], v[4:7]
v_cvt_pk_f16_f32 v240, v188, v189
v_cvt_pk_f16_f32 v205, v190, v191
v_mfma_f32_16x16x32_bf16 v[176:179], v[40:43], v[88:91], 0
ds_read_b128 v[0:3], v249 offset:25856
ds_read_b128 v[4:7], v254 offset:8080
v_pk_fma_f16 v242, v243, v243, s48
v_and_b32_e64 v193, s49, v193
v_mfma_f32_16x16x32_bf16 v[184:187], v[40:43], v[92:95], 0
v_pk_fma_f16 v207, v240, v240, s48
v_and_b32 v195, s49, v195
s_waitcnt lgkmcnt(3)
v_mfma_f32_16x16x32_f16 v[136:139], v[44:47], v[232:235], v[224:227]
ds_read_b128 v[40:43], v248 offset:29696
v_pk_fma_f16 v204, v205, v205, s48
v_bfe_u32 v192, v193, 2, 14
v_pk_mul_f16 v242, v243, v242
v_mfma_f32_16x16x32_f16 v[144:147], v[44:47], v[236:239], v[224:227]
v_bfe_u32 v194, v195, 2, 14
v_pk_mul_f16 v207, v240, v207
s_waitcnt vmcnt(7)
v_mfma_f32_16x16x32_bf16 v[72:75], v[26:29], v[216:219], v[72:75]
ds_read_b128 v[44:47], v249 offset:26624
ds_read_b128 v[224:227], v254 offset:16128
ds_read_u16_d16 v192, v192
ds_read_u16_d16 v194, v194
v_lshrrev_b32 v193, 18, v193
v_pk_mul_f16 v204, v205, v204
v_mfma_f32_16x16x32_bf16 v[76:79], v[24:27], v[216:219], v[76:79]
v_lshrrev_b32 v195, 18, v195
s_waitcnt lgkmcnt(5)
v_mfma_f32_16x16x32_bf16 v[180:183], v[228:231], v[88:91], 0
ds_read_u16_d16_hi v193, v193
ds_read_u16_d16_hi v195, v195
v_exp_f16 v241, v242
v_and_b32 v197, s49, v197
v_mfma_f32_16x16x32_bf16 v[188:191], v[228:231], v[92:95], 0
v_and_b32_e64 v199, s49, v199
v_mfma_f32_16x16x32_f16 v[140:143], v[0:3], v[232:235], v[4:7]
ds_read_b128 v[228:231], v249 offset:26880
v_exp_f16_e64 v206, v207
v_bfe_u32 v196, v197, 2, 14
v_mfma_f32_16x16x32_f16 v[148:151], v[0:3], v[236:239], v[4:7]
v_bfe_u32 v198, v199, 2, 14
v_exp_f16 v203, v204
s_waitcnt lgkmcnt(7)
v_mfma_f32_16x16x32_bf16 v[176:179], v[40:43], v[208:211], v[176:179]
ds_read_b128 v[0:3], v254 offset:16144
ds_read_b128 v[4:7], v248 offset:29952
ds_read_u16_d16 v196, v196
ds_read_u16_d16 v198, v198
v_lshrrev_b32_e64 v197, 18, v197
v_lshrrev_b32 v199, 18, v199
v_mfma_f32_16x16x32_bf16 v[184:187], v[40:43], v[212:215], v[184:187]
v_exp_f16_sdwa v241, v242 dst_sel:WORD_1 dst_unused:UNUSED_PRESERVE src0_sel:WORD_1
s_waitcnt lgkmcnt(7)
v_mfma_f32_16x16x32_f16 v[152:155], v[44:47], v[232:235], v[224:227]
ds_read_b128 v[40:43], v248 offset:30720
ds_read_u16_d16_hi v197, v197
ds_read_u16_d16_hi v199, v199
v_and_b32 v201, s49, v201
v_bfe_u32 v200, v201, 2, 14
v_mfma_f32_16x16x32_f16 v[160:163], v[44:47], v[236:239], v[224:227]
v_exp_f16_sdwa v206, v207 dst_sel:WORD_1 dst_unused:UNUSED_PRESERVE src0_sel:WORD_1
s_waitcnt lgkmcnt(6)
v_mfma_f32_16x16x32_f16 v[156:159], v[228:231], v[232:235], v[0:3]
ds_read_b128 v[44:47], v248 offset:30976
ds_read_b128 v[224:227], v249 offset:30720
ds_read_u16_d16 v200, v200
v_lshrrev_b32 v201, 18, v201
v_mfma_f32_16x16x32_f16 v[164:167], v[228:231], v[236:239], v[0:3]
v_exp_f16_sdwa v203, v204 dst_sel:WORD_1 dst_unused:UNUSED_PRESERVE src0_sel:WORD_1
v_pk_add_f16 v241, v241, 1.0 op_sel_hi:[1,0]
v_pk_add_f16 v206, v206, 1.0 op_sel_hi:[1,0]
s_waitcnt lgkmcnt(7)
v_mfma_f32_16x16x32_bf16 v[180:183], v[4:7], v[208:211], v[180:183]
ds_read_b128 v[228:231], v249 offset:30976
ds_read_b128 v[0:3], v248 offset:40960
ds_read_u16_d16_hi v201, v201
v_pk_add_f16 v203, v203, 1.0 op_sel_hi:[1,0]
v_mfma_f32_16x16x32_bf16 v[188:191], v[4:7], v[212:215], v[188:191]
v_rcp_f16 v242, v241
s_waitcnt lgkmcnt(8)
v_mfma_f32_16x16x32_bf16 v[176:179], v[40:43], v[32:35], v[176:179]
ds_read_b128 v[4:7], v249 offset:31744
v_rcp_f16_e64 v207, v206
v_mfma_f32_16x16x32_bf16 v[184:187], v[40:43], v[36:39], v[184:187]
v_rcp_f16 v204, v203
s_waitcnt lgkmcnt(6)
v_mfma_f32_16x16x32_bf16 v[180:183], v[44:47], v[32:35], v[180:183]
ds_read_b128 v[40:43], v248 offset:41216
v_rcp_f16_sdwa v242, v241 dst_sel:WORD_1 dst_unused:UNUSED_PRESERVE src0_sel:WORD_1
v_mfma_f32_16x16x32_bf16 v[188:191], v[44:47], v[36:39], v[188:191]
v_rcp_f16_sdwa v207, v206 dst_sel:WORD_1 dst_unused:UNUSED_PRESERVE src0_sel:WORD_1
v_or_b32 v232, v192, v193
v_or_b32 v233, v194, v195
v_or_b32_e64 v234, v196, v197
v_rcp_f16_sdwa v204, v203 dst_sel:WORD_1 dst_unused:UNUSED_PRESERVE src0_sel:WORD_1
v_or_b32 v235, v198, v199
s_waitcnt lgkmcnt(2)
v_or_b32_e64 v236, v200, v201
v_pk_mul_f16 v237, v243, v242
v_pk_mul_f16 v238, v240, v207
v_pk_mul_f16 v239, v205, v204
v_mfma_f32_16x16x32_f16 v[120:123], v[224:227], v[232:235], v[120:123]
s_add_u32 s46, s80, 16777216
buffer_load_dwordx4 v[108:111], v253, s[32:35], s46 offen offset:256 nt
ds_read_b128 v[44:47], v249 offset:32000
v_cvt_pkrtz_f16_f32 v193, v176, v177
v_cvt_pkrtz_f16_f32 v195, v178, v179
v_mfma_f32_16x16x32_f16 v[128:131], v[224:227], v[236:239], v[128:131]
v_cvt_pkrtz_f16_f32 v197, v180, v181
v_cvt_pkrtz_f16_f32 v199, v182, v183
v_mfma_f32_16x16x32_f16 v[124:127], v[228:231], v[232:235], v[124:127]
ds_read_b128 v[224:227], v248 offset:41984
v_cvt_pkrtz_f16_f32 v201, v184, v185
v_cvt_pk_f16_f32 v243, v186, v187
v_mfma_f32_16x16x32_f16 v[132:135], v[228:231], v[236:239], v[132:135]
v_cvt_pk_f16_f32 v240, v188, v189
v_cvt_pk_f16_f32 v205, v190, v191
v_mfma_f32_16x16x32_bf16 v[176:179], v[0:3], v[88:91], 0
ds_read_b128 v[228:231], v249 offset:32768
v_pk_fma_f16 v242, v243, v243, s48
v_and_b32_e64 v193, s49, v193
v_mfma_f32_16x16x32_bf16 v[184:187], v[0:3], v[92:95], 0
v_pk_fma_f16 v207, v240, v240, s48
v_and_b32 v195, s49, v195
s_waitcnt lgkmcnt(3)
v_mfma_f32_16x16x32_f16 v[136:139], v[4:7], v[232:235], v[136:139]
ds_read_b128 v[0:3], v249 offset:33024
v_pk_fma_f16 v204, v205, v205, s48
s_setprio 2
v_bfe_u32 v192, v193, 2, 14
v_pk_mul_f16 v242, v243, v242
v_mfma_f32_16x16x32_f16 v[144:147], v[4:7], v[236:239], v[144:147]
v_bfe_u32 v194, v195, 2, 14
v_pk_mul_f16 v207, v240, v207
s_waitcnt vmcnt(7)
v_mfma_f32_16x16x32_bf16 v[168:171], v[26:29], v[244:247], v[168:171]
ds_read_b128 v[4:7], v248 offset:42240
ds_read_u16_d16 v192, v192
ds_read_u16_d16 v194, v194
v_lshrrev_b32_e64 v193, 18, v193
v_pk_mul_f16 v204, v205, v204
v_mfma_f32_16x16x32_bf16 v[172:175], v[24:27], v[244:247], v[172:175]
v_lshrrev_b32_e64 v195, 18, v195
v_mfma_f32_16x16x32_bf16 v[180:183], v[40:43], v[88:91], 0
ds_read_u16_d16_hi v193, v193
ds_read_u16_d16_hi v195, v195
v_exp_f16 v241, v242
v_and_b32 v197, s49, v197
v_mfma_f32_16x16x32_bf16 v[188:191], v[40:43], v[92:95], 0
v_and_b32 v199, s49, v199
s_waitcnt lgkmcnt(6)
v_mfma_f32_16x16x32_f16 v[140:143], v[44:47], v[232:235], v[140:143]
ds_read_b128 v[40:43], v248 offset:43008
v_exp_f16_e64 v206, v207
v_bfe_u32 v196, v197, 2, 14
v_mfma_f32_16x16x32_f16 v[148:151], v[44:47], v[236:239], v[148:151]
v_bfe_u32 v198, v199, 2, 14
v_exp_f16_e64 v203, v204
v_mfma_f32_16x16x32_bf16 v[176:179], v[224:227], v[208:211], v[176:179]
ds_read_b128 v[44:47], v248 offset:43264
ds_read_u16_d16 v196, v196
ds_read_u16_d16 v198, v198
v_lshrrev_b32 v197, 18, v197
v_lshrrev_b32 v199, 18, v199
v_mfma_f32_16x16x32_bf16 v[184:187], v[224:227], v[212:215], v[184:187]
v_exp_f16_sdwa v241, v242 dst_sel:WORD_1 dst_unused:UNUSED_PRESERVE src0_sel:WORD_1
v_mfma_f32_16x16x32_f16 v[152:155], v[228:231], v[232:235], v[152:155]
ds_read_b128 v[224:227], v249 offset:36864
ds_read_u16_d16_hi v197, v197
ds_read_u16_d16_hi v199, v199
v_and_b32 v201, s49, v201
v_bfe_u32 v200, v201, 2, 14
v_mfma_f32_16x16x32_f16 v[160:163], v[228:231], v[236:239], v[160:163]
v_exp_f16_sdwa v206, v207 dst_sel:WORD_1 dst_unused:UNUSED_PRESERVE src0_sel:WORD_1
s_waitcnt lgkmcnt(7)
v_mfma_f32_16x16x32_f16 v[156:159], v[0:3], v[232:235], v[156:159]
ds_read_b128 v[228:231], v249 offset:37120
ds_read_u16_d16 v200, v200
v_lshrrev_b32_e64 v201, 18, v201
v_mfma_f32_16x16x32_f16 v[164:167], v[0:3], v[236:239], v[164:167]
v_exp_f16_sdwa v203, v204 dst_sel:WORD_1 dst_unused:UNUSED_PRESERVE src0_sel:WORD_1
v_pk_add_f16 v241, v241, 1.0 op_sel_hi:[1,0]
v_pk_add_f16 v206, v206, 1.0 op_sel_hi:[1,0]
v_mfma_f32_16x16x32_bf16 v[180:183], v[4:7], v[208:211], v[180:183]
ds_read_b128 v[0:3], v248 offset:34816
ds_read_u16_d16_hi v201, v201
v_pk_add_f16 v203, v203, 1.0 op_sel_hi:[1,0]
v_mfma_f32_16x16x32_bf16 v[188:191], v[4:7], v[212:215], v[188:191]
v_rcp_f16 v242, v241
s_waitcnt lgkmcnt(7)
v_mfma_f32_16x16x32_bf16 v[176:179], v[40:43], v[32:35], v[176:179]
ds_read_b128 v[4:7], v249 offset:37888
v_rcp_f16_e64 v207, v206
v_mfma_f32_16x16x32_bf16 v[184:187], v[40:43], v[36:39], v[184:187]
v_rcp_f16_e64 v204, v203
v_mfma_f32_16x16x32_bf16 v[180:183], v[44:47], v[32:35], v[180:183]
ds_read_b128 v[40:43], v248 offset:35072
v_rcp_f16_sdwa v242, v241 dst_sel:WORD_1 dst_unused:UNUSED_PRESERVE src0_sel:WORD_1
v_mfma_f32_16x16x32_bf16 v[188:191], v[44:47], v[36:39], v[188:191]
v_rcp_f16_sdwa v207, v206 dst_sel:WORD_1 dst_unused:UNUSED_PRESERVE src0_sel:WORD_1
v_or_b32 v232, v192, v193
v_or_b32 v233, v194, v195
s_waitcnt lgkmcnt(4)
v_or_b32 v234, v196, v197
v_rcp_f16_sdwa v204, v203 dst_sel:WORD_1 dst_unused:UNUSED_PRESERVE src0_sel:WORD_1
v_or_b32 v235, v198, v199
s_waitcnt lgkmcnt(2)
v_or_b32_e64 v236, v200, v201
v_pk_mul_f16 v237, v243, v242
v_pk_mul_f16 v238, v240, v207
v_pk_mul_f16 v239, v205, v204
v_mfma_f32_16x16x32_f16 v[120:123], v[224:227], v[232:235], v[120:123]
s_add_u32 s46, s80, 20971520
buffer_load_dwordx4 v[112:115], v253, s[32:35], s46 offen nt
ds_read_b128 v[44:47], v249 offset:38144
v_cvt_pkrtz_f16_f32 v193, v176, v177
v_cvt_pkrtz_f16_f32 v195, v178, v179
v_cvt_pkrtz_f16_f32 v197, v180, v181
v_mfma_f32_16x16x32_f16 v[128:131], v[224:227], v[236:239], v[128:131]
v_cvt_pkrtz_f16_f32 v199, v182, v183
v_cvt_pkrtz_f16_f32 v201, v184, v185
v_cvt_pkrtz_f16_f32 v203, v186, v187
v_mfma_f32_16x16x32_f16 v[124:127], v[228:231], v[232:235], v[124:127]
ds_read_b128 v[224:227], v248 offset:35840
v_cvt_pk_f16_f32 v243, v188, v189
v_cvt_pk_f16_f32 v240, v190, v191
s_setprio 1
v_pk_fma_f16 v242, v243, v243, s48
v_mfma_f32_16x16x32_f16 v[132:135], v[228:231], v[236:239], v[132:135]
v_cvt_pk_bf16_f32 v64, v64, v65
v_and_b32 v193, s49, v193
v_cvt_pk_bf16_f32 v65, v66, v67
v_mfma_f32_16x16x32_bf16 v[176:179], v[0:3], v[88:91], 0
ds_read_b128 v[228:231], v249 offset:38912
v_and_b32 v195, s49, v195
v_cvt_pk_bf16_f32 v66, v68, v69
v_pk_fma_f16 v207, v240, v240, s48
v_mfma_f32_16x16x32_bf16 v[184:187], v[0:3], v[92:95], 0
v_bfe_u32 v192, v193, 2, 14
v_cvt_pk_bf16_f32 v67, v70, v71
v_pk_mul_f16 v242, v243, v242
s_waitcnt lgkmcnt(2)
v_mfma_f32_16x16x32_f16 v[136:139], v[4:7], v[232:235], v[136:139]
ds_read_b128 v[0:3], v249 offset:39168
ds_read_u16_d16 v192, v192
v_cvt_pk_bf16_f32 v48, v48, v49
v_bfe_u32 v194, v195, 2, 14
v_cvt_pk_bf16_f32 v49, v50, v51
v_mfma_f32_16x16x32_f16 v[144:147], v[4:7], v[236:239], v[144:147]
v_pk_mul_f16 v207, v240, v207
v_lshrrev_b32_e64 v193, 18, v193
v_cvt_pk_bf16_f32 v50, v52, v53
v_mfma_f32_16x16x32_bf16 v[180:183], v[40:43], v[88:91], 0
ds_read_b128 v[4:7], v248 offset:36096
ds_read_u16_d16 v194, v194
ds_read_u16_d16_hi v193, v193
v_exp_f16_e64 v241, v242
v_cvt_pk_bf16_f32 v51, v54, v55
v_mfma_f32_16x16x32_bf16 v[188:191], v[40:43], v[92:95], 0
v_lshrrev_b32_e64 v195, 18, v195
v_cvt_pk_bf16_f32 v80, v80, v81
v_and_b32_e64 v197, s49, v197
v_mfma_f32_16x16x32_f16 v[140:143], v[44:47], v[232:235], v[140:143]
ds_read_b128 v[40:43], v248 offset:36864
ds_read_u16_d16_hi v195, v195
v_cvt_pk_bf16_f32 v81, v82, v83
v_exp_f16_e64 v206, v207
v_mfma_f32_16x16x32_f16 v[148:151], v[44:47], v[236:239], v[148:151]
v_cvt_pk_bf16_f32 v82, v84, v85
v_and_b32_e64 v199, s49, v199
v_cvt_pk_bf16_f32 v83, v86, v87
s_mov_b64 vcc, s[74:75]
s_waitcnt lgkmcnt(5)
v_mfma_f32_16x16x32_bf16 v[176:179], v[224:227], v[208:211], v[176:179]
ds_read_b128 v[44:47], v248 offset:37120
v_bfe_u32 v196, v197, 2, 14
v_cndmask_b32 v68, v48, v80, vcc
v_mfma_f32_16x16x32_bf16 v[184:187], v[224:227], v[212:215], v[184:187]
v_exp_f16_sdwa v241, v242 dst_sel:WORD_1 dst_unused:UNUSED_PRESERVE src0_sel:WORD_1
v_cndmask_b32 v69, v49, v81, vcc
v_bfe_u32 v198, v199, 2, 14
v_mfma_f32_16x16x32_f16 v[152:155], v[228:231], v[232:235], v[152:155]
ds_read_b128 v[224:227], v249 offset:49152
ds_read_u16_d16 v196, v196
ds_read_u16_d16 v198, v198
v_cndmask_b32 v70, v50, v82, vcc
v_lshrrev_b32 v197, 18, v197
v_cndmask_b32 v71, v51, v83, vcc
v_mfma_f32_16x16x32_f16 v[160:163], v[228:231], v[236:239], v[160:163]
v_lshrrev_b32 v199, 18, v199
v_exp_f16_sdwa v206, v207 dst_sel:WORD_1 dst_unused:UNUSED_PRESERVE src0_sel:WORD_1
v_mfma_f32_16x16x32_f16 v[156:159], v[0:3], v[232:235], v[156:159]
ds_read_b128 v[228:231], v249 offset:49408
ds_read_u16_d16_hi v197, v197
ds_read_u16_d16_hi v199, v199
v_cndmask_b32_dpp v48, v64, v48, vcc quad_perm:[1,0,3,2] row_mask:0xf bank_mask:0xf
v_cndmask_b32_dpp v49, v65, v49, vcc quad_perm:[1,0,3,2] row_mask:0xf bank_mask:0xf
v_and_b32_e64 v201, s49, v201
v_mfma_f32_16x16x32_f16 v[164:167], v[0:3], v[236:239], v[164:167]
v_cndmask_b32_dpp v50, v66, v50, vcc quad_perm:[1,0,3,2] row_mask:0xf bank_mask:0xf
v_and_b32 v203, s49, v203
v_pk_add_f16 v241, v241, 1.0 op_sel_hi:[1,0]
s_waitcnt lgkmcnt(6)
v_mfma_f32_16x16x32_bf16 v[180:183], v[4:7], v[208:211], v[180:183]
ds_read_b128 v[0:3], v248 offset:47104
v_cndmask_b32_dpp v51, v67, v51, vcc quad_perm:[1,0,3,2] row_mask:0xf bank_mask:0xf
s_not_b64 vcc, s[74:75]
v_bfe_u32 v200, v201, 2, 14
s_setprio 0
v_cndmask_b32_dpp v80, v64, v80, vcc quad_perm:[1,0,3,2] row_mask:0xf bank_mask:0xf
v_mfma_f32_16x16x32_bf16 v[188:191], v[4:7], v[212:215], v[188:191]
v_pk_add_f16 v206, v206, 1.0 op_sel_hi:[1,0]
v_cndmask_b32_dpp v81, v65, v81, vcc quad_perm:[1,0,3,2] row_mask:0xf bank_mask:0xf
v_bfe_u32 v202, v203, 2, 14
v_mfma_f32_16x16x32_bf16 v[176:179], v[40:43], v[32:35], v[176:179]
ds_read_b128 v[4:7], v249 offset:50176
ds_read_u16_d16 v200, v200
ds_read_u16_d16 v202, v202
v_rcp_f16_e64 v242, v241
v_cndmask_b32_dpp v82, v66, v82, vcc quad_perm:[1,0,3,2] row_mask:0xf bank_mask:0xf
v_mfma_f32_16x16x32_bf16 v[184:187], v[40:43], v[36:39], v[184:187]
v_cndmask_b32_dpp v83, v67, v83, vcc quad_perm:[1,0,3,2] row_mask:0xf bank_mask:0xf
v_lshrrev_b32 v201, 18, v201
v_lshrrev_b32 v203, 18, v203
v_mfma_f32_16x16x32_bf16 v[180:183], v[44:47], v[32:35], v[180:183]
ds_read_b128 v[40:43], v248 offset:47360
buffer_store_dwordx4 v[48:51], v255, s[8:11], s70 offen sc1
ds_read_u16_d16_hi v201, v201
ds_read_u16_d16_hi v203, v203
v_rcp_f16_e64 v207, v206
v_mfma_f32_16x16x32_bf16 v[188:191], v[44:47], v[36:39], v[188:191]
v_rcp_f16_sdwa v242, v241 dst_sel:WORD_1 dst_unused:UNUSED_PRESERVE src0_sel:WORD_1
v_or_b32 v232, v192, v193
v_or_b32 v233, v194, v195
s_waitcnt lgkmcnt(6)
v_or_b32 v234, v196, v197
v_rcp_f16_sdwa v207, v206 dst_sel:WORD_1 dst_unused:UNUSED_PRESERVE src0_sel:WORD_1
v_or_b32 v235, v198, v199
s_waitcnt lgkmcnt(1)
v_or_b32 v236, v200, v201
s_waitcnt lgkmcnt(0)
v_or_b32 v237, v202, v203
v_pk_mul_f16 v238, v243, v242
v_pk_mul_f16 v239, v240, v207
s_setprio 3
v_mfma_f32_16x16x32_f16 v[120:123], v[224:227], v[232:235], v[120:123]
buffer_store_dwordx4 v[68:71], v255, s[8:11], s70 offen offset:128 sc1
ds_read_b128 v[44:47], v249 offset:50432
v_cvt_pkrtz_f16_f32 v193, v176, v177
v_cvt_pkrtz_f16_f32 v195, v178, v179
v_mfma_f32_16x16x32_f16 v[128:131], v[224:227], v[236:239], v[128:131]
v_cvt_pkrtz_f16_f32 v197, v180, v181
v_cvt_pkrtz_f16_f32 v199, v182, v183
v_mfma_f32_16x16x32_f16 v[124:127], v[228:231], v[232:235], v[124:127]
ds_read_b128 v[224:227], v248 offset:48128
v_cvt_pkrtz_f16_f32 v201, v184, v185
v_cvt_pk_f16_f32 v243, v186, v187
v_cvt_pk_f16_f32 v240, v188, v189
v_mfma_f32_16x16x32_f16 v[132:135], v[228:231], v[236:239], v[132:135]
v_cvt_pk_f16_f32 v205, v190, v191
v_pk_fma_f16 v242, v243, v243, s48
v_mfma_f32_16x16x32_bf16 v[176:179], v[0:3], v[88:91], 0
ds_read_b128 v[228:231], v249 offset:51200
v_and_b32_e64 v193, s49, v193
v_pk_fma_f16 v207, v240, v240, s48
v_mfma_f32_16x16x32_bf16 v[184:187], v[0:3], v[92:95], 0
v_and_b32_e64 v195, s49, v195
v_pk_fma_f16 v204, v205, v205, s48
v_bfe_u32 v192, v193, 2, 14
v_mfma_f32_16x16x32_f16 v[136:139], v[4:7], v[232:235], v[136:139]
ds_read_b128 v[0:3], v249 offset:51456
ds_read_u16_d16 v192, v192
v_pk_mul_f16 v242, v243, v242
v_bfe_u32 v194, v195, 2, 14
v_mfma_f32_16x16x32_f16 v[144:147], v[4:7], v[236:239], v[144:147]
v_pk_mul_f16 v207, v240, v207
v_lshrrev_b32_e64 v193, 18, v193
v_mfma_f32_16x16x32_bf16 v[180:183], v[40:43], v[88:91], 0
ds_read_b128 v[4:7], v248 offset:48384
ds_read_u16_d16 v194, v194
ds_read_u16_d16_hi v193, v193
v_pk_mul_f16 v204, v205, v204
v_lshrrev_b32_e64 v195, 18, v195
v_mfma_f32_16x16x32_bf16 v[188:191], v[40:43], v[92:95], 0
v_exp_f16_e64 v241, v242
v_and_b32 v197, s49, v197
s_waitcnt lgkmcnt(6)
v_mfma_f32_16x16x32_f16 v[140:143], v[44:47], v[232:235], v[140:143]
ds_read_b128 v[40:43], v248 offset:49152
ds_read_u16_d16_hi v195, v195
v_and_b32_e64 v199, s49, v199
v_mfma_f32_16x16x32_f16 v[148:151], v[44:47], v[236:239], v[148:151]
v_exp_f16_e64 v206, v207
v_bfe_u32 v196, v197, 2, 14
v_bfe_u32 v198, v199, 2, 14
v_mfma_f32_16x16x32_bf16 v[176:179], v[224:227], v[208:211], v[176:179]
s_add_u32 s46, s80, 20971520
buffer_load_dwordx4 v[116:119], v253, s[32:35], s46 offen offset:256 nt
ds_read_b128 v[44:47], v248 offset:49408
ds_read_u16_d16 v196, v196
ds_read_u16_d16 v198, v198
v_exp_f16_e64 v203, v204
v_mfma_f32_16x16x32_bf16 v[184:187], v[224:227], v[212:215], v[184:187]
v_lshrrev_b32_e64 v197, 18, v197
v_lshrrev_b32 v199, 18, v199
s_waitcnt lgkmcnt(5)
v_mfma_f32_16x16x32_f16 v[152:155], v[228:231], v[232:235], v[152:155]
ds_read_b128 v[224:227], v249 offset:43008
ds_read_u16_d16_hi v197, v197
ds_read_u16_d16_hi v199, v199
v_exp_f16_sdwa v241, v242 dst_sel:WORD_1 dst_unused:UNUSED_PRESERVE src0_sel:WORD_1
v_and_b32_e64 v201, s49, v201
v_mfma_f32_16x16x32_f16 v[160:163], v[228:231], v[236:239], v[160:163]
v_bfe_u32 v200, v201, 2, 14
v_mfma_f32_16x16x32_f16 v[156:159], v[0:3], v[232:235], v[156:159]
ds_read_b128 v[228:231], v249 offset:43264
ds_read_u16_d16 v200, v200
v_exp_f16_sdwa v206, v207 dst_sel:WORD_1 dst_unused:UNUSED_PRESERVE src0_sel:WORD_1
v_lshrrev_b32_e64 v201, 18, v201
v_mfma_f32_16x16x32_f16 v[164:167], v[0:3], v[236:239], v[164:167]
v_exp_f16_sdwa v203, v204 dst_sel:WORD_1 dst_unused:UNUSED_PRESERVE src0_sel:WORD_1
v_pk_add_f16 v241, v241, 1.0 op_sel_hi:[1,0]
v_mfma_f32_16x16x32_bf16 v[180:183], v[4:7], v[208:211], v[180:183]
ds_read_b128 v[0:3], v248 offset:53248
ds_read_u16_d16_hi v201, v201
v_pk_add_f16 v206, v206, 1.0 op_sel_hi:[1,0]
v_pk_add_f16 v203, v203, 1.0 op_sel_hi:[1,0]
v_mfma_f32_16x16x32_bf16 v[188:191], v[4:7], v[212:215], v[188:191]
v_rcp_f16 v242, v241
s_waitcnt lgkmcnt(7)
v_mfma_f32_16x16x32_bf16 v[176:179], v[40:43], v[32:35], v[176:179]
ds_read_b128 v[4:7], v249 offset:44032
v_rcp_f16_e64 v207, v206
v_mfma_f32_16x16x32_bf16 v[184:187], v[40:43], v[36:39], v[184:187]
v_rcp_f16_e64 v204, v203
v_mfma_f32_16x16x32_bf16 v[180:183], v[44:47], v[32:35], v[180:183]
ds_read_b128 v[40:43], v248 offset:53504
v_rcp_f16_sdwa v242, v241 dst_sel:WORD_1 dst_unused:UNUSED_PRESERVE src0_sel:WORD_1
v_mfma_f32_16x16x32_bf16 v[188:191], v[44:47], v[36:39], v[188:191]
v_rcp_f16_sdwa v207, v206 dst_sel:WORD_1 dst_unused:UNUSED_PRESERVE src0_sel:WORD_1
v_or_b32 v232, v192, v193
v_or_b32 v233, v194, v195
s_waitcnt lgkmcnt(4)
v_or_b32 v234, v196, v197
v_rcp_f16_sdwa v204, v203 dst_sel:WORD_1 dst_unused:UNUSED_PRESERVE src0_sel:WORD_1
v_or_b32 v235, v198, v199
s_waitcnt lgkmcnt(2)
v_or_b32_e64 v236, v200, v201
v_pk_mul_f16 v237, v243, v242
v_pk_mul_f16 v238, v240, v207
v_pk_mul_f16 v239, v205, v204
v_mfma_f32_16x16x32_f16 v[120:123], v[224:227], v[232:235], v[120:123]
ds_read_b128 v[44:47], v249 offset:44288
v_cvt_pkrtz_f16_f32 v193, v176, v177
v_cvt_pkrtz_f16_f32 v195, v178, v179
v_mfma_f32_16x16x32_f16 v[128:131], v[224:227], v[236:239], v[128:131]
v_cvt_pkrtz_f16_f32 v197, v180, v181
v_cvt_pkrtz_f16_f32 v199, v182, v183
v_mfma_f32_16x16x32_f16 v[124:127], v[228:231], v[232:235], v[124:127]
ds_read_b128 v[224:227], v248 offset:54272
v_cvt_pkrtz_f16_f32 v201, v184, v185
v_cvt_pk_f16_f32 v243, v186, v187
v_cvt_pk_f16_f32 v240, v188, v189
v_mfma_f32_16x16x32_f16 v[132:135], v[228:231], v[236:239], v[132:135]
v_cvt_pk_f16_f32 v205, v190, v191
v_pk_fma_f16 v242, v243, v243, s48
v_mfma_f32_16x16x32_bf16 v[176:179], v[0:3], v[88:91], 0
ds_read_b128 v[228:231], v249 offset:45056
v_and_b32_e64 v193, s49, v193
v_pk_fma_f16 v207, v240, v240, s48
v_mfma_f32_16x16x32_bf16 v[184:187], v[0:3], v[92:95], 0
v_and_b32_e64 v195, s49, v195
v_pk_fma_f16 v204, v205, v205, s48
s_setprio 2
v_bfe_u32 v192, v193, 2, 14
s_waitcnt lgkmcnt(3)
v_mfma_f32_16x16x32_f16 v[136:139], v[4:7], v[232:235], v[136:139]
ds_read_b128 v[0:3], v249 offset:45312
ds_read_u16_d16 v192, v192
v_pk_mul_f16 v242, v243, v242
v_bfe_u32 v194, v195, 2, 14
v_mfma_f32_16x16x32_f16 v[144:147], v[4:7], v[236:239], v[144:147]
v_pk_mul_f16 v207, v240, v207
v_lshrrev_b32_e64 v193, 18, v193
v_mfma_f32_16x16x32_bf16 v[180:183], v[40:43], v[88:91], 0
ds_read_b128 v[4:7], v248 offset:54528
ds_read_u16_d16 v194, v194
ds_read_u16_d16_hi v193, v193
v_pk_mul_f16 v204, v205, v204
v_lshrrev_b32_e64 v195, 18, v195
v_mfma_f32_16x16x32_bf16 v[188:191], v[40:43], v[92:95], 0
v_exp_f16_e64 v241, v242
v_and_b32 v197, s49, v197
s_waitcnt lgkmcnt(5)
v_mfma_f32_16x16x32_f16 v[140:143], v[44:47], v[232:235], v[140:143]
ds_read_b128 v[40:43], v248 offset:55296
ds_read_u16_d16_hi v195, v195
v_and_b32_e64 v199, s49, v199
v_mfma_f32_16x16x32_f16 v[148:151], v[44:47], v[236:239], v[148:151]
v_exp_f16_e64 v206, v207
v_bfe_u32 v196, v197, 2, 14
v_bfe_u32 v198, v199, 2, 14
v_mfma_f32_16x16x32_bf16 v[176:179], v[224:227], v[208:211], v[176:179]
ds_read_b128 v[44:47], v248 offset:55552
ds_read_u16_d16 v196, v196
ds_read_u16_d16 v198, v198
v_exp_f16_e64 v203, v204
v_mfma_f32_16x16x32_bf16 v[184:187], v[224:227], v[212:215], v[184:187]
v_lshrrev_b32 v197, 18, v197
v_lshrrev_b32 v199, 18, v199
v_mfma_f32_16x16x32_f16 v[152:155], v[228:231], v[232:235], v[152:155]
ds_read_b128 v[224:227], v249 offset:55296
ds_read_u16_d16_hi v197, v197
ds_read_u16_d16_hi v199, v199
v_exp_f16_sdwa v241, v242 dst_sel:WORD_1 dst_unused:UNUSED_PRESERVE src0_sel:WORD_1
v_and_b32 v201, s49, v201
v_mfma_f32_16x16x32_f16 v[160:163], v[228:231], v[236:239], v[160:163]
v_bfe_u32 v200, v201, 2, 14
s_waitcnt lgkmcnt(8)
v_mfma_f32_16x16x32_f16 v[156:159], v[0:3], v[232:235], v[156:159]
ds_read_b128 v[228:231], v249 offset:55552
ds_read_u16_d16 v200, v200
v_exp_f16_sdwa v206, v207 dst_sel:WORD_1 dst_unused:UNUSED_PRESERVE src0_sel:WORD_1
v_lshrrev_b32_e64 v201, 18, v201
v_mfma_f32_16x16x32_f16 v[164:167], v[0:3], v[236:239], v[164:167]
v_exp_f16_sdwa v203, v204 dst_sel:WORD_1 dst_unused:UNUSED_PRESERVE src0_sel:WORD_1
v_pk_add_f16 v241, v241, 1.0 op_sel_hi:[1,0]
v_mfma_f32_16x16x32_bf16 v[180:183], v[4:7], v[208:211], v[180:183]
ds_read_b128 v[0:3], v248 offset:59392
ds_read_u16_d16_hi v201, v201
v_pk_add_f16 v206, v206, 1.0 op_sel_hi:[1,0]
v_pk_add_f16 v203, v203, 1.0 op_sel_hi:[1,0]
v_mfma_f32_16x16x32_bf16 v[188:191], v[4:7], v[212:215], v[188:191]
v_rcp_f16 v242, v241
s_waitcnt lgkmcnt(7)
v_mfma_f32_16x16x32_bf16 v[176:179], v[40:43], v[32:35], v[176:179]
ds_read_b128 v[4:7], v249 offset:56320
v_rcp_f16_e64 v207, v206
v_mfma_f32_16x16x32_bf16 v[184:187], v[40:43], v[36:39], v[184:187]
v_rcp_f16_e64 v204, v203
v_mfma_f32_16x16x32_bf16 v[180:183], v[44:47], v[32:35], v[180:183]
ds_read_b128 v[40:43], v248 offset:59648
v_rcp_f16_sdwa v242, v241 dst_sel:WORD_1 dst_unused:UNUSED_PRESERVE src0_sel:WORD_1
v_mfma_f32_16x16x32_bf16 v[188:191], v[44:47], v[36:39], v[188:191]
v_rcp_f16_sdwa v207, v206 dst_sel:WORD_1 dst_unused:UNUSED_PRESERVE src0_sel:WORD_1
v_or_b32 v232, v192, v193
v_or_b32 v233, v194, v195
s_waitcnt lgkmcnt(4)
v_or_b32 v234, v196, v197
v_rcp_f16_sdwa v204, v203 dst_sel:WORD_1 dst_unused:UNUSED_PRESERVE src0_sel:WORD_1
v_or_b32 v235, v198, v199
s_waitcnt lgkmcnt(2)
v_or_b32_e64 v236, v200, v201
v_pk_mul_f16 v237, v243, v242
v_pk_mul_f16 v238, v240, v207
v_pk_mul_f16 v239, v205, v204
v_mfma_f32_16x16x32_f16 v[120:123], v[224:227], v[232:235], v[120:123]
buffer_load_dwordx4 v[244:247], v252, s[4:7], s68 offen
ds_read_b128 v[44:47], v249 offset:56576
v_cvt_pkrtz_f16_f32 v193, v176, v177
v_cvt_pkrtz_f16_f32 v195, v178, v179
v_mfma_f32_16x16x32_f16 v[128:131], v[224:227], v[236:239], v[128:131]
v_cvt_pkrtz_f16_f32 v197, v180, v181
v_cvt_pkrtz_f16_f32 v199, v182, v183
v_mfma_f32_16x16x32_f16 v[124:127], v[228:231], v[232:235], v[124:127]
ds_read_b128 v[224:227], v248 offset:60416
v_cvt_pkrtz_f16_f32 v201, v184, v185
v_cvt_pk_f16_f32 v243, v186, v187
v_cvt_pk_f16_f32 v240, v188, v189
v_mfma_f32_16x16x32_f16 v[132:135], v[228:231], v[236:239], v[132:135]
v_cvt_pk_f16_f32 v205, v190, v191
s_setprio 1
v_pk_fma_f16 v242, v243, v243, s48
v_mfma_f32_16x16x32_bf16 v[176:179], v[0:3], v[88:91], 0
ds_read_b128 v[228:231], v249 offset:57344
v_and_b32 v193, s49, v193
v_pk_fma_f16 v207, v240, v240, s48
v_mfma_f32_16x16x32_bf16 v[184:187], v[0:3], v[92:95], 0
v_and_b32 v195, s49, v195
v_pk_fma_f16 v204, v205, v205, s48
v_bfe_u32 v192, v193, 2, 14
s_waitcnt lgkmcnt(3)
v_mfma_f32_16x16x32_f16 v[136:139], v[4:7], v[232:235], v[136:139]
ds_read_b128 v[0:3], v249 offset:57600
ds_read_u16_d16 v192, v192
v_pk_mul_f16 v242, v243, v242
v_bfe_u32 v194, v195, 2, 14
v_mfma_f32_16x16x32_f16 v[144:147], v[4:7], v[236:239], v[144:147]
v_pk_mul_f16 v207, v240, v207
v_lshrrev_b32_e64 v193, 18, v193
v_mfma_f32_16x16x32_bf16 v[180:183], v[40:43], v[88:91], 0
ds_read_b128 v[4:7], v248 offset:60672
ds_read_u16_d16 v194, v194
ds_read_u16_d16_hi v193, v193
v_pk_mul_f16 v204, v205, v204
v_lshrrev_b32_e64 v195, 18, v195
v_mfma_f32_16x16x32_bf16 v[188:191], v[40:43], v[92:95], 0
v_exp_f16_e64 v241, v242
v_and_b32 v197, s49, v197
s_waitcnt lgkmcnt(5)
v_mfma_f32_16x16x32_f16 v[140:143], v[44:47], v[232:235], v[140:143]
ds_read_b128 v[40:43], v248 offset:61440
ds_read_u16_d16_hi v195, v195
v_and_b32_e64 v199, s49, v199
v_mfma_f32_16x16x32_f16 v[148:151], v[44:47], v[236:239], v[148:151]
v_exp_f16_e64 v206, v207
v_bfe_u32 v196, v197, 2, 14
v_bfe_u32 v198, v199, 2, 14
v_mfma_f32_16x16x32_bf16 v[176:179], v[224:227], v[208:211], v[176:179]
buffer_store_dwordx4 v[80:83], v255, s[8:11], s70 offen offset:256 sc1
ds_read_b128 v[44:47], v248 offset:61696
ds_read_u16_d16 v196, v196
ds_read_u16_d16 v198, v198
v_exp_f16_e64 v203, v204
v_mfma_f32_16x16x32_bf16 v[184:187], v[224:227], v[212:215], v[184:187]
v_lshrrev_b32 v197, 18, v197
v_lshrrev_b32 v199, 18, v199
v_mfma_f32_16x16x32_f16 v[152:155], v[228:231], v[232:235], v[152:155]
ds_read_b128 v[224:227], v249 offset:61440
ds_read_u16_d16_hi v197, v197
ds_read_u16_d16_hi v199, v199
v_exp_f16_sdwa v241, v242 dst_sel:WORD_1 dst_unused:UNUSED_PRESERVE src0_sel:WORD_1
v_and_b32 v201, s49, v201
v_mfma_f32_16x16x32_f16 v[160:163], v[228:231], v[236:239], v[160:163]
v_bfe_u32 v200, v201, 2, 14
s_waitcnt lgkmcnt(8)
v_mfma_f32_16x16x32_f16 v[156:159], v[0:3], v[232:235], v[156:159]
ds_read_b128 v[228:231], v249 offset:61696
ds_read_u16_d16 v200, v200
v_exp_f16_sdwa v206, v207 dst_sel:WORD_1 dst_unused:UNUSED_PRESERVE src0_sel:WORD_1
v_lshrrev_b32_e64 v201, 18, v201
v_mfma_f32_16x16x32_f16 v[164:167], v[0:3], v[236:239], v[164:167]
v_exp_f16_sdwa v203, v204 dst_sel:WORD_1 dst_unused:UNUSED_PRESERVE src0_sel:WORD_1
v_pk_add_f16 v241, v241, 1.0 op_sel_hi:[1,0]
v_mfma_f32_16x16x32_bf16 v[180:183], v[4:7], v[208:211], v[180:183]
ds_read_b128 v[0:3], v249
ds_read_u16_d16_hi v201, v201
v_pk_add_f16 v206, v206, 1.0 op_sel_hi:[1,0]
v_pk_add_f16 v203, v203, 1.0 op_sel_hi:[1,0]
v_mfma_f32_16x16x32_bf16 v[188:191], v[4:7], v[212:215], v[188:191]
v_rcp_f16_e64 v242, v241
s_setprio 0
s_waitcnt lgkmcnt(7)
v_mfma_f32_16x16x32_bf16 v[176:179], v[40:43], v[32:35], v[176:179]
ds_read_b128 v[4:7], v249 offset:62464
v_rcp_f16_e64 v207, v206
v_mfma_f32_16x16x32_bf16 v[184:187], v[40:43], v[36:39], v[184:187]
v_rcp_f16_e64 v204, v203
v_mfma_f32_16x16x32_bf16 v[180:183], v[44:47], v[32:35], v[180:183]
ds_read_b128 v[40:43], v249 offset:256
v_rcp_f16_sdwa v242, v241 dst_sel:WORD_1 dst_unused:UNUSED_PRESERVE src0_sel:WORD_1
v_mfma_f32_16x16x32_bf16 v[188:191], v[44:47], v[36:39], v[188:191]
v_rcp_f16_sdwa v207, v206 dst_sel:WORD_1 dst_unused:UNUSED_PRESERVE src0_sel:WORD_1
v_or_b32 v232, v192, v193
v_or_b32 v233, v194, v195
s_waitcnt lgkmcnt(4)
v_or_b32 v234, v196, v197
v_rcp_f16_sdwa v204, v203 dst_sel:WORD_1 dst_unused:UNUSED_PRESERVE src0_sel:WORD_1
v_or_b32 v235, v198, v199
s_waitcnt lgkmcnt(2)
v_or_b32 v236, v200, v201
v_pk_mul_f16 v237, v243, v242
v_pk_mul_f16 v238, v240, v207
v_pk_mul_f16 v239, v205, v204
s_setprio 3
v_mfma_f32_16x16x32_f16 v[120:123], v[224:227], v[232:235], v[120:123]
buffer_load_dwordx4 v[216:219], v252, s[4:7], s68 offen offset:64
ds_read_b128 v[44:47], v249 offset:62720
v_cvt_pkrtz_f16_f32 v193, v176, v177
v_cvt_pkrtz_f16_f32 v195, v178, v179
v_mfma_f32_16x16x32_f16 v[128:131], v[224:227], v[236:239], v[128:131]
v_cvt_pkrtz_f16_f32 v197, v180, v181
v_cvt_pkrtz_f16_f32 v199, v182, v183
v_mfma_f32_16x16x32_f16 v[124:127], v[228:231], v[232:235], v[124:127]
ds_read_b128 v[224:227], v249 offset:1024
v_cvt_pkrtz_f16_f32 v201, v184, v185
v_cvt_pk_f16_f32 v243, v186, v187
v_cvt_pk_f16_f32 v240, v188, v189
v_mfma_f32_16x16x32_f16 v[132:135], v[228:231], v[236:239], v[132:135]
v_cvt_pk_f16_f32 v205, v190, v191
v_pk_fma_f16 v242, v243, v243, s48
v_mfma_f32_16x16x32_bf16 v[176:179], v[0:3], v[88:91], 0
ds_read_b128 v[228:231], v249 offset:63488
v_and_b32_e64 v193, s49, v193
v_pk_fma_f16 v207, v240, v240, s48
v_mfma_f32_16x16x32_bf16 v[184:187], v[0:3], v[92:95], 0
v_and_b32 v195, s49, v195
v_pk_fma_f16 v204, v205, v205, s48
v_bfe_u32 v192, v193, 2, 14
s_waitcnt lgkmcnt(3)
v_mfma_f32_16x16x32_f16 v[136:139], v[4:7], v[232:235], v[136:139]
ds_read_b128 v[0:3], v249 offset:63744
ds_read_u16_d16 v192, v192
v_pk_mul_f16 v242, v243, v242
v_bfe_u32 v194, v195, 2, 14
v_mfma_f32_16x16x32_f16 v[144:147], v[4:7], v[236:239], v[144:147]
v_pk_mul_f16 v207, v240, v207
v_lshrrev_b32_e64 v193, 18, v193
v_mfma_f32_16x16x32_bf16 v[180:183], v[40:43], v[88:91], 0
ds_read_b128 v[4:7], v249 offset:1280
ds_read_u16_d16 v194, v194
ds_read_u16_d16_hi v193, v193
v_pk_mul_f16 v204, v205, v204
v_lshrrev_b32_e64 v195, 18, v195
v_mfma_f32_16x16x32_bf16 v[188:191], v[40:43], v[92:95], 0
v_exp_f16_e64 v241, v242
v_and_b32 v197, s49, v197
s_waitcnt lgkmcnt(5)
v_mfma_f32_16x16x32_f16 v[140:143], v[44:47], v[232:235], v[140:143]
ds_read_b128 v[40:43], v249 offset:2048
ds_read_u16_d16_hi v195, v195
v_and_b32_e64 v199, s49, v199
v_mfma_f32_16x16x32_f16 v[148:151], v[44:47], v[236:239], v[148:151]
v_exp_f16_e64 v206, v207
v_bfe_u32 v196, v197, 2, 14
v_bfe_u32 v198, v199, 2, 14
v_mfma_f32_16x16x32_bf16 v[176:179], v[224:227], v[208:211], v[176:179]
ds_read_b128 v[44:47], v249 offset:2304
ds_read_u16_d16 v196, v196
ds_read_u16_d16 v198, v198
v_exp_f16_e64 v203, v204
v_mfma_f32_16x16x32_bf16 v[184:187], v[224:227], v[212:215], v[184:187]
v_lshrrev_b32 v197, 18, v197
v_lshrrev_b32 v199, 18, v199
v_mfma_f32_16x16x32_f16 v[152:155], v[228:231], v[232:235], v[152:155]
ds_read_b128 v[224:227], v250 offset:2048
ds_read_u16_d16_hi v197, v197
ds_read_u16_d16_hi v199, v199
v_exp_f16_sdwa v241, v242 dst_sel:WORD_1 dst_unused:UNUSED_PRESERVE src0_sel:WORD_1
v_and_b32 v201, s49, v201
v_mfma_f32_16x16x32_f16 v[160:163], v[228:231], v[236:239], v[160:163]
v_bfe_u32 v200, v201, 2, 14
s_waitcnt lgkmcnt(8)
v_mfma_f32_16x16x32_f16 v[156:159], v[0:3], v[232:235], v[156:159]
ds_read_b128 v[228:231], v250 offset:2304
ds_read_u16_d16 v200, v200
v_exp_f16_sdwa v206, v207 dst_sel:WORD_1 dst_unused:UNUSED_PRESERVE src0_sel:WORD_1
v_lshrrev_b32_e64 v201, 18, v201
v_mfma_f32_16x16x32_f16 v[164:167], v[0:3], v[236:239], v[164:167]
v_exp_f16_sdwa v203, v204 dst_sel:WORD_1 dst_unused:UNUSED_PRESERVE src0_sel:WORD_1
v_pk_add_f16 v241, v241, 1.0 op_sel_hi:[1,0]
v_mfma_f32_16x16x32_bf16 v[180:183], v[4:7], v[208:211], v[180:183]
ds_read_b128 v[0:3], v249 offset:6144
ds_read_u16_d16_hi v201, v201
v_pk_add_f16 v206, v206, 1.0 op_sel_hi:[1,0]
v_pk_add_f16 v203, v203, 1.0 op_sel_hi:[1,0]
v_mfma_f32_16x16x32_bf16 v[188:191], v[4:7], v[212:215], v[188:191]
v_rcp_f16 v242, v241
s_waitcnt lgkmcnt(7)
v_mfma_f32_16x16x32_bf16 v[176:179], v[40:43], v[32:35], v[176:179]
ds_read_b128 v[4:7], v250 offset:3072
v_rcp_f16_e64 v207, v206
v_mfma_f32_16x16x32_bf16 v[184:187], v[40:43], v[36:39], v[184:187]
v_rcp_f16_e64 v204, v203
v_mfma_f32_16x16x32_bf16 v[180:183], v[44:47], v[32:35], v[180:183]
ds_read_b128 v[40:43], v249 offset:6400
v_rcp_f16_sdwa v242, v241 dst_sel:WORD_1 dst_unused:UNUSED_PRESERVE src0_sel:WORD_1
v_mfma_f32_16x16x32_bf16 v[188:191], v[44:47], v[36:39], v[188:191]
v_rcp_f16_sdwa v207, v206 dst_sel:WORD_1 dst_unused:UNUSED_PRESERVE src0_sel:WORD_1
v_or_b32 v232, v192, v193
v_or_b32 v233, v194, v195
s_waitcnt lgkmcnt(4)
v_or_b32 v234, v196, v197
v_rcp_f16_sdwa v204, v203 dst_sel:WORD_1 dst_unused:UNUSED_PRESERVE src0_sel:WORD_1
v_or_b32 v235, v198, v199
s_waitcnt lgkmcnt(2)
v_or_b32_e64 v236, v200, v201
v_pk_mul_f16 v237, v243, v242
v_pk_mul_f16 v238, v240, v207
v_pk_mul_f16 v239, v205, v204
v_mfma_f32_16x16x32_f16 v[120:123], v[224:227], v[232:235], v[120:123]
ds_read_b128 v[44:47], v250 offset:3328
v_cvt_pkrtz_f16_f32 v193, v176, v177
v_cvt_pkrtz_f16_f32 v195, v178, v179
v_cvt_pkrtz_f16_f32 v197, v180, v181
v_mfma_f32_16x16x32_f16 v[128:131], v[224:227], v[236:239], v[128:131]
v_cvt_pkrtz_f16_f32 v199, v182, v183
v_cvt_pkrtz_f16_f32 v201, v184, v185
v_cvt_pkrtz_f16_f32 v203, v186, v187
v_mfma_f32_16x16x32_f16 v[124:127], v[228:231], v[232:235], v[124:127]
ds_read_b128 v[224:227], v249 offset:7168
v_cvt_pk_f16_f32 v243, v188, v189
v_cvt_pk_f16_f32 v240, v190, v191
v_pk_fma_f16 v242, v243, v243, s48
v_mfma_f32_16x16x32_f16 v[132:135], v[228:231], v[236:239], v[132:135]
v_cvt_pk_bf16_f32 v72, v72, v73
v_and_b32_e64 v193, s49, v193
v_cvt_pk_bf16_f32 v73, v74, v75
v_mfma_f32_16x16x32_bf16 v[176:179], v[0:3], v[88:91], 0
ds_read_b128 v[228:231], v250 offset:4096
v_and_b32_e64 v195, s49, v195
v_cvt_pk_bf16_f32 v74, v76, v77
v_pk_fma_f16 v207, v240, v240, s48
v_mfma_f32_16x16x32_bf16 v[184:187], v[0:3], v[92:95], 0
v_bfe_u32 v192, v193, 2, 14
s_setprio 2
v_cvt_pk_bf16_f32 v75, v78, v79
v_pk_mul_f16 v242, v243, v242
s_waitcnt lgkmcnt(2)
v_mfma_f32_16x16x32_f16 v[136:139], v[4:7], v[232:235], v[136:139]
ds_read_b128 v[0:3], v250 offset:4352
ds_read_u16_d16 v192, v192
v_cvt_pk_bf16_f32 v56, v56, v57
v_bfe_u32 v194, v195, 2, 14
v_cvt_pk_bf16_f32 v57, v58, v59
v_mfma_f32_16x16x32_f16 v[144:147], v[4:7], v[236:239], v[144:147]
v_pk_mul_f16 v207, v240, v207
v_lshrrev_b32_e64 v193, 18, v193
v_cvt_pk_bf16_f32 v58, v60, v61
v_mfma_f32_16x16x32_bf16 v[180:183], v[40:43], v[88:91], 0
ds_read_b128 v[4:7], v249 offset:7424
ds_read_u16_d16 v194, v194
ds_read_u16_d16_hi v193, v193
v_exp_f16_e64 v241, v242
v_cvt_pk_bf16_f32 v59, v62, v63
v_mfma_f32_16x16x32_bf16 v[188:191], v[40:43], v[92:95], 0
v_lshrrev_b32_e64 v195, 18, v195
v_cvt_pk_bf16_f32 v168, v168, v169
v_and_b32_e64 v197, s49, v197
v_mfma_f32_16x16x32_f16 v[140:143], v[44:47], v[232:235], v[140:143]
ds_read_b128 v[40:43], v249 offset:8192
ds_read_u16_d16_hi v195, v195
v_cvt_pk_bf16_f32 v169, v170, v171
v_exp_f16_e64 v206, v207
v_mfma_f32_16x16x32_f16 v[148:151], v[44:47], v[236:239], v[148:151]
v_cvt_pk_bf16_f32 v170, v172, v173
v_and_b32_e64 v199, s49, v199
v_cvt_pk_bf16_f32 v171, v174, v175
s_mov_b64 vcc, s[74:75]
s_waitcnt lgkmcnt(5)
v_mfma_f32_16x16x32_bf16 v[176:179], v[224:227], v[208:211], v[176:179]
ds_read_b128 v[44:47], v249 offset:8448
v_bfe_u32 v196, v197, 2, 14
v_cndmask_b32 v76, v56, v168, vcc
v_mfma_f32_16x16x32_bf16 v[184:187], v[224:227], v[212:215], v[184:187]
v_exp_f16_sdwa v241, v242 dst_sel:WORD_1 dst_unused:UNUSED_PRESERVE src0_sel:WORD_1
v_cndmask_b32 v77, v57, v169, vcc
v_bfe_u32 v198, v199, 2, 14
v_mfma_f32_16x16x32_f16 v[152:155], v[228:231], v[232:235], v[152:155]
ds_read_b128 v[224:227], v250 offset:8192
ds_read_u16_d16 v196, v196
ds_read_u16_d16 v198, v198
v_cndmask_b32 v78, v58, v170, vcc
v_lshrrev_b32 v197, 18, v197
v_cndmask_b32 v79, v59, v171, vcc
v_mfma_f32_16x16x32_f16 v[160:163], v[228:231], v[236:239], v[160:163]
v_lshrrev_b32 v199, 18, v199
v_exp_f16_sdwa v206, v207 dst_sel:WORD_1 dst_unused:UNUSED_PRESERVE src0_sel:WORD_1
v_mfma_f32_16x16x32_f16 v[156:159], v[0:3], v[232:235], v[156:159]
ds_read_b128 v[228:231], v250 offset:8448
ds_read_u16_d16_hi v197, v197
ds_read_u16_d16_hi v199, v199
v_cndmask_b32_dpp v56, v72, v56, vcc quad_perm:[1,0,3,2] row_mask:0xf bank_mask:0xf
v_cndmask_b32_dpp v57, v73, v57, vcc quad_perm:[1,0,3,2] row_mask:0xf bank_mask:0xf
v_and_b32_e64 v201, s49, v201
v_mfma_f32_16x16x32_f16 v[164:167], v[0:3], v[236:239], v[164:167]
v_cndmask_b32_dpp v58, v74, v58, vcc quad_perm:[1,0,3,2] row_mask:0xf bank_mask:0xf
v_and_b32_e64 v203, s49, v203
v_pk_add_f16 v241, v241, 1.0 op_sel_hi:[1,0]
s_waitcnt lgkmcnt(6)
v_mfma_f32_16x16x32_bf16 v[180:183], v[4:7], v[208:211], v[180:183]
ds_read_b128 v[0:3], v249 offset:12288
v_cndmask_b32_dpp v59, v75, v59, vcc quad_perm:[1,0,3,2] row_mask:0xf bank_mask:0xf
s_not_b64 vcc, s[74:75]
v_bfe_u32 v200, v201, 2, 14
v_cndmask_b32_dpp v168, v72, v168, vcc quad_perm:[1,0,3,2] row_mask:0xf bank_mask:0xf
v_mfma_f32_16x16x32_bf16 v[188:191], v[4:7], v[212:215], v[188:191]
v_pk_add_f16 v206, v206, 1.0 op_sel_hi:[1,0]
v_cndmask_b32_dpp v169, v73, v169, vcc quad_perm:[1,0,3,2] row_mask:0xf bank_mask:0xf
v_bfe_u32 v202, v203, 2, 14
v_mfma_f32_16x16x32_bf16 v[176:179], v[40:43], v[32:35], v[176:179]
ds_read_b128 v[4:7], v250 offset:9216
ds_read_u16_d16 v200, v200
ds_read_u16_d16 v202, v202
v_rcp_f16_e64 v242, v241
v_cndmask_b32_dpp v170, v74, v170, vcc quad_perm:[1,0,3,2] row_mask:0xf bank_mask:0xf
v_mfma_f32_16x16x32_bf16 v[184:187], v[40:43], v[36:39], v[184:187]
v_cndmask_b32_dpp v171, v75, v171, vcc quad_perm:[1,0,3,2] row_mask:0xf bank_mask:0xf
v_lshrrev_b32 v201, 18, v201
v_lshrrev_b32 v203, 18, v203
v_mfma_f32_16x16x32_bf16 v[180:183], v[44:47], v[32:35], v[180:183]
ds_read_b128 v[40:43], v249 offset:12544
s_add_u32 s46, s70, 98304
buffer_store_dwordx4 v[56:59], v255, s[8:11], s46 offen sc1
ds_read_u16_d16_hi v201, v201
ds_read_u16_d16_hi v203, v203
v_rcp_f16_e64 v207, v206
v_mfma_f32_16x16x32_bf16 v[188:191], v[44:47], v[36:39], v[188:191]
v_rcp_f16_sdwa v242, v241 dst_sel:WORD_1 dst_unused:UNUSED_PRESERVE src0_sel:WORD_1
v_or_b32 v232, v192, v193
v_or_b32 v233, v194, v195
s_waitcnt lgkmcnt(6)
v_or_b32 v234, v196, v197
v_rcp_f16_sdwa v207, v206 dst_sel:WORD_1 dst_unused:UNUSED_PRESERVE src0_sel:WORD_1
v_or_b32 v235, v198, v199
s_waitcnt lgkmcnt(1)
v_or_b32 v236, v200, v201
s_waitcnt lgkmcnt(0)
v_or_b32_e64 v237, v202, v203
v_pk_mul_f16 v238, v243, v242
v_pk_mul_f16 v239, v240, v207
v_mfma_f32_16x16x32_f16 v[120:123], v[224:227], v[232:235], v[120:123]
buffer_load_dwordx4 v[12:15], v252, s[4:7], s68 offen offset:128
ds_read_b128 v[44:47], v250 offset:9472
v_cvt_pkrtz_f16_f32 v193, v176, v177
v_cvt_pkrtz_f16_f32 v195, v178, v179
v_mfma_f32_16x16x32_f16 v[128:131], v[224:227], v[236:239], v[128:131]
v_cvt_pkrtz_f16_f32 v197, v180, v181
v_cvt_pkrtz_f16_f32 v199, v182, v183
v_mfma_f32_16x16x32_f16 v[124:127], v[228:231], v[232:235], v[124:127]
ds_read_b128 v[224:227], v249 offset:13312
v_cvt_pkrtz_f16_f32 v201, v184, v185
v_cvt_pk_f16_f32 v243, v186, v187
v_cvt_pk_f16_f32 v240, v188, v189
v_mfma_f32_16x16x32_f16 v[132:135], v[228:231], v[236:239], v[132:135]
v_cvt_pk_f16_f32 v205, v190, v191
s_setprio 1
v_pk_fma_f16 v242, v243, v243, s48
v_mfma_f32_16x16x32_bf16 v[176:179], v[0:3], v[88:91], 0
ds_read_b128 v[228:231], v250 offset:10240
v_and_b32 v193, s49, v193
v_pk_fma_f16 v207, v240, v240, s48
v_mfma_f32_16x16x32_bf16 v[184:187], v[0:3], v[92:95], 0
v_and_b32_e64 v195, s49, v195
v_pk_fma_f16 v204, v205, v205, s48
v_bfe_u32 v192, v193, 2, 14
v_mfma_f32_16x16x32_f16 v[136:139], v[4:7], v[232:235], v[136:139]
ds_read_b128 v[0:3], v250 offset:10496
ds_read_u16_d16 v192, v192
v_pk_mul_f16 v242, v243, v242
v_bfe_u32 v194, v195, 2, 14
v_mfma_f32_16x16x32_f16 v[144:147], v[4:7], v[236:239], v[144:147]
v_pk_mul_f16 v207, v240, v207
v_lshrrev_b32_e64 v193, 18, v193
v_mfma_f32_16x16x32_bf16 v[180:183], v[40:43], v[88:91], 0
ds_read_b128 v[4:7], v249 offset:13568
ds_read_u16_d16 v194, v194
ds_read_u16_d16_hi v193, v193
v_pk_mul_f16 v204, v205, v204
v_lshrrev_b32_e64 v195, 18, v195
v_mfma_f32_16x16x32_bf16 v[188:191], v[40:43], v[92:95], 0
v_exp_f16_e64 v241, v242
v_and_b32 v197, s49, v197
s_waitcnt lgkmcnt(6)
v_mfma_f32_16x16x32_f16 v[140:143], v[44:47], v[232:235], v[140:143]
ds_read_b128 v[40:43], v249 offset:14336
ds_read_u16_d16_hi v195, v195
v_and_b32_e64 v199, s49, v199
v_mfma_f32_16x16x32_f16 v[148:151], v[44:47], v[236:239], v[148:151]
v_exp_f16_e64 v206, v207
v_bfe_u32 v196, v197, 2, 14
v_bfe_u32 v198, v199, 2, 14
v_mfma_f32_16x16x32_bf16 v[176:179], v[224:227], v[208:211], v[176:179]
ds_read_b128 v[44:47], v249 offset:14592
ds_read_u16_d16 v196, v196
ds_read_u16_d16 v198, v198
v_exp_f16_e64 v203, v204
v_mfma_f32_16x16x32_bf16 v[184:187], v[224:227], v[212:215], v[184:187]
v_lshrrev_b32_e64 v197, 18, v197
v_lshrrev_b32 v199, 18, v199
s_waitcnt lgkmcnt(7)
v_mfma_f32_16x16x32_f16 v[152:155], v[228:231], v[232:235], v[152:155]
ds_read_b128 v[224:227], v250 offset:14336
ds_read_u16_d16_hi v197, v197
ds_read_u16_d16_hi v199, v199
v_exp_f16_sdwa v241, v242 dst_sel:WORD_1 dst_unused:UNUSED_PRESERVE src0_sel:WORD_1
v_and_b32_e64 v201, s49, v201
v_mfma_f32_16x16x32_f16 v[160:163], v[228:231], v[236:239], v[160:163]
v_bfe_u32 v200, v201, 2, 14
v_mfma_f32_16x16x32_f16 v[156:159], v[0:3], v[232:235], v[156:159]
ds_read_b128 v[228:231], v250 offset:14592
ds_read_u16_d16 v200, v200
v_exp_f16_sdwa v206, v207 dst_sel:WORD_1 dst_unused:UNUSED_PRESERVE src0_sel:WORD_1
v_lshrrev_b32_e64 v201, 18, v201
v_mfma_f32_16x16x32_f16 v[164:167], v[0:3], v[236:239], v[164:167]
v_exp_f16_sdwa v203, v204 dst_sel:WORD_1 dst_unused:UNUSED_PRESERVE src0_sel:WORD_1
v_pk_add_f16 v241, v241, 1.0 op_sel_hi:[1,0]
v_mfma_f32_16x16x32_bf16 v[180:183], v[4:7], v[208:211], v[180:183]
ds_read_b128 v[0:3], v249 offset:18432
ds_read_u16_d16_hi v201, v201
v_pk_add_f16 v206, v206, 1.0 op_sel_hi:[1,0]
v_pk_add_f16 v203, v203, 1.0 op_sel_hi:[1,0]
v_mfma_f32_16x16x32_bf16 v[188:191], v[4:7], v[212:215], v[188:191]
v_rcp_f16_e64 v242, v241
s_setprio 0
s_waitcnt lgkmcnt(7)
v_mfma_f32_16x16x32_bf16 v[176:179], v[40:43], v[32:35], v[176:179]
ds_read_b128 v[4:7], v250 offset:15360
v_rcp_f16_e64 v207, v206
v_mfma_f32_16x16x32_bf16 v[184:187], v[40:43], v[36:39], v[184:187]
v_rcp_f16_e64 v204, v203
v_mfma_f32_16x16x32_bf16 v[180:183], v[44:47], v[32:35], v[180:183]
ds_read_b128 v[40:43], v249 offset:18688
v_rcp_f16_sdwa v242, v241 dst_sel:WORD_1 dst_unused:UNUSED_PRESERVE src0_sel:WORD_1
v_mfma_f32_16x16x32_bf16 v[188:191], v[44:47], v[36:39], v[188:191]
v_rcp_f16_sdwa v207, v206 dst_sel:WORD_1 dst_unused:UNUSED_PRESERVE src0_sel:WORD_1
v_or_b32 v232, v192, v193
v_or_b32 v233, v194, v195
s_waitcnt lgkmcnt(4)
v_or_b32 v234, v196, v197
v_rcp_f16_sdwa v204, v203 dst_sel:WORD_1 dst_unused:UNUSED_PRESERVE src0_sel:WORD_1
v_or_b32 v235, v198, v199
s_waitcnt lgkmcnt(2)
v_or_b32 v236, v200, v201
v_pk_mul_f16 v237, v243, v242
v_pk_mul_f16 v238, v240, v207
v_pk_mul_f16 v239, v205, v204
s_setprio 3
v_mfma_f32_16x16x32_f16 v[120:123], v[224:227], v[232:235], v[120:123]
s_add_u32 s46, s68, 98304
buffer_load_dwordx4 v[8:11], v252, s[4:7], s46 offen
ds_read_b128 v[44:47], v250 offset:15616
v_cvt_pkrtz_f16_f32 v193, v176, v177
v_cvt_pkrtz_f16_f32 v195, v178, v179
v_mfma_f32_16x16x32_f16 v[128:131], v[224:227], v[236:239], v[128:131]
v_cvt_pkrtz_f16_f32 v197, v180, v181
v_cvt_pkrtz_f16_f32 v199, v182, v183
v_mfma_f32_16x16x32_f16 v[124:127], v[228:231], v[232:235], v[124:127]
ds_read_b128 v[224:227], v249 offset:19456
v_cvt_pkrtz_f16_f32 v201, v184, v185
v_cvt_pk_f16_f32 v243, v186, v187
v_cvt_pk_f16_f32 v240, v188, v189
v_mfma_f32_16x16x32_f16 v[132:135], v[228:231], v[236:239], v[132:135]
v_cvt_pk_f16_f32 v205, v190, v191
v_pk_fma_f16 v242, v243, v243, s48
v_mfma_f32_16x16x32_bf16 v[176:179], v[0:3], v[88:91], 0
ds_read_b128 v[228:231], v250 offset:16384
v_and_b32_e64 v193, s49, v193
v_pk_fma_f16 v207, v240, v240, s48
v_mfma_f32_16x16x32_bf16 v[184:187], v[0:3], v[92:95], 0
v_and_b32 v195, s49, v195
v_pk_fma_f16 v204, v205, v205, s48
v_bfe_u32 v192, v193, 2, 14
s_waitcnt lgkmcnt(3)
v_mfma_f32_16x16x32_f16 v[136:139], v[4:7], v[232:235], v[136:139]
ds_read_b128 v[0:3], v250 offset:16640
ds_read_u16_d16 v192, v192
v_pk_mul_f16 v242, v243, v242
v_bfe_u32 v194, v195, 2, 14
v_mfma_f32_16x16x32_f16 v[144:147], v[4:7], v[236:239], v[144:147]
v_pk_mul_f16 v207, v240, v207
v_lshrrev_b32_e64 v193, 18, v193
v_mfma_f32_16x16x32_bf16 v[180:183], v[40:43], v[88:91], 0
ds_read_b128 v[4:7], v249 offset:19712
ds_read_u16_d16 v194, v194
ds_read_u16_d16_hi v193, v193
v_pk_mul_f16 v204, v205, v204
v_lshrrev_b32_e64 v195, 18, v195
v_mfma_f32_16x16x32_bf16 v[188:191], v[40:43], v[92:95], 0
v_exp_f16_e64 v241, v242
v_and_b32 v197, s49, v197
s_waitcnt lgkmcnt(5)
v_mfma_f32_16x16x32_f16 v[140:143], v[44:47], v[232:235], v[140:143]
ds_read_b128 v[40:43], v249 offset:20480
ds_read_u16_d16_hi v195, v195
v_and_b32_e64 v199, s49, v199
v_mfma_f32_16x16x32_f16 v[148:151], v[44:47], v[236:239], v[148:151]
v_exp_f16_e64 v206, v207
v_bfe_u32 v196, v197, 2, 14
v_bfe_u32 v198, v199, 2, 14
v_mfma_f32_16x16x32_bf16 v[176:179], v[224:227], v[208:211], v[176:179]
s_add_u32 s46, s70, 98304
buffer_store_dwordx4 v[76:79], v255, s[8:11], s46 offen offset:128 sc1
ds_read_b128 v[44:47], v249 offset:20736
ds_read_u16_d16 v196, v196
ds_read_u16_d16 v198, v198
v_exp_f16_e64 v203, v204
v_mfma_f32_16x16x32_bf16 v[184:187], v[224:227], v[212:215], v[184:187]
v_lshrrev_b32 v197, 18, v197
v_lshrrev_b32 v199, 18, v199
v_mfma_f32_16x16x32_f16 v[152:155], v[228:231], v[232:235], v[152:155]
ds_read_b128 v[224:227], v250 offset:20480
ds_read_u16_d16_hi v197, v197
ds_read_u16_d16_hi v199, v199
v_exp_f16_sdwa v241, v242 dst_sel:WORD_1 dst_unused:UNUSED_PRESERVE src0_sel:WORD_1
v_and_b32 v201, s49, v201
v_mfma_f32_16x16x32_f16 v[160:163], v[228:231], v[236:239], v[160:163]
v_bfe_u32 v200, v201, 2, 14
s_waitcnt lgkmcnt(7)
v_mfma_f32_16x16x32_f16 v[156:159], v[0:3], v[232:235], v[156:159]
ds_read_b128 v[228:231], v250 offset:20736
ds_read_u16_d16 v200, v200
v_exp_f16_sdwa v206, v207 dst_sel:WORD_1 dst_unused:UNUSED_PRESERVE src0_sel:WORD_1
v_lshrrev_b32_e64 v201, 18, v201
v_mfma_f32_16x16x32_f16 v[164:167], v[0:3], v[236:239], v[164:167]
v_exp_f16_sdwa v203, v204 dst_sel:WORD_1 dst_unused:UNUSED_PRESERVE src0_sel:WORD_1
v_pk_add_f16 v241, v241, 1.0 op_sel_hi:[1,0]
v_mfma_f32_16x16x32_bf16 v[180:183], v[4:7], v[208:211], v[180:183]
ds_read_b128 v[0:3], v248 offset:16384
ds_read_u16_d16_hi v201, v201
v_pk_add_f16 v206, v206, 1.0 op_sel_hi:[1,0]
v_pk_add_f16 v203, v203, 1.0 op_sel_hi:[1,0]
v_mfma_f32_16x16x32_bf16 v[188:191], v[4:7], v[212:215], v[188:191]
v_rcp_f16_e64 v242, v241
v_mfma_f32_16x16x32_bf16 v[176:179], v[40:43], v[32:35], v[176:179]
ds_read_b128 v[4:7], v250 offset:21504
v_rcp_f16_e64 v207, v206
v_mfma_f32_16x16x32_bf16 v[184:187], v[40:43], v[36:39], v[184:187]
v_rcp_f16 v204, v203
s_waitcnt lgkmcnt(5)
v_mfma_f32_16x16x32_bf16 v[180:183], v[44:47], v[32:35], v[180:183]
ds_read_b128 v[40:43], v248 offset:16640
v_rcp_f16_sdwa v242, v241 dst_sel:WORD_1 dst_unused:UNUSED_PRESERVE src0_sel:WORD_1
v_mfma_f32_16x16x32_bf16 v[188:191], v[44:47], v[36:39], v[188:191]
v_rcp_f16_sdwa v207, v206 dst_sel:WORD_1 dst_unused:UNUSED_PRESERVE src0_sel:WORD_1
v_or_b32 v232, v192, v193
v_or_b32 v233, v194, v195
v_or_b32_e64 v234, v196, v197
v_rcp_f16_sdwa v204, v203 dst_sel:WORD_1 dst_unused:UNUSED_PRESERVE src0_sel:WORD_1
v_or_b32 v235, v198, v199
s_waitcnt lgkmcnt(2)
v_or_b32_e64 v236, v200, v201
v_pk_mul_f16 v237, v243, v242
v_pk_mul_f16 v238, v240, v207
v_pk_mul_f16 v239, v205, v204
v_mfma_f32_16x16x32_f16 v[120:123], v[224:227], v[232:235], v[120:123]
ds_read_b128 v[44:47], v250 offset:21760
v_cvt_pkrtz_f16_f32 v193, v176, v177
v_cvt_pkrtz_f16_f32 v195, v178, v179
v_mfma_f32_16x16x32_f16 v[128:131], v[224:227], v[236:239], v[128:131]
v_cvt_pkrtz_f16_f32 v197, v180, v181
v_cvt_pkrtz_f16_f32 v199, v182, v183
v_mfma_f32_16x16x32_f16 v[124:127], v[228:231], v[232:235], v[124:127]
ds_read_b128 v[224:227], v248 offset:17408
v_cvt_pkrtz_f16_f32 v201, v184, v185
v_cvt_pk_f16_f32 v243, v186, v187
v_cvt_pk_f16_f32 v240, v188, v189
v_mfma_f32_16x16x32_f16 v[132:135], v[228:231], v[236:239], v[132:135]
v_cvt_pk_f16_f32 v205, v190, v191
v_pk_fma_f16 v242, v243, v243, s48
s_waitcnt vmcnt(14)
v_mfma_f32_16x16x32_bf16 v[176:179], v[0:3], v[96:99], 0
ds_read_b128 v[228:231], v250 offset:22528
v_and_b32 v193, s49, v193
v_pk_fma_f16 v207, v240, v240, s48
s_waitcnt vmcnt(13)
v_mfma_f32_16x16x32_bf16 v[184:187], v[0:3], v[100:103], 0
v_and_b32 v195, s49, v195
v_pk_fma_f16 v204, v205, v205, s48
s_setprio 2
v_bfe_u32 v192, v193, 2, 14
s_waitcnt lgkmcnt(2)
v_mfma_f32_16x16x32_f16 v[136:139], v[4:7], v[232:235], v[136:139]
ds_read_b128 v[0:3], v250 offset:22784
ds_read_u16_d16 v192, v192
v_pk_mul_f16 v242, v243, v242
v_bfe_u32 v194, v195, 2, 14
v_mfma_f32_16x16x32_f16 v[144:147], v[4:7], v[236:239], v[144:147]
v_pk_mul_f16 v207, v240, v207
v_lshrrev_b32_e64 v193, 18, v193
v_mfma_f32_16x16x32_bf16 v[180:183], v[40:43], v[96:99], 0
ds_read_b128 v[4:7], v248 offset:17664
ds_read_u16_d16 v194, v194
ds_read_u16_d16_hi v193, v193
v_pk_mul_f16 v204, v205, v204
v_lshrrev_b32_e64 v195, 18, v195
v_mfma_f32_16x16x32_bf16 v[188:191], v[40:43], v[100:103], 0
v_exp_f16 v241, v242
v_and_b32 v197, s49, v197
v_mfma_f32_16x16x32_f16 v[140:143], v[44:47], v[232:235], v[140:143]
ds_read_b128 v[40:43], v248 offset:18432
ds_read_u16_d16_hi v195, v195
v_and_b32_e64 v199, s49, v199
v_mfma_f32_16x16x32_f16 v[148:151], v[44:47], v[236:239], v[148:151]
v_exp_f16 v206, v207
v_bfe_u32 v196, v197, 2, 14
v_bfe_u32 v198, v199, 2, 14
s_waitcnt vmcnt(12) lgkmcnt(7)
v_mfma_f32_16x16x32_bf16 v[176:179], v[224:227], v[104:107], v[176:179]
ds_read_b128 v[44:47], v248 offset:18688
ds_read_u16_d16 v196, v196
ds_read_u16_d16 v198, v198
v_exp_f16 v203, v204
s_waitcnt vmcnt(11)
v_mfma_f32_16x16x32_bf16 v[184:187], v[224:227], v[108:111], v[184:187]
v_lshrrev_b32 v197, 18, v197
v_lshrrev_b32 v199, 18, v199
v_mfma_f32_16x16x32_f16 v[152:155], v[228:231], v[232:235], v[152:155]
ds_read_b128 v[224:227], v250 offset:26624
ds_read_u16_d16_hi v197, v197
ds_read_u16_d16_hi v199, v199
v_exp_f16_sdwa v241, v242 dst_sel:WORD_1 dst_unused:UNUSED_PRESERVE src0_sel:WORD_1
v_and_b32 v201, s49, v201
v_mfma_f32_16x16x32_f16 v[160:163], v[228:231], v[236:239], v[160:163]
v_bfe_u32 v200, v201, 2, 14
s_waitcnt lgkmcnt(7)
v_mfma_f32_16x16x32_f16 v[156:159], v[0:3], v[232:235], v[156:159]
ds_read_b128 v[228:231], v250 offset:26880
ds_read_u16_d16 v200, v200
v_exp_f16_sdwa v206, v207 dst_sel:WORD_1 dst_unused:UNUSED_PRESERVE src0_sel:WORD_1
v_lshrrev_b32_e64 v201, 18, v201
v_mfma_f32_16x16x32_f16 v[164:167], v[0:3], v[236:239], v[164:167]
v_exp_f16_sdwa v203, v204 dst_sel:WORD_1 dst_unused:UNUSED_PRESERVE src0_sel:WORD_1
v_pk_add_f16 v241, v241, 1.0 op_sel_hi:[1,0]
v_mfma_f32_16x16x32_bf16 v[180:183], v[4:7], v[104:107], v[180:183]
ds_read_b128 v[0:3], v248 offset:22528
ds_read_u16_d16_hi v201, v201
v_pk_add_f16 v206, v206, 1.0 op_sel_hi:[1,0]
v_pk_add_f16 v203, v203, 1.0 op_sel_hi:[1,0]
v_mfma_f32_16x16x32_bf16 v[188:191], v[4:7], v[108:111], v[188:191]
v_rcp_f16 v242, v241
s_waitcnt vmcnt(10)
v_mfma_f32_16x16x32_bf16 v[176:179], v[40:43], v[112:115], v[176:179]
ds_read_b128 v[4:7], v250 offset:27648
v_rcp_f16 v207, v206
s_waitcnt vmcnt(7)
v_mfma_f32_16x16x32_bf16 v[184:187], v[40:43], v[116:119], v[184:187]
v_rcp_f16 v204, v203
s_waitcnt lgkmcnt(5)
v_mfma_f32_16x16x32_bf16 v[180:183], v[44:47], v[112:115], v[180:183]
ds_read_b128 v[40:43], v248 offset:22784
v_rcp_f16_sdwa v242, v241 dst_sel:WORD_1 dst_unused:UNUSED_PRESERVE src0_sel:WORD_1
v_mfma_f32_16x16x32_bf16 v[188:191], v[44:47], v[116:119], v[188:191]
v_rcp_f16_sdwa v207, v206 dst_sel:WORD_1 dst_unused:UNUSED_PRESERVE src0_sel:WORD_1
v_or_b32 v232, v192, v193
v_or_b32 v233, v194, v195
v_or_b32_e64 v234, v196, v197
v_rcp_f16_sdwa v204, v203 dst_sel:WORD_1 dst_unused:UNUSED_PRESERVE src0_sel:WORD_1
v_or_b32 v235, v198, v199
s_waitcnt lgkmcnt(2)
v_or_b32_e64 v236, v200, v201
v_pk_mul_f16 v237, v243, v242
v_pk_mul_f16 v238, v240, v207
v_pk_mul_f16 v239, v205, v204
v_mfma_f32_16x16x32_f16 v[120:123], v[224:227], v[232:235], v[120:123]
s_add_u32 s46, s68, 98304
buffer_load_dwordx4 v[36:39], v252, s[4:7], s46 offen offset:64
ds_read_b128 v[44:47], v250 offset:27904
v_cvt_pkrtz_f16_f32 v193, v176, v177
v_cvt_pkrtz_f16_f32 v195, v178, v179
v_mfma_f32_16x16x32_f16 v[128:131], v[224:227], v[236:239], v[128:131]
v_cvt_pkrtz_f16_f32 v197, v180, v181
v_cvt_pkrtz_f16_f32 v199, v182, v183
v_mfma_f32_16x16x32_f16 v[124:127], v[228:231], v[232:235], v[124:127]
ds_read_b128 v[224:227], v248 offset:23552
v_cvt_pkrtz_f16_f32 v201, v184, v185
v_cvt_pk_f16_f32 v243, v186, v187
v_mfma_f32_16x16x32_f16 v[132:135], v[228:231], v[236:239], v[132:135]
v_cvt_pk_f16_f32 v240, v188, v189
v_cvt_pk_f16_f32 v205, v190, v191
s_setprio 1
v_mfma_f32_16x16x32_bf16 v[176:179], v[0:3], v[96:99], 0
ds_read_b128 v[228:231], v250 offset:28672
v_pk_fma_f16 v242, v243, v243, s48
v_and_b32 v193, s49, v193
v_mfma_f32_16x16x32_bf16 v[184:187], v[0:3], v[100:103], 0
v_pk_fma_f16 v207, v240, v240, s48
v_and_b32 v195, s49, v195
s_waitcnt lgkmcnt(3)
v_mfma_f32_16x16x32_f16 v[136:139], v[4:7], v[232:235], v[136:139]
ds_read_b128 v[0:3], v250 offset:28928
v_pk_fma_f16 v204, v205, v205, s48
v_bfe_u32 v192, v193, 2, 14
v_pk_mul_f16 v242, v243, v242
v_mfma_f32_16x16x32_f16 v[144:147], v[4:7], v[236:239], v[144:147]
v_bfe_u32 v194, v195, 2, 14
v_pk_mul_f16 v207, v240, v207
s_waitcnt vmcnt(7)
v_mfma_f32_16x16x32_bf16 v[120:123], v[26:29], v[244:247], v[120:123]
ds_read_b128 v[4:7], v248 offset:23808
ds_read_u16_d16 v192, v192
ds_read_u16_d16 v194, v194
v_lshrrev_b32 v193, 18, v193
v_pk_mul_f16 v204, v205, v204
v_mfma_f32_16x16x32_bf16 v[124:127], v[24:27], v[244:247], v[124:127]
v_lshrrev_b32_e64 v195, 18, v195
v_mfma_f32_16x16x32_bf16 v[180:183], v[40:43], v[96:99], 0
ds_read_u16_d16_hi v193, v193
ds_read_u16_d16_hi v195, v195
v_exp_f16 v241, v242
v_and_b32 v197, s49, v197
v_mfma_f32_16x16x32_bf16 v[188:191], v[40:43], v[100:103], 0
v_and_b32 v199, s49, v199
s_waitcnt lgkmcnt(6)
v_mfma_f32_16x16x32_f16 v[140:143], v[44:47], v[232:235], v[140:143]
ds_read_b128 v[40:43], v248 offset:24576
v_exp_f16_e64 v206, v207
v_bfe_u32 v196, v197, 2, 14
v_mfma_f32_16x16x32_f16 v[148:151], v[44:47], v[236:239], v[148:151]
v_bfe_u32 v198, v199, 2, 14
v_exp_f16_e64 v203, v204
v_mfma_f32_16x16x32_bf16 v[176:179], v[224:227], v[104:107], v[176:179]
s_add_u32 s46, s70, 98304
buffer_store_dwordx4 v[168:171], v255, s[8:11], s46 offen offset:256 sc1
ds_read_b128 v[44:47], v248 offset:24832
ds_read_u16_d16 v196, v196
ds_read_u16_d16 v198, v198
v_lshrrev_b32 v197, 18, v197
v_lshrrev_b32 v199, 18, v199
v_mfma_f32_16x16x32_bf16 v[184:187], v[224:227], v[108:111], v[184:187]
v_exp_f16_sdwa v241, v242 dst_sel:WORD_1 dst_unused:UNUSED_PRESERVE src0_sel:WORD_1
v_mfma_f32_16x16x32_f16 v[152:155], v[228:231], v[232:235], v[152:155]
ds_read_b128 v[224:227], v249 offset:24576
ds_read_u16_d16_hi v197, v197
ds_read_u16_d16_hi v199, v199
v_and_b32 v201, s49, v201
v_bfe_u32 v200, v201, 2, 14
v_mfma_f32_16x16x32_f16 v[160:163], v[228:231], v[236:239], v[160:163]
v_exp_f16_sdwa v206, v207 dst_sel:WORD_1 dst_unused:UNUSED_PRESERVE src0_sel:WORD_1
s_waitcnt lgkmcnt(7)
v_mfma_f32_16x16x32_f16 v[156:159], v[0:3], v[232:235], v[156:159]
ds_read_b128 v[228:231], v254 offset:7936
ds_read_u16_d16 v200, v200
v_lshrrev_b32_e64 v201, 18, v201
v_mfma_f32_16x16x32_f16 v[164:167], v[0:3], v[236:239], v[164:167]
v_exp_f16_sdwa v203, v204 dst_sel:WORD_1 dst_unused:UNUSED_PRESERVE src0_sel:WORD_1
v_pk_add_f16 v241, v241, 1.0 op_sel_hi:[1,0]
v_pk_add_f16 v206, v206, 1.0 op_sel_hi:[1,0]
v_mfma_f32_16x16x32_bf16 v[180:183], v[4:7], v[104:107], v[180:183]
ds_read_b128 v[0:3], v249 offset:24832
ds_read_u16_d16_hi v201, v201
v_pk_add_f16 v203, v203, 1.0 op_sel_hi:[1,0]
v_mfma_f32_16x16x32_bf16 v[188:191], v[4:7], v[108:111], v[188:191]
v_rcp_f16_e64 v242, v241
s_setprio 0
s_waitcnt lgkmcnt(7)
v_mfma_f32_16x16x32_bf16 v[176:179], v[40:43], v[112:115], v[176:179]
ds_read_b128 v[4:7], v254 offset:7952
v_rcp_f16_e64 v207, v206
v_mfma_f32_16x16x32_bf16 v[184:187], v[40:43], v[116:119], v[184:187]
v_rcp_f16_e64 v204, v203
v_mfma_f32_16x16x32_bf16 v[180:183], v[44:47], v[112:115], v[180:183]
ds_read_b128 v[40:43], v248 offset:28672
v_rcp_f16_sdwa v242, v241 dst_sel:WORD_1 dst_unused:UNUSED_PRESERVE src0_sel:WORD_1
v_mfma_f32_16x16x32_bf16 v[188:191], v[44:47], v[116:119], v[188:191]
v_rcp_f16_sdwa v207, v206 dst_sel:WORD_1 dst_unused:UNUSED_PRESERVE src0_sel:WORD_1
v_or_b32 v232, v192, v193
v_or_b32 v233, v194, v195
s_waitcnt lgkmcnt(4)
v_or_b32 v234, v196, v197
v_rcp_f16_sdwa v204, v203 dst_sel:WORD_1 dst_unused:UNUSED_PRESERVE src0_sel:WORD_1
v_or_b32 v235, v198, v199
s_waitcnt lgkmcnt(2)
v_or_b32 v236, v200, v201
v_pk_mul_f16 v237, v243, v242
v_pk_mul_f16 v238, v240, v207
v_pk_mul_f16 v239, v205, v204
s_setprio 3
v_mfma_f32_16x16x32_f16 v[48:51], v[224:227], v[232:235], v[228:231]
ds_read_b128 v[44:47], v249 offset:25600
v_cvt_pkrtz_f16_f32 v193, v176, v177
v_cvt_pkrtz_f16_f32 v195, v178, v179
v_mfma_f32_16x16x32_f16 v[56:59], v[224:227], v[236:239], v[228:231]
v_cvt_pkrtz_f16_f32 v197, v180, v181
v_cvt_pkrtz_f16_f32 v199, v182, v183
s_waitcnt lgkmcnt(2)
v_mfma_f32_16x16x32_f16 v[52:55], v[0:3], v[232:235], v[4:7]
ds_read_b128 v[224:227], v254 offset:8064
ds_read_b128 v[228:231], v248 offset:28928
v_cvt_pkrtz_f16_f32 v201, v184, v185
v_cvt_pk_f16_f32 v243, v186, v187
v_mfma_f32_16x16x32_f16 v[60:63], v[0:3], v[236:239], v[4:7]
v_cvt_pk_f16_f32 v240, v188, v189
v_cvt_pk_f16_f32 v205, v190, v191
s_waitcnt lgkmcnt(3)
v_mfma_f32_16x16x32_bf16 v[176:179], v[40:43], v[96:99], 0
ds_read_b128 v[0:3], v249 offset:25856
ds_read_b128 v[4:7], v254 offset:8080
v_pk_fma_f16 v242, v243, v243, s48
v_and_b32_e64 v193, s49, v193
v_mfma_f32_16x16x32_bf16 v[184:187], v[40:43], v[100:103], 0
v_pk_fma_f16 v207, v240, v240, s48
v_and_b32 v195, s49, v195
s_waitcnt lgkmcnt(3)
v_mfma_f32_16x16x32_f16 v[64:67], v[44:47], v[232:235], v[224:227]
ds_read_b128 v[40:43], v248 offset:29696
v_pk_fma_f16 v204, v205, v205, s48
v_bfe_u32 v192, v193, 2, 14
v_pk_mul_f16 v242, v243, v242
v_mfma_f32_16x16x32_f16 v[72:75], v[44:47], v[236:239], v[224:227]
v_bfe_u32 v194, v195, 2, 14
v_pk_mul_f16 v207, v240, v207
s_waitcnt vmcnt(6)
v_mfma_f32_16x16x32_bf16 v[136:139], v[26:29], v[216:219], v[136:139]
ds_read_b128 v[44:47], v249 offset:26624
ds_read_b128 v[224:227], v254 offset:16128
ds_read_u16_d16 v192, v192
ds_read_u16_d16 v194, v194
v_lshrrev_b32 v193, 18, v193
v_pk_mul_f16 v204, v205, v204
v_mfma_f32_16x16x32_bf16 v[140:143], v[24:27], v[216:219], v[140:143]
v_lshrrev_b32 v195, 18, v195
s_waitcnt lgkmcnt(5)
v_mfma_f32_16x16x32_bf16 v[180:183], v[228:231], v[96:99], 0
ds_read_u16_d16_hi v193, v193
ds_read_u16_d16_hi v195, v195
v_exp_f16 v241, v242
v_and_b32 v197, s49, v197
v_mfma_f32_16x16x32_bf16 v[188:191], v[228:231], v[100:103], 0
v_and_b32_e64 v199, s49, v199
v_mfma_f32_16x16x32_f16 v[68:71], v[0:3], v[232:235], v[4:7]
ds_read_b128 v[228:231], v249 offset:26880
v_exp_f16_e64 v206, v207
v_bfe_u32 v196, v197, 2, 14
v_mfma_f32_16x16x32_f16 v[76:79], v[0:3], v[236:239], v[4:7]
v_bfe_u32 v198, v199, 2, 14
v_exp_f16 v203, v204
s_waitcnt lgkmcnt(7)
v_mfma_f32_16x16x32_bf16 v[176:179], v[40:43], v[104:107], v[176:179]
ds_read_b128 v[0:3], v254 offset:16144
ds_read_b128 v[4:7], v248 offset:29952
ds_read_u16_d16 v196, v196
ds_read_u16_d16 v198, v198
v_lshrrev_b32_e64 v197, 18, v197
v_lshrrev_b32 v199, 18, v199
v_mfma_f32_16x16x32_bf16 v[184:187], v[40:43], v[108:111], v[184:187]
v_exp_f16_sdwa v241, v242 dst_sel:WORD_1 dst_unused:UNUSED_PRESERVE src0_sel:WORD_1
s_waitcnt lgkmcnt(7)
v_mfma_f32_16x16x32_f16 v[80:83], v[44:47], v[232:235], v[224:227]
ds_read_b128 v[40:43], v248 offset:30720
ds_read_u16_d16_hi v197, v197
ds_read_u16_d16_hi v199, v199
v_and_b32 v201, s49, v201
v_bfe_u32 v200, v201, 2, 14
v_mfma_f32_16x16x32_f16 v[168:171], v[44:47], v[236:239], v[224:227]
v_exp_f16_sdwa v206, v207 dst_sel:WORD_1 dst_unused:UNUSED_PRESERVE src0_sel:WORD_1
s_waitcnt lgkmcnt(6)
v_mfma_f32_16x16x32_f16 v[84:87], v[228:231], v[232:235], v[0:3]
ds_read_b128 v[44:47], v248 offset:30976
ds_read_b128 v[224:227], v249 offset:30720
ds_read_u16_d16 v200, v200
v_lshrrev_b32 v201, 18, v201
v_mfma_f32_16x16x32_f16 v[172:175], v[228:231], v[236:239], v[0:3]
v_exp_f16_sdwa v203, v204 dst_sel:WORD_1 dst_unused:UNUSED_PRESERVE src0_sel:WORD_1
v_pk_add_f16 v241, v241, 1.0 op_sel_hi:[1,0]
v_pk_add_f16 v206, v206, 1.0 op_sel_hi:[1,0]
s_waitcnt lgkmcnt(7)
v_mfma_f32_16x16x32_bf16 v[180:183], v[4:7], v[104:107], v[180:183]
ds_read_b128 v[228:231], v249 offset:30976
ds_read_b128 v[0:3], v248 offset:34816
ds_read_u16_d16_hi v201, v201
v_pk_add_f16 v203, v203, 1.0 op_sel_hi:[1,0]
v_mfma_f32_16x16x32_bf16 v[188:191], v[4:7], v[108:111], v[188:191]
v_rcp_f16 v242, v241
s_waitcnt lgkmcnt(8)
v_mfma_f32_16x16x32_bf16 v[176:179], v[40:43], v[112:115], v[176:179]
ds_read_b128 v[4:7], v249 offset:31744
v_rcp_f16_e64 v207, v206
v_mfma_f32_16x16x32_bf16 v[184:187], v[40:43], v[116:119], v[184:187]
v_rcp_f16 v204, v203
s_waitcnt lgkmcnt(6)
v_mfma_f32_16x16x32_bf16 v[180:183], v[44:47], v[112:115], v[180:183]
ds_read_b128 v[40:43], v248 offset:35072
v_rcp_f16_sdwa v242, v241 dst_sel:WORD_1 dst_unused:UNUSED_PRESERVE src0_sel:WORD_1
v_mfma_f32_16x16x32_bf16 v[188:191], v[44:47], v[116:119], v[188:191]
v_rcp_f16_sdwa v207, v206 dst_sel:WORD_1 dst_unused:UNUSED_PRESERVE src0_sel:WORD_1
v_or_b32 v232, v192, v193
v_or_b32 v233, v194, v195
v_or_b32_e64 v234, v196, v197
v_rcp_f16_sdwa v204, v203 dst_sel:WORD_1 dst_unused:UNUSED_PRESERVE src0_sel:WORD_1
v_or_b32 v235, v198, v199
s_waitcnt lgkmcnt(2)
v_or_b32_e64 v236, v200, v201
v_pk_mul_f16 v237, v243, v242
v_pk_mul_f16 v238, v240, v207
v_pk_mul_f16 v239, v205, v204
v_mfma_f32_16x16x32_f16 v[48:51], v[224:227], v[232:235], v[48:51]
s_add_u32 s46, s68, 98304
buffer_load_dwordx4 v[216:219], v252, s[4:7], s46 offen offset:128
ds_read_b128 v[44:47], v249 offset:32000
v_cvt_pkrtz_f16_f32 v193, v176, v177
v_cvt_pkrtz_f16_f32 v195, v178, v179
v_mfma_f32_16x16x32_f16 v[56:59], v[224:227], v[236:239], v[56:59]
v_cvt_pkrtz_f16_f32 v197, v180, v181
v_cvt_pkrtz_f16_f32 v199, v182, v183
v_mfma_f32_16x16x32_f16 v[52:55], v[228:231], v[232:235], v[52:55]
ds_read_b128 v[224:227], v248 offset:35840
v_cvt_pkrtz_f16_f32 v201, v184, v185
v_cvt_pk_f16_f32 v243, v186, v187
v_mfma_f32_16x16x32_f16 v[60:63], v[228:231], v[236:239], v[60:63]
v_cvt_pk_f16_f32 v240, v188, v189
v_cvt_pk_f16_f32 v205, v190, v191
v_mfma_f32_16x16x32_bf16 v[176:179], v[0:3], v[96:99], 0
ds_read_b128 v[228:231], v249 offset:32768
v_pk_fma_f16 v242, v243, v243, s48
v_and_b32_e64 v193, s49, v193
v_mfma_f32_16x16x32_bf16 v[184:187], v[0:3], v[100:103], 0
v_pk_fma_f16 v207, v240, v240, s48
v_and_b32 v195, s49, v195
s_waitcnt lgkmcnt(3)
v_mfma_f32_16x16x32_f16 v[64:67], v[4:7], v[232:235], v[64:67]
ds_read_b128 v[0:3], v249 offset:33024
v_pk_fma_f16 v204, v205, v205, s48
s_setprio 2
v_bfe_u32 v192, v193, 2, 14
v_pk_mul_f16 v242, v243, v242
v_mfma_f32_16x16x32_f16 v[72:75], v[4:7], v[236:239], v[72:75]
v_bfe_u32 v194, v195, 2, 14
v_pk_mul_f16 v207, v240, v207
s_waitcnt vmcnt(5)
v_mfma_f32_16x16x32_bf16 v[152:155], v[26:29], v[12:15], v[152:155]
ds_read_b128 v[4:7], v248 offset:36096
ds_read_u16_d16 v192, v192
ds_read_u16_d16 v194, v194
v_lshrrev_b32_e64 v193, 18, v193
v_pk_mul_f16 v204, v205, v204
v_mfma_f32_16x16x32_bf16 v[156:159], v[24:27], v[12:15], v[156:159]
v_lshrrev_b32_e64 v195, 18, v195
v_mfma_f32_16x16x32_bf16 v[180:183], v[40:43], v[96:99], 0
ds_read_u16_d16_hi v193, v193
ds_read_u16_d16_hi v195, v195
v_exp_f16 v241, v242
v_and_b32 v197, s49, v197
v_mfma_f32_16x16x32_bf16 v[188:191], v[40:43], v[100:103], 0
v_and_b32 v199, s49, v199
s_waitcnt lgkmcnt(6)
v_mfma_f32_16x16x32_f16 v[68:71], v[44:47], v[232:235], v[68:71]
ds_read_b128 v[40:43], v248 offset:36864
v_exp_f16_e64 v206, v207
v_bfe_u32 v196, v197, 2, 14
v_mfma_f32_16x16x32_f16 v[76:79], v[44:47], v[236:239], v[76:79]
v_bfe_u32 v198, v199, 2, 14
v_exp_f16_e64 v203, v204
v_mfma_f32_16x16x32_bf16 v[176:179], v[224:227], v[104:107], v[176:179]
ds_read_b128 v[44:47], v248 offset:37120
ds_read_u16_d16 v196, v196
ds_read_u16_d16 v198, v198
v_lshrrev_b32 v197, 18, v197
v_lshrrev_b32 v199, 18, v199
v_mfma_f32_16x16x32_bf16 v[184:187], v[224:227], v[108:111], v[184:187]
v_exp_f16_sdwa v241, v242 dst_sel:WORD_1 dst_unused:UNUSED_PRESERVE src0_sel:WORD_1
v_mfma_f32_16x16x32_f16 v[80:83], v[228:231], v[232:235], v[80:83]
ds_read_b128 v[224:227], v249 offset:36864
ds_read_u16_d16_hi v197, v197
ds_read_u16_d16_hi v199, v199
v_and_b32 v201, s49, v201
v_bfe_u32 v200, v201, 2, 14
v_mfma_f32_16x16x32_f16 v[168:171], v[228:231], v[236:239], v[168:171]
v_exp_f16_sdwa v206, v207 dst_sel:WORD_1 dst_unused:UNUSED_PRESERVE src0_sel:WORD_1
s_waitcnt lgkmcnt(7)
v_mfma_f32_16x16x32_f16 v[84:87], v[0:3], v[232:235], v[84:87]
ds_read_b128 v[228:231], v249 offset:37120
ds_read_u16_d16 v200, v200
v_lshrrev_b32_e64 v201, 18, v201
v_mfma_f32_16x16x32_f16 v[172:175], v[0:3], v[236:239], v[172:175]
v_exp_f16_sdwa v203, v204 dst_sel:WORD_1 dst_unused:UNUSED_PRESERVE src0_sel:WORD_1
v_pk_add_f16 v241, v241, 1.0 op_sel_hi:[1,0]
v_pk_add_f16 v206, v206, 1.0 op_sel_hi:[1,0]
v_mfma_f32_16x16x32_bf16 v[180:183], v[4:7], v[104:107], v[180:183]
ds_read_b128 v[0:3], v248 offset:40960
ds_read_u16_d16_hi v201, v201
v_pk_add_f16 v203, v203, 1.0 op_sel_hi:[1,0]
v_mfma_f32_16x16x32_bf16 v[188:191], v[4:7], v[108:111], v[188:191]
v_rcp_f16 v242, v241
s_waitcnt lgkmcnt(7)
v_mfma_f32_16x16x32_bf16 v[176:179], v[40:43], v[112:115], v[176:179]
ds_read_b128 v[4:7], v249 offset:37888
v_rcp_f16_e64 v207, v206
v_mfma_f32_16x16x32_bf16 v[184:187], v[40:43], v[116:119], v[184:187]
v_rcp_f16_e64 v204, v203
v_mfma_f32_16x16x32_bf16 v[180:183], v[44:47], v[112:115], v[180:183]
ds_read_b128 v[40:43], v248 offset:41216
v_rcp_f16_sdwa v242, v241 dst_sel:WORD_1 dst_unused:UNUSED_PRESERVE src0_sel:WORD_1
v_mfma_f32_16x16x32_bf16 v[188:191], v[44:47], v[116:119], v[188:191]
v_rcp_f16_sdwa v207, v206 dst_sel:WORD_1 dst_unused:UNUSED_PRESERVE src0_sel:WORD_1
v_or_b32 v232, v192, v193
v_or_b32 v233, v194, v195
s_waitcnt lgkmcnt(4)
v_or_b32 v234, v196, v197
v_rcp_f16_sdwa v204, v203 dst_sel:WORD_1 dst_unused:UNUSED_PRESERVE src0_sel:WORD_1
v_or_b32 v235, v198, v199
s_waitcnt lgkmcnt(2)
v_or_b32_e64 v236, v200, v201
v_pk_mul_f16 v237, v243, v242
v_pk_mul_f16 v238, v240, v207
v_pk_mul_f16 v239, v205, v204
v_mfma_f32_16x16x32_f16 v[48:51], v[224:227], v[232:235], v[48:51]
buffer_load_dwordx4 v[12:15], v252, s[4:7], s69 offen
ds_read_b128 v[44:47], v249 offset:38144
v_cvt_pkrtz_f16_f32 v193, v176, v177
v_cvt_pkrtz_f16_f32 v195, v178, v179
v_cvt_pkrtz_f16_f32 v197, v180, v181
v_mfma_f32_16x16x32_f16 v[56:59], v[224:227], v[236:239], v[56:59]
v_cvt_pkrtz_f16_f32 v199, v182, v183
v_cvt_pkrtz_f16_f32 v201, v184, v185
v_cvt_pkrtz_f16_f32 v203, v186, v187
v_mfma_f32_16x16x32_f16 v[52:55], v[228:231], v[232:235], v[52:55]
ds_read_b128 v[224:227], v248 offset:41984
v_cvt_pk_f16_f32 v243, v188, v189
v_cvt_pk_f16_f32 v240, v190, v191
v_pk_fma_f16 v242, v243, v243, s48
s_setprio 1
v_mfma_f32_16x16x32_f16 v[60:63], v[228:231], v[236:239], v[60:63]
v_cvt_pk_bf16_f32 v136, v136, v137
v_and_b32 v193, s49, v193
v_cvt_pk_bf16_f32 v137, v138, v139
v_mfma_f32_16x16x32_bf16 v[176:179], v[0:3], v[96:99], 0
ds_read_b128 v[228:231], v249 offset:38912
v_and_b32 v195, s49, v195
v_cvt_pk_bf16_f32 v138, v140, v141
v_pk_fma_f16 v207, v240, v240, s48
v_mfma_f32_16x16x32_bf16 v[184:187], v[0:3], v[100:103], 0
v_bfe_u32 v192, v193, 2, 14
v_cvt_pk_bf16_f32 v139, v142, v143
v_pk_mul_f16 v242, v243, v242
s_waitcnt lgkmcnt(2)
v_mfma_f32_16x16x32_f16 v[64:67], v[4:7], v[232:235], v[64:67]
ds_read_b128 v[0:3], v249 offset:39168
ds_read_u16_d16 v192, v192
v_cvt_pk_bf16_f32 v120, v120, v121
v_bfe_u32 v194, v195, 2, 14
v_cvt_pk_bf16_f32 v121, v122, v123
v_mfma_f32_16x16x32_f16 v[72:75], v[4:7], v[236:239], v[72:75]
v_pk_mul_f16 v207, v240, v207
v_lshrrev_b32_e64 v193, 18, v193
v_cvt_pk_bf16_f32 v122, v124, v125
v_mfma_f32_16x16x32_bf16 v[180:183], v[40:43], v[96:99], 0
ds_read_b128 v[4:7], v248 offset:42240
ds_read_u16_d16 v194, v194
ds_read_u16_d16_hi v193, v193
v_exp_f16_e64 v241, v242
v_cvt_pk_bf16_f32 v123, v126, v127
v_mfma_f32_16x16x32_bf16 v[188:191], v[40:43], v[100:103], 0
v_lshrrev_b32_e64 v195, 18, v195
v_cvt_pk_bf16_f32 v152, v152, v153
v_and_b32_e64 v197, s49, v197
v_mfma_f32_16x16x32_f16 v[68:71], v[44:47], v[232:235], v[68:71]
ds_read_b128 v[40:43], v248 offset:43008
ds_read_u16_d16_hi v195, v195
v_cvt_pk_bf16_f32 v153, v154, v155
v_exp_f16_e64 v206, v207
v_mfma_f32_16x16x32_f16 v[76:79], v[44:47], v[236:239], v[76:79]
v_cvt_pk_bf16_f32 v154, v156, v157
v_and_b32_e64 v199, s49, v199
v_cvt_pk_bf16_f32 v155, v158, v159
s_mov_b64 vcc, s[74:75]
s_waitcnt lgkmcnt(5)
v_mfma_f32_16x16x32_bf16 v[176:179], v[224:227], v[104:107], v[176:179]
ds_read_b128 v[44:47], v248 offset:43264
v_bfe_u32 v196, v197, 2, 14
v_cndmask_b32 v140, v120, v152, vcc
v_mfma_f32_16x16x32_bf16 v[184:187], v[224:227], v[108:111], v[184:187]
v_exp_f16_sdwa v241, v242 dst_sel:WORD_1 dst_unused:UNUSED_PRESERVE src0_sel:WORD_1
v_cndmask_b32 v141, v121, v153, vcc
v_bfe_u32 v198, v199, 2, 14
v_mfma_f32_16x16x32_f16 v[80:83], v[228:231], v[232:235], v[80:83]
ds_read_b128 v[224:227], v249 offset:43008
ds_read_u16_d16 v196, v196
ds_read_u16_d16 v198, v198
v_cndmask_b32 v142, v122, v154, vcc
v_lshrrev_b32 v197, 18, v197
v_cndmask_b32 v143, v123, v155, vcc
v_mfma_f32_16x16x32_f16 v[168:171], v[228:231], v[236:239], v[168:171]
v_lshrrev_b32 v199, 18, v199
v_exp_f16_sdwa v206, v207 dst_sel:WORD_1 dst_unused:UNUSED_PRESERVE src0_sel:WORD_1
v_mfma_f32_16x16x32_f16 v[84:87], v[0:3], v[232:235], v[84:87]
ds_read_b128 v[228:231], v249 offset:43264
ds_read_u16_d16_hi v197, v197
ds_read_u16_d16_hi v199, v199
v_cndmask_b32_dpp v120, v136, v120, vcc quad_perm:[1,0,3,2] row_mask:0xf bank_mask:0xf
v_cndmask_b32_dpp v121, v137, v121, vcc quad_perm:[1,0,3,2] row_mask:0xf bank_mask:0xf
v_and_b32_e64 v201, s49, v201
v_mfma_f32_16x16x32_f16 v[172:175], v[0:3], v[236:239], v[172:175]
v_cndmask_b32_dpp v122, v138, v122, vcc quad_perm:[1,0,3,2] row_mask:0xf bank_mask:0xf
v_and_b32 v203, s49, v203
v_pk_add_f16 v241, v241, 1.0 op_sel_hi:[1,0]
s_waitcnt lgkmcnt(6)
v_mfma_f32_16x16x32_bf16 v[180:183], v[4:7], v[104:107], v[180:183]
ds_read_b128 v[0:3], v248 offset:47104
v_cndmask_b32_dpp v123, v139, v123, vcc quad_perm:[1,0,3,2] row_mask:0xf bank_mask:0xf
s_not_b64 vcc, s[74:75]
v_bfe_u32 v200, v201, 2, 14
s_setprio 0
v_cndmask_b32_dpp v152, v136, v152, vcc quad_perm:[1,0,3,2] row_mask:0xf bank_mask:0xf
v_mfma_f32_16x16x32_bf16 v[188:191], v[4:7], v[108:111], v[188:191]
v_pk_add_f16 v206, v206, 1.0 op_sel_hi:[1,0]
v_cndmask_b32_dpp v153, v137, v153, vcc quad_perm:[1,0,3,2] row_mask:0xf bank_mask:0xf
v_bfe_u32 v202, v203, 2, 14
v_mfma_f32_16x16x32_bf16 v[176:179], v[40:43], v[112:115], v[176:179]
ds_read_b128 v[4:7], v249 offset:44032
ds_read_u16_d16 v200, v200
ds_read_u16_d16 v202, v202
v_rcp_f16_e64 v242, v241
v_cndmask_b32_dpp v154, v138, v154, vcc quad_perm:[1,0,3,2] row_mask:0xf bank_mask:0xf
v_mfma_f32_16x16x32_bf16 v[184:187], v[40:43], v[116:119], v[184:187]
v_cndmask_b32_dpp v155, v139, v155, vcc quad_perm:[1,0,3,2] row_mask:0xf bank_mask:0xf
v_lshrrev_b32 v201, 18, v201
v_lshrrev_b32 v203, 18, v203
v_mfma_f32_16x16x32_bf16 v[180:183], v[44:47], v[112:115], v[180:183]
ds_read_b128 v[40:43], v248 offset:47360
buffer_store_dwordx4 v[120:123], v255, s[8:11], s68 offen sc1
ds_read_u16_d16_hi v201, v201
ds_read_u16_d16_hi v203, v203
v_rcp_f16_e64 v207, v206
v_mfma_f32_16x16x32_bf16 v[188:191], v[44:47], v[116:119], v[188:191]
v_rcp_f16_sdwa v242, v241 dst_sel:WORD_1 dst_unused:UNUSED_PRESERVE src0_sel:WORD_1
v_or_b32 v232, v192, v193
v_or_b32 v233, v194, v195
s_waitcnt lgkmcnt(6)
v_or_b32 v234, v196, v197
v_rcp_f16_sdwa v207, v206 dst_sel:WORD_1 dst_unused:UNUSED_PRESERVE src0_sel:WORD_1
v_or_b32 v235, v198, v199
s_waitcnt lgkmcnt(1)
v_or_b32 v236, v200, v201
s_waitcnt lgkmcnt(0)
v_or_b32 v237, v202, v203
v_pk_mul_f16 v238, v243, v242
v_pk_mul_f16 v239, v240, v207
s_setprio 3
v_mfma_f32_16x16x32_f16 v[48:51], v[224:227], v[232:235], v[48:51]
buffer_load_dwordx4 v[244:247], v252, s[4:7], s69 offen offset:64
ds_read_b128 v[44:47], v249 offset:44288
v_cvt_pkrtz_f16_f32 v193, v176, v177
v_cvt_pkrtz_f16_f32 v195, v178, v179
v_mfma_f32_16x16x32_f16 v[56:59], v[224:227], v[236:239], v[56:59]
v_cvt_pkrtz_f16_f32 v197, v180, v181
v_cvt_pkrtz_f16_f32 v199, v182, v183
v_mfma_f32_16x16x32_f16 v[52:55], v[228:231], v[232:235], v[52:55]
ds_read_b128 v[224:227], v248 offset:48128
v_cvt_pkrtz_f16_f32 v201, v184, v185
v_cvt_pk_f16_f32 v243, v186, v187
v_mfma_f32_16x16x32_f16 v[60:63], v[228:231], v[236:239], v[60:63]
v_cvt_pk_f16_f32 v240, v188, v189
v_cvt_pk_f16_f32 v205, v190, v191
v_mfma_f32_16x16x32_bf16 v[176:179], v[0:3], v[96:99], 0
ds_read_b128 v[228:231], v249 offset:45056
v_pk_fma_f16 v242, v243, v243, s48
v_and_b32_e64 v193, s49, v193
v_mfma_f32_16x16x32_bf16 v[184:187], v[0:3], v[100:103], 0
v_pk_fma_f16 v207, v240, v240, s48
v_and_b32_e64 v195, s49, v195
v_mfma_f32_16x16x32_f16 v[64:67], v[4:7], v[232:235], v[64:67]
ds_read_b128 v[0:3], v249 offset:45312
v_pk_fma_f16 v204, v205, v205, s48
v_bfe_u32 v192, v193, 2, 14
v_pk_mul_f16 v242, v243, v242
v_mfma_f32_16x16x32_f16 v[72:75], v[4:7], v[236:239], v[72:75]
v_bfe_u32 v194, v195, 2, 14
v_pk_mul_f16 v207, v240, v207
s_waitcnt vmcnt(7)
v_mfma_f32_16x16x32_bf16 v[128:131], v[26:29], v[8:11], v[128:131]
ds_read_b128 v[4:7], v248 offset:48384
ds_read_u16_d16 v192, v192
ds_read_u16_d16 v194, v194
v_lshrrev_b32 v193, 18, v193
v_pk_mul_f16 v204, v205, v204
v_mfma_f32_16x16x32_bf16 v[132:135], v[24:27], v[8:11], v[132:135]
v_lshrrev_b32_e64 v195, 18, v195
v_mfma_f32_16x16x32_bf16 v[180:183], v[40:43], v[96:99], 0
ds_read_u16_d16_hi v193, v193
ds_read_u16_d16_hi v195, v195
v_exp_f16 v241, v242
v_and_b32 v197, s49, v197
v_mfma_f32_16x16x32_bf16 v[188:191], v[40:43], v[100:103], 0
v_and_b32 v199, s49, v199
s_waitcnt lgkmcnt(6)
v_mfma_f32_16x16x32_f16 v[68:71], v[44:47], v[232:235], v[68:71]
ds_read_b128 v[40:43], v248 offset:49152
v_exp_f16_e64 v206, v207
v_bfe_u32 v196, v197, 2, 14
v_mfma_f32_16x16x32_f16 v[76:79], v[44:47], v[236:239], v[76:79]
v_bfe_u32 v198, v199, 2, 14
v_exp_f16_e64 v203, v204
v_mfma_f32_16x16x32_bf16 v[176:179], v[224:227], v[104:107], v[176:179]
buffer_store_dwordx4 v[140:143], v255, s[8:11], s68 offen offset:128 sc1
ds_read_b128 v[44:47], v248 offset:49408
ds_read_u16_d16 v196, v196
ds_read_u16_d16 v198, v198
v_lshrrev_b32 v197, 18, v197
v_lshrrev_b32 v199, 18, v199
v_mfma_f32_16x16x32_bf16 v[184:187], v[224:227], v[108:111], v[184:187]
v_exp_f16_sdwa v241, v242 dst_sel:WORD_1 dst_unused:UNUSED_PRESERVE src0_sel:WORD_1
v_mfma_f32_16x16x32_f16 v[80:83], v[228:231], v[232:235], v[80:83]
ds_read_b128 v[224:227], v249 offset:49152
ds_read_u16_d16_hi v197, v197
ds_read_u16_d16_hi v199, v199
v_and_b32 v201, s49, v201
v_bfe_u32 v200, v201, 2, 14
v_mfma_f32_16x16x32_f16 v[168:171], v[228:231], v[236:239], v[168:171]
v_exp_f16_sdwa v206, v207 dst_sel:WORD_1 dst_unused:UNUSED_PRESERVE src0_sel:WORD_1
s_waitcnt lgkmcnt(7)
v_mfma_f32_16x16x32_f16 v[84:87], v[0:3], v[232:235], v[84:87]
ds_read_b128 v[228:231], v249 offset:49408
ds_read_u16_d16 v200, v200
v_lshrrev_b32_e64 v201, 18, v201
v_mfma_f32_16x16x32_f16 v[172:175], v[0:3], v[236:239], v[172:175]
v_exp_f16_sdwa v203, v204 dst_sel:WORD_1 dst_unused:UNUSED_PRESERVE src0_sel:WORD_1
v_pk_add_f16 v241, v241, 1.0 op_sel_hi:[1,0]
v_pk_add_f16 v206, v206, 1.0 op_sel_hi:[1,0]
v_mfma_f32_16x16x32_bf16 v[180:183], v[4:7], v[104:107], v[180:183]
ds_read_b128 v[0:3], v248 offset:53248
ds_read_u16_d16_hi v201, v201
v_pk_add_f16 v203, v203, 1.0 op_sel_hi:[1,0]
v_mfma_f32_16x16x32_bf16 v[188:191], v[4:7], v[108:111], v[188:191]
v_rcp_f16 v242, v241
s_waitcnt lgkmcnt(7)
v_mfma_f32_16x16x32_bf16 v[176:179], v[40:43], v[112:115], v[176:179]
ds_read_b128 v[4:7], v249 offset:50176
v_rcp_f16_e64 v207, v206
v_mfma_f32_16x16x32_bf16 v[184:187], v[40:43], v[116:119], v[184:187]
v_rcp_f16_e64 v204, v203
v_mfma_f32_16x16x32_bf16 v[180:183], v[44:47], v[112:115], v[180:183]
ds_read_b128 v[40:43], v248 offset:53504
v_rcp_f16_sdwa v242, v241 dst_sel:WORD_1 dst_unused:UNUSED_PRESERVE src0_sel:WORD_1
v_mfma_f32_16x16x32_bf16 v[188:191], v[44:47], v[116:119], v[188:191]
v_rcp_f16_sdwa v207, v206 dst_sel:WORD_1 dst_unused:UNUSED_PRESERVE src0_sel:WORD_1
v_or_b32 v232, v192, v193
v_or_b32 v233, v194, v195
s_waitcnt lgkmcnt(4)
v_or_b32 v234, v196, v197
v_rcp_f16_sdwa v204, v203 dst_sel:WORD_1 dst_unused:UNUSED_PRESERVE src0_sel:WORD_1
v_or_b32 v235, v198, v199
s_waitcnt lgkmcnt(2)
v_or_b32_e64 v236, v200, v201
v_pk_mul_f16 v237, v243, v242
v_pk_mul_f16 v238, v240, v207
v_pk_mul_f16 v239, v205, v204
v_mfma_f32_16x16x32_f16 v[48:51], v[224:227], v[232:235], v[48:51]
buffer_load_dwordx4 v[8:11], v252, s[4:7], s69 offen offset:128
ds_read_b128 v[44:47], v249 offset:50432
v_cvt_pkrtz_f16_f32 v193, v176, v177
v_cvt_pkrtz_f16_f32 v195, v178, v179
v_mfma_f32_16x16x32_f16 v[56:59], v[224:227], v[236:239], v[56:59]
v_cvt_pkrtz_f16_f32 v197, v180, v181
v_cvt_pkrtz_f16_f32 v199, v182, v183
v_mfma_f32_16x16x32_f16 v[52:55], v[228:231], v[232:235], v[52:55]
ds_read_b128 v[224:227], v248 offset:54272
v_cvt_pkrtz_f16_f32 v201, v184, v185
v_cvt_pk_f16_f32 v243, v186, v187
v_mfma_f32_16x16x32_f16 v[60:63], v[228:231], v[236:239], v[60:63]
v_cvt_pk_f16_f32 v240, v188, v189
v_cvt_pk_f16_f32 v205, v190, v191
v_mfma_f32_16x16x32_bf16 v[176:179], v[0:3], v[96:99], 0
ds_read_b128 v[228:231], v249 offset:51200
v_pk_fma_f16 v242, v243, v243, s48
v_and_b32_e64 v193, s49, v193
v_mfma_f32_16x16x32_bf16 v[184:187], v[0:3], v[100:103], 0
v_pk_fma_f16 v207, v240, v240, s48
v_and_b32 v195, s49, v195
s_waitcnt lgkmcnt(3)
v_mfma_f32_16x16x32_f16 v[64:67], v[4:7], v[232:235], v[64:67]
ds_read_b128 v[0:3], v249 offset:51456
v_pk_fma_f16 v204, v205, v205, s48
s_setprio 2
v_bfe_u32 v192, v193, 2, 14
v_pk_mul_f16 v242, v243, v242
v_mfma_f32_16x16x32_f16 v[72:75], v[4:7], v[236:239], v[72:75]
v_bfe_u32 v194, v195, 2, 14
v_pk_mul_f16 v207, v240, v207
s_waitcnt vmcnt(7)
v_mfma_f32_16x16x32_bf16 v[144:147], v[26:29], v[36:39], v[144:147]
ds_read_b128 v[4:7], v248 offset:54528
ds_read_u16_d16 v192, v192
ds_read_u16_d16 v194, v194
v_lshrrev_b32_e64 v193, 18, v193
v_pk_mul_f16 v204, v205, v204
v_mfma_f32_16x16x32_bf16 v[148:151], v[24:27], v[36:39], v[148:151]
v_lshrrev_b32_e64 v195, 18, v195
v_mfma_f32_16x16x32_bf16 v[180:183], v[40:43], v[96:99], 0
ds_read_u16_d16_hi v193, v193
ds_read_u16_d16_hi v195, v195
v_exp_f16 v241, v242
v_and_b32 v197, s49, v197
v_mfma_f32_16x16x32_bf16 v[188:191], v[40:43], v[100:103], 0
v_and_b32 v199, s49, v199
s_waitcnt lgkmcnt(6)
v_mfma_f32_16x16x32_f16 v[68:71], v[44:47], v[232:235], v[68:71]
ds_read_b128 v[40:43], v248 offset:55296
v_exp_f16_e64 v206, v207
v_bfe_u32 v196, v197, 2, 14
v_mfma_f32_16x16x32_f16 v[76:79], v[44:47], v[236:239], v[76:79]
v_bfe_u32 v198, v199, 2, 14
v_exp_f16_e64 v203, v204
v_mfma_f32_16x16x32_bf16 v[176:179], v[224:227], v[104:107], v[176:179]
ds_read_b128 v[44:47], v248 offset:55552
ds_read_u16_d16 v196, v196
ds_read_u16_d16 v198, v198
v_lshrrev_b32 v197, 18, v197
v_lshrrev_b32 v199, 18, v199
v_mfma_f32_16x16x32_bf16 v[184:187], v[224:227], v[108:111], v[184:187]
v_exp_f16_sdwa v241, v242 dst_sel:WORD_1 dst_unused:UNUSED_PRESERVE src0_sel:WORD_1
v_mfma_f32_16x16x32_f16 v[80:83], v[228:231], v[232:235], v[80:83]
ds_read_b128 v[224:227], v249 offset:55296
ds_read_u16_d16_hi v197, v197
ds_read_u16_d16_hi v199, v199
v_and_b32 v201, s49, v201
v_bfe_u32 v200, v201, 2, 14
v_mfma_f32_16x16x32_f16 v[168:171], v[228:231], v[236:239], v[168:171]
v_exp_f16_sdwa v206, v207 dst_sel:WORD_1 dst_unused:UNUSED_PRESERVE src0_sel:WORD_1
s_waitcnt lgkmcnt(7)
v_mfma_f32_16x16x32_f16 v[84:87], v[0:3], v[232:235], v[84:87]
ds_read_b128 v[228:231], v249 offset:55552
ds_read_u16_d16 v200, v200
v_lshrrev_b32_e64 v201, 18, v201
v_mfma_f32_16x16x32_f16 v[172:175], v[0:3], v[236:239], v[172:175]
v_exp_f16_sdwa v203, v204 dst_sel:WORD_1 dst_unused:UNUSED_PRESERVE src0_sel:WORD_1
v_pk_add_f16 v241, v241, 1.0 op_sel_hi:[1,0]
v_pk_add_f16 v206, v206, 1.0 op_sel_hi:[1,0]
v_mfma_f32_16x16x32_bf16 v[180:183], v[4:7], v[104:107], v[180:183]
ds_read_b128 v[0:3], v248 offset:59392
ds_read_u16_d16_hi v201, v201
v_pk_add_f16 v203, v203, 1.0 op_sel_hi:[1,0]
v_mfma_f32_16x16x32_bf16 v[188:191], v[4:7], v[108:111], v[188:191]
v_rcp_f16 v242, v241
s_waitcnt lgkmcnt(7)
v_mfma_f32_16x16x32_bf16 v[176:179], v[40:43], v[112:115], v[176:179]
ds_read_b128 v[4:7], v249 offset:56320
v_rcp_f16_e64 v207, v206
v_mfma_f32_16x16x32_bf16 v[184:187], v[40:43], v[116:119], v[184:187]
v_rcp_f16_e64 v204, v203
v_mfma_f32_16x16x32_bf16 v[180:183], v[44:47], v[112:115], v[180:183]
ds_read_b128 v[40:43], v248 offset:59648
v_rcp_f16_sdwa v242, v241 dst_sel:WORD_1 dst_unused:UNUSED_PRESERVE src0_sel:WORD_1
v_mfma_f32_16x16x32_bf16 v[188:191], v[44:47], v[116:119], v[188:191]
v_rcp_f16_sdwa v207, v206 dst_sel:WORD_1 dst_unused:UNUSED_PRESERVE src0_sel:WORD_1
v_or_b32 v232, v192, v193
v_or_b32 v233, v194, v195
s_waitcnt lgkmcnt(4)
v_or_b32 v234, v196, v197
v_rcp_f16_sdwa v204, v203 dst_sel:WORD_1 dst_unused:UNUSED_PRESERVE src0_sel:WORD_1
v_or_b32 v235, v198, v199
s_waitcnt lgkmcnt(2)
v_or_b32_e64 v236, v200, v201
v_pk_mul_f16 v237, v243, v242
v_pk_mul_f16 v238, v240, v207
v_pk_mul_f16 v239, v205, v204
v_mfma_f32_16x16x32_f16 v[48:51], v[224:227], v[232:235], v[48:51]
s_add_u32 s46, s69, 98304
buffer_load_dwordx4 v[36:39], v252, s[4:7], s46 offen
ds_read_b128 v[44:47], v249 offset:56576
v_cvt_pkrtz_f16_f32 v193, v176, v177
v_cvt_pkrtz_f16_f32 v195, v178, v179
v_mfma_f32_16x16x32_f16 v[56:59], v[224:227], v[236:239], v[56:59]
v_cvt_pkrtz_f16_f32 v197, v180, v181
v_cvt_pkrtz_f16_f32 v199, v182, v183
v_mfma_f32_16x16x32_f16 v[52:55], v[228:231], v[232:235], v[52:55]
ds_read_b128 v[224:227], v248 offset:60416
v_cvt_pkrtz_f16_f32 v201, v184, v185
v_cvt_pk_f16_f32 v243, v186, v187
v_cvt_pk_f16_f32 v240, v188, v189
v_mfma_f32_16x16x32_f16 v[60:63], v[228:231], v[236:239], v[60:63]
v_cvt_pk_f16_f32 v205, v190, v191
s_setprio 1
v_pk_fma_f16 v242, v243, v243, s48
v_mfma_f32_16x16x32_bf16 v[176:179], v[0:3], v[96:99], 0
ds_read_b128 v[228:231], v249 offset:57344
v_and_b32 v193, s49, v193
v_pk_fma_f16 v207, v240, v240, s48
v_mfma_f32_16x16x32_bf16 v[184:187], v[0:3], v[100:103], 0
v_and_b32 v195, s49, v195
v_pk_fma_f16 v204, v205, v205, s48
v_bfe_u32 v192, v193, 2, 14
s_waitcnt lgkmcnt(3)
v_mfma_f32_16x16x32_f16 v[64:67], v[4:7], v[232:235], v[64:67]
ds_read_b128 v[0:3], v249 offset:57600
ds_read_u16_d16 v192, v192
v_pk_mul_f16 v242, v243, v242
v_bfe_u32 v194, v195, 2, 14
v_mfma_f32_16x16x32_f16 v[72:75], v[4:7], v[236:239], v[72:75]
v_pk_mul_f16 v207, v240, v207
v_lshrrev_b32_e64 v193, 18, v193
v_mfma_f32_16x16x32_bf16 v[180:183], v[40:43], v[96:99], 0
ds_read_b128 v[4:7], v248 offset:60672
ds_read_u16_d16 v194, v194
ds_read_u16_d16_hi v193, v193
v_pk_mul_f16 v204, v205, v204
v_lshrrev_b32_e64 v195, 18, v195
v_mfma_f32_16x16x32_bf16 v[188:191], v[40:43], v[100:103], 0
v_exp_f16_e64 v241, v242
v_and_b32 v197, s49, v197
s_waitcnt lgkmcnt(5)
v_mfma_f32_16x16x32_f16 v[68:71], v[44:47], v[232:235], v[68:71]
ds_read_b128 v[40:43], v248 offset:61440
ds_read_u16_d16_hi v195, v195
v_and_b32_e64 v199, s49, v199
v_mfma_f32_16x16x32_f16 v[76:79], v[44:47], v[236:239], v[76:79]
v_exp_f16_e64 v206, v207
v_bfe_u32 v196, v197, 2, 14
v_bfe_u32 v198, v199, 2, 14
v_mfma_f32_16x16x32_bf16 v[176:179], v[224:227], v[104:107], v[176:179]
buffer_store_dwordx4 v[152:155], v255, s[8:11], s68 offen offset:256 sc1
ds_read_b128 v[44:47], v248 offset:61696
ds_read_u16_d16 v196, v196
ds_read_u16_d16 v198, v198
v_exp_f16_e64 v203, v204
v_mfma_f32_16x16x32_bf16 v[184:187], v[224:227], v[108:111], v[184:187]
v_lshrrev_b32 v197, 18, v197
v_lshrrev_b32 v199, 18, v199
v_mfma_f32_16x16x32_f16 v[80:83], v[228:231], v[232:235], v[80:83]
ds_read_b128 v[224:227], v249 offset:61440
ds_read_u16_d16_hi v197, v197
ds_read_u16_d16_hi v199, v199
v_exp_f16_sdwa v241, v242 dst_sel:WORD_1 dst_unused:UNUSED_PRESERVE src0_sel:WORD_1
v_and_b32 v201, s49, v201
v_mfma_f32_16x16x32_f16 v[168:171], v[228:231], v[236:239], v[168:171]
v_bfe_u32 v200, v201, 2, 14
s_waitcnt lgkmcnt(8)
v_mfma_f32_16x16x32_f16 v[84:87], v[0:3], v[232:235], v[84:87]
ds_read_b128 v[228:231], v249 offset:61696
ds_read_u16_d16 v200, v200
v_exp_f16_sdwa v206, v207 dst_sel:WORD_1 dst_unused:UNUSED_PRESERVE src0_sel:WORD_1
v_lshrrev_b32_e64 v201, 18, v201
v_mfma_f32_16x16x32_f16 v[172:175], v[0:3], v[236:239], v[172:175]
v_exp_f16_sdwa v203, v204 dst_sel:WORD_1 dst_unused:UNUSED_PRESERVE src0_sel:WORD_1
v_pk_add_f16 v241, v241, 1.0 op_sel_hi:[1,0]
v_mfma_f32_16x16x32_bf16 v[180:183], v[4:7], v[104:107], v[180:183]
ds_read_b128 v[0:3], v249
ds_read_u16_d16_hi v201, v201
v_pk_add_f16 v206, v206, 1.0 op_sel_hi:[1,0]
v_pk_add_f16 v203, v203, 1.0 op_sel_hi:[1,0]
v_mfma_f32_16x16x32_bf16 v[188:191], v[4:7], v[108:111], v[188:191]
v_rcp_f16_e64 v242, v241
s_setprio 0
s_waitcnt lgkmcnt(7)
v_mfma_f32_16x16x32_bf16 v[176:179], v[40:43], v[112:115], v[176:179]
ds_read_b128 v[4:7], v249 offset:62464
v_rcp_f16_e64 v207, v206
v_mfma_f32_16x16x32_bf16 v[184:187], v[40:43], v[116:119], v[184:187]
v_rcp_f16_e64 v204, v203
v_mfma_f32_16x16x32_bf16 v[180:183], v[44:47], v[112:115], v[180:183]
ds_read_b128 v[40:43], v249 offset:256
v_rcp_f16_sdwa v242, v241 dst_sel:WORD_1 dst_unused:UNUSED_PRESERVE src0_sel:WORD_1
v_mfma_f32_16x16x32_bf16 v[188:191], v[44:47], v[116:119], v[188:191]
v_rcp_f16_sdwa v207, v206 dst_sel:WORD_1 dst_unused:UNUSED_PRESERVE src0_sel:WORD_1
v_or_b32 v232, v192, v193
v_or_b32 v233, v194, v195
s_waitcnt lgkmcnt(4)
v_or_b32 v234, v196, v197
v_rcp_f16_sdwa v204, v203 dst_sel:WORD_1 dst_unused:UNUSED_PRESERVE src0_sel:WORD_1
v_or_b32 v235, v198, v199
s_waitcnt lgkmcnt(2)
v_or_b32_e64 v236, v200, v201
v_pk_mul_f16 v237, v243, v242
v_pk_mul_f16 v238, v240, v207
v_pk_mul_f16 v239, v205, v204
v_mfma_f32_16x16x32_f16 v[48:51], v[224:227], v[232:235], v[48:51]
s_add_u32 s46, s69, 98304
buffer_load_dwordx4 v[32:35], v252, s[4:7], s46 offen offset:64
ds_read_b128 v[44:47], v249 offset:62720
v_cvt_pkrtz_f16_f32 v193, v176, v177
v_cvt_pkrtz_f16_f32 v195, v178, v179
v_mfma_f32_16x16x32_f16 v[56:59], v[224:227], v[236:239], v[56:59]
v_cvt_pkrtz_f16_f32 v197, v180, v181
v_cvt_pkrtz_f16_f32 v199, v182, v183
v_mfma_f32_16x16x32_f16 v[52:55], v[228:231], v[232:235], v[52:55]
ds_read_b128 v[224:227], v249 offset:1024
v_cvt_pkrtz_f16_f32 v201, v184, v185
v_cvt_pk_f16_f32 v243, v186, v187
v_mfma_f32_16x16x32_f16 v[60:63], v[228:231], v[236:239], v[60:63]
v_cvt_pk_f16_f32 v240, v188, v189
v_cvt_pk_f16_f32 v205, v190, v191
v_mfma_f32_16x16x32_bf16 v[176:179], v[0:3], v[96:99], 0
ds_read_b128 v[228:231], v249 offset:63488
v_pk_fma_f16 v242, v243, v243, s48
v_and_b32_e64 v193, s49, v193
v_mfma_f32_16x16x32_bf16 v[184:187], v[0:3], v[100:103], 0
v_pk_fma_f16 v207, v240, v240, s48
v_and_b32 v195, s49, v195
s_waitcnt lgkmcnt(3)
v_mfma_f32_16x16x32_f16 v[64:67], v[4:7], v[232:235], v[64:67]
ds_read_b128 v[0:3], v249 offset:63744
v_pk_fma_f16 v204, v205, v205, s48
v_bfe_u32 v192, v193, 2, 14
v_mfma_f32_16x16x32_f16 v[72:75], v[4:7], v[236:239], v[72:75]
v_pk_mul_f16 v242, v243, v242
v_bfe_u32 v194, v195, 2, 14
s_waitcnt vmcnt(8)
v_mfma_f32_16x16x32_bf16 v[160:163], v[26:29], v[216:219], v[160:163]
ds_read_b128 v[4:7], v249 offset:1280
ds_read_u16_d16 v192, v192
ds_read_u16_d16 v194, v194
v_pk_mul_f16 v207, v240, v207
v_lshrrev_b32 v193, 18, v193
v_mfma_f32_16x16x32_bf16 v[164:167], v[24:27], v[216:219], v[164:167]
v_pk_mul_f16 v204, v205, v204
v_lshrrev_b32_e64 v195, 18, v195
v_mfma_f32_16x16x32_bf16 v[180:183], v[40:43], v[96:99], 0
ds_read_u16_d16_hi v193, v193
ds_read_u16_d16_hi v195, v195
v_exp_f16_e64 v241, v242
v_mfma_f32_16x16x32_bf16 v[188:191], v[40:43], v[100:103], 0
v_and_b32_e64 v197, s49, v197
v_and_b32 v199, s49, v199
s_waitcnt lgkmcnt(6)
v_mfma_f32_16x16x32_f16 v[68:71], v[44:47], v[232:235], v[68:71]
ds_read_b128 v[40:43], v249 offset:2048
v_exp_f16_e64 v206, v207
v_mfma_f32_16x16x32_f16 v[76:79], v[44:47], v[236:239], v[76:79]
v_bfe_u32 v196, v197, 2, 14
v_bfe_u32 v198, v199, 2, 14
v_mfma_f32_16x16x32_bf16 v[176:179], v[224:227], v[104:107], v[176:179]
ds_read_b128 v[44:47], v249 offset:2304
ds_read_u16_d16 v196, v196
ds_read_u16_d16 v198, v198
v_exp_f16_e64 v203, v204
v_mfma_f32_16x16x32_bf16 v[184:187], v[224:227], v[108:111], v[184:187]
v_lshrrev_b32 v197, 18, v197
v_lshrrev_b32 v199, 18, v199
v_mfma_f32_16x16x32_f16 v[80:83], v[228:231], v[232:235], v[80:83]
ds_read_b128 v[224:227], v250 offset:2048
ds_read_u16_d16_hi v197, v197
ds_read_u16_d16_hi v199, v199
v_exp_f16_sdwa v241, v242 dst_sel:WORD_1 dst_unused:UNUSED_PRESERVE src0_sel:WORD_1
v_mfma_f32_16x16x32_f16 v[168:171], v[228:231], v[236:239], v[168:171]
v_and_b32 v201, s49, v201
v_bfe_u32 v200, v201, 2, 14
s_waitcnt lgkmcnt(7)
v_mfma_f32_16x16x32_f16 v[84:87], v[0:3], v[232:235], v[84:87]
ds_read_b128 v[228:231], v250 offset:2304
ds_read_u16_d16 v200, v200
v_exp_f16_sdwa v206, v207 dst_sel:WORD_1 dst_unused:UNUSED_PRESERVE src0_sel:WORD_1
v_mfma_f32_16x16x32_f16 v[172:175], v[0:3], v[236:239], v[172:175]
v_lshrrev_b32 v201, 18, v201
s_waitcnt vmcnt(7)
v_mfma_f32_16x16x32_bf16 v[48:51], v[26:29], v[12:15], v[48:51]
ds_read_b128 v[0:3], v249 offset:6144
ds_read_u16_d16_hi v201, v201
v_exp_f16_sdwa v203, v204 dst_sel:WORD_1 dst_unused:UNUSED_PRESERVE src0_sel:WORD_1
v_pk_add_f16 v241, v241, 1.0 op_sel_hi:[1,0]
v_mfma_f32_16x16x32_bf16 v[52:55], v[24:27], v[12:15], v[52:55]
v_pk_add_f16 v206, v206, 1.0 op_sel_hi:[1,0]
v_pk_add_f16 v203, v203, 1.0 op_sel_hi:[1,0]
v_mfma_f32_16x16x32_bf16 v[180:183], v[4:7], v[104:107], v[180:183]
v_rcp_f16_e64 v242, v241
v_mfma_f32_16x16x32_bf16 v[188:191], v[4:7], v[108:111], v[188:191]
v_rcp_f16 v207, v206
s_waitcnt lgkmcnt(4)
v_mfma_f32_16x16x32_bf16 v[176:179], v[40:43], v[112:115], v[176:179]
ds_read_b128 v[4:7], v250 offset:3072
v_rcp_f16_e64 v204, v203
v_mfma_f32_16x16x32_bf16 v[184:187], v[40:43], v[116:119], v[184:187]
v_rcp_f16_sdwa v242, v241 dst_sel:WORD_1 dst_unused:UNUSED_PRESERVE src0_sel:WORD_1
v_mfma_f32_16x16x32_bf16 v[180:183], v[44:47], v[112:115], v[180:183]
ds_read_b128 v[40:43], v249 offset:6400
v_rcp_f16_sdwa v207, v206 dst_sel:WORD_1 dst_unused:UNUSED_PRESERVE src0_sel:WORD_1
v_mfma_f32_16x16x32_bf16 v[188:191], v[44:47], v[116:119], v[188:191]
v_or_b32 v232, v192, v193
v_or_b32 v233, v194, v195
v_or_b32_e64 v234, v196, v197
v_rcp_f16_sdwa v204, v203 dst_sel:WORD_1 dst_unused:UNUSED_PRESERVE src0_sel:WORD_1
v_or_b32 v235, v198, v199
s_waitcnt lgkmcnt(2)
v_or_b32_e64 v236, v200, v201
v_pk_mul_f16 v237, v243, v242
v_pk_mul_f16 v238, v240, v207
v_pk_mul_f16 v239, v205, v204
v_mfma_f32_16x16x32_f16 v[48:51], v[224:227], v[232:235], v[48:51]
s_add_u32 s46, s69, 98304
buffer_load_dwordx4 v[216:219], v252, s[4:7], s46 offen offset:128
ds_read_b128 v[44:47], v250 offset:3328
v_cvt_pkrtz_f16_f32 v193, v176, v177
v_cvt_pkrtz_f16_f32 v195, v178, v179
v_mfma_f32_16x16x32_f16 v[56:59], v[224:227], v[236:239], v[56:59]
v_cvt_pkrtz_f16_f32 v197, v180, v181
v_cvt_pkrtz_f16_f32 v199, v182, v183
v_cvt_pkrtz_f16_f32 v201, v184, v185
v_mfma_f32_16x16x32_f16 v[52:55], v[228:231], v[232:235], v[52:55]
ds_read_b128 v[224:227], v249 offset:7168
v_cvt_pkrtz_f16_f32 v203, v186, v187
v_cvt_pk_f16_f32 v243, v188, v189
v_cvt_pk_f16_f32 v240, v190, v191
v_mfma_f32_16x16x32_f16 v[60:63], v[228:231], v[236:239], v[60:63]
v_pk_fma_f16 v242, v243, v243, s48
v_cvt_pk_bf16_f32 v144, v144, v145
v_and_b32_e64 v193, s49, v193
v_mfma_f32_16x16x32_bf16 v[176:179], v[0:3], v[96:99], 0
ds_read_b128 v[228:231], v250 offset:4096
v_cvt_pk_bf16_f32 v145, v146, v147
v_and_b32 v195, s49, v195
v_mfma_f32_16x16x32_bf16 v[184:187], v[0:3], v[100:103], 0
v_cvt_pk_bf16_f32 v146, v148, v149
v_pk_fma_f16 v207, v240, v240, s48
v_bfe_u32 v192, v193, 2, 14
s_waitcnt lgkmcnt(3)
v_mfma_f32_16x16x32_f16 v[64:67], v[4:7], v[232:235], v[64:67]
ds_read_b128 v[0:3], v250 offset:4352
ds_read_u16_d16 v192, v192
v_cvt_pk_bf16_f32 v147, v150, v151
v_pk_mul_f16 v242, v243, v242
v_cvt_pk_bf16_f32 v128, v128, v129
v_mfma_f32_16x16x32_f16 v[72:75], v[4:7], v[236:239], v[72:75]
v_bfe_u32 v194, v195, 2, 14
v_cvt_pk_bf16_f32 v129, v130, v131
v_pk_mul_f16 v207, v240, v207
s_waitcnt vmcnt(6)
v_mfma_f32_16x16x32_bf16 v[64:67], v[26:29], v[244:247], v[64:67]
ds_read_b128 v[4:7], v249 offset:7424
ds_read_u16_d16 v194, v194
v_lshrrev_b32 v193, 18, v193
v_cvt_pk_bf16_f32 v130, v132, v133
v_mfma_f32_16x16x32_bf16 v[68:71], v[24:27], v[244:247], v[68:71]
v_exp_f16_e64 v241, v242
v_cvt_pk_bf16_f32 v131, v134, v135
v_mfma_f32_16x16x32_bf16 v[180:183], v[40:43], v[96:99], 0
ds_read_u16_d16_hi v193, v193
v_lshrrev_b32_e64 v195, 18, v195
v_cvt_pk_bf16_f32 v160, v160, v161
v_and_b32_e64 v197, s49, v197
v_mfma_f32_16x16x32_bf16 v[188:191], v[40:43], v[100:103], 0
v_cvt_pk_bf16_f32 v161, v162, v163
v_exp_f16 v206, v207
s_waitcnt lgkmcnt(3)
v_mfma_f32_16x16x32_f16 v[68:71], v[44:47], v[232:235], v[68:71]
ds_read_b128 v[40:43], v249 offset:8192
ds_read_u16_d16_hi v195, v195
v_cvt_pk_bf16_f32 v162, v164, v165
v_and_b32_e64 v199, s49, v199
v_mfma_f32_16x16x32_f16 v[76:79], v[44:47], v[236:239], v[76:79]
v_cvt_pk_bf16_f32 v163, v166, v167
s_mov_b64 vcc, s[74:75]
v_bfe_u32 v196, v197, 2, 14
v_cndmask_b32 v148, v128, v160, vcc
v_mfma_f32_16x16x32_bf16 v[176:179], v[224:227], v[104:107], v[176:179]
ds_read_b128 v[44:47], v249 offset:8448
ds_read_u16_d16 v196, v196
v_exp_f16_sdwa v241, v242 dst_sel:WORD_1 dst_unused:UNUSED_PRESERVE src0_sel:WORD_1
v_cndmask_b32 v149, v129, v161, vcc
v_mfma_f32_16x16x32_bf16 v[184:187], v[224:227], v[108:111], v[184:187]
v_bfe_u32 v198, v199, 2, 14
v_cndmask_b32 v150, v130, v162, vcc
v_lshrrev_b32_e64 v197, 18, v197
v_mfma_f32_16x16x32_f16 v[80:83], v[228:231], v[232:235], v[80:83]
ds_read_b128 v[224:227], v250 offset:8192
ds_read_u16_d16 v198, v198
ds_read_u16_d16_hi v197, v197
v_cndmask_b32 v151, v131, v163, vcc
v_lshrrev_b32 v199, 18, v199
v_mfma_f32_16x16x32_f16 v[168:171], v[228:231], v[236:239], v[168:171]
v_exp_f16_sdwa v206, v207 dst_sel:WORD_1 dst_unused:UNUSED_PRESERVE src0_sel:WORD_1
v_cndmask_b32_dpp v128, v144, v128, vcc quad_perm:[1,0,3,2] row_mask:0xf bank_mask:0xf
v_mfma_f32_16x16x32_f16 v[84:87], v[0:3], v[232:235], v[84:87]
ds_read_b128 v[228:231], v250 offset:8448
ds_read_u16_d16_hi v199, v199
v_cndmask_b32_dpp v129, v145, v129, vcc quad_perm:[1,0,3,2] row_mask:0xf bank_mask:0xf
v_and_b32_e64 v201, s49, v201
v_cndmask_b32_dpp v130, v146, v130, vcc quad_perm:[1,0,3,2] row_mask:0xf bank_mask:0xf
v_mfma_f32_16x16x32_f16 v[172:175], v[0:3], v[236:239], v[172:175]
v_and_b32_e64 v203, s49, v203
v_pk_add_f16 v241, v241, 1.0 op_sel_hi:[1,0]
v_cndmask_b32_dpp v131, v147, v131, vcc quad_perm:[1,0,3,2] row_mask:0xf bank_mask:0xf
s_not_b64 vcc, s[74:75]
s_waitcnt lgkmcnt(5)
v_mfma_f32_16x16x32_bf16 v[180:183], v[4:7], v[104:107], v[180:183]
ds_read_b128 v[0:3], v249 offset:12288
v_bfe_u32 v200, v201, 2, 14
v_cndmask_b32_dpp v160, v144, v160, vcc quad_perm:[1,0,3,2] row_mask:0xf bank_mask:0xf
v_pk_add_f16 v206, v206, 1.0 op_sel_hi:[1,0]
v_mfma_f32_16x16x32_bf16 v[188:191], v[4:7], v[108:111], v[188:191]
v_cndmask_b32_dpp v161, v145, v161, vcc quad_perm:[1,0,3,2] row_mask:0xf bank_mask:0xf
v_bfe_u32 v202, v203, 2, 14
v_mfma_f32_16x16x32_bf16 v[176:179], v[40:43], v[112:115], v[176:179]
ds_read_b128 v[4:7], v250 offset:9216
ds_read_u16_d16 v200, v200
ds_read_u16_d16 v202, v202
v_rcp_f16_e64 v242, v241
v_cndmask_b32_dpp v162, v146, v162, vcc quad_perm:[1,0,3,2] row_mask:0xf bank_mask:0xf
v_mfma_f32_16x16x32_bf16 v[184:187], v[40:43], v[116:119], v[184:187]
v_cndmask_b32_dpp v163, v147, v163, vcc quad_perm:[1,0,3,2] row_mask:0xf bank_mask:0xf
v_lshrrev_b32 v201, 18, v201
v_lshrrev_b32 v203, 18, v203
v_mfma_f32_16x16x32_bf16 v[180:183], v[44:47], v[112:115], v[180:183]
ds_read_b128 v[40:43], v249 offset:12544
s_add_u32 s46, s68, 98304
buffer_store_dwordx4 v[128:131], v255, s[8:11], s46 offen sc1
ds_read_u16_d16_hi v201, v201
ds_read_u16_d16_hi v203, v203
v_rcp_f16_e64 v207, v206
v_mfma_f32_16x16x32_bf16 v[188:191], v[44:47], v[116:119], v[188:191]
v_rcp_f16_sdwa v242, v241 dst_sel:WORD_1 dst_unused:UNUSED_PRESERVE src0_sel:WORD_1
v_or_b32 v232, v192, v193
v_or_b32 v233, v194, v195
s_waitcnt lgkmcnt(6)
v_or_b32 v234, v196, v197
v_rcp_f16_sdwa v207, v206 dst_sel:WORD_1 dst_unused:UNUSED_PRESERVE src0_sel:WORD_1
v_or_b32 v235, v198, v199
s_waitcnt lgkmcnt(1)
v_or_b32 v236, v200, v201
s_waitcnt lgkmcnt(0)
v_or_b32_e64 v237, v202, v203
v_pk_mul_f16 v238, v243, v242
v_pk_mul_f16 v239, v240, v207
v_mfma_f32_16x16x32_f16 v[48:51], v[224:227], v[232:235], v[48:51]
s_add_u32 s46, s68, 98304
buffer_store_dwordx4 v[148:151], v255, s[8:11], s46 offen offset:128 sc1
ds_read_b128 v[44:47], v250 offset:9472
v_cvt_pkrtz_f16_f32 v193, v176, v177
v_cvt_pkrtz_f16_f32 v195, v178, v179
v_mfma_f32_16x16x32_f16 v[56:59], v[224:227], v[236:239], v[56:59]
v_cvt_pkrtz_f16_f32 v197, v180, v181
v_cvt_pkrtz_f16_f32 v199, v182, v183
v_mfma_f32_16x16x32_f16 v[52:55], v[228:231], v[232:235], v[52:55]
ds_read_b128 v[224:227], v249 offset:13312
v_cvt_pkrtz_f16_f32 v201, v184, v185
v_cvt_pk_f16_f32 v243, v186, v187
v_mfma_f32_16x16x32_f16 v[60:63], v[228:231], v[236:239], v[60:63]
v_cvt_pk_f16_f32 v240, v188, v189
v_cvt_pk_f16_f32 v205, v190, v191
v_mfma_f32_16x16x32_bf16 v[176:179], v[0:3], v[96:99], 0
ds_read_b128 v[228:231], v250 offset:10240
v_pk_fma_f16 v242, v243, v243, s48
v_and_b32_e64 v193, s49, v193
v_mfma_f32_16x16x32_bf16 v[184:187], v[0:3], v[100:103], 0
v_pk_fma_f16 v207, v240, v240, s48
v_and_b32_e64 v195, s49, v195
v_mfma_f32_16x16x32_f16 v[64:67], v[4:7], v[232:235], v[64:67]
ds_read_b128 v[0:3], v250 offset:10496
v_pk_fma_f16 v204, v205, v205, s48
v_bfe_u32 v192, v193, 2, 14
v_pk_mul_f16 v242, v243, v242
v_mfma_f32_16x16x32_f16 v[72:75], v[4:7], v[236:239], v[72:75]
v_bfe_u32 v194, v195, 2, 14
v_pk_mul_f16 v207, v240, v207
s_waitcnt vmcnt(6)
v_mfma_f32_16x16x32_bf16 v[80:83], v[26:29], v[8:11], v[80:83]
ds_read_b128 v[4:7], v249 offset:13568
ds_read_u16_d16 v192, v192
ds_read_u16_d16 v194, v194
v_lshrrev_b32 v193, 18, v193
v_pk_mul_f16 v204, v205, v204
v_mfma_f32_16x16x32_bf16 v[84:87], v[24:27], v[8:11], v[84:87]
v_lshrrev_b32_e64 v195, 18, v195
v_mfma_f32_16x16x32_bf16 v[180:183], v[40:43], v[96:99], 0
ds_read_u16_d16_hi v193, v193
ds_read_u16_d16_hi v195, v195
v_exp_f16 v241, v242
v_and_b32 v197, s49, v197
v_mfma_f32_16x16x32_bf16 v[188:191], v[40:43], v[100:103], 0
v_and_b32 v199, s49, v199
s_waitcnt lgkmcnt(6)
v_mfma_f32_16x16x32_f16 v[68:71], v[44:47], v[232:235], v[68:71]
ds_read_b128 v[40:43], v249 offset:14336
v_exp_f16_e64 v206, v207
v_bfe_u32 v196, v197, 2, 14
v_mfma_f32_16x16x32_f16 v[76:79], v[44:47], v[236:239], v[76:79]
v_bfe_u32 v198, v199, 2, 14
v_exp_f16_e64 v203, v204
v_mfma_f32_16x16x32_bf16 v[176:179], v[224:227], v[104:107], v[176:179]
ds_read_b128 v[44:47], v249 offset:14592
ds_read_u16_d16 v196, v196
ds_read_u16_d16 v198, v198
v_lshrrev_b32 v197, 18, v197
v_lshrrev_b32 v199, 18, v199
v_mfma_f32_16x16x32_bf16 v[184:187], v[224:227], v[108:111], v[184:187]
v_exp_f16_sdwa v241, v242 dst_sel:WORD_1 dst_unused:UNUSED_PRESERVE src0_sel:WORD_1
v_mfma_f32_16x16x32_f16 v[80:83], v[228:231], v[232:235], v[80:83]
ds_read_b128 v[224:227], v250 offset:14336
ds_read_u16_d16_hi v197, v197
ds_read_u16_d16_hi v199, v199
v_and_b32 v201, s49, v201
v_bfe_u32 v200, v201, 2, 14
v_mfma_f32_16x16x32_f16 v[168:171], v[228:231], v[236:239], v[168:171]
v_exp_f16_sdwa v206, v207 dst_sel:WORD_1 dst_unused:UNUSED_PRESERVE src0_sel:WORD_1
s_waitcnt lgkmcnt(7)
v_mfma_f32_16x16x32_f16 v[84:87], v[0:3], v[232:235], v[84:87]
ds_read_b128 v[228:231], v250 offset:14592
ds_read_u16_d16 v200, v200
v_lshrrev_b32_e64 v201, 18, v201
v_mfma_f32_16x16x32_f16 v[172:175], v[0:3], v[236:239], v[172:175]
v_exp_f16_sdwa v203, v204 dst_sel:WORD_1 dst_unused:UNUSED_PRESERVE src0_sel:WORD_1
v_pk_add_f16 v241, v241, 1.0 op_sel_hi:[1,0]
v_pk_add_f16 v206, v206, 1.0 op_sel_hi:[1,0]
v_mfma_f32_16x16x32_bf16 v[180:183], v[4:7], v[104:107], v[180:183]
ds_read_b128 v[0:3], v249 offset:18432
ds_read_u16_d16_hi v201, v201
v_pk_add_f16 v203, v203, 1.0 op_sel_hi:[1,0]
v_mfma_f32_16x16x32_bf16 v[188:191], v[4:7], v[108:111], v[188:191]
v_rcp_f16 v242, v241
s_waitcnt lgkmcnt(7)
v_mfma_f32_16x16x32_bf16 v[176:179], v[40:43], v[112:115], v[176:179]
ds_read_b128 v[4:7], v250 offset:15360
v_rcp_f16_e64 v207, v206
v_mfma_f32_16x16x32_bf16 v[184:187], v[40:43], v[116:119], v[184:187]
v_rcp_f16_e64 v204, v203
v_mfma_f32_16x16x32_bf16 v[180:183], v[44:47], v[112:115], v[180:183]
ds_read_b128 v[40:43], v249 offset:18688
v_rcp_f16_sdwa v242, v241 dst_sel:WORD_1 dst_unused:UNUSED_PRESERVE src0_sel:WORD_1
v_mfma_f32_16x16x32_bf16 v[188:191], v[44:47], v[116:119], v[188:191]
v_rcp_f16_sdwa v207, v206 dst_sel:WORD_1 dst_unused:UNUSED_PRESERVE src0_sel:WORD_1
v_or_b32 v232, v192, v193
v_or_b32 v233, v194, v195
s_waitcnt lgkmcnt(4)
v_or_b32 v234, v196, v197
v_rcp_f16_sdwa v204, v203 dst_sel:WORD_1 dst_unused:UNUSED_PRESERVE src0_sel:WORD_1
v_or_b32 v235, v198, v199
s_waitcnt lgkmcnt(2)
v_or_b32_e64 v236, v200, v201
v_pk_mul_f16 v237, v243, v242
v_pk_mul_f16 v238, v240, v207
v_pk_mul_f16 v239, v205, v204
v_mfma_f32_16x16x32_f16 v[48:51], v[224:227], v[232:235], v[48:51]
ds_read_b128 v[44:47], v250 offset:15616
v_cvt_pkrtz_f16_f32 v193, v176, v177
v_cvt_pkrtz_f16_f32 v195, v178, v179
v_mfma_f32_16x16x32_f16 v[56:59], v[224:227], v[236:239], v[56:59]
v_cvt_pkrtz_f16_f32 v197, v180, v181
v_cvt_pkrtz_f16_f32 v199, v182, v183
v_mfma_f32_16x16x32_f16 v[52:55], v[228:231], v[232:235], v[52:55]
ds_read_b128 v[224:227], v249 offset:19456
v_cvt_pkrtz_f16_f32 v201, v184, v185
v_cvt_pk_f16_f32 v243, v186, v187
v_mfma_f32_16x16x32_f16 v[60:63], v[228:231], v[236:239], v[60:63]
v_cvt_pk_f16_f32 v240, v188, v189
v_cvt_pk_f16_f32 v205, v190, v191
v_mfma_f32_16x16x32_bf16 v[176:179], v[0:3], v[96:99], 0
ds_read_b128 v[228:231], v250 offset:16384
v_pk_fma_f16 v242, v243, v243, s48
v_and_b32_e64 v193, s49, v193
v_mfma_f32_16x16x32_bf16 v[184:187], v[0:3], v[100:103], 0
v_pk_fma_f16 v207, v240, v240, s48
v_and_b32 v195, s49, v195
s_waitcnt lgkmcnt(3)
v_mfma_f32_16x16x32_f16 v[64:67], v[4:7], v[232:235], v[64:67]
ds_read_b128 v[0:3], v250 offset:16640
v_pk_fma_f16 v204, v205, v205, s48
v_bfe_u32 v192, v193, 2, 14
v_pk_mul_f16 v242, v243, v242
v_mfma_f32_16x16x32_f16 v[72:75], v[4:7], v[236:239], v[72:75]
v_bfe_u32 v194, v195, 2, 14
v_pk_mul_f16 v207, v240, v207
s_waitcnt vmcnt(5)
v_mfma_f32_16x16x32_bf16 v[56:59], v[26:29], v[36:39], v[56:59]
ds_read_b128 v[4:7], v249 offset:19712
ds_read_u16_d16 v192, v192
ds_read_u16_d16 v194, v194
v_lshrrev_b32 v193, 18, v193
v_pk_mul_f16 v204, v205, v204
v_mfma_f32_16x16x32_bf16 v[60:63], v[24:27], v[36:39], v[60:63]
v_lshrrev_b32_e64 v195, 18, v195
v_mfma_f32_16x16x32_bf16 v[180:183], v[40:43], v[96:99], 0
ds_read_u16_d16_hi v193, v193
ds_read_u16_d16_hi v195, v195
v_exp_f16 v241, v242
v_and_b32 v197, s49, v197
v_mfma_f32_16x16x32_bf16 v[188:191], v[40:43], v[100:103], 0
v_and_b32 v199, s49, v199
s_waitcnt lgkmcnt(6)
v_mfma_f32_16x16x32_f16 v[68:71], v[44:47], v[232:235], v[68:71]
ds_read_b128 v[40:43], v249 offset:20480
v_exp_f16_e64 v206, v207
v_bfe_u32 v196, v197, 2, 14
v_mfma_f32_16x16x32_f16 v[76:79], v[44:47], v[236:239], v[76:79]
v_bfe_u32 v198, v199, 2, 14
v_exp_f16_e64 v203, v204
v_mfma_f32_16x16x32_bf16 v[176:179], v[224:227], v[104:107], v[176:179]
ds_read_b128 v[44:47], v249 offset:20736
ds_read_u16_d16 v196, v196
ds_read_u16_d16 v198, v198
v_lshrrev_b32 v197, 18, v197
v_lshrrev_b32 v199, 18, v199
v_mfma_f32_16x16x32_bf16 v[184:187], v[224:227], v[108:111], v[184:187]
v_exp_f16_sdwa v241, v242 dst_sel:WORD_1 dst_unused:UNUSED_PRESERVE src0_sel:WORD_1
v_mfma_f32_16x16x32_f16 v[80:83], v[228:231], v[232:235], v[80:83]
ds_read_b128 v[224:227], v250 offset:20480
ds_read_u16_d16_hi v197, v197
ds_read_u16_d16_hi v199, v199
v_and_b32 v201, s49, v201
v_bfe_u32 v200, v201, 2, 14
v_mfma_f32_16x16x32_f16 v[168:171], v[228:231], v[236:239], v[168:171]
v_exp_f16_sdwa v206, v207 dst_sel:WORD_1 dst_unused:UNUSED_PRESERVE src0_sel:WORD_1
s_waitcnt lgkmcnt(7)
v_mfma_f32_16x16x32_f16 v[84:87], v[0:3], v[232:235], v[84:87]
ds_read_b128 v[228:231], v250 offset:20736
ds_read_u16_d16 v200, v200
v_lshrrev_b32_e64 v201, 18, v201
v_mfma_f32_16x16x32_f16 v[172:175], v[0:3], v[236:239], v[172:175]
v_exp_f16_sdwa v203, v204 dst_sel:WORD_1 dst_unused:UNUSED_PRESERVE src0_sel:WORD_1
v_pk_add_f16 v241, v241, 1.0 op_sel_hi:[1,0]
v_pk_add_f16 v206, v206, 1.0 op_sel_hi:[1,0]
v_mfma_f32_16x16x32_bf16 v[180:183], v[4:7], v[104:107], v[180:183]
ds_read_b128 v[0:3], v250 offset:21504
ds_read_u16_d16_hi v201, v201
v_pk_add_f16 v203, v203, 1.0 op_sel_hi:[1,0]
v_mfma_f32_16x16x32_bf16 v[188:191], v[4:7], v[108:111], v[188:191]
v_rcp_f16 v242, v241
s_waitcnt lgkmcnt(7)
v_mfma_f32_16x16x32_bf16 v[176:179], v[40:43], v[112:115], v[176:179]
ds_read_b128 v[4:7], v250 offset:21760
v_rcp_f16_e64 v207, v206
v_mfma_f32_16x16x32_bf16 v[184:187], v[40:43], v[116:119], v[184:187]
v_rcp_f16_e64 v204, v203
v_mfma_f32_16x16x32_bf16 v[180:183], v[44:47], v[112:115], v[180:183]
ds_read_b128 v[40:43], v250 offset:22528
v_rcp_f16_sdwa v242, v241 dst_sel:WORD_1 dst_unused:UNUSED_PRESERVE src0_sel:WORD_1
v_mfma_f32_16x16x32_bf16 v[188:191], v[44:47], v[116:119], v[188:191]
v_rcp_f16_sdwa v207, v206 dst_sel:WORD_1 dst_unused:UNUSED_PRESERVE src0_sel:WORD_1
v_or_b32 v232, v192, v193
v_or_b32 v233, v194, v195
s_waitcnt lgkmcnt(4)
v_or_b32 v234, v196, v197
v_rcp_f16_sdwa v204, v203 dst_sel:WORD_1 dst_unused:UNUSED_PRESERVE src0_sel:WORD_1
v_or_b32 v235, v198, v199
s_waitcnt lgkmcnt(2)
v_or_b32_e64 v236, v200, v201
v_pk_mul_f16 v237, v243, v242
v_pk_mul_f16 v238, v240, v207
v_pk_mul_f16 v239, v205, v204
v_mfma_f32_16x16x32_f16 v[48:51], v[224:227], v[232:235], v[48:51]
s_add_u32 s46, s68, 98304
buffer_store_dwordx4 v[160:163], v255, s[8:11], s46 offen offset:256 sc1
ds_read_b128 v[44:47], v250 offset:22784
v_cvt_pkrtz_f16_f32 v193, v176, v177
v_cvt_pkrtz_f16_f32 v195, v178, v179
v_cvt_pkrtz_f16_f32 v197, v180, v181
v_cvt_pkrtz_f16_f32 v199, v182, v183
v_mfma_f32_16x16x32_f16 v[56:59], v[224:227], v[236:239], v[56:59]
v_cvt_pkrtz_f16_f32 v201, v184, v185
v_cvt_pk_f16_f32 v243, v186, v187
v_cvt_pk_f16_f32 v240, v188, v189
v_cvt_pk_f16_f32 v205, v190, v191
v_mfma_f32_16x16x32_f16 v[52:55], v[228:231], v[232:235], v[52:55]
ds_read_b128 v[224:227], v250 offset:26624
v_pk_fma_f16 v242, v243, v243, s48
v_and_b32_e64 v193, s49, v193
v_pk_fma_f16 v207, v240, v240, s48
v_and_b32_e64 v195, s49, v195
v_mfma_f32_16x16x32_f16 v[60:63], v[228:231], v[236:239], v[60:63]
v_pk_fma_f16 v204, v205, v205, s48
v_bfe_u32 v192, v193, 2, 14
v_pk_mul_f16 v242, v243, v242
v_bfe_u32 v194, v195, 2, 14
v_mfma_f32_16x16x32_f16 v[64:67], v[0:3], v[232:235], v[64:67]
ds_read_b128 v[228:231], v250 offset:26880
ds_read_u16_d16 v192, v192
ds_read_u16_d16 v194, v194
v_pk_mul_f16 v207, v240, v207
v_lshrrev_b32_e64 v193, 18, v193
v_pk_mul_f16 v204, v205, v204
v_lshrrev_b32_e64 v195, 18, v195
v_mfma_f32_16x16x32_f16 v[72:75], v[0:3], v[236:239], v[72:75]
v_exp_f16 v241, v242
v_and_b32 v197, s49, v197
v_and_b32 v199, s49, v199
s_waitcnt vmcnt(4)
v_mfma_f32_16x16x32_bf16 v[72:75], v[26:29], v[32:35], v[72:75]
ds_read_b128 v[0:3], v250 offset:27648
ds_read_u16_d16_hi v193, v193
ds_read_u16_d16_hi v195, v195
v_exp_f16_e64 v206, v207
v_bfe_u32 v196, v197, 2, 14
v_bfe_u32 v198, v199, 2, 14
v_mfma_f32_16x16x32_bf16 v[76:79], v[24:27], v[32:35], v[76:79]
v_exp_f16 v203, v204
v_lshrrev_b32 v197, 18, v197
v_lshrrev_b32 v199, 18, v199
s_waitcnt lgkmcnt(6)
v_mfma_f32_16x16x32_f16 v[68:71], v[4:7], v[232:235], v[68:71]
ds_read_u16_d16 v196, v196
ds_read_u16_d16 v198, v198
ds_read_u16_d16_hi v197, v197
ds_read_u16_d16_hi v199, v199
v_exp_f16_sdwa v241, v242 dst_sel:WORD_1 dst_unused:UNUSED_PRESERVE src0_sel:WORD_1
v_and_b32_e64 v201, s49, v201
v_bfe_u32 v200, v201, 2, 14
v_mfma_f32_16x16x32_f16 v[76:79], v[4:7], v[236:239], v[76:79]
v_exp_f16_sdwa v206, v207 dst_sel:WORD_1 dst_unused:UNUSED_PRESERVE src0_sel:WORD_1
v_lshrrev_b32_e64 v201, 18, v201
v_mfma_f32_16x16x32_f16 v[80:83], v[40:43], v[232:235], v[80:83]
ds_read_b128 v[4:7], v250 offset:27904
ds_read_u16_d16 v200, v200
ds_read_u16_d16_hi v201, v201
v_exp_f16_sdwa v203, v204 dst_sel:WORD_1 dst_unused:UNUSED_PRESERVE src0_sel:WORD_1
v_pk_add_f16 v241, v241, 1.0 op_sel_hi:[1,0]
v_pk_add_f16 v206, v206, 1.0 op_sel_hi:[1,0]
v_pk_add_f16 v203, v203, 1.0 op_sel_hi:[1,0]
v_mfma_f32_16x16x32_f16 v[168:171], v[40:43], v[236:239], v[168:171]
v_rcp_f16 v242, v241
v_rcp_f16 v207, v206
v_mfma_f32_16x16x32_f16 v[84:87], v[44:47], v[232:235], v[84:87]
ds_read_b128 v[40:43], v250 offset:28672
v_rcp_f16_e64 v204, v203
v_rcp_f16_sdwa v242, v241 dst_sel:WORD_1 dst_unused:UNUSED_PRESERVE src0_sel:WORD_1
v_mfma_f32_16x16x32_f16 v[172:175], v[44:47], v[236:239], v[172:175]
v_rcp_f16_sdwa v207, v206 dst_sel:WORD_1 dst_unused:UNUSED_PRESERVE src0_sel:WORD_1
s_waitcnt lgkmcnt(5)
v_or_b32 v232, v192, v193
v_or_b32_e64 v233, v194, v195
v_or_b32 v234, v196, v197
v_rcp_f16_sdwa v204, v203 dst_sel:WORD_1 dst_unused:UNUSED_PRESERVE src0_sel:WORD_1
s_waitcnt lgkmcnt(4)
v_or_b32 v235, v198, v199
s_waitcnt lgkmcnt(1)
v_or_b32 v236, v200, v201
v_pk_mul_f16 v237, v243, v242
v_pk_mul_f16 v238, v240, v207
v_pk_mul_f16 v239, v205, v204
s_waitcnt vmcnt(3)
v_mfma_f32_16x16x32_bf16 v[168:171], v[26:29], v[216:219], v[168:171]
ds_read_b128 v[44:47], v250 offset:28928
v_mfma_f32_16x16x32_bf16 v[172:175], v[24:27], v[216:219], v[172:175]
v_mfma_f32_16x16x32_f16 v[48:51], v[224:227], v[232:235], v[48:51]
s_waitcnt lgkmcnt(0)
v_mfma_f32_16x16x32_f16 v[52:55], v[228:231], v[232:235], v[52:55]
v_mfma_f32_16x16x32_f16 v[64:67], v[0:3], v[232:235], v[64:67]
v_mfma_f32_16x16x32_f16 v[68:71], v[4:7], v[232:235], v[68:71]
v_mfma_f32_16x16x32_f16 v[80:83], v[40:43], v[232:235], v[80:83]
v_mfma_f32_16x16x32_f16 v[84:87], v[44:47], v[232:235], v[84:87]
s_nop 4
v_cvt_pk_bf16_f32 v64, v64, v65
v_cvt_pk_bf16_f32 v65, v66, v67
v_cvt_pk_bf16_f32 v66, v68, v69
v_cvt_pk_bf16_f32 v67, v70, v71
v_cvt_pk_bf16_f32 v48, v48, v49
v_cvt_pk_bf16_f32 v49, v50, v51
v_cvt_pk_bf16_f32 v50, v52, v53
v_cvt_pk_bf16_f32 v51, v54, v55
v_cvt_pk_bf16_f32 v80, v80, v81
v_cvt_pk_bf16_f32 v81, v82, v83
v_cvt_pk_bf16_f32 v82, v84, v85
v_cvt_pk_bf16_f32 v83, v86, v87
s_mov_b64 vcc, s[74:75]
v_cndmask_b32 v68, v48, v80, vcc
v_mfma_f32_16x16x32_f16 v[56:59], v[224:227], v[236:239], v[56:59]
v_cndmask_b32 v69, v49, v81, vcc
v_cndmask_b32 v70, v50, v82, vcc
v_mfma_f32_16x16x32_f16 v[60:63], v[228:231], v[236:239], v[60:63]
v_cndmask_b32 v71, v51, v83, vcc
v_cndmask_b32_dpp v48, v64, v48, vcc quad_perm:[1,0,3,2] row_mask:0xf bank_mask:0xf
v_mfma_f32_16x16x32_f16 v[72:75], v[0:3], v[236:239], v[72:75]
v_cndmask_b32_dpp v49, v65, v49, vcc quad_perm:[1,0,3,2] row_mask:0xf bank_mask:0xf
v_mfma_f32_16x16x32_f16 v[76:79], v[4:7], v[236:239], v[76:79]
v_cndmask_b32_dpp v50, v66, v50, vcc quad_perm:[1,0,3,2] row_mask:0xf bank_mask:0xf
v_cndmask_b32_dpp v51, v67, v51, vcc quad_perm:[1,0,3,2] row_mask:0xf bank_mask:0xf
s_not_b64 vcc, s[74:75]
v_mfma_f32_16x16x32_f16 v[168:171], v[40:43], v[236:239], v[168:171]
v_cndmask_b32_dpp v80, v64, v80, vcc quad_perm:[1,0,3,2] row_mask:0xf bank_mask:0xf
v_cndmask_b32_dpp v81, v65, v81, vcc quad_perm:[1,0,3,2] row_mask:0xf bank_mask:0xf
v_mfma_f32_16x16x32_f16 v[172:175], v[44:47], v[236:239], v[172:175]
v_cndmask_b32_dpp v82, v66, v82, vcc quad_perm:[1,0,3,2] row_mask:0xf bank_mask:0xf
v_cndmask_b32_dpp v83, v67, v83, vcc quad_perm:[1,0,3,2] row_mask:0xf bank_mask:0xf
buffer_store_dwordx4 v[48:51], v255, s[8:11], s69 offen sc1
buffer_store_dwordx4 v[68:71], v255, s[8:11], s69 offen offset:128 sc1
buffer_store_dwordx4 v[80:83], v255, s[8:11], s69 offen offset:256 sc1
v_cvt_pk_bf16_f32 v72, v72, v73
v_cvt_pk_bf16_f32 v73, v74, v75
v_cvt_pk_bf16_f32 v74, v76, v77
v_cvt_pk_bf16_f32 v75, v78, v79
v_cvt_pk_bf16_f32 v56, v56, v57
v_cvt_pk_bf16_f32 v57, v58, v59
v_cvt_pk_bf16_f32 v58, v60, v61
v_cvt_pk_bf16_f32 v59, v62, v63
v_cvt_pk_bf16_f32 v168, v168, v169
v_cvt_pk_bf16_f32 v169, v170, v171
v_cvt_pk_bf16_f32 v170, v172, v173
v_cvt_pk_bf16_f32 v171, v174, v175
s_mov_b64 vcc, s[74:75]
v_cndmask_b32 v76, v56, v168, vcc
v_cndmask_b32 v77, v57, v169, vcc
v_cndmask_b32 v78, v58, v170, vcc
v_cndmask_b32 v79, v59, v171, vcc
v_cndmask_b32_dpp v56, v72, v56, vcc quad_perm:[1,0,3,2] row_mask:0xf bank_mask:0xf
v_cndmask_b32_dpp v57, v73, v57, vcc quad_perm:[1,0,3,2] row_mask:0xf bank_mask:0xf
v_cndmask_b32_dpp v58, v74, v58, vcc quad_perm:[1,0,3,2] row_mask:0xf bank_mask:0xf
v_cndmask_b32_dpp v59, v75, v59, vcc quad_perm:[1,0,3,2] row_mask:0xf bank_mask:0xf
s_not_b64 vcc, s[74:75]
v_cndmask_b32_dpp v168, v72, v168, vcc quad_perm:[1,0,3,2] row_mask:0xf bank_mask:0xf
v_cndmask_b32_dpp v169, v73, v169, vcc quad_perm:[1,0,3,2] row_mask:0xf bank_mask:0xf
v_cndmask_b32_dpp v170, v74, v170, vcc quad_perm:[1,0,3,2] row_mask:0xf bank_mask:0xf
v_cndmask_b32_dpp v171, v75, v171, vcc quad_perm:[1,0,3,2] row_mask:0xf bank_mask:0xf
s_add_u32 s46, s69, 98304
buffer_store_dwordx4 v[56:59], v255, s[8:11], s46 offen sc1
s_add_u32 s46, s69, 98304
buffer_store_dwordx4 v[76:79], v255, s[8:11], s46 offen offset:128 sc1
s_add_u32 s46, s69, 98304
buffer_store_dwordx4 v[168:171], v255, s[8:11], s46 offen offset:256 sc1
s_endpgm
Lpoll:
s_waitcnt vmcnt(0)
Lpoll1:
s_cmp_eq_u32 s77, 2
s_cbranch_scc1 LpollC
v_max_u32 v250, v156, v157
v_max3_u32 v250, v250, v158, v159
v_max3_u32 v250, v250, v160, v161
v_max3_u32 v250, v250, v162, v163
v_max3_u32 v250, v250, v164, v165
v_max3_u32 v250, v250, v166, v167
v_max3_u32 v250, v250, v252, v253
v_max3_u32 v250, v250, v254, v255
v_cmp_eq_u32 vcc, -1, v250
s_nop 4
s_cbranch_vccz LpollR
v_lshlrev_b32 v250, 4, v251
s_lshl_b32 s44, s2, 12
buffer_load_dwordx4 v[156:159], v250, s[32:35], s44 offen sc1
buffer_load_dwordx4 v[160:163], v250, s[32:35], s44 offen offset:1024 sc1
buffer_load_dwordx4 v[164:167], v250, s[32:35], s44 offen offset:2048 sc1
buffer_load_dwordx4 v[252:255], v250, s[32:35], s44 offen offset:3072 sc1
s_setpc_b64 s[78:79]
LpollR:
s_setprio 3
v_add_f32 v156, v156, v160
v_add_f32 v252, v164, v252
v_add_f32 v252, v156, v252
v_add_f32 v157, v157, v161
v_add_f32 v253, v165, v253
v_add_f32 v253, v157, v253
v_add_f32 v158, v158, v162
v_add_f32 v254, v166, v254
v_add_f32 v254, v158, v254
v_add_f32 v159, v159, v163
v_add_f32 v255, v167, v255
v_add_f32 v255, v159, v255
v_add_f32_dpp v252, v252, v252 row_ror:8 row_mask:0xf bank_mask:0xf
v_add_f32_dpp v253, v253, v253 row_ror:8 row_mask:0xf bank_mask:0xf
v_add_f32_dpp v254, v254, v254 row_ror:8 row_mask:0xf bank_mask:0xf
v_add_f32_dpp v255, v255, v255 row_ror:8 row_mask:0xf bank_mask:0xf
v_add_f32_dpp v252, v252, v252 row_ror:4 row_mask:0xf bank_mask:0xf
v_add_f32_dpp v253, v253, v253 row_ror:4 row_mask:0xf bank_mask:0xf
v_add_f32_dpp v254, v254, v254 row_ror:4 row_mask:0xf bank_mask:0xf
v_add_f32_dpp v255, v255, v255 row_ror:4 row_mask:0xf bank_mask:0xf
v_add_f32_dpp v252, v252, v252 row_ror:2 row_mask:0xf bank_mask:0xf
v_add_f32_dpp v253, v253, v253 row_ror:2 row_mask:0xf bank_mask:0xf
v_add_f32_dpp v254, v254, v254 row_ror:2 row_mask:0xf bank_mask:0xf
v_add_f32_dpp v255, v255, v255 row_ror:2 row_mask:0xf bank_mask:0xf
v_add_f32_dpp v252, v252, v252 row_ror:1 row_mask:0xf bank_mask:0xf
v_add_f32_dpp v253, v253, v253 row_ror:1 row_mask:0xf bank_mask:0xf
v_add_f32_dpp v254, v254, v254 row_ror:1 row_mask:0xf bank_mask:0xf
v_add_f32_dpp v255, v255, v255 row_ror:1 row_mask:0xf bank_mask:0xf
v_mov_b32 v156, v252
v_mov_b32 v157, v253
v_mov_b32 v158, v254
v_mov_b32 v159, v255
v_permlane16_swap_b32 v252, v156
v_permlane16_swap_b32 v253, v157
v_permlane16_swap_b32 v254, v158
v_permlane16_swap_b32 v255, v159
v_add_f32 v252, v252, v156
v_add_f32 v253, v253, v157
v_add_f32 v254, v254, v158
v_add_f32 v255, v255, v159
v_mov_b32 v156, v252
v_mov_b32 v157, v253
v_mov_b32 v158, v254
v_mov_b32 v159, v255
v_permlane32_swap_b32 v252, v156
v_permlane32_swap_b32 v253, v157
v_permlane32_swap_b32 v254, v158
v_permlane32_swap_b32 v255, v159
v_add_f32 v252, v252, v156
v_add_f32 v253, v253, v157
v_add_f32 v254, v254, v158
v_add_f32 v255, v255, v159
v_min_u32 v252, -2, v252
v_min_u32 v253, -2, v253
v_min_u32_e64 v254, -2, v254
v_min_u32 v255, -2, v255
s_lshl_b32 s44, s2, 4
s_add_u32 s44, s44, 393216
v_lshlrev_b32_e64 v250, 11, v251
s_mov_b64 exec, 0xff
buffer_store_dwordx4 v[252:255], v250, s[32:35], s44 offen sc1
s_mov_b64 exec, -1
s_cmp_eq_u32 s40, 0
s_cselect_b32 s77, 2, 0
s_cbranch_scc0 LpollRx
v_lshlrev_b32_e64 v250, 2, v251
buffer_load_dword v162, v250, s[24:27], 0 offen
buffer_load_dword v163, v250, s[24:27], 0 offen offset:256
buffer_load_dword v164, v250, s[24:27], 0 offen offset:512
v_lshlrev_b32_e64 v250, 3, v251
s_and_b32 s44, s2, 7
s_lshl_b32 s44, s44, 11
s_add_u32 s44, s44, 393216
buffer_load_dwordx2 v[156:157], v250, s[32:35], s44 offen sc1
buffer_load_dwordx2 v[158:159], v250, s[32:35], s44 offen offset:512 sc1
buffer_load_dwordx2 v[160:161], v250, s[32:35], s44 offen offset:1024 sc1
LpollRx:
s_setpc_b64 s[78:79]
LpollC:
v_max3_u32 v250, v156, v157, v158
v_max3_u32 v250, v250, v159, v160
v_max_u32 v250, v250, v161
v_cmp_eq_u32 vcc, -1, v250
s_nop 4
s_cbranch_vccz LpollS
v_lshlrev_b32 v250, 2, v251
buffer_load_dword v162, v250, s[24:27], 0 offen
buffer_load_dword v163, v250, s[24:27], 0 offen offset:256
buffer_load_dword v164, v250, s[24:27], 0 offen offset:512
v_lshlrev_b32_e64 v250, 3, v251
s_and_b32 s44, s2, 7
s_lshl_b32 s44, s44, 11
s_add_u32 s44, s44, 393216
buffer_load_dwordx2 v[156:157], v250, s[32:35], s44 offen sc1
buffer_load_dwordx2 v[158:159], v250, s[32:35], s44 offen offset:512 sc1
buffer_load_dwordx2 v[160:161], v250, s[32:35], s44 offen offset:1024 sc1
s_setpc_b64 s[78:79]
LpollS:
s_setprio 3
s_mov_b32 s43, 1083296634
v_mov_b32 v165, 897988541
v_fma_f32 v156, v156, s43, v165
v_fma_f32 v157, v157, s43, v165
v_fma_f32 v158, v158, s43, v165
v_fma_f32 v159, v159, s43, v165
v_fma_f32 v160, v160, s43, v165
v_fma_f32 v161, v161, s43, v165
v_sqrt_f32 v156, v156
v_sqrt_f32 v157, v157
v_sqrt_f32 v158, v158
v_sqrt_f32 v159, v159
v_sqrt_f32 v160, v160
v_sqrt_f32 v161, v161
v_add_f32 v166, v156, v157
v_add_f32 v166, v166, v158
v_add_f32 v166, v166, v159
v_add_f32 v166, v166, v160
v_add_f32 v166, v166, v161
s_nop 1
v_add_f32_dpp v166, v166, v166 row_ror:8 row_mask:0xf bank_mask:0xf
s_nop 1
v_add_f32_dpp v166, v166, v166 row_ror:4 row_mask:0xf bank_mask:0xf
s_nop 1
v_add_f32_dpp v166, v166, v166 row_ror:2 row_mask:0xf bank_mask:0xf
s_nop 1
v_add_f32_dpp v166, v166, v166 row_ror:1 row_mask:0xf bank_mask:0xf
v_mov_b32 v250, v166
s_nop 1
v_permlane16_swap_b32 v166, v250
v_add_f32 v166, v166, v250
v_mov_b32 v250, v166
s_nop 1
v_permlane32_swap_b32 v166, v250
v_add_f32_e64 v166, v166, v250
s_mov_b32 s43, 992651947
v_fma_f32 v166, v166, s43, v165
v_rcp_f32_e64 v166, v166
v_mov_b32 v165, 3221789604
v_mul_f32 v166, v166, v165
v_lshlrev_b32 v167, 16, v162
v_and_b32 v252, 4294901760, v162
v_mul_f32 v156, v156, v166
v_mul_f32 v157, v157, v166
v_fma_f32 v167, v167, v156, v165
v_fma_f32 v252, v252, v157, v165
v_cvt_pk_f16_f32 v162, v167, v252
v_lshlrev_b32_e64 v167, 16, v163
v_and_b32 v252, 4294901760, v163
v_mul_f32 v158, v158, v166
v_mul_f32 v159, v159, v166
v_fma_f32 v167, v167, v158, v165
v_fma_f32 v252, v252, v159, v165
v_cvt_pk_f16_f32 v163, v167, v252
v_lshlrev_b32_e64 v167, 16, v164
v_and_b32 v252, 4294901760, v164
v_mul_f32 v160, v160, v166
v_mul_f32 v161, v161, v166
v_fma_f32 v167, v167, v160, v165
v_fma_f32 v252, v252, v161, v165
v_cvt_pk_f16_f32 v164, v167, v252
s_mov_b32 s77, 0
s_setpc_b64 s[78:79]
Lend:
s_endpgm

.section .rodata,"a"
.p2align 6
.amdhsa_kernel standalone__modern_conv_block_convnext_v2__vision_kernel
  .amdhsa_next_free_vgpr 256
  .amdhsa_next_free_sgpr 102
  .amdhsa_accum_offset 256
  .amdhsa_group_segment_fixed_size 0
  .amdhsa_kernarg_size 72
  .amdhsa_user_sgpr_count 2
  .amdhsa_user_sgpr_kernarg_segment_ptr 1
  .amdhsa_system_sgpr_workgroup_id_x 1
.end_amdhsa_kernel
```

```asm
; @launch grid=(256,1,1) block=(512,1,1) lds=163840
.amdgcn_target "amdgcn-amd-amdhsa--gfx950"
.text
.globl standalone__modern_conv_block_convnext_v2__vision_kernel
.p2align 8
.type standalone__modern_conv_block_convnext_v2__vision_kernel,@function
standalone__modern_conv_block_convnext_v2__vision_kernel:
Lmain:
s_cmp_ge_u32 s2, 256
s_cbranch_scc1 Lend
s_load_dwordx16 s[80:95], s[0:1], 0
s_load_dwordx2 s[96:97], s[0:1], 64
s_getpc_b64 s[74:75]
Lpc0:
s_sub_u32 s74, s74, Lpc0-Lmain
s_subb_u32 s75, s75, 0
v_lshlrev_b32 v159, 7, v0
s_movk_i32 s43, 64
v_cmp_gt_u32 vcc, s43, v0
s_and_saveexec_b64 s[78:79], vcc
s_cbranch_execz Lpf0x
global_load_dword v255, v159, s[74:75]
Lpf0x:
s_mov_b64 exec, s[78:79]
v_mov_b32 v199, v0
v_and_b32 v251, 63, v0
v_lshrrev_b32 v120, 6, v0
s_nop 0
v_readfirstlane_b32 s40, v120
s_and_b32 s43, s2, 7
s_lshr_b32 s44, s2, 3
s_and_b32 s41, s43, 0
s_lshl_b32 s41, s41, 4
s_and_b32 s45, s44, 15
s_add_u32 s41, s41, s45
s_lshr_b32 s42, s43, 0
s_lshl_b32 s42, s42, 1
s_lshr_b32 s45, s44, 4
s_add_u32 s42, s42, s45
s_lshl_b32 s41, s41, 5
s_lshl_b32 s42, s42, 5
s_lshl_b32 s67, s40, 6
s_cmp_eq_u32 s40, 6
s_cselect_b32 s67, 352, s67
v_add_u32_e64 v125, s67, v251
v_mul_u32_u24 v121, 5462, v125
v_lshrrev_b32 v121, 16, v121
v_mul_u32_u24 v122, 12, v121
v_sub_u32_e64 v122, v125, v122
v_bfe_u32 v123, v121, 2, 2
v_xor_b32_e64 v122, v122, v123
v_add_u32 v123, s41, v121
v_subrev_u32 v123, 1, v123
v_mul_u32_u24 v124, 192, v123
v_lshl_add_u32 v124, v122, 4, v124
v_mov_b32 v240, 2147483648
s_movk_i32 s43, 512
v_cmp_gt_u32 vcc, s43, v123
s_nop 1
v_cndmask_b32 v124, v240, v124, vcc
v_cmp_gt_u32 vcc, 34, v121
s_nop 1
v_cndmask_b32_e64 v240, v240, v124, vcc
s_add_i32 s43, s42, -1
s_mul_i32 s44, s43, 98304
s_cmp_lt_u32 s43, 512
s_cselect_b32 s46, s44, 1073741824
s_mul_i32 s66, s42, 98304
s_mov_b32 s6, 50331648
s_mov_b32 s7, 131072
s_lshl_b32 s67, s67, 4
s_add_u32 s67, s67, 90112
s_cmp_eq_u32 s40, 7
s_cselect_b32 s67, 163840, s67
v_lshlrev_b32_e64 v130, 1, v199
v_add_u32 v155, 768, v199
v_min_u32 v155, 863, v155
v_lshlrev_b32_e64 v131, 1, v155
s_waitcnt lgkmcnt(0)
s_mov_b32 s4, s80
s_and_b32 s5, s81, 65535
s_cmp_ge_u32 s40, 4
s_cbranch_scc1 Lnodw
s_mov_b32 s20, s82
s_and_b32 s21, s83, 65535
s_mov_b32 s22, 1728
s_mov_b32 s23, 131072
buffer_load_ushort v126, v130, s[20:23], 0 offen offset:0
buffer_load_ushort v127, v130, s[20:23], 0 offen offset:512
buffer_load_ushort v128, v130, s[20:23], 0 offen offset:1024
buffer_load_ushort v129, v131, s[20:23], 0 offen offset:0
Lnodw:
s_cmp_eq_u32 s40, 7
s_cbranch_scc1 Lskipx0
s_add_u32 m0, s67, 0
s_nop 0
buffer_load_dwordx4 v240, s[4:7], s46 offen nt lds
s_add_u32 m0, s67, 6656
s_nop 0
buffer_load_dwordx4 v240, s[4:7], s66 offen nt lds
s_add_u32 m0, s67, 13312
s_add_u32 s45, s66, 98304
buffer_load_dwordx4 v240, s[4:7], s45 offen nt lds
s_add_u32 m0, s67, 19968
s_add_u32 s45, s66, 196608
buffer_load_dwordx4 v240, s[4:7], s45 offen nt lds
s_add_u32 m0, s67, 26624
s_add_u32 s45, s66, 294912
buffer_load_dwordx4 v240, s[4:7], s45 offen nt lds
s_add_u32 m0, s67, 33280
s_add_u32 s45, s66, 393216
buffer_load_dwordx4 v240, s[4:7], s45 offen nt lds
Lskipx0:
s_mov_b32 s12, s84
s_and_b32 s13, s85, 65535
s_mov_b32 s14, 73728
s_mov_b32 s15, 131072
v_lshrrev_b32 v189, 2, v251
v_mul_u32_u24 v189, 768, v189
v_and_b32_e64 v125, 3, v251
v_lshl_add_u32 v189, v125, 4, v189
s_and_b32 s43, s40, 3
s_lshl_b32 s3, s43, 6
s_mul_i32 s77, s43, 6144
s_add_u32 s77, s77, 16384
v_mov_b32 v253, 16256
v_mov_b32 v254, 1
s_add_u32 s43, s42, s40
s_add_u32 s43, s43, 1
s_lshl_b32 s43, s43, 9
s_add_u32 s43, s43, s41
s_mul_i32 s47, s43, 192
s_sub_u32 s47, s47, 256
s_and_b32 s43, s40, 1
s_lshl_b32 s46, s43, 4
s_add_u32 s41, s41, s46
s_and_b32 s43, s40, 6
s_add_u32 s42, s42, s43
s_mul_i32 s45, s43, 6656
s_add_u32 s45, s45, 90112
v_and_b32 v131, 15, v251
v_lshrrev_b32 v132, 4, v251
v_mul_u32_u24 v122, 6656, v132
v_add_u32 v122, s45, v122
v_add_u32 v121, s46, v131
v_mul_u32_u24 v123, 192, v121
v_bfe_u32 v124, v121, 2, 2
v_lshl_add_u32 v123, v124, 4, v123
v_add_u32 v242, v122, v123
v_add_u32 v121, 1, v121
v_mul_u32_u24 v123, 192, v121
v_bfe_u32 v124, v121, 2, 2
v_lshl_add_u32 v123, v124, 4, v123
v_add_u32 v243, v122, v123
v_add_u32 v121, 1, v121
v_mul_u32_u24 v123, 192, v121
v_bfe_u32 v124, v121, 2, 2
v_lshl_add_u32 v123, v124, 4, v123
v_add_u32_e64 v244, v122, v123
s_mul_i32 s72, s40, 9216
s_add_u32 s72, s72, 90112
v_bfe_u32 v133, v131, 2, 1
v_sub_u32 v133, v132, v133
v_lshrrev_b32 v134, 3, v131
v_and_b32_e64 v135, 3, v131
v_lshl_add_u32 v135, v134, 2, v135
v_lshlrev_b32_e64 v136, 7, v133
v_lshl_add_u32 v136, v135, 4, v136
v_add_u32 v136, 156672, v136
v_mov_b32 v135, 163840
v_cmp_gt_u32 vcc, 3, v133
s_nop 1
v_cndmask_b32 v245, v135, v136, vcc
v_and_b32 v135, 3, v131
v_mul_u32_u24 v246, 85, v135
s_mov_b32 s16, s86
s_and_b32 s17, s87, 65535
s_mov_b32 s18, 73728
s_mov_b32 s19, 131072
s_mov_b32 s24, s88
s_and_b32 s25, s89, 65535
s_mov_b32 s26, 768
s_mov_b32 s27, 131072
s_mov_b32 s28, s90
s_and_b32 s29, s91, 65535
s_mov_b32 s30, 768
s_mov_b32 s31, 131072
s_mov_b32 s8, s92
s_and_b32 s9, s93, 65535
s_mov_b32 s10, 50331648
s_mov_b32 s11, 131072
s_mov_b32 s36, s94
s_and_b32 s37, s95, 65535
s_mov_b32 s38, 256
s_mov_b32 s39, 131072
s_mov_b32 s32, s96
s_and_b32 s33, s97, 65535
s_mov_b32 s34, 83886080
s_mov_b32 s35, 131072
v_lshlrev_b32 v241, 4, v251
v_and_b32 v133, 35, v251
v_bfe_u32 v134, v251, 2, 2
v_lshl_add_u32 v133, v134, 3, v133
v_bfe_u32 v134, v251, 4, 1
v_lshl_add_u32 v133, v134, 2, v133
v_lshlrev_b32_e64 v248, 4, v133
v_add_u32 v249, 65536, v248
v_add_u32 v250, 131072, v248
s_lshl_b32 s73, s2, 3
s_add_u32 s73, s73, s40
s_lshl_b32 s80, s73, 10
s_add_u32 s80, s80, 4194304
s_mul_i32 s73, s73, 16
s_add_u32 s73, s73, 1048576
s_mul_i32 s46, s41, 192
s_add_u32 s43, s42, 0
s_mul_i32 s43, s43, 98304
s_add_u32 s68, s43, s46
s_add_u32 s43, s42, 8
s_mul_i32 s43, s43, 98304
s_add_u32 s69, s43, s46
s_add_u32 s43, s42, 16
s_mul_i32 s43, s43, 98304
s_add_u32 s70, s43, s46
s_add_u32 s43, s42, 24
s_mul_i32 s43, s43, 98304
s_add_u32 s71, s43, s46
s_mul_i32 s82, s40, 9216
s_mov_b32 s48, 1156203754
s_mov_b32 s49, 4294508536
s_mov_b32 s76, 400000
v_lshrrev_b32 v148, 5, v251
v_lshlrev_b32 v190, 8, v148
v_bfe_u32 v148, v251, 2, 2
v_lshl_add_u32 v190, v148, 6, v190
v_bfe_u32 v148, v251, 4, 1
v_lshl_add_u32 v190, v148, 5, v190
v_bfe_u32 v148, v251, 0, 1
v_lshl_add_u32 v190, v148, 4, v190
v_bfe_u32 v148, v251, 1, 1
v_lshl_add_u32 v190, v148, 3, v190
v_add_u32 v190, s77, v190
v_add_u32 v191, s77, v248
s_cmp_lt_u32 s40, 4
s_cbranch_scc1 Lnoy
v_lshlrev_b32_e64 v24, 6, v199
s_mov_b32 s43, 1065362610
v_mov_b32 v25, 1084047360
v_add_u32 v0, 32772, v24
v_add_u32 v1, 32780, v24
v_add_u32 v2, 32788, v24
v_add_u32 v3, 32796, v24
v_add_u32 v4, 32804, v24
v_add_u32 v5, 32812, v24
v_add_u32 v6, 32820, v24
v_add_u32 v7, 32828, v24
v_cvt_f32_f16 v0, v0
v_cvt_f32_f16 v1, v1
v_cvt_f32_f16 v2, v2
v_cvt_f32_f16 v3, v3
v_cvt_f32_f16 v4, v4
v_cvt_f32_f16 v5, v5
v_cvt_f32_f16 v6, v6
v_cvt_f32_f16 v7, v7
v_mul_f32 v8, v0, v0
v_mul_f32 v9, v1, v1
v_mul_f32 v10, v2, v2
v_mul_f32 v11, v3, v3
v_mul_f32 v12, v4, v4
v_mul_f32 v13, v5, v5
v_mul_f32 v14, v6, v6
v_mul_f32 v15, v7, v7
v_fma_f32 v8, v8, s43, v25
v_fma_f32 v9, v9, s43, v25
v_fma_f32 v10, v10, s43, v25
v_fma_f32 v11, v11, s43, v25
v_fma_f32 v12, v12, s43, v25
v_fma_f32 v13, v13, s43, v25
v_fma_f32 v14, v14, s43, v25
v_fma_f32 v15, v15, s43, v25
v_mul_f32 v8, v0, v8
v_mul_f32 v9, v1, v9
v_mul_f32 v10, v2, v10
v_mul_f32 v11, v3, v11
v_mul_f32 v12, v4, v12
v_mul_f32 v13, v5, v13
v_mul_f32 v14, v6, v14
v_mul_f32 v15, v7, v15
v_exp_f32 v8, v8
v_exp_f32 v9, v9
v_exp_f32 v10, v10
v_exp_f32 v11, v11
v_exp_f32 v12, v12
v_exp_f32 v13, v13
v_exp_f32 v14, v14
v_exp_f32 v15, v15
v_add_f32 v16, 1.0, v8
v_add_f32 v17, 1.0, v9
v_add_f32 v18, 1.0, v10
v_add_f32 v19, 1.0, v11
v_add_f32 v20, 1.0, v12
v_add_f32 v21, 1.0, v13
v_add_f32 v22, 1.0, v14
v_add_f32 v23, 1.0, v15
v_rcp_f32 v16, v16
v_rcp_f32 v17, v17
v_rcp_f32 v18, v18
v_rcp_f32 v19, v19
v_rcp_f32 v20, v20
v_rcp_f32 v21, v21
v_rcp_f32 v22, v22
v_rcp_f32 v23, v23
v_mul_f32 v0, v0, v16
v_mul_f32 v1, v1, v17
v_mul_f32 v2, v2, v18
v_mul_f32 v3, v3, v19
v_mul_f32 v4, v4, v20
v_mul_f32 v5, v5, v21
v_mul_f32 v6, v6, v22
v_mul_f32 v7, v7, v23
v_mul_f32 v8, v8, v0
v_mul_f32 v9, v9, v1
v_mul_f32 v10, v10, v2
v_mul_f32 v11, v11, v3
v_mul_f32 v12, v12, v4
v_mul_f32 v13, v13, v5
v_mul_f32 v14, v14, v6
v_mul_f32 v15, v15, v7
v_cvt_pk_f16_f32 v28, v0, v1
v_cvt_pk_f16_f32 v32, -v8, -v9
v_cvt_pk_f16_f32 v29, v2, v3
v_cvt_pk_f16_f32 v33, -v10, -v11
v_cvt_pk_f16_f32 v30, v4, v5
v_cvt_pk_f16_f32 v34, -v12, -v13
v_cvt_pk_f16_f32 v31, v6, v7
v_cvt_pk_f16_f32 v35, -v14, -v15
v_lshlrev_b32_e64 v24, 4, v199
v_mov_b32 v25, 163840
s_movk_i32 s43, 496
v_cmp_gt_u32 vcc, s43, v199
s_nop 1
v_cndmask_b32 v24, v25, v24, vcc
ds_write_b128 v24, v[32:35]
ds_write_b128 v24, v[28:31] offset:8192
Lnoy:
s_cmp_ge_u32 s40, 4
s_cbranch_scc1 Lnoo
v_add_u32_e64 v152, 0, v199
v_mul_u32_u24 v140, 683, v152
v_lshrrev_b32 v140, 16, v140
v_mul_u32_u24 v142, 11, v140
v_lshrrev_b32 v142, 5, v142
v_lshrrev_b32 v143, 5, v152
v_bfe_u32 v141, v152, 3, 2
v_bfe_u32 v144, v152, 4, 1
v_xor_b32 v141, v141, v144
v_sub_u32 v141, v141, v142
v_mul_i32_i24 v141, 9, v141
v_add_u32 v143, v143, v141
v_lshrrev_b32_e64 v141, 1, v143
v_mul_u32_u24 v141, 368, v141
v_lshl_add_u32 v143, v143, 3, v141
v_lshl_add_u32 v143, v142, 7, v143
v_and_b32_e64 v144, 7, v152
v_lshl_add_u32 v143, v144, 4, v143
v_add_u32 v156, 156672, v143
v_add_u32 v153, 256, v199
v_mul_u32_u24 v140, 683, v153
v_lshrrev_b32 v140, 16, v140
v_mul_u32_u24 v142, 11, v140
v_lshrrev_b32 v142, 5, v142
v_lshrrev_b32 v143, 5, v153
v_bfe_u32 v141, v153, 3, 2
v_bfe_u32 v144, v153, 4, 1
v_xor_b32 v141, v141, v144
v_sub_u32 v141, v141, v142
v_mul_i32_i24 v141, 9, v141
v_add_u32 v143, v143, v141
v_lshrrev_b32_e64 v141, 1, v143
v_mul_u32_u24 v141, 368, v141
v_lshl_add_u32 v143, v143, 3, v141
v_lshl_add_u32 v143, v142, 7, v143
v_and_b32_e64 v144, 7, v153
v_lshl_add_u32 v143, v144, 4, v143
v_add_u32 v157, 156672, v143
v_add_u32 v154, 512, v199
v_mul_u32_u24 v140, 683, v154
v_lshrrev_b32 v140, 16, v140
v_mul_u32_u24 v142, 11, v140
v_lshrrev_b32 v142, 5, v142
v_lshrrev_b32 v143, 5, v154
v_bfe_u32 v141, v154, 3, 2
v_bfe_u32 v144, v154, 4, 1
v_xor_b32 v141, v141, v144
v_sub_u32 v141, v141, v142
v_mul_i32_i24 v141, 9, v141
v_add_u32 v143, v143, v141
v_lshrrev_b32_e64 v141, 1, v143
v_mul_u32_u24 v141, 368, v141
v_lshl_add_u32 v143, v143, 3, v141
v_lshl_add_u32 v143, v142, 7, v143
v_and_b32_e64 v144, 7, v154
v_lshl_add_u32 v143, v144, 4, v143
v_add_u32 v158, 156672, v143
v_mul_u32_u24 v140, 683, v155
v_lshrrev_b32 v140, 16, v140
v_mul_u32_u24 v142, 11, v140
v_lshrrev_b32 v142, 5, v142
v_lshrrev_b32 v143, 5, v155
v_bfe_u32 v141, v155, 3, 2
v_bfe_u32 v144, v155, 4, 1
v_xor_b32 v141, v141, v144
v_sub_u32 v141, v141, v142
v_mul_i32_i24 v141, 9, v141
v_add_u32 v143, v143, v141
v_lshrrev_b32_e64 v141, 1, v143
v_mul_u32_u24 v141, 368, v141
v_lshl_add_u32 v143, v143, 3, v141
v_lshl_add_u32 v143, v142, 7, v143
v_and_b32_e64 v144, 7, v155
v_lshl_add_u32 v143, v144, 4, v143
v_add_u32 v159, 156672, v143
v_mov_b32 v160, 0
v_mov_b32 v161, 0
v_mov_b32_e64 v162, 0
v_mov_b32 v163, 0
s_mov_b64 exec, 1
ds_write_b128 v253, v[160:163]
ds_write_b128 v253, v[160:163] offset:16
s_mov_b64 exec, -1
s_waitcnt vmcnt(6)
v_and_b32 v130, 4, v152
v_cmp_eq_u32 vcc, 0, v130
s_nop 1
v_cndmask_b32 v164, 0, v126, vcc
v_sub_u32_e64 v165, v126, v164
ds_write_b64 v156, v[164:165]
v_and_b32 v130, 4, v153
v_cmp_eq_u32 vcc, 0, v130
s_nop 1
v_cndmask_b32 v166, 0, v127, vcc
v_sub_u32_e64 v167, v127, v166
ds_write_b64 v157, v[166:167]
v_and_b32 v130, 4, v154
v_cmp_eq_u32 vcc, 0, v130
s_nop 1
v_cndmask_b32 v168, 0, v128, vcc
v_sub_u32_e64 v169, v128, v168
ds_write_b64 v158, v[168:169]
v_and_b32 v130, 4, v155
v_cmp_eq_u32 vcc, 0, v130
s_nop 1
v_cndmask_b32 v170, 0, v129, vcc
v_sub_u32_e64 v171, v129, v170
ds_write_b64 v159, v[170:171]
s_waitcnt lgkmcnt(0)
Lnoo:
s_barrier
s_cmp_lt_u32 s40, 4
s_cbranch_scc1 Lnoy2
v_subrev_u32 v199, 256, v199
v_lshlrev_b32_e64 v24, 6, v199
s_mov_b32 s43, 1065362610
v_mov_b32 v25, 1084047360
v_add_u32 v0, 32772, v24
v_add_u32 v1, 32780, v24
v_add_u32 v2, 32788, v24
v_add_u32 v3, 32796, v24
v_add_u32 v4, 32804, v24
v_add_u32 v5, 32812, v24
v_add_u32 v6, 32820, v24
v_add_u32 v7, 32828, v24
v_cvt_f32_f16 v0, v0
v_cvt_f32_f16 v1, v1
v_cvt_f32_f16 v2, v2
v_cvt_f32_f16 v3, v3
v_cvt_f32_f16 v4, v4
v_cvt_f32_f16 v5, v5
v_cvt_f32_f16 v6, v6
v_cvt_f32_f16 v7, v7
v_mul_f32 v8, v0, v0
v_mul_f32 v9, v1, v1
v_mul_f32 v10, v2, v2
v_mul_f32 v11, v3, v3
v_mul_f32 v12, v4, v4
v_mul_f32 v13, v5, v5
v_mul_f32 v14, v6, v6
v_mul_f32 v15, v7, v7
v_fma_f32 v8, v8, s43, v25
v_fma_f32 v9, v9, s43, v25
v_fma_f32 v10, v10, s43, v25
v_fma_f32 v11, v11, s43, v25
v_fma_f32 v12, v12, s43, v25
v_fma_f32 v13, v13, s43, v25
v_fma_f32 v14, v14, s43, v25
v_fma_f32 v15, v15, s43, v25
v_mul_f32 v8, v0, v8
v_mul_f32 v9, v1, v9
v_mul_f32 v10, v2, v10
v_mul_f32 v11, v3, v11
v_mul_f32 v12, v4, v12
v_mul_f32 v13, v5, v13
v_mul_f32 v14, v6, v14
v_mul_f32 v15, v7, v15
v_exp_f32 v8, v8
v_exp_f32 v9, v9
v_exp_f32 v10, v10
v_exp_f32 v11, v11
v_exp_f32 v12, v12
v_exp_f32 v13, v13
v_exp_f32 v14, v14
v_exp_f32 v15, v15
v_add_f32 v16, 1.0, v8
v_add_f32 v17, 1.0, v9
v_add_f32 v18, 1.0, v10
v_add_f32 v19, 1.0, v11
v_add_f32 v20, 1.0, v12
v_add_f32 v21, 1.0, v13
v_add_f32 v22, 1.0, v14
v_add_f32 v23, 1.0, v15
v_rcp_f32 v16, v16
v_rcp_f32 v17, v17
v_rcp_f32 v18, v18
v_rcp_f32 v19, v19
v_rcp_f32 v20, v20
v_rcp_f32 v21, v21
v_rcp_f32 v22, v22
v_rcp_f32 v23, v23
v_mul_f32 v0, v0, v16
v_mul_f32 v1, v1, v17
v_mul_f32 v2, v2, v18
v_mul_f32 v3, v3, v19
v_mul_f32 v4, v4, v20
v_mul_f32 v5, v5, v21
v_mul_f32 v6, v6, v22
v_mul_f32 v7, v7, v23
v_mul_f32 v8, v8, v0
v_mul_f32 v9, v9, v1
v_mul_f32 v10, v10, v2
v_mul_f32 v11, v11, v3
v_mul_f32 v12, v12, v4
v_mul_f32 v13, v13, v5
v_mul_f32 v14, v14, v6
v_mul_f32 v15, v15, v7
v_cvt_pk_f16_f32 v28, v0, v1
v_cvt_pk_f16_f32 v32, -v8, -v9
v_cvt_pk_f16_f32 v29, v2, v3
v_cvt_pk_f16_f32 v33, -v10, -v11
v_cvt_pk_f16_f32 v30, v4, v5
v_cvt_pk_f16_f32 v34, -v12, -v13
v_cvt_pk_f16_f32 v31, v6, v7
v_cvt_pk_f16_f32 v35, -v14, -v15
v_lshlrev_b32 v24, 4, v199
v_mov_b32 v25, 163840
s_movk_i32 s43, 496
v_cmp_gt_u32 vcc, s43, v199
s_nop 1
v_cndmask_b32 v24, v25, v24, vcc
ds_write_b128 v24, v[32:35]
ds_write_b128 v24, v[28:31] offset:8192
Lnoy2:
s_setprio 2
s_cmp_lt_u32 s40, 4
s_cbranch_scc0 Lsu0
s_call_b64 s[78:79], Lpre
s_call_b64 s[78:79], Lrb
s_waitcnt vmcnt(4)
s_mov_b64 exec, 1
ds_add_u32 v253, v254 offset:28
s_mov_b64 exec, -1
v_mov_b32 v253, 16256
Lsw288w:
ds_read_b32 v247, v253 offset:28
s_waitcnt lgkmcnt(0)
v_readfirstlane_b32 s43, v247
s_cmp_eq_u32 s76, 0
s_cbranch_scc1 Lsw288x
s_sub_u32 s76, s76, 1
s_cmp_lt_u32 s43, 8
s_cbranch_scc0 Lsw288x
s_sleep 2
s_branch Lsw288w
Lsw288x:
s_call_b64 s[78:79], Lconv0
s_mov_b64 exec, 1
ds_add_u32 v253, v254 offset:16
s_mov_b64 exec, -1
s_call_b64 s[78:79], Lln0
s_waitcnt vmcnt(0)
s_mov_b64 exec, 1
ds_add_u32 v253, v254 offset:12
s_mov_b64 exec, -1
s_call_b64 s[78:79], Lw1i
Lsu0:
s_cmp_ge_u32 s40, 4
s_cbranch_scc0 Lsu2
s_setprio 3
s_call_b64 s[78:79], Lw1f
s_waitcnt vmcnt(6)
s_mov_b64 exec, 1
ds_add_u32 v253, v254 offset:28
s_mov_b64 exec, -1
s_call_b64 s[78:79], Lrb
s_waitcnt vmcnt(4)
s_call_b64 s[78:79], Lw1a
s_mov_b64 exec, 1
ds_add_u32 v253, v254 offset:20
s_mov_b64 exec, -1
s_call_b64 s[78:79], Lpre
s_waitcnt vmcnt(0)
s_mov_b64 exec, 1
ds_add_u32 v253, v254 offset:12
s_mov_b64 exec, -1
v_mov_b32 v253, 16256
Lsw128w:
ds_read_b32 v247, v253 offset:12
s_waitcnt lgkmcnt(0)
v_readfirstlane_b32 s43, v247
s_cmp_eq_u32 s76, 0
s_cbranch_scc1 Lsw128x
s_sub_u32 s76, s76, 1
s_cmp_lt_u32 s43, 8
s_cbranch_scc0 Lsw128x
s_sleep 2
s_branch Lsw128w
Lsw128x:
s_call_b64 s[78:79], Lconv0
s_mov_b64 exec, 1
ds_add_u32 v253, v254 offset:16
s_mov_b64 exec, -1
s_call_b64 s[78:79], Lln0
Lsu2:
s_branch Lgo
Lconv0:
ds_read_b128 v[192:195], v242
ds_read_b128 v[196:199], v242 offset:64
ds_read_b128 v[200:203], v242 offset:128
ds_read_b128 v[204:207], v243
ds_read_b128 v[208:211], v243 offset:64
ds_read_b128 v[212:215], v243 offset:128
ds_read_b128 v[224:227], v244
ds_read_b128 v[228:231], v244 offset:64
ds_read_b128 v[232:235], v244 offset:128
v_xor_b32_e64 v242, 16, v242
ds_read_b128 v[236:239], v242
ds_read_b128 v[216:219], v242 offset:64
ds_read_b128 v[220:223], v242 offset:128
s_waitcnt lgkmcnt(11)
v_smfmac_f32_16x16x32_bf16 v[0:3], v[48:49], v[192:195], v246
s_waitcnt lgkmcnt(10)
v_smfmac_f32_16x16x32_bf16 v[16:19], v[50:51], v[196:199], v246
s_waitcnt lgkmcnt(9)
v_smfmac_f32_16x16x32_bf16 v[32:35], v[52:53], v[200:203], v246
s_waitcnt lgkmcnt(8)
v_xor_b32_e64 v243, 16, v243
ds_read_b128 v[192:195], v243
ds_read_b128 v[196:199], v243 offset:64
v_smfmac_f32_16x16x32_bf16 v[0:3], v[54:55], v[204:207], v246
s_waitcnt lgkmcnt(9)
v_smfmac_f32_16x16x32_bf16 v[16:19], v[56:57], v[208:211], v246
s_waitcnt lgkmcnt(8)
ds_read_b128 v[200:203], v243 offset:128
v_xor_b32_e64 v244, 16, v244
ds_read_b128 v[204:207], v244
v_smfmac_f32_16x16x32_bf16 v[32:35], v[58:59], v[212:215], v246
s_waitcnt lgkmcnt(9)
v_smfmac_f32_16x16x32_bf16 v[0:3], v[60:61], v[224:227], v246
s_waitcnt lgkmcnt(8)
ds_read_b128 v[208:211], v244 offset:64
ds_read_b128 v[212:215], v244 offset:128
v_smfmac_f32_16x16x32_bf16 v[16:19], v[62:63], v[228:231], v246
s_waitcnt lgkmcnt(9)
v_smfmac_f32_16x16x32_bf16 v[32:35], v[64:65], v[232:235], v246
s_waitcnt lgkmcnt(8)
v_xor_b32_e64 v242, 32, v242
ds_read_b128 v[224:227], v242
ds_read_b128 v[228:231], v242 offset:64
v_smfmac_f32_16x16x32_bf16 v[4:7], v[66:67], v[236:239], v246
s_waitcnt lgkmcnt(9)
v_smfmac_f32_16x16x32_bf16 v[20:23], v[68:69], v[216:219], v246
s_waitcnt lgkmcnt(8)
ds_read_b128 v[232:235], v242 offset:128
v_xor_b32_e64 v243, 32, v243
ds_read_b128 v[236:239], v243
v_smfmac_f32_16x16x32_bf16 v[36:39], v[70:71], v[220:223], v246
s_waitcnt lgkmcnt(9)
v_smfmac_f32_16x16x32_bf16 v[4:7], v[72:73], v[192:195], v246
s_waitcnt lgkmcnt(8)
ds_read_b128 v[216:219], v243 offset:64
ds_read_b128 v[220:223], v243 offset:128
v_smfmac_f32_16x16x32_bf16 v[20:23], v[74:75], v[196:199], v246
s_waitcnt lgkmcnt(9)
v_smfmac_f32_16x16x32_bf16 v[36:39], v[76:77], v[200:203], v246
s_waitcnt lgkmcnt(8)
v_xor_b32_e64 v244, 32, v244
ds_read_b128 v[192:195], v244
ds_read_b128 v[196:199], v244 offset:64
v_smfmac_f32_16x16x32_bf16 v[4:7], v[78:79], v[204:207], v246
s_waitcnt lgkmcnt(9)
v_smfmac_f32_16x16x32_bf16 v[20:23], v[80:81], v[208:211], v246
s_waitcnt lgkmcnt(8)
ds_read_b128 v[200:203], v244 offset:128
v_xor_b32_e64 v242, 16, v242
ds_read_b128 v[204:207], v242
v_smfmac_f32_16x16x32_bf16 v[36:39], v[82:83], v[212:215], v246
s_waitcnt lgkmcnt(9)
v_smfmac_f32_16x16x32_bf16 v[12:15], v[84:85], v[224:227], v246
s_waitcnt lgkmcnt(8)
ds_read_b128 v[208:211], v242 offset:64
ds_read_b128 v[212:215], v242 offset:128
v_smfmac_f32_16x16x32_bf16 v[28:31], v[86:87], v[228:231], v246
s_waitcnt lgkmcnt(9)
v_smfmac_f32_16x16x32_bf16 v[44:47], v[88:89], v[232:235], v246
s_waitcnt lgkmcnt(8)
v_xor_b32_e64 v243, 16, v243
ds_read_b128 v[224:227], v243
ds_read_b128 v[228:231], v243 offset:64
v_smfmac_f32_16x16x32_bf16 v[12:15], v[90:91], v[236:239], v246
s_waitcnt lgkmcnt(9)
v_smfmac_f32_16x16x32_bf16 v[28:31], v[92:93], v[216:219], v246
s_waitcnt lgkmcnt(8)
ds_read_b128 v[232:235], v243 offset:128
v_xor_b32_e64 v244, 16, v244
ds_read_b128 v[236:239], v244
v_smfmac_f32_16x16x32_bf16 v[44:47], v[94:95], v[220:223], v246
s_waitcnt lgkmcnt(9)
v_smfmac_f32_16x16x32_bf16 v[12:15], v[96:97], v[192:195], v246
s_waitcnt lgkmcnt(8)
ds_read_b128 v[216:219], v244 offset:64
ds_read_b128 v[220:223], v244 offset:128
v_smfmac_f32_16x16x32_bf16 v[28:31], v[98:99], v[196:199], v246
s_waitcnt lgkmcnt(9)
v_smfmac_f32_16x16x32_bf16 v[44:47], v[100:101], v[200:203], v246
s_waitcnt lgkmcnt(8)
v_smfmac_f32_16x16x32_bf16 v[8:11], v[102:103], v[204:207], v246
s_waitcnt lgkmcnt(7)
v_smfmac_f32_16x16x32_bf16 v[24:27], v[104:105], v[208:211], v246
s_waitcnt lgkmcnt(6)
v_smfmac_f32_16x16x32_bf16 v[40:43], v[106:107], v[212:215], v246
s_waitcnt lgkmcnt(5)
v_smfmac_f32_16x16x32_bf16 v[8:11], v[108:109], v[224:227], v246
s_waitcnt lgkmcnt(4)
v_smfmac_f32_16x16x32_bf16 v[24:27], v[110:111], v[228:231], v246
s_waitcnt lgkmcnt(3)
v_smfmac_f32_16x16x32_bf16 v[40:43], v[112:113], v[232:235], v246
s_waitcnt lgkmcnt(2)
v_smfmac_f32_16x16x32_bf16 v[8:11], v[114:115], v[236:239], v246
s_waitcnt lgkmcnt(1)
v_smfmac_f32_16x16x32_bf16 v[24:27], v[116:117], v[216:219], v246
s_waitcnt lgkmcnt(0)
v_smfmac_f32_16x16x32_bf16 v[40:43], v[118:119], v[220:223], v246
s_nop 11
s_setpc_b64 s[78:79]
Lln0:
v_pk_add_f32 v[168:169], v[0:1], v[2:3]
v_pk_mul_f32 v[170:171], v[0:1], v[0:1]
v_pk_fma_f32 v[170:171], v[2:3], v[2:3], v[170:171]
v_pk_add_f32 v[168:169], v[168:169], v[4:5]
v_pk_fma_f32 v[170:171], v[4:5], v[4:5], v[170:171]
v_pk_add_f32 v[168:169], v[168:169], v[6:7]
v_pk_fma_f32 v[170:171], v[6:7], v[6:7], v[170:171]
v_pk_add_f32 v[168:169], v[168:169], v[8:9]
v_pk_fma_f32 v[170:171], v[8:9], v[8:9], v[170:171]
v_pk_add_f32 v[168:169], v[168:169], v[10:11]
v_pk_fma_f32 v[170:171], v[10:11], v[10:11], v[170:171]
v_pk_add_f32 v[168:169], v[168:169], v[12:13]
v_pk_fma_f32 v[170:171], v[12:13], v[12:13], v[170:171]
v_pk_add_f32 v[168:169], v[168:169], v[14:15]
v_pk_fma_f32 v[170:171], v[14:15], v[14:15], v[170:171]
v_pk_add_f32 v[168:169], v[168:169], v[16:17]
v_pk_fma_f32 v[170:171], v[16:17], v[16:17], v[170:171]
v_pk_add_f32 v[168:169], v[168:169], v[18:19]
v_pk_fma_f32 v[170:171], v[18:19], v[18:19], v[170:171]
v_pk_add_f32 v[168:169], v[168:169], v[20:21]
v_pk_fma_f32 v[170:171], v[20:21], v[20:21], v[170:171]
v_pk_add_f32 v[168:169], v[168:169], v[22:23]
v_pk_fma_f32 v[170:171], v[22:23], v[22:23], v[170:171]
v_pk_add_f32 v[168:169], v[168:169], v[24:25]
v_pk_fma_f32 v[170:171], v[24:25], v[24:25], v[170:171]
v_pk_add_f32 v[168:169], v[168:169], v[26:27]
v_pk_fma_f32 v[170:171], v[26:27], v[26:27], v[170:171]
v_pk_add_f32 v[168:169], v[168:169], v[28:29]
v_pk_fma_f32 v[170:171], v[28:29], v[28:29], v[170:171]
v_pk_add_f32 v[168:169], v[168:169], v[30:31]
v_pk_fma_f32 v[170:171], v[30:31], v[30:31], v[170:171]
v_pk_add_f32 v[168:169], v[168:169], v[32:33]
v_pk_fma_f32 v[170:171], v[32:33], v[32:33], v[170:171]
v_pk_add_f32 v[168:169], v[168:169], v[34:35]
v_pk_fma_f32 v[170:171], v[34:35], v[34:35], v[170:171]
v_pk_add_f32 v[168:169], v[168:169], v[36:37]
v_pk_fma_f32 v[170:171], v[36:37], v[36:37], v[170:171]
v_pk_add_f32 v[168:169], v[168:169], v[38:39]
v_pk_fma_f32 v[170:171], v[38:39], v[38:39], v[170:171]
v_pk_add_f32 v[168:169], v[168:169], v[40:41]
v_pk_fma_f32 v[170:171], v[40:41], v[40:41], v[170:171]
v_pk_add_f32 v[168:169], v[168:169], v[42:43]
v_pk_fma_f32 v[170:171], v[42:43], v[42:43], v[170:171]
v_pk_add_f32 v[168:169], v[168:169], v[44:45]
v_pk_fma_f32 v[170:171], v[44:45], v[44:45], v[170:171]
v_pk_add_f32 v[168:169], v[168:169], v[46:47]
v_pk_fma_f32 v[170:171], v[46:47], v[46:47], v[170:171]
v_add_f32 v168, v168, v169
v_add_f32 v170, v170, v171
s_nop 1
v_permlane32_swap_b32 v168, v170
v_add_f32_e64 v168, v168, v170
v_mul_f32 v168, 1009429163, v168
v_mov_b32_e64 v170, v168
s_nop 1
v_permlane32_swap_b32 v168, v170
v_fma_f32 v170, -v168, v168, v170
v_max_f32_e64 v170, 0, v170
v_add_f32 v170, 925353388, v170
v_rsq_f32 v170, v170
s_nop 0
v_mul_f32 v172, 3203391086, v170
v_mul_f32_e64 v173, v168, v172
v_pk_fma_f32 v[0:1], v[0:1], v[172:173], v[172:173] op_sel:[0,0,1] op_sel_hi:[1,0,1] neg_lo:[0,0,1] neg_hi:[0,0,1]
v_pk_fma_f32 v[2:3], v[2:3], v[172:173], v[172:173] op_sel:[0,0,1] op_sel_hi:[1,0,1] neg_lo:[0,0,1] neg_hi:[0,0,1]
v_pk_fma_f32 v[4:5], v[4:5], v[172:173], v[172:173] op_sel:[0,0,1] op_sel_hi:[1,0,1] neg_lo:[0,0,1] neg_hi:[0,0,1]
v_pk_fma_f32 v[6:7], v[6:7], v[172:173], v[172:173] op_sel:[0,0,1] op_sel_hi:[1,0,1] neg_lo:[0,0,1] neg_hi:[0,0,1]
v_pk_fma_f32 v[8:9], v[8:9], v[172:173], v[172:173] op_sel:[0,0,1] op_sel_hi:[1,0,1] neg_lo:[0,0,1] neg_hi:[0,0,1]
v_pk_fma_f32 v[10:11], v[10:11], v[172:173], v[172:173] op_sel:[0,0,1] op_sel_hi:[1,0,1] neg_lo:[0,0,1] neg_hi:[0,0,1]
v_pk_fma_f32 v[12:13], v[12:13], v[172:173], v[172:173] op_sel:[0,0,1] op_sel_hi:[1,0,1] neg_lo:[0,0,1] neg_hi:[0,0,1]
v_pk_fma_f32 v[14:15], v[14:15], v[172:173], v[172:173] op_sel:[0,0,1] op_sel_hi:[1,0,1] neg_lo:[0,0,1] neg_hi:[0,0,1]
v_pk_fma_f32 v[16:17], v[16:17], v[172:173], v[172:173] op_sel:[0,0,1] op_sel_hi:[1,0,1] neg_lo:[0,0,1] neg_hi:[0,0,1]
v_pk_fma_f32 v[18:19], v[18:19], v[172:173], v[172:173] op_sel:[0,0,1] op_sel_hi:[1,0,1] neg_lo:[0,0,1] neg_hi:[0,0,1]
v_pk_fma_f32 v[20:21], v[20:21], v[172:173], v[172:173] op_sel:[0,0,1] op_sel_hi:[1,0,1] neg_lo:[0,0,1] neg_hi:[0,0,1]
v_pk_fma_f32 v[22:23], v[22:23], v[172:173], v[172:173] op_sel:[0,0,1] op_sel_hi:[1,0,1] neg_lo:[0,0,1] neg_hi:[0,0,1]
v_pk_fma_f32 v[24:25], v[24:25], v[172:173], v[172:173] op_sel:[0,0,1] op_sel_hi:[1,0,1] neg_lo:[0,0,1] neg_hi:[0,0,1]
v_pk_fma_f32 v[26:27], v[26:27], v[172:173], v[172:173] op_sel:[0,0,1] op_sel_hi:[1,0,1] neg_lo:[0,0,1] neg_hi:[0,0,1]
v_pk_fma_f32 v[28:29], v[28:29], v[172:173], v[172:173] op_sel:[0,0,1] op_sel_hi:[1,0,1] neg_lo:[0,0,1] neg_hi:[0,0,1]
v_pk_fma_f32 v[30:31], v[30:31], v[172:173], v[172:173] op_sel:[0,0,1] op_sel_hi:[1,0,1] neg_lo:[0,0,1] neg_hi:[0,0,1]
v_pk_fma_f32 v[32:33], v[32:33], v[172:173], v[172:173] op_sel:[0,0,1] op_sel_hi:[1,0,1] neg_lo:[0,0,1] neg_hi:[0,0,1]
v_pk_fma_f32 v[34:35], v[34:35], v[172:173], v[172:173] op_sel:[0,0,1] op_sel_hi:[1,0,1] neg_lo:[0,0,1] neg_hi:[0,0,1]
v_pk_fma_f32 v[36:37], v[36:37], v[172:173], v[172:173] op_sel:[0,0,1] op_sel_hi:[1,0,1] neg_lo:[0,0,1] neg_hi:[0,0,1]
v_pk_fma_f32 v[38:39], v[38:39], v[172:173], v[172:173] op_sel:[0,0,1] op_sel_hi:[1,0,1] neg_lo:[0,0,1] neg_hi:[0,0,1]
v_pk_fma_f32 v[40:41], v[40:41], v[172:173], v[172:173] op_sel:[0,0,1] op_sel_hi:[1,0,1] neg_lo:[0,0,1] neg_hi:[0,0,1]
v_pk_fma_f32 v[42:43], v[42:43], v[172:173], v[172:173] op_sel:[0,0,1] op_sel_hi:[1,0,1] neg_lo:[0,0,1] neg_hi:[0,0,1]
v_pk_fma_f32 v[44:45], v[44:45], v[172:173], v[172:173] op_sel:[0,0,1] op_sel_hi:[1,0,1] neg_lo:[0,0,1] neg_hi:[0,0,1]
v_pk_fma_f32 v[46:47], v[46:47], v[172:173], v[172:173] op_sel:[0,0,1] op_sel_hi:[1,0,1] neg_lo:[0,0,1] neg_hi:[0,0,1]
v_cvt_pk_bf16_f32 v48, v0, v1
v_cvt_pk_bf16_f32 v49, v2, v3
v_cvt_pk_bf16_f32 v50, v4, v5
v_cvt_pk_bf16_f32 v51, v6, v7
v_cvt_pk_bf16_f32 v52, v8, v9
v_cvt_pk_bf16_f32 v53, v10, v11
v_cvt_pk_bf16_f32 v54, v12, v13
v_cvt_pk_bf16_f32 v55, v14, v15
v_cvt_pk_bf16_f32 v56, v16, v17
v_cvt_pk_bf16_f32 v57, v18, v19
v_cvt_pk_bf16_f32 v58, v20, v21
v_cvt_pk_bf16_f32 v59, v22, v23
v_cvt_pk_bf16_f32 v60, v24, v25
v_cvt_pk_bf16_f32 v61, v26, v27
v_cvt_pk_bf16_f32 v62, v28, v29
v_cvt_pk_bf16_f32 v63, v30, v31
v_cvt_pk_bf16_f32 v64, v32, v33
v_cvt_pk_bf16_f32 v65, v34, v35
v_cvt_pk_bf16_f32 v66, v36, v37
v_cvt_pk_bf16_f32 v67, v38, v39
v_cvt_pk_bf16_f32 v68, v40, v41
v_cvt_pk_bf16_f32 v69, v42, v43
v_cvt_pk_bf16_f32 v70, v44, v45
v_cvt_pk_bf16_f32 v71, v46, v47
s_nop 1
s_setpc_b64 s[78:79]
Lw1a:
ds_read_b64_tr_b16 v[148:149], v190
ds_read_b64_tr_b16 v[150:151], v190 offset:512
ds_read_b64_tr_b16 v[152:153], v190 offset:1024
ds_read_b64_tr_b16 v[154:155], v190 offset:1536
ds_read_b64_tr_b16 v[156:157], v190 offset:2048
ds_read_b64_tr_b16 v[158:159], v190 offset:2560
ds_read_b64_tr_b16 v[160:161], v190 offset:3072
ds_read_b64_tr_b16 v[162:163], v190 offset:3584
ds_read_b64_tr_b16 v[164:165], v190 offset:4096
ds_read_b64_tr_b16 v[166:167], v190 offset:4608
ds_read_b64_tr_b16 v[168:169], v190 offset:5120
ds_read_b64_tr_b16 v[170:171], v190 offset:5632
s_waitcnt lgkmcnt(10)
ds_write_b128 v191, v[148:151]
s_waitcnt lgkmcnt(9)
ds_write_b128 v191, v[152:155] offset:1024
s_waitcnt lgkmcnt(8)
ds_write_b128 v191, v[156:159] offset:2048
s_waitcnt lgkmcnt(7)
ds_write_b128 v191, v[160:163] offset:3072
s_waitcnt lgkmcnt(6)
ds_write_b128 v191, v[164:167] offset:4096
s_waitcnt lgkmcnt(5)
ds_write_b128 v191, v[168:171] offset:5120
s_waitcnt lgkmcnt(0)
s_setpc_b64 s[78:79]
Lw1i:
s_add_u32 m0, s77, 24576
s_add_u32 s43, s3, 256
buffer_load_dwordx4 v189, s[12:15], s43 offen lds
s_add_u32 m0, s77, 25600
s_add_u32 s43, s3, 24832
buffer_load_dwordx4 v189, s[12:15], s43 offen lds
s_add_u32 m0, s77, 26624
s_add_u32 s43, s3, 49408
buffer_load_dwordx4 v189, s[12:15], s43 offen lds
s_add_u32 m0, s77, 27648
s_add_u32 s43, s3, 12544
buffer_load_dwordx4 v189, s[12:15], s43 offen lds
s_add_u32 m0, s77, 28672
s_add_u32 s43, s3, 37120
buffer_load_dwordx4 v189, s[12:15], s43 offen lds
s_add_u32 m0, s77, 29696
s_add_u32 s43, s3, 61696
buffer_load_dwordx4 v189, s[12:15], s43 offen lds
s_add_u32 m0, s77, 49152
s_add_u32 s43, s3, 512
buffer_load_dwordx4 v189, s[12:15], s43 offen lds
s_add_u32 m0, s77, 50176
s_add_u32 s43, s3, 25088
buffer_load_dwordx4 v189, s[12:15], s43 offen lds
s_add_u32 m0, s77, 51200
s_add_u32 s43, s3, 49664
buffer_load_dwordx4 v189, s[12:15], s43 offen lds
s_add_u32 m0, s77, 52224
s_add_u32 s43, s3, 12800
buffer_load_dwordx4 v189, s[12:15], s43 offen lds
s_add_u32 m0, s77, 53248
s_add_u32 s43, s3, 37376
buffer_load_dwordx4 v189, s[12:15], s43 offen lds
s_add_u32 m0, s77, 54272
s_add_u32 s43, s3, 61952
buffer_load_dwordx4 v189, s[12:15], s43 offen lds
s_setpc_b64 s[78:79]
Lw1b:
ds_read_b64_tr_b16 v[72:73], v190 offset:24576
ds_read_b64_tr_b16 v[74:75], v190 offset:25088
ds_read_b64_tr_b16 v[76:77], v190 offset:25600
ds_read_b64_tr_b16 v[78:79], v190 offset:26112
ds_read_b64_tr_b16 v[80:81], v190 offset:26624
ds_read_b64_tr_b16 v[82:83], v190 offset:27136
ds_read_b64_tr_b16 v[84:85], v190 offset:27648
ds_read_b64_tr_b16 v[86:87], v190 offset:28160
ds_read_b64_tr_b16 v[88:89], v190 offset:28672
ds_read_b64_tr_b16 v[90:91], v190 offset:29184
ds_read_b64_tr_b16 v[92:93], v190 offset:29696
ds_read_b64_tr_b16 v[94:95], v190 offset:30208
s_waitcnt lgkmcnt(10)
ds_write_b128 v191, v[72:75] offset:24576
s_waitcnt lgkmcnt(9)
ds_write_b128 v191, v[76:79] offset:25600
s_waitcnt lgkmcnt(8)
ds_write_b128 v191, v[80:83] offset:26624
s_waitcnt lgkmcnt(7)
ds_write_b128 v191, v[84:87] offset:27648
s_waitcnt lgkmcnt(6)
ds_write_b128 v191, v[88:91] offset:28672
s_waitcnt lgkmcnt(5)
ds_write_b128 v191, v[92:95] offset:29696
s_waitcnt lgkmcnt(0)
s_setpc_b64 s[78:79]
Lw1c:
ds_read_b64_tr_b16 v[72:73], v190 offset:49152
ds_read_b64_tr_b16 v[74:75], v190 offset:49664
ds_read_b64_tr_b16 v[76:77], v190 offset:50176
ds_read_b64_tr_b16 v[78:79], v190 offset:50688
ds_read_b64_tr_b16 v[80:81], v190 offset:51200
ds_read_b64_tr_b16 v[82:83], v190 offset:51712
ds_read_b64_tr_b16 v[84:85], v190 offset:52224
ds_read_b64_tr_b16 v[86:87], v190 offset:52736
ds_read_b64_tr_b16 v[88:89], v190 offset:53248
ds_read_b64_tr_b16 v[90:91], v190 offset:53760
ds_read_b64_tr_b16 v[92:93], v190 offset:54272
ds_read_b64_tr_b16 v[94:95], v190 offset:54784
s_waitcnt lgkmcnt(10)
ds_write_b128 v191, v[72:75] offset:49152
s_waitcnt lgkmcnt(9)
ds_write_b128 v191, v[76:79] offset:50176
s_waitcnt lgkmcnt(8)
ds_write_b128 v191, v[80:83] offset:51200
s_waitcnt lgkmcnt(7)
ds_write_b128 v191, v[84:87] offset:52224
s_waitcnt lgkmcnt(6)
ds_write_b128 v191, v[88:91] offset:53248
s_waitcnt lgkmcnt(5)
ds_write_b128 v191, v[92:95] offset:54272
s_waitcnt lgkmcnt(0)
s_setpc_b64 s[78:79]
Lpre:
ds_read_b128 v[48:51], v245
ds_read_b128 v[52:55], v245 offset:384
ds_read_b128 v[56:59], v245 offset:768
ds_read_b128 v[60:63], v245 offset:1152
ds_read_b128 v[64:67], v245 offset:1536
ds_read_b128 v[68:71], v245 offset:1920
ds_read_b128 v[72:75], v245 offset:2304
ds_read_b128 v[76:79], v245 offset:2688
ds_read_b128 v[80:83], v245 offset:3072
ds_read_b128 v[84:87], v245 offset:3456
ds_read_b128 v[88:91], v245 offset:3840
ds_read_b128 v[92:95], v245 offset:4224
ds_read_b128 v[96:99], v245 offset:4608
ds_read_b128 v[100:103], v245 offset:4992
ds_read_b128 v[104:107], v245 offset:5376
ds_read_b128 v[108:111], v245 offset:5760
ds_read_b128 v[112:115], v245 offset:6144
ds_read_b128 v[116:119], v245 offset:6528
v_mov_b32 v0, 0
v_mov_b32 v1, 0
v_mov_b32 v2, 0
v_mov_b32 v3, 0
v_mov_b32 v4, 0
v_mov_b32 v5, 0
v_mov_b32 v6, 0
v_mov_b32 v7, 0
v_mov_b32 v8, 0
v_mov_b32 v9, 0
v_mov_b32 v10, 0
v_mov_b32 v11, 0
v_mov_b32 v12, 0
v_mov_b32 v13, 0
v_mov_b32 v14, 0
v_mov_b32 v15, 0
v_mov_b32 v16, 0
v_mov_b32 v17, 0
v_mov_b32 v18, 0
v_mov_b32 v19, 0
v_mov_b32 v20, 0
v_mov_b32 v21, 0
v_mov_b32 v22, 0
v_mov_b32 v23, 0
v_mov_b32 v24, 0
v_mov_b32 v25, 0
v_mov_b32 v26, 0
v_mov_b32 v27, 0
v_mov_b32 v28, 0
v_mov_b32 v29, 0
v_mov_b32 v30, 0
v_mov_b32 v31, 0
v_mov_b32 v32, 0
v_mov_b32 v33, 0
v_mov_b32 v34, 0
v_mov_b32 v35, 0
v_mov_b32 v36, 0
v_mov_b32 v37, 0
v_mov_b32 v38, 0
v_mov_b32 v39, 0
v_mov_b32 v40, 0
v_mov_b32 v41, 0
v_mov_b32 v42, 0
v_mov_b32 v43, 0
v_mov_b32 v44, 0
v_mov_b32 v45, 0
v_mov_b32 v46, 0
v_mov_b32 v47, 0
s_waitcnt lgkmcnt(0)
s_setpc_b64 s[78:79]
Lrb:
s_add_u32 m0, s67, 39936
s_add_u32 s45, s66, 491520
buffer_load_dwordx4 v240, s[4:7], s45 offen nt lds
s_add_u32 m0, s67, 46592
s_add_u32 s45, s66, 589824
buffer_load_dwordx4 v240, s[4:7], s45 offen nt lds
s_add_u32 m0, s67, 53248
s_add_u32 s45, s66, 688128
buffer_load_dwordx4 v240, s[4:7], s45 offen nt lds
s_add_u32 m0, s67, 59904
s_add_u32 s45, s66, 786432
buffer_load_dwordx4 v240, s[4:7], s45 offen nt lds
s_setpc_b64 s[78:79]
Lw1f:
s_add_u32 m0, s77, 0
s_add_u32 s43, s3, 0
buffer_load_dwordx4 v189, s[12:15], s43 offen lds
s_add_u32 m0, s77, 1024
s_add_u32 s43, s3, 24576
buffer_load_dwordx4 v189, s[12:15], s43 offen lds
s_add_u32 m0, s77, 2048
s_add_u32 s43, s3, 49152
buffer_load_dwordx4 v189, s[12:15], s43 offen lds
s_add_u32 m0, s77, 3072
s_add_u32 s43, s3, 12288
buffer_load_dwordx4 v189, s[12:15], s43 offen lds
s_add_u32 m0, s77, 4096
s_add_u32 s43, s3, 36864
buffer_load_dwordx4 v189, s[12:15], s43 offen lds
s_add_u32 m0, s77, 5120
s_add_u32 s43, s3, 61440
buffer_load_dwordx4 v189, s[12:15], s43 offen lds
s_setpc_b64 s[78:79]
Lgo:
v_mov_b32 v253, 16256
Lsw204w:
ds_read_b32 v247, v253 offset:20
s_waitcnt lgkmcnt(0)
v_readfirstlane_b32 s43, v247
s_cmp_eq_u32 s76, 0
s_cbranch_scc1 Lsw204x
s_sub_u32 s76, s76, 1
s_cmp_lt_u32 s43, 4
s_cbranch_scc0 Lsw204x
s_sleep 2
s_branch Lsw204w
Lsw204x:
s_cmp_lg_u32 s40, 7
s_cbranch_scc1 Lnopf
s_getpc_b64 s[74:75]
Lpc:
s_lshr_b32 s43, s2, 3
s_and_b32 s43, s43, 15
s_lshl_b32 s43, s43, 13
v_lshlrev_b32 v102, 7, v251
v_add_u32 v102, s43, v102
v_min_u32 v102, Lend-Lpc, v102
global_load_dword v255, v102, s[74:75]
Lnopf:
s_add_u32 s66, s66, 786432
ds_read_b128 v[224:227], v248 offset:16384
ds_read_b128 v[228:231], v248 offset:19456
ds_read_b128 v[232:235], v248 offset:17408
ds_read_b128 v[236:239], v248 offset:20480
ds_read_b128 v[216:219], v248 offset:18432
ds_read_b128 v[220:223], v248 offset:21504
s_setprio 2
s_waitcnt lgkmcnt(5)
v_mfma_f32_32x32x16_bf16 v[120:135], v[48:51], v[224:227], 0
s_waitcnt lgkmcnt(4)
ds_read_b128 v[224:227], v248 offset:22528
v_mfma_f32_32x32x16_bf16 v[120:135], v[52:55], v[228:231], v[120:135]
s_waitcnt lgkmcnt(4)
ds_read_b128 v[228:231], v248 offset:25600
v_mfma_f32_32x32x16_bf16 v[120:135], v[56:59], v[232:235], v[120:135]
s_waitcnt lgkmcnt(4)
ds_read_b128 v[232:235], v248 offset:23552
v_mfma_f32_32x32x16_bf16 v[120:135], v[60:63], v[236:239], v[120:135]
s_waitcnt lgkmcnt(4)
ds_read_b128 v[236:239], v248 offset:26624
v_mfma_f32_32x32x16_bf16 v[120:135], v[64:67], v[216:219], v[120:135]
s_waitcnt lgkmcnt(4)
ds_read_b128 v[216:219], v248 offset:24576
v_mfma_f32_32x32x16_bf16 v[120:135], v[68:71], v[220:223], v[120:135]
v_add_u32 v174, -36864, v242
v_subrev_u32 v175, 66560, v174
v_min_u32 v174, v174, v175
v_add_u32 v174, 90112, v174
v_sub_u32 v175, v174, v242
v_add_u32 v242, v175, v242
v_add_u32_e64 v243, v175, v243
v_add_u32 v244, v175, v244
s_nop 3
v_cvt_pkrtz_f16_f32 v137, v120, v121
v_cvt_pkrtz_f16_f32 v139, v122, v123
v_cvt_pkrtz_f16_f32 v141, v124, v125
v_cvt_pkrtz_f16_f32 v143, v126, v127
v_cvt_pkrtz_f16_f32 v177, v128, v129
v_cvt_pk_f16_f32 v155, v130, v131
v_cvt_pk_f16_f32 v152, v132, v133
v_cvt_pk_f16_f32 v149, v134, v135
s_waitcnt lgkmcnt(1)
ds_read_b128 v[220:223], v248 offset:27648
v_mfma_f32_32x32x16_bf16 v[120:135], v[48:51], v[224:227], 0
v_pk_fma_f16 v154, v155, v155, s48
v_and_b32 v137, s49, v137
v_pk_fma_f16 v151, v152, v152, s48
v_pk_fma_f16 v148, v149, v149, s48
v_bfe_u32 v136, v137, 2, 14
v_pk_mul_f16 v154, v155, v154
v_pk_mul_f16 v151, v152, v151
v_pk_mul_f16 v148, v149, v148
ds_read_b128 v[224:227], v248 offset:28672
ds_read_u16_d16 v136, v136
v_mfma_f32_32x32x16_bf16 v[120:135], v[52:55], v[228:231], v[120:135]
v_lshrrev_b32 v137, 18, v137
v_exp_f16 v153, v154
v_exp_f16 v150, v151
v_and_b32 v139, s49, v139
v_exp_f16_e64 v147, v148
v_bfe_u32 v138, v139, 2, 14
ds_read_b128 v[228:231], v248 offset:31744
ds_read_u16_d16_hi v137, v137
ds_read_u16_d16 v138, v138
v_mfma_f32_32x32x16_bf16 v[120:135], v[56:59], v[232:235], v[120:135]
v_exp_f16_sdwa v153, v154 dst_sel:WORD_1 dst_unused:UNUSED_PRESERVE src0_sel:WORD_1
v_lshrrev_b32_e64 v139, 18, v139
v_exp_f16_sdwa v150, v151 dst_sel:WORD_1 dst_unused:UNUSED_PRESERVE src0_sel:WORD_1
v_exp_f16_sdwa v147, v148 dst_sel:WORD_1 dst_unused:UNUSED_PRESERVE src0_sel:WORD_1
v_and_b32_e64 v141, s49, v141
ds_read_b128 v[232:235], v248 offset:29696
ds_read_u16_d16_hi v139, v139
v_mfma_f32_32x32x16_bf16 v[120:135], v[60:63], v[236:239], v[120:135]
v_pk_add_f16 v153, v153, 1.0 op_sel_hi:[1,0]
v_bfe_u32 v140, v141, 2, 14
v_pk_add_f16 v150, v150, 1.0 op_sel_hi:[1,0]
v_pk_add_f16 v147, v147, 1.0 op_sel_hi:[1,0]
v_rcp_f16 v154, v153
v_lshrrev_b32 v141, 18, v141
v_rcp_f16 v151, v150
s_waitcnt lgkmcnt(5)
ds_read_b128 v[236:239], v248 offset:32768
ds_read_u16_d16 v140, v140
ds_read_u16_d16_hi v141, v141
v_mfma_f32_32x32x16_bf16 v[120:135], v[64:67], v[216:219], v[120:135]
v_and_b32 v143, s49, v143
v_rcp_f16 v148, v147
v_bfe_u32 v142, v143, 2, 14
v_rcp_f16_sdwa v154, v153 dst_sel:WORD_1 dst_unused:UNUSED_PRESERVE src0_sel:WORD_1
v_rcp_f16_sdwa v151, v150 dst_sel:WORD_1 dst_unused:UNUSED_PRESERVE src0_sel:WORD_1
ds_read_b128 v[216:219], v248 offset:30720
ds_read_u16_d16 v142, v142
ds_read_b32 v247, v253 offset:16
v_mfma_f32_32x32x16_bf16 v[120:135], v[68:71], v[220:223], v[120:135]
v_lshrrev_b32_e64 v143, 18, v143
v_rcp_f16_sdwa v148, v147 dst_sel:WORD_1 dst_unused:UNUSED_PRESERVE src0_sel:WORD_1
v_and_b32_e64 v177, s49, v177
v_pk_mul_f16 v155, v155, v154
v_pk_mul_f16 v152, v152, v151
v_bfe_u32 v176, v177, 2, 14
v_pk_mul_f16 v149, v149, v148
v_fma_mix_f32 v156, v155, v155, 0 op_sel:[0,0,0] op_sel_hi:[1,1,0]
v_fma_mix_f32 v156, v155, v155, v156 op_sel:[1,1,0] op_sel_hi:[1,1,0]
v_lshrrev_b32_e64 v177, 18, v177
v_fma_mix_f32 v156, v152, v152, v156 op_sel:[0,0,0] op_sel_hi:[1,1,0]
v_fma_mix_f32 v156, v152, v152, v156 op_sel:[1,1,0] op_sel_hi:[1,1,0]
v_fma_mix_f32 v156, v149, v149, v156 op_sel:[0,0,0] op_sel_hi:[1,1,0]
v_fma_mix_f32 v156, v149, v149, v156 op_sel:[1,1,0] op_sel_hi:[1,1,0]
ds_read_u16_d16_hi v143, v143
ds_read_u16_d16 v176, v176
ds_read_u16_d16_hi v177, v177
s_waitcnt lgkmcnt(3)
v_readfirstlane_b32 s43, v247
s_nop 1
s_cmp_ge_u32 s43, 8
s_cbranch_scc1 Lev1
Lev1w:
s_sleep 1
ds_read_b32 v247, v253 offset:16
s_waitcnt lgkmcnt(0)
v_readfirstlane_b32 s43, v247
s_cmp_eq_u32 s76, 0
s_cbranch_scc1 Lev1
s_sub_u32 s76, s76, 1
s_cmp_lt_u32 s43, 8
s_cbranch_scc1 Lev1w
Lev1:
v_cvt_pkrtz_f16_f32 v179, v120, v121
v_cvt_pkrtz_f16_f32 v181, v122, v123
v_cvt_pkrtz_f16_f32 v183, v124, v125
v_cvt_pkrtz_f16_f32 v185, v126, v127
v_cvt_pkrtz_f16_f32 v187, v128, v129
v_cvt_pk_f16_f32 v155, v130, v131
v_cvt_pk_f16_f32 v152, v132, v133
v_cvt_pk_f16_f32 v149, v134, v135
s_add_u32 m0, s67, 0
s_add_u32 s66, s66, 98304
buffer_load_dwordx4 v240, s[4:7], s66 offen lds
ds_read_b128 v[220:223], v248 offset:33792
v_mfma_f32_32x32x16_bf16 v[120:135], v[48:51], v[224:227], 0
v_pk_fma_f16 v154, v155, v155, s48
v_and_b32_e64 v179, s49, v179
v_fma_mix_f32 v156, v136, v136, v156 op_sel:[0,0,0] op_sel_hi:[1,1,0]
v_pk_fma_f16 v151, v152, v152, s48
v_pk_fma_f16 v148, v149, v149, s48
v_bfe_u32 v178, v179, 2, 14
v_pk_mul_f16 v154, v155, v154
v_pk_mul_f16 v151, v152, v151
v_fma_mix_f32 v156, v137, v137, v156 op_sel:[1,1,0] op_sel_hi:[1,1,0]
v_lshrrev_b32_e64 v179, 18, v179
s_add_u32 m0, s67, 6656
s_add_u32 s66, s66, 98304
buffer_load_dwordx4 v240, s[4:7], s66 offen lds
ds_read_b128 v[224:227], v248 offset:34816
ds_read_u16_d16 v178, v178
ds_read_u16_d16_hi v179, v179
v_mfma_f32_32x32x16_bf16 v[120:135], v[52:55], v[228:231], v[120:135]
v_pk_mul_f16 v148, v149, v148
v_exp_f16 v153, v154
v_exp_f16 v150, v151
v_and_b32_e64 v181, s49, v181
v_fma_mix_f32 v156, v138, v138, v156 op_sel:[0,0,0] op_sel_hi:[1,1,0]
v_exp_f16_e64 v147, v148
v_bfe_u32 v180, v181, 2, 14
s_add_u32 m0, s67, 13312
s_add_u32 s66, s66, 98304
buffer_load_dwordx4 v240, s[4:7], s66 offen lds
ds_read_b128 v[228:231], v248 offset:37888
ds_read_u16_d16 v180, v180
v_mfma_f32_32x32x16_bf16 v[120:135], v[56:59], v[232:235], v[120:135]
v_exp_f16_sdwa v153, v154 dst_sel:WORD_1 dst_unused:UNUSED_PRESERVE src0_sel:WORD_1
v_lshrrev_b32_e64 v181, 18, v181
v_fma_mix_f32 v156, v139, v139, v156 op_sel:[1,1,0] op_sel_hi:[1,1,0]
v_exp_f16_sdwa v150, v151 dst_sel:WORD_1 dst_unused:UNUSED_PRESERVE src0_sel:WORD_1
v_exp_f16_sdwa v147, v148 dst_sel:WORD_1 dst_unused:UNUSED_PRESERVE src0_sel:WORD_1
v_and_b32_e64 v183, s49, v183
v_fma_mix_f32 v156, v140, v140, v156 op_sel:[0,0,0] op_sel_hi:[1,1,0]
s_add_u32 m0, s67, 19968
s_add_u32 s66, s66, 98304
buffer_load_dwordx4 v240, s[4:7], s66 offen lds
s_add_u32 m0, s67, 26624
s_add_u32 s66, s66, 98304
buffer_load_dwordx4 v240, s[4:7], s66 offen lds
ds_read_b128 v[232:235], v248 offset:35840
ds_read_u16_d16_hi v181, v181
v_mfma_f32_32x32x16_bf16 v[120:135], v[60:63], v[236:239], v[120:135]
v_pk_add_f16 v153, v153, 1.0 op_sel_hi:[1,0]
v_bfe_u32 v182, v183, 2, 14
v_pk_add_f16 v150, v150, 1.0 op_sel_hi:[1,0]
v_pk_add_f16 v147, v147, 1.0 op_sel_hi:[1,0]
v_rcp_f16 v154, v153
v_lshrrev_b32 v183, 18, v183
v_fma_mix_f32 v156, v141, v141, v156 op_sel:[1,1,0] op_sel_hi:[1,1,0]
v_rcp_f16_e64 v151, v150
s_add_u32 m0, s67, 33280
s_add_u32 s66, s66, 98304
buffer_load_dwordx4 v240, s[4:7], s66 offen lds
ds_read_b128 v[236:239], v248 offset:38912
ds_read_u16_d16 v182, v182
ds_read_u16_d16_hi v183, v183
v_mfma_f32_32x32x16_bf16 v[120:135], v[64:67], v[216:219], v[120:135]
v_and_b32 v185, s49, v185
v_rcp_f16 v148, v147
v_fma_mix_f32 v156, v142, v142, v156 op_sel:[0,0,0] op_sel_hi:[1,1,0]
v_bfe_u32 v184, v185, 2, 14
v_rcp_f16_sdwa v154, v153 dst_sel:WORD_1 dst_unused:UNUSED_PRESERVE src0_sel:WORD_1
v_rcp_f16_sdwa v151, v150 dst_sel:WORD_1 dst_unused:UNUSED_PRESERVE src0_sel:WORD_1
v_lshrrev_b32 v185, 18, v185
s_waitcnt lgkmcnt(4)
s_add_u32 m0, s67, 39936
s_add_u32 s66, s66, 98304
buffer_load_dwordx4 v240, s[4:7], s66 offen lds
ds_read_b128 v[216:219], v248 offset:36864
ds_read_u16_d16 v184, v184
ds_read_u16_d16_hi v185, v185
v_mfma_f32_32x32x16_bf16 v[120:135], v[68:71], v[220:223], v[120:135]
v_fma_mix_f32 v156, v143, v143, v156 op_sel:[1,1,0] op_sel_hi:[1,1,0]
v_rcp_f16_sdwa v148, v147 dst_sel:WORD_1 dst_unused:UNUSED_PRESERVE src0_sel:WORD_1
v_and_b32_e64 v187, s49, v187
v_pk_mul_f16 v155, v155, v154
v_fma_mix_f32 v156, v176, v176, v156 op_sel:[0,0,0] op_sel_hi:[1,1,0]
v_pk_mul_f16 v152, v152, v151
v_bfe_u32 v186, v187, 2, 14
v_pk_mul_f16 v149, v149, v148
v_fma_mix_f32 v157, v155, v155, 0 op_sel:[0,0,0] op_sel_hi:[1,1,0]
s_add_u32 m0, s67, 46592
s_add_u32 s66, s66, 98304
buffer_load_dwordx4 v240, s[4:7], s66 offen lds
v_fma_mix_f32 v157, v155, v155, v157 op_sel:[1,1,0] op_sel_hi:[1,1,0]
v_lshrrev_b32 v187, 18, v187
v_fma_mix_f32 v156, v177, v177, v156 op_sel:[1,1,0] op_sel_hi:[1,1,0]
v_fma_mix_f32 v157, v152, v152, v157 op_sel:[0,0,0] op_sel_hi:[1,1,0]
v_fma_mix_f32 v157, v152, v152, v157 op_sel:[1,1,0] op_sel_hi:[1,1,0]
v_fma_mix_f32 v157, v149, v149, v157 op_sel:[0,0,0] op_sel_hi:[1,1,0]
v_fma_mix_f32 v157, v149, v149, v157 op_sel:[1,1,0] op_sel_hi:[1,1,0]
s_cmp_lt_u32 s40, 4
s_cbranch_scc0 Lsu5
s_waitcnt vmcnt(14)
s_call_b64 s[78:79], Lw1b
s_mov_b64 exec, 1
ds_add_u32 v253, v254 offset:24
s_mov_b64 exec, -1
Lsu5:
s_setprio 1
v_cvt_pkrtz_f16_f32 v137, v120, v121
v_cvt_pkrtz_f16_f32 v139, v122, v123
v_cvt_pkrtz_f16_f32 v141, v124, v125
v_cvt_pkrtz_f16_f32 v143, v126, v127
v_cvt_pkrtz_f16_f32 v177, v128, v129
v_cvt_pk_f16_f32 v155, v130, v131
v_cvt_pk_f16_f32 v152, v132, v133
v_cvt_pk_f16_f32 v149, v134, v135
ds_read_b128 v[220:223], v248 offset:39936
ds_read_u16_d16 v186, v186
ds_read_u16_d16_hi v187, v187
v_mfma_f32_32x32x16_bf16 v[120:135], v[48:51], v[224:227], 0
v_pk_fma_f16 v154, v155, v155, s48
v_and_b32_e64 v137, s49, v137
v_fma_mix_f32 v157, v178, v178, v157 op_sel:[0,0,0] op_sel_hi:[1,1,0]
v_pk_fma_f16 v151, v152, v152, s48
v_pk_fma_f16 v148, v149, v149, s48
v_bfe_u32 v136, v137, 2, 14
v_pk_mul_f16 v154, v155, v154
v_pk_mul_f16 v151, v152, v151
v_fma_mix_f32 v157, v179, v179, v157 op_sel:[1,1,0] op_sel_hi:[1,1,0]
v_lshrrev_b32_e64 v137, 18, v137
ds_read_u16_d16 v136, v136
ds_read_b32 v247, v253 offset:24
ds_read_u16_d16_hi v137, v137
v_mfma_f32_32x32x16_bf16 v[120:135], v[52:55], v[228:231], v[120:135]
v_pk_mul_f16 v148, v149, v148
v_exp_f16 v153, v154
v_exp_f16 v150, v151
v_and_b32_e64 v139, s49, v139
v_fma_mix_f32 v157, v180, v180, v157 op_sel:[0,0,0] op_sel_hi:[1,1,0]
v_exp_f16_e64 v147, v148
v_bfe_u32 v138, v139, 2, 14
ds_read_u16_d16 v138, v138
v_mfma_f32_32x32x16_bf16 v[120:135], v[56:59], v[232:235], v[120:135]
v_exp_f16_sdwa v153, v154 dst_sel:WORD_1 dst_unused:UNUSED_PRESERVE src0_sel:WORD_1
v_lshrrev_b32 v139, 18, v139
s_waitcnt lgkmcnt(4)
v_fma_mix_f32 v157, v181, v181, v157 op_sel:[1,1,0] op_sel_hi:[1,1,0]
v_exp_f16_sdwa v150, v151 dst_sel:WORD_1 dst_unused:UNUSED_PRESERVE src0_sel:WORD_1
v_exp_f16_sdwa v147, v148 dst_sel:WORD_1 dst_unused:UNUSED_PRESERVE src0_sel:WORD_1
v_and_b32 v141, s49, v141
v_fma_mix_f32 v157, v182, v182, v157 op_sel:[0,0,0] op_sel_hi:[1,1,0]
ds_read_u16_d16_hi v139, v139
s_waitcnt lgkmcnt(3)
v_readfirstlane_b32 s43, v247
s_nop 1
s_cmp_ge_u32 s43, 4
s_cbranch_scc1 Lev2
Lev2w:
s_sleep 1
ds_read_b32 v247, v253 offset:24
s_waitcnt lgkmcnt(0)
v_readfirstlane_b32 s43, v247
s_cmp_eq_u32 s76, 0
s_cbranch_scc1 Lev2
s_sub_u32 s76, s76, 1
s_cmp_lt_u32 s43, 4
s_cbranch_scc1 Lev2w
Lev2:
ds_read_b128 v[224:227], v248 offset:40960
ds_read_b128 v[228:231], v248 offset:44032
ds_read_b128 v[232:235], v248 offset:41984
v_mfma_f32_32x32x16_bf16 v[120:135], v[60:63], v[236:239], v[120:135]
v_pk_add_f16 v153, v153, 1.0 op_sel_hi:[1,0]
v_bfe_u32 v140, v141, 2, 14
v_pk_add_f16 v150, v150, 1.0 op_sel_hi:[1,0]
v_pk_add_f16 v147, v147, 1.0 op_sel_hi:[1,0]
v_rcp_f16 v154, v153
v_lshrrev_b32 v141, 18, v141
v_fma_mix_f32 v157, v183, v183, v157 op_sel:[1,1,0] op_sel_hi:[1,1,0]
v_rcp_f16_e64 v151, v150
ds_read_b128 v[236:239], v248 offset:45056
ds_read_u16_d16 v140, v140
ds_read_u16_d16_hi v141, v141
v_mfma_f32_32x32x16_bf16 v[120:135], v[64:67], v[216:219], v[120:135]
v_and_b32 v143, s49, v143
v_rcp_f16 v148, v147
v_fma_mix_f32 v157, v184, v184, v157 op_sel:[0,0,0] op_sel_hi:[1,1,0]
v_bfe_u32 v142, v143, 2, 14
v_rcp_f16_sdwa v154, v153 dst_sel:WORD_1 dst_unused:UNUSED_PRESERVE src0_sel:WORD_1
v_rcp_f16_sdwa v151, v150 dst_sel:WORD_1 dst_unused:UNUSED_PRESERVE src0_sel:WORD_1
v_lshrrev_b32_e64 v143, 18, v143
ds_read_b128 v[216:219], v248 offset:43008
ds_read_u16_d16 v142, v142
ds_read_u16_d16_hi v143, v143
v_mfma_f32_32x32x16_bf16 v[120:135], v[68:71], v[220:223], v[120:135]
v_fma_mix_f32 v157, v185, v185, v157 op_sel:[1,1,0] op_sel_hi:[1,1,0]
v_rcp_f16_sdwa v148, v147 dst_sel:WORD_1 dst_unused:UNUSED_PRESERVE src0_sel:WORD_1
v_and_b32_e64 v177, s49, v177
v_pk_mul_f16 v155, v155, v154
v_fma_mix_f32 v157, v186, v186, v157 op_sel:[0,0,0] op_sel_hi:[1,1,0]
v_pk_mul_f16 v152, v152, v151
v_bfe_u32 v176, v177, 2, 14
v_pk_mul_f16 v149, v149, v148
v_fma_mix_f32 v158, v155, v155, 0 op_sel:[0,0,0] op_sel_hi:[1,1,0]
v_fma_mix_f32 v158, v155, v155, v158 op_sel:[1,1,0] op_sel_hi:[1,1,0]
v_lshrrev_b32_e64 v177, 18, v177
v_fma_mix_f32 v157, v187, v187, v157 op_sel:[1,1,0] op_sel_hi:[1,1,0]
v_fma_mix_f32 v158, v152, v152, v158 op_sel:[0,0,0] op_sel_hi:[1,1,0]
v_fma_mix_f32 v158, v152, v152, v158 op_sel:[1,1,0] op_sel_hi:[1,1,0]
v_fma_mix_f32 v158, v149, v149, v158 op_sel:[0,0,0] op_sel_hi:[1,1,0]
v_fma_mix_f32 v158, v149, v149, v158 op_sel:[1,1,0] op_sel_hi:[1,1,0]
v_cvt_pkrtz_f16_f32 v179, v120, v121
v_cvt_pkrtz_f16_f32 v181, v122, v123
v_cvt_pkrtz_f16_f32 v183, v124, v125
v_cvt_pkrtz_f16_f32 v185, v126, v127
v_cvt_pkrtz_f16_f32 v187, v128, v129
v_cvt_pk_f16_f32 v155, v130, v131
v_cvt_pk_f16_f32 v152, v132, v133
v_cvt_pk_f16_f32 v149, v134, v135
s_waitcnt lgkmcnt(0)
ds_read_b128 v[220:223], v248 offset:46080
ds_read_u16_d16 v176, v176
ds_read_u16_d16_hi v177, v177
v_mfma_f32_32x32x16_bf16 v[120:135], v[48:51], v[224:227], 0
v_pk_fma_f16 v154, v155, v155, s48
v_and_b32 v179, s49, v179
v_fma_mix_f32 v158, v136, v136, v158 op_sel:[0,0,0] op_sel_hi:[1,1,0]
v_pk_fma_f16 v151, v152, v152, s48
v_pk_fma_f16 v148, v149, v149, s48
v_bfe_u32 v178, v179, 2, 14
v_pk_mul_f16 v154, v155, v154
v_pk_mul_f16 v151, v152, v151
v_fma_mix_f32 v158, v137, v137, v158 op_sel:[1,1,0] op_sel_hi:[1,1,0]
v_lshrrev_b32_e64 v179, 18, v179
ds_read_b128 v[224:227], v248 offset:47104
ds_read_u16_d16 v178, v178
ds_read_u16_d16_hi v179, v179
v_mfma_f32_32x32x16_bf16 v[120:135], v[52:55], v[228:231], v[120:135]
v_pk_mul_f16 v148, v149, v148
v_exp_f16 v153, v154
v_exp_f16 v150, v151
v_and_b32_e64 v181, s49, v181
v_fma_mix_f32 v158, v138, v138, v158 op_sel:[0,0,0] op_sel_hi:[1,1,0]
v_exp_f16_e64 v147, v148
v_bfe_u32 v180, v181, 2, 14
ds_read_b128 v[228:231], v248 offset:50176
ds_read_u16_d16 v180, v180
v_mfma_f32_32x32x16_bf16 v[120:135], v[56:59], v[232:235], v[120:135]
v_exp_f16_sdwa v153, v154 dst_sel:WORD_1 dst_unused:UNUSED_PRESERVE src0_sel:WORD_1
v_lshrrev_b32_e64 v181, 18, v181
v_fma_mix_f32 v158, v139, v139, v158 op_sel:[1,1,0] op_sel_hi:[1,1,0]
v_exp_f16_sdwa v150, v151 dst_sel:WORD_1 dst_unused:UNUSED_PRESERVE src0_sel:WORD_1
v_exp_f16_sdwa v147, v148 dst_sel:WORD_1 dst_unused:UNUSED_PRESERVE src0_sel:WORD_1
v_and_b32_e64 v183, s49, v183
v_fma_mix_f32 v158, v140, v140, v158 op_sel:[0,0,0] op_sel_hi:[1,1,0]
ds_read_b128 v[232:235], v248 offset:48128
ds_read_u16_d16_hi v181, v181
v_mfma_f32_32x32x16_bf16 v[120:135], v[60:63], v[236:239], v[120:135]
v_pk_add_f16 v153, v153, 1.0 op_sel_hi:[1,0]
v_bfe_u32 v182, v183, 2, 14
v_pk_add_f16 v150, v150, 1.0 op_sel_hi:[1,0]
v_pk_add_f16 v147, v147, 1.0 op_sel_hi:[1,0]
v_rcp_f16 v154, v153
v_lshrrev_b32 v183, 18, v183
v_fma_mix_f32 v158, v141, v141, v158 op_sel:[1,1,0] op_sel_hi:[1,1,0]
v_rcp_f16_e64 v151, v150
ds_read_b128 v[236:239], v248 offset:51200
ds_read_u16_d16 v182, v182
ds_read_u16_d16_hi v183, v183
v_mfma_f32_32x32x16_bf16 v[120:135], v[64:67], v[216:219], v[120:135]
v_and_b32 v185, s49, v185
v_rcp_f16 v148, v147
v_fma_mix_f32 v158, v142, v142, v158 op_sel:[0,0,0] op_sel_hi:[1,1,0]
v_bfe_u32 v184, v185, 2, 14
v_rcp_f16_sdwa v154, v153 dst_sel:WORD_1 dst_unused:UNUSED_PRESERVE src0_sel:WORD_1
v_rcp_f16_sdwa v151, v150 dst_sel:WORD_1 dst_unused:UNUSED_PRESERVE src0_sel:WORD_1
v_lshrrev_b32 v185, 18, v185
s_waitcnt lgkmcnt(5)
ds_read_b128 v[216:219], v248 offset:49152
ds_read_u16_d16 v184, v184
ds_read_u16_d16_hi v185, v185
v_mfma_f32_32x32x16_bf16 v[120:135], v[68:71], v[220:223], v[120:135]
v_fma_mix_f32 v158, v143, v143, v158 op_sel:[1,1,0] op_sel_hi:[1,1,0]
v_rcp_f16_sdwa v148, v147 dst_sel:WORD_1 dst_unused:UNUSED_PRESERVE src0_sel:WORD_1
s_cmp_eq_u32 s40, 7
s_cbranch_scc1 Lrdy8
s_waitcnt vmcnt(0)
Lrdy8:
s_mov_b64 exec, 1
ds_add_u32 v253, v254 offset:12
s_mov_b64 exec, -1
v_and_b32 v187, s49, v187
v_pk_mul_f16 v155, v155, v154
v_fma_mix_f32 v158, v176, v176, v158 op_sel:[0,0,0] op_sel_hi:[1,1,0]
v_pk_mul_f16 v152, v152, v151
v_bfe_u32 v186, v187, 2, 14
v_pk_mul_f16 v149, v149, v148
v_fma_mix_f32 v159, v155, v155, 0 op_sel:[0,0,0] op_sel_hi:[1,1,0]
v_fma_mix_f32 v159, v155, v155, v159 op_sel:[1,1,0] op_sel_hi:[1,1,0]
v_lshrrev_b32_e64 v187, 18, v187
v_fma_mix_f32 v158, v177, v177, v158 op_sel:[1,1,0] op_sel_hi:[1,1,0]
v_fma_mix_f32 v159, v152, v152, v159 op_sel:[0,0,0] op_sel_hi:[1,1,0]
v_fma_mix_f32 v159, v152, v152, v159 op_sel:[1,1,0] op_sel_hi:[1,1,0]
v_fma_mix_f32 v159, v149, v149, v159 op_sel:[0,0,0] op_sel_hi:[1,1,0]
v_fma_mix_f32 v159, v149, v149, v159 op_sel:[1,1,0] op_sel_hi:[1,1,0]
s_cmp_lt_u32 s40, 4
s_cbranch_scc0 Lsu6
s_waitcnt vmcnt(8)
s_call_b64 s[78:79], Lw1c
s_mov_b64 exec, 1
ds_add_u32 v253, v254 offset:28
s_mov_b64 exec, -1
Lsu6:
v_cvt_pkrtz_f16_f32 v137, v120, v121
v_cvt_pkrtz_f16_f32 v139, v122, v123
v_cvt_pkrtz_f16_f32 v141, v124, v125
v_cvt_pkrtz_f16_f32 v143, v126, v127
v_cvt_pkrtz_f16_f32 v177, v128, v129
v_cvt_pk_f16_f32 v155, v130, v131
v_cvt_pk_f16_f32 v152, v132, v133
v_cvt_pk_f16_f32 v149, v134, v135
s_setprio 0
ds_read_b128 v[220:223], v248 offset:52224
ds_read_u16_d16 v186, v186
ds_read_u16_d16_hi v187, v187
v_mfma_f32_32x32x16_bf16 v[120:135], v[48:51], v[224:227], 0
v_pk_fma_f16 v154, v155, v155, s48
v_and_b32 v137, s49, v137
v_fma_mix_f32 v159, v178, v178, v159 op_sel:[0,0,0] op_sel_hi:[1,1,0]
v_pk_fma_f16 v151, v152, v152, s48
v_pk_fma_f16 v148, v149, v149, s48
v_bfe_u32 v136, v137, 2, 14
v_pk_mul_f16 v154, v155, v154
v_pk_mul_f16 v151, v152, v151
v_fma_mix_f32 v159, v179, v179, v159 op_sel:[1,1,0] op_sel_hi:[1,1,0]
v_lshrrev_b32_e64 v137, 18, v137
ds_read_b128 v[224:227], v250 offset:65520
ds_read_u16_d16 v136, v136
ds_read_u16_d16_hi v137, v137
v_mfma_f32_32x32x16_bf16 v[120:135], v[52:55], v[228:231], v[120:135]
v_pk_mul_f16 v148, v149, v148
v_exp_f16 v153, v154
v_exp_f16 v150, v151
v_and_b32_e64 v139, s49, v139
v_fma_mix_f32 v159, v180, v180, v159 op_sel:[0,0,0] op_sel_hi:[1,1,0]
v_exp_f16 v147, v148
v_bfe_u32 v138, v139, 2, 14
s_waitcnt lgkmcnt(7)
ds_read_b128 v[228:231], v248 offset:53248
ds_read_b32 v247, v253 offset:12
ds_read_u16_d16 v138, v138
v_mfma_f32_32x32x16_bf16 v[120:135], v[56:59], v[232:235], v[120:135]
v_exp_f16_sdwa v153, v154 dst_sel:WORD_1 dst_unused:UNUSED_PRESERVE src0_sel:WORD_1
v_lshrrev_b32_e64 v139, 18, v139
v_fma_mix_f32 v159, v181, v181, v159 op_sel:[1,1,0] op_sel_hi:[1,1,0]
v_exp_f16_sdwa v150, v151 dst_sel:WORD_1 dst_unused:UNUSED_PRESERVE src0_sel:WORD_1
v_exp_f16_sdwa v147, v148 dst_sel:WORD_1 dst_unused:UNUSED_PRESERVE src0_sel:WORD_1
v_and_b32_e64 v141, s49, v141
v_fma_mix_f32 v159, v182, v182, v159 op_sel:[0,0,0] op_sel_hi:[1,1,0]
ds_read_b128 v[232:235], v248 offset:56320
ds_read_u16_d16_hi v139, v139
v_mfma_f32_32x32x16_bf16 v[120:135], v[60:63], v[236:239], v[120:135]
v_pk_add_f16 v153, v153, 1.0 op_sel_hi:[1,0]
v_bfe_u32 v140, v141, 2, 14
v_pk_add_f16 v150, v150, 1.0 op_sel_hi:[1,0]
v_pk_add_f16 v147, v147, 1.0 op_sel_hi:[1,0]
v_rcp_f16 v154, v153
v_lshrrev_b32 v141, 18, v141
ds_read_u16_d16 v140, v140
ds_read_u16_d16_hi v141, v141
s_waitcnt lgkmcnt(5)
v_readfirstlane_b32 s43, v247
s_nop 1
s_cmp_ge_u32 s43, 16
s_cbranch_scc1 Lev3
Lev3w:
s_sleep 1
ds_read_b32 v247, v253 offset:12
s_waitcnt lgkmcnt(0)
v_readfirstlane_b32 s43, v247
s_cmp_eq_u32 s76, 0
s_cbranch_scc1 Lev3
s_sub_u32 s76, s76, 1
s_cmp_lt_u32 s43, 16
s_cbranch_scc1 Lev3w
Lev3:
v_fma_mix_f32 v159, v183, v183, v159 op_sel:[1,1,0] op_sel_hi:[1,1,0]
v_rcp_f16 v151, v150
ds_read_b128 v[236:239], v245 offset:6528
ds_read_b128 v[192:195], v244 offset:128
ds_read_b128 v[196:199], v244 offset:64
v_mfma_f32_32x32x16_bf16 v[120:135], v[64:67], v[216:219], v[120:135]
v_and_b32 v143, s49, v143
v_rcp_f16 v148, v147
v_fma_mix_f32 v159, v184, v184, v159 op_sel:[0,0,0] op_sel_hi:[1,1,0]
v_bfe_u32 v142, v143, 2, 14
v_rcp_f16_sdwa v154, v153 dst_sel:WORD_1 dst_unused:UNUSED_PRESERVE src0_sel:WORD_1
v_rcp_f16_sdwa v151, v150 dst_sel:WORD_1 dst_unused:UNUSED_PRESERVE src0_sel:WORD_1
v_lshrrev_b32_e64 v143, 18, v143
ds_read_b128 v[216:219], v248 offset:54272
ds_read_u16_d16 v142, v142
ds_read_u16_d16_hi v143, v143
v_mfma_f32_32x32x16_bf16 v[120:135], v[68:71], v[220:223], v[120:135]
v_fma_mix_f32 v159, v185, v185, v159 op_sel:[1,1,0] op_sel_hi:[1,1,0]
v_rcp_f16_sdwa v148, v147 dst_sel:WORD_1 dst_unused:UNUSED_PRESERVE src0_sel:WORD_1
v_and_b32_e64 v177, s49, v177
v_pk_mul_f16 v155, v155, v154
v_fma_mix_f32 v159, v186, v186, v159 op_sel:[0,0,0] op_sel_hi:[1,1,0]
v_pk_mul_f16 v152, v152, v151
v_bfe_u32 v176, v177, 2, 14
v_pk_mul_f16 v149, v149, v148
v_fma_mix_f32 v160, v155, v155, 0 op_sel:[0,0,0] op_sel_hi:[1,1,0]
v_fma_mix_f32 v160, v155, v155, v160 op_sel:[1,1,0] op_sel_hi:[1,1,0]
v_lshrrev_b32 v177, 18, v177
v_fma_mix_f32 v159, v187, v187, v159 op_sel:[1,1,0] op_sel_hi:[1,1,0]
v_fma_mix_f32 v160, v152, v152, v160 op_sel:[0,0,0] op_sel_hi:[1,1,0]
v_fma_mix_f32 v160, v152, v152, v160 op_sel:[1,1,0] op_sel_hi:[1,1,0]
v_fma_mix_f32 v160, v149, v149, v160 op_sel:[0,0,0] op_sel_hi:[1,1,0]
v_fma_mix_f32 v160, v149, v149, v160 op_sel:[1,1,0] op_sel_hi:[1,1,0]
s_setprio 2
v_mfma_f32_32x32x16_bf16 v[0:15], v[224:227], v[224:227], 0
ds_read_b128 v[220:223], v245 offset:6144
ds_read_b128 v[200:203], v244
ds_read_b128 v[204:207], v243 offset:128
ds_read_u16_d16 v176, v176
ds_read_u16_d16_hi v177, v177
v_cvt_pkrtz_f16_f32 v179, v120, v121
v_cvt_pkrtz_f16_f32 v181, v122, v123
v_cvt_pkrtz_f16_f32 v183, v124, v125
v_mfma_f32_32x32x16_bf16 v[16:31], v[224:227], v[224:227], 0
v_cvt_pkrtz_f16_f32 v185, v126, v127
v_cvt_pkrtz_f16_f32 v187, v128, v129
v_cvt_pk_f16_f32 v155, v130, v131
v_mfma_f32_32x32x16_bf16 v[32:47], v[224:227], v[224:227], 0
v_cvt_pk_f16_f32 v152, v132, v133
v_cvt_pk_f16_f32 v149, v134, v135
v_pk_fma_f16 v154, v155, v155, s48
v_mfma_f32_32x32x16_bf16 v[120:135], v[48:51], v[228:231], 0
ds_read_b128 v[224:227], v248 offset:57344
v_and_b32 v179, s49, v179
v_fma_mix_f32 v160, v136, v136, v160 op_sel:[0,0,0] op_sel_hi:[1,1,0]
v_pk_fma_f16 v151, v152, v152, s48
v_pk_fma_f16 v148, v149, v149, s48
v_bfe_u32 v178, v179, 2, 14
v_pk_mul_f16 v154, v155, v154
s_waitcnt lgkmcnt(6)
v_mfma_f32_32x32x16_bf16 v[120:135], v[52:55], v[232:235], v[120:135]
ds_read_b128 v[228:231], v245 offset:5760
ds_read_b128 v[208:211], v243 offset:64
ds_read_b128 v[212:215], v243
ds_read_u16_d16 v178, v178
v_pk_mul_f16 v151, v152, v151
v_fma_mix_f32 v160, v137, v137, v160 op_sel:[1,1,0] op_sel_hi:[1,1,0]
v_lshrrev_b32_e64 v179, 18, v179
v_pk_mul_f16 v148, v149, v148
v_exp_f16_e64 v153, v154
v_smfmac_f32_16x16x32_bf16 v[40:43], v[238:239], v[192:195], v246
ds_read_b128 v[232:235], v248 offset:55296
ds_read_u16_d16_hi v179, v179
v_exp_f16 v150, v151
v_and_b32 v181, s49, v181
v_smfmac_f32_16x16x32_bf16 v[24:27], v[236:237], v[196:199], v246
v_fma_mix_f32 v160, v138, v138, v160 op_sel:[0,0,0] op_sel_hi:[1,1,0]
v_exp_f16_e64 v147, v148
v_mfma_f32_32x32x16_bf16 v[120:135], v[56:59], v[216:219], v[120:135]
ds_read_b128 v[236:239], v245 offset:5376
ds_read_b128 v[192:195], v242 offset:128
ds_read_b128 v[196:199], v242 offset:64
v_bfe_u32 v180, v181, 2, 14
v_exp_f16_sdwa v153, v154 dst_sel:WORD_1 dst_unused:UNUSED_PRESERVE src0_sel:WORD_1
v_lshrrev_b32 v181, 18, v181
v_fma_mix_f32 v160, v139, v139, v160 op_sel:[1,1,0] op_sel_hi:[1,1,0]
s_waitcnt lgkmcnt(8)
v_smfmac_f32_16x16x32_bf16 v[8:11], v[222:223], v[200:203], v246
ds_read_b128 v[216:219], v248 offset:58368
ds_read_u16_d16 v180, v180
ds_read_u16_d16_hi v181, v181
v_exp_f16_sdwa v150, v151 dst_sel:WORD_1 dst_unused:UNUSED_PRESERVE src0_sel:WORD_1
v_exp_f16_sdwa v147, v148 dst_sel:WORD_1 dst_unused:UNUSED_PRESERVE src0_sel:WORD_1
v_smfmac_f32_16x16x32_bf16 v[40:43], v[220:221], v[204:207], v246
v_and_b32_e64 v183, s49, v183
v_fma_mix_f32 v160, v140, v140, v160 op_sel:[0,0,0] op_sel_hi:[1,1,0]
v_pk_add_f16 v153, v153, 1.0 op_sel_hi:[1,0]
v_mfma_f32_32x32x16_bf16 v[120:135], v[60:63], v[224:227], v[120:135]
ds_read_b128 v[220:223], v245 offset:4992
ds_read_b128 v[200:203], v242
v_xor_b32_e64 v244, 16, v244
ds_read_b128 v[204:207], v244 offset:128
v_bfe_u32 v182, v183, 2, 14
v_pk_add_f16 v150, v150, 1.0 op_sel_hi:[1,0]
v_pk_add_f16 v147, v147, 1.0 op_sel_hi:[1,0]
v_rcp_f16_e64 v154, v153
v_lshrrev_b32 v183, 18, v183
s_waitcnt lgkmcnt(6)
v_smfmac_f32_16x16x32_bf16 v[24:27], v[230:231], v[208:211], v246
ds_read_b128 v[224:227], v245 offset:4608
ds_read_u16_d16 v182, v182
ds_read_u16_d16_hi v183, v183
v_fma_mix_f32 v160, v141, v141, v160 op_sel:[1,1,0] op_sel_hi:[1,1,0]
v_rcp_f16_e64 v151, v150
v_smfmac_f32_16x16x32_bf16 v[8:11], v[228:229], v[212:215], v246
v_and_b32 v185, s49, v185
v_rcp_f16 v148, v147
v_mfma_f32_32x32x16_bf16 v[120:135], v[64:67], v[232:235], v[120:135]
ds_read_b128 v[208:211], v244 offset:64
ds_read_b128 v[212:215], v244
ds_read_b128 v[228:231], v248 offset:59392
v_fma_mix_f32 v160, v142, v142, v160 op_sel:[0,0,0] op_sel_hi:[1,1,0]
v_bfe_u32 v184, v185, 2, 14
v_rcp_f16_sdwa v154, v153 dst_sel:WORD_1 dst_unused:UNUSED_PRESERVE src0_sel:WORD_1
v_rcp_f16_sdwa v151, v150 dst_sel:WORD_1 dst_unused:UNUSED_PRESERVE src0_sel:WORD_1
v_smfmac_f32_16x16x32_bf16 v[40:43], v[238:239], v[192:195], v246
ds_read_b128 v[232:235], v248 offset:62464
ds_read_u16_d16 v184, v184
ds_read_b32 v247, v253 offset:28
v_lshrrev_b32_e64 v185, 18, v185
v_fma_mix_f32 v160, v143, v143, v160 op_sel:[1,1,0] op_sel_hi:[1,1,0]
v_smfmac_f32_16x16x32_bf16 v[24:27], v[236:237], v[196:199], v246
v_rcp_f16_sdwa v148, v147 dst_sel:WORD_1 dst_unused:UNUSED_PRESERVE src0_sel:WORD_1
v_and_b32 v187, s49, v187
v_pk_mul_f16 v155, v155, v154
s_waitcnt lgkmcnt(7)
v_mfma_f32_32x32x16_bf16 v[120:135], v[68:71], v[216:219], v[120:135]
ds_read_b128 v[236:239], v248 offset:60416
ds_read_u16_d16_hi v185, v185
v_fma_mix_f32 v160, v176, v176, v160 op_sel:[0,0,0] op_sel_hi:[1,1,0]
v_pk_mul_f16 v152, v152, v151
v_bfe_u32 v186, v187, 2, 14
v_pk_mul_f16 v149, v149, v148
v_fma_mix_f32 v161, v155, v155, 0 op_sel:[0,0,0] op_sel_hi:[1,1,0]
v_fma_mix_f32 v161, v155, v155, v161 op_sel:[1,1,0] op_sel_hi:[1,1,0]
v_smfmac_f32_16x16x32_bf16 v[8:11], v[222:223], v[200:203], v246
ds_read_b128 v[216:219], v245 offset:4224
v_xor_b32_e64 v243, 16, v243
ds_read_b128 v[192:195], v243 offset:128
ds_read_b128 v[196:199], v243 offset:64
ds_read_u16_d16 v186, v186
v_lshrrev_b32_e64 v187, 18, v187
v_fma_mix_f32 v160, v177, v177, v160 op_sel:[1,1,0] op_sel_hi:[1,1,0]
v_fma_mix_f32 v161, v152, v152, v161 op_sel:[0,0,0] op_sel_hi:[1,1,0]
v_smfmac_f32_16x16x32_bf16 v[44:47], v[220:221], v[204:207], v246
v_fma_mix_f32 v161, v152, v152, v161 op_sel:[1,1,0] op_sel_hi:[1,1,0]
v_fma_mix_f32 v161, v149, v149, v161 op_sel:[0,0,0] op_sel_hi:[1,1,0]
v_fma_mix_f32 v161, v149, v149, v161 op_sel:[1,1,0] op_sel_hi:[1,1,0]
s_cmp_lg_u32 s40, 7
s_cbranch_scc1 Lnosent
v_mov_b32 v104, -1
v_mov_b32 v105, -1
v_mov_b32 v106, -1
v_mov_b32 v107, -1
v_lshlrev_b32_e64 v100, 12, v251
v_add_u32 v101, 262144, v100
v_cmp_gt_u32 vcc, 32, v251
v_mov_b32 v102, 2147483648
s_nop 0
v_cndmask_b32 v101, v102, v101, vcc
s_lshl_b32 s43, s2, 4
buffer_store_dwordx4 v[104:107], v100, s[32:35], s43 offen sc1
buffer_store_dwordx4 v[104:107], v101, s[32:35], s43 offen sc1
s_add_u32 s43, s43, 393216
s_cmp_lt_u32 s2, 96
s_cselect_b32 s43, s43, 1073741824
v_lshlrev_b32_e64 v102, 11, v251
s_mov_b64 exec, 0xff
buffer_store_dwordx4 v[104:107], v102, s[32:35], s43 offen sc1
s_mov_b64 exec, -1
s_sub_u32 s43, s2, 96
s_cmp_lt_u32 s43, 96
s_cbranch_scc0 Lnobias
s_lshl_b32 s44, s43, 1
v_mul_u32_u24 v100, 192, v251
v_lshlrev_b32 v101, 1, v251
s_add_u32 s45, s44, 0
buffer_load_ushort v102, v100, s[16:19], s45 offen
buffer_load_ushort v108, v101, s[28:31], 0 offen offset:0
s_add_u32 s45, s44, 12288
buffer_load_ushort v103, v100, s[16:19], s45 offen
buffer_load_ushort v109, v101, s[28:31], 0 offen offset:128
s_add_u32 s45, s44, 24576
buffer_load_ushort v104, v100, s[16:19], s45 offen
buffer_load_ushort v110, v101, s[28:31], 0 offen offset:256
s_add_u32 s45, s44, 36864
buffer_load_ushort v105, v100, s[16:19], s45 offen
buffer_load_ushort v111, v101, s[28:31], 0 offen offset:384
s_add_u32 s45, s44, 49152
buffer_load_ushort v106, v100, s[16:19], s45 offen
buffer_load_ushort v112, v101, s[28:31], 0 offen offset:512
s_add_u32 s45, s44, 61440
buffer_load_ushort v107, v100, s[16:19], s45 offen
buffer_load_ushort v113, v101, s[28:31], 0 offen offset:640
Lnobias:
s_nop 1
Lnosent:
ds_read_u16_d16_hi v187, v187
s_waitcnt lgkmcnt(1)
v_readfirstlane_b32 s43, v247
s_nop 1
s_cmp_ge_u32 s43, 12
s_cbranch_scc1 Lev4
Lev4w:
s_sleep 1
ds_read_b32 v247, v253 offset:28
s_waitcnt lgkmcnt(0)
v_readfirstlane_b32 s43, v247
s_cmp_eq_u32 s76, 0
s_cbranch_scc1 Lev4
s_sub_u32 s76, s76, 1
s_cmp_lt_u32 s43, 12
s_cbranch_scc1 Lev4w
Lev4:
s_setprio 1
v_smfmac_f32_16x16x32_bf16 v[28:31], v[226:227], v[208:211], v246
ds_read_b128 v[220:223], v248 offset:63488
v_cvt_pkrtz_f16_f32 v137, v120, v121
v_cvt_pkrtz_f16_f32 v139, v122, v123
v_cvt_pkrtz_f16_f32 v141, v124, v125
v_cvt_pkrtz_f16_f32 v143, v126, v127
v_smfmac_f32_16x16x32_bf16 v[12:15], v[224:225], v[212:215], v246
v_cvt_pk_f16_f32 v155, v128, v129
v_cvt_pk_f16_f32 v152, v130, v131
v_cvt_pk_f16_f32 v149, v132, v133
v_cvt_pk_f16_f32 v146, v134, v135
v_mfma_f32_32x32x16_bf16 v[120:135], v[48:51], v[228:231], 0
ds_read_b128 v[224:227], v248 offset:61440
v_pk_fma_f16 v154, v155, v155, s48
v_and_b32 v137, s49, v137
v_fma_mix_f32 v161, v178, v178, v161 op_sel:[0,0,0] op_sel_hi:[1,1,0]
v_pk_fma_f16 v151, v152, v152, s48
v_pk_fma_f16 v148, v149, v149, s48
v_pk_fma_f16 v145, v146, v146, s48
v_pk_mul_f16 v154, v155, v154
v_bfe_u32 v136, v137, 2, 14
v_pk_mul_f16 v151, v152, v151
v_mfma_f32_32x32x16_bf16 v[120:135], v[52:55], v[232:235], v[120:135]
ds_read_b128 v[228:231], v245 offset:3840
ds_read_b128 v[200:203], v243
v_xor_b32_e64 v242, 16, v242
ds_read_b128 v[204:207], v242 offset:128
ds_read_u16_d16 v136, v136
v_fma_mix_f32 v161, v179, v179, v161 op_sel:[1,1,0] op_sel_hi:[1,1,0]
v_pk_mul_f16 v148, v149, v148
v_pk_mul_f16 v145, v146, v145
v_exp_f16 v153, v154
v_lshrrev_b32 v137, 18, v137
v_exp_f16_e64 v150, v151
v_mfma_f32_32x32x16_bf16 v[120:135], v[56:59], v[236:239], v[120:135]
ds_read_b128 v[232:235], v248 offset:64512
ds_read_u16_d16_hi v137, v137
v_fma_mix_f32 v161, v180, v180, v161 op_sel:[0,0,0] op_sel_hi:[1,1,0]
v_exp_f16 v147, v148
v_and_b32 v139, s49, v139
v_exp_f16_e64 v144, v145
v_exp_f16_sdwa v153, v154 dst_sel:WORD_1 dst_unused:UNUSED_PRESERVE src0_sel:WORD_1
v_fma_mix_f32 v161, v181, v181, v161 op_sel:[1,1,0] op_sel_hi:[1,1,0]
v_smfmac_f32_16x16x32_bf16 v[44:47], v[218:219], v[192:195], v246
ds_read_b128 v[236:239], v245 offset:3456
ds_read_b128 v[208:211], v242 offset:64
ds_read_b128 v[212:215], v242
v_bfe_u32 v138, v139, 2, 14
v_exp_f16_sdwa v150, v151 dst_sel:WORD_1 dst_unused:UNUSED_PRESERVE src0_sel:WORD_1
v_smfmac_f32_16x16x32_bf16 v[28:31], v[216:217], v[196:199], v246
v_exp_f16_sdwa v147, v148 dst_sel:WORD_1 dst_unused:UNUSED_PRESERVE src0_sel:WORD_1
v_exp_f16_sdwa v144, v145 dst_sel:WORD_1 dst_unused:UNUSED_PRESERVE src0_sel:WORD_1
v_lshrrev_b32 v139, 18, v139
s_waitcnt lgkmcnt(5)
v_mfma_f32_32x32x16_bf16 v[120:135], v[60:63], v[220:223], v[120:135]
ds_read_b128 v[216:219], v245 offset:3072
v_xor_b32_e64 v244, 32, v244
ds_read_b128 v[192:195], v244 offset:128
ds_read_b128 v[196:199], v244 offset:64
ds_read_u16_d16 v138, v138
ds_read_u16_d16_hi v139, v139
v_fma_mix_f32 v161, v182, v182, v161 op_sel:[0,0,0] op_sel_hi:[1,1,0]
v_pk_add_f16 v153, v153, 1.0 op_sel_hi:[1,0]
v_pk_add_f16 v150, v150, 1.0 op_sel_hi:[1,0]
v_pk_add_f16 v147, v147, 1.0 op_sel_hi:[1,0]
v_and_b32_e64 v141, s49, v141
v_pk_add_f16 v144, v144, 1.0 op_sel_hi:[1,0]
v_rcp_f16_e64 v154, v153
v_fma_mix_f32 v161, v183, v183, v161 op_sel:[1,1,0] op_sel_hi:[1,1,0]
v_mfma_f32_32x32x16_bf16 v[120:135], v[64:67], v[224:227], v[120:135]
ds_read_b128 v[220:223], v249
v_rcp_f16_e64 v151, v150
v_bfe_u32 v140, v141, 2, 14
v_rcp_f16_e64 v148, v147
v_fma_mix_f32 v161, v184, v184, v161 op_sel:[0,0,0] op_sel_hi:[1,1,0]
v_rcp_f16 v145, v144
v_lshrrev_b32 v141, 18, v141
v_smfmac_f32_16x16x32_bf16 v[12:15], v[230:231], v[200:203], v246
ds_read_b128 v[224:227], v249 offset:3072
ds_read_u16_d16 v140, v140
ds_read_u16_d16_hi v141, v141
v_rcp_f16_sdwa v154, v153 dst_sel:WORD_1 dst_unused:UNUSED_PRESERVE src0_sel:WORD_1
s_setprio 0
v_rcp_f16_sdwa v151, v150 dst_sel:WORD_1 dst_unused:UNUSED_PRESERVE src0_sel:WORD_1
v_smfmac_f32_16x16x32_bf16 v[44:47], v[228:229], v[204:207], v246
v_fma_mix_f32 v161, v185, v185, v161 op_sel:[1,1,0] op_sel_hi:[1,1,0]
v_and_b32_e64 v143, s49, v143
v_rcp_f16_sdwa v148, v147 dst_sel:WORD_1 dst_unused:UNUSED_PRESERVE src0_sel:WORD_1
s_waitcnt lgkmcnt(4)
v_mfma_f32_32x32x16_bf16 v[120:135], v[68:71], v[232:235], v[120:135]
ds_read_b128 v[228:231], v245 offset:2688
ds_read_b128 v[200:203], v244
v_xor_b32_e64 v243, 32, v243
ds_read_b128 v[204:207], v243 offset:128
v_rcp_f16_sdwa v145, v144 dst_sel:WORD_1 dst_unused:UNUSED_PRESERVE src0_sel:WORD_1
v_pk_mul_f16 v155, v155, v154
v_bfe_u32 v142, v143, 2, 14
v_fma_mix_f32 v161, v186, v186, v161 op_sel:[0,0,0] op_sel_hi:[1,1,0]
v_pk_mul_f16 v152, v152, v151
v_pk_mul_f16 v149, v149, v148
v_pk_mul_f16 v146, v146, v145
v_fma_mix_f32 v162, v155, v155, 0 op_sel:[0,0,0] op_sel_hi:[1,1,0]
v_smfmac_f32_16x16x32_bf16 v[28:31], v[238:239], v[208:211], v246
ds_read_b128 v[232:235], v249 offset:1024
ds_read_u16_d16 v142, v142
v_lshrrev_b32_e64 v143, 18, v143
v_fma_mix_f32 v162, v155, v155, v162 op_sel:[1,1,0] op_sel_hi:[1,1,0]
v_fma_mix_f32 v162, v152, v152, v162 op_sel:[0,0,0] op_sel_hi:[1,1,0]
v_fma_mix_f32 v161, v187, v187, v161 op_sel:[1,1,0] op_sel_hi:[1,1,0]
v_smfmac_f32_16x16x32_bf16 v[12:15], v[236:237], v[212:215], v246
v_fma_mix_f32 v162, v152, v152, v162 op_sel:[1,1,0] op_sel_hi:[1,1,0]
v_fma_mix_f32 v162, v149, v149, v162 op_sel:[0,0,0] op_sel_hi:[1,1,0]
v_fma_mix_f32 v162, v149, v149, v162 op_sel:[1,1,0] op_sel_hi:[1,1,0]
v_fma_mix_f32 v162, v146, v146, v162 op_sel:[0,0,0] op_sel_hi:[1,1,0]
v_fma_mix_f32 v162, v146, v146, v162 op_sel:[1,1,0] op_sel_hi:[1,1,0]
v_lshlrev_b32_e64 v252, 7, v251
s_add_u32 s46, s47, 1572864
s_mov_b32 exec_lo, 131071
s_mov_b32 exec_hi, 0
s_mov_b32 m0, 16288
s_nop 0
buffer_load_dword v252, s[4:7], s46 offen lds
s_mov_b64 exec, -1
s_setprio 2
v_smfmac_f32_16x16x32_bf16 v[36:39], v[218:219], v[192:195], v246
ds_read_b128 v[236:239], v249 offset:4096
ds_read_u16_d16_hi v143, v143
v_cvt_pkrtz_f16_f32 v179, v120, v121
v_cvt_pkrtz_f16_f32 v181, v122, v123
v_cvt_pkrtz_f16_f32 v183, v124, v125
v_smfmac_f32_16x16x32_bf16 v[20:23], v[216:217], v[196:199], v246
v_cvt_pkrtz_f16_f32 v185, v126, v127
v_cvt_pkrtz_f16_f32 v187, v128, v129
v_cvt_pk_f16_f32 v155, v130, v131
v_cvt_pk_f16_f32 v152, v132, v133
v_cvt_pk_f16_f32 v149, v134, v135
s_waitcnt lgkmcnt(2)
v_mfma_f32_32x32x16_bf16 v[120:135], v[48:51], v[220:223], 0
ds_read_b128 v[216:219], v245 offset:2304
ds_read_b128 v[208:211], v243 offset:64
ds_read_b128 v[212:215], v243
v_pk_fma_f16 v154, v155, v155, s48
v_and_b32 v179, s49, v179
v_fma_mix_f32 v162, v136, v136, v162 op_sel:[0,0,0] op_sel_hi:[1,1,0]
v_pk_fma_f16 v151, v152, v152, s48
v_pk_fma_f16 v148, v149, v149, s48
v_mfma_f32_32x32x16_bf16 v[120:135], v[52:55], v[224:227], v[120:135]
ds_read_b128 v[220:223], v249 offset:2048
v_bfe_u32 v178, v179, 2, 14
v_pk_mul_f16 v154, v155, v154
v_pk_mul_f16 v151, v152, v151
v_pk_mul_f16 v148, v149, v148
v_lshrrev_b32_e64 v179, 18, v179
v_fma_mix_f32 v162, v137, v137, v162 op_sel:[1,1,0] op_sel_hi:[1,1,0]
v_smfmac_f32_16x16x32_bf16 v[4:7], v[230:231], v[200:203], v246
ds_read_b128 v[224:227], v245 offset:1920
v_xor_b32_e64 v242, 32, v242
ds_read_b128 v[192:195], v242 offset:128
ds_read_b128 v[196:199], v242 offset:64
ds_read_u16_d16 v178, v178
ds_read_u16_d16_hi v179, v179
v_exp_f16 v153, v154
v_and_b32 v181, s49, v181
v_smfmac_f32_16x16x32_bf16 v[36:39], v[228:229], v[204:207], v246
v_exp_f16 v150, v151
v_exp_f16 v147, v148
v_mfma_f32_32x32x16_bf16 v[120:135], v[56:59], v[232:235], v[120:135]
ds_read_b128 v[228:231], v249 offset:5120
v_bfe_u32 v180, v181, 2, 14
v_fma_mix_f32 v162, v138, v138, v162 op_sel:[0,0,0] op_sel_hi:[1,1,0]
v_exp_f16_sdwa v153, v154 dst_sel:WORD_1 dst_unused:UNUSED_PRESERVE src0_sel:WORD_1
v_lshrrev_b32 v181, 18, v181
v_exp_f16_sdwa v150, v151 dst_sel:WORD_1 dst_unused:UNUSED_PRESERVE src0_sel:WORD_1
s_waitcnt lgkmcnt(6)
v_mfma_f32_32x32x16_bf16 v[120:135], v[60:63], v[236:239], v[120:135]
ds_read_b128 v[232:235], v245 offset:1536
ds_read_b128 v[200:203], v242
v_xor_b32_e64 v244, 16, v244
ds_read_b128 v[204:207], v244 offset:128
ds_read_u16_d16 v180, v180
ds_read_u16_d16_hi v181, v181
v_fma_mix_f32 v162, v139, v139, v162 op_sel:[1,1,0] op_sel_hi:[1,1,0]
v_and_b32_e64 v183, s49, v183
v_exp_f16_sdwa v147, v148 dst_sel:WORD_1 dst_unused:UNUSED_PRESERVE src0_sel:WORD_1
v_pk_add_f16 v153, v153, 1.0 op_sel_hi:[1,0]
v_bfe_u32 v182, v183, 2, 14
v_smfmac_f32_16x16x32_bf16 v[20:23], v[218:219], v[208:211], v246
ds_read_b128 v[236:239], v245 offset:1152
ds_read_u16_d16 v182, v182
v_pk_add_f16 v150, v150, 1.0 op_sel_hi:[1,0]
v_pk_add_f16 v147, v147, 1.0 op_sel_hi:[1,0]
v_rcp_f16_e64 v154, v153
v_smfmac_f32_16x16x32_bf16 v[4:7], v[216:217], v[212:215], v246
v_lshrrev_b32_e64 v183, 18, v183
v_fma_mix_f32 v162, v140, v140, v162 op_sel:[0,0,0] op_sel_hi:[1,1,0]
v_mfma_f32_32x32x16_bf16 v[120:135], v[64:67], v[220:223], v[120:135]
ds_read_b128 v[208:211], v244 offset:64
ds_read_b128 v[212:215], v244
ds_read_b128 v[216:219], v249 offset:6144
ds_read_u16_d16_hi v183, v183
v_rcp_f16 v151, v150
v_and_b32 v185, s49, v185
v_rcp_f16 v148, v147
v_fma_mix_f32 v162, v141, v141, v162 op_sel:[1,1,0] op_sel_hi:[1,1,0]
v_bfe_u32 v184, v185, 2, 14
s_waitcnt lgkmcnt(6)
v_smfmac_f32_16x16x32_bf16 v[36:39], v[226:227], v[192:195], v246
ds_read_b128 v[220:223], v249 offset:9216
ds_read_u16_d16 v184, v184
v_rcp_f16_sdwa v154, v153 dst_sel:WORD_1 dst_unused:UNUSED_PRESERVE src0_sel:WORD_1
v_rcp_f16_sdwa v151, v150 dst_sel:WORD_1 dst_unused:UNUSED_PRESERVE src0_sel:WORD_1
v_smfmac_f32_16x16x32_bf16 v[20:23], v[224:225], v[196:199], v246
v_lshrrev_b32_e64 v185, 18, v185
v_rcp_f16_sdwa v148, v147 dst_sel:WORD_1 dst_unused:UNUSED_PRESERVE src0_sel:WORD_1
v_mfma_f32_32x32x16_bf16 v[120:135], v[68:71], v[228:231], v[120:135]
ds_read_b128 v[224:227], v249 offset:7168
ds_read_u16_d16_hi v185, v185
v_and_b32_e64 v187, s49, v187
v_fma_mix_f32 v162, v142, v142, v162 op_sel:[0,0,0] op_sel_hi:[1,1,0]
v_pk_mul_f16 v155, v155, v154
v_pk_mul_f16 v152, v152, v151
v_bfe_u32 v186, v187, 2, 14
v_pk_mul_f16 v149, v149, v148
v_fma_mix_f32 v163, v155, v155, 0 op_sel:[0,0,0] op_sel_hi:[1,1,0]
v_smfmac_f32_16x16x32_bf16 v[4:7], v[234:235], v[200:203], v246
ds_read_b128 v[228:231], v245 offset:768
v_xor_b32_e64 v243, 16, v243
ds_read_b128 v[192:195], v243 offset:128
ds_read_b128 v[196:199], v243 offset:64
ds_read_u16_d16 v186, v186
v_fma_mix_f32 v162, v143, v143, v162 op_sel:[1,1,0] op_sel_hi:[1,1,0]
v_lshrrev_b32_e64 v187, 18, v187
v_fma_mix_f32 v163, v155, v155, v163 op_sel:[1,1,0] op_sel_hi:[1,1,0]
v_smfmac_f32_16x16x32_bf16 v[32:35], v[232:233], v[204:207], v246
v_fma_mix_f32 v163, v152, v152, v163 op_sel:[0,0,0] op_sel_hi:[1,1,0]
v_fma_mix_f32 v163, v152, v152, v163 op_sel:[1,1,0] op_sel_hi:[1,1,0]
v_fma_mix_f32 v163, v149, v149, v163 op_sel:[0,0,0] op_sel_hi:[1,1,0]
v_fma_mix_f32 v163, v149, v149, v163 op_sel:[1,1,0] op_sel_hi:[1,1,0]
v_lshlrev_b32 v252, 7, v251
s_add_u32 s46, s47, 1572864
s_mov_b32 exec_lo, 4294836224
s_mov_b32 exec_hi, 3
s_mov_b32 m0, 16220
s_nop 0
buffer_load_dword v252, s[4:7], s46 offen lds
s_mov_b64 exec, -1
s_setprio 1
s_waitcnt lgkmcnt(4)
v_smfmac_f32_16x16x32_bf16 v[16:19], v[238:239], v[208:211], v246
ds_read_b128 v[232:235], v249 offset:10240
ds_read_u16_d16_hi v187, v187
v_cvt_pkrtz_f16_f32 v137, v120, v121
v_cvt_pkrtz_f16_f32 v139, v122, v123
v_cvt_pkrtz_f16_f32 v141, v124, v125
v_smfmac_f32_16x16x32_bf16 v[0:3], v[236:237], v[212:215], v246
v_cvt_pkrtz_f16_f32 v143, v126, v127
v_cvt_pk_f16_f32 v155, v128, v129
v_cvt_pk_f16_f32 v152, v130, v131
v_cvt_pk_f16_f32 v149, v132, v133
v_cvt_pk_f16_f32 v146, v134, v135
v_mfma_f32_32x32x16_bf16 v[120:135], v[48:51], v[216:219], 0
ds_read_b128 v[236:239], v249 offset:8192
v_pk_fma_f16 v154, v155, v155, s48
v_and_b32_e64 v137, s49, v137
v_fma_mix_f32 v163, v178, v178, v163 op_sel:[0,0,0] op_sel_hi:[1,1,0]
v_pk_fma_f16 v151, v152, v152, s48
v_pk_fma_f16 v148, v149, v149, s48
v_pk_fma_f16 v145, v146, v146, s48
v_pk_mul_f16 v154, v155, v154
v_mfma_f32_32x32x16_bf16 v[120:135], v[52:55], v[220:223], v[120:135]
ds_read_b128 v[216:219], v245 offset:384
ds_read_b128 v[200:203], v243
v_xor_b32_e64 v242, 16, v242
ds_read_b128 v[204:207], v242 offset:128
v_bfe_u32 v136, v137, 2, 14
v_pk_mul_f16 v151, v152, v151
v_fma_mix_f32 v163, v179, v179, v163 op_sel:[1,1,0] op_sel_hi:[1,1,0]
v_pk_mul_f16 v148, v149, v148
v_pk_mul_f16 v145, v146, v145
v_exp_f16 v153, v154
v_lshrrev_b32 v137, 18, v137
v_mfma_f32_32x32x16_bf16 v[120:135], v[56:59], v[224:227], v[120:135]
ds_read_b128 v[220:223], v249 offset:11264
ds_read_u16_d16 v136, v136
ds_read_u16_d16_hi v137, v137
v_exp_f16_e64 v150, v151
v_fma_mix_f32 v163, v180, v180, v163 op_sel:[0,0,0] op_sel_hi:[1,1,0]
v_exp_f16 v147, v148
v_and_b32 v139, s49, v139
v_exp_f16 v144, v145
s_waitcnt lgkmcnt(6)
v_smfmac_f32_16x16x32_bf16 v[32:35], v[230:231], v[192:195], v246
ds_read_b128 v[224:227], v245
ds_read_b128 v[208:211], v242 offset:64
ds_read_b128 v[212:215], v242
v_exp_f16_sdwa v153, v154 dst_sel:WORD_1 dst_unused:UNUSED_PRESERVE src0_sel:WORD_1
v_fma_mix_f32 v163, v181, v181, v163 op_sel:[1,1,0] op_sel_hi:[1,1,0]
v_bfe_u32 v138, v139, 2, 14
v_smfmac_f32_16x16x32_bf16 v[16:19], v[228:229], v[196:199], v246
v_exp_f16_sdwa v150, v151 dst_sel:WORD_1 dst_unused:UNUSED_PRESERVE src0_sel:WORD_1
v_mfma_f32_32x32x16_bf16 v[120:135], v[60:63], v[232:235], v[120:135]
ds_read_b128 v[228:231], v249 offset:12288
ds_read_u16_d16 v138, v138
v_exp_f16_sdwa v147, v148 dst_sel:WORD_1 dst_unused:UNUSED_PRESERVE src0_sel:WORD_1
v_exp_f16_sdwa v144, v145 dst_sel:WORD_1 dst_unused:UNUSED_PRESERVE src0_sel:WORD_1
v_lshrrev_b32_e64 v139, 18, v139
v_fma_mix_f32 v163, v182, v182, v163 op_sel:[0,0,0] op_sel_hi:[1,1,0]
v_pk_add_f16 v153, v153, 1.0 op_sel_hi:[1,0]
v_pk_add_f16 v150, v150, 1.0 op_sel_hi:[1,0]
v_pk_add_f16 v147, v147, 1.0 op_sel_hi:[1,0]
v_mfma_f32_32x32x16_bf16 v[120:135], v[64:67], v[236:239], v[120:135]
ds_read_b128 v[232:235], v249 offset:15360
ds_read_u16_d16_hi v139, v139
v_and_b32_e64 v141, s49, v141
v_pk_add_f16 v144, v144, 1.0 op_sel_hi:[1,0]
v_rcp_f16_e64 v154, v153
v_fma_mix_f32 v163, v183, v183, v163 op_sel:[1,1,0] op_sel_hi:[1,1,0]
v_rcp_f16 v151, v150
v_bfe_u32 v140, v141, 2, 14
s_waitcnt lgkmcnt(4)
v_smfmac_f32_16x16x32_bf16 v[0:3], v[218:219], v[200:203], v246
ds_read_b128 v[236:239], v249 offset:13312
ds_read_u16_d16 v140, v140
v_rcp_f16_e64 v148, v147
v_fma_mix_f32 v163, v184, v184, v163 op_sel:[0,0,0] op_sel_hi:[1,1,0]
v_smfmac_f32_16x16x32_bf16 v[32:35], v[216:217], v[204:207], v246
v_rcp_f16_e64 v145, v144
v_lshrrev_b32 v141, 18, v141
v_rcp_f16_sdwa v154, v153 dst_sel:WORD_1 dst_unused:UNUSED_PRESERVE src0_sel:WORD_1
s_setprio 0
v_mfma_f32_32x32x16_bf16 v[120:135], v[68:71], v[220:223], v[120:135]
ds_read_b128 v[216:219], v249 offset:16384
ds_read_u16_d16_hi v141, v141
v_rcp_f16_sdwa v151, v150 dst_sel:WORD_1 dst_unused:UNUSED_PRESERVE src0_sel:WORD_1
v_fma_mix_f32 v163, v185, v185, v163 op_sel:[1,1,0] op_sel_hi:[1,1,0]
v_and_b32_e64 v143, s49, v143
v_rcp_f16_sdwa v148, v147 dst_sel:WORD_1 dst_unused:UNUSED_PRESERVE src0_sel:WORD_1
v_rcp_f16_sdwa v145, v144 dst_sel:WORD_1 dst_unused:UNUSED_PRESERVE src0_sel:WORD_1
v_smfmac_f32_16x16x32_bf16 v[16:19], v[226:227], v[208:211], v246
ds_read_b128 v[220:223], v249 offset:14336
v_pk_mul_f16 v155, v155, v154
v_bfe_u32 v142, v143, 2, 14
v_fma_mix_f32 v163, v186, v186, v163 op_sel:[0,0,0] op_sel_hi:[1,1,0]
v_pk_mul_f16 v152, v152, v151
v_smfmac_f32_16x16x32_bf16 v[0:3], v[224:225], v[212:215], v246
s_mov_b64 exec, 1
ds_add_u32 v253, v254 offset:16
s_mov_b64 exec, -1
v_pk_mul_f16 v149, v149, v148
v_pk_mul_f16 v146, v146, v145
v_fma_mix_f32 v164, v155, v155, 0 op_sel:[0,0,0] op_sel_hi:[1,1,0]
v_lshrrev_b32 v143, 18, v143
v_fma_mix_f32 v164, v155, v155, v164 op_sel:[1,1,0] op_sel_hi:[1,1,0]
v_fma_mix_f32 v164, v152, v152, v164 op_sel:[0,0,0] op_sel_hi:[1,1,0]
v_fma_mix_f32 v163, v187, v187, v163 op_sel:[1,1,0] op_sel_hi:[1,1,0]
v_fma_mix_f32 v164, v152, v152, v164 op_sel:[1,1,0] op_sel_hi:[1,1,0]
v_fma_mix_f32 v164, v149, v149, v164 op_sel:[0,0,0] op_sel_hi:[1,1,0]
v_fma_mix_f32 v164, v149, v149, v164 op_sel:[1,1,0] op_sel_hi:[1,1,0]
v_fma_mix_f32 v164, v146, v146, v164 op_sel:[0,0,0] op_sel_hi:[1,1,0]
v_fma_mix_f32 v164, v146, v146, v164 op_sel:[1,1,0] op_sel_hi:[1,1,0]
s_setprio 3
v_pk_add_f32 v[168:169], v[0:1], v[2:3]
v_pk_mul_f32 v[170:171], v[0:1], v[0:1]
v_pk_fma_f32 v[170:171], v[2:3], v[2:3], v[170:171]
v_pk_add_f32 v[168:169], v[168:169], v[4:5]
v_pk_fma_f32 v[170:171], v[4:5], v[4:5], v[170:171]
v_pk_add_f32 v[168:169], v[168:169], v[6:7]
v_pk_fma_f32 v[170:171], v[6:7], v[6:7], v[170:171]
v_pk_add_f32 v[168:169], v[168:169], v[8:9]
v_pk_fma_f32 v[170:171], v[8:9], v[8:9], v[170:171]
v_pk_add_f32 v[168:169], v[168:169], v[10:11]
v_pk_fma_f32 v[170:171], v[10:11], v[10:11], v[170:171]
v_pk_add_f32 v[168:169], v[168:169], v[12:13]
v_pk_fma_f32 v[170:171], v[12:13], v[12:13], v[170:171]
v_pk_add_f32 v[168:169], v[168:169], v[14:15]
v_pk_fma_f32 v[170:171], v[14:15], v[14:15], v[170:171]
v_pk_add_f32 v[168:169], v[168:169], v[16:17]
v_pk_fma_f32 v[170:171], v[16:17], v[16:17], v[170:171]
v_pk_add_f32 v[168:169], v[168:169], v[18:19]
v_pk_fma_f32 v[170:171], v[18:19], v[18:19], v[170:171]
v_pk_add_f32 v[168:169], v[168:169], v[20:21]
v_pk_fma_f32 v[170:171], v[20:21], v[20:21], v[170:171]
v_pk_add_f32 v[168:169], v[168:169], v[22:23]
v_pk_fma_f32 v[170:171], v[22:23], v[22:23], v[170:171]
v_pk_add_f32 v[168:169], v[168:169], v[24:25]
v_pk_fma_f32 v[170:171], v[24:25], v[24:25], v[170:171]
v_pk_add_f32 v[168:169], v[168:169], v[26:27]
v_pk_fma_f32 v[170:171], v[26:27], v[26:27], v[170:171]
v_pk_add_f32 v[168:169], v[168:169], v[28:29]
v_pk_fma_f32 v[170:171], v[28:29], v[28:29], v[170:171]
v_pk_add_f32 v[168:169], v[168:169], v[30:31]
v_pk_fma_f32 v[170:171], v[30:31], v[30:31], v[170:171]
v_pk_add_f32 v[168:169], v[168:169], v[32:33]
v_pk_fma_f32 v[170:171], v[32:33], v[32:33], v[170:171]
v_pk_add_f32 v[168:169], v[168:169], v[34:35]
v_pk_fma_f32 v[170:171], v[34:35], v[34:35], v[170:171]
v_pk_add_f32 v[168:169], v[168:169], v[36:37]
v_pk_fma_f32 v[170:171], v[36:37], v[36:37], v[170:171]
v_pk_add_f32 v[168:169], v[168:169], v[38:39]
v_pk_fma_f32 v[170:171], v[38:39], v[38:39], v[170:171]
v_pk_add_f32 v[168:169], v[168:169], v[40:41]
v_pk_fma_f32 v[170:171], v[40:41], v[40:41], v[170:171]
v_pk_add_f32 v[168:169], v[168:169], v[42:43]
v_pk_fma_f32 v[170:171], v[42:43], v[42:43], v[170:171]
v_pk_add_f32 v[168:169], v[168:169], v[44:45]
v_pk_fma_f32 v[170:171], v[44:45], v[44:45], v[170:171]
v_pk_add_f32 v[168:169], v[168:169], v[46:47]
v_pk_fma_f32 v[170:171], v[46:47], v[46:47], v[170:171]
s_setprio 0
v_add_u32 v174, -36864, v242
v_subrev_u32 v175, 66560, v174
v_min_u32 v174, v174, v175
v_add_u32 v174, 90112, v174
v_sub_u32 v175, v174, v242
v_add_u32 v242, v175, v242
v_add_u32 v243, v175, v243
v_add_u32 v244, v175, v244
v_lshlrev_b32_e64 v252, 7, v251
s_add_u32 s46, s47, 1572864
s_mov_b32 exec_lo, 0
s_mov_b32 exec_hi, 1048572
s_mov_b32 m0, 16152
s_nop 0
buffer_load_dword v252, s[4:7], s46 offen lds
s_mov_b64 exec, -1
s_setprio 2
v_cvt_pkrtz_f16_f32 v179, v120, v121
v_cvt_pkrtz_f16_f32 v181, v122, v123
v_cvt_pkrtz_f16_f32 v183, v124, v125
v_cvt_pkrtz_f16_f32 v185, v126, v127
v_cvt_pkrtz_f16_f32 v187, v128, v129
v_cvt_pkrtz_f16_f32 v189, v130, v131
v_cvt_pk_f16_f32 v155, v132, v133
v_cvt_pk_f16_f32 v152, v134, v135
s_waitcnt lgkmcnt(1)
ds_read_b128 v[224:227], v249 offset:17408
ds_read_u16_d16 v142, v142
ds_read_u16_d16_hi v143, v143
v_mfma_f32_32x32x16_bf16 v[120:135], v[48:51], v[228:231], 0
v_pk_fma_f16 v154, v155, v155, s48
v_add_f32 v168, v168, v169
v_and_b32_e64 v179, s49, v179
v_fma_mix_f32 v164, v136, v136, v164 op_sel:[0,0,0] op_sel_hi:[1,1,0]
v_bfe_u32 v178, v179, 2, 14
v_add_f32_e64 v170, v170, v171
v_pk_fma_f16 v151, v152, v152, s48
v_pk_mul_f16 v154, v155, v154
v_lshrrev_b32_e64 v179, 18, v179
v_pk_mul_f16 v151, v152, v151
ds_read_b128 v[228:231], v249 offset:18432
ds_read_u16_d16 v178, v178
ds_read_u16_d16_hi v179, v179
v_mfma_f32_32x32x16_bf16 v[120:135], v[52:55], v[232:235], v[120:135]
v_permlane32_swap_b32 v168, v170
v_fma_mix_f32 v164, v137, v137, v164 op_sel:[1,1,0] op_sel_hi:[1,1,0]
v_and_b32 v181, s49, v181
v_exp_f16 v153, v154
v_add_f32 v168, v168, v170
v_bfe_u32 v180, v181, 2, 14
v_exp_f16 v150, v151
v_lshrrev_b32 v181, 18, v181
ds_read_b128 v[232:235], v249 offset:21504
ds_read_u16_d16 v180, v180
ds_read_u16_d16_hi v181, v181
v_mfma_f32_32x32x16_bf16 v[120:135], v[56:59], v[236:239], v[120:135]
v_mul_f32 v168, 1009429163, v168
v_fma_mix_f32 v164, v138, v138, v164 op_sel:[0,0,0] op_sel_hi:[1,1,0]
v_exp_f16_sdwa v153, v154 dst_sel:WORD_1 dst_unused:UNUSED_PRESERVE src0_sel:WORD_1
v_and_b32 v183, s49, v183
v_mov_b32 v170, v168
v_exp_f16_sdwa v150, v151 dst_sel:WORD_1 dst_unused:UNUSED_PRESERVE src0_sel:WORD_1
v_bfe_u32 v182, v183, 2, 14
v_fma_mix_f32 v164, v139, v139, v164 op_sel:[1,1,0] op_sel_hi:[1,1,0]
v_permlane32_swap_b32 v168, v170
ds_read_b128 v[236:239], v249 offset:19456
ds_read_u16_d16 v182, v182
v_mfma_f32_32x32x16_bf16 v[120:135], v[60:63], v[216:219], v[120:135]
v_lshrrev_b32 v183, 18, v183
v_pk_add_f16 v153, v153, 1.0 op_sel_hi:[1,0]
v_pk_add_f16 v150, v150, 1.0 op_sel_hi:[1,0]
v_and_b32_e64 v185, s49, v185
v_fma_f32 v170, -v168, v168, v170
v_rcp_f16_e64 v154, v153
v_bfe_u32 v184, v185, 2, 14
v_max_f32_e64 v170, 0, v170
v_fma_mix_f32 v164, v140, v140, v164 op_sel:[0,0,0] op_sel_hi:[1,1,0]
ds_read_b128 v[216:219], v249 offset:22528
ds_read_u16_d16_hi v183, v183
ds_read_u16_d16 v184, v184
v_mfma_f32_32x32x16_bf16 v[120:135], v[64:67], v[220:223], v[120:135]
v_lshrrev_b32 v185, 18, v185
v_rcp_f16 v151, v150
v_add_f32 v170, 925353388, v170
v_and_b32_e64 v187, s49, v187
v_fma_mix_f32 v164, v141, v141, v164 op_sel:[1,1,0] op_sel_hi:[1,1,0]
v_rcp_f16_sdwa v154, v153 dst_sel:WORD_1 dst_unused:UNUSED_PRESERVE src0_sel:WORD_1
v_rsq_f32 v170, v170
s_waitcnt lgkmcnt(5)
ds_read_b128 v[220:223], v249 offset:20480
ds_read_u16_d16_hi v185, v185
ds_read_b32 v247, v253 offset:16
v_mfma_f32_32x32x16_bf16 v[120:135], v[68:71], v[224:227], v[120:135]
v_bfe_u32 v186, v187, 2, 14
v_rcp_f16_sdwa v151, v150 dst_sel:WORD_1 dst_unused:UNUSED_PRESERVE src0_sel:WORD_1
v_lshrrev_b32_e64 v187, 18, v187
v_fma_mix_f32 v164, v142, v142, v164 op_sel:[0,0,0] op_sel_hi:[1,1,0]
v_and_b32_e64 v189, s49, v189
v_pk_mul_f16 v155, v155, v154
v_pk_mul_f16 v152, v152, v151
v_mul_f32 v172, 3203391086, v170
v_bfe_u32 v188, v189, 2, 14
v_fma_mix_f32 v165, v155, v155, 0 op_sel:[0,0,0] op_sel_hi:[1,1,0]
v_fma_mix_f32 v164, v143, v143, v164 op_sel:[1,1,0] op_sel_hi:[1,1,0]
v_lshrrev_b32_e64 v189, 18, v189
v_mul_f32 v173, v168, v172
v_fma_mix_f32 v165, v155, v155, v165 op_sel:[1,1,0] op_sel_hi:[1,1,0]
v_fma_mix_f32 v165, v152, v152, v165 op_sel:[0,0,0] op_sel_hi:[1,1,0]
v_fma_mix_f32 v165, v152, v152, v165 op_sel:[1,1,0] op_sel_hi:[1,1,0]
s_setprio 3
v_pk_fma_f32 v[0:1], v[0:1], v[172:173], v[172:173] op_sel:[0,0,1] op_sel_hi:[1,0,1] neg_lo:[0,0,1] neg_hi:[0,0,1]
v_pk_fma_f32 v[2:3], v[2:3], v[172:173], v[172:173] op_sel:[0,0,1] op_sel_hi:[1,0,1] neg_lo:[0,0,1] neg_hi:[0,0,1]
v_pk_fma_f32 v[4:5], v[4:5], v[172:173], v[172:173] op_sel:[0,0,1] op_sel_hi:[1,0,1] neg_lo:[0,0,1] neg_hi:[0,0,1]
v_pk_fma_f32 v[6:7], v[6:7], v[172:173], v[172:173] op_sel:[0,0,1] op_sel_hi:[1,0,1] neg_lo:[0,0,1] neg_hi:[0,0,1]
v_pk_fma_f32 v[8:9], v[8:9], v[172:173], v[172:173] op_sel:[0,0,1] op_sel_hi:[1,0,1] neg_lo:[0,0,1] neg_hi:[0,0,1]
v_pk_fma_f32 v[10:11], v[10:11], v[172:173], v[172:173] op_sel:[0,0,1] op_sel_hi:[1,0,1] neg_lo:[0,0,1] neg_hi:[0,0,1]
v_pk_fma_f32 v[12:13], v[12:13], v[172:173], v[172:173] op_sel:[0,0,1] op_sel_hi:[1,0,1] neg_lo:[0,0,1] neg_hi:[0,0,1]
v_pk_fma_f32 v[14:15], v[14:15], v[172:173], v[172:173] op_sel:[0,0,1] op_sel_hi:[1,0,1] neg_lo:[0,0,1] neg_hi:[0,0,1]
v_pk_fma_f32 v[16:17], v[16:17], v[172:173], v[172:173] op_sel:[0,0,1] op_sel_hi:[1,0,1] neg_lo:[0,0,1] neg_hi:[0,0,1]
v_pk_fma_f32 v[18:19], v[18:19], v[172:173], v[172:173] op_sel:[0,0,1] op_sel_hi:[1,0,1] neg_lo:[0,0,1] neg_hi:[0,0,1]
v_pk_fma_f32 v[20:21], v[20:21], v[172:173], v[172:173] op_sel:[0,0,1] op_sel_hi:[1,0,1] neg_lo:[0,0,1] neg_hi:[0,0,1]
v_pk_fma_f32 v[22:23], v[22:23], v[172:173], v[172:173] op_sel:[0,0,1] op_sel_hi:[1,0,1] neg_lo:[0,0,1] neg_hi:[0,0,1]
v_pk_fma_f32 v[24:25], v[24:25], v[172:173], v[172:173] op_sel:[0,0,1] op_sel_hi:[1,0,1] neg_lo:[0,0,1] neg_hi:[0,0,1]
v_pk_fma_f32 v[26:27], v[26:27], v[172:173], v[172:173] op_sel:[0,0,1] op_sel_hi:[1,0,1] neg_lo:[0,0,1] neg_hi:[0,0,1]
v_pk_fma_f32 v[28:29], v[28:29], v[172:173], v[172:173] op_sel:[0,0,1] op_sel_hi:[1,0,1] neg_lo:[0,0,1] neg_hi:[0,0,1]
v_pk_fma_f32 v[30:31], v[30:31], v[172:173], v[172:173] op_sel:[0,0,1] op_sel_hi:[1,0,1] neg_lo:[0,0,1] neg_hi:[0,0,1]
v_pk_fma_f32 v[32:33], v[32:33], v[172:173], v[172:173] op_sel:[0,0,1] op_sel_hi:[1,0,1] neg_lo:[0,0,1] neg_hi:[0,0,1]
v_pk_fma_f32 v[34:35], v[34:35], v[172:173], v[172:173] op_sel:[0,0,1] op_sel_hi:[1,0,1] neg_lo:[0,0,1] neg_hi:[0,0,1]
v_pk_fma_f32 v[36:37], v[36:37], v[172:173], v[172:173] op_sel:[0,0,1] op_sel_hi:[1,0,1] neg_lo:[0,0,1] neg_hi:[0,0,1]
v_pk_fma_f32 v[38:39], v[38:39], v[172:173], v[172:173] op_sel:[0,0,1] op_sel_hi:[1,0,1] neg_lo:[0,0,1] neg_hi:[0,0,1]
v_pk_fma_f32 v[40:41], v[40:41], v[172:173], v[172:173] op_sel:[0,0,1] op_sel_hi:[1,0,1] neg_lo:[0,0,1] neg_hi:[0,0,1]
v_pk_fma_f32 v[42:43], v[42:43], v[172:173], v[172:173] op_sel:[0,0,1] op_sel_hi:[1,0,1] neg_lo:[0,0,1] neg_hi:[0,0,1]
v_pk_fma_f32 v[44:45], v[44:45], v[172:173], v[172:173] op_sel:[0,0,1] op_sel_hi:[1,0,1] neg_lo:[0,0,1] neg_hi:[0,0,1]
v_pk_fma_f32 v[46:47], v[46:47], v[172:173], v[172:173] op_sel:[0,0,1] op_sel_hi:[1,0,1] neg_lo:[0,0,1] neg_hi:[0,0,1]
s_setprio 2
ds_read_u16_d16 v186, v186
ds_read_u16_d16_hi v187, v187
ds_read_u16_d16 v188, v188
ds_read_u16_d16_hi v189, v189
s_waitcnt lgkmcnt(4)
v_readfirstlane_b32 s43, v247
s_nop 1
s_cmp_ge_u32 s43, 16
s_cbranch_scc1 Lev5
Lev5w:
s_sleep 1
ds_read_b32 v247, v253 offset:16
s_waitcnt lgkmcnt(0)
v_readfirstlane_b32 s43, v247
s_cmp_eq_u32 s76, 0
s_cbranch_scc1 Lev5
s_sub_u32 s76, s76, 1
s_cmp_lt_u32 s43, 16
s_cbranch_scc1 Lev5w
Lev5:
s_setprio 1
v_cvt_pkrtz_f16_f32 v137, v120, v121
v_cvt_pkrtz_f16_f32 v139, v122, v123
v_cvt_pkrtz_f16_f32 v141, v124, v125
v_cvt_pkrtz_f16_f32 v143, v126, v127
v_cvt_pkrtz_f16_f32 v177, v128, v129
v_cvt_pkrtz_f16_f32 v191, v130, v131
v_cvt_pk_f16_f32 v155, v132, v133
v_cvt_pk_f16_f32 v152, v134, v135
s_add_u32 m0, s67, 53248
s_add_u32 s66, s66, 98304
buffer_load_dwordx4 v240, s[4:7], s66 offen lds
ds_read_b128 v[224:227], v249 offset:23552
v_mfma_f32_32x32x16_bf16 v[120:135], v[48:51], v[228:231], 0
v_pk_fma_f16 v154, v155, v155, s48
v_cvt_pk_bf16_f32 v72, v0, v1
v_and_b32 v137, s49, v137
v_fma_mix_f32 v165, v178, v178, v165 op_sel:[0,0,0] op_sel_hi:[1,1,0]
v_cvt_pk_bf16_f32 v73, v2, v3
v_pk_fma_f16 v151, v152, v152, s48
v_bfe_u32 v136, v137, 2, 14
v_cvt_pk_bf16_f32 v74, v4, v5
v_pk_mul_f16 v154, v155, v154
v_fma_mix_f32 v165, v179, v179, v165 op_sel:[1,1,0] op_sel_hi:[1,1,0]
v_lshrrev_b32_e64 v137, 18, v137
v_cvt_pk_bf16_f32 v75, v6, v7
s_add_u32 m0, s67, 59904
s_add_u32 s66, s66, 98304
buffer_load_dwordx4 v240, s[4:7], s66 offen lds
ds_read_b128 v[228:231], v248 offset:16384
ds_read_u16_d16 v136, v136
ds_read_u16_d16_hi v137, v137
v_mfma_f32_32x32x16_bf16 v[120:135], v[52:55], v[232:235], v[120:135]
v_pk_mul_f16 v151, v152, v151
v_exp_f16_e64 v153, v154
v_cvt_pk_bf16_f32 v76, v8, v9
v_and_b32_e64 v139, s49, v139
v_fma_mix_f32 v165, v180, v180, v165 op_sel:[0,0,0] op_sel_hi:[1,1,0]
v_cvt_pk_bf16_f32 v77, v10, v11
v_bfe_u32 v138, v139, 2, 14
v_exp_f16_e64 v150, v151
v_cvt_pk_bf16_f32 v78, v12, v13
v_lshrrev_b32 v139, 18, v139
v_cvt_pk_bf16_f32 v79, v14, v15
s_add_u32 m0, s67, 0
s_add_u32 s66, s66, 98304
buffer_load_dwordx4 v240, s[4:7], s66 offen lds
ds_read_b128 v[232:235], v248 offset:19456
ds_read_u16_d16 v138, v138
ds_read_u16_d16_hi v139, v139
v_mfma_f32_32x32x16_bf16 v[120:135], v[56:59], v[236:239], v[120:135]
v_fma_mix_f32 v165, v181, v181, v165 op_sel:[1,1,0] op_sel_hi:[1,1,0]
v_exp_f16_sdwa v153, v154 dst_sel:WORD_1 dst_unused:UNUSED_PRESERVE src0_sel:WORD_1
v_cvt_pk_bf16_f32 v80, v16, v17
v_and_b32_e64 v141, s49, v141
v_fma_mix_f32 v165, v182, v182, v165 op_sel:[0,0,0] op_sel_hi:[1,1,0]
v_cvt_pk_bf16_f32 v81, v18, v19
v_bfe_u32 v140, v141, 2, 14
v_exp_f16_sdwa v150, v151 dst_sel:WORD_1 dst_unused:UNUSED_PRESERVE src0_sel:WORD_1
v_cvt_pk_bf16_f32 v82, v20, v21
v_lshrrev_b32_e64 v141, 18, v141
s_add_u32 m0, s67, 6656
s_add_u32 s66, s66, 98304
buffer_load_dwordx4 v240, s[4:7], s66 offen lds
s_add_u32 m0, s67, 13312
s_add_u32 s66, s66, 98304
buffer_load_dwordx4 v240, s[4:7], s66 offen lds
ds_read_b128 v[236:239], v248 offset:17408
ds_read_u16_d16 v140, v140
ds_read_u16_d16_hi v141, v141
v_mfma_f32_32x32x16_bf16 v[120:135], v[60:63], v[216:219], v[120:135]
v_fma_mix_f32 v165, v183, v183, v165 op_sel:[1,1,0] op_sel_hi:[1,1,0]
v_cvt_pk_bf16_f32 v83, v22, v23
v_pk_add_f16 v153, v153, 1.0 op_sel_hi:[1,0]
v_pk_add_f16 v150, v150, 1.0 op_sel_hi:[1,0]
v_and_b32_e64 v143, s49, v143
v_cvt_pk_bf16_f32 v84, v24, v25
v_rcp_f16_e64 v154, v153
v_cvt_pk_bf16_f32 v85, v26, v27
v_bfe_u32 v142, v143, 2, 14
v_fma_mix_f32 v165, v184, v184, v165 op_sel:[0,0,0] op_sel_hi:[1,1,0]
v_cvt_pk_bf16_f32 v86, v28, v29
s_add_u32 m0, s67, 19968
s_add_u32 s66, s66, 98304
buffer_load_dwordx4 v240, s[4:7], s66 offen lds
ds_read_b128 v[216:219], v248 offset:20480
ds_read_u16_d16 v142, v142
v_mfma_f32_32x32x16_bf16 v[120:135], v[64:67], v[220:223], v[120:135]
v_rcp_f16 v151, v150
v_lshrrev_b32 v143, 18, v143
v_cvt_pk_bf16_f32 v87, v30, v31
v_fma_mix_f32 v165, v185, v185, v165 op_sel:[1,1,0] op_sel_hi:[1,1,0]
v_and_b32_e64 v177, s49, v177
s_setprio 0
v_cvt_pk_bf16_f32 v88, v32, v33
v_rcp_f16_sdwa v154, v153 dst_sel:WORD_1 dst_unused:UNUSED_PRESERVE src0_sel:WORD_1
v_bfe_u32 v176, v177, 2, 14
v_cvt_pk_bf16_f32 v89, v34, v35
s_waitcnt lgkmcnt(2)
v_fma_mix_f32 v165, v186, v186, v165 op_sel:[0,0,0] op_sel_hi:[1,1,0]
v_rcp_f16_sdwa v151, v150 dst_sel:WORD_1 dst_unused:UNUSED_PRESERVE src0_sel:WORD_1
s_add_u32 m0, s67, 26624
s_add_u32 s66, s66, 98304
buffer_load_dwordx4 v240, s[4:7], s66 offen lds
ds_read_b128 v[220:223], v248 offset:18432
ds_read_u16_d16_hi v143, v143
ds_read_u16_d16 v176, v176
v_mfma_f32_32x32x16_bf16 v[120:135], v[68:71], v[224:227], v[120:135]
v_cvt_pk_bf16_f32 v90, v36, v37
v_lshrrev_b32_e64 v177, 18, v177
v_cvt_pk_bf16_f32 v91, v38, v39
v_fma_mix_f32 v165, v187, v187, v165 op_sel:[1,1,0] op_sel_hi:[1,1,0]
v_and_b32_e64 v191, s49, v191
v_pk_mul_f16 v155, v155, v154
v_cvt_pk_bf16_f32 v92, v40, v41
v_pk_mul_f16 v152, v152, v151
v_bfe_u32 v190, v191, 2, 14
v_cvt_pk_bf16_f32 v93, v42, v43
v_fma_mix_f32 v165, v188, v188, v165 op_sel:[0,0,0] op_sel_hi:[1,1,0]
v_fma_mix_f32 v166, v155, v155, 0 op_sel:[0,0,0] op_sel_hi:[1,1,0]
s_add_u32 m0, s67, 33280
s_add_u32 s66, s66, 98304
buffer_load_dwordx4 v240, s[4:7], s66 offen lds
v_lshrrev_b32 v191, 18, v191
v_cvt_pk_bf16_f32 v94, v44, v45
v_fma_mix_f32 v166, v155, v155, v166 op_sel:[1,1,0] op_sel_hi:[1,1,0]
v_fma_mix_f32 v165, v189, v189, v165 op_sel:[1,1,0] op_sel_hi:[1,1,0]
v_cvt_pk_bf16_f32 v95, v46, v47
v_fma_mix_f32 v166, v152, v152, v166 op_sel:[0,0,0] op_sel_hi:[1,1,0]
v_fma_mix_f32 v166, v152, v152, v166 op_sel:[1,1,0] op_sel_hi:[1,1,0]
s_setprio 2
v_cvt_pkrtz_f16_f32 v179, v120, v121
v_cvt_pkrtz_f16_f32 v181, v122, v123
v_cvt_pkrtz_f16_f32 v183, v124, v125
v_cvt_pkrtz_f16_f32 v185, v126, v127
v_cvt_pkrtz_f16_f32 v187, v128, v129
v_cvt_pk_f16_f32 v155, v130, v131
v_cvt_pk_f16_f32 v152, v132, v133
v_cvt_pk_f16_f32 v149, v134, v135
ds_read_b128 v[224:227], v248 offset:21504
ds_read_u16_d16_hi v177, v177
ds_read_u16_d16 v190, v190
ds_read_u16_d16_hi v191, v191
v_mfma_f32_32x32x16_bf16 v[120:135], v[72:75], v[228:231], 0
v_pk_fma_f16 v154, v155, v155, s48
v_and_b32_e64 v179, s49, v179
v_fma_mix_f32 v166, v136, v136, v166 op_sel:[0,0,0] op_sel_hi:[1,1,0]
v_pk_fma_f16 v151, v152, v152, s48
v_pk_fma_f16 v148, v149, v149, s48
v_bfe_u32 v178, v179, 2, 14
v_pk_mul_f16 v154, v155, v154
v_fma_mix_f32 v166, v137, v137, v166 op_sel:[1,1,0] op_sel_hi:[1,1,0]
v_pk_mul_f16 v151, v152, v151
v_lshrrev_b32_e64 v179, 18, v179
ds_read_b128 v[228:231], v248 offset:22528
ds_read_u16_d16 v178, v178
ds_read_u16_d16_hi v179, v179
v_mfma_f32_32x32x16_bf16 v[120:135], v[76:79], v[232:235], v[120:135]
v_pk_mul_f16 v148, v149, v148
v_exp_f16_e64 v153, v154
v_fma_mix_f32 v166, v138, v138, v166 op_sel:[0,0,0] op_sel_hi:[1,1,0]
v_and_b32 v181, s49, v181
v_exp_f16 v150, v151
v_exp_f16_e64 v147, v148
v_bfe_u32 v180, v181, 2, 14
v_fma_mix_f32 v166, v139, v139, v166 op_sel:[1,1,0] op_sel_hi:[1,1,0]
ds_read_b128 v[232:235], v248 offset:25600
ds_read_u16_d16 v180, v180
v_mfma_f32_32x32x16_bf16 v[120:135], v[80:83], v[236:239], v[120:135]
v_exp_f16_sdwa v153, v154 dst_sel:WORD_1 dst_unused:UNUSED_PRESERVE src0_sel:WORD_1
v_lshrrev_b32_e64 v181, 18, v181
v_exp_f16_sdwa v150, v151 dst_sel:WORD_1 dst_unused:UNUSED_PRESERVE src0_sel:WORD_1
v_fma_mix_f32 v166, v140, v140, v166 op_sel:[0,0,0] op_sel_hi:[1,1,0]
v_and_b32 v183, s49, v183
v_exp_f16_sdwa v147, v148 dst_sel:WORD_1 dst_unused:UNUSED_PRESERVE src0_sel:WORD_1
v_fma_mix_f32 v166, v141, v141, v166 op_sel:[1,1,0] op_sel_hi:[1,1,0]
s_waitcnt lgkmcnt(5)
ds_read_b128 v[236:239], v248 offset:23552
ds_read_u16_d16_hi v181, v181
v_mfma_f32_32x32x16_bf16 v[120:135], v[84:87], v[216:219], v[120:135]
v_pk_add_f16 v153, v153, 1.0 op_sel_hi:[1,0]
v_bfe_u32 v182, v183, 2, 14
v_pk_add_f16 v150, v150, 1.0 op_sel_hi:[1,0]
v_pk_add_f16 v147, v147, 1.0 op_sel_hi:[1,0]
v_rcp_f16 v154, v153
v_lshrrev_b32 v183, 18, v183
v_fma_mix_f32 v166, v142, v142, v166 op_sel:[0,0,0] op_sel_hi:[1,1,0]
v_rcp_f16 v151, v150
v_and_b32 v185, s49, v185
ds_read_b128 v[216:219], v248 offset:26624
ds_read_u16_d16 v182, v182
ds_read_u16_d16_hi v183, v183
v_mfma_f32_32x32x16_bf16 v[120:135], v[88:91], v[220:223], v[120:135]
v_fma_mix_f32 v166, v143, v143, v166 op_sel:[1,1,0] op_sel_hi:[1,1,0]
v_rcp_f16_e64 v148, v147
v_bfe_u32 v184, v185, 2, 14
v_rcp_f16_sdwa v154, v153 dst_sel:WORD_1 dst_unused:UNUSED_PRESERVE src0_sel:WORD_1
v_fma_mix_f32 v166, v176, v176, v166 op_sel:[0,0,0] op_sel_hi:[1,1,0]
v_rcp_f16_sdwa v151, v150 dst_sel:WORD_1 dst_unused:UNUSED_PRESERVE src0_sel:WORD_1
v_lshrrev_b32_e64 v185, 18, v185
ds_read_b128 v[220:223], v248 offset:24576
ds_read_u16_d16 v184, v184
ds_read_u16_d16_hi v185, v185
v_mfma_f32_32x32x16_bf16 v[120:135], v[92:95], v[224:227], v[120:135]
v_rcp_f16_sdwa v148, v147 dst_sel:WORD_1 dst_unused:UNUSED_PRESERVE src0_sel:WORD_1
s_cmp_eq_u32 s40, 7
s_cbranch_scc1 Lrdy16
s_waitcnt vmcnt(0)
Lrdy16:
s_mov_b64 exec, 1
ds_add_u32 v253, v254 offset:12
s_mov_b64 exec, -1
v_and_b32 v187, s49, v187
v_fma_mix_f32 v166, v177, v177, v166 op_sel:[1,1,0] op_sel_hi:[1,1,0]
v_pk_mul_f16 v155, v155, v154
v_pk_mul_f16 v152, v152, v151
v_pk_mul_f16 v149, v149, v148
v_bfe_u32 v186, v187, 2, 14
v_fma_mix_f32 v166, v190, v190, v166 op_sel:[0,0,0] op_sel_hi:[1,1,0]
v_fma_mix_f32 v167, v155, v155, 0 op_sel:[0,0,0] op_sel_hi:[1,1,0]
v_fma_mix_f32 v167, v155, v155, v167 op_sel:[1,1,0] op_sel_hi:[1,1,0]
v_lshrrev_b32_e64 v187, 18, v187
v_fma_mix_f32 v167, v152, v152, v167 op_sel:[0,0,0] op_sel_hi:[1,1,0]
v_fma_mix_f32 v166, v191, v191, v166 op_sel:[1,1,0] op_sel_hi:[1,1,0]
v_fma_mix_f32 v167, v152, v152, v167 op_sel:[1,1,0] op_sel_hi:[1,1,0]
v_fma_mix_f32 v167, v149, v149, v167 op_sel:[0,0,0] op_sel_hi:[1,1,0]
v_fma_mix_f32 v167, v149, v149, v167 op_sel:[1,1,0] op_sel_hi:[1,1,0]
s_setprio 1
v_cvt_pkrtz_f16_f32 v137, v120, v121
v_cvt_pkrtz_f16_f32 v139, v122, v123
v_cvt_pkrtz_f16_f32 v141, v124, v125
v_cvt_pkrtz_f16_f32 v143, v126, v127
v_cvt_pkrtz_f16_f32 v177, v128, v129
v_cvt_pk_f16_f32 v155, v130, v131
v_cvt_pk_f16_f32 v152, v132, v133
v_cvt_pk_f16_f32 v149, v134, v135
s_waitcnt lgkmcnt(1)
ds_read_b128 v[224:227], v248 offset:27648
ds_read_u16_d16 v186, v186
ds_read_u16_d16_hi v187, v187
v_mfma_f32_32x32x16_bf16 v[120:135], v[72:75], v[228:231], 0
v_pk_fma_f16 v154, v155, v155, s48
v_and_b32_e64 v137, s49, v137
v_fma_mix_f32 v167, v178, v178, v167 op_sel:[0,0,0] op_sel_hi:[1,1,0]
v_pk_fma_f16 v151, v152, v152, s48
v_pk_fma_f16 v148, v149, v149, s48
v_bfe_u32 v136, v137, 2, 14
v_pk_mul_f16 v154, v155, v154
v_pk_mul_f16 v151, v152, v151
v_fma_mix_f32 v167, v179, v179, v167 op_sel:[1,1,0] op_sel_hi:[1,1,0]
v_lshrrev_b32_e64 v137, 18, v137
ds_read_b128 v[228:231], v250 offset:65520
ds_read_u16_d16 v136, v136
ds_read_u16_d16_hi v137, v137
v_mfma_f32_32x32x16_bf16 v[120:135], v[76:79], v[232:235], v[120:135]
v_pk_mul_f16 v148, v149, v148
v_exp_f16 v153, v154
v_exp_f16 v150, v151
v_and_b32_e64 v139, s49, v139
v_fma_mix_f32 v167, v180, v180, v167 op_sel:[0,0,0] op_sel_hi:[1,1,0]
v_exp_f16_e64 v147, v148
v_bfe_u32 v138, v139, 2, 14
ds_read_b128 v[232:235], v248 offset:28672
ds_read_b32 v247, v253 offset:12
ds_read_u16_d16 v138, v138
v_mfma_f32_32x32x16_bf16 v[120:135], v[80:83], v[236:239], v[120:135]
v_exp_f16_sdwa v153, v154 dst_sel:WORD_1 dst_unused:UNUSED_PRESERVE src0_sel:WORD_1
v_lshrrev_b32_e64 v139, 18, v139
v_fma_mix_f32 v167, v181, v181, v167 op_sel:[1,1,0] op_sel_hi:[1,1,0]
v_exp_f16_sdwa v150, v151 dst_sel:WORD_1 dst_unused:UNUSED_PRESERVE src0_sel:WORD_1
v_exp_f16_sdwa v147, v148 dst_sel:WORD_1 dst_unused:UNUSED_PRESERVE src0_sel:WORD_1
v_and_b32_e64 v141, s49, v141
v_fma_mix_f32 v167, v182, v182, v167 op_sel:[0,0,0] op_sel_hi:[1,1,0]
ds_read_b128 v[236:239], v248 offset:31744
ds_read_u16_d16_hi v139, v139
v_mfma_f32_32x32x16_bf16 v[120:135], v[84:87], v[216:219], v[120:135]
v_pk_add_f16 v153, v153, 1.0 op_sel_hi:[1,0]
v_bfe_u32 v140, v141, 2, 14
v_pk_add_f16 v150, v150, 1.0 op_sel_hi:[1,0]
v_pk_add_f16 v147, v147, 1.0 op_sel_hi:[1,0]
v_rcp_f16 v154, v153
v_lshrrev_b32 v141, 18, v141
ds_read_u16_d16 v140, v140
ds_read_u16_d16_hi v141, v141
s_waitcnt lgkmcnt(5)
v_readfirstlane_b32 s43, v247
s_nop 1
s_cmp_ge_u32 s43, 24
s_cbranch_scc1 Lev6
Lev6w:
s_sleep 1
ds_read_b32 v247, v253 offset:12
s_waitcnt lgkmcnt(0)
v_readfirstlane_b32 s43, v247
s_cmp_eq_u32 s76, 0
s_cbranch_scc1 Lev6
s_sub_u32 s76, s76, 1
s_cmp_lt_u32 s43, 24
s_cbranch_scc1 Lev6w
Lev6:
v_fma_mix_f32 v167, v183, v183, v167 op_sel:[1,1,0] op_sel_hi:[1,1,0]
v_rcp_f16 v151, v150
ds_read_b128 v[216:219], v248 offset:29696
v_mfma_f32_32x32x16_bf16 v[120:135], v[88:91], v[220:223], v[120:135]
v_and_b32 v143, s49, v143
v_rcp_f16 v148, v147
v_fma_mix_f32 v167, v184, v184, v167 op_sel:[0,0,0] op_sel_hi:[1,1,0]
v_bfe_u32 v142, v143, 2, 14
s_setprio 0
v_rcp_f16_sdwa v154, v153 dst_sel:WORD_1 dst_unused:UNUSED_PRESERVE src0_sel:WORD_1
v_rcp_f16_sdwa v151, v150 dst_sel:WORD_1 dst_unused:UNUSED_PRESERVE src0_sel:WORD_1
v_lshrrev_b32 v143, 18, v143
ds_read_b128 v[220:223], v245
ds_read_b128 v[192:195], v242
ds_read_b128 v[196:199], v242 offset:64
ds_read_u16_d16 v142, v142
ds_read_u16_d16_hi v143, v143
v_mfma_f32_32x32x16_bf16 v[120:135], v[92:95], v[224:227], v[120:135]
v_fma_mix_f32 v167, v185, v185, v167 op_sel:[1,1,0] op_sel_hi:[1,1,0]
v_rcp_f16_sdwa v148, v147 dst_sel:WORD_1 dst_unused:UNUSED_PRESERVE src0_sel:WORD_1
v_and_b32_e64 v177, s49, v177
v_pk_mul_f16 v155, v155, v154
v_fma_mix_f32 v167, v186, v186, v167 op_sel:[0,0,0] op_sel_hi:[1,1,0]
v_pk_mul_f16 v152, v152, v151
v_bfe_u32 v176, v177, 2, 14
v_pk_mul_f16 v149, v149, v148
v_fma_mix_f32 v156, v155, v155, v156 op_sel:[0,0,0] op_sel_hi:[1,1,0]
v_fma_mix_f32 v156, v155, v155, v156 op_sel:[1,1,0] op_sel_hi:[1,1,0]
v_lshrrev_b32 v177, 18, v177
v_fma_mix_f32 v167, v187, v187, v167 op_sel:[1,1,0] op_sel_hi:[1,1,0]
v_fma_mix_f32 v156, v152, v152, v156 op_sel:[0,0,0] op_sel_hi:[1,1,0]
v_fma_mix_f32 v156, v152, v152, v156 op_sel:[1,1,0] op_sel_hi:[1,1,0]
v_fma_mix_f32 v156, v149, v149, v156 op_sel:[0,0,0] op_sel_hi:[1,1,0]
v_fma_mix_f32 v156, v149, v149, v156 op_sel:[1,1,0] op_sel_hi:[1,1,0]
s_setprio 2
v_mfma_f32_32x32x16_bf16 v[0:15], v[228:231], v[228:231], 0
s_add_u32 s46, s80, 8388608
buffer_store_dwordx4 v[64:67], v241, s[32:35], s46 offen sc1
ds_read_b128 v[224:227], v248 offset:32768
ds_read_u16_d16 v176, v176
ds_read_u16_d16_hi v177, v177
v_cvt_pkrtz_f16_f32 v179, v120, v121
v_cvt_pkrtz_f16_f32 v181, v122, v123
v_cvt_pkrtz_f16_f32 v183, v124, v125
v_mfma_f32_32x32x16_bf16 v[16:31], v[228:231], v[228:231], 0
v_cvt_pkrtz_f16_f32 v185, v126, v127
v_cvt_pkrtz_f16_f32 v187, v128, v129
v_cvt_pk_f16_f32 v155, v130, v131
v_cvt_pk_f16_f32 v152, v132, v133
v_mfma_f32_32x32x16_bf16 v[32:47], v[228:231], v[228:231], 0
v_cvt_pk_f16_f32 v149, v134, v135
v_pk_fma_f16 v154, v155, v155, s48
v_and_b32_e64 v179, s49, v179
v_mfma_f32_32x32x16_bf16 v[120:135], v[72:75], v[232:235], 0
ds_read_b128 v[228:231], v248 offset:30720
v_fma_mix_f32 v156, v136, v136, v156 op_sel:[0,0,0] op_sel_hi:[1,1,0]
v_pk_fma_f16 v151, v152, v152, s48
v_pk_fma_f16 v148, v149, v149, s48
v_bfe_u32 v178, v179, 2, 14
v_pk_mul_f16 v154, v155, v154
v_pk_mul_f16 v151, v152, v151
v_fma_mix_f32 v156, v137, v137, v156 op_sel:[1,1,0] op_sel_hi:[1,1,0]
s_waitcnt lgkmcnt(4)
v_mfma_f32_32x32x16_bf16 v[120:135], v[76:79], v[236:239], v[120:135]
ds_read_b128 v[232:235], v245 offset:384
ds_read_b128 v[200:203], v242 offset:128
ds_read_b128 v[204:207], v243
ds_read_u16_d16 v178, v178
v_lshrrev_b32 v179, 18, v179
v_pk_mul_f16 v148, v149, v148
v_exp_f16 v153, v154
v_exp_f16 v150, v151
v_and_b32_e64 v181, s49, v181
v_fma_mix_f32 v156, v138, v138, v156 op_sel:[0,0,0] op_sel_hi:[1,1,0]
v_mfma_f32_32x32x16_bf16 v[120:135], v[80:83], v[216:219], v[120:135]
ds_read_b128 v[236:239], v248 offset:33792
ds_read_u16_d16_hi v179, v179
v_exp_f16_e64 v147, v148
v_bfe_u32 v180, v181, 2, 14
v_exp_f16_sdwa v153, v154 dst_sel:WORD_1 dst_unused:UNUSED_PRESERVE src0_sel:WORD_1
v_lshrrev_b32_e64 v181, 18, v181
v_fma_mix_f32 v156, v139, v139, v156 op_sel:[1,1,0] op_sel_hi:[1,1,0]
v_smfmac_f32_16x16x32_bf16 v[0:3], v[220:221], v[192:195], v246
ds_read_b128 v[216:219], v245 offset:768
ds_read_b128 v[208:211], v243 offset:64
ds_read_b128 v[212:215], v243 offset:128
ds_read_u16_d16 v180, v180
ds_read_u16_d16_hi v181, v181
v_exp_f16_sdwa v150, v151 dst_sel:WORD_1 dst_unused:UNUSED_PRESERVE src0_sel:WORD_1
v_smfmac_f32_16x16x32_bf16 v[16:19], v[222:223], v[196:199], v246
v_exp_f16_sdwa v147, v148 dst_sel:WORD_1 dst_unused:UNUSED_PRESERVE src0_sel:WORD_1
v_and_b32 v183, s49, v183
v_fma_mix_f32 v156, v140, v140, v156 op_sel:[0,0,0] op_sel_hi:[1,1,0]
v_pk_add_f16 v153, v153, 1.0 op_sel_hi:[1,0]
s_waitcnt lgkmcnt(7)
v_mfma_f32_32x32x16_bf16 v[120:135], v[84:87], v[224:227], v[120:135]
ds_read_b128 v[220:223], v245 offset:1152
ds_read_b128 v[192:195], v244
ds_read_b128 v[196:199], v244 offset:64
v_bfe_u32 v182, v183, 2, 14
v_pk_add_f16 v150, v150, 1.0 op_sel_hi:[1,0]
v_pk_add_f16 v147, v147, 1.0 op_sel_hi:[1,0]
v_rcp_f16 v154, v153
v_lshrrev_b32 v183, 18, v183
v_fma_mix_f32 v156, v141, v141, v156 op_sel:[1,1,0] op_sel_hi:[1,1,0]
v_mfma_f32_32x32x16_bf16 v[120:135], v[88:91], v[228:231], v[120:135]
ds_read_b128 v[224:227], v248 offset:34816
ds_read_u16_d16 v182, v182
ds_read_u16_d16_hi v183, v183
v_rcp_f16 v151, v150
v_and_b32 v185, s49, v185
v_rcp_f16_e64 v148, v147
v_fma_mix_f32 v156, v142, v142, v156 op_sel:[0,0,0] op_sel_hi:[1,1,0]
v_bfe_u32 v184, v185, 2, 14
v_smfmac_f32_16x16x32_bf16 v[32:35], v[232:233], v[200:203], v246
ds_read_b128 v[228:231], v248 offset:37888
ds_read_u16_d16 v184, v184
v_rcp_f16_sdwa v154, v153 dst_sel:WORD_1 dst_unused:UNUSED_PRESERVE src0_sel:WORD_1
v_rcp_f16_sdwa v151, v150 dst_sel:WORD_1 dst_unused:UNUSED_PRESERVE src0_sel:WORD_1
v_smfmac_f32_16x16x32_bf16 v[0:3], v[234:235], v[204:207], v246
v_lshrrev_b32 v185, 18, v185
v_fma_mix_f32 v156, v143, v143, v156 op_sel:[1,1,0] op_sel_hi:[1,1,0]
s_waitcnt lgkmcnt(6)
v_mfma_f32_32x32x16_bf16 v[120:135], v[92:95], v[236:239], v[120:135]
ds_read_b128 v[232:235], v248 offset:35840
ds_read_u16_d16_hi v185, v185
v_rcp_f16_sdwa v148, v147 dst_sel:WORD_1 dst_unused:UNUSED_PRESERVE src0_sel:WORD_1
v_and_b32_e64 v187, s49, v187
v_pk_mul_f16 v155, v155, v154
v_fma_mix_f32 v156, v176, v176, v156 op_sel:[0,0,0] op_sel_hi:[1,1,0]
v_pk_mul_f16 v152, v152, v151
v_bfe_u32 v186, v187, 2, 14
v_pk_mul_f16 v149, v149, v148
v_smfmac_f32_16x16x32_bf16 v[16:19], v[216:217], v[208:211], v246
ds_read_b128 v[236:239], v248 offset:38912
ds_read_u16_d16 v186, v186
v_fma_mix_f32 v157, v155, v155, v157 op_sel:[0,0,0] op_sel_hi:[1,1,0]
v_fma_mix_f32 v157, v155, v155, v157 op_sel:[1,1,0] op_sel_hi:[1,1,0]
v_lshrrev_b32_e64 v187, 18, v187
v_fma_mix_f32 v156, v177, v177, v156 op_sel:[1,1,0] op_sel_hi:[1,1,0]
v_smfmac_f32_16x16x32_bf16 v[32:35], v[218:219], v[212:215], v246
v_fma_mix_f32 v157, v152, v152, v157 op_sel:[0,0,0] op_sel_hi:[1,1,0]
v_fma_mix_f32 v157, v152, v152, v157 op_sel:[1,1,0] op_sel_hi:[1,1,0]
v_fma_mix_f32 v157, v149, v149, v157 op_sel:[0,0,0] op_sel_hi:[1,1,0]
v_fma_mix_f32 v157, v149, v149, v157 op_sel:[1,1,0] op_sel_hi:[1,1,0]
s_setprio 1
v_smfmac_f32_16x16x32_bf16 v[0:3], v[220:221], v[192:195], v246
s_waitcnt lgkmcnt(4)
s_add_u32 s46, s80, 10485760
buffer_store_dwordx4 v[68:71], v241, s[32:35], s46 offen sc1
ds_read_b128 v[216:219], v248 offset:36864
ds_read_u16_d16_hi v187, v187
v_cvt_pkrtz_f16_f32 v137, v120, v121
v_cvt_pkrtz_f16_f32 v139, v122, v123
v_cvt_pkrtz_f16_f32 v141, v124, v125
v_cvt_pkrtz_f16_f32 v143, v126, v127
v_cvt_pk_f16_f32 v155, v128, v129
v_smfmac_f32_16x16x32_bf16 v[16:19], v[222:223], v[196:199], v246
v_cvt_pk_f16_f32 v152, v130, v131
v_cvt_pk_f16_f32 v149, v132, v133
v_cvt_pk_f16_f32 v146, v134, v135
v_pk_fma_f16 v154, v155, v155, s48
v_and_b32_e64 v137, s49, v137
v_mfma_f32_32x32x16_bf16 v[120:135], v[72:75], v[224:227], 0
ds_read_b128 v[220:223], v248 offset:39936
v_fma_mix_f32 v157, v178, v178, v157 op_sel:[0,0,0] op_sel_hi:[1,1,0]
v_pk_fma_f16 v151, v152, v152, s48
v_pk_fma_f16 v148, v149, v149, s48
v_pk_fma_f16 v145, v146, v146, s48
v_pk_mul_f16 v154, v155, v154
v_bfe_u32 v136, v137, 2, 14
v_pk_mul_f16 v151, v152, v151
v_fma_mix_f32 v157, v179, v179, v157 op_sel:[1,1,0] op_sel_hi:[1,1,0]
v_pk_mul_f16 v148, v149, v148
v_pk_mul_f16 v145, v146, v145
v_mfma_f32_32x32x16_bf16 v[120:135], v[76:79], v[228:231], v[120:135]
ds_read_b128 v[224:227], v245 offset:1536
ds_read_b128 v[200:203], v244 offset:128
v_xor_b32_e64 v242, 16, v242
ds_read_b128 v[204:207], v242
ds_read_u16_d16 v136, v136
v_exp_f16 v153, v154
v_lshrrev_b32 v137, 18, v137
v_exp_f16_e64 v150, v151
v_fma_mix_f32 v157, v180, v180, v157 op_sel:[0,0,0] op_sel_hi:[1,1,0]
v_exp_f16 v147, v148
v_and_b32 v139, s49, v139
v_exp_f16 v144, v145
s_waitcnt lgkmcnt(5)
v_mfma_f32_32x32x16_bf16 v[120:135], v[80:83], v[232:235], v[120:135]
ds_read_b128 v[228:231], v245 offset:1920
ds_read_b128 v[208:211], v242 offset:64
ds_read_b128 v[212:215], v242 offset:128
ds_read_u16_d16_hi v137, v137
v_exp_f16_sdwa v153, v154 dst_sel:WORD_1 dst_unused:UNUSED_PRESERVE src0_sel:WORD_1
v_fma_mix_f32 v157, v181, v181, v157 op_sel:[1,1,0] op_sel_hi:[1,1,0]
v_bfe_u32 v138, v139, 2, 14
v_exp_f16_sdwa v150, v151 dst_sel:WORD_1 dst_unused:UNUSED_PRESERVE src0_sel:WORD_1
v_exp_f16_sdwa v147, v148 dst_sel:WORD_1 dst_unused:UNUSED_PRESERVE src0_sel:WORD_1
v_exp_f16_sdwa v144, v145 dst_sel:WORD_1 dst_unused:UNUSED_PRESERVE src0_sel:WORD_1
v_lshrrev_b32_e64 v139, 18, v139
v_fma_mix_f32 v157, v182, v182, v157 op_sel:[0,0,0] op_sel_hi:[1,1,0]
v_mfma_f32_32x32x16_bf16 v[120:135], v[84:87], v[236:239], v[120:135]
ds_read_b128 v[232:235], v248 offset:40960
ds_read_u16_d16 v138, v138
ds_read_u16_d16_hi v139, v139
v_pk_add_f16 v153, v153, 1.0 op_sel_hi:[1,0]
v_pk_add_f16 v150, v150, 1.0 op_sel_hi:[1,0]
v_pk_add_f16 v147, v147, 1.0 op_sel_hi:[1,0]
v_and_b32_e64 v141, s49, v141
v_pk_add_f16 v144, v144, 1.0 op_sel_hi:[1,0]
v_rcp_f16_e64 v154, v153
v_fma_mix_f32 v157, v183, v183, v157 op_sel:[1,1,0] op_sel_hi:[1,1,0]
v_rcp_f16_e64 v151, v150
v_mfma_f32_32x32x16_bf16 v[120:135], v[88:91], v[216:219], v[120:135]
ds_read_b128 v[236:239], v248 offset:44032
v_bfe_u32 v140, v141, 2, 14
v_rcp_f16_e64 v148, v147
v_fma_mix_f32 v157, v184, v184, v157 op_sel:[0,0,0] op_sel_hi:[1,1,0]
v_rcp_f16 v145, v144
v_lshrrev_b32 v141, 18, v141
v_rcp_f16_sdwa v154, v153 dst_sel:WORD_1 dst_unused:UNUSED_PRESERVE src0_sel:WORD_1
s_setprio 0
v_rcp_f16_sdwa v151, v150 dst_sel:WORD_1 dst_unused:UNUSED_PRESERVE src0_sel:WORD_1
s_waitcnt lgkmcnt(4)
v_mfma_f32_32x32x16_bf16 v[120:135], v[92:95], v[220:223], v[120:135]
ds_read_b128 v[216:219], v248 offset:41984
ds_read_u16_d16 v140, v140
ds_read_u16_d16_hi v141, v141
v_fma_mix_f32 v157, v185, v185, v157 op_sel:[1,1,0] op_sel_hi:[1,1,0]
v_and_b32_e64 v143, s49, v143
v_rcp_f16_sdwa v148, v147 dst_sel:WORD_1 dst_unused:UNUSED_PRESERVE src0_sel:WORD_1
v_rcp_f16_sdwa v145, v144 dst_sel:WORD_1 dst_unused:UNUSED_PRESERVE src0_sel:WORD_1
v_pk_mul_f16 v155, v155, v154
v_bfe_u32 v142, v143, 2, 14
v_fma_mix_f32 v157, v186, v186, v157 op_sel:[0,0,0] op_sel_hi:[1,1,0]
v_pk_mul_f16 v152, v152, v151
v_pk_mul_f16 v149, v149, v148
v_smfmac_f32_16x16x32_bf16 v[32:35], v[224:225], v[200:203], v246
ds_read_b128 v[220:223], v248 offset:45056
ds_read_u16_d16 v142, v142
v_pk_mul_f16 v146, v146, v145
v_fma_mix_f32 v158, v155, v155, v158 op_sel:[0,0,0] op_sel_hi:[1,1,0]
v_lshrrev_b32 v143, 18, v143
v_fma_mix_f32 v158, v155, v155, v158 op_sel:[1,1,0] op_sel_hi:[1,1,0]
v_fma_mix_f32 v158, v152, v152, v158 op_sel:[0,0,0] op_sel_hi:[1,1,0]
v_smfmac_f32_16x16x32_bf16 v[4:7], v[226:227], v[204:207], v246
v_fma_mix_f32 v157, v187, v187, v157 op_sel:[1,1,0] op_sel_hi:[1,1,0]
v_fma_mix_f32 v158, v152, v152, v158 op_sel:[1,1,0] op_sel_hi:[1,1,0]
v_fma_mix_f32 v158, v149, v149, v158 op_sel:[0,0,0] op_sel_hi:[1,1,0]
v_fma_mix_f32 v158, v149, v149, v158 op_sel:[1,1,0] op_sel_hi:[1,1,0]
v_fma_mix_f32 v158, v146, v146, v158 op_sel:[0,0,0] op_sel_hi:[1,1,0]
v_fma_mix_f32 v158, v146, v146, v158 op_sel:[1,1,0] op_sel_hi:[1,1,0]
s_setprio 2
v_smfmac_f32_16x16x32_bf16 v[20:23], v[228:229], v[208:211], v246
ds_read_b128 v[224:227], v248 offset:43008
ds_read_u16_d16_hi v143, v143
v_cvt_pkrtz_f16_f32 v179, v120, v121
v_cvt_pkrtz_f16_f32 v181, v122, v123
v_cvt_pkrtz_f16_f32 v183, v124, v125
v_cvt_pkrtz_f16_f32 v185, v126, v127
v_smfmac_f32_16x16x32_bf16 v[36:39], v[230:231], v[212:215], v246
v_cvt_pkrtz_f16_f32 v187, v128, v129
v_cvt_pk_f16_f32 v155, v130, v131
v_cvt_pk_f16_f32 v152, v132, v133
v_cvt_pk_f16_f32 v149, v134, v135
v_pk_fma_f16 v154, v155, v155, s48
s_waitcnt lgkmcnt(2)
v_mfma_f32_32x32x16_bf16 v[120:135], v[72:75], v[232:235], 0
ds_read_b128 v[228:231], v248 offset:46080
v_and_b32 v179, s49, v179
v_fma_mix_f32 v158, v136, v136, v158 op_sel:[0,0,0] op_sel_hi:[1,1,0]
v_pk_fma_f16 v151, v152, v152, s48
v_pk_fma_f16 v148, v149, v149, s48
v_bfe_u32 v178, v179, 2, 14
v_pk_mul_f16 v154, v155, v154
v_pk_mul_f16 v151, v152, v151
v_pk_mul_f16 v148, v149, v148
v_lshrrev_b32_e64 v179, 18, v179
v_mfma_f32_32x32x16_bf16 v[120:135], v[76:79], v[236:239], v[120:135]
ds_read_b128 v[232:235], v245 offset:2304
v_xor_b32_e64 v243, 16, v243
ds_read_b128 v[192:195], v243
ds_read_b128 v[196:199], v243 offset:64
ds_read_u16_d16 v178, v178
ds_read_u16_d16_hi v179, v179
v_fma_mix_f32 v158, v137, v137, v158 op_sel:[1,1,0] op_sel_hi:[1,1,0]
v_exp_f16 v153, v154
v_and_b32 v181, s49, v181
v_exp_f16 v150, v151
v_exp_f16 v147, v148
v_bfe_u32 v180, v181, 2, 14
v_mfma_f32_32x32x16_bf16 v[120:135], v[80:83], v[216:219], v[120:135]
ds_read_b128 v[236:239], v245 offset:2688
ds_read_b128 v[200:203], v243 offset:128
v_xor_b32_e64 v244, 16, v244
ds_read_b128 v[204:207], v244
ds_read_u16_d16 v180, v180
v_fma_mix_f32 v158, v138, v138, v158 op_sel:[0,0,0] op_sel_hi:[1,1,0]
v_exp_f16_sdwa v153, v154 dst_sel:WORD_1 dst_unused:UNUSED_PRESERVE src0_sel:WORD_1
v_lshrrev_b32_e64 v181, 18, v181
v_exp_f16_sdwa v150, v151 dst_sel:WORD_1 dst_unused:UNUSED_PRESERVE src0_sel:WORD_1
v_fma_mix_f32 v158, v139, v139, v158 op_sel:[1,1,0] op_sel_hi:[1,1,0]
v_and_b32_e64 v183, s49, v183
v_mfma_f32_32x32x16_bf16 v[120:135], v[84:87], v[220:223], v[120:135]
ds_read_b128 v[216:219], v248 offset:47104
ds_read_u16_d16_hi v181, v181
v_exp_f16_sdwa v147, v148 dst_sel:WORD_1 dst_unused:UNUSED_PRESERVE src0_sel:WORD_1
v_pk_add_f16 v153, v153, 1.0 op_sel_hi:[1,0]
v_bfe_u32 v182, v183, 2, 14
v_pk_add_f16 v150, v150, 1.0 op_sel_hi:[1,0]
v_pk_add_f16 v147, v147, 1.0 op_sel_hi:[1,0]
v_rcp_f16_e64 v154, v153
v_lshrrev_b32 v183, 18, v183
v_fma_mix_f32 v158, v140, v140, v158 op_sel:[0,0,0] op_sel_hi:[1,1,0]
s_waitcnt lgkmcnt(6)
v_mfma_f32_32x32x16_bf16 v[120:135], v[88:91], v[224:227], v[120:135]
ds_read_b128 v[220:223], v248 offset:50176
ds_read_u16_d16 v182, v182
ds_read_u16_d16_hi v183, v183
v_rcp_f16 v151, v150
v_and_b32 v185, s49, v185
v_rcp_f16_e64 v148, v147
v_fma_mix_f32 v158, v141, v141, v158 op_sel:[1,1,0] op_sel_hi:[1,1,0]
v_bfe_u32 v184, v185, 2, 14
v_rcp_f16_sdwa v154, v153 dst_sel:WORD_1 dst_unused:UNUSED_PRESERVE src0_sel:WORD_1
v_mfma_f32_32x32x16_bf16 v[120:135], v[92:95], v[228:231], v[120:135]
ds_read_b128 v[224:227], v248 offset:48128
ds_read_u16_d16 v184, v184
v_rcp_f16_sdwa v151, v150 dst_sel:WORD_1 dst_unused:UNUSED_PRESERVE src0_sel:WORD_1
v_lshrrev_b32_e64 v185, 18, v185
v_rcp_f16_sdwa v148, v147 dst_sel:WORD_1 dst_unused:UNUSED_PRESERVE src0_sel:WORD_1
v_and_b32_e64 v187, s49, v187
v_fma_mix_f32 v158, v142, v142, v158 op_sel:[0,0,0] op_sel_hi:[1,1,0]
v_pk_mul_f16 v155, v155, v154
v_pk_mul_f16 v152, v152, v151
v_smfmac_f32_16x16x32_bf16 v[4:7], v[232:233], v[192:195], v246
ds_read_b128 v[228:231], v248 offset:51200
ds_read_u16_d16_hi v185, v185
v_bfe_u32 v186, v187, 2, 14
v_pk_mul_f16 v149, v149, v148
v_fma_mix_f32 v159, v155, v155, v159 op_sel:[0,0,0] op_sel_hi:[1,1,0]
v_fma_mix_f32 v158, v143, v143, v158 op_sel:[1,1,0] op_sel_hi:[1,1,0]
v_lshrrev_b32_e64 v187, 18, v187
v_smfmac_f32_16x16x32_bf16 v[20:23], v[234:235], v[196:199], v246
v_fma_mix_f32 v159, v155, v155, v159 op_sel:[1,1,0] op_sel_hi:[1,1,0]
v_fma_mix_f32 v159, v152, v152, v159 op_sel:[0,0,0] op_sel_hi:[1,1,0]
v_fma_mix_f32 v159, v152, v152, v159 op_sel:[1,1,0] op_sel_hi:[1,1,0]
v_fma_mix_f32 v159, v149, v149, v159 op_sel:[0,0,0] op_sel_hi:[1,1,0]
v_fma_mix_f32 v159, v149, v149, v159 op_sel:[1,1,0] op_sel_hi:[1,1,0]
s_setprio 1
s_waitcnt lgkmcnt(4)
v_smfmac_f32_16x16x32_bf16 v[36:39], v[236:237], v[200:203], v246
ds_read_b128 v[232:235], v248 offset:49152
ds_read_u16_d16 v186, v186
ds_read_u16_d16_hi v187, v187
v_cvt_pkrtz_f16_f32 v137, v120, v121
v_cvt_pkrtz_f16_f32 v139, v122, v123
v_cvt_pkrtz_f16_f32 v141, v124, v125
v_cvt_pkrtz_f16_f32 v143, v126, v127
v_cvt_pk_f16_f32 v155, v128, v129
v_smfmac_f32_16x16x32_bf16 v[4:7], v[238:239], v[204:207], v246
v_cvt_pk_f16_f32 v152, v130, v131
v_cvt_pk_f16_f32 v149, v132, v133
v_cvt_pk_f16_f32 v146, v134, v135
v_pk_fma_f16 v154, v155, v155, s48
v_and_b32_e64 v137, s49, v137
v_mfma_f32_32x32x16_bf16 v[120:135], v[72:75], v[216:219], 0
ds_read_b128 v[236:239], v248 offset:52224
v_fma_mix_f32 v159, v178, v178, v159 op_sel:[0,0,0] op_sel_hi:[1,1,0]
v_pk_fma_f16 v151, v152, v152, s48
v_pk_fma_f16 v148, v149, v149, s48
v_pk_fma_f16 v145, v146, v146, s48
v_pk_mul_f16 v154, v155, v154
v_bfe_u32 v136, v137, 2, 14
v_pk_mul_f16 v151, v152, v151
v_fma_mix_f32 v159, v179, v179, v159 op_sel:[1,1,0] op_sel_hi:[1,1,0]
v_pk_mul_f16 v148, v149, v148
v_pk_mul_f16 v145, v146, v145
v_mfma_f32_32x32x16_bf16 v[120:135], v[76:79], v[220:223], v[120:135]
ds_read_b128 v[216:219], v245 offset:3072
ds_read_b128 v[208:211], v244 offset:64
ds_read_b128 v[212:215], v244 offset:128
ds_read_u16_d16 v136, v136
v_exp_f16 v153, v154
v_lshrrev_b32 v137, 18, v137
v_exp_f16_e64 v150, v151
v_fma_mix_f32 v159, v180, v180, v159 op_sel:[0,0,0] op_sel_hi:[1,1,0]
v_exp_f16 v147, v148
v_and_b32 v139, s49, v139
v_exp_f16 v144, v145
s_waitcnt lgkmcnt(5)
v_mfma_f32_32x32x16_bf16 v[120:135], v[80:83], v[224:227], v[120:135]
ds_read_b128 v[220:223], v245 offset:3456
v_xor_b32_e64 v242, 32, v242
ds_read_b128 v[192:195], v242
ds_read_b128 v[196:199], v242 offset:64
ds_read_u16_d16_hi v137, v137
v_exp_f16_sdwa v153, v154 dst_sel:WORD_1 dst_unused:UNUSED_PRESERVE src0_sel:WORD_1
v_fma_mix_f32 v159, v181, v181, v159 op_sel:[1,1,0] op_sel_hi:[1,1,0]
v_bfe_u32 v138, v139, 2, 14
v_exp_f16_sdwa v150, v151 dst_sel:WORD_1 dst_unused:UNUSED_PRESERVE src0_sel:WORD_1
v_exp_f16_sdwa v147, v148 dst_sel:WORD_1 dst_unused:UNUSED_PRESERVE src0_sel:WORD_1
v_exp_f16_sdwa v144, v145 dst_sel:WORD_1 dst_unused:UNUSED_PRESERVE src0_sel:WORD_1
v_lshrrev_b32_e64 v139, 18, v139
v_fma_mix_f32 v159, v182, v182, v159 op_sel:[0,0,0] op_sel_hi:[1,1,0]
v_mfma_f32_32x32x16_bf16 v[120:135], v[84:87], v[228:231], v[120:135]
ds_read_b128 v[224:227], v248 offset:53248
ds_read_u16_d16 v138, v138
ds_read_u16_d16_hi v139, v139
v_pk_add_f16 v153, v153, 1.0 op_sel_hi:[1,0]
v_pk_add_f16 v150, v150, 1.0 op_sel_hi:[1,0]
v_pk_add_f16 v147, v147, 1.0 op_sel_hi:[1,0]
v_and_b32_e64 v141, s49, v141
v_pk_add_f16 v144, v144, 1.0 op_sel_hi:[1,0]
v_rcp_f16_e64 v154, v153
v_fma_mix_f32 v159, v183, v183, v159 op_sel:[1,1,0] op_sel_hi:[1,1,0]
v_rcp_f16_e64 v151, v150
v_mfma_f32_32x32x16_bf16 v[120:135], v[88:91], v[232:235], v[120:135]
ds_read_b128 v[228:231], v248 offset:56320
v_bfe_u32 v140, v141, 2, 14
v_rcp_f16_e64 v148, v147
v_fma_mix_f32 v159, v184, v184, v159 op_sel:[0,0,0] op_sel_hi:[1,1,0]
v_rcp_f16 v145, v144
v_lshrrev_b32 v141, 18, v141
v_rcp_f16_sdwa v154, v153 dst_sel:WORD_1 dst_unused:UNUSED_PRESERVE src0_sel:WORD_1
s_setprio 0
v_rcp_f16_sdwa v151, v150 dst_sel:WORD_1 dst_unused:UNUSED_PRESERVE src0_sel:WORD_1
s_waitcnt lgkmcnt(4)
v_mfma_f32_32x32x16_bf16 v[120:135], v[92:95], v[236:239], v[120:135]
ds_read_b128 v[232:235], v248 offset:54272
ds_read_u16_d16 v140, v140
ds_read_u16_d16_hi v141, v141
v_fma_mix_f32 v159, v185, v185, v159 op_sel:[1,1,0] op_sel_hi:[1,1,0]
v_and_b32_e64 v143, s49, v143
v_rcp_f16_sdwa v148, v147 dst_sel:WORD_1 dst_unused:UNUSED_PRESERVE src0_sel:WORD_1
v_rcp_f16_sdwa v145, v144 dst_sel:WORD_1 dst_unused:UNUSED_PRESERVE src0_sel:WORD_1
v_pk_mul_f16 v155, v155, v154
v_bfe_u32 v142, v143, 2, 14
v_fma_mix_f32 v159, v186, v186, v159 op_sel:[0,0,0] op_sel_hi:[1,1,0]
v_pk_mul_f16 v152, v152, v151
v_pk_mul_f16 v149, v149, v148
v_smfmac_f32_16x16x32_bf16 v[20:23], v[216:217], v[208:211], v246
ds_read_b128 v[236:239], v248 offset:57344
ds_read_u16_d16 v142, v142
v_pk_mul_f16 v146, v146, v145
v_fma_mix_f32 v160, v155, v155, v160 op_sel:[0,0,0] op_sel_hi:[1,1,0]
v_lshrrev_b32_e64 v143, 18, v143
v_fma_mix_f32 v160, v155, v155, v160 op_sel:[1,1,0] op_sel_hi:[1,1,0]
v_fma_mix_f32 v160, v152, v152, v160 op_sel:[0,0,0] op_sel_hi:[1,1,0]
v_smfmac_f32_16x16x32_bf16 v[36:39], v[218:219], v[212:215], v246
v_fma_mix_f32 v159, v187, v187, v159 op_sel:[1,1,0] op_sel_hi:[1,1,0]
v_fma_mix_f32 v160, v152, v152, v160 op_sel:[1,1,0] op_sel_hi:[1,1,0]
v_fma_mix_f32 v160, v149, v149, v160 op_sel:[0,0,0] op_sel_hi:[1,1,0]
v_fma_mix_f32 v160, v149, v149, v160 op_sel:[1,1,0] op_sel_hi:[1,1,0]
v_fma_mix_f32 v160, v146, v146, v160 op_sel:[0,0,0] op_sel_hi:[1,1,0]
v_fma_mix_f32 v160, v146, v146, v160 op_sel:[1,1,0] op_sel_hi:[1,1,0]
s_cmp_lg_u32 s40, 7
s_cbranch_scc1 Lnobias2
s_sub_u32 s43, s2, 96
s_cmp_lt_u32 s43, 96
s_cbranch_scc0 Lnobias2
s_waitcnt vmcnt(13)
v_lshlrev_b32 v102, 16, v102
v_lshlrev_b32 v103, 16, v103
v_lshlrev_b32 v104, 16, v104
v_lshlrev_b32 v105, 16, v105
v_lshlrev_b32 v106, 16, v106
v_lshlrev_b32 v107, 16, v107
v_lshlrev_b32 v108, 16, v108
v_lshlrev_b32 v109, 16, v109
v_lshlrev_b32 v110, 16, v110
v_lshlrev_b32 v111, 16, v111
v_lshlrev_b32 v112, 16, v112
v_lshlrev_b32 v113, 16, v113
v_mul_f32 v100, v102, v108
v_fmac_f32 v100, v103, v109
v_fmac_f32 v100, v104, v110
v_fmac_f32 v100, v105, v111
v_fmac_f32 v100, v106, v112
v_fmac_f32 v100, v107, v113
s_nop 1
v_add_f32_dpp v100, v100, v100 row_ror:8 row_mask:0xf bank_mask:0xf
s_nop 1
v_add_f32_dpp v100, v100, v100 row_ror:4 row_mask:0xf bank_mask:0xf
s_nop 1
v_add_f32_dpp v100, v100, v100 row_ror:2 row_mask:0xf bank_mask:0xf
s_nop 1
v_add_f32_dpp v100, v100, v100 row_ror:1 row_mask:0xf bank_mask:0xf
v_mov_b32 v101, v100
s_nop 1
v_permlane16_swap_b32 v100, v101
v_add_f32 v100, v100, v101
v_mov_b32_e64 v101, v100
s_nop 1
v_permlane32_swap_b32 v100, v101
v_add_f32 v100, v100, v101
s_lshl_b32 s44, s43, 2
s_add_u32 s44, s44, 394752
v_lshlrev_b32_e64 v115, 11, v251
s_mov_b64 exec, 0xff
buffer_store_dword v100, v115, s[32:35], s44 offen sc1
s_mov_b64 exec, -1
Lnobias2:
s_setprio 2
v_smfmac_f32_16x16x32_bf16 v[12:15], v[220:221], v[192:195], v246
ds_read_b128 v[216:219], v248 offset:55296
ds_read_u16_d16_hi v143, v143
v_cvt_pkrtz_f16_f32 v179, v120, v121
v_cvt_pkrtz_f16_f32 v181, v122, v123
v_cvt_pkrtz_f16_f32 v183, v124, v125
v_cvt_pkrtz_f16_f32 v185, v126, v127
v_smfmac_f32_16x16x32_bf16 v[28:31], v[222:223], v[196:199], v246
v_cvt_pkrtz_f16_f32 v187, v128, v129
v_cvt_pk_f16_f32 v155, v130, v131
v_cvt_pk_f16_f32 v152, v132, v133
v_cvt_pk_f16_f32 v149, v134, v135
s_waitcnt lgkmcnt(2)
v_mfma_f32_32x32x16_bf16 v[120:135], v[72:75], v[224:227], 0
ds_read_b128 v[220:223], v245 offset:3840
ds_read_b128 v[200:203], v242 offset:128
v_xor_b32 v243, 32, v243
ds_read_b128 v[204:207], v243
v_pk_fma_f16 v154, v155, v155, s48
v_and_b32_e64 v179, s49, v179
v_fma_mix_f32 v160, v136, v136, v160 op_sel:[0,0,0] op_sel_hi:[1,1,0]
v_pk_fma_f16 v151, v152, v152, s48
v_pk_fma_f16 v148, v149, v149, s48
v_bfe_u32 v178, v179, 2, 14
v_pk_mul_f16 v154, v155, v154
v_pk_mul_f16 v151, v152, v151
v_mfma_f32_32x32x16_bf16 v[120:135], v[76:79], v[228:231], v[120:135]
ds_read_b128 v[224:227], v248 offset:58368
ds_read_u16_d16 v178, v178
v_pk_mul_f16 v148, v149, v148
v_lshrrev_b32_e64 v179, 18, v179
v_fma_mix_f32 v160, v137, v137, v160 op_sel:[1,1,0] op_sel_hi:[1,1,0]
v_exp_f16 v153, v154
v_and_b32 v181, s49, v181
v_exp_f16_e64 v150, v151
v_mfma_f32_32x32x16_bf16 v[120:135], v[80:83], v[232:235], v[120:135]
ds_read_b128 v[228:231], v245 offset:4224
ds_read_b128 v[208:211], v243 offset:64
ds_read_b128 v[212:215], v243 offset:128
ds_read_u16_d16_hi v179, v179
v_exp_f16_e64 v147, v148
v_bfe_u32 v180, v181, 2, 14
v_fma_mix_f32 v160, v138, v138, v160 op_sel:[0,0,0] op_sel_hi:[1,1,0]
v_exp_f16_sdwa v153, v154 dst_sel:WORD_1 dst_unused:UNUSED_PRESERVE src0_sel:WORD_1
v_lshrrev_b32_e64 v181, 18, v181
v_mfma_f32_32x32x16_bf16 v[120:135], v[84:87], v[236:239], v[120:135]
ds_read_b128 v[232:235], v245 offset:4608
v_xor_b32_e64 v244, 32, v244
ds_read_b128 v[192:195], v244
ds_read_b128 v[196:199], v244 offset:64
ds_read_u16_d16 v180, v180
ds_read_u16_d16_hi v181, v181
v_exp_f16_sdwa v150, v151 dst_sel:WORD_1 dst_unused:UNUSED_PRESERVE src0_sel:WORD_1
v_fma_mix_f32 v160, v139, v139, v160 op_sel:[1,1,0] op_sel_hi:[1,1,0]
v_and_b32 v183, s49, v183
v_exp_f16_sdwa v147, v148 dst_sel:WORD_1 dst_unused:UNUSED_PRESERVE src0_sel:WORD_1
v_pk_add_f16 v153, v153, 1.0 op_sel_hi:[1,0]
v_bfe_u32 v182, v183, 2, 14
v_pk_add_f16 v150, v150, 1.0 op_sel_hi:[1,0]
s_waitcnt lgkmcnt(9)
v_mfma_f32_32x32x16_bf16 v[120:135], v[88:91], v[216:219], v[120:135]
ds_read_b128 v[236:239], v248 offset:59392
ds_read_u16_d16 v182, v182
v_pk_add_f16 v147, v147, 1.0 op_sel_hi:[1,0]
v_rcp_f16 v154, v153
v_lshrrev_b32 v183, 18, v183
v_fma_mix_f32 v160, v140, v140, v160 op_sel:[0,0,0] op_sel_hi:[1,1,0]
v_rcp_f16 v151, v150
v_and_b32 v185, s49, v185
v_smfmac_f32_16x16x32_bf16 v[44:47], v[220:221], v[200:203], v246
ds_read_b128 v[216:219], v248 offset:62464
ds_read_u16_d16_hi v183, v183
v_rcp_f16_e64 v148, v147
v_fma_mix_f32 v160, v141, v141, v160 op_sel:[1,1,0] op_sel_hi:[1,1,0]
v_bfe_u32 v184, v185, 2, 14
v_smfmac_f32_16x16x32_bf16 v[12:15], v[222:223], v[204:207], v246
v_rcp_f16_sdwa v154, v153 dst_sel:WORD_1 dst_unused:UNUSED_PRESERVE src0_sel:WORD_1
v_rcp_f16_sdwa v151, v150 dst_sel:WORD_1 dst_unused:UNUSED_PRESERVE src0_sel:WORD_1
v_mfma_f32_32x32x16_bf16 v[120:135], v[92:95], v[224:227], v[120:135]
ds_read_b128 v[220:223], v248 offset:60416
ds_read_u16_d16 v184, v184
v_lshrrev_b32_e64 v185, 18, v185
v_rcp_f16_sdwa v148, v147 dst_sel:WORD_1 dst_unused:UNUSED_PRESERVE src0_sel:WORD_1
v_and_b32 v187, s49, v187
v_fma_mix_f32 v160, v142, v142, v160 op_sel:[0,0,0] op_sel_hi:[1,1,0]
v_pk_mul_f16 v155, v155, v154
v_pk_mul_f16 v152, v152, v151
v_bfe_u32 v186, v187, 2, 14
s_waitcnt lgkmcnt(4)
v_smfmac_f32_16x16x32_bf16 v[28:31], v[228:229], v[208:211], v246
ds_read_b128 v[224:227], v248 offset:63488
ds_read_u16_d16_hi v185, v185
ds_read_u16_d16 v186, v186
v_pk_mul_f16 v149, v149, v148
v_fma_mix_f32 v161, v155, v155, v161 op_sel:[0,0,0] op_sel_hi:[1,1,0]
v_fma_mix_f32 v160, v143, v143, v160 op_sel:[1,1,0] op_sel_hi:[1,1,0]
v_lshrrev_b32_e64 v187, 18, v187
v_smfmac_f32_16x16x32_bf16 v[44:47], v[230:231], v[212:215], v246
v_fma_mix_f32 v161, v155, v155, v161 op_sel:[1,1,0] op_sel_hi:[1,1,0]
v_fma_mix_f32 v161, v152, v152, v161 op_sel:[0,0,0] op_sel_hi:[1,1,0]
v_fma_mix_f32 v161, v152, v152, v161 op_sel:[1,1,0] op_sel_hi:[1,1,0]
v_fma_mix_f32 v161, v149, v149, v161 op_sel:[0,0,0] op_sel_hi:[1,1,0]
v_fma_mix_f32 v161, v149, v149, v161 op_sel:[1,1,0] op_sel_hi:[1,1,0]
v_lshlrev_b32_e64 v252, 7, v251
s_add_u32 s46, s47, 2359296
s_mov_b32 exec_lo, 131071
s_mov_b32 exec_hi, 0
s_mov_b32 m0, 16288
s_nop 0
buffer_load_dword v252, s[4:7], s46 offen lds
s_mov_b64 exec, -1
s_setprio 1
v_smfmac_f32_16x16x32_bf16 v[12:15], v[232:233], v[192:195], v246
ds_read_b128 v[228:231], v248 offset:61440
ds_read_u16_d16_hi v187, v187
v_cvt_pkrtz_f16_f32 v137, v120, v121
v_cvt_pkrtz_f16_f32 v139, v122, v123
v_cvt_pkrtz_f16_f32 v141, v124, v125
v_cvt_pkrtz_f16_f32 v143, v126, v127
v_cvt_pk_f16_f32 v155, v128, v129
v_smfmac_f32_16x16x32_bf16 v[28:31], v[234:235], v[196:199], v246
v_cvt_pk_f16_f32 v152, v130, v131
v_cvt_pk_f16_f32 v149, v132, v133
v_cvt_pk_f16_f32 v146, v134, v135
v_pk_fma_f16 v154, v155, v155, s48
v_and_b32_e64 v137, s49, v137
v_mfma_f32_32x32x16_bf16 v[120:135], v[72:75], v[236:239], 0
ds_read_b128 v[232:235], v248 offset:64512
v_fma_mix_f32 v161, v178, v178, v161 op_sel:[0,0,0] op_sel_hi:[1,1,0]
v_pk_fma_f16 v151, v152, v152, s48
v_pk_fma_f16 v148, v149, v149, s48
v_pk_fma_f16 v145, v146, v146, s48
v_pk_mul_f16 v154, v155, v154
v_bfe_u32 v136, v137, 2, 14
v_pk_mul_f16 v151, v152, v151
v_fma_mix_f32 v161, v179, v179, v161 op_sel:[1,1,0] op_sel_hi:[1,1,0]
v_pk_mul_f16 v148, v149, v148
v_pk_mul_f16 v145, v146, v145
s_waitcnt lgkmcnt(2)
v_mfma_f32_32x32x16_bf16 v[120:135], v[76:79], v[216:219], v[120:135]
ds_read_b128 v[236:239], v245 offset:4992
ds_read_b128 v[200:203], v244 offset:128
v_xor_b32 v242, 16, v242
ds_read_b128 v[204:207], v242
ds_read_u16_d16 v136, v136
v_exp_f16 v153, v154
v_lshrrev_b32 v137, 18, v137
v_exp_f16_e64 v150, v151
v_fma_mix_f32 v161, v180, v180, v161 op_sel:[0,0,0] op_sel_hi:[1,1,0]
v_exp_f16 v147, v148
v_and_b32 v139, s49, v139
v_exp_f16_e64 v144, v145
v_mfma_f32_32x32x16_bf16 v[120:135], v[80:83], v[220:223], v[120:135]
ds_read_b128 v[216:219], v245 offset:5376
ds_read_b128 v[208:211], v242 offset:64
ds_read_b128 v[212:215], v242 offset:128
ds_read_u16_d16_hi v137, v137
v_exp_f16_sdwa v153, v154 dst_sel:WORD_1 dst_unused:UNUSED_PRESERVE src0_sel:WORD_1
v_fma_mix_f32 v161, v181, v181, v161 op_sel:[1,1,0] op_sel_hi:[1,1,0]
v_bfe_u32 v138, v139, 2, 14
v_exp_f16_sdwa v150, v151 dst_sel:WORD_1 dst_unused:UNUSED_PRESERVE src0_sel:WORD_1
v_exp_f16_sdwa v147, v148 dst_sel:WORD_1 dst_unused:UNUSED_PRESERVE src0_sel:WORD_1
v_exp_f16_sdwa v144, v145 dst_sel:WORD_1 dst_unused:UNUSED_PRESERVE src0_sel:WORD_1
v_lshrrev_b32_e64 v139, 18, v139
v_fma_mix_f32 v161, v182, v182, v161 op_sel:[0,0,0] op_sel_hi:[1,1,0]
v_mfma_f32_32x32x16_bf16 v[120:135], v[84:87], v[224:227], v[120:135]
ds_read_b128 v[220:223], v249
ds_read_u16_d16 v138, v138
ds_read_u16_d16_hi v139, v139
v_pk_add_f16 v153, v153, 1.0 op_sel_hi:[1,0]
v_pk_add_f16 v150, v150, 1.0 op_sel_hi:[1,0]
v_pk_add_f16 v147, v147, 1.0 op_sel_hi:[1,0]
v_and_b32_e64 v141, s49, v141
v_pk_add_f16 v144, v144, 1.0 op_sel_hi:[1,0]
v_rcp_f16_e64 v154, v153
v_fma_mix_f32 v161, v183, v183, v161 op_sel:[1,1,0] op_sel_hi:[1,1,0]
v_rcp_f16_e64 v151, v150
v_mfma_f32_32x32x16_bf16 v[120:135], v[88:91], v[228:231], v[120:135]
ds_read_b128 v[224:227], v249 offset:3072
v_bfe_u32 v140, v141, 2, 14
v_rcp_f16_e64 v148, v147
v_fma_mix_f32 v161, v184, v184, v161 op_sel:[0,0,0] op_sel_hi:[1,1,0]
v_rcp_f16 v145, v144
v_lshrrev_b32 v141, 18, v141
v_rcp_f16_sdwa v154, v153 dst_sel:WORD_1 dst_unused:UNUSED_PRESERVE src0_sel:WORD_1
s_setprio 0
v_rcp_f16_sdwa v151, v150 dst_sel:WORD_1 dst_unused:UNUSED_PRESERVE src0_sel:WORD_1
s_waitcnt lgkmcnt(4)
v_mfma_f32_32x32x16_bf16 v[120:135], v[92:95], v[232:235], v[120:135]
ds_read_b128 v[228:231], v249 offset:1024
ds_read_u16_d16 v140, v140
ds_read_u16_d16_hi v141, v141
v_fma_mix_f32 v161, v185, v185, v161 op_sel:[1,1,0] op_sel_hi:[1,1,0]
v_and_b32_e64 v143, s49, v143
v_rcp_f16_sdwa v148, v147 dst_sel:WORD_1 dst_unused:UNUSED_PRESERVE src0_sel:WORD_1
v_rcp_f16_sdwa v145, v144 dst_sel:WORD_1 dst_unused:UNUSED_PRESERVE src0_sel:WORD_1
v_pk_mul_f16 v155, v155, v154
v_bfe_u32 v142, v143, 2, 14
v_fma_mix_f32 v161, v186, v186, v161 op_sel:[0,0,0] op_sel_hi:[1,1,0]
v_pk_mul_f16 v152, v152, v151
v_pk_mul_f16 v149, v149, v148
v_smfmac_f32_16x16x32_bf16 v[44:47], v[236:237], v[200:203], v246
ds_read_b128 v[232:235], v249 offset:4096
ds_read_u16_d16 v142, v142
v_pk_mul_f16 v146, v146, v145
v_fma_mix_f32 v162, v155, v155, v162 op_sel:[0,0,0] op_sel_hi:[1,1,0]
v_lshrrev_b32_e64 v143, 18, v143
v_fma_mix_f32 v162, v155, v155, v162 op_sel:[1,1,0] op_sel_hi:[1,1,0]
v_fma_mix_f32 v162, v152, v152, v162 op_sel:[0,0,0] op_sel_hi:[1,1,0]
v_smfmac_f32_16x16x32_bf16 v[8:11], v[238:239], v[204:207], v246
v_fma_mix_f32 v161, v187, v187, v161 op_sel:[1,1,0] op_sel_hi:[1,1,0]
v_fma_mix_f32 v162, v152, v152, v162 op_sel:[1,1,0] op_sel_hi:[1,1,0]
v_fma_mix_f32 v162, v149, v149, v162 op_sel:[0,0,0] op_sel_hi:[1,1,0]
v_fma_mix_f32 v162, v149, v149, v162 op_sel:[1,1,0] op_sel_hi:[1,1,0]
v_fma_mix_f32 v162, v146, v146, v162 op_sel:[0,0,0] op_sel_hi:[1,1,0]
v_fma_mix_f32 v162, v146, v146, v162 op_sel:[1,1,0] op_sel_hi:[1,1,0]
v_lshlrev_b32_e64 v252, 7, v251
s_add_u32 s46, s47, 2359296
s_mov_b32 exec_lo, 4294836224
s_mov_b32 exec_hi, 3
s_mov_b32 m0, 16220
s_nop 0
buffer_load_dword v252, s[4:7], s46 offen lds
s_mov_b64 exec, -1
s_setprio 2
v_smfmac_f32_16x16x32_bf16 v[24:27], v[216:217], v[208:211], v246
ds_read_b128 v[236:239], v249 offset:2048
ds_read_u16_d16_hi v143, v143
v_cvt_pkrtz_f16_f32 v179, v120, v121
v_cvt_pkrtz_f16_f32 v181, v122, v123
v_cvt_pkrtz_f16_f32 v183, v124, v125
v_cvt_pkrtz_f16_f32 v185, v126, v127
v_smfmac_f32_16x16x32_bf16 v[40:43], v[218:219], v[212:215], v246
v_cvt_pkrtz_f16_f32 v187, v128, v129
v_cvt_pk_f16_f32 v155, v130, v131
v_cvt_pk_f16_f32 v152, v132, v133
v_cvt_pk_f16_f32 v149, v134, v135
v_pk_fma_f16 v154, v155, v155, s48
s_waitcnt lgkmcnt(2)
v_mfma_f32_32x32x16_bf16 v[120:135], v[72:75], v[220:223], 0
ds_read_b128 v[216:219], v249 offset:5120
v_and_b32 v179, s49, v179
v_fma_mix_f32 v162, v136, v136, v162 op_sel:[0,0,0] op_sel_hi:[1,1,0]
v_pk_fma_f16 v151, v152, v152, s48
v_pk_fma_f16 v148, v149, v149, s48
v_bfe_u32 v178, v179, 2, 14
v_pk_mul_f16 v154, v155, v154
v_pk_mul_f16 v151, v152, v151
v_pk_mul_f16 v148, v149, v148
v_lshrrev_b32_e64 v179, 18, v179
v_mfma_f32_32x32x16_bf16 v[120:135], v[76:79], v[224:227], v[120:135]
ds_read_b128 v[220:223], v245 offset:5760
v_xor_b32_e64 v243, 16, v243
ds_read_b128 v[192:195], v243
ds_read_b128 v[196:199], v243 offset:64
ds_read_u16_d16 v178, v178
ds_read_u16_d16_hi v179, v179
v_fma_mix_f32 v162, v137, v137, v162 op_sel:[1,1,0] op_sel_hi:[1,1,0]
v_exp_f16 v153, v154
v_and_b32 v181, s49, v181
v_exp_f16 v150, v151
v_exp_f16 v147, v148
v_bfe_u32 v180, v181, 2, 14
v_mfma_f32_32x32x16_bf16 v[120:135], v[80:83], v[228:231], v[120:135]
ds_read_b128 v[224:227], v245 offset:6144
ds_read_b128 v[200:203], v243 offset:128
v_xor_b32_e64 v244, 16, v244
ds_read_b128 v[204:207], v244
ds_read_u16_d16 v180, v180
v_fma_mix_f32 v162, v138, v138, v162 op_sel:[0,0,0] op_sel_hi:[1,1,0]
v_exp_f16_sdwa v153, v154 dst_sel:WORD_1 dst_unused:UNUSED_PRESERVE src0_sel:WORD_1
v_lshrrev_b32_e64 v181, 18, v181
v_exp_f16_sdwa v150, v151 dst_sel:WORD_1 dst_unused:UNUSED_PRESERVE src0_sel:WORD_1
v_fma_mix_f32 v162, v139, v139, v162 op_sel:[1,1,0] op_sel_hi:[1,1,0]
v_and_b32_e64 v183, s49, v183
v_mfma_f32_32x32x16_bf16 v[120:135], v[84:87], v[232:235], v[120:135]
ds_read_b128 v[228:231], v249 offset:6144
ds_read_u16_d16_hi v181, v181
v_exp_f16_sdwa v147, v148 dst_sel:WORD_1 dst_unused:UNUSED_PRESERVE src0_sel:WORD_1
v_pk_add_f16 v153, v153, 1.0 op_sel_hi:[1,0]
v_bfe_u32 v182, v183, 2, 14
v_pk_add_f16 v150, v150, 1.0 op_sel_hi:[1,0]
v_pk_add_f16 v147, v147, 1.0 op_sel_hi:[1,0]
v_rcp_f16_e64 v154, v153
v_lshrrev_b32 v183, 18, v183
v_fma_mix_f32 v162, v140, v140, v162 op_sel:[0,0,0] op_sel_hi:[1,1,0]
s_waitcnt lgkmcnt(6)
v_mfma_f32_32x32x16_bf16 v[120:135], v[88:91], v[236:239], v[120:135]
ds_read_b128 v[232:235], v249 offset:9216
ds_read_u16_d16 v182, v182
ds_read_u16_d16_hi v183, v183
v_rcp_f16 v151, v150
v_and_b32 v185, s49, v185
v_rcp_f16_e64 v148, v147
v_fma_mix_f32 v162, v141, v141, v162 op_sel:[1,1,0] op_sel_hi:[1,1,0]
v_bfe_u32 v184, v185, 2, 14
v_rcp_f16_sdwa v154, v153 dst_sel:WORD_1 dst_unused:UNUSED_PRESERVE src0_sel:WORD_1
v_mfma_f32_32x32x16_bf16 v[120:135], v[92:95], v[216:219], v[120:135]
ds_read_b128 v[236:239], v249 offset:7168
ds_read_u16_d16 v184, v184
v_rcp_f16_sdwa v151, v150 dst_sel:WORD_1 dst_unused:UNUSED_PRESERVE src0_sel:WORD_1
v_lshrrev_b32_e64 v185, 18, v185
v_rcp_f16_sdwa v148, v147 dst_sel:WORD_1 dst_unused:UNUSED_PRESERVE src0_sel:WORD_1
v_and_b32_e64 v187, s49, v187
v_fma_mix_f32 v162, v142, v142, v162 op_sel:[0,0,0] op_sel_hi:[1,1,0]
v_pk_mul_f16 v155, v155, v154
v_pk_mul_f16 v152, v152, v151
v_smfmac_f32_16x16x32_bf16 v[8:11], v[220:221], v[192:195], v246
ds_read_b128 v[216:219], v249 offset:10240
ds_read_u16_d16_hi v185, v185
v_bfe_u32 v186, v187, 2, 14
v_pk_mul_f16 v149, v149, v148
v_fma_mix_f32 v163, v155, v155, v163 op_sel:[0,0,0] op_sel_hi:[1,1,0]
v_fma_mix_f32 v162, v143, v143, v162 op_sel:[1,1,0] op_sel_hi:[1,1,0]
v_lshrrev_b32_e64 v187, 18, v187
v_smfmac_f32_16x16x32_bf16 v[24:27], v[222:223], v[196:199], v246
v_fma_mix_f32 v163, v155, v155, v163 op_sel:[1,1,0] op_sel_hi:[1,1,0]
v_fma_mix_f32 v163, v152, v152, v163 op_sel:[0,0,0] op_sel_hi:[1,1,0]
v_fma_mix_f32 v163, v152, v152, v163 op_sel:[1,1,0] op_sel_hi:[1,1,0]
v_fma_mix_f32 v163, v149, v149, v163 op_sel:[0,0,0] op_sel_hi:[1,1,0]
v_fma_mix_f32 v163, v149, v149, v163 op_sel:[1,1,0] op_sel_hi:[1,1,0]
v_lshlrev_b32 v252, 7, v251
s_add_u32 s46, s47, 2359296
s_mov_b32 exec_lo, 0
s_mov_b32 exec_hi, 1048572
s_mov_b32 m0, 16152
s_nop 0
buffer_load_dword v252, s[4:7], s46 offen lds
s_mov_b64 exec, -1
s_setprio 1
s_waitcnt lgkmcnt(2)
v_smfmac_f32_16x16x32_bf16 v[40:43], v[224:225], v[200:203], v246
ds_read_b128 v[220:223], v249 offset:8192
ds_read_u16_d16 v186, v186
ds_read_u16_d16_hi v187, v187
v_cvt_pkrtz_f16_f32 v137, v120, v121
v_cvt_pkrtz_f16_f32 v139, v122, v123
v_cvt_pkrtz_f16_f32 v141, v124, v125
v_cvt_pkrtz_f16_f32 v143, v126, v127
v_smfmac_f32_16x16x32_bf16 v[8:11], v[226:227], v[204:207], v246
v_cvt_pk_f16_f32 v155, v128, v129
v_cvt_pk_f16_f32 v152, v130, v131
v_cvt_pk_f16_f32 v149, v132, v133
v_cvt_pk_f16_f32 v146, v134, v135
v_pk_fma_f16 v154, v155, v155, s48
v_mfma_f32_32x32x16_bf16 v[120:135], v[72:75], v[228:231], 0
ds_read_b128 v[224:227], v249 offset:11264
v_and_b32_e64 v137, s49, v137
v_fma_mix_f32 v163, v178, v178, v163 op_sel:[0,0,0] op_sel_hi:[1,1,0]
v_pk_fma_f16 v151, v152, v152, s48
v_pk_fma_f16 v148, v149, v149, s48
v_pk_fma_f16 v145, v146, v146, s48
v_pk_mul_f16 v154, v155, v154
v_bfe_u32 v136, v137, 2, 14
v_pk_mul_f16 v151, v152, v151
v_fma_mix_f32 v163, v179, v179, v163 op_sel:[1,1,0] op_sel_hi:[1,1,0]
v_pk_mul_f16 v148, v149, v148
v_mfma_f32_32x32x16_bf16 v[120:135], v[76:79], v[232:235], v[120:135]
ds_read_b128 v[228:231], v245 offset:6528
ds_read_b128 v[208:211], v244 offset:64
ds_read_b128 v[212:215], v244 offset:128
ds_read_u16_d16 v136, v136
v_pk_mul_f16 v145, v146, v145
v_exp_f16 v153, v154
v_lshrrev_b32 v137, 18, v137
v_exp_f16_e64 v150, v151
v_fma_mix_f32 v163, v180, v180, v163 op_sel:[0,0,0] op_sel_hi:[1,1,0]
v_exp_f16 v147, v148
v_and_b32 v139, s49, v139
v_mfma_f32_32x32x16_bf16 v[120:135], v[80:83], v[236:239], v[120:135]
ds_read_b128 v[232:235], v249 offset:12288
ds_read_u16_d16_hi v137, v137
v_exp_f16_e64 v144, v145
v_exp_f16_sdwa v153, v154 dst_sel:WORD_1 dst_unused:UNUSED_PRESERVE src0_sel:WORD_1
v_fma_mix_f32 v163, v181, v181, v163 op_sel:[1,1,0] op_sel_hi:[1,1,0]
v_bfe_u32 v138, v139, 2, 14
v_exp_f16_sdwa v150, v151 dst_sel:WORD_1 dst_unused:UNUSED_PRESERVE src0_sel:WORD_1
v_exp_f16_sdwa v147, v148 dst_sel:WORD_1 dst_unused:UNUSED_PRESERVE src0_sel:WORD_1
s_waitcnt lgkmcnt(6)
v_mfma_f32_32x32x16_bf16 v[120:135], v[84:87], v[216:219], v[120:135]
ds_read_b128 v[236:239], v249 offset:15360
ds_read_u16_d16 v138, v138
v_exp_f16_sdwa v144, v145 dst_sel:WORD_1 dst_unused:UNUSED_PRESERVE src0_sel:WORD_1
v_lshrrev_b32 v139, 18, v139
v_fma_mix_f32 v163, v182, v182, v163 op_sel:[0,0,0] op_sel_hi:[1,1,0]
v_pk_add_f16 v153, v153, 1.0 op_sel_hi:[1,0]
v_pk_add_f16 v150, v150, 1.0 op_sel_hi:[1,0]
v_pk_add_f16 v147, v147, 1.0 op_sel_hi:[1,0]
v_and_b32_e64 v141, s49, v141
v_pk_add_f16 v144, v144, 1.0 op_sel_hi:[1,0]
v_mfma_f32_32x32x16_bf16 v[120:135], v[88:91], v[220:223], v[120:135]
ds_read_b128 v[216:219], v249 offset:13312
ds_read_u16_d16_hi v139, v139
v_rcp_f16_e64 v154, v153
v_fma_mix_f32 v163, v183, v183, v163 op_sel:[1,1,0] op_sel_hi:[1,1,0]
v_rcp_f16_e64 v151, v150
v_bfe_u32 v140, v141, 2, 14
v_rcp_f16_e64 v148, v147
v_fma_mix_f32 v163, v184, v184, v163 op_sel:[0,0,0] op_sel_hi:[1,1,0]
v_mfma_f32_32x32x16_bf16 v[120:135], v[92:95], v[224:227], v[120:135]
ds_read_b128 v[220:223], v249 offset:16384
ds_read_u16_d16 v140, v140
v_rcp_f16_e64 v145, v144
v_lshrrev_b32 v141, 18, v141
v_rcp_f16_sdwa v154, v153 dst_sel:WORD_1 dst_unused:UNUSED_PRESERVE src0_sel:WORD_1
s_setprio 0
v_rcp_f16_sdwa v151, v150 dst_sel:WORD_1 dst_unused:UNUSED_PRESERVE src0_sel:WORD_1
v_fma_mix_f32 v163, v185, v185, v163 op_sel:[1,1,0] op_sel_hi:[1,1,0]
v_and_b32 v143, s49, v143
v_rcp_f16_sdwa v148, v147 dst_sel:WORD_1 dst_unused:UNUSED_PRESERVE src0_sel:WORD_1
s_waitcnt lgkmcnt(4)
v_smfmac_f32_16x16x32_bf16 v[24:27], v[228:229], v[208:211], v246
ds_read_b128 v[224:227], v249 offset:14336
ds_read_u16_d16_hi v141, v141
v_rcp_f16_sdwa v145, v144 dst_sel:WORD_1 dst_unused:UNUSED_PRESERVE src0_sel:WORD_1
v_pk_mul_f16 v155, v155, v154
v_bfe_u32 v142, v143, 2, 14
v_fma_mix_f32 v163, v186, v186, v163 op_sel:[0,0,0] op_sel_hi:[1,1,0]
v_smfmac_f32_16x16x32_bf16 v[40:43], v[230:231], v[212:215], v246
s_mov_b64 exec, 1
ds_add_u32 v253, v254 offset:16
s_mov_b64 exec, -1
v_pk_mul_f16 v152, v152, v151
v_pk_mul_f16 v149, v149, v148
v_pk_mul_f16 v146, v146, v145
v_fma_mix_f32 v164, v155, v155, v164 op_sel:[0,0,0] op_sel_hi:[1,1,0]
v_lshrrev_b32 v143, 18, v143
v_fma_mix_f32 v164, v155, v155, v164 op_sel:[1,1,0] op_sel_hi:[1,1,0]
v_fma_mix_f32 v164, v152, v152, v164 op_sel:[0,0,0] op_sel_hi:[1,1,0]
v_fma_mix_f32 v163, v187, v187, v163 op_sel:[1,1,0] op_sel_hi:[1,1,0]
v_fma_mix_f32 v164, v152, v152, v164 op_sel:[1,1,0] op_sel_hi:[1,1,0]
v_fma_mix_f32 v164, v149, v149, v164 op_sel:[0,0,0] op_sel_hi:[1,1,0]
v_fma_mix_f32 v164, v149, v149, v164 op_sel:[1,1,0] op_sel_hi:[1,1,0]
v_fma_mix_f32 v164, v146, v146, v164 op_sel:[0,0,0] op_sel_hi:[1,1,0]
v_fma_mix_f32 v164, v146, v146, v164 op_sel:[1,1,0] op_sel_hi:[1,1,0]
s_setprio 3
v_pk_add_f32 v[168:169], v[0:1], v[2:3]
v_pk_mul_f32 v[170:171], v[0:1], v[0:1]
v_pk_fma_f32 v[170:171], v[2:3], v[2:3], v[170:171]
v_pk_add_f32 v[168:169], v[168:169], v[4:5]
v_pk_fma_f32 v[170:171], v[4:5], v[4:5], v[170:171]
v_pk_add_f32 v[168:169], v[168:169], v[6:7]
v_pk_fma_f32 v[170:171], v[6:7], v[6:7], v[170:171]
v_pk_add_f32 v[168:169], v[168:169], v[8:9]
v_pk_fma_f32 v[170:171], v[8:9], v[8:9], v[170:171]
v_pk_add_f32 v[168:169], v[168:169], v[10:11]
v_pk_fma_f32 v[170:171], v[10:11], v[10:11], v[170:171]
v_pk_add_f32 v[168:169], v[168:169], v[12:13]
v_pk_fma_f32 v[170:171], v[12:13], v[12:13], v[170:171]
v_pk_add_f32 v[168:169], v[168:169], v[14:15]
v_pk_fma_f32 v[170:171], v[14:15], v[14:15], v[170:171]
v_pk_add_f32 v[168:169], v[168:169], v[16:17]
v_pk_fma_f32 v[170:171], v[16:17], v[16:17], v[170:171]
v_pk_add_f32 v[168:169], v[168:169], v[18:19]
v_pk_fma_f32 v[170:171], v[18:19], v[18:19], v[170:171]
v_pk_add_f32 v[168:169], v[168:169], v[20:21]
v_pk_fma_f32 v[170:171], v[20:21], v[20:21], v[170:171]
v_pk_add_f32 v[168:169], v[168:169], v[22:23]
v_pk_fma_f32 v[170:171], v[22:23], v[22:23], v[170:171]
v_pk_add_f32 v[168:169], v[168:169], v[24:25]
v_pk_fma_f32 v[170:171], v[24:25], v[24:25], v[170:171]
v_pk_add_f32 v[168:169], v[168:169], v[26:27]
v_pk_fma_f32 v[170:171], v[26:27], v[26:27], v[170:171]
v_pk_add_f32 v[168:169], v[168:169], v[28:29]
v_pk_fma_f32 v[170:171], v[28:29], v[28:29], v[170:171]
v_pk_add_f32 v[168:169], v[168:169], v[30:31]
v_pk_fma_f32 v[170:171], v[30:31], v[30:31], v[170:171]
v_pk_add_f32 v[168:169], v[168:169], v[32:33]
v_pk_fma_f32 v[170:171], v[32:33], v[32:33], v[170:171]
v_pk_add_f32 v[168:169], v[168:169], v[34:35]
v_pk_fma_f32 v[170:171], v[34:35], v[34:35], v[170:171]
v_pk_add_f32 v[168:169], v[168:169], v[36:37]
v_pk_fma_f32 v[170:171], v[36:37], v[36:37], v[170:171]
v_pk_add_f32 v[168:169], v[168:169], v[38:39]
v_pk_fma_f32 v[170:171], v[38:39], v[38:39], v[170:171]
v_pk_add_f32 v[168:169], v[168:169], v[40:41]
v_pk_fma_f32 v[170:171], v[40:41], v[40:41], v[170:171]
v_pk_add_f32 v[168:169], v[168:169], v[42:43]
v_pk_fma_f32 v[170:171], v[42:43], v[42:43], v[170:171]
v_pk_add_f32 v[168:169], v[168:169], v[44:45]
v_pk_fma_f32 v[170:171], v[44:45], v[44:45], v[170:171]
v_pk_add_f32 v[168:169], v[168:169], v[46:47]
v_pk_fma_f32 v[170:171], v[46:47], v[46:47], v[170:171]
s_setprio 0
v_add_u32 v174, -36864, v242
v_subrev_u32 v175, 66560, v174
v_min_u32 v174, v174, v175
v_add_u32 v174, 90112, v174
v_sub_u32 v175, v174, v242
v_add_u32 v242, v175, v242
v_add_u32_e64 v243, v175, v243
v_add_u32 v244, v175, v244
s_setprio 2
v_cvt_pkrtz_f16_f32 v179, v120, v121
v_cvt_pkrtz_f16_f32 v181, v122, v123
v_cvt_pkrtz_f16_f32 v183, v124, v125
v_cvt_pkrtz_f16_f32 v185, v126, v127
v_cvt_pkrtz_f16_f32 v187, v128, v129
v_cvt_pkrtz_f16_f32 v189, v130, v131
v_cvt_pk_f16_f32 v155, v132, v133
v_cvt_pk_f16_f32 v152, v134, v135
ds_read_b128 v[228:231], v249 offset:17408
ds_read_u16_d16 v142, v142
ds_read_u16_d16_hi v143, v143
v_mfma_f32_32x32x16_bf16 v[120:135], v[72:75], v[232:235], 0
v_pk_fma_f16 v154, v155, v155, s48
v_add_f32 v168, v168, v169
v_and_b32 v179, s49, v179
v_fma_mix_f32 v164, v136, v136, v164 op_sel:[0,0,0] op_sel_hi:[1,1,0]
v_bfe_u32 v178, v179, 2, 14
v_add_f32_e64 v170, v170, v171
v_pk_fma_f16 v151, v152, v152, s48
v_pk_mul_f16 v154, v155, v154
v_lshrrev_b32_e64 v179, 18, v179
v_pk_mul_f16 v151, v152, v151
ds_read_b128 v[232:235], v249 offset:18432
ds_read_u16_d16 v178, v178
ds_read_u16_d16_hi v179, v179
v_mfma_f32_32x32x16_bf16 v[120:135], v[76:79], v[236:239], v[120:135]
v_permlane32_swap_b32 v168, v170
v_fma_mix_f32 v164, v137, v137, v164 op_sel:[1,1,0] op_sel_hi:[1,1,0]
v_and_b32 v181, s49, v181
v_exp_f16 v153, v154
v_add_f32 v168, v168, v170
v_bfe_u32 v180, v181, 2, 14
v_exp_f16_e64 v150, v151
v_lshrrev_b32 v181, 18, v181
s_waitcnt lgkmcnt(7)
ds_read_b128 v[236:239], v249 offset:21504
ds_read_u16_d16 v180, v180
ds_read_u16_d16_hi v181, v181
v_mfma_f32_32x32x16_bf16 v[120:135], v[80:83], v[216:219], v[120:135]
v_mul_f32 v168, 1009429163, v168
v_fma_mix_f32 v164, v138, v138, v164 op_sel:[0,0,0] op_sel_hi:[1,1,0]
v_exp_f16_sdwa v153, v154 dst_sel:WORD_1 dst_unused:UNUSED_PRESERVE src0_sel:WORD_1
v_and_b32 v183, s49, v183
v_mov_b32 v170, v168
v_exp_f16_sdwa v150, v151 dst_sel:WORD_1 dst_unused:UNUSED_PRESERVE src0_sel:WORD_1
v_bfe_u32 v182, v183, 2, 14
v_fma_mix_f32 v164, v139, v139, v164 op_sel:[1,1,0] op_sel_hi:[1,1,0]
v_permlane32_swap_b32 v168, v170
ds_read_b128 v[216:219], v249 offset:19456
ds_read_u16_d16 v182, v182
v_mfma_f32_32x32x16_bf16 v[120:135], v[84:87], v[220:223], v[120:135]
v_lshrrev_b32 v183, 18, v183
v_pk_add_f16 v153, v153, 1.0 op_sel_hi:[1,0]
v_pk_add_f16 v150, v150, 1.0 op_sel_hi:[1,0]
v_and_b32_e64 v185, s49, v185
v_fma_f32 v170, -v168, v168, v170
v_rcp_f16_e64 v154, v153
v_bfe_u32 v184, v185, 2, 14
v_max_f32_e64 v170, 0, v170
v_fma_mix_f32 v164, v140, v140, v164 op_sel:[0,0,0] op_sel_hi:[1,1,0]
ds_read_b128 v[220:223], v249 offset:22528
ds_read_u16_d16_hi v183, v183
ds_read_u16_d16 v184, v184
v_mfma_f32_32x32x16_bf16 v[120:135], v[88:91], v[224:227], v[120:135]
v_lshrrev_b32 v185, 18, v185
v_rcp_f16 v151, v150
v_add_f32 v170, 925353388, v170
v_and_b32_e64 v187, s49, v187
v_fma_mix_f32 v164, v141, v141, v164 op_sel:[1,1,0] op_sel_hi:[1,1,0]
v_rcp_f16_sdwa v154, v153 dst_sel:WORD_1 dst_unused:UNUSED_PRESERVE src0_sel:WORD_1
v_rsq_f32 v170, v170
s_waitcnt lgkmcnt(5)
ds_read_b128 v[224:227], v249 offset:20480
ds_read_u16_d16_hi v185, v185
ds_read_b32 v247, v253 offset:16
v_mfma_f32_32x32x16_bf16 v[120:135], v[92:95], v[228:231], v[120:135]
v_bfe_u32 v186, v187, 2, 14
v_rcp_f16_sdwa v151, v150 dst_sel:WORD_1 dst_unused:UNUSED_PRESERVE src0_sel:WORD_1
v_lshrrev_b32_e64 v187, 18, v187
v_fma_mix_f32 v164, v142, v142, v164 op_sel:[0,0,0] op_sel_hi:[1,1,0]
v_and_b32_e64 v189, s49, v189
v_pk_mul_f16 v155, v155, v154
v_pk_mul_f16 v152, v152, v151
v_mul_f32 v172, 3203391086, v170
v_bfe_u32 v188, v189, 2, 14
v_fma_mix_f32 v165, v155, v155, v165 op_sel:[0,0,0] op_sel_hi:[1,1,0]
v_fma_mix_f32 v164, v143, v143, v164 op_sel:[1,1,0] op_sel_hi:[1,1,0]
v_lshrrev_b32_e64 v189, 18, v189
v_mul_f32 v173, v168, v172
v_fma_mix_f32 v165, v155, v155, v165 op_sel:[1,1,0] op_sel_hi:[1,1,0]
v_fma_mix_f32 v165, v152, v152, v165 op_sel:[0,0,0] op_sel_hi:[1,1,0]
v_fma_mix_f32 v165, v152, v152, v165 op_sel:[1,1,0] op_sel_hi:[1,1,0]
s_setprio 3
v_pk_fma_f32 v[0:1], v[0:1], v[172:173], v[172:173] op_sel:[0,0,1] op_sel_hi:[1,0,1] neg_lo:[0,0,1] neg_hi:[0,0,1]
v_pk_fma_f32 v[2:3], v[2:3], v[172:173], v[172:173] op_sel:[0,0,1] op_sel_hi:[1,0,1] neg_lo:[0,0,1] neg_hi:[0,0,1]
v_pk_fma_f32 v[4:5], v[4:5], v[172:173], v[172:173] op_sel:[0,0,1] op_sel_hi:[1,0,1] neg_lo:[0,0,1] neg_hi:[0,0,1]
v_pk_fma_f32 v[6:7], v[6:7], v[172:173], v[172:173] op_sel:[0,0,1] op_sel_hi:[1,0,1] neg_lo:[0,0,1] neg_hi:[0,0,1]
v_pk_fma_f32 v[8:9], v[8:9], v[172:173], v[172:173] op_sel:[0,0,1] op_sel_hi:[1,0,1] neg_lo:[0,0,1] neg_hi:[0,0,1]
v_pk_fma_f32 v[10:11], v[10:11], v[172:173], v[172:173] op_sel:[0,0,1] op_sel_hi:[1,0,1] neg_lo:[0,0,1] neg_hi:[0,0,1]
v_pk_fma_f32 v[12:13], v[12:13], v[172:173], v[172:173] op_sel:[0,0,1] op_sel_hi:[1,0,1] neg_lo:[0,0,1] neg_hi:[0,0,1]
v_pk_fma_f32 v[14:15], v[14:15], v[172:173], v[172:173] op_sel:[0,0,1] op_sel_hi:[1,0,1] neg_lo:[0,0,1] neg_hi:[0,0,1]
v_pk_fma_f32 v[16:17], v[16:17], v[172:173], v[172:173] op_sel:[0,0,1] op_sel_hi:[1,0,1] neg_lo:[0,0,1] neg_hi:[0,0,1]
v_pk_fma_f32 v[18:19], v[18:19], v[172:173], v[172:173] op_sel:[0,0,1] op_sel_hi:[1,0,1] neg_lo:[0,0,1] neg_hi:[0,0,1]
v_pk_fma_f32 v[20:21], v[20:21], v[172:173], v[172:173] op_sel:[0,0,1] op_sel_hi:[1,0,1] neg_lo:[0,0,1] neg_hi:[0,0,1]
v_pk_fma_f32 v[22:23], v[22:23], v[172:173], v[172:173] op_sel:[0,0,1] op_sel_hi:[1,0,1] neg_lo:[0,0,1] neg_hi:[0,0,1]
v_pk_fma_f32 v[24:25], v[24:25], v[172:173], v[172:173] op_sel:[0,0,1] op_sel_hi:[1,0,1] neg_lo:[0,0,1] neg_hi:[0,0,1]
v_pk_fma_f32 v[26:27], v[26:27], v[172:173], v[172:173] op_sel:[0,0,1] op_sel_hi:[1,0,1] neg_lo:[0,0,1] neg_hi:[0,0,1]
v_pk_fma_f32 v[28:29], v[28:29], v[172:173], v[172:173] op_sel:[0,0,1] op_sel_hi:[1,0,1] neg_lo:[0,0,1] neg_hi:[0,0,1]
v_pk_fma_f32 v[30:31], v[30:31], v[172:173], v[172:173] op_sel:[0,0,1] op_sel_hi:[1,0,1] neg_lo:[0,0,1] neg_hi:[0,0,1]
v_pk_fma_f32 v[32:33], v[32:33], v[172:173], v[172:173] op_sel:[0,0,1] op_sel_hi:[1,0,1] neg_lo:[0,0,1] neg_hi:[0,0,1]
v_pk_fma_f32 v[34:35], v[34:35], v[172:173], v[172:173] op_sel:[0,0,1] op_sel_hi:[1,0,1] neg_lo:[0,0,1] neg_hi:[0,0,1]
v_pk_fma_f32 v[36:37], v[36:37], v[172:173], v[172:173] op_sel:[0,0,1] op_sel_hi:[1,0,1] neg_lo:[0,0,1] neg_hi:[0,0,1]
v_pk_fma_f32 v[38:39], v[38:39], v[172:173], v[172:173] op_sel:[0,0,1] op_sel_hi:[1,0,1] neg_lo:[0,0,1] neg_hi:[0,0,1]
v_pk_fma_f32 v[40:41], v[40:41], v[172:173], v[172:173] op_sel:[0,0,1] op_sel_hi:[1,0,1] neg_lo:[0,0,1] neg_hi:[0,0,1]
v_pk_fma_f32 v[42:43], v[42:43], v[172:173], v[172:173] op_sel:[0,0,1] op_sel_hi:[1,0,1] neg_lo:[0,0,1] neg_hi:[0,0,1]
v_pk_fma_f32 v[44:45], v[44:45], v[172:173], v[172:173] op_sel:[0,0,1] op_sel_hi:[1,0,1] neg_lo:[0,0,1] neg_hi:[0,0,1]
v_pk_fma_f32 v[46:47], v[46:47], v[172:173], v[172:173] op_sel:[0,0,1] op_sel_hi:[1,0,1] neg_lo:[0,0,1] neg_hi:[0,0,1]
s_setprio 2
ds_read_u16_d16 v186, v186
ds_read_u16_d16_hi v187, v187
ds_read_u16_d16 v188, v188
ds_read_u16_d16_hi v189, v189
s_waitcnt lgkmcnt(4)
v_readfirstlane_b32 s43, v247
s_nop 1
s_cmp_ge_u32 s43, 24
s_cbranch_scc1 Lev7
Lev7w:
s_sleep 1
ds_read_b32 v247, v253 offset:16
s_waitcnt lgkmcnt(0)
v_readfirstlane_b32 s43, v247
s_cmp_eq_u32 s76, 0
s_cbranch_scc1 Lev7
s_sub_u32 s76, s76, 1
s_cmp_lt_u32 s43, 24
s_cbranch_scc1 Lev7w
Lev7:
s_setprio 1
v_cvt_pkrtz_f16_f32 v137, v120, v121
v_cvt_pkrtz_f16_f32 v139, v122, v123
v_cvt_pkrtz_f16_f32 v141, v124, v125
v_cvt_pkrtz_f16_f32 v143, v126, v127
v_cvt_pkrtz_f16_f32 v177, v128, v129
v_cvt_pkrtz_f16_f32 v191, v130, v131
v_cvt_pk_f16_f32 v155, v132, v133
v_cvt_pk_f16_f32 v152, v134, v135
s_add_u32 m0, s67, 39936
s_add_u32 s66, s66, 98304
buffer_load_dwordx4 v240, s[4:7], s66 offen lds
ds_read_b128 v[228:231], v249 offset:23552
v_mfma_f32_32x32x16_bf16 v[120:135], v[72:75], v[232:235], 0
v_pk_fma_f16 v154, v155, v155, s48
v_cvt_pk_bf16_f32 v96, v0, v1
v_and_b32 v137, s49, v137
v_fma_mix_f32 v165, v178, v178, v165 op_sel:[0,0,0] op_sel_hi:[1,1,0]
v_cvt_pk_bf16_f32 v97, v2, v3
v_pk_fma_f16 v151, v152, v152, s48
v_bfe_u32 v136, v137, 2, 14
v_cvt_pk_bf16_f32 v98, v4, v5
v_pk_mul_f16 v154, v155, v154
v_fma_mix_f32 v165, v179, v179, v165 op_sel:[1,1,0] op_sel_hi:[1,1,0]
v_lshrrev_b32_e64 v137, 18, v137
v_cvt_pk_bf16_f32 v99, v6, v7
s_add_u32 m0, s67, 46592
s_add_u32 s66, s66, 98304
buffer_load_dwordx4 v240, s[4:7], s66 offen lds
ds_read_b128 v[232:235], v248 offset:16384
ds_read_u16_d16 v136, v136
ds_read_u16_d16_hi v137, v137
v_mfma_f32_32x32x16_bf16 v[120:135], v[76:79], v[236:239], v[120:135]
v_pk_mul_f16 v151, v152, v151
v_exp_f16_e64 v153, v154
v_cvt_pk_bf16_f32 v100, v8, v9
v_and_b32_e64 v139, s49, v139
v_fma_mix_f32 v165, v180, v180, v165 op_sel:[0,0,0] op_sel_hi:[1,1,0]
v_cvt_pk_bf16_f32 v101, v10, v11
v_bfe_u32 v138, v139, 2, 14
v_exp_f16_e64 v150, v151
v_cvt_pk_bf16_f32 v102, v12, v13
v_lshrrev_b32_e64 v139, 18, v139
v_cvt_pk_bf16_f32 v103, v14, v15
s_add_u32 m0, s67, 53248
s_add_u32 s66, s66, 98304
buffer_load_dwordx4 v240, s[4:7], s66 offen lds
ds_read_b128 v[236:239], v248 offset:19456
ds_read_u16_d16 v138, v138
ds_read_u16_d16_hi v139, v139
v_mfma_f32_32x32x16_bf16 v[120:135], v[80:83], v[216:219], v[120:135]
v_fma_mix_f32 v165, v181, v181, v165 op_sel:[1,1,0] op_sel_hi:[1,1,0]
v_exp_f16_sdwa v153, v154 dst_sel:WORD_1 dst_unused:UNUSED_PRESERVE src0_sel:WORD_1
v_cvt_pk_bf16_f32 v104, v16, v17
v_and_b32_e64 v141, s49, v141
v_fma_mix_f32 v165, v182, v182, v165 op_sel:[0,0,0] op_sel_hi:[1,1,0]
v_cvt_pk_bf16_f32 v105, v18, v19
v_bfe_u32 v140, v141, 2, 14
v_exp_f16_sdwa v150, v151 dst_sel:WORD_1 dst_unused:UNUSED_PRESERVE src0_sel:WORD_1
v_cvt_pk_bf16_f32 v106, v20, v21
v_lshrrev_b32 v141, 18, v141
s_add_u32 m0, s67, 59904
s_add_u32 s66, s66, 98304
buffer_load_dwordx4 v240, s[4:7], s66 offen lds
s_add_u32 m0, s67, 0
s_add_u32 s66, s66, 98304
buffer_load_dwordx4 v240, s[4:7], s66 offen lds
ds_read_b128 v[216:219], v248 offset:17408
ds_read_u16_d16 v140, v140
ds_read_u16_d16_hi v141, v141
v_mfma_f32_32x32x16_bf16 v[120:135], v[84:87], v[220:223], v[120:135]
v_fma_mix_f32 v165, v183, v183, v165 op_sel:[1,1,0] op_sel_hi:[1,1,0]
v_cvt_pk_bf16_f32 v107, v22, v23
v_pk_add_f16 v153, v153, 1.0 op_sel_hi:[1,0]
v_pk_add_f16 v150, v150, 1.0 op_sel_hi:[1,0]
v_and_b32_e64 v143, s49, v143
v_cvt_pk_bf16_f32 v108, v24, v25
v_rcp_f16_e64 v154, v153
v_cvt_pk_bf16_f32 v109, v26, v27
v_bfe_u32 v142, v143, 2, 14
v_fma_mix_f32 v165, v184, v184, v165 op_sel:[0,0,0] op_sel_hi:[1,1,0]
v_cvt_pk_bf16_f32 v110, v28, v29
s_add_u32 m0, s67, 6656
s_add_u32 s66, s66, 98304
buffer_load_dwordx4 v240, s[4:7], s66 offen lds
ds_read_b128 v[220:223], v248 offset:20480
ds_read_u16_d16 v142, v142
v_mfma_f32_32x32x16_bf16 v[120:135], v[88:91], v[224:227], v[120:135]
v_rcp_f16 v151, v150
v_lshrrev_b32 v143, 18, v143
v_cvt_pk_bf16_f32 v111, v30, v31
v_fma_mix_f32 v165, v185, v185, v165 op_sel:[1,1,0] op_sel_hi:[1,1,0]
v_and_b32_e64 v177, s49, v177
s_setprio 0
v_cvt_pk_bf16_f32 v112, v32, v33
v_rcp_f16_sdwa v154, v153 dst_sel:WORD_1 dst_unused:UNUSED_PRESERVE src0_sel:WORD_1
v_bfe_u32 v176, v177, 2, 14
v_cvt_pk_bf16_f32 v113, v34, v35
s_waitcnt lgkmcnt(2)
v_fma_mix_f32 v165, v186, v186, v165 op_sel:[0,0,0] op_sel_hi:[1,1,0]
v_rcp_f16_sdwa v151, v150 dst_sel:WORD_1 dst_unused:UNUSED_PRESERVE src0_sel:WORD_1
s_add_u32 m0, s67, 13312
s_add_u32 s66, s66, 98304
buffer_load_dwordx4 v240, s[4:7], s66 offen lds
ds_read_b128 v[224:227], v248 offset:18432
ds_read_u16_d16_hi v143, v143
ds_read_u16_d16 v176, v176
v_mfma_f32_32x32x16_bf16 v[120:135], v[92:95], v[228:231], v[120:135]
v_cvt_pk_bf16_f32 v114, v36, v37
v_lshrrev_b32_e64 v177, 18, v177
v_cvt_pk_bf16_f32 v115, v38, v39
v_fma_mix_f32 v165, v187, v187, v165 op_sel:[1,1,0] op_sel_hi:[1,1,0]
v_and_b32_e64 v191, s49, v191
v_pk_mul_f16 v155, v155, v154
v_cvt_pk_bf16_f32 v116, v40, v41
v_pk_mul_f16 v152, v152, v151
v_bfe_u32 v190, v191, 2, 14
v_cvt_pk_bf16_f32 v117, v42, v43
v_fma_mix_f32 v165, v188, v188, v165 op_sel:[0,0,0] op_sel_hi:[1,1,0]
v_fma_mix_f32 v166, v155, v155, v166 op_sel:[0,0,0] op_sel_hi:[1,1,0]
s_add_u32 m0, s67, 19968
s_add_u32 s66, s66, 98304
buffer_load_dwordx4 v240, s[4:7], s66 offen lds
v_lshrrev_b32 v191, 18, v191
v_cvt_pk_bf16_f32 v118, v44, v45
v_fma_mix_f32 v166, v155, v155, v166 op_sel:[1,1,0] op_sel_hi:[1,1,0]
v_fma_mix_f32 v165, v189, v189, v165 op_sel:[1,1,0] op_sel_hi:[1,1,0]
v_cvt_pk_bf16_f32 v119, v46, v47
v_fma_mix_f32 v166, v152, v152, v166 op_sel:[0,0,0] op_sel_hi:[1,1,0]
v_fma_mix_f32 v166, v152, v152, v166 op_sel:[1,1,0] op_sel_hi:[1,1,0]
s_setprio 2
v_cvt_pkrtz_f16_f32 v179, v120, v121
v_cvt_pkrtz_f16_f32 v181, v122, v123
v_cvt_pkrtz_f16_f32 v183, v124, v125
v_cvt_pkrtz_f16_f32 v185, v126, v127
v_cvt_pkrtz_f16_f32 v187, v128, v129
v_cvt_pk_f16_f32 v155, v130, v131
v_cvt_pk_f16_f32 v152, v132, v133
v_cvt_pk_f16_f32 v149, v134, v135
ds_read_b128 v[228:231], v248 offset:21504
ds_read_u16_d16_hi v177, v177
ds_read_u16_d16 v190, v190
ds_read_u16_d16_hi v191, v191
v_mfma_f32_32x32x16_bf16 v[120:135], v[96:99], v[232:235], 0
v_pk_fma_f16 v154, v155, v155, s48
v_and_b32_e64 v179, s49, v179
v_fma_mix_f32 v166, v136, v136, v166 op_sel:[0,0,0] op_sel_hi:[1,1,0]
v_pk_fma_f16 v151, v152, v152, s48
v_pk_fma_f16 v148, v149, v149, s48
v_bfe_u32 v178, v179, 2, 14
v_pk_mul_f16 v154, v155, v154
v_fma_mix_f32 v166, v137, v137, v166 op_sel:[1,1,0] op_sel_hi:[1,1,0]
v_pk_mul_f16 v151, v152, v151
v_lshrrev_b32_e64 v179, 18, v179
ds_read_b128 v[232:235], v248 offset:22528
ds_read_u16_d16 v178, v178
ds_read_u16_d16_hi v179, v179
v_mfma_f32_32x32x16_bf16 v[120:135], v[100:103], v[236:239], v[120:135]
v_pk_mul_f16 v148, v149, v148
v_exp_f16_e64 v153, v154
v_fma_mix_f32 v166, v138, v138, v166 op_sel:[0,0,0] op_sel_hi:[1,1,0]
v_and_b32 v181, s49, v181
v_exp_f16 v150, v151
v_exp_f16_e64 v147, v148
v_bfe_u32 v180, v181, 2, 14
v_fma_mix_f32 v166, v139, v139, v166 op_sel:[1,1,0] op_sel_hi:[1,1,0]
ds_read_b128 v[236:239], v248 offset:25600
ds_read_u16_d16 v180, v180
v_mfma_f32_32x32x16_bf16 v[120:135], v[104:107], v[216:219], v[120:135]
v_exp_f16_sdwa v153, v154 dst_sel:WORD_1 dst_unused:UNUSED_PRESERVE src0_sel:WORD_1
v_lshrrev_b32_e64 v181, 18, v181
v_exp_f16_sdwa v150, v151 dst_sel:WORD_1 dst_unused:UNUSED_PRESERVE src0_sel:WORD_1
v_fma_mix_f32 v166, v140, v140, v166 op_sel:[0,0,0] op_sel_hi:[1,1,0]
v_and_b32 v183, s49, v183
v_exp_f16_sdwa v147, v148 dst_sel:WORD_1 dst_unused:UNUSED_PRESERVE src0_sel:WORD_1
v_fma_mix_f32 v166, v141, v141, v166 op_sel:[1,1,0] op_sel_hi:[1,1,0]
s_waitcnt lgkmcnt(5)
ds_read_b128 v[216:219], v248 offset:23552
ds_read_u16_d16_hi v181, v181
v_mfma_f32_32x32x16_bf16 v[120:135], v[108:111], v[220:223], v[120:135]
v_pk_add_f16 v153, v153, 1.0 op_sel_hi:[1,0]
v_bfe_u32 v182, v183, 2, 14
v_pk_add_f16 v150, v150, 1.0 op_sel_hi:[1,0]
v_pk_add_f16 v147, v147, 1.0 op_sel_hi:[1,0]
v_rcp_f16 v154, v153
v_lshrrev_b32 v183, 18, v183
v_fma_mix_f32 v166, v142, v142, v166 op_sel:[0,0,0] op_sel_hi:[1,1,0]
v_rcp_f16 v151, v150
v_and_b32 v185, s49, v185
ds_read_b128 v[220:223], v248 offset:26624
ds_read_u16_d16 v182, v182
ds_read_u16_d16_hi v183, v183
v_mfma_f32_32x32x16_bf16 v[120:135], v[112:115], v[224:227], v[120:135]
v_fma_mix_f32 v166, v143, v143, v166 op_sel:[1,1,0] op_sel_hi:[1,1,0]
v_rcp_f16_e64 v148, v147
v_bfe_u32 v184, v185, 2, 14
v_rcp_f16_sdwa v154, v153 dst_sel:WORD_1 dst_unused:UNUSED_PRESERVE src0_sel:WORD_1
v_fma_mix_f32 v166, v176, v176, v166 op_sel:[0,0,0] op_sel_hi:[1,1,0]
v_rcp_f16_sdwa v151, v150 dst_sel:WORD_1 dst_unused:UNUSED_PRESERVE src0_sel:WORD_1
v_lshrrev_b32_e64 v185, 18, v185
ds_read_b128 v[224:227], v248 offset:24576
ds_read_u16_d16 v184, v184
ds_read_u16_d16_hi v185, v185
v_mfma_f32_32x32x16_bf16 v[120:135], v[116:119], v[228:231], v[120:135]
v_rcp_f16_sdwa v148, v147 dst_sel:WORD_1 dst_unused:UNUSED_PRESERVE src0_sel:WORD_1
s_cmp_eq_u32 s40, 7
s_cbranch_scc1 Lrdy24
s_waitcnt vmcnt(0)
Lrdy24:
s_mov_b64 exec, 1
ds_add_u32 v253, v254 offset:12
s_mov_b64 exec, -1
v_and_b32 v187, s49, v187
v_fma_mix_f32 v166, v177, v177, v166 op_sel:[1,1,0] op_sel_hi:[1,1,0]
v_pk_mul_f16 v155, v155, v154
v_pk_mul_f16 v152, v152, v151
v_pk_mul_f16 v149, v149, v148
v_bfe_u32 v186, v187, 2, 14
v_fma_mix_f32 v166, v190, v190, v166 op_sel:[0,0,0] op_sel_hi:[1,1,0]
v_fma_mix_f32 v167, v155, v155, v167 op_sel:[0,0,0] op_sel_hi:[1,1,0]
v_fma_mix_f32 v167, v155, v155, v167 op_sel:[1,1,0] op_sel_hi:[1,1,0]
v_lshrrev_b32_e64 v187, 18, v187
v_fma_mix_f32 v167, v152, v152, v167 op_sel:[0,0,0] op_sel_hi:[1,1,0]
v_fma_mix_f32 v166, v191, v191, v166 op_sel:[1,1,0] op_sel_hi:[1,1,0]
v_fma_mix_f32 v167, v152, v152, v167 op_sel:[1,1,0] op_sel_hi:[1,1,0]
v_fma_mix_f32 v167, v149, v149, v167 op_sel:[0,0,0] op_sel_hi:[1,1,0]
v_fma_mix_f32 v167, v149, v149, v167 op_sel:[1,1,0] op_sel_hi:[1,1,0]
s_cmp_lg_u32 s40, 7
s_cbranch_scc1 Lnoinit
s_waitcnt vmcnt(11)
v_mov_b32_e64 v255, 1
s_mov_b64 exec, 1
buffer_atomic_add v255, v241, s[36:39], 0 offen
s_mov_b64 exec, -1
Lnoinit:
s_setprio 1
v_cvt_pkrtz_f16_f32 v137, v120, v121
v_cvt_pkrtz_f16_f32 v139, v122, v123
v_cvt_pkrtz_f16_f32 v141, v124, v125
v_cvt_pkrtz_f16_f32 v143, v126, v127
v_cvt_pkrtz_f16_f32 v177, v128, v129
v_cvt_pk_f16_f32 v155, v130, v131
v_cvt_pk_f16_f32 v152, v132, v133
v_cvt_pk_f16_f32 v149, v134, v135
s_waitcnt lgkmcnt(1)
s_add_u32 s46, s80, 12582912
buffer_store_dwordx4 v[72:75], v241, s[32:35], s46 offen sc1
ds_read_b128 v[228:231], v248 offset:27648
ds_read_u16_d16 v186, v186
ds_read_u16_d16_hi v187, v187
v_mfma_f32_32x32x16_bf16 v[120:135], v[96:99], v[232:235], 0
v_pk_fma_f16 v154, v155, v155, s48
v_and_b32 v137, s49, v137
v_fma_mix_f32 v167, v178, v178, v167 op_sel:[0,0,0] op_sel_hi:[1,1,0]
v_pk_fma_f16 v151, v152, v152, s48
v_pk_fma_f16 v148, v149, v149, s48
v_bfe_u32 v136, v137, 2, 14
v_pk_mul_f16 v154, v155, v154
v_pk_mul_f16 v151, v152, v151
v_fma_mix_f32 v167, v179, v179, v167 op_sel:[1,1,0] op_sel_hi:[1,1,0]
v_lshrrev_b32_e64 v137, 18, v137
ds_read_b128 v[232:235], v250 offset:65520
ds_read_u16_d16 v136, v136
ds_read_u16_d16_hi v137, v137
v_mfma_f32_32x32x16_bf16 v[120:135], v[100:103], v[236:239], v[120:135]
v_pk_mul_f16 v148, v149, v148
v_exp_f16 v153, v154
v_exp_f16 v150, v151
v_and_b32_e64 v139, s49, v139
v_fma_mix_f32 v167, v180, v180, v167 op_sel:[0,0,0] op_sel_hi:[1,1,0]
v_exp_f16_e64 v147, v148
v_bfe_u32 v138, v139, 2, 14
ds_read_b128 v[236:239], v248 offset:28672
ds_read_b32 v247, v253 offset:12
ds_read_u16_d16 v138, v138
v_mfma_f32_32x32x16_bf16 v[120:135], v[104:107], v[216:219], v[120:135]
v_exp_f16_sdwa v153, v154 dst_sel:WORD_1 dst_unused:UNUSED_PRESERVE src0_sel:WORD_1
v_lshrrev_b32_e64 v139, 18, v139
v_fma_mix_f32 v167, v181, v181, v167 op_sel:[1,1,0] op_sel_hi:[1,1,0]
v_exp_f16_sdwa v150, v151 dst_sel:WORD_1 dst_unused:UNUSED_PRESERVE src0_sel:WORD_1
v_exp_f16_sdwa v147, v148 dst_sel:WORD_1 dst_unused:UNUSED_PRESERVE src0_sel:WORD_1
v_and_b32_e64 v141, s49, v141
v_fma_mix_f32 v167, v182, v182, v167 op_sel:[0,0,0] op_sel_hi:[1,1,0]
ds_read_b128 v[216:219], v248 offset:31744
ds_read_u16_d16_hi v139, v139
v_mfma_f32_32x32x16_bf16 v[120:135], v[108:111], v[220:223], v[120:135]
v_pk_add_f16 v153, v153, 1.0 op_sel_hi:[1,0]
v_bfe_u32 v140, v141, 2, 14
v_pk_add_f16 v150, v150, 1.0 op_sel_hi:[1,0]
v_pk_add_f16 v147, v147, 1.0 op_sel_hi:[1,0]
v_rcp_f16 v154, v153
v_lshrrev_b32 v141, 18, v141
v_fma_mix_f32 v167, v183, v183, v167 op_sel:[1,1,0] op_sel_hi:[1,1,0]
ds_read_u16_d16 v140, v140
ds_read_u16_d16_hi v141, v141
s_waitcnt lgkmcnt(5)
v_readfirstlane_b32 s43, v247
s_nop 1
s_cmp_ge_u32 s43, 32
s_cbranch_scc1 Lev8
Lev8w:
s_sleep 1
ds_read_b32 v247, v253 offset:12
s_waitcnt lgkmcnt(0)
v_readfirstlane_b32 s43, v247
s_cmp_eq_u32 s76, 0
s_cbranch_scc1 Lev8
s_sub_u32 s76, s76, 1
s_cmp_lt_u32 s43, 32
s_cbranch_scc1 Lev8w
Lev8:
v_rcp_f16 v151, v150
ds_read_b128 v[220:223], v248 offset:29696
v_mfma_f32_32x32x16_bf16 v[120:135], v[112:115], v[224:227], v[120:135]
v_and_b32 v143, s49, v143
v_rcp_f16 v148, v147
v_fma_mix_f32 v167, v184, v184, v167 op_sel:[0,0,0] op_sel_hi:[1,1,0]
v_bfe_u32 v142, v143, 2, 14
s_setprio 0
v_rcp_f16_sdwa v154, v153 dst_sel:WORD_1 dst_unused:UNUSED_PRESERVE src0_sel:WORD_1
v_rcp_f16_sdwa v151, v150 dst_sel:WORD_1 dst_unused:UNUSED_PRESERVE src0_sel:WORD_1
v_lshrrev_b32 v143, 18, v143
ds_read_b128 v[224:227], v245 offset:6528
ds_read_b128 v[192:195], v244 offset:128
ds_read_b128 v[196:199], v244 offset:64
ds_read_u16_d16 v142, v142
ds_read_u16_d16_hi v143, v143
v_mfma_f32_32x32x16_bf16 v[120:135], v[116:119], v[228:231], v[120:135]
v_fma_mix_f32 v167, v185, v185, v167 op_sel:[1,1,0] op_sel_hi:[1,1,0]
v_rcp_f16_sdwa v148, v147 dst_sel:WORD_1 dst_unused:UNUSED_PRESERVE src0_sel:WORD_1
v_and_b32_e64 v177, s49, v177
v_pk_mul_f16 v155, v155, v154
v_fma_mix_f32 v167, v186, v186, v167 op_sel:[0,0,0] op_sel_hi:[1,1,0]
v_pk_mul_f16 v152, v152, v151
v_bfe_u32 v176, v177, 2, 14
v_pk_mul_f16 v149, v149, v148
v_fma_mix_f32 v156, v155, v155, v156 op_sel:[0,0,0] op_sel_hi:[1,1,0]
v_fma_mix_f32 v156, v155, v155, v156 op_sel:[1,1,0] op_sel_hi:[1,1,0]
v_lshrrev_b32 v177, 18, v177
v_fma_mix_f32 v167, v187, v187, v167 op_sel:[1,1,0] op_sel_hi:[1,1,0]
v_fma_mix_f32 v156, v152, v152, v156 op_sel:[0,0,0] op_sel_hi:[1,1,0]
v_fma_mix_f32 v156, v152, v152, v156 op_sel:[1,1,0] op_sel_hi:[1,1,0]
v_fma_mix_f32 v156, v149, v149, v156 op_sel:[0,0,0] op_sel_hi:[1,1,0]
v_fma_mix_f32 v156, v149, v149, v156 op_sel:[1,1,0] op_sel_hi:[1,1,0]
s_setprio 2
v_mfma_f32_32x32x16_bf16 v[0:15], v[232:235], v[232:235], 0
s_add_u32 s46, s80, 14680064
buffer_store_dwordx4 v[76:79], v241, s[32:35], s46 offen sc1
ds_read_b128 v[228:231], v248 offset:32768
ds_read_u16_d16 v176, v176
ds_read_u16_d16_hi v177, v177
v_cvt_pkrtz_f16_f32 v179, v120, v121
v_cvt_pkrtz_f16_f32 v181, v122, v123
v_cvt_pkrtz_f16_f32 v183, v124, v125
v_mfma_f32_32x32x16_bf16 v[16:31], v[232:235], v[232:235], 0
v_cvt_pkrtz_f16_f32 v185, v126, v127
v_cvt_pkrtz_f16_f32 v187, v128, v129
v_cvt_pk_f16_f32 v155, v130, v131
v_cvt_pk_f16_f32 v152, v132, v133
v_mfma_f32_32x32x16_bf16 v[32:47], v[232:235], v[232:235], 0
v_cvt_pk_f16_f32 v149, v134, v135
v_pk_fma_f16 v154, v155, v155, s48
v_and_b32_e64 v179, s49, v179
v_mfma_f32_32x32x16_bf16 v[120:135], v[96:99], v[236:239], 0
ds_read_b128 v[232:235], v248 offset:30720
v_fma_mix_f32 v156, v136, v136, v156 op_sel:[0,0,0] op_sel_hi:[1,1,0]
v_pk_fma_f16 v151, v152, v152, s48
v_pk_fma_f16 v148, v149, v149, s48
v_bfe_u32 v178, v179, 2, 14
v_pk_mul_f16 v154, v155, v154
v_pk_mul_f16 v151, v152, v151
v_fma_mix_f32 v156, v137, v137, v156 op_sel:[1,1,0] op_sel_hi:[1,1,0]
s_waitcnt lgkmcnt(4)
v_mfma_f32_32x32x16_bf16 v[120:135], v[100:103], v[216:219], v[120:135]
ds_read_b128 v[236:239], v245 offset:6144
ds_read_b128 v[200:203], v244
ds_read_b128 v[204:207], v243 offset:128
ds_read_u16_d16 v178, v178
v_lshrrev_b32 v179, 18, v179
v_pk_mul_f16 v148, v149, v148
v_exp_f16 v153, v154
v_exp_f16 v150, v151
v_and_b32_e64 v181, s49, v181
v_fma_mix_f32 v156, v138, v138, v156 op_sel:[0,0,0] op_sel_hi:[1,1,0]
v_mfma_f32_32x32x16_bf16 v[120:135], v[104:107], v[220:223], v[120:135]
ds_read_b128 v[216:219], v248 offset:33792
ds_read_u16_d16_hi v179, v179
v_exp_f16_e64 v147, v148
v_bfe_u32 v180, v181, 2, 14
v_exp_f16_sdwa v153, v154 dst_sel:WORD_1 dst_unused:UNUSED_PRESERVE src0_sel:WORD_1
v_lshrrev_b32_e64 v181, 18, v181
v_fma_mix_f32 v156, v139, v139, v156 op_sel:[1,1,0] op_sel_hi:[1,1,0]
v_smfmac_f32_16x16x32_bf16 v[40:43], v[226:227], v[192:195], v246
ds_read_b128 v[220:223], v245 offset:5760
ds_read_b128 v[208:211], v243 offset:64
ds_read_b128 v[212:215], v243
ds_read_u16_d16 v180, v180
ds_read_u16_d16_hi v181, v181
v_exp_f16_sdwa v150, v151 dst_sel:WORD_1 dst_unused:UNUSED_PRESERVE src0_sel:WORD_1
v_smfmac_f32_16x16x32_bf16 v[24:27], v[224:225], v[196:199], v246
v_exp_f16_sdwa v147, v148 dst_sel:WORD_1 dst_unused:UNUSED_PRESERVE src0_sel:WORD_1
v_and_b32 v183, s49, v183
v_fma_mix_f32 v156, v140, v140, v156 op_sel:[0,0,0] op_sel_hi:[1,1,0]
v_pk_add_f16 v153, v153, 1.0 op_sel_hi:[1,0]
s_waitcnt lgkmcnt(7)
v_mfma_f32_32x32x16_bf16 v[120:135], v[108:111], v[228:231], v[120:135]
ds_read_b128 v[224:227], v245 offset:5376
ds_read_b128 v[192:195], v242 offset:128
ds_read_b128 v[196:199], v242 offset:64
v_bfe_u32 v182, v183, 2, 14
v_pk_add_f16 v150, v150, 1.0 op_sel_hi:[1,0]
v_pk_add_f16 v147, v147, 1.0 op_sel_hi:[1,0]
v_rcp_f16 v154, v153
v_lshrrev_b32 v183, 18, v183
v_fma_mix_f32 v156, v141, v141, v156 op_sel:[1,1,0] op_sel_hi:[1,1,0]
v_mfma_f32_32x32x16_bf16 v[120:135], v[112:115], v[232:235], v[120:135]
ds_read_b128 v[228:231], v248 offset:34816
ds_read_u16_d16 v182, v182
ds_read_u16_d16_hi v183, v183
v_rcp_f16 v151, v150
v_and_b32 v185, s49, v185
v_rcp_f16_e64 v148, v147
v_fma_mix_f32 v156, v142, v142, v156 op_sel:[0,0,0] op_sel_hi:[1,1,0]
v_bfe_u32 v184, v185, 2, 14
v_smfmac_f32_16x16x32_bf16 v[8:11], v[238:239], v[200:203], v246
ds_read_b128 v[232:235], v248 offset:37888
ds_read_u16_d16 v184, v184
v_rcp_f16_sdwa v154, v153 dst_sel:WORD_1 dst_unused:UNUSED_PRESERVE src0_sel:WORD_1
v_rcp_f16_sdwa v151, v150 dst_sel:WORD_1 dst_unused:UNUSED_PRESERVE src0_sel:WORD_1
v_smfmac_f32_16x16x32_bf16 v[40:43], v[236:237], v[204:207], v246
v_lshrrev_b32 v185, 18, v185
v_fma_mix_f32 v156, v143, v143, v156 op_sel:[1,1,0] op_sel_hi:[1,1,0]
s_waitcnt lgkmcnt(6)
v_mfma_f32_32x32x16_bf16 v[120:135], v[116:119], v[216:219], v[120:135]
ds_read_b128 v[236:239], v248 offset:35840
ds_read_u16_d16_hi v185, v185
v_rcp_f16_sdwa v148, v147 dst_sel:WORD_1 dst_unused:UNUSED_PRESERVE src0_sel:WORD_1
v_and_b32_e64 v187, s49, v187
v_pk_mul_f16 v155, v155, v154
v_fma_mix_f32 v156, v176, v176, v156 op_sel:[0,0,0] op_sel_hi:[1,1,0]
v_pk_mul_f16 v152, v152, v151
v_bfe_u32 v186, v187, 2, 14
v_pk_mul_f16 v149, v149, v148
v_smfmac_f32_16x16x32_bf16 v[24:27], v[222:223], v[208:211], v246
ds_read_b128 v[216:219], v248 offset:38912
ds_read_u16_d16 v186, v186
v_fma_mix_f32 v157, v155, v155, v157 op_sel:[0,0,0] op_sel_hi:[1,1,0]
v_fma_mix_f32 v157, v155, v155, v157 op_sel:[1,1,0] op_sel_hi:[1,1,0]
v_lshrrev_b32_e64 v187, 18, v187
v_fma_mix_f32 v156, v177, v177, v156 op_sel:[1,1,0] op_sel_hi:[1,1,0]
v_smfmac_f32_16x16x32_bf16 v[8:11], v[220:221], v[212:215], v246
v_fma_mix_f32 v157, v152, v152, v157 op_sel:[0,0,0] op_sel_hi:[1,1,0]
v_fma_mix_f32 v157, v152, v152, v157 op_sel:[1,1,0] op_sel_hi:[1,1,0]
v_fma_mix_f32 v157, v149, v149, v157 op_sel:[0,0,0] op_sel_hi:[1,1,0]
v_fma_mix_f32 v157, v149, v149, v157 op_sel:[1,1,0] op_sel_hi:[1,1,0]
s_setprio 1
v_smfmac_f32_16x16x32_bf16 v[40:43], v[226:227], v[192:195], v246
s_waitcnt lgkmcnt(4)
s_add_u32 s46, s80, 16777216
buffer_store_dwordx4 v[80:83], v241, s[32:35], s46 offen sc1
ds_read_b128 v[220:223], v248 offset:36864
ds_read_u16_d16_hi v187, v187
v_cvt_pkrtz_f16_f32 v137, v120, v121
v_cvt_pkrtz_f16_f32 v139, v122, v123
v_cvt_pkrtz_f16_f32 v141, v124, v125
v_cvt_pkrtz_f16_f32 v143, v126, v127
v_cvt_pk_f16_f32 v155, v128, v129
v_smfmac_f32_16x16x32_bf16 v[24:27], v[224:225], v[196:199], v246
v_cvt_pk_f16_f32 v152, v130, v131
v_cvt_pk_f16_f32 v149, v132, v133
v_cvt_pk_f16_f32 v146, v134, v135
v_pk_fma_f16 v154, v155, v155, s48
v_and_b32_e64 v137, s49, v137
v_mfma_f32_32x32x16_bf16 v[120:135], v[96:99], v[228:231], 0
ds_read_b128 v[224:227], v248 offset:39936
v_fma_mix_f32 v157, v178, v178, v157 op_sel:[0,0,0] op_sel_hi:[1,1,0]
v_pk_fma_f16 v151, v152, v152, s48
v_pk_fma_f16 v148, v149, v149, s48
v_pk_fma_f16 v145, v146, v146, s48
v_pk_mul_f16 v154, v155, v154
v_bfe_u32 v136, v137, 2, 14
v_pk_mul_f16 v151, v152, v151
v_fma_mix_f32 v157, v179, v179, v157 op_sel:[1,1,0] op_sel_hi:[1,1,0]
v_pk_mul_f16 v148, v149, v148
v_pk_mul_f16 v145, v146, v145
v_mfma_f32_32x32x16_bf16 v[120:135], v[100:103], v[232:235], v[120:135]
ds_read_b128 v[228:231], v245 offset:4992
ds_read_b128 v[200:203], v242
v_xor_b32_e64 v244, 16, v244
ds_read_b128 v[204:207], v244 offset:128
ds_read_u16_d16 v136, v136
v_exp_f16 v153, v154
v_lshrrev_b32 v137, 18, v137
v_exp_f16_e64 v150, v151
v_fma_mix_f32 v157, v180, v180, v157 op_sel:[0,0,0] op_sel_hi:[1,1,0]
v_exp_f16 v147, v148
v_and_b32 v139, s49, v139
v_exp_f16 v144, v145
s_waitcnt lgkmcnt(5)
v_mfma_f32_32x32x16_bf16 v[120:135], v[104:107], v[236:239], v[120:135]
ds_read_b128 v[232:235], v245 offset:4608
ds_read_b128 v[208:211], v244 offset:64
ds_read_b128 v[212:215], v244
ds_read_u16_d16_hi v137, v137
v_exp_f16_sdwa v153, v154 dst_sel:WORD_1 dst_unused:UNUSED_PRESERVE src0_sel:WORD_1
v_fma_mix_f32 v157, v181, v181, v157 op_sel:[1,1,0] op_sel_hi:[1,1,0]
v_bfe_u32 v138, v139, 2, 14
v_exp_f16_sdwa v150, v151 dst_sel:WORD_1 dst_unused:UNUSED_PRESERVE src0_sel:WORD_1
v_exp_f16_sdwa v147, v148 dst_sel:WORD_1 dst_unused:UNUSED_PRESERVE src0_sel:WORD_1
v_exp_f16_sdwa v144, v145 dst_sel:WORD_1 dst_unused:UNUSED_PRESERVE src0_sel:WORD_1
v_lshrrev_b32_e64 v139, 18, v139
v_fma_mix_f32 v157, v182, v182, v157 op_sel:[0,0,0] op_sel_hi:[1,1,0]
v_mfma_f32_32x32x16_bf16 v[120:135], v[108:111], v[216:219], v[120:135]
ds_read_b128 v[236:239], v248 offset:40960
ds_read_u16_d16 v138, v138
ds_read_u16_d16_hi v139, v139
v_pk_add_f16 v153, v153, 1.0 op_sel_hi:[1,0]
v_pk_add_f16 v150, v150, 1.0 op_sel_hi:[1,0]
v_pk_add_f16 v147, v147, 1.0 op_sel_hi:[1,0]
v_and_b32_e64 v141, s49, v141
v_pk_add_f16 v144, v144, 1.0 op_sel_hi:[1,0]
v_rcp_f16_e64 v154, v153
v_fma_mix_f32 v157, v183, v183, v157 op_sel:[1,1,0] op_sel_hi:[1,1,0]
v_rcp_f16_e64 v151, v150
v_mfma_f32_32x32x16_bf16 v[120:135], v[112:115], v[220:223], v[120:135]
ds_read_b128 v[216:219], v248 offset:44032
v_bfe_u32 v140, v141, 2, 14
v_rcp_f16_e64 v148, v147
v_fma_mix_f32 v157, v184, v184, v157 op_sel:[0,0,0] op_sel_hi:[1,1,0]
v_rcp_f16 v145, v144
v_lshrrev_b32 v141, 18, v141
v_rcp_f16_sdwa v154, v153 dst_sel:WORD_1 dst_unused:UNUSED_PRESERVE src0_sel:WORD_1
s_setprio 0
v_rcp_f16_sdwa v151, v150 dst_sel:WORD_1 dst_unused:UNUSED_PRESERVE src0_sel:WORD_1
s_waitcnt lgkmcnt(4)
v_mfma_f32_32x32x16_bf16 v[120:135], v[116:119], v[224:227], v[120:135]
ds_read_b128 v[220:223], v248 offset:41984
ds_read_u16_d16 v140, v140
ds_read_u16_d16_hi v141, v141
v_fma_mix_f32 v157, v185, v185, v157 op_sel:[1,1,0] op_sel_hi:[1,1,0]
v_and_b32_e64 v143, s49, v143
v_rcp_f16_sdwa v148, v147 dst_sel:WORD_1 dst_unused:UNUSED_PRESERVE src0_sel:WORD_1
v_rcp_f16_sdwa v145, v144 dst_sel:WORD_1 dst_unused:UNUSED_PRESERVE src0_sel:WORD_1
v_pk_mul_f16 v155, v155, v154
v_bfe_u32 v142, v143, 2, 14
v_fma_mix_f32 v157, v186, v186, v157 op_sel:[0,0,0] op_sel_hi:[1,1,0]
v_pk_mul_f16 v152, v152, v151
v_pk_mul_f16 v149, v149, v148
v_smfmac_f32_16x16x32_bf16 v[8:11], v[230:231], v[200:203], v246
ds_read_b128 v[224:227], v248 offset:45056
ds_read_u16_d16 v142, v142
v_pk_mul_f16 v146, v146, v145
v_fma_mix_f32 v158, v155, v155, v158 op_sel:[0,0,0] op_sel_hi:[1,1,0]
v_lshrrev_b32 v143, 18, v143
v_fma_mix_f32 v158, v155, v155, v158 op_sel:[1,1,0] op_sel_hi:[1,1,0]
v_fma_mix_f32 v158, v152, v152, v158 op_sel:[0,0,0] op_sel_hi:[1,1,0]
v_smfmac_f32_16x16x32_bf16 v[44:47], v[228:229], v[204:207], v246
v_fma_mix_f32 v157, v187, v187, v157 op_sel:[1,1,0] op_sel_hi:[1,1,0]
v_fma_mix_f32 v158, v152, v152, v158 op_sel:[1,1,0] op_sel_hi:[1,1,0]
v_fma_mix_f32 v158, v149, v149, v158 op_sel:[0,0,0] op_sel_hi:[1,1,0]
v_fma_mix_f32 v158, v149, v149, v158 op_sel:[1,1,0] op_sel_hi:[1,1,0]
v_fma_mix_f32 v158, v146, v146, v158 op_sel:[0,0,0] op_sel_hi:[1,1,0]
v_fma_mix_f32 v158, v146, v146, v158 op_sel:[1,1,0] op_sel_hi:[1,1,0]
s_setprio 2
v_smfmac_f32_16x16x32_bf16 v[28:31], v[234:235], v[208:211], v246
s_add_u32 s46, s80, 18874368
buffer_store_dwordx4 v[84:87], v241, s[32:35], s46 offen sc1
ds_read_b128 v[228:231], v248 offset:43008
ds_read_u16_d16_hi v143, v143
v_cvt_pkrtz_f16_f32 v179, v120, v121
v_cvt_pkrtz_f16_f32 v181, v122, v123
v_cvt_pkrtz_f16_f32 v183, v124, v125
v_cvt_pkrtz_f16_f32 v185, v126, v127
v_smfmac_f32_16x16x32_bf16 v[12:15], v[232:233], v[212:215], v246
v_cvt_pkrtz_f16_f32 v187, v128, v129
v_cvt_pk_f16_f32 v155, v130, v131
v_cvt_pk_f16_f32 v152, v132, v133
v_cvt_pk_f16_f32 v149, v134, v135
v_pk_fma_f16 v154, v155, v155, s48
s_waitcnt lgkmcnt(2)
v_mfma_f32_32x32x16_bf16 v[120:135], v[96:99], v[236:239], 0
ds_read_b128 v[232:235], v248 offset:46080
v_and_b32 v179, s49, v179
v_fma_mix_f32 v158, v136, v136, v158 op_sel:[0,0,0] op_sel_hi:[1,1,0]
v_pk_fma_f16 v151, v152, v152, s48
v_pk_fma_f16 v148, v149, v149, s48
v_bfe_u32 v178, v179, 2, 14
v_pk_mul_f16 v154, v155, v154
v_pk_mul_f16 v151, v152, v151
v_pk_mul_f16 v148, v149, v148
v_lshrrev_b32_e64 v179, 18, v179
v_mfma_f32_32x32x16_bf16 v[120:135], v[100:103], v[216:219], v[120:135]
ds_read_b128 v[236:239], v245 offset:4224
v_xor_b32_e64 v243, 16, v243
ds_read_b128 v[192:195], v243 offset:128
ds_read_b128 v[196:199], v243 offset:64
ds_read_u16_d16 v178, v178
ds_read_u16_d16_hi v179, v179
v_fma_mix_f32 v158, v137, v137, v158 op_sel:[1,1,0] op_sel_hi:[1,1,0]
v_exp_f16 v153, v154
v_and_b32 v181, s49, v181
v_exp_f16 v150, v151
v_exp_f16 v147, v148
v_bfe_u32 v180, v181, 2, 14
v_mfma_f32_32x32x16_bf16 v[120:135], v[104:107], v[220:223], v[120:135]
ds_read_b128 v[216:219], v245 offset:3840
ds_read_b128 v[200:203], v243
v_xor_b32_e64 v242, 16, v242
ds_read_b128 v[204:207], v242 offset:128
ds_read_u16_d16 v180, v180
v_fma_mix_f32 v158, v138, v138, v158 op_sel:[0,0,0] op_sel_hi:[1,1,0]
v_exp_f16_sdwa v153, v154 dst_sel:WORD_1 dst_unused:UNUSED_PRESERVE src0_sel:WORD_1
v_lshrrev_b32_e64 v181, 18, v181
v_exp_f16_sdwa v150, v151 dst_sel:WORD_1 dst_unused:UNUSED_PRESERVE src0_sel:WORD_1
v_fma_mix_f32 v158, v139, v139, v158 op_sel:[1,1,0] op_sel_hi:[1,1,0]
v_and_b32_e64 v183, s49, v183
v_mfma_f32_32x32x16_bf16 v[120:135], v[108:111], v[224:227], v[120:135]
ds_read_b128 v[220:223], v248 offset:47104
ds_read_u16_d16_hi v181, v181
v_exp_f16_sdwa v147, v148 dst_sel:WORD_1 dst_unused:UNUSED_PRESERVE src0_sel:WORD_1
v_pk_add_f16 v153, v153, 1.0 op_sel_hi:[1,0]
v_bfe_u32 v182, v183, 2, 14
v_pk_add_f16 v150, v150, 1.0 op_sel_hi:[1,0]
v_pk_add_f16 v147, v147, 1.0 op_sel_hi:[1,0]
v_rcp_f16_e64 v154, v153
v_lshrrev_b32 v183, 18, v183
v_fma_mix_f32 v158, v140, v140, v158 op_sel:[0,0,0] op_sel_hi:[1,1,0]
s_waitcnt lgkmcnt(6)
v_mfma_f32_32x32x16_bf16 v[120:135], v[112:115], v[228:231], v[120:135]
ds_read_b128 v[224:227], v248 offset:50176
ds_read_u16_d16 v182, v182
ds_read_u16_d16_hi v183, v183
v_rcp_f16 v151, v150
v_and_b32 v185, s49, v185
v_rcp_f16_e64 v148, v147
v_fma_mix_f32 v158, v141, v141, v158 op_sel:[1,1,0] op_sel_hi:[1,1,0]
v_bfe_u32 v184, v185, 2, 14
v_rcp_f16_sdwa v154, v153 dst_sel:WORD_1 dst_unused:UNUSED_PRESERVE src0_sel:WORD_1
v_mfma_f32_32x32x16_bf16 v[120:135], v[116:119], v[232:235], v[120:135]
ds_read_b128 v[228:231], v248 offset:48128
ds_read_u16_d16 v184, v184
v_rcp_f16_sdwa v151, v150 dst_sel:WORD_1 dst_unused:UNUSED_PRESERVE src0_sel:WORD_1
v_lshrrev_b32_e64 v185, 18, v185
v_rcp_f16_sdwa v148, v147 dst_sel:WORD_1 dst_unused:UNUSED_PRESERVE src0_sel:WORD_1
v_and_b32_e64 v187, s49, v187
v_fma_mix_f32 v158, v142, v142, v158 op_sel:[0,0,0] op_sel_hi:[1,1,0]
v_pk_mul_f16 v155, v155, v154
v_pk_mul_f16 v152, v152, v151
v_smfmac_f32_16x16x32_bf16 v[44:47], v[238:239], v[192:195], v246
ds_read_b128 v[232:235], v248 offset:51200
ds_read_u16_d16_hi v185, v185
v_bfe_u32 v186, v187, 2, 14
v_pk_mul_f16 v149, v149, v148
v_fma_mix_f32 v159, v155, v155, v159 op_sel:[0,0,0] op_sel_hi:[1,1,0]
v_fma_mix_f32 v158, v143, v143, v158 op_sel:[1,1,0] op_sel_hi:[1,1,0]
v_lshrrev_b32_e64 v187, 18, v187
v_smfmac_f32_16x16x32_bf16 v[28:31], v[236:237], v[196:199], v246
v_fma_mix_f32 v159, v155, v155, v159 op_sel:[1,1,0] op_sel_hi:[1,1,0]
v_fma_mix_f32 v159, v152, v152, v159 op_sel:[0,0,0] op_sel_hi:[1,1,0]
v_fma_mix_f32 v159, v152, v152, v159 op_sel:[1,1,0] op_sel_hi:[1,1,0]
v_fma_mix_f32 v159, v149, v149, v159 op_sel:[0,0,0] op_sel_hi:[1,1,0]
v_fma_mix_f32 v159, v149, v149, v159 op_sel:[1,1,0] op_sel_hi:[1,1,0]
s_setprio 1
s_waitcnt lgkmcnt(4)
v_smfmac_f32_16x16x32_bf16 v[12:15], v[218:219], v[200:203], v246
s_add_u32 s46, s80, 20971520
buffer_store_dwordx4 v[88:91], v241, s[32:35], s46 offen sc1
ds_read_b128 v[236:239], v248 offset:49152
ds_read_u16_d16 v186, v186
ds_read_u16_d16_hi v187, v187
v_cvt_pkrtz_f16_f32 v137, v120, v121
v_cvt_pkrtz_f16_f32 v139, v122, v123
v_cvt_pkrtz_f16_f32 v141, v124, v125
v_cvt_pkrtz_f16_f32 v143, v126, v127
v_cvt_pk_f16_f32 v155, v128, v129
v_smfmac_f32_16x16x32_bf16 v[44:47], v[216:217], v[204:207], v246
v_cvt_pk_f16_f32 v152, v130, v131
v_cvt_pk_f16_f32 v149, v132, v133
v_cvt_pk_f16_f32 v146, v134, v135
v_pk_fma_f16 v154, v155, v155, s48
v_and_b32_e64 v137, s49, v137
v_mfma_f32_32x32x16_bf16 v[120:135], v[96:99], v[220:223], 0
ds_read_b128 v[216:219], v248 offset:52224
v_fma_mix_f32 v159, v178, v178, v159 op_sel:[0,0,0] op_sel_hi:[1,1,0]
v_pk_fma_f16 v151, v152, v152, s48
v_pk_fma_f16 v148, v149, v149, s48
v_pk_fma_f16 v145, v146, v146, s48
v_pk_mul_f16 v154, v155, v154
v_bfe_u32 v136, v137, 2, 14
v_pk_mul_f16 v151, v152, v151
v_fma_mix_f32 v159, v179, v179, v159 op_sel:[1,1,0] op_sel_hi:[1,1,0]
v_pk_mul_f16 v148, v149, v148
v_pk_mul_f16 v145, v146, v145
v_mfma_f32_32x32x16_bf16 v[120:135], v[100:103], v[224:227], v[120:135]
ds_read_b128 v[220:223], v245 offset:3456
ds_read_b128 v[208:211], v242 offset:64
ds_read_b128 v[212:215], v242
ds_read_u16_d16 v136, v136
v_exp_f16 v153, v154
v_lshrrev_b32 v137, 18, v137
v_exp_f16_e64 v150, v151
v_fma_mix_f32 v159, v180, v180, v159 op_sel:[0,0,0] op_sel_hi:[1,1,0]
v_exp_f16 v147, v148
v_and_b32 v139, s49, v139
v_exp_f16 v144, v145
s_waitcnt lgkmcnt(5)
v_mfma_f32_32x32x16_bf16 v[120:135], v[104:107], v[228:231], v[120:135]
ds_read_b128 v[224:227], v245 offset:3072
v_xor_b32_e64 v244, 32, v244
ds_read_b128 v[192:195], v244 offset:128
ds_read_b128 v[196:199], v244 offset:64
ds_read_u16_d16_hi v137, v137
v_exp_f16_sdwa v153, v154 dst_sel:WORD_1 dst_unused:UNUSED_PRESERVE src0_sel:WORD_1
v_fma_mix_f32 v159, v181, v181, v159 op_sel:[1,1,0] op_sel_hi:[1,1,0]
v_bfe_u32 v138, v139, 2, 14
v_exp_f16_sdwa v150, v151 dst_sel:WORD_1 dst_unused:UNUSED_PRESERVE src0_sel:WORD_1
v_exp_f16_sdwa v147, v148 dst_sel:WORD_1 dst_unused:UNUSED_PRESERVE src0_sel:WORD_1
v_exp_f16_sdwa v144, v145 dst_sel:WORD_1 dst_unused:UNUSED_PRESERVE src0_sel:WORD_1
v_lshrrev_b32_e64 v139, 18, v139
v_fma_mix_f32 v159, v182, v182, v159 op_sel:[0,0,0] op_sel_hi:[1,1,0]
v_mfma_f32_32x32x16_bf16 v[120:135], v[108:111], v[232:235], v[120:135]
ds_read_b128 v[228:231], v248 offset:53248
ds_read_u16_d16 v138, v138
ds_read_u16_d16_hi v139, v139
v_pk_add_f16 v153, v153, 1.0 op_sel_hi:[1,0]
v_pk_add_f16 v150, v150, 1.0 op_sel_hi:[1,0]
v_pk_add_f16 v147, v147, 1.0 op_sel_hi:[1,0]
v_and_b32_e64 v141, s49, v141
v_pk_add_f16 v144, v144, 1.0 op_sel_hi:[1,0]
v_rcp_f16_e64 v154, v153
v_fma_mix_f32 v159, v183, v183, v159 op_sel:[1,1,0] op_sel_hi:[1,1,0]
v_rcp_f16_e64 v151, v150
v_mfma_f32_32x32x16_bf16 v[120:135], v[112:115], v[236:239], v[120:135]
ds_read_b128 v[232:235], v248 offset:56320
v_bfe_u32 v140, v141, 2, 14
v_rcp_f16_e64 v148, v147
v_fma_mix_f32 v159, v184, v184, v159 op_sel:[0,0,0] op_sel_hi:[1,1,0]
v_rcp_f16 v145, v144
v_lshrrev_b32 v141, 18, v141
v_rcp_f16_sdwa v154, v153 dst_sel:WORD_1 dst_unused:UNUSED_PRESERVE src0_sel:WORD_1
s_setprio 0
v_rcp_f16_sdwa v151, v150 dst_sel:WORD_1 dst_unused:UNUSED_PRESERVE src0_sel:WORD_1
s_waitcnt lgkmcnt(4)
v_mfma_f32_32x32x16_bf16 v[120:135], v[116:119], v[216:219], v[120:135]
ds_read_b128 v[236:239], v248 offset:54272
ds_read_u16_d16 v140, v140
ds_read_u16_d16_hi v141, v141
v_fma_mix_f32 v159, v185, v185, v159 op_sel:[1,1,0] op_sel_hi:[1,1,0]
v_and_b32_e64 v143, s49, v143
v_rcp_f16_sdwa v148, v147 dst_sel:WORD_1 dst_unused:UNUSED_PRESERVE src0_sel:WORD_1
v_rcp_f16_sdwa v145, v144 dst_sel:WORD_1 dst_unused:UNUSED_PRESERVE src0_sel:WORD_1
v_pk_mul_f16 v155, v155, v154
v_bfe_u32 v142, v143, 2, 14
v_fma_mix_f32 v159, v186, v186, v159 op_sel:[0,0,0] op_sel_hi:[1,1,0]
v_pk_mul_f16 v152, v152, v151
v_pk_mul_f16 v149, v149, v148
v_smfmac_f32_16x16x32_bf16 v[28:31], v[222:223], v[208:211], v246
ds_read_b128 v[216:219], v248 offset:57344
ds_read_u16_d16 v142, v142
v_pk_mul_f16 v146, v146, v145
v_fma_mix_f32 v160, v155, v155, v160 op_sel:[0,0,0] op_sel_hi:[1,1,0]
v_lshrrev_b32 v143, 18, v143
v_fma_mix_f32 v160, v155, v155, v160 op_sel:[1,1,0] op_sel_hi:[1,1,0]
v_fma_mix_f32 v160, v152, v152, v160 op_sel:[0,0,0] op_sel_hi:[1,1,0]
v_smfmac_f32_16x16x32_bf16 v[12:15], v[220:221], v[212:215], v246
v_fma_mix_f32 v159, v187, v187, v159 op_sel:[1,1,0] op_sel_hi:[1,1,0]
v_fma_mix_f32 v160, v152, v152, v160 op_sel:[1,1,0] op_sel_hi:[1,1,0]
v_fma_mix_f32 v160, v149, v149, v160 op_sel:[0,0,0] op_sel_hi:[1,1,0]
v_fma_mix_f32 v160, v149, v149, v160 op_sel:[1,1,0] op_sel_hi:[1,1,0]
v_fma_mix_f32 v160, v146, v146, v160 op_sel:[0,0,0] op_sel_hi:[1,1,0]
v_fma_mix_f32 v160, v146, v146, v160 op_sel:[1,1,0] op_sel_hi:[1,1,0]
s_setprio 2
v_smfmac_f32_16x16x32_bf16 v[36:39], v[226:227], v[192:195], v246
s_add_u32 s46, s80, 23068672
buffer_store_dwordx4 v[92:95], v241, s[32:35], s46 offen sc1
ds_read_b128 v[220:223], v248 offset:55296
ds_read_u16_d16_hi v143, v143
v_cvt_pkrtz_f16_f32 v179, v120, v121
v_cvt_pkrtz_f16_f32 v181, v122, v123
v_cvt_pkrtz_f16_f32 v183, v124, v125
v_cvt_pkrtz_f16_f32 v185, v126, v127
v_smfmac_f32_16x16x32_bf16 v[20:23], v[224:225], v[196:199], v246
v_cvt_pkrtz_f16_f32 v187, v128, v129
v_cvt_pk_f16_f32 v155, v130, v131
v_cvt_pk_f16_f32 v152, v132, v133
v_cvt_pk_f16_f32 v149, v134, v135
s_waitcnt lgkmcnt(2)
v_mfma_f32_32x32x16_bf16 v[120:135], v[96:99], v[228:231], 0
ds_read_b128 v[224:227], v245 offset:2688
ds_read_b128 v[200:203], v244
v_xor_b32 v243, 32, v243
ds_read_b128 v[204:207], v243 offset:128
v_pk_fma_f16 v154, v155, v155, s48
v_and_b32_e64 v179, s49, v179
v_fma_mix_f32 v160, v136, v136, v160 op_sel:[0,0,0] op_sel_hi:[1,1,0]
v_pk_fma_f16 v151, v152, v152, s48
v_pk_fma_f16 v148, v149, v149, s48
v_bfe_u32 v178, v179, 2, 14
v_pk_mul_f16 v154, v155, v154
v_pk_mul_f16 v151, v152, v151
v_mfma_f32_32x32x16_bf16 v[120:135], v[100:103], v[232:235], v[120:135]
ds_read_b128 v[228:231], v248 offset:58368
ds_read_u16_d16 v178, v178
v_pk_mul_f16 v148, v149, v148
v_lshrrev_b32_e64 v179, 18, v179
v_fma_mix_f32 v160, v137, v137, v160 op_sel:[1,1,0] op_sel_hi:[1,1,0]
v_exp_f16 v153, v154
v_and_b32 v181, s49, v181
v_exp_f16_e64 v150, v151
v_mfma_f32_32x32x16_bf16 v[120:135], v[104:107], v[236:239], v[120:135]
ds_read_b128 v[232:235], v245 offset:2304
ds_read_b128 v[208:211], v243 offset:64
ds_read_b128 v[212:215], v243
ds_read_u16_d16_hi v179, v179
v_exp_f16_e64 v147, v148
v_bfe_u32 v180, v181, 2, 14
v_fma_mix_f32 v160, v138, v138, v160 op_sel:[0,0,0] op_sel_hi:[1,1,0]
v_exp_f16_sdwa v153, v154 dst_sel:WORD_1 dst_unused:UNUSED_PRESERVE src0_sel:WORD_1
v_lshrrev_b32_e64 v181, 18, v181
v_mfma_f32_32x32x16_bf16 v[120:135], v[108:111], v[216:219], v[120:135]
ds_read_b128 v[236:239], v245 offset:1920
v_xor_b32_e64 v242, 32, v242
ds_read_b128 v[192:195], v242 offset:128
ds_read_b128 v[196:199], v242 offset:64
ds_read_u16_d16 v180, v180
ds_read_u16_d16_hi v181, v181
v_exp_f16_sdwa v150, v151 dst_sel:WORD_1 dst_unused:UNUSED_PRESERVE src0_sel:WORD_1
v_fma_mix_f32 v160, v139, v139, v160 op_sel:[1,1,0] op_sel_hi:[1,1,0]
v_and_b32 v183, s49, v183
v_exp_f16_sdwa v147, v148 dst_sel:WORD_1 dst_unused:UNUSED_PRESERVE src0_sel:WORD_1
v_pk_add_f16 v153, v153, 1.0 op_sel_hi:[1,0]
v_bfe_u32 v182, v183, 2, 14
v_pk_add_f16 v150, v150, 1.0 op_sel_hi:[1,0]
s_waitcnt lgkmcnt(9)
v_mfma_f32_32x32x16_bf16 v[120:135], v[112:115], v[220:223], v[120:135]
ds_read_b128 v[216:219], v248 offset:59392
ds_read_u16_d16 v182, v182
v_pk_add_f16 v147, v147, 1.0 op_sel_hi:[1,0]
v_rcp_f16 v154, v153
v_lshrrev_b32 v183, 18, v183
v_fma_mix_f32 v160, v140, v140, v160 op_sel:[0,0,0] op_sel_hi:[1,1,0]
v_rcp_f16 v151, v150
v_and_b32 v185, s49, v185
v_smfmac_f32_16x16x32_bf16 v[4:7], v[226:227], v[200:203], v246
ds_read_b128 v[220:223], v248 offset:62464
ds_read_u16_d16_hi v183, v183
v_rcp_f16_e64 v148, v147
v_fma_mix_f32 v160, v141, v141, v160 op_sel:[1,1,0] op_sel_hi:[1,1,0]
v_bfe_u32 v184, v185, 2, 14
v_smfmac_f32_16x16x32_bf16 v[36:39], v[224:225], v[204:207], v246
v_rcp_f16_sdwa v154, v153 dst_sel:WORD_1 dst_unused:UNUSED_PRESERVE src0_sel:WORD_1
v_rcp_f16_sdwa v151, v150 dst_sel:WORD_1 dst_unused:UNUSED_PRESERVE src0_sel:WORD_1
v_mfma_f32_32x32x16_bf16 v[120:135], v[116:119], v[228:231], v[120:135]
ds_read_b128 v[224:227], v248 offset:60416
ds_read_u16_d16 v184, v184
v_lshrrev_b32_e64 v185, 18, v185
v_rcp_f16_sdwa v148, v147 dst_sel:WORD_1 dst_unused:UNUSED_PRESERVE src0_sel:WORD_1
v_and_b32 v187, s49, v187
v_fma_mix_f32 v160, v142, v142, v160 op_sel:[0,0,0] op_sel_hi:[1,1,0]
v_pk_mul_f16 v155, v155, v154
v_pk_mul_f16 v152, v152, v151
v_bfe_u32 v186, v187, 2, 14
s_waitcnt lgkmcnt(4)
v_smfmac_f32_16x16x32_bf16 v[20:23], v[234:235], v[208:211], v246
ds_read_b128 v[228:231], v248 offset:63488
ds_read_u16_d16_hi v185, v185
ds_read_u16_d16 v186, v186
v_pk_mul_f16 v149, v149, v148
v_fma_mix_f32 v161, v155, v155, v161 op_sel:[0,0,0] op_sel_hi:[1,1,0]
v_fma_mix_f32 v160, v143, v143, v160 op_sel:[1,1,0] op_sel_hi:[1,1,0]
v_lshrrev_b32 v187, 18, v187
v_smfmac_f32_16x16x32_bf16 v[4:7], v[232:233], v[212:215], v246
v_fma_mix_f32 v161, v155, v155, v161 op_sel:[1,1,0] op_sel_hi:[1,1,0]
v_fma_mix_f32 v161, v152, v152, v161 op_sel:[0,0,0] op_sel_hi:[1,1,0]
v_fma_mix_f32 v161, v152, v152, v161 op_sel:[1,1,0] op_sel_hi:[1,1,0]
v_fma_mix_f32 v161, v149, v149, v161 op_sel:[0,0,0] op_sel_hi:[1,1,0]
v_fma_mix_f32 v161, v149, v149, v161 op_sel:[1,1,0] op_sel_hi:[1,1,0]
s_setprio 1
v_smfmac_f32_16x16x32_bf16 v[36:39], v[238:239], v[192:195], v246
ds_read_b128 v[232:235], v248 offset:61440
ds_read_u16_d16_hi v187, v187
v_cvt_pkrtz_f16_f32 v137, v120, v121
v_cvt_pkrtz_f16_f32 v139, v122, v123
v_cvt_pkrtz_f16_f32 v141, v124, v125
v_cvt_pkrtz_f16_f32 v143, v126, v127
v_cvt_pk_f16_f32 v155, v128, v129
v_smfmac_f32_16x16x32_bf16 v[20:23], v[236:237], v[196:199], v246
v_cvt_pk_f16_f32 v152, v130, v131
v_cvt_pk_f16_f32 v149, v132, v133
v_cvt_pk_f16_f32 v146, v134, v135
v_pk_fma_f16 v154, v155, v155, s48
v_and_b32_e64 v137, s49, v137
v_mfma_f32_32x32x16_bf16 v[120:135], v[96:99], v[216:219], 0
ds_read_b128 v[236:239], v248 offset:64512
v_fma_mix_f32 v161, v178, v178, v161 op_sel:[0,0,0] op_sel_hi:[1,1,0]
v_pk_fma_f16 v151, v152, v152, s48
v_pk_fma_f16 v148, v149, v149, s48
v_pk_fma_f16 v145, v146, v146, s48
v_pk_mul_f16 v154, v155, v154
v_bfe_u32 v136, v137, 2, 14
v_pk_mul_f16 v151, v152, v151
v_fma_mix_f32 v161, v179, v179, v161 op_sel:[1,1,0] op_sel_hi:[1,1,0]
v_pk_mul_f16 v148, v149, v148
v_pk_mul_f16 v145, v146, v145
s_waitcnt lgkmcnt(2)
v_mfma_f32_32x32x16_bf16 v[120:135], v[100:103], v[220:223], v[120:135]
ds_read_b128 v[216:219], v245 offset:1536
ds_read_b128 v[200:203], v242
v_xor_b32 v244, 16, v244
ds_read_b128 v[204:207], v244 offset:128
ds_read_u16_d16 v136, v136
v_exp_f16 v153, v154
v_lshrrev_b32 v137, 18, v137
v_exp_f16_e64 v150, v151
v_fma_mix_f32 v161, v180, v180, v161 op_sel:[0,0,0] op_sel_hi:[1,1,0]
v_exp_f16 v147, v148
v_and_b32 v139, s49, v139
v_exp_f16_e64 v144, v145
v_mfma_f32_32x32x16_bf16 v[120:135], v[104:107], v[224:227], v[120:135]
ds_read_b128 v[220:223], v245 offset:1152
ds_read_b128 v[208:211], v244 offset:64
ds_read_b128 v[212:215], v244
ds_read_u16_d16_hi v137, v137
v_exp_f16_sdwa v153, v154 dst_sel:WORD_1 dst_unused:UNUSED_PRESERVE src0_sel:WORD_1
v_fma_mix_f32 v161, v181, v181, v161 op_sel:[1,1,0] op_sel_hi:[1,1,0]
v_bfe_u32 v138, v139, 2, 14
v_exp_f16_sdwa v150, v151 dst_sel:WORD_1 dst_unused:UNUSED_PRESERVE src0_sel:WORD_1
v_exp_f16_sdwa v147, v148 dst_sel:WORD_1 dst_unused:UNUSED_PRESERVE src0_sel:WORD_1
v_exp_f16_sdwa v144, v145 dst_sel:WORD_1 dst_unused:UNUSED_PRESERVE src0_sel:WORD_1
v_lshrrev_b32_e64 v139, 18, v139
v_fma_mix_f32 v161, v182, v182, v161 op_sel:[0,0,0] op_sel_hi:[1,1,0]
v_mfma_f32_32x32x16_bf16 v[120:135], v[108:111], v[228:231], v[120:135]
ds_read_b128 v[224:227], v249
ds_read_u16_d16 v138, v138
ds_read_u16_d16_hi v139, v139
v_pk_add_f16 v153, v153, 1.0 op_sel_hi:[1,0]
v_pk_add_f16 v150, v150, 1.0 op_sel_hi:[1,0]
v_pk_add_f16 v147, v147, 1.0 op_sel_hi:[1,0]
v_and_b32_e64 v141, s49, v141
v_pk_add_f16 v144, v144, 1.0 op_sel_hi:[1,0]
v_rcp_f16_e64 v154, v153
v_fma_mix_f32 v161, v183, v183, v161 op_sel:[1,1,0] op_sel_hi:[1,1,0]
v_rcp_f16_e64 v151, v150
v_mfma_f32_32x32x16_bf16 v[120:135], v[112:115], v[232:235], v[120:135]
ds_read_b128 v[228:231], v249 offset:3072
v_bfe_u32 v140, v141, 2, 14
v_rcp_f16_e64 v148, v147
v_fma_mix_f32 v161, v184, v184, v161 op_sel:[0,0,0] op_sel_hi:[1,1,0]
v_rcp_f16 v145, v144
v_lshrrev_b32 v141, 18, v141
v_rcp_f16_sdwa v154, v153 dst_sel:WORD_1 dst_unused:UNUSED_PRESERVE src0_sel:WORD_1
s_setprio 0
v_rcp_f16_sdwa v151, v150 dst_sel:WORD_1 dst_unused:UNUSED_PRESERVE src0_sel:WORD_1
s_waitcnt lgkmcnt(4)
v_mfma_f32_32x32x16_bf16 v[120:135], v[116:119], v[236:239], v[120:135]
ds_read_b128 v[232:235], v249 offset:1024
ds_read_u16_d16 v140, v140
ds_read_u16_d16_hi v141, v141
v_fma_mix_f32 v161, v185, v185, v161 op_sel:[1,1,0] op_sel_hi:[1,1,0]
v_and_b32_e64 v143, s49, v143
v_rcp_f16_sdwa v148, v147 dst_sel:WORD_1 dst_unused:UNUSED_PRESERVE src0_sel:WORD_1
v_rcp_f16_sdwa v145, v144 dst_sel:WORD_1 dst_unused:UNUSED_PRESERVE src0_sel:WORD_1
v_pk_mul_f16 v155, v155, v154
v_bfe_u32 v142, v143, 2, 14
v_fma_mix_f32 v161, v186, v186, v161 op_sel:[0,0,0] op_sel_hi:[1,1,0]
v_pk_mul_f16 v152, v152, v151
v_pk_mul_f16 v149, v149, v148
v_smfmac_f32_16x16x32_bf16 v[4:7], v[218:219], v[200:203], v246
ds_read_b128 v[236:239], v249 offset:4096
ds_read_u16_d16 v142, v142
v_pk_mul_f16 v146, v146, v145
v_fma_mix_f32 v162, v155, v155, v162 op_sel:[0,0,0] op_sel_hi:[1,1,0]
v_lshrrev_b32 v143, 18, v143
v_fma_mix_f32 v162, v155, v155, v162 op_sel:[1,1,0] op_sel_hi:[1,1,0]
v_fma_mix_f32 v162, v152, v152, v162 op_sel:[0,0,0] op_sel_hi:[1,1,0]
v_smfmac_f32_16x16x32_bf16 v[32:35], v[216:217], v[204:207], v246
v_fma_mix_f32 v161, v187, v187, v161 op_sel:[1,1,0] op_sel_hi:[1,1,0]
v_fma_mix_f32 v162, v152, v152, v162 op_sel:[1,1,0] op_sel_hi:[1,1,0]
v_fma_mix_f32 v162, v149, v149, v162 op_sel:[0,0,0] op_sel_hi:[1,1,0]
v_fma_mix_f32 v162, v149, v149, v162 op_sel:[1,1,0] op_sel_hi:[1,1,0]
v_fma_mix_f32 v162, v146, v146, v162 op_sel:[0,0,0] op_sel_hi:[1,1,0]
v_fma_mix_f32 v162, v146, v146, v162 op_sel:[1,1,0] op_sel_hi:[1,1,0]
s_setprio 2
v_smfmac_f32_16x16x32_bf16 v[16:19], v[222:223], v[208:211], v246
ds_read_b128 v[216:219], v249 offset:2048
ds_read_u16_d16_hi v143, v143
v_cvt_pkrtz_f16_f32 v179, v120, v121
v_cvt_pkrtz_f16_f32 v181, v122, v123
v_cvt_pkrtz_f16_f32 v183, v124, v125
v_cvt_pkrtz_f16_f32 v185, v126, v127
v_smfmac_f32_16x16x32_bf16 v[0:3], v[220:221], v[212:215], v246
v_cvt_pkrtz_f16_f32 v187, v128, v129
v_cvt_pk_f16_f32 v155, v130, v131
v_cvt_pk_f16_f32 v152, v132, v133
v_cvt_pk_f16_f32 v149, v134, v135
v_pk_fma_f16 v154, v155, v155, s48
s_waitcnt lgkmcnt(2)
v_mfma_f32_32x32x16_bf16 v[120:135], v[96:99], v[224:227], 0
ds_read_b128 v[220:223], v249 offset:5120
v_and_b32 v179, s49, v179
v_fma_mix_f32 v162, v136, v136, v162 op_sel:[0,0,0] op_sel_hi:[1,1,0]
v_pk_fma_f16 v151, v152, v152, s48
v_pk_fma_f16 v148, v149, v149, s48
v_bfe_u32 v178, v179, 2, 14
v_pk_mul_f16 v154, v155, v154
v_pk_mul_f16 v151, v152, v151
v_pk_mul_f16 v148, v149, v148
v_lshrrev_b32_e64 v179, 18, v179
v_mfma_f32_32x32x16_bf16 v[120:135], v[100:103], v[228:231], v[120:135]
ds_read_b128 v[224:227], v245 offset:768
v_xor_b32_e64 v243, 16, v243
ds_read_b128 v[192:195], v243 offset:128
ds_read_b128 v[196:199], v243 offset:64
ds_read_u16_d16 v178, v178
ds_read_u16_d16_hi v179, v179
v_fma_mix_f32 v162, v137, v137, v162 op_sel:[1,1,0] op_sel_hi:[1,1,0]
v_exp_f16 v153, v154
v_and_b32 v181, s49, v181
v_exp_f16 v150, v151
v_exp_f16 v147, v148
v_bfe_u32 v180, v181, 2, 14
v_mfma_f32_32x32x16_bf16 v[120:135], v[104:107], v[232:235], v[120:135]
ds_read_b128 v[228:231], v245 offset:384
ds_read_b128 v[200:203], v243
v_xor_b32_e64 v242, 16, v242
ds_read_b128 v[204:207], v242 offset:128
ds_read_u16_d16 v180, v180
v_fma_mix_f32 v162, v138, v138, v162 op_sel:[0,0,0] op_sel_hi:[1,1,0]
v_exp_f16_sdwa v153, v154 dst_sel:WORD_1 dst_unused:UNUSED_PRESERVE src0_sel:WORD_1
v_lshrrev_b32_e64 v181, 18, v181
v_exp_f16_sdwa v150, v151 dst_sel:WORD_1 dst_unused:UNUSED_PRESERVE src0_sel:WORD_1
v_fma_mix_f32 v162, v139, v139, v162 op_sel:[1,1,0] op_sel_hi:[1,1,0]
v_and_b32_e64 v183, s49, v183
v_mfma_f32_32x32x16_bf16 v[120:135], v[108:111], v[236:239], v[120:135]
ds_read_b128 v[232:235], v249 offset:6144
ds_read_u16_d16_hi v181, v181
v_exp_f16_sdwa v147, v148 dst_sel:WORD_1 dst_unused:UNUSED_PRESERVE src0_sel:WORD_1
v_pk_add_f16 v153, v153, 1.0 op_sel_hi:[1,0]
v_bfe_u32 v182, v183, 2, 14
v_pk_add_f16 v150, v150, 1.0 op_sel_hi:[1,0]
v_pk_add_f16 v147, v147, 1.0 op_sel_hi:[1,0]
v_rcp_f16_e64 v154, v153
v_lshrrev_b32 v183, 18, v183
v_fma_mix_f32 v162, v140, v140, v162 op_sel:[0,0,0] op_sel_hi:[1,1,0]
s_waitcnt lgkmcnt(6)
v_mfma_f32_32x32x16_bf16 v[120:135], v[112:115], v[216:219], v[120:135]
ds_read_b128 v[236:239], v249 offset:9216
ds_read_u16_d16 v182, v182
ds_read_u16_d16_hi v183, v183
v_rcp_f16 v151, v150
v_and_b32 v185, s49, v185
v_rcp_f16_e64 v148, v147
v_fma_mix_f32 v162, v141, v141, v162 op_sel:[1,1,0] op_sel_hi:[1,1,0]
v_bfe_u32 v184, v185, 2, 14
v_rcp_f16_sdwa v154, v153 dst_sel:WORD_1 dst_unused:UNUSED_PRESERVE src0_sel:WORD_1
v_mfma_f32_32x32x16_bf16 v[120:135], v[116:119], v[220:223], v[120:135]
ds_read_b128 v[216:219], v249 offset:7168
ds_read_u16_d16 v184, v184
v_rcp_f16_sdwa v151, v150 dst_sel:WORD_1 dst_unused:UNUSED_PRESERVE src0_sel:WORD_1
v_lshrrev_b32_e64 v185, 18, v185
v_rcp_f16_sdwa v148, v147 dst_sel:WORD_1 dst_unused:UNUSED_PRESERVE src0_sel:WORD_1
v_and_b32_e64 v187, s49, v187
v_fma_mix_f32 v162, v142, v142, v162 op_sel:[0,0,0] op_sel_hi:[1,1,0]
v_pk_mul_f16 v155, v155, v154
v_pk_mul_f16 v152, v152, v151
v_smfmac_f32_16x16x32_bf16 v[32:35], v[226:227], v[192:195], v246
ds_read_b128 v[220:223], v249 offset:10240
ds_read_u16_d16_hi v185, v185
v_bfe_u32 v186, v187, 2, 14
v_pk_mul_f16 v149, v149, v148
v_fma_mix_f32 v163, v155, v155, v163 op_sel:[0,0,0] op_sel_hi:[1,1,0]
v_fma_mix_f32 v162, v143, v143, v162 op_sel:[1,1,0] op_sel_hi:[1,1,0]
v_lshrrev_b32_e64 v187, 18, v187
v_smfmac_f32_16x16x32_bf16 v[16:19], v[224:225], v[196:199], v246
v_fma_mix_f32 v163, v155, v155, v163 op_sel:[1,1,0] op_sel_hi:[1,1,0]
v_fma_mix_f32 v163, v152, v152, v163 op_sel:[0,0,0] op_sel_hi:[1,1,0]
v_fma_mix_f32 v163, v152, v152, v163 op_sel:[1,1,0] op_sel_hi:[1,1,0]
v_fma_mix_f32 v163, v149, v149, v163 op_sel:[0,0,0] op_sel_hi:[1,1,0]
v_fma_mix_f32 v163, v149, v149, v163 op_sel:[1,1,0] op_sel_hi:[1,1,0]
s_setprio 1
s_waitcnt lgkmcnt(4)
v_smfmac_f32_16x16x32_bf16 v[0:3], v[230:231], v[200:203], v246
ds_read_b128 v[224:227], v249 offset:8192
ds_read_u16_d16 v186, v186
ds_read_u16_d16_hi v187, v187
v_cvt_pkrtz_f16_f32 v137, v120, v121
v_cvt_pkrtz_f16_f32 v139, v122, v123
v_cvt_pkrtz_f16_f32 v141, v124, v125
v_cvt_pkrtz_f16_f32 v143, v126, v127
v_smfmac_f32_16x16x32_bf16 v[32:35], v[228:229], v[204:207], v246
v_cvt_pk_f16_f32 v155, v128, v129
v_cvt_pk_f16_f32 v152, v130, v131
v_cvt_pk_f16_f32 v149, v132, v133
v_cvt_pk_f16_f32 v146, v134, v135
v_pk_fma_f16 v154, v155, v155, s48
v_mfma_f32_32x32x16_bf16 v[120:135], v[96:99], v[232:235], 0
ds_read_b128 v[228:231], v249 offset:11264
v_and_b32_e64 v137, s49, v137
v_fma_mix_f32 v163, v178, v178, v163 op_sel:[0,0,0] op_sel_hi:[1,1,0]
v_pk_fma_f16 v151, v152, v152, s48
v_pk_fma_f16 v148, v149, v149, s48
v_pk_fma_f16 v145, v146, v146, s48
v_pk_mul_f16 v154, v155, v154
v_bfe_u32 v136, v137, 2, 14
v_pk_mul_f16 v151, v152, v151
v_fma_mix_f32 v163, v179, v179, v163 op_sel:[1,1,0] op_sel_hi:[1,1,0]
v_pk_mul_f16 v148, v149, v148
v_mfma_f32_32x32x16_bf16 v[120:135], v[100:103], v[236:239], v[120:135]
ds_read_b128 v[232:235], v245
ds_read_b128 v[208:211], v242 offset:64
ds_read_b128 v[212:215], v242
ds_read_u16_d16 v136, v136
v_pk_mul_f16 v145, v146, v145
v_exp_f16 v153, v154
v_lshrrev_b32 v137, 18, v137
v_exp_f16_e64 v150, v151
v_fma_mix_f32 v163, v180, v180, v163 op_sel:[0,0,0] op_sel_hi:[1,1,0]
v_exp_f16_e64 v147, v148
v_and_b32 v139, s49, v139
s_waitcnt lgkmcnt(5)
v_mfma_f32_32x32x16_bf16 v[120:135], v[104:107], v[216:219], v[120:135]
ds_read_b128 v[236:239], v249 offset:12288
ds_read_u16_d16_hi v137, v137
v_exp_f16_e64 v144, v145
v_exp_f16_sdwa v153, v154 dst_sel:WORD_1 dst_unused:UNUSED_PRESERVE src0_sel:WORD_1
v_fma_mix_f32 v163, v181, v181, v163 op_sel:[1,1,0] op_sel_hi:[1,1,0]
v_bfe_u32 v138, v139, 2, 14
v_exp_f16_sdwa v150, v151 dst_sel:WORD_1 dst_unused:UNUSED_PRESERVE src0_sel:WORD_1
v_exp_f16_sdwa v147, v148 dst_sel:WORD_1 dst_unused:UNUSED_PRESERVE src0_sel:WORD_1
v_mfma_f32_32x32x16_bf16 v[120:135], v[108:111], v[220:223], v[120:135]
ds_read_b128 v[216:219], v249 offset:15360
ds_read_u16_d16 v138, v138
v_exp_f16_sdwa v144, v145 dst_sel:WORD_1 dst_unused:UNUSED_PRESERVE src0_sel:WORD_1
v_lshrrev_b32_e64 v139, 18, v139
v_fma_mix_f32 v163, v182, v182, v163 op_sel:[0,0,0] op_sel_hi:[1,1,0]
v_pk_add_f16 v153, v153, 1.0 op_sel_hi:[1,0]
v_pk_add_f16 v150, v150, 1.0 op_sel_hi:[1,0]
v_pk_add_f16 v147, v147, 1.0 op_sel_hi:[1,0]
v_and_b32_e64 v141, s49, v141
v_pk_add_f16 v144, v144, 1.0 op_sel_hi:[1,0]
v_mfma_f32_32x32x16_bf16 v[120:135], v[112:115], v[224:227], v[120:135]
ds_read_b128 v[220:223], v249 offset:13312
ds_read_u16_d16_hi v139, v139
v_rcp_f16_e64 v154, v153
v_fma_mix_f32 v163, v183, v183, v163 op_sel:[1,1,0] op_sel_hi:[1,1,0]
v_rcp_f16_e64 v151, v150
v_bfe_u32 v140, v141, 2, 14
v_rcp_f16 v148, v147
v_fma_mix_f32 v163, v184, v184, v163 op_sel:[0,0,0] op_sel_hi:[1,1,0]
s_waitcnt lgkmcnt(4)
v_mfma_f32_32x32x16_bf16 v[120:135], v[116:119], v[228:231], v[120:135]
ds_read_b128 v[224:227], v249 offset:16384
ds_read_u16_d16 v140, v140
v_rcp_f16_e64 v145, v144
v_lshrrev_b32 v141, 18, v141
v_rcp_f16_sdwa v154, v153 dst_sel:WORD_1 dst_unused:UNUSED_PRESERVE src0_sel:WORD_1
s_setprio 0
v_rcp_f16_sdwa v151, v150 dst_sel:WORD_1 dst_unused:UNUSED_PRESERVE src0_sel:WORD_1
v_fma_mix_f32 v163, v185, v185, v163 op_sel:[1,1,0] op_sel_hi:[1,1,0]
v_and_b32_e64 v143, s49, v143
v_rcp_f16_sdwa v148, v147 dst_sel:WORD_1 dst_unused:UNUSED_PRESERVE src0_sel:WORD_1
v_smfmac_f32_16x16x32_bf16 v[16:19], v[234:235], v[208:211], v246
ds_read_b128 v[228:231], v249 offset:14336
ds_read_u16_d16_hi v141, v141
v_rcp_f16_sdwa v145, v144 dst_sel:WORD_1 dst_unused:UNUSED_PRESERVE src0_sel:WORD_1
v_pk_mul_f16 v155, v155, v154
v_bfe_u32 v142, v143, 2, 14
v_fma_mix_f32 v163, v186, v186, v163 op_sel:[0,0,0] op_sel_hi:[1,1,0]
v_smfmac_f32_16x16x32_bf16 v[0:3], v[232:233], v[212:215], v246
s_mov_b64 exec, 1
ds_add_u32 v253, v254 offset:16
s_mov_b64 exec, -1
v_pk_mul_f16 v152, v152, v151
v_pk_mul_f16 v149, v149, v148
v_pk_mul_f16 v146, v146, v145
v_fma_mix_f32 v164, v155, v155, v164 op_sel:[0,0,0] op_sel_hi:[1,1,0]
v_lshrrev_b32 v143, 18, v143
v_fma_mix_f32 v164, v155, v155, v164 op_sel:[1,1,0] op_sel_hi:[1,1,0]
v_fma_mix_f32 v164, v152, v152, v164 op_sel:[0,0,0] op_sel_hi:[1,1,0]
v_fma_mix_f32 v163, v187, v187, v163 op_sel:[1,1,0] op_sel_hi:[1,1,0]
v_fma_mix_f32 v164, v152, v152, v164 op_sel:[1,1,0] op_sel_hi:[1,1,0]
v_fma_mix_f32 v164, v149, v149, v164 op_sel:[0,0,0] op_sel_hi:[1,1,0]
v_fma_mix_f32 v164, v149, v149, v164 op_sel:[1,1,0] op_sel_hi:[1,1,0]
v_fma_mix_f32 v164, v146, v146, v164 op_sel:[0,0,0] op_sel_hi:[1,1,0]
v_fma_mix_f32 v164, v146, v146, v164 op_sel:[1,1,0] op_sel_hi:[1,1,0]
s_setprio 3
v_pk_add_f32 v[168:169], v[0:1], v[2:3]
v_pk_mul_f32 v[170:171], v[0:1], v[0:1]
v_pk_fma_f32 v[170:171], v[2:3], v[2:3], v[170:171]
v_pk_add_f32 v[168:169], v[168:169], v[4:5]
v_pk_fma_f32 v[170:171], v[4:5], v[4:5], v[170:171]
v_pk_add_f32 v[168:169], v[168:169], v[6:7]
v_pk_fma_f32 v[170:171], v[6:7], v[6:7], v[170:171]
v_pk_add_f32 v[168:169], v[168:169], v[8:9]
v_pk_fma_f32 v[170:171], v[8:9], v[8:9], v[170:171]
v_pk_add_f32 v[168:169], v[168:169], v[10:11]
v_pk_fma_f32 v[170:171], v[10:11], v[10:11], v[170:171]
v_pk_add_f32 v[168:169], v[168:169], v[12:13]
v_pk_fma_f32 v[170:171], v[12:13], v[12:13], v[170:171]
v_pk_add_f32 v[168:169], v[168:169], v[14:15]
v_pk_fma_f32 v[170:171], v[14:15], v[14:15], v[170:171]
v_pk_add_f32 v[168:169], v[168:169], v[16:17]
v_pk_fma_f32 v[170:171], v[16:17], v[16:17], v[170:171]
v_pk_add_f32 v[168:169], v[168:169], v[18:19]
v_pk_fma_f32 v[170:171], v[18:19], v[18:19], v[170:171]
v_pk_add_f32 v[168:169], v[168:169], v[20:21]
v_pk_fma_f32 v[170:171], v[20:21], v[20:21], v[170:171]
v_pk_add_f32 v[168:169], v[168:169], v[22:23]
v_pk_fma_f32 v[170:171], v[22:23], v[22:23], v[170:171]
v_pk_add_f32 v[168:169], v[168:169], v[24:25]
v_pk_fma_f32 v[170:171], v[24:25], v[24:25], v[170:171]
v_pk_add_f32 v[168:169], v[168:169], v[26:27]
v_pk_fma_f32 v[170:171], v[26:27], v[26:27], v[170:171]
v_pk_add_f32 v[168:169], v[168:169], v[28:29]
v_pk_fma_f32 v[170:171], v[28:29], v[28:29], v[170:171]
v_pk_add_f32 v[168:169], v[168:169], v[30:31]
v_pk_fma_f32 v[170:171], v[30:31], v[30:31], v[170:171]
v_pk_add_f32 v[168:169], v[168:169], v[32:33]
v_pk_fma_f32 v[170:171], v[32:33], v[32:33], v[170:171]
v_pk_add_f32 v[168:169], v[168:169], v[34:35]
v_pk_fma_f32 v[170:171], v[34:35], v[34:35], v[170:171]
v_pk_add_f32 v[168:169], v[168:169], v[36:37]
v_pk_fma_f32 v[170:171], v[36:37], v[36:37], v[170:171]
v_pk_add_f32 v[168:169], v[168:169], v[38:39]
v_pk_fma_f32 v[170:171], v[38:39], v[38:39], v[170:171]
v_pk_add_f32 v[168:169], v[168:169], v[40:41]
v_pk_fma_f32 v[170:171], v[40:41], v[40:41], v[170:171]
v_pk_add_f32 v[168:169], v[168:169], v[42:43]
v_pk_fma_f32 v[170:171], v[42:43], v[42:43], v[170:171]
v_pk_add_f32 v[168:169], v[168:169], v[44:45]
v_pk_fma_f32 v[170:171], v[44:45], v[44:45], v[170:171]
v_pk_add_f32 v[168:169], v[168:169], v[46:47]
v_pk_fma_f32 v[170:171], v[46:47], v[46:47], v[170:171]
s_setprio 0
v_lshrrev_b32 v252, 2, v251
v_mul_u32_u24 v252, 192, v252
v_and_b32 v240, 3, v251
v_lshl_add_u32 v252, v240, 4, v252
s_setprio 2
v_cvt_pkrtz_f16_f32 v179, v120, v121
v_cvt_pkrtz_f16_f32 v181, v122, v123
v_cvt_pkrtz_f16_f32 v183, v124, v125
v_cvt_pkrtz_f16_f32 v185, v126, v127
v_cvt_pkrtz_f16_f32 v187, v128, v129
v_cvt_pkrtz_f16_f32 v189, v130, v131
v_cvt_pk_f16_f32 v155, v132, v133
v_cvt_pk_f16_f32 v152, v134, v135
ds_read_b128 v[232:235], v249 offset:17408
ds_read_u16_d16 v142, v142
ds_read_u16_d16_hi v143, v143
v_mfma_f32_32x32x16_bf16 v[120:135], v[96:99], v[236:239], 0
v_pk_fma_f16 v154, v155, v155, s48
v_add_f32 v168, v168, v169
v_and_b32 v179, s49, v179
v_fma_mix_f32 v164, v136, v136, v164 op_sel:[0,0,0] op_sel_hi:[1,1,0]
v_bfe_u32 v178, v179, 2, 14
v_pk_fma_f16 v151, v152, v152, s48
v_add_f32_e64 v170, v170, v171
v_pk_mul_f16 v154, v155, v154
v_lshrrev_b32_e64 v179, 18, v179
v_pk_mul_f16 v151, v152, v151
v_fma_mix_f32 v164, v137, v137, v164 op_sel:[1,1,0] op_sel_hi:[1,1,0]
v_and_b32 v181, s49, v181
s_waitcnt lgkmcnt(4)
ds_read_u16_d16 v178, v178
ds_read_u16_d16_hi v179, v179
v_mfma_f32_32x32x16_bf16 v[120:135], v[100:103], v[216:219], v[120:135]
v_permlane32_swap_b32 v168, v170
v_exp_f16 v153, v154
v_bfe_u32 v180, v181, 2, 14
v_exp_f16 v150, v151
v_add_f32 v168, v168, v170
v_lshrrev_b32_e64 v181, 18, v181
v_fma_mix_f32 v164, v138, v138, v164 op_sel:[0,0,0] op_sel_hi:[1,1,0]
v_and_b32_e64 v183, s49, v183
v_exp_f16_sdwa v153, v154 dst_sel:WORD_1 dst_unused:UNUSED_PRESERVE src0_sel:WORD_1
ds_read_u16_d16 v180, v180
ds_read_u16_d16_hi v181, v181
v_mfma_f32_32x32x16_bf16 v[120:135], v[104:107], v[220:223], v[120:135]
v_mul_f32 v168, 1009429163, v168
v_bfe_u32 v182, v183, 2, 14
v_fma_mix_f32 v164, v139, v139, v164 op_sel:[1,1,0] op_sel_hi:[1,1,0]
v_exp_f16_sdwa v150, v151 dst_sel:WORD_1 dst_unused:UNUSED_PRESERVE src0_sel:WORD_1
v_mov_b32 v170, v168
v_lshrrev_b32 v183, 18, v183
v_pk_add_f16 v153, v153, 1.0 op_sel_hi:[1,0]
v_and_b32 v185, s49, v185
v_fma_mix_f32 v164, v140, v140, v164 op_sel:[0,0,0] op_sel_hi:[1,1,0]
v_bfe_u32 v184, v185, 2, 14
v_permlane32_swap_b32 v168, v170
v_pk_add_f16 v150, v150, 1.0 op_sel_hi:[1,0]
ds_read_u16_d16 v182, v182
ds_read_u16_d16_hi v183, v183
ds_read_u16_d16 v184, v184
v_mfma_f32_32x32x16_bf16 v[120:135], v[108:111], v[224:227], v[120:135]
v_rcp_f16 v154, v153
v_lshrrev_b32 v185, 18, v185
v_fma_mix_f32 v164, v141, v141, v164 op_sel:[1,1,0] op_sel_hi:[1,1,0]
v_fma_f32 v170, -v168, v168, v170
v_and_b32 v187, s49, v187
v_rcp_f16 v151, v150
v_bfe_u32 v186, v187, 2, 14
v_max_f32_e64 v170, 0, v170
v_rcp_f16_sdwa v154, v153 dst_sel:WORD_1 dst_unused:UNUSED_PRESERVE src0_sel:WORD_1
ds_read_b128 v[224:227], v249 offset:18432
ds_read_u16_d16_hi v185, v185
ds_read_u16_d16 v186, v186
v_mfma_f32_32x32x16_bf16 v[120:135], v[112:115], v[228:231], v[120:135]
v_lshrrev_b32 v187, 18, v187
s_waitcnt lgkmcnt(6)
v_fma_mix_f32 v164, v142, v142, v164 op_sel:[0,0,0] op_sel_hi:[1,1,0]
v_and_b32_e64 v189, s49, v189
v_add_f32 v170, 925353388, v170
v_rcp_f16_sdwa v151, v150 dst_sel:WORD_1 dst_unused:UNUSED_PRESERVE src0_sel:WORD_1
v_bfe_u32 v188, v189, 2, 14
v_fma_mix_f32 v164, v143, v143, v164 op_sel:[1,1,0] op_sel_hi:[1,1,0]
v_pk_mul_f16 v155, v155, v154
v_rsq_f32 v170, v170
v_lshrrev_b32 v189, 18, v189
ds_read_b128 v[228:231], v249 offset:21504
ds_read_u16_d16_hi v187, v187
ds_read_b32 v247, v253 offset:16
ds_read_u16_d16 v188, v188
ds_read_u16_d16_hi v189, v189
v_mfma_f32_32x32x16_bf16 v[120:135], v[116:119], v[232:235], v[120:135]
v_pk_mul_f16 v152, v152, v151
v_fma_mix_f32 v165, v155, v155, v165 op_sel:[0,0,0] op_sel_hi:[1,1,0]
v_fma_mix_f32 v165, v178, v178, v165 op_sel:[0,0,0] op_sel_hi:[1,1,0]
v_fma_mix_f32 v165, v179, v179, v165 op_sel:[1,1,0] op_sel_hi:[1,1,0]
v_fma_mix_f32 v165, v180, v180, v165 op_sel:[0,0,0] op_sel_hi:[1,1,0]
v_fma_mix_f32 v165, v155, v155, v165 op_sel:[1,1,0] op_sel_hi:[1,1,0]
v_fma_mix_f32 v165, v181, v181, v165 op_sel:[1,1,0] op_sel_hi:[1,1,0]
s_waitcnt lgkmcnt(5)
v_fma_mix_f32 v165, v182, v182, v165 op_sel:[0,0,0] op_sel_hi:[1,1,0]
v_mul_f32 v172, 3203391086, v170
v_fma_mix_f32 v165, v183, v183, v165 op_sel:[1,1,0] op_sel_hi:[1,1,0]
v_fma_mix_f32 v165, v152, v152, v165 op_sel:[0,0,0] op_sel_hi:[1,1,0]
v_fma_mix_f32 v165, v184, v184, v165 op_sel:[0,0,0] op_sel_hi:[1,1,0]
v_fma_mix_f32 v165, v185, v185, v165 op_sel:[1,1,0] op_sel_hi:[1,1,0]
v_fma_mix_f32 v165, v186, v186, v165 op_sel:[0,0,0] op_sel_hi:[1,1,0]
v_mul_f32 v173, v168, v172
v_fma_mix_f32 v165, v152, v152, v165 op_sel:[1,1,0] op_sel_hi:[1,1,0]
s_waitcnt lgkmcnt(3)
v_fma_mix_f32 v165, v187, v187, v165 op_sel:[1,1,0] op_sel_hi:[1,1,0]
s_waitcnt lgkmcnt(1)
v_fma_mix_f32 v165, v188, v188, v165 op_sel:[0,0,0] op_sel_hi:[1,1,0]
s_waitcnt lgkmcnt(0)
v_fma_mix_f32 v165, v189, v189, v165 op_sel:[1,1,0] op_sel_hi:[1,1,0]
s_setprio 3
v_pk_fma_f32 v[0:1], v[0:1], v[172:173], v[172:173] op_sel:[0,0,1] op_sel_hi:[1,0,1] neg_lo:[0,0,1] neg_hi:[0,0,1]
v_pk_fma_f32 v[2:3], v[2:3], v[172:173], v[172:173] op_sel:[0,0,1] op_sel_hi:[1,0,1] neg_lo:[0,0,1] neg_hi:[0,0,1]
v_pk_fma_f32 v[4:5], v[4:5], v[172:173], v[172:173] op_sel:[0,0,1] op_sel_hi:[1,0,1] neg_lo:[0,0,1] neg_hi:[0,0,1]
v_pk_fma_f32 v[6:7], v[6:7], v[172:173], v[172:173] op_sel:[0,0,1] op_sel_hi:[1,0,1] neg_lo:[0,0,1] neg_hi:[0,0,1]
v_pk_fma_f32 v[8:9], v[8:9], v[172:173], v[172:173] op_sel:[0,0,1] op_sel_hi:[1,0,1] neg_lo:[0,0,1] neg_hi:[0,0,1]
v_pk_fma_f32 v[10:11], v[10:11], v[172:173], v[172:173] op_sel:[0,0,1] op_sel_hi:[1,0,1] neg_lo:[0,0,1] neg_hi:[0,0,1]
v_pk_fma_f32 v[12:13], v[12:13], v[172:173], v[172:173] op_sel:[0,0,1] op_sel_hi:[1,0,1] neg_lo:[0,0,1] neg_hi:[0,0,1]
v_pk_fma_f32 v[14:15], v[14:15], v[172:173], v[172:173] op_sel:[0,0,1] op_sel_hi:[1,0,1] neg_lo:[0,0,1] neg_hi:[0,0,1]
v_pk_fma_f32 v[16:17], v[16:17], v[172:173], v[172:173] op_sel:[0,0,1] op_sel_hi:[1,0,1] neg_lo:[0,0,1] neg_hi:[0,0,1]
v_pk_fma_f32 v[18:19], v[18:19], v[172:173], v[172:173] op_sel:[0,0,1] op_sel_hi:[1,0,1] neg_lo:[0,0,1] neg_hi:[0,0,1]
v_pk_fma_f32 v[20:21], v[20:21], v[172:173], v[172:173] op_sel:[0,0,1] op_sel_hi:[1,0,1] neg_lo:[0,0,1] neg_hi:[0,0,1]
v_pk_fma_f32 v[22:23], v[22:23], v[172:173], v[172:173] op_sel:[0,0,1] op_sel_hi:[1,0,1] neg_lo:[0,0,1] neg_hi:[0,0,1]
v_pk_fma_f32 v[24:25], v[24:25], v[172:173], v[172:173] op_sel:[0,0,1] op_sel_hi:[1,0,1] neg_lo:[0,0,1] neg_hi:[0,0,1]
v_pk_fma_f32 v[26:27], v[26:27], v[172:173], v[172:173] op_sel:[0,0,1] op_sel_hi:[1,0,1] neg_lo:[0,0,1] neg_hi:[0,0,1]
v_pk_fma_f32 v[28:29], v[28:29], v[172:173], v[172:173] op_sel:[0,0,1] op_sel_hi:[1,0,1] neg_lo:[0,0,1] neg_hi:[0,0,1]
v_pk_fma_f32 v[30:31], v[30:31], v[172:173], v[172:173] op_sel:[0,0,1] op_sel_hi:[1,0,1] neg_lo:[0,0,1] neg_hi:[0,0,1]
v_pk_fma_f32 v[32:33], v[32:33], v[172:173], v[172:173] op_sel:[0,0,1] op_sel_hi:[1,0,1] neg_lo:[0,0,1] neg_hi:[0,0,1]
v_pk_fma_f32 v[34:35], v[34:35], v[172:173], v[172:173] op_sel:[0,0,1] op_sel_hi:[1,0,1] neg_lo:[0,0,1] neg_hi:[0,0,1]
v_pk_fma_f32 v[36:37], v[36:37], v[172:173], v[172:173] op_sel:[0,0,1] op_sel_hi:[1,0,1] neg_lo:[0,0,1] neg_hi:[0,0,1]
v_pk_fma_f32 v[38:39], v[38:39], v[172:173], v[172:173] op_sel:[0,0,1] op_sel_hi:[1,0,1] neg_lo:[0,0,1] neg_hi:[0,0,1]
v_pk_fma_f32 v[40:41], v[40:41], v[172:173], v[172:173] op_sel:[0,0,1] op_sel_hi:[1,0,1] neg_lo:[0,0,1] neg_hi:[0,0,1]
v_pk_fma_f32 v[42:43], v[42:43], v[172:173], v[172:173] op_sel:[0,0,1] op_sel_hi:[1,0,1] neg_lo:[0,0,1] neg_hi:[0,0,1]
v_pk_fma_f32 v[44:45], v[44:45], v[172:173], v[172:173] op_sel:[0,0,1] op_sel_hi:[1,0,1] neg_lo:[0,0,1] neg_hi:[0,0,1]
v_pk_fma_f32 v[46:47], v[46:47], v[172:173], v[172:173] op_sel:[0,0,1] op_sel_hi:[1,0,1] neg_lo:[0,0,1] neg_hi:[0,0,1]
s_setprio 2
v_readfirstlane_b32 s43, v247
s_nop 1
s_cmp_ge_u32 s43, 32
s_cbranch_scc1 Lev9
Lev9w:
s_sleep 1
ds_read_b32 v247, v253 offset:16
s_waitcnt lgkmcnt(0)
v_readfirstlane_b32 s43, v247
s_cmp_eq_u32 s76, 0
s_cbranch_scc1 Lev9
s_sub_u32 s76, s76, 1
s_cmp_lt_u32 s43, 32
s_cbranch_scc1 Lev9w
Lev9:
s_setprio 1
v_cvt_pkrtz_f16_f32 v137, v120, v121
v_cvt_pkrtz_f16_f32 v139, v122, v123
v_cvt_pkrtz_f16_f32 v141, v124, v125
v_cvt_pkrtz_f16_f32 v143, v126, v127
v_cvt_pkrtz_f16_f32 v145, v128, v129
v_cvt_pkrtz_f16_f32 v147, v130, v131
v_cvt_pk_f16_f32 v155, v132, v133
v_cvt_pk_f16_f32 v152, v134, v135
s_add_u32 m0, s72, 0
s_add_u32 s43, s82, 0
buffer_load_dwordx4 v252, s[16:19], s43 offen lds
ds_read_b128 v[232:235], v249 offset:19456
ds_read_b128 v[236:239], v249 offset:22528
v_mfma_f32_32x32x16_bf16 v[120:135], v[224:227], v[96:99], 0
v_pk_fma_f16 v154, v155, v155, s48
v_and_b32_e64 v192, 1, v251
v_cvt_pk_bf16_f32 v168, v0, v1
v_and_b32_e64 v137, s49, v137
v_pk_fma_f16 v151, v152, v152, s48
v_cvt_pk_bf16_f32 v169, v2, v3
v_lshlrev_b32 v192, 4, v192
v_and_b32 v139, s49, v139
v_pk_mul_f16 v154, v155, v154
v_cvt_pk_bf16_f32 v170, v4, v5
v_bfe_u32 v136, v137, 2, 14
v_mov_b32 v193, 15360
v_pk_mul_f16 v151, v152, v151
v_bfe_u32 v138, v139, 2, 14
v_cvt_pk_bf16_f32 v171, v6, v7
ds_read_b128 v[224:227], v249 offset:20480
ds_read_u16_d16 v136, v136
ds_read_u16_d16 v138, v138
v_mfma_f32_32x32x16_bf16 v[120:135], v[228:231], v[100:103], v[120:135]
v_exp_f16 v153, v154
v_lshlrev_b32 v192, v192, v193
v_cvt_pk_bf16_f32 v172, v8, v9
v_lshrrev_b32 v137, 18, v137
v_exp_f16 v150, v151
v_lshrrev_b32_e64 v193, 3, v251
v_cvt_pk_bf16_f32 v173, v10, v11
v_lshrrev_b32 v139, 18, v139
v_and_b32 v141, s49, v141
v_xor_b32_e64 v193, v193, v251
v_cvt_pk_bf16_f32 v174, v12, v13
v_exp_f16_sdwa v153, v154 dst_sel:WORD_1 dst_unused:UNUSED_PRESERVE src0_sel:WORD_1
v_cvt_pk_bf16_f32 v175, v14, v15
v_and_b32_e64 v193, 4, v193
s_waitcnt lgkmcnt(3)
s_add_u32 m0, s72, 1024
s_add_u32 s43, s82, 64
buffer_load_dwordx4 v252, s[16:19], s43 offen lds
ds_read_b128 v[228:231], v249 offset:23552
ds_read_u16_d16_hi v137, v137
ds_read_u16_d16_hi v139, v139
v_mfma_f32_32x32x16_bf16 v[120:135], v[232:235], v[104:107], v[120:135]
v_and_b32_e64 v143, s49, v143
v_bfe_u32 v140, v141, 2, 14
v_exp_f16_sdwa v150, v151 dst_sel:WORD_1 dst_unused:UNUSED_PRESERVE src0_sel:WORD_1
v_bfe_u32 v194, v251, 3, 2
v_cvt_pk_bf16_f32 v176, v16, v17
v_bfe_u32 v142, v143, 2, 14
v_cvt_pk_bf16_f32 v177, v18, v19
v_pk_add_f16 v153, v153, 1.0 op_sel_hi:[1,0]
v_lshl_add_u32 v193, v193, 1, 0
v_lshrrev_b32_e64 v141, 18, v141
v_pk_add_f16 v150, v150, 1.0 op_sel_hi:[1,0]
v_cvt_pk_bf16_f32 v178, v20, v21
v_lshrrev_b32_e64 v143, 18, v143
v_lshl_add_u32 v193, v194, 1, v193
ds_read_b128 v[232:235], v248 offset:16384
ds_read_u16_d16 v140, v140
ds_read_u16_d16 v142, v142
ds_read_u16_d16_hi v141, v141
ds_read_u16_d16_hi v143, v143
v_mfma_f32_32x32x16_bf16 v[120:135], v[236:239], v[108:111], v[120:135]
v_rcp_f16_e64 v154, v153
v_cvt_pk_bf16_f32 v179, v22, v23
v_and_b32 v145, s49, v145
v_and_b32 v147, s49, v147
v_bfe_u32 v194, v251, 1, 1
v_cvt_pk_bf16_f32 v180, v24, v25
v_rcp_f16_e64 v151, v150
v_cvt_pk_bf16_f32 v181, v26, v27
v_add_u32_e64 v193, v193, v194
v_bfe_u32 v144, v145, 2, 14
v_rcp_f16_sdwa v154, v153 dst_sel:WORD_1 dst_unused:UNUSED_PRESERVE src0_sel:WORD_1
v_cvt_pk_bf16_f32 v182, v28, v29
v_cmp_eq_u32 vcc, 0, v193
s_nop 1
v_cndmask_b32 v240, 0, v192, vcc
v_bfe_u32 v146, v147, 2, 14
s_waitcnt lgkmcnt(5)
s_add_u32 m0, s72, 2048
s_add_u32 s43, s82, 128
buffer_load_dwordx4 v252, s[16:19], s43 offen lds
ds_read_b128 v[236:239], v248 offset:19456
ds_read_u16_d16 v144, v144
ds_read_u16_d16 v146, v146
v_mfma_f32_32x32x16_bf16 v[120:135], v[224:227], v[112:115], v[120:135]
v_lshrrev_b32_e64 v145, 18, v145
v_cvt_pk_bf16_f32 v183, v30, v31
v_rcp_f16_sdwa v151, v150 dst_sel:WORD_1 dst_unused:UNUSED_PRESERVE src0_sel:WORD_1
v_cmp_eq_u32 vcc, 1, v193
s_nop 1
v_cndmask_b32_e64 v241, 0, v192, vcc
v_cvt_pk_bf16_f32 v184, v32, v33
s_setprio 0
v_lshrrev_b32 v147, 18, v147
v_pk_mul_f16 v155, v155, v154
v_cmp_eq_u32 vcc, 2, v193
s_nop 1
v_cndmask_b32_e64 v242, 0, v192, vcc
v_fma_mix_f32 v166, v136, v136, v166 op_sel:[0,0,0] op_sel_hi:[1,1,0]
v_cvt_pk_bf16_f32 v185, v34, v35
v_fma_mix_f32 v166, v137, v137, v166 op_sel:[1,1,0] op_sel_hi:[1,1,0]
v_pk_mul_f16 v152, v152, v151
v_cmp_eq_u32 vcc, 3, v193
s_nop 1
v_cndmask_b32_e64 v243, 0, v192, vcc
v_cvt_pk_bf16_f32 v186, v36, v37
v_fma_mix_f32 v166, v138, v138, v166 op_sel:[0,0,0] op_sel_hi:[1,1,0]
ds_read_b128 v[224:227], v248 offset:17408
ds_read_u16_d16_hi v145, v145
ds_read_u16_d16_hi v147, v147
v_mfma_f32_32x32x16_bf16 v[120:135], v[228:231], v[116:119], v[120:135]
v_fma_mix_f32 v166, v139, v139, v166 op_sel:[1,1,0] op_sel_hi:[1,1,0]
v_cvt_pk_bf16_f32 v187, v38, v39
v_cmp_eq_u32 vcc, 4, v193
s_nop 1
v_cndmask_b32 v244, 0, v192, vcc
v_fma_mix_f32 v166, v155, v155, v166 op_sel:[0,0,0] op_sel_hi:[1,1,0]
s_waitcnt lgkmcnt(3)
v_fma_mix_f32 v166, v140, v140, v166 op_sel:[0,0,0] op_sel_hi:[1,1,0]
v_fma_mix_f32 v166, v141, v141, v166 op_sel:[1,1,0] op_sel_hi:[1,1,0]
v_cvt_pk_bf16_f32 v188, v40, v41
v_cmp_eq_u32 vcc, 5, v193
s_nop 1
v_cndmask_b32_e64 v245, 0, v192, vcc
v_fma_mix_f32 v166, v155, v155, v166 op_sel:[1,1,0] op_sel_hi:[1,1,0]
v_fma_mix_f32 v166, v142, v142, v166 op_sel:[0,0,0] op_sel_hi:[1,1,0]
v_cvt_pk_bf16_f32 v189, v42, v43
v_fma_mix_f32 v166, v143, v143, v166 op_sel:[1,1,0] op_sel_hi:[1,1,0]
v_cmp_eq_u32 vcc, 6, v193
s_nop 1
v_cndmask_b32_e64 v246, 0, v192, vcc
v_fma_mix_f32 v166, v152, v152, v166 op_sel:[0,0,0] op_sel_hi:[1,1,0]
v_fma_mix_f32 v166, v144, v144, v166 op_sel:[0,0,0] op_sel_hi:[1,1,0]
v_cvt_pk_bf16_f32 v190, v44, v45
s_waitcnt lgkmcnt(0)
v_fma_mix_f32 v166, v145, v145, v166 op_sel:[1,1,0] op_sel_hi:[1,1,0]
v_cmp_eq_u32 vcc, 7, v193
s_nop 1
v_cndmask_b32_e64 v247, 0, v192, vcc
v_fma_mix_f32 v166, v152, v152, v166 op_sel:[1,1,0] op_sel_hi:[1,1,0]
v_cvt_pk_bf16_f32 v191, v46, v47
v_fma_mix_f32 v166, v146, v146, v166 op_sel:[0,0,0] op_sel_hi:[1,1,0]
v_fma_mix_f32 v166, v147, v147, v166 op_sel:[1,1,0] op_sel_hi:[1,1,0]
s_setprio 2
v_cvt_pkrtz_f16_f32 v137, v120, v121
v_cvt_pkrtz_f16_f32 v139, v122, v123
v_cvt_pkrtz_f16_f32 v141, v124, v125
v_cvt_pkrtz_f16_f32 v143, v126, v127
v_cvt_pkrtz_f16_f32 v145, v128, v129
v_cvt_pk_f16_f32 v155, v130, v131
v_cvt_pk_f16_f32 v152, v132, v133
v_cvt_pk_f16_f32 v149, v134, v135
s_add_u32 m0, s72, 3072
s_add_u32 s43, s82, 3072
buffer_load_dwordx4 v252, s[16:19], s43 offen lds
ds_read_b128 v[228:231], v248 offset:20480
v_mfma_f32_32x32x16_bf16 v[120:135], v[232:235], v[168:171], 0
v_pk_fma_f16 v154, v155, v155, s48
v_mov_b32 v88, v48
v_and_b32 v137, s49, v137
v_pk_fma_f16 v151, v152, v152, s48
v_and_b32_e64 v139, s49, v139
v_pk_fma_f16 v148, v149, v149, s48
v_pk_mul_f16 v154, v155, v154
v_bfe_u32 v136, v137, 2, 14
v_pk_mul_f16 v151, v152, v151
ds_read_b128 v[232:235], v248 offset:18432
ds_read_u16_d16 v136, v136
v_mfma_f32_32x32x16_bf16 v[120:135], v[236:239], v[172:175], v[120:135]
v_mov_b32_e64 v89, v49
v_pk_mul_f16 v148, v149, v148
v_bfe_u32 v138, v139, 2, 14
v_exp_f16 v153, v154
v_lshrrev_b32 v137, 18, v137
v_exp_f16 v150, v151
v_mov_b32 v90, v50
v_lshrrev_b32_e64 v139, 18, v139
s_add_u32 m0, s72, 4096
s_add_u32 s43, s82, 3136
buffer_load_dwordx4 v252, s[16:19], s43 offen lds
ds_read_b128 v[236:239], v248 offset:21504
ds_read_u16_d16 v138, v138
ds_read_u16_d16_hi v137, v137
ds_read_u16_d16_hi v139, v139
v_mfma_f32_32x32x16_bf16 v[120:135], v[224:227], v[176:179], v[120:135]
v_exp_f16 v147, v148
v_and_b32 v141, s49, v141
v_and_b32_e64 v143, s49, v143
v_exp_f16_sdwa v153, v154 dst_sel:WORD_1 dst_unused:UNUSED_PRESERVE src0_sel:WORD_1
v_mov_b32 v91, v51
v_bfe_u32 v140, v141, 2, 14
s_waitcnt lgkmcnt(5)
ds_read_b128 v[224:227], v248 offset:22528
ds_read_u16_d16 v140, v140
v_mfma_f32_32x32x16_bf16 v[120:135], v[228:231], v[180:183], v[120:135]
v_exp_f16_sdwa v150, v151 dst_sel:WORD_1 dst_unused:UNUSED_PRESERVE src0_sel:WORD_1
v_bfe_u32 v142, v143, 2, 14
v_exp_f16_sdwa v147, v148 dst_sel:WORD_1 dst_unused:UNUSED_PRESERVE src0_sel:WORD_1
v_lshrrev_b32 v141, 18, v141
v_mov_b32 v92, v52
v_pk_add_f16 v153, v153, 1.0 op_sel_hi:[1,0]
v_lshrrev_b32_e64 v143, 18, v143
v_pk_add_f16 v150, v150, 1.0 op_sel_hi:[1,0]
v_pk_add_f16 v147, v147, 1.0 op_sel_hi:[1,0]
s_add_u32 m0, s72, 5120
s_add_u32 s43, s82, 3200
buffer_load_dwordx4 v252, s[16:19], s43 offen lds
ds_read_b128 v[228:231], v248 offset:25600
ds_read_u16_d16 v142, v142
ds_read_u16_d16_hi v141, v141
ds_read_u16_d16_hi v143, v143
v_mfma_f32_32x32x16_bf16 v[120:135], v[232:235], v[184:187], v[120:135]
v_and_b32 v145, s49, v145
v_rcp_f16 v154, v153
v_mov_b32_e64 v93, v53
v_bfe_u32 v144, v145, 2, 14
v_rcp_f16 v151, v150
v_lshrrev_b32 v145, 18, v145
v_rcp_f16 v148, v147
s_waitcnt lgkmcnt(4)
ds_read_b128 v[232:235], v248 offset:23552
ds_read_u16_d16 v144, v144
ds_read_u16_d16_hi v145, v145
v_mfma_f32_32x32x16_bf16 v[120:135], v[236:239], v[188:191], v[120:135]
v_or_b32 v216, v136, v137
v_mov_b32 v94, v54
v_or_b32_e64 v217, v138, v139
v_rcp_f16_sdwa v154, v153 dst_sel:WORD_1 dst_unused:UNUSED_PRESERVE src0_sel:WORD_1
s_waitcnt lgkmcnt(4)
v_or_b32 v218, v140, v141
v_rcp_f16_sdwa v151, v150 dst_sel:WORD_1 dst_unused:UNUSED_PRESERVE src0_sel:WORD_1
s_waitcnt lgkmcnt(3)
v_or_b32 v219, v142, v143
v_mov_b32_e64 v95, v55
v_rcp_f16_sdwa v148, v147 dst_sel:WORD_1 dst_unused:UNUSED_PRESERVE src0_sel:WORD_1
s_waitcnt lgkmcnt(0)
v_or_b32 v220, v144, v145
v_pk_mul_f16 v221, v155, v154
v_pk_mul_f16 v222, v152, v151
v_pk_mul_f16 v223, v149, v148
s_cmp_lg_u32 s40, 0
s_cbranch_scc1 Lrs0
v_mov_b32 v82, 0
buffer_load_dword v83, v82, s[36:39], 0 offen sc1
Lrs0:
s_setprio 1
s_add_u32 m0, s72, 6144
s_add_u32 s43, s82, 6144
buffer_load_dwordx4 v252, s[16:19], s43 offen lds
ds_read_b128 v[236:239], v248 offset:26624
v_mfma_f32_32x32x16_f16 v[192:207], v[216:219], v[240:243], 0
v_cvt_pkrtz_f16_f32 v137, v120, v121
v_cvt_pkrtz_f16_f32 v139, v122, v123
v_cvt_pkrtz_f16_f32 v141, v124, v125
v_cvt_pkrtz_f16_f32 v143, v126, v127
v_cvt_pkrtz_f16_f32 v145, v128, v129
v_mfma_f32_32x32x16_f16 v[192:207], v[220:223], v[244:247], v[192:207]
v_cvt_pkrtz_f16_f32 v147, v130, v131
v_cvt_pk_f16_f32 v155, v132, v133
v_cvt_pk_f16_f32 v152, v134, v135
v_pk_fma_f16 v154, v155, v155, s48
v_mov_b32 v208, v56
v_and_b32 v255, 51, v251
v_mfma_f32_32x32x16_bf16 v[120:135], v[224:227], v[168:171], 0
v_and_b32_e64 v137, s49, v137
v_pk_fma_f16 v151, v152, v152, s48
v_and_b32_e64 v139, s49, v139
v_pk_mul_f16 v154, v155, v154
v_bfe_u32 v136, v137, 2, 14
v_pk_mul_f16 v151, v152, v151
v_bfe_u32 v138, v139, 2, 14
v_mov_b32 v209, v57
v_exp_f16 v153, v154
v_fmac_f32_e64 v167, v192, v192
ds_read_b128 v[224:227], v248 offset:24576
ds_read_u16_d16 v136, v136
ds_read_u16_d16 v138, v138
v_mfma_f32_32x32x16_bf16 v[120:135], v[228:231], v[172:175], v[120:135]
v_bfe_u32 v87, v251, 2, 1
v_lshrrev_b32 v137, 18, v137
v_fmac_f32 v167, v193, v193
v_exp_f16 v150, v151
v_lshrrev_b32 v139, 18, v139
v_mov_b32 v210, v58
v_fmac_f32 v167, v194, v194
v_and_b32_e64 v141, s49, v141
v_exp_f16_sdwa v153, v154 dst_sel:WORD_1 dst_unused:UNUSED_PRESERVE src0_sel:WORD_1
v_fmac_f32_e64 v167, v195, v195
ds_read_b128 v[228:231], v248 offset:27648
ds_read_u16_d16_hi v137, v137
ds_read_u16_d16_hi v139, v139
v_mfma_f32_32x32x16_bf16 v[120:135], v[232:235], v[176:179], v[120:135]
v_and_b32_e64 v143, s49, v143
v_lshl_add_u32 v255, v87, 3, v255
v_bfe_u32 v140, v141, 2, 14
v_fmac_f32 v167, v196, v196
v_mov_b32 v211, v59
v_exp_f16_sdwa v150, v151 dst_sel:WORD_1 dst_unused:UNUSED_PRESERVE src0_sel:WORD_1
v_fmac_f32_e64 v167, v197, v197
v_bfe_u32 v142, v143, 2, 14
v_pk_add_f16 v153, v153, 1.0 op_sel_hi:[1,0]
v_lshrrev_b32 v141, 18, v141
s_waitcnt lgkmcnt(3)
ds_read_b128 v[232:235], v248 offset:28672
ds_read_u16_d16 v140, v140
ds_read_u16_d16 v142, v142
ds_read_u16_d16_hi v141, v141
v_mfma_f32_32x32x16_bf16 v[120:135], v[236:239], v[180:183], v[120:135]
v_fmac_f32_e64 v167, v198, v198
v_pk_add_f16 v150, v150, 1.0 op_sel_hi:[1,0]
v_lshrrev_b32 v143, 18, v143
v_mov_b32 v212, v60
v_bfe_u32 v87, v251, 3, 1
v_fmac_f32 v167, v199, v199
v_rcp_f16 v154, v153
v_and_b32 v145, s49, v145
v_fmac_f32 v167, v200, v200
v_and_b32_e64 v147, s49, v147
ds_read_b128 v[236:239], v248 offset:31744
ds_read_u16_d16_hi v143, v143
v_mfma_f32_32x32x16_bf16 v[120:135], v[224:227], v[184:187], v[120:135]
v_rcp_f16 v151, v150
v_mov_b32 v213, v61
v_fmac_f32 v167, v201, v201
v_bfe_u32 v144, v145, 2, 14
s_setprio 0
v_lshl_add_u32 v255, v87, 2, v255
v_rcp_f16_sdwa v154, v153 dst_sel:WORD_1 dst_unused:UNUSED_PRESERVE src0_sel:WORD_1
v_fmac_f32_e64 v167, v202, v202
v_bfe_u32 v146, v147, 2, 14
v_fmac_f32_e64 v167, v203, v203
v_mov_b32 v214, v62
s_waitcnt lgkmcnt(2)
ds_read_b128 v[224:227], v248 offset:29696
ds_read_u16_d16 v144, v144
ds_read_u16_d16 v146, v146
v_mfma_f32_32x32x16_bf16 v[120:135], v[228:231], v[188:191], v[120:135]
v_lshrrev_b32_e64 v145, 18, v145
v_rcp_f16_sdwa v151, v150 dst_sel:WORD_1 dst_unused:UNUSED_PRESERVE src0_sel:WORD_1
v_fmac_f32 v167, v204, v204
v_lshrrev_b32 v147, 18, v147
v_or_b32_e64 v0, v136, v137
v_lshl_add_u32 v255, v255, 2, s72
v_fmac_f32 v167, v205, v205
v_or_b32 v1, v138, v139
v_mov_b32 v215, v63
v_or_b32 v2, v140, v141
s_waitcnt lgkmcnt(3)
v_or_b32 v3, v142, v143
v_fmac_f32_e64 v167, v206, v206
ds_read_u16_d16_hi v145, v145
ds_read_u16_d16_hi v147, v147
s_waitcnt lgkmcnt(1)
v_or_b32 v4, v144, v145
s_waitcnt lgkmcnt(0)
v_or_b32 v5, v146, v147
v_fmac_f32 v167, v207, v207
v_pk_mul_f16 v6, v155, v154
v_pk_mul_f16 v7, v152, v151
s_setprio 2
ds_read_b128 v[228:231], v248 offset:32768
v_mfma_f32_32x32x16_f16 v[192:207], v[0:3], v[240:243], 0
v_cvt_pkrtz_f16_f32 v137, v120, v121
v_cvt_pkrtz_f16_f32 v139, v122, v123
v_cvt_pkrtz_f16_f32 v141, v124, v125
v_cvt_pkrtz_f16_f32 v143, v126, v127
v_cvt_pkrtz_f16_f32 v145, v128, v129
v_mfma_f32_32x32x16_f16 v[192:207], v[4:7], v[244:247], v[192:207]
v_cvt_pk_f16_f32 v155, v130, v131
v_cvt_pk_f16_f32 v152, v132, v133
v_cvt_pk_f16_f32 v149, v134, v135
v_pk_fma_f16 v154, v155, v155, s48
v_and_b32_e64 v137, s49, v137
v_mfma_f32_32x32x16_bf16 v[120:135], v[232:235], v[168:171], 0
v_pk_fma_f16 v151, v152, v152, s48
v_and_b32_e64 v139, s49, v139
v_pk_fma_f16 v148, v149, v149, s48
v_pk_mul_f16 v154, v155, v154
v_bfe_u32 v136, v137, 2, 14
v_pk_mul_f16 v151, v152, v151
v_pk_mul_f16 v148, v149, v148
v_bfe_u32 v138, v139, 2, 14
v_fmac_f32 v156, v192, v192
v_exp_f16 v153, v154
ds_read_b128 v[232:235], v248 offset:30720
ds_read_u16_d16 v136, v136
ds_read_u16_d16 v138, v138
v_mfma_f32_32x32x16_bf16 v[120:135], v[236:239], v[172:175], v[120:135]
v_fmac_f32 v156, v193, v193
v_lshrrev_b32 v137, 18, v137
v_exp_f16 v150, v151
v_fmac_f32 v156, v194, v194
v_lshrrev_b32 v139, 18, v139
v_exp_f16 v147, v148
v_fmac_f32 v156, v195, v195
v_and_b32 v141, s49, v141
ds_read_b128 v[236:239], v248 offset:33792
ds_read_u16_d16_hi v137, v137
ds_read_u16_d16_hi v139, v139
v_mfma_f32_32x32x16_bf16 v[120:135], v[224:227], v[176:179], v[120:135]
v_and_b32_e64 v143, s49, v143
v_exp_f16_sdwa v153, v154 dst_sel:WORD_1 dst_unused:UNUSED_PRESERVE src0_sel:WORD_1
v_fmac_f32_e64 v156, v196, v196
v_bfe_u32 v140, v141, 2, 14
v_exp_f16_sdwa v150, v151 dst_sel:WORD_1 dst_unused:UNUSED_PRESERVE src0_sel:WORD_1
v_fmac_f32 v156, v197, v197
v_bfe_u32 v142, v143, 2, 14
v_exp_f16_sdwa v147, v148 dst_sel:WORD_1 dst_unused:UNUSED_PRESERVE src0_sel:WORD_1
s_waitcnt lgkmcnt(6)
ds_read_b128 v[224:227], v248 offset:34816
ds_read_u16_d16 v140, v140
ds_read_u16_d16 v142, v142
v_mfma_f32_32x32x16_bf16 v[120:135], v[228:231], v[180:183], v[120:135]
v_fmac_f32 v156, v198, v198
v_lshrrev_b32 v141, 18, v141
v_pk_add_f16 v153, v153, 1.0 op_sel_hi:[1,0]
v_fmac_f32 v156, v199, v199
v_lshrrev_b32 v143, 18, v143
v_pk_add_f16 v150, v150, 1.0 op_sel_hi:[1,0]
v_pk_add_f16 v147, v147, 1.0 op_sel_hi:[1,0]
v_fmac_f32_e64 v156, v200, v200
v_and_b32 v145, s49, v145
s_waitcnt lgkmcnt(4)
ds_read_b128 v[228:231], v248 offset:37888
ds_read_u16_d16_hi v141, v141
ds_read_u16_d16_hi v143, v143
v_mfma_f32_32x32x16_bf16 v[120:135], v[232:235], v[184:187], v[120:135]
v_rcp_f16 v154, v153
v_fmac_f32 v156, v201, v201
v_bfe_u32 v144, v145, 2, 14
v_rcp_f16 v151, v150
v_fmac_f32 v156, v202, v202
v_lshrrev_b32 v145, 18, v145
v_rcp_f16 v148, v147
v_fmac_f32 v156, v203, v203
v_or_b32 v8, v136, v137
ds_read_b128 v[232:235], v248 offset:35840
ds_read_u16_d16 v144, v144
ds_read_u16_d16_hi v145, v145
v_mfma_f32_32x32x16_bf16 v[120:135], v[236:239], v[188:191], v[120:135]
s_waitcnt lgkmcnt(6)
v_or_b32 v9, v138, v139
v_rcp_f16_sdwa v154, v153 dst_sel:WORD_1 dst_unused:UNUSED_PRESERVE src0_sel:WORD_1
v_fmac_f32 v156, v204, v204
s_waitcnt lgkmcnt(4)
v_or_b32_e64 v10, v140, v141
v_rcp_f16_sdwa v151, v150 dst_sel:WORD_1 dst_unused:UNUSED_PRESERVE src0_sel:WORD_1
v_fmac_f32 v156, v205, v205
s_waitcnt lgkmcnt(3)
v_or_b32_e64 v11, v142, v143
v_rcp_f16_sdwa v148, v147 dst_sel:WORD_1 dst_unused:UNUSED_PRESERVE src0_sel:WORD_1
v_fmac_f32 v156, v206, v206
s_waitcnt lgkmcnt(0)
v_or_b32_e64 v12, v144, v145
v_pk_mul_f16 v13, v155, v154
v_fmac_f32 v156, v207, v207
v_pk_mul_f16 v14, v152, v151
v_pk_mul_f16 v15, v149, v148
s_setprio 1
ds_read_b128 v[236:239], v248 offset:38912
v_mfma_f32_32x32x16_f16 v[192:207], v[8:11], v[240:243], 0
v_cvt_pkrtz_f16_f32 v137, v120, v121
v_cvt_pkrtz_f16_f32 v139, v122, v123
v_cvt_pkrtz_f16_f32 v141, v124, v125
v_cvt_pkrtz_f16_f32 v143, v126, v127
v_mfma_f32_32x32x16_f16 v[192:207], v[12:15], v[244:247], v[192:207]
v_cvt_pkrtz_f16_f32 v145, v128, v129
v_cvt_pkrtz_f16_f32 v147, v130, v131
v_cvt_pk_f16_f32 v155, v132, v133
v_cvt_pk_f16_f32 v152, v134, v135
v_pk_fma_f16 v154, v155, v155, s48
v_mfma_f32_32x32x16_bf16 v[120:135], v[224:227], v[168:171], 0
v_and_b32_e64 v137, s49, v137
v_pk_fma_f16 v151, v152, v152, s48
v_and_b32_e64 v139, s49, v139
v_pk_mul_f16 v154, v155, v154
v_bfe_u32 v136, v137, 2, 14
v_pk_mul_f16 v151, v152, v151
v_bfe_u32 v138, v139, 2, 14
v_exp_f16 v153, v154
v_fmac_f32 v157, v192, v192
ds_read_b128 v[224:227], v248 offset:36864
ds_read_u16_d16 v136, v136
ds_read_u16_d16 v138, v138
v_mfma_f32_32x32x16_bf16 v[120:135], v[228:231], v[172:175], v[120:135]
v_lshrrev_b32 v137, 18, v137
v_fmac_f32 v157, v193, v193
v_exp_f16 v150, v151
v_fmac_f32 v157, v194, v194
v_lshrrev_b32 v139, 18, v139
v_and_b32 v141, s49, v141
v_fmac_f32_e64 v157, v195, v195
v_exp_f16_sdwa v153, v154 dst_sel:WORD_1 dst_unused:UNUSED_PRESERVE src0_sel:WORD_1
ds_read_b128 v[228:231], v248 offset:39936
ds_read_u16_d16_hi v137, v137
ds_read_u16_d16_hi v139, v139
v_mfma_f32_32x32x16_bf16 v[120:135], v[232:235], v[176:179], v[120:135]
v_fmac_f32 v157, v196, v196
v_and_b32 v143, s49, v143
v_bfe_u32 v140, v141, 2, 14
v_fmac_f32_e64 v157, v197, v197
v_exp_f16_sdwa v150, v151 dst_sel:WORD_1 dst_unused:UNUSED_PRESERVE src0_sel:WORD_1
v_fmac_f32_e64 v157, v198, v198
v_bfe_u32 v142, v143, 2, 14
v_pk_add_f16 v153, v153, 1.0 op_sel_hi:[1,0]
v_fmac_f32 v157, v199, v199
s_waitcnt lgkmcnt(5)
ds_read_b128 v[232:235], v248 offset:40960
ds_read_u16_d16 v140, v140
ds_read_u16_d16 v142, v142
v_mfma_f32_32x32x16_bf16 v[120:135], v[236:239], v[180:183], v[120:135]
v_lshrrev_b32_e64 v141, 18, v141
v_pk_add_f16 v150, v150, 1.0 op_sel_hi:[1,0]
v_fmac_f32 v157, v200, v200
v_lshrrev_b32 v143, 18, v143
v_rcp_f16 v154, v153
v_fmac_f32 v157, v201, v201
v_and_b32 v145, s49, v145
v_and_b32 v147, s49, v147
v_fmac_f32_e64 v157, v202, v202
ds_read_b128 v[236:239], v248 offset:44032
ds_read_u16_d16_hi v141, v141
ds_read_u16_d16_hi v143, v143
v_mfma_f32_32x32x16_bf16 v[120:135], v[224:227], v[184:187], v[120:135]
v_rcp_f16 v151, v150
v_fmac_f32 v157, v203, v203
v_bfe_u32 v144, v145, 2, 14
s_setprio 0
v_rcp_f16_sdwa v154, v153 dst_sel:WORD_1 dst_unused:UNUSED_PRESERVE src0_sel:WORD_1
v_fmac_f32 v157, v204, v204
v_bfe_u32 v146, v147, 2, 14
v_fmac_f32_e64 v157, v205, v205
v_lshrrev_b32 v145, 18, v145
s_waitcnt lgkmcnt(4)
ds_read_b128 v[224:227], v248 offset:41984
ds_read_u16_d16 v144, v144
ds_read_u16_d16 v146, v146
ds_read_u16_d16_hi v145, v145
v_mfma_f32_32x32x16_bf16 v[120:135], v[228:231], v[188:191], v[120:135]
v_rcp_f16_sdwa v151, v150 dst_sel:WORD_1 dst_unused:UNUSED_PRESERVE src0_sel:WORD_1
v_fmac_f32 v157, v206, v206
v_lshrrev_b32 v147, 18, v147
v_fmac_f32 v157, v207, v207
v_or_b32 v16, v136, v137
v_or_b32 v17, v138, v139
v_permlane32_swap_b32 v156, v157
s_waitcnt lgkmcnt(5)
v_or_b32 v18, v140, v141
s_waitcnt lgkmcnt(4)
v_or_b32 v19, v142, v143
s_waitcnt lgkmcnt(0)
v_or_b32 v20, v144, v145
ds_read_u16_d16_hi v147, v147
s_waitcnt lgkmcnt(0)
v_or_b32 v21, v146, v147
v_add_f32_e64 v156, v156, v157
ds_write_b32 v255, v156 offset:7168
v_pk_mul_f16 v22, v155, v154
v_pk_mul_f16 v23, v152, v151
s_cmp_lg_u32 s40, 0
s_cbranch_scc1 Lrs1
v_mov_b32 v82, 0
Lpi:
s_waitcnt vmcnt(0)
v_readfirstlane_b32 s43, v83
s_cmp_eq_u32 s76, 0
s_cbranch_scc1 Lpix
s_sub_u32 s76, s76, 1
s_cmp_ge_u32 s43, 256
s_cbranch_scc1 Lpix
buffer_load_dword v83, v82, s[36:39], 0 offen sc1
s_branch Lpi
Lpix:
v_min_u32_e64 v80, 47, v251
v_lshlrev_b32 v80, 3, v80
s_and_b32 s44, s2, 7
s_lshl_b32 s44, s44, 11
s_add_u32 s44, s44, 394752
buffer_load_dwordx2 v[84:85], v80, s[32:35], s44 offen sc1
Lrs1:
s_setprio 2
ds_read_b128 v[228:231], v248 offset:45056
v_mfma_f32_32x32x16_f16 v[192:207], v[16:19], v[240:243], 0
v_cvt_pkrtz_f16_f32 v137, v120, v121
v_cvt_pkrtz_f16_f32 v139, v122, v123
v_cvt_pkrtz_f16_f32 v141, v124, v125
v_cvt_pkrtz_f16_f32 v143, v126, v127
v_cvt_pkrtz_f16_f32 v145, v128, v129
v_mfma_f32_32x32x16_f16 v[192:207], v[20:23], v[244:247], v[192:207]
v_cvt_pk_f16_f32 v155, v130, v131
v_cvt_pk_f16_f32 v152, v132, v133
v_cvt_pk_f16_f32 v149, v134, v135
v_pk_fma_f16 v154, v155, v155, s48
v_and_b32_e64 v137, s49, v137
v_mfma_f32_32x32x16_bf16 v[120:135], v[232:235], v[168:171], 0
v_pk_fma_f16 v151, v152, v152, s48
v_and_b32_e64 v139, s49, v139
v_pk_fma_f16 v148, v149, v149, s48
v_pk_mul_f16 v154, v155, v154
v_bfe_u32 v136, v137, 2, 14
v_pk_mul_f16 v151, v152, v151
v_pk_mul_f16 v148, v149, v148
v_bfe_u32 v138, v139, 2, 14
v_fmac_f32 v158, v192, v192
v_exp_f16 v153, v154
ds_read_b128 v[232:235], v248 offset:43008
ds_read_u16_d16 v136, v136
ds_read_u16_d16 v138, v138
v_mfma_f32_32x32x16_bf16 v[120:135], v[236:239], v[172:175], v[120:135]
v_fmac_f32 v158, v193, v193
v_lshrrev_b32 v137, 18, v137
v_exp_f16 v150, v151
v_fmac_f32 v158, v194, v194
v_lshrrev_b32 v139, 18, v139
v_exp_f16 v147, v148
v_fmac_f32 v158, v195, v195
v_and_b32 v141, s49, v141
ds_read_b128 v[236:239], v248 offset:46080
ds_read_u16_d16_hi v137, v137
ds_read_u16_d16_hi v139, v139
v_mfma_f32_32x32x16_bf16 v[120:135], v[224:227], v[176:179], v[120:135]
v_and_b32_e64 v143, s49, v143
v_exp_f16_sdwa v153, v154 dst_sel:WORD_1 dst_unused:UNUSED_PRESERVE src0_sel:WORD_1
v_fmac_f32_e64 v158, v196, v196
v_bfe_u32 v140, v141, 2, 14
v_exp_f16_sdwa v150, v151 dst_sel:WORD_1 dst_unused:UNUSED_PRESERVE src0_sel:WORD_1
v_fmac_f32 v158, v197, v197
v_bfe_u32 v142, v143, 2, 14
v_exp_f16_sdwa v147, v148 dst_sel:WORD_1 dst_unused:UNUSED_PRESERVE src0_sel:WORD_1
s_waitcnt lgkmcnt(6)
ds_read_b128 v[224:227], v248 offset:47104
ds_read_u16_d16 v140, v140
ds_read_u16_d16 v142, v142
v_mfma_f32_32x32x16_bf16 v[120:135], v[228:231], v[180:183], v[120:135]
v_fmac_f32 v158, v198, v198
v_lshrrev_b32 v141, 18, v141
v_pk_add_f16 v153, v153, 1.0 op_sel_hi:[1,0]
v_fmac_f32 v158, v199, v199
v_lshrrev_b32 v143, 18, v143
v_pk_add_f16 v150, v150, 1.0 op_sel_hi:[1,0]
v_pk_add_f16 v147, v147, 1.0 op_sel_hi:[1,0]
v_fmac_f32_e64 v158, v200, v200
v_and_b32 v145, s49, v145
s_waitcnt lgkmcnt(4)
ds_read_b128 v[228:231], v248 offset:50176
ds_read_u16_d16_hi v141, v141
ds_read_u16_d16_hi v143, v143
v_mfma_f32_32x32x16_bf16 v[120:135], v[232:235], v[184:187], v[120:135]
v_rcp_f16 v154, v153
v_fmac_f32 v158, v201, v201
v_bfe_u32 v144, v145, 2, 14
v_rcp_f16 v151, v150
v_fmac_f32 v158, v202, v202
v_lshrrev_b32 v145, 18, v145
v_rcp_f16 v148, v147
v_fmac_f32 v158, v203, v203
v_or_b32 v24, v136, v137
ds_read_b128 v[232:235], v248 offset:48128
ds_read_u16_d16 v144, v144
ds_read_u16_d16_hi v145, v145
v_mfma_f32_32x32x16_bf16 v[120:135], v[236:239], v[188:191], v[120:135]
s_waitcnt lgkmcnt(6)
v_or_b32 v25, v138, v139
v_rcp_f16_sdwa v154, v153 dst_sel:WORD_1 dst_unused:UNUSED_PRESERVE src0_sel:WORD_1
v_fmac_f32 v158, v204, v204
s_waitcnt lgkmcnt(4)
v_or_b32_e64 v26, v140, v141
v_rcp_f16_sdwa v151, v150 dst_sel:WORD_1 dst_unused:UNUSED_PRESERVE src0_sel:WORD_1
v_fmac_f32 v158, v205, v205
s_waitcnt lgkmcnt(3)
v_or_b32_e64 v27, v142, v143
v_rcp_f16_sdwa v148, v147 dst_sel:WORD_1 dst_unused:UNUSED_PRESERVE src0_sel:WORD_1
v_fmac_f32 v158, v206, v206
s_waitcnt lgkmcnt(0)
v_or_b32_e64 v28, v144, v145
v_pk_mul_f16 v29, v155, v154
v_fmac_f32 v158, v207, v207
v_pk_mul_f16 v30, v152, v151
v_pk_mul_f16 v31, v149, v148
s_setprio 1
ds_read_b128 v[236:239], v248 offset:51200
v_mfma_f32_32x32x16_f16 v[192:207], v[24:27], v[240:243], 0
v_cvt_pkrtz_f16_f32 v137, v120, v121
v_cvt_pkrtz_f16_f32 v139, v122, v123
v_cvt_pkrtz_f16_f32 v141, v124, v125
v_cvt_pkrtz_f16_f32 v143, v126, v127
v_mfma_f32_32x32x16_f16 v[192:207], v[28:31], v[244:247], v[192:207]
v_cvt_pkrtz_f16_f32 v145, v128, v129
v_cvt_pkrtz_f16_f32 v147, v130, v131
v_cvt_pk_f16_f32 v155, v132, v133
v_cvt_pk_f16_f32 v152, v134, v135
v_pk_fma_f16 v154, v155, v155, s48
v_mfma_f32_32x32x16_bf16 v[120:135], v[224:227], v[168:171], 0
v_and_b32_e64 v137, s49, v137
v_pk_fma_f16 v151, v152, v152, s48
v_and_b32_e64 v139, s49, v139
v_pk_mul_f16 v154, v155, v154
v_bfe_u32 v136, v137, 2, 14
v_pk_mul_f16 v151, v152, v151
v_bfe_u32 v138, v139, 2, 14
v_exp_f16 v153, v154
v_fmac_f32 v159, v192, v192
ds_read_b128 v[224:227], v248 offset:49152
ds_read_u16_d16 v136, v136
ds_read_u16_d16 v138, v138
v_mfma_f32_32x32x16_bf16 v[120:135], v[228:231], v[172:175], v[120:135]
v_lshrrev_b32 v137, 18, v137
v_fmac_f32 v159, v193, v193
v_exp_f16 v150, v151
v_fmac_f32 v159, v194, v194
v_lshrrev_b32 v139, 18, v139
v_and_b32 v141, s49, v141
v_fmac_f32_e64 v159, v195, v195
v_exp_f16_sdwa v153, v154 dst_sel:WORD_1 dst_unused:UNUSED_PRESERVE src0_sel:WORD_1
ds_read_b128 v[228:231], v248 offset:52224
ds_read_u16_d16_hi v137, v137
ds_read_u16_d16_hi v139, v139
v_mfma_f32_32x32x16_bf16 v[120:135], v[232:235], v[176:179], v[120:135]
v_fmac_f32 v159, v196, v196
v_and_b32 v143, s49, v143
v_bfe_u32 v140, v141, 2, 14
v_fmac_f32_e64 v159, v197, v197
v_exp_f16_sdwa v150, v151 dst_sel:WORD_1 dst_unused:UNUSED_PRESERVE src0_sel:WORD_1
v_fmac_f32_e64 v159, v198, v198
v_bfe_u32 v142, v143, 2, 14
v_pk_add_f16 v153, v153, 1.0 op_sel_hi:[1,0]
v_fmac_f32 v159, v199, v199
s_waitcnt lgkmcnt(5)
ds_read_b128 v[232:235], v248 offset:53248
ds_read_u16_d16 v140, v140
ds_read_u16_d16 v142, v142
v_mfma_f32_32x32x16_bf16 v[120:135], v[236:239], v[180:183], v[120:135]
v_lshrrev_b32_e64 v141, 18, v141
v_pk_add_f16 v150, v150, 1.0 op_sel_hi:[1,0]
v_fmac_f32 v159, v200, v200
v_lshrrev_b32 v143, 18, v143
v_rcp_f16 v154, v153
v_fmac_f32 v159, v201, v201
v_and_b32 v145, s49, v145
v_and_b32 v147, s49, v147
v_fmac_f32_e64 v159, v202, v202
ds_read_b128 v[236:239], v248 offset:56320
ds_read_u16_d16_hi v141, v141
ds_read_u16_d16_hi v143, v143
v_mfma_f32_32x32x16_bf16 v[120:135], v[224:227], v[184:187], v[120:135]
v_rcp_f16 v151, v150
v_fmac_f32 v159, v203, v203
v_bfe_u32 v144, v145, 2, 14
s_setprio 0
v_rcp_f16_sdwa v154, v153 dst_sel:WORD_1 dst_unused:UNUSED_PRESERVE src0_sel:WORD_1
v_fmac_f32 v159, v204, v204
v_bfe_u32 v146, v147, 2, 14
v_fmac_f32_e64 v159, v205, v205
v_lshrrev_b32 v145, 18, v145
s_waitcnt lgkmcnt(4)
ds_read_b128 v[224:227], v248 offset:54272
ds_read_u16_d16 v144, v144
ds_read_u16_d16 v146, v146
ds_read_u16_d16_hi v145, v145
v_mfma_f32_32x32x16_bf16 v[120:135], v[228:231], v[188:191], v[120:135]
v_rcp_f16_sdwa v151, v150 dst_sel:WORD_1 dst_unused:UNUSED_PRESERVE src0_sel:WORD_1
v_fmac_f32 v159, v206, v206
v_lshrrev_b32 v147, 18, v147
v_fmac_f32 v159, v207, v207
v_or_b32 v32, v136, v137
v_or_b32 v33, v138, v139
v_permlane32_swap_b32 v158, v159
s_waitcnt lgkmcnt(5)
v_or_b32 v34, v140, v141
s_waitcnt lgkmcnt(4)
v_or_b32 v35, v142, v143
s_waitcnt lgkmcnt(0)
v_or_b32 v36, v144, v145
ds_read_u16_d16_hi v147, v147
s_waitcnt lgkmcnt(0)
v_or_b32 v37, v146, v147
v_add_f32 v158, v158, v159
ds_write_b32 v255, v158 offset:7424
v_pk_mul_f16 v38, v155, v154
v_pk_mul_f16 v39, v152, v151
s_setprio 2
ds_read_b128 v[228:231], v248 offset:57344
v_mfma_f32_32x32x16_f16 v[192:207], v[32:35], v[240:243], 0
v_cvt_pkrtz_f16_f32 v137, v120, v121
v_cvt_pkrtz_f16_f32 v139, v122, v123
v_cvt_pkrtz_f16_f32 v141, v124, v125
v_cvt_pkrtz_f16_f32 v143, v126, v127
v_cvt_pkrtz_f16_f32 v145, v128, v129
v_mfma_f32_32x32x16_f16 v[192:207], v[36:39], v[244:247], v[192:207]
v_cvt_pk_f16_f32 v155, v130, v131
v_cvt_pk_f16_f32 v152, v132, v133
v_cvt_pk_f16_f32 v149, v134, v135
v_pk_fma_f16 v154, v155, v155, s48
v_and_b32_e64 v137, s49, v137
v_mfma_f32_32x32x16_bf16 v[120:135], v[232:235], v[168:171], 0
v_pk_fma_f16 v151, v152, v152, s48
v_and_b32_e64 v139, s49, v139
v_pk_fma_f16 v148, v149, v149, s48
v_pk_mul_f16 v154, v155, v154
v_bfe_u32 v136, v137, 2, 14
v_pk_mul_f16 v151, v152, v151
v_pk_mul_f16 v148, v149, v148
v_bfe_u32 v138, v139, 2, 14
v_fmac_f32 v160, v192, v192
v_exp_f16 v153, v154
ds_read_b128 v[232:235], v248 offset:55296
ds_read_u16_d16 v136, v136
ds_read_u16_d16 v138, v138
v_mfma_f32_32x32x16_bf16 v[120:135], v[236:239], v[172:175], v[120:135]
v_fmac_f32 v160, v193, v193
v_lshrrev_b32 v137, 18, v137
v_exp_f16 v150, v151
v_fmac_f32 v160, v194, v194
v_lshrrev_b32 v139, 18, v139
v_exp_f16 v147, v148
v_fmac_f32 v160, v195, v195
v_and_b32 v141, s49, v141
ds_read_b128 v[236:239], v248 offset:58368
ds_read_u16_d16_hi v137, v137
ds_read_u16_d16_hi v139, v139
v_mfma_f32_32x32x16_bf16 v[120:135], v[224:227], v[176:179], v[120:135]
v_and_b32_e64 v143, s49, v143
v_exp_f16_sdwa v153, v154 dst_sel:WORD_1 dst_unused:UNUSED_PRESERVE src0_sel:WORD_1
v_fmac_f32_e64 v160, v196, v196
v_bfe_u32 v140, v141, 2, 14
v_exp_f16_sdwa v150, v151 dst_sel:WORD_1 dst_unused:UNUSED_PRESERVE src0_sel:WORD_1
v_fmac_f32 v160, v197, v197
v_bfe_u32 v142, v143, 2, 14
v_exp_f16_sdwa v147, v148 dst_sel:WORD_1 dst_unused:UNUSED_PRESERVE src0_sel:WORD_1
s_waitcnt lgkmcnt(6)
ds_read_b128 v[224:227], v248 offset:59392
ds_read_u16_d16 v140, v140
ds_read_u16_d16 v142, v142
v_mfma_f32_32x32x16_bf16 v[120:135], v[228:231], v[180:183], v[120:135]
v_fmac_f32 v160, v198, v198
v_lshrrev_b32 v141, 18, v141
v_pk_add_f16 v153, v153, 1.0 op_sel_hi:[1,0]
v_fmac_f32 v160, v199, v199
v_lshrrev_b32 v143, 18, v143
v_pk_add_f16 v150, v150, 1.0 op_sel_hi:[1,0]
v_pk_add_f16 v147, v147, 1.0 op_sel_hi:[1,0]
v_fmac_f32_e64 v160, v200, v200
v_and_b32 v145, s49, v145
s_waitcnt lgkmcnt(4)
ds_read_b128 v[228:231], v248 offset:62464
ds_read_u16_d16_hi v141, v141
ds_read_u16_d16_hi v143, v143
v_mfma_f32_32x32x16_bf16 v[120:135], v[232:235], v[184:187], v[120:135]
v_rcp_f16 v154, v153
v_fmac_f32 v160, v201, v201
v_bfe_u32 v144, v145, 2, 14
v_rcp_f16 v151, v150
v_fmac_f32 v160, v202, v202
v_lshrrev_b32 v145, 18, v145
v_rcp_f16 v148, v147
v_fmac_f32 v160, v203, v203
v_or_b32 v40, v136, v137
ds_read_b128 v[232:235], v248 offset:60416
ds_read_u16_d16 v144, v144
ds_read_u16_d16_hi v145, v145
v_mfma_f32_32x32x16_bf16 v[120:135], v[236:239], v[188:191], v[120:135]
s_waitcnt lgkmcnt(6)
v_or_b32 v41, v138, v139
v_rcp_f16_sdwa v154, v153 dst_sel:WORD_1 dst_unused:UNUSED_PRESERVE src0_sel:WORD_1
v_fmac_f32 v160, v204, v204
s_waitcnt lgkmcnt(4)
v_or_b32_e64 v42, v140, v141
v_rcp_f16_sdwa v151, v150 dst_sel:WORD_1 dst_unused:UNUSED_PRESERVE src0_sel:WORD_1
v_fmac_f32 v160, v205, v205
s_waitcnt lgkmcnt(3)
v_or_b32_e64 v43, v142, v143
v_rcp_f16_sdwa v148, v147 dst_sel:WORD_1 dst_unused:UNUSED_PRESERVE src0_sel:WORD_1
v_fmac_f32 v160, v206, v206
s_waitcnt lgkmcnt(0)
v_or_b32_e64 v44, v144, v145
v_pk_mul_f16 v45, v155, v154
v_fmac_f32_e64 v160, v207, v207
v_pk_mul_f16 v46, v152, v151
v_pk_mul_f16 v47, v149, v148
s_cmp_lg_u32 s40, 0
s_cbranch_scc1 Lrs2
v_min_u32 v80, 47, v251
v_lshlrev_b32 v80, 3, v80
v_add_u32 v81, 7936, v80
v_add_u32 v80, 15872, v80
v_cmp_gt_u32 vcc, 32, v251
s_nop 1
v_cndmask_b32 v80, v80, v81, vcc
s_waitcnt vmcnt(0)
ds_write_b64 v80, v[84:85]
Lrs2:
s_setprio 1
ds_read_b128 v[236:239], v248 offset:63488
v_mfma_f32_32x32x16_f16 v[192:207], v[40:43], v[240:243], 0
v_cvt_pkrtz_f16_f32 v137, v120, v121
v_cvt_pkrtz_f16_f32 v139, v122, v123
v_cvt_pkrtz_f16_f32 v141, v124, v125
v_cvt_pkrtz_f16_f32 v143, v126, v127
v_mfma_f32_32x32x16_f16 v[192:207], v[44:47], v[244:247], v[192:207]
s_waitcnt lgkmcnt(1)
v_cvt_pkrtz_f16_f32 v145, v128, v129
v_cvt_pkrtz_f16_f32 v147, v130, v131
v_cvt_pk_f16_f32 v155, v132, v133
v_cvt_pk_f16_f32 v152, v134, v135
v_pk_fma_f16 v154, v155, v155, s48
v_mfma_f32_32x32x16_bf16 v[120:135], v[224:227], v[168:171], 0
v_and_b32_e64 v137, s49, v137
v_pk_fma_f16 v151, v152, v152, s48
v_and_b32_e64 v139, s49, v139
v_pk_mul_f16 v154, v155, v154
v_bfe_u32 v136, v137, 2, 14
v_pk_mul_f16 v151, v152, v151
v_bfe_u32 v138, v139, 2, 14
v_exp_f16 v153, v154
v_fmac_f32 v161, v192, v192
ds_read_b128 v[224:227], v248 offset:61440
ds_read_u16_d16 v136, v136
ds_read_u16_d16 v138, v138
v_mfma_f32_32x32x16_bf16 v[120:135], v[228:231], v[172:175], v[120:135]
v_lshrrev_b32 v137, 18, v137
v_fmac_f32 v161, v193, v193
v_exp_f16 v150, v151
v_fmac_f32 v161, v194, v194
v_lshrrev_b32 v139, 18, v139
v_and_b32 v141, s49, v141
v_fmac_f32_e64 v161, v195, v195
v_exp_f16_sdwa v153, v154 dst_sel:WORD_1 dst_unused:UNUSED_PRESERVE src0_sel:WORD_1
ds_read_b128 v[228:231], v248 offset:64512
ds_read_u16_d16_hi v137, v137
ds_read_u16_d16_hi v139, v139
v_mfma_f32_32x32x16_bf16 v[120:135], v[232:235], v[176:179], v[120:135]
v_fmac_f32 v161, v196, v196
v_and_b32 v143, s49, v143
v_bfe_u32 v140, v141, 2, 14
v_fmac_f32_e64 v161, v197, v197
v_exp_f16_sdwa v150, v151 dst_sel:WORD_1 dst_unused:UNUSED_PRESERVE src0_sel:WORD_1
v_fmac_f32_e64 v161, v198, v198
v_bfe_u32 v142, v143, 2, 14
v_pk_add_f16 v153, v153, 1.0 op_sel_hi:[1,0]
v_fmac_f32 v161, v199, v199
s_waitcnt lgkmcnt(5)
ds_read_b128 v[232:235], v249
ds_read_u16_d16 v140, v140
ds_read_u16_d16 v142, v142
v_mfma_f32_32x32x16_bf16 v[120:135], v[236:239], v[180:183], v[120:135]
v_lshrrev_b32_e64 v141, 18, v141
v_pk_add_f16 v150, v150, 1.0 op_sel_hi:[1,0]
v_fmac_f32 v161, v200, v200
v_lshrrev_b32 v143, 18, v143
v_rcp_f16 v154, v153
v_fmac_f32 v161, v201, v201
v_and_b32 v145, s49, v145
v_and_b32 v147, s49, v147
v_fmac_f32_e64 v161, v202, v202
ds_read_b128 v[236:239], v249 offset:3072
ds_read_u16_d16_hi v141, v141
ds_read_u16_d16_hi v143, v143
v_mfma_f32_32x32x16_bf16 v[120:135], v[224:227], v[184:187], v[120:135]
v_rcp_f16 v151, v150
v_fmac_f32 v161, v203, v203
v_bfe_u32 v144, v145, 2, 14
s_setprio 0
v_rcp_f16_sdwa v154, v153 dst_sel:WORD_1 dst_unused:UNUSED_PRESERVE src0_sel:WORD_1
v_fmac_f32 v161, v204, v204
v_bfe_u32 v146, v147, 2, 14
v_fmac_f32_e64 v161, v205, v205
v_lshrrev_b32 v145, 18, v145
s_waitcnt lgkmcnt(4)
ds_read_b128 v[224:227], v249 offset:1024
ds_read_u16_d16 v144, v144
ds_read_u16_d16 v146, v146
ds_read_u16_d16_hi v145, v145
v_mfma_f32_32x32x16_bf16 v[120:135], v[228:231], v[188:191], v[120:135]
v_rcp_f16_sdwa v151, v150 dst_sel:WORD_1 dst_unused:UNUSED_PRESERVE src0_sel:WORD_1
v_fmac_f32 v161, v206, v206
v_lshrrev_b32 v147, 18, v147
v_fmac_f32 v161, v207, v207
v_or_b32 v48, v136, v137
v_or_b32 v49, v138, v139
v_permlane32_swap_b32 v160, v161
s_waitcnt lgkmcnt(5)
v_or_b32 v50, v140, v141
s_waitcnt lgkmcnt(4)
v_or_b32 v51, v142, v143
s_waitcnt lgkmcnt(0)
v_or_b32 v52, v144, v145
ds_read_u16_d16_hi v147, v147
s_waitcnt lgkmcnt(0)
v_or_b32 v53, v146, v147
v_add_f32 v160, v160, v161
ds_write_b32 v255, v160 offset:7680
v_pk_mul_f16 v54, v155, v154
v_pk_mul_f16 v55, v152, v151
s_setprio 2
ds_read_b128 v[228:231], v249 offset:4096
v_mfma_f32_32x32x16_f16 v[192:207], v[48:51], v[240:243], 0
v_cvt_pkrtz_f16_f32 v137, v120, v121
v_cvt_pkrtz_f16_f32 v139, v122, v123
v_cvt_pkrtz_f16_f32 v141, v124, v125
v_cvt_pkrtz_f16_f32 v143, v126, v127
v_cvt_pkrtz_f16_f32 v145, v128, v129
v_mfma_f32_32x32x16_f16 v[192:207], v[52:55], v[244:247], v[192:207]
v_cvt_pk_f16_f32 v155, v130, v131
v_cvt_pk_f16_f32 v152, v132, v133
v_cvt_pk_f16_f32 v149, v134, v135
v_pk_fma_f16 v154, v155, v155, s48
v_and_b32_e64 v137, s49, v137
v_mfma_f32_32x32x16_bf16 v[120:135], v[232:235], v[168:171], 0
v_pk_fma_f16 v151, v152, v152, s48
v_and_b32_e64 v139, s49, v139
v_pk_fma_f16 v148, v149, v149, s48
v_pk_mul_f16 v154, v155, v154
v_bfe_u32 v136, v137, 2, 14
v_pk_mul_f16 v151, v152, v151
v_pk_mul_f16 v148, v149, v148
v_bfe_u32 v138, v139, 2, 14
v_fmac_f32 v162, v192, v192
v_exp_f16 v153, v154
ds_read_b128 v[232:235], v249 offset:2048
ds_read_u16_d16 v136, v136
ds_read_u16_d16 v138, v138
v_mfma_f32_32x32x16_bf16 v[120:135], v[236:239], v[172:175], v[120:135]
v_fmac_f32 v162, v193, v193
v_lshrrev_b32 v137, 18, v137
v_exp_f16 v150, v151
v_fmac_f32 v162, v194, v194
v_lshrrev_b32 v139, 18, v139
v_exp_f16 v147, v148
v_fmac_f32 v162, v195, v195
v_and_b32 v141, s49, v141
ds_read_b128 v[236:239], v249 offset:5120
ds_read_u16_d16_hi v137, v137
ds_read_u16_d16_hi v139, v139
v_mfma_f32_32x32x16_bf16 v[120:135], v[224:227], v[176:179], v[120:135]
v_and_b32_e64 v143, s49, v143
v_exp_f16_sdwa v153, v154 dst_sel:WORD_1 dst_unused:UNUSED_PRESERVE src0_sel:WORD_1
v_fmac_f32_e64 v162, v196, v196
v_bfe_u32 v140, v141, 2, 14
v_exp_f16_sdwa v150, v151 dst_sel:WORD_1 dst_unused:UNUSED_PRESERVE src0_sel:WORD_1
v_fmac_f32 v162, v197, v197
v_bfe_u32 v142, v143, 2, 14
v_exp_f16_sdwa v147, v148 dst_sel:WORD_1 dst_unused:UNUSED_PRESERVE src0_sel:WORD_1
s_waitcnt lgkmcnt(6)
ds_read_b128 v[224:227], v249 offset:6144
ds_read_u16_d16 v140, v140
ds_read_u16_d16 v142, v142
v_mfma_f32_32x32x16_bf16 v[120:135], v[228:231], v[180:183], v[120:135]
v_fmac_f32 v162, v198, v198
v_lshrrev_b32 v141, 18, v141
v_pk_add_f16 v153, v153, 1.0 op_sel_hi:[1,0]
v_fmac_f32 v162, v199, v199
v_lshrrev_b32 v143, 18, v143
v_pk_add_f16 v150, v150, 1.0 op_sel_hi:[1,0]
v_pk_add_f16 v147, v147, 1.0 op_sel_hi:[1,0]
v_fmac_f32_e64 v162, v200, v200
v_and_b32 v145, s49, v145
s_waitcnt lgkmcnt(4)
ds_read_b128 v[228:231], v249 offset:9216
ds_read_u16_d16_hi v141, v141
ds_read_u16_d16_hi v143, v143
v_mfma_f32_32x32x16_bf16 v[120:135], v[232:235], v[184:187], v[120:135]
v_rcp_f16 v154, v153
v_fmac_f32 v162, v201, v201
v_bfe_u32 v144, v145, 2, 14
v_rcp_f16 v151, v150
v_fmac_f32 v162, v202, v202
v_lshrrev_b32 v145, 18, v145
v_rcp_f16 v148, v147
v_fmac_f32 v162, v203, v203
v_or_b32 v56, v136, v137
ds_read_b128 v[232:235], v249 offset:7168
ds_read_u16_d16 v144, v144
ds_read_u16_d16_hi v145, v145
v_mfma_f32_32x32x16_bf16 v[120:135], v[236:239], v[188:191], v[120:135]
s_waitcnt lgkmcnt(6)
v_or_b32 v57, v138, v139
v_rcp_f16_sdwa v154, v153 dst_sel:WORD_1 dst_unused:UNUSED_PRESERVE src0_sel:WORD_1
v_fmac_f32 v162, v204, v204
s_waitcnt lgkmcnt(4)
v_or_b32_e64 v58, v140, v141
v_rcp_f16_sdwa v151, v150 dst_sel:WORD_1 dst_unused:UNUSED_PRESERVE src0_sel:WORD_1
v_fmac_f32 v162, v205, v205
s_waitcnt lgkmcnt(3)
v_or_b32_e64 v59, v142, v143
v_rcp_f16_sdwa v148, v147 dst_sel:WORD_1 dst_unused:UNUSED_PRESERVE src0_sel:WORD_1
v_fmac_f32 v162, v206, v206
s_waitcnt lgkmcnt(0)
v_or_b32_e64 v60, v144, v145
v_pk_mul_f16 v61, v155, v154
v_fmac_f32 v162, v207, v207
v_pk_mul_f16 v62, v152, v151
v_pk_mul_f16 v63, v149, v148
s_setprio 1
ds_read_b128 v[236:239], v249 offset:10240
v_mfma_f32_32x32x16_f16 v[192:207], v[56:59], v[240:243], 0
v_cvt_pkrtz_f16_f32 v137, v120, v121
v_cvt_pkrtz_f16_f32 v139, v122, v123
v_cvt_pkrtz_f16_f32 v141, v124, v125
v_cvt_pkrtz_f16_f32 v143, v126, v127
v_mfma_f32_32x32x16_f16 v[192:207], v[60:63], v[244:247], v[192:207]
v_cvt_pkrtz_f16_f32 v145, v128, v129
v_cvt_pkrtz_f16_f32 v147, v130, v131
v_cvt_pk_f16_f32 v155, v132, v133
v_cvt_pk_f16_f32 v152, v134, v135
v_pk_fma_f16 v154, v155, v155, s48
v_mfma_f32_32x32x16_bf16 v[120:135], v[224:227], v[168:171], 0
v_and_b32_e64 v137, s49, v137
v_pk_fma_f16 v151, v152, v152, s48
v_and_b32_e64 v139, s49, v139
v_pk_mul_f16 v154, v155, v154
v_bfe_u32 v136, v137, 2, 14
v_pk_mul_f16 v151, v152, v151
v_bfe_u32 v138, v139, 2, 14
v_exp_f16 v153, v154
v_fmac_f32 v163, v192, v192
ds_read_b128 v[224:227], v249 offset:8192
ds_read_u16_d16 v136, v136
ds_read_u16_d16 v138, v138
v_mfma_f32_32x32x16_bf16 v[120:135], v[228:231], v[172:175], v[120:135]
v_lshrrev_b32 v137, 18, v137
v_fmac_f32 v163, v193, v193
v_exp_f16 v150, v151
v_fmac_f32 v163, v194, v194
v_lshrrev_b32 v139, 18, v139
v_and_b32 v141, s49, v141
v_fmac_f32_e64 v163, v195, v195
v_exp_f16_sdwa v153, v154 dst_sel:WORD_1 dst_unused:UNUSED_PRESERVE src0_sel:WORD_1
ds_read_b128 v[228:231], v249 offset:11264
ds_read_u16_d16_hi v137, v137
ds_read_u16_d16_hi v139, v139
v_mfma_f32_32x32x16_bf16 v[120:135], v[232:235], v[176:179], v[120:135]
v_fmac_f32 v163, v196, v196
v_and_b32 v143, s49, v143
v_bfe_u32 v140, v141, 2, 14
v_fmac_f32_e64 v163, v197, v197
v_exp_f16_sdwa v150, v151 dst_sel:WORD_1 dst_unused:UNUSED_PRESERVE src0_sel:WORD_1
v_fmac_f32_e64 v163, v198, v198
v_bfe_u32 v142, v143, 2, 14
v_pk_add_f16 v153, v153, 1.0 op_sel_hi:[1,0]
v_fmac_f32 v163, v199, v199
s_waitcnt lgkmcnt(5)
ds_read_b128 v[232:235], v249 offset:12288
ds_read_u16_d16 v140, v140
ds_read_u16_d16 v142, v142
v_mfma_f32_32x32x16_bf16 v[120:135], v[236:239], v[180:183], v[120:135]
v_lshrrev_b32_e64 v141, 18, v141
v_pk_add_f16 v150, v150, 1.0 op_sel_hi:[1,0]
v_fmac_f32 v163, v200, v200
v_lshrrev_b32 v143, 18, v143
v_rcp_f16 v154, v153
v_fmac_f32 v163, v201, v201
v_and_b32 v145, s49, v145
v_and_b32 v147, s49, v147
v_fmac_f32_e64 v163, v202, v202
ds_read_b128 v[236:239], v249 offset:15360
ds_read_u16_d16_hi v141, v141
ds_read_u16_d16_hi v143, v143
v_mfma_f32_32x32x16_bf16 v[120:135], v[224:227], v[184:187], v[120:135]
v_rcp_f16 v151, v150
v_fmac_f32 v163, v203, v203
v_bfe_u32 v144, v145, 2, 14
s_setprio 0
v_rcp_f16_sdwa v154, v153 dst_sel:WORD_1 dst_unused:UNUSED_PRESERVE src0_sel:WORD_1
v_fmac_f32 v163, v204, v204
v_bfe_u32 v146, v147, 2, 14
v_fmac_f32_e64 v163, v205, v205
v_lshrrev_b32 v145, 18, v145
s_waitcnt lgkmcnt(4)
ds_read_b128 v[224:227], v249 offset:13312
ds_read_u16_d16 v144, v144
ds_read_u16_d16 v146, v146
ds_read_u16_d16_hi v145, v145
v_mfma_f32_32x32x16_bf16 v[120:135], v[228:231], v[188:191], v[120:135]
v_rcp_f16_sdwa v151, v150 dst_sel:WORD_1 dst_unused:UNUSED_PRESERVE src0_sel:WORD_1
v_fmac_f32 v163, v206, v206
v_lshrrev_b32 v147, 18, v147
v_fmac_f32 v163, v207, v207
v_or_b32 v64, v136, v137
v_or_b32 v65, v138, v139
v_permlane32_swap_b32 v162, v163
s_waitcnt lgkmcnt(5)
v_or_b32 v66, v140, v141
s_waitcnt lgkmcnt(4)
v_or_b32 v67, v142, v143
s_waitcnt lgkmcnt(0)
v_or_b32 v68, v144, v145
ds_read_u16_d16_hi v147, v147
s_waitcnt lgkmcnt(0)
v_or_b32 v69, v146, v147
v_add_f32 v162, v162, v163
ds_write_b32 v255, v162 offset:7936
v_pk_mul_f16 v70, v155, v154
v_pk_mul_f16 v71, v152, v151
s_setprio 2
ds_read_b128 v[228:231], v249 offset:16384
v_mfma_f32_32x32x16_f16 v[192:207], v[64:67], v[240:243], 0
v_cvt_pkrtz_f16_f32 v137, v120, v121
v_cvt_pkrtz_f16_f32 v139, v122, v123
v_cvt_pkrtz_f16_f32 v141, v124, v125
v_cvt_pkrtz_f16_f32 v143, v126, v127
v_cvt_pkrtz_f16_f32 v145, v128, v129
v_mfma_f32_32x32x16_f16 v[192:207], v[68:71], v[244:247], v[192:207]
v_cvt_pk_f16_f32 v155, v130, v131
v_cvt_pk_f16_f32 v152, v132, v133
v_cvt_pk_f16_f32 v149, v134, v135
v_pk_fma_f16 v154, v155, v155, s48
v_and_b32_e64 v137, s49, v137
v_mfma_f32_32x32x16_bf16 v[120:135], v[232:235], v[168:171], 0
v_pk_fma_f16 v151, v152, v152, s48
v_and_b32_e64 v139, s49, v139
v_pk_fma_f16 v148, v149, v149, s48
v_pk_mul_f16 v154, v155, v154
v_bfe_u32 v136, v137, 2, 14
v_pk_mul_f16 v151, v152, v151
v_pk_mul_f16 v148, v149, v148
v_bfe_u32 v138, v139, 2, 14
v_fmac_f32 v164, v192, v192
v_exp_f16 v153, v154
ds_read_b128 v[232:235], v249 offset:14336
ds_read_u16_d16 v136, v136
ds_read_u16_d16 v138, v138
v_mfma_f32_32x32x16_bf16 v[120:135], v[236:239], v[172:175], v[120:135]
v_fmac_f32 v164, v193, v193
v_lshrrev_b32 v137, 18, v137
v_exp_f16 v150, v151
v_fmac_f32 v164, v194, v194
v_lshrrev_b32 v139, 18, v139
v_exp_f16 v147, v148
v_fmac_f32 v164, v195, v195
v_and_b32 v141, s49, v141
ds_read_b128 v[236:239], v249 offset:17408
ds_read_u16_d16_hi v137, v137
ds_read_u16_d16_hi v139, v139
v_mfma_f32_32x32x16_bf16 v[120:135], v[224:227], v[176:179], v[120:135]
v_and_b32_e64 v143, s49, v143
v_exp_f16_sdwa v153, v154 dst_sel:WORD_1 dst_unused:UNUSED_PRESERVE src0_sel:WORD_1
v_fmac_f32_e64 v164, v196, v196
v_bfe_u32 v140, v141, 2, 14
v_exp_f16_sdwa v150, v151 dst_sel:WORD_1 dst_unused:UNUSED_PRESERVE src0_sel:WORD_1
v_fmac_f32 v164, v197, v197
v_bfe_u32 v142, v143, 2, 14
v_exp_f16_sdwa v147, v148 dst_sel:WORD_1 dst_unused:UNUSED_PRESERVE src0_sel:WORD_1
s_waitcnt lgkmcnt(6)
ds_read_b128 v[224:227], v249 offset:18432
ds_read_u16_d16 v140, v140
ds_read_u16_d16 v142, v142
v_mfma_f32_32x32x16_bf16 v[120:135], v[228:231], v[180:183], v[120:135]
v_fmac_f32 v164, v198, v198
v_lshrrev_b32 v141, 18, v141
v_pk_add_f16 v153, v153, 1.0 op_sel_hi:[1,0]
v_fmac_f32 v164, v199, v199
v_lshrrev_b32 v143, 18, v143
v_pk_add_f16 v150, v150, 1.0 op_sel_hi:[1,0]
v_pk_add_f16 v147, v147, 1.0 op_sel_hi:[1,0]
v_fmac_f32_e64 v164, v200, v200
v_and_b32 v145, s49, v145
s_waitcnt lgkmcnt(4)
ds_read_b128 v[228:231], v249 offset:21504
ds_read_u16_d16_hi v141, v141
ds_read_u16_d16_hi v143, v143
v_mfma_f32_32x32x16_bf16 v[120:135], v[232:235], v[184:187], v[120:135]
v_rcp_f16 v154, v153
v_fmac_f32 v164, v201, v201
v_bfe_u32 v144, v145, 2, 14
v_rcp_f16 v151, v150
v_fmac_f32 v164, v202, v202
v_lshrrev_b32 v145, 18, v145
v_rcp_f16 v148, v147
v_fmac_f32 v164, v203, v203
v_or_b32 v72, v136, v137
ds_read_b128 v[232:235], v249 offset:19456
ds_read_u16_d16 v144, v144
ds_read_u16_d16_hi v145, v145
v_mfma_f32_32x32x16_bf16 v[120:135], v[236:239], v[188:191], v[120:135]
s_waitcnt lgkmcnt(6)
v_or_b32 v73, v138, v139
v_rcp_f16_sdwa v154, v153 dst_sel:WORD_1 dst_unused:UNUSED_PRESERVE src0_sel:WORD_1
v_fmac_f32 v164, v204, v204
s_waitcnt lgkmcnt(4)
v_or_b32_e64 v74, v140, v141
v_rcp_f16_sdwa v151, v150 dst_sel:WORD_1 dst_unused:UNUSED_PRESERVE src0_sel:WORD_1
v_fmac_f32 v164, v205, v205
s_waitcnt lgkmcnt(3)
v_or_b32_e64 v75, v142, v143
v_rcp_f16_sdwa v148, v147 dst_sel:WORD_1 dst_unused:UNUSED_PRESERVE src0_sel:WORD_1
v_fmac_f32 v164, v206, v206
s_waitcnt lgkmcnt(0)
v_or_b32_e64 v76, v144, v145
v_pk_mul_f16 v77, v155, v154
v_fmac_f32 v164, v207, v207
v_pk_mul_f16 v78, v152, v151
v_pk_mul_f16 v79, v149, v148
s_setprio 1
ds_read_b128 v[236:239], v249 offset:22528
v_mfma_f32_32x32x16_f16 v[192:207], v[72:75], v[240:243], 0
v_cvt_pkrtz_f16_f32 v137, v120, v121
v_cvt_pkrtz_f16_f32 v139, v122, v123
v_cvt_pkrtz_f16_f32 v141, v124, v125
v_cvt_pkrtz_f16_f32 v143, v126, v127
v_mfma_f32_32x32x16_f16 v[192:207], v[76:79], v[244:247], v[192:207]
v_cvt_pkrtz_f16_f32 v145, v128, v129
v_cvt_pkrtz_f16_f32 v147, v130, v131
v_cvt_pk_f16_f32 v155, v132, v133
v_cvt_pk_f16_f32 v152, v134, v135
v_pk_fma_f16 v154, v155, v155, s48
v_mfma_f32_32x32x16_bf16 v[120:135], v[224:227], v[168:171], 0
v_and_b32_e64 v137, s49, v137
v_pk_fma_f16 v151, v152, v152, s48
v_and_b32_e64 v139, s49, v139
v_pk_mul_f16 v154, v155, v154
v_bfe_u32 v136, v137, 2, 14
v_pk_mul_f16 v151, v152, v151
v_bfe_u32 v138, v139, 2, 14
v_exp_f16 v153, v154
v_fmac_f32 v165, v192, v192
ds_read_b128 v[224:227], v249 offset:20480
ds_read_u16_d16 v136, v136
ds_read_u16_d16 v138, v138
v_mfma_f32_32x32x16_bf16 v[120:135], v[228:231], v[172:175], v[120:135]
v_lshrrev_b32 v137, 18, v137
v_fmac_f32 v165, v193, v193
v_exp_f16 v150, v151
v_fmac_f32 v165, v194, v194
v_lshrrev_b32 v139, 18, v139
v_and_b32 v141, s49, v141
v_fmac_f32_e64 v165, v195, v195
v_exp_f16_sdwa v153, v154 dst_sel:WORD_1 dst_unused:UNUSED_PRESERVE src0_sel:WORD_1
ds_read_b128 v[228:231], v249 offset:23552
ds_read_u16_d16_hi v137, v137
ds_read_u16_d16_hi v139, v139
v_mfma_f32_32x32x16_bf16 v[120:135], v[232:235], v[176:179], v[120:135]
v_fmac_f32 v165, v196, v196
v_and_b32 v143, s49, v143
v_bfe_u32 v140, v141, 2, 14
v_fmac_f32_e64 v165, v197, v197
v_exp_f16_sdwa v150, v151 dst_sel:WORD_1 dst_unused:UNUSED_PRESERVE src0_sel:WORD_1
v_fmac_f32_e64 v165, v198, v198
v_bfe_u32 v142, v143, 2, 14
v_pk_add_f16 v153, v153, 1.0 op_sel_hi:[1,0]
v_fmac_f32 v165, v199, v199
s_waitcnt lgkmcnt(5)
ds_read_b128 v[232:235], v248 offset:47104
ds_read_u16_d16 v140, v140
ds_read_u16_d16 v142, v142
v_mfma_f32_32x32x16_bf16 v[120:135], v[236:239], v[180:183], v[120:135]
v_lshrrev_b32_e64 v141, 18, v141
v_pk_add_f16 v150, v150, 1.0 op_sel_hi:[1,0]
v_fmac_f32 v165, v200, v200
v_lshrrev_b32 v143, 18, v143
v_rcp_f16 v154, v153
v_fmac_f32 v165, v201, v201
v_and_b32 v145, s49, v145
v_and_b32 v147, s49, v147
v_fmac_f32_e64 v165, v202, v202
ds_read_b128 v[236:239], v248 offset:50176
ds_read_u16_d16_hi v141, v141
ds_read_u16_d16_hi v143, v143
v_mfma_f32_32x32x16_bf16 v[120:135], v[224:227], v[184:187], v[120:135]
v_rcp_f16 v151, v150
v_fmac_f32 v165, v203, v203
v_bfe_u32 v144, v145, 2, 14
s_setprio 0
v_rcp_f16_sdwa v154, v153 dst_sel:WORD_1 dst_unused:UNUSED_PRESERVE src0_sel:WORD_1
v_fmac_f32 v165, v204, v204
v_bfe_u32 v146, v147, 2, 14
v_fmac_f32_e64 v165, v205, v205
v_lshrrev_b32 v145, 18, v145
s_waitcnt lgkmcnt(4)
ds_read_b128 v[224:227], v248 offset:48128
ds_read_u16_d16 v144, v144
ds_read_u16_d16 v146, v146
ds_read_u16_d16_hi v145, v145
v_mfma_f32_32x32x16_bf16 v[120:135], v[228:231], v[188:191], v[120:135]
v_rcp_f16_sdwa v151, v150 dst_sel:WORD_1 dst_unused:UNUSED_PRESERVE src0_sel:WORD_1
v_fmac_f32 v165, v206, v206
v_lshrrev_b32 v147, 18, v147
v_fmac_f32 v165, v207, v207
v_or_b32 v80, v136, v137
v_or_b32 v81, v138, v139
v_permlane32_swap_b32 v164, v165
s_waitcnt lgkmcnt(5)
v_or_b32 v82, v140, v141
s_waitcnt lgkmcnt(4)
v_or_b32 v83, v142, v143
s_waitcnt lgkmcnt(0)
v_or_b32 v84, v144, v145
ds_read_u16_d16_hi v147, v147
s_waitcnt lgkmcnt(0)
v_or_b32 v85, v146, v147
v_add_f32 v164, v164, v165
ds_write_b32 v255, v164 offset:8192
v_pk_mul_f16 v86, v155, v154
v_pk_mul_f16 v87, v152, v151
s_setprio 2
ds_read_b128 v[228:231], v248 offset:51200
v_mfma_f32_32x32x16_f16 v[192:207], v[80:83], v[240:243], 0
v_cvt_pkrtz_f16_f32 v137, v120, v121
v_cvt_pkrtz_f16_f32 v139, v122, v123
v_cvt_pkrtz_f16_f32 v141, v124, v125
v_cvt_pkrtz_f16_f32 v143, v126, v127
v_cvt_pkrtz_f16_f32 v145, v128, v129
v_mfma_f32_32x32x16_f16 v[192:207], v[84:87], v[244:247], v[192:207]
v_cvt_pk_f16_f32 v155, v130, v131
v_cvt_pk_f16_f32 v152, v132, v133
v_cvt_pk_f16_f32 v149, v134, v135
v_pk_fma_f16 v154, v155, v155, s48
v_and_b32_e64 v137, s49, v137
v_mfma_f32_32x32x16_bf16 v[120:135], v[232:235], v[96:99], 0
v_pk_fma_f16 v151, v152, v152, s48
v_and_b32_e64 v139, s49, v139
v_pk_fma_f16 v148, v149, v149, s48
v_pk_mul_f16 v154, v155, v154
v_bfe_u32 v136, v137, 2, 14
v_pk_mul_f16 v151, v152, v151
v_pk_mul_f16 v148, v149, v148
v_bfe_u32 v138, v139, 2, 14
v_fmac_f32 v166, v192, v192
v_exp_f16 v153, v154
ds_read_b128 v[232:235], v248 offset:49152
ds_read_u16_d16 v136, v136
ds_read_u16_d16 v138, v138
v_mfma_f32_32x32x16_bf16 v[120:135], v[236:239], v[100:103], v[120:135]
v_fmac_f32 v166, v193, v193
v_lshrrev_b32 v137, 18, v137
v_exp_f16 v150, v151
v_fmac_f32 v166, v194, v194
v_lshrrev_b32 v139, 18, v139
v_exp_f16 v147, v148
v_fmac_f32 v166, v195, v195
v_and_b32 v141, s49, v141
ds_read_b128 v[236:239], v248 offset:52224
ds_read_u16_d16_hi v137, v137
ds_read_u16_d16_hi v139, v139
v_mfma_f32_32x32x16_bf16 v[120:135], v[224:227], v[104:107], v[120:135]
v_and_b32_e64 v143, s49, v143
v_exp_f16_sdwa v153, v154 dst_sel:WORD_1 dst_unused:UNUSED_PRESERVE src0_sel:WORD_1
v_fmac_f32_e64 v166, v196, v196
v_bfe_u32 v140, v141, 2, 14
v_exp_f16_sdwa v150, v151 dst_sel:WORD_1 dst_unused:UNUSED_PRESERVE src0_sel:WORD_1
v_fmac_f32 v166, v197, v197
v_bfe_u32 v142, v143, 2, 14
v_exp_f16_sdwa v147, v148 dst_sel:WORD_1 dst_unused:UNUSED_PRESERVE src0_sel:WORD_1
s_waitcnt lgkmcnt(6)
ds_read_b128 v[224:227], v248 offset:53248
ds_read_u16_d16 v140, v140
ds_read_u16_d16 v142, v142
v_mfma_f32_32x32x16_bf16 v[120:135], v[228:231], v[108:111], v[120:135]
v_fmac_f32 v166, v198, v198
v_lshrrev_b32 v141, 18, v141
v_pk_add_f16 v153, v153, 1.0 op_sel_hi:[1,0]
v_fmac_f32 v166, v199, v199
v_lshrrev_b32 v143, 18, v143
v_pk_add_f16 v150, v150, 1.0 op_sel_hi:[1,0]
v_pk_add_f16 v147, v147, 1.0 op_sel_hi:[1,0]
v_fmac_f32_e64 v166, v200, v200
v_and_b32 v145, s49, v145
s_waitcnt lgkmcnt(4)
ds_read_b128 v[228:231], v248 offset:56320
ds_read_u16_d16_hi v141, v141
ds_read_u16_d16_hi v143, v143
v_mfma_f32_32x32x16_bf16 v[120:135], v[232:235], v[112:115], v[120:135]
v_rcp_f16 v154, v153
v_fmac_f32 v166, v201, v201
v_bfe_u32 v144, v145, 2, 14
v_rcp_f16 v151, v150
v_fmac_f32 v166, v202, v202
v_lshrrev_b32 v145, 18, v145
v_rcp_f16 v148, v147
v_fmac_f32 v166, v203, v203
v_or_b32 v168, v136, v137
ds_read_b128 v[232:235], v248 offset:54272
ds_read_u16_d16 v144, v144
ds_read_u16_d16_hi v145, v145
v_mfma_f32_32x32x16_bf16 v[120:135], v[236:239], v[116:119], v[120:135]
s_waitcnt lgkmcnt(6)
v_or_b32 v169, v138, v139
v_rcp_f16_sdwa v154, v153 dst_sel:WORD_1 dst_unused:UNUSED_PRESERVE src0_sel:WORD_1
v_fmac_f32 v166, v204, v204
s_waitcnt lgkmcnt(4)
v_or_b32_e64 v170, v140, v141
v_rcp_f16_sdwa v151, v150 dst_sel:WORD_1 dst_unused:UNUSED_PRESERVE src0_sel:WORD_1
v_fmac_f32 v166, v205, v205
s_waitcnt lgkmcnt(3)
v_or_b32_e64 v171, v142, v143
v_rcp_f16_sdwa v148, v147 dst_sel:WORD_1 dst_unused:UNUSED_PRESERVE src0_sel:WORD_1
v_fmac_f32 v166, v206, v206
s_waitcnt lgkmcnt(0)
v_or_b32_e64 v172, v144, v145
v_pk_mul_f16 v173, v155, v154
v_fmac_f32 v166, v207, v207
v_pk_mul_f16 v174, v152, v151
v_pk_mul_f16 v175, v149, v148
s_setprio 1
ds_read_b128 v[236:239], v248 offset:57344
v_mfma_f32_32x32x16_f16 v[192:207], v[168:171], v[240:243], 0
v_cvt_pkrtz_f16_f32 v137, v120, v121
v_cvt_pkrtz_f16_f32 v139, v122, v123
v_cvt_pkrtz_f16_f32 v141, v124, v125
v_cvt_pkrtz_f16_f32 v143, v126, v127
v_cvt_pkrtz_f16_f32 v145, v128, v129
v_mfma_f32_32x32x16_f16 v[192:207], v[172:175], v[244:247], v[192:207]
v_cvt_pk_f16_f32 v155, v130, v131
v_cvt_pk_f16_f32 v152, v132, v133
v_cvt_pk_f16_f32 v149, v134, v135
v_pk_fma_f16 v154, v155, v155, s48
v_and_b32_e64 v137, s49, v137
v_pk_fma_f16 v151, v152, v152, s48
v_mfma_f32_32x32x16_bf16 v[120:135], v[224:227], v[96:99], 0
v_and_b32_e64 v139, s49, v139
v_pk_fma_f16 v148, v149, v149, s48
v_pk_mul_f16 v154, v155, v154
v_bfe_u32 v136, v137, 2, 14
v_pk_mul_f16 v151, v152, v151
v_pk_mul_f16 v148, v149, v148
v_fmac_f32 v167, v192, v192
v_fmac_f32 v167, v193, v193
v_fmac_f32 v167, v194, v194
v_fmac_f32 v167, v195, v195
v_fmac_f32_e64 v167, v196, v196
ds_read_b128 v[224:227], v248 offset:55296
ds_read_u16_d16 v136, v136
v_mfma_f32_32x32x16_bf16 v[120:135], v[228:231], v[100:103], v[120:135]
v_fmac_f32 v167, v197, v197
v_fmac_f32 v167, v198, v198
v_fmac_f32 v167, v199, v199
v_fmac_f32 v167, v200, v200
v_fmac_f32 v167, v201, v201
v_fmac_f32 v167, v202, v202
v_fmac_f32 v167, v203, v203
v_fmac_f32 v167, v204, v204
v_fmac_f32 v167, v205, v205
v_fmac_f32 v167, v206, v206
v_fmac_f32_e64 v167, v207, v207
ds_read_b128 v[228:231], v248 offset:58368
v_mfma_f32_32x32x16_bf16 v[120:135], v[232:235], v[104:107], v[120:135]
v_permlane32_swap_b32 v166, v167
v_add_f32 v166, v166, v167
ds_write_b32 v255, v166 offset:8448
s_setprio 3
s_mov_b64 exec, 1
ds_add_rtn_u32 v242, v253, v254
s_mov_b64 exec, -1
s_waitcnt lgkmcnt(0)
v_readfirstlane_b32 s43, v242
s_nop 1
s_cmp_lg_u32 s43, 7
s_cbranch_scc1 Lnopub
v_min_u32 v243, 47, v251
v_lshlrev_b32 v244, 5, v243
v_add_u32 v244, 97280, v244
ds_read_b128 v[176:179], v244
ds_read_b128 v[180:183], v244 offset:16
ds_read_b128 v[184:187], v244 offset:9216
ds_read_b128 v[188:191], v244 offset:9232
ds_read_b128 v[192:195], v244 offset:18432
ds_read_b128 v[196:199], v244 offset:18448
ds_read_b128 v[200:203], v244 offset:27648
ds_read_b128 v[204:207], v244 offset:27664
ds_read_b128 v[156:159], v244 offset:36864
ds_read_b128 v[160:163], v244 offset:36880
v_lshlrev_b32_e64 v246, 13, v243
v_add_u32 v247, 4096, v246
s_waitcnt lgkmcnt(7)
v_add_f32 v176, v176, v184
v_add_f32 v177, v177, v185
v_add_f32 v178, v178, v186
v_add_f32 v179, v179, v187
s_waitcnt lgkmcnt(6)
v_add_f32 v180, v180, v188
v_add_f32 v181, v181, v189
v_add_f32 v182, v182, v190
v_add_f32 v183, v183, v191
ds_read_b128 v[184:187], v244 offset:46080
ds_read_b128 v[188:191], v244 offset:46096
s_waitcnt lgkmcnt(5)
v_add_f32 v192, v192, v200
v_add_f32 v193, v193, v201
v_add_f32 v194, v194, v202
v_add_f32 v195, v195, v203
s_waitcnt lgkmcnt(4)
v_add_f32 v196, v196, v204
v_add_f32 v197, v197, v205
v_add_f32 v198, v198, v206
v_add_f32 v199, v199, v207
ds_read_b128 v[200:203], v244 offset:55296
ds_read_b128 v[204:207], v244 offset:55312
v_add_f32 v176, v176, v192
v_add_f32 v177, v177, v193
v_add_f32 v178, v178, v194
v_add_f32 v179, v179, v195
v_add_f32 v180, v180, v196
v_add_f32 v181, v181, v197
v_add_f32 v182, v182, v198
v_add_f32 v183, v183, v199
ds_read_b128 v[192:195], v244 offset:64512
ds_read_b128 v[196:199], v244 offset:64528
s_waitcnt lgkmcnt(5)
v_add_f32 v156, v156, v184
v_add_f32 v157, v157, v185
v_add_f32 v158, v158, v186
v_add_f32 v159, v159, v187
s_waitcnt lgkmcnt(4)
v_add_f32 v160, v160, v188
v_add_f32 v161, v161, v189
v_add_f32 v162, v162, v190
v_add_f32 v163, v163, v191
s_waitcnt lgkmcnt(1)
v_add_f32 v200, v200, v192
v_add_f32 v201, v201, v193
v_add_f32 v202, v202, v194
v_add_f32 v203, v203, v195
s_waitcnt lgkmcnt(0)
v_add_f32 v204, v204, v196
v_add_f32 v205, v205, v197
v_add_f32 v206, v206, v198
v_add_f32 v207, v207, v199
v_add_f32 v156, v156, v200
v_add_f32 v157, v157, v201
v_add_f32 v158, v158, v202
v_add_f32 v159, v159, v203
v_add_f32 v160, v160, v204
v_add_f32 v161, v161, v205
v_add_f32 v162, v162, v206
v_add_f32 v163, v163, v207
v_add_f32 v176, v176, v156
v_add_f32 v177, v177, v157
v_add_f32 v178, v178, v158
v_add_f32 v179, v179, v159
v_add_f32 v180, v180, v160
v_add_f32 v181, v181, v161
v_add_f32 v182, v182, v162
v_add_f32 v183, v183, v163
v_min_u32 v184, -2, v176
v_min_u32 v185, -2, v177
v_min_u32 v186, -2, v178
v_min_u32 v187, -2, v179
v_min_u32 v188, -2, v180
v_min_u32 v189, -2, v181
v_min_u32_e64 v190, -2, v182
v_min_u32 v191, -2, v183
s_lshl_b32 s43, s2, 4
buffer_store_dwordx4 v[184:187], v246, s[32:35], s43 offen sc1
buffer_store_dwordx4 v[188:191], v247, s[32:35], s43 offen sc1
ds_write_b32 v253, v254 offset:4
s_nop 1
Lnopub:
s_mov_b32 s77, 0
s_cmp_lg_u32 s40, 0
s_cbranch_scc1 Lnorole
s_cmp_lt_u32 s2, 96
s_cselect_b32 s77, 1, 2
s_waitcnt lgkmcnt(0)
v_mov_b32 v156, -1
v_mov_b32 v157, -1
v_mov_b32 v158, -1
v_mov_b32 v159, -1
v_mov_b32 v160, -1
v_mov_b32 v161, -1
v_mov_b32 v162, -1
v_mov_b32 v163, -1
v_mov_b32 v164, -1
v_mov_b32 v165, -1
v_mov_b32 v166, -1
v_mov_b32 v167, -1
v_mov_b32 v252, -1
v_mov_b32 v253, -1
v_mov_b32 v254, -1
v_mov_b32 v255, -1
s_call_b64 s[78:79], Lpoll1
Lnorole:
s_setprio 1
v_bfe_u32 v138, v139, 2, 14
v_exp_f16 v153, v154
v_lshrrev_b32 v137, 18, v137
v_exp_f16 v150, v151
v_lshrrev_b32 v139, 18, v139
ds_read_b128 v[232:235], v248 offset:59392
ds_read_u16_d16 v138, v138
ds_read_u16_d16_hi v137, v137
ds_read_u16_d16_hi v139, v139
v_mfma_f32_32x32x16_bf16 v[120:135], v[236:239], v[108:111], v[120:135]
v_exp_f16 v147, v148
v_and_b32 v141, s49, v141
v_and_b32_e64 v143, s49, v143
v_exp_f16_sdwa v153, v154 dst_sel:WORD_1 dst_unused:UNUSED_PRESERVE src0_sel:WORD_1
v_bfe_u32 v140, v141, 2, 14
v_exp_f16_sdwa v150, v151 dst_sel:WORD_1 dst_unused:UNUSED_PRESERVE src0_sel:WORD_1
v_bfe_u32 v142, v143, 2, 14
v_exp_f16_sdwa v147, v148 dst_sel:WORD_1 dst_unused:UNUSED_PRESERVE src0_sel:WORD_1
ds_read_b128 v[236:239], v248 offset:62464
ds_read_u16_d16 v140, v140
ds_read_u16_d16 v142, v142
v_mfma_f32_32x32x16_bf16 v[120:135], v[224:227], v[112:115], v[120:135]
v_lshrrev_b32_e64 v141, 18, v141
v_pk_add_f16 v153, v153, 1.0 op_sel_hi:[1,0]
v_lshrrev_b32 v143, 18, v143
v_pk_add_f16 v150, v150, 1.0 op_sel_hi:[1,0]
s_setprio 0
v_pk_add_f16 v147, v147, 1.0 op_sel_hi:[1,0]
v_and_b32 v145, s49, v145
v_rcp_f16 v154, v153
v_bfe_u32 v144, v145, 2, 14
v_rcp_f16_e64 v151, v150
ds_read_b128 v[224:227], v248 offset:60416
ds_read_u16_d16_hi v141, v141
ds_read_u16_d16_hi v143, v143
ds_read_u16_d16 v144, v144
v_mfma_f32_32x32x16_bf16 v[120:135], v[228:231], v[116:119], v[120:135]
v_lshrrev_b32 v145, 18, v145
v_rcp_f16 v148, v147
s_waitcnt lgkmcnt(7)
v_or_b32 v176, v136, v137
v_or_b32_e64 v177, v138, v139
v_rcp_f16_sdwa v154, v153 dst_sel:WORD_1 dst_unused:UNUSED_PRESERVE src0_sel:WORD_1
s_waitcnt lgkmcnt(2)
v_or_b32 v178, v140, v141
v_rcp_f16_sdwa v151, v150 dst_sel:WORD_1 dst_unused:UNUSED_PRESERVE src0_sel:WORD_1
s_waitcnt lgkmcnt(1)
v_or_b32 v179, v142, v143
v_rcp_f16_sdwa v148, v147 dst_sel:WORD_1 dst_unused:UNUSED_PRESERVE src0_sel:WORD_1
ds_read_u16_d16_hi v145, v145
s_waitcnt lgkmcnt(0)
v_or_b32 v180, v144, v145
v_pk_mul_f16 v181, v155, v154
v_pk_mul_f16 v182, v152, v151
v_pk_mul_f16 v183, v149, v148
s_cmp_eq_u32 s77, 0
s_cbranch_scc1 Lpp49
s_getreg_b32 s43, hwreg(HW_REG_IB_STS, 0, 4)
s_cmp_lg_u32 s43, 0
s_cbranch_scc1 Lpp49
s_call_b64 s[78:79], Lpoll
s_setprio 0
Lpp49:
s_setprio 2
v_cvt_pkrtz_f16_f32 v137, v120, v121
v_cvt_pkrtz_f16_f32 v139, v122, v123
v_cvt_pkrtz_f16_f32 v141, v124, v125
v_cvt_pkrtz_f16_f32 v143, v126, v127
v_cvt_pkrtz_f16_f32 v145, v128, v129
v_cvt_pk_f16_f32 v155, v130, v131
v_cvt_pk_f16_f32 v152, v132, v133
v_cvt_pk_f16_f32 v149, v134, v135
ds_read_b128 v[228:231], v248 offset:63488
v_mfma_f32_32x32x16_bf16 v[120:135], v[232:235], v[96:99], 0
v_pk_fma_f16 v154, v155, v155, s48
v_and_b32_e64 v137, s49, v137
v_pk_fma_f16 v151, v152, v152, s48
v_and_b32_e64 v139, s49, v139
v_pk_fma_f16 v148, v149, v149, s48
v_pk_mul_f16 v154, v155, v154
v_bfe_u32 v136, v137, 2, 14
v_pk_mul_f16 v151, v152, v151
ds_read_b128 v[232:235], v248 offset:61440
ds_read_u16_d16 v136, v136
v_mfma_f32_32x32x16_bf16 v[120:135], v[236:239], v[100:103], v[120:135]
v_pk_mul_f16 v148, v149, v148
v_bfe_u32 v138, v139, 2, 14
v_exp_f16 v153, v154
v_lshrrev_b32 v137, 18, v137
v_exp_f16 v150, v151
v_lshrrev_b32 v139, 18, v139
ds_read_b128 v[236:239], v248 offset:64512
ds_read_u16_d16 v138, v138
ds_read_u16_d16_hi v137, v137
ds_read_u16_d16_hi v139, v139
v_mfma_f32_32x32x16_bf16 v[120:135], v[224:227], v[104:107], v[120:135]
v_exp_f16 v147, v148
v_and_b32 v141, s49, v141
v_and_b32 v143, s49, v143
v_exp_f16_sdwa v153, v154 dst_sel:WORD_1 dst_unused:UNUSED_PRESERVE src0_sel:WORD_1
v_bfe_u32 v140, v141, 2, 14
v_exp_f16_sdwa v150, v151 dst_sel:WORD_1 dst_unused:UNUSED_PRESERVE src0_sel:WORD_1
s_waitcnt lgkmcnt(6)
ds_read_b128 v[224:227], v249
ds_read_u16_d16 v140, v140
v_mfma_f32_32x32x16_bf16 v[120:135], v[228:231], v[108:111], v[120:135]
v_bfe_u32 v142, v143, 2, 14
v_exp_f16_sdwa v147, v148 dst_sel:WORD_1 dst_unused:UNUSED_PRESERVE src0_sel:WORD_1
v_lshrrev_b32_e64 v141, 18, v141
v_pk_add_f16 v153, v153, 1.0 op_sel_hi:[1,0]
v_lshrrev_b32 v143, 18, v143
v_pk_add_f16 v150, v150, 1.0 op_sel_hi:[1,0]
v_pk_add_f16 v147, v147, 1.0 op_sel_hi:[1,0]
s_waitcnt lgkmcnt(6)
ds_read_b128 v[228:231], v249 offset:3072
ds_read_u16_d16 v142, v142
ds_read_u16_d16_hi v141, v141
ds_read_u16_d16_hi v143, v143
v_mfma_f32_32x32x16_bf16 v[120:135], v[232:235], v[112:115], v[120:135]
v_and_b32 v145, s49, v145
v_rcp_f16 v154, v153
v_bfe_u32 v144, v145, 2, 14
v_rcp_f16_e64 v151, v150
v_lshrrev_b32 v145, 18, v145
s_waitcnt lgkmcnt(6)
ds_read_b128 v[232:235], v249 offset:1024
ds_read_u16_d16 v144, v144
ds_read_u16_d16_hi v145, v145
v_mfma_f32_32x32x16_bf16 v[120:135], v[236:239], v[116:119], v[120:135]
v_rcp_f16 v148, v147
v_or_b32 v184, v136, v137
v_or_b32_e64 v185, v138, v139
v_rcp_f16_sdwa v154, v153 dst_sel:WORD_1 dst_unused:UNUSED_PRESERVE src0_sel:WORD_1
s_waitcnt lgkmcnt(4)
v_or_b32 v186, v140, v141
v_rcp_f16_sdwa v151, v150 dst_sel:WORD_1 dst_unused:UNUSED_PRESERVE src0_sel:WORD_1
s_waitcnt lgkmcnt(3)
v_or_b32 v187, v142, v143
v_rcp_f16_sdwa v148, v147 dst_sel:WORD_1 dst_unused:UNUSED_PRESERVE src0_sel:WORD_1
s_waitcnt lgkmcnt(0)
v_or_b32 v188, v144, v145
v_pk_mul_f16 v189, v155, v154
v_pk_mul_f16 v190, v152, v151
v_pk_mul_f16 v191, v149, v148
s_cmp_eq_u32 s77, 0
s_cbranch_scc1 Lpp50
s_getreg_b32 s43, hwreg(HW_REG_IB_STS, 0, 4)
s_cmp_lg_u32 s43, 0
s_cbranch_scc1 Lpp50
s_call_b64 s[78:79], Lpoll
s_setprio 2
Lpp50:
s_setprio 1
v_cvt_pkrtz_f16_f32 v137, v120, v121
v_cvt_pkrtz_f16_f32 v139, v122, v123
v_cvt_pkrtz_f16_f32 v141, v124, v125
v_cvt_pkrtz_f16_f32 v143, v126, v127
v_cvt_pkrtz_f16_f32 v145, v128, v129
v_cvt_pk_f16_f32 v155, v130, v131
v_cvt_pk_f16_f32 v152, v132, v133
v_cvt_pk_f16_f32 v149, v134, v135
ds_read_b128 v[236:239], v249 offset:4096
v_mfma_f32_32x32x16_bf16 v[120:135], v[224:227], v[96:99], 0
v_pk_fma_f16 v154, v155, v155, s48
v_and_b32_e64 v137, s49, v137
v_pk_fma_f16 v151, v152, v152, s48
v_and_b32_e64 v139, s49, v139
v_pk_fma_f16 v148, v149, v149, s48
v_pk_mul_f16 v154, v155, v154
v_bfe_u32 v136, v137, 2, 14
v_pk_mul_f16 v151, v152, v151
ds_read_b128 v[224:227], v249 offset:2048
ds_read_u16_d16 v136, v136
v_mfma_f32_32x32x16_bf16 v[120:135], v[228:231], v[100:103], v[120:135]
v_pk_mul_f16 v148, v149, v148
v_bfe_u32 v138, v139, 2, 14
v_exp_f16 v153, v154
v_lshrrev_b32 v137, 18, v137
v_exp_f16 v150, v151
v_lshrrev_b32 v139, 18, v139
ds_read_b128 v[228:231], v249 offset:5120
ds_read_u16_d16 v138, v138
ds_read_u16_d16_hi v137, v137
ds_read_u16_d16_hi v139, v139
v_mfma_f32_32x32x16_bf16 v[120:135], v[232:235], v[104:107], v[120:135]
v_exp_f16 v147, v148
v_and_b32 v141, s49, v141
v_and_b32 v143, s49, v143
v_exp_f16_sdwa v153, v154 dst_sel:WORD_1 dst_unused:UNUSED_PRESERVE src0_sel:WORD_1
v_bfe_u32 v140, v141, 2, 14
v_exp_f16_sdwa v150, v151 dst_sel:WORD_1 dst_unused:UNUSED_PRESERVE src0_sel:WORD_1
s_waitcnt lgkmcnt(6)
ds_read_b128 v[232:235], v249 offset:6144
ds_read_u16_d16 v140, v140
v_mfma_f32_32x32x16_bf16 v[120:135], v[236:239], v[108:111], v[120:135]
v_bfe_u32 v142, v143, 2, 14
v_exp_f16_sdwa v147, v148 dst_sel:WORD_1 dst_unused:UNUSED_PRESERVE src0_sel:WORD_1
v_lshrrev_b32_e64 v141, 18, v141
v_pk_add_f16 v153, v153, 1.0 op_sel_hi:[1,0]
v_lshrrev_b32 v143, 18, v143
v_pk_add_f16 v150, v150, 1.0 op_sel_hi:[1,0]
v_pk_add_f16 v147, v147, 1.0 op_sel_hi:[1,0]
s_waitcnt lgkmcnt(6)
ds_read_b128 v[236:239], v249 offset:9216
ds_read_u16_d16 v142, v142
ds_read_u16_d16_hi v141, v141
ds_read_u16_d16_hi v143, v143
v_mfma_f32_32x32x16_bf16 v[120:135], v[224:227], v[112:115], v[120:135]
v_and_b32 v145, s49, v145
v_rcp_f16 v154, v153
v_bfe_u32 v144, v145, 2, 14
s_setprio 0
v_rcp_f16 v151, v150
v_lshrrev_b32 v145, 18, v145
s_waitcnt lgkmcnt(6)
ds_read_b128 v[224:227], v249 offset:7168
ds_read_u16_d16 v144, v144
ds_read_u16_d16_hi v145, v145
v_mfma_f32_32x32x16_bf16 v[120:135], v[228:231], v[116:119], v[120:135]
v_rcp_f16 v148, v147
v_or_b32 v192, v136, v137
v_or_b32_e64 v193, v138, v139
v_rcp_f16_sdwa v154, v153 dst_sel:WORD_1 dst_unused:UNUSED_PRESERVE src0_sel:WORD_1
s_waitcnt lgkmcnt(4)
v_or_b32 v194, v140, v141
v_rcp_f16_sdwa v151, v150 dst_sel:WORD_1 dst_unused:UNUSED_PRESERVE src0_sel:WORD_1
s_waitcnt lgkmcnt(3)
v_or_b32 v195, v142, v143
v_rcp_f16_sdwa v148, v147 dst_sel:WORD_1 dst_unused:UNUSED_PRESERVE src0_sel:WORD_1
s_waitcnt lgkmcnt(0)
v_or_b32 v196, v144, v145
v_pk_mul_f16 v197, v155, v154
v_pk_mul_f16 v198, v152, v151
v_pk_mul_f16 v199, v149, v148
s_cmp_eq_u32 s77, 0
s_cbranch_scc1 Lpp51
s_getreg_b32 s43, hwreg(HW_REG_IB_STS, 0, 4)
s_cmp_lg_u32 s43, 0
s_cbranch_scc1 Lpp51
s_call_b64 s[78:79], Lpoll
s_setprio 0
Lpp51:
v_mov_b32 v136, 16256
Lw2w:
ds_read_b32 v137, v136 offset:4
s_waitcnt lgkmcnt(0)
v_readfirstlane_b32 s43, v137
s_cmp_eq_u32 s76, 0
s_cbranch_scc1 Lw2x
s_sub_u32 s76, s76, 1
s_cmp_lt_u32 s43, 1
s_cbranch_scc0 Lw2x
s_sleep 2
s_branch Lw2w
Lw2x:
v_lshrrev_b32_e64 v136, 2, v251
v_mul_u32_u24 v136, 192, v136
v_and_b32 v137, 3, v251
v_lshl_add_u32 v136, v137, 4, v136
s_add_u32 m0, s72, 7168
s_add_u32 s43, s82, 6208
buffer_load_dwordx4 v136, s[16:19], s43 offen lds
s_add_u32 m0, s72, 8192
s_add_u32 s43, s82, 6272
buffer_load_dwordx4 v136, s[16:19], s43 offen lds
s_setprio 2
v_cvt_pkrtz_f16_f32 v137, v120, v121
v_cvt_pkrtz_f16_f32 v139, v122, v123
v_cvt_pkrtz_f16_f32 v141, v124, v125
v_cvt_pkrtz_f16_f32 v143, v126, v127
v_cvt_pkrtz_f16_f32 v145, v128, v129
v_cvt_pk_f16_f32 v155, v130, v131
v_cvt_pk_f16_f32 v152, v132, v133
v_cvt_pk_f16_f32 v149, v134, v135
ds_read_b128 v[228:231], v249 offset:10240
v_mfma_f32_32x32x16_bf16 v[120:135], v[232:235], v[96:99], 0
v_pk_fma_f16 v154, v155, v155, s48
v_and_b32_e64 v137, s49, v137
v_pk_fma_f16 v151, v152, v152, s48
v_and_b32_e64 v139, s49, v139
v_pk_fma_f16 v148, v149, v149, s48
v_pk_mul_f16 v154, v155, v154
v_bfe_u32 v136, v137, 2, 14
v_pk_mul_f16 v151, v152, v151
ds_read_b128 v[232:235], v249 offset:8192
ds_read_u16_d16 v136, v136
v_mfma_f32_32x32x16_bf16 v[120:135], v[236:239], v[100:103], v[120:135]
v_pk_mul_f16 v148, v149, v148
v_bfe_u32 v138, v139, 2, 14
v_exp_f16 v153, v154
v_lshrrev_b32 v137, 18, v137
v_exp_f16 v150, v151
v_lshrrev_b32 v139, 18, v139
ds_read_b128 v[236:239], v249 offset:11264
ds_read_u16_d16 v138, v138
ds_read_u16_d16_hi v137, v137
ds_read_u16_d16_hi v139, v139
v_mfma_f32_32x32x16_bf16 v[120:135], v[224:227], v[104:107], v[120:135]
v_exp_f16 v147, v148
v_and_b32 v141, s49, v141
v_and_b32 v143, s49, v143
v_exp_f16_sdwa v153, v154 dst_sel:WORD_1 dst_unused:UNUSED_PRESERVE src0_sel:WORD_1
v_bfe_u32 v140, v141, 2, 14
v_exp_f16_sdwa v150, v151 dst_sel:WORD_1 dst_unused:UNUSED_PRESERVE src0_sel:WORD_1
s_waitcnt lgkmcnt(6)
ds_read_b128 v[224:227], v249 offset:12288
ds_read_u16_d16 v140, v140
v_mfma_f32_32x32x16_bf16 v[120:135], v[228:231], v[108:111], v[120:135]
v_bfe_u32 v142, v143, 2, 14
v_exp_f16_sdwa v147, v148 dst_sel:WORD_1 dst_unused:UNUSED_PRESERVE src0_sel:WORD_1
v_lshrrev_b32_e64 v141, 18, v141
v_pk_add_f16 v153, v153, 1.0 op_sel_hi:[1,0]
v_lshrrev_b32 v143, 18, v143
v_pk_add_f16 v150, v150, 1.0 op_sel_hi:[1,0]
v_pk_add_f16 v147, v147, 1.0 op_sel_hi:[1,0]
s_waitcnt lgkmcnt(6)
ds_read_b128 v[228:231], v249 offset:15360
ds_read_u16_d16 v142, v142
ds_read_u16_d16_hi v141, v141
ds_read_u16_d16_hi v143, v143
v_mfma_f32_32x32x16_bf16 v[120:135], v[232:235], v[112:115], v[120:135]
v_and_b32 v145, s49, v145
v_rcp_f16 v154, v153
v_bfe_u32 v144, v145, 2, 14
v_rcp_f16_e64 v151, v150
v_lshrrev_b32 v145, 18, v145
s_waitcnt lgkmcnt(6)
ds_read_b128 v[232:235], v249 offset:13312
ds_read_u16_d16 v144, v144
ds_read_u16_d16_hi v145, v145
v_mfma_f32_32x32x16_bf16 v[120:135], v[236:239], v[116:119], v[120:135]
v_rcp_f16 v148, v147
v_or_b32 v200, v136, v137
v_or_b32_e64 v201, v138, v139
v_rcp_f16_sdwa v154, v153 dst_sel:WORD_1 dst_unused:UNUSED_PRESERVE src0_sel:WORD_1
s_waitcnt lgkmcnt(4)
v_or_b32 v202, v140, v141
v_rcp_f16_sdwa v151, v150 dst_sel:WORD_1 dst_unused:UNUSED_PRESERVE src0_sel:WORD_1
s_waitcnt lgkmcnt(3)
v_or_b32 v203, v142, v143
v_rcp_f16_sdwa v148, v147 dst_sel:WORD_1 dst_unused:UNUSED_PRESERVE src0_sel:WORD_1
s_waitcnt lgkmcnt(0)
v_or_b32 v204, v144, v145
v_pk_mul_f16 v205, v155, v154
v_pk_mul_f16 v206, v152, v151
v_pk_mul_f16 v207, v149, v148
s_cmp_eq_u32 s77, 0
s_cbranch_scc1 Lpp52
s_getreg_b32 s43, hwreg(HW_REG_IB_STS, 0, 4)
s_cmp_lg_u32 s43, 0
s_cbranch_scc1 Lpp52
s_call_b64 s[78:79], Lpoll
s_setprio 2
Lpp52:
s_setprio 1
v_cvt_pkrtz_f16_f32 v137, v120, v121
v_cvt_pkrtz_f16_f32 v139, v122, v123
v_cvt_pkrtz_f16_f32 v141, v124, v125
v_cvt_pkrtz_f16_f32 v143, v126, v127
v_cvt_pkrtz_f16_f32 v145, v128, v129
v_cvt_pk_f16_f32 v155, v130, v131
v_cvt_pk_f16_f32 v152, v132, v133
v_cvt_pk_f16_f32 v149, v134, v135
ds_read_b128 v[236:239], v249 offset:16384
v_mfma_f32_32x32x16_bf16 v[120:135], v[224:227], v[96:99], 0
v_pk_fma_f16 v154, v155, v155, s48
v_and_b32_e64 v137, s49, v137
v_pk_fma_f16 v151, v152, v152, s48
v_and_b32_e64 v139, s49, v139
v_pk_fma_f16 v148, v149, v149, s48
v_pk_mul_f16 v154, v155, v154
v_bfe_u32 v136, v137, 2, 14
v_pk_mul_f16 v151, v152, v151
ds_read_b128 v[224:227], v249 offset:14336
ds_read_u16_d16 v136, v136
v_mfma_f32_32x32x16_bf16 v[120:135], v[228:231], v[100:103], v[120:135]
v_pk_mul_f16 v148, v149, v148
v_bfe_u32 v138, v139, 2, 14
v_exp_f16 v153, v154
v_lshrrev_b32 v137, 18, v137
v_exp_f16 v150, v151
v_lshrrev_b32 v139, 18, v139
ds_read_b128 v[228:231], v249 offset:17408
ds_read_u16_d16 v138, v138
ds_read_u16_d16_hi v137, v137
ds_read_u16_d16_hi v139, v139
v_mfma_f32_32x32x16_bf16 v[120:135], v[232:235], v[104:107], v[120:135]
v_exp_f16 v147, v148
v_and_b32 v141, s49, v141
v_and_b32 v143, s49, v143
v_exp_f16_sdwa v153, v154 dst_sel:WORD_1 dst_unused:UNUSED_PRESERVE src0_sel:WORD_1
v_bfe_u32 v140, v141, 2, 14
v_exp_f16_sdwa v150, v151 dst_sel:WORD_1 dst_unused:UNUSED_PRESERVE src0_sel:WORD_1
s_waitcnt lgkmcnt(6)
ds_read_u16_d16 v140, v140
v_mfma_f32_32x32x16_bf16 v[120:135], v[236:239], v[108:111], v[120:135]
v_bfe_u32 v142, v143, 2, 14
v_exp_f16_sdwa v147, v148 dst_sel:WORD_1 dst_unused:UNUSED_PRESERVE src0_sel:WORD_1
v_lshrrev_b32_e64 v141, 18, v141
v_pk_add_f16 v153, v153, 1.0 op_sel_hi:[1,0]
v_lshrrev_b32 v143, 18, v143
v_pk_add_f16 v150, v150, 1.0 op_sel_hi:[1,0]
v_pk_add_f16 v147, v147, 1.0 op_sel_hi:[1,0]
s_waitcnt lgkmcnt(5)
ds_read_u16_d16 v142, v142
ds_read_u16_d16_hi v141, v141
ds_read_u16_d16_hi v143, v143
v_mfma_f32_32x32x16_bf16 v[120:135], v[224:227], v[112:115], v[120:135]
v_and_b32 v145, s49, v145
v_rcp_f16 v154, v153
v_bfe_u32 v144, v145, 2, 14
s_setprio 0
v_rcp_f16 v151, v150
v_lshrrev_b32 v145, 18, v145
s_waitcnt lgkmcnt(4)
ds_read_u16_d16 v144, v144
ds_read_u16_d16_hi v145, v145
v_mfma_f32_32x32x16_bf16 v[120:135], v[228:231], v[116:119], v[120:135]
v_rcp_f16 v148, v147
v_or_b32 v240, v136, v137
v_or_b32_e64 v241, v138, v139
v_rcp_f16_sdwa v154, v153 dst_sel:WORD_1 dst_unused:UNUSED_PRESERVE src0_sel:WORD_1
s_waitcnt lgkmcnt(3)
v_or_b32 v242, v140, v141
v_rcp_f16_sdwa v151, v150 dst_sel:WORD_1 dst_unused:UNUSED_PRESERVE src0_sel:WORD_1
s_waitcnt lgkmcnt(2)
v_or_b32 v243, v142, v143
v_rcp_f16_sdwa v148, v147 dst_sel:WORD_1 dst_unused:UNUSED_PRESERVE src0_sel:WORD_1
s_waitcnt lgkmcnt(0)
v_or_b32 v244, v144, v145
v_pk_mul_f16 v245, v155, v154
v_pk_mul_f16 v246, v152, v151
v_pk_mul_f16 v247, v149, v148
s_cmp_eq_u32 s77, 0
s_cbranch_scc1 Lpp53
s_getreg_b32 s43, hwreg(HW_REG_IB_STS, 0, 4)
s_cmp_lg_u32 s43, 0
s_cbranch_scc1 Lpp53
s_call_b64 s[78:79], Lpoll
s_setprio 0
Lpp53:
s_setprio 2
v_cvt_pkrtz_f16_f32 v137, v120, v121
v_cvt_pkrtz_f16_f32 v139, v122, v123
v_cvt_pkrtz_f16_f32 v141, v124, v125
v_cvt_pkrtz_f16_f32 v143, v126, v127
v_cvt_pkrtz_f16_f32 v145, v128, v129
v_cvt_pk_f16_f32 v155, v130, v131
v_cvt_pk_f16_f32 v152, v132, v133
v_cvt_pk_f16_f32 v149, v134, v135
v_pk_fma_f16 v154, v155, v155, s48
v_and_b32_e64 v137, s49, v137
v_pk_fma_f16 v151, v152, v152, s48
v_and_b32_e64 v139, s49, v139
v_pk_fma_f16 v148, v149, v149, s48
v_pk_mul_f16 v154, v155, v154
v_bfe_u32 v136, v137, 2, 14
v_pk_mul_f16 v151, v152, v151
v_pk_mul_f16 v148, v149, v148
v_bfe_u32 v138, v139, 2, 14
v_exp_f16 v153, v154
v_lshrrev_b32 v137, 18, v137
v_exp_f16 v150, v151
v_lshrrev_b32 v139, 18, v139
v_exp_f16 v147, v148
v_and_b32 v141, s49, v141
v_and_b32_e64 v143, s49, v143
ds_read_u16_d16 v136, v136
ds_read_u16_d16 v138, v138
ds_read_u16_d16_hi v137, v137
ds_read_u16_d16_hi v139, v139
v_exp_f16_sdwa v153, v154 dst_sel:WORD_1 dst_unused:UNUSED_PRESERVE src0_sel:WORD_1
v_bfe_u32 v140, v141, 2, 14
v_exp_f16_sdwa v150, v151 dst_sel:WORD_1 dst_unused:UNUSED_PRESERVE src0_sel:WORD_1
s_setprio 1
v_bfe_u32 v142, v143, 2, 14
v_exp_f16_sdwa v147, v148 dst_sel:WORD_1 dst_unused:UNUSED_PRESERVE src0_sel:WORD_1
v_lshrrev_b32 v141, 18, v141
v_pk_add_f16 v153, v153, 1.0 op_sel_hi:[1,0]
v_lshrrev_b32_e64 v143, 18, v143
v_pk_add_f16 v150, v150, 1.0 op_sel_hi:[1,0]
v_pk_add_f16 v147, v147, 1.0 op_sel_hi:[1,0]
v_and_b32 v145, s49, v145
v_rcp_f16 v154, v153
v_bfe_u32 v144, v145, 2, 14
v_rcp_f16 v151, v150
v_lshrrev_b32 v145, 18, v145
ds_read_u16_d16 v140, v140
ds_read_u16_d16 v142, v142
ds_read_u16_d16_hi v141, v141
ds_read_u16_d16_hi v143, v143
ds_read_u16_d16 v144, v144
ds_read_u16_d16_hi v145, v145
v_rcp_f16 v148, v147
s_waitcnt lgkmcnt(7)
v_or_b32 v232, v136, v137
s_waitcnt lgkmcnt(6)
v_or_b32 v233, v138, v139
v_rcp_f16_sdwa v154, v153 dst_sel:WORD_1 dst_unused:UNUSED_PRESERVE src0_sel:WORD_1
s_waitcnt lgkmcnt(3)
v_or_b32 v234, v140, v141
s_setprio 0
v_rcp_f16_sdwa v151, v150 dst_sel:WORD_1 dst_unused:UNUSED_PRESERVE src0_sel:WORD_1
s_waitcnt lgkmcnt(2)
v_or_b32 v235, v142, v143
v_rcp_f16_sdwa v148, v147 dst_sel:WORD_1 dst_unused:UNUSED_PRESERVE src0_sel:WORD_1
s_waitcnt lgkmcnt(0)
v_or_b32 v236, v144, v145
v_pk_mul_f16 v237, v155, v154
v_pk_mul_f16 v238, v152, v151
v_pk_mul_f16 v239, v149, v148
s_cmp_eq_u32 s77, 0
s_cbranch_scc1 Lpp54
s_getreg_b32 s43, hwreg(HW_REG_IB_STS, 0, 4)
s_cmp_lg_u32 s43, 0
s_cbranch_scc1 Lpp54
s_call_b64 s[78:79], Lpoll
s_setprio 0
Lpp54:
s_setprio 2
v_lshrrev_b32_e64 v225, 5, v251
v_lshl_add_u32 v224, v225, 9, s72
v_lshl_add_u32 v226, v225, 4, s72
v_and_b32 v225, 15, v251
v_lshl_add_u32 v224, v225, 4, v224
v_bfe_u32 v225, v251, 4, 1
v_lshl_add_u32 v224, v225, 3, v224
s_waitcnt vmcnt(0)
ds_read_b64_tr_b16 v[120:121], v224
ds_read_b64_tr_b16 v[122:123], v224 offset:256
ds_read_b64_tr_b16 v[124:125], v224 offset:1024
ds_read_b64_tr_b16 v[126:127], v224 offset:1280
ds_read_b64_tr_b16 v[128:129], v224 offset:2048
ds_read_b64_tr_b16 v[130:131], v224 offset:2304
ds_read_b64_tr_b16 v[132:133], v224 offset:3072
ds_read_b64_tr_b16 v[134:135], v224 offset:3328
ds_read_b64_tr_b16 v[136:137], v224 offset:4096
ds_read_b64_tr_b16 v[138:139], v224 offset:4352
ds_read_b64_tr_b16 v[140:141], v224 offset:5120
ds_read_b64_tr_b16 v[142:143], v224 offset:5376
ds_read_b64_tr_b16 v[144:145], v224 offset:6144
ds_read_b64_tr_b16 v[146:147], v224 offset:6400
ds_read_b64_tr_b16 v[148:149], v224 offset:7168
ds_read_b64_tr_b16 v[150:151], v224 offset:7424
ds_read_b64_tr_b16 v[152:153], v224 offset:8192
ds_read_b64_tr_b16 v[154:155], v224 offset:8448
v_mov_b32 v225, 16256
v_mov_b32_e64 v227, 1
v_permlane16_swap_b32 v0, v4
v_permlane16_swap_b32 v1, v5
v_permlane16_swap_b32 v2, v6
v_permlane16_swap_b32 v3, v7
v_permlane16_swap_b32 v8, v12
v_permlane16_swap_b32 v9, v13
v_permlane16_swap_b32 v10, v14
v_permlane16_swap_b32 v11, v15
s_waitcnt lgkmcnt(0)
s_mov_b64 exec, 1
ds_add_u32 v225, v227 offset:8
s_mov_b64 exec, -1
v_lshlrev_b32 v228, 16, v120
v_and_b32 v229, 4294901760, v120
v_cvt_pk_f16_f32 v120, v228, v229
v_lshlrev_b32_e64 v230, 16, v121
v_and_b32 v231, 4294901760, v121
v_cvt_pk_f16_f32 v121, v230, v231
v_lshlrev_b32_e64 v228, 16, v122
v_and_b32 v229, 4294901760, v122
v_cvt_pk_f16_f32 v122, v228, v229
v_lshlrev_b32_e64 v230, 16, v123
v_and_b32 v231, 4294901760, v123
v_cvt_pk_f16_f32 v123, v230, v231
v_lshlrev_b32_e64 v228, 16, v124
v_and_b32 v229, 4294901760, v124
v_cvt_pk_f16_f32 v124, v228, v229
v_lshlrev_b32_e64 v230, 16, v125
v_and_b32 v231, 4294901760, v125
v_cvt_pk_f16_f32 v125, v230, v231
v_lshlrev_b32_e64 v228, 16, v126
v_and_b32 v229, 4294901760, v126
v_cvt_pk_f16_f32 v126, v228, v229
v_lshlrev_b32_e64 v230, 16, v127
v_and_b32 v231, 4294901760, v127
v_cvt_pk_f16_f32 v127, v230, v231
v_lshlrev_b32_e64 v228, 16, v128
v_and_b32 v229, 4294901760, v128
v_cvt_pk_f16_f32 v128, v228, v229
v_lshlrev_b32_e64 v230, 16, v129
v_and_b32 v231, 4294901760, v129
v_cvt_pk_f16_f32 v129, v230, v231
v_lshlrev_b32_e64 v228, 16, v130
v_and_b32 v229, 4294901760, v130
v_cvt_pk_f16_f32 v130, v228, v229
v_lshlrev_b32_e64 v230, 16, v131
v_and_b32 v231, 4294901760, v131
v_cvt_pk_f16_f32 v131, v230, v231
s_cmp_eq_u32 s77, 0
s_cbranch_scc1 Lpp911
s_getreg_b32 s43, hwreg(HW_REG_IB_STS, 0, 4)
s_cmp_lg_u32 s43, 0
s_cbranch_scc1 Lpp911
s_call_b64 s[78:79], Lpoll
s_setprio 2
Lpp911:
v_lshlrev_b32 v228, 16, v132
v_and_b32 v229, 4294901760, v132
v_cvt_pk_f16_f32 v132, v228, v229
v_lshlrev_b32_e64 v230, 16, v133
v_and_b32 v231, 4294901760, v133
v_cvt_pk_f16_f32 v133, v230, v231
v_lshlrev_b32_e64 v228, 16, v134
v_and_b32 v229, 4294901760, v134
v_cvt_pk_f16_f32 v134, v228, v229
v_lshlrev_b32_e64 v230, 16, v135
v_and_b32 v231, 4294901760, v135
v_cvt_pk_f16_f32 v135, v230, v231
v_lshlrev_b32_e64 v228, 16, v136
v_and_b32 v229, 4294901760, v136
v_cvt_pk_f16_f32 v136, v228, v229
v_lshlrev_b32_e64 v230, 16, v137
v_and_b32 v231, 4294901760, v137
v_cvt_pk_f16_f32 v137, v230, v231
v_lshlrev_b32_e64 v228, 16, v138
v_and_b32 v229, 4294901760, v138
v_cvt_pk_f16_f32 v138, v228, v229
v_lshlrev_b32_e64 v230, 16, v139
v_and_b32 v231, 4294901760, v139
v_cvt_pk_f16_f32 v139, v230, v231
v_lshlrev_b32_e64 v228, 16, v140
v_and_b32 v229, 4294901760, v140
v_cvt_pk_f16_f32 v140, v228, v229
v_lshlrev_b32_e64 v230, 16, v141
v_and_b32 v231, 4294901760, v141
v_cvt_pk_f16_f32 v141, v230, v231
v_lshlrev_b32_e64 v228, 16, v142
v_and_b32 v229, 4294901760, v142
v_cvt_pk_f16_f32 v142, v228, v229
v_lshlrev_b32_e64 v230, 16, v143
v_and_b32 v231, 4294901760, v143
v_cvt_pk_f16_f32 v143, v230, v231
s_cmp_eq_u32 s77, 0
s_cbranch_scc1 Lpp923
s_getreg_b32 s43, hwreg(HW_REG_IB_STS, 0, 4)
s_cmp_lg_u32 s43, 0
s_cbranch_scc1 Lpp923
s_call_b64 s[78:79], Lpoll
s_setprio 2
Lpp923:
v_lshlrev_b32 v228, 16, v144
v_and_b32 v229, 4294901760, v144
v_cvt_pk_f16_f32 v144, v228, v229
v_lshlrev_b32_e64 v230, 16, v145
v_and_b32 v231, 4294901760, v145
v_cvt_pk_f16_f32 v145, v230, v231
v_lshlrev_b32_e64 v228, 16, v146
v_and_b32 v229, 4294901760, v146
v_cvt_pk_f16_f32 v146, v228, v229
v_lshlrev_b32_e64 v230, 16, v147
v_and_b32 v231, 4294901760, v147
v_cvt_pk_f16_f32 v147, v230, v231
v_lshlrev_b32_e64 v228, 16, v148
v_and_b32 v229, 4294901760, v148
v_cvt_pk_f16_f32 v148, v228, v229
v_lshlrev_b32_e64 v230, 16, v149
v_and_b32 v231, 4294901760, v149
v_cvt_pk_f16_f32 v149, v230, v231
v_lshlrev_b32_e64 v228, 16, v150
v_and_b32 v229, 4294901760, v150
v_cvt_pk_f16_f32 v150, v228, v229
v_lshlrev_b32_e64 v230, 16, v151
v_and_b32 v231, 4294901760, v151
v_cvt_pk_f16_f32 v151, v230, v231
v_lshlrev_b32_e64 v228, 16, v152
v_and_b32 v229, 4294901760, v152
v_cvt_pk_f16_f32 v152, v228, v229
v_lshlrev_b32_e64 v230, 16, v153
v_and_b32 v231, 4294901760, v153
v_cvt_pk_f16_f32 v153, v230, v231
v_lshlrev_b32_e64 v228, 16, v154
v_and_b32 v229, 4294901760, v154
v_cvt_pk_f16_f32 v154, v228, v229
v_lshlrev_b32_e64 v230, 16, v155
v_and_b32 v231, 4294901760, v155
v_cvt_pk_f16_f32 v155, v230, v231
s_cmp_eq_u32 s77, 0
s_cbranch_scc1 Lpp935
s_getreg_b32 s43, hwreg(HW_REG_IB_STS, 0, 4)
s_cmp_lg_u32 s43, 0
s_cbranch_scc1 Lpp935
s_call_b64 s[78:79], Lpoll
s_setprio 2
Lpp935:
v_lshl_add_u32 v224, v251, 4, s72
v_add_u32 v228, 0, v251
v_mul_u32_u24 v231, 2731, v228
v_lshrrev_b32_e64 v231, 16, v231
v_mul_u32_u24 v231, 9120, v231
v_lshl_add_u32 v228, v228, 2, v231
v_add_u32 v228, 90112, v228
v_add_u32_e64 v229, 64, v251
v_mul_u32_u24 v231, 2731, v229
v_lshrrev_b32_e64 v231, 16, v231
v_mul_u32_u24 v231, 9120, v231
v_lshl_add_u32 v229, v229, 2, v231
v_add_u32 v229, 90112, v229
v_add_u32 v230, 128, v251
v_mul_u32_u24 v231, 2731, v230
v_lshrrev_b32_e64 v231, 16, v231
v_mul_u32_u24 v231, 9120, v231
v_lshl_add_u32 v230, v230, 2, v231
v_add_u32 v230, 90112, v230
Lspin:
s_cmp_eq_u32 s77, 0
s_cbranch_scc1 Lspinx
s_cmp_eq_u32 s76, 0
s_cbranch_scc1 Lspinx
s_sub_u32 s76, s76, 1
s_call_b64 s[78:79], Lpoll
s_branch Lspin
Lspinx:
s_cmp_lg_u32 s40, 0
s_cbranch_scc1 Lnofin
v_mov_b32 v252, 16256
Lrrw:
ds_read_b32 v253, v252 offset:8
s_waitcnt lgkmcnt(0)
v_readfirstlane_b32 s43, v253
s_cmp_eq_u32 s76, 0
s_cbranch_scc1 Lrrx
s_sub_u32 s76, s76, 1
s_cmp_lt_u32 s43, 8
s_cbranch_scc0 Lrrx
s_sleep 2
s_branch Lrrw
Lrrx:
ds_write_b32 v228, v162
ds_write_b32 v229, v163
ds_write_b32 v230, v164
Lnofin:
s_waitcnt lgkmcnt(0)
s_barrier
ds_read_b128 v[156:159], v226
ds_read_b128 v[160:163], v226 offset:32
ds_read_b128 v[164:167], v226 offset:64
v_lshrrev_b32 v225, 4, v251
v_and_b32 v227, 15, v251
v_mul_u32_u24 v252, 192, v227
v_lshl_add_u32 v252, v225, 4, v252
v_lshlrev_b32 v254, 5, v225
v_and_b32 v253, 47, v251
v_lshlrev_b32 v253, 4, v253
v_and_b32 v225, 1, v225
v_mul_u32_u24 v227, 3072, v225
v_add_u32 v248, v227, v253
v_add_u32 v249, 65536, v248
v_add_u32 v250, 131072, v248
v_lshl_add_u32 v253, v225, 21, v253
s_waitcnt lgkmcnt(0)
v_pk_mul_f16 v120, v120, v156
v_pk_mul_f16 v121, v121, v157
v_pk_mul_f16 v122, v122, v158
v_pk_mul_f16 v123, v123, v159
ds_write_b128 v224, v[120:123]
v_pk_mul_f16 v124, v124, v156
v_pk_mul_f16 v125, v125, v157
v_pk_mul_f16 v126, v126, v158
v_pk_mul_f16 v127, v127, v159
ds_write_b128 v224, v[124:127] offset:1024
v_pk_mul_f16 v128, v128, v156
v_pk_mul_f16 v129, v129, v157
v_pk_mul_f16 v130, v130, v158
v_pk_mul_f16 v131, v131, v159
ds_write_b128 v224, v[128:131] offset:2048
v_pk_mul_f16 v132, v132, v160
v_pk_mul_f16 v133, v133, v161
v_pk_mul_f16 v134, v134, v162
v_pk_mul_f16 v135, v135, v163
ds_write_b128 v224, v[132:135] offset:3072
v_pk_mul_f16 v136, v136, v160
v_pk_mul_f16 v137, v137, v161
v_pk_mul_f16 v138, v138, v162
v_pk_mul_f16 v139, v139, v163
ds_write_b128 v224, v[136:139] offset:4096
v_pk_mul_f16 v140, v140, v160
v_pk_mul_f16 v141, v141, v161
v_pk_mul_f16 v142, v142, v162
v_pk_mul_f16 v143, v143, v163
ds_write_b128 v224, v[140:143] offset:5120
v_pk_mul_f16 v144, v144, v164
v_pk_mul_f16 v145, v145, v165
v_pk_mul_f16 v146, v146, v166
v_pk_mul_f16 v147, v147, v167
ds_write_b128 v224, v[144:147] offset:6144
v_pk_mul_f16 v148, v148, v164
v_pk_mul_f16 v149, v149, v165
v_pk_mul_f16 v150, v150, v166
v_pk_mul_f16 v151, v151, v167
ds_write_b128 v224, v[148:151] offset:7168
v_pk_mul_f16 v152, v152, v164
v_pk_mul_f16 v153, v153, v165
v_pk_mul_f16 v154, v154, v166
v_pk_mul_f16 v155, v155, v167
ds_write_b128 v224, v[152:155] offset:8192
ds_read_b128 v[120:123], v254 offset:7936
ds_read_b128 v[124:127], v254 offset:7952
ds_read_b128 v[128:131], v254 offset:7936
ds_read_b128 v[132:135], v254 offset:7952
ds_read_b128 v[136:139], v254 offset:8064
ds_read_b128 v[140:143], v254 offset:8080
ds_read_b128 v[144:147], v254 offset:8064
ds_read_b128 v[148:151], v254 offset:8080
ds_read_b128 v[152:155], v254 offset:16128
ds_read_b128 v[156:159], v254 offset:16144
ds_read_b128 v[160:163], v254 offset:16128
ds_read_b128 v[164:167], v254 offset:16144
s_waitcnt lgkmcnt(12)
s_barrier
s_setprio 3
ds_read_b128 v[224:227], v249 offset:24576
ds_read_b128 v[228:231], v249 offset:24832
s_waitcnt lgkmcnt(1)
v_mfma_f32_16x16x32_f16 v[120:123], v[224:227], v[0:3], v[120:123]
v_mfma_f32_16x16x32_f16 v[128:131], v[224:227], v[4:7], v[128:131]
v_permlane16_swap_b32 v16, v20
s_waitcnt lgkmcnt(0)
v_mfma_f32_16x16x32_f16 v[124:127], v[228:231], v[0:3], v[124:127]
ds_read_b128 v[224:227], v249 offset:25600
v_mfma_f32_16x16x32_f16 v[132:135], v[228:231], v[4:7], v[132:135]
v_permlane16_swap_b32 v17, v21
s_waitcnt lgkmcnt(0)
v_mfma_f32_16x16x32_f16 v[136:139], v[224:227], v[0:3], v[136:139]
ds_read_b128 v[228:231], v249 offset:25856
v_mfma_f32_16x16x32_f16 v[144:147], v[224:227], v[4:7], v[144:147]
v_permlane16_swap_b32 v18, v22
s_waitcnt lgkmcnt(0)
v_mfma_f32_16x16x32_f16 v[140:143], v[228:231], v[0:3], v[140:143]
ds_read_b128 v[224:227], v249 offset:26624
v_mfma_f32_16x16x32_f16 v[148:151], v[228:231], v[4:7], v[148:151]
v_permlane16_swap_b32 v19, v23
s_waitcnt lgkmcnt(0)
v_mfma_f32_16x16x32_f16 v[152:155], v[224:227], v[0:3], v[152:155]
ds_read_b128 v[228:231], v249 offset:26880
v_mfma_f32_16x16x32_f16 v[160:163], v[224:227], v[4:7], v[160:163]
v_permlane16_swap_b32 v24, v28
s_waitcnt lgkmcnt(0)
v_mfma_f32_16x16x32_f16 v[156:159], v[228:231], v[0:3], v[156:159]
ds_read_b128 v[224:227], v249 offset:30720
v_mfma_f32_16x16x32_f16 v[164:167], v[228:231], v[4:7], v[164:167]
v_permlane16_swap_b32 v25, v29
s_waitcnt lgkmcnt(0)
v_mfma_f32_16x16x32_f16 v[120:123], v[224:227], v[8:11], v[120:123]
ds_read_b128 v[228:231], v249 offset:30976
ds_read_b128 v[0:3], v249 offset:31744
ds_read_b128 v[4:7], v249 offset:32000
v_mfma_f32_16x16x32_f16 v[128:131], v[224:227], v[12:15], v[128:131]
v_permlane16_swap_b32 v26, v30
s_waitcnt lgkmcnt(2)
v_mfma_f32_16x16x32_f16 v[124:127], v[228:231], v[8:11], v[124:127]
ds_read_b128 v[224:227], v249 offset:32768
v_mfma_f32_16x16x32_f16 v[132:135], v[228:231], v[12:15], v[132:135]
v_permlane16_swap_b32 v27, v31
s_waitcnt lgkmcnt(2)
v_mfma_f32_16x16x32_f16 v[136:139], v[0:3], v[8:11], v[136:139]
ds_read_b128 v[228:231], v249 offset:33024
v_mfma_f32_16x16x32_f16 v[144:147], v[0:3], v[12:15], v[144:147]
v_permlane16_swap_b32 v96, v100
s_waitcnt lgkmcnt(2)
v_mfma_f32_16x16x32_f16 v[140:143], v[4:7], v[8:11], v[140:143]
ds_read_b128 v[0:3], v249 offset:36864
v_mfma_f32_16x16x32_f16 v[148:151], v[4:7], v[12:15], v[148:151]
v_permlane16_swap_b32 v97, v101
s_waitcnt lgkmcnt(2)
v_mfma_f32_16x16x32_f16 v[152:155], v[224:227], v[8:11], v[152:155]
ds_read_b128 v[4:7], v249 offset:37120
v_mfma_f32_16x16x32_f16 v[160:163], v[224:227], v[12:15], v[160:163]
v_permlane16_swap_b32 v98, v102
s_waitcnt lgkmcnt(2)
v_mfma_f32_16x16x32_f16 v[156:159], v[228:231], v[8:11], v[156:159]
ds_read_b128 v[224:227], v249 offset:37888
v_mfma_f32_16x16x32_f16 v[164:167], v[228:231], v[12:15], v[164:167]
v_permlane16_swap_b32 v99, v103
s_waitcnt lgkmcnt(2)
v_mfma_f32_16x16x32_f16 v[120:123], v[0:3], v[16:19], v[120:123]
buffer_load_dwordx4 v[12:15], v252, s[4:7], s71 offen
ds_read_b128 v[228:231], v249 offset:38144
v_mfma_f32_16x16x32_f16 v[128:131], v[0:3], v[20:23], v[128:131]
v_permlane16_swap_b32 v32, v36
s_waitcnt lgkmcnt(2)
v_mfma_f32_16x16x32_f16 v[124:127], v[4:7], v[16:19], v[124:127]
ds_read_b128 v[0:3], v249 offset:38912
v_mfma_f32_16x16x32_f16 v[132:135], v[4:7], v[20:23], v[132:135]
v_permlane16_swap_b32 v33, v37
s_waitcnt lgkmcnt(2)
v_mfma_f32_16x16x32_f16 v[136:139], v[224:227], v[16:19], v[136:139]
ds_read_b128 v[4:7], v249 offset:39168
v_mfma_f32_16x16x32_f16 v[144:147], v[224:227], v[20:23], v[144:147]
v_permlane16_swap_b32 v34, v38
s_waitcnt lgkmcnt(2)
v_mfma_f32_16x16x32_f16 v[140:143], v[228:231], v[16:19], v[140:143]
ds_read_b128 v[224:227], v249 offset:43008
v_mfma_f32_16x16x32_f16 v[148:151], v[228:231], v[20:23], v[148:151]
v_permlane16_swap_b32 v35, v39
s_waitcnt lgkmcnt(2)
v_mfma_f32_16x16x32_f16 v[152:155], v[0:3], v[16:19], v[152:155]
ds_read_b128 v[228:231], v249 offset:43264
v_mfma_f32_16x16x32_f16 v[160:163], v[0:3], v[20:23], v[160:163]
v_permlane16_swap_b32 v40, v44
s_waitcnt lgkmcnt(2)
v_mfma_f32_16x16x32_f16 v[156:159], v[4:7], v[16:19], v[156:159]
ds_read_b128 v[0:3], v249 offset:44032
v_mfma_f32_16x16x32_f16 v[164:167], v[4:7], v[20:23], v[164:167]
v_permlane16_swap_b32 v41, v45
s_waitcnt lgkmcnt(2)
v_mfma_f32_16x16x32_f16 v[120:123], v[224:227], v[24:27], v[120:123]
buffer_load_dwordx4 v[8:11], v252, s[4:7], s71 offen offset:64
ds_read_b128 v[4:7], v249 offset:44288
v_mfma_f32_16x16x32_f16 v[128:131], v[224:227], v[28:31], v[128:131]
v_permlane16_swap_b32 v42, v46
s_waitcnt lgkmcnt(2)
v_mfma_f32_16x16x32_f16 v[124:127], v[228:231], v[24:27], v[124:127]
ds_read_b128 v[224:227], v249 offset:45056
v_mfma_f32_16x16x32_f16 v[132:135], v[228:231], v[28:31], v[132:135]
v_permlane16_swap_b32 v43, v47
s_waitcnt lgkmcnt(2)
v_mfma_f32_16x16x32_f16 v[136:139], v[0:3], v[24:27], v[136:139]
ds_read_b128 v[228:231], v249 offset:45312
v_mfma_f32_16x16x32_f16 v[144:147], v[0:3], v[28:31], v[144:147]
v_permlane16_swap_b32 v104, v108
s_waitcnt lgkmcnt(2)
v_mfma_f32_16x16x32_f16 v[140:143], v[4:7], v[24:27], v[140:143]
ds_read_b128 v[0:3], v249 offset:49152
v_mfma_f32_16x16x32_f16 v[148:151], v[4:7], v[28:31], v[148:151]
v_permlane16_swap_b32 v105, v109
s_waitcnt lgkmcnt(2)
v_mfma_f32_16x16x32_f16 v[152:155], v[224:227], v[24:27], v[152:155]
ds_read_b128 v[4:7], v249 offset:49408
v_mfma_f32_16x16x32_f16 v[160:163], v[224:227], v[28:31], v[160:163]
v_permlane16_swap_b32 v106, v110
s_waitcnt lgkmcnt(2)
v_mfma_f32_16x16x32_f16 v[156:159], v[228:231], v[24:27], v[156:159]
ds_read_b128 v[224:227], v249 offset:50176
v_mfma_f32_16x16x32_f16 v[164:167], v[228:231], v[28:31], v[164:167]
v_permlane16_swap_b32 v107, v111
s_waitcnt lgkmcnt(2)
v_mfma_f32_16x16x32_f16 v[120:123], v[0:3], v[32:35], v[120:123]
buffer_load_dwordx4 v[16:19], v252, s[4:7], s71 offen offset:128
ds_read_b128 v[228:231], v249 offset:50432
v_mfma_f32_16x16x32_f16 v[128:131], v[0:3], v[36:39], v[128:131]
v_permlane16_swap_b32 v48, v52
s_waitcnt lgkmcnt(2)
v_mfma_f32_16x16x32_f16 v[124:127], v[4:7], v[32:35], v[124:127]
ds_read_b128 v[0:3], v249 offset:51200
v_mfma_f32_16x16x32_f16 v[132:135], v[4:7], v[36:39], v[132:135]
v_permlane16_swap_b32 v49, v53
s_waitcnt lgkmcnt(2)
v_mfma_f32_16x16x32_f16 v[136:139], v[224:227], v[32:35], v[136:139]
ds_read_b128 v[4:7], v249 offset:51456
v_permlane16_swap_b32 v50, v54
v_mfma_f32_16x16x32_f16 v[144:147], v[224:227], v[36:39], v[144:147]
s_waitcnt lgkmcnt(2)
v_mfma_f32_16x16x32_f16 v[140:143], v[228:231], v[32:35], v[140:143]
ds_read_b128 v[224:227], v249 offset:55296
v_permlane16_swap_b32 v51, v55
v_mfma_f32_16x16x32_f16 v[148:151], v[228:231], v[36:39], v[148:151]
v_permlane16_swap_b32 v56, v60
s_waitcnt lgkmcnt(2)
v_mfma_f32_16x16x32_f16 v[152:155], v[0:3], v[32:35], v[152:155]
ds_read_b128 v[228:231], v249 offset:55552
v_mfma_f32_16x16x32_f16 v[160:163], v[0:3], v[36:39], v[160:163]
v_permlane16_swap_b32 v57, v61
s_waitcnt lgkmcnt(2)
v_mfma_f32_16x16x32_f16 v[156:159], v[4:7], v[32:35], v[156:159]
ds_read_b128 v[0:3], v249 offset:56320
v_permlane16_swap_b32 v58, v62
v_mfma_f32_16x16x32_f16 v[164:167], v[4:7], v[36:39], v[164:167]
s_waitcnt lgkmcnt(2)
v_mfma_f32_16x16x32_f16 v[120:123], v[224:227], v[40:43], v[120:123]
s_add_u32 s46, s71, 98304
buffer_load_dwordx4 v[20:23], v252, s[4:7], s46 offen
ds_read_b128 v[4:7], v249 offset:56576
v_permlane16_swap_b32 v59, v63
v_mfma_f32_16x16x32_f16 v[128:131], v[224:227], v[44:47], v[128:131]
v_and_b32_e64 v24, 1, v251
v_lshlrev_b32 v24, 4, v24
s_waitcnt lgkmcnt(2)
v_mfma_f32_16x16x32_f16 v[124:127], v[228:231], v[40:43], v[124:127]
ds_read_b128 v[224:227], v249 offset:57344
v_mov_b32 v25, 16256
v_mfma_f32_16x16x32_f16 v[132:135], v[228:231], v[44:47], v[132:135]
v_lshlrev_b32 v24, v24, v25
s_waitcnt lgkmcnt(2)
v_mfma_f32_16x16x32_f16 v[136:139], v[0:3], v[40:43], v[136:139]
ds_read_b128 v[228:231], v249 offset:57600
v_lshrrev_b32_e64 v25, 2, v251
v_mfma_f32_16x16x32_f16 v[144:147], v[0:3], v[44:47], v[144:147]
v_xor_b32_e64 v25, v25, v251
v_and_b32 v25, 12, v25
s_waitcnt lgkmcnt(2)
v_mfma_f32_16x16x32_f16 v[140:143], v[4:7], v[40:43], v[140:143]
ds_read_b128 v[0:3], v249 offset:61440
v_and_b32_e64 v28, 2, v251
v_mfma_f32_16x16x32_f16 v[148:151], v[4:7], v[44:47], v[148:151]
v_or_b32 v25, v25, v28
s_waitcnt lgkmcnt(2)
v_mfma_f32_16x16x32_f16 v[152:155], v[224:227], v[40:43], v[152:155]
ds_read_b128 v[4:7], v249 offset:61696
v_cmp_eq_u32 vcc, 0, v25
s_nop 1
v_cndmask_b32 v26, 0, v24, vcc
v_cmp_eq_u32 vcc, 2, v25
s_nop 1
v_cndmask_b32 v27, 0, v24, vcc
v_mfma_f32_16x16x32_f16 v[160:163], v[224:227], v[44:47], v[160:163]
v_mov_b32 v24, 0
s_waitcnt lgkmcnt(2)
v_mfma_f32_16x16x32_f16 v[156:159], v[228:231], v[40:43], v[156:159]
ds_read_b128 v[224:227], v249 offset:62464
v_mov_b32_e64 v25, 0
v_mfma_f32_16x16x32_f16 v[164:167], v[228:231], v[44:47], v[164:167]
v_mov_b32 v28, 0
v_mov_b32 v29, 0
s_waitcnt lgkmcnt(2)
v_mfma_f32_16x16x32_f16 v[120:123], v[0:3], v[48:51], v[120:123]
s_add_u32 s46, s80, 8388608
buffer_load_dwordx4 v[32:35], v253, s[32:35], s46 offen nt
ds_read_b128 v[228:231], v249 offset:62720
v_mfma_f32_16x16x32_f16 v[128:131], v[0:3], v[52:55], v[128:131]
s_waitcnt lgkmcnt(2)
v_mfma_f32_16x16x32_f16 v[124:127], v[4:7], v[48:51], v[124:127]
ds_read_b128 v[0:3], v249 offset:63488
v_permlane16_swap_b32 v64, v68
v_mfma_f32_16x16x32_f16 v[132:135], v[4:7], v[52:55], v[132:135]
s_waitcnt lgkmcnt(2)
v_mfma_f32_16x16x32_f16 v[136:139], v[224:227], v[48:51], v[136:139]
ds_read_b128 v[4:7], v249 offset:63744
v_permlane16_swap_b32 v65, v69
v_mfma_f32_16x16x32_f16 v[144:147], v[224:227], v[52:55], v[144:147]
s_waitcnt lgkmcnt(2)
v_mfma_f32_16x16x32_f16 v[140:143], v[228:231], v[48:51], v[140:143]
ds_read_b128 v[224:227], v250 offset:2048
v_permlane16_swap_b32 v66, v70
v_mfma_f32_16x16x32_f16 v[148:151], v[228:231], v[52:55], v[148:151]
s_waitcnt lgkmcnt(2)
v_mfma_f32_16x16x32_f16 v[152:155], v[0:3], v[48:51], v[152:155]
ds_read_b128 v[228:231], v250 offset:2304
v_mfma_f32_16x16x32_f16 v[160:163], v[0:3], v[52:55], v[160:163]
v_permlane16_swap_b32 v67, v71
s_waitcnt lgkmcnt(2)
v_mfma_f32_16x16x32_f16 v[156:159], v[4:7], v[48:51], v[156:159]
ds_read_b128 v[0:3], v250 offset:3072
v_mfma_f32_16x16x32_f16 v[164:167], v[4:7], v[52:55], v[164:167]
v_permlane16_swap_b32 v72, v76
s_waitcnt lgkmcnt(2)
v_mfma_f32_16x16x32_f16 v[120:123], v[224:227], v[56:59], v[120:123]
ds_read_b128 v[4:7], v250 offset:3328
v_mfma_f32_16x16x32_f16 v[128:131], v[224:227], v[60:63], v[128:131]
v_permlane16_swap_b32 v73, v77
s_waitcnt lgkmcnt(2)
v_mfma_f32_16x16x32_f16 v[124:127], v[228:231], v[56:59], v[124:127]
s_add_u32 s46, s80, 8388608
buffer_load_dwordx4 v[36:39], v253, s[32:35], s46 offen offset:256 nt
ds_read_b128 v[224:227], v250 offset:4096
v_mfma_f32_16x16x32_f16 v[132:135], v[228:231], v[60:63], v[132:135]
s_waitcnt lgkmcnt(2)
v_mfma_f32_16x16x32_f16 v[136:139], v[0:3], v[56:59], v[136:139]
ds_read_b128 v[228:231], v250 offset:4352
v_permlane16_swap_b32 v74, v78
v_mfma_f32_16x16x32_f16 v[144:147], v[0:3], v[60:63], v[144:147]
s_waitcnt lgkmcnt(2)
v_mfma_f32_16x16x32_f16 v[140:143], v[4:7], v[56:59], v[140:143]
ds_read_b128 v[0:3], v250 offset:8192
v_permlane16_swap_b32 v75, v79
v_mfma_f32_16x16x32_f16 v[148:151], v[4:7], v[60:63], v[148:151]
s_waitcnt lgkmcnt(2)
v_mfma_f32_16x16x32_f16 v[152:155], v[224:227], v[56:59], v[152:155]
ds_read_b128 v[4:7], v250 offset:8448
v_permlane16_swap_b32 v200, v204
v_mfma_f32_16x16x32_f16 v[160:163], v[224:227], v[60:63], v[160:163]
s_waitcnt lgkmcnt(2)
v_mfma_f32_16x16x32_f16 v[156:159], v[228:231], v[56:59], v[156:159]
ds_read_b128 v[224:227], v250 offset:9216
v_mfma_f32_16x16x32_f16 v[164:167], v[228:231], v[60:63], v[164:167]
v_permlane16_swap_b32 v201, v205
s_waitcnt vmcnt(5)
v_mfma_f32_16x16x32_bf16 v[120:123], v[26:29], v[12:15], v[120:123]
ds_read_b128 v[228:231], v250 offset:9472
v_mfma_f32_16x16x32_bf16 v[124:127], v[24:27], v[12:15], v[124:127]
v_permlane16_swap_b32 v202, v206
s_waitcnt vmcnt(4)
v_mfma_f32_16x16x32_bf16 v[136:139], v[26:29], v[8:11], v[136:139]
v_mfma_f32_16x16x32_bf16 v[140:143], v[24:27], v[8:11], v[140:143]
v_permlane16_swap_b32 v203, v207
s_waitcnt lgkmcnt(3)
v_mfma_f32_16x16x32_f16 v[120:123], v[0:3], v[64:67], v[120:123]
s_add_u32 s46, s71, 98304
buffer_load_dwordx4 v[8:11], v252, s[4:7], s46 offen offset:64
v_mfma_f32_16x16x32_f16 v[128:131], v[0:3], v[68:71], v[128:131]
s_waitcnt lgkmcnt(2)
v_mfma_f32_16x16x32_f16 v[124:127], v[4:7], v[64:67], v[124:127]
ds_read_b128 v[0:3], v250 offset:10240
v_permlane16_swap_b32 v80, v84
v_mfma_f32_16x16x32_f16 v[132:135], v[4:7], v[68:71], v[132:135]
s_waitcnt lgkmcnt(2)
v_mfma_f32_16x16x32_f16 v[136:139], v[224:227], v[64:67], v[136:139]
ds_read_b128 v[4:7], v250 offset:10496
v_permlane16_swap_b32 v81, v85
v_mfma_f32_16x16x32_f16 v[144:147], v[224:227], v[68:71], v[144:147]
s_waitcnt lgkmcnt(2)
v_mfma_f32_16x16x32_f16 v[140:143], v[228:231], v[64:67], v[140:143]
ds_read_b128 v[224:227], v250 offset:14336
v_permlane16_swap_b32 v82, v86
v_mfma_f32_16x16x32_f16 v[148:151], v[228:231], v[68:71], v[148:151]
s_waitcnt lgkmcnt(2)
v_mfma_f32_16x16x32_f16 v[152:155], v[0:3], v[64:67], v[152:155]
ds_read_b128 v[228:231], v250 offset:14592
v_mfma_f32_16x16x32_f16 v[160:163], v[0:3], v[68:71], v[160:163]
v_permlane16_swap_b32 v83, v87
s_waitcnt lgkmcnt(2)
v_mfma_f32_16x16x32_f16 v[156:159], v[4:7], v[64:67], v[156:159]
ds_read_b128 v[0:3], v250 offset:15360
v_mfma_f32_16x16x32_f16 v[164:167], v[4:7], v[68:71], v[164:167]
v_permlane16_swap_b32 v168, v172
s_waitcnt lgkmcnt(2)
v_mfma_f32_16x16x32_f16 v[120:123], v[224:227], v[72:75], v[120:123]
ds_read_b128 v[4:7], v250 offset:15616
v_mfma_f32_16x16x32_f16 v[128:131], v[224:227], v[76:79], v[128:131]
v_permlane16_swap_b32 v169, v173
s_waitcnt lgkmcnt(2)
v_mfma_f32_16x16x32_f16 v[124:127], v[228:231], v[72:75], v[124:127]
s_add_u32 s46, s71, 98304
buffer_load_dwordx4 v[12:15], v252, s[4:7], s46 offen offset:128
ds_read_b128 v[224:227], v250 offset:16384
v_mfma_f32_16x16x32_f16 v[132:135], v[228:231], v[76:79], v[132:135]
s_waitcnt lgkmcnt(2)
v_mfma_f32_16x16x32_f16 v[136:139], v[0:3], v[72:75], v[136:139]
ds_read_b128 v[228:231], v250 offset:16640
v_permlane16_swap_b32 v170, v174
v_mfma_f32_16x16x32_f16 v[144:147], v[0:3], v[76:79], v[144:147]
s_waitcnt lgkmcnt(2)
v_mfma_f32_16x16x32_f16 v[140:143], v[4:7], v[72:75], v[140:143]
ds_read_b128 v[0:3], v250 offset:20480
v_permlane16_swap_b32 v171, v175
v_mfma_f32_16x16x32_f16 v[148:151], v[4:7], v[76:79], v[148:151]
s_waitcnt lgkmcnt(2)
v_mfma_f32_16x16x32_f16 v[152:155], v[224:227], v[72:75], v[152:155]
ds_read_b128 v[4:7], v250 offset:20736
v_permlane16_swap_b32 v192, v196
v_mfma_f32_16x16x32_f16 v[160:163], v[224:227], v[76:79], v[160:163]
s_waitcnt lgkmcnt(2)
v_mfma_f32_16x16x32_f16 v[156:159], v[228:231], v[72:75], v[156:159]
ds_read_b128 v[224:227], v250 offset:21504
v_mfma_f32_16x16x32_f16 v[164:167], v[228:231], v[76:79], v[164:167]
v_permlane16_swap_b32 v193, v197
s_waitcnt vmcnt(5)
v_mfma_f32_16x16x32_bf16 v[152:155], v[26:29], v[16:19], v[152:155]
ds_read_b128 v[228:231], v250 offset:21760
v_mfma_f32_16x16x32_bf16 v[156:159], v[24:27], v[16:19], v[156:159]
v_permlane16_swap_b32 v194, v198
s_waitcnt vmcnt(4)
v_mfma_f32_16x16x32_bf16 v[128:131], v[26:29], v[20:23], v[128:131]
v_mfma_f32_16x16x32_bf16 v[132:135], v[24:27], v[20:23], v[132:135]
v_permlane16_swap_b32 v195, v199
v_and_b32 v255, 1, v251
v_lshlrev_b32 v255, 7, v255
v_sub_u32 v255, v252, v255
s_mov_b32 s74, 1431655765
s_mov_b32 s75, 1431655765
s_waitcnt lgkmcnt(3)
v_mfma_f32_16x16x32_f16 v[120:123], v[0:3], v[80:83], v[120:123]
buffer_load_dwordx4 v[20:23], v252, s[4:7], s70 offen
v_mfma_f32_16x16x32_f16 v[128:131], v[0:3], v[84:87], v[128:131]
v_permlane16_swap_b32 v176, v180
s_waitcnt lgkmcnt(2)
v_mfma_f32_16x16x32_f16 v[124:127], v[4:7], v[80:83], v[124:127]
ds_read_b128 v[0:3], v250 offset:22528
v_mfma_f32_16x16x32_f16 v[132:135], v[4:7], v[84:87], v[132:135]
v_permlane16_swap_b32 v177, v181
s_waitcnt lgkmcnt(2)
v_mfma_f32_16x16x32_f16 v[136:139], v[224:227], v[80:83], v[136:139]
ds_read_b128 v[4:7], v250 offset:22784
v_mfma_f32_16x16x32_f16 v[144:147], v[224:227], v[84:87], v[144:147]
v_permlane16_swap_b32 v178, v182
s_waitcnt lgkmcnt(2)
v_mfma_f32_16x16x32_f16 v[140:143], v[228:231], v[80:83], v[140:143]
ds_read_b128 v[224:227], v250 offset:26624
v_mfma_f32_16x16x32_f16 v[148:151], v[228:231], v[84:87], v[148:151]
v_permlane16_swap_b32 v179, v183
s_waitcnt lgkmcnt(2)
v_mfma_f32_16x16x32_f16 v[152:155], v[0:3], v[80:83], v[152:155]
ds_read_b128 v[228:231], v250 offset:26880
v_mfma_f32_16x16x32_f16 v[160:163], v[0:3], v[84:87], v[160:163]
v_permlane16_swap_b32 v184, v188
s_waitcnt lgkmcnt(2)
v_mfma_f32_16x16x32_f16 v[156:159], v[4:7], v[80:83], v[156:159]
ds_read_b128 v[0:3], v250 offset:27648
v_mfma_f32_16x16x32_f16 v[164:167], v[4:7], v[84:87], v[164:167]
v_permlane16_swap_b32 v185, v189
s_waitcnt lgkmcnt(2)
v_mfma_f32_16x16x32_f16 v[120:123], v[224:227], v[168:171], v[120:123]
buffer_load_dwordx4 v[16:19], v252, s[4:7], s70 offen offset:64
ds_read_b128 v[4:7], v250 offset:27904
v_mfma_f32_16x16x32_f16 v[128:131], v[224:227], v[172:175], v[128:131]
v_permlane16_swap_b32 v186, v190
s_waitcnt lgkmcnt(2)
v_mfma_f32_16x16x32_f16 v[124:127], v[228:231], v[168:171], v[124:127]
ds_read_b128 v[224:227], v250 offset:28672
v_mfma_f32_16x16x32_f16 v[132:135], v[228:231], v[172:175], v[132:135]
v_permlane16_swap_b32 v187, v191
s_waitcnt lgkmcnt(2)
v_mfma_f32_16x16x32_f16 v[136:139], v[0:3], v[168:171], v[136:139]
ds_read_b128 v[228:231], v250 offset:28928
v_mfma_f32_16x16x32_f16 v[144:147], v[0:3], v[172:175], v[144:147]
v_permlane16_swap_b32 v112, v116
s_waitcnt lgkmcnt(2)
v_mfma_f32_16x16x32_f16 v[140:143], v[4:7], v[168:171], v[140:143]
ds_read_b128 v[0:3], v249 offset:55296
v_mfma_f32_16x16x32_f16 v[148:151], v[4:7], v[172:175], v[148:151]
v_permlane16_swap_b32 v113, v117
s_waitcnt lgkmcnt(2)
v_mfma_f32_16x16x32_f16 v[152:155], v[224:227], v[168:171], v[152:155]
ds_read_b128 v[4:7], v254 offset:7936
v_mfma_f32_16x16x32_f16 v[160:163], v[224:227], v[172:175], v[160:163]
v_permlane16_swap_b32 v114, v118
s_waitcnt lgkmcnt(2)
v_mfma_f32_16x16x32_f16 v[156:159], v[228:231], v[168:171], v[156:159]
ds_read_b128 v[224:227], v249 offset:55552
v_mfma_f32_16x16x32_f16 v[164:167], v[228:231], v[172:175], v[164:167]
v_permlane16_swap_b32 v115, v119
s_waitcnt lgkmcnt(1)
v_mfma_f32_16x16x32_f16 v[48:51], v[0:3], v[176:179], v[4:7]
ds_read_b128 v[228:231], v254 offset:7952
v_mfma_f32_16x16x32_f16 v[56:59], v[0:3], v[180:183], v[4:7]
s_waitcnt lgkmcnt(0)
v_mfma_f32_16x16x32_f16 v[52:55], v[224:227], v[176:179], v[228:231]
ds_read_b128 v[0:3], v249 offset:56320
ds_read_b128 v[4:7], v254 offset:8064
v_mfma_f32_16x16x32_f16 v[60:63], v[224:227], v[180:183], v[228:231]
s_waitcnt lgkmcnt(0)
v_mfma_f32_16x16x32_f16 v[64:67], v[0:3], v[176:179], v[4:7]
ds_read_b128 v[224:227], v249 offset:56576
ds_read_b128 v[228:231], v254 offset:8080
v_mfma_f32_16x16x32_f16 v[72:75], v[0:3], v[180:183], v[4:7]
v_permlane16_swap_b32 v88, v92
s_waitcnt lgkmcnt(0)
v_mfma_f32_16x16x32_f16 v[68:71], v[224:227], v[176:179], v[228:231]
ds_read_b128 v[0:3], v249 offset:57344
ds_read_b128 v[4:7], v254 offset:16128
v_mfma_f32_16x16x32_f16 v[76:79], v[224:227], v[180:183], v[228:231]
v_permlane16_swap_b32 v89, v93
s_waitcnt lgkmcnt(0)
v_mfma_f32_16x16x32_f16 v[80:83], v[0:3], v[176:179], v[4:7]
ds_read_b128 v[224:227], v249 offset:57600
ds_read_b128 v[228:231], v254 offset:16144
v_permlane16_swap_b32 v90, v94
v_mfma_f32_16x16x32_f16 v[168:171], v[0:3], v[180:183], v[4:7]
s_waitcnt lgkmcnt(0)
v_mfma_f32_16x16x32_f16 v[84:87], v[224:227], v[176:179], v[228:231]
ds_read_b128 v[0:3], v249 offset:61440
ds_read_b128 v[4:7], v249 offset:61696
v_permlane16_swap_b32 v91, v95
v_mfma_f32_16x16x32_f16 v[172:175], v[224:227], v[180:183], v[228:231]
v_cvt_pk_bf16_f32 v136, v136, v137
v_cvt_pk_bf16_f32 v137, v138, v139
s_waitcnt lgkmcnt(1)
v_mfma_f32_16x16x32_f16 v[48:51], v[0:3], v[184:187], v[48:51]
ds_read_b128 v[224:227], v249 offset:62464
ds_read_b128 v[228:231], v249 offset:62720
v_cvt_pk_bf16_f32 v138, v140, v141
v_mfma_f32_16x16x32_f16 v[56:59], v[0:3], v[188:191], v[56:59]
v_cvt_pk_bf16_f32 v139, v142, v143
v_cvt_pk_bf16_f32 v120, v120, v121
s_waitcnt lgkmcnt(2)
v_mfma_f32_16x16x32_f16 v[52:55], v[4:7], v[184:187], v[52:55]
ds_read_b128 v[0:3], v249 offset:63488
v_cvt_pk_bf16_f32 v121, v122, v123
v_mfma_f32_16x16x32_f16 v[60:63], v[4:7], v[188:191], v[60:63]
v_cvt_pk_bf16_f32 v122, v124, v125
s_waitcnt lgkmcnt(2)
v_mfma_f32_16x16x32_f16 v[64:67], v[224:227], v[184:187], v[64:67]
ds_read_b128 v[4:7], v249 offset:63744
v_cvt_pk_bf16_f32 v123, v126, v127
v_cvt_pk_bf16_f32 v152, v152, v153
v_mfma_f32_16x16x32_f16 v[72:75], v[224:227], v[188:191], v[72:75]
v_cvt_pk_bf16_f32 v153, v154, v155
s_waitcnt lgkmcnt(2)
v_mfma_f32_16x16x32_f16 v[68:71], v[228:231], v[184:187], v[68:71]
ds_read_b128 v[224:227], v250 offset:2048
v_cvt_pk_bf16_f32 v154, v156, v157
v_mfma_f32_16x16x32_f16 v[76:79], v[228:231], v[188:191], v[76:79]
v_cvt_pk_bf16_f32 v155, v158, v159
s_mov_b64 vcc, s[74:75]
v_cndmask_b32_e64 v140, v120, v152, s[74:75]
s_waitcnt lgkmcnt(2)
v_mfma_f32_16x16x32_f16 v[80:83], v[0:3], v[184:187], v[80:83]
ds_read_b128 v[228:231], v250 offset:2304
v_cndmask_b32_dpp v120, v136, v120, vcc quad_perm:[1,0,3,2] row_mask:0xf bank_mask:0xf
v_mfma_f32_16x16x32_f16 v[168:171], v[0:3], v[188:191], v[168:171]
v_cndmask_b32_e64 v141, v121, v153, s[74:75]
s_waitcnt lgkmcnt(2)
v_mfma_f32_16x16x32_f16 v[84:87], v[4:7], v[184:187], v[84:87]
ds_read_b128 v[0:3], v248 offset:16384
v_cndmask_b32_dpp v121, v137, v121, vcc quad_perm:[1,0,3,2] row_mask:0xf bank_mask:0xf
v_cndmask_b32_e64 v142, v122, v154, s[74:75]
v_mfma_f32_16x16x32_f16 v[172:175], v[4:7], v[188:191], v[172:175]
v_cndmask_b32_dpp v122, v138, v122, vcc quad_perm:[1,0,3,2] row_mask:0xf bank_mask:0xf
s_waitcnt vmcnt(3)
v_mfma_f32_16x16x32_bf16 v[144:147], v[26:29], v[8:11], v[144:147]
ds_read_b128 v[4:7], v250 offset:3072
v_cndmask_b32_e64 v143, v123, v155, s[74:75]
v_mfma_f32_16x16x32_bf16 v[148:151], v[24:27], v[8:11], v[148:151]
v_cndmask_b32_dpp v123, v139, v123, vcc quad_perm:[1,0,3,2] row_mask:0xf bank_mask:0xf
s_not_b64 vcc, s[74:75]
v_cndmask_b32_dpp v152, v136, v152, vcc quad_perm:[1,0,3,2] row_mask:0xf bank_mask:0xf
s_waitcnt vmcnt(2)
v_mfma_f32_16x16x32_bf16 v[160:163], v[26:29], v[12:15], v[160:163]
v_cndmask_b32_dpp v153, v137, v153, vcc quad_perm:[1,0,3,2] row_mask:0xf bank_mask:0xf
v_mfma_f32_16x16x32_bf16 v[164:167], v[24:27], v[12:15], v[164:167]
v_cndmask_b32_dpp v154, v138, v154, vcc quad_perm:[1,0,3,2] row_mask:0xf bank_mask:0xf
v_cndmask_b32_dpp v155, v139, v155, vcc quad_perm:[1,0,3,2] row_mask:0xf bank_mask:0xf
s_waitcnt lgkmcnt(2)
v_mfma_f32_16x16x32_f16 v[48:51], v[224:227], v[192:195], v[48:51]
buffer_load_dwordx4 v[8:11], v252, s[4:7], s70 offen offset:128
buffer_store_dwordx4 v[120:123], v255, s[8:11], s71 offen sc1
v_mfma_f32_16x16x32_f16 v[56:59], v[224:227], v[196:199], v[56:59]
v_mfma_f32_16x16x32_f16 v[52:55], v[228:231], v[192:195], v[52:55]
ds_read_b128 v[224:227], v250 offset:3328
v_permlane16_swap_b32 v240, v244
v_mfma_f32_16x16x32_f16 v[60:63], v[228:231], v[196:199], v[60:63]
s_waitcnt lgkmcnt(2)
v_mfma_f32_16x16x32_bf16 v[176:179], v[0:3], v[96:99], 0
ds_read_b128 v[228:231], v250 offset:4096
v_permlane16_swap_b32 v241, v245
v_mfma_f32_16x16x32_bf16 v[184:187], v[0:3], v[100:103], 0
s_waitcnt lgkmcnt(2)
v_mfma_f32_16x16x32_f16 v[64:67], v[4:7], v[192:195], v[64:67]
ds_read_b128 v[0:3], v250 offset:4352
v_mfma_f32_16x16x32_f16 v[72:75], v[4:7], v[196:199], v[72:75]
v_permlane16_swap_b32 v242, v246
s_waitcnt lgkmcnt(2)
v_mfma_f32_16x16x32_f16 v[68:71], v[224:227], v[192:195], v[68:71]
ds_read_b128 v[4:7], v248 offset:16640
v_mfma_f32_16x16x32_f16 v[76:79], v[224:227], v[196:199], v[76:79]
v_permlane16_swap_b32 v243, v247
s_waitcnt lgkmcnt(2)
v_mfma_f32_16x16x32_f16 v[80:83], v[228:231], v[192:195], v[80:83]
s_add_u32 s46, s70, 98304
buffer_load_dwordx4 v[12:15], v252, s[4:7], s46 offen
ds_read_b128 v[224:227], v250 offset:8192
v_mfma_f32_16x16x32_f16 v[168:171], v[228:231], v[196:199], v[168:171]
s_waitcnt lgkmcnt(2)
v_mfma_f32_16x16x32_f16 v[84:87], v[0:3], v[192:195], v[84:87]
ds_read_b128 v[228:231], v250 offset:8448
v_permlane16_swap_b32 v232, v236
v_mfma_f32_16x16x32_f16 v[172:175], v[0:3], v[196:199], v[172:175]
s_waitcnt lgkmcnt(2)
v_mfma_f32_16x16x32_bf16 v[180:183], v[4:7], v[96:99], 0
ds_read_b128 v[0:3], v250 offset:9216
v_permlane16_swap_b32 v233, v237
v_mfma_f32_16x16x32_bf16 v[188:191], v[4:7], v[100:103], 0
s_waitcnt lgkmcnt(2)
v_mfma_f32_16x16x32_f16 v[48:51], v[224:227], v[200:203], v[48:51]
ds_read_b128 v[4:7], v250 offset:9472
v_mfma_f32_16x16x32_f16 v[56:59], v[224:227], v[204:207], v[56:59]
v_permlane16_swap_b32 v234, v238
s_waitcnt lgkmcnt(2)
v_mfma_f32_16x16x32_f16 v[52:55], v[228:231], v[200:203], v[52:55]
ds_read_b128 v[224:227], v248 offset:17408
v_mfma_f32_16x16x32_f16 v[60:63], v[228:231], v[204:207], v[60:63]
v_permlane16_swap_b32 v235, v239
s_waitcnt lgkmcnt(2)
v_mfma_f32_16x16x32_f16 v[64:67], v[0:3], v[200:203], v[64:67]
buffer_store_dwordx4 v[140:143], v255, s[8:11], s71 offen offset:128 sc1
ds_read_b128 v[228:231], v250 offset:10240
v_mfma_f32_16x16x32_f16 v[72:75], v[0:3], v[204:207], v[72:75]
s_waitcnt lgkmcnt(2)
v_mfma_f32_16x16x32_f16 v[68:71], v[4:7], v[200:203], v[68:71]
ds_read_b128 v[0:3], v250 offset:10496
v_permlane16_swap_b32 v216, v220
v_mfma_f32_16x16x32_f16 v[76:79], v[4:7], v[204:207], v[76:79]
s_waitcnt lgkmcnt(2)
v_mfma_f32_16x16x32_bf16 v[176:179], v[224:227], v[104:107], v[176:179]
ds_read_b128 v[4:7], v250 offset:14336
v_permlane16_swap_b32 v217, v221
v_mfma_f32_16x16x32_bf16 v[184:187], v[224:227], v[108:111], v[184:187]
s_waitcnt lgkmcnt(2)
v_mfma_f32_16x16x32_f16 v[80:83], v[228:231], v[200:203], v[80:83]
ds_read_b128 v[224:227], v250 offset:14592
v_mfma_f32_16x16x32_f16 v[168:171], v[228:231], v[204:207], v[168:171]
v_permlane16_swap_b32 v218, v222
s_waitcnt lgkmcnt(2)
v_mfma_f32_16x16x32_f16 v[84:87], v[0:3], v[200:203], v[84:87]
ds_read_b128 v[228:231], v248 offset:17664
v_mfma_f32_16x16x32_f16 v[172:175], v[0:3], v[204:207], v[172:175]
v_permlane16_swap_b32 v219, v223
s_waitcnt lgkmcnt(2)
v_mfma_f32_16x16x32_f16 v[48:51], v[4:7], v[240:243], v[48:51]
buffer_store_dwordx4 v[152:155], v255, s[8:11], s71 offen offset:256 sc1
ds_read_b128 v[0:3], v250 offset:15360
v_mfma_f32_16x16x32_f16 v[56:59], v[4:7], v[244:247], v[56:59]
s_waitcnt lgkmcnt(2)
v_mfma_f32_16x16x32_f16 v[52:55], v[224:227], v[240:243], v[52:55]
ds_read_b128 v[4:7], v250 offset:15616
v_mfma_f32_16x16x32_f16 v[60:63], v[224:227], v[244:247], v[60:63]
s_waitcnt lgkmcnt(2)
v_mfma_f32_16x16x32_bf16 v[180:183], v[228:231], v[104:107], v[180:183]
ds_read_b128 v[224:227], v250 offset:16384
v_mfma_f32_16x16x32_bf16 v[188:191], v[228:231], v[108:111], v[188:191]
s_waitcnt lgkmcnt(2)
v_mfma_f32_16x16x32_f16 v[64:67], v[0:3], v[240:243], v[64:67]
ds_read_b128 v[228:231], v250 offset:16640
v_mfma_f32_16x16x32_f16 v[72:75], v[0:3], v[244:247], v[72:75]
s_waitcnt lgkmcnt(2)
v_mfma_f32_16x16x32_f16 v[68:71], v[4:7], v[240:243], v[68:71]
ds_read_b128 v[0:3], v248 offset:18432
v_mfma_f32_16x16x32_f16 v[76:79], v[4:7], v[244:247], v[76:79]
s_waitcnt lgkmcnt(2)
v_mfma_f32_16x16x32_f16 v[80:83], v[224:227], v[240:243], v[80:83]
ds_read_b128 v[4:7], v250 offset:20480
v_permlane16_swap_b32 v208, v212
v_mfma_f32_16x16x32_f16 v[168:171], v[224:227], v[244:247], v[168:171]
s_waitcnt lgkmcnt(2)
v_mfma_f32_16x16x32_f16 v[84:87], v[228:231], v[240:243], v[84:87]
ds_read_b128 v[224:227], v250 offset:20736
v_mfma_f32_16x16x32_f16 v[172:175], v[228:231], v[244:247], v[172:175]
s_waitcnt lgkmcnt(2)
v_mfma_f32_16x16x32_bf16 v[176:179], v[0:3], v[112:115], v[176:179]
ds_read_b128 v[228:231], v250 offset:21504
v_mfma_f32_16x16x32_bf16 v[184:187], v[0:3], v[116:119], v[184:187]
s_waitcnt lgkmcnt(2)
v_mfma_f32_16x16x32_f16 v[48:51], v[4:7], v[232:235], v[48:51]
ds_read_b128 v[0:3], v250 offset:21760
v_mfma_f32_16x16x32_f16 v[56:59], v[4:7], v[236:239], v[56:59]
s_waitcnt lgkmcnt(2)
v_mfma_f32_16x16x32_f16 v[52:55], v[224:227], v[232:235], v[52:55]
ds_read_b128 v[4:7], v248 offset:18688
v_mfma_f32_16x16x32_f16 v[60:63], v[224:227], v[236:239], v[60:63]
s_waitcnt lgkmcnt(2)
v_mfma_f32_16x16x32_f16 v[64:67], v[228:231], v[232:235], v[64:67]
ds_read_b128 v[224:227], v250 offset:22528
v_mfma_f32_16x16x32_f16 v[72:75], v[228:231], v[236:239], v[72:75]
v_permlane16_swap_b32 v209, v213
s_waitcnt lgkmcnt(2)
v_mfma_f32_16x16x32_f16 v[68:71], v[0:3], v[232:235], v[68:71]
ds_read_b128 v[228:231], v250 offset:22784
v_mfma_f32_16x16x32_f16 v[76:79], v[0:3], v[236:239], v[76:79]
s_waitcnt lgkmcnt(2)
v_mfma_f32_16x16x32_bf16 v[180:183], v[4:7], v[112:115], v[180:183]
ds_read_b128 v[0:3], v250 offset:26624
v_mfma_f32_16x16x32_bf16 v[188:191], v[4:7], v[116:119], v[188:191]
s_waitcnt lgkmcnt(2)
v_mfma_f32_16x16x32_f16 v[80:83], v[224:227], v[232:235], v[80:83]
ds_read_b128 v[4:7], v250 offset:26880
v_mfma_f32_16x16x32_f16 v[168:171], v[224:227], v[236:239], v[168:171]
s_waitcnt lgkmcnt(2)
v_mfma_f32_16x16x32_f16 v[84:87], v[228:231], v[232:235], v[84:87]
ds_read_b128 v[224:227], v250 offset:27648
v_mfma_f32_16x16x32_f16 v[172:175], v[228:231], v[236:239], v[172:175]
s_waitcnt lgkmcnt(2)
v_mfma_f32_16x16x32_f16 v[48:51], v[0:3], v[216:219], v[48:51]
ds_read_b128 v[228:231], v250 offset:27904
v_mfma_f32_16x16x32_f16 v[56:59], v[0:3], v[220:223], v[56:59]
v_permlane16_swap_b32 v210, v214
s_waitcnt lgkmcnt(2)
v_mfma_f32_16x16x32_f16 v[52:55], v[4:7], v[216:219], v[52:55]
ds_read_b128 v[0:3], v250 offset:28672
v_mfma_f32_16x16x32_f16 v[60:63], v[4:7], v[220:223], v[60:63]
s_waitcnt lgkmcnt(2)
v_mfma_f32_16x16x32_f16 v[64:67], v[224:227], v[216:219], v[64:67]
ds_read_b128 v[4:7], v250 offset:28928
v_mfma_f32_16x16x32_f16 v[72:75], v[224:227], v[220:223], v[72:75]
s_waitcnt lgkmcnt(2)
v_mfma_f32_16x16x32_f16 v[68:71], v[228:231], v[216:219], v[68:71]
ds_read_b128 v[224:227], v248 offset:22528
v_mfma_f32_16x16x32_f16 v[76:79], v[228:231], v[220:223], v[76:79]
s_waitcnt lgkmcnt(2)
v_mfma_f32_16x16x32_f16 v[80:83], v[0:3], v[216:219], v[80:83]
ds_read_b128 v[228:231], v248 offset:22784
v_mfma_f32_16x16x32_f16 v[168:171], v[0:3], v[220:223], v[168:171]
s_waitcnt lgkmcnt(2)
v_mfma_f32_16x16x32_f16 v[84:87], v[4:7], v[216:219], v[84:87]
ds_read_b128 v[0:3], v248 offset:23552
v_mfma_f32_16x16x32_f16 v[172:175], v[4:7], v[220:223], v[172:175]
v_permlane16_swap_b32 v211, v215
s_setprio 3
v_cvt_pkrtz_f16_f32 v193, v176, v177
v_cvt_pkrtz_f16_f32 v195, v178, v179
v_cvt_pkrtz_f16_f32 v197, v180, v181
v_cvt_pkrtz_f16_f32 v199, v182, v183
v_cvt_pkrtz_f16_f32 v201, v184, v185
v_cvt_pkrtz_f16_f32 v203, v186, v187
v_cvt_pk_f16_f32 v243, v188, v189
v_cvt_pk_f16_f32 v240, v190, v191
s_waitcnt lgkmcnt(2)
v_mfma_f32_16x16x32_bf16 v[176:179], v[224:227], v[96:99], 0
s_add_u32 s46, s70, 98304
buffer_load_dwordx4 v[216:219], v252, s[4:7], s46 offen offset:64
ds_read_b128 v[4:7], v248 offset:23808
v_mfma_f32_16x16x32_bf16 v[184:187], v[224:227], v[100:103], 0
v_pk_fma_f16 v242, v243, v243, s48
v_cvt_pk_bf16_f32 v144, v144, v145
v_and_b32 v193, s49, v193
v_cvt_pk_bf16_f32 v145, v146, v147
s_waitcnt lgkmcnt(2)
v_mfma_f32_16x16x32_bf16 v[180:183], v[228:231], v[96:99], 0
ds_read_b128 v[224:227], v248 offset:24576
v_and_b32_e64 v195, s49, v195
v_cvt_pk_bf16_f32 v146, v148, v149
v_pk_fma_f16 v207, v240, v240, s48
v_bfe_u32 v192, v193, 2, 14
v_cvt_pk_bf16_f32 v147, v150, v151
v_pk_mul_f16 v242, v243, v242
v_mfma_f32_16x16x32_bf16 v[188:191], v[228:231], v[100:103], 0
v_cvt_pk_bf16_f32 v128, v128, v129
v_bfe_u32 v194, v195, 2, 14
v_pk_mul_f16 v207, v240, v207
v_cvt_pk_bf16_f32 v129, v130, v131
v_lshrrev_b32 v193, 18, v193
v_cvt_pk_bf16_f32 v130, v132, v133
s_waitcnt lgkmcnt(2)
v_mfma_f32_16x16x32_bf16 v[176:179], v[0:3], v[104:107], v[176:179]
ds_read_b128 v[228:231], v248 offset:24832
ds_read_u16_d16 v192, v192
ds_read_u16_d16 v194, v194
ds_read_u16_d16_hi v193, v193
v_exp_f16_e64 v241, v242
v_cvt_pk_bf16_f32 v131, v134, v135
v_lshrrev_b32_e64 v195, 18, v195
v_cvt_pk_bf16_f32 v160, v160, v161
v_and_b32_e64 v197, s49, v197
v_mfma_f32_16x16x32_bf16 v[184:187], v[0:3], v[108:111], v[184:187]
v_cvt_pk_bf16_f32 v161, v162, v163
v_exp_f16_e64 v206, v207
v_cvt_pk_bf16_f32 v162, v164, v165
v_and_b32_e64 v199, s49, v199
v_cvt_pk_bf16_f32 v163, v166, v167
s_mov_b64 vcc, s[74:75]
s_waitcnt lgkmcnt(4)
v_mfma_f32_16x16x32_bf16 v[180:183], v[4:7], v[104:107], v[180:183]
s_add_u32 s46, s70, 98304
buffer_load_dwordx4 v[244:247], v252, s[4:7], s46 offen offset:128
ds_read_u16_d16_hi v195, v195
v_bfe_u32 v196, v197, 2, 14
v_exp_f16_sdwa v241, v242 dst_sel:WORD_1 dst_unused:UNUSED_PRESERVE src0_sel:WORD_1
v_cndmask_b32_e64 v148, v128, v160, s[74:75]
v_cndmask_b32_dpp v128, v144, v128, vcc quad_perm:[1,0,3,2] row_mask:0xf bank_mask:0xf
v_bfe_u32 v198, v199, 2, 14
v_mfma_f32_16x16x32_bf16 v[188:191], v[4:7], v[108:111], v[188:191]
v_cndmask_b32_e64 v149, v129, v161, s[74:75]
v_lshrrev_b32 v197, 18, v197
v_lshrrev_b32 v199, 18, v199
v_cndmask_b32_dpp v129, v145, v129, vcc quad_perm:[1,0,3,2] row_mask:0xf bank_mask:0xf
v_exp_f16_sdwa v206, v207 dst_sel:WORD_1 dst_unused:UNUSED_PRESERVE src0_sel:WORD_1
v_mfma_f32_16x16x32_bf16 v[176:179], v[224:227], v[112:115], v[176:179]
ds_read_u16_d16 v196, v196
ds_read_u16_d16 v198, v198
ds_read_u16_d16_hi v197, v197
ds_read_u16_d16_hi v199, v199
v_cndmask_b32_e64 v150, v130, v162, s[74:75]
v_and_b32_e64 v201, s49, v201
v_cndmask_b32_dpp v130, v146, v130, vcc quad_perm:[1,0,3,2] row_mask:0xf bank_mask:0xf
v_and_b32_e64 v203, s49, v203
v_cndmask_b32_e64 v151, v131, v163, s[74:75]
v_pk_add_f16 v241, v241, 1.0 op_sel_hi:[1,0]
v_mfma_f32_16x16x32_bf16 v[184:187], v[224:227], v[116:119], v[184:187]
v_cndmask_b32_dpp v131, v147, v131, vcc quad_perm:[1,0,3,2] row_mask:0xf bank_mask:0xf
s_not_b64 vcc, s[74:75]
v_bfe_u32 v200, v201, 2, 14
v_pk_add_f16 v206, v206, 1.0 op_sel_hi:[1,0]
v_cndmask_b32_dpp v160, v144, v160, vcc quad_perm:[1,0,3,2] row_mask:0xf bank_mask:0xf
v_bfe_u32 v202, v203, 2, 14
v_cndmask_b32_dpp v161, v145, v161, vcc quad_perm:[1,0,3,2] row_mask:0xf bank_mask:0xf
s_waitcnt lgkmcnt(4)
v_mfma_f32_16x16x32_bf16 v[180:183], v[228:231], v[112:115], v[180:183]
ds_read_b128 v[224:227], v249 offset:24576
ds_read_u16_d16 v200, v200
ds_read_u16_d16 v202, v202
v_rcp_f16_e64 v242, v241
v_cndmask_b32_dpp v162, v146, v162, vcc quad_perm:[1,0,3,2] row_mask:0xf bank_mask:0xf
v_lshrrev_b32_e64 v201, 18, v201
v_cndmask_b32_dpp v163, v147, v163, vcc quad_perm:[1,0,3,2] row_mask:0xf bank_mask:0xf
v_lshrrev_b32_e64 v203, 18, v203
v_mfma_f32_16x16x32_bf16 v[188:191], v[228:231], v[116:119], v[188:191]
v_rcp_f16_e64 v207, v206
v_rcp_f16_sdwa v242, v241 dst_sel:WORD_1 dst_unused:UNUSED_PRESERVE src0_sel:WORD_1
v_or_b32 v232, v192, v193
v_or_b32 v233, v194, v195
s_waitcnt lgkmcnt(3)
v_or_b32 v234, v196, v197
v_rcp_f16_sdwa v207, v206 dst_sel:WORD_1 dst_unused:UNUSED_PRESERVE src0_sel:WORD_1
v_or_b32_e64 v235, v198, v199
ds_read_u16_d16_hi v201, v201
s_add_u32 s46, s71, 98304
buffer_store_dwordx4 v[128:131], v255, s[8:11], s46 offen sc1
ds_read_u16_d16_hi v203, v203
s_waitcnt lgkmcnt(1)
v_or_b32 v236, v200, v201
s_waitcnt lgkmcnt(0)
v_or_b32 v237, v202, v203
v_pk_mul_f16 v238, v243, v242
v_pk_mul_f16 v239, v240, v207
v_mfma_f32_16x16x32_f16 v[48:51], v[224:227], v[232:235], v[48:51]
s_add_u32 s46, s71, 98304
buffer_store_dwordx4 v[148:151], v255, s[8:11], s46 offen offset:128 sc1
ds_read_b128 v[228:231], v249 offset:24832
ds_read_b128 v[0:3], v248 offset:28672
ds_read_b128 v[4:7], v249 offset:25600
ds_read_b128 v[40:43], v248 offset:28928
ds_read_b128 v[44:47], v249 offset:25856
v_cvt_pkrtz_f16_f32 v193, v176, v177
v_cvt_pkrtz_f16_f32 v195, v178, v179
v_mfma_f32_16x16x32_f16 v[56:59], v[224:227], v[236:239], v[56:59]
v_cvt_pkrtz_f16_f32 v197, v180, v181
v_cvt_pkrtz_f16_f32 v199, v182, v183
s_waitcnt lgkmcnt(4)
v_mfma_f32_16x16x32_f16 v[52:55], v[228:231], v[232:235], v[52:55]
ds_read_b128 v[224:227], v248 offset:29696
v_cvt_pkrtz_f16_f32 v201, v184, v185
v_cvt_pk_f16_f32 v243, v186, v187
v_cvt_pk_f16_f32 v240, v188, v189
v_mfma_f32_16x16x32_f16 v[60:63], v[228:231], v[236:239], v[60:63]
v_cvt_pk_f16_f32 v205, v190, v191
v_pk_fma_f16 v242, v243, v243, s48
s_waitcnt lgkmcnt(4)
v_mfma_f32_16x16x32_bf16 v[176:179], v[0:3], v[96:99], 0
ds_read_b128 v[228:231], v249 offset:26624
v_and_b32_e64 v193, s49, v193
v_pk_fma_f16 v207, v240, v240, s48
v_mfma_f32_16x16x32_bf16 v[184:187], v[0:3], v[100:103], 0
v_and_b32_e64 v195, s49, v195
v_pk_fma_f16 v204, v205, v205, s48
s_setprio 2
v_bfe_u32 v192, v193, 2, 14
s_waitcnt lgkmcnt(2)
v_mfma_f32_16x16x32_f16 v[64:67], v[4:7], v[232:235], v[64:67]
ds_read_b128 v[0:3], v249 offset:26880
ds_read_u16_d16 v192, v192
v_pk_mul_f16 v242, v243, v242
v_bfe_u32 v194, v195, 2, 14
v_mfma_f32_16x16x32_f16 v[72:75], v[4:7], v[236:239], v[72:75]
v_pk_mul_f16 v207, v240, v207
v_lshrrev_b32_e64 v193, 18, v193
v_mfma_f32_16x16x32_bf16 v[180:183], v[40:43], v[96:99], 0
ds_read_b128 v[4:7], v248 offset:29952
ds_read_u16_d16 v194, v194
ds_read_u16_d16_hi v193, v193
v_pk_mul_f16 v204, v205, v204
v_lshrrev_b32_e64 v195, 18, v195
v_mfma_f32_16x16x32_bf16 v[188:191], v[40:43], v[100:103], 0
v_exp_f16 v241, v242
v_and_b32 v197, s49, v197
v_mfma_f32_16x16x32_f16 v[68:71], v[44:47], v[232:235], v[68:71]
ds_read_b128 v[40:43], v248 offset:30720
ds_read_u16_d16_hi v195, v195
v_and_b32_e64 v199, s49, v199
v_mfma_f32_16x16x32_f16 v[76:79], v[44:47], v[236:239], v[76:79]
v_exp_f16 v206, v207
v_bfe_u32 v196, v197, 2, 14
v_bfe_u32 v198, v199, 2, 14
s_waitcnt lgkmcnt(7)
v_mfma_f32_16x16x32_bf16 v[176:179], v[224:227], v[104:107], v[176:179]
ds_read_b128 v[44:47], v248 offset:30976
ds_read_u16_d16 v196, v196
ds_read_u16_d16 v198, v198
v_exp_f16_e64 v203, v204
v_mfma_f32_16x16x32_bf16 v[184:187], v[224:227], v[108:111], v[184:187]
v_lshrrev_b32 v197, 18, v197
v_lshrrev_b32 v199, 18, v199
v_mfma_f32_16x16x32_f16 v[80:83], v[228:231], v[232:235], v[80:83]
ds_read_b128 v[224:227], v249 offset:30720
ds_read_u16_d16_hi v197, v197
ds_read_u16_d16_hi v199, v199
v_exp_f16_sdwa v241, v242 dst_sel:WORD_1 dst_unused:UNUSED_PRESERVE src0_sel:WORD_1
v_and_b32 v201, s49, v201
v_mfma_f32_16x16x32_f16 v[168:171], v[228:231], v[236:239], v[168:171]
v_bfe_u32 v200, v201, 2, 14
s_waitcnt lgkmcnt(8)
v_mfma_f32_16x16x32_f16 v[84:87], v[0:3], v[232:235], v[84:87]
ds_read_b128 v[228:231], v249 offset:30976
ds_read_u16_d16 v200, v200
v_exp_f16_sdwa v206, v207 dst_sel:WORD_1 dst_unused:UNUSED_PRESERVE src0_sel:WORD_1
v_lshrrev_b32_e64 v201, 18, v201
v_mfma_f32_16x16x32_f16 v[172:175], v[0:3], v[236:239], v[172:175]
v_exp_f16_sdwa v203, v204 dst_sel:WORD_1 dst_unused:UNUSED_PRESERVE src0_sel:WORD_1
v_pk_add_f16 v241, v241, 1.0 op_sel_hi:[1,0]
v_mfma_f32_16x16x32_bf16 v[180:183], v[4:7], v[104:107], v[180:183]
ds_read_b128 v[0:3], v248 offset:34816
ds_read_u16_d16_hi v201, v201
v_pk_add_f16 v206, v206, 1.0 op_sel_hi:[1,0]
v_pk_add_f16 v203, v203, 1.0 op_sel_hi:[1,0]
v_mfma_f32_16x16x32_bf16 v[188:191], v[4:7], v[108:111], v[188:191]
v_rcp_f16 v242, v241
s_waitcnt lgkmcnt(7)
v_mfma_f32_16x16x32_bf16 v[176:179], v[40:43], v[112:115], v[176:179]
ds_read_b128 v[4:7], v249 offset:31744
v_rcp_f16_e64 v207, v206
v_mfma_f32_16x16x32_bf16 v[184:187], v[40:43], v[116:119], v[184:187]
v_rcp_f16_e64 v204, v203
v_mfma_f32_16x16x32_bf16 v[180:183], v[44:47], v[112:115], v[180:183]
ds_read_b128 v[40:43], v248 offset:35072
v_rcp_f16_sdwa v242, v241 dst_sel:WORD_1 dst_unused:UNUSED_PRESERVE src0_sel:WORD_1
v_mfma_f32_16x16x32_bf16 v[188:191], v[44:47], v[116:119], v[188:191]
v_rcp_f16_sdwa v207, v206 dst_sel:WORD_1 dst_unused:UNUSED_PRESERVE src0_sel:WORD_1
v_or_b32 v232, v192, v193
v_or_b32 v233, v194, v195
s_waitcnt lgkmcnt(4)
v_or_b32 v234, v196, v197
v_rcp_f16_sdwa v204, v203 dst_sel:WORD_1 dst_unused:UNUSED_PRESERVE src0_sel:WORD_1
v_or_b32 v235, v198, v199
s_waitcnt lgkmcnt(2)
v_or_b32_e64 v236, v200, v201
v_pk_mul_f16 v237, v243, v242
v_pk_mul_f16 v238, v240, v207
v_pk_mul_f16 v239, v205, v204
v_mfma_f32_16x16x32_f16 v[48:51], v[224:227], v[232:235], v[48:51]
s_add_u32 s46, s71, 98304
buffer_store_dwordx4 v[160:163], v255, s[8:11], s46 offen offset:256 sc1
ds_read_b128 v[44:47], v249 offset:32000
v_cvt_pkrtz_f16_f32 v193, v176, v177
v_cvt_pkrtz_f16_f32 v195, v178, v179
v_mfma_f32_16x16x32_f16 v[56:59], v[224:227], v[236:239], v[56:59]
v_cvt_pkrtz_f16_f32 v197, v180, v181
v_cvt_pkrtz_f16_f32 v199, v182, v183
v_mfma_f32_16x16x32_f16 v[52:55], v[228:231], v[232:235], v[52:55]
ds_read_b128 v[224:227], v248 offset:35840
v_cvt_pkrtz_f16_f32 v201, v184, v185
v_cvt_pk_f16_f32 v243, v186, v187
v_mfma_f32_16x16x32_f16 v[60:63], v[228:231], v[236:239], v[60:63]
v_cvt_pk_f16_f32 v240, v188, v189
v_cvt_pk_f16_f32 v205, v190, v191
s_setprio 1
v_mfma_f32_16x16x32_bf16 v[176:179], v[0:3], v[96:99], 0
ds_read_b128 v[228:231], v249 offset:32768
v_pk_fma_f16 v242, v243, v243, s48
v_and_b32 v193, s49, v193
v_mfma_f32_16x16x32_bf16 v[184:187], v[0:3], v[100:103], 0
v_pk_fma_f16 v207, v240, v240, s48
v_and_b32 v195, s49, v195
s_waitcnt lgkmcnt(3)
v_mfma_f32_16x16x32_f16 v[64:67], v[4:7], v[232:235], v[64:67]
ds_read_b128 v[0:3], v249 offset:33024
v_pk_fma_f16 v204, v205, v205, s48
v_bfe_u32 v192, v193, 2, 14
v_pk_mul_f16 v242, v243, v242
v_mfma_f32_16x16x32_f16 v[72:75], v[4:7], v[236:239], v[72:75]
v_bfe_u32 v194, v195, 2, 14
v_pk_mul_f16 v207, v240, v207
s_waitcnt vmcnt(11)
v_mfma_f32_16x16x32_bf16 v[48:51], v[26:29], v[20:23], v[48:51]
ds_read_b128 v[4:7], v248 offset:36096
ds_read_u16_d16 v192, v192
ds_read_u16_d16 v194, v194
v_lshrrev_b32 v193, 18, v193
v_pk_mul_f16 v204, v205, v204
v_mfma_f32_16x16x32_bf16 v[52:55], v[24:27], v[20:23], v[52:55]
v_lshrrev_b32_e64 v195, 18, v195
v_mfma_f32_16x16x32_bf16 v[180:183], v[40:43], v[96:99], 0
ds_read_u16_d16_hi v193, v193
ds_read_u16_d16_hi v195, v195
v_exp_f16 v241, v242
v_and_b32 v197, s49, v197
v_mfma_f32_16x16x32_bf16 v[188:191], v[40:43], v[100:103], 0
v_and_b32 v199, s49, v199
s_waitcnt lgkmcnt(6)
v_mfma_f32_16x16x32_f16 v[68:71], v[44:47], v[232:235], v[68:71]
ds_read_b128 v[40:43], v248 offset:36864
v_exp_f16_e64 v206, v207
v_bfe_u32 v196, v197, 2, 14
v_mfma_f32_16x16x32_f16 v[76:79], v[44:47], v[236:239], v[76:79]
v_bfe_u32 v198, v199, 2, 14
v_exp_f16_e64 v203, v204
v_mfma_f32_16x16x32_bf16 v[176:179], v[224:227], v[104:107], v[176:179]
ds_read_b128 v[44:47], v248 offset:37120
ds_read_u16_d16 v196, v196
ds_read_u16_d16 v198, v198
v_lshrrev_b32 v197, 18, v197
v_lshrrev_b32 v199, 18, v199
v_mfma_f32_16x16x32_bf16 v[184:187], v[224:227], v[108:111], v[184:187]
v_exp_f16_sdwa v241, v242 dst_sel:WORD_1 dst_unused:UNUSED_PRESERVE src0_sel:WORD_1
v_mfma_f32_16x16x32_f16 v[80:83], v[228:231], v[232:235], v[80:83]
ds_read_b128 v[224:227], v249 offset:36864
ds_read_u16_d16_hi v197, v197
ds_read_u16_d16_hi v199, v199
v_and_b32 v201, s49, v201
v_bfe_u32 v200, v201, 2, 14
v_mfma_f32_16x16x32_f16 v[168:171], v[228:231], v[236:239], v[168:171]
v_exp_f16_sdwa v206, v207 dst_sel:WORD_1 dst_unused:UNUSED_PRESERVE src0_sel:WORD_1
s_waitcnt lgkmcnt(7)
v_mfma_f32_16x16x32_f16 v[84:87], v[0:3], v[232:235], v[84:87]
ds_read_b128 v[228:231], v249 offset:37120
ds_read_u16_d16 v200, v200
v_lshrrev_b32_e64 v201, 18, v201
v_mfma_f32_16x16x32_f16 v[172:175], v[0:3], v[236:239], v[172:175]
v_exp_f16_sdwa v203, v204 dst_sel:WORD_1 dst_unused:UNUSED_PRESERVE src0_sel:WORD_1
v_pk_add_f16 v241, v241, 1.0 op_sel_hi:[1,0]
v_pk_add_f16 v206, v206, 1.0 op_sel_hi:[1,0]
v_mfma_f32_16x16x32_bf16 v[180:183], v[4:7], v[104:107], v[180:183]
ds_read_b128 v[0:3], v248 offset:40960
ds_read_u16_d16_hi v201, v201
v_pk_add_f16 v203, v203, 1.0 op_sel_hi:[1,0]
v_mfma_f32_16x16x32_bf16 v[188:191], v[4:7], v[108:111], v[188:191]
v_rcp_f16_e64 v242, v241
s_setprio 0
s_waitcnt lgkmcnt(7)
v_mfma_f32_16x16x32_bf16 v[176:179], v[40:43], v[112:115], v[176:179]
ds_read_b128 v[4:7], v249 offset:37888
v_rcp_f16_e64 v207, v206
v_mfma_f32_16x16x32_bf16 v[184:187], v[40:43], v[116:119], v[184:187]
v_rcp_f16_e64 v204, v203
v_mfma_f32_16x16x32_bf16 v[180:183], v[44:47], v[112:115], v[180:183]
ds_read_b128 v[40:43], v248 offset:41216
v_rcp_f16_sdwa v242, v241 dst_sel:WORD_1 dst_unused:UNUSED_PRESERVE src0_sel:WORD_1
v_mfma_f32_16x16x32_bf16 v[188:191], v[44:47], v[116:119], v[188:191]
v_rcp_f16_sdwa v207, v206 dst_sel:WORD_1 dst_unused:UNUSED_PRESERVE src0_sel:WORD_1
v_or_b32 v232, v192, v193
v_or_b32 v233, v194, v195
s_waitcnt lgkmcnt(4)
v_or_b32 v234, v196, v197
v_rcp_f16_sdwa v204, v203 dst_sel:WORD_1 dst_unused:UNUSED_PRESERVE src0_sel:WORD_1
v_or_b32 v235, v198, v199
s_waitcnt lgkmcnt(2)
v_or_b32 v236, v200, v201
v_pk_mul_f16 v237, v243, v242
v_pk_mul_f16 v238, v240, v207
v_pk_mul_f16 v239, v205, v204
s_setprio 3
v_mfma_f32_16x16x32_f16 v[48:51], v[224:227], v[232:235], v[48:51]
ds_read_b128 v[44:47], v249 offset:38144
v_cvt_pkrtz_f16_f32 v193, v176, v177
v_cvt_pkrtz_f16_f32 v195, v178, v179
v_mfma_f32_16x16x32_f16 v[56:59], v[224:227], v[236:239], v[56:59]
v_cvt_pkrtz_f16_f32 v197, v180, v181
v_cvt_pkrtz_f16_f32 v199, v182, v183
v_mfma_f32_16x16x32_f16 v[52:55], v[228:231], v[232:235], v[52:55]
ds_read_b128 v[224:227], v248 offset:41984
v_cvt_pkrtz_f16_f32 v201, v184, v185
v_cvt_pk_f16_f32 v243, v186, v187
v_mfma_f32_16x16x32_f16 v[60:63], v[228:231], v[236:239], v[60:63]
v_cvt_pk_f16_f32 v240, v188, v189
v_cvt_pk_f16_f32 v205, v190, v191
v_mfma_f32_16x16x32_bf16 v[176:179], v[0:3], v[96:99], 0
ds_read_b128 v[228:231], v249 offset:38912
v_pk_fma_f16 v242, v243, v243, s48
v_and_b32_e64 v193, s49, v193
v_mfma_f32_16x16x32_bf16 v[184:187], v[0:3], v[100:103], 0
v_pk_fma_f16 v207, v240, v240, s48
v_and_b32 v195, s49, v195
s_waitcnt lgkmcnt(3)
v_mfma_f32_16x16x32_f16 v[64:67], v[4:7], v[232:235], v[64:67]
ds_read_b128 v[0:3], v249 offset:39168
v_pk_fma_f16 v204, v205, v205, s48
v_bfe_u32 v192, v193, 2, 14
v_pk_mul_f16 v242, v243, v242
v_mfma_f32_16x16x32_f16 v[72:75], v[4:7], v[236:239], v[72:75]
v_bfe_u32 v194, v195, 2, 14
v_pk_mul_f16 v207, v240, v207
s_waitcnt vmcnt(10)
v_mfma_f32_16x16x32_bf16 v[64:67], v[26:29], v[16:19], v[64:67]
ds_read_b128 v[4:7], v248 offset:42240
ds_read_u16_d16 v192, v192
ds_read_u16_d16 v194, v194
v_lshrrev_b32 v193, 18, v193
v_pk_mul_f16 v204, v205, v204
v_mfma_f32_16x16x32_bf16 v[68:71], v[24:27], v[16:19], v[68:71]
v_lshrrev_b32_e64 v195, 18, v195
v_mfma_f32_16x16x32_bf16 v[180:183], v[40:43], v[96:99], 0
ds_read_u16_d16_hi v193, v193
ds_read_u16_d16_hi v195, v195
v_exp_f16 v241, v242
v_and_b32 v197, s49, v197
v_mfma_f32_16x16x32_bf16 v[188:191], v[40:43], v[100:103], 0
v_and_b32 v199, s49, v199
s_waitcnt lgkmcnt(6)
v_mfma_f32_16x16x32_f16 v[68:71], v[44:47], v[232:235], v[68:71]
ds_read_b128 v[40:43], v248 offset:43008
v_exp_f16_e64 v206, v207
v_bfe_u32 v196, v197, 2, 14
v_mfma_f32_16x16x32_f16 v[76:79], v[44:47], v[236:239], v[76:79]
v_bfe_u32 v198, v199, 2, 14
v_exp_f16_e64 v203, v204
v_mfma_f32_16x16x32_bf16 v[176:179], v[224:227], v[104:107], v[176:179]
ds_read_b128 v[44:47], v248 offset:43264
ds_read_u16_d16 v196, v196
ds_read_u16_d16 v198, v198
v_lshrrev_b32 v197, 18, v197
v_lshrrev_b32 v199, 18, v199
v_mfma_f32_16x16x32_bf16 v[184:187], v[224:227], v[108:111], v[184:187]
v_exp_f16_sdwa v241, v242 dst_sel:WORD_1 dst_unused:UNUSED_PRESERVE src0_sel:WORD_1
v_mfma_f32_16x16x32_f16 v[80:83], v[228:231], v[232:235], v[80:83]
ds_read_b128 v[224:227], v249 offset:43008
ds_read_u16_d16_hi v197, v197
ds_read_u16_d16_hi v199, v199
v_and_b32 v201, s49, v201
v_bfe_u32 v200, v201, 2, 14
v_mfma_f32_16x16x32_f16 v[168:171], v[228:231], v[236:239], v[168:171]
v_exp_f16_sdwa v206, v207 dst_sel:WORD_1 dst_unused:UNUSED_PRESERVE src0_sel:WORD_1
s_waitcnt lgkmcnt(7)
v_mfma_f32_16x16x32_f16 v[84:87], v[0:3], v[232:235], v[84:87]
ds_read_b128 v[228:231], v249 offset:43264
ds_read_u16_d16 v200, v200
v_lshrrev_b32_e64 v201, 18, v201
v_mfma_f32_16x16x32_f16 v[172:175], v[0:3], v[236:239], v[172:175]
v_exp_f16_sdwa v203, v204 dst_sel:WORD_1 dst_unused:UNUSED_PRESERVE src0_sel:WORD_1
v_pk_add_f16 v241, v241, 1.0 op_sel_hi:[1,0]
v_pk_add_f16 v206, v206, 1.0 op_sel_hi:[1,0]
v_mfma_f32_16x16x32_bf16 v[180:183], v[4:7], v[104:107], v[180:183]
ds_read_b128 v[0:3], v248 offset:16384
ds_read_u16_d16_hi v201, v201
v_pk_add_f16 v203, v203, 1.0 op_sel_hi:[1,0]
v_mfma_f32_16x16x32_bf16 v[188:191], v[4:7], v[108:111], v[188:191]
v_rcp_f16 v242, v241
s_waitcnt lgkmcnt(7)
v_mfma_f32_16x16x32_bf16 v[176:179], v[40:43], v[112:115], v[176:179]
ds_read_b128 v[4:7], v249 offset:44032
v_rcp_f16_e64 v207, v206
v_mfma_f32_16x16x32_bf16 v[184:187], v[40:43], v[116:119], v[184:187]
v_rcp_f16_e64 v204, v203
v_mfma_f32_16x16x32_bf16 v[180:183], v[44:47], v[112:115], v[180:183]
ds_read_b128 v[40:43], v248 offset:16640
v_rcp_f16_sdwa v242, v241 dst_sel:WORD_1 dst_unused:UNUSED_PRESERVE src0_sel:WORD_1
v_mfma_f32_16x16x32_bf16 v[188:191], v[44:47], v[116:119], v[188:191]
v_rcp_f16_sdwa v207, v206 dst_sel:WORD_1 dst_unused:UNUSED_PRESERVE src0_sel:WORD_1
v_or_b32 v232, v192, v193
v_or_b32 v233, v194, v195
s_waitcnt lgkmcnt(4)
v_or_b32 v234, v196, v197
v_rcp_f16_sdwa v204, v203 dst_sel:WORD_1 dst_unused:UNUSED_PRESERVE src0_sel:WORD_1
v_or_b32 v235, v198, v199
s_waitcnt lgkmcnt(2)
v_or_b32_e64 v236, v200, v201
v_pk_mul_f16 v237, v243, v242
v_pk_mul_f16 v238, v240, v207
v_pk_mul_f16 v239, v205, v204
v_mfma_f32_16x16x32_f16 v[48:51], v[224:227], v[232:235], v[48:51]
s_add_u32 s46, s80, 12582912
buffer_load_dwordx4 v[96:99], v253, s[32:35], s46 offen nt
ds_read_b128 v[44:47], v249 offset:44288
v_cvt_pkrtz_f16_f32 v193, v176, v177
v_cvt_pkrtz_f16_f32 v195, v178, v179
v_mfma_f32_16x16x32_f16 v[56:59], v[224:227], v[236:239], v[56:59]
v_cvt_pkrtz_f16_f32 v197, v180, v181
v_cvt_pkrtz_f16_f32 v199, v182, v183
v_mfma_f32_16x16x32_f16 v[52:55], v[228:231], v[232:235], v[52:55]
ds_read_b128 v[224:227], v248 offset:17408
v_cvt_pkrtz_f16_f32 v201, v184, v185
v_cvt_pk_f16_f32 v243, v186, v187
v_mfma_f32_16x16x32_f16 v[60:63], v[228:231], v[236:239], v[60:63]
v_cvt_pk_f16_f32 v240, v188, v189
v_cvt_pk_f16_f32 v205, v190, v191
v_mfma_f32_16x16x32_bf16 v[176:179], v[0:3], v[88:91], 0
ds_read_b128 v[228:231], v249 offset:45056
v_pk_fma_f16 v242, v243, v243, s48
v_and_b32_e64 v193, s49, v193
v_mfma_f32_16x16x32_bf16 v[184:187], v[0:3], v[92:95], 0
v_pk_fma_f16 v207, v240, v240, s48
v_and_b32 v195, s49, v195
s_waitcnt lgkmcnt(3)
v_mfma_f32_16x16x32_f16 v[64:67], v[4:7], v[232:235], v[64:67]
ds_read_b128 v[0:3], v249 offset:45312
v_pk_fma_f16 v204, v205, v205, s48
s_setprio 2
v_bfe_u32 v192, v193, 2, 14
v_pk_mul_f16 v242, v243, v242
v_mfma_f32_16x16x32_f16 v[72:75], v[4:7], v[236:239], v[72:75]
v_bfe_u32 v194, v195, 2, 14
v_pk_mul_f16 v207, v240, v207
s_waitcnt vmcnt(10)
v_mfma_f32_16x16x32_bf16 v[80:83], v[26:29], v[8:11], v[80:83]
ds_read_b128 v[4:7], v248 offset:17664
ds_read_u16_d16 v192, v192
ds_read_u16_d16 v194, v194
v_lshrrev_b32_e64 v193, 18, v193
v_pk_mul_f16 v204, v205, v204
v_mfma_f32_16x16x32_bf16 v[84:87], v[24:27], v[8:11], v[84:87]
v_lshrrev_b32_e64 v195, 18, v195
v_mfma_f32_16x16x32_bf16 v[180:183], v[40:43], v[88:91], 0
ds_read_u16_d16_hi v193, v193
ds_read_u16_d16_hi v195, v195
v_exp_f16 v241, v242
v_and_b32 v197, s49, v197
v_mfma_f32_16x16x32_bf16 v[188:191], v[40:43], v[92:95], 0
v_and_b32 v199, s49, v199
s_waitcnt lgkmcnt(6)
v_mfma_f32_16x16x32_f16 v[68:71], v[44:47], v[232:235], v[68:71]
ds_read_b128 v[40:43], v248 offset:18432
v_exp_f16_e64 v206, v207
v_bfe_u32 v196, v197, 2, 14
v_mfma_f32_16x16x32_f16 v[76:79], v[44:47], v[236:239], v[76:79]
v_bfe_u32 v198, v199, 2, 14
v_exp_f16_e64 v203, v204
v_mfma_f32_16x16x32_bf16 v[176:179], v[224:227], v[208:211], v[176:179]
ds_read_b128 v[44:47], v248 offset:18688
ds_read_u16_d16 v196, v196
ds_read_u16_d16 v198, v198
v_lshrrev_b32 v197, 18, v197
v_lshrrev_b32 v199, 18, v199
v_mfma_f32_16x16x32_bf16 v[184:187], v[224:227], v[212:215], v[184:187]
v_exp_f16_sdwa v241, v242 dst_sel:WORD_1 dst_unused:UNUSED_PRESERVE src0_sel:WORD_1
v_mfma_f32_16x16x32_f16 v[80:83], v[228:231], v[232:235], v[80:83]
ds_read_b128 v[224:227], v249 offset:49152
ds_read_u16_d16_hi v197, v197
ds_read_u16_d16_hi v199, v199
v_and_b32 v201, s49, v201
v_bfe_u32 v200, v201, 2, 14
v_mfma_f32_16x16x32_f16 v[168:171], v[228:231], v[236:239], v[168:171]
v_exp_f16_sdwa v206, v207 dst_sel:WORD_1 dst_unused:UNUSED_PRESERVE src0_sel:WORD_1
s_waitcnt lgkmcnt(7)
v_mfma_f32_16x16x32_f16 v[84:87], v[0:3], v[232:235], v[84:87]
ds_read_b128 v[228:231], v249 offset:49408
ds_read_u16_d16 v200, v200
v_lshrrev_b32_e64 v201, 18, v201
v_mfma_f32_16x16x32_f16 v[172:175], v[0:3], v[236:239], v[172:175]
v_exp_f16_sdwa v203, v204 dst_sel:WORD_1 dst_unused:UNUSED_PRESERVE src0_sel:WORD_1
v_pk_add_f16 v241, v241, 1.0 op_sel_hi:[1,0]
v_pk_add_f16 v206, v206, 1.0 op_sel_hi:[1,0]
v_mfma_f32_16x16x32_bf16 v[180:183], v[4:7], v[208:211], v[180:183]
ds_read_b128 v[0:3], v248 offset:22528
ds_read_u16_d16_hi v201, v201
v_pk_add_f16 v203, v203, 1.0 op_sel_hi:[1,0]
v_mfma_f32_16x16x32_bf16 v[188:191], v[4:7], v[212:215], v[188:191]
v_rcp_f16 v242, v241
s_waitcnt lgkmcnt(7)
v_mfma_f32_16x16x32_bf16 v[176:179], v[40:43], v[32:35], v[176:179]
ds_read_b128 v[4:7], v249 offset:50176
v_rcp_f16_e64 v207, v206
v_mfma_f32_16x16x32_bf16 v[184:187], v[40:43], v[36:39], v[184:187]
v_rcp_f16_e64 v204, v203
v_mfma_f32_16x16x32_bf16 v[180:183], v[44:47], v[32:35], v[180:183]
ds_read_b128 v[40:43], v248 offset:22784
v_rcp_f16_sdwa v242, v241 dst_sel:WORD_1 dst_unused:UNUSED_PRESERVE src0_sel:WORD_1
v_mfma_f32_16x16x32_bf16 v[188:191], v[44:47], v[36:39], v[188:191]
v_rcp_f16_sdwa v207, v206 dst_sel:WORD_1 dst_unused:UNUSED_PRESERVE src0_sel:WORD_1
v_or_b32 v232, v192, v193
v_or_b32 v233, v194, v195
s_waitcnt lgkmcnt(4)
v_or_b32 v234, v196, v197
v_rcp_f16_sdwa v204, v203 dst_sel:WORD_1 dst_unused:UNUSED_PRESERVE src0_sel:WORD_1
v_or_b32 v235, v198, v199
s_waitcnt lgkmcnt(2)
v_or_b32_e64 v236, v200, v201
v_pk_mul_f16 v237, v243, v242
v_pk_mul_f16 v238, v240, v207
v_pk_mul_f16 v239, v205, v204
v_mfma_f32_16x16x32_f16 v[48:51], v[224:227], v[232:235], v[48:51]
s_add_u32 s46, s80, 12582912
buffer_load_dwordx4 v[100:103], v253, s[32:35], s46 offen offset:256 nt
ds_read_b128 v[44:47], v249 offset:50432
v_cvt_pkrtz_f16_f32 v193, v176, v177
v_cvt_pkrtz_f16_f32 v195, v178, v179
v_mfma_f32_16x16x32_f16 v[56:59], v[224:227], v[236:239], v[56:59]
v_cvt_pkrtz_f16_f32 v197, v180, v181
v_cvt_pkrtz_f16_f32 v199, v182, v183
v_mfma_f32_16x16x32_f16 v[52:55], v[228:231], v[232:235], v[52:55]
ds_read_b128 v[224:227], v248 offset:23552
v_cvt_pkrtz_f16_f32 v201, v184, v185
v_cvt_pk_f16_f32 v243, v186, v187
v_mfma_f32_16x16x32_f16 v[60:63], v[228:231], v[236:239], v[60:63]
v_cvt_pk_f16_f32 v240, v188, v189
v_cvt_pk_f16_f32 v205, v190, v191
s_setprio 1
v_mfma_f32_16x16x32_bf16 v[176:179], v[0:3], v[88:91], 0
ds_read_b128 v[228:231], v249 offset:51200
v_pk_fma_f16 v242, v243, v243, s48
v_and_b32 v193, s49, v193
v_mfma_f32_16x16x32_bf16 v[184:187], v[0:3], v[92:95], 0
v_pk_fma_f16 v207, v240, v240, s48
v_and_b32 v195, s49, v195
s_waitcnt lgkmcnt(3)
v_mfma_f32_16x16x32_f16 v[64:67], v[4:7], v[232:235], v[64:67]
ds_read_b128 v[0:3], v249 offset:51456
v_pk_fma_f16 v204, v205, v205, s48
v_bfe_u32 v192, v193, 2, 14
v_pk_mul_f16 v242, v243, v242
v_mfma_f32_16x16x32_f16 v[72:75], v[4:7], v[236:239], v[72:75]
v_bfe_u32 v194, v195, 2, 14
v_pk_mul_f16 v207, v240, v207
s_waitcnt vmcnt(9)
v_mfma_f32_16x16x32_bf16 v[56:59], v[26:29], v[12:15], v[56:59]
ds_read_b128 v[4:7], v248 offset:23808
ds_read_u16_d16 v192, v192
ds_read_u16_d16 v194, v194
v_lshrrev_b32 v193, 18, v193
v_pk_mul_f16 v204, v205, v204
v_mfma_f32_16x16x32_bf16 v[60:63], v[24:27], v[12:15], v[60:63]
v_lshrrev_b32_e64 v195, 18, v195
v_mfma_f32_16x16x32_bf16 v[180:183], v[40:43], v[88:91], 0
ds_read_u16_d16_hi v193, v193
ds_read_u16_d16_hi v195, v195
v_exp_f16 v241, v242
v_and_b32 v197, s49, v197
v_mfma_f32_16x16x32_bf16 v[188:191], v[40:43], v[92:95], 0
v_and_b32 v199, s49, v199
s_waitcnt lgkmcnt(6)
v_mfma_f32_16x16x32_f16 v[68:71], v[44:47], v[232:235], v[68:71]
ds_read_b128 v[40:43], v248 offset:24576
v_exp_f16_e64 v206, v207
v_bfe_u32 v196, v197, 2, 14
v_mfma_f32_16x16x32_f16 v[76:79], v[44:47], v[236:239], v[76:79]
v_bfe_u32 v198, v199, 2, 14
v_exp_f16_e64 v203, v204
v_mfma_f32_16x16x32_bf16 v[176:179], v[224:227], v[208:211], v[176:179]
ds_read_b128 v[44:47], v248 offset:24832
ds_read_u16_d16 v196, v196
ds_read_u16_d16 v198, v198
v_lshrrev_b32 v197, 18, v197
v_lshrrev_b32 v199, 18, v199
v_mfma_f32_16x16x32_bf16 v[184:187], v[224:227], v[212:215], v[184:187]
v_exp_f16_sdwa v241, v242 dst_sel:WORD_1 dst_unused:UNUSED_PRESERVE src0_sel:WORD_1
v_mfma_f32_16x16x32_f16 v[80:83], v[228:231], v[232:235], v[80:83]
ds_read_b128 v[224:227], v249 offset:24576
ds_read_u16_d16_hi v197, v197
ds_read_u16_d16_hi v199, v199
v_and_b32 v201, s49, v201
v_bfe_u32 v200, v201, 2, 14
v_mfma_f32_16x16x32_f16 v[168:171], v[228:231], v[236:239], v[168:171]
v_exp_f16_sdwa v206, v207 dst_sel:WORD_1 dst_unused:UNUSED_PRESERVE src0_sel:WORD_1
s_waitcnt lgkmcnt(7)
v_mfma_f32_16x16x32_f16 v[84:87], v[0:3], v[232:235], v[84:87]
ds_read_b128 v[228:231], v254 offset:7936
ds_read_u16_d16 v200, v200
v_lshrrev_b32_e64 v201, 18, v201
v_mfma_f32_16x16x32_f16 v[172:175], v[0:3], v[236:239], v[172:175]
v_exp_f16_sdwa v203, v204 dst_sel:WORD_1 dst_unused:UNUSED_PRESERVE src0_sel:WORD_1
v_pk_add_f16 v241, v241, 1.0 op_sel_hi:[1,0]
v_pk_add_f16 v206, v206, 1.0 op_sel_hi:[1,0]
v_mfma_f32_16x16x32_bf16 v[180:183], v[4:7], v[208:211], v[180:183]
ds_read_b128 v[0:3], v249 offset:24832
ds_read_u16_d16_hi v201, v201
v_pk_add_f16 v203, v203, 1.0 op_sel_hi:[1,0]
v_mfma_f32_16x16x32_bf16 v[188:191], v[4:7], v[212:215], v[188:191]
v_rcp_f16_e64 v242, v241
s_setprio 0
s_waitcnt lgkmcnt(7)
v_mfma_f32_16x16x32_bf16 v[176:179], v[40:43], v[32:35], v[176:179]
ds_read_b128 v[4:7], v254 offset:7952
v_rcp_f16_e64 v207, v206
v_mfma_f32_16x16x32_bf16 v[184:187], v[40:43], v[36:39], v[184:187]
v_rcp_f16_e64 v204, v203
v_mfma_f32_16x16x32_bf16 v[180:183], v[44:47], v[32:35], v[180:183]
ds_read_b128 v[40:43], v248 offset:28672
v_rcp_f16_sdwa v242, v241 dst_sel:WORD_1 dst_unused:UNUSED_PRESERVE src0_sel:WORD_1
v_mfma_f32_16x16x32_bf16 v[188:191], v[44:47], v[36:39], v[188:191]
v_rcp_f16_sdwa v207, v206 dst_sel:WORD_1 dst_unused:UNUSED_PRESERVE src0_sel:WORD_1
v_or_b32 v232, v192, v193
v_or_b32 v233, v194, v195
s_waitcnt lgkmcnt(4)
v_or_b32 v234, v196, v197
v_rcp_f16_sdwa v204, v203 dst_sel:WORD_1 dst_unused:UNUSED_PRESERVE src0_sel:WORD_1
v_or_b32 v235, v198, v199
s_waitcnt lgkmcnt(2)
v_or_b32_e64 v236, v200, v201
v_pk_mul_f16 v237, v243, v242
v_pk_mul_f16 v238, v240, v207
v_pk_mul_f16 v239, v205, v204
s_setprio 3
v_mfma_f32_16x16x32_f16 v[120:123], v[224:227], v[232:235], v[228:231]
s_add_u32 s46, s80, 16777216
buffer_load_dwordx4 v[104:107], v253, s[32:35], s46 offen nt
ds_read_b128 v[44:47], v249 offset:25600
v_cvt_pkrtz_f16_f32 v193, v176, v177
v_cvt_pkrtz_f16_f32 v195, v178, v179
v_mfma_f32_16x16x32_f16 v[128:131], v[224:227], v[236:239], v[228:231]
v_cvt_pkrtz_f16_f32 v197, v180, v181
v_cvt_pkrtz_f16_f32 v199, v182, v183
s_waitcnt lgkmcnt(1)
v_mfma_f32_16x16x32_f16 v[124:127], v[0:3], v[232:235], v[4:7]
ds_read_b128 v[224:227], v254 offset:8064
ds_read_b128 v[228:231], v248 offset:28928
v_cvt_pkrtz_f16_f32 v201, v184, v185
v_cvt_pk_f16_f32 v243, v186, v187
v_mfma_f32_16x16x32_f16 v[132:135], v[0:3], v[236:239], v[4:7]
v_cvt_pk_f16_f32 v240, v188, v189
v_cvt_pk_f16_f32 v205, v190, v191
v_mfma_f32_16x16x32_bf16 v[176:179], v[40:43], v[88:91], 0
ds_read_b128 v[0:3], v249 offset:25856
ds_read_b128 v[4:7], v254 offset:8080
v_pk_fma_f16 v242, v243, v243, s48
v_and_b32_e64 v193, s49, v193
v_mfma_f32_16x16x32_bf16 v[184:187], v[40:43], v[92:95], 0
v_pk_fma_f16 v207, v240, v240, s48
v_and_b32 v195, s49, v195
s_waitcnt lgkmcnt(3)
v_mfma_f32_16x16x32_f16 v[136:139], v[44:47], v[232:235], v[224:227]
ds_read_b128 v[40:43], v248 offset:29696
v_pk_fma_f16 v204, v205, v205, s48
v_bfe_u32 v192, v193, 2, 14
v_pk_mul_f16 v242, v243, v242
v_mfma_f32_16x16x32_f16 v[144:147], v[44:47], v[236:239], v[224:227]
v_bfe_u32 v194, v195, 2, 14
v_pk_mul_f16 v207, v240, v207
s_waitcnt vmcnt(7)
v_mfma_f32_16x16x32_bf16 v[72:75], v[26:29], v[216:219], v[72:75]
ds_read_b128 v[44:47], v249 offset:26624
ds_read_b128 v[224:227], v254 offset:16128
ds_read_u16_d16 v192, v192
ds_read_u16_d16 v194, v194
v_lshrrev_b32 v193, 18, v193
v_pk_mul_f16 v204, v205, v204
v_mfma_f32_16x16x32_bf16 v[76:79], v[24:27], v[216:219], v[76:79]
v_lshrrev_b32 v195, 18, v195
s_waitcnt lgkmcnt(5)
v_mfma_f32_16x16x32_bf16 v[180:183], v[228:231], v[88:91], 0
ds_read_u16_d16_hi v193, v193
ds_read_u16_d16_hi v195, v195
v_exp_f16 v241, v242
v_and_b32 v197, s49, v197
v_mfma_f32_16x16x32_bf16 v[188:191], v[228:231], v[92:95], 0
v_and_b32_e64 v199, s49, v199
v_mfma_f32_16x16x32_f16 v[140:143], v[0:3], v[232:235], v[4:7]
ds_read_b128 v[228:231], v249 offset:26880
v_exp_f16_e64 v206, v207
v_bfe_u32 v196, v197, 2, 14
v_mfma_f32_16x16x32_f16 v[148:151], v[0:3], v[236:239], v[4:7]
v_bfe_u32 v198, v199, 2, 14
v_exp_f16 v203, v204
s_waitcnt lgkmcnt(7)
v_mfma_f32_16x16x32_bf16 v[176:179], v[40:43], v[208:211], v[176:179]
ds_read_b128 v[0:3], v254 offset:16144
ds_read_b128 v[4:7], v248 offset:29952
ds_read_u16_d16 v196, v196
ds_read_u16_d16 v198, v198
v_lshrrev_b32_e64 v197, 18, v197
v_lshrrev_b32 v199, 18, v199
v_mfma_f32_16x16x32_bf16 v[184:187], v[40:43], v[212:215], v[184:187]
v_exp_f16_sdwa v241, v242 dst_sel:WORD_1 dst_unused:UNUSED_PRESERVE src0_sel:WORD_1
s_waitcnt lgkmcnt(7)
v_mfma_f32_16x16x32_f16 v[152:155], v[44:47], v[232:235], v[224:227]
ds_read_b128 v[40:43], v248 offset:30720
ds_read_u16_d16_hi v197, v197
ds_read_u16_d16_hi v199, v199
v_and_b32 v201, s49, v201
v_bfe_u32 v200, v201, 2, 14
v_mfma_f32_16x16x32_f16 v[160:163], v[44:47], v[236:239], v[224:227]
v_exp_f16_sdwa v206, v207 dst_sel:WORD_1 dst_unused:UNUSED_PRESERVE src0_sel:WORD_1
s_waitcnt lgkmcnt(6)
v_mfma_f32_16x16x32_f16 v[156:159], v[228:231], v[232:235], v[0:3]
ds_read_b128 v[44:47], v248 offset:30976
ds_read_b128 v[224:227], v249 offset:30720
ds_read_u16_d16 v200, v200
v_lshrrev_b32 v201, 18, v201
v_mfma_f32_16x16x32_f16 v[164:167], v[228:231], v[236:239], v[0:3]
v_exp_f16_sdwa v203, v204 dst_sel:WORD_1 dst_unused:UNUSED_PRESERVE src0_sel:WORD_1
v_pk_add_f16 v241, v241, 1.0 op_sel_hi:[1,0]
v_pk_add_f16 v206, v206, 1.0 op_sel_hi:[1,0]
s_waitcnt lgkmcnt(7)
v_mfma_f32_16x16x32_bf16 v[180:183], v[4:7], v[208:211], v[180:183]
ds_read_b128 v[228:231], v249 offset:30976
ds_read_b128 v[0:3], v248 offset:40960
ds_read_u16_d16_hi v201, v201
v_pk_add_f16 v203, v203, 1.0 op_sel_hi:[1,0]
v_mfma_f32_16x16x32_bf16 v[188:191], v[4:7], v[212:215], v[188:191]
v_rcp_f16 v242, v241
s_waitcnt lgkmcnt(8)
v_mfma_f32_16x16x32_bf16 v[176:179], v[40:43], v[32:35], v[176:179]
ds_read_b128 v[4:7], v249 offset:31744
v_rcp_f16_e64 v207, v206
v_mfma_f32_16x16x32_bf16 v[184:187], v[40:43], v[36:39], v[184:187]
v_rcp_f16 v204, v203
s_waitcnt lgkmcnt(6)
v_mfma_f32_16x16x32_bf16 v[180:183], v[44:47], v[32:35], v[180:183]
ds_read_b128 v[40:43], v248 offset:41216
v_rcp_f16_sdwa v242, v241 dst_sel:WORD_1 dst_unused:UNUSED_PRESERVE src0_sel:WORD_1
v_mfma_f32_16x16x32_bf16 v[188:191], v[44:47], v[36:39], v[188:191]
v_rcp_f16_sdwa v207, v206 dst_sel:WORD_1 dst_unused:UNUSED_PRESERVE src0_sel:WORD_1
v_or_b32 v232, v192, v193
v_or_b32 v233, v194, v195
v_or_b32_e64 v234, v196, v197
v_rcp_f16_sdwa v204, v203 dst_sel:WORD_1 dst_unused:UNUSED_PRESERVE src0_sel:WORD_1
v_or_b32 v235, v198, v199
s_waitcnt lgkmcnt(2)
v_or_b32_e64 v236, v200, v201
v_pk_mul_f16 v237, v243, v242
v_pk_mul_f16 v238, v240, v207
v_pk_mul_f16 v239, v205, v204
v_mfma_f32_16x16x32_f16 v[120:123], v[224:227], v[232:235], v[120:123]
s_add_u32 s46, s80, 16777216
buffer_load_dwordx4 v[108:111], v253, s[32:35], s46 offen offset:256 nt
ds_read_b128 v[44:47], v249 offset:32000
v_cvt_pkrtz_f16_f32 v193, v176, v177
v_cvt_pkrtz_f16_f32 v195, v178, v179
v_mfma_f32_16x16x32_f16 v[128:131], v[224:227], v[236:239], v[128:131]
v_cvt_pkrtz_f16_f32 v197, v180, v181
v_cvt_pkrtz_f16_f32 v199, v182, v183
v_mfma_f32_16x16x32_f16 v[124:127], v[228:231], v[232:235], v[124:127]
ds_read_b128 v[224:227], v248 offset:41984
v_cvt_pkrtz_f16_f32 v201, v184, v185
v_cvt_pk_f16_f32 v243, v186, v187
v_mfma_f32_16x16x32_f16 v[132:135], v[228:231], v[236:239], v[132:135]
v_cvt_pk_f16_f32 v240, v188, v189
v_cvt_pk_f16_f32 v205, v190, v191
v_mfma_f32_16x16x32_bf16 v[176:179], v[0:3], v[88:91], 0
ds_read_b128 v[228:231], v249 offset:32768
v_pk_fma_f16 v242, v243, v243, s48
v_and_b32_e64 v193, s49, v193
v_mfma_f32_16x16x32_bf16 v[184:187], v[0:3], v[92:95], 0
v_pk_fma_f16 v207, v240, v240, s48
v_and_b32 v195, s49, v195
s_waitcnt lgkmcnt(3)
v_mfma_f32_16x16x32_f16 v[136:139], v[4:7], v[232:235], v[136:139]
ds_read_b128 v[0:3], v249 offset:33024
v_pk_fma_f16 v204, v205, v205, s48
s_setprio 2
v_bfe_u32 v192, v193, 2, 14
v_pk_mul_f16 v242, v243, v242
v_mfma_f32_16x16x32_f16 v[144:147], v[4:7], v[236:239], v[144:147]
v_bfe_u32 v194, v195, 2, 14
v_pk_mul_f16 v207, v240, v207
s_waitcnt vmcnt(7)
v_mfma_f32_16x16x32_bf16 v[168:171], v[26:29], v[244:247], v[168:171]
ds_read_b128 v[4:7], v248 offset:42240
ds_read_u16_d16 v192, v192
ds_read_u16_d16 v194, v194
v_lshrrev_b32_e64 v193, 18, v193
v_pk_mul_f16 v204, v205, v204
v_mfma_f32_16x16x32_bf16 v[172:175], v[24:27], v[244:247], v[172:175]
v_lshrrev_b32_e64 v195, 18, v195
v_mfma_f32_16x16x32_bf16 v[180:183], v[40:43], v[88:91], 0
ds_read_u16_d16_hi v193, v193
ds_read_u16_d16_hi v195, v195
v_exp_f16 v241, v242
v_and_b32 v197, s49, v197
v_mfma_f32_16x16x32_bf16 v[188:191], v[40:43], v[92:95], 0
v_and_b32 v199, s49, v199
s_waitcnt lgkmcnt(6)
v_mfma_f32_16x16x32_f16 v[140:143], v[44:47], v[232:235], v[140:143]
ds_read_b128 v[40:43], v248 offset:43008
v_exp_f16_e64 v206, v207
v_bfe_u32 v196, v197, 2, 14
v_mfma_f32_16x16x32_f16 v[148:151], v[44:47], v[236:239], v[148:151]
v_bfe_u32 v198, v199, 2, 14
v_exp_f16_e64 v203, v204
v_mfma_f32_16x16x32_bf16 v[176:179], v[224:227], v[208:211], v[176:179]
ds_read_b128 v[44:47], v248 offset:43264
ds_read_u16_d16 v196, v196
ds_read_u16_d16 v198, v198
v_lshrrev_b32 v197, 18, v197
v_lshrrev_b32 v199, 18, v199
v_mfma_f32_16x16x32_bf16 v[184:187], v[224:227], v[212:215], v[184:187]
v_exp_f16_sdwa v241, v242 dst_sel:WORD_1 dst_unused:UNUSED_PRESERVE src0_sel:WORD_1
v_mfma_f32_16x16x32_f16 v[152:155], v[228:231], v[232:235], v[152:155]
ds_read_b128 v[224:227], v249 offset:36864
ds_read_u16_d16_hi v197, v197
ds_read_u16_d16_hi v199, v199
v_and_b32 v201, s49, v201
v_bfe_u32 v200, v201, 2, 14
v_mfma_f32_16x16x32_f16 v[160:163], v[228:231], v[236:239], v[160:163]
v_exp_f16_sdwa v206, v207 dst_sel:WORD_1 dst_unused:UNUSED_PRESERVE src0_sel:WORD_1
s_waitcnt lgkmcnt(7)
v_mfma_f32_16x16x32_f16 v[156:159], v[0:3], v[232:235], v[156:159]
ds_read_b128 v[228:231], v249 offset:37120
ds_read_u16_d16 v200, v200
v_lshrrev_b32_e64 v201, 18, v201
v_mfma_f32_16x16x32_f16 v[164:167], v[0:3], v[236:239], v[164:167]
v_exp_f16_sdwa v203, v204 dst_sel:WORD_1 dst_unused:UNUSED_PRESERVE src0_sel:WORD_1
v_pk_add_f16 v241, v241, 1.0 op_sel_hi:[1,0]
v_pk_add_f16 v206, v206, 1.0 op_sel_hi:[1,0]
v_mfma_f32_16x16x32_bf16 v[180:183], v[4:7], v[208:211], v[180:183]
ds_read_b128 v[0:3], v248 offset:34816
ds_read_u16_d16_hi v201, v201
v_pk_add_f16 v203, v203, 1.0 op_sel_hi:[1,0]
v_mfma_f32_16x16x32_bf16 v[188:191], v[4:7], v[212:215], v[188:191]
v_rcp_f16 v242, v241
s_waitcnt lgkmcnt(7)
v_mfma_f32_16x16x32_bf16 v[176:179], v[40:43], v[32:35], v[176:179]
ds_read_b128 v[4:7], v249 offset:37888
v_rcp_f16_e64 v207, v206
v_mfma_f32_16x16x32_bf16 v[184:187], v[40:43], v[36:39], v[184:187]
v_rcp_f16_e64 v204, v203
v_mfma_f32_16x16x32_bf16 v[180:183], v[44:47], v[32:35], v[180:183]
ds_read_b128 v[40:43], v248 offset:35072
v_rcp_f16_sdwa v242, v241 dst_sel:WORD_1 dst_unused:UNUSED_PRESERVE src0_sel:WORD_1
v_mfma_f32_16x16x32_bf16 v[188:191], v[44:47], v[36:39], v[188:191]
v_rcp_f16_sdwa v207, v206 dst_sel:WORD_1 dst_unused:UNUSED_PRESERVE src0_sel:WORD_1
v_or_b32 v232, v192, v193
v_or_b32 v233, v194, v195
s_waitcnt lgkmcnt(4)
v_or_b32 v234, v196, v197
v_rcp_f16_sdwa v204, v203 dst_sel:WORD_1 dst_unused:UNUSED_PRESERVE src0_sel:WORD_1
v_or_b32 v235, v198, v199
s_waitcnt lgkmcnt(2)
v_or_b32_e64 v236, v200, v201
v_pk_mul_f16 v237, v243, v242
v_pk_mul_f16 v238, v240, v207
v_pk_mul_f16 v239, v205, v204
v_mfma_f32_16x16x32_f16 v[120:123], v[224:227], v[232:235], v[120:123]
s_add_u32 s46, s80, 20971520
buffer_load_dwordx4 v[112:115], v253, s[32:35], s46 offen nt
ds_read_b128 v[44:47], v249 offset:38144
v_cvt_pkrtz_f16_f32 v193, v176, v177
v_cvt_pkrtz_f16_f32 v195, v178, v179
v_cvt_pkrtz_f16_f32 v197, v180, v181
v_mfma_f32_16x16x32_f16 v[128:131], v[224:227], v[236:239], v[128:131]
v_cvt_pkrtz_f16_f32 v199, v182, v183
v_cvt_pkrtz_f16_f32 v201, v184, v185
v_cvt_pkrtz_f16_f32 v203, v186, v187
v_mfma_f32_16x16x32_f16 v[124:127], v[228:231], v[232:235], v[124:127]
ds_read_b128 v[224:227], v248 offset:35840
v_cvt_pk_f16_f32 v243, v188, v189
v_cvt_pk_f16_f32 v240, v190, v191
s_setprio 1
v_pk_fma_f16 v242, v243, v243, s48
v_mfma_f32_16x16x32_f16 v[132:135], v[228:231], v[236:239], v[132:135]
v_cvt_pk_bf16_f32 v64, v64, v65
v_and_b32 v193, s49, v193
v_cvt_pk_bf16_f32 v65, v66, v67
v_mfma_f32_16x16x32_bf16 v[176:179], v[0:3], v[88:91], 0
ds_read_b128 v[228:231], v249 offset:38912
v_and_b32 v195, s49, v195
v_cvt_pk_bf16_f32 v66, v68, v69
v_pk_fma_f16 v207, v240, v240, s48
v_mfma_f32_16x16x32_bf16 v[184:187], v[0:3], v[92:95], 0
v_bfe_u32 v192, v193, 2, 14
v_cvt_pk_bf16_f32 v67, v70, v71
v_pk_mul_f16 v242, v243, v242
s_waitcnt lgkmcnt(2)
v_mfma_f32_16x16x32_f16 v[136:139], v[4:7], v[232:235], v[136:139]
ds_read_b128 v[0:3], v249 offset:39168
ds_read_u16_d16 v192, v192
v_cvt_pk_bf16_f32 v48, v48, v49
v_bfe_u32 v194, v195, 2, 14
v_cvt_pk_bf16_f32 v49, v50, v51
v_mfma_f32_16x16x32_f16 v[144:147], v[4:7], v[236:239], v[144:147]
v_pk_mul_f16 v207, v240, v207
v_lshrrev_b32_e64 v193, 18, v193
v_cvt_pk_bf16_f32 v50, v52, v53
v_mfma_f32_16x16x32_bf16 v[180:183], v[40:43], v[88:91], 0
ds_read_b128 v[4:7], v248 offset:36096
ds_read_u16_d16 v194, v194
ds_read_u16_d16_hi v193, v193
v_exp_f16_e64 v241, v242
v_cvt_pk_bf16_f32 v51, v54, v55
v_mfma_f32_16x16x32_bf16 v[188:191], v[40:43], v[92:95], 0
v_lshrrev_b32_e64 v195, 18, v195
v_cvt_pk_bf16_f32 v80, v80, v81
v_and_b32_e64 v197, s49, v197
v_mfma_f32_16x16x32_f16 v[140:143], v[44:47], v[232:235], v[140:143]
ds_read_b128 v[40:43], v248 offset:36864
ds_read_u16_d16_hi v195, v195
v_cvt_pk_bf16_f32 v81, v82, v83
v_exp_f16_e64 v206, v207
v_mfma_f32_16x16x32_f16 v[148:151], v[44:47], v[236:239], v[148:151]
v_cvt_pk_bf16_f32 v82, v84, v85
v_and_b32_e64 v199, s49, v199
v_cvt_pk_bf16_f32 v83, v86, v87
s_mov_b64 vcc, s[74:75]
s_waitcnt lgkmcnt(5)
v_mfma_f32_16x16x32_bf16 v[176:179], v[224:227], v[208:211], v[176:179]
ds_read_b128 v[44:47], v248 offset:37120
v_bfe_u32 v196, v197, 2, 14
v_cndmask_b32_e64 v68, v48, v80, s[74:75]
v_mfma_f32_16x16x32_bf16 v[184:187], v[224:227], v[212:215], v[184:187]
v_exp_f16_sdwa v241, v242 dst_sel:WORD_1 dst_unused:UNUSED_PRESERVE src0_sel:WORD_1
v_cndmask_b32_dpp v48, v64, v48, vcc quad_perm:[1,0,3,2] row_mask:0xf bank_mask:0xf
v_bfe_u32 v198, v199, 2, 14
v_mfma_f32_16x16x32_f16 v[152:155], v[228:231], v[232:235], v[152:155]
ds_read_b128 v[224:227], v249 offset:49152
ds_read_u16_d16 v196, v196
ds_read_u16_d16 v198, v198
v_cndmask_b32_e64 v69, v49, v81, s[74:75]
v_lshrrev_b32_e64 v197, 18, v197
v_cndmask_b32_dpp v49, v65, v49, vcc quad_perm:[1,0,3,2] row_mask:0xf bank_mask:0xf
v_mfma_f32_16x16x32_f16 v[160:163], v[228:231], v[236:239], v[160:163]
v_lshrrev_b32_e64 v199, 18, v199
v_exp_f16_sdwa v206, v207 dst_sel:WORD_1 dst_unused:UNUSED_PRESERVE src0_sel:WORD_1
v_mfma_f32_16x16x32_f16 v[156:159], v[0:3], v[232:235], v[156:159]
ds_read_b128 v[228:231], v249 offset:49408
ds_read_u16_d16_hi v197, v197
ds_read_u16_d16_hi v199, v199
v_cndmask_b32_e64 v70, v50, v82, s[74:75]
v_cndmask_b32_dpp v50, v66, v50, vcc quad_perm:[1,0,3,2] row_mask:0xf bank_mask:0xf
v_and_b32_e64 v201, s49, v201
v_mfma_f32_16x16x32_f16 v[164:167], v[0:3], v[236:239], v[164:167]
v_cndmask_b32_e64 v71, v51, v83, s[74:75]
v_and_b32 v203, s49, v203
v_pk_add_f16 v241, v241, 1.0 op_sel_hi:[1,0]
s_waitcnt lgkmcnt(6)
v_mfma_f32_16x16x32_bf16 v[180:183], v[4:7], v[208:211], v[180:183]
ds_read_b128 v[0:3], v248 offset:47104
v_cndmask_b32_dpp v51, v67, v51, vcc quad_perm:[1,0,3,2] row_mask:0xf bank_mask:0xf
s_not_b64 vcc, s[74:75]
v_bfe_u32 v200, v201, 2, 14
s_setprio 0
v_cndmask_b32_dpp v80, v64, v80, vcc quad_perm:[1,0,3,2] row_mask:0xf bank_mask:0xf
v_mfma_f32_16x16x32_bf16 v[188:191], v[4:7], v[212:215], v[188:191]
v_pk_add_f16 v206, v206, 1.0 op_sel_hi:[1,0]
v_cndmask_b32_dpp v81, v65, v81, vcc quad_perm:[1,0,3,2] row_mask:0xf bank_mask:0xf
v_bfe_u32 v202, v203, 2, 14
v_mfma_f32_16x16x32_bf16 v[176:179], v[40:43], v[32:35], v[176:179]
ds_read_b128 v[4:7], v249 offset:50176
ds_read_u16_d16 v200, v200
ds_read_u16_d16 v202, v202
v_rcp_f16_e64 v242, v241
v_cndmask_b32_dpp v82, v66, v82, vcc quad_perm:[1,0,3,2] row_mask:0xf bank_mask:0xf
v_mfma_f32_16x16x32_bf16 v[184:187], v[40:43], v[36:39], v[184:187]
v_cndmask_b32_dpp v83, v67, v83, vcc quad_perm:[1,0,3,2] row_mask:0xf bank_mask:0xf
v_lshrrev_b32 v201, 18, v201
v_lshrrev_b32 v203, 18, v203
v_mfma_f32_16x16x32_bf16 v[180:183], v[44:47], v[32:35], v[180:183]
ds_read_b128 v[40:43], v248 offset:47360
buffer_store_dwordx4 v[48:51], v255, s[8:11], s70 offen sc1
ds_read_u16_d16_hi v201, v201
ds_read_u16_d16_hi v203, v203
v_rcp_f16_e64 v207, v206
v_mfma_f32_16x16x32_bf16 v[188:191], v[44:47], v[36:39], v[188:191]
v_rcp_f16_sdwa v242, v241 dst_sel:WORD_1 dst_unused:UNUSED_PRESERVE src0_sel:WORD_1
v_or_b32 v232, v192, v193
v_or_b32 v233, v194, v195
s_waitcnt lgkmcnt(6)
v_or_b32 v234, v196, v197
v_rcp_f16_sdwa v207, v206 dst_sel:WORD_1 dst_unused:UNUSED_PRESERVE src0_sel:WORD_1
v_or_b32 v235, v198, v199
s_waitcnt lgkmcnt(1)
v_or_b32 v236, v200, v201
s_waitcnt lgkmcnt(0)
v_or_b32 v237, v202, v203
v_pk_mul_f16 v238, v243, v242
v_pk_mul_f16 v239, v240, v207
s_setprio 3
v_mfma_f32_16x16x32_f16 v[120:123], v[224:227], v[232:235], v[120:123]
buffer_store_dwordx4 v[68:71], v255, s[8:11], s70 offen offset:128 sc1
ds_read_b128 v[44:47], v249 offset:50432
v_cvt_pkrtz_f16_f32 v193, v176, v177
v_cvt_pkrtz_f16_f32 v195, v178, v179
v_mfma_f32_16x16x32_f16 v[128:131], v[224:227], v[236:239], v[128:131]
v_cvt_pkrtz_f16_f32 v197, v180, v181
v_cvt_pkrtz_f16_f32 v199, v182, v183
v_mfma_f32_16x16x32_f16 v[124:127], v[228:231], v[232:235], v[124:127]
ds_read_b128 v[224:227], v248 offset:48128
v_cvt_pkrtz_f16_f32 v201, v184, v185
v_cvt_pk_f16_f32 v243, v186, v187
v_cvt_pk_f16_f32 v240, v188, v189
v_mfma_f32_16x16x32_f16 v[132:135], v[228:231], v[236:239], v[132:135]
v_cvt_pk_f16_f32 v205, v190, v191
v_pk_fma_f16 v242, v243, v243, s48
v_mfma_f32_16x16x32_bf16 v[176:179], v[0:3], v[88:91], 0
ds_read_b128 v[228:231], v249 offset:51200
v_and_b32_e64 v193, s49, v193
v_pk_fma_f16 v207, v240, v240, s48
v_mfma_f32_16x16x32_bf16 v[184:187], v[0:3], v[92:95], 0
v_and_b32_e64 v195, s49, v195
v_pk_fma_f16 v204, v205, v205, s48
v_bfe_u32 v192, v193, 2, 14
v_mfma_f32_16x16x32_f16 v[136:139], v[4:7], v[232:235], v[136:139]
ds_read_b128 v[0:3], v249 offset:51456
ds_read_u16_d16 v192, v192
v_pk_mul_f16 v242, v243, v242
v_bfe_u32 v194, v195, 2, 14
v_mfma_f32_16x16x32_f16 v[144:147], v[4:7], v[236:239], v[144:147]
v_pk_mul_f16 v207, v240, v207
v_lshrrev_b32_e64 v193, 18, v193
v_mfma_f32_16x16x32_bf16 v[180:183], v[40:43], v[88:91], 0
ds_read_b128 v[4:7], v248 offset:48384
ds_read_u16_d16 v194, v194
ds_read_u16_d16_hi v193, v193
v_pk_mul_f16 v204, v205, v204
v_lshrrev_b32_e64 v195, 18, v195
v_mfma_f32_16x16x32_bf16 v[188:191], v[40:43], v[92:95], 0
v_exp_f16_e64 v241, v242
v_and_b32 v197, s49, v197
s_waitcnt lgkmcnt(6)
v_mfma_f32_16x16x32_f16 v[140:143], v[44:47], v[232:235], v[140:143]
ds_read_b128 v[40:43], v248 offset:49152
ds_read_u16_d16_hi v195, v195
v_and_b32_e64 v199, s49, v199
v_mfma_f32_16x16x32_f16 v[148:151], v[44:47], v[236:239], v[148:151]
v_exp_f16_e64 v206, v207
v_bfe_u32 v196, v197, 2, 14
v_bfe_u32 v198, v199, 2, 14
v_mfma_f32_16x16x32_bf16 v[176:179], v[224:227], v[208:211], v[176:179]
s_add_u32 s46, s80, 20971520
buffer_load_dwordx4 v[116:119], v253, s[32:35], s46 offen offset:256 nt
ds_read_b128 v[44:47], v248 offset:49408
ds_read_u16_d16 v196, v196
ds_read_u16_d16 v198, v198
v_exp_f16_e64 v203, v204
v_mfma_f32_16x16x32_bf16 v[184:187], v[224:227], v[212:215], v[184:187]
v_lshrrev_b32_e64 v197, 18, v197
v_lshrrev_b32 v199, 18, v199
s_waitcnt lgkmcnt(5)
v_mfma_f32_16x16x32_f16 v[152:155], v[228:231], v[232:235], v[152:155]
ds_read_b128 v[224:227], v249 offset:43008
ds_read_u16_d16_hi v197, v197
ds_read_u16_d16_hi v199, v199
v_exp_f16_sdwa v241, v242 dst_sel:WORD_1 dst_unused:UNUSED_PRESERVE src0_sel:WORD_1
v_and_b32_e64 v201, s49, v201
v_mfma_f32_16x16x32_f16 v[160:163], v[228:231], v[236:239], v[160:163]
v_bfe_u32 v200, v201, 2, 14
v_mfma_f32_16x16x32_f16 v[156:159], v[0:3], v[232:235], v[156:159]
ds_read_b128 v[228:231], v249 offset:43264
ds_read_u16_d16 v200, v200
v_exp_f16_sdwa v206, v207 dst_sel:WORD_1 dst_unused:UNUSED_PRESERVE src0_sel:WORD_1
v_lshrrev_b32_e64 v201, 18, v201
v_mfma_f32_16x16x32_f16 v[164:167], v[0:3], v[236:239], v[164:167]
v_exp_f16_sdwa v203, v204 dst_sel:WORD_1 dst_unused:UNUSED_PRESERVE src0_sel:WORD_1
v_pk_add_f16 v241, v241, 1.0 op_sel_hi:[1,0]
v_mfma_f32_16x16x32_bf16 v[180:183], v[4:7], v[208:211], v[180:183]
ds_read_b128 v[0:3], v248 offset:53248
ds_read_u16_d16_hi v201, v201
v_pk_add_f16 v206, v206, 1.0 op_sel_hi:[1,0]
v_pk_add_f16 v203, v203, 1.0 op_sel_hi:[1,0]
v_mfma_f32_16x16x32_bf16 v[188:191], v[4:7], v[212:215], v[188:191]
v_rcp_f16 v242, v241
s_waitcnt lgkmcnt(7)
v_mfma_f32_16x16x32_bf16 v[176:179], v[40:43], v[32:35], v[176:179]
ds_read_b128 v[4:7], v249 offset:44032
v_rcp_f16_e64 v207, v206
v_mfma_f32_16x16x32_bf16 v[184:187], v[40:43], v[36:39], v[184:187]
v_rcp_f16_e64 v204, v203
v_mfma_f32_16x16x32_bf16 v[180:183], v[44:47], v[32:35], v[180:183]
ds_read_b128 v[40:43], v248 offset:53504
v_rcp_f16_sdwa v242, v241 dst_sel:WORD_1 dst_unused:UNUSED_PRESERVE src0_sel:WORD_1
v_mfma_f32_16x16x32_bf16 v[188:191], v[44:47], v[36:39], v[188:191]
v_rcp_f16_sdwa v207, v206 dst_sel:WORD_1 dst_unused:UNUSED_PRESERVE src0_sel:WORD_1
v_or_b32 v232, v192, v193
v_or_b32 v233, v194, v195
s_waitcnt lgkmcnt(4)
v_or_b32 v234, v196, v197
v_rcp_f16_sdwa v204, v203 dst_sel:WORD_1 dst_unused:UNUSED_PRESERVE src0_sel:WORD_1
v_or_b32 v235, v198, v199
s_waitcnt lgkmcnt(2)
v_or_b32_e64 v236, v200, v201
v_pk_mul_f16 v237, v243, v242
v_pk_mul_f16 v238, v240, v207
v_pk_mul_f16 v239, v205, v204
v_mfma_f32_16x16x32_f16 v[120:123], v[224:227], v[232:235], v[120:123]
ds_read_b128 v[44:47], v249 offset:44288
v_cvt_pkrtz_f16_f32 v193, v176, v177
v_cvt_pkrtz_f16_f32 v195, v178, v179
v_mfma_f32_16x16x32_f16 v[128:131], v[224:227], v[236:239], v[128:131]
v_cvt_pkrtz_f16_f32 v197, v180, v181
v_cvt_pkrtz_f16_f32 v199, v182, v183
v_mfma_f32_16x16x32_f16 v[124:127], v[228:231], v[232:235], v[124:127]
ds_read_b128 v[224:227], v248 offset:54272
v_cvt_pkrtz_f16_f32 v201, v184, v185
v_cvt_pk_f16_f32 v243, v186, v187
v_cvt_pk_f16_f32 v240, v188, v189
v_mfma_f32_16x16x32_f16 v[132:135], v[228:231], v[236:239], v[132:135]
v_cvt_pk_f16_f32 v205, v190, v191
v_pk_fma_f16 v242, v243, v243, s48
v_mfma_f32_16x16x32_bf16 v[176:179], v[0:3], v[88:91], 0
ds_read_b128 v[228:231], v249 offset:45056
v_and_b32_e64 v193, s49, v193
v_pk_fma_f16 v207, v240, v240, s48
v_mfma_f32_16x16x32_bf16 v[184:187], v[0:3], v[92:95], 0
v_and_b32_e64 v195, s49, v195
v_pk_fma_f16 v204, v205, v205, s48
s_setprio 2
v_bfe_u32 v192, v193, 2, 14
s_waitcnt lgkmcnt(3)
v_mfma_f32_16x16x32_f16 v[136:139], v[4:7], v[232:235], v[136:139]
ds_read_b128 v[0:3], v249 offset:45312
ds_read_u16_d16 v192, v192
v_pk_mul_f16 v242, v243, v242
v_bfe_u32 v194, v195, 2, 14
v_mfma_f32_16x16x32_f16 v[144:147], v[4:7], v[236:239], v[144:147]
v_pk_mul_f16 v207, v240, v207
v_lshrrev_b32_e64 v193, 18, v193
v_mfma_f32_16x16x32_bf16 v[180:183], v[40:43], v[88:91], 0
ds_read_b128 v[4:7], v248 offset:54528
ds_read_u16_d16 v194, v194
ds_read_u16_d16_hi v193, v193
v_pk_mul_f16 v204, v205, v204
v_lshrrev_b32_e64 v195, 18, v195
v_mfma_f32_16x16x32_bf16 v[188:191], v[40:43], v[92:95], 0
v_exp_f16_e64 v241, v242
v_and_b32 v197, s49, v197
s_waitcnt lgkmcnt(5)
v_mfma_f32_16x16x32_f16 v[140:143], v[44:47], v[232:235], v[140:143]
ds_read_b128 v[40:43], v248 offset:55296
ds_read_u16_d16_hi v195, v195
v_and_b32_e64 v199, s49, v199
v_mfma_f32_16x16x32_f16 v[148:151], v[44:47], v[236:239], v[148:151]
v_exp_f16_e64 v206, v207
v_bfe_u32 v196, v197, 2, 14
v_bfe_u32 v198, v199, 2, 14
v_mfma_f32_16x16x32_bf16 v[176:179], v[224:227], v[208:211], v[176:179]
ds_read_b128 v[44:47], v248 offset:55552
ds_read_u16_d16 v196, v196
ds_read_u16_d16 v198, v198
v_exp_f16_e64 v203, v204
v_mfma_f32_16x16x32_bf16 v[184:187], v[224:227], v[212:215], v[184:187]
v_lshrrev_b32 v197, 18, v197
v_lshrrev_b32 v199, 18, v199
v_mfma_f32_16x16x32_f16 v[152:155], v[228:231], v[232:235], v[152:155]
ds_read_b128 v[224:227], v249 offset:55296
ds_read_u16_d16_hi v197, v197
ds_read_u16_d16_hi v199, v199
v_exp_f16_sdwa v241, v242 dst_sel:WORD_1 dst_unused:UNUSED_PRESERVE src0_sel:WORD_1
v_and_b32 v201, s49, v201
v_mfma_f32_16x16x32_f16 v[160:163], v[228:231], v[236:239], v[160:163]
v_bfe_u32 v200, v201, 2, 14
s_waitcnt lgkmcnt(8)
v_mfma_f32_16x16x32_f16 v[156:159], v[0:3], v[232:235], v[156:159]
ds_read_b128 v[228:231], v249 offset:55552
ds_read_u16_d16 v200, v200
v_exp_f16_sdwa v206, v207 dst_sel:WORD_1 dst_unused:UNUSED_PRESERVE src0_sel:WORD_1
v_lshrrev_b32_e64 v201, 18, v201
v_mfma_f32_16x16x32_f16 v[164:167], v[0:3], v[236:239], v[164:167]
v_exp_f16_sdwa v203, v204 dst_sel:WORD_1 dst_unused:UNUSED_PRESERVE src0_sel:WORD_1
v_pk_add_f16 v241, v241, 1.0 op_sel_hi:[1,0]
v_mfma_f32_16x16x32_bf16 v[180:183], v[4:7], v[208:211], v[180:183]
ds_read_b128 v[0:3], v248 offset:59392
ds_read_u16_d16_hi v201, v201
v_pk_add_f16 v206, v206, 1.0 op_sel_hi:[1,0]
v_pk_add_f16 v203, v203, 1.0 op_sel_hi:[1,0]
v_mfma_f32_16x16x32_bf16 v[188:191], v[4:7], v[212:215], v[188:191]
v_rcp_f16 v242, v241
s_waitcnt lgkmcnt(7)
v_mfma_f32_16x16x32_bf16 v[176:179], v[40:43], v[32:35], v[176:179]
ds_read_b128 v[4:7], v249 offset:56320
v_rcp_f16_e64 v207, v206
v_mfma_f32_16x16x32_bf16 v[184:187], v[40:43], v[36:39], v[184:187]
v_rcp_f16_e64 v204, v203
v_mfma_f32_16x16x32_bf16 v[180:183], v[44:47], v[32:35], v[180:183]
ds_read_b128 v[40:43], v248 offset:59648
v_rcp_f16_sdwa v242, v241 dst_sel:WORD_1 dst_unused:UNUSED_PRESERVE src0_sel:WORD_1
v_mfma_f32_16x16x32_bf16 v[188:191], v[44:47], v[36:39], v[188:191]
v_rcp_f16_sdwa v207, v206 dst_sel:WORD_1 dst_unused:UNUSED_PRESERVE src0_sel:WORD_1
v_or_b32 v232, v192, v193
v_or_b32 v233, v194, v195
s_waitcnt lgkmcnt(4)
v_or_b32 v234, v196, v197
v_rcp_f16_sdwa v204, v203 dst_sel:WORD_1 dst_unused:UNUSED_PRESERVE src0_sel:WORD_1
v_or_b32 v235, v198, v199
s_waitcnt lgkmcnt(2)
v_or_b32_e64 v236, v200, v201
v_pk_mul_f16 v237, v243, v242
v_pk_mul_f16 v238, v240, v207
v_pk_mul_f16 v239, v205, v204
v_mfma_f32_16x16x32_f16 v[120:123], v[224:227], v[232:235], v[120:123]
buffer_load_dwordx4 v[244:247], v252, s[4:7], s68 offen
ds_read_b128 v[44:47], v249 offset:56576
v_cvt_pkrtz_f16_f32 v193, v176, v177
v_cvt_pkrtz_f16_f32 v195, v178, v179
v_mfma_f32_16x16x32_f16 v[128:131], v[224:227], v[236:239], v[128:131]
v_cvt_pkrtz_f16_f32 v197, v180, v181
v_cvt_pkrtz_f16_f32 v199, v182, v183
v_mfma_f32_16x16x32_f16 v[124:127], v[228:231], v[232:235], v[124:127]
ds_read_b128 v[224:227], v248 offset:60416
v_cvt_pkrtz_f16_f32 v201, v184, v185
v_cvt_pk_f16_f32 v243, v186, v187
v_cvt_pk_f16_f32 v240, v188, v189
v_mfma_f32_16x16x32_f16 v[132:135], v[228:231], v[236:239], v[132:135]
v_cvt_pk_f16_f32 v205, v190, v191
s_setprio 1
v_pk_fma_f16 v242, v243, v243, s48
v_mfma_f32_16x16x32_bf16 v[176:179], v[0:3], v[88:91], 0
ds_read_b128 v[228:231], v249 offset:57344
v_and_b32 v193, s49, v193
v_pk_fma_f16 v207, v240, v240, s48
v_mfma_f32_16x16x32_bf16 v[184:187], v[0:3], v[92:95], 0
v_and_b32 v195, s49, v195
v_pk_fma_f16 v204, v205, v205, s48
v_bfe_u32 v192, v193, 2, 14
s_waitcnt lgkmcnt(3)
v_mfma_f32_16x16x32_f16 v[136:139], v[4:7], v[232:235], v[136:139]
ds_read_b128 v[0:3], v249 offset:57600
ds_read_u16_d16 v192, v192
v_pk_mul_f16 v242, v243, v242
v_bfe_u32 v194, v195, 2, 14
v_mfma_f32_16x16x32_f16 v[144:147], v[4:7], v[236:239], v[144:147]
v_pk_mul_f16 v207, v240, v207
v_lshrrev_b32_e64 v193, 18, v193
v_mfma_f32_16x16x32_bf16 v[180:183], v[40:43], v[88:91], 0
ds_read_b128 v[4:7], v248 offset:60672
ds_read_u16_d16 v194, v194
ds_read_u16_d16_hi v193, v193
v_pk_mul_f16 v204, v205, v204
v_lshrrev_b32_e64 v195, 18, v195
v_mfma_f32_16x16x32_bf16 v[188:191], v[40:43], v[92:95], 0
v_exp_f16_e64 v241, v242
v_and_b32 v197, s49, v197
s_waitcnt lgkmcnt(5)
v_mfma_f32_16x16x32_f16 v[140:143], v[44:47], v[232:235], v[140:143]
ds_read_b128 v[40:43], v248 offset:61440
ds_read_u16_d16_hi v195, v195
v_and_b32_e64 v199, s49, v199
v_mfma_f32_16x16x32_f16 v[148:151], v[44:47], v[236:239], v[148:151]
v_exp_f16_e64 v206, v207
v_bfe_u32 v196, v197, 2, 14
v_bfe_u32 v198, v199, 2, 14
v_mfma_f32_16x16x32_bf16 v[176:179], v[224:227], v[208:211], v[176:179]
buffer_store_dwordx4 v[80:83], v255, s[8:11], s70 offen offset:256 sc1
ds_read_b128 v[44:47], v248 offset:61696
ds_read_u16_d16 v196, v196
ds_read_u16_d16 v198, v198
v_exp_f16_e64 v203, v204
v_mfma_f32_16x16x32_bf16 v[184:187], v[224:227], v[212:215], v[184:187]
v_lshrrev_b32 v197, 18, v197
v_lshrrev_b32 v199, 18, v199
v_mfma_f32_16x16x32_f16 v[152:155], v[228:231], v[232:235], v[152:155]
ds_read_b128 v[224:227], v249 offset:61440
ds_read_u16_d16_hi v197, v197
ds_read_u16_d16_hi v199, v199
v_exp_f16_sdwa v241, v242 dst_sel:WORD_1 dst_unused:UNUSED_PRESERVE src0_sel:WORD_1
v_and_b32 v201, s49, v201
v_mfma_f32_16x16x32_f16 v[160:163], v[228:231], v[236:239], v[160:163]
v_bfe_u32 v200, v201, 2, 14
s_waitcnt lgkmcnt(8)
v_mfma_f32_16x16x32_f16 v[156:159], v[0:3], v[232:235], v[156:159]
ds_read_b128 v[228:231], v249 offset:61696
ds_read_u16_d16 v200, v200
v_exp_f16_sdwa v206, v207 dst_sel:WORD_1 dst_unused:UNUSED_PRESERVE src0_sel:WORD_1
v_lshrrev_b32_e64 v201, 18, v201
v_mfma_f32_16x16x32_f16 v[164:167], v[0:3], v[236:239], v[164:167]
v_exp_f16_sdwa v203, v204 dst_sel:WORD_1 dst_unused:UNUSED_PRESERVE src0_sel:WORD_1
v_pk_add_f16 v241, v241, 1.0 op_sel_hi:[1,0]
v_mfma_f32_16x16x32_bf16 v[180:183], v[4:7], v[208:211], v[180:183]
ds_read_b128 v[0:3], v249
ds_read_u16_d16_hi v201, v201
v_pk_add_f16 v206, v206, 1.0 op_sel_hi:[1,0]
v_pk_add_f16 v203, v203, 1.0 op_sel_hi:[1,0]
v_mfma_f32_16x16x32_bf16 v[188:191], v[4:7], v[212:215], v[188:191]
v_rcp_f16_e64 v242, v241
s_setprio 0
s_waitcnt lgkmcnt(7)
v_mfma_f32_16x16x32_bf16 v[176:179], v[40:43], v[32:35], v[176:179]
ds_read_b128 v[4:7], v249 offset:62464
v_rcp_f16_e64 v207, v206
v_mfma_f32_16x16x32_bf16 v[184:187], v[40:43], v[36:39], v[184:187]
v_rcp_f16_e64 v204, v203
v_mfma_f32_16x16x32_bf16 v[180:183], v[44:47], v[32:35], v[180:183]
ds_read_b128 v[40:43], v249 offset:256
v_rcp_f16_sdwa v242, v241 dst_sel:WORD_1 dst_unused:UNUSED_PRESERVE src0_sel:WORD_1
v_mfma_f32_16x16x32_bf16 v[188:191], v[44:47], v[36:39], v[188:191]
v_rcp_f16_sdwa v207, v206 dst_sel:WORD_1 dst_unused:UNUSED_PRESERVE src0_sel:WORD_1
v_or_b32 v232, v192, v193
v_or_b32 v233, v194, v195
s_waitcnt lgkmcnt(4)
v_or_b32 v234, v196, v197
v_rcp_f16_sdwa v204, v203 dst_sel:WORD_1 dst_unused:UNUSED_PRESERVE src0_sel:WORD_1
v_or_b32 v235, v198, v199
s_waitcnt lgkmcnt(2)
v_or_b32 v236, v200, v201
v_pk_mul_f16 v237, v243, v242
v_pk_mul_f16 v238, v240, v207
v_pk_mul_f16 v239, v205, v204
s_setprio 3
v_mfma_f32_16x16x32_f16 v[120:123], v[224:227], v[232:235], v[120:123]
buffer_load_dwordx4 v[216:219], v252, s[4:7], s68 offen offset:64
ds_read_b128 v[44:47], v249 offset:62720
v_cvt_pkrtz_f16_f32 v193, v176, v177
v_cvt_pkrtz_f16_f32 v195, v178, v179
v_mfma_f32_16x16x32_f16 v[128:131], v[224:227], v[236:239], v[128:131]
v_cvt_pkrtz_f16_f32 v197, v180, v181
v_cvt_pkrtz_f16_f32 v199, v182, v183
v_mfma_f32_16x16x32_f16 v[124:127], v[228:231], v[232:235], v[124:127]
ds_read_b128 v[224:227], v249 offset:1024
v_cvt_pkrtz_f16_f32 v201, v184, v185
v_cvt_pk_f16_f32 v243, v186, v187
v_cvt_pk_f16_f32 v240, v188, v189
v_mfma_f32_16x16x32_f16 v[132:135], v[228:231], v[236:239], v[132:135]
v_cvt_pk_f16_f32 v205, v190, v191
v_pk_fma_f16 v242, v243, v243, s48
v_mfma_f32_16x16x32_bf16 v[176:179], v[0:3], v[88:91], 0
ds_read_b128 v[228:231], v249 offset:63488
v_and_b32_e64 v193, s49, v193
v_pk_fma_f16 v207, v240, v240, s48
v_mfma_f32_16x16x32_bf16 v[184:187], v[0:3], v[92:95], 0
v_and_b32 v195, s49, v195
v_pk_fma_f16 v204, v205, v205, s48
v_bfe_u32 v192, v193, 2, 14
s_waitcnt lgkmcnt(3)
v_mfma_f32_16x16x32_f16 v[136:139], v[4:7], v[232:235], v[136:139]
ds_read_b128 v[0:3], v249 offset:63744
ds_read_u16_d16 v192, v192
v_pk_mul_f16 v242, v243, v242
v_bfe_u32 v194, v195, 2, 14
v_mfma_f32_16x16x32_f16 v[144:147], v[4:7], v[236:239], v[144:147]
v_pk_mul_f16 v207, v240, v207
v_lshrrev_b32_e64 v193, 18, v193
v_mfma_f32_16x16x32_bf16 v[180:183], v[40:43], v[88:91], 0
ds_read_b128 v[4:7], v249 offset:1280
ds_read_u16_d16 v194, v194
ds_read_u16_d16_hi v193, v193
v_pk_mul_f16 v204, v205, v204
v_lshrrev_b32_e64 v195, 18, v195
v_mfma_f32_16x16x32_bf16 v[188:191], v[40:43], v[92:95], 0
v_exp_f16_e64 v241, v242
v_and_b32 v197, s49, v197
s_waitcnt lgkmcnt(5)
v_mfma_f32_16x16x32_f16 v[140:143], v[44:47], v[232:235], v[140:143]
ds_read_b128 v[40:43], v249 offset:2048
ds_read_u16_d16_hi v195, v195
v_and_b32_e64 v199, s49, v199
v_mfma_f32_16x16x32_f16 v[148:151], v[44:47], v[236:239], v[148:151]
v_exp_f16_e64 v206, v207
v_bfe_u32 v196, v197, 2, 14
v_bfe_u32 v198, v199, 2, 14
v_mfma_f32_16x16x32_bf16 v[176:179], v[224:227], v[208:211], v[176:179]
ds_read_b128 v[44:47], v249 offset:2304
ds_read_u16_d16 v196, v196
ds_read_u16_d16 v198, v198
v_exp_f16_e64 v203, v204
v_mfma_f32_16x16x32_bf16 v[184:187], v[224:227], v[212:215], v[184:187]
v_lshrrev_b32 v197, 18, v197
v_lshrrev_b32 v199, 18, v199
v_mfma_f32_16x16x32_f16 v[152:155], v[228:231], v[232:235], v[152:155]
ds_read_b128 v[224:227], v250 offset:2048
ds_read_u16_d16_hi v197, v197
ds_read_u16_d16_hi v199, v199
v_exp_f16_sdwa v241, v242 dst_sel:WORD_1 dst_unused:UNUSED_PRESERVE src0_sel:WORD_1
v_and_b32 v201, s49, v201
v_mfma_f32_16x16x32_f16 v[160:163], v[228:231], v[236:239], v[160:163]
v_bfe_u32 v200, v201, 2, 14
s_waitcnt lgkmcnt(8)
v_mfma_f32_16x16x32_f16 v[156:159], v[0:3], v[232:235], v[156:159]
ds_read_b128 v[228:231], v250 offset:2304
ds_read_u16_d16 v200, v200
v_exp_f16_sdwa v206, v207 dst_sel:WORD_1 dst_unused:UNUSED_PRESERVE src0_sel:WORD_1
v_lshrrev_b32_e64 v201, 18, v201
v_mfma_f32_16x16x32_f16 v[164:167], v[0:3], v[236:239], v[164:167]
v_exp_f16_sdwa v203, v204 dst_sel:WORD_1 dst_unused:UNUSED_PRESERVE src0_sel:WORD_1
v_pk_add_f16 v241, v241, 1.0 op_sel_hi:[1,0]
v_mfma_f32_16x16x32_bf16 v[180:183], v[4:7], v[208:211], v[180:183]
ds_read_b128 v[0:3], v249 offset:6144
ds_read_u16_d16_hi v201, v201
v_pk_add_f16 v206, v206, 1.0 op_sel_hi:[1,0]
v_pk_add_f16 v203, v203, 1.0 op_sel_hi:[1,0]
v_mfma_f32_16x16x32_bf16 v[188:191], v[4:7], v[212:215], v[188:191]
v_rcp_f16 v242, v241
s_waitcnt lgkmcnt(7)
v_mfma_f32_16x16x32_bf16 v[176:179], v[40:43], v[32:35], v[176:179]
ds_read_b128 v[4:7], v250 offset:3072
v_rcp_f16_e64 v207, v206
v_mfma_f32_16x16x32_bf16 v[184:187], v[40:43], v[36:39], v[184:187]
v_rcp_f16_e64 v204, v203
v_mfma_f32_16x16x32_bf16 v[180:183], v[44:47], v[32:35], v[180:183]
ds_read_b128 v[40:43], v249 offset:6400
v_rcp_f16_sdwa v242, v241 dst_sel:WORD_1 dst_unused:UNUSED_PRESERVE src0_sel:WORD_1
v_mfma_f32_16x16x32_bf16 v[188:191], v[44:47], v[36:39], v[188:191]
v_rcp_f16_sdwa v207, v206 dst_sel:WORD_1 dst_unused:UNUSED_PRESERVE src0_sel:WORD_1
v_or_b32 v232, v192, v193
v_or_b32 v233, v194, v195
s_waitcnt lgkmcnt(4)
v_or_b32 v234, v196, v197
v_rcp_f16_sdwa v204, v203 dst_sel:WORD_1 dst_unused:UNUSED_PRESERVE src0_sel:WORD_1
v_or_b32 v235, v198, v199
s_waitcnt lgkmcnt(2)
v_or_b32_e64 v236, v200, v201
v_pk_mul_f16 v237, v243, v242
v_pk_mul_f16 v238, v240, v207
v_pk_mul_f16 v239, v205, v204
v_mfma_f32_16x16x32_f16 v[120:123], v[224:227], v[232:235], v[120:123]
ds_read_b128 v[44:47], v250 offset:3328
v_cvt_pkrtz_f16_f32 v193, v176, v177
v_cvt_pkrtz_f16_f32 v195, v178, v179
v_cvt_pkrtz_f16_f32 v197, v180, v181
v_mfma_f32_16x16x32_f16 v[128:131], v[224:227], v[236:239], v[128:131]
v_cvt_pkrtz_f16_f32 v199, v182, v183
v_cvt_pkrtz_f16_f32 v201, v184, v185
v_cvt_pkrtz_f16_f32 v203, v186, v187
v_mfma_f32_16x16x32_f16 v[124:127], v[228:231], v[232:235], v[124:127]
ds_read_b128 v[224:227], v249 offset:7168
v_cvt_pk_f16_f32 v243, v188, v189
v_cvt_pk_f16_f32 v240, v190, v191
v_pk_fma_f16 v242, v243, v243, s48
v_mfma_f32_16x16x32_f16 v[132:135], v[228:231], v[236:239], v[132:135]
v_cvt_pk_bf16_f32 v72, v72, v73
v_and_b32_e64 v193, s49, v193
v_cvt_pk_bf16_f32 v73, v74, v75
v_mfma_f32_16x16x32_bf16 v[176:179], v[0:3], v[88:91], 0
ds_read_b128 v[228:231], v250 offset:4096
v_and_b32_e64 v195, s49, v195
v_cvt_pk_bf16_f32 v74, v76, v77
v_pk_fma_f16 v207, v240, v240, s48
v_mfma_f32_16x16x32_bf16 v[184:187], v[0:3], v[92:95], 0
v_bfe_u32 v192, v193, 2, 14
s_setprio 2
v_cvt_pk_bf16_f32 v75, v78, v79
v_pk_mul_f16 v242, v243, v242
s_waitcnt lgkmcnt(2)
v_mfma_f32_16x16x32_f16 v[136:139], v[4:7], v[232:235], v[136:139]
ds_read_b128 v[0:3], v250 offset:4352
ds_read_u16_d16 v192, v192
v_cvt_pk_bf16_f32 v56, v56, v57
v_bfe_u32 v194, v195, 2, 14
v_cvt_pk_bf16_f32 v57, v58, v59
v_mfma_f32_16x16x32_f16 v[144:147], v[4:7], v[236:239], v[144:147]
v_pk_mul_f16 v207, v240, v207
v_lshrrev_b32_e64 v193, 18, v193
v_cvt_pk_bf16_f32 v58, v60, v61
v_mfma_f32_16x16x32_bf16 v[180:183], v[40:43], v[88:91], 0
ds_read_b128 v[4:7], v249 offset:7424
ds_read_u16_d16 v194, v194
ds_read_u16_d16_hi v193, v193
v_exp_f16_e64 v241, v242
v_cvt_pk_bf16_f32 v59, v62, v63
v_mfma_f32_16x16x32_bf16 v[188:191], v[40:43], v[92:95], 0
v_lshrrev_b32_e64 v195, 18, v195
v_cvt_pk_bf16_f32 v168, v168, v169
v_and_b32_e64 v197, s49, v197
v_mfma_f32_16x16x32_f16 v[140:143], v[44:47], v[232:235], v[140:143]
ds_read_b128 v[40:43], v249 offset:8192
ds_read_u16_d16_hi v195, v195
v_cvt_pk_bf16_f32 v169, v170, v171
v_exp_f16_e64 v206, v207
v_mfma_f32_16x16x32_f16 v[148:151], v[44:47], v[236:239], v[148:151]
v_cvt_pk_bf16_f32 v170, v172, v173
v_and_b32_e64 v199, s49, v199
v_cvt_pk_bf16_f32 v171, v174, v175
s_mov_b64 vcc, s[74:75]
s_waitcnt lgkmcnt(5)
v_mfma_f32_16x16x32_bf16 v[176:179], v[224:227], v[208:211], v[176:179]
ds_read_b128 v[44:47], v249 offset:8448
v_bfe_u32 v196, v197, 2, 14
v_cndmask_b32_e64 v76, v56, v168, s[74:75]
v_mfma_f32_16x16x32_bf16 v[184:187], v[224:227], v[212:215], v[184:187]
v_exp_f16_sdwa v241, v242 dst_sel:WORD_1 dst_unused:UNUSED_PRESERVE src0_sel:WORD_1
v_cndmask_b32_dpp v56, v72, v56, vcc quad_perm:[1,0,3,2] row_mask:0xf bank_mask:0xf
v_bfe_u32 v198, v199, 2, 14
v_mfma_f32_16x16x32_f16 v[152:155], v[228:231], v[232:235], v[152:155]
ds_read_b128 v[224:227], v250 offset:8192
ds_read_u16_d16 v196, v196
ds_read_u16_d16 v198, v198
v_cndmask_b32_e64 v77, v57, v169, s[74:75]
v_lshrrev_b32_e64 v197, 18, v197
v_cndmask_b32_dpp v57, v73, v57, vcc quad_perm:[1,0,3,2] row_mask:0xf bank_mask:0xf
v_mfma_f32_16x16x32_f16 v[160:163], v[228:231], v[236:239], v[160:163]
v_lshrrev_b32_e64 v199, 18, v199
v_exp_f16_sdwa v206, v207 dst_sel:WORD_1 dst_unused:UNUSED_PRESERVE src0_sel:WORD_1
v_mfma_f32_16x16x32_f16 v[156:159], v[0:3], v[232:235], v[156:159]
ds_read_b128 v[228:231], v250 offset:8448
ds_read_u16_d16_hi v197, v197
ds_read_u16_d16_hi v199, v199
v_cndmask_b32_e64 v78, v58, v170, s[74:75]
v_cndmask_b32_dpp v58, v74, v58, vcc quad_perm:[1,0,3,2] row_mask:0xf bank_mask:0xf
v_and_b32_e64 v201, s49, v201
v_mfma_f32_16x16x32_f16 v[164:167], v[0:3], v[236:239], v[164:167]
v_cndmask_b32_e64 v79, v59, v171, s[74:75]
v_and_b32_e64 v203, s49, v203
v_pk_add_f16 v241, v241, 1.0 op_sel_hi:[1,0]
s_waitcnt lgkmcnt(6)
v_mfma_f32_16x16x32_bf16 v[180:183], v[4:7], v[208:211], v[180:183]
ds_read_b128 v[0:3], v249 offset:12288
v_cndmask_b32_dpp v59, v75, v59, vcc quad_perm:[1,0,3,2] row_mask:0xf bank_mask:0xf
s_not_b64 vcc, s[74:75]
v_bfe_u32 v200, v201, 2, 14
v_cndmask_b32_dpp v168, v72, v168, vcc quad_perm:[1,0,3,2] row_mask:0xf bank_mask:0xf
v_mfma_f32_16x16x32_bf16 v[188:191], v[4:7], v[212:215], v[188:191]
v_pk_add_f16 v206, v206, 1.0 op_sel_hi:[1,0]
v_cndmask_b32_dpp v169, v73, v169, vcc quad_perm:[1,0,3,2] row_mask:0xf bank_mask:0xf
v_bfe_u32 v202, v203, 2, 14
v_mfma_f32_16x16x32_bf16 v[176:179], v[40:43], v[32:35], v[176:179]
ds_read_b128 v[4:7], v250 offset:9216
ds_read_u16_d16 v200, v200
ds_read_u16_d16 v202, v202
v_rcp_f16_e64 v242, v241
v_cndmask_b32_dpp v170, v74, v170, vcc quad_perm:[1,0,3,2] row_mask:0xf bank_mask:0xf
v_mfma_f32_16x16x32_bf16 v[184:187], v[40:43], v[36:39], v[184:187]
v_cndmask_b32_dpp v171, v75, v171, vcc quad_perm:[1,0,3,2] row_mask:0xf bank_mask:0xf
v_lshrrev_b32 v201, 18, v201
v_lshrrev_b32 v203, 18, v203
v_mfma_f32_16x16x32_bf16 v[180:183], v[44:47], v[32:35], v[180:183]
ds_read_b128 v[40:43], v249 offset:12544
s_add_u32 s46, s70, 98304
buffer_store_dwordx4 v[56:59], v255, s[8:11], s46 offen sc1
ds_read_u16_d16_hi v201, v201
ds_read_u16_d16_hi v203, v203
v_rcp_f16_e64 v207, v206
v_mfma_f32_16x16x32_bf16 v[188:191], v[44:47], v[36:39], v[188:191]
v_rcp_f16_sdwa v242, v241 dst_sel:WORD_1 dst_unused:UNUSED_PRESERVE src0_sel:WORD_1
v_or_b32 v232, v192, v193
v_or_b32 v233, v194, v195
s_waitcnt lgkmcnt(6)
v_or_b32 v234, v196, v197
v_rcp_f16_sdwa v207, v206 dst_sel:WORD_1 dst_unused:UNUSED_PRESERVE src0_sel:WORD_1
v_or_b32 v235, v198, v199
s_waitcnt lgkmcnt(1)
v_or_b32 v236, v200, v201
s_waitcnt lgkmcnt(0)
v_or_b32_e64 v237, v202, v203
v_pk_mul_f16 v238, v243, v242
v_pk_mul_f16 v239, v240, v207
v_mfma_f32_16x16x32_f16 v[120:123], v[224:227], v[232:235], v[120:123]
buffer_load_dwordx4 v[12:15], v252, s[4:7], s68 offen offset:128
ds_read_b128 v[44:47], v250 offset:9472
v_cvt_pkrtz_f16_f32 v193, v176, v177
v_cvt_pkrtz_f16_f32 v195, v178, v179
v_mfma_f32_16x16x32_f16 v[128:131], v[224:227], v[236:239], v[128:131]
v_cvt_pkrtz_f16_f32 v197, v180, v181
v_cvt_pkrtz_f16_f32 v199, v182, v183
v_mfma_f32_16x16x32_f16 v[124:127], v[228:231], v[232:235], v[124:127]
ds_read_b128 v[224:227], v249 offset:13312
v_cvt_pkrtz_f16_f32 v201, v184, v185
v_cvt_pk_f16_f32 v243, v186, v187
v_cvt_pk_f16_f32 v240, v188, v189
v_mfma_f32_16x16x32_f16 v[132:135], v[228:231], v[236:239], v[132:135]
v_cvt_pk_f16_f32 v205, v190, v191
s_setprio 1
v_pk_fma_f16 v242, v243, v243, s48
v_mfma_f32_16x16x32_bf16 v[176:179], v[0:3], v[88:91], 0
ds_read_b128 v[228:231], v250 offset:10240
v_and_b32 v193, s49, v193
v_pk_fma_f16 v207, v240, v240, s48
v_mfma_f32_16x16x32_bf16 v[184:187], v[0:3], v[92:95], 0
v_and_b32_e64 v195, s49, v195
v_pk_fma_f16 v204, v205, v205, s48
v_bfe_u32 v192, v193, 2, 14
v_mfma_f32_16x16x32_f16 v[136:139], v[4:7], v[232:235], v[136:139]
ds_read_b128 v[0:3], v250 offset:10496
ds_read_u16_d16 v192, v192
v_pk_mul_f16 v242, v243, v242
v_bfe_u32 v194, v195, 2, 14
v_mfma_f32_16x16x32_f16 v[144:147], v[4:7], v[236:239], v[144:147]
v_pk_mul_f16 v207, v240, v207
v_lshrrev_b32_e64 v193, 18, v193
v_mfma_f32_16x16x32_bf16 v[180:183], v[40:43], v[88:91], 0
ds_read_b128 v[4:7], v249 offset:13568
ds_read_u16_d16 v194, v194
ds_read_u16_d16_hi v193, v193
v_pk_mul_f16 v204, v205, v204
v_lshrrev_b32_e64 v195, 18, v195
v_mfma_f32_16x16x32_bf16 v[188:191], v[40:43], v[92:95], 0
v_exp_f16_e64 v241, v242
v_and_b32 v197, s49, v197
s_waitcnt lgkmcnt(6)
v_mfma_f32_16x16x32_f16 v[140:143], v[44:47], v[232:235], v[140:143]
ds_read_b128 v[40:43], v249 offset:14336
ds_read_u16_d16_hi v195, v195
v_and_b32_e64 v199, s49, v199
v_mfma_f32_16x16x32_f16 v[148:151], v[44:47], v[236:239], v[148:151]
v_exp_f16_e64 v206, v207
v_bfe_u32 v196, v197, 2, 14
v_bfe_u32 v198, v199, 2, 14
v_mfma_f32_16x16x32_bf16 v[176:179], v[224:227], v[208:211], v[176:179]
ds_read_b128 v[44:47], v249 offset:14592
ds_read_u16_d16 v196, v196
ds_read_u16_d16 v198, v198
v_exp_f16_e64 v203, v204
v_mfma_f32_16x16x32_bf16 v[184:187], v[224:227], v[212:215], v[184:187]
v_lshrrev_b32_e64 v197, 18, v197
v_lshrrev_b32 v199, 18, v199
s_waitcnt lgkmcnt(7)
v_mfma_f32_16x16x32_f16 v[152:155], v[228:231], v[232:235], v[152:155]
ds_read_b128 v[224:227], v250 offset:14336
ds_read_u16_d16_hi v197, v197
ds_read_u16_d16_hi v199, v199
v_exp_f16_sdwa v241, v242 dst_sel:WORD_1 dst_unused:UNUSED_PRESERVE src0_sel:WORD_1
v_and_b32_e64 v201, s49, v201
v_mfma_f32_16x16x32_f16 v[160:163], v[228:231], v[236:239], v[160:163]
v_bfe_u32 v200, v201, 2, 14
v_mfma_f32_16x16x32_f16 v[156:159], v[0:3], v[232:235], v[156:159]
ds_read_b128 v[228:231], v250 offset:14592
ds_read_u16_d16 v200, v200
v_exp_f16_sdwa v206, v207 dst_sel:WORD_1 dst_unused:UNUSED_PRESERVE src0_sel:WORD_1
v_lshrrev_b32_e64 v201, 18, v201
v_mfma_f32_16x16x32_f16 v[164:167], v[0:3], v[236:239], v[164:167]
v_exp_f16_sdwa v203, v204 dst_sel:WORD_1 dst_unused:UNUSED_PRESERVE src0_sel:WORD_1
v_pk_add_f16 v241, v241, 1.0 op_sel_hi:[1,0]
v_mfma_f32_16x16x32_bf16 v[180:183], v[4:7], v[208:211], v[180:183]
ds_read_b128 v[0:3], v249 offset:18432
ds_read_u16_d16_hi v201, v201
v_pk_add_f16 v206, v206, 1.0 op_sel_hi:[1,0]
v_pk_add_f16 v203, v203, 1.0 op_sel_hi:[1,0]
v_mfma_f32_16x16x32_bf16 v[188:191], v[4:7], v[212:215], v[188:191]
v_rcp_f16_e64 v242, v241
s_setprio 0
s_waitcnt lgkmcnt(7)
v_mfma_f32_16x16x32_bf16 v[176:179], v[40:43], v[32:35], v[176:179]
ds_read_b128 v[4:7], v250 offset:15360
v_rcp_f16_e64 v207, v206
v_mfma_f32_16x16x32_bf16 v[184:187], v[40:43], v[36:39], v[184:187]
v_rcp_f16_e64 v204, v203
v_mfma_f32_16x16x32_bf16 v[180:183], v[44:47], v[32:35], v[180:183]
ds_read_b128 v[40:43], v249 offset:18688
v_rcp_f16_sdwa v242, v241 dst_sel:WORD_1 dst_unused:UNUSED_PRESERVE src0_sel:WORD_1
v_mfma_f32_16x16x32_bf16 v[188:191], v[44:47], v[36:39], v[188:191]
v_rcp_f16_sdwa v207, v206 dst_sel:WORD_1 dst_unused:UNUSED_PRESERVE src0_sel:WORD_1
v_or_b32 v232, v192, v193
v_or_b32 v233, v194, v195
s_waitcnt lgkmcnt(4)
v_or_b32 v234, v196, v197
v_rcp_f16_sdwa v204, v203 dst_sel:WORD_1 dst_unused:UNUSED_PRESERVE src0_sel:WORD_1
v_or_b32 v235, v198, v199
s_waitcnt lgkmcnt(2)
v_or_b32 v236, v200, v201
v_pk_mul_f16 v237, v243, v242
v_pk_mul_f16 v238, v240, v207
v_pk_mul_f16 v239, v205, v204
s_setprio 3
v_mfma_f32_16x16x32_f16 v[120:123], v[224:227], v[232:235], v[120:123]
s_add_u32 s46, s68, 98304
buffer_load_dwordx4 v[8:11], v252, s[4:7], s46 offen
ds_read_b128 v[44:47], v250 offset:15616
v_cvt_pkrtz_f16_f32 v193, v176, v177
v_cvt_pkrtz_f16_f32 v195, v178, v179
v_mfma_f32_16x16x32_f16 v[128:131], v[224:227], v[236:239], v[128:131]
v_cvt_pkrtz_f16_f32 v197, v180, v181
v_cvt_pkrtz_f16_f32 v199, v182, v183
v_mfma_f32_16x16x32_f16 v[124:127], v[228:231], v[232:235], v[124:127]
ds_read_b128 v[224:227], v249 offset:19456
v_cvt_pkrtz_f16_f32 v201, v184, v185
v_cvt_pk_f16_f32 v243, v186, v187
v_cvt_pk_f16_f32 v240, v188, v189
v_mfma_f32_16x16x32_f16 v[132:135], v[228:231], v[236:239], v[132:135]
v_cvt_pk_f16_f32 v205, v190, v191
v_pk_fma_f16 v242, v243, v243, s48
v_mfma_f32_16x16x32_bf16 v[176:179], v[0:3], v[88:91], 0
ds_read_b128 v[228:231], v250 offset:16384
v_and_b32_e64 v193, s49, v193
v_pk_fma_f16 v207, v240, v240, s48
v_mfma_f32_16x16x32_bf16 v[184:187], v[0:3], v[92:95], 0
v_and_b32 v195, s49, v195
v_pk_fma_f16 v204, v205, v205, s48
v_bfe_u32 v192, v193, 2, 14
s_waitcnt lgkmcnt(3)
v_mfma_f32_16x16x32_f16 v[136:139], v[4:7], v[232:235], v[136:139]
ds_read_b128 v[0:3], v250 offset:16640
ds_read_u16_d16 v192, v192
v_pk_mul_f16 v242, v243, v242
v_bfe_u32 v194, v195, 2, 14
v_mfma_f32_16x16x32_f16 v[144:147], v[4:7], v[236:239], v[144:147]
v_pk_mul_f16 v207, v240, v207
v_lshrrev_b32_e64 v193, 18, v193
v_mfma_f32_16x16x32_bf16 v[180:183], v[40:43], v[88:91], 0
ds_read_b128 v[4:7], v249 offset:19712
ds_read_u16_d16 v194, v194
ds_read_u16_d16_hi v193, v193
v_pk_mul_f16 v204, v205, v204
v_lshrrev_b32_e64 v195, 18, v195
v_mfma_f32_16x16x32_bf16 v[188:191], v[40:43], v[92:95], 0
v_exp_f16_e64 v241, v242
v_and_b32 v197, s49, v197
s_waitcnt lgkmcnt(5)
v_mfma_f32_16x16x32_f16 v[140:143], v[44:47], v[232:235], v[140:143]
ds_read_b128 v[40:43], v249 offset:20480
ds_read_u16_d16_hi v195, v195
v_and_b32_e64 v199, s49, v199
v_mfma_f32_16x16x32_f16 v[148:151], v[44:47], v[236:239], v[148:151]
v_exp_f16_e64 v206, v207
v_bfe_u32 v196, v197, 2, 14
v_bfe_u32 v198, v199, 2, 14
v_mfma_f32_16x16x32_bf16 v[176:179], v[224:227], v[208:211], v[176:179]
s_add_u32 s46, s70, 98304
buffer_store_dwordx4 v[76:79], v255, s[8:11], s46 offen offset:128 sc1
ds_read_b128 v[44:47], v249 offset:20736
ds_read_u16_d16 v196, v196
ds_read_u16_d16 v198, v198
v_exp_f16_e64 v203, v204
v_mfma_f32_16x16x32_bf16 v[184:187], v[224:227], v[212:215], v[184:187]
v_lshrrev_b32 v197, 18, v197
v_lshrrev_b32 v199, 18, v199
v_mfma_f32_16x16x32_f16 v[152:155], v[228:231], v[232:235], v[152:155]
ds_read_b128 v[224:227], v250 offset:20480
ds_read_u16_d16_hi v197, v197
ds_read_u16_d16_hi v199, v199
v_exp_f16_sdwa v241, v242 dst_sel:WORD_1 dst_unused:UNUSED_PRESERVE src0_sel:WORD_1
v_and_b32 v201, s49, v201
v_mfma_f32_16x16x32_f16 v[160:163], v[228:231], v[236:239], v[160:163]
v_bfe_u32 v200, v201, 2, 14
s_waitcnt lgkmcnt(7)
v_mfma_f32_16x16x32_f16 v[156:159], v[0:3], v[232:235], v[156:159]
ds_read_b128 v[228:231], v250 offset:20736
ds_read_u16_d16 v200, v200
v_exp_f16_sdwa v206, v207 dst_sel:WORD_1 dst_unused:UNUSED_PRESERVE src0_sel:WORD_1
v_lshrrev_b32_e64 v201, 18, v201
v_mfma_f32_16x16x32_f16 v[164:167], v[0:3], v[236:239], v[164:167]
v_exp_f16_sdwa v203, v204 dst_sel:WORD_1 dst_unused:UNUSED_PRESERVE src0_sel:WORD_1
v_pk_add_f16 v241, v241, 1.0 op_sel_hi:[1,0]
v_mfma_f32_16x16x32_bf16 v[180:183], v[4:7], v[208:211], v[180:183]
ds_read_b128 v[0:3], v248 offset:16384
ds_read_u16_d16_hi v201, v201
v_pk_add_f16 v206, v206, 1.0 op_sel_hi:[1,0]
v_pk_add_f16 v203, v203, 1.0 op_sel_hi:[1,0]
v_mfma_f32_16x16x32_bf16 v[188:191], v[4:7], v[212:215], v[188:191]
v_rcp_f16_e64 v242, v241
v_mfma_f32_16x16x32_bf16 v[176:179], v[40:43], v[32:35], v[176:179]
ds_read_b128 v[4:7], v250 offset:21504
v_rcp_f16_e64 v207, v206
v_mfma_f32_16x16x32_bf16 v[184:187], v[40:43], v[36:39], v[184:187]
v_rcp_f16 v204, v203
s_waitcnt lgkmcnt(5)
v_mfma_f32_16x16x32_bf16 v[180:183], v[44:47], v[32:35], v[180:183]
ds_read_b128 v[40:43], v248 offset:16640
v_rcp_f16_sdwa v242, v241 dst_sel:WORD_1 dst_unused:UNUSED_PRESERVE src0_sel:WORD_1
v_mfma_f32_16x16x32_bf16 v[188:191], v[44:47], v[36:39], v[188:191]
v_rcp_f16_sdwa v207, v206 dst_sel:WORD_1 dst_unused:UNUSED_PRESERVE src0_sel:WORD_1
v_or_b32 v232, v192, v193
v_or_b32 v233, v194, v195
v_or_b32_e64 v234, v196, v197
v_rcp_f16_sdwa v204, v203 dst_sel:WORD_1 dst_unused:UNUSED_PRESERVE src0_sel:WORD_1
v_or_b32 v235, v198, v199
s_waitcnt lgkmcnt(2)
v_or_b32_e64 v236, v200, v201
v_pk_mul_f16 v237, v243, v242
v_pk_mul_f16 v238, v240, v207
v_pk_mul_f16 v239, v205, v204
v_mfma_f32_16x16x32_f16 v[120:123], v[224:227], v[232:235], v[120:123]
ds_read_b128 v[44:47], v250 offset:21760
v_cvt_pkrtz_f16_f32 v193, v176, v177
v_cvt_pkrtz_f16_f32 v195, v178, v179
v_mfma_f32_16x16x32_f16 v[128:131], v[224:227], v[236:239], v[128:131]
v_cvt_pkrtz_f16_f32 v197, v180, v181
v_cvt_pkrtz_f16_f32 v199, v182, v183
v_mfma_f32_16x16x32_f16 v[124:127], v[228:231], v[232:235], v[124:127]
ds_read_b128 v[224:227], v248 offset:17408
v_cvt_pkrtz_f16_f32 v201, v184, v185
v_cvt_pk_f16_f32 v243, v186, v187
v_cvt_pk_f16_f32 v240, v188, v189
v_mfma_f32_16x16x32_f16 v[132:135], v[228:231], v[236:239], v[132:135]
v_cvt_pk_f16_f32 v205, v190, v191
v_pk_fma_f16 v242, v243, v243, s48
s_waitcnt vmcnt(14)
v_mfma_f32_16x16x32_bf16 v[176:179], v[0:3], v[96:99], 0
ds_read_b128 v[228:231], v250 offset:22528
v_and_b32 v193, s49, v193
v_pk_fma_f16 v207, v240, v240, s48
s_waitcnt vmcnt(13)
v_mfma_f32_16x16x32_bf16 v[184:187], v[0:3], v[100:103], 0
v_and_b32 v195, s49, v195
v_pk_fma_f16 v204, v205, v205, s48
s_setprio 2
v_bfe_u32 v192, v193, 2, 14
s_waitcnt lgkmcnt(2)
v_mfma_f32_16x16x32_f16 v[136:139], v[4:7], v[232:235], v[136:139]
ds_read_b128 v[0:3], v250 offset:22784
ds_read_u16_d16 v192, v192
v_pk_mul_f16 v242, v243, v242
v_bfe_u32 v194, v195, 2, 14
v_mfma_f32_16x16x32_f16 v[144:147], v[4:7], v[236:239], v[144:147]
v_pk_mul_f16 v207, v240, v207
v_lshrrev_b32_e64 v193, 18, v193
v_mfma_f32_16x16x32_bf16 v[180:183], v[40:43], v[96:99], 0
ds_read_b128 v[4:7], v248 offset:17664
ds_read_u16_d16 v194, v194
ds_read_u16_d16_hi v193, v193
v_pk_mul_f16 v204, v205, v204
v_lshrrev_b32_e64 v195, 18, v195
v_mfma_f32_16x16x32_bf16 v[188:191], v[40:43], v[100:103], 0
v_exp_f16 v241, v242
v_and_b32 v197, s49, v197
v_mfma_f32_16x16x32_f16 v[140:143], v[44:47], v[232:235], v[140:143]
ds_read_b128 v[40:43], v248 offset:18432
ds_read_u16_d16_hi v195, v195
v_and_b32_e64 v199, s49, v199
v_mfma_f32_16x16x32_f16 v[148:151], v[44:47], v[236:239], v[148:151]
v_exp_f16 v206, v207
v_bfe_u32 v196, v197, 2, 14
v_bfe_u32 v198, v199, 2, 14
s_waitcnt vmcnt(12) lgkmcnt(7)
v_mfma_f32_16x16x32_bf16 v[176:179], v[224:227], v[104:107], v[176:179]
ds_read_b128 v[44:47], v248 offset:18688
ds_read_u16_d16 v196, v196
ds_read_u16_d16 v198, v198
v_exp_f16 v203, v204
s_waitcnt vmcnt(11)
v_mfma_f32_16x16x32_bf16 v[184:187], v[224:227], v[108:111], v[184:187]
v_lshrrev_b32 v197, 18, v197
v_lshrrev_b32 v199, 18, v199
v_mfma_f32_16x16x32_f16 v[152:155], v[228:231], v[232:235], v[152:155]
ds_read_b128 v[224:227], v250 offset:26624
ds_read_u16_d16_hi v197, v197
ds_read_u16_d16_hi v199, v199
v_exp_f16_sdwa v241, v242 dst_sel:WORD_1 dst_unused:UNUSED_PRESERVE src0_sel:WORD_1
v_and_b32 v201, s49, v201
v_mfma_f32_16x16x32_f16 v[160:163], v[228:231], v[236:239], v[160:163]
v_bfe_u32 v200, v201, 2, 14
s_waitcnt lgkmcnt(7)
v_mfma_f32_16x16x32_f16 v[156:159], v[0:3], v[232:235], v[156:159]
ds_read_b128 v[228:231], v250 offset:26880
ds_read_u16_d16 v200, v200
v_exp_f16_sdwa v206, v207 dst_sel:WORD_1 dst_unused:UNUSED_PRESERVE src0_sel:WORD_1
v_lshrrev_b32_e64 v201, 18, v201
v_mfma_f32_16x16x32_f16 v[164:167], v[0:3], v[236:239], v[164:167]
v_exp_f16_sdwa v203, v204 dst_sel:WORD_1 dst_unused:UNUSED_PRESERVE src0_sel:WORD_1
v_pk_add_f16 v241, v241, 1.0 op_sel_hi:[1,0]
v_mfma_f32_16x16x32_bf16 v[180:183], v[4:7], v[104:107], v[180:183]
ds_read_b128 v[0:3], v248 offset:22528
ds_read_u16_d16_hi v201, v201
v_pk_add_f16 v206, v206, 1.0 op_sel_hi:[1,0]
v_pk_add_f16 v203, v203, 1.0 op_sel_hi:[1,0]
v_mfma_f32_16x16x32_bf16 v[188:191], v[4:7], v[108:111], v[188:191]
v_rcp_f16 v242, v241
s_waitcnt vmcnt(10)
v_mfma_f32_16x16x32_bf16 v[176:179], v[40:43], v[112:115], v[176:179]
ds_read_b128 v[4:7], v250 offset:27648
v_rcp_f16 v207, v206
s_waitcnt vmcnt(7)
v_mfma_f32_16x16x32_bf16 v[184:187], v[40:43], v[116:119], v[184:187]
v_rcp_f16 v204, v203
s_waitcnt lgkmcnt(5)
v_mfma_f32_16x16x32_bf16 v[180:183], v[44:47], v[112:115], v[180:183]
ds_read_b128 v[40:43], v248 offset:22784
v_rcp_f16_sdwa v242, v241 dst_sel:WORD_1 dst_unused:UNUSED_PRESERVE src0_sel:WORD_1
v_mfma_f32_16x16x32_bf16 v[188:191], v[44:47], v[116:119], v[188:191]
v_rcp_f16_sdwa v207, v206 dst_sel:WORD_1 dst_unused:UNUSED_PRESERVE src0_sel:WORD_1
v_or_b32 v232, v192, v193
v_or_b32 v233, v194, v195
v_or_b32_e64 v234, v196, v197
v_rcp_f16_sdwa v204, v203 dst_sel:WORD_1 dst_unused:UNUSED_PRESERVE src0_sel:WORD_1
v_or_b32 v235, v198, v199
s_waitcnt lgkmcnt(2)
v_or_b32_e64 v236, v200, v201
v_pk_mul_f16 v237, v243, v242
v_pk_mul_f16 v238, v240, v207
v_pk_mul_f16 v239, v205, v204
v_mfma_f32_16x16x32_f16 v[120:123], v[224:227], v[232:235], v[120:123]
s_add_u32 s46, s68, 98304
buffer_load_dwordx4 v[36:39], v252, s[4:7], s46 offen offset:64
ds_read_b128 v[44:47], v250 offset:27904
v_cvt_pkrtz_f16_f32 v193, v176, v177
v_cvt_pkrtz_f16_f32 v195, v178, v179
v_mfma_f32_16x16x32_f16 v[128:131], v[224:227], v[236:239], v[128:131]
v_cvt_pkrtz_f16_f32 v197, v180, v181
v_cvt_pkrtz_f16_f32 v199, v182, v183
v_mfma_f32_16x16x32_f16 v[124:127], v[228:231], v[232:235], v[124:127]
ds_read_b128 v[224:227], v248 offset:23552
v_cvt_pkrtz_f16_f32 v201, v184, v185
v_cvt_pk_f16_f32 v243, v186, v187
v_mfma_f32_16x16x32_f16 v[132:135], v[228:231], v[236:239], v[132:135]
v_cvt_pk_f16_f32 v240, v188, v189
v_cvt_pk_f16_f32 v205, v190, v191
s_setprio 1
v_mfma_f32_16x16x32_bf16 v[176:179], v[0:3], v[96:99], 0
ds_read_b128 v[228:231], v250 offset:28672
v_pk_fma_f16 v242, v243, v243, s48
v_and_b32 v193, s49, v193
v_mfma_f32_16x16x32_bf16 v[184:187], v[0:3], v[100:103], 0
v_pk_fma_f16 v207, v240, v240, s48
v_and_b32 v195, s49, v195
s_waitcnt lgkmcnt(3)
v_mfma_f32_16x16x32_f16 v[136:139], v[4:7], v[232:235], v[136:139]
ds_read_b128 v[0:3], v250 offset:28928
v_pk_fma_f16 v204, v205, v205, s48
v_bfe_u32 v192, v193, 2, 14
v_pk_mul_f16 v242, v243, v242
v_mfma_f32_16x16x32_f16 v[144:147], v[4:7], v[236:239], v[144:147]
v_bfe_u32 v194, v195, 2, 14
v_pk_mul_f16 v207, v240, v207
s_waitcnt vmcnt(7)
v_mfma_f32_16x16x32_bf16 v[120:123], v[26:29], v[244:247], v[120:123]
ds_read_b128 v[4:7], v248 offset:23808
ds_read_u16_d16 v192, v192
ds_read_u16_d16 v194, v194
v_lshrrev_b32 v193, 18, v193
v_pk_mul_f16 v204, v205, v204
v_mfma_f32_16x16x32_bf16 v[124:127], v[24:27], v[244:247], v[124:127]
v_lshrrev_b32_e64 v195, 18, v195
v_mfma_f32_16x16x32_bf16 v[180:183], v[40:43], v[96:99], 0
ds_read_u16_d16_hi v193, v193
ds_read_u16_d16_hi v195, v195
v_exp_f16 v241, v242
v_and_b32 v197, s49, v197
v_mfma_f32_16x16x32_bf16 v[188:191], v[40:43], v[100:103], 0
v_and_b32 v199, s49, v199
s_waitcnt lgkmcnt(6)
v_mfma_f32_16x16x32_f16 v[140:143], v[44:47], v[232:235], v[140:143]
ds_read_b128 v[40:43], v248 offset:24576
v_exp_f16_e64 v206, v207
v_bfe_u32 v196, v197, 2, 14
v_mfma_f32_16x16x32_f16 v[148:151], v[44:47], v[236:239], v[148:151]
v_bfe_u32 v198, v199, 2, 14
v_exp_f16_e64 v203, v204
v_mfma_f32_16x16x32_bf16 v[176:179], v[224:227], v[104:107], v[176:179]
s_add_u32 s46, s70, 98304
buffer_store_dwordx4 v[168:171], v255, s[8:11], s46 offen offset:256 sc1
ds_read_b128 v[44:47], v248 offset:24832
ds_read_u16_d16 v196, v196
ds_read_u16_d16 v198, v198
v_lshrrev_b32 v197, 18, v197
v_lshrrev_b32 v199, 18, v199
v_mfma_f32_16x16x32_bf16 v[184:187], v[224:227], v[108:111], v[184:187]
v_exp_f16_sdwa v241, v242 dst_sel:WORD_1 dst_unused:UNUSED_PRESERVE src0_sel:WORD_1
v_mfma_f32_16x16x32_f16 v[152:155], v[228:231], v[232:235], v[152:155]
ds_read_b128 v[224:227], v249 offset:24576
ds_read_u16_d16_hi v197, v197
ds_read_u16_d16_hi v199, v199
v_and_b32 v201, s49, v201
v_bfe_u32 v200, v201, 2, 14
v_mfma_f32_16x16x32_f16 v[160:163], v[228:231], v[236:239], v[160:163]
v_exp_f16_sdwa v206, v207 dst_sel:WORD_1 dst_unused:UNUSED_PRESERVE src0_sel:WORD_1
s_waitcnt lgkmcnt(7)
v_mfma_f32_16x16x32_f16 v[156:159], v[0:3], v[232:235], v[156:159]
ds_read_b128 v[228:231], v254 offset:7936
ds_read_u16_d16 v200, v200
v_lshrrev_b32_e64 v201, 18, v201
v_mfma_f32_16x16x32_f16 v[164:167], v[0:3], v[236:239], v[164:167]
v_exp_f16_sdwa v203, v204 dst_sel:WORD_1 dst_unused:UNUSED_PRESERVE src0_sel:WORD_1
v_pk_add_f16 v241, v241, 1.0 op_sel_hi:[1,0]
v_pk_add_f16 v206, v206, 1.0 op_sel_hi:[1,0]
v_mfma_f32_16x16x32_bf16 v[180:183], v[4:7], v[104:107], v[180:183]
ds_read_b128 v[0:3], v249 offset:24832
ds_read_u16_d16_hi v201, v201
v_pk_add_f16 v203, v203, 1.0 op_sel_hi:[1,0]
v_mfma_f32_16x16x32_bf16 v[188:191], v[4:7], v[108:111], v[188:191]
v_rcp_f16_e64 v242, v241
s_setprio 0
s_waitcnt lgkmcnt(7)
v_mfma_f32_16x16x32_bf16 v[176:179], v[40:43], v[112:115], v[176:179]
ds_read_b128 v[4:7], v254 offset:7952
v_rcp_f16_e64 v207, v206
v_mfma_f32_16x16x32_bf16 v[184:187], v[40:43], v[116:119], v[184:187]
v_rcp_f16_e64 v204, v203
v_mfma_f32_16x16x32_bf16 v[180:183], v[44:47], v[112:115], v[180:183]
ds_read_b128 v[40:43], v248 offset:28672
v_rcp_f16_sdwa v242, v241 dst_sel:WORD_1 dst_unused:UNUSED_PRESERVE src0_sel:WORD_1
v_mfma_f32_16x16x32_bf16 v[188:191], v[44:47], v[116:119], v[188:191]
v_rcp_f16_sdwa v207, v206 dst_sel:WORD_1 dst_unused:UNUSED_PRESERVE src0_sel:WORD_1
v_or_b32 v232, v192, v193
v_or_b32 v233, v194, v195
s_waitcnt lgkmcnt(4)
v_or_b32 v234, v196, v197
v_rcp_f16_sdwa v204, v203 dst_sel:WORD_1 dst_unused:UNUSED_PRESERVE src0_sel:WORD_1
v_or_b32 v235, v198, v199
s_waitcnt lgkmcnt(2)
v_or_b32 v236, v200, v201
v_pk_mul_f16 v237, v243, v242
v_pk_mul_f16 v238, v240, v207
v_pk_mul_f16 v239, v205, v204
s_setprio 3
v_mfma_f32_16x16x32_f16 v[48:51], v[224:227], v[232:235], v[228:231]
ds_read_b128 v[44:47], v249 offset:25600
v_cvt_pkrtz_f16_f32 v193, v176, v177
v_cvt_pkrtz_f16_f32 v195, v178, v179
v_mfma_f32_16x16x32_f16 v[56:59], v[224:227], v[236:239], v[228:231]
v_cvt_pkrtz_f16_f32 v197, v180, v181
v_cvt_pkrtz_f16_f32 v199, v182, v183
s_waitcnt lgkmcnt(2)
v_mfma_f32_16x16x32_f16 v[52:55], v[0:3], v[232:235], v[4:7]
ds_read_b128 v[224:227], v254 offset:8064
ds_read_b128 v[228:231], v248 offset:28928
v_cvt_pkrtz_f16_f32 v201, v184, v185
v_cvt_pk_f16_f32 v243, v186, v187
v_mfma_f32_16x16x32_f16 v[60:63], v[0:3], v[236:239], v[4:7]
v_cvt_pk_f16_f32 v240, v188, v189
v_cvt_pk_f16_f32 v205, v190, v191
s_waitcnt lgkmcnt(3)
v_mfma_f32_16x16x32_bf16 v[176:179], v[40:43], v[96:99], 0
ds_read_b128 v[0:3], v249 offset:25856
ds_read_b128 v[4:7], v254 offset:8080
v_pk_fma_f16 v242, v243, v243, s48
v_and_b32_e64 v193, s49, v193
v_mfma_f32_16x16x32_bf16 v[184:187], v[40:43], v[100:103], 0
v_pk_fma_f16 v207, v240, v240, s48
v_and_b32 v195, s49, v195
s_waitcnt lgkmcnt(3)
v_mfma_f32_16x16x32_f16 v[64:67], v[44:47], v[232:235], v[224:227]
ds_read_b128 v[40:43], v248 offset:29696
v_pk_fma_f16 v204, v205, v205, s48
v_bfe_u32 v192, v193, 2, 14
v_pk_mul_f16 v242, v243, v242
v_mfma_f32_16x16x32_f16 v[72:75], v[44:47], v[236:239], v[224:227]
v_bfe_u32 v194, v195, 2, 14
v_pk_mul_f16 v207, v240, v207
s_waitcnt vmcnt(6)
v_mfma_f32_16x16x32_bf16 v[136:139], v[26:29], v[216:219], v[136:139]
ds_read_b128 v[44:47], v249 offset:26624
ds_read_b128 v[224:227], v254 offset:16128
ds_read_u16_d16 v192, v192
ds_read_u16_d16 v194, v194
v_lshrrev_b32 v193, 18, v193
v_pk_mul_f16 v204, v205, v204
v_mfma_f32_16x16x32_bf16 v[140:143], v[24:27], v[216:219], v[140:143]
v_lshrrev_b32 v195, 18, v195
s_waitcnt lgkmcnt(5)
v_mfma_f32_16x16x32_bf16 v[180:183], v[228:231], v[96:99], 0
ds_read_u16_d16_hi v193, v193
ds_read_u16_d16_hi v195, v195
v_exp_f16 v241, v242
v_and_b32 v197, s49, v197
v_mfma_f32_16x16x32_bf16 v[188:191], v[228:231], v[100:103], 0
v_and_b32_e64 v199, s49, v199
v_mfma_f32_16x16x32_f16 v[68:71], v[0:3], v[232:235], v[4:7]
ds_read_b128 v[228:231], v249 offset:26880
v_exp_f16_e64 v206, v207
v_bfe_u32 v196, v197, 2, 14
v_mfma_f32_16x16x32_f16 v[76:79], v[0:3], v[236:239], v[4:7]
v_bfe_u32 v198, v199, 2, 14
v_exp_f16 v203, v204
s_waitcnt lgkmcnt(7)
v_mfma_f32_16x16x32_bf16 v[176:179], v[40:43], v[104:107], v[176:179]
ds_read_b128 v[0:3], v254 offset:16144
ds_read_b128 v[4:7], v248 offset:29952
ds_read_u16_d16 v196, v196
ds_read_u16_d16 v198, v198
v_lshrrev_b32_e64 v197, 18, v197
v_lshrrev_b32 v199, 18, v199
v_mfma_f32_16x16x32_bf16 v[184:187], v[40:43], v[108:111], v[184:187]
v_exp_f16_sdwa v241, v242 dst_sel:WORD_1 dst_unused:UNUSED_PRESERVE src0_sel:WORD_1
s_waitcnt lgkmcnt(7)
v_mfma_f32_16x16x32_f16 v[80:83], v[44:47], v[232:235], v[224:227]
ds_read_b128 v[40:43], v248 offset:30720
ds_read_u16_d16_hi v197, v197
ds_read_u16_d16_hi v199, v199
v_and_b32 v201, s49, v201
v_bfe_u32 v200, v201, 2, 14
v_mfma_f32_16x16x32_f16 v[168:171], v[44:47], v[236:239], v[224:227]
v_exp_f16_sdwa v206, v207 dst_sel:WORD_1 dst_unused:UNUSED_PRESERVE src0_sel:WORD_1
s_waitcnt lgkmcnt(6)
v_mfma_f32_16x16x32_f16 v[84:87], v[228:231], v[232:235], v[0:3]
ds_read_b128 v[44:47], v248 offset:30976
ds_read_b128 v[224:227], v249 offset:30720
ds_read_u16_d16 v200, v200
v_lshrrev_b32 v201, 18, v201
v_mfma_f32_16x16x32_f16 v[172:175], v[228:231], v[236:239], v[0:3]
v_exp_f16_sdwa v203, v204 dst_sel:WORD_1 dst_unused:UNUSED_PRESERVE src0_sel:WORD_1
v_pk_add_f16 v241, v241, 1.0 op_sel_hi:[1,0]
v_pk_add_f16 v206, v206, 1.0 op_sel_hi:[1,0]
s_waitcnt lgkmcnt(7)
v_mfma_f32_16x16x32_bf16 v[180:183], v[4:7], v[104:107], v[180:183]
ds_read_b128 v[228:231], v249 offset:30976
ds_read_b128 v[0:3], v248 offset:34816
ds_read_u16_d16_hi v201, v201
v_pk_add_f16 v203, v203, 1.0 op_sel_hi:[1,0]
v_mfma_f32_16x16x32_bf16 v[188:191], v[4:7], v[108:111], v[188:191]
v_rcp_f16 v242, v241
s_waitcnt lgkmcnt(8)
v_mfma_f32_16x16x32_bf16 v[176:179], v[40:43], v[112:115], v[176:179]
ds_read_b128 v[4:7], v249 offset:31744
v_rcp_f16_e64 v207, v206
v_mfma_f32_16x16x32_bf16 v[184:187], v[40:43], v[116:119], v[184:187]
v_rcp_f16 v204, v203
s_waitcnt lgkmcnt(6)
v_mfma_f32_16x16x32_bf16 v[180:183], v[44:47], v[112:115], v[180:183]
ds_read_b128 v[40:43], v248 offset:35072
v_rcp_f16_sdwa v242, v241 dst_sel:WORD_1 dst_unused:UNUSED_PRESERVE src0_sel:WORD_1
v_mfma_f32_16x16x32_bf16 v[188:191], v[44:47], v[116:119], v[188:191]
v_rcp_f16_sdwa v207, v206 dst_sel:WORD_1 dst_unused:UNUSED_PRESERVE src0_sel:WORD_1
v_or_b32 v232, v192, v193
v_or_b32 v233, v194, v195
v_or_b32_e64 v234, v196, v197
v_rcp_f16_sdwa v204, v203 dst_sel:WORD_1 dst_unused:UNUSED_PRESERVE src0_sel:WORD_1
v_or_b32 v235, v198, v199
s_waitcnt lgkmcnt(2)
v_or_b32_e64 v236, v200, v201
v_pk_mul_f16 v237, v243, v242
v_pk_mul_f16 v238, v240, v207
v_pk_mul_f16 v239, v205, v204
v_mfma_f32_16x16x32_f16 v[48:51], v[224:227], v[232:235], v[48:51]
s_add_u32 s46, s68, 98304
buffer_load_dwordx4 v[216:219], v252, s[4:7], s46 offen offset:128
ds_read_b128 v[44:47], v249 offset:32000
v_cvt_pkrtz_f16_f32 v193, v176, v177
v_cvt_pkrtz_f16_f32 v195, v178, v179
v_mfma_f32_16x16x32_f16 v[56:59], v[224:227], v[236:239], v[56:59]
v_cvt_pkrtz_f16_f32 v197, v180, v181
v_cvt_pkrtz_f16_f32 v199, v182, v183
v_mfma_f32_16x16x32_f16 v[52:55], v[228:231], v[232:235], v[52:55]
ds_read_b128 v[224:227], v248 offset:35840
v_cvt_pkrtz_f16_f32 v201, v184, v185
v_cvt_pk_f16_f32 v243, v186, v187
v_mfma_f32_16x16x32_f16 v[60:63], v[228:231], v[236:239], v[60:63]
v_cvt_pk_f16_f32 v240, v188, v189
v_cvt_pk_f16_f32 v205, v190, v191
v_mfma_f32_16x16x32_bf16 v[176:179], v[0:3], v[96:99], 0
ds_read_b128 v[228:231], v249 offset:32768
v_pk_fma_f16 v242, v243, v243, s48
v_and_b32_e64 v193, s49, v193
v_mfma_f32_16x16x32_bf16 v[184:187], v[0:3], v[100:103], 0
v_pk_fma_f16 v207, v240, v240, s48
v_and_b32 v195, s49, v195
s_waitcnt lgkmcnt(3)
v_mfma_f32_16x16x32_f16 v[64:67], v[4:7], v[232:235], v[64:67]
ds_read_b128 v[0:3], v249 offset:33024
v_pk_fma_f16 v204, v205, v205, s48
s_setprio 2
v_bfe_u32 v192, v193, 2, 14
v_pk_mul_f16 v242, v243, v242
v_mfma_f32_16x16x32_f16 v[72:75], v[4:7], v[236:239], v[72:75]
v_bfe_u32 v194, v195, 2, 14
v_pk_mul_f16 v207, v240, v207
s_waitcnt vmcnt(5)
v_mfma_f32_16x16x32_bf16 v[152:155], v[26:29], v[12:15], v[152:155]
ds_read_b128 v[4:7], v248 offset:36096
ds_read_u16_d16 v192, v192
ds_read_u16_d16 v194, v194
v_lshrrev_b32_e64 v193, 18, v193
v_pk_mul_f16 v204, v205, v204
v_mfma_f32_16x16x32_bf16 v[156:159], v[24:27], v[12:15], v[156:159]
v_lshrrev_b32_e64 v195, 18, v195
v_mfma_f32_16x16x32_bf16 v[180:183], v[40:43], v[96:99], 0
ds_read_u16_d16_hi v193, v193
ds_read_u16_d16_hi v195, v195
v_exp_f16 v241, v242
v_and_b32 v197, s49, v197
v_mfma_f32_16x16x32_bf16 v[188:191], v[40:43], v[100:103], 0
v_and_b32 v199, s49, v199
s_waitcnt lgkmcnt(6)
v_mfma_f32_16x16x32_f16 v[68:71], v[44:47], v[232:235], v[68:71]
ds_read_b128 v[40:43], v248 offset:36864
v_exp_f16_e64 v206, v207
v_bfe_u32 v196, v197, 2, 14
v_mfma_f32_16x16x32_f16 v[76:79], v[44:47], v[236:239], v[76:79]
v_bfe_u32 v198, v199, 2, 14
v_exp_f16_e64 v203, v204
v_mfma_f32_16x16x32_bf16 v[176:179], v[224:227], v[104:107], v[176:179]
ds_read_b128 v[44:47], v248 offset:37120
ds_read_u16_d16 v196, v196
ds_read_u16_d16 v198, v198
v_lshrrev_b32 v197, 18, v197
v_lshrrev_b32 v199, 18, v199
v_mfma_f32_16x16x32_bf16 v[184:187], v[224:227], v[108:111], v[184:187]
v_exp_f16_sdwa v241, v242 dst_sel:WORD_1 dst_unused:UNUSED_PRESERVE src0_sel:WORD_1
v_mfma_f32_16x16x32_f16 v[80:83], v[228:231], v[232:235], v[80:83]
ds_read_b128 v[224:227], v249 offset:36864
ds_read_u16_d16_hi v197, v197
ds_read_u16_d16_hi v199, v199
v_and_b32 v201, s49, v201
v_bfe_u32 v200, v201, 2, 14
v_mfma_f32_16x16x32_f16 v[168:171], v[228:231], v[236:239], v[168:171]
v_exp_f16_sdwa v206, v207 dst_sel:WORD_1 dst_unused:UNUSED_PRESERVE src0_sel:WORD_1
s_waitcnt lgkmcnt(7)
v_mfma_f32_16x16x32_f16 v[84:87], v[0:3], v[232:235], v[84:87]
ds_read_b128 v[228:231], v249 offset:37120
ds_read_u16_d16 v200, v200
v_lshrrev_b32_e64 v201, 18, v201
v_mfma_f32_16x16x32_f16 v[172:175], v[0:3], v[236:239], v[172:175]
v_exp_f16_sdwa v203, v204 dst_sel:WORD_1 dst_unused:UNUSED_PRESERVE src0_sel:WORD_1
v_pk_add_f16 v241, v241, 1.0 op_sel_hi:[1,0]
v_pk_add_f16 v206, v206, 1.0 op_sel_hi:[1,0]
v_mfma_f32_16x16x32_bf16 v[180:183], v[4:7], v[104:107], v[180:183]
ds_read_b128 v[0:3], v248 offset:40960
ds_read_u16_d16_hi v201, v201
v_pk_add_f16 v203, v203, 1.0 op_sel_hi:[1,0]
v_mfma_f32_16x16x32_bf16 v[188:191], v[4:7], v[108:111], v[188:191]
v_rcp_f16 v242, v241
s_waitcnt lgkmcnt(7)
v_mfma_f32_16x16x32_bf16 v[176:179], v[40:43], v[112:115], v[176:179]
ds_read_b128 v[4:7], v249 offset:37888
v_rcp_f16_e64 v207, v206
v_mfma_f32_16x16x32_bf16 v[184:187], v[40:43], v[116:119], v[184:187]
v_rcp_f16_e64 v204, v203
v_mfma_f32_16x16x32_bf16 v[180:183], v[44:47], v[112:115], v[180:183]
ds_read_b128 v[40:43], v248 offset:41216
v_rcp_f16_sdwa v242, v241 dst_sel:WORD_1 dst_unused:UNUSED_PRESERVE src0_sel:WORD_1
v_mfma_f32_16x16x32_bf16 v[188:191], v[44:47], v[116:119], v[188:191]
v_rcp_f16_sdwa v207, v206 dst_sel:WORD_1 dst_unused:UNUSED_PRESERVE src0_sel:WORD_1
v_or_b32 v232, v192, v193
v_or_b32 v233, v194, v195
s_waitcnt lgkmcnt(4)
v_or_b32 v234, v196, v197
v_rcp_f16_sdwa v204, v203 dst_sel:WORD_1 dst_unused:UNUSED_PRESERVE src0_sel:WORD_1
v_or_b32 v235, v198, v199
s_waitcnt lgkmcnt(2)
v_or_b32_e64 v236, v200, v201
v_pk_mul_f16 v237, v243, v242
v_pk_mul_f16 v238, v240, v207
v_pk_mul_f16 v239, v205, v204
v_mfma_f32_16x16x32_f16 v[48:51], v[224:227], v[232:235], v[48:51]
buffer_load_dwordx4 v[12:15], v252, s[4:7], s69 offen
ds_read_b128 v[44:47], v249 offset:38144
v_cvt_pkrtz_f16_f32 v193, v176, v177
v_cvt_pkrtz_f16_f32 v195, v178, v179
v_cvt_pkrtz_f16_f32 v197, v180, v181
v_mfma_f32_16x16x32_f16 v[56:59], v[224:227], v[236:239], v[56:59]
v_cvt_pkrtz_f16_f32 v199, v182, v183
v_cvt_pkrtz_f16_f32 v201, v184, v185
v_cvt_pkrtz_f16_f32 v203, v186, v187
v_mfma_f32_16x16x32_f16 v[52:55], v[228:231], v[232:235], v[52:55]
ds_read_b128 v[224:227], v248 offset:41984
v_cvt_pk_f16_f32 v243, v188, v189
v_cvt_pk_f16_f32 v240, v190, v191
v_pk_fma_f16 v242, v243, v243, s48
s_setprio 1
v_mfma_f32_16x16x32_f16 v[60:63], v[228:231], v[236:239], v[60:63]
v_cvt_pk_bf16_f32 v136, v136, v137
v_and_b32 v193, s49, v193
v_cvt_pk_bf16_f32 v137, v138, v139
v_mfma_f32_16x16x32_bf16 v[176:179], v[0:3], v[96:99], 0
ds_read_b128 v[228:231], v249 offset:38912
v_and_b32 v195, s49, v195
v_cvt_pk_bf16_f32 v138, v140, v141
v_pk_fma_f16 v207, v240, v240, s48
v_mfma_f32_16x16x32_bf16 v[184:187], v[0:3], v[100:103], 0
v_bfe_u32 v192, v193, 2, 14
v_cvt_pk_bf16_f32 v139, v142, v143
v_pk_mul_f16 v242, v243, v242
s_waitcnt lgkmcnt(2)
v_mfma_f32_16x16x32_f16 v[64:67], v[4:7], v[232:235], v[64:67]
ds_read_b128 v[0:3], v249 offset:39168
ds_read_u16_d16 v192, v192
v_cvt_pk_bf16_f32 v120, v120, v121
v_bfe_u32 v194, v195, 2, 14
v_cvt_pk_bf16_f32 v121, v122, v123
v_mfma_f32_16x16x32_f16 v[72:75], v[4:7], v[236:239], v[72:75]
v_pk_mul_f16 v207, v240, v207
v_lshrrev_b32_e64 v193, 18, v193
v_cvt_pk_bf16_f32 v122, v124, v125
v_mfma_f32_16x16x32_bf16 v[180:183], v[40:43], v[96:99], 0
ds_read_b128 v[4:7], v248 offset:42240
ds_read_u16_d16 v194, v194
ds_read_u16_d16_hi v193, v193
v_exp_f16_e64 v241, v242
v_cvt_pk_bf16_f32 v123, v126, v127
v_mfma_f32_16x16x32_bf16 v[188:191], v[40:43], v[100:103], 0
v_lshrrev_b32_e64 v195, 18, v195
v_cvt_pk_bf16_f32 v152, v152, v153
v_and_b32_e64 v197, s49, v197
v_mfma_f32_16x16x32_f16 v[68:71], v[44:47], v[232:235], v[68:71]
ds_read_b128 v[40:43], v248 offset:43008
ds_read_u16_d16_hi v195, v195
v_cvt_pk_bf16_f32 v153, v154, v155
v_exp_f16_e64 v206, v207
v_mfma_f32_16x16x32_f16 v[76:79], v[44:47], v[236:239], v[76:79]
v_cvt_pk_bf16_f32 v154, v156, v157
v_and_b32_e64 v199, s49, v199
v_cvt_pk_bf16_f32 v155, v158, v159
s_mov_b64 vcc, s[74:75]
s_waitcnt lgkmcnt(5)
v_mfma_f32_16x16x32_bf16 v[176:179], v[224:227], v[104:107], v[176:179]
ds_read_b128 v[44:47], v248 offset:43264
v_bfe_u32 v196, v197, 2, 14
v_cndmask_b32_e64 v140, v120, v152, s[74:75]
v_mfma_f32_16x16x32_bf16 v[184:187], v[224:227], v[108:111], v[184:187]
v_exp_f16_sdwa v241, v242 dst_sel:WORD_1 dst_unused:UNUSED_PRESERVE src0_sel:WORD_1
v_cndmask_b32_dpp v120, v136, v120, vcc quad_perm:[1,0,3,2] row_mask:0xf bank_mask:0xf
v_bfe_u32 v198, v199, 2, 14
v_mfma_f32_16x16x32_f16 v[80:83], v[228:231], v[232:235], v[80:83]
ds_read_b128 v[224:227], v249 offset:43008
ds_read_u16_d16 v196, v196
ds_read_u16_d16 v198, v198
v_cndmask_b32_e64 v141, v121, v153, s[74:75]
v_lshrrev_b32_e64 v197, 18, v197
v_cndmask_b32_dpp v121, v137, v121, vcc quad_perm:[1,0,3,2] row_mask:0xf bank_mask:0xf
v_mfma_f32_16x16x32_f16 v[168:171], v[228:231], v[236:239], v[168:171]
v_lshrrev_b32_e64 v199, 18, v199
v_exp_f16_sdwa v206, v207 dst_sel:WORD_1 dst_unused:UNUSED_PRESERVE src0_sel:WORD_1
v_mfma_f32_16x16x32_f16 v[84:87], v[0:3], v[232:235], v[84:87]
ds_read_b128 v[228:231], v249 offset:43264
ds_read_u16_d16_hi v197, v197
ds_read_u16_d16_hi v199, v199
v_cndmask_b32_e64 v142, v122, v154, s[74:75]
v_cndmask_b32_dpp v122, v138, v122, vcc quad_perm:[1,0,3,2] row_mask:0xf bank_mask:0xf
v_and_b32_e64 v201, s49, v201
v_mfma_f32_16x16x32_f16 v[172:175], v[0:3], v[236:239], v[172:175]
v_cndmask_b32_e64 v143, v123, v155, s[74:75]
v_and_b32 v203, s49, v203
v_pk_add_f16 v241, v241, 1.0 op_sel_hi:[1,0]
s_waitcnt lgkmcnt(6)
v_mfma_f32_16x16x32_bf16 v[180:183], v[4:7], v[104:107], v[180:183]
ds_read_b128 v[0:3], v248 offset:47104
v_cndmask_b32_dpp v123, v139, v123, vcc quad_perm:[1,0,3,2] row_mask:0xf bank_mask:0xf
s_not_b64 vcc, s[74:75]
v_bfe_u32 v200, v201, 2, 14
s_setprio 0
v_cndmask_b32_dpp v152, v136, v152, vcc quad_perm:[1,0,3,2] row_mask:0xf bank_mask:0xf
v_mfma_f32_16x16x32_bf16 v[188:191], v[4:7], v[108:111], v[188:191]
v_pk_add_f16 v206, v206, 1.0 op_sel_hi:[1,0]
v_cndmask_b32_dpp v153, v137, v153, vcc quad_perm:[1,0,3,2] row_mask:0xf bank_mask:0xf
v_bfe_u32 v202, v203, 2, 14
v_mfma_f32_16x16x32_bf16 v[176:179], v[40:43], v[112:115], v[176:179]
ds_read_b128 v[4:7], v249 offset:44032
ds_read_u16_d16 v200, v200
ds_read_u16_d16 v202, v202
v_rcp_f16_e64 v242, v241
v_cndmask_b32_dpp v154, v138, v154, vcc quad_perm:[1,0,3,2] row_mask:0xf bank_mask:0xf
v_mfma_f32_16x16x32_bf16 v[184:187], v[40:43], v[116:119], v[184:187]
v_cndmask_b32_dpp v155, v139, v155, vcc quad_perm:[1,0,3,2] row_mask:0xf bank_mask:0xf
v_lshrrev_b32 v201, 18, v201
v_lshrrev_b32 v203, 18, v203
v_mfma_f32_16x16x32_bf16 v[180:183], v[44:47], v[112:115], v[180:183]
ds_read_b128 v[40:43], v248 offset:47360
buffer_store_dwordx4 v[120:123], v255, s[8:11], s68 offen sc1
ds_read_u16_d16_hi v201, v201
ds_read_u16_d16_hi v203, v203
v_rcp_f16_e64 v207, v206
v_mfma_f32_16x16x32_bf16 v[188:191], v[44:47], v[116:119], v[188:191]
v_rcp_f16_sdwa v242, v241 dst_sel:WORD_1 dst_unused:UNUSED_PRESERVE src0_sel:WORD_1
v_or_b32 v232, v192, v193
v_or_b32 v233, v194, v195
s_waitcnt lgkmcnt(6)
v_or_b32 v234, v196, v197
v_rcp_f16_sdwa v207, v206 dst_sel:WORD_1 dst_unused:UNUSED_PRESERVE src0_sel:WORD_1
v_or_b32 v235, v198, v199
s_waitcnt lgkmcnt(1)
v_or_b32 v236, v200, v201
s_waitcnt lgkmcnt(0)
v_or_b32 v237, v202, v203
v_pk_mul_f16 v238, v243, v242
v_pk_mul_f16 v239, v240, v207
s_setprio 3
v_mfma_f32_16x16x32_f16 v[48:51], v[224:227], v[232:235], v[48:51]
buffer_load_dwordx4 v[244:247], v252, s[4:7], s69 offen offset:64
ds_read_b128 v[44:47], v249 offset:44288
v_cvt_pkrtz_f16_f32 v193, v176, v177
v_cvt_pkrtz_f16_f32 v195, v178, v179
v_mfma_f32_16x16x32_f16 v[56:59], v[224:227], v[236:239], v[56:59]
v_cvt_pkrtz_f16_f32 v197, v180, v181
v_cvt_pkrtz_f16_f32 v199, v182, v183
v_mfma_f32_16x16x32_f16 v[52:55], v[228:231], v[232:235], v[52:55]
ds_read_b128 v[224:227], v248 offset:48128
v_cvt_pkrtz_f16_f32 v201, v184, v185
v_cvt_pk_f16_f32 v243, v186, v187
v_mfma_f32_16x16x32_f16 v[60:63], v[228:231], v[236:239], v[60:63]
v_cvt_pk_f16_f32 v240, v188, v189
v_cvt_pk_f16_f32 v205, v190, v191
v_mfma_f32_16x16x32_bf16 v[176:179], v[0:3], v[96:99], 0
ds_read_b128 v[228:231], v249 offset:45056
v_pk_fma_f16 v242, v243, v243, s48
v_and_b32_e64 v193, s49, v193
v_mfma_f32_16x16x32_bf16 v[184:187], v[0:3], v[100:103], 0
v_pk_fma_f16 v207, v240, v240, s48
v_and_b32_e64 v195, s49, v195
v_mfma_f32_16x16x32_f16 v[64:67], v[4:7], v[232:235], v[64:67]
ds_read_b128 v[0:3], v249 offset:45312
v_pk_fma_f16 v204, v205, v205, s48
v_bfe_u32 v192, v193, 2, 14
v_pk_mul_f16 v242, v243, v242
v_mfma_f32_16x16x32_f16 v[72:75], v[4:7], v[236:239], v[72:75]
v_bfe_u32 v194, v195, 2, 14
v_pk_mul_f16 v207, v240, v207
s_waitcnt vmcnt(7)
v_mfma_f32_16x16x32_bf16 v[128:131], v[26:29], v[8:11], v[128:131]
ds_read_b128 v[4:7], v248 offset:48384
ds_read_u16_d16 v192, v192
ds_read_u16_d16 v194, v194
v_lshrrev_b32 v193, 18, v193
v_pk_mul_f16 v204, v205, v204
v_mfma_f32_16x16x32_bf16 v[132:135], v[24:27], v[8:11], v[132:135]
v_lshrrev_b32_e64 v195, 18, v195
v_mfma_f32_16x16x32_bf16 v[180:183], v[40:43], v[96:99], 0
ds_read_u16_d16_hi v193, v193
ds_read_u16_d16_hi v195, v195
v_exp_f16 v241, v242
v_and_b32 v197, s49, v197
v_mfma_f32_16x16x32_bf16 v[188:191], v[40:43], v[100:103], 0
v_and_b32 v199, s49, v199
s_waitcnt lgkmcnt(6)
v_mfma_f32_16x16x32_f16 v[68:71], v[44:47], v[232:235], v[68:71]
ds_read_b128 v[40:43], v248 offset:49152
v_exp_f16_e64 v206, v207
v_bfe_u32 v196, v197, 2, 14
v_mfma_f32_16x16x32_f16 v[76:79], v[44:47], v[236:239], v[76:79]
v_bfe_u32 v198, v199, 2, 14
v_exp_f16_e64 v203, v204
v_mfma_f32_16x16x32_bf16 v[176:179], v[224:227], v[104:107], v[176:179]
buffer_store_dwordx4 v[140:143], v255, s[8:11], s68 offen offset:128 sc1
ds_read_b128 v[44:47], v248 offset:49408
ds_read_u16_d16 v196, v196
ds_read_u16_d16 v198, v198
v_lshrrev_b32 v197, 18, v197
v_lshrrev_b32 v199, 18, v199
v_mfma_f32_16x16x32_bf16 v[184:187], v[224:227], v[108:111], v[184:187]
v_exp_f16_sdwa v241, v242 dst_sel:WORD_1 dst_unused:UNUSED_PRESERVE src0_sel:WORD_1
v_mfma_f32_16x16x32_f16 v[80:83], v[228:231], v[232:235], v[80:83]
ds_read_b128 v[224:227], v249 offset:49152
ds_read_u16_d16_hi v197, v197
ds_read_u16_d16_hi v199, v199
v_and_b32 v201, s49, v201
v_bfe_u32 v200, v201, 2, 14
v_mfma_f32_16x16x32_f16 v[168:171], v[228:231], v[236:239], v[168:171]
v_exp_f16_sdwa v206, v207 dst_sel:WORD_1 dst_unused:UNUSED_PRESERVE src0_sel:WORD_1
s_waitcnt lgkmcnt(7)
v_mfma_f32_16x16x32_f16 v[84:87], v[0:3], v[232:235], v[84:87]
ds_read_b128 v[228:231], v249 offset:49408
ds_read_u16_d16 v200, v200
v_lshrrev_b32_e64 v201, 18, v201
v_mfma_f32_16x16x32_f16 v[172:175], v[0:3], v[236:239], v[172:175]
v_exp_f16_sdwa v203, v204 dst_sel:WORD_1 dst_unused:UNUSED_PRESERVE src0_sel:WORD_1
v_pk_add_f16 v241, v241, 1.0 op_sel_hi:[1,0]
v_pk_add_f16 v206, v206, 1.0 op_sel_hi:[1,0]
v_mfma_f32_16x16x32_bf16 v[180:183], v[4:7], v[104:107], v[180:183]
ds_read_b128 v[0:3], v248 offset:53248
ds_read_u16_d16_hi v201, v201
v_pk_add_f16 v203, v203, 1.0 op_sel_hi:[1,0]
v_mfma_f32_16x16x32_bf16 v[188:191], v[4:7], v[108:111], v[188:191]
v_rcp_f16 v242, v241
s_waitcnt lgkmcnt(7)
v_mfma_f32_16x16x32_bf16 v[176:179], v[40:43], v[112:115], v[176:179]
ds_read_b128 v[4:7], v249 offset:50176
v_rcp_f16_e64 v207, v206
v_mfma_f32_16x16x32_bf16 v[184:187], v[40:43], v[116:119], v[184:187]
v_rcp_f16_e64 v204, v203
v_mfma_f32_16x16x32_bf16 v[180:183], v[44:47], v[112:115], v[180:183]
ds_read_b128 v[40:43], v248 offset:53504
v_rcp_f16_sdwa v242, v241 dst_sel:WORD_1 dst_unused:UNUSED_PRESERVE src0_sel:WORD_1
v_mfma_f32_16x16x32_bf16 v[188:191], v[44:47], v[116:119], v[188:191]
v_rcp_f16_sdwa v207, v206 dst_sel:WORD_1 dst_unused:UNUSED_PRESERVE src0_sel:WORD_1
v_or_b32 v232, v192, v193
v_or_b32 v233, v194, v195
s_waitcnt lgkmcnt(4)
v_or_b32 v234, v196, v197
v_rcp_f16_sdwa v204, v203 dst_sel:WORD_1 dst_unused:UNUSED_PRESERVE src0_sel:WORD_1
v_or_b32 v235, v198, v199
s_waitcnt lgkmcnt(2)
v_or_b32_e64 v236, v200, v201
v_pk_mul_f16 v237, v243, v242
v_pk_mul_f16 v238, v240, v207
v_pk_mul_f16 v239, v205, v204
v_mfma_f32_16x16x32_f16 v[48:51], v[224:227], v[232:235], v[48:51]
buffer_load_dwordx4 v[8:11], v252, s[4:7], s69 offen offset:128
ds_read_b128 v[44:47], v249 offset:50432
v_cvt_pkrtz_f16_f32 v193, v176, v177
v_cvt_pkrtz_f16_f32 v195, v178, v179
v_mfma_f32_16x16x32_f16 v[56:59], v[224:227], v[236:239], v[56:59]
v_cvt_pkrtz_f16_f32 v197, v180, v181
v_cvt_pkrtz_f16_f32 v199, v182, v183
v_mfma_f32_16x16x32_f16 v[52:55], v[228:231], v[232:235], v[52:55]
ds_read_b128 v[224:227], v248 offset:54272
v_cvt_pkrtz_f16_f32 v201, v184, v185
v_cvt_pk_f16_f32 v243, v186, v187
v_mfma_f32_16x16x32_f16 v[60:63], v[228:231], v[236:239], v[60:63]
v_cvt_pk_f16_f32 v240, v188, v189
v_cvt_pk_f16_f32 v205, v190, v191
v_mfma_f32_16x16x32_bf16 v[176:179], v[0:3], v[96:99], 0
ds_read_b128 v[228:231], v249 offset:51200
v_pk_fma_f16 v242, v243, v243, s48
v_and_b32_e64 v193, s49, v193
v_mfma_f32_16x16x32_bf16 v[184:187], v[0:3], v[100:103], 0
v_pk_fma_f16 v207, v240, v240, s48
v_and_b32 v195, s49, v195
s_waitcnt lgkmcnt(3)
v_mfma_f32_16x16x32_f16 v[64:67], v[4:7], v[232:235], v[64:67]
ds_read_b128 v[0:3], v249 offset:51456
v_pk_fma_f16 v204, v205, v205, s48
s_setprio 2
v_bfe_u32 v192, v193, 2, 14
v_pk_mul_f16 v242, v243, v242
v_mfma_f32_16x16x32_f16 v[72:75], v[4:7], v[236:239], v[72:75]
v_bfe_u32 v194, v195, 2, 14
v_pk_mul_f16 v207, v240, v207
s_waitcnt vmcnt(7)
v_mfma_f32_16x16x32_bf16 v[144:147], v[26:29], v[36:39], v[144:147]
ds_read_b128 v[4:7], v248 offset:54528
ds_read_u16_d16 v192, v192
ds_read_u16_d16 v194, v194
v_lshrrev_b32_e64 v193, 18, v193
v_pk_mul_f16 v204, v205, v204
v_mfma_f32_16x16x32_bf16 v[148:151], v[24:27], v[36:39], v[148:151]
v_lshrrev_b32_e64 v195, 18, v195
v_mfma_f32_16x16x32_bf16 v[180:183], v[40:43], v[96:99], 0
ds_read_u16_d16_hi v193, v193
ds_read_u16_d16_hi v195, v195
v_exp_f16 v241, v242
v_and_b32 v197, s49, v197
v_mfma_f32_16x16x32_bf16 v[188:191], v[40:43], v[100:103], 0
v_and_b32 v199, s49, v199
s_waitcnt lgkmcnt(6)
v_mfma_f32_16x16x32_f16 v[68:71], v[44:47], v[232:235], v[68:71]
ds_read_b128 v[40:43], v248 offset:55296
v_exp_f16_e64 v206, v207
v_bfe_u32 v196, v197, 2, 14
v_mfma_f32_16x16x32_f16 v[76:79], v[44:47], v[236:239], v[76:79]
v_bfe_u32 v198, v199, 2, 14
v_exp_f16_e64 v203, v204
v_mfma_f32_16x16x32_bf16 v[176:179], v[224:227], v[104:107], v[176:179]
ds_read_b128 v[44:47], v248 offset:55552
ds_read_u16_d16 v196, v196
ds_read_u16_d16 v198, v198
v_lshrrev_b32 v197, 18, v197
v_lshrrev_b32 v199, 18, v199
v_mfma_f32_16x16x32_bf16 v[184:187], v[224:227], v[108:111], v[184:187]
v_exp_f16_sdwa v241, v242 dst_sel:WORD_1 dst_unused:UNUSED_PRESERVE src0_sel:WORD_1
v_mfma_f32_16x16x32_f16 v[80:83], v[228:231], v[232:235], v[80:83]
ds_read_b128 v[224:227], v249 offset:55296
ds_read_u16_d16_hi v197, v197
ds_read_u16_d16_hi v199, v199
v_and_b32 v201, s49, v201
v_bfe_u32 v200, v201, 2, 14
v_mfma_f32_16x16x32_f16 v[168:171], v[228:231], v[236:239], v[168:171]
v_exp_f16_sdwa v206, v207 dst_sel:WORD_1 dst_unused:UNUSED_PRESERVE src0_sel:WORD_1
s_waitcnt lgkmcnt(7)
v_mfma_f32_16x16x32_f16 v[84:87], v[0:3], v[232:235], v[84:87]
ds_read_b128 v[228:231], v249 offset:55552
ds_read_u16_d16 v200, v200
v_lshrrev_b32_e64 v201, 18, v201
v_mfma_f32_16x16x32_f16 v[172:175], v[0:3], v[236:239], v[172:175]
v_exp_f16_sdwa v203, v204 dst_sel:WORD_1 dst_unused:UNUSED_PRESERVE src0_sel:WORD_1
v_pk_add_f16 v241, v241, 1.0 op_sel_hi:[1,0]
v_pk_add_f16 v206, v206, 1.0 op_sel_hi:[1,0]
v_mfma_f32_16x16x32_bf16 v[180:183], v[4:7], v[104:107], v[180:183]
ds_read_b128 v[0:3], v248 offset:59392
ds_read_u16_d16_hi v201, v201
v_pk_add_f16 v203, v203, 1.0 op_sel_hi:[1,0]
v_mfma_f32_16x16x32_bf16 v[188:191], v[4:7], v[108:111], v[188:191]
v_rcp_f16 v242, v241
s_waitcnt lgkmcnt(7)
v_mfma_f32_16x16x32_bf16 v[176:179], v[40:43], v[112:115], v[176:179]
ds_read_b128 v[4:7], v249 offset:56320
v_rcp_f16_e64 v207, v206
v_mfma_f32_16x16x32_bf16 v[184:187], v[40:43], v[116:119], v[184:187]
v_rcp_f16_e64 v204, v203
v_mfma_f32_16x16x32_bf16 v[180:183], v[44:47], v[112:115], v[180:183]
ds_read_b128 v[40:43], v248 offset:59648
v_rcp_f16_sdwa v242, v241 dst_sel:WORD_1 dst_unused:UNUSED_PRESERVE src0_sel:WORD_1
v_mfma_f32_16x16x32_bf16 v[188:191], v[44:47], v[116:119], v[188:191]
v_rcp_f16_sdwa v207, v206 dst_sel:WORD_1 dst_unused:UNUSED_PRESERVE src0_sel:WORD_1
v_or_b32 v232, v192, v193
v_or_b32 v233, v194, v195
s_waitcnt lgkmcnt(4)
v_or_b32 v234, v196, v197
v_rcp_f16_sdwa v204, v203 dst_sel:WORD_1 dst_unused:UNUSED_PRESERVE src0_sel:WORD_1
v_or_b32 v235, v198, v199
s_waitcnt lgkmcnt(2)
v_or_b32_e64 v236, v200, v201
v_pk_mul_f16 v237, v243, v242
v_pk_mul_f16 v238, v240, v207
v_pk_mul_f16 v239, v205, v204
v_mfma_f32_16x16x32_f16 v[48:51], v[224:227], v[232:235], v[48:51]
s_add_u32 s46, s69, 98304
buffer_load_dwordx4 v[36:39], v252, s[4:7], s46 offen
ds_read_b128 v[44:47], v249 offset:56576
v_cvt_pkrtz_f16_f32 v193, v176, v177
v_cvt_pkrtz_f16_f32 v195, v178, v179
v_mfma_f32_16x16x32_f16 v[56:59], v[224:227], v[236:239], v[56:59]
v_cvt_pkrtz_f16_f32 v197, v180, v181
v_cvt_pkrtz_f16_f32 v199, v182, v183
v_mfma_f32_16x16x32_f16 v[52:55], v[228:231], v[232:235], v[52:55]
ds_read_b128 v[224:227], v248 offset:60416
v_cvt_pkrtz_f16_f32 v201, v184, v185
v_cvt_pk_f16_f32 v243, v186, v187
v_cvt_pk_f16_f32 v240, v188, v189
v_mfma_f32_16x16x32_f16 v[60:63], v[228:231], v[236:239], v[60:63]
v_cvt_pk_f16_f32 v205, v190, v191
s_setprio 1
v_pk_fma_f16 v242, v243, v243, s48
v_mfma_f32_16x16x32_bf16 v[176:179], v[0:3], v[96:99], 0
ds_read_b128 v[228:231], v249 offset:57344
v_and_b32 v193, s49, v193
v_pk_fma_f16 v207, v240, v240, s48
v_mfma_f32_16x16x32_bf16 v[184:187], v[0:3], v[100:103], 0
v_and_b32 v195, s49, v195
v_pk_fma_f16 v204, v205, v205, s48
v_bfe_u32 v192, v193, 2, 14
s_waitcnt lgkmcnt(3)
v_mfma_f32_16x16x32_f16 v[64:67], v[4:7], v[232:235], v[64:67]
ds_read_b128 v[0:3], v249 offset:57600
ds_read_u16_d16 v192, v192
v_pk_mul_f16 v242, v243, v242
v_bfe_u32 v194, v195, 2, 14
v_mfma_f32_16x16x32_f16 v[72:75], v[4:7], v[236:239], v[72:75]
v_pk_mul_f16 v207, v240, v207
v_lshrrev_b32_e64 v193, 18, v193
v_mfma_f32_16x16x32_bf16 v[180:183], v[40:43], v[96:99], 0
ds_read_b128 v[4:7], v248 offset:60672
ds_read_u16_d16 v194, v194
ds_read_u16_d16_hi v193, v193
v_pk_mul_f16 v204, v205, v204
v_lshrrev_b32_e64 v195, 18, v195
v_mfma_f32_16x16x32_bf16 v[188:191], v[40:43], v[100:103], 0
v_exp_f16_e64 v241, v242
v_and_b32 v197, s49, v197
s_waitcnt lgkmcnt(5)
v_mfma_f32_16x16x32_f16 v[68:71], v[44:47], v[232:235], v[68:71]
ds_read_b128 v[40:43], v248 offset:61440
ds_read_u16_d16_hi v195, v195
v_and_b32_e64 v199, s49, v199
v_mfma_f32_16x16x32_f16 v[76:79], v[44:47], v[236:239], v[76:79]
v_exp_f16_e64 v206, v207
v_bfe_u32 v196, v197, 2, 14
v_bfe_u32 v198, v199, 2, 14
v_mfma_f32_16x16x32_bf16 v[176:179], v[224:227], v[104:107], v[176:179]
buffer_store_dwordx4 v[152:155], v255, s[8:11], s68 offen offset:256 sc1
ds_read_b128 v[44:47], v248 offset:61696
ds_read_u16_d16 v196, v196
ds_read_u16_d16 v198, v198
v_exp_f16_e64 v203, v204
v_mfma_f32_16x16x32_bf16 v[184:187], v[224:227], v[108:111], v[184:187]
v_lshrrev_b32 v197, 18, v197
v_lshrrev_b32 v199, 18, v199
v_mfma_f32_16x16x32_f16 v[80:83], v[228:231], v[232:235], v[80:83]
ds_read_b128 v[224:227], v249 offset:61440
ds_read_u16_d16_hi v197, v197
ds_read_u16_d16_hi v199, v199
v_exp_f16_sdwa v241, v242 dst_sel:WORD_1 dst_unused:UNUSED_PRESERVE src0_sel:WORD_1
v_and_b32 v201, s49, v201
v_mfma_f32_16x16x32_f16 v[168:171], v[228:231], v[236:239], v[168:171]
v_bfe_u32 v200, v201, 2, 14
s_waitcnt lgkmcnt(8)
v_mfma_f32_16x16x32_f16 v[84:87], v[0:3], v[232:235], v[84:87]
ds_read_b128 v[228:231], v249 offset:61696
ds_read_u16_d16 v200, v200
v_exp_f16_sdwa v206, v207 dst_sel:WORD_1 dst_unused:UNUSED_PRESERVE src0_sel:WORD_1
v_lshrrev_b32_e64 v201, 18, v201
v_mfma_f32_16x16x32_f16 v[172:175], v[0:3], v[236:239], v[172:175]
v_exp_f16_sdwa v203, v204 dst_sel:WORD_1 dst_unused:UNUSED_PRESERVE src0_sel:WORD_1
v_pk_add_f16 v241, v241, 1.0 op_sel_hi:[1,0]
v_mfma_f32_16x16x32_bf16 v[180:183], v[4:7], v[104:107], v[180:183]
ds_read_b128 v[0:3], v249
ds_read_u16_d16_hi v201, v201
v_pk_add_f16 v206, v206, 1.0 op_sel_hi:[1,0]
v_pk_add_f16 v203, v203, 1.0 op_sel_hi:[1,0]
v_mfma_f32_16x16x32_bf16 v[188:191], v[4:7], v[108:111], v[188:191]
v_rcp_f16_e64 v242, v241
s_setprio 0
s_waitcnt lgkmcnt(7)
v_mfma_f32_16x16x32_bf16 v[176:179], v[40:43], v[112:115], v[176:179]
ds_read_b128 v[4:7], v249 offset:62464
v_rcp_f16_e64 v207, v206
v_mfma_f32_16x16x32_bf16 v[184:187], v[40:43], v[116:119], v[184:187]
v_rcp_f16_e64 v204, v203
v_mfma_f32_16x16x32_bf16 v[180:183], v[44:47], v[112:115], v[180:183]
ds_read_b128 v[40:43], v249 offset:256
v_rcp_f16_sdwa v242, v241 dst_sel:WORD_1 dst_unused:UNUSED_PRESERVE src0_sel:WORD_1
v_mfma_f32_16x16x32_bf16 v[188:191], v[44:47], v[116:119], v[188:191]
v_rcp_f16_sdwa v207, v206 dst_sel:WORD_1 dst_unused:UNUSED_PRESERVE src0_sel:WORD_1
v_or_b32 v232, v192, v193
v_or_b32 v233, v194, v195
s_waitcnt lgkmcnt(4)
v_or_b32 v234, v196, v197
v_rcp_f16_sdwa v204, v203 dst_sel:WORD_1 dst_unused:UNUSED_PRESERVE src0_sel:WORD_1
v_or_b32 v235, v198, v199
s_waitcnt lgkmcnt(2)
v_or_b32_e64 v236, v200, v201
v_pk_mul_f16 v237, v243, v242
v_pk_mul_f16 v238, v240, v207
v_pk_mul_f16 v239, v205, v204
v_mfma_f32_16x16x32_f16 v[48:51], v[224:227], v[232:235], v[48:51]
s_add_u32 s46, s69, 98304
buffer_load_dwordx4 v[32:35], v252, s[4:7], s46 offen offset:64
ds_read_b128 v[44:47], v249 offset:62720
v_cvt_pkrtz_f16_f32 v193, v176, v177
v_cvt_pkrtz_f16_f32 v195, v178, v179
v_mfma_f32_16x16x32_f16 v[56:59], v[224:227], v[236:239], v[56:59]
v_cvt_pkrtz_f16_f32 v197, v180, v181
v_cvt_pkrtz_f16_f32 v199, v182, v183
v_mfma_f32_16x16x32_f16 v[52:55], v[228:231], v[232:235], v[52:55]
ds_read_b128 v[224:227], v249 offset:1024
v_cvt_pkrtz_f16_f32 v201, v184, v185
v_cvt_pk_f16_f32 v243, v186, v187
v_mfma_f32_16x16x32_f16 v[60:63], v[228:231], v[236:239], v[60:63]
v_cvt_pk_f16_f32 v240, v188, v189
v_cvt_pk_f16_f32 v205, v190, v191
v_mfma_f32_16x16x32_bf16 v[176:179], v[0:3], v[96:99], 0
ds_read_b128 v[228:231], v249 offset:63488
v_pk_fma_f16 v242, v243, v243, s48
v_and_b32_e64 v193, s49, v193
v_mfma_f32_16x16x32_bf16 v[184:187], v[0:3], v[100:103], 0
v_pk_fma_f16 v207, v240, v240, s48
v_and_b32 v195, s49, v195
s_waitcnt lgkmcnt(3)
v_mfma_f32_16x16x32_f16 v[64:67], v[4:7], v[232:235], v[64:67]
ds_read_b128 v[0:3], v249 offset:63744
v_pk_fma_f16 v204, v205, v205, s48
v_bfe_u32 v192, v193, 2, 14
v_mfma_f32_16x16x32_f16 v[72:75], v[4:7], v[236:239], v[72:75]
v_pk_mul_f16 v242, v243, v242
v_bfe_u32 v194, v195, 2, 14
s_waitcnt vmcnt(8)
v_mfma_f32_16x16x32_bf16 v[160:163], v[26:29], v[216:219], v[160:163]
ds_read_b128 v[4:7], v249 offset:1280
ds_read_u16_d16 v192, v192
ds_read_u16_d16 v194, v194
v_pk_mul_f16 v207, v240, v207
v_lshrrev_b32 v193, 18, v193
v_mfma_f32_16x16x32_bf16 v[164:167], v[24:27], v[216:219], v[164:167]
v_pk_mul_f16 v204, v205, v204
v_lshrrev_b32_e64 v195, 18, v195
v_mfma_f32_16x16x32_bf16 v[180:183], v[40:43], v[96:99], 0
ds_read_u16_d16_hi v193, v193
ds_read_u16_d16_hi v195, v195
v_exp_f16_e64 v241, v242
v_mfma_f32_16x16x32_bf16 v[188:191], v[40:43], v[100:103], 0
v_and_b32_e64 v197, s49, v197
v_and_b32 v199, s49, v199
s_waitcnt lgkmcnt(6)
v_mfma_f32_16x16x32_f16 v[68:71], v[44:47], v[232:235], v[68:71]
ds_read_b128 v[40:43], v249 offset:2048
v_exp_f16_e64 v206, v207
v_mfma_f32_16x16x32_f16 v[76:79], v[44:47], v[236:239], v[76:79]
v_bfe_u32 v196, v197, 2, 14
v_bfe_u32 v198, v199, 2, 14
v_mfma_f32_16x16x32_bf16 v[176:179], v[224:227], v[104:107], v[176:179]
ds_read_b128 v[44:47], v249 offset:2304
ds_read_u16_d16 v196, v196
ds_read_u16_d16 v198, v198
v_exp_f16_e64 v203, v204
v_mfma_f32_16x16x32_bf16 v[184:187], v[224:227], v[108:111], v[184:187]
v_lshrrev_b32 v197, 18, v197
v_lshrrev_b32 v199, 18, v199
v_mfma_f32_16x16x32_f16 v[80:83], v[228:231], v[232:235], v[80:83]
ds_read_b128 v[224:227], v250 offset:2048
ds_read_u16_d16_hi v197, v197
ds_read_u16_d16_hi v199, v199
v_exp_f16_sdwa v241, v242 dst_sel:WORD_1 dst_unused:UNUSED_PRESERVE src0_sel:WORD_1
v_mfma_f32_16x16x32_f16 v[168:171], v[228:231], v[236:239], v[168:171]
v_and_b32 v201, s49, v201
v_bfe_u32 v200, v201, 2, 14
s_waitcnt lgkmcnt(7)
v_mfma_f32_16x16x32_f16 v[84:87], v[0:3], v[232:235], v[84:87]
ds_read_b128 v[228:231], v250 offset:2304
ds_read_u16_d16 v200, v200
v_exp_f16_sdwa v206, v207 dst_sel:WORD_1 dst_unused:UNUSED_PRESERVE src0_sel:WORD_1
v_mfma_f32_16x16x32_f16 v[172:175], v[0:3], v[236:239], v[172:175]
v_lshrrev_b32 v201, 18, v201
s_waitcnt vmcnt(7)
v_mfma_f32_16x16x32_bf16 v[48:51], v[26:29], v[12:15], v[48:51]
ds_read_b128 v[0:3], v249 offset:6144
ds_read_u16_d16_hi v201, v201
v_exp_f16_sdwa v203, v204 dst_sel:WORD_1 dst_unused:UNUSED_PRESERVE src0_sel:WORD_1
v_pk_add_f16 v241, v241, 1.0 op_sel_hi:[1,0]
v_mfma_f32_16x16x32_bf16 v[52:55], v[24:27], v[12:15], v[52:55]
v_pk_add_f16 v206, v206, 1.0 op_sel_hi:[1,0]
v_pk_add_f16 v203, v203, 1.0 op_sel_hi:[1,0]
v_mfma_f32_16x16x32_bf16 v[180:183], v[4:7], v[104:107], v[180:183]
v_rcp_f16_e64 v242, v241
v_mfma_f32_16x16x32_bf16 v[188:191], v[4:7], v[108:111], v[188:191]
v_rcp_f16 v207, v206
s_waitcnt lgkmcnt(4)
v_mfma_f32_16x16x32_bf16 v[176:179], v[40:43], v[112:115], v[176:179]
ds_read_b128 v[4:7], v250 offset:3072
v_rcp_f16_e64 v204, v203
v_mfma_f32_16x16x32_bf16 v[184:187], v[40:43], v[116:119], v[184:187]
v_rcp_f16_sdwa v242, v241 dst_sel:WORD_1 dst_unused:UNUSED_PRESERVE src0_sel:WORD_1
v_mfma_f32_16x16x32_bf16 v[180:183], v[44:47], v[112:115], v[180:183]
ds_read_b128 v[40:43], v249 offset:6400
v_rcp_f16_sdwa v207, v206 dst_sel:WORD_1 dst_unused:UNUSED_PRESERVE src0_sel:WORD_1
v_mfma_f32_16x16x32_bf16 v[188:191], v[44:47], v[116:119], v[188:191]
v_or_b32 v232, v192, v193
v_or_b32 v233, v194, v195
v_or_b32_e64 v234, v196, v197
v_rcp_f16_sdwa v204, v203 dst_sel:WORD_1 dst_unused:UNUSED_PRESERVE src0_sel:WORD_1
v_or_b32 v235, v198, v199
s_waitcnt lgkmcnt(2)
v_or_b32_e64 v236, v200, v201
v_pk_mul_f16 v237, v243, v242
v_pk_mul_f16 v238, v240, v207
v_pk_mul_f16 v239, v205, v204
v_mfma_f32_16x16x32_f16 v[48:51], v[224:227], v[232:235], v[48:51]
s_add_u32 s46, s69, 98304
buffer_load_dwordx4 v[216:219], v252, s[4:7], s46 offen offset:128
ds_read_b128 v[44:47], v250 offset:3328
v_cvt_pkrtz_f16_f32 v193, v176, v177
v_cvt_pkrtz_f16_f32 v195, v178, v179
v_mfma_f32_16x16x32_f16 v[56:59], v[224:227], v[236:239], v[56:59]
v_cvt_pkrtz_f16_f32 v197, v180, v181
v_cvt_pkrtz_f16_f32 v199, v182, v183
v_cvt_pkrtz_f16_f32 v201, v184, v185
v_mfma_f32_16x16x32_f16 v[52:55], v[228:231], v[232:235], v[52:55]
ds_read_b128 v[224:227], v249 offset:7168
v_cvt_pkrtz_f16_f32 v203, v186, v187
v_cvt_pk_f16_f32 v243, v188, v189
v_cvt_pk_f16_f32 v240, v190, v191
v_mfma_f32_16x16x32_f16 v[60:63], v[228:231], v[236:239], v[60:63]
v_pk_fma_f16 v242, v243, v243, s48
v_cvt_pk_bf16_f32 v144, v144, v145
v_and_b32_e64 v193, s49, v193
v_mfma_f32_16x16x32_bf16 v[176:179], v[0:3], v[96:99], 0
ds_read_b128 v[228:231], v250 offset:4096
v_cvt_pk_bf16_f32 v145, v146, v147
v_and_b32 v195, s49, v195
v_mfma_f32_16x16x32_bf16 v[184:187], v[0:3], v[100:103], 0
v_cvt_pk_bf16_f32 v146, v148, v149
v_pk_fma_f16 v207, v240, v240, s48
v_bfe_u32 v192, v193, 2, 14
s_waitcnt lgkmcnt(3)
v_mfma_f32_16x16x32_f16 v[64:67], v[4:7], v[232:235], v[64:67]
ds_read_b128 v[0:3], v250 offset:4352
ds_read_u16_d16 v192, v192
v_cvt_pk_bf16_f32 v147, v150, v151
v_pk_mul_f16 v242, v243, v242
v_cvt_pk_bf16_f32 v128, v128, v129
v_mfma_f32_16x16x32_f16 v[72:75], v[4:7], v[236:239], v[72:75]
v_bfe_u32 v194, v195, 2, 14
v_cvt_pk_bf16_f32 v129, v130, v131
v_pk_mul_f16 v207, v240, v207
s_waitcnt vmcnt(6)
v_mfma_f32_16x16x32_bf16 v[64:67], v[26:29], v[244:247], v[64:67]
ds_read_b128 v[4:7], v249 offset:7424
ds_read_u16_d16 v194, v194
v_lshrrev_b32 v193, 18, v193
v_cvt_pk_bf16_f32 v130, v132, v133
v_mfma_f32_16x16x32_bf16 v[68:71], v[24:27], v[244:247], v[68:71]
v_exp_f16_e64 v241, v242
v_cvt_pk_bf16_f32 v131, v134, v135
v_mfma_f32_16x16x32_bf16 v[180:183], v[40:43], v[96:99], 0
ds_read_u16_d16_hi v193, v193
v_lshrrev_b32_e64 v195, 18, v195
v_cvt_pk_bf16_f32 v160, v160, v161
v_and_b32_e64 v197, s49, v197
v_mfma_f32_16x16x32_bf16 v[188:191], v[40:43], v[100:103], 0
v_cvt_pk_bf16_f32 v161, v162, v163
v_exp_f16 v206, v207
s_waitcnt lgkmcnt(3)
v_mfma_f32_16x16x32_f16 v[68:71], v[44:47], v[232:235], v[68:71]
ds_read_b128 v[40:43], v249 offset:8192
ds_read_u16_d16_hi v195, v195
v_cvt_pk_bf16_f32 v162, v164, v165
v_and_b32 v199, s49, v199
v_mfma_f32_16x16x32_f16 v[76:79], v[44:47], v[236:239], v[76:79]
v_cvt_pk_bf16_f32 v163, v166, v167
s_mov_b64 vcc, s[74:75]
v_bfe_u32 v196, v197, 2, 14
v_cndmask_b32_e64 v148, v128, v160, s[74:75]
v_mfma_f32_16x16x32_bf16 v[176:179], v[224:227], v[104:107], v[176:179]
ds_read_b128 v[44:47], v249 offset:8448
ds_read_u16_d16 v196, v196
v_exp_f16_sdwa v241, v242 dst_sel:WORD_1 dst_unused:UNUSED_PRESERVE src0_sel:WORD_1
v_cndmask_b32_dpp v128, v144, v128, vcc quad_perm:[1,0,3,2] row_mask:0xf bank_mask:0xf
v_mfma_f32_16x16x32_bf16 v[184:187], v[224:227], v[108:111], v[184:187]
v_bfe_u32 v198, v199, 2, 14
v_cndmask_b32_e64 v149, v129, v161, s[74:75]
v_lshrrev_b32_e64 v197, 18, v197
v_mfma_f32_16x16x32_f16 v[80:83], v[228:231], v[232:235], v[80:83]
ds_read_b128 v[224:227], v250 offset:8192
ds_read_u16_d16 v198, v198
ds_read_u16_d16_hi v197, v197
v_cndmask_b32_dpp v129, v145, v129, vcc quad_perm:[1,0,3,2] row_mask:0xf bank_mask:0xf
v_lshrrev_b32_e64 v199, 18, v199
v_mfma_f32_16x16x32_f16 v[168:171], v[228:231], v[236:239], v[168:171]
v_exp_f16_sdwa v206, v207 dst_sel:WORD_1 dst_unused:UNUSED_PRESERVE src0_sel:WORD_1
v_cndmask_b32_e64 v150, v130, v162, s[74:75]
v_mfma_f32_16x16x32_f16 v[84:87], v[0:3], v[232:235], v[84:87]
ds_read_b128 v[228:231], v250 offset:8448
ds_read_u16_d16_hi v199, v199
v_cndmask_b32_dpp v130, v146, v130, vcc quad_perm:[1,0,3,2] row_mask:0xf bank_mask:0xf
v_and_b32_e64 v201, s49, v201
v_cndmask_b32_e64 v151, v131, v163, s[74:75]
v_mfma_f32_16x16x32_f16 v[172:175], v[0:3], v[236:239], v[172:175]
v_and_b32_e64 v203, s49, v203
v_pk_add_f16 v241, v241, 1.0 op_sel_hi:[1,0]
v_cndmask_b32_dpp v131, v147, v131, vcc quad_perm:[1,0,3,2] row_mask:0xf bank_mask:0xf
s_not_b64 vcc, s[74:75]
s_waitcnt lgkmcnt(5)
v_mfma_f32_16x16x32_bf16 v[180:183], v[4:7], v[104:107], v[180:183]
ds_read_b128 v[0:3], v249 offset:12288
v_bfe_u32 v200, v201, 2, 14
v_cndmask_b32_dpp v160, v144, v160, vcc quad_perm:[1,0,3,2] row_mask:0xf bank_mask:0xf
v_pk_add_f16 v206, v206, 1.0 op_sel_hi:[1,0]
v_mfma_f32_16x16x32_bf16 v[188:191], v[4:7], v[108:111], v[188:191]
v_cndmask_b32_dpp v161, v145, v161, vcc quad_perm:[1,0,3,2] row_mask:0xf bank_mask:0xf
v_bfe_u32 v202, v203, 2, 14
v_mfma_f32_16x16x32_bf16 v[176:179], v[40:43], v[112:115], v[176:179]
ds_read_b128 v[4:7], v250 offset:9216
ds_read_u16_d16 v200, v200
ds_read_u16_d16 v202, v202
v_rcp_f16_e64 v242, v241
v_cndmask_b32_dpp v162, v146, v162, vcc quad_perm:[1,0,3,2] row_mask:0xf bank_mask:0xf
v_mfma_f32_16x16x32_bf16 v[184:187], v[40:43], v[116:119], v[184:187]
v_cndmask_b32_dpp v163, v147, v163, vcc quad_perm:[1,0,3,2] row_mask:0xf bank_mask:0xf
v_lshrrev_b32 v201, 18, v201
v_lshrrev_b32 v203, 18, v203
v_mfma_f32_16x16x32_bf16 v[180:183], v[44:47], v[112:115], v[180:183]
ds_read_b128 v[40:43], v249 offset:12544
s_add_u32 s46, s68, 98304
buffer_store_dwordx4 v[128:131], v255, s[8:11], s46 offen sc1
ds_read_u16_d16_hi v201, v201
ds_read_u16_d16_hi v203, v203
v_rcp_f16_e64 v207, v206
v_mfma_f32_16x16x32_bf16 v[188:191], v[44:47], v[116:119], v[188:191]
v_rcp_f16_sdwa v242, v241 dst_sel:WORD_1 dst_unused:UNUSED_PRESERVE src0_sel:WORD_1
v_or_b32 v232, v192, v193
v_or_b32 v233, v194, v195
s_waitcnt lgkmcnt(6)
v_or_b32 v234, v196, v197
v_rcp_f16_sdwa v207, v206 dst_sel:WORD_1 dst_unused:UNUSED_PRESERVE src0_sel:WORD_1
v_or_b32 v235, v198, v199
s_waitcnt lgkmcnt(1)
v_or_b32 v236, v200, v201
s_waitcnt lgkmcnt(0)
v_or_b32_e64 v237, v202, v203
v_pk_mul_f16 v238, v243, v242
v_pk_mul_f16 v239, v240, v207
v_mfma_f32_16x16x32_f16 v[48:51], v[224:227], v[232:235], v[48:51]
s_add_u32 s46, s68, 98304
buffer_store_dwordx4 v[148:151], v255, s[8:11], s46 offen offset:128 sc1
ds_read_b128 v[44:47], v250 offset:9472
v_cvt_pkrtz_f16_f32 v193, v176, v177
v_cvt_pkrtz_f16_f32 v195, v178, v179
v_mfma_f32_16x16x32_f16 v[56:59], v[224:227], v[236:239], v[56:59]
v_cvt_pkrtz_f16_f32 v197, v180, v181
v_cvt_pkrtz_f16_f32 v199, v182, v183
v_mfma_f32_16x16x32_f16 v[52:55], v[228:231], v[232:235], v[52:55]
ds_read_b128 v[224:227], v249 offset:13312
v_cvt_pkrtz_f16_f32 v201, v184, v185
v_cvt_pk_f16_f32 v243, v186, v187
v_mfma_f32_16x16x32_f16 v[60:63], v[228:231], v[236:239], v[60:63]
v_cvt_pk_f16_f32 v240, v188, v189
v_cvt_pk_f16_f32 v205, v190, v191
v_mfma_f32_16x16x32_bf16 v[176:179], v[0:3], v[96:99], 0
ds_read_b128 v[228:231], v250 offset:10240
v_pk_fma_f16 v242, v243, v243, s48
v_and_b32_e64 v193, s49, v193
v_mfma_f32_16x16x32_bf16 v[184:187], v[0:3], v[100:103], 0
v_pk_fma_f16 v207, v240, v240, s48
v_and_b32_e64 v195, s49, v195
v_mfma_f32_16x16x32_f16 v[64:67], v[4:7], v[232:235], v[64:67]
ds_read_b128 v[0:3], v250 offset:10496
v_pk_fma_f16 v204, v205, v205, s48
v_bfe_u32 v192, v193, 2, 14
v_pk_mul_f16 v242, v243, v242
v_mfma_f32_16x16x32_f16 v[72:75], v[4:7], v[236:239], v[72:75]
v_bfe_u32 v194, v195, 2, 14
v_pk_mul_f16 v207, v240, v207
s_waitcnt vmcnt(6)
v_mfma_f32_16x16x32_bf16 v[80:83], v[26:29], v[8:11], v[80:83]
ds_read_b128 v[4:7], v249 offset:13568
ds_read_u16_d16 v192, v192
ds_read_u16_d16 v194, v194
v_lshrrev_b32 v193, 18, v193
v_pk_mul_f16 v204, v205, v204
v_mfma_f32_16x16x32_bf16 v[84:87], v[24:27], v[8:11], v[84:87]
v_lshrrev_b32_e64 v195, 18, v195
v_mfma_f32_16x16x32_bf16 v[180:183], v[40:43], v[96:99], 0
ds_read_u16_d16_hi v193, v193
ds_read_u16_d16_hi v195, v195
v_exp_f16 v241, v242
v_and_b32 v197, s49, v197
v_mfma_f32_16x16x32_bf16 v[188:191], v[40:43], v[100:103], 0
v_and_b32 v199, s49, v199
s_waitcnt lgkmcnt(6)
v_mfma_f32_16x16x32_f16 v[68:71], v[44:47], v[232:235], v[68:71]
ds_read_b128 v[40:43], v249 offset:14336
v_exp_f16_e64 v206, v207
v_bfe_u32 v196, v197, 2, 14
v_mfma_f32_16x16x32_f16 v[76:79], v[44:47], v[236:239], v[76:79]
v_bfe_u32 v198, v199, 2, 14
v_exp_f16_e64 v203, v204
v_mfma_f32_16x16x32_bf16 v[176:179], v[224:227], v[104:107], v[176:179]
ds_read_b128 v[44:47], v249 offset:14592
ds_read_u16_d16 v196, v196
ds_read_u16_d16 v198, v198
v_lshrrev_b32 v197, 18, v197
v_lshrrev_b32 v199, 18, v199
v_mfma_f32_16x16x32_bf16 v[184:187], v[224:227], v[108:111], v[184:187]
v_exp_f16_sdwa v241, v242 dst_sel:WORD_1 dst_unused:UNUSED_PRESERVE src0_sel:WORD_1
v_mfma_f32_16x16x32_f16 v[80:83], v[228:231], v[232:235], v[80:83]
ds_read_b128 v[224:227], v250 offset:14336
ds_read_u16_d16_hi v197, v197
ds_read_u16_d16_hi v199, v199
v_and_b32 v201, s49, v201
v_bfe_u32 v200, v201, 2, 14
v_mfma_f32_16x16x32_f16 v[168:171], v[228:231], v[236:239], v[168:171]
v_exp_f16_sdwa v206, v207 dst_sel:WORD_1 dst_unused:UNUSED_PRESERVE src0_sel:WORD_1
s_waitcnt lgkmcnt(7)
v_mfma_f32_16x16x32_f16 v[84:87], v[0:3], v[232:235], v[84:87]
ds_read_b128 v[228:231], v250 offset:14592
ds_read_u16_d16 v200, v200
v_lshrrev_b32_e64 v201, 18, v201
v_mfma_f32_16x16x32_f16 v[172:175], v[0:3], v[236:239], v[172:175]
v_exp_f16_sdwa v203, v204 dst_sel:WORD_1 dst_unused:UNUSED_PRESERVE src0_sel:WORD_1
v_pk_add_f16 v241, v241, 1.0 op_sel_hi:[1,0]
v_pk_add_f16 v206, v206, 1.0 op_sel_hi:[1,0]
v_mfma_f32_16x16x32_bf16 v[180:183], v[4:7], v[104:107], v[180:183]
ds_read_b128 v[0:3], v249 offset:18432
ds_read_u16_d16_hi v201, v201
v_pk_add_f16 v203, v203, 1.0 op_sel_hi:[1,0]
v_mfma_f32_16x16x32_bf16 v[188:191], v[4:7], v[108:111], v[188:191]
v_rcp_f16 v242, v241
s_waitcnt lgkmcnt(7)
v_mfma_f32_16x16x32_bf16 v[176:179], v[40:43], v[112:115], v[176:179]
ds_read_b128 v[4:7], v250 offset:15360
v_rcp_f16_e64 v207, v206
v_mfma_f32_16x16x32_bf16 v[184:187], v[40:43], v[116:119], v[184:187]
v_rcp_f16_e64 v204, v203
v_mfma_f32_16x16x32_bf16 v[180:183], v[44:47], v[112:115], v[180:183]
ds_read_b128 v[40:43], v249 offset:18688
v_rcp_f16_sdwa v242, v241 dst_sel:WORD_1 dst_unused:UNUSED_PRESERVE src0_sel:WORD_1
v_mfma_f32_16x16x32_bf16 v[188:191], v[44:47], v[116:119], v[188:191]
v_rcp_f16_sdwa v207, v206 dst_sel:WORD_1 dst_unused:UNUSED_PRESERVE src0_sel:WORD_1
v_or_b32 v232, v192, v193
v_or_b32 v233, v194, v195
s_waitcnt lgkmcnt(4)
v_or_b32 v234, v196, v197
v_rcp_f16_sdwa v204, v203 dst_sel:WORD_1 dst_unused:UNUSED_PRESERVE src0_sel:WORD_1
v_or_b32 v235, v198, v199
s_waitcnt lgkmcnt(2)
v_or_b32_e64 v236, v200, v201
v_pk_mul_f16 v237, v243, v242
v_pk_mul_f16 v238, v240, v207
v_pk_mul_f16 v239, v205, v204
v_mfma_f32_16x16x32_f16 v[48:51], v[224:227], v[232:235], v[48:51]
ds_read_b128 v[44:47], v250 offset:15616
v_cvt_pkrtz_f16_f32 v193, v176, v177
v_cvt_pkrtz_f16_f32 v195, v178, v179
v_mfma_f32_16x16x32_f16 v[56:59], v[224:227], v[236:239], v[56:59]
v_cvt_pkrtz_f16_f32 v197, v180, v181
v_cvt_pkrtz_f16_f32 v199, v182, v183
v_mfma_f32_16x16x32_f16 v[52:55], v[228:231], v[232:235], v[52:55]
ds_read_b128 v[224:227], v249 offset:19456
v_cvt_pkrtz_f16_f32 v201, v184, v185
v_cvt_pk_f16_f32 v243, v186, v187
v_mfma_f32_16x16x32_f16 v[60:63], v[228:231], v[236:239], v[60:63]
v_cvt_pk_f16_f32 v240, v188, v189
v_cvt_pk_f16_f32 v205, v190, v191
v_mfma_f32_16x16x32_bf16 v[176:179], v[0:3], v[96:99], 0
ds_read_b128 v[228:231], v250 offset:16384
v_pk_fma_f16 v242, v243, v243, s48
v_and_b32_e64 v193, s49, v193
v_mfma_f32_16x16x32_bf16 v[184:187], v[0:3], v[100:103], 0
v_pk_fma_f16 v207, v240, v240, s48
v_and_b32 v195, s49, v195
s_waitcnt lgkmcnt(3)
v_mfma_f32_16x16x32_f16 v[64:67], v[4:7], v[232:235], v[64:67]
ds_read_b128 v[0:3], v250 offset:16640
v_pk_fma_f16 v204, v205, v205, s48
v_bfe_u32 v192, v193, 2, 14
v_pk_mul_f16 v242, v243, v242
v_mfma_f32_16x16x32_f16 v[72:75], v[4:7], v[236:239], v[72:75]
v_bfe_u32 v194, v195, 2, 14
v_pk_mul_f16 v207, v240, v207
s_waitcnt vmcnt(5)
v_mfma_f32_16x16x32_bf16 v[56:59], v[26:29], v[36:39], v[56:59]
ds_read_b128 v[4:7], v249 offset:19712
ds_read_u16_d16 v192, v192
ds_read_u16_d16 v194, v194
v_lshrrev_b32 v193, 18, v193
v_pk_mul_f16 v204, v205, v204
v_mfma_f32_16x16x32_bf16 v[60:63], v[24:27], v[36:39], v[60:63]
v_lshrrev_b32_e64 v195, 18, v195
v_mfma_f32_16x16x32_bf16 v[180:183], v[40:43], v[96:99], 0
ds_read_u16_d16_hi v193, v193
ds_read_u16_d16_hi v195, v195
v_exp_f16 v241, v242
v_and_b32 v197, s49, v197
v_mfma_f32_16x16x32_bf16 v[188:191], v[40:43], v[100:103], 0
v_and_b32 v199, s49, v199
s_waitcnt lgkmcnt(6)
v_mfma_f32_16x16x32_f16 v[68:71], v[44:47], v[232:235], v[68:71]
ds_read_b128 v[40:43], v249 offset:20480
v_exp_f16_e64 v206, v207
v_bfe_u32 v196, v197, 2, 14
v_mfma_f32_16x16x32_f16 v[76:79], v[44:47], v[236:239], v[76:79]
v_bfe_u32 v198, v199, 2, 14
v_exp_f16_e64 v203, v204
v_mfma_f32_16x16x32_bf16 v[176:179], v[224:227], v[104:107], v[176:179]
ds_read_b128 v[44:47], v249 offset:20736
ds_read_u16_d16 v196, v196
ds_read_u16_d16 v198, v198
v_lshrrev_b32 v197, 18, v197
v_lshrrev_b32 v199, 18, v199
v_mfma_f32_16x16x32_bf16 v[184:187], v[224:227], v[108:111], v[184:187]
v_exp_f16_sdwa v241, v242 dst_sel:WORD_1 dst_unused:UNUSED_PRESERVE src0_sel:WORD_1
v_mfma_f32_16x16x32_f16 v[80:83], v[228:231], v[232:235], v[80:83]
ds_read_b128 v[224:227], v250 offset:20480
ds_read_u16_d16_hi v197, v197
ds_read_u16_d16_hi v199, v199
v_and_b32 v201, s49, v201
v_bfe_u32 v200, v201, 2, 14
v_mfma_f32_16x16x32_f16 v[168:171], v[228:231], v[236:239], v[168:171]
v_exp_f16_sdwa v206, v207 dst_sel:WORD_1 dst_unused:UNUSED_PRESERVE src0_sel:WORD_1
s_waitcnt lgkmcnt(7)
v_mfma_f32_16x16x32_f16 v[84:87], v[0:3], v[232:235], v[84:87]
ds_read_b128 v[228:231], v250 offset:20736
ds_read_u16_d16 v200, v200
v_lshrrev_b32_e64 v201, 18, v201
v_mfma_f32_16x16x32_f16 v[172:175], v[0:3], v[236:239], v[172:175]
v_exp_f16_sdwa v203, v204 dst_sel:WORD_1 dst_unused:UNUSED_PRESERVE src0_sel:WORD_1
v_pk_add_f16 v241, v241, 1.0 op_sel_hi:[1,0]
v_pk_add_f16 v206, v206, 1.0 op_sel_hi:[1,0]
v_mfma_f32_16x16x32_bf16 v[180:183], v[4:7], v[104:107], v[180:183]
ds_read_b128 v[0:3], v250 offset:21504
ds_read_u16_d16_hi v201, v201
v_pk_add_f16 v203, v203, 1.0 op_sel_hi:[1,0]
v_mfma_f32_16x16x32_bf16 v[188:191], v[4:7], v[108:111], v[188:191]
v_rcp_f16 v242, v241
s_waitcnt lgkmcnt(7)
v_mfma_f32_16x16x32_bf16 v[176:179], v[40:43], v[112:115], v[176:179]
ds_read_b128 v[4:7], v250 offset:21760
v_rcp_f16_e64 v207, v206
v_mfma_f32_16x16x32_bf16 v[184:187], v[40:43], v[116:119], v[184:187]
v_rcp_f16_e64 v204, v203
v_mfma_f32_16x16x32_bf16 v[180:183], v[44:47], v[112:115], v[180:183]
ds_read_b128 v[40:43], v250 offset:22528
v_rcp_f16_sdwa v242, v241 dst_sel:WORD_1 dst_unused:UNUSED_PRESERVE src0_sel:WORD_1
v_mfma_f32_16x16x32_bf16 v[188:191], v[44:47], v[116:119], v[188:191]
v_rcp_f16_sdwa v207, v206 dst_sel:WORD_1 dst_unused:UNUSED_PRESERVE src0_sel:WORD_1
v_or_b32 v232, v192, v193
v_or_b32 v233, v194, v195
s_waitcnt lgkmcnt(4)
v_or_b32 v234, v196, v197
v_rcp_f16_sdwa v204, v203 dst_sel:WORD_1 dst_unused:UNUSED_PRESERVE src0_sel:WORD_1
v_or_b32 v235, v198, v199
s_waitcnt lgkmcnt(2)
v_or_b32_e64 v236, v200, v201
v_pk_mul_f16 v237, v243, v242
v_pk_mul_f16 v238, v240, v207
v_pk_mul_f16 v239, v205, v204
v_mfma_f32_16x16x32_f16 v[48:51], v[224:227], v[232:235], v[48:51]
s_add_u32 s46, s68, 98304
buffer_store_dwordx4 v[160:163], v255, s[8:11], s46 offen offset:256 sc1
ds_read_b128 v[44:47], v250 offset:22784
v_cvt_pkrtz_f16_f32 v193, v176, v177
v_cvt_pkrtz_f16_f32 v195, v178, v179
v_cvt_pkrtz_f16_f32 v197, v180, v181
v_cvt_pkrtz_f16_f32 v199, v182, v183
v_mfma_f32_16x16x32_f16 v[56:59], v[224:227], v[236:239], v[56:59]
v_cvt_pkrtz_f16_f32 v201, v184, v185
v_cvt_pk_f16_f32 v243, v186, v187
v_cvt_pk_f16_f32 v240, v188, v189
v_cvt_pk_f16_f32 v205, v190, v191
v_mfma_f32_16x16x32_f16 v[52:55], v[228:231], v[232:235], v[52:55]
ds_read_b128 v[224:227], v250 offset:26624
v_pk_fma_f16 v242, v243, v243, s48
v_and_b32_e64 v193, s49, v193
v_pk_fma_f16 v207, v240, v240, s48
v_and_b32_e64 v195, s49, v195
v_mfma_f32_16x16x32_f16 v[60:63], v[228:231], v[236:239], v[60:63]
v_pk_fma_f16 v204, v205, v205, s48
v_bfe_u32 v192, v193, 2, 14
v_pk_mul_f16 v242, v243, v242
v_bfe_u32 v194, v195, 2, 14
v_mfma_f32_16x16x32_f16 v[64:67], v[0:3], v[232:235], v[64:67]
ds_read_b128 v[228:231], v250 offset:26880
ds_read_u16_d16 v192, v192
ds_read_u16_d16 v194, v194
v_pk_mul_f16 v207, v240, v207
v_lshrrev_b32_e64 v193, 18, v193
v_pk_mul_f16 v204, v205, v204
v_lshrrev_b32_e64 v195, 18, v195
v_mfma_f32_16x16x32_f16 v[72:75], v[0:3], v[236:239], v[72:75]
v_exp_f16 v241, v242
v_and_b32 v197, s49, v197
v_and_b32 v199, s49, v199
s_waitcnt vmcnt(4)
v_mfma_f32_16x16x32_bf16 v[72:75], v[26:29], v[32:35], v[72:75]
ds_read_b128 v[0:3], v250 offset:27648
ds_read_u16_d16_hi v193, v193
ds_read_u16_d16_hi v195, v195
v_exp_f16_e64 v206, v207
v_bfe_u32 v196, v197, 2, 14
v_bfe_u32 v198, v199, 2, 14
v_mfma_f32_16x16x32_bf16 v[76:79], v[24:27], v[32:35], v[76:79]
v_exp_f16 v203, v204
v_lshrrev_b32 v197, 18, v197
v_lshrrev_b32 v199, 18, v199
s_waitcnt lgkmcnt(6)
v_mfma_f32_16x16x32_f16 v[68:71], v[4:7], v[232:235], v[68:71]
ds_read_u16_d16 v196, v196
ds_read_u16_d16 v198, v198
ds_read_u16_d16_hi v197, v197
ds_read_u16_d16_hi v199, v199
v_exp_f16_sdwa v241, v242 dst_sel:WORD_1 dst_unused:UNUSED_PRESERVE src0_sel:WORD_1
v_and_b32_e64 v201, s49, v201
v_bfe_u32 v200, v201, 2, 14
v_mfma_f32_16x16x32_f16 v[76:79], v[4:7], v[236:239], v[76:79]
v_exp_f16_sdwa v206, v207 dst_sel:WORD_1 dst_unused:UNUSED_PRESERVE src0_sel:WORD_1
v_lshrrev_b32_e64 v201, 18, v201
v_mfma_f32_16x16x32_f16 v[80:83], v[40:43], v[232:235], v[80:83]
ds_read_b128 v[4:7], v250 offset:27904
ds_read_u16_d16 v200, v200
ds_read_u16_d16_hi v201, v201
v_exp_f16_sdwa v203, v204 dst_sel:WORD_1 dst_unused:UNUSED_PRESERVE src0_sel:WORD_1
v_pk_add_f16 v241, v241, 1.0 op_sel_hi:[1,0]
v_pk_add_f16 v206, v206, 1.0 op_sel_hi:[1,0]
v_pk_add_f16 v203, v203, 1.0 op_sel_hi:[1,0]
v_mfma_f32_16x16x32_f16 v[168:171], v[40:43], v[236:239], v[168:171]
v_rcp_f16 v242, v241
v_rcp_f16 v207, v206
v_mfma_f32_16x16x32_f16 v[84:87], v[44:47], v[232:235], v[84:87]
ds_read_b128 v[40:43], v250 offset:28672
v_rcp_f16_e64 v204, v203
v_rcp_f16_sdwa v242, v241 dst_sel:WORD_1 dst_unused:UNUSED_PRESERVE src0_sel:WORD_1
v_mfma_f32_16x16x32_f16 v[172:175], v[44:47], v[236:239], v[172:175]
v_rcp_f16_sdwa v207, v206 dst_sel:WORD_1 dst_unused:UNUSED_PRESERVE src0_sel:WORD_1
s_waitcnt lgkmcnt(5)
v_or_b32 v232, v192, v193
v_or_b32_e64 v233, v194, v195
v_or_b32 v234, v196, v197
v_rcp_f16_sdwa v204, v203 dst_sel:WORD_1 dst_unused:UNUSED_PRESERVE src0_sel:WORD_1
s_waitcnt lgkmcnt(4)
v_or_b32 v235, v198, v199
s_waitcnt lgkmcnt(1)
v_or_b32 v236, v200, v201
v_pk_mul_f16 v237, v243, v242
v_pk_mul_f16 v238, v240, v207
v_pk_mul_f16 v239, v205, v204
s_waitcnt vmcnt(3)
v_mfma_f32_16x16x32_bf16 v[168:171], v[26:29], v[216:219], v[168:171]
ds_read_b128 v[44:47], v250 offset:28928
v_mfma_f32_16x16x32_bf16 v[172:175], v[24:27], v[216:219], v[172:175]
v_mfma_f32_16x16x32_f16 v[48:51], v[224:227], v[232:235], v[48:51]
s_waitcnt lgkmcnt(0)
v_mfma_f32_16x16x32_f16 v[52:55], v[228:231], v[232:235], v[52:55]
v_mfma_f32_16x16x32_f16 v[64:67], v[0:3], v[232:235], v[64:67]
v_mfma_f32_16x16x32_f16 v[68:71], v[4:7], v[232:235], v[68:71]
v_mfma_f32_16x16x32_f16 v[80:83], v[40:43], v[232:235], v[80:83]
v_mfma_f32_16x16x32_f16 v[84:87], v[44:47], v[232:235], v[84:87]
s_nop 4
v_cvt_pk_bf16_f32 v64, v64, v65
v_cvt_pk_bf16_f32 v65, v66, v67
v_cvt_pk_bf16_f32 v66, v68, v69
v_cvt_pk_bf16_f32 v67, v70, v71
v_cvt_pk_bf16_f32 v48, v48, v49
v_cvt_pk_bf16_f32 v49, v50, v51
v_cvt_pk_bf16_f32 v50, v52, v53
v_cvt_pk_bf16_f32 v51, v54, v55
v_cvt_pk_bf16_f32 v80, v80, v81
v_cvt_pk_bf16_f32 v81, v82, v83
v_cvt_pk_bf16_f32 v82, v84, v85
v_cvt_pk_bf16_f32 v83, v86, v87
s_mov_b64 vcc, s[74:75]
v_cndmask_b32_e64 v68, v48, v80, s[74:75]
v_mfma_f32_16x16x32_f16 v[56:59], v[224:227], v[236:239], v[56:59]
v_cndmask_b32_dpp v48, v64, v48, vcc quad_perm:[1,0,3,2] row_mask:0xf bank_mask:0xf
v_cndmask_b32_e64 v69, v49, v81, s[74:75]
v_mfma_f32_16x16x32_f16 v[60:63], v[228:231], v[236:239], v[60:63]
v_cndmask_b32_dpp v49, v65, v49, vcc quad_perm:[1,0,3,2] row_mask:0xf bank_mask:0xf
v_cndmask_b32_e64 v70, v50, v82, s[74:75]
v_mfma_f32_16x16x32_f16 v[72:75], v[0:3], v[236:239], v[72:75]
v_cndmask_b32_dpp v50, v66, v50, vcc quad_perm:[1,0,3,2] row_mask:0xf bank_mask:0xf
v_mfma_f32_16x16x32_f16 v[76:79], v[4:7], v[236:239], v[76:79]
v_cndmask_b32_e64 v71, v51, v83, s[74:75]
v_cndmask_b32_dpp v51, v67, v51, vcc quad_perm:[1,0,3,2] row_mask:0xf bank_mask:0xf
s_not_b64 vcc, s[74:75]
v_mfma_f32_16x16x32_f16 v[168:171], v[40:43], v[236:239], v[168:171]
v_cndmask_b32_dpp v80, v64, v80, vcc quad_perm:[1,0,3,2] row_mask:0xf bank_mask:0xf
v_cndmask_b32_dpp v81, v65, v81, vcc quad_perm:[1,0,3,2] row_mask:0xf bank_mask:0xf
v_mfma_f32_16x16x32_f16 v[172:175], v[44:47], v[236:239], v[172:175]
v_cndmask_b32_dpp v82, v66, v82, vcc quad_perm:[1,0,3,2] row_mask:0xf bank_mask:0xf
v_cndmask_b32_dpp v83, v67, v83, vcc quad_perm:[1,0,3,2] row_mask:0xf bank_mask:0xf
buffer_store_dwordx4 v[48:51], v255, s[8:11], s69 offen sc1
buffer_store_dwordx4 v[68:71], v255, s[8:11], s69 offen offset:128 sc1
buffer_store_dwordx4 v[80:83], v255, s[8:11], s69 offen offset:256 sc1
v_cvt_pk_bf16_f32 v72, v72, v73
v_cvt_pk_bf16_f32 v73, v74, v75
v_cvt_pk_bf16_f32 v74, v76, v77
v_cvt_pk_bf16_f32 v75, v78, v79
v_cvt_pk_bf16_f32 v56, v56, v57
v_cvt_pk_bf16_f32 v57, v58, v59
v_cvt_pk_bf16_f32 v58, v60, v61
v_cvt_pk_bf16_f32 v59, v62, v63
v_cvt_pk_bf16_f32 v168, v168, v169
v_cvt_pk_bf16_f32 v169, v170, v171
v_cvt_pk_bf16_f32 v170, v172, v173
v_cvt_pk_bf16_f32 v171, v174, v175
s_mov_b64 vcc, s[74:75]
v_cndmask_b32_e64 v76, v56, v168, s[74:75]
v_cndmask_b32_dpp v56, v72, v56, vcc quad_perm:[1,0,3,2] row_mask:0xf bank_mask:0xf
v_cndmask_b32_e64 v77, v57, v169, s[74:75]
v_cndmask_b32_dpp v57, v73, v57, vcc quad_perm:[1,0,3,2] row_mask:0xf bank_mask:0xf
v_cndmask_b32_e64 v78, v58, v170, s[74:75]
v_cndmask_b32_dpp v58, v74, v58, vcc quad_perm:[1,0,3,2] row_mask:0xf bank_mask:0xf
v_cndmask_b32_e64 v79, v59, v171, s[74:75]
v_cndmask_b32_dpp v59, v75, v59, vcc quad_perm:[1,0,3,2] row_mask:0xf bank_mask:0xf
s_not_b64 vcc, s[74:75]
v_cndmask_b32_dpp v168, v72, v168, vcc quad_perm:[1,0,3,2] row_mask:0xf bank_mask:0xf
v_cndmask_b32_dpp v169, v73, v169, vcc quad_perm:[1,0,3,2] row_mask:0xf bank_mask:0xf
v_cndmask_b32_dpp v170, v74, v170, vcc quad_perm:[1,0,3,2] row_mask:0xf bank_mask:0xf
v_cndmask_b32_dpp v171, v75, v171, vcc quad_perm:[1,0,3,2] row_mask:0xf bank_mask:0xf
s_add_u32 s46, s69, 98304
buffer_store_dwordx4 v[56:59], v255, s[8:11], s46 offen sc1
s_add_u32 s46, s69, 98304
buffer_store_dwordx4 v[76:79], v255, s[8:11], s46 offen offset:128 sc1
s_add_u32 s46, s69, 98304
buffer_store_dwordx4 v[168:171], v255, s[8:11], s46 offen offset:256 sc1
s_endpgm
Lpoll:
s_waitcnt vmcnt(0)
Lpoll1:
s_cmp_eq_u32 s77, 2
s_cbranch_scc1 LpollC
v_max_u32 v250, v156, v157
v_max3_u32 v250, v250, v158, v159
v_max3_u32 v250, v250, v160, v161
v_max3_u32 v250, v250, v162, v163
v_max3_u32 v250, v250, v164, v165
v_max3_u32 v250, v250, v166, v167
v_max3_u32 v250, v250, v252, v253
v_max3_u32 v250, v250, v254, v255
v_cmp_eq_u32 vcc, -1, v250
s_nop 4
s_cbranch_vccz LpollR
v_lshlrev_b32 v250, 4, v251
s_lshl_b32 s44, s2, 12
buffer_load_dwordx4 v[156:159], v250, s[32:35], s44 offen sc1
buffer_load_dwordx4 v[160:163], v250, s[32:35], s44 offen offset:1024 sc1
buffer_load_dwordx4 v[164:167], v250, s[32:35], s44 offen offset:2048 sc1
buffer_load_dwordx4 v[252:255], v250, s[32:35], s44 offen offset:3072 sc1
s_setpc_b64 s[78:79]
LpollR:
s_setprio 3
v_add_f32 v156, v156, v160
v_add_f32 v252, v164, v252
v_add_f32 v252, v156, v252
v_add_f32 v157, v157, v161
v_add_f32 v253, v165, v253
v_add_f32 v253, v157, v253
v_add_f32 v158, v158, v162
v_add_f32 v254, v166, v254
v_add_f32 v254, v158, v254
v_add_f32 v159, v159, v163
v_add_f32 v255, v167, v255
v_add_f32 v255, v159, v255
v_add_f32_dpp v252, v252, v252 row_ror:8 row_mask:0xf bank_mask:0xf
v_add_f32_dpp v253, v253, v253 row_ror:8 row_mask:0xf bank_mask:0xf
v_add_f32_dpp v254, v254, v254 row_ror:8 row_mask:0xf bank_mask:0xf
v_add_f32_dpp v255, v255, v255 row_ror:8 row_mask:0xf bank_mask:0xf
v_add_f32_dpp v252, v252, v252 row_ror:4 row_mask:0xf bank_mask:0xf
v_add_f32_dpp v253, v253, v253 row_ror:4 row_mask:0xf bank_mask:0xf
v_add_f32_dpp v254, v254, v254 row_ror:4 row_mask:0xf bank_mask:0xf
v_add_f32_dpp v255, v255, v255 row_ror:4 row_mask:0xf bank_mask:0xf
v_add_f32_dpp v252, v252, v252 row_ror:2 row_mask:0xf bank_mask:0xf
v_add_f32_dpp v253, v253, v253 row_ror:2 row_mask:0xf bank_mask:0xf
v_add_f32_dpp v254, v254, v254 row_ror:2 row_mask:0xf bank_mask:0xf
v_add_f32_dpp v255, v255, v255 row_ror:2 row_mask:0xf bank_mask:0xf
v_add_f32_dpp v252, v252, v252 row_ror:1 row_mask:0xf bank_mask:0xf
v_add_f32_dpp v253, v253, v253 row_ror:1 row_mask:0xf bank_mask:0xf
v_add_f32_dpp v254, v254, v254 row_ror:1 row_mask:0xf bank_mask:0xf
v_add_f32_dpp v255, v255, v255 row_ror:1 row_mask:0xf bank_mask:0xf
v_mov_b32 v156, v252
v_mov_b32 v157, v253
v_mov_b32 v158, v254
v_mov_b32 v159, v255
v_permlane16_swap_b32 v252, v156
v_permlane16_swap_b32 v253, v157
v_permlane16_swap_b32 v254, v158
v_permlane16_swap_b32 v255, v159
v_add_f32 v252, v252, v156
v_add_f32 v253, v253, v157
v_add_f32 v254, v254, v158
v_add_f32 v255, v255, v159
v_mov_b32 v156, v252
v_mov_b32 v157, v253
v_mov_b32 v158, v254
v_mov_b32 v159, v255
v_permlane32_swap_b32 v252, v156
v_permlane32_swap_b32 v253, v157
v_permlane32_swap_b32 v254, v158
v_permlane32_swap_b32 v255, v159
v_add_f32 v252, v252, v156
v_add_f32 v253, v253, v157
v_add_f32 v254, v254, v158
v_add_f32 v255, v255, v159
v_min_u32 v252, -2, v252
v_min_u32 v253, -2, v253
v_min_u32_e64 v254, -2, v254
v_min_u32 v255, -2, v255
s_lshl_b32 s44, s2, 4
s_add_u32 s44, s44, 393216
v_lshlrev_b32_e64 v250, 11, v251
s_mov_b64 exec, 0xff
buffer_store_dwordx4 v[252:255], v250, s[32:35], s44 offen sc1
s_mov_b64 exec, -1
s_cmp_eq_u32 s40, 0
s_cselect_b32 s77, 2, 0
s_cbranch_scc0 LpollRx
v_lshlrev_b32_e64 v250, 2, v251
buffer_load_dword v162, v250, s[24:27], 0 offen
buffer_load_dword v163, v250, s[24:27], 0 offen offset:256
buffer_load_dword v164, v250, s[24:27], 0 offen offset:512
v_lshlrev_b32_e64 v250, 3, v251
s_and_b32 s44, s2, 7
s_lshl_b32 s44, s44, 11
s_add_u32 s44, s44, 393216
buffer_load_dwordx2 v[156:157], v250, s[32:35], s44 offen sc1
buffer_load_dwordx2 v[158:159], v250, s[32:35], s44 offen offset:512 sc1
buffer_load_dwordx2 v[160:161], v250, s[32:35], s44 offen offset:1024 sc1
LpollRx:
s_setpc_b64 s[78:79]
LpollC:
v_max3_u32 v250, v156, v157, v158
v_max3_u32 v250, v250, v159, v160
v_max_u32 v250, v250, v161
v_cmp_eq_u32 vcc, -1, v250
s_nop 4
s_cbranch_vccz LpollS
v_lshlrev_b32 v250, 2, v251
buffer_load_dword v162, v250, s[24:27], 0 offen
buffer_load_dword v163, v250, s[24:27], 0 offen offset:256
buffer_load_dword v164, v250, s[24:27], 0 offen offset:512
v_lshlrev_b32_e64 v250, 3, v251
s_and_b32 s44, s2, 7
s_lshl_b32 s44, s44, 11
s_add_u32 s44, s44, 393216
buffer_load_dwordx2 v[156:157], v250, s[32:35], s44 offen sc1
buffer_load_dwordx2 v[158:159], v250, s[32:35], s44 offen offset:512 sc1
buffer_load_dwordx2 v[160:161], v250, s[32:35], s44 offen offset:1024 sc1
s_setpc_b64 s[78:79]
LpollS:
s_setprio 3
s_mov_b32 s43, 1083296634
v_mov_b32 v165, 897988541
v_fma_f32 v156, v156, s43, v165
v_fma_f32 v157, v157, s43, v165
v_fma_f32 v158, v158, s43, v165
v_fma_f32 v159, v159, s43, v165
v_fma_f32 v160, v160, s43, v165
v_fma_f32 v161, v161, s43, v165
v_sqrt_f32 v156, v156
v_sqrt_f32 v157, v157
v_sqrt_f32 v158, v158
v_sqrt_f32 v159, v159
v_sqrt_f32 v160, v160
v_sqrt_f32 v161, v161
v_add_f32 v166, v156, v157
v_add_f32 v166, v166, v158
v_add_f32 v166, v166, v159
v_add_f32 v166, v166, v160
v_add_f32 v166, v166, v161
s_nop 1
v_add_f32_dpp v166, v166, v166 row_ror:8 row_mask:0xf bank_mask:0xf
s_nop 1
v_add_f32_dpp v166, v166, v166 row_ror:4 row_mask:0xf bank_mask:0xf
s_nop 1
v_add_f32_dpp v166, v166, v166 row_ror:2 row_mask:0xf bank_mask:0xf
s_nop 1
v_add_f32_dpp v166, v166, v166 row_ror:1 row_mask:0xf bank_mask:0xf
v_mov_b32 v250, v166
s_nop 1
v_permlane16_swap_b32 v166, v250
v_add_f32 v166, v166, v250
v_mov_b32 v250, v166
s_nop 1
v_permlane32_swap_b32 v166, v250
v_add_f32_e64 v166, v166, v250
s_mov_b32 s43, 992651947
v_fma_f32 v166, v166, s43, v165
v_rcp_f32_e64 v166, v166
v_mov_b32 v165, 3221789604
v_mul_f32 v166, v166, v165
v_lshlrev_b32 v167, 16, v162
v_and_b32 v252, 4294901760, v162
v_mul_f32 v156, v156, v166
v_mul_f32 v157, v157, v166
v_fma_f32 v167, v167, v156, v165
v_fma_f32 v252, v252, v157, v165
v_cvt_pk_f16_f32 v162, v167, v252
v_lshlrev_b32_e64 v167, 16, v163
v_and_b32 v252, 4294901760, v163
v_mul_f32 v158, v158, v166
v_mul_f32 v159, v159, v166
v_fma_f32 v167, v167, v158, v165
v_fma_f32 v252, v252, v159, v165
v_cvt_pk_f16_f32 v163, v167, v252
v_lshlrev_b32_e64 v167, 16, v164
v_and_b32 v252, 4294901760, v164
v_mul_f32 v160, v160, v166
v_mul_f32 v161, v161, v166
v_fma_f32 v167, v167, v160, v165
v_fma_f32 v252, v252, v161, v165
v_cvt_pk_f16_f32 v164, v167, v252
s_mov_b32 s77, 0
s_setpc_b64 s[78:79]
Lend:
s_endpgm

.section .rodata,"a"
.p2align 6
.amdhsa_kernel standalone__modern_conv_block_convnext_v2__vision_kernel
  .amdhsa_next_free_vgpr 256
  .amdhsa_next_free_sgpr 102
  .amdhsa_accum_offset 256
  .amdhsa_group_segment_fixed_size 0
  .amdhsa_kernarg_size 72
  .amdhsa_user_sgpr_count 2
  .amdhsa_user_sgpr_kernarg_segment_ptr 1
  .amdhsa_system_sgpr_workgroup_id_x 1
.end_amdhsa_kernel
```

```asm
; @launch grid=(256,1,1) block=(512,1,1) lds=163840
.amdgcn_target "amdgcn-amd-amdhsa--gfx950"
.text
.globl standalone__modern_conv_block_convnext_v2__vision_kernel
.p2align 8
.type standalone__modern_conv_block_convnext_v2__vision_kernel,@function
standalone__modern_conv_block_convnext_v2__vision_kernel:
Lmain:
s_cmp_ge_u32 s2, 256
s_cbranch_scc1 Lend
s_load_dwordx16 s[80:95], s[0:1], 0
s_load_dwordx2 s[96:97], s[0:1], 64
s_getpc_b64 s[74:75]
Lpc0:
s_sub_u32 s74, s74, Lpc0-Lmain
s_subb_u32 s75, s75, 0
v_lshlrev_b32 v159, 7, v0
s_movk_i32 s43, 64
v_cmp_gt_u32 vcc, s43, v0
s_and_saveexec_b64 s[78:79], vcc
s_cbranch_execz Lpf0x
global_load_dword v255, v159, s[74:75]
Lpf0x:
s_mov_b64 exec, s[78:79]
v_mov_b32 v199, v0
v_and_b32 v251, 63, v0
v_lshrrev_b32 v120, 6, v0
s_nop 0
v_readfirstlane_b32 s40, v120
s_and_b32 s43, s2, 7
s_lshr_b32 s44, s2, 3
s_and_b32 s41, s43, 0
s_lshl_b32 s41, s41, 4
s_and_b32 s45, s44, 15
s_add_u32 s41, s41, s45
s_lshr_b32 s42, s43, 0
s_lshl_b32 s42, s42, 1
s_lshr_b32 s45, s44, 4
s_add_u32 s42, s42, s45
s_lshl_b32 s41, s41, 5
s_lshl_b32 s42, s42, 5
s_lshl_b32 s67, s40, 6
s_cmp_eq_u32 s40, 6
s_cselect_b32 s67, 352, s67
v_add_u32 v125, s67, v251
v_mul_u32_u24 v121, 5462, v125
v_lshrrev_b32 v121, 16, v121
v_mul_u32_u24 v122, 12, v121
v_sub_u32 v122, v125, v122
v_bfe_u32 v123, v121, 2, 2
v_xor_b32 v122, v122, v123
v_add_u32 v123, s41, v121
v_subrev_u32 v123, 1, v123
v_mul_u32_u24 v124, 192, v123
v_lshl_add_u32 v124, v122, 4, v124
v_mov_b32 v240, 2147483648
s_movk_i32 s43, 512
v_cmp_gt_u32 vcc, s43, v123
s_nop 1
v_cndmask_b32 v124, v240, v124, vcc
v_cmp_gt_u32 vcc, 34, v121
s_nop 1
v_cndmask_b32 v240, v240, v124, vcc
s_add_i32 s43, s42, -1
s_mul_i32 s44, s43, 98304
s_cmp_lt_u32 s43, 512
s_cselect_b32 s46, s44, 1073741824
s_mul_i32 s66, s42, 98304
s_mov_b32 s6, 50331648
s_mov_b32 s7, 131072
s_lshl_b32 s67, s67, 4
s_add_u32 s67, s67, 90112
s_cmp_eq_u32 s40, 7
s_cselect_b32 s67, 163840, s67
v_lshlrev_b32 v130, 1, v199
v_add_u32 v155, 768, v199
v_min_u32 v155, 863, v155
v_lshlrev_b32 v131, 1, v155
s_waitcnt lgkmcnt(0)
s_mov_b32 s4, s80
s_and_b32 s5, s81, 65535
s_cmp_ge_u32 s40, 4
s_cbranch_scc1 Lnodw
s_mov_b32 s20, s82
s_and_b32 s21, s83, 65535
s_mov_b32 s22, 1728
s_mov_b32 s23, 131072
buffer_load_ushort v126, v130, s[20:23], 0 offen offset:0
buffer_load_ushort v127, v130, s[20:23], 0 offen offset:512
buffer_load_ushort v128, v130, s[20:23], 0 offen offset:1024
buffer_load_ushort v129, v131, s[20:23], 0 offen offset:0
Lnodw:
s_cmp_eq_u32 s40, 7
s_cbranch_scc1 Lskipx0
s_add_u32 m0, s67, 0
s_nop 0
buffer_load_dwordx4 v240, s[4:7], s46 offen nt lds
s_add_u32 m0, s67, 6656
s_nop 0
buffer_load_dwordx4 v240, s[4:7], s66 offen nt lds
s_add_u32 m0, s67, 13312
s_add_u32 s45, s66, 98304
buffer_load_dwordx4 v240, s[4:7], s45 offen nt lds
s_add_u32 m0, s67, 19968
s_add_u32 s45, s66, 196608
buffer_load_dwordx4 v240, s[4:7], s45 offen nt lds
s_add_u32 m0, s67, 26624
s_add_u32 s45, s66, 294912
buffer_load_dwordx4 v240, s[4:7], s45 offen nt lds
s_add_u32 m0, s67, 33280
s_add_u32 s45, s66, 393216
buffer_load_dwordx4 v240, s[4:7], s45 offen nt lds
Lskipx0:
s_mov_b32 s12, s84
s_and_b32 s13, s85, 65535
s_mov_b32 s14, 73728
s_mov_b32 s15, 131072
v_lshrrev_b32 v189, 2, v251
v_mul_u32_u24 v189, 768, v189
v_and_b32 v125, 3, v251
v_lshl_add_u32 v189, v125, 4, v189
s_and_b32 s43, s40, 3
s_lshl_b32 s3, s43, 6
s_mul_i32 s77, s43, 6144
s_add_u32 s77, s77, 16384
v_mov_b32 v253, 16256
v_mov_b32 v254, 1
s_add_u32 s43, s42, s40
s_add_u32 s43, s43, 1
s_lshl_b32 s43, s43, 9
s_add_u32 s43, s43, s41
s_mul_i32 s47, s43, 192
s_sub_u32 s47, s47, 256
s_and_b32 s43, s40, 1
s_lshl_b32 s46, s43, 4
s_add_u32 s41, s41, s46
s_and_b32 s43, s40, 6
s_add_u32 s42, s42, s43
s_mul_i32 s45, s43, 6656
s_add_u32 s45, s45, 90112
v_and_b32 v131, 15, v251
v_lshrrev_b32 v132, 4, v251
v_mul_u32_u24 v122, 6656, v132
v_add_u32 v122, s45, v122
v_add_u32 v121, s46, v131
v_mul_u32_u24 v123, 192, v121
v_bfe_u32 v124, v121, 2, 2
v_lshl_add_u32 v123, v124, 4, v123
v_add_u32 v242, v122, v123
v_add_u32 v121, 1, v121
v_mul_u32_u24 v123, 192, v121
v_bfe_u32 v124, v121, 2, 2
v_lshl_add_u32 v123, v124, 4, v123
v_add_u32 v243, v122, v123
v_add_u32 v121, 1, v121
v_mul_u32_u24 v123, 192, v121
v_bfe_u32 v124, v121, 2, 2
v_lshl_add_u32 v123, v124, 4, v123
v_add_u32 v244, v122, v123
s_mul_i32 s72, s40, 9216
s_add_u32 s72, s72, 90112
v_bfe_u32 v133, v131, 2, 1
v_sub_u32 v133, v132, v133
v_lshrrev_b32 v134, 3, v131
v_and_b32 v135, 3, v131
v_lshl_add_u32 v135, v134, 2, v135
v_lshlrev_b32 v136, 7, v133
v_lshl_add_u32 v136, v135, 4, v136
v_add_u32 v136, 156672, v136
v_mov_b32 v135, 163840
v_cmp_gt_u32 vcc, 3, v133
s_nop 1
v_cndmask_b32 v245, v135, v136, vcc
v_and_b32 v135, 3, v131
v_mul_u32_u24 v246, 85, v135
s_mov_b32 s16, s86
s_and_b32 s17, s87, 65535
s_mov_b32 s18, 73728
s_mov_b32 s19, 131072
s_mov_b32 s24, s88
s_and_b32 s25, s89, 65535
s_mov_b32 s26, 768
s_mov_b32 s27, 131072
s_mov_b32 s28, s90
s_and_b32 s29, s91, 65535
s_mov_b32 s30, 768
s_mov_b32 s31, 131072
s_mov_b32 s8, s92
s_and_b32 s9, s93, 65535
s_mov_b32 s10, 50331648
s_mov_b32 s11, 131072
s_mov_b32 s36, s94
s_and_b32 s37, s95, 65535
s_mov_b32 s38, 256
s_mov_b32 s39, 131072
s_mov_b32 s32, s96
s_and_b32 s33, s97, 65535
s_mov_b32 s34, 83886080
s_mov_b32 s35, 131072
v_lshlrev_b32 v241, 4, v251
v_and_b32 v133, 35, v251
v_bfe_u32 v134, v251, 2, 2
v_lshl_add_u32 v133, v134, 3, v133
v_bfe_u32 v134, v251, 4, 1
v_lshl_add_u32 v133, v134, 2, v133
v_lshlrev_b32 v248, 4, v133
v_add_u32 v249, 65536, v248
v_add_u32 v250, 131072, v248
s_lshl_b32 s73, s2, 3
s_add_u32 s73, s73, s40
s_lshl_b32 s80, s73, 10
s_add_u32 s80, s80, 4194304
s_mul_i32 s73, s73, 16
s_add_u32 s73, s73, 1048576
s_mul_i32 s46, s41, 192
s_add_u32 s43, s42, 0
s_mul_i32 s43, s43, 98304
s_add_u32 s68, s43, s46
s_add_u32 s43, s42, 8
s_mul_i32 s43, s43, 98304
s_add_u32 s69, s43, s46
s_add_u32 s43, s42, 16
s_mul_i32 s43, s43, 98304
s_add_u32 s70, s43, s46
s_add_u32 s43, s42, 24
s_mul_i32 s43, s43, 98304
s_add_u32 s71, s43, s46
s_mul_i32 s82, s40, 9216
s_mov_b32 s48, 1156203754
s_mov_b32 s49, 4294508536
s_mov_b32 s76, 400000
v_lshrrev_b32 v148, 5, v251
v_lshlrev_b32 v190, 8, v148
v_bfe_u32 v148, v251, 2, 2
v_lshl_add_u32 v190, v148, 6, v190
v_bfe_u32 v148, v251, 4, 1
v_lshl_add_u32 v190, v148, 5, v190
v_bfe_u32 v148, v251, 0, 1
v_lshl_add_u32 v190, v148, 4, v190
v_bfe_u32 v148, v251, 1, 1
v_lshl_add_u32 v190, v148, 3, v190
v_add_u32 v190, s77, v190
v_add_u32 v191, s77, v248
s_cmp_lt_u32 s40, 4
s_cbranch_scc1 Lnoy
v_lshlrev_b32 v24, 6, v199
s_mov_b32 s43, 1065362610
v_mov_b32 v25, 1084047360
v_add_u32 v0, 32772, v24
v_add_u32 v1, 32780, v24
v_add_u32 v2, 32788, v24
v_add_u32 v3, 32796, v24
v_add_u32 v4, 32804, v24
v_add_u32 v5, 32812, v24
v_add_u32 v6, 32820, v24
v_add_u32 v7, 32828, v24
v_cvt_f32_f16 v0, v0
v_cvt_f32_f16 v1, v1
v_cvt_f32_f16 v2, v2
v_cvt_f32_f16 v3, v3
v_cvt_f32_f16 v4, v4
v_cvt_f32_f16 v5, v5
v_cvt_f32_f16 v6, v6
v_cvt_f32_f16 v7, v7
v_mul_f32 v8, v0, v0
v_mul_f32 v9, v1, v1
v_mul_f32 v10, v2, v2
v_mul_f32 v11, v3, v3
v_mul_f32 v12, v4, v4
v_mul_f32 v13, v5, v5
v_mul_f32 v14, v6, v6
v_mul_f32 v15, v7, v7
v_fma_f32 v8, v8, s43, v25
v_fma_f32 v9, v9, s43, v25
v_fma_f32 v10, v10, s43, v25
v_fma_f32 v11, v11, s43, v25
v_fma_f32 v12, v12, s43, v25
v_fma_f32 v13, v13, s43, v25
v_fma_f32 v14, v14, s43, v25
v_fma_f32 v15, v15, s43, v25
v_mul_f32 v8, v0, v8
v_mul_f32 v9, v1, v9
v_mul_f32 v10, v2, v10
v_mul_f32 v11, v3, v11
v_mul_f32 v12, v4, v12
v_mul_f32 v13, v5, v13
v_mul_f32 v14, v6, v14
v_mul_f32 v15, v7, v15
v_exp_f32 v8, v8
v_exp_f32 v9, v9
v_exp_f32 v10, v10
v_exp_f32 v11, v11
v_exp_f32 v12, v12
v_exp_f32 v13, v13
v_exp_f32 v14, v14
v_exp_f32 v15, v15
v_add_f32 v16, 1.0, v8
v_add_f32 v17, 1.0, v9
v_add_f32 v18, 1.0, v10
v_add_f32 v19, 1.0, v11
v_add_f32 v20, 1.0, v12
v_add_f32 v21, 1.0, v13
v_add_f32 v22, 1.0, v14
v_add_f32 v23, 1.0, v15
v_rcp_f32 v16, v16
v_rcp_f32 v17, v17
v_rcp_f32 v18, v18
v_rcp_f32 v19, v19
v_rcp_f32 v20, v20
v_rcp_f32 v21, v21
v_rcp_f32 v22, v22
v_rcp_f32 v23, v23
v_mul_f32 v0, v0, v16
v_mul_f32 v1, v1, v17
v_mul_f32 v2, v2, v18
v_mul_f32 v3, v3, v19
v_mul_f32 v4, v4, v20
v_mul_f32 v5, v5, v21
v_mul_f32 v6, v6, v22
v_mul_f32 v7, v7, v23
v_mul_f32 v8, v8, v0
v_mul_f32 v9, v9, v1
v_mul_f32 v10, v10, v2
v_mul_f32 v11, v11, v3
v_mul_f32 v12, v12, v4
v_mul_f32 v13, v13, v5
v_mul_f32 v14, v14, v6
v_mul_f32 v15, v15, v7
v_cvt_pk_f16_f32 v28, v0, v1
v_cvt_pk_f16_f32 v32, -v8, -v9
v_cvt_pk_f16_f32 v29, v2, v3
v_cvt_pk_f16_f32 v33, -v10, -v11
v_cvt_pk_f16_f32 v30, v4, v5
v_cvt_pk_f16_f32 v34, -v12, -v13
v_cvt_pk_f16_f32 v31, v6, v7
v_cvt_pk_f16_f32 v35, -v14, -v15
v_lshlrev_b32 v24, 4, v199
v_mov_b32 v25, 163840
s_movk_i32 s43, 496
v_cmp_gt_u32 vcc, s43, v199
s_nop 1
v_cndmask_b32 v24, v25, v24, vcc
ds_write_b128 v24, v[32:35]
ds_write_b128 v24, v[28:31] offset:8192
Lnoy:
s_cmp_ge_u32 s40, 4
s_cbranch_scc1 Lnoo
v_add_u32 v152, 0, v199
v_mul_u32_u24 v140, 683, v152
v_lshrrev_b32 v140, 16, v140
v_mul_u32_u24 v142, 11, v140
v_lshrrev_b32 v142, 5, v142
v_lshrrev_b32 v143, 5, v152
v_bfe_u32 v141, v152, 3, 2
v_bfe_u32 v144, v152, 4, 1
v_xor_b32 v141, v141, v144
v_sub_u32 v141, v141, v142
v_mul_i32_i24 v141, 9, v141
v_add_u32 v143, v143, v141
v_lshrrev_b32 v141, 1, v143
v_mul_u32_u24 v141, 368, v141
v_lshl_add_u32 v143, v143, 3, v141
v_lshl_add_u32 v143, v142, 7, v143
v_and_b32 v144, 7, v152
v_lshl_add_u32 v143, v144, 4, v143
v_add_u32 v156, 156672, v143
v_add_u32 v153, 256, v199
v_mul_u32_u24 v140, 683, v153
v_lshrrev_b32 v140, 16, v140
v_mul_u32_u24 v142, 11, v140
v_lshrrev_b32 v142, 5, v142
v_lshrrev_b32 v143, 5, v153
v_bfe_u32 v141, v153, 3, 2
v_bfe_u32 v144, v153, 4, 1
v_xor_b32 v141, v141, v144
v_sub_u32 v141, v141, v142
v_mul_i32_i24 v141, 9, v141
v_add_u32 v143, v143, v141
v_lshrrev_b32 v141, 1, v143
v_mul_u32_u24 v141, 368, v141
v_lshl_add_u32 v143, v143, 3, v141
v_lshl_add_u32 v143, v142, 7, v143
v_and_b32 v144, 7, v153
v_lshl_add_u32 v143, v144, 4, v143
v_add_u32 v157, 156672, v143
v_add_u32 v154, 512, v199
v_mul_u32_u24 v140, 683, v154
v_lshrrev_b32 v140, 16, v140
v_mul_u32_u24 v142, 11, v140
v_lshrrev_b32 v142, 5, v142
v_lshrrev_b32 v143, 5, v154
v_bfe_u32 v141, v154, 3, 2
v_bfe_u32 v144, v154, 4, 1
v_xor_b32 v141, v141, v144
v_sub_u32 v141, v141, v142
v_mul_i32_i24 v141, 9, v141
v_add_u32 v143, v143, v141
v_lshrrev_b32 v141, 1, v143
v_mul_u32_u24 v141, 368, v141
v_lshl_add_u32 v143, v143, 3, v141
v_lshl_add_u32 v143, v142, 7, v143
v_and_b32 v144, 7, v154
v_lshl_add_u32 v143, v144, 4, v143
v_add_u32 v158, 156672, v143
v_mul_u32_u24 v140, 683, v155
v_lshrrev_b32 v140, 16, v140
v_mul_u32_u24 v142, 11, v140
v_lshrrev_b32 v142, 5, v142
v_lshrrev_b32 v143, 5, v155
v_bfe_u32 v141, v155, 3, 2
v_bfe_u32 v144, v155, 4, 1
v_xor_b32 v141, v141, v144
v_sub_u32 v141, v141, v142
v_mul_i32_i24 v141, 9, v141
v_add_u32 v143, v143, v141
v_lshrrev_b32 v141, 1, v143
v_mul_u32_u24 v141, 368, v141
v_lshl_add_u32 v143, v143, 3, v141
v_lshl_add_u32 v143, v142, 7, v143
v_and_b32 v144, 7, v155
v_lshl_add_u32 v143, v144, 4, v143
v_add_u32 v159, 156672, v143
v_mov_b32 v160, 0
v_mov_b32 v161, 0
v_mov_b32 v162, 0
v_mov_b32 v163, 0
s_mov_b64 exec, 1
ds_write_b128 v253, v[160:163]
ds_write_b128 v253, v[160:163] offset:16
s_mov_b64 exec, -1
s_waitcnt vmcnt(6)
v_and_b32 v130, 4, v152
v_cmp_eq_u32 vcc, 0, v130
s_nop 1
v_cndmask_b32 v164, 0, v126, vcc
v_sub_u32 v165, v126, v164
ds_write_b64 v156, v[164:165]
v_and_b32 v130, 4, v153
v_cmp_eq_u32 vcc, 0, v130
s_nop 1
v_cndmask_b32 v166, 0, v127, vcc
v_sub_u32 v167, v127, v166
ds_write_b64 v157, v[166:167]
v_and_b32 v130, 4, v154
v_cmp_eq_u32 vcc, 0, v130
s_nop 1
v_cndmask_b32 v168, 0, v128, vcc
v_sub_u32 v169, v128, v168
ds_write_b64 v158, v[168:169]
v_and_b32 v130, 4, v155
v_cmp_eq_u32 vcc, 0, v130
s_nop 1
v_cndmask_b32 v170, 0, v129, vcc
v_sub_u32 v171, v129, v170
ds_write_b64 v159, v[170:171]
s_waitcnt lgkmcnt(0)
Lnoo:
s_barrier
s_cmp_lt_u32 s40, 4
s_cbranch_scc1 Lnoy2
v_subrev_u32 v199, 256, v199
v_lshlrev_b32 v24, 6, v199
s_mov_b32 s43, 1065362610
v_mov_b32 v25, 1084047360
v_add_u32 v0, 32772, v24
v_add_u32 v1, 32780, v24
v_add_u32 v2, 32788, v24
v_add_u32 v3, 32796, v24
v_add_u32 v4, 32804, v24
v_add_u32 v5, 32812, v24
v_add_u32 v6, 32820, v24
v_add_u32 v7, 32828, v24
v_cvt_f32_f16 v0, v0
v_cvt_f32_f16 v1, v1
v_cvt_f32_f16 v2, v2
v_cvt_f32_f16 v3, v3
v_cvt_f32_f16 v4, v4
v_cvt_f32_f16 v5, v5
v_cvt_f32_f16 v6, v6
v_cvt_f32_f16 v7, v7
v_mul_f32 v8, v0, v0
v_mul_f32 v9, v1, v1
v_mul_f32 v10, v2, v2
v_mul_f32 v11, v3, v3
v_mul_f32 v12, v4, v4
v_mul_f32 v13, v5, v5
v_mul_f32 v14, v6, v6
v_mul_f32 v15, v7, v7
v_fma_f32 v8, v8, s43, v25
v_fma_f32 v9, v9, s43, v25
v_fma_f32 v10, v10, s43, v25
v_fma_f32 v11, v11, s43, v25
v_fma_f32 v12, v12, s43, v25
v_fma_f32 v13, v13, s43, v25
v_fma_f32 v14, v14, s43, v25
v_fma_f32 v15, v15, s43, v25
v_mul_f32 v8, v0, v8
v_mul_f32 v9, v1, v9
v_mul_f32 v10, v2, v10
v_mul_f32 v11, v3, v11
v_mul_f32 v12, v4, v12
v_mul_f32 v13, v5, v13
v_mul_f32 v14, v6, v14
v_mul_f32 v15, v7, v15
v_exp_f32 v8, v8
v_exp_f32 v9, v9
v_exp_f32 v10, v10
v_exp_f32 v11, v11
v_exp_f32 v12, v12
v_exp_f32 v13, v13
v_exp_f32 v14, v14
v_exp_f32 v15, v15
v_add_f32 v16, 1.0, v8
v_add_f32 v17, 1.0, v9
v_add_f32 v18, 1.0, v10
v_add_f32 v19, 1.0, v11
v_add_f32 v20, 1.0, v12
v_add_f32 v21, 1.0, v13
v_add_f32 v22, 1.0, v14
v_add_f32 v23, 1.0, v15
v_rcp_f32 v16, v16
v_rcp_f32 v17, v17
v_rcp_f32 v18, v18
v_rcp_f32 v19, v19
v_rcp_f32 v20, v20
v_rcp_f32 v21, v21
v_rcp_f32 v22, v22
v_rcp_f32 v23, v23
v_mul_f32 v0, v0, v16
v_mul_f32 v1, v1, v17
v_mul_f32 v2, v2, v18
v_mul_f32 v3, v3, v19
v_mul_f32 v4, v4, v20
v_mul_f32 v5, v5, v21
v_mul_f32 v6, v6, v22
v_mul_f32 v7, v7, v23
v_mul_f32 v8, v8, v0
v_mul_f32 v9, v9, v1
v_mul_f32 v10, v10, v2
v_mul_f32 v11, v11, v3
v_mul_f32 v12, v12, v4
v_mul_f32 v13, v13, v5
v_mul_f32 v14, v14, v6
v_mul_f32 v15, v15, v7
v_cvt_pk_f16_f32 v28, v0, v1
v_cvt_pk_f16_f32 v32, -v8, -v9
v_cvt_pk_f16_f32 v29, v2, v3
v_cvt_pk_f16_f32 v33, -v10, -v11
v_cvt_pk_f16_f32 v30, v4, v5
v_cvt_pk_f16_f32 v34, -v12, -v13
v_cvt_pk_f16_f32 v31, v6, v7
v_cvt_pk_f16_f32 v35, -v14, -v15
v_lshlrev_b32 v24, 4, v199
v_mov_b32 v25, 163840
s_movk_i32 s43, 496
v_cmp_gt_u32 vcc, s43, v199
s_nop 1
v_cndmask_b32 v24, v25, v24, vcc
ds_write_b128 v24, v[32:35]
ds_write_b128 v24, v[28:31] offset:8192
Lnoy2:
s_setprio 2
s_cmp_lt_u32 s40, 4
s_cbranch_scc0 Lsu0
s_call_b64 s[78:79], Lpre
s_call_b64 s[78:79], Lrb
s_waitcnt vmcnt(4)
s_mov_b64 exec, 1
ds_add_u32 v253, v254 offset:28
s_mov_b64 exec, -1
v_mov_b32 v253, 16256
Lsw288w:
ds_read_b32 v247, v253 offset:28
s_waitcnt lgkmcnt(0)
v_readfirstlane_b32 s43, v247
s_cmp_eq_u32 s76, 0
s_cbranch_scc1 Lsw288x
s_sub_u32 s76, s76, 1
s_cmp_lt_u32 s43, 8
s_cbranch_scc0 Lsw288x
s_sleep 2
s_branch Lsw288w
Lsw288x:
s_call_b64 s[78:79], Lconv0
s_mov_b64 exec, 1
ds_add_u32 v253, v254 offset:16
s_mov_b64 exec, -1
s_call_b64 s[78:79], Lln0
s_waitcnt vmcnt(0)
s_mov_b64 exec, 1
ds_add_u32 v253, v254 offset:12
s_mov_b64 exec, -1
s_call_b64 s[78:79], Lw1i
Lsu0:
s_cmp_ge_u32 s40, 4
s_cbranch_scc0 Lsu2
s_setprio 3
s_call_b64 s[78:79], Lw1f
s_waitcnt vmcnt(6)
s_mov_b64 exec, 1
ds_add_u32 v253, v254 offset:28
s_mov_b64 exec, -1
s_call_b64 s[78:79], Lrb
s_waitcnt vmcnt(4)
s_call_b64 s[78:79], Lw1a
s_mov_b64 exec, 1
ds_add_u32 v253, v254 offset:20
s_mov_b64 exec, -1
s_call_b64 s[78:79], Lpre
s_waitcnt vmcnt(0)
s_mov_b64 exec, 1
ds_add_u32 v253, v254 offset:12
s_mov_b64 exec, -1
v_mov_b32 v253, 16256
Lsw128w:
ds_read_b32 v247, v253 offset:12
s_waitcnt lgkmcnt(0)
v_readfirstlane_b32 s43, v247
s_cmp_eq_u32 s76, 0
s_cbranch_scc1 Lsw128x
s_sub_u32 s76, s76, 1
s_cmp_lt_u32 s43, 8
s_cbranch_scc0 Lsw128x
s_sleep 2
s_branch Lsw128w
Lsw128x:
s_call_b64 s[78:79], Lconv0
s_mov_b64 exec, 1
ds_add_u32 v253, v254 offset:16
s_mov_b64 exec, -1
s_call_b64 s[78:79], Lln0
Lsu2:
s_branch Lgo
Lconv0:
ds_read_b128 v[192:195], v242
ds_read_b128 v[196:199], v242 offset:64
ds_read_b128 v[200:203], v242 offset:128
ds_read_b128 v[204:207], v243
ds_read_b128 v[208:211], v243 offset:64
ds_read_b128 v[212:215], v243 offset:128
ds_read_b128 v[224:227], v244
ds_read_b128 v[228:231], v244 offset:64
ds_read_b128 v[232:235], v244 offset:128
v_xor_b32 v242, 16, v242
ds_read_b128 v[236:239], v242
ds_read_b128 v[216:219], v242 offset:64
ds_read_b128 v[220:223], v242 offset:128
s_waitcnt lgkmcnt(11)
v_smfmac_f32_16x16x32_bf16 v[0:3], v[48:49], v[192:195], v246
s_waitcnt lgkmcnt(10)
v_smfmac_f32_16x16x32_bf16 v[16:19], v[50:51], v[196:199], v246
s_waitcnt lgkmcnt(9)
v_smfmac_f32_16x16x32_bf16 v[32:35], v[52:53], v[200:203], v246
s_waitcnt lgkmcnt(8)
v_xor_b32 v243, 16, v243
ds_read_b128 v[192:195], v243
ds_read_b128 v[196:199], v243 offset:64
v_smfmac_f32_16x16x32_bf16 v[0:3], v[54:55], v[204:207], v246
s_waitcnt lgkmcnt(9)
v_smfmac_f32_16x16x32_bf16 v[16:19], v[56:57], v[208:211], v246
s_waitcnt lgkmcnt(8)
ds_read_b128 v[200:203], v243 offset:128
v_xor_b32 v244, 16, v244
ds_read_b128 v[204:207], v244
v_smfmac_f32_16x16x32_bf16 v[32:35], v[58:59], v[212:215], v246
s_waitcnt lgkmcnt(9)
v_smfmac_f32_16x16x32_bf16 v[0:3], v[60:61], v[224:227], v246
s_waitcnt lgkmcnt(8)
ds_read_b128 v[208:211], v244 offset:64
ds_read_b128 v[212:215], v244 offset:128
v_smfmac_f32_16x16x32_bf16 v[16:19], v[62:63], v[228:231], v246
s_waitcnt lgkmcnt(9)
v_smfmac_f32_16x16x32_bf16 v[32:35], v[64:65], v[232:235], v246
s_waitcnt lgkmcnt(8)
v_xor_b32 v242, 32, v242
ds_read_b128 v[224:227], v242
ds_read_b128 v[228:231], v242 offset:64
v_smfmac_f32_16x16x32_bf16 v[4:7], v[66:67], v[236:239], v246
s_waitcnt lgkmcnt(9)
v_smfmac_f32_16x16x32_bf16 v[20:23], v[68:69], v[216:219], v246
s_waitcnt lgkmcnt(8)
ds_read_b128 v[232:235], v242 offset:128
v_xor_b32 v243, 32, v243
ds_read_b128 v[236:239], v243
v_smfmac_f32_16x16x32_bf16 v[36:39], v[70:71], v[220:223], v246
s_waitcnt lgkmcnt(9)
v_smfmac_f32_16x16x32_bf16 v[4:7], v[72:73], v[192:195], v246
s_waitcnt lgkmcnt(8)
ds_read_b128 v[216:219], v243 offset:64
ds_read_b128 v[220:223], v243 offset:128
v_smfmac_f32_16x16x32_bf16 v[20:23], v[74:75], v[196:199], v246
s_waitcnt lgkmcnt(9)
v_smfmac_f32_16x16x32_bf16 v[36:39], v[76:77], v[200:203], v246
s_waitcnt lgkmcnt(8)
v_xor_b32 v244, 32, v244
ds_read_b128 v[192:195], v244
ds_read_b128 v[196:199], v244 offset:64
v_smfmac_f32_16x16x32_bf16 v[4:7], v[78:79], v[204:207], v246
s_waitcnt lgkmcnt(9)
v_smfmac_f32_16x16x32_bf16 v[20:23], v[80:81], v[208:211], v246
s_waitcnt lgkmcnt(8)
ds_read_b128 v[200:203], v244 offset:128
v_xor_b32 v242, 16, v242
ds_read_b128 v[204:207], v242
v_smfmac_f32_16x16x32_bf16 v[36:39], v[82:83], v[212:215], v246
s_waitcnt lgkmcnt(9)
v_smfmac_f32_16x16x32_bf16 v[12:15], v[84:85], v[224:227], v246
s_waitcnt lgkmcnt(8)
ds_read_b128 v[208:211], v242 offset:64
ds_read_b128 v[212:215], v242 offset:128
v_smfmac_f32_16x16x32_bf16 v[28:31], v[86:87], v[228:231], v246
s_waitcnt lgkmcnt(9)
v_smfmac_f32_16x16x32_bf16 v[44:47], v[88:89], v[232:235], v246
s_waitcnt lgkmcnt(8)
v_xor_b32 v243, 16, v243
ds_read_b128 v[224:227], v243
ds_read_b128 v[228:231], v243 offset:64
v_smfmac_f32_16x16x32_bf16 v[12:15], v[90:91], v[236:239], v246
s_waitcnt lgkmcnt(9)
v_smfmac_f32_16x16x32_bf16 v[28:31], v[92:93], v[216:219], v246
s_waitcnt lgkmcnt(8)
ds_read_b128 v[232:235], v243 offset:128
v_xor_b32 v244, 16, v244
ds_read_b128 v[236:239], v244
v_smfmac_f32_16x16x32_bf16 v[44:47], v[94:95], v[220:223], v246
s_waitcnt lgkmcnt(9)
v_smfmac_f32_16x16x32_bf16 v[12:15], v[96:97], v[192:195], v246
s_waitcnt lgkmcnt(8)
ds_read_b128 v[216:219], v244 offset:64
ds_read_b128 v[220:223], v244 offset:128
v_smfmac_f32_16x16x32_bf16 v[28:31], v[98:99], v[196:199], v246
s_waitcnt lgkmcnt(9)
v_smfmac_f32_16x16x32_bf16 v[44:47], v[100:101], v[200:203], v246
s_waitcnt lgkmcnt(8)
v_smfmac_f32_16x16x32_bf16 v[8:11], v[102:103], v[204:207], v246
s_waitcnt lgkmcnt(7)
v_smfmac_f32_16x16x32_bf16 v[24:27], v[104:105], v[208:211], v246
s_waitcnt lgkmcnt(6)
v_smfmac_f32_16x16x32_bf16 v[40:43], v[106:107], v[212:215], v246
s_waitcnt lgkmcnt(5)
v_smfmac_f32_16x16x32_bf16 v[8:11], v[108:109], v[224:227], v246
s_waitcnt lgkmcnt(4)
v_smfmac_f32_16x16x32_bf16 v[24:27], v[110:111], v[228:231], v246
s_waitcnt lgkmcnt(3)
v_smfmac_f32_16x16x32_bf16 v[40:43], v[112:113], v[232:235], v246
s_waitcnt lgkmcnt(2)
v_smfmac_f32_16x16x32_bf16 v[8:11], v[114:115], v[236:239], v246
s_waitcnt lgkmcnt(1)
v_smfmac_f32_16x16x32_bf16 v[24:27], v[116:117], v[216:219], v246
s_waitcnt lgkmcnt(0)
v_smfmac_f32_16x16x32_bf16 v[40:43], v[118:119], v[220:223], v246
s_nop 11
s_setpc_b64 s[78:79]
Lln0:
v_pk_add_f32 v[168:169], v[0:1], v[2:3]
v_pk_mul_f32 v[170:171], v[0:1], v[0:1]
v_pk_fma_f32 v[170:171], v[2:3], v[2:3], v[170:171]
v_pk_add_f32 v[168:169], v[168:169], v[4:5]
v_pk_fma_f32 v[170:171], v[4:5], v[4:5], v[170:171]
v_pk_add_f32 v[168:169], v[168:169], v[6:7]
v_pk_fma_f32 v[170:171], v[6:7], v[6:7], v[170:171]
v_pk_add_f32 v[168:169], v[168:169], v[8:9]
v_pk_fma_f32 v[170:171], v[8:9], v[8:9], v[170:171]
v_pk_add_f32 v[168:169], v[168:169], v[10:11]
v_pk_fma_f32 v[170:171], v[10:11], v[10:11], v[170:171]
v_pk_add_f32 v[168:169], v[168:169], v[12:13]
v_pk_fma_f32 v[170:171], v[12:13], v[12:13], v[170:171]
v_pk_add_f32 v[168:169], v[168:169], v[14:15]
v_pk_fma_f32 v[170:171], v[14:15], v[14:15], v[170:171]
v_pk_add_f32 v[168:169], v[168:169], v[16:17]
v_pk_fma_f32 v[170:171], v[16:17], v[16:17], v[170:171]
v_pk_add_f32 v[168:169], v[168:169], v[18:19]
v_pk_fma_f32 v[170:171], v[18:19], v[18:19], v[170:171]
v_pk_add_f32 v[168:169], v[168:169], v[20:21]
v_pk_fma_f32 v[170:171], v[20:21], v[20:21], v[170:171]
v_pk_add_f32 v[168:169], v[168:169], v[22:23]
v_pk_fma_f32 v[170:171], v[22:23], v[22:23], v[170:171]
v_pk_add_f32 v[168:169], v[168:169], v[24:25]
v_pk_fma_f32 v[170:171], v[24:25], v[24:25], v[170:171]
v_pk_add_f32 v[168:169], v[168:169], v[26:27]
v_pk_fma_f32 v[170:171], v[26:27], v[26:27], v[170:171]
v_pk_add_f32 v[168:169], v[168:169], v[28:29]
v_pk_fma_f32 v[170:171], v[28:29], v[28:29], v[170:171]
v_pk_add_f32 v[168:169], v[168:169], v[30:31]
v_pk_fma_f32 v[170:171], v[30:31], v[30:31], v[170:171]
v_pk_add_f32 v[168:169], v[168:169], v[32:33]
v_pk_fma_f32 v[170:171], v[32:33], v[32:33], v[170:171]
v_pk_add_f32 v[168:169], v[168:169], v[34:35]
v_pk_fma_f32 v[170:171], v[34:35], v[34:35], v[170:171]
v_pk_add_f32 v[168:169], v[168:169], v[36:37]
v_pk_fma_f32 v[170:171], v[36:37], v[36:37], v[170:171]
v_pk_add_f32 v[168:169], v[168:169], v[38:39]
v_pk_fma_f32 v[170:171], v[38:39], v[38:39], v[170:171]
v_pk_add_f32 v[168:169], v[168:169], v[40:41]
v_pk_fma_f32 v[170:171], v[40:41], v[40:41], v[170:171]
v_pk_add_f32 v[168:169], v[168:169], v[42:43]
v_pk_fma_f32 v[170:171], v[42:43], v[42:43], v[170:171]
v_pk_add_f32 v[168:169], v[168:169], v[44:45]
v_pk_fma_f32 v[170:171], v[44:45], v[44:45], v[170:171]
v_pk_add_f32 v[168:169], v[168:169], v[46:47]
v_pk_fma_f32 v[170:171], v[46:47], v[46:47], v[170:171]
v_add_f32 v168, v168, v169
v_add_f32 v170, v170, v171
s_nop 1
v_permlane32_swap_b32 v168, v170
v_add_f32 v168, v168, v170
v_mul_f32 v168, 1009429163, v168
v_mov_b32 v170, v168
s_nop 1
v_permlane32_swap_b32 v168, v170
v_fma_f32 v170, -v168, v168, v170
v_max_f32 v170, 0, v170
v_add_f32 v170, 925353388, v170
v_rsq_f32 v170, v170
s_nop 0
v_mul_f32 v172, 3203391086, v170
v_mul_f32 v173, v168, v172
v_pk_fma_f32 v[0:1], v[0:1], v[172:173], v[172:173] op_sel:[0,0,1] op_sel_hi:[1,0,1] neg_lo:[0,0,1] neg_hi:[0,0,1]
v_pk_fma_f32 v[2:3], v[2:3], v[172:173], v[172:173] op_sel:[0,0,1] op_sel_hi:[1,0,1] neg_lo:[0,0,1] neg_hi:[0,0,1]
v_pk_fma_f32 v[4:5], v[4:5], v[172:173], v[172:173] op_sel:[0,0,1] op_sel_hi:[1,0,1] neg_lo:[0,0,1] neg_hi:[0,0,1]
v_pk_fma_f32 v[6:7], v[6:7], v[172:173], v[172:173] op_sel:[0,0,1] op_sel_hi:[1,0,1] neg_lo:[0,0,1] neg_hi:[0,0,1]
v_pk_fma_f32 v[8:9], v[8:9], v[172:173], v[172:173] op_sel:[0,0,1] op_sel_hi:[1,0,1] neg_lo:[0,0,1] neg_hi:[0,0,1]
v_pk_fma_f32 v[10:11], v[10:11], v[172:173], v[172:173] op_sel:[0,0,1] op_sel_hi:[1,0,1] neg_lo:[0,0,1] neg_hi:[0,0,1]
v_pk_fma_f32 v[12:13], v[12:13], v[172:173], v[172:173] op_sel:[0,0,1] op_sel_hi:[1,0,1] neg_lo:[0,0,1] neg_hi:[0,0,1]
v_pk_fma_f32 v[14:15], v[14:15], v[172:173], v[172:173] op_sel:[0,0,1] op_sel_hi:[1,0,1] neg_lo:[0,0,1] neg_hi:[0,0,1]
v_pk_fma_f32 v[16:17], v[16:17], v[172:173], v[172:173] op_sel:[0,0,1] op_sel_hi:[1,0,1] neg_lo:[0,0,1] neg_hi:[0,0,1]
v_pk_fma_f32 v[18:19], v[18:19], v[172:173], v[172:173] op_sel:[0,0,1] op_sel_hi:[1,0,1] neg_lo:[0,0,1] neg_hi:[0,0,1]
v_pk_fma_f32 v[20:21], v[20:21], v[172:173], v[172:173] op_sel:[0,0,1] op_sel_hi:[1,0,1] neg_lo:[0,0,1] neg_hi:[0,0,1]
v_pk_fma_f32 v[22:23], v[22:23], v[172:173], v[172:173] op_sel:[0,0,1] op_sel_hi:[1,0,1] neg_lo:[0,0,1] neg_hi:[0,0,1]
v_pk_fma_f32 v[24:25], v[24:25], v[172:173], v[172:173] op_sel:[0,0,1] op_sel_hi:[1,0,1] neg_lo:[0,0,1] neg_hi:[0,0,1]
v_pk_fma_f32 v[26:27], v[26:27], v[172:173], v[172:173] op_sel:[0,0,1] op_sel_hi:[1,0,1] neg_lo:[0,0,1] neg_hi:[0,0,1]
v_pk_fma_f32 v[28:29], v[28:29], v[172:173], v[172:173] op_sel:[0,0,1] op_sel_hi:[1,0,1] neg_lo:[0,0,1] neg_hi:[0,0,1]
v_pk_fma_f32 v[30:31], v[30:31], v[172:173], v[172:173] op_sel:[0,0,1] op_sel_hi:[1,0,1] neg_lo:[0,0,1] neg_hi:[0,0,1]
v_pk_fma_f32 v[32:33], v[32:33], v[172:173], v[172:173] op_sel:[0,0,1] op_sel_hi:[1,0,1] neg_lo:[0,0,1] neg_hi:[0,0,1]
v_pk_fma_f32 v[34:35], v[34:35], v[172:173], v[172:173] op_sel:[0,0,1] op_sel_hi:[1,0,1] neg_lo:[0,0,1] neg_hi:[0,0,1]
v_pk_fma_f32 v[36:37], v[36:37], v[172:173], v[172:173] op_sel:[0,0,1] op_sel_hi:[1,0,1] neg_lo:[0,0,1] neg_hi:[0,0,1]
v_pk_fma_f32 v[38:39], v[38:39], v[172:173], v[172:173] op_sel:[0,0,1] op_sel_hi:[1,0,1] neg_lo:[0,0,1] neg_hi:[0,0,1]
v_pk_fma_f32 v[40:41], v[40:41], v[172:173], v[172:173] op_sel:[0,0,1] op_sel_hi:[1,0,1] neg_lo:[0,0,1] neg_hi:[0,0,1]
v_pk_fma_f32 v[42:43], v[42:43], v[172:173], v[172:173] op_sel:[0,0,1] op_sel_hi:[1,0,1] neg_lo:[0,0,1] neg_hi:[0,0,1]
v_pk_fma_f32 v[44:45], v[44:45], v[172:173], v[172:173] op_sel:[0,0,1] op_sel_hi:[1,0,1] neg_lo:[0,0,1] neg_hi:[0,0,1]
v_pk_fma_f32 v[46:47], v[46:47], v[172:173], v[172:173] op_sel:[0,0,1] op_sel_hi:[1,0,1] neg_lo:[0,0,1] neg_hi:[0,0,1]
v_cvt_pk_bf16_f32 v48, v0, v1
v_cvt_pk_bf16_f32 v49, v2, v3
v_cvt_pk_bf16_f32 v50, v4, v5
v_cvt_pk_bf16_f32 v51, v6, v7
v_cvt_pk_bf16_f32 v52, v8, v9
v_cvt_pk_bf16_f32 v53, v10, v11
v_cvt_pk_bf16_f32 v54, v12, v13
v_cvt_pk_bf16_f32 v55, v14, v15
v_cvt_pk_bf16_f32 v56, v16, v17
v_cvt_pk_bf16_f32 v57, v18, v19
v_cvt_pk_bf16_f32 v58, v20, v21
v_cvt_pk_bf16_f32 v59, v22, v23
v_cvt_pk_bf16_f32 v60, v24, v25
v_cvt_pk_bf16_f32 v61, v26, v27
v_cvt_pk_bf16_f32 v62, v28, v29
v_cvt_pk_bf16_f32 v63, v30, v31
v_cvt_pk_bf16_f32 v64, v32, v33
v_cvt_pk_bf16_f32 v65, v34, v35
v_cvt_pk_bf16_f32 v66, v36, v37
v_cvt_pk_bf16_f32 v67, v38, v39
v_cvt_pk_bf16_f32 v68, v40, v41
v_cvt_pk_bf16_f32 v69, v42, v43
v_cvt_pk_bf16_f32 v70, v44, v45
v_cvt_pk_bf16_f32 v71, v46, v47
s_nop 1
s_setpc_b64 s[78:79]
Lw1a:
ds_read_b64_tr_b16 v[148:149], v190
ds_read_b64_tr_b16 v[150:151], v190 offset:512
ds_read_b64_tr_b16 v[152:153], v190 offset:1024
ds_read_b64_tr_b16 v[154:155], v190 offset:1536
ds_read_b64_tr_b16 v[156:157], v190 offset:2048
ds_read_b64_tr_b16 v[158:159], v190 offset:2560
ds_read_b64_tr_b16 v[160:161], v190 offset:3072
ds_read_b64_tr_b16 v[162:163], v190 offset:3584
ds_read_b64_tr_b16 v[164:165], v190 offset:4096
ds_read_b64_tr_b16 v[166:167], v190 offset:4608
ds_read_b64_tr_b16 v[168:169], v190 offset:5120
ds_read_b64_tr_b16 v[170:171], v190 offset:5632
s_waitcnt lgkmcnt(10)
ds_write_b128 v191, v[148:151]
s_waitcnt lgkmcnt(9)
ds_write_b128 v191, v[152:155] offset:1024
s_waitcnt lgkmcnt(8)
ds_write_b128 v191, v[156:159] offset:2048
s_waitcnt lgkmcnt(7)
ds_write_b128 v191, v[160:163] offset:3072
s_waitcnt lgkmcnt(6)
ds_write_b128 v191, v[164:167] offset:4096
s_waitcnt lgkmcnt(5)
ds_write_b128 v191, v[168:171] offset:5120
s_waitcnt lgkmcnt(0)
s_setpc_b64 s[78:79]
Lw1i:
s_add_u32 m0, s77, 24576
s_add_u32 s43, s3, 256
buffer_load_dwordx4 v189, s[12:15], s43 offen lds
s_add_u32 m0, s77, 25600
s_add_u32 s43, s3, 24832
buffer_load_dwordx4 v189, s[12:15], s43 offen lds
s_add_u32 m0, s77, 26624
s_add_u32 s43, s3, 49408
buffer_load_dwordx4 v189, s[12:15], s43 offen lds
s_add_u32 m0, s77, 27648
s_add_u32 s43, s3, 12544
buffer_load_dwordx4 v189, s[12:15], s43 offen lds
s_add_u32 m0, s77, 28672
s_add_u32 s43, s3, 37120
buffer_load_dwordx4 v189, s[12:15], s43 offen lds
s_add_u32 m0, s77, 29696
s_add_u32 s43, s3, 61696
buffer_load_dwordx4 v189, s[12:15], s43 offen lds
s_add_u32 m0, s77, 49152
s_add_u32 s43, s3, 512
buffer_load_dwordx4 v189, s[12:15], s43 offen lds
s_add_u32 m0, s77, 50176
s_add_u32 s43, s3, 25088
buffer_load_dwordx4 v189, s[12:15], s43 offen lds
s_add_u32 m0, s77, 51200
s_add_u32 s43, s3, 49664
buffer_load_dwordx4 v189, s[12:15], s43 offen lds
s_add_u32 m0, s77, 52224
s_add_u32 s43, s3, 12800
buffer_load_dwordx4 v189, s[12:15], s43 offen lds
s_add_u32 m0, s77, 53248
s_add_u32 s43, s3, 37376
buffer_load_dwordx4 v189, s[12:15], s43 offen lds
s_add_u32 m0, s77, 54272
s_add_u32 s43, s3, 61952
buffer_load_dwordx4 v189, s[12:15], s43 offen lds
s_setpc_b64 s[78:79]
Lw1b:
ds_read_b64_tr_b16 v[72:73], v190 offset:24576
ds_read_b64_tr_b16 v[74:75], v190 offset:25088
ds_read_b64_tr_b16 v[76:77], v190 offset:25600
ds_read_b64_tr_b16 v[78:79], v190 offset:26112
ds_read_b64_tr_b16 v[80:81], v190 offset:26624
ds_read_b64_tr_b16 v[82:83], v190 offset:27136
ds_read_b64_tr_b16 v[84:85], v190 offset:27648
ds_read_b64_tr_b16 v[86:87], v190 offset:28160
ds_read_b64_tr_b16 v[88:89], v190 offset:28672
ds_read_b64_tr_b16 v[90:91], v190 offset:29184
ds_read_b64_tr_b16 v[92:93], v190 offset:29696
ds_read_b64_tr_b16 v[94:95], v190 offset:30208
s_waitcnt lgkmcnt(10)
ds_write_b128 v191, v[72:75] offset:24576
s_waitcnt lgkmcnt(9)
ds_write_b128 v191, v[76:79] offset:25600
s_waitcnt lgkmcnt(8)
ds_write_b128 v191, v[80:83] offset:26624
s_waitcnt lgkmcnt(7)
ds_write_b128 v191, v[84:87] offset:27648
s_waitcnt lgkmcnt(6)
ds_write_b128 v191, v[88:91] offset:28672
s_waitcnt lgkmcnt(5)
ds_write_b128 v191, v[92:95] offset:29696
s_waitcnt lgkmcnt(0)
s_setpc_b64 s[78:79]
Lw1c:
ds_read_b64_tr_b16 v[72:73], v190 offset:49152
ds_read_b64_tr_b16 v[74:75], v190 offset:49664
ds_read_b64_tr_b16 v[76:77], v190 offset:50176
ds_read_b64_tr_b16 v[78:79], v190 offset:50688
ds_read_b64_tr_b16 v[80:81], v190 offset:51200
ds_read_b64_tr_b16 v[82:83], v190 offset:51712
ds_read_b64_tr_b16 v[84:85], v190 offset:52224
ds_read_b64_tr_b16 v[86:87], v190 offset:52736
ds_read_b64_tr_b16 v[88:89], v190 offset:53248
ds_read_b64_tr_b16 v[90:91], v190 offset:53760
ds_read_b64_tr_b16 v[92:93], v190 offset:54272
ds_read_b64_tr_b16 v[94:95], v190 offset:54784
s_waitcnt lgkmcnt(10)
ds_write_b128 v191, v[72:75] offset:49152
s_waitcnt lgkmcnt(9)
ds_write_b128 v191, v[76:79] offset:50176
s_waitcnt lgkmcnt(8)
ds_write_b128 v191, v[80:83] offset:51200
s_waitcnt lgkmcnt(7)
ds_write_b128 v191, v[84:87] offset:52224
s_waitcnt lgkmcnt(6)
ds_write_b128 v191, v[88:91] offset:53248
s_waitcnt lgkmcnt(5)
ds_write_b128 v191, v[92:95] offset:54272
s_waitcnt lgkmcnt(0)
s_setpc_b64 s[78:79]
Lpre:
ds_read_b128 v[48:51], v245
ds_read_b128 v[52:55], v245 offset:384
ds_read_b128 v[56:59], v245 offset:768
ds_read_b128 v[60:63], v245 offset:1152
ds_read_b128 v[64:67], v245 offset:1536
ds_read_b128 v[68:71], v245 offset:1920
ds_read_b128 v[72:75], v245 offset:2304
ds_read_b128 v[76:79], v245 offset:2688
ds_read_b128 v[80:83], v245 offset:3072
ds_read_b128 v[84:87], v245 offset:3456
ds_read_b128 v[88:91], v245 offset:3840
ds_read_b128 v[92:95], v245 offset:4224
ds_read_b128 v[96:99], v245 offset:4608
ds_read_b128 v[100:103], v245 offset:4992
ds_read_b128 v[104:107], v245 offset:5376
ds_read_b128 v[108:111], v245 offset:5760
ds_read_b128 v[112:115], v245 offset:6144
ds_read_b128 v[116:119], v245 offset:6528
v_mov_b32 v0, 0
v_mov_b32 v1, 0
v_mov_b32 v2, 0
v_mov_b32 v3, 0
v_mov_b32 v4, 0
v_mov_b32 v5, 0
v_mov_b32 v6, 0
v_mov_b32 v7, 0
v_mov_b32 v8, 0
v_mov_b32 v9, 0
v_mov_b32 v10, 0
v_mov_b32 v11, 0
v_mov_b32 v12, 0
v_mov_b32 v13, 0
v_mov_b32 v14, 0
v_mov_b32 v15, 0
v_mov_b32 v16, 0
v_mov_b32 v17, 0
v_mov_b32 v18, 0
v_mov_b32 v19, 0
v_mov_b32 v20, 0
v_mov_b32 v21, 0
v_mov_b32 v22, 0
v_mov_b32 v23, 0
v_mov_b32 v24, 0
v_mov_b32 v25, 0
v_mov_b32 v26, 0
v_mov_b32 v27, 0
v_mov_b32 v28, 0
v_mov_b32 v29, 0
v_mov_b32 v30, 0
v_mov_b32 v31, 0
v_mov_b32 v32, 0
v_mov_b32 v33, 0
v_mov_b32 v34, 0
v_mov_b32 v35, 0
v_mov_b32 v36, 0
v_mov_b32 v37, 0
v_mov_b32 v38, 0
v_mov_b32 v39, 0
v_mov_b32 v40, 0
v_mov_b32 v41, 0
v_mov_b32 v42, 0
v_mov_b32 v43, 0
v_mov_b32 v44, 0
v_mov_b32 v45, 0
v_mov_b32 v46, 0
v_mov_b32 v47, 0
s_waitcnt lgkmcnt(0)
s_setpc_b64 s[78:79]
Lrb:
s_add_u32 m0, s67, 39936
s_add_u32 s45, s66, 491520
buffer_load_dwordx4 v240, s[4:7], s45 offen nt lds
s_add_u32 m0, s67, 46592
s_add_u32 s45, s66, 589824
buffer_load_dwordx4 v240, s[4:7], s45 offen nt lds
s_add_u32 m0, s67, 53248
s_add_u32 s45, s66, 688128
buffer_load_dwordx4 v240, s[4:7], s45 offen nt lds
s_add_u32 m0, s67, 59904
s_add_u32 s45, s66, 786432
buffer_load_dwordx4 v240, s[4:7], s45 offen nt lds
s_setpc_b64 s[78:79]
Lw1f:
s_add_u32 m0, s77, 0
s_add_u32 s43, s3, 0
buffer_load_dwordx4 v189, s[12:15], s43 offen lds
s_add_u32 m0, s77, 1024
s_add_u32 s43, s3, 24576
buffer_load_dwordx4 v189, s[12:15], s43 offen lds
s_add_u32 m0, s77, 2048
s_add_u32 s43, s3, 49152
buffer_load_dwordx4 v189, s[12:15], s43 offen lds
s_add_u32 m0, s77, 3072
s_add_u32 s43, s3, 12288
buffer_load_dwordx4 v189, s[12:15], s43 offen lds
s_add_u32 m0, s77, 4096
s_add_u32 s43, s3, 36864
buffer_load_dwordx4 v189, s[12:15], s43 offen lds
s_add_u32 m0, s77, 5120
s_add_u32 s43, s3, 61440
buffer_load_dwordx4 v189, s[12:15], s43 offen lds
s_setpc_b64 s[78:79]
Lgo:
v_mov_b32 v253, 16256
Lsw204w:
ds_read_b32 v247, v253 offset:20
s_waitcnt lgkmcnt(0)
v_readfirstlane_b32 s43, v247
s_cmp_eq_u32 s76, 0
s_cbranch_scc1 Lsw204x
s_sub_u32 s76, s76, 1
s_cmp_lt_u32 s43, 4
s_cbranch_scc0 Lsw204x
s_sleep 2
s_branch Lsw204w
Lsw204x:
s_cmp_lg_u32 s40, 7
s_cbranch_scc1 Lnopf
s_getpc_b64 s[74:75]
Lpc:
s_lshr_b32 s43, s2, 3
s_and_b32 s43, s43, 15
s_lshl_b32 s43, s43, 13
v_lshlrev_b32 v102, 7, v251
v_add_u32 v102, s43, v102
v_min_u32 v102, Lend-Lpc, v102
global_load_dword v255, v102, s[74:75]
Lnopf:
s_add_u32 s66, s66, 786432
ds_read_b128 v[224:227], v248 offset:16384
ds_read_b128 v[228:231], v248 offset:19456
ds_read_b128 v[232:235], v248 offset:17408
ds_read_b128 v[236:239], v248 offset:20480
ds_read_b128 v[216:219], v248 offset:18432
ds_read_b128 v[220:223], v248 offset:21504
s_setprio 2
s_waitcnt lgkmcnt(5)
v_mfma_f32_32x32x16_bf16 v[120:135], v[48:51], v[224:227], 0
s_waitcnt lgkmcnt(4)
ds_read_b128 v[224:227], v248 offset:22528
v_mfma_f32_32x32x16_bf16 v[120:135], v[52:55], v[228:231], v[120:135]
s_waitcnt lgkmcnt(4)
ds_read_b128 v[228:231], v248 offset:25600
v_mfma_f32_32x32x16_bf16 v[120:135], v[56:59], v[232:235], v[120:135]
s_waitcnt lgkmcnt(4)
ds_read_b128 v[232:235], v248 offset:23552
v_mfma_f32_32x32x16_bf16 v[120:135], v[60:63], v[236:239], v[120:135]
s_waitcnt lgkmcnt(4)
ds_read_b128 v[236:239], v248 offset:26624
v_mfma_f32_32x32x16_bf16 v[120:135], v[64:67], v[216:219], v[120:135]
s_waitcnt lgkmcnt(4)
ds_read_b128 v[216:219], v248 offset:24576
v_mfma_f32_32x32x16_bf16 v[120:135], v[68:71], v[220:223], v[120:135]
v_add_u32 v174, -36864, v242
v_subrev_u32 v175, 66560, v174
v_min_u32 v174, v174, v175
v_add_u32 v174, 90112, v174
v_sub_u32 v175, v174, v242
v_add_u32 v242, v175, v242
v_add_u32 v243, v175, v243
v_add_u32 v244, v175, v244
s_nop 3
v_cvt_pkrtz_f16_f32 v137, v120, v121
v_cvt_pkrtz_f16_f32 v139, v122, v123
v_cvt_pkrtz_f16_f32 v141, v124, v125
v_cvt_pkrtz_f16_f32 v143, v126, v127
v_cvt_pkrtz_f16_f32 v177, v128, v129
v_cvt_pk_f16_f32 v155, v130, v131
v_cvt_pk_f16_f32 v152, v132, v133
v_cvt_pk_f16_f32 v149, v134, v135
s_waitcnt lgkmcnt(1)
ds_read_b128 v[220:223], v248 offset:27648
v_mfma_f32_32x32x16_bf16 v[120:135], v[48:51], v[224:227], 0
v_pk_fma_f16 v154, v155, v155, s48
v_and_b32 v137, s49, v137
v_pk_fma_f16 v151, v152, v152, s48
v_pk_fma_f16 v148, v149, v149, s48
v_lshrrev_b16 v136, 2, v137
v_pk_mul_f16 v154, v155, v154
v_pk_mul_f16 v151, v152, v151
v_pk_mul_f16 v148, v149, v148
ds_read_b128 v[224:227], v248 offset:28672
ds_read_u16_d16 v136, v136
v_mfma_f32_32x32x16_bf16 v[120:135], v[52:55], v[228:231], v[120:135]
v_lshrrev_b32 v137, 18, v137
v_exp_f16 v153, v154
v_exp_f16 v150, v151
v_and_b32 v139, s49, v139
v_exp_f16 v147, v148
v_lshrrev_b16 v138, 2, v139
ds_read_b128 v[228:231], v248 offset:31744
ds_read_u16_d16_hi v137, v137
ds_read_u16_d16 v138, v138
v_mfma_f32_32x32x16_bf16 v[120:135], v[56:59], v[232:235], v[120:135]
v_exp_f16_sdwa v153, v154 dst_sel:WORD_1 dst_unused:UNUSED_PRESERVE src0_sel:WORD_1
v_lshrrev_b32 v139, 18, v139
v_exp_f16_sdwa v150, v151 dst_sel:WORD_1 dst_unused:UNUSED_PRESERVE src0_sel:WORD_1
v_exp_f16_sdwa v147, v148 dst_sel:WORD_1 dst_unused:UNUSED_PRESERVE src0_sel:WORD_1
v_and_b32 v141, s49, v141
ds_read_b128 v[232:235], v248 offset:29696
ds_read_u16_d16_hi v139, v139
v_mfma_f32_32x32x16_bf16 v[120:135], v[60:63], v[236:239], v[120:135]
v_pk_add_f16 v153, v153, 1.0 op_sel_hi:[1,0]
v_lshrrev_b16 v140, 2, v141
v_pk_add_f16 v150, v150, 1.0 op_sel_hi:[1,0]
v_pk_add_f16 v147, v147, 1.0 op_sel_hi:[1,0]
v_rcp_f16 v154, v153
v_lshrrev_b32 v141, 18, v141
v_rcp_f16 v151, v150
s_waitcnt lgkmcnt(5)
ds_read_b128 v[236:239], v248 offset:32768
ds_read_u16_d16 v140, v140
ds_read_u16_d16_hi v141, v141
v_mfma_f32_32x32x16_bf16 v[120:135], v[64:67], v[216:219], v[120:135]
v_and_b32 v143, s49, v143
v_rcp_f16 v148, v147
v_lshrrev_b16 v142, 2, v143
v_rcp_f16_sdwa v154, v153 dst_sel:WORD_1 dst_unused:UNUSED_PRESERVE src0_sel:WORD_1
v_rcp_f16_sdwa v151, v150 dst_sel:WORD_1 dst_unused:UNUSED_PRESERVE src0_sel:WORD_1
ds_read_b128 v[216:219], v248 offset:30720
ds_read_u16_d16 v142, v142
ds_read_b32 v247, v253 offset:16
v_mfma_f32_32x32x16_bf16 v[120:135], v[68:71], v[220:223], v[120:135]
v_lshrrev_b32 v143, 18, v143
v_rcp_f16_sdwa v148, v147 dst_sel:WORD_1 dst_unused:UNUSED_PRESERVE src0_sel:WORD_1
v_and_b32 v177, s49, v177
v_pk_mul_f16 v155, v155, v154
v_pk_mul_f16 v152, v152, v151
v_lshrrev_b16 v176, 2, v177
v_pk_mul_f16 v149, v149, v148
v_fma_mix_f32 v156, v155, v155, 0 op_sel:[0,0,0] op_sel_hi:[1,1,0]
v_fma_mix_f32 v156, v155, v155, v156 op_sel:[1,1,0] op_sel_hi:[1,1,0]
v_lshrrev_b32 v177, 18, v177
v_fma_mix_f32 v156, v152, v152, v156 op_sel:[0,0,0] op_sel_hi:[1,1,0]
v_fma_mix_f32 v156, v152, v152, v156 op_sel:[1,1,0] op_sel_hi:[1,1,0]
v_fma_mix_f32 v156, v149, v149, v156 op_sel:[0,0,0] op_sel_hi:[1,1,0]
v_fma_mix_f32 v156, v149, v149, v156 op_sel:[1,1,0] op_sel_hi:[1,1,0]
ds_read_u16_d16_hi v143, v143
ds_read_u16_d16 v176, v176
ds_read_u16_d16_hi v177, v177
s_waitcnt lgkmcnt(3)
v_readfirstlane_b32 s43, v247
s_nop 1
s_cmp_ge_u32 s43, 8
s_cbranch_scc1 Lev1
Lev1w:
s_sleep 1
ds_read_b32 v247, v253 offset:16
s_waitcnt lgkmcnt(0)
v_readfirstlane_b32 s43, v247
s_cmp_eq_u32 s76, 0
s_cbranch_scc1 Lev1
s_sub_u32 s76, s76, 1
s_cmp_lt_u32 s43, 8
s_cbranch_scc1 Lev1w
Lev1:
v_cvt_pkrtz_f16_f32 v179, v120, v121
v_cvt_pkrtz_f16_f32 v181, v122, v123
v_cvt_pkrtz_f16_f32 v183, v124, v125
v_cvt_pkrtz_f16_f32 v185, v126, v127
v_cvt_pkrtz_f16_f32 v187, v128, v129
v_cvt_pk_f16_f32 v155, v130, v131
v_cvt_pk_f16_f32 v152, v132, v133
v_cvt_pk_f16_f32 v149, v134, v135
s_add_u32 m0, s67, 0
s_add_u32 s66, s66, 98304
buffer_load_dwordx4 v240, s[4:7], s66 offen lds
ds_read_b128 v[220:223], v248 offset:33792
v_mfma_f32_32x32x16_bf16 v[120:135], v[48:51], v[224:227], 0
v_pk_fma_f16 v154, v155, v155, s48
v_and_b32 v179, s49, v179
v_fma_mix_f32 v156, v136, v136, v156 op_sel:[0,0,0] op_sel_hi:[1,1,0]
v_pk_fma_f16 v151, v152, v152, s48
v_pk_fma_f16 v148, v149, v149, s48
v_lshrrev_b16 v178, 2, v179
v_pk_mul_f16 v154, v155, v154
v_pk_mul_f16 v151, v152, v151
v_fma_mix_f32 v156, v137, v137, v156 op_sel:[1,1,0] op_sel_hi:[1,1,0]
v_lshrrev_b32 v179, 18, v179
s_add_u32 m0, s67, 6656
s_add_u32 s66, s66, 98304
buffer_load_dwordx4 v240, s[4:7], s66 offen lds
ds_read_b128 v[224:227], v248 offset:34816
ds_read_u16_d16 v178, v178
ds_read_u16_d16_hi v179, v179
v_mfma_f32_32x32x16_bf16 v[120:135], v[52:55], v[228:231], v[120:135]
v_pk_mul_f16 v148, v149, v148
v_exp_f16 v153, v154
v_exp_f16 v150, v151
v_and_b32 v181, s49, v181
v_fma_mix_f32 v156, v138, v138, v156 op_sel:[0,0,0] op_sel_hi:[1,1,0]
v_exp_f16 v147, v148
v_lshrrev_b16 v180, 2, v181
s_add_u32 m0, s67, 13312
s_add_u32 s66, s66, 98304
buffer_load_dwordx4 v240, s[4:7], s66 offen lds
ds_read_b128 v[228:231], v248 offset:37888
ds_read_u16_d16 v180, v180
v_mfma_f32_32x32x16_bf16 v[120:135], v[56:59], v[232:235], v[120:135]
v_exp_f16_sdwa v153, v154 dst_sel:WORD_1 dst_unused:UNUSED_PRESERVE src0_sel:WORD_1
v_lshrrev_b32 v181, 18, v181
v_fma_mix_f32 v156, v139, v139, v156 op_sel:[1,1,0] op_sel_hi:[1,1,0]
v_exp_f16_sdwa v150, v151 dst_sel:WORD_1 dst_unused:UNUSED_PRESERVE src0_sel:WORD_1
v_exp_f16_sdwa v147, v148 dst_sel:WORD_1 dst_unused:UNUSED_PRESERVE src0_sel:WORD_1
v_and_b32 v183, s49, v183
v_fma_mix_f32 v156, v140, v140, v156 op_sel:[0,0,0] op_sel_hi:[1,1,0]
s_add_u32 m0, s67, 19968
s_add_u32 s66, s66, 98304
buffer_load_dwordx4 v240, s[4:7], s66 offen lds
s_add_u32 m0, s67, 26624
s_add_u32 s66, s66, 98304
buffer_load_dwordx4 v240, s[4:7], s66 offen lds
ds_read_b128 v[232:235], v248 offset:35840
ds_read_u16_d16_hi v181, v181
v_mfma_f32_32x32x16_bf16 v[120:135], v[60:63], v[236:239], v[120:135]
v_pk_add_f16 v153, v153, 1.0 op_sel_hi:[1,0]
v_lshrrev_b16 v182, 2, v183
v_pk_add_f16 v150, v150, 1.0 op_sel_hi:[1,0]
v_pk_add_f16 v147, v147, 1.0 op_sel_hi:[1,0]
v_rcp_f16 v154, v153
v_lshrrev_b32 v183, 18, v183
v_fma_mix_f32 v156, v141, v141, v156 op_sel:[1,1,0] op_sel_hi:[1,1,0]
v_rcp_f16 v151, v150
s_add_u32 m0, s67, 33280
s_add_u32 s66, s66, 98304
buffer_load_dwordx4 v240, s[4:7], s66 offen lds
ds_read_b128 v[236:239], v248 offset:38912
ds_read_u16_d16 v182, v182
ds_read_u16_d16_hi v183, v183
v_mfma_f32_32x32x16_bf16 v[120:135], v[64:67], v[216:219], v[120:135]
v_and_b32 v185, s49, v185
v_rcp_f16 v148, v147
v_fma_mix_f32 v156, v142, v142, v156 op_sel:[0,0,0] op_sel_hi:[1,1,0]
v_lshrrev_b16 v184, 2, v185
v_rcp_f16_sdwa v154, v153 dst_sel:WORD_1 dst_unused:UNUSED_PRESERVE src0_sel:WORD_1
v_rcp_f16_sdwa v151, v150 dst_sel:WORD_1 dst_unused:UNUSED_PRESERVE src0_sel:WORD_1
v_lshrrev_b32 v185, 18, v185
s_waitcnt lgkmcnt(4)
s_add_u32 m0, s67, 39936
s_add_u32 s66, s66, 98304
buffer_load_dwordx4 v240, s[4:7], s66 offen lds
ds_read_b128 v[216:219], v248 offset:36864
ds_read_u16_d16 v184, v184
ds_read_u16_d16_hi v185, v185
v_mfma_f32_32x32x16_bf16 v[120:135], v[68:71], v[220:223], v[120:135]
v_fma_mix_f32 v156, v143, v143, v156 op_sel:[1,1,0] op_sel_hi:[1,1,0]
v_rcp_f16_sdwa v148, v147 dst_sel:WORD_1 dst_unused:UNUSED_PRESERVE src0_sel:WORD_1
v_and_b32 v187, s49, v187
v_pk_mul_f16 v155, v155, v154
v_fma_mix_f32 v156, v176, v176, v156 op_sel:[0,0,0] op_sel_hi:[1,1,0]
v_pk_mul_f16 v152, v152, v151
v_lshrrev_b16 v186, 2, v187
v_pk_mul_f16 v149, v149, v148
v_fma_mix_f32 v157, v155, v155, 0 op_sel:[0,0,0] op_sel_hi:[1,1,0]
s_add_u32 m0, s67, 46592
s_add_u32 s66, s66, 98304
buffer_load_dwordx4 v240, s[4:7], s66 offen lds
v_fma_mix_f32 v157, v155, v155, v157 op_sel:[1,1,0] op_sel_hi:[1,1,0]
v_lshrrev_b32 v187, 18, v187
v_fma_mix_f32 v156, v177, v177, v156 op_sel:[1,1,0] op_sel_hi:[1,1,0]
v_fma_mix_f32 v157, v152, v152, v157 op_sel:[0,0,0] op_sel_hi:[1,1,0]
v_fma_mix_f32 v157, v152, v152, v157 op_sel:[1,1,0] op_sel_hi:[1,1,0]
v_fma_mix_f32 v157, v149, v149, v157 op_sel:[0,0,0] op_sel_hi:[1,1,0]
v_fma_mix_f32 v157, v149, v149, v157 op_sel:[1,1,0] op_sel_hi:[1,1,0]
s_cmp_lt_u32 s40, 4
s_cbranch_scc0 Lsu5
s_waitcnt vmcnt(14)
s_call_b64 s[78:79], Lw1b
s_mov_b64 exec, 1
ds_add_u32 v253, v254 offset:24
s_mov_b64 exec, -1
Lsu5:
s_setprio 1
v_cvt_pkrtz_f16_f32 v137, v120, v121
v_cvt_pkrtz_f16_f32 v139, v122, v123
v_cvt_pkrtz_f16_f32 v141, v124, v125
v_cvt_pkrtz_f16_f32 v143, v126, v127
v_cvt_pkrtz_f16_f32 v177, v128, v129
v_cvt_pk_f16_f32 v155, v130, v131
v_cvt_pk_f16_f32 v152, v132, v133
v_cvt_pk_f16_f32 v149, v134, v135
ds_read_b128 v[220:223], v248 offset:39936
ds_read_u16_d16 v186, v186
ds_read_u16_d16_hi v187, v187
v_mfma_f32_32x32x16_bf16 v[120:135], v[48:51], v[224:227], 0
v_pk_fma_f16 v154, v155, v155, s48
v_and_b32 v137, s49, v137
v_fma_mix_f32 v157, v178, v178, v157 op_sel:[0,0,0] op_sel_hi:[1,1,0]
v_pk_fma_f16 v151, v152, v152, s48
v_pk_fma_f16 v148, v149, v149, s48
v_lshrrev_b16 v136, 2, v137
v_pk_mul_f16 v154, v155, v154
v_pk_mul_f16 v151, v152, v151
v_fma_mix_f32 v157, v179, v179, v157 op_sel:[1,1,0] op_sel_hi:[1,1,0]
v_lshrrev_b32 v137, 18, v137
ds_read_u16_d16 v136, v136
ds_read_b32 v247, v253 offset:24
ds_read_u16_d16_hi v137, v137
v_mfma_f32_32x32x16_bf16 v[120:135], v[52:55], v[228:231], v[120:135]
v_pk_mul_f16 v148, v149, v148
v_exp_f16 v153, v154
v_exp_f16 v150, v151
v_and_b32 v139, s49, v139
v_fma_mix_f32 v157, v180, v180, v157 op_sel:[0,0,0] op_sel_hi:[1,1,0]
v_exp_f16 v147, v148
v_lshrrev_b16 v138, 2, v139
ds_read_u16_d16 v138, v138
v_mfma_f32_32x32x16_bf16 v[120:135], v[56:59], v[232:235], v[120:135]
v_exp_f16_sdwa v153, v154 dst_sel:WORD_1 dst_unused:UNUSED_PRESERVE src0_sel:WORD_1
v_lshrrev_b32 v139, 18, v139
s_waitcnt lgkmcnt(4)
v_fma_mix_f32 v157, v181, v181, v157 op_sel:[1,1,0] op_sel_hi:[1,1,0]
v_exp_f16_sdwa v150, v151 dst_sel:WORD_1 dst_unused:UNUSED_PRESERVE src0_sel:WORD_1
v_exp_f16_sdwa v147, v148 dst_sel:WORD_1 dst_unused:UNUSED_PRESERVE src0_sel:WORD_1
v_and_b32 v141, s49, v141
v_fma_mix_f32 v157, v182, v182, v157 op_sel:[0,0,0] op_sel_hi:[1,1,0]
ds_read_u16_d16_hi v139, v139
s_waitcnt lgkmcnt(3)
v_readfirstlane_b32 s43, v247
s_nop 1
s_cmp_ge_u32 s43, 4
s_cbranch_scc1 Lev2
Lev2w:
s_sleep 1
ds_read_b32 v247, v253 offset:24
s_waitcnt lgkmcnt(0)
v_readfirstlane_b32 s43, v247
s_cmp_eq_u32 s76, 0
s_cbranch_scc1 Lev2
s_sub_u32 s76, s76, 1
s_cmp_lt_u32 s43, 4
s_cbranch_scc1 Lev2w
Lev2:
ds_read_b128 v[224:227], v248 offset:40960
ds_read_b128 v[228:231], v248 offset:44032
ds_read_b128 v[232:235], v248 offset:41984
v_mfma_f32_32x32x16_bf16 v[120:135], v[60:63], v[236:239], v[120:135]
v_pk_add_f16 v153, v153, 1.0 op_sel_hi:[1,0]
v_lshrrev_b16 v140, 2, v141
v_pk_add_f16 v150, v150, 1.0 op_sel_hi:[1,0]
v_pk_add_f16 v147, v147, 1.0 op_sel_hi:[1,0]
v_rcp_f16 v154, v153
v_lshrrev_b32 v141, 18, v141
v_fma_mix_f32 v157, v183, v183, v157 op_sel:[1,1,0] op_sel_hi:[1,1,0]
v_rcp_f16 v151, v150
ds_read_b128 v[236:239], v248 offset:45056
ds_read_u16_d16 v140, v140
ds_read_u16_d16_hi v141, v141
v_mfma_f32_32x32x16_bf16 v[120:135], v[64:67], v[216:219], v[120:135]
v_and_b32 v143, s49, v143
v_rcp_f16 v148, v147
v_fma_mix_f32 v157, v184, v184, v157 op_sel:[0,0,0] op_sel_hi:[1,1,0]
v_lshrrev_b16 v142, 2, v143
v_rcp_f16_sdwa v154, v153 dst_sel:WORD_1 dst_unused:UNUSED_PRESERVE src0_sel:WORD_1
v_rcp_f16_sdwa v151, v150 dst_sel:WORD_1 dst_unused:UNUSED_PRESERVE src0_sel:WORD_1
v_lshrrev_b32 v143, 18, v143
ds_read_b128 v[216:219], v248 offset:43008
ds_read_u16_d16 v142, v142
ds_read_u16_d16_hi v143, v143
v_mfma_f32_32x32x16_bf16 v[120:135], v[68:71], v[220:223], v[120:135]
v_fma_mix_f32 v157, v185, v185, v157 op_sel:[1,1,0] op_sel_hi:[1,1,0]
v_rcp_f16_sdwa v148, v147 dst_sel:WORD_1 dst_unused:UNUSED_PRESERVE src0_sel:WORD_1
v_and_b32 v177, s49, v177
v_pk_mul_f16 v155, v155, v154
v_fma_mix_f32 v157, v186, v186, v157 op_sel:[0,0,0] op_sel_hi:[1,1,0]
v_pk_mul_f16 v152, v152, v151
v_lshrrev_b16 v176, 2, v177
v_pk_mul_f16 v149, v149, v148
v_fma_mix_f32 v158, v155, v155, 0 op_sel:[0,0,0] op_sel_hi:[1,1,0]
v_fma_mix_f32 v158, v155, v155, v158 op_sel:[1,1,0] op_sel_hi:[1,1,0]
v_lshrrev_b32 v177, 18, v177
v_fma_mix_f32 v157, v187, v187, v157 op_sel:[1,1,0] op_sel_hi:[1,1,0]
v_fma_mix_f32 v158, v152, v152, v158 op_sel:[0,0,0] op_sel_hi:[1,1,0]
v_fma_mix_f32 v158, v152, v152, v158 op_sel:[1,1,0] op_sel_hi:[1,1,0]
v_fma_mix_f32 v158, v149, v149, v158 op_sel:[0,0,0] op_sel_hi:[1,1,0]
v_fma_mix_f32 v158, v149, v149, v158 op_sel:[1,1,0] op_sel_hi:[1,1,0]
v_cvt_pkrtz_f16_f32 v179, v120, v121
v_cvt_pkrtz_f16_f32 v181, v122, v123
v_cvt_pkrtz_f16_f32 v183, v124, v125
v_cvt_pkrtz_f16_f32 v185, v126, v127
v_cvt_pkrtz_f16_f32 v187, v128, v129
v_cvt_pk_f16_f32 v155, v130, v131
v_cvt_pk_f16_f32 v152, v132, v133
v_cvt_pk_f16_f32 v149, v134, v135
s_waitcnt lgkmcnt(0)
ds_read_b128 v[220:223], v248 offset:46080
ds_read_u16_d16 v176, v176
ds_read_u16_d16_hi v177, v177
v_mfma_f32_32x32x16_bf16 v[120:135], v[48:51], v[224:227], 0
v_pk_fma_f16 v154, v155, v155, s48
v_and_b32 v179, s49, v179
v_fma_mix_f32 v158, v136, v136, v158 op_sel:[0,0,0] op_sel_hi:[1,1,0]
v_pk_fma_f16 v151, v152, v152, s48
v_pk_fma_f16 v148, v149, v149, s48
v_lshrrev_b16 v178, 2, v179
v_pk_mul_f16 v154, v155, v154
v_pk_mul_f16 v151, v152, v151
v_fma_mix_f32 v158, v137, v137, v158 op_sel:[1,1,0] op_sel_hi:[1,1,0]
v_lshrrev_b32 v179, 18, v179
ds_read_b128 v[224:227], v248 offset:47104
ds_read_u16_d16 v178, v178
ds_read_u16_d16_hi v179, v179
v_mfma_f32_32x32x16_bf16 v[120:135], v[52:55], v[228:231], v[120:135]
v_pk_mul_f16 v148, v149, v148
v_exp_f16 v153, v154
v_exp_f16 v150, v151
v_and_b32 v181, s49, v181
v_fma_mix_f32 v158, v138, v138, v158 op_sel:[0,0,0] op_sel_hi:[1,1,0]
v_exp_f16 v147, v148
v_lshrrev_b16 v180, 2, v181
ds_read_b128 v[228:231], v248 offset:50176
ds_read_u16_d16 v180, v180
v_mfma_f32_32x32x16_bf16 v[120:135], v[56:59], v[232:235], v[120:135]
v_exp_f16_sdwa v153, v154 dst_sel:WORD_1 dst_unused:UNUSED_PRESERVE src0_sel:WORD_1
v_lshrrev_b32 v181, 18, v181
v_fma_mix_f32 v158, v139, v139, v158 op_sel:[1,1,0] op_sel_hi:[1,1,0]
v_exp_f16_sdwa v150, v151 dst_sel:WORD_1 dst_unused:UNUSED_PRESERVE src0_sel:WORD_1
v_exp_f16_sdwa v147, v148 dst_sel:WORD_1 dst_unused:UNUSED_PRESERVE src0_sel:WORD_1
v_and_b32 v183, s49, v183
v_fma_mix_f32 v158, v140, v140, v158 op_sel:[0,0,0] op_sel_hi:[1,1,0]
ds_read_b128 v[232:235], v248 offset:48128
ds_read_u16_d16_hi v181, v181
v_mfma_f32_32x32x16_bf16 v[120:135], v[60:63], v[236:239], v[120:135]
v_pk_add_f16 v153, v153, 1.0 op_sel_hi:[1,0]
v_lshrrev_b16 v182, 2, v183
v_pk_add_f16 v150, v150, 1.0 op_sel_hi:[1,0]
v_pk_add_f16 v147, v147, 1.0 op_sel_hi:[1,0]
v_rcp_f16 v154, v153
v_lshrrev_b32 v183, 18, v183
v_fma_mix_f32 v158, v141, v141, v158 op_sel:[1,1,0] op_sel_hi:[1,1,0]
v_rcp_f16 v151, v150
ds_read_b128 v[236:239], v248 offset:51200
ds_read_u16_d16 v182, v182
ds_read_u16_d16_hi v183, v183
v_mfma_f32_32x32x16_bf16 v[120:135], v[64:67], v[216:219], v[120:135]
v_and_b32 v185, s49, v185
v_rcp_f16 v148, v147
v_fma_mix_f32 v158, v142, v142, v158 op_sel:[0,0,0] op_sel_hi:[1,1,0]
v_lshrrev_b16 v184, 2, v185
v_rcp_f16_sdwa v154, v153 dst_sel:WORD_1 dst_unused:UNUSED_PRESERVE src0_sel:WORD_1
v_rcp_f16_sdwa v151, v150 dst_sel:WORD_1 dst_unused:UNUSED_PRESERVE src0_sel:WORD_1
v_lshrrev_b32 v185, 18, v185
s_waitcnt lgkmcnt(5)
ds_read_b128 v[216:219], v248 offset:49152
ds_read_u16_d16 v184, v184
ds_read_u16_d16_hi v185, v185
v_mfma_f32_32x32x16_bf16 v[120:135], v[68:71], v[220:223], v[120:135]
v_fma_mix_f32 v158, v143, v143, v158 op_sel:[1,1,0] op_sel_hi:[1,1,0]
v_rcp_f16_sdwa v148, v147 dst_sel:WORD_1 dst_unused:UNUSED_PRESERVE src0_sel:WORD_1
s_cmp_eq_u32 s40, 7
s_cbranch_scc1 Lrdy8
s_waitcnt vmcnt(0)
Lrdy8:
s_mov_b64 exec, 1
ds_add_u32 v253, v254 offset:12
s_mov_b64 exec, -1
v_and_b32 v187, s49, v187
v_pk_mul_f16 v155, v155, v154
v_fma_mix_f32 v158, v176, v176, v158 op_sel:[0,0,0] op_sel_hi:[1,1,0]
v_pk_mul_f16 v152, v152, v151
v_lshrrev_b16 v186, 2, v187
v_pk_mul_f16 v149, v149, v148
v_fma_mix_f32 v159, v155, v155, 0 op_sel:[0,0,0] op_sel_hi:[1,1,0]
v_fma_mix_f32 v159, v155, v155, v159 op_sel:[1,1,0] op_sel_hi:[1,1,0]
v_lshrrev_b32 v187, 18, v187
v_fma_mix_f32 v158, v177, v177, v158 op_sel:[1,1,0] op_sel_hi:[1,1,0]
v_fma_mix_f32 v159, v152, v152, v159 op_sel:[0,0,0] op_sel_hi:[1,1,0]
v_fma_mix_f32 v159, v152, v152, v159 op_sel:[1,1,0] op_sel_hi:[1,1,0]
v_fma_mix_f32 v159, v149, v149, v159 op_sel:[0,0,0] op_sel_hi:[1,1,0]
v_fma_mix_f32 v159, v149, v149, v159 op_sel:[1,1,0] op_sel_hi:[1,1,0]
s_cmp_lt_u32 s40, 4
s_cbranch_scc0 Lsu6
s_waitcnt vmcnt(8)
s_call_b64 s[78:79], Lw1c
s_mov_b64 exec, 1
ds_add_u32 v253, v254 offset:28
s_mov_b64 exec, -1
Lsu6:
v_cvt_pkrtz_f16_f32 v137, v120, v121
v_cvt_pkrtz_f16_f32 v139, v122, v123
v_cvt_pkrtz_f16_f32 v141, v124, v125
v_cvt_pkrtz_f16_f32 v143, v126, v127
v_cvt_pkrtz_f16_f32 v177, v128, v129
v_cvt_pk_f16_f32 v155, v130, v131
v_cvt_pk_f16_f32 v152, v132, v133
v_cvt_pk_f16_f32 v149, v134, v135
s_setprio 0
ds_read_b128 v[220:223], v248 offset:52224
ds_read_u16_d16 v186, v186
ds_read_u16_d16_hi v187, v187
v_mfma_f32_32x32x16_bf16 v[120:135], v[48:51], v[224:227], 0
v_pk_fma_f16 v154, v155, v155, s48
v_and_b32 v137, s49, v137
v_fma_mix_f32 v159, v178, v178, v159 op_sel:[0,0,0] op_sel_hi:[1,1,0]
v_pk_fma_f16 v151, v152, v152, s48
v_pk_fma_f16 v148, v149, v149, s48
v_lshrrev_b16 v136, 2, v137
v_pk_mul_f16 v154, v155, v154
v_pk_mul_f16 v151, v152, v151
v_fma_mix_f32 v159, v179, v179, v159 op_sel:[1,1,0] op_sel_hi:[1,1,0]
v_lshrrev_b32 v137, 18, v137
ds_read_b128 v[224:227], v250 offset:65520
ds_read_u16_d16 v136, v136
ds_read_u16_d16_hi v137, v137
v_mfma_f32_32x32x16_bf16 v[120:135], v[52:55], v[228:231], v[120:135]
v_pk_mul_f16 v148, v149, v148
v_exp_f16 v153, v154
v_exp_f16 v150, v151
v_and_b32 v139, s49, v139
v_fma_mix_f32 v159, v180, v180, v159 op_sel:[0,0,0] op_sel_hi:[1,1,0]
v_exp_f16 v147, v148
v_lshrrev_b16 v138, 2, v139
s_waitcnt lgkmcnt(7)
ds_read_b128 v[228:231], v248 offset:53248
ds_read_b32 v247, v253 offset:12
ds_read_u16_d16 v138, v138
v_mfma_f32_32x32x16_bf16 v[120:135], v[56:59], v[232:235], v[120:135]
v_exp_f16_sdwa v153, v154 dst_sel:WORD_1 dst_unused:UNUSED_PRESERVE src0_sel:WORD_1
v_lshrrev_b32 v139, 18, v139
v_fma_mix_f32 v159, v181, v181, v159 op_sel:[1,1,0] op_sel_hi:[1,1,0]
v_exp_f16_sdwa v150, v151 dst_sel:WORD_1 dst_unused:UNUSED_PRESERVE src0_sel:WORD_1
v_exp_f16_sdwa v147, v148 dst_sel:WORD_1 dst_unused:UNUSED_PRESERVE src0_sel:WORD_1
v_and_b32 v141, s49, v141
v_fma_mix_f32 v159, v182, v182, v159 op_sel:[0,0,0] op_sel_hi:[1,1,0]
ds_read_b128 v[232:235], v248 offset:56320
ds_read_u16_d16_hi v139, v139
v_mfma_f32_32x32x16_bf16 v[120:135], v[60:63], v[236:239], v[120:135]
v_pk_add_f16 v153, v153, 1.0 op_sel_hi:[1,0]
v_lshrrev_b16 v140, 2, v141
v_pk_add_f16 v150, v150, 1.0 op_sel_hi:[1,0]
v_pk_add_f16 v147, v147, 1.0 op_sel_hi:[1,0]
v_rcp_f16 v154, v153
v_lshrrev_b32 v141, 18, v141
ds_read_u16_d16 v140, v140
ds_read_u16_d16_hi v141, v141
s_waitcnt lgkmcnt(5)
v_readfirstlane_b32 s43, v247
s_nop 1
s_cmp_ge_u32 s43, 16
s_cbranch_scc1 Lev3
Lev3w:
s_sleep 1
ds_read_b32 v247, v253 offset:12
s_waitcnt lgkmcnt(0)
v_readfirstlane_b32 s43, v247
s_cmp_eq_u32 s76, 0
s_cbranch_scc1 Lev3
s_sub_u32 s76, s76, 1
s_cmp_lt_u32 s43, 16
s_cbranch_scc1 Lev3w
Lev3:
v_fma_mix_f32 v159, v183, v183, v159 op_sel:[1,1,0] op_sel_hi:[1,1,0]
v_rcp_f16 v151, v150
ds_read_b128 v[236:239], v245 offset:6528
ds_read_b128 v[192:195], v244 offset:128
ds_read_b128 v[196:199], v244 offset:64
v_mfma_f32_32x32x16_bf16 v[120:135], v[64:67], v[216:219], v[120:135]
v_and_b32 v143, s49, v143
v_rcp_f16 v148, v147
v_fma_mix_f32 v159, v184, v184, v159 op_sel:[0,0,0] op_sel_hi:[1,1,0]
v_lshrrev_b16 v142, 2, v143
v_rcp_f16_sdwa v154, v153 dst_sel:WORD_1 dst_unused:UNUSED_PRESERVE src0_sel:WORD_1
v_rcp_f16_sdwa v151, v150 dst_sel:WORD_1 dst_unused:UNUSED_PRESERVE src0_sel:WORD_1
v_lshrrev_b32 v143, 18, v143
ds_read_b128 v[216:219], v248 offset:54272
ds_read_u16_d16 v142, v142
ds_read_u16_d16_hi v143, v143
v_mfma_f32_32x32x16_bf16 v[120:135], v[68:71], v[220:223], v[120:135]
v_fma_mix_f32 v159, v185, v185, v159 op_sel:[1,1,0] op_sel_hi:[1,1,0]
v_rcp_f16_sdwa v148, v147 dst_sel:WORD_1 dst_unused:UNUSED_PRESERVE src0_sel:WORD_1
v_and_b32 v177, s49, v177
v_pk_mul_f16 v155, v155, v154
v_fma_mix_f32 v159, v186, v186, v159 op_sel:[0,0,0] op_sel_hi:[1,1,0]
v_pk_mul_f16 v152, v152, v151
v_lshrrev_b16 v176, 2, v177
v_pk_mul_f16 v149, v149, v148
v_fma_mix_f32 v160, v155, v155, 0 op_sel:[0,0,0] op_sel_hi:[1,1,0]
v_fma_mix_f32 v160, v155, v155, v160 op_sel:[1,1,0] op_sel_hi:[1,1,0]
v_lshrrev_b32 v177, 18, v177
v_fma_mix_f32 v159, v187, v187, v159 op_sel:[1,1,0] op_sel_hi:[1,1,0]
v_fma_mix_f32 v160, v152, v152, v160 op_sel:[0,0,0] op_sel_hi:[1,1,0]
v_fma_mix_f32 v160, v152, v152, v160 op_sel:[1,1,0] op_sel_hi:[1,1,0]
v_fma_mix_f32 v160, v149, v149, v160 op_sel:[0,0,0] op_sel_hi:[1,1,0]
v_fma_mix_f32 v160, v149, v149, v160 op_sel:[1,1,0] op_sel_hi:[1,1,0]
s_setprio 2
v_mfma_f32_32x32x16_bf16 v[0:15], v[224:227], v[224:227], 0
ds_read_b128 v[220:223], v245 offset:6144
ds_read_b128 v[200:203], v244
ds_read_b128 v[204:207], v243 offset:128
ds_read_u16_d16 v176, v176
ds_read_u16_d16_hi v177, v177
v_cvt_pkrtz_f16_f32 v179, v120, v121
v_cvt_pkrtz_f16_f32 v181, v122, v123
v_cvt_pkrtz_f16_f32 v183, v124, v125
v_mfma_f32_32x32x16_bf16 v[16:31], v[224:227], v[224:227], 0
v_cvt_pkrtz_f16_f32 v185, v126, v127
v_cvt_pkrtz_f16_f32 v187, v128, v129
v_cvt_pk_f16_f32 v155, v130, v131
v_mfma_f32_32x32x16_bf16 v[32:47], v[224:227], v[224:227], 0
v_cvt_pk_f16_f32 v152, v132, v133
v_cvt_pk_f16_f32 v149, v134, v135
v_pk_fma_f16 v154, v155, v155, s48
v_mfma_f32_32x32x16_bf16 v[120:135], v[48:51], v[228:231], 0
ds_read_b128 v[224:227], v248 offset:57344
v_and_b32 v179, s49, v179
v_fma_mix_f32 v160, v136, v136, v160 op_sel:[0,0,0] op_sel_hi:[1,1,0]
v_pk_fma_f16 v151, v152, v152, s48
v_pk_fma_f16 v148, v149, v149, s48
v_lshrrev_b16 v178, 2, v179
v_pk_mul_f16 v154, v155, v154
s_waitcnt lgkmcnt(6)
v_mfma_f32_32x32x16_bf16 v[120:135], v[52:55], v[232:235], v[120:135]
ds_read_b128 v[228:231], v245 offset:5760
ds_read_b128 v[208:211], v243 offset:64
ds_read_b128 v[212:215], v243
ds_read_u16_d16 v178, v178
v_pk_mul_f16 v151, v152, v151
v_fma_mix_f32 v160, v137, v137, v160 op_sel:[1,1,0] op_sel_hi:[1,1,0]
v_lshrrev_b32 v179, 18, v179
v_pk_mul_f16 v148, v149, v148
v_exp_f16 v153, v154
v_smfmac_f32_16x16x32_bf16 v[40:43], v[238:239], v[192:195], v246
ds_read_b128 v[232:235], v248 offset:55296
ds_read_u16_d16_hi v179, v179
v_exp_f16 v150, v151
v_and_b32 v181, s49, v181
v_smfmac_f32_16x16x32_bf16 v[24:27], v[236:237], v[196:199], v246
v_fma_mix_f32 v160, v138, v138, v160 op_sel:[0,0,0] op_sel_hi:[1,1,0]
v_exp_f16 v147, v148
v_mfma_f32_32x32x16_bf16 v[120:135], v[56:59], v[216:219], v[120:135]
ds_read_b128 v[236:239], v245 offset:5376
ds_read_b128 v[192:195], v242 offset:128
ds_read_b128 v[196:199], v242 offset:64
v_lshrrev_b16 v180, 2, v181
v_exp_f16_sdwa v153, v154 dst_sel:WORD_1 dst_unused:UNUSED_PRESERVE src0_sel:WORD_1
v_lshrrev_b32 v181, 18, v181
v_fma_mix_f32 v160, v139, v139, v160 op_sel:[1,1,0] op_sel_hi:[1,1,0]
s_waitcnt lgkmcnt(8)
v_smfmac_f32_16x16x32_bf16 v[8:11], v[222:223], v[200:203], v246
ds_read_b128 v[216:219], v248 offset:58368
ds_read_u16_d16 v180, v180
ds_read_u16_d16_hi v181, v181
v_exp_f16_sdwa v150, v151 dst_sel:WORD_1 dst_unused:UNUSED_PRESERVE src0_sel:WORD_1
v_exp_f16_sdwa v147, v148 dst_sel:WORD_1 dst_unused:UNUSED_PRESERVE src0_sel:WORD_1
v_smfmac_f32_16x16x32_bf16 v[40:43], v[220:221], v[204:207], v246
v_and_b32 v183, s49, v183
v_fma_mix_f32 v160, v140, v140, v160 op_sel:[0,0,0] op_sel_hi:[1,1,0]
v_pk_add_f16 v153, v153, 1.0 op_sel_hi:[1,0]
v_mfma_f32_32x32x16_bf16 v[120:135], v[60:63], v[224:227], v[120:135]
ds_read_b128 v[220:223], v245 offset:4992
ds_read_b128 v[200:203], v242
v_xor_b32 v244, 16, v244
ds_read_b128 v[204:207], v244 offset:128
v_lshrrev_b16 v182, 2, v183
v_pk_add_f16 v150, v150, 1.0 op_sel_hi:[1,0]
v_pk_add_f16 v147, v147, 1.0 op_sel_hi:[1,0]
v_rcp_f16 v154, v153
v_lshrrev_b32 v183, 18, v183
s_waitcnt lgkmcnt(6)
v_smfmac_f32_16x16x32_bf16 v[24:27], v[230:231], v[208:211], v246
ds_read_b128 v[224:227], v245 offset:4608
ds_read_u16_d16 v182, v182
ds_read_u16_d16_hi v183, v183
v_fma_mix_f32 v160, v141, v141, v160 op_sel:[1,1,0] op_sel_hi:[1,1,0]
v_rcp_f16 v151, v150
v_smfmac_f32_16x16x32_bf16 v[8:11], v[228:229], v[212:215], v246
v_and_b32 v185, s49, v185
v_rcp_f16 v148, v147
v_mfma_f32_32x32x16_bf16 v[120:135], v[64:67], v[232:235], v[120:135]
ds_read_b128 v[208:211], v244 offset:64
ds_read_b128 v[212:215], v244
ds_read_b128 v[228:231], v248 offset:59392
v_fma_mix_f32 v160, v142, v142, v160 op_sel:[0,0,0] op_sel_hi:[1,1,0]
v_lshrrev_b16 v184, 2, v185
v_rcp_f16_sdwa v154, v153 dst_sel:WORD_1 dst_unused:UNUSED_PRESERVE src0_sel:WORD_1
v_rcp_f16_sdwa v151, v150 dst_sel:WORD_1 dst_unused:UNUSED_PRESERVE src0_sel:WORD_1
v_smfmac_f32_16x16x32_bf16 v[40:43], v[238:239], v[192:195], v246
ds_read_b128 v[232:235], v248 offset:62464
ds_read_u16_d16 v184, v184
ds_read_b32 v247, v253 offset:28
v_lshrrev_b32 v185, 18, v185
v_fma_mix_f32 v160, v143, v143, v160 op_sel:[1,1,0] op_sel_hi:[1,1,0]
v_smfmac_f32_16x16x32_bf16 v[24:27], v[236:237], v[196:199], v246
v_rcp_f16_sdwa v148, v147 dst_sel:WORD_1 dst_unused:UNUSED_PRESERVE src0_sel:WORD_1
v_and_b32 v187, s49, v187
v_pk_mul_f16 v155, v155, v154
s_waitcnt lgkmcnt(7)
v_mfma_f32_32x32x16_bf16 v[120:135], v[68:71], v[216:219], v[120:135]
ds_read_b128 v[236:239], v248 offset:60416
ds_read_u16_d16_hi v185, v185
v_fma_mix_f32 v160, v176, v176, v160 op_sel:[0,0,0] op_sel_hi:[1,1,0]
v_pk_mul_f16 v152, v152, v151
v_lshrrev_b16 v186, 2, v187
v_pk_mul_f16 v149, v149, v148
v_fma_mix_f32 v161, v155, v155, 0 op_sel:[0,0,0] op_sel_hi:[1,1,0]
v_fma_mix_f32 v161, v155, v155, v161 op_sel:[1,1,0] op_sel_hi:[1,1,0]
v_smfmac_f32_16x16x32_bf16 v[8:11], v[222:223], v[200:203], v246
ds_read_b128 v[216:219], v245 offset:4224
v_xor_b32 v243, 16, v243
ds_read_b128 v[192:195], v243 offset:128
ds_read_b128 v[196:199], v243 offset:64
ds_read_u16_d16 v186, v186
v_lshrrev_b32 v187, 18, v187
v_fma_mix_f32 v160, v177, v177, v160 op_sel:[1,1,0] op_sel_hi:[1,1,0]
v_fma_mix_f32 v161, v152, v152, v161 op_sel:[0,0,0] op_sel_hi:[1,1,0]
v_smfmac_f32_16x16x32_bf16 v[44:47], v[220:221], v[204:207], v246
v_fma_mix_f32 v161, v152, v152, v161 op_sel:[1,1,0] op_sel_hi:[1,1,0]
v_fma_mix_f32 v161, v149, v149, v161 op_sel:[0,0,0] op_sel_hi:[1,1,0]
v_fma_mix_f32 v161, v149, v149, v161 op_sel:[1,1,0] op_sel_hi:[1,1,0]
s_cmp_lg_u32 s40, 7
s_cbranch_scc1 Lnosent
v_mov_b32 v104, -1
v_mov_b32 v105, -1
v_mov_b32 v106, -1
v_mov_b32 v107, -1
v_lshlrev_b32 v100, 12, v251
v_add_u32 v101, 262144, v100
v_cmp_gt_u32 vcc, 32, v251
v_mov_b32 v102, 2147483648
s_nop 0
v_cndmask_b32 v101, v102, v101, vcc
s_lshl_b32 s43, s2, 4
buffer_store_dwordx4 v[104:107], v100, s[32:35], s43 offen sc1
buffer_store_dwordx4 v[104:107], v101, s[32:35], s43 offen sc1
s_add_u32 s43, s43, 393216
s_cmp_lt_u32 s2, 96
s_cselect_b32 s43, s43, 1073741824
v_lshlrev_b32 v102, 11, v251
s_mov_b64 exec, 0xff
buffer_store_dwordx4 v[104:107], v102, s[32:35], s43 offen sc1
s_mov_b64 exec, -1
s_sub_u32 s43, s2, 96
s_cmp_lt_u32 s43, 96
s_cbranch_scc0 Lnobias
s_lshl_b32 s44, s43, 1
v_mul_u32_u24 v100, 192, v251
v_lshlrev_b32 v101, 1, v251
s_add_u32 s45, s44, 0
buffer_load_ushort v102, v100, s[16:19], s45 offen
buffer_load_ushort v108, v101, s[28:31], 0 offen offset:0
s_add_u32 s45, s44, 12288
buffer_load_ushort v103, v100, s[16:19], s45 offen
buffer_load_ushort v109, v101, s[28:31], 0 offen offset:128
s_add_u32 s45, s44, 24576
buffer_load_ushort v104, v100, s[16:19], s45 offen
buffer_load_ushort v110, v101, s[28:31], 0 offen offset:256
s_add_u32 s45, s44, 36864
buffer_load_ushort v105, v100, s[16:19], s45 offen
buffer_load_ushort v111, v101, s[28:31], 0 offen offset:384
s_add_u32 s45, s44, 49152
buffer_load_ushort v106, v100, s[16:19], s45 offen
buffer_load_ushort v112, v101, s[28:31], 0 offen offset:512
s_add_u32 s45, s44, 61440
buffer_load_ushort v107, v100, s[16:19], s45 offen
buffer_load_ushort v113, v101, s[28:31], 0 offen offset:640
Lnobias:
s_nop 1
Lnosent:
ds_read_u16_d16_hi v187, v187
s_waitcnt lgkmcnt(1)
v_readfirstlane_b32 s43, v247
s_nop 1
s_cmp_ge_u32 s43, 12
s_cbranch_scc1 Lev4
Lev4w:
s_sleep 1
ds_read_b32 v247, v253 offset:28
s_waitcnt lgkmcnt(0)
v_readfirstlane_b32 s43, v247
s_cmp_eq_u32 s76, 0
s_cbranch_scc1 Lev4
s_sub_u32 s76, s76, 1
s_cmp_lt_u32 s43, 12
s_cbranch_scc1 Lev4w
Lev4:
s_setprio 1
v_smfmac_f32_16x16x32_bf16 v[28:31], v[226:227], v[208:211], v246
ds_read_b128 v[220:223], v248 offset:63488
v_cvt_pkrtz_f16_f32 v137, v120, v121
v_cvt_pkrtz_f16_f32 v139, v122, v123
v_cvt_pkrtz_f16_f32 v141, v124, v125
v_cvt_pkrtz_f16_f32 v143, v126, v127
v_smfmac_f32_16x16x32_bf16 v[12:15], v[224:225], v[212:215], v246
v_cvt_pk_f16_f32 v155, v128, v129
v_cvt_pk_f16_f32 v152, v130, v131
v_cvt_pk_f16_f32 v149, v132, v133
v_cvt_pk_f16_f32 v146, v134, v135
v_mfma_f32_32x32x16_bf16 v[120:135], v[48:51], v[228:231], 0
ds_read_b128 v[224:227], v248 offset:61440
v_pk_fma_f16 v154, v155, v155, s48
v_and_b32 v137, s49, v137
v_fma_mix_f32 v161, v178, v178, v161 op_sel:[0,0,0] op_sel_hi:[1,1,0]
v_pk_fma_f16 v151, v152, v152, s48
v_pk_fma_f16 v148, v149, v149, s48
v_pk_fma_f16 v145, v146, v146, s48
v_pk_mul_f16 v154, v155, v154
v_lshrrev_b16 v136, 2, v137
v_pk_mul_f16 v151, v152, v151
v_mfma_f32_32x32x16_bf16 v[120:135], v[52:55], v[232:235], v[120:135]
ds_read_b128 v[228:231], v245 offset:3840
ds_read_b128 v[200:203], v243
v_xor_b32 v242, 16, v242
ds_read_b128 v[204:207], v242 offset:128
ds_read_u16_d16 v136, v136
v_fma_mix_f32 v161, v179, v179, v161 op_sel:[1,1,0] op_sel_hi:[1,1,0]
v_pk_mul_f16 v148, v149, v148
v_pk_mul_f16 v145, v146, v145
v_exp_f16 v153, v154
v_lshrrev_b32 v137, 18, v137
v_exp_f16 v150, v151
v_mfma_f32_32x32x16_bf16 v[120:135], v[56:59], v[236:239], v[120:135]
ds_read_b128 v[232:235], v248 offset:64512
ds_read_u16_d16_hi v137, v137
v_fma_mix_f32 v161, v180, v180, v161 op_sel:[0,0,0] op_sel_hi:[1,1,0]
v_exp_f16 v147, v148
v_and_b32 v139, s49, v139
v_exp_f16 v144, v145
v_exp_f16_sdwa v153, v154 dst_sel:WORD_1 dst_unused:UNUSED_PRESERVE src0_sel:WORD_1
v_fma_mix_f32 v161, v181, v181, v161 op_sel:[1,1,0] op_sel_hi:[1,1,0]
v_smfmac_f32_16x16x32_bf16 v[44:47], v[218:219], v[192:195], v246
ds_read_b128 v[236:239], v245 offset:3456
ds_read_b128 v[208:211], v242 offset:64
ds_read_b128 v[212:215], v242
v_lshrrev_b16 v138, 2, v139
v_exp_f16_sdwa v150, v151 dst_sel:WORD_1 dst_unused:UNUSED_PRESERVE src0_sel:WORD_1
v_smfmac_f32_16x16x32_bf16 v[28:31], v[216:217], v[196:199], v246
v_exp_f16_sdwa v147, v148 dst_sel:WORD_1 dst_unused:UNUSED_PRESERVE src0_sel:WORD_1
v_exp_f16_sdwa v144, v145 dst_sel:WORD_1 dst_unused:UNUSED_PRESERVE src0_sel:WORD_1
v_lshrrev_b32 v139, 18, v139
s_waitcnt lgkmcnt(5)
v_mfma_f32_32x32x16_bf16 v[120:135], v[60:63], v[220:223], v[120:135]
ds_read_b128 v[216:219], v245 offset:3072
v_xor_b32 v244, 32, v244
ds_read_b128 v[192:195], v244 offset:128
ds_read_b128 v[196:199], v244 offset:64
ds_read_u16_d16 v138, v138
ds_read_u16_d16_hi v139, v139
v_fma_mix_f32 v161, v182, v182, v161 op_sel:[0,0,0] op_sel_hi:[1,1,0]
v_pk_add_f16 v153, v153, 1.0 op_sel_hi:[1,0]
v_pk_add_f16 v150, v150, 1.0 op_sel_hi:[1,0]
v_pk_add_f16 v147, v147, 1.0 op_sel_hi:[1,0]
v_and_b32 v141, s49, v141
v_pk_add_f16 v144, v144, 1.0 op_sel_hi:[1,0]
v_rcp_f16 v154, v153
v_fma_mix_f32 v161, v183, v183, v161 op_sel:[1,1,0] op_sel_hi:[1,1,0]
v_mfma_f32_32x32x16_bf16 v[120:135], v[64:67], v[224:227], v[120:135]
ds_read_b128 v[220:223], v249
v_rcp_f16 v151, v150
v_lshrrev_b16 v140, 2, v141
v_rcp_f16 v148, v147
v_fma_mix_f32 v161, v184, v184, v161 op_sel:[0,0,0] op_sel_hi:[1,1,0]
v_rcp_f16 v145, v144
v_lshrrev_b32 v141, 18, v141
v_smfmac_f32_16x16x32_bf16 v[12:15], v[230:231], v[200:203], v246
ds_read_b128 v[224:227], v249 offset:3072
ds_read_u16_d16 v140, v140
ds_read_u16_d16_hi v141, v141
v_rcp_f16_sdwa v154, v153 dst_sel:WORD_1 dst_unused:UNUSED_PRESERVE src0_sel:WORD_1
s_setprio 0
v_rcp_f16_sdwa v151, v150 dst_sel:WORD_1 dst_unused:UNUSED_PRESERVE src0_sel:WORD_1
v_smfmac_f32_16x16x32_bf16 v[44:47], v[228:229], v[204:207], v246
v_fma_mix_f32 v161, v185, v185, v161 op_sel:[1,1,0] op_sel_hi:[1,1,0]
v_and_b32 v143, s49, v143
v_rcp_f16_sdwa v148, v147 dst_sel:WORD_1 dst_unused:UNUSED_PRESERVE src0_sel:WORD_1
s_waitcnt lgkmcnt(4)
v_mfma_f32_32x32x16_bf16 v[120:135], v[68:71], v[232:235], v[120:135]
ds_read_b128 v[228:231], v245 offset:2688
ds_read_b128 v[200:203], v244
v_xor_b32 v243, 32, v243
ds_read_b128 v[204:207], v243 offset:128
v_rcp_f16_sdwa v145, v144 dst_sel:WORD_1 dst_unused:UNUSED_PRESERVE src0_sel:WORD_1
v_pk_mul_f16 v155, v155, v154
v_lshrrev_b16 v142, 2, v143
v_fma_mix_f32 v161, v186, v186, v161 op_sel:[0,0,0] op_sel_hi:[1,1,0]
v_pk_mul_f16 v152, v152, v151
v_pk_mul_f16 v149, v149, v148
v_pk_mul_f16 v146, v146, v145
v_fma_mix_f32 v162, v155, v155, 0 op_sel:[0,0,0] op_sel_hi:[1,1,0]
v_smfmac_f32_16x16x32_bf16 v[28:31], v[238:239], v[208:211], v246
ds_read_b128 v[232:235], v249 offset:1024
ds_read_u16_d16 v142, v142
v_lshrrev_b32 v143, 18, v143
v_fma_mix_f32 v162, v155, v155, v162 op_sel:[1,1,0] op_sel_hi:[1,1,0]
v_fma_mix_f32 v162, v152, v152, v162 op_sel:[0,0,0] op_sel_hi:[1,1,0]
v_fma_mix_f32 v161, v187, v187, v161 op_sel:[1,1,0] op_sel_hi:[1,1,0]
v_smfmac_f32_16x16x32_bf16 v[12:15], v[236:237], v[212:215], v246
v_fma_mix_f32 v162, v152, v152, v162 op_sel:[1,1,0] op_sel_hi:[1,1,0]
v_fma_mix_f32 v162, v149, v149, v162 op_sel:[0,0,0] op_sel_hi:[1,1,0]
v_fma_mix_f32 v162, v149, v149, v162 op_sel:[1,1,0] op_sel_hi:[1,1,0]
v_fma_mix_f32 v162, v146, v146, v162 op_sel:[0,0,0] op_sel_hi:[1,1,0]
v_fma_mix_f32 v162, v146, v146, v162 op_sel:[1,1,0] op_sel_hi:[1,1,0]
v_lshlrev_b32 v252, 7, v251
s_add_u32 s46, s47, 1572864
s_mov_b32 exec_lo, 131071
s_mov_b32 exec_hi, 0
s_mov_b32 m0, 16288
s_nop 0
buffer_load_dword v252, s[4:7], s46 offen lds
s_mov_b64 exec, -1
s_setprio 2
v_smfmac_f32_16x16x32_bf16 v[36:39], v[218:219], v[192:195], v246
ds_read_b128 v[236:239], v249 offset:4096
ds_read_u16_d16_hi v143, v143
v_cvt_pkrtz_f16_f32 v179, v120, v121
v_cvt_pkrtz_f16_f32 v181, v122, v123
v_cvt_pkrtz_f16_f32 v183, v124, v125
v_smfmac_f32_16x16x32_bf16 v[20:23], v[216:217], v[196:199], v246
v_cvt_pkrtz_f16_f32 v185, v126, v127
v_cvt_pkrtz_f16_f32 v187, v128, v129
v_cvt_pk_f16_f32 v155, v130, v131
v_cvt_pk_f16_f32 v152, v132, v133
v_cvt_pk_f16_f32 v149, v134, v135
s_waitcnt lgkmcnt(2)
v_mfma_f32_32x32x16_bf16 v[120:135], v[48:51], v[220:223], 0
ds_read_b128 v[216:219], v245 offset:2304
ds_read_b128 v[208:211], v243 offset:64
ds_read_b128 v[212:215], v243
v_pk_fma_f16 v154, v155, v155, s48
v_and_b32 v179, s49, v179
v_fma_mix_f32 v162, v136, v136, v162 op_sel:[0,0,0] op_sel_hi:[1,1,0]
v_pk_fma_f16 v151, v152, v152, s48
v_pk_fma_f16 v148, v149, v149, s48
v_mfma_f32_32x32x16_bf16 v[120:135], v[52:55], v[224:227], v[120:135]
ds_read_b128 v[220:223], v249 offset:2048
v_lshrrev_b16 v178, 2, v179
v_pk_mul_f16 v154, v155, v154
v_pk_mul_f16 v151, v152, v151
v_pk_mul_f16 v148, v149, v148
v_lshrrev_b32 v179, 18, v179
v_fma_mix_f32 v162, v137, v137, v162 op_sel:[1,1,0] op_sel_hi:[1,1,0]
v_smfmac_f32_16x16x32_bf16 v[4:7], v[230:231], v[200:203], v246
ds_read_b128 v[224:227], v245 offset:1920
v_xor_b32 v242, 32, v242
ds_read_b128 v[192:195], v242 offset:128
ds_read_b128 v[196:199], v242 offset:64
ds_read_u16_d16 v178, v178
ds_read_u16_d16_hi v179, v179
v_exp_f16 v153, v154
v_and_b32 v181, s49, v181
v_smfmac_f32_16x16x32_bf16 v[36:39], v[228:229], v[204:207], v246
v_exp_f16 v150, v151
v_exp_f16 v147, v148
v_mfma_f32_32x32x16_bf16 v[120:135], v[56:59], v[232:235], v[120:135]
ds_read_b128 v[228:231], v249 offset:5120
v_lshrrev_b16 v180, 2, v181
v_fma_mix_f32 v162, v138, v138, v162 op_sel:[0,0,0] op_sel_hi:[1,1,0]
v_exp_f16_sdwa v153, v154 dst_sel:WORD_1 dst_unused:UNUSED_PRESERVE src0_sel:WORD_1
v_lshrrev_b32 v181, 18, v181
v_exp_f16_sdwa v150, v151 dst_sel:WORD_1 dst_unused:UNUSED_PRESERVE src0_sel:WORD_1
s_waitcnt lgkmcnt(6)
v_mfma_f32_32x32x16_bf16 v[120:135], v[60:63], v[236:239], v[120:135]
ds_read_b128 v[232:235], v245 offset:1536
ds_read_b128 v[200:203], v242
v_xor_b32 v244, 16, v244
ds_read_b128 v[204:207], v244 offset:128
ds_read_u16_d16 v180, v180
ds_read_u16_d16_hi v181, v181
v_fma_mix_f32 v162, v139, v139, v162 op_sel:[1,1,0] op_sel_hi:[1,1,0]
v_and_b32 v183, s49, v183
v_exp_f16_sdwa v147, v148 dst_sel:WORD_1 dst_unused:UNUSED_PRESERVE src0_sel:WORD_1
v_pk_add_f16 v153, v153, 1.0 op_sel_hi:[1,0]
v_lshrrev_b16 v182, 2, v183
v_smfmac_f32_16x16x32_bf16 v[20:23], v[218:219], v[208:211], v246
ds_read_b128 v[236:239], v245 offset:1152
ds_read_u16_d16 v182, v182
v_pk_add_f16 v150, v150, 1.0 op_sel_hi:[1,0]
v_pk_add_f16 v147, v147, 1.0 op_sel_hi:[1,0]
v_rcp_f16 v154, v153
v_smfmac_f32_16x16x32_bf16 v[4:7], v[216:217], v[212:215], v246
v_lshrrev_b32 v183, 18, v183
v_fma_mix_f32 v162, v140, v140, v162 op_sel:[0,0,0] op_sel_hi:[1,1,0]
v_mfma_f32_32x32x16_bf16 v[120:135], v[64:67], v[220:223], v[120:135]
ds_read_b128 v[208:211], v244 offset:64
ds_read_b128 v[212:215], v244
ds_read_b128 v[216:219], v249 offset:6144
ds_read_u16_d16_hi v183, v183
v_rcp_f16 v151, v150
v_and_b32 v185, s49, v185
v_rcp_f16 v148, v147
v_fma_mix_f32 v162, v141, v141, v162 op_sel:[1,1,0] op_sel_hi:[1,1,0]
v_lshrrev_b16 v184, 2, v185
s_waitcnt lgkmcnt(6)
v_smfmac_f32_16x16x32_bf16 v[36:39], v[226:227], v[192:195], v246
ds_read_b128 v[220:223], v249 offset:9216
ds_read_u16_d16 v184, v184
v_rcp_f16_sdwa v154, v153 dst_sel:WORD_1 dst_unused:UNUSED_PRESERVE src0_sel:WORD_1
v_rcp_f16_sdwa v151, v150 dst_sel:WORD_1 dst_unused:UNUSED_PRESERVE src0_sel:WORD_1
v_smfmac_f32_16x16x32_bf16 v[20:23], v[224:225], v[196:199], v246
v_lshrrev_b32 v185, 18, v185
v_rcp_f16_sdwa v148, v147 dst_sel:WORD_1 dst_unused:UNUSED_PRESERVE src0_sel:WORD_1
v_mfma_f32_32x32x16_bf16 v[120:135], v[68:71], v[228:231], v[120:135]
ds_read_b128 v[224:227], v249 offset:7168
ds_read_u16_d16_hi v185, v185
v_and_b32 v187, s49, v187
v_fma_mix_f32 v162, v142, v142, v162 op_sel:[0,0,0] op_sel_hi:[1,1,0]
v_pk_mul_f16 v155, v155, v154
v_pk_mul_f16 v152, v152, v151
v_lshrrev_b16 v186, 2, v187
v_pk_mul_f16 v149, v149, v148
v_fma_mix_f32 v163, v155, v155, 0 op_sel:[0,0,0] op_sel_hi:[1,1,0]
v_smfmac_f32_16x16x32_bf16 v[4:7], v[234:235], v[200:203], v246
ds_read_b128 v[228:231], v245 offset:768
v_xor_b32 v243, 16, v243
ds_read_b128 v[192:195], v243 offset:128
ds_read_b128 v[196:199], v243 offset:64
ds_read_u16_d16 v186, v186
v_fma_mix_f32 v162, v143, v143, v162 op_sel:[1,1,0] op_sel_hi:[1,1,0]
v_lshrrev_b32 v187, 18, v187
v_fma_mix_f32 v163, v155, v155, v163 op_sel:[1,1,0] op_sel_hi:[1,1,0]
v_smfmac_f32_16x16x32_bf16 v[32:35], v[232:233], v[204:207], v246
v_fma_mix_f32 v163, v152, v152, v163 op_sel:[0,0,0] op_sel_hi:[1,1,0]
v_fma_mix_f32 v163, v152, v152, v163 op_sel:[1,1,0] op_sel_hi:[1,1,0]
v_fma_mix_f32 v163, v149, v149, v163 op_sel:[0,0,0] op_sel_hi:[1,1,0]
v_fma_mix_f32 v163, v149, v149, v163 op_sel:[1,1,0] op_sel_hi:[1,1,0]
v_lshlrev_b32 v252, 7, v251
s_add_u32 s46, s47, 1572864
s_mov_b32 exec_lo, 4294836224
s_mov_b32 exec_hi, 3
s_mov_b32 m0, 16220
s_nop 0
buffer_load_dword v252, s[4:7], s46 offen lds
s_mov_b64 exec, -1
s_setprio 1
s_waitcnt lgkmcnt(4)
v_smfmac_f32_16x16x32_bf16 v[16:19], v[238:239], v[208:211], v246
ds_read_b128 v[232:235], v249 offset:10240
ds_read_u16_d16_hi v187, v187
v_cvt_pkrtz_f16_f32 v137, v120, v121
v_cvt_pkrtz_f16_f32 v139, v122, v123
v_cvt_pkrtz_f16_f32 v141, v124, v125
v_smfmac_f32_16x16x32_bf16 v[0:3], v[236:237], v[212:215], v246
v_cvt_pkrtz_f16_f32 v143, v126, v127
v_cvt_pk_f16_f32 v155, v128, v129
v_cvt_pk_f16_f32 v152, v130, v131
v_cvt_pk_f16_f32 v149, v132, v133
v_cvt_pk_f16_f32 v146, v134, v135
v_mfma_f32_32x32x16_bf16 v[120:135], v[48:51], v[216:219], 0
ds_read_b128 v[236:239], v249 offset:8192
v_pk_fma_f16 v154, v155, v155, s48
v_and_b32 v137, s49, v137
v_fma_mix_f32 v163, v178, v178, v163 op_sel:[0,0,0] op_sel_hi:[1,1,0]
v_pk_fma_f16 v151, v152, v152, s48
v_pk_fma_f16 v148, v149, v149, s48
v_pk_fma_f16 v145, v146, v146, s48
v_pk_mul_f16 v154, v155, v154
v_mfma_f32_32x32x16_bf16 v[120:135], v[52:55], v[220:223], v[120:135]
ds_read_b128 v[216:219], v245 offset:384
ds_read_b128 v[200:203], v243
v_xor_b32 v242, 16, v242
ds_read_b128 v[204:207], v242 offset:128
v_lshrrev_b16 v136, 2, v137
v_pk_mul_f16 v151, v152, v151
v_fma_mix_f32 v163, v179, v179, v163 op_sel:[1,1,0] op_sel_hi:[1,1,0]
v_pk_mul_f16 v148, v149, v148
v_pk_mul_f16 v145, v146, v145
v_exp_f16 v153, v154
v_lshrrev_b32 v137, 18, v137
v_mfma_f32_32x32x16_bf16 v[120:135], v[56:59], v[224:227], v[120:135]
ds_read_b128 v[220:223], v249 offset:11264
ds_read_u16_d16 v136, v136
ds_read_u16_d16_hi v137, v137
v_exp_f16 v150, v151
v_fma_mix_f32 v163, v180, v180, v163 op_sel:[0,0,0] op_sel_hi:[1,1,0]
v_exp_f16 v147, v148
v_and_b32 v139, s49, v139
v_exp_f16 v144, v145
s_waitcnt lgkmcnt(6)
v_smfmac_f32_16x16x32_bf16 v[32:35], v[230:231], v[192:195], v246
ds_read_b128 v[224:227], v245
ds_read_b128 v[208:211], v242 offset:64
ds_read_b128 v[212:215], v242
v_exp_f16_sdwa v153, v154 dst_sel:WORD_1 dst_unused:UNUSED_PRESERVE src0_sel:WORD_1
v_fma_mix_f32 v163, v181, v181, v163 op_sel:[1,1,0] op_sel_hi:[1,1,0]
v_lshrrev_b16 v138, 2, v139
v_smfmac_f32_16x16x32_bf16 v[16:19], v[228:229], v[196:199], v246
v_exp_f16_sdwa v150, v151 dst_sel:WORD_1 dst_unused:UNUSED_PRESERVE src0_sel:WORD_1
v_mfma_f32_32x32x16_bf16 v[120:135], v[60:63], v[232:235], v[120:135]
ds_read_b128 v[228:231], v249 offset:12288
ds_read_u16_d16 v138, v138
v_exp_f16_sdwa v147, v148 dst_sel:WORD_1 dst_unused:UNUSED_PRESERVE src0_sel:WORD_1
v_exp_f16_sdwa v144, v145 dst_sel:WORD_1 dst_unused:UNUSED_PRESERVE src0_sel:WORD_1
v_lshrrev_b32 v139, 18, v139
v_fma_mix_f32 v163, v182, v182, v163 op_sel:[0,0,0] op_sel_hi:[1,1,0]
v_pk_add_f16 v153, v153, 1.0 op_sel_hi:[1,0]
v_pk_add_f16 v150, v150, 1.0 op_sel_hi:[1,0]
v_pk_add_f16 v147, v147, 1.0 op_sel_hi:[1,0]
v_mfma_f32_32x32x16_bf16 v[120:135], v[64:67], v[236:239], v[120:135]
ds_read_b128 v[232:235], v249 offset:15360
ds_read_u16_d16_hi v139, v139
v_and_b32 v141, s49, v141
v_pk_add_f16 v144, v144, 1.0 op_sel_hi:[1,0]
v_rcp_f16 v154, v153
v_fma_mix_f32 v163, v183, v183, v163 op_sel:[1,1,0] op_sel_hi:[1,1,0]
v_rcp_f16 v151, v150
v_lshrrev_b16 v140, 2, v141
s_waitcnt lgkmcnt(4)
v_smfmac_f32_16x16x32_bf16 v[0:3], v[218:219], v[200:203], v246
ds_read_b128 v[236:239], v249 offset:13312
ds_read_u16_d16 v140, v140
v_rcp_f16 v148, v147
v_fma_mix_f32 v163, v184, v184, v163 op_sel:[0,0,0] op_sel_hi:[1,1,0]
v_smfmac_f32_16x16x32_bf16 v[32:35], v[216:217], v[204:207], v246
v_rcp_f16 v145, v144
v_lshrrev_b32 v141, 18, v141
v_rcp_f16_sdwa v154, v153 dst_sel:WORD_1 dst_unused:UNUSED_PRESERVE src0_sel:WORD_1
s_setprio 0
v_mfma_f32_32x32x16_bf16 v[120:135], v[68:71], v[220:223], v[120:135]
ds_read_b128 v[216:219], v249 offset:16384
ds_read_u16_d16_hi v141, v141
v_rcp_f16_sdwa v151, v150 dst_sel:WORD_1 dst_unused:UNUSED_PRESERVE src0_sel:WORD_1
v_fma_mix_f32 v163, v185, v185, v163 op_sel:[1,1,0] op_sel_hi:[1,1,0]
v_and_b32 v143, s49, v143
v_rcp_f16_sdwa v148, v147 dst_sel:WORD_1 dst_unused:UNUSED_PRESERVE src0_sel:WORD_1
v_rcp_f16_sdwa v145, v144 dst_sel:WORD_1 dst_unused:UNUSED_PRESERVE src0_sel:WORD_1
v_smfmac_f32_16x16x32_bf16 v[16:19], v[226:227], v[208:211], v246
ds_read_b128 v[220:223], v249 offset:14336
v_pk_mul_f16 v155, v155, v154
v_lshrrev_b16 v142, 2, v143
v_fma_mix_f32 v163, v186, v186, v163 op_sel:[0,0,0] op_sel_hi:[1,1,0]
v_pk_mul_f16 v152, v152, v151
v_smfmac_f32_16x16x32_bf16 v[0:3], v[224:225], v[212:215], v246
s_mov_b64 exec, 1
ds_add_u32 v253, v254 offset:16
s_mov_b64 exec, -1
v_pk_mul_f16 v149, v149, v148
v_pk_mul_f16 v146, v146, v145
v_fma_mix_f32 v164, v155, v155, 0 op_sel:[0,0,0] op_sel_hi:[1,1,0]
v_lshrrev_b32 v143, 18, v143
v_fma_mix_f32 v164, v155, v155, v164 op_sel:[1,1,0] op_sel_hi:[1,1,0]
v_fma_mix_f32 v164, v152, v152, v164 op_sel:[0,0,0] op_sel_hi:[1,1,0]
v_fma_mix_f32 v163, v187, v187, v163 op_sel:[1,1,0] op_sel_hi:[1,1,0]
v_fma_mix_f32 v164, v152, v152, v164 op_sel:[1,1,0] op_sel_hi:[1,1,0]
v_fma_mix_f32 v164, v149, v149, v164 op_sel:[0,0,0] op_sel_hi:[1,1,0]
v_fma_mix_f32 v164, v149, v149, v164 op_sel:[1,1,0] op_sel_hi:[1,1,0]
v_fma_mix_f32 v164, v146, v146, v164 op_sel:[0,0,0] op_sel_hi:[1,1,0]
v_fma_mix_f32 v164, v146, v146, v164 op_sel:[1,1,0] op_sel_hi:[1,1,0]
s_setprio 3
v_pk_add_f32 v[168:169], v[0:1], v[2:3]
v_pk_mul_f32 v[170:171], v[0:1], v[0:1]
v_pk_fma_f32 v[170:171], v[2:3], v[2:3], v[170:171]
v_pk_add_f32 v[168:169], v[168:169], v[4:5]
v_pk_fma_f32 v[170:171], v[4:5], v[4:5], v[170:171]
v_pk_add_f32 v[168:169], v[168:169], v[6:7]
v_pk_fma_f32 v[170:171], v[6:7], v[6:7], v[170:171]
v_pk_add_f32 v[168:169], v[168:169], v[8:9]
v_pk_fma_f32 v[170:171], v[8:9], v[8:9], v[170:171]
v_pk_add_f32 v[168:169], v[168:169], v[10:11]
v_pk_fma_f32 v[170:171], v[10:11], v[10:11], v[170:171]
v_pk_add_f32 v[168:169], v[168:169], v[12:13]
v_pk_fma_f32 v[170:171], v[12:13], v[12:13], v[170:171]
v_pk_add_f32 v[168:169], v[168:169], v[14:15]
v_pk_fma_f32 v[170:171], v[14:15], v[14:15], v[170:171]
v_pk_add_f32 v[168:169], v[168:169], v[16:17]
v_pk_fma_f32 v[170:171], v[16:17], v[16:17], v[170:171]
v_pk_add_f32 v[168:169], v[168:169], v[18:19]
v_pk_fma_f32 v[170:171], v[18:19], v[18:19], v[170:171]
v_pk_add_f32 v[168:169], v[168:169], v[20:21]
v_pk_fma_f32 v[170:171], v[20:21], v[20:21], v[170:171]
v_pk_add_f32 v[168:169], v[168:169], v[22:23]
v_pk_fma_f32 v[170:171], v[22:23], v[22:23], v[170:171]
v_pk_add_f32 v[168:169], v[168:169], v[24:25]
v_pk_fma_f32 v[170:171], v[24:25], v[24:25], v[170:171]
v_pk_add_f32 v[168:169], v[168:169], v[26:27]
v_pk_fma_f32 v[170:171], v[26:27], v[26:27], v[170:171]
v_pk_add_f32 v[168:169], v[168:169], v[28:29]
v_pk_fma_f32 v[170:171], v[28:29], v[28:29], v[170:171]
v_pk_add_f32 v[168:169], v[168:169], v[30:31]
v_pk_fma_f32 v[170:171], v[30:31], v[30:31], v[170:171]
v_pk_add_f32 v[168:169], v[168:169], v[32:33]
v_pk_fma_f32 v[170:171], v[32:33], v[32:33], v[170:171]
v_pk_add_f32 v[168:169], v[168:169], v[34:35]
v_pk_fma_f32 v[170:171], v[34:35], v[34:35], v[170:171]
v_pk_add_f32 v[168:169], v[168:169], v[36:37]
v_pk_fma_f32 v[170:171], v[36:37], v[36:37], v[170:171]
v_pk_add_f32 v[168:169], v[168:169], v[38:39]
v_pk_fma_f32 v[170:171], v[38:39], v[38:39], v[170:171]
v_pk_add_f32 v[168:169], v[168:169], v[40:41]
v_pk_fma_f32 v[170:171], v[40:41], v[40:41], v[170:171]
v_pk_add_f32 v[168:169], v[168:169], v[42:43]
v_pk_fma_f32 v[170:171], v[42:43], v[42:43], v[170:171]
v_pk_add_f32 v[168:169], v[168:169], v[44:45]
v_pk_fma_f32 v[170:171], v[44:45], v[44:45], v[170:171]
v_pk_add_f32 v[168:169], v[168:169], v[46:47]
v_pk_fma_f32 v[170:171], v[46:47], v[46:47], v[170:171]
s_setprio 0
v_add_u32 v174, -36864, v242
v_subrev_u32 v175, 66560, v174
v_min_u32 v174, v174, v175
v_add_u32 v174, 90112, v174
v_sub_u32 v175, v174, v242
v_add_u32 v242, v175, v242
v_add_u32 v243, v175, v243
v_add_u32 v244, v175, v244
v_lshlrev_b32 v252, 7, v251
s_add_u32 s46, s47, 1572864
s_mov_b32 exec_lo, 0
s_mov_b32 exec_hi, 1048572
s_mov_b32 m0, 16152
s_nop 0
buffer_load_dword v252, s[4:7], s46 offen lds
s_mov_b64 exec, -1
s_setprio 2
v_cvt_pkrtz_f16_f32 v179, v120, v121
v_cvt_pkrtz_f16_f32 v181, v122, v123
v_cvt_pkrtz_f16_f32 v183, v124, v125
v_cvt_pkrtz_f16_f32 v185, v126, v127
v_cvt_pkrtz_f16_f32 v187, v128, v129
v_cvt_pkrtz_f16_f32 v189, v130, v131
v_cvt_pk_f16_f32 v155, v132, v133
v_cvt_pk_f16_f32 v152, v134, v135
s_waitcnt lgkmcnt(1)
ds_read_b128 v[224:227], v249 offset:17408
ds_read_u16_d16 v142, v142
ds_read_u16_d16_hi v143, v143
v_mfma_f32_32x32x16_bf16 v[120:135], v[48:51], v[228:231], 0
v_pk_fma_f16 v154, v155, v155, s48
v_add_f32 v168, v168, v169
v_and_b32 v179, s49, v179
v_fma_mix_f32 v164, v136, v136, v164 op_sel:[0,0,0] op_sel_hi:[1,1,0]
v_lshrrev_b16 v178, 2, v179
v_add_f32 v170, v170, v171
v_pk_fma_f16 v151, v152, v152, s48
v_pk_mul_f16 v154, v155, v154
v_lshrrev_b32 v179, 18, v179
v_pk_mul_f16 v151, v152, v151
ds_read_b128 v[228:231], v249 offset:18432
ds_read_u16_d16 v178, v178
ds_read_u16_d16_hi v179, v179
v_mfma_f32_32x32x16_bf16 v[120:135], v[52:55], v[232:235], v[120:135]
v_permlane32_swap_b32 v168, v170
v_fma_mix_f32 v164, v137, v137, v164 op_sel:[1,1,0] op_sel_hi:[1,1,0]
v_and_b32 v181, s49, v181
v_exp_f16 v153, v154
v_add_f32 v168, v168, v170
v_lshrrev_b16 v180, 2, v181
v_exp_f16 v150, v151
v_lshrrev_b32 v181, 18, v181
ds_read_b128 v[232:235], v249 offset:21504
ds_read_u16_d16 v180, v180
ds_read_u16_d16_hi v181, v181
v_mfma_f32_32x32x16_bf16 v[120:135], v[56:59], v[236:239], v[120:135]
v_mul_f32 v168, 1009429163, v168
v_fma_mix_f32 v164, v138, v138, v164 op_sel:[0,0,0] op_sel_hi:[1,1,0]
v_exp_f16_sdwa v153, v154 dst_sel:WORD_1 dst_unused:UNUSED_PRESERVE src0_sel:WORD_1
v_and_b32 v183, s49, v183
v_mov_b32 v170, v168
v_exp_f16_sdwa v150, v151 dst_sel:WORD_1 dst_unused:UNUSED_PRESERVE src0_sel:WORD_1
v_lshrrev_b16 v182, 2, v183
v_fma_mix_f32 v164, v139, v139, v164 op_sel:[1,1,0] op_sel_hi:[1,1,0]
v_permlane32_swap_b32 v168, v170
ds_read_b128 v[236:239], v249 offset:19456
ds_read_u16_d16 v182, v182
v_mfma_f32_32x32x16_bf16 v[120:135], v[60:63], v[216:219], v[120:135]
v_lshrrev_b32 v183, 18, v183
v_pk_add_f16 v153, v153, 1.0 op_sel_hi:[1,0]
v_pk_add_f16 v150, v150, 1.0 op_sel_hi:[1,0]
v_and_b32 v185, s49, v185
v_fma_f32 v170, -v168, v168, v170
v_rcp_f16 v154, v153
v_lshrrev_b16 v184, 2, v185
v_max_f32 v170, 0, v170
v_fma_mix_f32 v164, v140, v140, v164 op_sel:[0,0,0] op_sel_hi:[1,1,0]
ds_read_b128 v[216:219], v249 offset:22528
ds_read_u16_d16_hi v183, v183
ds_read_u16_d16 v184, v184
v_mfma_f32_32x32x16_bf16 v[120:135], v[64:67], v[220:223], v[120:135]
v_lshrrev_b32 v185, 18, v185
v_rcp_f16 v151, v150
v_add_f32 v170, 925353388, v170
v_and_b32 v187, s49, v187
v_fma_mix_f32 v164, v141, v141, v164 op_sel:[1,1,0] op_sel_hi:[1,1,0]
v_rcp_f16_sdwa v154, v153 dst_sel:WORD_1 dst_unused:UNUSED_PRESERVE src0_sel:WORD_1
v_rsq_f32 v170, v170
s_waitcnt lgkmcnt(5)
ds_read_b128 v[220:223], v249 offset:20480
ds_read_u16_d16_hi v185, v185
ds_read_b32 v247, v253 offset:16
v_mfma_f32_32x32x16_bf16 v[120:135], v[68:71], v[224:227], v[120:135]
v_lshrrev_b16 v186, 2, v187
v_rcp_f16_sdwa v151, v150 dst_sel:WORD_1 dst_unused:UNUSED_PRESERVE src0_sel:WORD_1
v_lshrrev_b32 v187, 18, v187
v_fma_mix_f32 v164, v142, v142, v164 op_sel:[0,0,0] op_sel_hi:[1,1,0]
v_and_b32 v189, s49, v189
v_pk_mul_f16 v155, v155, v154
v_pk_mul_f16 v152, v152, v151
v_mul_f32 v172, 3203391086, v170
v_lshrrev_b16 v188, 2, v189
v_fma_mix_f32 v165, v155, v155, 0 op_sel:[0,0,0] op_sel_hi:[1,1,0]
v_fma_mix_f32 v164, v143, v143, v164 op_sel:[1,1,0] op_sel_hi:[1,1,0]
v_lshrrev_b32 v189, 18, v189
v_mul_f32 v173, v168, v172
v_fma_mix_f32 v165, v155, v155, v165 op_sel:[1,1,0] op_sel_hi:[1,1,0]
v_fma_mix_f32 v165, v152, v152, v165 op_sel:[0,0,0] op_sel_hi:[1,1,0]
v_fma_mix_f32 v165, v152, v152, v165 op_sel:[1,1,0] op_sel_hi:[1,1,0]
s_setprio 3
v_pk_fma_f32 v[0:1], v[0:1], v[172:173], v[172:173] op_sel:[0,0,1] op_sel_hi:[1,0,1] neg_lo:[0,0,1] neg_hi:[0,0,1]
v_pk_fma_f32 v[2:3], v[2:3], v[172:173], v[172:173] op_sel:[0,0,1] op_sel_hi:[1,0,1] neg_lo:[0,0,1] neg_hi:[0,0,1]
v_pk_fma_f32 v[4:5], v[4:5], v[172:173], v[172:173] op_sel:[0,0,1] op_sel_hi:[1,0,1] neg_lo:[0,0,1] neg_hi:[0,0,1]
v_pk_fma_f32 v[6:7], v[6:7], v[172:173], v[172:173] op_sel:[0,0,1] op_sel_hi:[1,0,1] neg_lo:[0,0,1] neg_hi:[0,0,1]
v_pk_fma_f32 v[8:9], v[8:9], v[172:173], v[172:173] op_sel:[0,0,1] op_sel_hi:[1,0,1] neg_lo:[0,0,1] neg_hi:[0,0,1]
v_pk_fma_f32 v[10:11], v[10:11], v[172:173], v[172:173] op_sel:[0,0,1] op_sel_hi:[1,0,1] neg_lo:[0,0,1] neg_hi:[0,0,1]
v_pk_fma_f32 v[12:13], v[12:13], v[172:173], v[172:173] op_sel:[0,0,1] op_sel_hi:[1,0,1] neg_lo:[0,0,1] neg_hi:[0,0,1]
v_pk_fma_f32 v[14:15], v[14:15], v[172:173], v[172:173] op_sel:[0,0,1] op_sel_hi:[1,0,1] neg_lo:[0,0,1] neg_hi:[0,0,1]
v_pk_fma_f32 v[16:17], v[16:17], v[172:173], v[172:173] op_sel:[0,0,1] op_sel_hi:[1,0,1] neg_lo:[0,0,1] neg_hi:[0,0,1]
v_pk_fma_f32 v[18:19], v[18:19], v[172:173], v[172:173] op_sel:[0,0,1] op_sel_hi:[1,0,1] neg_lo:[0,0,1] neg_hi:[0,0,1]
v_pk_fma_f32 v[20:21], v[20:21], v[172:173], v[172:173] op_sel:[0,0,1] op_sel_hi:[1,0,1] neg_lo:[0,0,1] neg_hi:[0,0,1]
v_pk_fma_f32 v[22:23], v[22:23], v[172:173], v[172:173] op_sel:[0,0,1] op_sel_hi:[1,0,1] neg_lo:[0,0,1] neg_hi:[0,0,1]
v_pk_fma_f32 v[24:25], v[24:25], v[172:173], v[172:173] op_sel:[0,0,1] op_sel_hi:[1,0,1] neg_lo:[0,0,1] neg_hi:[0,0,1]
v_pk_fma_f32 v[26:27], v[26:27], v[172:173], v[172:173] op_sel:[0,0,1] op_sel_hi:[1,0,1] neg_lo:[0,0,1] neg_hi:[0,0,1]
v_pk_fma_f32 v[28:29], v[28:29], v[172:173], v[172:173] op_sel:[0,0,1] op_sel_hi:[1,0,1] neg_lo:[0,0,1] neg_hi:[0,0,1]
v_pk_fma_f32 v[30:31], v[30:31], v[172:173], v[172:173] op_sel:[0,0,1] op_sel_hi:[1,0,1] neg_lo:[0,0,1] neg_hi:[0,0,1]
v_pk_fma_f32 v[32:33], v[32:33], v[172:173], v[172:173] op_sel:[0,0,1] op_sel_hi:[1,0,1] neg_lo:[0,0,1] neg_hi:[0,0,1]
v_pk_fma_f32 v[34:35], v[34:35], v[172:173], v[172:173] op_sel:[0,0,1] op_sel_hi:[1,0,1] neg_lo:[0,0,1] neg_hi:[0,0,1]
v_pk_fma_f32 v[36:37], v[36:37], v[172:173], v[172:173] op_sel:[0,0,1] op_sel_hi:[1,0,1] neg_lo:[0,0,1] neg_hi:[0,0,1]
v_pk_fma_f32 v[38:39], v[38:39], v[172:173], v[172:173] op_sel:[0,0,1] op_sel_hi:[1,0,1] neg_lo:[0,0,1] neg_hi:[0,0,1]
v_pk_fma_f32 v[40:41], v[40:41], v[172:173], v[172:173] op_sel:[0,0,1] op_sel_hi:[1,0,1] neg_lo:[0,0,1] neg_hi:[0,0,1]
v_pk_fma_f32 v[42:43], v[42:43], v[172:173], v[172:173] op_sel:[0,0,1] op_sel_hi:[1,0,1] neg_lo:[0,0,1] neg_hi:[0,0,1]
v_pk_fma_f32 v[44:45], v[44:45], v[172:173], v[172:173] op_sel:[0,0,1] op_sel_hi:[1,0,1] neg_lo:[0,0,1] neg_hi:[0,0,1]
v_pk_fma_f32 v[46:47], v[46:47], v[172:173], v[172:173] op_sel:[0,0,1] op_sel_hi:[1,0,1] neg_lo:[0,0,1] neg_hi:[0,0,1]
s_setprio 2
ds_read_u16_d16 v186, v186
ds_read_u16_d16_hi v187, v187
ds_read_u16_d16 v188, v188
ds_read_u16_d16_hi v189, v189
s_waitcnt lgkmcnt(4)
v_readfirstlane_b32 s43, v247
s_nop 1
s_cmp_ge_u32 s43, 16
s_cbranch_scc1 Lev5
Lev5w:
s_sleep 1
ds_read_b32 v247, v253 offset:16
s_waitcnt lgkmcnt(0)
v_readfirstlane_b32 s43, v247
s_cmp_eq_u32 s76, 0
s_cbranch_scc1 Lev5
s_sub_u32 s76, s76, 1
s_cmp_lt_u32 s43, 16
s_cbranch_scc1 Lev5w
Lev5:
s_setprio 1
v_cvt_pkrtz_f16_f32 v137, v120, v121
v_cvt_pkrtz_f16_f32 v139, v122, v123
v_cvt_pkrtz_f16_f32 v141, v124, v125
v_cvt_pkrtz_f16_f32 v143, v126, v127
v_cvt_pkrtz_f16_f32 v177, v128, v129
v_cvt_pkrtz_f16_f32 v191, v130, v131
v_cvt_pk_f16_f32 v155, v132, v133
v_cvt_pk_f16_f32 v152, v134, v135
s_add_u32 m0, s67, 53248
s_add_u32 s66, s66, 98304
buffer_load_dwordx4 v240, s[4:7], s66 offen lds
ds_read_b128 v[224:227], v249 offset:23552
v_mfma_f32_32x32x16_bf16 v[120:135], v[48:51], v[228:231], 0
v_pk_fma_f16 v154, v155, v155, s48
v_cvt_pk_bf16_f32 v72, v0, v1
v_and_b32 v137, s49, v137
v_fma_mix_f32 v165, v178, v178, v165 op_sel:[0,0,0] op_sel_hi:[1,1,0]
v_cvt_pk_bf16_f32 v73, v2, v3
v_pk_fma_f16 v151, v152, v152, s48
v_lshrrev_b16 v136, 2, v137
v_cvt_pk_bf16_f32 v74, v4, v5
v_pk_mul_f16 v154, v155, v154
v_fma_mix_f32 v165, v179, v179, v165 op_sel:[1,1,0] op_sel_hi:[1,1,0]
v_lshrrev_b32 v137, 18, v137
v_cvt_pk_bf16_f32 v75, v6, v7
s_add_u32 m0, s67, 59904
s_add_u32 s66, s66, 98304
buffer_load_dwordx4 v240, s[4:7], s66 offen lds
ds_read_b128 v[228:231], v248 offset:16384
ds_read_u16_d16 v136, v136
ds_read_u16_d16_hi v137, v137
v_mfma_f32_32x32x16_bf16 v[120:135], v[52:55], v[232:235], v[120:135]
v_pk_mul_f16 v151, v152, v151
v_exp_f16 v153, v154
v_cvt_pk_bf16_f32 v76, v8, v9
v_and_b32 v139, s49, v139
v_fma_mix_f32 v165, v180, v180, v165 op_sel:[0,0,0] op_sel_hi:[1,1,0]
v_cvt_pk_bf16_f32 v77, v10, v11
v_lshrrev_b16 v138, 2, v139
v_exp_f16 v150, v151
v_cvt_pk_bf16_f32 v78, v12, v13
v_lshrrev_b32 v139, 18, v139
v_cvt_pk_bf16_f32 v79, v14, v15
s_add_u32 m0, s67, 0
s_add_u32 s66, s66, 98304
buffer_load_dwordx4 v240, s[4:7], s66 offen lds
ds_read_b128 v[232:235], v248 offset:19456
ds_read_u16_d16 v138, v138
ds_read_u16_d16_hi v139, v139
v_mfma_f32_32x32x16_bf16 v[120:135], v[56:59], v[236:239], v[120:135]
v_fma_mix_f32 v165, v181, v181, v165 op_sel:[1,1,0] op_sel_hi:[1,1,0]
v_exp_f16_sdwa v153, v154 dst_sel:WORD_1 dst_unused:UNUSED_PRESERVE src0_sel:WORD_1
v_cvt_pk_bf16_f32 v80, v16, v17
v_and_b32 v141, s49, v141
v_fma_mix_f32 v165, v182, v182, v165 op_sel:[0,0,0] op_sel_hi:[1,1,0]
v_cvt_pk_bf16_f32 v81, v18, v19
v_lshrrev_b16 v140, 2, v141
v_exp_f16_sdwa v150, v151 dst_sel:WORD_1 dst_unused:UNUSED_PRESERVE src0_sel:WORD_1
v_cvt_pk_bf16_f32 v82, v20, v21
v_lshrrev_b32 v141, 18, v141
s_add_u32 m0, s67, 6656
s_add_u32 s66, s66, 98304
buffer_load_dwordx4 v240, s[4:7], s66 offen lds
s_add_u32 m0, s67, 13312
s_add_u32 s66, s66, 98304
buffer_load_dwordx4 v240, s[4:7], s66 offen lds
ds_read_b128 v[236:239], v248 offset:17408
ds_read_u16_d16 v140, v140
ds_read_u16_d16_hi v141, v141
v_mfma_f32_32x32x16_bf16 v[120:135], v[60:63], v[216:219], v[120:135]
v_fma_mix_f32 v165, v183, v183, v165 op_sel:[1,1,0] op_sel_hi:[1,1,0]
v_cvt_pk_bf16_f32 v83, v22, v23
v_pk_add_f16 v153, v153, 1.0 op_sel_hi:[1,0]
v_pk_add_f16 v150, v150, 1.0 op_sel_hi:[1,0]
v_and_b32 v143, s49, v143
v_cvt_pk_bf16_f32 v84, v24, v25
v_rcp_f16 v154, v153
v_cvt_pk_bf16_f32 v85, v26, v27
v_lshrrev_b16 v142, 2, v143
v_fma_mix_f32 v165, v184, v184, v165 op_sel:[0,0,0] op_sel_hi:[1,1,0]
v_cvt_pk_bf16_f32 v86, v28, v29
s_add_u32 m0, s67, 19968
s_add_u32 s66, s66, 98304
buffer_load_dwordx4 v240, s[4:7], s66 offen lds
ds_read_b128 v[216:219], v248 offset:20480
ds_read_u16_d16 v142, v142
v_mfma_f32_32x32x16_bf16 v[120:135], v[64:67], v[220:223], v[120:135]
v_rcp_f16 v151, v150
v_lshrrev_b32 v143, 18, v143
v_cvt_pk_bf16_f32 v87, v30, v31
v_fma_mix_f32 v165, v185, v185, v165 op_sel:[1,1,0] op_sel_hi:[1,1,0]
v_and_b32 v177, s49, v177
s_setprio 0
v_cvt_pk_bf16_f32 v88, v32, v33
v_rcp_f16_sdwa v154, v153 dst_sel:WORD_1 dst_unused:UNUSED_PRESERVE src0_sel:WORD_1
v_lshrrev_b16 v176, 2, v177
v_cvt_pk_bf16_f32 v89, v34, v35
s_waitcnt lgkmcnt(2)
v_fma_mix_f32 v165, v186, v186, v165 op_sel:[0,0,0] op_sel_hi:[1,1,0]
v_rcp_f16_sdwa v151, v150 dst_sel:WORD_1 dst_unused:UNUSED_PRESERVE src0_sel:WORD_1
s_add_u32 m0, s67, 26624
s_add_u32 s66, s66, 98304
buffer_load_dwordx4 v240, s[4:7], s66 offen lds
ds_read_b128 v[220:223], v248 offset:18432
ds_read_u16_d16_hi v143, v143
ds_read_u16_d16 v176, v176
v_mfma_f32_32x32x16_bf16 v[120:135], v[68:71], v[224:227], v[120:135]
v_cvt_pk_bf16_f32 v90, v36, v37
v_lshrrev_b32 v177, 18, v177
v_cvt_pk_bf16_f32 v91, v38, v39
v_fma_mix_f32 v165, v187, v187, v165 op_sel:[1,1,0] op_sel_hi:[1,1,0]
v_and_b32 v191, s49, v191
v_pk_mul_f16 v155, v155, v154
v_cvt_pk_bf16_f32 v92, v40, v41
v_pk_mul_f16 v152, v152, v151
v_lshrrev_b16 v190, 2, v191
v_cvt_pk_bf16_f32 v93, v42, v43
v_fma_mix_f32 v165, v188, v188, v165 op_sel:[0,0,0] op_sel_hi:[1,1,0]
v_fma_mix_f32 v166, v155, v155, 0 op_sel:[0,0,0] op_sel_hi:[1,1,0]
s_add_u32 m0, s67, 33280
s_add_u32 s66, s66, 98304
buffer_load_dwordx4 v240, s[4:7], s66 offen lds
v_lshrrev_b32 v191, 18, v191
v_cvt_pk_bf16_f32 v94, v44, v45
v_fma_mix_f32 v166, v155, v155, v166 op_sel:[1,1,0] op_sel_hi:[1,1,0]
v_fma_mix_f32 v165, v189, v189, v165 op_sel:[1,1,0] op_sel_hi:[1,1,0]
v_cvt_pk_bf16_f32 v95, v46, v47
v_fma_mix_f32 v166, v152, v152, v166 op_sel:[0,0,0] op_sel_hi:[1,1,0]
v_fma_mix_f32 v166, v152, v152, v166 op_sel:[1,1,0] op_sel_hi:[1,1,0]
s_setprio 2
v_cvt_pkrtz_f16_f32 v179, v120, v121
v_cvt_pkrtz_f16_f32 v181, v122, v123
v_cvt_pkrtz_f16_f32 v183, v124, v125
v_cvt_pkrtz_f16_f32 v185, v126, v127
v_cvt_pkrtz_f16_f32 v187, v128, v129
v_cvt_pk_f16_f32 v155, v130, v131
v_cvt_pk_f16_f32 v152, v132, v133
v_cvt_pk_f16_f32 v149, v134, v135
ds_read_b128 v[224:227], v248 offset:21504
ds_read_u16_d16_hi v177, v177
ds_read_u16_d16 v190, v190
ds_read_u16_d16_hi v191, v191
v_mfma_f32_32x32x16_bf16 v[120:135], v[72:75], v[228:231], 0
v_pk_fma_f16 v154, v155, v155, s48
v_and_b32 v179, s49, v179
v_fma_mix_f32 v166, v136, v136, v166 op_sel:[0,0,0] op_sel_hi:[1,1,0]
v_pk_fma_f16 v151, v152, v152, s48
v_pk_fma_f16 v148, v149, v149, s48
v_lshrrev_b16 v178, 2, v179
v_pk_mul_f16 v154, v155, v154
v_fma_mix_f32 v166, v137, v137, v166 op_sel:[1,1,0] op_sel_hi:[1,1,0]
v_pk_mul_f16 v151, v152, v151
v_lshrrev_b32 v179, 18, v179
ds_read_b128 v[228:231], v248 offset:22528
ds_read_u16_d16 v178, v178
ds_read_u16_d16_hi v179, v179
v_mfma_f32_32x32x16_bf16 v[120:135], v[76:79], v[232:235], v[120:135]
v_pk_mul_f16 v148, v149, v148
v_exp_f16 v153, v154
v_fma_mix_f32 v166, v138, v138, v166 op_sel:[0,0,0] op_sel_hi:[1,1,0]
v_and_b32 v181, s49, v181
v_exp_f16 v150, v151
v_exp_f16 v147, v148
v_lshrrev_b16 v180, 2, v181
v_fma_mix_f32 v166, v139, v139, v166 op_sel:[1,1,0] op_sel_hi:[1,1,0]
ds_read_b128 v[232:235], v248 offset:25600
ds_read_u16_d16 v180, v180
v_mfma_f32_32x32x16_bf16 v[120:135], v[80:83], v[236:239], v[120:135]
v_exp_f16_sdwa v153, v154 dst_sel:WORD_1 dst_unused:UNUSED_PRESERVE src0_sel:WORD_1
v_lshrrev_b32 v181, 18, v181
v_exp_f16_sdwa v150, v151 dst_sel:WORD_1 dst_unused:UNUSED_PRESERVE src0_sel:WORD_1
v_fma_mix_f32 v166, v140, v140, v166 op_sel:[0,0,0] op_sel_hi:[1,1,0]
v_and_b32 v183, s49, v183
v_exp_f16_sdwa v147, v148 dst_sel:WORD_1 dst_unused:UNUSED_PRESERVE src0_sel:WORD_1
v_fma_mix_f32 v166, v141, v141, v166 op_sel:[1,1,0] op_sel_hi:[1,1,0]
s_waitcnt lgkmcnt(5)
ds_read_b128 v[236:239], v248 offset:23552
ds_read_u16_d16_hi v181, v181
v_mfma_f32_32x32x16_bf16 v[120:135], v[84:87], v[216:219], v[120:135]
v_pk_add_f16 v153, v153, 1.0 op_sel_hi:[1,0]
v_lshrrev_b16 v182, 2, v183
v_pk_add_f16 v150, v150, 1.0 op_sel_hi:[1,0]
v_pk_add_f16 v147, v147, 1.0 op_sel_hi:[1,0]
v_rcp_f16 v154, v153
v_lshrrev_b32 v183, 18, v183
v_fma_mix_f32 v166, v142, v142, v166 op_sel:[0,0,0] op_sel_hi:[1,1,0]
v_rcp_f16 v151, v150
v_and_b32 v185, s49, v185
ds_read_b128 v[216:219], v248 offset:26624
ds_read_u16_d16 v182, v182
ds_read_u16_d16_hi v183, v183
v_mfma_f32_32x32x16_bf16 v[120:135], v[88:91], v[220:223], v[120:135]
v_fma_mix_f32 v166, v143, v143, v166 op_sel:[1,1,0] op_sel_hi:[1,1,0]
v_rcp_f16 v148, v147
v_lshrrev_b16 v184, 2, v185
v_rcp_f16_sdwa v154, v153 dst_sel:WORD_1 dst_unused:UNUSED_PRESERVE src0_sel:WORD_1
v_fma_mix_f32 v166, v176, v176, v166 op_sel:[0,0,0] op_sel_hi:[1,1,0]
v_rcp_f16_sdwa v151, v150 dst_sel:WORD_1 dst_unused:UNUSED_PRESERVE src0_sel:WORD_1
v_lshrrev_b32 v185, 18, v185
ds_read_b128 v[220:223], v248 offset:24576
ds_read_u16_d16 v184, v184
ds_read_u16_d16_hi v185, v185
v_mfma_f32_32x32x16_bf16 v[120:135], v[92:95], v[224:227], v[120:135]
v_rcp_f16_sdwa v148, v147 dst_sel:WORD_1 dst_unused:UNUSED_PRESERVE src0_sel:WORD_1
s_cmp_eq_u32 s40, 7
s_cbranch_scc1 Lrdy16
s_waitcnt vmcnt(0)
Lrdy16:
s_mov_b64 exec, 1
ds_add_u32 v253, v254 offset:12
s_mov_b64 exec, -1
v_and_b32 v187, s49, v187
v_fma_mix_f32 v166, v177, v177, v166 op_sel:[1,1,0] op_sel_hi:[1,1,0]
v_pk_mul_f16 v155, v155, v154
v_pk_mul_f16 v152, v152, v151
v_pk_mul_f16 v149, v149, v148
v_lshrrev_b16 v186, 2, v187
v_fma_mix_f32 v166, v190, v190, v166 op_sel:[0,0,0] op_sel_hi:[1,1,0]
v_fma_mix_f32 v167, v155, v155, 0 op_sel:[0,0,0] op_sel_hi:[1,1,0]
v_fma_mix_f32 v167, v155, v155, v167 op_sel:[1,1,0] op_sel_hi:[1,1,0]
v_lshrrev_b32 v187, 18, v187
v_fma_mix_f32 v167, v152, v152, v167 op_sel:[0,0,0] op_sel_hi:[1,1,0]
v_fma_mix_f32 v166, v191, v191, v166 op_sel:[1,1,0] op_sel_hi:[1,1,0]
v_fma_mix_f32 v167, v152, v152, v167 op_sel:[1,1,0] op_sel_hi:[1,1,0]
v_fma_mix_f32 v167, v149, v149, v167 op_sel:[0,0,0] op_sel_hi:[1,1,0]
v_fma_mix_f32 v167, v149, v149, v167 op_sel:[1,1,0] op_sel_hi:[1,1,0]
s_setprio 1
v_cvt_pkrtz_f16_f32 v137, v120, v121
v_cvt_pkrtz_f16_f32 v139, v122, v123
v_cvt_pkrtz_f16_f32 v141, v124, v125
v_cvt_pkrtz_f16_f32 v143, v126, v127
v_cvt_pkrtz_f16_f32 v177, v128, v129
v_cvt_pk_f16_f32 v155, v130, v131
v_cvt_pk_f16_f32 v152, v132, v133
v_cvt_pk_f16_f32 v149, v134, v135
s_waitcnt lgkmcnt(1)
ds_read_b128 v[224:227], v248 offset:27648
ds_read_u16_d16 v186, v186
ds_read_u16_d16_hi v187, v187
v_mfma_f32_32x32x16_bf16 v[120:135], v[72:75], v[228:231], 0
v_pk_fma_f16 v154, v155, v155, s48
v_and_b32 v137, s49, v137
v_fma_mix_f32 v167, v178, v178, v167 op_sel:[0,0,0] op_sel_hi:[1,1,0]
v_pk_fma_f16 v151, v152, v152, s48
v_pk_fma_f16 v148, v149, v149, s48
v_lshrrev_b16 v136, 2, v137
v_pk_mul_f16 v154, v155, v154
v_pk_mul_f16 v151, v152, v151
v_fma_mix_f32 v167, v179, v179, v167 op_sel:[1,1,0] op_sel_hi:[1,1,0]
v_lshrrev_b32 v137, 18, v137
ds_read_b128 v[228:231], v250 offset:65520
ds_read_u16_d16 v136, v136
ds_read_u16_d16_hi v137, v137
v_mfma_f32_32x32x16_bf16 v[120:135], v[76:79], v[232:235], v[120:135]
v_pk_mul_f16 v148, v149, v148
v_exp_f16 v153, v154
v_exp_f16 v150, v151
v_and_b32 v139, s49, v139
v_fma_mix_f32 v167, v180, v180, v167 op_sel:[0,0,0] op_sel_hi:[1,1,0]
v_exp_f16 v147, v148
v_lshrrev_b16 v138, 2, v139
ds_read_b128 v[232:235], v248 offset:28672
ds_read_b32 v247, v253 offset:12
ds_read_u16_d16 v138, v138
v_mfma_f32_32x32x16_bf16 v[120:135], v[80:83], v[236:239], v[120:135]
v_exp_f16_sdwa v153, v154 dst_sel:WORD_1 dst_unused:UNUSED_PRESERVE src0_sel:WORD_1
v_lshrrev_b32 v139, 18, v139
v_fma_mix_f32 v167, v181, v181, v167 op_sel:[1,1,0] op_sel_hi:[1,1,0]
v_exp_f16_sdwa v150, v151 dst_sel:WORD_1 dst_unused:UNUSED_PRESERVE src0_sel:WORD_1
v_exp_f16_sdwa v147, v148 dst_sel:WORD_1 dst_unused:UNUSED_PRESERVE src0_sel:WORD_1
v_and_b32 v141, s49, v141
v_fma_mix_f32 v167, v182, v182, v167 op_sel:[0,0,0] op_sel_hi:[1,1,0]
ds_read_b128 v[236:239], v248 offset:31744
ds_read_u16_d16_hi v139, v139
v_mfma_f32_32x32x16_bf16 v[120:135], v[84:87], v[216:219], v[120:135]
v_pk_add_f16 v153, v153, 1.0 op_sel_hi:[1,0]
v_lshrrev_b16 v140, 2, v141
v_pk_add_f16 v150, v150, 1.0 op_sel_hi:[1,0]
v_pk_add_f16 v147, v147, 1.0 op_sel_hi:[1,0]
v_rcp_f16 v154, v153
v_lshrrev_b32 v141, 18, v141
ds_read_u16_d16 v140, v140
ds_read_u16_d16_hi v141, v141
s_waitcnt lgkmcnt(5)
v_readfirstlane_b32 s43, v247
s_nop 1
s_cmp_ge_u32 s43, 24
s_cbranch_scc1 Lev6
Lev6w:
s_sleep 1
ds_read_b32 v247, v253 offset:12
s_waitcnt lgkmcnt(0)
v_readfirstlane_b32 s43, v247
s_cmp_eq_u32 s76, 0
s_cbranch_scc1 Lev6
s_sub_u32 s76, s76, 1
s_cmp_lt_u32 s43, 24
s_cbranch_scc1 Lev6w
Lev6:
v_fma_mix_f32 v167, v183, v183, v167 op_sel:[1,1,0] op_sel_hi:[1,1,0]
v_rcp_f16 v151, v150
ds_read_b128 v[216:219], v248 offset:29696
v_mfma_f32_32x32x16_bf16 v[120:135], v[88:91], v[220:223], v[120:135]
v_and_b32 v143, s49, v143
v_rcp_f16 v148, v147
v_fma_mix_f32 v167, v184, v184, v167 op_sel:[0,0,0] op_sel_hi:[1,1,0]
v_lshrrev_b16 v142, 2, v143
s_setprio 0
v_rcp_f16_sdwa v154, v153 dst_sel:WORD_1 dst_unused:UNUSED_PRESERVE src0_sel:WORD_1
v_rcp_f16_sdwa v151, v150 dst_sel:WORD_1 dst_unused:UNUSED_PRESERVE src0_sel:WORD_1
v_lshrrev_b32 v143, 18, v143
ds_read_b128 v[220:223], v245
ds_read_b128 v[192:195], v242
ds_read_b128 v[196:199], v242 offset:64
ds_read_u16_d16 v142, v142
ds_read_u16_d16_hi v143, v143
v_mfma_f32_32x32x16_bf16 v[120:135], v[92:95], v[224:227], v[120:135]
v_fma_mix_f32 v167, v185, v185, v167 op_sel:[1,1,0] op_sel_hi:[1,1,0]
v_rcp_f16_sdwa v148, v147 dst_sel:WORD_1 dst_unused:UNUSED_PRESERVE src0_sel:WORD_1
v_and_b32 v177, s49, v177
v_pk_mul_f16 v155, v155, v154
v_fma_mix_f32 v167, v186, v186, v167 op_sel:[0,0,0] op_sel_hi:[1,1,0]
v_pk_mul_f16 v152, v152, v151
v_lshrrev_b16 v176, 2, v177
v_pk_mul_f16 v149, v149, v148
v_fma_mix_f32 v156, v155, v155, v156 op_sel:[0,0,0] op_sel_hi:[1,1,0]
v_fma_mix_f32 v156, v155, v155, v156 op_sel:[1,1,0] op_sel_hi:[1,1,0]
v_lshrrev_b32 v177, 18, v177
v_fma_mix_f32 v167, v187, v187, v167 op_sel:[1,1,0] op_sel_hi:[1,1,0]
v_fma_mix_f32 v156, v152, v152, v156 op_sel:[0,0,0] op_sel_hi:[1,1,0]
v_fma_mix_f32 v156, v152, v152, v156 op_sel:[1,1,0] op_sel_hi:[1,1,0]
v_fma_mix_f32 v156, v149, v149, v156 op_sel:[0,0,0] op_sel_hi:[1,1,0]
v_fma_mix_f32 v156, v149, v149, v156 op_sel:[1,1,0] op_sel_hi:[1,1,0]
s_setprio 2
v_mfma_f32_32x32x16_bf16 v[0:15], v[228:231], v[228:231], 0
s_add_u32 s46, s80, 8388608
buffer_store_dwordx4 v[64:67], v241, s[32:35], s46 offen sc1
ds_read_b128 v[224:227], v248 offset:32768
ds_read_u16_d16 v176, v176
ds_read_u16_d16_hi v177, v177
v_cvt_pkrtz_f16_f32 v179, v120, v121
v_cvt_pkrtz_f16_f32 v181, v122, v123
v_cvt_pkrtz_f16_f32 v183, v124, v125
v_mfma_f32_32x32x16_bf16 v[16:31], v[228:231], v[228:231], 0
v_cvt_pkrtz_f16_f32 v185, v126, v127
v_cvt_pkrtz_f16_f32 v187, v128, v129
v_cvt_pk_f16_f32 v155, v130, v131
v_cvt_pk_f16_f32 v152, v132, v133
v_mfma_f32_32x32x16_bf16 v[32:47], v[228:231], v[228:231], 0
v_cvt_pk_f16_f32 v149, v134, v135
v_pk_fma_f16 v154, v155, v155, s48
v_and_b32 v179, s49, v179
v_mfma_f32_32x32x16_bf16 v[120:135], v[72:75], v[232:235], 0
ds_read_b128 v[228:231], v248 offset:30720
v_fma_mix_f32 v156, v136, v136, v156 op_sel:[0,0,0] op_sel_hi:[1,1,0]
v_pk_fma_f16 v151, v152, v152, s48
v_pk_fma_f16 v148, v149, v149, s48
v_lshrrev_b16 v178, 2, v179
v_pk_mul_f16 v154, v155, v154
v_pk_mul_f16 v151, v152, v151
v_fma_mix_f32 v156, v137, v137, v156 op_sel:[1,1,0] op_sel_hi:[1,1,0]
s_waitcnt lgkmcnt(4)
v_mfma_f32_32x32x16_bf16 v[120:135], v[76:79], v[236:239], v[120:135]
ds_read_b128 v[232:235], v245 offset:384
ds_read_b128 v[200:203], v242 offset:128
ds_read_b128 v[204:207], v243
ds_read_u16_d16 v178, v178
v_lshrrev_b32 v179, 18, v179
v_pk_mul_f16 v148, v149, v148
v_exp_f16 v153, v154
v_exp_f16 v150, v151
v_and_b32 v181, s49, v181
v_fma_mix_f32 v156, v138, v138, v156 op_sel:[0,0,0] op_sel_hi:[1,1,0]
v_mfma_f32_32x32x16_bf16 v[120:135], v[80:83], v[216:219], v[120:135]
ds_read_b128 v[236:239], v248 offset:33792
ds_read_u16_d16_hi v179, v179
v_exp_f16 v147, v148
v_lshrrev_b16 v180, 2, v181
v_exp_f16_sdwa v153, v154 dst_sel:WORD_1 dst_unused:UNUSED_PRESERVE src0_sel:WORD_1
v_lshrrev_b32 v181, 18, v181
v_fma_mix_f32 v156, v139, v139, v156 op_sel:[1,1,0] op_sel_hi:[1,1,0]
v_smfmac_f32_16x16x32_bf16 v[0:3], v[220:221], v[192:195], v246
ds_read_b128 v[216:219], v245 offset:768
ds_read_b128 v[208:211], v243 offset:64
ds_read_b128 v[212:215], v243 offset:128
ds_read_u16_d16 v180, v180
ds_read_u16_d16_hi v181, v181
v_exp_f16_sdwa v150, v151 dst_sel:WORD_1 dst_unused:UNUSED_PRESERVE src0_sel:WORD_1
v_smfmac_f32_16x16x32_bf16 v[16:19], v[222:223], v[196:199], v246
v_exp_f16_sdwa v147, v148 dst_sel:WORD_1 dst_unused:UNUSED_PRESERVE src0_sel:WORD_1
v_and_b32 v183, s49, v183
v_fma_mix_f32 v156, v140, v140, v156 op_sel:[0,0,0] op_sel_hi:[1,1,0]
v_pk_add_f16 v153, v153, 1.0 op_sel_hi:[1,0]
s_waitcnt lgkmcnt(7)
v_mfma_f32_32x32x16_bf16 v[120:135], v[84:87], v[224:227], v[120:135]
ds_read_b128 v[220:223], v245 offset:1152
ds_read_b128 v[192:195], v244
ds_read_b128 v[196:199], v244 offset:64
v_lshrrev_b16 v182, 2, v183
v_pk_add_f16 v150, v150, 1.0 op_sel_hi:[1,0]
v_pk_add_f16 v147, v147, 1.0 op_sel_hi:[1,0]
v_rcp_f16 v154, v153
v_lshrrev_b32 v183, 18, v183
v_fma_mix_f32 v156, v141, v141, v156 op_sel:[1,1,0] op_sel_hi:[1,1,0]
v_mfma_f32_32x32x16_bf16 v[120:135], v[88:91], v[228:231], v[120:135]
ds_read_b128 v[224:227], v248 offset:34816
ds_read_u16_d16 v182, v182
ds_read_u16_d16_hi v183, v183
v_rcp_f16 v151, v150
v_and_b32 v185, s49, v185
v_rcp_f16 v148, v147
v_fma_mix_f32 v156, v142, v142, v156 op_sel:[0,0,0] op_sel_hi:[1,1,0]
v_lshrrev_b16 v184, 2, v185
v_smfmac_f32_16x16x32_bf16 v[32:35], v[232:233], v[200:203], v246
ds_read_b128 v[228:231], v248 offset:37888
ds_read_u16_d16 v184, v184
v_rcp_f16_sdwa v154, v153 dst_sel:WORD_1 dst_unused:UNUSED_PRESERVE src0_sel:WORD_1
v_rcp_f16_sdwa v151, v150 dst_sel:WORD_1 dst_unused:UNUSED_PRESERVE src0_sel:WORD_1
v_smfmac_f32_16x16x32_bf16 v[0:3], v[234:235], v[204:207], v246
v_lshrrev_b32 v185, 18, v185
v_fma_mix_f32 v156, v143, v143, v156 op_sel:[1,1,0] op_sel_hi:[1,1,0]
s_waitcnt lgkmcnt(6)
v_mfma_f32_32x32x16_bf16 v[120:135], v[92:95], v[236:239], v[120:135]
ds_read_b128 v[232:235], v248 offset:35840
ds_read_u16_d16_hi v185, v185
v_rcp_f16_sdwa v148, v147 dst_sel:WORD_1 dst_unused:UNUSED_PRESERVE src0_sel:WORD_1
v_and_b32 v187, s49, v187
v_pk_mul_f16 v155, v155, v154
v_fma_mix_f32 v156, v176, v176, v156 op_sel:[0,0,0] op_sel_hi:[1,1,0]
v_pk_mul_f16 v152, v152, v151
v_lshrrev_b16 v186, 2, v187
v_pk_mul_f16 v149, v149, v148
v_smfmac_f32_16x16x32_bf16 v[16:19], v[216:217], v[208:211], v246
ds_read_b128 v[236:239], v248 offset:38912
ds_read_u16_d16 v186, v186
v_fma_mix_f32 v157, v155, v155, v157 op_sel:[0,0,0] op_sel_hi:[1,1,0]
v_fma_mix_f32 v157, v155, v155, v157 op_sel:[1,1,0] op_sel_hi:[1,1,0]
v_lshrrev_b32 v187, 18, v187
v_fma_mix_f32 v156, v177, v177, v156 op_sel:[1,1,0] op_sel_hi:[1,1,0]
v_smfmac_f32_16x16x32_bf16 v[32:35], v[218:219], v[212:215], v246
v_fma_mix_f32 v157, v152, v152, v157 op_sel:[0,0,0] op_sel_hi:[1,1,0]
v_fma_mix_f32 v157, v152, v152, v157 op_sel:[1,1,0] op_sel_hi:[1,1,0]
v_fma_mix_f32 v157, v149, v149, v157 op_sel:[0,0,0] op_sel_hi:[1,1,0]
v_fma_mix_f32 v157, v149, v149, v157 op_sel:[1,1,0] op_sel_hi:[1,1,0]
s_setprio 1
v_smfmac_f32_16x16x32_bf16 v[0:3], v[220:221], v[192:195], v246
s_waitcnt lgkmcnt(4)
s_add_u32 s46, s80, 10485760
buffer_store_dwordx4 v[68:71], v241, s[32:35], s46 offen sc1
ds_read_b128 v[216:219], v248 offset:36864
ds_read_u16_d16_hi v187, v187
v_cvt_pkrtz_f16_f32 v137, v120, v121
v_cvt_pkrtz_f16_f32 v139, v122, v123
v_cvt_pkrtz_f16_f32 v141, v124, v125
v_cvt_pkrtz_f16_f32 v143, v126, v127
v_cvt_pk_f16_f32 v155, v128, v129
v_smfmac_f32_16x16x32_bf16 v[16:19], v[222:223], v[196:199], v246
v_cvt_pk_f16_f32 v152, v130, v131
v_cvt_pk_f16_f32 v149, v132, v133
v_cvt_pk_f16_f32 v146, v134, v135
v_pk_fma_f16 v154, v155, v155, s48
v_and_b32 v137, s49, v137
v_mfma_f32_32x32x16_bf16 v[120:135], v[72:75], v[224:227], 0
ds_read_b128 v[220:223], v248 offset:39936
v_fma_mix_f32 v157, v178, v178, v157 op_sel:[0,0,0] op_sel_hi:[1,1,0]
v_pk_fma_f16 v151, v152, v152, s48
v_pk_fma_f16 v148, v149, v149, s48
v_pk_fma_f16 v145, v146, v146, s48
v_pk_mul_f16 v154, v155, v154
v_lshrrev_b16 v136, 2, v137
v_pk_mul_f16 v151, v152, v151
v_fma_mix_f32 v157, v179, v179, v157 op_sel:[1,1,0] op_sel_hi:[1,1,0]
v_pk_mul_f16 v148, v149, v148
v_pk_mul_f16 v145, v146, v145
v_mfma_f32_32x32x16_bf16 v[120:135], v[76:79], v[228:231], v[120:135]
ds_read_b128 v[224:227], v245 offset:1536
ds_read_b128 v[200:203], v244 offset:128
v_xor_b32 v242, 16, v242
ds_read_b128 v[204:207], v242
ds_read_u16_d16 v136, v136
v_exp_f16 v153, v154
v_lshrrev_b32 v137, 18, v137
v_exp_f16 v150, v151
v_fma_mix_f32 v157, v180, v180, v157 op_sel:[0,0,0] op_sel_hi:[1,1,0]
v_exp_f16 v147, v148
v_and_b32 v139, s49, v139
v_exp_f16 v144, v145
s_waitcnt lgkmcnt(5)
v_mfma_f32_32x32x16_bf16 v[120:135], v[80:83], v[232:235], v[120:135]
ds_read_b128 v[228:231], v245 offset:1920
ds_read_b128 v[208:211], v242 offset:64
ds_read_b128 v[212:215], v242 offset:128
ds_read_u16_d16_hi v137, v137
v_exp_f16_sdwa v153, v154 dst_sel:WORD_1 dst_unused:UNUSED_PRESERVE src0_sel:WORD_1
v_fma_mix_f32 v157, v181, v181, v157 op_sel:[1,1,0] op_sel_hi:[1,1,0]
v_lshrrev_b16 v138, 2, v139
v_exp_f16_sdwa v150, v151 dst_sel:WORD_1 dst_unused:UNUSED_PRESERVE src0_sel:WORD_1
v_exp_f16_sdwa v147, v148 dst_sel:WORD_1 dst_unused:UNUSED_PRESERVE src0_sel:WORD_1
v_exp_f16_sdwa v144, v145 dst_sel:WORD_1 dst_unused:UNUSED_PRESERVE src0_sel:WORD_1
v_lshrrev_b32 v139, 18, v139
v_fma_mix_f32 v157, v182, v182, v157 op_sel:[0,0,0] op_sel_hi:[1,1,0]
v_mfma_f32_32x32x16_bf16 v[120:135], v[84:87], v[236:239], v[120:135]
ds_read_b128 v[232:235], v248 offset:40960
ds_read_u16_d16 v138, v138
ds_read_u16_d16_hi v139, v139
v_pk_add_f16 v153, v153, 1.0 op_sel_hi:[1,0]
v_pk_add_f16 v150, v150, 1.0 op_sel_hi:[1,0]
v_pk_add_f16 v147, v147, 1.0 op_sel_hi:[1,0]
v_and_b32 v141, s49, v141
v_pk_add_f16 v144, v144, 1.0 op_sel_hi:[1,0]
v_rcp_f16 v154, v153
v_fma_mix_f32 v157, v183, v183, v157 op_sel:[1,1,0] op_sel_hi:[1,1,0]
v_rcp_f16 v151, v150
v_mfma_f32_32x32x16_bf16 v[120:135], v[88:91], v[216:219], v[120:135]
ds_read_b128 v[236:239], v248 offset:44032
v_lshrrev_b16 v140, 2, v141
v_rcp_f16 v148, v147
v_fma_mix_f32 v157, v184, v184, v157 op_sel:[0,0,0] op_sel_hi:[1,1,0]
v_rcp_f16 v145, v144
v_lshrrev_b32 v141, 18, v141
v_rcp_f16_sdwa v154, v153 dst_sel:WORD_1 dst_unused:UNUSED_PRESERVE src0_sel:WORD_1
s_setprio 0
v_rcp_f16_sdwa v151, v150 dst_sel:WORD_1 dst_unused:UNUSED_PRESERVE src0_sel:WORD_1
s_waitcnt lgkmcnt(4)
v_mfma_f32_32x32x16_bf16 v[120:135], v[92:95], v[220:223], v[120:135]
ds_read_b128 v[216:219], v248 offset:41984
ds_read_u16_d16 v140, v140
ds_read_u16_d16_hi v141, v141
v_fma_mix_f32 v157, v185, v185, v157 op_sel:[1,1,0] op_sel_hi:[1,1,0]
v_and_b32 v143, s49, v143
v_rcp_f16_sdwa v148, v147 dst_sel:WORD_1 dst_unused:UNUSED_PRESERVE src0_sel:WORD_1
v_rcp_f16_sdwa v145, v144 dst_sel:WORD_1 dst_unused:UNUSED_PRESERVE src0_sel:WORD_1
v_pk_mul_f16 v155, v155, v154
v_lshrrev_b16 v142, 2, v143
v_fma_mix_f32 v157, v186, v186, v157 op_sel:[0,0,0] op_sel_hi:[1,1,0]
v_pk_mul_f16 v152, v152, v151
v_pk_mul_f16 v149, v149, v148
v_smfmac_f32_16x16x32_bf16 v[32:35], v[224:225], v[200:203], v246
ds_read_b128 v[220:223], v248 offset:45056
ds_read_u16_d16 v142, v142
v_pk_mul_f16 v146, v146, v145
v_fma_mix_f32 v158, v155, v155, v158 op_sel:[0,0,0] op_sel_hi:[1,1,0]
v_lshrrev_b32 v143, 18, v143
v_fma_mix_f32 v158, v155, v155, v158 op_sel:[1,1,0] op_sel_hi:[1,1,0]
v_fma_mix_f32 v158, v152, v152, v158 op_sel:[0,0,0] op_sel_hi:[1,1,0]
v_smfmac_f32_16x16x32_bf16 v[4:7], v[226:227], v[204:207], v246
v_fma_mix_f32 v157, v187, v187, v157 op_sel:[1,1,0] op_sel_hi:[1,1,0]
v_fma_mix_f32 v158, v152, v152, v158 op_sel:[1,1,0] op_sel_hi:[1,1,0]
v_fma_mix_f32 v158, v149, v149, v158 op_sel:[0,0,0] op_sel_hi:[1,1,0]
v_fma_mix_f32 v158, v149, v149, v158 op_sel:[1,1,0] op_sel_hi:[1,1,0]
v_fma_mix_f32 v158, v146, v146, v158 op_sel:[0,0,0] op_sel_hi:[1,1,0]
v_fma_mix_f32 v158, v146, v146, v158 op_sel:[1,1,0] op_sel_hi:[1,1,0]
s_setprio 2
v_smfmac_f32_16x16x32_bf16 v[20:23], v[228:229], v[208:211], v246
ds_read_b128 v[224:227], v248 offset:43008
ds_read_u16_d16_hi v143, v143
v_cvt_pkrtz_f16_f32 v179, v120, v121
v_cvt_pkrtz_f16_f32 v181, v122, v123
v_cvt_pkrtz_f16_f32 v183, v124, v125
v_cvt_pkrtz_f16_f32 v185, v126, v127
v_smfmac_f32_16x16x32_bf16 v[36:39], v[230:231], v[212:215], v246
v_cvt_pkrtz_f16_f32 v187, v128, v129
v_cvt_pk_f16_f32 v155, v130, v131
v_cvt_pk_f16_f32 v152, v132, v133
v_cvt_pk_f16_f32 v149, v134, v135
v_pk_fma_f16 v154, v155, v155, s48
s_waitcnt lgkmcnt(2)
v_mfma_f32_32x32x16_bf16 v[120:135], v[72:75], v[232:235], 0
ds_read_b128 v[228:231], v248 offset:46080
v_and_b32 v179, s49, v179
v_fma_mix_f32 v158, v136, v136, v158 op_sel:[0,0,0] op_sel_hi:[1,1,0]
v_pk_fma_f16 v151, v152, v152, s48
v_pk_fma_f16 v148, v149, v149, s48
v_lshrrev_b16 v178, 2, v179
v_pk_mul_f16 v154, v155, v154
v_pk_mul_f16 v151, v152, v151
v_pk_mul_f16 v148, v149, v148
v_lshrrev_b32 v179, 18, v179
v_mfma_f32_32x32x16_bf16 v[120:135], v[76:79], v[236:239], v[120:135]
ds_read_b128 v[232:235], v245 offset:2304
v_xor_b32 v243, 16, v243
ds_read_b128 v[192:195], v243
ds_read_b128 v[196:199], v243 offset:64
ds_read_u16_d16 v178, v178
ds_read_u16_d16_hi v179, v179
v_fma_mix_f32 v158, v137, v137, v158 op_sel:[1,1,0] op_sel_hi:[1,1,0]
v_exp_f16 v153, v154
v_and_b32 v181, s49, v181
v_exp_f16 v150, v151
v_exp_f16 v147, v148
v_lshrrev_b16 v180, 2, v181
v_mfma_f32_32x32x16_bf16 v[120:135], v[80:83], v[216:219], v[120:135]
ds_read_b128 v[236:239], v245 offset:2688
ds_read_b128 v[200:203], v243 offset:128
v_xor_b32 v244, 16, v244
ds_read_b128 v[204:207], v244
ds_read_u16_d16 v180, v180
v_fma_mix_f32 v158, v138, v138, v158 op_sel:[0,0,0] op_sel_hi:[1,1,0]
v_exp_f16_sdwa v153, v154 dst_sel:WORD_1 dst_unused:UNUSED_PRESERVE src0_sel:WORD_1
v_lshrrev_b32 v181, 18, v181
v_exp_f16_sdwa v150, v151 dst_sel:WORD_1 dst_unused:UNUSED_PRESERVE src0_sel:WORD_1
v_fma_mix_f32 v158, v139, v139, v158 op_sel:[1,1,0] op_sel_hi:[1,1,0]
v_and_b32 v183, s49, v183
v_mfma_f32_32x32x16_bf16 v[120:135], v[84:87], v[220:223], v[120:135]
ds_read_b128 v[216:219], v248 offset:47104
ds_read_u16_d16_hi v181, v181
v_exp_f16_sdwa v147, v148 dst_sel:WORD_1 dst_unused:UNUSED_PRESERVE src0_sel:WORD_1
v_pk_add_f16 v153, v153, 1.0 op_sel_hi:[1,0]
v_lshrrev_b16 v182, 2, v183
v_pk_add_f16 v150, v150, 1.0 op_sel_hi:[1,0]
v_pk_add_f16 v147, v147, 1.0 op_sel_hi:[1,0]
v_rcp_f16 v154, v153
v_lshrrev_b32 v183, 18, v183
v_fma_mix_f32 v158, v140, v140, v158 op_sel:[0,0,0] op_sel_hi:[1,1,0]
s_waitcnt lgkmcnt(6)
v_mfma_f32_32x32x16_bf16 v[120:135], v[88:91], v[224:227], v[120:135]
ds_read_b128 v[220:223], v248 offset:50176
ds_read_u16_d16 v182, v182
ds_read_u16_d16_hi v183, v183
v_rcp_f16 v151, v150
v_and_b32 v185, s49, v185
v_rcp_f16 v148, v147
v_fma_mix_f32 v158, v141, v141, v158 op_sel:[1,1,0] op_sel_hi:[1,1,0]
v_lshrrev_b16 v184, 2, v185
v_rcp_f16_sdwa v154, v153 dst_sel:WORD_1 dst_unused:UNUSED_PRESERVE src0_sel:WORD_1
v_mfma_f32_32x32x16_bf16 v[120:135], v[92:95], v[228:231], v[120:135]
ds_read_b128 v[224:227], v248 offset:48128
ds_read_u16_d16 v184, v184
v_rcp_f16_sdwa v151, v150 dst_sel:WORD_1 dst_unused:UNUSED_PRESERVE src0_sel:WORD_1
v_lshrrev_b32 v185, 18, v185
v_rcp_f16_sdwa v148, v147 dst_sel:WORD_1 dst_unused:UNUSED_PRESERVE src0_sel:WORD_1
v_and_b32 v187, s49, v187
v_fma_mix_f32 v158, v142, v142, v158 op_sel:[0,0,0] op_sel_hi:[1,1,0]
v_pk_mul_f16 v155, v155, v154
v_pk_mul_f16 v152, v152, v151
v_smfmac_f32_16x16x32_bf16 v[4:7], v[232:233], v[192:195], v246
ds_read_b128 v[228:231], v248 offset:51200
ds_read_u16_d16_hi v185, v185
v_lshrrev_b16 v186, 2, v187
v_pk_mul_f16 v149, v149, v148
v_fma_mix_f32 v159, v155, v155, v159 op_sel:[0,0,0] op_sel_hi:[1,1,0]
v_fma_mix_f32 v158, v143, v143, v158 op_sel:[1,1,0] op_sel_hi:[1,1,0]
v_lshrrev_b32 v187, 18, v187
v_smfmac_f32_16x16x32_bf16 v[20:23], v[234:235], v[196:199], v246
v_fma_mix_f32 v159, v155, v155, v159 op_sel:[1,1,0] op_sel_hi:[1,1,0]
v_fma_mix_f32 v159, v152, v152, v159 op_sel:[0,0,0] op_sel_hi:[1,1,0]
v_fma_mix_f32 v159, v152, v152, v159 op_sel:[1,1,0] op_sel_hi:[1,1,0]
v_fma_mix_f32 v159, v149, v149, v159 op_sel:[0,0,0] op_sel_hi:[1,1,0]
v_fma_mix_f32 v159, v149, v149, v159 op_sel:[1,1,0] op_sel_hi:[1,1,0]
s_setprio 1
s_waitcnt lgkmcnt(4)
v_smfmac_f32_16x16x32_bf16 v[36:39], v[236:237], v[200:203], v246
ds_read_b128 v[232:235], v248 offset:49152
ds_read_u16_d16 v186, v186
ds_read_u16_d16_hi v187, v187
v_cvt_pkrtz_f16_f32 v137, v120, v121
v_cvt_pkrtz_f16_f32 v139, v122, v123
v_cvt_pkrtz_f16_f32 v141, v124, v125
v_cvt_pkrtz_f16_f32 v143, v126, v127
v_cvt_pk_f16_f32 v155, v128, v129
v_smfmac_f32_16x16x32_bf16 v[4:7], v[238:239], v[204:207], v246
v_cvt_pk_f16_f32 v152, v130, v131
v_cvt_pk_f16_f32 v149, v132, v133
v_cvt_pk_f16_f32 v146, v134, v135
v_pk_fma_f16 v154, v155, v155, s48
v_and_b32 v137, s49, v137
v_mfma_f32_32x32x16_bf16 v[120:135], v[72:75], v[216:219], 0
ds_read_b128 v[236:239], v248 offset:52224
v_fma_mix_f32 v159, v178, v178, v159 op_sel:[0,0,0] op_sel_hi:[1,1,0]
v_pk_fma_f16 v151, v152, v152, s48
v_pk_fma_f16 v148, v149, v149, s48
v_pk_fma_f16 v145, v146, v146, s48
v_pk_mul_f16 v154, v155, v154
v_lshrrev_b16 v136, 2, v137
v_pk_mul_f16 v151, v152, v151
v_fma_mix_f32 v159, v179, v179, v159 op_sel:[1,1,0] op_sel_hi:[1,1,0]
v_pk_mul_f16 v148, v149, v148
v_pk_mul_f16 v145, v146, v145
v_mfma_f32_32x32x16_bf16 v[120:135], v[76:79], v[220:223], v[120:135]
ds_read_b128 v[216:219], v245 offset:3072
ds_read_b128 v[208:211], v244 offset:64
ds_read_b128 v[212:215], v244 offset:128
ds_read_u16_d16 v136, v136
v_exp_f16 v153, v154
v_lshrrev_b32 v137, 18, v137
v_exp_f16 v150, v151
v_fma_mix_f32 v159, v180, v180, v159 op_sel:[0,0,0] op_sel_hi:[1,1,0]
v_exp_f16 v147, v148
v_and_b32 v139, s49, v139
v_exp_f16 v144, v145
s_waitcnt lgkmcnt(5)
v_mfma_f32_32x32x16_bf16 v[120:135], v[80:83], v[224:227], v[120:135]
ds_read_b128 v[220:223], v245 offset:3456
v_xor_b32 v242, 32, v242
ds_read_b128 v[192:195], v242
ds_read_b128 v[196:199], v242 offset:64
ds_read_u16_d16_hi v137, v137
v_exp_f16_sdwa v153, v154 dst_sel:WORD_1 dst_unused:UNUSED_PRESERVE src0_sel:WORD_1
v_fma_mix_f32 v159, v181, v181, v159 op_sel:[1,1,0] op_sel_hi:[1,1,0]
v_lshrrev_b16 v138, 2, v139
v_exp_f16_sdwa v150, v151 dst_sel:WORD_1 dst_unused:UNUSED_PRESERVE src0_sel:WORD_1
v_exp_f16_sdwa v147, v148 dst_sel:WORD_1 dst_unused:UNUSED_PRESERVE src0_sel:WORD_1
v_exp_f16_sdwa v144, v145 dst_sel:WORD_1 dst_unused:UNUSED_PRESERVE src0_sel:WORD_1
v_lshrrev_b32 v139, 18, v139
v_fma_mix_f32 v159, v182, v182, v159 op_sel:[0,0,0] op_sel_hi:[1,1,0]
v_mfma_f32_32x32x16_bf16 v[120:135], v[84:87], v[228:231], v[120:135]
ds_read_b128 v[224:227], v248 offset:53248
ds_read_u16_d16 v138, v138
ds_read_u16_d16_hi v139, v139
v_pk_add_f16 v153, v153, 1.0 op_sel_hi:[1,0]
v_pk_add_f16 v150, v150, 1.0 op_sel_hi:[1,0]
v_pk_add_f16 v147, v147, 1.0 op_sel_hi:[1,0]
v_and_b32 v141, s49, v141
v_pk_add_f16 v144, v144, 1.0 op_sel_hi:[1,0]
v_rcp_f16 v154, v153
v_fma_mix_f32 v159, v183, v183, v159 op_sel:[1,1,0] op_sel_hi:[1,1,0]
v_rcp_f16 v151, v150
v_mfma_f32_32x32x16_bf16 v[120:135], v[88:91], v[232:235], v[120:135]
ds_read_b128 v[228:231], v248 offset:56320
v_lshrrev_b16 v140, 2, v141
v_rcp_f16 v148, v147
v_fma_mix_f32 v159, v184, v184, v159 op_sel:[0,0,0] op_sel_hi:[1,1,0]
v_rcp_f16 v145, v144
v_lshrrev_b32 v141, 18, v141
v_rcp_f16_sdwa v154, v153 dst_sel:WORD_1 dst_unused:UNUSED_PRESERVE src0_sel:WORD_1
s_setprio 0
v_rcp_f16_sdwa v151, v150 dst_sel:WORD_1 dst_unused:UNUSED_PRESERVE src0_sel:WORD_1
s_waitcnt lgkmcnt(4)
v_mfma_f32_32x32x16_bf16 v[120:135], v[92:95], v[236:239], v[120:135]
ds_read_b128 v[232:235], v248 offset:54272
ds_read_u16_d16 v140, v140
ds_read_u16_d16_hi v141, v141
v_fma_mix_f32 v159, v185, v185, v159 op_sel:[1,1,0] op_sel_hi:[1,1,0]
v_and_b32 v143, s49, v143
v_rcp_f16_sdwa v148, v147 dst_sel:WORD_1 dst_unused:UNUSED_PRESERVE src0_sel:WORD_1
v_rcp_f16_sdwa v145, v144 dst_sel:WORD_1 dst_unused:UNUSED_PRESERVE src0_sel:WORD_1
v_pk_mul_f16 v155, v155, v154
v_lshrrev_b16 v142, 2, v143
v_fma_mix_f32 v159, v186, v186, v159 op_sel:[0,0,0] op_sel_hi:[1,1,0]
v_pk_mul_f16 v152, v152, v151
v_pk_mul_f16 v149, v149, v148
v_smfmac_f32_16x16x32_bf16 v[20:23], v[216:217], v[208:211], v246
ds_read_b128 v[236:239], v248 offset:57344
ds_read_u16_d16 v142, v142
v_pk_mul_f16 v146, v146, v145
v_fma_mix_f32 v160, v155, v155, v160 op_sel:[0,0,0] op_sel_hi:[1,1,0]
v_lshrrev_b32 v143, 18, v143
v_fma_mix_f32 v160, v155, v155, v160 op_sel:[1,1,0] op_sel_hi:[1,1,0]
v_fma_mix_f32 v160, v152, v152, v160 op_sel:[0,0,0] op_sel_hi:[1,1,0]
v_smfmac_f32_16x16x32_bf16 v[36:39], v[218:219], v[212:215], v246
v_fma_mix_f32 v159, v187, v187, v159 op_sel:[1,1,0] op_sel_hi:[1,1,0]
v_fma_mix_f32 v160, v152, v152, v160 op_sel:[1,1,0] op_sel_hi:[1,1,0]
v_fma_mix_f32 v160, v149, v149, v160 op_sel:[0,0,0] op_sel_hi:[1,1,0]
v_fma_mix_f32 v160, v149, v149, v160 op_sel:[1,1,0] op_sel_hi:[1,1,0]
v_fma_mix_f32 v160, v146, v146, v160 op_sel:[0,0,0] op_sel_hi:[1,1,0]
v_fma_mix_f32 v160, v146, v146, v160 op_sel:[1,1,0] op_sel_hi:[1,1,0]
s_cmp_lg_u32 s40, 7
s_cbranch_scc1 Lnobias2
s_sub_u32 s43, s2, 96
s_cmp_lt_u32 s43, 96
s_cbranch_scc0 Lnobias2
s_waitcnt vmcnt(13)
v_lshlrev_b32 v102, 16, v102
v_lshlrev_b32 v103, 16, v103
v_lshlrev_b32 v104, 16, v104
v_lshlrev_b32 v105, 16, v105
v_lshlrev_b32 v106, 16, v106
v_lshlrev_b32 v107, 16, v107
v_lshlrev_b32 v108, 16, v108
v_lshlrev_b32 v109, 16, v109
v_lshlrev_b32 v110, 16, v110
v_lshlrev_b32 v111, 16, v111
v_lshlrev_b32 v112, 16, v112
v_lshlrev_b32 v113, 16, v113
v_mul_f32 v100, v102, v108
v_fmac_f32 v100, v103, v109
v_fmac_f32 v100, v104, v110
v_fmac_f32 v100, v105, v111
v_fmac_f32 v100, v106, v112
v_fmac_f32 v100, v107, v113
s_nop 1
v_add_f32_dpp v100, v100, v100 row_ror:8 row_mask:0xf bank_mask:0xf
s_nop 1
v_add_f32_dpp v100, v100, v100 row_ror:4 row_mask:0xf bank_mask:0xf
s_nop 1
v_add_f32_dpp v100, v100, v100 row_ror:2 row_mask:0xf bank_mask:0xf
s_nop 1
v_add_f32_dpp v100, v100, v100 row_ror:1 row_mask:0xf bank_mask:0xf
v_mov_b32 v101, v100
s_nop 1
v_permlane16_swap_b32 v100, v101
v_add_f32 v100, v100, v101
v_mov_b32 v101, v100
s_nop 1
v_permlane32_swap_b32 v100, v101
v_add_f32 v100, v100, v101
s_lshl_b32 s44, s43, 2
s_add_u32 s44, s44, 394752
v_lshlrev_b32 v115, 11, v251
s_mov_b64 exec, 0xff
buffer_store_dword v100, v115, s[32:35], s44 offen sc1
s_mov_b64 exec, -1
Lnobias2:
s_setprio 2
v_smfmac_f32_16x16x32_bf16 v[12:15], v[220:221], v[192:195], v246
ds_read_b128 v[216:219], v248 offset:55296
ds_read_u16_d16_hi v143, v143
v_cvt_pkrtz_f16_f32 v179, v120, v121
v_cvt_pkrtz_f16_f32 v181, v122, v123
v_cvt_pkrtz_f16_f32 v183, v124, v125
v_cvt_pkrtz_f16_f32 v185, v126, v127
v_smfmac_f32_16x16x32_bf16 v[28:31], v[222:223], v[196:199], v246
v_cvt_pkrtz_f16_f32 v187, v128, v129
v_cvt_pk_f16_f32 v155, v130, v131
v_cvt_pk_f16_f32 v152, v132, v133
v_cvt_pk_f16_f32 v149, v134, v135
s_waitcnt lgkmcnt(2)
v_mfma_f32_32x32x16_bf16 v[120:135], v[72:75], v[224:227], 0
ds_read_b128 v[220:223], v245 offset:3840
ds_read_b128 v[200:203], v242 offset:128
v_xor_b32 v243, 32, v243
ds_read_b128 v[204:207], v243
v_pk_fma_f16 v154, v155, v155, s48
v_and_b32 v179, s49, v179
v_fma_mix_f32 v160, v136, v136, v160 op_sel:[0,0,0] op_sel_hi:[1,1,0]
v_pk_fma_f16 v151, v152, v152, s48
v_pk_fma_f16 v148, v149, v149, s48
v_lshrrev_b16 v178, 2, v179
v_pk_mul_f16 v154, v155, v154
v_pk_mul_f16 v151, v152, v151
v_mfma_f32_32x32x16_bf16 v[120:135], v[76:79], v[228:231], v[120:135]
ds_read_b128 v[224:227], v248 offset:58368
ds_read_u16_d16 v178, v178
v_pk_mul_f16 v148, v149, v148
v_lshrrev_b32 v179, 18, v179
v_fma_mix_f32 v160, v137, v137, v160 op_sel:[1,1,0] op_sel_hi:[1,1,0]
v_exp_f16 v153, v154
v_and_b32 v181, s49, v181
v_exp_f16 v150, v151
v_mfma_f32_32x32x16_bf16 v[120:135], v[80:83], v[232:235], v[120:135]
ds_read_b128 v[228:231], v245 offset:4224
ds_read_b128 v[208:211], v243 offset:64
ds_read_b128 v[212:215], v243 offset:128
ds_read_u16_d16_hi v179, v179
v_exp_f16 v147, v148
v_lshrrev_b16 v180, 2, v181
v_fma_mix_f32 v160, v138, v138, v160 op_sel:[0,0,0] op_sel_hi:[1,1,0]
v_exp_f16_sdwa v153, v154 dst_sel:WORD_1 dst_unused:UNUSED_PRESERVE src0_sel:WORD_1
v_lshrrev_b32 v181, 18, v181
v_mfma_f32_32x32x16_bf16 v[120:135], v[84:87], v[236:239], v[120:135]
ds_read_b128 v[232:235], v245 offset:4608
v_xor_b32 v244, 32, v244
ds_read_b128 v[192:195], v244
ds_read_b128 v[196:199], v244 offset:64
ds_read_u16_d16 v180, v180
ds_read_u16_d16_hi v181, v181
v_exp_f16_sdwa v150, v151 dst_sel:WORD_1 dst_unused:UNUSED_PRESERVE src0_sel:WORD_1
v_fma_mix_f32 v160, v139, v139, v160 op_sel:[1,1,0] op_sel_hi:[1,1,0]
v_and_b32 v183, s49, v183
v_exp_f16_sdwa v147, v148 dst_sel:WORD_1 dst_unused:UNUSED_PRESERVE src0_sel:WORD_1
v_pk_add_f16 v153, v153, 1.0 op_sel_hi:[1,0]
v_lshrrev_b16 v182, 2, v183
v_pk_add_f16 v150, v150, 1.0 op_sel_hi:[1,0]
s_waitcnt lgkmcnt(9)
v_mfma_f32_32x32x16_bf16 v[120:135], v[88:91], v[216:219], v[120:135]
ds_read_b128 v[236:239], v248 offset:59392
ds_read_u16_d16 v182, v182
v_pk_add_f16 v147, v147, 1.0 op_sel_hi:[1,0]
v_rcp_f16 v154, v153
v_lshrrev_b32 v183, 18, v183
v_fma_mix_f32 v160, v140, v140, v160 op_sel:[0,0,0] op_sel_hi:[1,1,0]
v_rcp_f16 v151, v150
v_and_b32 v185, s49, v185
v_smfmac_f32_16x16x32_bf16 v[44:47], v[220:221], v[200:203], v246
ds_read_b128 v[216:219], v248 offset:62464
ds_read_u16_d16_hi v183, v183
v_rcp_f16 v148, v147
v_fma_mix_f32 v160, v141, v141, v160 op_sel:[1,1,0] op_sel_hi:[1,1,0]
v_lshrrev_b16 v184, 2, v185
v_smfmac_f32_16x16x32_bf16 v[12:15], v[222:223], v[204:207], v246
v_rcp_f16_sdwa v154, v153 dst_sel:WORD_1 dst_unused:UNUSED_PRESERVE src0_sel:WORD_1
v_rcp_f16_sdwa v151, v150 dst_sel:WORD_1 dst_unused:UNUSED_PRESERVE src0_sel:WORD_1
v_mfma_f32_32x32x16_bf16 v[120:135], v[92:95], v[224:227], v[120:135]
ds_read_b128 v[220:223], v248 offset:60416
ds_read_u16_d16 v184, v184
v_lshrrev_b32 v185, 18, v185
v_rcp_f16_sdwa v148, v147 dst_sel:WORD_1 dst_unused:UNUSED_PRESERVE src0_sel:WORD_1
v_and_b32 v187, s49, v187
v_fma_mix_f32 v160, v142, v142, v160 op_sel:[0,0,0] op_sel_hi:[1,1,0]
v_pk_mul_f16 v155, v155, v154
v_pk_mul_f16 v152, v152, v151
v_lshrrev_b16 v186, 2, v187
s_waitcnt lgkmcnt(4)
v_smfmac_f32_16x16x32_bf16 v[28:31], v[228:229], v[208:211], v246
ds_read_b128 v[224:227], v248 offset:63488
ds_read_u16_d16_hi v185, v185
ds_read_u16_d16 v186, v186
v_pk_mul_f16 v149, v149, v148
v_fma_mix_f32 v161, v155, v155, v161 op_sel:[0,0,0] op_sel_hi:[1,1,0]
v_fma_mix_f32 v160, v143, v143, v160 op_sel:[1,1,0] op_sel_hi:[1,1,0]
v_lshrrev_b32 v187, 18, v187
v_smfmac_f32_16x16x32_bf16 v[44:47], v[230:231], v[212:215], v246
v_fma_mix_f32 v161, v155, v155, v161 op_sel:[1,1,0] op_sel_hi:[1,1,0]
v_fma_mix_f32 v161, v152, v152, v161 op_sel:[0,0,0] op_sel_hi:[1,1,0]
v_fma_mix_f32 v161, v152, v152, v161 op_sel:[1,1,0] op_sel_hi:[1,1,0]
v_fma_mix_f32 v161, v149, v149, v161 op_sel:[0,0,0] op_sel_hi:[1,1,0]
v_fma_mix_f32 v161, v149, v149, v161 op_sel:[1,1,0] op_sel_hi:[1,1,0]
v_lshlrev_b32 v252, 7, v251
s_add_u32 s46, s47, 2359296
s_mov_b32 exec_lo, 131071
s_mov_b32 exec_hi, 0
s_mov_b32 m0, 16288
s_nop 0
buffer_load_dword v252, s[4:7], s46 offen lds
s_mov_b64 exec, -1
s_setprio 1
v_smfmac_f32_16x16x32_bf16 v[12:15], v[232:233], v[192:195], v246
ds_read_b128 v[228:231], v248 offset:61440
ds_read_u16_d16_hi v187, v187
v_cvt_pkrtz_f16_f32 v137, v120, v121
v_cvt_pkrtz_f16_f32 v139, v122, v123
v_cvt_pkrtz_f16_f32 v141, v124, v125
v_cvt_pkrtz_f16_f32 v143, v126, v127
v_cvt_pk_f16_f32 v155, v128, v129
v_smfmac_f32_16x16x32_bf16 v[28:31], v[234:235], v[196:199], v246
v_cvt_pk_f16_f32 v152, v130, v131
v_cvt_pk_f16_f32 v149, v132, v133
v_cvt_pk_f16_f32 v146, v134, v135
v_pk_fma_f16 v154, v155, v155, s48
v_and_b32 v137, s49, v137
v_mfma_f32_32x32x16_bf16 v[120:135], v[72:75], v[236:239], 0
ds_read_b128 v[232:235], v248 offset:64512
v_fma_mix_f32 v161, v178, v178, v161 op_sel:[0,0,0] op_sel_hi:[1,1,0]
v_pk_fma_f16 v151, v152, v152, s48
v_pk_fma_f16 v148, v149, v149, s48
v_pk_fma_f16 v145, v146, v146, s48
v_pk_mul_f16 v154, v155, v154
v_lshrrev_b16 v136, 2, v137
v_pk_mul_f16 v151, v152, v151
v_fma_mix_f32 v161, v179, v179, v161 op_sel:[1,1,0] op_sel_hi:[1,1,0]
v_pk_mul_f16 v148, v149, v148
v_pk_mul_f16 v145, v146, v145
s_waitcnt lgkmcnt(2)
v_mfma_f32_32x32x16_bf16 v[120:135], v[76:79], v[216:219], v[120:135]
ds_read_b128 v[236:239], v245 offset:4992
ds_read_b128 v[200:203], v244 offset:128
v_xor_b32 v242, 16, v242
ds_read_b128 v[204:207], v242
ds_read_u16_d16 v136, v136
v_exp_f16 v153, v154
v_lshrrev_b32 v137, 18, v137
v_exp_f16 v150, v151
v_fma_mix_f32 v161, v180, v180, v161 op_sel:[0,0,0] op_sel_hi:[1,1,0]
v_exp_f16 v147, v148
v_and_b32 v139, s49, v139
v_exp_f16 v144, v145
v_mfma_f32_32x32x16_bf16 v[120:135], v[80:83], v[220:223], v[120:135]
ds_read_b128 v[216:219], v245 offset:5376
ds_read_b128 v[208:211], v242 offset:64
ds_read_b128 v[212:215], v242 offset:128
ds_read_u16_d16_hi v137, v137
v_exp_f16_sdwa v153, v154 dst_sel:WORD_1 dst_unused:UNUSED_PRESERVE src0_sel:WORD_1
v_fma_mix_f32 v161, v181, v181, v161 op_sel:[1,1,0] op_sel_hi:[1,1,0]
v_lshrrev_b16 v138, 2, v139
v_exp_f16_sdwa v150, v151 dst_sel:WORD_1 dst_unused:UNUSED_PRESERVE src0_sel:WORD_1
v_exp_f16_sdwa v147, v148 dst_sel:WORD_1 dst_unused:UNUSED_PRESERVE src0_sel:WORD_1
v_exp_f16_sdwa v144, v145 dst_sel:WORD_1 dst_unused:UNUSED_PRESERVE src0_sel:WORD_1
v_lshrrev_b32 v139, 18, v139
v_fma_mix_f32 v161, v182, v182, v161 op_sel:[0,0,0] op_sel_hi:[1,1,0]
v_mfma_f32_32x32x16_bf16 v[120:135], v[84:87], v[224:227], v[120:135]
ds_read_b128 v[220:223], v249
ds_read_u16_d16 v138, v138
ds_read_u16_d16_hi v139, v139
v_pk_add_f16 v153, v153, 1.0 op_sel_hi:[1,0]
v_pk_add_f16 v150, v150, 1.0 op_sel_hi:[1,0]
v_pk_add_f16 v147, v147, 1.0 op_sel_hi:[1,0]
v_and_b32 v141, s49, v141
v_pk_add_f16 v144, v144, 1.0 op_sel_hi:[1,0]
v_rcp_f16 v154, v153
v_fma_mix_f32 v161, v183, v183, v161 op_sel:[1,1,0] op_sel_hi:[1,1,0]
v_rcp_f16 v151, v150
v_mfma_f32_32x32x16_bf16 v[120:135], v[88:91], v[228:231], v[120:135]
ds_read_b128 v[224:227], v249 offset:3072
v_lshrrev_b16 v140, 2, v141
v_rcp_f16 v148, v147
v_fma_mix_f32 v161, v184, v184, v161 op_sel:[0,0,0] op_sel_hi:[1,1,0]
v_rcp_f16 v145, v144
v_lshrrev_b32 v141, 18, v141
v_rcp_f16_sdwa v154, v153 dst_sel:WORD_1 dst_unused:UNUSED_PRESERVE src0_sel:WORD_1
s_setprio 0
v_rcp_f16_sdwa v151, v150 dst_sel:WORD_1 dst_unused:UNUSED_PRESERVE src0_sel:WORD_1
s_waitcnt lgkmcnt(4)
v_mfma_f32_32x32x16_bf16 v[120:135], v[92:95], v[232:235], v[120:135]
ds_read_b128 v[228:231], v249 offset:1024
ds_read_u16_d16 v140, v140
ds_read_u16_d16_hi v141, v141
v_fma_mix_f32 v161, v185, v185, v161 op_sel:[1,1,0] op_sel_hi:[1,1,0]
v_and_b32 v143, s49, v143
v_rcp_f16_sdwa v148, v147 dst_sel:WORD_1 dst_unused:UNUSED_PRESERVE src0_sel:WORD_1
v_rcp_f16_sdwa v145, v144 dst_sel:WORD_1 dst_unused:UNUSED_PRESERVE src0_sel:WORD_1
v_pk_mul_f16 v155, v155, v154
v_lshrrev_b16 v142, 2, v143
v_fma_mix_f32 v161, v186, v186, v161 op_sel:[0,0,0] op_sel_hi:[1,1,0]
v_pk_mul_f16 v152, v152, v151
v_pk_mul_f16 v149, v149, v148
v_smfmac_f32_16x16x32_bf16 v[44:47], v[236:237], v[200:203], v246
ds_read_b128 v[232:235], v249 offset:4096
ds_read_u16_d16 v142, v142
v_pk_mul_f16 v146, v146, v145
v_fma_mix_f32 v162, v155, v155, v162 op_sel:[0,0,0] op_sel_hi:[1,1,0]
v_lshrrev_b32 v143, 18, v143
v_fma_mix_f32 v162, v155, v155, v162 op_sel:[1,1,0] op_sel_hi:[1,1,0]
v_fma_mix_f32 v162, v152, v152, v162 op_sel:[0,0,0] op_sel_hi:[1,1,0]
v_smfmac_f32_16x16x32_bf16 v[8:11], v[238:239], v[204:207], v246
v_fma_mix_f32 v161, v187, v187, v161 op_sel:[1,1,0] op_sel_hi:[1,1,0]
v_fma_mix_f32 v162, v152, v152, v162 op_sel:[1,1,0] op_sel_hi:[1,1,0]
v_fma_mix_f32 v162, v149, v149, v162 op_sel:[0,0,0] op_sel_hi:[1,1,0]
v_fma_mix_f32 v162, v149, v149, v162 op_sel:[1,1,0] op_sel_hi:[1,1,0]
v_fma_mix_f32 v162, v146, v146, v162 op_sel:[0,0,0] op_sel_hi:[1,1,0]
v_fma_mix_f32 v162, v146, v146, v162 op_sel:[1,1,0] op_sel_hi:[1,1,0]
v_lshlrev_b32 v252, 7, v251
s_add_u32 s46, s47, 2359296
s_mov_b32 exec_lo, 4294836224
s_mov_b32 exec_hi, 3
s_mov_b32 m0, 16220
s_nop 0
buffer_load_dword v252, s[4:7], s46 offen lds
s_mov_b64 exec, -1
s_setprio 2
v_smfmac_f32_16x16x32_bf16 v[24:27], v[216:217], v[208:211], v246
ds_read_b128 v[236:239], v249 offset:2048
ds_read_u16_d16_hi v143, v143
v_cvt_pkrtz_f16_f32 v179, v120, v121
v_cvt_pkrtz_f16_f32 v181, v122, v123
v_cvt_pkrtz_f16_f32 v183, v124, v125
v_cvt_pkrtz_f16_f32 v185, v126, v127
v_smfmac_f32_16x16x32_bf16 v[40:43], v[218:219], v[212:215], v246
v_cvt_pkrtz_f16_f32 v187, v128, v129
v_cvt_pk_f16_f32 v155, v130, v131
v_cvt_pk_f16_f32 v152, v132, v133
v_cvt_pk_f16_f32 v149, v134, v135
v_pk_fma_f16 v154, v155, v155, s48
s_waitcnt lgkmcnt(2)
v_mfma_f32_32x32x16_bf16 v[120:135], v[72:75], v[220:223], 0
ds_read_b128 v[216:219], v249 offset:5120
v_and_b32 v179, s49, v179
v_fma_mix_f32 v162, v136, v136, v162 op_sel:[0,0,0] op_sel_hi:[1,1,0]
v_pk_fma_f16 v151, v152, v152, s48
v_pk_fma_f16 v148, v149, v149, s48
v_lshrrev_b16 v178, 2, v179
v_pk_mul_f16 v154, v155, v154
v_pk_mul_f16 v151, v152, v151
v_pk_mul_f16 v148, v149, v148
v_lshrrev_b32 v179, 18, v179
v_mfma_f32_32x32x16_bf16 v[120:135], v[76:79], v[224:227], v[120:135]
ds_read_b128 v[220:223], v245 offset:5760
v_xor_b32 v243, 16, v243
ds_read_b128 v[192:195], v243
ds_read_b128 v[196:199], v243 offset:64
ds_read_u16_d16 v178, v178
ds_read_u16_d16_hi v179, v179
v_fma_mix_f32 v162, v137, v137, v162 op_sel:[1,1,0] op_sel_hi:[1,1,0]
v_exp_f16 v153, v154
v_and_b32 v181, s49, v181
v_exp_f16 v150, v151
v_exp_f16 v147, v148
v_lshrrev_b16 v180, 2, v181
v_mfma_f32_32x32x16_bf16 v[120:135], v[80:83], v[228:231], v[120:135]
ds_read_b128 v[224:227], v245 offset:6144
ds_read_b128 v[200:203], v243 offset:128
v_xor_b32 v244, 16, v244
ds_read_b128 v[204:207], v244
ds_read_u16_d16 v180, v180
v_fma_mix_f32 v162, v138, v138, v162 op_sel:[0,0,0] op_sel_hi:[1,1,0]
v_exp_f16_sdwa v153, v154 dst_sel:WORD_1 dst_unused:UNUSED_PRESERVE src0_sel:WORD_1
v_lshrrev_b32 v181, 18, v181
v_exp_f16_sdwa v150, v151 dst_sel:WORD_1 dst_unused:UNUSED_PRESERVE src0_sel:WORD_1
v_fma_mix_f32 v162, v139, v139, v162 op_sel:[1,1,0] op_sel_hi:[1,1,0]
v_and_b32 v183, s49, v183
v_mfma_f32_32x32x16_bf16 v[120:135], v[84:87], v[232:235], v[120:135]
ds_read_b128 v[228:231], v249 offset:6144
ds_read_u16_d16_hi v181, v181
v_exp_f16_sdwa v147, v148 dst_sel:WORD_1 dst_unused:UNUSED_PRESERVE src0_sel:WORD_1
v_pk_add_f16 v153, v153, 1.0 op_sel_hi:[1,0]
v_lshrrev_b16 v182, 2, v183
v_pk_add_f16 v150, v150, 1.0 op_sel_hi:[1,0]
v_pk_add_f16 v147, v147, 1.0 op_sel_hi:[1,0]
v_rcp_f16 v154, v153
v_lshrrev_b32 v183, 18, v183
v_fma_mix_f32 v162, v140, v140, v162 op_sel:[0,0,0] op_sel_hi:[1,1,0]
s_waitcnt lgkmcnt(6)
v_mfma_f32_32x32x16_bf16 v[120:135], v[88:91], v[236:239], v[120:135]
ds_read_b128 v[232:235], v249 offset:9216
ds_read_u16_d16 v182, v182
ds_read_u16_d16_hi v183, v183
v_rcp_f16 v151, v150
v_and_b32 v185, s49, v185
v_rcp_f16 v148, v147
v_fma_mix_f32 v162, v141, v141, v162 op_sel:[1,1,0] op_sel_hi:[1,1,0]
v_lshrrev_b16 v184, 2, v185
v_rcp_f16_sdwa v154, v153 dst_sel:WORD_1 dst_unused:UNUSED_PRESERVE src0_sel:WORD_1
v_mfma_f32_32x32x16_bf16 v[120:135], v[92:95], v[216:219], v[120:135]
ds_read_b128 v[236:239], v249 offset:7168
ds_read_u16_d16 v184, v184
v_rcp_f16_sdwa v151, v150 dst_sel:WORD_1 dst_unused:UNUSED_PRESERVE src0_sel:WORD_1
v_lshrrev_b32 v185, 18, v185
v_rcp_f16_sdwa v148, v147 dst_sel:WORD_1 dst_unused:UNUSED_PRESERVE src0_sel:WORD_1
v_and_b32 v187, s49, v187
v_fma_mix_f32 v162, v142, v142, v162 op_sel:[0,0,0] op_sel_hi:[1,1,0]
v_pk_mul_f16 v155, v155, v154
v_pk_mul_f16 v152, v152, v151
v_smfmac_f32_16x16x32_bf16 v[8:11], v[220:221], v[192:195], v246
ds_read_b128 v[216:219], v249 offset:10240
ds_read_u16_d16_hi v185, v185
v_lshrrev_b16 v186, 2, v187
v_pk_mul_f16 v149, v149, v148
v_fma_mix_f32 v163, v155, v155, v163 op_sel:[0,0,0] op_sel_hi:[1,1,0]
v_fma_mix_f32 v162, v143, v143, v162 op_sel:[1,1,0] op_sel_hi:[1,1,0]
v_lshrrev_b32 v187, 18, v187
v_smfmac_f32_16x16x32_bf16 v[24:27], v[222:223], v[196:199], v246
v_fma_mix_f32 v163, v155, v155, v163 op_sel:[1,1,0] op_sel_hi:[1,1,0]
v_fma_mix_f32 v163, v152, v152, v163 op_sel:[0,0,0] op_sel_hi:[1,1,0]
v_fma_mix_f32 v163, v152, v152, v163 op_sel:[1,1,0] op_sel_hi:[1,1,0]
v_fma_mix_f32 v163, v149, v149, v163 op_sel:[0,0,0] op_sel_hi:[1,1,0]
v_fma_mix_f32 v163, v149, v149, v163 op_sel:[1,1,0] op_sel_hi:[1,1,0]
v_lshlrev_b32 v252, 7, v251
s_add_u32 s46, s47, 2359296
s_mov_b32 exec_lo, 0
s_mov_b32 exec_hi, 1048572
s_mov_b32 m0, 16152
s_nop 0
buffer_load_dword v252, s[4:7], s46 offen lds
s_mov_b64 exec, -1
s_setprio 1
s_waitcnt lgkmcnt(2)
v_smfmac_f32_16x16x32_bf16 v[40:43], v[224:225], v[200:203], v246
ds_read_b128 v[220:223], v249 offset:8192
ds_read_u16_d16 v186, v186
ds_read_u16_d16_hi v187, v187
v_cvt_pkrtz_f16_f32 v137, v120, v121
v_cvt_pkrtz_f16_f32 v139, v122, v123
v_cvt_pkrtz_f16_f32 v141, v124, v125
v_cvt_pkrtz_f16_f32 v143, v126, v127
v_smfmac_f32_16x16x32_bf16 v[8:11], v[226:227], v[204:207], v246
v_cvt_pk_f16_f32 v155, v128, v129
v_cvt_pk_f16_f32 v152, v130, v131
v_cvt_pk_f16_f32 v149, v132, v133
v_cvt_pk_f16_f32 v146, v134, v135
v_pk_fma_f16 v154, v155, v155, s48
v_mfma_f32_32x32x16_bf16 v[120:135], v[72:75], v[228:231], 0
ds_read_b128 v[224:227], v249 offset:11264
v_and_b32 v137, s49, v137
v_fma_mix_f32 v163, v178, v178, v163 op_sel:[0,0,0] op_sel_hi:[1,1,0]
v_pk_fma_f16 v151, v152, v152, s48
v_pk_fma_f16 v148, v149, v149, s48
v_pk_fma_f16 v145, v146, v146, s48
v_pk_mul_f16 v154, v155, v154
v_lshrrev_b16 v136, 2, v137
v_pk_mul_f16 v151, v152, v151
v_fma_mix_f32 v163, v179, v179, v163 op_sel:[1,1,0] op_sel_hi:[1,1,0]
v_pk_mul_f16 v148, v149, v148
v_mfma_f32_32x32x16_bf16 v[120:135], v[76:79], v[232:235], v[120:135]
ds_read_b128 v[228:231], v245 offset:6528
ds_read_b128 v[208:211], v244 offset:64
ds_read_b128 v[212:215], v244 offset:128
ds_read_u16_d16 v136, v136
v_pk_mul_f16 v145, v146, v145
v_exp_f16 v153, v154
v_lshrrev_b32 v137, 18, v137
v_exp_f16 v150, v151
v_fma_mix_f32 v163, v180, v180, v163 op_sel:[0,0,0] op_sel_hi:[1,1,0]
v_exp_f16 v147, v148
v_and_b32 v139, s49, v139
v_mfma_f32_32x32x16_bf16 v[120:135], v[80:83], v[236:239], v[120:135]
ds_read_b128 v[232:235], v249 offset:12288
ds_read_u16_d16_hi v137, v137
v_exp_f16 v144, v145
v_exp_f16_sdwa v153, v154 dst_sel:WORD_1 dst_unused:UNUSED_PRESERVE src0_sel:WORD_1
v_fma_mix_f32 v163, v181, v181, v163 op_sel:[1,1,0] op_sel_hi:[1,1,0]
v_lshrrev_b16 v138, 2, v139
v_exp_f16_sdwa v150, v151 dst_sel:WORD_1 dst_unused:UNUSED_PRESERVE src0_sel:WORD_1
v_exp_f16_sdwa v147, v148 dst_sel:WORD_1 dst_unused:UNUSED_PRESERVE src0_sel:WORD_1
s_waitcnt lgkmcnt(6)
v_mfma_f32_32x32x16_bf16 v[120:135], v[84:87], v[216:219], v[120:135]
ds_read_b128 v[236:239], v249 offset:15360
ds_read_u16_d16 v138, v138
v_exp_f16_sdwa v144, v145 dst_sel:WORD_1 dst_unused:UNUSED_PRESERVE src0_sel:WORD_1
v_lshrrev_b32 v139, 18, v139
v_fma_mix_f32 v163, v182, v182, v163 op_sel:[0,0,0] op_sel_hi:[1,1,0]
v_pk_add_f16 v153, v153, 1.0 op_sel_hi:[1,0]
v_pk_add_f16 v150, v150, 1.0 op_sel_hi:[1,0]
v_pk_add_f16 v147, v147, 1.0 op_sel_hi:[1,0]
v_and_b32 v141, s49, v141
v_pk_add_f16 v144, v144, 1.0 op_sel_hi:[1,0]
v_mfma_f32_32x32x16_bf16 v[120:135], v[88:91], v[220:223], v[120:135]
ds_read_b128 v[216:219], v249 offset:13312
ds_read_u16_d16_hi v139, v139
v_rcp_f16 v154, v153
v_fma_mix_f32 v163, v183, v183, v163 op_sel:[1,1,0] op_sel_hi:[1,1,0]
v_rcp_f16 v151, v150
v_lshrrev_b16 v140, 2, v141
v_rcp_f16 v148, v147
v_fma_mix_f32 v163, v184, v184, v163 op_sel:[0,0,0] op_sel_hi:[1,1,0]
v_mfma_f32_32x32x16_bf16 v[120:135], v[92:95], v[224:227], v[120:135]
ds_read_b128 v[220:223], v249 offset:16384
ds_read_u16_d16 v140, v140
v_rcp_f16 v145, v144
v_lshrrev_b32 v141, 18, v141
v_rcp_f16_sdwa v154, v153 dst_sel:WORD_1 dst_unused:UNUSED_PRESERVE src0_sel:WORD_1
s_setprio 0
v_rcp_f16_sdwa v151, v150 dst_sel:WORD_1 dst_unused:UNUSED_PRESERVE src0_sel:WORD_1
v_fma_mix_f32 v163, v185, v185, v163 op_sel:[1,1,0] op_sel_hi:[1,1,0]
v_and_b32 v143, s49, v143
v_rcp_f16_sdwa v148, v147 dst_sel:WORD_1 dst_unused:UNUSED_PRESERVE src0_sel:WORD_1
s_waitcnt lgkmcnt(4)
v_smfmac_f32_16x16x32_bf16 v[24:27], v[228:229], v[208:211], v246
ds_read_b128 v[224:227], v249 offset:14336
ds_read_u16_d16_hi v141, v141
v_rcp_f16_sdwa v145, v144 dst_sel:WORD_1 dst_unused:UNUSED_PRESERVE src0_sel:WORD_1
v_pk_mul_f16 v155, v155, v154
v_lshrrev_b16 v142, 2, v143
v_fma_mix_f32 v163, v186, v186, v163 op_sel:[0,0,0] op_sel_hi:[1,1,0]
v_smfmac_f32_16x16x32_bf16 v[40:43], v[230:231], v[212:215], v246
s_mov_b64 exec, 1
ds_add_u32 v253, v254 offset:16
s_mov_b64 exec, -1
v_pk_mul_f16 v152, v152, v151
v_pk_mul_f16 v149, v149, v148
v_pk_mul_f16 v146, v146, v145
v_fma_mix_f32 v164, v155, v155, v164 op_sel:[0,0,0] op_sel_hi:[1,1,0]
v_lshrrev_b32 v143, 18, v143
v_fma_mix_f32 v164, v155, v155, v164 op_sel:[1,1,0] op_sel_hi:[1,1,0]
v_fma_mix_f32 v164, v152, v152, v164 op_sel:[0,0,0] op_sel_hi:[1,1,0]
v_fma_mix_f32 v163, v187, v187, v163 op_sel:[1,1,0] op_sel_hi:[1,1,0]
v_fma_mix_f32 v164, v152, v152, v164 op_sel:[1,1,0] op_sel_hi:[1,1,0]
v_fma_mix_f32 v164, v149, v149, v164 op_sel:[0,0,0] op_sel_hi:[1,1,0]
v_fma_mix_f32 v164, v149, v149, v164 op_sel:[1,1,0] op_sel_hi:[1,1,0]
v_fma_mix_f32 v164, v146, v146, v164 op_sel:[0,0,0] op_sel_hi:[1,1,0]
v_fma_mix_f32 v164, v146, v146, v164 op_sel:[1,1,0] op_sel_hi:[1,1,0]
s_setprio 3
v_pk_add_f32 v[168:169], v[0:1], v[2:3]
v_pk_mul_f32 v[170:171], v[0:1], v[0:1]
v_pk_fma_f32 v[170:171], v[2:3], v[2:3], v[170:171]
v_pk_add_f32 v[168:169], v[168:169], v[4:5]
v_pk_fma_f32 v[170:171], v[4:5], v[4:5], v[170:171]
v_pk_add_f32 v[168:169], v[168:169], v[6:7]
v_pk_fma_f32 v[170:171], v[6:7], v[6:7], v[170:171]
v_pk_add_f32 v[168:169], v[168:169], v[8:9]
v_pk_fma_f32 v[170:171], v[8:9], v[8:9], v[170:171]
v_pk_add_f32 v[168:169], v[168:169], v[10:11]
v_pk_fma_f32 v[170:171], v[10:11], v[10:11], v[170:171]
v_pk_add_f32 v[168:169], v[168:169], v[12:13]
v_pk_fma_f32 v[170:171], v[12:13], v[12:13], v[170:171]
v_pk_add_f32 v[168:169], v[168:169], v[14:15]
v_pk_fma_f32 v[170:171], v[14:15], v[14:15], v[170:171]
v_pk_add_f32 v[168:169], v[168:169], v[16:17]
v_pk_fma_f32 v[170:171], v[16:17], v[16:17], v[170:171]
v_pk_add_f32 v[168:169], v[168:169], v[18:19]
v_pk_fma_f32 v[170:171], v[18:19], v[18:19], v[170:171]
v_pk_add_f32 v[168:169], v[168:169], v[20:21]
v_pk_fma_f32 v[170:171], v[20:21], v[20:21], v[170:171]
v_pk_add_f32 v[168:169], v[168:169], v[22:23]
v_pk_fma_f32 v[170:171], v[22:23], v[22:23], v[170:171]
v_pk_add_f32 v[168:169], v[168:169], v[24:25]
v_pk_fma_f32 v[170:171], v[24:25], v[24:25], v[170:171]
v_pk_add_f32 v[168:169], v[168:169], v[26:27]
v_pk_fma_f32 v[170:171], v[26:27], v[26:27], v[170:171]
v_pk_add_f32 v[168:169], v[168:169], v[28:29]
v_pk_fma_f32 v[170:171], v[28:29], v[28:29], v[170:171]
v_pk_add_f32 v[168:169], v[168:169], v[30:31]
v_pk_fma_f32 v[170:171], v[30:31], v[30:31], v[170:171]
v_pk_add_f32 v[168:169], v[168:169], v[32:33]
v_pk_fma_f32 v[170:171], v[32:33], v[32:33], v[170:171]
v_pk_add_f32 v[168:169], v[168:169], v[34:35]
v_pk_fma_f32 v[170:171], v[34:35], v[34:35], v[170:171]
v_pk_add_f32 v[168:169], v[168:169], v[36:37]
v_pk_fma_f32 v[170:171], v[36:37], v[36:37], v[170:171]
v_pk_add_f32 v[168:169], v[168:169], v[38:39]
v_pk_fma_f32 v[170:171], v[38:39], v[38:39], v[170:171]
v_pk_add_f32 v[168:169], v[168:169], v[40:41]
v_pk_fma_f32 v[170:171], v[40:41], v[40:41], v[170:171]
v_pk_add_f32 v[168:169], v[168:169], v[42:43]
v_pk_fma_f32 v[170:171], v[42:43], v[42:43], v[170:171]
v_pk_add_f32 v[168:169], v[168:169], v[44:45]
v_pk_fma_f32 v[170:171], v[44:45], v[44:45], v[170:171]
v_pk_add_f32 v[168:169], v[168:169], v[46:47]
v_pk_fma_f32 v[170:171], v[46:47], v[46:47], v[170:171]
s_setprio 0
v_add_u32 v174, -36864, v242
v_subrev_u32 v175, 66560, v174
v_min_u32 v174, v174, v175
v_add_u32 v174, 90112, v174
v_sub_u32 v175, v174, v242
v_add_u32 v242, v175, v242
v_add_u32 v243, v175, v243
v_add_u32 v244, v175, v244
s_setprio 2
v_cvt_pkrtz_f16_f32 v179, v120, v121
v_cvt_pkrtz_f16_f32 v181, v122, v123
v_cvt_pkrtz_f16_f32 v183, v124, v125
v_cvt_pkrtz_f16_f32 v185, v126, v127
v_cvt_pkrtz_f16_f32 v187, v128, v129
v_cvt_pkrtz_f16_f32 v189, v130, v131
v_cvt_pk_f16_f32 v155, v132, v133
v_cvt_pk_f16_f32 v152, v134, v135
ds_read_b128 v[228:231], v249 offset:17408
ds_read_u16_d16 v142, v142
ds_read_u16_d16_hi v143, v143
v_mfma_f32_32x32x16_bf16 v[120:135], v[72:75], v[232:235], 0
v_pk_fma_f16 v154, v155, v155, s48
v_add_f32 v168, v168, v169
v_and_b32 v179, s49, v179
v_fma_mix_f32 v164, v136, v136, v164 op_sel:[0,0,0] op_sel_hi:[1,1,0]
v_lshrrev_b16 v178, 2, v179
v_add_f32 v170, v170, v171
v_pk_fma_f16 v151, v152, v152, s48
v_pk_mul_f16 v154, v155, v154
v_lshrrev_b32 v179, 18, v179
v_pk_mul_f16 v151, v152, v151
ds_read_b128 v[232:235], v249 offset:18432
ds_read_u16_d16 v178, v178
ds_read_u16_d16_hi v179, v179
v_mfma_f32_32x32x16_bf16 v[120:135], v[76:79], v[236:239], v[120:135]
v_permlane32_swap_b32 v168, v170
v_fma_mix_f32 v164, v137, v137, v164 op_sel:[1,1,0] op_sel_hi:[1,1,0]
v_and_b32 v181, s49, v181
v_exp_f16 v153, v154
v_add_f32 v168, v168, v170
v_lshrrev_b16 v180, 2, v181
v_exp_f16 v150, v151
v_lshrrev_b32 v181, 18, v181
s_waitcnt lgkmcnt(7)
ds_read_b128 v[236:239], v249 offset:21504
ds_read_u16_d16 v180, v180
ds_read_u16_d16_hi v181, v181
v_mfma_f32_32x32x16_bf16 v[120:135], v[80:83], v[216:219], v[120:135]
v_mul_f32 v168, 1009429163, v168
v_fma_mix_f32 v164, v138, v138, v164 op_sel:[0,0,0] op_sel_hi:[1,1,0]
v_exp_f16_sdwa v153, v154 dst_sel:WORD_1 dst_unused:UNUSED_PRESERVE src0_sel:WORD_1
v_and_b32 v183, s49, v183
v_mov_b32 v170, v168
v_exp_f16_sdwa v150, v151 dst_sel:WORD_1 dst_unused:UNUSED_PRESERVE src0_sel:WORD_1
v_lshrrev_b16 v182, 2, v183
v_fma_mix_f32 v164, v139, v139, v164 op_sel:[1,1,0] op_sel_hi:[1,1,0]
v_permlane32_swap_b32 v168, v170
ds_read_b128 v[216:219], v249 offset:19456
ds_read_u16_d16 v182, v182
v_mfma_f32_32x32x16_bf16 v[120:135], v[84:87], v[220:223], v[120:135]
v_lshrrev_b32 v183, 18, v183
v_pk_add_f16 v153, v153, 1.0 op_sel_hi:[1,0]
v_pk_add_f16 v150, v150, 1.0 op_sel_hi:[1,0]
v_and_b32 v185, s49, v185
v_fma_f32 v170, -v168, v168, v170
v_rcp_f16 v154, v153
v_lshrrev_b16 v184, 2, v185
v_max_f32 v170, 0, v170
v_fma_mix_f32 v164, v140, v140, v164 op_sel:[0,0,0] op_sel_hi:[1,1,0]
ds_read_b128 v[220:223], v249 offset:22528
ds_read_u16_d16_hi v183, v183
ds_read_u16_d16 v184, v184
v_mfma_f32_32x32x16_bf16 v[120:135], v[88:91], v[224:227], v[120:135]
v_lshrrev_b32 v185, 18, v185
v_rcp_f16 v151, v150
v_add_f32 v170, 925353388, v170
v_and_b32 v187, s49, v187
v_fma_mix_f32 v164, v141, v141, v164 op_sel:[1,1,0] op_sel_hi:[1,1,0]
v_rcp_f16_sdwa v154, v153 dst_sel:WORD_1 dst_unused:UNUSED_PRESERVE src0_sel:WORD_1
v_rsq_f32 v170, v170
s_waitcnt lgkmcnt(5)
ds_read_b128 v[224:227], v249 offset:20480
ds_read_u16_d16_hi v185, v185
ds_read_b32 v247, v253 offset:16
v_mfma_f32_32x32x16_bf16 v[120:135], v[92:95], v[228:231], v[120:135]
v_lshrrev_b16 v186, 2, v187
v_rcp_f16_sdwa v151, v150 dst_sel:WORD_1 dst_unused:UNUSED_PRESERVE src0_sel:WORD_1
v_lshrrev_b32 v187, 18, v187
v_fma_mix_f32 v164, v142, v142, v164 op_sel:[0,0,0] op_sel_hi:[1,1,0]
v_and_b32 v189, s49, v189
v_pk_mul_f16 v155, v155, v154
v_pk_mul_f16 v152, v152, v151
v_mul_f32 v172, 3203391086, v170
v_lshrrev_b16 v188, 2, v189
v_fma_mix_f32 v165, v155, v155, v165 op_sel:[0,0,0] op_sel_hi:[1,1,0]
v_fma_mix_f32 v164, v143, v143, v164 op_sel:[1,1,0] op_sel_hi:[1,1,0]
v_lshrrev_b32 v189, 18, v189
v_mul_f32 v173, v168, v172
v_fma_mix_f32 v165, v155, v155, v165 op_sel:[1,1,0] op_sel_hi:[1,1,0]
v_fma_mix_f32 v165, v152, v152, v165 op_sel:[0,0,0] op_sel_hi:[1,1,0]
v_fma_mix_f32 v165, v152, v152, v165 op_sel:[1,1,0] op_sel_hi:[1,1,0]
s_setprio 3
v_pk_fma_f32 v[0:1], v[0:1], v[172:173], v[172:173] op_sel:[0,0,1] op_sel_hi:[1,0,1] neg_lo:[0,0,1] neg_hi:[0,0,1]
v_pk_fma_f32 v[2:3], v[2:3], v[172:173], v[172:173] op_sel:[0,0,1] op_sel_hi:[1,0,1] neg_lo:[0,0,1] neg_hi:[0,0,1]
v_pk_fma_f32 v[4:5], v[4:5], v[172:173], v[172:173] op_sel:[0,0,1] op_sel_hi:[1,0,1] neg_lo:[0,0,1] neg_hi:[0,0,1]
v_pk_fma_f32 v[6:7], v[6:7], v[172:173], v[172:173] op_sel:[0,0,1] op_sel_hi:[1,0,1] neg_lo:[0,0,1] neg_hi:[0,0,1]
v_pk_fma_f32 v[8:9], v[8:9], v[172:173], v[172:173] op_sel:[0,0,1] op_sel_hi:[1,0,1] neg_lo:[0,0,1] neg_hi:[0,0,1]
v_pk_fma_f32 v[10:11], v[10:11], v[172:173], v[172:173] op_sel:[0,0,1] op_sel_hi:[1,0,1] neg_lo:[0,0,1] neg_hi:[0,0,1]
v_pk_fma_f32 v[12:13], v[12:13], v[172:173], v[172:173] op_sel:[0,0,1] op_sel_hi:[1,0,1] neg_lo:[0,0,1] neg_hi:[0,0,1]
v_pk_fma_f32 v[14:15], v[14:15], v[172:173], v[172:173] op_sel:[0,0,1] op_sel_hi:[1,0,1] neg_lo:[0,0,1] neg_hi:[0,0,1]
v_pk_fma_f32 v[16:17], v[16:17], v[172:173], v[172:173] op_sel:[0,0,1] op_sel_hi:[1,0,1] neg_lo:[0,0,1] neg_hi:[0,0,1]
v_pk_fma_f32 v[18:19], v[18:19], v[172:173], v[172:173] op_sel:[0,0,1] op_sel_hi:[1,0,1] neg_lo:[0,0,1] neg_hi:[0,0,1]
v_pk_fma_f32 v[20:21], v[20:21], v[172:173], v[172:173] op_sel:[0,0,1] op_sel_hi:[1,0,1] neg_lo:[0,0,1] neg_hi:[0,0,1]
v_pk_fma_f32 v[22:23], v[22:23], v[172:173], v[172:173] op_sel:[0,0,1] op_sel_hi:[1,0,1] neg_lo:[0,0,1] neg_hi:[0,0,1]
v_pk_fma_f32 v[24:25], v[24:25], v[172:173], v[172:173] op_sel:[0,0,1] op_sel_hi:[1,0,1] neg_lo:[0,0,1] neg_hi:[0,0,1]
v_pk_fma_f32 v[26:27], v[26:27], v[172:173], v[172:173] op_sel:[0,0,1] op_sel_hi:[1,0,1] neg_lo:[0,0,1] neg_hi:[0,0,1]
v_pk_fma_f32 v[28:29], v[28:29], v[172:173], v[172:173] op_sel:[0,0,1] op_sel_hi:[1,0,1] neg_lo:[0,0,1] neg_hi:[0,0,1]
v_pk_fma_f32 v[30:31], v[30:31], v[172:173], v[172:173] op_sel:[0,0,1] op_sel_hi:[1,0,1] neg_lo:[0,0,1] neg_hi:[0,0,1]
v_pk_fma_f32 v[32:33], v[32:33], v[172:173], v[172:173] op_sel:[0,0,1] op_sel_hi:[1,0,1] neg_lo:[0,0,1] neg_hi:[0,0,1]
v_pk_fma_f32 v[34:35], v[34:35], v[172:173], v[172:173] op_sel:[0,0,1] op_sel_hi:[1,0,1] neg_lo:[0,0,1] neg_hi:[0,0,1]
v_pk_fma_f32 v[36:37], v[36:37], v[172:173], v[172:173] op_sel:[0,0,1] op_sel_hi:[1,0,1] neg_lo:[0,0,1] neg_hi:[0,0,1]
v_pk_fma_f32 v[38:39], v[38:39], v[172:173], v[172:173] op_sel:[0,0,1] op_sel_hi:[1,0,1] neg_lo:[0,0,1] neg_hi:[0,0,1]
v_pk_fma_f32 v[40:41], v[40:41], v[172:173], v[172:173] op_sel:[0,0,1] op_sel_hi:[1,0,1] neg_lo:[0,0,1] neg_hi:[0,0,1]
v_pk_fma_f32 v[42:43], v[42:43], v[172:173], v[172:173] op_sel:[0,0,1] op_sel_hi:[1,0,1] neg_lo:[0,0,1] neg_hi:[0,0,1]
v_pk_fma_f32 v[44:45], v[44:45], v[172:173], v[172:173] op_sel:[0,0,1] op_sel_hi:[1,0,1] neg_lo:[0,0,1] neg_hi:[0,0,1]
v_pk_fma_f32 v[46:47], v[46:47], v[172:173], v[172:173] op_sel:[0,0,1] op_sel_hi:[1,0,1] neg_lo:[0,0,1] neg_hi:[0,0,1]
s_setprio 2
ds_read_u16_d16 v186, v186
ds_read_u16_d16_hi v187, v187
ds_read_u16_d16 v188, v188
ds_read_u16_d16_hi v189, v189
s_waitcnt lgkmcnt(4)
v_readfirstlane_b32 s43, v247
s_nop 1
s_cmp_ge_u32 s43, 24
s_cbranch_scc1 Lev7
Lev7w:
s_sleep 1
ds_read_b32 v247, v253 offset:16
s_waitcnt lgkmcnt(0)
v_readfirstlane_b32 s43, v247
s_cmp_eq_u32 s76, 0
s_cbranch_scc1 Lev7
s_sub_u32 s76, s76, 1
s_cmp_lt_u32 s43, 24
s_cbranch_scc1 Lev7w
Lev7:
s_setprio 1
v_cvt_pkrtz_f16_f32 v137, v120, v121
v_cvt_pkrtz_f16_f32 v139, v122, v123
v_cvt_pkrtz_f16_f32 v141, v124, v125
v_cvt_pkrtz_f16_f32 v143, v126, v127
v_cvt_pkrtz_f16_f32 v177, v128, v129
v_cvt_pkrtz_f16_f32 v191, v130, v131
v_cvt_pk_f16_f32 v155, v132, v133
v_cvt_pk_f16_f32 v152, v134, v135
s_add_u32 m0, s67, 39936
s_add_u32 s66, s66, 98304
buffer_load_dwordx4 v240, s[4:7], s66 offen lds
ds_read_b128 v[228:231], v249 offset:23552
v_mfma_f32_32x32x16_bf16 v[120:135], v[72:75], v[232:235], 0
v_pk_fma_f16 v154, v155, v155, s48
v_cvt_pk_bf16_f32 v96, v0, v1
v_and_b32 v137, s49, v137
v_fma_mix_f32 v165, v178, v178, v165 op_sel:[0,0,0] op_sel_hi:[1,1,0]
v_cvt_pk_bf16_f32 v97, v2, v3
v_pk_fma_f16 v151, v152, v152, s48
v_lshrrev_b16 v136, 2, v137
v_cvt_pk_bf16_f32 v98, v4, v5
v_pk_mul_f16 v154, v155, v154
v_fma_mix_f32 v165, v179, v179, v165 op_sel:[1,1,0] op_sel_hi:[1,1,0]
v_lshrrev_b32 v137, 18, v137
v_cvt_pk_bf16_f32 v99, v6, v7
s_add_u32 m0, s67, 46592
s_add_u32 s66, s66, 98304
buffer_load_dwordx4 v240, s[4:7], s66 offen lds
ds_read_b128 v[232:235], v248 offset:16384
ds_read_u16_d16 v136, v136
ds_read_u16_d16_hi v137, v137
v_mfma_f32_32x32x16_bf16 v[120:135], v[76:79], v[236:239], v[120:135]
v_pk_mul_f16 v151, v152, v151
v_exp_f16 v153, v154
v_cvt_pk_bf16_f32 v100, v8, v9
v_and_b32 v139, s49, v139
v_fma_mix_f32 v165, v180, v180, v165 op_sel:[0,0,0] op_sel_hi:[1,1,0]
v_cvt_pk_bf16_f32 v101, v10, v11
v_lshrrev_b16 v138, 2, v139
v_exp_f16 v150, v151
v_cvt_pk_bf16_f32 v102, v12, v13
v_lshrrev_b32 v139, 18, v139
v_cvt_pk_bf16_f32 v103, v14, v15
s_add_u32 m0, s67, 53248
s_add_u32 s66, s66, 98304
buffer_load_dwordx4 v240, s[4:7], s66 offen lds
ds_read_b128 v[236:239], v248 offset:19456
ds_read_u16_d16 v138, v138
ds_read_u16_d16_hi v139, v139
v_mfma_f32_32x32x16_bf16 v[120:135], v[80:83], v[216:219], v[120:135]
v_fma_mix_f32 v165, v181, v181, v165 op_sel:[1,1,0] op_sel_hi:[1,1,0]
v_exp_f16_sdwa v153, v154 dst_sel:WORD_1 dst_unused:UNUSED_PRESERVE src0_sel:WORD_1
v_cvt_pk_bf16_f32 v104, v16, v17
v_and_b32 v141, s49, v141
v_fma_mix_f32 v165, v182, v182, v165 op_sel:[0,0,0] op_sel_hi:[1,1,0]
v_cvt_pk_bf16_f32 v105, v18, v19
v_lshrrev_b16 v140, 2, v141
v_exp_f16_sdwa v150, v151 dst_sel:WORD_1 dst_unused:UNUSED_PRESERVE src0_sel:WORD_1
v_cvt_pk_bf16_f32 v106, v20, v21
v_lshrrev_b32 v141, 18, v141
s_add_u32 m0, s67, 59904
s_add_u32 s66, s66, 98304
buffer_load_dwordx4 v240, s[4:7], s66 offen lds
s_add_u32 m0, s67, 0
s_add_u32 s66, s66, 98304
buffer_load_dwordx4 v240, s[4:7], s66 offen lds
ds_read_b128 v[216:219], v248 offset:17408
ds_read_u16_d16 v140, v140
ds_read_u16_d16_hi v141, v141
v_mfma_f32_32x32x16_bf16 v[120:135], v[84:87], v[220:223], v[120:135]
v_fma_mix_f32 v165, v183, v183, v165 op_sel:[1,1,0] op_sel_hi:[1,1,0]
v_cvt_pk_bf16_f32 v107, v22, v23
v_pk_add_f16 v153, v153, 1.0 op_sel_hi:[1,0]
v_pk_add_f16 v150, v150, 1.0 op_sel_hi:[1,0]
v_and_b32 v143, s49, v143
v_cvt_pk_bf16_f32 v108, v24, v25
v_rcp_f16 v154, v153
v_cvt_pk_bf16_f32 v109, v26, v27
v_lshrrev_b16 v142, 2, v143
v_fma_mix_f32 v165, v184, v184, v165 op_sel:[0,0,0] op_sel_hi:[1,1,0]
v_cvt_pk_bf16_f32 v110, v28, v29
s_add_u32 m0, s67, 6656
s_add_u32 s66, s66, 98304
buffer_load_dwordx4 v240, s[4:7], s66 offen lds
ds_read_b128 v[220:223], v248 offset:20480
ds_read_u16_d16 v142, v142
v_mfma_f32_32x32x16_bf16 v[120:135], v[88:91], v[224:227], v[120:135]
v_rcp_f16 v151, v150
v_lshrrev_b32 v143, 18, v143
v_cvt_pk_bf16_f32 v111, v30, v31
v_fma_mix_f32 v165, v185, v185, v165 op_sel:[1,1,0] op_sel_hi:[1,1,0]
v_and_b32 v177, s49, v177
s_setprio 0
v_cvt_pk_bf16_f32 v112, v32, v33
v_rcp_f16_sdwa v154, v153 dst_sel:WORD_1 dst_unused:UNUSED_PRESERVE src0_sel:WORD_1
v_lshrrev_b16 v176, 2, v177
v_cvt_pk_bf16_f32 v113, v34, v35
s_waitcnt lgkmcnt(2)
v_fma_mix_f32 v165, v186, v186, v165 op_sel:[0,0,0] op_sel_hi:[1,1,0]
v_rcp_f16_sdwa v151, v150 dst_sel:WORD_1 dst_unused:UNUSED_PRESERVE src0_sel:WORD_1
s_add_u32 m0, s67, 13312
s_add_u32 s66, s66, 98304
buffer_load_dwordx4 v240, s[4:7], s66 offen lds
ds_read_b128 v[224:227], v248 offset:18432
ds_read_u16_d16_hi v143, v143
ds_read_u16_d16 v176, v176
v_mfma_f32_32x32x16_bf16 v[120:135], v[92:95], v[228:231], v[120:135]
v_cvt_pk_bf16_f32 v114, v36, v37
v_lshrrev_b32 v177, 18, v177
v_cvt_pk_bf16_f32 v115, v38, v39
v_fma_mix_f32 v165, v187, v187, v165 op_sel:[1,1,0] op_sel_hi:[1,1,0]
v_and_b32 v191, s49, v191
v_pk_mul_f16 v155, v155, v154
v_cvt_pk_bf16_f32 v116, v40, v41
v_pk_mul_f16 v152, v152, v151
v_lshrrev_b16 v190, 2, v191
v_cvt_pk_bf16_f32 v117, v42, v43
v_fma_mix_f32 v165, v188, v188, v165 op_sel:[0,0,0] op_sel_hi:[1,1,0]
v_fma_mix_f32 v166, v155, v155, v166 op_sel:[0,0,0] op_sel_hi:[1,1,0]
s_add_u32 m0, s67, 19968
s_add_u32 s66, s66, 98304
buffer_load_dwordx4 v240, s[4:7], s66 offen lds
v_lshrrev_b32 v191, 18, v191
v_cvt_pk_bf16_f32 v118, v44, v45
v_fma_mix_f32 v166, v155, v155, v166 op_sel:[1,1,0] op_sel_hi:[1,1,0]
v_fma_mix_f32 v165, v189, v189, v165 op_sel:[1,1,0] op_sel_hi:[1,1,0]
v_cvt_pk_bf16_f32 v119, v46, v47
v_fma_mix_f32 v166, v152, v152, v166 op_sel:[0,0,0] op_sel_hi:[1,1,0]
v_fma_mix_f32 v166, v152, v152, v166 op_sel:[1,1,0] op_sel_hi:[1,1,0]
s_setprio 2
v_cvt_pkrtz_f16_f32 v179, v120, v121
v_cvt_pkrtz_f16_f32 v181, v122, v123
v_cvt_pkrtz_f16_f32 v183, v124, v125
v_cvt_pkrtz_f16_f32 v185, v126, v127
v_cvt_pkrtz_f16_f32 v187, v128, v129
v_cvt_pk_f16_f32 v155, v130, v131
v_cvt_pk_f16_f32 v152, v132, v133
v_cvt_pk_f16_f32 v149, v134, v135
ds_read_b128 v[228:231], v248 offset:21504
ds_read_u16_d16_hi v177, v177
ds_read_u16_d16 v190, v190
ds_read_u16_d16_hi v191, v191
v_mfma_f32_32x32x16_bf16 v[120:135], v[96:99], v[232:235], 0
v_pk_fma_f16 v154, v155, v155, s48
v_and_b32 v179, s49, v179
v_fma_mix_f32 v166, v136, v136, v166 op_sel:[0,0,0] op_sel_hi:[1,1,0]
v_pk_fma_f16 v151, v152, v152, s48
v_pk_fma_f16 v148, v149, v149, s48
v_lshrrev_b16 v178, 2, v179
v_pk_mul_f16 v154, v155, v154
v_fma_mix_f32 v166, v137, v137, v166 op_sel:[1,1,0] op_sel_hi:[1,1,0]
v_pk_mul_f16 v151, v152, v151
v_lshrrev_b32 v179, 18, v179
ds_read_b128 v[232:235], v248 offset:22528
ds_read_u16_d16 v178, v178
ds_read_u16_d16_hi v179, v179
v_mfma_f32_32x32x16_bf16 v[120:135], v[100:103], v[236:239], v[120:135]
v_pk_mul_f16 v148, v149, v148
v_exp_f16 v153, v154
v_fma_mix_f32 v166, v138, v138, v166 op_sel:[0,0,0] op_sel_hi:[1,1,0]
v_and_b32 v181, s49, v181
v_exp_f16 v150, v151
v_exp_f16 v147, v148
v_lshrrev_b16 v180, 2, v181
v_fma_mix_f32 v166, v139, v139, v166 op_sel:[1,1,0] op_sel_hi:[1,1,0]
ds_read_b128 v[236:239], v248 offset:25600
ds_read_u16_d16 v180, v180
v_mfma_f32_32x32x16_bf16 v[120:135], v[104:107], v[216:219], v[120:135]
v_exp_f16_sdwa v153, v154 dst_sel:WORD_1 dst_unused:UNUSED_PRESERVE src0_sel:WORD_1
v_lshrrev_b32 v181, 18, v181
v_exp_f16_sdwa v150, v151 dst_sel:WORD_1 dst_unused:UNUSED_PRESERVE src0_sel:WORD_1
v_fma_mix_f32 v166, v140, v140, v166 op_sel:[0,0,0] op_sel_hi:[1,1,0]
v_and_b32 v183, s49, v183
v_exp_f16_sdwa v147, v148 dst_sel:WORD_1 dst_unused:UNUSED_PRESERVE src0_sel:WORD_1
v_fma_mix_f32 v166, v141, v141, v166 op_sel:[1,1,0] op_sel_hi:[1,1,0]
s_waitcnt lgkmcnt(5)
ds_read_b128 v[216:219], v248 offset:23552
ds_read_u16_d16_hi v181, v181
v_mfma_f32_32x32x16_bf16 v[120:135], v[108:111], v[220:223], v[120:135]
v_pk_add_f16 v153, v153, 1.0 op_sel_hi:[1,0]
v_lshrrev_b16 v182, 2, v183
v_pk_add_f16 v150, v150, 1.0 op_sel_hi:[1,0]
v_pk_add_f16 v147, v147, 1.0 op_sel_hi:[1,0]
v_rcp_f16 v154, v153
v_lshrrev_b32 v183, 18, v183
v_fma_mix_f32 v166, v142, v142, v166 op_sel:[0,0,0] op_sel_hi:[1,1,0]
v_rcp_f16 v151, v150
v_and_b32 v185, s49, v185
ds_read_b128 v[220:223], v248 offset:26624
ds_read_u16_d16 v182, v182
ds_read_u16_d16_hi v183, v183
v_mfma_f32_32x32x16_bf16 v[120:135], v[112:115], v[224:227], v[120:135]
v_fma_mix_f32 v166, v143, v143, v166 op_sel:[1,1,0] op_sel_hi:[1,1,0]
v_rcp_f16 v148, v147
v_lshrrev_b16 v184, 2, v185
v_rcp_f16_sdwa v154, v153 dst_sel:WORD_1 dst_unused:UNUSED_PRESERVE src0_sel:WORD_1
v_fma_mix_f32 v166, v176, v176, v166 op_sel:[0,0,0] op_sel_hi:[1,1,0]
v_rcp_f16_sdwa v151, v150 dst_sel:WORD_1 dst_unused:UNUSED_PRESERVE src0_sel:WORD_1
v_lshrrev_b32 v185, 18, v185
ds_read_b128 v[224:227], v248 offset:24576
ds_read_u16_d16 v184, v184
ds_read_u16_d16_hi v185, v185
v_mfma_f32_32x32x16_bf16 v[120:135], v[116:119], v[228:231], v[120:135]
v_rcp_f16_sdwa v148, v147 dst_sel:WORD_1 dst_unused:UNUSED_PRESERVE src0_sel:WORD_1
s_cmp_eq_u32 s40, 7
s_cbranch_scc1 Lrdy24
s_waitcnt vmcnt(0)
Lrdy24:
s_mov_b64 exec, 1
ds_add_u32 v253, v254 offset:12
s_mov_b64 exec, -1
v_and_b32 v187, s49, v187
v_fma_mix_f32 v166, v177, v177, v166 op_sel:[1,1,0] op_sel_hi:[1,1,0]
v_pk_mul_f16 v155, v155, v154
v_pk_mul_f16 v152, v152, v151
v_pk_mul_f16 v149, v149, v148
v_lshrrev_b16 v186, 2, v187
v_fma_mix_f32 v166, v190, v190, v166 op_sel:[0,0,0] op_sel_hi:[1,1,0]
v_fma_mix_f32 v167, v155, v155, v167 op_sel:[0,0,0] op_sel_hi:[1,1,0]
v_fma_mix_f32 v167, v155, v155, v167 op_sel:[1,1,0] op_sel_hi:[1,1,0]
v_lshrrev_b32 v187, 18, v187
v_fma_mix_f32 v167, v152, v152, v167 op_sel:[0,0,0] op_sel_hi:[1,1,0]
v_fma_mix_f32 v166, v191, v191, v166 op_sel:[1,1,0] op_sel_hi:[1,1,0]
v_fma_mix_f32 v167, v152, v152, v167 op_sel:[1,1,0] op_sel_hi:[1,1,0]
v_fma_mix_f32 v167, v149, v149, v167 op_sel:[0,0,0] op_sel_hi:[1,1,0]
v_fma_mix_f32 v167, v149, v149, v167 op_sel:[1,1,0] op_sel_hi:[1,1,0]
s_cmp_lg_u32 s40, 7
s_cbranch_scc1 Lnoinit
s_waitcnt vmcnt(11)
v_mov_b32 v255, 1
s_mov_b64 exec, 1
buffer_atomic_add v255, v241, s[36:39], 0 offen
s_mov_b64 exec, -1
Lnoinit:
s_setprio 1
v_cvt_pkrtz_f16_f32 v137, v120, v121
v_cvt_pkrtz_f16_f32 v139, v122, v123
v_cvt_pkrtz_f16_f32 v141, v124, v125
v_cvt_pkrtz_f16_f32 v143, v126, v127
v_cvt_pkrtz_f16_f32 v177, v128, v129
v_cvt_pk_f16_f32 v155, v130, v131
v_cvt_pk_f16_f32 v152, v132, v133
v_cvt_pk_f16_f32 v149, v134, v135
s_waitcnt lgkmcnt(1)
s_add_u32 s46, s80, 12582912
buffer_store_dwordx4 v[72:75], v241, s[32:35], s46 offen sc1
ds_read_b128 v[228:231], v248 offset:27648
ds_read_u16_d16 v186, v186
ds_read_u16_d16_hi v187, v187
v_mfma_f32_32x32x16_bf16 v[120:135], v[96:99], v[232:235], 0
v_pk_fma_f16 v154, v155, v155, s48
v_and_b32 v137, s49, v137
v_fma_mix_f32 v167, v178, v178, v167 op_sel:[0,0,0] op_sel_hi:[1,1,0]
v_pk_fma_f16 v151, v152, v152, s48
v_pk_fma_f16 v148, v149, v149, s48
v_lshrrev_b16 v136, 2, v137
v_pk_mul_f16 v154, v155, v154
v_pk_mul_f16 v151, v152, v151
v_fma_mix_f32 v167, v179, v179, v167 op_sel:[1,1,0] op_sel_hi:[1,1,0]
v_lshrrev_b32 v137, 18, v137
ds_read_b128 v[232:235], v250 offset:65520
ds_read_u16_d16 v136, v136
ds_read_u16_d16_hi v137, v137
v_mfma_f32_32x32x16_bf16 v[120:135], v[100:103], v[236:239], v[120:135]
v_pk_mul_f16 v148, v149, v148
v_exp_f16 v153, v154
v_exp_f16 v150, v151
v_and_b32 v139, s49, v139
v_fma_mix_f32 v167, v180, v180, v167 op_sel:[0,0,0] op_sel_hi:[1,1,0]
v_exp_f16 v147, v148
v_lshrrev_b16 v138, 2, v139
ds_read_b128 v[236:239], v248 offset:28672
ds_read_b32 v247, v253 offset:12
ds_read_u16_d16 v138, v138
v_mfma_f32_32x32x16_bf16 v[120:135], v[104:107], v[216:219], v[120:135]
v_exp_f16_sdwa v153, v154 dst_sel:WORD_1 dst_unused:UNUSED_PRESERVE src0_sel:WORD_1
v_lshrrev_b32 v139, 18, v139
v_fma_mix_f32 v167, v181, v181, v167 op_sel:[1,1,0] op_sel_hi:[1,1,0]
v_exp_f16_sdwa v150, v151 dst_sel:WORD_1 dst_unused:UNUSED_PRESERVE src0_sel:WORD_1
v_exp_f16_sdwa v147, v148 dst_sel:WORD_1 dst_unused:UNUSED_PRESERVE src0_sel:WORD_1
v_and_b32 v141, s49, v141
v_fma_mix_f32 v167, v182, v182, v167 op_sel:[0,0,0] op_sel_hi:[1,1,0]
ds_read_b128 v[216:219], v248 offset:31744
ds_read_u16_d16_hi v139, v139
v_mfma_f32_32x32x16_bf16 v[120:135], v[108:111], v[220:223], v[120:135]
v_pk_add_f16 v153, v153, 1.0 op_sel_hi:[1,0]
v_lshrrev_b16 v140, 2, v141
v_pk_add_f16 v150, v150, 1.0 op_sel_hi:[1,0]
v_pk_add_f16 v147, v147, 1.0 op_sel_hi:[1,0]
v_rcp_f16 v154, v153
v_lshrrev_b32 v141, 18, v141
v_fma_mix_f32 v167, v183, v183, v167 op_sel:[1,1,0] op_sel_hi:[1,1,0]
ds_read_u16_d16 v140, v140
ds_read_u16_d16_hi v141, v141
s_waitcnt lgkmcnt(5)
v_readfirstlane_b32 s43, v247
s_nop 1
s_cmp_ge_u32 s43, 32
s_cbranch_scc1 Lev8
Lev8w:
s_sleep 1
ds_read_b32 v247, v253 offset:12
s_waitcnt lgkmcnt(0)
v_readfirstlane_b32 s43, v247
s_cmp_eq_u32 s76, 0
s_cbranch_scc1 Lev8
s_sub_u32 s76, s76, 1
s_cmp_lt_u32 s43, 32
s_cbranch_scc1 Lev8w
Lev8:
v_rcp_f16 v151, v150
ds_read_b128 v[220:223], v248 offset:29696
v_mfma_f32_32x32x16_bf16 v[120:135], v[112:115], v[224:227], v[120:135]
v_and_b32 v143, s49, v143
v_rcp_f16 v148, v147
v_fma_mix_f32 v167, v184, v184, v167 op_sel:[0,0,0] op_sel_hi:[1,1,0]
v_lshrrev_b16 v142, 2, v143
s_setprio 0
v_rcp_f16_sdwa v154, v153 dst_sel:WORD_1 dst_unused:UNUSED_PRESERVE src0_sel:WORD_1
v_rcp_f16_sdwa v151, v150 dst_sel:WORD_1 dst_unused:UNUSED_PRESERVE src0_sel:WORD_1
v_lshrrev_b32 v143, 18, v143
ds_read_b128 v[224:227], v245 offset:6528
ds_read_b128 v[192:195], v244 offset:128
ds_read_b128 v[196:199], v244 offset:64
ds_read_u16_d16 v142, v142
ds_read_u16_d16_hi v143, v143
v_mfma_f32_32x32x16_bf16 v[120:135], v[116:119], v[228:231], v[120:135]
v_fma_mix_f32 v167, v185, v185, v167 op_sel:[1,1,0] op_sel_hi:[1,1,0]
v_rcp_f16_sdwa v148, v147 dst_sel:WORD_1 dst_unused:UNUSED_PRESERVE src0_sel:WORD_1
v_and_b32 v177, s49, v177
v_pk_mul_f16 v155, v155, v154
v_fma_mix_f32 v167, v186, v186, v167 op_sel:[0,0,0] op_sel_hi:[1,1,0]
v_pk_mul_f16 v152, v152, v151
v_lshrrev_b16 v176, 2, v177
v_pk_mul_f16 v149, v149, v148
v_fma_mix_f32 v156, v155, v155, v156 op_sel:[0,0,0] op_sel_hi:[1,1,0]
v_fma_mix_f32 v156, v155, v155, v156 op_sel:[1,1,0] op_sel_hi:[1,1,0]
v_lshrrev_b32 v177, 18, v177
v_fma_mix_f32 v167, v187, v187, v167 op_sel:[1,1,0] op_sel_hi:[1,1,0]
v_fma_mix_f32 v156, v152, v152, v156 op_sel:[0,0,0] op_sel_hi:[1,1,0]
v_fma_mix_f32 v156, v152, v152, v156 op_sel:[1,1,0] op_sel_hi:[1,1,0]
v_fma_mix_f32 v156, v149, v149, v156 op_sel:[0,0,0] op_sel_hi:[1,1,0]
v_fma_mix_f32 v156, v149, v149, v156 op_sel:[1,1,0] op_sel_hi:[1,1,0]
s_setprio 2
v_mfma_f32_32x32x16_bf16 v[0:15], v[232:235], v[232:235], 0
s_add_u32 s46, s80, 14680064
buffer_store_dwordx4 v[76:79], v241, s[32:35], s46 offen sc1
ds_read_b128 v[228:231], v248 offset:32768
ds_read_u16_d16 v176, v176
ds_read_u16_d16_hi v177, v177
v_cvt_pkrtz_f16_f32 v179, v120, v121
v_cvt_pkrtz_f16_f32 v181, v122, v123
v_cvt_pkrtz_f16_f32 v183, v124, v125
v_mfma_f32_32x32x16_bf16 v[16:31], v[232:235], v[232:235], 0
v_cvt_pkrtz_f16_f32 v185, v126, v127
v_cvt_pkrtz_f16_f32 v187, v128, v129
v_cvt_pk_f16_f32 v155, v130, v131
v_cvt_pk_f16_f32 v152, v132, v133
v_mfma_f32_32x32x16_bf16 v[32:47], v[232:235], v[232:235], 0
v_cvt_pk_f16_f32 v149, v134, v135
v_pk_fma_f16 v154, v155, v155, s48
v_and_b32 v179, s49, v179
v_mfma_f32_32x32x16_bf16 v[120:135], v[96:99], v[236:239], 0
ds_read_b128 v[232:235], v248 offset:30720
v_fma_mix_f32 v156, v136, v136, v156 op_sel:[0,0,0] op_sel_hi:[1,1,0]
v_pk_fma_f16 v151, v152, v152, s48
v_pk_fma_f16 v148, v149, v149, s48
v_lshrrev_b16 v178, 2, v179
v_pk_mul_f16 v154, v155, v154
v_pk_mul_f16 v151, v152, v151
v_fma_mix_f32 v156, v137, v137, v156 op_sel:[1,1,0] op_sel_hi:[1,1,0]
s_waitcnt lgkmcnt(4)
v_mfma_f32_32x32x16_bf16 v[120:135], v[100:103], v[216:219], v[120:135]
ds_read_b128 v[236:239], v245 offset:6144
ds_read_b128 v[200:203], v244
ds_read_b128 v[204:207], v243 offset:128
ds_read_u16_d16 v178, v178
v_lshrrev_b32 v179, 18, v179
v_pk_mul_f16 v148, v149, v148
v_exp_f16 v153, v154
v_exp_f16 v150, v151
v_and_b32 v181, s49, v181
v_fma_mix_f32 v156, v138, v138, v156 op_sel:[0,0,0] op_sel_hi:[1,1,0]
v_mfma_f32_32x32x16_bf16 v[120:135], v[104:107], v[220:223], v[120:135]
ds_read_b128 v[216:219], v248 offset:33792
ds_read_u16_d16_hi v179, v179
v_exp_f16 v147, v148
v_lshrrev_b16 v180, 2, v181
v_exp_f16_sdwa v153, v154 dst_sel:WORD_1 dst_unused:UNUSED_PRESERVE src0_sel:WORD_1
v_lshrrev_b32 v181, 18, v181
v_fma_mix_f32 v156, v139, v139, v156 op_sel:[1,1,0] op_sel_hi:[1,1,0]
v_smfmac_f32_16x16x32_bf16 v[40:43], v[226:227], v[192:195], v246
ds_read_b128 v[220:223], v245 offset:5760
ds_read_b128 v[208:211], v243 offset:64
ds_read_b128 v[212:215], v243
ds_read_u16_d16 v180, v180
ds_read_u16_d16_hi v181, v181
v_exp_f16_sdwa v150, v151 dst_sel:WORD_1 dst_unused:UNUSED_PRESERVE src0_sel:WORD_1
v_smfmac_f32_16x16x32_bf16 v[24:27], v[224:225], v[196:199], v246
v_exp_f16_sdwa v147, v148 dst_sel:WORD_1 dst_unused:UNUSED_PRESERVE src0_sel:WORD_1
v_and_b32 v183, s49, v183
v_fma_mix_f32 v156, v140, v140, v156 op_sel:[0,0,0] op_sel_hi:[1,1,0]
v_pk_add_f16 v153, v153, 1.0 op_sel_hi:[1,0]
s_waitcnt lgkmcnt(7)
v_mfma_f32_32x32x16_bf16 v[120:135], v[108:111], v[228:231], v[120:135]
ds_read_b128 v[224:227], v245 offset:5376
ds_read_b128 v[192:195], v242 offset:128
ds_read_b128 v[196:199], v242 offset:64
v_lshrrev_b16 v182, 2, v183
v_pk_add_f16 v150, v150, 1.0 op_sel_hi:[1,0]
v_pk_add_f16 v147, v147, 1.0 op_sel_hi:[1,0]
v_rcp_f16 v154, v153
v_lshrrev_b32 v183, 18, v183
v_fma_mix_f32 v156, v141, v141, v156 op_sel:[1,1,0] op_sel_hi:[1,1,0]
v_mfma_f32_32x32x16_bf16 v[120:135], v[112:115], v[232:235], v[120:135]
ds_read_b128 v[228:231], v248 offset:34816
ds_read_u16_d16 v182, v182
ds_read_u16_d16_hi v183, v183
v_rcp_f16 v151, v150
v_and_b32 v185, s49, v185
v_rcp_f16 v148, v147
v_fma_mix_f32 v156, v142, v142, v156 op_sel:[0,0,0] op_sel_hi:[1,1,0]
v_lshrrev_b16 v184, 2, v185
v_smfmac_f32_16x16x32_bf16 v[8:11], v[238:239], v[200:203], v246
ds_read_b128 v[232:235], v248 offset:37888
ds_read_u16_d16 v184, v184
v_rcp_f16_sdwa v154, v153 dst_sel:WORD_1 dst_unused:UNUSED_PRESERVE src0_sel:WORD_1
v_rcp_f16_sdwa v151, v150 dst_sel:WORD_1 dst_unused:UNUSED_PRESERVE src0_sel:WORD_1
v_smfmac_f32_16x16x32_bf16 v[40:43], v[236:237], v[204:207], v246
v_lshrrev_b32 v185, 18, v185
v_fma_mix_f32 v156, v143, v143, v156 op_sel:[1,1,0] op_sel_hi:[1,1,0]
s_waitcnt lgkmcnt(6)
v_mfma_f32_32x32x16_bf16 v[120:135], v[116:119], v[216:219], v[120:135]
ds_read_b128 v[236:239], v248 offset:35840
ds_read_u16_d16_hi v185, v185
v_rcp_f16_sdwa v148, v147 dst_sel:WORD_1 dst_unused:UNUSED_PRESERVE src0_sel:WORD_1
v_and_b32 v187, s49, v187
v_pk_mul_f16 v155, v155, v154
v_fma_mix_f32 v156, v176, v176, v156 op_sel:[0,0,0] op_sel_hi:[1,1,0]
v_pk_mul_f16 v152, v152, v151
v_lshrrev_b16 v186, 2, v187
v_pk_mul_f16 v149, v149, v148
v_smfmac_f32_16x16x32_bf16 v[24:27], v[222:223], v[208:211], v246
ds_read_b128 v[216:219], v248 offset:38912
ds_read_u16_d16 v186, v186
v_fma_mix_f32 v157, v155, v155, v157 op_sel:[0,0,0] op_sel_hi:[1,1,0]
v_fma_mix_f32 v157, v155, v155, v157 op_sel:[1,1,0] op_sel_hi:[1,1,0]
v_lshrrev_b32 v187, 18, v187
v_fma_mix_f32 v156, v177, v177, v156 op_sel:[1,1,0] op_sel_hi:[1,1,0]
v_smfmac_f32_16x16x32_bf16 v[8:11], v[220:221], v[212:215], v246
v_fma_mix_f32 v157, v152, v152, v157 op_sel:[0,0,0] op_sel_hi:[1,1,0]
v_fma_mix_f32 v157, v152, v152, v157 op_sel:[1,1,0] op_sel_hi:[1,1,0]
v_fma_mix_f32 v157, v149, v149, v157 op_sel:[0,0,0] op_sel_hi:[1,1,0]
v_fma_mix_f32 v157, v149, v149, v157 op_sel:[1,1,0] op_sel_hi:[1,1,0]
s_setprio 1
v_smfmac_f32_16x16x32_bf16 v[40:43], v[226:227], v[192:195], v246
s_waitcnt lgkmcnt(4)
s_add_u32 s46, s80, 16777216
buffer_store_dwordx4 v[80:83], v241, s[32:35], s46 offen sc1
ds_read_b128 v[220:223], v248 offset:36864
ds_read_u16_d16_hi v187, v187
v_cvt_pkrtz_f16_f32 v137, v120, v121
v_cvt_pkrtz_f16_f32 v139, v122, v123
v_cvt_pkrtz_f16_f32 v141, v124, v125
v_cvt_pkrtz_f16_f32 v143, v126, v127
v_cvt_pk_f16_f32 v155, v128, v129
v_smfmac_f32_16x16x32_bf16 v[24:27], v[224:225], v[196:199], v246
v_cvt_pk_f16_f32 v152, v130, v131
v_cvt_pk_f16_f32 v149, v132, v133
v_cvt_pk_f16_f32 v146, v134, v135
v_pk_fma_f16 v154, v155, v155, s48
v_and_b32 v137, s49, v137
v_mfma_f32_32x32x16_bf16 v[120:135], v[96:99], v[228:231], 0
ds_read_b128 v[224:227], v248 offset:39936
v_fma_mix_f32 v157, v178, v178, v157 op_sel:[0,0,0] op_sel_hi:[1,1,0]
v_pk_fma_f16 v151, v152, v152, s48
v_pk_fma_f16 v148, v149, v149, s48
v_pk_fma_f16 v145, v146, v146, s48
v_pk_mul_f16 v154, v155, v154
v_lshrrev_b16 v136, 2, v137
v_pk_mul_f16 v151, v152, v151
v_fma_mix_f32 v157, v179, v179, v157 op_sel:[1,1,0] op_sel_hi:[1,1,0]
v_pk_mul_f16 v148, v149, v148
v_pk_mul_f16 v145, v146, v145
v_mfma_f32_32x32x16_bf16 v[120:135], v[100:103], v[232:235], v[120:135]
ds_read_b128 v[228:231], v245 offset:4992
ds_read_b128 v[200:203], v242
v_xor_b32 v244, 16, v244
ds_read_b128 v[204:207], v244 offset:128
ds_read_u16_d16 v136, v136
v_exp_f16 v153, v154
v_lshrrev_b32 v137, 18, v137
v_exp_f16 v150, v151
v_fma_mix_f32 v157, v180, v180, v157 op_sel:[0,0,0] op_sel_hi:[1,1,0]
v_exp_f16 v147, v148
v_and_b32 v139, s49, v139
v_exp_f16 v144, v145
s_waitcnt lgkmcnt(5)
v_mfma_f32_32x32x16_bf16 v[120:135], v[104:107], v[236:239], v[120:135]
ds_read_b128 v[232:235], v245 offset:4608
ds_read_b128 v[208:211], v244 offset:64
ds_read_b128 v[212:215], v244
ds_read_u16_d16_hi v137, v137
v_exp_f16_sdwa v153, v154 dst_sel:WORD_1 dst_unused:UNUSED_PRESERVE src0_sel:WORD_1
v_fma_mix_f32 v157, v181, v181, v157 op_sel:[1,1,0] op_sel_hi:[1,1,0]
v_lshrrev_b16 v138, 2, v139
v_exp_f16_sdwa v150, v151 dst_sel:WORD_1 dst_unused:UNUSED_PRESERVE src0_sel:WORD_1
v_exp_f16_sdwa v147, v148 dst_sel:WORD_1 dst_unused:UNUSED_PRESERVE src0_sel:WORD_1
v_exp_f16_sdwa v144, v145 dst_sel:WORD_1 dst_unused:UNUSED_PRESERVE src0_sel:WORD_1
v_lshrrev_b32 v139, 18, v139
v_fma_mix_f32 v157, v182, v182, v157 op_sel:[0,0,0] op_sel_hi:[1,1,0]
v_mfma_f32_32x32x16_bf16 v[120:135], v[108:111], v[216:219], v[120:135]
ds_read_b128 v[236:239], v248 offset:40960
ds_read_u16_d16 v138, v138
ds_read_u16_d16_hi v139, v139
v_pk_add_f16 v153, v153, 1.0 op_sel_hi:[1,0]
v_pk_add_f16 v150, v150, 1.0 op_sel_hi:[1,0]
v_pk_add_f16 v147, v147, 1.0 op_sel_hi:[1,0]
v_and_b32 v141, s49, v141
v_pk_add_f16 v144, v144, 1.0 op_sel_hi:[1,0]
v_rcp_f16 v154, v153
v_fma_mix_f32 v157, v183, v183, v157 op_sel:[1,1,0] op_sel_hi:[1,1,0]
v_rcp_f16 v151, v150
v_mfma_f32_32x32x16_bf16 v[120:135], v[112:115], v[220:223], v[120:135]
ds_read_b128 v[216:219], v248 offset:44032
v_lshrrev_b16 v140, 2, v141
v_rcp_f16 v148, v147
v_fma_mix_f32 v157, v184, v184, v157 op_sel:[0,0,0] op_sel_hi:[1,1,0]
v_rcp_f16 v145, v144
v_lshrrev_b32 v141, 18, v141
v_rcp_f16_sdwa v154, v153 dst_sel:WORD_1 dst_unused:UNUSED_PRESERVE src0_sel:WORD_1
s_setprio 0
v_rcp_f16_sdwa v151, v150 dst_sel:WORD_1 dst_unused:UNUSED_PRESERVE src0_sel:WORD_1
s_waitcnt lgkmcnt(4)
v_mfma_f32_32x32x16_bf16 v[120:135], v[116:119], v[224:227], v[120:135]
ds_read_b128 v[220:223], v248 offset:41984
ds_read_u16_d16 v140, v140
ds_read_u16_d16_hi v141, v141
v_fma_mix_f32 v157, v185, v185, v157 op_sel:[1,1,0] op_sel_hi:[1,1,0]
v_and_b32 v143, s49, v143
v_rcp_f16_sdwa v148, v147 dst_sel:WORD_1 dst_unused:UNUSED_PRESERVE src0_sel:WORD_1
v_rcp_f16_sdwa v145, v144 dst_sel:WORD_1 dst_unused:UNUSED_PRESERVE src0_sel:WORD_1
v_pk_mul_f16 v155, v155, v154
v_lshrrev_b16 v142, 2, v143
v_fma_mix_f32 v157, v186, v186, v157 op_sel:[0,0,0] op_sel_hi:[1,1,0]
v_pk_mul_f16 v152, v152, v151
v_pk_mul_f16 v149, v149, v148
v_smfmac_f32_16x16x32_bf16 v[8:11], v[230:231], v[200:203], v246
ds_read_b128 v[224:227], v248 offset:45056
ds_read_u16_d16 v142, v142
v_pk_mul_f16 v146, v146, v145
v_fma_mix_f32 v158, v155, v155, v158 op_sel:[0,0,0] op_sel_hi:[1,1,0]
v_lshrrev_b32 v143, 18, v143
v_fma_mix_f32 v158, v155, v155, v158 op_sel:[1,1,0] op_sel_hi:[1,1,0]
v_fma_mix_f32 v158, v152, v152, v158 op_sel:[0,0,0] op_sel_hi:[1,1,0]
v_smfmac_f32_16x16x32_bf16 v[44:47], v[228:229], v[204:207], v246
v_fma_mix_f32 v157, v187, v187, v157 op_sel:[1,1,0] op_sel_hi:[1,1,0]
v_fma_mix_f32 v158, v152, v152, v158 op_sel:[1,1,0] op_sel_hi:[1,1,0]
v_fma_mix_f32 v158, v149, v149, v158 op_sel:[0,0,0] op_sel_hi:[1,1,0]
v_fma_mix_f32 v158, v149, v149, v158 op_sel:[1,1,0] op_sel_hi:[1,1,0]
v_fma_mix_f32 v158, v146, v146, v158 op_sel:[0,0,0] op_sel_hi:[1,1,0]
v_fma_mix_f32 v158, v146, v146, v158 op_sel:[1,1,0] op_sel_hi:[1,1,0]
s_setprio 2
v_smfmac_f32_16x16x32_bf16 v[28:31], v[234:235], v[208:211], v246
s_add_u32 s46, s80, 18874368
buffer_store_dwordx4 v[84:87], v241, s[32:35], s46 offen sc1
ds_read_b128 v[228:231], v248 offset:43008
ds_read_u16_d16_hi v143, v143
v_cvt_pkrtz_f16_f32 v179, v120, v121
v_cvt_pkrtz_f16_f32 v181, v122, v123
v_cvt_pkrtz_f16_f32 v183, v124, v125
v_cvt_pkrtz_f16_f32 v185, v126, v127
v_smfmac_f32_16x16x32_bf16 v[12:15], v[232:233], v[212:215], v246
v_cvt_pkrtz_f16_f32 v187, v128, v129
v_cvt_pk_f16_f32 v155, v130, v131
v_cvt_pk_f16_f32 v152, v132, v133
v_cvt_pk_f16_f32 v149, v134, v135
v_pk_fma_f16 v154, v155, v155, s48
s_waitcnt lgkmcnt(2)
v_mfma_f32_32x32x16_bf16 v[120:135], v[96:99], v[236:239], 0
ds_read_b128 v[232:235], v248 offset:46080
v_and_b32 v179, s49, v179
v_fma_mix_f32 v158, v136, v136, v158 op_sel:[0,0,0] op_sel_hi:[1,1,0]
v_pk_fma_f16 v151, v152, v152, s48
v_pk_fma_f16 v148, v149, v149, s48
v_lshrrev_b16 v178, 2, v179
v_pk_mul_f16 v154, v155, v154
v_pk_mul_f16 v151, v152, v151
v_pk_mul_f16 v148, v149, v148
v_lshrrev_b32 v179, 18, v179
v_mfma_f32_32x32x16_bf16 v[120:135], v[100:103], v[216:219], v[120:135]
ds_read_b128 v[236:239], v245 offset:4224
v_xor_b32 v243, 16, v243
ds_read_b128 v[192:195], v243 offset:128
ds_read_b128 v[196:199], v243 offset:64
ds_read_u16_d16 v178, v178
ds_read_u16_d16_hi v179, v179
v_fma_mix_f32 v158, v137, v137, v158 op_sel:[1,1,0] op_sel_hi:[1,1,0]
v_exp_f16 v153, v154
v_and_b32 v181, s49, v181
v_exp_f16 v150, v151
v_exp_f16 v147, v148
v_lshrrev_b16 v180, 2, v181
v_mfma_f32_32x32x16_bf16 v[120:135], v[104:107], v[220:223], v[120:135]
ds_read_b128 v[216:219], v245 offset:3840
ds_read_b128 v[200:203], v243
v_xor_b32 v242, 16, v242
ds_read_b128 v[204:207], v242 offset:128
ds_read_u16_d16 v180, v180
v_fma_mix_f32 v158, v138, v138, v158 op_sel:[0,0,0] op_sel_hi:[1,1,0]
v_exp_f16_sdwa v153, v154 dst_sel:WORD_1 dst_unused:UNUSED_PRESERVE src0_sel:WORD_1
v_lshrrev_b32 v181, 18, v181
v_exp_f16_sdwa v150, v151 dst_sel:WORD_1 dst_unused:UNUSED_PRESERVE src0_sel:WORD_1
v_fma_mix_f32 v158, v139, v139, v158 op_sel:[1,1,0] op_sel_hi:[1,1,0]
v_and_b32 v183, s49, v183
v_mfma_f32_32x32x16_bf16 v[120:135], v[108:111], v[224:227], v[120:135]
ds_read_b128 v[220:223], v248 offset:47104
ds_read_u16_d16_hi v181, v181
v_exp_f16_sdwa v147, v148 dst_sel:WORD_1 dst_unused:UNUSED_PRESERVE src0_sel:WORD_1
v_pk_add_f16 v153, v153, 1.0 op_sel_hi:[1,0]
v_lshrrev_b16 v182, 2, v183
v_pk_add_f16 v150, v150, 1.0 op_sel_hi:[1,0]
v_pk_add_f16 v147, v147, 1.0 op_sel_hi:[1,0]
v_rcp_f16 v154, v153
v_lshrrev_b32 v183, 18, v183
v_fma_mix_f32 v158, v140, v140, v158 op_sel:[0,0,0] op_sel_hi:[1,1,0]
s_waitcnt lgkmcnt(6)
v_mfma_f32_32x32x16_bf16 v[120:135], v[112:115], v[228:231], v[120:135]
ds_read_b128 v[224:227], v248 offset:50176
ds_read_u16_d16 v182, v182
ds_read_u16_d16_hi v183, v183
v_rcp_f16 v151, v150
v_and_b32 v185, s49, v185
v_rcp_f16 v148, v147
v_fma_mix_f32 v158, v141, v141, v158 op_sel:[1,1,0] op_sel_hi:[1,1,0]
v_lshrrev_b16 v184, 2, v185
v_rcp_f16_sdwa v154, v153 dst_sel:WORD_1 dst_unused:UNUSED_PRESERVE src0_sel:WORD_1
v_mfma_f32_32x32x16_bf16 v[120:135], v[116:119], v[232:235], v[120:135]
ds_read_b128 v[228:231], v248 offset:48128
ds_read_u16_d16 v184, v184
v_rcp_f16_sdwa v151, v150 dst_sel:WORD_1 dst_unused:UNUSED_PRESERVE src0_sel:WORD_1
v_lshrrev_b32 v185, 18, v185
v_rcp_f16_sdwa v148, v147 dst_sel:WORD_1 dst_unused:UNUSED_PRESERVE src0_sel:WORD_1
v_and_b32 v187, s49, v187
v_fma_mix_f32 v158, v142, v142, v158 op_sel:[0,0,0] op_sel_hi:[1,1,0]
v_pk_mul_f16 v155, v155, v154
v_pk_mul_f16 v152, v152, v151
v_smfmac_f32_16x16x32_bf16 v[44:47], v[238:239], v[192:195], v246
ds_read_b128 v[232:235], v248 offset:51200
ds_read_u16_d16_hi v185, v185
v_lshrrev_b16 v186, 2, v187
v_pk_mul_f16 v149, v149, v148
v_fma_mix_f32 v159, v155, v155, v159 op_sel:[0,0,0] op_sel_hi:[1,1,0]
v_fma_mix_f32 v158, v143, v143, v158 op_sel:[1,1,0] op_sel_hi:[1,1,0]
v_lshrrev_b32 v187, 18, v187
v_smfmac_f32_16x16x32_bf16 v[28:31], v[236:237], v[196:199], v246
v_fma_mix_f32 v159, v155, v155, v159 op_sel:[1,1,0] op_sel_hi:[1,1,0]
v_fma_mix_f32 v159, v152, v152, v159 op_sel:[0,0,0] op_sel_hi:[1,1,0]
v_fma_mix_f32 v159, v152, v152, v159 op_sel:[1,1,0] op_sel_hi:[1,1,0]
v_fma_mix_f32 v159, v149, v149, v159 op_sel:[0,0,0] op_sel_hi:[1,1,0]
v_fma_mix_f32 v159, v149, v149, v159 op_sel:[1,1,0] op_sel_hi:[1,1,0]
s_setprio 1
s_waitcnt lgkmcnt(4)
v_smfmac_f32_16x16x32_bf16 v[12:15], v[218:219], v[200:203], v246
s_add_u32 s46, s80, 20971520
buffer_store_dwordx4 v[88:91], v241, s[32:35], s46 offen sc1
ds_read_b128 v[236:239], v248 offset:49152
ds_read_u16_d16 v186, v186
ds_read_u16_d16_hi v187, v187
v_cvt_pkrtz_f16_f32 v137, v120, v121
v_cvt_pkrtz_f16_f32 v139, v122, v123
v_cvt_pkrtz_f16_f32 v141, v124, v125
v_cvt_pkrtz_f16_f32 v143, v126, v127
v_cvt_pk_f16_f32 v155, v128, v129
v_smfmac_f32_16x16x32_bf16 v[44:47], v[216:217], v[204:207], v246
v_cvt_pk_f16_f32 v152, v130, v131
v_cvt_pk_f16_f32 v149, v132, v133
v_cvt_pk_f16_f32 v146, v134, v135
v_pk_fma_f16 v154, v155, v155, s48
v_and_b32 v137, s49, v137
v_mfma_f32_32x32x16_bf16 v[120:135], v[96:99], v[220:223], 0
ds_read_b128 v[216:219], v248 offset:52224
v_fma_mix_f32 v159, v178, v178, v159 op_sel:[0,0,0] op_sel_hi:[1,1,0]
v_pk_fma_f16 v151, v152, v152, s48
v_pk_fma_f16 v148, v149, v149, s48
v_pk_fma_f16 v145, v146, v146, s48
v_pk_mul_f16 v154, v155, v154
v_lshrrev_b16 v136, 2, v137
v_pk_mul_f16 v151, v152, v151
v_fma_mix_f32 v159, v179, v179, v159 op_sel:[1,1,0] op_sel_hi:[1,1,0]
v_pk_mul_f16 v148, v149, v148
v_pk_mul_f16 v145, v146, v145
v_mfma_f32_32x32x16_bf16 v[120:135], v[100:103], v[224:227], v[120:135]
ds_read_b128 v[220:223], v245 offset:3456
ds_read_b128 v[208:211], v242 offset:64
ds_read_b128 v[212:215], v242
ds_read_u16_d16 v136, v136
v_exp_f16 v153, v154
v_lshrrev_b32 v137, 18, v137
v_exp_f16 v150, v151
v_fma_mix_f32 v159, v180, v180, v159 op_sel:[0,0,0] op_sel_hi:[1,1,0]
v_exp_f16 v147, v148
v_and_b32 v139, s49, v139
v_exp_f16 v144, v145
s_waitcnt lgkmcnt(5)
v_mfma_f32_32x32x16_bf16 v[120:135], v[104:107], v[228:231], v[120:135]
ds_read_b128 v[224:227], v245 offset:3072
v_xor_b32 v244, 32, v244
ds_read_b128 v[192:195], v244 offset:128
ds_read_b128 v[196:199], v244 offset:64
ds_read_u16_d16_hi v137, v137
v_exp_f16_sdwa v153, v154 dst_sel:WORD_1 dst_unused:UNUSED_PRESERVE src0_sel:WORD_1
v_fma_mix_f32 v159, v181, v181, v159 op_sel:[1,1,0] op_sel_hi:[1,1,0]
v_lshrrev_b16 v138, 2, v139
v_exp_f16_sdwa v150, v151 dst_sel:WORD_1 dst_unused:UNUSED_PRESERVE src0_sel:WORD_1
v_exp_f16_sdwa v147, v148 dst_sel:WORD_1 dst_unused:UNUSED_PRESERVE src0_sel:WORD_1
v_exp_f16_sdwa v144, v145 dst_sel:WORD_1 dst_unused:UNUSED_PRESERVE src0_sel:WORD_1
v_lshrrev_b32 v139, 18, v139
v_fma_mix_f32 v159, v182, v182, v159 op_sel:[0,0,0] op_sel_hi:[1,1,0]
v_mfma_f32_32x32x16_bf16 v[120:135], v[108:111], v[232:235], v[120:135]
ds_read_b128 v[228:231], v248 offset:53248
ds_read_u16_d16 v138, v138
ds_read_u16_d16_hi v139, v139
v_pk_add_f16 v153, v153, 1.0 op_sel_hi:[1,0]
v_pk_add_f16 v150, v150, 1.0 op_sel_hi:[1,0]
v_pk_add_f16 v147, v147, 1.0 op_sel_hi:[1,0]
v_and_b32 v141, s49, v141
v_pk_add_f16 v144, v144, 1.0 op_sel_hi:[1,0]
v_rcp_f16 v154, v153
v_fma_mix_f32 v159, v183, v183, v159 op_sel:[1,1,0] op_sel_hi:[1,1,0]
v_rcp_f16 v151, v150
v_mfma_f32_32x32x16_bf16 v[120:135], v[112:115], v[236:239], v[120:135]
ds_read_b128 v[232:235], v248 offset:56320
v_lshrrev_b16 v140, 2, v141
v_rcp_f16 v148, v147
v_fma_mix_f32 v159, v184, v184, v159 op_sel:[0,0,0] op_sel_hi:[1,1,0]
v_rcp_f16 v145, v144
v_lshrrev_b32 v141, 18, v141
v_rcp_f16_sdwa v154, v153 dst_sel:WORD_1 dst_unused:UNUSED_PRESERVE src0_sel:WORD_1
s_setprio 0
v_rcp_f16_sdwa v151, v150 dst_sel:WORD_1 dst_unused:UNUSED_PRESERVE src0_sel:WORD_1
s_waitcnt lgkmcnt(4)
v_mfma_f32_32x32x16_bf16 v[120:135], v[116:119], v[216:219], v[120:135]
ds_read_b128 v[236:239], v248 offset:54272
ds_read_u16_d16 v140, v140
ds_read_u16_d16_hi v141, v141
v_fma_mix_f32 v159, v185, v185, v159 op_sel:[1,1,0] op_sel_hi:[1,1,0]
v_and_b32 v143, s49, v143
v_rcp_f16_sdwa v148, v147 dst_sel:WORD_1 dst_unused:UNUSED_PRESERVE src0_sel:WORD_1
v_rcp_f16_sdwa v145, v144 dst_sel:WORD_1 dst_unused:UNUSED_PRESERVE src0_sel:WORD_1
v_pk_mul_f16 v155, v155, v154
v_lshrrev_b16 v142, 2, v143
v_fma_mix_f32 v159, v186, v186, v159 op_sel:[0,0,0] op_sel_hi:[1,1,0]
v_pk_mul_f16 v152, v152, v151
v_pk_mul_f16 v149, v149, v148
v_smfmac_f32_16x16x32_bf16 v[28:31], v[222:223], v[208:211], v246
ds_read_b128 v[216:219], v248 offset:57344
ds_read_u16_d16 v142, v142
v_pk_mul_f16 v146, v146, v145
v_fma_mix_f32 v160, v155, v155, v160 op_sel:[0,0,0] op_sel_hi:[1,1,0]
v_lshrrev_b32 v143, 18, v143
v_fma_mix_f32 v160, v155, v155, v160 op_sel:[1,1,0] op_sel_hi:[1,1,0]
v_fma_mix_f32 v160, v152, v152, v160 op_sel:[0,0,0] op_sel_hi:[1,1,0]
v_smfmac_f32_16x16x32_bf16 v[12:15], v[220:221], v[212:215], v246
v_fma_mix_f32 v159, v187, v187, v159 op_sel:[1,1,0] op_sel_hi:[1,1,0]
v_fma_mix_f32 v160, v152, v152, v160 op_sel:[1,1,0] op_sel_hi:[1,1,0]
v_fma_mix_f32 v160, v149, v149, v160 op_sel:[0,0,0] op_sel_hi:[1,1,0]
v_fma_mix_f32 v160, v149, v149, v160 op_sel:[1,1,0] op_sel_hi:[1,1,0]
v_fma_mix_f32 v160, v146, v146, v160 op_sel:[0,0,0] op_sel_hi:[1,1,0]
v_fma_mix_f32 v160, v146, v146, v160 op_sel:[1,1,0] op_sel_hi:[1,1,0]
s_setprio 2
v_smfmac_f32_16x16x32_bf16 v[36:39], v[226:227], v[192:195], v246
s_add_u32 s46, s80, 23068672
buffer_store_dwordx4 v[92:95], v241, s[32:35], s46 offen sc1
ds_read_b128 v[220:223], v248 offset:55296
ds_read_u16_d16_hi v143, v143
v_cvt_pkrtz_f16_f32 v179, v120, v121
v_cvt_pkrtz_f16_f32 v181, v122, v123
v_cvt_pkrtz_f16_f32 v183, v124, v125
v_cvt_pkrtz_f16_f32 v185, v126, v127
v_smfmac_f32_16x16x32_bf16 v[20:23], v[224:225], v[196:199], v246
v_cvt_pkrtz_f16_f32 v187, v128, v129
v_cvt_pk_f16_f32 v155, v130, v131
v_cvt_pk_f16_f32 v152, v132, v133
v_cvt_pk_f16_f32 v149, v134, v135
s_waitcnt lgkmcnt(2)
v_mfma_f32_32x32x16_bf16 v[120:135], v[96:99], v[228:231], 0
ds_read_b128 v[224:227], v245 offset:2688
ds_read_b128 v[200:203], v244
v_xor_b32 v243, 32, v243
ds_read_b128 v[204:207], v243 offset:128
v_pk_fma_f16 v154, v155, v155, s48
v_and_b32 v179, s49, v179
v_fma_mix_f32 v160, v136, v136, v160 op_sel:[0,0,0] op_sel_hi:[1,1,0]
v_pk_fma_f16 v151, v152, v152, s48
v_pk_fma_f16 v148, v149, v149, s48
v_lshrrev_b16 v178, 2, v179
v_pk_mul_f16 v154, v155, v154
v_pk_mul_f16 v151, v152, v151
v_mfma_f32_32x32x16_bf16 v[120:135], v[100:103], v[232:235], v[120:135]
ds_read_b128 v[228:231], v248 offset:58368
ds_read_u16_d16 v178, v178
v_pk_mul_f16 v148, v149, v148
v_lshrrev_b32 v179, 18, v179
v_fma_mix_f32 v160, v137, v137, v160 op_sel:[1,1,0] op_sel_hi:[1,1,0]
v_exp_f16 v153, v154
v_and_b32 v181, s49, v181
v_exp_f16 v150, v151
v_mfma_f32_32x32x16_bf16 v[120:135], v[104:107], v[236:239], v[120:135]
ds_read_b128 v[232:235], v245 offset:2304
ds_read_b128 v[208:211], v243 offset:64
ds_read_b128 v[212:215], v243
ds_read_u16_d16_hi v179, v179
v_exp_f16 v147, v148
v_lshrrev_b16 v180, 2, v181
v_fma_mix_f32 v160, v138, v138, v160 op_sel:[0,0,0] op_sel_hi:[1,1,0]
v_exp_f16_sdwa v153, v154 dst_sel:WORD_1 dst_unused:UNUSED_PRESERVE src0_sel:WORD_1
v_lshrrev_b32 v181, 18, v181
v_mfma_f32_32x32x16_bf16 v[120:135], v[108:111], v[216:219], v[120:135]
ds_read_b128 v[236:239], v245 offset:1920
v_xor_b32 v242, 32, v242
ds_read_b128 v[192:195], v242 offset:128
ds_read_b128 v[196:199], v242 offset:64
ds_read_u16_d16 v180, v180
ds_read_u16_d16_hi v181, v181
v_exp_f16_sdwa v150, v151 dst_sel:WORD_1 dst_unused:UNUSED_PRESERVE src0_sel:WORD_1
v_fma_mix_f32 v160, v139, v139, v160 op_sel:[1,1,0] op_sel_hi:[1,1,0]
v_and_b32 v183, s49, v183
v_exp_f16_sdwa v147, v148 dst_sel:WORD_1 dst_unused:UNUSED_PRESERVE src0_sel:WORD_1
v_pk_add_f16 v153, v153, 1.0 op_sel_hi:[1,0]
v_lshrrev_b16 v182, 2, v183
v_pk_add_f16 v150, v150, 1.0 op_sel_hi:[1,0]
s_waitcnt lgkmcnt(9)
v_mfma_f32_32x32x16_bf16 v[120:135], v[112:115], v[220:223], v[120:135]
ds_read_b128 v[216:219], v248 offset:59392
ds_read_u16_d16 v182, v182
v_pk_add_f16 v147, v147, 1.0 op_sel_hi:[1,0]
v_rcp_f16 v154, v153
v_lshrrev_b32 v183, 18, v183
v_fma_mix_f32 v160, v140, v140, v160 op_sel:[0,0,0] op_sel_hi:[1,1,0]
v_rcp_f16 v151, v150
v_and_b32 v185, s49, v185
v_smfmac_f32_16x16x32_bf16 v[4:7], v[226:227], v[200:203], v246
ds_read_b128 v[220:223], v248 offset:62464
ds_read_u16_d16_hi v183, v183
v_rcp_f16 v148, v147
v_fma_mix_f32 v160, v141, v141, v160 op_sel:[1,1,0] op_sel_hi:[1,1,0]
v_lshrrev_b16 v184, 2, v185
v_smfmac_f32_16x16x32_bf16 v[36:39], v[224:225], v[204:207], v246
v_rcp_f16_sdwa v154, v153 dst_sel:WORD_1 dst_unused:UNUSED_PRESERVE src0_sel:WORD_1
v_rcp_f16_sdwa v151, v150 dst_sel:WORD_1 dst_unused:UNUSED_PRESERVE src0_sel:WORD_1
v_mfma_f32_32x32x16_bf16 v[120:135], v[116:119], v[228:231], v[120:135]
ds_read_b128 v[224:227], v248 offset:60416
ds_read_u16_d16 v184, v184
v_lshrrev_b32 v185, 18, v185
v_rcp_f16_sdwa v148, v147 dst_sel:WORD_1 dst_unused:UNUSED_PRESERVE src0_sel:WORD_1
v_and_b32 v187, s49, v187
v_fma_mix_f32 v160, v142, v142, v160 op_sel:[0,0,0] op_sel_hi:[1,1,0]
v_pk_mul_f16 v155, v155, v154
v_pk_mul_f16 v152, v152, v151
v_lshrrev_b16 v186, 2, v187
s_waitcnt lgkmcnt(4)
v_smfmac_f32_16x16x32_bf16 v[20:23], v[234:235], v[208:211], v246
ds_read_b128 v[228:231], v248 offset:63488
ds_read_u16_d16_hi v185, v185
ds_read_u16_d16 v186, v186
v_pk_mul_f16 v149, v149, v148
v_fma_mix_f32 v161, v155, v155, v161 op_sel:[0,0,0] op_sel_hi:[1,1,0]
v_fma_mix_f32 v160, v143, v143, v160 op_sel:[1,1,0] op_sel_hi:[1,1,0]
v_lshrrev_b32 v187, 18, v187
v_smfmac_f32_16x16x32_bf16 v[4:7], v[232:233], v[212:215], v246
v_fma_mix_f32 v161, v155, v155, v161 op_sel:[1,1,0] op_sel_hi:[1,1,0]
v_fma_mix_f32 v161, v152, v152, v161 op_sel:[0,0,0] op_sel_hi:[1,1,0]
v_fma_mix_f32 v161, v152, v152, v161 op_sel:[1,1,0] op_sel_hi:[1,1,0]
v_fma_mix_f32 v161, v149, v149, v161 op_sel:[0,0,0] op_sel_hi:[1,1,0]
v_fma_mix_f32 v161, v149, v149, v161 op_sel:[1,1,0] op_sel_hi:[1,1,0]
s_setprio 1
v_smfmac_f32_16x16x32_bf16 v[36:39], v[238:239], v[192:195], v246
ds_read_b128 v[232:235], v248 offset:61440
ds_read_u16_d16_hi v187, v187
v_cvt_pkrtz_f16_f32 v137, v120, v121
v_cvt_pkrtz_f16_f32 v139, v122, v123
v_cvt_pkrtz_f16_f32 v141, v124, v125
v_cvt_pkrtz_f16_f32 v143, v126, v127
v_cvt_pk_f16_f32 v155, v128, v129
v_smfmac_f32_16x16x32_bf16 v[20:23], v[236:237], v[196:199], v246
v_cvt_pk_f16_f32 v152, v130, v131
v_cvt_pk_f16_f32 v149, v132, v133
v_cvt_pk_f16_f32 v146, v134, v135
v_pk_fma_f16 v154, v155, v155, s48
v_and_b32 v137, s49, v137
v_mfma_f32_32x32x16_bf16 v[120:135], v[96:99], v[216:219], 0
ds_read_b128 v[236:239], v248 offset:64512
v_fma_mix_f32 v161, v178, v178, v161 op_sel:[0,0,0] op_sel_hi:[1,1,0]
v_pk_fma_f16 v151, v152, v152, s48
v_pk_fma_f16 v148, v149, v149, s48
v_pk_fma_f16 v145, v146, v146, s48
v_pk_mul_f16 v154, v155, v154
v_lshrrev_b16 v136, 2, v137
v_pk_mul_f16 v151, v152, v151
v_fma_mix_f32 v161, v179, v179, v161 op_sel:[1,1,0] op_sel_hi:[1,1,0]
v_pk_mul_f16 v148, v149, v148
v_pk_mul_f16 v145, v146, v145
s_waitcnt lgkmcnt(2)
v_mfma_f32_32x32x16_bf16 v[120:135], v[100:103], v[220:223], v[120:135]
ds_read_b128 v[216:219], v245 offset:1536
ds_read_b128 v[200:203], v242
v_xor_b32 v244, 16, v244
ds_read_b128 v[204:207], v244 offset:128
ds_read_u16_d16 v136, v136
v_exp_f16 v153, v154
v_lshrrev_b32 v137, 18, v137
v_exp_f16 v150, v151
v_fma_mix_f32 v161, v180, v180, v161 op_sel:[0,0,0] op_sel_hi:[1,1,0]
v_exp_f16 v147, v148
v_and_b32 v139, s49, v139
v_exp_f16 v144, v145
v_mfma_f32_32x32x16_bf16 v[120:135], v[104:107], v[224:227], v[120:135]
ds_read_b128 v[220:223], v245 offset:1152
ds_read_b128 v[208:211], v244 offset:64
ds_read_b128 v[212:215], v244
ds_read_u16_d16_hi v137, v137
v_exp_f16_sdwa v153, v154 dst_sel:WORD_1 dst_unused:UNUSED_PRESERVE src0_sel:WORD_1
v_fma_mix_f32 v161, v181, v181, v161 op_sel:[1,1,0] op_sel_hi:[1,1,0]
v_lshrrev_b16 v138, 2, v139
v_exp_f16_sdwa v150, v151 dst_sel:WORD_1 dst_unused:UNUSED_PRESERVE src0_sel:WORD_1
v_exp_f16_sdwa v147, v148 dst_sel:WORD_1 dst_unused:UNUSED_PRESERVE src0_sel:WORD_1
v_exp_f16_sdwa v144, v145 dst_sel:WORD_1 dst_unused:UNUSED_PRESERVE src0_sel:WORD_1
v_lshrrev_b32 v139, 18, v139
v_fma_mix_f32 v161, v182, v182, v161 op_sel:[0,0,0] op_sel_hi:[1,1,0]
v_mfma_f32_32x32x16_bf16 v[120:135], v[108:111], v[228:231], v[120:135]
ds_read_b128 v[224:227], v249
ds_read_u16_d16 v138, v138
ds_read_u16_d16_hi v139, v139
v_pk_add_f16 v153, v153, 1.0 op_sel_hi:[1,0]
v_pk_add_f16 v150, v150, 1.0 op_sel_hi:[1,0]
v_pk_add_f16 v147, v147, 1.0 op_sel_hi:[1,0]
v_and_b32 v141, s49, v141
v_pk_add_f16 v144, v144, 1.0 op_sel_hi:[1,0]
v_rcp_f16 v154, v153
v_fma_mix_f32 v161, v183, v183, v161 op_sel:[1,1,0] op_sel_hi:[1,1,0]
v_rcp_f16 v151, v150
v_mfma_f32_32x32x16_bf16 v[120:135], v[112:115], v[232:235], v[120:135]
ds_read_b128 v[228:231], v249 offset:3072
v_lshrrev_b16 v140, 2, v141
v_rcp_f16 v148, v147
v_fma_mix_f32 v161, v184, v184, v161 op_sel:[0,0,0] op_sel_hi:[1,1,0]
v_rcp_f16 v145, v144
v_lshrrev_b32 v141, 18, v141
v_rcp_f16_sdwa v154, v153 dst_sel:WORD_1 dst_unused:UNUSED_PRESERVE src0_sel:WORD_1
s_setprio 0
v_rcp_f16_sdwa v151, v150 dst_sel:WORD_1 dst_unused:UNUSED_PRESERVE src0_sel:WORD_1
s_waitcnt lgkmcnt(4)
v_mfma_f32_32x32x16_bf16 v[120:135], v[116:119], v[236:239], v[120:135]
ds_read_b128 v[232:235], v249 offset:1024
ds_read_u16_d16 v140, v140
ds_read_u16_d16_hi v141, v141
v_fma_mix_f32 v161, v185, v185, v161 op_sel:[1,1,0] op_sel_hi:[1,1,0]
v_and_b32 v143, s49, v143
v_rcp_f16_sdwa v148, v147 dst_sel:WORD_1 dst_unused:UNUSED_PRESERVE src0_sel:WORD_1
v_rcp_f16_sdwa v145, v144 dst_sel:WORD_1 dst_unused:UNUSED_PRESERVE src0_sel:WORD_1
v_pk_mul_f16 v155, v155, v154
v_lshrrev_b16 v142, 2, v143
v_fma_mix_f32 v161, v186, v186, v161 op_sel:[0,0,0] op_sel_hi:[1,1,0]
v_pk_mul_f16 v152, v152, v151
v_pk_mul_f16 v149, v149, v148
v_smfmac_f32_16x16x32_bf16 v[4:7], v[218:219], v[200:203], v246
ds_read_b128 v[236:239], v249 offset:4096
ds_read_u16_d16 v142, v142
v_pk_mul_f16 v146, v146, v145
v_fma_mix_f32 v162, v155, v155, v162 op_sel:[0,0,0] op_sel_hi:[1,1,0]
v_lshrrev_b32 v143, 18, v143
v_fma_mix_f32 v162, v155, v155, v162 op_sel:[1,1,0] op_sel_hi:[1,1,0]
v_fma_mix_f32 v162, v152, v152, v162 op_sel:[0,0,0] op_sel_hi:[1,1,0]
v_smfmac_f32_16x16x32_bf16 v[32:35], v[216:217], v[204:207], v246
v_fma_mix_f32 v161, v187, v187, v161 op_sel:[1,1,0] op_sel_hi:[1,1,0]
v_fma_mix_f32 v162, v152, v152, v162 op_sel:[1,1,0] op_sel_hi:[1,1,0]
v_fma_mix_f32 v162, v149, v149, v162 op_sel:[0,0,0] op_sel_hi:[1,1,0]
v_fma_mix_f32 v162, v149, v149, v162 op_sel:[1,1,0] op_sel_hi:[1,1,0]
v_fma_mix_f32 v162, v146, v146, v162 op_sel:[0,0,0] op_sel_hi:[1,1,0]
v_fma_mix_f32 v162, v146, v146, v162 op_sel:[1,1,0] op_sel_hi:[1,1,0]
s_setprio 2
v_smfmac_f32_16x16x32_bf16 v[16:19], v[222:223], v[208:211], v246
ds_read_b128 v[216:219], v249 offset:2048
ds_read_u16_d16_hi v143, v143
v_cvt_pkrtz_f16_f32 v179, v120, v121
v_cvt_pkrtz_f16_f32 v181, v122, v123
v_cvt_pkrtz_f16_f32 v183, v124, v125
v_cvt_pkrtz_f16_f32 v185, v126, v127
v_smfmac_f32_16x16x32_bf16 v[0:3], v[220:221], v[212:215], v246
v_cvt_pkrtz_f16_f32 v187, v128, v129
v_cvt_pk_f16_f32 v155, v130, v131
v_cvt_pk_f16_f32 v152, v132, v133
v_cvt_pk_f16_f32 v149, v134, v135
v_pk_fma_f16 v154, v155, v155, s48
s_waitcnt lgkmcnt(2)
v_mfma_f32_32x32x16_bf16 v[120:135], v[96:99], v[224:227], 0
ds_read_b128 v[220:223], v249 offset:5120
v_and_b32 v179, s49, v179
v_fma_mix_f32 v162, v136, v136, v162 op_sel:[0,0,0] op_sel_hi:[1,1,0]
v_pk_fma_f16 v151, v152, v152, s48
v_pk_fma_f16 v148, v149, v149, s48
v_lshrrev_b16 v178, 2, v179
v_pk_mul_f16 v154, v155, v154
v_pk_mul_f16 v151, v152, v151
v_pk_mul_f16 v148, v149, v148
v_lshrrev_b32 v179, 18, v179
v_mfma_f32_32x32x16_bf16 v[120:135], v[100:103], v[228:231], v[120:135]
ds_read_b128 v[224:227], v245 offset:768
v_xor_b32 v243, 16, v243
ds_read_b128 v[192:195], v243 offset:128
ds_read_b128 v[196:199], v243 offset:64
ds_read_u16_d16 v178, v178
ds_read_u16_d16_hi v179, v179
v_fma_mix_f32 v162, v137, v137, v162 op_sel:[1,1,0] op_sel_hi:[1,1,0]
v_exp_f16 v153, v154
v_and_b32 v181, s49, v181
v_exp_f16 v150, v151
v_exp_f16 v147, v148
v_lshrrev_b16 v180, 2, v181
v_mfma_f32_32x32x16_bf16 v[120:135], v[104:107], v[232:235], v[120:135]
ds_read_b128 v[228:231], v245 offset:384
ds_read_b128 v[200:203], v243
v_xor_b32 v242, 16, v242
ds_read_b128 v[204:207], v242 offset:128
ds_read_u16_d16 v180, v180
v_fma_mix_f32 v162, v138, v138, v162 op_sel:[0,0,0] op_sel_hi:[1,1,0]
v_exp_f16_sdwa v153, v154 dst_sel:WORD_1 dst_unused:UNUSED_PRESERVE src0_sel:WORD_1
v_lshrrev_b32 v181, 18, v181
v_exp_f16_sdwa v150, v151 dst_sel:WORD_1 dst_unused:UNUSED_PRESERVE src0_sel:WORD_1
v_fma_mix_f32 v162, v139, v139, v162 op_sel:[1,1,0] op_sel_hi:[1,1,0]
v_and_b32 v183, s49, v183
v_mfma_f32_32x32x16_bf16 v[120:135], v[108:111], v[236:239], v[120:135]
ds_read_b128 v[232:235], v249 offset:6144
ds_read_u16_d16_hi v181, v181
v_exp_f16_sdwa v147, v148 dst_sel:WORD_1 dst_unused:UNUSED_PRESERVE src0_sel:WORD_1
v_pk_add_f16 v153, v153, 1.0 op_sel_hi:[1,0]
v_lshrrev_b16 v182, 2, v183
v_pk_add_f16 v150, v150, 1.0 op_sel_hi:[1,0]
v_pk_add_f16 v147, v147, 1.0 op_sel_hi:[1,0]
v_rcp_f16 v154, v153
v_lshrrev_b32 v183, 18, v183
v_fma_mix_f32 v162, v140, v140, v162 op_sel:[0,0,0] op_sel_hi:[1,1,0]
s_waitcnt lgkmcnt(6)
v_mfma_f32_32x32x16_bf16 v[120:135], v[112:115], v[216:219], v[120:135]
ds_read_b128 v[236:239], v249 offset:9216
ds_read_u16_d16 v182, v182
ds_read_u16_d16_hi v183, v183
v_rcp_f16 v151, v150
v_and_b32 v185, s49, v185
v_rcp_f16 v148, v147
v_fma_mix_f32 v162, v141, v141, v162 op_sel:[1,1,0] op_sel_hi:[1,1,0]
v_lshrrev_b16 v184, 2, v185
v_rcp_f16_sdwa v154, v153 dst_sel:WORD_1 dst_unused:UNUSED_PRESERVE src0_sel:WORD_1
v_mfma_f32_32x32x16_bf16 v[120:135], v[116:119], v[220:223], v[120:135]
ds_read_b128 v[216:219], v249 offset:7168
ds_read_u16_d16 v184, v184
v_rcp_f16_sdwa v151, v150 dst_sel:WORD_1 dst_unused:UNUSED_PRESERVE src0_sel:WORD_1
v_lshrrev_b32 v185, 18, v185
v_rcp_f16_sdwa v148, v147 dst_sel:WORD_1 dst_unused:UNUSED_PRESERVE src0_sel:WORD_1
v_and_b32 v187, s49, v187
v_fma_mix_f32 v162, v142, v142, v162 op_sel:[0,0,0] op_sel_hi:[1,1,0]
v_pk_mul_f16 v155, v155, v154
v_pk_mul_f16 v152, v152, v151
v_smfmac_f32_16x16x32_bf16 v[32:35], v[226:227], v[192:195], v246
ds_read_b128 v[220:223], v249 offset:10240
ds_read_u16_d16_hi v185, v185
v_lshrrev_b16 v186, 2, v187
v_pk_mul_f16 v149, v149, v148
v_fma_mix_f32 v163, v155, v155, v163 op_sel:[0,0,0] op_sel_hi:[1,1,0]
v_fma_mix_f32 v162, v143, v143, v162 op_sel:[1,1,0] op_sel_hi:[1,1,0]
v_lshrrev_b32 v187, 18, v187
v_smfmac_f32_16x16x32_bf16 v[16:19], v[224:225], v[196:199], v246
v_fma_mix_f32 v163, v155, v155, v163 op_sel:[1,1,0] op_sel_hi:[1,1,0]
v_fma_mix_f32 v163, v152, v152, v163 op_sel:[0,0,0] op_sel_hi:[1,1,0]
v_fma_mix_f32 v163, v152, v152, v163 op_sel:[1,1,0] op_sel_hi:[1,1,0]
v_fma_mix_f32 v163, v149, v149, v163 op_sel:[0,0,0] op_sel_hi:[1,1,0]
v_fma_mix_f32 v163, v149, v149, v163 op_sel:[1,1,0] op_sel_hi:[1,1,0]
s_setprio 1
s_waitcnt lgkmcnt(4)
v_smfmac_f32_16x16x32_bf16 v[0:3], v[230:231], v[200:203], v246
ds_read_b128 v[224:227], v249 offset:8192
ds_read_u16_d16 v186, v186
ds_read_u16_d16_hi v187, v187
v_cvt_pkrtz_f16_f32 v137, v120, v121
v_cvt_pkrtz_f16_f32 v139, v122, v123
v_cvt_pkrtz_f16_f32 v141, v124, v125
v_cvt_pkrtz_f16_f32 v143, v126, v127
v_smfmac_f32_16x16x32_bf16 v[32:35], v[228:229], v[204:207], v246
v_cvt_pk_f16_f32 v155, v128, v129
v_cvt_pk_f16_f32 v152, v130, v131
v_cvt_pk_f16_f32 v149, v132, v133
v_cvt_pk_f16_f32 v146, v134, v135
v_pk_fma_f16 v154, v155, v155, s48
v_mfma_f32_32x32x16_bf16 v[120:135], v[96:99], v[232:235], 0
ds_read_b128 v[228:231], v249 offset:11264
v_and_b32 v137, s49, v137
v_fma_mix_f32 v163, v178, v178, v163 op_sel:[0,0,0] op_sel_hi:[1,1,0]
v_pk_fma_f16 v151, v152, v152, s48
v_pk_fma_f16 v148, v149, v149, s48
v_pk_fma_f16 v145, v146, v146, s48
v_pk_mul_f16 v154, v155, v154
v_lshrrev_b16 v136, 2, v137
v_pk_mul_f16 v151, v152, v151
v_fma_mix_f32 v163, v179, v179, v163 op_sel:[1,1,0] op_sel_hi:[1,1,0]
v_pk_mul_f16 v148, v149, v148
v_mfma_f32_32x32x16_bf16 v[120:135], v[100:103], v[236:239], v[120:135]
ds_read_b128 v[232:235], v245
ds_read_b128 v[208:211], v242 offset:64
ds_read_b128 v[212:215], v242
ds_read_u16_d16 v136, v136
v_pk_mul_f16 v145, v146, v145
v_exp_f16 v153, v154
v_lshrrev_b32 v137, 18, v137
v_exp_f16 v150, v151
v_fma_mix_f32 v163, v180, v180, v163 op_sel:[0,0,0] op_sel_hi:[1,1,0]
v_exp_f16 v147, v148
v_and_b32 v139, s49, v139
s_waitcnt lgkmcnt(5)
v_mfma_f32_32x32x16_bf16 v[120:135], v[104:107], v[216:219], v[120:135]
ds_read_b128 v[236:239], v249 offset:12288
ds_read_u16_d16_hi v137, v137
v_exp_f16 v144, v145
v_exp_f16_sdwa v153, v154 dst_sel:WORD_1 dst_unused:UNUSED_PRESERVE src0_sel:WORD_1
v_fma_mix_f32 v163, v181, v181, v163 op_sel:[1,1,0] op_sel_hi:[1,1,0]
v_lshrrev_b16 v138, 2, v139
v_exp_f16_sdwa v150, v151 dst_sel:WORD_1 dst_unused:UNUSED_PRESERVE src0_sel:WORD_1
v_exp_f16_sdwa v147, v148 dst_sel:WORD_1 dst_unused:UNUSED_PRESERVE src0_sel:WORD_1
v_mfma_f32_32x32x16_bf16 v[120:135], v[108:111], v[220:223], v[120:135]
ds_read_b128 v[216:219], v249 offset:15360
ds_read_u16_d16 v138, v138
v_exp_f16_sdwa v144, v145 dst_sel:WORD_1 dst_unused:UNUSED_PRESERVE src0_sel:WORD_1
v_lshrrev_b32 v139, 18, v139
v_fma_mix_f32 v163, v182, v182, v163 op_sel:[0,0,0] op_sel_hi:[1,1,0]
v_pk_add_f16 v153, v153, 1.0 op_sel_hi:[1,0]
v_pk_add_f16 v150, v150, 1.0 op_sel_hi:[1,0]
v_pk_add_f16 v147, v147, 1.0 op_sel_hi:[1,0]
v_and_b32 v141, s49, v141
v_pk_add_f16 v144, v144, 1.0 op_sel_hi:[1,0]
v_mfma_f32_32x32x16_bf16 v[120:135], v[112:115], v[224:227], v[120:135]
ds_read_b128 v[220:223], v249 offset:13312
ds_read_u16_d16_hi v139, v139
v_rcp_f16 v154, v153
v_fma_mix_f32 v163, v183, v183, v163 op_sel:[1,1,0] op_sel_hi:[1,1,0]
v_rcp_f16 v151, v150
v_lshrrev_b16 v140, 2, v141
v_rcp_f16 v148, v147
v_fma_mix_f32 v163, v184, v184, v163 op_sel:[0,0,0] op_sel_hi:[1,1,0]
s_waitcnt lgkmcnt(4)
v_mfma_f32_32x32x16_bf16 v[120:135], v[116:119], v[228:231], v[120:135]
ds_read_b128 v[224:227], v249 offset:16384
ds_read_u16_d16 v140, v140
v_rcp_f16 v145, v144
v_lshrrev_b32 v141, 18, v141
v_rcp_f16_sdwa v154, v153 dst_sel:WORD_1 dst_unused:UNUSED_PRESERVE src0_sel:WORD_1
s_setprio 0
v_rcp_f16_sdwa v151, v150 dst_sel:WORD_1 dst_unused:UNUSED_PRESERVE src0_sel:WORD_1
v_fma_mix_f32 v163, v185, v185, v163 op_sel:[1,1,0] op_sel_hi:[1,1,0]
v_and_b32 v143, s49, v143
v_rcp_f16_sdwa v148, v147 dst_sel:WORD_1 dst_unused:UNUSED_PRESERVE src0_sel:WORD_1
v_smfmac_f32_16x16x32_bf16 v[16:19], v[234:235], v[208:211], v246
ds_read_b128 v[228:231], v249 offset:14336
ds_read_u16_d16_hi v141, v141
v_rcp_f16_sdwa v145, v144 dst_sel:WORD_1 dst_unused:UNUSED_PRESERVE src0_sel:WORD_1
v_pk_mul_f16 v155, v155, v154
v_lshrrev_b16 v142, 2, v143
v_fma_mix_f32 v163, v186, v186, v163 op_sel:[0,0,0] op_sel_hi:[1,1,0]
v_smfmac_f32_16x16x32_bf16 v[0:3], v[232:233], v[212:215], v246
s_mov_b64 exec, 1
ds_add_u32 v253, v254 offset:16
s_mov_b64 exec, -1
v_pk_mul_f16 v152, v152, v151
v_pk_mul_f16 v149, v149, v148
v_pk_mul_f16 v146, v146, v145
v_fma_mix_f32 v164, v155, v155, v164 op_sel:[0,0,0] op_sel_hi:[1,1,0]
v_lshrrev_b32 v143, 18, v143
v_fma_mix_f32 v164, v155, v155, v164 op_sel:[1,1,0] op_sel_hi:[1,1,0]
v_fma_mix_f32 v164, v152, v152, v164 op_sel:[0,0,0] op_sel_hi:[1,1,0]
v_fma_mix_f32 v163, v187, v187, v163 op_sel:[1,1,0] op_sel_hi:[1,1,0]
v_fma_mix_f32 v164, v152, v152, v164 op_sel:[1,1,0] op_sel_hi:[1,1,0]
v_fma_mix_f32 v164, v149, v149, v164 op_sel:[0,0,0] op_sel_hi:[1,1,0]
v_fma_mix_f32 v164, v149, v149, v164 op_sel:[1,1,0] op_sel_hi:[1,1,0]
v_fma_mix_f32 v164, v146, v146, v164 op_sel:[0,0,0] op_sel_hi:[1,1,0]
v_fma_mix_f32 v164, v146, v146, v164 op_sel:[1,1,0] op_sel_hi:[1,1,0]
s_setprio 3
v_pk_add_f32 v[168:169], v[0:1], v[2:3]
v_pk_mul_f32 v[170:171], v[0:1], v[0:1]
v_pk_fma_f32 v[170:171], v[2:3], v[2:3], v[170:171]
v_pk_add_f32 v[168:169], v[168:169], v[4:5]
v_pk_fma_f32 v[170:171], v[4:5], v[4:5], v[170:171]
v_pk_add_f32 v[168:169], v[168:169], v[6:7]
v_pk_fma_f32 v[170:171], v[6:7], v[6:7], v[170:171]
v_pk_add_f32 v[168:169], v[168:169], v[8:9]
v_pk_fma_f32 v[170:171], v[8:9], v[8:9], v[170:171]
v_pk_add_f32 v[168:169], v[168:169], v[10:11]
v_pk_fma_f32 v[170:171], v[10:11], v[10:11], v[170:171]
v_pk_add_f32 v[168:169], v[168:169], v[12:13]
v_pk_fma_f32 v[170:171], v[12:13], v[12:13], v[170:171]
v_pk_add_f32 v[168:169], v[168:169], v[14:15]
v_pk_fma_f32 v[170:171], v[14:15], v[14:15], v[170:171]
v_pk_add_f32 v[168:169], v[168:169], v[16:17]
v_pk_fma_f32 v[170:171], v[16:17], v[16:17], v[170:171]
v_pk_add_f32 v[168:169], v[168:169], v[18:19]
v_pk_fma_f32 v[170:171], v[18:19], v[18:19], v[170:171]
v_pk_add_f32 v[168:169], v[168:169], v[20:21]
v_pk_fma_f32 v[170:171], v[20:21], v[20:21], v[170:171]
v_pk_add_f32 v[168:169], v[168:169], v[22:23]
v_pk_fma_f32 v[170:171], v[22:23], v[22:23], v[170:171]
v_pk_add_f32 v[168:169], v[168:169], v[24:25]
v_pk_fma_f32 v[170:171], v[24:25], v[24:25], v[170:171]
v_pk_add_f32 v[168:169], v[168:169], v[26:27]
v_pk_fma_f32 v[170:171], v[26:27], v[26:27], v[170:171]
v_pk_add_f32 v[168:169], v[168:169], v[28:29]
v_pk_fma_f32 v[170:171], v[28:29], v[28:29], v[170:171]
v_pk_add_f32 v[168:169], v[168:169], v[30:31]
v_pk_fma_f32 v[170:171], v[30:31], v[30:31], v[170:171]
v_pk_add_f32 v[168:169], v[168:169], v[32:33]
v_pk_fma_f32 v[170:171], v[32:33], v[32:33], v[170:171]
v_pk_add_f32 v[168:169], v[168:169], v[34:35]
v_pk_fma_f32 v[170:171], v[34:35], v[34:35], v[170:171]
v_pk_add_f32 v[168:169], v[168:169], v[36:37]
v_pk_fma_f32 v[170:171], v[36:37], v[36:37], v[170:171]
v_pk_add_f32 v[168:169], v[168:169], v[38:39]
v_pk_fma_f32 v[170:171], v[38:39], v[38:39], v[170:171]
v_pk_add_f32 v[168:169], v[168:169], v[40:41]
v_pk_fma_f32 v[170:171], v[40:41], v[40:41], v[170:171]
v_pk_add_f32 v[168:169], v[168:169], v[42:43]
v_pk_fma_f32 v[170:171], v[42:43], v[42:43], v[170:171]
v_pk_add_f32 v[168:169], v[168:169], v[44:45]
v_pk_fma_f32 v[170:171], v[44:45], v[44:45], v[170:171]
v_pk_add_f32 v[168:169], v[168:169], v[46:47]
v_pk_fma_f32 v[170:171], v[46:47], v[46:47], v[170:171]
s_setprio 0
v_lshrrev_b32 v252, 2, v251
v_mul_u32_u24 v252, 192, v252
v_and_b32 v240, 3, v251
v_lshl_add_u32 v252, v240, 4, v252
s_setprio 2
v_cvt_pkrtz_f16_f32 v179, v120, v121
v_cvt_pkrtz_f16_f32 v181, v122, v123
v_cvt_pkrtz_f16_f32 v183, v124, v125
v_cvt_pkrtz_f16_f32 v185, v126, v127
v_cvt_pkrtz_f16_f32 v187, v128, v129
v_cvt_pkrtz_f16_f32 v189, v130, v131
v_cvt_pk_f16_f32 v155, v132, v133
v_cvt_pk_f16_f32 v152, v134, v135
ds_read_b128 v[232:235], v249 offset:17408
ds_read_u16_d16 v142, v142
ds_read_u16_d16_hi v143, v143
v_mfma_f32_32x32x16_bf16 v[120:135], v[96:99], v[236:239], 0
v_pk_fma_f16 v154, v155, v155, s48
v_add_f32 v168, v168, v169
v_and_b32 v179, s49, v179
v_fma_mix_f32 v164, v136, v136, v164 op_sel:[0,0,0] op_sel_hi:[1,1,0]
v_lshrrev_b16 v178, 2, v179
v_pk_fma_f16 v151, v152, v152, s48
v_add_f32 v170, v170, v171
v_pk_mul_f16 v154, v155, v154
v_lshrrev_b32 v179, 18, v179
v_pk_mul_f16 v151, v152, v151
v_fma_mix_f32 v164, v137, v137, v164 op_sel:[1,1,0] op_sel_hi:[1,1,0]
v_and_b32 v181, s49, v181
s_waitcnt lgkmcnt(4)
ds_read_u16_d16 v178, v178
ds_read_u16_d16_hi v179, v179
v_mfma_f32_32x32x16_bf16 v[120:135], v[100:103], v[216:219], v[120:135]
v_permlane32_swap_b32 v168, v170
v_exp_f16 v153, v154
v_lshrrev_b16 v180, 2, v181
v_exp_f16 v150, v151
v_add_f32 v168, v168, v170
v_lshrrev_b32 v181, 18, v181
v_fma_mix_f32 v164, v138, v138, v164 op_sel:[0,0,0] op_sel_hi:[1,1,0]
v_and_b32 v183, s49, v183
v_exp_f16_sdwa v153, v154 dst_sel:WORD_1 dst_unused:UNUSED_PRESERVE src0_sel:WORD_1
ds_read_u16_d16 v180, v180
ds_read_u16_d16_hi v181, v181
v_mfma_f32_32x32x16_bf16 v[120:135], v[104:107], v[220:223], v[120:135]
v_mul_f32 v168, 1009429163, v168
v_lshrrev_b16 v182, 2, v183
v_fma_mix_f32 v164, v139, v139, v164 op_sel:[1,1,0] op_sel_hi:[1,1,0]
v_exp_f16_sdwa v150, v151 dst_sel:WORD_1 dst_unused:UNUSED_PRESERVE src0_sel:WORD_1
v_mov_b32 v170, v168
v_lshrrev_b32 v183, 18, v183
v_pk_add_f16 v153, v153, 1.0 op_sel_hi:[1,0]
v_and_b32 v185, s49, v185
v_fma_mix_f32 v164, v140, v140, v164 op_sel:[0,0,0] op_sel_hi:[1,1,0]
v_lshrrev_b16 v184, 2, v185
v_permlane32_swap_b32 v168, v170
v_pk_add_f16 v150, v150, 1.0 op_sel_hi:[1,0]
ds_read_u16_d16 v182, v182
ds_read_u16_d16_hi v183, v183
ds_read_u16_d16 v184, v184
v_mfma_f32_32x32x16_bf16 v[120:135], v[108:111], v[224:227], v[120:135]
v_rcp_f16 v154, v153
v_lshrrev_b32 v185, 18, v185
v_fma_mix_f32 v164, v141, v141, v164 op_sel:[1,1,0] op_sel_hi:[1,1,0]
v_fma_f32 v170, -v168, v168, v170
v_and_b32 v187, s49, v187
v_rcp_f16 v151, v150
v_lshrrev_b16 v186, 2, v187
v_max_f32 v170, 0, v170
v_rcp_f16_sdwa v154, v153 dst_sel:WORD_1 dst_unused:UNUSED_PRESERVE src0_sel:WORD_1
ds_read_b128 v[224:227], v249 offset:18432
ds_read_u16_d16_hi v185, v185
ds_read_u16_d16 v186, v186
v_mfma_f32_32x32x16_bf16 v[120:135], v[112:115], v[228:231], v[120:135]
v_lshrrev_b32 v187, 18, v187
s_waitcnt lgkmcnt(6)
v_fma_mix_f32 v164, v142, v142, v164 op_sel:[0,0,0] op_sel_hi:[1,1,0]
v_and_b32 v189, s49, v189
v_add_f32 v170, 925353388, v170
v_rcp_f16_sdwa v151, v150 dst_sel:WORD_1 dst_unused:UNUSED_PRESERVE src0_sel:WORD_1
v_lshrrev_b16 v188, 2, v189
v_fma_mix_f32 v164, v143, v143, v164 op_sel:[1,1,0] op_sel_hi:[1,1,0]
v_pk_mul_f16 v155, v155, v154
v_rsq_f32 v170, v170
v_lshrrev_b32 v189, 18, v189
ds_read_b128 v[228:231], v249 offset:21504
ds_read_u16_d16_hi v187, v187
ds_read_b32 v247, v253 offset:16
ds_read_u16_d16 v188, v188
ds_read_u16_d16_hi v189, v189
v_mfma_f32_32x32x16_bf16 v[120:135], v[116:119], v[232:235], v[120:135]
v_pk_mul_f16 v152, v152, v151
v_fma_mix_f32 v165, v155, v155, v165 op_sel:[0,0,0] op_sel_hi:[1,1,0]
v_fma_mix_f32 v165, v178, v178, v165 op_sel:[0,0,0] op_sel_hi:[1,1,0]
v_fma_mix_f32 v165, v179, v179, v165 op_sel:[1,1,0] op_sel_hi:[1,1,0]
v_fma_mix_f32 v165, v180, v180, v165 op_sel:[0,0,0] op_sel_hi:[1,1,0]
v_fma_mix_f32 v165, v155, v155, v165 op_sel:[1,1,0] op_sel_hi:[1,1,0]
v_fma_mix_f32 v165, v181, v181, v165 op_sel:[1,1,0] op_sel_hi:[1,1,0]
s_waitcnt lgkmcnt(5)
v_fma_mix_f32 v165, v182, v182, v165 op_sel:[0,0,0] op_sel_hi:[1,1,0]
v_mul_f32 v172, 3203391086, v170
v_fma_mix_f32 v165, v183, v183, v165 op_sel:[1,1,0] op_sel_hi:[1,1,0]
v_fma_mix_f32 v165, v152, v152, v165 op_sel:[0,0,0] op_sel_hi:[1,1,0]
v_fma_mix_f32 v165, v184, v184, v165 op_sel:[0,0,0] op_sel_hi:[1,1,0]
v_fma_mix_f32 v165, v185, v185, v165 op_sel:[1,1,0] op_sel_hi:[1,1,0]
v_fma_mix_f32 v165, v186, v186, v165 op_sel:[0,0,0] op_sel_hi:[1,1,0]
v_mul_f32 v173, v168, v172
v_fma_mix_f32 v165, v152, v152, v165 op_sel:[1,1,0] op_sel_hi:[1,1,0]
s_waitcnt lgkmcnt(3)
v_fma_mix_f32 v165, v187, v187, v165 op_sel:[1,1,0] op_sel_hi:[1,1,0]
s_waitcnt lgkmcnt(1)
v_fma_mix_f32 v165, v188, v188, v165 op_sel:[0,0,0] op_sel_hi:[1,1,0]
s_waitcnt lgkmcnt(0)
v_fma_mix_f32 v165, v189, v189, v165 op_sel:[1,1,0] op_sel_hi:[1,1,0]
s_setprio 3
v_pk_fma_f32 v[0:1], v[0:1], v[172:173], v[172:173] op_sel:[0,0,1] op_sel_hi:[1,0,1] neg_lo:[0,0,1] neg_hi:[0,0,1]
v_pk_fma_f32 v[2:3], v[2:3], v[172:173], v[172:173] op_sel:[0,0,1] op_sel_hi:[1,0,1] neg_lo:[0,0,1] neg_hi:[0,0,1]
v_pk_fma_f32 v[4:5], v[4:5], v[172:173], v[172:173] op_sel:[0,0,1] op_sel_hi:[1,0,1] neg_lo:[0,0,1] neg_hi:[0,0,1]
v_pk_fma_f32 v[6:7], v[6:7], v[172:173], v[172:173] op_sel:[0,0,1] op_sel_hi:[1,0,1] neg_lo:[0,0,1] neg_hi:[0,0,1]
v_pk_fma_f32 v[8:9], v[8:9], v[172:173], v[172:173] op_sel:[0,0,1] op_sel_hi:[1,0,1] neg_lo:[0,0,1] neg_hi:[0,0,1]
v_pk_fma_f32 v[10:11], v[10:11], v[172:173], v[172:173] op_sel:[0,0,1] op_sel_hi:[1,0,1] neg_lo:[0,0,1] neg_hi:[0,0,1]
v_pk_fma_f32 v[12:13], v[12:13], v[172:173], v[172:173] op_sel:[0,0,1] op_sel_hi:[1,0,1] neg_lo:[0,0,1] neg_hi:[0,0,1]
v_pk_fma_f32 v[14:15], v[14:15], v[172:173], v[172:173] op_sel:[0,0,1] op_sel_hi:[1,0,1] neg_lo:[0,0,1] neg_hi:[0,0,1]
v_pk_fma_f32 v[16:17], v[16:17], v[172:173], v[172:173] op_sel:[0,0,1] op_sel_hi:[1,0,1] neg_lo:[0,0,1] neg_hi:[0,0,1]
v_pk_fma_f32 v[18:19], v[18:19], v[172:173], v[172:173] op_sel:[0,0,1] op_sel_hi:[1,0,1] neg_lo:[0,0,1] neg_hi:[0,0,1]
v_pk_fma_f32 v[20:21], v[20:21], v[172:173], v[172:173] op_sel:[0,0,1] op_sel_hi:[1,0,1] neg_lo:[0,0,1] neg_hi:[0,0,1]
v_pk_fma_f32 v[22:23], v[22:23], v[172:173], v[172:173] op_sel:[0,0,1] op_sel_hi:[1,0,1] neg_lo:[0,0,1] neg_hi:[0,0,1]
v_pk_fma_f32 v[24:25], v[24:25], v[172:173], v[172:173] op_sel:[0,0,1] op_sel_hi:[1,0,1] neg_lo:[0,0,1] neg_hi:[0,0,1]
v_pk_fma_f32 v[26:27], v[26:27], v[172:173], v[172:173] op_sel:[0,0,1] op_sel_hi:[1,0,1] neg_lo:[0,0,1] neg_hi:[0,0,1]
v_pk_fma_f32 v[28:29], v[28:29], v[172:173], v[172:173] op_sel:[0,0,1] op_sel_hi:[1,0,1] neg_lo:[0,0,1] neg_hi:[0,0,1]
v_pk_fma_f32 v[30:31], v[30:31], v[172:173], v[172:173] op_sel:[0,0,1] op_sel_hi:[1,0,1] neg_lo:[0,0,1] neg_hi:[0,0,1]
v_pk_fma_f32 v[32:33], v[32:33], v[172:173], v[172:173] op_sel:[0,0,1] op_sel_hi:[1,0,1] neg_lo:[0,0,1] neg_hi:[0,0,1]
v_pk_fma_f32 v[34:35], v[34:35], v[172:173], v[172:173] op_sel:[0,0,1] op_sel_hi:[1,0,1] neg_lo:[0,0,1] neg_hi:[0,0,1]
v_pk_fma_f32 v[36:37], v[36:37], v[172:173], v[172:173] op_sel:[0,0,1] op_sel_hi:[1,0,1] neg_lo:[0,0,1] neg_hi:[0,0,1]
v_pk_fma_f32 v[38:39], v[38:39], v[172:173], v[172:173] op_sel:[0,0,1] op_sel_hi:[1,0,1] neg_lo:[0,0,1] neg_hi:[0,0,1]
v_pk_fma_f32 v[40:41], v[40:41], v[172:173], v[172:173] op_sel:[0,0,1] op_sel_hi:[1,0,1] neg_lo:[0,0,1] neg_hi:[0,0,1]
v_pk_fma_f32 v[42:43], v[42:43], v[172:173], v[172:173] op_sel:[0,0,1] op_sel_hi:[1,0,1] neg_lo:[0,0,1] neg_hi:[0,0,1]
v_pk_fma_f32 v[44:45], v[44:45], v[172:173], v[172:173] op_sel:[0,0,1] op_sel_hi:[1,0,1] neg_lo:[0,0,1] neg_hi:[0,0,1]
v_pk_fma_f32 v[46:47], v[46:47], v[172:173], v[172:173] op_sel:[0,0,1] op_sel_hi:[1,0,1] neg_lo:[0,0,1] neg_hi:[0,0,1]
s_setprio 2
v_readfirstlane_b32 s43, v247
s_nop 1
s_cmp_ge_u32 s43, 32
s_cbranch_scc1 Lev9
Lev9w:
s_sleep 1
ds_read_b32 v247, v253 offset:16
s_waitcnt lgkmcnt(0)
v_readfirstlane_b32 s43, v247
s_cmp_eq_u32 s76, 0
s_cbranch_scc1 Lev9
s_sub_u32 s76, s76, 1
s_cmp_lt_u32 s43, 32
s_cbranch_scc1 Lev9w
Lev9:
s_setprio 1
v_cvt_pkrtz_f16_f32 v137, v120, v121
v_cvt_pkrtz_f16_f32 v139, v122, v123
v_cvt_pkrtz_f16_f32 v141, v124, v125
v_cvt_pkrtz_f16_f32 v143, v126, v127
v_cvt_pkrtz_f16_f32 v145, v128, v129
v_cvt_pkrtz_f16_f32 v147, v130, v131
v_cvt_pk_f16_f32 v155, v132, v133
v_cvt_pk_f16_f32 v152, v134, v135
s_add_u32 m0, s72, 0
s_add_u32 s43, s82, 0
buffer_load_dwordx4 v252, s[16:19], s43 offen lds
ds_read_b128 v[232:235], v249 offset:19456
ds_read_b128 v[236:239], v249 offset:22528
v_mfma_f32_32x32x16_bf16 v[120:135], v[224:227], v[96:99], 0
v_pk_fma_f16 v154, v155, v155, s48
v_and_b32 v192, 1, v251
v_cvt_pk_bf16_f32 v168, v0, v1
v_and_b32 v137, s49, v137
v_pk_fma_f16 v151, v152, v152, s48
v_cvt_pk_bf16_f32 v169, v2, v3
v_lshlrev_b32 v192, 4, v192
v_and_b32 v139, s49, v139
v_pk_mul_f16 v154, v155, v154
v_cvt_pk_bf16_f32 v170, v4, v5
v_lshrrev_b16 v136, 2, v137
v_mov_b32 v193, 15360
v_pk_mul_f16 v151, v152, v151
v_lshrrev_b16 v138, 2, v139
v_cvt_pk_bf16_f32 v171, v6, v7
ds_read_b128 v[224:227], v249 offset:20480
ds_read_u16_d16 v136, v136
ds_read_u16_d16 v138, v138
v_mfma_f32_32x32x16_bf16 v[120:135], v[228:231], v[100:103], v[120:135]
v_exp_f16 v153, v154
v_lshlrev_b32 v192, v192, v193
v_cvt_pk_bf16_f32 v172, v8, v9
v_lshrrev_b32 v137, 18, v137
v_exp_f16 v150, v151
v_lshrrev_b32 v193, 3, v251
v_cvt_pk_bf16_f32 v173, v10, v11
v_lshrrev_b32 v139, 18, v139
v_and_b32 v141, s49, v141
v_xor_b32 v193, v193, v251
v_cvt_pk_bf16_f32 v174, v12, v13
v_exp_f16_sdwa v153, v154 dst_sel:WORD_1 dst_unused:UNUSED_PRESERVE src0_sel:WORD_1
v_cvt_pk_bf16_f32 v175, v14, v15
v_and_b32 v193, 4, v193
s_waitcnt lgkmcnt(3)
s_add_u32 m0, s72, 1024
s_add_u32 s43, s82, 64
buffer_load_dwordx4 v252, s[16:19], s43 offen lds
ds_read_b128 v[228:231], v249 offset:23552
ds_read_u16_d16_hi v137, v137
ds_read_u16_d16_hi v139, v139
v_mfma_f32_32x32x16_bf16 v[120:135], v[232:235], v[104:107], v[120:135]
v_and_b32 v143, s49, v143
v_lshrrev_b16 v140, 2, v141
v_exp_f16_sdwa v150, v151 dst_sel:WORD_1 dst_unused:UNUSED_PRESERVE src0_sel:WORD_1
v_bfe_u32 v194, v251, 3, 2
v_cvt_pk_bf16_f32 v176, v16, v17
v_lshrrev_b16 v142, 2, v143
v_cvt_pk_bf16_f32 v177, v18, v19
v_pk_add_f16 v153, v153, 1.0 op_sel_hi:[1,0]
v_lshl_add_u32 v193, v193, 1, 0
v_lshrrev_b32 v141, 18, v141
v_pk_add_f16 v150, v150, 1.0 op_sel_hi:[1,0]
v_cvt_pk_bf16_f32 v178, v20, v21
v_lshrrev_b32 v143, 18, v143
v_lshl_add_u32 v193, v194, 1, v193
ds_read_b128 v[232:235], v248 offset:16384
ds_read_u16_d16 v140, v140
ds_read_u16_d16 v142, v142
ds_read_u16_d16_hi v141, v141
ds_read_u16_d16_hi v143, v143
v_mfma_f32_32x32x16_bf16 v[120:135], v[236:239], v[108:111], v[120:135]
v_rcp_f16 v154, v153
v_cvt_pk_bf16_f32 v179, v22, v23
v_and_b32 v145, s49, v145
v_and_b32 v147, s49, v147
v_bfe_u32 v194, v251, 1, 1
v_cvt_pk_bf16_f32 v180, v24, v25
v_rcp_f16 v151, v150
v_cvt_pk_bf16_f32 v181, v26, v27
v_add_u32 v193, v193, v194
v_lshrrev_b16 v144, 2, v145
v_rcp_f16_sdwa v154, v153 dst_sel:WORD_1 dst_unused:UNUSED_PRESERVE src0_sel:WORD_1
v_cvt_pk_bf16_f32 v182, v28, v29
v_cmp_eq_u32 vcc, 0, v193
s_nop 1
v_cndmask_b32 v240, 0, v192, vcc
v_lshrrev_b16 v146, 2, v147
s_waitcnt lgkmcnt(5)
s_add_u32 m0, s72, 2048
s_add_u32 s43, s82, 128
buffer_load_dwordx4 v252, s[16:19], s43 offen lds
ds_read_b128 v[236:239], v248 offset:19456
ds_read_u16_d16 v144, v144
ds_read_u16_d16 v146, v146
v_mfma_f32_32x32x16_bf16 v[120:135], v[224:227], v[112:115], v[120:135]
v_lshrrev_b32 v145, 18, v145
v_cvt_pk_bf16_f32 v183, v30, v31
v_rcp_f16_sdwa v151, v150 dst_sel:WORD_1 dst_unused:UNUSED_PRESERVE src0_sel:WORD_1
v_cmp_eq_u32 vcc, 1, v193
s_nop 1
v_cndmask_b32 v241, 0, v192, vcc
v_cvt_pk_bf16_f32 v184, v32, v33
s_setprio 0
v_lshrrev_b32 v147, 18, v147
v_pk_mul_f16 v155, v155, v154
v_cmp_eq_u32 vcc, 2, v193
s_nop 1
v_cndmask_b32 v242, 0, v192, vcc
v_fma_mix_f32 v166, v136, v136, v166 op_sel:[0,0,0] op_sel_hi:[1,1,0]
v_cvt_pk_bf16_f32 v185, v34, v35
v_fma_mix_f32 v166, v137, v137, v166 op_sel:[1,1,0] op_sel_hi:[1,1,0]
v_pk_mul_f16 v152, v152, v151
v_cmp_eq_u32 vcc, 3, v193
s_nop 1
v_cndmask_b32 v243, 0, v192, vcc
v_cvt_pk_bf16_f32 v186, v36, v37
v_fma_mix_f32 v166, v138, v138, v166 op_sel:[0,0,0] op_sel_hi:[1,1,0]
ds_read_b128 v[224:227], v248 offset:17408
ds_read_u16_d16_hi v145, v145
ds_read_u16_d16_hi v147, v147
v_mfma_f32_32x32x16_bf16 v[120:135], v[228:231], v[116:119], v[120:135]
v_fma_mix_f32 v166, v139, v139, v166 op_sel:[1,1,0] op_sel_hi:[1,1,0]
v_cvt_pk_bf16_f32 v187, v38, v39
v_cmp_eq_u32 vcc, 4, v193
s_nop 1
v_cndmask_b32 v244, 0, v192, vcc
v_fma_mix_f32 v166, v155, v155, v166 op_sel:[0,0,0] op_sel_hi:[1,1,0]
s_waitcnt lgkmcnt(3)
v_fma_mix_f32 v166, v140, v140, v166 op_sel:[0,0,0] op_sel_hi:[1,1,0]
v_fma_mix_f32 v166, v141, v141, v166 op_sel:[1,1,0] op_sel_hi:[1,1,0]
v_cvt_pk_bf16_f32 v188, v40, v41
v_cmp_eq_u32 vcc, 5, v193
s_nop 1
v_cndmask_b32 v245, 0, v192, vcc
v_fma_mix_f32 v166, v155, v155, v166 op_sel:[1,1,0] op_sel_hi:[1,1,0]
v_fma_mix_f32 v166, v142, v142, v166 op_sel:[0,0,0] op_sel_hi:[1,1,0]
v_cvt_pk_bf16_f32 v189, v42, v43
v_fma_mix_f32 v166, v143, v143, v166 op_sel:[1,1,0] op_sel_hi:[1,1,0]
v_cmp_eq_u32 vcc, 6, v193
s_nop 1
v_cndmask_b32 v246, 0, v192, vcc
v_fma_mix_f32 v166, v152, v152, v166 op_sel:[0,0,0] op_sel_hi:[1,1,0]
v_fma_mix_f32 v166, v144, v144, v166 op_sel:[0,0,0] op_sel_hi:[1,1,0]
v_cvt_pk_bf16_f32 v190, v44, v45
s_waitcnt lgkmcnt(0)
v_fma_mix_f32 v166, v145, v145, v166 op_sel:[1,1,0] op_sel_hi:[1,1,0]
v_cmp_eq_u32 vcc, 7, v193
s_nop 1
v_cndmask_b32 v247, 0, v192, vcc
v_fma_mix_f32 v166, v152, v152, v166 op_sel:[1,1,0] op_sel_hi:[1,1,0]
v_cvt_pk_bf16_f32 v191, v46, v47
v_fma_mix_f32 v166, v146, v146, v166 op_sel:[0,0,0] op_sel_hi:[1,1,0]
v_fma_mix_f32 v166, v147, v147, v166 op_sel:[1,1,0] op_sel_hi:[1,1,0]
s_setprio 2
v_cvt_pkrtz_f16_f32 v137, v120, v121
v_cvt_pkrtz_f16_f32 v139, v122, v123
v_cvt_pkrtz_f16_f32 v141, v124, v125
v_cvt_pkrtz_f16_f32 v143, v126, v127
v_cvt_pkrtz_f16_f32 v145, v128, v129
v_cvt_pk_f16_f32 v155, v130, v131
v_cvt_pk_f16_f32 v152, v132, v133
v_cvt_pk_f16_f32 v149, v134, v135
s_add_u32 m0, s72, 3072
s_add_u32 s43, s82, 3072
buffer_load_dwordx4 v252, s[16:19], s43 offen lds
ds_read_b128 v[228:231], v248 offset:20480
v_mfma_f32_32x32x16_bf16 v[120:135], v[232:235], v[168:171], 0
v_pk_fma_f16 v154, v155, v155, s48
v_mov_b32 v88, v48
v_and_b32 v137, s49, v137
v_pk_fma_f16 v151, v152, v152, s48
v_and_b32 v139, s49, v139
v_pk_fma_f16 v148, v149, v149, s48
v_pk_mul_f16 v154, v155, v154
v_lshrrev_b16 v136, 2, v137
v_pk_mul_f16 v151, v152, v151
ds_read_b128 v[232:235], v248 offset:18432
ds_read_u16_d16 v136, v136
v_mfma_f32_32x32x16_bf16 v[120:135], v[236:239], v[172:175], v[120:135]
v_mov_b32 v89, v49
v_pk_mul_f16 v148, v149, v148
v_lshrrev_b16 v138, 2, v139
v_exp_f16 v153, v154
v_lshrrev_b32 v137, 18, v137
v_exp_f16 v150, v151
v_mov_b32 v90, v50
v_lshrrev_b32 v139, 18, v139
s_add_u32 m0, s72, 4096
s_add_u32 s43, s82, 3136
buffer_load_dwordx4 v252, s[16:19], s43 offen lds
ds_read_b128 v[236:239], v248 offset:21504
ds_read_u16_d16 v138, v138
ds_read_u16_d16_hi v137, v137
ds_read_u16_d16_hi v139, v139
v_mfma_f32_32x32x16_bf16 v[120:135], v[224:227], v[176:179], v[120:135]
v_exp_f16 v147, v148
v_and_b32 v141, s49, v141
v_and_b32 v143, s49, v143
v_exp_f16_sdwa v153, v154 dst_sel:WORD_1 dst_unused:UNUSED_PRESERVE src0_sel:WORD_1
v_mov_b32 v91, v51
v_lshrrev_b16 v140, 2, v141
s_waitcnt lgkmcnt(5)
ds_read_b128 v[224:227], v248 offset:22528
ds_read_u16_d16 v140, v140
v_mfma_f32_32x32x16_bf16 v[120:135], v[228:231], v[180:183], v[120:135]
v_exp_f16_sdwa v150, v151 dst_sel:WORD_1 dst_unused:UNUSED_PRESERVE src0_sel:WORD_1
v_lshrrev_b16 v142, 2, v143
v_exp_f16_sdwa v147, v148 dst_sel:WORD_1 dst_unused:UNUSED_PRESERVE src0_sel:WORD_1
v_lshrrev_b32 v141, 18, v141
v_mov_b32 v92, v52
v_pk_add_f16 v153, v153, 1.0 op_sel_hi:[1,0]
v_lshrrev_b32 v143, 18, v143
v_pk_add_f16 v150, v150, 1.0 op_sel_hi:[1,0]
v_pk_add_f16 v147, v147, 1.0 op_sel_hi:[1,0]
s_add_u32 m0, s72, 5120
s_add_u32 s43, s82, 3200
buffer_load_dwordx4 v252, s[16:19], s43 offen lds
ds_read_b128 v[228:231], v248 offset:25600
ds_read_u16_d16 v142, v142
ds_read_u16_d16_hi v141, v141
ds_read_u16_d16_hi v143, v143
v_mfma_f32_32x32x16_bf16 v[120:135], v[232:235], v[184:187], v[120:135]
v_and_b32 v145, s49, v145
v_rcp_f16 v154, v153
v_mov_b32 v93, v53
v_lshrrev_b16 v144, 2, v145
v_rcp_f16 v151, v150
v_lshrrev_b32 v145, 18, v145
v_rcp_f16 v148, v147
s_waitcnt lgkmcnt(4)
ds_read_b128 v[232:235], v248 offset:23552
ds_read_u16_d16 v144, v144
ds_read_u16_d16_hi v145, v145
v_mfma_f32_32x32x16_bf16 v[120:135], v[236:239], v[188:191], v[120:135]
v_or_b32 v216, v136, v137
v_mov_b32 v94, v54
v_or_b32 v217, v138, v139
v_rcp_f16_sdwa v154, v153 dst_sel:WORD_1 dst_unused:UNUSED_PRESERVE src0_sel:WORD_1
s_waitcnt lgkmcnt(4)
v_or_b32 v218, v140, v141
v_rcp_f16_sdwa v151, v150 dst_sel:WORD_1 dst_unused:UNUSED_PRESERVE src0_sel:WORD_1
s_waitcnt lgkmcnt(3)
v_or_b32 v219, v142, v143
v_mov_b32 v95, v55
v_rcp_f16_sdwa v148, v147 dst_sel:WORD_1 dst_unused:UNUSED_PRESERVE src0_sel:WORD_1
s_waitcnt lgkmcnt(0)
v_or_b32 v220, v144, v145
v_pk_mul_f16 v221, v155, v154
v_pk_mul_f16 v222, v152, v151
v_pk_mul_f16 v223, v149, v148
s_cmp_lg_u32 s40, 0
s_cbranch_scc1 Lrs0
v_mov_b32 v82, 0
buffer_load_dword v83, v82, s[36:39], 0 offen sc1
Lrs0:
s_setprio 1
s_add_u32 m0, s72, 6144
s_add_u32 s43, s82, 6144
buffer_load_dwordx4 v252, s[16:19], s43 offen lds
ds_read_b128 v[236:239], v248 offset:26624
v_mfma_f32_32x32x16_f16 v[192:207], v[216:219], v[240:243], 0
v_cvt_pkrtz_f16_f32 v137, v120, v121
v_cvt_pkrtz_f16_f32 v139, v122, v123
v_cvt_pkrtz_f16_f32 v141, v124, v125
v_cvt_pkrtz_f16_f32 v143, v126, v127
v_cvt_pkrtz_f16_f32 v145, v128, v129
v_mfma_f32_32x32x16_f16 v[192:207], v[220:223], v[244:247], v[192:207]
v_cvt_pkrtz_f16_f32 v147, v130, v131
v_cvt_pk_f16_f32 v155, v132, v133
v_cvt_pk_f16_f32 v152, v134, v135
v_pk_fma_f16 v154, v155, v155, s48
v_mov_b32 v208, v56
v_and_b32 v255, 51, v251
v_mfma_f32_32x32x16_bf16 v[120:135], v[224:227], v[168:171], 0
v_and_b32 v137, s49, v137
v_pk_fma_f16 v151, v152, v152, s48
v_and_b32 v139, s49, v139
v_pk_mul_f16 v154, v155, v154
v_lshrrev_b16 v136, 2, v137
v_pk_mul_f16 v151, v152, v151
v_lshrrev_b16 v138, 2, v139
v_mov_b32 v209, v57
v_exp_f16 v153, v154
v_fmac_f32 v167, v192, v192
ds_read_b128 v[224:227], v248 offset:24576
ds_read_u16_d16 v136, v136
ds_read_u16_d16 v138, v138
v_mfma_f32_32x32x16_bf16 v[120:135], v[228:231], v[172:175], v[120:135]
v_bfe_u32 v87, v251, 2, 1
v_lshrrev_b32 v137, 18, v137
v_fmac_f32 v167, v193, v193
v_exp_f16 v150, v151
v_lshrrev_b32 v139, 18, v139
v_mov_b32 v210, v58
v_fmac_f32 v167, v194, v194
v_and_b32 v141, s49, v141
v_exp_f16_sdwa v153, v154 dst_sel:WORD_1 dst_unused:UNUSED_PRESERVE src0_sel:WORD_1
v_fmac_f32 v167, v195, v195
ds_read_b128 v[228:231], v248 offset:27648
ds_read_u16_d16_hi v137, v137
ds_read_u16_d16_hi v139, v139
v_mfma_f32_32x32x16_bf16 v[120:135], v[232:235], v[176:179], v[120:135]
v_and_b32 v143, s49, v143
v_lshl_add_u32 v255, v87, 3, v255
v_lshrrev_b16 v140, 2, v141
v_fmac_f32 v167, v196, v196
v_mov_b32 v211, v59
v_exp_f16_sdwa v150, v151 dst_sel:WORD_1 dst_unused:UNUSED_PRESERVE src0_sel:WORD_1
v_fmac_f32 v167, v197, v197
v_lshrrev_b16 v142, 2, v143
v_pk_add_f16 v153, v153, 1.0 op_sel_hi:[1,0]
v_lshrrev_b32 v141, 18, v141
s_waitcnt lgkmcnt(3)
ds_read_b128 v[232:235], v248 offset:28672
ds_read_u16_d16 v140, v140
ds_read_u16_d16 v142, v142
ds_read_u16_d16_hi v141, v141
v_mfma_f32_32x32x16_bf16 v[120:135], v[236:239], v[180:183], v[120:135]
v_fmac_f32 v167, v198, v198
v_pk_add_f16 v150, v150, 1.0 op_sel_hi:[1,0]
v_lshrrev_b32 v143, 18, v143
v_mov_b32 v212, v60
v_bfe_u32 v87, v251, 3, 1
v_fmac_f32 v167, v199, v199
v_rcp_f16 v154, v153
v_and_b32 v145, s49, v145
v_fmac_f32 v167, v200, v200
v_and_b32 v147, s49, v147
ds_read_b128 v[236:239], v248 offset:31744
ds_read_u16_d16_hi v143, v143
v_mfma_f32_32x32x16_bf16 v[120:135], v[224:227], v[184:187], v[120:135]
v_rcp_f16 v151, v150
v_mov_b32 v213, v61
v_fmac_f32 v167, v201, v201
v_lshrrev_b16 v144, 2, v145
s_setprio 0
v_lshl_add_u32 v255, v87, 2, v255
v_rcp_f16_sdwa v154, v153 dst_sel:WORD_1 dst_unused:UNUSED_PRESERVE src0_sel:WORD_1
v_fmac_f32 v167, v202, v202
v_lshrrev_b16 v146, 2, v147
v_fmac_f32 v167, v203, v203
v_mov_b32 v214, v62
s_waitcnt lgkmcnt(2)
ds_read_b128 v[224:227], v248 offset:29696
ds_read_u16_d16 v144, v144
ds_read_u16_d16 v146, v146
v_mfma_f32_32x32x16_bf16 v[120:135], v[228:231], v[188:191], v[120:135]
v_lshrrev_b32 v145, 18, v145
v_rcp_f16_sdwa v151, v150 dst_sel:WORD_1 dst_unused:UNUSED_PRESERVE src0_sel:WORD_1
v_fmac_f32 v167, v204, v204
v_lshrrev_b32 v147, 18, v147
v_or_b32 v0, v136, v137
v_lshl_add_u32 v255, v255, 2, s72
v_fmac_f32 v167, v205, v205
v_or_b32 v1, v138, v139
v_mov_b32 v215, v63
v_or_b32 v2, v140, v141
s_waitcnt lgkmcnt(3)
v_or_b32 v3, v142, v143
v_fmac_f32 v167, v206, v206
ds_read_u16_d16_hi v145, v145
ds_read_u16_d16_hi v147, v147
s_waitcnt lgkmcnt(1)
v_or_b32 v4, v144, v145
s_waitcnt lgkmcnt(0)
v_or_b32 v5, v146, v147
v_fmac_f32 v167, v207, v207
v_pk_mul_f16 v6, v155, v154
v_pk_mul_f16 v7, v152, v151
s_setprio 2
ds_read_b128 v[228:231], v248 offset:32768
v_mfma_f32_32x32x16_f16 v[192:207], v[0:3], v[240:243], 0
v_cvt_pkrtz_f16_f32 v137, v120, v121
v_cvt_pkrtz_f16_f32 v139, v122, v123
v_cvt_pkrtz_f16_f32 v141, v124, v125
v_cvt_pkrtz_f16_f32 v143, v126, v127
v_cvt_pkrtz_f16_f32 v145, v128, v129
v_mfma_f32_32x32x16_f16 v[192:207], v[4:7], v[244:247], v[192:207]
v_cvt_pk_f16_f32 v155, v130, v131
v_cvt_pk_f16_f32 v152, v132, v133
v_cvt_pk_f16_f32 v149, v134, v135
v_pk_fma_f16 v154, v155, v155, s48
v_and_b32 v137, s49, v137
v_mfma_f32_32x32x16_bf16 v[120:135], v[232:235], v[168:171], 0
v_pk_fma_f16 v151, v152, v152, s48
v_and_b32 v139, s49, v139
v_pk_fma_f16 v148, v149, v149, s48
v_pk_mul_f16 v154, v155, v154
v_lshrrev_b16 v136, 2, v137
v_pk_mul_f16 v151, v152, v151
v_pk_mul_f16 v148, v149, v148
v_lshrrev_b16 v138, 2, v139
v_fmac_f32 v156, v192, v192
v_exp_f16 v153, v154
ds_read_b128 v[232:235], v248 offset:30720
ds_read_u16_d16 v136, v136
ds_read_u16_d16 v138, v138
v_mfma_f32_32x32x16_bf16 v[120:135], v[236:239], v[172:175], v[120:135]
v_fmac_f32 v156, v193, v193
v_lshrrev_b32 v137, 18, v137
v_exp_f16 v150, v151
v_fmac_f32 v156, v194, v194
v_lshrrev_b32 v139, 18, v139
v_exp_f16 v147, v148
v_fmac_f32 v156, v195, v195
v_and_b32 v141, s49, v141
ds_read_b128 v[236:239], v248 offset:33792
ds_read_u16_d16_hi v137, v137
ds_read_u16_d16_hi v139, v139
v_mfma_f32_32x32x16_bf16 v[120:135], v[224:227], v[176:179], v[120:135]
v_and_b32 v143, s49, v143
v_exp_f16_sdwa v153, v154 dst_sel:WORD_1 dst_unused:UNUSED_PRESERVE src0_sel:WORD_1
v_fmac_f32 v156, v196, v196
v_lshrrev_b16 v140, 2, v141
v_exp_f16_sdwa v150, v151 dst_sel:WORD_1 dst_unused:UNUSED_PRESERVE src0_sel:WORD_1
v_fmac_f32 v156, v197, v197
v_lshrrev_b16 v142, 2, v143
v_exp_f16_sdwa v147, v148 dst_sel:WORD_1 dst_unused:UNUSED_PRESERVE src0_sel:WORD_1
s_waitcnt lgkmcnt(6)
ds_read_b128 v[224:227], v248 offset:34816
ds_read_u16_d16 v140, v140
ds_read_u16_d16 v142, v142
v_mfma_f32_32x32x16_bf16 v[120:135], v[228:231], v[180:183], v[120:135]
v_fmac_f32 v156, v198, v198
v_lshrrev_b32 v141, 18, v141
v_pk_add_f16 v153, v153, 1.0 op_sel_hi:[1,0]
v_fmac_f32 v156, v199, v199
v_lshrrev_b32 v143, 18, v143
v_pk_add_f16 v150, v150, 1.0 op_sel_hi:[1,0]
v_pk_add_f16 v147, v147, 1.0 op_sel_hi:[1,0]
v_fmac_f32 v156, v200, v200
v_and_b32 v145, s49, v145
s_waitcnt lgkmcnt(4)
ds_read_b128 v[228:231], v248 offset:37888
ds_read_u16_d16_hi v141, v141
ds_read_u16_d16_hi v143, v143
v_mfma_f32_32x32x16_bf16 v[120:135], v[232:235], v[184:187], v[120:135]
v_rcp_f16 v154, v153
v_fmac_f32 v156, v201, v201
v_lshrrev_b16 v144, 2, v145
v_rcp_f16 v151, v150
v_fmac_f32 v156, v202, v202
v_lshrrev_b32 v145, 18, v145
v_rcp_f16 v148, v147
v_fmac_f32 v156, v203, v203
v_or_b32 v8, v136, v137
ds_read_b128 v[232:235], v248 offset:35840
ds_read_u16_d16 v144, v144
ds_read_u16_d16_hi v145, v145
v_mfma_f32_32x32x16_bf16 v[120:135], v[236:239], v[188:191], v[120:135]
s_waitcnt lgkmcnt(6)
v_or_b32 v9, v138, v139
v_rcp_f16_sdwa v154, v153 dst_sel:WORD_1 dst_unused:UNUSED_PRESERVE src0_sel:WORD_1
v_fmac_f32 v156, v204, v204
s_waitcnt lgkmcnt(4)
v_or_b32 v10, v140, v141
v_rcp_f16_sdwa v151, v150 dst_sel:WORD_1 dst_unused:UNUSED_PRESERVE src0_sel:WORD_1
v_fmac_f32 v156, v205, v205
s_waitcnt lgkmcnt(3)
v_or_b32 v11, v142, v143
v_rcp_f16_sdwa v148, v147 dst_sel:WORD_1 dst_unused:UNUSED_PRESERVE src0_sel:WORD_1
v_fmac_f32 v156, v206, v206
s_waitcnt lgkmcnt(0)
v_or_b32 v12, v144, v145
v_pk_mul_f16 v13, v155, v154
v_fmac_f32 v156, v207, v207
v_pk_mul_f16 v14, v152, v151
v_pk_mul_f16 v15, v149, v148
s_setprio 1
ds_read_b128 v[236:239], v248 offset:38912
v_mfma_f32_32x32x16_f16 v[192:207], v[8:11], v[240:243], 0
v_cvt_pkrtz_f16_f32 v137, v120, v121
v_cvt_pkrtz_f16_f32 v139, v122, v123
v_cvt_pkrtz_f16_f32 v141, v124, v125
v_cvt_pkrtz_f16_f32 v143, v126, v127
v_mfma_f32_32x32x16_f16 v[192:207], v[12:15], v[244:247], v[192:207]
v_cvt_pkrtz_f16_f32 v145, v128, v129
v_cvt_pkrtz_f16_f32 v147, v130, v131
v_cvt_pk_f16_f32 v155, v132, v133
v_cvt_pk_f16_f32 v152, v134, v135
v_pk_fma_f16 v154, v155, v155, s48
v_mfma_f32_32x32x16_bf16 v[120:135], v[224:227], v[168:171], 0
v_and_b32 v137, s49, v137
v_pk_fma_f16 v151, v152, v152, s48
v_and_b32 v139, s49, v139
v_pk_mul_f16 v154, v155, v154
v_lshrrev_b16 v136, 2, v137
v_pk_mul_f16 v151, v152, v151
v_lshrrev_b16 v138, 2, v139
v_exp_f16 v153, v154
v_fmac_f32 v157, v192, v192
ds_read_b128 v[224:227], v248 offset:36864
ds_read_u16_d16 v136, v136
ds_read_u16_d16 v138, v138
v_mfma_f32_32x32x16_bf16 v[120:135], v[228:231], v[172:175], v[120:135]
v_lshrrev_b32 v137, 18, v137
v_fmac_f32 v157, v193, v193
v_exp_f16 v150, v151
v_fmac_f32 v157, v194, v194
v_lshrrev_b32 v139, 18, v139
v_and_b32 v141, s49, v141
v_fmac_f32 v157, v195, v195
v_exp_f16_sdwa v153, v154 dst_sel:WORD_1 dst_unused:UNUSED_PRESERVE src0_sel:WORD_1
ds_read_b128 v[228:231], v248 offset:39936
ds_read_u16_d16_hi v137, v137
ds_read_u16_d16_hi v139, v139
v_mfma_f32_32x32x16_bf16 v[120:135], v[232:235], v[176:179], v[120:135]
v_fmac_f32 v157, v196, v196
v_and_b32 v143, s49, v143
v_lshrrev_b16 v140, 2, v141
v_fmac_f32 v157, v197, v197
v_exp_f16_sdwa v150, v151 dst_sel:WORD_1 dst_unused:UNUSED_PRESERVE src0_sel:WORD_1
v_fmac_f32 v157, v198, v198
v_lshrrev_b16 v142, 2, v143
v_pk_add_f16 v153, v153, 1.0 op_sel_hi:[1,0]
v_fmac_f32 v157, v199, v199
s_waitcnt lgkmcnt(5)
ds_read_b128 v[232:235], v248 offset:40960
ds_read_u16_d16 v140, v140
ds_read_u16_d16 v142, v142
v_mfma_f32_32x32x16_bf16 v[120:135], v[236:239], v[180:183], v[120:135]
v_lshrrev_b32 v141, 18, v141
v_pk_add_f16 v150, v150, 1.0 op_sel_hi:[1,0]
v_fmac_f32 v157, v200, v200
v_lshrrev_b32 v143, 18, v143
v_rcp_f16 v154, v153
v_fmac_f32 v157, v201, v201
v_and_b32 v145, s49, v145
v_and_b32 v147, s49, v147
v_fmac_f32 v157, v202, v202
ds_read_b128 v[236:239], v248 offset:44032
ds_read_u16_d16_hi v141, v141
ds_read_u16_d16_hi v143, v143
v_mfma_f32_32x32x16_bf16 v[120:135], v[224:227], v[184:187], v[120:135]
v_rcp_f16 v151, v150
v_fmac_f32 v157, v203, v203
v_lshrrev_b16 v144, 2, v145
s_setprio 0
v_rcp_f16_sdwa v154, v153 dst_sel:WORD_1 dst_unused:UNUSED_PRESERVE src0_sel:WORD_1
v_fmac_f32 v157, v204, v204
v_lshrrev_b16 v146, 2, v147
v_fmac_f32 v157, v205, v205
v_lshrrev_b32 v145, 18, v145
s_waitcnt lgkmcnt(4)
ds_read_b128 v[224:227], v248 offset:41984
ds_read_u16_d16 v144, v144
ds_read_u16_d16 v146, v146
ds_read_u16_d16_hi v145, v145
v_mfma_f32_32x32x16_bf16 v[120:135], v[228:231], v[188:191], v[120:135]
v_rcp_f16_sdwa v151, v150 dst_sel:WORD_1 dst_unused:UNUSED_PRESERVE src0_sel:WORD_1
v_fmac_f32 v157, v206, v206
v_lshrrev_b32 v147, 18, v147
v_fmac_f32 v157, v207, v207
v_or_b32 v16, v136, v137
v_or_b32 v17, v138, v139
v_permlane32_swap_b32 v156, v157
s_waitcnt lgkmcnt(5)
v_or_b32 v18, v140, v141
s_waitcnt lgkmcnt(4)
v_or_b32 v19, v142, v143
s_waitcnt lgkmcnt(0)
v_or_b32 v20, v144, v145
ds_read_u16_d16_hi v147, v147
s_waitcnt lgkmcnt(0)
v_or_b32 v21, v146, v147
v_add_f32 v156, v156, v157
ds_write_b32 v255, v156 offset:7168
v_pk_mul_f16 v22, v155, v154
v_pk_mul_f16 v23, v152, v151
s_cmp_lg_u32 s40, 0
s_cbranch_scc1 Lrs1
v_mov_b32 v82, 0
Lpi:
s_waitcnt vmcnt(0)
v_readfirstlane_b32 s43, v83
s_cmp_eq_u32 s76, 0
s_cbranch_scc1 Lpix
s_sub_u32 s76, s76, 1
s_cmp_ge_u32 s43, 256
s_cbranch_scc1 Lpix
buffer_load_dword v83, v82, s[36:39], 0 offen sc1
s_branch Lpi
Lpix:
v_min_u32 v80, 47, v251
v_lshlrev_b32 v80, 3, v80
s_and_b32 s44, s2, 7
s_lshl_b32 s44, s44, 11
s_add_u32 s44, s44, 394752
buffer_load_dwordx2 v[84:85], v80, s[32:35], s44 offen sc1
Lrs1:
s_setprio 2
ds_read_b128 v[228:231], v248 offset:45056
v_mfma_f32_32x32x16_f16 v[192:207], v[16:19], v[240:243], 0
v_cvt_pkrtz_f16_f32 v137, v120, v121
v_cvt_pkrtz_f16_f32 v139, v122, v123
v_cvt_pkrtz_f16_f32 v141, v124, v125
v_cvt_pkrtz_f16_f32 v143, v126, v127
v_cvt_pkrtz_f16_f32 v145, v128, v129
v_mfma_f32_32x32x16_f16 v[192:207], v[20:23], v[244:247], v[192:207]
v_cvt_pk_f16_f32 v155, v130, v131
v_cvt_pk_f16_f32 v152, v132, v133
v_cvt_pk_f16_f32 v149, v134, v135
v_pk_fma_f16 v154, v155, v155, s48
v_and_b32 v137, s49, v137
v_mfma_f32_32x32x16_bf16 v[120:135], v[232:235], v[168:171], 0
v_pk_fma_f16 v151, v152, v152, s48
v_and_b32 v139, s49, v139
v_pk_fma_f16 v148, v149, v149, s48
v_pk_mul_f16 v154, v155, v154
v_lshrrev_b16 v136, 2, v137
v_pk_mul_f16 v151, v152, v151
v_pk_mul_f16 v148, v149, v148
v_lshrrev_b16 v138, 2, v139
v_fmac_f32 v158, v192, v192
v_exp_f16 v153, v154
ds_read_b128 v[232:235], v248 offset:43008
ds_read_u16_d16 v136, v136
ds_read_u16_d16 v138, v138
v_mfma_f32_32x32x16_bf16 v[120:135], v[236:239], v[172:175], v[120:135]
v_fmac_f32 v158, v193, v193
v_lshrrev_b32 v137, 18, v137
v_exp_f16 v150, v151
v_fmac_f32 v158, v194, v194
v_lshrrev_b32 v139, 18, v139
v_exp_f16 v147, v148
v_fmac_f32 v158, v195, v195
v_and_b32 v141, s49, v141
ds_read_b128 v[236:239], v248 offset:46080
ds_read_u16_d16_hi v137, v137
ds_read_u16_d16_hi v139, v139
v_mfma_f32_32x32x16_bf16 v[120:135], v[224:227], v[176:179], v[120:135]
v_and_b32 v143, s49, v143
v_exp_f16_sdwa v153, v154 dst_sel:WORD_1 dst_unused:UNUSED_PRESERVE src0_sel:WORD_1
v_fmac_f32 v158, v196, v196
v_lshrrev_b16 v140, 2, v141
v_exp_f16_sdwa v150, v151 dst_sel:WORD_1 dst_unused:UNUSED_PRESERVE src0_sel:WORD_1
v_fmac_f32 v158, v197, v197
v_lshrrev_b16 v142, 2, v143
v_exp_f16_sdwa v147, v148 dst_sel:WORD_1 dst_unused:UNUSED_PRESERVE src0_sel:WORD_1
s_waitcnt lgkmcnt(6)
ds_read_b128 v[224:227], v248 offset:47104
ds_read_u16_d16 v140, v140
ds_read_u16_d16 v142, v142
v_mfma_f32_32x32x16_bf16 v[120:135], v[228:231], v[180:183], v[120:135]
v_fmac_f32 v158, v198, v198
v_lshrrev_b32 v141, 18, v141
v_pk_add_f16 v153, v153, 1.0 op_sel_hi:[1,0]
v_fmac_f32 v158, v199, v199
v_lshrrev_b32 v143, 18, v143
v_pk_add_f16 v150, v150, 1.0 op_sel_hi:[1,0]
v_pk_add_f16 v147, v147, 1.0 op_sel_hi:[1,0]
v_fmac_f32 v158, v200, v200
v_and_b32 v145, s49, v145
s_waitcnt lgkmcnt(4)
ds_read_b128 v[228:231], v248 offset:50176
ds_read_u16_d16_hi v141, v141
ds_read_u16_d16_hi v143, v143
v_mfma_f32_32x32x16_bf16 v[120:135], v[232:235], v[184:187], v[120:135]
v_rcp_f16 v154, v153
v_fmac_f32 v158, v201, v201
v_lshrrev_b16 v144, 2, v145
v_rcp_f16 v151, v150
v_fmac_f32 v158, v202, v202
v_lshrrev_b32 v145, 18, v145
v_rcp_f16 v148, v147
v_fmac_f32 v158, v203, v203
v_or_b32 v24, v136, v137
ds_read_b128 v[232:235], v248 offset:48128
ds_read_u16_d16 v144, v144
ds_read_u16_d16_hi v145, v145
v_mfma_f32_32x32x16_bf16 v[120:135], v[236:239], v[188:191], v[120:135]
s_waitcnt lgkmcnt(6)
v_or_b32 v25, v138, v139
v_rcp_f16_sdwa v154, v153 dst_sel:WORD_1 dst_unused:UNUSED_PRESERVE src0_sel:WORD_1
v_fmac_f32 v158, v204, v204
s_waitcnt lgkmcnt(4)
v_or_b32 v26, v140, v141
v_rcp_f16_sdwa v151, v150 dst_sel:WORD_1 dst_unused:UNUSED_PRESERVE src0_sel:WORD_1
v_fmac_f32 v158, v205, v205
s_waitcnt lgkmcnt(3)
v_or_b32 v27, v142, v143
v_rcp_f16_sdwa v148, v147 dst_sel:WORD_1 dst_unused:UNUSED_PRESERVE src0_sel:WORD_1
v_fmac_f32 v158, v206, v206
s_waitcnt lgkmcnt(0)
v_or_b32 v28, v144, v145
v_pk_mul_f16 v29, v155, v154
v_fmac_f32 v158, v207, v207
v_pk_mul_f16 v30, v152, v151
v_pk_mul_f16 v31, v149, v148
s_setprio 1
ds_read_b128 v[236:239], v248 offset:51200
v_mfma_f32_32x32x16_f16 v[192:207], v[24:27], v[240:243], 0
v_cvt_pkrtz_f16_f32 v137, v120, v121
v_cvt_pkrtz_f16_f32 v139, v122, v123
v_cvt_pkrtz_f16_f32 v141, v124, v125
v_cvt_pkrtz_f16_f32 v143, v126, v127
v_mfma_f32_32x32x16_f16 v[192:207], v[28:31], v[244:247], v[192:207]
v_cvt_pkrtz_f16_f32 v145, v128, v129
v_cvt_pkrtz_f16_f32 v147, v130, v131
v_cvt_pk_f16_f32 v155, v132, v133
v_cvt_pk_f16_f32 v152, v134, v135
v_pk_fma_f16 v154, v155, v155, s48
v_mfma_f32_32x32x16_bf16 v[120:135], v[224:227], v[168:171], 0
v_and_b32 v137, s49, v137
v_pk_fma_f16 v151, v152, v152, s48
v_and_b32 v139, s49, v139
v_pk_mul_f16 v154, v155, v154
v_lshrrev_b16 v136, 2, v137
v_pk_mul_f16 v151, v152, v151
v_lshrrev_b16 v138, 2, v139
v_exp_f16 v153, v154
v_fmac_f32 v159, v192, v192
ds_read_b128 v[224:227], v248 offset:49152
ds_read_u16_d16 v136, v136
ds_read_u16_d16 v138, v138
v_mfma_f32_32x32x16_bf16 v[120:135], v[228:231], v[172:175], v[120:135]
v_lshrrev_b32 v137, 18, v137
v_fmac_f32 v159, v193, v193
v_exp_f16 v150, v151
v_fmac_f32 v159, v194, v194
v_lshrrev_b32 v139, 18, v139
v_and_b32 v141, s49, v141
v_fmac_f32 v159, v195, v195
v_exp_f16_sdwa v153, v154 dst_sel:WORD_1 dst_unused:UNUSED_PRESERVE src0_sel:WORD_1
ds_read_b128 v[228:231], v248 offset:52224
ds_read_u16_d16_hi v137, v137
ds_read_u16_d16_hi v139, v139
v_mfma_f32_32x32x16_bf16 v[120:135], v[232:235], v[176:179], v[120:135]
v_fmac_f32 v159, v196, v196
v_and_b32 v143, s49, v143
v_lshrrev_b16 v140, 2, v141
v_fmac_f32 v159, v197, v197
v_exp_f16_sdwa v150, v151 dst_sel:WORD_1 dst_unused:UNUSED_PRESERVE src0_sel:WORD_1
v_fmac_f32 v159, v198, v198
v_lshrrev_b16 v142, 2, v143
v_pk_add_f16 v153, v153, 1.0 op_sel_hi:[1,0]
v_fmac_f32 v159, v199, v199
s_waitcnt lgkmcnt(5)
ds_read_b128 v[232:235], v248 offset:53248
ds_read_u16_d16 v140, v140
ds_read_u16_d16 v142, v142
v_mfma_f32_32x32x16_bf16 v[120:135], v[236:239], v[180:183], v[120:135]
v_lshrrev_b32 v141, 18, v141
v_pk_add_f16 v150, v150, 1.0 op_sel_hi:[1,0]
v_fmac_f32 v159, v200, v200
v_lshrrev_b32 v143, 18, v143
v_rcp_f16 v154, v153
v_fmac_f32 v159, v201, v201
v_and_b32 v145, s49, v145
v_and_b32 v147, s49, v147
v_fmac_f32 v159, v202, v202
ds_read_b128 v[236:239], v248 offset:56320
ds_read_u16_d16_hi v141, v141
ds_read_u16_d16_hi v143, v143
v_mfma_f32_32x32x16_bf16 v[120:135], v[224:227], v[184:187], v[120:135]
v_rcp_f16 v151, v150
v_fmac_f32 v159, v203, v203
v_lshrrev_b16 v144, 2, v145
s_setprio 0
v_rcp_f16_sdwa v154, v153 dst_sel:WORD_1 dst_unused:UNUSED_PRESERVE src0_sel:WORD_1
v_fmac_f32 v159, v204, v204
v_lshrrev_b16 v146, 2, v147
v_fmac_f32 v159, v205, v205
v_lshrrev_b32 v145, 18, v145
s_waitcnt lgkmcnt(4)
ds_read_b128 v[224:227], v248 offset:54272
ds_read_u16_d16 v144, v144
ds_read_u16_d16 v146, v146
ds_read_u16_d16_hi v145, v145
v_mfma_f32_32x32x16_bf16 v[120:135], v[228:231], v[188:191], v[120:135]
v_rcp_f16_sdwa v151, v150 dst_sel:WORD_1 dst_unused:UNUSED_PRESERVE src0_sel:WORD_1
v_fmac_f32 v159, v206, v206
v_lshrrev_b32 v147, 18, v147
v_fmac_f32 v159, v207, v207
v_or_b32 v32, v136, v137
v_or_b32 v33, v138, v139
v_permlane32_swap_b32 v158, v159
s_waitcnt lgkmcnt(5)
v_or_b32 v34, v140, v141
s_waitcnt lgkmcnt(4)
v_or_b32 v35, v142, v143
s_waitcnt lgkmcnt(0)
v_or_b32 v36, v144, v145
ds_read_u16_d16_hi v147, v147
s_waitcnt lgkmcnt(0)
v_or_b32 v37, v146, v147
v_add_f32 v158, v158, v159
ds_write_b32 v255, v158 offset:7424
v_pk_mul_f16 v38, v155, v154
v_pk_mul_f16 v39, v152, v151
s_setprio 2
ds_read_b128 v[228:231], v248 offset:57344
v_mfma_f32_32x32x16_f16 v[192:207], v[32:35], v[240:243], 0
v_cvt_pkrtz_f16_f32 v137, v120, v121
v_cvt_pkrtz_f16_f32 v139, v122, v123
v_cvt_pkrtz_f16_f32 v141, v124, v125
v_cvt_pkrtz_f16_f32 v143, v126, v127
v_cvt_pkrtz_f16_f32 v145, v128, v129
v_mfma_f32_32x32x16_f16 v[192:207], v[36:39], v[244:247], v[192:207]
v_cvt_pk_f16_f32 v155, v130, v131
v_cvt_pk_f16_f32 v152, v132, v133
v_cvt_pk_f16_f32 v149, v134, v135
v_pk_fma_f16 v154, v155, v155, s48
v_and_b32 v137, s49, v137
v_mfma_f32_32x32x16_bf16 v[120:135], v[232:235], v[168:171], 0
v_pk_fma_f16 v151, v152, v152, s48
v_and_b32 v139, s49, v139
v_pk_fma_f16 v148, v149, v149, s48
v_pk_mul_f16 v154, v155, v154
v_lshrrev_b16 v136, 2, v137
v_pk_mul_f16 v151, v152, v151
v_pk_mul_f16 v148, v149, v148
v_lshrrev_b16 v138, 2, v139
v_fmac_f32 v160, v192, v192
v_exp_f16 v153, v154
ds_read_b128 v[232:235], v248 offset:55296
ds_read_u16_d16 v136, v136
ds_read_u16_d16 v138, v138
v_mfma_f32_32x32x16_bf16 v[120:135], v[236:239], v[172:175], v[120:135]
v_fmac_f32 v160, v193, v193
v_lshrrev_b32 v137, 18, v137
v_exp_f16 v150, v151
v_fmac_f32 v160, v194, v194
v_lshrrev_b32 v139, 18, v139
v_exp_f16 v147, v148
v_fmac_f32 v160, v195, v195
v_and_b32 v141, s49, v141
ds_read_b128 v[236:239], v248 offset:58368
ds_read_u16_d16_hi v137, v137
ds_read_u16_d16_hi v139, v139
v_mfma_f32_32x32x16_bf16 v[120:135], v[224:227], v[176:179], v[120:135]
v_and_b32 v143, s49, v143
v_exp_f16_sdwa v153, v154 dst_sel:WORD_1 dst_unused:UNUSED_PRESERVE src0_sel:WORD_1
v_fmac_f32 v160, v196, v196
v_lshrrev_b16 v140, 2, v141
v_exp_f16_sdwa v150, v151 dst_sel:WORD_1 dst_unused:UNUSED_PRESERVE src0_sel:WORD_1
v_fmac_f32 v160, v197, v197
v_lshrrev_b16 v142, 2, v143
v_exp_f16_sdwa v147, v148 dst_sel:WORD_1 dst_unused:UNUSED_PRESERVE src0_sel:WORD_1
s_waitcnt lgkmcnt(6)
ds_read_b128 v[224:227], v248 offset:59392
ds_read_u16_d16 v140, v140
ds_read_u16_d16 v142, v142
v_mfma_f32_32x32x16_bf16 v[120:135], v[228:231], v[180:183], v[120:135]
v_fmac_f32 v160, v198, v198
v_lshrrev_b32 v141, 18, v141
v_pk_add_f16 v153, v153, 1.0 op_sel_hi:[1,0]
v_fmac_f32 v160, v199, v199
v_lshrrev_b32 v143, 18, v143
v_pk_add_f16 v150, v150, 1.0 op_sel_hi:[1,0]
v_pk_add_f16 v147, v147, 1.0 op_sel_hi:[1,0]
v_fmac_f32 v160, v200, v200
v_and_b32 v145, s49, v145
s_waitcnt lgkmcnt(4)
ds_read_b128 v[228:231], v248 offset:62464
ds_read_u16_d16_hi v141, v141
ds_read_u16_d16_hi v143, v143
v_mfma_f32_32x32x16_bf16 v[120:135], v[232:235], v[184:187], v[120:135]
v_rcp_f16 v154, v153
v_fmac_f32 v160, v201, v201
v_lshrrev_b16 v144, 2, v145
v_rcp_f16 v151, v150
v_fmac_f32 v160, v202, v202
v_lshrrev_b32 v145, 18, v145
v_rcp_f16 v148, v147
v_fmac_f32 v160, v203, v203
v_or_b32 v40, v136, v137
ds_read_b128 v[232:235], v248 offset:60416
ds_read_u16_d16 v144, v144
ds_read_u16_d16_hi v145, v145
v_mfma_f32_32x32x16_bf16 v[120:135], v[236:239], v[188:191], v[120:135]
s_waitcnt lgkmcnt(6)
v_or_b32 v41, v138, v139
v_rcp_f16_sdwa v154, v153 dst_sel:WORD_1 dst_unused:UNUSED_PRESERVE src0_sel:WORD_1
v_fmac_f32 v160, v204, v204
s_waitcnt lgkmcnt(4)
v_or_b32 v42, v140, v141
v_rcp_f16_sdwa v151, v150 dst_sel:WORD_1 dst_unused:UNUSED_PRESERVE src0_sel:WORD_1
v_fmac_f32 v160, v205, v205
s_waitcnt lgkmcnt(3)
v_or_b32 v43, v142, v143
v_rcp_f16_sdwa v148, v147 dst_sel:WORD_1 dst_unused:UNUSED_PRESERVE src0_sel:WORD_1
v_fmac_f32 v160, v206, v206
s_waitcnt lgkmcnt(0)
v_or_b32 v44, v144, v145
v_pk_mul_f16 v45, v155, v154
v_fmac_f32 v160, v207, v207
v_pk_mul_f16 v46, v152, v151
v_pk_mul_f16 v47, v149, v148
s_cmp_lg_u32 s40, 0
s_cbranch_scc1 Lrs2
v_min_u32 v80, 47, v251
v_lshlrev_b32 v80, 3, v80
v_add_u32 v81, 7936, v80
v_add_u32 v80, 15872, v80
v_cmp_gt_u32 vcc, 32, v251
s_nop 1
v_cndmask_b32 v80, v80, v81, vcc
s_waitcnt vmcnt(0)
ds_write_b64 v80, v[84:85]
Lrs2:
s_setprio 1
ds_read_b128 v[236:239], v248 offset:63488
v_mfma_f32_32x32x16_f16 v[192:207], v[40:43], v[240:243], 0
v_cvt_pkrtz_f16_f32 v137, v120, v121
v_cvt_pkrtz_f16_f32 v139, v122, v123
v_cvt_pkrtz_f16_f32 v141, v124, v125
v_cvt_pkrtz_f16_f32 v143, v126, v127
v_mfma_f32_32x32x16_f16 v[192:207], v[44:47], v[244:247], v[192:207]
s_waitcnt lgkmcnt(1)
v_cvt_pkrtz_f16_f32 v145, v128, v129
v_cvt_pkrtz_f16_f32 v147, v130, v131
v_cvt_pk_f16_f32 v155, v132, v133
v_cvt_pk_f16_f32 v152, v134, v135
v_pk_fma_f16 v154, v155, v155, s48
v_mfma_f32_32x32x16_bf16 v[120:135], v[224:227], v[168:171], 0
v_and_b32 v137, s49, v137
v_pk_fma_f16 v151, v152, v152, s48
v_and_b32 v139, s49, v139
v_pk_mul_f16 v154, v155, v154
v_lshrrev_b16 v136, 2, v137
v_pk_mul_f16 v151, v152, v151
v_lshrrev_b16 v138, 2, v139
v_exp_f16 v153, v154
v_fmac_f32 v161, v192, v192
ds_read_b128 v[224:227], v248 offset:61440
ds_read_u16_d16 v136, v136
ds_read_u16_d16 v138, v138
v_mfma_f32_32x32x16_bf16 v[120:135], v[228:231], v[172:175], v[120:135]
v_lshrrev_b32 v137, 18, v137
v_fmac_f32 v161, v193, v193
v_exp_f16 v150, v151
v_fmac_f32 v161, v194, v194
v_lshrrev_b32 v139, 18, v139
v_and_b32 v141, s49, v141
v_fmac_f32 v161, v195, v195
v_exp_f16_sdwa v153, v154 dst_sel:WORD_1 dst_unused:UNUSED_PRESERVE src0_sel:WORD_1
ds_read_b128 v[228:231], v248 offset:64512
ds_read_u16_d16_hi v137, v137
ds_read_u16_d16_hi v139, v139
v_mfma_f32_32x32x16_bf16 v[120:135], v[232:235], v[176:179], v[120:135]
v_fmac_f32 v161, v196, v196
v_and_b32 v143, s49, v143
v_lshrrev_b16 v140, 2, v141
v_fmac_f32 v161, v197, v197
v_exp_f16_sdwa v150, v151 dst_sel:WORD_1 dst_unused:UNUSED_PRESERVE src0_sel:WORD_1
v_fmac_f32 v161, v198, v198
v_lshrrev_b16 v142, 2, v143
v_pk_add_f16 v153, v153, 1.0 op_sel_hi:[1,0]
v_fmac_f32 v161, v199, v199
s_waitcnt lgkmcnt(5)
ds_read_b128 v[232:235], v249
ds_read_u16_d16 v140, v140
ds_read_u16_d16 v142, v142
v_mfma_f32_32x32x16_bf16 v[120:135], v[236:239], v[180:183], v[120:135]
v_lshrrev_b32 v141, 18, v141
v_pk_add_f16 v150, v150, 1.0 op_sel_hi:[1,0]
v_fmac_f32 v161, v200, v200
v_lshrrev_b32 v143, 18, v143
v_rcp_f16 v154, v153
v_fmac_f32 v161, v201, v201
v_and_b32 v145, s49, v145
v_and_b32 v147, s49, v147
v_fmac_f32 v161, v202, v202
ds_read_b128 v[236:239], v249 offset:3072
ds_read_u16_d16_hi v141, v141
ds_read_u16_d16_hi v143, v143
v_mfma_f32_32x32x16_bf16 v[120:135], v[224:227], v[184:187], v[120:135]
v_rcp_f16 v151, v150
v_fmac_f32 v161, v203, v203
v_lshrrev_b16 v144, 2, v145
s_setprio 0
v_rcp_f16_sdwa v154, v153 dst_sel:WORD_1 dst_unused:UNUSED_PRESERVE src0_sel:WORD_1
v_fmac_f32 v161, v204, v204
v_lshrrev_b16 v146, 2, v147
v_fmac_f32 v161, v205, v205
v_lshrrev_b32 v145, 18, v145
s_waitcnt lgkmcnt(4)
ds_read_b128 v[224:227], v249 offset:1024
ds_read_u16_d16 v144, v144
ds_read_u16_d16 v146, v146
ds_read_u16_d16_hi v145, v145
v_mfma_f32_32x32x16_bf16 v[120:135], v[228:231], v[188:191], v[120:135]
v_rcp_f16_sdwa v151, v150 dst_sel:WORD_1 dst_unused:UNUSED_PRESERVE src0_sel:WORD_1
v_fmac_f32 v161, v206, v206
v_lshrrev_b32 v147, 18, v147
v_fmac_f32 v161, v207, v207
v_or_b32 v48, v136, v137
v_or_b32 v49, v138, v139
v_permlane32_swap_b32 v160, v161
s_waitcnt lgkmcnt(5)
v_or_b32 v50, v140, v141
s_waitcnt lgkmcnt(4)
v_or_b32 v51, v142, v143
s_waitcnt lgkmcnt(0)
v_or_b32 v52, v144, v145
ds_read_u16_d16_hi v147, v147
s_waitcnt lgkmcnt(0)
v_or_b32 v53, v146, v147
v_add_f32 v160, v160, v161
ds_write_b32 v255, v160 offset:7680
v_pk_mul_f16 v54, v155, v154
v_pk_mul_f16 v55, v152, v151
s_setprio 2
ds_read_b128 v[228:231], v249 offset:4096
v_mfma_f32_32x32x16_f16 v[192:207], v[48:51], v[240:243], 0
v_cvt_pkrtz_f16_f32 v137, v120, v121
v_cvt_pkrtz_f16_f32 v139, v122, v123
v_cvt_pkrtz_f16_f32 v141, v124, v125
v_cvt_pkrtz_f16_f32 v143, v126, v127
v_cvt_pkrtz_f16_f32 v145, v128, v129
v_mfma_f32_32x32x16_f16 v[192:207], v[52:55], v[244:247], v[192:207]
v_cvt_pk_f16_f32 v155, v130, v131
v_cvt_pk_f16_f32 v152, v132, v133
v_cvt_pk_f16_f32 v149, v134, v135
v_pk_fma_f16 v154, v155, v155, s48
v_and_b32 v137, s49, v137
v_mfma_f32_32x32x16_bf16 v[120:135], v[232:235], v[168:171], 0
v_pk_fma_f16 v151, v152, v152, s48
v_and_b32 v139, s49, v139
v_pk_fma_f16 v148, v149, v149, s48
v_pk_mul_f16 v154, v155, v154
v_lshrrev_b16 v136, 2, v137
v_pk_mul_f16 v151, v152, v151
v_pk_mul_f16 v148, v149, v148
v_lshrrev_b16 v138, 2, v139
v_fmac_f32 v162, v192, v192
v_exp_f16 v153, v154
ds_read_b128 v[232:235], v249 offset:2048
ds_read_u16_d16 v136, v136
ds_read_u16_d16 v138, v138
v_mfma_f32_32x32x16_bf16 v[120:135], v[236:239], v[172:175], v[120:135]
v_fmac_f32 v162, v193, v193
v_lshrrev_b32 v137, 18, v137
v_exp_f16 v150, v151
v_fmac_f32 v162, v194, v194
v_lshrrev_b32 v139, 18, v139
v_exp_f16 v147, v148
v_fmac_f32 v162, v195, v195
v_and_b32 v141, s49, v141
ds_read_b128 v[236:239], v249 offset:5120
ds_read_u16_d16_hi v137, v137
ds_read_u16_d16_hi v139, v139
v_mfma_f32_32x32x16_bf16 v[120:135], v[224:227], v[176:179], v[120:135]
v_and_b32 v143, s49, v143
v_exp_f16_sdwa v153, v154 dst_sel:WORD_1 dst_unused:UNUSED_PRESERVE src0_sel:WORD_1
v_fmac_f32 v162, v196, v196
v_lshrrev_b16 v140, 2, v141
v_exp_f16_sdwa v150, v151 dst_sel:WORD_1 dst_unused:UNUSED_PRESERVE src0_sel:WORD_1
v_fmac_f32 v162, v197, v197
v_lshrrev_b16 v142, 2, v143
v_exp_f16_sdwa v147, v148 dst_sel:WORD_1 dst_unused:UNUSED_PRESERVE src0_sel:WORD_1
s_waitcnt lgkmcnt(6)
ds_read_b128 v[224:227], v249 offset:6144
ds_read_u16_d16 v140, v140
ds_read_u16_d16 v142, v142
v_mfma_f32_32x32x16_bf16 v[120:135], v[228:231], v[180:183], v[120:135]
v_fmac_f32 v162, v198, v198
v_lshrrev_b32 v141, 18, v141
v_pk_add_f16 v153, v153, 1.0 op_sel_hi:[1,0]
v_fmac_f32 v162, v199, v199
v_lshrrev_b32 v143, 18, v143
v_pk_add_f16 v150, v150, 1.0 op_sel_hi:[1,0]
v_pk_add_f16 v147, v147, 1.0 op_sel_hi:[1,0]
v_fmac_f32 v162, v200, v200
v_and_b32 v145, s49, v145
s_waitcnt lgkmcnt(4)
ds_read_b128 v[228:231], v249 offset:9216
ds_read_u16_d16_hi v141, v141
ds_read_u16_d16_hi v143, v143
v_mfma_f32_32x32x16_bf16 v[120:135], v[232:235], v[184:187], v[120:135]
v_rcp_f16 v154, v153
v_fmac_f32 v162, v201, v201
v_lshrrev_b16 v144, 2, v145
v_rcp_f16 v151, v150
v_fmac_f32 v162, v202, v202
v_lshrrev_b32 v145, 18, v145
v_rcp_f16 v148, v147
v_fmac_f32 v162, v203, v203
v_or_b32 v56, v136, v137
ds_read_b128 v[232:235], v249 offset:7168
ds_read_u16_d16 v144, v144
ds_read_u16_d16_hi v145, v145
v_mfma_f32_32x32x16_bf16 v[120:135], v[236:239], v[188:191], v[120:135]
s_waitcnt lgkmcnt(6)
v_or_b32 v57, v138, v139
v_rcp_f16_sdwa v154, v153 dst_sel:WORD_1 dst_unused:UNUSED_PRESERVE src0_sel:WORD_1
v_fmac_f32 v162, v204, v204
s_waitcnt lgkmcnt(4)
v_or_b32 v58, v140, v141
v_rcp_f16_sdwa v151, v150 dst_sel:WORD_1 dst_unused:UNUSED_PRESERVE src0_sel:WORD_1
v_fmac_f32 v162, v205, v205
s_waitcnt lgkmcnt(3)
v_or_b32 v59, v142, v143
v_rcp_f16_sdwa v148, v147 dst_sel:WORD_1 dst_unused:UNUSED_PRESERVE src0_sel:WORD_1
v_fmac_f32 v162, v206, v206
s_waitcnt lgkmcnt(0)
v_or_b32 v60, v144, v145
v_pk_mul_f16 v61, v155, v154
v_fmac_f32 v162, v207, v207
v_pk_mul_f16 v62, v152, v151
v_pk_mul_f16 v63, v149, v148
s_setprio 1
ds_read_b128 v[236:239], v249 offset:10240
v_mfma_f32_32x32x16_f16 v[192:207], v[56:59], v[240:243], 0
v_cvt_pkrtz_f16_f32 v137, v120, v121
v_cvt_pkrtz_f16_f32 v139, v122, v123
v_cvt_pkrtz_f16_f32 v141, v124, v125
v_cvt_pkrtz_f16_f32 v143, v126, v127
v_mfma_f32_32x32x16_f16 v[192:207], v[60:63], v[244:247], v[192:207]
v_cvt_pkrtz_f16_f32 v145, v128, v129
v_cvt_pkrtz_f16_f32 v147, v130, v131
v_cvt_pk_f16_f32 v155, v132, v133
v_cvt_pk_f16_f32 v152, v134, v135
v_pk_fma_f16 v154, v155, v155, s48
v_mfma_f32_32x32x16_bf16 v[120:135], v[224:227], v[168:171], 0
v_and_b32 v137, s49, v137
v_pk_fma_f16 v151, v152, v152, s48
v_and_b32 v139, s49, v139
v_pk_mul_f16 v154, v155, v154
v_lshrrev_b16 v136, 2, v137
v_pk_mul_f16 v151, v152, v151
v_lshrrev_b16 v138, 2, v139
v_exp_f16 v153, v154
v_fmac_f32 v163, v192, v192
ds_read_b128 v[224:227], v249 offset:8192
ds_read_u16_d16 v136, v136
ds_read_u16_d16 v138, v138
v_mfma_f32_32x32x16_bf16 v[120:135], v[228:231], v[172:175], v[120:135]
v_lshrrev_b32 v137, 18, v137
v_fmac_f32 v163, v193, v193
v_exp_f16 v150, v151
v_fmac_f32 v163, v194, v194
v_lshrrev_b32 v139, 18, v139
v_and_b32 v141, s49, v141
v_fmac_f32 v163, v195, v195
v_exp_f16_sdwa v153, v154 dst_sel:WORD_1 dst_unused:UNUSED_PRESERVE src0_sel:WORD_1
ds_read_b128 v[228:231], v249 offset:11264
ds_read_u16_d16_hi v137, v137
ds_read_u16_d16_hi v139, v139
v_mfma_f32_32x32x16_bf16 v[120:135], v[232:235], v[176:179], v[120:135]
v_fmac_f32 v163, v196, v196
v_and_b32 v143, s49, v143
v_lshrrev_b16 v140, 2, v141
v_fmac_f32 v163, v197, v197
v_exp_f16_sdwa v150, v151 dst_sel:WORD_1 dst_unused:UNUSED_PRESERVE src0_sel:WORD_1
v_fmac_f32 v163, v198, v198
v_lshrrev_b16 v142, 2, v143
v_pk_add_f16 v153, v153, 1.0 op_sel_hi:[1,0]
v_fmac_f32 v163, v199, v199
s_waitcnt lgkmcnt(5)
ds_read_b128 v[232:235], v249 offset:12288
ds_read_u16_d16 v140, v140
ds_read_u16_d16 v142, v142
v_mfma_f32_32x32x16_bf16 v[120:135], v[236:239], v[180:183], v[120:135]
v_lshrrev_b32 v141, 18, v141
v_pk_add_f16 v150, v150, 1.0 op_sel_hi:[1,0]
v_fmac_f32 v163, v200, v200
v_lshrrev_b32 v143, 18, v143
v_rcp_f16 v154, v153
v_fmac_f32 v163, v201, v201
v_and_b32 v145, s49, v145
v_and_b32 v147, s49, v147
v_fmac_f32 v163, v202, v202
ds_read_b128 v[236:239], v249 offset:15360
ds_read_u16_d16_hi v141, v141
ds_read_u16_d16_hi v143, v143
v_mfma_f32_32x32x16_bf16 v[120:135], v[224:227], v[184:187], v[120:135]
v_rcp_f16 v151, v150
v_fmac_f32 v163, v203, v203
v_lshrrev_b16 v144, 2, v145
s_setprio 0
v_rcp_f16_sdwa v154, v153 dst_sel:WORD_1 dst_unused:UNUSED_PRESERVE src0_sel:WORD_1
v_fmac_f32 v163, v204, v204
v_lshrrev_b16 v146, 2, v147
v_fmac_f32 v163, v205, v205
v_lshrrev_b32 v145, 18, v145
s_waitcnt lgkmcnt(4)
ds_read_b128 v[224:227], v249 offset:13312
ds_read_u16_d16 v144, v144
ds_read_u16_d16 v146, v146
ds_read_u16_d16_hi v145, v145
v_mfma_f32_32x32x16_bf16 v[120:135], v[228:231], v[188:191], v[120:135]
v_rcp_f16_sdwa v151, v150 dst_sel:WORD_1 dst_unused:UNUSED_PRESERVE src0_sel:WORD_1
v_fmac_f32 v163, v206, v206
v_lshrrev_b32 v147, 18, v147
v_fmac_f32 v163, v207, v207
v_or_b32 v64, v136, v137
v_or_b32 v65, v138, v139
v_permlane32_swap_b32 v162, v163
s_waitcnt lgkmcnt(5)
v_or_b32 v66, v140, v141
s_waitcnt lgkmcnt(4)
v_or_b32 v67, v142, v143
s_waitcnt lgkmcnt(0)
v_or_b32 v68, v144, v145
ds_read_u16_d16_hi v147, v147
s_waitcnt lgkmcnt(0)
v_or_b32 v69, v146, v147
v_add_f32 v162, v162, v163
ds_write_b32 v255, v162 offset:7936
v_pk_mul_f16 v70, v155, v154
v_pk_mul_f16 v71, v152, v151
s_setprio 2
ds_read_b128 v[228:231], v249 offset:16384
v_mfma_f32_32x32x16_f16 v[192:207], v[64:67], v[240:243], 0
v_cvt_pkrtz_f16_f32 v137, v120, v121
v_cvt_pkrtz_f16_f32 v139, v122, v123
v_cvt_pkrtz_f16_f32 v141, v124, v125
v_cvt_pkrtz_f16_f32 v143, v126, v127
v_cvt_pkrtz_f16_f32 v145, v128, v129
v_mfma_f32_32x32x16_f16 v[192:207], v[68:71], v[244:247], v[192:207]
v_cvt_pk_f16_f32 v155, v130, v131
v_cvt_pk_f16_f32 v152, v132, v133
v_cvt_pk_f16_f32 v149, v134, v135
v_pk_fma_f16 v154, v155, v155, s48
v_and_b32 v137, s49, v137
v_mfma_f32_32x32x16_bf16 v[120:135], v[232:235], v[168:171], 0
v_pk_fma_f16 v151, v152, v152, s48
v_and_b32 v139, s49, v139
v_pk_fma_f16 v148, v149, v149, s48
v_pk_mul_f16 v154, v155, v154
v_lshrrev_b16 v136, 2, v137
v_pk_mul_f16 v151, v152, v151
v_pk_mul_f16 v148, v149, v148
v_lshrrev_b16 v138, 2, v139
v_fmac_f32 v164, v192, v192
v_exp_f16 v153, v154
ds_read_b128 v[232:235], v249 offset:14336
ds_read_u16_d16 v136, v136
ds_read_u16_d16 v138, v138
v_mfma_f32_32x32x16_bf16 v[120:135], v[236:239], v[172:175], v[120:135]
v_fmac_f32 v164, v193, v193
v_lshrrev_b32 v137, 18, v137
v_exp_f16 v150, v151
v_fmac_f32 v164, v194, v194
v_lshrrev_b32 v139, 18, v139
v_exp_f16 v147, v148
v_fmac_f32 v164, v195, v195
v_and_b32 v141, s49, v141
ds_read_b128 v[236:239], v249 offset:17408
ds_read_u16_d16_hi v137, v137
ds_read_u16_d16_hi v139, v139
v_mfma_f32_32x32x16_bf16 v[120:135], v[224:227], v[176:179], v[120:135]
v_and_b32 v143, s49, v143
v_exp_f16_sdwa v153, v154 dst_sel:WORD_1 dst_unused:UNUSED_PRESERVE src0_sel:WORD_1
v_fmac_f32 v164, v196, v196
v_lshrrev_b16 v140, 2, v141
v_exp_f16_sdwa v150, v151 dst_sel:WORD_1 dst_unused:UNUSED_PRESERVE src0_sel:WORD_1
v_fmac_f32 v164, v197, v197
v_lshrrev_b16 v142, 2, v143
v_exp_f16_sdwa v147, v148 dst_sel:WORD_1 dst_unused:UNUSED_PRESERVE src0_sel:WORD_1
s_waitcnt lgkmcnt(6)
ds_read_b128 v[224:227], v249 offset:18432
ds_read_u16_d16 v140, v140
ds_read_u16_d16 v142, v142
v_mfma_f32_32x32x16_bf16 v[120:135], v[228:231], v[180:183], v[120:135]
v_fmac_f32 v164, v198, v198
v_lshrrev_b32 v141, 18, v141
v_pk_add_f16 v153, v153, 1.0 op_sel_hi:[1,0]
v_fmac_f32 v164, v199, v199
v_lshrrev_b32 v143, 18, v143
v_pk_add_f16 v150, v150, 1.0 op_sel_hi:[1,0]
v_pk_add_f16 v147, v147, 1.0 op_sel_hi:[1,0]
v_fmac_f32 v164, v200, v200
v_and_b32 v145, s49, v145
s_waitcnt lgkmcnt(4)
ds_read_b128 v[228:231], v249 offset:21504
ds_read_u16_d16_hi v141, v141
ds_read_u16_d16_hi v143, v143
v_mfma_f32_32x32x16_bf16 v[120:135], v[232:235], v[184:187], v[120:135]
v_rcp_f16 v154, v153
v_fmac_f32 v164, v201, v201
v_lshrrev_b16 v144, 2, v145
v_rcp_f16 v151, v150
v_fmac_f32 v164, v202, v202
v_lshrrev_b32 v145, 18, v145
v_rcp_f16 v148, v147
v_fmac_f32 v164, v203, v203
v_or_b32 v72, v136, v137
ds_read_b128 v[232:235], v249 offset:19456
ds_read_u16_d16 v144, v144
ds_read_u16_d16_hi v145, v145
v_mfma_f32_32x32x16_bf16 v[120:135], v[236:239], v[188:191], v[120:135]
s_waitcnt lgkmcnt(6)
v_or_b32 v73, v138, v139
v_rcp_f16_sdwa v154, v153 dst_sel:WORD_1 dst_unused:UNUSED_PRESERVE src0_sel:WORD_1
v_fmac_f32 v164, v204, v204
s_waitcnt lgkmcnt(4)
v_or_b32 v74, v140, v141
v_rcp_f16_sdwa v151, v150 dst_sel:WORD_1 dst_unused:UNUSED_PRESERVE src0_sel:WORD_1
v_fmac_f32 v164, v205, v205
s_waitcnt lgkmcnt(3)
v_or_b32 v75, v142, v143
v_rcp_f16_sdwa v148, v147 dst_sel:WORD_1 dst_unused:UNUSED_PRESERVE src0_sel:WORD_1
v_fmac_f32 v164, v206, v206
s_waitcnt lgkmcnt(0)
v_or_b32 v76, v144, v145
v_pk_mul_f16 v77, v155, v154
v_fmac_f32 v164, v207, v207
v_pk_mul_f16 v78, v152, v151
v_pk_mul_f16 v79, v149, v148
s_setprio 1
ds_read_b128 v[236:239], v249 offset:22528
v_mfma_f32_32x32x16_f16 v[192:207], v[72:75], v[240:243], 0
v_cvt_pkrtz_f16_f32 v137, v120, v121
v_cvt_pkrtz_f16_f32 v139, v122, v123
v_cvt_pkrtz_f16_f32 v141, v124, v125
v_cvt_pkrtz_f16_f32 v143, v126, v127
v_mfma_f32_32x32x16_f16 v[192:207], v[76:79], v[244:247], v[192:207]
v_cvt_pkrtz_f16_f32 v145, v128, v129
v_cvt_pkrtz_f16_f32 v147, v130, v131
v_cvt_pk_f16_f32 v155, v132, v133
v_cvt_pk_f16_f32 v152, v134, v135
v_pk_fma_f16 v154, v155, v155, s48
v_mfma_f32_32x32x16_bf16 v[120:135], v[224:227], v[168:171], 0
v_and_b32 v137, s49, v137
v_pk_fma_f16 v151, v152, v152, s48
v_and_b32 v139, s49, v139
v_pk_mul_f16 v154, v155, v154
v_lshrrev_b16 v136, 2, v137
v_pk_mul_f16 v151, v152, v151
v_lshrrev_b16 v138, 2, v139
v_exp_f16 v153, v154
v_fmac_f32 v165, v192, v192
ds_read_b128 v[224:227], v249 offset:20480
ds_read_u16_d16 v136, v136
ds_read_u16_d16 v138, v138
v_mfma_f32_32x32x16_bf16 v[120:135], v[228:231], v[172:175], v[120:135]
v_lshrrev_b32 v137, 18, v137
v_fmac_f32 v165, v193, v193
v_exp_f16 v150, v151
v_fmac_f32 v165, v194, v194
v_lshrrev_b32 v139, 18, v139
v_and_b32 v141, s49, v141
v_fmac_f32 v165, v195, v195
v_exp_f16_sdwa v153, v154 dst_sel:WORD_1 dst_unused:UNUSED_PRESERVE src0_sel:WORD_1
ds_read_b128 v[228:231], v249 offset:23552
ds_read_u16_d16_hi v137, v137
ds_read_u16_d16_hi v139, v139
v_mfma_f32_32x32x16_bf16 v[120:135], v[232:235], v[176:179], v[120:135]
v_fmac_f32 v165, v196, v196
v_and_b32 v143, s49, v143
v_lshrrev_b16 v140, 2, v141
v_fmac_f32 v165, v197, v197
v_exp_f16_sdwa v150, v151 dst_sel:WORD_1 dst_unused:UNUSED_PRESERVE src0_sel:WORD_1
v_fmac_f32 v165, v198, v198
v_lshrrev_b16 v142, 2, v143
v_pk_add_f16 v153, v153, 1.0 op_sel_hi:[1,0]
v_fmac_f32 v165, v199, v199
s_waitcnt lgkmcnt(5)
ds_read_b128 v[232:235], v248 offset:47104
ds_read_u16_d16 v140, v140
ds_read_u16_d16 v142, v142
v_mfma_f32_32x32x16_bf16 v[120:135], v[236:239], v[180:183], v[120:135]
v_lshrrev_b32 v141, 18, v141
v_pk_add_f16 v150, v150, 1.0 op_sel_hi:[1,0]
v_fmac_f32 v165, v200, v200
v_lshrrev_b32 v143, 18, v143
v_rcp_f16 v154, v153
v_fmac_f32 v165, v201, v201
v_and_b32 v145, s49, v145
v_and_b32 v147, s49, v147
v_fmac_f32 v165, v202, v202
ds_read_b128 v[236:239], v248 offset:50176
ds_read_u16_d16_hi v141, v141
ds_read_u16_d16_hi v143, v143
v_mfma_f32_32x32x16_bf16 v[120:135], v[224:227], v[184:187], v[120:135]
v_rcp_f16 v151, v150
v_fmac_f32 v165, v203, v203
v_lshrrev_b16 v144, 2, v145
s_setprio 0
v_rcp_f16_sdwa v154, v153 dst_sel:WORD_1 dst_unused:UNUSED_PRESERVE src0_sel:WORD_1
v_fmac_f32 v165, v204, v204
v_lshrrev_b16 v146, 2, v147
v_fmac_f32 v165, v205, v205
v_lshrrev_b32 v145, 18, v145
s_waitcnt lgkmcnt(4)
ds_read_b128 v[224:227], v248 offset:48128
ds_read_u16_d16 v144, v144
ds_read_u16_d16 v146, v146
ds_read_u16_d16_hi v145, v145
v_mfma_f32_32x32x16_bf16 v[120:135], v[228:231], v[188:191], v[120:135]
v_rcp_f16_sdwa v151, v150 dst_sel:WORD_1 dst_unused:UNUSED_PRESERVE src0_sel:WORD_1
v_fmac_f32 v165, v206, v206
v_lshrrev_b32 v147, 18, v147
v_fmac_f32 v165, v207, v207
v_or_b32 v80, v136, v137
v_or_b32 v81, v138, v139
v_permlane32_swap_b32 v164, v165
s_waitcnt lgkmcnt(5)
v_or_b32 v82, v140, v141
s_waitcnt lgkmcnt(4)
v_or_b32 v83, v142, v143
s_waitcnt lgkmcnt(0)
v_or_b32 v84, v144, v145
ds_read_u16_d16_hi v147, v147
s_waitcnt lgkmcnt(0)
v_or_b32 v85, v146, v147
v_add_f32 v164, v164, v165
ds_write_b32 v255, v164 offset:8192
v_pk_mul_f16 v86, v155, v154
v_pk_mul_f16 v87, v152, v151
s_setprio 2
ds_read_b128 v[228:231], v248 offset:51200
v_mfma_f32_32x32x16_f16 v[192:207], v[80:83], v[240:243], 0
v_cvt_pkrtz_f16_f32 v137, v120, v121
v_cvt_pkrtz_f16_f32 v139, v122, v123
v_cvt_pkrtz_f16_f32 v141, v124, v125
v_cvt_pkrtz_f16_f32 v143, v126, v127
v_cvt_pkrtz_f16_f32 v145, v128, v129
v_mfma_f32_32x32x16_f16 v[192:207], v[84:87], v[244:247], v[192:207]
v_cvt_pk_f16_f32 v155, v130, v131
v_cvt_pk_f16_f32 v152, v132, v133
v_cvt_pk_f16_f32 v149, v134, v135
v_pk_fma_f16 v154, v155, v155, s48
v_and_b32 v137, s49, v137
v_mfma_f32_32x32x16_bf16 v[120:135], v[232:235], v[96:99], 0
v_pk_fma_f16 v151, v152, v152, s48
v_and_b32 v139, s49, v139
v_pk_fma_f16 v148, v149, v149, s48
v_pk_mul_f16 v154, v155, v154
v_lshrrev_b16 v136, 2, v137
v_pk_mul_f16 v151, v152, v151
v_pk_mul_f16 v148, v149, v148
v_lshrrev_b16 v138, 2, v139
v_fmac_f32 v166, v192, v192
v_exp_f16 v153, v154
ds_read_b128 v[232:235], v248 offset:49152
ds_read_u16_d16 v136, v136
ds_read_u16_d16 v138, v138
v_mfma_f32_32x32x16_bf16 v[120:135], v[236:239], v[100:103], v[120:135]
v_fmac_f32 v166, v193, v193
v_lshrrev_b32 v137, 18, v137
v_exp_f16 v150, v151
v_fmac_f32 v166, v194, v194
v_lshrrev_b32 v139, 18, v139
v_exp_f16 v147, v148
v_fmac_f32 v166, v195, v195
v_and_b32 v141, s49, v141
ds_read_b128 v[236:239], v248 offset:52224
ds_read_u16_d16_hi v137, v137
ds_read_u16_d16_hi v139, v139
v_mfma_f32_32x32x16_bf16 v[120:135], v[224:227], v[104:107], v[120:135]
v_and_b32 v143, s49, v143
v_exp_f16_sdwa v153, v154 dst_sel:WORD_1 dst_unused:UNUSED_PRESERVE src0_sel:WORD_1
v_fmac_f32 v166, v196, v196
v_lshrrev_b16 v140, 2, v141
v_exp_f16_sdwa v150, v151 dst_sel:WORD_1 dst_unused:UNUSED_PRESERVE src0_sel:WORD_1
v_fmac_f32 v166, v197, v197
v_lshrrev_b16 v142, 2, v143
v_exp_f16_sdwa v147, v148 dst_sel:WORD_1 dst_unused:UNUSED_PRESERVE src0_sel:WORD_1
s_waitcnt lgkmcnt(6)
ds_read_b128 v[224:227], v248 offset:53248
ds_read_u16_d16 v140, v140
ds_read_u16_d16 v142, v142
v_mfma_f32_32x32x16_bf16 v[120:135], v[228:231], v[108:111], v[120:135]
v_fmac_f32 v166, v198, v198
v_lshrrev_b32 v141, 18, v141
v_pk_add_f16 v153, v153, 1.0 op_sel_hi:[1,0]
v_fmac_f32 v166, v199, v199
v_lshrrev_b32 v143, 18, v143
v_pk_add_f16 v150, v150, 1.0 op_sel_hi:[1,0]
v_pk_add_f16 v147, v147, 1.0 op_sel_hi:[1,0]
v_fmac_f32 v166, v200, v200
v_and_b32 v145, s49, v145
s_waitcnt lgkmcnt(4)
ds_read_b128 v[228:231], v248 offset:56320
ds_read_u16_d16_hi v141, v141
ds_read_u16_d16_hi v143, v143
v_mfma_f32_32x32x16_bf16 v[120:135], v[232:235], v[112:115], v[120:135]
v_rcp_f16 v154, v153
v_fmac_f32 v166, v201, v201
v_lshrrev_b16 v144, 2, v145
v_rcp_f16 v151, v150
v_fmac_f32 v166, v202, v202
v_lshrrev_b32 v145, 18, v145
v_rcp_f16 v148, v147
v_fmac_f32 v166, v203, v203
v_or_b32 v168, v136, v137
ds_read_b128 v[232:235], v248 offset:54272
ds_read_u16_d16 v144, v144
ds_read_u16_d16_hi v145, v145
v_mfma_f32_32x32x16_bf16 v[120:135], v[236:239], v[116:119], v[120:135]
s_waitcnt lgkmcnt(6)
v_or_b32 v169, v138, v139
v_rcp_f16_sdwa v154, v153 dst_sel:WORD_1 dst_unused:UNUSED_PRESERVE src0_sel:WORD_1
v_fmac_f32 v166, v204, v204
s_waitcnt lgkmcnt(4)
v_or_b32 v170, v140, v141
v_rcp_f16_sdwa v151, v150 dst_sel:WORD_1 dst_unused:UNUSED_PRESERVE src0_sel:WORD_1
v_fmac_f32 v166, v205, v205
s_waitcnt lgkmcnt(3)
v_or_b32 v171, v142, v143
v_rcp_f16_sdwa v148, v147 dst_sel:WORD_1 dst_unused:UNUSED_PRESERVE src0_sel:WORD_1
v_fmac_f32 v166, v206, v206
s_waitcnt lgkmcnt(0)
v_or_b32 v172, v144, v145
v_pk_mul_f16 v173, v155, v154
v_fmac_f32 v166, v207, v207
v_pk_mul_f16 v174, v152, v151
v_pk_mul_f16 v175, v149, v148
s_setprio 1
ds_read_b128 v[236:239], v248 offset:57344
v_mfma_f32_32x32x16_f16 v[192:207], v[168:171], v[240:243], 0
v_cvt_pkrtz_f16_f32 v137, v120, v121
v_cvt_pkrtz_f16_f32 v139, v122, v123
v_cvt_pkrtz_f16_f32 v141, v124, v125
v_cvt_pkrtz_f16_f32 v143, v126, v127
v_cvt_pkrtz_f16_f32 v145, v128, v129
v_mfma_f32_32x32x16_f16 v[192:207], v[172:175], v[244:247], v[192:207]
v_cvt_pk_f16_f32 v155, v130, v131
v_cvt_pk_f16_f32 v152, v132, v133
v_cvt_pk_f16_f32 v149, v134, v135
v_pk_fma_f16 v154, v155, v155, s48
v_and_b32 v137, s49, v137
v_pk_fma_f16 v151, v152, v152, s48
v_mfma_f32_32x32x16_bf16 v[120:135], v[224:227], v[96:99], 0
v_and_b32 v139, s49, v139
v_pk_fma_f16 v148, v149, v149, s48
v_pk_mul_f16 v154, v155, v154
v_lshrrev_b16 v136, 2, v137
v_pk_mul_f16 v151, v152, v151
v_pk_mul_f16 v148, v149, v148
v_fmac_f32 v167, v192, v192
v_fmac_f32 v167, v193, v193
v_fmac_f32 v167, v194, v194
v_fmac_f32 v167, v195, v195
v_fmac_f32 v167, v196, v196
ds_read_b128 v[224:227], v248 offset:55296
ds_read_u16_d16 v136, v136
v_mfma_f32_32x32x16_bf16 v[120:135], v[228:231], v[100:103], v[120:135]
v_fmac_f32 v167, v197, v197
v_fmac_f32 v167, v198, v198
v_fmac_f32 v167, v199, v199
v_fmac_f32 v167, v200, v200
v_fmac_f32 v167, v201, v201
v_fmac_f32 v167, v202, v202
v_fmac_f32 v167, v203, v203
v_fmac_f32 v167, v204, v204
v_fmac_f32 v167, v205, v205
v_fmac_f32 v167, v206, v206
v_fmac_f32 v167, v207, v207
ds_read_b128 v[228:231], v248 offset:58368
v_mfma_f32_32x32x16_bf16 v[120:135], v[232:235], v[104:107], v[120:135]
v_permlane32_swap_b32 v166, v167
v_add_f32 v166, v166, v167
ds_write_b32 v255, v166 offset:8448
s_setprio 3
s_mov_b64 exec, 1
ds_add_rtn_u32 v242, v253, v254
s_mov_b64 exec, -1
s_waitcnt lgkmcnt(0)
v_readfirstlane_b32 s43, v242
s_nop 1
s_cmp_lg_u32 s43, 7
s_cbranch_scc1 Lnopub
v_min_u32 v243, 47, v251
v_lshlrev_b32 v244, 5, v243
v_add_u32 v244, 97280, v244
ds_read_b128 v[176:179], v244
ds_read_b128 v[180:183], v244 offset:16
ds_read_b128 v[184:187], v244 offset:9216
ds_read_b128 v[188:191], v244 offset:9232
ds_read_b128 v[192:195], v244 offset:18432
ds_read_b128 v[196:199], v244 offset:18448
ds_read_b128 v[200:203], v244 offset:27648
ds_read_b128 v[204:207], v244 offset:27664
ds_read_b128 v[156:159], v244 offset:36864
ds_read_b128 v[160:163], v244 offset:36880
v_lshlrev_b32 v246, 13, v243
v_add_u32 v247, 4096, v246
s_waitcnt lgkmcnt(7)
v_add_f32 v176, v176, v184
v_add_f32 v177, v177, v185
v_add_f32 v178, v178, v186
v_add_f32 v179, v179, v187
s_waitcnt lgkmcnt(6)
v_add_f32 v180, v180, v188
v_add_f32 v181, v181, v189
v_add_f32 v182, v182, v190
v_add_f32 v183, v183, v191
ds_read_b128 v[184:187], v244 offset:46080
ds_read_b128 v[188:191], v244 offset:46096
s_waitcnt lgkmcnt(5)
v_add_f32 v192, v192, v200
v_add_f32 v193, v193, v201
v_add_f32 v194, v194, v202
v_add_f32 v195, v195, v203
s_waitcnt lgkmcnt(4)
v_add_f32 v196, v196, v204
v_add_f32 v197, v197, v205
v_add_f32 v198, v198, v206
v_add_f32 v199, v199, v207
ds_read_b128 v[200:203], v244 offset:55296
ds_read_b128 v[204:207], v244 offset:55312
v_add_f32 v176, v176, v192
v_add_f32 v177, v177, v193
v_add_f32 v178, v178, v194
v_add_f32 v179, v179, v195
v_add_f32 v180, v180, v196
v_add_f32 v181, v181, v197
v_add_f32 v182, v182, v198
v_add_f32 v183, v183, v199
ds_read_b128 v[192:195], v244 offset:64512
ds_read_b128 v[196:199], v244 offset:64528
s_waitcnt lgkmcnt(5)
v_add_f32 v156, v156, v184
v_add_f32 v157, v157, v185
v_add_f32 v158, v158, v186
v_add_f32 v159, v159, v187
s_waitcnt lgkmcnt(4)
v_add_f32 v160, v160, v188
v_add_f32 v161, v161, v189
v_add_f32 v162, v162, v190
v_add_f32 v163, v163, v191
s_waitcnt lgkmcnt(1)
v_add_f32 v200, v200, v192
v_add_f32 v201, v201, v193
v_add_f32 v202, v202, v194
v_add_f32 v203, v203, v195
s_waitcnt lgkmcnt(0)
v_add_f32 v204, v204, v196
v_add_f32 v205, v205, v197
v_add_f32 v206, v206, v198
v_add_f32 v207, v207, v199
v_add_f32 v156, v156, v200
v_add_f32 v157, v157, v201
v_add_f32 v158, v158, v202
v_add_f32 v159, v159, v203
v_add_f32 v160, v160, v204
v_add_f32 v161, v161, v205
v_add_f32 v162, v162, v206
v_add_f32 v163, v163, v207
v_add_f32 v176, v176, v156
v_add_f32 v177, v177, v157
v_add_f32 v178, v178, v158
v_add_f32 v179, v179, v159
v_add_f32 v180, v180, v160
v_add_f32 v181, v181, v161
v_add_f32 v182, v182, v162
v_add_f32 v183, v183, v163
v_min_u32 v184, -2, v176
v_min_u32 v185, -2, v177
v_min_u32 v186, -2, v178
v_min_u32 v187, -2, v179
v_min_u32 v188, -2, v180
v_min_u32 v189, -2, v181
v_min_u32 v190, -2, v182
v_min_u32 v191, -2, v183
s_lshl_b32 s43, s2, 4
buffer_store_dwordx4 v[184:187], v246, s[32:35], s43 offen sc1
buffer_store_dwordx4 v[188:191], v247, s[32:35], s43 offen sc1
ds_write_b32 v253, v254 offset:4
s_nop 1
Lnopub:
s_mov_b32 s77, 0
s_cmp_lg_u32 s40, 0
s_cbranch_scc1 Lnorole
s_cmp_lt_u32 s2, 96
s_cselect_b32 s77, 1, 2
s_waitcnt lgkmcnt(0)
v_mov_b32 v156, -1
v_mov_b32 v157, -1
v_mov_b32 v158, -1
v_mov_b32 v159, -1
v_mov_b32 v160, -1
v_mov_b32 v161, -1
v_mov_b32 v162, -1
v_mov_b32 v163, -1
v_mov_b32 v164, -1
v_mov_b32 v165, -1
v_mov_b32 v166, -1
v_mov_b32 v167, -1
v_mov_b32 v252, -1
v_mov_b32 v253, -1
v_mov_b32 v254, -1
v_mov_b32 v255, -1
s_call_b64 s[78:79], Lpoll1
Lnorole:
s_setprio 1
v_lshrrev_b16 v138, 2, v139
v_exp_f16 v153, v154
v_lshrrev_b32 v137, 18, v137
v_exp_f16 v150, v151
v_lshrrev_b32 v139, 18, v139
ds_read_b128 v[232:235], v248 offset:59392
ds_read_u16_d16 v138, v138
ds_read_u16_d16_hi v137, v137
ds_read_u16_d16_hi v139, v139
v_mfma_f32_32x32x16_bf16 v[120:135], v[236:239], v[108:111], v[120:135]
v_exp_f16 v147, v148
v_and_b32 v141, s49, v141
v_and_b32 v143, s49, v143
v_exp_f16_sdwa v153, v154 dst_sel:WORD_1 dst_unused:UNUSED_PRESERVE src0_sel:WORD_1
v_lshrrev_b16 v140, 2, v141
v_exp_f16_sdwa v150, v151 dst_sel:WORD_1 dst_unused:UNUSED_PRESERVE src0_sel:WORD_1
v_lshrrev_b16 v142, 2, v143
v_exp_f16_sdwa v147, v148 dst_sel:WORD_1 dst_unused:UNUSED_PRESERVE src0_sel:WORD_1
ds_read_b128 v[236:239], v248 offset:62464
ds_read_u16_d16 v140, v140
ds_read_u16_d16 v142, v142
v_mfma_f32_32x32x16_bf16 v[120:135], v[224:227], v[112:115], v[120:135]
v_lshrrev_b32 v141, 18, v141
v_pk_add_f16 v153, v153, 1.0 op_sel_hi:[1,0]
v_lshrrev_b32 v143, 18, v143
v_pk_add_f16 v150, v150, 1.0 op_sel_hi:[1,0]
s_setprio 0
v_pk_add_f16 v147, v147, 1.0 op_sel_hi:[1,0]
v_and_b32 v145, s49, v145
v_rcp_f16 v154, v153
v_lshrrev_b16 v144, 2, v145
v_rcp_f16 v151, v150
ds_read_b128 v[224:227], v248 offset:60416
ds_read_u16_d16_hi v141, v141
ds_read_u16_d16_hi v143, v143
ds_read_u16_d16 v144, v144
v_mfma_f32_32x32x16_bf16 v[120:135], v[228:231], v[116:119], v[120:135]
v_lshrrev_b32 v145, 18, v145
v_rcp_f16 v148, v147
s_waitcnt lgkmcnt(7)
v_or_b32 v176, v136, v137
v_or_b32 v177, v138, v139
v_rcp_f16_sdwa v154, v153 dst_sel:WORD_1 dst_unused:UNUSED_PRESERVE src0_sel:WORD_1
s_waitcnt lgkmcnt(2)
v_or_b32 v178, v140, v141
v_rcp_f16_sdwa v151, v150 dst_sel:WORD_1 dst_unused:UNUSED_PRESERVE src0_sel:WORD_1
s_waitcnt lgkmcnt(1)
v_or_b32 v179, v142, v143
v_rcp_f16_sdwa v148, v147 dst_sel:WORD_1 dst_unused:UNUSED_PRESERVE src0_sel:WORD_1
ds_read_u16_d16_hi v145, v145
s_waitcnt lgkmcnt(0)
v_or_b32 v180, v144, v145
v_pk_mul_f16 v181, v155, v154
v_pk_mul_f16 v182, v152, v151
v_pk_mul_f16 v183, v149, v148
s_cmp_eq_u32 s77, 0
s_cbranch_scc1 Lpp49
s_getreg_b32 s43, hwreg(HW_REG_IB_STS, 0, 4)
s_cmp_lg_u32 s43, 0
s_cbranch_scc1 Lpp49
s_call_b64 s[78:79], Lpoll
s_setprio 0
Lpp49:
s_setprio 2
v_cvt_pkrtz_f16_f32 v137, v120, v121
v_cvt_pkrtz_f16_f32 v139, v122, v123
v_cvt_pkrtz_f16_f32 v141, v124, v125
v_cvt_pkrtz_f16_f32 v143, v126, v127
v_cvt_pkrtz_f16_f32 v145, v128, v129
v_cvt_pk_f16_f32 v155, v130, v131
v_cvt_pk_f16_f32 v152, v132, v133
v_cvt_pk_f16_f32 v149, v134, v135
ds_read_b128 v[228:231], v248 offset:63488
v_mfma_f32_32x32x16_bf16 v[120:135], v[232:235], v[96:99], 0
v_pk_fma_f16 v154, v155, v155, s48
v_and_b32 v137, s49, v137
v_pk_fma_f16 v151, v152, v152, s48
v_and_b32 v139, s49, v139
v_pk_fma_f16 v148, v149, v149, s48
v_pk_mul_f16 v154, v155, v154
v_lshrrev_b16 v136, 2, v137
v_pk_mul_f16 v151, v152, v151
ds_read_b128 v[232:235], v248 offset:61440
ds_read_u16_d16 v136, v136
v_mfma_f32_32x32x16_bf16 v[120:135], v[236:239], v[100:103], v[120:135]
v_pk_mul_f16 v148, v149, v148
v_lshrrev_b16 v138, 2, v139
v_exp_f16 v153, v154
v_lshrrev_b32 v137, 18, v137
v_exp_f16 v150, v151
v_lshrrev_b32 v139, 18, v139
ds_read_b128 v[236:239], v248 offset:64512
ds_read_u16_d16 v138, v138
ds_read_u16_d16_hi v137, v137
ds_read_u16_d16_hi v139, v139
v_mfma_f32_32x32x16_bf16 v[120:135], v[224:227], v[104:107], v[120:135]
v_exp_f16 v147, v148
v_and_b32 v141, s49, v141
v_and_b32 v143, s49, v143
v_exp_f16_sdwa v153, v154 dst_sel:WORD_1 dst_unused:UNUSED_PRESERVE src0_sel:WORD_1
v_lshrrev_b16 v140, 2, v141
v_exp_f16_sdwa v150, v151 dst_sel:WORD_1 dst_unused:UNUSED_PRESERVE src0_sel:WORD_1
s_waitcnt lgkmcnt(6)
ds_read_b128 v[224:227], v249
ds_read_u16_d16 v140, v140
v_mfma_f32_32x32x16_bf16 v[120:135], v[228:231], v[108:111], v[120:135]
v_lshrrev_b16 v142, 2, v143
v_exp_f16_sdwa v147, v148 dst_sel:WORD_1 dst_unused:UNUSED_PRESERVE src0_sel:WORD_1
v_lshrrev_b32 v141, 18, v141
v_pk_add_f16 v153, v153, 1.0 op_sel_hi:[1,0]
v_lshrrev_b32 v143, 18, v143
v_pk_add_f16 v150, v150, 1.0 op_sel_hi:[1,0]
v_pk_add_f16 v147, v147, 1.0 op_sel_hi:[1,0]
s_waitcnt lgkmcnt(6)
ds_read_b128 v[228:231], v249 offset:3072
ds_read_u16_d16 v142, v142
ds_read_u16_d16_hi v141, v141
ds_read_u16_d16_hi v143, v143
v_mfma_f32_32x32x16_bf16 v[120:135], v[232:235], v[112:115], v[120:135]
v_and_b32 v145, s49, v145
v_rcp_f16 v154, v153
v_lshrrev_b16 v144, 2, v145
v_rcp_f16 v151, v150
v_lshrrev_b32 v145, 18, v145
s_waitcnt lgkmcnt(6)
ds_read_b128 v[232:235], v249 offset:1024
ds_read_u16_d16 v144, v144
ds_read_u16_d16_hi v145, v145
v_mfma_f32_32x32x16_bf16 v[120:135], v[236:239], v[116:119], v[120:135]
v_rcp_f16 v148, v147
v_or_b32 v184, v136, v137
v_or_b32 v185, v138, v139
v_rcp_f16_sdwa v154, v153 dst_sel:WORD_1 dst_unused:UNUSED_PRESERVE src0_sel:WORD_1
s_waitcnt lgkmcnt(4)
v_or_b32 v186, v140, v141
v_rcp_f16_sdwa v151, v150 dst_sel:WORD_1 dst_unused:UNUSED_PRESERVE src0_sel:WORD_1
s_waitcnt lgkmcnt(3)
v_or_b32 v187, v142, v143
v_rcp_f16_sdwa v148, v147 dst_sel:WORD_1 dst_unused:UNUSED_PRESERVE src0_sel:WORD_1
s_waitcnt lgkmcnt(0)
v_or_b32 v188, v144, v145
v_pk_mul_f16 v189, v155, v154
v_pk_mul_f16 v190, v152, v151
v_pk_mul_f16 v191, v149, v148
s_cmp_eq_u32 s77, 0
s_cbranch_scc1 Lpp50
s_getreg_b32 s43, hwreg(HW_REG_IB_STS, 0, 4)
s_cmp_lg_u32 s43, 0
s_cbranch_scc1 Lpp50
s_call_b64 s[78:79], Lpoll
s_setprio 2
Lpp50:
s_setprio 1
v_cvt_pkrtz_f16_f32 v137, v120, v121
v_cvt_pkrtz_f16_f32 v139, v122, v123
v_cvt_pkrtz_f16_f32 v141, v124, v125
v_cvt_pkrtz_f16_f32 v143, v126, v127
v_cvt_pkrtz_f16_f32 v145, v128, v129
v_cvt_pk_f16_f32 v155, v130, v131
v_cvt_pk_f16_f32 v152, v132, v133
v_cvt_pk_f16_f32 v149, v134, v135
ds_read_b128 v[236:239], v249 offset:4096
v_mfma_f32_32x32x16_bf16 v[120:135], v[224:227], v[96:99], 0
v_pk_fma_f16 v154, v155, v155, s48
v_and_b32 v137, s49, v137
v_pk_fma_f16 v151, v152, v152, s48
v_and_b32 v139, s49, v139
v_pk_fma_f16 v148, v149, v149, s48
v_pk_mul_f16 v154, v155, v154
v_lshrrev_b16 v136, 2, v137
v_pk_mul_f16 v151, v152, v151
ds_read_b128 v[224:227], v249 offset:2048
ds_read_u16_d16 v136, v136
v_mfma_f32_32x32x16_bf16 v[120:135], v[228:231], v[100:103], v[120:135]
v_pk_mul_f16 v148, v149, v148
v_lshrrev_b16 v138, 2, v139
v_exp_f16 v153, v154
v_lshrrev_b32 v137, 18, v137
v_exp_f16 v150, v151
v_lshrrev_b32 v139, 18, v139
ds_read_b128 v[228:231], v249 offset:5120
ds_read_u16_d16 v138, v138
ds_read_u16_d16_hi v137, v137
ds_read_u16_d16_hi v139, v139
v_mfma_f32_32x32x16_bf16 v[120:135], v[232:235], v[104:107], v[120:135]
v_exp_f16 v147, v148
v_and_b32 v141, s49, v141
v_and_b32 v143, s49, v143
v_exp_f16_sdwa v153, v154 dst_sel:WORD_1 dst_unused:UNUSED_PRESERVE src0_sel:WORD_1
v_lshrrev_b16 v140, 2, v141
v_exp_f16_sdwa v150, v151 dst_sel:WORD_1 dst_unused:UNUSED_PRESERVE src0_sel:WORD_1
s_waitcnt lgkmcnt(6)
ds_read_b128 v[232:235], v249 offset:6144
ds_read_u16_d16 v140, v140
v_mfma_f32_32x32x16_bf16 v[120:135], v[236:239], v[108:111], v[120:135]
v_lshrrev_b16 v142, 2, v143
v_exp_f16_sdwa v147, v148 dst_sel:WORD_1 dst_unused:UNUSED_PRESERVE src0_sel:WORD_1
v_lshrrev_b32 v141, 18, v141
v_pk_add_f16 v153, v153, 1.0 op_sel_hi:[1,0]
v_lshrrev_b32 v143, 18, v143
v_pk_add_f16 v150, v150, 1.0 op_sel_hi:[1,0]
v_pk_add_f16 v147, v147, 1.0 op_sel_hi:[1,0]
s_waitcnt lgkmcnt(6)
ds_read_b128 v[236:239], v249 offset:9216
ds_read_u16_d16 v142, v142
ds_read_u16_d16_hi v141, v141
ds_read_u16_d16_hi v143, v143
v_mfma_f32_32x32x16_bf16 v[120:135], v[224:227], v[112:115], v[120:135]
v_and_b32 v145, s49, v145
v_rcp_f16 v154, v153
v_lshrrev_b16 v144, 2, v145
s_setprio 0
v_rcp_f16 v151, v150
v_lshrrev_b32 v145, 18, v145
s_waitcnt lgkmcnt(6)
ds_read_b128 v[224:227], v249 offset:7168
ds_read_u16_d16 v144, v144
ds_read_u16_d16_hi v145, v145
v_mfma_f32_32x32x16_bf16 v[120:135], v[228:231], v[116:119], v[120:135]
v_rcp_f16 v148, v147
v_or_b32 v192, v136, v137
v_or_b32 v193, v138, v139
v_rcp_f16_sdwa v154, v153 dst_sel:WORD_1 dst_unused:UNUSED_PRESERVE src0_sel:WORD_1
s_waitcnt lgkmcnt(4)
v_or_b32 v194, v140, v141
v_rcp_f16_sdwa v151, v150 dst_sel:WORD_1 dst_unused:UNUSED_PRESERVE src0_sel:WORD_1
s_waitcnt lgkmcnt(3)
v_or_b32 v195, v142, v143
v_rcp_f16_sdwa v148, v147 dst_sel:WORD_1 dst_unused:UNUSED_PRESERVE src0_sel:WORD_1
s_waitcnt lgkmcnt(0)
v_or_b32 v196, v144, v145
v_pk_mul_f16 v197, v155, v154
v_pk_mul_f16 v198, v152, v151
v_pk_mul_f16 v199, v149, v148
s_cmp_eq_u32 s77, 0
s_cbranch_scc1 Lpp51
s_getreg_b32 s43, hwreg(HW_REG_IB_STS, 0, 4)
s_cmp_lg_u32 s43, 0
s_cbranch_scc1 Lpp51
s_call_b64 s[78:79], Lpoll
s_setprio 0
Lpp51:
v_mov_b32 v136, 16256
Lw2w:
ds_read_b32 v137, v136 offset:4
s_waitcnt lgkmcnt(0)
v_readfirstlane_b32 s43, v137
s_cmp_eq_u32 s76, 0
s_cbranch_scc1 Lw2x
s_sub_u32 s76, s76, 1
s_cmp_lt_u32 s43, 1
s_cbranch_scc0 Lw2x
s_sleep 2
s_branch Lw2w
Lw2x:
v_lshrrev_b32 v136, 2, v251
v_mul_u32_u24 v136, 192, v136
v_and_b32 v137, 3, v251
v_lshl_add_u32 v136, v137, 4, v136
s_add_u32 m0, s72, 7168
s_add_u32 s43, s82, 6208
buffer_load_dwordx4 v136, s[16:19], s43 offen lds
s_add_u32 m0, s72, 8192
s_add_u32 s43, s82, 6272
buffer_load_dwordx4 v136, s[16:19], s43 offen lds
s_setprio 2
v_cvt_pkrtz_f16_f32 v137, v120, v121
v_cvt_pkrtz_f16_f32 v139, v122, v123
v_cvt_pkrtz_f16_f32 v141, v124, v125
v_cvt_pkrtz_f16_f32 v143, v126, v127
v_cvt_pkrtz_f16_f32 v145, v128, v129
v_cvt_pk_f16_f32 v155, v130, v131
v_cvt_pk_f16_f32 v152, v132, v133
v_cvt_pk_f16_f32 v149, v134, v135
ds_read_b128 v[228:231], v249 offset:10240
v_mfma_f32_32x32x16_bf16 v[120:135], v[232:235], v[96:99], 0
v_pk_fma_f16 v154, v155, v155, s48
v_and_b32 v137, s49, v137
v_pk_fma_f16 v151, v152, v152, s48
v_and_b32 v139, s49, v139
v_pk_fma_f16 v148, v149, v149, s48
v_pk_mul_f16 v154, v155, v154
v_lshrrev_b16 v136, 2, v137
v_pk_mul_f16 v151, v152, v151
ds_read_b128 v[232:235], v249 offset:8192
ds_read_u16_d16 v136, v136
v_mfma_f32_32x32x16_bf16 v[120:135], v[236:239], v[100:103], v[120:135]
v_pk_mul_f16 v148, v149, v148
v_lshrrev_b16 v138, 2, v139
v_exp_f16 v153, v154
v_lshrrev_b32 v137, 18, v137
v_exp_f16 v150, v151
v_lshrrev_b32 v139, 18, v139
ds_read_b128 v[236:239], v249 offset:11264
ds_read_u16_d16 v138, v138
ds_read_u16_d16_hi v137, v137
ds_read_u16_d16_hi v139, v139
v_mfma_f32_32x32x16_bf16 v[120:135], v[224:227], v[104:107], v[120:135]
v_exp_f16 v147, v148
v_and_b32 v141, s49, v141
v_and_b32 v143, s49, v143
v_exp_f16_sdwa v153, v154 dst_sel:WORD_1 dst_unused:UNUSED_PRESERVE src0_sel:WORD_1
v_lshrrev_b16 v140, 2, v141
v_exp_f16_sdwa v150, v151 dst_sel:WORD_1 dst_unused:UNUSED_PRESERVE src0_sel:WORD_1
s_waitcnt lgkmcnt(6)
ds_read_b128 v[224:227], v249 offset:12288
ds_read_u16_d16 v140, v140
v_mfma_f32_32x32x16_bf16 v[120:135], v[228:231], v[108:111], v[120:135]
v_lshrrev_b16 v142, 2, v143
v_exp_f16_sdwa v147, v148 dst_sel:WORD_1 dst_unused:UNUSED_PRESERVE src0_sel:WORD_1
v_lshrrev_b32 v141, 18, v141
v_pk_add_f16 v153, v153, 1.0 op_sel_hi:[1,0]
v_lshrrev_b32 v143, 18, v143
v_pk_add_f16 v150, v150, 1.0 op_sel_hi:[1,0]
v_pk_add_f16 v147, v147, 1.0 op_sel_hi:[1,0]
s_waitcnt lgkmcnt(6)
ds_read_b128 v[228:231], v249 offset:15360
ds_read_u16_d16 v142, v142
ds_read_u16_d16_hi v141, v141
ds_read_u16_d16_hi v143, v143
v_mfma_f32_32x32x16_bf16 v[120:135], v[232:235], v[112:115], v[120:135]
v_and_b32 v145, s49, v145
v_rcp_f16 v154, v153
v_lshrrev_b16 v144, 2, v145
v_rcp_f16 v151, v150
v_lshrrev_b32 v145, 18, v145
s_waitcnt lgkmcnt(6)
ds_read_b128 v[232:235], v249 offset:13312
ds_read_u16_d16 v144, v144
ds_read_u16_d16_hi v145, v145
v_mfma_f32_32x32x16_bf16 v[120:135], v[236:239], v[116:119], v[120:135]
v_rcp_f16 v148, v147
v_or_b32 v200, v136, v137
v_or_b32 v201, v138, v139
v_rcp_f16_sdwa v154, v153 dst_sel:WORD_1 dst_unused:UNUSED_PRESERVE src0_sel:WORD_1
s_waitcnt lgkmcnt(4)
v_or_b32 v202, v140, v141
v_rcp_f16_sdwa v151, v150 dst_sel:WORD_1 dst_unused:UNUSED_PRESERVE src0_sel:WORD_1
s_waitcnt lgkmcnt(3)
v_or_b32 v203, v142, v143
v_rcp_f16_sdwa v148, v147 dst_sel:WORD_1 dst_unused:UNUSED_PRESERVE src0_sel:WORD_1
s_waitcnt lgkmcnt(0)
v_or_b32 v204, v144, v145
v_pk_mul_f16 v205, v155, v154
v_pk_mul_f16 v206, v152, v151
v_pk_mul_f16 v207, v149, v148
s_cmp_eq_u32 s77, 0
s_cbranch_scc1 Lpp52
s_getreg_b32 s43, hwreg(HW_REG_IB_STS, 0, 4)
s_cmp_lg_u32 s43, 0
s_cbranch_scc1 Lpp52
s_call_b64 s[78:79], Lpoll
s_setprio 2
Lpp52:
s_setprio 1
v_cvt_pkrtz_f16_f32 v137, v120, v121
v_cvt_pkrtz_f16_f32 v139, v122, v123
v_cvt_pkrtz_f16_f32 v141, v124, v125
v_cvt_pkrtz_f16_f32 v143, v126, v127
v_cvt_pkrtz_f16_f32 v145, v128, v129
v_cvt_pk_f16_f32 v155, v130, v131
v_cvt_pk_f16_f32 v152, v132, v133
v_cvt_pk_f16_f32 v149, v134, v135
ds_read_b128 v[236:239], v249 offset:16384
v_mfma_f32_32x32x16_bf16 v[120:135], v[224:227], v[96:99], 0
v_pk_fma_f16 v154, v155, v155, s48
v_and_b32 v137, s49, v137
v_pk_fma_f16 v151, v152, v152, s48
v_and_b32 v139, s49, v139
v_pk_fma_f16 v148, v149, v149, s48
v_pk_mul_f16 v154, v155, v154
v_lshrrev_b16 v136, 2, v137
v_pk_mul_f16 v151, v152, v151
ds_read_b128 v[224:227], v249 offset:14336
ds_read_u16_d16 v136, v136
v_mfma_f32_32x32x16_bf16 v[120:135], v[228:231], v[100:103], v[120:135]
v_pk_mul_f16 v148, v149, v148
v_lshrrev_b16 v138, 2, v139
v_exp_f16 v153, v154
v_lshrrev_b32 v137, 18, v137
v_exp_f16 v150, v151
v_lshrrev_b32 v139, 18, v139
ds_read_b128 v[228:231], v249 offset:17408
ds_read_u16_d16 v138, v138
ds_read_u16_d16_hi v137, v137
ds_read_u16_d16_hi v139, v139
v_mfma_f32_32x32x16_bf16 v[120:135], v[232:235], v[104:107], v[120:135]
v_exp_f16 v147, v148
v_and_b32 v141, s49, v141
v_and_b32 v143, s49, v143
v_exp_f16_sdwa v153, v154 dst_sel:WORD_1 dst_unused:UNUSED_PRESERVE src0_sel:WORD_1
v_lshrrev_b16 v140, 2, v141
v_exp_f16_sdwa v150, v151 dst_sel:WORD_1 dst_unused:UNUSED_PRESERVE src0_sel:WORD_1
s_waitcnt lgkmcnt(6)
ds_read_u16_d16 v140, v140
v_mfma_f32_32x32x16_bf16 v[120:135], v[236:239], v[108:111], v[120:135]
v_lshrrev_b16 v142, 2, v143
v_exp_f16_sdwa v147, v148 dst_sel:WORD_1 dst_unused:UNUSED_PRESERVE src0_sel:WORD_1
v_lshrrev_b32 v141, 18, v141
v_pk_add_f16 v153, v153, 1.0 op_sel_hi:[1,0]
v_lshrrev_b32 v143, 18, v143
v_pk_add_f16 v150, v150, 1.0 op_sel_hi:[1,0]
v_pk_add_f16 v147, v147, 1.0 op_sel_hi:[1,0]
s_waitcnt lgkmcnt(5)
ds_read_u16_d16 v142, v142
ds_read_u16_d16_hi v141, v141
ds_read_u16_d16_hi v143, v143
v_mfma_f32_32x32x16_bf16 v[120:135], v[224:227], v[112:115], v[120:135]
v_and_b32 v145, s49, v145
v_rcp_f16 v154, v153
v_lshrrev_b16 v144, 2, v145
s_setprio 0
v_rcp_f16 v151, v150
v_lshrrev_b32 v145, 18, v145
s_waitcnt lgkmcnt(4)
ds_read_u16_d16 v144, v144
ds_read_u16_d16_hi v145, v145
v_mfma_f32_32x32x16_bf16 v[120:135], v[228:231], v[116:119], v[120:135]
v_rcp_f16 v148, v147
v_or_b32 v240, v136, v137
v_or_b32 v241, v138, v139
v_rcp_f16_sdwa v154, v153 dst_sel:WORD_1 dst_unused:UNUSED_PRESERVE src0_sel:WORD_1
s_waitcnt lgkmcnt(3)
v_or_b32 v242, v140, v141
v_rcp_f16_sdwa v151, v150 dst_sel:WORD_1 dst_unused:UNUSED_PRESERVE src0_sel:WORD_1
s_waitcnt lgkmcnt(2)
v_or_b32 v243, v142, v143
v_rcp_f16_sdwa v148, v147 dst_sel:WORD_1 dst_unused:UNUSED_PRESERVE src0_sel:WORD_1
s_waitcnt lgkmcnt(0)
v_or_b32 v244, v144, v145
v_pk_mul_f16 v245, v155, v154
v_pk_mul_f16 v246, v152, v151
v_pk_mul_f16 v247, v149, v148
s_cmp_eq_u32 s77, 0
s_cbranch_scc1 Lpp53
s_getreg_b32 s43, hwreg(HW_REG_IB_STS, 0, 4)
s_cmp_lg_u32 s43, 0
s_cbranch_scc1 Lpp53
s_call_b64 s[78:79], Lpoll
s_setprio 0
Lpp53:
s_setprio 2
v_cvt_pkrtz_f16_f32 v137, v120, v121
v_cvt_pkrtz_f16_f32 v139, v122, v123
v_cvt_pkrtz_f16_f32 v141, v124, v125
v_cvt_pkrtz_f16_f32 v143, v126, v127
v_cvt_pkrtz_f16_f32 v145, v128, v129
v_cvt_pk_f16_f32 v155, v130, v131
v_cvt_pk_f16_f32 v152, v132, v133
v_cvt_pk_f16_f32 v149, v134, v135
v_pk_fma_f16 v154, v155, v155, s48
v_and_b32 v137, s49, v137
v_pk_fma_f16 v151, v152, v152, s48
v_and_b32 v139, s49, v139
v_pk_fma_f16 v148, v149, v149, s48
v_pk_mul_f16 v154, v155, v154
v_lshrrev_b16 v136, 2, v137
v_pk_mul_f16 v151, v152, v151
v_pk_mul_f16 v148, v149, v148
v_lshrrev_b16 v138, 2, v139
v_exp_f16 v153, v154
v_lshrrev_b32 v137, 18, v137
v_exp_f16 v150, v151
v_lshrrev_b32 v139, 18, v139
v_exp_f16 v147, v148
v_and_b32 v141, s49, v141
v_and_b32 v143, s49, v143
ds_read_u16_d16 v136, v136
ds_read_u16_d16 v138, v138
ds_read_u16_d16_hi v137, v137
ds_read_u16_d16_hi v139, v139
v_exp_f16_sdwa v153, v154 dst_sel:WORD_1 dst_unused:UNUSED_PRESERVE src0_sel:WORD_1
v_lshrrev_b16 v140, 2, v141
v_exp_f16_sdwa v150, v151 dst_sel:WORD_1 dst_unused:UNUSED_PRESERVE src0_sel:WORD_1
s_setprio 1
v_lshrrev_b16 v142, 2, v143
v_exp_f16_sdwa v147, v148 dst_sel:WORD_1 dst_unused:UNUSED_PRESERVE src0_sel:WORD_1
v_lshrrev_b32 v141, 18, v141
v_pk_add_f16 v153, v153, 1.0 op_sel_hi:[1,0]
v_lshrrev_b32 v143, 18, v143
v_pk_add_f16 v150, v150, 1.0 op_sel_hi:[1,0]
v_pk_add_f16 v147, v147, 1.0 op_sel_hi:[1,0]
v_and_b32 v145, s49, v145
v_rcp_f16 v154, v153
v_lshrrev_b16 v144, 2, v145
v_rcp_f16 v151, v150
v_lshrrev_b32 v145, 18, v145
ds_read_u16_d16 v140, v140
ds_read_u16_d16 v142, v142
ds_read_u16_d16_hi v141, v141
ds_read_u16_d16_hi v143, v143
ds_read_u16_d16 v144, v144
ds_read_u16_d16_hi v145, v145
v_rcp_f16 v148, v147
s_waitcnt lgkmcnt(7)
v_or_b32 v232, v136, v137
s_waitcnt lgkmcnt(6)
v_or_b32 v233, v138, v139
v_rcp_f16_sdwa v154, v153 dst_sel:WORD_1 dst_unused:UNUSED_PRESERVE src0_sel:WORD_1
s_waitcnt lgkmcnt(3)
v_or_b32 v234, v140, v141
s_setprio 0
v_rcp_f16_sdwa v151, v150 dst_sel:WORD_1 dst_unused:UNUSED_PRESERVE src0_sel:WORD_1
s_waitcnt lgkmcnt(2)
v_or_b32 v235, v142, v143
v_rcp_f16_sdwa v148, v147 dst_sel:WORD_1 dst_unused:UNUSED_PRESERVE src0_sel:WORD_1
s_waitcnt lgkmcnt(0)
v_or_b32 v236, v144, v145
v_pk_mul_f16 v237, v155, v154
v_pk_mul_f16 v238, v152, v151
v_pk_mul_f16 v239, v149, v148
s_cmp_eq_u32 s77, 0
s_cbranch_scc1 Lpp54
s_getreg_b32 s43, hwreg(HW_REG_IB_STS, 0, 4)
s_cmp_lg_u32 s43, 0
s_cbranch_scc1 Lpp54
s_call_b64 s[78:79], Lpoll
s_setprio 0
Lpp54:
s_setprio 2
v_lshrrev_b32 v225, 5, v251
v_lshl_add_u32 v224, v225, 9, s72
v_lshl_add_u32 v226, v225, 4, s72
v_and_b32 v225, 15, v251
v_lshl_add_u32 v224, v225, 4, v224
v_bfe_u32 v225, v251, 4, 1
v_lshl_add_u32 v224, v225, 3, v224
s_waitcnt vmcnt(0)
ds_read_b64_tr_b16 v[120:121], v224
ds_read_b64_tr_b16 v[122:123], v224 offset:256
ds_read_b64_tr_b16 v[124:125], v224 offset:1024
ds_read_b64_tr_b16 v[126:127], v224 offset:1280
ds_read_b64_tr_b16 v[128:129], v224 offset:2048
ds_read_b64_tr_b16 v[130:131], v224 offset:2304
ds_read_b64_tr_b16 v[132:133], v224 offset:3072
ds_read_b64_tr_b16 v[134:135], v224 offset:3328
ds_read_b64_tr_b16 v[136:137], v224 offset:4096
ds_read_b64_tr_b16 v[138:139], v224 offset:4352
ds_read_b64_tr_b16 v[140:141], v224 offset:5120
ds_read_b64_tr_b16 v[142:143], v224 offset:5376
ds_read_b64_tr_b16 v[144:145], v224 offset:6144
ds_read_b64_tr_b16 v[146:147], v224 offset:6400
ds_read_b64_tr_b16 v[148:149], v224 offset:7168
ds_read_b64_tr_b16 v[150:151], v224 offset:7424
ds_read_b64_tr_b16 v[152:153], v224 offset:8192
ds_read_b64_tr_b16 v[154:155], v224 offset:8448
v_mov_b32 v225, 16256
v_mov_b32 v227, 1
v_permlane16_swap_b32 v0, v4
v_permlane16_swap_b32 v1, v5
v_permlane16_swap_b32 v2, v6
v_permlane16_swap_b32 v3, v7
v_permlane16_swap_b32 v8, v12
v_permlane16_swap_b32 v9, v13
v_permlane16_swap_b32 v10, v14
v_permlane16_swap_b32 v11, v15
s_waitcnt lgkmcnt(0)
s_mov_b64 exec, 1
ds_add_u32 v225, v227 offset:8
s_mov_b64 exec, -1
v_lshlrev_b32 v228, 16, v120
v_and_b32 v229, 4294901760, v120
v_cvt_pk_f16_f32 v120, v228, v229
v_lshlrev_b32 v230, 16, v121
v_and_b32 v231, 4294901760, v121
v_cvt_pk_f16_f32 v121, v230, v231
v_lshlrev_b32 v228, 16, v122
v_and_b32 v229, 4294901760, v122
v_cvt_pk_f16_f32 v122, v228, v229
v_lshlrev_b32 v230, 16, v123
v_and_b32 v231, 4294901760, v123
v_cvt_pk_f16_f32 v123, v230, v231
v_lshlrev_b32 v228, 16, v124
v_and_b32 v229, 4294901760, v124
v_cvt_pk_f16_f32 v124, v228, v229
v_lshlrev_b32 v230, 16, v125
v_and_b32 v231, 4294901760, v125
v_cvt_pk_f16_f32 v125, v230, v231
v_lshlrev_b32 v228, 16, v126
v_and_b32 v229, 4294901760, v126
v_cvt_pk_f16_f32 v126, v228, v229
v_lshlrev_b32 v230, 16, v127
v_and_b32 v231, 4294901760, v127
v_cvt_pk_f16_f32 v127, v230, v231
v_lshlrev_b32 v228, 16, v128
v_and_b32 v229, 4294901760, v128
v_cvt_pk_f16_f32 v128, v228, v229
v_lshlrev_b32 v230, 16, v129
v_and_b32 v231, 4294901760, v129
v_cvt_pk_f16_f32 v129, v230, v231
v_lshlrev_b32 v228, 16, v130
v_and_b32 v229, 4294901760, v130
v_cvt_pk_f16_f32 v130, v228, v229
v_lshlrev_b32 v230, 16, v131
v_and_b32 v231, 4294901760, v131
v_cvt_pk_f16_f32 v131, v230, v231
s_cmp_eq_u32 s77, 0
s_cbranch_scc1 Lpp911
s_getreg_b32 s43, hwreg(HW_REG_IB_STS, 0, 4)
s_cmp_lg_u32 s43, 0
s_cbranch_scc1 Lpp911
s_call_b64 s[78:79], Lpoll
s_setprio 2
Lpp911:
v_lshlrev_b32 v228, 16, v132
v_and_b32 v229, 4294901760, v132
v_cvt_pk_f16_f32 v132, v228, v229
v_lshlrev_b32 v230, 16, v133
v_and_b32 v231, 4294901760, v133
v_cvt_pk_f16_f32 v133, v230, v231
v_lshlrev_b32 v228, 16, v134
v_and_b32 v229, 4294901760, v134
v_cvt_pk_f16_f32 v134, v228, v229
v_lshlrev_b32 v230, 16, v135
v_and_b32 v231, 4294901760, v135
v_cvt_pk_f16_f32 v135, v230, v231
v_lshlrev_b32 v228, 16, v136
v_and_b32 v229, 4294901760, v136
v_cvt_pk_f16_f32 v136, v228, v229
v_lshlrev_b32 v230, 16, v137
v_and_b32 v231, 4294901760, v137
v_cvt_pk_f16_f32 v137, v230, v231
v_lshlrev_b32 v228, 16, v138
v_and_b32 v229, 4294901760, v138
v_cvt_pk_f16_f32 v138, v228, v229
v_lshlrev_b32 v230, 16, v139
v_and_b32 v231, 4294901760, v139
v_cvt_pk_f16_f32 v139, v230, v231
v_lshlrev_b32 v228, 16, v140
v_and_b32 v229, 4294901760, v140
v_cvt_pk_f16_f32 v140, v228, v229
v_lshlrev_b32 v230, 16, v141
v_and_b32 v231, 4294901760, v141
v_cvt_pk_f16_f32 v141, v230, v231
v_lshlrev_b32 v228, 16, v142
v_and_b32 v229, 4294901760, v142
v_cvt_pk_f16_f32 v142, v228, v229
v_lshlrev_b32 v230, 16, v143
v_and_b32 v231, 4294901760, v143
v_cvt_pk_f16_f32 v143, v230, v231
s_cmp_eq_u32 s77, 0
s_cbranch_scc1 Lpp923
s_getreg_b32 s43, hwreg(HW_REG_IB_STS, 0, 4)
s_cmp_lg_u32 s43, 0
s_cbranch_scc1 Lpp923
s_call_b64 s[78:79], Lpoll
s_setprio 2
Lpp923:
v_lshlrev_b32 v228, 16, v144
v_and_b32 v229, 4294901760, v144
v_cvt_pk_f16_f32 v144, v228, v229
v_lshlrev_b32 v230, 16, v145
v_and_b32 v231, 4294901760, v145
v_cvt_pk_f16_f32 v145, v230, v231
v_lshlrev_b32 v228, 16, v146
v_and_b32 v229, 4294901760, v146
v_cvt_pk_f16_f32 v146, v228, v229
v_lshlrev_b32 v230, 16, v147
v_and_b32 v231, 4294901760, v147
v_cvt_pk_f16_f32 v147, v230, v231
v_lshlrev_b32 v228, 16, v148
v_and_b32 v229, 4294901760, v148
v_cvt_pk_f16_f32 v148, v228, v229
v_lshlrev_b32 v230, 16, v149
v_and_b32 v231, 4294901760, v149
v_cvt_pk_f16_f32 v149, v230, v231
v_lshlrev_b32 v228, 16, v150
v_and_b32 v229, 4294901760, v150
v_cvt_pk_f16_f32 v150, v228, v229
v_lshlrev_b32 v230, 16, v151
v_and_b32 v231, 4294901760, v151
v_cvt_pk_f16_f32 v151, v230, v231
v_lshlrev_b32 v228, 16, v152
v_and_b32 v229, 4294901760, v152
v_cvt_pk_f16_f32 v152, v228, v229
v_lshlrev_b32 v230, 16, v153
v_and_b32 v231, 4294901760, v153
v_cvt_pk_f16_f32 v153, v230, v231
v_lshlrev_b32 v228, 16, v154
v_and_b32 v229, 4294901760, v154
v_cvt_pk_f16_f32 v154, v228, v229
v_lshlrev_b32 v230, 16, v155
v_and_b32 v231, 4294901760, v155
v_cvt_pk_f16_f32 v155, v230, v231
s_cmp_eq_u32 s77, 0
s_cbranch_scc1 Lpp935
s_getreg_b32 s43, hwreg(HW_REG_IB_STS, 0, 4)
s_cmp_lg_u32 s43, 0
s_cbranch_scc1 Lpp935
s_call_b64 s[78:79], Lpoll
s_setprio 2
Lpp935:
v_lshl_add_u32 v224, v251, 4, s72
v_add_u32 v228, 0, v251
v_mul_u32_u24 v231, 2731, v228
v_lshrrev_b32 v231, 16, v231
v_mul_u32_u24 v231, 9120, v231
v_lshl_add_u32 v228, v228, 2, v231
v_add_u32 v228, 90112, v228
v_add_u32 v229, 64, v251
v_mul_u32_u24 v231, 2731, v229
v_lshrrev_b32 v231, 16, v231
v_mul_u32_u24 v231, 9120, v231
v_lshl_add_u32 v229, v229, 2, v231
v_add_u32 v229, 90112, v229
v_add_u32 v230, 128, v251
v_mul_u32_u24 v231, 2731, v230
v_lshrrev_b32 v231, 16, v231
v_mul_u32_u24 v231, 9120, v231
v_lshl_add_u32 v230, v230, 2, v231
v_add_u32 v230, 90112, v230
Lspin:
s_cmp_eq_u32 s77, 0
s_cbranch_scc1 Lspinx
s_cmp_eq_u32 s76, 0
s_cbranch_scc1 Lspinx
s_sub_u32 s76, s76, 1
s_call_b64 s[78:79], Lpoll
s_branch Lspin
Lspinx:
s_cmp_lg_u32 s40, 0
s_cbranch_scc1 Lnofin
v_mov_b32 v252, 16256
Lrrw:
ds_read_b32 v253, v252 offset:8
s_waitcnt lgkmcnt(0)
v_readfirstlane_b32 s43, v253
s_cmp_eq_u32 s76, 0
s_cbranch_scc1 Lrrx
s_sub_u32 s76, s76, 1
s_cmp_lt_u32 s43, 8
s_cbranch_scc0 Lrrx
s_sleep 2
s_branch Lrrw
Lrrx:
ds_write_b32 v228, v162
ds_write_b32 v229, v163
ds_write_b32 v230, v164
Lnofin:
s_waitcnt lgkmcnt(0)
s_barrier
ds_read_b128 v[156:159], v226
ds_read_b128 v[160:163], v226 offset:32
ds_read_b128 v[164:167], v226 offset:64
v_lshrrev_b32 v225, 4, v251
v_and_b32 v227, 15, v251
v_mul_u32_u24 v252, 192, v227
v_lshl_add_u32 v252, v225, 4, v252
v_lshlrev_b32 v254, 5, v225
v_and_b32 v253, 47, v251
v_lshlrev_b32 v253, 4, v253
v_and_b32 v225, 1, v225
v_mul_u32_u24 v227, 3072, v225
v_add_u32 v248, v227, v253
v_add_u32 v249, 65536, v248
v_add_u32 v250, 131072, v248
v_lshl_add_u32 v253, v225, 21, v253
s_waitcnt lgkmcnt(0)
v_pk_mul_f16 v120, v120, v156
v_pk_mul_f16 v121, v121, v157
v_pk_mul_f16 v122, v122, v158
v_pk_mul_f16 v123, v123, v159
ds_write_b128 v224, v[120:123]
v_pk_mul_f16 v124, v124, v156
v_pk_mul_f16 v125, v125, v157
v_pk_mul_f16 v126, v126, v158
v_pk_mul_f16 v127, v127, v159
ds_write_b128 v224, v[124:127] offset:1024
v_pk_mul_f16 v128, v128, v156
v_pk_mul_f16 v129, v129, v157
v_pk_mul_f16 v130, v130, v158
v_pk_mul_f16 v131, v131, v159
ds_write_b128 v224, v[128:131] offset:2048
v_pk_mul_f16 v132, v132, v160
v_pk_mul_f16 v133, v133, v161
v_pk_mul_f16 v134, v134, v162
v_pk_mul_f16 v135, v135, v163
ds_write_b128 v224, v[132:135] offset:3072
v_pk_mul_f16 v136, v136, v160
v_pk_mul_f16 v137, v137, v161
v_pk_mul_f16 v138, v138, v162
v_pk_mul_f16 v139, v139, v163
ds_write_b128 v224, v[136:139] offset:4096
v_pk_mul_f16 v140, v140, v160
v_pk_mul_f16 v141, v141, v161
v_pk_mul_f16 v142, v142, v162
v_pk_mul_f16 v143, v143, v163
ds_write_b128 v224, v[140:143] offset:5120
v_pk_mul_f16 v144, v144, v164
v_pk_mul_f16 v145, v145, v165
v_pk_mul_f16 v146, v146, v166
v_pk_mul_f16 v147, v147, v167
ds_write_b128 v224, v[144:147] offset:6144
v_pk_mul_f16 v148, v148, v164
v_pk_mul_f16 v149, v149, v165
v_pk_mul_f16 v150, v150, v166
v_pk_mul_f16 v151, v151, v167
ds_write_b128 v224, v[148:151] offset:7168
v_pk_mul_f16 v152, v152, v164
v_pk_mul_f16 v153, v153, v165
v_pk_mul_f16 v154, v154, v166
v_pk_mul_f16 v155, v155, v167
ds_write_b128 v224, v[152:155] offset:8192
ds_read_b128 v[120:123], v254 offset:7936
ds_read_b128 v[124:127], v254 offset:7952
ds_read_b128 v[128:131], v254 offset:7936
ds_read_b128 v[132:135], v254 offset:7952
ds_read_b128 v[136:139], v254 offset:8064
ds_read_b128 v[140:143], v254 offset:8080
ds_read_b128 v[144:147], v254 offset:8064
ds_read_b128 v[148:151], v254 offset:8080
ds_read_b128 v[152:155], v254 offset:16128
ds_read_b128 v[156:159], v254 offset:16144
ds_read_b128 v[160:163], v254 offset:16128
ds_read_b128 v[164:167], v254 offset:16144
s_waitcnt lgkmcnt(12)
s_barrier
s_setprio 3
ds_read_b128 v[224:227], v249 offset:24576
ds_read_b128 v[228:231], v249 offset:24832
s_waitcnt lgkmcnt(1)
v_mfma_f32_16x16x32_f16 v[120:123], v[224:227], v[0:3], v[120:123]
v_mfma_f32_16x16x32_f16 v[128:131], v[224:227], v[4:7], v[128:131]
v_permlane16_swap_b32 v16, v20
s_waitcnt lgkmcnt(0)
v_mfma_f32_16x16x32_f16 v[124:127], v[228:231], v[0:3], v[124:127]
ds_read_b128 v[224:227], v249 offset:25600
v_mfma_f32_16x16x32_f16 v[132:135], v[228:231], v[4:7], v[132:135]
v_permlane16_swap_b32 v17, v21
s_waitcnt lgkmcnt(0)
v_mfma_f32_16x16x32_f16 v[136:139], v[224:227], v[0:3], v[136:139]
ds_read_b128 v[228:231], v249 offset:25856
v_mfma_f32_16x16x32_f16 v[144:147], v[224:227], v[4:7], v[144:147]
v_permlane16_swap_b32 v18, v22
s_waitcnt lgkmcnt(0)
v_mfma_f32_16x16x32_f16 v[140:143], v[228:231], v[0:3], v[140:143]
ds_read_b128 v[224:227], v249 offset:26624
v_mfma_f32_16x16x32_f16 v[148:151], v[228:231], v[4:7], v[148:151]
v_permlane16_swap_b32 v19, v23
s_waitcnt lgkmcnt(0)
v_mfma_f32_16x16x32_f16 v[152:155], v[224:227], v[0:3], v[152:155]
ds_read_b128 v[228:231], v249 offset:26880
v_mfma_f32_16x16x32_f16 v[160:163], v[224:227], v[4:7], v[160:163]
v_permlane16_swap_b32 v24, v28
s_waitcnt lgkmcnt(0)
v_mfma_f32_16x16x32_f16 v[156:159], v[228:231], v[0:3], v[156:159]
ds_read_b128 v[224:227], v249 offset:30720
v_mfma_f32_16x16x32_f16 v[164:167], v[228:231], v[4:7], v[164:167]
v_permlane16_swap_b32 v25, v29
s_waitcnt lgkmcnt(0)
v_mfma_f32_16x16x32_f16 v[120:123], v[224:227], v[8:11], v[120:123]
ds_read_b128 v[228:231], v249 offset:30976
ds_read_b128 v[0:3], v249 offset:31744
ds_read_b128 v[4:7], v249 offset:32000
v_mfma_f32_16x16x32_f16 v[128:131], v[224:227], v[12:15], v[128:131]
v_permlane16_swap_b32 v26, v30
s_waitcnt lgkmcnt(2)
v_mfma_f32_16x16x32_f16 v[124:127], v[228:231], v[8:11], v[124:127]
ds_read_b128 v[224:227], v249 offset:32768
v_mfma_f32_16x16x32_f16 v[132:135], v[228:231], v[12:15], v[132:135]
v_permlane16_swap_b32 v27, v31
s_waitcnt lgkmcnt(2)
v_mfma_f32_16x16x32_f16 v[136:139], v[0:3], v[8:11], v[136:139]
ds_read_b128 v[228:231], v249 offset:33024
v_mfma_f32_16x16x32_f16 v[144:147], v[0:3], v[12:15], v[144:147]
v_permlane16_swap_b32 v96, v100
s_waitcnt lgkmcnt(2)
v_mfma_f32_16x16x32_f16 v[140:143], v[4:7], v[8:11], v[140:143]
ds_read_b128 v[0:3], v249 offset:36864
v_mfma_f32_16x16x32_f16 v[148:151], v[4:7], v[12:15], v[148:151]
v_permlane16_swap_b32 v97, v101
s_waitcnt lgkmcnt(2)
v_mfma_f32_16x16x32_f16 v[152:155], v[224:227], v[8:11], v[152:155]
ds_read_b128 v[4:7], v249 offset:37120
v_mfma_f32_16x16x32_f16 v[160:163], v[224:227], v[12:15], v[160:163]
v_permlane16_swap_b32 v98, v102
s_waitcnt lgkmcnt(2)
v_mfma_f32_16x16x32_f16 v[156:159], v[228:231], v[8:11], v[156:159]
ds_read_b128 v[224:227], v249 offset:37888
v_mfma_f32_16x16x32_f16 v[164:167], v[228:231], v[12:15], v[164:167]
v_permlane16_swap_b32 v99, v103
s_waitcnt lgkmcnt(2)
v_mfma_f32_16x16x32_f16 v[120:123], v[0:3], v[16:19], v[120:123]
buffer_load_dwordx4 v[12:15], v252, s[4:7], s71 offen
ds_read_b128 v[228:231], v249 offset:38144
v_mfma_f32_16x16x32_f16 v[128:131], v[0:3], v[20:23], v[128:131]
v_permlane16_swap_b32 v32, v36
s_waitcnt lgkmcnt(2)
v_mfma_f32_16x16x32_f16 v[124:127], v[4:7], v[16:19], v[124:127]
ds_read_b128 v[0:3], v249 offset:38912
v_mfma_f32_16x16x32_f16 v[132:135], v[4:7], v[20:23], v[132:135]
v_permlane16_swap_b32 v33, v37
s_waitcnt lgkmcnt(2)
v_mfma_f32_16x16x32_f16 v[136:139], v[224:227], v[16:19], v[136:139]
ds_read_b128 v[4:7], v249 offset:39168
v_mfma_f32_16x16x32_f16 v[144:147], v[224:227], v[20:23], v[144:147]
v_permlane16_swap_b32 v34, v38
s_waitcnt lgkmcnt(2)
v_mfma_f32_16x16x32_f16 v[140:143], v[228:231], v[16:19], v[140:143]
ds_read_b128 v[224:227], v249 offset:43008
v_mfma_f32_16x16x32_f16 v[148:151], v[228:231], v[20:23], v[148:151]
v_permlane16_swap_b32 v35, v39
s_waitcnt lgkmcnt(2)
v_mfma_f32_16x16x32_f16 v[152:155], v[0:3], v[16:19], v[152:155]
ds_read_b128 v[228:231], v249 offset:43264
v_mfma_f32_16x16x32_f16 v[160:163], v[0:3], v[20:23], v[160:163]
v_permlane16_swap_b32 v40, v44
s_waitcnt lgkmcnt(2)
v_mfma_f32_16x16x32_f16 v[156:159], v[4:7], v[16:19], v[156:159]
ds_read_b128 v[0:3], v249 offset:44032
v_mfma_f32_16x16x32_f16 v[164:167], v[4:7], v[20:23], v[164:167]
v_permlane16_swap_b32 v41, v45
s_waitcnt lgkmcnt(2)
v_mfma_f32_16x16x32_f16 v[120:123], v[224:227], v[24:27], v[120:123]
buffer_load_dwordx4 v[8:11], v252, s[4:7], s71 offen offset:64
ds_read_b128 v[4:7], v249 offset:44288
v_mfma_f32_16x16x32_f16 v[128:131], v[224:227], v[28:31], v[128:131]
v_permlane16_swap_b32 v42, v46
s_waitcnt lgkmcnt(2)
v_mfma_f32_16x16x32_f16 v[124:127], v[228:231], v[24:27], v[124:127]
ds_read_b128 v[224:227], v249 offset:45056
v_mfma_f32_16x16x32_f16 v[132:135], v[228:231], v[28:31], v[132:135]
v_permlane16_swap_b32 v43, v47
s_waitcnt lgkmcnt(2)
v_mfma_f32_16x16x32_f16 v[136:139], v[0:3], v[24:27], v[136:139]
ds_read_b128 v[228:231], v249 offset:45312
v_mfma_f32_16x16x32_f16 v[144:147], v[0:3], v[28:31], v[144:147]
v_permlane16_swap_b32 v104, v108
s_waitcnt lgkmcnt(2)
v_mfma_f32_16x16x32_f16 v[140:143], v[4:7], v[24:27], v[140:143]
ds_read_b128 v[0:3], v249 offset:49152
v_mfma_f32_16x16x32_f16 v[148:151], v[4:7], v[28:31], v[148:151]
v_permlane16_swap_b32 v105, v109
s_waitcnt lgkmcnt(2)
v_mfma_f32_16x16x32_f16 v[152:155], v[224:227], v[24:27], v[152:155]
ds_read_b128 v[4:7], v249 offset:49408
v_mfma_f32_16x16x32_f16 v[160:163], v[224:227], v[28:31], v[160:163]
v_permlane16_swap_b32 v106, v110
s_waitcnt lgkmcnt(2)
v_mfma_f32_16x16x32_f16 v[156:159], v[228:231], v[24:27], v[156:159]
ds_read_b128 v[224:227], v249 offset:50176
v_mfma_f32_16x16x32_f16 v[164:167], v[228:231], v[28:31], v[164:167]
v_permlane16_swap_b32 v107, v111
s_waitcnt lgkmcnt(2)
v_mfma_f32_16x16x32_f16 v[120:123], v[0:3], v[32:35], v[120:123]
buffer_load_dwordx4 v[16:19], v252, s[4:7], s71 offen offset:128
ds_read_b128 v[228:231], v249 offset:50432
v_mfma_f32_16x16x32_f16 v[128:131], v[0:3], v[36:39], v[128:131]
v_permlane16_swap_b32 v48, v52
s_waitcnt lgkmcnt(2)
v_mfma_f32_16x16x32_f16 v[124:127], v[4:7], v[32:35], v[124:127]
ds_read_b128 v[0:3], v249 offset:51200
v_mfma_f32_16x16x32_f16 v[132:135], v[4:7], v[36:39], v[132:135]
v_permlane16_swap_b32 v49, v53
s_waitcnt lgkmcnt(2)
v_mfma_f32_16x16x32_f16 v[136:139], v[224:227], v[32:35], v[136:139]
ds_read_b128 v[4:7], v249 offset:51456
v_permlane16_swap_b32 v50, v54
v_mfma_f32_16x16x32_f16 v[144:147], v[224:227], v[36:39], v[144:147]
s_waitcnt lgkmcnt(2)
v_mfma_f32_16x16x32_f16 v[140:143], v[228:231], v[32:35], v[140:143]
ds_read_b128 v[224:227], v249 offset:55296
v_permlane16_swap_b32 v51, v55
v_mfma_f32_16x16x32_f16 v[148:151], v[228:231], v[36:39], v[148:151]
v_permlane16_swap_b32 v56, v60
s_waitcnt lgkmcnt(2)
v_mfma_f32_16x16x32_f16 v[152:155], v[0:3], v[32:35], v[152:155]
ds_read_b128 v[228:231], v249 offset:55552
v_mfma_f32_16x16x32_f16 v[160:163], v[0:3], v[36:39], v[160:163]
v_permlane16_swap_b32 v57, v61
s_waitcnt lgkmcnt(2)
v_mfma_f32_16x16x32_f16 v[156:159], v[4:7], v[32:35], v[156:159]
ds_read_b128 v[0:3], v249 offset:56320
v_permlane16_swap_b32 v58, v62
v_mfma_f32_16x16x32_f16 v[164:167], v[4:7], v[36:39], v[164:167]
s_waitcnt lgkmcnt(2)
v_mfma_f32_16x16x32_f16 v[120:123], v[224:227], v[40:43], v[120:123]
s_add_u32 s46, s71, 98304
buffer_load_dwordx4 v[20:23], v252, s[4:7], s46 offen
ds_read_b128 v[4:7], v249 offset:56576
v_permlane16_swap_b32 v59, v63
v_mfma_f32_16x16x32_f16 v[128:131], v[224:227], v[44:47], v[128:131]
v_and_b32 v24, 1, v251
v_lshlrev_b32 v24, 4, v24
s_waitcnt lgkmcnt(2)
v_mfma_f32_16x16x32_f16 v[124:127], v[228:231], v[40:43], v[124:127]
ds_read_b128 v[224:227], v249 offset:57344
v_mov_b32 v25, 16256
v_mfma_f32_16x16x32_f16 v[132:135], v[228:231], v[44:47], v[132:135]
v_lshlrev_b32 v24, v24, v25
s_waitcnt lgkmcnt(2)
v_mfma_f32_16x16x32_f16 v[136:139], v[0:3], v[40:43], v[136:139]
ds_read_b128 v[228:231], v249 offset:57600
v_lshrrev_b32 v25, 2, v251
v_mfma_f32_16x16x32_f16 v[144:147], v[0:3], v[44:47], v[144:147]
v_xor_b32 v25, v25, v251
v_and_b32 v25, 12, v25
s_waitcnt lgkmcnt(2)
v_mfma_f32_16x16x32_f16 v[140:143], v[4:7], v[40:43], v[140:143]
ds_read_b128 v[0:3], v249 offset:61440
v_and_b32 v28, 2, v251
v_mfma_f32_16x16x32_f16 v[148:151], v[4:7], v[44:47], v[148:151]
v_or_b32 v25, v25, v28
s_waitcnt lgkmcnt(2)
v_mfma_f32_16x16x32_f16 v[152:155], v[224:227], v[40:43], v[152:155]
ds_read_b128 v[4:7], v249 offset:61696
v_cmp_eq_u32 vcc, 0, v25
s_nop 1
v_cndmask_b32 v26, 0, v24, vcc
v_cmp_eq_u32 vcc, 2, v25
s_nop 1
v_cndmask_b32 v27, 0, v24, vcc
v_mfma_f32_16x16x32_f16 v[160:163], v[224:227], v[44:47], v[160:163]
v_mov_b32 v24, 0
s_waitcnt lgkmcnt(2)
v_mfma_f32_16x16x32_f16 v[156:159], v[228:231], v[40:43], v[156:159]
ds_read_b128 v[224:227], v249 offset:62464
v_mov_b32 v25, 0
v_mfma_f32_16x16x32_f16 v[164:167], v[228:231], v[44:47], v[164:167]
v_mov_b32 v28, 0
v_mov_b32 v29, 0
s_waitcnt lgkmcnt(2)
v_mfma_f32_16x16x32_f16 v[120:123], v[0:3], v[48:51], v[120:123]
s_add_u32 s46, s80, 8388608
buffer_load_dwordx4 v[32:35], v253, s[32:35], s46 offen nt
ds_read_b128 v[228:231], v249 offset:62720
v_mfma_f32_16x16x32_f16 v[128:131], v[0:3], v[52:55], v[128:131]
s_waitcnt lgkmcnt(2)
v_mfma_f32_16x16x32_f16 v[124:127], v[4:7], v[48:51], v[124:127]
ds_read_b128 v[0:3], v249 offset:63488
v_permlane16_swap_b32 v64, v68
v_mfma_f32_16x16x32_f16 v[132:135], v[4:7], v[52:55], v[132:135]
s_waitcnt lgkmcnt(2)
v_mfma_f32_16x16x32_f16 v[136:139], v[224:227], v[48:51], v[136:139]
ds_read_b128 v[4:7], v249 offset:63744
v_permlane16_swap_b32 v65, v69
v_mfma_f32_16x16x32_f16 v[144:147], v[224:227], v[52:55], v[144:147]
s_waitcnt lgkmcnt(2)
v_mfma_f32_16x16x32_f16 v[140:143], v[228:231], v[48:51], v[140:143]
ds_read_b128 v[224:227], v250 offset:2048
v_permlane16_swap_b32 v66, v70
v_mfma_f32_16x16x32_f16 v[148:151], v[228:231], v[52:55], v[148:151]
s_waitcnt lgkmcnt(2)
v_mfma_f32_16x16x32_f16 v[152:155], v[0:3], v[48:51], v[152:155]
ds_read_b128 v[228:231], v250 offset:2304
v_mfma_f32_16x16x32_f16 v[160:163], v[0:3], v[52:55], v[160:163]
v_permlane16_swap_b32 v67, v71
s_waitcnt lgkmcnt(2)
v_mfma_f32_16x16x32_f16 v[156:159], v[4:7], v[48:51], v[156:159]
ds_read_b128 v[0:3], v250 offset:3072
v_mfma_f32_16x16x32_f16 v[164:167], v[4:7], v[52:55], v[164:167]
v_permlane16_swap_b32 v72, v76
s_waitcnt lgkmcnt(2)
v_mfma_f32_16x16x32_f16 v[120:123], v[224:227], v[56:59], v[120:123]
ds_read_b128 v[4:7], v250 offset:3328
v_mfma_f32_16x16x32_f16 v[128:131], v[224:227], v[60:63], v[128:131]
v_permlane16_swap_b32 v73, v77
s_waitcnt lgkmcnt(2)
v_mfma_f32_16x16x32_f16 v[124:127], v[228:231], v[56:59], v[124:127]
s_add_u32 s46, s80, 8388608
buffer_load_dwordx4 v[36:39], v253, s[32:35], s46 offen offset:256 nt
ds_read_b128 v[224:227], v250 offset:4096
v_mfma_f32_16x16x32_f16 v[132:135], v[228:231], v[60:63], v[132:135]
s_waitcnt lgkmcnt(2)
v_mfma_f32_16x16x32_f16 v[136:139], v[0:3], v[56:59], v[136:139]
ds_read_b128 v[228:231], v250 offset:4352
v_permlane16_swap_b32 v74, v78
v_mfma_f32_16x16x32_f16 v[144:147], v[0:3], v[60:63], v[144:147]
s_waitcnt lgkmcnt(2)
v_mfma_f32_16x16x32_f16 v[140:143], v[4:7], v[56:59], v[140:143]
ds_read_b128 v[0:3], v250 offset:8192
v_permlane16_swap_b32 v75, v79
v_mfma_f32_16x16x32_f16 v[148:151], v[4:7], v[60:63], v[148:151]
s_waitcnt lgkmcnt(2)
v_mfma_f32_16x16x32_f16 v[152:155], v[224:227], v[56:59], v[152:155]
ds_read_b128 v[4:7], v250 offset:8448
v_permlane16_swap_b32 v200, v204
v_mfma_f32_16x16x32_f16 v[160:163], v[224:227], v[60:63], v[160:163]
s_waitcnt lgkmcnt(2)
v_mfma_f32_16x16x32_f16 v[156:159], v[228:231], v[56:59], v[156:159]
ds_read_b128 v[224:227], v250 offset:9216
v_mfma_f32_16x16x32_f16 v[164:167], v[228:231], v[60:63], v[164:167]
v_permlane16_swap_b32 v201, v205
s_waitcnt vmcnt(5)
v_mfma_f32_16x16x32_bf16 v[120:123], v[26:29], v[12:15], v[120:123]
ds_read_b128 v[228:231], v250 offset:9472
v_mfma_f32_16x16x32_bf16 v[124:127], v[24:27], v[12:15], v[124:127]
v_permlane16_swap_b32 v202, v206
s_waitcnt vmcnt(4)
v_mfma_f32_16x16x32_bf16 v[136:139], v[26:29], v[8:11], v[136:139]
v_mfma_f32_16x16x32_bf16 v[140:143], v[24:27], v[8:11], v[140:143]
v_permlane16_swap_b32 v203, v207
s_waitcnt lgkmcnt(3)
v_mfma_f32_16x16x32_f16 v[120:123], v[0:3], v[64:67], v[120:123]
s_add_u32 s46, s71, 98304
buffer_load_dwordx4 v[8:11], v252, s[4:7], s46 offen offset:64
v_mfma_f32_16x16x32_f16 v[128:131], v[0:3], v[68:71], v[128:131]
s_waitcnt lgkmcnt(2)
v_mfma_f32_16x16x32_f16 v[124:127], v[4:7], v[64:67], v[124:127]
ds_read_b128 v[0:3], v250 offset:10240
v_permlane16_swap_b32 v80, v84
v_mfma_f32_16x16x32_f16 v[132:135], v[4:7], v[68:71], v[132:135]
s_waitcnt lgkmcnt(2)
v_mfma_f32_16x16x32_f16 v[136:139], v[224:227], v[64:67], v[136:139]
ds_read_b128 v[4:7], v250 offset:10496
v_permlane16_swap_b32 v81, v85
v_mfma_f32_16x16x32_f16 v[144:147], v[224:227], v[68:71], v[144:147]
s_waitcnt lgkmcnt(2)
v_mfma_f32_16x16x32_f16 v[140:143], v[228:231], v[64:67], v[140:143]
ds_read_b128 v[224:227], v250 offset:14336
v_permlane16_swap_b32 v82, v86
v_mfma_f32_16x16x32_f16 v[148:151], v[228:231], v[68:71], v[148:151]
s_waitcnt lgkmcnt(2)
v_mfma_f32_16x16x32_f16 v[152:155], v[0:3], v[64:67], v[152:155]
ds_read_b128 v[228:231], v250 offset:14592
v_mfma_f32_16x16x32_f16 v[160:163], v[0:3], v[68:71], v[160:163]
v_permlane16_swap_b32 v83, v87
s_waitcnt lgkmcnt(2)
v_mfma_f32_16x16x32_f16 v[156:159], v[4:7], v[64:67], v[156:159]
ds_read_b128 v[0:3], v250 offset:15360
v_mfma_f32_16x16x32_f16 v[164:167], v[4:7], v[68:71], v[164:167]
v_permlane16_swap_b32 v168, v172
s_waitcnt lgkmcnt(2)
v_mfma_f32_16x16x32_f16 v[120:123], v[224:227], v[72:75], v[120:123]
ds_read_b128 v[4:7], v250 offset:15616
v_mfma_f32_16x16x32_f16 v[128:131], v[224:227], v[76:79], v[128:131]
v_permlane16_swap_b32 v169, v173
s_waitcnt lgkmcnt(2)
v_mfma_f32_16x16x32_f16 v[124:127], v[228:231], v[72:75], v[124:127]
s_add_u32 s46, s71, 98304
buffer_load_dwordx4 v[12:15], v252, s[4:7], s46 offen offset:128
ds_read_b128 v[224:227], v250 offset:16384
v_mfma_f32_16x16x32_f16 v[132:135], v[228:231], v[76:79], v[132:135]
s_waitcnt lgkmcnt(2)
v_mfma_f32_16x16x32_f16 v[136:139], v[0:3], v[72:75], v[136:139]
ds_read_b128 v[228:231], v250 offset:16640
v_permlane16_swap_b32 v170, v174
v_mfma_f32_16x16x32_f16 v[144:147], v[0:3], v[76:79], v[144:147]
s_waitcnt lgkmcnt(2)
v_mfma_f32_16x16x32_f16 v[140:143], v[4:7], v[72:75], v[140:143]
ds_read_b128 v[0:3], v250 offset:20480
v_permlane16_swap_b32 v171, v175
v_mfma_f32_16x16x32_f16 v[148:151], v[4:7], v[76:79], v[148:151]
s_waitcnt lgkmcnt(2)
v_mfma_f32_16x16x32_f16 v[152:155], v[224:227], v[72:75], v[152:155]
ds_read_b128 v[4:7], v250 offset:20736
v_permlane16_swap_b32 v192, v196
v_mfma_f32_16x16x32_f16 v[160:163], v[224:227], v[76:79], v[160:163]
s_waitcnt lgkmcnt(2)
v_mfma_f32_16x16x32_f16 v[156:159], v[228:231], v[72:75], v[156:159]
ds_read_b128 v[224:227], v250 offset:21504
v_mfma_f32_16x16x32_f16 v[164:167], v[228:231], v[76:79], v[164:167]
v_permlane16_swap_b32 v193, v197
s_waitcnt vmcnt(5)
v_mfma_f32_16x16x32_bf16 v[152:155], v[26:29], v[16:19], v[152:155]
ds_read_b128 v[228:231], v250 offset:21760
v_mfma_f32_16x16x32_bf16 v[156:159], v[24:27], v[16:19], v[156:159]
v_permlane16_swap_b32 v194, v198
s_waitcnt vmcnt(4)
v_mfma_f32_16x16x32_bf16 v[128:131], v[26:29], v[20:23], v[128:131]
v_mfma_f32_16x16x32_bf16 v[132:135], v[24:27], v[20:23], v[132:135]
v_permlane16_swap_b32 v195, v199
v_and_b32 v255, 1, v251
v_lshlrev_b32 v255, 7, v255
v_sub_u32 v255, v252, v255
s_mov_b32 s74, 1431655765
s_mov_b32 s75, 1431655765
s_waitcnt lgkmcnt(3)
v_mfma_f32_16x16x32_f16 v[120:123], v[0:3], v[80:83], v[120:123]
buffer_load_dwordx4 v[20:23], v252, s[4:7], s70 offen
v_mfma_f32_16x16x32_f16 v[128:131], v[0:3], v[84:87], v[128:131]
v_permlane16_swap_b32 v176, v180
s_waitcnt lgkmcnt(2)
v_mfma_f32_16x16x32_f16 v[124:127], v[4:7], v[80:83], v[124:127]
ds_read_b128 v[0:3], v250 offset:22528
v_mfma_f32_16x16x32_f16 v[132:135], v[4:7], v[84:87], v[132:135]
v_permlane16_swap_b32 v177, v181
s_waitcnt lgkmcnt(2)
v_mfma_f32_16x16x32_f16 v[136:139], v[224:227], v[80:83], v[136:139]
ds_read_b128 v[4:7], v250 offset:22784
v_mfma_f32_16x16x32_f16 v[144:147], v[224:227], v[84:87], v[144:147]
v_permlane16_swap_b32 v178, v182
s_waitcnt lgkmcnt(2)
v_mfma_f32_16x16x32_f16 v[140:143], v[228:231], v[80:83], v[140:143]
ds_read_b128 v[224:227], v250 offset:26624
v_mfma_f32_16x16x32_f16 v[148:151], v[228:231], v[84:87], v[148:151]
v_permlane16_swap_b32 v179, v183
s_waitcnt lgkmcnt(2)
v_mfma_f32_16x16x32_f16 v[152:155], v[0:3], v[80:83], v[152:155]
ds_read_b128 v[228:231], v250 offset:26880
v_mfma_f32_16x16x32_f16 v[160:163], v[0:3], v[84:87], v[160:163]
v_permlane16_swap_b32 v184, v188
s_waitcnt lgkmcnt(2)
v_mfma_f32_16x16x32_f16 v[156:159], v[4:7], v[80:83], v[156:159]
ds_read_b128 v[0:3], v250 offset:27648
v_mfma_f32_16x16x32_f16 v[164:167], v[4:7], v[84:87], v[164:167]
v_permlane16_swap_b32 v185, v189
s_waitcnt lgkmcnt(2)
v_mfma_f32_16x16x32_f16 v[120:123], v[224:227], v[168:171], v[120:123]
buffer_load_dwordx4 v[16:19], v252, s[4:7], s70 offen offset:64
ds_read_b128 v[4:7], v250 offset:27904
v_mfma_f32_16x16x32_f16 v[128:131], v[224:227], v[172:175], v[128:131]
v_permlane16_swap_b32 v186, v190
s_waitcnt lgkmcnt(2)
v_mfma_f32_16x16x32_f16 v[124:127], v[228:231], v[168:171], v[124:127]
ds_read_b128 v[224:227], v250 offset:28672
v_mfma_f32_16x16x32_f16 v[132:135], v[228:231], v[172:175], v[132:135]
v_permlane16_swap_b32 v187, v191
s_waitcnt lgkmcnt(2)
v_mfma_f32_16x16x32_f16 v[136:139], v[0:3], v[168:171], v[136:139]
ds_read_b128 v[228:231], v250 offset:28928
v_mfma_f32_16x16x32_f16 v[144:147], v[0:3], v[172:175], v[144:147]
v_permlane16_swap_b32 v112, v116
s_waitcnt lgkmcnt(2)
v_mfma_f32_16x16x32_f16 v[140:143], v[4:7], v[168:171], v[140:143]
ds_read_b128 v[0:3], v249 offset:55296
v_mfma_f32_16x16x32_f16 v[148:151], v[4:7], v[172:175], v[148:151]
v_permlane16_swap_b32 v113, v117
s_waitcnt lgkmcnt(2)
v_mfma_f32_16x16x32_f16 v[152:155], v[224:227], v[168:171], v[152:155]
ds_read_b128 v[4:7], v254 offset:7936
v_mfma_f32_16x16x32_f16 v[160:163], v[224:227], v[172:175], v[160:163]
v_permlane16_swap_b32 v114, v118
s_waitcnt lgkmcnt(2)
v_mfma_f32_16x16x32_f16 v[156:159], v[228:231], v[168:171], v[156:159]
ds_read_b128 v[224:227], v249 offset:55552
v_mfma_f32_16x16x32_f16 v[164:167], v[228:231], v[172:175], v[164:167]
v_permlane16_swap_b32 v115, v119
s_waitcnt lgkmcnt(1)
v_mfma_f32_16x16x32_f16 v[48:51], v[0:3], v[176:179], v[4:7]
ds_read_b128 v[228:231], v254 offset:7952
v_mfma_f32_16x16x32_f16 v[56:59], v[0:3], v[180:183], v[4:7]
s_waitcnt lgkmcnt(0)
v_mfma_f32_16x16x32_f16 v[52:55], v[224:227], v[176:179], v[228:231]
ds_read_b128 v[0:3], v249 offset:56320
ds_read_b128 v[4:7], v254 offset:8064
v_mfma_f32_16x16x32_f16 v[60:63], v[224:227], v[180:183], v[228:231]
s_waitcnt lgkmcnt(0)
v_mfma_f32_16x16x32_f16 v[64:67], v[0:3], v[176:179], v[4:7]
ds_read_b128 v[224:227], v249 offset:56576
ds_read_b128 v[228:231], v254 offset:8080
v_mfma_f32_16x16x32_f16 v[72:75], v[0:3], v[180:183], v[4:7]
v_permlane16_swap_b32 v88, v92
s_waitcnt lgkmcnt(0)
v_mfma_f32_16x16x32_f16 v[68:71], v[224:227], v[176:179], v[228:231]
ds_read_b128 v[0:3], v249 offset:57344
ds_read_b128 v[4:7], v254 offset:16128
v_mfma_f32_16x16x32_f16 v[76:79], v[224:227], v[180:183], v[228:231]
v_permlane16_swap_b32 v89, v93
s_waitcnt lgkmcnt(0)
v_mfma_f32_16x16x32_f16 v[80:83], v[0:3], v[176:179], v[4:7]
ds_read_b128 v[224:227], v249 offset:57600
ds_read_b128 v[228:231], v254 offset:16144
v_permlane16_swap_b32 v90, v94
v_mfma_f32_16x16x32_f16 v[168:171], v[0:3], v[180:183], v[4:7]
s_waitcnt lgkmcnt(0)
v_mfma_f32_16x16x32_f16 v[84:87], v[224:227], v[176:179], v[228:231]
ds_read_b128 v[0:3], v249 offset:61440
ds_read_b128 v[4:7], v249 offset:61696
v_permlane16_swap_b32 v91, v95
v_mfma_f32_16x16x32_f16 v[172:175], v[224:227], v[180:183], v[228:231]
v_cvt_pk_bf16_f32 v136, v136, v137
v_cvt_pk_bf16_f32 v137, v138, v139
s_waitcnt lgkmcnt(1)
v_mfma_f32_16x16x32_f16 v[48:51], v[0:3], v[184:187], v[48:51]
ds_read_b128 v[224:227], v249 offset:62464
ds_read_b128 v[228:231], v249 offset:62720
v_cvt_pk_bf16_f32 v138, v140, v141
v_mfma_f32_16x16x32_f16 v[56:59], v[0:3], v[188:191], v[56:59]
v_cvt_pk_bf16_f32 v139, v142, v143
v_cvt_pk_bf16_f32 v120, v120, v121
s_waitcnt lgkmcnt(2)
v_mfma_f32_16x16x32_f16 v[52:55], v[4:7], v[184:187], v[52:55]
ds_read_b128 v[0:3], v249 offset:63488
v_cvt_pk_bf16_f32 v121, v122, v123
v_mfma_f32_16x16x32_f16 v[60:63], v[4:7], v[188:191], v[60:63]
v_cvt_pk_bf16_f32 v122, v124, v125
s_waitcnt lgkmcnt(2)
v_mfma_f32_16x16x32_f16 v[64:67], v[224:227], v[184:187], v[64:67]
ds_read_b128 v[4:7], v249 offset:63744
v_cvt_pk_bf16_f32 v123, v126, v127
v_cvt_pk_bf16_f32 v152, v152, v153
v_mfma_f32_16x16x32_f16 v[72:75], v[224:227], v[188:191], v[72:75]
v_cvt_pk_bf16_f32 v153, v154, v155
s_waitcnt lgkmcnt(2)
v_mfma_f32_16x16x32_f16 v[68:71], v[228:231], v[184:187], v[68:71]
ds_read_b128 v[224:227], v250 offset:2048
v_cvt_pk_bf16_f32 v154, v156, v157
v_mfma_f32_16x16x32_f16 v[76:79], v[228:231], v[188:191], v[76:79]
v_cvt_pk_bf16_f32 v155, v158, v159
s_mov_b64 vcc, s[74:75]
v_cndmask_b32_e64 v140, v120, v152, s[74:75]
s_waitcnt lgkmcnt(2)
v_mfma_f32_16x16x32_f16 v[80:83], v[0:3], v[184:187], v[80:83]
ds_read_b128 v[228:231], v250 offset:2304
v_cndmask_b32_dpp v120, v136, v120, vcc quad_perm:[1,0,3,2] row_mask:0xf bank_mask:0xf
v_mfma_f32_16x16x32_f16 v[168:171], v[0:3], v[188:191], v[168:171]
v_cndmask_b32_e64 v141, v121, v153, s[74:75]
s_waitcnt lgkmcnt(2)
v_mfma_f32_16x16x32_f16 v[84:87], v[4:7], v[184:187], v[84:87]
ds_read_b128 v[0:3], v248 offset:16384
v_cndmask_b32_dpp v121, v137, v121, vcc quad_perm:[1,0,3,2] row_mask:0xf bank_mask:0xf
v_cndmask_b32_e64 v142, v122, v154, s[74:75]
v_mfma_f32_16x16x32_f16 v[172:175], v[4:7], v[188:191], v[172:175]
v_cndmask_b32_dpp v122, v138, v122, vcc quad_perm:[1,0,3,2] row_mask:0xf bank_mask:0xf
s_waitcnt vmcnt(3)
v_mfma_f32_16x16x32_bf16 v[144:147], v[26:29], v[8:11], v[144:147]
ds_read_b128 v[4:7], v250 offset:3072
v_cndmask_b32_e64 v143, v123, v155, s[74:75]
v_mfma_f32_16x16x32_bf16 v[148:151], v[24:27], v[8:11], v[148:151]
v_cndmask_b32_dpp v123, v139, v123, vcc quad_perm:[1,0,3,2] row_mask:0xf bank_mask:0xf
s_not_b64 vcc, s[74:75]
v_cndmask_b32_dpp v152, v136, v152, vcc quad_perm:[1,0,3,2] row_mask:0xf bank_mask:0xf
s_waitcnt vmcnt(2)
v_mfma_f32_16x16x32_bf16 v[160:163], v[26:29], v[12:15], v[160:163]
v_cndmask_b32_dpp v153, v137, v153, vcc quad_perm:[1,0,3,2] row_mask:0xf bank_mask:0xf
v_mfma_f32_16x16x32_bf16 v[164:167], v[24:27], v[12:15], v[164:167]
v_cndmask_b32_dpp v154, v138, v154, vcc quad_perm:[1,0,3,2] row_mask:0xf bank_mask:0xf
v_cndmask_b32_dpp v155, v139, v155, vcc quad_perm:[1,0,3,2] row_mask:0xf bank_mask:0xf
s_waitcnt lgkmcnt(2)
v_mfma_f32_16x16x32_f16 v[48:51], v[224:227], v[192:195], v[48:51]
buffer_load_dwordx4 v[8:11], v252, s[4:7], s70 offen offset:128
buffer_store_dwordx4 v[120:123], v255, s[8:11], s71 offen sc1
v_mfma_f32_16x16x32_f16 v[56:59], v[224:227], v[196:199], v[56:59]
v_mfma_f32_16x16x32_f16 v[52:55], v[228:231], v[192:195], v[52:55]
ds_read_b128 v[224:227], v250 offset:3328
v_permlane16_swap_b32 v240, v244
v_mfma_f32_16x16x32_f16 v[60:63], v[228:231], v[196:199], v[60:63]
s_waitcnt lgkmcnt(2)
v_mfma_f32_16x16x32_bf16 v[176:179], v[0:3], v[96:99], 0
ds_read_b128 v[228:231], v250 offset:4096
v_permlane16_swap_b32 v241, v245
v_mfma_f32_16x16x32_bf16 v[184:187], v[0:3], v[100:103], 0
s_waitcnt lgkmcnt(2)
v_mfma_f32_16x16x32_f16 v[64:67], v[4:7], v[192:195], v[64:67]
ds_read_b128 v[0:3], v250 offset:4352
v_mfma_f32_16x16x32_f16 v[72:75], v[4:7], v[196:199], v[72:75]
v_permlane16_swap_b32 v242, v246
s_waitcnt lgkmcnt(2)
v_mfma_f32_16x16x32_f16 v[68:71], v[224:227], v[192:195], v[68:71]
ds_read_b128 v[4:7], v248 offset:16640
v_mfma_f32_16x16x32_f16 v[76:79], v[224:227], v[196:199], v[76:79]
v_permlane16_swap_b32 v243, v247
s_waitcnt lgkmcnt(2)
v_mfma_f32_16x16x32_f16 v[80:83], v[228:231], v[192:195], v[80:83]
s_add_u32 s46, s70, 98304
buffer_load_dwordx4 v[12:15], v252, s[4:7], s46 offen
ds_read_b128 v[224:227], v250 offset:8192
v_mfma_f32_16x16x32_f16 v[168:171], v[228:231], v[196:199], v[168:171]
s_waitcnt lgkmcnt(2)
v_mfma_f32_16x16x32_f16 v[84:87], v[0:3], v[192:195], v[84:87]
ds_read_b128 v[228:231], v250 offset:8448
v_permlane16_swap_b32 v232, v236
v_mfma_f32_16x16x32_f16 v[172:175], v[0:3], v[196:199], v[172:175]
s_waitcnt lgkmcnt(2)
v_mfma_f32_16x16x32_bf16 v[180:183], v[4:7], v[96:99], 0
ds_read_b128 v[0:3], v250 offset:9216
v_permlane16_swap_b32 v233, v237
v_mfma_f32_16x16x32_bf16 v[188:191], v[4:7], v[100:103], 0
s_waitcnt lgkmcnt(2)
v_mfma_f32_16x16x32_f16 v[48:51], v[224:227], v[200:203], v[48:51]
ds_read_b128 v[4:7], v250 offset:9472
v_mfma_f32_16x16x32_f16 v[56:59], v[224:227], v[204:207], v[56:59]
v_permlane16_swap_b32 v234, v238
s_waitcnt lgkmcnt(2)
v_mfma_f32_16x16x32_f16 v[52:55], v[228:231], v[200:203], v[52:55]
ds_read_b128 v[224:227], v248 offset:17408
v_mfma_f32_16x16x32_f16 v[60:63], v[228:231], v[204:207], v[60:63]
v_permlane16_swap_b32 v235, v239
s_waitcnt lgkmcnt(2)
v_mfma_f32_16x16x32_f16 v[64:67], v[0:3], v[200:203], v[64:67]
buffer_store_dwordx4 v[140:143], v255, s[8:11], s71 offen offset:128 sc1
ds_read_b128 v[228:231], v250 offset:10240
v_mfma_f32_16x16x32_f16 v[72:75], v[0:3], v[204:207], v[72:75]
s_waitcnt lgkmcnt(2)
v_mfma_f32_16x16x32_f16 v[68:71], v[4:7], v[200:203], v[68:71]
ds_read_b128 v[0:3], v250 offset:10496
v_permlane16_swap_b32 v216, v220
v_mfma_f32_16x16x32_f16 v[76:79], v[4:7], v[204:207], v[76:79]
s_waitcnt lgkmcnt(2)
v_mfma_f32_16x16x32_bf16 v[176:179], v[224:227], v[104:107], v[176:179]
ds_read_b128 v[4:7], v250 offset:14336
v_permlane16_swap_b32 v217, v221
v_mfma_f32_16x16x32_bf16 v[184:187], v[224:227], v[108:111], v[184:187]
s_waitcnt lgkmcnt(2)
v_mfma_f32_16x16x32_f16 v[80:83], v[228:231], v[200:203], v[80:83]
ds_read_b128 v[224:227], v250 offset:14592
v_mfma_f32_16x16x32_f16 v[168:171], v[228:231], v[204:207], v[168:171]
v_permlane16_swap_b32 v218, v222
s_waitcnt lgkmcnt(2)
v_mfma_f32_16x16x32_f16 v[84:87], v[0:3], v[200:203], v[84:87]
ds_read_b128 v[228:231], v248 offset:17664
v_mfma_f32_16x16x32_f16 v[172:175], v[0:3], v[204:207], v[172:175]
v_permlane16_swap_b32 v219, v223
s_waitcnt lgkmcnt(2)
v_mfma_f32_16x16x32_f16 v[48:51], v[4:7], v[240:243], v[48:51]
buffer_store_dwordx4 v[152:155], v255, s[8:11], s71 offen offset:256 sc1
ds_read_b128 v[0:3], v250 offset:15360
v_mfma_f32_16x16x32_f16 v[56:59], v[4:7], v[244:247], v[56:59]
s_waitcnt lgkmcnt(2)
v_mfma_f32_16x16x32_f16 v[52:55], v[224:227], v[240:243], v[52:55]
ds_read_b128 v[4:7], v250 offset:15616
v_mfma_f32_16x16x32_f16 v[60:63], v[224:227], v[244:247], v[60:63]
s_waitcnt lgkmcnt(2)
v_mfma_f32_16x16x32_bf16 v[180:183], v[228:231], v[104:107], v[180:183]
ds_read_b128 v[224:227], v250 offset:16384
v_mfma_f32_16x16x32_bf16 v[188:191], v[228:231], v[108:111], v[188:191]
s_waitcnt lgkmcnt(2)
v_mfma_f32_16x16x32_f16 v[64:67], v[0:3], v[240:243], v[64:67]
ds_read_b128 v[228:231], v250 offset:16640
v_mfma_f32_16x16x32_f16 v[72:75], v[0:3], v[244:247], v[72:75]
s_waitcnt lgkmcnt(2)
v_mfma_f32_16x16x32_f16 v[68:71], v[4:7], v[240:243], v[68:71]
ds_read_b128 v[0:3], v248 offset:18432
v_mfma_f32_16x16x32_f16 v[76:79], v[4:7], v[244:247], v[76:79]
s_waitcnt lgkmcnt(2)
v_mfma_f32_16x16x32_f16 v[80:83], v[224:227], v[240:243], v[80:83]
ds_read_b128 v[4:7], v250 offset:20480
v_permlane16_swap_b32 v208, v212
v_mfma_f32_16x16x32_f16 v[168:171], v[224:227], v[244:247], v[168:171]
s_waitcnt lgkmcnt(2)
v_mfma_f32_16x16x32_f16 v[84:87], v[228:231], v[240:243], v[84:87]
ds_read_b128 v[224:227], v250 offset:20736
v_mfma_f32_16x16x32_f16 v[172:175], v[228:231], v[244:247], v[172:175]
s_waitcnt lgkmcnt(2)
v_mfma_f32_16x16x32_bf16 v[176:179], v[0:3], v[112:115], v[176:179]
ds_read_b128 v[228:231], v250 offset:21504
v_mfma_f32_16x16x32_bf16 v[184:187], v[0:3], v[116:119], v[184:187]
s_waitcnt lgkmcnt(2)
v_mfma_f32_16x16x32_f16 v[48:51], v[4:7], v[232:235], v[48:51]
ds_read_b128 v[0:3], v250 offset:21760
v_mfma_f32_16x16x32_f16 v[56:59], v[4:7], v[236:239], v[56:59]
s_waitcnt lgkmcnt(2)
v_mfma_f32_16x16x32_f16 v[52:55], v[224:227], v[232:235], v[52:55]
ds_read_b128 v[4:7], v248 offset:18688
v_mfma_f32_16x16x32_f16 v[60:63], v[224:227], v[236:239], v[60:63]
s_waitcnt lgkmcnt(2)
v_mfma_f32_16x16x32_f16 v[64:67], v[228:231], v[232:235], v[64:67]
ds_read_b128 v[224:227], v250 offset:22528
v_mfma_f32_16x16x32_f16 v[72:75], v[228:231], v[236:239], v[72:75]
v_permlane16_swap_b32 v209, v213
s_waitcnt lgkmcnt(2)
v_mfma_f32_16x16x32_f16 v[68:71], v[0:3], v[232:235], v[68:71]
ds_read_b128 v[228:231], v250 offset:22784
v_mfma_f32_16x16x32_f16 v[76:79], v[0:3], v[236:239], v[76:79]
s_waitcnt lgkmcnt(2)
v_mfma_f32_16x16x32_bf16 v[180:183], v[4:7], v[112:115], v[180:183]
ds_read_b128 v[0:3], v250 offset:26624
v_mfma_f32_16x16x32_bf16 v[188:191], v[4:7], v[116:119], v[188:191]
s_waitcnt lgkmcnt(2)
v_mfma_f32_16x16x32_f16 v[80:83], v[224:227], v[232:235], v[80:83]
ds_read_b128 v[4:7], v250 offset:26880
v_mfma_f32_16x16x32_f16 v[168:171], v[224:227], v[236:239], v[168:171]
s_waitcnt lgkmcnt(2)
v_mfma_f32_16x16x32_f16 v[84:87], v[228:231], v[232:235], v[84:87]
ds_read_b128 v[224:227], v250 offset:27648
v_mfma_f32_16x16x32_f16 v[172:175], v[228:231], v[236:239], v[172:175]
s_waitcnt lgkmcnt(2)
v_mfma_f32_16x16x32_f16 v[48:51], v[0:3], v[216:219], v[48:51]
ds_read_b128 v[228:231], v250 offset:27904
v_mfma_f32_16x16x32_f16 v[56:59], v[0:3], v[220:223], v[56:59]
v_permlane16_swap_b32 v210, v214
s_waitcnt lgkmcnt(2)
v_mfma_f32_16x16x32_f16 v[52:55], v[4:7], v[216:219], v[52:55]
ds_read_b128 v[0:3], v250 offset:28672
v_mfma_f32_16x16x32_f16 v[60:63], v[4:7], v[220:223], v[60:63]
s_waitcnt lgkmcnt(2)
v_mfma_f32_16x16x32_f16 v[64:67], v[224:227], v[216:219], v[64:67]
ds_read_b128 v[4:7], v250 offset:28928
v_mfma_f32_16x16x32_f16 v[72:75], v[224:227], v[220:223], v[72:75]
s_waitcnt lgkmcnt(2)
v_mfma_f32_16x16x32_f16 v[68:71], v[228:231], v[216:219], v[68:71]
ds_read_b128 v[224:227], v248 offset:22528
v_mfma_f32_16x16x32_f16 v[76:79], v[228:231], v[220:223], v[76:79]
s_waitcnt lgkmcnt(2)
v_mfma_f32_16x16x32_f16 v[80:83], v[0:3], v[216:219], v[80:83]
ds_read_b128 v[228:231], v248 offset:22784
v_mfma_f32_16x16x32_f16 v[168:171], v[0:3], v[220:223], v[168:171]
s_waitcnt lgkmcnt(2)
v_mfma_f32_16x16x32_f16 v[84:87], v[4:7], v[216:219], v[84:87]
ds_read_b128 v[0:3], v248 offset:23552
v_mfma_f32_16x16x32_f16 v[172:175], v[4:7], v[220:223], v[172:175]
v_permlane16_swap_b32 v211, v215
s_setprio 3
v_cvt_pkrtz_f16_f32 v193, v176, v177
v_cvt_pkrtz_f16_f32 v195, v178, v179
v_cvt_pkrtz_f16_f32 v197, v180, v181
v_cvt_pkrtz_f16_f32 v199, v182, v183
v_cvt_pkrtz_f16_f32 v201, v184, v185
v_cvt_pkrtz_f16_f32 v203, v186, v187
v_cvt_pk_f16_f32 v243, v188, v189
v_cvt_pk_f16_f32 v240, v190, v191
s_waitcnt lgkmcnt(2)
v_mfma_f32_16x16x32_bf16 v[176:179], v[224:227], v[96:99], 0
s_add_u32 s46, s70, 98304
buffer_load_dwordx4 v[216:219], v252, s[4:7], s46 offen offset:64
ds_read_b128 v[4:7], v248 offset:23808
v_mfma_f32_16x16x32_bf16 v[184:187], v[224:227], v[100:103], 0
v_pk_fma_f16 v242, v243, v243, s48
v_cvt_pk_bf16_f32 v144, v144, v145
v_and_b32 v193, s49, v193
v_cvt_pk_bf16_f32 v145, v146, v147
s_waitcnt lgkmcnt(2)
v_mfma_f32_16x16x32_bf16 v[180:183], v[228:231], v[96:99], 0
ds_read_b128 v[224:227], v248 offset:24576
v_and_b32 v195, s49, v195
v_cvt_pk_bf16_f32 v146, v148, v149
v_pk_fma_f16 v207, v240, v240, s48
v_lshrrev_b16 v192, 2, v193
v_cvt_pk_bf16_f32 v147, v150, v151
v_pk_mul_f16 v242, v243, v242
v_mfma_f32_16x16x32_bf16 v[188:191], v[228:231], v[100:103], 0
v_cvt_pk_bf16_f32 v128, v128, v129
v_lshrrev_b16 v194, 2, v195
v_pk_mul_f16 v207, v240, v207
v_cvt_pk_bf16_f32 v129, v130, v131
v_lshrrev_b32 v193, 18, v193
v_cvt_pk_bf16_f32 v130, v132, v133
s_waitcnt lgkmcnt(2)
v_mfma_f32_16x16x32_bf16 v[176:179], v[0:3], v[104:107], v[176:179]
ds_read_b128 v[228:231], v248 offset:24832
ds_read_u16_d16 v192, v192
ds_read_u16_d16 v194, v194
ds_read_u16_d16_hi v193, v193
v_exp_f16 v241, v242
v_cvt_pk_bf16_f32 v131, v134, v135
v_lshrrev_b32 v195, 18, v195
v_cvt_pk_bf16_f32 v160, v160, v161
v_and_b32 v197, s49, v197
v_mfma_f32_16x16x32_bf16 v[184:187], v[0:3], v[108:111], v[184:187]
v_cvt_pk_bf16_f32 v161, v162, v163
v_exp_f16 v206, v207
v_cvt_pk_bf16_f32 v162, v164, v165
v_and_b32 v199, s49, v199
v_cvt_pk_bf16_f32 v163, v166, v167
s_mov_b64 vcc, s[74:75]
s_waitcnt lgkmcnt(4)
v_mfma_f32_16x16x32_bf16 v[180:183], v[4:7], v[104:107], v[180:183]
s_add_u32 s46, s70, 98304
buffer_load_dwordx4 v[244:247], v252, s[4:7], s46 offen offset:128
ds_read_u16_d16_hi v195, v195
v_lshrrev_b16 v196, 2, v197
v_exp_f16_sdwa v241, v242 dst_sel:WORD_1 dst_unused:UNUSED_PRESERVE src0_sel:WORD_1
v_cndmask_b32_e64 v148, v128, v160, s[74:75]
v_cndmask_b32_dpp v128, v144, v128, vcc quad_perm:[1,0,3,2] row_mask:0xf bank_mask:0xf
v_lshrrev_b16 v198, 2, v199
v_mfma_f32_16x16x32_bf16 v[188:191], v[4:7], v[108:111], v[188:191]
v_cndmask_b32_e64 v149, v129, v161, s[74:75]
v_lshrrev_b32 v197, 18, v197
v_lshrrev_b32 v199, 18, v199
v_cndmask_b32_dpp v129, v145, v129, vcc quad_perm:[1,0,3,2] row_mask:0xf bank_mask:0xf
v_exp_f16_sdwa v206, v207 dst_sel:WORD_1 dst_unused:UNUSED_PRESERVE src0_sel:WORD_1
v_mfma_f32_16x16x32_bf16 v[176:179], v[224:227], v[112:115], v[176:179]
ds_read_u16_d16 v196, v196
ds_read_u16_d16 v198, v198
ds_read_u16_d16_hi v197, v197
ds_read_u16_d16_hi v199, v199
v_cndmask_b32_e64 v150, v130, v162, s[74:75]
v_and_b32 v201, s49, v201
v_cndmask_b32_dpp v130, v146, v130, vcc quad_perm:[1,0,3,2] row_mask:0xf bank_mask:0xf
v_and_b32 v203, s49, v203
v_cndmask_b32_e64 v151, v131, v163, s[74:75]
v_pk_add_f16 v241, v241, 1.0 op_sel_hi:[1,0]
v_mfma_f32_16x16x32_bf16 v[184:187], v[224:227], v[116:119], v[184:187]
v_cndmask_b32_dpp v131, v147, v131, vcc quad_perm:[1,0,3,2] row_mask:0xf bank_mask:0xf
s_not_b64 vcc, s[74:75]
v_lshrrev_b16 v200, 2, v201
v_pk_add_f16 v206, v206, 1.0 op_sel_hi:[1,0]
v_cndmask_b32_dpp v160, v144, v160, vcc quad_perm:[1,0,3,2] row_mask:0xf bank_mask:0xf
v_lshrrev_b16 v202, 2, v203
v_cndmask_b32_dpp v161, v145, v161, vcc quad_perm:[1,0,3,2] row_mask:0xf bank_mask:0xf
s_waitcnt lgkmcnt(4)
v_mfma_f32_16x16x32_bf16 v[180:183], v[228:231], v[112:115], v[180:183]
ds_read_b128 v[224:227], v249 offset:24576
ds_read_u16_d16 v200, v200
ds_read_u16_d16 v202, v202
v_rcp_f16 v242, v241
v_cndmask_b32_dpp v162, v146, v162, vcc quad_perm:[1,0,3,2] row_mask:0xf bank_mask:0xf
v_lshrrev_b32 v201, 18, v201
v_cndmask_b32_dpp v163, v147, v163, vcc quad_perm:[1,0,3,2] row_mask:0xf bank_mask:0xf
v_lshrrev_b32 v203, 18, v203
v_mfma_f32_16x16x32_bf16 v[188:191], v[228:231], v[116:119], v[188:191]
v_rcp_f16 v207, v206
v_rcp_f16_sdwa v242, v241 dst_sel:WORD_1 dst_unused:UNUSED_PRESERVE src0_sel:WORD_1
v_or_b32 v232, v192, v193
v_or_b32 v233, v194, v195
s_waitcnt lgkmcnt(3)
v_or_b32 v234, v196, v197
v_rcp_f16_sdwa v207, v206 dst_sel:WORD_1 dst_unused:UNUSED_PRESERVE src0_sel:WORD_1
v_or_b32 v235, v198, v199
ds_read_u16_d16_hi v201, v201
s_add_u32 s46, s71, 98304
buffer_store_dwordx4 v[128:131], v255, s[8:11], s46 offen sc1
ds_read_u16_d16_hi v203, v203
s_waitcnt lgkmcnt(1)
v_or_b32 v236, v200, v201
s_waitcnt lgkmcnt(0)
v_or_b32 v237, v202, v203
v_pk_mul_f16 v238, v243, v242
v_pk_mul_f16 v239, v240, v207
v_mfma_f32_16x16x32_f16 v[48:51], v[224:227], v[232:235], v[48:51]
s_add_u32 s46, s71, 98304
buffer_store_dwordx4 v[148:151], v255, s[8:11], s46 offen offset:128 sc1
ds_read_b128 v[228:231], v249 offset:24832
ds_read_b128 v[0:3], v248 offset:28672
ds_read_b128 v[4:7], v249 offset:25600
ds_read_b128 v[40:43], v248 offset:28928
ds_read_b128 v[44:47], v249 offset:25856
v_cvt_pkrtz_f16_f32 v193, v176, v177
v_cvt_pkrtz_f16_f32 v195, v178, v179
v_mfma_f32_16x16x32_f16 v[56:59], v[224:227], v[236:239], v[56:59]
v_cvt_pkrtz_f16_f32 v197, v180, v181
v_cvt_pkrtz_f16_f32 v199, v182, v183
s_waitcnt lgkmcnt(4)
v_mfma_f32_16x16x32_f16 v[52:55], v[228:231], v[232:235], v[52:55]
ds_read_b128 v[224:227], v248 offset:29696
v_cvt_pkrtz_f16_f32 v201, v184, v185
v_cvt_pk_f16_f32 v243, v186, v187
v_cvt_pk_f16_f32 v240, v188, v189
v_mfma_f32_16x16x32_f16 v[60:63], v[228:231], v[236:239], v[60:63]
v_cvt_pk_f16_f32 v205, v190, v191
v_pk_fma_f16 v242, v243, v243, s48
s_waitcnt lgkmcnt(4)
v_mfma_f32_16x16x32_bf16 v[176:179], v[0:3], v[96:99], 0
ds_read_b128 v[228:231], v249 offset:26624
v_and_b32 v193, s49, v193
v_pk_fma_f16 v207, v240, v240, s48
v_mfma_f32_16x16x32_bf16 v[184:187], v[0:3], v[100:103], 0
v_and_b32 v195, s49, v195
v_pk_fma_f16 v204, v205, v205, s48
s_setprio 2
v_lshrrev_b16 v192, 2, v193
s_waitcnt lgkmcnt(2)
v_mfma_f32_16x16x32_f16 v[64:67], v[4:7], v[232:235], v[64:67]
ds_read_b128 v[0:3], v249 offset:26880
ds_read_u16_d16 v192, v192
v_pk_mul_f16 v242, v243, v242
v_lshrrev_b16 v194, 2, v195
v_mfma_f32_16x16x32_f16 v[72:75], v[4:7], v[236:239], v[72:75]
v_pk_mul_f16 v207, v240, v207
v_lshrrev_b32 v193, 18, v193
v_mfma_f32_16x16x32_bf16 v[180:183], v[40:43], v[96:99], 0
ds_read_b128 v[4:7], v248 offset:29952
ds_read_u16_d16 v194, v194
ds_read_u16_d16_hi v193, v193
v_pk_mul_f16 v204, v205, v204
v_lshrrev_b32 v195, 18, v195
v_mfma_f32_16x16x32_bf16 v[188:191], v[40:43], v[100:103], 0
v_exp_f16 v241, v242
v_and_b32 v197, s49, v197
v_mfma_f32_16x16x32_f16 v[68:71], v[44:47], v[232:235], v[68:71]
ds_read_b128 v[40:43], v248 offset:30720
ds_read_u16_d16_hi v195, v195
v_and_b32 v199, s49, v199
v_mfma_f32_16x16x32_f16 v[76:79], v[44:47], v[236:239], v[76:79]
v_exp_f16 v206, v207
v_lshrrev_b16 v196, 2, v197
v_lshrrev_b16 v198, 2, v199
s_waitcnt lgkmcnt(7)
v_mfma_f32_16x16x32_bf16 v[176:179], v[224:227], v[104:107], v[176:179]
ds_read_b128 v[44:47], v248 offset:30976
ds_read_u16_d16 v196, v196
ds_read_u16_d16 v198, v198
v_exp_f16 v203, v204
v_mfma_f32_16x16x32_bf16 v[184:187], v[224:227], v[108:111], v[184:187]
v_lshrrev_b32 v197, 18, v197
v_lshrrev_b32 v199, 18, v199
v_mfma_f32_16x16x32_f16 v[80:83], v[228:231], v[232:235], v[80:83]
ds_read_b128 v[224:227], v249 offset:30720
ds_read_u16_d16_hi v197, v197
ds_read_u16_d16_hi v199, v199
v_exp_f16_sdwa v241, v242 dst_sel:WORD_1 dst_unused:UNUSED_PRESERVE src0_sel:WORD_1
v_and_b32 v201, s49, v201
v_mfma_f32_16x16x32_f16 v[168:171], v[228:231], v[236:239], v[168:171]
v_lshrrev_b16 v200, 2, v201
s_waitcnt lgkmcnt(8)
v_mfma_f32_16x16x32_f16 v[84:87], v[0:3], v[232:235], v[84:87]
ds_read_b128 v[228:231], v249 offset:30976
ds_read_u16_d16 v200, v200
v_exp_f16_sdwa v206, v207 dst_sel:WORD_1 dst_unused:UNUSED_PRESERVE src0_sel:WORD_1
v_lshrrev_b32 v201, 18, v201
v_mfma_f32_16x16x32_f16 v[172:175], v[0:3], v[236:239], v[172:175]
v_exp_f16_sdwa v203, v204 dst_sel:WORD_1 dst_unused:UNUSED_PRESERVE src0_sel:WORD_1
v_pk_add_f16 v241, v241, 1.0 op_sel_hi:[1,0]
v_mfma_f32_16x16x32_bf16 v[180:183], v[4:7], v[104:107], v[180:183]
ds_read_b128 v[0:3], v248 offset:34816
ds_read_u16_d16_hi v201, v201
v_pk_add_f16 v206, v206, 1.0 op_sel_hi:[1,0]
v_pk_add_f16 v203, v203, 1.0 op_sel_hi:[1,0]
v_mfma_f32_16x16x32_bf16 v[188:191], v[4:7], v[108:111], v[188:191]
v_rcp_f16 v242, v241
s_waitcnt lgkmcnt(7)
v_mfma_f32_16x16x32_bf16 v[176:179], v[40:43], v[112:115], v[176:179]
ds_read_b128 v[4:7], v249 offset:31744
v_rcp_f16 v207, v206
v_mfma_f32_16x16x32_bf16 v[184:187], v[40:43], v[116:119], v[184:187]
v_rcp_f16 v204, v203
v_mfma_f32_16x16x32_bf16 v[180:183], v[44:47], v[112:115], v[180:183]
ds_read_b128 v[40:43], v248 offset:35072
v_rcp_f16_sdwa v242, v241 dst_sel:WORD_1 dst_unused:UNUSED_PRESERVE src0_sel:WORD_1
v_mfma_f32_16x16x32_bf16 v[188:191], v[44:47], v[116:119], v[188:191]
v_rcp_f16_sdwa v207, v206 dst_sel:WORD_1 dst_unused:UNUSED_PRESERVE src0_sel:WORD_1
v_or_b32 v232, v192, v193
v_or_b32 v233, v194, v195
s_waitcnt lgkmcnt(4)
v_or_b32 v234, v196, v197
v_rcp_f16_sdwa v204, v203 dst_sel:WORD_1 dst_unused:UNUSED_PRESERVE src0_sel:WORD_1
v_or_b32 v235, v198, v199
s_waitcnt lgkmcnt(2)
v_or_b32 v236, v200, v201
v_pk_mul_f16 v237, v243, v242
v_pk_mul_f16 v238, v240, v207
v_pk_mul_f16 v239, v205, v204
v_mfma_f32_16x16x32_f16 v[48:51], v[224:227], v[232:235], v[48:51]
s_add_u32 s46, s71, 98304
buffer_store_dwordx4 v[160:163], v255, s[8:11], s46 offen offset:256 sc1
ds_read_b128 v[44:47], v249 offset:32000
v_cvt_pkrtz_f16_f32 v193, v176, v177
v_cvt_pkrtz_f16_f32 v195, v178, v179
v_mfma_f32_16x16x32_f16 v[56:59], v[224:227], v[236:239], v[56:59]
v_cvt_pkrtz_f16_f32 v197, v180, v181
v_cvt_pkrtz_f16_f32 v199, v182, v183
v_mfma_f32_16x16x32_f16 v[52:55], v[228:231], v[232:235], v[52:55]
ds_read_b128 v[224:227], v248 offset:35840
v_cvt_pkrtz_f16_f32 v201, v184, v185
v_cvt_pk_f16_f32 v243, v186, v187
v_mfma_f32_16x16x32_f16 v[60:63], v[228:231], v[236:239], v[60:63]
v_cvt_pk_f16_f32 v240, v188, v189
v_cvt_pk_f16_f32 v205, v190, v191
s_setprio 1
v_mfma_f32_16x16x32_bf16 v[176:179], v[0:3], v[96:99], 0
ds_read_b128 v[228:231], v249 offset:32768
v_pk_fma_f16 v242, v243, v243, s48
v_and_b32 v193, s49, v193
v_mfma_f32_16x16x32_bf16 v[184:187], v[0:3], v[100:103], 0
v_pk_fma_f16 v207, v240, v240, s48
v_and_b32 v195, s49, v195
s_waitcnt lgkmcnt(3)
v_mfma_f32_16x16x32_f16 v[64:67], v[4:7], v[232:235], v[64:67]
ds_read_b128 v[0:3], v249 offset:33024
v_pk_fma_f16 v204, v205, v205, s48
v_lshrrev_b16 v192, 2, v193
v_pk_mul_f16 v242, v243, v242
v_mfma_f32_16x16x32_f16 v[72:75], v[4:7], v[236:239], v[72:75]
v_lshrrev_b16 v194, 2, v195
v_pk_mul_f16 v207, v240, v207
s_waitcnt vmcnt(11)
v_mfma_f32_16x16x32_bf16 v[48:51], v[26:29], v[20:23], v[48:51]
ds_read_b128 v[4:7], v248 offset:36096
ds_read_u16_d16 v192, v192
ds_read_u16_d16 v194, v194
v_lshrrev_b32 v193, 18, v193
v_pk_mul_f16 v204, v205, v204
v_mfma_f32_16x16x32_bf16 v[52:55], v[24:27], v[20:23], v[52:55]
v_lshrrev_b32 v195, 18, v195
v_mfma_f32_16x16x32_bf16 v[180:183], v[40:43], v[96:99], 0
ds_read_u16_d16_hi v193, v193
ds_read_u16_d16_hi v195, v195
v_exp_f16 v241, v242
v_and_b32 v197, s49, v197
v_mfma_f32_16x16x32_bf16 v[188:191], v[40:43], v[100:103], 0
v_and_b32 v199, s49, v199
s_waitcnt lgkmcnt(6)
v_mfma_f32_16x16x32_f16 v[68:71], v[44:47], v[232:235], v[68:71]
ds_read_b128 v[40:43], v248 offset:36864
v_exp_f16 v206, v207
v_lshrrev_b16 v196, 2, v197
v_mfma_f32_16x16x32_f16 v[76:79], v[44:47], v[236:239], v[76:79]
v_lshrrev_b16 v198, 2, v199
v_exp_f16 v203, v204
v_mfma_f32_16x16x32_bf16 v[176:179], v[224:227], v[104:107], v[176:179]
ds_read_b128 v[44:47], v248 offset:37120
ds_read_u16_d16 v196, v196
ds_read_u16_d16 v198, v198
v_lshrrev_b32 v197, 18, v197
v_lshrrev_b32 v199, 18, v199
v_mfma_f32_16x16x32_bf16 v[184:187], v[224:227], v[108:111], v[184:187]
v_exp_f16_sdwa v241, v242 dst_sel:WORD_1 dst_unused:UNUSED_PRESERVE src0_sel:WORD_1
v_mfma_f32_16x16x32_f16 v[80:83], v[228:231], v[232:235], v[80:83]
ds_read_b128 v[224:227], v249 offset:36864
ds_read_u16_d16_hi v197, v197
ds_read_u16_d16_hi v199, v199
v_and_b32 v201, s49, v201
v_lshrrev_b16 v200, 2, v201
v_mfma_f32_16x16x32_f16 v[168:171], v[228:231], v[236:239], v[168:171]
v_exp_f16_sdwa v206, v207 dst_sel:WORD_1 dst_unused:UNUSED_PRESERVE src0_sel:WORD_1
s_waitcnt lgkmcnt(7)
v_mfma_f32_16x16x32_f16 v[84:87], v[0:3], v[232:235], v[84:87]
ds_read_b128 v[228:231], v249 offset:37120
ds_read_u16_d16 v200, v200
v_lshrrev_b32 v201, 18, v201
v_mfma_f32_16x16x32_f16 v[172:175], v[0:3], v[236:239], v[172:175]
v_exp_f16_sdwa v203, v204 dst_sel:WORD_1 dst_unused:UNUSED_PRESERVE src0_sel:WORD_1
v_pk_add_f16 v241, v241, 1.0 op_sel_hi:[1,0]
v_pk_add_f16 v206, v206, 1.0 op_sel_hi:[1,0]
v_mfma_f32_16x16x32_bf16 v[180:183], v[4:7], v[104:107], v[180:183]
ds_read_b128 v[0:3], v248 offset:40960
ds_read_u16_d16_hi v201, v201
v_pk_add_f16 v203, v203, 1.0 op_sel_hi:[1,0]
v_mfma_f32_16x16x32_bf16 v[188:191], v[4:7], v[108:111], v[188:191]
v_rcp_f16 v242, v241
s_setprio 0
s_waitcnt lgkmcnt(7)
v_mfma_f32_16x16x32_bf16 v[176:179], v[40:43], v[112:115], v[176:179]
ds_read_b128 v[4:7], v249 offset:37888
v_rcp_f16 v207, v206
v_mfma_f32_16x16x32_bf16 v[184:187], v[40:43], v[116:119], v[184:187]
v_rcp_f16 v204, v203
v_mfma_f32_16x16x32_bf16 v[180:183], v[44:47], v[112:115], v[180:183]
ds_read_b128 v[40:43], v248 offset:41216
v_rcp_f16_sdwa v242, v241 dst_sel:WORD_1 dst_unused:UNUSED_PRESERVE src0_sel:WORD_1
v_mfma_f32_16x16x32_bf16 v[188:191], v[44:47], v[116:119], v[188:191]
v_rcp_f16_sdwa v207, v206 dst_sel:WORD_1 dst_unused:UNUSED_PRESERVE src0_sel:WORD_1
v_or_b32 v232, v192, v193
v_or_b32 v233, v194, v195
s_waitcnt lgkmcnt(4)
v_or_b32 v234, v196, v197
v_rcp_f16_sdwa v204, v203 dst_sel:WORD_1 dst_unused:UNUSED_PRESERVE src0_sel:WORD_1
v_or_b32 v235, v198, v199
s_waitcnt lgkmcnt(2)
v_or_b32 v236, v200, v201
v_pk_mul_f16 v237, v243, v242
v_pk_mul_f16 v238, v240, v207
v_pk_mul_f16 v239, v205, v204
s_setprio 3
v_mfma_f32_16x16x32_f16 v[48:51], v[224:227], v[232:235], v[48:51]
ds_read_b128 v[44:47], v249 offset:38144
v_cvt_pkrtz_f16_f32 v193, v176, v177
v_cvt_pkrtz_f16_f32 v195, v178, v179
v_mfma_f32_16x16x32_f16 v[56:59], v[224:227], v[236:239], v[56:59]
v_cvt_pkrtz_f16_f32 v197, v180, v181
v_cvt_pkrtz_f16_f32 v199, v182, v183
v_mfma_f32_16x16x32_f16 v[52:55], v[228:231], v[232:235], v[52:55]
ds_read_b128 v[224:227], v248 offset:41984
v_cvt_pkrtz_f16_f32 v201, v184, v185
v_cvt_pk_f16_f32 v243, v186, v187
v_mfma_f32_16x16x32_f16 v[60:63], v[228:231], v[236:239], v[60:63]
v_cvt_pk_f16_f32 v240, v188, v189
v_cvt_pk_f16_f32 v205, v190, v191
v_mfma_f32_16x16x32_bf16 v[176:179], v[0:3], v[96:99], 0
ds_read_b128 v[228:231], v249 offset:38912
v_pk_fma_f16 v242, v243, v243, s48
v_and_b32 v193, s49, v193
v_mfma_f32_16x16x32_bf16 v[184:187], v[0:3], v[100:103], 0
v_pk_fma_f16 v207, v240, v240, s48
v_and_b32 v195, s49, v195
s_waitcnt lgkmcnt(3)
v_mfma_f32_16x16x32_f16 v[64:67], v[4:7], v[232:235], v[64:67]
ds_read_b128 v[0:3], v249 offset:39168
v_pk_fma_f16 v204, v205, v205, s48
v_lshrrev_b16 v192, 2, v193
v_pk_mul_f16 v242, v243, v242
v_mfma_f32_16x16x32_f16 v[72:75], v[4:7], v[236:239], v[72:75]
v_lshrrev_b16 v194, 2, v195
v_pk_mul_f16 v207, v240, v207
s_waitcnt vmcnt(10)
v_mfma_f32_16x16x32_bf16 v[64:67], v[26:29], v[16:19], v[64:67]
ds_read_b128 v[4:7], v248 offset:42240
ds_read_u16_d16 v192, v192
ds_read_u16_d16 v194, v194
v_lshrrev_b32 v193, 18, v193
v_pk_mul_f16 v204, v205, v204
v_mfma_f32_16x16x32_bf16 v[68:71], v[24:27], v[16:19], v[68:71]
v_lshrrev_b32 v195, 18, v195
v_mfma_f32_16x16x32_bf16 v[180:183], v[40:43], v[96:99], 0
ds_read_u16_d16_hi v193, v193
ds_read_u16_d16_hi v195, v195
v_exp_f16 v241, v242
v_and_b32 v197, s49, v197
v_mfma_f32_16x16x32_bf16 v[188:191], v[40:43], v[100:103], 0
v_and_b32 v199, s49, v199
s_waitcnt lgkmcnt(6)
v_mfma_f32_16x16x32_f16 v[68:71], v[44:47], v[232:235], v[68:71]
ds_read_b128 v[40:43], v248 offset:43008
v_exp_f16 v206, v207
v_lshrrev_b16 v196, 2, v197
v_mfma_f32_16x16x32_f16 v[76:79], v[44:47], v[236:239], v[76:79]
v_lshrrev_b16 v198, 2, v199
v_exp_f16 v203, v204
v_mfma_f32_16x16x32_bf16 v[176:179], v[224:227], v[104:107], v[176:179]
ds_read_b128 v[44:47], v248 offset:43264
ds_read_u16_d16 v196, v196
ds_read_u16_d16 v198, v198
v_lshrrev_b32 v197, 18, v197
v_lshrrev_b32 v199, 18, v199
v_mfma_f32_16x16x32_bf16 v[184:187], v[224:227], v[108:111], v[184:187]
v_exp_f16_sdwa v241, v242 dst_sel:WORD_1 dst_unused:UNUSED_PRESERVE src0_sel:WORD_1
v_mfma_f32_16x16x32_f16 v[80:83], v[228:231], v[232:235], v[80:83]
ds_read_b128 v[224:227], v249 offset:43008
ds_read_u16_d16_hi v197, v197
ds_read_u16_d16_hi v199, v199
v_and_b32 v201, s49, v201
v_lshrrev_b16 v200, 2, v201
v_mfma_f32_16x16x32_f16 v[168:171], v[228:231], v[236:239], v[168:171]
v_exp_f16_sdwa v206, v207 dst_sel:WORD_1 dst_unused:UNUSED_PRESERVE src0_sel:WORD_1
s_waitcnt lgkmcnt(7)
v_mfma_f32_16x16x32_f16 v[84:87], v[0:3], v[232:235], v[84:87]
ds_read_b128 v[228:231], v249 offset:43264
ds_read_u16_d16 v200, v200
v_lshrrev_b32 v201, 18, v201
v_mfma_f32_16x16x32_f16 v[172:175], v[0:3], v[236:239], v[172:175]
v_exp_f16_sdwa v203, v204 dst_sel:WORD_1 dst_unused:UNUSED_PRESERVE src0_sel:WORD_1
v_pk_add_f16 v241, v241, 1.0 op_sel_hi:[1,0]
v_pk_add_f16 v206, v206, 1.0 op_sel_hi:[1,0]
v_mfma_f32_16x16x32_bf16 v[180:183], v[4:7], v[104:107], v[180:183]
ds_read_b128 v[0:3], v248 offset:16384
ds_read_u16_d16_hi v201, v201
v_pk_add_f16 v203, v203, 1.0 op_sel_hi:[1,0]
v_mfma_f32_16x16x32_bf16 v[188:191], v[4:7], v[108:111], v[188:191]
v_rcp_f16 v242, v241
s_waitcnt lgkmcnt(7)
v_mfma_f32_16x16x32_bf16 v[176:179], v[40:43], v[112:115], v[176:179]
ds_read_b128 v[4:7], v249 offset:44032
v_rcp_f16 v207, v206
v_mfma_f32_16x16x32_bf16 v[184:187], v[40:43], v[116:119], v[184:187]
v_rcp_f16 v204, v203
v_mfma_f32_16x16x32_bf16 v[180:183], v[44:47], v[112:115], v[180:183]
ds_read_b128 v[40:43], v248 offset:16640
v_rcp_f16_sdwa v242, v241 dst_sel:WORD_1 dst_unused:UNUSED_PRESERVE src0_sel:WORD_1
v_mfma_f32_16x16x32_bf16 v[188:191], v[44:47], v[116:119], v[188:191]
v_rcp_f16_sdwa v207, v206 dst_sel:WORD_1 dst_unused:UNUSED_PRESERVE src0_sel:WORD_1
v_or_b32 v232, v192, v193
v_or_b32 v233, v194, v195
s_waitcnt lgkmcnt(4)
v_or_b32 v234, v196, v197
v_rcp_f16_sdwa v204, v203 dst_sel:WORD_1 dst_unused:UNUSED_PRESERVE src0_sel:WORD_1
v_or_b32 v235, v198, v199
s_waitcnt lgkmcnt(2)
v_or_b32 v236, v200, v201
v_pk_mul_f16 v237, v243, v242
v_pk_mul_f16 v238, v240, v207
v_pk_mul_f16 v239, v205, v204
v_mfma_f32_16x16x32_f16 v[48:51], v[224:227], v[232:235], v[48:51]
s_add_u32 s46, s80, 12582912
buffer_load_dwordx4 v[96:99], v253, s[32:35], s46 offen nt
ds_read_b128 v[44:47], v249 offset:44288
v_cvt_pkrtz_f16_f32 v193, v176, v177
v_cvt_pkrtz_f16_f32 v195, v178, v179
v_mfma_f32_16x16x32_f16 v[56:59], v[224:227], v[236:239], v[56:59]
v_cvt_pkrtz_f16_f32 v197, v180, v181
v_cvt_pkrtz_f16_f32 v199, v182, v183
v_mfma_f32_16x16x32_f16 v[52:55], v[228:231], v[232:235], v[52:55]
ds_read_b128 v[224:227], v248 offset:17408
v_cvt_pkrtz_f16_f32 v201, v184, v185
v_cvt_pk_f16_f32 v243, v186, v187
v_mfma_f32_16x16x32_f16 v[60:63], v[228:231], v[236:239], v[60:63]
v_cvt_pk_f16_f32 v240, v188, v189
v_cvt_pk_f16_f32 v205, v190, v191
v_mfma_f32_16x16x32_bf16 v[176:179], v[0:3], v[88:91], 0
ds_read_b128 v[228:231], v249 offset:45056
v_pk_fma_f16 v242, v243, v243, s48
v_and_b32 v193, s49, v193
v_mfma_f32_16x16x32_bf16 v[184:187], v[0:3], v[92:95], 0
v_pk_fma_f16 v207, v240, v240, s48
v_and_b32 v195, s49, v195
s_waitcnt lgkmcnt(3)
v_mfma_f32_16x16x32_f16 v[64:67], v[4:7], v[232:235], v[64:67]
ds_read_b128 v[0:3], v249 offset:45312
v_pk_fma_f16 v204, v205, v205, s48
s_setprio 2
v_lshrrev_b16 v192, 2, v193
v_pk_mul_f16 v242, v243, v242
v_mfma_f32_16x16x32_f16 v[72:75], v[4:7], v[236:239], v[72:75]
v_lshrrev_b16 v194, 2, v195
v_pk_mul_f16 v207, v240, v207
s_waitcnt vmcnt(10)
v_mfma_f32_16x16x32_bf16 v[80:83], v[26:29], v[8:11], v[80:83]
ds_read_b128 v[4:7], v248 offset:17664
ds_read_u16_d16 v192, v192
ds_read_u16_d16 v194, v194
v_lshrrev_b32 v193, 18, v193
v_pk_mul_f16 v204, v205, v204
v_mfma_f32_16x16x32_bf16 v[84:87], v[24:27], v[8:11], v[84:87]
v_lshrrev_b32 v195, 18, v195
v_mfma_f32_16x16x32_bf16 v[180:183], v[40:43], v[88:91], 0
ds_read_u16_d16_hi v193, v193
ds_read_u16_d16_hi v195, v195
v_exp_f16 v241, v242
v_and_b32 v197, s49, v197
v_mfma_f32_16x16x32_bf16 v[188:191], v[40:43], v[92:95], 0
v_and_b32 v199, s49, v199
s_waitcnt lgkmcnt(6)
v_mfma_f32_16x16x32_f16 v[68:71], v[44:47], v[232:235], v[68:71]
ds_read_b128 v[40:43], v248 offset:18432
v_exp_f16 v206, v207
v_lshrrev_b16 v196, 2, v197
v_mfma_f32_16x16x32_f16 v[76:79], v[44:47], v[236:239], v[76:79]
v_lshrrev_b16 v198, 2, v199
v_exp_f16 v203, v204
v_mfma_f32_16x16x32_bf16 v[176:179], v[224:227], v[208:211], v[176:179]
ds_read_b128 v[44:47], v248 offset:18688
ds_read_u16_d16 v196, v196
ds_read_u16_d16 v198, v198
v_lshrrev_b32 v197, 18, v197
v_lshrrev_b32 v199, 18, v199
v_mfma_f32_16x16x32_bf16 v[184:187], v[224:227], v[212:215], v[184:187]
v_exp_f16_sdwa v241, v242 dst_sel:WORD_1 dst_unused:UNUSED_PRESERVE src0_sel:WORD_1
v_mfma_f32_16x16x32_f16 v[80:83], v[228:231], v[232:235], v[80:83]
ds_read_b128 v[224:227], v249 offset:49152
ds_read_u16_d16_hi v197, v197
ds_read_u16_d16_hi v199, v199
v_and_b32 v201, s49, v201
v_lshrrev_b16 v200, 2, v201
v_mfma_f32_16x16x32_f16 v[168:171], v[228:231], v[236:239], v[168:171]
v_exp_f16_sdwa v206, v207 dst_sel:WORD_1 dst_unused:UNUSED_PRESERVE src0_sel:WORD_1
s_waitcnt lgkmcnt(7)
v_mfma_f32_16x16x32_f16 v[84:87], v[0:3], v[232:235], v[84:87]
ds_read_b128 v[228:231], v249 offset:49408
ds_read_u16_d16 v200, v200
v_lshrrev_b32 v201, 18, v201
v_mfma_f32_16x16x32_f16 v[172:175], v[0:3], v[236:239], v[172:175]
v_exp_f16_sdwa v203, v204 dst_sel:WORD_1 dst_unused:UNUSED_PRESERVE src0_sel:WORD_1
v_pk_add_f16 v241, v241, 1.0 op_sel_hi:[1,0]
v_pk_add_f16 v206, v206, 1.0 op_sel_hi:[1,0]
v_mfma_f32_16x16x32_bf16 v[180:183], v[4:7], v[208:211], v[180:183]
ds_read_b128 v[0:3], v248 offset:22528
ds_read_u16_d16_hi v201, v201
v_pk_add_f16 v203, v203, 1.0 op_sel_hi:[1,0]
v_mfma_f32_16x16x32_bf16 v[188:191], v[4:7], v[212:215], v[188:191]
v_rcp_f16 v242, v241
s_waitcnt lgkmcnt(7)
v_mfma_f32_16x16x32_bf16 v[176:179], v[40:43], v[32:35], v[176:179]
ds_read_b128 v[4:7], v249 offset:50176
v_rcp_f16 v207, v206
v_mfma_f32_16x16x32_bf16 v[184:187], v[40:43], v[36:39], v[184:187]
v_rcp_f16 v204, v203
v_mfma_f32_16x16x32_bf16 v[180:183], v[44:47], v[32:35], v[180:183]
ds_read_b128 v[40:43], v248 offset:22784
v_rcp_f16_sdwa v242, v241 dst_sel:WORD_1 dst_unused:UNUSED_PRESERVE src0_sel:WORD_1
v_mfma_f32_16x16x32_bf16 v[188:191], v[44:47], v[36:39], v[188:191]
v_rcp_f16_sdwa v207, v206 dst_sel:WORD_1 dst_unused:UNUSED_PRESERVE src0_sel:WORD_1
v_or_b32 v232, v192, v193
v_or_b32 v233, v194, v195
s_waitcnt lgkmcnt(4)
v_or_b32 v234, v196, v197
v_rcp_f16_sdwa v204, v203 dst_sel:WORD_1 dst_unused:UNUSED_PRESERVE src0_sel:WORD_1
v_or_b32 v235, v198, v199
s_waitcnt lgkmcnt(2)
v_or_b32 v236, v200, v201
v_pk_mul_f16 v237, v243, v242
v_pk_mul_f16 v238, v240, v207
v_pk_mul_f16 v239, v205, v204
v_mfma_f32_16x16x32_f16 v[48:51], v[224:227], v[232:235], v[48:51]
s_add_u32 s46, s80, 12582912
buffer_load_dwordx4 v[100:103], v253, s[32:35], s46 offen offset:256 nt
ds_read_b128 v[44:47], v249 offset:50432
v_cvt_pkrtz_f16_f32 v193, v176, v177
v_cvt_pkrtz_f16_f32 v195, v178, v179
v_mfma_f32_16x16x32_f16 v[56:59], v[224:227], v[236:239], v[56:59]
v_cvt_pkrtz_f16_f32 v197, v180, v181
v_cvt_pkrtz_f16_f32 v199, v182, v183
v_mfma_f32_16x16x32_f16 v[52:55], v[228:231], v[232:235], v[52:55]
ds_read_b128 v[224:227], v248 offset:23552
v_cvt_pkrtz_f16_f32 v201, v184, v185
v_cvt_pk_f16_f32 v243, v186, v187
v_mfma_f32_16x16x32_f16 v[60:63], v[228:231], v[236:239], v[60:63]
v_cvt_pk_f16_f32 v240, v188, v189
v_cvt_pk_f16_f32 v205, v190, v191
s_setprio 1
v_mfma_f32_16x16x32_bf16 v[176:179], v[0:3], v[88:91], 0
ds_read_b128 v[228:231], v249 offset:51200
v_pk_fma_f16 v242, v243, v243, s48
v_and_b32 v193, s49, v193
v_mfma_f32_16x16x32_bf16 v[184:187], v[0:3], v[92:95], 0
v_pk_fma_f16 v207, v240, v240, s48
v_and_b32 v195, s49, v195
s_waitcnt lgkmcnt(3)
v_mfma_f32_16x16x32_f16 v[64:67], v[4:7], v[232:235], v[64:67]
ds_read_b128 v[0:3], v249 offset:51456
v_pk_fma_f16 v204, v205, v205, s48
v_lshrrev_b16 v192, 2, v193
v_pk_mul_f16 v242, v243, v242
v_mfma_f32_16x16x32_f16 v[72:75], v[4:7], v[236:239], v[72:75]
v_lshrrev_b16 v194, 2, v195
v_pk_mul_f16 v207, v240, v207
s_waitcnt vmcnt(9)
v_mfma_f32_16x16x32_bf16 v[56:59], v[26:29], v[12:15], v[56:59]
ds_read_b128 v[4:7], v248 offset:23808
ds_read_u16_d16 v192, v192
ds_read_u16_d16 v194, v194
v_lshrrev_b32 v193, 18, v193
v_pk_mul_f16 v204, v205, v204
v_mfma_f32_16x16x32_bf16 v[60:63], v[24:27], v[12:15], v[60:63]
v_lshrrev_b32 v195, 18, v195
v_mfma_f32_16x16x32_bf16 v[180:183], v[40:43], v[88:91], 0
ds_read_u16_d16_hi v193, v193
ds_read_u16_d16_hi v195, v195
v_exp_f16 v241, v242
v_and_b32 v197, s49, v197
v_mfma_f32_16x16x32_bf16 v[188:191], v[40:43], v[92:95], 0
v_and_b32 v199, s49, v199
s_waitcnt lgkmcnt(6)
v_mfma_f32_16x16x32_f16 v[68:71], v[44:47], v[232:235], v[68:71]
ds_read_b128 v[40:43], v248 offset:24576
v_exp_f16 v206, v207
v_lshrrev_b16 v196, 2, v197
v_mfma_f32_16x16x32_f16 v[76:79], v[44:47], v[236:239], v[76:79]
v_lshrrev_b16 v198, 2, v199
v_exp_f16 v203, v204
v_mfma_f32_16x16x32_bf16 v[176:179], v[224:227], v[208:211], v[176:179]
ds_read_b128 v[44:47], v248 offset:24832
ds_read_u16_d16 v196, v196
ds_read_u16_d16 v198, v198
v_lshrrev_b32 v197, 18, v197
v_lshrrev_b32 v199, 18, v199
v_mfma_f32_16x16x32_bf16 v[184:187], v[224:227], v[212:215], v[184:187]
v_exp_f16_sdwa v241, v242 dst_sel:WORD_1 dst_unused:UNUSED_PRESERVE src0_sel:WORD_1
v_mfma_f32_16x16x32_f16 v[80:83], v[228:231], v[232:235], v[80:83]
ds_read_b128 v[224:227], v249 offset:24576
ds_read_u16_d16_hi v197, v197
ds_read_u16_d16_hi v199, v199
v_and_b32 v201, s49, v201
v_lshrrev_b16 v200, 2, v201
v_mfma_f32_16x16x32_f16 v[168:171], v[228:231], v[236:239], v[168:171]
v_exp_f16_sdwa v206, v207 dst_sel:WORD_1 dst_unused:UNUSED_PRESERVE src0_sel:WORD_1
s_waitcnt lgkmcnt(7)
v_mfma_f32_16x16x32_f16 v[84:87], v[0:3], v[232:235], v[84:87]
ds_read_b128 v[228:231], v254 offset:7936
ds_read_u16_d16 v200, v200
v_lshrrev_b32 v201, 18, v201
v_mfma_f32_16x16x32_f16 v[172:175], v[0:3], v[236:239], v[172:175]
v_exp_f16_sdwa v203, v204 dst_sel:WORD_1 dst_unused:UNUSED_PRESERVE src0_sel:WORD_1
v_pk_add_f16 v241, v241, 1.0 op_sel_hi:[1,0]
v_pk_add_f16 v206, v206, 1.0 op_sel_hi:[1,0]
v_mfma_f32_16x16x32_bf16 v[180:183], v[4:7], v[208:211], v[180:183]
ds_read_b128 v[0:3], v249 offset:24832
ds_read_u16_d16_hi v201, v201
v_pk_add_f16 v203, v203, 1.0 op_sel_hi:[1,0]
v_mfma_f32_16x16x32_bf16 v[188:191], v[4:7], v[212:215], v[188:191]
v_rcp_f16 v242, v241
s_setprio 0
s_waitcnt lgkmcnt(7)
v_mfma_f32_16x16x32_bf16 v[176:179], v[40:43], v[32:35], v[176:179]
ds_read_b128 v[4:7], v254 offset:7952
v_rcp_f16 v207, v206
v_mfma_f32_16x16x32_bf16 v[184:187], v[40:43], v[36:39], v[184:187]
v_rcp_f16 v204, v203
v_mfma_f32_16x16x32_bf16 v[180:183], v[44:47], v[32:35], v[180:183]
ds_read_b128 v[40:43], v248 offset:28672
v_rcp_f16_sdwa v242, v241 dst_sel:WORD_1 dst_unused:UNUSED_PRESERVE src0_sel:WORD_1
v_mfma_f32_16x16x32_bf16 v[188:191], v[44:47], v[36:39], v[188:191]
v_rcp_f16_sdwa v207, v206 dst_sel:WORD_1 dst_unused:UNUSED_PRESERVE src0_sel:WORD_1
v_or_b32 v232, v192, v193
v_or_b32 v233, v194, v195
s_waitcnt lgkmcnt(4)
v_or_b32 v234, v196, v197
v_rcp_f16_sdwa v204, v203 dst_sel:WORD_1 dst_unused:UNUSED_PRESERVE src0_sel:WORD_1
v_or_b32 v235, v198, v199
s_waitcnt lgkmcnt(2)
v_or_b32 v236, v200, v201
v_pk_mul_f16 v237, v243, v242
v_pk_mul_f16 v238, v240, v207
v_pk_mul_f16 v239, v205, v204
s_setprio 3
v_mfma_f32_16x16x32_f16 v[120:123], v[224:227], v[232:235], v[228:231]
s_add_u32 s46, s80, 16777216
buffer_load_dwordx4 v[104:107], v253, s[32:35], s46 offen nt
ds_read_b128 v[44:47], v249 offset:25600
v_cvt_pkrtz_f16_f32 v193, v176, v177
v_cvt_pkrtz_f16_f32 v195, v178, v179
v_mfma_f32_16x16x32_f16 v[128:131], v[224:227], v[236:239], v[228:231]
v_cvt_pkrtz_f16_f32 v197, v180, v181
v_cvt_pkrtz_f16_f32 v199, v182, v183
s_waitcnt lgkmcnt(1)
v_mfma_f32_16x16x32_f16 v[124:127], v[0:3], v[232:235], v[4:7]
ds_read_b128 v[224:227], v254 offset:8064
ds_read_b128 v[228:231], v248 offset:28928
v_cvt_pkrtz_f16_f32 v201, v184, v185
v_cvt_pk_f16_f32 v243, v186, v187
v_mfma_f32_16x16x32_f16 v[132:135], v[0:3], v[236:239], v[4:7]
v_cvt_pk_f16_f32 v240, v188, v189
v_cvt_pk_f16_f32 v205, v190, v191
v_mfma_f32_16x16x32_bf16 v[176:179], v[40:43], v[88:91], 0
ds_read_b128 v[0:3], v249 offset:25856
ds_read_b128 v[4:7], v254 offset:8080
v_pk_fma_f16 v242, v243, v243, s48
v_and_b32 v193, s49, v193
v_mfma_f32_16x16x32_bf16 v[184:187], v[40:43], v[92:95], 0
v_pk_fma_f16 v207, v240, v240, s48
v_and_b32 v195, s49, v195
s_waitcnt lgkmcnt(3)
v_mfma_f32_16x16x32_f16 v[136:139], v[44:47], v[232:235], v[224:227]
ds_read_b128 v[40:43], v248 offset:29696
v_pk_fma_f16 v204, v205, v205, s48
v_lshrrev_b16 v192, 2, v193
v_pk_mul_f16 v242, v243, v242
v_mfma_f32_16x16x32_f16 v[144:147], v[44:47], v[236:239], v[224:227]
v_lshrrev_b16 v194, 2, v195
v_pk_mul_f16 v207, v240, v207
s_waitcnt vmcnt(7)
v_mfma_f32_16x16x32_bf16 v[72:75], v[26:29], v[216:219], v[72:75]
ds_read_b128 v[44:47], v249 offset:26624
ds_read_b128 v[224:227], v254 offset:16128
ds_read_u16_d16 v192, v192
ds_read_u16_d16 v194, v194
v_lshrrev_b32 v193, 18, v193
v_pk_mul_f16 v204, v205, v204
v_mfma_f32_16x16x32_bf16 v[76:79], v[24:27], v[216:219], v[76:79]
v_lshrrev_b32 v195, 18, v195
s_waitcnt lgkmcnt(5)
v_mfma_f32_16x16x32_bf16 v[180:183], v[228:231], v[88:91], 0
ds_read_u16_d16_hi v193, v193
ds_read_u16_d16_hi v195, v195
v_exp_f16 v241, v242
v_and_b32 v197, s49, v197
v_mfma_f32_16x16x32_bf16 v[188:191], v[228:231], v[92:95], 0
v_and_b32 v199, s49, v199
v_mfma_f32_16x16x32_f16 v[140:143], v[0:3], v[232:235], v[4:7]
ds_read_b128 v[228:231], v249 offset:26880
v_exp_f16 v206, v207
v_lshrrev_b16 v196, 2, v197
v_mfma_f32_16x16x32_f16 v[148:151], v[0:3], v[236:239], v[4:7]
v_lshrrev_b16 v198, 2, v199
v_exp_f16 v203, v204
s_waitcnt lgkmcnt(7)
v_mfma_f32_16x16x32_bf16 v[176:179], v[40:43], v[208:211], v[176:179]
ds_read_b128 v[0:3], v254 offset:16144
ds_read_b128 v[4:7], v248 offset:29952
ds_read_u16_d16 v196, v196
ds_read_u16_d16 v198, v198
v_lshrrev_b32 v197, 18, v197
v_lshrrev_b32 v199, 18, v199
v_mfma_f32_16x16x32_bf16 v[184:187], v[40:43], v[212:215], v[184:187]
v_exp_f16_sdwa v241, v242 dst_sel:WORD_1 dst_unused:UNUSED_PRESERVE src0_sel:WORD_1
s_waitcnt lgkmcnt(7)
v_mfma_f32_16x16x32_f16 v[152:155], v[44:47], v[232:235], v[224:227]
ds_read_b128 v[40:43], v248 offset:30720
ds_read_u16_d16_hi v197, v197
ds_read_u16_d16_hi v199, v199
v_and_b32 v201, s49, v201
v_lshrrev_b16 v200, 2, v201
v_mfma_f32_16x16x32_f16 v[160:163], v[44:47], v[236:239], v[224:227]
v_exp_f16_sdwa v206, v207 dst_sel:WORD_1 dst_unused:UNUSED_PRESERVE src0_sel:WORD_1
s_waitcnt lgkmcnt(6)
v_mfma_f32_16x16x32_f16 v[156:159], v[228:231], v[232:235], v[0:3]
ds_read_b128 v[44:47], v248 offset:30976
ds_read_b128 v[224:227], v249 offset:30720
ds_read_u16_d16 v200, v200
v_lshrrev_b32 v201, 18, v201
v_mfma_f32_16x16x32_f16 v[164:167], v[228:231], v[236:239], v[0:3]
v_exp_f16_sdwa v203, v204 dst_sel:WORD_1 dst_unused:UNUSED_PRESERVE src0_sel:WORD_1
v_pk_add_f16 v241, v241, 1.0 op_sel_hi:[1,0]
v_pk_add_f16 v206, v206, 1.0 op_sel_hi:[1,0]
s_waitcnt lgkmcnt(7)
v_mfma_f32_16x16x32_bf16 v[180:183], v[4:7], v[208:211], v[180:183]
ds_read_b128 v[228:231], v249 offset:30976
ds_read_b128 v[0:3], v248 offset:40960
ds_read_u16_d16_hi v201, v201
v_pk_add_f16 v203, v203, 1.0 op_sel_hi:[1,0]
v_mfma_f32_16x16x32_bf16 v[188:191], v[4:7], v[212:215], v[188:191]
v_rcp_f16 v242, v241
s_waitcnt lgkmcnt(8)
v_mfma_f32_16x16x32_bf16 v[176:179], v[40:43], v[32:35], v[176:179]
ds_read_b128 v[4:7], v249 offset:31744
v_rcp_f16 v207, v206
v_mfma_f32_16x16x32_bf16 v[184:187], v[40:43], v[36:39], v[184:187]
v_rcp_f16 v204, v203
s_waitcnt lgkmcnt(6)
v_mfma_f32_16x16x32_bf16 v[180:183], v[44:47], v[32:35], v[180:183]
ds_read_b128 v[40:43], v248 offset:41216
v_rcp_f16_sdwa v242, v241 dst_sel:WORD_1 dst_unused:UNUSED_PRESERVE src0_sel:WORD_1
v_mfma_f32_16x16x32_bf16 v[188:191], v[44:47], v[36:39], v[188:191]
v_rcp_f16_sdwa v207, v206 dst_sel:WORD_1 dst_unused:UNUSED_PRESERVE src0_sel:WORD_1
v_or_b32 v232, v192, v193
v_or_b32 v233, v194, v195
v_or_b32 v234, v196, v197
v_rcp_f16_sdwa v204, v203 dst_sel:WORD_1 dst_unused:UNUSED_PRESERVE src0_sel:WORD_1
v_or_b32 v235, v198, v199
s_waitcnt lgkmcnt(2)
v_or_b32 v236, v200, v201
v_pk_mul_f16 v237, v243, v242
v_pk_mul_f16 v238, v240, v207
v_pk_mul_f16 v239, v205, v204
v_mfma_f32_16x16x32_f16 v[120:123], v[224:227], v[232:235], v[120:123]
s_add_u32 s46, s80, 16777216
buffer_load_dwordx4 v[108:111], v253, s[32:35], s46 offen offset:256 nt
ds_read_b128 v[44:47], v249 offset:32000
v_cvt_pkrtz_f16_f32 v193, v176, v177
v_cvt_pkrtz_f16_f32 v195, v178, v179
v_mfma_f32_16x16x32_f16 v[128:131], v[224:227], v[236:239], v[128:131]
v_cvt_pkrtz_f16_f32 v197, v180, v181
v_cvt_pkrtz_f16_f32 v199, v182, v183
v_mfma_f32_16x16x32_f16 v[124:127], v[228:231], v[232:235], v[124:127]
ds_read_b128 v[224:227], v248 offset:41984
v_cvt_pkrtz_f16_f32 v201, v184, v185
v_cvt_pk_f16_f32 v243, v186, v187
v_mfma_f32_16x16x32_f16 v[132:135], v[228:231], v[236:239], v[132:135]
v_cvt_pk_f16_f32 v240, v188, v189
v_cvt_pk_f16_f32 v205, v190, v191
v_mfma_f32_16x16x32_bf16 v[176:179], v[0:3], v[88:91], 0
ds_read_b128 v[228:231], v249 offset:32768
v_pk_fma_f16 v242, v243, v243, s48
v_and_b32 v193, s49, v193
v_mfma_f32_16x16x32_bf16 v[184:187], v[0:3], v[92:95], 0
v_pk_fma_f16 v207, v240, v240, s48
v_and_b32 v195, s49, v195
s_waitcnt lgkmcnt(3)
v_mfma_f32_16x16x32_f16 v[136:139], v[4:7], v[232:235], v[136:139]
ds_read_b128 v[0:3], v249 offset:33024
v_pk_fma_f16 v204, v205, v205, s48
s_setprio 2
v_lshrrev_b16 v192, 2, v193
v_pk_mul_f16 v242, v243, v242
v_mfma_f32_16x16x32_f16 v[144:147], v[4:7], v[236:239], v[144:147]
v_lshrrev_b16 v194, 2, v195
v_pk_mul_f16 v207, v240, v207
s_waitcnt vmcnt(7)
v_mfma_f32_16x16x32_bf16 v[168:171], v[26:29], v[244:247], v[168:171]
ds_read_b128 v[4:7], v248 offset:42240
ds_read_u16_d16 v192, v192
ds_read_u16_d16 v194, v194
v_lshrrev_b32 v193, 18, v193
v_pk_mul_f16 v204, v205, v204
v_mfma_f32_16x16x32_bf16 v[172:175], v[24:27], v[244:247], v[172:175]
v_lshrrev_b32 v195, 18, v195
v_mfma_f32_16x16x32_bf16 v[180:183], v[40:43], v[88:91], 0
ds_read_u16_d16_hi v193, v193
ds_read_u16_d16_hi v195, v195
v_exp_f16 v241, v242
v_and_b32 v197, s49, v197
v_mfma_f32_16x16x32_bf16 v[188:191], v[40:43], v[92:95], 0
v_and_b32 v199, s49, v199
s_waitcnt lgkmcnt(6)
v_mfma_f32_16x16x32_f16 v[140:143], v[44:47], v[232:235], v[140:143]
ds_read_b128 v[40:43], v248 offset:43008
v_exp_f16 v206, v207
v_lshrrev_b16 v196, 2, v197
v_mfma_f32_16x16x32_f16 v[148:151], v[44:47], v[236:239], v[148:151]
v_lshrrev_b16 v198, 2, v199
v_exp_f16 v203, v204
v_mfma_f32_16x16x32_bf16 v[176:179], v[224:227], v[208:211], v[176:179]
ds_read_b128 v[44:47], v248 offset:43264
ds_read_u16_d16 v196, v196
ds_read_u16_d16 v198, v198
v_lshrrev_b32 v197, 18, v197
v_lshrrev_b32 v199, 18, v199
v_mfma_f32_16x16x32_bf16 v[184:187], v[224:227], v[212:215], v[184:187]
v_exp_f16_sdwa v241, v242 dst_sel:WORD_1 dst_unused:UNUSED_PRESERVE src0_sel:WORD_1
v_mfma_f32_16x16x32_f16 v[152:155], v[228:231], v[232:235], v[152:155]
ds_read_b128 v[224:227], v249 offset:36864
ds_read_u16_d16_hi v197, v197
ds_read_u16_d16_hi v199, v199
v_and_b32 v201, s49, v201
v_lshrrev_b16 v200, 2, v201
v_mfma_f32_16x16x32_f16 v[160:163], v[228:231], v[236:239], v[160:163]
v_exp_f16_sdwa v206, v207 dst_sel:WORD_1 dst_unused:UNUSED_PRESERVE src0_sel:WORD_1
s_waitcnt lgkmcnt(7)
v_mfma_f32_16x16x32_f16 v[156:159], v[0:3], v[232:235], v[156:159]
ds_read_b128 v[228:231], v249 offset:37120
ds_read_u16_d16 v200, v200
v_lshrrev_b32 v201, 18, v201
v_mfma_f32_16x16x32_f16 v[164:167], v[0:3], v[236:239], v[164:167]
v_exp_f16_sdwa v203, v204 dst_sel:WORD_1 dst_unused:UNUSED_PRESERVE src0_sel:WORD_1
v_pk_add_f16 v241, v241, 1.0 op_sel_hi:[1,0]
v_pk_add_f16 v206, v206, 1.0 op_sel_hi:[1,0]
v_mfma_f32_16x16x32_bf16 v[180:183], v[4:7], v[208:211], v[180:183]
ds_read_b128 v[0:3], v248 offset:34816
ds_read_u16_d16_hi v201, v201
v_pk_add_f16 v203, v203, 1.0 op_sel_hi:[1,0]
v_mfma_f32_16x16x32_bf16 v[188:191], v[4:7], v[212:215], v[188:191]
v_rcp_f16 v242, v241
s_waitcnt lgkmcnt(7)
v_mfma_f32_16x16x32_bf16 v[176:179], v[40:43], v[32:35], v[176:179]
ds_read_b128 v[4:7], v249 offset:37888
v_rcp_f16 v207, v206
v_mfma_f32_16x16x32_bf16 v[184:187], v[40:43], v[36:39], v[184:187]
v_rcp_f16 v204, v203
v_mfma_f32_16x16x32_bf16 v[180:183], v[44:47], v[32:35], v[180:183]
ds_read_b128 v[40:43], v248 offset:35072
v_rcp_f16_sdwa v242, v241 dst_sel:WORD_1 dst_unused:UNUSED_PRESERVE src0_sel:WORD_1
v_mfma_f32_16x16x32_bf16 v[188:191], v[44:47], v[36:39], v[188:191]
v_rcp_f16_sdwa v207, v206 dst_sel:WORD_1 dst_unused:UNUSED_PRESERVE src0_sel:WORD_1
v_or_b32 v232, v192, v193
v_or_b32 v233, v194, v195
s_waitcnt lgkmcnt(4)
v_or_b32 v234, v196, v197
v_rcp_f16_sdwa v204, v203 dst_sel:WORD_1 dst_unused:UNUSED_PRESERVE src0_sel:WORD_1
v_or_b32 v235, v198, v199
s_waitcnt lgkmcnt(2)
v_or_b32 v236, v200, v201
v_pk_mul_f16 v237, v243, v242
v_pk_mul_f16 v238, v240, v207
v_pk_mul_f16 v239, v205, v204
v_mfma_f32_16x16x32_f16 v[120:123], v[224:227], v[232:235], v[120:123]
s_add_u32 s46, s80, 20971520
buffer_load_dwordx4 v[112:115], v253, s[32:35], s46 offen nt
ds_read_b128 v[44:47], v249 offset:38144
v_cvt_pkrtz_f16_f32 v193, v176, v177
v_cvt_pkrtz_f16_f32 v195, v178, v179
v_cvt_pkrtz_f16_f32 v197, v180, v181
v_mfma_f32_16x16x32_f16 v[128:131], v[224:227], v[236:239], v[128:131]
v_cvt_pkrtz_f16_f32 v199, v182, v183
v_cvt_pkrtz_f16_f32 v201, v184, v185
v_cvt_pkrtz_f16_f32 v203, v186, v187
v_mfma_f32_16x16x32_f16 v[124:127], v[228:231], v[232:235], v[124:127]
ds_read_b128 v[224:227], v248 offset:35840
v_cvt_pk_f16_f32 v243, v188, v189
v_cvt_pk_f16_f32 v240, v190, v191
s_setprio 1
v_pk_fma_f16 v242, v243, v243, s48
v_mfma_f32_16x16x32_f16 v[132:135], v[228:231], v[236:239], v[132:135]
v_cvt_pk_bf16_f32 v64, v64, v65
v_and_b32 v193, s49, v193
v_cvt_pk_bf16_f32 v65, v66, v67
v_mfma_f32_16x16x32_bf16 v[176:179], v[0:3], v[88:91], 0
ds_read_b128 v[228:231], v249 offset:38912
v_and_b32 v195, s49, v195
v_cvt_pk_bf16_f32 v66, v68, v69
v_pk_fma_f16 v207, v240, v240, s48
v_mfma_f32_16x16x32_bf16 v[184:187], v[0:3], v[92:95], 0
v_lshrrev_b16 v192, 2, v193
v_cvt_pk_bf16_f32 v67, v70, v71
v_pk_mul_f16 v242, v243, v242
s_waitcnt lgkmcnt(2)
v_mfma_f32_16x16x32_f16 v[136:139], v[4:7], v[232:235], v[136:139]
ds_read_b128 v[0:3], v249 offset:39168
ds_read_u16_d16 v192, v192
v_cvt_pk_bf16_f32 v48, v48, v49
v_lshrrev_b16 v194, 2, v195
v_cvt_pk_bf16_f32 v49, v50, v51
v_mfma_f32_16x16x32_f16 v[144:147], v[4:7], v[236:239], v[144:147]
v_pk_mul_f16 v207, v240, v207
v_lshrrev_b32 v193, 18, v193
v_cvt_pk_bf16_f32 v50, v52, v53
v_mfma_f32_16x16x32_bf16 v[180:183], v[40:43], v[88:91], 0
ds_read_b128 v[4:7], v248 offset:36096
ds_read_u16_d16 v194, v194
ds_read_u16_d16_hi v193, v193
v_exp_f16 v241, v242
v_cvt_pk_bf16_f32 v51, v54, v55
v_mfma_f32_16x16x32_bf16 v[188:191], v[40:43], v[92:95], 0
v_lshrrev_b32 v195, 18, v195
v_cvt_pk_bf16_f32 v80, v80, v81
v_and_b32 v197, s49, v197
v_mfma_f32_16x16x32_f16 v[140:143], v[44:47], v[232:235], v[140:143]
ds_read_b128 v[40:43], v248 offset:36864
ds_read_u16_d16_hi v195, v195
v_cvt_pk_bf16_f32 v81, v82, v83
v_exp_f16 v206, v207
v_mfma_f32_16x16x32_f16 v[148:151], v[44:47], v[236:239], v[148:151]
v_cvt_pk_bf16_f32 v82, v84, v85
v_and_b32 v199, s49, v199
v_cvt_pk_bf16_f32 v83, v86, v87
s_mov_b64 vcc, s[74:75]
s_waitcnt lgkmcnt(5)
v_mfma_f32_16x16x32_bf16 v[176:179], v[224:227], v[208:211], v[176:179]
ds_read_b128 v[44:47], v248 offset:37120
v_lshrrev_b16 v196, 2, v197
v_cndmask_b32_e64 v68, v48, v80, s[74:75]
v_mfma_f32_16x16x32_bf16 v[184:187], v[224:227], v[212:215], v[184:187]
v_exp_f16_sdwa v241, v242 dst_sel:WORD_1 dst_unused:UNUSED_PRESERVE src0_sel:WORD_1
v_cndmask_b32_dpp v48, v64, v48, vcc quad_perm:[1,0,3,2] row_mask:0xf bank_mask:0xf
v_lshrrev_b16 v198, 2, v199
v_mfma_f32_16x16x32_f16 v[152:155], v[228:231], v[232:235], v[152:155]
ds_read_b128 v[224:227], v249 offset:49152
ds_read_u16_d16 v196, v196
ds_read_u16_d16 v198, v198
v_cndmask_b32_e64 v69, v49, v81, s[74:75]
v_lshrrev_b32 v197, 18, v197
v_cndmask_b32_dpp v49, v65, v49, vcc quad_perm:[1,0,3,2] row_mask:0xf bank_mask:0xf
v_mfma_f32_16x16x32_f16 v[160:163], v[228:231], v[236:239], v[160:163]
v_lshrrev_b32 v199, 18, v199
v_exp_f16_sdwa v206, v207 dst_sel:WORD_1 dst_unused:UNUSED_PRESERVE src0_sel:WORD_1
v_mfma_f32_16x16x32_f16 v[156:159], v[0:3], v[232:235], v[156:159]
ds_read_b128 v[228:231], v249 offset:49408
ds_read_u16_d16_hi v197, v197
ds_read_u16_d16_hi v199, v199
v_cndmask_b32_e64 v70, v50, v82, s[74:75]
v_cndmask_b32_dpp v50, v66, v50, vcc quad_perm:[1,0,3,2] row_mask:0xf bank_mask:0xf
v_and_b32 v201, s49, v201
v_mfma_f32_16x16x32_f16 v[164:167], v[0:3], v[236:239], v[164:167]
v_cndmask_b32_e64 v71, v51, v83, s[74:75]
v_and_b32 v203, s49, v203
v_pk_add_f16 v241, v241, 1.0 op_sel_hi:[1,0]
s_waitcnt lgkmcnt(6)
v_mfma_f32_16x16x32_bf16 v[180:183], v[4:7], v[208:211], v[180:183]
ds_read_b128 v[0:3], v248 offset:47104
v_cndmask_b32_dpp v51, v67, v51, vcc quad_perm:[1,0,3,2] row_mask:0xf bank_mask:0xf
s_not_b64 vcc, s[74:75]
v_lshrrev_b16 v200, 2, v201
s_setprio 0
v_cndmask_b32_dpp v80, v64, v80, vcc quad_perm:[1,0,3,2] row_mask:0xf bank_mask:0xf
v_mfma_f32_16x16x32_bf16 v[188:191], v[4:7], v[212:215], v[188:191]
v_pk_add_f16 v206, v206, 1.0 op_sel_hi:[1,0]
v_cndmask_b32_dpp v81, v65, v81, vcc quad_perm:[1,0,3,2] row_mask:0xf bank_mask:0xf
v_lshrrev_b16 v202, 2, v203
v_mfma_f32_16x16x32_bf16 v[176:179], v[40:43], v[32:35], v[176:179]
ds_read_b128 v[4:7], v249 offset:50176
ds_read_u16_d16 v200, v200
ds_read_u16_d16 v202, v202
v_rcp_f16 v242, v241
v_cndmask_b32_dpp v82, v66, v82, vcc quad_perm:[1,0,3,2] row_mask:0xf bank_mask:0xf
v_mfma_f32_16x16x32_bf16 v[184:187], v[40:43], v[36:39], v[184:187]
v_cndmask_b32_dpp v83, v67, v83, vcc quad_perm:[1,0,3,2] row_mask:0xf bank_mask:0xf
v_lshrrev_b32 v201, 18, v201
v_lshrrev_b32 v203, 18, v203
v_mfma_f32_16x16x32_bf16 v[180:183], v[44:47], v[32:35], v[180:183]
ds_read_b128 v[40:43], v248 offset:47360
buffer_store_dwordx4 v[48:51], v255, s[8:11], s70 offen sc1
ds_read_u16_d16_hi v201, v201
ds_read_u16_d16_hi v203, v203
v_rcp_f16 v207, v206
v_mfma_f32_16x16x32_bf16 v[188:191], v[44:47], v[36:39], v[188:191]
v_rcp_f16_sdwa v242, v241 dst_sel:WORD_1 dst_unused:UNUSED_PRESERVE src0_sel:WORD_1
v_or_b32 v232, v192, v193
v_or_b32 v233, v194, v195
s_waitcnt lgkmcnt(6)
v_or_b32 v234, v196, v197
v_rcp_f16_sdwa v207, v206 dst_sel:WORD_1 dst_unused:UNUSED_PRESERVE src0_sel:WORD_1
v_or_b32 v235, v198, v199
s_waitcnt lgkmcnt(1)
v_or_b32 v236, v200, v201
s_waitcnt lgkmcnt(0)
v_or_b32 v237, v202, v203
v_pk_mul_f16 v238, v243, v242
v_pk_mul_f16 v239, v240, v207
s_setprio 3
v_mfma_f32_16x16x32_f16 v[120:123], v[224:227], v[232:235], v[120:123]
buffer_store_dwordx4 v[68:71], v255, s[8:11], s70 offen offset:128 sc1
ds_read_b128 v[44:47], v249 offset:50432
v_cvt_pkrtz_f16_f32 v193, v176, v177
v_cvt_pkrtz_f16_f32 v195, v178, v179
v_mfma_f32_16x16x32_f16 v[128:131], v[224:227], v[236:239], v[128:131]
v_cvt_pkrtz_f16_f32 v197, v180, v181
v_cvt_pkrtz_f16_f32 v199, v182, v183
v_mfma_f32_16x16x32_f16 v[124:127], v[228:231], v[232:235], v[124:127]
ds_read_b128 v[224:227], v248 offset:48128
v_cvt_pkrtz_f16_f32 v201, v184, v185
v_cvt_pk_f16_f32 v243, v186, v187
v_cvt_pk_f16_f32 v240, v188, v189
v_mfma_f32_16x16x32_f16 v[132:135], v[228:231], v[236:239], v[132:135]
v_cvt_pk_f16_f32 v205, v190, v191
v_pk_fma_f16 v242, v243, v243, s48
v_mfma_f32_16x16x32_bf16 v[176:179], v[0:3], v[88:91], 0
ds_read_b128 v[228:231], v249 offset:51200
v_and_b32 v193, s49, v193
v_pk_fma_f16 v207, v240, v240, s48
v_mfma_f32_16x16x32_bf16 v[184:187], v[0:3], v[92:95], 0
v_and_b32 v195, s49, v195
v_pk_fma_f16 v204, v205, v205, s48
v_lshrrev_b16 v192, 2, v193
v_mfma_f32_16x16x32_f16 v[136:139], v[4:7], v[232:235], v[136:139]
ds_read_b128 v[0:3], v249 offset:51456
ds_read_u16_d16 v192, v192
v_pk_mul_f16 v242, v243, v242
v_lshrrev_b16 v194, 2, v195
v_mfma_f32_16x16x32_f16 v[144:147], v[4:7], v[236:239], v[144:147]
v_pk_mul_f16 v207, v240, v207
v_lshrrev_b32 v193, 18, v193
v_mfma_f32_16x16x32_bf16 v[180:183], v[40:43], v[88:91], 0
ds_read_b128 v[4:7], v248 offset:48384
ds_read_u16_d16 v194, v194
ds_read_u16_d16_hi v193, v193
v_pk_mul_f16 v204, v205, v204
v_lshrrev_b32 v195, 18, v195
v_mfma_f32_16x16x32_bf16 v[188:191], v[40:43], v[92:95], 0
v_exp_f16 v241, v242
v_and_b32 v197, s49, v197
s_waitcnt lgkmcnt(6)
v_mfma_f32_16x16x32_f16 v[140:143], v[44:47], v[232:235], v[140:143]
ds_read_b128 v[40:43], v248 offset:49152
ds_read_u16_d16_hi v195, v195
v_and_b32 v199, s49, v199
v_mfma_f32_16x16x32_f16 v[148:151], v[44:47], v[236:239], v[148:151]
v_exp_f16 v206, v207
v_lshrrev_b16 v196, 2, v197
v_lshrrev_b16 v198, 2, v199
v_mfma_f32_16x16x32_bf16 v[176:179], v[224:227], v[208:211], v[176:179]
s_add_u32 s46, s80, 20971520
buffer_load_dwordx4 v[116:119], v253, s[32:35], s46 offen offset:256 nt
ds_read_b128 v[44:47], v248 offset:49408
ds_read_u16_d16 v196, v196
ds_read_u16_d16 v198, v198
v_exp_f16 v203, v204
v_mfma_f32_16x16x32_bf16 v[184:187], v[224:227], v[212:215], v[184:187]
v_lshrrev_b32 v197, 18, v197
v_lshrrev_b32 v199, 18, v199
s_waitcnt lgkmcnt(5)
v_mfma_f32_16x16x32_f16 v[152:155], v[228:231], v[232:235], v[152:155]
ds_read_b128 v[224:227], v249 offset:43008
ds_read_u16_d16_hi v197, v197
ds_read_u16_d16_hi v199, v199
v_exp_f16_sdwa v241, v242 dst_sel:WORD_1 dst_unused:UNUSED_PRESERVE src0_sel:WORD_1
v_and_b32 v201, s49, v201
v_mfma_f32_16x16x32_f16 v[160:163], v[228:231], v[236:239], v[160:163]
v_lshrrev_b16 v200, 2, v201
v_mfma_f32_16x16x32_f16 v[156:159], v[0:3], v[232:235], v[156:159]
ds_read_b128 v[228:231], v249 offset:43264
ds_read_u16_d16 v200, v200
v_exp_f16_sdwa v206, v207 dst_sel:WORD_1 dst_unused:UNUSED_PRESERVE src0_sel:WORD_1
v_lshrrev_b32 v201, 18, v201
v_mfma_f32_16x16x32_f16 v[164:167], v[0:3], v[236:239], v[164:167]
v_exp_f16_sdwa v203, v204 dst_sel:WORD_1 dst_unused:UNUSED_PRESERVE src0_sel:WORD_1
v_pk_add_f16 v241, v241, 1.0 op_sel_hi:[1,0]
v_mfma_f32_16x16x32_bf16 v[180:183], v[4:7], v[208:211], v[180:183]
ds_read_b128 v[0:3], v248 offset:53248
ds_read_u16_d16_hi v201, v201
v_pk_add_f16 v206, v206, 1.0 op_sel_hi:[1,0]
v_pk_add_f16 v203, v203, 1.0 op_sel_hi:[1,0]
v_mfma_f32_16x16x32_bf16 v[188:191], v[4:7], v[212:215], v[188:191]
v_rcp_f16 v242, v241
s_waitcnt lgkmcnt(7)
v_mfma_f32_16x16x32_bf16 v[176:179], v[40:43], v[32:35], v[176:179]
ds_read_b128 v[4:7], v249 offset:44032
v_rcp_f16 v207, v206
v_mfma_f32_16x16x32_bf16 v[184:187], v[40:43], v[36:39], v[184:187]
v_rcp_f16 v204, v203
v_mfma_f32_16x16x32_bf16 v[180:183], v[44:47], v[32:35], v[180:183]
ds_read_b128 v[40:43], v248 offset:53504
v_rcp_f16_sdwa v242, v241 dst_sel:WORD_1 dst_unused:UNUSED_PRESERVE src0_sel:WORD_1
v_mfma_f32_16x16x32_bf16 v[188:191], v[44:47], v[36:39], v[188:191]
v_rcp_f16_sdwa v207, v206 dst_sel:WORD_1 dst_unused:UNUSED_PRESERVE src0_sel:WORD_1
v_or_b32 v232, v192, v193
v_or_b32 v233, v194, v195
s_waitcnt lgkmcnt(4)
v_or_b32 v234, v196, v197
v_rcp_f16_sdwa v204, v203 dst_sel:WORD_1 dst_unused:UNUSED_PRESERVE src0_sel:WORD_1
v_or_b32 v235, v198, v199
s_waitcnt lgkmcnt(2)
v_or_b32 v236, v200, v201
v_pk_mul_f16 v237, v243, v242
v_pk_mul_f16 v238, v240, v207
v_pk_mul_f16 v239, v205, v204
v_mfma_f32_16x16x32_f16 v[120:123], v[224:227], v[232:235], v[120:123]
ds_read_b128 v[44:47], v249 offset:44288
v_cvt_pkrtz_f16_f32 v193, v176, v177
v_cvt_pkrtz_f16_f32 v195, v178, v179
v_mfma_f32_16x16x32_f16 v[128:131], v[224:227], v[236:239], v[128:131]
v_cvt_pkrtz_f16_f32 v197, v180, v181
v_cvt_pkrtz_f16_f32 v199, v182, v183
v_mfma_f32_16x16x32_f16 v[124:127], v[228:231], v[232:235], v[124:127]
ds_read_b128 v[224:227], v248 offset:54272
v_cvt_pkrtz_f16_f32 v201, v184, v185
v_cvt_pk_f16_f32 v243, v186, v187
v_cvt_pk_f16_f32 v240, v188, v189
v_mfma_f32_16x16x32_f16 v[132:135], v[228:231], v[236:239], v[132:135]
v_cvt_pk_f16_f32 v205, v190, v191
v_pk_fma_f16 v242, v243, v243, s48
v_mfma_f32_16x16x32_bf16 v[176:179], v[0:3], v[88:91], 0
ds_read_b128 v[228:231], v249 offset:45056
v_and_b32 v193, s49, v193
v_pk_fma_f16 v207, v240, v240, s48
v_mfma_f32_16x16x32_bf16 v[184:187], v[0:3], v[92:95], 0
v_and_b32 v195, s49, v195
v_pk_fma_f16 v204, v205, v205, s48
s_setprio 2
v_lshrrev_b16 v192, 2, v193
s_waitcnt lgkmcnt(3)
v_mfma_f32_16x16x32_f16 v[136:139], v[4:7], v[232:235], v[136:139]
ds_read_b128 v[0:3], v249 offset:45312
ds_read_u16_d16 v192, v192
v_pk_mul_f16 v242, v243, v242
v_lshrrev_b16 v194, 2, v195
v_mfma_f32_16x16x32_f16 v[144:147], v[4:7], v[236:239], v[144:147]
v_pk_mul_f16 v207, v240, v207
v_lshrrev_b32 v193, 18, v193
v_mfma_f32_16x16x32_bf16 v[180:183], v[40:43], v[88:91], 0
ds_read_b128 v[4:7], v248 offset:54528
ds_read_u16_d16 v194, v194
ds_read_u16_d16_hi v193, v193
v_pk_mul_f16 v204, v205, v204
v_lshrrev_b32 v195, 18, v195
v_mfma_f32_16x16x32_bf16 v[188:191], v[40:43], v[92:95], 0
v_exp_f16 v241, v242
v_and_b32 v197, s49, v197
s_waitcnt lgkmcnt(5)
v_mfma_f32_16x16x32_f16 v[140:143], v[44:47], v[232:235], v[140:143]
ds_read_b128 v[40:43], v248 offset:55296
ds_read_u16_d16_hi v195, v195
v_and_b32 v199, s49, v199
v_mfma_f32_16x16x32_f16 v[148:151], v[44:47], v[236:239], v[148:151]
v_exp_f16 v206, v207
v_lshrrev_b16 v196, 2, v197
v_lshrrev_b16 v198, 2, v199
v_mfma_f32_16x16x32_bf16 v[176:179], v[224:227], v[208:211], v[176:179]
ds_read_b128 v[44:47], v248 offset:55552
ds_read_u16_d16 v196, v196
ds_read_u16_d16 v198, v198
v_exp_f16 v203, v204
v_mfma_f32_16x16x32_bf16 v[184:187], v[224:227], v[212:215], v[184:187]
v_lshrrev_b32 v197, 18, v197
v_lshrrev_b32 v199, 18, v199
v_mfma_f32_16x16x32_f16 v[152:155], v[228:231], v[232:235], v[152:155]
ds_read_b128 v[224:227], v249 offset:55296
ds_read_u16_d16_hi v197, v197
ds_read_u16_d16_hi v199, v199
v_exp_f16_sdwa v241, v242 dst_sel:WORD_1 dst_unused:UNUSED_PRESERVE src0_sel:WORD_1
v_and_b32 v201, s49, v201
v_mfma_f32_16x16x32_f16 v[160:163], v[228:231], v[236:239], v[160:163]
v_lshrrev_b16 v200, 2, v201
s_waitcnt lgkmcnt(8)
v_mfma_f32_16x16x32_f16 v[156:159], v[0:3], v[232:235], v[156:159]
ds_read_b128 v[228:231], v249 offset:55552
ds_read_u16_d16 v200, v200
v_exp_f16_sdwa v206, v207 dst_sel:WORD_1 dst_unused:UNUSED_PRESERVE src0_sel:WORD_1
v_lshrrev_b32 v201, 18, v201
v_mfma_f32_16x16x32_f16 v[164:167], v[0:3], v[236:239], v[164:167]
v_exp_f16_sdwa v203, v204 dst_sel:WORD_1 dst_unused:UNUSED_PRESERVE src0_sel:WORD_1
v_pk_add_f16 v241, v241, 1.0 op_sel_hi:[1,0]
v_mfma_f32_16x16x32_bf16 v[180:183], v[4:7], v[208:211], v[180:183]
ds_read_b128 v[0:3], v248 offset:59392
ds_read_u16_d16_hi v201, v201
v_pk_add_f16 v206, v206, 1.0 op_sel_hi:[1,0]
v_pk_add_f16 v203, v203, 1.0 op_sel_hi:[1,0]
v_mfma_f32_16x16x32_bf16 v[188:191], v[4:7], v[212:215], v[188:191]
v_rcp_f16 v242, v241
s_waitcnt lgkmcnt(7)
v_mfma_f32_16x16x32_bf16 v[176:179], v[40:43], v[32:35], v[176:179]
ds_read_b128 v[4:7], v249 offset:56320
v_rcp_f16 v207, v206
v_mfma_f32_16x16x32_bf16 v[184:187], v[40:43], v[36:39], v[184:187]
v_rcp_f16 v204, v203
v_mfma_f32_16x16x32_bf16 v[180:183], v[44:47], v[32:35], v[180:183]
ds_read_b128 v[40:43], v248 offset:59648
v_rcp_f16_sdwa v242, v241 dst_sel:WORD_1 dst_unused:UNUSED_PRESERVE src0_sel:WORD_1
v_mfma_f32_16x16x32_bf16 v[188:191], v[44:47], v[36:39], v[188:191]
v_rcp_f16_sdwa v207, v206 dst_sel:WORD_1 dst_unused:UNUSED_PRESERVE src0_sel:WORD_1
v_or_b32 v232, v192, v193
v_or_b32 v233, v194, v195
s_waitcnt lgkmcnt(4)
v_or_b32 v234, v196, v197
v_rcp_f16_sdwa v204, v203 dst_sel:WORD_1 dst_unused:UNUSED_PRESERVE src0_sel:WORD_1
v_or_b32 v235, v198, v199
s_waitcnt lgkmcnt(2)
v_or_b32 v236, v200, v201
v_pk_mul_f16 v237, v243, v242
v_pk_mul_f16 v238, v240, v207
v_pk_mul_f16 v239, v205, v204
v_mfma_f32_16x16x32_f16 v[120:123], v[224:227], v[232:235], v[120:123]
buffer_load_dwordx4 v[244:247], v252, s[4:7], s68 offen
ds_read_b128 v[44:47], v249 offset:56576
v_cvt_pkrtz_f16_f32 v193, v176, v177
v_cvt_pkrtz_f16_f32 v195, v178, v179
v_mfma_f32_16x16x32_f16 v[128:131], v[224:227], v[236:239], v[128:131]
v_cvt_pkrtz_f16_f32 v197, v180, v181
v_cvt_pkrtz_f16_f32 v199, v182, v183
v_mfma_f32_16x16x32_f16 v[124:127], v[228:231], v[232:235], v[124:127]
ds_read_b128 v[224:227], v248 offset:60416
v_cvt_pkrtz_f16_f32 v201, v184, v185
v_cvt_pk_f16_f32 v243, v186, v187
v_cvt_pk_f16_f32 v240, v188, v189
v_mfma_f32_16x16x32_f16 v[132:135], v[228:231], v[236:239], v[132:135]
v_cvt_pk_f16_f32 v205, v190, v191
s_setprio 1
v_pk_fma_f16 v242, v243, v243, s48
v_mfma_f32_16x16x32_bf16 v[176:179], v[0:3], v[88:91], 0
ds_read_b128 v[228:231], v249 offset:57344
v_and_b32 v193, s49, v193
v_pk_fma_f16 v207, v240, v240, s48
v_mfma_f32_16x16x32_bf16 v[184:187], v[0:3], v[92:95], 0
v_and_b32 v195, s49, v195
v_pk_fma_f16 v204, v205, v205, s48
v_lshrrev_b16 v192, 2, v193
s_waitcnt lgkmcnt(3)
v_mfma_f32_16x16x32_f16 v[136:139], v[4:7], v[232:235], v[136:139]
ds_read_b128 v[0:3], v249 offset:57600
ds_read_u16_d16 v192, v192
v_pk_mul_f16 v242, v243, v242
v_lshrrev_b16 v194, 2, v195
v_mfma_f32_16x16x32_f16 v[144:147], v[4:7], v[236:239], v[144:147]
v_pk_mul_f16 v207, v240, v207
v_lshrrev_b32 v193, 18, v193
v_mfma_f32_16x16x32_bf16 v[180:183], v[40:43], v[88:91], 0
ds_read_b128 v[4:7], v248 offset:60672
ds_read_u16_d16 v194, v194
ds_read_u16_d16_hi v193, v193
v_pk_mul_f16 v204, v205, v204
v_lshrrev_b32 v195, 18, v195
v_mfma_f32_16x16x32_bf16 v[188:191], v[40:43], v[92:95], 0
v_exp_f16 v241, v242
v_and_b32 v197, s49, v197
s_waitcnt lgkmcnt(5)
v_mfma_f32_16x16x32_f16 v[140:143], v[44:47], v[232:235], v[140:143]
ds_read_b128 v[40:43], v248 offset:61440
ds_read_u16_d16_hi v195, v195
v_and_b32 v199, s49, v199
v_mfma_f32_16x16x32_f16 v[148:151], v[44:47], v[236:239], v[148:151]
v_exp_f16 v206, v207
v_lshrrev_b16 v196, 2, v197
v_lshrrev_b16 v198, 2, v199
v_mfma_f32_16x16x32_bf16 v[176:179], v[224:227], v[208:211], v[176:179]
buffer_store_dwordx4 v[80:83], v255, s[8:11], s70 offen offset:256 sc1
ds_read_b128 v[44:47], v248 offset:61696
ds_read_u16_d16 v196, v196
ds_read_u16_d16 v198, v198
v_exp_f16 v203, v204
v_mfma_f32_16x16x32_bf16 v[184:187], v[224:227], v[212:215], v[184:187]
v_lshrrev_b32 v197, 18, v197
v_lshrrev_b32 v199, 18, v199
v_mfma_f32_16x16x32_f16 v[152:155], v[228:231], v[232:235], v[152:155]
ds_read_b128 v[224:227], v249 offset:61440
ds_read_u16_d16_hi v197, v197
ds_read_u16_d16_hi v199, v199
v_exp_f16_sdwa v241, v242 dst_sel:WORD_1 dst_unused:UNUSED_PRESERVE src0_sel:WORD_1
v_and_b32 v201, s49, v201
v_mfma_f32_16x16x32_f16 v[160:163], v[228:231], v[236:239], v[160:163]
v_lshrrev_b16 v200, 2, v201
s_waitcnt lgkmcnt(8)
v_mfma_f32_16x16x32_f16 v[156:159], v[0:3], v[232:235], v[156:159]
ds_read_b128 v[228:231], v249 offset:61696
ds_read_u16_d16 v200, v200
v_exp_f16_sdwa v206, v207 dst_sel:WORD_1 dst_unused:UNUSED_PRESERVE src0_sel:WORD_1
v_lshrrev_b32 v201, 18, v201
v_mfma_f32_16x16x32_f16 v[164:167], v[0:3], v[236:239], v[164:167]
v_exp_f16_sdwa v203, v204 dst_sel:WORD_1 dst_unused:UNUSED_PRESERVE src0_sel:WORD_1
v_pk_add_f16 v241, v241, 1.0 op_sel_hi:[1,0]
v_mfma_f32_16x16x32_bf16 v[180:183], v[4:7], v[208:211], v[180:183]
ds_read_b128 v[0:3], v249
ds_read_u16_d16_hi v201, v201
v_pk_add_f16 v206, v206, 1.0 op_sel_hi:[1,0]
v_pk_add_f16 v203, v203, 1.0 op_sel_hi:[1,0]
v_mfma_f32_16x16x32_bf16 v[188:191], v[4:7], v[212:215], v[188:191]
v_rcp_f16 v242, v241
s_setprio 0
s_waitcnt lgkmcnt(7)
v_mfma_f32_16x16x32_bf16 v[176:179], v[40:43], v[32:35], v[176:179]
ds_read_b128 v[4:7], v249 offset:62464
v_rcp_f16 v207, v206
v_mfma_f32_16x16x32_bf16 v[184:187], v[40:43], v[36:39], v[184:187]
v_rcp_f16 v204, v203
v_mfma_f32_16x16x32_bf16 v[180:183], v[44:47], v[32:35], v[180:183]
ds_read_b128 v[40:43], v249 offset:256
v_rcp_f16_sdwa v242, v241 dst_sel:WORD_1 dst_unused:UNUSED_PRESERVE src0_sel:WORD_1
v_mfma_f32_16x16x32_bf16 v[188:191], v[44:47], v[36:39], v[188:191]
v_rcp_f16_sdwa v207, v206 dst_sel:WORD_1 dst_unused:UNUSED_PRESERVE src0_sel:WORD_1
v_or_b32 v232, v192, v193
v_or_b32 v233, v194, v195
s_waitcnt lgkmcnt(4)
v_or_b32 v234, v196, v197
v_rcp_f16_sdwa v204, v203 dst_sel:WORD_1 dst_unused:UNUSED_PRESERVE src0_sel:WORD_1
v_or_b32 v235, v198, v199
s_waitcnt lgkmcnt(2)
v_or_b32 v236, v200, v201
v_pk_mul_f16 v237, v243, v242
v_pk_mul_f16 v238, v240, v207
v_pk_mul_f16 v239, v205, v204
s_setprio 3
v_mfma_f32_16x16x32_f16 v[120:123], v[224:227], v[232:235], v[120:123]
buffer_load_dwordx4 v[216:219], v252, s[4:7], s68 offen offset:64
ds_read_b128 v[44:47], v249 offset:62720
v_cvt_pkrtz_f16_f32 v193, v176, v177
v_cvt_pkrtz_f16_f32 v195, v178, v179
v_mfma_f32_16x16x32_f16 v[128:131], v[224:227], v[236:239], v[128:131]
v_cvt_pkrtz_f16_f32 v197, v180, v181
v_cvt_pkrtz_f16_f32 v199, v182, v183
v_mfma_f32_16x16x32_f16 v[124:127], v[228:231], v[232:235], v[124:127]
ds_read_b128 v[224:227], v249 offset:1024
v_cvt_pkrtz_f16_f32 v201, v184, v185
v_cvt_pk_f16_f32 v243, v186, v187
v_cvt_pk_f16_f32 v240, v188, v189
v_mfma_f32_16x16x32_f16 v[132:135], v[228:231], v[236:239], v[132:135]
v_cvt_pk_f16_f32 v205, v190, v191
v_pk_fma_f16 v242, v243, v243, s48
v_mfma_f32_16x16x32_bf16 v[176:179], v[0:3], v[88:91], 0
ds_read_b128 v[228:231], v249 offset:63488
v_and_b32 v193, s49, v193
v_pk_fma_f16 v207, v240, v240, s48
v_mfma_f32_16x16x32_bf16 v[184:187], v[0:3], v[92:95], 0
v_and_b32 v195, s49, v195
v_pk_fma_f16 v204, v205, v205, s48
v_lshrrev_b16 v192, 2, v193
s_waitcnt lgkmcnt(3)
v_mfma_f32_16x16x32_f16 v[136:139], v[4:7], v[232:235], v[136:139]
ds_read_b128 v[0:3], v249 offset:63744
ds_read_u16_d16 v192, v192
v_pk_mul_f16 v242, v243, v242
v_lshrrev_b16 v194, 2, v195
v_mfma_f32_16x16x32_f16 v[144:147], v[4:7], v[236:239], v[144:147]
v_pk_mul_f16 v207, v240, v207
v_lshrrev_b32 v193, 18, v193
v_mfma_f32_16x16x32_bf16 v[180:183], v[40:43], v[88:91], 0
ds_read_b128 v[4:7], v249 offset:1280
ds_read_u16_d16 v194, v194
ds_read_u16_d16_hi v193, v193
v_pk_mul_f16 v204, v205, v204
v_lshrrev_b32 v195, 18, v195
v_mfma_f32_16x16x32_bf16 v[188:191], v[40:43], v[92:95], 0
v_exp_f16 v241, v242
v_and_b32 v197, s49, v197
s_waitcnt lgkmcnt(5)
v_mfma_f32_16x16x32_f16 v[140:143], v[44:47], v[232:235], v[140:143]
ds_read_b128 v[40:43], v249 offset:2048
ds_read_u16_d16_hi v195, v195
v_and_b32 v199, s49, v199
v_mfma_f32_16x16x32_f16 v[148:151], v[44:47], v[236:239], v[148:151]
v_exp_f16 v206, v207
v_lshrrev_b16 v196, 2, v197
v_lshrrev_b16 v198, 2, v199
v_mfma_f32_16x16x32_bf16 v[176:179], v[224:227], v[208:211], v[176:179]
ds_read_b128 v[44:47], v249 offset:2304
ds_read_u16_d16 v196, v196
ds_read_u16_d16 v198, v198
v_exp_f16 v203, v204
v_mfma_f32_16x16x32_bf16 v[184:187], v[224:227], v[212:215], v[184:187]
v_lshrrev_b32 v197, 18, v197
v_lshrrev_b32 v199, 18, v199
v_mfma_f32_16x16x32_f16 v[152:155], v[228:231], v[232:235], v[152:155]
ds_read_b128 v[224:227], v250 offset:2048
ds_read_u16_d16_hi v197, v197
ds_read_u16_d16_hi v199, v199
v_exp_f16_sdwa v241, v242 dst_sel:WORD_1 dst_unused:UNUSED_PRESERVE src0_sel:WORD_1
v_and_b32 v201, s49, v201
v_mfma_f32_16x16x32_f16 v[160:163], v[228:231], v[236:239], v[160:163]
v_lshrrev_b16 v200, 2, v201
s_waitcnt lgkmcnt(8)
v_mfma_f32_16x16x32_f16 v[156:159], v[0:3], v[232:235], v[156:159]
ds_read_b128 v[228:231], v250 offset:2304
ds_read_u16_d16 v200, v200
v_exp_f16_sdwa v206, v207 dst_sel:WORD_1 dst_unused:UNUSED_PRESERVE src0_sel:WORD_1
v_lshrrev_b32 v201, 18, v201
v_mfma_f32_16x16x32_f16 v[164:167], v[0:3], v[236:239], v[164:167]
v_exp_f16_sdwa v203, v204 dst_sel:WORD_1 dst_unused:UNUSED_PRESERVE src0_sel:WORD_1
v_pk_add_f16 v241, v241, 1.0 op_sel_hi:[1,0]
v_mfma_f32_16x16x32_bf16 v[180:183], v[4:7], v[208:211], v[180:183]
ds_read_b128 v[0:3], v249 offset:6144
ds_read_u16_d16_hi v201, v201
v_pk_add_f16 v206, v206, 1.0 op_sel_hi:[1,0]
v_pk_add_f16 v203, v203, 1.0 op_sel_hi:[1,0]
v_mfma_f32_16x16x32_bf16 v[188:191], v[4:7], v[212:215], v[188:191]
v_rcp_f16 v242, v241
s_waitcnt lgkmcnt(7)
v_mfma_f32_16x16x32_bf16 v[176:179], v[40:43], v[32:35], v[176:179]
ds_read_b128 v[4:7], v250 offset:3072
v_rcp_f16 v207, v206
v_mfma_f32_16x16x32_bf16 v[184:187], v[40:43], v[36:39], v[184:187]
v_rcp_f16 v204, v203
v_mfma_f32_16x16x32_bf16 v[180:183], v[44:47], v[32:35], v[180:183]
ds_read_b128 v[40:43], v249 offset:6400
v_rcp_f16_sdwa v242, v241 dst_sel:WORD_1 dst_unused:UNUSED_PRESERVE src0_sel:WORD_1
v_mfma_f32_16x16x32_bf16 v[188:191], v[44:47], v[36:39], v[188:191]
v_rcp_f16_sdwa v207, v206 dst_sel:WORD_1 dst_unused:UNUSED_PRESERVE src0_sel:WORD_1
v_or_b32 v232, v192, v193
v_or_b32 v233, v194, v195
s_waitcnt lgkmcnt(4)
v_or_b32 v234, v196, v197
v_rcp_f16_sdwa v204, v203 dst_sel:WORD_1 dst_unused:UNUSED_PRESERVE src0_sel:WORD_1
v_or_b32 v235, v198, v199
s_waitcnt lgkmcnt(2)
v_or_b32 v236, v200, v201
v_pk_mul_f16 v237, v243, v242
v_pk_mul_f16 v238, v240, v207
v_pk_mul_f16 v239, v205, v204
v_mfma_f32_16x16x32_f16 v[120:123], v[224:227], v[232:235], v[120:123]
ds_read_b128 v[44:47], v250 offset:3328
v_cvt_pkrtz_f16_f32 v193, v176, v177
v_cvt_pkrtz_f16_f32 v195, v178, v179
v_cvt_pkrtz_f16_f32 v197, v180, v181
v_mfma_f32_16x16x32_f16 v[128:131], v[224:227], v[236:239], v[128:131]
v_cvt_pkrtz_f16_f32 v199, v182, v183
v_cvt_pkrtz_f16_f32 v201, v184, v185
v_cvt_pkrtz_f16_f32 v203, v186, v187
v_mfma_f32_16x16x32_f16 v[124:127], v[228:231], v[232:235], v[124:127]
ds_read_b128 v[224:227], v249 offset:7168
v_cvt_pk_f16_f32 v243, v188, v189
v_cvt_pk_f16_f32 v240, v190, v191
v_pk_fma_f16 v242, v243, v243, s48
v_mfma_f32_16x16x32_f16 v[132:135], v[228:231], v[236:239], v[132:135]
v_cvt_pk_bf16_f32 v72, v72, v73
v_and_b32 v193, s49, v193
v_cvt_pk_bf16_f32 v73, v74, v75
v_mfma_f32_16x16x32_bf16 v[176:179], v[0:3], v[88:91], 0
ds_read_b128 v[228:231], v250 offset:4096
v_and_b32 v195, s49, v195
v_cvt_pk_bf16_f32 v74, v76, v77
v_pk_fma_f16 v207, v240, v240, s48
v_mfma_f32_16x16x32_bf16 v[184:187], v[0:3], v[92:95], 0
v_lshrrev_b16 v192, 2, v193
s_setprio 2
v_cvt_pk_bf16_f32 v75, v78, v79
v_pk_mul_f16 v242, v243, v242
s_waitcnt lgkmcnt(2)
v_mfma_f32_16x16x32_f16 v[136:139], v[4:7], v[232:235], v[136:139]
ds_read_b128 v[0:3], v250 offset:4352
ds_read_u16_d16 v192, v192
v_cvt_pk_bf16_f32 v56, v56, v57
v_lshrrev_b16 v194, 2, v195
v_cvt_pk_bf16_f32 v57, v58, v59
v_mfma_f32_16x16x32_f16 v[144:147], v[4:7], v[236:239], v[144:147]
v_pk_mul_f16 v207, v240, v207
v_lshrrev_b32 v193, 18, v193
v_cvt_pk_bf16_f32 v58, v60, v61
v_mfma_f32_16x16x32_bf16 v[180:183], v[40:43], v[88:91], 0
ds_read_b128 v[4:7], v249 offset:7424
ds_read_u16_d16 v194, v194
ds_read_u16_d16_hi v193, v193
v_exp_f16 v241, v242
v_cvt_pk_bf16_f32 v59, v62, v63
v_mfma_f32_16x16x32_bf16 v[188:191], v[40:43], v[92:95], 0
v_lshrrev_b32 v195, 18, v195
v_cvt_pk_bf16_f32 v168, v168, v169
v_and_b32 v197, s49, v197
v_mfma_f32_16x16x32_f16 v[140:143], v[44:47], v[232:235], v[140:143]
ds_read_b128 v[40:43], v249 offset:8192
ds_read_u16_d16_hi v195, v195
v_cvt_pk_bf16_f32 v169, v170, v171
v_exp_f16 v206, v207
v_mfma_f32_16x16x32_f16 v[148:151], v[44:47], v[236:239], v[148:151]
v_cvt_pk_bf16_f32 v170, v172, v173
v_and_b32 v199, s49, v199
v_cvt_pk_bf16_f32 v171, v174, v175
s_mov_b64 vcc, s[74:75]
s_waitcnt lgkmcnt(5)
v_mfma_f32_16x16x32_bf16 v[176:179], v[224:227], v[208:211], v[176:179]
ds_read_b128 v[44:47], v249 offset:8448
v_lshrrev_b16 v196, 2, v197
v_cndmask_b32_e64 v76, v56, v168, s[74:75]
v_mfma_f32_16x16x32_bf16 v[184:187], v[224:227], v[212:215], v[184:187]
v_exp_f16_sdwa v241, v242 dst_sel:WORD_1 dst_unused:UNUSED_PRESERVE src0_sel:WORD_1
v_cndmask_b32_dpp v56, v72, v56, vcc quad_perm:[1,0,3,2] row_mask:0xf bank_mask:0xf
v_lshrrev_b16 v198, 2, v199
v_mfma_f32_16x16x32_f16 v[152:155], v[228:231], v[232:235], v[152:155]
ds_read_b128 v[224:227], v250 offset:8192
ds_read_u16_d16 v196, v196
ds_read_u16_d16 v198, v198
v_cndmask_b32_e64 v77, v57, v169, s[74:75]
v_lshrrev_b32 v197, 18, v197
v_cndmask_b32_dpp v57, v73, v57, vcc quad_perm:[1,0,3,2] row_mask:0xf bank_mask:0xf
v_mfma_f32_16x16x32_f16 v[160:163], v[228:231], v[236:239], v[160:163]
v_lshrrev_b32 v199, 18, v199
v_exp_f16_sdwa v206, v207 dst_sel:WORD_1 dst_unused:UNUSED_PRESERVE src0_sel:WORD_1
v_mfma_f32_16x16x32_f16 v[156:159], v[0:3], v[232:235], v[156:159]
ds_read_b128 v[228:231], v250 offset:8448
ds_read_u16_d16_hi v197, v197
ds_read_u16_d16_hi v199, v199
v_cndmask_b32_e64 v78, v58, v170, s[74:75]
v_cndmask_b32_dpp v58, v74, v58, vcc quad_perm:[1,0,3,2] row_mask:0xf bank_mask:0xf
v_and_b32 v201, s49, v201
v_mfma_f32_16x16x32_f16 v[164:167], v[0:3], v[236:239], v[164:167]
v_cndmask_b32_e64 v79, v59, v171, s[74:75]
v_and_b32 v203, s49, v203
v_pk_add_f16 v241, v241, 1.0 op_sel_hi:[1,0]
s_waitcnt lgkmcnt(6)
v_mfma_f32_16x16x32_bf16 v[180:183], v[4:7], v[208:211], v[180:183]
ds_read_b128 v[0:3], v249 offset:12288
v_cndmask_b32_dpp v59, v75, v59, vcc quad_perm:[1,0,3,2] row_mask:0xf bank_mask:0xf
s_not_b64 vcc, s[74:75]
v_lshrrev_b16 v200, 2, v201
v_cndmask_b32_dpp v168, v72, v168, vcc quad_perm:[1,0,3,2] row_mask:0xf bank_mask:0xf
v_mfma_f32_16x16x32_bf16 v[188:191], v[4:7], v[212:215], v[188:191]
v_pk_add_f16 v206, v206, 1.0 op_sel_hi:[1,0]
v_cndmask_b32_dpp v169, v73, v169, vcc quad_perm:[1,0,3,2] row_mask:0xf bank_mask:0xf
v_lshrrev_b16 v202, 2, v203
v_mfma_f32_16x16x32_bf16 v[176:179], v[40:43], v[32:35], v[176:179]
ds_read_b128 v[4:7], v250 offset:9216
ds_read_u16_d16 v200, v200
ds_read_u16_d16 v202, v202
v_rcp_f16 v242, v241
v_cndmask_b32_dpp v170, v74, v170, vcc quad_perm:[1,0,3,2] row_mask:0xf bank_mask:0xf
v_mfma_f32_16x16x32_bf16 v[184:187], v[40:43], v[36:39], v[184:187]
v_cndmask_b32_dpp v171, v75, v171, vcc quad_perm:[1,0,3,2] row_mask:0xf bank_mask:0xf
v_lshrrev_b32 v201, 18, v201
v_lshrrev_b32 v203, 18, v203
v_mfma_f32_16x16x32_bf16 v[180:183], v[44:47], v[32:35], v[180:183]
ds_read_b128 v[40:43], v249 offset:12544
s_add_u32 s46, s70, 98304
buffer_store_dwordx4 v[56:59], v255, s[8:11], s46 offen sc1
ds_read_u16_d16_hi v201, v201
ds_read_u16_d16_hi v203, v203
v_rcp_f16 v207, v206
v_mfma_f32_16x16x32_bf16 v[188:191], v[44:47], v[36:39], v[188:191]
v_rcp_f16_sdwa v242, v241 dst_sel:WORD_1 dst_unused:UNUSED_PRESERVE src0_sel:WORD_1
v_or_b32 v232, v192, v193
v_or_b32 v233, v194, v195
s_waitcnt lgkmcnt(6)
v_or_b32 v234, v196, v197
v_rcp_f16_sdwa v207, v206 dst_sel:WORD_1 dst_unused:UNUSED_PRESERVE src0_sel:WORD_1
v_or_b32 v235, v198, v199
s_waitcnt lgkmcnt(1)
v_or_b32 v236, v200, v201
s_waitcnt lgkmcnt(0)
v_or_b32 v237, v202, v203
v_pk_mul_f16 v238, v243, v242
v_pk_mul_f16 v239, v240, v207
v_mfma_f32_16x16x32_f16 v[120:123], v[224:227], v[232:235], v[120:123]
buffer_load_dwordx4 v[12:15], v252, s[4:7], s68 offen offset:128
ds_read_b128 v[44:47], v250 offset:9472
v_cvt_pkrtz_f16_f32 v193, v176, v177
v_cvt_pkrtz_f16_f32 v195, v178, v179
v_mfma_f32_16x16x32_f16 v[128:131], v[224:227], v[236:239], v[128:131]
v_cvt_pkrtz_f16_f32 v197, v180, v181
v_cvt_pkrtz_f16_f32 v199, v182, v183
v_mfma_f32_16x16x32_f16 v[124:127], v[228:231], v[232:235], v[124:127]
ds_read_b128 v[224:227], v249 offset:13312
v_cvt_pkrtz_f16_f32 v201, v184, v185
v_cvt_pk_f16_f32 v243, v186, v187
v_cvt_pk_f16_f32 v240, v188, v189
v_mfma_f32_16x16x32_f16 v[132:135], v[228:231], v[236:239], v[132:135]
v_cvt_pk_f16_f32 v205, v190, v191
s_setprio 1
v_pk_fma_f16 v242, v243, v243, s48
v_mfma_f32_16x16x32_bf16 v[176:179], v[0:3], v[88:91], 0
ds_read_b128 v[228:231], v250 offset:10240
v_and_b32 v193, s49, v193
v_pk_fma_f16 v207, v240, v240, s48
v_mfma_f32_16x16x32_bf16 v[184:187], v[0:3], v[92:95], 0
v_and_b32 v195, s49, v195
v_pk_fma_f16 v204, v205, v205, s48
v_lshrrev_b16 v192, 2, v193
v_mfma_f32_16x16x32_f16 v[136:139], v[4:7], v[232:235], v[136:139]
ds_read_b128 v[0:3], v250 offset:10496
ds_read_u16_d16 v192, v192
v_pk_mul_f16 v242, v243, v242
v_lshrrev_b16 v194, 2, v195
v_mfma_f32_16x16x32_f16 v[144:147], v[4:7], v[236:239], v[144:147]
v_pk_mul_f16 v207, v240, v207
v_lshrrev_b32 v193, 18, v193
v_mfma_f32_16x16x32_bf16 v[180:183], v[40:43], v[88:91], 0
ds_read_b128 v[4:7], v249 offset:13568
ds_read_u16_d16 v194, v194
ds_read_u16_d16_hi v193, v193
v_pk_mul_f16 v204, v205, v204
v_lshrrev_b32 v195, 18, v195
v_mfma_f32_16x16x32_bf16 v[188:191], v[40:43], v[92:95], 0
v_exp_f16 v241, v242
v_and_b32 v197, s49, v197
s_waitcnt lgkmcnt(6)
v_mfma_f32_16x16x32_f16 v[140:143], v[44:47], v[232:235], v[140:143]
ds_read_b128 v[40:43], v249 offset:14336
ds_read_u16_d16_hi v195, v195
v_and_b32 v199, s49, v199
v_mfma_f32_16x16x32_f16 v[148:151], v[44:47], v[236:239], v[148:151]
v_exp_f16 v206, v207
v_lshrrev_b16 v196, 2, v197
v_lshrrev_b16 v198, 2, v199
v_mfma_f32_16x16x32_bf16 v[176:179], v[224:227], v[208:211], v[176:179]
ds_read_b128 v[44:47], v249 offset:14592
ds_read_u16_d16 v196, v196
ds_read_u16_d16 v198, v198
v_exp_f16 v203, v204
v_mfma_f32_16x16x32_bf16 v[184:187], v[224:227], v[212:215], v[184:187]
v_lshrrev_b32 v197, 18, v197
v_lshrrev_b32 v199, 18, v199
s_waitcnt lgkmcnt(7)
v_mfma_f32_16x16x32_f16 v[152:155], v[228:231], v[232:235], v[152:155]
ds_read_b128 v[224:227], v250 offset:14336
ds_read_u16_d16_hi v197, v197
ds_read_u16_d16_hi v199, v199
v_exp_f16_sdwa v241, v242 dst_sel:WORD_1 dst_unused:UNUSED_PRESERVE src0_sel:WORD_1
v_and_b32 v201, s49, v201
v_mfma_f32_16x16x32_f16 v[160:163], v[228:231], v[236:239], v[160:163]
v_lshrrev_b16 v200, 2, v201
v_mfma_f32_16x16x32_f16 v[156:159], v[0:3], v[232:235], v[156:159]
ds_read_b128 v[228:231], v250 offset:14592
ds_read_u16_d16 v200, v200
v_exp_f16_sdwa v206, v207 dst_sel:WORD_1 dst_unused:UNUSED_PRESERVE src0_sel:WORD_1
v_lshrrev_b32 v201, 18, v201
v_mfma_f32_16x16x32_f16 v[164:167], v[0:3], v[236:239], v[164:167]
v_exp_f16_sdwa v203, v204 dst_sel:WORD_1 dst_unused:UNUSED_PRESERVE src0_sel:WORD_1
v_pk_add_f16 v241, v241, 1.0 op_sel_hi:[1,0]
v_mfma_f32_16x16x32_bf16 v[180:183], v[4:7], v[208:211], v[180:183]
ds_read_b128 v[0:3], v249 offset:18432
ds_read_u16_d16_hi v201, v201
v_pk_add_f16 v206, v206, 1.0 op_sel_hi:[1,0]
v_pk_add_f16 v203, v203, 1.0 op_sel_hi:[1,0]
v_mfma_f32_16x16x32_bf16 v[188:191], v[4:7], v[212:215], v[188:191]
v_rcp_f16 v242, v241
s_setprio 0
s_waitcnt lgkmcnt(7)
v_mfma_f32_16x16x32_bf16 v[176:179], v[40:43], v[32:35], v[176:179]
ds_read_b128 v[4:7], v250 offset:15360
v_rcp_f16 v207, v206
v_mfma_f32_16x16x32_bf16 v[184:187], v[40:43], v[36:39], v[184:187]
v_rcp_f16 v204, v203
v_mfma_f32_16x16x32_bf16 v[180:183], v[44:47], v[32:35], v[180:183]
ds_read_b128 v[40:43], v249 offset:18688
v_rcp_f16_sdwa v242, v241 dst_sel:WORD_1 dst_unused:UNUSED_PRESERVE src0_sel:WORD_1
v_mfma_f32_16x16x32_bf16 v[188:191], v[44:47], v[36:39], v[188:191]
v_rcp_f16_sdwa v207, v206 dst_sel:WORD_1 dst_unused:UNUSED_PRESERVE src0_sel:WORD_1
v_or_b32 v232, v192, v193
v_or_b32 v233, v194, v195
s_waitcnt lgkmcnt(4)
v_or_b32 v234, v196, v197
v_rcp_f16_sdwa v204, v203 dst_sel:WORD_1 dst_unused:UNUSED_PRESERVE src0_sel:WORD_1
v_or_b32 v235, v198, v199
s_waitcnt lgkmcnt(2)
v_or_b32 v236, v200, v201
v_pk_mul_f16 v237, v243, v242
v_pk_mul_f16 v238, v240, v207
v_pk_mul_f16 v239, v205, v204
s_setprio 3
v_mfma_f32_16x16x32_f16 v[120:123], v[224:227], v[232:235], v[120:123]
s_add_u32 s46, s68, 98304
buffer_load_dwordx4 v[8:11], v252, s[4:7], s46 offen
ds_read_b128 v[44:47], v250 offset:15616
v_cvt_pkrtz_f16_f32 v193, v176, v177
v_cvt_pkrtz_f16_f32 v195, v178, v179
v_mfma_f32_16x16x32_f16 v[128:131], v[224:227], v[236:239], v[128:131]
v_cvt_pkrtz_f16_f32 v197, v180, v181
v_cvt_pkrtz_f16_f32 v199, v182, v183
v_mfma_f32_16x16x32_f16 v[124:127], v[228:231], v[232:235], v[124:127]
ds_read_b128 v[224:227], v249 offset:19456
v_cvt_pkrtz_f16_f32 v201, v184, v185
v_cvt_pk_f16_f32 v243, v186, v187
v_cvt_pk_f16_f32 v240, v188, v189
v_mfma_f32_16x16x32_f16 v[132:135], v[228:231], v[236:239], v[132:135]
v_cvt_pk_f16_f32 v205, v190, v191
v_pk_fma_f16 v242, v243, v243, s48
v_mfma_f32_16x16x32_bf16 v[176:179], v[0:3], v[88:91], 0
ds_read_b128 v[228:231], v250 offset:16384
v_and_b32 v193, s49, v193
v_pk_fma_f16 v207, v240, v240, s48
v_mfma_f32_16x16x32_bf16 v[184:187], v[0:3], v[92:95], 0
v_and_b32 v195, s49, v195
v_pk_fma_f16 v204, v205, v205, s48
v_lshrrev_b16 v192, 2, v193
s_waitcnt lgkmcnt(3)
v_mfma_f32_16x16x32_f16 v[136:139], v[4:7], v[232:235], v[136:139]
ds_read_b128 v[0:3], v250 offset:16640
ds_read_u16_d16 v192, v192
v_pk_mul_f16 v242, v243, v242
v_lshrrev_b16 v194, 2, v195
v_mfma_f32_16x16x32_f16 v[144:147], v[4:7], v[236:239], v[144:147]
v_pk_mul_f16 v207, v240, v207
v_lshrrev_b32 v193, 18, v193
v_mfma_f32_16x16x32_bf16 v[180:183], v[40:43], v[88:91], 0
ds_read_b128 v[4:7], v249 offset:19712
ds_read_u16_d16 v194, v194
ds_read_u16_d16_hi v193, v193
v_pk_mul_f16 v204, v205, v204
v_lshrrev_b32 v195, 18, v195
v_mfma_f32_16x16x32_bf16 v[188:191], v[40:43], v[92:95], 0
v_exp_f16 v241, v242
v_and_b32 v197, s49, v197
s_waitcnt lgkmcnt(5)
v_mfma_f32_16x16x32_f16 v[140:143], v[44:47], v[232:235], v[140:143]
ds_read_b128 v[40:43], v249 offset:20480
ds_read_u16_d16_hi v195, v195
v_and_b32 v199, s49, v199
v_mfma_f32_16x16x32_f16 v[148:151], v[44:47], v[236:239], v[148:151]
v_exp_f16 v206, v207
v_lshrrev_b16 v196, 2, v197
v_lshrrev_b16 v198, 2, v199
v_mfma_f32_16x16x32_bf16 v[176:179], v[224:227], v[208:211], v[176:179]
s_add_u32 s46, s70, 98304
buffer_store_dwordx4 v[76:79], v255, s[8:11], s46 offen offset:128 sc1
ds_read_b128 v[44:47], v249 offset:20736
ds_read_u16_d16 v196, v196
ds_read_u16_d16 v198, v198
v_exp_f16 v203, v204
v_mfma_f32_16x16x32_bf16 v[184:187], v[224:227], v[212:215], v[184:187]
v_lshrrev_b32 v197, 18, v197
v_lshrrev_b32 v199, 18, v199
v_mfma_f32_16x16x32_f16 v[152:155], v[228:231], v[232:235], v[152:155]
ds_read_b128 v[224:227], v250 offset:20480
ds_read_u16_d16_hi v197, v197
ds_read_u16_d16_hi v199, v199
v_exp_f16_sdwa v241, v242 dst_sel:WORD_1 dst_unused:UNUSED_PRESERVE src0_sel:WORD_1
v_and_b32 v201, s49, v201
v_mfma_f32_16x16x32_f16 v[160:163], v[228:231], v[236:239], v[160:163]
v_lshrrev_b16 v200, 2, v201
s_waitcnt lgkmcnt(7)
v_mfma_f32_16x16x32_f16 v[156:159], v[0:3], v[232:235], v[156:159]
ds_read_b128 v[228:231], v250 offset:20736
ds_read_u16_d16 v200, v200
v_exp_f16_sdwa v206, v207 dst_sel:WORD_1 dst_unused:UNUSED_PRESERVE src0_sel:WORD_1
v_lshrrev_b32 v201, 18, v201
v_mfma_f32_16x16x32_f16 v[164:167], v[0:3], v[236:239], v[164:167]
v_exp_f16_sdwa v203, v204 dst_sel:WORD_1 dst_unused:UNUSED_PRESERVE src0_sel:WORD_1
v_pk_add_f16 v241, v241, 1.0 op_sel_hi:[1,0]
v_mfma_f32_16x16x32_bf16 v[180:183], v[4:7], v[208:211], v[180:183]
ds_read_b128 v[0:3], v248 offset:16384
ds_read_u16_d16_hi v201, v201
v_pk_add_f16 v206, v206, 1.0 op_sel_hi:[1,0]
v_pk_add_f16 v203, v203, 1.0 op_sel_hi:[1,0]
v_mfma_f32_16x16x32_bf16 v[188:191], v[4:7], v[212:215], v[188:191]
v_rcp_f16 v242, v241
v_mfma_f32_16x16x32_bf16 v[176:179], v[40:43], v[32:35], v[176:179]
ds_read_b128 v[4:7], v250 offset:21504
v_rcp_f16 v207, v206
v_mfma_f32_16x16x32_bf16 v[184:187], v[40:43], v[36:39], v[184:187]
v_rcp_f16 v204, v203
s_waitcnt lgkmcnt(5)
v_mfma_f32_16x16x32_bf16 v[180:183], v[44:47], v[32:35], v[180:183]
ds_read_b128 v[40:43], v248 offset:16640
v_rcp_f16_sdwa v242, v241 dst_sel:WORD_1 dst_unused:UNUSED_PRESERVE src0_sel:WORD_1
v_mfma_f32_16x16x32_bf16 v[188:191], v[44:47], v[36:39], v[188:191]
v_rcp_f16_sdwa v207, v206 dst_sel:WORD_1 dst_unused:UNUSED_PRESERVE src0_sel:WORD_1
v_or_b32 v232, v192, v193
v_or_b32 v233, v194, v195
v_or_b32 v234, v196, v197
v_rcp_f16_sdwa v204, v203 dst_sel:WORD_1 dst_unused:UNUSED_PRESERVE src0_sel:WORD_1
v_or_b32 v235, v198, v199
s_waitcnt lgkmcnt(2)
v_or_b32 v236, v200, v201
v_pk_mul_f16 v237, v243, v242
v_pk_mul_f16 v238, v240, v207
v_pk_mul_f16 v239, v205, v204
v_mfma_f32_16x16x32_f16 v[120:123], v[224:227], v[232:235], v[120:123]
ds_read_b128 v[44:47], v250 offset:21760
v_cvt_pkrtz_f16_f32 v193, v176, v177
v_cvt_pkrtz_f16_f32 v195, v178, v179
v_mfma_f32_16x16x32_f16 v[128:131], v[224:227], v[236:239], v[128:131]
v_cvt_pkrtz_f16_f32 v197, v180, v181
v_cvt_pkrtz_f16_f32 v199, v182, v183
v_mfma_f32_16x16x32_f16 v[124:127], v[228:231], v[232:235], v[124:127]
ds_read_b128 v[224:227], v248 offset:17408
v_cvt_pkrtz_f16_f32 v201, v184, v185
v_cvt_pk_f16_f32 v243, v186, v187
v_cvt_pk_f16_f32 v240, v188, v189
v_mfma_f32_16x16x32_f16 v[132:135], v[228:231], v[236:239], v[132:135]
v_cvt_pk_f16_f32 v205, v190, v191
v_pk_fma_f16 v242, v243, v243, s48
s_waitcnt vmcnt(14)
v_mfma_f32_16x16x32_bf16 v[176:179], v[0:3], v[96:99], 0
ds_read_b128 v[228:231], v250 offset:22528
v_and_b32 v193, s49, v193
v_pk_fma_f16 v207, v240, v240, s48
s_waitcnt vmcnt(13)
v_mfma_f32_16x16x32_bf16 v[184:187], v[0:3], v[100:103], 0
v_and_b32 v195, s49, v195
v_pk_fma_f16 v204, v205, v205, s48
s_setprio 2
v_lshrrev_b16 v192, 2, v193
s_waitcnt lgkmcnt(2)
v_mfma_f32_16x16x32_f16 v[136:139], v[4:7], v[232:235], v[136:139]
ds_read_b128 v[0:3], v250 offset:22784
ds_read_u16_d16 v192, v192
v_pk_mul_f16 v242, v243, v242
v_lshrrev_b16 v194, 2, v195
v_mfma_f32_16x16x32_f16 v[144:147], v[4:7], v[236:239], v[144:147]
v_pk_mul_f16 v207, v240, v207
v_lshrrev_b32 v193, 18, v193
v_mfma_f32_16x16x32_bf16 v[180:183], v[40:43], v[96:99], 0
ds_read_b128 v[4:7], v248 offset:17664
ds_read_u16_d16 v194, v194
ds_read_u16_d16_hi v193, v193
v_pk_mul_f16 v204, v205, v204
v_lshrrev_b32 v195, 18, v195
v_mfma_f32_16x16x32_bf16 v[188:191], v[40:43], v[100:103], 0
v_exp_f16 v241, v242
v_and_b32 v197, s49, v197
v_mfma_f32_16x16x32_f16 v[140:143], v[44:47], v[232:235], v[140:143]
ds_read_b128 v[40:43], v248 offset:18432
ds_read_u16_d16_hi v195, v195
v_and_b32 v199, s49, v199
v_mfma_f32_16x16x32_f16 v[148:151], v[44:47], v[236:239], v[148:151]
v_exp_f16 v206, v207
v_lshrrev_b16 v196, 2, v197
v_lshrrev_b16 v198, 2, v199
s_waitcnt vmcnt(12) lgkmcnt(7)
v_mfma_f32_16x16x32_bf16 v[176:179], v[224:227], v[104:107], v[176:179]
ds_read_b128 v[44:47], v248 offset:18688
ds_read_u16_d16 v196, v196
ds_read_u16_d16 v198, v198
v_exp_f16 v203, v204
s_waitcnt vmcnt(11)
v_mfma_f32_16x16x32_bf16 v[184:187], v[224:227], v[108:111], v[184:187]
v_lshrrev_b32 v197, 18, v197
v_lshrrev_b32 v199, 18, v199
v_mfma_f32_16x16x32_f16 v[152:155], v[228:231], v[232:235], v[152:155]
ds_read_b128 v[224:227], v250 offset:26624
ds_read_u16_d16_hi v197, v197
ds_read_u16_d16_hi v199, v199
v_exp_f16_sdwa v241, v242 dst_sel:WORD_1 dst_unused:UNUSED_PRESERVE src0_sel:WORD_1
v_and_b32 v201, s49, v201
v_mfma_f32_16x16x32_f16 v[160:163], v[228:231], v[236:239], v[160:163]
v_lshrrev_b16 v200, 2, v201
s_waitcnt lgkmcnt(7)
v_mfma_f32_16x16x32_f16 v[156:159], v[0:3], v[232:235], v[156:159]
ds_read_b128 v[228:231], v250 offset:26880
ds_read_u16_d16 v200, v200
v_exp_f16_sdwa v206, v207 dst_sel:WORD_1 dst_unused:UNUSED_PRESERVE src0_sel:WORD_1
v_lshrrev_b32 v201, 18, v201
v_mfma_f32_16x16x32_f16 v[164:167], v[0:3], v[236:239], v[164:167]
v_exp_f16_sdwa v203, v204 dst_sel:WORD_1 dst_unused:UNUSED_PRESERVE src0_sel:WORD_1
v_pk_add_f16 v241, v241, 1.0 op_sel_hi:[1,0]
v_mfma_f32_16x16x32_bf16 v[180:183], v[4:7], v[104:107], v[180:183]
ds_read_b128 v[0:3], v248 offset:22528
ds_read_u16_d16_hi v201, v201
v_pk_add_f16 v206, v206, 1.0 op_sel_hi:[1,0]
v_pk_add_f16 v203, v203, 1.0 op_sel_hi:[1,0]
v_mfma_f32_16x16x32_bf16 v[188:191], v[4:7], v[108:111], v[188:191]
v_rcp_f16 v242, v241
s_waitcnt vmcnt(10)
v_mfma_f32_16x16x32_bf16 v[176:179], v[40:43], v[112:115], v[176:179]
ds_read_b128 v[4:7], v250 offset:27648
v_rcp_f16 v207, v206
s_waitcnt vmcnt(7)
v_mfma_f32_16x16x32_bf16 v[184:187], v[40:43], v[116:119], v[184:187]
v_rcp_f16 v204, v203
s_waitcnt lgkmcnt(5)
v_mfma_f32_16x16x32_bf16 v[180:183], v[44:47], v[112:115], v[180:183]
ds_read_b128 v[40:43], v248 offset:22784
v_rcp_f16_sdwa v242, v241 dst_sel:WORD_1 dst_unused:UNUSED_PRESERVE src0_sel:WORD_1
v_mfma_f32_16x16x32_bf16 v[188:191], v[44:47], v[116:119], v[188:191]
v_rcp_f16_sdwa v207, v206 dst_sel:WORD_1 dst_unused:UNUSED_PRESERVE src0_sel:WORD_1
v_or_b32 v232, v192, v193
v_or_b32 v233, v194, v195
v_or_b32 v234, v196, v197
v_rcp_f16_sdwa v204, v203 dst_sel:WORD_1 dst_unused:UNUSED_PRESERVE src0_sel:WORD_1
v_or_b32 v235, v198, v199
s_waitcnt lgkmcnt(2)
v_or_b32 v236, v200, v201
v_pk_mul_f16 v237, v243, v242
v_pk_mul_f16 v238, v240, v207
v_pk_mul_f16 v239, v205, v204
v_mfma_f32_16x16x32_f16 v[120:123], v[224:227], v[232:235], v[120:123]
s_add_u32 s46, s68, 98304
buffer_load_dwordx4 v[36:39], v252, s[4:7], s46 offen offset:64
ds_read_b128 v[44:47], v250 offset:27904
v_cvt_pkrtz_f16_f32 v193, v176, v177
v_cvt_pkrtz_f16_f32 v195, v178, v179
v_mfma_f32_16x16x32_f16 v[128:131], v[224:227], v[236:239], v[128:131]
v_cvt_pkrtz_f16_f32 v197, v180, v181
v_cvt_pkrtz_f16_f32 v199, v182, v183
v_mfma_f32_16x16x32_f16 v[124:127], v[228:231], v[232:235], v[124:127]
ds_read_b128 v[224:227], v248 offset:23552
v_cvt_pkrtz_f16_f32 v201, v184, v185
v_cvt_pk_f16_f32 v243, v186, v187
v_mfma_f32_16x16x32_f16 v[132:135], v[228:231], v[236:239], v[132:135]
v_cvt_pk_f16_f32 v240, v188, v189
v_cvt_pk_f16_f32 v205, v190, v191
s_setprio 1
v_mfma_f32_16x16x32_bf16 v[176:179], v[0:3], v[96:99], 0
ds_read_b128 v[228:231], v250 offset:28672
v_pk_fma_f16 v242, v243, v243, s48
v_and_b32 v193, s49, v193
v_mfma_f32_16x16x32_bf16 v[184:187], v[0:3], v[100:103], 0
v_pk_fma_f16 v207, v240, v240, s48
v_and_b32 v195, s49, v195
s_waitcnt lgkmcnt(3)
v_mfma_f32_16x16x32_f16 v[136:139], v[4:7], v[232:235], v[136:139]
ds_read_b128 v[0:3], v250 offset:28928
v_pk_fma_f16 v204, v205, v205, s48
v_lshrrev_b16 v192, 2, v193
v_pk_mul_f16 v242, v243, v242
v_mfma_f32_16x16x32_f16 v[144:147], v[4:7], v[236:239], v[144:147]
v_lshrrev_b16 v194, 2, v195
v_pk_mul_f16 v207, v240, v207
s_waitcnt vmcnt(7)
v_mfma_f32_16x16x32_bf16 v[120:123], v[26:29], v[244:247], v[120:123]
ds_read_b128 v[4:7], v248 offset:23808
ds_read_u16_d16 v192, v192
ds_read_u16_d16 v194, v194
v_lshrrev_b32 v193, 18, v193
v_pk_mul_f16 v204, v205, v204
v_mfma_f32_16x16x32_bf16 v[124:127], v[24:27], v[244:247], v[124:127]
v_lshrrev_b32 v195, 18, v195
v_mfma_f32_16x16x32_bf16 v[180:183], v[40:43], v[96:99], 0
ds_read_u16_d16_hi v193, v193
ds_read_u16_d16_hi v195, v195
v_exp_f16 v241, v242
v_and_b32 v197, s49, v197
v_mfma_f32_16x16x32_bf16 v[188:191], v[40:43], v[100:103], 0
v_and_b32 v199, s49, v199
s_waitcnt lgkmcnt(6)
v_mfma_f32_16x16x32_f16 v[140:143], v[44:47], v[232:235], v[140:143]
ds_read_b128 v[40:43], v248 offset:24576
v_exp_f16 v206, v207
v_lshrrev_b16 v196, 2, v197
v_mfma_f32_16x16x32_f16 v[148:151], v[44:47], v[236:239], v[148:151]
v_lshrrev_b16 v198, 2, v199
v_exp_f16 v203, v204
v_mfma_f32_16x16x32_bf16 v[176:179], v[224:227], v[104:107], v[176:179]
s_add_u32 s46, s70, 98304
buffer_store_dwordx4 v[168:171], v255, s[8:11], s46 offen offset:256 sc1
ds_read_b128 v[44:47], v248 offset:24832
ds_read_u16_d16 v196, v196
ds_read_u16_d16 v198, v198
v_lshrrev_b32 v197, 18, v197
v_lshrrev_b32 v199, 18, v199
v_mfma_f32_16x16x32_bf16 v[184:187], v[224:227], v[108:111], v[184:187]
v_exp_f16_sdwa v241, v242 dst_sel:WORD_1 dst_unused:UNUSED_PRESERVE src0_sel:WORD_1
v_mfma_f32_16x16x32_f16 v[152:155], v[228:231], v[232:235], v[152:155]
ds_read_b128 v[224:227], v249 offset:24576
ds_read_u16_d16_hi v197, v197
ds_read_u16_d16_hi v199, v199
v_and_b32 v201, s49, v201
v_lshrrev_b16 v200, 2, v201
v_mfma_f32_16x16x32_f16 v[160:163], v[228:231], v[236:239], v[160:163]
v_exp_f16_sdwa v206, v207 dst_sel:WORD_1 dst_unused:UNUSED_PRESERVE src0_sel:WORD_1
s_waitcnt lgkmcnt(7)
v_mfma_f32_16x16x32_f16 v[156:159], v[0:3], v[232:235], v[156:159]
ds_read_b128 v[228:231], v254 offset:7936
ds_read_u16_d16 v200, v200
v_lshrrev_b32 v201, 18, v201
v_mfma_f32_16x16x32_f16 v[164:167], v[0:3], v[236:239], v[164:167]
v_exp_f16_sdwa v203, v204 dst_sel:WORD_1 dst_unused:UNUSED_PRESERVE src0_sel:WORD_1
v_pk_add_f16 v241, v241, 1.0 op_sel_hi:[1,0]
v_pk_add_f16 v206, v206, 1.0 op_sel_hi:[1,0]
v_mfma_f32_16x16x32_bf16 v[180:183], v[4:7], v[104:107], v[180:183]
ds_read_b128 v[0:3], v249 offset:24832
ds_read_u16_d16_hi v201, v201
v_pk_add_f16 v203, v203, 1.0 op_sel_hi:[1,0]
v_mfma_f32_16x16x32_bf16 v[188:191], v[4:7], v[108:111], v[188:191]
v_rcp_f16 v242, v241
s_setprio 0
s_waitcnt lgkmcnt(7)
v_mfma_f32_16x16x32_bf16 v[176:179], v[40:43], v[112:115], v[176:179]
ds_read_b128 v[4:7], v254 offset:7952
v_rcp_f16 v207, v206
v_mfma_f32_16x16x32_bf16 v[184:187], v[40:43], v[116:119], v[184:187]
v_rcp_f16 v204, v203
v_mfma_f32_16x16x32_bf16 v[180:183], v[44:47], v[112:115], v[180:183]
ds_read_b128 v[40:43], v248 offset:28672
v_rcp_f16_sdwa v242, v241 dst_sel:WORD_1 dst_unused:UNUSED_PRESERVE src0_sel:WORD_1
v_mfma_f32_16x16x32_bf16 v[188:191], v[44:47], v[116:119], v[188:191]
v_rcp_f16_sdwa v207, v206 dst_sel:WORD_1 dst_unused:UNUSED_PRESERVE src0_sel:WORD_1
v_or_b32 v232, v192, v193
v_or_b32 v233, v194, v195
s_waitcnt lgkmcnt(4)
v_or_b32 v234, v196, v197
v_rcp_f16_sdwa v204, v203 dst_sel:WORD_1 dst_unused:UNUSED_PRESERVE src0_sel:WORD_1
v_or_b32 v235, v198, v199
s_waitcnt lgkmcnt(2)
v_or_b32 v236, v200, v201
v_pk_mul_f16 v237, v243, v242
v_pk_mul_f16 v238, v240, v207
v_pk_mul_f16 v239, v205, v204
s_setprio 3
v_mfma_f32_16x16x32_f16 v[48:51], v[224:227], v[232:235], v[228:231]
ds_read_b128 v[44:47], v249 offset:25600
v_cvt_pkrtz_f16_f32 v193, v176, v177
v_cvt_pkrtz_f16_f32 v195, v178, v179
v_mfma_f32_16x16x32_f16 v[56:59], v[224:227], v[236:239], v[228:231]
v_cvt_pkrtz_f16_f32 v197, v180, v181
v_cvt_pkrtz_f16_f32 v199, v182, v183
s_waitcnt lgkmcnt(2)
v_mfma_f32_16x16x32_f16 v[52:55], v[0:3], v[232:235], v[4:7]
ds_read_b128 v[224:227], v254 offset:8064
ds_read_b128 v[228:231], v248 offset:28928
v_cvt_pkrtz_f16_f32 v201, v184, v185
v_cvt_pk_f16_f32 v243, v186, v187
v_mfma_f32_16x16x32_f16 v[60:63], v[0:3], v[236:239], v[4:7]
v_cvt_pk_f16_f32 v240, v188, v189
v_cvt_pk_f16_f32 v205, v190, v191
s_waitcnt lgkmcnt(3)
v_mfma_f32_16x16x32_bf16 v[176:179], v[40:43], v[96:99], 0
ds_read_b128 v[0:3], v249 offset:25856
ds_read_b128 v[4:7], v254 offset:8080
v_pk_fma_f16 v242, v243, v243, s48
v_and_b32 v193, s49, v193
v_mfma_f32_16x16x32_bf16 v[184:187], v[40:43], v[100:103], 0
v_pk_fma_f16 v207, v240, v240, s48
v_and_b32 v195, s49, v195
s_waitcnt lgkmcnt(3)
v_mfma_f32_16x16x32_f16 v[64:67], v[44:47], v[232:235], v[224:227]
ds_read_b128 v[40:43], v248 offset:29696
v_pk_fma_f16 v204, v205, v205, s48
v_lshrrev_b16 v192, 2, v193
v_pk_mul_f16 v242, v243, v242
v_mfma_f32_16x16x32_f16 v[72:75], v[44:47], v[236:239], v[224:227]
v_lshrrev_b16 v194, 2, v195
v_pk_mul_f16 v207, v240, v207
s_waitcnt vmcnt(6)
v_mfma_f32_16x16x32_bf16 v[136:139], v[26:29], v[216:219], v[136:139]
ds_read_b128 v[44:47], v249 offset:26624
ds_read_b128 v[224:227], v254 offset:16128
ds_read_u16_d16 v192, v192
ds_read_u16_d16 v194, v194
v_lshrrev_b32 v193, 18, v193
v_pk_mul_f16 v204, v205, v204
v_mfma_f32_16x16x32_bf16 v[140:143], v[24:27], v[216:219], v[140:143]
v_lshrrev_b32 v195, 18, v195
s_waitcnt lgkmcnt(5)
v_mfma_f32_16x16x32_bf16 v[180:183], v[228:231], v[96:99], 0
ds_read_u16_d16_hi v193, v193
ds_read_u16_d16_hi v195, v195
v_exp_f16 v241, v242
v_and_b32 v197, s49, v197
v_mfma_f32_16x16x32_bf16 v[188:191], v[228:231], v[100:103], 0
v_and_b32 v199, s49, v199
v_mfma_f32_16x16x32_f16 v[68:71], v[0:3], v[232:235], v[4:7]
ds_read_b128 v[228:231], v249 offset:26880
v_exp_f16 v206, v207
v_lshrrev_b16 v196, 2, v197
v_mfma_f32_16x16x32_f16 v[76:79], v[0:3], v[236:239], v[4:7]
v_lshrrev_b16 v198, 2, v199
v_exp_f16 v203, v204
s_waitcnt lgkmcnt(7)
v_mfma_f32_16x16x32_bf16 v[176:179], v[40:43], v[104:107], v[176:179]
ds_read_b128 v[0:3], v254 offset:16144
ds_read_b128 v[4:7], v248 offset:29952
ds_read_u16_d16 v196, v196
ds_read_u16_d16 v198, v198
v_lshrrev_b32 v197, 18, v197
v_lshrrev_b32 v199, 18, v199
v_mfma_f32_16x16x32_bf16 v[184:187], v[40:43], v[108:111], v[184:187]
v_exp_f16_sdwa v241, v242 dst_sel:WORD_1 dst_unused:UNUSED_PRESERVE src0_sel:WORD_1
s_waitcnt lgkmcnt(7)
v_mfma_f32_16x16x32_f16 v[80:83], v[44:47], v[232:235], v[224:227]
ds_read_b128 v[40:43], v248 offset:30720
ds_read_u16_d16_hi v197, v197
ds_read_u16_d16_hi v199, v199
v_and_b32 v201, s49, v201
v_lshrrev_b16 v200, 2, v201
v_mfma_f32_16x16x32_f16 v[168:171], v[44:47], v[236:239], v[224:227]
v_exp_f16_sdwa v206, v207 dst_sel:WORD_1 dst_unused:UNUSED_PRESERVE src0_sel:WORD_1
s_waitcnt lgkmcnt(6)
v_mfma_f32_16x16x32_f16 v[84:87], v[228:231], v[232:235], v[0:3]
ds_read_b128 v[44:47], v248 offset:30976
ds_read_b128 v[224:227], v249 offset:30720
ds_read_u16_d16 v200, v200
v_lshrrev_b32 v201, 18, v201
v_mfma_f32_16x16x32_f16 v[172:175], v[228:231], v[236:239], v[0:3]
v_exp_f16_sdwa v203, v204 dst_sel:WORD_1 dst_unused:UNUSED_PRESERVE src0_sel:WORD_1
v_pk_add_f16 v241, v241, 1.0 op_sel_hi:[1,0]
v_pk_add_f16 v206, v206, 1.0 op_sel_hi:[1,0]
s_waitcnt lgkmcnt(7)
v_mfma_f32_16x16x32_bf16 v[180:183], v[4:7], v[104:107], v[180:183]
ds_read_b128 v[228:231], v249 offset:30976
ds_read_b128 v[0:3], v248 offset:34816
ds_read_u16_d16_hi v201, v201
v_pk_add_f16 v203, v203, 1.0 op_sel_hi:[1,0]
v_mfma_f32_16x16x32_bf16 v[188:191], v[4:7], v[108:111], v[188:191]
v_rcp_f16 v242, v241
s_waitcnt lgkmcnt(8)
v_mfma_f32_16x16x32_bf16 v[176:179], v[40:43], v[112:115], v[176:179]
ds_read_b128 v[4:7], v249 offset:31744
v_rcp_f16 v207, v206
v_mfma_f32_16x16x32_bf16 v[184:187], v[40:43], v[116:119], v[184:187]
v_rcp_f16 v204, v203
s_waitcnt lgkmcnt(6)
v_mfma_f32_16x16x32_bf16 v[180:183], v[44:47], v[112:115], v[180:183]
ds_read_b128 v[40:43], v248 offset:35072
v_rcp_f16_sdwa v242, v241 dst_sel:WORD_1 dst_unused:UNUSED_PRESERVE src0_sel:WORD_1
v_mfma_f32_16x16x32_bf16 v[188:191], v[44:47], v[116:119], v[188:191]
v_rcp_f16_sdwa v207, v206 dst_sel:WORD_1 dst_unused:UNUSED_PRESERVE src0_sel:WORD_1
v_or_b32 v232, v192, v193
v_or_b32 v233, v194, v195
v_or_b32 v234, v196, v197
v_rcp_f16_sdwa v204, v203 dst_sel:WORD_1 dst_unused:UNUSED_PRESERVE src0_sel:WORD_1
v_or_b32 v235, v198, v199
s_waitcnt lgkmcnt(2)
v_or_b32 v236, v200, v201
v_pk_mul_f16 v237, v243, v242
v_pk_mul_f16 v238, v240, v207
v_pk_mul_f16 v239, v205, v204
v_mfma_f32_16x16x32_f16 v[48:51], v[224:227], v[232:235], v[48:51]
s_add_u32 s46, s68, 98304
buffer_load_dwordx4 v[216:219], v252, s[4:7], s46 offen offset:128
ds_read_b128 v[44:47], v249 offset:32000
v_cvt_pkrtz_f16_f32 v193, v176, v177
v_cvt_pkrtz_f16_f32 v195, v178, v179
v_mfma_f32_16x16x32_f16 v[56:59], v[224:227], v[236:239], v[56:59]
v_cvt_pkrtz_f16_f32 v197, v180, v181
v_cvt_pkrtz_f16_f32 v199, v182, v183
v_mfma_f32_16x16x32_f16 v[52:55], v[228:231], v[232:235], v[52:55]
ds_read_b128 v[224:227], v248 offset:35840
v_cvt_pkrtz_f16_f32 v201, v184, v185
v_cvt_pk_f16_f32 v243, v186, v187
v_mfma_f32_16x16x32_f16 v[60:63], v[228:231], v[236:239], v[60:63]
v_cvt_pk_f16_f32 v240, v188, v189
v_cvt_pk_f16_f32 v205, v190, v191
v_mfma_f32_16x16x32_bf16 v[176:179], v[0:3], v[96:99], 0
ds_read_b128 v[228:231], v249 offset:32768
v_pk_fma_f16 v242, v243, v243, s48
v_and_b32 v193, s49, v193
v_mfma_f32_16x16x32_bf16 v[184:187], v[0:3], v[100:103], 0
v_pk_fma_f16 v207, v240, v240, s48
v_and_b32 v195, s49, v195
s_waitcnt lgkmcnt(3)
v_mfma_f32_16x16x32_f16 v[64:67], v[4:7], v[232:235], v[64:67]
ds_read_b128 v[0:3], v249 offset:33024
v_pk_fma_f16 v204, v205, v205, s48
s_setprio 2
v_lshrrev_b16 v192, 2, v193
v_pk_mul_f16 v242, v243, v242
v_mfma_f32_16x16x32_f16 v[72:75], v[4:7], v[236:239], v[72:75]
v_lshrrev_b16 v194, 2, v195
v_pk_mul_f16 v207, v240, v207
s_waitcnt vmcnt(5)
v_mfma_f32_16x16x32_bf16 v[152:155], v[26:29], v[12:15], v[152:155]
ds_read_b128 v[4:7], v248 offset:36096
ds_read_u16_d16 v192, v192
ds_read_u16_d16 v194, v194
v_lshrrev_b32 v193, 18, v193
v_pk_mul_f16 v204, v205, v204
v_mfma_f32_16x16x32_bf16 v[156:159], v[24:27], v[12:15], v[156:159]
v_lshrrev_b32 v195, 18, v195
v_mfma_f32_16x16x32_bf16 v[180:183], v[40:43], v[96:99], 0
ds_read_u16_d16_hi v193, v193
ds_read_u16_d16_hi v195, v195
v_exp_f16 v241, v242
v_and_b32 v197, s49, v197
v_mfma_f32_16x16x32_bf16 v[188:191], v[40:43], v[100:103], 0
v_and_b32 v199, s49, v199
s_waitcnt lgkmcnt(6)
v_mfma_f32_16x16x32_f16 v[68:71], v[44:47], v[232:235], v[68:71]
ds_read_b128 v[40:43], v248 offset:36864
v_exp_f16 v206, v207
v_lshrrev_b16 v196, 2, v197
v_mfma_f32_16x16x32_f16 v[76:79], v[44:47], v[236:239], v[76:79]
v_lshrrev_b16 v198, 2, v199
v_exp_f16 v203, v204
v_mfma_f32_16x16x32_bf16 v[176:179], v[224:227], v[104:107], v[176:179]
ds_read_b128 v[44:47], v248 offset:37120
ds_read_u16_d16 v196, v196
ds_read_u16_d16 v198, v198
v_lshrrev_b32 v197, 18, v197
v_lshrrev_b32 v199, 18, v199
v_mfma_f32_16x16x32_bf16 v[184:187], v[224:227], v[108:111], v[184:187]
v_exp_f16_sdwa v241, v242 dst_sel:WORD_1 dst_unused:UNUSED_PRESERVE src0_sel:WORD_1
v_mfma_f32_16x16x32_f16 v[80:83], v[228:231], v[232:235], v[80:83]
ds_read_b128 v[224:227], v249 offset:36864
ds_read_u16_d16_hi v197, v197
ds_read_u16_d16_hi v199, v199
v_and_b32 v201, s49, v201
v_lshrrev_b16 v200, 2, v201
v_mfma_f32_16x16x32_f16 v[168:171], v[228:231], v[236:239], v[168:171]
v_exp_f16_sdwa v206, v207 dst_sel:WORD_1 dst_unused:UNUSED_PRESERVE src0_sel:WORD_1
s_waitcnt lgkmcnt(7)
v_mfma_f32_16x16x32_f16 v[84:87], v[0:3], v[232:235], v[84:87]
ds_read_b128 v[228:231], v249 offset:37120
ds_read_u16_d16 v200, v200
v_lshrrev_b32 v201, 18, v201
v_mfma_f32_16x16x32_f16 v[172:175], v[0:3], v[236:239], v[172:175]
v_exp_f16_sdwa v203, v204 dst_sel:WORD_1 dst_unused:UNUSED_PRESERVE src0_sel:WORD_1
v_pk_add_f16 v241, v241, 1.0 op_sel_hi:[1,0]
v_pk_add_f16 v206, v206, 1.0 op_sel_hi:[1,0]
v_mfma_f32_16x16x32_bf16 v[180:183], v[4:7], v[104:107], v[180:183]
ds_read_b128 v[0:3], v248 offset:40960
ds_read_u16_d16_hi v201, v201
v_pk_add_f16 v203, v203, 1.0 op_sel_hi:[1,0]
v_mfma_f32_16x16x32_bf16 v[188:191], v[4:7], v[108:111], v[188:191]
v_rcp_f16 v242, v241
s_waitcnt lgkmcnt(7)
v_mfma_f32_16x16x32_bf16 v[176:179], v[40:43], v[112:115], v[176:179]
ds_read_b128 v[4:7], v249 offset:37888
v_rcp_f16 v207, v206
v_mfma_f32_16x16x32_bf16 v[184:187], v[40:43], v[116:119], v[184:187]
v_rcp_f16 v204, v203
v_mfma_f32_16x16x32_bf16 v[180:183], v[44:47], v[112:115], v[180:183]
ds_read_b128 v[40:43], v248 offset:41216
v_rcp_f16_sdwa v242, v241 dst_sel:WORD_1 dst_unused:UNUSED_PRESERVE src0_sel:WORD_1
v_mfma_f32_16x16x32_bf16 v[188:191], v[44:47], v[116:119], v[188:191]
v_rcp_f16_sdwa v207, v206 dst_sel:WORD_1 dst_unused:UNUSED_PRESERVE src0_sel:WORD_1
v_or_b32 v232, v192, v193
v_or_b32 v233, v194, v195
s_waitcnt lgkmcnt(4)
v_or_b32 v234, v196, v197
v_rcp_f16_sdwa v204, v203 dst_sel:WORD_1 dst_unused:UNUSED_PRESERVE src0_sel:WORD_1
v_or_b32 v235, v198, v199
s_waitcnt lgkmcnt(2)
v_or_b32 v236, v200, v201
v_pk_mul_f16 v237, v243, v242
v_pk_mul_f16 v238, v240, v207
v_pk_mul_f16 v239, v205, v204
v_mfma_f32_16x16x32_f16 v[48:51], v[224:227], v[232:235], v[48:51]
buffer_load_dwordx4 v[12:15], v252, s[4:7], s69 offen
ds_read_b128 v[44:47], v249 offset:38144
v_cvt_pkrtz_f16_f32 v193, v176, v177
v_cvt_pkrtz_f16_f32 v195, v178, v179
v_cvt_pkrtz_f16_f32 v197, v180, v181
v_mfma_f32_16x16x32_f16 v[56:59], v[224:227], v[236:239], v[56:59]
v_cvt_pkrtz_f16_f32 v199, v182, v183
v_cvt_pkrtz_f16_f32 v201, v184, v185
v_cvt_pkrtz_f16_f32 v203, v186, v187
v_mfma_f32_16x16x32_f16 v[52:55], v[228:231], v[232:235], v[52:55]
ds_read_b128 v[224:227], v248 offset:41984
v_cvt_pk_f16_f32 v243, v188, v189
v_cvt_pk_f16_f32 v240, v190, v191
v_pk_fma_f16 v242, v243, v243, s48
s_setprio 1
v_mfma_f32_16x16x32_f16 v[60:63], v[228:231], v[236:239], v[60:63]
v_cvt_pk_bf16_f32 v136, v136, v137
v_and_b32 v193, s49, v193
v_cvt_pk_bf16_f32 v137, v138, v139
v_mfma_f32_16x16x32_bf16 v[176:179], v[0:3], v[96:99], 0
ds_read_b128 v[228:231], v249 offset:38912
v_and_b32 v195, s49, v195
v_cvt_pk_bf16_f32 v138, v140, v141
v_pk_fma_f16 v207, v240, v240, s48
v_mfma_f32_16x16x32_bf16 v[184:187], v[0:3], v[100:103], 0
v_lshrrev_b16 v192, 2, v193
v_cvt_pk_bf16_f32 v139, v142, v143
v_pk_mul_f16 v242, v243, v242
s_waitcnt lgkmcnt(2)
v_mfma_f32_16x16x32_f16 v[64:67], v[4:7], v[232:235], v[64:67]
ds_read_b128 v[0:3], v249 offset:39168
ds_read_u16_d16 v192, v192
v_cvt_pk_bf16_f32 v120, v120, v121
v_lshrrev_b16 v194, 2, v195
v_cvt_pk_bf16_f32 v121, v122, v123
v_mfma_f32_16x16x32_f16 v[72:75], v[4:7], v[236:239], v[72:75]
v_pk_mul_f16 v207, v240, v207
v_lshrrev_b32 v193, 18, v193
v_cvt_pk_bf16_f32 v122, v124, v125
v_mfma_f32_16x16x32_bf16 v[180:183], v[40:43], v[96:99], 0
ds_read_b128 v[4:7], v248 offset:42240
ds_read_u16_d16 v194, v194
ds_read_u16_d16_hi v193, v193
v_exp_f16 v241, v242
v_cvt_pk_bf16_f32 v123, v126, v127
v_mfma_f32_16x16x32_bf16 v[188:191], v[40:43], v[100:103], 0
v_lshrrev_b32 v195, 18, v195
v_cvt_pk_bf16_f32 v152, v152, v153
v_and_b32 v197, s49, v197
v_mfma_f32_16x16x32_f16 v[68:71], v[44:47], v[232:235], v[68:71]
ds_read_b128 v[40:43], v248 offset:43008
ds_read_u16_d16_hi v195, v195
v_cvt_pk_bf16_f32 v153, v154, v155
v_exp_f16 v206, v207
v_mfma_f32_16x16x32_f16 v[76:79], v[44:47], v[236:239], v[76:79]
v_cvt_pk_bf16_f32 v154, v156, v157
v_and_b32 v199, s49, v199
v_cvt_pk_bf16_f32 v155, v158, v159
s_mov_b64 vcc, s[74:75]
s_waitcnt lgkmcnt(5)
v_mfma_f32_16x16x32_bf16 v[176:179], v[224:227], v[104:107], v[176:179]
ds_read_b128 v[44:47], v248 offset:43264
v_lshrrev_b16 v196, 2, v197
v_cndmask_b32_e64 v140, v120, v152, s[74:75]
v_mfma_f32_16x16x32_bf16 v[184:187], v[224:227], v[108:111], v[184:187]
v_exp_f16_sdwa v241, v242 dst_sel:WORD_1 dst_unused:UNUSED_PRESERVE src0_sel:WORD_1
v_cndmask_b32_dpp v120, v136, v120, vcc quad_perm:[1,0,3,2] row_mask:0xf bank_mask:0xf
v_lshrrev_b16 v198, 2, v199
v_mfma_f32_16x16x32_f16 v[80:83], v[228:231], v[232:235], v[80:83]
ds_read_b128 v[224:227], v249 offset:43008
ds_read_u16_d16 v196, v196
ds_read_u16_d16 v198, v198
v_cndmask_b32_e64 v141, v121, v153, s[74:75]
v_lshrrev_b32 v197, 18, v197
v_cndmask_b32_dpp v121, v137, v121, vcc quad_perm:[1,0,3,2] row_mask:0xf bank_mask:0xf
v_mfma_f32_16x16x32_f16 v[168:171], v[228:231], v[236:239], v[168:171]
v_lshrrev_b32 v199, 18, v199
v_exp_f16_sdwa v206, v207 dst_sel:WORD_1 dst_unused:UNUSED_PRESERVE src0_sel:WORD_1
v_mfma_f32_16x16x32_f16 v[84:87], v[0:3], v[232:235], v[84:87]
ds_read_b128 v[228:231], v249 offset:43264
ds_read_u16_d16_hi v197, v197
ds_read_u16_d16_hi v199, v199
v_cndmask_b32_e64 v142, v122, v154, s[74:75]
v_cndmask_b32_dpp v122, v138, v122, vcc quad_perm:[1,0,3,2] row_mask:0xf bank_mask:0xf
v_and_b32 v201, s49, v201
v_mfma_f32_16x16x32_f16 v[172:175], v[0:3], v[236:239], v[172:175]
v_cndmask_b32_e64 v143, v123, v155, s[74:75]
v_and_b32 v203, s49, v203
v_pk_add_f16 v241, v241, 1.0 op_sel_hi:[1,0]
s_waitcnt lgkmcnt(6)
v_mfma_f32_16x16x32_bf16 v[180:183], v[4:7], v[104:107], v[180:183]
ds_read_b128 v[0:3], v248 offset:47104
v_cndmask_b32_dpp v123, v139, v123, vcc quad_perm:[1,0,3,2] row_mask:0xf bank_mask:0xf
s_not_b64 vcc, s[74:75]
v_lshrrev_b16 v200, 2, v201
s_setprio 0
v_cndmask_b32_dpp v152, v136, v152, vcc quad_perm:[1,0,3,2] row_mask:0xf bank_mask:0xf
v_mfma_f32_16x16x32_bf16 v[188:191], v[4:7], v[108:111], v[188:191]
v_pk_add_f16 v206, v206, 1.0 op_sel_hi:[1,0]
v_cndmask_b32_dpp v153, v137, v153, vcc quad_perm:[1,0,3,2] row_mask:0xf bank_mask:0xf
v_lshrrev_b16 v202, 2, v203
v_mfma_f32_16x16x32_bf16 v[176:179], v[40:43], v[112:115], v[176:179]
ds_read_b128 v[4:7], v249 offset:44032
ds_read_u16_d16 v200, v200
ds_read_u16_d16 v202, v202
v_rcp_f16 v242, v241
v_cndmask_b32_dpp v154, v138, v154, vcc quad_perm:[1,0,3,2] row_mask:0xf bank_mask:0xf
v_mfma_f32_16x16x32_bf16 v[184:187], v[40:43], v[116:119], v[184:187]
v_cndmask_b32_dpp v155, v139, v155, vcc quad_perm:[1,0,3,2] row_mask:0xf bank_mask:0xf
v_lshrrev_b32 v201, 18, v201
v_lshrrev_b32 v203, 18, v203
v_mfma_f32_16x16x32_bf16 v[180:183], v[44:47], v[112:115], v[180:183]
ds_read_b128 v[40:43], v248 offset:47360
buffer_store_dwordx4 v[120:123], v255, s[8:11], s68 offen sc1
ds_read_u16_d16_hi v201, v201
ds_read_u16_d16_hi v203, v203
v_rcp_f16 v207, v206
v_mfma_f32_16x16x32_bf16 v[188:191], v[44:47], v[116:119], v[188:191]
v_rcp_f16_sdwa v242, v241 dst_sel:WORD_1 dst_unused:UNUSED_PRESERVE src0_sel:WORD_1
v_or_b32 v232, v192, v193
v_or_b32 v233, v194, v195
s_waitcnt lgkmcnt(6)
v_or_b32 v234, v196, v197
v_rcp_f16_sdwa v207, v206 dst_sel:WORD_1 dst_unused:UNUSED_PRESERVE src0_sel:WORD_1
v_or_b32 v235, v198, v199
s_waitcnt lgkmcnt(1)
v_or_b32 v236, v200, v201
s_waitcnt lgkmcnt(0)
v_or_b32 v237, v202, v203
v_pk_mul_f16 v238, v243, v242
v_pk_mul_f16 v239, v240, v207
s_setprio 3
v_mfma_f32_16x16x32_f16 v[48:51], v[224:227], v[232:235], v[48:51]
buffer_load_dwordx4 v[244:247], v252, s[4:7], s69 offen offset:64
ds_read_b128 v[44:47], v249 offset:44288
v_cvt_pkrtz_f16_f32 v193, v176, v177
v_cvt_pkrtz_f16_f32 v195, v178, v179
v_mfma_f32_16x16x32_f16 v[56:59], v[224:227], v[236:239], v[56:59]
v_cvt_pkrtz_f16_f32 v197, v180, v181
v_cvt_pkrtz_f16_f32 v199, v182, v183
v_mfma_f32_16x16x32_f16 v[52:55], v[228:231], v[232:235], v[52:55]
ds_read_b128 v[224:227], v248 offset:48128
v_cvt_pkrtz_f16_f32 v201, v184, v185
v_cvt_pk_f16_f32 v243, v186, v187
v_mfma_f32_16x16x32_f16 v[60:63], v[228:231], v[236:239], v[60:63]
v_cvt_pk_f16_f32 v240, v188, v189
v_cvt_pk_f16_f32 v205, v190, v191
v_mfma_f32_16x16x32_bf16 v[176:179], v[0:3], v[96:99], 0
ds_read_b128 v[228:231], v249 offset:45056
v_pk_fma_f16 v242, v243, v243, s48
v_and_b32 v193, s49, v193
v_mfma_f32_16x16x32_bf16 v[184:187], v[0:3], v[100:103], 0
v_pk_fma_f16 v207, v240, v240, s48
v_and_b32 v195, s49, v195
v_mfma_f32_16x16x32_f16 v[64:67], v[4:7], v[232:235], v[64:67]
ds_read_b128 v[0:3], v249 offset:45312
v_pk_fma_f16 v204, v205, v205, s48
v_lshrrev_b16 v192, 2, v193
v_pk_mul_f16 v242, v243, v242
v_mfma_f32_16x16x32_f16 v[72:75], v[4:7], v[236:239], v[72:75]
v_lshrrev_b16 v194, 2, v195
v_pk_mul_f16 v207, v240, v207
s_waitcnt vmcnt(7)
v_mfma_f32_16x16x32_bf16 v[128:131], v[26:29], v[8:11], v[128:131]
ds_read_b128 v[4:7], v248 offset:48384
ds_read_u16_d16 v192, v192
ds_read_u16_d16 v194, v194
v_lshrrev_b32 v193, 18, v193
v_pk_mul_f16 v204, v205, v204
v_mfma_f32_16x16x32_bf16 v[132:135], v[24:27], v[8:11], v[132:135]
v_lshrrev_b32 v195, 18, v195
v_mfma_f32_16x16x32_bf16 v[180:183], v[40:43], v[96:99], 0
ds_read_u16_d16_hi v193, v193
ds_read_u16_d16_hi v195, v195
v_exp_f16 v241, v242
v_and_b32 v197, s49, v197
v_mfma_f32_16x16x32_bf16 v[188:191], v[40:43], v[100:103], 0
v_and_b32 v199, s49, v199
s_waitcnt lgkmcnt(6)
v_mfma_f32_16x16x32_f16 v[68:71], v[44:47], v[232:235], v[68:71]
ds_read_b128 v[40:43], v248 offset:49152
v_exp_f16 v206, v207
v_lshrrev_b16 v196, 2, v197
v_mfma_f32_16x16x32_f16 v[76:79], v[44:47], v[236:239], v[76:79]
v_lshrrev_b16 v198, 2, v199
v_exp_f16 v203, v204
v_mfma_f32_16x16x32_bf16 v[176:179], v[224:227], v[104:107], v[176:179]
buffer_store_dwordx4 v[140:143], v255, s[8:11], s68 offen offset:128 sc1
ds_read_b128 v[44:47], v248 offset:49408
ds_read_u16_d16 v196, v196
ds_read_u16_d16 v198, v198
v_lshrrev_b32 v197, 18, v197
v_lshrrev_b32 v199, 18, v199
v_mfma_f32_16x16x32_bf16 v[184:187], v[224:227], v[108:111], v[184:187]
v_exp_f16_sdwa v241, v242 dst_sel:WORD_1 dst_unused:UNUSED_PRESERVE src0_sel:WORD_1
v_mfma_f32_16x16x32_f16 v[80:83], v[228:231], v[232:235], v[80:83]
ds_read_b128 v[224:227], v249 offset:49152
ds_read_u16_d16_hi v197, v197
ds_read_u16_d16_hi v199, v199
v_and_b32 v201, s49, v201
v_lshrrev_b16 v200, 2, v201
v_mfma_f32_16x16x32_f16 v[168:171], v[228:231], v[236:239], v[168:171]
v_exp_f16_sdwa v206, v207 dst_sel:WORD_1 dst_unused:UNUSED_PRESERVE src0_sel:WORD_1
s_waitcnt lgkmcnt(7)
v_mfma_f32_16x16x32_f16 v[84:87], v[0:3], v[232:235], v[84:87]
ds_read_b128 v[228:231], v249 offset:49408
ds_read_u16_d16 v200, v200
v_lshrrev_b32 v201, 18, v201
v_mfma_f32_16x16x32_f16 v[172:175], v[0:3], v[236:239], v[172:175]
v_exp_f16_sdwa v203, v204 dst_sel:WORD_1 dst_unused:UNUSED_PRESERVE src0_sel:WORD_1
v_pk_add_f16 v241, v241, 1.0 op_sel_hi:[1,0]
v_pk_add_f16 v206, v206, 1.0 op_sel_hi:[1,0]
v_mfma_f32_16x16x32_bf16 v[180:183], v[4:7], v[104:107], v[180:183]
ds_read_b128 v[0:3], v248 offset:53248
ds_read_u16_d16_hi v201, v201
v_pk_add_f16 v203, v203, 1.0 op_sel_hi:[1,0]
v_mfma_f32_16x16x32_bf16 v[188:191], v[4:7], v[108:111], v[188:191]
v_rcp_f16 v242, v241
s_waitcnt lgkmcnt(7)
v_mfma_f32_16x16x32_bf16 v[176:179], v[40:43], v[112:115], v[176:179]
ds_read_b128 v[4:7], v249 offset:50176
v_rcp_f16 v207, v206
v_mfma_f32_16x16x32_bf16 v[184:187], v[40:43], v[116:119], v[184:187]
v_rcp_f16 v204, v203
v_mfma_f32_16x16x32_bf16 v[180:183], v[44:47], v[112:115], v[180:183]
ds_read_b128 v[40:43], v248 offset:53504
v_rcp_f16_sdwa v242, v241 dst_sel:WORD_1 dst_unused:UNUSED_PRESERVE src0_sel:WORD_1
v_mfma_f32_16x16x32_bf16 v[188:191], v[44:47], v[116:119], v[188:191]
v_rcp_f16_sdwa v207, v206 dst_sel:WORD_1 dst_unused:UNUSED_PRESERVE src0_sel:WORD_1
v_or_b32 v232, v192, v193
v_or_b32 v233, v194, v195
s_waitcnt lgkmcnt(4)
v_or_b32 v234, v196, v197
v_rcp_f16_sdwa v204, v203 dst_sel:WORD_1 dst_unused:UNUSED_PRESERVE src0_sel:WORD_1
v_or_b32 v235, v198, v199
s_waitcnt lgkmcnt(2)
v_or_b32 v236, v200, v201
v_pk_mul_f16 v237, v243, v242
v_pk_mul_f16 v238, v240, v207
v_pk_mul_f16 v239, v205, v204
v_mfma_f32_16x16x32_f16 v[48:51], v[224:227], v[232:235], v[48:51]
buffer_load_dwordx4 v[8:11], v252, s[4:7], s69 offen offset:128
ds_read_b128 v[44:47], v249 offset:50432
v_cvt_pkrtz_f16_f32 v193, v176, v177
v_cvt_pkrtz_f16_f32 v195, v178, v179
v_mfma_f32_16x16x32_f16 v[56:59], v[224:227], v[236:239], v[56:59]
v_cvt_pkrtz_f16_f32 v197, v180, v181
v_cvt_pkrtz_f16_f32 v199, v182, v183
v_mfma_f32_16x16x32_f16 v[52:55], v[228:231], v[232:235], v[52:55]
ds_read_b128 v[224:227], v248 offset:54272
v_cvt_pkrtz_f16_f32 v201, v184, v185
v_cvt_pk_f16_f32 v243, v186, v187
v_mfma_f32_16x16x32_f16 v[60:63], v[228:231], v[236:239], v[60:63]
v_cvt_pk_f16_f32 v240, v188, v189
v_cvt_pk_f16_f32 v205, v190, v191
v_mfma_f32_16x16x32_bf16 v[176:179], v[0:3], v[96:99], 0
ds_read_b128 v[228:231], v249 offset:51200
v_pk_fma_f16 v242, v243, v243, s48
v_and_b32 v193, s49, v193
v_mfma_f32_16x16x32_bf16 v[184:187], v[0:3], v[100:103], 0
v_pk_fma_f16 v207, v240, v240, s48
v_and_b32 v195, s49, v195
s_waitcnt lgkmcnt(3)
v_mfma_f32_16x16x32_f16 v[64:67], v[4:7], v[232:235], v[64:67]
ds_read_b128 v[0:3], v249 offset:51456
v_pk_fma_f16 v204, v205, v205, s48
s_setprio 2
v_lshrrev_b16 v192, 2, v193
v_pk_mul_f16 v242, v243, v242
v_mfma_f32_16x16x32_f16 v[72:75], v[4:7], v[236:239], v[72:75]
v_lshrrev_b16 v194, 2, v195
v_pk_mul_f16 v207, v240, v207
s_waitcnt vmcnt(7)
v_mfma_f32_16x16x32_bf16 v[144:147], v[26:29], v[36:39], v[144:147]
ds_read_b128 v[4:7], v248 offset:54528
ds_read_u16_d16 v192, v192
ds_read_u16_d16 v194, v194
v_lshrrev_b32 v193, 18, v193
v_pk_mul_f16 v204, v205, v204
v_mfma_f32_16x16x32_bf16 v[148:151], v[24:27], v[36:39], v[148:151]
v_lshrrev_b32 v195, 18, v195
v_mfma_f32_16x16x32_bf16 v[180:183], v[40:43], v[96:99], 0
ds_read_u16_d16_hi v193, v193
ds_read_u16_d16_hi v195, v195
v_exp_f16 v241, v242
v_and_b32 v197, s49, v197
v_mfma_f32_16x16x32_bf16 v[188:191], v[40:43], v[100:103], 0
v_and_b32 v199, s49, v199
s_waitcnt lgkmcnt(6)
v_mfma_f32_16x16x32_f16 v[68:71], v[44:47], v[232:235], v[68:71]
ds_read_b128 v[40:43], v248 offset:55296
v_exp_f16 v206, v207
v_lshrrev_b16 v196, 2, v197
v_mfma_f32_16x16x32_f16 v[76:79], v[44:47], v[236:239], v[76:79]
v_lshrrev_b16 v198, 2, v199
v_exp_f16 v203, v204
v_mfma_f32_16x16x32_bf16 v[176:179], v[224:227], v[104:107], v[176:179]
ds_read_b128 v[44:47], v248 offset:55552
ds_read_u16_d16 v196, v196
ds_read_u16_d16 v198, v198
v_lshrrev_b32 v197, 18, v197
v_lshrrev_b32 v199, 18, v199
v_mfma_f32_16x16x32_bf16 v[184:187], v[224:227], v[108:111], v[184:187]
v_exp_f16_sdwa v241, v242 dst_sel:WORD_1 dst_unused:UNUSED_PRESERVE src0_sel:WORD_1
v_mfma_f32_16x16x32_f16 v[80:83], v[228:231], v[232:235], v[80:83]
ds_read_b128 v[224:227], v249 offset:55296
ds_read_u16_d16_hi v197, v197
ds_read_u16_d16_hi v199, v199
v_and_b32 v201, s49, v201
v_lshrrev_b16 v200, 2, v201
v_mfma_f32_16x16x32_f16 v[168:171], v[228:231], v[236:239], v[168:171]
v_exp_f16_sdwa v206, v207 dst_sel:WORD_1 dst_unused:UNUSED_PRESERVE src0_sel:WORD_1
s_waitcnt lgkmcnt(7)
v_mfma_f32_16x16x32_f16 v[84:87], v[0:3], v[232:235], v[84:87]
ds_read_b128 v[228:231], v249 offset:55552
ds_read_u16_d16 v200, v200
v_lshrrev_b32 v201, 18, v201
v_mfma_f32_16x16x32_f16 v[172:175], v[0:3], v[236:239], v[172:175]
v_exp_f16_sdwa v203, v204 dst_sel:WORD_1 dst_unused:UNUSED_PRESERVE src0_sel:WORD_1
v_pk_add_f16 v241, v241, 1.0 op_sel_hi:[1,0]
v_pk_add_f16 v206, v206, 1.0 op_sel_hi:[1,0]
v_mfma_f32_16x16x32_bf16 v[180:183], v[4:7], v[104:107], v[180:183]
ds_read_b128 v[0:3], v248 offset:59392
ds_read_u16_d16_hi v201, v201
v_pk_add_f16 v203, v203, 1.0 op_sel_hi:[1,0]
v_mfma_f32_16x16x32_bf16 v[188:191], v[4:7], v[108:111], v[188:191]
v_rcp_f16 v242, v241
s_waitcnt lgkmcnt(7)
v_mfma_f32_16x16x32_bf16 v[176:179], v[40:43], v[112:115], v[176:179]
ds_read_b128 v[4:7], v249 offset:56320
v_rcp_f16 v207, v206
v_mfma_f32_16x16x32_bf16 v[184:187], v[40:43], v[116:119], v[184:187]
v_rcp_f16 v204, v203
v_mfma_f32_16x16x32_bf16 v[180:183], v[44:47], v[112:115], v[180:183]
ds_read_b128 v[40:43], v248 offset:59648
v_rcp_f16_sdwa v242, v241 dst_sel:WORD_1 dst_unused:UNUSED_PRESERVE src0_sel:WORD_1
v_mfma_f32_16x16x32_bf16 v[188:191], v[44:47], v[116:119], v[188:191]
v_rcp_f16_sdwa v207, v206 dst_sel:WORD_1 dst_unused:UNUSED_PRESERVE src0_sel:WORD_1
v_or_b32 v232, v192, v193
v_or_b32 v233, v194, v195
s_waitcnt lgkmcnt(4)
v_or_b32 v234, v196, v197
v_rcp_f16_sdwa v204, v203 dst_sel:WORD_1 dst_unused:UNUSED_PRESERVE src0_sel:WORD_1
v_or_b32 v235, v198, v199
s_waitcnt lgkmcnt(2)
v_or_b32 v236, v200, v201
v_pk_mul_f16 v237, v243, v242
v_pk_mul_f16 v238, v240, v207
v_pk_mul_f16 v239, v205, v204
v_mfma_f32_16x16x32_f16 v[48:51], v[224:227], v[232:235], v[48:51]
s_add_u32 s46, s69, 98304
buffer_load_dwordx4 v[36:39], v252, s[4:7], s46 offen
ds_read_b128 v[44:47], v249 offset:56576
v_cvt_pkrtz_f16_f32 v193, v176, v177
v_cvt_pkrtz_f16_f32 v195, v178, v179
v_mfma_f32_16x16x32_f16 v[56:59], v[224:227], v[236:239], v[56:59]
v_cvt_pkrtz_f16_f32 v197, v180, v181
v_cvt_pkrtz_f16_f32 v199, v182, v183
v_mfma_f32_16x16x32_f16 v[52:55], v[228:231], v[232:235], v[52:55]
ds_read_b128 v[224:227], v248 offset:60416
v_cvt_pkrtz_f16_f32 v201, v184, v185
v_cvt_pk_f16_f32 v243, v186, v187
v_cvt_pk_f16_f32 v240, v188, v189
v_mfma_f32_16x16x32_f16 v[60:63], v[228:231], v[236:239], v[60:63]
v_cvt_pk_f16_f32 v205, v190, v191
s_setprio 1
v_pk_fma_f16 v242, v243, v243, s48
v_mfma_f32_16x16x32_bf16 v[176:179], v[0:3], v[96:99], 0
ds_read_b128 v[228:231], v249 offset:57344
v_and_b32 v193, s49, v193
v_pk_fma_f16 v207, v240, v240, s48
v_mfma_f32_16x16x32_bf16 v[184:187], v[0:3], v[100:103], 0
v_and_b32 v195, s49, v195
v_pk_fma_f16 v204, v205, v205, s48
v_lshrrev_b16 v192, 2, v193
s_waitcnt lgkmcnt(3)
v_mfma_f32_16x16x32_f16 v[64:67], v[4:7], v[232:235], v[64:67]
ds_read_b128 v[0:3], v249 offset:57600
ds_read_u16_d16 v192, v192
v_pk_mul_f16 v242, v243, v242
v_lshrrev_b16 v194, 2, v195
v_mfma_f32_16x16x32_f16 v[72:75], v[4:7], v[236:239], v[72:75]
v_pk_mul_f16 v207, v240, v207
v_lshrrev_b32 v193, 18, v193
v_mfma_f32_16x16x32_bf16 v[180:183], v[40:43], v[96:99], 0
ds_read_b128 v[4:7], v248 offset:60672
ds_read_u16_d16 v194, v194
ds_read_u16_d16_hi v193, v193
v_pk_mul_f16 v204, v205, v204
v_lshrrev_b32 v195, 18, v195
v_mfma_f32_16x16x32_bf16 v[188:191], v[40:43], v[100:103], 0
v_exp_f16 v241, v242
v_and_b32 v197, s49, v197
s_waitcnt lgkmcnt(5)
v_mfma_f32_16x16x32_f16 v[68:71], v[44:47], v[232:235], v[68:71]
ds_read_b128 v[40:43], v248 offset:61440
ds_read_u16_d16_hi v195, v195
v_and_b32 v199, s49, v199
v_mfma_f32_16x16x32_f16 v[76:79], v[44:47], v[236:239], v[76:79]
v_exp_f16 v206, v207
v_lshrrev_b16 v196, 2, v197
v_lshrrev_b16 v198, 2, v199
v_mfma_f32_16x16x32_bf16 v[176:179], v[224:227], v[104:107], v[176:179]
buffer_store_dwordx4 v[152:155], v255, s[8:11], s68 offen offset:256 sc1
ds_read_b128 v[44:47], v248 offset:61696
ds_read_u16_d16 v196, v196
ds_read_u16_d16 v198, v198
v_exp_f16 v203, v204
v_mfma_f32_16x16x32_bf16 v[184:187], v[224:227], v[108:111], v[184:187]
v_lshrrev_b32 v197, 18, v197
v_lshrrev_b32 v199, 18, v199
v_mfma_f32_16x16x32_f16 v[80:83], v[228:231], v[232:235], v[80:83]
ds_read_b128 v[224:227], v249 offset:61440
ds_read_u16_d16_hi v197, v197
ds_read_u16_d16_hi v199, v199
v_exp_f16_sdwa v241, v242 dst_sel:WORD_1 dst_unused:UNUSED_PRESERVE src0_sel:WORD_1
v_and_b32 v201, s49, v201
v_mfma_f32_16x16x32_f16 v[168:171], v[228:231], v[236:239], v[168:171]
v_lshrrev_b16 v200, 2, v201
s_waitcnt lgkmcnt(8)
v_mfma_f32_16x16x32_f16 v[84:87], v[0:3], v[232:235], v[84:87]
ds_read_b128 v[228:231], v249 offset:61696
ds_read_u16_d16 v200, v200
v_exp_f16_sdwa v206, v207 dst_sel:WORD_1 dst_unused:UNUSED_PRESERVE src0_sel:WORD_1
v_lshrrev_b32 v201, 18, v201
v_mfma_f32_16x16x32_f16 v[172:175], v[0:3], v[236:239], v[172:175]
v_exp_f16_sdwa v203, v204 dst_sel:WORD_1 dst_unused:UNUSED_PRESERVE src0_sel:WORD_1
v_pk_add_f16 v241, v241, 1.0 op_sel_hi:[1,0]
v_mfma_f32_16x16x32_bf16 v[180:183], v[4:7], v[104:107], v[180:183]
ds_read_b128 v[0:3], v249
ds_read_u16_d16_hi v201, v201
v_pk_add_f16 v206, v206, 1.0 op_sel_hi:[1,0]
v_pk_add_f16 v203, v203, 1.0 op_sel_hi:[1,0]
v_mfma_f32_16x16x32_bf16 v[188:191], v[4:7], v[108:111], v[188:191]
v_rcp_f16 v242, v241
s_setprio 0
s_waitcnt lgkmcnt(7)
v_mfma_f32_16x16x32_bf16 v[176:179], v[40:43], v[112:115], v[176:179]
ds_read_b128 v[4:7], v249 offset:62464
v_rcp_f16 v207, v206
v_mfma_f32_16x16x32_bf16 v[184:187], v[40:43], v[116:119], v[184:187]
v_rcp_f16 v204, v203
v_mfma_f32_16x16x32_bf16 v[180:183], v[44:47], v[112:115], v[180:183]
ds_read_b128 v[40:43], v249 offset:256
v_rcp_f16_sdwa v242, v241 dst_sel:WORD_1 dst_unused:UNUSED_PRESERVE src0_sel:WORD_1
v_mfma_f32_16x16x32_bf16 v[188:191], v[44:47], v[116:119], v[188:191]
v_rcp_f16_sdwa v207, v206 dst_sel:WORD_1 dst_unused:UNUSED_PRESERVE src0_sel:WORD_1
v_or_b32 v232, v192, v193
v_or_b32 v233, v194, v195
s_waitcnt lgkmcnt(4)
v_or_b32 v234, v196, v197
v_rcp_f16_sdwa v204, v203 dst_sel:WORD_1 dst_unused:UNUSED_PRESERVE src0_sel:WORD_1
v_or_b32 v235, v198, v199
s_waitcnt lgkmcnt(2)
v_or_b32 v236, v200, v201
v_pk_mul_f16 v237, v243, v242
v_pk_mul_f16 v238, v240, v207
v_pk_mul_f16 v239, v205, v204
v_mfma_f32_16x16x32_f16 v[48:51], v[224:227], v[232:235], v[48:51]
s_add_u32 s46, s69, 98304
buffer_load_dwordx4 v[32:35], v252, s[4:7], s46 offen offset:64
ds_read_b128 v[44:47], v249 offset:62720
v_cvt_pkrtz_f16_f32 v193, v176, v177
v_cvt_pkrtz_f16_f32 v195, v178, v179
v_mfma_f32_16x16x32_f16 v[56:59], v[224:227], v[236:239], v[56:59]
v_cvt_pkrtz_f16_f32 v197, v180, v181
v_cvt_pkrtz_f16_f32 v199, v182, v183
v_mfma_f32_16x16x32_f16 v[52:55], v[228:231], v[232:235], v[52:55]
ds_read_b128 v[224:227], v249 offset:1024
v_cvt_pkrtz_f16_f32 v201, v184, v185
v_cvt_pk_f16_f32 v243, v186, v187
v_mfma_f32_16x16x32_f16 v[60:63], v[228:231], v[236:239], v[60:63]
v_cvt_pk_f16_f32 v240, v188, v189
v_cvt_pk_f16_f32 v205, v190, v191
v_mfma_f32_16x16x32_bf16 v[176:179], v[0:3], v[96:99], 0
ds_read_b128 v[228:231], v249 offset:63488
v_pk_fma_f16 v242, v243, v243, s48
v_and_b32 v193, s49, v193
v_mfma_f32_16x16x32_bf16 v[184:187], v[0:3], v[100:103], 0
v_pk_fma_f16 v207, v240, v240, s48
v_and_b32 v195, s49, v195
s_waitcnt lgkmcnt(3)
v_mfma_f32_16x16x32_f16 v[64:67], v[4:7], v[232:235], v[64:67]
ds_read_b128 v[0:3], v249 offset:63744
v_pk_fma_f16 v204, v205, v205, s48
v_lshrrev_b16 v192, 2, v193
v_mfma_f32_16x16x32_f16 v[72:75], v[4:7], v[236:239], v[72:75]
v_pk_mul_f16 v242, v243, v242
v_lshrrev_b16 v194, 2, v195
s_waitcnt vmcnt(8)
v_mfma_f32_16x16x32_bf16 v[160:163], v[26:29], v[216:219], v[160:163]
ds_read_b128 v[4:7], v249 offset:1280
ds_read_u16_d16 v192, v192
ds_read_u16_d16 v194, v194
v_pk_mul_f16 v207, v240, v207
v_lshrrev_b32 v193, 18, v193
v_mfma_f32_16x16x32_bf16 v[164:167], v[24:27], v[216:219], v[164:167]
v_pk_mul_f16 v204, v205, v204
v_lshrrev_b32 v195, 18, v195
v_mfma_f32_16x16x32_bf16 v[180:183], v[40:43], v[96:99], 0
ds_read_u16_d16_hi v193, v193
ds_read_u16_d16_hi v195, v195
v_exp_f16 v241, v242
v_mfma_f32_16x16x32_bf16 v[188:191], v[40:43], v[100:103], 0
v_and_b32 v197, s49, v197
v_and_b32 v199, s49, v199
s_waitcnt lgkmcnt(6)
v_mfma_f32_16x16x32_f16 v[68:71], v[44:47], v[232:235], v[68:71]
ds_read_b128 v[40:43], v249 offset:2048
v_exp_f16 v206, v207
v_mfma_f32_16x16x32_f16 v[76:79], v[44:47], v[236:239], v[76:79]
v_lshrrev_b16 v196, 2, v197
v_lshrrev_b16 v198, 2, v199
v_mfma_f32_16x16x32_bf16 v[176:179], v[224:227], v[104:107], v[176:179]
ds_read_b128 v[44:47], v249 offset:2304
ds_read_u16_d16 v196, v196
ds_read_u16_d16 v198, v198
v_exp_f16 v203, v204
v_mfma_f32_16x16x32_bf16 v[184:187], v[224:227], v[108:111], v[184:187]
v_lshrrev_b32 v197, 18, v197
v_lshrrev_b32 v199, 18, v199
v_mfma_f32_16x16x32_f16 v[80:83], v[228:231], v[232:235], v[80:83]
ds_read_b128 v[224:227], v250 offset:2048
ds_read_u16_d16_hi v197, v197
ds_read_u16_d16_hi v199, v199
v_exp_f16_sdwa v241, v242 dst_sel:WORD_1 dst_unused:UNUSED_PRESERVE src0_sel:WORD_1
v_mfma_f32_16x16x32_f16 v[168:171], v[228:231], v[236:239], v[168:171]
v_and_b32 v201, s49, v201
v_lshrrev_b16 v200, 2, v201
s_waitcnt lgkmcnt(7)
v_mfma_f32_16x16x32_f16 v[84:87], v[0:3], v[232:235], v[84:87]
ds_read_b128 v[228:231], v250 offset:2304
ds_read_u16_d16 v200, v200
v_exp_f16_sdwa v206, v207 dst_sel:WORD_1 dst_unused:UNUSED_PRESERVE src0_sel:WORD_1
v_mfma_f32_16x16x32_f16 v[172:175], v[0:3], v[236:239], v[172:175]
v_lshrrev_b32 v201, 18, v201
s_waitcnt vmcnt(7)
v_mfma_f32_16x16x32_bf16 v[48:51], v[26:29], v[12:15], v[48:51]
ds_read_b128 v[0:3], v249 offset:6144
ds_read_u16_d16_hi v201, v201
v_exp_f16_sdwa v203, v204 dst_sel:WORD_1 dst_unused:UNUSED_PRESERVE src0_sel:WORD_1
v_pk_add_f16 v241, v241, 1.0 op_sel_hi:[1,0]
v_mfma_f32_16x16x32_bf16 v[52:55], v[24:27], v[12:15], v[52:55]
v_pk_add_f16 v206, v206, 1.0 op_sel_hi:[1,0]
v_pk_add_f16 v203, v203, 1.0 op_sel_hi:[1,0]
v_mfma_f32_16x16x32_bf16 v[180:183], v[4:7], v[104:107], v[180:183]
v_rcp_f16 v242, v241
v_mfma_f32_16x16x32_bf16 v[188:191], v[4:7], v[108:111], v[188:191]
v_rcp_f16 v207, v206
s_waitcnt lgkmcnt(4)
v_mfma_f32_16x16x32_bf16 v[176:179], v[40:43], v[112:115], v[176:179]
ds_read_b128 v[4:7], v250 offset:3072
v_rcp_f16 v204, v203
v_mfma_f32_16x16x32_bf16 v[184:187], v[40:43], v[116:119], v[184:187]
v_rcp_f16_sdwa v242, v241 dst_sel:WORD_1 dst_unused:UNUSED_PRESERVE src0_sel:WORD_1
v_mfma_f32_16x16x32_bf16 v[180:183], v[44:47], v[112:115], v[180:183]
ds_read_b128 v[40:43], v249 offset:6400
v_rcp_f16_sdwa v207, v206 dst_sel:WORD_1 dst_unused:UNUSED_PRESERVE src0_sel:WORD_1
v_mfma_f32_16x16x32_bf16 v[188:191], v[44:47], v[116:119], v[188:191]
v_or_b32 v232, v192, v193
v_or_b32 v233, v194, v195
v_or_b32 v234, v196, v197
v_rcp_f16_sdwa v204, v203 dst_sel:WORD_1 dst_unused:UNUSED_PRESERVE src0_sel:WORD_1
v_or_b32 v235, v198, v199
s_waitcnt lgkmcnt(2)
v_or_b32 v236, v200, v201
v_pk_mul_f16 v237, v243, v242
v_pk_mul_f16 v238, v240, v207
v_pk_mul_f16 v239, v205, v204
v_mfma_f32_16x16x32_f16 v[48:51], v[224:227], v[232:235], v[48:51]
s_add_u32 s46, s69, 98304
buffer_load_dwordx4 v[216:219], v252, s[4:7], s46 offen offset:128
ds_read_b128 v[44:47], v250 offset:3328
v_cvt_pkrtz_f16_f32 v193, v176, v177
v_cvt_pkrtz_f16_f32 v195, v178, v179
v_mfma_f32_16x16x32_f16 v[56:59], v[224:227], v[236:239], v[56:59]
v_cvt_pkrtz_f16_f32 v197, v180, v181
v_cvt_pkrtz_f16_f32 v199, v182, v183
v_cvt_pkrtz_f16_f32 v201, v184, v185
v_mfma_f32_16x16x32_f16 v[52:55], v[228:231], v[232:235], v[52:55]
ds_read_b128 v[224:227], v249 offset:7168
v_cvt_pkrtz_f16_f32 v203, v186, v187
v_cvt_pk_f16_f32 v243, v188, v189
v_cvt_pk_f16_f32 v240, v190, v191
v_mfma_f32_16x16x32_f16 v[60:63], v[228:231], v[236:239], v[60:63]
v_pk_fma_f16 v242, v243, v243, s48
v_cvt_pk_bf16_f32 v144, v144, v145
v_and_b32 v193, s49, v193
v_mfma_f32_16x16x32_bf16 v[176:179], v[0:3], v[96:99], 0
ds_read_b128 v[228:231], v250 offset:4096
v_cvt_pk_bf16_f32 v145, v146, v147
v_and_b32 v195, s49, v195
v_mfma_f32_16x16x32_bf16 v[184:187], v[0:3], v[100:103], 0
v_cvt_pk_bf16_f32 v146, v148, v149
v_pk_fma_f16 v207, v240, v240, s48
v_lshrrev_b16 v192, 2, v193
s_waitcnt lgkmcnt(3)
v_mfma_f32_16x16x32_f16 v[64:67], v[4:7], v[232:235], v[64:67]
ds_read_b128 v[0:3], v250 offset:4352
ds_read_u16_d16 v192, v192
v_cvt_pk_bf16_f32 v147, v150, v151
v_pk_mul_f16 v242, v243, v242
v_cvt_pk_bf16_f32 v128, v128, v129
v_mfma_f32_16x16x32_f16 v[72:75], v[4:7], v[236:239], v[72:75]
v_lshrrev_b16 v194, 2, v195
v_cvt_pk_bf16_f32 v129, v130, v131
v_pk_mul_f16 v207, v240, v207
s_waitcnt vmcnt(6)
v_mfma_f32_16x16x32_bf16 v[64:67], v[26:29], v[244:247], v[64:67]
ds_read_b128 v[4:7], v249 offset:7424
ds_read_u16_d16 v194, v194
v_lshrrev_b32 v193, 18, v193
v_cvt_pk_bf16_f32 v130, v132, v133
v_mfma_f32_16x16x32_bf16 v[68:71], v[24:27], v[244:247], v[68:71]
v_exp_f16 v241, v242
v_cvt_pk_bf16_f32 v131, v134, v135
v_mfma_f32_16x16x32_bf16 v[180:183], v[40:43], v[96:99], 0
ds_read_u16_d16_hi v193, v193
v_lshrrev_b32 v195, 18, v195
v_cvt_pk_bf16_f32 v160, v160, v161
v_and_b32 v197, s49, v197
v_mfma_f32_16x16x32_bf16 v[188:191], v[40:43], v[100:103], 0
v_cvt_pk_bf16_f32 v161, v162, v163
v_exp_f16 v206, v207
s_waitcnt lgkmcnt(3)
v_mfma_f32_16x16x32_f16 v[68:71], v[44:47], v[232:235], v[68:71]
ds_read_b128 v[40:43], v249 offset:8192
ds_read_u16_d16_hi v195, v195
v_cvt_pk_bf16_f32 v162, v164, v165
v_and_b32 v199, s49, v199
v_mfma_f32_16x16x32_f16 v[76:79], v[44:47], v[236:239], v[76:79]
v_cvt_pk_bf16_f32 v163, v166, v167
s_mov_b64 vcc, s[74:75]
v_lshrrev_b16 v196, 2, v197
v_cndmask_b32_e64 v148, v128, v160, s[74:75]
v_mfma_f32_16x16x32_bf16 v[176:179], v[224:227], v[104:107], v[176:179]
ds_read_b128 v[44:47], v249 offset:8448
ds_read_u16_d16 v196, v196
v_exp_f16_sdwa v241, v242 dst_sel:WORD_1 dst_unused:UNUSED_PRESERVE src0_sel:WORD_1
v_cndmask_b32_dpp v128, v144, v128, vcc quad_perm:[1,0,3,2] row_mask:0xf bank_mask:0xf
v_mfma_f32_16x16x32_bf16 v[184:187], v[224:227], v[108:111], v[184:187]
v_lshrrev_b16 v198, 2, v199
v_cndmask_b32_e64 v149, v129, v161, s[74:75]
v_lshrrev_b32 v197, 18, v197
v_mfma_f32_16x16x32_f16 v[80:83], v[228:231], v[232:235], v[80:83]
ds_read_b128 v[224:227], v250 offset:8192
ds_read_u16_d16 v198, v198
ds_read_u16_d16_hi v197, v197
v_cndmask_b32_dpp v129, v145, v129, vcc quad_perm:[1,0,3,2] row_mask:0xf bank_mask:0xf
v_lshrrev_b32 v199, 18, v199
v_mfma_f32_16x16x32_f16 v[168:171], v[228:231], v[236:239], v[168:171]
v_exp_f16_sdwa v206, v207 dst_sel:WORD_1 dst_unused:UNUSED_PRESERVE src0_sel:WORD_1
v_cndmask_b32_e64 v150, v130, v162, s[74:75]
v_mfma_f32_16x16x32_f16 v[84:87], v[0:3], v[232:235], v[84:87]
ds_read_b128 v[228:231], v250 offset:8448
ds_read_u16_d16_hi v199, v199
v_cndmask_b32_dpp v130, v146, v130, vcc quad_perm:[1,0,3,2] row_mask:0xf bank_mask:0xf
v_and_b32 v201, s49, v201
v_cndmask_b32_e64 v151, v131, v163, s[74:75]
v_mfma_f32_16x16x32_f16 v[172:175], v[0:3], v[236:239], v[172:175]
v_and_b32 v203, s49, v203
v_pk_add_f16 v241, v241, 1.0 op_sel_hi:[1,0]
v_cndmask_b32_dpp v131, v147, v131, vcc quad_perm:[1,0,3,2] row_mask:0xf bank_mask:0xf
s_not_b64 vcc, s[74:75]
s_waitcnt lgkmcnt(5)
v_mfma_f32_16x16x32_bf16 v[180:183], v[4:7], v[104:107], v[180:183]
ds_read_b128 v[0:3], v249 offset:12288
v_lshrrev_b16 v200, 2, v201
v_cndmask_b32_dpp v160, v144, v160, vcc quad_perm:[1,0,3,2] row_mask:0xf bank_mask:0xf
v_pk_add_f16 v206, v206, 1.0 op_sel_hi:[1,0]
v_mfma_f32_16x16x32_bf16 v[188:191], v[4:7], v[108:111], v[188:191]
v_cndmask_b32_dpp v161, v145, v161, vcc quad_perm:[1,0,3,2] row_mask:0xf bank_mask:0xf
v_lshrrev_b16 v202, 2, v203
v_mfma_f32_16x16x32_bf16 v[176:179], v[40:43], v[112:115], v[176:179]
ds_read_b128 v[4:7], v250 offset:9216
ds_read_u16_d16 v200, v200
ds_read_u16_d16 v202, v202
v_rcp_f16 v242, v241
v_cndmask_b32_dpp v162, v146, v162, vcc quad_perm:[1,0,3,2] row_mask:0xf bank_mask:0xf
v_mfma_f32_16x16x32_bf16 v[184:187], v[40:43], v[116:119], v[184:187]
v_cndmask_b32_dpp v163, v147, v163, vcc quad_perm:[1,0,3,2] row_mask:0xf bank_mask:0xf
v_lshrrev_b32 v201, 18, v201
v_lshrrev_b32 v203, 18, v203
v_mfma_f32_16x16x32_bf16 v[180:183], v[44:47], v[112:115], v[180:183]
ds_read_b128 v[40:43], v249 offset:12544
s_add_u32 s46, s68, 98304
buffer_store_dwordx4 v[128:131], v255, s[8:11], s46 offen sc1
ds_read_u16_d16_hi v201, v201
ds_read_u16_d16_hi v203, v203
v_rcp_f16 v207, v206
v_mfma_f32_16x16x32_bf16 v[188:191], v[44:47], v[116:119], v[188:191]
v_rcp_f16_sdwa v242, v241 dst_sel:WORD_1 dst_unused:UNUSED_PRESERVE src0_sel:WORD_1
v_or_b32 v232, v192, v193
v_or_b32 v233, v194, v195
s_waitcnt lgkmcnt(6)
v_or_b32 v234, v196, v197
v_rcp_f16_sdwa v207, v206 dst_sel:WORD_1 dst_unused:UNUSED_PRESERVE src0_sel:WORD_1
v_or_b32 v235, v198, v199
s_waitcnt lgkmcnt(1)
v_or_b32 v236, v200, v201
s_waitcnt lgkmcnt(0)
v_or_b32 v237, v202, v203
v_pk_mul_f16 v238, v243, v242
v_pk_mul_f16 v239, v240, v207
v_mfma_f32_16x16x32_f16 v[48:51], v[224:227], v[232:235], v[48:51]
s_add_u32 s46, s68, 98304
buffer_store_dwordx4 v[148:151], v255, s[8:11], s46 offen offset:128 sc1
ds_read_b128 v[44:47], v250 offset:9472
v_cvt_pkrtz_f16_f32 v193, v176, v177
v_cvt_pkrtz_f16_f32 v195, v178, v179
v_mfma_f32_16x16x32_f16 v[56:59], v[224:227], v[236:239], v[56:59]
v_cvt_pkrtz_f16_f32 v197, v180, v181
v_cvt_pkrtz_f16_f32 v199, v182, v183
v_mfma_f32_16x16x32_f16 v[52:55], v[228:231], v[232:235], v[52:55]
ds_read_b128 v[224:227], v249 offset:13312
v_cvt_pkrtz_f16_f32 v201, v184, v185
v_cvt_pk_f16_f32 v243, v186, v187
v_mfma_f32_16x16x32_f16 v[60:63], v[228:231], v[236:239], v[60:63]
v_cvt_pk_f16_f32 v240, v188, v189
v_cvt_pk_f16_f32 v205, v190, v191
v_mfma_f32_16x16x32_bf16 v[176:179], v[0:3], v[96:99], 0
ds_read_b128 v[228:231], v250 offset:10240
v_pk_fma_f16 v242, v243, v243, s48
v_and_b32 v193, s49, v193
v_mfma_f32_16x16x32_bf16 v[184:187], v[0:3], v[100:103], 0
v_pk_fma_f16 v207, v240, v240, s48
v_and_b32 v195, s49, v195
v_mfma_f32_16x16x32_f16 v[64:67], v[4:7], v[232:235], v[64:67]
ds_read_b128 v[0:3], v250 offset:10496
v_pk_fma_f16 v204, v205, v205, s48
v_lshrrev_b16 v192, 2, v193
v_pk_mul_f16 v242, v243, v242
v_mfma_f32_16x16x32_f16 v[72:75], v[4:7], v[236:239], v[72:75]
v_lshrrev_b16 v194, 2, v195
v_pk_mul_f16 v207, v240, v207
s_waitcnt vmcnt(6)
v_mfma_f32_16x16x32_bf16 v[80:83], v[26:29], v[8:11], v[80:83]
ds_read_b128 v[4:7], v249 offset:13568
ds_read_u16_d16 v192, v192
ds_read_u16_d16 v194, v194
v_lshrrev_b32 v193, 18, v193
v_pk_mul_f16 v204, v205, v204
v_mfma_f32_16x16x32_bf16 v[84:87], v[24:27], v[8:11], v[84:87]
v_lshrrev_b32 v195, 18, v195
v_mfma_f32_16x16x32_bf16 v[180:183], v[40:43], v[96:99], 0
ds_read_u16_d16_hi v193, v193
ds_read_u16_d16_hi v195, v195
v_exp_f16 v241, v242
v_and_b32 v197, s49, v197
v_mfma_f32_16x16x32_bf16 v[188:191], v[40:43], v[100:103], 0
v_and_b32 v199, s49, v199
s_waitcnt lgkmcnt(6)
v_mfma_f32_16x16x32_f16 v[68:71], v[44:47], v[232:235], v[68:71]
ds_read_b128 v[40:43], v249 offset:14336
v_exp_f16 v206, v207
v_lshrrev_b16 v196, 2, v197
v_mfma_f32_16x16x32_f16 v[76:79], v[44:47], v[236:239], v[76:79]
v_lshrrev_b16 v198, 2, v199
v_exp_f16 v203, v204
v_mfma_f32_16x16x32_bf16 v[176:179], v[224:227], v[104:107], v[176:179]
ds_read_b128 v[44:47], v249 offset:14592
ds_read_u16_d16 v196, v196
ds_read_u16_d16 v198, v198
v_lshrrev_b32 v197, 18, v197
v_lshrrev_b32 v199, 18, v199
v_mfma_f32_16x16x32_bf16 v[184:187], v[224:227], v[108:111], v[184:187]
v_exp_f16_sdwa v241, v242 dst_sel:WORD_1 dst_unused:UNUSED_PRESERVE src0_sel:WORD_1
v_mfma_f32_16x16x32_f16 v[80:83], v[228:231], v[232:235], v[80:83]
ds_read_b128 v[224:227], v250 offset:14336
ds_read_u16_d16_hi v197, v197
ds_read_u16_d16_hi v199, v199
v_and_b32 v201, s49, v201
v_lshrrev_b16 v200, 2, v201
v_mfma_f32_16x16x32_f16 v[168:171], v[228:231], v[236:239], v[168:171]
v_exp_f16_sdwa v206, v207 dst_sel:WORD_1 dst_unused:UNUSED_PRESERVE src0_sel:WORD_1
s_waitcnt lgkmcnt(7)
v_mfma_f32_16x16x32_f16 v[84:87], v[0:3], v[232:235], v[84:87]
ds_read_b128 v[228:231], v250 offset:14592
ds_read_u16_d16 v200, v200
v_lshrrev_b32 v201, 18, v201
v_mfma_f32_16x16x32_f16 v[172:175], v[0:3], v[236:239], v[172:175]
v_exp_f16_sdwa v203, v204 dst_sel:WORD_1 dst_unused:UNUSED_PRESERVE src0_sel:WORD_1
v_pk_add_f16 v241, v241, 1.0 op_sel_hi:[1,0]
v_pk_add_f16 v206, v206, 1.0 op_sel_hi:[1,0]
v_mfma_f32_16x16x32_bf16 v[180:183], v[4:7], v[104:107], v[180:183]
ds_read_b128 v[0:3], v249 offset:18432
ds_read_u16_d16_hi v201, v201
v_pk_add_f16 v203, v203, 1.0 op_sel_hi:[1,0]
v_mfma_f32_16x16x32_bf16 v[188:191], v[4:7], v[108:111], v[188:191]
v_rcp_f16 v242, v241
s_waitcnt lgkmcnt(7)
v_mfma_f32_16x16x32_bf16 v[176:179], v[40:43], v[112:115], v[176:179]
ds_read_b128 v[4:7], v250 offset:15360
v_rcp_f16 v207, v206
v_mfma_f32_16x16x32_bf16 v[184:187], v[40:43], v[116:119], v[184:187]
v_rcp_f16 v204, v203
v_mfma_f32_16x16x32_bf16 v[180:183], v[44:47], v[112:115], v[180:183]
ds_read_b128 v[40:43], v249 offset:18688
v_rcp_f16_sdwa v242, v241 dst_sel:WORD_1 dst_unused:UNUSED_PRESERVE src0_sel:WORD_1
v_mfma_f32_16x16x32_bf16 v[188:191], v[44:47], v[116:119], v[188:191]
v_rcp_f16_sdwa v207, v206 dst_sel:WORD_1 dst_unused:UNUSED_PRESERVE src0_sel:WORD_1
v_or_b32 v232, v192, v193
v_or_b32 v233, v194, v195
s_waitcnt lgkmcnt(4)
v_or_b32 v234, v196, v197
v_rcp_f16_sdwa v204, v203 dst_sel:WORD_1 dst_unused:UNUSED_PRESERVE src0_sel:WORD_1
v_or_b32 v235, v198, v199
s_waitcnt lgkmcnt(2)
v_or_b32 v236, v200, v201
v_pk_mul_f16 v237, v243, v242
v_pk_mul_f16 v238, v240, v207
v_pk_mul_f16 v239, v205, v204
v_mfma_f32_16x16x32_f16 v[48:51], v[224:227], v[232:235], v[48:51]
ds_read_b128 v[44:47], v250 offset:15616
v_cvt_pkrtz_f16_f32 v193, v176, v177
v_cvt_pkrtz_f16_f32 v195, v178, v179
v_mfma_f32_16x16x32_f16 v[56:59], v[224:227], v[236:239], v[56:59]
v_cvt_pkrtz_f16_f32 v197, v180, v181
v_cvt_pkrtz_f16_f32 v199, v182, v183
v_mfma_f32_16x16x32_f16 v[52:55], v[228:231], v[232:235], v[52:55]
ds_read_b128 v[224:227], v249 offset:19456
v_cvt_pkrtz_f16_f32 v201, v184, v185
v_cvt_pk_f16_f32 v243, v186, v187
v_mfma_f32_16x16x32_f16 v[60:63], v[228:231], v[236:239], v[60:63]
v_cvt_pk_f16_f32 v240, v188, v189
v_cvt_pk_f16_f32 v205, v190, v191
v_mfma_f32_16x16x32_bf16 v[176:179], v[0:3], v[96:99], 0
ds_read_b128 v[228:231], v250 offset:16384
v_pk_fma_f16 v242, v243, v243, s48
v_and_b32 v193, s49, v193
v_mfma_f32_16x16x32_bf16 v[184:187], v[0:3], v[100:103], 0
v_pk_fma_f16 v207, v240, v240, s48
v_and_b32 v195, s49, v195
s_waitcnt lgkmcnt(3)
v_mfma_f32_16x16x32_f16 v[64:67], v[4:7], v[232:235], v[64:67]
ds_read_b128 v[0:3], v250 offset:16640
v_pk_fma_f16 v204, v205, v205, s48
v_lshrrev_b16 v192, 2, v193
v_pk_mul_f16 v242, v243, v242
v_mfma_f32_16x16x32_f16 v[72:75], v[4:7], v[236:239], v[72:75]
v_lshrrev_b16 v194, 2, v195
v_pk_mul_f16 v207, v240, v207
s_waitcnt vmcnt(5)
v_mfma_f32_16x16x32_bf16 v[56:59], v[26:29], v[36:39], v[56:59]
ds_read_b128 v[4:7], v249 offset:19712
ds_read_u16_d16 v192, v192
ds_read_u16_d16 v194, v194
v_lshrrev_b32 v193, 18, v193
v_pk_mul_f16 v204, v205, v204
v_mfma_f32_16x16x32_bf16 v[60:63], v[24:27], v[36:39], v[60:63]
v_lshrrev_b32 v195, 18, v195
v_mfma_f32_16x16x32_bf16 v[180:183], v[40:43], v[96:99], 0
ds_read_u16_d16_hi v193, v193
ds_read_u16_d16_hi v195, v195
v_exp_f16 v241, v242
v_and_b32 v197, s49, v197
v_mfma_f32_16x16x32_bf16 v[188:191], v[40:43], v[100:103], 0
v_and_b32 v199, s49, v199
s_waitcnt lgkmcnt(6)
v_mfma_f32_16x16x32_f16 v[68:71], v[44:47], v[232:235], v[68:71]
ds_read_b128 v[40:43], v249 offset:20480
v_exp_f16 v206, v207
v_lshrrev_b16 v196, 2, v197
v_mfma_f32_16x16x32_f16 v[76:79], v[44:47], v[236:239], v[76:79]
v_lshrrev_b16 v198, 2, v199
v_exp_f16 v203, v204
v_mfma_f32_16x16x32_bf16 v[176:179], v[224:227], v[104:107], v[176:179]
ds_read_b128 v[44:47], v249 offset:20736
ds_read_u16_d16 v196, v196
ds_read_u16_d16 v198, v198
v_lshrrev_b32 v197, 18, v197
v_lshrrev_b32 v199, 18, v199
v_mfma_f32_16x16x32_bf16 v[184:187], v[224:227], v[108:111], v[184:187]
v_exp_f16_sdwa v241, v242 dst_sel:WORD_1 dst_unused:UNUSED_PRESERVE src0_sel:WORD_1
v_mfma_f32_16x16x32_f16 v[80:83], v[228:231], v[232:235], v[80:83]
ds_read_b128 v[224:227], v250 offset:20480
ds_read_u16_d16_hi v197, v197
ds_read_u16_d16_hi v199, v199
v_and_b32 v201, s49, v201
v_lshrrev_b16 v200, 2, v201
v_mfma_f32_16x16x32_f16 v[168:171], v[228:231], v[236:239], v[168:171]
v_exp_f16_sdwa v206, v207 dst_sel:WORD_1 dst_unused:UNUSED_PRESERVE src0_sel:WORD_1
s_waitcnt lgkmcnt(7)
v_mfma_f32_16x16x32_f16 v[84:87], v[0:3], v[232:235], v[84:87]
ds_read_b128 v[228:231], v250 offset:20736
ds_read_u16_d16 v200, v200
v_lshrrev_b32 v201, 18, v201
v_mfma_f32_16x16x32_f16 v[172:175], v[0:3], v[236:239], v[172:175]
v_exp_f16_sdwa v203, v204 dst_sel:WORD_1 dst_unused:UNUSED_PRESERVE src0_sel:WORD_1
v_pk_add_f16 v241, v241, 1.0 op_sel_hi:[1,0]
v_pk_add_f16 v206, v206, 1.0 op_sel_hi:[1,0]
v_mfma_f32_16x16x32_bf16 v[180:183], v[4:7], v[104:107], v[180:183]
ds_read_b128 v[0:3], v250 offset:21504
ds_read_u16_d16_hi v201, v201
v_pk_add_f16 v203, v203, 1.0 op_sel_hi:[1,0]
v_mfma_f32_16x16x32_bf16 v[188:191], v[4:7], v[108:111], v[188:191]
v_rcp_f16 v242, v241
s_waitcnt lgkmcnt(7)
v_mfma_f32_16x16x32_bf16 v[176:179], v[40:43], v[112:115], v[176:179]
ds_read_b128 v[4:7], v250 offset:21760
v_rcp_f16 v207, v206
v_mfma_f32_16x16x32_bf16 v[184:187], v[40:43], v[116:119], v[184:187]
v_rcp_f16 v204, v203
v_mfma_f32_16x16x32_bf16 v[180:183], v[44:47], v[112:115], v[180:183]
ds_read_b128 v[40:43], v250 offset:22528
v_rcp_f16_sdwa v242, v241 dst_sel:WORD_1 dst_unused:UNUSED_PRESERVE src0_sel:WORD_1
v_mfma_f32_16x16x32_bf16 v[188:191], v[44:47], v[116:119], v[188:191]
v_rcp_f16_sdwa v207, v206 dst_sel:WORD_1 dst_unused:UNUSED_PRESERVE src0_sel:WORD_1
v_or_b32 v232, v192, v193
v_or_b32 v233, v194, v195
s_waitcnt lgkmcnt(4)
v_or_b32 v234, v196, v197
v_rcp_f16_sdwa v204, v203 dst_sel:WORD_1 dst_unused:UNUSED_PRESERVE src0_sel:WORD_1
v_or_b32 v235, v198, v199
s_waitcnt lgkmcnt(2)
v_or_b32 v236, v200, v201
v_pk_mul_f16 v237, v243, v242
v_pk_mul_f16 v238, v240, v207
v_pk_mul_f16 v239, v205, v204
v_mfma_f32_16x16x32_f16 v[48:51], v[224:227], v[232:235], v[48:51]
s_add_u32 s46, s68, 98304
buffer_store_dwordx4 v[160:163], v255, s[8:11], s46 offen offset:256 sc1
ds_read_b128 v[44:47], v250 offset:22784
v_cvt_pkrtz_f16_f32 v193, v176, v177
v_cvt_pkrtz_f16_f32 v195, v178, v179
v_cvt_pkrtz_f16_f32 v197, v180, v181
v_cvt_pkrtz_f16_f32 v199, v182, v183
v_mfma_f32_16x16x32_f16 v[56:59], v[224:227], v[236:239], v[56:59]
v_cvt_pkrtz_f16_f32 v201, v184, v185
v_cvt_pk_f16_f32 v243, v186, v187
v_cvt_pk_f16_f32 v240, v188, v189
v_cvt_pk_f16_f32 v205, v190, v191
v_mfma_f32_16x16x32_f16 v[52:55], v[228:231], v[232:235], v[52:55]
ds_read_b128 v[224:227], v250 offset:26624
v_pk_fma_f16 v242, v243, v243, s48
v_and_b32 v193, s49, v193
v_pk_fma_f16 v207, v240, v240, s48
v_and_b32 v195, s49, v195
v_mfma_f32_16x16x32_f16 v[60:63], v[228:231], v[236:239], v[60:63]
v_pk_fma_f16 v204, v205, v205, s48
v_lshrrev_b16 v192, 2, v193
v_pk_mul_f16 v242, v243, v242
v_lshrrev_b16 v194, 2, v195
v_mfma_f32_16x16x32_f16 v[64:67], v[0:3], v[232:235], v[64:67]
ds_read_b128 v[228:231], v250 offset:26880
ds_read_u16_d16 v192, v192
ds_read_u16_d16 v194, v194
v_pk_mul_f16 v207, v240, v207
v_lshrrev_b32 v193, 18, v193
v_pk_mul_f16 v204, v205, v204
v_lshrrev_b32 v195, 18, v195
v_mfma_f32_16x16x32_f16 v[72:75], v[0:3], v[236:239], v[72:75]
v_exp_f16 v241, v242
v_and_b32 v197, s49, v197
v_and_b32 v199, s49, v199
s_waitcnt vmcnt(4)
v_mfma_f32_16x16x32_bf16 v[72:75], v[26:29], v[32:35], v[72:75]
ds_read_b128 v[0:3], v250 offset:27648
ds_read_u16_d16_hi v193, v193
ds_read_u16_d16_hi v195, v195
v_exp_f16 v206, v207
v_lshrrev_b16 v196, 2, v197
v_lshrrev_b16 v198, 2, v199
v_mfma_f32_16x16x32_bf16 v[76:79], v[24:27], v[32:35], v[76:79]
v_exp_f16 v203, v204
v_lshrrev_b32 v197, 18, v197
v_lshrrev_b32 v199, 18, v199
s_waitcnt lgkmcnt(6)
v_mfma_f32_16x16x32_f16 v[68:71], v[4:7], v[232:235], v[68:71]
ds_read_u16_d16 v196, v196
ds_read_u16_d16 v198, v198
ds_read_u16_d16_hi v197, v197
ds_read_u16_d16_hi v199, v199
v_exp_f16_sdwa v241, v242 dst_sel:WORD_1 dst_unused:UNUSED_PRESERVE src0_sel:WORD_1
v_and_b32 v201, s49, v201
v_lshrrev_b16 v200, 2, v201
v_mfma_f32_16x16x32_f16 v[76:79], v[4:7], v[236:239], v[76:79]
v_exp_f16_sdwa v206, v207 dst_sel:WORD_1 dst_unused:UNUSED_PRESERVE src0_sel:WORD_1
v_lshrrev_b32 v201, 18, v201
v_mfma_f32_16x16x32_f16 v[80:83], v[40:43], v[232:235], v[80:83]
ds_read_b128 v[4:7], v250 offset:27904
ds_read_u16_d16 v200, v200
ds_read_u16_d16_hi v201, v201
v_exp_f16_sdwa v203, v204 dst_sel:WORD_1 dst_unused:UNUSED_PRESERVE src0_sel:WORD_1
v_pk_add_f16 v241, v241, 1.0 op_sel_hi:[1,0]
v_pk_add_f16 v206, v206, 1.0 op_sel_hi:[1,0]
v_pk_add_f16 v203, v203, 1.0 op_sel_hi:[1,0]
v_mfma_f32_16x16x32_f16 v[168:171], v[40:43], v[236:239], v[168:171]
v_rcp_f16 v242, v241
v_rcp_f16 v207, v206
v_mfma_f32_16x16x32_f16 v[84:87], v[44:47], v[232:235], v[84:87]
ds_read_b128 v[40:43], v250 offset:28672
v_rcp_f16 v204, v203
v_rcp_f16_sdwa v242, v241 dst_sel:WORD_1 dst_unused:UNUSED_PRESERVE src0_sel:WORD_1
v_mfma_f32_16x16x32_f16 v[172:175], v[44:47], v[236:239], v[172:175]
v_rcp_f16_sdwa v207, v206 dst_sel:WORD_1 dst_unused:UNUSED_PRESERVE src0_sel:WORD_1
s_waitcnt lgkmcnt(5)
v_or_b32 v232, v192, v193
v_or_b32 v233, v194, v195
v_or_b32 v234, v196, v197
v_rcp_f16_sdwa v204, v203 dst_sel:WORD_1 dst_unused:UNUSED_PRESERVE src0_sel:WORD_1
s_waitcnt lgkmcnt(4)
v_or_b32 v235, v198, v199
s_waitcnt lgkmcnt(1)
v_or_b32 v236, v200, v201
v_pk_mul_f16 v237, v243, v242
v_pk_mul_f16 v238, v240, v207
v_pk_mul_f16 v239, v205, v204
s_waitcnt vmcnt(3)
v_mfma_f32_16x16x32_bf16 v[168:171], v[26:29], v[216:219], v[168:171]
ds_read_b128 v[44:47], v250 offset:28928
v_mfma_f32_16x16x32_bf16 v[172:175], v[24:27], v[216:219], v[172:175]
v_mfma_f32_16x16x32_f16 v[48:51], v[224:227], v[232:235], v[48:51]
s_waitcnt lgkmcnt(0)
v_mfma_f32_16x16x32_f16 v[52:55], v[228:231], v[232:235], v[52:55]
v_mfma_f32_16x16x32_f16 v[64:67], v[0:3], v[232:235], v[64:67]
v_mfma_f32_16x16x32_f16 v[68:71], v[4:7], v[232:235], v[68:71]
v_mfma_f32_16x16x32_f16 v[80:83], v[40:43], v[232:235], v[80:83]
v_mfma_f32_16x16x32_f16 v[84:87], v[44:47], v[232:235], v[84:87]
s_nop 4
v_cvt_pk_bf16_f32 v64, v64, v65
v_cvt_pk_bf16_f32 v65, v66, v67
v_cvt_pk_bf16_f32 v66, v68, v69
v_cvt_pk_bf16_f32 v67, v70, v71
v_cvt_pk_bf16_f32 v48, v48, v49
v_cvt_pk_bf16_f32 v49, v50, v51
v_cvt_pk_bf16_f32 v50, v52, v53
v_cvt_pk_bf16_f32 v51, v54, v55
v_cvt_pk_bf16_f32 v80, v80, v81
v_cvt_pk_bf16_f32 v81, v82, v83
v_cvt_pk_bf16_f32 v82, v84, v85
v_cvt_pk_bf16_f32 v83, v86, v87
s_mov_b64 vcc, s[74:75]
v_cndmask_b32_e64 v68, v48, v80, s[74:75]
v_mfma_f32_16x16x32_f16 v[56:59], v[224:227], v[236:239], v[56:59]
v_cndmask_b32_dpp v48, v64, v48, vcc quad_perm:[1,0,3,2] row_mask:0xf bank_mask:0xf
v_cndmask_b32_e64 v69, v49, v81, s[74:75]
v_mfma_f32_16x16x32_f16 v[60:63], v[228:231], v[236:239], v[60:63]
v_cndmask_b32_dpp v49, v65, v49, vcc quad_perm:[1,0,3,2] row_mask:0xf bank_mask:0xf
v_cndmask_b32_e64 v70, v50, v82, s[74:75]
v_mfma_f32_16x16x32_f16 v[72:75], v[0:3], v[236:239], v[72:75]
v_cndmask_b32_dpp v50, v66, v50, vcc quad_perm:[1,0,3,2] row_mask:0xf bank_mask:0xf
v_mfma_f32_16x16x32_f16 v[76:79], v[4:7], v[236:239], v[76:79]
v_cndmask_b32_e64 v71, v51, v83, s[74:75]
v_cndmask_b32_dpp v51, v67, v51, vcc quad_perm:[1,0,3,2] row_mask:0xf bank_mask:0xf
s_not_b64 vcc, s[74:75]
v_mfma_f32_16x16x32_f16 v[168:171], v[40:43], v[236:239], v[168:171]
v_cndmask_b32_dpp v80, v64, v80, vcc quad_perm:[1,0,3,2] row_mask:0xf bank_mask:0xf
v_cndmask_b32_dpp v81, v65, v81, vcc quad_perm:[1,0,3,2] row_mask:0xf bank_mask:0xf
v_mfma_f32_16x16x32_f16 v[172:175], v[44:47], v[236:239], v[172:175]
v_cndmask_b32_dpp v82, v66, v82, vcc quad_perm:[1,0,3,2] row_mask:0xf bank_mask:0xf
v_cndmask_b32_dpp v83, v67, v83, vcc quad_perm:[1,0,3,2] row_mask:0xf bank_mask:0xf
buffer_store_dwordx4 v[48:51], v255, s[8:11], s69 offen sc1
buffer_store_dwordx4 v[68:71], v255, s[8:11], s69 offen offset:128 sc1
buffer_store_dwordx4 v[80:83], v255, s[8:11], s69 offen offset:256 sc1
v_cvt_pk_bf16_f32 v72, v72, v73
v_cvt_pk_bf16_f32 v73, v74, v75
v_cvt_pk_bf16_f32 v74, v76, v77
v_cvt_pk_bf16_f32 v75, v78, v79
v_cvt_pk_bf16_f32 v56, v56, v57
v_cvt_pk_bf16_f32 v57, v58, v59
v_cvt_pk_bf16_f32 v58, v60, v61
v_cvt_pk_bf16_f32 v59, v62, v63
v_cvt_pk_bf16_f32 v168, v168, v169
v_cvt_pk_bf16_f32 v169, v170, v171
v_cvt_pk_bf16_f32 v170, v172, v173
v_cvt_pk_bf16_f32 v171, v174, v175
s_mov_b64 vcc, s[74:75]
v_cndmask_b32_e64 v76, v56, v168, s[74:75]
v_cndmask_b32_dpp v56, v72, v56, vcc quad_perm:[1,0,3,2] row_mask:0xf bank_mask:0xf
v_cndmask_b32_e64 v77, v57, v169, s[74:75]
v_cndmask_b32_dpp v57, v73, v57, vcc quad_perm:[1,0,3,2] row_mask:0xf bank_mask:0xf
v_cndmask_b32_e64 v78, v58, v170, s[74:75]
v_cndmask_b32_dpp v58, v74, v58, vcc quad_perm:[1,0,3,2] row_mask:0xf bank_mask:0xf
v_cndmask_b32_e64 v79, v59, v171, s[74:75]
v_cndmask_b32_dpp v59, v75, v59, vcc quad_perm:[1,0,3,2] row_mask:0xf bank_mask:0xf
s_not_b64 vcc, s[74:75]
v_cndmask_b32_dpp v168, v72, v168, vcc quad_perm:[1,0,3,2] row_mask:0xf bank_mask:0xf
v_cndmask_b32_dpp v169, v73, v169, vcc quad_perm:[1,0,3,2] row_mask:0xf bank_mask:0xf
v_cndmask_b32_dpp v170, v74, v170, vcc quad_perm:[1,0,3,2] row_mask:0xf bank_mask:0xf
v_cndmask_b32_dpp v171, v75, v171, vcc quad_perm:[1,0,3,2] row_mask:0xf bank_mask:0xf
s_add_u32 s46, s69, 98304
buffer_store_dwordx4 v[56:59], v255, s[8:11], s46 offen sc1
s_add_u32 s46, s69, 98304
buffer_store_dwordx4 v[76:79], v255, s[8:11], s46 offen offset:128 sc1
s_add_u32 s46, s69, 98304
buffer_store_dwordx4 v[168:171], v255, s[8:11], s46 offen offset:256 sc1
s_endpgm
Lpoll:
s_waitcnt vmcnt(0)
Lpoll1:
s_cmp_eq_u32 s77, 2
s_cbranch_scc1 LpollC
v_max_u32 v250, v156, v157
v_max3_u32 v250, v250, v158, v159
v_max3_u32 v250, v250, v160, v161
v_max3_u32 v250, v250, v162, v163
v_max3_u32 v250, v250, v164, v165
v_max3_u32 v250, v250, v166, v167
v_max3_u32 v250, v250, v252, v253
v_max3_u32 v250, v250, v254, v255
v_cmp_eq_u32 vcc, -1, v250
s_nop 4
s_cbranch_vccz LpollR
v_lshlrev_b32 v250, 4, v251
s_lshl_b32 s44, s2, 12
buffer_load_dwordx4 v[156:159], v250, s[32:35], s44 offen sc1
buffer_load_dwordx4 v[160:163], v250, s[32:35], s44 offen offset:1024 sc1
buffer_load_dwordx4 v[164:167], v250, s[32:35], s44 offen offset:2048 sc1
buffer_load_dwordx4 v[252:255], v250, s[32:35], s44 offen offset:3072 sc1
s_setpc_b64 s[78:79]
LpollR:
s_setprio 3
v_add_f32 v156, v156, v160
v_add_f32 v252, v164, v252
v_add_f32 v252, v156, v252
v_add_f32 v157, v157, v161
v_add_f32 v253, v165, v253
v_add_f32 v253, v157, v253
v_add_f32 v158, v158, v162
v_add_f32 v254, v166, v254
v_add_f32 v254, v158, v254
v_add_f32 v159, v159, v163
v_add_f32 v255, v167, v255
v_add_f32 v255, v159, v255
v_add_f32_dpp v252, v252, v252 row_ror:8 row_mask:0xf bank_mask:0xf
v_add_f32_dpp v253, v253, v253 row_ror:8 row_mask:0xf bank_mask:0xf
v_add_f32_dpp v254, v254, v254 row_ror:8 row_mask:0xf bank_mask:0xf
v_add_f32_dpp v255, v255, v255 row_ror:8 row_mask:0xf bank_mask:0xf
v_add_f32_dpp v252, v252, v252 row_ror:4 row_mask:0xf bank_mask:0xf
v_add_f32_dpp v253, v253, v253 row_ror:4 row_mask:0xf bank_mask:0xf
v_add_f32_dpp v254, v254, v254 row_ror:4 row_mask:0xf bank_mask:0xf
v_add_f32_dpp v255, v255, v255 row_ror:4 row_mask:0xf bank_mask:0xf
v_add_f32_dpp v252, v252, v252 row_ror:2 row_mask:0xf bank_mask:0xf
v_add_f32_dpp v253, v253, v253 row_ror:2 row_mask:0xf bank_mask:0xf
v_add_f32_dpp v254, v254, v254 row_ror:2 row_mask:0xf bank_mask:0xf
v_add_f32_dpp v255, v255, v255 row_ror:2 row_mask:0xf bank_mask:0xf
v_add_f32_dpp v252, v252, v252 row_ror:1 row_mask:0xf bank_mask:0xf
v_add_f32_dpp v253, v253, v253 row_ror:1 row_mask:0xf bank_mask:0xf
v_add_f32_dpp v254, v254, v254 row_ror:1 row_mask:0xf bank_mask:0xf
v_add_f32_dpp v255, v255, v255 row_ror:1 row_mask:0xf bank_mask:0xf
v_mov_b32 v156, v252
v_mov_b32 v157, v253
v_mov_b32 v158, v254
v_mov_b32 v159, v255
v_permlane16_swap_b32 v252, v156
v_permlane16_swap_b32 v253, v157
v_permlane16_swap_b32 v254, v158
v_permlane16_swap_b32 v255, v159
v_add_f32 v252, v252, v156
v_add_f32 v253, v253, v157
v_add_f32 v254, v254, v158
v_add_f32 v255, v255, v159
v_mov_b32 v156, v252
v_mov_b32 v157, v253
v_mov_b32 v158, v254
v_mov_b32 v159, v255
v_permlane32_swap_b32 v252, v156
v_permlane32_swap_b32 v253, v157
v_permlane32_swap_b32 v254, v158
v_permlane32_swap_b32 v255, v159
v_add_f32 v252, v252, v156
v_add_f32 v253, v253, v157
v_add_f32 v254, v254, v158
v_add_f32 v255, v255, v159
v_min_u32 v252, -2, v252
v_min_u32 v253, -2, v253
v_min_u32 v254, -2, v254
v_min_u32 v255, -2, v255
s_lshl_b32 s44, s2, 4
s_add_u32 s44, s44, 393216
v_lshlrev_b32 v250, 11, v251
s_mov_b64 exec, 0xff
buffer_store_dwordx4 v[252:255], v250, s[32:35], s44 offen sc1
s_mov_b64 exec, -1
s_cmp_eq_u32 s40, 0
s_cselect_b32 s77, 2, 0
s_cbranch_scc0 LpollRx
v_lshlrev_b32 v250, 2, v251
buffer_load_dword v162, v250, s[24:27], 0 offen
buffer_load_dword v163, v250, s[24:27], 0 offen offset:256
buffer_load_dword v164, v250, s[24:27], 0 offen offset:512
v_lshlrev_b32 v250, 3, v251
s_and_b32 s44, s2, 7
s_lshl_b32 s44, s44, 11
s_add_u32 s44, s44, 393216
buffer_load_dwordx2 v[156:157], v250, s[32:35], s44 offen sc1
buffer_load_dwordx2 v[158:159], v250, s[32:35], s44 offen offset:512 sc1
buffer_load_dwordx2 v[160:161], v250, s[32:35], s44 offen offset:1024 sc1
LpollRx:
s_setpc_b64 s[78:79]
LpollC:
v_max3_u32 v250, v156, v157, v158
v_max3_u32 v250, v250, v159, v160
v_max_u32 v250, v250, v161
v_cmp_eq_u32 vcc, -1, v250
s_nop 4
s_cbranch_vccz LpollS
v_lshlrev_b32 v250, 2, v251
buffer_load_dword v162, v250, s[24:27], 0 offen
buffer_load_dword v163, v250, s[24:27], 0 offen offset:256
buffer_load_dword v164, v250, s[24:27], 0 offen offset:512
v_lshlrev_b32 v250, 3, v251
s_and_b32 s44, s2, 7
s_lshl_b32 s44, s44, 11
s_add_u32 s44, s44, 393216
buffer_load_dwordx2 v[156:157], v250, s[32:35], s44 offen sc1
buffer_load_dwordx2 v[158:159], v250, s[32:35], s44 offen offset:512 sc1
buffer_load_dwordx2 v[160:161], v250, s[32:35], s44 offen offset:1024 sc1
s_setpc_b64 s[78:79]
LpollS:
s_setprio 3
s_mov_b32 s43, 1083296634
v_mov_b32 v165, 897988541
v_fma_f32 v156, v156, s43, v165
v_fma_f32 v157, v157, s43, v165
v_fma_f32 v158, v158, s43, v165
v_fma_f32 v159, v159, s43, v165
v_fma_f32 v160, v160, s43, v165
v_fma_f32 v161, v161, s43, v165
v_sqrt_f32 v156, v156
v_sqrt_f32 v157, v157
v_sqrt_f32 v158, v158
v_sqrt_f32 v159, v159
v_sqrt_f32 v160, v160
v_sqrt_f32 v161, v161
v_add_f32 v166, v156, v157
v_add_f32 v166, v166, v158
v_add_f32 v166, v166, v159
v_add_f32 v166, v166, v160
v_add_f32 v166, v166, v161
s_nop 1
v_add_f32_dpp v166, v166, v166 row_ror:8 row_mask:0xf bank_mask:0xf
s_nop 1
v_add_f32_dpp v166, v166, v166 row_ror:4 row_mask:0xf bank_mask:0xf
s_nop 1
v_add_f32_dpp v166, v166, v166 row_ror:2 row_mask:0xf bank_mask:0xf
s_nop 1
v_add_f32_dpp v166, v166, v166 row_ror:1 row_mask:0xf bank_mask:0xf
v_mov_b32 v250, v166
s_nop 1
v_permlane16_swap_b32 v166, v250
v_add_f32 v166, v166, v250
v_mov_b32 v250, v166
s_nop 1
v_permlane32_swap_b32 v166, v250
v_add_f32 v166, v166, v250
s_mov_b32 s43, 992651947
v_fma_f32 v166, v166, s43, v165
v_rcp_f32 v166, v166
v_mov_b32 v165, 3221789604
v_mul_f32 v166, v166, v165
v_lshlrev_b32 v167, 16, v162
v_and_b32 v252, 4294901760, v162
v_mul_f32 v156, v156, v166
v_mul_f32 v157, v157, v166
v_fma_f32 v167, v167, v156, v165
v_fma_f32 v252, v252, v157, v165
v_cvt_pk_f16_f32 v162, v167, v252
v_lshlrev_b32 v167, 16, v163
v_and_b32 v252, 4294901760, v163
v_mul_f32 v158, v158, v166
v_mul_f32 v159, v159, v166
v_fma_f32 v167, v167, v158, v165
v_fma_f32 v252, v252, v159, v165
v_cvt_pk_f16_f32 v163, v167, v252
v_lshlrev_b32 v167, 16, v164
v_and_b32 v252, 4294901760, v164
v_mul_f32 v160, v160, v166
v_mul_f32 v161, v161, v166
v_fma_f32 v167, v167, v160, v165
v_fma_f32 v252, v252, v161, v165
v_cvt_pk_f16_f32 v164, v167, v252
s_mov_b32 s77, 0
s_setpc_b64 s[78:79]
Lend:
s_endpgm

.section .rodata,"a"
.p2align 6
.amdhsa_kernel standalone__modern_conv_block_convnext_v2__vision_kernel
  .amdhsa_next_free_vgpr 256
  .amdhsa_next_free_sgpr 102
  .amdhsa_accum_offset 256
  .amdhsa_group_segment_fixed_size 0
  .amdhsa_kernarg_size 72
  .amdhsa_user_sgpr_count 2
  .amdhsa_user_sgpr_kernarg_segment_ptr 1
  .amdhsa_system_sgpr_workgroup_id_x 1
.end_amdhsa_kernel
```

```asm
; @launch grid=(256,1,1) block=(512,1,1) lds=163840
.amdgcn_target "amdgcn-amd-amdhsa--gfx950"
.text
.globl standalone__modern_conv_block_convnext_v2__vision_kernel
.p2align 8
.type standalone__modern_conv_block_convnext_v2__vision_kernel,@function
standalone__modern_conv_block_convnext_v2__vision_kernel:
Lmain:
s_cmp_ge_u32 s2, 256
s_cbranch_scc1 Lend
s_load_dwordx16 s[80:95], s[0:1], 0
s_load_dwordx2 s[96:97], s[0:1], 64
s_getpc_b64 s[74:75]
Lpc0:
s_sub_u32 s74, s74, Lpc0-Lmain
s_subb_u32 s75, s75, 0
v_lshlrev_b32 v159, 7, v0
s_movk_i32 s43, 64
v_cmp_gt_u32 vcc, s43, v0
s_and_saveexec_b64 s[78:79], vcc
s_cbranch_execz Lpf0x
global_load_dword v255, v159, s[74:75]
Lpf0x:
s_mov_b64 exec, s[78:79]
v_mov_b32 v199, v0
v_and_b32 v251, 63, v0
v_lshrrev_b32 v120, 6, v0
s_nop 0
v_readfirstlane_b32 s40, v120
s_and_b32 s43, s2, 7
s_lshr_b32 s44, s2, 3
s_and_b32 s41, s43, 0
s_lshl_b32 s41, s41, 4
s_and_b32 s45, s44, 15
s_add_u32 s41, s41, s45
s_lshr_b32 s42, s43, 0
s_lshl_b32 s42, s42, 1
s_lshr_b32 s45, s44, 4
s_add_u32 s42, s42, s45
s_lshl_b32 s41, s41, 5
s_lshl_b32 s42, s42, 5
s_lshl_b32 s67, s40, 6
s_cmp_eq_u32 s40, 6
s_cselect_b32 s67, 352, s67
v_add_u32 v125, s67, v251
v_mul_u32_u24 v121, 5462, v125
v_lshrrev_b32 v121, 16, v121
v_mul_u32_u24 v122, 12, v121
v_sub_u32 v122, v125, v122
v_bfe_u32 v123, v121, 2, 2
v_xor_b32 v122, v122, v123
v_add_u32 v123, s41, v121
v_subrev_u32 v123, 1, v123
v_mul_u32_u24 v124, 192, v123
v_lshl_add_u32 v124, v122, 4, v124
v_mov_b32 v240, 2147483648
s_movk_i32 s43, 512
v_cmp_gt_u32 vcc, s43, v123
s_nop 1
v_cndmask_b32 v124, v240, v124, vcc
v_cmp_gt_u32 vcc, 34, v121
s_nop 1
v_cndmask_b32 v240, v240, v124, vcc
s_add_i32 s43, s42, -1
s_mul_i32 s44, s43, 98304
s_cmp_lt_u32 s43, 512
s_cselect_b32 s46, s44, 1073741824
s_mul_i32 s66, s42, 98304
s_mov_b32 s6, 50331648
s_mov_b32 s7, 131072
s_lshl_b32 s67, s67, 4
s_add_u32 s67, s67, 90112
s_cmp_eq_u32 s40, 7
s_cselect_b32 s67, 163840, s67
v_lshlrev_b32 v130, 1, v199
v_add_u32 v155, 768, v199
v_min_u32 v155, 863, v155
v_lshlrev_b32 v131, 1, v155
s_waitcnt lgkmcnt(0)
s_mov_b32 s4, s80
s_and_b32 s5, s81, 65535
s_cmp_ge_u32 s40, 4
s_cbranch_scc1 Lnodw
s_mov_b32 s20, s82
s_and_b32 s21, s83, 65535
s_mov_b32 s22, 1728
s_mov_b32 s23, 131072
buffer_load_ushort v126, v130, s[20:23], 0 offen offset:0
buffer_load_ushort v127, v130, s[20:23], 0 offen offset:512
buffer_load_ushort v128, v130, s[20:23], 0 offen offset:1024
buffer_load_ushort v129, v131, s[20:23], 0 offen offset:0
Lnodw:
s_cmp_eq_u32 s40, 7
s_cbranch_scc1 Lskipx0
s_add_u32 m0, s67, 0
s_nop 0
buffer_load_dwordx4 v240, s[4:7], s46 offen nt lds
s_add_u32 m0, s67, 6656
s_nop 0
buffer_load_dwordx4 v240, s[4:7], s66 offen nt lds
s_add_u32 m0, s67, 13312
s_add_u32 s45, s66, 98304
buffer_load_dwordx4 v240, s[4:7], s45 offen nt lds
s_add_u32 m0, s67, 19968
s_add_u32 s45, s66, 196608
buffer_load_dwordx4 v240, s[4:7], s45 offen nt lds
s_add_u32 m0, s67, 26624
s_add_u32 s45, s66, 294912
buffer_load_dwordx4 v240, s[4:7], s45 offen nt lds
s_add_u32 m0, s67, 33280
s_add_u32 s45, s66, 393216
buffer_load_dwordx4 v240, s[4:7], s45 offen nt lds
Lskipx0:
s_mov_b32 s12, s84
s_and_b32 s13, s85, 65535
s_mov_b32 s14, 73728
s_mov_b32 s15, 131072
v_lshrrev_b32 v189, 2, v251
v_mul_u32_u24 v189, 768, v189
v_and_b32 v125, 3, v251
v_lshl_add_u32 v189, v125, 4, v189
s_and_b32 s43, s40, 3
s_lshl_b32 s3, s43, 6
s_mul_i32 s77, s43, 6144
s_add_u32 s77, s77, 16384
v_mov_b32 v253, 16256
v_mov_b32 v254, 1
s_add_u32 s43, s42, s40
s_add_u32 s43, s43, 1
s_lshl_b32 s43, s43, 9
s_add_u32 s43, s43, s41
s_mul_i32 s47, s43, 192
s_sub_u32 s47, s47, 256
s_and_b32 s43, s40, 1
s_lshl_b32 s46, s43, 4
s_add_u32 s41, s41, s46
s_and_b32 s43, s40, 6
s_add_u32 s42, s42, s43
s_mul_i32 s45, s43, 6656
s_add_u32 s45, s45, 90112
v_and_b32 v131, 15, v251
v_lshrrev_b32 v132, 4, v251
v_mul_u32_u24 v122, 6656, v132
v_add_u32 v122, s45, v122
v_add_u32 v121, s46, v131
v_mul_u32_u24 v123, 192, v121
v_bfe_u32 v124, v121, 2, 2
v_lshl_add_u32 v123, v124, 4, v123
v_add_u32 v242, v122, v123
v_add_u32 v121, 1, v121
v_mul_u32_u24 v123, 192, v121
v_bfe_u32 v124, v121, 2, 2
v_lshl_add_u32 v123, v124, 4, v123
v_add_u32 v243, v122, v123
v_add_u32 v121, 1, v121
v_mul_u32_u24 v123, 192, v121
v_bfe_u32 v124, v121, 2, 2
v_lshl_add_u32 v123, v124, 4, v123
v_add_u32 v244, v122, v123
s_mul_i32 s72, s40, 9216
s_add_u32 s72, s72, 90112
v_bfe_u32 v133, v131, 2, 1
v_sub_u32 v133, v132, v133
v_lshrrev_b32 v134, 3, v131
v_and_b32 v135, 3, v131
v_lshl_add_u32 v135, v134, 2, v135
v_lshlrev_b32 v136, 7, v133
v_lshl_add_u32 v136, v135, 4, v136
v_add_u32 v136, 156672, v136
v_mov_b32 v135, 163840
v_cmp_gt_u32 vcc, 3, v133
s_nop 1
v_cndmask_b32 v245, v135, v136, vcc
v_and_b32 v135, 3, v131
v_mul_u32_u24 v246, 85, v135
s_mov_b32 s16, s86
s_and_b32 s17, s87, 65535
s_mov_b32 s18, 73728
s_mov_b32 s19, 131072
s_mov_b32 s24, s88
s_and_b32 s25, s89, 65535
s_mov_b32 s26, 768
s_mov_b32 s27, 131072
s_mov_b32 s28, s90
s_and_b32 s29, s91, 65535
s_mov_b32 s30, 768
s_mov_b32 s31, 131072
s_mov_b32 s8, s92
s_and_b32 s9, s93, 65535
s_mov_b32 s10, 50331648
s_mov_b32 s11, 131072
s_mov_b32 s36, s94
s_and_b32 s37, s95, 65535
s_mov_b32 s38, 256
s_mov_b32 s39, 131072
s_mov_b32 s32, s96
s_and_b32 s33, s97, 65535
s_mov_b32 s34, 83886080
s_mov_b32 s35, 131072
v_lshlrev_b32 v241, 4, v251
v_and_b32 v133, 35, v251
v_bfe_u32 v134, v251, 2, 2
v_lshl_add_u32 v133, v134, 3, v133
v_bfe_u32 v134, v251, 4, 1
v_lshl_add_u32 v133, v134, 2, v133
v_lshlrev_b32 v248, 4, v133
v_add_u32 v249, 65536, v248
v_add_u32 v250, 131072, v248
s_lshl_b32 s73, s2, 3
s_add_u32 s73, s73, s40
s_lshl_b32 s80, s73, 10
s_add_u32 s80, s80, 4194304
s_mul_i32 s73, s73, 16
s_add_u32 s73, s73, 1048576
s_mul_i32 s46, s41, 192
s_add_u32 s43, s42, 0
s_mul_i32 s43, s43, 98304
s_add_u32 s68, s43, s46
s_add_u32 s43, s42, 8
s_mul_i32 s43, s43, 98304
s_add_u32 s69, s43, s46
s_add_u32 s43, s42, 16
s_mul_i32 s43, s43, 98304
s_add_u32 s70, s43, s46
s_add_u32 s43, s42, 24
s_mul_i32 s43, s43, 98304
s_add_u32 s71, s43, s46
s_mul_i32 s82, s40, 9216
s_mov_b32 s48, 1156203754
s_mov_b32 s49, 4294508536
s_mov_b32 s76, 400000
v_lshrrev_b32 v148, 5, v251
v_lshlrev_b32 v190, 8, v148
v_bfe_u32 v148, v251, 2, 2
v_lshl_add_u32 v190, v148, 6, v190
v_bfe_u32 v148, v251, 4, 1
v_lshl_add_u32 v190, v148, 5, v190
v_bfe_u32 v148, v251, 0, 1
v_lshl_add_u32 v190, v148, 4, v190
v_bfe_u32 v148, v251, 1, 1
v_lshl_add_u32 v190, v148, 3, v190
v_add_u32 v190, s77, v190
v_add_u32 v191, s77, v248
s_cmp_lt_u32 s40, 4
s_cbranch_scc1 Lnoy
v_lshlrev_b32 v24, 6, v199
s_mov_b32 s43, 1065362610
v_mov_b32 v25, 1084047360
v_add_u32 v0, 32772, v24
v_add_u32 v1, 32780, v24
v_add_u32 v2, 32788, v24
v_add_u32 v3, 32796, v24
v_add_u32 v4, 32804, v24
v_add_u32 v5, 32812, v24
v_add_u32 v6, 32820, v24
v_add_u32 v7, 32828, v24
v_cvt_f32_f16 v0, v0
v_cvt_f32_f16 v1, v1
v_cvt_f32_f16 v2, v2
v_cvt_f32_f16 v3, v3
v_cvt_f32_f16 v4, v4
v_cvt_f32_f16 v5, v5
v_cvt_f32_f16 v6, v6
v_cvt_f32_f16 v7, v7
v_mul_f32 v8, v0, v0
v_mul_f32 v9, v1, v1
v_mul_f32 v10, v2, v2
v_mul_f32 v11, v3, v3
v_mul_f32 v12, v4, v4
v_mul_f32 v13, v5, v5
v_mul_f32 v14, v6, v6
v_mul_f32 v15, v7, v7
v_fma_f32 v8, v8, s43, v25
v_fma_f32 v9, v9, s43, v25
v_fma_f32 v10, v10, s43, v25
v_fma_f32 v11, v11, s43, v25
v_fma_f32 v12, v12, s43, v25
v_fma_f32 v13, v13, s43, v25
v_fma_f32 v14, v14, s43, v25
v_fma_f32 v15, v15, s43, v25
v_mul_f32 v8, v0, v8
v_mul_f32 v9, v1, v9
v_mul_f32 v10, v2, v10
v_mul_f32 v11, v3, v11
v_mul_f32 v12, v4, v12
v_mul_f32 v13, v5, v13
v_mul_f32 v14, v6, v14
v_mul_f32 v15, v7, v15
v_exp_f32 v8, v8
v_exp_f32 v9, v9
v_exp_f32 v10, v10
v_exp_f32 v11, v11
v_exp_f32 v12, v12
v_exp_f32 v13, v13
v_exp_f32 v14, v14
v_exp_f32 v15, v15
v_add_f32 v16, 1.0, v8
v_add_f32 v17, 1.0, v9
v_add_f32 v18, 1.0, v10
v_add_f32 v19, 1.0, v11
v_add_f32 v20, 1.0, v12
v_add_f32 v21, 1.0, v13
v_add_f32 v22, 1.0, v14
v_add_f32 v23, 1.0, v15
v_rcp_f32 v16, v16
v_rcp_f32 v17, v17
v_rcp_f32 v18, v18
v_rcp_f32 v19, v19
v_rcp_f32 v20, v20
v_rcp_f32 v21, v21
v_rcp_f32 v22, v22
v_rcp_f32 v23, v23
v_mul_f32 v0, v0, v16
v_mul_f32 v1, v1, v17
v_mul_f32 v2, v2, v18
v_mul_f32 v3, v3, v19
v_mul_f32 v4, v4, v20
v_mul_f32 v5, v5, v21
v_mul_f32 v6, v6, v22
v_mul_f32 v7, v7, v23
v_mul_f32 v8, v8, v0
v_mul_f32 v9, v9, v1
v_mul_f32 v10, v10, v2
v_mul_f32 v11, v11, v3
v_mul_f32 v12, v12, v4
v_mul_f32 v13, v13, v5
v_mul_f32 v14, v14, v6
v_mul_f32 v15, v15, v7
v_cvt_pk_f16_f32 v28, v0, v1
v_cvt_pk_f16_f32 v32, -v8, -v9
v_cvt_pk_f16_f32 v29, v2, v3
v_cvt_pk_f16_f32 v33, -v10, -v11
v_cvt_pk_f16_f32 v30, v4, v5
v_cvt_pk_f16_f32 v34, -v12, -v13
v_cvt_pk_f16_f32 v31, v6, v7
v_cvt_pk_f16_f32 v35, -v14, -v15
v_lshlrev_b32 v24, 4, v199
v_mov_b32 v25, 163840
s_movk_i32 s43, 496
v_cmp_gt_u32 vcc, s43, v199
s_nop 1
v_cndmask_b32 v24, v25, v24, vcc
ds_write_b128 v24, v[32:35]
ds_write_b128 v24, v[28:31] offset:8192
Lnoy:
s_cmp_ge_u32 s40, 4
s_cbranch_scc1 Lnoo
v_add_u32 v152, 0, v199
v_mul_u32_u24 v140, 683, v152
v_lshrrev_b32 v140, 16, v140
v_mul_u32_u24 v142, 11, v140
v_lshrrev_b32 v142, 5, v142
v_lshrrev_b32 v143, 5, v152
v_bfe_u32 v141, v152, 3, 2
v_bfe_u32 v144, v152, 4, 1
v_xor_b32 v141, v141, v144
v_sub_u32 v141, v141, v142
v_mul_i32_i24 v141, 9, v141
v_add_u32 v143, v143, v141
v_lshrrev_b32 v141, 1, v143
v_mul_u32_u24 v141, 368, v141
v_lshl_add_u32 v143, v143, 3, v141
v_lshl_add_u32 v143, v142, 7, v143
v_and_b32 v144, 7, v152
v_lshl_add_u32 v143, v144, 4, v143
v_add_u32 v156, 156672, v143
v_add_u32 v153, 256, v199
v_mul_u32_u24 v140, 683, v153
v_lshrrev_b32 v140, 16, v140
v_mul_u32_u24 v142, 11, v140
v_lshrrev_b32 v142, 5, v142
v_lshrrev_b32 v143, 5, v153
v_bfe_u32 v141, v153, 3, 2
v_bfe_u32 v144, v153, 4, 1
v_xor_b32 v141, v141, v144
v_sub_u32 v141, v141, v142
v_mul_i32_i24 v141, 9, v141
v_add_u32 v143, v143, v141
v_lshrrev_b32 v141, 1, v143
v_mul_u32_u24 v141, 368, v141
v_lshl_add_u32 v143, v143, 3, v141
v_lshl_add_u32 v143, v142, 7, v143
v_and_b32 v144, 7, v153
v_lshl_add_u32 v143, v144, 4, v143
v_add_u32 v157, 156672, v143
v_add_u32 v154, 512, v199
v_mul_u32_u24 v140, 683, v154
v_lshrrev_b32 v140, 16, v140
v_mul_u32_u24 v142, 11, v140
v_lshrrev_b32 v142, 5, v142
v_lshrrev_b32 v143, 5, v154
v_bfe_u32 v141, v154, 3, 2
v_bfe_u32 v144, v154, 4, 1
v_xor_b32 v141, v141, v144
v_sub_u32 v141, v141, v142
v_mul_i32_i24 v141, 9, v141
v_add_u32 v143, v143, v141
v_lshrrev_b32 v141, 1, v143
v_mul_u32_u24 v141, 368, v141
v_lshl_add_u32 v143, v143, 3, v141
v_lshl_add_u32 v143, v142, 7, v143
v_and_b32 v144, 7, v154
v_lshl_add_u32 v143, v144, 4, v143
v_add_u32 v158, 156672, v143
v_mul_u32_u24 v140, 683, v155
v_lshrrev_b32 v140, 16, v140
v_mul_u32_u24 v142, 11, v140
v_lshrrev_b32 v142, 5, v142
v_lshrrev_b32 v143, 5, v155
v_bfe_u32 v141, v155, 3, 2
v_bfe_u32 v144, v155, 4, 1
v_xor_b32 v141, v141, v144
v_sub_u32 v141, v141, v142
v_mul_i32_i24 v141, 9, v141
v_add_u32 v143, v143, v141
v_lshrrev_b32 v141, 1, v143
v_mul_u32_u24 v141, 368, v141
v_lshl_add_u32 v143, v143, 3, v141
v_lshl_add_u32 v143, v142, 7, v143
v_and_b32 v144, 7, v155
v_lshl_add_u32 v143, v144, 4, v143
v_add_u32 v159, 156672, v143
v_mov_b32 v160, 0
v_mov_b32 v161, 0
v_mov_b32 v162, 0
v_mov_b32 v163, 0
s_mov_b64 exec, 1
ds_write_b128 v253, v[160:163]
ds_write_b128 v253, v[160:163] offset:16
s_mov_b64 exec, -1
s_waitcnt vmcnt(6)
v_and_b32 v130, 4, v152
v_cmp_eq_u32 vcc, 0, v130
s_nop 1
v_cndmask_b32 v164, 0, v126, vcc
v_sub_u32 v165, v126, v164
ds_write_b64 v156, v[164:165]
v_and_b32 v130, 4, v153
v_cmp_eq_u32 vcc, 0, v130
s_nop 1
v_cndmask_b32 v166, 0, v127, vcc
v_sub_u32 v167, v127, v166
ds_write_b64 v157, v[166:167]
v_and_b32 v130, 4, v154
v_cmp_eq_u32 vcc, 0, v130
s_nop 1
v_cndmask_b32 v168, 0, v128, vcc
v_sub_u32 v169, v128, v168
ds_write_b64 v158, v[168:169]
v_and_b32 v130, 4, v155
v_cmp_eq_u32 vcc, 0, v130
s_nop 1
v_cndmask_b32 v170, 0, v129, vcc
v_sub_u32 v171, v129, v170
ds_write_b64 v159, v[170:171]
s_waitcnt lgkmcnt(0)
Lnoo:
s_barrier
s_cmp_lt_u32 s40, 4
s_cbranch_scc1 Lnoy2
v_subrev_u32 v199, 256, v199
v_lshlrev_b32 v24, 6, v199
s_mov_b32 s43, 1065362610
v_mov_b32 v25, 1084047360
v_add_u32 v0, 32772, v24
v_add_u32 v1, 32780, v24
v_add_u32 v2, 32788, v24
v_add_u32 v3, 32796, v24
v_add_u32 v4, 32804, v24
v_add_u32 v5, 32812, v24
v_add_u32 v6, 32820, v24
v_add_u32 v7, 32828, v24
v_cvt_f32_f16 v0, v0
v_cvt_f32_f16 v1, v1
v_cvt_f32_f16 v2, v2
v_cvt_f32_f16 v3, v3
v_cvt_f32_f16 v4, v4
v_cvt_f32_f16 v5, v5
v_cvt_f32_f16 v6, v6
v_cvt_f32_f16 v7, v7
v_mul_f32 v8, v0, v0
v_mul_f32 v9, v1, v1
v_mul_f32 v10, v2, v2
v_mul_f32 v11, v3, v3
v_mul_f32 v12, v4, v4
v_mul_f32 v13, v5, v5
v_mul_f32 v14, v6, v6
v_mul_f32 v15, v7, v7
v_fma_f32 v8, v8, s43, v25
v_fma_f32 v9, v9, s43, v25
v_fma_f32 v10, v10, s43, v25
v_fma_f32 v11, v11, s43, v25
v_fma_f32 v12, v12, s43, v25
v_fma_f32 v13, v13, s43, v25
v_fma_f32 v14, v14, s43, v25
v_fma_f32 v15, v15, s43, v25
v_mul_f32 v8, v0, v8
v_mul_f32 v9, v1, v9
v_mul_f32 v10, v2, v10
v_mul_f32 v11, v3, v11
v_mul_f32 v12, v4, v12
v_mul_f32 v13, v5, v13
v_mul_f32 v14, v6, v14
v_mul_f32 v15, v7, v15
v_exp_f32 v8, v8
v_exp_f32 v9, v9
v_exp_f32 v10, v10
v_exp_f32 v11, v11
v_exp_f32 v12, v12
v_exp_f32 v13, v13
v_exp_f32 v14, v14
v_exp_f32 v15, v15
v_add_f32 v16, 1.0, v8
v_add_f32 v17, 1.0, v9
v_add_f32 v18, 1.0, v10
v_add_f32 v19, 1.0, v11
v_add_f32 v20, 1.0, v12
v_add_f32 v21, 1.0, v13
v_add_f32 v22, 1.0, v14
v_add_f32 v23, 1.0, v15
v_rcp_f32 v16, v16
v_rcp_f32 v17, v17
v_rcp_f32 v18, v18
v_rcp_f32 v19, v19
v_rcp_f32 v20, v20
v_rcp_f32 v21, v21
v_rcp_f32 v22, v22
v_rcp_f32 v23, v23
v_mul_f32 v0, v0, v16
v_mul_f32 v1, v1, v17
v_mul_f32 v2, v2, v18
v_mul_f32 v3, v3, v19
v_mul_f32 v4, v4, v20
v_mul_f32 v5, v5, v21
v_mul_f32 v6, v6, v22
v_mul_f32 v7, v7, v23
v_mul_f32 v8, v8, v0
v_mul_f32 v9, v9, v1
v_mul_f32 v10, v10, v2
v_mul_f32 v11, v11, v3
v_mul_f32 v12, v12, v4
v_mul_f32 v13, v13, v5
v_mul_f32 v14, v14, v6
v_mul_f32 v15, v15, v7
v_cvt_pk_f16_f32 v28, v0, v1
v_cvt_pk_f16_f32 v32, -v8, -v9
v_cvt_pk_f16_f32 v29, v2, v3
v_cvt_pk_f16_f32 v33, -v10, -v11
v_cvt_pk_f16_f32 v30, v4, v5
v_cvt_pk_f16_f32 v34, -v12, -v13
v_cvt_pk_f16_f32 v31, v6, v7
v_cvt_pk_f16_f32 v35, -v14, -v15
v_lshlrev_b32 v24, 4, v199
v_mov_b32 v25, 163840
s_movk_i32 s43, 496
v_cmp_gt_u32 vcc, s43, v199
s_nop 1
v_cndmask_b32 v24, v25, v24, vcc
ds_write_b128 v24, v[32:35]
ds_write_b128 v24, v[28:31] offset:8192
Lnoy2:
s_setprio 2
s_cmp_lt_u32 s40, 4
s_cbranch_scc0 Lsu0
s_call_b64 s[78:79], Lpre
s_call_b64 s[78:79], Lrb
s_waitcnt vmcnt(4)
s_mov_b64 exec, 1
ds_add_u32 v253, v254 offset:28
s_mov_b64 exec, -1
v_mov_b32 v253, 16256
Lsw288w:
ds_read_b32 v247, v253 offset:28
s_waitcnt lgkmcnt(0)
v_readfirstlane_b32 s43, v247
s_cmp_eq_u32 s76, 0
s_cbranch_scc1 Lsw288x
s_sub_u32 s76, s76, 1
s_cmp_lt_u32 s43, 8
s_cbranch_scc0 Lsw288x
s_sleep 2
s_branch Lsw288w
Lsw288x:
s_call_b64 s[78:79], Lconv0
s_mov_b64 exec, 1
ds_add_u32 v253, v254 offset:16
s_mov_b64 exec, -1
s_call_b64 s[78:79], Lln0
s_waitcnt vmcnt(0)
s_mov_b64 exec, 1
ds_add_u32 v253, v254 offset:12
s_mov_b64 exec, -1
s_call_b64 s[78:79], Lw1i
Lsu0:
s_cmp_ge_u32 s40, 4
s_cbranch_scc0 Lsu2
s_setprio 3
s_call_b64 s[78:79], Lw1f
s_waitcnt vmcnt(6)
s_mov_b64 exec, 1
ds_add_u32 v253, v254 offset:28
s_mov_b64 exec, -1
s_call_b64 s[78:79], Lrb
s_waitcnt vmcnt(4)
s_call_b64 s[78:79], Lw1a
s_mov_b64 exec, 1
ds_add_u32 v253, v254 offset:20
s_mov_b64 exec, -1
s_call_b64 s[78:79], Lpre
s_waitcnt vmcnt(0)
s_mov_b64 exec, 1
ds_add_u32 v253, v254 offset:12
s_mov_b64 exec, -1
v_mov_b32 v253, 16256
Lsw128w:
ds_read_b32 v247, v253 offset:12
s_waitcnt lgkmcnt(0)
v_readfirstlane_b32 s43, v247
s_cmp_eq_u32 s76, 0
s_cbranch_scc1 Lsw128x
s_sub_u32 s76, s76, 1
s_cmp_lt_u32 s43, 8
s_cbranch_scc0 Lsw128x
s_sleep 2
s_branch Lsw128w
Lsw128x:
s_call_b64 s[78:79], Lconv0
s_mov_b64 exec, 1
ds_add_u32 v253, v254 offset:16
s_mov_b64 exec, -1
s_call_b64 s[78:79], Lln0
Lsu2:
s_branch Lgo
Lconv0:
ds_read_b128 v[192:195], v242
ds_read_b128 v[196:199], v242 offset:64
ds_read_b128 v[200:203], v242 offset:128
ds_read_b128 v[204:207], v243
ds_read_b128 v[208:211], v243 offset:64
ds_read_b128 v[212:215], v243 offset:128
ds_read_b128 v[224:227], v244
ds_read_b128 v[228:231], v244 offset:64
ds_read_b128 v[232:235], v244 offset:128
v_xor_b32 v242, 16, v242
ds_read_b128 v[236:239], v242
ds_read_b128 v[216:219], v242 offset:64
ds_read_b128 v[220:223], v242 offset:128
s_waitcnt lgkmcnt(11)
v_smfmac_f32_16x16x32_bf16 v[0:3], v[48:49], v[192:195], v246
s_waitcnt lgkmcnt(10)
v_smfmac_f32_16x16x32_bf16 v[16:19], v[50:51], v[196:199], v246
s_waitcnt lgkmcnt(9)
v_smfmac_f32_16x16x32_bf16 v[32:35], v[52:53], v[200:203], v246
s_waitcnt lgkmcnt(8)
v_xor_b32 v243, 16, v243
ds_read_b128 v[192:195], v243
ds_read_b128 v[196:199], v243 offset:64
v_smfmac_f32_16x16x32_bf16 v[0:3], v[54:55], v[204:207], v246
s_waitcnt lgkmcnt(9)
v_smfmac_f32_16x16x32_bf16 v[16:19], v[56:57], v[208:211], v246
s_waitcnt lgkmcnt(8)
ds_read_b128 v[200:203], v243 offset:128
v_xor_b32 v244, 16, v244
ds_read_b128 v[204:207], v244
v_smfmac_f32_16x16x32_bf16 v[32:35], v[58:59], v[212:215], v246
s_waitcnt lgkmcnt(9)
v_smfmac_f32_16x16x32_bf16 v[0:3], v[60:61], v[224:227], v246
s_waitcnt lgkmcnt(8)
ds_read_b128 v[208:211], v244 offset:64
ds_read_b128 v[212:215], v244 offset:128
v_smfmac_f32_16x16x32_bf16 v[16:19], v[62:63], v[228:231], v246
s_waitcnt lgkmcnt(9)
v_smfmac_f32_16x16x32_bf16 v[32:35], v[64:65], v[232:235], v246
s_waitcnt lgkmcnt(8)
v_xor_b32 v242, 32, v242
ds_read_b128 v[224:227], v242
ds_read_b128 v[228:231], v242 offset:64
v_smfmac_f32_16x16x32_bf16 v[4:7], v[66:67], v[236:239], v246
s_waitcnt lgkmcnt(9)
v_smfmac_f32_16x16x32_bf16 v[20:23], v[68:69], v[216:219], v246
s_waitcnt lgkmcnt(8)
ds_read_b128 v[232:235], v242 offset:128
v_xor_b32 v243, 32, v243
ds_read_b128 v[236:239], v243
v_smfmac_f32_16x16x32_bf16 v[36:39], v[70:71], v[220:223], v246
s_waitcnt lgkmcnt(9)
v_smfmac_f32_16x16x32_bf16 v[4:7], v[72:73], v[192:195], v246
s_waitcnt lgkmcnt(8)
ds_read_b128 v[216:219], v243 offset:64
ds_read_b128 v[220:223], v243 offset:128
v_smfmac_f32_16x16x32_bf16 v[20:23], v[74:75], v[196:199], v246
s_waitcnt lgkmcnt(9)
v_smfmac_f32_16x16x32_bf16 v[36:39], v[76:77], v[200:203], v246
s_waitcnt lgkmcnt(8)
v_xor_b32 v244, 32, v244
ds_read_b128 v[192:195], v244
ds_read_b128 v[196:199], v244 offset:64
v_smfmac_f32_16x16x32_bf16 v[4:7], v[78:79], v[204:207], v246
s_waitcnt lgkmcnt(9)
v_smfmac_f32_16x16x32_bf16 v[20:23], v[80:81], v[208:211], v246
s_waitcnt lgkmcnt(8)
ds_read_b128 v[200:203], v244 offset:128
v_xor_b32 v242, 16, v242
ds_read_b128 v[204:207], v242
v_smfmac_f32_16x16x32_bf16 v[36:39], v[82:83], v[212:215], v246
s_waitcnt lgkmcnt(9)
v_smfmac_f32_16x16x32_bf16 v[12:15], v[84:85], v[224:227], v246
s_waitcnt lgkmcnt(8)
ds_read_b128 v[208:211], v242 offset:64
ds_read_b128 v[212:215], v242 offset:128
v_smfmac_f32_16x16x32_bf16 v[28:31], v[86:87], v[228:231], v246
s_waitcnt lgkmcnt(9)
v_smfmac_f32_16x16x32_bf16 v[44:47], v[88:89], v[232:235], v246
s_waitcnt lgkmcnt(8)
v_xor_b32 v243, 16, v243
ds_read_b128 v[224:227], v243
ds_read_b128 v[228:231], v243 offset:64
v_smfmac_f32_16x16x32_bf16 v[12:15], v[90:91], v[236:239], v246
s_waitcnt lgkmcnt(9)
v_smfmac_f32_16x16x32_bf16 v[28:31], v[92:93], v[216:219], v246
s_waitcnt lgkmcnt(8)
ds_read_b128 v[232:235], v243 offset:128
v_xor_b32 v244, 16, v244
ds_read_b128 v[236:239], v244
v_smfmac_f32_16x16x32_bf16 v[44:47], v[94:95], v[220:223], v246
s_waitcnt lgkmcnt(9)
v_smfmac_f32_16x16x32_bf16 v[12:15], v[96:97], v[192:195], v246
s_waitcnt lgkmcnt(8)
ds_read_b128 v[216:219], v244 offset:64
ds_read_b128 v[220:223], v244 offset:128
v_smfmac_f32_16x16x32_bf16 v[28:31], v[98:99], v[196:199], v246
s_waitcnt lgkmcnt(9)
v_smfmac_f32_16x16x32_bf16 v[44:47], v[100:101], v[200:203], v246
s_waitcnt lgkmcnt(8)
v_smfmac_f32_16x16x32_bf16 v[8:11], v[102:103], v[204:207], v246
s_waitcnt lgkmcnt(7)
v_smfmac_f32_16x16x32_bf16 v[24:27], v[104:105], v[208:211], v246
s_waitcnt lgkmcnt(6)
v_smfmac_f32_16x16x32_bf16 v[40:43], v[106:107], v[212:215], v246
s_waitcnt lgkmcnt(5)
v_smfmac_f32_16x16x32_bf16 v[8:11], v[108:109], v[224:227], v246
s_waitcnt lgkmcnt(4)
v_smfmac_f32_16x16x32_bf16 v[24:27], v[110:111], v[228:231], v246
s_waitcnt lgkmcnt(3)
v_smfmac_f32_16x16x32_bf16 v[40:43], v[112:113], v[232:235], v246
s_waitcnt lgkmcnt(2)
v_smfmac_f32_16x16x32_bf16 v[8:11], v[114:115], v[236:239], v246
s_waitcnt lgkmcnt(1)
v_smfmac_f32_16x16x32_bf16 v[24:27], v[116:117], v[216:219], v246
s_waitcnt lgkmcnt(0)
v_smfmac_f32_16x16x32_bf16 v[40:43], v[118:119], v[220:223], v246
s_nop 11
s_setpc_b64 s[78:79]
Lln0:
v_pk_add_f32 v[168:169], v[0:1], v[2:3]
v_pk_mul_f32 v[170:171], v[0:1], v[0:1]
v_pk_fma_f32 v[170:171], v[2:3], v[2:3], v[170:171]
v_pk_add_f32 v[168:169], v[168:169], v[4:5]
v_pk_fma_f32 v[170:171], v[4:5], v[4:5], v[170:171]
v_pk_add_f32 v[168:169], v[168:169], v[6:7]
v_pk_fma_f32 v[170:171], v[6:7], v[6:7], v[170:171]
v_pk_add_f32 v[168:169], v[168:169], v[8:9]
v_pk_fma_f32 v[170:171], v[8:9], v[8:9], v[170:171]
v_pk_add_f32 v[168:169], v[168:169], v[10:11]
v_pk_fma_f32 v[170:171], v[10:11], v[10:11], v[170:171]
v_pk_add_f32 v[168:169], v[168:169], v[12:13]
v_pk_fma_f32 v[170:171], v[12:13], v[12:13], v[170:171]
v_pk_add_f32 v[168:169], v[168:169], v[14:15]
v_pk_fma_f32 v[170:171], v[14:15], v[14:15], v[170:171]
v_pk_add_f32 v[168:169], v[168:169], v[16:17]
v_pk_fma_f32 v[170:171], v[16:17], v[16:17], v[170:171]
v_pk_add_f32 v[168:169], v[168:169], v[18:19]
v_pk_fma_f32 v[170:171], v[18:19], v[18:19], v[170:171]
v_pk_add_f32 v[168:169], v[168:169], v[20:21]
v_pk_fma_f32 v[170:171], v[20:21], v[20:21], v[170:171]
v_pk_add_f32 v[168:169], v[168:169], v[22:23]
v_pk_fma_f32 v[170:171], v[22:23], v[22:23], v[170:171]
v_pk_add_f32 v[168:169], v[168:169], v[24:25]
v_pk_fma_f32 v[170:171], v[24:25], v[24:25], v[170:171]
v_pk_add_f32 v[168:169], v[168:169], v[26:27]
v_pk_fma_f32 v[170:171], v[26:27], v[26:27], v[170:171]
v_pk_add_f32 v[168:169], v[168:169], v[28:29]
v_pk_fma_f32 v[170:171], v[28:29], v[28:29], v[170:171]
v_pk_add_f32 v[168:169], v[168:169], v[30:31]
v_pk_fma_f32 v[170:171], v[30:31], v[30:31], v[170:171]
v_pk_add_f32 v[168:169], v[168:169], v[32:33]
v_pk_fma_f32 v[170:171], v[32:33], v[32:33], v[170:171]
v_pk_add_f32 v[168:169], v[168:169], v[34:35]
v_pk_fma_f32 v[170:171], v[34:35], v[34:35], v[170:171]
v_pk_add_f32 v[168:169], v[168:169], v[36:37]
v_pk_fma_f32 v[170:171], v[36:37], v[36:37], v[170:171]
v_pk_add_f32 v[168:169], v[168:169], v[38:39]
v_pk_fma_f32 v[170:171], v[38:39], v[38:39], v[170:171]
v_pk_add_f32 v[168:169], v[168:169], v[40:41]
v_pk_fma_f32 v[170:171], v[40:41], v[40:41], v[170:171]
v_pk_add_f32 v[168:169], v[168:169], v[42:43]
v_pk_fma_f32 v[170:171], v[42:43], v[42:43], v[170:171]
v_pk_add_f32 v[168:169], v[168:169], v[44:45]
v_pk_fma_f32 v[170:171], v[44:45], v[44:45], v[170:171]
v_pk_add_f32 v[168:169], v[168:169], v[46:47]
v_pk_fma_f32 v[170:171], v[46:47], v[46:47], v[170:171]
v_add_f32 v168, v168, v169
v_add_f32 v170, v170, v171
s_nop 1
v_permlane32_swap_b32 v168, v170
v_add_f32 v168, v168, v170
v_mul_f32 v168, 1009429163, v168
v_mov_b32 v170, v168
s_nop 1
v_permlane32_swap_b32 v168, v170
v_fma_f32 v170, -v168, v168, v170
v_max_f32 v170, 0, v170
v_add_f32 v170, 925353388, v170
v_rsq_f32 v170, v170
s_nop 0
v_mul_f32 v172, 3203391086, v170
v_mul_f32 v173, v168, v172
v_pk_fma_f32 v[0:1], v[0:1], v[172:173], v[172:173] op_sel:[0,0,1] op_sel_hi:[1,0,1] neg_lo:[0,0,1] neg_hi:[0,0,1]
v_pk_fma_f32 v[2:3], v[2:3], v[172:173], v[172:173] op_sel:[0,0,1] op_sel_hi:[1,0,1] neg_lo:[0,0,1] neg_hi:[0,0,1]
v_pk_fma_f32 v[4:5], v[4:5], v[172:173], v[172:173] op_sel:[0,0,1] op_sel_hi:[1,0,1] neg_lo:[0,0,1] neg_hi:[0,0,1]
v_pk_fma_f32 v[6:7], v[6:7], v[172:173], v[172:173] op_sel:[0,0,1] op_sel_hi:[1,0,1] neg_lo:[0,0,1] neg_hi:[0,0,1]
v_pk_fma_f32 v[8:9], v[8:9], v[172:173], v[172:173] op_sel:[0,0,1] op_sel_hi:[1,0,1] neg_lo:[0,0,1] neg_hi:[0,0,1]
v_pk_fma_f32 v[10:11], v[10:11], v[172:173], v[172:173] op_sel:[0,0,1] op_sel_hi:[1,0,1] neg_lo:[0,0,1] neg_hi:[0,0,1]
v_pk_fma_f32 v[12:13], v[12:13], v[172:173], v[172:173] op_sel:[0,0,1] op_sel_hi:[1,0,1] neg_lo:[0,0,1] neg_hi:[0,0,1]
v_pk_fma_f32 v[14:15], v[14:15], v[172:173], v[172:173] op_sel:[0,0,1] op_sel_hi:[1,0,1] neg_lo:[0,0,1] neg_hi:[0,0,1]
v_pk_fma_f32 v[16:17], v[16:17], v[172:173], v[172:173] op_sel:[0,0,1] op_sel_hi:[1,0,1] neg_lo:[0,0,1] neg_hi:[0,0,1]
v_pk_fma_f32 v[18:19], v[18:19], v[172:173], v[172:173] op_sel:[0,0,1] op_sel_hi:[1,0,1] neg_lo:[0,0,1] neg_hi:[0,0,1]
v_pk_fma_f32 v[20:21], v[20:21], v[172:173], v[172:173] op_sel:[0,0,1] op_sel_hi:[1,0,1] neg_lo:[0,0,1] neg_hi:[0,0,1]
v_pk_fma_f32 v[22:23], v[22:23], v[172:173], v[172:173] op_sel:[0,0,1] op_sel_hi:[1,0,1] neg_lo:[0,0,1] neg_hi:[0,0,1]
v_pk_fma_f32 v[24:25], v[24:25], v[172:173], v[172:173] op_sel:[0,0,1] op_sel_hi:[1,0,1] neg_lo:[0,0,1] neg_hi:[0,0,1]
v_pk_fma_f32 v[26:27], v[26:27], v[172:173], v[172:173] op_sel:[0,0,1] op_sel_hi:[1,0,1] neg_lo:[0,0,1] neg_hi:[0,0,1]
v_pk_fma_f32 v[28:29], v[28:29], v[172:173], v[172:173] op_sel:[0,0,1] op_sel_hi:[1,0,1] neg_lo:[0,0,1] neg_hi:[0,0,1]
v_pk_fma_f32 v[30:31], v[30:31], v[172:173], v[172:173] op_sel:[0,0,1] op_sel_hi:[1,0,1] neg_lo:[0,0,1] neg_hi:[0,0,1]
v_pk_fma_f32 v[32:33], v[32:33], v[172:173], v[172:173] op_sel:[0,0,1] op_sel_hi:[1,0,1] neg_lo:[0,0,1] neg_hi:[0,0,1]
v_pk_fma_f32 v[34:35], v[34:35], v[172:173], v[172:173] op_sel:[0,0,1] op_sel_hi:[1,0,1] neg_lo:[0,0,1] neg_hi:[0,0,1]
v_pk_fma_f32 v[36:37], v[36:37], v[172:173], v[172:173] op_sel:[0,0,1] op_sel_hi:[1,0,1] neg_lo:[0,0,1] neg_hi:[0,0,1]
v_pk_fma_f32 v[38:39], v[38:39], v[172:173], v[172:173] op_sel:[0,0,1] op_sel_hi:[1,0,1] neg_lo:[0,0,1] neg_hi:[0,0,1]
v_pk_fma_f32 v[40:41], v[40:41], v[172:173], v[172:173] op_sel:[0,0,1] op_sel_hi:[1,0,1] neg_lo:[0,0,1] neg_hi:[0,0,1]
v_pk_fma_f32 v[42:43], v[42:43], v[172:173], v[172:173] op_sel:[0,0,1] op_sel_hi:[1,0,1] neg_lo:[0,0,1] neg_hi:[0,0,1]
v_pk_fma_f32 v[44:45], v[44:45], v[172:173], v[172:173] op_sel:[0,0,1] op_sel_hi:[1,0,1] neg_lo:[0,0,1] neg_hi:[0,0,1]
v_pk_fma_f32 v[46:47], v[46:47], v[172:173], v[172:173] op_sel:[0,0,1] op_sel_hi:[1,0,1] neg_lo:[0,0,1] neg_hi:[0,0,1]
v_cvt_pk_bf16_f32 v48, v0, v1
v_cvt_pk_bf16_f32 v49, v2, v3
v_cvt_pk_bf16_f32 v50, v4, v5
v_cvt_pk_bf16_f32 v51, v6, v7
v_cvt_pk_bf16_f32 v52, v8, v9
v_cvt_pk_bf16_f32 v53, v10, v11
v_cvt_pk_bf16_f32 v54, v12, v13
v_cvt_pk_bf16_f32 v55, v14, v15
v_cvt_pk_bf16_f32 v56, v16, v17
v_cvt_pk_bf16_f32 v57, v18, v19
v_cvt_pk_bf16_f32 v58, v20, v21
v_cvt_pk_bf16_f32 v59, v22, v23
v_cvt_pk_bf16_f32 v60, v24, v25
v_cvt_pk_bf16_f32 v61, v26, v27
v_cvt_pk_bf16_f32 v62, v28, v29
v_cvt_pk_bf16_f32 v63, v30, v31
v_cvt_pk_bf16_f32 v64, v32, v33
v_cvt_pk_bf16_f32 v65, v34, v35
v_cvt_pk_bf16_f32 v66, v36, v37
v_cvt_pk_bf16_f32 v67, v38, v39
v_cvt_pk_bf16_f32 v68, v40, v41
v_cvt_pk_bf16_f32 v69, v42, v43
v_cvt_pk_bf16_f32 v70, v44, v45
v_cvt_pk_bf16_f32 v71, v46, v47
s_nop 1
s_setpc_b64 s[78:79]
Lw1a:
ds_read_b64_tr_b16 v[148:149], v190
ds_read_b64_tr_b16 v[150:151], v190 offset:512
ds_read_b64_tr_b16 v[152:153], v190 offset:1024
ds_read_b64_tr_b16 v[154:155], v190 offset:1536
ds_read_b64_tr_b16 v[156:157], v190 offset:2048
ds_read_b64_tr_b16 v[158:159], v190 offset:2560
ds_read_b64_tr_b16 v[160:161], v190 offset:3072
ds_read_b64_tr_b16 v[162:163], v190 offset:3584
ds_read_b64_tr_b16 v[164:165], v190 offset:4096
ds_read_b64_tr_b16 v[166:167], v190 offset:4608
ds_read_b64_tr_b16 v[168:169], v190 offset:5120
ds_read_b64_tr_b16 v[170:171], v190 offset:5632
s_waitcnt lgkmcnt(10)
ds_write_b128 v191, v[148:151]
s_waitcnt lgkmcnt(9)
ds_write_b128 v191, v[152:155] offset:1024
s_waitcnt lgkmcnt(8)
ds_write_b128 v191, v[156:159] offset:2048
s_waitcnt lgkmcnt(7)
ds_write_b128 v191, v[160:163] offset:3072
s_waitcnt lgkmcnt(6)
ds_write_b128 v191, v[164:167] offset:4096
s_waitcnt lgkmcnt(5)
ds_write_b128 v191, v[168:171] offset:5120
s_waitcnt lgkmcnt(0)
s_setpc_b64 s[78:79]
Lw1i:
s_add_u32 m0, s77, 24576
s_add_u32 s43, s3, 256
buffer_load_dwordx4 v189, s[12:15], s43 offen lds
s_add_u32 m0, s77, 25600
s_add_u32 s43, s3, 24832
buffer_load_dwordx4 v189, s[12:15], s43 offen lds
s_add_u32 m0, s77, 26624
s_add_u32 s43, s3, 49408
buffer_load_dwordx4 v189, s[12:15], s43 offen lds
s_add_u32 m0, s77, 27648
s_add_u32 s43, s3, 12544
buffer_load_dwordx4 v189, s[12:15], s43 offen lds
s_add_u32 m0, s77, 28672
s_add_u32 s43, s3, 37120
buffer_load_dwordx4 v189, s[12:15], s43 offen lds
s_add_u32 m0, s77, 29696
s_add_u32 s43, s3, 61696
buffer_load_dwordx4 v189, s[12:15], s43 offen lds
s_add_u32 m0, s77, 49152
s_add_u32 s43, s3, 512
buffer_load_dwordx4 v189, s[12:15], s43 offen lds
s_add_u32 m0, s77, 50176
s_add_u32 s43, s3, 25088
buffer_load_dwordx4 v189, s[12:15], s43 offen lds
s_add_u32 m0, s77, 51200
s_add_u32 s43, s3, 49664
buffer_load_dwordx4 v189, s[12:15], s43 offen lds
s_add_u32 m0, s77, 52224
s_add_u32 s43, s3, 12800
buffer_load_dwordx4 v189, s[12:15], s43 offen lds
s_add_u32 m0, s77, 53248
s_add_u32 s43, s3, 37376
buffer_load_dwordx4 v189, s[12:15], s43 offen lds
s_add_u32 m0, s77, 54272
s_add_u32 s43, s3, 61952
buffer_load_dwordx4 v189, s[12:15], s43 offen lds
s_setpc_b64 s[78:79]
Lw1b:
ds_read_b64_tr_b16 v[72:73], v190 offset:24576
ds_read_b64_tr_b16 v[74:75], v190 offset:25088
ds_read_b64_tr_b16 v[76:77], v190 offset:25600
ds_read_b64_tr_b16 v[78:79], v190 offset:26112
ds_read_b64_tr_b16 v[80:81], v190 offset:26624
ds_read_b64_tr_b16 v[82:83], v190 offset:27136
ds_read_b64_tr_b16 v[84:85], v190 offset:27648
ds_read_b64_tr_b16 v[86:87], v190 offset:28160
ds_read_b64_tr_b16 v[88:89], v190 offset:28672
ds_read_b64_tr_b16 v[90:91], v190 offset:29184
ds_read_b64_tr_b16 v[92:93], v190 offset:29696
ds_read_b64_tr_b16 v[94:95], v190 offset:30208
s_waitcnt lgkmcnt(10)
ds_write_b128 v191, v[72:75] offset:24576
s_waitcnt lgkmcnt(9)
ds_write_b128 v191, v[76:79] offset:25600
s_waitcnt lgkmcnt(8)
ds_write_b128 v191, v[80:83] offset:26624
s_waitcnt lgkmcnt(7)
ds_write_b128 v191, v[84:87] offset:27648
s_waitcnt lgkmcnt(6)
ds_write_b128 v191, v[88:91] offset:28672
s_waitcnt lgkmcnt(5)
ds_write_b128 v191, v[92:95] offset:29696
s_waitcnt lgkmcnt(0)
s_setpc_b64 s[78:79]
Lw1c:
ds_read_b64_tr_b16 v[72:73], v190 offset:49152
ds_read_b64_tr_b16 v[74:75], v190 offset:49664
ds_read_b64_tr_b16 v[76:77], v190 offset:50176
ds_read_b64_tr_b16 v[78:79], v190 offset:50688
ds_read_b64_tr_b16 v[80:81], v190 offset:51200
ds_read_b64_tr_b16 v[82:83], v190 offset:51712
ds_read_b64_tr_b16 v[84:85], v190 offset:52224
ds_read_b64_tr_b16 v[86:87], v190 offset:52736
ds_read_b64_tr_b16 v[88:89], v190 offset:53248
ds_read_b64_tr_b16 v[90:91], v190 offset:53760
ds_read_b64_tr_b16 v[92:93], v190 offset:54272
ds_read_b64_tr_b16 v[94:95], v190 offset:54784
s_waitcnt lgkmcnt(10)
ds_write_b128 v191, v[72:75] offset:49152
s_waitcnt lgkmcnt(9)
ds_write_b128 v191, v[76:79] offset:50176
s_waitcnt lgkmcnt(8)
ds_write_b128 v191, v[80:83] offset:51200
s_waitcnt lgkmcnt(7)
ds_write_b128 v191, v[84:87] offset:52224
s_waitcnt lgkmcnt(6)
ds_write_b128 v191, v[88:91] offset:53248
s_waitcnt lgkmcnt(5)
ds_write_b128 v191, v[92:95] offset:54272
s_waitcnt lgkmcnt(0)
s_setpc_b64 s[78:79]
Lpre:
ds_read_b128 v[48:51], v245
ds_read_b128 v[52:55], v245 offset:384
ds_read_b128 v[56:59], v245 offset:768
ds_read_b128 v[60:63], v245 offset:1152
ds_read_b128 v[64:67], v245 offset:1536
ds_read_b128 v[68:71], v245 offset:1920
ds_read_b128 v[72:75], v245 offset:2304
ds_read_b128 v[76:79], v245 offset:2688
ds_read_b128 v[80:83], v245 offset:3072
ds_read_b128 v[84:87], v245 offset:3456
ds_read_b128 v[88:91], v245 offset:3840
ds_read_b128 v[92:95], v245 offset:4224
ds_read_b128 v[96:99], v245 offset:4608
ds_read_b128 v[100:103], v245 offset:4992
ds_read_b128 v[104:107], v245 offset:5376
ds_read_b128 v[108:111], v245 offset:5760
ds_read_b128 v[112:115], v245 offset:6144
ds_read_b128 v[116:119], v245 offset:6528
v_mov_b32 v0, 0
v_mov_b32 v1, 0
v_mov_b32 v2, 0
v_mov_b32 v3, 0
v_mov_b32 v4, 0
v_mov_b32 v5, 0
v_mov_b32 v6, 0
v_mov_b32 v7, 0
v_mov_b32 v8, 0
v_mov_b32 v9, 0
v_mov_b32 v10, 0
v_mov_b32 v11, 0
v_mov_b32 v12, 0
v_mov_b32 v13, 0
v_mov_b32 v14, 0
v_mov_b32 v15, 0
v_mov_b32 v16, 0
v_mov_b32 v17, 0
v_mov_b32 v18, 0
v_mov_b32 v19, 0
v_mov_b32 v20, 0
v_mov_b32 v21, 0
v_mov_b32 v22, 0
v_mov_b32 v23, 0
v_mov_b32 v24, 0
v_mov_b32 v25, 0
v_mov_b32 v26, 0
v_mov_b32 v27, 0
v_mov_b32 v28, 0
v_mov_b32 v29, 0
v_mov_b32 v30, 0
v_mov_b32 v31, 0
v_mov_b32 v32, 0
v_mov_b32 v33, 0
v_mov_b32 v34, 0
v_mov_b32 v35, 0
v_mov_b32 v36, 0
v_mov_b32 v37, 0
v_mov_b32 v38, 0
v_mov_b32 v39, 0
v_mov_b32 v40, 0
v_mov_b32 v41, 0
v_mov_b32 v42, 0
v_mov_b32 v43, 0
v_mov_b32 v44, 0
v_mov_b32 v45, 0
v_mov_b32 v46, 0
v_mov_b32 v47, 0
s_waitcnt lgkmcnt(0)
s_setpc_b64 s[78:79]
Lrb:
s_add_u32 m0, s67, 39936
s_add_u32 s45, s66, 491520
buffer_load_dwordx4 v240, s[4:7], s45 offen nt lds
s_add_u32 m0, s67, 46592
s_add_u32 s45, s66, 589824
buffer_load_dwordx4 v240, s[4:7], s45 offen nt lds
s_add_u32 m0, s67, 53248
s_add_u32 s45, s66, 688128
buffer_load_dwordx4 v240, s[4:7], s45 offen nt lds
s_add_u32 m0, s67, 59904
s_add_u32 s45, s66, 786432
buffer_load_dwordx4 v240, s[4:7], s45 offen nt lds
s_setpc_b64 s[78:79]
Lw1f:
s_add_u32 m0, s77, 0
s_add_u32 s43, s3, 0
buffer_load_dwordx4 v189, s[12:15], s43 offen lds
s_add_u32 m0, s77, 1024
s_add_u32 s43, s3, 24576
buffer_load_dwordx4 v189, s[12:15], s43 offen lds
s_add_u32 m0, s77, 2048
s_add_u32 s43, s3, 49152
buffer_load_dwordx4 v189, s[12:15], s43 offen lds
s_add_u32 m0, s77, 3072
s_add_u32 s43, s3, 12288
buffer_load_dwordx4 v189, s[12:15], s43 offen lds
s_add_u32 m0, s77, 4096
s_add_u32 s43, s3, 36864
buffer_load_dwordx4 v189, s[12:15], s43 offen lds
s_add_u32 m0, s77, 5120
s_add_u32 s43, s3, 61440
buffer_load_dwordx4 v189, s[12:15], s43 offen lds
s_setpc_b64 s[78:79]
Lgo:
v_mov_b32 v253, 16256
Lsw204w:
ds_read_b32 v247, v253 offset:20
s_waitcnt lgkmcnt(0)
v_readfirstlane_b32 s43, v247
s_cmp_eq_u32 s76, 0
s_cbranch_scc1 Lsw204x
s_sub_u32 s76, s76, 1
s_cmp_lt_u32 s43, 4
s_cbranch_scc0 Lsw204x
s_sleep 2
s_branch Lsw204w
Lsw204x:
s_cmp_lg_u32 s40, 7
s_cbranch_scc1 Lnopf
s_getpc_b64 s[74:75]
Lpc:
s_lshr_b32 s43, s2, 3
s_and_b32 s43, s43, 15
s_lshl_b32 s43, s43, 13
v_lshlrev_b32 v102, 7, v251
v_add_u32 v102, s43, v102
v_min_u32 v102, Lend-Lpc, v102
global_load_dword v255, v102, s[74:75]
Lnopf:
s_add_u32 s66, s66, 786432
ds_read_b128 v[224:227], v248 offset:16384
ds_read_b128 v[228:231], v248 offset:19456
ds_read_b128 v[232:235], v248 offset:17408
ds_read_b128 v[236:239], v248 offset:20480
ds_read_b128 v[216:219], v248 offset:18432
ds_read_b128 v[220:223], v248 offset:21504
s_setprio 2
s_waitcnt lgkmcnt(5)
v_mfma_f32_32x32x16_bf16 v[120:135], v[48:51], v[224:227], 0
s_waitcnt lgkmcnt(4)
ds_read_b128 v[224:227], v248 offset:22528
v_mfma_f32_32x32x16_bf16 v[120:135], v[52:55], v[228:231], v[120:135]
s_waitcnt lgkmcnt(4)
ds_read_b128 v[228:231], v248 offset:25600
v_mfma_f32_32x32x16_bf16 v[120:135], v[56:59], v[232:235], v[120:135]
s_waitcnt lgkmcnt(4)
ds_read_b128 v[232:235], v248 offset:23552
v_mfma_f32_32x32x16_bf16 v[120:135], v[60:63], v[236:239], v[120:135]
s_waitcnt lgkmcnt(4)
ds_read_b128 v[236:239], v248 offset:26624
v_mfma_f32_32x32x16_bf16 v[120:135], v[64:67], v[216:219], v[120:135]
s_waitcnt lgkmcnt(4)
ds_read_b128 v[216:219], v248 offset:24576
v_mfma_f32_32x32x16_bf16 v[120:135], v[68:71], v[220:223], v[120:135]
v_add_u32 v174, -36864, v242
v_subrev_u32 v175, 66560, v174
v_min_u32 v174, v174, v175
v_add_u32 v174, 90112, v174
v_sub_u32 v175, v174, v242
v_add_u32 v242, v175, v242
v_add_u32 v243, v175, v243
v_add_u32 v244, v175, v244
s_nop 3
v_cvt_pkrtz_f16_f32 v137, v120, v121
v_cvt_pkrtz_f16_f32 v139, v122, v123
v_cvt_pkrtz_f16_f32 v141, v124, v125
v_cvt_pkrtz_f16_f32 v143, v126, v127
v_cvt_pkrtz_f16_f32 v177, v128, v129
v_cvt_pk_f16_f32 v155, v130, v131
v_cvt_pk_f16_f32 v152, v132, v133
v_cvt_pk_f16_f32 v149, v134, v135
s_waitcnt lgkmcnt(1)
ds_read_b128 v[220:223], v248 offset:27648
v_mfma_f32_32x32x16_bf16 v[120:135], v[48:51], v[224:227], 0
v_pk_fma_f16 v154, v155, v155, s48
v_and_b32 v137, s49, v137
v_pk_fma_f16 v151, v152, v152, s48
v_pk_fma_f16 v148, v149, v149, s48
v_lshrrev_b16 v136, 2, v137
v_pk_mul_f16 v154, v155, v154
v_pk_mul_f16 v151, v152, v151
v_pk_mul_f16 v148, v149, v148
ds_read_b128 v[224:227], v248 offset:28672
ds_read_u16_d16 v136, v136
v_mfma_f32_32x32x16_bf16 v[120:135], v[52:55], v[228:231], v[120:135]
v_lshrrev_b32 v137, 18, v137
v_exp_f16 v153, v154
v_exp_f16 v150, v151
v_and_b32 v139, s49, v139
v_exp_f16 v147, v148
v_lshrrev_b16 v138, 2, v139
ds_read_b128 v[228:231], v248 offset:31744
ds_read_u16_d16_hi v137, v137
ds_read_u16_d16 v138, v138
v_mfma_f32_32x32x16_bf16 v[120:135], v[56:59], v[232:235], v[120:135]
v_exp_f16_sdwa v153, v154 dst_sel:WORD_1 dst_unused:UNUSED_PRESERVE src0_sel:WORD_1
v_lshrrev_b32 v139, 18, v139
v_exp_f16_sdwa v150, v151 dst_sel:WORD_1 dst_unused:UNUSED_PRESERVE src0_sel:WORD_1
v_exp_f16_sdwa v147, v148 dst_sel:WORD_1 dst_unused:UNUSED_PRESERVE src0_sel:WORD_1
v_and_b32 v141, s49, v141
ds_read_b128 v[232:235], v248 offset:29696
ds_read_u16_d16_hi v139, v139
v_mfma_f32_32x32x16_bf16 v[120:135], v[60:63], v[236:239], v[120:135]
v_pk_add_f16 v153, v153, 1.0 op_sel_hi:[1,0]
v_lshrrev_b16 v140, 2, v141
v_pk_add_f16 v150, v150, 1.0 op_sel_hi:[1,0]
v_pk_add_f16 v147, v147, 1.0 op_sel_hi:[1,0]
v_rcp_f16 v154, v153
v_lshrrev_b32 v141, 18, v141
v_rcp_f16 v151, v150
s_waitcnt lgkmcnt(5)
ds_read_b128 v[236:239], v248 offset:32768
ds_read_u16_d16 v140, v140
ds_read_u16_d16_hi v141, v141
v_mfma_f32_32x32x16_bf16 v[120:135], v[64:67], v[216:219], v[120:135]
v_and_b32 v143, s49, v143
v_rcp_f16 v148, v147
v_lshrrev_b16 v142, 2, v143
v_rcp_f16_sdwa v154, v153 dst_sel:WORD_1 dst_unused:UNUSED_PRESERVE src0_sel:WORD_1
v_rcp_f16_sdwa v151, v150 dst_sel:WORD_1 dst_unused:UNUSED_PRESERVE src0_sel:WORD_1
ds_read_b128 v[216:219], v248 offset:30720
ds_read_u16_d16 v142, v142
ds_read_b32 v247, v253 offset:16
v_mfma_f32_32x32x16_bf16 v[120:135], v[68:71], v[220:223], v[120:135]
v_lshrrev_b32 v143, 18, v143
v_rcp_f16_sdwa v148, v147 dst_sel:WORD_1 dst_unused:UNUSED_PRESERVE src0_sel:WORD_1
v_and_b32 v177, s49, v177
v_pk_mul_f16 v155, v155, v154
v_pk_mul_f16 v152, v152, v151
v_lshrrev_b16 v176, 2, v177
v_pk_mul_f16 v149, v149, v148
v_fma_mix_f32 v156, v155, v155, 0 op_sel:[0,0,0] op_sel_hi:[1,1,0]
v_fma_mix_f32 v156, v155, v155, v156 op_sel:[1,1,0] op_sel_hi:[1,1,0]
v_lshrrev_b32 v177, 18, v177
v_fma_mix_f32 v156, v152, v152, v156 op_sel:[0,0,0] op_sel_hi:[1,1,0]
v_fma_mix_f32 v156, v152, v152, v156 op_sel:[1,1,0] op_sel_hi:[1,1,0]
v_fma_mix_f32 v156, v149, v149, v156 op_sel:[0,0,0] op_sel_hi:[1,1,0]
v_fma_mix_f32 v156, v149, v149, v156 op_sel:[1,1,0] op_sel_hi:[1,1,0]
ds_read_u16_d16_hi v143, v143
ds_read_u16_d16 v176, v176
ds_read_u16_d16_hi v177, v177
s_waitcnt lgkmcnt(3)
v_readfirstlane_b32 s43, v247
s_nop 1
s_cmp_ge_u32 s43, 8
s_cbranch_scc1 Lev1
Lev1w:
s_sleep 1
ds_read_b32 v247, v253 offset:16
s_waitcnt lgkmcnt(0)
v_readfirstlane_b32 s43, v247
s_cmp_eq_u32 s76, 0
s_cbranch_scc1 Lev1
s_sub_u32 s76, s76, 1
s_cmp_lt_u32 s43, 8
s_cbranch_scc1 Lev1w
Lev1:
v_cvt_pkrtz_f16_f32 v179, v120, v121
v_cvt_pkrtz_f16_f32 v181, v122, v123
v_cvt_pkrtz_f16_f32 v183, v124, v125
v_cvt_pkrtz_f16_f32 v185, v126, v127
v_cvt_pkrtz_f16_f32 v187, v128, v129
v_cvt_pk_f16_f32 v155, v130, v131
v_cvt_pk_f16_f32 v152, v132, v133
v_cvt_pk_f16_f32 v149, v134, v135
s_add_u32 m0, s67, 0
s_add_u32 s66, s66, 98304
buffer_load_dwordx4 v240, s[4:7], s66 offen lds
ds_read_b128 v[220:223], v248 offset:33792
v_mfma_f32_32x32x16_bf16 v[120:135], v[48:51], v[224:227], 0
v_pk_fma_f16 v154, v155, v155, s48
v_and_b32 v179, s49, v179
v_fma_mix_f32 v156, v136, v136, v156 op_sel:[0,0,0] op_sel_hi:[1,1,0]
v_pk_fma_f16 v151, v152, v152, s48
v_pk_fma_f16 v148, v149, v149, s48
v_lshrrev_b16 v178, 2, v179
v_pk_mul_f16 v154, v155, v154
v_pk_mul_f16 v151, v152, v151
v_fma_mix_f32 v156, v137, v137, v156 op_sel:[1,1,0] op_sel_hi:[1,1,0]
v_lshrrev_b32 v179, 18, v179
s_add_u32 m0, s67, 6656
s_add_u32 s66, s66, 98304
buffer_load_dwordx4 v240, s[4:7], s66 offen lds
ds_read_b128 v[224:227], v248 offset:34816
ds_read_u16_d16 v178, v178
ds_read_u16_d16_hi v179, v179
v_mfma_f32_32x32x16_bf16 v[120:135], v[52:55], v[228:231], v[120:135]
v_pk_mul_f16 v148, v149, v148
v_exp_f16 v153, v154
v_exp_f16 v150, v151
v_and_b32 v181, s49, v181
v_fma_mix_f32 v156, v138, v138, v156 op_sel:[0,0,0] op_sel_hi:[1,1,0]
v_exp_f16 v147, v148
v_lshrrev_b16 v180, 2, v181
s_add_u32 m0, s67, 13312
s_add_u32 s66, s66, 98304
buffer_load_dwordx4 v240, s[4:7], s66 offen lds
ds_read_b128 v[228:231], v248 offset:37888
ds_read_u16_d16 v180, v180
v_mfma_f32_32x32x16_bf16 v[120:135], v[56:59], v[232:235], v[120:135]
v_exp_f16_sdwa v153, v154 dst_sel:WORD_1 dst_unused:UNUSED_PRESERVE src0_sel:WORD_1
v_lshrrev_b32 v181, 18, v181
v_fma_mix_f32 v156, v139, v139, v156 op_sel:[1,1,0] op_sel_hi:[1,1,0]
v_exp_f16_sdwa v150, v151 dst_sel:WORD_1 dst_unused:UNUSED_PRESERVE src0_sel:WORD_1
v_exp_f16_sdwa v147, v148 dst_sel:WORD_1 dst_unused:UNUSED_PRESERVE src0_sel:WORD_1
v_and_b32 v183, s49, v183
v_fma_mix_f32 v156, v140, v140, v156 op_sel:[0,0,0] op_sel_hi:[1,1,0]
s_add_u32 m0, s67, 19968
s_add_u32 s66, s66, 98304
buffer_load_dwordx4 v240, s[4:7], s66 offen lds
s_add_u32 m0, s67, 26624
s_add_u32 s66, s66, 98304
buffer_load_dwordx4 v240, s[4:7], s66 offen lds
ds_read_b128 v[232:235], v248 offset:35840
ds_read_u16_d16_hi v181, v181
v_mfma_f32_32x32x16_bf16 v[120:135], v[60:63], v[236:239], v[120:135]
v_pk_add_f16 v153, v153, 1.0 op_sel_hi:[1,0]
v_lshrrev_b16 v182, 2, v183
v_pk_add_f16 v150, v150, 1.0 op_sel_hi:[1,0]
v_pk_add_f16 v147, v147, 1.0 op_sel_hi:[1,0]
v_rcp_f16 v154, v153
v_lshrrev_b32 v183, 18, v183
v_fma_mix_f32 v156, v141, v141, v156 op_sel:[1,1,0] op_sel_hi:[1,1,0]
v_rcp_f16 v151, v150
s_add_u32 m0, s67, 33280
s_add_u32 s66, s66, 98304
buffer_load_dwordx4 v240, s[4:7], s66 offen lds
ds_read_b128 v[236:239], v248 offset:38912
ds_read_u16_d16 v182, v182
ds_read_u16_d16_hi v183, v183
v_mfma_f32_32x32x16_bf16 v[120:135], v[64:67], v[216:219], v[120:135]
v_and_b32 v185, s49, v185
v_rcp_f16 v148, v147
v_fma_mix_f32 v156, v142, v142, v156 op_sel:[0,0,0] op_sel_hi:[1,1,0]
v_lshrrev_b16 v184, 2, v185
v_rcp_f16_sdwa v154, v153 dst_sel:WORD_1 dst_unused:UNUSED_PRESERVE src0_sel:WORD_1
v_rcp_f16_sdwa v151, v150 dst_sel:WORD_1 dst_unused:UNUSED_PRESERVE src0_sel:WORD_1
v_lshrrev_b32 v185, 18, v185
s_waitcnt lgkmcnt(4)
s_add_u32 m0, s67, 39936
s_add_u32 s66, s66, 98304
buffer_load_dwordx4 v240, s[4:7], s66 offen lds
ds_read_b128 v[216:219], v248 offset:36864
ds_read_u16_d16 v184, v184
ds_read_u16_d16_hi v185, v185
v_mfma_f32_32x32x16_bf16 v[120:135], v[68:71], v[220:223], v[120:135]
v_fma_mix_f32 v156, v143, v143, v156 op_sel:[1,1,0] op_sel_hi:[1,1,0]
v_rcp_f16_sdwa v148, v147 dst_sel:WORD_1 dst_unused:UNUSED_PRESERVE src0_sel:WORD_1
v_and_b32 v187, s49, v187
v_pk_mul_f16 v155, v155, v154
v_fma_mix_f32 v156, v176, v176, v156 op_sel:[0,0,0] op_sel_hi:[1,1,0]
v_pk_mul_f16 v152, v152, v151
v_lshrrev_b16 v186, 2, v187
v_pk_mul_f16 v149, v149, v148
v_fma_mix_f32 v157, v155, v155, 0 op_sel:[0,0,0] op_sel_hi:[1,1,0]
s_add_u32 m0, s67, 46592
s_add_u32 s66, s66, 98304
buffer_load_dwordx4 v240, s[4:7], s66 offen lds
v_fma_mix_f32 v157, v155, v155, v157 op_sel:[1,1,0] op_sel_hi:[1,1,0]
v_lshrrev_b32 v187, 18, v187
v_fma_mix_f32 v156, v177, v177, v156 op_sel:[1,1,0] op_sel_hi:[1,1,0]
v_fma_mix_f32 v157, v152, v152, v157 op_sel:[0,0,0] op_sel_hi:[1,1,0]
v_fma_mix_f32 v157, v152, v152, v157 op_sel:[1,1,0] op_sel_hi:[1,1,0]
v_fma_mix_f32 v157, v149, v149, v157 op_sel:[0,0,0] op_sel_hi:[1,1,0]
v_fma_mix_f32 v157, v149, v149, v157 op_sel:[1,1,0] op_sel_hi:[1,1,0]
s_cmp_lt_u32 s40, 4
s_cbranch_scc0 Lsu5
s_waitcnt vmcnt(14)
s_call_b64 s[78:79], Lw1b
s_mov_b64 exec, 1
ds_add_u32 v253, v254 offset:24
s_mov_b64 exec, -1
Lsu5:
s_setprio 1
v_cvt_pkrtz_f16_f32 v137, v120, v121
v_cvt_pkrtz_f16_f32 v139, v122, v123
v_cvt_pkrtz_f16_f32 v141, v124, v125
v_cvt_pkrtz_f16_f32 v143, v126, v127
v_cvt_pkrtz_f16_f32 v177, v128, v129
v_cvt_pk_f16_f32 v155, v130, v131
v_cvt_pk_f16_f32 v152, v132, v133
v_cvt_pk_f16_f32 v149, v134, v135
ds_read_b128 v[220:223], v248 offset:39936
ds_read_u16_d16 v186, v186
ds_read_u16_d16_hi v187, v187
v_mfma_f32_32x32x16_bf16 v[120:135], v[48:51], v[224:227], 0
v_pk_fma_f16 v154, v155, v155, s48
v_and_b32 v137, s49, v137
v_fma_mix_f32 v157, v178, v178, v157 op_sel:[0,0,0] op_sel_hi:[1,1,0]
v_pk_fma_f16 v151, v152, v152, s48
v_pk_fma_f16 v148, v149, v149, s48
v_lshrrev_b16 v136, 2, v137
v_pk_mul_f16 v154, v155, v154
v_pk_mul_f16 v151, v152, v151
v_fma_mix_f32 v157, v179, v179, v157 op_sel:[1,1,0] op_sel_hi:[1,1,0]
v_lshrrev_b32 v137, 18, v137
ds_read_u16_d16 v136, v136
ds_read_b32 v247, v253 offset:24
ds_read_u16_d16_hi v137, v137
v_mfma_f32_32x32x16_bf16 v[120:135], v[52:55], v[228:231], v[120:135]
v_pk_mul_f16 v148, v149, v148
v_exp_f16 v153, v154
v_exp_f16 v150, v151
v_and_b32 v139, s49, v139
v_fma_mix_f32 v157, v180, v180, v157 op_sel:[0,0,0] op_sel_hi:[1,1,0]
v_exp_f16 v147, v148
v_lshrrev_b16 v138, 2, v139
ds_read_u16_d16 v138, v138
v_mfma_f32_32x32x16_bf16 v[120:135], v[56:59], v[232:235], v[120:135]
v_exp_f16_sdwa v153, v154 dst_sel:WORD_1 dst_unused:UNUSED_PRESERVE src0_sel:WORD_1
v_lshrrev_b32 v139, 18, v139
s_waitcnt lgkmcnt(4)
v_fma_mix_f32 v157, v181, v181, v157 op_sel:[1,1,0] op_sel_hi:[1,1,0]
v_exp_f16_sdwa v150, v151 dst_sel:WORD_1 dst_unused:UNUSED_PRESERVE src0_sel:WORD_1
v_exp_f16_sdwa v147, v148 dst_sel:WORD_1 dst_unused:UNUSED_PRESERVE src0_sel:WORD_1
v_and_b32 v141, s49, v141
v_fma_mix_f32 v157, v182, v182, v157 op_sel:[0,0,0] op_sel_hi:[1,1,0]
ds_read_u16_d16_hi v139, v139
s_waitcnt lgkmcnt(3)
v_readfirstlane_b32 s43, v247
s_nop 1
s_cmp_ge_u32 s43, 4
s_cbranch_scc1 Lev2
Lev2w:
s_sleep 1
ds_read_b32 v247, v253 offset:24
s_waitcnt lgkmcnt(0)
v_readfirstlane_b32 s43, v247
s_cmp_eq_u32 s76, 0
s_cbranch_scc1 Lev2
s_sub_u32 s76, s76, 1
s_cmp_lt_u32 s43, 4
s_cbranch_scc1 Lev2w
Lev2:
ds_read_b128 v[224:227], v248 offset:40960
ds_read_b128 v[228:231], v248 offset:44032
ds_read_b128 v[232:235], v248 offset:41984
v_mfma_f32_32x32x16_bf16 v[120:135], v[60:63], v[236:239], v[120:135]
v_pk_add_f16 v153, v153, 1.0 op_sel_hi:[1,0]
v_lshrrev_b16 v140, 2, v141
v_pk_add_f16 v150, v150, 1.0 op_sel_hi:[1,0]
v_pk_add_f16 v147, v147, 1.0 op_sel_hi:[1,0]
v_rcp_f16 v154, v153
v_lshrrev_b32 v141, 18, v141
v_fma_mix_f32 v157, v183, v183, v157 op_sel:[1,1,0] op_sel_hi:[1,1,0]
v_rcp_f16 v151, v150
ds_read_b128 v[236:239], v248 offset:45056
ds_read_u16_d16 v140, v140
ds_read_u16_d16_hi v141, v141
v_mfma_f32_32x32x16_bf16 v[120:135], v[64:67], v[216:219], v[120:135]
v_and_b32 v143, s49, v143
v_rcp_f16 v148, v147
v_fma_mix_f32 v157, v184, v184, v157 op_sel:[0,0,0] op_sel_hi:[1,1,0]
v_lshrrev_b16 v142, 2, v143
v_rcp_f16_sdwa v154, v153 dst_sel:WORD_1 dst_unused:UNUSED_PRESERVE src0_sel:WORD_1
v_rcp_f16_sdwa v151, v150 dst_sel:WORD_1 dst_unused:UNUSED_PRESERVE src0_sel:WORD_1
v_lshrrev_b32 v143, 18, v143
ds_read_b128 v[216:219], v248 offset:43008
ds_read_u16_d16 v142, v142
ds_read_u16_d16_hi v143, v143
v_mfma_f32_32x32x16_bf16 v[120:135], v[68:71], v[220:223], v[120:135]
v_fma_mix_f32 v157, v185, v185, v157 op_sel:[1,1,0] op_sel_hi:[1,1,0]
v_rcp_f16_sdwa v148, v147 dst_sel:WORD_1 dst_unused:UNUSED_PRESERVE src0_sel:WORD_1
v_and_b32 v177, s49, v177
v_pk_mul_f16 v155, v155, v154
v_fma_mix_f32 v157, v186, v186, v157 op_sel:[0,0,0] op_sel_hi:[1,1,0]
v_pk_mul_f16 v152, v152, v151
v_lshrrev_b16 v176, 2, v177
v_pk_mul_f16 v149, v149, v148
v_fma_mix_f32 v158, v155, v155, 0 op_sel:[0,0,0] op_sel_hi:[1,1,0]
v_fma_mix_f32 v158, v155, v155, v158 op_sel:[1,1,0] op_sel_hi:[1,1,0]
v_lshrrev_b32 v177, 18, v177
v_fma_mix_f32 v157, v187, v187, v157 op_sel:[1,1,0] op_sel_hi:[1,1,0]
v_fma_mix_f32 v158, v152, v152, v158 op_sel:[0,0,0] op_sel_hi:[1,1,0]
v_fma_mix_f32 v158, v152, v152, v158 op_sel:[1,1,0] op_sel_hi:[1,1,0]
v_fma_mix_f32 v158, v149, v149, v158 op_sel:[0,0,0] op_sel_hi:[1,1,0]
v_fma_mix_f32 v158, v149, v149, v158 op_sel:[1,1,0] op_sel_hi:[1,1,0]
v_cvt_pkrtz_f16_f32 v179, v120, v121
v_cvt_pkrtz_f16_f32 v181, v122, v123
v_cvt_pkrtz_f16_f32 v183, v124, v125
v_cvt_pkrtz_f16_f32 v185, v126, v127
v_cvt_pkrtz_f16_f32 v187, v128, v129
v_cvt_pk_f16_f32 v155, v130, v131
v_cvt_pk_f16_f32 v152, v132, v133
v_cvt_pk_f16_f32 v149, v134, v135
s_waitcnt lgkmcnt(0)
ds_read_b128 v[220:223], v248 offset:46080
ds_read_u16_d16 v176, v176
ds_read_u16_d16_hi v177, v177
v_mfma_f32_32x32x16_bf16 v[120:135], v[48:51], v[224:227], 0
v_pk_fma_f16 v154, v155, v155, s48
v_and_b32 v179, s49, v179
v_fma_mix_f32 v158, v136, v136, v158 op_sel:[0,0,0] op_sel_hi:[1,1,0]
v_pk_fma_f16 v151, v152, v152, s48
v_pk_fma_f16 v148, v149, v149, s48
v_lshrrev_b16 v178, 2, v179
v_pk_mul_f16 v154, v155, v154
v_pk_mul_f16 v151, v152, v151
v_fma_mix_f32 v158, v137, v137, v158 op_sel:[1,1,0] op_sel_hi:[1,1,0]
v_lshrrev_b32 v179, 18, v179
ds_read_b128 v[224:227], v248 offset:47104
ds_read_u16_d16 v178, v178
ds_read_u16_d16_hi v179, v179
v_mfma_f32_32x32x16_bf16 v[120:135], v[52:55], v[228:231], v[120:135]
v_pk_mul_f16 v148, v149, v148
v_exp_f16 v153, v154
v_exp_f16 v150, v151
v_and_b32 v181, s49, v181
v_fma_mix_f32 v158, v138, v138, v158 op_sel:[0,0,0] op_sel_hi:[1,1,0]
v_exp_f16 v147, v148
v_lshrrev_b16 v180, 2, v181
ds_read_b128 v[228:231], v248 offset:50176
ds_read_u16_d16 v180, v180
v_mfma_f32_32x32x16_bf16 v[120:135], v[56:59], v[232:235], v[120:135]
v_exp_f16_sdwa v153, v154 dst_sel:WORD_1 dst_unused:UNUSED_PRESERVE src0_sel:WORD_1
v_lshrrev_b32 v181, 18, v181
v_fma_mix_f32 v158, v139, v139, v158 op_sel:[1,1,0] op_sel_hi:[1,1,0]
v_exp_f16_sdwa v150, v151 dst_sel:WORD_1 dst_unused:UNUSED_PRESERVE src0_sel:WORD_1
v_exp_f16_sdwa v147, v148 dst_sel:WORD_1 dst_unused:UNUSED_PRESERVE src0_sel:WORD_1
v_and_b32 v183, s49, v183
v_fma_mix_f32 v158, v140, v140, v158 op_sel:[0,0,0] op_sel_hi:[1,1,0]
ds_read_b128 v[232:235], v248 offset:48128
ds_read_u16_d16_hi v181, v181
v_mfma_f32_32x32x16_bf16 v[120:135], v[60:63], v[236:239], v[120:135]
v_pk_add_f16 v153, v153, 1.0 op_sel_hi:[1,0]
v_lshrrev_b16 v182, 2, v183
v_pk_add_f16 v150, v150, 1.0 op_sel_hi:[1,0]
v_pk_add_f16 v147, v147, 1.0 op_sel_hi:[1,0]
v_rcp_f16 v154, v153
v_lshrrev_b32 v183, 18, v183
v_fma_mix_f32 v158, v141, v141, v158 op_sel:[1,1,0] op_sel_hi:[1,1,0]
v_rcp_f16 v151, v150
ds_read_b128 v[236:239], v248 offset:51200
ds_read_u16_d16 v182, v182
ds_read_u16_d16_hi v183, v183
v_mfma_f32_32x32x16_bf16 v[120:135], v[64:67], v[216:219], v[120:135]
v_and_b32 v185, s49, v185
v_rcp_f16 v148, v147
v_fma_mix_f32 v158, v142, v142, v158 op_sel:[0,0,0] op_sel_hi:[1,1,0]
v_lshrrev_b16 v184, 2, v185
v_rcp_f16_sdwa v154, v153 dst_sel:WORD_1 dst_unused:UNUSED_PRESERVE src0_sel:WORD_1
v_rcp_f16_sdwa v151, v150 dst_sel:WORD_1 dst_unused:UNUSED_PRESERVE src0_sel:WORD_1
v_lshrrev_b32 v185, 18, v185
s_waitcnt lgkmcnt(5)
ds_read_b128 v[216:219], v248 offset:49152
ds_read_u16_d16 v184, v184
ds_read_u16_d16_hi v185, v185
v_mfma_f32_32x32x16_bf16 v[120:135], v[68:71], v[220:223], v[120:135]
v_fma_mix_f32 v158, v143, v143, v158 op_sel:[1,1,0] op_sel_hi:[1,1,0]
v_rcp_f16_sdwa v148, v147 dst_sel:WORD_1 dst_unused:UNUSED_PRESERVE src0_sel:WORD_1
s_cmp_eq_u32 s40, 7
s_cbranch_scc1 Lrdy8
s_waitcnt vmcnt(0)
Lrdy8:
s_mov_b64 exec, 1
ds_add_u32 v253, v254 offset:12
s_mov_b64 exec, -1
v_and_b32 v187, s49, v187
v_pk_mul_f16 v155, v155, v154
v_fma_mix_f32 v158, v176, v176, v158 op_sel:[0,0,0] op_sel_hi:[1,1,0]
v_pk_mul_f16 v152, v152, v151
v_lshrrev_b16 v186, 2, v187
v_pk_mul_f16 v149, v149, v148
v_fma_mix_f32 v159, v155, v155, 0 op_sel:[0,0,0] op_sel_hi:[1,1,0]
v_fma_mix_f32 v159, v155, v155, v159 op_sel:[1,1,0] op_sel_hi:[1,1,0]
v_lshrrev_b32 v187, 18, v187
v_fma_mix_f32 v158, v177, v177, v158 op_sel:[1,1,0] op_sel_hi:[1,1,0]
v_fma_mix_f32 v159, v152, v152, v159 op_sel:[0,0,0] op_sel_hi:[1,1,0]
v_fma_mix_f32 v159, v152, v152, v159 op_sel:[1,1,0] op_sel_hi:[1,1,0]
v_fma_mix_f32 v159, v149, v149, v159 op_sel:[0,0,0] op_sel_hi:[1,1,0]
v_fma_mix_f32 v159, v149, v149, v159 op_sel:[1,1,0] op_sel_hi:[1,1,0]
s_cmp_lt_u32 s40, 4
s_cbranch_scc0 Lsu6
s_waitcnt vmcnt(8)
s_call_b64 s[78:79], Lw1c
s_mov_b64 exec, 1
ds_add_u32 v253, v254 offset:28
s_mov_b64 exec, -1
Lsu6:
v_cvt_pkrtz_f16_f32 v137, v120, v121
v_cvt_pkrtz_f16_f32 v139, v122, v123
v_cvt_pkrtz_f16_f32 v141, v124, v125
v_cvt_pkrtz_f16_f32 v143, v126, v127
v_cvt_pkrtz_f16_f32 v177, v128, v129
v_cvt_pk_f16_f32 v155, v130, v131
v_cvt_pk_f16_f32 v152, v132, v133
v_cvt_pk_f16_f32 v149, v134, v135
s_setprio 0
ds_read_b128 v[220:223], v248 offset:52224
ds_read_u16_d16 v186, v186
ds_read_u16_d16_hi v187, v187
v_mfma_f32_32x32x16_bf16 v[120:135], v[48:51], v[224:227], 0
v_pk_fma_f16 v154, v155, v155, s48
v_and_b32 v137, s49, v137
v_fma_mix_f32 v159, v178, v178, v159 op_sel:[0,0,0] op_sel_hi:[1,1,0]
v_pk_fma_f16 v151, v152, v152, s48
v_pk_fma_f16 v148, v149, v149, s48
v_lshrrev_b16 v136, 2, v137
v_pk_mul_f16 v154, v155, v154
v_pk_mul_f16 v151, v152, v151
v_fma_mix_f32 v159, v179, v179, v159 op_sel:[1,1,0] op_sel_hi:[1,1,0]
v_lshrrev_b32 v137, 18, v137
ds_read_b128 v[224:227], v250 offset:65520
ds_read_u16_d16 v136, v136
ds_read_u16_d16_hi v137, v137
v_mfma_f32_32x32x16_bf16 v[120:135], v[52:55], v[228:231], v[120:135]
v_pk_mul_f16 v148, v149, v148
v_exp_f16 v153, v154
v_exp_f16 v150, v151
v_and_b32 v139, s49, v139
v_fma_mix_f32 v159, v180, v180, v159 op_sel:[0,0,0] op_sel_hi:[1,1,0]
v_exp_f16 v147, v148
v_lshrrev_b16 v138, 2, v139
s_waitcnt lgkmcnt(7)
ds_read_b128 v[228:231], v248 offset:53248
ds_read_b32 v247, v253 offset:12
ds_read_u16_d16 v138, v138
v_mfma_f32_32x32x16_bf16 v[120:135], v[56:59], v[232:235], v[120:135]
v_exp_f16_sdwa v153, v154 dst_sel:WORD_1 dst_unused:UNUSED_PRESERVE src0_sel:WORD_1
v_lshrrev_b32 v139, 18, v139
v_fma_mix_f32 v159, v181, v181, v159 op_sel:[1,1,0] op_sel_hi:[1,1,0]
v_exp_f16_sdwa v150, v151 dst_sel:WORD_1 dst_unused:UNUSED_PRESERVE src0_sel:WORD_1
v_exp_f16_sdwa v147, v148 dst_sel:WORD_1 dst_unused:UNUSED_PRESERVE src0_sel:WORD_1
v_and_b32 v141, s49, v141
v_fma_mix_f32 v159, v182, v182, v159 op_sel:[0,0,0] op_sel_hi:[1,1,0]
ds_read_b128 v[232:235], v248 offset:56320
ds_read_u16_d16_hi v139, v139
v_mfma_f32_32x32x16_bf16 v[120:135], v[60:63], v[236:239], v[120:135]
v_pk_add_f16 v153, v153, 1.0 op_sel_hi:[1,0]
v_lshrrev_b16 v140, 2, v141
v_pk_add_f16 v150, v150, 1.0 op_sel_hi:[1,0]
v_pk_add_f16 v147, v147, 1.0 op_sel_hi:[1,0]
v_rcp_f16 v154, v153
v_lshrrev_b32 v141, 18, v141
ds_read_u16_d16 v140, v140
ds_read_u16_d16_hi v141, v141
s_waitcnt lgkmcnt(5)
v_readfirstlane_b32 s43, v247
s_nop 1
s_cmp_ge_u32 s43, 16
s_cbranch_scc1 Lev3
Lev3w:
s_sleep 1
ds_read_b32 v247, v253 offset:12
s_waitcnt lgkmcnt(0)
v_readfirstlane_b32 s43, v247
s_cmp_eq_u32 s76, 0
s_cbranch_scc1 Lev3
s_sub_u32 s76, s76, 1
s_cmp_lt_u32 s43, 16
s_cbranch_scc1 Lev3w
Lev3:
v_fma_mix_f32 v159, v183, v183, v159 op_sel:[1,1,0] op_sel_hi:[1,1,0]
v_rcp_f16 v151, v150
ds_read_b128 v[236:239], v245 offset:6528
ds_read_b128 v[192:195], v244 offset:128
ds_read_b128 v[196:199], v244 offset:64
v_mfma_f32_32x32x16_bf16 v[120:135], v[64:67], v[216:219], v[120:135]
v_and_b32 v143, s49, v143
v_rcp_f16 v148, v147
v_fma_mix_f32 v159, v184, v184, v159 op_sel:[0,0,0] op_sel_hi:[1,1,0]
v_lshrrev_b16 v142, 2, v143
v_rcp_f16_sdwa v154, v153 dst_sel:WORD_1 dst_unused:UNUSED_PRESERVE src0_sel:WORD_1
v_rcp_f16_sdwa v151, v150 dst_sel:WORD_1 dst_unused:UNUSED_PRESERVE src0_sel:WORD_1
v_lshrrev_b32 v143, 18, v143
ds_read_b128 v[216:219], v248 offset:54272
ds_read_u16_d16 v142, v142
ds_read_u16_d16_hi v143, v143
v_mfma_f32_32x32x16_bf16 v[120:135], v[68:71], v[220:223], v[120:135]
v_fma_mix_f32 v159, v185, v185, v159 op_sel:[1,1,0] op_sel_hi:[1,1,0]
v_rcp_f16_sdwa v148, v147 dst_sel:WORD_1 dst_unused:UNUSED_PRESERVE src0_sel:WORD_1
v_and_b32 v177, s49, v177
v_pk_mul_f16 v155, v155, v154
v_fma_mix_f32 v159, v186, v186, v159 op_sel:[0,0,0] op_sel_hi:[1,1,0]
v_pk_mul_f16 v152, v152, v151
v_lshrrev_b16 v176, 2, v177
v_pk_mul_f16 v149, v149, v148
v_fma_mix_f32 v160, v155, v155, 0 op_sel:[0,0,0] op_sel_hi:[1,1,0]
v_fma_mix_f32 v160, v155, v155, v160 op_sel:[1,1,0] op_sel_hi:[1,1,0]
v_lshrrev_b32 v177, 18, v177
v_fma_mix_f32 v159, v187, v187, v159 op_sel:[1,1,0] op_sel_hi:[1,1,0]
v_fma_mix_f32 v160, v152, v152, v160 op_sel:[0,0,0] op_sel_hi:[1,1,0]
v_fma_mix_f32 v160, v152, v152, v160 op_sel:[1,1,0] op_sel_hi:[1,1,0]
v_fma_mix_f32 v160, v149, v149, v160 op_sel:[0,0,0] op_sel_hi:[1,1,0]
v_fma_mix_f32 v160, v149, v149, v160 op_sel:[1,1,0] op_sel_hi:[1,1,0]
s_setprio 2
v_mfma_f32_32x32x16_bf16 v[0:15], v[224:227], v[224:227], 0
ds_read_b128 v[220:223], v245 offset:6144
ds_read_b128 v[200:203], v244
ds_read_b128 v[204:207], v243 offset:128
ds_read_u16_d16 v176, v176
ds_read_u16_d16_hi v177, v177
v_cvt_pkrtz_f16_f32 v179, v120, v121
v_cvt_pkrtz_f16_f32 v181, v122, v123
v_cvt_pkrtz_f16_f32 v183, v124, v125
v_mfma_f32_32x32x16_bf16 v[16:31], v[224:227], v[224:227], 0
v_cvt_pkrtz_f16_f32 v185, v126, v127
v_cvt_pkrtz_f16_f32 v187, v128, v129
v_cvt_pk_f16_f32 v155, v130, v131
v_mfma_f32_32x32x16_bf16 v[32:47], v[224:227], v[224:227], 0
v_cvt_pk_f16_f32 v152, v132, v133
v_cvt_pk_f16_f32 v149, v134, v135
v_pk_fma_f16 v154, v155, v155, s48
v_mfma_f32_32x32x16_bf16 v[120:135], v[48:51], v[228:231], 0
ds_read_b128 v[224:227], v248 offset:57344
v_and_b32 v179, s49, v179
v_fma_mix_f32 v160, v136, v136, v160 op_sel:[0,0,0] op_sel_hi:[1,1,0]
v_pk_fma_f16 v151, v152, v152, s48
v_pk_fma_f16 v148, v149, v149, s48
v_lshrrev_b16 v178, 2, v179
v_pk_mul_f16 v154, v155, v154
s_waitcnt lgkmcnt(6)
v_mfma_f32_32x32x16_bf16 v[120:135], v[52:55], v[232:235], v[120:135]
ds_read_b128 v[228:231], v245 offset:5760
ds_read_b128 v[208:211], v243 offset:64
ds_read_b128 v[212:215], v243
ds_read_u16_d16 v178, v178
v_pk_mul_f16 v151, v152, v151
v_fma_mix_f32 v160, v137, v137, v160 op_sel:[1,1,0] op_sel_hi:[1,1,0]
v_lshrrev_b32 v179, 18, v179
v_pk_mul_f16 v148, v149, v148
v_exp_f16 v153, v154
v_smfmac_f32_16x16x32_bf16 v[40:43], v[238:239], v[192:195], v246
ds_read_b128 v[232:235], v248 offset:55296
ds_read_u16_d16_hi v179, v179
v_exp_f16 v150, v151
v_and_b32 v181, s49, v181
v_smfmac_f32_16x16x32_bf16 v[24:27], v[236:237], v[196:199], v246
v_fma_mix_f32 v160, v138, v138, v160 op_sel:[0,0,0] op_sel_hi:[1,1,0]
v_exp_f16 v147, v148
v_mfma_f32_32x32x16_bf16 v[120:135], v[56:59], v[216:219], v[120:135]
ds_read_b128 v[236:239], v245 offset:5376
ds_read_b128 v[192:195], v242 offset:128
ds_read_b128 v[196:199], v242 offset:64
v_lshrrev_b16 v180, 2, v181
v_exp_f16_sdwa v153, v154 dst_sel:WORD_1 dst_unused:UNUSED_PRESERVE src0_sel:WORD_1
v_lshrrev_b32 v181, 18, v181
v_fma_mix_f32 v160, v139, v139, v160 op_sel:[1,1,0] op_sel_hi:[1,1,0]
s_waitcnt lgkmcnt(8)
v_smfmac_f32_16x16x32_bf16 v[8:11], v[222:223], v[200:203], v246
ds_read_b128 v[216:219], v248 offset:58368
ds_read_u16_d16 v180, v180
ds_read_u16_d16_hi v181, v181
v_exp_f16_sdwa v150, v151 dst_sel:WORD_1 dst_unused:UNUSED_PRESERVE src0_sel:WORD_1
v_exp_f16_sdwa v147, v148 dst_sel:WORD_1 dst_unused:UNUSED_PRESERVE src0_sel:WORD_1
v_smfmac_f32_16x16x32_bf16 v[40:43], v[220:221], v[204:207], v246
v_and_b32 v183, s49, v183
v_fma_mix_f32 v160, v140, v140, v160 op_sel:[0,0,0] op_sel_hi:[1,1,0]
v_pk_add_f16 v153, v153, 1.0 op_sel_hi:[1,0]
v_mfma_f32_32x32x16_bf16 v[120:135], v[60:63], v[224:227], v[120:135]
ds_read_b128 v[220:223], v245 offset:4992
ds_read_b128 v[200:203], v242
v_xor_b32 v244, 16, v244
ds_read_b128 v[204:207], v244 offset:128
v_lshrrev_b16 v182, 2, v183
v_pk_add_f16 v150, v150, 1.0 op_sel_hi:[1,0]
v_pk_add_f16 v147, v147, 1.0 op_sel_hi:[1,0]
v_rcp_f16 v154, v153
v_lshrrev_b32 v183, 18, v183
s_waitcnt lgkmcnt(6)
v_smfmac_f32_16x16x32_bf16 v[24:27], v[230:231], v[208:211], v246
ds_read_b128 v[224:227], v245 offset:4608
ds_read_u16_d16 v182, v182
ds_read_u16_d16_hi v183, v183
v_fma_mix_f32 v160, v141, v141, v160 op_sel:[1,1,0] op_sel_hi:[1,1,0]
v_rcp_f16 v151, v150
v_smfmac_f32_16x16x32_bf16 v[8:11], v[228:229], v[212:215], v246
v_and_b32 v185, s49, v185
v_rcp_f16 v148, v147
v_mfma_f32_32x32x16_bf16 v[120:135], v[64:67], v[232:235], v[120:135]
ds_read_b128 v[208:211], v244 offset:64
ds_read_b128 v[212:215], v244
ds_read_b128 v[228:231], v248 offset:59392
v_fma_mix_f32 v160, v142, v142, v160 op_sel:[0,0,0] op_sel_hi:[1,1,0]
v_lshrrev_b16 v184, 2, v185
v_rcp_f16_sdwa v154, v153 dst_sel:WORD_1 dst_unused:UNUSED_PRESERVE src0_sel:WORD_1
v_rcp_f16_sdwa v151, v150 dst_sel:WORD_1 dst_unused:UNUSED_PRESERVE src0_sel:WORD_1
v_smfmac_f32_16x16x32_bf16 v[40:43], v[238:239], v[192:195], v246
ds_read_b128 v[232:235], v248 offset:62464
ds_read_u16_d16 v184, v184
ds_read_b32 v247, v253 offset:28
v_lshrrev_b32 v185, 18, v185
v_fma_mix_f32 v160, v143, v143, v160 op_sel:[1,1,0] op_sel_hi:[1,1,0]
v_smfmac_f32_16x16x32_bf16 v[24:27], v[236:237], v[196:199], v246
v_rcp_f16_sdwa v148, v147 dst_sel:WORD_1 dst_unused:UNUSED_PRESERVE src0_sel:WORD_1
v_and_b32 v187, s49, v187
v_pk_mul_f16 v155, v155, v154
s_waitcnt lgkmcnt(7)
v_mfma_f32_32x32x16_bf16 v[120:135], v[68:71], v[216:219], v[120:135]
ds_read_b128 v[236:239], v248 offset:60416
ds_read_u16_d16_hi v185, v185
v_fma_mix_f32 v160, v176, v176, v160 op_sel:[0,0,0] op_sel_hi:[1,1,0]
v_pk_mul_f16 v152, v152, v151
v_lshrrev_b16 v186, 2, v187
v_pk_mul_f16 v149, v149, v148
v_fma_mix_f32 v161, v155, v155, 0 op_sel:[0,0,0] op_sel_hi:[1,1,0]
v_fma_mix_f32 v161, v155, v155, v161 op_sel:[1,1,0] op_sel_hi:[1,1,0]
v_smfmac_f32_16x16x32_bf16 v[8:11], v[222:223], v[200:203], v246
ds_read_b128 v[216:219], v245 offset:4224
v_xor_b32 v243, 16, v243
ds_read_b128 v[192:195], v243 offset:128
ds_read_b128 v[196:199], v243 offset:64
ds_read_u16_d16 v186, v186
v_lshrrev_b32 v187, 18, v187
v_fma_mix_f32 v160, v177, v177, v160 op_sel:[1,1,0] op_sel_hi:[1,1,0]
v_fma_mix_f32 v161, v152, v152, v161 op_sel:[0,0,0] op_sel_hi:[1,1,0]
v_smfmac_f32_16x16x32_bf16 v[44:47], v[220:221], v[204:207], v246
v_fma_mix_f32 v161, v152, v152, v161 op_sel:[1,1,0] op_sel_hi:[1,1,0]
v_fma_mix_f32 v161, v149, v149, v161 op_sel:[0,0,0] op_sel_hi:[1,1,0]
v_fma_mix_f32 v161, v149, v149, v161 op_sel:[1,1,0] op_sel_hi:[1,1,0]
s_cmp_lg_u32 s40, 7
s_cbranch_scc1 Lnosent
v_mov_b32 v104, -1
v_mov_b32 v105, -1
v_mov_b32 v106, -1
v_mov_b32 v107, -1
v_lshlrev_b32 v100, 12, v251
v_add_u32 v101, 262144, v100
v_cmp_gt_u32 vcc, 32, v251
v_mov_b32 v102, 2147483648
s_nop 0
v_cndmask_b32 v101, v102, v101, vcc
s_lshl_b32 s43, s2, 4
buffer_store_dwordx4 v[104:107], v100, s[32:35], s43 offen sc1
buffer_store_dwordx4 v[104:107], v101, s[32:35], s43 offen sc1
s_add_u32 s43, s43, 393216
s_cmp_lt_u32 s2, 96
s_cselect_b32 s43, s43, 1073741824
v_lshlrev_b32 v102, 11, v251
s_mov_b64 exec, 0xff
buffer_store_dwordx4 v[104:107], v102, s[32:35], s43 offen sc1
s_mov_b64 exec, -1
s_sub_u32 s43, s2, 96
s_cmp_lt_u32 s43, 96
s_cbranch_scc0 Lnobias
s_lshl_b32 s44, s43, 1
v_mul_u32_u24 v100, 192, v251
v_lshlrev_b32 v101, 1, v251
s_add_u32 s45, s44, 0
buffer_load_ushort v102, v100, s[16:19], s45 offen
buffer_load_ushort v108, v101, s[28:31], 0 offen offset:0
s_add_u32 s45, s44, 12288
buffer_load_ushort v103, v100, s[16:19], s45 offen
buffer_load_ushort v109, v101, s[28:31], 0 offen offset:128
s_add_u32 s45, s44, 24576
buffer_load_ushort v104, v100, s[16:19], s45 offen
buffer_load_ushort v110, v101, s[28:31], 0 offen offset:256
s_add_u32 s45, s44, 36864
buffer_load_ushort v105, v100, s[16:19], s45 offen
buffer_load_ushort v111, v101, s[28:31], 0 offen offset:384
s_add_u32 s45, s44, 49152
buffer_load_ushort v106, v100, s[16:19], s45 offen
buffer_load_ushort v112, v101, s[28:31], 0 offen offset:512
s_add_u32 s45, s44, 61440
buffer_load_ushort v107, v100, s[16:19], s45 offen
buffer_load_ushort v113, v101, s[28:31], 0 offen offset:640
Lnobias:
s_nop 1
Lnosent:
ds_read_u16_d16_hi v187, v187
s_waitcnt lgkmcnt(1)
v_readfirstlane_b32 s43, v247
s_nop 1
s_cmp_ge_u32 s43, 12
s_cbranch_scc1 Lev4
Lev4w:
s_sleep 1
ds_read_b32 v247, v253 offset:28
s_waitcnt lgkmcnt(0)
v_readfirstlane_b32 s43, v247
s_cmp_eq_u32 s76, 0
s_cbranch_scc1 Lev4
s_sub_u32 s76, s76, 1
s_cmp_lt_u32 s43, 12
s_cbranch_scc1 Lev4w
Lev4:
s_setprio 1
v_smfmac_f32_16x16x32_bf16 v[28:31], v[226:227], v[208:211], v246
ds_read_b128 v[220:223], v248 offset:63488
v_cvt_pkrtz_f16_f32 v137, v120, v121
v_cvt_pkrtz_f16_f32 v139, v122, v123
v_cvt_pkrtz_f16_f32 v141, v124, v125
v_cvt_pkrtz_f16_f32 v143, v126, v127
v_smfmac_f32_16x16x32_bf16 v[12:15], v[224:225], v[212:215], v246
v_cvt_pk_f16_f32 v155, v128, v129
v_cvt_pk_f16_f32 v152, v130, v131
v_cvt_pk_f16_f32 v149, v132, v133
v_cvt_pk_f16_f32 v146, v134, v135
v_mfma_f32_32x32x16_bf16 v[120:135], v[48:51], v[228:231], 0
ds_read_b128 v[224:227], v248 offset:61440
v_pk_fma_f16 v154, v155, v155, s48
v_and_b32 v137, s49, v137
v_fma_mix_f32 v161, v178, v178, v161 op_sel:[0,0,0] op_sel_hi:[1,1,0]
v_pk_fma_f16 v151, v152, v152, s48
v_pk_fma_f16 v148, v149, v149, s48
v_pk_fma_f16 v145, v146, v146, s48
v_pk_mul_f16 v154, v155, v154
v_lshrrev_b16 v136, 2, v137
v_pk_mul_f16 v151, v152, v151
v_mfma_f32_32x32x16_bf16 v[120:135], v[52:55], v[232:235], v[120:135]
ds_read_b128 v[228:231], v245 offset:3840
ds_read_b128 v[200:203], v243
v_xor_b32 v242, 16, v242
ds_read_b128 v[204:207], v242 offset:128
ds_read_u16_d16 v136, v136
v_fma_mix_f32 v161, v179, v179, v161 op_sel:[1,1,0] op_sel_hi:[1,1,0]
v_pk_mul_f16 v148, v149, v148
v_pk_mul_f16 v145, v146, v145
v_exp_f16 v153, v154
v_lshrrev_b32 v137, 18, v137
v_exp_f16 v150, v151
v_mfma_f32_32x32x16_bf16 v[120:135], v[56:59], v[236:239], v[120:135]
ds_read_b128 v[232:235], v248 offset:64512
ds_read_u16_d16_hi v137, v137
v_fma_mix_f32 v161, v180, v180, v161 op_sel:[0,0,0] op_sel_hi:[1,1,0]
v_exp_f16 v147, v148
v_and_b32 v139, s49, v139
v_exp_f16 v144, v145
v_exp_f16_sdwa v153, v154 dst_sel:WORD_1 dst_unused:UNUSED_PRESERVE src0_sel:WORD_1
v_fma_mix_f32 v161, v181, v181, v161 op_sel:[1,1,0] op_sel_hi:[1,1,0]
v_smfmac_f32_16x16x32_bf16 v[44:47], v[218:219], v[192:195], v246
ds_read_b128 v[236:239], v245 offset:3456
ds_read_b128 v[208:211], v242 offset:64
ds_read_b128 v[212:215], v242
v_lshrrev_b16 v138, 2, v139
v_exp_f16_sdwa v150, v151 dst_sel:WORD_1 dst_unused:UNUSED_PRESERVE src0_sel:WORD_1
v_smfmac_f32_16x16x32_bf16 v[28:31], v[216:217], v[196:199], v246
v_exp_f16_sdwa v147, v148 dst_sel:WORD_1 dst_unused:UNUSED_PRESERVE src0_sel:WORD_1
v_exp_f16_sdwa v144, v145 dst_sel:WORD_1 dst_unused:UNUSED_PRESERVE src0_sel:WORD_1
v_lshrrev_b32 v139, 18, v139
s_waitcnt lgkmcnt(5)
v_mfma_f32_32x32x16_bf16 v[120:135], v[60:63], v[220:223], v[120:135]
ds_read_b128 v[216:219], v245 offset:3072
v_xor_b32 v244, 32, v244
ds_read_b128 v[192:195], v244 offset:128
ds_read_b128 v[196:199], v244 offset:64
ds_read_u16_d16 v138, v138
ds_read_u16_d16_hi v139, v139
v_fma_mix_f32 v161, v182, v182, v161 op_sel:[0,0,0] op_sel_hi:[1,1,0]
v_pk_add_f16 v153, v153, 1.0 op_sel_hi:[1,0]
v_pk_add_f16 v150, v150, 1.0 op_sel_hi:[1,0]
v_pk_add_f16 v147, v147, 1.0 op_sel_hi:[1,0]
v_and_b32 v141, s49, v141
v_pk_add_f16 v144, v144, 1.0 op_sel_hi:[1,0]
v_rcp_f16 v154, v153
v_fma_mix_f32 v161, v183, v183, v161 op_sel:[1,1,0] op_sel_hi:[1,1,0]
v_mfma_f32_32x32x16_bf16 v[120:135], v[64:67], v[224:227], v[120:135]
ds_read_b128 v[220:223], v249
v_rcp_f16 v151, v150
v_lshrrev_b16 v140, 2, v141
v_rcp_f16 v148, v147
v_fma_mix_f32 v161, v184, v184, v161 op_sel:[0,0,0] op_sel_hi:[1,1,0]
v_rcp_f16 v145, v144
v_lshrrev_b32 v141, 18, v141
v_smfmac_f32_16x16x32_bf16 v[12:15], v[230:231], v[200:203], v246
ds_read_b128 v[224:227], v249 offset:3072
ds_read_u16_d16 v140, v140
ds_read_u16_d16_hi v141, v141
v_rcp_f16_sdwa v154, v153 dst_sel:WORD_1 dst_unused:UNUSED_PRESERVE src0_sel:WORD_1
s_setprio 0
v_rcp_f16_sdwa v151, v150 dst_sel:WORD_1 dst_unused:UNUSED_PRESERVE src0_sel:WORD_1
v_smfmac_f32_16x16x32_bf16 v[44:47], v[228:229], v[204:207], v246
v_fma_mix_f32 v161, v185, v185, v161 op_sel:[1,1,0] op_sel_hi:[1,1,0]
v_and_b32 v143, s49, v143
v_rcp_f16_sdwa v148, v147 dst_sel:WORD_1 dst_unused:UNUSED_PRESERVE src0_sel:WORD_1
s_waitcnt lgkmcnt(4)
v_mfma_f32_32x32x16_bf16 v[120:135], v[68:71], v[232:235], v[120:135]
ds_read_b128 v[228:231], v245 offset:2688
ds_read_b128 v[200:203], v244
v_xor_b32 v243, 32, v243
ds_read_b128 v[204:207], v243 offset:128
v_rcp_f16_sdwa v145, v144 dst_sel:WORD_1 dst_unused:UNUSED_PRESERVE src0_sel:WORD_1
v_pk_mul_f16 v155, v155, v154
v_lshrrev_b16 v142, 2, v143
v_fma_mix_f32 v161, v186, v186, v161 op_sel:[0,0,0] op_sel_hi:[1,1,0]
v_pk_mul_f16 v152, v152, v151
v_pk_mul_f16 v149, v149, v148
v_pk_mul_f16 v146, v146, v145
v_fma_mix_f32 v162, v155, v155, 0 op_sel:[0,0,0] op_sel_hi:[1,1,0]
v_smfmac_f32_16x16x32_bf16 v[28:31], v[238:239], v[208:211], v246
ds_read_b128 v[232:235], v249 offset:1024
ds_read_u16_d16 v142, v142
v_lshrrev_b32 v143, 18, v143
v_fma_mix_f32 v162, v155, v155, v162 op_sel:[1,1,0] op_sel_hi:[1,1,0]
v_fma_mix_f32 v162, v152, v152, v162 op_sel:[0,0,0] op_sel_hi:[1,1,0]
v_fma_mix_f32 v161, v187, v187, v161 op_sel:[1,1,0] op_sel_hi:[1,1,0]
v_smfmac_f32_16x16x32_bf16 v[12:15], v[236:237], v[212:215], v246
v_fma_mix_f32 v162, v152, v152, v162 op_sel:[1,1,0] op_sel_hi:[1,1,0]
v_fma_mix_f32 v162, v149, v149, v162 op_sel:[0,0,0] op_sel_hi:[1,1,0]
v_fma_mix_f32 v162, v149, v149, v162 op_sel:[1,1,0] op_sel_hi:[1,1,0]
v_fma_mix_f32 v162, v146, v146, v162 op_sel:[0,0,0] op_sel_hi:[1,1,0]
v_fma_mix_f32 v162, v146, v146, v162 op_sel:[1,1,0] op_sel_hi:[1,1,0]
v_lshlrev_b32 v252, 7, v251
s_add_u32 s46, s47, 1572864
s_mov_b32 exec_lo, 131071
s_mov_b32 exec_hi, 0
s_mov_b32 m0, 16288
s_nop 0
buffer_load_dword v252, s[4:7], s46 offen lds
s_mov_b64 exec, -1
s_setprio 2
v_smfmac_f32_16x16x32_bf16 v[36:39], v[218:219], v[192:195], v246
ds_read_b128 v[236:239], v249 offset:4096
ds_read_u16_d16_hi v143, v143
v_cvt_pkrtz_f16_f32 v179, v120, v121
v_cvt_pkrtz_f16_f32 v181, v122, v123
v_cvt_pkrtz_f16_f32 v183, v124, v125
v_smfmac_f32_16x16x32_bf16 v[20:23], v[216:217], v[196:199], v246
v_cvt_pkrtz_f16_f32 v185, v126, v127
v_cvt_pkrtz_f16_f32 v187, v128, v129
v_cvt_pk_f16_f32 v155, v130, v131
v_cvt_pk_f16_f32 v152, v132, v133
v_cvt_pk_f16_f32 v149, v134, v135
s_waitcnt lgkmcnt(2)
v_mfma_f32_32x32x16_bf16 v[120:135], v[48:51], v[220:223], 0
ds_read_b128 v[216:219], v245 offset:2304
ds_read_b128 v[208:211], v243 offset:64
ds_read_b128 v[212:215], v243
v_pk_fma_f16 v154, v155, v155, s48
v_and_b32 v179, s49, v179
v_fma_mix_f32 v162, v136, v136, v162 op_sel:[0,0,0] op_sel_hi:[1,1,0]
v_pk_fma_f16 v151, v152, v152, s48
v_pk_fma_f16 v148, v149, v149, s48
v_mfma_f32_32x32x16_bf16 v[120:135], v[52:55], v[224:227], v[120:135]
ds_read_b128 v[220:223], v249 offset:2048
v_lshrrev_b16 v178, 2, v179
v_pk_mul_f16 v154, v155, v154
v_pk_mul_f16 v151, v152, v151
v_pk_mul_f16 v148, v149, v148
v_lshrrev_b32 v179, 18, v179
v_fma_mix_f32 v162, v137, v137, v162 op_sel:[1,1,0] op_sel_hi:[1,1,0]
v_smfmac_f32_16x16x32_bf16 v[4:7], v[230:231], v[200:203], v246
ds_read_b128 v[224:227], v245 offset:1920
v_xor_b32 v242, 32, v242
ds_read_b128 v[192:195], v242 offset:128
ds_read_b128 v[196:199], v242 offset:64
ds_read_u16_d16 v178, v178
ds_read_u16_d16_hi v179, v179
v_exp_f16 v153, v154
v_and_b32 v181, s49, v181
v_smfmac_f32_16x16x32_bf16 v[36:39], v[228:229], v[204:207], v246
v_exp_f16 v150, v151
v_exp_f16 v147, v148
v_mfma_f32_32x32x16_bf16 v[120:135], v[56:59], v[232:235], v[120:135]
ds_read_b128 v[228:231], v249 offset:5120
v_lshrrev_b16 v180, 2, v181
v_fma_mix_f32 v162, v138, v138, v162 op_sel:[0,0,0] op_sel_hi:[1,1,0]
v_exp_f16_sdwa v153, v154 dst_sel:WORD_1 dst_unused:UNUSED_PRESERVE src0_sel:WORD_1
v_lshrrev_b32 v181, 18, v181
v_exp_f16_sdwa v150, v151 dst_sel:WORD_1 dst_unused:UNUSED_PRESERVE src0_sel:WORD_1
s_waitcnt lgkmcnt(6)
v_mfma_f32_32x32x16_bf16 v[120:135], v[60:63], v[236:239], v[120:135]
ds_read_b128 v[232:235], v245 offset:1536
ds_read_b128 v[200:203], v242
v_xor_b32 v244, 16, v244
ds_read_b128 v[204:207], v244 offset:128
ds_read_u16_d16 v180, v180
ds_read_u16_d16_hi v181, v181
v_fma_mix_f32 v162, v139, v139, v162 op_sel:[1,1,0] op_sel_hi:[1,1,0]
v_and_b32 v183, s49, v183
v_exp_f16_sdwa v147, v148 dst_sel:WORD_1 dst_unused:UNUSED_PRESERVE src0_sel:WORD_1
v_pk_add_f16 v153, v153, 1.0 op_sel_hi:[1,0]
v_lshrrev_b16 v182, 2, v183
v_smfmac_f32_16x16x32_bf16 v[20:23], v[218:219], v[208:211], v246
ds_read_b128 v[236:239], v245 offset:1152
ds_read_u16_d16 v182, v182
v_pk_add_f16 v150, v150, 1.0 op_sel_hi:[1,0]
v_pk_add_f16 v147, v147, 1.0 op_sel_hi:[1,0]
v_rcp_f16 v154, v153
v_smfmac_f32_16x16x32_bf16 v[4:7], v[216:217], v[212:215], v246
v_lshrrev_b32 v183, 18, v183
v_fma_mix_f32 v162, v140, v140, v162 op_sel:[0,0,0] op_sel_hi:[1,1,0]
v_mfma_f32_32x32x16_bf16 v[120:135], v[64:67], v[220:223], v[120:135]
ds_read_b128 v[208:211], v244 offset:64
ds_read_b128 v[212:215], v244
ds_read_b128 v[216:219], v249 offset:6144
ds_read_u16_d16_hi v183, v183
v_rcp_f16 v151, v150
v_and_b32 v185, s49, v185
v_rcp_f16 v148, v147
v_fma_mix_f32 v162, v141, v141, v162 op_sel:[1,1,0] op_sel_hi:[1,1,0]
v_lshrrev_b16 v184, 2, v185
s_waitcnt lgkmcnt(6)
v_smfmac_f32_16x16x32_bf16 v[36:39], v[226:227], v[192:195], v246
ds_read_b128 v[220:223], v249 offset:9216
ds_read_u16_d16 v184, v184
v_rcp_f16_sdwa v154, v153 dst_sel:WORD_1 dst_unused:UNUSED_PRESERVE src0_sel:WORD_1
v_rcp_f16_sdwa v151, v150 dst_sel:WORD_1 dst_unused:UNUSED_PRESERVE src0_sel:WORD_1
v_smfmac_f32_16x16x32_bf16 v[20:23], v[224:225], v[196:199], v246
v_lshrrev_b32 v185, 18, v185
v_rcp_f16_sdwa v148, v147 dst_sel:WORD_1 dst_unused:UNUSED_PRESERVE src0_sel:WORD_1
v_mfma_f32_32x32x16_bf16 v[120:135], v[68:71], v[228:231], v[120:135]
ds_read_b128 v[224:227], v249 offset:7168
ds_read_u16_d16_hi v185, v185
v_and_b32 v187, s49, v187
v_fma_mix_f32 v162, v142, v142, v162 op_sel:[0,0,0] op_sel_hi:[1,1,0]
v_pk_mul_f16 v155, v155, v154
v_pk_mul_f16 v152, v152, v151
v_lshrrev_b16 v186, 2, v187
v_pk_mul_f16 v149, v149, v148
v_fma_mix_f32 v163, v155, v155, 0 op_sel:[0,0,0] op_sel_hi:[1,1,0]
v_smfmac_f32_16x16x32_bf16 v[4:7], v[234:235], v[200:203], v246
ds_read_b128 v[228:231], v245 offset:768
v_xor_b32 v243, 16, v243
ds_read_b128 v[192:195], v243 offset:128
ds_read_b128 v[196:199], v243 offset:64
ds_read_u16_d16 v186, v186
v_fma_mix_f32 v162, v143, v143, v162 op_sel:[1,1,0] op_sel_hi:[1,1,0]
v_lshrrev_b32 v187, 18, v187
v_fma_mix_f32 v163, v155, v155, v163 op_sel:[1,1,0] op_sel_hi:[1,1,0]
v_smfmac_f32_16x16x32_bf16 v[32:35], v[232:233], v[204:207], v246
v_fma_mix_f32 v163, v152, v152, v163 op_sel:[0,0,0] op_sel_hi:[1,1,0]
v_fma_mix_f32 v163, v152, v152, v163 op_sel:[1,1,0] op_sel_hi:[1,1,0]
v_fma_mix_f32 v163, v149, v149, v163 op_sel:[0,0,0] op_sel_hi:[1,1,0]
v_fma_mix_f32 v163, v149, v149, v163 op_sel:[1,1,0] op_sel_hi:[1,1,0]
v_lshlrev_b32 v252, 7, v251
s_add_u32 s46, s47, 1572864
s_mov_b32 exec_lo, 4294836224
s_mov_b32 exec_hi, 3
s_mov_b32 m0, 16220
s_nop 0
buffer_load_dword v252, s[4:7], s46 offen lds
s_mov_b64 exec, -1
s_setprio 1
s_waitcnt lgkmcnt(4)
v_smfmac_f32_16x16x32_bf16 v[16:19], v[238:239], v[208:211], v246
ds_read_b128 v[232:235], v249 offset:10240
ds_read_u16_d16_hi v187, v187
v_cvt_pkrtz_f16_f32 v137, v120, v121
v_cvt_pkrtz_f16_f32 v139, v122, v123
v_cvt_pkrtz_f16_f32 v141, v124, v125
v_smfmac_f32_16x16x32_bf16 v[0:3], v[236:237], v[212:215], v246
v_cvt_pkrtz_f16_f32 v143, v126, v127
v_cvt_pk_f16_f32 v155, v128, v129
v_cvt_pk_f16_f32 v152, v130, v131
v_cvt_pk_f16_f32 v149, v132, v133
v_cvt_pk_f16_f32 v146, v134, v135
v_mfma_f32_32x32x16_bf16 v[120:135], v[48:51], v[216:219], 0
ds_read_b128 v[236:239], v249 offset:8192
v_pk_fma_f16 v154, v155, v155, s48
v_and_b32 v137, s49, v137
v_fma_mix_f32 v163, v178, v178, v163 op_sel:[0,0,0] op_sel_hi:[1,1,0]
v_pk_fma_f16 v151, v152, v152, s48
v_pk_fma_f16 v148, v149, v149, s48
v_pk_fma_f16 v145, v146, v146, s48
v_pk_mul_f16 v154, v155, v154
v_mfma_f32_32x32x16_bf16 v[120:135], v[52:55], v[220:223], v[120:135]
ds_read_b128 v[216:219], v245 offset:384
ds_read_b128 v[200:203], v243
v_xor_b32 v242, 16, v242
ds_read_b128 v[204:207], v242 offset:128
v_lshrrev_b16 v136, 2, v137
v_pk_mul_f16 v151, v152, v151
v_fma_mix_f32 v163, v179, v179, v163 op_sel:[1,1,0] op_sel_hi:[1,1,0]
v_pk_mul_f16 v148, v149, v148
v_pk_mul_f16 v145, v146, v145
v_exp_f16 v153, v154
v_lshrrev_b32 v137, 18, v137
v_mfma_f32_32x32x16_bf16 v[120:135], v[56:59], v[224:227], v[120:135]
ds_read_b128 v[220:223], v249 offset:11264
ds_read_u16_d16 v136, v136
ds_read_u16_d16_hi v137, v137
v_exp_f16 v150, v151
v_fma_mix_f32 v163, v180, v180, v163 op_sel:[0,0,0] op_sel_hi:[1,1,0]
v_exp_f16 v147, v148
v_and_b32 v139, s49, v139
v_exp_f16 v144, v145
s_waitcnt lgkmcnt(6)
v_smfmac_f32_16x16x32_bf16 v[32:35], v[230:231], v[192:195], v246
ds_read_b128 v[224:227], v245
ds_read_b128 v[208:211], v242 offset:64
ds_read_b128 v[212:215], v242
v_exp_f16_sdwa v153, v154 dst_sel:WORD_1 dst_unused:UNUSED_PRESERVE src0_sel:WORD_1
v_fma_mix_f32 v163, v181, v181, v163 op_sel:[1,1,0] op_sel_hi:[1,1,0]
v_lshrrev_b16 v138, 2, v139
v_smfmac_f32_16x16x32_bf16 v[16:19], v[228:229], v[196:199], v246
v_exp_f16_sdwa v150, v151 dst_sel:WORD_1 dst_unused:UNUSED_PRESERVE src0_sel:WORD_1
v_mfma_f32_32x32x16_bf16 v[120:135], v[60:63], v[232:235], v[120:135]
ds_read_b128 v[228:231], v249 offset:12288
ds_read_u16_d16 v138, v138
v_exp_f16_sdwa v147, v148 dst_sel:WORD_1 dst_unused:UNUSED_PRESERVE src0_sel:WORD_1
v_exp_f16_sdwa v144, v145 dst_sel:WORD_1 dst_unused:UNUSED_PRESERVE src0_sel:WORD_1
v_lshrrev_b32 v139, 18, v139
v_fma_mix_f32 v163, v182, v182, v163 op_sel:[0,0,0] op_sel_hi:[1,1,0]
v_pk_add_f16 v153, v153, 1.0 op_sel_hi:[1,0]
v_pk_add_f16 v150, v150, 1.0 op_sel_hi:[1,0]
v_pk_add_f16 v147, v147, 1.0 op_sel_hi:[1,0]
v_mfma_f32_32x32x16_bf16 v[120:135], v[64:67], v[236:239], v[120:135]
ds_read_b128 v[232:235], v249 offset:15360
ds_read_u16_d16_hi v139, v139
v_and_b32 v141, s49, v141
v_pk_add_f16 v144, v144, 1.0 op_sel_hi:[1,0]
v_rcp_f16 v154, v153
v_fma_mix_f32 v163, v183, v183, v163 op_sel:[1,1,0] op_sel_hi:[1,1,0]
v_rcp_f16 v151, v150
v_lshrrev_b16 v140, 2, v141
s_waitcnt lgkmcnt(4)
v_smfmac_f32_16x16x32_bf16 v[0:3], v[218:219], v[200:203], v246
ds_read_b128 v[236:239], v249 offset:13312
ds_read_u16_d16 v140, v140
v_rcp_f16 v148, v147
v_fma_mix_f32 v163, v184, v184, v163 op_sel:[0,0,0] op_sel_hi:[1,1,0]
v_smfmac_f32_16x16x32_bf16 v[32:35], v[216:217], v[204:207], v246
v_rcp_f16 v145, v144
v_lshrrev_b32 v141, 18, v141
v_rcp_f16_sdwa v154, v153 dst_sel:WORD_1 dst_unused:UNUSED_PRESERVE src0_sel:WORD_1
s_setprio 0
v_mfma_f32_32x32x16_bf16 v[120:135], v[68:71], v[220:223], v[120:135]
ds_read_b128 v[216:219], v249 offset:16384
ds_read_u16_d16_hi v141, v141
v_rcp_f16_sdwa v151, v150 dst_sel:WORD_1 dst_unused:UNUSED_PRESERVE src0_sel:WORD_1
v_fma_mix_f32 v163, v185, v185, v163 op_sel:[1,1,0] op_sel_hi:[1,1,0]
v_and_b32 v143, s49, v143
v_rcp_f16_sdwa v148, v147 dst_sel:WORD_1 dst_unused:UNUSED_PRESERVE src0_sel:WORD_1
v_rcp_f16_sdwa v145, v144 dst_sel:WORD_1 dst_unused:UNUSED_PRESERVE src0_sel:WORD_1
v_smfmac_f32_16x16x32_bf16 v[16:19], v[226:227], v[208:211], v246
ds_read_b128 v[220:223], v249 offset:14336
v_pk_mul_f16 v155, v155, v154
v_lshrrev_b16 v142, 2, v143
v_fma_mix_f32 v163, v186, v186, v163 op_sel:[0,0,0] op_sel_hi:[1,1,0]
v_pk_mul_f16 v152, v152, v151
v_smfmac_f32_16x16x32_bf16 v[0:3], v[224:225], v[212:215], v246
s_mov_b64 exec, 1
ds_add_u32 v253, v254 offset:16
s_mov_b64 exec, -1
v_pk_mul_f16 v149, v149, v148
v_pk_mul_f16 v146, v146, v145
v_fma_mix_f32 v164, v155, v155, 0 op_sel:[0,0,0] op_sel_hi:[1,1,0]
v_lshrrev_b32 v143, 18, v143
v_fma_mix_f32 v164, v155, v155, v164 op_sel:[1,1,0] op_sel_hi:[1,1,0]
v_fma_mix_f32 v164, v152, v152, v164 op_sel:[0,0,0] op_sel_hi:[1,1,0]
v_fma_mix_f32 v163, v187, v187, v163 op_sel:[1,1,0] op_sel_hi:[1,1,0]
v_fma_mix_f32 v164, v152, v152, v164 op_sel:[1,1,0] op_sel_hi:[1,1,0]
v_fma_mix_f32 v164, v149, v149, v164 op_sel:[0,0,0] op_sel_hi:[1,1,0]
v_fma_mix_f32 v164, v149, v149, v164 op_sel:[1,1,0] op_sel_hi:[1,1,0]
v_fma_mix_f32 v164, v146, v146, v164 op_sel:[0,0,0] op_sel_hi:[1,1,0]
v_fma_mix_f32 v164, v146, v146, v164 op_sel:[1,1,0] op_sel_hi:[1,1,0]
s_setprio 3
v_pk_add_f32 v[168:169], v[0:1], v[2:3]
v_pk_mul_f32 v[170:171], v[0:1], v[0:1]
v_pk_fma_f32 v[170:171], v[2:3], v[2:3], v[170:171]
v_pk_add_f32 v[168:169], v[168:169], v[4:5]
v_pk_fma_f32 v[170:171], v[4:5], v[4:5], v[170:171]
v_pk_add_f32 v[168:169], v[168:169], v[6:7]
v_pk_fma_f32 v[170:171], v[6:7], v[6:7], v[170:171]
v_pk_add_f32 v[168:169], v[168:169], v[8:9]
v_pk_fma_f32 v[170:171], v[8:9], v[8:9], v[170:171]
v_pk_add_f32 v[168:169], v[168:169], v[10:11]
v_pk_fma_f32 v[170:171], v[10:11], v[10:11], v[170:171]
v_pk_add_f32 v[168:169], v[168:169], v[12:13]
v_pk_fma_f32 v[170:171], v[12:13], v[12:13], v[170:171]
v_pk_add_f32 v[168:169], v[168:169], v[14:15]
v_pk_fma_f32 v[170:171], v[14:15], v[14:15], v[170:171]
v_pk_add_f32 v[168:169], v[168:169], v[16:17]
v_pk_fma_f32 v[170:171], v[16:17], v[16:17], v[170:171]
v_pk_add_f32 v[168:169], v[168:169], v[18:19]
v_pk_fma_f32 v[170:171], v[18:19], v[18:19], v[170:171]
v_pk_add_f32 v[168:169], v[168:169], v[20:21]
v_pk_fma_f32 v[170:171], v[20:21], v[20:21], v[170:171]
v_pk_add_f32 v[168:169], v[168:169], v[22:23]
v_pk_fma_f32 v[170:171], v[22:23], v[22:23], v[170:171]
v_pk_add_f32 v[168:169], v[168:169], v[24:25]
v_pk_fma_f32 v[170:171], v[24:25], v[24:25], v[170:171]
v_pk_add_f32 v[168:169], v[168:169], v[26:27]
v_pk_fma_f32 v[170:171], v[26:27], v[26:27], v[170:171]
v_pk_add_f32 v[168:169], v[168:169], v[28:29]
v_pk_fma_f32 v[170:171], v[28:29], v[28:29], v[170:171]
v_pk_add_f32 v[168:169], v[168:169], v[30:31]
v_pk_fma_f32 v[170:171], v[30:31], v[30:31], v[170:171]
v_pk_add_f32 v[168:169], v[168:169], v[32:33]
v_pk_fma_f32 v[170:171], v[32:33], v[32:33], v[170:171]
v_pk_add_f32 v[168:169], v[168:169], v[34:35]
v_pk_fma_f32 v[170:171], v[34:35], v[34:35], v[170:171]
v_pk_add_f32 v[168:169], v[168:169], v[36:37]
v_pk_fma_f32 v[170:171], v[36:37], v[36:37], v[170:171]
v_pk_add_f32 v[168:169], v[168:169], v[38:39]
v_pk_fma_f32 v[170:171], v[38:39], v[38:39], v[170:171]
v_pk_add_f32 v[168:169], v[168:169], v[40:41]
v_pk_fma_f32 v[170:171], v[40:41], v[40:41], v[170:171]
v_pk_add_f32 v[168:169], v[168:169], v[42:43]
v_pk_fma_f32 v[170:171], v[42:43], v[42:43], v[170:171]
v_pk_add_f32 v[168:169], v[168:169], v[44:45]
v_pk_fma_f32 v[170:171], v[44:45], v[44:45], v[170:171]
v_pk_add_f32 v[168:169], v[168:169], v[46:47]
v_pk_fma_f32 v[170:171], v[46:47], v[46:47], v[170:171]
s_setprio 0
v_add_u32 v174, -36864, v242
v_subrev_u32 v175, 66560, v174
v_min_u32 v174, v174, v175
v_add_u32 v174, 90112, v174
v_sub_u32 v175, v174, v242
v_add_u32 v242, v175, v242
v_add_u32 v243, v175, v243
v_add_u32 v244, v175, v244
v_lshlrev_b32 v252, 7, v251
s_add_u32 s46, s47, 1572864
s_mov_b32 exec_lo, 0
s_mov_b32 exec_hi, 1048572
s_mov_b32 m0, 16152
s_nop 0
buffer_load_dword v252, s[4:7], s46 offen lds
s_mov_b64 exec, -1
s_setprio 2
v_cvt_pkrtz_f16_f32 v179, v120, v121
v_cvt_pkrtz_f16_f32 v181, v122, v123
v_cvt_pkrtz_f16_f32 v183, v124, v125
v_cvt_pkrtz_f16_f32 v185, v126, v127
v_cvt_pkrtz_f16_f32 v187, v128, v129
v_cvt_pkrtz_f16_f32 v189, v130, v131
v_cvt_pk_f16_f32 v155, v132, v133
v_cvt_pk_f16_f32 v152, v134, v135
s_waitcnt lgkmcnt(1)
ds_read_b128 v[224:227], v249 offset:17408
ds_read_u16_d16 v142, v142
ds_read_u16_d16_hi v143, v143
v_mfma_f32_32x32x16_bf16 v[120:135], v[48:51], v[228:231], 0
v_pk_fma_f16 v154, v155, v155, s48
v_add_f32 v168, v168, v169
v_and_b32 v179, s49, v179
v_fma_mix_f32 v164, v136, v136, v164 op_sel:[0,0,0] op_sel_hi:[1,1,0]
v_lshrrev_b16 v178, 2, v179
v_add_f32 v170, v170, v171
v_pk_fma_f16 v151, v152, v152, s48
v_pk_mul_f16 v154, v155, v154
v_lshrrev_b32 v179, 18, v179
v_pk_mul_f16 v151, v152, v151
ds_read_b128 v[228:231], v249 offset:18432
ds_read_u16_d16 v178, v178
ds_read_u16_d16_hi v179, v179
v_mfma_f32_32x32x16_bf16 v[120:135], v[52:55], v[232:235], v[120:135]
v_permlane32_swap_b32 v168, v170
v_fma_mix_f32 v164, v137, v137, v164 op_sel:[1,1,0] op_sel_hi:[1,1,0]
v_and_b32 v181, s49, v181
v_exp_f16 v153, v154
v_add_f32 v168, v168, v170
v_lshrrev_b16 v180, 2, v181
v_exp_f16 v150, v151
v_lshrrev_b32 v181, 18, v181
ds_read_b128 v[232:235], v249 offset:21504
ds_read_u16_d16 v180, v180
ds_read_u16_d16_hi v181, v181
v_mfma_f32_32x32x16_bf16 v[120:135], v[56:59], v[236:239], v[120:135]
v_mul_f32 v168, 1009429163, v168
v_fma_mix_f32 v164, v138, v138, v164 op_sel:[0,0,0] op_sel_hi:[1,1,0]
v_exp_f16_sdwa v153, v154 dst_sel:WORD_1 dst_unused:UNUSED_PRESERVE src0_sel:WORD_1
v_and_b32 v183, s49, v183
v_mov_b32 v170, v168
v_exp_f16_sdwa v150, v151 dst_sel:WORD_1 dst_unused:UNUSED_PRESERVE src0_sel:WORD_1
v_lshrrev_b16 v182, 2, v183
v_fma_mix_f32 v164, v139, v139, v164 op_sel:[1,1,0] op_sel_hi:[1,1,0]
v_permlane32_swap_b32 v168, v170
ds_read_b128 v[236:239], v249 offset:19456
ds_read_u16_d16 v182, v182
v_mfma_f32_32x32x16_bf16 v[120:135], v[60:63], v[216:219], v[120:135]
v_lshrrev_b32 v183, 18, v183
v_pk_add_f16 v153, v153, 1.0 op_sel_hi:[1,0]
v_pk_add_f16 v150, v150, 1.0 op_sel_hi:[1,0]
v_and_b32 v185, s49, v185
v_fma_f32 v170, -v168, v168, v170
v_rcp_f16 v154, v153
v_lshrrev_b16 v184, 2, v185
v_max_f32 v170, 0, v170
v_fma_mix_f32 v164, v140, v140, v164 op_sel:[0,0,0] op_sel_hi:[1,1,0]
ds_read_b128 v[216:219], v249 offset:22528
ds_read_u16_d16_hi v183, v183
ds_read_u16_d16 v184, v184
v_mfma_f32_32x32x16_bf16 v[120:135], v[64:67], v[220:223], v[120:135]
v_lshrrev_b32 v185, 18, v185
v_rcp_f16 v151, v150
v_add_f32 v170, 925353388, v170
v_and_b32 v187, s49, v187
v_fma_mix_f32 v164, v141, v141, v164 op_sel:[1,1,0] op_sel_hi:[1,1,0]
v_rcp_f16_sdwa v154, v153 dst_sel:WORD_1 dst_unused:UNUSED_PRESERVE src0_sel:WORD_1
v_rsq_f32 v170, v170
s_waitcnt lgkmcnt(5)
ds_read_b128 v[220:223], v249 offset:20480
ds_read_u16_d16_hi v185, v185
ds_read_b32 v247, v253 offset:16
v_mfma_f32_32x32x16_bf16 v[120:135], v[68:71], v[224:227], v[120:135]
v_lshrrev_b16 v186, 2, v187
v_rcp_f16_sdwa v151, v150 dst_sel:WORD_1 dst_unused:UNUSED_PRESERVE src0_sel:WORD_1
v_lshrrev_b32 v187, 18, v187
v_fma_mix_f32 v164, v142, v142, v164 op_sel:[0,0,0] op_sel_hi:[1,1,0]
v_and_b32 v189, s49, v189
v_pk_mul_f16 v155, v155, v154
v_pk_mul_f16 v152, v152, v151
v_mul_f32 v172, 3203391086, v170
v_lshrrev_b16 v188, 2, v189
v_fma_mix_f32 v165, v155, v155, 0 op_sel:[0,0,0] op_sel_hi:[1,1,0]
v_fma_mix_f32 v164, v143, v143, v164 op_sel:[1,1,0] op_sel_hi:[1,1,0]
v_lshrrev_b32 v189, 18, v189
v_mul_f32 v173, v168, v172
v_fma_mix_f32 v165, v155, v155, v165 op_sel:[1,1,0] op_sel_hi:[1,1,0]
v_fma_mix_f32 v165, v152, v152, v165 op_sel:[0,0,0] op_sel_hi:[1,1,0]
v_fma_mix_f32 v165, v152, v152, v165 op_sel:[1,1,0] op_sel_hi:[1,1,0]
s_setprio 3
v_pk_fma_f32 v[0:1], v[0:1], v[172:173], v[172:173] op_sel:[0,0,1] op_sel_hi:[1,0,1] neg_lo:[0,0,1] neg_hi:[0,0,1]
v_pk_fma_f32 v[2:3], v[2:3], v[172:173], v[172:173] op_sel:[0,0,1] op_sel_hi:[1,0,1] neg_lo:[0,0,1] neg_hi:[0,0,1]
v_pk_fma_f32 v[4:5], v[4:5], v[172:173], v[172:173] op_sel:[0,0,1] op_sel_hi:[1,0,1] neg_lo:[0,0,1] neg_hi:[0,0,1]
v_pk_fma_f32 v[6:7], v[6:7], v[172:173], v[172:173] op_sel:[0,0,1] op_sel_hi:[1,0,1] neg_lo:[0,0,1] neg_hi:[0,0,1]
v_pk_fma_f32 v[8:9], v[8:9], v[172:173], v[172:173] op_sel:[0,0,1] op_sel_hi:[1,0,1] neg_lo:[0,0,1] neg_hi:[0,0,1]
v_pk_fma_f32 v[10:11], v[10:11], v[172:173], v[172:173] op_sel:[0,0,1] op_sel_hi:[1,0,1] neg_lo:[0,0,1] neg_hi:[0,0,1]
v_pk_fma_f32 v[12:13], v[12:13], v[172:173], v[172:173] op_sel:[0,0,1] op_sel_hi:[1,0,1] neg_lo:[0,0,1] neg_hi:[0,0,1]
v_pk_fma_f32 v[14:15], v[14:15], v[172:173], v[172:173] op_sel:[0,0,1] op_sel_hi:[1,0,1] neg_lo:[0,0,1] neg_hi:[0,0,1]
v_pk_fma_f32 v[16:17], v[16:17], v[172:173], v[172:173] op_sel:[0,0,1] op_sel_hi:[1,0,1] neg_lo:[0,0,1] neg_hi:[0,0,1]
v_pk_fma_f32 v[18:19], v[18:19], v[172:173], v[172:173] op_sel:[0,0,1] op_sel_hi:[1,0,1] neg_lo:[0,0,1] neg_hi:[0,0,1]
v_pk_fma_f32 v[20:21], v[20:21], v[172:173], v[172:173] op_sel:[0,0,1] op_sel_hi:[1,0,1] neg_lo:[0,0,1] neg_hi:[0,0,1]
v_pk_fma_f32 v[22:23], v[22:23], v[172:173], v[172:173] op_sel:[0,0,1] op_sel_hi:[1,0,1] neg_lo:[0,0,1] neg_hi:[0,0,1]
v_pk_fma_f32 v[24:25], v[24:25], v[172:173], v[172:173] op_sel:[0,0,1] op_sel_hi:[1,0,1] neg_lo:[0,0,1] neg_hi:[0,0,1]
v_pk_fma_f32 v[26:27], v[26:27], v[172:173], v[172:173] op_sel:[0,0,1] op_sel_hi:[1,0,1] neg_lo:[0,0,1] neg_hi:[0,0,1]
v_pk_fma_f32 v[28:29], v[28:29], v[172:173], v[172:173] op_sel:[0,0,1] op_sel_hi:[1,0,1] neg_lo:[0,0,1] neg_hi:[0,0,1]
v_pk_fma_f32 v[30:31], v[30:31], v[172:173], v[172:173] op_sel:[0,0,1] op_sel_hi:[1,0,1] neg_lo:[0,0,1] neg_hi:[0,0,1]
v_pk_fma_f32 v[32:33], v[32:33], v[172:173], v[172:173] op_sel:[0,0,1] op_sel_hi:[1,0,1] neg_lo:[0,0,1] neg_hi:[0,0,1]
v_pk_fma_f32 v[34:35], v[34:35], v[172:173], v[172:173] op_sel:[0,0,1] op_sel_hi:[1,0,1] neg_lo:[0,0,1] neg_hi:[0,0,1]
v_pk_fma_f32 v[36:37], v[36:37], v[172:173], v[172:173] op_sel:[0,0,1] op_sel_hi:[1,0,1] neg_lo:[0,0,1] neg_hi:[0,0,1]
v_pk_fma_f32 v[38:39], v[38:39], v[172:173], v[172:173] op_sel:[0,0,1] op_sel_hi:[1,0,1] neg_lo:[0,0,1] neg_hi:[0,0,1]
v_pk_fma_f32 v[40:41], v[40:41], v[172:173], v[172:173] op_sel:[0,0,1] op_sel_hi:[1,0,1] neg_lo:[0,0,1] neg_hi:[0,0,1]
v_pk_fma_f32 v[42:43], v[42:43], v[172:173], v[172:173] op_sel:[0,0,1] op_sel_hi:[1,0,1] neg_lo:[0,0,1] neg_hi:[0,0,1]
v_pk_fma_f32 v[44:45], v[44:45], v[172:173], v[172:173] op_sel:[0,0,1] op_sel_hi:[1,0,1] neg_lo:[0,0,1] neg_hi:[0,0,1]
v_pk_fma_f32 v[46:47], v[46:47], v[172:173], v[172:173] op_sel:[0,0,1] op_sel_hi:[1,0,1] neg_lo:[0,0,1] neg_hi:[0,0,1]
s_setprio 2
ds_read_u16_d16 v186, v186
ds_read_u16_d16_hi v187, v187
ds_read_u16_d16 v188, v188
ds_read_u16_d16_hi v189, v189
s_waitcnt lgkmcnt(4)
v_readfirstlane_b32 s43, v247
s_nop 1
s_cmp_ge_u32 s43, 16
s_cbranch_scc1 Lev5
Lev5w:
s_sleep 1
ds_read_b32 v247, v253 offset:16
s_waitcnt lgkmcnt(0)
v_readfirstlane_b32 s43, v247
s_cmp_eq_u32 s76, 0
s_cbranch_scc1 Lev5
s_sub_u32 s76, s76, 1
s_cmp_lt_u32 s43, 16
s_cbranch_scc1 Lev5w
Lev5:
s_setprio 1
v_cvt_pkrtz_f16_f32 v137, v120, v121
v_cvt_pkrtz_f16_f32 v139, v122, v123
v_cvt_pkrtz_f16_f32 v141, v124, v125
v_cvt_pkrtz_f16_f32 v143, v126, v127
v_cvt_pkrtz_f16_f32 v177, v128, v129
v_cvt_pkrtz_f16_f32 v191, v130, v131
v_cvt_pk_f16_f32 v155, v132, v133
v_cvt_pk_f16_f32 v152, v134, v135
s_add_u32 m0, s67, 53248
s_add_u32 s66, s66, 98304
buffer_load_dwordx4 v240, s[4:7], s66 offen lds
ds_read_b128 v[224:227], v249 offset:23552
v_mfma_f32_32x32x16_bf16 v[120:135], v[48:51], v[228:231], 0
v_pk_fma_f16 v154, v155, v155, s48
v_cvt_pk_bf16_f32 v72, v0, v1
v_and_b32 v137, s49, v137
v_fma_mix_f32 v165, v178, v178, v165 op_sel:[0,0,0] op_sel_hi:[1,1,0]
v_cvt_pk_bf16_f32 v73, v2, v3
v_pk_fma_f16 v151, v152, v152, s48
v_lshrrev_b16 v136, 2, v137
v_cvt_pk_bf16_f32 v74, v4, v5
v_pk_mul_f16 v154, v155, v154
v_fma_mix_f32 v165, v179, v179, v165 op_sel:[1,1,0] op_sel_hi:[1,1,0]
v_lshrrev_b32 v137, 18, v137
v_cvt_pk_bf16_f32 v75, v6, v7
s_add_u32 m0, s67, 59904
s_add_u32 s66, s66, 98304
buffer_load_dwordx4 v240, s[4:7], s66 offen lds
ds_read_b128 v[228:231], v248 offset:16384
ds_read_u16_d16 v136, v136
ds_read_u16_d16_hi v137, v137
v_mfma_f32_32x32x16_bf16 v[120:135], v[52:55], v[232:235], v[120:135]
v_pk_mul_f16 v151, v152, v151
v_exp_f16 v153, v154
v_cvt_pk_bf16_f32 v76, v8, v9
v_and_b32 v139, s49, v139
v_fma_mix_f32 v165, v180, v180, v165 op_sel:[0,0,0] op_sel_hi:[1,1,0]
v_cvt_pk_bf16_f32 v77, v10, v11
v_lshrrev_b16 v138, 2, v139
v_exp_f16 v150, v151
v_cvt_pk_bf16_f32 v78, v12, v13
v_lshrrev_b32 v139, 18, v139
v_cvt_pk_bf16_f32 v79, v14, v15
s_add_u32 m0, s67, 0
s_add_u32 s66, s66, 98304
buffer_load_dwordx4 v240, s[4:7], s66 offen lds
ds_read_b128 v[232:235], v248 offset:19456
ds_read_u16_d16 v138, v138
ds_read_u16_d16_hi v139, v139
v_mfma_f32_32x32x16_bf16 v[120:135], v[56:59], v[236:239], v[120:135]
v_fma_mix_f32 v165, v181, v181, v165 op_sel:[1,1,0] op_sel_hi:[1,1,0]
v_exp_f16_sdwa v153, v154 dst_sel:WORD_1 dst_unused:UNUSED_PRESERVE src0_sel:WORD_1
v_cvt_pk_bf16_f32 v80, v16, v17
v_and_b32 v141, s49, v141
v_fma_mix_f32 v165, v182, v182, v165 op_sel:[0,0,0] op_sel_hi:[1,1,0]
v_cvt_pk_bf16_f32 v81, v18, v19
v_lshrrev_b16 v140, 2, v141
v_exp_f16_sdwa v150, v151 dst_sel:WORD_1 dst_unused:UNUSED_PRESERVE src0_sel:WORD_1
v_cvt_pk_bf16_f32 v82, v20, v21
v_lshrrev_b32 v141, 18, v141
s_add_u32 m0, s67, 6656
s_add_u32 s66, s66, 98304
buffer_load_dwordx4 v240, s[4:7], s66 offen lds
s_add_u32 m0, s67, 13312
s_add_u32 s66, s66, 98304
buffer_load_dwordx4 v240, s[4:7], s66 offen lds
ds_read_b128 v[236:239], v248 offset:17408
ds_read_u16_d16 v140, v140
ds_read_u16_d16_hi v141, v141
v_mfma_f32_32x32x16_bf16 v[120:135], v[60:63], v[216:219], v[120:135]
v_fma_mix_f32 v165, v183, v183, v165 op_sel:[1,1,0] op_sel_hi:[1,1,0]
v_cvt_pk_bf16_f32 v83, v22, v23
v_pk_add_f16 v153, v153, 1.0 op_sel_hi:[1,0]
v_pk_add_f16 v150, v150, 1.0 op_sel_hi:[1,0]
v_and_b32 v143, s49, v143
v_cvt_pk_bf16_f32 v84, v24, v25
v_rcp_f16 v154, v153
v_cvt_pk_bf16_f32 v85, v26, v27
v_lshrrev_b16 v142, 2, v143
v_fma_mix_f32 v165, v184, v184, v165 op_sel:[0,0,0] op_sel_hi:[1,1,0]
v_cvt_pk_bf16_f32 v86, v28, v29
s_add_u32 m0, s67, 19968
s_add_u32 s66, s66, 98304
buffer_load_dwordx4 v240, s[4:7], s66 offen lds
ds_read_b128 v[216:219], v248 offset:20480
ds_read_u16_d16 v142, v142
v_mfma_f32_32x32x16_bf16 v[120:135], v[64:67], v[220:223], v[120:135]
v_rcp_f16 v151, v150
v_lshrrev_b32 v143, 18, v143
v_cvt_pk_bf16_f32 v87, v30, v31
v_fma_mix_f32 v165, v185, v185, v165 op_sel:[1,1,0] op_sel_hi:[1,1,0]
v_and_b32 v177, s49, v177
s_setprio 0
v_cvt_pk_bf16_f32 v88, v32, v33
v_rcp_f16_sdwa v154, v153 dst_sel:WORD_1 dst_unused:UNUSED_PRESERVE src0_sel:WORD_1
v_lshrrev_b16 v176, 2, v177
v_cvt_pk_bf16_f32 v89, v34, v35
s_waitcnt lgkmcnt(2)
v_fma_mix_f32 v165, v186, v186, v165 op_sel:[0,0,0] op_sel_hi:[1,1,0]
v_rcp_f16_sdwa v151, v150 dst_sel:WORD_1 dst_unused:UNUSED_PRESERVE src0_sel:WORD_1
s_add_u32 m0, s67, 26624
s_add_u32 s66, s66, 98304
buffer_load_dwordx4 v240, s[4:7], s66 offen lds
ds_read_b128 v[220:223], v248 offset:18432
ds_read_u16_d16_hi v143, v143
ds_read_u16_d16 v176, v176
v_mfma_f32_32x32x16_bf16 v[120:135], v[68:71], v[224:227], v[120:135]
v_cvt_pk_bf16_f32 v90, v36, v37
v_lshrrev_b32 v177, 18, v177
v_cvt_pk_bf16_f32 v91, v38, v39
v_fma_mix_f32 v165, v187, v187, v165 op_sel:[1,1,0] op_sel_hi:[1,1,0]
v_and_b32 v191, s49, v191
v_pk_mul_f16 v155, v155, v154
v_cvt_pk_bf16_f32 v92, v40, v41
v_pk_mul_f16 v152, v152, v151
v_lshrrev_b16 v190, 2, v191
v_cvt_pk_bf16_f32 v93, v42, v43
v_fma_mix_f32 v165, v188, v188, v165 op_sel:[0,0,0] op_sel_hi:[1,1,0]
v_fma_mix_f32 v166, v155, v155, 0 op_sel:[0,0,0] op_sel_hi:[1,1,0]
s_add_u32 m0, s67, 33280
s_add_u32 s66, s66, 98304
buffer_load_dwordx4 v240, s[4:7], s66 offen lds
v_lshrrev_b32 v191, 18, v191
v_cvt_pk_bf16_f32 v94, v44, v45
v_fma_mix_f32 v166, v155, v155, v166 op_sel:[1,1,0] op_sel_hi:[1,1,0]
v_fma_mix_f32 v165, v189, v189, v165 op_sel:[1,1,0] op_sel_hi:[1,1,0]
v_cvt_pk_bf16_f32 v95, v46, v47
v_fma_mix_f32 v166, v152, v152, v166 op_sel:[0,0,0] op_sel_hi:[1,1,0]
v_fma_mix_f32 v166, v152, v152, v166 op_sel:[1,1,0] op_sel_hi:[1,1,0]
s_setprio 2
v_cvt_pkrtz_f16_f32 v179, v120, v121
v_cvt_pkrtz_f16_f32 v181, v122, v123
v_cvt_pkrtz_f16_f32 v183, v124, v125
v_cvt_pkrtz_f16_f32 v185, v126, v127
v_cvt_pkrtz_f16_f32 v187, v128, v129
v_cvt_pk_f16_f32 v155, v130, v131
v_cvt_pk_f16_f32 v152, v132, v133
v_cvt_pk_f16_f32 v149, v134, v135
ds_read_b128 v[224:227], v248 offset:21504
ds_read_u16_d16_hi v177, v177
ds_read_u16_d16 v190, v190
ds_read_u16_d16_hi v191, v191
v_mfma_f32_32x32x16_bf16 v[120:135], v[72:75], v[228:231], 0
v_pk_fma_f16 v154, v155, v155, s48
v_and_b32 v179, s49, v179
v_fma_mix_f32 v166, v136, v136, v166 op_sel:[0,0,0] op_sel_hi:[1,1,0]
v_pk_fma_f16 v151, v152, v152, s48
v_pk_fma_f16 v148, v149, v149, s48
v_lshrrev_b16 v178, 2, v179
v_pk_mul_f16 v154, v155, v154
v_fma_mix_f32 v166, v137, v137, v166 op_sel:[1,1,0] op_sel_hi:[1,1,0]
v_pk_mul_f16 v151, v152, v151
v_lshrrev_b32 v179, 18, v179
ds_read_b128 v[228:231], v248 offset:22528
ds_read_u16_d16 v178, v178
ds_read_u16_d16_hi v179, v179
v_mfma_f32_32x32x16_bf16 v[120:135], v[76:79], v[232:235], v[120:135]
v_pk_mul_f16 v148, v149, v148
v_exp_f16 v153, v154
v_fma_mix_f32 v166, v138, v138, v166 op_sel:[0,0,0] op_sel_hi:[1,1,0]
v_and_b32 v181, s49, v181
v_exp_f16 v150, v151
v_exp_f16 v147, v148
v_lshrrev_b16 v180, 2, v181
v_fma_mix_f32 v166, v139, v139, v166 op_sel:[1,1,0] op_sel_hi:[1,1,0]
ds_read_b128 v[232:235], v248 offset:25600
ds_read_u16_d16 v180, v180
v_mfma_f32_32x32x16_bf16 v[120:135], v[80:83], v[236:239], v[120:135]
v_exp_f16_sdwa v153, v154 dst_sel:WORD_1 dst_unused:UNUSED_PRESERVE src0_sel:WORD_1
v_lshrrev_b32 v181, 18, v181
v_exp_f16_sdwa v150, v151 dst_sel:WORD_1 dst_unused:UNUSED_PRESERVE src0_sel:WORD_1
v_fma_mix_f32 v166, v140, v140, v166 op_sel:[0,0,0] op_sel_hi:[1,1,0]
v_and_b32 v183, s49, v183
v_exp_f16_sdwa v147, v148 dst_sel:WORD_1 dst_unused:UNUSED_PRESERVE src0_sel:WORD_1
v_fma_mix_f32 v166, v141, v141, v166 op_sel:[1,1,0] op_sel_hi:[1,1,0]
s_waitcnt lgkmcnt(5)
ds_read_b128 v[236:239], v248 offset:23552
ds_read_u16_d16_hi v181, v181
v_mfma_f32_32x32x16_bf16 v[120:135], v[84:87], v[216:219], v[120:135]
v_pk_add_f16 v153, v153, 1.0 op_sel_hi:[1,0]
v_lshrrev_b16 v182, 2, v183
v_pk_add_f16 v150, v150, 1.0 op_sel_hi:[1,0]
v_pk_add_f16 v147, v147, 1.0 op_sel_hi:[1,0]
v_rcp_f16 v154, v153
v_lshrrev_b32 v183, 18, v183
v_fma_mix_f32 v166, v142, v142, v166 op_sel:[0,0,0] op_sel_hi:[1,1,0]
v_rcp_f16 v151, v150
v_and_b32 v185, s49, v185
ds_read_b128 v[216:219], v248 offset:26624
ds_read_u16_d16 v182, v182
ds_read_u16_d16_hi v183, v183
v_mfma_f32_32x32x16_bf16 v[120:135], v[88:91], v[220:223], v[120:135]
v_fma_mix_f32 v166, v143, v143, v166 op_sel:[1,1,0] op_sel_hi:[1,1,0]
v_rcp_f16 v148, v147
v_lshrrev_b16 v184, 2, v185
v_rcp_f16_sdwa v154, v153 dst_sel:WORD_1 dst_unused:UNUSED_PRESERVE src0_sel:WORD_1
v_fma_mix_f32 v166, v176, v176, v166 op_sel:[0,0,0] op_sel_hi:[1,1,0]
v_rcp_f16_sdwa v151, v150 dst_sel:WORD_1 dst_unused:UNUSED_PRESERVE src0_sel:WORD_1
v_lshrrev_b32 v185, 18, v185
ds_read_b128 v[220:223], v248 offset:24576
ds_read_u16_d16 v184, v184
ds_read_u16_d16_hi v185, v185
v_mfma_f32_32x32x16_bf16 v[120:135], v[92:95], v[224:227], v[120:135]
v_rcp_f16_sdwa v148, v147 dst_sel:WORD_1 dst_unused:UNUSED_PRESERVE src0_sel:WORD_1
s_cmp_eq_u32 s40, 7
s_cbranch_scc1 Lrdy16
s_waitcnt vmcnt(0)
Lrdy16:
s_mov_b64 exec, 1
ds_add_u32 v253, v254 offset:12
s_mov_b64 exec, -1
v_and_b32 v187, s49, v187
v_fma_mix_f32 v166, v177, v177, v166 op_sel:[1,1,0] op_sel_hi:[1,1,0]
v_pk_mul_f16 v155, v155, v154
v_pk_mul_f16 v152, v152, v151
v_pk_mul_f16 v149, v149, v148
v_lshrrev_b16 v186, 2, v187
v_fma_mix_f32 v166, v190, v190, v166 op_sel:[0,0,0] op_sel_hi:[1,1,0]
v_fma_mix_f32 v167, v155, v155, 0 op_sel:[0,0,0] op_sel_hi:[1,1,0]
v_fma_mix_f32 v167, v155, v155, v167 op_sel:[1,1,0] op_sel_hi:[1,1,0]
v_lshrrev_b32 v187, 18, v187
v_fma_mix_f32 v167, v152, v152, v167 op_sel:[0,0,0] op_sel_hi:[1,1,0]
v_fma_mix_f32 v166, v191, v191, v166 op_sel:[1,1,0] op_sel_hi:[1,1,0]
v_fma_mix_f32 v167, v152, v152, v167 op_sel:[1,1,0] op_sel_hi:[1,1,0]
v_fma_mix_f32 v167, v149, v149, v167 op_sel:[0,0,0] op_sel_hi:[1,1,0]
v_fma_mix_f32 v167, v149, v149, v167 op_sel:[1,1,0] op_sel_hi:[1,1,0]
s_setprio 1
v_cvt_pkrtz_f16_f32 v137, v120, v121
v_cvt_pkrtz_f16_f32 v139, v122, v123
v_cvt_pkrtz_f16_f32 v141, v124, v125
v_cvt_pkrtz_f16_f32 v143, v126, v127
v_cvt_pkrtz_f16_f32 v177, v128, v129
v_cvt_pk_f16_f32 v155, v130, v131
v_cvt_pk_f16_f32 v152, v132, v133
v_cvt_pk_f16_f32 v149, v134, v135
s_waitcnt lgkmcnt(1)
ds_read_b128 v[224:227], v248 offset:27648
ds_read_u16_d16 v186, v186
ds_read_u16_d16_hi v187, v187
v_mfma_f32_32x32x16_bf16 v[120:135], v[72:75], v[228:231], 0
v_pk_fma_f16 v154, v155, v155, s48
v_and_b32 v137, s49, v137
v_fma_mix_f32 v167, v178, v178, v167 op_sel:[0,0,0] op_sel_hi:[1,1,0]
v_pk_fma_f16 v151, v152, v152, s48
v_pk_fma_f16 v148, v149, v149, s48
v_lshrrev_b16 v136, 2, v137
v_pk_mul_f16 v154, v155, v154
v_pk_mul_f16 v151, v152, v151
v_fma_mix_f32 v167, v179, v179, v167 op_sel:[1,1,0] op_sel_hi:[1,1,0]
v_lshrrev_b32 v137, 18, v137
ds_read_b128 v[228:231], v250 offset:65520
ds_read_u16_d16 v136, v136
ds_read_u16_d16_hi v137, v137
v_mfma_f32_32x32x16_bf16 v[120:135], v[76:79], v[232:235], v[120:135]
v_pk_mul_f16 v148, v149, v148
v_exp_f16 v153, v154
v_exp_f16 v150, v151
v_and_b32 v139, s49, v139
v_fma_mix_f32 v167, v180, v180, v167 op_sel:[0,0,0] op_sel_hi:[1,1,0]
v_exp_f16 v147, v148
v_lshrrev_b16 v138, 2, v139
ds_read_b128 v[232:235], v248 offset:28672
ds_read_b32 v247, v253 offset:12
ds_read_u16_d16 v138, v138
v_mfma_f32_32x32x16_bf16 v[120:135], v[80:83], v[236:239], v[120:135]
v_exp_f16_sdwa v153, v154 dst_sel:WORD_1 dst_unused:UNUSED_PRESERVE src0_sel:WORD_1
v_lshrrev_b32 v139, 18, v139
v_fma_mix_f32 v167, v181, v181, v167 op_sel:[1,1,0] op_sel_hi:[1,1,0]
v_exp_f16_sdwa v150, v151 dst_sel:WORD_1 dst_unused:UNUSED_PRESERVE src0_sel:WORD_1
v_exp_f16_sdwa v147, v148 dst_sel:WORD_1 dst_unused:UNUSED_PRESERVE src0_sel:WORD_1
v_and_b32 v141, s49, v141
v_fma_mix_f32 v167, v182, v182, v167 op_sel:[0,0,0] op_sel_hi:[1,1,0]
ds_read_b128 v[236:239], v248 offset:31744
ds_read_u16_d16_hi v139, v139
v_mfma_f32_32x32x16_bf16 v[120:135], v[84:87], v[216:219], v[120:135]
v_pk_add_f16 v153, v153, 1.0 op_sel_hi:[1,0]
v_lshrrev_b16 v140, 2, v141
v_pk_add_f16 v150, v150, 1.0 op_sel_hi:[1,0]
v_pk_add_f16 v147, v147, 1.0 op_sel_hi:[1,0]
v_rcp_f16 v154, v153
v_lshrrev_b32 v141, 18, v141
ds_read_u16_d16 v140, v140
ds_read_u16_d16_hi v141, v141
s_waitcnt lgkmcnt(5)
v_readfirstlane_b32 s43, v247
s_nop 1
s_cmp_ge_u32 s43, 24
s_cbranch_scc1 Lev6
Lev6w:
s_sleep 1
ds_read_b32 v247, v253 offset:12
s_waitcnt lgkmcnt(0)
v_readfirstlane_b32 s43, v247
s_cmp_eq_u32 s76, 0
s_cbranch_scc1 Lev6
s_sub_u32 s76, s76, 1
s_cmp_lt_u32 s43, 24
s_cbranch_scc1 Lev6w
Lev6:
v_fma_mix_f32 v167, v183, v183, v167 op_sel:[1,1,0] op_sel_hi:[1,1,0]
v_rcp_f16 v151, v150
ds_read_b128 v[216:219], v248 offset:29696
v_mfma_f32_32x32x16_bf16 v[120:135], v[88:91], v[220:223], v[120:135]
v_and_b32 v143, s49, v143
v_rcp_f16 v148, v147
v_fma_mix_f32 v167, v184, v184, v167 op_sel:[0,0,0] op_sel_hi:[1,1,0]
v_lshrrev_b16 v142, 2, v143
s_setprio 0
v_rcp_f16_sdwa v154, v153 dst_sel:WORD_1 dst_unused:UNUSED_PRESERVE src0_sel:WORD_1
v_rcp_f16_sdwa v151, v150 dst_sel:WORD_1 dst_unused:UNUSED_PRESERVE src0_sel:WORD_1
v_lshrrev_b32 v143, 18, v143
ds_read_b128 v[220:223], v245
ds_read_b128 v[192:195], v242
ds_read_b128 v[196:199], v242 offset:64
ds_read_u16_d16 v142, v142
ds_read_u16_d16_hi v143, v143
v_mfma_f32_32x32x16_bf16 v[120:135], v[92:95], v[224:227], v[120:135]
v_fma_mix_f32 v167, v185, v185, v167 op_sel:[1,1,0] op_sel_hi:[1,1,0]
v_rcp_f16_sdwa v148, v147 dst_sel:WORD_1 dst_unused:UNUSED_PRESERVE src0_sel:WORD_1
v_and_b32 v177, s49, v177
v_pk_mul_f16 v155, v155, v154
v_fma_mix_f32 v167, v186, v186, v167 op_sel:[0,0,0] op_sel_hi:[1,1,0]
v_pk_mul_f16 v152, v152, v151
v_lshrrev_b16 v176, 2, v177
v_pk_mul_f16 v149, v149, v148
v_fma_mix_f32 v156, v155, v155, v156 op_sel:[0,0,0] op_sel_hi:[1,1,0]
v_fma_mix_f32 v156, v155, v155, v156 op_sel:[1,1,0] op_sel_hi:[1,1,0]
v_lshrrev_b32 v177, 18, v177
v_fma_mix_f32 v167, v187, v187, v167 op_sel:[1,1,0] op_sel_hi:[1,1,0]
v_fma_mix_f32 v156, v152, v152, v156 op_sel:[0,0,0] op_sel_hi:[1,1,0]
v_fma_mix_f32 v156, v152, v152, v156 op_sel:[1,1,0] op_sel_hi:[1,1,0]
v_fma_mix_f32 v156, v149, v149, v156 op_sel:[0,0,0] op_sel_hi:[1,1,0]
v_fma_mix_f32 v156, v149, v149, v156 op_sel:[1,1,0] op_sel_hi:[1,1,0]
s_setprio 2
v_mfma_f32_32x32x16_bf16 v[0:15], v[228:231], v[228:231], 0
s_add_u32 s46, s80, 8388608
buffer_store_dwordx4 v[64:67], v241, s[32:35], s46 offen sc1
ds_read_b128 v[224:227], v248 offset:32768
ds_read_u16_d16 v176, v176
ds_read_u16_d16_hi v177, v177
v_cvt_pkrtz_f16_f32 v179, v120, v121
v_cvt_pkrtz_f16_f32 v181, v122, v123
v_cvt_pkrtz_f16_f32 v183, v124, v125
v_mfma_f32_32x32x16_bf16 v[16:31], v[228:231], v[228:231], 0
v_cvt_pkrtz_f16_f32 v185, v126, v127
v_cvt_pkrtz_f16_f32 v187, v128, v129
v_cvt_pk_f16_f32 v155, v130, v131
v_cvt_pk_f16_f32 v152, v132, v133
v_mfma_f32_32x32x16_bf16 v[32:47], v[228:231], v[228:231], 0
v_cvt_pk_f16_f32 v149, v134, v135
v_pk_fma_f16 v154, v155, v155, s48
v_and_b32 v179, s49, v179
v_mfma_f32_32x32x16_bf16 v[120:135], v[72:75], v[232:235], 0
ds_read_b128 v[228:231], v248 offset:30720
v_fma_mix_f32 v156, v136, v136, v156 op_sel:[0,0,0] op_sel_hi:[1,1,0]
v_pk_fma_f16 v151, v152, v152, s48
v_pk_fma_f16 v148, v149, v149, s48
v_lshrrev_b16 v178, 2, v179
v_pk_mul_f16 v154, v155, v154
v_pk_mul_f16 v151, v152, v151
v_fma_mix_f32 v156, v137, v137, v156 op_sel:[1,1,0] op_sel_hi:[1,1,0]
s_waitcnt lgkmcnt(4)
v_mfma_f32_32x32x16_bf16 v[120:135], v[76:79], v[236:239], v[120:135]
ds_read_b128 v[232:235], v245 offset:384
ds_read_b128 v[200:203], v242 offset:128
ds_read_b128 v[204:207], v243
ds_read_u16_d16 v178, v178
v_lshrrev_b32 v179, 18, v179
v_pk_mul_f16 v148, v149, v148
v_exp_f16 v153, v154
v_exp_f16 v150, v151
v_and_b32 v181, s49, v181
v_fma_mix_f32 v156, v138, v138, v156 op_sel:[0,0,0] op_sel_hi:[1,1,0]
v_mfma_f32_32x32x16_bf16 v[120:135], v[80:83], v[216:219], v[120:135]
ds_read_b128 v[236:239], v248 offset:33792
ds_read_u16_d16_hi v179, v179
v_exp_f16 v147, v148
v_lshrrev_b16 v180, 2, v181
v_exp_f16_sdwa v153, v154 dst_sel:WORD_1 dst_unused:UNUSED_PRESERVE src0_sel:WORD_1
v_lshrrev_b32 v181, 18, v181
v_fma_mix_f32 v156, v139, v139, v156 op_sel:[1,1,0] op_sel_hi:[1,1,0]
v_smfmac_f32_16x16x32_bf16 v[0:3], v[220:221], v[192:195], v246
ds_read_b128 v[216:219], v245 offset:768
ds_read_b128 v[208:211], v243 offset:64
ds_read_b128 v[212:215], v243 offset:128
ds_read_u16_d16 v180, v180
ds_read_u16_d16_hi v181, v181
v_exp_f16_sdwa v150, v151 dst_sel:WORD_1 dst_unused:UNUSED_PRESERVE src0_sel:WORD_1
v_smfmac_f32_16x16x32_bf16 v[16:19], v[222:223], v[196:199], v246
v_exp_f16_sdwa v147, v148 dst_sel:WORD_1 dst_unused:UNUSED_PRESERVE src0_sel:WORD_1
v_and_b32 v183, s49, v183
v_fma_mix_f32 v156, v140, v140, v156 op_sel:[0,0,0] op_sel_hi:[1,1,0]
v_pk_add_f16 v153, v153, 1.0 op_sel_hi:[1,0]
s_waitcnt lgkmcnt(7)
v_mfma_f32_32x32x16_bf16 v[120:135], v[84:87], v[224:227], v[120:135]
ds_read_b128 v[220:223], v245 offset:1152
ds_read_b128 v[192:195], v244
ds_read_b128 v[196:199], v244 offset:64
v_lshrrev_b16 v182, 2, v183
v_pk_add_f16 v150, v150, 1.0 op_sel_hi:[1,0]
v_pk_add_f16 v147, v147, 1.0 op_sel_hi:[1,0]
v_rcp_f16 v154, v153
v_lshrrev_b32 v183, 18, v183
v_fma_mix_f32 v156, v141, v141, v156 op_sel:[1,1,0] op_sel_hi:[1,1,0]
v_mfma_f32_32x32x16_bf16 v[120:135], v[88:91], v[228:231], v[120:135]
ds_read_b128 v[224:227], v248 offset:34816
ds_read_u16_d16 v182, v182
ds_read_u16_d16_hi v183, v183
v_rcp_f16 v151, v150
v_and_b32 v185, s49, v185
v_rcp_f16 v148, v147
v_fma_mix_f32 v156, v142, v142, v156 op_sel:[0,0,0] op_sel_hi:[1,1,0]
v_lshrrev_b16 v184, 2, v185
v_smfmac_f32_16x16x32_bf16 v[32:35], v[232:233], v[200:203], v246
ds_read_b128 v[228:231], v248 offset:37888
ds_read_u16_d16 v184, v184
v_rcp_f16_sdwa v154, v153 dst_sel:WORD_1 dst_unused:UNUSED_PRESERVE src0_sel:WORD_1
v_rcp_f16_sdwa v151, v150 dst_sel:WORD_1 dst_unused:UNUSED_PRESERVE src0_sel:WORD_1
v_smfmac_f32_16x16x32_bf16 v[0:3], v[234:235], v[204:207], v246
v_lshrrev_b32 v185, 18, v185
v_fma_mix_f32 v156, v143, v143, v156 op_sel:[1,1,0] op_sel_hi:[1,1,0]
s_waitcnt lgkmcnt(6)
v_mfma_f32_32x32x16_bf16 v[120:135], v[92:95], v[236:239], v[120:135]
ds_read_b128 v[232:235], v248 offset:35840
ds_read_u16_d16_hi v185, v185
v_rcp_f16_sdwa v148, v147 dst_sel:WORD_1 dst_unused:UNUSED_PRESERVE src0_sel:WORD_1
v_and_b32 v187, s49, v187
v_pk_mul_f16 v155, v155, v154
v_fma_mix_f32 v156, v176, v176, v156 op_sel:[0,0,0] op_sel_hi:[1,1,0]
v_pk_mul_f16 v152, v152, v151
v_lshrrev_b16 v186, 2, v187
v_pk_mul_f16 v149, v149, v148
v_smfmac_f32_16x16x32_bf16 v[16:19], v[216:217], v[208:211], v246
ds_read_b128 v[236:239], v248 offset:38912
ds_read_u16_d16 v186, v186
v_fma_mix_f32 v157, v155, v155, v157 op_sel:[0,0,0] op_sel_hi:[1,1,0]
v_fma_mix_f32 v157, v155, v155, v157 op_sel:[1,1,0] op_sel_hi:[1,1,0]
v_lshrrev_b32 v187, 18, v187
v_fma_mix_f32 v156, v177, v177, v156 op_sel:[1,1,0] op_sel_hi:[1,1,0]
v_smfmac_f32_16x16x32_bf16 v[32:35], v[218:219], v[212:215], v246
v_fma_mix_f32 v157, v152, v152, v157 op_sel:[0,0,0] op_sel_hi:[1,1,0]
v_fma_mix_f32 v157, v152, v152, v157 op_sel:[1,1,0] op_sel_hi:[1,1,0]
v_fma_mix_f32 v157, v149, v149, v157 op_sel:[0,0,0] op_sel_hi:[1,1,0]
v_fma_mix_f32 v157, v149, v149, v157 op_sel:[1,1,0] op_sel_hi:[1,1,0]
s_setprio 1
v_smfmac_f32_16x16x32_bf16 v[0:3], v[220:221], v[192:195], v246
s_waitcnt lgkmcnt(4)
s_add_u32 s46, s80, 10485760
buffer_store_dwordx4 v[68:71], v241, s[32:35], s46 offen sc1
ds_read_b128 v[216:219], v248 offset:36864
ds_read_u16_d16_hi v187, v187
v_cvt_pkrtz_f16_f32 v137, v120, v121
v_cvt_pkrtz_f16_f32 v139, v122, v123
v_cvt_pkrtz_f16_f32 v141, v124, v125
v_cvt_pkrtz_f16_f32 v143, v126, v127
v_cvt_pk_f16_f32 v155, v128, v129
v_smfmac_f32_16x16x32_bf16 v[16:19], v[222:223], v[196:199], v246
v_cvt_pk_f16_f32 v152, v130, v131
v_cvt_pk_f16_f32 v149, v132, v133
v_cvt_pk_f16_f32 v146, v134, v135
v_pk_fma_f16 v154, v155, v155, s48
v_and_b32 v137, s49, v137
v_mfma_f32_32x32x16_bf16 v[120:135], v[72:75], v[224:227], 0
ds_read_b128 v[220:223], v248 offset:39936
v_fma_mix_f32 v157, v178, v178, v157 op_sel:[0,0,0] op_sel_hi:[1,1,0]
v_pk_fma_f16 v151, v152, v152, s48
v_pk_fma_f16 v148, v149, v149, s48
v_pk_fma_f16 v145, v146, v146, s48
v_pk_mul_f16 v154, v155, v154
v_lshrrev_b16 v136, 2, v137
v_pk_mul_f16 v151, v152, v151
v_fma_mix_f32 v157, v179, v179, v157 op_sel:[1,1,0] op_sel_hi:[1,1,0]
v_pk_mul_f16 v148, v149, v148
v_pk_mul_f16 v145, v146, v145
v_mfma_f32_32x32x16_bf16 v[120:135], v[76:79], v[228:231], v[120:135]
ds_read_b128 v[224:227], v245 offset:1536
ds_read_b128 v[200:203], v244 offset:128
v_xor_b32 v242, 16, v242
ds_read_b128 v[204:207], v242
ds_read_u16_d16 v136, v136
v_exp_f16 v153, v154
v_lshrrev_b32 v137, 18, v137
v_exp_f16 v150, v151
v_fma_mix_f32 v157, v180, v180, v157 op_sel:[0,0,0] op_sel_hi:[1,1,0]
v_exp_f16 v147, v148
v_and_b32 v139, s49, v139
v_exp_f16 v144, v145
s_waitcnt lgkmcnt(5)
v_mfma_f32_32x32x16_bf16 v[120:135], v[80:83], v[232:235], v[120:135]
ds_read_b128 v[228:231], v245 offset:1920
ds_read_b128 v[208:211], v242 offset:64
ds_read_b128 v[212:215], v242 offset:128
ds_read_u16_d16_hi v137, v137
v_exp_f16_sdwa v153, v154 dst_sel:WORD_1 dst_unused:UNUSED_PRESERVE src0_sel:WORD_1
v_fma_mix_f32 v157, v181, v181, v157 op_sel:[1,1,0] op_sel_hi:[1,1,0]
v_lshrrev_b16 v138, 2, v139
v_exp_f16_sdwa v150, v151 dst_sel:WORD_1 dst_unused:UNUSED_PRESERVE src0_sel:WORD_1
v_exp_f16_sdwa v147, v148 dst_sel:WORD_1 dst_unused:UNUSED_PRESERVE src0_sel:WORD_1
v_exp_f16_sdwa v144, v145 dst_sel:WORD_1 dst_unused:UNUSED_PRESERVE src0_sel:WORD_1
v_lshrrev_b32 v139, 18, v139
v_fma_mix_f32 v157, v182, v182, v157 op_sel:[0,0,0] op_sel_hi:[1,1,0]
v_mfma_f32_32x32x16_bf16 v[120:135], v[84:87], v[236:239], v[120:135]
ds_read_b128 v[232:235], v248 offset:40960
ds_read_u16_d16 v138, v138
ds_read_u16_d16_hi v139, v139
v_pk_add_f16 v153, v153, 1.0 op_sel_hi:[1,0]
v_pk_add_f16 v150, v150, 1.0 op_sel_hi:[1,0]
v_pk_add_f16 v147, v147, 1.0 op_sel_hi:[1,0]
v_and_b32 v141, s49, v141
v_pk_add_f16 v144, v144, 1.0 op_sel_hi:[1,0]
v_rcp_f16 v154, v153
v_fma_mix_f32 v157, v183, v183, v157 op_sel:[1,1,0] op_sel_hi:[1,1,0]
v_rcp_f16 v151, v150
v_mfma_f32_32x32x16_bf16 v[120:135], v[88:91], v[216:219], v[120:135]
ds_read_b128 v[236:239], v248 offset:44032
v_lshrrev_b16 v140, 2, v141
v_rcp_f16 v148, v147
v_fma_mix_f32 v157, v184, v184, v157 op_sel:[0,0,0] op_sel_hi:[1,1,0]
v_rcp_f16 v145, v144
v_lshrrev_b32 v141, 18, v141
v_rcp_f16_sdwa v154, v153 dst_sel:WORD_1 dst_unused:UNUSED_PRESERVE src0_sel:WORD_1
s_setprio 0
v_rcp_f16_sdwa v151, v150 dst_sel:WORD_1 dst_unused:UNUSED_PRESERVE src0_sel:WORD_1
s_waitcnt lgkmcnt(4)
v_mfma_f32_32x32x16_bf16 v[120:135], v[92:95], v[220:223], v[120:135]
ds_read_b128 v[216:219], v248 offset:41984
ds_read_u16_d16 v140, v140
ds_read_u16_d16_hi v141, v141
v_fma_mix_f32 v157, v185, v185, v157 op_sel:[1,1,0] op_sel_hi:[1,1,0]
v_and_b32 v143, s49, v143
v_rcp_f16_sdwa v148, v147 dst_sel:WORD_1 dst_unused:UNUSED_PRESERVE src0_sel:WORD_1
v_rcp_f16_sdwa v145, v144 dst_sel:WORD_1 dst_unused:UNUSED_PRESERVE src0_sel:WORD_1
v_pk_mul_f16 v155, v155, v154
v_lshrrev_b16 v142, 2, v143
v_fma_mix_f32 v157, v186, v186, v157 op_sel:[0,0,0] op_sel_hi:[1,1,0]
v_pk_mul_f16 v152, v152, v151
v_pk_mul_f16 v149, v149, v148
v_smfmac_f32_16x16x32_bf16 v[32:35], v[224:225], v[200:203], v246
ds_read_b128 v[220:223], v248 offset:45056
ds_read_u16_d16 v142, v142
v_pk_mul_f16 v146, v146, v145
v_fma_mix_f32 v158, v155, v155, v158 op_sel:[0,0,0] op_sel_hi:[1,1,0]
v_lshrrev_b32 v143, 18, v143
v_fma_mix_f32 v158, v155, v155, v158 op_sel:[1,1,0] op_sel_hi:[1,1,0]
v_fma_mix_f32 v158, v152, v152, v158 op_sel:[0,0,0] op_sel_hi:[1,1,0]
v_smfmac_f32_16x16x32_bf16 v[4:7], v[226:227], v[204:207], v246
v_fma_mix_f32 v157, v187, v187, v157 op_sel:[1,1,0] op_sel_hi:[1,1,0]
v_fma_mix_f32 v158, v152, v152, v158 op_sel:[1,1,0] op_sel_hi:[1,1,0]
v_fma_mix_f32 v158, v149, v149, v158 op_sel:[0,0,0] op_sel_hi:[1,1,0]
v_fma_mix_f32 v158, v149, v149, v158 op_sel:[1,1,0] op_sel_hi:[1,1,0]
v_fma_mix_f32 v158, v146, v146, v158 op_sel:[0,0,0] op_sel_hi:[1,1,0]
v_fma_mix_f32 v158, v146, v146, v158 op_sel:[1,1,0] op_sel_hi:[1,1,0]
s_setprio 2
v_smfmac_f32_16x16x32_bf16 v[20:23], v[228:229], v[208:211], v246
ds_read_b128 v[224:227], v248 offset:43008
ds_read_u16_d16_hi v143, v143
v_cvt_pkrtz_f16_f32 v179, v120, v121
v_cvt_pkrtz_f16_f32 v181, v122, v123
v_cvt_pkrtz_f16_f32 v183, v124, v125
v_cvt_pkrtz_f16_f32 v185, v126, v127
v_smfmac_f32_16x16x32_bf16 v[36:39], v[230:231], v[212:215], v246
v_cvt_pkrtz_f16_f32 v187, v128, v129
v_cvt_pk_f16_f32 v155, v130, v131
v_cvt_pk_f16_f32 v152, v132, v133
v_cvt_pk_f16_f32 v149, v134, v135
v_pk_fma_f16 v154, v155, v155, s48
s_waitcnt lgkmcnt(2)
v_mfma_f32_32x32x16_bf16 v[120:135], v[72:75], v[232:235], 0
ds_read_b128 v[228:231], v248 offset:46080
v_and_b32 v179, s49, v179
v_fma_mix_f32 v158, v136, v136, v158 op_sel:[0,0,0] op_sel_hi:[1,1,0]
v_pk_fma_f16 v151, v152, v152, s48
v_pk_fma_f16 v148, v149, v149, s48
v_lshrrev_b16 v178, 2, v179
v_pk_mul_f16 v154, v155, v154
v_pk_mul_f16 v151, v152, v151
v_pk_mul_f16 v148, v149, v148
v_lshrrev_b32 v179, 18, v179
v_mfma_f32_32x32x16_bf16 v[120:135], v[76:79], v[236:239], v[120:135]
ds_read_b128 v[232:235], v245 offset:2304
v_xor_b32 v243, 16, v243
ds_read_b128 v[192:195], v243
ds_read_b128 v[196:199], v243 offset:64
ds_read_u16_d16 v178, v178
ds_read_u16_d16_hi v179, v179
v_fma_mix_f32 v158, v137, v137, v158 op_sel:[1,1,0] op_sel_hi:[1,1,0]
v_exp_f16 v153, v154
v_and_b32 v181, s49, v181
v_exp_f16 v150, v151
v_exp_f16 v147, v148
v_lshrrev_b16 v180, 2, v181
v_mfma_f32_32x32x16_bf16 v[120:135], v[80:83], v[216:219], v[120:135]
ds_read_b128 v[236:239], v245 offset:2688
ds_read_b128 v[200:203], v243 offset:128
v_xor_b32 v244, 16, v244
ds_read_b128 v[204:207], v244
ds_read_u16_d16 v180, v180
v_fma_mix_f32 v158, v138, v138, v158 op_sel:[0,0,0] op_sel_hi:[1,1,0]
v_exp_f16_sdwa v153, v154 dst_sel:WORD_1 dst_unused:UNUSED_PRESERVE src0_sel:WORD_1
v_lshrrev_b32 v181, 18, v181
v_exp_f16_sdwa v150, v151 dst_sel:WORD_1 dst_unused:UNUSED_PRESERVE src0_sel:WORD_1
v_fma_mix_f32 v158, v139, v139, v158 op_sel:[1,1,0] op_sel_hi:[1,1,0]
v_and_b32 v183, s49, v183
v_mfma_f32_32x32x16_bf16 v[120:135], v[84:87], v[220:223], v[120:135]
ds_read_b128 v[216:219], v248 offset:47104
ds_read_u16_d16_hi v181, v181
v_exp_f16_sdwa v147, v148 dst_sel:WORD_1 dst_unused:UNUSED_PRESERVE src0_sel:WORD_1
v_pk_add_f16 v153, v153, 1.0 op_sel_hi:[1,0]
v_lshrrev_b16 v182, 2, v183
v_pk_add_f16 v150, v150, 1.0 op_sel_hi:[1,0]
v_pk_add_f16 v147, v147, 1.0 op_sel_hi:[1,0]
v_rcp_f16 v154, v153
v_lshrrev_b32 v183, 18, v183
v_fma_mix_f32 v158, v140, v140, v158 op_sel:[0,0,0] op_sel_hi:[1,1,0]
s_waitcnt lgkmcnt(6)
v_mfma_f32_32x32x16_bf16 v[120:135], v[88:91], v[224:227], v[120:135]
ds_read_b128 v[220:223], v248 offset:50176
ds_read_u16_d16 v182, v182
ds_read_u16_d16_hi v183, v183
v_rcp_f16 v151, v150
v_and_b32 v185, s49, v185
v_rcp_f16 v148, v147
v_fma_mix_f32 v158, v141, v141, v158 op_sel:[1,1,0] op_sel_hi:[1,1,0]
v_lshrrev_b16 v184, 2, v185
v_rcp_f16_sdwa v154, v153 dst_sel:WORD_1 dst_unused:UNUSED_PRESERVE src0_sel:WORD_1
v_mfma_f32_32x32x16_bf16 v[120:135], v[92:95], v[228:231], v[120:135]
ds_read_b128 v[224:227], v248 offset:48128
ds_read_u16_d16 v184, v184
v_rcp_f16_sdwa v151, v150 dst_sel:WORD_1 dst_unused:UNUSED_PRESERVE src0_sel:WORD_1
v_lshrrev_b32 v185, 18, v185
v_rcp_f16_sdwa v148, v147 dst_sel:WORD_1 dst_unused:UNUSED_PRESERVE src0_sel:WORD_1
v_and_b32 v187, s49, v187
v_fma_mix_f32 v158, v142, v142, v158 op_sel:[0,0,0] op_sel_hi:[1,1,0]
v_pk_mul_f16 v155, v155, v154
v_pk_mul_f16 v152, v152, v151
v_smfmac_f32_16x16x32_bf16 v[4:7], v[232:233], v[192:195], v246
ds_read_b128 v[228:231], v248 offset:51200
ds_read_u16_d16_hi v185, v185
v_lshrrev_b16 v186, 2, v187
v_pk_mul_f16 v149, v149, v148
v_fma_mix_f32 v159, v155, v155, v159 op_sel:[0,0,0] op_sel_hi:[1,1,0]
v_fma_mix_f32 v158, v143, v143, v158 op_sel:[1,1,0] op_sel_hi:[1,1,0]
v_lshrrev_b32 v187, 18, v187
v_smfmac_f32_16x16x32_bf16 v[20:23], v[234:235], v[196:199], v246
v_fma_mix_f32 v159, v155, v155, v159 op_sel:[1,1,0] op_sel_hi:[1,1,0]
v_fma_mix_f32 v159, v152, v152, v159 op_sel:[0,0,0] op_sel_hi:[1,1,0]
v_fma_mix_f32 v159, v152, v152, v159 op_sel:[1,1,0] op_sel_hi:[1,1,0]
v_fma_mix_f32 v159, v149, v149, v159 op_sel:[0,0,0] op_sel_hi:[1,1,0]
v_fma_mix_f32 v159, v149, v149, v159 op_sel:[1,1,0] op_sel_hi:[1,1,0]
s_setprio 1
s_waitcnt lgkmcnt(4)
v_smfmac_f32_16x16x32_bf16 v[36:39], v[236:237], v[200:203], v246
ds_read_b128 v[232:235], v248 offset:49152
ds_read_u16_d16 v186, v186
ds_read_u16_d16_hi v187, v187
v_cvt_pkrtz_f16_f32 v137, v120, v121
v_cvt_pkrtz_f16_f32 v139, v122, v123
v_cvt_pkrtz_f16_f32 v141, v124, v125
v_cvt_pkrtz_f16_f32 v143, v126, v127
v_cvt_pk_f16_f32 v155, v128, v129
v_smfmac_f32_16x16x32_bf16 v[4:7], v[238:239], v[204:207], v246
v_cvt_pk_f16_f32 v152, v130, v131
v_cvt_pk_f16_f32 v149, v132, v133
v_cvt_pk_f16_f32 v146, v134, v135
v_pk_fma_f16 v154, v155, v155, s48
v_and_b32 v137, s49, v137
v_mfma_f32_32x32x16_bf16 v[120:135], v[72:75], v[216:219], 0
ds_read_b128 v[236:239], v248 offset:52224
v_fma_mix_f32 v159, v178, v178, v159 op_sel:[0,0,0] op_sel_hi:[1,1,0]
v_pk_fma_f16 v151, v152, v152, s48
v_pk_fma_f16 v148, v149, v149, s48
v_pk_fma_f16 v145, v146, v146, s48
v_pk_mul_f16 v154, v155, v154
v_lshrrev_b16 v136, 2, v137
v_pk_mul_f16 v151, v152, v151
v_fma_mix_f32 v159, v179, v179, v159 op_sel:[1,1,0] op_sel_hi:[1,1,0]
v_pk_mul_f16 v148, v149, v148
v_pk_mul_f16 v145, v146, v145
v_mfma_f32_32x32x16_bf16 v[120:135], v[76:79], v[220:223], v[120:135]
ds_read_b128 v[216:219], v245 offset:3072
ds_read_b128 v[208:211], v244 offset:64
ds_read_b128 v[212:215], v244 offset:128
ds_read_u16_d16 v136, v136
v_exp_f16 v153, v154
v_lshrrev_b32 v137, 18, v137
v_exp_f16 v150, v151
v_fma_mix_f32 v159, v180, v180, v159 op_sel:[0,0,0] op_sel_hi:[1,1,0]
v_exp_f16 v147, v148
v_and_b32 v139, s49, v139
v_exp_f16 v144, v145
s_waitcnt lgkmcnt(5)
v_mfma_f32_32x32x16_bf16 v[120:135], v[80:83], v[224:227], v[120:135]
ds_read_b128 v[220:223], v245 offset:3456
v_xor_b32 v242, 32, v242
ds_read_b128 v[192:195], v242
ds_read_b128 v[196:199], v242 offset:64
ds_read_u16_d16_hi v137, v137
v_exp_f16_sdwa v153, v154 dst_sel:WORD_1 dst_unused:UNUSED_PRESERVE src0_sel:WORD_1
v_fma_mix_f32 v159, v181, v181, v159 op_sel:[1,1,0] op_sel_hi:[1,1,0]
v_lshrrev_b16 v138, 2, v139
v_exp_f16_sdwa v150, v151 dst_sel:WORD_1 dst_unused:UNUSED_PRESERVE src0_sel:WORD_1
v_exp_f16_sdwa v147, v148 dst_sel:WORD_1 dst_unused:UNUSED_PRESERVE src0_sel:WORD_1
v_exp_f16_sdwa v144, v145 dst_sel:WORD_1 dst_unused:UNUSED_PRESERVE src0_sel:WORD_1
v_lshrrev_b32 v139, 18, v139
v_fma_mix_f32 v159, v182, v182, v159 op_sel:[0,0,0] op_sel_hi:[1,1,0]
v_mfma_f32_32x32x16_bf16 v[120:135], v[84:87], v[228:231], v[120:135]
ds_read_b128 v[224:227], v248 offset:53248
ds_read_u16_d16 v138, v138
ds_read_u16_d16_hi v139, v139
v_pk_add_f16 v153, v153, 1.0 op_sel_hi:[1,0]
v_pk_add_f16 v150, v150, 1.0 op_sel_hi:[1,0]
v_pk_add_f16 v147, v147, 1.0 op_sel_hi:[1,0]
v_and_b32 v141, s49, v141
v_pk_add_f16 v144, v144, 1.0 op_sel_hi:[1,0]
v_rcp_f16 v154, v153
v_fma_mix_f32 v159, v183, v183, v159 op_sel:[1,1,0] op_sel_hi:[1,1,0]
v_rcp_f16 v151, v150
v_mfma_f32_32x32x16_bf16 v[120:135], v[88:91], v[232:235], v[120:135]
ds_read_b128 v[228:231], v248 offset:56320
v_lshrrev_b16 v140, 2, v141
v_rcp_f16 v148, v147
v_fma_mix_f32 v159, v184, v184, v159 op_sel:[0,0,0] op_sel_hi:[1,1,0]
v_rcp_f16 v145, v144
v_lshrrev_b32 v141, 18, v141
v_rcp_f16_sdwa v154, v153 dst_sel:WORD_1 dst_unused:UNUSED_PRESERVE src0_sel:WORD_1
s_setprio 0
v_rcp_f16_sdwa v151, v150 dst_sel:WORD_1 dst_unused:UNUSED_PRESERVE src0_sel:WORD_1
s_waitcnt lgkmcnt(4)
v_mfma_f32_32x32x16_bf16 v[120:135], v[92:95], v[236:239], v[120:135]
ds_read_b128 v[232:235], v248 offset:54272
ds_read_u16_d16 v140, v140
ds_read_u16_d16_hi v141, v141
v_fma_mix_f32 v159, v185, v185, v159 op_sel:[1,1,0] op_sel_hi:[1,1,0]
v_and_b32 v143, s49, v143
v_rcp_f16_sdwa v148, v147 dst_sel:WORD_1 dst_unused:UNUSED_PRESERVE src0_sel:WORD_1
v_rcp_f16_sdwa v145, v144 dst_sel:WORD_1 dst_unused:UNUSED_PRESERVE src0_sel:WORD_1
v_pk_mul_f16 v155, v155, v154
v_lshrrev_b16 v142, 2, v143
v_fma_mix_f32 v159, v186, v186, v159 op_sel:[0,0,0] op_sel_hi:[1,1,0]
v_pk_mul_f16 v152, v152, v151
v_pk_mul_f16 v149, v149, v148
v_smfmac_f32_16x16x32_bf16 v[20:23], v[216:217], v[208:211], v246
ds_read_b128 v[236:239], v248 offset:57344
ds_read_u16_d16 v142, v142
v_pk_mul_f16 v146, v146, v145
v_fma_mix_f32 v160, v155, v155, v160 op_sel:[0,0,0] op_sel_hi:[1,1,0]
v_lshrrev_b32 v143, 18, v143
v_fma_mix_f32 v160, v155, v155, v160 op_sel:[1,1,0] op_sel_hi:[1,1,0]
v_fma_mix_f32 v160, v152, v152, v160 op_sel:[0,0,0] op_sel_hi:[1,1,0]
v_smfmac_f32_16x16x32_bf16 v[36:39], v[218:219], v[212:215], v246
v_fma_mix_f32 v159, v187, v187, v159 op_sel:[1,1,0] op_sel_hi:[1,1,0]
v_fma_mix_f32 v160, v152, v152, v160 op_sel:[1,1,0] op_sel_hi:[1,1,0]
v_fma_mix_f32 v160, v149, v149, v160 op_sel:[0,0,0] op_sel_hi:[1,1,0]
v_fma_mix_f32 v160, v149, v149, v160 op_sel:[1,1,0] op_sel_hi:[1,1,0]
v_fma_mix_f32 v160, v146, v146, v160 op_sel:[0,0,0] op_sel_hi:[1,1,0]
v_fma_mix_f32 v160, v146, v146, v160 op_sel:[1,1,0] op_sel_hi:[1,1,0]
s_cmp_lg_u32 s40, 7
s_cbranch_scc1 Lnobias2
s_sub_u32 s43, s2, 96
s_cmp_lt_u32 s43, 96
s_cbranch_scc0 Lnobias2
s_waitcnt vmcnt(13)
v_lshlrev_b32 v102, 16, v102
v_lshlrev_b32 v103, 16, v103
v_lshlrev_b32 v104, 16, v104
v_lshlrev_b32 v105, 16, v105
v_lshlrev_b32 v106, 16, v106
v_lshlrev_b32 v107, 16, v107
v_lshlrev_b32 v108, 16, v108
v_lshlrev_b32 v109, 16, v109
v_lshlrev_b32 v110, 16, v110
v_lshlrev_b32 v111, 16, v111
v_lshlrev_b32 v112, 16, v112
v_lshlrev_b32 v113, 16, v113
v_mul_f32 v100, v102, v108
v_fmac_f32 v100, v103, v109
v_fmac_f32 v100, v104, v110
v_fmac_f32 v100, v105, v111
v_fmac_f32 v100, v106, v112
v_fmac_f32 v100, v107, v113
s_nop 1
v_add_f32_dpp v100, v100, v100 row_ror:8 row_mask:0xf bank_mask:0xf
s_nop 1
v_add_f32_dpp v100, v100, v100 row_ror:4 row_mask:0xf bank_mask:0xf
s_nop 1
v_add_f32_dpp v100, v100, v100 row_ror:2 row_mask:0xf bank_mask:0xf
s_nop 1
v_add_f32_dpp v100, v100, v100 row_ror:1 row_mask:0xf bank_mask:0xf
v_mov_b32 v101, v100
s_nop 1
v_permlane16_swap_b32 v100, v101
v_add_f32 v100, v100, v101
v_mov_b32 v101, v100
s_nop 1
v_permlane32_swap_b32 v100, v101
v_add_f32 v100, v100, v101
s_lshl_b32 s44, s43, 2
s_add_u32 s44, s44, 394752
v_lshlrev_b32 v115, 11, v251
s_mov_b64 exec, 0xff
buffer_store_dword v100, v115, s[32:35], s44 offen sc1
s_mov_b64 exec, -1
Lnobias2:
s_setprio 2
v_smfmac_f32_16x16x32_bf16 v[12:15], v[220:221], v[192:195], v246
ds_read_b128 v[216:219], v248 offset:55296
ds_read_u16_d16_hi v143, v143
v_cvt_pkrtz_f16_f32 v179, v120, v121
v_cvt_pkrtz_f16_f32 v181, v122, v123
v_cvt_pkrtz_f16_f32 v183, v124, v125
v_cvt_pkrtz_f16_f32 v185, v126, v127
v_smfmac_f32_16x16x32_bf16 v[28:31], v[222:223], v[196:199], v246
v_cvt_pkrtz_f16_f32 v187, v128, v129
v_cvt_pk_f16_f32 v155, v130, v131
v_cvt_pk_f16_f32 v152, v132, v133
v_cvt_pk_f16_f32 v149, v134, v135
s_waitcnt lgkmcnt(2)
v_mfma_f32_32x32x16_bf16 v[120:135], v[72:75], v[224:227], 0
ds_read_b128 v[220:223], v245 offset:3840
ds_read_b128 v[200:203], v242 offset:128
v_xor_b32 v243, 32, v243
ds_read_b128 v[204:207], v243
v_pk_fma_f16 v154, v155, v155, s48
v_and_b32 v179, s49, v179
v_fma_mix_f32 v160, v136, v136, v160 op_sel:[0,0,0] op_sel_hi:[1,1,0]
v_pk_fma_f16 v151, v152, v152, s48
v_pk_fma_f16 v148, v149, v149, s48
v_lshrrev_b16 v178, 2, v179
v_pk_mul_f16 v154, v155, v154
v_pk_mul_f16 v151, v152, v151
v_mfma_f32_32x32x16_bf16 v[120:135], v[76:79], v[228:231], v[120:135]
ds_read_b128 v[224:227], v248 offset:58368
ds_read_u16_d16 v178, v178
v_pk_mul_f16 v148, v149, v148
v_lshrrev_b32 v179, 18, v179
v_fma_mix_f32 v160, v137, v137, v160 op_sel:[1,1,0] op_sel_hi:[1,1,0]
v_exp_f16 v153, v154
v_and_b32 v181, s49, v181
v_exp_f16 v150, v151
v_mfma_f32_32x32x16_bf16 v[120:135], v[80:83], v[232:235], v[120:135]
ds_read_b128 v[228:231], v245 offset:4224
ds_read_b128 v[208:211], v243 offset:64
ds_read_b128 v[212:215], v243 offset:128
ds_read_u16_d16_hi v179, v179
v_exp_f16 v147, v148
v_lshrrev_b16 v180, 2, v181
v_fma_mix_f32 v160, v138, v138, v160 op_sel:[0,0,0] op_sel_hi:[1,1,0]
v_exp_f16_sdwa v153, v154 dst_sel:WORD_1 dst_unused:UNUSED_PRESERVE src0_sel:WORD_1
v_lshrrev_b32 v181, 18, v181
v_mfma_f32_32x32x16_bf16 v[120:135], v[84:87], v[236:239], v[120:135]
ds_read_b128 v[232:235], v245 offset:4608
v_xor_b32 v244, 32, v244
ds_read_b128 v[192:195], v244
ds_read_b128 v[196:199], v244 offset:64
ds_read_u16_d16 v180, v180
ds_read_u16_d16_hi v181, v181
v_exp_f16_sdwa v150, v151 dst_sel:WORD_1 dst_unused:UNUSED_PRESERVE src0_sel:WORD_1
v_fma_mix_f32 v160, v139, v139, v160 op_sel:[1,1,0] op_sel_hi:[1,1,0]
v_and_b32 v183, s49, v183
v_exp_f16_sdwa v147, v148 dst_sel:WORD_1 dst_unused:UNUSED_PRESERVE src0_sel:WORD_1
v_pk_add_f16 v153, v153, 1.0 op_sel_hi:[1,0]
v_lshrrev_b16 v182, 2, v183
v_pk_add_f16 v150, v150, 1.0 op_sel_hi:[1,0]
s_waitcnt lgkmcnt(9)
v_mfma_f32_32x32x16_bf16 v[120:135], v[88:91], v[216:219], v[120:135]
ds_read_b128 v[236:239], v248 offset:59392
ds_read_u16_d16 v182, v182
v_pk_add_f16 v147, v147, 1.0 op_sel_hi:[1,0]
v_rcp_f16 v154, v153
v_lshrrev_b32 v183, 18, v183
v_fma_mix_f32 v160, v140, v140, v160 op_sel:[0,0,0] op_sel_hi:[1,1,0]
v_rcp_f16 v151, v150
v_and_b32 v185, s49, v185
v_smfmac_f32_16x16x32_bf16 v[44:47], v[220:221], v[200:203], v246
ds_read_b128 v[216:219], v248 offset:62464
ds_read_u16_d16_hi v183, v183
v_rcp_f16 v148, v147
v_fma_mix_f32 v160, v141, v141, v160 op_sel:[1,1,0] op_sel_hi:[1,1,0]
v_lshrrev_b16 v184, 2, v185
v_smfmac_f32_16x16x32_bf16 v[12:15], v[222:223], v[204:207], v246
v_rcp_f16_sdwa v154, v153 dst_sel:WORD_1 dst_unused:UNUSED_PRESERVE src0_sel:WORD_1
v_rcp_f16_sdwa v151, v150 dst_sel:WORD_1 dst_unused:UNUSED_PRESERVE src0_sel:WORD_1
v_mfma_f32_32x32x16_bf16 v[120:135], v[92:95], v[224:227], v[120:135]
ds_read_b128 v[220:223], v248 offset:60416
ds_read_u16_d16 v184, v184
v_lshrrev_b32 v185, 18, v185
v_rcp_f16_sdwa v148, v147 dst_sel:WORD_1 dst_unused:UNUSED_PRESERVE src0_sel:WORD_1
v_and_b32 v187, s49, v187
v_fma_mix_f32 v160, v142, v142, v160 op_sel:[0,0,0] op_sel_hi:[1,1,0]
v_pk_mul_f16 v155, v155, v154
v_pk_mul_f16 v152, v152, v151
v_lshrrev_b16 v186, 2, v187
s_waitcnt lgkmcnt(4)
v_smfmac_f32_16x16x32_bf16 v[28:31], v[228:229], v[208:211], v246
ds_read_b128 v[224:227], v248 offset:63488
ds_read_u16_d16_hi v185, v185
ds_read_u16_d16 v186, v186
v_pk_mul_f16 v149, v149, v148
v_fma_mix_f32 v161, v155, v155, v161 op_sel:[0,0,0] op_sel_hi:[1,1,0]
v_fma_mix_f32 v160, v143, v143, v160 op_sel:[1,1,0] op_sel_hi:[1,1,0]
v_lshrrev_b32 v187, 18, v187
v_smfmac_f32_16x16x32_bf16 v[44:47], v[230:231], v[212:215], v246
v_fma_mix_f32 v161, v155, v155, v161 op_sel:[1,1,0] op_sel_hi:[1,1,0]
v_fma_mix_f32 v161, v152, v152, v161 op_sel:[0,0,0] op_sel_hi:[1,1,0]
v_fma_mix_f32 v161, v152, v152, v161 op_sel:[1,1,0] op_sel_hi:[1,1,0]
v_fma_mix_f32 v161, v149, v149, v161 op_sel:[0,0,0] op_sel_hi:[1,1,0]
v_fma_mix_f32 v161, v149, v149, v161 op_sel:[1,1,0] op_sel_hi:[1,1,0]
v_lshlrev_b32 v252, 7, v251
s_add_u32 s46, s47, 2359296
s_mov_b32 exec_lo, 131071
s_mov_b32 exec_hi, 0
s_mov_b32 m0, 16288
s_nop 0
buffer_load_dword v252, s[4:7], s46 offen lds
s_mov_b64 exec, -1
s_setprio 1
v_smfmac_f32_16x16x32_bf16 v[12:15], v[232:233], v[192:195], v246
ds_read_b128 v[228:231], v248 offset:61440
ds_read_u16_d16_hi v187, v187
v_cvt_pkrtz_f16_f32 v137, v120, v121
v_cvt_pkrtz_f16_f32 v139, v122, v123
v_cvt_pkrtz_f16_f32 v141, v124, v125
v_cvt_pkrtz_f16_f32 v143, v126, v127
v_cvt_pk_f16_f32 v155, v128, v129
v_smfmac_f32_16x16x32_bf16 v[28:31], v[234:235], v[196:199], v246
v_cvt_pk_f16_f32 v152, v130, v131
v_cvt_pk_f16_f32 v149, v132, v133
v_cvt_pk_f16_f32 v146, v134, v135
v_pk_fma_f16 v154, v155, v155, s48
v_and_b32 v137, s49, v137
v_mfma_f32_32x32x16_bf16 v[120:135], v[72:75], v[236:239], 0
ds_read_b128 v[232:235], v248 offset:64512
v_fma_mix_f32 v161, v178, v178, v161 op_sel:[0,0,0] op_sel_hi:[1,1,0]
v_pk_fma_f16 v151, v152, v152, s48
v_pk_fma_f16 v148, v149, v149, s48
v_pk_fma_f16 v145, v146, v146, s48
v_pk_mul_f16 v154, v155, v154
v_lshrrev_b16 v136, 2, v137
v_pk_mul_f16 v151, v152, v151
v_fma_mix_f32 v161, v179, v179, v161 op_sel:[1,1,0] op_sel_hi:[1,1,0]
v_pk_mul_f16 v148, v149, v148
v_pk_mul_f16 v145, v146, v145
s_waitcnt lgkmcnt(2)
v_mfma_f32_32x32x16_bf16 v[120:135], v[76:79], v[216:219], v[120:135]
ds_read_b128 v[236:239], v245 offset:4992
ds_read_b128 v[200:203], v244 offset:128
v_xor_b32 v242, 16, v242
ds_read_b128 v[204:207], v242
ds_read_u16_d16 v136, v136
v_exp_f16 v153, v154
v_lshrrev_b32 v137, 18, v137
v_exp_f16 v150, v151
v_fma_mix_f32 v161, v180, v180, v161 op_sel:[0,0,0] op_sel_hi:[1,1,0]
v_exp_f16 v147, v148
v_and_b32 v139, s49, v139
v_exp_f16 v144, v145
v_mfma_f32_32x32x16_bf16 v[120:135], v[80:83], v[220:223], v[120:135]
ds_read_b128 v[216:219], v245 offset:5376
ds_read_b128 v[208:211], v242 offset:64
ds_read_b128 v[212:215], v242 offset:128
ds_read_u16_d16_hi v137, v137
v_exp_f16_sdwa v153, v154 dst_sel:WORD_1 dst_unused:UNUSED_PRESERVE src0_sel:WORD_1
v_fma_mix_f32 v161, v181, v181, v161 op_sel:[1,1,0] op_sel_hi:[1,1,0]
v_lshrrev_b16 v138, 2, v139
v_exp_f16_sdwa v150, v151 dst_sel:WORD_1 dst_unused:UNUSED_PRESERVE src0_sel:WORD_1
v_exp_f16_sdwa v147, v148 dst_sel:WORD_1 dst_unused:UNUSED_PRESERVE src0_sel:WORD_1
v_exp_f16_sdwa v144, v145 dst_sel:WORD_1 dst_unused:UNUSED_PRESERVE src0_sel:WORD_1
v_lshrrev_b32 v139, 18, v139
v_fma_mix_f32 v161, v182, v182, v161 op_sel:[0,0,0] op_sel_hi:[1,1,0]
v_mfma_f32_32x32x16_bf16 v[120:135], v[84:87], v[224:227], v[120:135]
ds_read_b128 v[220:223], v249
ds_read_u16_d16 v138, v138
ds_read_u16_d16_hi v139, v139
v_pk_add_f16 v153, v153, 1.0 op_sel_hi:[1,0]
v_pk_add_f16 v150, v150, 1.0 op_sel_hi:[1,0]
v_pk_add_f16 v147, v147, 1.0 op_sel_hi:[1,0]
v_and_b32 v141, s49, v141
v_pk_add_f16 v144, v144, 1.0 op_sel_hi:[1,0]
v_rcp_f16 v154, v153
v_fma_mix_f32 v161, v183, v183, v161 op_sel:[1,1,0] op_sel_hi:[1,1,0]
v_rcp_f16 v151, v150
v_mfma_f32_32x32x16_bf16 v[120:135], v[88:91], v[228:231], v[120:135]
ds_read_b128 v[224:227], v249 offset:3072
v_lshrrev_b16 v140, 2, v141
v_rcp_f16 v148, v147
v_fma_mix_f32 v161, v184, v184, v161 op_sel:[0,0,0] op_sel_hi:[1,1,0]
v_rcp_f16 v145, v144
v_lshrrev_b32 v141, 18, v141
v_rcp_f16_sdwa v154, v153 dst_sel:WORD_1 dst_unused:UNUSED_PRESERVE src0_sel:WORD_1
s_setprio 0
v_rcp_f16_sdwa v151, v150 dst_sel:WORD_1 dst_unused:UNUSED_PRESERVE src0_sel:WORD_1
s_waitcnt lgkmcnt(4)
v_mfma_f32_32x32x16_bf16 v[120:135], v[92:95], v[232:235], v[120:135]
ds_read_b128 v[228:231], v249 offset:1024
ds_read_u16_d16 v140, v140
ds_read_u16_d16_hi v141, v141
v_fma_mix_f32 v161, v185, v185, v161 op_sel:[1,1,0] op_sel_hi:[1,1,0]
v_and_b32 v143, s49, v143
v_rcp_f16_sdwa v148, v147 dst_sel:WORD_1 dst_unused:UNUSED_PRESERVE src0_sel:WORD_1
v_rcp_f16_sdwa v145, v144 dst_sel:WORD_1 dst_unused:UNUSED_PRESERVE src0_sel:WORD_1
v_pk_mul_f16 v155, v155, v154
v_lshrrev_b16 v142, 2, v143
v_fma_mix_f32 v161, v186, v186, v161 op_sel:[0,0,0] op_sel_hi:[1,1,0]
v_pk_mul_f16 v152, v152, v151
v_pk_mul_f16 v149, v149, v148
v_smfmac_f32_16x16x32_bf16 v[44:47], v[236:237], v[200:203], v246
ds_read_b128 v[232:235], v249 offset:4096
ds_read_u16_d16 v142, v142
v_pk_mul_f16 v146, v146, v145
v_fma_mix_f32 v162, v155, v155, v162 op_sel:[0,0,0] op_sel_hi:[1,1,0]
v_lshrrev_b32 v143, 18, v143
v_fma_mix_f32 v162, v155, v155, v162 op_sel:[1,1,0] op_sel_hi:[1,1,0]
v_fma_mix_f32 v162, v152, v152, v162 op_sel:[0,0,0] op_sel_hi:[1,1,0]
v_smfmac_f32_16x16x32_bf16 v[8:11], v[238:239], v[204:207], v246
v_fma_mix_f32 v161, v187, v187, v161 op_sel:[1,1,0] op_sel_hi:[1,1,0]
v_fma_mix_f32 v162, v152, v152, v162 op_sel:[1,1,0] op_sel_hi:[1,1,0]
v_fma_mix_f32 v162, v149, v149, v162 op_sel:[0,0,0] op_sel_hi:[1,1,0]
v_fma_mix_f32 v162, v149, v149, v162 op_sel:[1,1,0] op_sel_hi:[1,1,0]
v_fma_mix_f32 v162, v146, v146, v162 op_sel:[0,0,0] op_sel_hi:[1,1,0]
v_fma_mix_f32 v162, v146, v146, v162 op_sel:[1,1,0] op_sel_hi:[1,1,0]
v_lshlrev_b32 v252, 7, v251
s_add_u32 s46, s47, 2359296
s_mov_b32 exec_lo, 4294836224
s_mov_b32 exec_hi, 3
s_mov_b32 m0, 16220
s_nop 0
buffer_load_dword v252, s[4:7], s46 offen lds
s_mov_b64 exec, -1
s_setprio 2
v_smfmac_f32_16x16x32_bf16 v[24:27], v[216:217], v[208:211], v246
ds_read_b128 v[236:239], v249 offset:2048
ds_read_u16_d16_hi v143, v143
v_cvt_pkrtz_f16_f32 v179, v120, v121
v_cvt_pkrtz_f16_f32 v181, v122, v123
v_cvt_pkrtz_f16_f32 v183, v124, v125
v_cvt_pkrtz_f16_f32 v185, v126, v127
v_smfmac_f32_16x16x32_bf16 v[40:43], v[218:219], v[212:215], v246
v_cvt_pkrtz_f16_f32 v187, v128, v129
v_cvt_pk_f16_f32 v155, v130, v131
v_cvt_pk_f16_f32 v152, v132, v133
v_cvt_pk_f16_f32 v149, v134, v135
v_pk_fma_f16 v154, v155, v155, s48
s_waitcnt lgkmcnt(2)
v_mfma_f32_32x32x16_bf16 v[120:135], v[72:75], v[220:223], 0
ds_read_b128 v[216:219], v249 offset:5120
v_and_b32 v179, s49, v179
v_fma_mix_f32 v162, v136, v136, v162 op_sel:[0,0,0] op_sel_hi:[1,1,0]
v_pk_fma_f16 v151, v152, v152, s48
v_pk_fma_f16 v148, v149, v149, s48
v_lshrrev_b16 v178, 2, v179
v_pk_mul_f16 v154, v155, v154
v_pk_mul_f16 v151, v152, v151
v_pk_mul_f16 v148, v149, v148
v_lshrrev_b32 v179, 18, v179
v_mfma_f32_32x32x16_bf16 v[120:135], v[76:79], v[224:227], v[120:135]
ds_read_b128 v[220:223], v245 offset:5760
v_xor_b32 v243, 16, v243
ds_read_b128 v[192:195], v243
ds_read_b128 v[196:199], v243 offset:64
ds_read_u16_d16 v178, v178
ds_read_u16_d16_hi v179, v179
v_fma_mix_f32 v162, v137, v137, v162 op_sel:[1,1,0] op_sel_hi:[1,1,0]
v_exp_f16 v153, v154
v_and_b32 v181, s49, v181
v_exp_f16 v150, v151
v_exp_f16 v147, v148
v_lshrrev_b16 v180, 2, v181
v_mfma_f32_32x32x16_bf16 v[120:135], v[80:83], v[228:231], v[120:135]
ds_read_b128 v[224:227], v245 offset:6144
ds_read_b128 v[200:203], v243 offset:128
v_xor_b32 v244, 16, v244
ds_read_b128 v[204:207], v244
ds_read_u16_d16 v180, v180
v_fma_mix_f32 v162, v138, v138, v162 op_sel:[0,0,0] op_sel_hi:[1,1,0]
v_exp_f16_sdwa v153, v154 dst_sel:WORD_1 dst_unused:UNUSED_PRESERVE src0_sel:WORD_1
v_lshrrev_b32 v181, 18, v181
v_exp_f16_sdwa v150, v151 dst_sel:WORD_1 dst_unused:UNUSED_PRESERVE src0_sel:WORD_1
v_fma_mix_f32 v162, v139, v139, v162 op_sel:[1,1,0] op_sel_hi:[1,1,0]
v_and_b32 v183, s49, v183
v_mfma_f32_32x32x16_bf16 v[120:135], v[84:87], v[232:235], v[120:135]
ds_read_b128 v[228:231], v249 offset:6144
ds_read_u16_d16_hi v181, v181
v_exp_f16_sdwa v147, v148 dst_sel:WORD_1 dst_unused:UNUSED_PRESERVE src0_sel:WORD_1
v_pk_add_f16 v153, v153, 1.0 op_sel_hi:[1,0]
v_lshrrev_b16 v182, 2, v183
v_pk_add_f16 v150, v150, 1.0 op_sel_hi:[1,0]
v_pk_add_f16 v147, v147, 1.0 op_sel_hi:[1,0]
v_rcp_f16 v154, v153
v_lshrrev_b32 v183, 18, v183
v_fma_mix_f32 v162, v140, v140, v162 op_sel:[0,0,0] op_sel_hi:[1,1,0]
s_waitcnt lgkmcnt(6)
v_mfma_f32_32x32x16_bf16 v[120:135], v[88:91], v[236:239], v[120:135]
ds_read_b128 v[232:235], v249 offset:9216
ds_read_u16_d16 v182, v182
ds_read_u16_d16_hi v183, v183
v_rcp_f16 v151, v150
v_and_b32 v185, s49, v185
v_rcp_f16 v148, v147
v_fma_mix_f32 v162, v141, v141, v162 op_sel:[1,1,0] op_sel_hi:[1,1,0]
v_lshrrev_b16 v184, 2, v185
v_rcp_f16_sdwa v154, v153 dst_sel:WORD_1 dst_unused:UNUSED_PRESERVE src0_sel:WORD_1
v_mfma_f32_32x32x16_bf16 v[120:135], v[92:95], v[216:219], v[120:135]
ds_read_b128 v[236:239], v249 offset:7168
ds_read_u16_d16 v184, v184
v_rcp_f16_sdwa v151, v150 dst_sel:WORD_1 dst_unused:UNUSED_PRESERVE src0_sel:WORD_1
v_lshrrev_b32 v185, 18, v185
v_rcp_f16_sdwa v148, v147 dst_sel:WORD_1 dst_unused:UNUSED_PRESERVE src0_sel:WORD_1
v_and_b32 v187, s49, v187
v_fma_mix_f32 v162, v142, v142, v162 op_sel:[0,0,0] op_sel_hi:[1,1,0]
v_pk_mul_f16 v155, v155, v154
v_pk_mul_f16 v152, v152, v151
v_smfmac_f32_16x16x32_bf16 v[8:11], v[220:221], v[192:195], v246
ds_read_b128 v[216:219], v249 offset:10240
ds_read_u16_d16_hi v185, v185
v_lshrrev_b16 v186, 2, v187
v_pk_mul_f16 v149, v149, v148
v_fma_mix_f32 v163, v155, v155, v163 op_sel:[0,0,0] op_sel_hi:[1,1,0]
v_fma_mix_f32 v162, v143, v143, v162 op_sel:[1,1,0] op_sel_hi:[1,1,0]
v_lshrrev_b32 v187, 18, v187
v_smfmac_f32_16x16x32_bf16 v[24:27], v[222:223], v[196:199], v246
v_fma_mix_f32 v163, v155, v155, v163 op_sel:[1,1,0] op_sel_hi:[1,1,0]
v_fma_mix_f32 v163, v152, v152, v163 op_sel:[0,0,0] op_sel_hi:[1,1,0]
v_fma_mix_f32 v163, v152, v152, v163 op_sel:[1,1,0] op_sel_hi:[1,1,0]
v_fma_mix_f32 v163, v149, v149, v163 op_sel:[0,0,0] op_sel_hi:[1,1,0]
v_fma_mix_f32 v163, v149, v149, v163 op_sel:[1,1,0] op_sel_hi:[1,1,0]
v_lshlrev_b32 v252, 7, v251
s_add_u32 s46, s47, 2359296
s_mov_b32 exec_lo, 0
s_mov_b32 exec_hi, 1048572
s_mov_b32 m0, 16152
s_nop 0
buffer_load_dword v252, s[4:7], s46 offen lds
s_mov_b64 exec, -1
s_setprio 1
s_waitcnt lgkmcnt(2)
v_smfmac_f32_16x16x32_bf16 v[40:43], v[224:225], v[200:203], v246
ds_read_b128 v[220:223], v249 offset:8192
ds_read_u16_d16 v186, v186
ds_read_u16_d16_hi v187, v187
v_cvt_pkrtz_f16_f32 v137, v120, v121
v_cvt_pkrtz_f16_f32 v139, v122, v123
v_cvt_pkrtz_f16_f32 v141, v124, v125
v_cvt_pkrtz_f16_f32 v143, v126, v127
v_smfmac_f32_16x16x32_bf16 v[8:11], v[226:227], v[204:207], v246
v_cvt_pk_f16_f32 v155, v128, v129
v_cvt_pk_f16_f32 v152, v130, v131
v_cvt_pk_f16_f32 v149, v132, v133
v_cvt_pk_f16_f32 v146, v134, v135
v_pk_fma_f16 v154, v155, v155, s48
v_mfma_f32_32x32x16_bf16 v[120:135], v[72:75], v[228:231], 0
ds_read_b128 v[224:227], v249 offset:11264
v_and_b32 v137, s49, v137
v_fma_mix_f32 v163, v178, v178, v163 op_sel:[0,0,0] op_sel_hi:[1,1,0]
v_pk_fma_f16 v151, v152, v152, s48
v_pk_fma_f16 v148, v149, v149, s48
v_pk_fma_f16 v145, v146, v146, s48
v_pk_mul_f16 v154, v155, v154
v_lshrrev_b16 v136, 2, v137
v_pk_mul_f16 v151, v152, v151
v_fma_mix_f32 v163, v179, v179, v163 op_sel:[1,1,0] op_sel_hi:[1,1,0]
v_pk_mul_f16 v148, v149, v148
v_mfma_f32_32x32x16_bf16 v[120:135], v[76:79], v[232:235], v[120:135]
ds_read_b128 v[228:231], v245 offset:6528
ds_read_b128 v[208:211], v244 offset:64
ds_read_b128 v[212:215], v244 offset:128
ds_read_u16_d16 v136, v136
v_pk_mul_f16 v145, v146, v145
v_exp_f16 v153, v154
v_lshrrev_b32 v137, 18, v137
v_exp_f16 v150, v151
v_fma_mix_f32 v163, v180, v180, v163 op_sel:[0,0,0] op_sel_hi:[1,1,0]
v_exp_f16 v147, v148
v_and_b32 v139, s49, v139
v_mfma_f32_32x32x16_bf16 v[120:135], v[80:83], v[236:239], v[120:135]
ds_read_b128 v[232:235], v249 offset:12288
ds_read_u16_d16_hi v137, v137
v_exp_f16 v144, v145
v_exp_f16_sdwa v153, v154 dst_sel:WORD_1 dst_unused:UNUSED_PRESERVE src0_sel:WORD_1
v_fma_mix_f32 v163, v181, v181, v163 op_sel:[1,1,0] op_sel_hi:[1,1,0]
v_lshrrev_b16 v138, 2, v139
v_exp_f16_sdwa v150, v151 dst_sel:WORD_1 dst_unused:UNUSED_PRESERVE src0_sel:WORD_1
v_exp_f16_sdwa v147, v148 dst_sel:WORD_1 dst_unused:UNUSED_PRESERVE src0_sel:WORD_1
s_waitcnt lgkmcnt(6)
v_mfma_f32_32x32x16_bf16 v[120:135], v[84:87], v[216:219], v[120:135]
ds_read_b128 v[236:239], v249 offset:15360
ds_read_u16_d16 v138, v138
v_exp_f16_sdwa v144, v145 dst_sel:WORD_1 dst_unused:UNUSED_PRESERVE src0_sel:WORD_1
v_lshrrev_b32 v139, 18, v139
v_fma_mix_f32 v163, v182, v182, v163 op_sel:[0,0,0] op_sel_hi:[1,1,0]
v_pk_add_f16 v153, v153, 1.0 op_sel_hi:[1,0]
v_pk_add_f16 v150, v150, 1.0 op_sel_hi:[1,0]
v_pk_add_f16 v147, v147, 1.0 op_sel_hi:[1,0]
v_and_b32 v141, s49, v141
v_pk_add_f16 v144, v144, 1.0 op_sel_hi:[1,0]
v_mfma_f32_32x32x16_bf16 v[120:135], v[88:91], v[220:223], v[120:135]
ds_read_b128 v[216:219], v249 offset:13312
ds_read_u16_d16_hi v139, v139
v_rcp_f16 v154, v153
v_fma_mix_f32 v163, v183, v183, v163 op_sel:[1,1,0] op_sel_hi:[1,1,0]
v_rcp_f16 v151, v150
v_lshrrev_b16 v140, 2, v141
v_rcp_f16 v148, v147
v_fma_mix_f32 v163, v184, v184, v163 op_sel:[0,0,0] op_sel_hi:[1,1,0]
v_mfma_f32_32x32x16_bf16 v[120:135], v[92:95], v[224:227], v[120:135]
ds_read_b128 v[220:223], v249 offset:16384
ds_read_u16_d16 v140, v140
v_rcp_f16 v145, v144
v_lshrrev_b32 v141, 18, v141
v_rcp_f16_sdwa v154, v153 dst_sel:WORD_1 dst_unused:UNUSED_PRESERVE src0_sel:WORD_1
s_setprio 0
v_rcp_f16_sdwa v151, v150 dst_sel:WORD_1 dst_unused:UNUSED_PRESERVE src0_sel:WORD_1
v_fma_mix_f32 v163, v185, v185, v163 op_sel:[1,1,0] op_sel_hi:[1,1,0]
v_and_b32 v143, s49, v143
v_rcp_f16_sdwa v148, v147 dst_sel:WORD_1 dst_unused:UNUSED_PRESERVE src0_sel:WORD_1
s_waitcnt lgkmcnt(4)
v_smfmac_f32_16x16x32_bf16 v[24:27], v[228:229], v[208:211], v246
ds_read_b128 v[224:227], v249 offset:14336
ds_read_u16_d16_hi v141, v141
v_rcp_f16_sdwa v145, v144 dst_sel:WORD_1 dst_unused:UNUSED_PRESERVE src0_sel:WORD_1
v_pk_mul_f16 v155, v155, v154
v_lshrrev_b16 v142, 2, v143
v_fma_mix_f32 v163, v186, v186, v163 op_sel:[0,0,0] op_sel_hi:[1,1,0]
v_smfmac_f32_16x16x32_bf16 v[40:43], v[230:231], v[212:215], v246
s_mov_b64 exec, 1
ds_add_u32 v253, v254 offset:16
s_mov_b64 exec, -1
v_pk_mul_f16 v152, v152, v151
v_pk_mul_f16 v149, v149, v148
v_pk_mul_f16 v146, v146, v145
v_fma_mix_f32 v164, v155, v155, v164 op_sel:[0,0,0] op_sel_hi:[1,1,0]
v_lshrrev_b32 v143, 18, v143
v_fma_mix_f32 v164, v155, v155, v164 op_sel:[1,1,0] op_sel_hi:[1,1,0]
v_fma_mix_f32 v164, v152, v152, v164 op_sel:[0,0,0] op_sel_hi:[1,1,0]
v_fma_mix_f32 v163, v187, v187, v163 op_sel:[1,1,0] op_sel_hi:[1,1,0]
v_fma_mix_f32 v164, v152, v152, v164 op_sel:[1,1,0] op_sel_hi:[1,1,0]
v_fma_mix_f32 v164, v149, v149, v164 op_sel:[0,0,0] op_sel_hi:[1,1,0]
v_fma_mix_f32 v164, v149, v149, v164 op_sel:[1,1,0] op_sel_hi:[1,1,0]
v_fma_mix_f32 v164, v146, v146, v164 op_sel:[0,0,0] op_sel_hi:[1,1,0]
v_fma_mix_f32 v164, v146, v146, v164 op_sel:[1,1,0] op_sel_hi:[1,1,0]
s_setprio 3
v_pk_add_f32 v[168:169], v[0:1], v[2:3]
v_pk_mul_f32 v[170:171], v[0:1], v[0:1]
v_pk_fma_f32 v[170:171], v[2:3], v[2:3], v[170:171]
v_pk_add_f32 v[168:169], v[168:169], v[4:5]
v_pk_fma_f32 v[170:171], v[4:5], v[4:5], v[170:171]
v_pk_add_f32 v[168:169], v[168:169], v[6:7]
v_pk_fma_f32 v[170:171], v[6:7], v[6:7], v[170:171]
v_pk_add_f32 v[168:169], v[168:169], v[8:9]
v_pk_fma_f32 v[170:171], v[8:9], v[8:9], v[170:171]
v_pk_add_f32 v[168:169], v[168:169], v[10:11]
v_pk_fma_f32 v[170:171], v[10:11], v[10:11], v[170:171]
v_pk_add_f32 v[168:169], v[168:169], v[12:13]
v_pk_fma_f32 v[170:171], v[12:13], v[12:13], v[170:171]
v_pk_add_f32 v[168:169], v[168:169], v[14:15]
v_pk_fma_f32 v[170:171], v[14:15], v[14:15], v[170:171]
v_pk_add_f32 v[168:169], v[168:169], v[16:17]
v_pk_fma_f32 v[170:171], v[16:17], v[16:17], v[170:171]
v_pk_add_f32 v[168:169], v[168:169], v[18:19]
v_pk_fma_f32 v[170:171], v[18:19], v[18:19], v[170:171]
v_pk_add_f32 v[168:169], v[168:169], v[20:21]
v_pk_fma_f32 v[170:171], v[20:21], v[20:21], v[170:171]
v_pk_add_f32 v[168:169], v[168:169], v[22:23]
v_pk_fma_f32 v[170:171], v[22:23], v[22:23], v[170:171]
v_pk_add_f32 v[168:169], v[168:169], v[24:25]
v_pk_fma_f32 v[170:171], v[24:25], v[24:25], v[170:171]
v_pk_add_f32 v[168:169], v[168:169], v[26:27]
v_pk_fma_f32 v[170:171], v[26:27], v[26:27], v[170:171]
v_pk_add_f32 v[168:169], v[168:169], v[28:29]
v_pk_fma_f32 v[170:171], v[28:29], v[28:29], v[170:171]
v_pk_add_f32 v[168:169], v[168:169], v[30:31]
v_pk_fma_f32 v[170:171], v[30:31], v[30:31], v[170:171]
v_pk_add_f32 v[168:169], v[168:169], v[32:33]
v_pk_fma_f32 v[170:171], v[32:33], v[32:33], v[170:171]
v_pk_add_f32 v[168:169], v[168:169], v[34:35]
v_pk_fma_f32 v[170:171], v[34:35], v[34:35], v[170:171]
v_pk_add_f32 v[168:169], v[168:169], v[36:37]
v_pk_fma_f32 v[170:171], v[36:37], v[36:37], v[170:171]
v_pk_add_f32 v[168:169], v[168:169], v[38:39]
v_pk_fma_f32 v[170:171], v[38:39], v[38:39], v[170:171]
v_pk_add_f32 v[168:169], v[168:169], v[40:41]
v_pk_fma_f32 v[170:171], v[40:41], v[40:41], v[170:171]
v_pk_add_f32 v[168:169], v[168:169], v[42:43]
v_pk_fma_f32 v[170:171], v[42:43], v[42:43], v[170:171]
v_pk_add_f32 v[168:169], v[168:169], v[44:45]
v_pk_fma_f32 v[170:171], v[44:45], v[44:45], v[170:171]
v_pk_add_f32 v[168:169], v[168:169], v[46:47]
v_pk_fma_f32 v[170:171], v[46:47], v[46:47], v[170:171]
s_setprio 0
v_add_u32 v174, -36864, v242
v_subrev_u32 v175, 66560, v174
v_min_u32 v174, v174, v175
v_add_u32 v174, 90112, v174
v_sub_u32 v175, v174, v242
v_add_u32 v242, v175, v242
v_add_u32 v243, v175, v243
v_add_u32 v244, v175, v244
s_setprio 2
v_cvt_pkrtz_f16_f32 v179, v120, v121
v_cvt_pkrtz_f16_f32 v181, v122, v123
v_cvt_pkrtz_f16_f32 v183, v124, v125
v_cvt_pkrtz_f16_f32 v185, v126, v127
v_cvt_pkrtz_f16_f32 v187, v128, v129
v_cvt_pkrtz_f16_f32 v189, v130, v131
v_cvt_pk_f16_f32 v155, v132, v133
v_cvt_pk_f16_f32 v152, v134, v135
ds_read_b128 v[228:231], v249 offset:17408
ds_read_u16_d16 v142, v142
ds_read_u16_d16_hi v143, v143
v_mfma_f32_32x32x16_bf16 v[120:135], v[72:75], v[232:235], 0
v_pk_fma_f16 v154, v155, v155, s48
v_add_f32 v168, v168, v169
v_and_b32 v179, s49, v179
v_fma_mix_f32 v164, v136, v136, v164 op_sel:[0,0,0] op_sel_hi:[1,1,0]
v_lshrrev_b16 v178, 2, v179
v_add_f32 v170, v170, v171
v_pk_fma_f16 v151, v152, v152, s48
v_pk_mul_f16 v154, v155, v154
v_lshrrev_b32 v179, 18, v179
v_pk_mul_f16 v151, v152, v151
ds_read_b128 v[232:235], v249 offset:18432
ds_read_u16_d16 v178, v178
ds_read_u16_d16_hi v179, v179
v_mfma_f32_32x32x16_bf16 v[120:135], v[76:79], v[236:239], v[120:135]
v_permlane32_swap_b32 v168, v170
v_fma_mix_f32 v164, v137, v137, v164 op_sel:[1,1,0] op_sel_hi:[1,1,0]
v_and_b32 v181, s49, v181
v_exp_f16 v153, v154
v_add_f32 v168, v168, v170
v_lshrrev_b16 v180, 2, v181
v_exp_f16 v150, v151
v_lshrrev_b32 v181, 18, v181
s_waitcnt lgkmcnt(7)
ds_read_b128 v[236:239], v249 offset:21504
ds_read_u16_d16 v180, v180
ds_read_u16_d16_hi v181, v181
v_mfma_f32_32x32x16_bf16 v[120:135], v[80:83], v[216:219], v[120:135]
v_mul_f32 v168, 1009429163, v168
v_fma_mix_f32 v164, v138, v138, v164 op_sel:[0,0,0] op_sel_hi:[1,1,0]
v_exp_f16_sdwa v153, v154 dst_sel:WORD_1 dst_unused:UNUSED_PRESERVE src0_sel:WORD_1
v_and_b32 v183, s49, v183
v_mov_b32 v170, v168
v_exp_f16_sdwa v150, v151 dst_sel:WORD_1 dst_unused:UNUSED_PRESERVE src0_sel:WORD_1
v_lshrrev_b16 v182, 2, v183
v_fma_mix_f32 v164, v139, v139, v164 op_sel:[1,1,0] op_sel_hi:[1,1,0]
v_permlane32_swap_b32 v168, v170
ds_read_b128 v[216:219], v249 offset:19456
ds_read_u16_d16 v182, v182
v_mfma_f32_32x32x16_bf16 v[120:135], v[84:87], v[220:223], v[120:135]
v_lshrrev_b32 v183, 18, v183
v_pk_add_f16 v153, v153, 1.0 op_sel_hi:[1,0]
v_pk_add_f16 v150, v150, 1.0 op_sel_hi:[1,0]
v_and_b32 v185, s49, v185
v_fma_f32 v170, -v168, v168, v170
v_rcp_f16 v154, v153
v_lshrrev_b16 v184, 2, v185
v_max_f32 v170, 0, v170
v_fma_mix_f32 v164, v140, v140, v164 op_sel:[0,0,0] op_sel_hi:[1,1,0]
ds_read_b128 v[220:223], v249 offset:22528
ds_read_u16_d16_hi v183, v183
ds_read_u16_d16 v184, v184
v_mfma_f32_32x32x16_bf16 v[120:135], v[88:91], v[224:227], v[120:135]
v_lshrrev_b32 v185, 18, v185
v_rcp_f16 v151, v150
v_add_f32 v170, 925353388, v170
v_and_b32 v187, s49, v187
v_fma_mix_f32 v164, v141, v141, v164 op_sel:[1,1,0] op_sel_hi:[1,1,0]
v_rcp_f16_sdwa v154, v153 dst_sel:WORD_1 dst_unused:UNUSED_PRESERVE src0_sel:WORD_1
v_rsq_f32 v170, v170
s_waitcnt lgkmcnt(5)
ds_read_b128 v[224:227], v249 offset:20480
ds_read_u16_d16_hi v185, v185
ds_read_b32 v247, v253 offset:16
v_mfma_f32_32x32x16_bf16 v[120:135], v[92:95], v[228:231], v[120:135]
v_lshrrev_b16 v186, 2, v187
v_rcp_f16_sdwa v151, v150 dst_sel:WORD_1 dst_unused:UNUSED_PRESERVE src0_sel:WORD_1
v_lshrrev_b32 v187, 18, v187
v_fma_mix_f32 v164, v142, v142, v164 op_sel:[0,0,0] op_sel_hi:[1,1,0]
v_and_b32 v189, s49, v189
v_pk_mul_f16 v155, v155, v154
v_pk_mul_f16 v152, v152, v151
v_mul_f32 v172, 3203391086, v170
v_lshrrev_b16 v188, 2, v189
v_fma_mix_f32 v165, v155, v155, v165 op_sel:[0,0,0] op_sel_hi:[1,1,0]
v_fma_mix_f32 v164, v143, v143, v164 op_sel:[1,1,0] op_sel_hi:[1,1,0]
v_lshrrev_b32 v189, 18, v189
v_mul_f32 v173, v168, v172
v_fma_mix_f32 v165, v155, v155, v165 op_sel:[1,1,0] op_sel_hi:[1,1,0]
v_fma_mix_f32 v165, v152, v152, v165 op_sel:[0,0,0] op_sel_hi:[1,1,0]
v_fma_mix_f32 v165, v152, v152, v165 op_sel:[1,1,0] op_sel_hi:[1,1,0]
s_setprio 3
v_pk_fma_f32 v[0:1], v[0:1], v[172:173], v[172:173] op_sel:[0,0,1] op_sel_hi:[1,0,1] neg_lo:[0,0,1] neg_hi:[0,0,1]
v_pk_fma_f32 v[2:3], v[2:3], v[172:173], v[172:173] op_sel:[0,0,1] op_sel_hi:[1,0,1] neg_lo:[0,0,1] neg_hi:[0,0,1]
v_pk_fma_f32 v[4:5], v[4:5], v[172:173], v[172:173] op_sel:[0,0,1] op_sel_hi:[1,0,1] neg_lo:[0,0,1] neg_hi:[0,0,1]
v_pk_fma_f32 v[6:7], v[6:7], v[172:173], v[172:173] op_sel:[0,0,1] op_sel_hi:[1,0,1] neg_lo:[0,0,1] neg_hi:[0,0,1]
v_pk_fma_f32 v[8:9], v[8:9], v[172:173], v[172:173] op_sel:[0,0,1] op_sel_hi:[1,0,1] neg_lo:[0,0,1] neg_hi:[0,0,1]
v_pk_fma_f32 v[10:11], v[10:11], v[172:173], v[172:173] op_sel:[0,0,1] op_sel_hi:[1,0,1] neg_lo:[0,0,1] neg_hi:[0,0,1]
v_pk_fma_f32 v[12:13], v[12:13], v[172:173], v[172:173] op_sel:[0,0,1] op_sel_hi:[1,0,1] neg_lo:[0,0,1] neg_hi:[0,0,1]
v_pk_fma_f32 v[14:15], v[14:15], v[172:173], v[172:173] op_sel:[0,0,1] op_sel_hi:[1,0,1] neg_lo:[0,0,1] neg_hi:[0,0,1]
v_pk_fma_f32 v[16:17], v[16:17], v[172:173], v[172:173] op_sel:[0,0,1] op_sel_hi:[1,0,1] neg_lo:[0,0,1] neg_hi:[0,0,1]
v_pk_fma_f32 v[18:19], v[18:19], v[172:173], v[172:173] op_sel:[0,0,1] op_sel_hi:[1,0,1] neg_lo:[0,0,1] neg_hi:[0,0,1]
v_pk_fma_f32 v[20:21], v[20:21], v[172:173], v[172:173] op_sel:[0,0,1] op_sel_hi:[1,0,1] neg_lo:[0,0,1] neg_hi:[0,0,1]
v_pk_fma_f32 v[22:23], v[22:23], v[172:173], v[172:173] op_sel:[0,0,1] op_sel_hi:[1,0,1] neg_lo:[0,0,1] neg_hi:[0,0,1]
v_pk_fma_f32 v[24:25], v[24:25], v[172:173], v[172:173] op_sel:[0,0,1] op_sel_hi:[1,0,1] neg_lo:[0,0,1] neg_hi:[0,0,1]
v_pk_fma_f32 v[26:27], v[26:27], v[172:173], v[172:173] op_sel:[0,0,1] op_sel_hi:[1,0,1] neg_lo:[0,0,1] neg_hi:[0,0,1]
v_pk_fma_f32 v[28:29], v[28:29], v[172:173], v[172:173] op_sel:[0,0,1] op_sel_hi:[1,0,1] neg_lo:[0,0,1] neg_hi:[0,0,1]
v_pk_fma_f32 v[30:31], v[30:31], v[172:173], v[172:173] op_sel:[0,0,1] op_sel_hi:[1,0,1] neg_lo:[0,0,1] neg_hi:[0,0,1]
v_pk_fma_f32 v[32:33], v[32:33], v[172:173], v[172:173] op_sel:[0,0,1] op_sel_hi:[1,0,1] neg_lo:[0,0,1] neg_hi:[0,0,1]
v_pk_fma_f32 v[34:35], v[34:35], v[172:173], v[172:173] op_sel:[0,0,1] op_sel_hi:[1,0,1] neg_lo:[0,0,1] neg_hi:[0,0,1]
v_pk_fma_f32 v[36:37], v[36:37], v[172:173], v[172:173] op_sel:[0,0,1] op_sel_hi:[1,0,1] neg_lo:[0,0,1] neg_hi:[0,0,1]
v_pk_fma_f32 v[38:39], v[38:39], v[172:173], v[172:173] op_sel:[0,0,1] op_sel_hi:[1,0,1] neg_lo:[0,0,1] neg_hi:[0,0,1]
v_pk_fma_f32 v[40:41], v[40:41], v[172:173], v[172:173] op_sel:[0,0,1] op_sel_hi:[1,0,1] neg_lo:[0,0,1] neg_hi:[0,0,1]
v_pk_fma_f32 v[42:43], v[42:43], v[172:173], v[172:173] op_sel:[0,0,1] op_sel_hi:[1,0,1] neg_lo:[0,0,1] neg_hi:[0,0,1]
v_pk_fma_f32 v[44:45], v[44:45], v[172:173], v[172:173] op_sel:[0,0,1] op_sel_hi:[1,0,1] neg_lo:[0,0,1] neg_hi:[0,0,1]
v_pk_fma_f32 v[46:47], v[46:47], v[172:173], v[172:173] op_sel:[0,0,1] op_sel_hi:[1,0,1] neg_lo:[0,0,1] neg_hi:[0,0,1]
s_setprio 2
ds_read_u16_d16 v186, v186
ds_read_u16_d16_hi v187, v187
ds_read_u16_d16 v188, v188
ds_read_u16_d16_hi v189, v189
s_waitcnt lgkmcnt(4)
v_readfirstlane_b32 s43, v247
s_nop 1
s_cmp_ge_u32 s43, 24
s_cbranch_scc1 Lev7
Lev7w:
s_sleep 1
ds_read_b32 v247, v253 offset:16
s_waitcnt lgkmcnt(0)
v_readfirstlane_b32 s43, v247
s_cmp_eq_u32 s76, 0
s_cbranch_scc1 Lev7
s_sub_u32 s76, s76, 1
s_cmp_lt_u32 s43, 24
s_cbranch_scc1 Lev7w
Lev7:
s_setprio 1
v_cvt_pkrtz_f16_f32 v137, v120, v121
v_cvt_pkrtz_f16_f32 v139, v122, v123
v_cvt_pkrtz_f16_f32 v141, v124, v125
v_cvt_pkrtz_f16_f32 v143, v126, v127
v_cvt_pkrtz_f16_f32 v177, v128, v129
v_cvt_pkrtz_f16_f32 v191, v130, v131
v_cvt_pk_f16_f32 v155, v132, v133
v_cvt_pk_f16_f32 v152, v134, v135
s_add_u32 m0, s67, 39936
s_add_u32 s66, s66, 98304
buffer_load_dwordx4 v240, s[4:7], s66 offen lds
ds_read_b128 v[228:231], v249 offset:23552
v_mfma_f32_32x32x16_bf16 v[120:135], v[72:75], v[232:235], 0
v_pk_fma_f16 v154, v155, v155, s48
v_cvt_pk_bf16_f32 v96, v0, v1
v_and_b32 v137, s49, v137
v_fma_mix_f32 v165, v178, v178, v165 op_sel:[0,0,0] op_sel_hi:[1,1,0]
v_cvt_pk_bf16_f32 v97, v2, v3
v_pk_fma_f16 v151, v152, v152, s48
v_lshrrev_b16 v136, 2, v137
v_cvt_pk_bf16_f32 v98, v4, v5
v_pk_mul_f16 v154, v155, v154
v_fma_mix_f32 v165, v179, v179, v165 op_sel:[1,1,0] op_sel_hi:[1,1,0]
v_lshrrev_b32 v137, 18, v137
v_cvt_pk_bf16_f32 v99, v6, v7
s_add_u32 m0, s67, 46592
s_add_u32 s66, s66, 98304
buffer_load_dwordx4 v240, s[4:7], s66 offen lds
ds_read_b128 v[232:235], v248 offset:16384
ds_read_u16_d16 v136, v136
ds_read_u16_d16_hi v137, v137
v_mfma_f32_32x32x16_bf16 v[120:135], v[76:79], v[236:239], v[120:135]
v_pk_mul_f16 v151, v152, v151
v_exp_f16 v153, v154
v_cvt_pk_bf16_f32 v100, v8, v9
v_and_b32 v139, s49, v139
v_fma_mix_f32 v165, v180, v180, v165 op_sel:[0,0,0] op_sel_hi:[1,1,0]
v_cvt_pk_bf16_f32 v101, v10, v11
v_lshrrev_b16 v138, 2, v139
v_exp_f16 v150, v151
v_cvt_pk_bf16_f32 v102, v12, v13
v_lshrrev_b32 v139, 18, v139
v_cvt_pk_bf16_f32 v103, v14, v15
s_add_u32 m0, s67, 53248
s_add_u32 s66, s66, 98304
buffer_load_dwordx4 v240, s[4:7], s66 offen lds
ds_read_b128 v[236:239], v248 offset:19456
ds_read_u16_d16 v138, v138
ds_read_u16_d16_hi v139, v139
v_mfma_f32_32x32x16_bf16 v[120:135], v[80:83], v[216:219], v[120:135]
v_fma_mix_f32 v165, v181, v181, v165 op_sel:[1,1,0] op_sel_hi:[1,1,0]
v_exp_f16_sdwa v153, v154 dst_sel:WORD_1 dst_unused:UNUSED_PRESERVE src0_sel:WORD_1
v_cvt_pk_bf16_f32 v104, v16, v17
v_and_b32 v141, s49, v141
v_fma_mix_f32 v165, v182, v182, v165 op_sel:[0,0,0] op_sel_hi:[1,1,0]
v_cvt_pk_bf16_f32 v105, v18, v19
v_lshrrev_b16 v140, 2, v141
v_exp_f16_sdwa v150, v151 dst_sel:WORD_1 dst_unused:UNUSED_PRESERVE src0_sel:WORD_1
v_cvt_pk_bf16_f32 v106, v20, v21
v_lshrrev_b32 v141, 18, v141
s_add_u32 m0, s67, 59904
s_add_u32 s66, s66, 98304
buffer_load_dwordx4 v240, s[4:7], s66 offen lds
s_add_u32 m0, s67, 0
s_add_u32 s66, s66, 98304
buffer_load_dwordx4 v240, s[4:7], s66 offen lds
ds_read_b128 v[216:219], v248 offset:17408
ds_read_u16_d16 v140, v140
ds_read_u16_d16_hi v141, v141
v_mfma_f32_32x32x16_bf16 v[120:135], v[84:87], v[220:223], v[120:135]
v_fma_mix_f32 v165, v183, v183, v165 op_sel:[1,1,0] op_sel_hi:[1,1,0]
v_cvt_pk_bf16_f32 v107, v22, v23
v_pk_add_f16 v153, v153, 1.0 op_sel_hi:[1,0]
v_pk_add_f16 v150, v150, 1.0 op_sel_hi:[1,0]
v_and_b32 v143, s49, v143
v_cvt_pk_bf16_f32 v108, v24, v25
v_rcp_f16 v154, v153
v_cvt_pk_bf16_f32 v109, v26, v27
v_lshrrev_b16 v142, 2, v143
v_fma_mix_f32 v165, v184, v184, v165 op_sel:[0,0,0] op_sel_hi:[1,1,0]
v_cvt_pk_bf16_f32 v110, v28, v29
s_add_u32 m0, s67, 6656
s_add_u32 s66, s66, 98304
buffer_load_dwordx4 v240, s[4:7], s66 offen lds
ds_read_b128 v[220:223], v248 offset:20480
ds_read_u16_d16 v142, v142
v_mfma_f32_32x32x16_bf16 v[120:135], v[88:91], v[224:227], v[120:135]
v_rcp_f16 v151, v150
v_lshrrev_b32 v143, 18, v143
v_cvt_pk_bf16_f32 v111, v30, v31
v_fma_mix_f32 v165, v185, v185, v165 op_sel:[1,1,0] op_sel_hi:[1,1,0]
v_and_b32 v177, s49, v177
s_setprio 0
v_cvt_pk_bf16_f32 v112, v32, v33
v_rcp_f16_sdwa v154, v153 dst_sel:WORD_1 dst_unused:UNUSED_PRESERVE src0_sel:WORD_1
v_lshrrev_b16 v176, 2, v177
v_cvt_pk_bf16_f32 v113, v34, v35
s_waitcnt lgkmcnt(2)
v_fma_mix_f32 v165, v186, v186, v165 op_sel:[0,0,0] op_sel_hi:[1,1,0]
v_rcp_f16_sdwa v151, v150 dst_sel:WORD_1 dst_unused:UNUSED_PRESERVE src0_sel:WORD_1
s_add_u32 m0, s67, 13312
s_add_u32 s66, s66, 98304
buffer_load_dwordx4 v240, s[4:7], s66 offen lds
ds_read_b128 v[224:227], v248 offset:18432
ds_read_u16_d16_hi v143, v143
ds_read_u16_d16 v176, v176
v_mfma_f32_32x32x16_bf16 v[120:135], v[92:95], v[228:231], v[120:135]
v_cvt_pk_bf16_f32 v114, v36, v37
v_lshrrev_b32 v177, 18, v177
v_cvt_pk_bf16_f32 v115, v38, v39
v_fma_mix_f32 v165, v187, v187, v165 op_sel:[1,1,0] op_sel_hi:[1,1,0]
v_and_b32 v191, s49, v191
v_pk_mul_f16 v155, v155, v154
v_cvt_pk_bf16_f32 v116, v40, v41
v_pk_mul_f16 v152, v152, v151
v_lshrrev_b16 v190, 2, v191
v_cvt_pk_bf16_f32 v117, v42, v43
v_fma_mix_f32 v165, v188, v188, v165 op_sel:[0,0,0] op_sel_hi:[1,1,0]
v_fma_mix_f32 v166, v155, v155, v166 op_sel:[0,0,0] op_sel_hi:[1,1,0]
s_add_u32 m0, s67, 19968
s_add_u32 s66, s66, 98304
buffer_load_dwordx4 v240, s[4:7], s66 offen lds
v_lshrrev_b32 v191, 18, v191
v_cvt_pk_bf16_f32 v118, v44, v45
v_fma_mix_f32 v166, v155, v155, v166 op_sel:[1,1,0] op_sel_hi:[1,1,0]
v_fma_mix_f32 v165, v189, v189, v165 op_sel:[1,1,0] op_sel_hi:[1,1,0]
v_cvt_pk_bf16_f32 v119, v46, v47
v_fma_mix_f32 v166, v152, v152, v166 op_sel:[0,0,0] op_sel_hi:[1,1,0]
v_fma_mix_f32 v166, v152, v152, v166 op_sel:[1,1,0] op_sel_hi:[1,1,0]
s_setprio 2
v_cvt_pkrtz_f16_f32 v179, v120, v121
v_cvt_pkrtz_f16_f32 v181, v122, v123
v_cvt_pkrtz_f16_f32 v183, v124, v125
v_cvt_pkrtz_f16_f32 v185, v126, v127
v_cvt_pkrtz_f16_f32 v187, v128, v129
v_cvt_pk_f16_f32 v155, v130, v131
v_cvt_pk_f16_f32 v152, v132, v133
v_cvt_pk_f16_f32 v149, v134, v135
ds_read_b128 v[228:231], v248 offset:21504
ds_read_u16_d16_hi v177, v177
ds_read_u16_d16 v190, v190
ds_read_u16_d16_hi v191, v191
v_mfma_f32_32x32x16_bf16 v[120:135], v[96:99], v[232:235], 0
v_pk_fma_f16 v154, v155, v155, s48
v_and_b32 v179, s49, v179
v_fma_mix_f32 v166, v136, v136, v166 op_sel:[0,0,0] op_sel_hi:[1,1,0]
v_pk_fma_f16 v151, v152, v152, s48
v_pk_fma_f16 v148, v149, v149, s48
v_lshrrev_b16 v178, 2, v179
v_pk_mul_f16 v154, v155, v154
v_fma_mix_f32 v166, v137, v137, v166 op_sel:[1,1,0] op_sel_hi:[1,1,0]
v_pk_mul_f16 v151, v152, v151
v_lshrrev_b32 v179, 18, v179
ds_read_b128 v[232:235], v248 offset:22528
ds_read_u16_d16 v178, v178
ds_read_u16_d16_hi v179, v179
v_mfma_f32_32x32x16_bf16 v[120:135], v[100:103], v[236:239], v[120:135]
v_pk_mul_f16 v148, v149, v148
v_exp_f16 v153, v154
v_fma_mix_f32 v166, v138, v138, v166 op_sel:[0,0,0] op_sel_hi:[1,1,0]
v_and_b32 v181, s49, v181
v_exp_f16 v150, v151
v_exp_f16 v147, v148
v_lshrrev_b16 v180, 2, v181
v_fma_mix_f32 v166, v139, v139, v166 op_sel:[1,1,0] op_sel_hi:[1,1,0]
ds_read_b128 v[236:239], v248 offset:25600
ds_read_u16_d16 v180, v180
v_mfma_f32_32x32x16_bf16 v[120:135], v[104:107], v[216:219], v[120:135]
v_exp_f16_sdwa v153, v154 dst_sel:WORD_1 dst_unused:UNUSED_PRESERVE src0_sel:WORD_1
v_lshrrev_b32 v181, 18, v181
v_exp_f16_sdwa v150, v151 dst_sel:WORD_1 dst_unused:UNUSED_PRESERVE src0_sel:WORD_1
v_fma_mix_f32 v166, v140, v140, v166 op_sel:[0,0,0] op_sel_hi:[1,1,0]
v_and_b32 v183, s49, v183
v_exp_f16_sdwa v147, v148 dst_sel:WORD_1 dst_unused:UNUSED_PRESERVE src0_sel:WORD_1
v_fma_mix_f32 v166, v141, v141, v166 op_sel:[1,1,0] op_sel_hi:[1,1,0]
s_waitcnt lgkmcnt(5)
ds_read_b128 v[216:219], v248 offset:23552
ds_read_u16_d16_hi v181, v181
v_mfma_f32_32x32x16_bf16 v[120:135], v[108:111], v[220:223], v[120:135]
v_pk_add_f16 v153, v153, 1.0 op_sel_hi:[1,0]
v_lshrrev_b16 v182, 2, v183
v_pk_add_f16 v150, v150, 1.0 op_sel_hi:[1,0]
v_pk_add_f16 v147, v147, 1.0 op_sel_hi:[1,0]
v_rcp_f16 v154, v153
v_lshrrev_b32 v183, 18, v183
v_fma_mix_f32 v166, v142, v142, v166 op_sel:[0,0,0] op_sel_hi:[1,1,0]
v_rcp_f16 v151, v150
v_and_b32 v185, s49, v185
ds_read_b128 v[220:223], v248 offset:26624
ds_read_u16_d16 v182, v182
ds_read_u16_d16_hi v183, v183
v_mfma_f32_32x32x16_bf16 v[120:135], v[112:115], v[224:227], v[120:135]
v_fma_mix_f32 v166, v143, v143, v166 op_sel:[1,1,0] op_sel_hi:[1,1,0]
v_rcp_f16 v148, v147
v_lshrrev_b16 v184, 2, v185
v_rcp_f16_sdwa v154, v153 dst_sel:WORD_1 dst_unused:UNUSED_PRESERVE src0_sel:WORD_1
v_fma_mix_f32 v166, v176, v176, v166 op_sel:[0,0,0] op_sel_hi:[1,1,0]
v_rcp_f16_sdwa v151, v150 dst_sel:WORD_1 dst_unused:UNUSED_PRESERVE src0_sel:WORD_1
v_lshrrev_b32 v185, 18, v185
ds_read_b128 v[224:227], v248 offset:24576
ds_read_u16_d16 v184, v184
ds_read_u16_d16_hi v185, v185
v_mfma_f32_32x32x16_bf16 v[120:135], v[116:119], v[228:231], v[120:135]
v_rcp_f16_sdwa v148, v147 dst_sel:WORD_1 dst_unused:UNUSED_PRESERVE src0_sel:WORD_1
s_cmp_eq_u32 s40, 7
s_cbranch_scc1 Lrdy24
s_waitcnt vmcnt(0)
Lrdy24:
s_mov_b64 exec, 1
ds_add_u32 v253, v254 offset:12
s_mov_b64 exec, -1
v_and_b32 v187, s49, v187
v_fma_mix_f32 v166, v177, v177, v166 op_sel:[1,1,0] op_sel_hi:[1,1,0]
v_pk_mul_f16 v155, v155, v154
v_pk_mul_f16 v152, v152, v151
v_pk_mul_f16 v149, v149, v148
v_lshrrev_b16 v186, 2, v187
v_fma_mix_f32 v166, v190, v190, v166 op_sel:[0,0,0] op_sel_hi:[1,1,0]
v_fma_mix_f32 v167, v155, v155, v167 op_sel:[0,0,0] op_sel_hi:[1,1,0]
v_fma_mix_f32 v167, v155, v155, v167 op_sel:[1,1,0] op_sel_hi:[1,1,0]
v_lshrrev_b32 v187, 18, v187
v_fma_mix_f32 v167, v152, v152, v167 op_sel:[0,0,0] op_sel_hi:[1,1,0]
v_fma_mix_f32 v166, v191, v191, v166 op_sel:[1,1,0] op_sel_hi:[1,1,0]
v_fma_mix_f32 v167, v152, v152, v167 op_sel:[1,1,0] op_sel_hi:[1,1,0]
v_fma_mix_f32 v167, v149, v149, v167 op_sel:[0,0,0] op_sel_hi:[1,1,0]
v_fma_mix_f32 v167, v149, v149, v167 op_sel:[1,1,0] op_sel_hi:[1,1,0]
s_cmp_lg_u32 s40, 7
s_cbranch_scc1 Lnoinit
s_waitcnt vmcnt(11)
v_mov_b32 v255, 1
s_mov_b64 exec, 1
buffer_atomic_add v255, v241, s[36:39], 0 offen
s_mov_b64 exec, -1
Lnoinit:
s_setprio 1
v_cvt_pkrtz_f16_f32 v137, v120, v121
v_cvt_pkrtz_f16_f32 v139, v122, v123
v_cvt_pkrtz_f16_f32 v141, v124, v125
v_cvt_pkrtz_f16_f32 v143, v126, v127
v_cvt_pkrtz_f16_f32 v177, v128, v129
v_cvt_pk_f16_f32 v155, v130, v131
v_cvt_pk_f16_f32 v152, v132, v133
v_cvt_pk_f16_f32 v149, v134, v135
s_waitcnt lgkmcnt(1)
s_add_u32 s46, s80, 12582912
buffer_store_dwordx4 v[72:75], v241, s[32:35], s46 offen sc1
ds_read_b128 v[228:231], v248 offset:27648
ds_read_u16_d16 v186, v186
ds_read_u16_d16_hi v187, v187
v_mfma_f32_32x32x16_bf16 v[120:135], v[96:99], v[232:235], 0
v_pk_fma_f16 v154, v155, v155, s48
v_and_b32 v137, s49, v137
v_fma_mix_f32 v167, v178, v178, v167 op_sel:[0,0,0] op_sel_hi:[1,1,0]
v_pk_fma_f16 v151, v152, v152, s48
v_pk_fma_f16 v148, v149, v149, s48
v_lshrrev_b16 v136, 2, v137
v_pk_mul_f16 v154, v155, v154
v_pk_mul_f16 v151, v152, v151
v_fma_mix_f32 v167, v179, v179, v167 op_sel:[1,1,0] op_sel_hi:[1,1,0]
v_lshrrev_b32 v137, 18, v137
ds_read_b128 v[232:235], v250 offset:65520
ds_read_u16_d16 v136, v136
ds_read_u16_d16_hi v137, v137
v_mfma_f32_32x32x16_bf16 v[120:135], v[100:103], v[236:239], v[120:135]
v_pk_mul_f16 v148, v149, v148
v_exp_f16 v153, v154
v_exp_f16 v150, v151
v_and_b32 v139, s49, v139
v_fma_mix_f32 v167, v180, v180, v167 op_sel:[0,0,0] op_sel_hi:[1,1,0]
v_exp_f16 v147, v148
v_lshrrev_b16 v138, 2, v139
ds_read_b128 v[236:239], v248 offset:28672
ds_read_b32 v247, v253 offset:12
ds_read_u16_d16 v138, v138
v_mfma_f32_32x32x16_bf16 v[120:135], v[104:107], v[216:219], v[120:135]
v_exp_f16_sdwa v153, v154 dst_sel:WORD_1 dst_unused:UNUSED_PRESERVE src0_sel:WORD_1
v_lshrrev_b32 v139, 18, v139
v_fma_mix_f32 v167, v181, v181, v167 op_sel:[1,1,0] op_sel_hi:[1,1,0]
v_exp_f16_sdwa v150, v151 dst_sel:WORD_1 dst_unused:UNUSED_PRESERVE src0_sel:WORD_1
v_exp_f16_sdwa v147, v148 dst_sel:WORD_1 dst_unused:UNUSED_PRESERVE src0_sel:WORD_1
v_and_b32 v141, s49, v141
v_fma_mix_f32 v167, v182, v182, v167 op_sel:[0,0,0] op_sel_hi:[1,1,0]
ds_read_b128 v[216:219], v248 offset:31744
ds_read_u16_d16_hi v139, v139
v_mfma_f32_32x32x16_bf16 v[120:135], v[108:111], v[220:223], v[120:135]
v_pk_add_f16 v153, v153, 1.0 op_sel_hi:[1,0]
v_lshrrev_b16 v140, 2, v141
v_pk_add_f16 v150, v150, 1.0 op_sel_hi:[1,0]
v_pk_add_f16 v147, v147, 1.0 op_sel_hi:[1,0]
v_rcp_f16 v154, v153
v_lshrrev_b32 v141, 18, v141
v_fma_mix_f32 v167, v183, v183, v167 op_sel:[1,1,0] op_sel_hi:[1,1,0]
ds_read_u16_d16 v140, v140
ds_read_u16_d16_hi v141, v141
s_waitcnt lgkmcnt(5)
v_readfirstlane_b32 s43, v247
s_nop 1
s_cmp_ge_u32 s43, 32
s_cbranch_scc1 Lev8
Lev8w:
s_sleep 1
ds_read_b32 v247, v253 offset:12
s_waitcnt lgkmcnt(0)
v_readfirstlane_b32 s43, v247
s_cmp_eq_u32 s76, 0
s_cbranch_scc1 Lev8
s_sub_u32 s76, s76, 1
s_cmp_lt_u32 s43, 32
s_cbranch_scc1 Lev8w
Lev8:
v_rcp_f16 v151, v150
ds_read_b128 v[220:223], v248 offset:29696
v_mfma_f32_32x32x16_bf16 v[120:135], v[112:115], v[224:227], v[120:135]
v_and_b32 v143, s49, v143
v_rcp_f16 v148, v147
v_fma_mix_f32 v167, v184, v184, v167 op_sel:[0,0,0] op_sel_hi:[1,1,0]
v_lshrrev_b16 v142, 2, v143
s_setprio 0
v_rcp_f16_sdwa v154, v153 dst_sel:WORD_1 dst_unused:UNUSED_PRESERVE src0_sel:WORD_1
v_rcp_f16_sdwa v151, v150 dst_sel:WORD_1 dst_unused:UNUSED_PRESERVE src0_sel:WORD_1
v_lshrrev_b32 v143, 18, v143
ds_read_b128 v[224:227], v245 offset:6528
ds_read_b128 v[192:195], v244 offset:128
ds_read_b128 v[196:199], v244 offset:64
ds_read_u16_d16 v142, v142
ds_read_u16_d16_hi v143, v143
v_mfma_f32_32x32x16_bf16 v[120:135], v[116:119], v[228:231], v[120:135]
v_fma_mix_f32 v167, v185, v185, v167 op_sel:[1,1,0] op_sel_hi:[1,1,0]
v_rcp_f16_sdwa v148, v147 dst_sel:WORD_1 dst_unused:UNUSED_PRESERVE src0_sel:WORD_1
v_and_b32 v177, s49, v177
v_pk_mul_f16 v155, v155, v154
v_fma_mix_f32 v167, v186, v186, v167 op_sel:[0,0,0] op_sel_hi:[1,1,0]
v_pk_mul_f16 v152, v152, v151
v_lshrrev_b16 v176, 2, v177
v_pk_mul_f16 v149, v149, v148
v_fma_mix_f32 v156, v155, v155, v156 op_sel:[0,0,0] op_sel_hi:[1,1,0]
v_fma_mix_f32 v156, v155, v155, v156 op_sel:[1,1,0] op_sel_hi:[1,1,0]
v_lshrrev_b32 v177, 18, v177
v_fma_mix_f32 v167, v187, v187, v167 op_sel:[1,1,0] op_sel_hi:[1,1,0]
v_fma_mix_f32 v156, v152, v152, v156 op_sel:[0,0,0] op_sel_hi:[1,1,0]
v_fma_mix_f32 v156, v152, v152, v156 op_sel:[1,1,0] op_sel_hi:[1,1,0]
v_fma_mix_f32 v156, v149, v149, v156 op_sel:[0,0,0] op_sel_hi:[1,1,0]
v_fma_mix_f32 v156, v149, v149, v156 op_sel:[1,1,0] op_sel_hi:[1,1,0]
s_setprio 2
v_mfma_f32_32x32x16_bf16 v[0:15], v[232:235], v[232:235], 0
s_add_u32 s46, s80, 14680064
buffer_store_dwordx4 v[76:79], v241, s[32:35], s46 offen sc1
ds_read_b128 v[228:231], v248 offset:32768
ds_read_u16_d16 v176, v176
ds_read_u16_d16_hi v177, v177
v_cvt_pkrtz_f16_f32 v179, v120, v121
v_cvt_pkrtz_f16_f32 v181, v122, v123
v_cvt_pkrtz_f16_f32 v183, v124, v125
v_mfma_f32_32x32x16_bf16 v[16:31], v[232:235], v[232:235], 0
v_cvt_pkrtz_f16_f32 v185, v126, v127
v_cvt_pkrtz_f16_f32 v187, v128, v129
v_cvt_pk_f16_f32 v155, v130, v131
v_cvt_pk_f16_f32 v152, v132, v133
v_mfma_f32_32x32x16_bf16 v[32:47], v[232:235], v[232:235], 0
v_cvt_pk_f16_f32 v149, v134, v135
v_pk_fma_f16 v154, v155, v155, s48
v_and_b32 v179, s49, v179
v_mfma_f32_32x32x16_bf16 v[120:135], v[96:99], v[236:239], 0
ds_read_b128 v[232:235], v248 offset:30720
v_fma_mix_f32 v156, v136, v136, v156 op_sel:[0,0,0] op_sel_hi:[1,1,0]
v_pk_fma_f16 v151, v152, v152, s48
v_pk_fma_f16 v148, v149, v149, s48
v_lshrrev_b16 v178, 2, v179
v_pk_mul_f16 v154, v155, v154
v_pk_mul_f16 v151, v152, v151
v_fma_mix_f32 v156, v137, v137, v156 op_sel:[1,1,0] op_sel_hi:[1,1,0]
s_waitcnt lgkmcnt(4)
v_mfma_f32_32x32x16_bf16 v[120:135], v[100:103], v[216:219], v[120:135]
ds_read_b128 v[236:239], v245 offset:6144
ds_read_b128 v[200:203], v244
ds_read_b128 v[204:207], v243 offset:128
ds_read_u16_d16 v178, v178
v_lshrrev_b32 v179, 18, v179
v_pk_mul_f16 v148, v149, v148
v_exp_f16 v153, v154
v_exp_f16 v150, v151
v_and_b32 v181, s49, v181
v_fma_mix_f32 v156, v138, v138, v156 op_sel:[0,0,0] op_sel_hi:[1,1,0]
v_mfma_f32_32x32x16_bf16 v[120:135], v[104:107], v[220:223], v[120:135]
ds_read_b128 v[216:219], v248 offset:33792
ds_read_u16_d16_hi v179, v179
v_exp_f16 v147, v148
v_lshrrev_b16 v180, 2, v181
v_exp_f16_sdwa v153, v154 dst_sel:WORD_1 dst_unused:UNUSED_PRESERVE src0_sel:WORD_1
v_lshrrev_b32 v181, 18, v181
v_fma_mix_f32 v156, v139, v139, v156 op_sel:[1,1,0] op_sel_hi:[1,1,0]
v_smfmac_f32_16x16x32_bf16 v[40:43], v[226:227], v[192:195], v246
ds_read_b128 v[220:223], v245 offset:5760
ds_read_b128 v[208:211], v243 offset:64
ds_read_b128 v[212:215], v243
ds_read_u16_d16 v180, v180
ds_read_u16_d16_hi v181, v181
v_exp_f16_sdwa v150, v151 dst_sel:WORD_1 dst_unused:UNUSED_PRESERVE src0_sel:WORD_1
v_smfmac_f32_16x16x32_bf16 v[24:27], v[224:225], v[196:199], v246
v_exp_f16_sdwa v147, v148 dst_sel:WORD_1 dst_unused:UNUSED_PRESERVE src0_sel:WORD_1
v_and_b32 v183, s49, v183
v_fma_mix_f32 v156, v140, v140, v156 op_sel:[0,0,0] op_sel_hi:[1,1,0]
v_pk_add_f16 v153, v153, 1.0 op_sel_hi:[1,0]
s_waitcnt lgkmcnt(7)
v_mfma_f32_32x32x16_bf16 v[120:135], v[108:111], v[228:231], v[120:135]
ds_read_b128 v[224:227], v245 offset:5376
ds_read_b128 v[192:195], v242 offset:128
ds_read_b128 v[196:199], v242 offset:64
v_lshrrev_b16 v182, 2, v183
v_pk_add_f16 v150, v150, 1.0 op_sel_hi:[1,0]
v_pk_add_f16 v147, v147, 1.0 op_sel_hi:[1,0]
v_rcp_f16 v154, v153
v_lshrrev_b32 v183, 18, v183
v_fma_mix_f32 v156, v141, v141, v156 op_sel:[1,1,0] op_sel_hi:[1,1,0]
v_mfma_f32_32x32x16_bf16 v[120:135], v[112:115], v[232:235], v[120:135]
ds_read_b128 v[228:231], v248 offset:34816
ds_read_u16_d16 v182, v182
ds_read_u16_d16_hi v183, v183
v_rcp_f16 v151, v150
v_and_b32 v185, s49, v185
v_rcp_f16 v148, v147
v_fma_mix_f32 v156, v142, v142, v156 op_sel:[0,0,0] op_sel_hi:[1,1,0]
v_lshrrev_b16 v184, 2, v185
v_smfmac_f32_16x16x32_bf16 v[8:11], v[238:239], v[200:203], v246
ds_read_b128 v[232:235], v248 offset:37888
ds_read_u16_d16 v184, v184
v_rcp_f16_sdwa v154, v153 dst_sel:WORD_1 dst_unused:UNUSED_PRESERVE src0_sel:WORD_1
v_rcp_f16_sdwa v151, v150 dst_sel:WORD_1 dst_unused:UNUSED_PRESERVE src0_sel:WORD_1
v_smfmac_f32_16x16x32_bf16 v[40:43], v[236:237], v[204:207], v246
v_lshrrev_b32 v185, 18, v185
v_fma_mix_f32 v156, v143, v143, v156 op_sel:[1,1,0] op_sel_hi:[1,1,0]
s_waitcnt lgkmcnt(6)
v_mfma_f32_32x32x16_bf16 v[120:135], v[116:119], v[216:219], v[120:135]
ds_read_b128 v[236:239], v248 offset:35840
ds_read_u16_d16_hi v185, v185
v_rcp_f16_sdwa v148, v147 dst_sel:WORD_1 dst_unused:UNUSED_PRESERVE src0_sel:WORD_1
v_and_b32 v187, s49, v187
v_pk_mul_f16 v155, v155, v154
v_fma_mix_f32 v156, v176, v176, v156 op_sel:[0,0,0] op_sel_hi:[1,1,0]
v_pk_mul_f16 v152, v152, v151
v_lshrrev_b16 v186, 2, v187
v_pk_mul_f16 v149, v149, v148
v_smfmac_f32_16x16x32_bf16 v[24:27], v[222:223], v[208:211], v246
ds_read_b128 v[216:219], v248 offset:38912
ds_read_u16_d16 v186, v186
v_fma_mix_f32 v157, v155, v155, v157 op_sel:[0,0,0] op_sel_hi:[1,1,0]
v_fma_mix_f32 v157, v155, v155, v157 op_sel:[1,1,0] op_sel_hi:[1,1,0]
v_lshrrev_b32 v187, 18, v187
v_fma_mix_f32 v156, v177, v177, v156 op_sel:[1,1,0] op_sel_hi:[1,1,0]
v_smfmac_f32_16x16x32_bf16 v[8:11], v[220:221], v[212:215], v246
v_fma_mix_f32 v157, v152, v152, v157 op_sel:[0,0,0] op_sel_hi:[1,1,0]
v_fma_mix_f32 v157, v152, v152, v157 op_sel:[1,1,0] op_sel_hi:[1,1,0]
v_fma_mix_f32 v157, v149, v149, v157 op_sel:[0,0,0] op_sel_hi:[1,1,0]
v_fma_mix_f32 v157, v149, v149, v157 op_sel:[1,1,0] op_sel_hi:[1,1,0]
s_setprio 1
v_smfmac_f32_16x16x32_bf16 v[40:43], v[226:227], v[192:195], v246
s_waitcnt lgkmcnt(4)
s_add_u32 s46, s80, 16777216
buffer_store_dwordx4 v[80:83], v241, s[32:35], s46 offen sc1
ds_read_b128 v[220:223], v248 offset:36864
ds_read_u16_d16_hi v187, v187
v_cvt_pkrtz_f16_f32 v137, v120, v121
v_cvt_pkrtz_f16_f32 v139, v122, v123
v_cvt_pkrtz_f16_f32 v141, v124, v125
v_cvt_pkrtz_f16_f32 v143, v126, v127
v_cvt_pk_f16_f32 v155, v128, v129
v_smfmac_f32_16x16x32_bf16 v[24:27], v[224:225], v[196:199], v246
v_cvt_pk_f16_f32 v152, v130, v131
v_cvt_pk_f16_f32 v149, v132, v133
v_cvt_pk_f16_f32 v146, v134, v135
v_pk_fma_f16 v154, v155, v155, s48
v_and_b32 v137, s49, v137
v_mfma_f32_32x32x16_bf16 v[120:135], v[96:99], v[228:231], 0
ds_read_b128 v[224:227], v248 offset:39936
v_fma_mix_f32 v157, v178, v178, v157 op_sel:[0,0,0] op_sel_hi:[1,1,0]
v_pk_fma_f16 v151, v152, v152, s48
v_pk_fma_f16 v148, v149, v149, s48
v_pk_fma_f16 v145, v146, v146, s48
v_pk_mul_f16 v154, v155, v154
v_lshrrev_b16 v136, 2, v137
v_pk_mul_f16 v151, v152, v151
v_fma_mix_f32 v157, v179, v179, v157 op_sel:[1,1,0] op_sel_hi:[1,1,0]
v_pk_mul_f16 v148, v149, v148
v_pk_mul_f16 v145, v146, v145
v_mfma_f32_32x32x16_bf16 v[120:135], v[100:103], v[232:235], v[120:135]
ds_read_b128 v[228:231], v245 offset:4992
ds_read_b128 v[200:203], v242
v_xor_b32 v244, 16, v244
ds_read_b128 v[204:207], v244 offset:128
ds_read_u16_d16 v136, v136
v_exp_f16 v153, v154
v_lshrrev_b32 v137, 18, v137
v_exp_f16 v150, v151
v_fma_mix_f32 v157, v180, v180, v157 op_sel:[0,0,0] op_sel_hi:[1,1,0]
v_exp_f16 v147, v148
v_and_b32 v139, s49, v139
v_exp_f16 v144, v145
s_waitcnt lgkmcnt(5)
v_mfma_f32_32x32x16_bf16 v[120:135], v[104:107], v[236:239], v[120:135]
ds_read_b128 v[232:235], v245 offset:4608
ds_read_b128 v[208:211], v244 offset:64
ds_read_b128 v[212:215], v244
ds_read_u16_d16_hi v137, v137
v_exp_f16_sdwa v153, v154 dst_sel:WORD_1 dst_unused:UNUSED_PRESERVE src0_sel:WORD_1
v_fma_mix_f32 v157, v181, v181, v157 op_sel:[1,1,0] op_sel_hi:[1,1,0]
v_lshrrev_b16 v138, 2, v139
v_exp_f16_sdwa v150, v151 dst_sel:WORD_1 dst_unused:UNUSED_PRESERVE src0_sel:WORD_1
v_exp_f16_sdwa v147, v148 dst_sel:WORD_1 dst_unused:UNUSED_PRESERVE src0_sel:WORD_1
v_exp_f16_sdwa v144, v145 dst_sel:WORD_1 dst_unused:UNUSED_PRESERVE src0_sel:WORD_1
v_lshrrev_b32 v139, 18, v139
v_fma_mix_f32 v157, v182, v182, v157 op_sel:[0,0,0] op_sel_hi:[1,1,0]
v_mfma_f32_32x32x16_bf16 v[120:135], v[108:111], v[216:219], v[120:135]
ds_read_b128 v[236:239], v248 offset:40960
ds_read_u16_d16 v138, v138
ds_read_u16_d16_hi v139, v139
v_pk_add_f16 v153, v153, 1.0 op_sel_hi:[1,0]
v_pk_add_f16 v150, v150, 1.0 op_sel_hi:[1,0]
v_pk_add_f16 v147, v147, 1.0 op_sel_hi:[1,0]
v_and_b32 v141, s49, v141
v_pk_add_f16 v144, v144, 1.0 op_sel_hi:[1,0]
v_rcp_f16 v154, v153
v_fma_mix_f32 v157, v183, v183, v157 op_sel:[1,1,0] op_sel_hi:[1,1,0]
v_rcp_f16 v151, v150
v_mfma_f32_32x32x16_bf16 v[120:135], v[112:115], v[220:223], v[120:135]
ds_read_b128 v[216:219], v248 offset:44032
v_lshrrev_b16 v140, 2, v141
v_rcp_f16 v148, v147
v_fma_mix_f32 v157, v184, v184, v157 op_sel:[0,0,0] op_sel_hi:[1,1,0]
v_rcp_f16 v145, v144
v_lshrrev_b32 v141, 18, v141
v_rcp_f16_sdwa v154, v153 dst_sel:WORD_1 dst_unused:UNUSED_PRESERVE src0_sel:WORD_1
s_setprio 0
v_rcp_f16_sdwa v151, v150 dst_sel:WORD_1 dst_unused:UNUSED_PRESERVE src0_sel:WORD_1
s_waitcnt lgkmcnt(4)
v_mfma_f32_32x32x16_bf16 v[120:135], v[116:119], v[224:227], v[120:135]
ds_read_b128 v[220:223], v248 offset:41984
ds_read_u16_d16 v140, v140
ds_read_u16_d16_hi v141, v141
v_fma_mix_f32 v157, v185, v185, v157 op_sel:[1,1,0] op_sel_hi:[1,1,0]
v_and_b32 v143, s49, v143
v_rcp_f16_sdwa v148, v147 dst_sel:WORD_1 dst_unused:UNUSED_PRESERVE src0_sel:WORD_1
v_rcp_f16_sdwa v145, v144 dst_sel:WORD_1 dst_unused:UNUSED_PRESERVE src0_sel:WORD_1
v_pk_mul_f16 v155, v155, v154
v_lshrrev_b16 v142, 2, v143
v_fma_mix_f32 v157, v186, v186, v157 op_sel:[0,0,0] op_sel_hi:[1,1,0]
v_pk_mul_f16 v152, v152, v151
v_pk_mul_f16 v149, v149, v148
v_smfmac_f32_16x16x32_bf16 v[8:11], v[230:231], v[200:203], v246
ds_read_b128 v[224:227], v248 offset:45056
ds_read_u16_d16 v142, v142
v_pk_mul_f16 v146, v146, v145
v_fma_mix_f32 v158, v155, v155, v158 op_sel:[0,0,0] op_sel_hi:[1,1,0]
v_lshrrev_b32 v143, 18, v143
v_fma_mix_f32 v158, v155, v155, v158 op_sel:[1,1,0] op_sel_hi:[1,1,0]
v_fma_mix_f32 v158, v152, v152, v158 op_sel:[0,0,0] op_sel_hi:[1,1,0]
v_smfmac_f32_16x16x32_bf16 v[44:47], v[228:229], v[204:207], v246
v_fma_mix_f32 v157, v187, v187, v157 op_sel:[1,1,0] op_sel_hi:[1,1,0]
v_fma_mix_f32 v158, v152, v152, v158 op_sel:[1,1,0] op_sel_hi:[1,1,0]
v_fma_mix_f32 v158, v149, v149, v158 op_sel:[0,0,0] op_sel_hi:[1,1,0]
v_fma_mix_f32 v158, v149, v149, v158 op_sel:[1,1,0] op_sel_hi:[1,1,0]
v_fma_mix_f32 v158, v146, v146, v158 op_sel:[0,0,0] op_sel_hi:[1,1,0]
v_fma_mix_f32 v158, v146, v146, v158 op_sel:[1,1,0] op_sel_hi:[1,1,0]
s_setprio 2
v_smfmac_f32_16x16x32_bf16 v[28:31], v[234:235], v[208:211], v246
s_add_u32 s46, s80, 18874368
buffer_store_dwordx4 v[84:87], v241, s[32:35], s46 offen sc1
ds_read_b128 v[228:231], v248 offset:43008
ds_read_u16_d16_hi v143, v143
v_cvt_pkrtz_f16_f32 v179, v120, v121
v_cvt_pkrtz_f16_f32 v181, v122, v123
v_cvt_pkrtz_f16_f32 v183, v124, v125
v_cvt_pkrtz_f16_f32 v185, v126, v127
v_smfmac_f32_16x16x32_bf16 v[12:15], v[232:233], v[212:215], v246
v_cvt_pkrtz_f16_f32 v187, v128, v129
v_cvt_pk_f16_f32 v155, v130, v131
v_cvt_pk_f16_f32 v152, v132, v133
v_cvt_pk_f16_f32 v149, v134, v135
v_pk_fma_f16 v154, v155, v155, s48
s_waitcnt lgkmcnt(2)
v_mfma_f32_32x32x16_bf16 v[120:135], v[96:99], v[236:239], 0
ds_read_b128 v[232:235], v248 offset:46080
v_and_b32 v179, s49, v179
v_fma_mix_f32 v158, v136, v136, v158 op_sel:[0,0,0] op_sel_hi:[1,1,0]
v_pk_fma_f16 v151, v152, v152, s48
v_pk_fma_f16 v148, v149, v149, s48
v_lshrrev_b16 v178, 2, v179
v_pk_mul_f16 v154, v155, v154
v_pk_mul_f16 v151, v152, v151
v_pk_mul_f16 v148, v149, v148
v_lshrrev_b32 v179, 18, v179
v_mfma_f32_32x32x16_bf16 v[120:135], v[100:103], v[216:219], v[120:135]
ds_read_b128 v[236:239], v245 offset:4224
v_xor_b32 v243, 16, v243
ds_read_b128 v[192:195], v243 offset:128
ds_read_b128 v[196:199], v243 offset:64
ds_read_u16_d16 v178, v178
ds_read_u16_d16_hi v179, v179
v_fma_mix_f32 v158, v137, v137, v158 op_sel:[1,1,0] op_sel_hi:[1,1,0]
v_exp_f16 v153, v154
v_and_b32 v181, s49, v181
v_exp_f16 v150, v151
v_exp_f16 v147, v148
v_lshrrev_b16 v180, 2, v181
v_mfma_f32_32x32x16_bf16 v[120:135], v[104:107], v[220:223], v[120:135]
ds_read_b128 v[216:219], v245 offset:3840
ds_read_b128 v[200:203], v243
v_xor_b32 v242, 16, v242
ds_read_b128 v[204:207], v242 offset:128
ds_read_u16_d16 v180, v180
v_fma_mix_f32 v158, v138, v138, v158 op_sel:[0,0,0] op_sel_hi:[1,1,0]
v_exp_f16_sdwa v153, v154 dst_sel:WORD_1 dst_unused:UNUSED_PRESERVE src0_sel:WORD_1
v_lshrrev_b32 v181, 18, v181
v_exp_f16_sdwa v150, v151 dst_sel:WORD_1 dst_unused:UNUSED_PRESERVE src0_sel:WORD_1
v_fma_mix_f32 v158, v139, v139, v158 op_sel:[1,1,0] op_sel_hi:[1,1,0]
v_and_b32 v183, s49, v183
v_mfma_f32_32x32x16_bf16 v[120:135], v[108:111], v[224:227], v[120:135]
ds_read_b128 v[220:223], v248 offset:47104
ds_read_u16_d16_hi v181, v181
v_exp_f16_sdwa v147, v148 dst_sel:WORD_1 dst_unused:UNUSED_PRESERVE src0_sel:WORD_1
v_pk_add_f16 v153, v153, 1.0 op_sel_hi:[1,0]
v_lshrrev_b16 v182, 2, v183
v_pk_add_f16 v150, v150, 1.0 op_sel_hi:[1,0]
v_pk_add_f16 v147, v147, 1.0 op_sel_hi:[1,0]
v_rcp_f16 v154, v153
v_lshrrev_b32 v183, 18, v183
v_fma_mix_f32 v158, v140, v140, v158 op_sel:[0,0,0] op_sel_hi:[1,1,0]
s_waitcnt lgkmcnt(6)
v_mfma_f32_32x32x16_bf16 v[120:135], v[112:115], v[228:231], v[120:135]
ds_read_b128 v[224:227], v248 offset:50176
ds_read_u16_d16 v182, v182
ds_read_u16_d16_hi v183, v183
v_rcp_f16 v151, v150
v_and_b32 v185, s49, v185
v_rcp_f16 v148, v147
v_fma_mix_f32 v158, v141, v141, v158 op_sel:[1,1,0] op_sel_hi:[1,1,0]
v_lshrrev_b16 v184, 2, v185
v_rcp_f16_sdwa v154, v153 dst_sel:WORD_1 dst_unused:UNUSED_PRESERVE src0_sel:WORD_1
v_mfma_f32_32x32x16_bf16 v[120:135], v[116:119], v[232:235], v[120:135]
ds_read_b128 v[228:231], v248 offset:48128
ds_read_u16_d16 v184, v184
v_rcp_f16_sdwa v151, v150 dst_sel:WORD_1 dst_unused:UNUSED_PRESERVE src0_sel:WORD_1
v_lshrrev_b32 v185, 18, v185
v_rcp_f16_sdwa v148, v147 dst_sel:WORD_1 dst_unused:UNUSED_PRESERVE src0_sel:WORD_1
v_and_b32 v187, s49, v187
v_fma_mix_f32 v158, v142, v142, v158 op_sel:[0,0,0] op_sel_hi:[1,1,0]
v_pk_mul_f16 v155, v155, v154
v_pk_mul_f16 v152, v152, v151
v_smfmac_f32_16x16x32_bf16 v[44:47], v[238:239], v[192:195], v246
ds_read_b128 v[232:235], v248 offset:51200
ds_read_u16_d16_hi v185, v185
v_lshrrev_b16 v186, 2, v187
v_pk_mul_f16 v149, v149, v148
v_fma_mix_f32 v159, v155, v155, v159 op_sel:[0,0,0] op_sel_hi:[1,1,0]
v_fma_mix_f32 v158, v143, v143, v158 op_sel:[1,1,0] op_sel_hi:[1,1,0]
v_lshrrev_b32 v187, 18, v187
v_smfmac_f32_16x16x32_bf16 v[28:31], v[236:237], v[196:199], v246
v_fma_mix_f32 v159, v155, v155, v159 op_sel:[1,1,0] op_sel_hi:[1,1,0]
v_fma_mix_f32 v159, v152, v152, v159 op_sel:[0,0,0] op_sel_hi:[1,1,0]
v_fma_mix_f32 v159, v152, v152, v159 op_sel:[1,1,0] op_sel_hi:[1,1,0]
v_fma_mix_f32 v159, v149, v149, v159 op_sel:[0,0,0] op_sel_hi:[1,1,0]
v_fma_mix_f32 v159, v149, v149, v159 op_sel:[1,1,0] op_sel_hi:[1,1,0]
s_setprio 1
s_waitcnt lgkmcnt(4)
v_smfmac_f32_16x16x32_bf16 v[12:15], v[218:219], v[200:203], v246
s_add_u32 s46, s80, 20971520
buffer_store_dwordx4 v[88:91], v241, s[32:35], s46 offen sc1
ds_read_b128 v[236:239], v248 offset:49152
ds_read_u16_d16 v186, v186
ds_read_u16_d16_hi v187, v187
v_cvt_pkrtz_f16_f32 v137, v120, v121
v_cvt_pkrtz_f16_f32 v139, v122, v123
v_cvt_pkrtz_f16_f32 v141, v124, v125
v_cvt_pkrtz_f16_f32 v143, v126, v127
v_cvt_pk_f16_f32 v155, v128, v129
v_smfmac_f32_16x16x32_bf16 v[44:47], v[216:217], v[204:207], v246
v_cvt_pk_f16_f32 v152, v130, v131
v_cvt_pk_f16_f32 v149, v132, v133
v_cvt_pk_f16_f32 v146, v134, v135
v_pk_fma_f16 v154, v155, v155, s48
v_and_b32 v137, s49, v137
v_mfma_f32_32x32x16_bf16 v[120:135], v[96:99], v[220:223], 0
ds_read_b128 v[216:219], v248 offset:52224
v_fma_mix_f32 v159, v178, v178, v159 op_sel:[0,0,0] op_sel_hi:[1,1,0]
v_pk_fma_f16 v151, v152, v152, s48
v_pk_fma_f16 v148, v149, v149, s48
v_pk_fma_f16 v145, v146, v146, s48
v_pk_mul_f16 v154, v155, v154
v_lshrrev_b16 v136, 2, v137
v_pk_mul_f16 v151, v152, v151
v_fma_mix_f32 v159, v179, v179, v159 op_sel:[1,1,0] op_sel_hi:[1,1,0]
v_pk_mul_f16 v148, v149, v148
v_pk_mul_f16 v145, v146, v145
v_mfma_f32_32x32x16_bf16 v[120:135], v[100:103], v[224:227], v[120:135]
ds_read_b128 v[220:223], v245 offset:3456
ds_read_b128 v[208:211], v242 offset:64
ds_read_b128 v[212:215], v242
ds_read_u16_d16 v136, v136
v_exp_f16 v153, v154
v_lshrrev_b32 v137, 18, v137
v_exp_f16 v150, v151
v_fma_mix_f32 v159, v180, v180, v159 op_sel:[0,0,0] op_sel_hi:[1,1,0]
v_exp_f16 v147, v148
v_and_b32 v139, s49, v139
v_exp_f16 v144, v145
s_waitcnt lgkmcnt(5)
v_mfma_f32_32x32x16_bf16 v[120:135], v[104:107], v[228:231], v[120:135]
ds_read_b128 v[224:227], v245 offset:3072
v_xor_b32 v244, 32, v244
ds_read_b128 v[192:195], v244 offset:128
ds_read_b128 v[196:199], v244 offset:64
ds_read_u16_d16_hi v137, v137
v_exp_f16_sdwa v153, v154 dst_sel:WORD_1 dst_unused:UNUSED_PRESERVE src0_sel:WORD_1
v_fma_mix_f32 v159, v181, v181, v159 op_sel:[1,1,0] op_sel_hi:[1,1,0]
v_lshrrev_b16 v138, 2, v139
v_exp_f16_sdwa v150, v151 dst_sel:WORD_1 dst_unused:UNUSED_PRESERVE src0_sel:WORD_1
v_exp_f16_sdwa v147, v148 dst_sel:WORD_1 dst_unused:UNUSED_PRESERVE src0_sel:WORD_1
v_exp_f16_sdwa v144, v145 dst_sel:WORD_1 dst_unused:UNUSED_PRESERVE src0_sel:WORD_1
v_lshrrev_b32 v139, 18, v139
v_fma_mix_f32 v159, v182, v182, v159 op_sel:[0,0,0] op_sel_hi:[1,1,0]
v_mfma_f32_32x32x16_bf16 v[120:135], v[108:111], v[232:235], v[120:135]
ds_read_b128 v[228:231], v248 offset:53248
ds_read_u16_d16 v138, v138
ds_read_u16_d16_hi v139, v139
v_pk_add_f16 v153, v153, 1.0 op_sel_hi:[1,0]
v_pk_add_f16 v150, v150, 1.0 op_sel_hi:[1,0]
v_pk_add_f16 v147, v147, 1.0 op_sel_hi:[1,0]
v_and_b32 v141, s49, v141
v_pk_add_f16 v144, v144, 1.0 op_sel_hi:[1,0]
v_rcp_f16 v154, v153
v_fma_mix_f32 v159, v183, v183, v159 op_sel:[1,1,0] op_sel_hi:[1,1,0]
v_rcp_f16 v151, v150
v_mfma_f32_32x32x16_bf16 v[120:135], v[112:115], v[236:239], v[120:135]
ds_read_b128 v[232:235], v248 offset:56320
v_lshrrev_b16 v140, 2, v141
v_rcp_f16 v148, v147
v_fma_mix_f32 v159, v184, v184, v159 op_sel:[0,0,0] op_sel_hi:[1,1,0]
v_rcp_f16 v145, v144
v_lshrrev_b32 v141, 18, v141
v_rcp_f16_sdwa v154, v153 dst_sel:WORD_1 dst_unused:UNUSED_PRESERVE src0_sel:WORD_1
s_setprio 0
v_rcp_f16_sdwa v151, v150 dst_sel:WORD_1 dst_unused:UNUSED_PRESERVE src0_sel:WORD_1
s_waitcnt lgkmcnt(4)
v_mfma_f32_32x32x16_bf16 v[120:135], v[116:119], v[216:219], v[120:135]
ds_read_b128 v[236:239], v248 offset:54272
ds_read_u16_d16 v140, v140
ds_read_u16_d16_hi v141, v141
v_fma_mix_f32 v159, v185, v185, v159 op_sel:[1,1,0] op_sel_hi:[1,1,0]
v_and_b32 v143, s49, v143
v_rcp_f16_sdwa v148, v147 dst_sel:WORD_1 dst_unused:UNUSED_PRESERVE src0_sel:WORD_1
v_rcp_f16_sdwa v145, v144 dst_sel:WORD_1 dst_unused:UNUSED_PRESERVE src0_sel:WORD_1
v_pk_mul_f16 v155, v155, v154
v_lshrrev_b16 v142, 2, v143
v_fma_mix_f32 v159, v186, v186, v159 op_sel:[0,0,0] op_sel_hi:[1,1,0]
v_pk_mul_f16 v152, v152, v151
v_pk_mul_f16 v149, v149, v148
v_smfmac_f32_16x16x32_bf16 v[28:31], v[222:223], v[208:211], v246
ds_read_b128 v[216:219], v248 offset:57344
ds_read_u16_d16 v142, v142
v_pk_mul_f16 v146, v146, v145
v_fma_mix_f32 v160, v155, v155, v160 op_sel:[0,0,0] op_sel_hi:[1,1,0]
v_lshrrev_b32 v143, 18, v143
v_fma_mix_f32 v160, v155, v155, v160 op_sel:[1,1,0] op_sel_hi:[1,1,0]
v_fma_mix_f32 v160, v152, v152, v160 op_sel:[0,0,0] op_sel_hi:[1,1,0]
v_smfmac_f32_16x16x32_bf16 v[12:15], v[220:221], v[212:215], v246
v_fma_mix_f32 v159, v187, v187, v159 op_sel:[1,1,0] op_sel_hi:[1,1,0]
v_fma_mix_f32 v160, v152, v152, v160 op_sel:[1,1,0] op_sel_hi:[1,1,0]
v_fma_mix_f32 v160, v149, v149, v160 op_sel:[0,0,0] op_sel_hi:[1,1,0]
v_fma_mix_f32 v160, v149, v149, v160 op_sel:[1,1,0] op_sel_hi:[1,1,0]
v_fma_mix_f32 v160, v146, v146, v160 op_sel:[0,0,0] op_sel_hi:[1,1,0]
v_fma_mix_f32 v160, v146, v146, v160 op_sel:[1,1,0] op_sel_hi:[1,1,0]
s_setprio 2
v_smfmac_f32_16x16x32_bf16 v[36:39], v[226:227], v[192:195], v246
s_add_u32 s46, s80, 23068672
buffer_store_dwordx4 v[92:95], v241, s[32:35], s46 offen sc1
ds_read_b128 v[220:223], v248 offset:55296
ds_read_u16_d16_hi v143, v143
v_cvt_pkrtz_f16_f32 v179, v120, v121
v_cvt_pkrtz_f16_f32 v181, v122, v123
v_cvt_pkrtz_f16_f32 v183, v124, v125
v_cvt_pkrtz_f16_f32 v185, v126, v127
v_smfmac_f32_16x16x32_bf16 v[20:23], v[224:225], v[196:199], v246
v_cvt_pkrtz_f16_f32 v187, v128, v129
v_cvt_pk_f16_f32 v155, v130, v131
v_cvt_pk_f16_f32 v152, v132, v133
v_cvt_pk_f16_f32 v149, v134, v135
s_waitcnt lgkmcnt(2)
v_mfma_f32_32x32x16_bf16 v[120:135], v[96:99], v[228:231], 0
ds_read_b128 v[224:227], v245 offset:2688
ds_read_b128 v[200:203], v244
v_xor_b32 v243, 32, v243
ds_read_b128 v[204:207], v243 offset:128
v_pk_fma_f16 v154, v155, v155, s48
v_and_b32 v179, s49, v179
v_fma_mix_f32 v160, v136, v136, v160 op_sel:[0,0,0] op_sel_hi:[1,1,0]
v_pk_fma_f16 v151, v152, v152, s48
v_pk_fma_f16 v148, v149, v149, s48
v_lshrrev_b16 v178, 2, v179
v_pk_mul_f16 v154, v155, v154
v_pk_mul_f16 v151, v152, v151
v_mfma_f32_32x32x16_bf16 v[120:135], v[100:103], v[232:235], v[120:135]
ds_read_b128 v[228:231], v248 offset:58368
ds_read_u16_d16 v178, v178
v_pk_mul_f16 v148, v149, v148
v_lshrrev_b32 v179, 18, v179
v_fma_mix_f32 v160, v137, v137, v160 op_sel:[1,1,0] op_sel_hi:[1,1,0]
v_exp_f16 v153, v154
v_and_b32 v181, s49, v181
v_exp_f16 v150, v151
v_mfma_f32_32x32x16_bf16 v[120:135], v[104:107], v[236:239], v[120:135]
ds_read_b128 v[232:235], v245 offset:2304
ds_read_b128 v[208:211], v243 offset:64
ds_read_b128 v[212:215], v243
ds_read_u16_d16_hi v179, v179
v_exp_f16 v147, v148
v_lshrrev_b16 v180, 2, v181
v_fma_mix_f32 v160, v138, v138, v160 op_sel:[0,0,0] op_sel_hi:[1,1,0]
v_exp_f16_sdwa v153, v154 dst_sel:WORD_1 dst_unused:UNUSED_PRESERVE src0_sel:WORD_1
v_lshrrev_b32 v181, 18, v181
v_mfma_f32_32x32x16_bf16 v[120:135], v[108:111], v[216:219], v[120:135]
ds_read_b128 v[236:239], v245 offset:1920
v_xor_b32 v242, 32, v242
ds_read_b128 v[192:195], v242 offset:128
ds_read_b128 v[196:199], v242 offset:64
ds_read_u16_d16 v180, v180
ds_read_u16_d16_hi v181, v181
v_exp_f16_sdwa v150, v151 dst_sel:WORD_1 dst_unused:UNUSED_PRESERVE src0_sel:WORD_1
v_fma_mix_f32 v160, v139, v139, v160 op_sel:[1,1,0] op_sel_hi:[1,1,0]
v_and_b32 v183, s49, v183
v_exp_f16_sdwa v147, v148 dst_sel:WORD_1 dst_unused:UNUSED_PRESERVE src0_sel:WORD_1
v_pk_add_f16 v153, v153, 1.0 op_sel_hi:[1,0]
v_lshrrev_b16 v182, 2, v183
v_pk_add_f16 v150, v150, 1.0 op_sel_hi:[1,0]
s_waitcnt lgkmcnt(9)
v_mfma_f32_32x32x16_bf16 v[120:135], v[112:115], v[220:223], v[120:135]
ds_read_b128 v[216:219], v248 offset:59392
ds_read_u16_d16 v182, v182
v_pk_add_f16 v147, v147, 1.0 op_sel_hi:[1,0]
v_rcp_f16 v154, v153
v_lshrrev_b32 v183, 18, v183
v_fma_mix_f32 v160, v140, v140, v160 op_sel:[0,0,0] op_sel_hi:[1,1,0]
v_rcp_f16 v151, v150
v_and_b32 v185, s49, v185
v_smfmac_f32_16x16x32_bf16 v[4:7], v[226:227], v[200:203], v246
ds_read_b128 v[220:223], v248 offset:62464
ds_read_u16_d16_hi v183, v183
v_rcp_f16 v148, v147
v_fma_mix_f32 v160, v141, v141, v160 op_sel:[1,1,0] op_sel_hi:[1,1,0]
v_lshrrev_b16 v184, 2, v185
v_smfmac_f32_16x16x32_bf16 v[36:39], v[224:225], v[204:207], v246
v_rcp_f16_sdwa v154, v153 dst_sel:WORD_1 dst_unused:UNUSED_PRESERVE src0_sel:WORD_1
v_rcp_f16_sdwa v151, v150 dst_sel:WORD_1 dst_unused:UNUSED_PRESERVE src0_sel:WORD_1
v_mfma_f32_32x32x16_bf16 v[120:135], v[116:119], v[228:231], v[120:135]
ds_read_b128 v[224:227], v248 offset:60416
ds_read_u16_d16 v184, v184
v_lshrrev_b32 v185, 18, v185
v_rcp_f16_sdwa v148, v147 dst_sel:WORD_1 dst_unused:UNUSED_PRESERVE src0_sel:WORD_1
v_and_b32 v187, s49, v187
v_fma_mix_f32 v160, v142, v142, v160 op_sel:[0,0,0] op_sel_hi:[1,1,0]
v_pk_mul_f16 v155, v155, v154
v_pk_mul_f16 v152, v152, v151
v_lshrrev_b16 v186, 2, v187
s_waitcnt lgkmcnt(4)
v_smfmac_f32_16x16x32_bf16 v[20:23], v[234:235], v[208:211], v246
ds_read_b128 v[228:231], v248 offset:63488
ds_read_u16_d16_hi v185, v185
ds_read_u16_d16 v186, v186
v_pk_mul_f16 v149, v149, v148
v_fma_mix_f32 v161, v155, v155, v161 op_sel:[0,0,0] op_sel_hi:[1,1,0]
v_fma_mix_f32 v160, v143, v143, v160 op_sel:[1,1,0] op_sel_hi:[1,1,0]
v_lshrrev_b32 v187, 18, v187
v_smfmac_f32_16x16x32_bf16 v[4:7], v[232:233], v[212:215], v246
v_fma_mix_f32 v161, v155, v155, v161 op_sel:[1,1,0] op_sel_hi:[1,1,0]
v_fma_mix_f32 v161, v152, v152, v161 op_sel:[0,0,0] op_sel_hi:[1,1,0]
v_fma_mix_f32 v161, v152, v152, v161 op_sel:[1,1,0] op_sel_hi:[1,1,0]
v_fma_mix_f32 v161, v149, v149, v161 op_sel:[0,0,0] op_sel_hi:[1,1,0]
v_fma_mix_f32 v161, v149, v149, v161 op_sel:[1,1,0] op_sel_hi:[1,1,0]
s_setprio 1
v_smfmac_f32_16x16x32_bf16 v[36:39], v[238:239], v[192:195], v246
ds_read_b128 v[232:235], v248 offset:61440
ds_read_u16_d16_hi v187, v187
v_cvt_pkrtz_f16_f32 v137, v120, v121
v_cvt_pkrtz_f16_f32 v139, v122, v123
v_cvt_pkrtz_f16_f32 v141, v124, v125
v_cvt_pkrtz_f16_f32 v143, v126, v127
v_cvt_pk_f16_f32 v155, v128, v129
v_smfmac_f32_16x16x32_bf16 v[20:23], v[236:237], v[196:199], v246
v_cvt_pk_f16_f32 v152, v130, v131
v_cvt_pk_f16_f32 v149, v132, v133
v_cvt_pk_f16_f32 v146, v134, v135
v_pk_fma_f16 v154, v155, v155, s48
v_and_b32 v137, s49, v137
v_mfma_f32_32x32x16_bf16 v[120:135], v[96:99], v[216:219], 0
ds_read_b128 v[236:239], v248 offset:64512
v_fma_mix_f32 v161, v178, v178, v161 op_sel:[0,0,0] op_sel_hi:[1,1,0]
v_pk_fma_f16 v151, v152, v152, s48
v_pk_fma_f16 v148, v149, v149, s48
v_pk_fma_f16 v145, v146, v146, s48
v_pk_mul_f16 v154, v155, v154
v_lshrrev_b16 v136, 2, v137
v_pk_mul_f16 v151, v152, v151
v_fma_mix_f32 v161, v179, v179, v161 op_sel:[1,1,0] op_sel_hi:[1,1,0]
v_pk_mul_f16 v148, v149, v148
v_pk_mul_f16 v145, v146, v145
s_waitcnt lgkmcnt(2)
v_mfma_f32_32x32x16_bf16 v[120:135], v[100:103], v[220:223], v[120:135]
ds_read_b128 v[216:219], v245 offset:1536
ds_read_b128 v[200:203], v242
v_xor_b32 v244, 16, v244
ds_read_b128 v[204:207], v244 offset:128
ds_read_u16_d16 v136, v136
v_exp_f16 v153, v154
v_lshrrev_b32 v137, 18, v137
v_exp_f16 v150, v151
v_fma_mix_f32 v161, v180, v180, v161 op_sel:[0,0,0] op_sel_hi:[1,1,0]
v_exp_f16 v147, v148
v_and_b32 v139, s49, v139
v_exp_f16 v144, v145
v_mfma_f32_32x32x16_bf16 v[120:135], v[104:107], v[224:227], v[120:135]
ds_read_b128 v[220:223], v245 offset:1152
ds_read_b128 v[208:211], v244 offset:64
ds_read_b128 v[212:215], v244
ds_read_u16_d16_hi v137, v137
v_exp_f16_sdwa v153, v154 dst_sel:WORD_1 dst_unused:UNUSED_PRESERVE src0_sel:WORD_1
v_fma_mix_f32 v161, v181, v181, v161 op_sel:[1,1,0] op_sel_hi:[1,1,0]
v_lshrrev_b16 v138, 2, v139
v_exp_f16_sdwa v150, v151 dst_sel:WORD_1 dst_unused:UNUSED_PRESERVE src0_sel:WORD_1
v_exp_f16_sdwa v147, v148 dst_sel:WORD_1 dst_unused:UNUSED_PRESERVE src0_sel:WORD_1
v_exp_f16_sdwa v144, v145 dst_sel:WORD_1 dst_unused:UNUSED_PRESERVE src0_sel:WORD_1
v_lshrrev_b32 v139, 18, v139
v_fma_mix_f32 v161, v182, v182, v161 op_sel:[0,0,0] op_sel_hi:[1,1,0]
v_mfma_f32_32x32x16_bf16 v[120:135], v[108:111], v[228:231], v[120:135]
ds_read_b128 v[224:227], v249
ds_read_u16_d16 v138, v138
ds_read_u16_d16_hi v139, v139
v_pk_add_f16 v153, v153, 1.0 op_sel_hi:[1,0]
v_pk_add_f16 v150, v150, 1.0 op_sel_hi:[1,0]
v_pk_add_f16 v147, v147, 1.0 op_sel_hi:[1,0]
v_and_b32 v141, s49, v141
v_pk_add_f16 v144, v144, 1.0 op_sel_hi:[1,0]
v_rcp_f16 v154, v153
v_fma_mix_f32 v161, v183, v183, v161 op_sel:[1,1,0] op_sel_hi:[1,1,0]
v_rcp_f16 v151, v150
v_mfma_f32_32x32x16_bf16 v[120:135], v[112:115], v[232:235], v[120:135]
ds_read_b128 v[228:231], v249 offset:3072
v_lshrrev_b16 v140, 2, v141
v_rcp_f16 v148, v147
v_fma_mix_f32 v161, v184, v184, v161 op_sel:[0,0,0] op_sel_hi:[1,1,0]
v_rcp_f16 v145, v144
v_lshrrev_b32 v141, 18, v141
v_rcp_f16_sdwa v154, v153 dst_sel:WORD_1 dst_unused:UNUSED_PRESERVE src0_sel:WORD_1
s_setprio 0
v_rcp_f16_sdwa v151, v150 dst_sel:WORD_1 dst_unused:UNUSED_PRESERVE src0_sel:WORD_1
s_waitcnt lgkmcnt(4)
v_mfma_f32_32x32x16_bf16 v[120:135], v[116:119], v[236:239], v[120:135]
ds_read_b128 v[232:235], v249 offset:1024
ds_read_u16_d16 v140, v140
ds_read_u16_d16_hi v141, v141
v_fma_mix_f32 v161, v185, v185, v161 op_sel:[1,1,0] op_sel_hi:[1,1,0]
v_and_b32 v143, s49, v143
v_rcp_f16_sdwa v148, v147 dst_sel:WORD_1 dst_unused:UNUSED_PRESERVE src0_sel:WORD_1
v_rcp_f16_sdwa v145, v144 dst_sel:WORD_1 dst_unused:UNUSED_PRESERVE src0_sel:WORD_1
v_pk_mul_f16 v155, v155, v154
v_lshrrev_b16 v142, 2, v143
v_fma_mix_f32 v161, v186, v186, v161 op_sel:[0,0,0] op_sel_hi:[1,1,0]
v_pk_mul_f16 v152, v152, v151
v_pk_mul_f16 v149, v149, v148
v_smfmac_f32_16x16x32_bf16 v[4:7], v[218:219], v[200:203], v246
ds_read_b128 v[236:239], v249 offset:4096
ds_read_u16_d16 v142, v142
v_pk_mul_f16 v146, v146, v145
v_fma_mix_f32 v162, v155, v155, v162 op_sel:[0,0,0] op_sel_hi:[1,1,0]
v_lshrrev_b32 v143, 18, v143
v_fma_mix_f32 v162, v155, v155, v162 op_sel:[1,1,0] op_sel_hi:[1,1,0]
v_fma_mix_f32 v162, v152, v152, v162 op_sel:[0,0,0] op_sel_hi:[1,1,0]
v_smfmac_f32_16x16x32_bf16 v[32:35], v[216:217], v[204:207], v246
v_fma_mix_f32 v161, v187, v187, v161 op_sel:[1,1,0] op_sel_hi:[1,1,0]
v_fma_mix_f32 v162, v152, v152, v162 op_sel:[1,1,0] op_sel_hi:[1,1,0]
v_fma_mix_f32 v162, v149, v149, v162 op_sel:[0,0,0] op_sel_hi:[1,1,0]
v_fma_mix_f32 v162, v149, v149, v162 op_sel:[1,1,0] op_sel_hi:[1,1,0]
v_fma_mix_f32 v162, v146, v146, v162 op_sel:[0,0,0] op_sel_hi:[1,1,0]
v_fma_mix_f32 v162, v146, v146, v162 op_sel:[1,1,0] op_sel_hi:[1,1,0]
s_setprio 2
v_smfmac_f32_16x16x32_bf16 v[16:19], v[222:223], v[208:211], v246
ds_read_b128 v[216:219], v249 offset:2048
ds_read_u16_d16_hi v143, v143
v_cvt_pkrtz_f16_f32 v179, v120, v121
v_cvt_pkrtz_f16_f32 v181, v122, v123
v_cvt_pkrtz_f16_f32 v183, v124, v125
v_cvt_pkrtz_f16_f32 v185, v126, v127
v_smfmac_f32_16x16x32_bf16 v[0:3], v[220:221], v[212:215], v246
v_cvt_pkrtz_f16_f32 v187, v128, v129
v_cvt_pk_f16_f32 v155, v130, v131
v_cvt_pk_f16_f32 v152, v132, v133
v_cvt_pk_f16_f32 v149, v134, v135
v_pk_fma_f16 v154, v155, v155, s48
s_waitcnt lgkmcnt(2)
v_mfma_f32_32x32x16_bf16 v[120:135], v[96:99], v[224:227], 0
ds_read_b128 v[220:223], v249 offset:5120
v_and_b32 v179, s49, v179
v_fma_mix_f32 v162, v136, v136, v162 op_sel:[0,0,0] op_sel_hi:[1,1,0]
v_pk_fma_f16 v151, v152, v152, s48
v_pk_fma_f16 v148, v149, v149, s48
v_lshrrev_b16 v178, 2, v179
v_pk_mul_f16 v154, v155, v154
v_pk_mul_f16 v151, v152, v151
v_pk_mul_f16 v148, v149, v148
v_lshrrev_b32 v179, 18, v179
v_mfma_f32_32x32x16_bf16 v[120:135], v[100:103], v[228:231], v[120:135]
ds_read_b128 v[224:227], v245 offset:768
v_xor_b32 v243, 16, v243
ds_read_b128 v[192:195], v243 offset:128
ds_read_b128 v[196:199], v243 offset:64
ds_read_u16_d16 v178, v178
ds_read_u16_d16_hi v179, v179
v_fma_mix_f32 v162, v137, v137, v162 op_sel:[1,1,0] op_sel_hi:[1,1,0]
v_exp_f16 v153, v154
v_and_b32 v181, s49, v181
v_exp_f16 v150, v151
v_exp_f16 v147, v148
v_lshrrev_b16 v180, 2, v181
v_mfma_f32_32x32x16_bf16 v[120:135], v[104:107], v[232:235], v[120:135]
ds_read_b128 v[228:231], v245 offset:384
ds_read_b128 v[200:203], v243
v_xor_b32 v242, 16, v242
ds_read_b128 v[204:207], v242 offset:128
ds_read_u16_d16 v180, v180
v_fma_mix_f32 v162, v138, v138, v162 op_sel:[0,0,0] op_sel_hi:[1,1,0]
v_exp_f16_sdwa v153, v154 dst_sel:WORD_1 dst_unused:UNUSED_PRESERVE src0_sel:WORD_1
v_lshrrev_b32 v181, 18, v181
v_exp_f16_sdwa v150, v151 dst_sel:WORD_1 dst_unused:UNUSED_PRESERVE src0_sel:WORD_1
v_fma_mix_f32 v162, v139, v139, v162 op_sel:[1,1,0] op_sel_hi:[1,1,0]
v_and_b32 v183, s49, v183
v_mfma_f32_32x32x16_bf16 v[120:135], v[108:111], v[236:239], v[120:135]
ds_read_b128 v[232:235], v249 offset:6144
ds_read_u16_d16_hi v181, v181
v_exp_f16_sdwa v147, v148 dst_sel:WORD_1 dst_unused:UNUSED_PRESERVE src0_sel:WORD_1
v_pk_add_f16 v153, v153, 1.0 op_sel_hi:[1,0]
v_lshrrev_b16 v182, 2, v183
v_pk_add_f16 v150, v150, 1.0 op_sel_hi:[1,0]
v_pk_add_f16 v147, v147, 1.0 op_sel_hi:[1,0]
v_rcp_f16 v154, v153
v_lshrrev_b32 v183, 18, v183
v_fma_mix_f32 v162, v140, v140, v162 op_sel:[0,0,0] op_sel_hi:[1,1,0]
s_waitcnt lgkmcnt(6)
v_mfma_f32_32x32x16_bf16 v[120:135], v[112:115], v[216:219], v[120:135]
ds_read_b128 v[236:239], v249 offset:9216
ds_read_u16_d16 v182, v182
ds_read_u16_d16_hi v183, v183
v_rcp_f16 v151, v150
v_and_b32 v185, s49, v185
v_rcp_f16 v148, v147
v_fma_mix_f32 v162, v141, v141, v162 op_sel:[1,1,0] op_sel_hi:[1,1,0]
v_lshrrev_b16 v184, 2, v185
v_rcp_f16_sdwa v154, v153 dst_sel:WORD_1 dst_unused:UNUSED_PRESERVE src0_sel:WORD_1
v_mfma_f32_32x32x16_bf16 v[120:135], v[116:119], v[220:223], v[120:135]
ds_read_b128 v[216:219], v249 offset:7168
ds_read_u16_d16 v184, v184
v_rcp_f16_sdwa v151, v150 dst_sel:WORD_1 dst_unused:UNUSED_PRESERVE src0_sel:WORD_1
v_lshrrev_b32 v185, 18, v185
v_rcp_f16_sdwa v148, v147 dst_sel:WORD_1 dst_unused:UNUSED_PRESERVE src0_sel:WORD_1
v_and_b32 v187, s49, v187
v_fma_mix_f32 v162, v142, v142, v162 op_sel:[0,0,0] op_sel_hi:[1,1,0]
v_pk_mul_f16 v155, v155, v154
v_pk_mul_f16 v152, v152, v151
v_smfmac_f32_16x16x32_bf16 v[32:35], v[226:227], v[192:195], v246
ds_read_b128 v[220:223], v249 offset:10240
ds_read_u16_d16_hi v185, v185
v_lshrrev_b16 v186, 2, v187
v_pk_mul_f16 v149, v149, v148
v_fma_mix_f32 v163, v155, v155, v163 op_sel:[0,0,0] op_sel_hi:[1,1,0]
v_fma_mix_f32 v162, v143, v143, v162 op_sel:[1,1,0] op_sel_hi:[1,1,0]
v_lshrrev_b32 v187, 18, v187
v_smfmac_f32_16x16x32_bf16 v[16:19], v[224:225], v[196:199], v246
v_fma_mix_f32 v163, v155, v155, v163 op_sel:[1,1,0] op_sel_hi:[1,1,0]
v_fma_mix_f32 v163, v152, v152, v163 op_sel:[0,0,0] op_sel_hi:[1,1,0]
v_fma_mix_f32 v163, v152, v152, v163 op_sel:[1,1,0] op_sel_hi:[1,1,0]
v_fma_mix_f32 v163, v149, v149, v163 op_sel:[0,0,0] op_sel_hi:[1,1,0]
v_fma_mix_f32 v163, v149, v149, v163 op_sel:[1,1,0] op_sel_hi:[1,1,0]
s_setprio 1
s_waitcnt lgkmcnt(4)
v_smfmac_f32_16x16x32_bf16 v[0:3], v[230:231], v[200:203], v246
ds_read_b128 v[224:227], v249 offset:8192
ds_read_u16_d16 v186, v186
ds_read_u16_d16_hi v187, v187
v_cvt_pkrtz_f16_f32 v137, v120, v121
v_cvt_pkrtz_f16_f32 v139, v122, v123
v_cvt_pkrtz_f16_f32 v141, v124, v125
v_cvt_pkrtz_f16_f32 v143, v126, v127
v_smfmac_f32_16x16x32_bf16 v[32:35], v[228:229], v[204:207], v246
v_cvt_pk_f16_f32 v155, v128, v129
v_cvt_pk_f16_f32 v152, v130, v131
v_cvt_pk_f16_f32 v149, v132, v133
v_cvt_pk_f16_f32 v146, v134, v135
v_pk_fma_f16 v154, v155, v155, s48
v_mfma_f32_32x32x16_bf16 v[120:135], v[96:99], v[232:235], 0
ds_read_b128 v[228:231], v249 offset:11264
v_and_b32 v137, s49, v137
v_fma_mix_f32 v163, v178, v178, v163 op_sel:[0,0,0] op_sel_hi:[1,1,0]
v_pk_fma_f16 v151, v152, v152, s48
v_pk_fma_f16 v148, v149, v149, s48
v_pk_fma_f16 v145, v146, v146, s48
v_pk_mul_f16 v154, v155, v154
v_lshrrev_b16 v136, 2, v137
v_pk_mul_f16 v151, v152, v151
v_fma_mix_f32 v163, v179, v179, v163 op_sel:[1,1,0] op_sel_hi:[1,1,0]
v_pk_mul_f16 v148, v149, v148
v_mfma_f32_32x32x16_bf16 v[120:135], v[100:103], v[236:239], v[120:135]
ds_read_b128 v[232:235], v245
ds_read_b128 v[208:211], v242 offset:64
ds_read_b128 v[212:215], v242
ds_read_u16_d16 v136, v136
v_pk_mul_f16 v145, v146, v145
v_exp_f16 v153, v154
v_lshrrev_b32 v137, 18, v137
v_exp_f16 v150, v151
v_fma_mix_f32 v163, v180, v180, v163 op_sel:[0,0,0] op_sel_hi:[1,1,0]
v_exp_f16 v147, v148
v_and_b32 v139, s49, v139
s_waitcnt lgkmcnt(5)
v_mfma_f32_32x32x16_bf16 v[120:135], v[104:107], v[216:219], v[120:135]
ds_read_b128 v[236:239], v249 offset:12288
ds_read_u16_d16_hi v137, v137
v_exp_f16 v144, v145
v_exp_f16_sdwa v153, v154 dst_sel:WORD_1 dst_unused:UNUSED_PRESERVE src0_sel:WORD_1
v_fma_mix_f32 v163, v181, v181, v163 op_sel:[1,1,0] op_sel_hi:[1,1,0]
v_lshrrev_b16 v138, 2, v139
v_exp_f16_sdwa v150, v151 dst_sel:WORD_1 dst_unused:UNUSED_PRESERVE src0_sel:WORD_1
v_exp_f16_sdwa v147, v148 dst_sel:WORD_1 dst_unused:UNUSED_PRESERVE src0_sel:WORD_1
v_mfma_f32_32x32x16_bf16 v[120:135], v[108:111], v[220:223], v[120:135]
ds_read_b128 v[216:219], v249 offset:15360
ds_read_u16_d16 v138, v138
v_exp_f16_sdwa v144, v145 dst_sel:WORD_1 dst_unused:UNUSED_PRESERVE src0_sel:WORD_1
v_lshrrev_b32 v139, 18, v139
v_fma_mix_f32 v163, v182, v182, v163 op_sel:[0,0,0] op_sel_hi:[1,1,0]
v_pk_add_f16 v153, v153, 1.0 op_sel_hi:[1,0]
v_pk_add_f16 v150, v150, 1.0 op_sel_hi:[1,0]
v_pk_add_f16 v147, v147, 1.0 op_sel_hi:[1,0]
v_and_b32 v141, s49, v141
v_pk_add_f16 v144, v144, 1.0 op_sel_hi:[1,0]
v_mfma_f32_32x32x16_bf16 v[120:135], v[112:115], v[224:227], v[120:135]
ds_read_b128 v[220:223], v249 offset:13312
ds_read_u16_d16_hi v139, v139
v_rcp_f16 v154, v153
v_fma_mix_f32 v163, v183, v183, v163 op_sel:[1,1,0] op_sel_hi:[1,1,0]
v_rcp_f16 v151, v150
v_lshrrev_b16 v140, 2, v141
v_rcp_f16 v148, v147
v_fma_mix_f32 v163, v184, v184, v163 op_sel:[0,0,0] op_sel_hi:[1,1,0]
s_waitcnt lgkmcnt(4)
v_mfma_f32_32x32x16_bf16 v[120:135], v[116:119], v[228:231], v[120:135]
ds_read_b128 v[224:227], v249 offset:16384
ds_read_u16_d16 v140, v140
v_rcp_f16 v145, v144
v_lshrrev_b32 v141, 18, v141
v_rcp_f16_sdwa v154, v153 dst_sel:WORD_1 dst_unused:UNUSED_PRESERVE src0_sel:WORD_1
s_setprio 0
v_rcp_f16_sdwa v151, v150 dst_sel:WORD_1 dst_unused:UNUSED_PRESERVE src0_sel:WORD_1
v_fma_mix_f32 v163, v185, v185, v163 op_sel:[1,1,0] op_sel_hi:[1,1,0]
v_and_b32 v143, s49, v143
v_rcp_f16_sdwa v148, v147 dst_sel:WORD_1 dst_unused:UNUSED_PRESERVE src0_sel:WORD_1
v_smfmac_f32_16x16x32_bf16 v[16:19], v[234:235], v[208:211], v246
ds_read_b128 v[228:231], v249 offset:14336
ds_read_u16_d16_hi v141, v141
v_rcp_f16_sdwa v145, v144 dst_sel:WORD_1 dst_unused:UNUSED_PRESERVE src0_sel:WORD_1
v_pk_mul_f16 v155, v155, v154
v_lshrrev_b16 v142, 2, v143
v_fma_mix_f32 v163, v186, v186, v163 op_sel:[0,0,0] op_sel_hi:[1,1,0]
v_smfmac_f32_16x16x32_bf16 v[0:3], v[232:233], v[212:215], v246
s_mov_b64 exec, 1
ds_add_u32 v253, v254 offset:16
s_mov_b64 exec, -1
v_pk_mul_f16 v152, v152, v151
v_pk_mul_f16 v149, v149, v148
v_pk_mul_f16 v146, v146, v145
v_fma_mix_f32 v164, v155, v155, v164 op_sel:[0,0,0] op_sel_hi:[1,1,0]
v_lshrrev_b32 v143, 18, v143
v_fma_mix_f32 v164, v155, v155, v164 op_sel:[1,1,0] op_sel_hi:[1,1,0]
v_fma_mix_f32 v164, v152, v152, v164 op_sel:[0,0,0] op_sel_hi:[1,1,0]
v_fma_mix_f32 v163, v187, v187, v163 op_sel:[1,1,0] op_sel_hi:[1,1,0]
v_fma_mix_f32 v164, v152, v152, v164 op_sel:[1,1,0] op_sel_hi:[1,1,0]
v_fma_mix_f32 v164, v149, v149, v164 op_sel:[0,0,0] op_sel_hi:[1,1,0]
v_fma_mix_f32 v164, v149, v149, v164 op_sel:[1,1,0] op_sel_hi:[1,1,0]
v_fma_mix_f32 v164, v146, v146, v164 op_sel:[0,0,0] op_sel_hi:[1,1,0]
v_fma_mix_f32 v164, v146, v146, v164 op_sel:[1,1,0] op_sel_hi:[1,1,0]
s_setprio 3
v_pk_add_f32 v[168:169], v[0:1], v[2:3]
v_pk_mul_f32 v[170:171], v[0:1], v[0:1]
v_pk_fma_f32 v[170:171], v[2:3], v[2:3], v[170:171]
v_pk_add_f32 v[168:169], v[168:169], v[4:5]
v_pk_fma_f32 v[170:171], v[4:5], v[4:5], v[170:171]
v_pk_add_f32 v[168:169], v[168:169], v[6:7]
v_pk_fma_f32 v[170:171], v[6:7], v[6:7], v[170:171]
v_pk_add_f32 v[168:169], v[168:169], v[8:9]
v_pk_fma_f32 v[170:171], v[8:9], v[8:9], v[170:171]
v_pk_add_f32 v[168:169], v[168:169], v[10:11]
v_pk_fma_f32 v[170:171], v[10:11], v[10:11], v[170:171]
v_pk_add_f32 v[168:169], v[168:169], v[12:13]
v_pk_fma_f32 v[170:171], v[12:13], v[12:13], v[170:171]
v_pk_add_f32 v[168:169], v[168:169], v[14:15]
v_pk_fma_f32 v[170:171], v[14:15], v[14:15], v[170:171]
v_pk_add_f32 v[168:169], v[168:169], v[16:17]
v_pk_fma_f32 v[170:171], v[16:17], v[16:17], v[170:171]
v_pk_add_f32 v[168:169], v[168:169], v[18:19]
v_pk_fma_f32 v[170:171], v[18:19], v[18:19], v[170:171]
v_pk_add_f32 v[168:169], v[168:169], v[20:21]
v_pk_fma_f32 v[170:171], v[20:21], v[20:21], v[170:171]
v_pk_add_f32 v[168:169], v[168:169], v[22:23]
v_pk_fma_f32 v[170:171], v[22:23], v[22:23], v[170:171]
v_pk_add_f32 v[168:169], v[168:169], v[24:25]
v_pk_fma_f32 v[170:171], v[24:25], v[24:25], v[170:171]
v_pk_add_f32 v[168:169], v[168:169], v[26:27]
v_pk_fma_f32 v[170:171], v[26:27], v[26:27], v[170:171]
v_pk_add_f32 v[168:169], v[168:169], v[28:29]
v_pk_fma_f32 v[170:171], v[28:29], v[28:29], v[170:171]
v_pk_add_f32 v[168:169], v[168:169], v[30:31]
v_pk_fma_f32 v[170:171], v[30:31], v[30:31], v[170:171]
v_pk_add_f32 v[168:169], v[168:169], v[32:33]
v_pk_fma_f32 v[170:171], v[32:33], v[32:33], v[170:171]
v_pk_add_f32 v[168:169], v[168:169], v[34:35]
v_pk_fma_f32 v[170:171], v[34:35], v[34:35], v[170:171]
v_pk_add_f32 v[168:169], v[168:169], v[36:37]
v_pk_fma_f32 v[170:171], v[36:37], v[36:37], v[170:171]
v_pk_add_f32 v[168:169], v[168:169], v[38:39]
v_pk_fma_f32 v[170:171], v[38:39], v[38:39], v[170:171]
v_pk_add_f32 v[168:169], v[168:169], v[40:41]
v_pk_fma_f32 v[170:171], v[40:41], v[40:41], v[170:171]
v_pk_add_f32 v[168:169], v[168:169], v[42:43]
v_pk_fma_f32 v[170:171], v[42:43], v[42:43], v[170:171]
v_pk_add_f32 v[168:169], v[168:169], v[44:45]
v_pk_fma_f32 v[170:171], v[44:45], v[44:45], v[170:171]
v_pk_add_f32 v[168:169], v[168:169], v[46:47]
v_pk_fma_f32 v[170:171], v[46:47], v[46:47], v[170:171]
s_setprio 0
v_lshrrev_b32 v252, 2, v251
v_mul_u32_u24 v252, 192, v252
v_and_b32 v240, 3, v251
v_lshl_add_u32 v252, v240, 4, v252
s_setprio 2
v_cvt_pkrtz_f16_f32 v179, v120, v121
v_cvt_pkrtz_f16_f32 v181, v122, v123
v_cvt_pkrtz_f16_f32 v183, v124, v125
v_cvt_pkrtz_f16_f32 v185, v126, v127
v_cvt_pkrtz_f16_f32 v187, v128, v129
v_cvt_pkrtz_f16_f32 v189, v130, v131
v_cvt_pk_f16_f32 v155, v132, v133
v_cvt_pk_f16_f32 v152, v134, v135
ds_read_b128 v[232:235], v249 offset:17408
ds_read_u16_d16 v142, v142
ds_read_u16_d16_hi v143, v143
v_mfma_f32_32x32x16_bf16 v[120:135], v[96:99], v[236:239], 0
v_pk_fma_f16 v154, v155, v155, s48
v_add_f32 v168, v168, v169
v_and_b32 v179, s49, v179
v_fma_mix_f32 v164, v136, v136, v164 op_sel:[0,0,0] op_sel_hi:[1,1,0]
v_lshrrev_b16 v178, 2, v179
v_pk_fma_f16 v151, v152, v152, s48
v_add_f32 v170, v170, v171
v_pk_mul_f16 v154, v155, v154
v_lshrrev_b32 v179, 18, v179
v_pk_mul_f16 v151, v152, v151
v_fma_mix_f32 v164, v137, v137, v164 op_sel:[1,1,0] op_sel_hi:[1,1,0]
v_and_b32 v181, s49, v181
s_waitcnt lgkmcnt(4)
ds_read_u16_d16 v178, v178
ds_read_u16_d16_hi v179, v179
v_mfma_f32_32x32x16_bf16 v[120:135], v[100:103], v[216:219], v[120:135]
v_permlane32_swap_b32 v168, v170
v_exp_f16 v153, v154
v_lshrrev_b16 v180, 2, v181
v_exp_f16 v150, v151
v_add_f32 v168, v168, v170
v_lshrrev_b32 v181, 18, v181
v_fma_mix_f32 v164, v138, v138, v164 op_sel:[0,0,0] op_sel_hi:[1,1,0]
v_and_b32 v183, s49, v183
v_exp_f16_sdwa v153, v154 dst_sel:WORD_1 dst_unused:UNUSED_PRESERVE src0_sel:WORD_1
ds_read_u16_d16 v180, v180
ds_read_u16_d16_hi v181, v181
v_mfma_f32_32x32x16_bf16 v[120:135], v[104:107], v[220:223], v[120:135]
v_mul_f32 v168, 1009429163, v168
v_lshrrev_b16 v182, 2, v183
v_fma_mix_f32 v164, v139, v139, v164 op_sel:[1,1,0] op_sel_hi:[1,1,0]
v_exp_f16_sdwa v150, v151 dst_sel:WORD_1 dst_unused:UNUSED_PRESERVE src0_sel:WORD_1
v_mov_b32 v170, v168
v_lshrrev_b32 v183, 18, v183
v_pk_add_f16 v153, v153, 1.0 op_sel_hi:[1,0]
v_and_b32 v185, s49, v185
v_fma_mix_f32 v164, v140, v140, v164 op_sel:[0,0,0] op_sel_hi:[1,1,0]
v_lshrrev_b16 v184, 2, v185
v_permlane32_swap_b32 v168, v170
v_pk_add_f16 v150, v150, 1.0 op_sel_hi:[1,0]
ds_read_u16_d16 v182, v182
ds_read_u16_d16_hi v183, v183
ds_read_u16_d16 v184, v184
v_mfma_f32_32x32x16_bf16 v[120:135], v[108:111], v[224:227], v[120:135]
v_rcp_f16 v154, v153
v_lshrrev_b32 v185, 18, v185
v_fma_mix_f32 v164, v141, v141, v164 op_sel:[1,1,0] op_sel_hi:[1,1,0]
v_fma_f32 v170, -v168, v168, v170
v_and_b32 v187, s49, v187
v_rcp_f16 v151, v150
v_lshrrev_b16 v186, 2, v187
v_max_f32 v170, 0, v170
v_rcp_f16_sdwa v154, v153 dst_sel:WORD_1 dst_unused:UNUSED_PRESERVE src0_sel:WORD_1
ds_read_b128 v[224:227], v249 offset:18432
ds_read_u16_d16_hi v185, v185
ds_read_u16_d16 v186, v186
v_mfma_f32_32x32x16_bf16 v[120:135], v[112:115], v[228:231], v[120:135]
v_lshrrev_b32 v187, 18, v187
s_waitcnt lgkmcnt(6)
v_fma_mix_f32 v164, v142, v142, v164 op_sel:[0,0,0] op_sel_hi:[1,1,0]
v_and_b32 v189, s49, v189
v_add_f32 v170, 925353388, v170
v_rcp_f16_sdwa v151, v150 dst_sel:WORD_1 dst_unused:UNUSED_PRESERVE src0_sel:WORD_1
v_lshrrev_b16 v188, 2, v189
v_fma_mix_f32 v164, v143, v143, v164 op_sel:[1,1,0] op_sel_hi:[1,1,0]
v_pk_mul_f16 v155, v155, v154
v_rsq_f32 v170, v170
v_lshrrev_b32 v189, 18, v189
ds_read_b128 v[228:231], v249 offset:21504
ds_read_u16_d16_hi v187, v187
ds_read_b32 v247, v253 offset:16
ds_read_u16_d16 v188, v188
ds_read_u16_d16_hi v189, v189
v_mfma_f32_32x32x16_bf16 v[120:135], v[116:119], v[232:235], v[120:135]
v_pk_mul_f16 v152, v152, v151
v_fma_mix_f32 v165, v155, v155, v165 op_sel:[0,0,0] op_sel_hi:[1,1,0]
v_fma_mix_f32 v165, v178, v178, v165 op_sel:[0,0,0] op_sel_hi:[1,1,0]
v_fma_mix_f32 v165, v179, v179, v165 op_sel:[1,1,0] op_sel_hi:[1,1,0]
v_fma_mix_f32 v165, v180, v180, v165 op_sel:[0,0,0] op_sel_hi:[1,1,0]
v_fma_mix_f32 v165, v155, v155, v165 op_sel:[1,1,0] op_sel_hi:[1,1,0]
v_fma_mix_f32 v165, v181, v181, v165 op_sel:[1,1,0] op_sel_hi:[1,1,0]
s_waitcnt lgkmcnt(5)
v_fma_mix_f32 v165, v182, v182, v165 op_sel:[0,0,0] op_sel_hi:[1,1,0]
v_mul_f32 v172, 3203391086, v170
v_fma_mix_f32 v165, v183, v183, v165 op_sel:[1,1,0] op_sel_hi:[1,1,0]
v_fma_mix_f32 v165, v152, v152, v165 op_sel:[0,0,0] op_sel_hi:[1,1,0]
v_fma_mix_f32 v165, v184, v184, v165 op_sel:[0,0,0] op_sel_hi:[1,1,0]
v_fma_mix_f32 v165, v185, v185, v165 op_sel:[1,1,0] op_sel_hi:[1,1,0]
v_fma_mix_f32 v165, v186, v186, v165 op_sel:[0,0,0] op_sel_hi:[1,1,0]
v_mul_f32 v173, v168, v172
v_fma_mix_f32 v165, v152, v152, v165 op_sel:[1,1,0] op_sel_hi:[1,1,0]
s_waitcnt lgkmcnt(3)
v_fma_mix_f32 v165, v187, v187, v165 op_sel:[1,1,0] op_sel_hi:[1,1,0]
s_waitcnt lgkmcnt(1)
v_fma_mix_f32 v165, v188, v188, v165 op_sel:[0,0,0] op_sel_hi:[1,1,0]
s_waitcnt lgkmcnt(0)
v_fma_mix_f32 v165, v189, v189, v165 op_sel:[1,1,0] op_sel_hi:[1,1,0]
s_setprio 3
v_pk_fma_f32 v[0:1], v[0:1], v[172:173], v[172:173] op_sel:[0,0,1] op_sel_hi:[1,0,1] neg_lo:[0,0,1] neg_hi:[0,0,1]
v_pk_fma_f32 v[2:3], v[2:3], v[172:173], v[172:173] op_sel:[0,0,1] op_sel_hi:[1,0,1] neg_lo:[0,0,1] neg_hi:[0,0,1]
v_pk_fma_f32 v[4:5], v[4:5], v[172:173], v[172:173] op_sel:[0,0,1] op_sel_hi:[1,0,1] neg_lo:[0,0,1] neg_hi:[0,0,1]
v_pk_fma_f32 v[6:7], v[6:7], v[172:173], v[172:173] op_sel:[0,0,1] op_sel_hi:[1,0,1] neg_lo:[0,0,1] neg_hi:[0,0,1]
v_pk_fma_f32 v[8:9], v[8:9], v[172:173], v[172:173] op_sel:[0,0,1] op_sel_hi:[1,0,1] neg_lo:[0,0,1] neg_hi:[0,0,1]
v_pk_fma_f32 v[10:11], v[10:11], v[172:173], v[172:173] op_sel:[0,0,1] op_sel_hi:[1,0,1] neg_lo:[0,0,1] neg_hi:[0,0,1]
v_pk_fma_f32 v[12:13], v[12:13], v[172:173], v[172:173] op_sel:[0,0,1] op_sel_hi:[1,0,1] neg_lo:[0,0,1] neg_hi:[0,0,1]
v_pk_fma_f32 v[14:15], v[14:15], v[172:173], v[172:173] op_sel:[0,0,1] op_sel_hi:[1,0,1] neg_lo:[0,0,1] neg_hi:[0,0,1]
v_pk_fma_f32 v[16:17], v[16:17], v[172:173], v[172:173] op_sel:[0,0,1] op_sel_hi:[1,0,1] neg_lo:[0,0,1] neg_hi:[0,0,1]
v_pk_fma_f32 v[18:19], v[18:19], v[172:173], v[172:173] op_sel:[0,0,1] op_sel_hi:[1,0,1] neg_lo:[0,0,1] neg_hi:[0,0,1]
v_pk_fma_f32 v[20:21], v[20:21], v[172:173], v[172:173] op_sel:[0,0,1] op_sel_hi:[1,0,1] neg_lo:[0,0,1] neg_hi:[0,0,1]
v_pk_fma_f32 v[22:23], v[22:23], v[172:173], v[172:173] op_sel:[0,0,1] op_sel_hi:[1,0,1] neg_lo:[0,0,1] neg_hi:[0,0,1]
v_pk_fma_f32 v[24:25], v[24:25], v[172:173], v[172:173] op_sel:[0,0,1] op_sel_hi:[1,0,1] neg_lo:[0,0,1] neg_hi:[0,0,1]
v_pk_fma_f32 v[26:27], v[26:27], v[172:173], v[172:173] op_sel:[0,0,1] op_sel_hi:[1,0,1] neg_lo:[0,0,1] neg_hi:[0,0,1]
v_pk_fma_f32 v[28:29], v[28:29], v[172:173], v[172:173] op_sel:[0,0,1] op_sel_hi:[1,0,1] neg_lo:[0,0,1] neg_hi:[0,0,1]
v_pk_fma_f32 v[30:31], v[30:31], v[172:173], v[172:173] op_sel:[0,0,1] op_sel_hi:[1,0,1] neg_lo:[0,0,1] neg_hi:[0,0,1]
v_pk_fma_f32 v[32:33], v[32:33], v[172:173], v[172:173] op_sel:[0,0,1] op_sel_hi:[1,0,1] neg_lo:[0,0,1] neg_hi:[0,0,1]
v_pk_fma_f32 v[34:35], v[34:35], v[172:173], v[172:173] op_sel:[0,0,1] op_sel_hi:[1,0,1] neg_lo:[0,0,1] neg_hi:[0,0,1]
v_pk_fma_f32 v[36:37], v[36:37], v[172:173], v[172:173] op_sel:[0,0,1] op_sel_hi:[1,0,1] neg_lo:[0,0,1] neg_hi:[0,0,1]
v_pk_fma_f32 v[38:39], v[38:39], v[172:173], v[172:173] op_sel:[0,0,1] op_sel_hi:[1,0,1] neg_lo:[0,0,1] neg_hi:[0,0,1]
v_pk_fma_f32 v[40:41], v[40:41], v[172:173], v[172:173] op_sel:[0,0,1] op_sel_hi:[1,0,1] neg_lo:[0,0,1] neg_hi:[0,0,1]
v_pk_fma_f32 v[42:43], v[42:43], v[172:173], v[172:173] op_sel:[0,0,1] op_sel_hi:[1,0,1] neg_lo:[0,0,1] neg_hi:[0,0,1]
v_pk_fma_f32 v[44:45], v[44:45], v[172:173], v[172:173] op_sel:[0,0,1] op_sel_hi:[1,0,1] neg_lo:[0,0,1] neg_hi:[0,0,1]
v_pk_fma_f32 v[46:47], v[46:47], v[172:173], v[172:173] op_sel:[0,0,1] op_sel_hi:[1,0,1] neg_lo:[0,0,1] neg_hi:[0,0,1]
s_setprio 2
v_readfirstlane_b32 s43, v247
s_nop 1
s_cmp_ge_u32 s43, 32
s_cbranch_scc1 Lev9
Lev9w:
s_sleep 1
ds_read_b32 v247, v253 offset:16
s_waitcnt lgkmcnt(0)
v_readfirstlane_b32 s43, v247
s_cmp_eq_u32 s76, 0
s_cbranch_scc1 Lev9
s_sub_u32 s76, s76, 1
s_cmp_lt_u32 s43, 32
s_cbranch_scc1 Lev9w
Lev9:
s_setprio 1
v_cvt_pkrtz_f16_f32 v137, v120, v121
v_cvt_pkrtz_f16_f32 v139, v122, v123
v_cvt_pkrtz_f16_f32 v141, v124, v125
v_cvt_pkrtz_f16_f32 v143, v126, v127
v_cvt_pkrtz_f16_f32 v145, v128, v129
v_cvt_pkrtz_f16_f32 v147, v130, v131
v_cvt_pk_f16_f32 v155, v132, v133
v_cvt_pk_f16_f32 v152, v134, v135
s_add_u32 m0, s72, 0
s_add_u32 s43, s82, 0
buffer_load_dwordx4 v252, s[16:19], s43 offen lds
ds_read_b128 v[232:235], v249 offset:19456
ds_read_b128 v[236:239], v249 offset:22528
v_mfma_f32_32x32x16_bf16 v[120:135], v[224:227], v[96:99], 0
v_pk_fma_f16 v154, v155, v155, s48
v_and_b32 v192, 1, v251
v_cvt_pk_bf16_f32 v168, v0, v1
v_and_b32 v137, s49, v137
v_pk_fma_f16 v151, v152, v152, s48
v_cvt_pk_bf16_f32 v169, v2, v3
v_lshlrev_b32 v192, 4, v192
v_and_b32 v139, s49, v139
v_pk_mul_f16 v154, v155, v154
v_cvt_pk_bf16_f32 v170, v4, v5
v_lshrrev_b16 v136, 2, v137
v_mov_b32 v193, 15360
v_pk_mul_f16 v151, v152, v151
v_lshrrev_b16 v138, 2, v139
v_cvt_pk_bf16_f32 v171, v6, v7
ds_read_b128 v[224:227], v249 offset:20480
ds_read_u16_d16 v136, v136
ds_read_u16_d16 v138, v138
v_mfma_f32_32x32x16_bf16 v[120:135], v[228:231], v[100:103], v[120:135]
v_exp_f16 v153, v154
v_lshlrev_b32 v192, v192, v193
v_cvt_pk_bf16_f32 v172, v8, v9
v_lshrrev_b32 v137, 18, v137
v_exp_f16 v150, v151
v_lshrrev_b32 v193, 3, v251
v_cvt_pk_bf16_f32 v173, v10, v11
v_lshrrev_b32 v139, 18, v139
v_and_b32 v141, s49, v141
v_xor_b32 v193, v193, v251
v_cvt_pk_bf16_f32 v174, v12, v13
v_exp_f16_sdwa v153, v154 dst_sel:WORD_1 dst_unused:UNUSED_PRESERVE src0_sel:WORD_1
v_cvt_pk_bf16_f32 v175, v14, v15
v_and_b32 v193, 4, v193
s_waitcnt lgkmcnt(3)
s_add_u32 m0, s72, 1024
s_add_u32 s43, s82, 64
buffer_load_dwordx4 v252, s[16:19], s43 offen lds
ds_read_b128 v[228:231], v249 offset:23552
ds_read_u16_d16_hi v137, v137
ds_read_u16_d16_hi v139, v139
v_mfma_f32_32x32x16_bf16 v[120:135], v[232:235], v[104:107], v[120:135]
v_and_b32 v143, s49, v143
v_lshrrev_b16 v140, 2, v141
v_exp_f16_sdwa v150, v151 dst_sel:WORD_1 dst_unused:UNUSED_PRESERVE src0_sel:WORD_1
v_bfe_u32 v194, v251, 3, 2
v_cvt_pk_bf16_f32 v176, v16, v17
v_lshrrev_b16 v142, 2, v143
v_cvt_pk_bf16_f32 v177, v18, v19
v_pk_add_f16 v153, v153, 1.0 op_sel_hi:[1,0]
v_lshl_add_u32 v193, v193, 1, 0
v_lshrrev_b32 v141, 18, v141
v_pk_add_f16 v150, v150, 1.0 op_sel_hi:[1,0]
v_cvt_pk_bf16_f32 v178, v20, v21
v_lshrrev_b32 v143, 18, v143
v_lshl_add_u32 v193, v194, 1, v193
ds_read_b128 v[232:235], v248 offset:16384
ds_read_u16_d16 v140, v140
ds_read_u16_d16 v142, v142
ds_read_u16_d16_hi v141, v141
ds_read_u16_d16_hi v143, v143
v_mfma_f32_32x32x16_bf16 v[120:135], v[236:239], v[108:111], v[120:135]
v_rcp_f16 v154, v153
v_cvt_pk_bf16_f32 v179, v22, v23
v_and_b32 v145, s49, v145
v_and_b32 v147, s49, v147
v_bfe_u32 v194, v251, 1, 1
v_cvt_pk_bf16_f32 v180, v24, v25
v_rcp_f16 v151, v150
v_cvt_pk_bf16_f32 v181, v26, v27
v_add_u32 v193, v193, v194
v_lshrrev_b16 v144, 2, v145
v_rcp_f16_sdwa v154, v153 dst_sel:WORD_1 dst_unused:UNUSED_PRESERVE src0_sel:WORD_1
v_cvt_pk_bf16_f32 v182, v28, v29
v_cmp_eq_u32 vcc, 0, v193
s_nop 1
v_cndmask_b32 v240, 0, v192, vcc
v_lshrrev_b16 v146, 2, v147
s_waitcnt lgkmcnt(5)
s_add_u32 m0, s72, 2048
s_add_u32 s43, s82, 128
buffer_load_dwordx4 v252, s[16:19], s43 offen lds
ds_read_b128 v[236:239], v248 offset:19456
ds_read_u16_d16 v144, v144
ds_read_u16_d16 v146, v146
v_mfma_f32_32x32x16_bf16 v[120:135], v[224:227], v[112:115], v[120:135]
v_lshrrev_b32 v145, 18, v145
v_cvt_pk_bf16_f32 v183, v30, v31
v_rcp_f16_sdwa v151, v150 dst_sel:WORD_1 dst_unused:UNUSED_PRESERVE src0_sel:WORD_1
v_cmp_eq_u32 vcc, 1, v193
s_nop 1
v_cndmask_b32 v241, 0, v192, vcc
v_cvt_pk_bf16_f32 v184, v32, v33
s_setprio 0
v_lshrrev_b32 v147, 18, v147
v_pk_mul_f16 v155, v155, v154
v_cmp_eq_u32 vcc, 2, v193
s_nop 1
v_cndmask_b32 v242, 0, v192, vcc
v_fma_mix_f32 v166, v136, v136, v166 op_sel:[0,0,0] op_sel_hi:[1,1,0]
v_cvt_pk_bf16_f32 v185, v34, v35
v_fma_mix_f32 v166, v137, v137, v166 op_sel:[1,1,0] op_sel_hi:[1,1,0]
v_pk_mul_f16 v152, v152, v151
v_cmp_eq_u32 vcc, 3, v193
s_nop 1
v_cndmask_b32 v243, 0, v192, vcc
v_cvt_pk_bf16_f32 v186, v36, v37
v_fma_mix_f32 v166, v138, v138, v166 op_sel:[0,0,0] op_sel_hi:[1,1,0]
ds_read_b128 v[224:227], v248 offset:17408
ds_read_u16_d16_hi v145, v145
ds_read_u16_d16_hi v147, v147
v_mfma_f32_32x32x16_bf16 v[120:135], v[228:231], v[116:119], v[120:135]
v_fma_mix_f32 v166, v139, v139, v166 op_sel:[1,1,0] op_sel_hi:[1,1,0]
v_cvt_pk_bf16_f32 v187, v38, v39
v_cmp_eq_u32 vcc, 4, v193
s_nop 1
v_cndmask_b32 v244, 0, v192, vcc
v_fma_mix_f32 v166, v155, v155, v166 op_sel:[0,0,0] op_sel_hi:[1,1,0]
s_waitcnt lgkmcnt(3)
v_fma_mix_f32 v166, v140, v140, v166 op_sel:[0,0,0] op_sel_hi:[1,1,0]
v_fma_mix_f32 v166, v141, v141, v166 op_sel:[1,1,0] op_sel_hi:[1,1,0]
v_cvt_pk_bf16_f32 v188, v40, v41
v_cmp_eq_u32 vcc, 5, v193
s_nop 1
v_cndmask_b32 v245, 0, v192, vcc
v_fma_mix_f32 v166, v155, v155, v166 op_sel:[1,1,0] op_sel_hi:[1,1,0]
v_fma_mix_f32 v166, v142, v142, v166 op_sel:[0,0,0] op_sel_hi:[1,1,0]
v_cvt_pk_bf16_f32 v189, v42, v43
v_fma_mix_f32 v166, v143, v143, v166 op_sel:[1,1,0] op_sel_hi:[1,1,0]
v_cmp_eq_u32 vcc, 6, v193
s_nop 1
v_cndmask_b32 v246, 0, v192, vcc
v_fma_mix_f32 v166, v152, v152, v166 op_sel:[0,0,0] op_sel_hi:[1,1,0]
v_fma_mix_f32 v166, v144, v144, v166 op_sel:[0,0,0] op_sel_hi:[1,1,0]
v_cvt_pk_bf16_f32 v190, v44, v45
s_waitcnt lgkmcnt(0)
v_fma_mix_f32 v166, v145, v145, v166 op_sel:[1,1,0] op_sel_hi:[1,1,0]
v_cmp_eq_u32 vcc, 7, v193
s_nop 1
v_cndmask_b32 v247, 0, v192, vcc
v_fma_mix_f32 v166, v152, v152, v166 op_sel:[1,1,0] op_sel_hi:[1,1,0]
v_cvt_pk_bf16_f32 v191, v46, v47
v_fma_mix_f32 v166, v146, v146, v166 op_sel:[0,0,0] op_sel_hi:[1,1,0]
v_fma_mix_f32 v166, v147, v147, v166 op_sel:[1,1,0] op_sel_hi:[1,1,0]
s_setprio 2
v_cvt_pkrtz_f16_f32 v137, v120, v121
v_cvt_pkrtz_f16_f32 v139, v122, v123
v_cvt_pkrtz_f16_f32 v141, v124, v125
v_cvt_pkrtz_f16_f32 v143, v126, v127
v_cvt_pkrtz_f16_f32 v145, v128, v129
v_cvt_pk_f16_f32 v155, v130, v131
v_cvt_pk_f16_f32 v152, v132, v133
v_cvt_pk_f16_f32 v149, v134, v135
s_add_u32 m0, s72, 3072
s_add_u32 s43, s82, 3072
buffer_load_dwordx4 v252, s[16:19], s43 offen lds
ds_read_b128 v[228:231], v248 offset:20480
v_mfma_f32_32x32x16_bf16 v[120:135], v[232:235], v[168:171], 0
v_pk_fma_f16 v154, v155, v155, s48
v_mov_b32 v88, v48
v_and_b32 v137, s49, v137
v_pk_fma_f16 v151, v152, v152, s48
v_and_b32 v139, s49, v139
v_pk_fma_f16 v148, v149, v149, s48
v_pk_mul_f16 v154, v155, v154
v_lshrrev_b16 v136, 2, v137
v_pk_mul_f16 v151, v152, v151
ds_read_b128 v[232:235], v248 offset:18432
ds_read_u16_d16 v136, v136
v_mfma_f32_32x32x16_bf16 v[120:135], v[236:239], v[172:175], v[120:135]
v_mov_b32 v89, v49
v_pk_mul_f16 v148, v149, v148
v_lshrrev_b16 v138, 2, v139
v_exp_f16 v153, v154
v_lshrrev_b32 v137, 18, v137
v_exp_f16 v150, v151
v_mov_b32 v90, v50
v_lshrrev_b32 v139, 18, v139
s_add_u32 m0, s72, 4096
s_add_u32 s43, s82, 3136
buffer_load_dwordx4 v252, s[16:19], s43 offen lds
ds_read_b128 v[236:239], v248 offset:21504
ds_read_u16_d16 v138, v138
ds_read_u16_d16_hi v137, v137
ds_read_u16_d16_hi v139, v139
v_mfma_f32_32x32x16_bf16 v[120:135], v[224:227], v[176:179], v[120:135]
v_exp_f16 v147, v148
v_and_b32 v141, s49, v141
v_and_b32 v143, s49, v143
v_exp_f16_sdwa v153, v154 dst_sel:WORD_1 dst_unused:UNUSED_PRESERVE src0_sel:WORD_1
v_mov_b32 v91, v51
v_lshrrev_b16 v140, 2, v141
s_waitcnt lgkmcnt(5)
ds_read_b128 v[224:227], v248 offset:22528
ds_read_u16_d16 v140, v140
v_mfma_f32_32x32x16_bf16 v[120:135], v[228:231], v[180:183], v[120:135]
v_exp_f16_sdwa v150, v151 dst_sel:WORD_1 dst_unused:UNUSED_PRESERVE src0_sel:WORD_1
v_lshrrev_b16 v142, 2, v143
v_exp_f16_sdwa v147, v148 dst_sel:WORD_1 dst_unused:UNUSED_PRESERVE src0_sel:WORD_1
v_lshrrev_b32 v141, 18, v141
v_mov_b32 v92, v52
v_pk_add_f16 v153, v153, 1.0 op_sel_hi:[1,0]
v_lshrrev_b32 v143, 18, v143
v_pk_add_f16 v150, v150, 1.0 op_sel_hi:[1,0]
v_pk_add_f16 v147, v147, 1.0 op_sel_hi:[1,0]
s_add_u32 m0, s72, 5120
s_add_u32 s43, s82, 3200
buffer_load_dwordx4 v252, s[16:19], s43 offen lds
ds_read_b128 v[228:231], v248 offset:25600
ds_read_u16_d16 v142, v142
ds_read_u16_d16_hi v141, v141
ds_read_u16_d16_hi v143, v143
v_mfma_f32_32x32x16_bf16 v[120:135], v[232:235], v[184:187], v[120:135]
v_and_b32 v145, s49, v145
v_rcp_f16 v154, v153
v_mov_b32 v93, v53
v_lshrrev_b16 v144, 2, v145
v_rcp_f16 v151, v150
v_lshrrev_b32 v145, 18, v145
v_rcp_f16 v148, v147
s_waitcnt lgkmcnt(4)
ds_read_b128 v[232:235], v248 offset:23552
ds_read_u16_d16 v144, v144
ds_read_u16_d16_hi v145, v145
v_mfma_f32_32x32x16_bf16 v[120:135], v[236:239], v[188:191], v[120:135]
v_or_b32 v216, v136, v137
v_mov_b32 v94, v54
v_or_b32 v217, v138, v139
v_rcp_f16_sdwa v154, v153 dst_sel:WORD_1 dst_unused:UNUSED_PRESERVE src0_sel:WORD_1
s_waitcnt lgkmcnt(4)
v_or_b32 v218, v140, v141
v_rcp_f16_sdwa v151, v150 dst_sel:WORD_1 dst_unused:UNUSED_PRESERVE src0_sel:WORD_1
s_waitcnt lgkmcnt(3)
v_or_b32 v219, v142, v143
v_mov_b32 v95, v55
v_rcp_f16_sdwa v148, v147 dst_sel:WORD_1 dst_unused:UNUSED_PRESERVE src0_sel:WORD_1
s_waitcnt lgkmcnt(0)
v_or_b32 v220, v144, v145
v_pk_mul_f16 v221, v155, v154
v_pk_mul_f16 v222, v152, v151
v_pk_mul_f16 v223, v149, v148
s_cmp_lg_u32 s40, 0
s_cbranch_scc1 Lrs0
v_mov_b32 v82, 0
buffer_load_dword v83, v82, s[36:39], 0 offen sc1
Lrs0:
s_setprio 1
s_add_u32 m0, s72, 6144
s_add_u32 s43, s82, 6144
buffer_load_dwordx4 v252, s[16:19], s43 offen lds
ds_read_b128 v[236:239], v248 offset:26624
v_mfma_f32_32x32x16_f16 v[192:207], v[216:219], v[240:243], 0
v_cvt_pkrtz_f16_f32 v137, v120, v121
v_cvt_pkrtz_f16_f32 v139, v122, v123
v_cvt_pkrtz_f16_f32 v141, v124, v125
v_cvt_pkrtz_f16_f32 v143, v126, v127
v_cvt_pkrtz_f16_f32 v145, v128, v129
v_mfma_f32_32x32x16_f16 v[192:207], v[220:223], v[244:247], v[192:207]
v_cvt_pkrtz_f16_f32 v147, v130, v131
v_cvt_pk_f16_f32 v155, v132, v133
v_cvt_pk_f16_f32 v152, v134, v135
v_pk_fma_f16 v154, v155, v155, s48
v_mov_b32 v208, v56
v_and_b32 v255, 51, v251
v_mfma_f32_32x32x16_bf16 v[120:135], v[224:227], v[168:171], 0
v_and_b32 v137, s49, v137
v_pk_fma_f16 v151, v152, v152, s48
v_and_b32 v139, s49, v139
v_pk_mul_f16 v154, v155, v154
v_lshrrev_b16 v136, 2, v137
v_pk_mul_f16 v151, v152, v151
v_lshrrev_b16 v138, 2, v139
v_mov_b32 v209, v57
v_exp_f16 v153, v154
v_fmac_f32 v167, v192, v192
ds_read_b128 v[224:227], v248 offset:24576
ds_read_u16_d16 v136, v136
ds_read_u16_d16 v138, v138
v_mfma_f32_32x32x16_bf16 v[120:135], v[228:231], v[172:175], v[120:135]
v_bfe_u32 v87, v251, 2, 1
v_lshrrev_b32 v137, 18, v137
v_fmac_f32 v167, v193, v193
v_exp_f16 v150, v151
v_lshrrev_b32 v139, 18, v139
v_mov_b32 v210, v58
v_fmac_f32 v167, v194, v194
v_and_b32 v141, s49, v141
v_exp_f16_sdwa v153, v154 dst_sel:WORD_1 dst_unused:UNUSED_PRESERVE src0_sel:WORD_1
v_fmac_f32 v167, v195, v195
ds_read_b128 v[228:231], v248 offset:27648
ds_read_u16_d16_hi v137, v137
ds_read_u16_d16_hi v139, v139
v_mfma_f32_32x32x16_bf16 v[120:135], v[232:235], v[176:179], v[120:135]
v_and_b32 v143, s49, v143
v_lshl_add_u32 v255, v87, 3, v255
v_lshrrev_b16 v140, 2, v141
v_fmac_f32 v167, v196, v196
v_mov_b32 v211, v59
v_exp_f16_sdwa v150, v151 dst_sel:WORD_1 dst_unused:UNUSED_PRESERVE src0_sel:WORD_1
v_fmac_f32 v167, v197, v197
v_lshrrev_b16 v142, 2, v143
v_pk_add_f16 v153, v153, 1.0 op_sel_hi:[1,0]
v_lshrrev_b32 v141, 18, v141
s_waitcnt lgkmcnt(3)
ds_read_b128 v[232:235], v248 offset:28672
ds_read_u16_d16 v140, v140
ds_read_u16_d16 v142, v142
ds_read_u16_d16_hi v141, v141
v_mfma_f32_32x32x16_bf16 v[120:135], v[236:239], v[180:183], v[120:135]
v_fmac_f32 v167, v198, v198
v_pk_add_f16 v150, v150, 1.0 op_sel_hi:[1,0]
v_lshrrev_b32 v143, 18, v143
v_mov_b32 v212, v60
v_bfe_u32 v87, v251, 3, 1
v_fmac_f32 v167, v199, v199
v_rcp_f16 v154, v153
v_and_b32 v145, s49, v145
v_fmac_f32 v167, v200, v200
v_and_b32 v147, s49, v147
ds_read_b128 v[236:239], v248 offset:31744
ds_read_u16_d16_hi v143, v143
v_mfma_f32_32x32x16_bf16 v[120:135], v[224:227], v[184:187], v[120:135]
v_rcp_f16 v151, v150
v_mov_b32 v213, v61
v_fmac_f32 v167, v201, v201
v_lshrrev_b16 v144, 2, v145
s_setprio 0
v_lshl_add_u32 v255, v87, 2, v255
v_rcp_f16_sdwa v154, v153 dst_sel:WORD_1 dst_unused:UNUSED_PRESERVE src0_sel:WORD_1
v_fmac_f32 v167, v202, v202
v_lshrrev_b16 v146, 2, v147
v_fmac_f32 v167, v203, v203
v_mov_b32 v214, v62
s_waitcnt lgkmcnt(2)
ds_read_b128 v[224:227], v248 offset:29696
ds_read_u16_d16 v144, v144
ds_read_u16_d16 v146, v146
v_mfma_f32_32x32x16_bf16 v[120:135], v[228:231], v[188:191], v[120:135]
v_lshrrev_b32 v145, 18, v145
v_rcp_f16_sdwa v151, v150 dst_sel:WORD_1 dst_unused:UNUSED_PRESERVE src0_sel:WORD_1
v_fmac_f32 v167, v204, v204
v_lshrrev_b32 v147, 18, v147
v_or_b32 v0, v136, v137
v_lshl_add_u32 v255, v255, 2, s72
v_fmac_f32 v167, v205, v205
v_or_b32 v1, v138, v139
v_mov_b32 v215, v63
v_or_b32 v2, v140, v141
s_waitcnt lgkmcnt(3)
v_or_b32 v3, v142, v143
v_fmac_f32 v167, v206, v206
ds_read_u16_d16_hi v145, v145
ds_read_u16_d16_hi v147, v147
s_waitcnt lgkmcnt(1)
v_or_b32 v4, v144, v145
s_waitcnt lgkmcnt(0)
v_or_b32 v5, v146, v147
v_fmac_f32 v167, v207, v207
v_pk_mul_f16 v6, v155, v154
v_pk_mul_f16 v7, v152, v151
s_setprio 2
ds_read_b128 v[228:231], v248 offset:32768
v_mfma_f32_32x32x16_f16 v[192:207], v[0:3], v[240:243], 0
v_cvt_pkrtz_f16_f32 v137, v120, v121
v_cvt_pkrtz_f16_f32 v139, v122, v123
v_cvt_pkrtz_f16_f32 v141, v124, v125
v_cvt_pkrtz_f16_f32 v143, v126, v127
v_cvt_pkrtz_f16_f32 v145, v128, v129
v_mfma_f32_32x32x16_f16 v[192:207], v[4:7], v[244:247], v[192:207]
v_cvt_pk_f16_f32 v155, v130, v131
v_cvt_pk_f16_f32 v152, v132, v133
v_cvt_pk_f16_f32 v149, v134, v135
v_pk_fma_f16 v154, v155, v155, s48
v_and_b32 v137, s49, v137
v_mfma_f32_32x32x16_bf16 v[120:135], v[232:235], v[168:171], 0
v_pk_fma_f16 v151, v152, v152, s48
v_and_b32 v139, s49, v139
v_pk_fma_f16 v148, v149, v149, s48
v_pk_mul_f16 v154, v155, v154
v_lshrrev_b16 v136, 2, v137
v_pk_mul_f16 v151, v152, v151
v_pk_mul_f16 v148, v149, v148
v_lshrrev_b16 v138, 2, v139
v_fmac_f32 v156, v192, v192
v_exp_f16 v153, v154
ds_read_b128 v[232:235], v248 offset:30720
ds_read_u16_d16 v136, v136
ds_read_u16_d16 v138, v138
v_mfma_f32_32x32x16_bf16 v[120:135], v[236:239], v[172:175], v[120:135]
v_fmac_f32 v156, v193, v193
v_lshrrev_b32 v137, 18, v137
v_exp_f16 v150, v151
v_fmac_f32 v156, v194, v194
v_lshrrev_b32 v139, 18, v139
v_exp_f16 v147, v148
v_fmac_f32 v156, v195, v195
v_and_b32 v141, s49, v141
ds_read_b128 v[236:239], v248 offset:33792
ds_read_u16_d16_hi v137, v137
ds_read_u16_d16_hi v139, v139
v_mfma_f32_32x32x16_bf16 v[120:135], v[224:227], v[176:179], v[120:135]
v_and_b32 v143, s49, v143
v_exp_f16_sdwa v153, v154 dst_sel:WORD_1 dst_unused:UNUSED_PRESERVE src0_sel:WORD_1
v_fmac_f32 v156, v196, v196
v_lshrrev_b16 v140, 2, v141
v_exp_f16_sdwa v150, v151 dst_sel:WORD_1 dst_unused:UNUSED_PRESERVE src0_sel:WORD_1
v_fmac_f32 v156, v197, v197
v_lshrrev_b16 v142, 2, v143
v_exp_f16_sdwa v147, v148 dst_sel:WORD_1 dst_unused:UNUSED_PRESERVE src0_sel:WORD_1
s_waitcnt lgkmcnt(6)
ds_read_b128 v[224:227], v248 offset:34816
ds_read_u16_d16 v140, v140
ds_read_u16_d16 v142, v142
v_mfma_f32_32x32x16_bf16 v[120:135], v[228:231], v[180:183], v[120:135]
v_fmac_f32 v156, v198, v198
v_lshrrev_b32 v141, 18, v141
v_pk_add_f16 v153, v153, 1.0 op_sel_hi:[1,0]
v_fmac_f32 v156, v199, v199
v_lshrrev_b32 v143, 18, v143
v_pk_add_f16 v150, v150, 1.0 op_sel_hi:[1,0]
v_pk_add_f16 v147, v147, 1.0 op_sel_hi:[1,0]
v_fmac_f32 v156, v200, v200
v_and_b32 v145, s49, v145
s_waitcnt lgkmcnt(4)
ds_read_b128 v[228:231], v248 offset:37888
ds_read_u16_d16_hi v141, v141
ds_read_u16_d16_hi v143, v143
v_mfma_f32_32x32x16_bf16 v[120:135], v[232:235], v[184:187], v[120:135]
v_rcp_f16 v154, v153
v_fmac_f32 v156, v201, v201
v_lshrrev_b16 v144, 2, v145
v_rcp_f16 v151, v150
v_fmac_f32 v156, v202, v202
v_lshrrev_b32 v145, 18, v145
v_rcp_f16 v148, v147
v_fmac_f32 v156, v203, v203
v_or_b32 v8, v136, v137
ds_read_b128 v[232:235], v248 offset:35840
ds_read_u16_d16 v144, v144
ds_read_u16_d16_hi v145, v145
v_mfma_f32_32x32x16_bf16 v[120:135], v[236:239], v[188:191], v[120:135]
s_waitcnt lgkmcnt(6)
v_or_b32 v9, v138, v139
v_rcp_f16_sdwa v154, v153 dst_sel:WORD_1 dst_unused:UNUSED_PRESERVE src0_sel:WORD_1
v_fmac_f32 v156, v204, v204
s_waitcnt lgkmcnt(4)
v_or_b32 v10, v140, v141
v_rcp_f16_sdwa v151, v150 dst_sel:WORD_1 dst_unused:UNUSED_PRESERVE src0_sel:WORD_1
v_fmac_f32 v156, v205, v205
s_waitcnt lgkmcnt(3)
v_or_b32 v11, v142, v143
v_rcp_f16_sdwa v148, v147 dst_sel:WORD_1 dst_unused:UNUSED_PRESERVE src0_sel:WORD_1
v_fmac_f32 v156, v206, v206
s_waitcnt lgkmcnt(0)
v_or_b32 v12, v144, v145
v_pk_mul_f16 v13, v155, v154
v_fmac_f32 v156, v207, v207
v_pk_mul_f16 v14, v152, v151
v_pk_mul_f16 v15, v149, v148
s_setprio 1
ds_read_b128 v[236:239], v248 offset:38912
v_mfma_f32_32x32x16_f16 v[192:207], v[8:11], v[240:243], 0
v_cvt_pkrtz_f16_f32 v137, v120, v121
v_cvt_pkrtz_f16_f32 v139, v122, v123
v_cvt_pkrtz_f16_f32 v141, v124, v125
v_cvt_pkrtz_f16_f32 v143, v126, v127
v_mfma_f32_32x32x16_f16 v[192:207], v[12:15], v[244:247], v[192:207]
v_cvt_pkrtz_f16_f32 v145, v128, v129
v_cvt_pkrtz_f16_f32 v147, v130, v131
v_cvt_pk_f16_f32 v155, v132, v133
v_cvt_pk_f16_f32 v152, v134, v135
v_pk_fma_f16 v154, v155, v155, s48
v_mfma_f32_32x32x16_bf16 v[120:135], v[224:227], v[168:171], 0
v_and_b32 v137, s49, v137
v_pk_fma_f16 v151, v152, v152, s48
v_and_b32 v139, s49, v139
v_pk_mul_f16 v154, v155, v154
v_lshrrev_b16 v136, 2, v137
v_pk_mul_f16 v151, v152, v151
v_lshrrev_b16 v138, 2, v139
v_exp_f16 v153, v154
v_fmac_f32 v157, v192, v192
ds_read_b128 v[224:227], v248 offset:36864
ds_read_u16_d16 v136, v136
ds_read_u16_d16 v138, v138
v_mfma_f32_32x32x16_bf16 v[120:135], v[228:231], v[172:175], v[120:135]
v_lshrrev_b32 v137, 18, v137
v_fmac_f32 v157, v193, v193
v_exp_f16 v150, v151
v_fmac_f32 v157, v194, v194
v_lshrrev_b32 v139, 18, v139
v_and_b32 v141, s49, v141
v_fmac_f32 v157, v195, v195
v_exp_f16_sdwa v153, v154 dst_sel:WORD_1 dst_unused:UNUSED_PRESERVE src0_sel:WORD_1
ds_read_b128 v[228:231], v248 offset:39936
ds_read_u16_d16_hi v137, v137
ds_read_u16_d16_hi v139, v139
v_mfma_f32_32x32x16_bf16 v[120:135], v[232:235], v[176:179], v[120:135]
v_fmac_f32 v157, v196, v196
v_and_b32 v143, s49, v143
v_lshrrev_b16 v140, 2, v141
v_fmac_f32 v157, v197, v197
v_exp_f16_sdwa v150, v151 dst_sel:WORD_1 dst_unused:UNUSED_PRESERVE src0_sel:WORD_1
v_fmac_f32 v157, v198, v198
v_lshrrev_b16 v142, 2, v143
v_pk_add_f16 v153, v153, 1.0 op_sel_hi:[1,0]
v_fmac_f32 v157, v199, v199
s_waitcnt lgkmcnt(5)
ds_read_b128 v[232:235], v248 offset:40960
ds_read_u16_d16 v140, v140
ds_read_u16_d16 v142, v142
v_mfma_f32_32x32x16_bf16 v[120:135], v[236:239], v[180:183], v[120:135]
v_lshrrev_b32 v141, 18, v141
v_pk_add_f16 v150, v150, 1.0 op_sel_hi:[1,0]
v_fmac_f32 v157, v200, v200
v_lshrrev_b32 v143, 18, v143
v_rcp_f16 v154, v153
v_fmac_f32 v157, v201, v201
v_and_b32 v145, s49, v145
v_and_b32 v147, s49, v147
v_fmac_f32 v157, v202, v202
ds_read_b128 v[236:239], v248 offset:44032
ds_read_u16_d16_hi v141, v141
ds_read_u16_d16_hi v143, v143
v_mfma_f32_32x32x16_bf16 v[120:135], v[224:227], v[184:187], v[120:135]
v_rcp_f16 v151, v150
v_fmac_f32 v157, v203, v203
v_lshrrev_b16 v144, 2, v145
s_setprio 0
v_rcp_f16_sdwa v154, v153 dst_sel:WORD_1 dst_unused:UNUSED_PRESERVE src0_sel:WORD_1
v_fmac_f32 v157, v204, v204
v_lshrrev_b16 v146, 2, v147
v_fmac_f32 v157, v205, v205
v_lshrrev_b32 v145, 18, v145
s_waitcnt lgkmcnt(4)
ds_read_b128 v[224:227], v248 offset:41984
ds_read_u16_d16 v144, v144
ds_read_u16_d16 v146, v146
ds_read_u16_d16_hi v145, v145
v_mfma_f32_32x32x16_bf16 v[120:135], v[228:231], v[188:191], v[120:135]
v_rcp_f16_sdwa v151, v150 dst_sel:WORD_1 dst_unused:UNUSED_PRESERVE src0_sel:WORD_1
v_fmac_f32 v157, v206, v206
v_lshrrev_b32 v147, 18, v147
v_fmac_f32 v157, v207, v207
v_or_b32 v16, v136, v137
v_or_b32 v17, v138, v139
v_permlane32_swap_b32 v156, v157
s_waitcnt lgkmcnt(5)
v_or_b32 v18, v140, v141
s_waitcnt lgkmcnt(4)
v_or_b32 v19, v142, v143
s_waitcnt lgkmcnt(0)
v_or_b32 v20, v144, v145
ds_read_u16_d16_hi v147, v147
s_waitcnt lgkmcnt(0)
v_or_b32 v21, v146, v147
v_add_f32 v156, v156, v157
ds_write_b32 v255, v156 offset:7168
v_pk_mul_f16 v22, v155, v154
v_pk_mul_f16 v23, v152, v151
s_cmp_lg_u32 s40, 0
s_cbranch_scc1 Lrs1
v_mov_b32 v82, 0
Lpi:
s_waitcnt vmcnt(0)
v_readfirstlane_b32 s43, v83
s_cmp_eq_u32 s76, 0
s_cbranch_scc1 Lpix
s_sub_u32 s76, s76, 1
s_cmp_ge_u32 s43, 256
s_cbranch_scc1 Lpix
buffer_load_dword v83, v82, s[36:39], 0 offen sc1
s_branch Lpi
Lpix:
v_min_u32 v80, 47, v251
v_lshlrev_b32 v80, 3, v80
s_and_b32 s44, s2, 7
s_lshl_b32 s44, s44, 11
s_add_u32 s44, s44, 394752
buffer_load_dwordx2 v[84:85], v80, s[32:35], s44 offen sc1
Lrs1:
s_setprio 2
ds_read_b128 v[228:231], v248 offset:45056
v_mfma_f32_32x32x16_f16 v[192:207], v[16:19], v[240:243], 0
v_cvt_pkrtz_f16_f32 v137, v120, v121
v_cvt_pkrtz_f16_f32 v139, v122, v123
v_cvt_pkrtz_f16_f32 v141, v124, v125
v_cvt_pkrtz_f16_f32 v143, v126, v127
v_cvt_pkrtz_f16_f32 v145, v128, v129
v_mfma_f32_32x32x16_f16 v[192:207], v[20:23], v[244:247], v[192:207]
v_cvt_pk_f16_f32 v155, v130, v131
v_cvt_pk_f16_f32 v152, v132, v133
v_cvt_pk_f16_f32 v149, v134, v135
v_pk_fma_f16 v154, v155, v155, s48
v_and_b32 v137, s49, v137
v_mfma_f32_32x32x16_bf16 v[120:135], v[232:235], v[168:171], 0
v_pk_fma_f16 v151, v152, v152, s48
v_and_b32 v139, s49, v139
v_pk_fma_f16 v148, v149, v149, s48
v_pk_mul_f16 v154, v155, v154
v_lshrrev_b16 v136, 2, v137
v_pk_mul_f16 v151, v152, v151
v_pk_mul_f16 v148, v149, v148
v_lshrrev_b16 v138, 2, v139
v_fmac_f32 v158, v192, v192
v_exp_f16 v153, v154
ds_read_b128 v[232:235], v248 offset:43008
ds_read_u16_d16 v136, v136
ds_read_u16_d16 v138, v138
v_mfma_f32_32x32x16_bf16 v[120:135], v[236:239], v[172:175], v[120:135]
v_fmac_f32 v158, v193, v193
v_lshrrev_b32 v137, 18, v137
v_exp_f16 v150, v151
v_fmac_f32 v158, v194, v194
v_lshrrev_b32 v139, 18, v139
v_exp_f16 v147, v148
v_fmac_f32 v158, v195, v195
v_and_b32 v141, s49, v141
ds_read_b128 v[236:239], v248 offset:46080
ds_read_u16_d16_hi v137, v137
ds_read_u16_d16_hi v139, v139
v_mfma_f32_32x32x16_bf16 v[120:135], v[224:227], v[176:179], v[120:135]
v_and_b32 v143, s49, v143
v_exp_f16_sdwa v153, v154 dst_sel:WORD_1 dst_unused:UNUSED_PRESERVE src0_sel:WORD_1
v_fmac_f32 v158, v196, v196
v_lshrrev_b16 v140, 2, v141
v_exp_f16_sdwa v150, v151 dst_sel:WORD_1 dst_unused:UNUSED_PRESERVE src0_sel:WORD_1
v_fmac_f32 v158, v197, v197
v_lshrrev_b16 v142, 2, v143
v_exp_f16_sdwa v147, v148 dst_sel:WORD_1 dst_unused:UNUSED_PRESERVE src0_sel:WORD_1
s_waitcnt lgkmcnt(6)
ds_read_b128 v[224:227], v248 offset:47104
ds_read_u16_d16 v140, v140
ds_read_u16_d16 v142, v142
v_mfma_f32_32x32x16_bf16 v[120:135], v[228:231], v[180:183], v[120:135]
v_fmac_f32 v158, v198, v198
v_lshrrev_b32 v141, 18, v141
v_pk_add_f16 v153, v153, 1.0 op_sel_hi:[1,0]
v_fmac_f32 v158, v199, v199
v_lshrrev_b32 v143, 18, v143
v_pk_add_f16 v150, v150, 1.0 op_sel_hi:[1,0]
v_pk_add_f16 v147, v147, 1.0 op_sel_hi:[1,0]
v_fmac_f32 v158, v200, v200
v_and_b32 v145, s49, v145
s_waitcnt lgkmcnt(4)
ds_read_b128 v[228:231], v248 offset:50176
ds_read_u16_d16_hi v141, v141
ds_read_u16_d16_hi v143, v143
v_mfma_f32_32x32x16_bf16 v[120:135], v[232:235], v[184:187], v[120:135]
v_rcp_f16 v154, v153
v_fmac_f32 v158, v201, v201
v_lshrrev_b16 v144, 2, v145
v_rcp_f16 v151, v150
v_fmac_f32 v158, v202, v202
v_lshrrev_b32 v145, 18, v145
v_rcp_f16 v148, v147
v_fmac_f32 v158, v203, v203
v_or_b32 v24, v136, v137
ds_read_b128 v[232:235], v248 offset:48128
ds_read_u16_d16 v144, v144
ds_read_u16_d16_hi v145, v145
v_mfma_f32_32x32x16_bf16 v[120:135], v[236:239], v[188:191], v[120:135]
s_waitcnt lgkmcnt(6)
v_or_b32 v25, v138, v139
v_rcp_f16_sdwa v154, v153 dst_sel:WORD_1 dst_unused:UNUSED_PRESERVE src0_sel:WORD_1
v_fmac_f32 v158, v204, v204
s_waitcnt lgkmcnt(4)
v_or_b32 v26, v140, v141
v_rcp_f16_sdwa v151, v150 dst_sel:WORD_1 dst_unused:UNUSED_PRESERVE src0_sel:WORD_1
v_fmac_f32 v158, v205, v205
s_waitcnt lgkmcnt(3)
v_or_b32 v27, v142, v143
v_rcp_f16_sdwa v148, v147 dst_sel:WORD_1 dst_unused:UNUSED_PRESERVE src0_sel:WORD_1
v_fmac_f32 v158, v206, v206
s_waitcnt lgkmcnt(0)
v_or_b32 v28, v144, v145
v_pk_mul_f16 v29, v155, v154
v_fmac_f32 v158, v207, v207
v_pk_mul_f16 v30, v152, v151
v_pk_mul_f16 v31, v149, v148
s_setprio 1
ds_read_b128 v[236:239], v248 offset:51200
v_mfma_f32_32x32x16_f16 v[192:207], v[24:27], v[240:243], 0
v_cvt_pkrtz_f16_f32 v137, v120, v121
v_cvt_pkrtz_f16_f32 v139, v122, v123
v_cvt_pkrtz_f16_f32 v141, v124, v125
v_cvt_pkrtz_f16_f32 v143, v126, v127
v_mfma_f32_32x32x16_f16 v[192:207], v[28:31], v[244:247], v[192:207]
v_cvt_pkrtz_f16_f32 v145, v128, v129
v_cvt_pkrtz_f16_f32 v147, v130, v131
v_cvt_pk_f16_f32 v155, v132, v133
v_cvt_pk_f16_f32 v152, v134, v135
v_pk_fma_f16 v154, v155, v155, s48
v_mfma_f32_32x32x16_bf16 v[120:135], v[224:227], v[168:171], 0
v_and_b32 v137, s49, v137
v_pk_fma_f16 v151, v152, v152, s48
v_and_b32 v139, s49, v139
v_pk_mul_f16 v154, v155, v154
v_lshrrev_b16 v136, 2, v137
v_pk_mul_f16 v151, v152, v151
v_lshrrev_b16 v138, 2, v139
v_exp_f16 v153, v154
v_fmac_f32 v159, v192, v192
ds_read_b128 v[224:227], v248 offset:49152
ds_read_u16_d16 v136, v136
ds_read_u16_d16 v138, v138
v_mfma_f32_32x32x16_bf16 v[120:135], v[228:231], v[172:175], v[120:135]
v_lshrrev_b32 v137, 18, v137
v_fmac_f32 v159, v193, v193
v_exp_f16 v150, v151
v_fmac_f32 v159, v194, v194
v_lshrrev_b32 v139, 18, v139
v_and_b32 v141, s49, v141
v_fmac_f32 v159, v195, v195
v_exp_f16_sdwa v153, v154 dst_sel:WORD_1 dst_unused:UNUSED_PRESERVE src0_sel:WORD_1
ds_read_b128 v[228:231], v248 offset:52224
ds_read_u16_d16_hi v137, v137
ds_read_u16_d16_hi v139, v139
v_mfma_f32_32x32x16_bf16 v[120:135], v[232:235], v[176:179], v[120:135]
v_fmac_f32 v159, v196, v196
v_and_b32 v143, s49, v143
v_lshrrev_b16 v140, 2, v141
v_fmac_f32 v159, v197, v197
v_exp_f16_sdwa v150, v151 dst_sel:WORD_1 dst_unused:UNUSED_PRESERVE src0_sel:WORD_1
v_fmac_f32 v159, v198, v198
v_lshrrev_b16 v142, 2, v143
v_pk_add_f16 v153, v153, 1.0 op_sel_hi:[1,0]
v_fmac_f32 v159, v199, v199
s_waitcnt lgkmcnt(5)
ds_read_b128 v[232:235], v248 offset:53248
ds_read_u16_d16 v140, v140
ds_read_u16_d16 v142, v142
v_mfma_f32_32x32x16_bf16 v[120:135], v[236:239], v[180:183], v[120:135]
v_lshrrev_b32 v141, 18, v141
v_pk_add_f16 v150, v150, 1.0 op_sel_hi:[1,0]
v_fmac_f32 v159, v200, v200
v_lshrrev_b32 v143, 18, v143
v_rcp_f16 v154, v153
v_fmac_f32 v159, v201, v201
v_and_b32 v145, s49, v145
v_and_b32 v147, s49, v147
v_fmac_f32 v159, v202, v202
ds_read_b128 v[236:239], v248 offset:56320
ds_read_u16_d16_hi v141, v141
ds_read_u16_d16_hi v143, v143
v_mfma_f32_32x32x16_bf16 v[120:135], v[224:227], v[184:187], v[120:135]
v_rcp_f16 v151, v150
v_fmac_f32 v159, v203, v203
v_lshrrev_b16 v144, 2, v145
s_setprio 0
v_rcp_f16_sdwa v154, v153 dst_sel:WORD_1 dst_unused:UNUSED_PRESERVE src0_sel:WORD_1
v_fmac_f32 v159, v204, v204
v_lshrrev_b16 v146, 2, v147
v_fmac_f32 v159, v205, v205
v_lshrrev_b32 v145, 18, v145
s_waitcnt lgkmcnt(4)
ds_read_b128 v[224:227], v248 offset:54272
ds_read_u16_d16 v144, v144
ds_read_u16_d16 v146, v146
ds_read_u16_d16_hi v145, v145
v_mfma_f32_32x32x16_bf16 v[120:135], v[228:231], v[188:191], v[120:135]
v_rcp_f16_sdwa v151, v150 dst_sel:WORD_1 dst_unused:UNUSED_PRESERVE src0_sel:WORD_1
v_fmac_f32 v159, v206, v206
v_lshrrev_b32 v147, 18, v147
v_fmac_f32 v159, v207, v207
v_or_b32 v32, v136, v137
v_or_b32 v33, v138, v139
v_permlane32_swap_b32 v158, v159
s_waitcnt lgkmcnt(5)
v_or_b32 v34, v140, v141
s_waitcnt lgkmcnt(4)
v_or_b32 v35, v142, v143
s_waitcnt lgkmcnt(0)
v_or_b32 v36, v144, v145
ds_read_u16_d16_hi v147, v147
s_waitcnt lgkmcnt(0)
v_or_b32 v37, v146, v147
v_add_f32 v158, v158, v159
ds_write_b32 v255, v158 offset:7424
v_pk_mul_f16 v38, v155, v154
v_pk_mul_f16 v39, v152, v151
s_setprio 2
ds_read_b128 v[228:231], v248 offset:57344
v_mfma_f32_32x32x16_f16 v[192:207], v[32:35], v[240:243], 0
v_cvt_pkrtz_f16_f32 v137, v120, v121
v_cvt_pkrtz_f16_f32 v139, v122, v123
v_cvt_pkrtz_f16_f32 v141, v124, v125
v_cvt_pkrtz_f16_f32 v143, v126, v127
v_cvt_pkrtz_f16_f32 v145, v128, v129
v_mfma_f32_32x32x16_f16 v[192:207], v[36:39], v[244:247], v[192:207]
v_cvt_pk_f16_f32 v155, v130, v131
v_cvt_pk_f16_f32 v152, v132, v133
v_cvt_pk_f16_f32 v149, v134, v135
v_pk_fma_f16 v154, v155, v155, s48
v_and_b32 v137, s49, v137
v_mfma_f32_32x32x16_bf16 v[120:135], v[232:235], v[168:171], 0
v_pk_fma_f16 v151, v152, v152, s48
v_and_b32 v139, s49, v139
v_pk_fma_f16 v148, v149, v149, s48
v_pk_mul_f16 v154, v155, v154
v_lshrrev_b16 v136, 2, v137
v_pk_mul_f16 v151, v152, v151
v_pk_mul_f16 v148, v149, v148
v_lshrrev_b16 v138, 2, v139
v_fmac_f32 v160, v192, v192
v_exp_f16 v153, v154
ds_read_b128 v[232:235], v248 offset:55296
ds_read_u16_d16 v136, v136
ds_read_u16_d16 v138, v138
v_mfma_f32_32x32x16_bf16 v[120:135], v[236:239], v[172:175], v[120:135]
v_fmac_f32 v160, v193, v193
v_lshrrev_b32 v137, 18, v137
v_exp_f16 v150, v151
v_fmac_f32 v160, v194, v194
v_lshrrev_b32 v139, 18, v139
v_exp_f16 v147, v148
v_fmac_f32 v160, v195, v195
v_and_b32 v141, s49, v141
ds_read_b128 v[236:239], v248 offset:58368
ds_read_u16_d16_hi v137, v137
ds_read_u16_d16_hi v139, v139
v_mfma_f32_32x32x16_bf16 v[120:135], v[224:227], v[176:179], v[120:135]
v_and_b32 v143, s49, v143
v_exp_f16_sdwa v153, v154 dst_sel:WORD_1 dst_unused:UNUSED_PRESERVE src0_sel:WORD_1
v_fmac_f32 v160, v196, v196
v_lshrrev_b16 v140, 2, v141
v_exp_f16_sdwa v150, v151 dst_sel:WORD_1 dst_unused:UNUSED_PRESERVE src0_sel:WORD_1
v_fmac_f32 v160, v197, v197
v_lshrrev_b16 v142, 2, v143
v_exp_f16_sdwa v147, v148 dst_sel:WORD_1 dst_unused:UNUSED_PRESERVE src0_sel:WORD_1
s_waitcnt lgkmcnt(6)
ds_read_b128 v[224:227], v248 offset:59392
ds_read_u16_d16 v140, v140
ds_read_u16_d16 v142, v142
v_mfma_f32_32x32x16_bf16 v[120:135], v[228:231], v[180:183], v[120:135]
v_fmac_f32 v160, v198, v198
v_lshrrev_b32 v141, 18, v141
v_pk_add_f16 v153, v153, 1.0 op_sel_hi:[1,0]
v_fmac_f32 v160, v199, v199
v_lshrrev_b32 v143, 18, v143
v_pk_add_f16 v150, v150, 1.0 op_sel_hi:[1,0]
v_pk_add_f16 v147, v147, 1.0 op_sel_hi:[1,0]
v_fmac_f32 v160, v200, v200
v_and_b32 v145, s49, v145
s_waitcnt lgkmcnt(4)
ds_read_b128 v[228:231], v248 offset:62464
ds_read_u16_d16_hi v141, v141
ds_read_u16_d16_hi v143, v143
v_mfma_f32_32x32x16_bf16 v[120:135], v[232:235], v[184:187], v[120:135]
v_rcp_f16 v154, v153
v_fmac_f32 v160, v201, v201
v_lshrrev_b16 v144, 2, v145
v_rcp_f16 v151, v150
v_fmac_f32 v160, v202, v202
v_lshrrev_b32 v145, 18, v145
v_rcp_f16 v148, v147
v_fmac_f32 v160, v203, v203
v_or_b32 v40, v136, v137
ds_read_b128 v[232:235], v248 offset:60416
ds_read_u16_d16 v144, v144
ds_read_u16_d16_hi v145, v145
v_mfma_f32_32x32x16_bf16 v[120:135], v[236:239], v[188:191], v[120:135]
s_waitcnt lgkmcnt(6)
v_or_b32 v41, v138, v139
v_rcp_f16_sdwa v154, v153 dst_sel:WORD_1 dst_unused:UNUSED_PRESERVE src0_sel:WORD_1
v_fmac_f32 v160, v204, v204
s_waitcnt lgkmcnt(4)
v_or_b32 v42, v140, v141
v_rcp_f16_sdwa v151, v150 dst_sel:WORD_1 dst_unused:UNUSED_PRESERVE src0_sel:WORD_1
v_fmac_f32 v160, v205, v205
s_waitcnt lgkmcnt(3)
v_or_b32 v43, v142, v143
v_rcp_f16_sdwa v148, v147 dst_sel:WORD_1 dst_unused:UNUSED_PRESERVE src0_sel:WORD_1
v_fmac_f32 v160, v206, v206
s_waitcnt lgkmcnt(0)
v_or_b32 v44, v144, v145
v_pk_mul_f16 v45, v155, v154
v_fmac_f32 v160, v207, v207
v_pk_mul_f16 v46, v152, v151
v_pk_mul_f16 v47, v149, v148
s_cmp_lg_u32 s40, 0
s_cbranch_scc1 Lrs2
v_min_u32 v80, 47, v251
v_lshlrev_b32 v80, 3, v80
v_add_u32 v81, 7936, v80
v_add_u32 v80, 15872, v80
v_cmp_gt_u32 vcc, 32, v251
s_nop 1
v_cndmask_b32 v80, v80, v81, vcc
s_waitcnt vmcnt(0)
ds_write_b64 v80, v[84:85]
Lrs2:
s_setprio 1
ds_read_b128 v[236:239], v248 offset:63488
v_mfma_f32_32x32x16_f16 v[192:207], v[40:43], v[240:243], 0
v_cvt_pkrtz_f16_f32 v137, v120, v121
v_cvt_pkrtz_f16_f32 v139, v122, v123
v_cvt_pkrtz_f16_f32 v141, v124, v125
v_cvt_pkrtz_f16_f32 v143, v126, v127
v_mfma_f32_32x32x16_f16 v[192:207], v[44:47], v[244:247], v[192:207]
s_waitcnt lgkmcnt(1)
v_cvt_pkrtz_f16_f32 v145, v128, v129
v_cvt_pkrtz_f16_f32 v147, v130, v131
v_cvt_pk_f16_f32 v155, v132, v133
v_cvt_pk_f16_f32 v152, v134, v135
v_pk_fma_f16 v154, v155, v155, s48
v_mfma_f32_32x32x16_bf16 v[120:135], v[224:227], v[168:171], 0
v_and_b32 v137, s49, v137
v_pk_fma_f16 v151, v152, v152, s48
v_and_b32 v139, s49, v139
v_pk_mul_f16 v154, v155, v154
v_lshrrev_b16 v136, 2, v137
v_pk_mul_f16 v151, v152, v151
v_lshrrev_b16 v138, 2, v139
v_exp_f16 v153, v154
v_fmac_f32 v161, v192, v192
ds_read_b128 v[224:227], v248 offset:61440
ds_read_u16_d16 v136, v136
ds_read_u16_d16 v138, v138
v_mfma_f32_32x32x16_bf16 v[120:135], v[228:231], v[172:175], v[120:135]
v_lshrrev_b32 v137, 18, v137
v_fmac_f32 v161, v193, v193
v_exp_f16 v150, v151
v_fmac_f32 v161, v194, v194
v_lshrrev_b32 v139, 18, v139
v_and_b32 v141, s49, v141
v_fmac_f32 v161, v195, v195
v_exp_f16_sdwa v153, v154 dst_sel:WORD_1 dst_unused:UNUSED_PRESERVE src0_sel:WORD_1
ds_read_b128 v[228:231], v248 offset:64512
ds_read_u16_d16_hi v137, v137
ds_read_u16_d16_hi v139, v139
v_mfma_f32_32x32x16_bf16 v[120:135], v[232:235], v[176:179], v[120:135]
v_fmac_f32 v161, v196, v196
v_and_b32 v143, s49, v143
v_lshrrev_b16 v140, 2, v141
v_fmac_f32 v161, v197, v197
v_exp_f16_sdwa v150, v151 dst_sel:WORD_1 dst_unused:UNUSED_PRESERVE src0_sel:WORD_1
v_fmac_f32 v161, v198, v198
v_lshrrev_b16 v142, 2, v143
v_pk_add_f16 v153, v153, 1.0 op_sel_hi:[1,0]
v_fmac_f32 v161, v199, v199
s_waitcnt lgkmcnt(5)
ds_read_b128 v[232:235], v249
ds_read_u16_d16 v140, v140
ds_read_u16_d16 v142, v142
v_mfma_f32_32x32x16_bf16 v[120:135], v[236:239], v[180:183], v[120:135]
v_lshrrev_b32 v141, 18, v141
v_pk_add_f16 v150, v150, 1.0 op_sel_hi:[1,0]
v_fmac_f32 v161, v200, v200
v_lshrrev_b32 v143, 18, v143
v_rcp_f16 v154, v153
v_fmac_f32 v161, v201, v201
v_and_b32 v145, s49, v145
v_and_b32 v147, s49, v147
v_fmac_f32 v161, v202, v202
ds_read_b128 v[236:239], v249 offset:3072
ds_read_u16_d16_hi v141, v141
ds_read_u16_d16_hi v143, v143
v_mfma_f32_32x32x16_bf16 v[120:135], v[224:227], v[184:187], v[120:135]
v_rcp_f16 v151, v150
v_fmac_f32 v161, v203, v203
v_lshrrev_b16 v144, 2, v145
s_setprio 0
v_rcp_f16_sdwa v154, v153 dst_sel:WORD_1 dst_unused:UNUSED_PRESERVE src0_sel:WORD_1
v_fmac_f32 v161, v204, v204
v_lshrrev_b16 v146, 2, v147
v_fmac_f32 v161, v205, v205
v_lshrrev_b32 v145, 18, v145
s_waitcnt lgkmcnt(4)
ds_read_b128 v[224:227], v249 offset:1024
ds_read_u16_d16 v144, v144
ds_read_u16_d16 v146, v146
ds_read_u16_d16_hi v145, v145
v_mfma_f32_32x32x16_bf16 v[120:135], v[228:231], v[188:191], v[120:135]
v_rcp_f16_sdwa v151, v150 dst_sel:WORD_1 dst_unused:UNUSED_PRESERVE src0_sel:WORD_1
v_fmac_f32 v161, v206, v206
v_lshrrev_b32 v147, 18, v147
v_fmac_f32 v161, v207, v207
v_or_b32 v48, v136, v137
v_or_b32 v49, v138, v139
v_permlane32_swap_b32 v160, v161
s_waitcnt lgkmcnt(5)
v_or_b32 v50, v140, v141
s_waitcnt lgkmcnt(4)
v_or_b32 v51, v142, v143
s_waitcnt lgkmcnt(0)
v_or_b32 v52, v144, v145
ds_read_u16_d16_hi v147, v147
s_waitcnt lgkmcnt(0)
v_or_b32 v53, v146, v147
v_add_f32 v160, v160, v161
ds_write_b32 v255, v160 offset:7680
v_pk_mul_f16 v54, v155, v154
v_pk_mul_f16 v55, v152, v151
s_setprio 2
ds_read_b128 v[228:231], v249 offset:4096
v_mfma_f32_32x32x16_f16 v[192:207], v[48:51], v[240:243], 0
v_cvt_pkrtz_f16_f32 v137, v120, v121
v_cvt_pkrtz_f16_f32 v139, v122, v123
v_cvt_pkrtz_f16_f32 v141, v124, v125
v_cvt_pkrtz_f16_f32 v143, v126, v127
v_cvt_pkrtz_f16_f32 v145, v128, v129
v_mfma_f32_32x32x16_f16 v[192:207], v[52:55], v[244:247], v[192:207]
v_cvt_pk_f16_f32 v155, v130, v131
v_cvt_pk_f16_f32 v152, v132, v133
v_cvt_pk_f16_f32 v149, v134, v135
v_pk_fma_f16 v154, v155, v155, s48
v_and_b32 v137, s49, v137
v_mfma_f32_32x32x16_bf16 v[120:135], v[232:235], v[168:171], 0
v_pk_fma_f16 v151, v152, v152, s48
v_and_b32 v139, s49, v139
v_pk_fma_f16 v148, v149, v149, s48
v_pk_mul_f16 v154, v155, v154
v_lshrrev_b16 v136, 2, v137
v_pk_mul_f16 v151, v152, v151
v_pk_mul_f16 v148, v149, v148
v_lshrrev_b16 v138, 2, v139
v_fmac_f32 v162, v192, v192
v_exp_f16 v153, v154
ds_read_b128 v[232:235], v249 offset:2048
ds_read_u16_d16 v136, v136
ds_read_u16_d16 v138, v138
v_mfma_f32_32x32x16_bf16 v[120:135], v[236:239], v[172:175], v[120:135]
v_fmac_f32 v162, v193, v193
v_lshrrev_b32 v137, 18, v137
v_exp_f16 v150, v151
v_fmac_f32 v162, v194, v194
v_lshrrev_b32 v139, 18, v139
v_exp_f16 v147, v148
v_fmac_f32 v162, v195, v195
v_and_b32 v141, s49, v141
ds_read_b128 v[236:239], v249 offset:5120
ds_read_u16_d16_hi v137, v137
ds_read_u16_d16_hi v139, v139
v_mfma_f32_32x32x16_bf16 v[120:135], v[224:227], v[176:179], v[120:135]
v_and_b32 v143, s49, v143
v_exp_f16_sdwa v153, v154 dst_sel:WORD_1 dst_unused:UNUSED_PRESERVE src0_sel:WORD_1
v_fmac_f32 v162, v196, v196
v_lshrrev_b16 v140, 2, v141
v_exp_f16_sdwa v150, v151 dst_sel:WORD_1 dst_unused:UNUSED_PRESERVE src0_sel:WORD_1
v_fmac_f32 v162, v197, v197
v_lshrrev_b16 v142, 2, v143
v_exp_f16_sdwa v147, v148 dst_sel:WORD_1 dst_unused:UNUSED_PRESERVE src0_sel:WORD_1
s_waitcnt lgkmcnt(6)
ds_read_b128 v[224:227], v249 offset:6144
ds_read_u16_d16 v140, v140
ds_read_u16_d16 v142, v142
v_mfma_f32_32x32x16_bf16 v[120:135], v[228:231], v[180:183], v[120:135]
v_fmac_f32 v162, v198, v198
v_lshrrev_b32 v141, 18, v141
v_pk_add_f16 v153, v153, 1.0 op_sel_hi:[1,0]
v_fmac_f32 v162, v199, v199
v_lshrrev_b32 v143, 18, v143
v_pk_add_f16 v150, v150, 1.0 op_sel_hi:[1,0]
v_pk_add_f16 v147, v147, 1.0 op_sel_hi:[1,0]
v_fmac_f32 v162, v200, v200
v_and_b32 v145, s49, v145
s_waitcnt lgkmcnt(4)
ds_read_b128 v[228:231], v249 offset:9216
ds_read_u16_d16_hi v141, v141
ds_read_u16_d16_hi v143, v143
v_mfma_f32_32x32x16_bf16 v[120:135], v[232:235], v[184:187], v[120:135]
v_rcp_f16 v154, v153
v_fmac_f32 v162, v201, v201
v_lshrrev_b16 v144, 2, v145
v_rcp_f16 v151, v150
v_fmac_f32 v162, v202, v202
v_lshrrev_b32 v145, 18, v145
v_rcp_f16 v148, v147
v_fmac_f32 v162, v203, v203
v_or_b32 v56, v136, v137
ds_read_b128 v[232:235], v249 offset:7168
ds_read_u16_d16 v144, v144
ds_read_u16_d16_hi v145, v145
v_mfma_f32_32x32x16_bf16 v[120:135], v[236:239], v[188:191], v[120:135]
s_waitcnt lgkmcnt(6)
v_or_b32 v57, v138, v139
v_rcp_f16_sdwa v154, v153 dst_sel:WORD_1 dst_unused:UNUSED_PRESERVE src0_sel:WORD_1
v_fmac_f32 v162, v204, v204
s_waitcnt lgkmcnt(4)
v_or_b32 v58, v140, v141
v_rcp_f16_sdwa v151, v150 dst_sel:WORD_1 dst_unused:UNUSED_PRESERVE src0_sel:WORD_1
v_fmac_f32 v162, v205, v205
s_waitcnt lgkmcnt(3)
v_or_b32 v59, v142, v143
v_rcp_f16_sdwa v148, v147 dst_sel:WORD_1 dst_unused:UNUSED_PRESERVE src0_sel:WORD_1
v_fmac_f32 v162, v206, v206
s_waitcnt lgkmcnt(0)
v_or_b32 v60, v144, v145
v_pk_mul_f16 v61, v155, v154
v_fmac_f32 v162, v207, v207
v_pk_mul_f16 v62, v152, v151
v_pk_mul_f16 v63, v149, v148
s_cmp_lg_u32 s40, 0
s_cbranch_scc1 Lrs3
v_mov_b32 v250, 1
v_mov_b32 v82, 0
s_mov_b64 exec, 1
buffer_atomic_add v250, v82, s[36:39], 0 offen offset:128 sc0
s_mov_b64 exec, -1
Lrs3:
s_setprio 1
ds_read_b128 v[236:239], v249 offset:10240
v_mfma_f32_32x32x16_f16 v[192:207], v[56:59], v[240:243], 0
v_cvt_pkrtz_f16_f32 v137, v120, v121
v_cvt_pkrtz_f16_f32 v139, v122, v123
v_cvt_pkrtz_f16_f32 v141, v124, v125
v_cvt_pkrtz_f16_f32 v143, v126, v127
v_mfma_f32_32x32x16_f16 v[192:207], v[60:63], v[244:247], v[192:207]
v_cvt_pkrtz_f16_f32 v145, v128, v129
v_cvt_pkrtz_f16_f32 v147, v130, v131
v_cvt_pk_f16_f32 v155, v132, v133
v_cvt_pk_f16_f32 v152, v134, v135
v_pk_fma_f16 v154, v155, v155, s48
v_mfma_f32_32x32x16_bf16 v[120:135], v[224:227], v[168:171], 0
v_and_b32 v137, s49, v137
v_pk_fma_f16 v151, v152, v152, s48
v_and_b32 v139, s49, v139
v_pk_mul_f16 v154, v155, v154
v_lshrrev_b16 v136, 2, v137
v_pk_mul_f16 v151, v152, v151
v_lshrrev_b16 v138, 2, v139
v_exp_f16 v153, v154
v_fmac_f32 v163, v192, v192
ds_read_b128 v[224:227], v249 offset:8192
ds_read_u16_d16 v136, v136
ds_read_u16_d16 v138, v138
v_mfma_f32_32x32x16_bf16 v[120:135], v[228:231], v[172:175], v[120:135]
v_lshrrev_b32 v137, 18, v137
v_fmac_f32 v163, v193, v193
v_exp_f16 v150, v151
v_fmac_f32 v163, v194, v194
v_lshrrev_b32 v139, 18, v139
v_and_b32 v141, s49, v141
v_fmac_f32 v163, v195, v195
v_exp_f16_sdwa v153, v154 dst_sel:WORD_1 dst_unused:UNUSED_PRESERVE src0_sel:WORD_1
ds_read_b128 v[228:231], v249 offset:11264
ds_read_u16_d16_hi v137, v137
ds_read_u16_d16_hi v139, v139
v_mfma_f32_32x32x16_bf16 v[120:135], v[232:235], v[176:179], v[120:135]
v_fmac_f32 v163, v196, v196
v_and_b32 v143, s49, v143
v_lshrrev_b16 v140, 2, v141
v_fmac_f32 v163, v197, v197
v_exp_f16_sdwa v150, v151 dst_sel:WORD_1 dst_unused:UNUSED_PRESERVE src0_sel:WORD_1
v_fmac_f32 v163, v198, v198
v_lshrrev_b16 v142, 2, v143
v_pk_add_f16 v153, v153, 1.0 op_sel_hi:[1,0]
v_fmac_f32 v163, v199, v199
s_waitcnt lgkmcnt(5)
ds_read_b128 v[232:235], v249 offset:12288
ds_read_u16_d16 v140, v140
ds_read_u16_d16 v142, v142
v_mfma_f32_32x32x16_bf16 v[120:135], v[236:239], v[180:183], v[120:135]
v_lshrrev_b32 v141, 18, v141
v_pk_add_f16 v150, v150, 1.0 op_sel_hi:[1,0]
v_fmac_f32 v163, v200, v200
v_lshrrev_b32 v143, 18, v143
v_rcp_f16 v154, v153
v_fmac_f32 v163, v201, v201
v_and_b32 v145, s49, v145
v_and_b32 v147, s49, v147
v_fmac_f32 v163, v202, v202
ds_read_b128 v[236:239], v249 offset:15360
ds_read_u16_d16_hi v141, v141
ds_read_u16_d16_hi v143, v143
v_mfma_f32_32x32x16_bf16 v[120:135], v[224:227], v[184:187], v[120:135]
v_rcp_f16 v151, v150
v_fmac_f32 v163, v203, v203
v_lshrrev_b16 v144, 2, v145
s_setprio 0
v_rcp_f16_sdwa v154, v153 dst_sel:WORD_1 dst_unused:UNUSED_PRESERVE src0_sel:WORD_1
v_fmac_f32 v163, v204, v204
v_lshrrev_b16 v146, 2, v147
v_fmac_f32 v163, v205, v205
v_lshrrev_b32 v145, 18, v145
s_waitcnt lgkmcnt(4)
ds_read_b128 v[224:227], v249 offset:13312
ds_read_u16_d16 v144, v144
ds_read_u16_d16 v146, v146
ds_read_u16_d16_hi v145, v145
v_mfma_f32_32x32x16_bf16 v[120:135], v[228:231], v[188:191], v[120:135]
v_rcp_f16_sdwa v151, v150 dst_sel:WORD_1 dst_unused:UNUSED_PRESERVE src0_sel:WORD_1
v_fmac_f32 v163, v206, v206
v_lshrrev_b32 v147, 18, v147
v_fmac_f32 v163, v207, v207
v_or_b32 v64, v136, v137
v_or_b32 v65, v138, v139
v_permlane32_swap_b32 v162, v163
s_waitcnt lgkmcnt(5)
v_or_b32 v66, v140, v141
s_waitcnt lgkmcnt(4)
v_or_b32 v67, v142, v143
s_waitcnt lgkmcnt(0)
v_or_b32 v68, v144, v145
ds_read_u16_d16_hi v147, v147
s_waitcnt lgkmcnt(0)
v_or_b32 v69, v146, v147
v_add_f32 v162, v162, v163
ds_write_b32 v255, v162 offset:7936
v_pk_mul_f16 v70, v155, v154
v_pk_mul_f16 v71, v152, v151
s_setprio 2
ds_read_b128 v[228:231], v249 offset:16384
v_mfma_f32_32x32x16_f16 v[192:207], v[64:67], v[240:243], 0
v_cvt_pkrtz_f16_f32 v137, v120, v121
v_cvt_pkrtz_f16_f32 v139, v122, v123
v_cvt_pkrtz_f16_f32 v141, v124, v125
v_cvt_pkrtz_f16_f32 v143, v126, v127
v_cvt_pkrtz_f16_f32 v145, v128, v129
v_mfma_f32_32x32x16_f16 v[192:207], v[68:71], v[244:247], v[192:207]
v_cvt_pk_f16_f32 v155, v130, v131
v_cvt_pk_f16_f32 v152, v132, v133
v_cvt_pk_f16_f32 v149, v134, v135
v_pk_fma_f16 v154, v155, v155, s48
v_and_b32 v137, s49, v137
v_mfma_f32_32x32x16_bf16 v[120:135], v[232:235], v[168:171], 0
v_pk_fma_f16 v151, v152, v152, s48
v_and_b32 v139, s49, v139
v_pk_fma_f16 v148, v149, v149, s48
v_pk_mul_f16 v154, v155, v154
v_lshrrev_b16 v136, 2, v137
v_pk_mul_f16 v151, v152, v151
v_pk_mul_f16 v148, v149, v148
v_lshrrev_b16 v138, 2, v139
v_fmac_f32 v164, v192, v192
v_exp_f16 v153, v154
ds_read_b128 v[232:235], v249 offset:14336
ds_read_u16_d16 v136, v136
ds_read_u16_d16 v138, v138
v_mfma_f32_32x32x16_bf16 v[120:135], v[236:239], v[172:175], v[120:135]
v_fmac_f32 v164, v193, v193
v_lshrrev_b32 v137, 18, v137
v_exp_f16 v150, v151
v_fmac_f32 v164, v194, v194
v_lshrrev_b32 v139, 18, v139
v_exp_f16 v147, v148
v_fmac_f32 v164, v195, v195
v_and_b32 v141, s49, v141
ds_read_b128 v[236:239], v249 offset:17408
ds_read_u16_d16_hi v137, v137
ds_read_u16_d16_hi v139, v139
v_mfma_f32_32x32x16_bf16 v[120:135], v[224:227], v[176:179], v[120:135]
v_and_b32 v143, s49, v143
v_exp_f16_sdwa v153, v154 dst_sel:WORD_1 dst_unused:UNUSED_PRESERVE src0_sel:WORD_1
v_fmac_f32 v164, v196, v196
v_lshrrev_b16 v140, 2, v141
v_exp_f16_sdwa v150, v151 dst_sel:WORD_1 dst_unused:UNUSED_PRESERVE src0_sel:WORD_1
v_fmac_f32 v164, v197, v197
v_lshrrev_b16 v142, 2, v143
v_exp_f16_sdwa v147, v148 dst_sel:WORD_1 dst_unused:UNUSED_PRESERVE src0_sel:WORD_1
s_waitcnt lgkmcnt(6)
ds_read_b128 v[224:227], v249 offset:18432
ds_read_u16_d16 v140, v140
ds_read_u16_d16 v142, v142
v_mfma_f32_32x32x16_bf16 v[120:135], v[228:231], v[180:183], v[120:135]
v_fmac_f32 v164, v198, v198
v_lshrrev_b32 v141, 18, v141
v_pk_add_f16 v153, v153, 1.0 op_sel_hi:[1,0]
v_fmac_f32 v164, v199, v199
v_lshrrev_b32 v143, 18, v143
v_pk_add_f16 v150, v150, 1.0 op_sel_hi:[1,0]
v_pk_add_f16 v147, v147, 1.0 op_sel_hi:[1,0]
v_fmac_f32 v164, v200, v200
v_and_b32 v145, s49, v145
s_waitcnt lgkmcnt(4)
ds_read_b128 v[228:231], v249 offset:21504
ds_read_u16_d16_hi v141, v141
ds_read_u16_d16_hi v143, v143
v_mfma_f32_32x32x16_bf16 v[120:135], v[232:235], v[184:187], v[120:135]
v_rcp_f16 v154, v153
v_fmac_f32 v164, v201, v201
v_lshrrev_b16 v144, 2, v145
v_rcp_f16 v151, v150
v_fmac_f32 v164, v202, v202
v_lshrrev_b32 v145, 18, v145
v_rcp_f16 v148, v147
v_fmac_f32 v164, v203, v203
v_or_b32 v72, v136, v137
ds_read_b128 v[232:235], v249 offset:19456
ds_read_u16_d16 v144, v144
ds_read_u16_d16_hi v145, v145
v_mfma_f32_32x32x16_bf16 v[120:135], v[236:239], v[188:191], v[120:135]
s_waitcnt lgkmcnt(6)
v_or_b32 v73, v138, v139
v_rcp_f16_sdwa v154, v153 dst_sel:WORD_1 dst_unused:UNUSED_PRESERVE src0_sel:WORD_1
v_fmac_f32 v164, v204, v204
s_waitcnt lgkmcnt(4)
v_or_b32 v74, v140, v141
v_rcp_f16_sdwa v151, v150 dst_sel:WORD_1 dst_unused:UNUSED_PRESERVE src0_sel:WORD_1
v_fmac_f32 v164, v205, v205
s_waitcnt lgkmcnt(3)
v_or_b32 v75, v142, v143
v_rcp_f16_sdwa v148, v147 dst_sel:WORD_1 dst_unused:UNUSED_PRESERVE src0_sel:WORD_1
v_fmac_f32 v164, v206, v206
s_waitcnt lgkmcnt(0)
v_or_b32 v76, v144, v145
v_pk_mul_f16 v77, v155, v154
v_fmac_f32 v164, v207, v207
v_pk_mul_f16 v78, v152, v151
v_pk_mul_f16 v79, v149, v148
s_setprio 1
ds_read_b128 v[236:239], v249 offset:22528
v_mfma_f32_32x32x16_f16 v[192:207], v[72:75], v[240:243], 0
v_cvt_pkrtz_f16_f32 v137, v120, v121
v_cvt_pkrtz_f16_f32 v139, v122, v123
v_cvt_pkrtz_f16_f32 v141, v124, v125
v_cvt_pkrtz_f16_f32 v143, v126, v127
v_mfma_f32_32x32x16_f16 v[192:207], v[76:79], v[244:247], v[192:207]
v_cvt_pkrtz_f16_f32 v145, v128, v129
v_cvt_pkrtz_f16_f32 v147, v130, v131
v_cvt_pk_f16_f32 v155, v132, v133
v_cvt_pk_f16_f32 v152, v134, v135
v_pk_fma_f16 v154, v155, v155, s48
v_mfma_f32_32x32x16_bf16 v[120:135], v[224:227], v[168:171], 0
v_and_b32 v137, s49, v137
v_pk_fma_f16 v151, v152, v152, s48
v_and_b32 v139, s49, v139
v_pk_mul_f16 v154, v155, v154
v_lshrrev_b16 v136, 2, v137
v_pk_mul_f16 v151, v152, v151
v_lshrrev_b16 v138, 2, v139
v_exp_f16 v153, v154
v_fmac_f32 v165, v192, v192
ds_read_b128 v[224:227], v249 offset:20480
ds_read_u16_d16 v136, v136
ds_read_u16_d16 v138, v138
v_mfma_f32_32x32x16_bf16 v[120:135], v[228:231], v[172:175], v[120:135]
v_lshrrev_b32 v137, 18, v137
v_fmac_f32 v165, v193, v193
v_exp_f16 v150, v151
v_fmac_f32 v165, v194, v194
v_lshrrev_b32 v139, 18, v139
v_and_b32 v141, s49, v141
v_fmac_f32 v165, v195, v195
v_exp_f16_sdwa v153, v154 dst_sel:WORD_1 dst_unused:UNUSED_PRESERVE src0_sel:WORD_1
ds_read_b128 v[228:231], v249 offset:23552
ds_read_u16_d16_hi v137, v137
ds_read_u16_d16_hi v139, v139
v_mfma_f32_32x32x16_bf16 v[120:135], v[232:235], v[176:179], v[120:135]
v_fmac_f32 v165, v196, v196
v_and_b32 v143, s49, v143
v_lshrrev_b16 v140, 2, v141
v_fmac_f32 v165, v197, v197
v_exp_f16_sdwa v150, v151 dst_sel:WORD_1 dst_unused:UNUSED_PRESERVE src0_sel:WORD_1
v_fmac_f32 v165, v198, v198
v_lshrrev_b16 v142, 2, v143
v_pk_add_f16 v153, v153, 1.0 op_sel_hi:[1,0]
v_fmac_f32 v165, v199, v199
s_waitcnt lgkmcnt(5)
ds_read_b128 v[232:235], v248 offset:47104
ds_read_u16_d16 v140, v140
ds_read_u16_d16 v142, v142
v_mfma_f32_32x32x16_bf16 v[120:135], v[236:239], v[180:183], v[120:135]
v_lshrrev_b32 v141, 18, v141
v_pk_add_f16 v150, v150, 1.0 op_sel_hi:[1,0]
v_fmac_f32 v165, v200, v200
v_lshrrev_b32 v143, 18, v143
v_rcp_f16 v154, v153
v_fmac_f32 v165, v201, v201
v_and_b32 v145, s49, v145
v_and_b32 v147, s49, v147
v_fmac_f32 v165, v202, v202
ds_read_b128 v[236:239], v248 offset:50176
ds_read_u16_d16_hi v141, v141
ds_read_u16_d16_hi v143, v143
v_mfma_f32_32x32x16_bf16 v[120:135], v[224:227], v[184:187], v[120:135]
v_rcp_f16 v151, v150
v_fmac_f32 v165, v203, v203
v_lshrrev_b16 v144, 2, v145
s_setprio 0
v_rcp_f16_sdwa v154, v153 dst_sel:WORD_1 dst_unused:UNUSED_PRESERVE src0_sel:WORD_1
v_fmac_f32 v165, v204, v204
v_lshrrev_b16 v146, 2, v147
v_fmac_f32 v165, v205, v205
v_lshrrev_b32 v145, 18, v145
s_waitcnt lgkmcnt(4)
ds_read_b128 v[224:227], v248 offset:48128
ds_read_u16_d16 v144, v144
ds_read_u16_d16 v146, v146
ds_read_u16_d16_hi v145, v145
v_mfma_f32_32x32x16_bf16 v[120:135], v[228:231], v[188:191], v[120:135]
v_rcp_f16_sdwa v151, v150 dst_sel:WORD_1 dst_unused:UNUSED_PRESERVE src0_sel:WORD_1
v_fmac_f32 v165, v206, v206
v_lshrrev_b32 v147, 18, v147
v_fmac_f32 v165, v207, v207
v_or_b32 v80, v136, v137
v_or_b32 v81, v138, v139
v_permlane32_swap_b32 v164, v165
s_waitcnt lgkmcnt(5)
v_or_b32 v82, v140, v141
s_waitcnt lgkmcnt(4)
v_or_b32 v83, v142, v143
s_waitcnt lgkmcnt(0)
v_or_b32 v84, v144, v145
ds_read_u16_d16_hi v147, v147
s_waitcnt lgkmcnt(0)
v_or_b32 v85, v146, v147
v_add_f32 v164, v164, v165
ds_write_b32 v255, v164 offset:8192
v_pk_mul_f16 v86, v155, v154
v_pk_mul_f16 v87, v152, v151
s_setprio 2
ds_read_b128 v[228:231], v248 offset:51200
v_mfma_f32_32x32x16_f16 v[192:207], v[80:83], v[240:243], 0
v_cvt_pkrtz_f16_f32 v137, v120, v121
v_cvt_pkrtz_f16_f32 v139, v122, v123
v_cvt_pkrtz_f16_f32 v141, v124, v125
v_cvt_pkrtz_f16_f32 v143, v126, v127
v_cvt_pkrtz_f16_f32 v145, v128, v129
v_mfma_f32_32x32x16_f16 v[192:207], v[84:87], v[244:247], v[192:207]
v_cvt_pk_f16_f32 v155, v130, v131
v_cvt_pk_f16_f32 v152, v132, v133
v_cvt_pk_f16_f32 v149, v134, v135
v_pk_fma_f16 v154, v155, v155, s48
v_and_b32 v137, s49, v137
v_mfma_f32_32x32x16_bf16 v[120:135], v[232:235], v[96:99], 0
v_pk_fma_f16 v151, v152, v152, s48
v_and_b32 v139, s49, v139
v_pk_fma_f16 v148, v149, v149, s48
v_pk_mul_f16 v154, v155, v154
v_lshrrev_b16 v136, 2, v137
v_pk_mul_f16 v151, v152, v151
v_pk_mul_f16 v148, v149, v148
v_lshrrev_b16 v138, 2, v139
v_fmac_f32 v166, v192, v192
v_exp_f16 v153, v154
ds_read_b128 v[232:235], v248 offset:49152
ds_read_u16_d16 v136, v136
ds_read_u16_d16 v138, v138
v_mfma_f32_32x32x16_bf16 v[120:135], v[236:239], v[100:103], v[120:135]
v_fmac_f32 v166, v193, v193
v_lshrrev_b32 v137, 18, v137
v_exp_f16 v150, v151
v_fmac_f32 v166, v194, v194
v_lshrrev_b32 v139, 18, v139
v_exp_f16 v147, v148
v_fmac_f32 v166, v195, v195
v_and_b32 v141, s49, v141
ds_read_b128 v[236:239], v248 offset:52224
ds_read_u16_d16_hi v137, v137
ds_read_u16_d16_hi v139, v139
v_mfma_f32_32x32x16_bf16 v[120:135], v[224:227], v[104:107], v[120:135]
v_and_b32 v143, s49, v143
v_exp_f16_sdwa v153, v154 dst_sel:WORD_1 dst_unused:UNUSED_PRESERVE src0_sel:WORD_1
v_fmac_f32 v166, v196, v196
v_lshrrev_b16 v140, 2, v141
v_exp_f16_sdwa v150, v151 dst_sel:WORD_1 dst_unused:UNUSED_PRESERVE src0_sel:WORD_1
v_fmac_f32 v166, v197, v197
v_lshrrev_b16 v142, 2, v143
v_exp_f16_sdwa v147, v148 dst_sel:WORD_1 dst_unused:UNUSED_PRESERVE src0_sel:WORD_1
s_waitcnt lgkmcnt(6)
ds_read_b128 v[224:227], v248 offset:53248
ds_read_u16_d16 v140, v140
ds_read_u16_d16 v142, v142
v_mfma_f32_32x32x16_bf16 v[120:135], v[228:231], v[108:111], v[120:135]
v_fmac_f32 v166, v198, v198
v_lshrrev_b32 v141, 18, v141
v_pk_add_f16 v153, v153, 1.0 op_sel_hi:[1,0]
v_fmac_f32 v166, v199, v199
v_lshrrev_b32 v143, 18, v143
v_pk_add_f16 v150, v150, 1.0 op_sel_hi:[1,0]
v_pk_add_f16 v147, v147, 1.0 op_sel_hi:[1,0]
v_fmac_f32 v166, v200, v200
v_and_b32 v145, s49, v145
s_waitcnt lgkmcnt(4)
ds_read_b128 v[228:231], v248 offset:56320
ds_read_u16_d16_hi v141, v141
ds_read_u16_d16_hi v143, v143
v_mfma_f32_32x32x16_bf16 v[120:135], v[232:235], v[112:115], v[120:135]
v_rcp_f16 v154, v153
v_fmac_f32 v166, v201, v201
v_lshrrev_b16 v144, 2, v145
v_rcp_f16 v151, v150
v_fmac_f32 v166, v202, v202
v_lshrrev_b32 v145, 18, v145
v_rcp_f16 v148, v147
v_fmac_f32 v166, v203, v203
v_or_b32 v168, v136, v137
ds_read_b128 v[232:235], v248 offset:54272
ds_read_u16_d16 v144, v144
ds_read_u16_d16_hi v145, v145
v_mfma_f32_32x32x16_bf16 v[120:135], v[236:239], v[116:119], v[120:135]
s_waitcnt lgkmcnt(6)
v_or_b32 v169, v138, v139
v_rcp_f16_sdwa v154, v153 dst_sel:WORD_1 dst_unused:UNUSED_PRESERVE src0_sel:WORD_1
v_fmac_f32 v166, v204, v204
s_waitcnt lgkmcnt(4)
v_or_b32 v170, v140, v141
v_rcp_f16_sdwa v151, v150 dst_sel:WORD_1 dst_unused:UNUSED_PRESERVE src0_sel:WORD_1
v_fmac_f32 v166, v205, v205
s_waitcnt lgkmcnt(3)
v_or_b32 v171, v142, v143
v_rcp_f16_sdwa v148, v147 dst_sel:WORD_1 dst_unused:UNUSED_PRESERVE src0_sel:WORD_1
v_fmac_f32 v166, v206, v206
s_waitcnt lgkmcnt(0)
v_or_b32 v172, v144, v145
v_pk_mul_f16 v173, v155, v154
v_fmac_f32 v166, v207, v207
v_pk_mul_f16 v174, v152, v151
v_pk_mul_f16 v175, v149, v148
s_cmp_lg_u32 s40, 0
s_cbranch_scc1 Lrs4
s_waitcnt vmcnt(0)
v_readfirstlane_b32 s3, v250
s_nop 1
s_and_b32 s3, s3, 255
Lrs4:
s_setprio 1
ds_read_b128 v[236:239], v248 offset:57344
v_mfma_f32_32x32x16_f16 v[192:207], v[168:171], v[240:243], 0
v_cvt_pkrtz_f16_f32 v137, v120, v121
v_cvt_pkrtz_f16_f32 v139, v122, v123
v_cvt_pkrtz_f16_f32 v141, v124, v125
v_cvt_pkrtz_f16_f32 v143, v126, v127
v_cvt_pkrtz_f16_f32 v145, v128, v129
v_mfma_f32_32x32x16_f16 v[192:207], v[172:175], v[244:247], v[192:207]
v_cvt_pk_f16_f32 v155, v130, v131
v_cvt_pk_f16_f32 v152, v132, v133
v_cvt_pk_f16_f32 v149, v134, v135
v_pk_fma_f16 v154, v155, v155, s48
v_and_b32 v137, s49, v137
v_pk_fma_f16 v151, v152, v152, s48
v_mfma_f32_32x32x16_bf16 v[120:135], v[224:227], v[96:99], 0
v_and_b32 v139, s49, v139
v_pk_fma_f16 v148, v149, v149, s48
v_pk_mul_f16 v154, v155, v154
v_lshrrev_b16 v136, 2, v137
v_pk_mul_f16 v151, v152, v151
v_pk_mul_f16 v148, v149, v148
v_fmac_f32 v167, v192, v192
v_fmac_f32 v167, v193, v193
v_fmac_f32 v167, v194, v194
v_fmac_f32 v167, v195, v195
v_fmac_f32 v167, v196, v196
ds_read_b128 v[224:227], v248 offset:55296
ds_read_u16_d16 v136, v136
v_mfma_f32_32x32x16_bf16 v[120:135], v[228:231], v[100:103], v[120:135]
v_fmac_f32 v167, v197, v197
v_fmac_f32 v167, v198, v198
v_fmac_f32 v167, v199, v199
v_fmac_f32 v167, v200, v200
v_fmac_f32 v167, v201, v201
v_fmac_f32 v167, v202, v202
v_fmac_f32 v167, v203, v203
v_fmac_f32 v167, v204, v204
v_fmac_f32 v167, v205, v205
v_fmac_f32 v167, v206, v206
v_fmac_f32 v167, v207, v207
ds_read_b128 v[228:231], v248 offset:58368
v_mfma_f32_32x32x16_bf16 v[120:135], v[232:235], v[104:107], v[120:135]
v_permlane32_swap_b32 v166, v167
v_add_f32 v166, v166, v167
ds_write_b32 v255, v166 offset:8448
s_setprio 3
s_mov_b64 exec, 1
ds_add_rtn_u32 v242, v253, v254
s_mov_b64 exec, -1
s_waitcnt lgkmcnt(0)
v_readfirstlane_b32 s43, v242
s_nop 1
s_cmp_lg_u32 s43, 7
s_cbranch_scc1 Lnopub
v_min_u32 v243, 47, v251
v_lshlrev_b32 v244, 5, v243
v_add_u32 v244, 97280, v244
ds_read_b128 v[176:179], v244
ds_read_b128 v[180:183], v244 offset:16
ds_read_b128 v[184:187], v244 offset:9216
ds_read_b128 v[188:191], v244 offset:9232
ds_read_b128 v[192:195], v244 offset:18432
ds_read_b128 v[196:199], v244 offset:18448
ds_read_b128 v[200:203], v244 offset:27648
ds_read_b128 v[204:207], v244 offset:27664
ds_read_b128 v[156:159], v244 offset:36864
ds_read_b128 v[160:163], v244 offset:36880
v_lshlrev_b32 v246, 13, v243
v_add_u32 v247, 4096, v246
s_waitcnt lgkmcnt(7)
v_add_f32 v176, v176, v184
v_add_f32 v177, v177, v185
v_add_f32 v178, v178, v186
v_add_f32 v179, v179, v187
s_waitcnt lgkmcnt(6)
v_add_f32 v180, v180, v188
v_add_f32 v181, v181, v189
v_add_f32 v182, v182, v190
v_add_f32 v183, v183, v191
ds_read_b128 v[184:187], v244 offset:46080
ds_read_b128 v[188:191], v244 offset:46096
s_waitcnt lgkmcnt(5)
v_add_f32 v192, v192, v200
v_add_f32 v193, v193, v201
v_add_f32 v194, v194, v202
v_add_f32 v195, v195, v203
s_waitcnt lgkmcnt(4)
v_add_f32 v196, v196, v204
v_add_f32 v197, v197, v205
v_add_f32 v198, v198, v206
v_add_f32 v199, v199, v207
ds_read_b128 v[200:203], v244 offset:55296
ds_read_b128 v[204:207], v244 offset:55312
v_add_f32 v176, v176, v192
v_add_f32 v177, v177, v193
v_add_f32 v178, v178, v194
v_add_f32 v179, v179, v195
v_add_f32 v180, v180, v196
v_add_f32 v181, v181, v197
v_add_f32 v182, v182, v198
v_add_f32 v183, v183, v199
ds_read_b128 v[192:195], v244 offset:64512
ds_read_b128 v[196:199], v244 offset:64528
s_waitcnt lgkmcnt(5)
v_add_f32 v156, v156, v184
v_add_f32 v157, v157, v185
v_add_f32 v158, v158, v186
v_add_f32 v159, v159, v187
s_waitcnt lgkmcnt(4)
v_add_f32 v160, v160, v188
v_add_f32 v161, v161, v189
v_add_f32 v162, v162, v190
v_add_f32 v163, v163, v191
s_waitcnt lgkmcnt(1)
v_add_f32 v200, v200, v192
v_add_f32 v201, v201, v193
v_add_f32 v202, v202, v194
v_add_f32 v203, v203, v195
s_waitcnt lgkmcnt(0)
v_add_f32 v204, v204, v196
v_add_f32 v205, v205, v197
v_add_f32 v206, v206, v198
v_add_f32 v207, v207, v199
v_add_f32 v156, v156, v200
v_add_f32 v157, v157, v201
v_add_f32 v158, v158, v202
v_add_f32 v159, v159, v203
v_add_f32 v160, v160, v204
v_add_f32 v161, v161, v205
v_add_f32 v162, v162, v206
v_add_f32 v163, v163, v207
v_add_f32 v176, v176, v156
v_add_f32 v177, v177, v157
v_add_f32 v178, v178, v158
v_add_f32 v179, v179, v159
v_add_f32 v180, v180, v160
v_add_f32 v181, v181, v161
v_add_f32 v182, v182, v162
v_add_f32 v183, v183, v163
v_min_u32 v184, -2, v176
v_min_u32 v185, -2, v177
v_min_u32 v186, -2, v178
v_min_u32 v187, -2, v179
v_min_u32 v188, -2, v180
v_min_u32 v189, -2, v181
v_min_u32 v190, -2, v182
v_min_u32 v191, -2, v183
s_lshl_b32 s43, s2, 4
buffer_store_dwordx4 v[184:187], v246, s[32:35], s43 offen sc1
buffer_store_dwordx4 v[188:191], v247, s[32:35], s43 offen sc1
ds_write_b32 v253, v254 offset:4
s_nop 1
Lnopub:
s_mov_b32 s77, 0
s_cmp_lg_u32 s40, 0
s_cbranch_scc1 Lnorole
s_cmp_lt_u32 s3, 96
s_cselect_b32 s77, 1, 2
s_waitcnt lgkmcnt(0)
v_mov_b32 v156, -1
v_mov_b32 v157, -1
v_mov_b32 v158, -1
v_mov_b32 v159, -1
v_mov_b32 v160, -1
v_mov_b32 v161, -1
v_mov_b32 v162, -1
v_mov_b32 v163, -1
v_mov_b32 v164, -1
v_mov_b32 v165, -1
v_mov_b32 v166, -1
v_mov_b32 v167, -1
v_mov_b32 v252, -1
v_mov_b32 v253, -1
v_mov_b32 v254, -1
v_mov_b32 v255, -1
s_cbranch_scc1 Lrole1
s_call_b64 s[78:79], LpollG
s_branch Lnorole
Lrole1:
s_call_b64 s[78:79], Lpoll1
Lnorole:
s_setprio 1
v_lshrrev_b16 v138, 2, v139
v_exp_f16 v153, v154
v_lshrrev_b32 v137, 18, v137
v_exp_f16 v150, v151
v_lshrrev_b32 v139, 18, v139
ds_read_b128 v[232:235], v248 offset:59392
ds_read_u16_d16 v138, v138
ds_read_u16_d16_hi v137, v137
ds_read_u16_d16_hi v139, v139
v_mfma_f32_32x32x16_bf16 v[120:135], v[236:239], v[108:111], v[120:135]
v_exp_f16 v147, v148
v_and_b32 v141, s49, v141
v_and_b32 v143, s49, v143
v_exp_f16_sdwa v153, v154 dst_sel:WORD_1 dst_unused:UNUSED_PRESERVE src0_sel:WORD_1
v_lshrrev_b16 v140, 2, v141
v_exp_f16_sdwa v150, v151 dst_sel:WORD_1 dst_unused:UNUSED_PRESERVE src0_sel:WORD_1
v_lshrrev_b16 v142, 2, v143
v_exp_f16_sdwa v147, v148 dst_sel:WORD_1 dst_unused:UNUSED_PRESERVE src0_sel:WORD_1
ds_read_b128 v[236:239], v248 offset:62464
ds_read_u16_d16 v140, v140
ds_read_u16_d16 v142, v142
v_mfma_f32_32x32x16_bf16 v[120:135], v[224:227], v[112:115], v[120:135]
v_lshrrev_b32 v141, 18, v141
v_pk_add_f16 v153, v153, 1.0 op_sel_hi:[1,0]
v_lshrrev_b32 v143, 18, v143
v_pk_add_f16 v150, v150, 1.0 op_sel_hi:[1,0]
s_setprio 0
v_pk_add_f16 v147, v147, 1.0 op_sel_hi:[1,0]
v_and_b32 v145, s49, v145
v_rcp_f16 v154, v153
v_lshrrev_b16 v144, 2, v145
v_rcp_f16 v151, v150
ds_read_b128 v[224:227], v248 offset:60416
ds_read_u16_d16_hi v141, v141
ds_read_u16_d16_hi v143, v143
ds_read_u16_d16 v144, v144
v_mfma_f32_32x32x16_bf16 v[120:135], v[228:231], v[116:119], v[120:135]
v_lshrrev_b32 v145, 18, v145
v_rcp_f16 v148, v147
s_waitcnt lgkmcnt(7)
v_or_b32 v176, v136, v137
v_or_b32 v177, v138, v139
v_rcp_f16_sdwa v154, v153 dst_sel:WORD_1 dst_unused:UNUSED_PRESERVE src0_sel:WORD_1
s_waitcnt lgkmcnt(2)
v_or_b32 v178, v140, v141
v_rcp_f16_sdwa v151, v150 dst_sel:WORD_1 dst_unused:UNUSED_PRESERVE src0_sel:WORD_1
s_waitcnt lgkmcnt(1)
v_or_b32 v179, v142, v143
v_rcp_f16_sdwa v148, v147 dst_sel:WORD_1 dst_unused:UNUSED_PRESERVE src0_sel:WORD_1
ds_read_u16_d16_hi v145, v145
s_waitcnt lgkmcnt(0)
v_or_b32 v180, v144, v145
v_pk_mul_f16 v181, v155, v154
v_pk_mul_f16 v182, v152, v151
v_pk_mul_f16 v183, v149, v148
s_cmp_lg_u32 s77, 1
s_cbranch_scc1 Lpp49
s_getreg_b32 s43, hwreg(HW_REG_IB_STS, 0, 4)
s_cmp_lg_u32 s43, 0
s_cbranch_scc1 Lpp49
s_call_b64 s[78:79], Lpoll
s_setprio 0
Lpp49:
s_setprio 2
v_cvt_pkrtz_f16_f32 v137, v120, v121
v_cvt_pkrtz_f16_f32 v139, v122, v123
v_cvt_pkrtz_f16_f32 v141, v124, v125
v_cvt_pkrtz_f16_f32 v143, v126, v127
v_cvt_pkrtz_f16_f32 v145, v128, v129
v_cvt_pk_f16_f32 v155, v130, v131
v_cvt_pk_f16_f32 v152, v132, v133
v_cvt_pk_f16_f32 v149, v134, v135
ds_read_b128 v[228:231], v248 offset:63488
v_mfma_f32_32x32x16_bf16 v[120:135], v[232:235], v[96:99], 0
v_pk_fma_f16 v154, v155, v155, s48
v_and_b32 v137, s49, v137
v_pk_fma_f16 v151, v152, v152, s48
v_and_b32 v139, s49, v139
v_pk_fma_f16 v148, v149, v149, s48
v_pk_mul_f16 v154, v155, v154
v_lshrrev_b16 v136, 2, v137
v_pk_mul_f16 v151, v152, v151
ds_read_b128 v[232:235], v248 offset:61440
ds_read_u16_d16 v136, v136
v_mfma_f32_32x32x16_bf16 v[120:135], v[236:239], v[100:103], v[120:135]
v_pk_mul_f16 v148, v149, v148
v_lshrrev_b16 v138, 2, v139
v_exp_f16 v153, v154
v_lshrrev_b32 v137, 18, v137
v_exp_f16 v150, v151
v_lshrrev_b32 v139, 18, v139
ds_read_b128 v[236:239], v248 offset:64512
ds_read_u16_d16 v138, v138
ds_read_u16_d16_hi v137, v137
ds_read_u16_d16_hi v139, v139
v_mfma_f32_32x32x16_bf16 v[120:135], v[224:227], v[104:107], v[120:135]
v_exp_f16 v147, v148
v_and_b32 v141, s49, v141
v_and_b32 v143, s49, v143
v_exp_f16_sdwa v153, v154 dst_sel:WORD_1 dst_unused:UNUSED_PRESERVE src0_sel:WORD_1
v_lshrrev_b16 v140, 2, v141
v_exp_f16_sdwa v150, v151 dst_sel:WORD_1 dst_unused:UNUSED_PRESERVE src0_sel:WORD_1
s_waitcnt lgkmcnt(6)
ds_read_b128 v[224:227], v249
ds_read_u16_d16 v140, v140
v_mfma_f32_32x32x16_bf16 v[120:135], v[228:231], v[108:111], v[120:135]
v_lshrrev_b16 v142, 2, v143
v_exp_f16_sdwa v147, v148 dst_sel:WORD_1 dst_unused:UNUSED_PRESERVE src0_sel:WORD_1
v_lshrrev_b32 v141, 18, v141
v_pk_add_f16 v153, v153, 1.0 op_sel_hi:[1,0]
v_lshrrev_b32 v143, 18, v143
v_pk_add_f16 v150, v150, 1.0 op_sel_hi:[1,0]
v_pk_add_f16 v147, v147, 1.0 op_sel_hi:[1,0]
s_waitcnt lgkmcnt(6)
ds_read_b128 v[228:231], v249 offset:3072
ds_read_u16_d16 v142, v142
ds_read_u16_d16_hi v141, v141
ds_read_u16_d16_hi v143, v143
v_mfma_f32_32x32x16_bf16 v[120:135], v[232:235], v[112:115], v[120:135]
v_and_b32 v145, s49, v145
v_rcp_f16 v154, v153
v_lshrrev_b16 v144, 2, v145
v_rcp_f16 v151, v150
v_lshrrev_b32 v145, 18, v145
s_waitcnt lgkmcnt(6)
ds_read_b128 v[232:235], v249 offset:1024
ds_read_u16_d16 v144, v144
ds_read_u16_d16_hi v145, v145
v_mfma_f32_32x32x16_bf16 v[120:135], v[236:239], v[116:119], v[120:135]
v_rcp_f16 v148, v147
v_or_b32 v184, v136, v137
v_or_b32 v185, v138, v139
v_rcp_f16_sdwa v154, v153 dst_sel:WORD_1 dst_unused:UNUSED_PRESERVE src0_sel:WORD_1
s_waitcnt lgkmcnt(4)
v_or_b32 v186, v140, v141
v_rcp_f16_sdwa v151, v150 dst_sel:WORD_1 dst_unused:UNUSED_PRESERVE src0_sel:WORD_1
s_waitcnt lgkmcnt(3)
v_or_b32 v187, v142, v143
v_rcp_f16_sdwa v148, v147 dst_sel:WORD_1 dst_unused:UNUSED_PRESERVE src0_sel:WORD_1
s_waitcnt lgkmcnt(0)
v_or_b32 v188, v144, v145
v_pk_mul_f16 v189, v155, v154
v_pk_mul_f16 v190, v152, v151
v_pk_mul_f16 v191, v149, v148
s_cmp_lg_u32 s77, 1
s_cbranch_scc1 Lpp50
s_getreg_b32 s43, hwreg(HW_REG_IB_STS, 0, 4)
s_cmp_lg_u32 s43, 0
s_cbranch_scc1 Lpp50
s_call_b64 s[78:79], Lpoll
s_setprio 2
Lpp50:
s_setprio 1
v_cvt_pkrtz_f16_f32 v137, v120, v121
v_cvt_pkrtz_f16_f32 v139, v122, v123
v_cvt_pkrtz_f16_f32 v141, v124, v125
v_cvt_pkrtz_f16_f32 v143, v126, v127
v_cvt_pkrtz_f16_f32 v145, v128, v129
v_cvt_pk_f16_f32 v155, v130, v131
v_cvt_pk_f16_f32 v152, v132, v133
v_cvt_pk_f16_f32 v149, v134, v135
ds_read_b128 v[236:239], v249 offset:4096
v_mfma_f32_32x32x16_bf16 v[120:135], v[224:227], v[96:99], 0
v_pk_fma_f16 v154, v155, v155, s48
v_and_b32 v137, s49, v137
v_pk_fma_f16 v151, v152, v152, s48
v_and_b32 v139, s49, v139
v_pk_fma_f16 v148, v149, v149, s48
v_pk_mul_f16 v154, v155, v154
v_lshrrev_b16 v136, 2, v137
v_pk_mul_f16 v151, v152, v151
ds_read_b128 v[224:227], v249 offset:2048
ds_read_u16_d16 v136, v136
v_mfma_f32_32x32x16_bf16 v[120:135], v[228:231], v[100:103], v[120:135]
v_pk_mul_f16 v148, v149, v148
v_lshrrev_b16 v138, 2, v139
v_exp_f16 v153, v154
v_lshrrev_b32 v137, 18, v137
v_exp_f16 v150, v151
v_lshrrev_b32 v139, 18, v139
ds_read_b128 v[228:231], v249 offset:5120
ds_read_u16_d16 v138, v138
ds_read_u16_d16_hi v137, v137
ds_read_u16_d16_hi v139, v139
v_mfma_f32_32x32x16_bf16 v[120:135], v[232:235], v[104:107], v[120:135]
v_exp_f16 v147, v148
v_and_b32 v141, s49, v141
v_and_b32 v143, s49, v143
v_exp_f16_sdwa v153, v154 dst_sel:WORD_1 dst_unused:UNUSED_PRESERVE src0_sel:WORD_1
v_lshrrev_b16 v140, 2, v141
v_exp_f16_sdwa v150, v151 dst_sel:WORD_1 dst_unused:UNUSED_PRESERVE src0_sel:WORD_1
s_waitcnt lgkmcnt(6)
ds_read_b128 v[232:235], v249 offset:6144
ds_read_u16_d16 v140, v140
v_mfma_f32_32x32x16_bf16 v[120:135], v[236:239], v[108:111], v[120:135]
v_lshrrev_b16 v142, 2, v143
v_exp_f16_sdwa v147, v148 dst_sel:WORD_1 dst_unused:UNUSED_PRESERVE src0_sel:WORD_1
v_lshrrev_b32 v141, 18, v141
v_pk_add_f16 v153, v153, 1.0 op_sel_hi:[1,0]
v_lshrrev_b32 v143, 18, v143
v_pk_add_f16 v150, v150, 1.0 op_sel_hi:[1,0]
v_pk_add_f16 v147, v147, 1.0 op_sel_hi:[1,0]
s_waitcnt lgkmcnt(6)
ds_read_b128 v[236:239], v249 offset:9216
ds_read_u16_d16 v142, v142
ds_read_u16_d16_hi v141, v141
ds_read_u16_d16_hi v143, v143
v_mfma_f32_32x32x16_bf16 v[120:135], v[224:227], v[112:115], v[120:135]
v_and_b32 v145, s49, v145
v_rcp_f16 v154, v153
v_lshrrev_b16 v144, 2, v145
s_setprio 0
v_rcp_f16 v151, v150
v_lshrrev_b32 v145, 18, v145
s_waitcnt lgkmcnt(6)
ds_read_b128 v[224:227], v249 offset:7168
ds_read_u16_d16 v144, v144
ds_read_u16_d16_hi v145, v145
v_mfma_f32_32x32x16_bf16 v[120:135], v[228:231], v[116:119], v[120:135]
v_rcp_f16 v148, v147
v_or_b32 v192, v136, v137
v_or_b32 v193, v138, v139
v_rcp_f16_sdwa v154, v153 dst_sel:WORD_1 dst_unused:UNUSED_PRESERVE src0_sel:WORD_1
s_waitcnt lgkmcnt(4)
v_or_b32 v194, v140, v141
v_rcp_f16_sdwa v151, v150 dst_sel:WORD_1 dst_unused:UNUSED_PRESERVE src0_sel:WORD_1
s_waitcnt lgkmcnt(3)
v_or_b32 v195, v142, v143
v_rcp_f16_sdwa v148, v147 dst_sel:WORD_1 dst_unused:UNUSED_PRESERVE src0_sel:WORD_1
s_waitcnt lgkmcnt(0)
v_or_b32 v196, v144, v145
v_pk_mul_f16 v197, v155, v154
v_pk_mul_f16 v198, v152, v151
v_pk_mul_f16 v199, v149, v148
s_cmp_lg_u32 s77, 1
s_cbranch_scc1 Lpp51
s_getreg_b32 s43, hwreg(HW_REG_IB_STS, 0, 4)
s_cmp_lg_u32 s43, 0
s_cbranch_scc1 Lpp51
s_call_b64 s[78:79], Lpoll
s_setprio 0
Lpp51:
v_mov_b32 v136, 16256
Lw2w:
ds_read_b32 v137, v136 offset:4
s_waitcnt lgkmcnt(0)
v_readfirstlane_b32 s43, v137
s_cmp_eq_u32 s76, 0
s_cbranch_scc1 Lw2x
s_sub_u32 s76, s76, 1
s_cmp_lt_u32 s43, 1
s_cbranch_scc0 Lw2x
s_sleep 2
s_branch Lw2w
Lw2x:
v_lshrrev_b32 v136, 2, v251
v_mul_u32_u24 v136, 192, v136
v_and_b32 v137, 3, v251
v_lshl_add_u32 v136, v137, 4, v136
s_add_u32 m0, s72, 7168
s_add_u32 s43, s82, 6208
buffer_load_dwordx4 v136, s[16:19], s43 offen lds
s_add_u32 m0, s72, 8192
s_add_u32 s43, s82, 6272
buffer_load_dwordx4 v136, s[16:19], s43 offen lds
s_setprio 2
v_cvt_pkrtz_f16_f32 v137, v120, v121
v_cvt_pkrtz_f16_f32 v139, v122, v123
v_cvt_pkrtz_f16_f32 v141, v124, v125
v_cvt_pkrtz_f16_f32 v143, v126, v127
v_cvt_pkrtz_f16_f32 v145, v128, v129
v_cvt_pk_f16_f32 v155, v130, v131
v_cvt_pk_f16_f32 v152, v132, v133
v_cvt_pk_f16_f32 v149, v134, v135
ds_read_b128 v[228:231], v249 offset:10240
v_mfma_f32_32x32x16_bf16 v[120:135], v[232:235], v[96:99], 0
v_pk_fma_f16 v154, v155, v155, s48
v_and_b32 v137, s49, v137
v_pk_fma_f16 v151, v152, v152, s48
v_and_b32 v139, s49, v139
v_pk_fma_f16 v148, v149, v149, s48
v_pk_mul_f16 v154, v155, v154
v_lshrrev_b16 v136, 2, v137
v_pk_mul_f16 v151, v152, v151
ds_read_b128 v[232:235], v249 offset:8192
ds_read_u16_d16 v136, v136
v_mfma_f32_32x32x16_bf16 v[120:135], v[236:239], v[100:103], v[120:135]
v_pk_mul_f16 v148, v149, v148
v_lshrrev_b16 v138, 2, v139
v_exp_f16 v153, v154
v_lshrrev_b32 v137, 18, v137
v_exp_f16 v150, v151
v_lshrrev_b32 v139, 18, v139
ds_read_b128 v[236:239], v249 offset:11264
ds_read_u16_d16 v138, v138
ds_read_u16_d16_hi v137, v137
ds_read_u16_d16_hi v139, v139
v_mfma_f32_32x32x16_bf16 v[120:135], v[224:227], v[104:107], v[120:135]
v_exp_f16 v147, v148
v_and_b32 v141, s49, v141
v_and_b32 v143, s49, v143
v_exp_f16_sdwa v153, v154 dst_sel:WORD_1 dst_unused:UNUSED_PRESERVE src0_sel:WORD_1
v_lshrrev_b16 v140, 2, v141
v_exp_f16_sdwa v150, v151 dst_sel:WORD_1 dst_unused:UNUSED_PRESERVE src0_sel:WORD_1
s_waitcnt lgkmcnt(6)
ds_read_b128 v[224:227], v249 offset:12288
ds_read_u16_d16 v140, v140
v_mfma_f32_32x32x16_bf16 v[120:135], v[228:231], v[108:111], v[120:135]
v_lshrrev_b16 v142, 2, v143
v_exp_f16_sdwa v147, v148 dst_sel:WORD_1 dst_unused:UNUSED_PRESERVE src0_sel:WORD_1
v_lshrrev_b32 v141, 18, v141
v_pk_add_f16 v153, v153, 1.0 op_sel_hi:[1,0]
v_lshrrev_b32 v143, 18, v143
v_pk_add_f16 v150, v150, 1.0 op_sel_hi:[1,0]
v_pk_add_f16 v147, v147, 1.0 op_sel_hi:[1,0]
s_waitcnt lgkmcnt(6)
ds_read_b128 v[228:231], v249 offset:15360
ds_read_u16_d16 v142, v142
ds_read_u16_d16_hi v141, v141
ds_read_u16_d16_hi v143, v143
v_mfma_f32_32x32x16_bf16 v[120:135], v[232:235], v[112:115], v[120:135]
v_and_b32 v145, s49, v145
v_rcp_f16 v154, v153
v_lshrrev_b16 v144, 2, v145
v_rcp_f16 v151, v150
v_lshrrev_b32 v145, 18, v145
s_waitcnt lgkmcnt(6)
ds_read_b128 v[232:235], v249 offset:13312
ds_read_u16_d16 v144, v144
ds_read_u16_d16_hi v145, v145
v_mfma_f32_32x32x16_bf16 v[120:135], v[236:239], v[116:119], v[120:135]
v_rcp_f16 v148, v147
v_or_b32 v200, v136, v137
v_or_b32 v201, v138, v139
v_rcp_f16_sdwa v154, v153 dst_sel:WORD_1 dst_unused:UNUSED_PRESERVE src0_sel:WORD_1
s_waitcnt lgkmcnt(4)
v_or_b32 v202, v140, v141
v_rcp_f16_sdwa v151, v150 dst_sel:WORD_1 dst_unused:UNUSED_PRESERVE src0_sel:WORD_1
s_waitcnt lgkmcnt(3)
v_or_b32 v203, v142, v143
v_rcp_f16_sdwa v148, v147 dst_sel:WORD_1 dst_unused:UNUSED_PRESERVE src0_sel:WORD_1
s_waitcnt lgkmcnt(0)
v_or_b32 v204, v144, v145
v_pk_mul_f16 v205, v155, v154
v_pk_mul_f16 v206, v152, v151
v_pk_mul_f16 v207, v149, v148
s_cmp_lg_u32 s77, 1
s_cbranch_scc1 Lpp52
s_getreg_b32 s43, hwreg(HW_REG_IB_STS, 0, 4)
s_cmp_lg_u32 s43, 0
s_cbranch_scc1 Lpp52
s_call_b64 s[78:79], Lpoll
s_setprio 2
Lpp52:
s_setprio 1
v_cvt_pkrtz_f16_f32 v137, v120, v121
v_cvt_pkrtz_f16_f32 v139, v122, v123
v_cvt_pkrtz_f16_f32 v141, v124, v125
v_cvt_pkrtz_f16_f32 v143, v126, v127
v_cvt_pkrtz_f16_f32 v145, v128, v129
v_cvt_pk_f16_f32 v155, v130, v131
v_cvt_pk_f16_f32 v152, v132, v133
v_cvt_pk_f16_f32 v149, v134, v135
ds_read_b128 v[236:239], v249 offset:16384
v_mfma_f32_32x32x16_bf16 v[120:135], v[224:227], v[96:99], 0
v_pk_fma_f16 v154, v155, v155, s48
v_and_b32 v137, s49, v137
v_pk_fma_f16 v151, v152, v152, s48
v_and_b32 v139, s49, v139
v_pk_fma_f16 v148, v149, v149, s48
v_pk_mul_f16 v154, v155, v154
v_lshrrev_b16 v136, 2, v137
v_pk_mul_f16 v151, v152, v151
ds_read_b128 v[224:227], v249 offset:14336
ds_read_u16_d16 v136, v136
v_mfma_f32_32x32x16_bf16 v[120:135], v[228:231], v[100:103], v[120:135]
v_pk_mul_f16 v148, v149, v148
v_lshrrev_b16 v138, 2, v139
v_exp_f16 v153, v154
v_lshrrev_b32 v137, 18, v137
v_exp_f16 v150, v151
v_lshrrev_b32 v139, 18, v139
ds_read_b128 v[228:231], v249 offset:17408
ds_read_u16_d16 v138, v138
ds_read_u16_d16_hi v137, v137
ds_read_u16_d16_hi v139, v139
v_mfma_f32_32x32x16_bf16 v[120:135], v[232:235], v[104:107], v[120:135]
v_exp_f16 v147, v148
v_and_b32 v141, s49, v141
v_and_b32 v143, s49, v143
v_exp_f16_sdwa v153, v154 dst_sel:WORD_1 dst_unused:UNUSED_PRESERVE src0_sel:WORD_1
v_lshrrev_b16 v140, 2, v141
v_exp_f16_sdwa v150, v151 dst_sel:WORD_1 dst_unused:UNUSED_PRESERVE src0_sel:WORD_1
s_waitcnt lgkmcnt(6)
ds_read_u16_d16 v140, v140
v_mfma_f32_32x32x16_bf16 v[120:135], v[236:239], v[108:111], v[120:135]
v_lshrrev_b16 v142, 2, v143
v_exp_f16_sdwa v147, v148 dst_sel:WORD_1 dst_unused:UNUSED_PRESERVE src0_sel:WORD_1
v_lshrrev_b32 v141, 18, v141
v_pk_add_f16 v153, v153, 1.0 op_sel_hi:[1,0]
v_lshrrev_b32 v143, 18, v143
v_pk_add_f16 v150, v150, 1.0 op_sel_hi:[1,0]
v_pk_add_f16 v147, v147, 1.0 op_sel_hi:[1,0]
s_waitcnt lgkmcnt(5)
ds_read_u16_d16 v142, v142
ds_read_u16_d16_hi v141, v141
ds_read_u16_d16_hi v143, v143
v_mfma_f32_32x32x16_bf16 v[120:135], v[224:227], v[112:115], v[120:135]
v_and_b32 v145, s49, v145
v_rcp_f16 v154, v153
v_lshrrev_b16 v144, 2, v145
s_setprio 0
v_rcp_f16 v151, v150
v_lshrrev_b32 v145, 18, v145
s_waitcnt lgkmcnt(4)
ds_read_u16_d16 v144, v144
ds_read_u16_d16_hi v145, v145
v_mfma_f32_32x32x16_bf16 v[120:135], v[228:231], v[116:119], v[120:135]
v_rcp_f16 v148, v147
v_or_b32 v240, v136, v137
v_or_b32 v241, v138, v139
v_rcp_f16_sdwa v154, v153 dst_sel:WORD_1 dst_unused:UNUSED_PRESERVE src0_sel:WORD_1
s_waitcnt lgkmcnt(3)
v_or_b32 v242, v140, v141
v_rcp_f16_sdwa v151, v150 dst_sel:WORD_1 dst_unused:UNUSED_PRESERVE src0_sel:WORD_1
s_waitcnt lgkmcnt(2)
v_or_b32 v243, v142, v143
v_rcp_f16_sdwa v148, v147 dst_sel:WORD_1 dst_unused:UNUSED_PRESERVE src0_sel:WORD_1
s_waitcnt lgkmcnt(0)
v_or_b32 v244, v144, v145
v_pk_mul_f16 v245, v155, v154
v_pk_mul_f16 v246, v152, v151
v_pk_mul_f16 v247, v149, v148
s_cmp_lg_u32 s77, 1
s_cbranch_scc1 Lpp53
s_getreg_b32 s43, hwreg(HW_REG_IB_STS, 0, 4)
s_cmp_lg_u32 s43, 0
s_cbranch_scc1 Lpp53
s_call_b64 s[78:79], Lpoll
s_setprio 0
Lpp53:
s_setprio 2
v_cvt_pkrtz_f16_f32 v137, v120, v121
v_cvt_pkrtz_f16_f32 v139, v122, v123
v_cvt_pkrtz_f16_f32 v141, v124, v125
v_cvt_pkrtz_f16_f32 v143, v126, v127
v_cvt_pkrtz_f16_f32 v145, v128, v129
v_cvt_pk_f16_f32 v155, v130, v131
v_cvt_pk_f16_f32 v152, v132, v133
v_cvt_pk_f16_f32 v149, v134, v135
v_pk_fma_f16 v154, v155, v155, s48
v_and_b32 v137, s49, v137
v_pk_fma_f16 v151, v152, v152, s48
v_and_b32 v139, s49, v139
v_pk_fma_f16 v148, v149, v149, s48
v_pk_mul_f16 v154, v155, v154
v_lshrrev_b16 v136, 2, v137
v_pk_mul_f16 v151, v152, v151
v_pk_mul_f16 v148, v149, v148
v_lshrrev_b16 v138, 2, v139
v_exp_f16 v153, v154
v_lshrrev_b32 v137, 18, v137
v_exp_f16 v150, v151
v_lshrrev_b32 v139, 18, v139
v_exp_f16 v147, v148
v_and_b32 v141, s49, v141
v_and_b32 v143, s49, v143
ds_read_u16_d16 v136, v136
ds_read_u16_d16 v138, v138
ds_read_u16_d16_hi v137, v137
ds_read_u16_d16_hi v139, v139
v_exp_f16_sdwa v153, v154 dst_sel:WORD_1 dst_unused:UNUSED_PRESERVE src0_sel:WORD_1
v_lshrrev_b16 v140, 2, v141
v_exp_f16_sdwa v150, v151 dst_sel:WORD_1 dst_unused:UNUSED_PRESERVE src0_sel:WORD_1
s_setprio 1
v_lshrrev_b16 v142, 2, v143
v_exp_f16_sdwa v147, v148 dst_sel:WORD_1 dst_unused:UNUSED_PRESERVE src0_sel:WORD_1
v_lshrrev_b32 v141, 18, v141
v_pk_add_f16 v153, v153, 1.0 op_sel_hi:[1,0]
v_lshrrev_b32 v143, 18, v143
v_pk_add_f16 v150, v150, 1.0 op_sel_hi:[1,0]
v_pk_add_f16 v147, v147, 1.0 op_sel_hi:[1,0]
v_and_b32 v145, s49, v145
v_rcp_f16 v154, v153
v_lshrrev_b16 v144, 2, v145
v_rcp_f16 v151, v150
v_lshrrev_b32 v145, 18, v145
ds_read_u16_d16 v140, v140
ds_read_u16_d16 v142, v142
ds_read_u16_d16_hi v141, v141
ds_read_u16_d16_hi v143, v143
ds_read_u16_d16 v144, v144
ds_read_u16_d16_hi v145, v145
v_rcp_f16 v148, v147
s_waitcnt lgkmcnt(7)
v_or_b32 v232, v136, v137
s_waitcnt lgkmcnt(6)
v_or_b32 v233, v138, v139
v_rcp_f16_sdwa v154, v153 dst_sel:WORD_1 dst_unused:UNUSED_PRESERVE src0_sel:WORD_1
s_waitcnt lgkmcnt(3)
v_or_b32 v234, v140, v141
s_setprio 0
v_rcp_f16_sdwa v151, v150 dst_sel:WORD_1 dst_unused:UNUSED_PRESERVE src0_sel:WORD_1
s_waitcnt lgkmcnt(2)
v_or_b32 v235, v142, v143
v_rcp_f16_sdwa v148, v147 dst_sel:WORD_1 dst_unused:UNUSED_PRESERVE src0_sel:WORD_1
s_waitcnt lgkmcnt(0)
v_or_b32 v236, v144, v145
v_pk_mul_f16 v237, v155, v154
v_pk_mul_f16 v238, v152, v151
v_pk_mul_f16 v239, v149, v148
s_cmp_eq_u32 s77, 0
s_cbranch_scc1 Lpp54
s_getreg_b32 s43, hwreg(HW_REG_IB_STS, 0, 4)
s_cmp_lg_u32 s43, 0
s_cbranch_scc1 Lpp54
s_call_b64 s[78:79], Lpoll
s_setprio 0
Lpp54:
s_setprio 2
v_lshrrev_b32 v225, 5, v251
v_lshl_add_u32 v224, v225, 9, s72
v_lshl_add_u32 v226, v225, 4, s72
v_and_b32 v225, 15, v251
v_lshl_add_u32 v224, v225, 4, v224
v_bfe_u32 v225, v251, 4, 1
v_lshl_add_u32 v224, v225, 3, v224
s_waitcnt vmcnt(0)
ds_read_b64_tr_b16 v[120:121], v224
ds_read_b64_tr_b16 v[122:123], v224 offset:256
ds_read_b64_tr_b16 v[124:125], v224 offset:1024
ds_read_b64_tr_b16 v[126:127], v224 offset:1280
ds_read_b64_tr_b16 v[128:129], v224 offset:2048
ds_read_b64_tr_b16 v[130:131], v224 offset:2304
ds_read_b64_tr_b16 v[132:133], v224 offset:3072
ds_read_b64_tr_b16 v[134:135], v224 offset:3328
ds_read_b64_tr_b16 v[136:137], v224 offset:4096
ds_read_b64_tr_b16 v[138:139], v224 offset:4352
ds_read_b64_tr_b16 v[140:141], v224 offset:5120
ds_read_b64_tr_b16 v[142:143], v224 offset:5376
ds_read_b64_tr_b16 v[144:145], v224 offset:6144
ds_read_b64_tr_b16 v[146:147], v224 offset:6400
ds_read_b64_tr_b16 v[148:149], v224 offset:7168
ds_read_b64_tr_b16 v[150:151], v224 offset:7424
ds_read_b64_tr_b16 v[152:153], v224 offset:8192
ds_read_b64_tr_b16 v[154:155], v224 offset:8448
v_mov_b32 v225, 16256
v_mov_b32 v227, 1
v_permlane16_swap_b32 v0, v4
v_permlane16_swap_b32 v1, v5
v_permlane16_swap_b32 v2, v6
v_permlane16_swap_b32 v3, v7
v_permlane16_swap_b32 v8, v12
v_permlane16_swap_b32 v9, v13
v_permlane16_swap_b32 v10, v14
v_permlane16_swap_b32 v11, v15
s_waitcnt lgkmcnt(0)
s_mov_b64 exec, 1
ds_add_u32 v225, v227 offset:8
s_mov_b64 exec, -1
v_lshlrev_b32 v228, 16, v120
v_and_b32 v229, 4294901760, v120
v_cvt_pk_f16_f32 v120, v228, v229
v_lshlrev_b32 v230, 16, v121
v_and_b32 v231, 4294901760, v121
v_cvt_pk_f16_f32 v121, v230, v231
v_lshlrev_b32 v228, 16, v122
v_and_b32 v229, 4294901760, v122
v_cvt_pk_f16_f32 v122, v228, v229
v_lshlrev_b32 v230, 16, v123
v_and_b32 v231, 4294901760, v123
v_cvt_pk_f16_f32 v123, v230, v231
v_lshlrev_b32 v228, 16, v124
v_and_b32 v229, 4294901760, v124
v_cvt_pk_f16_f32 v124, v228, v229
v_lshlrev_b32 v230, 16, v125
v_and_b32 v231, 4294901760, v125
v_cvt_pk_f16_f32 v125, v230, v231
v_lshlrev_b32 v228, 16, v126
v_and_b32 v229, 4294901760, v126
v_cvt_pk_f16_f32 v126, v228, v229
v_lshlrev_b32 v230, 16, v127
v_and_b32 v231, 4294901760, v127
v_cvt_pk_f16_f32 v127, v230, v231
v_lshlrev_b32 v228, 16, v128
v_and_b32 v229, 4294901760, v128
v_cvt_pk_f16_f32 v128, v228, v229
v_lshlrev_b32 v230, 16, v129
v_and_b32 v231, 4294901760, v129
v_cvt_pk_f16_f32 v129, v230, v231
v_lshlrev_b32 v228, 16, v130
v_and_b32 v229, 4294901760, v130
v_cvt_pk_f16_f32 v130, v228, v229
v_lshlrev_b32 v230, 16, v131
v_and_b32 v231, 4294901760, v131
v_cvt_pk_f16_f32 v131, v230, v231
s_cmp_eq_u32 s77, 0
s_cbranch_scc1 Lpp911
s_getreg_b32 s43, hwreg(HW_REG_IB_STS, 0, 4)
s_cmp_lg_u32 s43, 0
s_cbranch_scc1 Lpp911
s_call_b64 s[78:79], Lpoll
s_setprio 2
Lpp911:
v_lshlrev_b32 v228, 16, v132
v_and_b32 v229, 4294901760, v132
v_cvt_pk_f16_f32 v132, v228, v229
v_lshlrev_b32 v230, 16, v133
v_and_b32 v231, 4294901760, v133
v_cvt_pk_f16_f32 v133, v230, v231
v_lshlrev_b32 v228, 16, v134
v_and_b32 v229, 4294901760, v134
v_cvt_pk_f16_f32 v134, v228, v229
v_lshlrev_b32 v230, 16, v135
v_and_b32 v231, 4294901760, v135
v_cvt_pk_f16_f32 v135, v230, v231
v_lshlrev_b32 v228, 16, v136
v_and_b32 v229, 4294901760, v136
v_cvt_pk_f16_f32 v136, v228, v229
v_lshlrev_b32 v230, 16, v137
v_and_b32 v231, 4294901760, v137
v_cvt_pk_f16_f32 v137, v230, v231
v_lshlrev_b32 v228, 16, v138
v_and_b32 v229, 4294901760, v138
v_cvt_pk_f16_f32 v138, v228, v229
v_lshlrev_b32 v230, 16, v139
v_and_b32 v231, 4294901760, v139
v_cvt_pk_f16_f32 v139, v230, v231
v_lshlrev_b32 v228, 16, v140
v_and_b32 v229, 4294901760, v140
v_cvt_pk_f16_f32 v140, v228, v229
v_lshlrev_b32 v230, 16, v141
v_and_b32 v231, 4294901760, v141
v_cvt_pk_f16_f32 v141, v230, v231
v_lshlrev_b32 v228, 16, v142
v_and_b32 v229, 4294901760, v142
v_cvt_pk_f16_f32 v142, v228, v229
v_lshlrev_b32 v230, 16, v143
v_and_b32 v231, 4294901760, v143
v_cvt_pk_f16_f32 v143, v230, v231
s_cmp_eq_u32 s77, 0
s_cbranch_scc1 Lpp923
s_getreg_b32 s43, hwreg(HW_REG_IB_STS, 0, 4)
s_cmp_lg_u32 s43, 0
s_cbranch_scc1 Lpp923
s_call_b64 s[78:79], Lpoll
s_setprio 2
Lpp923:
v_lshlrev_b32 v228, 16, v144
v_and_b32 v229, 4294901760, v144
v_cvt_pk_f16_f32 v144, v228, v229
v_lshlrev_b32 v230, 16, v145
v_and_b32 v231, 4294901760, v145
v_cvt_pk_f16_f32 v145, v230, v231
v_lshlrev_b32 v228, 16, v146
v_and_b32 v229, 4294901760, v146
v_cvt_pk_f16_f32 v146, v228, v229
v_lshlrev_b32 v230, 16, v147
v_and_b32 v231, 4294901760, v147
v_cvt_pk_f16_f32 v147, v230, v231
v_lshlrev_b32 v228, 16, v148
v_and_b32 v229, 4294901760, v148
v_cvt_pk_f16_f32 v148, v228, v229
v_lshlrev_b32 v230, 16, v149
v_and_b32 v231, 4294901760, v149
v_cvt_pk_f16_f32 v149, v230, v231
v_lshlrev_b32 v228, 16, v150
v_and_b32 v229, 4294901760, v150
v_cvt_pk_f16_f32 v150, v228, v229
v_lshlrev_b32 v230, 16, v151
v_and_b32 v231, 4294901760, v151
v_cvt_pk_f16_f32 v151, v230, v231
v_lshlrev_b32 v228, 16, v152
v_and_b32 v229, 4294901760, v152
v_cvt_pk_f16_f32 v152, v228, v229
v_lshlrev_b32 v230, 16, v153
v_and_b32 v231, 4294901760, v153
v_cvt_pk_f16_f32 v153, v230, v231
v_lshlrev_b32 v228, 16, v154
v_and_b32 v229, 4294901760, v154
v_cvt_pk_f16_f32 v154, v228, v229
v_lshlrev_b32 v230, 16, v155
v_and_b32 v231, 4294901760, v155
v_cvt_pk_f16_f32 v155, v230, v231
s_cmp_eq_u32 s77, 0
s_cbranch_scc1 Lpp935
s_getreg_b32 s43, hwreg(HW_REG_IB_STS, 0, 4)
s_cmp_lg_u32 s43, 0
s_cbranch_scc1 Lpp935
s_call_b64 s[78:79], Lpoll
s_setprio 2
Lpp935:
v_lshl_add_u32 v224, v251, 4, s72
v_add_u32 v228, 0, v251
v_mul_u32_u24 v231, 2731, v228
v_lshrrev_b32 v231, 16, v231
v_mul_u32_u24 v231, 9120, v231
v_lshl_add_u32 v228, v228, 2, v231
v_add_u32 v228, 90112, v228
v_add_u32 v229, 64, v251
v_mul_u32_u24 v231, 2731, v229
v_lshrrev_b32 v231, 16, v231
v_mul_u32_u24 v231, 9120, v231
v_lshl_add_u32 v229, v229, 2, v231
v_add_u32 v229, 90112, v229
v_add_u32 v230, 128, v251
v_mul_u32_u24 v231, 2731, v230
v_lshrrev_b32 v231, 16, v231
v_mul_u32_u24 v231, 9120, v231
v_lshl_add_u32 v230, v230, 2, v231
v_add_u32 v230, 90112, v230
Lspin:
s_cmp_eq_u32 s77, 0
s_cbranch_scc1 Lspinx
s_cmp_eq_u32 s76, 0
s_cbranch_scc1 Lspinx
s_sub_u32 s76, s76, 1
s_call_b64 s[78:79], Lpoll
s_branch Lspin
Lspinx:
s_cmp_lg_u32 s40, 0
s_cbranch_scc1 Lnofin
v_mov_b32 v252, 16256
Lrrw:
ds_read_b32 v253, v252 offset:8
s_waitcnt lgkmcnt(0)
v_readfirstlane_b32 s43, v253
s_cmp_eq_u32 s76, 0
s_cbranch_scc1 Lrrx
s_sub_u32 s76, s76, 1
s_cmp_lt_u32 s43, 8
s_cbranch_scc0 Lrrx
s_sleep 2
s_branch Lrrw
Lrrx:
ds_write_b32 v228, v162
ds_write_b32 v229, v163
ds_write_b32 v230, v164
Lnofin:
s_waitcnt lgkmcnt(0)
s_barrier
ds_read_b128 v[156:159], v226
ds_read_b128 v[160:163], v226 offset:32
ds_read_b128 v[164:167], v226 offset:64
v_lshrrev_b32 v225, 4, v251
v_and_b32 v227, 15, v251
v_mul_u32_u24 v252, 192, v227
v_lshl_add_u32 v252, v225, 4, v252
v_lshlrev_b32 v254, 5, v225
v_and_b32 v253, 47, v251
v_lshlrev_b32 v253, 4, v253
v_and_b32 v225, 1, v225
v_mul_u32_u24 v227, 3072, v225
v_add_u32 v248, v227, v253
v_add_u32 v249, 65536, v248
v_add_u32 v250, 131072, v248
v_lshl_add_u32 v253, v225, 21, v253
s_waitcnt lgkmcnt(0)
v_pk_mul_f16 v120, v120, v156
v_pk_mul_f16 v121, v121, v157
v_pk_mul_f16 v122, v122, v158
v_pk_mul_f16 v123, v123, v159
ds_write_b128 v224, v[120:123]
v_pk_mul_f16 v124, v124, v156
v_pk_mul_f16 v125, v125, v157
v_pk_mul_f16 v126, v126, v158
v_pk_mul_f16 v127, v127, v159
ds_write_b128 v224, v[124:127] offset:1024
v_pk_mul_f16 v128, v128, v156
v_pk_mul_f16 v129, v129, v157
v_pk_mul_f16 v130, v130, v158
v_pk_mul_f16 v131, v131, v159
ds_write_b128 v224, v[128:131] offset:2048
v_pk_mul_f16 v132, v132, v160
v_pk_mul_f16 v133, v133, v161
v_pk_mul_f16 v134, v134, v162
v_pk_mul_f16 v135, v135, v163
ds_write_b128 v224, v[132:135] offset:3072
v_pk_mul_f16 v136, v136, v160
v_pk_mul_f16 v137, v137, v161
v_pk_mul_f16 v138, v138, v162
v_pk_mul_f16 v139, v139, v163
ds_write_b128 v224, v[136:139] offset:4096
v_pk_mul_f16 v140, v140, v160
v_pk_mul_f16 v141, v141, v161
v_pk_mul_f16 v142, v142, v162
v_pk_mul_f16 v143, v143, v163
ds_write_b128 v224, v[140:143] offset:5120
v_pk_mul_f16 v144, v144, v164
v_pk_mul_f16 v145, v145, v165
v_pk_mul_f16 v146, v146, v166
v_pk_mul_f16 v147, v147, v167
ds_write_b128 v224, v[144:147] offset:6144
v_pk_mul_f16 v148, v148, v164
v_pk_mul_f16 v149, v149, v165
v_pk_mul_f16 v150, v150, v166
v_pk_mul_f16 v151, v151, v167
ds_write_b128 v224, v[148:151] offset:7168
v_pk_mul_f16 v152, v152, v164
v_pk_mul_f16 v153, v153, v165
v_pk_mul_f16 v154, v154, v166
v_pk_mul_f16 v155, v155, v167
ds_write_b128 v224, v[152:155] offset:8192
ds_read_b128 v[120:123], v254 offset:7936
ds_read_b128 v[124:127], v254 offset:7952
ds_read_b128 v[128:131], v254 offset:7936
ds_read_b128 v[132:135], v254 offset:7952
ds_read_b128 v[136:139], v254 offset:8064
ds_read_b128 v[140:143], v254 offset:8080
ds_read_b128 v[144:147], v254 offset:8064
ds_read_b128 v[148:151], v254 offset:8080
ds_read_b128 v[152:155], v254 offset:16128
ds_read_b128 v[156:159], v254 offset:16144
ds_read_b128 v[160:163], v254 offset:16128
ds_read_b128 v[164:167], v254 offset:16144
s_waitcnt lgkmcnt(12)
s_barrier
s_setprio 3
ds_read_b128 v[224:227], v249 offset:24576
ds_read_b128 v[228:231], v249 offset:24832
s_waitcnt lgkmcnt(1)
v_mfma_f32_16x16x32_f16 v[120:123], v[224:227], v[0:3], v[120:123]
v_mfma_f32_16x16x32_f16 v[128:131], v[224:227], v[4:7], v[128:131]
v_permlane16_swap_b32 v16, v20
s_waitcnt lgkmcnt(0)
v_mfma_f32_16x16x32_f16 v[124:127], v[228:231], v[0:3], v[124:127]
ds_read_b128 v[224:227], v249 offset:25600
v_mfma_f32_16x16x32_f16 v[132:135], v[228:231], v[4:7], v[132:135]
v_permlane16_swap_b32 v17, v21
s_waitcnt lgkmcnt(0)
v_mfma_f32_16x16x32_f16 v[136:139], v[224:227], v[0:3], v[136:139]
ds_read_b128 v[228:231], v249 offset:25856
v_mfma_f32_16x16x32_f16 v[144:147], v[224:227], v[4:7], v[144:147]
v_permlane16_swap_b32 v18, v22
s_waitcnt lgkmcnt(0)
v_mfma_f32_16x16x32_f16 v[140:143], v[228:231], v[0:3], v[140:143]
ds_read_b128 v[224:227], v249 offset:26624
v_mfma_f32_16x16x32_f16 v[148:151], v[228:231], v[4:7], v[148:151]
v_permlane16_swap_b32 v19, v23
s_waitcnt lgkmcnt(0)
v_mfma_f32_16x16x32_f16 v[152:155], v[224:227], v[0:3], v[152:155]
ds_read_b128 v[228:231], v249 offset:26880
v_mfma_f32_16x16x32_f16 v[160:163], v[224:227], v[4:7], v[160:163]
v_permlane16_swap_b32 v24, v28
s_waitcnt lgkmcnt(0)
v_mfma_f32_16x16x32_f16 v[156:159], v[228:231], v[0:3], v[156:159]
ds_read_b128 v[224:227], v249 offset:30720
v_mfma_f32_16x16x32_f16 v[164:167], v[228:231], v[4:7], v[164:167]
v_permlane16_swap_b32 v25, v29
s_waitcnt lgkmcnt(0)
v_mfma_f32_16x16x32_f16 v[120:123], v[224:227], v[8:11], v[120:123]
ds_read_b128 v[228:231], v249 offset:30976
ds_read_b128 v[0:3], v249 offset:31744
ds_read_b128 v[4:7], v249 offset:32000
v_mfma_f32_16x16x32_f16 v[128:131], v[224:227], v[12:15], v[128:131]
v_permlane16_swap_b32 v26, v30
s_waitcnt lgkmcnt(2)
v_mfma_f32_16x16x32_f16 v[124:127], v[228:231], v[8:11], v[124:127]
ds_read_b128 v[224:227], v249 offset:32768
v_mfma_f32_16x16x32_f16 v[132:135], v[228:231], v[12:15], v[132:135]
v_permlane16_swap_b32 v27, v31
s_waitcnt lgkmcnt(2)
v_mfma_f32_16x16x32_f16 v[136:139], v[0:3], v[8:11], v[136:139]
ds_read_b128 v[228:231], v249 offset:33024
v_mfma_f32_16x16x32_f16 v[144:147], v[0:3], v[12:15], v[144:147]
v_permlane16_swap_b32 v96, v100
s_waitcnt lgkmcnt(2)
v_mfma_f32_16x16x32_f16 v[140:143], v[4:7], v[8:11], v[140:143]
ds_read_b128 v[0:3], v249 offset:36864
v_mfma_f32_16x16x32_f16 v[148:151], v[4:7], v[12:15], v[148:151]
v_permlane16_swap_b32 v97, v101
s_waitcnt lgkmcnt(2)
v_mfma_f32_16x16x32_f16 v[152:155], v[224:227], v[8:11], v[152:155]
ds_read_b128 v[4:7], v249 offset:37120
v_mfma_f32_16x16x32_f16 v[160:163], v[224:227], v[12:15], v[160:163]
v_permlane16_swap_b32 v98, v102
s_waitcnt lgkmcnt(2)
v_mfma_f32_16x16x32_f16 v[156:159], v[228:231], v[8:11], v[156:159]
ds_read_b128 v[224:227], v249 offset:37888
v_mfma_f32_16x16x32_f16 v[164:167], v[228:231], v[12:15], v[164:167]
v_permlane16_swap_b32 v99, v103
s_waitcnt lgkmcnt(2)
v_mfma_f32_16x16x32_f16 v[120:123], v[0:3], v[16:19], v[120:123]
buffer_load_dwordx4 v[12:15], v252, s[4:7], s71 offen
ds_read_b128 v[228:231], v249 offset:38144
v_mfma_f32_16x16x32_f16 v[128:131], v[0:3], v[20:23], v[128:131]
v_permlane16_swap_b32 v32, v36
s_waitcnt lgkmcnt(2)
v_mfma_f32_16x16x32_f16 v[124:127], v[4:7], v[16:19], v[124:127]
ds_read_b128 v[0:3], v249 offset:38912
v_mfma_f32_16x16x32_f16 v[132:135], v[4:7], v[20:23], v[132:135]
v_permlane16_swap_b32 v33, v37
s_waitcnt lgkmcnt(2)
v_mfma_f32_16x16x32_f16 v[136:139], v[224:227], v[16:19], v[136:139]
ds_read_b128 v[4:7], v249 offset:39168
v_mfma_f32_16x16x32_f16 v[144:147], v[224:227], v[20:23], v[144:147]
v_permlane16_swap_b32 v34, v38
s_waitcnt lgkmcnt(2)
v_mfma_f32_16x16x32_f16 v[140:143], v[228:231], v[16:19], v[140:143]
ds_read_b128 v[224:227], v249 offset:43008
v_mfma_f32_16x16x32_f16 v[148:151], v[228:231], v[20:23], v[148:151]
v_permlane16_swap_b32 v35, v39
s_waitcnt lgkmcnt(2)
v_mfma_f32_16x16x32_f16 v[152:155], v[0:3], v[16:19], v[152:155]
ds_read_b128 v[228:231], v249 offset:43264
v_mfma_f32_16x16x32_f16 v[160:163], v[0:3], v[20:23], v[160:163]
v_permlane16_swap_b32 v40, v44
s_waitcnt lgkmcnt(2)
v_mfma_f32_16x16x32_f16 v[156:159], v[4:7], v[16:19], v[156:159]
ds_read_b128 v[0:3], v249 offset:44032
v_mfma_f32_16x16x32_f16 v[164:167], v[4:7], v[20:23], v[164:167]
v_permlane16_swap_b32 v41, v45
s_waitcnt lgkmcnt(2)
v_mfma_f32_16x16x32_f16 v[120:123], v[224:227], v[24:27], v[120:123]
buffer_load_dwordx4 v[8:11], v252, s[4:7], s71 offen offset:64
ds_read_b128 v[4:7], v249 offset:44288
v_mfma_f32_16x16x32_f16 v[128:131], v[224:227], v[28:31], v[128:131]
v_permlane16_swap_b32 v42, v46
s_waitcnt lgkmcnt(2)
v_mfma_f32_16x16x32_f16 v[124:127], v[228:231], v[24:27], v[124:127]
ds_read_b128 v[224:227], v249 offset:45056
v_mfma_f32_16x16x32_f16 v[132:135], v[228:231], v[28:31], v[132:135]
v_permlane16_swap_b32 v43, v47
s_waitcnt lgkmcnt(2)
v_mfma_f32_16x16x32_f16 v[136:139], v[0:3], v[24:27], v[136:139]
ds_read_b128 v[228:231], v249 offset:45312
v_mfma_f32_16x16x32_f16 v[144:147], v[0:3], v[28:31], v[144:147]
v_permlane16_swap_b32 v104, v108
s_waitcnt lgkmcnt(2)
v_mfma_f32_16x16x32_f16 v[140:143], v[4:7], v[24:27], v[140:143]
ds_read_b128 v[0:3], v249 offset:49152
v_mfma_f32_16x16x32_f16 v[148:151], v[4:7], v[28:31], v[148:151]
v_permlane16_swap_b32 v105, v109
s_waitcnt lgkmcnt(2)
v_mfma_f32_16x16x32_f16 v[152:155], v[224:227], v[24:27], v[152:155]
ds_read_b128 v[4:7], v249 offset:49408
v_mfma_f32_16x16x32_f16 v[160:163], v[224:227], v[28:31], v[160:163]
v_permlane16_swap_b32 v106, v110
s_waitcnt lgkmcnt(2)
v_mfma_f32_16x16x32_f16 v[156:159], v[228:231], v[24:27], v[156:159]
ds_read_b128 v[224:227], v249 offset:50176
v_mfma_f32_16x16x32_f16 v[164:167], v[228:231], v[28:31], v[164:167]
v_permlane16_swap_b32 v107, v111
s_waitcnt lgkmcnt(2)
v_mfma_f32_16x16x32_f16 v[120:123], v[0:3], v[32:35], v[120:123]
buffer_load_dwordx4 v[16:19], v252, s[4:7], s71 offen offset:128
ds_read_b128 v[228:231], v249 offset:50432
v_mfma_f32_16x16x32_f16 v[128:131], v[0:3], v[36:39], v[128:131]
v_permlane16_swap_b32 v48, v52
s_waitcnt lgkmcnt(2)
v_mfma_f32_16x16x32_f16 v[124:127], v[4:7], v[32:35], v[124:127]
ds_read_b128 v[0:3], v249 offset:51200
v_mfma_f32_16x16x32_f16 v[132:135], v[4:7], v[36:39], v[132:135]
v_permlane16_swap_b32 v49, v53
s_waitcnt lgkmcnt(2)
v_mfma_f32_16x16x32_f16 v[136:139], v[224:227], v[32:35], v[136:139]
ds_read_b128 v[4:7], v249 offset:51456
v_permlane16_swap_b32 v50, v54
v_mfma_f32_16x16x32_f16 v[144:147], v[224:227], v[36:39], v[144:147]
s_waitcnt lgkmcnt(2)
v_mfma_f32_16x16x32_f16 v[140:143], v[228:231], v[32:35], v[140:143]
ds_read_b128 v[224:227], v249 offset:55296
v_permlane16_swap_b32 v51, v55
v_mfma_f32_16x16x32_f16 v[148:151], v[228:231], v[36:39], v[148:151]
v_permlane16_swap_b32 v56, v60
s_waitcnt lgkmcnt(2)
v_mfma_f32_16x16x32_f16 v[152:155], v[0:3], v[32:35], v[152:155]
ds_read_b128 v[228:231], v249 offset:55552
v_mfma_f32_16x16x32_f16 v[160:163], v[0:3], v[36:39], v[160:163]
v_permlane16_swap_b32 v57, v61
s_waitcnt lgkmcnt(2)
v_mfma_f32_16x16x32_f16 v[156:159], v[4:7], v[32:35], v[156:159]
ds_read_b128 v[0:3], v249 offset:56320
v_permlane16_swap_b32 v58, v62
v_mfma_f32_16x16x32_f16 v[164:167], v[4:7], v[36:39], v[164:167]
s_waitcnt lgkmcnt(2)
v_mfma_f32_16x16x32_f16 v[120:123], v[224:227], v[40:43], v[120:123]
s_add_u32 s46, s71, 98304
buffer_load_dwordx4 v[20:23], v252, s[4:7], s46 offen
ds_read_b128 v[4:7], v249 offset:56576
v_permlane16_swap_b32 v59, v63
v_mfma_f32_16x16x32_f16 v[128:131], v[224:227], v[44:47], v[128:131]
v_and_b32 v24, 1, v251
v_lshlrev_b32 v24, 4, v24
s_waitcnt lgkmcnt(2)
v_mfma_f32_16x16x32_f16 v[124:127], v[228:231], v[40:43], v[124:127]
ds_read_b128 v[224:227], v249 offset:57344
v_mov_b32 v25, 16256
v_mfma_f32_16x16x32_f16 v[132:135], v[228:231], v[44:47], v[132:135]
v_lshlrev_b32 v24, v24, v25
s_waitcnt lgkmcnt(2)
v_mfma_f32_16x16x32_f16 v[136:139], v[0:3], v[40:43], v[136:139]
ds_read_b128 v[228:231], v249 offset:57600
v_lshrrev_b32 v25, 2, v251
v_mfma_f32_16x16x32_f16 v[144:147], v[0:3], v[44:47], v[144:147]
v_xor_b32 v25, v25, v251
v_and_b32 v25, 12, v25
s_waitcnt lgkmcnt(2)
v_mfma_f32_16x16x32_f16 v[140:143], v[4:7], v[40:43], v[140:143]
ds_read_b128 v[0:3], v249 offset:61440
v_and_b32 v28, 2, v251
v_mfma_f32_16x16x32_f16 v[148:151], v[4:7], v[44:47], v[148:151]
v_or_b32 v25, v25, v28
s_waitcnt lgkmcnt(2)
v_mfma_f32_16x16x32_f16 v[152:155], v[224:227], v[40:43], v[152:155]
ds_read_b128 v[4:7], v249 offset:61696
v_cmp_eq_u32 vcc, 0, v25
s_nop 1
v_cndmask_b32 v26, 0, v24, vcc
v_cmp_eq_u32 vcc, 2, v25
s_nop 1
v_cndmask_b32 v27, 0, v24, vcc
v_mfma_f32_16x16x32_f16 v[160:163], v[224:227], v[44:47], v[160:163]
v_mov_b32 v24, 0
s_waitcnt lgkmcnt(2)
v_mfma_f32_16x16x32_f16 v[156:159], v[228:231], v[40:43], v[156:159]
ds_read_b128 v[224:227], v249 offset:62464
v_mov_b32 v25, 0
v_mfma_f32_16x16x32_f16 v[164:167], v[228:231], v[44:47], v[164:167]
v_mov_b32 v28, 0
v_mov_b32 v29, 0
s_waitcnt lgkmcnt(2)
v_mfma_f32_16x16x32_f16 v[120:123], v[0:3], v[48:51], v[120:123]
s_add_u32 s46, s80, 8388608
buffer_load_dwordx4 v[32:35], v253, s[32:35], s46 offen nt
ds_read_b128 v[228:231], v249 offset:62720
v_mfma_f32_16x16x32_f16 v[128:131], v[0:3], v[52:55], v[128:131]
s_waitcnt lgkmcnt(2)
v_mfma_f32_16x16x32_f16 v[124:127], v[4:7], v[48:51], v[124:127]
ds_read_b128 v[0:3], v249 offset:63488
v_permlane16_swap_b32 v64, v68
v_mfma_f32_16x16x32_f16 v[132:135], v[4:7], v[52:55], v[132:135]
s_waitcnt lgkmcnt(2)
v_mfma_f32_16x16x32_f16 v[136:139], v[224:227], v[48:51], v[136:139]
ds_read_b128 v[4:7], v249 offset:63744
v_permlane16_swap_b32 v65, v69
v_mfma_f32_16x16x32_f16 v[144:147], v[224:227], v[52:55], v[144:147]
s_waitcnt lgkmcnt(2)
v_mfma_f32_16x16x32_f16 v[140:143], v[228:231], v[48:51], v[140:143]
ds_read_b128 v[224:227], v250 offset:2048
v_permlane16_swap_b32 v66, v70
v_mfma_f32_16x16x32_f16 v[148:151], v[228:231], v[52:55], v[148:151]
s_waitcnt lgkmcnt(2)
v_mfma_f32_16x16x32_f16 v[152:155], v[0:3], v[48:51], v[152:155]
ds_read_b128 v[228:231], v250 offset:2304
v_mfma_f32_16x16x32_f16 v[160:163], v[0:3], v[52:55], v[160:163]
v_permlane16_swap_b32 v67, v71
s_waitcnt lgkmcnt(2)
v_mfma_f32_16x16x32_f16 v[156:159], v[4:7], v[48:51], v[156:159]
ds_read_b128 v[0:3], v250 offset:3072
v_mfma_f32_16x16x32_f16 v[164:167], v[4:7], v[52:55], v[164:167]
v_permlane16_swap_b32 v72, v76
s_waitcnt lgkmcnt(2)
v_mfma_f32_16x16x32_f16 v[120:123], v[224:227], v[56:59], v[120:123]
ds_read_b128 v[4:7], v250 offset:3328
v_mfma_f32_16x16x32_f16 v[128:131], v[224:227], v[60:63], v[128:131]
v_permlane16_swap_b32 v73, v77
s_waitcnt lgkmcnt(2)
v_mfma_f32_16x16x32_f16 v[124:127], v[228:231], v[56:59], v[124:127]
s_add_u32 s46, s80, 8388608
buffer_load_dwordx4 v[36:39], v253, s[32:35], s46 offen offset:256 nt
ds_read_b128 v[224:227], v250 offset:4096
v_mfma_f32_16x16x32_f16 v[132:135], v[228:231], v[60:63], v[132:135]
s_waitcnt lgkmcnt(2)
v_mfma_f32_16x16x32_f16 v[136:139], v[0:3], v[56:59], v[136:139]
ds_read_b128 v[228:231], v250 offset:4352
v_permlane16_swap_b32 v74, v78
v_mfma_f32_16x16x32_f16 v[144:147], v[0:3], v[60:63], v[144:147]
s_waitcnt lgkmcnt(2)
v_mfma_f32_16x16x32_f16 v[140:143], v[4:7], v[56:59], v[140:143]
ds_read_b128 v[0:3], v250 offset:8192
v_permlane16_swap_b32 v75, v79
v_mfma_f32_16x16x32_f16 v[148:151], v[4:7], v[60:63], v[148:151]
s_waitcnt lgkmcnt(2)
v_mfma_f32_16x16x32_f16 v[152:155], v[224:227], v[56:59], v[152:155]
ds_read_b128 v[4:7], v250 offset:8448
v_permlane16_swap_b32 v200, v204
v_mfma_f32_16x16x32_f16 v[160:163], v[224:227], v[60:63], v[160:163]
s_waitcnt lgkmcnt(2)
v_mfma_f32_16x16x32_f16 v[156:159], v[228:231], v[56:59], v[156:159]
ds_read_b128 v[224:227], v250 offset:9216
v_mfma_f32_16x16x32_f16 v[164:167], v[228:231], v[60:63], v[164:167]
v_permlane16_swap_b32 v201, v205
s_waitcnt vmcnt(5)
v_mfma_f32_16x16x32_bf16 v[120:123], v[26:29], v[12:15], v[120:123]
ds_read_b128 v[228:231], v250 offset:9472
v_mfma_f32_16x16x32_bf16 v[124:127], v[24:27], v[12:15], v[124:127]
v_permlane16_swap_b32 v202, v206
s_waitcnt vmcnt(4)
v_mfma_f32_16x16x32_bf16 v[136:139], v[26:29], v[8:11], v[136:139]
v_mfma_f32_16x16x32_bf16 v[140:143], v[24:27], v[8:11], v[140:143]
v_permlane16_swap_b32 v203, v207
s_waitcnt lgkmcnt(3)
v_mfma_f32_16x16x32_f16 v[120:123], v[0:3], v[64:67], v[120:123]
s_add_u32 s46, s71, 98304
buffer_load_dwordx4 v[8:11], v252, s[4:7], s46 offen offset:64
v_mfma_f32_16x16x32_f16 v[128:131], v[0:3], v[68:71], v[128:131]
s_waitcnt lgkmcnt(2)
v_mfma_f32_16x16x32_f16 v[124:127], v[4:7], v[64:67], v[124:127]
ds_read_b128 v[0:3], v250 offset:10240
v_permlane16_swap_b32 v80, v84
v_mfma_f32_16x16x32_f16 v[132:135], v[4:7], v[68:71], v[132:135]
s_waitcnt lgkmcnt(2)
v_mfma_f32_16x16x32_f16 v[136:139], v[224:227], v[64:67], v[136:139]
ds_read_b128 v[4:7], v250 offset:10496
v_permlane16_swap_b32 v81, v85
v_mfma_f32_16x16x32_f16 v[144:147], v[224:227], v[68:71], v[144:147]
s_waitcnt lgkmcnt(2)
v_mfma_f32_16x16x32_f16 v[140:143], v[228:231], v[64:67], v[140:143]
ds_read_b128 v[224:227], v250 offset:14336
v_permlane16_swap_b32 v82, v86
v_mfma_f32_16x16x32_f16 v[148:151], v[228:231], v[68:71], v[148:151]
s_waitcnt lgkmcnt(2)
v_mfma_f32_16x16x32_f16 v[152:155], v[0:3], v[64:67], v[152:155]
ds_read_b128 v[228:231], v250 offset:14592
v_mfma_f32_16x16x32_f16 v[160:163], v[0:3], v[68:71], v[160:163]
v_permlane16_swap_b32 v83, v87
s_waitcnt lgkmcnt(2)
v_mfma_f32_16x16x32_f16 v[156:159], v[4:7], v[64:67], v[156:159]
ds_read_b128 v[0:3], v250 offset:15360
v_mfma_f32_16x16x32_f16 v[164:167], v[4:7], v[68:71], v[164:167]
v_permlane16_swap_b32 v168, v172
s_waitcnt lgkmcnt(2)
v_mfma_f32_16x16x32_f16 v[120:123], v[224:227], v[72:75], v[120:123]
ds_read_b128 v[4:7], v250 offset:15616
v_mfma_f32_16x16x32_f16 v[128:131], v[224:227], v[76:79], v[128:131]
v_permlane16_swap_b32 v169, v173
s_waitcnt lgkmcnt(2)
v_mfma_f32_16x16x32_f16 v[124:127], v[228:231], v[72:75], v[124:127]
s_add_u32 s46, s71, 98304
buffer_load_dwordx4 v[12:15], v252, s[4:7], s46 offen offset:128
ds_read_b128 v[224:227], v250 offset:16384
v_mfma_f32_16x16x32_f16 v[132:135], v[228:231], v[76:79], v[132:135]
s_waitcnt lgkmcnt(2)
v_mfma_f32_16x16x32_f16 v[136:139], v[0:3], v[72:75], v[136:139]
ds_read_b128 v[228:231], v250 offset:16640
v_permlane16_swap_b32 v170, v174
v_mfma_f32_16x16x32_f16 v[144:147], v[0:3], v[76:79], v[144:147]
s_waitcnt lgkmcnt(2)
v_mfma_f32_16x16x32_f16 v[140:143], v[4:7], v[72:75], v[140:143]
ds_read_b128 v[0:3], v250 offset:20480
v_permlane16_swap_b32 v171, v175
v_mfma_f32_16x16x32_f16 v[148:151], v[4:7], v[76:79], v[148:151]
s_waitcnt lgkmcnt(2)
v_mfma_f32_16x16x32_f16 v[152:155], v[224:227], v[72:75], v[152:155]
ds_read_b128 v[4:7], v250 offset:20736
v_permlane16_swap_b32 v192, v196
v_mfma_f32_16x16x32_f16 v[160:163], v[224:227], v[76:79], v[160:163]
s_waitcnt lgkmcnt(2)
v_mfma_f32_16x16x32_f16 v[156:159], v[228:231], v[72:75], v[156:159]
ds_read_b128 v[224:227], v250 offset:21504
v_mfma_f32_16x16x32_f16 v[164:167], v[228:231], v[76:79], v[164:167]
v_permlane16_swap_b32 v193, v197
s_waitcnt vmcnt(5)
v_mfma_f32_16x16x32_bf16 v[152:155], v[26:29], v[16:19], v[152:155]
ds_read_b128 v[228:231], v250 offset:21760
v_mfma_f32_16x16x32_bf16 v[156:159], v[24:27], v[16:19], v[156:159]
v_permlane16_swap_b32 v194, v198
s_waitcnt vmcnt(4)
v_mfma_f32_16x16x32_bf16 v[128:131], v[26:29], v[20:23], v[128:131]
v_mfma_f32_16x16x32_bf16 v[132:135], v[24:27], v[20:23], v[132:135]
v_permlane16_swap_b32 v195, v199
v_and_b32 v255, 1, v251
v_lshlrev_b32 v255, 7, v255
v_sub_u32 v255, v252, v255
s_mov_b32 s74, 1431655765
s_mov_b32 s75, 1431655765
s_waitcnt lgkmcnt(3)
v_mfma_f32_16x16x32_f16 v[120:123], v[0:3], v[80:83], v[120:123]
buffer_load_dwordx4 v[20:23], v252, s[4:7], s70 offen
v_mfma_f32_16x16x32_f16 v[128:131], v[0:3], v[84:87], v[128:131]
v_permlane16_swap_b32 v176, v180
s_waitcnt lgkmcnt(2)
v_mfma_f32_16x16x32_f16 v[124:127], v[4:7], v[80:83], v[124:127]
ds_read_b128 v[0:3], v250 offset:22528
v_mfma_f32_16x16x32_f16 v[132:135], v[4:7], v[84:87], v[132:135]
v_permlane16_swap_b32 v177, v181
s_waitcnt lgkmcnt(2)
v_mfma_f32_16x16x32_f16 v[136:139], v[224:227], v[80:83], v[136:139]
ds_read_b128 v[4:7], v250 offset:22784
v_mfma_f32_16x16x32_f16 v[144:147], v[224:227], v[84:87], v[144:147]
v_permlane16_swap_b32 v178, v182
s_waitcnt lgkmcnt(2)
v_mfma_f32_16x16x32_f16 v[140:143], v[228:231], v[80:83], v[140:143]
ds_read_b128 v[224:227], v250 offset:26624
v_mfma_f32_16x16x32_f16 v[148:151], v[228:231], v[84:87], v[148:151]
v_permlane16_swap_b32 v179, v183
s_waitcnt lgkmcnt(2)
v_mfma_f32_16x16x32_f16 v[152:155], v[0:3], v[80:83], v[152:155]
ds_read_b128 v[228:231], v250 offset:26880
v_mfma_f32_16x16x32_f16 v[160:163], v[0:3], v[84:87], v[160:163]
v_permlane16_swap_b32 v184, v188
s_waitcnt lgkmcnt(2)
v_mfma_f32_16x16x32_f16 v[156:159], v[4:7], v[80:83], v[156:159]
ds_read_b128 v[0:3], v250 offset:27648
v_mfma_f32_16x16x32_f16 v[164:167], v[4:7], v[84:87], v[164:167]
v_permlane16_swap_b32 v185, v189
s_waitcnt lgkmcnt(2)
v_mfma_f32_16x16x32_f16 v[120:123], v[224:227], v[168:171], v[120:123]
buffer_load_dwordx4 v[16:19], v252, s[4:7], s70 offen offset:64
ds_read_b128 v[4:7], v250 offset:27904
v_mfma_f32_16x16x32_f16 v[128:131], v[224:227], v[172:175], v[128:131]
v_permlane16_swap_b32 v186, v190
s_waitcnt lgkmcnt(2)
v_mfma_f32_16x16x32_f16 v[124:127], v[228:231], v[168:171], v[124:127]
ds_read_b128 v[224:227], v250 offset:28672
v_mfma_f32_16x16x32_f16 v[132:135], v[228:231], v[172:175], v[132:135]
v_permlane16_swap_b32 v187, v191
s_waitcnt lgkmcnt(2)
v_mfma_f32_16x16x32_f16 v[136:139], v[0:3], v[168:171], v[136:139]
ds_read_b128 v[228:231], v250 offset:28928
v_mfma_f32_16x16x32_f16 v[144:147], v[0:3], v[172:175], v[144:147]
v_permlane16_swap_b32 v112, v116
s_waitcnt lgkmcnt(2)
v_mfma_f32_16x16x32_f16 v[140:143], v[4:7], v[168:171], v[140:143]
ds_read_b128 v[0:3], v249 offset:55296
v_mfma_f32_16x16x32_f16 v[148:151], v[4:7], v[172:175], v[148:151]
v_permlane16_swap_b32 v113, v117
s_waitcnt lgkmcnt(2)
v_mfma_f32_16x16x32_f16 v[152:155], v[224:227], v[168:171], v[152:155]
ds_read_b128 v[4:7], v254 offset:7936
v_mfma_f32_16x16x32_f16 v[160:163], v[224:227], v[172:175], v[160:163]
v_permlane16_swap_b32 v114, v118
s_waitcnt lgkmcnt(2)
v_mfma_f32_16x16x32_f16 v[156:159], v[228:231], v[168:171], v[156:159]
ds_read_b128 v[224:227], v249 offset:55552
v_mfma_f32_16x16x32_f16 v[164:167], v[228:231], v[172:175], v[164:167]
v_permlane16_swap_b32 v115, v119
s_waitcnt lgkmcnt(1)
v_mfma_f32_16x16x32_f16 v[48:51], v[0:3], v[176:179], v[4:7]
ds_read_b128 v[228:231], v254 offset:7952
v_mfma_f32_16x16x32_f16 v[56:59], v[0:3], v[180:183], v[4:7]
s_waitcnt lgkmcnt(0)
v_mfma_f32_16x16x32_f16 v[52:55], v[224:227], v[176:179], v[228:231]
ds_read_b128 v[0:3], v249 offset:56320
ds_read_b128 v[4:7], v254 offset:8064
v_mfma_f32_16x16x32_f16 v[60:63], v[224:227], v[180:183], v[228:231]
s_waitcnt lgkmcnt(0)
v_mfma_f32_16x16x32_f16 v[64:67], v[0:3], v[176:179], v[4:7]
ds_read_b128 v[224:227], v249 offset:56576
ds_read_b128 v[228:231], v254 offset:8080
v_mfma_f32_16x16x32_f16 v[72:75], v[0:3], v[180:183], v[4:7]
v_permlane16_swap_b32 v88, v92
s_waitcnt lgkmcnt(0)
v_mfma_f32_16x16x32_f16 v[68:71], v[224:227], v[176:179], v[228:231]
ds_read_b128 v[0:3], v249 offset:57344
ds_read_b128 v[4:7], v254 offset:16128
v_mfma_f32_16x16x32_f16 v[76:79], v[224:227], v[180:183], v[228:231]
v_permlane16_swap_b32 v89, v93
s_waitcnt lgkmcnt(0)
v_mfma_f32_16x16x32_f16 v[80:83], v[0:3], v[176:179], v[4:7]
ds_read_b128 v[224:227], v249 offset:57600
ds_read_b128 v[228:231], v254 offset:16144
v_permlane16_swap_b32 v90, v94
v_mfma_f32_16x16x32_f16 v[168:171], v[0:3], v[180:183], v[4:7]
s_waitcnt lgkmcnt(0)
v_mfma_f32_16x16x32_f16 v[84:87], v[224:227], v[176:179], v[228:231]
ds_read_b128 v[0:3], v249 offset:61440
ds_read_b128 v[4:7], v249 offset:61696
v_permlane16_swap_b32 v91, v95
v_mfma_f32_16x16x32_f16 v[172:175], v[224:227], v[180:183], v[228:231]
v_cvt_pk_bf16_f32 v136, v136, v137
v_cvt_pk_bf16_f32 v137, v138, v139
s_waitcnt lgkmcnt(1)
v_mfma_f32_16x16x32_f16 v[48:51], v[0:3], v[184:187], v[48:51]
ds_read_b128 v[224:227], v249 offset:62464
ds_read_b128 v[228:231], v249 offset:62720
v_cvt_pk_bf16_f32 v138, v140, v141
v_mfma_f32_16x16x32_f16 v[56:59], v[0:3], v[188:191], v[56:59]
v_cvt_pk_bf16_f32 v139, v142, v143
v_cvt_pk_bf16_f32 v120, v120, v121
s_waitcnt lgkmcnt(2)
v_mfma_f32_16x16x32_f16 v[52:55], v[4:7], v[184:187], v[52:55]
ds_read_b128 v[0:3], v249 offset:63488
v_cvt_pk_bf16_f32 v121, v122, v123
v_mfma_f32_16x16x32_f16 v[60:63], v[4:7], v[188:191], v[60:63]
v_cvt_pk_bf16_f32 v122, v124, v125
s_waitcnt lgkmcnt(2)
v_mfma_f32_16x16x32_f16 v[64:67], v[224:227], v[184:187], v[64:67]
ds_read_b128 v[4:7], v249 offset:63744
v_cvt_pk_bf16_f32 v123, v126, v127
v_cvt_pk_bf16_f32 v152, v152, v153
v_mfma_f32_16x16x32_f16 v[72:75], v[224:227], v[188:191], v[72:75]
v_cvt_pk_bf16_f32 v153, v154, v155
s_waitcnt lgkmcnt(2)
v_mfma_f32_16x16x32_f16 v[68:71], v[228:231], v[184:187], v[68:71]
ds_read_b128 v[224:227], v250 offset:2048
v_cvt_pk_bf16_f32 v154, v156, v157
v_mfma_f32_16x16x32_f16 v[76:79], v[228:231], v[188:191], v[76:79]
v_cvt_pk_bf16_f32 v155, v158, v159
s_mov_b64 vcc, s[74:75]
v_cndmask_b32_e64 v140, v120, v152, s[74:75]
s_waitcnt lgkmcnt(2)
v_mfma_f32_16x16x32_f16 v[80:83], v[0:3], v[184:187], v[80:83]
ds_read_b128 v[228:231], v250 offset:2304
v_cndmask_b32_dpp v120, v136, v120, vcc quad_perm:[1,0,3,2] row_mask:0xf bank_mask:0xf
v_mfma_f32_16x16x32_f16 v[168:171], v[0:3], v[188:191], v[168:171]
v_cndmask_b32_e64 v141, v121, v153, s[74:75]
s_waitcnt lgkmcnt(2)
v_mfma_f32_16x16x32_f16 v[84:87], v[4:7], v[184:187], v[84:87]
ds_read_b128 v[0:3], v248 offset:16384
v_cndmask_b32_dpp v121, v137, v121, vcc quad_perm:[1,0,3,2] row_mask:0xf bank_mask:0xf
v_cndmask_b32_e64 v142, v122, v154, s[74:75]
v_mfma_f32_16x16x32_f16 v[172:175], v[4:7], v[188:191], v[172:175]
v_cndmask_b32_dpp v122, v138, v122, vcc quad_perm:[1,0,3,2] row_mask:0xf bank_mask:0xf
s_waitcnt vmcnt(3)
v_mfma_f32_16x16x32_bf16 v[144:147], v[26:29], v[8:11], v[144:147]
ds_read_b128 v[4:7], v250 offset:3072
v_cndmask_b32_e64 v143, v123, v155, s[74:75]
v_mfma_f32_16x16x32_bf16 v[148:151], v[24:27], v[8:11], v[148:151]
v_cndmask_b32_dpp v123, v139, v123, vcc quad_perm:[1,0,3,2] row_mask:0xf bank_mask:0xf
s_not_b64 vcc, s[74:75]
v_cndmask_b32_dpp v152, v136, v152, vcc quad_perm:[1,0,3,2] row_mask:0xf bank_mask:0xf
s_waitcnt vmcnt(2)
v_mfma_f32_16x16x32_bf16 v[160:163], v[26:29], v[12:15], v[160:163]
v_cndmask_b32_dpp v153, v137, v153, vcc quad_perm:[1,0,3,2] row_mask:0xf bank_mask:0xf
v_mfma_f32_16x16x32_bf16 v[164:167], v[24:27], v[12:15], v[164:167]
v_cndmask_b32_dpp v154, v138, v154, vcc quad_perm:[1,0,3,2] row_mask:0xf bank_mask:0xf
v_cndmask_b32_dpp v155, v139, v155, vcc quad_perm:[1,0,3,2] row_mask:0xf bank_mask:0xf
s_waitcnt lgkmcnt(2)
v_mfma_f32_16x16x32_f16 v[48:51], v[224:227], v[192:195], v[48:51]
buffer_load_dwordx4 v[8:11], v252, s[4:7], s70 offen offset:128
buffer_store_dwordx4 v[120:123], v255, s[8:11], s71 offen sc1
v_mfma_f32_16x16x32_f16 v[56:59], v[224:227], v[196:199], v[56:59]
v_mfma_f32_16x16x32_f16 v[52:55], v[228:231], v[192:195], v[52:55]
ds_read_b128 v[224:227], v250 offset:3328
v_permlane16_swap_b32 v240, v244
v_mfma_f32_16x16x32_f16 v[60:63], v[228:231], v[196:199], v[60:63]
s_waitcnt lgkmcnt(2)
v_mfma_f32_16x16x32_bf16 v[176:179], v[0:3], v[96:99], 0
ds_read_b128 v[228:231], v250 offset:4096
v_permlane16_swap_b32 v241, v245
v_mfma_f32_16x16x32_bf16 v[184:187], v[0:3], v[100:103], 0
s_waitcnt lgkmcnt(2)
v_mfma_f32_16x16x32_f16 v[64:67], v[4:7], v[192:195], v[64:67]
ds_read_b128 v[0:3], v250 offset:4352
v_mfma_f32_16x16x32_f16 v[72:75], v[4:7], v[196:199], v[72:75]
v_permlane16_swap_b32 v242, v246
s_waitcnt lgkmcnt(2)
v_mfma_f32_16x16x32_f16 v[68:71], v[224:227], v[192:195], v[68:71]
ds_read_b128 v[4:7], v248 offset:16640
v_mfma_f32_16x16x32_f16 v[76:79], v[224:227], v[196:199], v[76:79]
v_permlane16_swap_b32 v243, v247
s_waitcnt lgkmcnt(2)
v_mfma_f32_16x16x32_f16 v[80:83], v[228:231], v[192:195], v[80:83]
s_add_u32 s46, s70, 98304
buffer_load_dwordx4 v[12:15], v252, s[4:7], s46 offen
ds_read_b128 v[224:227], v250 offset:8192
v_mfma_f32_16x16x32_f16 v[168:171], v[228:231], v[196:199], v[168:171]
s_waitcnt lgkmcnt(2)
v_mfma_f32_16x16x32_f16 v[84:87], v[0:3], v[192:195], v[84:87]
ds_read_b128 v[228:231], v250 offset:8448
v_permlane16_swap_b32 v232, v236
v_mfma_f32_16x16x32_f16 v[172:175], v[0:3], v[196:199], v[172:175]
s_waitcnt lgkmcnt(2)
v_mfma_f32_16x16x32_bf16 v[180:183], v[4:7], v[96:99], 0
ds_read_b128 v[0:3], v250 offset:9216
v_permlane16_swap_b32 v233, v237
v_mfma_f32_16x16x32_bf16 v[188:191], v[4:7], v[100:103], 0
s_waitcnt lgkmcnt(2)
v_mfma_f32_16x16x32_f16 v[48:51], v[224:227], v[200:203], v[48:51]
ds_read_b128 v[4:7], v250 offset:9472
v_mfma_f32_16x16x32_f16 v[56:59], v[224:227], v[204:207], v[56:59]
v_permlane16_swap_b32 v234, v238
s_waitcnt lgkmcnt(2)
v_mfma_f32_16x16x32_f16 v[52:55], v[228:231], v[200:203], v[52:55]
ds_read_b128 v[224:227], v248 offset:17408
v_mfma_f32_16x16x32_f16 v[60:63], v[228:231], v[204:207], v[60:63]
v_permlane16_swap_b32 v235, v239
s_waitcnt lgkmcnt(2)
v_mfma_f32_16x16x32_f16 v[64:67], v[0:3], v[200:203], v[64:67]
buffer_store_dwordx4 v[140:143], v255, s[8:11], s71 offen offset:128 sc1
ds_read_b128 v[228:231], v250 offset:10240
v_mfma_f32_16x16x32_f16 v[72:75], v[0:3], v[204:207], v[72:75]
s_waitcnt lgkmcnt(2)
v_mfma_f32_16x16x32_f16 v[68:71], v[4:7], v[200:203], v[68:71]
ds_read_b128 v[0:3], v250 offset:10496
v_permlane16_swap_b32 v216, v220
v_mfma_f32_16x16x32_f16 v[76:79], v[4:7], v[204:207], v[76:79]
s_waitcnt lgkmcnt(2)
v_mfma_f32_16x16x32_bf16 v[176:179], v[224:227], v[104:107], v[176:179]
ds_read_b128 v[4:7], v250 offset:14336
v_permlane16_swap_b32 v217, v221
v_mfma_f32_16x16x32_bf16 v[184:187], v[224:227], v[108:111], v[184:187]
s_waitcnt lgkmcnt(2)
v_mfma_f32_16x16x32_f16 v[80:83], v[228:231], v[200:203], v[80:83]
ds_read_b128 v[224:227], v250 offset:14592
v_mfma_f32_16x16x32_f16 v[168:171], v[228:231], v[204:207], v[168:171]
v_permlane16_swap_b32 v218, v222
s_waitcnt lgkmcnt(2)
v_mfma_f32_16x16x32_f16 v[84:87], v[0:3], v[200:203], v[84:87]
ds_read_b128 v[228:231], v248 offset:17664
v_mfma_f32_16x16x32_f16 v[172:175], v[0:3], v[204:207], v[172:175]
v_permlane16_swap_b32 v219, v223
s_waitcnt lgkmcnt(2)
v_mfma_f32_16x16x32_f16 v[48:51], v[4:7], v[240:243], v[48:51]
buffer_store_dwordx4 v[152:155], v255, s[8:11], s71 offen offset:256 sc1
ds_read_b128 v[0:3], v250 offset:15360
v_mfma_f32_16x16x32_f16 v[56:59], v[4:7], v[244:247], v[56:59]
s_waitcnt lgkmcnt(2)
v_mfma_f32_16x16x32_f16 v[52:55], v[224:227], v[240:243], v[52:55]
ds_read_b128 v[4:7], v250 offset:15616
v_mfma_f32_16x16x32_f16 v[60:63], v[224:227], v[244:247], v[60:63]
s_waitcnt lgkmcnt(2)
v_mfma_f32_16x16x32_bf16 v[180:183], v[228:231], v[104:107], v[180:183]
ds_read_b128 v[224:227], v250 offset:16384
v_mfma_f32_16x16x32_bf16 v[188:191], v[228:231], v[108:111], v[188:191]
s_waitcnt lgkmcnt(2)
v_mfma_f32_16x16x32_f16 v[64:67], v[0:3], v[240:243], v[64:67]
ds_read_b128 v[228:231], v250 offset:16640
v_mfma_f32_16x16x32_f16 v[72:75], v[0:3], v[244:247], v[72:75]
s_waitcnt lgkmcnt(2)
v_mfma_f32_16x16x32_f16 v[68:71], v[4:7], v[240:243], v[68:71]
ds_read_b128 v[0:3], v248 offset:18432
v_mfma_f32_16x16x32_f16 v[76:79], v[4:7], v[244:247], v[76:79]
s_waitcnt lgkmcnt(2)
v_mfma_f32_16x16x32_f16 v[80:83], v[224:227], v[240:243], v[80:83]
ds_read_b128 v[4:7], v250 offset:20480
v_permlane16_swap_b32 v208, v212
v_mfma_f32_16x16x32_f16 v[168:171], v[224:227], v[244:247], v[168:171]
s_waitcnt lgkmcnt(2)
v_mfma_f32_16x16x32_f16 v[84:87], v[228:231], v[240:243], v[84:87]
ds_read_b128 v[224:227], v250 offset:20736
v_mfma_f32_16x16x32_f16 v[172:175], v[228:231], v[244:247], v[172:175]
s_waitcnt lgkmcnt(2)
v_mfma_f32_16x16x32_bf16 v[176:179], v[0:3], v[112:115], v[176:179]
ds_read_b128 v[228:231], v250 offset:21504
v_mfma_f32_16x16x32_bf16 v[184:187], v[0:3], v[116:119], v[184:187]
s_waitcnt lgkmcnt(2)
v_mfma_f32_16x16x32_f16 v[48:51], v[4:7], v[232:235], v[48:51]
ds_read_b128 v[0:3], v250 offset:21760
v_mfma_f32_16x16x32_f16 v[56:59], v[4:7], v[236:239], v[56:59]
s_waitcnt lgkmcnt(2)
v_mfma_f32_16x16x32_f16 v[52:55], v[224:227], v[232:235], v[52:55]
ds_read_b128 v[4:7], v248 offset:18688
v_mfma_f32_16x16x32_f16 v[60:63], v[224:227], v[236:239], v[60:63]
s_waitcnt lgkmcnt(2)
v_mfma_f32_16x16x32_f16 v[64:67], v[228:231], v[232:235], v[64:67]
ds_read_b128 v[224:227], v250 offset:22528
v_mfma_f32_16x16x32_f16 v[72:75], v[228:231], v[236:239], v[72:75]
v_permlane16_swap_b32 v209, v213
s_waitcnt lgkmcnt(2)
v_mfma_f32_16x16x32_f16 v[68:71], v[0:3], v[232:235], v[68:71]
ds_read_b128 v[228:231], v250 offset:22784
v_mfma_f32_16x16x32_f16 v[76:79], v[0:3], v[236:239], v[76:79]
s_waitcnt lgkmcnt(2)
v_mfma_f32_16x16x32_bf16 v[180:183], v[4:7], v[112:115], v[180:183]
ds_read_b128 v[0:3], v250 offset:26624
v_mfma_f32_16x16x32_bf16 v[188:191], v[4:7], v[116:119], v[188:191]
s_waitcnt lgkmcnt(2)
v_mfma_f32_16x16x32_f16 v[80:83], v[224:227], v[232:235], v[80:83]
ds_read_b128 v[4:7], v250 offset:26880
v_mfma_f32_16x16x32_f16 v[168:171], v[224:227], v[236:239], v[168:171]
s_waitcnt lgkmcnt(2)
v_mfma_f32_16x16x32_f16 v[84:87], v[228:231], v[232:235], v[84:87]
ds_read_b128 v[224:227], v250 offset:27648
v_mfma_f32_16x16x32_f16 v[172:175], v[228:231], v[236:239], v[172:175]
s_waitcnt lgkmcnt(2)
v_mfma_f32_16x16x32_f16 v[48:51], v[0:3], v[216:219], v[48:51]
ds_read_b128 v[228:231], v250 offset:27904
v_mfma_f32_16x16x32_f16 v[56:59], v[0:3], v[220:223], v[56:59]
v_permlane16_swap_b32 v210, v214
s_waitcnt lgkmcnt(2)
v_mfma_f32_16x16x32_f16 v[52:55], v[4:7], v[216:219], v[52:55]
ds_read_b128 v[0:3], v250 offset:28672
v_mfma_f32_16x16x32_f16 v[60:63], v[4:7], v[220:223], v[60:63]
s_waitcnt lgkmcnt(2)
v_mfma_f32_16x16x32_f16 v[64:67], v[224:227], v[216:219], v[64:67]
ds_read_b128 v[4:7], v250 offset:28928
v_mfma_f32_16x16x32_f16 v[72:75], v[224:227], v[220:223], v[72:75]
s_waitcnt lgkmcnt(2)
v_mfma_f32_16x16x32_f16 v[68:71], v[228:231], v[216:219], v[68:71]
ds_read_b128 v[224:227], v248 offset:22528
v_mfma_f32_16x16x32_f16 v[76:79], v[228:231], v[220:223], v[76:79]
s_waitcnt lgkmcnt(2)
v_mfma_f32_16x16x32_f16 v[80:83], v[0:3], v[216:219], v[80:83]
ds_read_b128 v[228:231], v248 offset:22784
v_mfma_f32_16x16x32_f16 v[168:171], v[0:3], v[220:223], v[168:171]
s_waitcnt lgkmcnt(2)
v_mfma_f32_16x16x32_f16 v[84:87], v[4:7], v[216:219], v[84:87]
ds_read_b128 v[0:3], v248 offset:23552
v_mfma_f32_16x16x32_f16 v[172:175], v[4:7], v[220:223], v[172:175]
v_permlane16_swap_b32 v211, v215
s_setprio 3
v_cvt_pkrtz_f16_f32 v193, v176, v177
v_cvt_pkrtz_f16_f32 v195, v178, v179
v_cvt_pkrtz_f16_f32 v197, v180, v181
v_cvt_pkrtz_f16_f32 v199, v182, v183
v_cvt_pkrtz_f16_f32 v201, v184, v185
v_cvt_pkrtz_f16_f32 v203, v186, v187
v_cvt_pk_f16_f32 v243, v188, v189
v_cvt_pk_f16_f32 v240, v190, v191
s_waitcnt lgkmcnt(2)
v_mfma_f32_16x16x32_bf16 v[176:179], v[224:227], v[96:99], 0
s_add_u32 s46, s70, 98304
buffer_load_dwordx4 v[216:219], v252, s[4:7], s46 offen offset:64
ds_read_b128 v[4:7], v248 offset:23808
v_mfma_f32_16x16x32_bf16 v[184:187], v[224:227], v[100:103], 0
v_pk_fma_f16 v242, v243, v243, s48
v_cvt_pk_bf16_f32 v144, v144, v145
v_and_b32 v193, s49, v193
v_cvt_pk_bf16_f32 v145, v146, v147
s_waitcnt lgkmcnt(2)
v_mfma_f32_16x16x32_bf16 v[180:183], v[228:231], v[96:99], 0
ds_read_b128 v[224:227], v248 offset:24576
v_and_b32 v195, s49, v195
v_cvt_pk_bf16_f32 v146, v148, v149
v_pk_fma_f16 v207, v240, v240, s48
v_lshrrev_b16 v192, 2, v193
v_cvt_pk_bf16_f32 v147, v150, v151
v_pk_mul_f16 v242, v243, v242
v_mfma_f32_16x16x32_bf16 v[188:191], v[228:231], v[100:103], 0
v_cvt_pk_bf16_f32 v128, v128, v129
v_lshrrev_b16 v194, 2, v195
v_pk_mul_f16 v207, v240, v207
v_cvt_pk_bf16_f32 v129, v130, v131
v_lshrrev_b32 v193, 18, v193
v_cvt_pk_bf16_f32 v130, v132, v133
s_waitcnt lgkmcnt(2)
v_mfma_f32_16x16x32_bf16 v[176:179], v[0:3], v[104:107], v[176:179]
ds_read_b128 v[228:231], v248 offset:24832
ds_read_u16_d16 v192, v192
ds_read_u16_d16 v194, v194
ds_read_u16_d16_hi v193, v193
v_exp_f16 v241, v242
v_cvt_pk_bf16_f32 v131, v134, v135
v_lshrrev_b32 v195, 18, v195
v_cvt_pk_bf16_f32 v160, v160, v161
v_and_b32 v197, s49, v197
v_mfma_f32_16x16x32_bf16 v[184:187], v[0:3], v[108:111], v[184:187]
v_cvt_pk_bf16_f32 v161, v162, v163
v_exp_f16 v206, v207
v_cvt_pk_bf16_f32 v162, v164, v165
v_and_b32 v199, s49, v199
v_cvt_pk_bf16_f32 v163, v166, v167
s_mov_b64 vcc, s[74:75]
s_waitcnt lgkmcnt(4)
v_mfma_f32_16x16x32_bf16 v[180:183], v[4:7], v[104:107], v[180:183]
s_add_u32 s46, s70, 98304
buffer_load_dwordx4 v[244:247], v252, s[4:7], s46 offen offset:128
ds_read_u16_d16_hi v195, v195
v_lshrrev_b16 v196, 2, v197
v_exp_f16_sdwa v241, v242 dst_sel:WORD_1 dst_unused:UNUSED_PRESERVE src0_sel:WORD_1
v_cndmask_b32_e64 v148, v128, v160, s[74:75]
v_cndmask_b32_dpp v128, v144, v128, vcc quad_perm:[1,0,3,2] row_mask:0xf bank_mask:0xf
v_lshrrev_b16 v198, 2, v199
v_mfma_f32_16x16x32_bf16 v[188:191], v[4:7], v[108:111], v[188:191]
v_cndmask_b32_e64 v149, v129, v161, s[74:75]
v_lshrrev_b32 v197, 18, v197
v_lshrrev_b32 v199, 18, v199
v_cndmask_b32_dpp v129, v145, v129, vcc quad_perm:[1,0,3,2] row_mask:0xf bank_mask:0xf
v_exp_f16_sdwa v206, v207 dst_sel:WORD_1 dst_unused:UNUSED_PRESERVE src0_sel:WORD_1
v_mfma_f32_16x16x32_bf16 v[176:179], v[224:227], v[112:115], v[176:179]
ds_read_u16_d16 v196, v196
ds_read_u16_d16 v198, v198
ds_read_u16_d16_hi v197, v197
ds_read_u16_d16_hi v199, v199
v_cndmask_b32_e64 v150, v130, v162, s[74:75]
v_and_b32 v201, s49, v201
v_cndmask_b32_dpp v130, v146, v130, vcc quad_perm:[1,0,3,2] row_mask:0xf bank_mask:0xf
v_and_b32 v203, s49, v203
v_cndmask_b32_e64 v151, v131, v163, s[74:75]
v_pk_add_f16 v241, v241, 1.0 op_sel_hi:[1,0]
v_mfma_f32_16x16x32_bf16 v[184:187], v[224:227], v[116:119], v[184:187]
v_cndmask_b32_dpp v131, v147, v131, vcc quad_perm:[1,0,3,2] row_mask:0xf bank_mask:0xf
s_not_b64 vcc, s[74:75]
v_lshrrev_b16 v200, 2, v201
v_pk_add_f16 v206, v206, 1.0 op_sel_hi:[1,0]
v_cndmask_b32_dpp v160, v144, v160, vcc quad_perm:[1,0,3,2] row_mask:0xf bank_mask:0xf
v_lshrrev_b16 v202, 2, v203
v_cndmask_b32_dpp v161, v145, v161, vcc quad_perm:[1,0,3,2] row_mask:0xf bank_mask:0xf
s_waitcnt lgkmcnt(4)
v_mfma_f32_16x16x32_bf16 v[180:183], v[228:231], v[112:115], v[180:183]
ds_read_b128 v[224:227], v249 offset:24576
ds_read_u16_d16 v200, v200
ds_read_u16_d16 v202, v202
v_rcp_f16 v242, v241
v_cndmask_b32_dpp v162, v146, v162, vcc quad_perm:[1,0,3,2] row_mask:0xf bank_mask:0xf
v_lshrrev_b32 v201, 18, v201
v_cndmask_b32_dpp v163, v147, v163, vcc quad_perm:[1,0,3,2] row_mask:0xf bank_mask:0xf
v_lshrrev_b32 v203, 18, v203
v_mfma_f32_16x16x32_bf16 v[188:191], v[228:231], v[116:119], v[188:191]
v_rcp_f16 v207, v206
v_rcp_f16_sdwa v242, v241 dst_sel:WORD_1 dst_unused:UNUSED_PRESERVE src0_sel:WORD_1
v_or_b32 v232, v192, v193
v_or_b32 v233, v194, v195
s_waitcnt lgkmcnt(3)
v_or_b32 v234, v196, v197
v_rcp_f16_sdwa v207, v206 dst_sel:WORD_1 dst_unused:UNUSED_PRESERVE src0_sel:WORD_1
v_or_b32 v235, v198, v199
ds_read_u16_d16_hi v201, v201
s_add_u32 s46, s71, 98304
buffer_store_dwordx4 v[128:131], v255, s[8:11], s46 offen sc1
ds_read_u16_d16_hi v203, v203
s_waitcnt lgkmcnt(1)
v_or_b32 v236, v200, v201
s_waitcnt lgkmcnt(0)
v_or_b32 v237, v202, v203
v_pk_mul_f16 v238, v243, v242
v_pk_mul_f16 v239, v240, v207
v_mfma_f32_16x16x32_f16 v[48:51], v[224:227], v[232:235], v[48:51]
s_add_u32 s46, s71, 98304
buffer_store_dwordx4 v[148:151], v255, s[8:11], s46 offen offset:128 sc1
ds_read_b128 v[228:231], v249 offset:24832
ds_read_b128 v[0:3], v248 offset:28672
ds_read_b128 v[4:7], v249 offset:25600
ds_read_b128 v[40:43], v248 offset:28928
ds_read_b128 v[44:47], v249 offset:25856
v_cvt_pkrtz_f16_f32 v193, v176, v177
v_cvt_pkrtz_f16_f32 v195, v178, v179
v_mfma_f32_16x16x32_f16 v[56:59], v[224:227], v[236:239], v[56:59]
v_cvt_pkrtz_f16_f32 v197, v180, v181
v_cvt_pkrtz_f16_f32 v199, v182, v183
s_waitcnt lgkmcnt(4)
v_mfma_f32_16x16x32_f16 v[52:55], v[228:231], v[232:235], v[52:55]
ds_read_b128 v[224:227], v248 offset:29696
v_cvt_pkrtz_f16_f32 v201, v184, v185
v_cvt_pk_f16_f32 v243, v186, v187
v_cvt_pk_f16_f32 v240, v188, v189
v_mfma_f32_16x16x32_f16 v[60:63], v[228:231], v[236:239], v[60:63]
v_cvt_pk_f16_f32 v205, v190, v191
v_pk_fma_f16 v242, v243, v243, s48
s_waitcnt lgkmcnt(4)
v_mfma_f32_16x16x32_bf16 v[176:179], v[0:3], v[96:99], 0
ds_read_b128 v[228:231], v249 offset:26624
v_and_b32 v193, s49, v193
v_pk_fma_f16 v207, v240, v240, s48
v_mfma_f32_16x16x32_bf16 v[184:187], v[0:3], v[100:103], 0
v_and_b32 v195, s49, v195
v_pk_fma_f16 v204, v205, v205, s48
s_setprio 2
v_lshrrev_b16 v192, 2, v193
s_waitcnt lgkmcnt(2)
v_mfma_f32_16x16x32_f16 v[64:67], v[4:7], v[232:235], v[64:67]
ds_read_b128 v[0:3], v249 offset:26880
ds_read_u16_d16 v192, v192
v_pk_mul_f16 v242, v243, v242
v_lshrrev_b16 v194, 2, v195
v_mfma_f32_16x16x32_f16 v[72:75], v[4:7], v[236:239], v[72:75]
v_pk_mul_f16 v207, v240, v207
v_lshrrev_b32 v193, 18, v193
v_mfma_f32_16x16x32_bf16 v[180:183], v[40:43], v[96:99], 0
ds_read_b128 v[4:7], v248 offset:29952
ds_read_u16_d16 v194, v194
ds_read_u16_d16_hi v193, v193
v_pk_mul_f16 v204, v205, v204
v_lshrrev_b32 v195, 18, v195
v_mfma_f32_16x16x32_bf16 v[188:191], v[40:43], v[100:103], 0
v_exp_f16 v241, v242
v_and_b32 v197, s49, v197
v_mfma_f32_16x16x32_f16 v[68:71], v[44:47], v[232:235], v[68:71]
ds_read_b128 v[40:43], v248 offset:30720
ds_read_u16_d16_hi v195, v195
v_and_b32 v199, s49, v199
v_mfma_f32_16x16x32_f16 v[76:79], v[44:47], v[236:239], v[76:79]
v_exp_f16 v206, v207
v_lshrrev_b16 v196, 2, v197
v_lshrrev_b16 v198, 2, v199
s_waitcnt lgkmcnt(7)
v_mfma_f32_16x16x32_bf16 v[176:179], v[224:227], v[104:107], v[176:179]
ds_read_b128 v[44:47], v248 offset:30976
ds_read_u16_d16 v196, v196
ds_read_u16_d16 v198, v198
v_exp_f16 v203, v204
v_mfma_f32_16x16x32_bf16 v[184:187], v[224:227], v[108:111], v[184:187]
v_lshrrev_b32 v197, 18, v197
v_lshrrev_b32 v199, 18, v199
v_mfma_f32_16x16x32_f16 v[80:83], v[228:231], v[232:235], v[80:83]
ds_read_b128 v[224:227], v249 offset:30720
ds_read_u16_d16_hi v197, v197
ds_read_u16_d16_hi v199, v199
v_exp_f16_sdwa v241, v242 dst_sel:WORD_1 dst_unused:UNUSED_PRESERVE src0_sel:WORD_1
v_and_b32 v201, s49, v201
v_mfma_f32_16x16x32_f16 v[168:171], v[228:231], v[236:239], v[168:171]
v_lshrrev_b16 v200, 2, v201
s_waitcnt lgkmcnt(8)
v_mfma_f32_16x16x32_f16 v[84:87], v[0:3], v[232:235], v[84:87]
ds_read_b128 v[228:231], v249 offset:30976
ds_read_u16_d16 v200, v200
v_exp_f16_sdwa v206, v207 dst_sel:WORD_1 dst_unused:UNUSED_PRESERVE src0_sel:WORD_1
v_lshrrev_b32 v201, 18, v201
v_mfma_f32_16x16x32_f16 v[172:175], v[0:3], v[236:239], v[172:175]
v_exp_f16_sdwa v203, v204 dst_sel:WORD_1 dst_unused:UNUSED_PRESERVE src0_sel:WORD_1
v_pk_add_f16 v241, v241, 1.0 op_sel_hi:[1,0]
v_mfma_f32_16x16x32_bf16 v[180:183], v[4:7], v[104:107], v[180:183]
ds_read_b128 v[0:3], v248 offset:34816
ds_read_u16_d16_hi v201, v201
v_pk_add_f16 v206, v206, 1.0 op_sel_hi:[1,0]
v_pk_add_f16 v203, v203, 1.0 op_sel_hi:[1,0]
v_mfma_f32_16x16x32_bf16 v[188:191], v[4:7], v[108:111], v[188:191]
v_rcp_f16 v242, v241
s_waitcnt lgkmcnt(7)
v_mfma_f32_16x16x32_bf16 v[176:179], v[40:43], v[112:115], v[176:179]
ds_read_b128 v[4:7], v249 offset:31744
v_rcp_f16 v207, v206
v_mfma_f32_16x16x32_bf16 v[184:187], v[40:43], v[116:119], v[184:187]
v_rcp_f16 v204, v203
v_mfma_f32_16x16x32_bf16 v[180:183], v[44:47], v[112:115], v[180:183]
ds_read_b128 v[40:43], v248 offset:35072
v_rcp_f16_sdwa v242, v241 dst_sel:WORD_1 dst_unused:UNUSED_PRESERVE src0_sel:WORD_1
v_mfma_f32_16x16x32_bf16 v[188:191], v[44:47], v[116:119], v[188:191]
v_rcp_f16_sdwa v207, v206 dst_sel:WORD_1 dst_unused:UNUSED_PRESERVE src0_sel:WORD_1
v_or_b32 v232, v192, v193
v_or_b32 v233, v194, v195
s_waitcnt lgkmcnt(4)
v_or_b32 v234, v196, v197
v_rcp_f16_sdwa v204, v203 dst_sel:WORD_1 dst_unused:UNUSED_PRESERVE src0_sel:WORD_1
v_or_b32 v235, v198, v199
s_waitcnt lgkmcnt(2)
v_or_b32 v236, v200, v201
v_pk_mul_f16 v237, v243, v242
v_pk_mul_f16 v238, v240, v207
v_pk_mul_f16 v239, v205, v204
v_mfma_f32_16x16x32_f16 v[48:51], v[224:227], v[232:235], v[48:51]
s_add_u32 s46, s71, 98304
buffer_store_dwordx4 v[160:163], v255, s[8:11], s46 offen offset:256 sc1
ds_read_b128 v[44:47], v249 offset:32000
v_cvt_pkrtz_f16_f32 v193, v176, v177
v_cvt_pkrtz_f16_f32 v195, v178, v179
v_mfma_f32_16x16x32_f16 v[56:59], v[224:227], v[236:239], v[56:59]
v_cvt_pkrtz_f16_f32 v197, v180, v181
v_cvt_pkrtz_f16_f32 v199, v182, v183
v_mfma_f32_16x16x32_f16 v[52:55], v[228:231], v[232:235], v[52:55]
ds_read_b128 v[224:227], v248 offset:35840
v_cvt_pkrtz_f16_f32 v201, v184, v185
v_cvt_pk_f16_f32 v243, v186, v187
v_mfma_f32_16x16x32_f16 v[60:63], v[228:231], v[236:239], v[60:63]
v_cvt_pk_f16_f32 v240, v188, v189
v_cvt_pk_f16_f32 v205, v190, v191
s_setprio 1
v_mfma_f32_16x16x32_bf16 v[176:179], v[0:3], v[96:99], 0
ds_read_b128 v[228:231], v249 offset:32768
v_pk_fma_f16 v242, v243, v243, s48
v_and_b32 v193, s49, v193
v_mfma_f32_16x16x32_bf16 v[184:187], v[0:3], v[100:103], 0
v_pk_fma_f16 v207, v240, v240, s48
v_and_b32 v195, s49, v195
s_waitcnt lgkmcnt(3)
v_mfma_f32_16x16x32_f16 v[64:67], v[4:7], v[232:235], v[64:67]
ds_read_b128 v[0:3], v249 offset:33024
v_pk_fma_f16 v204, v205, v205, s48
v_lshrrev_b16 v192, 2, v193
v_pk_mul_f16 v242, v243, v242
v_mfma_f32_16x16x32_f16 v[72:75], v[4:7], v[236:239], v[72:75]
v_lshrrev_b16 v194, 2, v195
v_pk_mul_f16 v207, v240, v207
s_waitcnt vmcnt(11)
v_mfma_f32_16x16x32_bf16 v[48:51], v[26:29], v[20:23], v[48:51]
ds_read_b128 v[4:7], v248 offset:36096
ds_read_u16_d16 v192, v192
ds_read_u16_d16 v194, v194
v_lshrrev_b32 v193, 18, v193
v_pk_mul_f16 v204, v205, v204
v_mfma_f32_16x16x32_bf16 v[52:55], v[24:27], v[20:23], v[52:55]
v_lshrrev_b32 v195, 18, v195
v_mfma_f32_16x16x32_bf16 v[180:183], v[40:43], v[96:99], 0
ds_read_u16_d16_hi v193, v193
ds_read_u16_d16_hi v195, v195
v_exp_f16 v241, v242
v_and_b32 v197, s49, v197
v_mfma_f32_16x16x32_bf16 v[188:191], v[40:43], v[100:103], 0
v_and_b32 v199, s49, v199
s_waitcnt lgkmcnt(6)
v_mfma_f32_16x16x32_f16 v[68:71], v[44:47], v[232:235], v[68:71]
ds_read_b128 v[40:43], v248 offset:36864
v_exp_f16 v206, v207
v_lshrrev_b16 v196, 2, v197
v_mfma_f32_16x16x32_f16 v[76:79], v[44:47], v[236:239], v[76:79]
v_lshrrev_b16 v198, 2, v199
v_exp_f16 v203, v204
v_mfma_f32_16x16x32_bf16 v[176:179], v[224:227], v[104:107], v[176:179]
ds_read_b128 v[44:47], v248 offset:37120
ds_read_u16_d16 v196, v196
ds_read_u16_d16 v198, v198
v_lshrrev_b32 v197, 18, v197
v_lshrrev_b32 v199, 18, v199
v_mfma_f32_16x16x32_bf16 v[184:187], v[224:227], v[108:111], v[184:187]
v_exp_f16_sdwa v241, v242 dst_sel:WORD_1 dst_unused:UNUSED_PRESERVE src0_sel:WORD_1
v_mfma_f32_16x16x32_f16 v[80:83], v[228:231], v[232:235], v[80:83]
ds_read_b128 v[224:227], v249 offset:36864
ds_read_u16_d16_hi v197, v197
ds_read_u16_d16_hi v199, v199
v_and_b32 v201, s49, v201
v_lshrrev_b16 v200, 2, v201
v_mfma_f32_16x16x32_f16 v[168:171], v[228:231], v[236:239], v[168:171]
v_exp_f16_sdwa v206, v207 dst_sel:WORD_1 dst_unused:UNUSED_PRESERVE src0_sel:WORD_1
s_waitcnt lgkmcnt(7)
v_mfma_f32_16x16x32_f16 v[84:87], v[0:3], v[232:235], v[84:87]
ds_read_b128 v[228:231], v249 offset:37120
ds_read_u16_d16 v200, v200
v_lshrrev_b32 v201, 18, v201
v_mfma_f32_16x16x32_f16 v[172:175], v[0:3], v[236:239], v[172:175]
v_exp_f16_sdwa v203, v204 dst_sel:WORD_1 dst_unused:UNUSED_PRESERVE src0_sel:WORD_1
v_pk_add_f16 v241, v241, 1.0 op_sel_hi:[1,0]
v_pk_add_f16 v206, v206, 1.0 op_sel_hi:[1,0]
v_mfma_f32_16x16x32_bf16 v[180:183], v[4:7], v[104:107], v[180:183]
ds_read_b128 v[0:3], v248 offset:40960
ds_read_u16_d16_hi v201, v201
v_pk_add_f16 v203, v203, 1.0 op_sel_hi:[1,0]
v_mfma_f32_16x16x32_bf16 v[188:191], v[4:7], v[108:111], v[188:191]
v_rcp_f16 v242, v241
s_setprio 0
s_waitcnt lgkmcnt(7)
v_mfma_f32_16x16x32_bf16 v[176:179], v[40:43], v[112:115], v[176:179]
ds_read_b128 v[4:7], v249 offset:37888
v_rcp_f16 v207, v206
v_mfma_f32_16x16x32_bf16 v[184:187], v[40:43], v[116:119], v[184:187]
v_rcp_f16 v204, v203
v_mfma_f32_16x16x32_bf16 v[180:183], v[44:47], v[112:115], v[180:183]
ds_read_b128 v[40:43], v248 offset:41216
v_rcp_f16_sdwa v242, v241 dst_sel:WORD_1 dst_unused:UNUSED_PRESERVE src0_sel:WORD_1
v_mfma_f32_16x16x32_bf16 v[188:191], v[44:47], v[116:119], v[188:191]
v_rcp_f16_sdwa v207, v206 dst_sel:WORD_1 dst_unused:UNUSED_PRESERVE src0_sel:WORD_1
v_or_b32 v232, v192, v193
v_or_b32 v233, v194, v195
s_waitcnt lgkmcnt(4)
v_or_b32 v234, v196, v197
v_rcp_f16_sdwa v204, v203 dst_sel:WORD_1 dst_unused:UNUSED_PRESERVE src0_sel:WORD_1
v_or_b32 v235, v198, v199
s_waitcnt lgkmcnt(2)
v_or_b32 v236, v200, v201
v_pk_mul_f16 v237, v243, v242
v_pk_mul_f16 v238, v240, v207
v_pk_mul_f16 v239, v205, v204
s_setprio 3
v_mfma_f32_16x16x32_f16 v[48:51], v[224:227], v[232:235], v[48:51]
ds_read_b128 v[44:47], v249 offset:38144
v_cvt_pkrtz_f16_f32 v193, v176, v177
v_cvt_pkrtz_f16_f32 v195, v178, v179
v_mfma_f32_16x16x32_f16 v[56:59], v[224:227], v[236:239], v[56:59]
v_cvt_pkrtz_f16_f32 v197, v180, v181
v_cvt_pkrtz_f16_f32 v199, v182, v183
v_mfma_f32_16x16x32_f16 v[52:55], v[228:231], v[232:235], v[52:55]
ds_read_b128 v[224:227], v248 offset:41984
v_cvt_pkrtz_f16_f32 v201, v184, v185
v_cvt_pk_f16_f32 v243, v186, v187
v_mfma_f32_16x16x32_f16 v[60:63], v[228:231], v[236:239], v[60:63]
v_cvt_pk_f16_f32 v240, v188, v189
v_cvt_pk_f16_f32 v205, v190, v191
v_mfma_f32_16x16x32_bf16 v[176:179], v[0:3], v[96:99], 0
ds_read_b128 v[228:231], v249 offset:38912
v_pk_fma_f16 v242, v243, v243, s48
v_and_b32 v193, s49, v193
v_mfma_f32_16x16x32_bf16 v[184:187], v[0:3], v[100:103], 0
v_pk_fma_f16 v207, v240, v240, s48
v_and_b32 v195, s49, v195
s_waitcnt lgkmcnt(3)
v_mfma_f32_16x16x32_f16 v[64:67], v[4:7], v[232:235], v[64:67]
ds_read_b128 v[0:3], v249 offset:39168
v_pk_fma_f16 v204, v205, v205, s48
v_lshrrev_b16 v192, 2, v193
v_pk_mul_f16 v242, v243, v242
v_mfma_f32_16x16x32_f16 v[72:75], v[4:7], v[236:239], v[72:75]
v_lshrrev_b16 v194, 2, v195
v_pk_mul_f16 v207, v240, v207
s_waitcnt vmcnt(10)
v_mfma_f32_16x16x32_bf16 v[64:67], v[26:29], v[16:19], v[64:67]
ds_read_b128 v[4:7], v248 offset:42240
ds_read_u16_d16 v192, v192
ds_read_u16_d16 v194, v194
v_lshrrev_b32 v193, 18, v193
v_pk_mul_f16 v204, v205, v204
v_mfma_f32_16x16x32_bf16 v[68:71], v[24:27], v[16:19], v[68:71]
v_lshrrev_b32 v195, 18, v195
v_mfma_f32_16x16x32_bf16 v[180:183], v[40:43], v[96:99], 0
ds_read_u16_d16_hi v193, v193
ds_read_u16_d16_hi v195, v195
v_exp_f16 v241, v242
v_and_b32 v197, s49, v197
v_mfma_f32_16x16x32_bf16 v[188:191], v[40:43], v[100:103], 0
v_and_b32 v199, s49, v199
s_waitcnt lgkmcnt(6)
v_mfma_f32_16x16x32_f16 v[68:71], v[44:47], v[232:235], v[68:71]
ds_read_b128 v[40:43], v248 offset:43008
v_exp_f16 v206, v207
v_lshrrev_b16 v196, 2, v197
v_mfma_f32_16x16x32_f16 v[76:79], v[44:47], v[236:239], v[76:79]
v_lshrrev_b16 v198, 2, v199
v_exp_f16 v203, v204
v_mfma_f32_16x16x32_bf16 v[176:179], v[224:227], v[104:107], v[176:179]
ds_read_b128 v[44:47], v248 offset:43264
ds_read_u16_d16 v196, v196
ds_read_u16_d16 v198, v198
v_lshrrev_b32 v197, 18, v197
v_lshrrev_b32 v199, 18, v199
v_mfma_f32_16x16x32_bf16 v[184:187], v[224:227], v[108:111], v[184:187]
v_exp_f16_sdwa v241, v242 dst_sel:WORD_1 dst_unused:UNUSED_PRESERVE src0_sel:WORD_1
v_mfma_f32_16x16x32_f16 v[80:83], v[228:231], v[232:235], v[80:83]
ds_read_b128 v[224:227], v249 offset:43008
ds_read_u16_d16_hi v197, v197
ds_read_u16_d16_hi v199, v199
v_and_b32 v201, s49, v201
v_lshrrev_b16 v200, 2, v201
v_mfma_f32_16x16x32_f16 v[168:171], v[228:231], v[236:239], v[168:171]
v_exp_f16_sdwa v206, v207 dst_sel:WORD_1 dst_unused:UNUSED_PRESERVE src0_sel:WORD_1
s_waitcnt lgkmcnt(7)
v_mfma_f32_16x16x32_f16 v[84:87], v[0:3], v[232:235], v[84:87]
ds_read_b128 v[228:231], v249 offset:43264
ds_read_u16_d16 v200, v200
v_lshrrev_b32 v201, 18, v201
v_mfma_f32_16x16x32_f16 v[172:175], v[0:3], v[236:239], v[172:175]
v_exp_f16_sdwa v203, v204 dst_sel:WORD_1 dst_unused:UNUSED_PRESERVE src0_sel:WORD_1
v_pk_add_f16 v241, v241, 1.0 op_sel_hi:[1,0]
v_pk_add_f16 v206, v206, 1.0 op_sel_hi:[1,0]
v_mfma_f32_16x16x32_bf16 v[180:183], v[4:7], v[104:107], v[180:183]
ds_read_b128 v[0:3], v248 offset:16384
ds_read_u16_d16_hi v201, v201
v_pk_add_f16 v203, v203, 1.0 op_sel_hi:[1,0]
v_mfma_f32_16x16x32_bf16 v[188:191], v[4:7], v[108:111], v[188:191]
v_rcp_f16 v242, v241
s_waitcnt lgkmcnt(7)
v_mfma_f32_16x16x32_bf16 v[176:179], v[40:43], v[112:115], v[176:179]
ds_read_b128 v[4:7], v249 offset:44032
v_rcp_f16 v207, v206
v_mfma_f32_16x16x32_bf16 v[184:187], v[40:43], v[116:119], v[184:187]
v_rcp_f16 v204, v203
v_mfma_f32_16x16x32_bf16 v[180:183], v[44:47], v[112:115], v[180:183]
ds_read_b128 v[40:43], v248 offset:16640
v_rcp_f16_sdwa v242, v241 dst_sel:WORD_1 dst_unused:UNUSED_PRESERVE src0_sel:WORD_1
v_mfma_f32_16x16x32_bf16 v[188:191], v[44:47], v[116:119], v[188:191]
v_rcp_f16_sdwa v207, v206 dst_sel:WORD_1 dst_unused:UNUSED_PRESERVE src0_sel:WORD_1
v_or_b32 v232, v192, v193
v_or_b32 v233, v194, v195
s_waitcnt lgkmcnt(4)
v_or_b32 v234, v196, v197
v_rcp_f16_sdwa v204, v203 dst_sel:WORD_1 dst_unused:UNUSED_PRESERVE src0_sel:WORD_1
v_or_b32 v235, v198, v199
s_waitcnt lgkmcnt(2)
v_or_b32 v236, v200, v201
v_pk_mul_f16 v237, v243, v242
v_pk_mul_f16 v238, v240, v207
v_pk_mul_f16 v239, v205, v204
v_mfma_f32_16x16x32_f16 v[48:51], v[224:227], v[232:235], v[48:51]
s_add_u32 s46, s80, 12582912
buffer_load_dwordx4 v[96:99], v253, s[32:35], s46 offen nt
ds_read_b128 v[44:47], v249 offset:44288
v_cvt_pkrtz_f16_f32 v193, v176, v177
v_cvt_pkrtz_f16_f32 v195, v178, v179
v_mfma_f32_16x16x32_f16 v[56:59], v[224:227], v[236:239], v[56:59]
v_cvt_pkrtz_f16_f32 v197, v180, v181
v_cvt_pkrtz_f16_f32 v199, v182, v183
v_mfma_f32_16x16x32_f16 v[52:55], v[228:231], v[232:235], v[52:55]
ds_read_b128 v[224:227], v248 offset:17408
v_cvt_pkrtz_f16_f32 v201, v184, v185
v_cvt_pk_f16_f32 v243, v186, v187
v_mfma_f32_16x16x32_f16 v[60:63], v[228:231], v[236:239], v[60:63]
v_cvt_pk_f16_f32 v240, v188, v189
v_cvt_pk_f16_f32 v205, v190, v191
v_mfma_f32_16x16x32_bf16 v[176:179], v[0:3], v[88:91], 0
ds_read_b128 v[228:231], v249 offset:45056
v_pk_fma_f16 v242, v243, v243, s48
v_and_b32 v193, s49, v193
v_mfma_f32_16x16x32_bf16 v[184:187], v[0:3], v[92:95], 0
v_pk_fma_f16 v207, v240, v240, s48
v_and_b32 v195, s49, v195
s_waitcnt lgkmcnt(3)
v_mfma_f32_16x16x32_f16 v[64:67], v[4:7], v[232:235], v[64:67]
ds_read_b128 v[0:3], v249 offset:45312
v_pk_fma_f16 v204, v205, v205, s48
s_setprio 2
v_lshrrev_b16 v192, 2, v193
v_pk_mul_f16 v242, v243, v242
v_mfma_f32_16x16x32_f16 v[72:75], v[4:7], v[236:239], v[72:75]
v_lshrrev_b16 v194, 2, v195
v_pk_mul_f16 v207, v240, v207
s_waitcnt vmcnt(10)
v_mfma_f32_16x16x32_bf16 v[80:83], v[26:29], v[8:11], v[80:83]
ds_read_b128 v[4:7], v248 offset:17664
ds_read_u16_d16 v192, v192
ds_read_u16_d16 v194, v194
v_lshrrev_b32 v193, 18, v193
v_pk_mul_f16 v204, v205, v204
v_mfma_f32_16x16x32_bf16 v[84:87], v[24:27], v[8:11], v[84:87]
v_lshrrev_b32 v195, 18, v195
v_mfma_f32_16x16x32_bf16 v[180:183], v[40:43], v[88:91], 0
ds_read_u16_d16_hi v193, v193
ds_read_u16_d16_hi v195, v195
v_exp_f16 v241, v242
v_and_b32 v197, s49, v197
v_mfma_f32_16x16x32_bf16 v[188:191], v[40:43], v[92:95], 0
v_and_b32 v199, s49, v199
s_waitcnt lgkmcnt(6)
v_mfma_f32_16x16x32_f16 v[68:71], v[44:47], v[232:235], v[68:71]
ds_read_b128 v[40:43], v248 offset:18432
v_exp_f16 v206, v207
v_lshrrev_b16 v196, 2, v197
v_mfma_f32_16x16x32_f16 v[76:79], v[44:47], v[236:239], v[76:79]
v_lshrrev_b16 v198, 2, v199
v_exp_f16 v203, v204
v_mfma_f32_16x16x32_bf16 v[176:179], v[224:227], v[208:211], v[176:179]
ds_read_b128 v[44:47], v248 offset:18688
ds_read_u16_d16 v196, v196
ds_read_u16_d16 v198, v198
v_lshrrev_b32 v197, 18, v197
v_lshrrev_b32 v199, 18, v199
v_mfma_f32_16x16x32_bf16 v[184:187], v[224:227], v[212:215], v[184:187]
v_exp_f16_sdwa v241, v242 dst_sel:WORD_1 dst_unused:UNUSED_PRESERVE src0_sel:WORD_1
v_mfma_f32_16x16x32_f16 v[80:83], v[228:231], v[232:235], v[80:83]
ds_read_b128 v[224:227], v249 offset:49152
ds_read_u16_d16_hi v197, v197
ds_read_u16_d16_hi v199, v199
v_and_b32 v201, s49, v201
v_lshrrev_b16 v200, 2, v201
v_mfma_f32_16x16x32_f16 v[168:171], v[228:231], v[236:239], v[168:171]
v_exp_f16_sdwa v206, v207 dst_sel:WORD_1 dst_unused:UNUSED_PRESERVE src0_sel:WORD_1
s_waitcnt lgkmcnt(7)
v_mfma_f32_16x16x32_f16 v[84:87], v[0:3], v[232:235], v[84:87]
ds_read_b128 v[228:231], v249 offset:49408
ds_read_u16_d16 v200, v200
v_lshrrev_b32 v201, 18, v201
v_mfma_f32_16x16x32_f16 v[172:175], v[0:3], v[236:239], v[172:175]
v_exp_f16_sdwa v203, v204 dst_sel:WORD_1 dst_unused:UNUSED_PRESERVE src0_sel:WORD_1
v_pk_add_f16 v241, v241, 1.0 op_sel_hi:[1,0]
v_pk_add_f16 v206, v206, 1.0 op_sel_hi:[1,0]
v_mfma_f32_16x16x32_bf16 v[180:183], v[4:7], v[208:211], v[180:183]
ds_read_b128 v[0:3], v248 offset:22528
ds_read_u16_d16_hi v201, v201
v_pk_add_f16 v203, v203, 1.0 op_sel_hi:[1,0]
v_mfma_f32_16x16x32_bf16 v[188:191], v[4:7], v[212:215], v[188:191]
v_rcp_f16 v242, v241
s_waitcnt lgkmcnt(7)
v_mfma_f32_16x16x32_bf16 v[176:179], v[40:43], v[32:35], v[176:179]
ds_read_b128 v[4:7], v249 offset:50176
v_rcp_f16 v207, v206
v_mfma_f32_16x16x32_bf16 v[184:187], v[40:43], v[36:39], v[184:187]
v_rcp_f16 v204, v203
v_mfma_f32_16x16x32_bf16 v[180:183], v[44:47], v[32:35], v[180:183]
ds_read_b128 v[40:43], v248 offset:22784
v_rcp_f16_sdwa v242, v241 dst_sel:WORD_1 dst_unused:UNUSED_PRESERVE src0_sel:WORD_1
v_mfma_f32_16x16x32_bf16 v[188:191], v[44:47], v[36:39], v[188:191]
v_rcp_f16_sdwa v207, v206 dst_sel:WORD_1 dst_unused:UNUSED_PRESERVE src0_sel:WORD_1
v_or_b32 v232, v192, v193
v_or_b32 v233, v194, v195
s_waitcnt lgkmcnt(4)
v_or_b32 v234, v196, v197
v_rcp_f16_sdwa v204, v203 dst_sel:WORD_1 dst_unused:UNUSED_PRESERVE src0_sel:WORD_1
v_or_b32 v235, v198, v199
s_waitcnt lgkmcnt(2)
v_or_b32 v236, v200, v201
v_pk_mul_f16 v237, v243, v242
v_pk_mul_f16 v238, v240, v207
v_pk_mul_f16 v239, v205, v204
v_mfma_f32_16x16x32_f16 v[48:51], v[224:227], v[232:235], v[48:51]
s_add_u32 s46, s80, 12582912
buffer_load_dwordx4 v[100:103], v253, s[32:35], s46 offen offset:256 nt
ds_read_b128 v[44:47], v249 offset:50432
v_cvt_pkrtz_f16_f32 v193, v176, v177
v_cvt_pkrtz_f16_f32 v195, v178, v179
v_mfma_f32_16x16x32_f16 v[56:59], v[224:227], v[236:239], v[56:59]
v_cvt_pkrtz_f16_f32 v197, v180, v181
v_cvt_pkrtz_f16_f32 v199, v182, v183
v_mfma_f32_16x16x32_f16 v[52:55], v[228:231], v[232:235], v[52:55]
ds_read_b128 v[224:227], v248 offset:23552
v_cvt_pkrtz_f16_f32 v201, v184, v185
v_cvt_pk_f16_f32 v243, v186, v187
v_mfma_f32_16x16x32_f16 v[60:63], v[228:231], v[236:239], v[60:63]
v_cvt_pk_f16_f32 v240, v188, v189
v_cvt_pk_f16_f32 v205, v190, v191
s_setprio 1
v_mfma_f32_16x16x32_bf16 v[176:179], v[0:3], v[88:91], 0
ds_read_b128 v[228:231], v249 offset:51200
v_pk_fma_f16 v242, v243, v243, s48
v_and_b32 v193, s49, v193
v_mfma_f32_16x16x32_bf16 v[184:187], v[0:3], v[92:95], 0
v_pk_fma_f16 v207, v240, v240, s48
v_and_b32 v195, s49, v195
s_waitcnt lgkmcnt(3)
v_mfma_f32_16x16x32_f16 v[64:67], v[4:7], v[232:235], v[64:67]
ds_read_b128 v[0:3], v249 offset:51456
v_pk_fma_f16 v204, v205, v205, s48
v_lshrrev_b16 v192, 2, v193
v_pk_mul_f16 v242, v243, v242
v_mfma_f32_16x16x32_f16 v[72:75], v[4:7], v[236:239], v[72:75]
v_lshrrev_b16 v194, 2, v195
v_pk_mul_f16 v207, v240, v207
s_waitcnt vmcnt(9)
v_mfma_f32_16x16x32_bf16 v[56:59], v[26:29], v[12:15], v[56:59]
ds_read_b128 v[4:7], v248 offset:23808
ds_read_u16_d16 v192, v192
ds_read_u16_d16 v194, v194
v_lshrrev_b32 v193, 18, v193
v_pk_mul_f16 v204, v205, v204
v_mfma_f32_16x16x32_bf16 v[60:63], v[24:27], v[12:15], v[60:63]
v_lshrrev_b32 v195, 18, v195
v_mfma_f32_16x16x32_bf16 v[180:183], v[40:43], v[88:91], 0
ds_read_u16_d16_hi v193, v193
ds_read_u16_d16_hi v195, v195
v_exp_f16 v241, v242
v_and_b32 v197, s49, v197
v_mfma_f32_16x16x32_bf16 v[188:191], v[40:43], v[92:95], 0
v_and_b32 v199, s49, v199
s_waitcnt lgkmcnt(6)
v_mfma_f32_16x16x32_f16 v[68:71], v[44:47], v[232:235], v[68:71]
ds_read_b128 v[40:43], v248 offset:24576
v_exp_f16 v206, v207
v_lshrrev_b16 v196, 2, v197
v_mfma_f32_16x16x32_f16 v[76:79], v[44:47], v[236:239], v[76:79]
v_lshrrev_b16 v198, 2, v199
v_exp_f16 v203, v204
v_mfma_f32_16x16x32_bf16 v[176:179], v[224:227], v[208:211], v[176:179]
ds_read_b128 v[44:47], v248 offset:24832
ds_read_u16_d16 v196, v196
ds_read_u16_d16 v198, v198
v_lshrrev_b32 v197, 18, v197
v_lshrrev_b32 v199, 18, v199
v_mfma_f32_16x16x32_bf16 v[184:187], v[224:227], v[212:215], v[184:187]
v_exp_f16_sdwa v241, v242 dst_sel:WORD_1 dst_unused:UNUSED_PRESERVE src0_sel:WORD_1
v_mfma_f32_16x16x32_f16 v[80:83], v[228:231], v[232:235], v[80:83]
ds_read_b128 v[224:227], v249 offset:24576
ds_read_u16_d16_hi v197, v197
ds_read_u16_d16_hi v199, v199
v_and_b32 v201, s49, v201
v_lshrrev_b16 v200, 2, v201
v_mfma_f32_16x16x32_f16 v[168:171], v[228:231], v[236:239], v[168:171]
v_exp_f16_sdwa v206, v207 dst_sel:WORD_1 dst_unused:UNUSED_PRESERVE src0_sel:WORD_1
s_waitcnt lgkmcnt(7)
v_mfma_f32_16x16x32_f16 v[84:87], v[0:3], v[232:235], v[84:87]
ds_read_b128 v[228:231], v254 offset:7936
ds_read_u16_d16 v200, v200
v_lshrrev_b32 v201, 18, v201
v_mfma_f32_16x16x32_f16 v[172:175], v[0:3], v[236:239], v[172:175]
v_exp_f16_sdwa v203, v204 dst_sel:WORD_1 dst_unused:UNUSED_PRESERVE src0_sel:WORD_1
v_pk_add_f16 v241, v241, 1.0 op_sel_hi:[1,0]
v_pk_add_f16 v206, v206, 1.0 op_sel_hi:[1,0]
v_mfma_f32_16x16x32_bf16 v[180:183], v[4:7], v[208:211], v[180:183]
ds_read_b128 v[0:3], v249 offset:24832
ds_read_u16_d16_hi v201, v201
v_pk_add_f16 v203, v203, 1.0 op_sel_hi:[1,0]
v_mfma_f32_16x16x32_bf16 v[188:191], v[4:7], v[212:215], v[188:191]
v_rcp_f16 v242, v241
s_setprio 0
s_waitcnt lgkmcnt(7)
v_mfma_f32_16x16x32_bf16 v[176:179], v[40:43], v[32:35], v[176:179]
ds_read_b128 v[4:7], v254 offset:7952
v_rcp_f16 v207, v206
v_mfma_f32_16x16x32_bf16 v[184:187], v[40:43], v[36:39], v[184:187]
v_rcp_f16 v204, v203
v_mfma_f32_16x16x32_bf16 v[180:183], v[44:47], v[32:35], v[180:183]
ds_read_b128 v[40:43], v248 offset:28672
v_rcp_f16_sdwa v242, v241 dst_sel:WORD_1 dst_unused:UNUSED_PRESERVE src0_sel:WORD_1
v_mfma_f32_16x16x32_bf16 v[188:191], v[44:47], v[36:39], v[188:191]
v_rcp_f16_sdwa v207, v206 dst_sel:WORD_1 dst_unused:UNUSED_PRESERVE src0_sel:WORD_1
v_or_b32 v232, v192, v193
v_or_b32 v233, v194, v195
s_waitcnt lgkmcnt(4)
v_or_b32 v234, v196, v197
v_rcp_f16_sdwa v204, v203 dst_sel:WORD_1 dst_unused:UNUSED_PRESERVE src0_sel:WORD_1
v_or_b32 v235, v198, v199
s_waitcnt lgkmcnt(2)
v_or_b32 v236, v200, v201
v_pk_mul_f16 v237, v243, v242
v_pk_mul_f16 v238, v240, v207
v_pk_mul_f16 v239, v205, v204
s_setprio 3
v_mfma_f32_16x16x32_f16 v[120:123], v[224:227], v[232:235], v[228:231]
s_add_u32 s46, s80, 16777216
buffer_load_dwordx4 v[104:107], v253, s[32:35], s46 offen nt
ds_read_b128 v[44:47], v249 offset:25600
v_cvt_pkrtz_f16_f32 v193, v176, v177
v_cvt_pkrtz_f16_f32 v195, v178, v179
v_mfma_f32_16x16x32_f16 v[128:131], v[224:227], v[236:239], v[228:231]
v_cvt_pkrtz_f16_f32 v197, v180, v181
v_cvt_pkrtz_f16_f32 v199, v182, v183
s_waitcnt lgkmcnt(1)
v_mfma_f32_16x16x32_f16 v[124:127], v[0:3], v[232:235], v[4:7]
ds_read_b128 v[224:227], v254 offset:8064
ds_read_b128 v[228:231], v248 offset:28928
v_cvt_pkrtz_f16_f32 v201, v184, v185
v_cvt_pk_f16_f32 v243, v186, v187
v_mfma_f32_16x16x32_f16 v[132:135], v[0:3], v[236:239], v[4:7]
v_cvt_pk_f16_f32 v240, v188, v189
v_cvt_pk_f16_f32 v205, v190, v191
v_mfma_f32_16x16x32_bf16 v[176:179], v[40:43], v[88:91], 0
ds_read_b128 v[0:3], v249 offset:25856
ds_read_b128 v[4:7], v254 offset:8080
v_pk_fma_f16 v242, v243, v243, s48
v_and_b32 v193, s49, v193
v_mfma_f32_16x16x32_bf16 v[184:187], v[40:43], v[92:95], 0
v_pk_fma_f16 v207, v240, v240, s48
v_and_b32 v195, s49, v195
s_waitcnt lgkmcnt(3)
v_mfma_f32_16x16x32_f16 v[136:139], v[44:47], v[232:235], v[224:227]
ds_read_b128 v[40:43], v248 offset:29696
v_pk_fma_f16 v204, v205, v205, s48
v_lshrrev_b16 v192, 2, v193
v_pk_mul_f16 v242, v243, v242
v_mfma_f32_16x16x32_f16 v[144:147], v[44:47], v[236:239], v[224:227]
v_lshrrev_b16 v194, 2, v195
v_pk_mul_f16 v207, v240, v207
s_waitcnt vmcnt(7)
v_mfma_f32_16x16x32_bf16 v[72:75], v[26:29], v[216:219], v[72:75]
ds_read_b128 v[44:47], v249 offset:26624
ds_read_b128 v[224:227], v254 offset:16128
ds_read_u16_d16 v192, v192
ds_read_u16_d16 v194, v194
v_lshrrev_b32 v193, 18, v193
v_pk_mul_f16 v204, v205, v204
v_mfma_f32_16x16x32_bf16 v[76:79], v[24:27], v[216:219], v[76:79]
v_lshrrev_b32 v195, 18, v195
s_waitcnt lgkmcnt(5)
v_mfma_f32_16x16x32_bf16 v[180:183], v[228:231], v[88:91], 0
ds_read_u16_d16_hi v193, v193
ds_read_u16_d16_hi v195, v195
v_exp_f16 v241, v242
v_and_b32 v197, s49, v197
v_mfma_f32_16x16x32_bf16 v[188:191], v[228:231], v[92:95], 0
v_and_b32 v199, s49, v199
v_mfma_f32_16x16x32_f16 v[140:143], v[0:3], v[232:235], v[4:7]
ds_read_b128 v[228:231], v249 offset:26880
v_exp_f16 v206, v207
v_lshrrev_b16 v196, 2, v197
v_mfma_f32_16x16x32_f16 v[148:151], v[0:3], v[236:239], v[4:7]
v_lshrrev_b16 v198, 2, v199
v_exp_f16 v203, v204
s_waitcnt lgkmcnt(7)
v_mfma_f32_16x16x32_bf16 v[176:179], v[40:43], v[208:211], v[176:179]
ds_read_b128 v[0:3], v254 offset:16144
ds_read_b128 v[4:7], v248 offset:29952
ds_read_u16_d16 v196, v196
ds_read_u16_d16 v198, v198
v_lshrrev_b32 v197, 18, v197
v_lshrrev_b32 v199, 18, v199
v_mfma_f32_16x16x32_bf16 v[184:187], v[40:43], v[212:215], v[184:187]
v_exp_f16_sdwa v241, v242 dst_sel:WORD_1 dst_unused:UNUSED_PRESERVE src0_sel:WORD_1
s_waitcnt lgkmcnt(7)
v_mfma_f32_16x16x32_f16 v[152:155], v[44:47], v[232:235], v[224:227]
ds_read_b128 v[40:43], v248 offset:30720
ds_read_u16_d16_hi v197, v197
ds_read_u16_d16_hi v199, v199
v_and_b32 v201, s49, v201
v_lshrrev_b16 v200, 2, v201
v_mfma_f32_16x16x32_f16 v[160:163], v[44:47], v[236:239], v[224:227]
v_exp_f16_sdwa v206, v207 dst_sel:WORD_1 dst_unused:UNUSED_PRESERVE src0_sel:WORD_1
s_waitcnt lgkmcnt(6)
v_mfma_f32_16x16x32_f16 v[156:159], v[228:231], v[232:235], v[0:3]
ds_read_b128 v[44:47], v248 offset:30976
ds_read_b128 v[224:227], v249 offset:30720
ds_read_u16_d16 v200, v200
v_lshrrev_b32 v201, 18, v201
v_mfma_f32_16x16x32_f16 v[164:167], v[228:231], v[236:239], v[0:3]
v_exp_f16_sdwa v203, v204 dst_sel:WORD_1 dst_unused:UNUSED_PRESERVE src0_sel:WORD_1
v_pk_add_f16 v241, v241, 1.0 op_sel_hi:[1,0]
v_pk_add_f16 v206, v206, 1.0 op_sel_hi:[1,0]
s_waitcnt lgkmcnt(7)
v_mfma_f32_16x16x32_bf16 v[180:183], v[4:7], v[208:211], v[180:183]
ds_read_b128 v[228:231], v249 offset:30976
ds_read_b128 v[0:3], v248 offset:40960
ds_read_u16_d16_hi v201, v201
v_pk_add_f16 v203, v203, 1.0 op_sel_hi:[1,0]
v_mfma_f32_16x16x32_bf16 v[188:191], v[4:7], v[212:215], v[188:191]
v_rcp_f16 v242, v241
s_waitcnt lgkmcnt(8)
v_mfma_f32_16x16x32_bf16 v[176:179], v[40:43], v[32:35], v[176:179]
ds_read_b128 v[4:7], v249 offset:31744
v_rcp_f16 v207, v206
v_mfma_f32_16x16x32_bf16 v[184:187], v[40:43], v[36:39], v[184:187]
v_rcp_f16 v204, v203
s_waitcnt lgkmcnt(6)
v_mfma_f32_16x16x32_bf16 v[180:183], v[44:47], v[32:35], v[180:183]
ds_read_b128 v[40:43], v248 offset:41216
v_rcp_f16_sdwa v242, v241 dst_sel:WORD_1 dst_unused:UNUSED_PRESERVE src0_sel:WORD_1
v_mfma_f32_16x16x32_bf16 v[188:191], v[44:47], v[36:39], v[188:191]
v_rcp_f16_sdwa v207, v206 dst_sel:WORD_1 dst_unused:UNUSED_PRESERVE src0_sel:WORD_1
v_or_b32 v232, v192, v193
v_or_b32 v233, v194, v195
v_or_b32 v234, v196, v197
v_rcp_f16_sdwa v204, v203 dst_sel:WORD_1 dst_unused:UNUSED_PRESERVE src0_sel:WORD_1
v_or_b32 v235, v198, v199
s_waitcnt lgkmcnt(2)
v_or_b32 v236, v200, v201
v_pk_mul_f16 v237, v243, v242
v_pk_mul_f16 v238, v240, v207
v_pk_mul_f16 v239, v205, v204
v_mfma_f32_16x16x32_f16 v[120:123], v[224:227], v[232:235], v[120:123]
s_add_u32 s46, s80, 16777216
buffer_load_dwordx4 v[108:111], v253, s[32:35], s46 offen offset:256 nt
ds_read_b128 v[44:47], v249 offset:32000
v_cvt_pkrtz_f16_f32 v193, v176, v177
v_cvt_pkrtz_f16_f32 v195, v178, v179
v_mfma_f32_16x16x32_f16 v[128:131], v[224:227], v[236:239], v[128:131]
v_cvt_pkrtz_f16_f32 v197, v180, v181
v_cvt_pkrtz_f16_f32 v199, v182, v183
v_mfma_f32_16x16x32_f16 v[124:127], v[228:231], v[232:235], v[124:127]
ds_read_b128 v[224:227], v248 offset:41984
v_cvt_pkrtz_f16_f32 v201, v184, v185
v_cvt_pk_f16_f32 v243, v186, v187
v_mfma_f32_16x16x32_f16 v[132:135], v[228:231], v[236:239], v[132:135]
v_cvt_pk_f16_f32 v240, v188, v189
v_cvt_pk_f16_f32 v205, v190, v191
v_mfma_f32_16x16x32_bf16 v[176:179], v[0:3], v[88:91], 0
ds_read_b128 v[228:231], v249 offset:32768
v_pk_fma_f16 v242, v243, v243, s48
v_and_b32 v193, s49, v193
v_mfma_f32_16x16x32_bf16 v[184:187], v[0:3], v[92:95], 0
v_pk_fma_f16 v207, v240, v240, s48
v_and_b32 v195, s49, v195
s_waitcnt lgkmcnt(3)
v_mfma_f32_16x16x32_f16 v[136:139], v[4:7], v[232:235], v[136:139]
ds_read_b128 v[0:3], v249 offset:33024
v_pk_fma_f16 v204, v205, v205, s48
s_setprio 2
v_lshrrev_b16 v192, 2, v193
v_pk_mul_f16 v242, v243, v242
v_mfma_f32_16x16x32_f16 v[144:147], v[4:7], v[236:239], v[144:147]
v_lshrrev_b16 v194, 2, v195
v_pk_mul_f16 v207, v240, v207
s_waitcnt vmcnt(7)
v_mfma_f32_16x16x32_bf16 v[168:171], v[26:29], v[244:247], v[168:171]
ds_read_b128 v[4:7], v248 offset:42240
ds_read_u16_d16 v192, v192
ds_read_u16_d16 v194, v194
v_lshrrev_b32 v193, 18, v193
v_pk_mul_f16 v204, v205, v204
v_mfma_f32_16x16x32_bf16 v[172:175], v[24:27], v[244:247], v[172:175]
v_lshrrev_b32 v195, 18, v195
v_mfma_f32_16x16x32_bf16 v[180:183], v[40:43], v[88:91], 0
ds_read_u16_d16_hi v193, v193
ds_read_u16_d16_hi v195, v195
v_exp_f16 v241, v242
v_and_b32 v197, s49, v197
v_mfma_f32_16x16x32_bf16 v[188:191], v[40:43], v[92:95], 0
v_and_b32 v199, s49, v199
s_waitcnt lgkmcnt(6)
v_mfma_f32_16x16x32_f16 v[140:143], v[44:47], v[232:235], v[140:143]
ds_read_b128 v[40:43], v248 offset:43008
v_exp_f16 v206, v207
v_lshrrev_b16 v196, 2, v197
v_mfma_f32_16x16x32_f16 v[148:151], v[44:47], v[236:239], v[148:151]
v_lshrrev_b16 v198, 2, v199
v_exp_f16 v203, v204
v_mfma_f32_16x16x32_bf16 v[176:179], v[224:227], v[208:211], v[176:179]
ds_read_b128 v[44:47], v248 offset:43264
ds_read_u16_d16 v196, v196
ds_read_u16_d16 v198, v198
v_lshrrev_b32 v197, 18, v197
v_lshrrev_b32 v199, 18, v199
v_mfma_f32_16x16x32_bf16 v[184:187], v[224:227], v[212:215], v[184:187]
v_exp_f16_sdwa v241, v242 dst_sel:WORD_1 dst_unused:UNUSED_PRESERVE src0_sel:WORD_1
v_mfma_f32_16x16x32_f16 v[152:155], v[228:231], v[232:235], v[152:155]
ds_read_b128 v[224:227], v249 offset:36864
ds_read_u16_d16_hi v197, v197
ds_read_u16_d16_hi v199, v199
v_and_b32 v201, s49, v201
v_lshrrev_b16 v200, 2, v201
v_mfma_f32_16x16x32_f16 v[160:163], v[228:231], v[236:239], v[160:163]
v_exp_f16_sdwa v206, v207 dst_sel:WORD_1 dst_unused:UNUSED_PRESERVE src0_sel:WORD_1
s_waitcnt lgkmcnt(7)
v_mfma_f32_16x16x32_f16 v[156:159], v[0:3], v[232:235], v[156:159]
ds_read_b128 v[228:231], v249 offset:37120
ds_read_u16_d16 v200, v200
v_lshrrev_b32 v201, 18, v201
v_mfma_f32_16x16x32_f16 v[164:167], v[0:3], v[236:239], v[164:167]
v_exp_f16_sdwa v203, v204 dst_sel:WORD_1 dst_unused:UNUSED_PRESERVE src0_sel:WORD_1
v_pk_add_f16 v241, v241, 1.0 op_sel_hi:[1,0]
v_pk_add_f16 v206, v206, 1.0 op_sel_hi:[1,0]
v_mfma_f32_16x16x32_bf16 v[180:183], v[4:7], v[208:211], v[180:183]
ds_read_b128 v[0:3], v248 offset:34816
ds_read_u16_d16_hi v201, v201
v_pk_add_f16 v203, v203, 1.0 op_sel_hi:[1,0]
v_mfma_f32_16x16x32_bf16 v[188:191], v[4:7], v[212:215], v[188:191]
v_rcp_f16 v242, v241
s_waitcnt lgkmcnt(7)
v_mfma_f32_16x16x32_bf16 v[176:179], v[40:43], v[32:35], v[176:179]
ds_read_b128 v[4:7], v249 offset:37888
v_rcp_f16 v207, v206
v_mfma_f32_16x16x32_bf16 v[184:187], v[40:43], v[36:39], v[184:187]
v_rcp_f16 v204, v203
v_mfma_f32_16x16x32_bf16 v[180:183], v[44:47], v[32:35], v[180:183]
ds_read_b128 v[40:43], v248 offset:35072
v_rcp_f16_sdwa v242, v241 dst_sel:WORD_1 dst_unused:UNUSED_PRESERVE src0_sel:WORD_1
v_mfma_f32_16x16x32_bf16 v[188:191], v[44:47], v[36:39], v[188:191]
v_rcp_f16_sdwa v207, v206 dst_sel:WORD_1 dst_unused:UNUSED_PRESERVE src0_sel:WORD_1
v_or_b32 v232, v192, v193
v_or_b32 v233, v194, v195
s_waitcnt lgkmcnt(4)
v_or_b32 v234, v196, v197
v_rcp_f16_sdwa v204, v203 dst_sel:WORD_1 dst_unused:UNUSED_PRESERVE src0_sel:WORD_1
v_or_b32 v235, v198, v199
s_waitcnt lgkmcnt(2)
v_or_b32 v236, v200, v201
v_pk_mul_f16 v237, v243, v242
v_pk_mul_f16 v238, v240, v207
v_pk_mul_f16 v239, v205, v204
v_mfma_f32_16x16x32_f16 v[120:123], v[224:227], v[232:235], v[120:123]
s_add_u32 s46, s80, 20971520
buffer_load_dwordx4 v[112:115], v253, s[32:35], s46 offen nt
ds_read_b128 v[44:47], v249 offset:38144
v_cvt_pkrtz_f16_f32 v193, v176, v177
v_cvt_pkrtz_f16_f32 v195, v178, v179
v_cvt_pkrtz_f16_f32 v197, v180, v181
v_mfma_f32_16x16x32_f16 v[128:131], v[224:227], v[236:239], v[128:131]
v_cvt_pkrtz_f16_f32 v199, v182, v183
v_cvt_pkrtz_f16_f32 v201, v184, v185
v_cvt_pkrtz_f16_f32 v203, v186, v187
v_mfma_f32_16x16x32_f16 v[124:127], v[228:231], v[232:235], v[124:127]
ds_read_b128 v[224:227], v248 offset:35840
v_cvt_pk_f16_f32 v243, v188, v189
v_cvt_pk_f16_f32 v240, v190, v191
s_setprio 1
v_pk_fma_f16 v242, v243, v243, s48
v_mfma_f32_16x16x32_f16 v[132:135], v[228:231], v[236:239], v[132:135]
v_cvt_pk_bf16_f32 v64, v64, v65
v_and_b32 v193, s49, v193
v_cvt_pk_bf16_f32 v65, v66, v67
v_mfma_f32_16x16x32_bf16 v[176:179], v[0:3], v[88:91], 0
ds_read_b128 v[228:231], v249 offset:38912
v_and_b32 v195, s49, v195
v_cvt_pk_bf16_f32 v66, v68, v69
v_pk_fma_f16 v207, v240, v240, s48
v_mfma_f32_16x16x32_bf16 v[184:187], v[0:3], v[92:95], 0
v_lshrrev_b16 v192, 2, v193
v_cvt_pk_bf16_f32 v67, v70, v71
v_pk_mul_f16 v242, v243, v242
s_waitcnt lgkmcnt(2)
v_mfma_f32_16x16x32_f16 v[136:139], v[4:7], v[232:235], v[136:139]
ds_read_b128 v[0:3], v249 offset:39168
ds_read_u16_d16 v192, v192
v_cvt_pk_bf16_f32 v48, v48, v49
v_lshrrev_b16 v194, 2, v195
v_cvt_pk_bf16_f32 v49, v50, v51
v_mfma_f32_16x16x32_f16 v[144:147], v[4:7], v[236:239], v[144:147]
v_pk_mul_f16 v207, v240, v207
v_lshrrev_b32 v193, 18, v193
v_cvt_pk_bf16_f32 v50, v52, v53
v_mfma_f32_16x16x32_bf16 v[180:183], v[40:43], v[88:91], 0
ds_read_b128 v[4:7], v248 offset:36096
ds_read_u16_d16 v194, v194
ds_read_u16_d16_hi v193, v193
v_exp_f16 v241, v242
v_cvt_pk_bf16_f32 v51, v54, v55
v_mfma_f32_16x16x32_bf16 v[188:191], v[40:43], v[92:95], 0
v_lshrrev_b32 v195, 18, v195
v_cvt_pk_bf16_f32 v80, v80, v81
v_and_b32 v197, s49, v197
v_mfma_f32_16x16x32_f16 v[140:143], v[44:47], v[232:235], v[140:143]
ds_read_b128 v[40:43], v248 offset:36864
ds_read_u16_d16_hi v195, v195
v_cvt_pk_bf16_f32 v81, v82, v83
v_exp_f16 v206, v207
v_mfma_f32_16x16x32_f16 v[148:151], v[44:47], v[236:239], v[148:151]
v_cvt_pk_bf16_f32 v82, v84, v85
v_and_b32 v199, s49, v199
v_cvt_pk_bf16_f32 v83, v86, v87
s_mov_b64 vcc, s[74:75]
s_waitcnt lgkmcnt(5)
v_mfma_f32_16x16x32_bf16 v[176:179], v[224:227], v[208:211], v[176:179]
ds_read_b128 v[44:47], v248 offset:37120
v_lshrrev_b16 v196, 2, v197
v_cndmask_b32_e64 v68, v48, v80, s[74:75]
v_mfma_f32_16x16x32_bf16 v[184:187], v[224:227], v[212:215], v[184:187]
v_exp_f16_sdwa v241, v242 dst_sel:WORD_1 dst_unused:UNUSED_PRESERVE src0_sel:WORD_1
v_cndmask_b32_dpp v48, v64, v48, vcc quad_perm:[1,0,3,2] row_mask:0xf bank_mask:0xf
v_lshrrev_b16 v198, 2, v199
v_mfma_f32_16x16x32_f16 v[152:155], v[228:231], v[232:235], v[152:155]
ds_read_b128 v[224:227], v249 offset:49152
ds_read_u16_d16 v196, v196
ds_read_u16_d16 v198, v198
v_cndmask_b32_e64 v69, v49, v81, s[74:75]
v_lshrrev_b32 v197, 18, v197
v_cndmask_b32_dpp v49, v65, v49, vcc quad_perm:[1,0,3,2] row_mask:0xf bank_mask:0xf
v_mfma_f32_16x16x32_f16 v[160:163], v[228:231], v[236:239], v[160:163]
v_lshrrev_b32 v199, 18, v199
v_exp_f16_sdwa v206, v207 dst_sel:WORD_1 dst_unused:UNUSED_PRESERVE src0_sel:WORD_1
v_mfma_f32_16x16x32_f16 v[156:159], v[0:3], v[232:235], v[156:159]
ds_read_b128 v[228:231], v249 offset:49408
ds_read_u16_d16_hi v197, v197
ds_read_u16_d16_hi v199, v199
v_cndmask_b32_e64 v70, v50, v82, s[74:75]
v_cndmask_b32_dpp v50, v66, v50, vcc quad_perm:[1,0,3,2] row_mask:0xf bank_mask:0xf
v_and_b32 v201, s49, v201
v_mfma_f32_16x16x32_f16 v[164:167], v[0:3], v[236:239], v[164:167]
v_cndmask_b32_e64 v71, v51, v83, s[74:75]
v_and_b32 v203, s49, v203
v_pk_add_f16 v241, v241, 1.0 op_sel_hi:[1,0]
s_waitcnt lgkmcnt(6)
v_mfma_f32_16x16x32_bf16 v[180:183], v[4:7], v[208:211], v[180:183]
ds_read_b128 v[0:3], v248 offset:47104
v_cndmask_b32_dpp v51, v67, v51, vcc quad_perm:[1,0,3,2] row_mask:0xf bank_mask:0xf
s_not_b64 vcc, s[74:75]
v_lshrrev_b16 v200, 2, v201
s_setprio 0
v_cndmask_b32_dpp v80, v64, v80, vcc quad_perm:[1,0,3,2] row_mask:0xf bank_mask:0xf
v_mfma_f32_16x16x32_bf16 v[188:191], v[4:7], v[212:215], v[188:191]
v_pk_add_f16 v206, v206, 1.0 op_sel_hi:[1,0]
v_cndmask_b32_dpp v81, v65, v81, vcc quad_perm:[1,0,3,2] row_mask:0xf bank_mask:0xf
v_lshrrev_b16 v202, 2, v203
v_mfma_f32_16x16x32_bf16 v[176:179], v[40:43], v[32:35], v[176:179]
ds_read_b128 v[4:7], v249 offset:50176
ds_read_u16_d16 v200, v200
ds_read_u16_d16 v202, v202
v_rcp_f16 v242, v241
v_cndmask_b32_dpp v82, v66, v82, vcc quad_perm:[1,0,3,2] row_mask:0xf bank_mask:0xf
v_mfma_f32_16x16x32_bf16 v[184:187], v[40:43], v[36:39], v[184:187]
v_cndmask_b32_dpp v83, v67, v83, vcc quad_perm:[1,0,3,2] row_mask:0xf bank_mask:0xf
v_lshrrev_b32 v201, 18, v201
v_lshrrev_b32 v203, 18, v203
v_mfma_f32_16x16x32_bf16 v[180:183], v[44:47], v[32:35], v[180:183]
ds_read_b128 v[40:43], v248 offset:47360
buffer_store_dwordx4 v[48:51], v255, s[8:11], s70 offen sc1
ds_read_u16_d16_hi v201, v201
ds_read_u16_d16_hi v203, v203
v_rcp_f16 v207, v206
v_mfma_f32_16x16x32_bf16 v[188:191], v[44:47], v[36:39], v[188:191]
v_rcp_f16_sdwa v242, v241 dst_sel:WORD_1 dst_unused:UNUSED_PRESERVE src0_sel:WORD_1
v_or_b32 v232, v192, v193
v_or_b32 v233, v194, v195
s_waitcnt lgkmcnt(6)
v_or_b32 v234, v196, v197
v_rcp_f16_sdwa v207, v206 dst_sel:WORD_1 dst_unused:UNUSED_PRESERVE src0_sel:WORD_1
v_or_b32 v235, v198, v199
s_waitcnt lgkmcnt(1)
v_or_b32 v236, v200, v201
s_waitcnt lgkmcnt(0)
v_or_b32 v237, v202, v203
v_pk_mul_f16 v238, v243, v242
v_pk_mul_f16 v239, v240, v207
s_setprio 3
v_mfma_f32_16x16x32_f16 v[120:123], v[224:227], v[232:235], v[120:123]
buffer_store_dwordx4 v[68:71], v255, s[8:11], s70 offen offset:128 sc1
ds_read_b128 v[44:47], v249 offset:50432
v_cvt_pkrtz_f16_f32 v193, v176, v177
v_cvt_pkrtz_f16_f32 v195, v178, v179
v_mfma_f32_16x16x32_f16 v[128:131], v[224:227], v[236:239], v[128:131]
v_cvt_pkrtz_f16_f32 v197, v180, v181
v_cvt_pkrtz_f16_f32 v199, v182, v183
v_mfma_f32_16x16x32_f16 v[124:127], v[228:231], v[232:235], v[124:127]
ds_read_b128 v[224:227], v248 offset:48128
v_cvt_pkrtz_f16_f32 v201, v184, v185
v_cvt_pk_f16_f32 v243, v186, v187
v_cvt_pk_f16_f32 v240, v188, v189
v_mfma_f32_16x16x32_f16 v[132:135], v[228:231], v[236:239], v[132:135]
v_cvt_pk_f16_f32 v205, v190, v191
v_pk_fma_f16 v242, v243, v243, s48
v_mfma_f32_16x16x32_bf16 v[176:179], v[0:3], v[88:91], 0
ds_read_b128 v[228:231], v249 offset:51200
v_and_b32 v193, s49, v193
v_pk_fma_f16 v207, v240, v240, s48
v_mfma_f32_16x16x32_bf16 v[184:187], v[0:3], v[92:95], 0
v_and_b32 v195, s49, v195
v_pk_fma_f16 v204, v205, v205, s48
v_lshrrev_b16 v192, 2, v193
v_mfma_f32_16x16x32_f16 v[136:139], v[4:7], v[232:235], v[136:139]
ds_read_b128 v[0:3], v249 offset:51456
ds_read_u16_d16 v192, v192
v_pk_mul_f16 v242, v243, v242
v_lshrrev_b16 v194, 2, v195
v_mfma_f32_16x16x32_f16 v[144:147], v[4:7], v[236:239], v[144:147]
v_pk_mul_f16 v207, v240, v207
v_lshrrev_b32 v193, 18, v193
v_mfma_f32_16x16x32_bf16 v[180:183], v[40:43], v[88:91], 0
ds_read_b128 v[4:7], v248 offset:48384
ds_read_u16_d16 v194, v194
ds_read_u16_d16_hi v193, v193
v_pk_mul_f16 v204, v205, v204
v_lshrrev_b32 v195, 18, v195
v_mfma_f32_16x16x32_bf16 v[188:191], v[40:43], v[92:95], 0
v_exp_f16 v241, v242
v_and_b32 v197, s49, v197
s_waitcnt lgkmcnt(6)
v_mfma_f32_16x16x32_f16 v[140:143], v[44:47], v[232:235], v[140:143]
ds_read_b128 v[40:43], v248 offset:49152
ds_read_u16_d16_hi v195, v195
v_and_b32 v199, s49, v199
v_mfma_f32_16x16x32_f16 v[148:151], v[44:47], v[236:239], v[148:151]
v_exp_f16 v206, v207
v_lshrrev_b16 v196, 2, v197
v_lshrrev_b16 v198, 2, v199
v_mfma_f32_16x16x32_bf16 v[176:179], v[224:227], v[208:211], v[176:179]
s_add_u32 s46, s80, 20971520
buffer_load_dwordx4 v[116:119], v253, s[32:35], s46 offen offset:256 nt
ds_read_b128 v[44:47], v248 offset:49408
ds_read_u16_d16 v196, v196
ds_read_u16_d16 v198, v198
v_exp_f16 v203, v204
v_mfma_f32_16x16x32_bf16 v[184:187], v[224:227], v[212:215], v[184:187]
v_lshrrev_b32 v197, 18, v197
v_lshrrev_b32 v199, 18, v199
s_waitcnt lgkmcnt(5)
v_mfma_f32_16x16x32_f16 v[152:155], v[228:231], v[232:235], v[152:155]
ds_read_b128 v[224:227], v249 offset:43008
ds_read_u16_d16_hi v197, v197
ds_read_u16_d16_hi v199, v199
v_exp_f16_sdwa v241, v242 dst_sel:WORD_1 dst_unused:UNUSED_PRESERVE src0_sel:WORD_1
v_and_b32 v201, s49, v201
v_mfma_f32_16x16x32_f16 v[160:163], v[228:231], v[236:239], v[160:163]
v_lshrrev_b16 v200, 2, v201
v_mfma_f32_16x16x32_f16 v[156:159], v[0:3], v[232:235], v[156:159]
ds_read_b128 v[228:231], v249 offset:43264
ds_read_u16_d16 v200, v200
v_exp_f16_sdwa v206, v207 dst_sel:WORD_1 dst_unused:UNUSED_PRESERVE src0_sel:WORD_1
v_lshrrev_b32 v201, 18, v201
v_mfma_f32_16x16x32_f16 v[164:167], v[0:3], v[236:239], v[164:167]
v_exp_f16_sdwa v203, v204 dst_sel:WORD_1 dst_unused:UNUSED_PRESERVE src0_sel:WORD_1
v_pk_add_f16 v241, v241, 1.0 op_sel_hi:[1,0]
v_mfma_f32_16x16x32_bf16 v[180:183], v[4:7], v[208:211], v[180:183]
ds_read_b128 v[0:3], v248 offset:53248
ds_read_u16_d16_hi v201, v201
v_pk_add_f16 v206, v206, 1.0 op_sel_hi:[1,0]
v_pk_add_f16 v203, v203, 1.0 op_sel_hi:[1,0]
v_mfma_f32_16x16x32_bf16 v[188:191], v[4:7], v[212:215], v[188:191]
v_rcp_f16 v242, v241
s_waitcnt lgkmcnt(7)
v_mfma_f32_16x16x32_bf16 v[176:179], v[40:43], v[32:35], v[176:179]
ds_read_b128 v[4:7], v249 offset:44032
v_rcp_f16 v207, v206
v_mfma_f32_16x16x32_bf16 v[184:187], v[40:43], v[36:39], v[184:187]
v_rcp_f16 v204, v203
v_mfma_f32_16x16x32_bf16 v[180:183], v[44:47], v[32:35], v[180:183]
ds_read_b128 v[40:43], v248 offset:53504
v_rcp_f16_sdwa v242, v241 dst_sel:WORD_1 dst_unused:UNUSED_PRESERVE src0_sel:WORD_1
v_mfma_f32_16x16x32_bf16 v[188:191], v[44:47], v[36:39], v[188:191]
v_rcp_f16_sdwa v207, v206 dst_sel:WORD_1 dst_unused:UNUSED_PRESERVE src0_sel:WORD_1
v_or_b32 v232, v192, v193
v_or_b32 v233, v194, v195
s_waitcnt lgkmcnt(4)
v_or_b32 v234, v196, v197
v_rcp_f16_sdwa v204, v203 dst_sel:WORD_1 dst_unused:UNUSED_PRESERVE src0_sel:WORD_1
v_or_b32 v235, v198, v199
s_waitcnt lgkmcnt(2)
v_or_b32 v236, v200, v201
v_pk_mul_f16 v237, v243, v242
v_pk_mul_f16 v238, v240, v207
v_pk_mul_f16 v239, v205, v204
v_mfma_f32_16x16x32_f16 v[120:123], v[224:227], v[232:235], v[120:123]
ds_read_b128 v[44:47], v249 offset:44288
v_cvt_pkrtz_f16_f32 v193, v176, v177
v_cvt_pkrtz_f16_f32 v195, v178, v179
v_mfma_f32_16x16x32_f16 v[128:131], v[224:227], v[236:239], v[128:131]
v_cvt_pkrtz_f16_f32 v197, v180, v181
v_cvt_pkrtz_f16_f32 v199, v182, v183
v_mfma_f32_16x16x32_f16 v[124:127], v[228:231], v[232:235], v[124:127]
ds_read_b128 v[224:227], v248 offset:54272
v_cvt_pkrtz_f16_f32 v201, v184, v185
v_cvt_pk_f16_f32 v243, v186, v187
v_cvt_pk_f16_f32 v240, v188, v189
v_mfma_f32_16x16x32_f16 v[132:135], v[228:231], v[236:239], v[132:135]
v_cvt_pk_f16_f32 v205, v190, v191
v_pk_fma_f16 v242, v243, v243, s48
v_mfma_f32_16x16x32_bf16 v[176:179], v[0:3], v[88:91], 0
ds_read_b128 v[228:231], v249 offset:45056
v_and_b32 v193, s49, v193
v_pk_fma_f16 v207, v240, v240, s48
v_mfma_f32_16x16x32_bf16 v[184:187], v[0:3], v[92:95], 0
v_and_b32 v195, s49, v195
v_pk_fma_f16 v204, v205, v205, s48
s_setprio 2
v_lshrrev_b16 v192, 2, v193
s_waitcnt lgkmcnt(3)
v_mfma_f32_16x16x32_f16 v[136:139], v[4:7], v[232:235], v[136:139]
ds_read_b128 v[0:3], v249 offset:45312
ds_read_u16_d16 v192, v192
v_pk_mul_f16 v242, v243, v242
v_lshrrev_b16 v194, 2, v195
v_mfma_f32_16x16x32_f16 v[144:147], v[4:7], v[236:239], v[144:147]
v_pk_mul_f16 v207, v240, v207
v_lshrrev_b32 v193, 18, v193
v_mfma_f32_16x16x32_bf16 v[180:183], v[40:43], v[88:91], 0
ds_read_b128 v[4:7], v248 offset:54528
ds_read_u16_d16 v194, v194
ds_read_u16_d16_hi v193, v193
v_pk_mul_f16 v204, v205, v204
v_lshrrev_b32 v195, 18, v195
v_mfma_f32_16x16x32_bf16 v[188:191], v[40:43], v[92:95], 0
v_exp_f16 v241, v242
v_and_b32 v197, s49, v197
s_waitcnt lgkmcnt(5)
v_mfma_f32_16x16x32_f16 v[140:143], v[44:47], v[232:235], v[140:143]
ds_read_b128 v[40:43], v248 offset:55296
ds_read_u16_d16_hi v195, v195
v_and_b32 v199, s49, v199
v_mfma_f32_16x16x32_f16 v[148:151], v[44:47], v[236:239], v[148:151]
v_exp_f16 v206, v207
v_lshrrev_b16 v196, 2, v197
v_lshrrev_b16 v198, 2, v199
v_mfma_f32_16x16x32_bf16 v[176:179], v[224:227], v[208:211], v[176:179]
ds_read_b128 v[44:47], v248 offset:55552
ds_read_u16_d16 v196, v196
ds_read_u16_d16 v198, v198
v_exp_f16 v203, v204
v_mfma_f32_16x16x32_bf16 v[184:187], v[224:227], v[212:215], v[184:187]
v_lshrrev_b32 v197, 18, v197
v_lshrrev_b32 v199, 18, v199
v_mfma_f32_16x16x32_f16 v[152:155], v[228:231], v[232:235], v[152:155]
ds_read_b128 v[224:227], v249 offset:55296
ds_read_u16_d16_hi v197, v197
ds_read_u16_d16_hi v199, v199
v_exp_f16_sdwa v241, v242 dst_sel:WORD_1 dst_unused:UNUSED_PRESERVE src0_sel:WORD_1
v_and_b32 v201, s49, v201
v_mfma_f32_16x16x32_f16 v[160:163], v[228:231], v[236:239], v[160:163]
v_lshrrev_b16 v200, 2, v201
s_waitcnt lgkmcnt(8)
v_mfma_f32_16x16x32_f16 v[156:159], v[0:3], v[232:235], v[156:159]
ds_read_b128 v[228:231], v249 offset:55552
ds_read_u16_d16 v200, v200
v_exp_f16_sdwa v206, v207 dst_sel:WORD_1 dst_unused:UNUSED_PRESERVE src0_sel:WORD_1
v_lshrrev_b32 v201, 18, v201
v_mfma_f32_16x16x32_f16 v[164:167], v[0:3], v[236:239], v[164:167]
v_exp_f16_sdwa v203, v204 dst_sel:WORD_1 dst_unused:UNUSED_PRESERVE src0_sel:WORD_1
v_pk_add_f16 v241, v241, 1.0 op_sel_hi:[1,0]
v_mfma_f32_16x16x32_bf16 v[180:183], v[4:7], v[208:211], v[180:183]
ds_read_b128 v[0:3], v248 offset:59392
ds_read_u16_d16_hi v201, v201
v_pk_add_f16 v206, v206, 1.0 op_sel_hi:[1,0]
v_pk_add_f16 v203, v203, 1.0 op_sel_hi:[1,0]
v_mfma_f32_16x16x32_bf16 v[188:191], v[4:7], v[212:215], v[188:191]
v_rcp_f16 v242, v241
s_waitcnt lgkmcnt(7)
v_mfma_f32_16x16x32_bf16 v[176:179], v[40:43], v[32:35], v[176:179]
ds_read_b128 v[4:7], v249 offset:56320
v_rcp_f16 v207, v206
v_mfma_f32_16x16x32_bf16 v[184:187], v[40:43], v[36:39], v[184:187]
v_rcp_f16 v204, v203
v_mfma_f32_16x16x32_bf16 v[180:183], v[44:47], v[32:35], v[180:183]
ds_read_b128 v[40:43], v248 offset:59648
v_rcp_f16_sdwa v242, v241 dst_sel:WORD_1 dst_unused:UNUSED_PRESERVE src0_sel:WORD_1
v_mfma_f32_16x16x32_bf16 v[188:191], v[44:47], v[36:39], v[188:191]
v_rcp_f16_sdwa v207, v206 dst_sel:WORD_1 dst_unused:UNUSED_PRESERVE src0_sel:WORD_1
v_or_b32 v232, v192, v193
v_or_b32 v233, v194, v195
s_waitcnt lgkmcnt(4)
v_or_b32 v234, v196, v197
v_rcp_f16_sdwa v204, v203 dst_sel:WORD_1 dst_unused:UNUSED_PRESERVE src0_sel:WORD_1
v_or_b32 v235, v198, v199
s_waitcnt lgkmcnt(2)
v_or_b32 v236, v200, v201
v_pk_mul_f16 v237, v243, v242
v_pk_mul_f16 v238, v240, v207
v_pk_mul_f16 v239, v205, v204
v_mfma_f32_16x16x32_f16 v[120:123], v[224:227], v[232:235], v[120:123]
buffer_load_dwordx4 v[244:247], v252, s[4:7], s68 offen
ds_read_b128 v[44:47], v249 offset:56576
v_cvt_pkrtz_f16_f32 v193, v176, v177
v_cvt_pkrtz_f16_f32 v195, v178, v179
v_mfma_f32_16x16x32_f16 v[128:131], v[224:227], v[236:239], v[128:131]
v_cvt_pkrtz_f16_f32 v197, v180, v181
v_cvt_pkrtz_f16_f32 v199, v182, v183
v_mfma_f32_16x16x32_f16 v[124:127], v[228:231], v[232:235], v[124:127]
ds_read_b128 v[224:227], v248 offset:60416
v_cvt_pkrtz_f16_f32 v201, v184, v185
v_cvt_pk_f16_f32 v243, v186, v187
v_cvt_pk_f16_f32 v240, v188, v189
v_mfma_f32_16x16x32_f16 v[132:135], v[228:231], v[236:239], v[132:135]
v_cvt_pk_f16_f32 v205, v190, v191
s_setprio 1
v_pk_fma_f16 v242, v243, v243, s48
v_mfma_f32_16x16x32_bf16 v[176:179], v[0:3], v[88:91], 0
ds_read_b128 v[228:231], v249 offset:57344
v_and_b32 v193, s49, v193
v_pk_fma_f16 v207, v240, v240, s48
v_mfma_f32_16x16x32_bf16 v[184:187], v[0:3], v[92:95], 0
v_and_b32 v195, s49, v195
v_pk_fma_f16 v204, v205, v205, s48
v_lshrrev_b16 v192, 2, v193
s_waitcnt lgkmcnt(3)
v_mfma_f32_16x16x32_f16 v[136:139], v[4:7], v[232:235], v[136:139]
ds_read_b128 v[0:3], v249 offset:57600
ds_read_u16_d16 v192, v192
v_pk_mul_f16 v242, v243, v242
v_lshrrev_b16 v194, 2, v195
v_mfma_f32_16x16x32_f16 v[144:147], v[4:7], v[236:239], v[144:147]
v_pk_mul_f16 v207, v240, v207
v_lshrrev_b32 v193, 18, v193
v_mfma_f32_16x16x32_bf16 v[180:183], v[40:43], v[88:91], 0
ds_read_b128 v[4:7], v248 offset:60672
ds_read_u16_d16 v194, v194
ds_read_u16_d16_hi v193, v193
v_pk_mul_f16 v204, v205, v204
v_lshrrev_b32 v195, 18, v195
v_mfma_f32_16x16x32_bf16 v[188:191], v[40:43], v[92:95], 0
v_exp_f16 v241, v242
v_and_b32 v197, s49, v197
s_waitcnt lgkmcnt(5)
v_mfma_f32_16x16x32_f16 v[140:143], v[44:47], v[232:235], v[140:143]
ds_read_b128 v[40:43], v248 offset:61440
ds_read_u16_d16_hi v195, v195
v_and_b32 v199, s49, v199
v_mfma_f32_16x16x32_f16 v[148:151], v[44:47], v[236:239], v[148:151]
v_exp_f16 v206, v207
v_lshrrev_b16 v196, 2, v197
v_lshrrev_b16 v198, 2, v199
v_mfma_f32_16x16x32_bf16 v[176:179], v[224:227], v[208:211], v[176:179]
buffer_store_dwordx4 v[80:83], v255, s[8:11], s70 offen offset:256 sc1
ds_read_b128 v[44:47], v248 offset:61696
ds_read_u16_d16 v196, v196
ds_read_u16_d16 v198, v198
v_exp_f16 v203, v204
v_mfma_f32_16x16x32_bf16 v[184:187], v[224:227], v[212:215], v[184:187]
v_lshrrev_b32 v197, 18, v197
v_lshrrev_b32 v199, 18, v199
v_mfma_f32_16x16x32_f16 v[152:155], v[228:231], v[232:235], v[152:155]
ds_read_b128 v[224:227], v249 offset:61440
ds_read_u16_d16_hi v197, v197
ds_read_u16_d16_hi v199, v199
v_exp_f16_sdwa v241, v242 dst_sel:WORD_1 dst_unused:UNUSED_PRESERVE src0_sel:WORD_1
v_and_b32 v201, s49, v201
v_mfma_f32_16x16x32_f16 v[160:163], v[228:231], v[236:239], v[160:163]
v_lshrrev_b16 v200, 2, v201
s_waitcnt lgkmcnt(8)
v_mfma_f32_16x16x32_f16 v[156:159], v[0:3], v[232:235], v[156:159]
ds_read_b128 v[228:231], v249 offset:61696
ds_read_u16_d16 v200, v200
v_exp_f16_sdwa v206, v207 dst_sel:WORD_1 dst_unused:UNUSED_PRESERVE src0_sel:WORD_1
v_lshrrev_b32 v201, 18, v201
v_mfma_f32_16x16x32_f16 v[164:167], v[0:3], v[236:239], v[164:167]
v_exp_f16_sdwa v203, v204 dst_sel:WORD_1 dst_unused:UNUSED_PRESERVE src0_sel:WORD_1
v_pk_add_f16 v241, v241, 1.0 op_sel_hi:[1,0]
v_mfma_f32_16x16x32_bf16 v[180:183], v[4:7], v[208:211], v[180:183]
ds_read_b128 v[0:3], v249
ds_read_u16_d16_hi v201, v201
v_pk_add_f16 v206, v206, 1.0 op_sel_hi:[1,0]
v_pk_add_f16 v203, v203, 1.0 op_sel_hi:[1,0]
v_mfma_f32_16x16x32_bf16 v[188:191], v[4:7], v[212:215], v[188:191]
v_rcp_f16 v242, v241
s_setprio 0
s_waitcnt lgkmcnt(7)
v_mfma_f32_16x16x32_bf16 v[176:179], v[40:43], v[32:35], v[176:179]
ds_read_b128 v[4:7], v249 offset:62464
v_rcp_f16 v207, v206
v_mfma_f32_16x16x32_bf16 v[184:187], v[40:43], v[36:39], v[184:187]
v_rcp_f16 v204, v203
v_mfma_f32_16x16x32_bf16 v[180:183], v[44:47], v[32:35], v[180:183]
ds_read_b128 v[40:43], v249 offset:256
v_rcp_f16_sdwa v242, v241 dst_sel:WORD_1 dst_unused:UNUSED_PRESERVE src0_sel:WORD_1
v_mfma_f32_16x16x32_bf16 v[188:191], v[44:47], v[36:39], v[188:191]
v_rcp_f16_sdwa v207, v206 dst_sel:WORD_1 dst_unused:UNUSED_PRESERVE src0_sel:WORD_1
v_or_b32 v232, v192, v193
v_or_b32 v233, v194, v195
s_waitcnt lgkmcnt(4)
v_or_b32 v234, v196, v197
v_rcp_f16_sdwa v204, v203 dst_sel:WORD_1 dst_unused:UNUSED_PRESERVE src0_sel:WORD_1
v_or_b32 v235, v198, v199
s_waitcnt lgkmcnt(2)
v_or_b32 v236, v200, v201
v_pk_mul_f16 v237, v243, v242
v_pk_mul_f16 v238, v240, v207
v_pk_mul_f16 v239, v205, v204
s_setprio 3
v_mfma_f32_16x16x32_f16 v[120:123], v[224:227], v[232:235], v[120:123]
buffer_load_dwordx4 v[216:219], v252, s[4:7], s68 offen offset:64
ds_read_b128 v[44:47], v249 offset:62720
v_cvt_pkrtz_f16_f32 v193, v176, v177
v_cvt_pkrtz_f16_f32 v195, v178, v179
v_mfma_f32_16x16x32_f16 v[128:131], v[224:227], v[236:239], v[128:131]
v_cvt_pkrtz_f16_f32 v197, v180, v181
v_cvt_pkrtz_f16_f32 v199, v182, v183
v_mfma_f32_16x16x32_f16 v[124:127], v[228:231], v[232:235], v[124:127]
ds_read_b128 v[224:227], v249 offset:1024
v_cvt_pkrtz_f16_f32 v201, v184, v185
v_cvt_pk_f16_f32 v243, v186, v187
v_cvt_pk_f16_f32 v240, v188, v189
v_mfma_f32_16x16x32_f16 v[132:135], v[228:231], v[236:239], v[132:135]
v_cvt_pk_f16_f32 v205, v190, v191
v_pk_fma_f16 v242, v243, v243, s48
v_mfma_f32_16x16x32_bf16 v[176:179], v[0:3], v[88:91], 0
ds_read_b128 v[228:231], v249 offset:63488
v_and_b32 v193, s49, v193
v_pk_fma_f16 v207, v240, v240, s48
v_mfma_f32_16x16x32_bf16 v[184:187], v[0:3], v[92:95], 0
v_and_b32 v195, s49, v195
v_pk_fma_f16 v204, v205, v205, s48
v_lshrrev_b16 v192, 2, v193
s_waitcnt lgkmcnt(3)
v_mfma_f32_16x16x32_f16 v[136:139], v[4:7], v[232:235], v[136:139]
ds_read_b128 v[0:3], v249 offset:63744
ds_read_u16_d16 v192, v192
v_pk_mul_f16 v242, v243, v242
v_lshrrev_b16 v194, 2, v195
v_mfma_f32_16x16x32_f16 v[144:147], v[4:7], v[236:239], v[144:147]
v_pk_mul_f16 v207, v240, v207
v_lshrrev_b32 v193, 18, v193
v_mfma_f32_16x16x32_bf16 v[180:183], v[40:43], v[88:91], 0
ds_read_b128 v[4:7], v249 offset:1280
ds_read_u16_d16 v194, v194
ds_read_u16_d16_hi v193, v193
v_pk_mul_f16 v204, v205, v204
v_lshrrev_b32 v195, 18, v195
v_mfma_f32_16x16x32_bf16 v[188:191], v[40:43], v[92:95], 0
v_exp_f16 v241, v242
v_and_b32 v197, s49, v197
s_waitcnt lgkmcnt(5)
v_mfma_f32_16x16x32_f16 v[140:143], v[44:47], v[232:235], v[140:143]
ds_read_b128 v[40:43], v249 offset:2048
ds_read_u16_d16_hi v195, v195
v_and_b32 v199, s49, v199
v_mfma_f32_16x16x32_f16 v[148:151], v[44:47], v[236:239], v[148:151]
v_exp_f16 v206, v207
v_lshrrev_b16 v196, 2, v197
v_lshrrev_b16 v198, 2, v199
v_mfma_f32_16x16x32_bf16 v[176:179], v[224:227], v[208:211], v[176:179]
ds_read_b128 v[44:47], v249 offset:2304
ds_read_u16_d16 v196, v196
ds_read_u16_d16 v198, v198
v_exp_f16 v203, v204
v_mfma_f32_16x16x32_bf16 v[184:187], v[224:227], v[212:215], v[184:187]
v_lshrrev_b32 v197, 18, v197
v_lshrrev_b32 v199, 18, v199
v_mfma_f32_16x16x32_f16 v[152:155], v[228:231], v[232:235], v[152:155]
ds_read_b128 v[224:227], v250 offset:2048
ds_read_u16_d16_hi v197, v197
ds_read_u16_d16_hi v199, v199
v_exp_f16_sdwa v241, v242 dst_sel:WORD_1 dst_unused:UNUSED_PRESERVE src0_sel:WORD_1
v_and_b32 v201, s49, v201
v_mfma_f32_16x16x32_f16 v[160:163], v[228:231], v[236:239], v[160:163]
v_lshrrev_b16 v200, 2, v201
s_waitcnt lgkmcnt(8)
v_mfma_f32_16x16x32_f16 v[156:159], v[0:3], v[232:235], v[156:159]
ds_read_b128 v[228:231], v250 offset:2304
ds_read_u16_d16 v200, v200
v_exp_f16_sdwa v206, v207 dst_sel:WORD_1 dst_unused:UNUSED_PRESERVE src0_sel:WORD_1
v_lshrrev_b32 v201, 18, v201
v_mfma_f32_16x16x32_f16 v[164:167], v[0:3], v[236:239], v[164:167]
v_exp_f16_sdwa v203, v204 dst_sel:WORD_1 dst_unused:UNUSED_PRESERVE src0_sel:WORD_1
v_pk_add_f16 v241, v241, 1.0 op_sel_hi:[1,0]
v_mfma_f32_16x16x32_bf16 v[180:183], v[4:7], v[208:211], v[180:183]
ds_read_b128 v[0:3], v249 offset:6144
ds_read_u16_d16_hi v201, v201
v_pk_add_f16 v206, v206, 1.0 op_sel_hi:[1,0]
v_pk_add_f16 v203, v203, 1.0 op_sel_hi:[1,0]
v_mfma_f32_16x16x32_bf16 v[188:191], v[4:7], v[212:215], v[188:191]
v_rcp_f16 v242, v241
s_waitcnt lgkmcnt(7)
v_mfma_f32_16x16x32_bf16 v[176:179], v[40:43], v[32:35], v[176:179]
ds_read_b128 v[4:7], v250 offset:3072
v_rcp_f16 v207, v206
v_mfma_f32_16x16x32_bf16 v[184:187], v[40:43], v[36:39], v[184:187]
v_rcp_f16 v204, v203
v_mfma_f32_16x16x32_bf16 v[180:183], v[44:47], v[32:35], v[180:183]
ds_read_b128 v[40:43], v249 offset:6400
v_rcp_f16_sdwa v242, v241 dst_sel:WORD_1 dst_unused:UNUSED_PRESERVE src0_sel:WORD_1
v_mfma_f32_16x16x32_bf16 v[188:191], v[44:47], v[36:39], v[188:191]
v_rcp_f16_sdwa v207, v206 dst_sel:WORD_1 dst_unused:UNUSED_PRESERVE src0_sel:WORD_1
v_or_b32 v232, v192, v193
v_or_b32 v233, v194, v195
s_waitcnt lgkmcnt(4)
v_or_b32 v234, v196, v197
v_rcp_f16_sdwa v204, v203 dst_sel:WORD_1 dst_unused:UNUSED_PRESERVE src0_sel:WORD_1
v_or_b32 v235, v198, v199
s_waitcnt lgkmcnt(2)
v_or_b32 v236, v200, v201
v_pk_mul_f16 v237, v243, v242
v_pk_mul_f16 v238, v240, v207
v_pk_mul_f16 v239, v205, v204
v_mfma_f32_16x16x32_f16 v[120:123], v[224:227], v[232:235], v[120:123]
ds_read_b128 v[44:47], v250 offset:3328
v_cvt_pkrtz_f16_f32 v193, v176, v177
v_cvt_pkrtz_f16_f32 v195, v178, v179
v_cvt_pkrtz_f16_f32 v197, v180, v181
v_mfma_f32_16x16x32_f16 v[128:131], v[224:227], v[236:239], v[128:131]
v_cvt_pkrtz_f16_f32 v199, v182, v183
v_cvt_pkrtz_f16_f32 v201, v184, v185
v_cvt_pkrtz_f16_f32 v203, v186, v187
v_mfma_f32_16x16x32_f16 v[124:127], v[228:231], v[232:235], v[124:127]
ds_read_b128 v[224:227], v249 offset:7168
v_cvt_pk_f16_f32 v243, v188, v189
v_cvt_pk_f16_f32 v240, v190, v191
v_pk_fma_f16 v242, v243, v243, s48
v_mfma_f32_16x16x32_f16 v[132:135], v[228:231], v[236:239], v[132:135]
v_cvt_pk_bf16_f32 v72, v72, v73
v_and_b32 v193, s49, v193
v_cvt_pk_bf16_f32 v73, v74, v75
v_mfma_f32_16x16x32_bf16 v[176:179], v[0:3], v[88:91], 0
ds_read_b128 v[228:231], v250 offset:4096
v_and_b32 v195, s49, v195
v_cvt_pk_bf16_f32 v74, v76, v77
v_pk_fma_f16 v207, v240, v240, s48
v_mfma_f32_16x16x32_bf16 v[184:187], v[0:3], v[92:95], 0
v_lshrrev_b16 v192, 2, v193
s_setprio 2
v_cvt_pk_bf16_f32 v75, v78, v79
v_pk_mul_f16 v242, v243, v242
s_waitcnt lgkmcnt(2)
v_mfma_f32_16x16x32_f16 v[136:139], v[4:7], v[232:235], v[136:139]
ds_read_b128 v[0:3], v250 offset:4352
ds_read_u16_d16 v192, v192
v_cvt_pk_bf16_f32 v56, v56, v57
v_lshrrev_b16 v194, 2, v195
v_cvt_pk_bf16_f32 v57, v58, v59
v_mfma_f32_16x16x32_f16 v[144:147], v[4:7], v[236:239], v[144:147]
v_pk_mul_f16 v207, v240, v207
v_lshrrev_b32 v193, 18, v193
v_cvt_pk_bf16_f32 v58, v60, v61
v_mfma_f32_16x16x32_bf16 v[180:183], v[40:43], v[88:91], 0
ds_read_b128 v[4:7], v249 offset:7424
ds_read_u16_d16 v194, v194
ds_read_u16_d16_hi v193, v193
v_exp_f16 v241, v242
v_cvt_pk_bf16_f32 v59, v62, v63
v_mfma_f32_16x16x32_bf16 v[188:191], v[40:43], v[92:95], 0
v_lshrrev_b32 v195, 18, v195
v_cvt_pk_bf16_f32 v168, v168, v169
v_and_b32 v197, s49, v197
v_mfma_f32_16x16x32_f16 v[140:143], v[44:47], v[232:235], v[140:143]
ds_read_b128 v[40:43], v249 offset:8192
ds_read_u16_d16_hi v195, v195
v_cvt_pk_bf16_f32 v169, v170, v171
v_exp_f16 v206, v207
v_mfma_f32_16x16x32_f16 v[148:151], v[44:47], v[236:239], v[148:151]
v_cvt_pk_bf16_f32 v170, v172, v173
v_and_b32 v199, s49, v199
v_cvt_pk_bf16_f32 v171, v174, v175
s_mov_b64 vcc, s[74:75]
s_waitcnt lgkmcnt(5)
v_mfma_f32_16x16x32_bf16 v[176:179], v[224:227], v[208:211], v[176:179]
ds_read_b128 v[44:47], v249 offset:8448
v_lshrrev_b16 v196, 2, v197
v_cndmask_b32_e64 v76, v56, v168, s[74:75]
v_mfma_f32_16x16x32_bf16 v[184:187], v[224:227], v[212:215], v[184:187]
v_exp_f16_sdwa v241, v242 dst_sel:WORD_1 dst_unused:UNUSED_PRESERVE src0_sel:WORD_1
v_cndmask_b32_dpp v56, v72, v56, vcc quad_perm:[1,0,3,2] row_mask:0xf bank_mask:0xf
v_lshrrev_b16 v198, 2, v199
v_mfma_f32_16x16x32_f16 v[152:155], v[228:231], v[232:235], v[152:155]
ds_read_b128 v[224:227], v250 offset:8192
ds_read_u16_d16 v196, v196
ds_read_u16_d16 v198, v198
v_cndmask_b32_e64 v77, v57, v169, s[74:75]
v_lshrrev_b32 v197, 18, v197
v_cndmask_b32_dpp v57, v73, v57, vcc quad_perm:[1,0,3,2] row_mask:0xf bank_mask:0xf
v_mfma_f32_16x16x32_f16 v[160:163], v[228:231], v[236:239], v[160:163]
v_lshrrev_b32 v199, 18, v199
v_exp_f16_sdwa v206, v207 dst_sel:WORD_1 dst_unused:UNUSED_PRESERVE src0_sel:WORD_1
v_mfma_f32_16x16x32_f16 v[156:159], v[0:3], v[232:235], v[156:159]
ds_read_b128 v[228:231], v250 offset:8448
ds_read_u16_d16_hi v197, v197
ds_read_u16_d16_hi v199, v199
v_cndmask_b32_e64 v78, v58, v170, s[74:75]
v_cndmask_b32_dpp v58, v74, v58, vcc quad_perm:[1,0,3,2] row_mask:0xf bank_mask:0xf
v_and_b32 v201, s49, v201
v_mfma_f32_16x16x32_f16 v[164:167], v[0:3], v[236:239], v[164:167]
v_cndmask_b32_e64 v79, v59, v171, s[74:75]
v_and_b32 v203, s49, v203
v_pk_add_f16 v241, v241, 1.0 op_sel_hi:[1,0]
s_waitcnt lgkmcnt(6)
v_mfma_f32_16x16x32_bf16 v[180:183], v[4:7], v[208:211], v[180:183]
ds_read_b128 v[0:3], v249 offset:12288
v_cndmask_b32_dpp v59, v75, v59, vcc quad_perm:[1,0,3,2] row_mask:0xf bank_mask:0xf
s_not_b64 vcc, s[74:75]
v_lshrrev_b16 v200, 2, v201
v_cndmask_b32_dpp v168, v72, v168, vcc quad_perm:[1,0,3,2] row_mask:0xf bank_mask:0xf
v_mfma_f32_16x16x32_bf16 v[188:191], v[4:7], v[212:215], v[188:191]
v_pk_add_f16 v206, v206, 1.0 op_sel_hi:[1,0]
v_cndmask_b32_dpp v169, v73, v169, vcc quad_perm:[1,0,3,2] row_mask:0xf bank_mask:0xf
v_lshrrev_b16 v202, 2, v203
v_mfma_f32_16x16x32_bf16 v[176:179], v[40:43], v[32:35], v[176:179]
ds_read_b128 v[4:7], v250 offset:9216
ds_read_u16_d16 v200, v200
ds_read_u16_d16 v202, v202
v_rcp_f16 v242, v241
v_cndmask_b32_dpp v170, v74, v170, vcc quad_perm:[1,0,3,2] row_mask:0xf bank_mask:0xf
v_mfma_f32_16x16x32_bf16 v[184:187], v[40:43], v[36:39], v[184:187]
v_cndmask_b32_dpp v171, v75, v171, vcc quad_perm:[1,0,3,2] row_mask:0xf bank_mask:0xf
v_lshrrev_b32 v201, 18, v201
v_lshrrev_b32 v203, 18, v203
v_mfma_f32_16x16x32_bf16 v[180:183], v[44:47], v[32:35], v[180:183]
ds_read_b128 v[40:43], v249 offset:12544
s_add_u32 s46, s70, 98304
buffer_store_dwordx4 v[56:59], v255, s[8:11], s46 offen sc1
ds_read_u16_d16_hi v201, v201
ds_read_u16_d16_hi v203, v203
v_rcp_f16 v207, v206
v_mfma_f32_16x16x32_bf16 v[188:191], v[44:47], v[36:39], v[188:191]
v_rcp_f16_sdwa v242, v241 dst_sel:WORD_1 dst_unused:UNUSED_PRESERVE src0_sel:WORD_1
v_or_b32 v232, v192, v193
v_or_b32 v233, v194, v195
s_waitcnt lgkmcnt(6)
v_or_b32 v234, v196, v197
v_rcp_f16_sdwa v207, v206 dst_sel:WORD_1 dst_unused:UNUSED_PRESERVE src0_sel:WORD_1
v_or_b32 v235, v198, v199
s_waitcnt lgkmcnt(1)
v_or_b32 v236, v200, v201
s_waitcnt lgkmcnt(0)
v_or_b32 v237, v202, v203
v_pk_mul_f16 v238, v243, v242
v_pk_mul_f16 v239, v240, v207
v_mfma_f32_16x16x32_f16 v[120:123], v[224:227], v[232:235], v[120:123]
buffer_load_dwordx4 v[12:15], v252, s[4:7], s68 offen offset:128
ds_read_b128 v[44:47], v250 offset:9472
v_cvt_pkrtz_f16_f32 v193, v176, v177
v_cvt_pkrtz_f16_f32 v195, v178, v179
v_mfma_f32_16x16x32_f16 v[128:131], v[224:227], v[236:239], v[128:131]
v_cvt_pkrtz_f16_f32 v197, v180, v181
v_cvt_pkrtz_f16_f32 v199, v182, v183
v_mfma_f32_16x16x32_f16 v[124:127], v[228:231], v[232:235], v[124:127]
ds_read_b128 v[224:227], v249 offset:13312
v_cvt_pkrtz_f16_f32 v201, v184, v185
v_cvt_pk_f16_f32 v243, v186, v187
v_cvt_pk_f16_f32 v240, v188, v189
v_mfma_f32_16x16x32_f16 v[132:135], v[228:231], v[236:239], v[132:135]
v_cvt_pk_f16_f32 v205, v190, v191
s_setprio 1
v_pk_fma_f16 v242, v243, v243, s48
v_mfma_f32_16x16x32_bf16 v[176:179], v[0:3], v[88:91], 0
ds_read_b128 v[228:231], v250 offset:10240
v_and_b32 v193, s49, v193
v_pk_fma_f16 v207, v240, v240, s48
v_mfma_f32_16x16x32_bf16 v[184:187], v[0:3], v[92:95], 0
v_and_b32 v195, s49, v195
v_pk_fma_f16 v204, v205, v205, s48
v_lshrrev_b16 v192, 2, v193
v_mfma_f32_16x16x32_f16 v[136:139], v[4:7], v[232:235], v[136:139]
ds_read_b128 v[0:3], v250 offset:10496
ds_read_u16_d16 v192, v192
v_pk_mul_f16 v242, v243, v242
v_lshrrev_b16 v194, 2, v195
v_mfma_f32_16x16x32_f16 v[144:147], v[4:7], v[236:239], v[144:147]
v_pk_mul_f16 v207, v240, v207
v_lshrrev_b32 v193, 18, v193
v_mfma_f32_16x16x32_bf16 v[180:183], v[40:43], v[88:91], 0
ds_read_b128 v[4:7], v249 offset:13568
ds_read_u16_d16 v194, v194
ds_read_u16_d16_hi v193, v193
v_pk_mul_f16 v204, v205, v204
v_lshrrev_b32 v195, 18, v195
v_mfma_f32_16x16x32_bf16 v[188:191], v[40:43], v[92:95], 0
v_exp_f16 v241, v242
v_and_b32 v197, s49, v197
s_waitcnt lgkmcnt(6)
v_mfma_f32_16x16x32_f16 v[140:143], v[44:47], v[232:235], v[140:143]
ds_read_b128 v[40:43], v249 offset:14336
ds_read_u16_d16_hi v195, v195
v_and_b32 v199, s49, v199
v_mfma_f32_16x16x32_f16 v[148:151], v[44:47], v[236:239], v[148:151]
v_exp_f16 v206, v207
v_lshrrev_b16 v196, 2, v197
v_lshrrev_b16 v198, 2, v199
v_mfma_f32_16x16x32_bf16 v[176:179], v[224:227], v[208:211], v[176:179]
ds_read_b128 v[44:47], v249 offset:14592
ds_read_u16_d16 v196, v196
ds_read_u16_d16 v198, v198
v_exp_f16 v203, v204
v_mfma_f32_16x16x32_bf16 v[184:187], v[224:227], v[212:215], v[184:187]
v_lshrrev_b32 v197, 18, v197
v_lshrrev_b32 v199, 18, v199
s_waitcnt lgkmcnt(7)
v_mfma_f32_16x16x32_f16 v[152:155], v[228:231], v[232:235], v[152:155]
ds_read_b128 v[224:227], v250 offset:14336
ds_read_u16_d16_hi v197, v197
ds_read_u16_d16_hi v199, v199
v_exp_f16_sdwa v241, v242 dst_sel:WORD_1 dst_unused:UNUSED_PRESERVE src0_sel:WORD_1
v_and_b32 v201, s49, v201
v_mfma_f32_16x16x32_f16 v[160:163], v[228:231], v[236:239], v[160:163]
v_lshrrev_b16 v200, 2, v201
v_mfma_f32_16x16x32_f16 v[156:159], v[0:3], v[232:235], v[156:159]
ds_read_b128 v[228:231], v250 offset:14592
ds_read_u16_d16 v200, v200
v_exp_f16_sdwa v206, v207 dst_sel:WORD_1 dst_unused:UNUSED_PRESERVE src0_sel:WORD_1
v_lshrrev_b32 v201, 18, v201
v_mfma_f32_16x16x32_f16 v[164:167], v[0:3], v[236:239], v[164:167]
v_exp_f16_sdwa v203, v204 dst_sel:WORD_1 dst_unused:UNUSED_PRESERVE src0_sel:WORD_1
v_pk_add_f16 v241, v241, 1.0 op_sel_hi:[1,0]
v_mfma_f32_16x16x32_bf16 v[180:183], v[4:7], v[208:211], v[180:183]
ds_read_b128 v[0:3], v249 offset:18432
ds_read_u16_d16_hi v201, v201
v_pk_add_f16 v206, v206, 1.0 op_sel_hi:[1,0]
v_pk_add_f16 v203, v203, 1.0 op_sel_hi:[1,0]
v_mfma_f32_16x16x32_bf16 v[188:191], v[4:7], v[212:215], v[188:191]
v_rcp_f16 v242, v241
s_setprio 0
s_waitcnt lgkmcnt(7)
v_mfma_f32_16x16x32_bf16 v[176:179], v[40:43], v[32:35], v[176:179]
ds_read_b128 v[4:7], v250 offset:15360
v_rcp_f16 v207, v206
v_mfma_f32_16x16x32_bf16 v[184:187], v[40:43], v[36:39], v[184:187]
v_rcp_f16 v204, v203
v_mfma_f32_16x16x32_bf16 v[180:183], v[44:47], v[32:35], v[180:183]
ds_read_b128 v[40:43], v249 offset:18688
v_rcp_f16_sdwa v242, v241 dst_sel:WORD_1 dst_unused:UNUSED_PRESERVE src0_sel:WORD_1
v_mfma_f32_16x16x32_bf16 v[188:191], v[44:47], v[36:39], v[188:191]
v_rcp_f16_sdwa v207, v206 dst_sel:WORD_1 dst_unused:UNUSED_PRESERVE src0_sel:WORD_1
v_or_b32 v232, v192, v193
v_or_b32 v233, v194, v195
s_waitcnt lgkmcnt(4)
v_or_b32 v234, v196, v197
v_rcp_f16_sdwa v204, v203 dst_sel:WORD_1 dst_unused:UNUSED_PRESERVE src0_sel:WORD_1
v_or_b32 v235, v198, v199
s_waitcnt lgkmcnt(2)
v_or_b32 v236, v200, v201
v_pk_mul_f16 v237, v243, v242
v_pk_mul_f16 v238, v240, v207
v_pk_mul_f16 v239, v205, v204
s_setprio 3
v_mfma_f32_16x16x32_f16 v[120:123], v[224:227], v[232:235], v[120:123]
s_add_u32 s46, s68, 98304
buffer_load_dwordx4 v[8:11], v252, s[4:7], s46 offen
ds_read_b128 v[44:47], v250 offset:15616
v_cvt_pkrtz_f16_f32 v193, v176, v177
v_cvt_pkrtz_f16_f32 v195, v178, v179
v_mfma_f32_16x16x32_f16 v[128:131], v[224:227], v[236:239], v[128:131]
v_cvt_pkrtz_f16_f32 v197, v180, v181
v_cvt_pkrtz_f16_f32 v199, v182, v183
v_mfma_f32_16x16x32_f16 v[124:127], v[228:231], v[232:235], v[124:127]
ds_read_b128 v[224:227], v249 offset:19456
v_cvt_pkrtz_f16_f32 v201, v184, v185
v_cvt_pk_f16_f32 v243, v186, v187
v_cvt_pk_f16_f32 v240, v188, v189
v_mfma_f32_16x16x32_f16 v[132:135], v[228:231], v[236:239], v[132:135]
v_cvt_pk_f16_f32 v205, v190, v191
v_pk_fma_f16 v242, v243, v243, s48
v_mfma_f32_16x16x32_bf16 v[176:179], v[0:3], v[88:91], 0
ds_read_b128 v[228:231], v250 offset:16384
v_and_b32 v193, s49, v193
v_pk_fma_f16 v207, v240, v240, s48
v_mfma_f32_16x16x32_bf16 v[184:187], v[0:3], v[92:95], 0
v_and_b32 v195, s49, v195
v_pk_fma_f16 v204, v205, v205, s48
v_lshrrev_b16 v192, 2, v193
s_waitcnt lgkmcnt(3)
v_mfma_f32_16x16x32_f16 v[136:139], v[4:7], v[232:235], v[136:139]
ds_read_b128 v[0:3], v250 offset:16640
ds_read_u16_d16 v192, v192
v_pk_mul_f16 v242, v243, v242
v_lshrrev_b16 v194, 2, v195
v_mfma_f32_16x16x32_f16 v[144:147], v[4:7], v[236:239], v[144:147]
v_pk_mul_f16 v207, v240, v207
v_lshrrev_b32 v193, 18, v193
v_mfma_f32_16x16x32_bf16 v[180:183], v[40:43], v[88:91], 0
ds_read_b128 v[4:7], v249 offset:19712
ds_read_u16_d16 v194, v194
ds_read_u16_d16_hi v193, v193
v_pk_mul_f16 v204, v205, v204
v_lshrrev_b32 v195, 18, v195
v_mfma_f32_16x16x32_bf16 v[188:191], v[40:43], v[92:95], 0
v_exp_f16 v241, v242
v_and_b32 v197, s49, v197
s_waitcnt lgkmcnt(5)
v_mfma_f32_16x16x32_f16 v[140:143], v[44:47], v[232:235], v[140:143]
ds_read_b128 v[40:43], v249 offset:20480
ds_read_u16_d16_hi v195, v195
v_and_b32 v199, s49, v199
v_mfma_f32_16x16x32_f16 v[148:151], v[44:47], v[236:239], v[148:151]
v_exp_f16 v206, v207
v_lshrrev_b16 v196, 2, v197
v_lshrrev_b16 v198, 2, v199
v_mfma_f32_16x16x32_bf16 v[176:179], v[224:227], v[208:211], v[176:179]
s_add_u32 s46, s70, 98304
buffer_store_dwordx4 v[76:79], v255, s[8:11], s46 offen offset:128 sc1
ds_read_b128 v[44:47], v249 offset:20736
ds_read_u16_d16 v196, v196
ds_read_u16_d16 v198, v198
v_exp_f16 v203, v204
v_mfma_f32_16x16x32_bf16 v[184:187], v[224:227], v[212:215], v[184:187]
v_lshrrev_b32 v197, 18, v197
v_lshrrev_b32 v199, 18, v199
v_mfma_f32_16x16x32_f16 v[152:155], v[228:231], v[232:235], v[152:155]
ds_read_b128 v[224:227], v250 offset:20480
ds_read_u16_d16_hi v197, v197
ds_read_u16_d16_hi v199, v199
v_exp_f16_sdwa v241, v242 dst_sel:WORD_1 dst_unused:UNUSED_PRESERVE src0_sel:WORD_1
v_and_b32 v201, s49, v201
v_mfma_f32_16x16x32_f16 v[160:163], v[228:231], v[236:239], v[160:163]
v_lshrrev_b16 v200, 2, v201
s_waitcnt lgkmcnt(7)
v_mfma_f32_16x16x32_f16 v[156:159], v[0:3], v[232:235], v[156:159]
ds_read_b128 v[228:231], v250 offset:20736
ds_read_u16_d16 v200, v200
v_exp_f16_sdwa v206, v207 dst_sel:WORD_1 dst_unused:UNUSED_PRESERVE src0_sel:WORD_1
v_lshrrev_b32 v201, 18, v201
v_mfma_f32_16x16x32_f16 v[164:167], v[0:3], v[236:239], v[164:167]
v_exp_f16_sdwa v203, v204 dst_sel:WORD_1 dst_unused:UNUSED_PRESERVE src0_sel:WORD_1
v_pk_add_f16 v241, v241, 1.0 op_sel_hi:[1,0]
v_mfma_f32_16x16x32_bf16 v[180:183], v[4:7], v[208:211], v[180:183]
ds_read_b128 v[0:3], v248 offset:16384
ds_read_u16_d16_hi v201, v201
v_pk_add_f16 v206, v206, 1.0 op_sel_hi:[1,0]
v_pk_add_f16 v203, v203, 1.0 op_sel_hi:[1,0]
v_mfma_f32_16x16x32_bf16 v[188:191], v[4:7], v[212:215], v[188:191]
v_rcp_f16 v242, v241
v_mfma_f32_16x16x32_bf16 v[176:179], v[40:43], v[32:35], v[176:179]
ds_read_b128 v[4:7], v250 offset:21504
v_rcp_f16 v207, v206
v_mfma_f32_16x16x32_bf16 v[184:187], v[40:43], v[36:39], v[184:187]
v_rcp_f16 v204, v203
s_waitcnt lgkmcnt(5)
v_mfma_f32_16x16x32_bf16 v[180:183], v[44:47], v[32:35], v[180:183]
ds_read_b128 v[40:43], v248 offset:16640
v_rcp_f16_sdwa v242, v241 dst_sel:WORD_1 dst_unused:UNUSED_PRESERVE src0_sel:WORD_1
v_mfma_f32_16x16x32_bf16 v[188:191], v[44:47], v[36:39], v[188:191]
v_rcp_f16_sdwa v207, v206 dst_sel:WORD_1 dst_unused:UNUSED_PRESERVE src0_sel:WORD_1
v_or_b32 v232, v192, v193
v_or_b32 v233, v194, v195
v_or_b32 v234, v196, v197
v_rcp_f16_sdwa v204, v203 dst_sel:WORD_1 dst_unused:UNUSED_PRESERVE src0_sel:WORD_1
v_or_b32 v235, v198, v199
s_waitcnt lgkmcnt(2)
v_or_b32 v236, v200, v201
v_pk_mul_f16 v237, v243, v242
v_pk_mul_f16 v238, v240, v207
v_pk_mul_f16 v239, v205, v204
v_mfma_f32_16x16x32_f16 v[120:123], v[224:227], v[232:235], v[120:123]
ds_read_b128 v[44:47], v250 offset:21760
v_cvt_pkrtz_f16_f32 v193, v176, v177
v_cvt_pkrtz_f16_f32 v195, v178, v179
v_mfma_f32_16x16x32_f16 v[128:131], v[224:227], v[236:239], v[128:131]
v_cvt_pkrtz_f16_f32 v197, v180, v181
v_cvt_pkrtz_f16_f32 v199, v182, v183
v_mfma_f32_16x16x32_f16 v[124:127], v[228:231], v[232:235], v[124:127]
ds_read_b128 v[224:227], v248 offset:17408
v_cvt_pkrtz_f16_f32 v201, v184, v185
v_cvt_pk_f16_f32 v243, v186, v187
v_cvt_pk_f16_f32 v240, v188, v189
v_mfma_f32_16x16x32_f16 v[132:135], v[228:231], v[236:239], v[132:135]
v_cvt_pk_f16_f32 v205, v190, v191
v_pk_fma_f16 v242, v243, v243, s48
s_waitcnt vmcnt(14)
v_mfma_f32_16x16x32_bf16 v[176:179], v[0:3], v[96:99], 0
ds_read_b128 v[228:231], v250 offset:22528
v_and_b32 v193, s49, v193
v_pk_fma_f16 v207, v240, v240, s48
s_waitcnt vmcnt(13)
v_mfma_f32_16x16x32_bf16 v[184:187], v[0:3], v[100:103], 0
v_and_b32 v195, s49, v195
v_pk_fma_f16 v204, v205, v205, s48
s_setprio 2
v_lshrrev_b16 v192, 2, v193
s_waitcnt lgkmcnt(2)
v_mfma_f32_16x16x32_f16 v[136:139], v[4:7], v[232:235], v[136:139]
ds_read_b128 v[0:3], v250 offset:22784
ds_read_u16_d16 v192, v192
v_pk_mul_f16 v242, v243, v242
v_lshrrev_b16 v194, 2, v195
v_mfma_f32_16x16x32_f16 v[144:147], v[4:7], v[236:239], v[144:147]
v_pk_mul_f16 v207, v240, v207
v_lshrrev_b32 v193, 18, v193
v_mfma_f32_16x16x32_bf16 v[180:183], v[40:43], v[96:99], 0
ds_read_b128 v[4:7], v248 offset:17664
ds_read_u16_d16 v194, v194
ds_read_u16_d16_hi v193, v193
v_pk_mul_f16 v204, v205, v204
v_lshrrev_b32 v195, 18, v195
v_mfma_f32_16x16x32_bf16 v[188:191], v[40:43], v[100:103], 0
v_exp_f16 v241, v242
v_and_b32 v197, s49, v197
v_mfma_f32_16x16x32_f16 v[140:143], v[44:47], v[232:235], v[140:143]
ds_read_b128 v[40:43], v248 offset:18432
ds_read_u16_d16_hi v195, v195
v_and_b32 v199, s49, v199
v_mfma_f32_16x16x32_f16 v[148:151], v[44:47], v[236:239], v[148:151]
v_exp_f16 v206, v207
v_lshrrev_b16 v196, 2, v197
v_lshrrev_b16 v198, 2, v199
s_waitcnt vmcnt(12) lgkmcnt(7)
v_mfma_f32_16x16x32_bf16 v[176:179], v[224:227], v[104:107], v[176:179]
ds_read_b128 v[44:47], v248 offset:18688
ds_read_u16_d16 v196, v196
ds_read_u16_d16 v198, v198
v_exp_f16 v203, v204
s_waitcnt vmcnt(11)
v_mfma_f32_16x16x32_bf16 v[184:187], v[224:227], v[108:111], v[184:187]
v_lshrrev_b32 v197, 18, v197
v_lshrrev_b32 v199, 18, v199
v_mfma_f32_16x16x32_f16 v[152:155], v[228:231], v[232:235], v[152:155]
ds_read_b128 v[224:227], v250 offset:26624
ds_read_u16_d16_hi v197, v197
ds_read_u16_d16_hi v199, v199
v_exp_f16_sdwa v241, v242 dst_sel:WORD_1 dst_unused:UNUSED_PRESERVE src0_sel:WORD_1
v_and_b32 v201, s49, v201
v_mfma_f32_16x16x32_f16 v[160:163], v[228:231], v[236:239], v[160:163]
v_lshrrev_b16 v200, 2, v201
s_waitcnt lgkmcnt(7)
v_mfma_f32_16x16x32_f16 v[156:159], v[0:3], v[232:235], v[156:159]
ds_read_b128 v[228:231], v250 offset:26880
ds_read_u16_d16 v200, v200
v_exp_f16_sdwa v206, v207 dst_sel:WORD_1 dst_unused:UNUSED_PRESERVE src0_sel:WORD_1
v_lshrrev_b32 v201, 18, v201
v_mfma_f32_16x16x32_f16 v[164:167], v[0:3], v[236:239], v[164:167]
v_exp_f16_sdwa v203, v204 dst_sel:WORD_1 dst_unused:UNUSED_PRESERVE src0_sel:WORD_1
v_pk_add_f16 v241, v241, 1.0 op_sel_hi:[1,0]
v_mfma_f32_16x16x32_bf16 v[180:183], v[4:7], v[104:107], v[180:183]
ds_read_b128 v[0:3], v248 offset:22528
ds_read_u16_d16_hi v201, v201
v_pk_add_f16 v206, v206, 1.0 op_sel_hi:[1,0]
v_pk_add_f16 v203, v203, 1.0 op_sel_hi:[1,0]
v_mfma_f32_16x16x32_bf16 v[188:191], v[4:7], v[108:111], v[188:191]
v_rcp_f16 v242, v241
s_waitcnt vmcnt(10)
v_mfma_f32_16x16x32_bf16 v[176:179], v[40:43], v[112:115], v[176:179]
ds_read_b128 v[4:7], v250 offset:27648
v_rcp_f16 v207, v206
s_waitcnt vmcnt(7)
v_mfma_f32_16x16x32_bf16 v[184:187], v[40:43], v[116:119], v[184:187]
v_rcp_f16 v204, v203
s_waitcnt lgkmcnt(5)
v_mfma_f32_16x16x32_bf16 v[180:183], v[44:47], v[112:115], v[180:183]
ds_read_b128 v[40:43], v248 offset:22784
v_rcp_f16_sdwa v242, v241 dst_sel:WORD_1 dst_unused:UNUSED_PRESERVE src0_sel:WORD_1
v_mfma_f32_16x16x32_bf16 v[188:191], v[44:47], v[116:119], v[188:191]
v_rcp_f16_sdwa v207, v206 dst_sel:WORD_1 dst_unused:UNUSED_PRESERVE src0_sel:WORD_1
v_or_b32 v232, v192, v193
v_or_b32 v233, v194, v195
v_or_b32 v234, v196, v197
v_rcp_f16_sdwa v204, v203 dst_sel:WORD_1 dst_unused:UNUSED_PRESERVE src0_sel:WORD_1
v_or_b32 v235, v198, v199
s_waitcnt lgkmcnt(2)
v_or_b32 v236, v200, v201
v_pk_mul_f16 v237, v243, v242
v_pk_mul_f16 v238, v240, v207
v_pk_mul_f16 v239, v205, v204
v_mfma_f32_16x16x32_f16 v[120:123], v[224:227], v[232:235], v[120:123]
s_add_u32 s46, s68, 98304
buffer_load_dwordx4 v[36:39], v252, s[4:7], s46 offen offset:64
ds_read_b128 v[44:47], v250 offset:27904
v_cvt_pkrtz_f16_f32 v193, v176, v177
v_cvt_pkrtz_f16_f32 v195, v178, v179
v_mfma_f32_16x16x32_f16 v[128:131], v[224:227], v[236:239], v[128:131]
v_cvt_pkrtz_f16_f32 v197, v180, v181
v_cvt_pkrtz_f16_f32 v199, v182, v183
v_mfma_f32_16x16x32_f16 v[124:127], v[228:231], v[232:235], v[124:127]
ds_read_b128 v[224:227], v248 offset:23552
v_cvt_pkrtz_f16_f32 v201, v184, v185
v_cvt_pk_f16_f32 v243, v186, v187
v_mfma_f32_16x16x32_f16 v[132:135], v[228:231], v[236:239], v[132:135]
v_cvt_pk_f16_f32 v240, v188, v189
v_cvt_pk_f16_f32 v205, v190, v191
s_setprio 1
v_mfma_f32_16x16x32_bf16 v[176:179], v[0:3], v[96:99], 0
ds_read_b128 v[228:231], v250 offset:28672
v_pk_fma_f16 v242, v243, v243, s48
v_and_b32 v193, s49, v193
v_mfma_f32_16x16x32_bf16 v[184:187], v[0:3], v[100:103], 0
v_pk_fma_f16 v207, v240, v240, s48
v_and_b32 v195, s49, v195
s_waitcnt lgkmcnt(3)
v_mfma_f32_16x16x32_f16 v[136:139], v[4:7], v[232:235], v[136:139]
ds_read_b128 v[0:3], v250 offset:28928
v_pk_fma_f16 v204, v205, v205, s48
v_lshrrev_b16 v192, 2, v193
v_pk_mul_f16 v242, v243, v242
v_mfma_f32_16x16x32_f16 v[144:147], v[4:7], v[236:239], v[144:147]
v_lshrrev_b16 v194, 2, v195
v_pk_mul_f16 v207, v240, v207
s_waitcnt vmcnt(7)
v_mfma_f32_16x16x32_bf16 v[120:123], v[26:29], v[244:247], v[120:123]
ds_read_b128 v[4:7], v248 offset:23808
ds_read_u16_d16 v192, v192
ds_read_u16_d16 v194, v194
v_lshrrev_b32 v193, 18, v193
v_pk_mul_f16 v204, v205, v204
v_mfma_f32_16x16x32_bf16 v[124:127], v[24:27], v[244:247], v[124:127]
v_lshrrev_b32 v195, 18, v195
v_mfma_f32_16x16x32_bf16 v[180:183], v[40:43], v[96:99], 0
ds_read_u16_d16_hi v193, v193
ds_read_u16_d16_hi v195, v195
v_exp_f16 v241, v242
v_and_b32 v197, s49, v197
v_mfma_f32_16x16x32_bf16 v[188:191], v[40:43], v[100:103], 0
v_and_b32 v199, s49, v199
s_waitcnt lgkmcnt(6)
v_mfma_f32_16x16x32_f16 v[140:143], v[44:47], v[232:235], v[140:143]
ds_read_b128 v[40:43], v248 offset:24576
v_exp_f16 v206, v207
v_lshrrev_b16 v196, 2, v197
v_mfma_f32_16x16x32_f16 v[148:151], v[44:47], v[236:239], v[148:151]
v_lshrrev_b16 v198, 2, v199
v_exp_f16 v203, v204
v_mfma_f32_16x16x32_bf16 v[176:179], v[224:227], v[104:107], v[176:179]
s_add_u32 s46, s70, 98304
buffer_store_dwordx4 v[168:171], v255, s[8:11], s46 offen offset:256 sc1
ds_read_b128 v[44:47], v248 offset:24832
ds_read_u16_d16 v196, v196
ds_read_u16_d16 v198, v198
v_lshrrev_b32 v197, 18, v197
v_lshrrev_b32 v199, 18, v199
v_mfma_f32_16x16x32_bf16 v[184:187], v[224:227], v[108:111], v[184:187]
v_exp_f16_sdwa v241, v242 dst_sel:WORD_1 dst_unused:UNUSED_PRESERVE src0_sel:WORD_1
v_mfma_f32_16x16x32_f16 v[152:155], v[228:231], v[232:235], v[152:155]
ds_read_b128 v[224:227], v249 offset:24576
ds_read_u16_d16_hi v197, v197
ds_read_u16_d16_hi v199, v199
v_and_b32 v201, s49, v201
v_lshrrev_b16 v200, 2, v201
v_mfma_f32_16x16x32_f16 v[160:163], v[228:231], v[236:239], v[160:163]
v_exp_f16_sdwa v206, v207 dst_sel:WORD_1 dst_unused:UNUSED_PRESERVE src0_sel:WORD_1
s_waitcnt lgkmcnt(7)
v_mfma_f32_16x16x32_f16 v[156:159], v[0:3], v[232:235], v[156:159]
ds_read_b128 v[228:231], v254 offset:7936
ds_read_u16_d16 v200, v200
v_lshrrev_b32 v201, 18, v201
v_mfma_f32_16x16x32_f16 v[164:167], v[0:3], v[236:239], v[164:167]
v_exp_f16_sdwa v203, v204 dst_sel:WORD_1 dst_unused:UNUSED_PRESERVE src0_sel:WORD_1
v_pk_add_f16 v241, v241, 1.0 op_sel_hi:[1,0]
v_pk_add_f16 v206, v206, 1.0 op_sel_hi:[1,0]
v_mfma_f32_16x16x32_bf16 v[180:183], v[4:7], v[104:107], v[180:183]
ds_read_b128 v[0:3], v249 offset:24832
ds_read_u16_d16_hi v201, v201
v_pk_add_f16 v203, v203, 1.0 op_sel_hi:[1,0]
v_mfma_f32_16x16x32_bf16 v[188:191], v[4:7], v[108:111], v[188:191]
v_rcp_f16 v242, v241
s_setprio 0
s_waitcnt lgkmcnt(7)
v_mfma_f32_16x16x32_bf16 v[176:179], v[40:43], v[112:115], v[176:179]
ds_read_b128 v[4:7], v254 offset:7952
v_rcp_f16 v207, v206
v_mfma_f32_16x16x32_bf16 v[184:187], v[40:43], v[116:119], v[184:187]
v_rcp_f16 v204, v203
v_mfma_f32_16x16x32_bf16 v[180:183], v[44:47], v[112:115], v[180:183]
ds_read_b128 v[40:43], v248 offset:28672
v_rcp_f16_sdwa v242, v241 dst_sel:WORD_1 dst_unused:UNUSED_PRESERVE src0_sel:WORD_1
v_mfma_f32_16x16x32_bf16 v[188:191], v[44:47], v[116:119], v[188:191]
v_rcp_f16_sdwa v207, v206 dst_sel:WORD_1 dst_unused:UNUSED_PRESERVE src0_sel:WORD_1
v_or_b32 v232, v192, v193
v_or_b32 v233, v194, v195
s_waitcnt lgkmcnt(4)
v_or_b32 v234, v196, v197
v_rcp_f16_sdwa v204, v203 dst_sel:WORD_1 dst_unused:UNUSED_PRESERVE src0_sel:WORD_1
v_or_b32 v235, v198, v199
s_waitcnt lgkmcnt(2)
v_or_b32 v236, v200, v201
v_pk_mul_f16 v237, v243, v242
v_pk_mul_f16 v238, v240, v207
v_pk_mul_f16 v239, v205, v204
s_setprio 3
v_mfma_f32_16x16x32_f16 v[48:51], v[224:227], v[232:235], v[228:231]
ds_read_b128 v[44:47], v249 offset:25600
v_cvt_pkrtz_f16_f32 v193, v176, v177
v_cvt_pkrtz_f16_f32 v195, v178, v179
v_mfma_f32_16x16x32_f16 v[56:59], v[224:227], v[236:239], v[228:231]
v_cvt_pkrtz_f16_f32 v197, v180, v181
v_cvt_pkrtz_f16_f32 v199, v182, v183
s_waitcnt lgkmcnt(2)
v_mfma_f32_16x16x32_f16 v[52:55], v[0:3], v[232:235], v[4:7]
ds_read_b128 v[224:227], v254 offset:8064
ds_read_b128 v[228:231], v248 offset:28928
v_cvt_pkrtz_f16_f32 v201, v184, v185
v_cvt_pk_f16_f32 v243, v186, v187
v_mfma_f32_16x16x32_f16 v[60:63], v[0:3], v[236:239], v[4:7]
v_cvt_pk_f16_f32 v240, v188, v189
v_cvt_pk_f16_f32 v205, v190, v191
s_waitcnt lgkmcnt(3)
v_mfma_f32_16x16x32_bf16 v[176:179], v[40:43], v[96:99], 0
ds_read_b128 v[0:3], v249 offset:25856
ds_read_b128 v[4:7], v254 offset:8080
v_pk_fma_f16 v242, v243, v243, s48
v_and_b32 v193, s49, v193
v_mfma_f32_16x16x32_bf16 v[184:187], v[40:43], v[100:103], 0
v_pk_fma_f16 v207, v240, v240, s48
v_and_b32 v195, s49, v195
s_waitcnt lgkmcnt(3)
v_mfma_f32_16x16x32_f16 v[64:67], v[44:47], v[232:235], v[224:227]
ds_read_b128 v[40:43], v248 offset:29696
v_pk_fma_f16 v204, v205, v205, s48
v_lshrrev_b16 v192, 2, v193
v_pk_mul_f16 v242, v243, v242
v_mfma_f32_16x16x32_f16 v[72:75], v[44:47], v[236:239], v[224:227]
v_lshrrev_b16 v194, 2, v195
v_pk_mul_f16 v207, v240, v207
s_waitcnt vmcnt(6)
v_mfma_f32_16x16x32_bf16 v[136:139], v[26:29], v[216:219], v[136:139]
ds_read_b128 v[44:47], v249 offset:26624
ds_read_b128 v[224:227], v254 offset:16128
ds_read_u16_d16 v192, v192
ds_read_u16_d16 v194, v194
v_lshrrev_b32 v193, 18, v193
v_pk_mul_f16 v204, v205, v204
v_mfma_f32_16x16x32_bf16 v[140:143], v[24:27], v[216:219], v[140:143]
v_lshrrev_b32 v195, 18, v195
s_waitcnt lgkmcnt(5)
v_mfma_f32_16x16x32_bf16 v[180:183], v[228:231], v[96:99], 0
ds_read_u16_d16_hi v193, v193
ds_read_u16_d16_hi v195, v195
v_exp_f16 v241, v242
v_and_b32 v197, s49, v197
v_mfma_f32_16x16x32_bf16 v[188:191], v[228:231], v[100:103], 0
v_and_b32 v199, s49, v199
v_mfma_f32_16x16x32_f16 v[68:71], v[0:3], v[232:235], v[4:7]
ds_read_b128 v[228:231], v249 offset:26880
v_exp_f16 v206, v207
v_lshrrev_b16 v196, 2, v197
v_mfma_f32_16x16x32_f16 v[76:79], v[0:3], v[236:239], v[4:7]
v_lshrrev_b16 v198, 2, v199
v_exp_f16 v203, v204
s_waitcnt lgkmcnt(7)
v_mfma_f32_16x16x32_bf16 v[176:179], v[40:43], v[104:107], v[176:179]
ds_read_b128 v[0:3], v254 offset:16144
ds_read_b128 v[4:7], v248 offset:29952
ds_read_u16_d16 v196, v196
ds_read_u16_d16 v198, v198
v_lshrrev_b32 v197, 18, v197
v_lshrrev_b32 v199, 18, v199
v_mfma_f32_16x16x32_bf16 v[184:187], v[40:43], v[108:111], v[184:187]
v_exp_f16_sdwa v241, v242 dst_sel:WORD_1 dst_unused:UNUSED_PRESERVE src0_sel:WORD_1
s_waitcnt lgkmcnt(7)
v_mfma_f32_16x16x32_f16 v[80:83], v[44:47], v[232:235], v[224:227]
ds_read_b128 v[40:43], v248 offset:30720
ds_read_u16_d16_hi v197, v197
ds_read_u16_d16_hi v199, v199
v_and_b32 v201, s49, v201
v_lshrrev_b16 v200, 2, v201
v_mfma_f32_16x16x32_f16 v[168:171], v[44:47], v[236:239], v[224:227]
v_exp_f16_sdwa v206, v207 dst_sel:WORD_1 dst_unused:UNUSED_PRESERVE src0_sel:WORD_1
s_waitcnt lgkmcnt(6)
v_mfma_f32_16x16x32_f16 v[84:87], v[228:231], v[232:235], v[0:3]
ds_read_b128 v[44:47], v248 offset:30976
ds_read_b128 v[224:227], v249 offset:30720
ds_read_u16_d16 v200, v200
v_lshrrev_b32 v201, 18, v201
v_mfma_f32_16x16x32_f16 v[172:175], v[228:231], v[236:239], v[0:3]
v_exp_f16_sdwa v203, v204 dst_sel:WORD_1 dst_unused:UNUSED_PRESERVE src0_sel:WORD_1
v_pk_add_f16 v241, v241, 1.0 op_sel_hi:[1,0]
v_pk_add_f16 v206, v206, 1.0 op_sel_hi:[1,0]
s_waitcnt lgkmcnt(7)
v_mfma_f32_16x16x32_bf16 v[180:183], v[4:7], v[104:107], v[180:183]
ds_read_b128 v[228:231], v249 offset:30976
ds_read_b128 v[0:3], v248 offset:34816
ds_read_u16_d16_hi v201, v201
v_pk_add_f16 v203, v203, 1.0 op_sel_hi:[1,0]
v_mfma_f32_16x16x32_bf16 v[188:191], v[4:7], v[108:111], v[188:191]
v_rcp_f16 v242, v241
s_waitcnt lgkmcnt(8)
v_mfma_f32_16x16x32_bf16 v[176:179], v[40:43], v[112:115], v[176:179]
ds_read_b128 v[4:7], v249 offset:31744
v_rcp_f16 v207, v206
v_mfma_f32_16x16x32_bf16 v[184:187], v[40:43], v[116:119], v[184:187]
v_rcp_f16 v204, v203
s_waitcnt lgkmcnt(6)
v_mfma_f32_16x16x32_bf16 v[180:183], v[44:47], v[112:115], v[180:183]
ds_read_b128 v[40:43], v248 offset:35072
v_rcp_f16_sdwa v242, v241 dst_sel:WORD_1 dst_unused:UNUSED_PRESERVE src0_sel:WORD_1
v_mfma_f32_16x16x32_bf16 v[188:191], v[44:47], v[116:119], v[188:191]
v_rcp_f16_sdwa v207, v206 dst_sel:WORD_1 dst_unused:UNUSED_PRESERVE src0_sel:WORD_1
v_or_b32 v232, v192, v193
v_or_b32 v233, v194, v195
v_or_b32 v234, v196, v197
v_rcp_f16_sdwa v204, v203 dst_sel:WORD_1 dst_unused:UNUSED_PRESERVE src0_sel:WORD_1
v_or_b32 v235, v198, v199
s_waitcnt lgkmcnt(2)
v_or_b32 v236, v200, v201
v_pk_mul_f16 v237, v243, v242
v_pk_mul_f16 v238, v240, v207
v_pk_mul_f16 v239, v205, v204
v_mfma_f32_16x16x32_f16 v[48:51], v[224:227], v[232:235], v[48:51]
s_add_u32 s46, s68, 98304
buffer_load_dwordx4 v[216:219], v252, s[4:7], s46 offen offset:128
ds_read_b128 v[44:47], v249 offset:32000
v_cvt_pkrtz_f16_f32 v193, v176, v177
v_cvt_pkrtz_f16_f32 v195, v178, v179
v_mfma_f32_16x16x32_f16 v[56:59], v[224:227], v[236:239], v[56:59]
v_cvt_pkrtz_f16_f32 v197, v180, v181
v_cvt_pkrtz_f16_f32 v199, v182, v183
v_mfma_f32_16x16x32_f16 v[52:55], v[228:231], v[232:235], v[52:55]
ds_read_b128 v[224:227], v248 offset:35840
v_cvt_pkrtz_f16_f32 v201, v184, v185
v_cvt_pk_f16_f32 v243, v186, v187
v_mfma_f32_16x16x32_f16 v[60:63], v[228:231], v[236:239], v[60:63]
v_cvt_pk_f16_f32 v240, v188, v189
v_cvt_pk_f16_f32 v205, v190, v191
v_mfma_f32_16x16x32_bf16 v[176:179], v[0:3], v[96:99], 0
ds_read_b128 v[228:231], v249 offset:32768
v_pk_fma_f16 v242, v243, v243, s48
v_and_b32 v193, s49, v193
v_mfma_f32_16x16x32_bf16 v[184:187], v[0:3], v[100:103], 0
v_pk_fma_f16 v207, v240, v240, s48
v_and_b32 v195, s49, v195
s_waitcnt lgkmcnt(3)
v_mfma_f32_16x16x32_f16 v[64:67], v[4:7], v[232:235], v[64:67]
ds_read_b128 v[0:3], v249 offset:33024
v_pk_fma_f16 v204, v205, v205, s48
s_setprio 2
v_lshrrev_b16 v192, 2, v193
v_pk_mul_f16 v242, v243, v242
v_mfma_f32_16x16x32_f16 v[72:75], v[4:7], v[236:239], v[72:75]
v_lshrrev_b16 v194, 2, v195
v_pk_mul_f16 v207, v240, v207
s_waitcnt vmcnt(5)
v_mfma_f32_16x16x32_bf16 v[152:155], v[26:29], v[12:15], v[152:155]
ds_read_b128 v[4:7], v248 offset:36096
ds_read_u16_d16 v192, v192
ds_read_u16_d16 v194, v194
v_lshrrev_b32 v193, 18, v193
v_pk_mul_f16 v204, v205, v204
v_mfma_f32_16x16x32_bf16 v[156:159], v[24:27], v[12:15], v[156:159]
v_lshrrev_b32 v195, 18, v195
v_mfma_f32_16x16x32_bf16 v[180:183], v[40:43], v[96:99], 0
ds_read_u16_d16_hi v193, v193
ds_read_u16_d16_hi v195, v195
v_exp_f16 v241, v242
v_and_b32 v197, s49, v197
v_mfma_f32_16x16x32_bf16 v[188:191], v[40:43], v[100:103], 0
v_and_b32 v199, s49, v199
s_waitcnt lgkmcnt(6)
v_mfma_f32_16x16x32_f16 v[68:71], v[44:47], v[232:235], v[68:71]
ds_read_b128 v[40:43], v248 offset:36864
v_exp_f16 v206, v207
v_lshrrev_b16 v196, 2, v197
v_mfma_f32_16x16x32_f16 v[76:79], v[44:47], v[236:239], v[76:79]
v_lshrrev_b16 v198, 2, v199
v_exp_f16 v203, v204
v_mfma_f32_16x16x32_bf16 v[176:179], v[224:227], v[104:107], v[176:179]
ds_read_b128 v[44:47], v248 offset:37120
ds_read_u16_d16 v196, v196
ds_read_u16_d16 v198, v198
v_lshrrev_b32 v197, 18, v197
v_lshrrev_b32 v199, 18, v199
v_mfma_f32_16x16x32_bf16 v[184:187], v[224:227], v[108:111], v[184:187]
v_exp_f16_sdwa v241, v242 dst_sel:WORD_1 dst_unused:UNUSED_PRESERVE src0_sel:WORD_1
v_mfma_f32_16x16x32_f16 v[80:83], v[228:231], v[232:235], v[80:83]
ds_read_b128 v[224:227], v249 offset:36864
ds_read_u16_d16_hi v197, v197
ds_read_u16_d16_hi v199, v199
v_and_b32 v201, s49, v201
v_lshrrev_b16 v200, 2, v201
v_mfma_f32_16x16x32_f16 v[168:171], v[228:231], v[236:239], v[168:171]
v_exp_f16_sdwa v206, v207 dst_sel:WORD_1 dst_unused:UNUSED_PRESERVE src0_sel:WORD_1
s_waitcnt lgkmcnt(7)
v_mfma_f32_16x16x32_f16 v[84:87], v[0:3], v[232:235], v[84:87]
ds_read_b128 v[228:231], v249 offset:37120
ds_read_u16_d16 v200, v200
v_lshrrev_b32 v201, 18, v201
v_mfma_f32_16x16x32_f16 v[172:175], v[0:3], v[236:239], v[172:175]
v_exp_f16_sdwa v203, v204 dst_sel:WORD_1 dst_unused:UNUSED_PRESERVE src0_sel:WORD_1
v_pk_add_f16 v241, v241, 1.0 op_sel_hi:[1,0]
v_pk_add_f16 v206, v206, 1.0 op_sel_hi:[1,0]
v_mfma_f32_16x16x32_bf16 v[180:183], v[4:7], v[104:107], v[180:183]
ds_read_b128 v[0:3], v248 offset:40960
ds_read_u16_d16_hi v201, v201
v_pk_add_f16 v203, v203, 1.0 op_sel_hi:[1,0]
v_mfma_f32_16x16x32_bf16 v[188:191], v[4:7], v[108:111], v[188:191]
v_rcp_f16 v242, v241
s_waitcnt lgkmcnt(7)
v_mfma_f32_16x16x32_bf16 v[176:179], v[40:43], v[112:115], v[176:179]
ds_read_b128 v[4:7], v249 offset:37888
v_rcp_f16 v207, v206
v_mfma_f32_16x16x32_bf16 v[184:187], v[40:43], v[116:119], v[184:187]
v_rcp_f16 v204, v203
v_mfma_f32_16x16x32_bf16 v[180:183], v[44:47], v[112:115], v[180:183]
ds_read_b128 v[40:43], v248 offset:41216
v_rcp_f16_sdwa v242, v241 dst_sel:WORD_1 dst_unused:UNUSED_PRESERVE src0_sel:WORD_1
v_mfma_f32_16x16x32_bf16 v[188:191], v[44:47], v[116:119], v[188:191]
v_rcp_f16_sdwa v207, v206 dst_sel:WORD_1 dst_unused:UNUSED_PRESERVE src0_sel:WORD_1
v_or_b32 v232, v192, v193
v_or_b32 v233, v194, v195
s_waitcnt lgkmcnt(4)
v_or_b32 v234, v196, v197
v_rcp_f16_sdwa v204, v203 dst_sel:WORD_1 dst_unused:UNUSED_PRESERVE src0_sel:WORD_1
v_or_b32 v235, v198, v199
s_waitcnt lgkmcnt(2)
v_or_b32 v236, v200, v201
v_pk_mul_f16 v237, v243, v242
v_pk_mul_f16 v238, v240, v207
v_pk_mul_f16 v239, v205, v204
v_mfma_f32_16x16x32_f16 v[48:51], v[224:227], v[232:235], v[48:51]
buffer_load_dwordx4 v[12:15], v252, s[4:7], s69 offen
ds_read_b128 v[44:47], v249 offset:38144
v_cvt_pkrtz_f16_f32 v193, v176, v177
v_cvt_pkrtz_f16_f32 v195, v178, v179
v_cvt_pkrtz_f16_f32 v197, v180, v181
v_mfma_f32_16x16x32_f16 v[56:59], v[224:227], v[236:239], v[56:59]
v_cvt_pkrtz_f16_f32 v199, v182, v183
v_cvt_pkrtz_f16_f32 v201, v184, v185
v_cvt_pkrtz_f16_f32 v203, v186, v187
v_mfma_f32_16x16x32_f16 v[52:55], v[228:231], v[232:235], v[52:55]
ds_read_b128 v[224:227], v248 offset:41984
v_cvt_pk_f16_f32 v243, v188, v189
v_cvt_pk_f16_f32 v240, v190, v191
v_pk_fma_f16 v242, v243, v243, s48
s_setprio 1
v_mfma_f32_16x16x32_f16 v[60:63], v[228:231], v[236:239], v[60:63]
v_cvt_pk_bf16_f32 v136, v136, v137
v_and_b32 v193, s49, v193
v_cvt_pk_bf16_f32 v137, v138, v139
v_mfma_f32_16x16x32_bf16 v[176:179], v[0:3], v[96:99], 0
ds_read_b128 v[228:231], v249 offset:38912
v_and_b32 v195, s49, v195
v_cvt_pk_bf16_f32 v138, v140, v141
v_pk_fma_f16 v207, v240, v240, s48
v_mfma_f32_16x16x32_bf16 v[184:187], v[0:3], v[100:103], 0
v_lshrrev_b16 v192, 2, v193
v_cvt_pk_bf16_f32 v139, v142, v143
v_pk_mul_f16 v242, v243, v242
s_waitcnt lgkmcnt(2)
v_mfma_f32_16x16x32_f16 v[64:67], v[4:7], v[232:235], v[64:67]
ds_read_b128 v[0:3], v249 offset:39168
ds_read_u16_d16 v192, v192
v_cvt_pk_bf16_f32 v120, v120, v121
v_lshrrev_b16 v194, 2, v195
v_cvt_pk_bf16_f32 v121, v122, v123
v_mfma_f32_16x16x32_f16 v[72:75], v[4:7], v[236:239], v[72:75]
v_pk_mul_f16 v207, v240, v207
v_lshrrev_b32 v193, 18, v193
v_cvt_pk_bf16_f32 v122, v124, v125
v_mfma_f32_16x16x32_bf16 v[180:183], v[40:43], v[96:99], 0
ds_read_b128 v[4:7], v248 offset:42240
ds_read_u16_d16 v194, v194
ds_read_u16_d16_hi v193, v193
v_exp_f16 v241, v242
v_cvt_pk_bf16_f32 v123, v126, v127
v_mfma_f32_16x16x32_bf16 v[188:191], v[40:43], v[100:103], 0
v_lshrrev_b32 v195, 18, v195
v_cvt_pk_bf16_f32 v152, v152, v153
v_and_b32 v197, s49, v197
v_mfma_f32_16x16x32_f16 v[68:71], v[44:47], v[232:235], v[68:71]
ds_read_b128 v[40:43], v248 offset:43008
ds_read_u16_d16_hi v195, v195
v_cvt_pk_bf16_f32 v153, v154, v155
v_exp_f16 v206, v207
v_mfma_f32_16x16x32_f16 v[76:79], v[44:47], v[236:239], v[76:79]
v_cvt_pk_bf16_f32 v154, v156, v157
v_and_b32 v199, s49, v199
v_cvt_pk_bf16_f32 v155, v158, v159
s_mov_b64 vcc, s[74:75]
s_waitcnt lgkmcnt(5)
v_mfma_f32_16x16x32_bf16 v[176:179], v[224:227], v[104:107], v[176:179]
ds_read_b128 v[44:47], v248 offset:43264
v_lshrrev_b16 v196, 2, v197
v_cndmask_b32_e64 v140, v120, v152, s[74:75]
v_mfma_f32_16x16x32_bf16 v[184:187], v[224:227], v[108:111], v[184:187]
v_exp_f16_sdwa v241, v242 dst_sel:WORD_1 dst_unused:UNUSED_PRESERVE src0_sel:WORD_1
v_cndmask_b32_dpp v120, v136, v120, vcc quad_perm:[1,0,3,2] row_mask:0xf bank_mask:0xf
v_lshrrev_b16 v198, 2, v199
v_mfma_f32_16x16x32_f16 v[80:83], v[228:231], v[232:235], v[80:83]
ds_read_b128 v[224:227], v249 offset:43008
ds_read_u16_d16 v196, v196
ds_read_u16_d16 v198, v198
v_cndmask_b32_e64 v141, v121, v153, s[74:75]
v_lshrrev_b32 v197, 18, v197
v_cndmask_b32_dpp v121, v137, v121, vcc quad_perm:[1,0,3,2] row_mask:0xf bank_mask:0xf
v_mfma_f32_16x16x32_f16 v[168:171], v[228:231], v[236:239], v[168:171]
v_lshrrev_b32 v199, 18, v199
v_exp_f16_sdwa v206, v207 dst_sel:WORD_1 dst_unused:UNUSED_PRESERVE src0_sel:WORD_1
v_mfma_f32_16x16x32_f16 v[84:87], v[0:3], v[232:235], v[84:87]
ds_read_b128 v[228:231], v249 offset:43264
ds_read_u16_d16_hi v197, v197
ds_read_u16_d16_hi v199, v199
v_cndmask_b32_e64 v142, v122, v154, s[74:75]
v_cndmask_b32_dpp v122, v138, v122, vcc quad_perm:[1,0,3,2] row_mask:0xf bank_mask:0xf
v_and_b32 v201, s49, v201
v_mfma_f32_16x16x32_f16 v[172:175], v[0:3], v[236:239], v[172:175]
v_cndmask_b32_e64 v143, v123, v155, s[74:75]
v_and_b32 v203, s49, v203
v_pk_add_f16 v241, v241, 1.0 op_sel_hi:[1,0]
s_waitcnt lgkmcnt(6)
v_mfma_f32_16x16x32_bf16 v[180:183], v[4:7], v[104:107], v[180:183]
ds_read_b128 v[0:3], v248 offset:47104
v_cndmask_b32_dpp v123, v139, v123, vcc quad_perm:[1,0,3,2] row_mask:0xf bank_mask:0xf
s_not_b64 vcc, s[74:75]
v_lshrrev_b16 v200, 2, v201
s_setprio 0
v_cndmask_b32_dpp v152, v136, v152, vcc quad_perm:[1,0,3,2] row_mask:0xf bank_mask:0xf
v_mfma_f32_16x16x32_bf16 v[188:191], v[4:7], v[108:111], v[188:191]
v_pk_add_f16 v206, v206, 1.0 op_sel_hi:[1,0]
v_cndmask_b32_dpp v153, v137, v153, vcc quad_perm:[1,0,3,2] row_mask:0xf bank_mask:0xf
v_lshrrev_b16 v202, 2, v203
v_mfma_f32_16x16x32_bf16 v[176:179], v[40:43], v[112:115], v[176:179]
ds_read_b128 v[4:7], v249 offset:44032
ds_read_u16_d16 v200, v200
ds_read_u16_d16 v202, v202
v_rcp_f16 v242, v241
v_cndmask_b32_dpp v154, v138, v154, vcc quad_perm:[1,0,3,2] row_mask:0xf bank_mask:0xf
v_mfma_f32_16x16x32_bf16 v[184:187], v[40:43], v[116:119], v[184:187]
v_cndmask_b32_dpp v155, v139, v155, vcc quad_perm:[1,0,3,2] row_mask:0xf bank_mask:0xf
v_lshrrev_b32 v201, 18, v201
v_lshrrev_b32 v203, 18, v203
v_mfma_f32_16x16x32_bf16 v[180:183], v[44:47], v[112:115], v[180:183]
ds_read_b128 v[40:43], v248 offset:47360
buffer_store_dwordx4 v[120:123], v255, s[8:11], s68 offen sc1
ds_read_u16_d16_hi v201, v201
ds_read_u16_d16_hi v203, v203
v_rcp_f16 v207, v206
v_mfma_f32_16x16x32_bf16 v[188:191], v[44:47], v[116:119], v[188:191]
v_rcp_f16_sdwa v242, v241 dst_sel:WORD_1 dst_unused:UNUSED_PRESERVE src0_sel:WORD_1
v_or_b32 v232, v192, v193
v_or_b32 v233, v194, v195
s_waitcnt lgkmcnt(6)
v_or_b32 v234, v196, v197
v_rcp_f16_sdwa v207, v206 dst_sel:WORD_1 dst_unused:UNUSED_PRESERVE src0_sel:WORD_1
v_or_b32 v235, v198, v199
s_waitcnt lgkmcnt(1)
v_or_b32 v236, v200, v201
s_waitcnt lgkmcnt(0)
v_or_b32 v237, v202, v203
v_pk_mul_f16 v238, v243, v242
v_pk_mul_f16 v239, v240, v207
s_setprio 3
v_mfma_f32_16x16x32_f16 v[48:51], v[224:227], v[232:235], v[48:51]
buffer_load_dwordx4 v[244:247], v252, s[4:7], s69 offen offset:64
ds_read_b128 v[44:47], v249 offset:44288
v_cvt_pkrtz_f16_f32 v193, v176, v177
v_cvt_pkrtz_f16_f32 v195, v178, v179
v_mfma_f32_16x16x32_f16 v[56:59], v[224:227], v[236:239], v[56:59]
v_cvt_pkrtz_f16_f32 v197, v180, v181
v_cvt_pkrtz_f16_f32 v199, v182, v183
v_mfma_f32_16x16x32_f16 v[52:55], v[228:231], v[232:235], v[52:55]
ds_read_b128 v[224:227], v248 offset:48128
v_cvt_pkrtz_f16_f32 v201, v184, v185
v_cvt_pk_f16_f32 v243, v186, v187
v_mfma_f32_16x16x32_f16 v[60:63], v[228:231], v[236:239], v[60:63]
v_cvt_pk_f16_f32 v240, v188, v189
v_cvt_pk_f16_f32 v205, v190, v191
v_mfma_f32_16x16x32_bf16 v[176:179], v[0:3], v[96:99], 0
ds_read_b128 v[228:231], v249 offset:45056
v_pk_fma_f16 v242, v243, v243, s48
v_and_b32 v193, s49, v193
v_mfma_f32_16x16x32_bf16 v[184:187], v[0:3], v[100:103], 0
v_pk_fma_f16 v207, v240, v240, s48
v_and_b32 v195, s49, v195
v_mfma_f32_16x16x32_f16 v[64:67], v[4:7], v[232:235], v[64:67]
ds_read_b128 v[0:3], v249 offset:45312
v_pk_fma_f16 v204, v205, v205, s48
v_lshrrev_b16 v192, 2, v193
v_pk_mul_f16 v242, v243, v242
v_mfma_f32_16x16x32_f16 v[72:75], v[4:7], v[236:239], v[72:75]
v_lshrrev_b16 v194, 2, v195
v_pk_mul_f16 v207, v240, v207
s_waitcnt vmcnt(7)
v_mfma_f32_16x16x32_bf16 v[128:131], v[26:29], v[8:11], v[128:131]
ds_read_b128 v[4:7], v248 offset:48384
ds_read_u16_d16 v192, v192
ds_read_u16_d16 v194, v194
v_lshrrev_b32 v193, 18, v193
v_pk_mul_f16 v204, v205, v204
v_mfma_f32_16x16x32_bf16 v[132:135], v[24:27], v[8:11], v[132:135]
v_lshrrev_b32 v195, 18, v195
v_mfma_f32_16x16x32_bf16 v[180:183], v[40:43], v[96:99], 0
ds_read_u16_d16_hi v193, v193
ds_read_u16_d16_hi v195, v195
v_exp_f16 v241, v242
v_and_b32 v197, s49, v197
v_mfma_f32_16x16x32_bf16 v[188:191], v[40:43], v[100:103], 0
v_and_b32 v199, s49, v199
s_waitcnt lgkmcnt(6)
v_mfma_f32_16x16x32_f16 v[68:71], v[44:47], v[232:235], v[68:71]
ds_read_b128 v[40:43], v248 offset:49152
v_exp_f16 v206, v207
v_lshrrev_b16 v196, 2, v197
v_mfma_f32_16x16x32_f16 v[76:79], v[44:47], v[236:239], v[76:79]
v_lshrrev_b16 v198, 2, v199
v_exp_f16 v203, v204
v_mfma_f32_16x16x32_bf16 v[176:179], v[224:227], v[104:107], v[176:179]
buffer_store_dwordx4 v[140:143], v255, s[8:11], s68 offen offset:128 sc1
ds_read_b128 v[44:47], v248 offset:49408
ds_read_u16_d16 v196, v196
ds_read_u16_d16 v198, v198
v_lshrrev_b32 v197, 18, v197
v_lshrrev_b32 v199, 18, v199
v_mfma_f32_16x16x32_bf16 v[184:187], v[224:227], v[108:111], v[184:187]
v_exp_f16_sdwa v241, v242 dst_sel:WORD_1 dst_unused:UNUSED_PRESERVE src0_sel:WORD_1
v_mfma_f32_16x16x32_f16 v[80:83], v[228:231], v[232:235], v[80:83]
ds_read_b128 v[224:227], v249 offset:49152
ds_read_u16_d16_hi v197, v197
ds_read_u16_d16_hi v199, v199
v_and_b32 v201, s49, v201
v_lshrrev_b16 v200, 2, v201
v_mfma_f32_16x16x32_f16 v[168:171], v[228:231], v[236:239], v[168:171]
v_exp_f16_sdwa v206, v207 dst_sel:WORD_1 dst_unused:UNUSED_PRESERVE src0_sel:WORD_1
s_waitcnt lgkmcnt(7)
v_mfma_f32_16x16x32_f16 v[84:87], v[0:3], v[232:235], v[84:87]
ds_read_b128 v[228:231], v249 offset:49408
ds_read_u16_d16 v200, v200
v_lshrrev_b32 v201, 18, v201
v_mfma_f32_16x16x32_f16 v[172:175], v[0:3], v[236:239], v[172:175]
v_exp_f16_sdwa v203, v204 dst_sel:WORD_1 dst_unused:UNUSED_PRESERVE src0_sel:WORD_1
v_pk_add_f16 v241, v241, 1.0 op_sel_hi:[1,0]
v_pk_add_f16 v206, v206, 1.0 op_sel_hi:[1,0]
v_mfma_f32_16x16x32_bf16 v[180:183], v[4:7], v[104:107], v[180:183]
ds_read_b128 v[0:3], v248 offset:53248
ds_read_u16_d16_hi v201, v201
v_pk_add_f16 v203, v203, 1.0 op_sel_hi:[1,0]
v_mfma_f32_16x16x32_bf16 v[188:191], v[4:7], v[108:111], v[188:191]
v_rcp_f16 v242, v241
s_waitcnt lgkmcnt(7)
v_mfma_f32_16x16x32_bf16 v[176:179], v[40:43], v[112:115], v[176:179]
ds_read_b128 v[4:7], v249 offset:50176
v_rcp_f16 v207, v206
v_mfma_f32_16x16x32_bf16 v[184:187], v[40:43], v[116:119], v[184:187]
v_rcp_f16 v204, v203
v_mfma_f32_16x16x32_bf16 v[180:183], v[44:47], v[112:115], v[180:183]
ds_read_b128 v[40:43], v248 offset:53504
v_rcp_f16_sdwa v242, v241 dst_sel:WORD_1 dst_unused:UNUSED_PRESERVE src0_sel:WORD_1
v_mfma_f32_16x16x32_bf16 v[188:191], v[44:47], v[116:119], v[188:191]
v_rcp_f16_sdwa v207, v206 dst_sel:WORD_1 dst_unused:UNUSED_PRESERVE src0_sel:WORD_1
v_or_b32 v232, v192, v193
v_or_b32 v233, v194, v195
s_waitcnt lgkmcnt(4)
v_or_b32 v234, v196, v197
v_rcp_f16_sdwa v204, v203 dst_sel:WORD_1 dst_unused:UNUSED_PRESERVE src0_sel:WORD_1
v_or_b32 v235, v198, v199
s_waitcnt lgkmcnt(2)
v_or_b32 v236, v200, v201
v_pk_mul_f16 v237, v243, v242
v_pk_mul_f16 v238, v240, v207
v_pk_mul_f16 v239, v205, v204
v_mfma_f32_16x16x32_f16 v[48:51], v[224:227], v[232:235], v[48:51]
buffer_load_dwordx4 v[8:11], v252, s[4:7], s69 offen offset:128
ds_read_b128 v[44:47], v249 offset:50432
v_cvt_pkrtz_f16_f32 v193, v176, v177
v_cvt_pkrtz_f16_f32 v195, v178, v179
v_mfma_f32_16x16x32_f16 v[56:59], v[224:227], v[236:239], v[56:59]
v_cvt_pkrtz_f16_f32 v197, v180, v181
v_cvt_pkrtz_f16_f32 v199, v182, v183
v_mfma_f32_16x16x32_f16 v[52:55], v[228:231], v[232:235], v[52:55]
ds_read_b128 v[224:227], v248 offset:54272
v_cvt_pkrtz_f16_f32 v201, v184, v185
v_cvt_pk_f16_f32 v243, v186, v187
v_mfma_f32_16x16x32_f16 v[60:63], v[228:231], v[236:239], v[60:63]
v_cvt_pk_f16_f32 v240, v188, v189
v_cvt_pk_f16_f32 v205, v190, v191
v_mfma_f32_16x16x32_bf16 v[176:179], v[0:3], v[96:99], 0
ds_read_b128 v[228:231], v249 offset:51200
v_pk_fma_f16 v242, v243, v243, s48
v_and_b32 v193, s49, v193
v_mfma_f32_16x16x32_bf16 v[184:187], v[0:3], v[100:103], 0
v_pk_fma_f16 v207, v240, v240, s48
v_and_b32 v195, s49, v195
s_waitcnt lgkmcnt(3)
v_mfma_f32_16x16x32_f16 v[64:67], v[4:7], v[232:235], v[64:67]
ds_read_b128 v[0:3], v249 offset:51456
v_pk_fma_f16 v204, v205, v205, s48
s_setprio 2
v_lshrrev_b16 v192, 2, v193
v_pk_mul_f16 v242, v243, v242
v_mfma_f32_16x16x32_f16 v[72:75], v[4:7], v[236:239], v[72:75]
v_lshrrev_b16 v194, 2, v195
v_pk_mul_f16 v207, v240, v207
s_waitcnt vmcnt(7)
v_mfma_f32_16x16x32_bf16 v[144:147], v[26:29], v[36:39], v[144:147]
ds_read_b128 v[4:7], v248 offset:54528
ds_read_u16_d16 v192, v192
ds_read_u16_d16 v194, v194
v_lshrrev_b32 v193, 18, v193
v_pk_mul_f16 v204, v205, v204
v_mfma_f32_16x16x32_bf16 v[148:151], v[24:27], v[36:39], v[148:151]
v_lshrrev_b32 v195, 18, v195
v_mfma_f32_16x16x32_bf16 v[180:183], v[40:43], v[96:99], 0
ds_read_u16_d16_hi v193, v193
ds_read_u16_d16_hi v195, v195
v_exp_f16 v241, v242
v_and_b32 v197, s49, v197
v_mfma_f32_16x16x32_bf16 v[188:191], v[40:43], v[100:103], 0
v_and_b32 v199, s49, v199
s_waitcnt lgkmcnt(6)
v_mfma_f32_16x16x32_f16 v[68:71], v[44:47], v[232:235], v[68:71]
ds_read_b128 v[40:43], v248 offset:55296
v_exp_f16 v206, v207
v_lshrrev_b16 v196, 2, v197
v_mfma_f32_16x16x32_f16 v[76:79], v[44:47], v[236:239], v[76:79]
v_lshrrev_b16 v198, 2, v199
v_exp_f16 v203, v204
v_mfma_f32_16x16x32_bf16 v[176:179], v[224:227], v[104:107], v[176:179]
ds_read_b128 v[44:47], v248 offset:55552
ds_read_u16_d16 v196, v196
ds_read_u16_d16 v198, v198
v_lshrrev_b32 v197, 18, v197
v_lshrrev_b32 v199, 18, v199
v_mfma_f32_16x16x32_bf16 v[184:187], v[224:227], v[108:111], v[184:187]
v_exp_f16_sdwa v241, v242 dst_sel:WORD_1 dst_unused:UNUSED_PRESERVE src0_sel:WORD_1
v_mfma_f32_16x16x32_f16 v[80:83], v[228:231], v[232:235], v[80:83]
ds_read_b128 v[224:227], v249 offset:55296
ds_read_u16_d16_hi v197, v197
ds_read_u16_d16_hi v199, v199
v_and_b32 v201, s49, v201
v_lshrrev_b16 v200, 2, v201
v_mfma_f32_16x16x32_f16 v[168:171], v[228:231], v[236:239], v[168:171]
v_exp_f16_sdwa v206, v207 dst_sel:WORD_1 dst_unused:UNUSED_PRESERVE src0_sel:WORD_1
s_waitcnt lgkmcnt(7)
v_mfma_f32_16x16x32_f16 v[84:87], v[0:3], v[232:235], v[84:87]
ds_read_b128 v[228:231], v249 offset:55552
ds_read_u16_d16 v200, v200
v_lshrrev_b32 v201, 18, v201
v_mfma_f32_16x16x32_f16 v[172:175], v[0:3], v[236:239], v[172:175]
v_exp_f16_sdwa v203, v204 dst_sel:WORD_1 dst_unused:UNUSED_PRESERVE src0_sel:WORD_1
v_pk_add_f16 v241, v241, 1.0 op_sel_hi:[1,0]
v_pk_add_f16 v206, v206, 1.0 op_sel_hi:[1,0]
v_mfma_f32_16x16x32_bf16 v[180:183], v[4:7], v[104:107], v[180:183]
ds_read_b128 v[0:3], v248 offset:59392
ds_read_u16_d16_hi v201, v201
v_pk_add_f16 v203, v203, 1.0 op_sel_hi:[1,0]
v_mfma_f32_16x16x32_bf16 v[188:191], v[4:7], v[108:111], v[188:191]
v_rcp_f16 v242, v241
s_waitcnt lgkmcnt(7)
v_mfma_f32_16x16x32_bf16 v[176:179], v[40:43], v[112:115], v[176:179]
ds_read_b128 v[4:7], v249 offset:56320
v_rcp_f16 v207, v206
v_mfma_f32_16x16x32_bf16 v[184:187], v[40:43], v[116:119], v[184:187]
v_rcp_f16 v204, v203
v_mfma_f32_16x16x32_bf16 v[180:183], v[44:47], v[112:115], v[180:183]
ds_read_b128 v[40:43], v248 offset:59648
v_rcp_f16_sdwa v242, v241 dst_sel:WORD_1 dst_unused:UNUSED_PRESERVE src0_sel:WORD_1
v_mfma_f32_16x16x32_bf16 v[188:191], v[44:47], v[116:119], v[188:191]
v_rcp_f16_sdwa v207, v206 dst_sel:WORD_1 dst_unused:UNUSED_PRESERVE src0_sel:WORD_1
v_or_b32 v232, v192, v193
v_or_b32 v233, v194, v195
s_waitcnt lgkmcnt(4)
v_or_b32 v234, v196, v197
v_rcp_f16_sdwa v204, v203 dst_sel:WORD_1 dst_unused:UNUSED_PRESERVE src0_sel:WORD_1
v_or_b32 v235, v198, v199
s_waitcnt lgkmcnt(2)
v_or_b32 v236, v200, v201
v_pk_mul_f16 v237, v243, v242
v_pk_mul_f16 v238, v240, v207
v_pk_mul_f16 v239, v205, v204
v_mfma_f32_16x16x32_f16 v[48:51], v[224:227], v[232:235], v[48:51]
s_add_u32 s46, s69, 98304
buffer_load_dwordx4 v[36:39], v252, s[4:7], s46 offen
ds_read_b128 v[44:47], v249 offset:56576
v_cvt_pkrtz_f16_f32 v193, v176, v177
v_cvt_pkrtz_f16_f32 v195, v178, v179
v_mfma_f32_16x16x32_f16 v[56:59], v[224:227], v[236:239], v[56:59]
v_cvt_pkrtz_f16_f32 v197, v180, v181
v_cvt_pkrtz_f16_f32 v199, v182, v183
v_mfma_f32_16x16x32_f16 v[52:55], v[228:231], v[232:235], v[52:55]
ds_read_b128 v[224:227], v248 offset:60416
v_cvt_pkrtz_f16_f32 v201, v184, v185
v_cvt_pk_f16_f32 v243, v186, v187
v_cvt_pk_f16_f32 v240, v188, v189
v_mfma_f32_16x16x32_f16 v[60:63], v[228:231], v[236:239], v[60:63]
v_cvt_pk_f16_f32 v205, v190, v191
s_setprio 1
v_pk_fma_f16 v242, v243, v243, s48
v_mfma_f32_16x16x32_bf16 v[176:179], v[0:3], v[96:99], 0
ds_read_b128 v[228:231], v249 offset:57344
v_and_b32 v193, s49, v193
v_pk_fma_f16 v207, v240, v240, s48
v_mfma_f32_16x16x32_bf16 v[184:187], v[0:3], v[100:103], 0
v_and_b32 v195, s49, v195
v_pk_fma_f16 v204, v205, v205, s48
v_lshrrev_b16 v192, 2, v193
s_waitcnt lgkmcnt(3)
v_mfma_f32_16x16x32_f16 v[64:67], v[4:7], v[232:235], v[64:67]
ds_read_b128 v[0:3], v249 offset:57600
ds_read_u16_d16 v192, v192
v_pk_mul_f16 v242, v243, v242
v_lshrrev_b16 v194, 2, v195
v_mfma_f32_16x16x32_f16 v[72:75], v[4:7], v[236:239], v[72:75]
v_pk_mul_f16 v207, v240, v207
v_lshrrev_b32 v193, 18, v193
v_mfma_f32_16x16x32_bf16 v[180:183], v[40:43], v[96:99], 0
ds_read_b128 v[4:7], v248 offset:60672
ds_read_u16_d16 v194, v194
ds_read_u16_d16_hi v193, v193
v_pk_mul_f16 v204, v205, v204
v_lshrrev_b32 v195, 18, v195
v_mfma_f32_16x16x32_bf16 v[188:191], v[40:43], v[100:103], 0
v_exp_f16 v241, v242
v_and_b32 v197, s49, v197
s_waitcnt lgkmcnt(5)
v_mfma_f32_16x16x32_f16 v[68:71], v[44:47], v[232:235], v[68:71]
ds_read_b128 v[40:43], v248 offset:61440
ds_read_u16_d16_hi v195, v195
v_and_b32 v199, s49, v199
v_mfma_f32_16x16x32_f16 v[76:79], v[44:47], v[236:239], v[76:79]
v_exp_f16 v206, v207
v_lshrrev_b16 v196, 2, v197
v_lshrrev_b16 v198, 2, v199
v_mfma_f32_16x16x32_bf16 v[176:179], v[224:227], v[104:107], v[176:179]
buffer_store_dwordx4 v[152:155], v255, s[8:11], s68 offen offset:256 sc1
ds_read_b128 v[44:47], v248 offset:61696
ds_read_u16_d16 v196, v196
ds_read_u16_d16 v198, v198
v_exp_f16 v203, v204
v_mfma_f32_16x16x32_bf16 v[184:187], v[224:227], v[108:111], v[184:187]
v_lshrrev_b32 v197, 18, v197
v_lshrrev_b32 v199, 18, v199
v_mfma_f32_16x16x32_f16 v[80:83], v[228:231], v[232:235], v[80:83]
ds_read_b128 v[224:227], v249 offset:61440
ds_read_u16_d16_hi v197, v197
ds_read_u16_d16_hi v199, v199
v_exp_f16_sdwa v241, v242 dst_sel:WORD_1 dst_unused:UNUSED_PRESERVE src0_sel:WORD_1
v_and_b32 v201, s49, v201
v_mfma_f32_16x16x32_f16 v[168:171], v[228:231], v[236:239], v[168:171]
v_lshrrev_b16 v200, 2, v201
s_waitcnt lgkmcnt(8)
v_mfma_f32_16x16x32_f16 v[84:87], v[0:3], v[232:235], v[84:87]
ds_read_b128 v[228:231], v249 offset:61696
ds_read_u16_d16 v200, v200
v_exp_f16_sdwa v206, v207 dst_sel:WORD_1 dst_unused:UNUSED_PRESERVE src0_sel:WORD_1
v_lshrrev_b32 v201, 18, v201
v_mfma_f32_16x16x32_f16 v[172:175], v[0:3], v[236:239], v[172:175]
v_exp_f16_sdwa v203, v204 dst_sel:WORD_1 dst_unused:UNUSED_PRESERVE src0_sel:WORD_1
v_pk_add_f16 v241, v241, 1.0 op_sel_hi:[1,0]
v_mfma_f32_16x16x32_bf16 v[180:183], v[4:7], v[104:107], v[180:183]
ds_read_b128 v[0:3], v249
ds_read_u16_d16_hi v201, v201
v_pk_add_f16 v206, v206, 1.0 op_sel_hi:[1,0]
v_pk_add_f16 v203, v203, 1.0 op_sel_hi:[1,0]
v_mfma_f32_16x16x32_bf16 v[188:191], v[4:7], v[108:111], v[188:191]
v_rcp_f16 v242, v241
s_setprio 0
s_waitcnt lgkmcnt(7)
v_mfma_f32_16x16x32_bf16 v[176:179], v[40:43], v[112:115], v[176:179]
ds_read_b128 v[4:7], v249 offset:62464
v_rcp_f16 v207, v206
v_mfma_f32_16x16x32_bf16 v[184:187], v[40:43], v[116:119], v[184:187]
v_rcp_f16 v204, v203
v_mfma_f32_16x16x32_bf16 v[180:183], v[44:47], v[112:115], v[180:183]
ds_read_b128 v[40:43], v249 offset:256
v_rcp_f16_sdwa v242, v241 dst_sel:WORD_1 dst_unused:UNUSED_PRESERVE src0_sel:WORD_1
v_mfma_f32_16x16x32_bf16 v[188:191], v[44:47], v[116:119], v[188:191]
v_rcp_f16_sdwa v207, v206 dst_sel:WORD_1 dst_unused:UNUSED_PRESERVE src0_sel:WORD_1
v_or_b32 v232, v192, v193
v_or_b32 v233, v194, v195
s_waitcnt lgkmcnt(4)
v_or_b32 v234, v196, v197
v_rcp_f16_sdwa v204, v203 dst_sel:WORD_1 dst_unused:UNUSED_PRESERVE src0_sel:WORD_1
v_or_b32 v235, v198, v199
s_waitcnt lgkmcnt(2)
v_or_b32 v236, v200, v201
v_pk_mul_f16 v237, v243, v242
v_pk_mul_f16 v238, v240, v207
v_pk_mul_f16 v239, v205, v204
v_mfma_f32_16x16x32_f16 v[48:51], v[224:227], v[232:235], v[48:51]
s_add_u32 s46, s69, 98304
buffer_load_dwordx4 v[32:35], v252, s[4:7], s46 offen offset:64
ds_read_b128 v[44:47], v249 offset:62720
v_cvt_pkrtz_f16_f32 v193, v176, v177
v_cvt_pkrtz_f16_f32 v195, v178, v179
v_mfma_f32_16x16x32_f16 v[56:59], v[224:227], v[236:239], v[56:59]
v_cvt_pkrtz_f16_f32 v197, v180, v181
v_cvt_pkrtz_f16_f32 v199, v182, v183
v_mfma_f32_16x16x32_f16 v[52:55], v[228:231], v[232:235], v[52:55]
ds_read_b128 v[224:227], v249 offset:1024
v_cvt_pkrtz_f16_f32 v201, v184, v185
v_cvt_pk_f16_f32 v243, v186, v187
v_mfma_f32_16x16x32_f16 v[60:63], v[228:231], v[236:239], v[60:63]
v_cvt_pk_f16_f32 v240, v188, v189
v_cvt_pk_f16_f32 v205, v190, v191
v_mfma_f32_16x16x32_bf16 v[176:179], v[0:3], v[96:99], 0
ds_read_b128 v[228:231], v249 offset:63488
v_pk_fma_f16 v242, v243, v243, s48
v_and_b32 v193, s49, v193
v_mfma_f32_16x16x32_bf16 v[184:187], v[0:3], v[100:103], 0
v_pk_fma_f16 v207, v240, v240, s48
v_and_b32 v195, s49, v195
s_waitcnt lgkmcnt(3)
v_mfma_f32_16x16x32_f16 v[64:67], v[4:7], v[232:235], v[64:67]
ds_read_b128 v[0:3], v249 offset:63744
v_pk_fma_f16 v204, v205, v205, s48
v_lshrrev_b16 v192, 2, v193
v_mfma_f32_16x16x32_f16 v[72:75], v[4:7], v[236:239], v[72:75]
v_pk_mul_f16 v242, v243, v242
v_lshrrev_b16 v194, 2, v195
s_waitcnt vmcnt(8)
v_mfma_f32_16x16x32_bf16 v[160:163], v[26:29], v[216:219], v[160:163]
ds_read_b128 v[4:7], v249 offset:1280
ds_read_u16_d16 v192, v192
ds_read_u16_d16 v194, v194
v_pk_mul_f16 v207, v240, v207
v_lshrrev_b32 v193, 18, v193
v_mfma_f32_16x16x32_bf16 v[164:167], v[24:27], v[216:219], v[164:167]
v_pk_mul_f16 v204, v205, v204
v_lshrrev_b32 v195, 18, v195
v_mfma_f32_16x16x32_bf16 v[180:183], v[40:43], v[96:99], 0
ds_read_u16_d16_hi v193, v193
ds_read_u16_d16_hi v195, v195
v_exp_f16 v241, v242
v_mfma_f32_16x16x32_bf16 v[188:191], v[40:43], v[100:103], 0
v_and_b32 v197, s49, v197
v_and_b32 v199, s49, v199
s_waitcnt lgkmcnt(6)
v_mfma_f32_16x16x32_f16 v[68:71], v[44:47], v[232:235], v[68:71]
ds_read_b128 v[40:43], v249 offset:2048
v_exp_f16 v206, v207
v_mfma_f32_16x16x32_f16 v[76:79], v[44:47], v[236:239], v[76:79]
v_lshrrev_b16 v196, 2, v197
v_lshrrev_b16 v198, 2, v199
v_mfma_f32_16x16x32_bf16 v[176:179], v[224:227], v[104:107], v[176:179]
ds_read_b128 v[44:47], v249 offset:2304
ds_read_u16_d16 v196, v196
ds_read_u16_d16 v198, v198
v_exp_f16 v203, v204
v_mfma_f32_16x16x32_bf16 v[184:187], v[224:227], v[108:111], v[184:187]
v_lshrrev_b32 v197, 18, v197
v_lshrrev_b32 v199, 18, v199
v_mfma_f32_16x16x32_f16 v[80:83], v[228:231], v[232:235], v[80:83]
ds_read_b128 v[224:227], v250 offset:2048
ds_read_u16_d16_hi v197, v197
ds_read_u16_d16_hi v199, v199
v_exp_f16_sdwa v241, v242 dst_sel:WORD_1 dst_unused:UNUSED_PRESERVE src0_sel:WORD_1
v_mfma_f32_16x16x32_f16 v[168:171], v[228:231], v[236:239], v[168:171]
v_and_b32 v201, s49, v201
v_lshrrev_b16 v200, 2, v201
s_waitcnt lgkmcnt(7)
v_mfma_f32_16x16x32_f16 v[84:87], v[0:3], v[232:235], v[84:87]
ds_read_b128 v[228:231], v250 offset:2304
ds_read_u16_d16 v200, v200
v_exp_f16_sdwa v206, v207 dst_sel:WORD_1 dst_unused:UNUSED_PRESERVE src0_sel:WORD_1
v_mfma_f32_16x16x32_f16 v[172:175], v[0:3], v[236:239], v[172:175]
v_lshrrev_b32 v201, 18, v201
s_waitcnt vmcnt(7)
v_mfma_f32_16x16x32_bf16 v[48:51], v[26:29], v[12:15], v[48:51]
ds_read_b128 v[0:3], v249 offset:6144
ds_read_u16_d16_hi v201, v201
v_exp_f16_sdwa v203, v204 dst_sel:WORD_1 dst_unused:UNUSED_PRESERVE src0_sel:WORD_1
v_pk_add_f16 v241, v241, 1.0 op_sel_hi:[1,0]
v_mfma_f32_16x16x32_bf16 v[52:55], v[24:27], v[12:15], v[52:55]
v_pk_add_f16 v206, v206, 1.0 op_sel_hi:[1,0]
v_pk_add_f16 v203, v203, 1.0 op_sel_hi:[1,0]
v_mfma_f32_16x16x32_bf16 v[180:183], v[4:7], v[104:107], v[180:183]
v_rcp_f16 v242, v241
v_mfma_f32_16x16x32_bf16 v[188:191], v[4:7], v[108:111], v[188:191]
v_rcp_f16 v207, v206
s_waitcnt lgkmcnt(4)
v_mfma_f32_16x16x32_bf16 v[176:179], v[40:43], v[112:115], v[176:179]
ds_read_b128 v[4:7], v250 offset:3072
v_rcp_f16 v204, v203
v_mfma_f32_16x16x32_bf16 v[184:187], v[40:43], v[116:119], v[184:187]
v_rcp_f16_sdwa v242, v241 dst_sel:WORD_1 dst_unused:UNUSED_PRESERVE src0_sel:WORD_1
v_mfma_f32_16x16x32_bf16 v[180:183], v[44:47], v[112:115], v[180:183]
ds_read_b128 v[40:43], v249 offset:6400
v_rcp_f16_sdwa v207, v206 dst_sel:WORD_1 dst_unused:UNUSED_PRESERVE src0_sel:WORD_1
v_mfma_f32_16x16x32_bf16 v[188:191], v[44:47], v[116:119], v[188:191]
v_or_b32 v232, v192, v193
v_or_b32 v233, v194, v195
v_or_b32 v234, v196, v197
v_rcp_f16_sdwa v204, v203 dst_sel:WORD_1 dst_unused:UNUSED_PRESERVE src0_sel:WORD_1
v_or_b32 v235, v198, v199
s_waitcnt lgkmcnt(2)
v_or_b32 v236, v200, v201
v_pk_mul_f16 v237, v243, v242
v_pk_mul_f16 v238, v240, v207
v_pk_mul_f16 v239, v205, v204
v_mfma_f32_16x16x32_f16 v[48:51], v[224:227], v[232:235], v[48:51]
s_add_u32 s46, s69, 98304
buffer_load_dwordx4 v[216:219], v252, s[4:7], s46 offen offset:128
ds_read_b128 v[44:47], v250 offset:3328
v_cvt_pkrtz_f16_f32 v193, v176, v177
v_cvt_pkrtz_f16_f32 v195, v178, v179
v_mfma_f32_16x16x32_f16 v[56:59], v[224:227], v[236:239], v[56:59]
v_cvt_pkrtz_f16_f32 v197, v180, v181
v_cvt_pkrtz_f16_f32 v199, v182, v183
v_cvt_pkrtz_f16_f32 v201, v184, v185
v_mfma_f32_16x16x32_f16 v[52:55], v[228:231], v[232:235], v[52:55]
ds_read_b128 v[224:227], v249 offset:7168
v_cvt_pkrtz_f16_f32 v203, v186, v187
v_cvt_pk_f16_f32 v243, v188, v189
v_cvt_pk_f16_f32 v240, v190, v191
v_mfma_f32_16x16x32_f16 v[60:63], v[228:231], v[236:239], v[60:63]
v_pk_fma_f16 v242, v243, v243, s48
v_cvt_pk_bf16_f32 v144, v144, v145
v_and_b32 v193, s49, v193
v_mfma_f32_16x16x32_bf16 v[176:179], v[0:3], v[96:99], 0
ds_read_b128 v[228:231], v250 offset:4096
v_cvt_pk_bf16_f32 v145, v146, v147
v_and_b32 v195, s49, v195
v_mfma_f32_16x16x32_bf16 v[184:187], v[0:3], v[100:103], 0
v_cvt_pk_bf16_f32 v146, v148, v149
v_pk_fma_f16 v207, v240, v240, s48
v_lshrrev_b16 v192, 2, v193
s_waitcnt lgkmcnt(3)
v_mfma_f32_16x16x32_f16 v[64:67], v[4:7], v[232:235], v[64:67]
ds_read_b128 v[0:3], v250 offset:4352
ds_read_u16_d16 v192, v192
v_cvt_pk_bf16_f32 v147, v150, v151
v_pk_mul_f16 v242, v243, v242
v_cvt_pk_bf16_f32 v128, v128, v129
v_mfma_f32_16x16x32_f16 v[72:75], v[4:7], v[236:239], v[72:75]
v_lshrrev_b16 v194, 2, v195
v_cvt_pk_bf16_f32 v129, v130, v131
v_pk_mul_f16 v207, v240, v207
s_waitcnt vmcnt(6)
v_mfma_f32_16x16x32_bf16 v[64:67], v[26:29], v[244:247], v[64:67]
ds_read_b128 v[4:7], v249 offset:7424
ds_read_u16_d16 v194, v194
v_lshrrev_b32 v193, 18, v193
v_cvt_pk_bf16_f32 v130, v132, v133
v_mfma_f32_16x16x32_bf16 v[68:71], v[24:27], v[244:247], v[68:71]
v_exp_f16 v241, v242
v_cvt_pk_bf16_f32 v131, v134, v135
v_mfma_f32_16x16x32_bf16 v[180:183], v[40:43], v[96:99], 0
ds_read_u16_d16_hi v193, v193
v_lshrrev_b32 v195, 18, v195
v_cvt_pk_bf16_f32 v160, v160, v161
v_and_b32 v197, s49, v197
v_mfma_f32_16x16x32_bf16 v[188:191], v[40:43], v[100:103], 0
v_cvt_pk_bf16_f32 v161, v162, v163
v_exp_f16 v206, v207
s_waitcnt lgkmcnt(3)
v_mfma_f32_16x16x32_f16 v[68:71], v[44:47], v[232:235], v[68:71]
ds_read_b128 v[40:43], v249 offset:8192
ds_read_u16_d16_hi v195, v195
v_cvt_pk_bf16_f32 v162, v164, v165
v_and_b32 v199, s49, v199
v_mfma_f32_16x16x32_f16 v[76:79], v[44:47], v[236:239], v[76:79]
v_cvt_pk_bf16_f32 v163, v166, v167
s_mov_b64 vcc, s[74:75]
v_lshrrev_b16 v196, 2, v197
v_cndmask_b32_e64 v148, v128, v160, s[74:75]
v_mfma_f32_16x16x32_bf16 v[176:179], v[224:227], v[104:107], v[176:179]
ds_read_b128 v[44:47], v249 offset:8448
ds_read_u16_d16 v196, v196
v_exp_f16_sdwa v241, v242 dst_sel:WORD_1 dst_unused:UNUSED_PRESERVE src0_sel:WORD_1
v_cndmask_b32_dpp v128, v144, v128, vcc quad_perm:[1,0,3,2] row_mask:0xf bank_mask:0xf
v_mfma_f32_16x16x32_bf16 v[184:187], v[224:227], v[108:111], v[184:187]
v_lshrrev_b16 v198, 2, v199
v_cndmask_b32_e64 v149, v129, v161, s[74:75]
v_lshrrev_b32 v197, 18, v197
v_mfma_f32_16x16x32_f16 v[80:83], v[228:231], v[232:235], v[80:83]
ds_read_b128 v[224:227], v250 offset:8192
ds_read_u16_d16 v198, v198
ds_read_u16_d16_hi v197, v197
v_cndmask_b32_dpp v129, v145, v129, vcc quad_perm:[1,0,3,2] row_mask:0xf bank_mask:0xf
v_lshrrev_b32 v199, 18, v199
v_mfma_f32_16x16x32_f16 v[168:171], v[228:231], v[236:239], v[168:171]
v_exp_f16_sdwa v206, v207 dst_sel:WORD_1 dst_unused:UNUSED_PRESERVE src0_sel:WORD_1
v_cndmask_b32_e64 v150, v130, v162, s[74:75]
v_mfma_f32_16x16x32_f16 v[84:87], v[0:3], v[232:235], v[84:87]
ds_read_b128 v[228:231], v250 offset:8448
ds_read_u16_d16_hi v199, v199
v_cndmask_b32_dpp v130, v146, v130, vcc quad_perm:[1,0,3,2] row_mask:0xf bank_mask:0xf
v_and_b32 v201, s49, v201
v_cndmask_b32_e64 v151, v131, v163, s[74:75]
v_mfma_f32_16x16x32_f16 v[172:175], v[0:3], v[236:239], v[172:175]
v_and_b32 v203, s49, v203
v_pk_add_f16 v241, v241, 1.0 op_sel_hi:[1,0]
v_cndmask_b32_dpp v131, v147, v131, vcc quad_perm:[1,0,3,2] row_mask:0xf bank_mask:0xf
s_not_b64 vcc, s[74:75]
s_waitcnt lgkmcnt(5)
v_mfma_f32_16x16x32_bf16 v[180:183], v[4:7], v[104:107], v[180:183]
ds_read_b128 v[0:3], v249 offset:12288
v_lshrrev_b16 v200, 2, v201
v_cndmask_b32_dpp v160, v144, v160, vcc quad_perm:[1,0,3,2] row_mask:0xf bank_mask:0xf
v_pk_add_f16 v206, v206, 1.0 op_sel_hi:[1,0]
v_mfma_f32_16x16x32_bf16 v[188:191], v[4:7], v[108:111], v[188:191]
v_cndmask_b32_dpp v161, v145, v161, vcc quad_perm:[1,0,3,2] row_mask:0xf bank_mask:0xf
v_lshrrev_b16 v202, 2, v203
v_mfma_f32_16x16x32_bf16 v[176:179], v[40:43], v[112:115], v[176:179]
ds_read_b128 v[4:7], v250 offset:9216
ds_read_u16_d16 v200, v200
ds_read_u16_d16 v202, v202
v_rcp_f16 v242, v241
v_cndmask_b32_dpp v162, v146, v162, vcc quad_perm:[1,0,3,2] row_mask:0xf bank_mask:0xf
v_mfma_f32_16x16x32_bf16 v[184:187], v[40:43], v[116:119], v[184:187]
v_cndmask_b32_dpp v163, v147, v163, vcc quad_perm:[1,0,3,2] row_mask:0xf bank_mask:0xf
v_lshrrev_b32 v201, 18, v201
v_lshrrev_b32 v203, 18, v203
v_mfma_f32_16x16x32_bf16 v[180:183], v[44:47], v[112:115], v[180:183]
ds_read_b128 v[40:43], v249 offset:12544
s_add_u32 s46, s68, 98304
buffer_store_dwordx4 v[128:131], v255, s[8:11], s46 offen sc1
ds_read_u16_d16_hi v201, v201
ds_read_u16_d16_hi v203, v203
v_rcp_f16 v207, v206
v_mfma_f32_16x16x32_bf16 v[188:191], v[44:47], v[116:119], v[188:191]
v_rcp_f16_sdwa v242, v241 dst_sel:WORD_1 dst_unused:UNUSED_PRESERVE src0_sel:WORD_1
v_or_b32 v232, v192, v193
v_or_b32 v233, v194, v195
s_waitcnt lgkmcnt(6)
v_or_b32 v234, v196, v197
v_rcp_f16_sdwa v207, v206 dst_sel:WORD_1 dst_unused:UNUSED_PRESERVE src0_sel:WORD_1
v_or_b32 v235, v198, v199
s_waitcnt lgkmcnt(1)
v_or_b32 v236, v200, v201
s_waitcnt lgkmcnt(0)
v_or_b32 v237, v202, v203
v_pk_mul_f16 v238, v243, v242
v_pk_mul_f16 v239, v240, v207
v_mfma_f32_16x16x32_f16 v[48:51], v[224:227], v[232:235], v[48:51]
s_add_u32 s46, s68, 98304
buffer_store_dwordx4 v[148:151], v255, s[8:11], s46 offen offset:128 sc1
ds_read_b128 v[44:47], v250 offset:9472
v_cvt_pkrtz_f16_f32 v193, v176, v177
v_cvt_pkrtz_f16_f32 v195, v178, v179
v_mfma_f32_16x16x32_f16 v[56:59], v[224:227], v[236:239], v[56:59]
v_cvt_pkrtz_f16_f32 v197, v180, v181
v_cvt_pkrtz_f16_f32 v199, v182, v183
v_mfma_f32_16x16x32_f16 v[52:55], v[228:231], v[232:235], v[52:55]
ds_read_b128 v[224:227], v249 offset:13312
v_cvt_pkrtz_f16_f32 v201, v184, v185
v_cvt_pk_f16_f32 v243, v186, v187
v_mfma_f32_16x16x32_f16 v[60:63], v[228:231], v[236:239], v[60:63]
v_cvt_pk_f16_f32 v240, v188, v189
v_cvt_pk_f16_f32 v205, v190, v191
v_mfma_f32_16x16x32_bf16 v[176:179], v[0:3], v[96:99], 0
ds_read_b128 v[228:231], v250 offset:10240
v_pk_fma_f16 v242, v243, v243, s48
v_and_b32 v193, s49, v193
v_mfma_f32_16x16x32_bf16 v[184:187], v[0:3], v[100:103], 0
v_pk_fma_f16 v207, v240, v240, s48
v_and_b32 v195, s49, v195
v_mfma_f32_16x16x32_f16 v[64:67], v[4:7], v[232:235], v[64:67]
ds_read_b128 v[0:3], v250 offset:10496
v_pk_fma_f16 v204, v205, v205, s48
v_lshrrev_b16 v192, 2, v193
v_pk_mul_f16 v242, v243, v242
v_mfma_f32_16x16x32_f16 v[72:75], v[4:7], v[236:239], v[72:75]
v_lshrrev_b16 v194, 2, v195
v_pk_mul_f16 v207, v240, v207
s_waitcnt vmcnt(6)
v_mfma_f32_16x16x32_bf16 v[80:83], v[26:29], v[8:11], v[80:83]
ds_read_b128 v[4:7], v249 offset:13568
ds_read_u16_d16 v192, v192
ds_read_u16_d16 v194, v194
v_lshrrev_b32 v193, 18, v193
v_pk_mul_f16 v204, v205, v204
v_mfma_f32_16x16x32_bf16 v[84:87], v[24:27], v[8:11], v[84:87]
v_lshrrev_b32 v195, 18, v195
v_mfma_f32_16x16x32_bf16 v[180:183], v[40:43], v[96:99], 0
ds_read_u16_d16_hi v193, v193
ds_read_u16_d16_hi v195, v195
v_exp_f16 v241, v242
v_and_b32 v197, s49, v197
v_mfma_f32_16x16x32_bf16 v[188:191], v[40:43], v[100:103], 0
v_and_b32 v199, s49, v199
s_waitcnt lgkmcnt(6)
v_mfma_f32_16x16x32_f16 v[68:71], v[44:47], v[232:235], v[68:71]
ds_read_b128 v[40:43], v249 offset:14336
v_exp_f16 v206, v207
v_lshrrev_b16 v196, 2, v197
v_mfma_f32_16x16x32_f16 v[76:79], v[44:47], v[236:239], v[76:79]
v_lshrrev_b16 v198, 2, v199
v_exp_f16 v203, v204
v_mfma_f32_16x16x32_bf16 v[176:179], v[224:227], v[104:107], v[176:179]
ds_read_b128 v[44:47], v249 offset:14592
ds_read_u16_d16 v196, v196
ds_read_u16_d16 v198, v198
v_lshrrev_b32 v197, 18, v197
v_lshrrev_b32 v199, 18, v199
v_mfma_f32_16x16x32_bf16 v[184:187], v[224:227], v[108:111], v[184:187]
v_exp_f16_sdwa v241, v242 dst_sel:WORD_1 dst_unused:UNUSED_PRESERVE src0_sel:WORD_1
v_mfma_f32_16x16x32_f16 v[80:83], v[228:231], v[232:235], v[80:83]
ds_read_b128 v[224:227], v250 offset:14336
ds_read_u16_d16_hi v197, v197
ds_read_u16_d16_hi v199, v199
v_and_b32 v201, s49, v201
v_lshrrev_b16 v200, 2, v201
v_mfma_f32_16x16x32_f16 v[168:171], v[228:231], v[236:239], v[168:171]
v_exp_f16_sdwa v206, v207 dst_sel:WORD_1 dst_unused:UNUSED_PRESERVE src0_sel:WORD_1
s_waitcnt lgkmcnt(7)
v_mfma_f32_16x16x32_f16 v[84:87], v[0:3], v[232:235], v[84:87]
ds_read_b128 v[228:231], v250 offset:14592
ds_read_u16_d16 v200, v200
v_lshrrev_b32 v201, 18, v201
v_mfma_f32_16x16x32_f16 v[172:175], v[0:3], v[236:239], v[172:175]
v_exp_f16_sdwa v203, v204 dst_sel:WORD_1 dst_unused:UNUSED_PRESERVE src0_sel:WORD_1
v_pk_add_f16 v241, v241, 1.0 op_sel_hi:[1,0]
v_pk_add_f16 v206, v206, 1.0 op_sel_hi:[1,0]
v_mfma_f32_16x16x32_bf16 v[180:183], v[4:7], v[104:107], v[180:183]
ds_read_b128 v[0:3], v249 offset:18432
ds_read_u16_d16_hi v201, v201
v_pk_add_f16 v203, v203, 1.0 op_sel_hi:[1,0]
v_mfma_f32_16x16x32_bf16 v[188:191], v[4:7], v[108:111], v[188:191]
v_rcp_f16 v242, v241
s_waitcnt lgkmcnt(7)
v_mfma_f32_16x16x32_bf16 v[176:179], v[40:43], v[112:115], v[176:179]
ds_read_b128 v[4:7], v250 offset:15360
v_rcp_f16 v207, v206
v_mfma_f32_16x16x32_bf16 v[184:187], v[40:43], v[116:119], v[184:187]
v_rcp_f16 v204, v203
v_mfma_f32_16x16x32_bf16 v[180:183], v[44:47], v[112:115], v[180:183]
ds_read_b128 v[40:43], v249 offset:18688
v_rcp_f16_sdwa v242, v241 dst_sel:WORD_1 dst_unused:UNUSED_PRESERVE src0_sel:WORD_1
v_mfma_f32_16x16x32_bf16 v[188:191], v[44:47], v[116:119], v[188:191]
v_rcp_f16_sdwa v207, v206 dst_sel:WORD_1 dst_unused:UNUSED_PRESERVE src0_sel:WORD_1
v_or_b32 v232, v192, v193
v_or_b32 v233, v194, v195
s_waitcnt lgkmcnt(4)
v_or_b32 v234, v196, v197
v_rcp_f16_sdwa v204, v203 dst_sel:WORD_1 dst_unused:UNUSED_PRESERVE src0_sel:WORD_1
v_or_b32 v235, v198, v199
s_waitcnt lgkmcnt(2)
v_or_b32 v236, v200, v201
v_pk_mul_f16 v237, v243, v242
v_pk_mul_f16 v238, v240, v207
v_pk_mul_f16 v239, v205, v204
v_mfma_f32_16x16x32_f16 v[48:51], v[224:227], v[232:235], v[48:51]
ds_read_b128 v[44:47], v250 offset:15616
v_cvt_pkrtz_f16_f32 v193, v176, v177
v_cvt_pkrtz_f16_f32 v195, v178, v179
v_mfma_f32_16x16x32_f16 v[56:59], v[224:227], v[236:239], v[56:59]
v_cvt_pkrtz_f16_f32 v197, v180, v181
v_cvt_pkrtz_f16_f32 v199, v182, v183
v_mfma_f32_16x16x32_f16 v[52:55], v[228:231], v[232:235], v[52:55]
ds_read_b128 v[224:227], v249 offset:19456
v_cvt_pkrtz_f16_f32 v201, v184, v185
v_cvt_pk_f16_f32 v243, v186, v187
v_mfma_f32_16x16x32_f16 v[60:63], v[228:231], v[236:239], v[60:63]
v_cvt_pk_f16_f32 v240, v188, v189
v_cvt_pk_f16_f32 v205, v190, v191
v_mfma_f32_16x16x32_bf16 v[176:179], v[0:3], v[96:99], 0
ds_read_b128 v[228:231], v250 offset:16384
v_pk_fma_f16 v242, v243, v243, s48
v_and_b32 v193, s49, v193
v_mfma_f32_16x16x32_bf16 v[184:187], v[0:3], v[100:103], 0
v_pk_fma_f16 v207, v240, v240, s48
v_and_b32 v195, s49, v195
s_waitcnt lgkmcnt(3)
v_mfma_f32_16x16x32_f16 v[64:67], v[4:7], v[232:235], v[64:67]
ds_read_b128 v[0:3], v250 offset:16640
v_pk_fma_f16 v204, v205, v205, s48
v_lshrrev_b16 v192, 2, v193
v_pk_mul_f16 v242, v243, v242
v_mfma_f32_16x16x32_f16 v[72:75], v[4:7], v[236:239], v[72:75]
v_lshrrev_b16 v194, 2, v195
v_pk_mul_f16 v207, v240, v207
s_waitcnt vmcnt(5)
v_mfma_f32_16x16x32_bf16 v[56:59], v[26:29], v[36:39], v[56:59]
ds_read_b128 v[4:7], v249 offset:19712
ds_read_u16_d16 v192, v192
ds_read_u16_d16 v194, v194
v_lshrrev_b32 v193, 18, v193
v_pk_mul_f16 v204, v205, v204
v_mfma_f32_16x16x32_bf16 v[60:63], v[24:27], v[36:39], v[60:63]
v_lshrrev_b32 v195, 18, v195
v_mfma_f32_16x16x32_bf16 v[180:183], v[40:43], v[96:99], 0
ds_read_u16_d16_hi v193, v193
ds_read_u16_d16_hi v195, v195
v_exp_f16 v241, v242
v_and_b32 v197, s49, v197
v_mfma_f32_16x16x32_bf16 v[188:191], v[40:43], v[100:103], 0
v_and_b32 v199, s49, v199
s_waitcnt lgkmcnt(6)
v_mfma_f32_16x16x32_f16 v[68:71], v[44:47], v[232:235], v[68:71]
ds_read_b128 v[40:43], v249 offset:20480
v_exp_f16 v206, v207
v_lshrrev_b16 v196, 2, v197
v_mfma_f32_16x16x32_f16 v[76:79], v[44:47], v[236:239], v[76:79]
v_lshrrev_b16 v198, 2, v199
v_exp_f16 v203, v204
v_mfma_f32_16x16x32_bf16 v[176:179], v[224:227], v[104:107], v[176:179]
ds_read_b128 v[44:47], v249 offset:20736
ds_read_u16_d16 v196, v196
ds_read_u16_d16 v198, v198
v_lshrrev_b32 v197, 18, v197
v_lshrrev_b32 v199, 18, v199
v_mfma_f32_16x16x32_bf16 v[184:187], v[224:227], v[108:111], v[184:187]
v_exp_f16_sdwa v241, v242 dst_sel:WORD_1 dst_unused:UNUSED_PRESERVE src0_sel:WORD_1
v_mfma_f32_16x16x32_f16 v[80:83], v[228:231], v[232:235], v[80:83]
ds_read_b128 v[224:227], v250 offset:20480
ds_read_u16_d16_hi v197, v197
ds_read_u16_d16_hi v199, v199
v_and_b32 v201, s49, v201
v_lshrrev_b16 v200, 2, v201
v_mfma_f32_16x16x32_f16 v[168:171], v[228:231], v[236:239], v[168:171]
v_exp_f16_sdwa v206, v207 dst_sel:WORD_1 dst_unused:UNUSED_PRESERVE src0_sel:WORD_1
s_waitcnt lgkmcnt(7)
v_mfma_f32_16x16x32_f16 v[84:87], v[0:3], v[232:235], v[84:87]
ds_read_b128 v[228:231], v250 offset:20736
ds_read_u16_d16 v200, v200
v_lshrrev_b32 v201, 18, v201
v_mfma_f32_16x16x32_f16 v[172:175], v[0:3], v[236:239], v[172:175]
v_exp_f16_sdwa v203, v204 dst_sel:WORD_1 dst_unused:UNUSED_PRESERVE src0_sel:WORD_1
v_pk_add_f16 v241, v241, 1.0 op_sel_hi:[1,0]
v_pk_add_f16 v206, v206, 1.0 op_sel_hi:[1,0]
v_mfma_f32_16x16x32_bf16 v[180:183], v[4:7], v[104:107], v[180:183]
ds_read_b128 v[0:3], v250 offset:21504
ds_read_u16_d16_hi v201, v201
v_pk_add_f16 v203, v203, 1.0 op_sel_hi:[1,0]
v_mfma_f32_16x16x32_bf16 v[188:191], v[4:7], v[108:111], v[188:191]
v_rcp_f16 v242, v241
s_waitcnt lgkmcnt(7)
v_mfma_f32_16x16x32_bf16 v[176:179], v[40:43], v[112:115], v[176:179]
ds_read_b128 v[4:7], v250 offset:21760
v_rcp_f16 v207, v206
v_mfma_f32_16x16x32_bf16 v[184:187], v[40:43], v[116:119], v[184:187]
v_rcp_f16 v204, v203
v_mfma_f32_16x16x32_bf16 v[180:183], v[44:47], v[112:115], v[180:183]
ds_read_b128 v[40:43], v250 offset:22528
v_rcp_f16_sdwa v242, v241 dst_sel:WORD_1 dst_unused:UNUSED_PRESERVE src0_sel:WORD_1
v_mfma_f32_16x16x32_bf16 v[188:191], v[44:47], v[116:119], v[188:191]
v_rcp_f16_sdwa v207, v206 dst_sel:WORD_1 dst_unused:UNUSED_PRESERVE src0_sel:WORD_1
v_or_b32 v232, v192, v193
v_or_b32 v233, v194, v195
s_waitcnt lgkmcnt(4)
v_or_b32 v234, v196, v197
v_rcp_f16_sdwa v204, v203 dst_sel:WORD_1 dst_unused:UNUSED_PRESERVE src0_sel:WORD_1
v_or_b32 v235, v198, v199
s_waitcnt lgkmcnt(2)
v_or_b32 v236, v200, v201
v_pk_mul_f16 v237, v243, v242
v_pk_mul_f16 v238, v240, v207
v_pk_mul_f16 v239, v205, v204
v_mfma_f32_16x16x32_f16 v[48:51], v[224:227], v[232:235], v[48:51]
s_add_u32 s46, s68, 98304
buffer_store_dwordx4 v[160:163], v255, s[8:11], s46 offen offset:256 sc1
ds_read_b128 v[44:47], v250 offset:22784
v_cvt_pkrtz_f16_f32 v193, v176, v177
v_cvt_pkrtz_f16_f32 v195, v178, v179
v_cvt_pkrtz_f16_f32 v197, v180, v181
v_cvt_pkrtz_f16_f32 v199, v182, v183
v_mfma_f32_16x16x32_f16 v[56:59], v[224:227], v[236:239], v[56:59]
v_cvt_pkrtz_f16_f32 v201, v184, v185
v_cvt_pk_f16_f32 v243, v186, v187
v_cvt_pk_f16_f32 v240, v188, v189
v_cvt_pk_f16_f32 v205, v190, v191
v_mfma_f32_16x16x32_f16 v[52:55], v[228:231], v[232:235], v[52:55]
ds_read_b128 v[224:227], v250 offset:26624
v_pk_fma_f16 v242, v243, v243, s48
v_and_b32 v193, s49, v193
v_pk_fma_f16 v207, v240, v240, s48
v_and_b32 v195, s49, v195
v_mfma_f32_16x16x32_f16 v[60:63], v[228:231], v[236:239], v[60:63]
v_pk_fma_f16 v204, v205, v205, s48
v_lshrrev_b16 v192, 2, v193
v_pk_mul_f16 v242, v243, v242
v_lshrrev_b16 v194, 2, v195
v_mfma_f32_16x16x32_f16 v[64:67], v[0:3], v[232:235], v[64:67]
ds_read_b128 v[228:231], v250 offset:26880
ds_read_u16_d16 v192, v192
ds_read_u16_d16 v194, v194
v_pk_mul_f16 v207, v240, v207
v_lshrrev_b32 v193, 18, v193
v_pk_mul_f16 v204, v205, v204
v_lshrrev_b32 v195, 18, v195
v_mfma_f32_16x16x32_f16 v[72:75], v[0:3], v[236:239], v[72:75]
v_exp_f16 v241, v242
v_and_b32 v197, s49, v197
v_and_b32 v199, s49, v199
s_waitcnt vmcnt(4)
v_mfma_f32_16x16x32_bf16 v[72:75], v[26:29], v[32:35], v[72:75]
ds_read_b128 v[0:3], v250 offset:27648
ds_read_u16_d16_hi v193, v193
ds_read_u16_d16_hi v195, v195
v_exp_f16 v206, v207
v_lshrrev_b16 v196, 2, v197
v_lshrrev_b16 v198, 2, v199
v_mfma_f32_16x16x32_bf16 v[76:79], v[24:27], v[32:35], v[76:79]
v_exp_f16 v203, v204
v_lshrrev_b32 v197, 18, v197
v_lshrrev_b32 v199, 18, v199
s_waitcnt lgkmcnt(6)
v_mfma_f32_16x16x32_f16 v[68:71], v[4:7], v[232:235], v[68:71]
ds_read_u16_d16 v196, v196
ds_read_u16_d16 v198, v198
ds_read_u16_d16_hi v197, v197
ds_read_u16_d16_hi v199, v199
v_exp_f16_sdwa v241, v242 dst_sel:WORD_1 dst_unused:UNUSED_PRESERVE src0_sel:WORD_1
v_and_b32 v201, s49, v201
v_lshrrev_b16 v200, 2, v201
v_mfma_f32_16x16x32_f16 v[76:79], v[4:7], v[236:239], v[76:79]
v_exp_f16_sdwa v206, v207 dst_sel:WORD_1 dst_unused:UNUSED_PRESERVE src0_sel:WORD_1
v_lshrrev_b32 v201, 18, v201
v_mfma_f32_16x16x32_f16 v[80:83], v[40:43], v[232:235], v[80:83]
ds_read_b128 v[4:7], v250 offset:27904
ds_read_u16_d16 v200, v200
ds_read_u16_d16_hi v201, v201
v_exp_f16_sdwa v203, v204 dst_sel:WORD_1 dst_unused:UNUSED_PRESERVE src0_sel:WORD_1
v_pk_add_f16 v241, v241, 1.0 op_sel_hi:[1,0]
v_pk_add_f16 v206, v206, 1.0 op_sel_hi:[1,0]
v_pk_add_f16 v203, v203, 1.0 op_sel_hi:[1,0]
v_mfma_f32_16x16x32_f16 v[168:171], v[40:43], v[236:239], v[168:171]
v_rcp_f16 v242, v241
v_rcp_f16 v207, v206
v_mfma_f32_16x16x32_f16 v[84:87], v[44:47], v[232:235], v[84:87]
ds_read_b128 v[40:43], v250 offset:28672
v_rcp_f16 v204, v203
v_rcp_f16_sdwa v242, v241 dst_sel:WORD_1 dst_unused:UNUSED_PRESERVE src0_sel:WORD_1
v_mfma_f32_16x16x32_f16 v[172:175], v[44:47], v[236:239], v[172:175]
v_rcp_f16_sdwa v207, v206 dst_sel:WORD_1 dst_unused:UNUSED_PRESERVE src0_sel:WORD_1
s_waitcnt lgkmcnt(5)
v_or_b32 v232, v192, v193
v_or_b32 v233, v194, v195
v_or_b32 v234, v196, v197
v_rcp_f16_sdwa v204, v203 dst_sel:WORD_1 dst_unused:UNUSED_PRESERVE src0_sel:WORD_1
s_waitcnt lgkmcnt(4)
v_or_b32 v235, v198, v199
s_waitcnt lgkmcnt(1)
v_or_b32 v236, v200, v201
v_pk_mul_f16 v237, v243, v242
v_pk_mul_f16 v238, v240, v207
v_pk_mul_f16 v239, v205, v204
s_waitcnt vmcnt(3)
v_mfma_f32_16x16x32_bf16 v[168:171], v[26:29], v[216:219], v[168:171]
ds_read_b128 v[44:47], v250 offset:28928
v_mfma_f32_16x16x32_bf16 v[172:175], v[24:27], v[216:219], v[172:175]
v_mfma_f32_16x16x32_f16 v[48:51], v[224:227], v[232:235], v[48:51]
s_waitcnt lgkmcnt(0)
v_mfma_f32_16x16x32_f16 v[52:55], v[228:231], v[232:235], v[52:55]
v_mfma_f32_16x16x32_f16 v[64:67], v[0:3], v[232:235], v[64:67]
v_mfma_f32_16x16x32_f16 v[68:71], v[4:7], v[232:235], v[68:71]
v_mfma_f32_16x16x32_f16 v[80:83], v[40:43], v[232:235], v[80:83]
v_mfma_f32_16x16x32_f16 v[84:87], v[44:47], v[232:235], v[84:87]
s_nop 4
v_cvt_pk_bf16_f32 v64, v64, v65
v_cvt_pk_bf16_f32 v65, v66, v67
v_cvt_pk_bf16_f32 v66, v68, v69
v_cvt_pk_bf16_f32 v67, v70, v71
v_cvt_pk_bf16_f32 v48, v48, v49
v_cvt_pk_bf16_f32 v49, v50, v51
v_cvt_pk_bf16_f32 v50, v52, v53
v_cvt_pk_bf16_f32 v51, v54, v55
v_cvt_pk_bf16_f32 v80, v80, v81
v_cvt_pk_bf16_f32 v81, v82, v83
v_cvt_pk_bf16_f32 v82, v84, v85
v_cvt_pk_bf16_f32 v83, v86, v87
s_mov_b64 vcc, s[74:75]
v_cndmask_b32_e64 v68, v48, v80, s[74:75]
v_mfma_f32_16x16x32_f16 v[56:59], v[224:227], v[236:239], v[56:59]
v_cndmask_b32_dpp v48, v64, v48, vcc quad_perm:[1,0,3,2] row_mask:0xf bank_mask:0xf
v_cndmask_b32_e64 v69, v49, v81, s[74:75]
v_mfma_f32_16x16x32_f16 v[60:63], v[228:231], v[236:239], v[60:63]
v_cndmask_b32_dpp v49, v65, v49, vcc quad_perm:[1,0,3,2] row_mask:0xf bank_mask:0xf
v_cndmask_b32_e64 v70, v50, v82, s[74:75]
v_mfma_f32_16x16x32_f16 v[72:75], v[0:3], v[236:239], v[72:75]
v_cndmask_b32_dpp v50, v66, v50, vcc quad_perm:[1,0,3,2] row_mask:0xf bank_mask:0xf
v_mfma_f32_16x16x32_f16 v[76:79], v[4:7], v[236:239], v[76:79]
v_cndmask_b32_e64 v71, v51, v83, s[74:75]
v_cndmask_b32_dpp v51, v67, v51, vcc quad_perm:[1,0,3,2] row_mask:0xf bank_mask:0xf
s_not_b64 vcc, s[74:75]
v_mfma_f32_16x16x32_f16 v[168:171], v[40:43], v[236:239], v[168:171]
v_cndmask_b32_dpp v80, v64, v80, vcc quad_perm:[1,0,3,2] row_mask:0xf bank_mask:0xf
v_cndmask_b32_dpp v81, v65, v81, vcc quad_perm:[1,0,3,2] row_mask:0xf bank_mask:0xf
v_mfma_f32_16x16x32_f16 v[172:175], v[44:47], v[236:239], v[172:175]
v_cndmask_b32_dpp v82, v66, v82, vcc quad_perm:[1,0,3,2] row_mask:0xf bank_mask:0xf
v_cndmask_b32_dpp v83, v67, v83, vcc quad_perm:[1,0,3,2] row_mask:0xf bank_mask:0xf
buffer_store_dwordx4 v[48:51], v255, s[8:11], s69 offen sc1
buffer_store_dwordx4 v[68:71], v255, s[8:11], s69 offen offset:128 sc1
buffer_store_dwordx4 v[80:83], v255, s[8:11], s69 offen offset:256 sc1
v_cvt_pk_bf16_f32 v72, v72, v73
v_cvt_pk_bf16_f32 v73, v74, v75
v_cvt_pk_bf16_f32 v74, v76, v77
v_cvt_pk_bf16_f32 v75, v78, v79
v_cvt_pk_bf16_f32 v56, v56, v57
v_cvt_pk_bf16_f32 v57, v58, v59
v_cvt_pk_bf16_f32 v58, v60, v61
v_cvt_pk_bf16_f32 v59, v62, v63
v_cvt_pk_bf16_f32 v168, v168, v169
v_cvt_pk_bf16_f32 v169, v170, v171
v_cvt_pk_bf16_f32 v170, v172, v173
v_cvt_pk_bf16_f32 v171, v174, v175
s_mov_b64 vcc, s[74:75]
v_cndmask_b32_e64 v76, v56, v168, s[74:75]
v_cndmask_b32_dpp v56, v72, v56, vcc quad_perm:[1,0,3,2] row_mask:0xf bank_mask:0xf
v_cndmask_b32_e64 v77, v57, v169, s[74:75]
v_cndmask_b32_dpp v57, v73, v57, vcc quad_perm:[1,0,3,2] row_mask:0xf bank_mask:0xf
v_cndmask_b32_e64 v78, v58, v170, s[74:75]
v_cndmask_b32_dpp v58, v74, v58, vcc quad_perm:[1,0,3,2] row_mask:0xf bank_mask:0xf
v_cndmask_b32_e64 v79, v59, v171, s[74:75]
v_cndmask_b32_dpp v59, v75, v59, vcc quad_perm:[1,0,3,2] row_mask:0xf bank_mask:0xf
s_not_b64 vcc, s[74:75]
v_cndmask_b32_dpp v168, v72, v168, vcc quad_perm:[1,0,3,2] row_mask:0xf bank_mask:0xf
v_cndmask_b32_dpp v169, v73, v169, vcc quad_perm:[1,0,3,2] row_mask:0xf bank_mask:0xf
v_cndmask_b32_dpp v170, v74, v170, vcc quad_perm:[1,0,3,2] row_mask:0xf bank_mask:0xf
v_cndmask_b32_dpp v171, v75, v171, vcc quad_perm:[1,0,3,2] row_mask:0xf bank_mask:0xf
s_add_u32 s46, s69, 98304
buffer_store_dwordx4 v[56:59], v255, s[8:11], s46 offen sc1
s_add_u32 s46, s69, 98304
buffer_store_dwordx4 v[76:79], v255, s[8:11], s46 offen offset:128 sc1
s_add_u32 s46, s69, 98304
buffer_store_dwordx4 v[168:171], v255, s[8:11], s46 offen offset:256 sc1
s_endpgm
Lpoll:
s_waitcnt vmcnt(0)
Lpoll1:
s_cmp_eq_u32 s77, 2
s_cbranch_scc1 LpollC
v_max_u32 v250, v156, v157
v_max3_u32 v250, v250, v158, v159
v_max3_u32 v250, v250, v160, v161
v_max3_u32 v250, v250, v162, v163
v_max3_u32 v250, v250, v164, v165
v_max3_u32 v250, v250, v166, v167
v_max3_u32 v250, v250, v252, v253
v_max3_u32 v250, v250, v254, v255
v_cmp_eq_u32 vcc, -1, v250
s_nop 4
s_cbranch_vccz LpollR
v_lshlrev_b32 v250, 4, v251
s_lshl_b32 s44, s3, 12
buffer_load_dwordx4 v[156:159], v250, s[32:35], s44 offen sc1
buffer_load_dwordx4 v[160:163], v250, s[32:35], s44 offen offset:1024 sc1
buffer_load_dwordx4 v[164:167], v250, s[32:35], s44 offen offset:2048 sc1
buffer_load_dwordx4 v[252:255], v250, s[32:35], s44 offen offset:3072 sc1
s_setpc_b64 s[78:79]
LpollR:
s_setprio 3
v_add_f32 v156, v156, v160
v_add_f32 v252, v164, v252
v_add_f32 v252, v156, v252
v_add_f32 v157, v157, v161
v_add_f32 v253, v165, v253
v_add_f32 v253, v157, v253
v_add_f32 v158, v158, v162
v_add_f32 v254, v166, v254
v_add_f32 v254, v158, v254
v_add_f32 v159, v159, v163
v_add_f32 v255, v167, v255
v_add_f32 v255, v159, v255
v_add_f32_dpp v252, v252, v252 row_ror:8 row_mask:0xf bank_mask:0xf
v_add_f32_dpp v253, v253, v253 row_ror:8 row_mask:0xf bank_mask:0xf
v_add_f32_dpp v254, v254, v254 row_ror:8 row_mask:0xf bank_mask:0xf
v_add_f32_dpp v255, v255, v255 row_ror:8 row_mask:0xf bank_mask:0xf
v_add_f32_dpp v252, v252, v252 row_ror:4 row_mask:0xf bank_mask:0xf
v_add_f32_dpp v253, v253, v253 row_ror:4 row_mask:0xf bank_mask:0xf
v_add_f32_dpp v254, v254, v254 row_ror:4 row_mask:0xf bank_mask:0xf
v_add_f32_dpp v255, v255, v255 row_ror:4 row_mask:0xf bank_mask:0xf
v_add_f32_dpp v252, v252, v252 row_ror:2 row_mask:0xf bank_mask:0xf
v_add_f32_dpp v253, v253, v253 row_ror:2 row_mask:0xf bank_mask:0xf
v_add_f32_dpp v254, v254, v254 row_ror:2 row_mask:0xf bank_mask:0xf
v_add_f32_dpp v255, v255, v255 row_ror:2 row_mask:0xf bank_mask:0xf
v_add_f32_dpp v252, v252, v252 row_ror:1 row_mask:0xf bank_mask:0xf
v_add_f32_dpp v253, v253, v253 row_ror:1 row_mask:0xf bank_mask:0xf
v_add_f32_dpp v254, v254, v254 row_ror:1 row_mask:0xf bank_mask:0xf
v_add_f32_dpp v255, v255, v255 row_ror:1 row_mask:0xf bank_mask:0xf
v_mov_b32 v156, v252
v_mov_b32 v157, v253
v_mov_b32 v158, v254
v_mov_b32 v159, v255
v_permlane16_swap_b32 v252, v156
v_permlane16_swap_b32 v253, v157
v_permlane16_swap_b32 v254, v158
v_permlane16_swap_b32 v255, v159
v_add_f32 v252, v252, v156
v_add_f32 v253, v253, v157
v_add_f32 v254, v254, v158
v_add_f32 v255, v255, v159
v_mov_b32 v156, v252
v_mov_b32 v157, v253
v_mov_b32 v158, v254
v_mov_b32 v159, v255
v_permlane32_swap_b32 v252, v156
v_permlane32_swap_b32 v253, v157
v_permlane32_swap_b32 v254, v158
v_permlane32_swap_b32 v255, v159
v_add_f32 v252, v252, v156
v_add_f32 v253, v253, v157
v_add_f32 v254, v254, v158
v_add_f32 v255, v255, v159
v_min_u32 v252, -2, v252
v_min_u32 v253, -2, v253
v_min_u32 v254, -2, v254
v_min_u32 v255, -2, v255
s_lshl_b32 s44, s3, 4
s_add_u32 s44, s44, 393216
v_lshlrev_b32 v250, 11, v251
s_mov_b64 exec, 0xff
buffer_store_dwordx4 v[252:255], v250, s[32:35], s44 offen sc1
s_mov_b64 exec, -1
s_cmp_eq_u32 s40, 0
s_cselect_b32 s77, 2, 0
s_cbranch_scc0 LpollRx
LpollG:
s_nop 1
v_lshlrev_b32 v250, 2, v251
buffer_load_dword v162, v250, s[24:27], 0 offen
buffer_load_dword v163, v250, s[24:27], 0 offen offset:256
buffer_load_dword v164, v250, s[24:27], 0 offen offset:512
v_lshlrev_b32 v250, 3, v251
s_and_b32 s44, s2, 7
s_lshl_b32 s44, s44, 11
s_add_u32 s44, s44, 393216
buffer_load_dwordx2 v[156:157], v250, s[32:35], s44 offen sc1
buffer_load_dwordx2 v[158:159], v250, s[32:35], s44 offen offset:512 sc1
buffer_load_dwordx2 v[160:161], v250, s[32:35], s44 offen offset:1024 sc1
LpollRx:
s_setpc_b64 s[78:79]
LpollC:
v_max3_u32 v250, v156, v157, v158
v_max3_u32 v250, v250, v159, v160
v_max_u32 v250, v250, v161
v_cmp_eq_u32 vcc, -1, v250
s_nop 4
s_cbranch_vccz LpollS
v_lshlrev_b32 v250, 3, v251
s_and_b32 s44, s2, 7
s_lshl_b32 s44, s44, 11
s_add_u32 s44, s44, 393216
buffer_load_dwordx2 v[156:157], v250, s[32:35], s44 offen sc1
buffer_load_dwordx2 v[158:159], v250, s[32:35], s44 offen offset:512 sc1
buffer_load_dwordx2 v[160:161], v250, s[32:35], s44 offen offset:1024 sc1
s_setpc_b64 s[78:79]
LpollS:
s_setprio 3
s_mov_b32 s43, 1083296634
v_mov_b32 v165, 897988541
v_fma_f32 v156, v156, s43, v165
v_fma_f32 v157, v157, s43, v165
v_fma_f32 v158, v158, s43, v165
v_fma_f32 v159, v159, s43, v165
v_fma_f32 v160, v160, s43, v165
v_fma_f32 v161, v161, s43, v165
v_sqrt_f32 v156, v156
v_sqrt_f32 v157, v157
v_sqrt_f32 v158, v158
v_sqrt_f32 v159, v159
v_sqrt_f32 v160, v160
v_sqrt_f32 v161, v161
v_add_f32 v166, v156, v157
v_add_f32 v166, v166, v158
v_add_f32 v166, v166, v159
v_add_f32 v166, v166, v160
v_add_f32 v166, v166, v161
s_nop 1
v_add_f32_dpp v166, v166, v166 row_ror:8 row_mask:0xf bank_mask:0xf
s_nop 1
v_add_f32_dpp v166, v166, v166 row_ror:4 row_mask:0xf bank_mask:0xf
s_nop 1
v_add_f32_dpp v166, v166, v166 row_ror:2 row_mask:0xf bank_mask:0xf
s_nop 1
v_add_f32_dpp v166, v166, v166 row_ror:1 row_mask:0xf bank_mask:0xf
v_mov_b32 v250, v166
s_nop 1
v_permlane16_swap_b32 v166, v250
v_add_f32 v166, v166, v250
v_mov_b32 v250, v166
s_nop 1
v_permlane32_swap_b32 v166, v250
v_add_f32 v166, v166, v250
s_mov_b32 s43, 992651947
v_fma_f32 v166, v166, s43, v165
v_rcp_f32 v166, v166
v_mov_b32 v165, 3221789604
v_mul_f32 v166, v166, v165
v_lshlrev_b32 v167, 16, v162
v_and_b32 v252, 4294901760, v162
v_mul_f32 v156, v156, v166
v_mul_f32 v157, v157, v166
v_fma_f32 v167, v167, v156, v165
v_fma_f32 v252, v252, v157, v165
v_cvt_pk_f16_f32 v162, v167, v252
v_lshlrev_b32 v167, 16, v163
v_and_b32 v252, 4294901760, v163
v_mul_f32 v158, v158, v166
v_mul_f32 v159, v159, v166
v_fma_f32 v167, v167, v158, v165
v_fma_f32 v252, v252, v159, v165
v_cvt_pk_f16_f32 v163, v167, v252
v_lshlrev_b32 v167, 16, v164
v_and_b32 v252, 4294901760, v164
v_mul_f32 v160, v160, v166
v_mul_f32 v161, v161, v166
v_fma_f32 v167, v167, v160, v165
v_fma_f32 v252, v252, v161, v165
v_cvt_pk_f16_f32 v164, v167, v252
s_mov_b32 s77, 0
s_setpc_b64 s[78:79]
Lend:
s_endpgm

.section .rodata,"a"
.p2align 6
.amdhsa_kernel standalone__modern_conv_block_convnext_v2__vision_kernel
  .amdhsa_next_free_vgpr 256
  .amdhsa_next_free_sgpr 102
  .amdhsa_accum_offset 256
  .amdhsa_group_segment_fixed_size 0
  .amdhsa_kernarg_size 72
  .amdhsa_user_sgpr_count 2
  .amdhsa_user_sgpr_kernarg_segment_ptr 1
  .amdhsa_system_sgpr_workgroup_id_x 1
.end_amdhsa_kernel
```

```asm
; @launch grid=(256,1,1) block=(512,1,1) lds=163840
.amdgcn_target "amdgcn-amd-amdhsa--gfx950"
.text
.globl standalone__modern_conv_block_convnext_v2__vision_kernel
.p2align 8
.type standalone__modern_conv_block_convnext_v2__vision_kernel,@function
standalone__modern_conv_block_convnext_v2__vision_kernel:
Lmain:
s_cmp_ge_u32 s2, 256
s_cbranch_scc1 Lend
s_load_dwordx16 s[80:95], s[0:1], 0
s_load_dwordx2 s[96:97], s[0:1], 64
s_getpc_b64 s[74:75]
Lpc0:
s_sub_u32 s74, s74, Lpc0-Lmain
s_subb_u32 s75, s75, 0
v_lshlrev_b32 v159, 7, v0
s_movk_i32 s43, 64
v_cmp_gt_u32 vcc, s43, v0
s_and_saveexec_b64 s[78:79], vcc
s_cbranch_execz Lpf0x
global_load_dword v255, v159, s[74:75]
Lpf0x:
s_mov_b64 exec, s[78:79]
v_mov_b32 v199, v0
v_and_b32 v251, 63, v0
v_lshrrev_b32 v120, 6, v0
s_nop 0
v_readfirstlane_b32 s40, v120
s_and_b32 s43, s2, 7
s_lshr_b32 s44, s2, 3
s_and_b32 s41, s43, 0
s_lshl_b32 s41, s41, 4
s_and_b32 s45, s44, 15
s_add_u32 s41, s41, s45
s_lshr_b32 s42, s43, 0
s_lshl_b32 s42, s42, 1
s_lshr_b32 s45, s44, 4
s_add_u32 s42, s42, s45
s_lshl_b32 s41, s41, 5
s_lshl_b32 s42, s42, 5
s_lshl_b32 s67, s40, 6
s_cmp_eq_u32 s40, 6
s_cselect_b32 s67, 352, s67
v_add_u32 v125, s67, v251
v_mul_u32_u24 v121, 5462, v125
v_lshrrev_b32 v121, 16, v121
v_mul_u32_u24 v122, 12, v121
v_sub_u32 v122, v125, v122
v_bfe_u32 v123, v121, 2, 2
v_xor_b32 v122, v122, v123
v_add_u32 v123, s41, v121
v_subrev_u32 v123, 1, v123
v_mul_u32_u24 v124, 192, v123
v_lshl_add_u32 v124, v122, 4, v124
v_mov_b32 v240, 2147483648
s_movk_i32 s43, 512
v_cmp_gt_u32 vcc, s43, v123
s_nop 1
v_cndmask_b32 v124, v240, v124, vcc
v_cmp_gt_u32 vcc, 34, v121
s_nop 1
v_cndmask_b32 v240, v240, v124, vcc
s_add_i32 s43, s42, -1
s_mul_i32 s44, s43, 98304
s_cmp_lt_u32 s43, 512
s_cselect_b32 s46, s44, 1073741824
s_mul_i32 s66, s42, 98304
s_mov_b32 s6, 50331648
s_mov_b32 s7, 131072
s_lshl_b32 s67, s67, 4
s_add_u32 s67, s67, 90112
s_cmp_eq_u32 s40, 7
s_cselect_b32 s67, 163840, s67
v_lshlrev_b32 v130, 1, v199
v_add_u32 v155, 768, v199
v_min_u32 v155, 863, v155
v_lshlrev_b32 v131, 1, v155
s_waitcnt lgkmcnt(0)
s_mov_b32 s4, s80
s_and_b32 s5, s81, 65535
s_cmp_ge_u32 s40, 4
s_cbranch_scc1 Lnodw
s_mov_b32 s20, s82
s_and_b32 s21, s83, 65535
s_mov_b32 s22, 1728
s_mov_b32 s23, 131072
buffer_load_ushort v126, v130, s[20:23], 0 offen offset:0
buffer_load_ushort v127, v130, s[20:23], 0 offen offset:512
buffer_load_ushort v128, v130, s[20:23], 0 offen offset:1024
buffer_load_ushort v129, v131, s[20:23], 0 offen offset:0
Lnodw:
s_cmp_eq_u32 s40, 7
s_cbranch_scc1 Lskipx0
s_add_u32 m0, s67, 0
s_nop 0
buffer_load_dwordx4 v240, s[4:7], s46 offen nt lds
s_add_u32 m0, s67, 6656
s_nop 0
buffer_load_dwordx4 v240, s[4:7], s66 offen nt lds
s_add_u32 m0, s67, 13312
s_add_u32 s45, s66, 98304
buffer_load_dwordx4 v240, s[4:7], s45 offen nt lds
s_add_u32 m0, s67, 19968
s_add_u32 s45, s66, 196608
buffer_load_dwordx4 v240, s[4:7], s45 offen nt lds
s_add_u32 m0, s67, 26624
s_add_u32 s45, s66, 294912
buffer_load_dwordx4 v240, s[4:7], s45 offen nt lds
s_add_u32 m0, s67, 33280
s_add_u32 s45, s66, 393216
buffer_load_dwordx4 v240, s[4:7], s45 offen nt lds
Lskipx0:
s_mov_b32 s12, s84
s_and_b32 s13, s85, 65535
s_mov_b32 s14, 73728
s_mov_b32 s15, 131072
v_lshrrev_b32 v189, 2, v251
v_mul_u32_u24 v189, 768, v189
v_and_b32 v125, 3, v251
v_lshl_add_u32 v189, v125, 4, v189
s_and_b32 s43, s40, 3
s_lshl_b32 s3, s43, 6
s_mul_i32 s77, s43, 6144
s_add_u32 s77, s77, 16384
v_mov_b32 v253, 16256
v_mov_b32 v254, 1
s_add_u32 s43, s42, s40
s_add_u32 s43, s43, 1
s_lshl_b32 s43, s43, 9
s_add_u32 s43, s43, s41
s_mul_i32 s47, s43, 192
s_sub_u32 s47, s47, 256
s_and_b32 s43, s40, 1
s_lshl_b32 s46, s43, 4
s_add_u32 s41, s41, s46
s_and_b32 s43, s40, 6
s_add_u32 s42, s42, s43
s_mul_i32 s45, s43, 6656
s_add_u32 s45, s45, 90112
v_and_b32 v131, 15, v251
v_lshrrev_b32 v132, 4, v251
v_mul_u32_u24 v122, 6656, v132
v_add_u32 v122, s45, v122
v_add_u32 v121, s46, v131
v_mul_u32_u24 v123, 192, v121
v_bfe_u32 v124, v121, 2, 2
v_lshl_add_u32 v123, v124, 4, v123
v_add_u32 v242, v122, v123
v_add_u32 v121, 1, v121
v_mul_u32_u24 v123, 192, v121
v_bfe_u32 v124, v121, 2, 2
v_lshl_add_u32 v123, v124, 4, v123
v_add_u32 v243, v122, v123
v_add_u32 v121, 1, v121
v_mul_u32_u24 v123, 192, v121
v_bfe_u32 v124, v121, 2, 2
v_lshl_add_u32 v123, v124, 4, v123
v_add_u32 v244, v122, v123
s_mul_i32 s72, s40, 9216
s_add_u32 s72, s72, 90112
v_bfe_u32 v133, v131, 2, 1
v_sub_u32 v133, v132, v133
v_lshrrev_b32 v134, 3, v131
v_and_b32 v135, 3, v131
v_lshl_add_u32 v135, v134, 2, v135
v_lshlrev_b32 v136, 7, v133
v_lshl_add_u32 v136, v135, 4, v136
v_add_u32 v136, 156672, v136
v_mov_b32 v135, 163840
v_cmp_gt_u32 vcc, 3, v133
s_nop 1
v_cndmask_b32 v245, v135, v136, vcc
v_and_b32 v135, 3, v131
v_mul_u32_u24 v246, 85, v135
s_mov_b32 s16, s86
s_and_b32 s17, s87, 65535
s_mov_b32 s18, 73728
s_mov_b32 s19, 131072
s_mov_b32 s24, s88
s_and_b32 s25, s89, 65535
s_mov_b32 s26, 768
s_mov_b32 s27, 131072
s_mov_b32 s28, s90
s_and_b32 s29, s91, 65535
s_mov_b32 s30, 768
s_mov_b32 s31, 131072
s_mov_b32 s8, s92
s_and_b32 s9, s93, 65535
s_mov_b32 s10, 50331648
s_mov_b32 s11, 131072
s_mov_b32 s36, s94
s_and_b32 s37, s95, 65535
s_mov_b32 s38, 256
s_mov_b32 s39, 131072
s_mov_b32 s32, s96
s_and_b32 s33, s97, 65535
s_mov_b32 s34, 83886080
s_mov_b32 s35, 131072
v_lshlrev_b32 v241, 4, v251
v_and_b32 v133, 35, v251
v_bfe_u32 v134, v251, 2, 2
v_lshl_add_u32 v133, v134, 3, v133
v_bfe_u32 v134, v251, 4, 1
v_lshl_add_u32 v133, v134, 2, v133
v_lshlrev_b32 v248, 4, v133
v_add_u32 v249, 65536, v248
v_add_u32 v250, 131072, v248
s_lshl_b32 s73, s2, 3
s_add_u32 s73, s73, s40
s_lshl_b32 s80, s73, 10
s_add_u32 s80, s80, 4194304
s_mul_i32 s73, s73, 16
s_add_u32 s73, s73, 1048576
s_mul_i32 s46, s41, 192
s_add_u32 s43, s42, 0
s_mul_i32 s43, s43, 98304
s_add_u32 s68, s43, s46
s_add_u32 s43, s42, 8
s_mul_i32 s43, s43, 98304
s_add_u32 s69, s43, s46
s_add_u32 s43, s42, 16
s_mul_i32 s43, s43, 98304
s_add_u32 s70, s43, s46
s_add_u32 s43, s42, 24
s_mul_i32 s43, s43, 98304
s_add_u32 s71, s43, s46
s_mul_i32 s82, s40, 9216
s_mov_b32 s48, 1156203754
s_mov_b32 s49, 4294508536
s_mov_b32 s76, 400000
v_lshrrev_b32 v148, 5, v251
v_lshlrev_b32 v190, 8, v148
v_bfe_u32 v148, v251, 2, 2
v_lshl_add_u32 v190, v148, 6, v190
v_bfe_u32 v148, v251, 4, 1
v_lshl_add_u32 v190, v148, 5, v190
v_bfe_u32 v148, v251, 0, 1
v_lshl_add_u32 v190, v148, 4, v190
v_bfe_u32 v148, v251, 1, 1
v_lshl_add_u32 v190, v148, 3, v190
v_add_u32 v190, s77, v190
v_add_u32 v191, s77, v248
s_cmp_lt_u32 s40, 4
s_cbranch_scc1 Lnoy
v_lshlrev_b32 v24, 6, v199
s_mov_b32 s43, 1065362610
v_mov_b32 v25, 1084047360
v_add_u32 v0, 32772, v24
v_add_u32 v1, 32780, v24
v_add_u32 v2, 32788, v24
v_add_u32 v3, 32796, v24
v_add_u32 v4, 32804, v24
v_add_u32 v5, 32812, v24
v_add_u32 v6, 32820, v24
v_add_u32 v7, 32828, v24
v_cvt_f32_f16 v0, v0
v_cvt_f32_f16 v1, v1
v_cvt_f32_f16 v2, v2
v_cvt_f32_f16 v3, v3
v_cvt_f32_f16 v4, v4
v_cvt_f32_f16 v5, v5
v_cvt_f32_f16 v6, v6
v_cvt_f32_f16 v7, v7
v_mul_f32 v8, v0, v0
v_mul_f32 v9, v1, v1
v_mul_f32 v10, v2, v2
v_mul_f32 v11, v3, v3
v_mul_f32 v12, v4, v4
v_mul_f32 v13, v5, v5
v_mul_f32 v14, v6, v6
v_mul_f32 v15, v7, v7
v_fma_f32 v8, v8, s43, v25
v_fma_f32 v9, v9, s43, v25
v_fma_f32 v10, v10, s43, v25
v_fma_f32 v11, v11, s43, v25
v_fma_f32 v12, v12, s43, v25
v_fma_f32 v13, v13, s43, v25
v_fma_f32 v14, v14, s43, v25
v_fma_f32 v15, v15, s43, v25
v_mul_f32 v8, v0, v8
v_mul_f32 v9, v1, v9
v_mul_f32 v10, v2, v10
v_mul_f32 v11, v3, v11
v_mul_f32 v12, v4, v12
v_mul_f32 v13, v5, v13
v_mul_f32 v14, v6, v14
v_mul_f32 v15, v7, v15
v_exp_f32 v8, v8
v_exp_f32 v9, v9
v_exp_f32 v10, v10
v_exp_f32 v11, v11
v_exp_f32 v12, v12
v_exp_f32 v13, v13
v_exp_f32 v14, v14
v_exp_f32 v15, v15
v_add_f32 v16, 1.0, v8
v_add_f32 v17, 1.0, v9
v_add_f32 v18, 1.0, v10
v_add_f32 v19, 1.0, v11
v_add_f32 v20, 1.0, v12
v_add_f32 v21, 1.0, v13
v_add_f32 v22, 1.0, v14
v_add_f32 v23, 1.0, v15
v_rcp_f32 v16, v16
v_rcp_f32 v17, v17
v_rcp_f32 v18, v18
v_rcp_f32 v19, v19
v_rcp_f32 v20, v20
v_rcp_f32 v21, v21
v_rcp_f32 v22, v22
v_rcp_f32 v23, v23
v_mul_f32 v0, v0, v16
v_mul_f32 v1, v1, v17
v_mul_f32 v2, v2, v18
v_mul_f32 v3, v3, v19
v_mul_f32 v4, v4, v20
v_mul_f32 v5, v5, v21
v_mul_f32 v6, v6, v22
v_mul_f32 v7, v7, v23
v_mul_f32 v8, v8, v0
v_mul_f32 v9, v9, v1
v_mul_f32 v10, v10, v2
v_mul_f32 v11, v11, v3
v_mul_f32 v12, v12, v4
v_mul_f32 v13, v13, v5
v_mul_f32 v14, v14, v6
v_mul_f32 v15, v15, v7
v_cvt_pk_f16_f32 v28, v0, v1
v_cvt_pk_f16_f32 v32, -v8, -v9
v_cvt_pk_f16_f32 v29, v2, v3
v_cvt_pk_f16_f32 v33, -v10, -v11
v_cvt_pk_f16_f32 v30, v4, v5
v_cvt_pk_f16_f32 v34, -v12, -v13
v_cvt_pk_f16_f32 v31, v6, v7
v_cvt_pk_f16_f32 v35, -v14, -v15
v_lshlrev_b32 v24, 4, v199
v_mov_b32 v25, 163840
s_movk_i32 s43, 496
v_cmp_gt_u32 vcc, s43, v199
s_nop 1
v_cndmask_b32 v24, v25, v24, vcc
ds_write_b128 v24, v[32:35]
ds_write_b128 v24, v[28:31] offset:8192
Lnoy:
s_cmp_ge_u32 s40, 4
s_cbranch_scc1 Lnoo
v_add_u32 v152, 0, v199
v_mul_u32_u24 v140, 683, v152
v_lshrrev_b32 v140, 16, v140
v_mul_u32_u24 v142, 11, v140
v_lshrrev_b32 v142, 5, v142
v_lshrrev_b32 v143, 5, v152
v_bfe_u32 v141, v152, 3, 2
v_bfe_u32 v144, v152, 4, 1
v_xor_b32 v141, v141, v144
v_sub_u32 v141, v141, v142
v_mul_i32_i24 v141, 9, v141
v_add_u32 v143, v143, v141
v_lshrrev_b32 v141, 1, v143
v_mul_u32_u24 v141, 368, v141
v_lshl_add_u32 v143, v143, 3, v141
v_lshl_add_u32 v143, v142, 7, v143
v_and_b32 v144, 7, v152
v_lshl_add_u32 v143, v144, 4, v143
v_add_u32 v156, 156672, v143
v_add_u32 v153, 256, v199
v_mul_u32_u24 v140, 683, v153
v_lshrrev_b32 v140, 16, v140
v_mul_u32_u24 v142, 11, v140
v_lshrrev_b32 v142, 5, v142
v_lshrrev_b32 v143, 5, v153
v_bfe_u32 v141, v153, 3, 2
v_bfe_u32 v144, v153, 4, 1
v_xor_b32 v141, v141, v144
v_sub_u32 v141, v141, v142
v_mul_i32_i24 v141, 9, v141
v_add_u32 v143, v143, v141
v_lshrrev_b32 v141, 1, v143
v_mul_u32_u24 v141, 368, v141
v_lshl_add_u32 v143, v143, 3, v141
v_lshl_add_u32 v143, v142, 7, v143
v_and_b32 v144, 7, v153
v_lshl_add_u32 v143, v144, 4, v143
v_add_u32 v157, 156672, v143
v_add_u32 v154, 512, v199
v_mul_u32_u24 v140, 683, v154
v_lshrrev_b32 v140, 16, v140
v_mul_u32_u24 v142, 11, v140
v_lshrrev_b32 v142, 5, v142
v_lshrrev_b32 v143, 5, v154
v_bfe_u32 v141, v154, 3, 2
v_bfe_u32 v144, v154, 4, 1
v_xor_b32 v141, v141, v144
v_sub_u32 v141, v141, v142
v_mul_i32_i24 v141, 9, v141
v_add_u32 v143, v143, v141
v_lshrrev_b32 v141, 1, v143
v_mul_u32_u24 v141, 368, v141
v_lshl_add_u32 v143, v143, 3, v141
v_lshl_add_u32 v143, v142, 7, v143
v_and_b32 v144, 7, v154
v_lshl_add_u32 v143, v144, 4, v143
v_add_u32 v158, 156672, v143
v_mul_u32_u24 v140, 683, v155
v_lshrrev_b32 v140, 16, v140
v_mul_u32_u24 v142, 11, v140
v_lshrrev_b32 v142, 5, v142
v_lshrrev_b32 v143, 5, v155
v_bfe_u32 v141, v155, 3, 2
v_bfe_u32 v144, v155, 4, 1
v_xor_b32 v141, v141, v144
v_sub_u32 v141, v141, v142
v_mul_i32_i24 v141, 9, v141
v_add_u32 v143, v143, v141
v_lshrrev_b32 v141, 1, v143
v_mul_u32_u24 v141, 368, v141
v_lshl_add_u32 v143, v143, 3, v141
v_lshl_add_u32 v143, v142, 7, v143
v_and_b32 v144, 7, v155
v_lshl_add_u32 v143, v144, 4, v143
v_add_u32 v159, 156672, v143
v_mov_b32 v160, 0
v_mov_b32 v161, 0
v_mov_b32 v162, 0
v_mov_b32 v163, 0
s_mov_b64 exec, 1
ds_write_b128 v253, v[160:163]
ds_write_b128 v253, v[160:163] offset:16
s_mov_b64 exec, -1
s_waitcnt vmcnt(6)
v_and_b32 v130, 4, v152
v_cmp_eq_u32 vcc, 0, v130
s_nop 1
v_cndmask_b32 v164, 0, v126, vcc
v_sub_u32 v165, v126, v164
ds_write_b64 v156, v[164:165]
v_and_b32 v130, 4, v153
v_cmp_eq_u32 vcc, 0, v130
s_nop 1
v_cndmask_b32 v166, 0, v127, vcc
v_sub_u32 v167, v127, v166
ds_write_b64 v157, v[166:167]
v_and_b32 v130, 4, v154
v_cmp_eq_u32 vcc, 0, v130
s_nop 1
v_cndmask_b32 v168, 0, v128, vcc
v_sub_u32 v169, v128, v168
ds_write_b64 v158, v[168:169]
v_and_b32 v130, 4, v155
v_cmp_eq_u32 vcc, 0, v130
s_nop 1
v_cndmask_b32 v170, 0, v129, vcc
v_sub_u32 v171, v129, v170
ds_write_b64 v159, v[170:171]
s_waitcnt lgkmcnt(0)
Lnoo:
s_barrier
s_cmp_lt_u32 s40, 4
s_cbranch_scc1 Lnoy2
v_subrev_u32 v199, 256, v199
v_lshlrev_b32 v24, 6, v199
s_mov_b32 s43, 1065362610
v_mov_b32 v25, 1084047360
v_add_u32 v0, 32772, v24
v_add_u32 v1, 32780, v24
v_add_u32 v2, 32788, v24
v_add_u32 v3, 32796, v24
v_add_u32 v4, 32804, v24
v_add_u32 v5, 32812, v24
v_add_u32 v6, 32820, v24
v_add_u32 v7, 32828, v24
v_cvt_f32_f16 v0, v0
v_cvt_f32_f16 v1, v1
v_cvt_f32_f16 v2, v2
v_cvt_f32_f16 v3, v3
v_cvt_f32_f16 v4, v4
v_cvt_f32_f16 v5, v5
v_cvt_f32_f16 v6, v6
v_cvt_f32_f16 v7, v7
v_mul_f32 v8, v0, v0
v_mul_f32 v9, v1, v1
v_mul_f32 v10, v2, v2
v_mul_f32 v11, v3, v3
v_mul_f32 v12, v4, v4
v_mul_f32 v13, v5, v5
v_mul_f32 v14, v6, v6
v_mul_f32 v15, v7, v7
v_fma_f32 v8, v8, s43, v25
v_fma_f32 v9, v9, s43, v25
v_fma_f32 v10, v10, s43, v25
v_fma_f32 v11, v11, s43, v25
v_fma_f32 v12, v12, s43, v25
v_fma_f32 v13, v13, s43, v25
v_fma_f32 v14, v14, s43, v25
v_fma_f32 v15, v15, s43, v25
v_mul_f32 v8, v0, v8
v_mul_f32 v9, v1, v9
v_mul_f32 v10, v2, v10
v_mul_f32 v11, v3, v11
v_mul_f32 v12, v4, v12
v_mul_f32 v13, v5, v13
v_mul_f32 v14, v6, v14
v_mul_f32 v15, v7, v15
v_exp_f32 v8, v8
v_exp_f32 v9, v9
v_exp_f32 v10, v10
v_exp_f32 v11, v11
v_exp_f32 v12, v12
v_exp_f32 v13, v13
v_exp_f32 v14, v14
v_exp_f32 v15, v15
v_add_f32 v16, 1.0, v8
v_add_f32 v17, 1.0, v9
v_add_f32 v18, 1.0, v10
v_add_f32 v19, 1.0, v11
v_add_f32 v20, 1.0, v12
v_add_f32 v21, 1.0, v13
v_add_f32 v22, 1.0, v14
v_add_f32 v23, 1.0, v15
v_rcp_f32 v16, v16
v_rcp_f32 v17, v17
v_rcp_f32 v18, v18
v_rcp_f32 v19, v19
v_rcp_f32 v20, v20
v_rcp_f32 v21, v21
v_rcp_f32 v22, v22
v_rcp_f32 v23, v23
v_mul_f32 v0, v0, v16
v_mul_f32 v1, v1, v17
v_mul_f32 v2, v2, v18
v_mul_f32 v3, v3, v19
v_mul_f32 v4, v4, v20
v_mul_f32 v5, v5, v21
v_mul_f32 v6, v6, v22
v_mul_f32 v7, v7, v23
v_mul_f32 v8, v8, v0
v_mul_f32 v9, v9, v1
v_mul_f32 v10, v10, v2
v_mul_f32 v11, v11, v3
v_mul_f32 v12, v12, v4
v_mul_f32 v13, v13, v5
v_mul_f32 v14, v14, v6
v_mul_f32 v15, v15, v7
v_cvt_pk_f16_f32 v28, v0, v1
v_cvt_pk_f16_f32 v32, -v8, -v9
v_cvt_pk_f16_f32 v29, v2, v3
v_cvt_pk_f16_f32 v33, -v10, -v11
v_cvt_pk_f16_f32 v30, v4, v5
v_cvt_pk_f16_f32 v34, -v12, -v13
v_cvt_pk_f16_f32 v31, v6, v7
v_cvt_pk_f16_f32 v35, -v14, -v15
v_lshlrev_b32 v24, 4, v199
v_mov_b32 v25, 163840
s_movk_i32 s43, 496
v_cmp_gt_u32 vcc, s43, v199
s_nop 1
v_cndmask_b32 v24, v25, v24, vcc
ds_write_b128 v24, v[32:35]
ds_write_b128 v24, v[28:31] offset:8192
Lnoy2:
s_setprio 2
s_cmp_lt_u32 s40, 4
s_cbranch_scc0 Lsu0
s_call_b64 s[78:79], Lpre
s_call_b64 s[78:79], Lrb
s_waitcnt vmcnt(4)
s_mov_b64 exec, 1
ds_add_u32 v253, v254 offset:28
s_mov_b64 exec, -1
v_mov_b32 v253, 16256
Lsw288w:
ds_read_b32 v247, v253 offset:28
s_waitcnt lgkmcnt(0)
v_readfirstlane_b32 s43, v247
s_cmp_eq_u32 s76, 0
s_cbranch_scc1 Lsw288x
s_sub_u32 s76, s76, 1
s_cmp_lt_u32 s43, 8
s_cbranch_scc0 Lsw288x
s_sleep 2
s_branch Lsw288w
Lsw288x:
s_call_b64 s[78:79], Lconv0
s_mov_b64 exec, 1
ds_add_u32 v253, v254 offset:16
s_mov_b64 exec, -1
s_call_b64 s[78:79], Lln0
s_waitcnt vmcnt(0)
s_mov_b64 exec, 1
ds_add_u32 v253, v254 offset:12
s_mov_b64 exec, -1
s_call_b64 s[78:79], Lw1i
Lsu0:
s_cmp_ge_u32 s40, 4
s_cbranch_scc0 Lsu2
s_setprio 3
s_call_b64 s[78:79], Lw1f
s_waitcnt vmcnt(6)
s_mov_b64 exec, 1
ds_add_u32 v253, v254 offset:28
s_mov_b64 exec, -1
s_call_b64 s[78:79], Lrb
s_waitcnt vmcnt(4)
s_call_b64 s[78:79], Lw1a
s_mov_b64 exec, 1
ds_add_u32 v253, v254 offset:20
s_mov_b64 exec, -1
s_call_b64 s[78:79], Lpre
s_waitcnt vmcnt(0)
s_mov_b64 exec, 1
ds_add_u32 v253, v254 offset:12
s_mov_b64 exec, -1
v_mov_b32 v253, 16256
Lsw128w:
ds_read_b32 v247, v253 offset:12
s_waitcnt lgkmcnt(0)
v_readfirstlane_b32 s43, v247
s_cmp_eq_u32 s76, 0
s_cbranch_scc1 Lsw128x
s_sub_u32 s76, s76, 1
s_cmp_lt_u32 s43, 8
s_cbranch_scc0 Lsw128x
s_sleep 2
s_branch Lsw128w
Lsw128x:
s_call_b64 s[78:79], Lconv0
s_mov_b64 exec, 1
ds_add_u32 v253, v254 offset:16
s_mov_b64 exec, -1
s_call_b64 s[78:79], Lln0
Lsu2:
s_branch Lgo
Lconv0:
ds_read_b128 v[192:195], v242
ds_read_b128 v[196:199], v242 offset:64
ds_read_b128 v[200:203], v242 offset:128
ds_read_b128 v[204:207], v243
ds_read_b128 v[208:211], v243 offset:64
ds_read_b128 v[212:215], v243 offset:128
ds_read_b128 v[224:227], v244
ds_read_b128 v[228:231], v244 offset:64
ds_read_b128 v[232:235], v244 offset:128
v_xor_b32 v242, 16, v242
ds_read_b128 v[236:239], v242
ds_read_b128 v[216:219], v242 offset:64
ds_read_b128 v[220:223], v242 offset:128
s_waitcnt lgkmcnt(11)
v_smfmac_f32_16x16x32_bf16 v[0:3], v[48:49], v[192:195], v246
s_waitcnt lgkmcnt(10)
v_smfmac_f32_16x16x32_bf16 v[16:19], v[50:51], v[196:199], v246
s_waitcnt lgkmcnt(9)
v_smfmac_f32_16x16x32_bf16 v[32:35], v[52:53], v[200:203], v246
s_waitcnt lgkmcnt(8)
v_xor_b32 v243, 16, v243
ds_read_b128 v[192:195], v243
ds_read_b128 v[196:199], v243 offset:64
v_smfmac_f32_16x16x32_bf16 v[0:3], v[54:55], v[204:207], v246
s_waitcnt lgkmcnt(9)
v_smfmac_f32_16x16x32_bf16 v[16:19], v[56:57], v[208:211], v246
s_waitcnt lgkmcnt(8)
ds_read_b128 v[200:203], v243 offset:128
v_xor_b32 v244, 16, v244
ds_read_b128 v[204:207], v244
v_smfmac_f32_16x16x32_bf16 v[32:35], v[58:59], v[212:215], v246
s_waitcnt lgkmcnt(9)
v_smfmac_f32_16x16x32_bf16 v[0:3], v[60:61], v[224:227], v246
s_waitcnt lgkmcnt(8)
ds_read_b128 v[208:211], v244 offset:64
ds_read_b128 v[212:215], v244 offset:128
v_smfmac_f32_16x16x32_bf16 v[16:19], v[62:63], v[228:231], v246
s_waitcnt lgkmcnt(9)
v_smfmac_f32_16x16x32_bf16 v[32:35], v[64:65], v[232:235], v246
s_waitcnt lgkmcnt(8)
v_xor_b32 v242, 32, v242
ds_read_b128 v[224:227], v242
ds_read_b128 v[228:231], v242 offset:64
v_smfmac_f32_16x16x32_bf16 v[4:7], v[66:67], v[236:239], v246
s_waitcnt lgkmcnt(9)
v_smfmac_f32_16x16x32_bf16 v[20:23], v[68:69], v[216:219], v246
s_waitcnt lgkmcnt(8)
ds_read_b128 v[232:235], v242 offset:128
v_xor_b32 v243, 32, v243
ds_read_b128 v[236:239], v243
v_smfmac_f32_16x16x32_bf16 v[36:39], v[70:71], v[220:223], v246
s_waitcnt lgkmcnt(9)
v_smfmac_f32_16x16x32_bf16 v[4:7], v[72:73], v[192:195], v246
s_waitcnt lgkmcnt(8)
ds_read_b128 v[216:219], v243 offset:64
ds_read_b128 v[220:223], v243 offset:128
v_smfmac_f32_16x16x32_bf16 v[20:23], v[74:75], v[196:199], v246
s_waitcnt lgkmcnt(9)
v_smfmac_f32_16x16x32_bf16 v[36:39], v[76:77], v[200:203], v246
s_waitcnt lgkmcnt(8)
v_xor_b32 v244, 32, v244
ds_read_b128 v[192:195], v244
ds_read_b128 v[196:199], v244 offset:64
v_smfmac_f32_16x16x32_bf16 v[4:7], v[78:79], v[204:207], v246
s_waitcnt lgkmcnt(9)
v_smfmac_f32_16x16x32_bf16 v[20:23], v[80:81], v[208:211], v246
s_waitcnt lgkmcnt(8)
ds_read_b128 v[200:203], v244 offset:128
v_xor_b32 v242, 16, v242
ds_read_b128 v[204:207], v242
v_smfmac_f32_16x16x32_bf16 v[36:39], v[82:83], v[212:215], v246
s_waitcnt lgkmcnt(9)
v_smfmac_f32_16x16x32_bf16 v[12:15], v[84:85], v[224:227], v246
s_waitcnt lgkmcnt(8)
ds_read_b128 v[208:211], v242 offset:64
ds_read_b128 v[212:215], v242 offset:128
v_smfmac_f32_16x16x32_bf16 v[28:31], v[86:87], v[228:231], v246
s_waitcnt lgkmcnt(9)
v_smfmac_f32_16x16x32_bf16 v[44:47], v[88:89], v[232:235], v246
s_waitcnt lgkmcnt(8)
v_xor_b32 v243, 16, v243
ds_read_b128 v[224:227], v243
ds_read_b128 v[228:231], v243 offset:64
v_smfmac_f32_16x16x32_bf16 v[12:15], v[90:91], v[236:239], v246
s_waitcnt lgkmcnt(9)
v_smfmac_f32_16x16x32_bf16 v[28:31], v[92:93], v[216:219], v246
s_waitcnt lgkmcnt(8)
ds_read_b128 v[232:235], v243 offset:128
v_xor_b32 v244, 16, v244
ds_read_b128 v[236:239], v244
v_smfmac_f32_16x16x32_bf16 v[44:47], v[94:95], v[220:223], v246
s_waitcnt lgkmcnt(9)
v_smfmac_f32_16x16x32_bf16 v[12:15], v[96:97], v[192:195], v246
s_waitcnt lgkmcnt(8)
ds_read_b128 v[216:219], v244 offset:64
ds_read_b128 v[220:223], v244 offset:128
v_smfmac_f32_16x16x32_bf16 v[28:31], v[98:99], v[196:199], v246
s_waitcnt lgkmcnt(9)
v_smfmac_f32_16x16x32_bf16 v[44:47], v[100:101], v[200:203], v246
s_waitcnt lgkmcnt(8)
v_smfmac_f32_16x16x32_bf16 v[8:11], v[102:103], v[204:207], v246
s_waitcnt lgkmcnt(7)
v_smfmac_f32_16x16x32_bf16 v[24:27], v[104:105], v[208:211], v246
s_waitcnt lgkmcnt(6)
v_smfmac_f32_16x16x32_bf16 v[40:43], v[106:107], v[212:215], v246
s_waitcnt lgkmcnt(5)
v_smfmac_f32_16x16x32_bf16 v[8:11], v[108:109], v[224:227], v246
s_waitcnt lgkmcnt(4)
v_smfmac_f32_16x16x32_bf16 v[24:27], v[110:111], v[228:231], v246
s_waitcnt lgkmcnt(3)
v_smfmac_f32_16x16x32_bf16 v[40:43], v[112:113], v[232:235], v246
s_waitcnt lgkmcnt(2)
v_smfmac_f32_16x16x32_bf16 v[8:11], v[114:115], v[236:239], v246
s_waitcnt lgkmcnt(1)
v_smfmac_f32_16x16x32_bf16 v[24:27], v[116:117], v[216:219], v246
s_waitcnt lgkmcnt(0)
v_smfmac_f32_16x16x32_bf16 v[40:43], v[118:119], v[220:223], v246
s_nop 11
s_setpc_b64 s[78:79]
Lln0:
v_pk_add_f32 v[168:169], v[0:1], v[2:3]
v_pk_mul_f32 v[170:171], v[0:1], v[0:1]
v_pk_fma_f32 v[170:171], v[2:3], v[2:3], v[170:171]
v_pk_add_f32 v[168:169], v[168:169], v[4:5]
v_pk_fma_f32 v[170:171], v[4:5], v[4:5], v[170:171]
v_pk_add_f32 v[168:169], v[168:169], v[6:7]
v_pk_fma_f32 v[170:171], v[6:7], v[6:7], v[170:171]
v_pk_add_f32 v[168:169], v[168:169], v[8:9]
v_pk_fma_f32 v[170:171], v[8:9], v[8:9], v[170:171]
v_pk_add_f32 v[168:169], v[168:169], v[10:11]
v_pk_fma_f32 v[170:171], v[10:11], v[10:11], v[170:171]
v_pk_add_f32 v[168:169], v[168:169], v[12:13]
v_pk_fma_f32 v[170:171], v[12:13], v[12:13], v[170:171]
v_pk_add_f32 v[168:169], v[168:169], v[14:15]
v_pk_fma_f32 v[170:171], v[14:15], v[14:15], v[170:171]
v_pk_add_f32 v[168:169], v[168:169], v[16:17]
v_pk_fma_f32 v[170:171], v[16:17], v[16:17], v[170:171]
v_pk_add_f32 v[168:169], v[168:169], v[18:19]
v_pk_fma_f32 v[170:171], v[18:19], v[18:19], v[170:171]
v_pk_add_f32 v[168:169], v[168:169], v[20:21]
v_pk_fma_f32 v[170:171], v[20:21], v[20:21], v[170:171]
v_pk_add_f32 v[168:169], v[168:169], v[22:23]
v_pk_fma_f32 v[170:171], v[22:23], v[22:23], v[170:171]
v_pk_add_f32 v[168:169], v[168:169], v[24:25]
v_pk_fma_f32 v[170:171], v[24:25], v[24:25], v[170:171]
v_pk_add_f32 v[168:169], v[168:169], v[26:27]
v_pk_fma_f32 v[170:171], v[26:27], v[26:27], v[170:171]
v_pk_add_f32 v[168:169], v[168:169], v[28:29]
v_pk_fma_f32 v[170:171], v[28:29], v[28:29], v[170:171]
v_pk_add_f32 v[168:169], v[168:169], v[30:31]
v_pk_fma_f32 v[170:171], v[30:31], v[30:31], v[170:171]
v_pk_add_f32 v[168:169], v[168:169], v[32:33]
v_pk_fma_f32 v[170:171], v[32:33], v[32:33], v[170:171]
v_pk_add_f32 v[168:169], v[168:169], v[34:35]
v_pk_fma_f32 v[170:171], v[34:35], v[34:35], v[170:171]
v_pk_add_f32 v[168:169], v[168:169], v[36:37]
v_pk_fma_f32 v[170:171], v[36:37], v[36:37], v[170:171]
v_pk_add_f32 v[168:169], v[168:169], v[38:39]
v_pk_fma_f32 v[170:171], v[38:39], v[38:39], v[170:171]
v_pk_add_f32 v[168:169], v[168:169], v[40:41]
v_pk_fma_f32 v[170:171], v[40:41], v[40:41], v[170:171]
v_pk_add_f32 v[168:169], v[168:169], v[42:43]
v_pk_fma_f32 v[170:171], v[42:43], v[42:43], v[170:171]
v_pk_add_f32 v[168:169], v[168:169], v[44:45]
v_pk_fma_f32 v[170:171], v[44:45], v[44:45], v[170:171]
v_pk_add_f32 v[168:169], v[168:169], v[46:47]
v_pk_fma_f32 v[170:171], v[46:47], v[46:47], v[170:171]
v_add_f32 v168, v168, v169
v_add_f32 v170, v170, v171
s_nop 1
v_permlane32_swap_b32 v168, v170
v_add_f32 v168, v168, v170
v_mul_f32 v168, 1009429163, v168
v_mov_b32 v170, v168
s_nop 1
v_permlane32_swap_b32 v168, v170
v_fma_f32 v170, -v168, v168, v170
v_max_f32 v170, 0, v170
v_add_f32 v170, 925353388, v170
v_rsq_f32 v170, v170
s_nop 0
v_mul_f32 v172, 3203391086, v170
v_mul_f32 v173, v168, v172
v_pk_fma_f32 v[0:1], v[0:1], v[172:173], v[172:173] op_sel:[0,0,1] op_sel_hi:[1,0,1] neg_lo:[0,0,1] neg_hi:[0,0,1]
v_pk_fma_f32 v[2:3], v[2:3], v[172:173], v[172:173] op_sel:[0,0,1] op_sel_hi:[1,0,1] neg_lo:[0,0,1] neg_hi:[0,0,1]
v_pk_fma_f32 v[4:5], v[4:5], v[172:173], v[172:173] op_sel:[0,0,1] op_sel_hi:[1,0,1] neg_lo:[0,0,1] neg_hi:[0,0,1]
v_pk_fma_f32 v[6:7], v[6:7], v[172:173], v[172:173] op_sel:[0,0,1] op_sel_hi:[1,0,1] neg_lo:[0,0,1] neg_hi:[0,0,1]
v_pk_fma_f32 v[8:9], v[8:9], v[172:173], v[172:173] op_sel:[0,0,1] op_sel_hi:[1,0,1] neg_lo:[0,0,1] neg_hi:[0,0,1]
v_pk_fma_f32 v[10:11], v[10:11], v[172:173], v[172:173] op_sel:[0,0,1] op_sel_hi:[1,0,1] neg_lo:[0,0,1] neg_hi:[0,0,1]
v_pk_fma_f32 v[12:13], v[12:13], v[172:173], v[172:173] op_sel:[0,0,1] op_sel_hi:[1,0,1] neg_lo:[0,0,1] neg_hi:[0,0,1]
v_pk_fma_f32 v[14:15], v[14:15], v[172:173], v[172:173] op_sel:[0,0,1] op_sel_hi:[1,0,1] neg_lo:[0,0,1] neg_hi:[0,0,1]
v_pk_fma_f32 v[16:17], v[16:17], v[172:173], v[172:173] op_sel:[0,0,1] op_sel_hi:[1,0,1] neg_lo:[0,0,1] neg_hi:[0,0,1]
v_pk_fma_f32 v[18:19], v[18:19], v[172:173], v[172:173] op_sel:[0,0,1] op_sel_hi:[1,0,1] neg_lo:[0,0,1] neg_hi:[0,0,1]
v_pk_fma_f32 v[20:21], v[20:21], v[172:173], v[172:173] op_sel:[0,0,1] op_sel_hi:[1,0,1] neg_lo:[0,0,1] neg_hi:[0,0,1]
v_pk_fma_f32 v[22:23], v[22:23], v[172:173], v[172:173] op_sel:[0,0,1] op_sel_hi:[1,0,1] neg_lo:[0,0,1] neg_hi:[0,0,1]
v_pk_fma_f32 v[24:25], v[24:25], v[172:173], v[172:173] op_sel:[0,0,1] op_sel_hi:[1,0,1] neg_lo:[0,0,1] neg_hi:[0,0,1]
v_pk_fma_f32 v[26:27], v[26:27], v[172:173], v[172:173] op_sel:[0,0,1] op_sel_hi:[1,0,1] neg_lo:[0,0,1] neg_hi:[0,0,1]
v_pk_fma_f32 v[28:29], v[28:29], v[172:173], v[172:173] op_sel:[0,0,1] op_sel_hi:[1,0,1] neg_lo:[0,0,1] neg_hi:[0,0,1]
v_pk_fma_f32 v[30:31], v[30:31], v[172:173], v[172:173] op_sel:[0,0,1] op_sel_hi:[1,0,1] neg_lo:[0,0,1] neg_hi:[0,0,1]
v_pk_fma_f32 v[32:33], v[32:33], v[172:173], v[172:173] op_sel:[0,0,1] op_sel_hi:[1,0,1] neg_lo:[0,0,1] neg_hi:[0,0,1]
v_pk_fma_f32 v[34:35], v[34:35], v[172:173], v[172:173] op_sel:[0,0,1] op_sel_hi:[1,0,1] neg_lo:[0,0,1] neg_hi:[0,0,1]
v_pk_fma_f32 v[36:37], v[36:37], v[172:173], v[172:173] op_sel:[0,0,1] op_sel_hi:[1,0,1] neg_lo:[0,0,1] neg_hi:[0,0,1]
v_pk_fma_f32 v[38:39], v[38:39], v[172:173], v[172:173] op_sel:[0,0,1] op_sel_hi:[1,0,1] neg_lo:[0,0,1] neg_hi:[0,0,1]
v_pk_fma_f32 v[40:41], v[40:41], v[172:173], v[172:173] op_sel:[0,0,1] op_sel_hi:[1,0,1] neg_lo:[0,0,1] neg_hi:[0,0,1]
v_pk_fma_f32 v[42:43], v[42:43], v[172:173], v[172:173] op_sel:[0,0,1] op_sel_hi:[1,0,1] neg_lo:[0,0,1] neg_hi:[0,0,1]
v_pk_fma_f32 v[44:45], v[44:45], v[172:173], v[172:173] op_sel:[0,0,1] op_sel_hi:[1,0,1] neg_lo:[0,0,1] neg_hi:[0,0,1]
v_pk_fma_f32 v[46:47], v[46:47], v[172:173], v[172:173] op_sel:[0,0,1] op_sel_hi:[1,0,1] neg_lo:[0,0,1] neg_hi:[0,0,1]
v_cvt_pk_bf16_f32 v48, v0, v1
v_cvt_pk_bf16_f32 v49, v2, v3
v_cvt_pk_bf16_f32 v50, v4, v5
v_cvt_pk_bf16_f32 v51, v6, v7
v_cvt_pk_bf16_f32 v52, v8, v9
v_cvt_pk_bf16_f32 v53, v10, v11
v_cvt_pk_bf16_f32 v54, v12, v13
v_cvt_pk_bf16_f32 v55, v14, v15
v_cvt_pk_bf16_f32 v56, v16, v17
v_cvt_pk_bf16_f32 v57, v18, v19
v_cvt_pk_bf16_f32 v58, v20, v21
v_cvt_pk_bf16_f32 v59, v22, v23
v_cvt_pk_bf16_f32 v60, v24, v25
v_cvt_pk_bf16_f32 v61, v26, v27
v_cvt_pk_bf16_f32 v62, v28, v29
v_cvt_pk_bf16_f32 v63, v30, v31
v_cvt_pk_bf16_f32 v64, v32, v33
v_cvt_pk_bf16_f32 v65, v34, v35
v_cvt_pk_bf16_f32 v66, v36, v37
v_cvt_pk_bf16_f32 v67, v38, v39
v_cvt_pk_bf16_f32 v68, v40, v41
v_cvt_pk_bf16_f32 v69, v42, v43
v_cvt_pk_bf16_f32 v70, v44, v45
v_cvt_pk_bf16_f32 v71, v46, v47
s_nop 1
s_setpc_b64 s[78:79]
Lw1a:
ds_read_b64_tr_b16 v[148:149], v190
ds_read_b64_tr_b16 v[150:151], v190 offset:512
ds_read_b64_tr_b16 v[152:153], v190 offset:1024
ds_read_b64_tr_b16 v[154:155], v190 offset:1536
ds_read_b64_tr_b16 v[156:157], v190 offset:2048
ds_read_b64_tr_b16 v[158:159], v190 offset:2560
ds_read_b64_tr_b16 v[160:161], v190 offset:3072
ds_read_b64_tr_b16 v[162:163], v190 offset:3584
ds_read_b64_tr_b16 v[164:165], v190 offset:4096
ds_read_b64_tr_b16 v[166:167], v190 offset:4608
ds_read_b64_tr_b16 v[168:169], v190 offset:5120
ds_read_b64_tr_b16 v[170:171], v190 offset:5632
s_waitcnt lgkmcnt(10)
ds_write_b128 v191, v[148:151]
s_waitcnt lgkmcnt(9)
ds_write_b128 v191, v[152:155] offset:1024
s_waitcnt lgkmcnt(8)
ds_write_b128 v191, v[156:159] offset:2048
s_waitcnt lgkmcnt(7)
ds_write_b128 v191, v[160:163] offset:3072
s_waitcnt lgkmcnt(6)
ds_write_b128 v191, v[164:167] offset:4096
s_waitcnt lgkmcnt(5)
ds_write_b128 v191, v[168:171] offset:5120
s_waitcnt lgkmcnt(0)
s_setpc_b64 s[78:79]
Lw1i:
s_add_u32 m0, s77, 24576
s_add_u32 s43, s3, 256
buffer_load_dwordx4 v189, s[12:15], s43 offen lds
s_add_u32 m0, s77, 25600
s_add_u32 s43, s3, 24832
buffer_load_dwordx4 v189, s[12:15], s43 offen lds
s_add_u32 m0, s77, 26624
s_add_u32 s43, s3, 49408
buffer_load_dwordx4 v189, s[12:15], s43 offen lds
s_add_u32 m0, s77, 27648
s_add_u32 s43, s3, 12544
buffer_load_dwordx4 v189, s[12:15], s43 offen lds
s_add_u32 m0, s77, 28672
s_add_u32 s43, s3, 37120
buffer_load_dwordx4 v189, s[12:15], s43 offen lds
s_add_u32 m0, s77, 29696
s_add_u32 s43, s3, 61696
buffer_load_dwordx4 v189, s[12:15], s43 offen lds
s_add_u32 m0, s77, 49152
s_add_u32 s43, s3, 512
buffer_load_dwordx4 v189, s[12:15], s43 offen lds
s_add_u32 m0, s77, 50176
s_add_u32 s43, s3, 25088
buffer_load_dwordx4 v189, s[12:15], s43 offen lds
s_add_u32 m0, s77, 51200
s_add_u32 s43, s3, 49664
buffer_load_dwordx4 v189, s[12:15], s43 offen lds
s_add_u32 m0, s77, 52224
s_add_u32 s43, s3, 12800
buffer_load_dwordx4 v189, s[12:15], s43 offen lds
s_add_u32 m0, s77, 53248
s_add_u32 s43, s3, 37376
buffer_load_dwordx4 v189, s[12:15], s43 offen lds
s_add_u32 m0, s77, 54272
s_add_u32 s43, s3, 61952
buffer_load_dwordx4 v189, s[12:15], s43 offen lds
s_setpc_b64 s[78:79]
Lw1b:
ds_read_b64_tr_b16 v[72:73], v190 offset:24576
ds_read_b64_tr_b16 v[74:75], v190 offset:25088
ds_read_b64_tr_b16 v[76:77], v190 offset:25600
ds_read_b64_tr_b16 v[78:79], v190 offset:26112
ds_read_b64_tr_b16 v[80:81], v190 offset:26624
ds_read_b64_tr_b16 v[82:83], v190 offset:27136
ds_read_b64_tr_b16 v[84:85], v190 offset:27648
ds_read_b64_tr_b16 v[86:87], v190 offset:28160
ds_read_b64_tr_b16 v[88:89], v190 offset:28672
ds_read_b64_tr_b16 v[90:91], v190 offset:29184
ds_read_b64_tr_b16 v[92:93], v190 offset:29696
ds_read_b64_tr_b16 v[94:95], v190 offset:30208
s_waitcnt lgkmcnt(10)
ds_write_b128 v191, v[72:75] offset:24576
s_waitcnt lgkmcnt(9)
ds_write_b128 v191, v[76:79] offset:25600
s_waitcnt lgkmcnt(8)
ds_write_b128 v191, v[80:83] offset:26624
s_waitcnt lgkmcnt(7)
ds_write_b128 v191, v[84:87] offset:27648
s_waitcnt lgkmcnt(6)
ds_write_b128 v191, v[88:91] offset:28672
s_waitcnt lgkmcnt(5)
ds_write_b128 v191, v[92:95] offset:29696
s_waitcnt lgkmcnt(0)
s_setpc_b64 s[78:79]
Lw1c:
ds_read_b64_tr_b16 v[72:73], v190 offset:49152
ds_read_b64_tr_b16 v[74:75], v190 offset:49664
ds_read_b64_tr_b16 v[76:77], v190 offset:50176
ds_read_b64_tr_b16 v[78:79], v190 offset:50688
ds_read_b64_tr_b16 v[80:81], v190 offset:51200
ds_read_b64_tr_b16 v[82:83], v190 offset:51712
ds_read_b64_tr_b16 v[84:85], v190 offset:52224
ds_read_b64_tr_b16 v[86:87], v190 offset:52736
ds_read_b64_tr_b16 v[88:89], v190 offset:53248
ds_read_b64_tr_b16 v[90:91], v190 offset:53760
ds_read_b64_tr_b16 v[92:93], v190 offset:54272
ds_read_b64_tr_b16 v[94:95], v190 offset:54784
s_waitcnt lgkmcnt(10)
ds_write_b128 v191, v[72:75] offset:49152
s_waitcnt lgkmcnt(9)
ds_write_b128 v191, v[76:79] offset:50176
s_waitcnt lgkmcnt(8)
ds_write_b128 v191, v[80:83] offset:51200
s_waitcnt lgkmcnt(7)
ds_write_b128 v191, v[84:87] offset:52224
s_waitcnt lgkmcnt(6)
ds_write_b128 v191, v[88:91] offset:53248
s_waitcnt lgkmcnt(5)
ds_write_b128 v191, v[92:95] offset:54272
s_waitcnt lgkmcnt(0)
s_setpc_b64 s[78:79]
Lpre:
ds_read_b128 v[48:51], v245
ds_read_b128 v[52:55], v245 offset:384
ds_read_b128 v[56:59], v245 offset:768
ds_read_b128 v[60:63], v245 offset:1152
ds_read_b128 v[64:67], v245 offset:1536
ds_read_b128 v[68:71], v245 offset:1920
ds_read_b128 v[72:75], v245 offset:2304
ds_read_b128 v[76:79], v245 offset:2688
ds_read_b128 v[80:83], v245 offset:3072
ds_read_b128 v[84:87], v245 offset:3456
ds_read_b128 v[88:91], v245 offset:3840
ds_read_b128 v[92:95], v245 offset:4224
ds_read_b128 v[96:99], v245 offset:4608
ds_read_b128 v[100:103], v245 offset:4992
ds_read_b128 v[104:107], v245 offset:5376
ds_read_b128 v[108:111], v245 offset:5760
ds_read_b128 v[112:115], v245 offset:6144
ds_read_b128 v[116:119], v245 offset:6528
v_mov_b32 v0, 0
v_mov_b32 v1, 0
v_mov_b32 v2, 0
v_mov_b32 v3, 0
v_mov_b32 v4, 0
v_mov_b32 v5, 0
v_mov_b32 v6, 0
v_mov_b32 v7, 0
v_mov_b32 v8, 0
v_mov_b32 v9, 0
v_mov_b32 v10, 0
v_mov_b32 v11, 0
v_mov_b32 v12, 0
v_mov_b32 v13, 0
v_mov_b32 v14, 0
v_mov_b32 v15, 0
v_mov_b32 v16, 0
v_mov_b32 v17, 0
v_mov_b32 v18, 0
v_mov_b32 v19, 0
v_mov_b32 v20, 0
v_mov_b32 v21, 0
v_mov_b32 v22, 0
v_mov_b32 v23, 0
v_mov_b32 v24, 0
v_mov_b32 v25, 0
v_mov_b32 v26, 0
v_mov_b32 v27, 0
v_mov_b32 v28, 0
v_mov_b32 v29, 0
v_mov_b32 v30, 0
v_mov_b32 v31, 0
v_mov_b32 v32, 0
v_mov_b32 v33, 0
v_mov_b32 v34, 0
v_mov_b32 v35, 0
v_mov_b32 v36, 0
v_mov_b32 v37, 0
v_mov_b32 v38, 0
v_mov_b32 v39, 0
v_mov_b32 v40, 0
v_mov_b32 v41, 0
v_mov_b32 v42, 0
v_mov_b32 v43, 0
v_mov_b32 v44, 0
v_mov_b32 v45, 0
v_mov_b32 v46, 0
v_mov_b32 v47, 0
s_waitcnt lgkmcnt(0)
s_setpc_b64 s[78:79]
Lrb:
s_add_u32 m0, s67, 39936
s_add_u32 s45, s66, 491520
buffer_load_dwordx4 v240, s[4:7], s45 offen nt lds
s_add_u32 m0, s67, 46592
s_add_u32 s45, s66, 589824
buffer_load_dwordx4 v240, s[4:7], s45 offen nt lds
s_add_u32 m0, s67, 53248
s_add_u32 s45, s66, 688128
buffer_load_dwordx4 v240, s[4:7], s45 offen nt lds
s_add_u32 m0, s67, 59904
s_add_u32 s45, s66, 786432
buffer_load_dwordx4 v240, s[4:7], s45 offen nt lds
s_setpc_b64 s[78:79]
Lw1f:
s_add_u32 m0, s77, 0
s_add_u32 s43, s3, 0
buffer_load_dwordx4 v189, s[12:15], s43 offen lds
s_add_u32 m0, s77, 1024
s_add_u32 s43, s3, 24576
buffer_load_dwordx4 v189, s[12:15], s43 offen lds
s_add_u32 m0, s77, 2048
s_add_u32 s43, s3, 49152
buffer_load_dwordx4 v189, s[12:15], s43 offen lds
s_add_u32 m0, s77, 3072
s_add_u32 s43, s3, 12288
buffer_load_dwordx4 v189, s[12:15], s43 offen lds
s_add_u32 m0, s77, 4096
s_add_u32 s43, s3, 36864
buffer_load_dwordx4 v189, s[12:15], s43 offen lds
s_add_u32 m0, s77, 5120
s_add_u32 s43, s3, 61440
buffer_load_dwordx4 v189, s[12:15], s43 offen lds
s_setpc_b64 s[78:79]
Lgo:
v_mov_b32 v253, 16256
Lsw204w:
ds_read_b32 v247, v253 offset:20
s_waitcnt lgkmcnt(0)
v_readfirstlane_b32 s43, v247
s_cmp_eq_u32 s76, 0
s_cbranch_scc1 Lsw204x
s_sub_u32 s76, s76, 1
s_cmp_lt_u32 s43, 4
s_cbranch_scc0 Lsw204x
s_sleep 2
s_branch Lsw204w
Lsw204x:
s_cmp_lg_u32 s40, 7
s_cbranch_scc1 Lnopf
s_getpc_b64 s[74:75]
Lpc:
s_lshr_b32 s43, s2, 3
s_and_b32 s43, s43, 15
s_lshl_b32 s43, s43, 13
v_lshlrev_b32 v102, 7, v251
v_add_u32 v102, s43, v102
v_min_u32 v102, Lend-Lpc, v102
global_load_dword v255, v102, s[74:75]
Lnopf:
s_add_u32 s66, s66, 786432
ds_read_b128 v[224:227], v248 offset:16384
ds_read_b128 v[228:231], v248 offset:19456
ds_read_b128 v[232:235], v248 offset:17408
ds_read_b128 v[236:239], v248 offset:20480
ds_read_b128 v[216:219], v248 offset:18432
ds_read_b128 v[220:223], v248 offset:21504
s_setprio 2
s_waitcnt lgkmcnt(5)
v_mfma_f32_32x32x16_bf16 v[120:135], v[48:51], v[224:227], 0
s_waitcnt lgkmcnt(4)
ds_read_b128 v[224:227], v248 offset:22528
v_mfma_f32_32x32x16_bf16 v[120:135], v[52:55], v[228:231], v[120:135]
s_waitcnt lgkmcnt(4)
ds_read_b128 v[228:231], v248 offset:25600
v_mfma_f32_32x32x16_bf16 v[120:135], v[56:59], v[232:235], v[120:135]
s_waitcnt lgkmcnt(4)
ds_read_b128 v[232:235], v248 offset:23552
v_mfma_f32_32x32x16_bf16 v[120:135], v[60:63], v[236:239], v[120:135]
s_waitcnt lgkmcnt(4)
ds_read_b128 v[236:239], v248 offset:26624
v_mfma_f32_32x32x16_bf16 v[120:135], v[64:67], v[216:219], v[120:135]
s_waitcnt lgkmcnt(4)
ds_read_b128 v[216:219], v248 offset:24576
v_mfma_f32_32x32x16_bf16 v[120:135], v[68:71], v[220:223], v[120:135]
v_add_u32 v174, -36864, v242
v_subrev_u32 v175, 66560, v174
v_min_u32 v174, v174, v175
v_add_u32 v174, 90112, v174
v_sub_u32 v175, v174, v242
v_add_u32 v242, v175, v242
v_add_u32 v243, v175, v243
v_add_u32 v244, v175, v244
s_nop 3
v_cvt_pkrtz_f16_f32 v137, v120, v121
v_cvt_pkrtz_f16_f32 v139, v122, v123
v_cvt_pkrtz_f16_f32 v141, v124, v125
v_cvt_pkrtz_f16_f32 v143, v126, v127
v_cvt_pkrtz_f16_f32 v177, v128, v129
v_cvt_pk_f16_f32 v155, v130, v131
v_cvt_pk_f16_f32 v152, v132, v133
v_cvt_pk_f16_f32 v149, v134, v135
s_waitcnt lgkmcnt(1)
ds_read_b128 v[220:223], v248 offset:27648
v_mfma_f32_32x32x16_bf16 v[120:135], v[48:51], v[224:227], 0
v_pk_fma_f16 v154, v155, v155, s48
v_and_b32 v137, s49, v137
v_pk_fma_f16 v151, v152, v152, s48
v_pk_fma_f16 v148, v149, v149, s48
v_lshrrev_b16 v136, 2, v137
v_pk_mul_f16 v154, v155, v154
v_pk_mul_f16 v151, v152, v151
v_pk_mul_f16 v148, v149, v148
ds_read_b128 v[224:227], v248 offset:28672
ds_read_u16_d16 v136, v136
v_mfma_f32_32x32x16_bf16 v[120:135], v[52:55], v[228:231], v[120:135]
v_lshrrev_b32 v137, 18, v137
v_exp_f16 v153, v154
v_exp_f16 v150, v151
v_and_b32 v139, s49, v139
v_exp_f16 v147, v148
v_lshrrev_b16 v138, 2, v139
ds_read_b128 v[228:231], v248 offset:31744
ds_read_u16_d16_hi v137, v137
ds_read_u16_d16 v138, v138
v_mfma_f32_32x32x16_bf16 v[120:135], v[56:59], v[232:235], v[120:135]
v_exp_f16_sdwa v153, v154 dst_sel:WORD_1 dst_unused:UNUSED_PRESERVE src0_sel:WORD_1
v_lshrrev_b32 v139, 18, v139
v_exp_f16_sdwa v150, v151 dst_sel:WORD_1 dst_unused:UNUSED_PRESERVE src0_sel:WORD_1
v_exp_f16_sdwa v147, v148 dst_sel:WORD_1 dst_unused:UNUSED_PRESERVE src0_sel:WORD_1
v_and_b32 v141, s49, v141
ds_read_b128 v[232:235], v248 offset:29696
ds_read_u16_d16_hi v139, v139
v_mfma_f32_32x32x16_bf16 v[120:135], v[60:63], v[236:239], v[120:135]
v_pk_add_f16 v153, v153, 1.0 op_sel_hi:[1,0]
v_lshrrev_b16 v140, 2, v141
v_pk_add_f16 v150, v150, 1.0 op_sel_hi:[1,0]
v_pk_add_f16 v147, v147, 1.0 op_sel_hi:[1,0]
v_rcp_f16 v154, v153
v_lshrrev_b32 v141, 18, v141
v_rcp_f16 v151, v150
s_waitcnt lgkmcnt(5)
ds_read_b128 v[236:239], v248 offset:32768
ds_read_u16_d16 v140, v140
ds_read_u16_d16_hi v141, v141
v_mfma_f32_32x32x16_bf16 v[120:135], v[64:67], v[216:219], v[120:135]
v_and_b32 v143, s49, v143
v_rcp_f16 v148, v147
v_lshrrev_b16 v142, 2, v143
v_rcp_f16_sdwa v154, v153 dst_sel:WORD_1 dst_unused:UNUSED_PRESERVE src0_sel:WORD_1
v_rcp_f16_sdwa v151, v150 dst_sel:WORD_1 dst_unused:UNUSED_PRESERVE src0_sel:WORD_1
ds_read_b128 v[216:219], v248 offset:30720
ds_read_u16_d16 v142, v142
ds_read_b32 v247, v253 offset:16
v_mfma_f32_32x32x16_bf16 v[120:135], v[68:71], v[220:223], v[120:135]
v_lshrrev_b32 v143, 18, v143
v_rcp_f16_sdwa v148, v147 dst_sel:WORD_1 dst_unused:UNUSED_PRESERVE src0_sel:WORD_1
v_and_b32 v177, s49, v177
v_pk_mul_f16 v155, v155, v154
v_pk_mul_f16 v152, v152, v151
v_lshrrev_b16 v176, 2, v177
v_pk_mul_f16 v149, v149, v148
v_fma_mix_f32 v156, v155, v155, 0 op_sel:[0,0,0] op_sel_hi:[1,1,0]
v_fma_mix_f32 v156, v155, v155, v156 op_sel:[1,1,0] op_sel_hi:[1,1,0]
v_lshrrev_b32 v177, 18, v177
v_fma_mix_f32 v156, v152, v152, v156 op_sel:[0,0,0] op_sel_hi:[1,1,0]
v_fma_mix_f32 v156, v152, v152, v156 op_sel:[1,1,0] op_sel_hi:[1,1,0]
v_fma_mix_f32 v156, v149, v149, v156 op_sel:[0,0,0] op_sel_hi:[1,1,0]
v_fma_mix_f32 v156, v149, v149, v156 op_sel:[1,1,0] op_sel_hi:[1,1,0]
ds_read_u16_d16_hi v143, v143
ds_read_u16_d16 v176, v176
ds_read_u16_d16_hi v177, v177
s_waitcnt lgkmcnt(3)
v_readfirstlane_b32 s43, v247
s_nop 1
s_cmp_ge_u32 s43, 8
s_cbranch_scc1 Lev1
Lev1w:
s_sleep 1
ds_read_b32 v247, v253 offset:16
s_waitcnt lgkmcnt(0)
v_readfirstlane_b32 s43, v247
s_cmp_eq_u32 s76, 0
s_cbranch_scc1 Lev1
s_sub_u32 s76, s76, 1
s_cmp_lt_u32 s43, 8
s_cbranch_scc1 Lev1w
Lev1:
v_cvt_pkrtz_f16_f32 v179, v120, v121
v_cvt_pkrtz_f16_f32 v181, v122, v123
v_cvt_pkrtz_f16_f32 v183, v124, v125
v_cvt_pkrtz_f16_f32 v185, v126, v127
v_cvt_pkrtz_f16_f32 v187, v128, v129
v_cvt_pk_f16_f32 v155, v130, v131
v_cvt_pk_f16_f32 v152, v132, v133
v_cvt_pk_f16_f32 v149, v134, v135
s_add_u32 m0, s67, 0
s_add_u32 s66, s66, 98304
buffer_load_dwordx4 v240, s[4:7], s66 offen lds
ds_read_b128 v[220:223], v248 offset:33792
v_mfma_f32_32x32x16_bf16 v[120:135], v[48:51], v[224:227], 0
v_pk_fma_f16 v154, v155, v155, s48
v_and_b32 v179, s49, v179
v_fma_mix_f32 v156, v136, v136, v156 op_sel:[0,0,0] op_sel_hi:[1,1,0]
v_pk_fma_f16 v151, v152, v152, s48
v_pk_fma_f16 v148, v149, v149, s48
v_lshrrev_b16 v178, 2, v179
v_pk_mul_f16 v154, v155, v154
v_pk_mul_f16 v151, v152, v151
v_fma_mix_f32 v156, v137, v137, v156 op_sel:[1,1,0] op_sel_hi:[1,1,0]
v_lshrrev_b32 v179, 18, v179
s_add_u32 m0, s67, 6656
s_add_u32 s66, s66, 98304
buffer_load_dwordx4 v240, s[4:7], s66 offen lds
ds_read_b128 v[224:227], v248 offset:34816
ds_read_u16_d16 v178, v178
ds_read_u16_d16_hi v179, v179
v_mfma_f32_32x32x16_bf16 v[120:135], v[52:55], v[228:231], v[120:135]
v_pk_mul_f16 v148, v149, v148
v_exp_f16 v153, v154
v_exp_f16 v150, v151
v_and_b32 v181, s49, v181
v_fma_mix_f32 v156, v138, v138, v156 op_sel:[0,0,0] op_sel_hi:[1,1,0]
v_exp_f16 v147, v148
v_lshrrev_b16 v180, 2, v181
s_add_u32 m0, s67, 13312
s_add_u32 s66, s66, 98304
buffer_load_dwordx4 v240, s[4:7], s66 offen lds
ds_read_b128 v[228:231], v248 offset:37888
ds_read_u16_d16 v180, v180
v_mfma_f32_32x32x16_bf16 v[120:135], v[56:59], v[232:235], v[120:135]
v_exp_f16_sdwa v153, v154 dst_sel:WORD_1 dst_unused:UNUSED_PRESERVE src0_sel:WORD_1
v_lshrrev_b32 v181, 18, v181
v_fma_mix_f32 v156, v139, v139, v156 op_sel:[1,1,0] op_sel_hi:[1,1,0]
v_exp_f16_sdwa v150, v151 dst_sel:WORD_1 dst_unused:UNUSED_PRESERVE src0_sel:WORD_1
v_exp_f16_sdwa v147, v148 dst_sel:WORD_1 dst_unused:UNUSED_PRESERVE src0_sel:WORD_1
v_and_b32 v183, s49, v183
v_fma_mix_f32 v156, v140, v140, v156 op_sel:[0,0,0] op_sel_hi:[1,1,0]
s_add_u32 m0, s67, 19968
s_add_u32 s66, s66, 98304
buffer_load_dwordx4 v240, s[4:7], s66 offen lds
s_add_u32 m0, s67, 26624
s_add_u32 s66, s66, 98304
buffer_load_dwordx4 v240, s[4:7], s66 offen lds
ds_read_b128 v[232:235], v248 offset:35840
ds_read_u16_d16_hi v181, v181
v_mfma_f32_32x32x16_bf16 v[120:135], v[60:63], v[236:239], v[120:135]
v_pk_add_f16 v153, v153, 1.0 op_sel_hi:[1,0]
v_lshrrev_b16 v182, 2, v183
v_pk_add_f16 v150, v150, 1.0 op_sel_hi:[1,0]
v_pk_add_f16 v147, v147, 1.0 op_sel_hi:[1,0]
v_rcp_f16 v154, v153
v_lshrrev_b32 v183, 18, v183
v_fma_mix_f32 v156, v141, v141, v156 op_sel:[1,1,0] op_sel_hi:[1,1,0]
v_rcp_f16 v151, v150
s_add_u32 m0, s67, 33280
s_add_u32 s66, s66, 98304
buffer_load_dwordx4 v240, s[4:7], s66 offen lds
ds_read_b128 v[236:239], v248 offset:38912
ds_read_u16_d16 v182, v182
ds_read_u16_d16_hi v183, v183
v_mfma_f32_32x32x16_bf16 v[120:135], v[64:67], v[216:219], v[120:135]
v_and_b32 v185, s49, v185
v_rcp_f16 v148, v147
v_fma_mix_f32 v156, v142, v142, v156 op_sel:[0,0,0] op_sel_hi:[1,1,0]
v_lshrrev_b16 v184, 2, v185
v_rcp_f16_sdwa v154, v153 dst_sel:WORD_1 dst_unused:UNUSED_PRESERVE src0_sel:WORD_1
v_rcp_f16_sdwa v151, v150 dst_sel:WORD_1 dst_unused:UNUSED_PRESERVE src0_sel:WORD_1
v_lshrrev_b32 v185, 18, v185
s_waitcnt lgkmcnt(4)
s_add_u32 m0, s67, 39936
s_add_u32 s66, s66, 98304
buffer_load_dwordx4 v240, s[4:7], s66 offen lds
ds_read_b128 v[216:219], v248 offset:36864
ds_read_u16_d16 v184, v184
ds_read_u16_d16_hi v185, v185
v_mfma_f32_32x32x16_bf16 v[120:135], v[68:71], v[220:223], v[120:135]
v_fma_mix_f32 v156, v143, v143, v156 op_sel:[1,1,0] op_sel_hi:[1,1,0]
v_rcp_f16_sdwa v148, v147 dst_sel:WORD_1 dst_unused:UNUSED_PRESERVE src0_sel:WORD_1
v_and_b32 v187, s49, v187
v_pk_mul_f16 v155, v155, v154
v_fma_mix_f32 v156, v176, v176, v156 op_sel:[0,0,0] op_sel_hi:[1,1,0]
v_pk_mul_f16 v152, v152, v151
v_lshrrev_b16 v186, 2, v187
v_pk_mul_f16 v149, v149, v148
v_fma_mix_f32 v157, v155, v155, 0 op_sel:[0,0,0] op_sel_hi:[1,1,0]
s_add_u32 m0, s67, 46592
s_add_u32 s66, s66, 98304
buffer_load_dwordx4 v240, s[4:7], s66 offen lds
v_fma_mix_f32 v157, v155, v155, v157 op_sel:[1,1,0] op_sel_hi:[1,1,0]
v_lshrrev_b32 v187, 18, v187
v_fma_mix_f32 v156, v177, v177, v156 op_sel:[1,1,0] op_sel_hi:[1,1,0]
v_fma_mix_f32 v157, v152, v152, v157 op_sel:[0,0,0] op_sel_hi:[1,1,0]
v_fma_mix_f32 v157, v152, v152, v157 op_sel:[1,1,0] op_sel_hi:[1,1,0]
v_fma_mix_f32 v157, v149, v149, v157 op_sel:[0,0,0] op_sel_hi:[1,1,0]
v_fma_mix_f32 v157, v149, v149, v157 op_sel:[1,1,0] op_sel_hi:[1,1,0]
s_cmp_lt_u32 s40, 4
s_cbranch_scc0 Lsu5
s_waitcnt vmcnt(14)
s_call_b64 s[78:79], Lw1b
s_mov_b64 exec, 1
ds_add_u32 v253, v254 offset:24
s_mov_b64 exec, -1
Lsu5:
s_setprio 1
v_cvt_pkrtz_f16_f32 v137, v120, v121
v_cvt_pkrtz_f16_f32 v139, v122, v123
v_cvt_pkrtz_f16_f32 v141, v124, v125
v_cvt_pkrtz_f16_f32 v143, v126, v127
v_cvt_pkrtz_f16_f32 v177, v128, v129
v_cvt_pk_f16_f32 v155, v130, v131
v_cvt_pk_f16_f32 v152, v132, v133
v_cvt_pk_f16_f32 v149, v134, v135
ds_read_b128 v[220:223], v248 offset:39936
ds_read_u16_d16 v186, v186
ds_read_u16_d16_hi v187, v187
v_mfma_f32_32x32x16_bf16 v[120:135], v[48:51], v[224:227], 0
v_pk_fma_f16 v154, v155, v155, s48
v_and_b32 v137, s49, v137
v_fma_mix_f32 v157, v178, v178, v157 op_sel:[0,0,0] op_sel_hi:[1,1,0]
v_pk_fma_f16 v151, v152, v152, s48
v_pk_fma_f16 v148, v149, v149, s48
v_lshrrev_b16 v136, 2, v137
v_pk_mul_f16 v154, v155, v154
v_pk_mul_f16 v151, v152, v151
v_fma_mix_f32 v157, v179, v179, v157 op_sel:[1,1,0] op_sel_hi:[1,1,0]
v_lshrrev_b32 v137, 18, v137
ds_read_u16_d16 v136, v136
ds_read_b32 v247, v253 offset:24
ds_read_u16_d16_hi v137, v137
v_mfma_f32_32x32x16_bf16 v[120:135], v[52:55], v[228:231], v[120:135]
v_pk_mul_f16 v148, v149, v148
v_exp_f16 v153, v154
v_exp_f16 v150, v151
v_and_b32 v139, s49, v139
v_fma_mix_f32 v157, v180, v180, v157 op_sel:[0,0,0] op_sel_hi:[1,1,0]
v_exp_f16 v147, v148
v_lshrrev_b16 v138, 2, v139
ds_read_u16_d16 v138, v138
v_mfma_f32_32x32x16_bf16 v[120:135], v[56:59], v[232:235], v[120:135]
v_exp_f16_sdwa v153, v154 dst_sel:WORD_1 dst_unused:UNUSED_PRESERVE src0_sel:WORD_1
v_lshrrev_b32 v139, 18, v139
s_waitcnt lgkmcnt(4)
v_fma_mix_f32 v157, v181, v181, v157 op_sel:[1,1,0] op_sel_hi:[1,1,0]
v_exp_f16_sdwa v150, v151 dst_sel:WORD_1 dst_unused:UNUSED_PRESERVE src0_sel:WORD_1
v_exp_f16_sdwa v147, v148 dst_sel:WORD_1 dst_unused:UNUSED_PRESERVE src0_sel:WORD_1
v_and_b32 v141, s49, v141
v_fma_mix_f32 v157, v182, v182, v157 op_sel:[0,0,0] op_sel_hi:[1,1,0]
ds_read_u16_d16_hi v139, v139
s_waitcnt lgkmcnt(3)
v_readfirstlane_b32 s43, v247
s_nop 1
s_cmp_ge_u32 s43, 4
s_cbranch_scc1 Lev2
Lev2w:
s_sleep 1
ds_read_b32 v247, v253 offset:24
s_waitcnt lgkmcnt(0)
v_readfirstlane_b32 s43, v247
s_cmp_eq_u32 s76, 0
s_cbranch_scc1 Lev2
s_sub_u32 s76, s76, 1
s_cmp_lt_u32 s43, 4
s_cbranch_scc1 Lev2w
Lev2:
ds_read_b128 v[224:227], v248 offset:40960
ds_read_b128 v[228:231], v248 offset:44032
ds_read_b128 v[232:235], v248 offset:41984
v_mfma_f32_32x32x16_bf16 v[120:135], v[60:63], v[236:239], v[120:135]
v_pk_add_f16 v153, v153, 1.0 op_sel_hi:[1,0]
v_lshrrev_b16 v140, 2, v141
v_pk_add_f16 v150, v150, 1.0 op_sel_hi:[1,0]
v_pk_add_f16 v147, v147, 1.0 op_sel_hi:[1,0]
v_rcp_f16 v154, v153
v_lshrrev_b32 v141, 18, v141
v_fma_mix_f32 v157, v183, v183, v157 op_sel:[1,1,0] op_sel_hi:[1,1,0]
v_rcp_f16 v151, v150
ds_read_b128 v[236:239], v248 offset:45056
ds_read_u16_d16 v140, v140
ds_read_u16_d16_hi v141, v141
v_mfma_f32_32x32x16_bf16 v[120:135], v[64:67], v[216:219], v[120:135]
v_and_b32 v143, s49, v143
v_rcp_f16 v148, v147
v_fma_mix_f32 v157, v184, v184, v157 op_sel:[0,0,0] op_sel_hi:[1,1,0]
v_lshrrev_b16 v142, 2, v143
v_rcp_f16_sdwa v154, v153 dst_sel:WORD_1 dst_unused:UNUSED_PRESERVE src0_sel:WORD_1
v_rcp_f16_sdwa v151, v150 dst_sel:WORD_1 dst_unused:UNUSED_PRESERVE src0_sel:WORD_1
v_lshrrev_b32 v143, 18, v143
ds_read_b128 v[216:219], v248 offset:43008
ds_read_u16_d16 v142, v142
ds_read_u16_d16_hi v143, v143
v_mfma_f32_32x32x16_bf16 v[120:135], v[68:71], v[220:223], v[120:135]
v_fma_mix_f32 v157, v185, v185, v157 op_sel:[1,1,0] op_sel_hi:[1,1,0]
v_rcp_f16_sdwa v148, v147 dst_sel:WORD_1 dst_unused:UNUSED_PRESERVE src0_sel:WORD_1
v_and_b32 v177, s49, v177
v_pk_mul_f16 v155, v155, v154
v_fma_mix_f32 v157, v186, v186, v157 op_sel:[0,0,0] op_sel_hi:[1,1,0]
v_pk_mul_f16 v152, v152, v151
v_lshrrev_b16 v176, 2, v177
v_pk_mul_f16 v149, v149, v148
v_fma_mix_f32 v158, v155, v155, 0 op_sel:[0,0,0] op_sel_hi:[1,1,0]
v_fma_mix_f32 v158, v155, v155, v158 op_sel:[1,1,0] op_sel_hi:[1,1,0]
v_lshrrev_b32 v177, 18, v177
v_fma_mix_f32 v157, v187, v187, v157 op_sel:[1,1,0] op_sel_hi:[1,1,0]
v_fma_mix_f32 v158, v152, v152, v158 op_sel:[0,0,0] op_sel_hi:[1,1,0]
v_fma_mix_f32 v158, v152, v152, v158 op_sel:[1,1,0] op_sel_hi:[1,1,0]
v_fma_mix_f32 v158, v149, v149, v158 op_sel:[0,0,0] op_sel_hi:[1,1,0]
v_fma_mix_f32 v158, v149, v149, v158 op_sel:[1,1,0] op_sel_hi:[1,1,0]
v_cvt_pkrtz_f16_f32 v179, v120, v121
v_cvt_pkrtz_f16_f32 v181, v122, v123
v_cvt_pkrtz_f16_f32 v183, v124, v125
v_cvt_pkrtz_f16_f32 v185, v126, v127
v_cvt_pkrtz_f16_f32 v187, v128, v129
v_cvt_pk_f16_f32 v155, v130, v131
v_cvt_pk_f16_f32 v152, v132, v133
v_cvt_pk_f16_f32 v149, v134, v135
s_waitcnt lgkmcnt(0)
ds_read_b128 v[220:223], v248 offset:46080
ds_read_u16_d16 v176, v176
ds_read_u16_d16_hi v177, v177
v_mfma_f32_32x32x16_bf16 v[120:135], v[48:51], v[224:227], 0
v_pk_fma_f16 v154, v155, v155, s48
v_and_b32 v179, s49, v179
v_fma_mix_f32 v158, v136, v136, v158 op_sel:[0,0,0] op_sel_hi:[1,1,0]
v_pk_fma_f16 v151, v152, v152, s48
v_pk_fma_f16 v148, v149, v149, s48
v_lshrrev_b16 v178, 2, v179
v_pk_mul_f16 v154, v155, v154
v_pk_mul_f16 v151, v152, v151
v_fma_mix_f32 v158, v137, v137, v158 op_sel:[1,1,0] op_sel_hi:[1,1,0]
v_lshrrev_b32 v179, 18, v179
ds_read_b128 v[224:227], v248 offset:47104
ds_read_u16_d16 v178, v178
ds_read_u16_d16_hi v179, v179
v_mfma_f32_32x32x16_bf16 v[120:135], v[52:55], v[228:231], v[120:135]
v_pk_mul_f16 v148, v149, v148
v_exp_f16 v153, v154
v_exp_f16 v150, v151
v_and_b32 v181, s49, v181
v_fma_mix_f32 v158, v138, v138, v158 op_sel:[0,0,0] op_sel_hi:[1,1,0]
v_exp_f16 v147, v148
v_lshrrev_b16 v180, 2, v181
ds_read_b128 v[228:231], v248 offset:50176
ds_read_u16_d16 v180, v180
v_mfma_f32_32x32x16_bf16 v[120:135], v[56:59], v[232:235], v[120:135]
v_exp_f16_sdwa v153, v154 dst_sel:WORD_1 dst_unused:UNUSED_PRESERVE src0_sel:WORD_1
v_lshrrev_b32 v181, 18, v181
v_fma_mix_f32 v158, v139, v139, v158 op_sel:[1,1,0] op_sel_hi:[1,1,0]
v_exp_f16_sdwa v150, v151 dst_sel:WORD_1 dst_unused:UNUSED_PRESERVE src0_sel:WORD_1
v_exp_f16_sdwa v147, v148 dst_sel:WORD_1 dst_unused:UNUSED_PRESERVE src0_sel:WORD_1
v_and_b32 v183, s49, v183
v_fma_mix_f32 v158, v140, v140, v158 op_sel:[0,0,0] op_sel_hi:[1,1,0]
ds_read_b128 v[232:235], v248 offset:48128
ds_read_u16_d16_hi v181, v181
v_mfma_f32_32x32x16_bf16 v[120:135], v[60:63], v[236:239], v[120:135]
v_pk_add_f16 v153, v153, 1.0 op_sel_hi:[1,0]
v_lshrrev_b16 v182, 2, v183
v_pk_add_f16 v150, v150, 1.0 op_sel_hi:[1,0]
v_pk_add_f16 v147, v147, 1.0 op_sel_hi:[1,0]
v_rcp_f16 v154, v153
v_lshrrev_b32 v183, 18, v183
v_fma_mix_f32 v158, v141, v141, v158 op_sel:[1,1,0] op_sel_hi:[1,1,0]
v_rcp_f16 v151, v150
ds_read_b128 v[236:239], v248 offset:51200
ds_read_u16_d16 v182, v182
ds_read_u16_d16_hi v183, v183
v_mfma_f32_32x32x16_bf16 v[120:135], v[64:67], v[216:219], v[120:135]
v_and_b32 v185, s49, v185
v_rcp_f16 v148, v147
v_fma_mix_f32 v158, v142, v142, v158 op_sel:[0,0,0] op_sel_hi:[1,1,0]
v_lshrrev_b16 v184, 2, v185
v_rcp_f16_sdwa v154, v153 dst_sel:WORD_1 dst_unused:UNUSED_PRESERVE src0_sel:WORD_1
v_rcp_f16_sdwa v151, v150 dst_sel:WORD_1 dst_unused:UNUSED_PRESERVE src0_sel:WORD_1
v_lshrrev_b32 v185, 18, v185
s_waitcnt lgkmcnt(5)
ds_read_b128 v[216:219], v248 offset:49152
ds_read_u16_d16 v184, v184
ds_read_u16_d16_hi v185, v185
v_mfma_f32_32x32x16_bf16 v[120:135], v[68:71], v[220:223], v[120:135]
v_fma_mix_f32 v158, v143, v143, v158 op_sel:[1,1,0] op_sel_hi:[1,1,0]
v_rcp_f16_sdwa v148, v147 dst_sel:WORD_1 dst_unused:UNUSED_PRESERVE src0_sel:WORD_1
s_cmp_eq_u32 s40, 7
s_cbranch_scc1 Lrdy8
s_waitcnt vmcnt(0)
Lrdy8:
s_mov_b64 exec, 1
ds_add_u32 v253, v254 offset:12
s_mov_b64 exec, -1
v_and_b32 v187, s49, v187
v_pk_mul_f16 v155, v155, v154
v_fma_mix_f32 v158, v176, v176, v158 op_sel:[0,0,0] op_sel_hi:[1,1,0]
v_pk_mul_f16 v152, v152, v151
v_lshrrev_b16 v186, 2, v187
v_pk_mul_f16 v149, v149, v148
v_fma_mix_f32 v159, v155, v155, 0 op_sel:[0,0,0] op_sel_hi:[1,1,0]
v_fma_mix_f32 v159, v155, v155, v159 op_sel:[1,1,0] op_sel_hi:[1,1,0]
v_lshrrev_b32 v187, 18, v187
v_fma_mix_f32 v158, v177, v177, v158 op_sel:[1,1,0] op_sel_hi:[1,1,0]
v_fma_mix_f32 v159, v152, v152, v159 op_sel:[0,0,0] op_sel_hi:[1,1,0]
v_fma_mix_f32 v159, v152, v152, v159 op_sel:[1,1,0] op_sel_hi:[1,1,0]
v_fma_mix_f32 v159, v149, v149, v159 op_sel:[0,0,0] op_sel_hi:[1,1,0]
v_fma_mix_f32 v159, v149, v149, v159 op_sel:[1,1,0] op_sel_hi:[1,1,0]
s_cmp_lt_u32 s40, 4
s_cbranch_scc0 Lsu6
s_waitcnt vmcnt(8)
s_call_b64 s[78:79], Lw1c
s_mov_b64 exec, 1
ds_add_u32 v253, v254 offset:28
s_mov_b64 exec, -1
Lsu6:
v_cvt_pkrtz_f16_f32 v137, v120, v121
v_cvt_pkrtz_f16_f32 v139, v122, v123
v_cvt_pkrtz_f16_f32 v141, v124, v125
v_cvt_pkrtz_f16_f32 v143, v126, v127
v_cvt_pkrtz_f16_f32 v177, v128, v129
v_cvt_pk_f16_f32 v155, v130, v131
v_cvt_pk_f16_f32 v152, v132, v133
v_cvt_pk_f16_f32 v149, v134, v135
s_setprio 0
ds_read_b128 v[220:223], v248 offset:52224
ds_read_u16_d16 v186, v186
ds_read_u16_d16_hi v187, v187
v_mfma_f32_32x32x16_bf16 v[120:135], v[48:51], v[224:227], 0
v_pk_fma_f16 v154, v155, v155, s48
v_and_b32 v137, s49, v137
v_fma_mix_f32 v159, v178, v178, v159 op_sel:[0,0,0] op_sel_hi:[1,1,0]
v_pk_fma_f16 v151, v152, v152, s48
v_pk_fma_f16 v148, v149, v149, s48
v_lshrrev_b16 v136, 2, v137
v_pk_mul_f16 v154, v155, v154
v_pk_mul_f16 v151, v152, v151
v_fma_mix_f32 v159, v179, v179, v159 op_sel:[1,1,0] op_sel_hi:[1,1,0]
v_lshrrev_b32 v137, 18, v137
ds_read_b128 v[224:227], v250 offset:65520
ds_read_u16_d16 v136, v136
ds_read_u16_d16_hi v137, v137
v_mfma_f32_32x32x16_bf16 v[120:135], v[52:55], v[228:231], v[120:135]
v_pk_mul_f16 v148, v149, v148
v_exp_f16 v153, v154
v_exp_f16 v150, v151
v_and_b32 v139, s49, v139
v_fma_mix_f32 v159, v180, v180, v159 op_sel:[0,0,0] op_sel_hi:[1,1,0]
v_exp_f16 v147, v148
v_lshrrev_b16 v138, 2, v139
s_waitcnt lgkmcnt(7)
ds_read_b128 v[228:231], v248 offset:53248
ds_read_b32 v247, v253 offset:12
ds_read_u16_d16 v138, v138
v_mfma_f32_32x32x16_bf16 v[120:135], v[56:59], v[232:235], v[120:135]
v_exp_f16_sdwa v153, v154 dst_sel:WORD_1 dst_unused:UNUSED_PRESERVE src0_sel:WORD_1
v_lshrrev_b32 v139, 18, v139
v_fma_mix_f32 v159, v181, v181, v159 op_sel:[1,1,0] op_sel_hi:[1,1,0]
v_exp_f16_sdwa v150, v151 dst_sel:WORD_1 dst_unused:UNUSED_PRESERVE src0_sel:WORD_1
v_exp_f16_sdwa v147, v148 dst_sel:WORD_1 dst_unused:UNUSED_PRESERVE src0_sel:WORD_1
v_and_b32 v141, s49, v141
v_fma_mix_f32 v159, v182, v182, v159 op_sel:[0,0,0] op_sel_hi:[1,1,0]
ds_read_b128 v[232:235], v248 offset:56320
ds_read_u16_d16_hi v139, v139
v_mfma_f32_32x32x16_bf16 v[120:135], v[60:63], v[236:239], v[120:135]
v_pk_add_f16 v153, v153, 1.0 op_sel_hi:[1,0]
v_lshrrev_b16 v140, 2, v141
v_pk_add_f16 v150, v150, 1.0 op_sel_hi:[1,0]
v_pk_add_f16 v147, v147, 1.0 op_sel_hi:[1,0]
v_rcp_f16 v154, v153
v_lshrrev_b32 v141, 18, v141
ds_read_u16_d16 v140, v140
ds_read_u16_d16_hi v141, v141
s_waitcnt lgkmcnt(5)
v_readfirstlane_b32 s43, v247
s_nop 1
s_cmp_ge_u32 s43, 16
s_cbranch_scc1 Lev3
Lev3w:
s_sleep 1
ds_read_b32 v247, v253 offset:12
s_waitcnt lgkmcnt(0)
v_readfirstlane_b32 s43, v247
s_cmp_eq_u32 s76, 0
s_cbranch_scc1 Lev3
s_sub_u32 s76, s76, 1
s_cmp_lt_u32 s43, 16
s_cbranch_scc1 Lev3w
Lev3:
v_fma_mix_f32 v159, v183, v183, v159 op_sel:[1,1,0] op_sel_hi:[1,1,0]
v_rcp_f16 v151, v150
ds_read_b128 v[236:239], v245 offset:6528
ds_read_b128 v[192:195], v244 offset:128
ds_read_b128 v[196:199], v244 offset:64
v_mfma_f32_32x32x16_bf16 v[120:135], v[64:67], v[216:219], v[120:135]
v_and_b32 v143, s49, v143
v_rcp_f16 v148, v147
v_fma_mix_f32 v159, v184, v184, v159 op_sel:[0,0,0] op_sel_hi:[1,1,0]
v_lshrrev_b16 v142, 2, v143
v_rcp_f16_sdwa v154, v153 dst_sel:WORD_1 dst_unused:UNUSED_PRESERVE src0_sel:WORD_1
v_rcp_f16_sdwa v151, v150 dst_sel:WORD_1 dst_unused:UNUSED_PRESERVE src0_sel:WORD_1
v_lshrrev_b32 v143, 18, v143
ds_read_b128 v[216:219], v248 offset:54272
ds_read_u16_d16 v142, v142
ds_read_u16_d16_hi v143, v143
v_mfma_f32_32x32x16_bf16 v[120:135], v[68:71], v[220:223], v[120:135]
v_fma_mix_f32 v159, v185, v185, v159 op_sel:[1,1,0] op_sel_hi:[1,1,0]
v_rcp_f16_sdwa v148, v147 dst_sel:WORD_1 dst_unused:UNUSED_PRESERVE src0_sel:WORD_1
v_and_b32 v177, s49, v177
v_pk_mul_f16 v155, v155, v154
v_fma_mix_f32 v159, v186, v186, v159 op_sel:[0,0,0] op_sel_hi:[1,1,0]
v_pk_mul_f16 v152, v152, v151
v_lshrrev_b16 v176, 2, v177
v_pk_mul_f16 v149, v149, v148
v_fma_mix_f32 v160, v155, v155, 0 op_sel:[0,0,0] op_sel_hi:[1,1,0]
v_fma_mix_f32 v160, v155, v155, v160 op_sel:[1,1,0] op_sel_hi:[1,1,0]
v_lshrrev_b32 v177, 18, v177
v_fma_mix_f32 v159, v187, v187, v159 op_sel:[1,1,0] op_sel_hi:[1,1,0]
v_fma_mix_f32 v160, v152, v152, v160 op_sel:[0,0,0] op_sel_hi:[1,1,0]
v_fma_mix_f32 v160, v152, v152, v160 op_sel:[1,1,0] op_sel_hi:[1,1,0]
v_fma_mix_f32 v160, v149, v149, v160 op_sel:[0,0,0] op_sel_hi:[1,1,0]
v_fma_mix_f32 v160, v149, v149, v160 op_sel:[1,1,0] op_sel_hi:[1,1,0]
s_setprio 2
v_mfma_f32_32x32x16_bf16 v[0:15], v[224:227], v[224:227], 0
ds_read_b128 v[220:223], v245 offset:6144
ds_read_b128 v[200:203], v244
ds_read_b128 v[204:207], v243 offset:128
ds_read_u16_d16 v176, v176
ds_read_u16_d16_hi v177, v177
v_cvt_pkrtz_f16_f32 v179, v120, v121
v_cvt_pkrtz_f16_f32 v181, v122, v123
v_cvt_pkrtz_f16_f32 v183, v124, v125
v_mfma_f32_32x32x16_bf16 v[16:31], v[224:227], v[224:227], 0
v_cvt_pkrtz_f16_f32 v185, v126, v127
v_cvt_pkrtz_f16_f32 v187, v128, v129
v_cvt_pk_f16_f32 v155, v130, v131
v_mfma_f32_32x32x16_bf16 v[32:47], v[224:227], v[224:227], 0
v_cvt_pk_f16_f32 v152, v132, v133
v_cvt_pk_f16_f32 v149, v134, v135
v_pk_fma_f16 v154, v155, v155, s48
v_mfma_f32_32x32x16_bf16 v[120:135], v[48:51], v[228:231], 0
ds_read_b128 v[224:227], v248 offset:57344
v_and_b32 v179, s49, v179
v_fma_mix_f32 v160, v136, v136, v160 op_sel:[0,0,0] op_sel_hi:[1,1,0]
v_pk_fma_f16 v151, v152, v152, s48
v_pk_fma_f16 v148, v149, v149, s48
v_lshrrev_b16 v178, 2, v179
v_pk_mul_f16 v154, v155, v154
s_waitcnt lgkmcnt(6)
v_mfma_f32_32x32x16_bf16 v[120:135], v[52:55], v[232:235], v[120:135]
ds_read_b128 v[228:231], v245 offset:5760
ds_read_b128 v[208:211], v243 offset:64
ds_read_b128 v[212:215], v243
ds_read_u16_d16 v178, v178
v_pk_mul_f16 v151, v152, v151
v_fma_mix_f32 v160, v137, v137, v160 op_sel:[1,1,0] op_sel_hi:[1,1,0]
v_lshrrev_b32 v179, 18, v179
v_pk_mul_f16 v148, v149, v148
v_exp_f16 v153, v154
v_smfmac_f32_16x16x32_bf16 v[40:43], v[238:239], v[192:195], v246
ds_read_b128 v[232:235], v248 offset:55296
ds_read_u16_d16_hi v179, v179
v_exp_f16 v150, v151
v_and_b32 v181, s49, v181
v_smfmac_f32_16x16x32_bf16 v[24:27], v[236:237], v[196:199], v246
v_fma_mix_f32 v160, v138, v138, v160 op_sel:[0,0,0] op_sel_hi:[1,1,0]
v_exp_f16 v147, v148
v_mfma_f32_32x32x16_bf16 v[120:135], v[56:59], v[216:219], v[120:135]
ds_read_b128 v[236:239], v245 offset:5376
ds_read_b128 v[192:195], v242 offset:128
ds_read_b128 v[196:199], v242 offset:64
v_lshrrev_b16 v180, 2, v181
v_exp_f16_sdwa v153, v154 dst_sel:WORD_1 dst_unused:UNUSED_PRESERVE src0_sel:WORD_1
v_lshrrev_b32 v181, 18, v181
v_fma_mix_f32 v160, v139, v139, v160 op_sel:[1,1,0] op_sel_hi:[1,1,0]
s_waitcnt lgkmcnt(8)
v_smfmac_f32_16x16x32_bf16 v[8:11], v[222:223], v[200:203], v246
ds_read_b128 v[216:219], v248 offset:58368
ds_read_u16_d16 v180, v180
ds_read_u16_d16_hi v181, v181
v_exp_f16_sdwa v150, v151 dst_sel:WORD_1 dst_unused:UNUSED_PRESERVE src0_sel:WORD_1
v_exp_f16_sdwa v147, v148 dst_sel:WORD_1 dst_unused:UNUSED_PRESERVE src0_sel:WORD_1
v_smfmac_f32_16x16x32_bf16 v[40:43], v[220:221], v[204:207], v246
v_and_b32 v183, s49, v183
v_fma_mix_f32 v160, v140, v140, v160 op_sel:[0,0,0] op_sel_hi:[1,1,0]
v_pk_add_f16 v153, v153, 1.0 op_sel_hi:[1,0]
v_mfma_f32_32x32x16_bf16 v[120:135], v[60:63], v[224:227], v[120:135]
ds_read_b128 v[220:223], v245 offset:4992
ds_read_b128 v[200:203], v242
v_xor_b32 v244, 16, v244
ds_read_b128 v[204:207], v244 offset:128
v_lshrrev_b16 v182, 2, v183
v_pk_add_f16 v150, v150, 1.0 op_sel_hi:[1,0]
v_pk_add_f16 v147, v147, 1.0 op_sel_hi:[1,0]
v_rcp_f16 v154, v153
v_lshrrev_b32 v183, 18, v183
s_waitcnt lgkmcnt(6)
v_smfmac_f32_16x16x32_bf16 v[24:27], v[230:231], v[208:211], v246
ds_read_b128 v[224:227], v245 offset:4608
ds_read_u16_d16 v182, v182
ds_read_u16_d16_hi v183, v183
v_fma_mix_f32 v160, v141, v141, v160 op_sel:[1,1,0] op_sel_hi:[1,1,0]
v_rcp_f16 v151, v150
v_smfmac_f32_16x16x32_bf16 v[8:11], v[228:229], v[212:215], v246
v_and_b32 v185, s49, v185
v_rcp_f16 v148, v147
v_mfma_f32_32x32x16_bf16 v[120:135], v[64:67], v[232:235], v[120:135]
ds_read_b128 v[208:211], v244 offset:64
ds_read_b128 v[212:215], v244
ds_read_b128 v[228:231], v248 offset:59392
v_fma_mix_f32 v160, v142, v142, v160 op_sel:[0,0,0] op_sel_hi:[1,1,0]
v_lshrrev_b16 v184, 2, v185
v_rcp_f16_sdwa v154, v153 dst_sel:WORD_1 dst_unused:UNUSED_PRESERVE src0_sel:WORD_1
v_rcp_f16_sdwa v151, v150 dst_sel:WORD_1 dst_unused:UNUSED_PRESERVE src0_sel:WORD_1
v_smfmac_f32_16x16x32_bf16 v[40:43], v[238:239], v[192:195], v246
ds_read_b128 v[232:235], v248 offset:62464
ds_read_u16_d16 v184, v184
ds_read_b32 v247, v253 offset:28
v_lshrrev_b32 v185, 18, v185
v_fma_mix_f32 v160, v143, v143, v160 op_sel:[1,1,0] op_sel_hi:[1,1,0]
v_smfmac_f32_16x16x32_bf16 v[24:27], v[236:237], v[196:199], v246
v_rcp_f16_sdwa v148, v147 dst_sel:WORD_1 dst_unused:UNUSED_PRESERVE src0_sel:WORD_1
v_and_b32 v187, s49, v187
v_pk_mul_f16 v155, v155, v154
s_waitcnt lgkmcnt(7)
v_mfma_f32_32x32x16_bf16 v[120:135], v[68:71], v[216:219], v[120:135]
ds_read_b128 v[236:239], v248 offset:60416
ds_read_u16_d16_hi v185, v185
v_fma_mix_f32 v160, v176, v176, v160 op_sel:[0,0,0] op_sel_hi:[1,1,0]
v_pk_mul_f16 v152, v152, v151
v_lshrrev_b16 v186, 2, v187
v_pk_mul_f16 v149, v149, v148
v_fma_mix_f32 v161, v155, v155, 0 op_sel:[0,0,0] op_sel_hi:[1,1,0]
v_fma_mix_f32 v161, v155, v155, v161 op_sel:[1,1,0] op_sel_hi:[1,1,0]
v_smfmac_f32_16x16x32_bf16 v[8:11], v[222:223], v[200:203], v246
ds_read_b128 v[216:219], v245 offset:4224
v_xor_b32 v243, 16, v243
ds_read_b128 v[192:195], v243 offset:128
ds_read_b128 v[196:199], v243 offset:64
ds_read_u16_d16 v186, v186
v_lshrrev_b32 v187, 18, v187
v_fma_mix_f32 v160, v177, v177, v160 op_sel:[1,1,0] op_sel_hi:[1,1,0]
v_fma_mix_f32 v161, v152, v152, v161 op_sel:[0,0,0] op_sel_hi:[1,1,0]
v_smfmac_f32_16x16x32_bf16 v[44:47], v[220:221], v[204:207], v246
v_fma_mix_f32 v161, v152, v152, v161 op_sel:[1,1,0] op_sel_hi:[1,1,0]
v_fma_mix_f32 v161, v149, v149, v161 op_sel:[0,0,0] op_sel_hi:[1,1,0]
v_fma_mix_f32 v161, v149, v149, v161 op_sel:[1,1,0] op_sel_hi:[1,1,0]
s_cmp_lg_u32 s40, 7
s_cbranch_scc1 Lnosent
v_mov_b32 v104, -1
v_mov_b32 v105, -1
v_mov_b32 v106, -1
v_mov_b32 v107, -1
v_lshlrev_b32 v100, 12, v251
v_add_u32 v101, 262144, v100
v_cmp_gt_u32 vcc, 32, v251
v_mov_b32 v102, 2147483648
s_nop 0
v_cndmask_b32 v101, v102, v101, vcc
s_lshl_b32 s43, s2, 4
buffer_store_dwordx4 v[104:107], v100, s[32:35], s43 offen sc1
buffer_store_dwordx4 v[104:107], v101, s[32:35], s43 offen sc1
s_add_u32 s43, s43, 393216
s_cmp_lt_u32 s2, 96
s_cselect_b32 s43, s43, 1073741824
v_lshlrev_b32 v102, 11, v251
s_mov_b64 exec, 0xff
buffer_store_dwordx4 v[104:107], v102, s[32:35], s43 offen sc1
s_mov_b64 exec, -1
s_sub_u32 s43, s2, 96
s_cmp_lt_u32 s43, 96
s_cbranch_scc0 Lnobias
s_lshl_b32 s44, s43, 1
v_mul_u32_u24 v100, 192, v251
v_lshlrev_b32 v101, 1, v251
s_add_u32 s45, s44, 0
buffer_load_ushort v102, v100, s[16:19], s45 offen
buffer_load_ushort v108, v101, s[28:31], 0 offen offset:0
s_add_u32 s45, s44, 12288
buffer_load_ushort v103, v100, s[16:19], s45 offen
buffer_load_ushort v109, v101, s[28:31], 0 offen offset:128
s_add_u32 s45, s44, 24576
buffer_load_ushort v104, v100, s[16:19], s45 offen
buffer_load_ushort v110, v101, s[28:31], 0 offen offset:256
s_add_u32 s45, s44, 36864
buffer_load_ushort v105, v100, s[16:19], s45 offen
buffer_load_ushort v111, v101, s[28:31], 0 offen offset:384
s_add_u32 s45, s44, 49152
buffer_load_ushort v106, v100, s[16:19], s45 offen
buffer_load_ushort v112, v101, s[28:31], 0 offen offset:512
s_add_u32 s45, s44, 61440
buffer_load_ushort v107, v100, s[16:19], s45 offen
buffer_load_ushort v113, v101, s[28:31], 0 offen offset:640
Lnobias:
s_nop 1
Lnosent:
ds_read_u16_d16_hi v187, v187
s_waitcnt lgkmcnt(1)
v_readfirstlane_b32 s43, v247
s_nop 1
s_cmp_ge_u32 s43, 12
s_cbranch_scc1 Lev4
Lev4w:
s_sleep 1
ds_read_b32 v247, v253 offset:28
s_waitcnt lgkmcnt(0)
v_readfirstlane_b32 s43, v247
s_cmp_eq_u32 s76, 0
s_cbranch_scc1 Lev4
s_sub_u32 s76, s76, 1
s_cmp_lt_u32 s43, 12
s_cbranch_scc1 Lev4w
Lev4:
s_setprio 1
v_smfmac_f32_16x16x32_bf16 v[28:31], v[226:227], v[208:211], v246
ds_read_b128 v[220:223], v248 offset:63488
v_cvt_pkrtz_f16_f32 v137, v120, v121
v_cvt_pkrtz_f16_f32 v139, v122, v123
v_cvt_pkrtz_f16_f32 v141, v124, v125
v_cvt_pkrtz_f16_f32 v143, v126, v127
v_smfmac_f32_16x16x32_bf16 v[12:15], v[224:225], v[212:215], v246
v_cvt_pk_f16_f32 v155, v128, v129
v_cvt_pk_f16_f32 v152, v130, v131
v_cvt_pk_f16_f32 v149, v132, v133
v_cvt_pk_f16_f32 v146, v134, v135
v_mfma_f32_32x32x16_bf16 v[120:135], v[48:51], v[228:231], 0
ds_read_b128 v[224:227], v248 offset:61440
v_pk_fma_f16 v154, v155, v155, s48
v_and_b32 v137, s49, v137
v_fma_mix_f32 v161, v178, v178, v161 op_sel:[0,0,0] op_sel_hi:[1,1,0]
v_pk_fma_f16 v151, v152, v152, s48
v_pk_fma_f16 v148, v149, v149, s48
v_pk_fma_f16 v145, v146, v146, s48
v_pk_mul_f16 v154, v155, v154
v_lshrrev_b16 v136, 2, v137
v_pk_mul_f16 v151, v152, v151
v_mfma_f32_32x32x16_bf16 v[120:135], v[52:55], v[232:235], v[120:135]
ds_read_b128 v[228:231], v245 offset:3840
ds_read_b128 v[200:203], v243
v_xor_b32 v242, 16, v242
ds_read_b128 v[204:207], v242 offset:128
ds_read_u16_d16 v136, v136
v_fma_mix_f32 v161, v179, v179, v161 op_sel:[1,1,0] op_sel_hi:[1,1,0]
v_pk_mul_f16 v148, v149, v148
v_pk_mul_f16 v145, v146, v145
v_exp_f16 v153, v154
v_lshrrev_b32 v137, 18, v137
v_exp_f16 v150, v151
v_mfma_f32_32x32x16_bf16 v[120:135], v[56:59], v[236:239], v[120:135]
ds_read_b128 v[232:235], v248 offset:64512
ds_read_u16_d16_hi v137, v137
v_fma_mix_f32 v161, v180, v180, v161 op_sel:[0,0,0] op_sel_hi:[1,1,0]
v_exp_f16 v147, v148
v_and_b32 v139, s49, v139
v_exp_f16 v144, v145
v_exp_f16_sdwa v153, v154 dst_sel:WORD_1 dst_unused:UNUSED_PRESERVE src0_sel:WORD_1
v_fma_mix_f32 v161, v181, v181, v161 op_sel:[1,1,0] op_sel_hi:[1,1,0]
v_smfmac_f32_16x16x32_bf16 v[44:47], v[218:219], v[192:195], v246
ds_read_b128 v[236:239], v245 offset:3456
ds_read_b128 v[208:211], v242 offset:64
ds_read_b128 v[212:215], v242
v_lshrrev_b16 v138, 2, v139
v_exp_f16_sdwa v150, v151 dst_sel:WORD_1 dst_unused:UNUSED_PRESERVE src0_sel:WORD_1
v_smfmac_f32_16x16x32_bf16 v[28:31], v[216:217], v[196:199], v246
v_exp_f16_sdwa v147, v148 dst_sel:WORD_1 dst_unused:UNUSED_PRESERVE src0_sel:WORD_1
v_exp_f16_sdwa v144, v145 dst_sel:WORD_1 dst_unused:UNUSED_PRESERVE src0_sel:WORD_1
v_lshrrev_b32 v139, 18, v139
s_waitcnt lgkmcnt(5)
v_mfma_f32_32x32x16_bf16 v[120:135], v[60:63], v[220:223], v[120:135]
ds_read_b128 v[216:219], v245 offset:3072
v_xor_b32 v244, 32, v244
ds_read_b128 v[192:195], v244 offset:128
ds_read_b128 v[196:199], v244 offset:64
ds_read_u16_d16 v138, v138
ds_read_u16_d16_hi v139, v139
v_fma_mix_f32 v161, v182, v182, v161 op_sel:[0,0,0] op_sel_hi:[1,1,0]
v_pk_add_f16 v153, v153, 1.0 op_sel_hi:[1,0]
v_pk_add_f16 v150, v150, 1.0 op_sel_hi:[1,0]
v_pk_add_f16 v147, v147, 1.0 op_sel_hi:[1,0]
v_and_b32 v141, s49, v141
v_pk_add_f16 v144, v144, 1.0 op_sel_hi:[1,0]
v_rcp_f16 v154, v153
v_fma_mix_f32 v161, v183, v183, v161 op_sel:[1,1,0] op_sel_hi:[1,1,0]
v_mfma_f32_32x32x16_bf16 v[120:135], v[64:67], v[224:227], v[120:135]
ds_read_b128 v[220:223], v249
v_rcp_f16 v151, v150
v_lshrrev_b16 v140, 2, v141
v_rcp_f16 v148, v147
v_fma_mix_f32 v161, v184, v184, v161 op_sel:[0,0,0] op_sel_hi:[1,1,0]
v_rcp_f16 v145, v144
v_lshrrev_b32 v141, 18, v141
v_smfmac_f32_16x16x32_bf16 v[12:15], v[230:231], v[200:203], v246
ds_read_b128 v[224:227], v249 offset:3072
ds_read_u16_d16 v140, v140
ds_read_u16_d16_hi v141, v141
v_rcp_f16_sdwa v154, v153 dst_sel:WORD_1 dst_unused:UNUSED_PRESERVE src0_sel:WORD_1
s_setprio 0
v_rcp_f16_sdwa v151, v150 dst_sel:WORD_1 dst_unused:UNUSED_PRESERVE src0_sel:WORD_1
v_smfmac_f32_16x16x32_bf16 v[44:47], v[228:229], v[204:207], v246
v_fma_mix_f32 v161, v185, v185, v161 op_sel:[1,1,0] op_sel_hi:[1,1,0]
v_and_b32 v143, s49, v143
v_rcp_f16_sdwa v148, v147 dst_sel:WORD_1 dst_unused:UNUSED_PRESERVE src0_sel:WORD_1
s_waitcnt lgkmcnt(4)
v_mfma_f32_32x32x16_bf16 v[120:135], v[68:71], v[232:235], v[120:135]
ds_read_b128 v[228:231], v245 offset:2688
ds_read_b128 v[200:203], v244
v_xor_b32 v243, 32, v243
ds_read_b128 v[204:207], v243 offset:128
v_rcp_f16_sdwa v145, v144 dst_sel:WORD_1 dst_unused:UNUSED_PRESERVE src0_sel:WORD_1
v_pk_mul_f16 v155, v155, v154
v_lshrrev_b16 v142, 2, v143
v_fma_mix_f32 v161, v186, v186, v161 op_sel:[0,0,0] op_sel_hi:[1,1,0]
v_pk_mul_f16 v152, v152, v151
v_pk_mul_f16 v149, v149, v148
v_pk_mul_f16 v146, v146, v145
v_fma_mix_f32 v162, v155, v155, 0 op_sel:[0,0,0] op_sel_hi:[1,1,0]
v_smfmac_f32_16x16x32_bf16 v[28:31], v[238:239], v[208:211], v246
ds_read_b128 v[232:235], v249 offset:1024
ds_read_u16_d16 v142, v142
v_lshrrev_b32 v143, 18, v143
v_fma_mix_f32 v162, v155, v155, v162 op_sel:[1,1,0] op_sel_hi:[1,1,0]
v_fma_mix_f32 v162, v152, v152, v162 op_sel:[0,0,0] op_sel_hi:[1,1,0]
v_fma_mix_f32 v161, v187, v187, v161 op_sel:[1,1,0] op_sel_hi:[1,1,0]
v_smfmac_f32_16x16x32_bf16 v[12:15], v[236:237], v[212:215], v246
v_fma_mix_f32 v162, v152, v152, v162 op_sel:[1,1,0] op_sel_hi:[1,1,0]
v_fma_mix_f32 v162, v149, v149, v162 op_sel:[0,0,0] op_sel_hi:[1,1,0]
v_fma_mix_f32 v162, v149, v149, v162 op_sel:[1,1,0] op_sel_hi:[1,1,0]
v_fma_mix_f32 v162, v146, v146, v162 op_sel:[0,0,0] op_sel_hi:[1,1,0]
v_fma_mix_f32 v162, v146, v146, v162 op_sel:[1,1,0] op_sel_hi:[1,1,0]
v_lshlrev_b32 v252, 7, v251
s_add_u32 s46, s47, 1572864
s_mov_b32 exec_lo, 131071
s_mov_b32 exec_hi, 0
s_mov_b32 m0, 16288
s_nop 0
buffer_load_dword v252, s[4:7], s46 offen lds
s_mov_b64 exec, -1
s_setprio 2
v_smfmac_f32_16x16x32_bf16 v[36:39], v[218:219], v[192:195], v246
ds_read_b128 v[236:239], v249 offset:4096
ds_read_u16_d16_hi v143, v143
v_cvt_pkrtz_f16_f32 v179, v120, v121
v_cvt_pkrtz_f16_f32 v181, v122, v123
v_cvt_pkrtz_f16_f32 v183, v124, v125
v_smfmac_f32_16x16x32_bf16 v[20:23], v[216:217], v[196:199], v246
v_cvt_pkrtz_f16_f32 v185, v126, v127
v_cvt_pkrtz_f16_f32 v187, v128, v129
v_cvt_pk_f16_f32 v155, v130, v131
v_cvt_pk_f16_f32 v152, v132, v133
v_cvt_pk_f16_f32 v149, v134, v135
s_waitcnt lgkmcnt(2)
v_mfma_f32_32x32x16_bf16 v[120:135], v[48:51], v[220:223], 0
ds_read_b128 v[216:219], v245 offset:2304
ds_read_b128 v[208:211], v243 offset:64
ds_read_b128 v[212:215], v243
v_pk_fma_f16 v154, v155, v155, s48
v_and_b32 v179, s49, v179
v_fma_mix_f32 v162, v136, v136, v162 op_sel:[0,0,0] op_sel_hi:[1,1,0]
v_pk_fma_f16 v151, v152, v152, s48
v_pk_fma_f16 v148, v149, v149, s48
v_mfma_f32_32x32x16_bf16 v[120:135], v[52:55], v[224:227], v[120:135]
ds_read_b128 v[220:223], v249 offset:2048
v_lshrrev_b16 v178, 2, v179
v_pk_mul_f16 v154, v155, v154
v_pk_mul_f16 v151, v152, v151
v_pk_mul_f16 v148, v149, v148
v_lshrrev_b32 v179, 18, v179
v_fma_mix_f32 v162, v137, v137, v162 op_sel:[1,1,0] op_sel_hi:[1,1,0]
v_smfmac_f32_16x16x32_bf16 v[4:7], v[230:231], v[200:203], v246
ds_read_b128 v[224:227], v245 offset:1920
v_xor_b32 v242, 32, v242
ds_read_b128 v[192:195], v242 offset:128
ds_read_b128 v[196:199], v242 offset:64
ds_read_u16_d16 v178, v178
ds_read_u16_d16_hi v179, v179
v_exp_f16 v153, v154
v_and_b32 v181, s49, v181
v_smfmac_f32_16x16x32_bf16 v[36:39], v[228:229], v[204:207], v246
v_exp_f16 v150, v151
v_exp_f16 v147, v148
v_mfma_f32_32x32x16_bf16 v[120:135], v[56:59], v[232:235], v[120:135]
ds_read_b128 v[228:231], v249 offset:5120
v_lshrrev_b16 v180, 2, v181
v_fma_mix_f32 v162, v138, v138, v162 op_sel:[0,0,0] op_sel_hi:[1,1,0]
v_exp_f16_sdwa v153, v154 dst_sel:WORD_1 dst_unused:UNUSED_PRESERVE src0_sel:WORD_1
v_lshrrev_b32 v181, 18, v181
v_exp_f16_sdwa v150, v151 dst_sel:WORD_1 dst_unused:UNUSED_PRESERVE src0_sel:WORD_1
s_waitcnt lgkmcnt(6)
v_mfma_f32_32x32x16_bf16 v[120:135], v[60:63], v[236:239], v[120:135]
ds_read_b128 v[232:235], v245 offset:1536
ds_read_b128 v[200:203], v242
v_xor_b32 v244, 16, v244
ds_read_b128 v[204:207], v244 offset:128
ds_read_u16_d16 v180, v180
ds_read_u16_d16_hi v181, v181
v_fma_mix_f32 v162, v139, v139, v162 op_sel:[1,1,0] op_sel_hi:[1,1,0]
v_and_b32 v183, s49, v183
v_exp_f16_sdwa v147, v148 dst_sel:WORD_1 dst_unused:UNUSED_PRESERVE src0_sel:WORD_1
v_pk_add_f16 v153, v153, 1.0 op_sel_hi:[1,0]
v_lshrrev_b16 v182, 2, v183
v_smfmac_f32_16x16x32_bf16 v[20:23], v[218:219], v[208:211], v246
ds_read_b128 v[236:239], v245 offset:1152
ds_read_u16_d16 v182, v182
v_pk_add_f16 v150, v150, 1.0 op_sel_hi:[1,0]
v_pk_add_f16 v147, v147, 1.0 op_sel_hi:[1,0]
v_rcp_f16 v154, v153
v_smfmac_f32_16x16x32_bf16 v[4:7], v[216:217], v[212:215], v246
v_lshrrev_b32 v183, 18, v183
v_fma_mix_f32 v162, v140, v140, v162 op_sel:[0,0,0] op_sel_hi:[1,1,0]
v_mfma_f32_32x32x16_bf16 v[120:135], v[64:67], v[220:223], v[120:135]
ds_read_b128 v[208:211], v244 offset:64
ds_read_b128 v[212:215], v244
ds_read_b128 v[216:219], v249 offset:6144
ds_read_u16_d16_hi v183, v183
v_rcp_f16 v151, v150
v_and_b32 v185, s49, v185
v_rcp_f16 v148, v147
v_fma_mix_f32 v162, v141, v141, v162 op_sel:[1,1,0] op_sel_hi:[1,1,0]
v_lshrrev_b16 v184, 2, v185
s_waitcnt lgkmcnt(6)
v_smfmac_f32_16x16x32_bf16 v[36:39], v[226:227], v[192:195], v246
ds_read_b128 v[220:223], v249 offset:9216
ds_read_u16_d16 v184, v184
v_rcp_f16_sdwa v154, v153 dst_sel:WORD_1 dst_unused:UNUSED_PRESERVE src0_sel:WORD_1
v_rcp_f16_sdwa v151, v150 dst_sel:WORD_1 dst_unused:UNUSED_PRESERVE src0_sel:WORD_1
v_smfmac_f32_16x16x32_bf16 v[20:23], v[224:225], v[196:199], v246
v_lshrrev_b32 v185, 18, v185
v_rcp_f16_sdwa v148, v147 dst_sel:WORD_1 dst_unused:UNUSED_PRESERVE src0_sel:WORD_1
v_mfma_f32_32x32x16_bf16 v[120:135], v[68:71], v[228:231], v[120:135]
ds_read_b128 v[224:227], v249 offset:7168
ds_read_u16_d16_hi v185, v185
v_and_b32 v187, s49, v187
v_fma_mix_f32 v162, v142, v142, v162 op_sel:[0,0,0] op_sel_hi:[1,1,0]
v_pk_mul_f16 v155, v155, v154
v_pk_mul_f16 v152, v152, v151
v_lshrrev_b16 v186, 2, v187
v_pk_mul_f16 v149, v149, v148
v_fma_mix_f32 v163, v155, v155, 0 op_sel:[0,0,0] op_sel_hi:[1,1,0]
v_smfmac_f32_16x16x32_bf16 v[4:7], v[234:235], v[200:203], v246
ds_read_b128 v[228:231], v245 offset:768
v_xor_b32 v243, 16, v243
ds_read_b128 v[192:195], v243 offset:128
ds_read_b128 v[196:199], v243 offset:64
ds_read_u16_d16 v186, v186
v_fma_mix_f32 v162, v143, v143, v162 op_sel:[1,1,0] op_sel_hi:[1,1,0]
v_lshrrev_b32 v187, 18, v187
v_fma_mix_f32 v163, v155, v155, v163 op_sel:[1,1,0] op_sel_hi:[1,1,0]
v_smfmac_f32_16x16x32_bf16 v[32:35], v[232:233], v[204:207], v246
v_fma_mix_f32 v163, v152, v152, v163 op_sel:[0,0,0] op_sel_hi:[1,1,0]
v_fma_mix_f32 v163, v152, v152, v163 op_sel:[1,1,0] op_sel_hi:[1,1,0]
v_fma_mix_f32 v163, v149, v149, v163 op_sel:[0,0,0] op_sel_hi:[1,1,0]
v_fma_mix_f32 v163, v149, v149, v163 op_sel:[1,1,0] op_sel_hi:[1,1,0]
v_lshlrev_b32 v252, 7, v251
s_add_u32 s46, s47, 1572864
s_mov_b32 exec_lo, 4294836224
s_mov_b32 exec_hi, 3
s_mov_b32 m0, 16220
s_nop 0
buffer_load_dword v252, s[4:7], s46 offen lds
s_mov_b64 exec, -1
s_setprio 1
s_waitcnt lgkmcnt(4)
v_smfmac_f32_16x16x32_bf16 v[16:19], v[238:239], v[208:211], v246
ds_read_b128 v[232:235], v249 offset:10240
ds_read_u16_d16_hi v187, v187
v_cvt_pkrtz_f16_f32 v137, v120, v121
v_cvt_pkrtz_f16_f32 v139, v122, v123
v_cvt_pkrtz_f16_f32 v141, v124, v125
v_smfmac_f32_16x16x32_bf16 v[0:3], v[236:237], v[212:215], v246
v_cvt_pkrtz_f16_f32 v143, v126, v127
v_cvt_pk_f16_f32 v155, v128, v129
v_cvt_pk_f16_f32 v152, v130, v131
v_cvt_pk_f16_f32 v149, v132, v133
v_cvt_pk_f16_f32 v146, v134, v135
v_mfma_f32_32x32x16_bf16 v[120:135], v[48:51], v[216:219], 0
ds_read_b128 v[236:239], v249 offset:8192
v_pk_fma_f16 v154, v155, v155, s48
v_and_b32 v137, s49, v137
v_fma_mix_f32 v163, v178, v178, v163 op_sel:[0,0,0] op_sel_hi:[1,1,0]
v_pk_fma_f16 v151, v152, v152, s48
v_pk_fma_f16 v148, v149, v149, s48
v_pk_fma_f16 v145, v146, v146, s48
v_pk_mul_f16 v154, v155, v154
v_mfma_f32_32x32x16_bf16 v[120:135], v[52:55], v[220:223], v[120:135]
ds_read_b128 v[216:219], v245 offset:384
ds_read_b128 v[200:203], v243
v_xor_b32 v242, 16, v242
ds_read_b128 v[204:207], v242 offset:128
v_lshrrev_b16 v136, 2, v137
v_pk_mul_f16 v151, v152, v151
v_fma_mix_f32 v163, v179, v179, v163 op_sel:[1,1,0] op_sel_hi:[1,1,0]
v_pk_mul_f16 v148, v149, v148
v_pk_mul_f16 v145, v146, v145
v_exp_f16 v153, v154
v_lshrrev_b32 v137, 18, v137
v_mfma_f32_32x32x16_bf16 v[120:135], v[56:59], v[224:227], v[120:135]
ds_read_b128 v[220:223], v249 offset:11264
ds_read_u16_d16 v136, v136
ds_read_u16_d16_hi v137, v137
v_exp_f16 v150, v151
v_fma_mix_f32 v163, v180, v180, v163 op_sel:[0,0,0] op_sel_hi:[1,1,0]
v_exp_f16 v147, v148
v_and_b32 v139, s49, v139
v_exp_f16 v144, v145
s_waitcnt lgkmcnt(6)
v_smfmac_f32_16x16x32_bf16 v[32:35], v[230:231], v[192:195], v246
ds_read_b128 v[224:227], v245
ds_read_b128 v[208:211], v242 offset:64
ds_read_b128 v[212:215], v242
v_exp_f16_sdwa v153, v154 dst_sel:WORD_1 dst_unused:UNUSED_PRESERVE src0_sel:WORD_1
v_fma_mix_f32 v163, v181, v181, v163 op_sel:[1,1,0] op_sel_hi:[1,1,0]
v_lshrrev_b16 v138, 2, v139
v_smfmac_f32_16x16x32_bf16 v[16:19], v[228:229], v[196:199], v246
v_exp_f16_sdwa v150, v151 dst_sel:WORD_1 dst_unused:UNUSED_PRESERVE src0_sel:WORD_1
v_mfma_f32_32x32x16_bf16 v[120:135], v[60:63], v[232:235], v[120:135]
ds_read_b128 v[228:231], v249 offset:12288
ds_read_u16_d16 v138, v138
v_exp_f16_sdwa v147, v148 dst_sel:WORD_1 dst_unused:UNUSED_PRESERVE src0_sel:WORD_1
v_exp_f16_sdwa v144, v145 dst_sel:WORD_1 dst_unused:UNUSED_PRESERVE src0_sel:WORD_1
v_lshrrev_b32 v139, 18, v139
v_fma_mix_f32 v163, v182, v182, v163 op_sel:[0,0,0] op_sel_hi:[1,1,0]
v_pk_add_f16 v153, v153, 1.0 op_sel_hi:[1,0]
v_pk_add_f16 v150, v150, 1.0 op_sel_hi:[1,0]
v_pk_add_f16 v147, v147, 1.0 op_sel_hi:[1,0]
v_mfma_f32_32x32x16_bf16 v[120:135], v[64:67], v[236:239], v[120:135]
ds_read_b128 v[232:235], v249 offset:15360
ds_read_u16_d16_hi v139, v139
v_and_b32 v141, s49, v141
v_pk_add_f16 v144, v144, 1.0 op_sel_hi:[1,0]
v_rcp_f16 v154, v153
v_fma_mix_f32 v163, v183, v183, v163 op_sel:[1,1,0] op_sel_hi:[1,1,0]
v_rcp_f16 v151, v150
v_lshrrev_b16 v140, 2, v141
s_waitcnt lgkmcnt(4)
v_smfmac_f32_16x16x32_bf16 v[0:3], v[218:219], v[200:203], v246
ds_read_b128 v[236:239], v249 offset:13312
ds_read_u16_d16 v140, v140
v_rcp_f16 v148, v147
v_fma_mix_f32 v163, v184, v184, v163 op_sel:[0,0,0] op_sel_hi:[1,1,0]
v_smfmac_f32_16x16x32_bf16 v[32:35], v[216:217], v[204:207], v246
v_rcp_f16 v145, v144
v_lshrrev_b32 v141, 18, v141
v_rcp_f16_sdwa v154, v153 dst_sel:WORD_1 dst_unused:UNUSED_PRESERVE src0_sel:WORD_1
s_setprio 0
v_mfma_f32_32x32x16_bf16 v[120:135], v[68:71], v[220:223], v[120:135]
ds_read_b128 v[216:219], v249 offset:16384
ds_read_u16_d16_hi v141, v141
v_rcp_f16_sdwa v151, v150 dst_sel:WORD_1 dst_unused:UNUSED_PRESERVE src0_sel:WORD_1
v_fma_mix_f32 v163, v185, v185, v163 op_sel:[1,1,0] op_sel_hi:[1,1,0]
v_and_b32 v143, s49, v143
v_rcp_f16_sdwa v148, v147 dst_sel:WORD_1 dst_unused:UNUSED_PRESERVE src0_sel:WORD_1
v_rcp_f16_sdwa v145, v144 dst_sel:WORD_1 dst_unused:UNUSED_PRESERVE src0_sel:WORD_1
v_smfmac_f32_16x16x32_bf16 v[16:19], v[226:227], v[208:211], v246
ds_read_b128 v[220:223], v249 offset:14336
v_pk_mul_f16 v155, v155, v154
v_lshrrev_b16 v142, 2, v143
v_fma_mix_f32 v163, v186, v186, v163 op_sel:[0,0,0] op_sel_hi:[1,1,0]
v_pk_mul_f16 v152, v152, v151
v_smfmac_f32_16x16x32_bf16 v[0:3], v[224:225], v[212:215], v246
s_mov_b64 exec, 1
ds_add_u32 v253, v254 offset:16
s_mov_b64 exec, -1
v_pk_mul_f16 v149, v149, v148
v_pk_mul_f16 v146, v146, v145
v_fma_mix_f32 v164, v155, v155, 0 op_sel:[0,0,0] op_sel_hi:[1,1,0]
v_lshrrev_b32 v143, 18, v143
v_fma_mix_f32 v164, v155, v155, v164 op_sel:[1,1,0] op_sel_hi:[1,1,0]
v_fma_mix_f32 v164, v152, v152, v164 op_sel:[0,0,0] op_sel_hi:[1,1,0]
v_fma_mix_f32 v163, v187, v187, v163 op_sel:[1,1,0] op_sel_hi:[1,1,0]
v_fma_mix_f32 v164, v152, v152, v164 op_sel:[1,1,0] op_sel_hi:[1,1,0]
v_fma_mix_f32 v164, v149, v149, v164 op_sel:[0,0,0] op_sel_hi:[1,1,0]
v_fma_mix_f32 v164, v149, v149, v164 op_sel:[1,1,0] op_sel_hi:[1,1,0]
v_fma_mix_f32 v164, v146, v146, v164 op_sel:[0,0,0] op_sel_hi:[1,1,0]
v_fma_mix_f32 v164, v146, v146, v164 op_sel:[1,1,0] op_sel_hi:[1,1,0]
s_setprio 3
v_pk_add_f32 v[168:169], v[0:1], v[2:3]
v_pk_mul_f32 v[170:171], v[0:1], v[0:1]
v_pk_fma_f32 v[170:171], v[2:3], v[2:3], v[170:171]
v_pk_add_f32 v[168:169], v[168:169], v[4:5]
v_pk_fma_f32 v[170:171], v[4:5], v[4:5], v[170:171]
v_pk_add_f32 v[168:169], v[168:169], v[6:7]
v_pk_fma_f32 v[170:171], v[6:7], v[6:7], v[170:171]
v_pk_add_f32 v[168:169], v[168:169], v[8:9]
v_pk_fma_f32 v[170:171], v[8:9], v[8:9], v[170:171]
v_pk_add_f32 v[168:169], v[168:169], v[10:11]
v_pk_fma_f32 v[170:171], v[10:11], v[10:11], v[170:171]
v_pk_add_f32 v[168:169], v[168:169], v[12:13]
v_pk_fma_f32 v[170:171], v[12:13], v[12:13], v[170:171]
v_pk_add_f32 v[168:169], v[168:169], v[14:15]
v_pk_fma_f32 v[170:171], v[14:15], v[14:15], v[170:171]
v_pk_add_f32 v[168:169], v[168:169], v[16:17]
v_pk_fma_f32 v[170:171], v[16:17], v[16:17], v[170:171]
v_pk_add_f32 v[168:169], v[168:169], v[18:19]
v_pk_fma_f32 v[170:171], v[18:19], v[18:19], v[170:171]
v_pk_add_f32 v[168:169], v[168:169], v[20:21]
v_pk_fma_f32 v[170:171], v[20:21], v[20:21], v[170:171]
v_pk_add_f32 v[168:169], v[168:169], v[22:23]
v_pk_fma_f32 v[170:171], v[22:23], v[22:23], v[170:171]
v_pk_add_f32 v[168:169], v[168:169], v[24:25]
v_pk_fma_f32 v[170:171], v[24:25], v[24:25], v[170:171]
v_pk_add_f32 v[168:169], v[168:169], v[26:27]
v_pk_fma_f32 v[170:171], v[26:27], v[26:27], v[170:171]
v_pk_add_f32 v[168:169], v[168:169], v[28:29]
v_pk_fma_f32 v[170:171], v[28:29], v[28:29], v[170:171]
v_pk_add_f32 v[168:169], v[168:169], v[30:31]
v_pk_fma_f32 v[170:171], v[30:31], v[30:31], v[170:171]
v_pk_add_f32 v[168:169], v[168:169], v[32:33]
v_pk_fma_f32 v[170:171], v[32:33], v[32:33], v[170:171]
v_pk_add_f32 v[168:169], v[168:169], v[34:35]
v_pk_fma_f32 v[170:171], v[34:35], v[34:35], v[170:171]
v_pk_add_f32 v[168:169], v[168:169], v[36:37]
v_pk_fma_f32 v[170:171], v[36:37], v[36:37], v[170:171]
v_pk_add_f32 v[168:169], v[168:169], v[38:39]
v_pk_fma_f32 v[170:171], v[38:39], v[38:39], v[170:171]
v_pk_add_f32 v[168:169], v[168:169], v[40:41]
v_pk_fma_f32 v[170:171], v[40:41], v[40:41], v[170:171]
v_pk_add_f32 v[168:169], v[168:169], v[42:43]
v_pk_fma_f32 v[170:171], v[42:43], v[42:43], v[170:171]
v_pk_add_f32 v[168:169], v[168:169], v[44:45]
v_pk_fma_f32 v[170:171], v[44:45], v[44:45], v[170:171]
v_pk_add_f32 v[168:169], v[168:169], v[46:47]
v_pk_fma_f32 v[170:171], v[46:47], v[46:47], v[170:171]
s_setprio 0
v_add_u32 v174, -36864, v242
v_subrev_u32 v175, 66560, v174
v_min_u32 v174, v174, v175
v_add_u32 v174, 90112, v174
v_sub_u32 v175, v174, v242
v_add_u32 v242, v175, v242
v_add_u32 v243, v175, v243
v_add_u32 v244, v175, v244
v_lshlrev_b32 v252, 7, v251
s_add_u32 s46, s47, 1572864
s_mov_b32 exec_lo, 0
s_mov_b32 exec_hi, 1048572
s_mov_b32 m0, 16152
s_nop 0
buffer_load_dword v252, s[4:7], s46 offen lds
s_mov_b64 exec, -1
s_setprio 2
v_cvt_pkrtz_f16_f32 v179, v120, v121
v_cvt_pkrtz_f16_f32 v181, v122, v123
v_cvt_pkrtz_f16_f32 v183, v124, v125
v_cvt_pkrtz_f16_f32 v185, v126, v127
v_cvt_pkrtz_f16_f32 v187, v128, v129
v_cvt_pkrtz_f16_f32 v189, v130, v131
v_cvt_pk_f16_f32 v155, v132, v133
v_cvt_pk_f16_f32 v152, v134, v135
s_waitcnt lgkmcnt(1)
ds_read_b128 v[224:227], v249 offset:17408
ds_read_u16_d16 v142, v142
ds_read_u16_d16_hi v143, v143
v_mfma_f32_32x32x16_bf16 v[120:135], v[48:51], v[228:231], 0
v_pk_fma_f16 v154, v155, v155, s48
v_add_f32 v168, v168, v169
v_and_b32 v179, s49, v179
v_fma_mix_f32 v164, v136, v136, v164 op_sel:[0,0,0] op_sel_hi:[1,1,0]
v_lshrrev_b16 v178, 2, v179
v_add_f32 v170, v170, v171
v_pk_fma_f16 v151, v152, v152, s48
v_pk_mul_f16 v154, v155, v154
v_lshrrev_b32 v179, 18, v179
v_pk_mul_f16 v151, v152, v151
ds_read_b128 v[228:231], v249 offset:18432
ds_read_u16_d16 v178, v178
ds_read_u16_d16_hi v179, v179
v_mfma_f32_32x32x16_bf16 v[120:135], v[52:55], v[232:235], v[120:135]
v_permlane32_swap_b32 v168, v170
v_fma_mix_f32 v164, v137, v137, v164 op_sel:[1,1,0] op_sel_hi:[1,1,0]
v_and_b32 v181, s49, v181
v_exp_f16 v153, v154
v_add_f32 v168, v168, v170
v_lshrrev_b16 v180, 2, v181
v_exp_f16 v150, v151
v_lshrrev_b32 v181, 18, v181
ds_read_b128 v[232:235], v249 offset:21504
ds_read_u16_d16 v180, v180
ds_read_u16_d16_hi v181, v181
v_mfma_f32_32x32x16_bf16 v[120:135], v[56:59], v[236:239], v[120:135]
v_mul_f32 v168, 1009429163, v168
v_fma_mix_f32 v164, v138, v138, v164 op_sel:[0,0,0] op_sel_hi:[1,1,0]
v_exp_f16_sdwa v153, v154 dst_sel:WORD_1 dst_unused:UNUSED_PRESERVE src0_sel:WORD_1
v_and_b32 v183, s49, v183
v_mov_b32 v170, v168
v_exp_f16_sdwa v150, v151 dst_sel:WORD_1 dst_unused:UNUSED_PRESERVE src0_sel:WORD_1
v_lshrrev_b16 v182, 2, v183
v_fma_mix_f32 v164, v139, v139, v164 op_sel:[1,1,0] op_sel_hi:[1,1,0]
v_permlane32_swap_b32 v168, v170
ds_read_b128 v[236:239], v249 offset:19456
ds_read_u16_d16 v182, v182
v_mfma_f32_32x32x16_bf16 v[120:135], v[60:63], v[216:219], v[120:135]
v_lshrrev_b32 v183, 18, v183
v_pk_add_f16 v153, v153, 1.0 op_sel_hi:[1,0]
v_pk_add_f16 v150, v150, 1.0 op_sel_hi:[1,0]
v_and_b32 v185, s49, v185
v_fma_f32 v170, -v168, v168, v170
v_rcp_f16 v154, v153
v_lshrrev_b16 v184, 2, v185
v_max_f32 v170, 0, v170
v_fma_mix_f32 v164, v140, v140, v164 op_sel:[0,0,0] op_sel_hi:[1,1,0]
ds_read_b128 v[216:219], v249 offset:22528
ds_read_u16_d16_hi v183, v183
ds_read_u16_d16 v184, v184
v_mfma_f32_32x32x16_bf16 v[120:135], v[64:67], v[220:223], v[120:135]
v_lshrrev_b32 v185, 18, v185
v_rcp_f16 v151, v150
v_add_f32 v170, 925353388, v170
v_and_b32 v187, s49, v187
v_fma_mix_f32 v164, v141, v141, v164 op_sel:[1,1,0] op_sel_hi:[1,1,0]
v_rcp_f16_sdwa v154, v153 dst_sel:WORD_1 dst_unused:UNUSED_PRESERVE src0_sel:WORD_1
v_rsq_f32 v170, v170
s_waitcnt lgkmcnt(5)
ds_read_b128 v[220:223], v249 offset:20480
ds_read_u16_d16_hi v185, v185
ds_read_b32 v247, v253 offset:16
v_mfma_f32_32x32x16_bf16 v[120:135], v[68:71], v[224:227], v[120:135]
v_lshrrev_b16 v186, 2, v187
v_rcp_f16_sdwa v151, v150 dst_sel:WORD_1 dst_unused:UNUSED_PRESERVE src0_sel:WORD_1
v_lshrrev_b32 v187, 18, v187
v_fma_mix_f32 v164, v142, v142, v164 op_sel:[0,0,0] op_sel_hi:[1,1,0]
v_and_b32 v189, s49, v189
v_pk_mul_f16 v155, v155, v154
v_pk_mul_f16 v152, v152, v151
v_mul_f32 v172, 3203391086, v170
v_lshrrev_b16 v188, 2, v189
v_fma_mix_f32 v165, v155, v155, 0 op_sel:[0,0,0] op_sel_hi:[1,1,0]
v_fma_mix_f32 v164, v143, v143, v164 op_sel:[1,1,0] op_sel_hi:[1,1,0]
v_lshrrev_b32 v189, 18, v189
v_mul_f32 v173, v168, v172
v_fma_mix_f32 v165, v155, v155, v165 op_sel:[1,1,0] op_sel_hi:[1,1,0]
v_fma_mix_f32 v165, v152, v152, v165 op_sel:[0,0,0] op_sel_hi:[1,1,0]
v_fma_mix_f32 v165, v152, v152, v165 op_sel:[1,1,0] op_sel_hi:[1,1,0]
s_setprio 3
v_pk_fma_f32 v[0:1], v[0:1], v[172:173], v[172:173] op_sel:[0,0,1] op_sel_hi:[1,0,1] neg_lo:[0,0,1] neg_hi:[0,0,1]
v_pk_fma_f32 v[2:3], v[2:3], v[172:173], v[172:173] op_sel:[0,0,1] op_sel_hi:[1,0,1] neg_lo:[0,0,1] neg_hi:[0,0,1]
v_pk_fma_f32 v[4:5], v[4:5], v[172:173], v[172:173] op_sel:[0,0,1] op_sel_hi:[1,0,1] neg_lo:[0,0,1] neg_hi:[0,0,1]
v_pk_fma_f32 v[6:7], v[6:7], v[172:173], v[172:173] op_sel:[0,0,1] op_sel_hi:[1,0,1] neg_lo:[0,0,1] neg_hi:[0,0,1]
v_pk_fma_f32 v[8:9], v[8:9], v[172:173], v[172:173] op_sel:[0,0,1] op_sel_hi:[1,0,1] neg_lo:[0,0,1] neg_hi:[0,0,1]
v_pk_fma_f32 v[10:11], v[10:11], v[172:173], v[172:173] op_sel:[0,0,1] op_sel_hi:[1,0,1] neg_lo:[0,0,1] neg_hi:[0,0,1]
v_pk_fma_f32 v[12:13], v[12:13], v[172:173], v[172:173] op_sel:[0,0,1] op_sel_hi:[1,0,1] neg_lo:[0,0,1] neg_hi:[0,0,1]
v_pk_fma_f32 v[14:15], v[14:15], v[172:173], v[172:173] op_sel:[0,0,1] op_sel_hi:[1,0,1] neg_lo:[0,0,1] neg_hi:[0,0,1]
v_pk_fma_f32 v[16:17], v[16:17], v[172:173], v[172:173] op_sel:[0,0,1] op_sel_hi:[1,0,1] neg_lo:[0,0,1] neg_hi:[0,0,1]
v_pk_fma_f32 v[18:19], v[18:19], v[172:173], v[172:173] op_sel:[0,0,1] op_sel_hi:[1,0,1] neg_lo:[0,0,1] neg_hi:[0,0,1]
v_pk_fma_f32 v[20:21], v[20:21], v[172:173], v[172:173] op_sel:[0,0,1] op_sel_hi:[1,0,1] neg_lo:[0,0,1] neg_hi:[0,0,1]
v_pk_fma_f32 v[22:23], v[22:23], v[172:173], v[172:173] op_sel:[0,0,1] op_sel_hi:[1,0,1] neg_lo:[0,0,1] neg_hi:[0,0,1]
v_pk_fma_f32 v[24:25], v[24:25], v[172:173], v[172:173] op_sel:[0,0,1] op_sel_hi:[1,0,1] neg_lo:[0,0,1] neg_hi:[0,0,1]
v_pk_fma_f32 v[26:27], v[26:27], v[172:173], v[172:173] op_sel:[0,0,1] op_sel_hi:[1,0,1] neg_lo:[0,0,1] neg_hi:[0,0,1]
v_pk_fma_f32 v[28:29], v[28:29], v[172:173], v[172:173] op_sel:[0,0,1] op_sel_hi:[1,0,1] neg_lo:[0,0,1] neg_hi:[0,0,1]
v_pk_fma_f32 v[30:31], v[30:31], v[172:173], v[172:173] op_sel:[0,0,1] op_sel_hi:[1,0,1] neg_lo:[0,0,1] neg_hi:[0,0,1]
v_pk_fma_f32 v[32:33], v[32:33], v[172:173], v[172:173] op_sel:[0,0,1] op_sel_hi:[1,0,1] neg_lo:[0,0,1] neg_hi:[0,0,1]
v_pk_fma_f32 v[34:35], v[34:35], v[172:173], v[172:173] op_sel:[0,0,1] op_sel_hi:[1,0,1] neg_lo:[0,0,1] neg_hi:[0,0,1]
v_pk_fma_f32 v[36:37], v[36:37], v[172:173], v[172:173] op_sel:[0,0,1] op_sel_hi:[1,0,1] neg_lo:[0,0,1] neg_hi:[0,0,1]
v_pk_fma_f32 v[38:39], v[38:39], v[172:173], v[172:173] op_sel:[0,0,1] op_sel_hi:[1,0,1] neg_lo:[0,0,1] neg_hi:[0,0,1]
v_pk_fma_f32 v[40:41], v[40:41], v[172:173], v[172:173] op_sel:[0,0,1] op_sel_hi:[1,0,1] neg_lo:[0,0,1] neg_hi:[0,0,1]
v_pk_fma_f32 v[42:43], v[42:43], v[172:173], v[172:173] op_sel:[0,0,1] op_sel_hi:[1,0,1] neg_lo:[0,0,1] neg_hi:[0,0,1]
v_pk_fma_f32 v[44:45], v[44:45], v[172:173], v[172:173] op_sel:[0,0,1] op_sel_hi:[1,0,1] neg_lo:[0,0,1] neg_hi:[0,0,1]
v_pk_fma_f32 v[46:47], v[46:47], v[172:173], v[172:173] op_sel:[0,0,1] op_sel_hi:[1,0,1] neg_lo:[0,0,1] neg_hi:[0,0,1]
s_setprio 2
ds_read_u16_d16 v186, v186
ds_read_u16_d16_hi v187, v187
ds_read_u16_d16 v188, v188
ds_read_u16_d16_hi v189, v189
s_waitcnt lgkmcnt(4)
v_readfirstlane_b32 s43, v247
s_nop 1
s_cmp_ge_u32 s43, 16
s_cbranch_scc1 Lev5
Lev5w:
s_sleep 1
ds_read_b32 v247, v253 offset:16
s_waitcnt lgkmcnt(0)
v_readfirstlane_b32 s43, v247
s_cmp_eq_u32 s76, 0
s_cbranch_scc1 Lev5
s_sub_u32 s76, s76, 1
s_cmp_lt_u32 s43, 16
s_cbranch_scc1 Lev5w
Lev5:
s_setprio 1
v_cvt_pkrtz_f16_f32 v137, v120, v121
v_cvt_pkrtz_f16_f32 v139, v122, v123
v_cvt_pkrtz_f16_f32 v141, v124, v125
v_cvt_pkrtz_f16_f32 v143, v126, v127
v_cvt_pkrtz_f16_f32 v177, v128, v129
v_cvt_pkrtz_f16_f32 v191, v130, v131
v_cvt_pk_f16_f32 v155, v132, v133
v_cvt_pk_f16_f32 v152, v134, v135
s_add_u32 m0, s67, 53248
s_add_u32 s66, s66, 98304
buffer_load_dwordx4 v240, s[4:7], s66 offen lds
ds_read_b128 v[224:227], v249 offset:23552
v_mfma_f32_32x32x16_bf16 v[120:135], v[48:51], v[228:231], 0
v_pk_fma_f16 v154, v155, v155, s48
v_cvt_pk_bf16_f32 v72, v0, v1
v_and_b32 v137, s49, v137
v_fma_mix_f32 v165, v178, v178, v165 op_sel:[0,0,0] op_sel_hi:[1,1,0]
v_cvt_pk_bf16_f32 v73, v2, v3
v_pk_fma_f16 v151, v152, v152, s48
v_lshrrev_b16 v136, 2, v137
v_cvt_pk_bf16_f32 v74, v4, v5
v_pk_mul_f16 v154, v155, v154
v_fma_mix_f32 v165, v179, v179, v165 op_sel:[1,1,0] op_sel_hi:[1,1,0]
v_lshrrev_b32 v137, 18, v137
v_cvt_pk_bf16_f32 v75, v6, v7
s_add_u32 m0, s67, 59904
s_add_u32 s66, s66, 98304
buffer_load_dwordx4 v240, s[4:7], s66 offen lds
ds_read_b128 v[228:231], v248 offset:16384
ds_read_u16_d16 v136, v136
ds_read_u16_d16_hi v137, v137
v_mfma_f32_32x32x16_bf16 v[120:135], v[52:55], v[232:235], v[120:135]
v_pk_mul_f16 v151, v152, v151
v_exp_f16 v153, v154
v_cvt_pk_bf16_f32 v76, v8, v9
v_and_b32 v139, s49, v139
v_fma_mix_f32 v165, v180, v180, v165 op_sel:[0,0,0] op_sel_hi:[1,1,0]
v_cvt_pk_bf16_f32 v77, v10, v11
v_lshrrev_b16 v138, 2, v139
v_exp_f16 v150, v151
v_cvt_pk_bf16_f32 v78, v12, v13
v_lshrrev_b32 v139, 18, v139
v_cvt_pk_bf16_f32 v79, v14, v15
s_add_u32 m0, s67, 0
s_add_u32 s66, s66, 98304
buffer_load_dwordx4 v240, s[4:7], s66 offen lds
ds_read_b128 v[232:235], v248 offset:19456
ds_read_u16_d16 v138, v138
ds_read_u16_d16_hi v139, v139
v_mfma_f32_32x32x16_bf16 v[120:135], v[56:59], v[236:239], v[120:135]
v_fma_mix_f32 v165, v181, v181, v165 op_sel:[1,1,0] op_sel_hi:[1,1,0]
v_exp_f16_sdwa v153, v154 dst_sel:WORD_1 dst_unused:UNUSED_PRESERVE src0_sel:WORD_1
v_cvt_pk_bf16_f32 v80, v16, v17
v_and_b32 v141, s49, v141
v_fma_mix_f32 v165, v182, v182, v165 op_sel:[0,0,0] op_sel_hi:[1,1,0]
v_cvt_pk_bf16_f32 v81, v18, v19
v_lshrrev_b16 v140, 2, v141
v_exp_f16_sdwa v150, v151 dst_sel:WORD_1 dst_unused:UNUSED_PRESERVE src0_sel:WORD_1
v_cvt_pk_bf16_f32 v82, v20, v21
v_lshrrev_b32 v141, 18, v141
s_add_u32 m0, s67, 6656
s_add_u32 s66, s66, 98304
buffer_load_dwordx4 v240, s[4:7], s66 offen lds
s_add_u32 m0, s67, 13312
s_add_u32 s66, s66, 98304
buffer_load_dwordx4 v240, s[4:7], s66 offen lds
ds_read_b128 v[236:239], v248 offset:17408
ds_read_u16_d16 v140, v140
ds_read_u16_d16_hi v141, v141
v_mfma_f32_32x32x16_bf16 v[120:135], v[60:63], v[216:219], v[120:135]
v_fma_mix_f32 v165, v183, v183, v165 op_sel:[1,1,0] op_sel_hi:[1,1,0]
v_cvt_pk_bf16_f32 v83, v22, v23
v_pk_add_f16 v153, v153, 1.0 op_sel_hi:[1,0]
v_pk_add_f16 v150, v150, 1.0 op_sel_hi:[1,0]
v_and_b32 v143, s49, v143
v_cvt_pk_bf16_f32 v84, v24, v25
v_rcp_f16 v154, v153
v_cvt_pk_bf16_f32 v85, v26, v27
v_lshrrev_b16 v142, 2, v143
v_fma_mix_f32 v165, v184, v184, v165 op_sel:[0,0,0] op_sel_hi:[1,1,0]
v_cvt_pk_bf16_f32 v86, v28, v29
s_add_u32 m0, s67, 19968
s_add_u32 s66, s66, 98304
buffer_load_dwordx4 v240, s[4:7], s66 offen lds
ds_read_b128 v[216:219], v248 offset:20480
ds_read_u16_d16 v142, v142
v_mfma_f32_32x32x16_bf16 v[120:135], v[64:67], v[220:223], v[120:135]
v_rcp_f16 v151, v150
v_lshrrev_b32 v143, 18, v143
v_cvt_pk_bf16_f32 v87, v30, v31
v_fma_mix_f32 v165, v185, v185, v165 op_sel:[1,1,0] op_sel_hi:[1,1,0]
v_and_b32 v177, s49, v177
s_setprio 0
v_cvt_pk_bf16_f32 v88, v32, v33
v_rcp_f16_sdwa v154, v153 dst_sel:WORD_1 dst_unused:UNUSED_PRESERVE src0_sel:WORD_1
v_lshrrev_b16 v176, 2, v177
v_cvt_pk_bf16_f32 v89, v34, v35
s_waitcnt lgkmcnt(2)
v_fma_mix_f32 v165, v186, v186, v165 op_sel:[0,0,0] op_sel_hi:[1,1,0]
v_rcp_f16_sdwa v151, v150 dst_sel:WORD_1 dst_unused:UNUSED_PRESERVE src0_sel:WORD_1
s_add_u32 m0, s67, 26624
s_add_u32 s66, s66, 98304
buffer_load_dwordx4 v240, s[4:7], s66 offen lds
ds_read_b128 v[220:223], v248 offset:18432
ds_read_u16_d16_hi v143, v143
ds_read_u16_d16 v176, v176
v_mfma_f32_32x32x16_bf16 v[120:135], v[68:71], v[224:227], v[120:135]
v_cvt_pk_bf16_f32 v90, v36, v37
v_lshrrev_b32 v177, 18, v177
v_cvt_pk_bf16_f32 v91, v38, v39
v_fma_mix_f32 v165, v187, v187, v165 op_sel:[1,1,0] op_sel_hi:[1,1,0]
v_and_b32 v191, s49, v191
v_pk_mul_f16 v155, v155, v154
v_cvt_pk_bf16_f32 v92, v40, v41
v_pk_mul_f16 v152, v152, v151
v_lshrrev_b16 v190, 2, v191
v_cvt_pk_bf16_f32 v93, v42, v43
v_fma_mix_f32 v165, v188, v188, v165 op_sel:[0,0,0] op_sel_hi:[1,1,0]
v_fma_mix_f32 v166, v155, v155, 0 op_sel:[0,0,0] op_sel_hi:[1,1,0]
s_add_u32 m0, s67, 33280
s_add_u32 s66, s66, 98304
buffer_load_dwordx4 v240, s[4:7], s66 offen lds
v_lshrrev_b32 v191, 18, v191
v_cvt_pk_bf16_f32 v94, v44, v45
v_fma_mix_f32 v166, v155, v155, v166 op_sel:[1,1,0] op_sel_hi:[1,1,0]
v_fma_mix_f32 v165, v189, v189, v165 op_sel:[1,1,0] op_sel_hi:[1,1,0]
v_cvt_pk_bf16_f32 v95, v46, v47
v_fma_mix_f32 v166, v152, v152, v166 op_sel:[0,0,0] op_sel_hi:[1,1,0]
v_fma_mix_f32 v166, v152, v152, v166 op_sel:[1,1,0] op_sel_hi:[1,1,0]
s_setprio 2
v_cvt_pkrtz_f16_f32 v179, v120, v121
v_cvt_pkrtz_f16_f32 v181, v122, v123
v_cvt_pkrtz_f16_f32 v183, v124, v125
v_cvt_pkrtz_f16_f32 v185, v126, v127
v_cvt_pkrtz_f16_f32 v187, v128, v129
v_cvt_pk_f16_f32 v155, v130, v131
v_cvt_pk_f16_f32 v152, v132, v133
v_cvt_pk_f16_f32 v149, v134, v135
ds_read_b128 v[224:227], v248 offset:21504
ds_read_u16_d16_hi v177, v177
ds_read_u16_d16 v190, v190
ds_read_u16_d16_hi v191, v191
v_mfma_f32_32x32x16_bf16 v[120:135], v[72:75], v[228:231], 0
v_pk_fma_f16 v154, v155, v155, s48
v_and_b32 v179, s49, v179
v_fma_mix_f32 v166, v136, v136, v166 op_sel:[0,0,0] op_sel_hi:[1,1,0]
v_pk_fma_f16 v151, v152, v152, s48
v_pk_fma_f16 v148, v149, v149, s48
v_lshrrev_b16 v178, 2, v179
v_pk_mul_f16 v154, v155, v154
v_fma_mix_f32 v166, v137, v137, v166 op_sel:[1,1,0] op_sel_hi:[1,1,0]
v_pk_mul_f16 v151, v152, v151
v_lshrrev_b32 v179, 18, v179
ds_read_b128 v[228:231], v248 offset:22528
ds_read_u16_d16 v178, v178
ds_read_u16_d16_hi v179, v179
v_mfma_f32_32x32x16_bf16 v[120:135], v[76:79], v[232:235], v[120:135]
v_pk_mul_f16 v148, v149, v148
v_exp_f16 v153, v154
v_fma_mix_f32 v166, v138, v138, v166 op_sel:[0,0,0] op_sel_hi:[1,1,0]
v_and_b32 v181, s49, v181
v_exp_f16 v150, v151
v_exp_f16 v147, v148
v_lshrrev_b16 v180, 2, v181
v_fma_mix_f32 v166, v139, v139, v166 op_sel:[1,1,0] op_sel_hi:[1,1,0]
ds_read_b128 v[232:235], v248 offset:25600
ds_read_u16_d16 v180, v180
v_mfma_f32_32x32x16_bf16 v[120:135], v[80:83], v[236:239], v[120:135]
v_exp_f16_sdwa v153, v154 dst_sel:WORD_1 dst_unused:UNUSED_PRESERVE src0_sel:WORD_1
v_lshrrev_b32 v181, 18, v181
v_exp_f16_sdwa v150, v151 dst_sel:WORD_1 dst_unused:UNUSED_PRESERVE src0_sel:WORD_1
v_fma_mix_f32 v166, v140, v140, v166 op_sel:[0,0,0] op_sel_hi:[1,1,0]
v_and_b32 v183, s49, v183
v_exp_f16_sdwa v147, v148 dst_sel:WORD_1 dst_unused:UNUSED_PRESERVE src0_sel:WORD_1
v_fma_mix_f32 v166, v141, v141, v166 op_sel:[1,1,0] op_sel_hi:[1,1,0]
s_waitcnt lgkmcnt(5)
ds_read_b128 v[236:239], v248 offset:23552
ds_read_u16_d16_hi v181, v181
v_mfma_f32_32x32x16_bf16 v[120:135], v[84:87], v[216:219], v[120:135]
v_pk_add_f16 v153, v153, 1.0 op_sel_hi:[1,0]
v_lshrrev_b16 v182, 2, v183
v_pk_add_f16 v150, v150, 1.0 op_sel_hi:[1,0]
v_pk_add_f16 v147, v147, 1.0 op_sel_hi:[1,0]
v_rcp_f16 v154, v153
v_lshrrev_b32 v183, 18, v183
v_fma_mix_f32 v166, v142, v142, v166 op_sel:[0,0,0] op_sel_hi:[1,1,0]
v_rcp_f16 v151, v150
v_and_b32 v185, s49, v185
ds_read_b128 v[216:219], v248 offset:26624
ds_read_u16_d16 v182, v182
ds_read_u16_d16_hi v183, v183
v_mfma_f32_32x32x16_bf16 v[120:135], v[88:91], v[220:223], v[120:135]
v_fma_mix_f32 v166, v143, v143, v166 op_sel:[1,1,0] op_sel_hi:[1,1,0]
v_rcp_f16 v148, v147
v_lshrrev_b16 v184, 2, v185
v_rcp_f16_sdwa v154, v153 dst_sel:WORD_1 dst_unused:UNUSED_PRESERVE src0_sel:WORD_1
v_fma_mix_f32 v166, v176, v176, v166 op_sel:[0,0,0] op_sel_hi:[1,1,0]
v_rcp_f16_sdwa v151, v150 dst_sel:WORD_1 dst_unused:UNUSED_PRESERVE src0_sel:WORD_1
v_lshrrev_b32 v185, 18, v185
ds_read_b128 v[220:223], v248 offset:24576
ds_read_u16_d16 v184, v184
ds_read_u16_d16_hi v185, v185
v_mfma_f32_32x32x16_bf16 v[120:135], v[92:95], v[224:227], v[120:135]
v_rcp_f16_sdwa v148, v147 dst_sel:WORD_1 dst_unused:UNUSED_PRESERVE src0_sel:WORD_1
s_cmp_eq_u32 s40, 7
s_cbranch_scc1 Lrdy16
s_waitcnt vmcnt(0)
Lrdy16:
s_mov_b64 exec, 1
ds_add_u32 v253, v254 offset:12
s_mov_b64 exec, -1
v_and_b32 v187, s49, v187
v_fma_mix_f32 v166, v177, v177, v166 op_sel:[1,1,0] op_sel_hi:[1,1,0]
v_pk_mul_f16 v155, v155, v154
v_pk_mul_f16 v152, v152, v151
v_pk_mul_f16 v149, v149, v148
v_lshrrev_b16 v186, 2, v187
v_fma_mix_f32 v166, v190, v190, v166 op_sel:[0,0,0] op_sel_hi:[1,1,0]
v_fma_mix_f32 v167, v155, v155, 0 op_sel:[0,0,0] op_sel_hi:[1,1,0]
v_fma_mix_f32 v167, v155, v155, v167 op_sel:[1,1,0] op_sel_hi:[1,1,0]
v_lshrrev_b32 v187, 18, v187
v_fma_mix_f32 v167, v152, v152, v167 op_sel:[0,0,0] op_sel_hi:[1,1,0]
v_fma_mix_f32 v166, v191, v191, v166 op_sel:[1,1,0] op_sel_hi:[1,1,0]
v_fma_mix_f32 v167, v152, v152, v167 op_sel:[1,1,0] op_sel_hi:[1,1,0]
v_fma_mix_f32 v167, v149, v149, v167 op_sel:[0,0,0] op_sel_hi:[1,1,0]
v_fma_mix_f32 v167, v149, v149, v167 op_sel:[1,1,0] op_sel_hi:[1,1,0]
s_setprio 1
v_cvt_pkrtz_f16_f32 v137, v120, v121
v_cvt_pkrtz_f16_f32 v139, v122, v123
v_cvt_pkrtz_f16_f32 v141, v124, v125
v_cvt_pkrtz_f16_f32 v143, v126, v127
v_cvt_pkrtz_f16_f32 v177, v128, v129
v_cvt_pk_f16_f32 v155, v130, v131
v_cvt_pk_f16_f32 v152, v132, v133
v_cvt_pk_f16_f32 v149, v134, v135
s_waitcnt lgkmcnt(1)
ds_read_b128 v[224:227], v248 offset:27648
ds_read_u16_d16 v186, v186
ds_read_u16_d16_hi v187, v187
v_mfma_f32_32x32x16_bf16 v[120:135], v[72:75], v[228:231], 0
v_pk_fma_f16 v154, v155, v155, s48
v_and_b32 v137, s49, v137
v_fma_mix_f32 v167, v178, v178, v167 op_sel:[0,0,0] op_sel_hi:[1,1,0]
v_pk_fma_f16 v151, v152, v152, s48
v_pk_fma_f16 v148, v149, v149, s48
v_lshrrev_b16 v136, 2, v137
v_pk_mul_f16 v154, v155, v154
v_pk_mul_f16 v151, v152, v151
v_fma_mix_f32 v167, v179, v179, v167 op_sel:[1,1,0] op_sel_hi:[1,1,0]
v_lshrrev_b32 v137, 18, v137
ds_read_b128 v[228:231], v250 offset:65520
ds_read_u16_d16 v136, v136
ds_read_u16_d16_hi v137, v137
v_mfma_f32_32x32x16_bf16 v[120:135], v[76:79], v[232:235], v[120:135]
v_pk_mul_f16 v148, v149, v148
v_exp_f16 v153, v154
v_exp_f16 v150, v151
v_and_b32 v139, s49, v139
v_fma_mix_f32 v167, v180, v180, v167 op_sel:[0,0,0] op_sel_hi:[1,1,0]
v_exp_f16 v147, v148
v_lshrrev_b16 v138, 2, v139
ds_read_b128 v[232:235], v248 offset:28672
ds_read_b32 v247, v253 offset:12
ds_read_u16_d16 v138, v138
v_mfma_f32_32x32x16_bf16 v[120:135], v[80:83], v[236:239], v[120:135]
v_exp_f16_sdwa v153, v154 dst_sel:WORD_1 dst_unused:UNUSED_PRESERVE src0_sel:WORD_1
v_lshrrev_b32 v139, 18, v139
v_fma_mix_f32 v167, v181, v181, v167 op_sel:[1,1,0] op_sel_hi:[1,1,0]
v_exp_f16_sdwa v150, v151 dst_sel:WORD_1 dst_unused:UNUSED_PRESERVE src0_sel:WORD_1
v_exp_f16_sdwa v147, v148 dst_sel:WORD_1 dst_unused:UNUSED_PRESERVE src0_sel:WORD_1
v_and_b32 v141, s49, v141
v_fma_mix_f32 v167, v182, v182, v167 op_sel:[0,0,0] op_sel_hi:[1,1,0]
ds_read_b128 v[236:239], v248 offset:31744
ds_read_u16_d16_hi v139, v139
v_mfma_f32_32x32x16_bf16 v[120:135], v[84:87], v[216:219], v[120:135]
v_pk_add_f16 v153, v153, 1.0 op_sel_hi:[1,0]
v_lshrrev_b16 v140, 2, v141
v_pk_add_f16 v150, v150, 1.0 op_sel_hi:[1,0]
v_pk_add_f16 v147, v147, 1.0 op_sel_hi:[1,0]
v_rcp_f16 v154, v153
v_lshrrev_b32 v141, 18, v141
ds_read_u16_d16 v140, v140
ds_read_u16_d16_hi v141, v141
s_waitcnt lgkmcnt(5)
v_readfirstlane_b32 s43, v247
s_nop 1
s_cmp_ge_u32 s43, 24
s_cbranch_scc1 Lev6
Lev6w:
s_sleep 1
ds_read_b32 v247, v253 offset:12
s_waitcnt lgkmcnt(0)
v_readfirstlane_b32 s43, v247
s_cmp_eq_u32 s76, 0
s_cbranch_scc1 Lev6
s_sub_u32 s76, s76, 1
s_cmp_lt_u32 s43, 24
s_cbranch_scc1 Lev6w
Lev6:
v_fma_mix_f32 v167, v183, v183, v167 op_sel:[1,1,0] op_sel_hi:[1,1,0]
v_rcp_f16 v151, v150
ds_read_b128 v[216:219], v248 offset:29696
v_mfma_f32_32x32x16_bf16 v[120:135], v[88:91], v[220:223], v[120:135]
v_and_b32 v143, s49, v143
v_rcp_f16 v148, v147
v_fma_mix_f32 v167, v184, v184, v167 op_sel:[0,0,0] op_sel_hi:[1,1,0]
v_lshrrev_b16 v142, 2, v143
s_setprio 0
v_rcp_f16_sdwa v154, v153 dst_sel:WORD_1 dst_unused:UNUSED_PRESERVE src0_sel:WORD_1
v_rcp_f16_sdwa v151, v150 dst_sel:WORD_1 dst_unused:UNUSED_PRESERVE src0_sel:WORD_1
v_lshrrev_b32 v143, 18, v143
ds_read_b128 v[220:223], v245
ds_read_b128 v[192:195], v242
ds_read_b128 v[196:199], v242 offset:64
ds_read_u16_d16 v142, v142
ds_read_u16_d16_hi v143, v143
v_mfma_f32_32x32x16_bf16 v[120:135], v[92:95], v[224:227], v[120:135]
v_fma_mix_f32 v167, v185, v185, v167 op_sel:[1,1,0] op_sel_hi:[1,1,0]
v_rcp_f16_sdwa v148, v147 dst_sel:WORD_1 dst_unused:UNUSED_PRESERVE src0_sel:WORD_1
v_and_b32 v177, s49, v177
v_pk_mul_f16 v155, v155, v154
v_fma_mix_f32 v167, v186, v186, v167 op_sel:[0,0,0] op_sel_hi:[1,1,0]
v_pk_mul_f16 v152, v152, v151
v_lshrrev_b16 v176, 2, v177
v_pk_mul_f16 v149, v149, v148
v_fma_mix_f32 v156, v155, v155, v156 op_sel:[0,0,0] op_sel_hi:[1,1,0]
v_fma_mix_f32 v156, v155, v155, v156 op_sel:[1,1,0] op_sel_hi:[1,1,0]
v_lshrrev_b32 v177, 18, v177
v_fma_mix_f32 v167, v187, v187, v167 op_sel:[1,1,0] op_sel_hi:[1,1,0]
v_fma_mix_f32 v156, v152, v152, v156 op_sel:[0,0,0] op_sel_hi:[1,1,0]
v_fma_mix_f32 v156, v152, v152, v156 op_sel:[1,1,0] op_sel_hi:[1,1,0]
v_fma_mix_f32 v156, v149, v149, v156 op_sel:[0,0,0] op_sel_hi:[1,1,0]
v_fma_mix_f32 v156, v149, v149, v156 op_sel:[1,1,0] op_sel_hi:[1,1,0]
s_setprio 2
v_mfma_f32_32x32x16_bf16 v[0:15], v[228:231], v[228:231], 0
s_add_u32 s46, s80, 8388608
buffer_store_dwordx4 v[64:67], v241, s[32:35], s46 offen sc1
ds_read_b128 v[224:227], v248 offset:32768
ds_read_u16_d16 v176, v176
ds_read_u16_d16_hi v177, v177
v_cvt_pkrtz_f16_f32 v179, v120, v121
v_cvt_pkrtz_f16_f32 v181, v122, v123
v_cvt_pkrtz_f16_f32 v183, v124, v125
v_mfma_f32_32x32x16_bf16 v[16:31], v[228:231], v[228:231], 0
v_cvt_pkrtz_f16_f32 v185, v126, v127
v_cvt_pkrtz_f16_f32 v187, v128, v129
v_cvt_pk_f16_f32 v155, v130, v131
v_cvt_pk_f16_f32 v152, v132, v133
v_mfma_f32_32x32x16_bf16 v[32:47], v[228:231], v[228:231], 0
v_cvt_pk_f16_f32 v149, v134, v135
v_pk_fma_f16 v154, v155, v155, s48
v_and_b32 v179, s49, v179
v_mfma_f32_32x32x16_bf16 v[120:135], v[72:75], v[232:235], 0
ds_read_b128 v[228:231], v248 offset:30720
v_fma_mix_f32 v156, v136, v136, v156 op_sel:[0,0,0] op_sel_hi:[1,1,0]
v_pk_fma_f16 v151, v152, v152, s48
v_pk_fma_f16 v148, v149, v149, s48
v_lshrrev_b16 v178, 2, v179
v_pk_mul_f16 v154, v155, v154
v_pk_mul_f16 v151, v152, v151
v_fma_mix_f32 v156, v137, v137, v156 op_sel:[1,1,0] op_sel_hi:[1,1,0]
s_waitcnt lgkmcnt(4)
v_mfma_f32_32x32x16_bf16 v[120:135], v[76:79], v[236:239], v[120:135]
ds_read_b128 v[232:235], v245 offset:384
ds_read_b128 v[200:203], v242 offset:128
ds_read_b128 v[204:207], v243
ds_read_u16_d16 v178, v178
v_lshrrev_b32 v179, 18, v179
v_pk_mul_f16 v148, v149, v148
v_exp_f16 v153, v154
v_exp_f16 v150, v151
v_and_b32 v181, s49, v181
v_fma_mix_f32 v156, v138, v138, v156 op_sel:[0,0,0] op_sel_hi:[1,1,0]
v_mfma_f32_32x32x16_bf16 v[120:135], v[80:83], v[216:219], v[120:135]
ds_read_b128 v[236:239], v248 offset:33792
ds_read_u16_d16_hi v179, v179
v_exp_f16 v147, v148
v_lshrrev_b16 v180, 2, v181
v_exp_f16_sdwa v153, v154 dst_sel:WORD_1 dst_unused:UNUSED_PRESERVE src0_sel:WORD_1
v_lshrrev_b32 v181, 18, v181
v_fma_mix_f32 v156, v139, v139, v156 op_sel:[1,1,0] op_sel_hi:[1,1,0]
v_smfmac_f32_16x16x32_bf16 v[0:3], v[220:221], v[192:195], v246
ds_read_b128 v[216:219], v245 offset:768
ds_read_b128 v[208:211], v243 offset:64
ds_read_b128 v[212:215], v243 offset:128
ds_read_u16_d16 v180, v180
ds_read_u16_d16_hi v181, v181
v_exp_f16_sdwa v150, v151 dst_sel:WORD_1 dst_unused:UNUSED_PRESERVE src0_sel:WORD_1
v_smfmac_f32_16x16x32_bf16 v[16:19], v[222:223], v[196:199], v246
v_exp_f16_sdwa v147, v148 dst_sel:WORD_1 dst_unused:UNUSED_PRESERVE src0_sel:WORD_1
v_and_b32 v183, s49, v183
v_fma_mix_f32 v156, v140, v140, v156 op_sel:[0,0,0] op_sel_hi:[1,1,0]
v_pk_add_f16 v153, v153, 1.0 op_sel_hi:[1,0]
s_waitcnt lgkmcnt(7)
v_mfma_f32_32x32x16_bf16 v[120:135], v[84:87], v[224:227], v[120:135]
ds_read_b128 v[220:223], v245 offset:1152
ds_read_b128 v[192:195], v244
ds_read_b128 v[196:199], v244 offset:64
v_lshrrev_b16 v182, 2, v183
v_pk_add_f16 v150, v150, 1.0 op_sel_hi:[1,0]
v_pk_add_f16 v147, v147, 1.0 op_sel_hi:[1,0]
v_rcp_f16 v154, v153
v_lshrrev_b32 v183, 18, v183
v_fma_mix_f32 v156, v141, v141, v156 op_sel:[1,1,0] op_sel_hi:[1,1,0]
v_mfma_f32_32x32x16_bf16 v[120:135], v[88:91], v[228:231], v[120:135]
ds_read_b128 v[224:227], v248 offset:34816
ds_read_u16_d16 v182, v182
ds_read_u16_d16_hi v183, v183
v_rcp_f16 v151, v150
v_and_b32 v185, s49, v185
v_rcp_f16 v148, v147
v_fma_mix_f32 v156, v142, v142, v156 op_sel:[0,0,0] op_sel_hi:[1,1,0]
v_lshrrev_b16 v184, 2, v185
v_smfmac_f32_16x16x32_bf16 v[32:35], v[232:233], v[200:203], v246
ds_read_b128 v[228:231], v248 offset:37888
ds_read_u16_d16 v184, v184
v_rcp_f16_sdwa v154, v153 dst_sel:WORD_1 dst_unused:UNUSED_PRESERVE src0_sel:WORD_1
v_rcp_f16_sdwa v151, v150 dst_sel:WORD_1 dst_unused:UNUSED_PRESERVE src0_sel:WORD_1
v_smfmac_f32_16x16x32_bf16 v[0:3], v[234:235], v[204:207], v246
v_lshrrev_b32 v185, 18, v185
v_fma_mix_f32 v156, v143, v143, v156 op_sel:[1,1,0] op_sel_hi:[1,1,0]
s_waitcnt lgkmcnt(6)
v_mfma_f32_32x32x16_bf16 v[120:135], v[92:95], v[236:239], v[120:135]
ds_read_b128 v[232:235], v248 offset:35840
ds_read_u16_d16_hi v185, v185
v_rcp_f16_sdwa v148, v147 dst_sel:WORD_1 dst_unused:UNUSED_PRESERVE src0_sel:WORD_1
v_and_b32 v187, s49, v187
v_pk_mul_f16 v155, v155, v154
v_fma_mix_f32 v156, v176, v176, v156 op_sel:[0,0,0] op_sel_hi:[1,1,0]
v_pk_mul_f16 v152, v152, v151
v_lshrrev_b16 v186, 2, v187
v_pk_mul_f16 v149, v149, v148
v_smfmac_f32_16x16x32_bf16 v[16:19], v[216:217], v[208:211], v246
ds_read_b128 v[236:239], v248 offset:38912
ds_read_u16_d16 v186, v186
v_fma_mix_f32 v157, v155, v155, v157 op_sel:[0,0,0] op_sel_hi:[1,1,0]
v_fma_mix_f32 v157, v155, v155, v157 op_sel:[1,1,0] op_sel_hi:[1,1,0]
v_lshrrev_b32 v187, 18, v187
v_fma_mix_f32 v156, v177, v177, v156 op_sel:[1,1,0] op_sel_hi:[1,1,0]
v_smfmac_f32_16x16x32_bf16 v[32:35], v[218:219], v[212:215], v246
v_fma_mix_f32 v157, v152, v152, v157 op_sel:[0,0,0] op_sel_hi:[1,1,0]
v_fma_mix_f32 v157, v152, v152, v157 op_sel:[1,1,0] op_sel_hi:[1,1,0]
v_fma_mix_f32 v157, v149, v149, v157 op_sel:[0,0,0] op_sel_hi:[1,1,0]
v_fma_mix_f32 v157, v149, v149, v157 op_sel:[1,1,0] op_sel_hi:[1,1,0]
s_setprio 1
v_smfmac_f32_16x16x32_bf16 v[0:3], v[220:221], v[192:195], v246
s_waitcnt lgkmcnt(4)
s_add_u32 s46, s80, 10485760
buffer_store_dwordx4 v[68:71], v241, s[32:35], s46 offen sc1
ds_read_b128 v[216:219], v248 offset:36864
ds_read_u16_d16_hi v187, v187
v_cvt_pkrtz_f16_f32 v137, v120, v121
v_cvt_pkrtz_f16_f32 v139, v122, v123
v_cvt_pkrtz_f16_f32 v141, v124, v125
v_cvt_pkrtz_f16_f32 v143, v126, v127
v_cvt_pk_f16_f32 v155, v128, v129
v_smfmac_f32_16x16x32_bf16 v[16:19], v[222:223], v[196:199], v246
v_cvt_pk_f16_f32 v152, v130, v131
v_cvt_pk_f16_f32 v149, v132, v133
v_cvt_pk_f16_f32 v146, v134, v135
v_pk_fma_f16 v154, v155, v155, s48
v_and_b32 v137, s49, v137
v_mfma_f32_32x32x16_bf16 v[120:135], v[72:75], v[224:227], 0
ds_read_b128 v[220:223], v248 offset:39936
v_fma_mix_f32 v157, v178, v178, v157 op_sel:[0,0,0] op_sel_hi:[1,1,0]
v_pk_fma_f16 v151, v152, v152, s48
v_pk_fma_f16 v148, v149, v149, s48
v_pk_fma_f16 v145, v146, v146, s48
v_pk_mul_f16 v154, v155, v154
v_lshrrev_b16 v136, 2, v137
v_pk_mul_f16 v151, v152, v151
v_fma_mix_f32 v157, v179, v179, v157 op_sel:[1,1,0] op_sel_hi:[1,1,0]
v_pk_mul_f16 v148, v149, v148
v_pk_mul_f16 v145, v146, v145
v_mfma_f32_32x32x16_bf16 v[120:135], v[76:79], v[228:231], v[120:135]
ds_read_b128 v[224:227], v245 offset:1536
ds_read_b128 v[200:203], v244 offset:128
v_xor_b32 v242, 16, v242
ds_read_b128 v[204:207], v242
ds_read_u16_d16 v136, v136
v_exp_f16 v153, v154
v_lshrrev_b32 v137, 18, v137
v_exp_f16 v150, v151
v_fma_mix_f32 v157, v180, v180, v157 op_sel:[0,0,0] op_sel_hi:[1,1,0]
v_exp_f16 v147, v148
v_and_b32 v139, s49, v139
v_exp_f16 v144, v145
s_waitcnt lgkmcnt(5)
v_mfma_f32_32x32x16_bf16 v[120:135], v[80:83], v[232:235], v[120:135]
ds_read_b128 v[228:231], v245 offset:1920
ds_read_b128 v[208:211], v242 offset:64
ds_read_b128 v[212:215], v242 offset:128
ds_read_u16_d16_hi v137, v137
v_exp_f16_sdwa v153, v154 dst_sel:WORD_1 dst_unused:UNUSED_PRESERVE src0_sel:WORD_1
v_fma_mix_f32 v157, v181, v181, v157 op_sel:[1,1,0] op_sel_hi:[1,1,0]
v_lshrrev_b16 v138, 2, v139
v_exp_f16_sdwa v150, v151 dst_sel:WORD_1 dst_unused:UNUSED_PRESERVE src0_sel:WORD_1
v_exp_f16_sdwa v147, v148 dst_sel:WORD_1 dst_unused:UNUSED_PRESERVE src0_sel:WORD_1
v_exp_f16_sdwa v144, v145 dst_sel:WORD_1 dst_unused:UNUSED_PRESERVE src0_sel:WORD_1
v_lshrrev_b32 v139, 18, v139
v_fma_mix_f32 v157, v182, v182, v157 op_sel:[0,0,0] op_sel_hi:[1,1,0]
v_mfma_f32_32x32x16_bf16 v[120:135], v[84:87], v[236:239], v[120:135]
ds_read_b128 v[232:235], v248 offset:40960
ds_read_u16_d16 v138, v138
ds_read_u16_d16_hi v139, v139
v_pk_add_f16 v153, v153, 1.0 op_sel_hi:[1,0]
v_pk_add_f16 v150, v150, 1.0 op_sel_hi:[1,0]
v_pk_add_f16 v147, v147, 1.0 op_sel_hi:[1,0]
v_and_b32 v141, s49, v141
v_pk_add_f16 v144, v144, 1.0 op_sel_hi:[1,0]
v_rcp_f16 v154, v153
v_fma_mix_f32 v157, v183, v183, v157 op_sel:[1,1,0] op_sel_hi:[1,1,0]
v_rcp_f16 v151, v150
v_mfma_f32_32x32x16_bf16 v[120:135], v[88:91], v[216:219], v[120:135]
ds_read_b128 v[236:239], v248 offset:44032
v_lshrrev_b16 v140, 2, v141
v_rcp_f16 v148, v147
v_fma_mix_f32 v157, v184, v184, v157 op_sel:[0,0,0] op_sel_hi:[1,1,0]
v_rcp_f16 v145, v144
v_lshrrev_b32 v141, 18, v141
v_rcp_f16_sdwa v154, v153 dst_sel:WORD_1 dst_unused:UNUSED_PRESERVE src0_sel:WORD_1
s_setprio 0
v_rcp_f16_sdwa v151, v150 dst_sel:WORD_1 dst_unused:UNUSED_PRESERVE src0_sel:WORD_1
s_waitcnt lgkmcnt(4)
v_mfma_f32_32x32x16_bf16 v[120:135], v[92:95], v[220:223], v[120:135]
ds_read_b128 v[216:219], v248 offset:41984
ds_read_u16_d16 v140, v140
ds_read_u16_d16_hi v141, v141
v_fma_mix_f32 v157, v185, v185, v157 op_sel:[1,1,0] op_sel_hi:[1,1,0]
v_and_b32 v143, s49, v143
v_rcp_f16_sdwa v148, v147 dst_sel:WORD_1 dst_unused:UNUSED_PRESERVE src0_sel:WORD_1
v_rcp_f16_sdwa v145, v144 dst_sel:WORD_1 dst_unused:UNUSED_PRESERVE src0_sel:WORD_1
v_pk_mul_f16 v155, v155, v154
v_lshrrev_b16 v142, 2, v143
v_fma_mix_f32 v157, v186, v186, v157 op_sel:[0,0,0] op_sel_hi:[1,1,0]
v_pk_mul_f16 v152, v152, v151
v_pk_mul_f16 v149, v149, v148
v_smfmac_f32_16x16x32_bf16 v[32:35], v[224:225], v[200:203], v246
ds_read_b128 v[220:223], v248 offset:45056
ds_read_u16_d16 v142, v142
v_pk_mul_f16 v146, v146, v145
v_fma_mix_f32 v158, v155, v155, v158 op_sel:[0,0,0] op_sel_hi:[1,1,0]
v_lshrrev_b32 v143, 18, v143
v_fma_mix_f32 v158, v155, v155, v158 op_sel:[1,1,0] op_sel_hi:[1,1,0]
v_fma_mix_f32 v158, v152, v152, v158 op_sel:[0,0,0] op_sel_hi:[1,1,0]
v_smfmac_f32_16x16x32_bf16 v[4:7], v[226:227], v[204:207], v246
v_fma_mix_f32 v157, v187, v187, v157 op_sel:[1,1,0] op_sel_hi:[1,1,0]
v_fma_mix_f32 v158, v152, v152, v158 op_sel:[1,1,0] op_sel_hi:[1,1,0]
v_fma_mix_f32 v158, v149, v149, v158 op_sel:[0,0,0] op_sel_hi:[1,1,0]
v_fma_mix_f32 v158, v149, v149, v158 op_sel:[1,1,0] op_sel_hi:[1,1,0]
v_fma_mix_f32 v158, v146, v146, v158 op_sel:[0,0,0] op_sel_hi:[1,1,0]
v_fma_mix_f32 v158, v146, v146, v158 op_sel:[1,1,0] op_sel_hi:[1,1,0]
s_setprio 2
v_smfmac_f32_16x16x32_bf16 v[20:23], v[228:229], v[208:211], v246
ds_read_b128 v[224:227], v248 offset:43008
ds_read_u16_d16_hi v143, v143
v_cvt_pkrtz_f16_f32 v179, v120, v121
v_cvt_pkrtz_f16_f32 v181, v122, v123
v_cvt_pkrtz_f16_f32 v183, v124, v125
v_cvt_pkrtz_f16_f32 v185, v126, v127
v_smfmac_f32_16x16x32_bf16 v[36:39], v[230:231], v[212:215], v246
v_cvt_pkrtz_f16_f32 v187, v128, v129
v_cvt_pk_f16_f32 v155, v130, v131
v_cvt_pk_f16_f32 v152, v132, v133
v_cvt_pk_f16_f32 v149, v134, v135
v_pk_fma_f16 v154, v155, v155, s48
s_waitcnt lgkmcnt(2)
v_mfma_f32_32x32x16_bf16 v[120:135], v[72:75], v[232:235], 0
ds_read_b128 v[228:231], v248 offset:46080
v_and_b32 v179, s49, v179
v_fma_mix_f32 v158, v136, v136, v158 op_sel:[0,0,0] op_sel_hi:[1,1,0]
v_pk_fma_f16 v151, v152, v152, s48
v_pk_fma_f16 v148, v149, v149, s48
v_lshrrev_b16 v178, 2, v179
v_pk_mul_f16 v154, v155, v154
v_pk_mul_f16 v151, v152, v151
v_pk_mul_f16 v148, v149, v148
v_lshrrev_b32 v179, 18, v179
v_mfma_f32_32x32x16_bf16 v[120:135], v[76:79], v[236:239], v[120:135]
ds_read_b128 v[232:235], v245 offset:2304
v_xor_b32 v243, 16, v243
ds_read_b128 v[192:195], v243
ds_read_b128 v[196:199], v243 offset:64
ds_read_u16_d16 v178, v178
ds_read_u16_d16_hi v179, v179
v_fma_mix_f32 v158, v137, v137, v158 op_sel:[1,1,0] op_sel_hi:[1,1,0]
v_exp_f16 v153, v154
v_and_b32 v181, s49, v181
v_exp_f16 v150, v151
v_exp_f16 v147, v148
v_lshrrev_b16 v180, 2, v181
v_mfma_f32_32x32x16_bf16 v[120:135], v[80:83], v[216:219], v[120:135]
ds_read_b128 v[236:239], v245 offset:2688
ds_read_b128 v[200:203], v243 offset:128
v_xor_b32 v244, 16, v244
ds_read_b128 v[204:207], v244
ds_read_u16_d16 v180, v180
v_fma_mix_f32 v158, v138, v138, v158 op_sel:[0,0,0] op_sel_hi:[1,1,0]
v_exp_f16_sdwa v153, v154 dst_sel:WORD_1 dst_unused:UNUSED_PRESERVE src0_sel:WORD_1
v_lshrrev_b32 v181, 18, v181
v_exp_f16_sdwa v150, v151 dst_sel:WORD_1 dst_unused:UNUSED_PRESERVE src0_sel:WORD_1
v_fma_mix_f32 v158, v139, v139, v158 op_sel:[1,1,0] op_sel_hi:[1,1,0]
v_and_b32 v183, s49, v183
v_mfma_f32_32x32x16_bf16 v[120:135], v[84:87], v[220:223], v[120:135]
ds_read_b128 v[216:219], v248 offset:47104
ds_read_u16_d16_hi v181, v181
v_exp_f16_sdwa v147, v148 dst_sel:WORD_1 dst_unused:UNUSED_PRESERVE src0_sel:WORD_1
v_pk_add_f16 v153, v153, 1.0 op_sel_hi:[1,0]
v_lshrrev_b16 v182, 2, v183
v_pk_add_f16 v150, v150, 1.0 op_sel_hi:[1,0]
v_pk_add_f16 v147, v147, 1.0 op_sel_hi:[1,0]
v_rcp_f16 v154, v153
v_lshrrev_b32 v183, 18, v183
v_fma_mix_f32 v158, v140, v140, v158 op_sel:[0,0,0] op_sel_hi:[1,1,0]
s_waitcnt lgkmcnt(6)
v_mfma_f32_32x32x16_bf16 v[120:135], v[88:91], v[224:227], v[120:135]
ds_read_b128 v[220:223], v248 offset:50176
ds_read_u16_d16 v182, v182
ds_read_u16_d16_hi v183, v183
v_rcp_f16 v151, v150
v_and_b32 v185, s49, v185
v_rcp_f16 v148, v147
v_fma_mix_f32 v158, v141, v141, v158 op_sel:[1,1,0] op_sel_hi:[1,1,0]
v_lshrrev_b16 v184, 2, v185
v_rcp_f16_sdwa v154, v153 dst_sel:WORD_1 dst_unused:UNUSED_PRESERVE src0_sel:WORD_1
v_mfma_f32_32x32x16_bf16 v[120:135], v[92:95], v[228:231], v[120:135]
ds_read_b128 v[224:227], v248 offset:48128
ds_read_u16_d16 v184, v184
v_rcp_f16_sdwa v151, v150 dst_sel:WORD_1 dst_unused:UNUSED_PRESERVE src0_sel:WORD_1
v_lshrrev_b32 v185, 18, v185
v_rcp_f16_sdwa v148, v147 dst_sel:WORD_1 dst_unused:UNUSED_PRESERVE src0_sel:WORD_1
v_and_b32 v187, s49, v187
v_fma_mix_f32 v158, v142, v142, v158 op_sel:[0,0,0] op_sel_hi:[1,1,0]
v_pk_mul_f16 v155, v155, v154
v_pk_mul_f16 v152, v152, v151
v_smfmac_f32_16x16x32_bf16 v[4:7], v[232:233], v[192:195], v246
ds_read_b128 v[228:231], v248 offset:51200
ds_read_u16_d16_hi v185, v185
v_lshrrev_b16 v186, 2, v187
v_pk_mul_f16 v149, v149, v148
v_fma_mix_f32 v159, v155, v155, v159 op_sel:[0,0,0] op_sel_hi:[1,1,0]
v_fma_mix_f32 v158, v143, v143, v158 op_sel:[1,1,0] op_sel_hi:[1,1,0]
v_lshrrev_b32 v187, 18, v187
v_smfmac_f32_16x16x32_bf16 v[20:23], v[234:235], v[196:199], v246
v_fma_mix_f32 v159, v155, v155, v159 op_sel:[1,1,0] op_sel_hi:[1,1,0]
v_fma_mix_f32 v159, v152, v152, v159 op_sel:[0,0,0] op_sel_hi:[1,1,0]
v_fma_mix_f32 v159, v152, v152, v159 op_sel:[1,1,0] op_sel_hi:[1,1,0]
v_fma_mix_f32 v159, v149, v149, v159 op_sel:[0,0,0] op_sel_hi:[1,1,0]
v_fma_mix_f32 v159, v149, v149, v159 op_sel:[1,1,0] op_sel_hi:[1,1,0]
s_setprio 1
s_waitcnt lgkmcnt(4)
v_smfmac_f32_16x16x32_bf16 v[36:39], v[236:237], v[200:203], v246
ds_read_b128 v[232:235], v248 offset:49152
ds_read_u16_d16 v186, v186
ds_read_u16_d16_hi v187, v187
v_cvt_pkrtz_f16_f32 v137, v120, v121
v_cvt_pkrtz_f16_f32 v139, v122, v123
v_cvt_pkrtz_f16_f32 v141, v124, v125
v_cvt_pkrtz_f16_f32 v143, v126, v127
v_cvt_pk_f16_f32 v155, v128, v129
v_smfmac_f32_16x16x32_bf16 v[4:7], v[238:239], v[204:207], v246
v_cvt_pk_f16_f32 v152, v130, v131
v_cvt_pk_f16_f32 v149, v132, v133
v_cvt_pk_f16_f32 v146, v134, v135
v_pk_fma_f16 v154, v155, v155, s48
v_and_b32 v137, s49, v137
v_mfma_f32_32x32x16_bf16 v[120:135], v[72:75], v[216:219], 0
ds_read_b128 v[236:239], v248 offset:52224
v_fma_mix_f32 v159, v178, v178, v159 op_sel:[0,0,0] op_sel_hi:[1,1,0]
v_pk_fma_f16 v151, v152, v152, s48
v_pk_fma_f16 v148, v149, v149, s48
v_pk_fma_f16 v145, v146, v146, s48
v_pk_mul_f16 v154, v155, v154
v_lshrrev_b16 v136, 2, v137
v_pk_mul_f16 v151, v152, v151
v_fma_mix_f32 v159, v179, v179, v159 op_sel:[1,1,0] op_sel_hi:[1,1,0]
v_pk_mul_f16 v148, v149, v148
v_pk_mul_f16 v145, v146, v145
v_mfma_f32_32x32x16_bf16 v[120:135], v[76:79], v[220:223], v[120:135]
ds_read_b128 v[216:219], v245 offset:3072
ds_read_b128 v[208:211], v244 offset:64
ds_read_b128 v[212:215], v244 offset:128
ds_read_u16_d16 v136, v136
v_exp_f16 v153, v154
v_lshrrev_b32 v137, 18, v137
v_exp_f16 v150, v151
v_fma_mix_f32 v159, v180, v180, v159 op_sel:[0,0,0] op_sel_hi:[1,1,0]
v_exp_f16 v147, v148
v_and_b32 v139, s49, v139
v_exp_f16 v144, v145
s_waitcnt lgkmcnt(5)
v_mfma_f32_32x32x16_bf16 v[120:135], v[80:83], v[224:227], v[120:135]
ds_read_b128 v[220:223], v245 offset:3456
v_xor_b32 v242, 32, v242
ds_read_b128 v[192:195], v242
ds_read_b128 v[196:199], v242 offset:64
ds_read_u16_d16_hi v137, v137
v_exp_f16_sdwa v153, v154 dst_sel:WORD_1 dst_unused:UNUSED_PRESERVE src0_sel:WORD_1
v_fma_mix_f32 v159, v181, v181, v159 op_sel:[1,1,0] op_sel_hi:[1,1,0]
v_lshrrev_b16 v138, 2, v139
v_exp_f16_sdwa v150, v151 dst_sel:WORD_1 dst_unused:UNUSED_PRESERVE src0_sel:WORD_1
v_exp_f16_sdwa v147, v148 dst_sel:WORD_1 dst_unused:UNUSED_PRESERVE src0_sel:WORD_1
v_exp_f16_sdwa v144, v145 dst_sel:WORD_1 dst_unused:UNUSED_PRESERVE src0_sel:WORD_1
v_lshrrev_b32 v139, 18, v139
v_fma_mix_f32 v159, v182, v182, v159 op_sel:[0,0,0] op_sel_hi:[1,1,0]
v_mfma_f32_32x32x16_bf16 v[120:135], v[84:87], v[228:231], v[120:135]
ds_read_b128 v[224:227], v248 offset:53248
ds_read_u16_d16 v138, v138
ds_read_u16_d16_hi v139, v139
v_pk_add_f16 v153, v153, 1.0 op_sel_hi:[1,0]
v_pk_add_f16 v150, v150, 1.0 op_sel_hi:[1,0]
v_pk_add_f16 v147, v147, 1.0 op_sel_hi:[1,0]
v_and_b32 v141, s49, v141
v_pk_add_f16 v144, v144, 1.0 op_sel_hi:[1,0]
v_rcp_f16 v154, v153
v_fma_mix_f32 v159, v183, v183, v159 op_sel:[1,1,0] op_sel_hi:[1,1,0]
v_rcp_f16 v151, v150
v_mfma_f32_32x32x16_bf16 v[120:135], v[88:91], v[232:235], v[120:135]
ds_read_b128 v[228:231], v248 offset:56320
v_lshrrev_b16 v140, 2, v141
v_rcp_f16 v148, v147
v_fma_mix_f32 v159, v184, v184, v159 op_sel:[0,0,0] op_sel_hi:[1,1,0]
v_rcp_f16 v145, v144
v_lshrrev_b32 v141, 18, v141
v_rcp_f16_sdwa v154, v153 dst_sel:WORD_1 dst_unused:UNUSED_PRESERVE src0_sel:WORD_1
s_setprio 0
v_rcp_f16_sdwa v151, v150 dst_sel:WORD_1 dst_unused:UNUSED_PRESERVE src0_sel:WORD_1
s_waitcnt lgkmcnt(4)
v_mfma_f32_32x32x16_bf16 v[120:135], v[92:95], v[236:239], v[120:135]
ds_read_b128 v[232:235], v248 offset:54272
ds_read_u16_d16 v140, v140
ds_read_u16_d16_hi v141, v141
v_fma_mix_f32 v159, v185, v185, v159 op_sel:[1,1,0] op_sel_hi:[1,1,0]
v_and_b32 v143, s49, v143
v_rcp_f16_sdwa v148, v147 dst_sel:WORD_1 dst_unused:UNUSED_PRESERVE src0_sel:WORD_1
v_rcp_f16_sdwa v145, v144 dst_sel:WORD_1 dst_unused:UNUSED_PRESERVE src0_sel:WORD_1
v_pk_mul_f16 v155, v155, v154
v_lshrrev_b16 v142, 2, v143
v_fma_mix_f32 v159, v186, v186, v159 op_sel:[0,0,0] op_sel_hi:[1,1,0]
v_pk_mul_f16 v152, v152, v151
v_pk_mul_f16 v149, v149, v148
v_smfmac_f32_16x16x32_bf16 v[20:23], v[216:217], v[208:211], v246
ds_read_b128 v[236:239], v248 offset:57344
ds_read_u16_d16 v142, v142
v_pk_mul_f16 v146, v146, v145
v_fma_mix_f32 v160, v155, v155, v160 op_sel:[0,0,0] op_sel_hi:[1,1,0]
v_lshrrev_b32 v143, 18, v143
v_fma_mix_f32 v160, v155, v155, v160 op_sel:[1,1,0] op_sel_hi:[1,1,0]
v_fma_mix_f32 v160, v152, v152, v160 op_sel:[0,0,0] op_sel_hi:[1,1,0]
v_smfmac_f32_16x16x32_bf16 v[36:39], v[218:219], v[212:215], v246
v_fma_mix_f32 v159, v187, v187, v159 op_sel:[1,1,0] op_sel_hi:[1,1,0]
v_fma_mix_f32 v160, v152, v152, v160 op_sel:[1,1,0] op_sel_hi:[1,1,0]
v_fma_mix_f32 v160, v149, v149, v160 op_sel:[0,0,0] op_sel_hi:[1,1,0]
v_fma_mix_f32 v160, v149, v149, v160 op_sel:[1,1,0] op_sel_hi:[1,1,0]
v_fma_mix_f32 v160, v146, v146, v160 op_sel:[0,0,0] op_sel_hi:[1,1,0]
v_fma_mix_f32 v160, v146, v146, v160 op_sel:[1,1,0] op_sel_hi:[1,1,0]
s_cmp_lg_u32 s40, 7
s_cbranch_scc1 Lnobias2
s_sub_u32 s43, s2, 96
s_cmp_lt_u32 s43, 96
s_cbranch_scc0 Lnobias2
s_waitcnt vmcnt(13)
v_lshlrev_b32 v102, 16, v102
v_lshlrev_b32 v103, 16, v103
v_lshlrev_b32 v104, 16, v104
v_lshlrev_b32 v105, 16, v105
v_lshlrev_b32 v106, 16, v106
v_lshlrev_b32 v107, 16, v107
v_lshlrev_b32 v108, 16, v108
v_lshlrev_b32 v109, 16, v109
v_lshlrev_b32 v110, 16, v110
v_lshlrev_b32 v111, 16, v111
v_lshlrev_b32 v112, 16, v112
v_lshlrev_b32 v113, 16, v113
v_mul_f32 v100, v102, v108
v_fmac_f32 v100, v103, v109
v_fmac_f32 v100, v104, v110
v_fmac_f32 v100, v105, v111
v_fmac_f32 v100, v106, v112
v_fmac_f32 v100, v107, v113
s_nop 1
v_add_f32_dpp v100, v100, v100 row_ror:8 row_mask:0xf bank_mask:0xf
s_nop 1
v_add_f32_dpp v100, v100, v100 row_ror:4 row_mask:0xf bank_mask:0xf
s_nop 1
v_add_f32_dpp v100, v100, v100 row_ror:2 row_mask:0xf bank_mask:0xf
s_nop 1
v_add_f32_dpp v100, v100, v100 row_ror:1 row_mask:0xf bank_mask:0xf
v_mov_b32 v101, v100
s_nop 1
v_permlane16_swap_b32 v100, v101
v_add_f32 v100, v100, v101
v_mov_b32 v101, v100
s_nop 1
v_permlane32_swap_b32 v100, v101
v_add_f32 v100, v100, v101
s_lshl_b32 s44, s43, 2
s_add_u32 s44, s44, 394752
v_lshlrev_b32 v115, 11, v251
s_mov_b64 exec, 0xff
buffer_store_dword v100, v115, s[32:35], s44 offen sc1
s_mov_b64 exec, -1
Lnobias2:
s_setprio 2
v_smfmac_f32_16x16x32_bf16 v[12:15], v[220:221], v[192:195], v246
ds_read_b128 v[216:219], v248 offset:55296
ds_read_u16_d16_hi v143, v143
v_cvt_pkrtz_f16_f32 v179, v120, v121
v_cvt_pkrtz_f16_f32 v181, v122, v123
v_cvt_pkrtz_f16_f32 v183, v124, v125
v_cvt_pkrtz_f16_f32 v185, v126, v127
v_smfmac_f32_16x16x32_bf16 v[28:31], v[222:223], v[196:199], v246
v_cvt_pkrtz_f16_f32 v187, v128, v129
v_cvt_pk_f16_f32 v155, v130, v131
v_cvt_pk_f16_f32 v152, v132, v133
v_cvt_pk_f16_f32 v149, v134, v135
s_waitcnt lgkmcnt(2)
v_mfma_f32_32x32x16_bf16 v[120:135], v[72:75], v[224:227], 0
ds_read_b128 v[220:223], v245 offset:3840
ds_read_b128 v[200:203], v242 offset:128
v_xor_b32 v243, 32, v243
ds_read_b128 v[204:207], v243
v_pk_fma_f16 v154, v155, v155, s48
v_and_b32 v179, s49, v179
v_fma_mix_f32 v160, v136, v136, v160 op_sel:[0,0,0] op_sel_hi:[1,1,0]
v_pk_fma_f16 v151, v152, v152, s48
v_pk_fma_f16 v148, v149, v149, s48
v_lshrrev_b16 v178, 2, v179
v_pk_mul_f16 v154, v155, v154
v_pk_mul_f16 v151, v152, v151
v_mfma_f32_32x32x16_bf16 v[120:135], v[76:79], v[228:231], v[120:135]
ds_read_b128 v[224:227], v248 offset:58368
ds_read_u16_d16 v178, v178
v_pk_mul_f16 v148, v149, v148
v_lshrrev_b32 v179, 18, v179
v_fma_mix_f32 v160, v137, v137, v160 op_sel:[1,1,0] op_sel_hi:[1,1,0]
v_exp_f16 v153, v154
v_and_b32 v181, s49, v181
v_exp_f16 v150, v151
v_mfma_f32_32x32x16_bf16 v[120:135], v[80:83], v[232:235], v[120:135]
ds_read_b128 v[228:231], v245 offset:4224
ds_read_b128 v[208:211], v243 offset:64
ds_read_b128 v[212:215], v243 offset:128
ds_read_u16_d16_hi v179, v179
v_exp_f16 v147, v148
v_lshrrev_b16 v180, 2, v181
v_fma_mix_f32 v160, v138, v138, v160 op_sel:[0,0,0] op_sel_hi:[1,1,0]
v_exp_f16_sdwa v153, v154 dst_sel:WORD_1 dst_unused:UNUSED_PRESERVE src0_sel:WORD_1
v_lshrrev_b32 v181, 18, v181
v_mfma_f32_32x32x16_bf16 v[120:135], v[84:87], v[236:239], v[120:135]
ds_read_b128 v[232:235], v245 offset:4608
v_xor_b32 v244, 32, v244
ds_read_b128 v[192:195], v244
ds_read_b128 v[196:199], v244 offset:64
ds_read_u16_d16 v180, v180
ds_read_u16_d16_hi v181, v181
v_exp_f16_sdwa v150, v151 dst_sel:WORD_1 dst_unused:UNUSED_PRESERVE src0_sel:WORD_1
v_fma_mix_f32 v160, v139, v139, v160 op_sel:[1,1,0] op_sel_hi:[1,1,0]
v_and_b32 v183, s49, v183
v_exp_f16_sdwa v147, v148 dst_sel:WORD_1 dst_unused:UNUSED_PRESERVE src0_sel:WORD_1
v_pk_add_f16 v153, v153, 1.0 op_sel_hi:[1,0]
v_lshrrev_b16 v182, 2, v183
v_pk_add_f16 v150, v150, 1.0 op_sel_hi:[1,0]
s_waitcnt lgkmcnt(9)
v_mfma_f32_32x32x16_bf16 v[120:135], v[88:91], v[216:219], v[120:135]
ds_read_b128 v[236:239], v248 offset:59392
ds_read_u16_d16 v182, v182
v_pk_add_f16 v147, v147, 1.0 op_sel_hi:[1,0]
v_rcp_f16 v154, v153
v_lshrrev_b32 v183, 18, v183
v_fma_mix_f32 v160, v140, v140, v160 op_sel:[0,0,0] op_sel_hi:[1,1,0]
v_rcp_f16 v151, v150
v_and_b32 v185, s49, v185
v_smfmac_f32_16x16x32_bf16 v[44:47], v[220:221], v[200:203], v246
ds_read_b128 v[216:219], v248 offset:62464
ds_read_u16_d16_hi v183, v183
v_rcp_f16 v148, v147
v_fma_mix_f32 v160, v141, v141, v160 op_sel:[1,1,0] op_sel_hi:[1,1,0]
v_lshrrev_b16 v184, 2, v185
v_smfmac_f32_16x16x32_bf16 v[12:15], v[222:223], v[204:207], v246
v_rcp_f16_sdwa v154, v153 dst_sel:WORD_1 dst_unused:UNUSED_PRESERVE src0_sel:WORD_1
v_rcp_f16_sdwa v151, v150 dst_sel:WORD_1 dst_unused:UNUSED_PRESERVE src0_sel:WORD_1
v_mfma_f32_32x32x16_bf16 v[120:135], v[92:95], v[224:227], v[120:135]
ds_read_b128 v[220:223], v248 offset:60416
ds_read_u16_d16 v184, v184
v_lshrrev_b32 v185, 18, v185
v_rcp_f16_sdwa v148, v147 dst_sel:WORD_1 dst_unused:UNUSED_PRESERVE src0_sel:WORD_1
v_and_b32 v187, s49, v187
v_fma_mix_f32 v160, v142, v142, v160 op_sel:[0,0,0] op_sel_hi:[1,1,0]
v_pk_mul_f16 v155, v155, v154
v_pk_mul_f16 v152, v152, v151
v_lshrrev_b16 v186, 2, v187
s_waitcnt lgkmcnt(4)
v_smfmac_f32_16x16x32_bf16 v[28:31], v[228:229], v[208:211], v246
ds_read_b128 v[224:227], v248 offset:63488
ds_read_u16_d16_hi v185, v185
ds_read_u16_d16 v186, v186
v_pk_mul_f16 v149, v149, v148
v_fma_mix_f32 v161, v155, v155, v161 op_sel:[0,0,0] op_sel_hi:[1,1,0]
v_fma_mix_f32 v160, v143, v143, v160 op_sel:[1,1,0] op_sel_hi:[1,1,0]
v_lshrrev_b32 v187, 18, v187
v_smfmac_f32_16x16x32_bf16 v[44:47], v[230:231], v[212:215], v246
v_fma_mix_f32 v161, v155, v155, v161 op_sel:[1,1,0] op_sel_hi:[1,1,0]
v_fma_mix_f32 v161, v152, v152, v161 op_sel:[0,0,0] op_sel_hi:[1,1,0]
v_fma_mix_f32 v161, v152, v152, v161 op_sel:[1,1,0] op_sel_hi:[1,1,0]
v_fma_mix_f32 v161, v149, v149, v161 op_sel:[0,0,0] op_sel_hi:[1,1,0]
v_fma_mix_f32 v161, v149, v149, v161 op_sel:[1,1,0] op_sel_hi:[1,1,0]
v_lshlrev_b32 v252, 7, v251
s_add_u32 s46, s47, 2359296
s_mov_b32 exec_lo, 131071
s_mov_b32 exec_hi, 0
s_mov_b32 m0, 16288
s_nop 0
buffer_load_dword v252, s[4:7], s46 offen lds
s_mov_b64 exec, -1
s_setprio 1
v_smfmac_f32_16x16x32_bf16 v[12:15], v[232:233], v[192:195], v246
ds_read_b128 v[228:231], v248 offset:61440
ds_read_u16_d16_hi v187, v187
v_cvt_pkrtz_f16_f32 v137, v120, v121
v_cvt_pkrtz_f16_f32 v139, v122, v123
v_cvt_pkrtz_f16_f32 v141, v124, v125
v_cvt_pkrtz_f16_f32 v143, v126, v127
v_cvt_pk_f16_f32 v155, v128, v129
v_smfmac_f32_16x16x32_bf16 v[28:31], v[234:235], v[196:199], v246
v_cvt_pk_f16_f32 v152, v130, v131
v_cvt_pk_f16_f32 v149, v132, v133
v_cvt_pk_f16_f32 v146, v134, v135
v_pk_fma_f16 v154, v155, v155, s48
v_and_b32 v137, s49, v137
v_mfma_f32_32x32x16_bf16 v[120:135], v[72:75], v[236:239], 0
ds_read_b128 v[232:235], v248 offset:64512
v_fma_mix_f32 v161, v178, v178, v161 op_sel:[0,0,0] op_sel_hi:[1,1,0]
v_pk_fma_f16 v151, v152, v152, s48
v_pk_fma_f16 v148, v149, v149, s48
v_pk_fma_f16 v145, v146, v146, s48
v_pk_mul_f16 v154, v155, v154
v_lshrrev_b16 v136, 2, v137
v_pk_mul_f16 v151, v152, v151
v_fma_mix_f32 v161, v179, v179, v161 op_sel:[1,1,0] op_sel_hi:[1,1,0]
v_pk_mul_f16 v148, v149, v148
v_pk_mul_f16 v145, v146, v145
s_waitcnt lgkmcnt(2)
v_mfma_f32_32x32x16_bf16 v[120:135], v[76:79], v[216:219], v[120:135]
ds_read_b128 v[236:239], v245 offset:4992
ds_read_b128 v[200:203], v244 offset:128
v_xor_b32 v242, 16, v242
ds_read_b128 v[204:207], v242
ds_read_u16_d16 v136, v136
v_exp_f16 v153, v154
v_lshrrev_b32 v137, 18, v137
v_exp_f16 v150, v151
v_fma_mix_f32 v161, v180, v180, v161 op_sel:[0,0,0] op_sel_hi:[1,1,0]
v_exp_f16 v147, v148
v_and_b32 v139, s49, v139
v_exp_f16 v144, v145
v_mfma_f32_32x32x16_bf16 v[120:135], v[80:83], v[220:223], v[120:135]
ds_read_b128 v[216:219], v245 offset:5376
ds_read_b128 v[208:211], v242 offset:64
ds_read_b128 v[212:215], v242 offset:128
ds_read_u16_d16_hi v137, v137
v_exp_f16_sdwa v153, v154 dst_sel:WORD_1 dst_unused:UNUSED_PRESERVE src0_sel:WORD_1
v_fma_mix_f32 v161, v181, v181, v161 op_sel:[1,1,0] op_sel_hi:[1,1,0]
v_lshrrev_b16 v138, 2, v139
v_exp_f16_sdwa v150, v151 dst_sel:WORD_1 dst_unused:UNUSED_PRESERVE src0_sel:WORD_1
v_exp_f16_sdwa v147, v148 dst_sel:WORD_1 dst_unused:UNUSED_PRESERVE src0_sel:WORD_1
v_exp_f16_sdwa v144, v145 dst_sel:WORD_1 dst_unused:UNUSED_PRESERVE src0_sel:WORD_1
v_lshrrev_b32 v139, 18, v139
v_fma_mix_f32 v161, v182, v182, v161 op_sel:[0,0,0] op_sel_hi:[1,1,0]
v_mfma_f32_32x32x16_bf16 v[120:135], v[84:87], v[224:227], v[120:135]
ds_read_b128 v[220:223], v249
ds_read_u16_d16 v138, v138
ds_read_u16_d16_hi v139, v139
v_pk_add_f16 v153, v153, 1.0 op_sel_hi:[1,0]
v_pk_add_f16 v150, v150, 1.0 op_sel_hi:[1,0]
v_pk_add_f16 v147, v147, 1.0 op_sel_hi:[1,0]
v_and_b32 v141, s49, v141
v_pk_add_f16 v144, v144, 1.0 op_sel_hi:[1,0]
v_rcp_f16 v154, v153
v_fma_mix_f32 v161, v183, v183, v161 op_sel:[1,1,0] op_sel_hi:[1,1,0]
v_rcp_f16 v151, v150
v_mfma_f32_32x32x16_bf16 v[120:135], v[88:91], v[228:231], v[120:135]
ds_read_b128 v[224:227], v249 offset:3072
v_lshrrev_b16 v140, 2, v141
v_rcp_f16 v148, v147
v_fma_mix_f32 v161, v184, v184, v161 op_sel:[0,0,0] op_sel_hi:[1,1,0]
v_rcp_f16 v145, v144
v_lshrrev_b32 v141, 18, v141
v_rcp_f16_sdwa v154, v153 dst_sel:WORD_1 dst_unused:UNUSED_PRESERVE src0_sel:WORD_1
s_setprio 0
v_rcp_f16_sdwa v151, v150 dst_sel:WORD_1 dst_unused:UNUSED_PRESERVE src0_sel:WORD_1
s_waitcnt lgkmcnt(4)
v_mfma_f32_32x32x16_bf16 v[120:135], v[92:95], v[232:235], v[120:135]
ds_read_b128 v[228:231], v249 offset:1024
ds_read_u16_d16 v140, v140
ds_read_u16_d16_hi v141, v141
v_fma_mix_f32 v161, v185, v185, v161 op_sel:[1,1,0] op_sel_hi:[1,1,0]
v_and_b32 v143, s49, v143
v_rcp_f16_sdwa v148, v147 dst_sel:WORD_1 dst_unused:UNUSED_PRESERVE src0_sel:WORD_1
v_rcp_f16_sdwa v145, v144 dst_sel:WORD_1 dst_unused:UNUSED_PRESERVE src0_sel:WORD_1
v_pk_mul_f16 v155, v155, v154
v_lshrrev_b16 v142, 2, v143
v_fma_mix_f32 v161, v186, v186, v161 op_sel:[0,0,0] op_sel_hi:[1,1,0]
v_pk_mul_f16 v152, v152, v151
v_pk_mul_f16 v149, v149, v148
v_smfmac_f32_16x16x32_bf16 v[44:47], v[236:237], v[200:203], v246
ds_read_b128 v[232:235], v249 offset:4096
ds_read_u16_d16 v142, v142
v_pk_mul_f16 v146, v146, v145
v_fma_mix_f32 v162, v155, v155, v162 op_sel:[0,0,0] op_sel_hi:[1,1,0]
v_lshrrev_b32 v143, 18, v143
v_fma_mix_f32 v162, v155, v155, v162 op_sel:[1,1,0] op_sel_hi:[1,1,0]
v_fma_mix_f32 v162, v152, v152, v162 op_sel:[0,0,0] op_sel_hi:[1,1,0]
v_smfmac_f32_16x16x32_bf16 v[8:11], v[238:239], v[204:207], v246
v_fma_mix_f32 v161, v187, v187, v161 op_sel:[1,1,0] op_sel_hi:[1,1,0]
v_fma_mix_f32 v162, v152, v152, v162 op_sel:[1,1,0] op_sel_hi:[1,1,0]
v_fma_mix_f32 v162, v149, v149, v162 op_sel:[0,0,0] op_sel_hi:[1,1,0]
v_fma_mix_f32 v162, v149, v149, v162 op_sel:[1,1,0] op_sel_hi:[1,1,0]
v_fma_mix_f32 v162, v146, v146, v162 op_sel:[0,0,0] op_sel_hi:[1,1,0]
v_fma_mix_f32 v162, v146, v146, v162 op_sel:[1,1,0] op_sel_hi:[1,1,0]
v_lshlrev_b32 v252, 7, v251
s_add_u32 s46, s47, 2359296
s_mov_b32 exec_lo, 4294836224
s_mov_b32 exec_hi, 3
s_mov_b32 m0, 16220
s_nop 0
buffer_load_dword v252, s[4:7], s46 offen lds
s_mov_b64 exec, -1
s_setprio 2
v_smfmac_f32_16x16x32_bf16 v[24:27], v[216:217], v[208:211], v246
ds_read_b128 v[236:239], v249 offset:2048
ds_read_u16_d16_hi v143, v143
v_cvt_pkrtz_f16_f32 v179, v120, v121
v_cvt_pkrtz_f16_f32 v181, v122, v123
v_cvt_pkrtz_f16_f32 v183, v124, v125
v_cvt_pkrtz_f16_f32 v185, v126, v127
v_smfmac_f32_16x16x32_bf16 v[40:43], v[218:219], v[212:215], v246
v_cvt_pkrtz_f16_f32 v187, v128, v129
v_cvt_pk_f16_f32 v155, v130, v131
v_cvt_pk_f16_f32 v152, v132, v133
v_cvt_pk_f16_f32 v149, v134, v135
v_pk_fma_f16 v154, v155, v155, s48
s_waitcnt lgkmcnt(2)
v_mfma_f32_32x32x16_bf16 v[120:135], v[72:75], v[220:223], 0
ds_read_b128 v[216:219], v249 offset:5120
v_and_b32 v179, s49, v179
v_fma_mix_f32 v162, v136, v136, v162 op_sel:[0,0,0] op_sel_hi:[1,1,0]
v_pk_fma_f16 v151, v152, v152, s48
v_pk_fma_f16 v148, v149, v149, s48
v_lshrrev_b16 v178, 2, v179
v_pk_mul_f16 v154, v155, v154
v_pk_mul_f16 v151, v152, v151
v_pk_mul_f16 v148, v149, v148
v_lshrrev_b32 v179, 18, v179
v_mfma_f32_32x32x16_bf16 v[120:135], v[76:79], v[224:227], v[120:135]
ds_read_b128 v[220:223], v245 offset:5760
v_xor_b32 v243, 16, v243
ds_read_b128 v[192:195], v243
ds_read_b128 v[196:199], v243 offset:64
ds_read_u16_d16 v178, v178
ds_read_u16_d16_hi v179, v179
v_fma_mix_f32 v162, v137, v137, v162 op_sel:[1,1,0] op_sel_hi:[1,1,0]
v_exp_f16 v153, v154
v_and_b32 v181, s49, v181
v_exp_f16 v150, v151
v_exp_f16 v147, v148
v_lshrrev_b16 v180, 2, v181
v_mfma_f32_32x32x16_bf16 v[120:135], v[80:83], v[228:231], v[120:135]
ds_read_b128 v[224:227], v245 offset:6144
ds_read_b128 v[200:203], v243 offset:128
v_xor_b32 v244, 16, v244
ds_read_b128 v[204:207], v244
ds_read_u16_d16 v180, v180
v_fma_mix_f32 v162, v138, v138, v162 op_sel:[0,0,0] op_sel_hi:[1,1,0]
v_exp_f16_sdwa v153, v154 dst_sel:WORD_1 dst_unused:UNUSED_PRESERVE src0_sel:WORD_1
v_lshrrev_b32 v181, 18, v181
v_exp_f16_sdwa v150, v151 dst_sel:WORD_1 dst_unused:UNUSED_PRESERVE src0_sel:WORD_1
v_fma_mix_f32 v162, v139, v139, v162 op_sel:[1,1,0] op_sel_hi:[1,1,0]
v_and_b32 v183, s49, v183
v_mfma_f32_32x32x16_bf16 v[120:135], v[84:87], v[232:235], v[120:135]
ds_read_b128 v[228:231], v249 offset:6144
ds_read_u16_d16_hi v181, v181
v_exp_f16_sdwa v147, v148 dst_sel:WORD_1 dst_unused:UNUSED_PRESERVE src0_sel:WORD_1
v_pk_add_f16 v153, v153, 1.0 op_sel_hi:[1,0]
v_lshrrev_b16 v182, 2, v183
v_pk_add_f16 v150, v150, 1.0 op_sel_hi:[1,0]
v_pk_add_f16 v147, v147, 1.0 op_sel_hi:[1,0]
v_rcp_f16 v154, v153
v_lshrrev_b32 v183, 18, v183
v_fma_mix_f32 v162, v140, v140, v162 op_sel:[0,0,0] op_sel_hi:[1,1,0]
s_waitcnt lgkmcnt(6)
v_mfma_f32_32x32x16_bf16 v[120:135], v[88:91], v[236:239], v[120:135]
ds_read_b128 v[232:235], v249 offset:9216
ds_read_u16_d16 v182, v182
ds_read_u16_d16_hi v183, v183
v_rcp_f16 v151, v150
v_and_b32 v185, s49, v185
v_rcp_f16 v148, v147
v_fma_mix_f32 v162, v141, v141, v162 op_sel:[1,1,0] op_sel_hi:[1,1,0]
v_lshrrev_b16 v184, 2, v185
v_rcp_f16_sdwa v154, v153 dst_sel:WORD_1 dst_unused:UNUSED_PRESERVE src0_sel:WORD_1
v_mfma_f32_32x32x16_bf16 v[120:135], v[92:95], v[216:219], v[120:135]
ds_read_b128 v[236:239], v249 offset:7168
ds_read_u16_d16 v184, v184
v_rcp_f16_sdwa v151, v150 dst_sel:WORD_1 dst_unused:UNUSED_PRESERVE src0_sel:WORD_1
v_lshrrev_b32 v185, 18, v185
v_rcp_f16_sdwa v148, v147 dst_sel:WORD_1 dst_unused:UNUSED_PRESERVE src0_sel:WORD_1
v_and_b32 v187, s49, v187
v_fma_mix_f32 v162, v142, v142, v162 op_sel:[0,0,0] op_sel_hi:[1,1,0]
v_pk_mul_f16 v155, v155, v154
v_pk_mul_f16 v152, v152, v151
v_smfmac_f32_16x16x32_bf16 v[8:11], v[220:221], v[192:195], v246
ds_read_b128 v[216:219], v249 offset:10240
ds_read_u16_d16_hi v185, v185
v_lshrrev_b16 v186, 2, v187
v_pk_mul_f16 v149, v149, v148
v_fma_mix_f32 v163, v155, v155, v163 op_sel:[0,0,0] op_sel_hi:[1,1,0]
v_fma_mix_f32 v162, v143, v143, v162 op_sel:[1,1,0] op_sel_hi:[1,1,0]
v_lshrrev_b32 v187, 18, v187
v_smfmac_f32_16x16x32_bf16 v[24:27], v[222:223], v[196:199], v246
v_fma_mix_f32 v163, v155, v155, v163 op_sel:[1,1,0] op_sel_hi:[1,1,0]
v_fma_mix_f32 v163, v152, v152, v163 op_sel:[0,0,0] op_sel_hi:[1,1,0]
v_fma_mix_f32 v163, v152, v152, v163 op_sel:[1,1,0] op_sel_hi:[1,1,0]
v_fma_mix_f32 v163, v149, v149, v163 op_sel:[0,0,0] op_sel_hi:[1,1,0]
v_fma_mix_f32 v163, v149, v149, v163 op_sel:[1,1,0] op_sel_hi:[1,1,0]
v_lshlrev_b32 v252, 7, v251
s_add_u32 s46, s47, 2359296
s_mov_b32 exec_lo, 0
s_mov_b32 exec_hi, 1048572
s_mov_b32 m0, 16152
s_nop 0
buffer_load_dword v252, s[4:7], s46 offen lds
s_mov_b64 exec, -1
s_setprio 1
s_waitcnt lgkmcnt(2)
v_smfmac_f32_16x16x32_bf16 v[40:43], v[224:225], v[200:203], v246
ds_read_b128 v[220:223], v249 offset:8192
ds_read_u16_d16 v186, v186
ds_read_u16_d16_hi v187, v187
v_cvt_pkrtz_f16_f32 v137, v120, v121
v_cvt_pkrtz_f16_f32 v139, v122, v123
v_cvt_pkrtz_f16_f32 v141, v124, v125
v_cvt_pkrtz_f16_f32 v143, v126, v127
v_smfmac_f32_16x16x32_bf16 v[8:11], v[226:227], v[204:207], v246
v_cvt_pk_f16_f32 v155, v128, v129
v_cvt_pk_f16_f32 v152, v130, v131
v_cvt_pk_f16_f32 v149, v132, v133
v_cvt_pk_f16_f32 v146, v134, v135
v_pk_fma_f16 v154, v155, v155, s48
v_mfma_f32_32x32x16_bf16 v[120:135], v[72:75], v[228:231], 0
ds_read_b128 v[224:227], v249 offset:11264
v_and_b32 v137, s49, v137
v_fma_mix_f32 v163, v178, v178, v163 op_sel:[0,0,0] op_sel_hi:[1,1,0]
v_pk_fma_f16 v151, v152, v152, s48
v_pk_fma_f16 v148, v149, v149, s48
v_pk_fma_f16 v145, v146, v146, s48
v_pk_mul_f16 v154, v155, v154
v_lshrrev_b16 v136, 2, v137
v_pk_mul_f16 v151, v152, v151
v_fma_mix_f32 v163, v179, v179, v163 op_sel:[1,1,0] op_sel_hi:[1,1,0]
v_pk_mul_f16 v148, v149, v148
v_mfma_f32_32x32x16_bf16 v[120:135], v[76:79], v[232:235], v[120:135]
ds_read_b128 v[228:231], v245 offset:6528
ds_read_b128 v[208:211], v244 offset:64
ds_read_b128 v[212:215], v244 offset:128
ds_read_u16_d16 v136, v136
v_pk_mul_f16 v145, v146, v145
v_exp_f16 v153, v154
v_lshrrev_b32 v137, 18, v137
v_exp_f16 v150, v151
v_fma_mix_f32 v163, v180, v180, v163 op_sel:[0,0,0] op_sel_hi:[1,1,0]
v_exp_f16 v147, v148
v_and_b32 v139, s49, v139
v_mfma_f32_32x32x16_bf16 v[120:135], v[80:83], v[236:239], v[120:135]
ds_read_b128 v[232:235], v249 offset:12288
ds_read_u16_d16_hi v137, v137
v_exp_f16 v144, v145
v_exp_f16_sdwa v153, v154 dst_sel:WORD_1 dst_unused:UNUSED_PRESERVE src0_sel:WORD_1
v_fma_mix_f32 v163, v181, v181, v163 op_sel:[1,1,0] op_sel_hi:[1,1,0]
v_lshrrev_b16 v138, 2, v139
v_exp_f16_sdwa v150, v151 dst_sel:WORD_1 dst_unused:UNUSED_PRESERVE src0_sel:WORD_1
v_exp_f16_sdwa v147, v148 dst_sel:WORD_1 dst_unused:UNUSED_PRESERVE src0_sel:WORD_1
s_waitcnt lgkmcnt(6)
v_mfma_f32_32x32x16_bf16 v[120:135], v[84:87], v[216:219], v[120:135]
ds_read_b128 v[236:239], v249 offset:15360
ds_read_u16_d16 v138, v138
v_exp_f16_sdwa v144, v145 dst_sel:WORD_1 dst_unused:UNUSED_PRESERVE src0_sel:WORD_1
v_lshrrev_b32 v139, 18, v139
v_fma_mix_f32 v163, v182, v182, v163 op_sel:[0,0,0] op_sel_hi:[1,1,0]
v_pk_add_f16 v153, v153, 1.0 op_sel_hi:[1,0]
v_pk_add_f16 v150, v150, 1.0 op_sel_hi:[1,0]
v_pk_add_f16 v147, v147, 1.0 op_sel_hi:[1,0]
v_and_b32 v141, s49, v141
v_pk_add_f16 v144, v144, 1.0 op_sel_hi:[1,0]
v_mfma_f32_32x32x16_bf16 v[120:135], v[88:91], v[220:223], v[120:135]
ds_read_b128 v[216:219], v249 offset:13312
ds_read_u16_d16_hi v139, v139
v_rcp_f16 v154, v153
v_fma_mix_f32 v163, v183, v183, v163 op_sel:[1,1,0] op_sel_hi:[1,1,0]
v_rcp_f16 v151, v150
v_lshrrev_b16 v140, 2, v141
v_rcp_f16 v148, v147
v_fma_mix_f32 v163, v184, v184, v163 op_sel:[0,0,0] op_sel_hi:[1,1,0]
v_mfma_f32_32x32x16_bf16 v[120:135], v[92:95], v[224:227], v[120:135]
ds_read_b128 v[220:223], v249 offset:16384
ds_read_u16_d16 v140, v140
v_rcp_f16 v145, v144
v_lshrrev_b32 v141, 18, v141
v_rcp_f16_sdwa v154, v153 dst_sel:WORD_1 dst_unused:UNUSED_PRESERVE src0_sel:WORD_1
s_setprio 0
v_rcp_f16_sdwa v151, v150 dst_sel:WORD_1 dst_unused:UNUSED_PRESERVE src0_sel:WORD_1
v_fma_mix_f32 v163, v185, v185, v163 op_sel:[1,1,0] op_sel_hi:[1,1,0]
v_and_b32 v143, s49, v143
v_rcp_f16_sdwa v148, v147 dst_sel:WORD_1 dst_unused:UNUSED_PRESERVE src0_sel:WORD_1
s_waitcnt lgkmcnt(4)
v_smfmac_f32_16x16x32_bf16 v[24:27], v[228:229], v[208:211], v246
ds_read_b128 v[224:227], v249 offset:14336
ds_read_u16_d16_hi v141, v141
v_rcp_f16_sdwa v145, v144 dst_sel:WORD_1 dst_unused:UNUSED_PRESERVE src0_sel:WORD_1
v_pk_mul_f16 v155, v155, v154
v_lshrrev_b16 v142, 2, v143
v_fma_mix_f32 v163, v186, v186, v163 op_sel:[0,0,0] op_sel_hi:[1,1,0]
v_smfmac_f32_16x16x32_bf16 v[40:43], v[230:231], v[212:215], v246
s_mov_b64 exec, 1
ds_add_u32 v253, v254 offset:16
s_mov_b64 exec, -1
v_pk_mul_f16 v152, v152, v151
v_pk_mul_f16 v149, v149, v148
v_pk_mul_f16 v146, v146, v145
v_fma_mix_f32 v164, v155, v155, v164 op_sel:[0,0,0] op_sel_hi:[1,1,0]
v_lshrrev_b32 v143, 18, v143
v_fma_mix_f32 v164, v155, v155, v164 op_sel:[1,1,0] op_sel_hi:[1,1,0]
v_fma_mix_f32 v164, v152, v152, v164 op_sel:[0,0,0] op_sel_hi:[1,1,0]
v_fma_mix_f32 v163, v187, v187, v163 op_sel:[1,1,0] op_sel_hi:[1,1,0]
v_fma_mix_f32 v164, v152, v152, v164 op_sel:[1,1,0] op_sel_hi:[1,1,0]
v_fma_mix_f32 v164, v149, v149, v164 op_sel:[0,0,0] op_sel_hi:[1,1,0]
v_fma_mix_f32 v164, v149, v149, v164 op_sel:[1,1,0] op_sel_hi:[1,1,0]
v_fma_mix_f32 v164, v146, v146, v164 op_sel:[0,0,0] op_sel_hi:[1,1,0]
v_fma_mix_f32 v164, v146, v146, v164 op_sel:[1,1,0] op_sel_hi:[1,1,0]
s_setprio 3
v_pk_add_f32 v[168:169], v[0:1], v[2:3]
v_pk_mul_f32 v[170:171], v[0:1], v[0:1]
v_pk_fma_f32 v[170:171], v[2:3], v[2:3], v[170:171]
v_pk_add_f32 v[168:169], v[168:169], v[4:5]
v_pk_fma_f32 v[170:171], v[4:5], v[4:5], v[170:171]
v_pk_add_f32 v[168:169], v[168:169], v[6:7]
v_pk_fma_f32 v[170:171], v[6:7], v[6:7], v[170:171]
v_pk_add_f32 v[168:169], v[168:169], v[8:9]
v_pk_fma_f32 v[170:171], v[8:9], v[8:9], v[170:171]
v_pk_add_f32 v[168:169], v[168:169], v[10:11]
v_pk_fma_f32 v[170:171], v[10:11], v[10:11], v[170:171]
v_pk_add_f32 v[168:169], v[168:169], v[12:13]
v_pk_fma_f32 v[170:171], v[12:13], v[12:13], v[170:171]
v_pk_add_f32 v[168:169], v[168:169], v[14:15]
v_pk_fma_f32 v[170:171], v[14:15], v[14:15], v[170:171]
v_pk_add_f32 v[168:169], v[168:169], v[16:17]
v_pk_fma_f32 v[170:171], v[16:17], v[16:17], v[170:171]
v_pk_add_f32 v[168:169], v[168:169], v[18:19]
v_pk_fma_f32 v[170:171], v[18:19], v[18:19], v[170:171]
v_pk_add_f32 v[168:169], v[168:169], v[20:21]
v_pk_fma_f32 v[170:171], v[20:21], v[20:21], v[170:171]
v_pk_add_f32 v[168:169], v[168:169], v[22:23]
v_pk_fma_f32 v[170:171], v[22:23], v[22:23], v[170:171]
v_pk_add_f32 v[168:169], v[168:169], v[24:25]
v_pk_fma_f32 v[170:171], v[24:25], v[24:25], v[170:171]
v_pk_add_f32 v[168:169], v[168:169], v[26:27]
v_pk_fma_f32 v[170:171], v[26:27], v[26:27], v[170:171]
v_pk_add_f32 v[168:169], v[168:169], v[28:29]
v_pk_fma_f32 v[170:171], v[28:29], v[28:29], v[170:171]
v_pk_add_f32 v[168:169], v[168:169], v[30:31]
v_pk_fma_f32 v[170:171], v[30:31], v[30:31], v[170:171]
v_pk_add_f32 v[168:169], v[168:169], v[32:33]
v_pk_fma_f32 v[170:171], v[32:33], v[32:33], v[170:171]
v_pk_add_f32 v[168:169], v[168:169], v[34:35]
v_pk_fma_f32 v[170:171], v[34:35], v[34:35], v[170:171]
v_pk_add_f32 v[168:169], v[168:169], v[36:37]
v_pk_fma_f32 v[170:171], v[36:37], v[36:37], v[170:171]
v_pk_add_f32 v[168:169], v[168:169], v[38:39]
v_pk_fma_f32 v[170:171], v[38:39], v[38:39], v[170:171]
v_pk_add_f32 v[168:169], v[168:169], v[40:41]
v_pk_fma_f32 v[170:171], v[40:41], v[40:41], v[170:171]
v_pk_add_f32 v[168:169], v[168:169], v[42:43]
v_pk_fma_f32 v[170:171], v[42:43], v[42:43], v[170:171]
v_pk_add_f32 v[168:169], v[168:169], v[44:45]
v_pk_fma_f32 v[170:171], v[44:45], v[44:45], v[170:171]
v_pk_add_f32 v[168:169], v[168:169], v[46:47]
v_pk_fma_f32 v[170:171], v[46:47], v[46:47], v[170:171]
s_setprio 0
v_add_u32 v174, -36864, v242
v_subrev_u32 v175, 66560, v174
v_min_u32 v174, v174, v175
v_add_u32 v174, 90112, v174
v_sub_u32 v175, v174, v242
v_add_u32 v242, v175, v242
v_add_u32 v243, v175, v243
v_add_u32 v244, v175, v244
s_setprio 2
v_cvt_pkrtz_f16_f32 v179, v120, v121
v_cvt_pkrtz_f16_f32 v181, v122, v123
v_cvt_pkrtz_f16_f32 v183, v124, v125
v_cvt_pkrtz_f16_f32 v185, v126, v127
v_cvt_pkrtz_f16_f32 v187, v128, v129
v_cvt_pkrtz_f16_f32 v189, v130, v131
v_cvt_pk_f16_f32 v155, v132, v133
v_cvt_pk_f16_f32 v152, v134, v135
ds_read_b128 v[228:231], v249 offset:17408
ds_read_u16_d16 v142, v142
ds_read_u16_d16_hi v143, v143
v_mfma_f32_32x32x16_bf16 v[120:135], v[72:75], v[232:235], 0
v_pk_fma_f16 v154, v155, v155, s48
v_add_f32 v168, v168, v169
v_and_b32 v179, s49, v179
v_fma_mix_f32 v164, v136, v136, v164 op_sel:[0,0,0] op_sel_hi:[1,1,0]
v_lshrrev_b16 v178, 2, v179
v_add_f32 v170, v170, v171
v_pk_fma_f16 v151, v152, v152, s48
v_pk_mul_f16 v154, v155, v154
v_lshrrev_b32 v179, 18, v179
v_pk_mul_f16 v151, v152, v151
ds_read_b128 v[232:235], v249 offset:18432
ds_read_u16_d16 v178, v178
ds_read_u16_d16_hi v179, v179
v_mfma_f32_32x32x16_bf16 v[120:135], v[76:79], v[236:239], v[120:135]
v_permlane32_swap_b32 v168, v170
v_fma_mix_f32 v164, v137, v137, v164 op_sel:[1,1,0] op_sel_hi:[1,1,0]
v_and_b32 v181, s49, v181
v_exp_f16 v153, v154
v_add_f32 v168, v168, v170
v_lshrrev_b16 v180, 2, v181
v_exp_f16 v150, v151
v_lshrrev_b32 v181, 18, v181
s_waitcnt lgkmcnt(7)
ds_read_b128 v[236:239], v249 offset:21504
ds_read_u16_d16 v180, v180
ds_read_u16_d16_hi v181, v181
v_mfma_f32_32x32x16_bf16 v[120:135], v[80:83], v[216:219], v[120:135]
v_mul_f32 v168, 1009429163, v168
v_fma_mix_f32 v164, v138, v138, v164 op_sel:[0,0,0] op_sel_hi:[1,1,0]
v_exp_f16_sdwa v153, v154 dst_sel:WORD_1 dst_unused:UNUSED_PRESERVE src0_sel:WORD_1
v_and_b32 v183, s49, v183
v_mov_b32 v170, v168
v_exp_f16_sdwa v150, v151 dst_sel:WORD_1 dst_unused:UNUSED_PRESERVE src0_sel:WORD_1
v_lshrrev_b16 v182, 2, v183
v_fma_mix_f32 v164, v139, v139, v164 op_sel:[1,1,0] op_sel_hi:[1,1,0]
v_permlane32_swap_b32 v168, v170
ds_read_b128 v[216:219], v249 offset:19456
ds_read_u16_d16 v182, v182
v_mfma_f32_32x32x16_bf16 v[120:135], v[84:87], v[220:223], v[120:135]
v_lshrrev_b32 v183, 18, v183
v_pk_add_f16 v153, v153, 1.0 op_sel_hi:[1,0]
v_pk_add_f16 v150, v150, 1.0 op_sel_hi:[1,0]
v_and_b32 v185, s49, v185
v_fma_f32 v170, -v168, v168, v170
v_rcp_f16 v154, v153
v_lshrrev_b16 v184, 2, v185
v_max_f32 v170, 0, v170
v_fma_mix_f32 v164, v140, v140, v164 op_sel:[0,0,0] op_sel_hi:[1,1,0]
ds_read_b128 v[220:223], v249 offset:22528
ds_read_u16_d16_hi v183, v183
ds_read_u16_d16 v184, v184
v_mfma_f32_32x32x16_bf16 v[120:135], v[88:91], v[224:227], v[120:135]
v_lshrrev_b32 v185, 18, v185
v_rcp_f16 v151, v150
v_add_f32 v170, 925353388, v170
v_and_b32 v187, s49, v187
v_fma_mix_f32 v164, v141, v141, v164 op_sel:[1,1,0] op_sel_hi:[1,1,0]
v_rcp_f16_sdwa v154, v153 dst_sel:WORD_1 dst_unused:UNUSED_PRESERVE src0_sel:WORD_1
v_rsq_f32 v170, v170
s_waitcnt lgkmcnt(5)
ds_read_b128 v[224:227], v249 offset:20480
ds_read_u16_d16_hi v185, v185
ds_read_b32 v247, v253 offset:16
v_mfma_f32_32x32x16_bf16 v[120:135], v[92:95], v[228:231], v[120:135]
v_lshrrev_b16 v186, 2, v187
v_rcp_f16_sdwa v151, v150 dst_sel:WORD_1 dst_unused:UNUSED_PRESERVE src0_sel:WORD_1
v_lshrrev_b32 v187, 18, v187
v_fma_mix_f32 v164, v142, v142, v164 op_sel:[0,0,0] op_sel_hi:[1,1,0]
v_and_b32 v189, s49, v189
v_pk_mul_f16 v155, v155, v154
v_pk_mul_f16 v152, v152, v151
v_mul_f32 v172, 3203391086, v170
v_lshrrev_b16 v188, 2, v189
v_fma_mix_f32 v165, v155, v155, v165 op_sel:[0,0,0] op_sel_hi:[1,1,0]
v_fma_mix_f32 v164, v143, v143, v164 op_sel:[1,1,0] op_sel_hi:[1,1,0]
v_lshrrev_b32 v189, 18, v189
v_mul_f32 v173, v168, v172
v_fma_mix_f32 v165, v155, v155, v165 op_sel:[1,1,0] op_sel_hi:[1,1,0]
v_fma_mix_f32 v165, v152, v152, v165 op_sel:[0,0,0] op_sel_hi:[1,1,0]
v_fma_mix_f32 v165, v152, v152, v165 op_sel:[1,1,0] op_sel_hi:[1,1,0]
s_setprio 3
v_pk_fma_f32 v[0:1], v[0:1], v[172:173], v[172:173] op_sel:[0,0,1] op_sel_hi:[1,0,1] neg_lo:[0,0,1] neg_hi:[0,0,1]
v_pk_fma_f32 v[2:3], v[2:3], v[172:173], v[172:173] op_sel:[0,0,1] op_sel_hi:[1,0,1] neg_lo:[0,0,1] neg_hi:[0,0,1]
v_pk_fma_f32 v[4:5], v[4:5], v[172:173], v[172:173] op_sel:[0,0,1] op_sel_hi:[1,0,1] neg_lo:[0,0,1] neg_hi:[0,0,1]
v_pk_fma_f32 v[6:7], v[6:7], v[172:173], v[172:173] op_sel:[0,0,1] op_sel_hi:[1,0,1] neg_lo:[0,0,1] neg_hi:[0,0,1]
v_pk_fma_f32 v[8:9], v[8:9], v[172:173], v[172:173] op_sel:[0,0,1] op_sel_hi:[1,0,1] neg_lo:[0,0,1] neg_hi:[0,0,1]
v_pk_fma_f32 v[10:11], v[10:11], v[172:173], v[172:173] op_sel:[0,0,1] op_sel_hi:[1,0,1] neg_lo:[0,0,1] neg_hi:[0,0,1]
v_pk_fma_f32 v[12:13], v[12:13], v[172:173], v[172:173] op_sel:[0,0,1] op_sel_hi:[1,0,1] neg_lo:[0,0,1] neg_hi:[0,0,1]
v_pk_fma_f32 v[14:15], v[14:15], v[172:173], v[172:173] op_sel:[0,0,1] op_sel_hi:[1,0,1] neg_lo:[0,0,1] neg_hi:[0,0,1]
v_pk_fma_f32 v[16:17], v[16:17], v[172:173], v[172:173] op_sel:[0,0,1] op_sel_hi:[1,0,1] neg_lo:[0,0,1] neg_hi:[0,0,1]
v_pk_fma_f32 v[18:19], v[18:19], v[172:173], v[172:173] op_sel:[0,0,1] op_sel_hi:[1,0,1] neg_lo:[0,0,1] neg_hi:[0,0,1]
v_pk_fma_f32 v[20:21], v[20:21], v[172:173], v[172:173] op_sel:[0,0,1] op_sel_hi:[1,0,1] neg_lo:[0,0,1] neg_hi:[0,0,1]
v_pk_fma_f32 v[22:23], v[22:23], v[172:173], v[172:173] op_sel:[0,0,1] op_sel_hi:[1,0,1] neg_lo:[0,0,1] neg_hi:[0,0,1]
v_pk_fma_f32 v[24:25], v[24:25], v[172:173], v[172:173] op_sel:[0,0,1] op_sel_hi:[1,0,1] neg_lo:[0,0,1] neg_hi:[0,0,1]
v_pk_fma_f32 v[26:27], v[26:27], v[172:173], v[172:173] op_sel:[0,0,1] op_sel_hi:[1,0,1] neg_lo:[0,0,1] neg_hi:[0,0,1]
v_pk_fma_f32 v[28:29], v[28:29], v[172:173], v[172:173] op_sel:[0,0,1] op_sel_hi:[1,0,1] neg_lo:[0,0,1] neg_hi:[0,0,1]
v_pk_fma_f32 v[30:31], v[30:31], v[172:173], v[172:173] op_sel:[0,0,1] op_sel_hi:[1,0,1] neg_lo:[0,0,1] neg_hi:[0,0,1]
v_pk_fma_f32 v[32:33], v[32:33], v[172:173], v[172:173] op_sel:[0,0,1] op_sel_hi:[1,0,1] neg_lo:[0,0,1] neg_hi:[0,0,1]
v_pk_fma_f32 v[34:35], v[34:35], v[172:173], v[172:173] op_sel:[0,0,1] op_sel_hi:[1,0,1] neg_lo:[0,0,1] neg_hi:[0,0,1]
v_pk_fma_f32 v[36:37], v[36:37], v[172:173], v[172:173] op_sel:[0,0,1] op_sel_hi:[1,0,1] neg_lo:[0,0,1] neg_hi:[0,0,1]
v_pk_fma_f32 v[38:39], v[38:39], v[172:173], v[172:173] op_sel:[0,0,1] op_sel_hi:[1,0,1] neg_lo:[0,0,1] neg_hi:[0,0,1]
v_pk_fma_f32 v[40:41], v[40:41], v[172:173], v[172:173] op_sel:[0,0,1] op_sel_hi:[1,0,1] neg_lo:[0,0,1] neg_hi:[0,0,1]
v_pk_fma_f32 v[42:43], v[42:43], v[172:173], v[172:173] op_sel:[0,0,1] op_sel_hi:[1,0,1] neg_lo:[0,0,1] neg_hi:[0,0,1]
v_pk_fma_f32 v[44:45], v[44:45], v[172:173], v[172:173] op_sel:[0,0,1] op_sel_hi:[1,0,1] neg_lo:[0,0,1] neg_hi:[0,0,1]
v_pk_fma_f32 v[46:47], v[46:47], v[172:173], v[172:173] op_sel:[0,0,1] op_sel_hi:[1,0,1] neg_lo:[0,0,1] neg_hi:[0,0,1]
s_setprio 2
ds_read_u16_d16 v186, v186
ds_read_u16_d16_hi v187, v187
ds_read_u16_d16 v188, v188
ds_read_u16_d16_hi v189, v189
s_waitcnt lgkmcnt(4)
v_readfirstlane_b32 s43, v247
s_nop 1
s_cmp_ge_u32 s43, 24
s_cbranch_scc1 Lev7
Lev7w:
s_sleep 1
ds_read_b32 v247, v253 offset:16
s_waitcnt lgkmcnt(0)
v_readfirstlane_b32 s43, v247
s_cmp_eq_u32 s76, 0
s_cbranch_scc1 Lev7
s_sub_u32 s76, s76, 1
s_cmp_lt_u32 s43, 24
s_cbranch_scc1 Lev7w
Lev7:
s_setprio 1
v_cvt_pkrtz_f16_f32 v137, v120, v121
v_cvt_pkrtz_f16_f32 v139, v122, v123
v_cvt_pkrtz_f16_f32 v141, v124, v125
v_cvt_pkrtz_f16_f32 v143, v126, v127
v_cvt_pkrtz_f16_f32 v177, v128, v129
v_cvt_pkrtz_f16_f32 v191, v130, v131
v_cvt_pk_f16_f32 v155, v132, v133
v_cvt_pk_f16_f32 v152, v134, v135
s_add_u32 m0, s67, 39936
s_add_u32 s66, s66, 98304
buffer_load_dwordx4 v240, s[4:7], s66 offen lds
ds_read_b128 v[228:231], v249 offset:23552
v_mfma_f32_32x32x16_bf16 v[120:135], v[72:75], v[232:235], 0
v_pk_fma_f16 v154, v155, v155, s48
v_cvt_pk_bf16_f32 v96, v0, v1
v_and_b32 v137, s49, v137
v_fma_mix_f32 v165, v178, v178, v165 op_sel:[0,0,0] op_sel_hi:[1,1,0]
v_cvt_pk_bf16_f32 v97, v2, v3
v_pk_fma_f16 v151, v152, v152, s48
v_lshrrev_b16 v136, 2, v137
v_cvt_pk_bf16_f32 v98, v4, v5
v_pk_mul_f16 v154, v155, v154
v_fma_mix_f32 v165, v179, v179, v165 op_sel:[1,1,0] op_sel_hi:[1,1,0]
v_lshrrev_b32 v137, 18, v137
v_cvt_pk_bf16_f32 v99, v6, v7
s_add_u32 m0, s67, 46592
s_add_u32 s66, s66, 98304
buffer_load_dwordx4 v240, s[4:7], s66 offen lds
ds_read_b128 v[232:235], v248 offset:16384
ds_read_u16_d16 v136, v136
ds_read_u16_d16_hi v137, v137
v_mfma_f32_32x32x16_bf16 v[120:135], v[76:79], v[236:239], v[120:135]
v_pk_mul_f16 v151, v152, v151
v_exp_f16 v153, v154
v_cvt_pk_bf16_f32 v100, v8, v9
v_and_b32 v139, s49, v139
v_fma_mix_f32 v165, v180, v180, v165 op_sel:[0,0,0] op_sel_hi:[1,1,0]
v_cvt_pk_bf16_f32 v101, v10, v11
v_lshrrev_b16 v138, 2, v139
v_exp_f16 v150, v151
v_cvt_pk_bf16_f32 v102, v12, v13
v_lshrrev_b32 v139, 18, v139
v_cvt_pk_bf16_f32 v103, v14, v15
s_add_u32 m0, s67, 53248
s_add_u32 s66, s66, 98304
buffer_load_dwordx4 v240, s[4:7], s66 offen lds
ds_read_b128 v[236:239], v248 offset:19456
ds_read_u16_d16 v138, v138
ds_read_u16_d16_hi v139, v139
v_mfma_f32_32x32x16_bf16 v[120:135], v[80:83], v[216:219], v[120:135]
v_fma_mix_f32 v165, v181, v181, v165 op_sel:[1,1,0] op_sel_hi:[1,1,0]
v_exp_f16_sdwa v153, v154 dst_sel:WORD_1 dst_unused:UNUSED_PRESERVE src0_sel:WORD_1
v_cvt_pk_bf16_f32 v104, v16, v17
v_and_b32 v141, s49, v141
v_fma_mix_f32 v165, v182, v182, v165 op_sel:[0,0,0] op_sel_hi:[1,1,0]
v_cvt_pk_bf16_f32 v105, v18, v19
v_lshrrev_b16 v140, 2, v141
v_exp_f16_sdwa v150, v151 dst_sel:WORD_1 dst_unused:UNUSED_PRESERVE src0_sel:WORD_1
v_cvt_pk_bf16_f32 v106, v20, v21
v_lshrrev_b32 v141, 18, v141
s_add_u32 m0, s67, 59904
s_add_u32 s66, s66, 98304
buffer_load_dwordx4 v240, s[4:7], s66 offen lds
s_add_u32 m0, s67, 0
s_add_u32 s66, s66, 98304
buffer_load_dwordx4 v240, s[4:7], s66 offen lds
ds_read_b128 v[216:219], v248 offset:17408
ds_read_u16_d16 v140, v140
ds_read_u16_d16_hi v141, v141
v_mfma_f32_32x32x16_bf16 v[120:135], v[84:87], v[220:223], v[120:135]
v_fma_mix_f32 v165, v183, v183, v165 op_sel:[1,1,0] op_sel_hi:[1,1,0]
v_cvt_pk_bf16_f32 v107, v22, v23
v_pk_add_f16 v153, v153, 1.0 op_sel_hi:[1,0]
v_pk_add_f16 v150, v150, 1.0 op_sel_hi:[1,0]
v_and_b32 v143, s49, v143
v_cvt_pk_bf16_f32 v108, v24, v25
v_rcp_f16 v154, v153
v_cvt_pk_bf16_f32 v109, v26, v27
v_lshrrev_b16 v142, 2, v143
v_fma_mix_f32 v165, v184, v184, v165 op_sel:[0,0,0] op_sel_hi:[1,1,0]
v_cvt_pk_bf16_f32 v110, v28, v29
s_add_u32 m0, s67, 6656
s_add_u32 s66, s66, 98304
buffer_load_dwordx4 v240, s[4:7], s66 offen lds
ds_read_b128 v[220:223], v248 offset:20480
ds_read_u16_d16 v142, v142
v_mfma_f32_32x32x16_bf16 v[120:135], v[88:91], v[224:227], v[120:135]
v_rcp_f16 v151, v150
v_lshrrev_b32 v143, 18, v143
v_cvt_pk_bf16_f32 v111, v30, v31
v_fma_mix_f32 v165, v185, v185, v165 op_sel:[1,1,0] op_sel_hi:[1,1,0]
v_and_b32 v177, s49, v177
s_setprio 0
v_cvt_pk_bf16_f32 v112, v32, v33
v_rcp_f16_sdwa v154, v153 dst_sel:WORD_1 dst_unused:UNUSED_PRESERVE src0_sel:WORD_1
v_lshrrev_b16 v176, 2, v177
v_cvt_pk_bf16_f32 v113, v34, v35
s_waitcnt lgkmcnt(2)
v_fma_mix_f32 v165, v186, v186, v165 op_sel:[0,0,0] op_sel_hi:[1,1,0]
v_rcp_f16_sdwa v151, v150 dst_sel:WORD_1 dst_unused:UNUSED_PRESERVE src0_sel:WORD_1
s_add_u32 m0, s67, 13312
s_add_u32 s66, s66, 98304
buffer_load_dwordx4 v240, s[4:7], s66 offen lds
ds_read_b128 v[224:227], v248 offset:18432
ds_read_u16_d16_hi v143, v143
ds_read_u16_d16 v176, v176
v_mfma_f32_32x32x16_bf16 v[120:135], v[92:95], v[228:231], v[120:135]
v_cvt_pk_bf16_f32 v114, v36, v37
v_lshrrev_b32 v177, 18, v177
v_cvt_pk_bf16_f32 v115, v38, v39
v_fma_mix_f32 v165, v187, v187, v165 op_sel:[1,1,0] op_sel_hi:[1,1,0]
v_and_b32 v191, s49, v191
v_pk_mul_f16 v155, v155, v154
v_cvt_pk_bf16_f32 v116, v40, v41
v_pk_mul_f16 v152, v152, v151
v_lshrrev_b16 v190, 2, v191
v_cvt_pk_bf16_f32 v117, v42, v43
v_fma_mix_f32 v165, v188, v188, v165 op_sel:[0,0,0] op_sel_hi:[1,1,0]
v_fma_mix_f32 v166, v155, v155, v166 op_sel:[0,0,0] op_sel_hi:[1,1,0]
s_add_u32 m0, s67, 19968
s_add_u32 s66, s66, 98304
buffer_load_dwordx4 v240, s[4:7], s66 offen lds
v_lshrrev_b32 v191, 18, v191
v_cvt_pk_bf16_f32 v118, v44, v45
v_fma_mix_f32 v166, v155, v155, v166 op_sel:[1,1,0] op_sel_hi:[1,1,0]
v_fma_mix_f32 v165, v189, v189, v165 op_sel:[1,1,0] op_sel_hi:[1,1,0]
v_cvt_pk_bf16_f32 v119, v46, v47
v_fma_mix_f32 v166, v152, v152, v166 op_sel:[0,0,0] op_sel_hi:[1,1,0]
v_fma_mix_f32 v166, v152, v152, v166 op_sel:[1,1,0] op_sel_hi:[1,1,0]
s_setprio 2
v_cvt_pkrtz_f16_f32 v179, v120, v121
v_cvt_pkrtz_f16_f32 v181, v122, v123
v_cvt_pkrtz_f16_f32 v183, v124, v125
v_cvt_pkrtz_f16_f32 v185, v126, v127
v_cvt_pkrtz_f16_f32 v187, v128, v129
v_cvt_pk_f16_f32 v155, v130, v131
v_cvt_pk_f16_f32 v152, v132, v133
v_cvt_pk_f16_f32 v149, v134, v135
ds_read_b128 v[228:231], v248 offset:21504
ds_read_u16_d16_hi v177, v177
ds_read_u16_d16 v190, v190
ds_read_u16_d16_hi v191, v191
v_mfma_f32_32x32x16_bf16 v[120:135], v[96:99], v[232:235], 0
v_pk_fma_f16 v154, v155, v155, s48
v_and_b32 v179, s49, v179
v_fma_mix_f32 v166, v136, v136, v166 op_sel:[0,0,0] op_sel_hi:[1,1,0]
v_pk_fma_f16 v151, v152, v152, s48
v_pk_fma_f16 v148, v149, v149, s48
v_lshrrev_b16 v178, 2, v179
v_pk_mul_f16 v154, v155, v154
v_fma_mix_f32 v166, v137, v137, v166 op_sel:[1,1,0] op_sel_hi:[1,1,0]
v_pk_mul_f16 v151, v152, v151
v_lshrrev_b32 v179, 18, v179
ds_read_b128 v[232:235], v248 offset:22528
ds_read_u16_d16 v178, v178
ds_read_u16_d16_hi v179, v179
v_mfma_f32_32x32x16_bf16 v[120:135], v[100:103], v[236:239], v[120:135]
v_pk_mul_f16 v148, v149, v148
v_exp_f16 v153, v154
v_fma_mix_f32 v166, v138, v138, v166 op_sel:[0,0,0] op_sel_hi:[1,1,0]
v_and_b32 v181, s49, v181
v_exp_f16 v150, v151
v_exp_f16 v147, v148
v_lshrrev_b16 v180, 2, v181
v_fma_mix_f32 v166, v139, v139, v166 op_sel:[1,1,0] op_sel_hi:[1,1,0]
ds_read_b128 v[236:239], v248 offset:25600
ds_read_u16_d16 v180, v180
v_mfma_f32_32x32x16_bf16 v[120:135], v[104:107], v[216:219], v[120:135]
v_exp_f16_sdwa v153, v154 dst_sel:WORD_1 dst_unused:UNUSED_PRESERVE src0_sel:WORD_1
v_lshrrev_b32 v181, 18, v181
v_exp_f16_sdwa v150, v151 dst_sel:WORD_1 dst_unused:UNUSED_PRESERVE src0_sel:WORD_1
v_fma_mix_f32 v166, v140, v140, v166 op_sel:[0,0,0] op_sel_hi:[1,1,0]
v_and_b32 v183, s49, v183
v_exp_f16_sdwa v147, v148 dst_sel:WORD_1 dst_unused:UNUSED_PRESERVE src0_sel:WORD_1
v_fma_mix_f32 v166, v141, v141, v166 op_sel:[1,1,0] op_sel_hi:[1,1,0]
s_waitcnt lgkmcnt(5)
ds_read_b128 v[216:219], v248 offset:23552
ds_read_u16_d16_hi v181, v181
v_mfma_f32_32x32x16_bf16 v[120:135], v[108:111], v[220:223], v[120:135]
v_pk_add_f16 v153, v153, 1.0 op_sel_hi:[1,0]
v_lshrrev_b16 v182, 2, v183
v_pk_add_f16 v150, v150, 1.0 op_sel_hi:[1,0]
v_pk_add_f16 v147, v147, 1.0 op_sel_hi:[1,0]
v_rcp_f16 v154, v153
v_lshrrev_b32 v183, 18, v183
v_fma_mix_f32 v166, v142, v142, v166 op_sel:[0,0,0] op_sel_hi:[1,1,0]
v_rcp_f16 v151, v150
v_and_b32 v185, s49, v185
ds_read_b128 v[220:223], v248 offset:26624
ds_read_u16_d16 v182, v182
ds_read_u16_d16_hi v183, v183
v_mfma_f32_32x32x16_bf16 v[120:135], v[112:115], v[224:227], v[120:135]
v_fma_mix_f32 v166, v143, v143, v166 op_sel:[1,1,0] op_sel_hi:[1,1,0]
v_rcp_f16 v148, v147
v_lshrrev_b16 v184, 2, v185
v_rcp_f16_sdwa v154, v153 dst_sel:WORD_1 dst_unused:UNUSED_PRESERVE src0_sel:WORD_1
v_fma_mix_f32 v166, v176, v176, v166 op_sel:[0,0,0] op_sel_hi:[1,1,0]
v_rcp_f16_sdwa v151, v150 dst_sel:WORD_1 dst_unused:UNUSED_PRESERVE src0_sel:WORD_1
v_lshrrev_b32 v185, 18, v185
ds_read_b128 v[224:227], v248 offset:24576
ds_read_u16_d16 v184, v184
ds_read_u16_d16_hi v185, v185
v_mfma_f32_32x32x16_bf16 v[120:135], v[116:119], v[228:231], v[120:135]
v_rcp_f16_sdwa v148, v147 dst_sel:WORD_1 dst_unused:UNUSED_PRESERVE src0_sel:WORD_1
s_cmp_eq_u32 s40, 7
s_cbranch_scc1 Lrdy24
s_waitcnt vmcnt(0)
Lrdy24:
s_mov_b64 exec, 1
ds_add_u32 v253, v254 offset:12
s_mov_b64 exec, -1
v_and_b32 v187, s49, v187
v_fma_mix_f32 v166, v177, v177, v166 op_sel:[1,1,0] op_sel_hi:[1,1,0]
v_pk_mul_f16 v155, v155, v154
v_pk_mul_f16 v152, v152, v151
v_pk_mul_f16 v149, v149, v148
v_lshrrev_b16 v186, 2, v187
v_fma_mix_f32 v166, v190, v190, v166 op_sel:[0,0,0] op_sel_hi:[1,1,0]
v_fma_mix_f32 v167, v155, v155, v167 op_sel:[0,0,0] op_sel_hi:[1,1,0]
v_fma_mix_f32 v167, v155, v155, v167 op_sel:[1,1,0] op_sel_hi:[1,1,0]
v_lshrrev_b32 v187, 18, v187
v_fma_mix_f32 v167, v152, v152, v167 op_sel:[0,0,0] op_sel_hi:[1,1,0]
v_fma_mix_f32 v166, v191, v191, v166 op_sel:[1,1,0] op_sel_hi:[1,1,0]
v_fma_mix_f32 v167, v152, v152, v167 op_sel:[1,1,0] op_sel_hi:[1,1,0]
v_fma_mix_f32 v167, v149, v149, v167 op_sel:[0,0,0] op_sel_hi:[1,1,0]
v_fma_mix_f32 v167, v149, v149, v167 op_sel:[1,1,0] op_sel_hi:[1,1,0]
s_cmp_lg_u32 s40, 7
s_cbranch_scc1 Lnoinit
s_waitcnt vmcnt(11)
v_mov_b32 v255, 1
s_mov_b64 exec, 1
buffer_atomic_add v255, v241, s[36:39], 0 offen
s_mov_b64 exec, -1
Lnoinit:
s_setprio 1
v_cvt_pkrtz_f16_f32 v137, v120, v121
v_cvt_pkrtz_f16_f32 v139, v122, v123
v_cvt_pkrtz_f16_f32 v141, v124, v125
v_cvt_pkrtz_f16_f32 v143, v126, v127
v_cvt_pkrtz_f16_f32 v177, v128, v129
v_cvt_pk_f16_f32 v155, v130, v131
v_cvt_pk_f16_f32 v152, v132, v133
v_cvt_pk_f16_f32 v149, v134, v135
s_waitcnt lgkmcnt(1)
s_add_u32 s46, s80, 12582912
buffer_store_dwordx4 v[72:75], v241, s[32:35], s46 offen sc1
ds_read_b128 v[228:231], v248 offset:27648
ds_read_u16_d16 v186, v186
ds_read_u16_d16_hi v187, v187
v_mfma_f32_32x32x16_bf16 v[120:135], v[96:99], v[232:235], 0
v_pk_fma_f16 v154, v155, v155, s48
v_and_b32 v137, s49, v137
v_fma_mix_f32 v167, v178, v178, v167 op_sel:[0,0,0] op_sel_hi:[1,1,0]
v_pk_fma_f16 v151, v152, v152, s48
v_pk_fma_f16 v148, v149, v149, s48
v_lshrrev_b16 v136, 2, v137
v_pk_mul_f16 v154, v155, v154
v_pk_mul_f16 v151, v152, v151
v_fma_mix_f32 v167, v179, v179, v167 op_sel:[1,1,0] op_sel_hi:[1,1,0]
v_lshrrev_b32 v137, 18, v137
ds_read_b128 v[232:235], v250 offset:65520
ds_read_u16_d16 v136, v136
ds_read_u16_d16_hi v137, v137
v_mfma_f32_32x32x16_bf16 v[120:135], v[100:103], v[236:239], v[120:135]
v_pk_mul_f16 v148, v149, v148
v_exp_f16 v153, v154
v_exp_f16 v150, v151
v_and_b32 v139, s49, v139
v_fma_mix_f32 v167, v180, v180, v167 op_sel:[0,0,0] op_sel_hi:[1,1,0]
v_exp_f16 v147, v148
v_lshrrev_b16 v138, 2, v139
ds_read_b128 v[236:239], v248 offset:28672
ds_read_b32 v247, v253 offset:12
ds_read_u16_d16 v138, v138
v_mfma_f32_32x32x16_bf16 v[120:135], v[104:107], v[216:219], v[120:135]
v_exp_f16_sdwa v153, v154 dst_sel:WORD_1 dst_unused:UNUSED_PRESERVE src0_sel:WORD_1
v_lshrrev_b32 v139, 18, v139
v_fma_mix_f32 v167, v181, v181, v167 op_sel:[1,1,0] op_sel_hi:[1,1,0]
v_exp_f16_sdwa v150, v151 dst_sel:WORD_1 dst_unused:UNUSED_PRESERVE src0_sel:WORD_1
v_exp_f16_sdwa v147, v148 dst_sel:WORD_1 dst_unused:UNUSED_PRESERVE src0_sel:WORD_1
v_and_b32 v141, s49, v141
v_fma_mix_f32 v167, v182, v182, v167 op_sel:[0,0,0] op_sel_hi:[1,1,0]
ds_read_b128 v[216:219], v248 offset:31744
ds_read_u16_d16_hi v139, v139
v_mfma_f32_32x32x16_bf16 v[120:135], v[108:111], v[220:223], v[120:135]
v_pk_add_f16 v153, v153, 1.0 op_sel_hi:[1,0]
v_lshrrev_b16 v140, 2, v141
v_pk_add_f16 v150, v150, 1.0 op_sel_hi:[1,0]
v_pk_add_f16 v147, v147, 1.0 op_sel_hi:[1,0]
v_rcp_f16 v154, v153
v_lshrrev_b32 v141, 18, v141
v_fma_mix_f32 v167, v183, v183, v167 op_sel:[1,1,0] op_sel_hi:[1,1,0]
ds_read_u16_d16 v140, v140
ds_read_u16_d16_hi v141, v141
s_waitcnt lgkmcnt(5)
v_readfirstlane_b32 s43, v247
s_nop 1
s_cmp_ge_u32 s43, 32
s_cbranch_scc1 Lev8
Lev8w:
s_sleep 1
ds_read_b32 v247, v253 offset:12
s_waitcnt lgkmcnt(0)
v_readfirstlane_b32 s43, v247
s_cmp_eq_u32 s76, 0
s_cbranch_scc1 Lev8
s_sub_u32 s76, s76, 1
s_cmp_lt_u32 s43, 32
s_cbranch_scc1 Lev8w
Lev8:
v_rcp_f16 v151, v150
ds_read_b128 v[220:223], v248 offset:29696
v_mfma_f32_32x32x16_bf16 v[120:135], v[112:115], v[224:227], v[120:135]
v_and_b32 v143, s49, v143
v_rcp_f16 v148, v147
v_fma_mix_f32 v167, v184, v184, v167 op_sel:[0,0,0] op_sel_hi:[1,1,0]
v_lshrrev_b16 v142, 2, v143
s_setprio 0
v_rcp_f16_sdwa v154, v153 dst_sel:WORD_1 dst_unused:UNUSED_PRESERVE src0_sel:WORD_1
v_rcp_f16_sdwa v151, v150 dst_sel:WORD_1 dst_unused:UNUSED_PRESERVE src0_sel:WORD_1
v_lshrrev_b32 v143, 18, v143
ds_read_b128 v[224:227], v245 offset:6528
ds_read_b128 v[192:195], v244 offset:128
ds_read_b128 v[196:199], v244 offset:64
ds_read_u16_d16 v142, v142
ds_read_u16_d16_hi v143, v143
v_mfma_f32_32x32x16_bf16 v[120:135], v[116:119], v[228:231], v[120:135]
v_fma_mix_f32 v167, v185, v185, v167 op_sel:[1,1,0] op_sel_hi:[1,1,0]
v_rcp_f16_sdwa v148, v147 dst_sel:WORD_1 dst_unused:UNUSED_PRESERVE src0_sel:WORD_1
v_and_b32 v177, s49, v177
v_pk_mul_f16 v155, v155, v154
v_fma_mix_f32 v167, v186, v186, v167 op_sel:[0,0,0] op_sel_hi:[1,1,0]
v_pk_mul_f16 v152, v152, v151
v_lshrrev_b16 v176, 2, v177
v_pk_mul_f16 v149, v149, v148
v_fma_mix_f32 v156, v155, v155, v156 op_sel:[0,0,0] op_sel_hi:[1,1,0]
v_fma_mix_f32 v156, v155, v155, v156 op_sel:[1,1,0] op_sel_hi:[1,1,0]
v_lshrrev_b32 v177, 18, v177
v_fma_mix_f32 v167, v187, v187, v167 op_sel:[1,1,0] op_sel_hi:[1,1,0]
v_fma_mix_f32 v156, v152, v152, v156 op_sel:[0,0,0] op_sel_hi:[1,1,0]
v_fma_mix_f32 v156, v152, v152, v156 op_sel:[1,1,0] op_sel_hi:[1,1,0]
v_fma_mix_f32 v156, v149, v149, v156 op_sel:[0,0,0] op_sel_hi:[1,1,0]
v_fma_mix_f32 v156, v149, v149, v156 op_sel:[1,1,0] op_sel_hi:[1,1,0]
s_setprio 2
v_mfma_f32_32x32x16_bf16 v[0:15], v[232:235], v[232:235], 0
s_add_u32 s46, s80, 14680064
buffer_store_dwordx4 v[76:79], v241, s[32:35], s46 offen sc1
ds_read_b128 v[228:231], v248 offset:32768
ds_read_u16_d16 v176, v176
ds_read_u16_d16_hi v177, v177
v_cvt_pkrtz_f16_f32 v179, v120, v121
v_cvt_pkrtz_f16_f32 v181, v122, v123
v_cvt_pkrtz_f16_f32 v183, v124, v125
v_mfma_f32_32x32x16_bf16 v[16:31], v[232:235], v[232:235], 0
v_cvt_pkrtz_f16_f32 v185, v126, v127
v_cvt_pkrtz_f16_f32 v187, v128, v129
v_cvt_pk_f16_f32 v155, v130, v131
v_cvt_pk_f16_f32 v152, v132, v133
v_mfma_f32_32x32x16_bf16 v[32:47], v[232:235], v[232:235], 0
v_cvt_pk_f16_f32 v149, v134, v135
v_pk_fma_f16 v154, v155, v155, s48
v_and_b32 v179, s49, v179
v_mfma_f32_32x32x16_bf16 v[120:135], v[96:99], v[236:239], 0
ds_read_b128 v[232:235], v248 offset:30720
v_fma_mix_f32 v156, v136, v136, v156 op_sel:[0,0,0] op_sel_hi:[1,1,0]
v_pk_fma_f16 v151, v152, v152, s48
v_pk_fma_f16 v148, v149, v149, s48
v_lshrrev_b16 v178, 2, v179
v_pk_mul_f16 v154, v155, v154
v_pk_mul_f16 v151, v152, v151
v_fma_mix_f32 v156, v137, v137, v156 op_sel:[1,1,0] op_sel_hi:[1,1,0]
s_waitcnt lgkmcnt(4)
v_mfma_f32_32x32x16_bf16 v[120:135], v[100:103], v[216:219], v[120:135]
ds_read_b128 v[236:239], v245 offset:6144
ds_read_b128 v[200:203], v244
ds_read_b128 v[204:207], v243 offset:128
ds_read_u16_d16 v178, v178
v_lshrrev_b32 v179, 18, v179
v_pk_mul_f16 v148, v149, v148
v_exp_f16 v153, v154
v_exp_f16 v150, v151
v_and_b32 v181, s49, v181
v_fma_mix_f32 v156, v138, v138, v156 op_sel:[0,0,0] op_sel_hi:[1,1,0]
v_mfma_f32_32x32x16_bf16 v[120:135], v[104:107], v[220:223], v[120:135]
ds_read_b128 v[216:219], v248 offset:33792
ds_read_u16_d16_hi v179, v179
v_exp_f16 v147, v148
v_lshrrev_b16 v180, 2, v181
v_exp_f16_sdwa v153, v154 dst_sel:WORD_1 dst_unused:UNUSED_PRESERVE src0_sel:WORD_1
v_lshrrev_b32 v181, 18, v181
v_fma_mix_f32 v156, v139, v139, v156 op_sel:[1,1,0] op_sel_hi:[1,1,0]
v_smfmac_f32_16x16x32_bf16 v[40:43], v[226:227], v[192:195], v246
ds_read_b128 v[220:223], v245 offset:5760
ds_read_b128 v[208:211], v243 offset:64
ds_read_b128 v[212:215], v243
ds_read_u16_d16 v180, v180
ds_read_u16_d16_hi v181, v181
v_exp_f16_sdwa v150, v151 dst_sel:WORD_1 dst_unused:UNUSED_PRESERVE src0_sel:WORD_1
v_smfmac_f32_16x16x32_bf16 v[24:27], v[224:225], v[196:199], v246
v_exp_f16_sdwa v147, v148 dst_sel:WORD_1 dst_unused:UNUSED_PRESERVE src0_sel:WORD_1
v_and_b32 v183, s49, v183
v_fma_mix_f32 v156, v140, v140, v156 op_sel:[0,0,0] op_sel_hi:[1,1,0]
v_pk_add_f16 v153, v153, 1.0 op_sel_hi:[1,0]
s_waitcnt lgkmcnt(7)
v_mfma_f32_32x32x16_bf16 v[120:135], v[108:111], v[228:231], v[120:135]
ds_read_b128 v[224:227], v245 offset:5376
ds_read_b128 v[192:195], v242 offset:128
ds_read_b128 v[196:199], v242 offset:64
v_lshrrev_b16 v182, 2, v183
v_pk_add_f16 v150, v150, 1.0 op_sel_hi:[1,0]
v_pk_add_f16 v147, v147, 1.0 op_sel_hi:[1,0]
v_rcp_f16 v154, v153
v_lshrrev_b32 v183, 18, v183
v_fma_mix_f32 v156, v141, v141, v156 op_sel:[1,1,0] op_sel_hi:[1,1,0]
v_mfma_f32_32x32x16_bf16 v[120:135], v[112:115], v[232:235], v[120:135]
ds_read_b128 v[228:231], v248 offset:34816
ds_read_u16_d16 v182, v182
ds_read_u16_d16_hi v183, v183
v_rcp_f16 v151, v150
v_and_b32 v185, s49, v185
v_rcp_f16 v148, v147
v_fma_mix_f32 v156, v142, v142, v156 op_sel:[0,0,0] op_sel_hi:[1,1,0]
v_lshrrev_b16 v184, 2, v185
v_smfmac_f32_16x16x32_bf16 v[8:11], v[238:239], v[200:203], v246
ds_read_b128 v[232:235], v248 offset:37888
ds_read_u16_d16 v184, v184
v_rcp_f16_sdwa v154, v153 dst_sel:WORD_1 dst_unused:UNUSED_PRESERVE src0_sel:WORD_1
v_rcp_f16_sdwa v151, v150 dst_sel:WORD_1 dst_unused:UNUSED_PRESERVE src0_sel:WORD_1
v_smfmac_f32_16x16x32_bf16 v[40:43], v[236:237], v[204:207], v246
v_lshrrev_b32 v185, 18, v185
v_fma_mix_f32 v156, v143, v143, v156 op_sel:[1,1,0] op_sel_hi:[1,1,0]
s_waitcnt lgkmcnt(6)
v_mfma_f32_32x32x16_bf16 v[120:135], v[116:119], v[216:219], v[120:135]
ds_read_b128 v[236:239], v248 offset:35840
ds_read_u16_d16_hi v185, v185
v_rcp_f16_sdwa v148, v147 dst_sel:WORD_1 dst_unused:UNUSED_PRESERVE src0_sel:WORD_1
v_and_b32 v187, s49, v187
v_pk_mul_f16 v155, v155, v154
v_fma_mix_f32 v156, v176, v176, v156 op_sel:[0,0,0] op_sel_hi:[1,1,0]
v_pk_mul_f16 v152, v152, v151
v_lshrrev_b16 v186, 2, v187
v_pk_mul_f16 v149, v149, v148
v_smfmac_f32_16x16x32_bf16 v[24:27], v[222:223], v[208:211], v246
ds_read_b128 v[216:219], v248 offset:38912
ds_read_u16_d16 v186, v186
v_fma_mix_f32 v157, v155, v155, v157 op_sel:[0,0,0] op_sel_hi:[1,1,0]
v_fma_mix_f32 v157, v155, v155, v157 op_sel:[1,1,0] op_sel_hi:[1,1,0]
v_lshrrev_b32 v187, 18, v187
v_fma_mix_f32 v156, v177, v177, v156 op_sel:[1,1,0] op_sel_hi:[1,1,0]
v_smfmac_f32_16x16x32_bf16 v[8:11], v[220:221], v[212:215], v246
v_fma_mix_f32 v157, v152, v152, v157 op_sel:[0,0,0] op_sel_hi:[1,1,0]
v_fma_mix_f32 v157, v152, v152, v157 op_sel:[1,1,0] op_sel_hi:[1,1,0]
v_fma_mix_f32 v157, v149, v149, v157 op_sel:[0,0,0] op_sel_hi:[1,1,0]
v_fma_mix_f32 v157, v149, v149, v157 op_sel:[1,1,0] op_sel_hi:[1,1,0]
s_setprio 1
v_smfmac_f32_16x16x32_bf16 v[40:43], v[226:227], v[192:195], v246
s_waitcnt lgkmcnt(4)
s_add_u32 s46, s80, 16777216
buffer_store_dwordx4 v[80:83], v241, s[32:35], s46 offen sc1
ds_read_b128 v[220:223], v248 offset:36864
ds_read_u16_d16_hi v187, v187
v_cvt_pkrtz_f16_f32 v137, v120, v121
v_cvt_pkrtz_f16_f32 v139, v122, v123
v_cvt_pkrtz_f16_f32 v141, v124, v125
v_cvt_pkrtz_f16_f32 v143, v126, v127
v_cvt_pk_f16_f32 v155, v128, v129
v_smfmac_f32_16x16x32_bf16 v[24:27], v[224:225], v[196:199], v246
v_cvt_pk_f16_f32 v152, v130, v131
v_cvt_pk_f16_f32 v149, v132, v133
v_cvt_pk_f16_f32 v146, v134, v135
v_pk_fma_f16 v154, v155, v155, s48
v_and_b32 v137, s49, v137
v_mfma_f32_32x32x16_bf16 v[120:135], v[96:99], v[228:231], 0
ds_read_b128 v[224:227], v248 offset:39936
v_fma_mix_f32 v157, v178, v178, v157 op_sel:[0,0,0] op_sel_hi:[1,1,0]
v_pk_fma_f16 v151, v152, v152, s48
v_pk_fma_f16 v148, v149, v149, s48
v_pk_fma_f16 v145, v146, v146, s48
v_pk_mul_f16 v154, v155, v154
v_lshrrev_b16 v136, 2, v137
v_pk_mul_f16 v151, v152, v151
v_fma_mix_f32 v157, v179, v179, v157 op_sel:[1,1,0] op_sel_hi:[1,1,0]
v_pk_mul_f16 v148, v149, v148
v_pk_mul_f16 v145, v146, v145
v_mfma_f32_32x32x16_bf16 v[120:135], v[100:103], v[232:235], v[120:135]
ds_read_b128 v[228:231], v245 offset:4992
ds_read_b128 v[200:203], v242
v_xor_b32 v244, 16, v244
ds_read_b128 v[204:207], v244 offset:128
ds_read_u16_d16 v136, v136
v_exp_f16 v153, v154
v_lshrrev_b32 v137, 18, v137
v_exp_f16 v150, v151
v_fma_mix_f32 v157, v180, v180, v157 op_sel:[0,0,0] op_sel_hi:[1,1,0]
v_exp_f16 v147, v148
v_and_b32 v139, s49, v139
v_exp_f16 v144, v145
s_waitcnt lgkmcnt(5)
v_mfma_f32_32x32x16_bf16 v[120:135], v[104:107], v[236:239], v[120:135]
ds_read_b128 v[232:235], v245 offset:4608
ds_read_b128 v[208:211], v244 offset:64
ds_read_b128 v[212:215], v244
ds_read_u16_d16_hi v137, v137
v_exp_f16_sdwa v153, v154 dst_sel:WORD_1 dst_unused:UNUSED_PRESERVE src0_sel:WORD_1
v_fma_mix_f32 v157, v181, v181, v157 op_sel:[1,1,0] op_sel_hi:[1,1,0]
v_lshrrev_b16 v138, 2, v139
v_exp_f16_sdwa v150, v151 dst_sel:WORD_1 dst_unused:UNUSED_PRESERVE src0_sel:WORD_1
v_exp_f16_sdwa v147, v148 dst_sel:WORD_1 dst_unused:UNUSED_PRESERVE src0_sel:WORD_1
v_exp_f16_sdwa v144, v145 dst_sel:WORD_1 dst_unused:UNUSED_PRESERVE src0_sel:WORD_1
v_lshrrev_b32 v139, 18, v139
v_fma_mix_f32 v157, v182, v182, v157 op_sel:[0,0,0] op_sel_hi:[1,1,0]
v_mfma_f32_32x32x16_bf16 v[120:135], v[108:111], v[216:219], v[120:135]
ds_read_b128 v[236:239], v248 offset:40960
ds_read_u16_d16 v138, v138
ds_read_u16_d16_hi v139, v139
v_pk_add_f16 v153, v153, 1.0 op_sel_hi:[1,0]
v_pk_add_f16 v150, v150, 1.0 op_sel_hi:[1,0]
v_pk_add_f16 v147, v147, 1.0 op_sel_hi:[1,0]
v_and_b32 v141, s49, v141
v_pk_add_f16 v144, v144, 1.0 op_sel_hi:[1,0]
v_rcp_f16 v154, v153
v_fma_mix_f32 v157, v183, v183, v157 op_sel:[1,1,0] op_sel_hi:[1,1,0]
v_rcp_f16 v151, v150
v_mfma_f32_32x32x16_bf16 v[120:135], v[112:115], v[220:223], v[120:135]
ds_read_b128 v[216:219], v248 offset:44032
v_lshrrev_b16 v140, 2, v141
v_rcp_f16 v148, v147
v_fma_mix_f32 v157, v184, v184, v157 op_sel:[0,0,0] op_sel_hi:[1,1,0]
v_rcp_f16 v145, v144
v_lshrrev_b32 v141, 18, v141
v_rcp_f16_sdwa v154, v153 dst_sel:WORD_1 dst_unused:UNUSED_PRESERVE src0_sel:WORD_1
s_setprio 0
v_rcp_f16_sdwa v151, v150 dst_sel:WORD_1 dst_unused:UNUSED_PRESERVE src0_sel:WORD_1
s_waitcnt lgkmcnt(4)
v_mfma_f32_32x32x16_bf16 v[120:135], v[116:119], v[224:227], v[120:135]
ds_read_b128 v[220:223], v248 offset:41984
ds_read_u16_d16 v140, v140
ds_read_u16_d16_hi v141, v141
v_fma_mix_f32 v157, v185, v185, v157 op_sel:[1,1,0] op_sel_hi:[1,1,0]
v_and_b32 v143, s49, v143
v_rcp_f16_sdwa v148, v147 dst_sel:WORD_1 dst_unused:UNUSED_PRESERVE src0_sel:WORD_1
v_rcp_f16_sdwa v145, v144 dst_sel:WORD_1 dst_unused:UNUSED_PRESERVE src0_sel:WORD_1
v_pk_mul_f16 v155, v155, v154
v_lshrrev_b16 v142, 2, v143
v_fma_mix_f32 v157, v186, v186, v157 op_sel:[0,0,0] op_sel_hi:[1,1,0]
v_pk_mul_f16 v152, v152, v151
v_pk_mul_f16 v149, v149, v148
v_smfmac_f32_16x16x32_bf16 v[8:11], v[230:231], v[200:203], v246
ds_read_b128 v[224:227], v248 offset:45056
ds_read_u16_d16 v142, v142
v_pk_mul_f16 v146, v146, v145
v_fma_mix_f32 v158, v155, v155, v158 op_sel:[0,0,0] op_sel_hi:[1,1,0]
v_lshrrev_b32 v143, 18, v143
v_fma_mix_f32 v158, v155, v155, v158 op_sel:[1,1,0] op_sel_hi:[1,1,0]
v_fma_mix_f32 v158, v152, v152, v158 op_sel:[0,0,0] op_sel_hi:[1,1,0]
v_smfmac_f32_16x16x32_bf16 v[44:47], v[228:229], v[204:207], v246
v_fma_mix_f32 v157, v187, v187, v157 op_sel:[1,1,0] op_sel_hi:[1,1,0]
v_fma_mix_f32 v158, v152, v152, v158 op_sel:[1,1,0] op_sel_hi:[1,1,0]
v_fma_mix_f32 v158, v149, v149, v158 op_sel:[0,0,0] op_sel_hi:[1,1,0]
v_fma_mix_f32 v158, v149, v149, v158 op_sel:[1,1,0] op_sel_hi:[1,1,0]
v_fma_mix_f32 v158, v146, v146, v158 op_sel:[0,0,0] op_sel_hi:[1,1,0]
v_fma_mix_f32 v158, v146, v146, v158 op_sel:[1,1,0] op_sel_hi:[1,1,0]
s_setprio 2
v_smfmac_f32_16x16x32_bf16 v[28:31], v[234:235], v[208:211], v246
s_add_u32 s46, s80, 18874368
buffer_store_dwordx4 v[84:87], v241, s[32:35], s46 offen sc1
ds_read_b128 v[228:231], v248 offset:43008
ds_read_u16_d16_hi v143, v143
v_cvt_pkrtz_f16_f32 v179, v120, v121
v_cvt_pkrtz_f16_f32 v181, v122, v123
v_cvt_pkrtz_f16_f32 v183, v124, v125
v_cvt_pkrtz_f16_f32 v185, v126, v127
v_smfmac_f32_16x16x32_bf16 v[12:15], v[232:233], v[212:215], v246
v_cvt_pkrtz_f16_f32 v187, v128, v129
v_cvt_pk_f16_f32 v155, v130, v131
v_cvt_pk_f16_f32 v152, v132, v133
v_cvt_pk_f16_f32 v149, v134, v135
v_pk_fma_f16 v154, v155, v155, s48
s_waitcnt lgkmcnt(2)
v_mfma_f32_32x32x16_bf16 v[120:135], v[96:99], v[236:239], 0
ds_read_b128 v[232:235], v248 offset:46080
v_and_b32 v179, s49, v179
v_fma_mix_f32 v158, v136, v136, v158 op_sel:[0,0,0] op_sel_hi:[1,1,0]
v_pk_fma_f16 v151, v152, v152, s48
v_pk_fma_f16 v148, v149, v149, s48
v_lshrrev_b16 v178, 2, v179
v_pk_mul_f16 v154, v155, v154
v_pk_mul_f16 v151, v152, v151
v_pk_mul_f16 v148, v149, v148
v_lshrrev_b32 v179, 18, v179
v_mfma_f32_32x32x16_bf16 v[120:135], v[100:103], v[216:219], v[120:135]
ds_read_b128 v[236:239], v245 offset:4224
v_xor_b32 v243, 16, v243
ds_read_b128 v[192:195], v243 offset:128
ds_read_b128 v[196:199], v243 offset:64
ds_read_u16_d16 v178, v178
ds_read_u16_d16_hi v179, v179
v_fma_mix_f32 v158, v137, v137, v158 op_sel:[1,1,0] op_sel_hi:[1,1,0]
v_exp_f16 v153, v154
v_and_b32 v181, s49, v181
v_exp_f16 v150, v151
v_exp_f16 v147, v148
v_lshrrev_b16 v180, 2, v181
v_mfma_f32_32x32x16_bf16 v[120:135], v[104:107], v[220:223], v[120:135]
ds_read_b128 v[216:219], v245 offset:3840
ds_read_b128 v[200:203], v243
v_xor_b32 v242, 16, v242
ds_read_b128 v[204:207], v242 offset:128
ds_read_u16_d16 v180, v180
v_fma_mix_f32 v158, v138, v138, v158 op_sel:[0,0,0] op_sel_hi:[1,1,0]
v_exp_f16_sdwa v153, v154 dst_sel:WORD_1 dst_unused:UNUSED_PRESERVE src0_sel:WORD_1
v_lshrrev_b32 v181, 18, v181
v_exp_f16_sdwa v150, v151 dst_sel:WORD_1 dst_unused:UNUSED_PRESERVE src0_sel:WORD_1
v_fma_mix_f32 v158, v139, v139, v158 op_sel:[1,1,0] op_sel_hi:[1,1,0]
v_and_b32 v183, s49, v183
v_mfma_f32_32x32x16_bf16 v[120:135], v[108:111], v[224:227], v[120:135]
ds_read_b128 v[220:223], v248 offset:47104
ds_read_u16_d16_hi v181, v181
v_exp_f16_sdwa v147, v148 dst_sel:WORD_1 dst_unused:UNUSED_PRESERVE src0_sel:WORD_1
v_pk_add_f16 v153, v153, 1.0 op_sel_hi:[1,0]
v_lshrrev_b16 v182, 2, v183
v_pk_add_f16 v150, v150, 1.0 op_sel_hi:[1,0]
v_pk_add_f16 v147, v147, 1.0 op_sel_hi:[1,0]
v_rcp_f16 v154, v153
v_lshrrev_b32 v183, 18, v183
v_fma_mix_f32 v158, v140, v140, v158 op_sel:[0,0,0] op_sel_hi:[1,1,0]
s_waitcnt lgkmcnt(6)
v_mfma_f32_32x32x16_bf16 v[120:135], v[112:115], v[228:231], v[120:135]
ds_read_b128 v[224:227], v248 offset:50176
ds_read_u16_d16 v182, v182
ds_read_u16_d16_hi v183, v183
v_rcp_f16 v151, v150
v_and_b32 v185, s49, v185
v_rcp_f16 v148, v147
v_fma_mix_f32 v158, v141, v141, v158 op_sel:[1,1,0] op_sel_hi:[1,1,0]
v_lshrrev_b16 v184, 2, v185
v_rcp_f16_sdwa v154, v153 dst_sel:WORD_1 dst_unused:UNUSED_PRESERVE src0_sel:WORD_1
v_mfma_f32_32x32x16_bf16 v[120:135], v[116:119], v[232:235], v[120:135]
ds_read_b128 v[228:231], v248 offset:48128
ds_read_u16_d16 v184, v184
v_rcp_f16_sdwa v151, v150 dst_sel:WORD_1 dst_unused:UNUSED_PRESERVE src0_sel:WORD_1
v_lshrrev_b32 v185, 18, v185
v_rcp_f16_sdwa v148, v147 dst_sel:WORD_1 dst_unused:UNUSED_PRESERVE src0_sel:WORD_1
v_and_b32 v187, s49, v187
v_fma_mix_f32 v158, v142, v142, v158 op_sel:[0,0,0] op_sel_hi:[1,1,0]
v_pk_mul_f16 v155, v155, v154
v_pk_mul_f16 v152, v152, v151
v_smfmac_f32_16x16x32_bf16 v[44:47], v[238:239], v[192:195], v246
ds_read_b128 v[232:235], v248 offset:51200
ds_read_u16_d16_hi v185, v185
v_lshrrev_b16 v186, 2, v187
v_pk_mul_f16 v149, v149, v148
v_fma_mix_f32 v159, v155, v155, v159 op_sel:[0,0,0] op_sel_hi:[1,1,0]
v_fma_mix_f32 v158, v143, v143, v158 op_sel:[1,1,0] op_sel_hi:[1,1,0]
v_lshrrev_b32 v187, 18, v187
v_smfmac_f32_16x16x32_bf16 v[28:31], v[236:237], v[196:199], v246
v_fma_mix_f32 v159, v155, v155, v159 op_sel:[1,1,0] op_sel_hi:[1,1,0]
v_fma_mix_f32 v159, v152, v152, v159 op_sel:[0,0,0] op_sel_hi:[1,1,0]
v_fma_mix_f32 v159, v152, v152, v159 op_sel:[1,1,0] op_sel_hi:[1,1,0]
v_fma_mix_f32 v159, v149, v149, v159 op_sel:[0,0,0] op_sel_hi:[1,1,0]
v_fma_mix_f32 v159, v149, v149, v159 op_sel:[1,1,0] op_sel_hi:[1,1,0]
s_setprio 1
s_waitcnt lgkmcnt(4)
v_smfmac_f32_16x16x32_bf16 v[12:15], v[218:219], v[200:203], v246
s_add_u32 s46, s80, 20971520
buffer_store_dwordx4 v[88:91], v241, s[32:35], s46 offen sc1
ds_read_b128 v[236:239], v248 offset:49152
ds_read_u16_d16 v186, v186
ds_read_u16_d16_hi v187, v187
v_cvt_pkrtz_f16_f32 v137, v120, v121
v_cvt_pkrtz_f16_f32 v139, v122, v123
v_cvt_pkrtz_f16_f32 v141, v124, v125
v_cvt_pkrtz_f16_f32 v143, v126, v127
v_cvt_pk_f16_f32 v155, v128, v129
v_smfmac_f32_16x16x32_bf16 v[44:47], v[216:217], v[204:207], v246
v_cvt_pk_f16_f32 v152, v130, v131
v_cvt_pk_f16_f32 v149, v132, v133
v_cvt_pk_f16_f32 v146, v134, v135
v_pk_fma_f16 v154, v155, v155, s48
v_and_b32 v137, s49, v137
v_mfma_f32_32x32x16_bf16 v[120:135], v[96:99], v[220:223], 0
ds_read_b128 v[216:219], v248 offset:52224
v_fma_mix_f32 v159, v178, v178, v159 op_sel:[0,0,0] op_sel_hi:[1,1,0]
v_pk_fma_f16 v151, v152, v152, s48
v_pk_fma_f16 v148, v149, v149, s48
v_pk_fma_f16 v145, v146, v146, s48
v_pk_mul_f16 v154, v155, v154
v_lshrrev_b16 v136, 2, v137
v_pk_mul_f16 v151, v152, v151
v_fma_mix_f32 v159, v179, v179, v159 op_sel:[1,1,0] op_sel_hi:[1,1,0]
v_pk_mul_f16 v148, v149, v148
v_pk_mul_f16 v145, v146, v145
v_mfma_f32_32x32x16_bf16 v[120:135], v[100:103], v[224:227], v[120:135]
ds_read_b128 v[220:223], v245 offset:3456
ds_read_b128 v[208:211], v242 offset:64
ds_read_b128 v[212:215], v242
ds_read_u16_d16 v136, v136
v_exp_f16 v153, v154
v_lshrrev_b32 v137, 18, v137
v_exp_f16 v150, v151
v_fma_mix_f32 v159, v180, v180, v159 op_sel:[0,0,0] op_sel_hi:[1,1,0]
v_exp_f16 v147, v148
v_and_b32 v139, s49, v139
v_exp_f16 v144, v145
s_waitcnt lgkmcnt(5)
v_mfma_f32_32x32x16_bf16 v[120:135], v[104:107], v[228:231], v[120:135]
ds_read_b128 v[224:227], v245 offset:3072
v_xor_b32 v244, 32, v244
ds_read_b128 v[192:195], v244 offset:128
ds_read_b128 v[196:199], v244 offset:64
ds_read_u16_d16_hi v137, v137
v_exp_f16_sdwa v153, v154 dst_sel:WORD_1 dst_unused:UNUSED_PRESERVE src0_sel:WORD_1
v_fma_mix_f32 v159, v181, v181, v159 op_sel:[1,1,0] op_sel_hi:[1,1,0]
v_lshrrev_b16 v138, 2, v139
v_exp_f16_sdwa v150, v151 dst_sel:WORD_1 dst_unused:UNUSED_PRESERVE src0_sel:WORD_1
v_exp_f16_sdwa v147, v148 dst_sel:WORD_1 dst_unused:UNUSED_PRESERVE src0_sel:WORD_1
v_exp_f16_sdwa v144, v145 dst_sel:WORD_1 dst_unused:UNUSED_PRESERVE src0_sel:WORD_1
v_lshrrev_b32 v139, 18, v139
v_fma_mix_f32 v159, v182, v182, v159 op_sel:[0,0,0] op_sel_hi:[1,1,0]
v_mfma_f32_32x32x16_bf16 v[120:135], v[108:111], v[232:235], v[120:135]
ds_read_b128 v[228:231], v248 offset:53248
ds_read_u16_d16 v138, v138
ds_read_u16_d16_hi v139, v139
v_pk_add_f16 v153, v153, 1.0 op_sel_hi:[1,0]
v_pk_add_f16 v150, v150, 1.0 op_sel_hi:[1,0]
v_pk_add_f16 v147, v147, 1.0 op_sel_hi:[1,0]
v_and_b32 v141, s49, v141
v_pk_add_f16 v144, v144, 1.0 op_sel_hi:[1,0]
v_rcp_f16 v154, v153
v_fma_mix_f32 v159, v183, v183, v159 op_sel:[1,1,0] op_sel_hi:[1,1,0]
v_rcp_f16 v151, v150
v_mfma_f32_32x32x16_bf16 v[120:135], v[112:115], v[236:239], v[120:135]
ds_read_b128 v[232:235], v248 offset:56320
v_lshrrev_b16 v140, 2, v141
v_rcp_f16 v148, v147
v_fma_mix_f32 v159, v184, v184, v159 op_sel:[0,0,0] op_sel_hi:[1,1,0]
v_rcp_f16 v145, v144
v_lshrrev_b32 v141, 18, v141
v_rcp_f16_sdwa v154, v153 dst_sel:WORD_1 dst_unused:UNUSED_PRESERVE src0_sel:WORD_1
s_setprio 0
v_rcp_f16_sdwa v151, v150 dst_sel:WORD_1 dst_unused:UNUSED_PRESERVE src0_sel:WORD_1
s_waitcnt lgkmcnt(4)
v_mfma_f32_32x32x16_bf16 v[120:135], v[116:119], v[216:219], v[120:135]
ds_read_b128 v[236:239], v248 offset:54272
ds_read_u16_d16 v140, v140
ds_read_u16_d16_hi v141, v141
v_fma_mix_f32 v159, v185, v185, v159 op_sel:[1,1,0] op_sel_hi:[1,1,0]
v_and_b32 v143, s49, v143
v_rcp_f16_sdwa v148, v147 dst_sel:WORD_1 dst_unused:UNUSED_PRESERVE src0_sel:WORD_1
v_rcp_f16_sdwa v145, v144 dst_sel:WORD_1 dst_unused:UNUSED_PRESERVE src0_sel:WORD_1
v_pk_mul_f16 v155, v155, v154
v_lshrrev_b16 v142, 2, v143
v_fma_mix_f32 v159, v186, v186, v159 op_sel:[0,0,0] op_sel_hi:[1,1,0]
v_pk_mul_f16 v152, v152, v151
v_pk_mul_f16 v149, v149, v148
v_smfmac_f32_16x16x32_bf16 v[28:31], v[222:223], v[208:211], v246
ds_read_b128 v[216:219], v248 offset:57344
ds_read_u16_d16 v142, v142
v_pk_mul_f16 v146, v146, v145
v_fma_mix_f32 v160, v155, v155, v160 op_sel:[0,0,0] op_sel_hi:[1,1,0]
v_lshrrev_b32 v143, 18, v143
v_fma_mix_f32 v160, v155, v155, v160 op_sel:[1,1,0] op_sel_hi:[1,1,0]
v_fma_mix_f32 v160, v152, v152, v160 op_sel:[0,0,0] op_sel_hi:[1,1,0]
v_smfmac_f32_16x16x32_bf16 v[12:15], v[220:221], v[212:215], v246
v_fma_mix_f32 v159, v187, v187, v159 op_sel:[1,1,0] op_sel_hi:[1,1,0]
v_fma_mix_f32 v160, v152, v152, v160 op_sel:[1,1,0] op_sel_hi:[1,1,0]
v_fma_mix_f32 v160, v149, v149, v160 op_sel:[0,0,0] op_sel_hi:[1,1,0]
v_fma_mix_f32 v160, v149, v149, v160 op_sel:[1,1,0] op_sel_hi:[1,1,0]
v_fma_mix_f32 v160, v146, v146, v160 op_sel:[0,0,0] op_sel_hi:[1,1,0]
v_fma_mix_f32 v160, v146, v146, v160 op_sel:[1,1,0] op_sel_hi:[1,1,0]
s_setprio 2
v_smfmac_f32_16x16x32_bf16 v[36:39], v[226:227], v[192:195], v246
s_add_u32 s46, s80, 23068672
buffer_store_dwordx4 v[92:95], v241, s[32:35], s46 offen sc1
ds_read_b128 v[220:223], v248 offset:55296
ds_read_u16_d16_hi v143, v143
v_cvt_pkrtz_f16_f32 v179, v120, v121
v_cvt_pkrtz_f16_f32 v181, v122, v123
v_cvt_pkrtz_f16_f32 v183, v124, v125
v_cvt_pkrtz_f16_f32 v185, v126, v127
v_smfmac_f32_16x16x32_bf16 v[20:23], v[224:225], v[196:199], v246
v_cvt_pkrtz_f16_f32 v187, v128, v129
v_cvt_pk_f16_f32 v155, v130, v131
v_cvt_pk_f16_f32 v152, v132, v133
v_cvt_pk_f16_f32 v149, v134, v135
s_waitcnt lgkmcnt(2)
v_mfma_f32_32x32x16_bf16 v[120:135], v[96:99], v[228:231], 0
ds_read_b128 v[224:227], v245 offset:2688
ds_read_b128 v[200:203], v244
v_xor_b32 v243, 32, v243
ds_read_b128 v[204:207], v243 offset:128
v_pk_fma_f16 v154, v155, v155, s48
v_and_b32 v179, s49, v179
v_fma_mix_f32 v160, v136, v136, v160 op_sel:[0,0,0] op_sel_hi:[1,1,0]
v_pk_fma_f16 v151, v152, v152, s48
v_pk_fma_f16 v148, v149, v149, s48
v_lshrrev_b16 v178, 2, v179
v_pk_mul_f16 v154, v155, v154
v_pk_mul_f16 v151, v152, v151
v_mfma_f32_32x32x16_bf16 v[120:135], v[100:103], v[232:235], v[120:135]
ds_read_b128 v[228:231], v248 offset:58368
ds_read_u16_d16 v178, v178
v_pk_mul_f16 v148, v149, v148
v_lshrrev_b32 v179, 18, v179
v_fma_mix_f32 v160, v137, v137, v160 op_sel:[1,1,0] op_sel_hi:[1,1,0]
v_exp_f16 v153, v154
v_and_b32 v181, s49, v181
v_exp_f16 v150, v151
v_mfma_f32_32x32x16_bf16 v[120:135], v[104:107], v[236:239], v[120:135]
ds_read_b128 v[232:235], v245 offset:2304
ds_read_b128 v[208:211], v243 offset:64
ds_read_b128 v[212:215], v243
ds_read_u16_d16_hi v179, v179
v_exp_f16 v147, v148
v_lshrrev_b16 v180, 2, v181
v_fma_mix_f32 v160, v138, v138, v160 op_sel:[0,0,0] op_sel_hi:[1,1,0]
v_exp_f16_sdwa v153, v154 dst_sel:WORD_1 dst_unused:UNUSED_PRESERVE src0_sel:WORD_1
v_lshrrev_b32 v181, 18, v181
v_mfma_f32_32x32x16_bf16 v[120:135], v[108:111], v[216:219], v[120:135]
ds_read_b128 v[236:239], v245 offset:1920
v_xor_b32 v242, 32, v242
ds_read_b128 v[192:195], v242 offset:128
ds_read_b128 v[196:199], v242 offset:64
ds_read_u16_d16 v180, v180
ds_read_u16_d16_hi v181, v181
v_exp_f16_sdwa v150, v151 dst_sel:WORD_1 dst_unused:UNUSED_PRESERVE src0_sel:WORD_1
v_fma_mix_f32 v160, v139, v139, v160 op_sel:[1,1,0] op_sel_hi:[1,1,0]
v_and_b32 v183, s49, v183
v_exp_f16_sdwa v147, v148 dst_sel:WORD_1 dst_unused:UNUSED_PRESERVE src0_sel:WORD_1
v_pk_add_f16 v153, v153, 1.0 op_sel_hi:[1,0]
v_lshrrev_b16 v182, 2, v183
v_pk_add_f16 v150, v150, 1.0 op_sel_hi:[1,0]
s_waitcnt lgkmcnt(9)
v_mfma_f32_32x32x16_bf16 v[120:135], v[112:115], v[220:223], v[120:135]
ds_read_b128 v[216:219], v248 offset:59392
ds_read_u16_d16 v182, v182
v_pk_add_f16 v147, v147, 1.0 op_sel_hi:[1,0]
v_rcp_f16 v154, v153
v_lshrrev_b32 v183, 18, v183
v_fma_mix_f32 v160, v140, v140, v160 op_sel:[0,0,0] op_sel_hi:[1,1,0]
v_rcp_f16 v151, v150
v_and_b32 v185, s49, v185
v_smfmac_f32_16x16x32_bf16 v[4:7], v[226:227], v[200:203], v246
ds_read_b128 v[220:223], v248 offset:62464
ds_read_u16_d16_hi v183, v183
v_rcp_f16 v148, v147
v_fma_mix_f32 v160, v141, v141, v160 op_sel:[1,1,0] op_sel_hi:[1,1,0]
v_lshrrev_b16 v184, 2, v185
v_smfmac_f32_16x16x32_bf16 v[36:39], v[224:225], v[204:207], v246
v_rcp_f16_sdwa v154, v153 dst_sel:WORD_1 dst_unused:UNUSED_PRESERVE src0_sel:WORD_1
v_rcp_f16_sdwa v151, v150 dst_sel:WORD_1 dst_unused:UNUSED_PRESERVE src0_sel:WORD_1
v_mfma_f32_32x32x16_bf16 v[120:135], v[116:119], v[228:231], v[120:135]
ds_read_b128 v[224:227], v248 offset:60416
ds_read_u16_d16 v184, v184
v_lshrrev_b32 v185, 18, v185
v_rcp_f16_sdwa v148, v147 dst_sel:WORD_1 dst_unused:UNUSED_PRESERVE src0_sel:WORD_1
v_and_b32 v187, s49, v187
v_fma_mix_f32 v160, v142, v142, v160 op_sel:[0,0,0] op_sel_hi:[1,1,0]
v_pk_mul_f16 v155, v155, v154
v_pk_mul_f16 v152, v152, v151
v_lshrrev_b16 v186, 2, v187
s_waitcnt lgkmcnt(4)
v_smfmac_f32_16x16x32_bf16 v[20:23], v[234:235], v[208:211], v246
ds_read_b128 v[228:231], v248 offset:63488
ds_read_u16_d16_hi v185, v185
ds_read_u16_d16 v186, v186
v_pk_mul_f16 v149, v149, v148
v_fma_mix_f32 v161, v155, v155, v161 op_sel:[0,0,0] op_sel_hi:[1,1,0]
v_fma_mix_f32 v160, v143, v143, v160 op_sel:[1,1,0] op_sel_hi:[1,1,0]
v_lshrrev_b32 v187, 18, v187
v_smfmac_f32_16x16x32_bf16 v[4:7], v[232:233], v[212:215], v246
v_fma_mix_f32 v161, v155, v155, v161 op_sel:[1,1,0] op_sel_hi:[1,1,0]
v_fma_mix_f32 v161, v152, v152, v161 op_sel:[0,0,0] op_sel_hi:[1,1,0]
v_fma_mix_f32 v161, v152, v152, v161 op_sel:[1,1,0] op_sel_hi:[1,1,0]
v_fma_mix_f32 v161, v149, v149, v161 op_sel:[0,0,0] op_sel_hi:[1,1,0]
v_fma_mix_f32 v161, v149, v149, v161 op_sel:[1,1,0] op_sel_hi:[1,1,0]
s_setprio 1
v_smfmac_f32_16x16x32_bf16 v[36:39], v[238:239], v[192:195], v246
ds_read_b128 v[232:235], v248 offset:61440
ds_read_u16_d16_hi v187, v187
v_cvt_pkrtz_f16_f32 v137, v120, v121
v_cvt_pkrtz_f16_f32 v139, v122, v123
v_cvt_pkrtz_f16_f32 v141, v124, v125
v_cvt_pkrtz_f16_f32 v143, v126, v127
v_cvt_pk_f16_f32 v155, v128, v129
v_smfmac_f32_16x16x32_bf16 v[20:23], v[236:237], v[196:199], v246
v_cvt_pk_f16_f32 v152, v130, v131
v_cvt_pk_f16_f32 v149, v132, v133
v_cvt_pk_f16_f32 v146, v134, v135
v_pk_fma_f16 v154, v155, v155, s48
v_and_b32 v137, s49, v137
v_mfma_f32_32x32x16_bf16 v[120:135], v[96:99], v[216:219], 0
ds_read_b128 v[236:239], v248 offset:64512
v_fma_mix_f32 v161, v178, v178, v161 op_sel:[0,0,0] op_sel_hi:[1,1,0]
v_pk_fma_f16 v151, v152, v152, s48
v_pk_fma_f16 v148, v149, v149, s48
v_pk_fma_f16 v145, v146, v146, s48
v_pk_mul_f16 v154, v155, v154
v_lshrrev_b16 v136, 2, v137
v_pk_mul_f16 v151, v152, v151
v_fma_mix_f32 v161, v179, v179, v161 op_sel:[1,1,0] op_sel_hi:[1,1,0]
v_pk_mul_f16 v148, v149, v148
v_pk_mul_f16 v145, v146, v145
s_waitcnt lgkmcnt(2)
v_mfma_f32_32x32x16_bf16 v[120:135], v[100:103], v[220:223], v[120:135]
ds_read_b128 v[216:219], v245 offset:1536
ds_read_b128 v[200:203], v242
v_xor_b32 v244, 16, v244
ds_read_b128 v[204:207], v244 offset:128
ds_read_u16_d16 v136, v136
v_exp_f16 v153, v154
v_lshrrev_b32 v137, 18, v137
v_exp_f16 v150, v151
v_fma_mix_f32 v161, v180, v180, v161 op_sel:[0,0,0] op_sel_hi:[1,1,0]
v_exp_f16 v147, v148
v_and_b32 v139, s49, v139
v_exp_f16 v144, v145
v_mfma_f32_32x32x16_bf16 v[120:135], v[104:107], v[224:227], v[120:135]
ds_read_b128 v[220:223], v245 offset:1152
ds_read_b128 v[208:211], v244 offset:64
ds_read_b128 v[212:215], v244
ds_read_u16_d16_hi v137, v137
v_exp_f16_sdwa v153, v154 dst_sel:WORD_1 dst_unused:UNUSED_PRESERVE src0_sel:WORD_1
v_fma_mix_f32 v161, v181, v181, v161 op_sel:[1,1,0] op_sel_hi:[1,1,0]
v_lshrrev_b16 v138, 2, v139
v_exp_f16_sdwa v150, v151 dst_sel:WORD_1 dst_unused:UNUSED_PRESERVE src0_sel:WORD_1
v_exp_f16_sdwa v147, v148 dst_sel:WORD_1 dst_unused:UNUSED_PRESERVE src0_sel:WORD_1
v_exp_f16_sdwa v144, v145 dst_sel:WORD_1 dst_unused:UNUSED_PRESERVE src0_sel:WORD_1
v_lshrrev_b32 v139, 18, v139
v_fma_mix_f32 v161, v182, v182, v161 op_sel:[0,0,0] op_sel_hi:[1,1,0]
v_mfma_f32_32x32x16_bf16 v[120:135], v[108:111], v[228:231], v[120:135]
ds_read_b128 v[224:227], v249
ds_read_u16_d16 v138, v138
ds_read_u16_d16_hi v139, v139
v_pk_add_f16 v153, v153, 1.0 op_sel_hi:[1,0]
v_pk_add_f16 v150, v150, 1.0 op_sel_hi:[1,0]
v_pk_add_f16 v147, v147, 1.0 op_sel_hi:[1,0]
v_and_b32 v141, s49, v141
v_pk_add_f16 v144, v144, 1.0 op_sel_hi:[1,0]
v_rcp_f16 v154, v153
v_fma_mix_f32 v161, v183, v183, v161 op_sel:[1,1,0] op_sel_hi:[1,1,0]
v_rcp_f16 v151, v150
v_mfma_f32_32x32x16_bf16 v[120:135], v[112:115], v[232:235], v[120:135]
ds_read_b128 v[228:231], v249 offset:3072
v_lshrrev_b16 v140, 2, v141
v_rcp_f16 v148, v147
v_fma_mix_f32 v161, v184, v184, v161 op_sel:[0,0,0] op_sel_hi:[1,1,0]
v_rcp_f16 v145, v144
v_lshrrev_b32 v141, 18, v141
v_rcp_f16_sdwa v154, v153 dst_sel:WORD_1 dst_unused:UNUSED_PRESERVE src0_sel:WORD_1
s_setprio 0
v_rcp_f16_sdwa v151, v150 dst_sel:WORD_1 dst_unused:UNUSED_PRESERVE src0_sel:WORD_1
s_waitcnt lgkmcnt(4)
v_mfma_f32_32x32x16_bf16 v[120:135], v[116:119], v[236:239], v[120:135]
ds_read_b128 v[232:235], v249 offset:1024
ds_read_u16_d16 v140, v140
ds_read_u16_d16_hi v141, v141
v_fma_mix_f32 v161, v185, v185, v161 op_sel:[1,1,0] op_sel_hi:[1,1,0]
v_and_b32 v143, s49, v143
v_rcp_f16_sdwa v148, v147 dst_sel:WORD_1 dst_unused:UNUSED_PRESERVE src0_sel:WORD_1
v_rcp_f16_sdwa v145, v144 dst_sel:WORD_1 dst_unused:UNUSED_PRESERVE src0_sel:WORD_1
v_pk_mul_f16 v155, v155, v154
v_lshrrev_b16 v142, 2, v143
v_fma_mix_f32 v161, v186, v186, v161 op_sel:[0,0,0] op_sel_hi:[1,1,0]
v_pk_mul_f16 v152, v152, v151
v_pk_mul_f16 v149, v149, v148
v_smfmac_f32_16x16x32_bf16 v[4:7], v[218:219], v[200:203], v246
ds_read_b128 v[236:239], v249 offset:4096
ds_read_u16_d16 v142, v142
v_pk_mul_f16 v146, v146, v145
v_fma_mix_f32 v162, v155, v155, v162 op_sel:[0,0,0] op_sel_hi:[1,1,0]
v_lshrrev_b32 v143, 18, v143
v_fma_mix_f32 v162, v155, v155, v162 op_sel:[1,1,0] op_sel_hi:[1,1,0]
v_fma_mix_f32 v162, v152, v152, v162 op_sel:[0,0,0] op_sel_hi:[1,1,0]
v_smfmac_f32_16x16x32_bf16 v[32:35], v[216:217], v[204:207], v246
v_fma_mix_f32 v161, v187, v187, v161 op_sel:[1,1,0] op_sel_hi:[1,1,0]
v_fma_mix_f32 v162, v152, v152, v162 op_sel:[1,1,0] op_sel_hi:[1,1,0]
v_fma_mix_f32 v162, v149, v149, v162 op_sel:[0,0,0] op_sel_hi:[1,1,0]
v_fma_mix_f32 v162, v149, v149, v162 op_sel:[1,1,0] op_sel_hi:[1,1,0]
v_fma_mix_f32 v162, v146, v146, v162 op_sel:[0,0,0] op_sel_hi:[1,1,0]
v_fma_mix_f32 v162, v146, v146, v162 op_sel:[1,1,0] op_sel_hi:[1,1,0]
s_setprio 2
v_smfmac_f32_16x16x32_bf16 v[16:19], v[222:223], v[208:211], v246
ds_read_b128 v[216:219], v249 offset:2048
ds_read_u16_d16_hi v143, v143
v_cvt_pkrtz_f16_f32 v179, v120, v121
v_cvt_pkrtz_f16_f32 v181, v122, v123
v_cvt_pkrtz_f16_f32 v183, v124, v125
v_cvt_pkrtz_f16_f32 v185, v126, v127
v_smfmac_f32_16x16x32_bf16 v[0:3], v[220:221], v[212:215], v246
v_cvt_pkrtz_f16_f32 v187, v128, v129
v_cvt_pk_f16_f32 v155, v130, v131
v_cvt_pk_f16_f32 v152, v132, v133
v_cvt_pk_f16_f32 v149, v134, v135
v_pk_fma_f16 v154, v155, v155, s48
s_waitcnt lgkmcnt(2)
v_mfma_f32_32x32x16_bf16 v[120:135], v[96:99], v[224:227], 0
ds_read_b128 v[220:223], v249 offset:5120
v_and_b32 v179, s49, v179
v_fma_mix_f32 v162, v136, v136, v162 op_sel:[0,0,0] op_sel_hi:[1,1,0]
v_pk_fma_f16 v151, v152, v152, s48
v_pk_fma_f16 v148, v149, v149, s48
v_lshrrev_b16 v178, 2, v179
v_pk_mul_f16 v154, v155, v154
v_pk_mul_f16 v151, v152, v151
v_pk_mul_f16 v148, v149, v148
v_lshrrev_b32 v179, 18, v179
v_mfma_f32_32x32x16_bf16 v[120:135], v[100:103], v[228:231], v[120:135]
ds_read_b128 v[224:227], v245 offset:768
v_xor_b32 v243, 16, v243
ds_read_b128 v[192:195], v243 offset:128
ds_read_b128 v[196:199], v243 offset:64
ds_read_u16_d16 v178, v178
ds_read_u16_d16_hi v179, v179
v_fma_mix_f32 v162, v137, v137, v162 op_sel:[1,1,0] op_sel_hi:[1,1,0]
v_exp_f16 v153, v154
v_and_b32 v181, s49, v181
v_exp_f16 v150, v151
v_exp_f16 v147, v148
v_lshrrev_b16 v180, 2, v181
v_mfma_f32_32x32x16_bf16 v[120:135], v[104:107], v[232:235], v[120:135]
ds_read_b128 v[228:231], v245 offset:384
ds_read_b128 v[200:203], v243
v_xor_b32 v242, 16, v242
ds_read_b128 v[204:207], v242 offset:128
ds_read_u16_d16 v180, v180
v_fma_mix_f32 v162, v138, v138, v162 op_sel:[0,0,0] op_sel_hi:[1,1,0]
v_exp_f16_sdwa v153, v154 dst_sel:WORD_1 dst_unused:UNUSED_PRESERVE src0_sel:WORD_1
v_lshrrev_b32 v181, 18, v181
v_exp_f16_sdwa v150, v151 dst_sel:WORD_1 dst_unused:UNUSED_PRESERVE src0_sel:WORD_1
v_fma_mix_f32 v162, v139, v139, v162 op_sel:[1,1,0] op_sel_hi:[1,1,0]
v_and_b32 v183, s49, v183
v_mfma_f32_32x32x16_bf16 v[120:135], v[108:111], v[236:239], v[120:135]
ds_read_b128 v[232:235], v249 offset:6144
ds_read_u16_d16_hi v181, v181
v_exp_f16_sdwa v147, v148 dst_sel:WORD_1 dst_unused:UNUSED_PRESERVE src0_sel:WORD_1
v_pk_add_f16 v153, v153, 1.0 op_sel_hi:[1,0]
v_lshrrev_b16 v182, 2, v183
v_pk_add_f16 v150, v150, 1.0 op_sel_hi:[1,0]
v_pk_add_f16 v147, v147, 1.0 op_sel_hi:[1,0]
v_rcp_f16 v154, v153
v_lshrrev_b32 v183, 18, v183
v_fma_mix_f32 v162, v140, v140, v162 op_sel:[0,0,0] op_sel_hi:[1,1,0]
s_waitcnt lgkmcnt(6)
v_mfma_f32_32x32x16_bf16 v[120:135], v[112:115], v[216:219], v[120:135]
ds_read_b128 v[236:239], v249 offset:9216
ds_read_u16_d16 v182, v182
ds_read_u16_d16_hi v183, v183
v_rcp_f16 v151, v150
v_and_b32 v185, s49, v185
v_rcp_f16 v148, v147
v_fma_mix_f32 v162, v141, v141, v162 op_sel:[1,1,0] op_sel_hi:[1,1,0]
v_lshrrev_b16 v184, 2, v185
v_rcp_f16_sdwa v154, v153 dst_sel:WORD_1 dst_unused:UNUSED_PRESERVE src0_sel:WORD_1
v_mfma_f32_32x32x16_bf16 v[120:135], v[116:119], v[220:223], v[120:135]
ds_read_b128 v[216:219], v249 offset:7168
ds_read_u16_d16 v184, v184
v_rcp_f16_sdwa v151, v150 dst_sel:WORD_1 dst_unused:UNUSED_PRESERVE src0_sel:WORD_1
v_lshrrev_b32 v185, 18, v185
v_rcp_f16_sdwa v148, v147 dst_sel:WORD_1 dst_unused:UNUSED_PRESERVE src0_sel:WORD_1
v_and_b32 v187, s49, v187
v_fma_mix_f32 v162, v142, v142, v162 op_sel:[0,0,0] op_sel_hi:[1,1,0]
v_pk_mul_f16 v155, v155, v154
v_pk_mul_f16 v152, v152, v151
v_smfmac_f32_16x16x32_bf16 v[32:35], v[226:227], v[192:195], v246
ds_read_b128 v[220:223], v249 offset:10240
ds_read_u16_d16_hi v185, v185
v_lshrrev_b16 v186, 2, v187
v_pk_mul_f16 v149, v149, v148
v_fma_mix_f32 v163, v155, v155, v163 op_sel:[0,0,0] op_sel_hi:[1,1,0]
v_fma_mix_f32 v162, v143, v143, v162 op_sel:[1,1,0] op_sel_hi:[1,1,0]
v_lshrrev_b32 v187, 18, v187
v_smfmac_f32_16x16x32_bf16 v[16:19], v[224:225], v[196:199], v246
v_fma_mix_f32 v163, v155, v155, v163 op_sel:[1,1,0] op_sel_hi:[1,1,0]
v_fma_mix_f32 v163, v152, v152, v163 op_sel:[0,0,0] op_sel_hi:[1,1,0]
v_fma_mix_f32 v163, v152, v152, v163 op_sel:[1,1,0] op_sel_hi:[1,1,0]
v_fma_mix_f32 v163, v149, v149, v163 op_sel:[0,0,0] op_sel_hi:[1,1,0]
v_fma_mix_f32 v163, v149, v149, v163 op_sel:[1,1,0] op_sel_hi:[1,1,0]
s_setprio 1
s_waitcnt lgkmcnt(4)
v_smfmac_f32_16x16x32_bf16 v[0:3], v[230:231], v[200:203], v246
ds_read_b128 v[224:227], v249 offset:8192
ds_read_u16_d16 v186, v186
ds_read_u16_d16_hi v187, v187
v_cvt_pkrtz_f16_f32 v137, v120, v121
v_cvt_pkrtz_f16_f32 v139, v122, v123
v_cvt_pkrtz_f16_f32 v141, v124, v125
v_cvt_pkrtz_f16_f32 v143, v126, v127
v_smfmac_f32_16x16x32_bf16 v[32:35], v[228:229], v[204:207], v246
v_cvt_pk_f16_f32 v155, v128, v129
v_cvt_pk_f16_f32 v152, v130, v131
v_cvt_pk_f16_f32 v149, v132, v133
v_cvt_pk_f16_f32 v146, v134, v135
v_pk_fma_f16 v154, v155, v155, s48
v_mfma_f32_32x32x16_bf16 v[120:135], v[96:99], v[232:235], 0
ds_read_b128 v[228:231], v249 offset:11264
v_and_b32 v137, s49, v137
v_fma_mix_f32 v163, v178, v178, v163 op_sel:[0,0,0] op_sel_hi:[1,1,0]
v_pk_fma_f16 v151, v152, v152, s48
v_pk_fma_f16 v148, v149, v149, s48
v_pk_fma_f16 v145, v146, v146, s48
v_pk_mul_f16 v154, v155, v154
v_lshrrev_b16 v136, 2, v137
v_pk_mul_f16 v151, v152, v151
v_fma_mix_f32 v163, v179, v179, v163 op_sel:[1,1,0] op_sel_hi:[1,1,0]
v_pk_mul_f16 v148, v149, v148
v_mfma_f32_32x32x16_bf16 v[120:135], v[100:103], v[236:239], v[120:135]
ds_read_b128 v[232:235], v245
ds_read_b128 v[208:211], v242 offset:64
ds_read_b128 v[212:215], v242
ds_read_u16_d16 v136, v136
v_pk_mul_f16 v145, v146, v145
v_exp_f16 v153, v154
v_lshrrev_b32 v137, 18, v137
v_exp_f16 v150, v151
v_fma_mix_f32 v163, v180, v180, v163 op_sel:[0,0,0] op_sel_hi:[1,1,0]
v_exp_f16 v147, v148
v_and_b32 v139, s49, v139
s_waitcnt lgkmcnt(5)
v_mfma_f32_32x32x16_bf16 v[120:135], v[104:107], v[216:219], v[120:135]
ds_read_b128 v[236:239], v249 offset:12288
ds_read_u16_d16_hi v137, v137
v_exp_f16 v144, v145
v_exp_f16_sdwa v153, v154 dst_sel:WORD_1 dst_unused:UNUSED_PRESERVE src0_sel:WORD_1
v_fma_mix_f32 v163, v181, v181, v163 op_sel:[1,1,0] op_sel_hi:[1,1,0]
v_lshrrev_b16 v138, 2, v139
v_exp_f16_sdwa v150, v151 dst_sel:WORD_1 dst_unused:UNUSED_PRESERVE src0_sel:WORD_1
v_exp_f16_sdwa v147, v148 dst_sel:WORD_1 dst_unused:UNUSED_PRESERVE src0_sel:WORD_1
v_mfma_f32_32x32x16_bf16 v[120:135], v[108:111], v[220:223], v[120:135]
ds_read_b128 v[216:219], v249 offset:15360
ds_read_u16_d16 v138, v138
v_exp_f16_sdwa v144, v145 dst_sel:WORD_1 dst_unused:UNUSED_PRESERVE src0_sel:WORD_1
v_lshrrev_b32 v139, 18, v139
v_fma_mix_f32 v163, v182, v182, v163 op_sel:[0,0,0] op_sel_hi:[1,1,0]
v_pk_add_f16 v153, v153, 1.0 op_sel_hi:[1,0]
v_pk_add_f16 v150, v150, 1.0 op_sel_hi:[1,0]
v_pk_add_f16 v147, v147, 1.0 op_sel_hi:[1,0]
v_and_b32 v141, s49, v141
v_pk_add_f16 v144, v144, 1.0 op_sel_hi:[1,0]
v_mfma_f32_32x32x16_bf16 v[120:135], v[112:115], v[224:227], v[120:135]
ds_read_b128 v[220:223], v249 offset:13312
ds_read_u16_d16_hi v139, v139
v_rcp_f16 v154, v153
v_fma_mix_f32 v163, v183, v183, v163 op_sel:[1,1,0] op_sel_hi:[1,1,0]
v_rcp_f16 v151, v150
v_lshrrev_b16 v140, 2, v141
v_rcp_f16 v148, v147
v_fma_mix_f32 v163, v184, v184, v163 op_sel:[0,0,0] op_sel_hi:[1,1,0]
s_waitcnt lgkmcnt(4)
v_mfma_f32_32x32x16_bf16 v[120:135], v[116:119], v[228:231], v[120:135]
ds_read_b128 v[224:227], v249 offset:16384
ds_read_u16_d16 v140, v140
v_rcp_f16 v145, v144
v_lshrrev_b32 v141, 18, v141
v_rcp_f16_sdwa v154, v153 dst_sel:WORD_1 dst_unused:UNUSED_PRESERVE src0_sel:WORD_1
s_setprio 0
v_rcp_f16_sdwa v151, v150 dst_sel:WORD_1 dst_unused:UNUSED_PRESERVE src0_sel:WORD_1
v_fma_mix_f32 v163, v185, v185, v163 op_sel:[1,1,0] op_sel_hi:[1,1,0]
v_and_b32 v143, s49, v143
v_rcp_f16_sdwa v148, v147 dst_sel:WORD_1 dst_unused:UNUSED_PRESERVE src0_sel:WORD_1
v_smfmac_f32_16x16x32_bf16 v[16:19], v[234:235], v[208:211], v246
ds_read_b128 v[228:231], v249 offset:14336
ds_read_u16_d16_hi v141, v141
v_rcp_f16_sdwa v145, v144 dst_sel:WORD_1 dst_unused:UNUSED_PRESERVE src0_sel:WORD_1
v_pk_mul_f16 v155, v155, v154
v_lshrrev_b16 v142, 2, v143
v_fma_mix_f32 v163, v186, v186, v163 op_sel:[0,0,0] op_sel_hi:[1,1,0]
v_smfmac_f32_16x16x32_bf16 v[0:3], v[232:233], v[212:215], v246
s_mov_b64 exec, 1
ds_add_u32 v253, v254 offset:16
s_mov_b64 exec, -1
v_pk_mul_f16 v152, v152, v151
v_pk_mul_f16 v149, v149, v148
v_pk_mul_f16 v146, v146, v145
v_fma_mix_f32 v164, v155, v155, v164 op_sel:[0,0,0] op_sel_hi:[1,1,0]
v_lshrrev_b32 v143, 18, v143
v_fma_mix_f32 v164, v155, v155, v164 op_sel:[1,1,0] op_sel_hi:[1,1,0]
v_fma_mix_f32 v164, v152, v152, v164 op_sel:[0,0,0] op_sel_hi:[1,1,0]
v_fma_mix_f32 v163, v187, v187, v163 op_sel:[1,1,0] op_sel_hi:[1,1,0]
v_fma_mix_f32 v164, v152, v152, v164 op_sel:[1,1,0] op_sel_hi:[1,1,0]
v_fma_mix_f32 v164, v149, v149, v164 op_sel:[0,0,0] op_sel_hi:[1,1,0]
v_fma_mix_f32 v164, v149, v149, v164 op_sel:[1,1,0] op_sel_hi:[1,1,0]
v_fma_mix_f32 v164, v146, v146, v164 op_sel:[0,0,0] op_sel_hi:[1,1,0]
v_fma_mix_f32 v164, v146, v146, v164 op_sel:[1,1,0] op_sel_hi:[1,1,0]
s_setprio 3
v_pk_add_f32 v[168:169], v[0:1], v[2:3]
v_pk_mul_f32 v[170:171], v[0:1], v[0:1]
v_pk_fma_f32 v[170:171], v[2:3], v[2:3], v[170:171]
v_pk_add_f32 v[168:169], v[168:169], v[4:5]
v_pk_fma_f32 v[170:171], v[4:5], v[4:5], v[170:171]
v_pk_add_f32 v[168:169], v[168:169], v[6:7]
v_pk_fma_f32 v[170:171], v[6:7], v[6:7], v[170:171]
v_pk_add_f32 v[168:169], v[168:169], v[8:9]
v_pk_fma_f32 v[170:171], v[8:9], v[8:9], v[170:171]
v_pk_add_f32 v[168:169], v[168:169], v[10:11]
v_pk_fma_f32 v[170:171], v[10:11], v[10:11], v[170:171]
v_pk_add_f32 v[168:169], v[168:169], v[12:13]
v_pk_fma_f32 v[170:171], v[12:13], v[12:13], v[170:171]
v_pk_add_f32 v[168:169], v[168:169], v[14:15]
v_pk_fma_f32 v[170:171], v[14:15], v[14:15], v[170:171]
v_pk_add_f32 v[168:169], v[168:169], v[16:17]
v_pk_fma_f32 v[170:171], v[16:17], v[16:17], v[170:171]
v_pk_add_f32 v[168:169], v[168:169], v[18:19]
v_pk_fma_f32 v[170:171], v[18:19], v[18:19], v[170:171]
v_pk_add_f32 v[168:169], v[168:169], v[20:21]
v_pk_fma_f32 v[170:171], v[20:21], v[20:21], v[170:171]
v_pk_add_f32 v[168:169], v[168:169], v[22:23]
v_pk_fma_f32 v[170:171], v[22:23], v[22:23], v[170:171]
v_pk_add_f32 v[168:169], v[168:169], v[24:25]
v_pk_fma_f32 v[170:171], v[24:25], v[24:25], v[170:171]
v_pk_add_f32 v[168:169], v[168:169], v[26:27]
v_pk_fma_f32 v[170:171], v[26:27], v[26:27], v[170:171]
v_pk_add_f32 v[168:169], v[168:169], v[28:29]
v_pk_fma_f32 v[170:171], v[28:29], v[28:29], v[170:171]
v_pk_add_f32 v[168:169], v[168:169], v[30:31]
v_pk_fma_f32 v[170:171], v[30:31], v[30:31], v[170:171]
v_pk_add_f32 v[168:169], v[168:169], v[32:33]
v_pk_fma_f32 v[170:171], v[32:33], v[32:33], v[170:171]
v_pk_add_f32 v[168:169], v[168:169], v[34:35]
v_pk_fma_f32 v[170:171], v[34:35], v[34:35], v[170:171]
v_pk_add_f32 v[168:169], v[168:169], v[36:37]
v_pk_fma_f32 v[170:171], v[36:37], v[36:37], v[170:171]
v_pk_add_f32 v[168:169], v[168:169], v[38:39]
v_pk_fma_f32 v[170:171], v[38:39], v[38:39], v[170:171]
v_pk_add_f32 v[168:169], v[168:169], v[40:41]
v_pk_fma_f32 v[170:171], v[40:41], v[40:41], v[170:171]
v_pk_add_f32 v[168:169], v[168:169], v[42:43]
v_pk_fma_f32 v[170:171], v[42:43], v[42:43], v[170:171]
v_pk_add_f32 v[168:169], v[168:169], v[44:45]
v_pk_fma_f32 v[170:171], v[44:45], v[44:45], v[170:171]
v_pk_add_f32 v[168:169], v[168:169], v[46:47]
v_pk_fma_f32 v[170:171], v[46:47], v[46:47], v[170:171]
s_setprio 0
v_lshrrev_b32 v252, 2, v251
v_mul_u32_u24 v252, 192, v252
v_and_b32 v240, 3, v251
v_lshl_add_u32 v252, v240, 4, v252
s_setprio 2
v_cvt_pkrtz_f16_f32 v179, v120, v121
v_cvt_pkrtz_f16_f32 v181, v122, v123
v_cvt_pkrtz_f16_f32 v183, v124, v125
v_cvt_pkrtz_f16_f32 v185, v126, v127
v_cvt_pkrtz_f16_f32 v187, v128, v129
v_cvt_pkrtz_f16_f32 v189, v130, v131
v_cvt_pk_f16_f32 v155, v132, v133
v_cvt_pk_f16_f32 v152, v134, v135
ds_read_b128 v[232:235], v249 offset:17408
ds_read_u16_d16 v142, v142
ds_read_u16_d16_hi v143, v143
v_mfma_f32_32x32x16_bf16 v[120:135], v[96:99], v[236:239], 0
v_pk_fma_f16 v154, v155, v155, s48
v_add_f32 v168, v168, v169
v_and_b32 v179, s49, v179
v_fma_mix_f32 v164, v136, v136, v164 op_sel:[0,0,0] op_sel_hi:[1,1,0]
v_lshrrev_b16 v178, 2, v179
v_pk_fma_f16 v151, v152, v152, s48
v_add_f32 v170, v170, v171
v_pk_mul_f16 v154, v155, v154
v_lshrrev_b32 v179, 18, v179
v_pk_mul_f16 v151, v152, v151
v_fma_mix_f32 v164, v137, v137, v164 op_sel:[1,1,0] op_sel_hi:[1,1,0]
v_and_b32 v181, s49, v181
s_waitcnt lgkmcnt(4)
ds_read_u16_d16 v178, v178
ds_read_u16_d16_hi v179, v179
v_mfma_f32_32x32x16_bf16 v[120:135], v[100:103], v[216:219], v[120:135]
v_permlane32_swap_b32 v168, v170
v_exp_f16 v153, v154
v_lshrrev_b16 v180, 2, v181
v_exp_f16 v150, v151
v_add_f32 v168, v168, v170
v_lshrrev_b32 v181, 18, v181
v_fma_mix_f32 v164, v138, v138, v164 op_sel:[0,0,0] op_sel_hi:[1,1,0]
v_and_b32 v183, s49, v183
v_exp_f16_sdwa v153, v154 dst_sel:WORD_1 dst_unused:UNUSED_PRESERVE src0_sel:WORD_1
ds_read_u16_d16 v180, v180
ds_read_u16_d16_hi v181, v181
v_mfma_f32_32x32x16_bf16 v[120:135], v[104:107], v[220:223], v[120:135]
v_mul_f32 v168, 1009429163, v168
v_lshrrev_b16 v182, 2, v183
v_fma_mix_f32 v164, v139, v139, v164 op_sel:[1,1,0] op_sel_hi:[1,1,0]
v_exp_f16_sdwa v150, v151 dst_sel:WORD_1 dst_unused:UNUSED_PRESERVE src0_sel:WORD_1
v_mov_b32 v170, v168
v_lshrrev_b32 v183, 18, v183
v_pk_add_f16 v153, v153, 1.0 op_sel_hi:[1,0]
v_and_b32 v185, s49, v185
v_fma_mix_f32 v164, v140, v140, v164 op_sel:[0,0,0] op_sel_hi:[1,1,0]
v_lshrrev_b16 v184, 2, v185
v_permlane32_swap_b32 v168, v170
v_pk_add_f16 v150, v150, 1.0 op_sel_hi:[1,0]
ds_read_u16_d16 v182, v182
ds_read_u16_d16_hi v183, v183
ds_read_u16_d16 v184, v184
v_mfma_f32_32x32x16_bf16 v[120:135], v[108:111], v[224:227], v[120:135]
v_rcp_f16 v154, v153
v_lshrrev_b32 v185, 18, v185
v_fma_mix_f32 v164, v141, v141, v164 op_sel:[1,1,0] op_sel_hi:[1,1,0]
v_fma_f32 v170, -v168, v168, v170
v_and_b32 v187, s49, v187
v_rcp_f16 v151, v150
v_lshrrev_b16 v186, 2, v187
v_max_f32 v170, 0, v170
v_rcp_f16_sdwa v154, v153 dst_sel:WORD_1 dst_unused:UNUSED_PRESERVE src0_sel:WORD_1
ds_read_b128 v[224:227], v249 offset:18432
ds_read_u16_d16_hi v185, v185
ds_read_u16_d16 v186, v186
v_mfma_f32_32x32x16_bf16 v[120:135], v[112:115], v[228:231], v[120:135]
v_lshrrev_b32 v187, 18, v187
s_waitcnt lgkmcnt(6)
v_fma_mix_f32 v164, v142, v142, v164 op_sel:[0,0,0] op_sel_hi:[1,1,0]
v_and_b32 v189, s49, v189
v_add_f32 v170, 925353388, v170
v_rcp_f16_sdwa v151, v150 dst_sel:WORD_1 dst_unused:UNUSED_PRESERVE src0_sel:WORD_1
v_lshrrev_b16 v188, 2, v189
v_fma_mix_f32 v164, v143, v143, v164 op_sel:[1,1,0] op_sel_hi:[1,1,0]
v_pk_mul_f16 v155, v155, v154
v_rsq_f32 v170, v170
v_lshrrev_b32 v189, 18, v189
ds_read_b128 v[228:231], v249 offset:21504
ds_read_u16_d16_hi v187, v187
ds_read_b32 v247, v253 offset:16
ds_read_u16_d16 v188, v188
ds_read_u16_d16_hi v189, v189
v_mfma_f32_32x32x16_bf16 v[120:135], v[116:119], v[232:235], v[120:135]
v_pk_mul_f16 v152, v152, v151
v_fma_mix_f32 v165, v155, v155, v165 op_sel:[0,0,0] op_sel_hi:[1,1,0]
v_fma_mix_f32 v165, v178, v178, v165 op_sel:[0,0,0] op_sel_hi:[1,1,0]
v_fma_mix_f32 v165, v179, v179, v165 op_sel:[1,1,0] op_sel_hi:[1,1,0]
v_fma_mix_f32 v165, v180, v180, v165 op_sel:[0,0,0] op_sel_hi:[1,1,0]
v_fma_mix_f32 v165, v155, v155, v165 op_sel:[1,1,0] op_sel_hi:[1,1,0]
v_fma_mix_f32 v165, v181, v181, v165 op_sel:[1,1,0] op_sel_hi:[1,1,0]
s_waitcnt lgkmcnt(5)
v_fma_mix_f32 v165, v182, v182, v165 op_sel:[0,0,0] op_sel_hi:[1,1,0]
v_mul_f32 v172, 3203391086, v170
v_fma_mix_f32 v165, v183, v183, v165 op_sel:[1,1,0] op_sel_hi:[1,1,0]
v_fma_mix_f32 v165, v152, v152, v165 op_sel:[0,0,0] op_sel_hi:[1,1,0]
v_fma_mix_f32 v165, v184, v184, v165 op_sel:[0,0,0] op_sel_hi:[1,1,0]
v_fma_mix_f32 v165, v185, v185, v165 op_sel:[1,1,0] op_sel_hi:[1,1,0]
v_fma_mix_f32 v165, v186, v186, v165 op_sel:[0,0,0] op_sel_hi:[1,1,0]
v_mul_f32 v173, v168, v172
v_fma_mix_f32 v165, v152, v152, v165 op_sel:[1,1,0] op_sel_hi:[1,1,0]
s_waitcnt lgkmcnt(3)
v_fma_mix_f32 v165, v187, v187, v165 op_sel:[1,1,0] op_sel_hi:[1,1,0]
s_waitcnt lgkmcnt(1)
v_fma_mix_f32 v165, v188, v188, v165 op_sel:[0,0,0] op_sel_hi:[1,1,0]
s_waitcnt lgkmcnt(0)
v_fma_mix_f32 v165, v189, v189, v165 op_sel:[1,1,0] op_sel_hi:[1,1,0]
s_setprio 3
v_pk_fma_f32 v[0:1], v[0:1], v[172:173], v[172:173] op_sel:[0,0,1] op_sel_hi:[1,0,1] neg_lo:[0,0,1] neg_hi:[0,0,1]
v_pk_fma_f32 v[2:3], v[2:3], v[172:173], v[172:173] op_sel:[0,0,1] op_sel_hi:[1,0,1] neg_lo:[0,0,1] neg_hi:[0,0,1]
v_pk_fma_f32 v[4:5], v[4:5], v[172:173], v[172:173] op_sel:[0,0,1] op_sel_hi:[1,0,1] neg_lo:[0,0,1] neg_hi:[0,0,1]
v_pk_fma_f32 v[6:7], v[6:7], v[172:173], v[172:173] op_sel:[0,0,1] op_sel_hi:[1,0,1] neg_lo:[0,0,1] neg_hi:[0,0,1]
v_pk_fma_f32 v[8:9], v[8:9], v[172:173], v[172:173] op_sel:[0,0,1] op_sel_hi:[1,0,1] neg_lo:[0,0,1] neg_hi:[0,0,1]
v_pk_fma_f32 v[10:11], v[10:11], v[172:173], v[172:173] op_sel:[0,0,1] op_sel_hi:[1,0,1] neg_lo:[0,0,1] neg_hi:[0,0,1]
v_pk_fma_f32 v[12:13], v[12:13], v[172:173], v[172:173] op_sel:[0,0,1] op_sel_hi:[1,0,1] neg_lo:[0,0,1] neg_hi:[0,0,1]
v_pk_fma_f32 v[14:15], v[14:15], v[172:173], v[172:173] op_sel:[0,0,1] op_sel_hi:[1,0,1] neg_lo:[0,0,1] neg_hi:[0,0,1]
v_pk_fma_f32 v[16:17], v[16:17], v[172:173], v[172:173] op_sel:[0,0,1] op_sel_hi:[1,0,1] neg_lo:[0,0,1] neg_hi:[0,0,1]
v_pk_fma_f32 v[18:19], v[18:19], v[172:173], v[172:173] op_sel:[0,0,1] op_sel_hi:[1,0,1] neg_lo:[0,0,1] neg_hi:[0,0,1]
v_pk_fma_f32 v[20:21], v[20:21], v[172:173], v[172:173] op_sel:[0,0,1] op_sel_hi:[1,0,1] neg_lo:[0,0,1] neg_hi:[0,0,1]
v_pk_fma_f32 v[22:23], v[22:23], v[172:173], v[172:173] op_sel:[0,0,1] op_sel_hi:[1,0,1] neg_lo:[0,0,1] neg_hi:[0,0,1]
v_pk_fma_f32 v[24:25], v[24:25], v[172:173], v[172:173] op_sel:[0,0,1] op_sel_hi:[1,0,1] neg_lo:[0,0,1] neg_hi:[0,0,1]
v_pk_fma_f32 v[26:27], v[26:27], v[172:173], v[172:173] op_sel:[0,0,1] op_sel_hi:[1,0,1] neg_lo:[0,0,1] neg_hi:[0,0,1]
v_pk_fma_f32 v[28:29], v[28:29], v[172:173], v[172:173] op_sel:[0,0,1] op_sel_hi:[1,0,1] neg_lo:[0,0,1] neg_hi:[0,0,1]
v_pk_fma_f32 v[30:31], v[30:31], v[172:173], v[172:173] op_sel:[0,0,1] op_sel_hi:[1,0,1] neg_lo:[0,0,1] neg_hi:[0,0,1]
v_pk_fma_f32 v[32:33], v[32:33], v[172:173], v[172:173] op_sel:[0,0,1] op_sel_hi:[1,0,1] neg_lo:[0,0,1] neg_hi:[0,0,1]
v_pk_fma_f32 v[34:35], v[34:35], v[172:173], v[172:173] op_sel:[0,0,1] op_sel_hi:[1,0,1] neg_lo:[0,0,1] neg_hi:[0,0,1]
v_pk_fma_f32 v[36:37], v[36:37], v[172:173], v[172:173] op_sel:[0,0,1] op_sel_hi:[1,0,1] neg_lo:[0,0,1] neg_hi:[0,0,1]
v_pk_fma_f32 v[38:39], v[38:39], v[172:173], v[172:173] op_sel:[0,0,1] op_sel_hi:[1,0,1] neg_lo:[0,0,1] neg_hi:[0,0,1]
v_pk_fma_f32 v[40:41], v[40:41], v[172:173], v[172:173] op_sel:[0,0,1] op_sel_hi:[1,0,1] neg_lo:[0,0,1] neg_hi:[0,0,1]
v_pk_fma_f32 v[42:43], v[42:43], v[172:173], v[172:173] op_sel:[0,0,1] op_sel_hi:[1,0,1] neg_lo:[0,0,1] neg_hi:[0,0,1]
v_pk_fma_f32 v[44:45], v[44:45], v[172:173], v[172:173] op_sel:[0,0,1] op_sel_hi:[1,0,1] neg_lo:[0,0,1] neg_hi:[0,0,1]
v_pk_fma_f32 v[46:47], v[46:47], v[172:173], v[172:173] op_sel:[0,0,1] op_sel_hi:[1,0,1] neg_lo:[0,0,1] neg_hi:[0,0,1]
s_setprio 2
v_readfirstlane_b32 s43, v247
s_nop 1
s_cmp_ge_u32 s43, 32
s_cbranch_scc1 Lev9
Lev9w:
s_sleep 1
ds_read_b32 v247, v253 offset:16
s_waitcnt lgkmcnt(0)
v_readfirstlane_b32 s43, v247
s_cmp_eq_u32 s76, 0
s_cbranch_scc1 Lev9
s_sub_u32 s76, s76, 1
s_cmp_lt_u32 s43, 32
s_cbranch_scc1 Lev9w
Lev9:
s_setprio 1
v_cvt_pkrtz_f16_f32 v137, v120, v121
v_cvt_pkrtz_f16_f32 v139, v122, v123
v_cvt_pkrtz_f16_f32 v141, v124, v125
v_cvt_pkrtz_f16_f32 v143, v126, v127
v_cvt_pkrtz_f16_f32 v145, v128, v129
v_cvt_pkrtz_f16_f32 v147, v130, v131
v_cvt_pk_f16_f32 v155, v132, v133
v_cvt_pk_f16_f32 v152, v134, v135
s_add_u32 m0, s72, 0
s_add_u32 s43, s82, 0
buffer_load_dwordx4 v252, s[16:19], s43 offen lds
ds_read_b128 v[232:235], v249 offset:19456
ds_read_b128 v[236:239], v249 offset:22528
v_mfma_f32_32x32x16_bf16 v[120:135], v[224:227], v[96:99], 0
v_pk_fma_f16 v154, v155, v155, s48
v_and_b32 v192, 1, v251
v_cvt_pk_bf16_f32 v168, v0, v1
v_and_b32 v137, s49, v137
v_pk_fma_f16 v151, v152, v152, s48
v_cvt_pk_bf16_f32 v169, v2, v3
v_lshlrev_b32 v192, 4, v192
v_and_b32 v139, s49, v139
v_pk_mul_f16 v154, v155, v154
v_cvt_pk_bf16_f32 v170, v4, v5
v_lshrrev_b16 v136, 2, v137
v_mov_b32 v193, 15360
v_pk_mul_f16 v151, v152, v151
v_lshrrev_b16 v138, 2, v139
v_cvt_pk_bf16_f32 v171, v6, v7
ds_read_b128 v[224:227], v249 offset:20480
ds_read_u16_d16 v136, v136
ds_read_u16_d16 v138, v138
v_mfma_f32_32x32x16_bf16 v[120:135], v[228:231], v[100:103], v[120:135]
v_exp_f16 v153, v154
v_lshlrev_b32 v192, v192, v193
v_cvt_pk_bf16_f32 v172, v8, v9
v_lshrrev_b32 v137, 18, v137
v_exp_f16 v150, v151
v_lshrrev_b32 v193, 3, v251
v_cvt_pk_bf16_f32 v173, v10, v11
v_lshrrev_b32 v139, 18, v139
v_and_b32 v141, s49, v141
v_xor_b32 v193, v193, v251
v_cvt_pk_bf16_f32 v174, v12, v13
v_exp_f16_sdwa v153, v154 dst_sel:WORD_1 dst_unused:UNUSED_PRESERVE src0_sel:WORD_1
v_cvt_pk_bf16_f32 v175, v14, v15
v_and_b32 v193, 4, v193
s_waitcnt lgkmcnt(3)
s_add_u32 m0, s72, 1024
s_add_u32 s43, s82, 64
buffer_load_dwordx4 v252, s[16:19], s43 offen lds
ds_read_b128 v[228:231], v249 offset:23552
ds_read_u16_d16_hi v137, v137
ds_read_u16_d16_hi v139, v139
v_mfma_f32_32x32x16_bf16 v[120:135], v[232:235], v[104:107], v[120:135]
v_and_b32 v143, s49, v143
v_lshrrev_b16 v140, 2, v141
v_exp_f16_sdwa v150, v151 dst_sel:WORD_1 dst_unused:UNUSED_PRESERVE src0_sel:WORD_1
v_bfe_u32 v194, v251, 3, 2
v_cvt_pk_bf16_f32 v176, v16, v17
v_lshrrev_b16 v142, 2, v143
v_cvt_pk_bf16_f32 v177, v18, v19
v_pk_add_f16 v153, v153, 1.0 op_sel_hi:[1,0]
v_lshl_add_u32 v193, v193, 1, 0
v_lshrrev_b32 v141, 18, v141
v_pk_add_f16 v150, v150, 1.0 op_sel_hi:[1,0]
v_cvt_pk_bf16_f32 v178, v20, v21
v_lshrrev_b32 v143, 18, v143
v_lshl_add_u32 v193, v194, 1, v193
ds_read_b128 v[232:235], v248 offset:16384
ds_read_u16_d16 v140, v140
ds_read_u16_d16 v142, v142
ds_read_u16_d16_hi v141, v141
ds_read_u16_d16_hi v143, v143
v_mfma_f32_32x32x16_bf16 v[120:135], v[236:239], v[108:111], v[120:135]
v_rcp_f16 v154, v153
v_cvt_pk_bf16_f32 v179, v22, v23
v_and_b32 v145, s49, v145
v_and_b32 v147, s49, v147
v_bfe_u32 v194, v251, 1, 1
v_cvt_pk_bf16_f32 v180, v24, v25
v_rcp_f16 v151, v150
v_cvt_pk_bf16_f32 v181, v26, v27
v_add_u32 v193, v193, v194
v_lshrrev_b16 v144, 2, v145
v_rcp_f16_sdwa v154, v153 dst_sel:WORD_1 dst_unused:UNUSED_PRESERVE src0_sel:WORD_1
v_cvt_pk_bf16_f32 v182, v28, v29
v_cmp_eq_u32 vcc, 0, v193
s_nop 1
v_cndmask_b32 v240, 0, v192, vcc
v_lshrrev_b16 v146, 2, v147
s_waitcnt lgkmcnt(5)
s_add_u32 m0, s72, 2048
s_add_u32 s43, s82, 128
buffer_load_dwordx4 v252, s[16:19], s43 offen lds
ds_read_b128 v[236:239], v248 offset:19456
ds_read_u16_d16 v144, v144
ds_read_u16_d16 v146, v146
v_mfma_f32_32x32x16_bf16 v[120:135], v[224:227], v[112:115], v[120:135]
v_lshrrev_b32 v145, 18, v145
v_cvt_pk_bf16_f32 v183, v30, v31
v_rcp_f16_sdwa v151, v150 dst_sel:WORD_1 dst_unused:UNUSED_PRESERVE src0_sel:WORD_1
v_cmp_eq_u32 vcc, 1, v193
s_nop 1
v_cndmask_b32 v241, 0, v192, vcc
v_cvt_pk_bf16_f32 v184, v32, v33
s_setprio 0
v_lshrrev_b32 v147, 18, v147
v_pk_mul_f16 v155, v155, v154
v_cmp_eq_u32 vcc, 2, v193
s_nop 1
v_cndmask_b32 v242, 0, v192, vcc
v_fma_mix_f32 v166, v136, v136, v166 op_sel:[0,0,0] op_sel_hi:[1,1,0]
v_cvt_pk_bf16_f32 v185, v34, v35
v_fma_mix_f32 v166, v137, v137, v166 op_sel:[1,1,0] op_sel_hi:[1,1,0]
v_pk_mul_f16 v152, v152, v151
v_cmp_eq_u32 vcc, 3, v193
s_nop 1
v_cndmask_b32 v243, 0, v192, vcc
v_cvt_pk_bf16_f32 v186, v36, v37
v_fma_mix_f32 v166, v138, v138, v166 op_sel:[0,0,0] op_sel_hi:[1,1,0]
ds_read_b128 v[224:227], v248 offset:17408
ds_read_u16_d16_hi v145, v145
ds_read_u16_d16_hi v147, v147
v_mfma_f32_32x32x16_bf16 v[120:135], v[228:231], v[116:119], v[120:135]
v_fma_mix_f32 v166, v139, v139, v166 op_sel:[1,1,0] op_sel_hi:[1,1,0]
v_cvt_pk_bf16_f32 v187, v38, v39
v_cmp_eq_u32 vcc, 4, v193
s_nop 1
v_cndmask_b32 v244, 0, v192, vcc
v_fma_mix_f32 v166, v155, v155, v166 op_sel:[0,0,0] op_sel_hi:[1,1,0]
s_waitcnt lgkmcnt(3)
v_fma_mix_f32 v166, v140, v140, v166 op_sel:[0,0,0] op_sel_hi:[1,1,0]
v_fma_mix_f32 v166, v141, v141, v166 op_sel:[1,1,0] op_sel_hi:[1,1,0]
v_cvt_pk_bf16_f32 v188, v40, v41
v_cmp_eq_u32 vcc, 5, v193
s_nop 1
v_cndmask_b32 v245, 0, v192, vcc
v_fma_mix_f32 v166, v155, v155, v166 op_sel:[1,1,0] op_sel_hi:[1,1,0]
v_fma_mix_f32 v166, v142, v142, v166 op_sel:[0,0,0] op_sel_hi:[1,1,0]
v_cvt_pk_bf16_f32 v189, v42, v43
v_fma_mix_f32 v166, v143, v143, v166 op_sel:[1,1,0] op_sel_hi:[1,1,0]
v_cmp_eq_u32 vcc, 6, v193
s_nop 1
v_cndmask_b32 v246, 0, v192, vcc
v_fma_mix_f32 v166, v152, v152, v166 op_sel:[0,0,0] op_sel_hi:[1,1,0]
v_fma_mix_f32 v166, v144, v144, v166 op_sel:[0,0,0] op_sel_hi:[1,1,0]
v_cvt_pk_bf16_f32 v190, v44, v45
s_waitcnt lgkmcnt(0)
v_fma_mix_f32 v166, v145, v145, v166 op_sel:[1,1,0] op_sel_hi:[1,1,0]
v_cmp_eq_u32 vcc, 7, v193
s_nop 1
v_cndmask_b32 v247, 0, v192, vcc
v_fma_mix_f32 v166, v152, v152, v166 op_sel:[1,1,0] op_sel_hi:[1,1,0]
v_cvt_pk_bf16_f32 v191, v46, v47
v_fma_mix_f32 v166, v146, v146, v166 op_sel:[0,0,0] op_sel_hi:[1,1,0]
v_fma_mix_f32 v166, v147, v147, v166 op_sel:[1,1,0] op_sel_hi:[1,1,0]
s_setprio 2
v_cvt_pkrtz_f16_f32 v137, v120, v121
v_cvt_pkrtz_f16_f32 v139, v122, v123
v_cvt_pkrtz_f16_f32 v141, v124, v125
v_cvt_pkrtz_f16_f32 v143, v126, v127
v_cvt_pkrtz_f16_f32 v145, v128, v129
v_cvt_pk_f16_f32 v155, v130, v131
v_cvt_pk_f16_f32 v152, v132, v133
v_cvt_pk_f16_f32 v149, v134, v135
s_add_u32 m0, s72, 3072
s_add_u32 s43, s82, 3072
buffer_load_dwordx4 v252, s[16:19], s43 offen lds
ds_read_b128 v[228:231], v248 offset:20480
v_mfma_f32_32x32x16_bf16 v[120:135], v[232:235], v[168:171], 0
v_pk_fma_f16 v154, v155, v155, s48
v_mov_b32 v88, v48
v_and_b32 v137, s49, v137
v_pk_fma_f16 v151, v152, v152, s48
v_and_b32 v139, s49, v139
v_pk_fma_f16 v148, v149, v149, s48
v_pk_mul_f16 v154, v155, v154
v_lshrrev_b16 v136, 2, v137
v_pk_mul_f16 v151, v152, v151
ds_read_b128 v[232:235], v248 offset:18432
ds_read_u16_d16 v136, v136
v_mfma_f32_32x32x16_bf16 v[120:135], v[236:239], v[172:175], v[120:135]
v_mov_b32 v89, v49
v_pk_mul_f16 v148, v149, v148
v_lshrrev_b16 v138, 2, v139
v_exp_f16 v153, v154
v_lshrrev_b32 v137, 18, v137
v_exp_f16 v150, v151
v_mov_b32 v90, v50
v_lshrrev_b32 v139, 18, v139
s_add_u32 m0, s72, 4096
s_add_u32 s43, s82, 3136
buffer_load_dwordx4 v252, s[16:19], s43 offen lds
ds_read_b128 v[236:239], v248 offset:21504
ds_read_u16_d16 v138, v138
ds_read_u16_d16_hi v137, v137
ds_read_u16_d16_hi v139, v139
v_mfma_f32_32x32x16_bf16 v[120:135], v[224:227], v[176:179], v[120:135]
v_exp_f16 v147, v148
v_and_b32 v141, s49, v141
v_and_b32 v143, s49, v143
v_exp_f16_sdwa v153, v154 dst_sel:WORD_1 dst_unused:UNUSED_PRESERVE src0_sel:WORD_1
v_mov_b32 v91, v51
v_lshrrev_b16 v140, 2, v141
s_waitcnt lgkmcnt(5)
ds_read_b128 v[224:227], v248 offset:22528
ds_read_u16_d16 v140, v140
v_mfma_f32_32x32x16_bf16 v[120:135], v[228:231], v[180:183], v[120:135]
v_exp_f16_sdwa v150, v151 dst_sel:WORD_1 dst_unused:UNUSED_PRESERVE src0_sel:WORD_1
v_lshrrev_b16 v142, 2, v143
v_exp_f16_sdwa v147, v148 dst_sel:WORD_1 dst_unused:UNUSED_PRESERVE src0_sel:WORD_1
v_lshrrev_b32 v141, 18, v141
v_mov_b32 v92, v52
v_pk_add_f16 v153, v153, 1.0 op_sel_hi:[1,0]
v_lshrrev_b32 v143, 18, v143
v_pk_add_f16 v150, v150, 1.0 op_sel_hi:[1,0]
v_pk_add_f16 v147, v147, 1.0 op_sel_hi:[1,0]
s_add_u32 m0, s72, 5120
s_add_u32 s43, s82, 3200
buffer_load_dwordx4 v252, s[16:19], s43 offen lds
ds_read_b128 v[228:231], v248 offset:25600
ds_read_u16_d16 v142, v142
ds_read_u16_d16_hi v141, v141
ds_read_u16_d16_hi v143, v143
v_mfma_f32_32x32x16_bf16 v[120:135], v[232:235], v[184:187], v[120:135]
v_and_b32 v145, s49, v145
v_rcp_f16 v154, v153
v_mov_b32 v93, v53
v_lshrrev_b16 v144, 2, v145
v_rcp_f16 v151, v150
v_lshrrev_b32 v145, 18, v145
v_rcp_f16 v148, v147
s_waitcnt lgkmcnt(4)
ds_read_b128 v[232:235], v248 offset:23552
ds_read_u16_d16 v144, v144
ds_read_u16_d16_hi v145, v145
v_mfma_f32_32x32x16_bf16 v[120:135], v[236:239], v[188:191], v[120:135]
v_or_b32 v216, v136, v137
v_mov_b32 v94, v54
v_or_b32 v217, v138, v139
v_rcp_f16_sdwa v154, v153 dst_sel:WORD_1 dst_unused:UNUSED_PRESERVE src0_sel:WORD_1
s_waitcnt lgkmcnt(4)
v_or_b32 v218, v140, v141
v_rcp_f16_sdwa v151, v150 dst_sel:WORD_1 dst_unused:UNUSED_PRESERVE src0_sel:WORD_1
s_waitcnt lgkmcnt(3)
v_or_b32 v219, v142, v143
v_mov_b32 v95, v55
v_rcp_f16_sdwa v148, v147 dst_sel:WORD_1 dst_unused:UNUSED_PRESERVE src0_sel:WORD_1
s_waitcnt lgkmcnt(0)
v_or_b32 v220, v144, v145
v_pk_mul_f16 v221, v155, v154
v_pk_mul_f16 v222, v152, v151
v_pk_mul_f16 v223, v149, v148
s_cmp_lg_u32 s40, 0
s_cbranch_scc1 Lrs0
v_mov_b32 v82, 0
buffer_load_dword v83, v82, s[36:39], 0 offen sc1
Lrs0:
s_setprio 1
s_add_u32 m0, s72, 6144
s_add_u32 s43, s82, 6144
buffer_load_dwordx4 v252, s[16:19], s43 offen lds
ds_read_b128 v[236:239], v248 offset:26624
v_mfma_f32_32x32x16_f16 v[192:207], v[216:219], v[240:243], 0
v_cvt_pkrtz_f16_f32 v137, v120, v121
v_cvt_pkrtz_f16_f32 v139, v122, v123
v_cvt_pkrtz_f16_f32 v141, v124, v125
v_cvt_pkrtz_f16_f32 v143, v126, v127
v_cvt_pkrtz_f16_f32 v145, v128, v129
v_mfma_f32_32x32x16_f16 v[192:207], v[220:223], v[244:247], v[192:207]
v_cvt_pk_f16_f32 v155, v130, v131
v_cvt_pk_f16_f32 v152, v132, v133
v_cvt_pk_f16_f32 v149, v134, v135
v_pk_fma_f16 v154, v155, v155, s48
v_mov_b32 v208, v56
v_and_b32 v255, 51, v251
v_mfma_f32_32x32x16_bf16 v[120:135], v[224:227], v[168:171], 0
v_and_b32 v137, s49, v137
v_pk_fma_f16 v151, v152, v152, s48
v_and_b32 v139, s49, v139
v_pk_fma_f16 v148, v149, v149, s48
v_pk_mul_f16 v154, v155, v154
v_lshrrev_b16 v136, 2, v137
v_pk_mul_f16 v151, v152, v151
v_pk_mul_f16 v148, v149, v148
v_mov_b32 v209, v57
v_lshrrev_b16 v138, 2, v139
ds_read_b128 v[224:227], v248 offset:24576
ds_read_u16_d16 v136, v136
ds_read_u16_d16 v138, v138
v_mfma_f32_32x32x16_bf16 v[120:135], v[228:231], v[172:175], v[120:135]
v_exp_f16 v153, v154
v_bfe_u32 v87, v251, 2, 1
v_lshrrev_b32 v137, 18, v137
v_exp_f16 v150, v151
v_lshrrev_b32 v139, 18, v139
v_exp_f16 v147, v148
v_mov_b32 v210, v58
v_and_b32 v141, s49, v141
v_and_b32 v143, s49, v143
ds_read_b128 v[228:231], v248 offset:27648
ds_read_u16_d16_hi v137, v137
ds_read_u16_d16_hi v139, v139
v_mfma_f32_32x32x16_bf16 v[120:135], v[232:235], v[176:179], v[120:135]
v_exp_f16_sdwa v153, v154 dst_sel:WORD_1 dst_unused:UNUSED_PRESERVE src0_sel:WORD_1
v_lshrrev_b16 v140, 2, v141
v_lshl_add_u32 v255, v87, 3, v255
v_exp_f16_sdwa v150, v151 dst_sel:WORD_1 dst_unused:UNUSED_PRESERVE src0_sel:WORD_1
v_mov_b32 v211, v59
v_lshrrev_b16 v142, 2, v143
v_exp_f16_sdwa v147, v148 dst_sel:WORD_1 dst_unused:UNUSED_PRESERVE src0_sel:WORD_1
v_lshrrev_b32 v141, 18, v141
s_waitcnt lgkmcnt(5)
ds_read_b128 v[232:235], v248 offset:28672
ds_read_u16_d16 v140, v140
ds_read_u16_d16 v142, v142
ds_read_u16_d16_hi v141, v141
v_mfma_f32_32x32x16_bf16 v[120:135], v[236:239], v[180:183], v[120:135]
v_pk_add_f16 v153, v153, 1.0 op_sel_hi:[1,0]
v_lshrrev_b32 v143, 18, v143
v_pk_add_f16 v150, v150, 1.0 op_sel_hi:[1,0]
v_pk_add_f16 v147, v147, 1.0 op_sel_hi:[1,0]
v_and_b32 v145, s49, v145
v_mov_b32 v212, v60
v_bfe_u32 v87, v251, 3, 1
v_rcp_f16 v154, v153
v_lshrrev_b16 v144, 2, v145
ds_read_b128 v[236:239], v248 offset:31744
ds_read_u16_d16_hi v143, v143
ds_read_u16_d16 v144, v144
v_mfma_f32_32x32x16_bf16 v[120:135], v[224:227], v[184:187], v[120:135]
v_rcp_f16 v151, v150
v_lshrrev_b32 v145, 18, v145
v_rcp_f16 v148, v147
v_mov_b32 v213, v61
s_waitcnt lgkmcnt(7)
v_or_b32 v0, v136, v137
v_or_b32 v1, v138, v139
s_setprio 0
v_rcp_f16_sdwa v154, v153 dst_sel:WORD_1 dst_unused:UNUSED_PRESERVE src0_sel:WORD_1
v_lshl_add_u32 v255, v87, 2, v255
s_waitcnt lgkmcnt(3)
v_or_b32 v2, v140, v141
ds_read_b128 v[224:227], v248 offset:29696
ds_read_u16_d16_hi v145, v145
v_mfma_f32_32x32x16_bf16 v[120:135], v[228:231], v[188:191], v[120:135]
v_rcp_f16_sdwa v151, v150 dst_sel:WORD_1 dst_unused:UNUSED_PRESERVE src0_sel:WORD_1
s_waitcnt lgkmcnt(3)
v_or_b32 v3, v142, v143
v_mov_b32 v214, v62
v_rcp_f16_sdwa v148, v147 dst_sel:WORD_1 dst_unused:UNUSED_PRESERVE src0_sel:WORD_1
s_waitcnt lgkmcnt(0)
v_or_b32 v4, v144, v145
v_pk_mul_f16 v5, v155, v154
v_pk_mul_f16 v6, v152, v151
v_pk_mul_f16 v7, v149, v148
v_lshl_add_u32 v255, v255, 2, s72
s_setprio 3
v_pk_mul_f32 v[192:193], v[192:193], v[192:193]
v_pk_fma_f32 v[192:193], v[194:195], v[194:195], v[192:193]
v_pk_fma_f32 v[192:193], v[196:197], v[196:197], v[192:193]
v_pk_fma_f32 v[192:193], v[198:199], v[198:199], v[192:193]
v_pk_fma_f32 v[192:193], v[200:201], v[200:201], v[192:193]
v_pk_fma_f32 v[192:193], v[202:203], v[202:203], v[192:193]
v_pk_fma_f32 v[192:193], v[204:205], v[204:205], v[192:193]
v_pk_fma_f32 v[192:193], v[206:207], v[206:207], v[192:193]
s_setprio 0
v_mov_b32 v215, v63
v_add_f32 v167, v167, v192
v_add_f32 v167, v167, v193
s_setprio 2
ds_read_b128 v[228:231], v248 offset:32768
v_mfma_f32_32x32x16_f16 v[192:207], v[0:3], v[240:243], 0
v_cvt_pkrtz_f16_f32 v137, v120, v121
v_cvt_pkrtz_f16_f32 v139, v122, v123
v_cvt_pkrtz_f16_f32 v141, v124, v125
v_cvt_pkrtz_f16_f32 v143, v126, v127
v_mfma_f32_32x32x16_f16 v[192:207], v[4:7], v[244:247], v[192:207]
v_cvt_pkrtz_f16_f32 v145, v128, v129
v_cvt_pk_f16_f32 v155, v130, v131
v_cvt_pk_f16_f32 v152, v132, v133
v_cvt_pk_f16_f32 v149, v134, v135
v_pk_fma_f16 v154, v155, v155, s48
v_mfma_f32_32x32x16_bf16 v[120:135], v[232:235], v[168:171], 0
v_and_b32 v137, s49, v137
v_pk_fma_f16 v151, v152, v152, s48
v_and_b32 v139, s49, v139
v_pk_fma_f16 v148, v149, v149, s48
v_pk_mul_f16 v154, v155, v154
v_lshrrev_b16 v136, 2, v137
v_pk_mul_f16 v151, v152, v151
v_pk_mul_f16 v148, v149, v148
v_lshrrev_b16 v138, 2, v139
ds_read_b128 v[232:235], v248 offset:30720
ds_read_u16_d16 v136, v136
ds_read_u16_d16 v138, v138
v_mfma_f32_32x32x16_bf16 v[120:135], v[236:239], v[172:175], v[120:135]
v_exp_f16 v153, v154
v_lshrrev_b32 v137, 18, v137
v_exp_f16 v150, v151
v_lshrrev_b32 v139, 18, v139
v_exp_f16 v147, v148
v_and_b32 v141, s49, v141
ds_read_b128 v[236:239], v248 offset:33792
ds_read_u16_d16_hi v137, v137
ds_read_u16_d16_hi v139, v139
v_mfma_f32_32x32x16_bf16 v[120:135], v[224:227], v[176:179], v[120:135]
v_and_b32 v143, s49, v143
v_exp_f16_sdwa v153, v154 dst_sel:WORD_1 dst_unused:UNUSED_PRESERVE src0_sel:WORD_1
v_lshrrev_b16 v140, 2, v141
v_exp_f16_sdwa v150, v151 dst_sel:WORD_1 dst_unused:UNUSED_PRESERVE src0_sel:WORD_1
v_lshrrev_b16 v142, 2, v143
v_exp_f16_sdwa v147, v148 dst_sel:WORD_1 dst_unused:UNUSED_PRESERVE src0_sel:WORD_1
s_waitcnt lgkmcnt(6)
ds_read_b128 v[224:227], v248 offset:34816
ds_read_u16_d16 v140, v140
ds_read_u16_d16 v142, v142
v_mfma_f32_32x32x16_bf16 v[120:135], v[228:231], v[180:183], v[120:135]
v_lshrrev_b32 v141, 18, v141
v_pk_add_f16 v153, v153, 1.0 op_sel_hi:[1,0]
v_lshrrev_b32 v143, 18, v143
v_pk_add_f16 v150, v150, 1.0 op_sel_hi:[1,0]
v_pk_add_f16 v147, v147, 1.0 op_sel_hi:[1,0]
v_and_b32 v145, s49, v145
v_rcp_f16 v154, v153
v_lshrrev_b16 v144, 2, v145
s_waitcnt lgkmcnt(6)
ds_read_b128 v[228:231], v248 offset:37888
ds_read_u16_d16_hi v141, v141
ds_read_u16_d16_hi v143, v143
ds_read_u16_d16 v144, v144
v_mfma_f32_32x32x16_bf16 v[120:135], v[232:235], v[184:187], v[120:135]
v_rcp_f16 v151, v150
v_lshrrev_b32 v145, 18, v145
v_rcp_f16 v148, v147
s_waitcnt lgkmcnt(7)
v_or_b32 v8, v136, v137
v_or_b32 v9, v138, v139
v_rcp_f16_sdwa v154, v153 dst_sel:WORD_1 dst_unused:UNUSED_PRESERVE src0_sel:WORD_1
ds_read_b128 v[232:235], v248 offset:35840
ds_read_u16_d16_hi v145, v145
v_mfma_f32_32x32x16_bf16 v[120:135], v[236:239], v[188:191], v[120:135]
s_waitcnt lgkmcnt(4)
v_or_b32 v10, v140, v141
v_rcp_f16_sdwa v151, v150 dst_sel:WORD_1 dst_unused:UNUSED_PRESERVE src0_sel:WORD_1
s_waitcnt lgkmcnt(3)
v_or_b32 v11, v142, v143
v_rcp_f16_sdwa v148, v147 dst_sel:WORD_1 dst_unused:UNUSED_PRESERVE src0_sel:WORD_1
s_waitcnt lgkmcnt(0)
v_or_b32 v12, v144, v145
v_pk_mul_f16 v13, v155, v154
v_pk_mul_f16 v14, v152, v151
v_pk_mul_f16 v15, v149, v148
s_setprio 3
v_pk_mul_f32 v[192:193], v[192:193], v[192:193]
v_pk_fma_f32 v[192:193], v[194:195], v[194:195], v[192:193]
v_pk_fma_f32 v[192:193], v[196:197], v[196:197], v[192:193]
v_pk_fma_f32 v[192:193], v[198:199], v[198:199], v[192:193]
v_pk_fma_f32 v[192:193], v[200:201], v[200:201], v[192:193]
v_pk_fma_f32 v[192:193], v[202:203], v[202:203], v[192:193]
v_pk_fma_f32 v[192:193], v[204:205], v[204:205], v[192:193]
v_pk_fma_f32 v[192:193], v[206:207], v[206:207], v[192:193]
s_setprio 2
v_add_f32 v156, v156, v192
v_add_f32 v156, v156, v193
s_setprio 1
ds_read_b128 v[236:239], v248 offset:38912
v_mfma_f32_32x32x16_f16 v[192:207], v[8:11], v[240:243], 0
v_cvt_pkrtz_f16_f32 v137, v120, v121
v_cvt_pkrtz_f16_f32 v139, v122, v123
v_cvt_pkrtz_f16_f32 v141, v124, v125
v_cvt_pkrtz_f16_f32 v143, v126, v127
v_mfma_f32_32x32x16_f16 v[192:207], v[12:15], v[244:247], v[192:207]
v_cvt_pkrtz_f16_f32 v145, v128, v129
v_cvt_pk_f16_f32 v155, v130, v131
v_cvt_pk_f16_f32 v152, v132, v133
v_cvt_pk_f16_f32 v149, v134, v135
v_pk_fma_f16 v154, v155, v155, s48
v_mfma_f32_32x32x16_bf16 v[120:135], v[224:227], v[168:171], 0
v_and_b32 v137, s49, v137
v_pk_fma_f16 v151, v152, v152, s48
v_and_b32 v139, s49, v139
v_pk_fma_f16 v148, v149, v149, s48
v_pk_mul_f16 v154, v155, v154
v_lshrrev_b16 v136, 2, v137
v_pk_mul_f16 v151, v152, v151
v_pk_mul_f16 v148, v149, v148
v_lshrrev_b16 v138, 2, v139
ds_read_b128 v[224:227], v248 offset:36864
ds_read_u16_d16 v136, v136
ds_read_u16_d16 v138, v138
v_mfma_f32_32x32x16_bf16 v[120:135], v[228:231], v[172:175], v[120:135]
v_exp_f16 v153, v154
v_lshrrev_b32 v137, 18, v137
v_exp_f16 v150, v151
v_lshrrev_b32 v139, 18, v139
v_exp_f16 v147, v148
v_and_b32 v141, s49, v141
v_and_b32 v143, s49, v143
ds_read_b128 v[228:231], v248 offset:39936
ds_read_u16_d16_hi v137, v137
ds_read_u16_d16_hi v139, v139
v_mfma_f32_32x32x16_bf16 v[120:135], v[232:235], v[176:179], v[120:135]
v_exp_f16_sdwa v153, v154 dst_sel:WORD_1 dst_unused:UNUSED_PRESERVE src0_sel:WORD_1
v_lshrrev_b16 v140, 2, v141
v_exp_f16_sdwa v150, v151 dst_sel:WORD_1 dst_unused:UNUSED_PRESERVE src0_sel:WORD_1
v_lshrrev_b16 v142, 2, v143
v_exp_f16_sdwa v147, v148 dst_sel:WORD_1 dst_unused:UNUSED_PRESERVE src0_sel:WORD_1
v_lshrrev_b32 v141, 18, v141
v_pk_add_f16 v153, v153, 1.0 op_sel_hi:[1,0]
s_waitcnt lgkmcnt(6)
ds_read_b128 v[232:235], v248 offset:40960
ds_read_u16_d16 v140, v140
ds_read_u16_d16 v142, v142
ds_read_u16_d16_hi v141, v141
v_mfma_f32_32x32x16_bf16 v[120:135], v[236:239], v[180:183], v[120:135]
v_lshrrev_b32 v143, 18, v143
v_pk_add_f16 v150, v150, 1.0 op_sel_hi:[1,0]
v_pk_add_f16 v147, v147, 1.0 op_sel_hi:[1,0]
v_and_b32 v145, s49, v145
v_rcp_f16 v154, v153
v_lshrrev_b16 v144, 2, v145
v_rcp_f16 v151, v150
s_waitcnt lgkmcnt(7)
ds_read_b128 v[236:239], v248 offset:44032
ds_read_u16_d16_hi v143, v143
ds_read_u16_d16 v144, v144
v_mfma_f32_32x32x16_bf16 v[120:135], v[224:227], v[184:187], v[120:135]
v_lshrrev_b32 v145, 18, v145
v_rcp_f16 v148, v147
s_waitcnt lgkmcnt(7)
v_or_b32 v16, v136, v137
v_or_b32 v17, v138, v139
v_rcp_f16_sdwa v154, v153 dst_sel:WORD_1 dst_unused:UNUSED_PRESERVE src0_sel:WORD_1
s_setprio 0
s_waitcnt lgkmcnt(3)
v_or_b32 v18, v140, v141
v_rcp_f16_sdwa v151, v150 dst_sel:WORD_1 dst_unused:UNUSED_PRESERVE src0_sel:WORD_1
ds_read_b128 v[224:227], v248 offset:41984
ds_read_u16_d16_hi v145, v145
v_mfma_f32_32x32x16_bf16 v[120:135], v[228:231], v[188:191], v[120:135]
s_waitcnt lgkmcnt(3)
v_or_b32 v19, v142, v143
v_rcp_f16_sdwa v148, v147 dst_sel:WORD_1 dst_unused:UNUSED_PRESERVE src0_sel:WORD_1
s_waitcnt lgkmcnt(0)
v_or_b32 v20, v144, v145
v_pk_mul_f16 v21, v155, v154
v_pk_mul_f16 v22, v152, v151
v_pk_mul_f16 v23, v149, v148
s_setprio 3
v_pk_mul_f32 v[192:193], v[192:193], v[192:193]
v_pk_fma_f32 v[192:193], v[194:195], v[194:195], v[192:193]
v_pk_fma_f32 v[192:193], v[196:197], v[196:197], v[192:193]
v_pk_fma_f32 v[192:193], v[198:199], v[198:199], v[192:193]
v_pk_fma_f32 v[192:193], v[200:201], v[200:201], v[192:193]
v_pk_fma_f32 v[192:193], v[202:203], v[202:203], v[192:193]
v_pk_fma_f32 v[192:193], v[204:205], v[204:205], v[192:193]
v_pk_fma_f32 v[192:193], v[206:207], v[206:207], v[192:193]
s_setprio 0
v_add_f32 v157, v157, v192
v_add_f32 v157, v157, v193
s_nop 1
v_permlane32_swap_b32 v156, v157
v_add_f32 v156, v156, v157
ds_write_b32 v255, v156 offset:7168
s_cmp_lg_u32 s40, 0
s_cbranch_scc1 Lrs1
v_mov_b32 v82, 0
Lpi:
s_waitcnt vmcnt(0)
v_readfirstlane_b32 s43, v83
s_cmp_eq_u32 s76, 0
s_cbranch_scc1 Lpix
s_sub_u32 s76, s76, 1
s_cmp_ge_u32 s43, 256
s_cbranch_scc1 Lpix
buffer_load_dword v83, v82, s[36:39], 0 offen sc1
s_branch Lpi
Lpix:
v_min_u32 v80, 47, v251
v_lshlrev_b32 v80, 3, v80
s_and_b32 s44, s2, 7
s_lshl_b32 s44, s44, 11
s_add_u32 s44, s44, 394752
buffer_load_dwordx2 v[84:85], v80, s[32:35], s44 offen sc1
Lrs1:
s_setprio 2
ds_read_b128 v[228:231], v248 offset:45056
v_mfma_f32_32x32x16_f16 v[192:207], v[16:19], v[240:243], 0
v_cvt_pkrtz_f16_f32 v137, v120, v121
v_cvt_pkrtz_f16_f32 v139, v122, v123
v_cvt_pkrtz_f16_f32 v141, v124, v125
v_cvt_pkrtz_f16_f32 v143, v126, v127
v_mfma_f32_32x32x16_f16 v[192:207], v[20:23], v[244:247], v[192:207]
v_cvt_pkrtz_f16_f32 v145, v128, v129
v_cvt_pk_f16_f32 v155, v130, v131
v_cvt_pk_f16_f32 v152, v132, v133
v_cvt_pk_f16_f32 v149, v134, v135
v_pk_fma_f16 v154, v155, v155, s48
v_mfma_f32_32x32x16_bf16 v[120:135], v[232:235], v[168:171], 0
v_and_b32 v137, s49, v137
v_pk_fma_f16 v151, v152, v152, s48
v_and_b32 v139, s49, v139
v_pk_fma_f16 v148, v149, v149, s48
v_pk_mul_f16 v154, v155, v154
v_lshrrev_b16 v136, 2, v137
v_pk_mul_f16 v151, v152, v151
v_pk_mul_f16 v148, v149, v148
v_lshrrev_b16 v138, 2, v139
ds_read_b128 v[232:235], v248 offset:43008
ds_read_u16_d16 v136, v136
ds_read_u16_d16 v138, v138
v_mfma_f32_32x32x16_bf16 v[120:135], v[236:239], v[172:175], v[120:135]
v_exp_f16 v153, v154
v_lshrrev_b32 v137, 18, v137
v_exp_f16 v150, v151
v_lshrrev_b32 v139, 18, v139
v_exp_f16 v147, v148
v_and_b32 v141, s49, v141
ds_read_b128 v[236:239], v248 offset:46080
ds_read_u16_d16_hi v137, v137
ds_read_u16_d16_hi v139, v139
v_mfma_f32_32x32x16_bf16 v[120:135], v[224:227], v[176:179], v[120:135]
v_and_b32 v143, s49, v143
v_exp_f16_sdwa v153, v154 dst_sel:WORD_1 dst_unused:UNUSED_PRESERVE src0_sel:WORD_1
v_lshrrev_b16 v140, 2, v141
v_exp_f16_sdwa v150, v151 dst_sel:WORD_1 dst_unused:UNUSED_PRESERVE src0_sel:WORD_1
v_lshrrev_b16 v142, 2, v143
v_exp_f16_sdwa v147, v148 dst_sel:WORD_1 dst_unused:UNUSED_PRESERVE src0_sel:WORD_1
s_waitcnt lgkmcnt(6)
ds_read_b128 v[224:227], v248 offset:47104
ds_read_u16_d16 v140, v140
ds_read_u16_d16 v142, v142
v_mfma_f32_32x32x16_bf16 v[120:135], v[228:231], v[180:183], v[120:135]
v_lshrrev_b32 v141, 18, v141
v_pk_add_f16 v153, v153, 1.0 op_sel_hi:[1,0]
v_lshrrev_b32 v143, 18, v143
v_pk_add_f16 v150, v150, 1.0 op_sel_hi:[1,0]
v_pk_add_f16 v147, v147, 1.0 op_sel_hi:[1,0]
v_and_b32 v145, s49, v145
v_rcp_f16 v154, v153
v_lshrrev_b16 v144, 2, v145
s_waitcnt lgkmcnt(6)
ds_read_b128 v[228:231], v248 offset:50176
ds_read_u16_d16_hi v141, v141
ds_read_u16_d16_hi v143, v143
ds_read_u16_d16 v144, v144
v_mfma_f32_32x32x16_bf16 v[120:135], v[232:235], v[184:187], v[120:135]
v_rcp_f16 v151, v150
v_lshrrev_b32 v145, 18, v145
v_rcp_f16 v148, v147
s_waitcnt lgkmcnt(7)
v_or_b32 v24, v136, v137
v_or_b32 v25, v138, v139
v_rcp_f16_sdwa v154, v153 dst_sel:WORD_1 dst_unused:UNUSED_PRESERVE src0_sel:WORD_1
ds_read_b128 v[232:235], v248 offset:48128
ds_read_u16_d16_hi v145, v145
v_mfma_f32_32x32x16_bf16 v[120:135], v[236:239], v[188:191], v[120:135]
s_waitcnt lgkmcnt(4)
v_or_b32 v26, v140, v141
v_rcp_f16_sdwa v151, v150 dst_sel:WORD_1 dst_unused:UNUSED_PRESERVE src0_sel:WORD_1
s_waitcnt lgkmcnt(3)
v_or_b32 v27, v142, v143
v_rcp_f16_sdwa v148, v147 dst_sel:WORD_1 dst_unused:UNUSED_PRESERVE src0_sel:WORD_1
s_waitcnt lgkmcnt(0)
v_or_b32 v28, v144, v145
v_pk_mul_f16 v29, v155, v154
v_pk_mul_f16 v30, v152, v151
v_pk_mul_f16 v31, v149, v148
s_setprio 3
v_pk_mul_f32 v[192:193], v[192:193], v[192:193]
v_pk_fma_f32 v[192:193], v[194:195], v[194:195], v[192:193]
v_pk_fma_f32 v[192:193], v[196:197], v[196:197], v[192:193]
v_pk_fma_f32 v[192:193], v[198:199], v[198:199], v[192:193]
v_pk_fma_f32 v[192:193], v[200:201], v[200:201], v[192:193]
v_pk_fma_f32 v[192:193], v[202:203], v[202:203], v[192:193]
v_pk_fma_f32 v[192:193], v[204:205], v[204:205], v[192:193]
v_pk_fma_f32 v[192:193], v[206:207], v[206:207], v[192:193]
s_setprio 2
v_add_f32 v158, v158, v192
v_add_f32 v158, v158, v193
s_setprio 1
ds_read_b128 v[236:239], v248 offset:51200
v_mfma_f32_32x32x16_f16 v[192:207], v[24:27], v[240:243], 0
v_cvt_pkrtz_f16_f32 v137, v120, v121
v_cvt_pkrtz_f16_f32 v139, v122, v123
v_cvt_pkrtz_f16_f32 v141, v124, v125
v_cvt_pkrtz_f16_f32 v143, v126, v127
v_mfma_f32_32x32x16_f16 v[192:207], v[28:31], v[244:247], v[192:207]
v_cvt_pkrtz_f16_f32 v145, v128, v129
v_cvt_pk_f16_f32 v155, v130, v131
v_cvt_pk_f16_f32 v152, v132, v133
v_cvt_pk_f16_f32 v149, v134, v135
v_pk_fma_f16 v154, v155, v155, s48
v_mfma_f32_32x32x16_bf16 v[120:135], v[224:227], v[168:171], 0
v_and_b32 v137, s49, v137
v_pk_fma_f16 v151, v152, v152, s48
v_and_b32 v139, s49, v139
v_pk_fma_f16 v148, v149, v149, s48
v_pk_mul_f16 v154, v155, v154
v_lshrrev_b16 v136, 2, v137
v_pk_mul_f16 v151, v152, v151
v_pk_mul_f16 v148, v149, v148
v_lshrrev_b16 v138, 2, v139
ds_read_b128 v[224:227], v248 offset:49152
ds_read_u16_d16 v136, v136
ds_read_u16_d16 v138, v138
v_mfma_f32_32x32x16_bf16 v[120:135], v[228:231], v[172:175], v[120:135]
v_exp_f16 v153, v154
v_lshrrev_b32 v137, 18, v137
v_exp_f16 v150, v151
v_lshrrev_b32 v139, 18, v139
v_exp_f16 v147, v148
v_and_b32 v141, s49, v141
v_and_b32 v143, s49, v143
ds_read_b128 v[228:231], v248 offset:52224
ds_read_u16_d16_hi v137, v137
ds_read_u16_d16_hi v139, v139
v_mfma_f32_32x32x16_bf16 v[120:135], v[232:235], v[176:179], v[120:135]
v_exp_f16_sdwa v153, v154 dst_sel:WORD_1 dst_unused:UNUSED_PRESERVE src0_sel:WORD_1
v_lshrrev_b16 v140, 2, v141
v_exp_f16_sdwa v150, v151 dst_sel:WORD_1 dst_unused:UNUSED_PRESERVE src0_sel:WORD_1
v_lshrrev_b16 v142, 2, v143
v_exp_f16_sdwa v147, v148 dst_sel:WORD_1 dst_unused:UNUSED_PRESERVE src0_sel:WORD_1
v_lshrrev_b32 v141, 18, v141
v_pk_add_f16 v153, v153, 1.0 op_sel_hi:[1,0]
s_waitcnt lgkmcnt(6)
ds_read_b128 v[232:235], v248 offset:53248
ds_read_u16_d16 v140, v140
ds_read_u16_d16 v142, v142
ds_read_u16_d16_hi v141, v141
v_mfma_f32_32x32x16_bf16 v[120:135], v[236:239], v[180:183], v[120:135]
v_lshrrev_b32 v143, 18, v143
v_pk_add_f16 v150, v150, 1.0 op_sel_hi:[1,0]
v_pk_add_f16 v147, v147, 1.0 op_sel_hi:[1,0]
v_and_b32 v145, s49, v145
v_rcp_f16 v154, v153
v_lshrrev_b16 v144, 2, v145
v_rcp_f16 v151, v150
s_waitcnt lgkmcnt(7)
ds_read_b128 v[236:239], v248 offset:56320
ds_read_u16_d16_hi v143, v143
ds_read_u16_d16 v144, v144
v_mfma_f32_32x32x16_bf16 v[120:135], v[224:227], v[184:187], v[120:135]
v_lshrrev_b32 v145, 18, v145
v_rcp_f16 v148, v147
s_waitcnt lgkmcnt(7)
v_or_b32 v32, v136, v137
v_or_b32 v33, v138, v139
v_rcp_f16_sdwa v154, v153 dst_sel:WORD_1 dst_unused:UNUSED_PRESERVE src0_sel:WORD_1
s_setprio 0
s_waitcnt lgkmcnt(3)
v_or_b32 v34, v140, v141
v_rcp_f16_sdwa v151, v150 dst_sel:WORD_1 dst_unused:UNUSED_PRESERVE src0_sel:WORD_1
ds_read_b128 v[224:227], v248 offset:54272
ds_read_u16_d16_hi v145, v145
v_mfma_f32_32x32x16_bf16 v[120:135], v[228:231], v[188:191], v[120:135]
s_waitcnt lgkmcnt(3)
v_or_b32 v35, v142, v143
v_rcp_f16_sdwa v148, v147 dst_sel:WORD_1 dst_unused:UNUSED_PRESERVE src0_sel:WORD_1
s_waitcnt lgkmcnt(0)
v_or_b32 v36, v144, v145
v_pk_mul_f16 v37, v155, v154
v_pk_mul_f16 v38, v152, v151
v_pk_mul_f16 v39, v149, v148
s_setprio 3
v_pk_mul_f32 v[192:193], v[192:193], v[192:193]
v_pk_fma_f32 v[192:193], v[194:195], v[194:195], v[192:193]
v_pk_fma_f32 v[192:193], v[196:197], v[196:197], v[192:193]
v_pk_fma_f32 v[192:193], v[198:199], v[198:199], v[192:193]
v_pk_fma_f32 v[192:193], v[200:201], v[200:201], v[192:193]
v_pk_fma_f32 v[192:193], v[202:203], v[202:203], v[192:193]
v_pk_fma_f32 v[192:193], v[204:205], v[204:205], v[192:193]
v_pk_fma_f32 v[192:193], v[206:207], v[206:207], v[192:193]
s_setprio 0
v_add_f32 v159, v159, v192
v_add_f32 v159, v159, v193
s_nop 1
v_permlane32_swap_b32 v158, v159
v_add_f32 v158, v158, v159
ds_write_b32 v255, v158 offset:7424
s_setprio 2
ds_read_b128 v[228:231], v248 offset:57344
v_mfma_f32_32x32x16_f16 v[192:207], v[32:35], v[240:243], 0
v_cvt_pkrtz_f16_f32 v137, v120, v121
v_cvt_pkrtz_f16_f32 v139, v122, v123
v_cvt_pkrtz_f16_f32 v141, v124, v125
v_cvt_pkrtz_f16_f32 v143, v126, v127
v_mfma_f32_32x32x16_f16 v[192:207], v[36:39], v[244:247], v[192:207]
v_cvt_pkrtz_f16_f32 v145, v128, v129
v_cvt_pk_f16_f32 v155, v130, v131
v_cvt_pk_f16_f32 v152, v132, v133
v_cvt_pk_f16_f32 v149, v134, v135
v_pk_fma_f16 v154, v155, v155, s48
v_mfma_f32_32x32x16_bf16 v[120:135], v[232:235], v[168:171], 0
v_and_b32 v137, s49, v137
v_pk_fma_f16 v151, v152, v152, s48
v_and_b32 v139, s49, v139
v_pk_fma_f16 v148, v149, v149, s48
v_pk_mul_f16 v154, v155, v154
v_lshrrev_b16 v136, 2, v137
v_pk_mul_f16 v151, v152, v151
v_pk_mul_f16 v148, v149, v148
v_lshrrev_b16 v138, 2, v139
ds_read_b128 v[232:235], v248 offset:55296
ds_read_u16_d16 v136, v136
ds_read_u16_d16 v138, v138
v_mfma_f32_32x32x16_bf16 v[120:135], v[236:239], v[172:175], v[120:135]
v_exp_f16 v153, v154
v_lshrrev_b32 v137, 18, v137
v_exp_f16 v150, v151
v_lshrrev_b32 v139, 18, v139
v_exp_f16 v147, v148
v_and_b32 v141, s49, v141
ds_read_b128 v[236:239], v248 offset:58368
ds_read_u16_d16_hi v137, v137
ds_read_u16_d16_hi v139, v139
v_mfma_f32_32x32x16_bf16 v[120:135], v[224:227], v[176:179], v[120:135]
v_and_b32 v143, s49, v143
v_exp_f16_sdwa v153, v154 dst_sel:WORD_1 dst_unused:UNUSED_PRESERVE src0_sel:WORD_1
v_lshrrev_b16 v140, 2, v141
v_exp_f16_sdwa v150, v151 dst_sel:WORD_1 dst_unused:UNUSED_PRESERVE src0_sel:WORD_1
v_lshrrev_b16 v142, 2, v143
v_exp_f16_sdwa v147, v148 dst_sel:WORD_1 dst_unused:UNUSED_PRESERVE src0_sel:WORD_1
s_waitcnt lgkmcnt(6)
ds_read_b128 v[224:227], v248 offset:59392
ds_read_u16_d16 v140, v140
ds_read_u16_d16 v142, v142
v_mfma_f32_32x32x16_bf16 v[120:135], v[228:231], v[180:183], v[120:135]
v_lshrrev_b32 v141, 18, v141
v_pk_add_f16 v153, v153, 1.0 op_sel_hi:[1,0]
v_lshrrev_b32 v143, 18, v143
v_pk_add_f16 v150, v150, 1.0 op_sel_hi:[1,0]
v_pk_add_f16 v147, v147, 1.0 op_sel_hi:[1,0]
v_and_b32 v145, s49, v145
v_rcp_f16 v154, v153
v_lshrrev_b16 v144, 2, v145
s_waitcnt lgkmcnt(6)
ds_read_b128 v[228:231], v248 offset:62464
ds_read_u16_d16_hi v141, v141
ds_read_u16_d16_hi v143, v143
ds_read_u16_d16 v144, v144
v_mfma_f32_32x32x16_bf16 v[120:135], v[232:235], v[184:187], v[120:135]
v_rcp_f16 v151, v150
v_lshrrev_b32 v145, 18, v145
v_rcp_f16 v148, v147
s_waitcnt lgkmcnt(7)
v_or_b32 v40, v136, v137
v_or_b32 v41, v138, v139
v_rcp_f16_sdwa v154, v153 dst_sel:WORD_1 dst_unused:UNUSED_PRESERVE src0_sel:WORD_1
ds_read_b128 v[232:235], v248 offset:60416
ds_read_u16_d16_hi v145, v145
v_mfma_f32_32x32x16_bf16 v[120:135], v[236:239], v[188:191], v[120:135]
s_waitcnt lgkmcnt(4)
v_or_b32 v42, v140, v141
v_rcp_f16_sdwa v151, v150 dst_sel:WORD_1 dst_unused:UNUSED_PRESERVE src0_sel:WORD_1
s_waitcnt lgkmcnt(3)
v_or_b32 v43, v142, v143
v_rcp_f16_sdwa v148, v147 dst_sel:WORD_1 dst_unused:UNUSED_PRESERVE src0_sel:WORD_1
s_waitcnt lgkmcnt(0)
v_or_b32 v44, v144, v145
v_pk_mul_f16 v45, v155, v154
v_pk_mul_f16 v46, v152, v151
v_pk_mul_f16 v47, v149, v148
s_setprio 3
v_pk_mul_f32 v[192:193], v[192:193], v[192:193]
v_pk_fma_f32 v[192:193], v[194:195], v[194:195], v[192:193]
v_pk_fma_f32 v[192:193], v[196:197], v[196:197], v[192:193]
v_pk_fma_f32 v[192:193], v[198:199], v[198:199], v[192:193]
v_pk_fma_f32 v[192:193], v[200:201], v[200:201], v[192:193]
v_pk_fma_f32 v[192:193], v[202:203], v[202:203], v[192:193]
v_pk_fma_f32 v[192:193], v[204:205], v[204:205], v[192:193]
v_pk_fma_f32 v[192:193], v[206:207], v[206:207], v[192:193]
s_setprio 2
v_add_f32 v160, v160, v192
v_add_f32 v160, v160, v193
s_cmp_lg_u32 s40, 0
s_cbranch_scc1 Lrs2
v_min_u32 v80, 47, v251
v_lshlrev_b32 v80, 3, v80
v_add_u32 v81, 7936, v80
v_add_u32 v80, 15872, v80
v_cmp_gt_u32 vcc, 32, v251
s_nop 1
v_cndmask_b32 v80, v80, v81, vcc
s_waitcnt vmcnt(0)
ds_write_b64 v80, v[84:85]
Lrs2:
s_setprio 1
ds_read_b128 v[236:239], v248 offset:63488
v_mfma_f32_32x32x16_f16 v[192:207], v[40:43], v[240:243], 0
v_cvt_pkrtz_f16_f32 v137, v120, v121
v_cvt_pkrtz_f16_f32 v139, v122, v123
v_cvt_pkrtz_f16_f32 v141, v124, v125
v_cvt_pkrtz_f16_f32 v143, v126, v127
v_mfma_f32_32x32x16_f16 v[192:207], v[44:47], v[244:247], v[192:207]
s_waitcnt lgkmcnt(1)
v_cvt_pkrtz_f16_f32 v145, v128, v129
v_cvt_pk_f16_f32 v155, v130, v131
v_cvt_pk_f16_f32 v152, v132, v133
v_cvt_pk_f16_f32 v149, v134, v135
v_pk_fma_f16 v154, v155, v155, s48
v_mfma_f32_32x32x16_bf16 v[120:135], v[224:227], v[168:171], 0
v_and_b32 v137, s49, v137
v_pk_fma_f16 v151, v152, v152, s48
v_and_b32 v139, s49, v139
v_pk_fma_f16 v148, v149, v149, s48
v_pk_mul_f16 v154, v155, v154
v_lshrrev_b16 v136, 2, v137
v_pk_mul_f16 v151, v152, v151
v_pk_mul_f16 v148, v149, v148
v_lshrrev_b16 v138, 2, v139
ds_read_b128 v[224:227], v248 offset:61440
ds_read_u16_d16 v136, v136
ds_read_u16_d16 v138, v138
v_mfma_f32_32x32x16_bf16 v[120:135], v[228:231], v[172:175], v[120:135]
v_exp_f16 v153, v154
v_lshrrev_b32 v137, 18, v137
v_exp_f16 v150, v151
v_lshrrev_b32 v139, 18, v139
v_exp_f16 v147, v148
v_and_b32 v141, s49, v141
v_and_b32 v143, s49, v143
ds_read_b128 v[228:231], v248 offset:64512
ds_read_u16_d16_hi v137, v137
ds_read_u16_d16_hi v139, v139
v_mfma_f32_32x32x16_bf16 v[120:135], v[232:235], v[176:179], v[120:135]
v_exp_f16_sdwa v153, v154 dst_sel:WORD_1 dst_unused:UNUSED_PRESERVE src0_sel:WORD_1
v_lshrrev_b16 v140, 2, v141
v_exp_f16_sdwa v150, v151 dst_sel:WORD_1 dst_unused:UNUSED_PRESERVE src0_sel:WORD_1
v_lshrrev_b16 v142, 2, v143
v_exp_f16_sdwa v147, v148 dst_sel:WORD_1 dst_unused:UNUSED_PRESERVE src0_sel:WORD_1
v_lshrrev_b32 v141, 18, v141
v_pk_add_f16 v153, v153, 1.0 op_sel_hi:[1,0]
s_waitcnt lgkmcnt(6)
ds_read_b128 v[232:235], v249
ds_read_u16_d16 v140, v140
ds_read_u16_d16 v142, v142
ds_read_u16_d16_hi v141, v141
v_mfma_f32_32x32x16_bf16 v[120:135], v[236:239], v[180:183], v[120:135]
v_lshrrev_b32 v143, 18, v143
v_pk_add_f16 v150, v150, 1.0 op_sel_hi:[1,0]
v_pk_add_f16 v147, v147, 1.0 op_sel_hi:[1,0]
v_and_b32 v145, s49, v145
v_rcp_f16 v154, v153
v_lshrrev_b16 v144, 2, v145
v_rcp_f16 v151, v150
s_waitcnt lgkmcnt(7)
ds_read_b128 v[236:239], v249 offset:3072
ds_read_u16_d16_hi v143, v143
ds_read_u16_d16 v144, v144
v_mfma_f32_32x32x16_bf16 v[120:135], v[224:227], v[184:187], v[120:135]
v_lshrrev_b32 v145, 18, v145
v_rcp_f16 v148, v147
s_waitcnt lgkmcnt(7)
v_or_b32 v48, v136, v137
v_or_b32 v49, v138, v139
v_rcp_f16_sdwa v154, v153 dst_sel:WORD_1 dst_unused:UNUSED_PRESERVE src0_sel:WORD_1
s_setprio 0
s_waitcnt lgkmcnt(3)
v_or_b32 v50, v140, v141
v_rcp_f16_sdwa v151, v150 dst_sel:WORD_1 dst_unused:UNUSED_PRESERVE src0_sel:WORD_1
ds_read_b128 v[224:227], v249 offset:1024
ds_read_u16_d16_hi v145, v145
v_mfma_f32_32x32x16_bf16 v[120:135], v[228:231], v[188:191], v[120:135]
s_waitcnt lgkmcnt(3)
v_or_b32 v51, v142, v143
v_rcp_f16_sdwa v148, v147 dst_sel:WORD_1 dst_unused:UNUSED_PRESERVE src0_sel:WORD_1
s_waitcnt lgkmcnt(0)
v_or_b32 v52, v144, v145
v_pk_mul_f16 v53, v155, v154
v_pk_mul_f16 v54, v152, v151
v_pk_mul_f16 v55, v149, v148
s_setprio 3
v_pk_mul_f32 v[192:193], v[192:193], v[192:193]
v_pk_fma_f32 v[192:193], v[194:195], v[194:195], v[192:193]
v_pk_fma_f32 v[192:193], v[196:197], v[196:197], v[192:193]
v_pk_fma_f32 v[192:193], v[198:199], v[198:199], v[192:193]
v_pk_fma_f32 v[192:193], v[200:201], v[200:201], v[192:193]
v_pk_fma_f32 v[192:193], v[202:203], v[202:203], v[192:193]
v_pk_fma_f32 v[192:193], v[204:205], v[204:205], v[192:193]
v_pk_fma_f32 v[192:193], v[206:207], v[206:207], v[192:193]
s_setprio 0
v_add_f32 v161, v161, v192
v_add_f32 v161, v161, v193
s_nop 1
v_permlane32_swap_b32 v160, v161
v_add_f32 v160, v160, v161
ds_write_b32 v255, v160 offset:7680
s_setprio 2
ds_read_b128 v[228:231], v249 offset:4096
v_mfma_f32_32x32x16_f16 v[192:207], v[48:51], v[240:243], 0
v_cvt_pkrtz_f16_f32 v137, v120, v121
v_cvt_pkrtz_f16_f32 v139, v122, v123
v_cvt_pkrtz_f16_f32 v141, v124, v125
v_cvt_pkrtz_f16_f32 v143, v126, v127
v_mfma_f32_32x32x16_f16 v[192:207], v[52:55], v[244:247], v[192:207]
v_cvt_pkrtz_f16_f32 v145, v128, v129
v_cvt_pk_f16_f32 v155, v130, v131
v_cvt_pk_f16_f32 v152, v132, v133
v_cvt_pk_f16_f32 v149, v134, v135
v_pk_fma_f16 v154, v155, v155, s48
v_mfma_f32_32x32x16_bf16 v[120:135], v[232:235], v[168:171], 0
v_and_b32 v137, s49, v137
v_pk_fma_f16 v151, v152, v152, s48
v_and_b32 v139, s49, v139
v_pk_fma_f16 v148, v149, v149, s48
v_pk_mul_f16 v154, v155, v154
v_lshrrev_b16 v136, 2, v137
v_pk_mul_f16 v151, v152, v151
v_pk_mul_f16 v148, v149, v148
v_lshrrev_b16 v138, 2, v139
ds_read_b128 v[232:235], v249 offset:2048
ds_read_u16_d16 v136, v136
ds_read_u16_d16 v138, v138
v_mfma_f32_32x32x16_bf16 v[120:135], v[236:239], v[172:175], v[120:135]
v_exp_f16 v153, v154
v_lshrrev_b32 v137, 18, v137
v_exp_f16 v150, v151
v_lshrrev_b32 v139, 18, v139
v_exp_f16 v147, v148
v_and_b32 v141, s49, v141
ds_read_b128 v[236:239], v249 offset:5120
ds_read_u16_d16_hi v137, v137
ds_read_u16_d16_hi v139, v139
v_mfma_f32_32x32x16_bf16 v[120:135], v[224:227], v[176:179], v[120:135]
v_and_b32 v143, s49, v143
v_exp_f16_sdwa v153, v154 dst_sel:WORD_1 dst_unused:UNUSED_PRESERVE src0_sel:WORD_1
v_lshrrev_b16 v140, 2, v141
v_exp_f16_sdwa v150, v151 dst_sel:WORD_1 dst_unused:UNUSED_PRESERVE src0_sel:WORD_1
v_lshrrev_b16 v142, 2, v143
v_exp_f16_sdwa v147, v148 dst_sel:WORD_1 dst_unused:UNUSED_PRESERVE src0_sel:WORD_1
s_waitcnt lgkmcnt(6)
ds_read_b128 v[224:227], v249 offset:6144
ds_read_u16_d16 v140, v140
ds_read_u16_d16 v142, v142
v_mfma_f32_32x32x16_bf16 v[120:135], v[228:231], v[180:183], v[120:135]
v_lshrrev_b32 v141, 18, v141
v_pk_add_f16 v153, v153, 1.0 op_sel_hi:[1,0]
v_lshrrev_b32 v143, 18, v143
v_pk_add_f16 v150, v150, 1.0 op_sel_hi:[1,0]
v_pk_add_f16 v147, v147, 1.0 op_sel_hi:[1,0]
v_and_b32 v145, s49, v145
v_rcp_f16 v154, v153
v_lshrrev_b16 v144, 2, v145
s_waitcnt lgkmcnt(6)
ds_read_b128 v[228:231], v249 offset:9216
ds_read_u16_d16_hi v141, v141
ds_read_u16_d16_hi v143, v143
ds_read_u16_d16 v144, v144
v_mfma_f32_32x32x16_bf16 v[120:135], v[232:235], v[184:187], v[120:135]
v_rcp_f16 v151, v150
v_lshrrev_b32 v145, 18, v145
v_rcp_f16 v148, v147
s_waitcnt lgkmcnt(7)
v_or_b32 v56, v136, v137
v_or_b32 v57, v138, v139
v_rcp_f16_sdwa v154, v153 dst_sel:WORD_1 dst_unused:UNUSED_PRESERVE src0_sel:WORD_1
ds_read_b128 v[232:235], v249 offset:7168
ds_read_u16_d16_hi v145, v145
v_mfma_f32_32x32x16_bf16 v[120:135], v[236:239], v[188:191], v[120:135]
s_waitcnt lgkmcnt(4)
v_or_b32 v58, v140, v141
v_rcp_f16_sdwa v151, v150 dst_sel:WORD_1 dst_unused:UNUSED_PRESERVE src0_sel:WORD_1
s_waitcnt lgkmcnt(3)
v_or_b32 v59, v142, v143
v_rcp_f16_sdwa v148, v147 dst_sel:WORD_1 dst_unused:UNUSED_PRESERVE src0_sel:WORD_1
s_waitcnt lgkmcnt(0)
v_or_b32 v60, v144, v145
v_pk_mul_f16 v61, v155, v154
v_pk_mul_f16 v62, v152, v151
v_pk_mul_f16 v63, v149, v148
s_setprio 3
v_pk_mul_f32 v[192:193], v[192:193], v[192:193]
v_pk_fma_f32 v[192:193], v[194:195], v[194:195], v[192:193]
v_pk_fma_f32 v[192:193], v[196:197], v[196:197], v[192:193]
v_pk_fma_f32 v[192:193], v[198:199], v[198:199], v[192:193]
v_pk_fma_f32 v[192:193], v[200:201], v[200:201], v[192:193]
v_pk_fma_f32 v[192:193], v[202:203], v[202:203], v[192:193]
v_pk_fma_f32 v[192:193], v[204:205], v[204:205], v[192:193]
v_pk_fma_f32 v[192:193], v[206:207], v[206:207], v[192:193]
s_setprio 2
v_add_f32 v162, v162, v192
v_add_f32 v162, v162, v193
s_cmp_lg_u32 s40, 0
s_cbranch_scc1 Lrs3
v_mov_b32 v250, 1
v_mov_b32 v82, 0
s_mov_b64 exec, 1
buffer_atomic_add v250, v82, s[36:39], 0 offen offset:128 sc0
s_mov_b64 exec, -1
Lrs3:
s_setprio 1
ds_read_b128 v[236:239], v249 offset:10240
v_mfma_f32_32x32x16_f16 v[192:207], v[56:59], v[240:243], 0
v_cvt_pkrtz_f16_f32 v137, v120, v121
v_cvt_pkrtz_f16_f32 v139, v122, v123
v_cvt_pkrtz_f16_f32 v141, v124, v125
v_cvt_pkrtz_f16_f32 v143, v126, v127
v_mfma_f32_32x32x16_f16 v[192:207], v[60:63], v[244:247], v[192:207]
v_cvt_pkrtz_f16_f32 v145, v128, v129
v_cvt_pk_f16_f32 v155, v130, v131
v_cvt_pk_f16_f32 v152, v132, v133
v_cvt_pk_f16_f32 v149, v134, v135
v_pk_fma_f16 v154, v155, v155, s48
v_mfma_f32_32x32x16_bf16 v[120:135], v[224:227], v[168:171], 0
v_and_b32 v137, s49, v137
v_pk_fma_f16 v151, v152, v152, s48
v_and_b32 v139, s49, v139
v_pk_fma_f16 v148, v149, v149, s48
v_pk_mul_f16 v154, v155, v154
v_lshrrev_b16 v136, 2, v137
v_pk_mul_f16 v151, v152, v151
v_pk_mul_f16 v148, v149, v148
v_lshrrev_b16 v138, 2, v139
ds_read_b128 v[224:227], v249 offset:8192
ds_read_u16_d16 v136, v136
ds_read_u16_d16 v138, v138
v_mfma_f32_32x32x16_bf16 v[120:135], v[228:231], v[172:175], v[120:135]
v_exp_f16 v153, v154
v_lshrrev_b32 v137, 18, v137
v_exp_f16 v150, v151
v_lshrrev_b32 v139, 18, v139
v_exp_f16 v147, v148
v_and_b32 v141, s49, v141
v_and_b32 v143, s49, v143
ds_read_b128 v[228:231], v249 offset:11264
ds_read_u16_d16_hi v137, v137
ds_read_u16_d16_hi v139, v139
v_mfma_f32_32x32x16_bf16 v[120:135], v[232:235], v[176:179], v[120:135]
v_exp_f16_sdwa v153, v154 dst_sel:WORD_1 dst_unused:UNUSED_PRESERVE src0_sel:WORD_1
v_lshrrev_b16 v140, 2, v141
v_exp_f16_sdwa v150, v151 dst_sel:WORD_1 dst_unused:UNUSED_PRESERVE src0_sel:WORD_1
v_lshrrev_b16 v142, 2, v143
v_exp_f16_sdwa v147, v148 dst_sel:WORD_1 dst_unused:UNUSED_PRESERVE src0_sel:WORD_1
v_lshrrev_b32 v141, 18, v141
v_pk_add_f16 v153, v153, 1.0 op_sel_hi:[1,0]
s_waitcnt lgkmcnt(6)
ds_read_b128 v[232:235], v249 offset:12288
ds_read_u16_d16 v140, v140
ds_read_u16_d16 v142, v142
ds_read_u16_d16_hi v141, v141
v_mfma_f32_32x32x16_bf16 v[120:135], v[236:239], v[180:183], v[120:135]
v_lshrrev_b32 v143, 18, v143
v_pk_add_f16 v150, v150, 1.0 op_sel_hi:[1,0]
v_pk_add_f16 v147, v147, 1.0 op_sel_hi:[1,0]
v_and_b32 v145, s49, v145
v_rcp_f16 v154, v153
v_lshrrev_b16 v144, 2, v145
v_rcp_f16 v151, v150
s_waitcnt lgkmcnt(7)
ds_read_b128 v[236:239], v249 offset:15360
ds_read_u16_d16_hi v143, v143
ds_read_u16_d16 v144, v144
v_mfma_f32_32x32x16_bf16 v[120:135], v[224:227], v[184:187], v[120:135]
v_lshrrev_b32 v145, 18, v145
v_rcp_f16 v148, v147
s_waitcnt lgkmcnt(7)
v_or_b32 v64, v136, v137
v_or_b32 v65, v138, v139
v_rcp_f16_sdwa v154, v153 dst_sel:WORD_1 dst_unused:UNUSED_PRESERVE src0_sel:WORD_1
s_setprio 0
s_waitcnt lgkmcnt(3)
v_or_b32 v66, v140, v141
v_rcp_f16_sdwa v151, v150 dst_sel:WORD_1 dst_unused:UNUSED_PRESERVE src0_sel:WORD_1
ds_read_b128 v[224:227], v249 offset:13312
ds_read_u16_d16_hi v145, v145
v_mfma_f32_32x32x16_bf16 v[120:135], v[228:231], v[188:191], v[120:135]
s_waitcnt lgkmcnt(3)
v_or_b32 v67, v142, v143
v_rcp_f16_sdwa v148, v147 dst_sel:WORD_1 dst_unused:UNUSED_PRESERVE src0_sel:WORD_1
s_waitcnt lgkmcnt(0)
v_or_b32 v68, v144, v145
v_pk_mul_f16 v69, v155, v154
v_pk_mul_f16 v70, v152, v151
v_pk_mul_f16 v71, v149, v148
s_setprio 3
v_pk_mul_f32 v[192:193], v[192:193], v[192:193]
v_pk_fma_f32 v[192:193], v[194:195], v[194:195], v[192:193]
v_pk_fma_f32 v[192:193], v[196:197], v[196:197], v[192:193]
v_pk_fma_f32 v[192:193], v[198:199], v[198:199], v[192:193]
v_pk_fma_f32 v[192:193], v[200:201], v[200:201], v[192:193]
v_pk_fma_f32 v[192:193], v[202:203], v[202:203], v[192:193]
v_pk_fma_f32 v[192:193], v[204:205], v[204:205], v[192:193]
v_pk_fma_f32 v[192:193], v[206:207], v[206:207], v[192:193]
s_setprio 0
v_add_f32 v163, v163, v192
v_add_f32 v163, v163, v193
s_nop 1
v_permlane32_swap_b32 v162, v163
v_add_f32 v162, v162, v163
ds_write_b32 v255, v162 offset:7936
s_setprio 2
ds_read_b128 v[228:231], v249 offset:16384
v_mfma_f32_32x32x16_f16 v[192:207], v[64:67], v[240:243], 0
v_cvt_pkrtz_f16_f32 v137, v120, v121
v_cvt_pkrtz_f16_f32 v139, v122, v123
v_cvt_pkrtz_f16_f32 v141, v124, v125
v_cvt_pkrtz_f16_f32 v143, v126, v127
v_mfma_f32_32x32x16_f16 v[192:207], v[68:71], v[244:247], v[192:207]
v_cvt_pkrtz_f16_f32 v145, v128, v129
v_cvt_pk_f16_f32 v155, v130, v131
v_cvt_pk_f16_f32 v152, v132, v133
v_cvt_pk_f16_f32 v149, v134, v135
v_pk_fma_f16 v154, v155, v155, s48
v_mfma_f32_32x32x16_bf16 v[120:135], v[232:235], v[168:171], 0
v_and_b32 v137, s49, v137
v_pk_fma_f16 v151, v152, v152, s48
v_and_b32 v139, s49, v139
v_pk_fma_f16 v148, v149, v149, s48
v_pk_mul_f16 v154, v155, v154
v_lshrrev_b16 v136, 2, v137
v_pk_mul_f16 v151, v152, v151
v_pk_mul_f16 v148, v149, v148
v_lshrrev_b16 v138, 2, v139
ds_read_b128 v[232:235], v249 offset:14336
ds_read_u16_d16 v136, v136
ds_read_u16_d16 v138, v138
v_mfma_f32_32x32x16_bf16 v[120:135], v[236:239], v[172:175], v[120:135]
v_exp_f16 v153, v154
v_lshrrev_b32 v137, 18, v137
v_exp_f16 v150, v151
v_lshrrev_b32 v139, 18, v139
v_exp_f16 v147, v148
v_and_b32 v141, s49, v141
ds_read_b128 v[236:239], v249 offset:17408
ds_read_u16_d16_hi v137, v137
ds_read_u16_d16_hi v139, v139
v_mfma_f32_32x32x16_bf16 v[120:135], v[224:227], v[176:179], v[120:135]
v_and_b32 v143, s49, v143
v_exp_f16_sdwa v153, v154 dst_sel:WORD_1 dst_unused:UNUSED_PRESERVE src0_sel:WORD_1
v_lshrrev_b16 v140, 2, v141
v_exp_f16_sdwa v150, v151 dst_sel:WORD_1 dst_unused:UNUSED_PRESERVE src0_sel:WORD_1
v_lshrrev_b16 v142, 2, v143
v_exp_f16_sdwa v147, v148 dst_sel:WORD_1 dst_unused:UNUSED_PRESERVE src0_sel:WORD_1
s_waitcnt lgkmcnt(6)
ds_read_b128 v[224:227], v249 offset:18432
ds_read_u16_d16 v140, v140
ds_read_u16_d16 v142, v142
v_mfma_f32_32x32x16_bf16 v[120:135], v[228:231], v[180:183], v[120:135]
v_lshrrev_b32 v141, 18, v141
v_pk_add_f16 v153, v153, 1.0 op_sel_hi:[1,0]
v_lshrrev_b32 v143, 18, v143
v_pk_add_f16 v150, v150, 1.0 op_sel_hi:[1,0]
v_pk_add_f16 v147, v147, 1.0 op_sel_hi:[1,0]
v_and_b32 v145, s49, v145
v_rcp_f16 v154, v153
v_lshrrev_b16 v144, 2, v145
s_waitcnt lgkmcnt(6)
ds_read_b128 v[228:231], v249 offset:21504
ds_read_u16_d16_hi v141, v141
ds_read_u16_d16_hi v143, v143
ds_read_u16_d16 v144, v144
v_mfma_f32_32x32x16_bf16 v[120:135], v[232:235], v[184:187], v[120:135]
v_rcp_f16 v151, v150
v_lshrrev_b32 v145, 18, v145
v_rcp_f16 v148, v147
s_waitcnt lgkmcnt(7)
v_or_b32 v72, v136, v137
v_or_b32 v73, v138, v139
v_rcp_f16_sdwa v154, v153 dst_sel:WORD_1 dst_unused:UNUSED_PRESERVE src0_sel:WORD_1
ds_read_b128 v[232:235], v249 offset:19456
ds_read_u16_d16_hi v145, v145
v_mfma_f32_32x32x16_bf16 v[120:135], v[236:239], v[188:191], v[120:135]
s_waitcnt lgkmcnt(4)
v_or_b32 v74, v140, v141
v_rcp_f16_sdwa v151, v150 dst_sel:WORD_1 dst_unused:UNUSED_PRESERVE src0_sel:WORD_1
s_waitcnt lgkmcnt(3)
v_or_b32 v75, v142, v143
v_rcp_f16_sdwa v148, v147 dst_sel:WORD_1 dst_unused:UNUSED_PRESERVE src0_sel:WORD_1
s_waitcnt lgkmcnt(0)
v_or_b32 v76, v144, v145
v_pk_mul_f16 v77, v155, v154
v_pk_mul_f16 v78, v152, v151
v_pk_mul_f16 v79, v149, v148
s_setprio 3
v_pk_mul_f32 v[192:193], v[192:193], v[192:193]
v_pk_fma_f32 v[192:193], v[194:195], v[194:195], v[192:193]
v_pk_fma_f32 v[192:193], v[196:197], v[196:197], v[192:193]
v_pk_fma_f32 v[192:193], v[198:199], v[198:199], v[192:193]
v_pk_fma_f32 v[192:193], v[200:201], v[200:201], v[192:193]
v_pk_fma_f32 v[192:193], v[202:203], v[202:203], v[192:193]
v_pk_fma_f32 v[192:193], v[204:205], v[204:205], v[192:193]
v_pk_fma_f32 v[192:193], v[206:207], v[206:207], v[192:193]
s_setprio 2
v_add_f32 v164, v164, v192
v_add_f32 v164, v164, v193
s_setprio 1
ds_read_b128 v[236:239], v249 offset:22528
v_mfma_f32_32x32x16_f16 v[192:207], v[72:75], v[240:243], 0
v_cvt_pkrtz_f16_f32 v137, v120, v121
v_cvt_pkrtz_f16_f32 v139, v122, v123
v_cvt_pkrtz_f16_f32 v141, v124, v125
v_cvt_pkrtz_f16_f32 v143, v126, v127
v_mfma_f32_32x32x16_f16 v[192:207], v[76:79], v[244:247], v[192:207]
v_cvt_pkrtz_f16_f32 v145, v128, v129
v_cvt_pk_f16_f32 v155, v130, v131
v_cvt_pk_f16_f32 v152, v132, v133
v_cvt_pk_f16_f32 v149, v134, v135
v_pk_fma_f16 v154, v155, v155, s48
v_mfma_f32_32x32x16_bf16 v[120:135], v[224:227], v[168:171], 0
v_and_b32 v137, s49, v137
v_pk_fma_f16 v151, v152, v152, s48
v_and_b32 v139, s49, v139
v_pk_fma_f16 v148, v149, v149, s48
v_pk_mul_f16 v154, v155, v154
v_lshrrev_b16 v136, 2, v137
v_pk_mul_f16 v151, v152, v151
v_pk_mul_f16 v148, v149, v148
v_lshrrev_b16 v138, 2, v139
ds_read_b128 v[224:227], v249 offset:20480
ds_read_u16_d16 v136, v136
ds_read_u16_d16 v138, v138
v_mfma_f32_32x32x16_bf16 v[120:135], v[228:231], v[172:175], v[120:135]
v_exp_f16 v153, v154
v_lshrrev_b32 v137, 18, v137
v_exp_f16 v150, v151
v_lshrrev_b32 v139, 18, v139
v_exp_f16 v147, v148
v_and_b32 v141, s49, v141
v_and_b32 v143, s49, v143
ds_read_b128 v[228:231], v249 offset:23552
ds_read_u16_d16_hi v137, v137
ds_read_u16_d16_hi v139, v139
v_mfma_f32_32x32x16_bf16 v[120:135], v[232:235], v[176:179], v[120:135]
v_exp_f16_sdwa v153, v154 dst_sel:WORD_1 dst_unused:UNUSED_PRESERVE src0_sel:WORD_1
v_lshrrev_b16 v140, 2, v141
v_exp_f16_sdwa v150, v151 dst_sel:WORD_1 dst_unused:UNUSED_PRESERVE src0_sel:WORD_1
v_lshrrev_b16 v142, 2, v143
v_exp_f16_sdwa v147, v148 dst_sel:WORD_1 dst_unused:UNUSED_PRESERVE src0_sel:WORD_1
v_lshrrev_b32 v141, 18, v141
v_pk_add_f16 v153, v153, 1.0 op_sel_hi:[1,0]
s_waitcnt lgkmcnt(6)
ds_read_b128 v[232:235], v248 offset:47104
ds_read_u16_d16 v140, v140
ds_read_u16_d16 v142, v142
ds_read_u16_d16_hi v141, v141
v_mfma_f32_32x32x16_bf16 v[120:135], v[236:239], v[180:183], v[120:135]
v_lshrrev_b32 v143, 18, v143
v_pk_add_f16 v150, v150, 1.0 op_sel_hi:[1,0]
v_pk_add_f16 v147, v147, 1.0 op_sel_hi:[1,0]
v_and_b32 v145, s49, v145
v_rcp_f16 v154, v153
v_lshrrev_b16 v144, 2, v145
v_rcp_f16 v151, v150
s_waitcnt lgkmcnt(7)
ds_read_b128 v[236:239], v248 offset:50176
ds_read_u16_d16_hi v143, v143
ds_read_u16_d16 v144, v144
v_mfma_f32_32x32x16_bf16 v[120:135], v[224:227], v[184:187], v[120:135]
v_lshrrev_b32 v145, 18, v145
v_rcp_f16 v148, v147
s_waitcnt lgkmcnt(7)
v_or_b32 v80, v136, v137
v_or_b32 v81, v138, v139
v_rcp_f16_sdwa v154, v153 dst_sel:WORD_1 dst_unused:UNUSED_PRESERVE src0_sel:WORD_1
s_setprio 0
s_waitcnt lgkmcnt(3)
v_or_b32 v82, v140, v141
v_rcp_f16_sdwa v151, v150 dst_sel:WORD_1 dst_unused:UNUSED_PRESERVE src0_sel:WORD_1
ds_read_b128 v[224:227], v248 offset:48128
ds_read_u16_d16_hi v145, v145
v_mfma_f32_32x32x16_bf16 v[120:135], v[228:231], v[188:191], v[120:135]
s_waitcnt lgkmcnt(3)
v_or_b32 v83, v142, v143
v_rcp_f16_sdwa v148, v147 dst_sel:WORD_1 dst_unused:UNUSED_PRESERVE src0_sel:WORD_1
s_waitcnt lgkmcnt(0)
v_or_b32 v84, v144, v145
v_pk_mul_f16 v85, v155, v154
v_pk_mul_f16 v86, v152, v151
v_pk_mul_f16 v87, v149, v148
s_setprio 3
v_pk_mul_f32 v[192:193], v[192:193], v[192:193]
v_pk_fma_f32 v[192:193], v[194:195], v[194:195], v[192:193]
v_pk_fma_f32 v[192:193], v[196:197], v[196:197], v[192:193]
v_pk_fma_f32 v[192:193], v[198:199], v[198:199], v[192:193]
v_pk_fma_f32 v[192:193], v[200:201], v[200:201], v[192:193]
v_pk_fma_f32 v[192:193], v[202:203], v[202:203], v[192:193]
v_pk_fma_f32 v[192:193], v[204:205], v[204:205], v[192:193]
v_pk_fma_f32 v[192:193], v[206:207], v[206:207], v[192:193]
s_setprio 0
v_add_f32 v165, v165, v192
v_add_f32 v165, v165, v193
s_nop 1
v_permlane32_swap_b32 v164, v165
v_add_f32 v164, v164, v165
ds_write_b32 v255, v164 offset:8192
s_setprio 2
ds_read_b128 v[228:231], v248 offset:51200
v_mfma_f32_32x32x16_f16 v[192:207], v[80:83], v[240:243], 0
v_cvt_pkrtz_f16_f32 v137, v120, v121
v_cvt_pkrtz_f16_f32 v139, v122, v123
v_cvt_pkrtz_f16_f32 v141, v124, v125
v_cvt_pkrtz_f16_f32 v143, v126, v127
v_mfma_f32_32x32x16_f16 v[192:207], v[84:87], v[244:247], v[192:207]
v_cvt_pkrtz_f16_f32 v145, v128, v129
v_cvt_pk_f16_f32 v155, v130, v131
v_cvt_pk_f16_f32 v152, v132, v133
v_cvt_pk_f16_f32 v149, v134, v135
v_pk_fma_f16 v154, v155, v155, s48
v_mfma_f32_32x32x16_bf16 v[120:135], v[232:235], v[96:99], 0
v_and_b32 v137, s49, v137
v_pk_fma_f16 v151, v152, v152, s48
v_and_b32 v139, s49, v139
v_pk_fma_f16 v148, v149, v149, s48
v_pk_mul_f16 v154, v155, v154
v_lshrrev_b16 v136, 2, v137
v_pk_mul_f16 v151, v152, v151
v_pk_mul_f16 v148, v149, v148
v_lshrrev_b16 v138, 2, v139
ds_read_b128 v[232:235], v248 offset:49152
ds_read_u16_d16 v136, v136
ds_read_u16_d16 v138, v138
v_mfma_f32_32x32x16_bf16 v[120:135], v[236:239], v[100:103], v[120:135]
v_exp_f16 v153, v154
v_lshrrev_b32 v137, 18, v137
v_exp_f16 v150, v151
v_lshrrev_b32 v139, 18, v139
v_exp_f16 v147, v148
v_and_b32 v141, s49, v141
ds_read_b128 v[236:239], v248 offset:52224
ds_read_u16_d16_hi v137, v137
ds_read_u16_d16_hi v139, v139
v_mfma_f32_32x32x16_bf16 v[120:135], v[224:227], v[104:107], v[120:135]
v_and_b32 v143, s49, v143
v_exp_f16_sdwa v153, v154 dst_sel:WORD_1 dst_unused:UNUSED_PRESERVE src0_sel:WORD_1
v_lshrrev_b16 v140, 2, v141
v_exp_f16_sdwa v150, v151 dst_sel:WORD_1 dst_unused:UNUSED_PRESERVE src0_sel:WORD_1
v_lshrrev_b16 v142, 2, v143
v_exp_f16_sdwa v147, v148 dst_sel:WORD_1 dst_unused:UNUSED_PRESERVE src0_sel:WORD_1
s_waitcnt lgkmcnt(6)
ds_read_b128 v[224:227], v248 offset:53248
ds_read_u16_d16 v140, v140
ds_read_u16_d16 v142, v142
v_mfma_f32_32x32x16_bf16 v[120:135], v[228:231], v[108:111], v[120:135]
v_lshrrev_b32 v141, 18, v141
v_pk_add_f16 v153, v153, 1.0 op_sel_hi:[1,0]
v_lshrrev_b32 v143, 18, v143
v_pk_add_f16 v150, v150, 1.0 op_sel_hi:[1,0]
v_pk_add_f16 v147, v147, 1.0 op_sel_hi:[1,0]
v_and_b32 v145, s49, v145
v_rcp_f16 v154, v153
v_lshrrev_b16 v144, 2, v145
s_waitcnt lgkmcnt(6)
ds_read_b128 v[228:231], v248 offset:56320
ds_read_u16_d16_hi v141, v141
ds_read_u16_d16_hi v143, v143
ds_read_u16_d16 v144, v144
v_mfma_f32_32x32x16_bf16 v[120:135], v[232:235], v[112:115], v[120:135]
v_rcp_f16 v151, v150
v_lshrrev_b32 v145, 18, v145
v_rcp_f16 v148, v147
s_waitcnt lgkmcnt(7)
v_or_b32 v168, v136, v137
v_or_b32 v169, v138, v139
v_rcp_f16_sdwa v154, v153 dst_sel:WORD_1 dst_unused:UNUSED_PRESERVE src0_sel:WORD_1
ds_read_b128 v[232:235], v248 offset:54272
ds_read_u16_d16_hi v145, v145
v_mfma_f32_32x32x16_bf16 v[120:135], v[236:239], v[116:119], v[120:135]
s_waitcnt lgkmcnt(4)
v_or_b32 v170, v140, v141
v_rcp_f16_sdwa v151, v150 dst_sel:WORD_1 dst_unused:UNUSED_PRESERVE src0_sel:WORD_1
s_waitcnt lgkmcnt(3)
v_or_b32 v171, v142, v143
v_rcp_f16_sdwa v148, v147 dst_sel:WORD_1 dst_unused:UNUSED_PRESERVE src0_sel:WORD_1
s_waitcnt lgkmcnt(0)
v_or_b32 v172, v144, v145
v_pk_mul_f16 v173, v155, v154
v_pk_mul_f16 v174, v152, v151
v_pk_mul_f16 v175, v149, v148
s_setprio 3
v_pk_mul_f32 v[192:193], v[192:193], v[192:193]
v_pk_fma_f32 v[192:193], v[194:195], v[194:195], v[192:193]
v_pk_fma_f32 v[192:193], v[196:197], v[196:197], v[192:193]
v_pk_fma_f32 v[192:193], v[198:199], v[198:199], v[192:193]
v_pk_fma_f32 v[192:193], v[200:201], v[200:201], v[192:193]
v_pk_fma_f32 v[192:193], v[202:203], v[202:203], v[192:193]
v_pk_fma_f32 v[192:193], v[204:205], v[204:205], v[192:193]
v_pk_fma_f32 v[192:193], v[206:207], v[206:207], v[192:193]
s_setprio 2
v_add_f32 v166, v166, v192
v_add_f32 v166, v166, v193
s_cmp_lg_u32 s40, 0
s_cbranch_scc1 Lrs4
s_waitcnt vmcnt(0)
v_readfirstlane_b32 s3, v250
s_nop 1
s_and_b32 s3, s3, 255
Lrs4:
s_setprio 1
ds_read_b128 v[236:239], v248 offset:57344
v_mfma_f32_32x32x16_f16 v[192:207], v[168:171], v[240:243], 0
v_cvt_pkrtz_f16_f32 v137, v120, v121
v_cvt_pkrtz_f16_f32 v139, v122, v123
v_cvt_pkrtz_f16_f32 v141, v124, v125
v_cvt_pkrtz_f16_f32 v143, v126, v127
v_cvt_pkrtz_f16_f32 v145, v128, v129
v_mfma_f32_32x32x16_f16 v[192:207], v[172:175], v[244:247], v[192:207]
v_cvt_pk_f16_f32 v155, v130, v131
v_cvt_pk_f16_f32 v152, v132, v133
v_cvt_pk_f16_f32 v149, v134, v135
v_pk_fma_f16 v154, v155, v155, s48
v_and_b32 v137, s49, v137
v_pk_fma_f16 v151, v152, v152, s48
v_mfma_f32_32x32x16_bf16 v[120:135], v[224:227], v[96:99], 0
v_and_b32 v139, s49, v139
v_pk_fma_f16 v148, v149, v149, s48
v_pk_mul_f16 v154, v155, v154
v_lshrrev_b16 v136, 2, v137
v_pk_mul_f16 v151, v152, v151
v_pk_mul_f16 v148, v149, v148
v_fmac_f32 v167, v192, v192
v_fmac_f32 v167, v193, v193
v_fmac_f32 v167, v194, v194
v_fmac_f32 v167, v195, v195
v_fmac_f32 v167, v196, v196
ds_read_b128 v[224:227], v248 offset:55296
ds_read_u16_d16 v136, v136
v_mfma_f32_32x32x16_bf16 v[120:135], v[228:231], v[100:103], v[120:135]
v_fmac_f32 v167, v197, v197
v_fmac_f32 v167, v198, v198
v_fmac_f32 v167, v199, v199
v_fmac_f32 v167, v200, v200
v_fmac_f32 v167, v201, v201
v_fmac_f32 v167, v202, v202
v_fmac_f32 v167, v203, v203
v_fmac_f32 v167, v204, v204
v_fmac_f32 v167, v205, v205
v_fmac_f32 v167, v206, v206
v_fmac_f32 v167, v207, v207
ds_read_b128 v[228:231], v248 offset:58368
v_mfma_f32_32x32x16_bf16 v[120:135], v[232:235], v[104:107], v[120:135]
v_permlane32_swap_b32 v166, v167
v_add_f32 v166, v166, v167
ds_write_b32 v255, v166 offset:8448
s_setprio 3
s_mov_b64 exec, 1
ds_add_rtn_u32 v242, v253, v254
s_mov_b64 exec, -1
s_waitcnt lgkmcnt(0)
v_readfirstlane_b32 s43, v242
s_nop 1
s_cmp_lg_u32 s43, 7
s_cbranch_scc1 Lnopub
v_min_u32 v243, 47, v251
v_lshlrev_b32 v244, 5, v243
v_add_u32 v244, 97280, v244
ds_read_b128 v[176:179], v244
ds_read_b128 v[180:183], v244 offset:16
ds_read_b128 v[184:187], v244 offset:9216
ds_read_b128 v[188:191], v244 offset:9232
ds_read_b128 v[192:195], v244 offset:18432
ds_read_b128 v[196:199], v244 offset:18448
ds_read_b128 v[200:203], v244 offset:27648
ds_read_b128 v[204:207], v244 offset:27664
ds_read_b128 v[156:159], v244 offset:36864
ds_read_b128 v[160:163], v244 offset:36880
v_lshlrev_b32 v246, 13, v243
v_add_u32 v247, 4096, v246
s_waitcnt lgkmcnt(7)
v_add_f32 v176, v176, v184
v_add_f32 v177, v177, v185
v_add_f32 v178, v178, v186
v_add_f32 v179, v179, v187
s_waitcnt lgkmcnt(6)
v_add_f32 v180, v180, v188
v_add_f32 v181, v181, v189
v_add_f32 v182, v182, v190
v_add_f32 v183, v183, v191
ds_read_b128 v[184:187], v244 offset:46080
ds_read_b128 v[188:191], v244 offset:46096
s_waitcnt lgkmcnt(5)
v_add_f32 v192, v192, v200
v_add_f32 v193, v193, v201
v_add_f32 v194, v194, v202
v_add_f32 v195, v195, v203
s_waitcnt lgkmcnt(4)
v_add_f32 v196, v196, v204
v_add_f32 v197, v197, v205
v_add_f32 v198, v198, v206
v_add_f32 v199, v199, v207
ds_read_b128 v[200:203], v244 offset:55296
ds_read_b128 v[204:207], v244 offset:55312
v_add_f32 v176, v176, v192
v_add_f32 v177, v177, v193
v_add_f32 v178, v178, v194
v_add_f32 v179, v179, v195
v_add_f32 v180, v180, v196
v_add_f32 v181, v181, v197
v_add_f32 v182, v182, v198
v_add_f32 v183, v183, v199
ds_read_b128 v[192:195], v244 offset:64512
ds_read_b128 v[196:199], v244 offset:64528
s_waitcnt lgkmcnt(5)
v_add_f32 v156, v156, v184
v_add_f32 v157, v157, v185
v_add_f32 v158, v158, v186
v_add_f32 v159, v159, v187
s_waitcnt lgkmcnt(4)
v_add_f32 v160, v160, v188
v_add_f32 v161, v161, v189
v_add_f32 v162, v162, v190
v_add_f32 v163, v163, v191
s_waitcnt lgkmcnt(1)
v_add_f32 v200, v200, v192
v_add_f32 v201, v201, v193
v_add_f32 v202, v202, v194
v_add_f32 v203, v203, v195
s_waitcnt lgkmcnt(0)
v_add_f32 v204, v204, v196
v_add_f32 v205, v205, v197
v_add_f32 v206, v206, v198
v_add_f32 v207, v207, v199
v_add_f32 v156, v156, v200
v_add_f32 v157, v157, v201
v_add_f32 v158, v158, v202
v_add_f32 v159, v159, v203
v_add_f32 v160, v160, v204
v_add_f32 v161, v161, v205
v_add_f32 v162, v162, v206
v_add_f32 v163, v163, v207
v_add_f32 v176, v176, v156
v_add_f32 v177, v177, v157
v_add_f32 v178, v178, v158
v_add_f32 v179, v179, v159
v_add_f32 v180, v180, v160
v_add_f32 v181, v181, v161
v_add_f32 v182, v182, v162
v_add_f32 v183, v183, v163
v_min_u32 v184, -2, v176
v_min_u32 v185, -2, v177
v_min_u32 v186, -2, v178
v_min_u32 v187, -2, v179
v_min_u32 v188, -2, v180
v_min_u32 v189, -2, v181
v_min_u32 v190, -2, v182
v_min_u32 v191, -2, v183
s_lshl_b32 s43, s2, 4
buffer_store_dwordx4 v[184:187], v246, s[32:35], s43 offen sc1
buffer_store_dwordx4 v[188:191], v247, s[32:35], s43 offen sc1
ds_write_b32 v253, v254 offset:4
s_nop 1
Lnopub:
s_mov_b32 s77, 0
s_cmp_lg_u32 s40, 0
s_cbranch_scc1 Lnorole
s_cmp_lt_u32 s3, 96
s_cselect_b32 s77, 1, 2
s_waitcnt lgkmcnt(0)
v_mov_b32 v156, -1
v_mov_b32 v157, -1
v_mov_b32 v158, -1
v_mov_b32 v159, -1
v_mov_b32 v160, -1
v_mov_b32 v161, -1
v_mov_b32 v162, -1
v_mov_b32 v163, -1
v_mov_b32 v164, -1
v_mov_b32 v165, -1
v_mov_b32 v166, -1
v_mov_b32 v167, -1
v_mov_b32 v252, -1
v_mov_b32 v253, -1
v_mov_b32 v254, -1
v_mov_b32 v255, -1
s_cbranch_scc1 Lrole1
s_call_b64 s[78:79], LpollG
s_branch Lnorole
Lrole1:
s_call_b64 s[78:79], Lpoll1
Lnorole:
s_setprio 1
v_lshrrev_b16 v138, 2, v139
v_exp_f16 v153, v154
v_lshrrev_b32 v137, 18, v137
v_exp_f16 v150, v151
v_lshrrev_b32 v139, 18, v139
ds_read_b128 v[232:235], v248 offset:59392
ds_read_u16_d16 v138, v138
ds_read_u16_d16_hi v137, v137
ds_read_u16_d16_hi v139, v139
v_mfma_f32_32x32x16_bf16 v[120:135], v[236:239], v[108:111], v[120:135]
v_exp_f16 v147, v148
v_and_b32 v141, s49, v141
v_and_b32 v143, s49, v143
v_exp_f16_sdwa v153, v154 dst_sel:WORD_1 dst_unused:UNUSED_PRESERVE src0_sel:WORD_1
v_lshrrev_b16 v140, 2, v141
v_exp_f16_sdwa v150, v151 dst_sel:WORD_1 dst_unused:UNUSED_PRESERVE src0_sel:WORD_1
v_lshrrev_b16 v142, 2, v143
v_exp_f16_sdwa v147, v148 dst_sel:WORD_1 dst_unused:UNUSED_PRESERVE src0_sel:WORD_1
ds_read_b128 v[236:239], v248 offset:62464
ds_read_u16_d16 v140, v140
ds_read_u16_d16 v142, v142
v_mfma_f32_32x32x16_bf16 v[120:135], v[224:227], v[112:115], v[120:135]
v_lshrrev_b32 v141, 18, v141
v_pk_add_f16 v153, v153, 1.0 op_sel_hi:[1,0]
v_lshrrev_b32 v143, 18, v143
v_pk_add_f16 v150, v150, 1.0 op_sel_hi:[1,0]
s_setprio 0
v_pk_add_f16 v147, v147, 1.0 op_sel_hi:[1,0]
v_and_b32 v145, s49, v145
v_rcp_f16 v154, v153
v_lshrrev_b16 v144, 2, v145
v_rcp_f16 v151, v150
ds_read_b128 v[224:227], v248 offset:60416
ds_read_u16_d16_hi v141, v141
ds_read_u16_d16_hi v143, v143
ds_read_u16_d16 v144, v144
v_mfma_f32_32x32x16_bf16 v[120:135], v[228:231], v[116:119], v[120:135]
v_lshrrev_b32 v145, 18, v145
v_rcp_f16 v148, v147
s_waitcnt lgkmcnt(7)
v_or_b32 v176, v136, v137
v_or_b32 v177, v138, v139
v_rcp_f16_sdwa v154, v153 dst_sel:WORD_1 dst_unused:UNUSED_PRESERVE src0_sel:WORD_1
s_waitcnt lgkmcnt(2)
v_or_b32 v178, v140, v141
v_rcp_f16_sdwa v151, v150 dst_sel:WORD_1 dst_unused:UNUSED_PRESERVE src0_sel:WORD_1
s_waitcnt lgkmcnt(1)
v_or_b32 v179, v142, v143
v_rcp_f16_sdwa v148, v147 dst_sel:WORD_1 dst_unused:UNUSED_PRESERVE src0_sel:WORD_1
ds_read_u16_d16_hi v145, v145
s_waitcnt lgkmcnt(0)
v_or_b32 v180, v144, v145
v_pk_mul_f16 v181, v155, v154
v_pk_mul_f16 v182, v152, v151
v_pk_mul_f16 v183, v149, v148
s_cmp_lg_u32 s77, 1
s_cbranch_scc1 Lpp49
s_getreg_b32 s43, hwreg(HW_REG_IB_STS, 0, 4)
s_cmp_lg_u32 s43, 0
s_cbranch_scc1 Lpp49
s_call_b64 s[78:79], Lpoll
s_setprio 0
Lpp49:
s_setprio 2
v_cvt_pkrtz_f16_f32 v137, v120, v121
v_cvt_pkrtz_f16_f32 v139, v122, v123
v_cvt_pkrtz_f16_f32 v141, v124, v125
v_cvt_pkrtz_f16_f32 v143, v126, v127
v_cvt_pkrtz_f16_f32 v145, v128, v129
v_cvt_pk_f16_f32 v155, v130, v131
v_cvt_pk_f16_f32 v152, v132, v133
v_cvt_pk_f16_f32 v149, v134, v135
ds_read_b128 v[228:231], v248 offset:63488
v_mfma_f32_32x32x16_bf16 v[120:135], v[232:235], v[96:99], 0
v_pk_fma_f16 v154, v155, v155, s48
v_and_b32 v137, s49, v137
v_pk_fma_f16 v151, v152, v152, s48
v_and_b32 v139, s49, v139
v_pk_fma_f16 v148, v149, v149, s48
v_pk_mul_f16 v154, v155, v154
v_lshrrev_b16 v136, 2, v137
v_pk_mul_f16 v151, v152, v151
ds_read_b128 v[232:235], v248 offset:61440
ds_read_u16_d16 v136, v136
v_mfma_f32_32x32x16_bf16 v[120:135], v[236:239], v[100:103], v[120:135]
v_pk_mul_f16 v148, v149, v148
v_lshrrev_b16 v138, 2, v139
v_exp_f16 v153, v154
v_lshrrev_b32 v137, 18, v137
v_exp_f16 v150, v151
v_lshrrev_b32 v139, 18, v139
ds_read_b128 v[236:239], v248 offset:64512
ds_read_u16_d16 v138, v138
ds_read_u16_d16_hi v137, v137
ds_read_u16_d16_hi v139, v139
v_mfma_f32_32x32x16_bf16 v[120:135], v[224:227], v[104:107], v[120:135]
v_exp_f16 v147, v148
v_and_b32 v141, s49, v141
v_and_b32 v143, s49, v143
v_exp_f16_sdwa v153, v154 dst_sel:WORD_1 dst_unused:UNUSED_PRESERVE src0_sel:WORD_1
v_lshrrev_b16 v140, 2, v141
v_exp_f16_sdwa v150, v151 dst_sel:WORD_1 dst_unused:UNUSED_PRESERVE src0_sel:WORD_1
s_waitcnt lgkmcnt(6)
ds_read_b128 v[224:227], v249
ds_read_u16_d16 v140, v140
v_mfma_f32_32x32x16_bf16 v[120:135], v[228:231], v[108:111], v[120:135]
v_lshrrev_b16 v142, 2, v143
v_exp_f16_sdwa v147, v148 dst_sel:WORD_1 dst_unused:UNUSED_PRESERVE src0_sel:WORD_1
v_lshrrev_b32 v141, 18, v141
v_pk_add_f16 v153, v153, 1.0 op_sel_hi:[1,0]
v_lshrrev_b32 v143, 18, v143
v_pk_add_f16 v150, v150, 1.0 op_sel_hi:[1,0]
v_pk_add_f16 v147, v147, 1.0 op_sel_hi:[1,0]
s_waitcnt lgkmcnt(6)
ds_read_b128 v[228:231], v249 offset:3072
ds_read_u16_d16 v142, v142
ds_read_u16_d16_hi v141, v141
ds_read_u16_d16_hi v143, v143
v_mfma_f32_32x32x16_bf16 v[120:135], v[232:235], v[112:115], v[120:135]
v_and_b32 v145, s49, v145
v_rcp_f16 v154, v153
v_lshrrev_b16 v144, 2, v145
v_rcp_f16 v151, v150
v_lshrrev_b32 v145, 18, v145
s_waitcnt lgkmcnt(6)
ds_read_b128 v[232:235], v249 offset:1024
ds_read_u16_d16 v144, v144
ds_read_u16_d16_hi v145, v145
v_mfma_f32_32x32x16_bf16 v[120:135], v[236:239], v[116:119], v[120:135]
v_rcp_f16 v148, v147
v_or_b32 v184, v136, v137
v_or_b32 v185, v138, v139
v_rcp_f16_sdwa v154, v153 dst_sel:WORD_1 dst_unused:UNUSED_PRESERVE src0_sel:WORD_1
s_waitcnt lgkmcnt(4)
v_or_b32 v186, v140, v141
v_rcp_f16_sdwa v151, v150 dst_sel:WORD_1 dst_unused:UNUSED_PRESERVE src0_sel:WORD_1
s_waitcnt lgkmcnt(3)
v_or_b32 v187, v142, v143
v_rcp_f16_sdwa v148, v147 dst_sel:WORD_1 dst_unused:UNUSED_PRESERVE src0_sel:WORD_1
s_waitcnt lgkmcnt(0)
v_or_b32 v188, v144, v145
v_pk_mul_f16 v189, v155, v154
v_pk_mul_f16 v190, v152, v151
v_pk_mul_f16 v191, v149, v148
s_cmp_lg_u32 s77, 1
s_cbranch_scc1 Lpp50
s_getreg_b32 s43, hwreg(HW_REG_IB_STS, 0, 4)
s_cmp_lg_u32 s43, 0
s_cbranch_scc1 Lpp50
s_call_b64 s[78:79], Lpoll
s_setprio 2
Lpp50:
s_setprio 1
v_cvt_pkrtz_f16_f32 v137, v120, v121
v_cvt_pkrtz_f16_f32 v139, v122, v123
v_cvt_pkrtz_f16_f32 v141, v124, v125
v_cvt_pkrtz_f16_f32 v143, v126, v127
v_cvt_pkrtz_f16_f32 v145, v128, v129
v_cvt_pk_f16_f32 v155, v130, v131
v_cvt_pk_f16_f32 v152, v132, v133
v_cvt_pk_f16_f32 v149, v134, v135
ds_read_b128 v[236:239], v249 offset:4096
v_mfma_f32_32x32x16_bf16 v[120:135], v[224:227], v[96:99], 0
v_pk_fma_f16 v154, v155, v155, s48
v_and_b32 v137, s49, v137
v_pk_fma_f16 v151, v152, v152, s48
v_and_b32 v139, s49, v139
v_pk_fma_f16 v148, v149, v149, s48
v_pk_mul_f16 v154, v155, v154
v_lshrrev_b16 v136, 2, v137
v_pk_mul_f16 v151, v152, v151
ds_read_b128 v[224:227], v249 offset:2048
ds_read_u16_d16 v136, v136
v_mfma_f32_32x32x16_bf16 v[120:135], v[228:231], v[100:103], v[120:135]
v_pk_mul_f16 v148, v149, v148
v_lshrrev_b16 v138, 2, v139
v_exp_f16 v153, v154
v_lshrrev_b32 v137, 18, v137
v_exp_f16 v150, v151
v_lshrrev_b32 v139, 18, v139
ds_read_b128 v[228:231], v249 offset:5120
ds_read_u16_d16 v138, v138
ds_read_u16_d16_hi v137, v137
ds_read_u16_d16_hi v139, v139
v_mfma_f32_32x32x16_bf16 v[120:135], v[232:235], v[104:107], v[120:135]
v_exp_f16 v147, v148
v_and_b32 v141, s49, v141
v_and_b32 v143, s49, v143
v_exp_f16_sdwa v153, v154 dst_sel:WORD_1 dst_unused:UNUSED_PRESERVE src0_sel:WORD_1
v_lshrrev_b16 v140, 2, v141
v_exp_f16_sdwa v150, v151 dst_sel:WORD_1 dst_unused:UNUSED_PRESERVE src0_sel:WORD_1
s_waitcnt lgkmcnt(6)
ds_read_b128 v[232:235], v249 offset:6144
ds_read_u16_d16 v140, v140
v_mfma_f32_32x32x16_bf16 v[120:135], v[236:239], v[108:111], v[120:135]
v_lshrrev_b16 v142, 2, v143
v_exp_f16_sdwa v147, v148 dst_sel:WORD_1 dst_unused:UNUSED_PRESERVE src0_sel:WORD_1
v_lshrrev_b32 v141, 18, v141
v_pk_add_f16 v153, v153, 1.0 op_sel_hi:[1,0]
v_lshrrev_b32 v143, 18, v143
v_pk_add_f16 v150, v150, 1.0 op_sel_hi:[1,0]
v_pk_add_f16 v147, v147, 1.0 op_sel_hi:[1,0]
s_waitcnt lgkmcnt(6)
ds_read_b128 v[236:239], v249 offset:9216
ds_read_u16_d16 v142, v142
ds_read_u16_d16_hi v141, v141
ds_read_u16_d16_hi v143, v143
v_mfma_f32_32x32x16_bf16 v[120:135], v[224:227], v[112:115], v[120:135]
v_and_b32 v145, s49, v145
v_rcp_f16 v154, v153
v_lshrrev_b16 v144, 2, v145
s_setprio 0
v_rcp_f16 v151, v150
v_lshrrev_b32 v145, 18, v145
s_waitcnt lgkmcnt(6)
ds_read_b128 v[224:227], v249 offset:7168
ds_read_u16_d16 v144, v144
ds_read_u16_d16_hi v145, v145
v_mfma_f32_32x32x16_bf16 v[120:135], v[228:231], v[116:119], v[120:135]
v_rcp_f16 v148, v147
v_or_b32 v192, v136, v137
v_or_b32 v193, v138, v139
v_rcp_f16_sdwa v154, v153 dst_sel:WORD_1 dst_unused:UNUSED_PRESERVE src0_sel:WORD_1
s_waitcnt lgkmcnt(4)
v_or_b32 v194, v140, v141
v_rcp_f16_sdwa v151, v150 dst_sel:WORD_1 dst_unused:UNUSED_PRESERVE src0_sel:WORD_1
s_waitcnt lgkmcnt(3)
v_or_b32 v195, v142, v143
v_rcp_f16_sdwa v148, v147 dst_sel:WORD_1 dst_unused:UNUSED_PRESERVE src0_sel:WORD_1
s_waitcnt lgkmcnt(0)
v_or_b32 v196, v144, v145
v_pk_mul_f16 v197, v155, v154
v_pk_mul_f16 v198, v152, v151
v_pk_mul_f16 v199, v149, v148
s_cmp_lg_u32 s77, 1
s_cbranch_scc1 Lpp51
s_getreg_b32 s43, hwreg(HW_REG_IB_STS, 0, 4)
s_cmp_lg_u32 s43, 0
s_cbranch_scc1 Lpp51
s_call_b64 s[78:79], Lpoll
s_setprio 0
Lpp51:
v_mov_b32 v136, 16256
Lw2w:
ds_read_b32 v137, v136 offset:4
s_waitcnt lgkmcnt(0)
v_readfirstlane_b32 s43, v137
s_cmp_eq_u32 s76, 0
s_cbranch_scc1 Lw2x
s_sub_u32 s76, s76, 1
s_cmp_lt_u32 s43, 1
s_cbranch_scc0 Lw2x
s_sleep 2
s_branch Lw2w
Lw2x:
v_lshrrev_b32 v136, 2, v251
v_mul_u32_u24 v136, 192, v136
v_and_b32 v137, 3, v251
v_lshl_add_u32 v136, v137, 4, v136
s_add_u32 m0, s72, 7168
s_add_u32 s43, s82, 6208
buffer_load_dwordx4 v136, s[16:19], s43 offen lds
s_add_u32 m0, s72, 8192
s_add_u32 s43, s82, 6272
buffer_load_dwordx4 v136, s[16:19], s43 offen lds
s_setprio 2
v_cvt_pkrtz_f16_f32 v137, v120, v121
v_cvt_pkrtz_f16_f32 v139, v122, v123
v_cvt_pkrtz_f16_f32 v141, v124, v125
v_cvt_pkrtz_f16_f32 v143, v126, v127
v_cvt_pkrtz_f16_f32 v145, v128, v129
v_cvt_pk_f16_f32 v155, v130, v131
v_cvt_pk_f16_f32 v152, v132, v133
v_cvt_pk_f16_f32 v149, v134, v135
ds_read_b128 v[228:231], v249 offset:10240
v_mfma_f32_32x32x16_bf16 v[120:135], v[232:235], v[96:99], 0
v_pk_fma_f16 v154, v155, v155, s48
v_and_b32 v137, s49, v137
v_pk_fma_f16 v151, v152, v152, s48
v_and_b32 v139, s49, v139
v_pk_fma_f16 v148, v149, v149, s48
v_pk_mul_f16 v154, v155, v154
v_lshrrev_b16 v136, 2, v137
v_pk_mul_f16 v151, v152, v151
ds_read_b128 v[232:235], v249 offset:8192
ds_read_u16_d16 v136, v136
v_mfma_f32_32x32x16_bf16 v[120:135], v[236:239], v[100:103], v[120:135]
v_pk_mul_f16 v148, v149, v148
v_lshrrev_b16 v138, 2, v139
v_exp_f16 v153, v154
v_lshrrev_b32 v137, 18, v137
v_exp_f16 v150, v151
v_lshrrev_b32 v139, 18, v139
ds_read_b128 v[236:239], v249 offset:11264
ds_read_u16_d16 v138, v138
ds_read_u16_d16_hi v137, v137
ds_read_u16_d16_hi v139, v139
v_mfma_f32_32x32x16_bf16 v[120:135], v[224:227], v[104:107], v[120:135]
v_exp_f16 v147, v148
v_and_b32 v141, s49, v141
v_and_b32 v143, s49, v143
v_exp_f16_sdwa v153, v154 dst_sel:WORD_1 dst_unused:UNUSED_PRESERVE src0_sel:WORD_1
v_lshrrev_b16 v140, 2, v141
v_exp_f16_sdwa v150, v151 dst_sel:WORD_1 dst_unused:UNUSED_PRESERVE src0_sel:WORD_1
s_waitcnt lgkmcnt(6)
ds_read_b128 v[224:227], v249 offset:12288
ds_read_u16_d16 v140, v140
v_mfma_f32_32x32x16_bf16 v[120:135], v[228:231], v[108:111], v[120:135]
v_lshrrev_b16 v142, 2, v143
v_exp_f16_sdwa v147, v148 dst_sel:WORD_1 dst_unused:UNUSED_PRESERVE src0_sel:WORD_1
v_lshrrev_b32 v141, 18, v141
v_pk_add_f16 v153, v153, 1.0 op_sel_hi:[1,0]
v_lshrrev_b32 v143, 18, v143
v_pk_add_f16 v150, v150, 1.0 op_sel_hi:[1,0]
v_pk_add_f16 v147, v147, 1.0 op_sel_hi:[1,0]
s_waitcnt lgkmcnt(6)
ds_read_b128 v[228:231], v249 offset:15360
ds_read_u16_d16 v142, v142
ds_read_u16_d16_hi v141, v141
ds_read_u16_d16_hi v143, v143
v_mfma_f32_32x32x16_bf16 v[120:135], v[232:235], v[112:115], v[120:135]
v_and_b32 v145, s49, v145
v_rcp_f16 v154, v153
v_lshrrev_b16 v144, 2, v145
v_rcp_f16 v151, v150
v_lshrrev_b32 v145, 18, v145
s_waitcnt lgkmcnt(6)
ds_read_b128 v[232:235], v249 offset:13312
ds_read_u16_d16 v144, v144
ds_read_u16_d16_hi v145, v145
v_mfma_f32_32x32x16_bf16 v[120:135], v[236:239], v[116:119], v[120:135]
v_rcp_f16 v148, v147
v_or_b32 v200, v136, v137
v_or_b32 v201, v138, v139
v_rcp_f16_sdwa v154, v153 dst_sel:WORD_1 dst_unused:UNUSED_PRESERVE src0_sel:WORD_1
s_waitcnt lgkmcnt(4)
v_or_b32 v202, v140, v141
v_rcp_f16_sdwa v151, v150 dst_sel:WORD_1 dst_unused:UNUSED_PRESERVE src0_sel:WORD_1
s_waitcnt lgkmcnt(3)
v_or_b32 v203, v142, v143
v_rcp_f16_sdwa v148, v147 dst_sel:WORD_1 dst_unused:UNUSED_PRESERVE src0_sel:WORD_1
s_waitcnt lgkmcnt(0)
v_or_b32 v204, v144, v145
v_pk_mul_f16 v205, v155, v154
v_pk_mul_f16 v206, v152, v151
v_pk_mul_f16 v207, v149, v148
s_cmp_lg_u32 s77, 1
s_cbranch_scc1 Lpp52
s_getreg_b32 s43, hwreg(HW_REG_IB_STS, 0, 4)
s_cmp_lg_u32 s43, 0
s_cbranch_scc1 Lpp52
s_call_b64 s[78:79], Lpoll
s_setprio 2
Lpp52:
s_setprio 1
v_cvt_pkrtz_f16_f32 v137, v120, v121
v_cvt_pkrtz_f16_f32 v139, v122, v123
v_cvt_pkrtz_f16_f32 v141, v124, v125
v_cvt_pkrtz_f16_f32 v143, v126, v127
v_cvt_pkrtz_f16_f32 v145, v128, v129
v_cvt_pk_f16_f32 v155, v130, v131
v_cvt_pk_f16_f32 v152, v132, v133
v_cvt_pk_f16_f32 v149, v134, v135
ds_read_b128 v[236:239], v249 offset:16384
v_mfma_f32_32x32x16_bf16 v[120:135], v[224:227], v[96:99], 0
v_pk_fma_f16 v154, v155, v155, s48
v_and_b32 v137, s49, v137
v_pk_fma_f16 v151, v152, v152, s48
v_and_b32 v139, s49, v139
v_pk_fma_f16 v148, v149, v149, s48
v_pk_mul_f16 v154, v155, v154
v_lshrrev_b16 v136, 2, v137
v_pk_mul_f16 v151, v152, v151
ds_read_b128 v[224:227], v249 offset:14336
ds_read_u16_d16 v136, v136
v_mfma_f32_32x32x16_bf16 v[120:135], v[228:231], v[100:103], v[120:135]
v_pk_mul_f16 v148, v149, v148
v_lshrrev_b16 v138, 2, v139
v_exp_f16 v153, v154
v_lshrrev_b32 v137, 18, v137
v_exp_f16 v150, v151
v_lshrrev_b32 v139, 18, v139
ds_read_b128 v[228:231], v249 offset:17408
ds_read_u16_d16 v138, v138
ds_read_u16_d16_hi v137, v137
ds_read_u16_d16_hi v139, v139
v_mfma_f32_32x32x16_bf16 v[120:135], v[232:235], v[104:107], v[120:135]
v_exp_f16 v147, v148
v_and_b32 v141, s49, v141
v_and_b32 v143, s49, v143
v_exp_f16_sdwa v153, v154 dst_sel:WORD_1 dst_unused:UNUSED_PRESERVE src0_sel:WORD_1
v_lshrrev_b16 v140, 2, v141
v_exp_f16_sdwa v150, v151 dst_sel:WORD_1 dst_unused:UNUSED_PRESERVE src0_sel:WORD_1
s_waitcnt lgkmcnt(6)
ds_read_u16_d16 v140, v140
v_mfma_f32_32x32x16_bf16 v[120:135], v[236:239], v[108:111], v[120:135]
v_lshrrev_b16 v142, 2, v143
v_exp_f16_sdwa v147, v148 dst_sel:WORD_1 dst_unused:UNUSED_PRESERVE src0_sel:WORD_1
v_lshrrev_b32 v141, 18, v141
v_pk_add_f16 v153, v153, 1.0 op_sel_hi:[1,0]
v_lshrrev_b32 v143, 18, v143
v_pk_add_f16 v150, v150, 1.0 op_sel_hi:[1,0]
v_pk_add_f16 v147, v147, 1.0 op_sel_hi:[1,0]
s_waitcnt lgkmcnt(5)
ds_read_u16_d16 v142, v142
ds_read_u16_d16_hi v141, v141
ds_read_u16_d16_hi v143, v143
v_mfma_f32_32x32x16_bf16 v[120:135], v[224:227], v[112:115], v[120:135]
v_and_b32 v145, s49, v145
v_rcp_f16 v154, v153
v_lshrrev_b16 v144, 2, v145
s_setprio 0
v_rcp_f16 v151, v150
v_lshrrev_b32 v145, 18, v145
s_waitcnt lgkmcnt(4)
ds_read_u16_d16 v144, v144
ds_read_u16_d16_hi v145, v145
v_mfma_f32_32x32x16_bf16 v[120:135], v[228:231], v[116:119], v[120:135]
v_rcp_f16 v148, v147
v_or_b32 v240, v136, v137
v_or_b32 v241, v138, v139
v_rcp_f16_sdwa v154, v153 dst_sel:WORD_1 dst_unused:UNUSED_PRESERVE src0_sel:WORD_1
s_waitcnt lgkmcnt(3)
v_or_b32 v242, v140, v141
v_rcp_f16_sdwa v151, v150 dst_sel:WORD_1 dst_unused:UNUSED_PRESERVE src0_sel:WORD_1
s_waitcnt lgkmcnt(2)
v_or_b32 v243, v142, v143
v_rcp_f16_sdwa v148, v147 dst_sel:WORD_1 dst_unused:UNUSED_PRESERVE src0_sel:WORD_1
s_waitcnt lgkmcnt(0)
v_or_b32 v244, v144, v145
v_pk_mul_f16 v245, v155, v154
v_pk_mul_f16 v246, v152, v151
v_pk_mul_f16 v247, v149, v148
s_cmp_lg_u32 s77, 1
s_cbranch_scc1 Lpp53
s_getreg_b32 s43, hwreg(HW_REG_IB_STS, 0, 4)
s_cmp_lg_u32 s43, 0
s_cbranch_scc1 Lpp53
s_call_b64 s[78:79], Lpoll
s_setprio 0
Lpp53:
s_setprio 2
v_cvt_pkrtz_f16_f32 v137, v120, v121
v_cvt_pkrtz_f16_f32 v139, v122, v123
v_cvt_pkrtz_f16_f32 v141, v124, v125
v_cvt_pkrtz_f16_f32 v143, v126, v127
v_cvt_pkrtz_f16_f32 v145, v128, v129
v_cvt_pk_f16_f32 v155, v130, v131
v_cvt_pk_f16_f32 v152, v132, v133
v_cvt_pk_f16_f32 v149, v134, v135
v_pk_fma_f16 v154, v155, v155, s48
v_and_b32 v137, s49, v137
v_pk_fma_f16 v151, v152, v152, s48
v_and_b32 v139, s49, v139
v_pk_fma_f16 v148, v149, v149, s48
v_pk_mul_f16 v154, v155, v154
v_lshrrev_b16 v136, 2, v137
v_pk_mul_f16 v151, v152, v151
v_pk_mul_f16 v148, v149, v148
v_lshrrev_b16 v138, 2, v139
v_exp_f16 v153, v154
v_lshrrev_b32 v137, 18, v137
v_exp_f16 v150, v151
v_lshrrev_b32 v139, 18, v139
v_exp_f16 v147, v148
v_and_b32 v141, s49, v141
v_and_b32 v143, s49, v143
ds_read_u16_d16 v136, v136
ds_read_u16_d16 v138, v138
ds_read_u16_d16_hi v137, v137
ds_read_u16_d16_hi v139, v139
v_exp_f16_sdwa v153, v154 dst_sel:WORD_1 dst_unused:UNUSED_PRESERVE src0_sel:WORD_1
v_lshrrev_b16 v140, 2, v141
v_exp_f16_sdwa v150, v151 dst_sel:WORD_1 dst_unused:UNUSED_PRESERVE src0_sel:WORD_1
s_setprio 1
v_lshrrev_b16 v142, 2, v143
v_exp_f16_sdwa v147, v148 dst_sel:WORD_1 dst_unused:UNUSED_PRESERVE src0_sel:WORD_1
v_lshrrev_b32 v141, 18, v141
v_pk_add_f16 v153, v153, 1.0 op_sel_hi:[1,0]
v_lshrrev_b32 v143, 18, v143
v_pk_add_f16 v150, v150, 1.0 op_sel_hi:[1,0]
v_pk_add_f16 v147, v147, 1.0 op_sel_hi:[1,0]
v_and_b32 v145, s49, v145
v_rcp_f16 v154, v153
v_lshrrev_b16 v144, 2, v145
v_rcp_f16 v151, v150
v_lshrrev_b32 v145, 18, v145
ds_read_u16_d16 v140, v140
ds_read_u16_d16 v142, v142
ds_read_u16_d16_hi v141, v141
ds_read_u16_d16_hi v143, v143
ds_read_u16_d16 v144, v144
ds_read_u16_d16_hi v145, v145
v_rcp_f16 v148, v147
s_waitcnt lgkmcnt(7)
v_or_b32 v232, v136, v137
s_waitcnt lgkmcnt(6)
v_or_b32 v233, v138, v139
v_rcp_f16_sdwa v154, v153 dst_sel:WORD_1 dst_unused:UNUSED_PRESERVE src0_sel:WORD_1
s_waitcnt lgkmcnt(3)
v_or_b32 v234, v140, v141
s_setprio 0
v_rcp_f16_sdwa v151, v150 dst_sel:WORD_1 dst_unused:UNUSED_PRESERVE src0_sel:WORD_1
s_waitcnt lgkmcnt(2)
v_or_b32 v235, v142, v143
v_rcp_f16_sdwa v148, v147 dst_sel:WORD_1 dst_unused:UNUSED_PRESERVE src0_sel:WORD_1
s_waitcnt lgkmcnt(0)
v_or_b32 v236, v144, v145
v_pk_mul_f16 v237, v155, v154
v_pk_mul_f16 v238, v152, v151
v_pk_mul_f16 v239, v149, v148
s_cmp_eq_u32 s77, 0
s_cbranch_scc1 Lpp54
s_getreg_b32 s43, hwreg(HW_REG_IB_STS, 0, 4)
s_cmp_lg_u32 s43, 0
s_cbranch_scc1 Lpp54
s_call_b64 s[78:79], Lpoll
s_setprio 0
Lpp54:
s_setprio 2
v_lshrrev_b32 v225, 5, v251
v_lshl_add_u32 v224, v225, 9, s72
v_lshl_add_u32 v226, v225, 4, s72
v_and_b32 v225, 15, v251
v_lshl_add_u32 v224, v225, 4, v224
v_bfe_u32 v225, v251, 4, 1
v_lshl_add_u32 v224, v225, 3, v224
s_waitcnt vmcnt(0)
ds_read_b64_tr_b16 v[120:121], v224
ds_read_b64_tr_b16 v[122:123], v224 offset:256
ds_read_b64_tr_b16 v[124:125], v224 offset:1024
ds_read_b64_tr_b16 v[126:127], v224 offset:1280
ds_read_b64_tr_b16 v[128:129], v224 offset:2048
ds_read_b64_tr_b16 v[130:131], v224 offset:2304
ds_read_b64_tr_b16 v[132:133], v224 offset:3072
ds_read_b64_tr_b16 v[134:135], v224 offset:3328
ds_read_b64_tr_b16 v[136:137], v224 offset:4096
ds_read_b64_tr_b16 v[138:139], v224 offset:4352
ds_read_b64_tr_b16 v[140:141], v224 offset:5120
ds_read_b64_tr_b16 v[142:143], v224 offset:5376
ds_read_b64_tr_b16 v[144:145], v224 offset:6144
ds_read_b64_tr_b16 v[146:147], v224 offset:6400
ds_read_b64_tr_b16 v[148:149], v224 offset:7168
ds_read_b64_tr_b16 v[150:151], v224 offset:7424
ds_read_b64_tr_b16 v[152:153], v224 offset:8192
ds_read_b64_tr_b16 v[154:155], v224 offset:8448
v_mov_b32 v225, 16256
v_mov_b32 v227, 1
v_permlane16_swap_b32 v0, v4
v_permlane16_swap_b32 v1, v5
v_permlane16_swap_b32 v2, v6
v_permlane16_swap_b32 v3, v7
v_permlane16_swap_b32 v8, v12
v_permlane16_swap_b32 v9, v13
v_permlane16_swap_b32 v10, v14
v_permlane16_swap_b32 v11, v15
s_waitcnt lgkmcnt(0)
s_mov_b64 exec, 1
ds_add_u32 v225, v227 offset:8
s_mov_b64 exec, -1
v_lshlrev_b32 v228, 16, v120
v_and_b32 v229, 4294901760, v120
v_cvt_pk_f16_f32 v120, v228, v229
v_lshlrev_b32 v230, 16, v121
v_and_b32 v231, 4294901760, v121
v_cvt_pk_f16_f32 v121, v230, v231
v_lshlrev_b32 v228, 16, v122
v_and_b32 v229, 4294901760, v122
v_cvt_pk_f16_f32 v122, v228, v229
v_lshlrev_b32 v230, 16, v123
v_and_b32 v231, 4294901760, v123
v_cvt_pk_f16_f32 v123, v230, v231
v_lshlrev_b32 v228, 16, v124
v_and_b32 v229, 4294901760, v124
v_cvt_pk_f16_f32 v124, v228, v229
v_lshlrev_b32 v230, 16, v125
v_and_b32 v231, 4294901760, v125
v_cvt_pk_f16_f32 v125, v230, v231
v_lshlrev_b32 v228, 16, v126
v_and_b32 v229, 4294901760, v126
v_cvt_pk_f16_f32 v126, v228, v229
v_lshlrev_b32 v230, 16, v127
v_and_b32 v231, 4294901760, v127
v_cvt_pk_f16_f32 v127, v230, v231
v_lshlrev_b32 v228, 16, v128
v_and_b32 v229, 4294901760, v128
v_cvt_pk_f16_f32 v128, v228, v229
v_lshlrev_b32 v230, 16, v129
v_and_b32 v231, 4294901760, v129
v_cvt_pk_f16_f32 v129, v230, v231
v_lshlrev_b32 v228, 16, v130
v_and_b32 v229, 4294901760, v130
v_cvt_pk_f16_f32 v130, v228, v229
v_lshlrev_b32 v230, 16, v131
v_and_b32 v231, 4294901760, v131
v_cvt_pk_f16_f32 v131, v230, v231
s_cmp_eq_u32 s77, 0
s_cbranch_scc1 Lpp911
s_getreg_b32 s43, hwreg(HW_REG_IB_STS, 0, 4)
s_cmp_lg_u32 s43, 0
s_cbranch_scc1 Lpp911
s_call_b64 s[78:79], Lpoll
s_setprio 2
Lpp911:
v_lshlrev_b32 v228, 16, v132
v_and_b32 v229, 4294901760, v132
v_cvt_pk_f16_f32 v132, v228, v229
v_lshlrev_b32 v230, 16, v133
v_and_b32 v231, 4294901760, v133
v_cvt_pk_f16_f32 v133, v230, v231
v_lshlrev_b32 v228, 16, v134
v_and_b32 v229, 4294901760, v134
v_cvt_pk_f16_f32 v134, v228, v229
v_lshlrev_b32 v230, 16, v135
v_and_b32 v231, 4294901760, v135
v_cvt_pk_f16_f32 v135, v230, v231
v_lshlrev_b32 v228, 16, v136
v_and_b32 v229, 4294901760, v136
v_cvt_pk_f16_f32 v136, v228, v229
v_lshlrev_b32 v230, 16, v137
v_and_b32 v231, 4294901760, v137
v_cvt_pk_f16_f32 v137, v230, v231
v_lshlrev_b32 v228, 16, v138
v_and_b32 v229, 4294901760, v138
v_cvt_pk_f16_f32 v138, v228, v229
v_lshlrev_b32 v230, 16, v139
v_and_b32 v231, 4294901760, v139
v_cvt_pk_f16_f32 v139, v230, v231
v_lshlrev_b32 v228, 16, v140
v_and_b32 v229, 4294901760, v140
v_cvt_pk_f16_f32 v140, v228, v229
v_lshlrev_b32 v230, 16, v141
v_and_b32 v231, 4294901760, v141
v_cvt_pk_f16_f32 v141, v230, v231
v_lshlrev_b32 v228, 16, v142
v_and_b32 v229, 4294901760, v142
v_cvt_pk_f16_f32 v142, v228, v229
v_lshlrev_b32 v230, 16, v143
v_and_b32 v231, 4294901760, v143
v_cvt_pk_f16_f32 v143, v230, v231
s_cmp_eq_u32 s77, 0
s_cbranch_scc1 Lpp923
s_getreg_b32 s43, hwreg(HW_REG_IB_STS, 0, 4)
s_cmp_lg_u32 s43, 0
s_cbranch_scc1 Lpp923
s_call_b64 s[78:79], Lpoll
s_setprio 2
Lpp923:
v_lshlrev_b32 v228, 16, v144
v_and_b32 v229, 4294901760, v144
v_cvt_pk_f16_f32 v144, v228, v229
v_lshlrev_b32 v230, 16, v145
v_and_b32 v231, 4294901760, v145
v_cvt_pk_f16_f32 v145, v230, v231
v_lshlrev_b32 v228, 16, v146
v_and_b32 v229, 4294901760, v146
v_cvt_pk_f16_f32 v146, v228, v229
v_lshlrev_b32 v230, 16, v147
v_and_b32 v231, 4294901760, v147
v_cvt_pk_f16_f32 v147, v230, v231
v_lshlrev_b32 v228, 16, v148
v_and_b32 v229, 4294901760, v148
v_cvt_pk_f16_f32 v148, v228, v229
v_lshlrev_b32 v230, 16, v149
v_and_b32 v231, 4294901760, v149
v_cvt_pk_f16_f32 v149, v230, v231
v_lshlrev_b32 v228, 16, v150
v_and_b32 v229, 4294901760, v150
v_cvt_pk_f16_f32 v150, v228, v229
v_lshlrev_b32 v230, 16, v151
v_and_b32 v231, 4294901760, v151
v_cvt_pk_f16_f32 v151, v230, v231
v_lshlrev_b32 v228, 16, v152
v_and_b32 v229, 4294901760, v152
v_cvt_pk_f16_f32 v152, v228, v229
v_lshlrev_b32 v230, 16, v153
v_and_b32 v231, 4294901760, v153
v_cvt_pk_f16_f32 v153, v230, v231
v_lshlrev_b32 v228, 16, v154
v_and_b32 v229, 4294901760, v154
v_cvt_pk_f16_f32 v154, v228, v229
v_lshlrev_b32 v230, 16, v155
v_and_b32 v231, 4294901760, v155
v_cvt_pk_f16_f32 v155, v230, v231
s_cmp_eq_u32 s77, 0
s_cbranch_scc1 Lpp935
s_getreg_b32 s43, hwreg(HW_REG_IB_STS, 0, 4)
s_cmp_lg_u32 s43, 0
s_cbranch_scc1 Lpp935
s_call_b64 s[78:79], Lpoll
s_setprio 2
Lpp935:
v_lshl_add_u32 v224, v251, 4, s72
v_add_u32 v228, 0, v251
v_mul_u32_u24 v231, 2731, v228
v_lshrrev_b32 v231, 16, v231
v_mul_u32_u24 v231, 9120, v231
v_lshl_add_u32 v228, v228, 2, v231
v_add_u32 v228, 90112, v228
v_add_u32 v229, 64, v251
v_mul_u32_u24 v231, 2731, v229
v_lshrrev_b32 v231, 16, v231
v_mul_u32_u24 v231, 9120, v231
v_lshl_add_u32 v229, v229, 2, v231
v_add_u32 v229, 90112, v229
v_add_u32 v230, 128, v251
v_mul_u32_u24 v231, 2731, v230
v_lshrrev_b32 v231, 16, v231
v_mul_u32_u24 v231, 9120, v231
v_lshl_add_u32 v230, v230, 2, v231
v_add_u32 v230, 90112, v230
Lspin:
s_cmp_eq_u32 s77, 0
s_cbranch_scc1 Lspinx
s_cmp_eq_u32 s76, 0
s_cbranch_scc1 Lspinx
s_sub_u32 s76, s76, 1
s_call_b64 s[78:79], Lpoll
s_branch Lspin
Lspinx:
s_cmp_lg_u32 s40, 0
s_cbranch_scc1 Lnofin
v_mov_b32 v252, 16256
Lrrw:
ds_read_b32 v253, v252 offset:8
s_waitcnt lgkmcnt(0)
v_readfirstlane_b32 s43, v253
s_cmp_eq_u32 s76, 0
s_cbranch_scc1 Lrrx
s_sub_u32 s76, s76, 1
s_cmp_lt_u32 s43, 8
s_cbranch_scc0 Lrrx
s_sleep 2
s_branch Lrrw
Lrrx:
ds_write_b32 v228, v162
ds_write_b32 v229, v163
ds_write_b32 v230, v164
Lnofin:
s_waitcnt lgkmcnt(0)
s_barrier
ds_read_b128 v[156:159], v226
ds_read_b128 v[160:163], v226 offset:32
ds_read_b128 v[164:167], v226 offset:64
v_lshrrev_b32 v225, 4, v251
v_and_b32 v227, 15, v251
v_mul_u32_u24 v252, 192, v227
v_lshl_add_u32 v252, v225, 4, v252
v_lshlrev_b32 v254, 5, v225
v_and_b32 v253, 47, v251
v_lshlrev_b32 v253, 4, v253
v_and_b32 v225, 1, v225
v_mul_u32_u24 v227, 3072, v225
v_add_u32 v248, v227, v253
v_add_u32 v249, 65536, v248
v_add_u32 v250, 131072, v248
v_lshl_add_u32 v253, v225, 21, v253
s_waitcnt lgkmcnt(0)
v_pk_mul_f16 v120, v120, v156
v_pk_mul_f16 v121, v121, v157
v_pk_mul_f16 v122, v122, v158
v_pk_mul_f16 v123, v123, v159
ds_write_b128 v224, v[120:123]
v_pk_mul_f16 v124, v124, v156
v_pk_mul_f16 v125, v125, v157
v_pk_mul_f16 v126, v126, v158
v_pk_mul_f16 v127, v127, v159
ds_write_b128 v224, v[124:127] offset:1024
v_pk_mul_f16 v128, v128, v156
v_pk_mul_f16 v129, v129, v157
v_pk_mul_f16 v130, v130, v158
v_pk_mul_f16 v131, v131, v159
ds_write_b128 v224, v[128:131] offset:2048
v_pk_mul_f16 v132, v132, v160
v_pk_mul_f16 v133, v133, v161
v_pk_mul_f16 v134, v134, v162
v_pk_mul_f16 v135, v135, v163
ds_write_b128 v224, v[132:135] offset:3072
v_pk_mul_f16 v136, v136, v160
v_pk_mul_f16 v137, v137, v161
v_pk_mul_f16 v138, v138, v162
v_pk_mul_f16 v139, v139, v163
ds_write_b128 v224, v[136:139] offset:4096
v_pk_mul_f16 v140, v140, v160
v_pk_mul_f16 v141, v141, v161
v_pk_mul_f16 v142, v142, v162
v_pk_mul_f16 v143, v143, v163
ds_write_b128 v224, v[140:143] offset:5120
v_pk_mul_f16 v144, v144, v164
v_pk_mul_f16 v145, v145, v165
v_pk_mul_f16 v146, v146, v166
v_pk_mul_f16 v147, v147, v167
ds_write_b128 v224, v[144:147] offset:6144
v_pk_mul_f16 v148, v148, v164
v_pk_mul_f16 v149, v149, v165
v_pk_mul_f16 v150, v150, v166
v_pk_mul_f16 v151, v151, v167
ds_write_b128 v224, v[148:151] offset:7168
v_pk_mul_f16 v152, v152, v164
v_pk_mul_f16 v153, v153, v165
v_pk_mul_f16 v154, v154, v166
v_pk_mul_f16 v155, v155, v167
ds_write_b128 v224, v[152:155] offset:8192
ds_read_b128 v[120:123], v254 offset:7936
ds_read_b128 v[124:127], v254 offset:7952
ds_read_b128 v[128:131], v254 offset:7936
ds_read_b128 v[132:135], v254 offset:7952
ds_read_b128 v[136:139], v254 offset:8064
ds_read_b128 v[140:143], v254 offset:8080
ds_read_b128 v[144:147], v254 offset:8064
ds_read_b128 v[148:151], v254 offset:8080
ds_read_b128 v[152:155], v254 offset:16128
ds_read_b128 v[156:159], v254 offset:16144
ds_read_b128 v[160:163], v254 offset:16128
ds_read_b128 v[164:167], v254 offset:16144
s_waitcnt lgkmcnt(12)
s_barrier
s_setprio 3
ds_read_b128 v[224:227], v249 offset:24576
ds_read_b128 v[228:231], v249 offset:24832
s_waitcnt lgkmcnt(1)
v_mfma_f32_16x16x32_f16 v[120:123], v[224:227], v[0:3], v[120:123]
v_mfma_f32_16x16x32_f16 v[128:131], v[224:227], v[4:7], v[128:131]
v_permlane16_swap_b32 v16, v20
s_waitcnt lgkmcnt(0)
v_mfma_f32_16x16x32_f16 v[124:127], v[228:231], v[0:3], v[124:127]
ds_read_b128 v[224:227], v249 offset:25600
v_mfma_f32_16x16x32_f16 v[132:135], v[228:231], v[4:7], v[132:135]
v_permlane16_swap_b32 v17, v21
s_waitcnt lgkmcnt(0)
v_mfma_f32_16x16x32_f16 v[136:139], v[224:227], v[0:3], v[136:139]
ds_read_b128 v[228:231], v249 offset:25856
v_mfma_f32_16x16x32_f16 v[144:147], v[224:227], v[4:7], v[144:147]
v_permlane16_swap_b32 v18, v22
s_waitcnt lgkmcnt(0)
v_mfma_f32_16x16x32_f16 v[140:143], v[228:231], v[0:3], v[140:143]
ds_read_b128 v[224:227], v249 offset:26624
v_mfma_f32_16x16x32_f16 v[148:151], v[228:231], v[4:7], v[148:151]
v_permlane16_swap_b32 v19, v23
s_waitcnt lgkmcnt(0)
v_mfma_f32_16x16x32_f16 v[152:155], v[224:227], v[0:3], v[152:155]
ds_read_b128 v[228:231], v249 offset:26880
v_mfma_f32_16x16x32_f16 v[160:163], v[224:227], v[4:7], v[160:163]
v_permlane16_swap_b32 v24, v28
s_waitcnt lgkmcnt(0)
v_mfma_f32_16x16x32_f16 v[156:159], v[228:231], v[0:3], v[156:159]
ds_read_b128 v[224:227], v249 offset:30720
v_mfma_f32_16x16x32_f16 v[164:167], v[228:231], v[4:7], v[164:167]
v_permlane16_swap_b32 v25, v29
s_waitcnt lgkmcnt(0)
v_mfma_f32_16x16x32_f16 v[120:123], v[224:227], v[8:11], v[120:123]
ds_read_b128 v[228:231], v249 offset:30976
ds_read_b128 v[0:3], v249 offset:31744
ds_read_b128 v[4:7], v249 offset:32000
v_mfma_f32_16x16x32_f16 v[128:131], v[224:227], v[12:15], v[128:131]
v_permlane16_swap_b32 v26, v30
s_waitcnt lgkmcnt(2)
v_mfma_f32_16x16x32_f16 v[124:127], v[228:231], v[8:11], v[124:127]
ds_read_b128 v[224:227], v249 offset:32768
v_mfma_f32_16x16x32_f16 v[132:135], v[228:231], v[12:15], v[132:135]
v_permlane16_swap_b32 v27, v31
s_waitcnt lgkmcnt(2)
v_mfma_f32_16x16x32_f16 v[136:139], v[0:3], v[8:11], v[136:139]
ds_read_b128 v[228:231], v249 offset:33024
v_mfma_f32_16x16x32_f16 v[144:147], v[0:3], v[12:15], v[144:147]
v_permlane16_swap_b32 v96, v100
s_waitcnt lgkmcnt(2)
v_mfma_f32_16x16x32_f16 v[140:143], v[4:7], v[8:11], v[140:143]
ds_read_b128 v[0:3], v249 offset:36864
v_mfma_f32_16x16x32_f16 v[148:151], v[4:7], v[12:15], v[148:151]
v_permlane16_swap_b32 v97, v101
s_waitcnt lgkmcnt(2)
v_mfma_f32_16x16x32_f16 v[152:155], v[224:227], v[8:11], v[152:155]
ds_read_b128 v[4:7], v249 offset:37120
v_mfma_f32_16x16x32_f16 v[160:163], v[224:227], v[12:15], v[160:163]
v_permlane16_swap_b32 v98, v102
s_waitcnt lgkmcnt(2)
v_mfma_f32_16x16x32_f16 v[156:159], v[228:231], v[8:11], v[156:159]
ds_read_b128 v[224:227], v249 offset:37888
v_mfma_f32_16x16x32_f16 v[164:167], v[228:231], v[12:15], v[164:167]
v_permlane16_swap_b32 v99, v103
s_waitcnt lgkmcnt(2)
v_mfma_f32_16x16x32_f16 v[120:123], v[0:3], v[16:19], v[120:123]
buffer_load_dwordx4 v[12:15], v252, s[4:7], s71 offen
ds_read_b128 v[228:231], v249 offset:38144
v_mfma_f32_16x16x32_f16 v[128:131], v[0:3], v[20:23], v[128:131]
v_permlane16_swap_b32 v32, v36
s_waitcnt lgkmcnt(2)
v_mfma_f32_16x16x32_f16 v[124:127], v[4:7], v[16:19], v[124:127]
ds_read_b128 v[0:3], v249 offset:38912
v_mfma_f32_16x16x32_f16 v[132:135], v[4:7], v[20:23], v[132:135]
v_permlane16_swap_b32 v33, v37
s_waitcnt lgkmcnt(2)
v_mfma_f32_16x16x32_f16 v[136:139], v[224:227], v[16:19], v[136:139]
ds_read_b128 v[4:7], v249 offset:39168
v_mfma_f32_16x16x32_f16 v[144:147], v[224:227], v[20:23], v[144:147]
v_permlane16_swap_b32 v34, v38
s_waitcnt lgkmcnt(2)
v_mfma_f32_16x16x32_f16 v[140:143], v[228:231], v[16:19], v[140:143]
ds_read_b128 v[224:227], v249 offset:43008
v_mfma_f32_16x16x32_f16 v[148:151], v[228:231], v[20:23], v[148:151]
v_permlane16_swap_b32 v35, v39
s_waitcnt lgkmcnt(2)
v_mfma_f32_16x16x32_f16 v[152:155], v[0:3], v[16:19], v[152:155]
ds_read_b128 v[228:231], v249 offset:43264
v_mfma_f32_16x16x32_f16 v[160:163], v[0:3], v[20:23], v[160:163]
v_permlane16_swap_b32 v40, v44
s_waitcnt lgkmcnt(2)
v_mfma_f32_16x16x32_f16 v[156:159], v[4:7], v[16:19], v[156:159]
ds_read_b128 v[0:3], v249 offset:44032
v_mfma_f32_16x16x32_f16 v[164:167], v[4:7], v[20:23], v[164:167]
v_permlane16_swap_b32 v41, v45
s_waitcnt lgkmcnt(2)
v_mfma_f32_16x16x32_f16 v[120:123], v[224:227], v[24:27], v[120:123]
buffer_load_dwordx4 v[8:11], v252, s[4:7], s71 offen offset:64
ds_read_b128 v[4:7], v249 offset:44288
v_mfma_f32_16x16x32_f16 v[128:131], v[224:227], v[28:31], v[128:131]
v_permlane16_swap_b32 v42, v46
s_waitcnt lgkmcnt(2)
v_mfma_f32_16x16x32_f16 v[124:127], v[228:231], v[24:27], v[124:127]
ds_read_b128 v[224:227], v249 offset:45056
v_mfma_f32_16x16x32_f16 v[132:135], v[228:231], v[28:31], v[132:135]
v_permlane16_swap_b32 v43, v47
s_waitcnt lgkmcnt(2)
v_mfma_f32_16x16x32_f16 v[136:139], v[0:3], v[24:27], v[136:139]
ds_read_b128 v[228:231], v249 offset:45312
v_mfma_f32_16x16x32_f16 v[144:147], v[0:3], v[28:31], v[144:147]
v_permlane16_swap_b32 v104, v108
s_waitcnt lgkmcnt(2)
v_mfma_f32_16x16x32_f16 v[140:143], v[4:7], v[24:27], v[140:143]
ds_read_b128 v[0:3], v249 offset:49152
v_mfma_f32_16x16x32_f16 v[148:151], v[4:7], v[28:31], v[148:151]
v_permlane16_swap_b32 v105, v109
s_waitcnt lgkmcnt(2)
v_mfma_f32_16x16x32_f16 v[152:155], v[224:227], v[24:27], v[152:155]
ds_read_b128 v[4:7], v249 offset:49408
v_mfma_f32_16x16x32_f16 v[160:163], v[224:227], v[28:31], v[160:163]
v_permlane16_swap_b32 v106, v110
s_waitcnt lgkmcnt(2)
v_mfma_f32_16x16x32_f16 v[156:159], v[228:231], v[24:27], v[156:159]
ds_read_b128 v[224:227], v249 offset:50176
v_mfma_f32_16x16x32_f16 v[164:167], v[228:231], v[28:31], v[164:167]
v_permlane16_swap_b32 v107, v111
s_waitcnt lgkmcnt(2)
v_mfma_f32_16x16x32_f16 v[120:123], v[0:3], v[32:35], v[120:123]
buffer_load_dwordx4 v[16:19], v252, s[4:7], s71 offen offset:128
ds_read_b128 v[228:231], v249 offset:50432
v_mfma_f32_16x16x32_f16 v[128:131], v[0:3], v[36:39], v[128:131]
v_permlane16_swap_b32 v48, v52
s_waitcnt lgkmcnt(2)
v_mfma_f32_16x16x32_f16 v[124:127], v[4:7], v[32:35], v[124:127]
ds_read_b128 v[0:3], v249 offset:51200
v_mfma_f32_16x16x32_f16 v[132:135], v[4:7], v[36:39], v[132:135]
v_permlane16_swap_b32 v49, v53
s_waitcnt lgkmcnt(2)
v_mfma_f32_16x16x32_f16 v[136:139], v[224:227], v[32:35], v[136:139]
ds_read_b128 v[4:7], v249 offset:51456
v_permlane16_swap_b32 v50, v54
v_mfma_f32_16x16x32_f16 v[144:147], v[224:227], v[36:39], v[144:147]
s_waitcnt lgkmcnt(2)
v_mfma_f32_16x16x32_f16 v[140:143], v[228:231], v[32:35], v[140:143]
ds_read_b128 v[224:227], v249 offset:55296
v_permlane16_swap_b32 v51, v55
v_mfma_f32_16x16x32_f16 v[148:151], v[228:231], v[36:39], v[148:151]
v_permlane16_swap_b32 v56, v60
s_waitcnt lgkmcnt(2)
v_mfma_f32_16x16x32_f16 v[152:155], v[0:3], v[32:35], v[152:155]
ds_read_b128 v[228:231], v249 offset:55552
v_mfma_f32_16x16x32_f16 v[160:163], v[0:3], v[36:39], v[160:163]
v_permlane16_swap_b32 v57, v61
s_waitcnt lgkmcnt(2)
v_mfma_f32_16x16x32_f16 v[156:159], v[4:7], v[32:35], v[156:159]
ds_read_b128 v[0:3], v249 offset:56320
v_permlane16_swap_b32 v58, v62
v_mfma_f32_16x16x32_f16 v[164:167], v[4:7], v[36:39], v[164:167]
s_waitcnt lgkmcnt(2)
v_mfma_f32_16x16x32_f16 v[120:123], v[224:227], v[40:43], v[120:123]
s_add_u32 s46, s71, 98304
buffer_load_dwordx4 v[20:23], v252, s[4:7], s46 offen
ds_read_b128 v[4:7], v249 offset:56576
v_permlane16_swap_b32 v59, v63
v_mfma_f32_16x16x32_f16 v[128:131], v[224:227], v[44:47], v[128:131]
v_and_b32 v24, 1, v251
v_lshlrev_b32 v24, 4, v24
s_waitcnt lgkmcnt(2)
v_mfma_f32_16x16x32_f16 v[124:127], v[228:231], v[40:43], v[124:127]
ds_read_b128 v[224:227], v249 offset:57344
v_mov_b32 v25, 16256
v_mfma_f32_16x16x32_f16 v[132:135], v[228:231], v[44:47], v[132:135]
v_lshlrev_b32 v24, v24, v25
s_waitcnt lgkmcnt(2)
v_mfma_f32_16x16x32_f16 v[136:139], v[0:3], v[40:43], v[136:139]
ds_read_b128 v[228:231], v249 offset:57600
v_lshrrev_b32 v25, 2, v251
v_mfma_f32_16x16x32_f16 v[144:147], v[0:3], v[44:47], v[144:147]
v_xor_b32 v25, v25, v251
v_and_b32 v25, 12, v25
s_waitcnt lgkmcnt(2)
v_mfma_f32_16x16x32_f16 v[140:143], v[4:7], v[40:43], v[140:143]
ds_read_b128 v[0:3], v249 offset:61440
v_and_b32 v28, 2, v251
v_mfma_f32_16x16x32_f16 v[148:151], v[4:7], v[44:47], v[148:151]
v_or_b32 v25, v25, v28
s_waitcnt lgkmcnt(2)
v_mfma_f32_16x16x32_f16 v[152:155], v[224:227], v[40:43], v[152:155]
ds_read_b128 v[4:7], v249 offset:61696
v_cmp_eq_u32 vcc, 0, v25
s_nop 1
v_cndmask_b32 v26, 0, v24, vcc
v_cmp_eq_u32 vcc, 2, v25
s_nop 1
v_cndmask_b32 v27, 0, v24, vcc
v_mfma_f32_16x16x32_f16 v[160:163], v[224:227], v[44:47], v[160:163]
v_mov_b32 v24, 0
s_waitcnt lgkmcnt(2)
v_mfma_f32_16x16x32_f16 v[156:159], v[228:231], v[40:43], v[156:159]
ds_read_b128 v[224:227], v249 offset:62464
v_mov_b32 v25, 0
v_mfma_f32_16x16x32_f16 v[164:167], v[228:231], v[44:47], v[164:167]
v_mov_b32 v28, 0
v_mov_b32 v29, 0
s_waitcnt lgkmcnt(2)
v_mfma_f32_16x16x32_f16 v[120:123], v[0:3], v[48:51], v[120:123]
s_add_u32 s46, s80, 8388608
buffer_load_dwordx4 v[32:35], v253, s[32:35], s46 offen nt
ds_read_b128 v[228:231], v249 offset:62720
v_mfma_f32_16x16x32_f16 v[128:131], v[0:3], v[52:55], v[128:131]
s_waitcnt lgkmcnt(2)
v_mfma_f32_16x16x32_f16 v[124:127], v[4:7], v[48:51], v[124:127]
ds_read_b128 v[0:3], v249 offset:63488
v_permlane16_swap_b32 v64, v68
v_mfma_f32_16x16x32_f16 v[132:135], v[4:7], v[52:55], v[132:135]
s_waitcnt lgkmcnt(2)
v_mfma_f32_16x16x32_f16 v[136:139], v[224:227], v[48:51], v[136:139]
ds_read_b128 v[4:7], v249 offset:63744
v_permlane16_swap_b32 v65, v69
v_mfma_f32_16x16x32_f16 v[144:147], v[224:227], v[52:55], v[144:147]
s_waitcnt lgkmcnt(2)
v_mfma_f32_16x16x32_f16 v[140:143], v[228:231], v[48:51], v[140:143]
ds_read_b128 v[224:227], v250 offset:2048
v_permlane16_swap_b32 v66, v70
v_mfma_f32_16x16x32_f16 v[148:151], v[228:231], v[52:55], v[148:151]
s_waitcnt lgkmcnt(2)
v_mfma_f32_16x16x32_f16 v[152:155], v[0:3], v[48:51], v[152:155]
ds_read_b128 v[228:231], v250 offset:2304
v_mfma_f32_16x16x32_f16 v[160:163], v[0:3], v[52:55], v[160:163]
v_permlane16_swap_b32 v67, v71
s_waitcnt lgkmcnt(2)
v_mfma_f32_16x16x32_f16 v[156:159], v[4:7], v[48:51], v[156:159]
ds_read_b128 v[0:3], v250 offset:3072
v_mfma_f32_16x16x32_f16 v[164:167], v[4:7], v[52:55], v[164:167]
v_permlane16_swap_b32 v72, v76
s_waitcnt lgkmcnt(2)
v_mfma_f32_16x16x32_f16 v[120:123], v[224:227], v[56:59], v[120:123]
ds_read_b128 v[4:7], v250 offset:3328
v_mfma_f32_16x16x32_f16 v[128:131], v[224:227], v[60:63], v[128:131]
v_permlane16_swap_b32 v73, v77
s_waitcnt lgkmcnt(2)
v_mfma_f32_16x16x32_f16 v[124:127], v[228:231], v[56:59], v[124:127]
s_add_u32 s46, s80, 8388608
buffer_load_dwordx4 v[36:39], v253, s[32:35], s46 offen offset:256 nt
ds_read_b128 v[224:227], v250 offset:4096
v_mfma_f32_16x16x32_f16 v[132:135], v[228:231], v[60:63], v[132:135]
s_waitcnt lgkmcnt(2)
v_mfma_f32_16x16x32_f16 v[136:139], v[0:3], v[56:59], v[136:139]
ds_read_b128 v[228:231], v250 offset:4352
v_permlane16_swap_b32 v74, v78
v_mfma_f32_16x16x32_f16 v[144:147], v[0:3], v[60:63], v[144:147]
s_waitcnt lgkmcnt(2)
v_mfma_f32_16x16x32_f16 v[140:143], v[4:7], v[56:59], v[140:143]
ds_read_b128 v[0:3], v250 offset:8192
v_permlane16_swap_b32 v75, v79
v_mfma_f32_16x16x32_f16 v[148:151], v[4:7], v[60:63], v[148:151]
s_waitcnt lgkmcnt(2)
v_mfma_f32_16x16x32_f16 v[152:155], v[224:227], v[56:59], v[152:155]
ds_read_b128 v[4:7], v250 offset:8448
v_permlane16_swap_b32 v200, v204
v_mfma_f32_16x16x32_f16 v[160:163], v[224:227], v[60:63], v[160:163]
s_waitcnt lgkmcnt(2)
v_mfma_f32_16x16x32_f16 v[156:159], v[228:231], v[56:59], v[156:159]
ds_read_b128 v[224:227], v250 offset:9216
v_mfma_f32_16x16x32_f16 v[164:167], v[228:231], v[60:63], v[164:167]
v_permlane16_swap_b32 v201, v205
s_waitcnt vmcnt(5)
v_mfma_f32_16x16x32_bf16 v[120:123], v[26:29], v[12:15], v[120:123]
ds_read_b128 v[228:231], v250 offset:9472
v_mfma_f32_16x16x32_bf16 v[124:127], v[24:27], v[12:15], v[124:127]
v_permlane16_swap_b32 v202, v206
s_waitcnt vmcnt(4)
v_mfma_f32_16x16x32_bf16 v[136:139], v[26:29], v[8:11], v[136:139]
v_mfma_f32_16x16x32_bf16 v[140:143], v[24:27], v[8:11], v[140:143]
v_permlane16_swap_b32 v203, v207
s_waitcnt lgkmcnt(3)
v_mfma_f32_16x16x32_f16 v[120:123], v[0:3], v[64:67], v[120:123]
s_add_u32 s46, s71, 98304
buffer_load_dwordx4 v[8:11], v252, s[4:7], s46 offen offset:64
v_mfma_f32_16x16x32_f16 v[128:131], v[0:3], v[68:71], v[128:131]
s_waitcnt lgkmcnt(2)
v_mfma_f32_16x16x32_f16 v[124:127], v[4:7], v[64:67], v[124:127]
ds_read_b128 v[0:3], v250 offset:10240
v_permlane16_swap_b32 v80, v84
v_mfma_f32_16x16x32_f16 v[132:135], v[4:7], v[68:71], v[132:135]
s_waitcnt lgkmcnt(2)
v_mfma_f32_16x16x32_f16 v[136:139], v[224:227], v[64:67], v[136:139]
ds_read_b128 v[4:7], v250 offset:10496
v_permlane16_swap_b32 v81, v85
v_mfma_f32_16x16x32_f16 v[144:147], v[224:227], v[68:71], v[144:147]
s_waitcnt lgkmcnt(2)
v_mfma_f32_16x16x32_f16 v[140:143], v[228:231], v[64:67], v[140:143]
ds_read_b128 v[224:227], v250 offset:14336
v_permlane16_swap_b32 v82, v86
v_mfma_f32_16x16x32_f16 v[148:151], v[228:231], v[68:71], v[148:151]
s_waitcnt lgkmcnt(2)
v_mfma_f32_16x16x32_f16 v[152:155], v[0:3], v[64:67], v[152:155]
ds_read_b128 v[228:231], v250 offset:14592
v_mfma_f32_16x16x32_f16 v[160:163], v[0:3], v[68:71], v[160:163]
v_permlane16_swap_b32 v83, v87
s_waitcnt lgkmcnt(2)
v_mfma_f32_16x16x32_f16 v[156:159], v[4:7], v[64:67], v[156:159]
ds_read_b128 v[0:3], v250 offset:15360
v_mfma_f32_16x16x32_f16 v[164:167], v[4:7], v[68:71], v[164:167]
v_permlane16_swap_b32 v168, v172
s_waitcnt lgkmcnt(2)
v_mfma_f32_16x16x32_f16 v[120:123], v[224:227], v[72:75], v[120:123]
ds_read_b128 v[4:7], v250 offset:15616
v_mfma_f32_16x16x32_f16 v[128:131], v[224:227], v[76:79], v[128:131]
v_permlane16_swap_b32 v169, v173
s_waitcnt lgkmcnt(2)
v_mfma_f32_16x16x32_f16 v[124:127], v[228:231], v[72:75], v[124:127]
s_add_u32 s46, s71, 98304
buffer_load_dwordx4 v[12:15], v252, s[4:7], s46 offen offset:128
ds_read_b128 v[224:227], v250 offset:16384
v_mfma_f32_16x16x32_f16 v[132:135], v[228:231], v[76:79], v[132:135]
s_waitcnt lgkmcnt(2)
v_mfma_f32_16x16x32_f16 v[136:139], v[0:3], v[72:75], v[136:139]
ds_read_b128 v[228:231], v250 offset:16640
v_permlane16_swap_b32 v170, v174
v_mfma_f32_16x16x32_f16 v[144:147], v[0:3], v[76:79], v[144:147]
s_waitcnt lgkmcnt(2)
v_mfma_f32_16x16x32_f16 v[140:143], v[4:7], v[72:75], v[140:143]
ds_read_b128 v[0:3], v250 offset:20480
v_permlane16_swap_b32 v171, v175
v_mfma_f32_16x16x32_f16 v[148:151], v[4:7], v[76:79], v[148:151]
s_waitcnt lgkmcnt(2)
v_mfma_f32_16x16x32_f16 v[152:155], v[224:227], v[72:75], v[152:155]
ds_read_b128 v[4:7], v250 offset:20736
v_permlane16_swap_b32 v192, v196
v_mfma_f32_16x16x32_f16 v[160:163], v[224:227], v[76:79], v[160:163]
s_waitcnt lgkmcnt(2)
v_mfma_f32_16x16x32_f16 v[156:159], v[228:231], v[72:75], v[156:159]
ds_read_b128 v[224:227], v250 offset:21504
v_mfma_f32_16x16x32_f16 v[164:167], v[228:231], v[76:79], v[164:167]
v_permlane16_swap_b32 v193, v197
s_waitcnt vmcnt(5)
v_mfma_f32_16x16x32_bf16 v[152:155], v[26:29], v[16:19], v[152:155]
ds_read_b128 v[228:231], v250 offset:21760
v_mfma_f32_16x16x32_bf16 v[156:159], v[24:27], v[16:19], v[156:159]
v_permlane16_swap_b32 v194, v198
s_waitcnt vmcnt(4)
v_mfma_f32_16x16x32_bf16 v[128:131], v[26:29], v[20:23], v[128:131]
v_mfma_f32_16x16x32_bf16 v[132:135], v[24:27], v[20:23], v[132:135]
v_permlane16_swap_b32 v195, v199
v_and_b32 v255, 1, v251
v_lshlrev_b32 v255, 7, v255
v_sub_u32 v255, v252, v255
s_mov_b32 s74, 1431655765
s_mov_b32 s75, 1431655765
s_waitcnt lgkmcnt(3)
v_mfma_f32_16x16x32_f16 v[120:123], v[0:3], v[80:83], v[120:123]
buffer_load_dwordx4 v[20:23], v252, s[4:7], s70 offen
v_mfma_f32_16x16x32_f16 v[128:131], v[0:3], v[84:87], v[128:131]
v_permlane16_swap_b32 v176, v180
s_waitcnt lgkmcnt(2)
v_mfma_f32_16x16x32_f16 v[124:127], v[4:7], v[80:83], v[124:127]
ds_read_b128 v[0:3], v250 offset:22528
v_mfma_f32_16x16x32_f16 v[132:135], v[4:7], v[84:87], v[132:135]
v_permlane16_swap_b32 v177, v181
s_waitcnt lgkmcnt(2)
v_mfma_f32_16x16x32_f16 v[136:139], v[224:227], v[80:83], v[136:139]
ds_read_b128 v[4:7], v250 offset:22784
v_mfma_f32_16x16x32_f16 v[144:147], v[224:227], v[84:87], v[144:147]
v_permlane16_swap_b32 v178, v182
s_waitcnt lgkmcnt(2)
v_mfma_f32_16x16x32_f16 v[140:143], v[228:231], v[80:83], v[140:143]
ds_read_b128 v[224:227], v250 offset:26624
v_mfma_f32_16x16x32_f16 v[148:151], v[228:231], v[84:87], v[148:151]
v_permlane16_swap_b32 v179, v183
s_waitcnt lgkmcnt(2)
v_mfma_f32_16x16x32_f16 v[152:155], v[0:3], v[80:83], v[152:155]
ds_read_b128 v[228:231], v250 offset:26880
v_mfma_f32_16x16x32_f16 v[160:163], v[0:3], v[84:87], v[160:163]
v_permlane16_swap_b32 v184, v188
s_waitcnt lgkmcnt(2)
v_mfma_f32_16x16x32_f16 v[156:159], v[4:7], v[80:83], v[156:159]
ds_read_b128 v[0:3], v250 offset:27648
v_mfma_f32_16x16x32_f16 v[164:167], v[4:7], v[84:87], v[164:167]
v_permlane16_swap_b32 v185, v189
s_waitcnt lgkmcnt(2)
v_mfma_f32_16x16x32_f16 v[120:123], v[224:227], v[168:171], v[120:123]
buffer_load_dwordx4 v[16:19], v252, s[4:7], s70 offen offset:64
ds_read_b128 v[4:7], v250 offset:27904
v_mfma_f32_16x16x32_f16 v[128:131], v[224:227], v[172:175], v[128:131]
v_permlane16_swap_b32 v186, v190
s_waitcnt lgkmcnt(2)
v_mfma_f32_16x16x32_f16 v[124:127], v[228:231], v[168:171], v[124:127]
ds_read_b128 v[224:227], v250 offset:28672
v_mfma_f32_16x16x32_f16 v[132:135], v[228:231], v[172:175], v[132:135]
v_permlane16_swap_b32 v187, v191
s_waitcnt lgkmcnt(2)
v_mfma_f32_16x16x32_f16 v[136:139], v[0:3], v[168:171], v[136:139]
ds_read_b128 v[228:231], v250 offset:28928
v_mfma_f32_16x16x32_f16 v[144:147], v[0:3], v[172:175], v[144:147]
v_permlane16_swap_b32 v112, v116
s_waitcnt lgkmcnt(2)
v_mfma_f32_16x16x32_f16 v[140:143], v[4:7], v[168:171], v[140:143]
ds_read_b128 v[0:3], v249 offset:55296
v_mfma_f32_16x16x32_f16 v[148:151], v[4:7], v[172:175], v[148:151]
v_permlane16_swap_b32 v113, v117
s_waitcnt lgkmcnt(2)
v_mfma_f32_16x16x32_f16 v[152:155], v[224:227], v[168:171], v[152:155]
ds_read_b128 v[4:7], v254 offset:7936
v_mfma_f32_16x16x32_f16 v[160:163], v[224:227], v[172:175], v[160:163]
v_permlane16_swap_b32 v114, v118
s_waitcnt lgkmcnt(2)
v_mfma_f32_16x16x32_f16 v[156:159], v[228:231], v[168:171], v[156:159]
ds_read_b128 v[224:227], v249 offset:55552
v_mfma_f32_16x16x32_f16 v[164:167], v[228:231], v[172:175], v[164:167]
v_permlane16_swap_b32 v115, v119
s_waitcnt lgkmcnt(1)
v_mfma_f32_16x16x32_f16 v[48:51], v[0:3], v[176:179], v[4:7]
ds_read_b128 v[228:231], v254 offset:7952
v_mfma_f32_16x16x32_f16 v[56:59], v[0:3], v[180:183], v[4:7]
s_waitcnt lgkmcnt(0)
v_mfma_f32_16x16x32_f16 v[52:55], v[224:227], v[176:179], v[228:231]
ds_read_b128 v[0:3], v249 offset:56320
ds_read_b128 v[4:7], v254 offset:8064
v_mfma_f32_16x16x32_f16 v[60:63], v[224:227], v[180:183], v[228:231]
s_waitcnt lgkmcnt(0)
v_mfma_f32_16x16x32_f16 v[64:67], v[0:3], v[176:179], v[4:7]
ds_read_b128 v[224:227], v249 offset:56576
ds_read_b128 v[228:231], v254 offset:8080
v_mfma_f32_16x16x32_f16 v[72:75], v[0:3], v[180:183], v[4:7]
v_permlane16_swap_b32 v88, v92
s_waitcnt lgkmcnt(0)
v_mfma_f32_16x16x32_f16 v[68:71], v[224:227], v[176:179], v[228:231]
ds_read_b128 v[0:3], v249 offset:57344
ds_read_b128 v[4:7], v254 offset:16128
v_mfma_f32_16x16x32_f16 v[76:79], v[224:227], v[180:183], v[228:231]
v_permlane16_swap_b32 v89, v93
s_waitcnt lgkmcnt(0)
v_mfma_f32_16x16x32_f16 v[80:83], v[0:3], v[176:179], v[4:7]
ds_read_b128 v[224:227], v249 offset:57600
ds_read_b128 v[228:231], v254 offset:16144
v_permlane16_swap_b32 v90, v94
v_mfma_f32_16x16x32_f16 v[168:171], v[0:3], v[180:183], v[4:7]
s_waitcnt lgkmcnt(0)
v_mfma_f32_16x16x32_f16 v[84:87], v[224:227], v[176:179], v[228:231]
ds_read_b128 v[0:3], v249 offset:61440
ds_read_b128 v[4:7], v249 offset:61696
v_permlane16_swap_b32 v91, v95
v_mfma_f32_16x16x32_f16 v[172:175], v[224:227], v[180:183], v[228:231]
v_cvt_pk_bf16_f32 v136, v136, v137
v_cvt_pk_bf16_f32 v137, v138, v139
s_waitcnt lgkmcnt(1)
v_mfma_f32_16x16x32_f16 v[48:51], v[0:3], v[184:187], v[48:51]
ds_read_b128 v[224:227], v249 offset:62464
ds_read_b128 v[228:231], v249 offset:62720
v_cvt_pk_bf16_f32 v138, v140, v141
v_mfma_f32_16x16x32_f16 v[56:59], v[0:3], v[188:191], v[56:59]
v_cvt_pk_bf16_f32 v139, v142, v143
v_cvt_pk_bf16_f32 v120, v120, v121
s_waitcnt lgkmcnt(2)
v_mfma_f32_16x16x32_f16 v[52:55], v[4:7], v[184:187], v[52:55]
ds_read_b128 v[0:3], v249 offset:63488
v_cvt_pk_bf16_f32 v121, v122, v123
v_mfma_f32_16x16x32_f16 v[60:63], v[4:7], v[188:191], v[60:63]
v_cvt_pk_bf16_f32 v122, v124, v125
s_waitcnt lgkmcnt(2)
v_mfma_f32_16x16x32_f16 v[64:67], v[224:227], v[184:187], v[64:67]
ds_read_b128 v[4:7], v249 offset:63744
v_cvt_pk_bf16_f32 v123, v126, v127
v_cvt_pk_bf16_f32 v152, v152, v153
v_mfma_f32_16x16x32_f16 v[72:75], v[224:227], v[188:191], v[72:75]
v_cvt_pk_bf16_f32 v153, v154, v155
s_waitcnt lgkmcnt(2)
v_mfma_f32_16x16x32_f16 v[68:71], v[228:231], v[184:187], v[68:71]
ds_read_b128 v[224:227], v250 offset:2048
v_cvt_pk_bf16_f32 v154, v156, v157
v_mfma_f32_16x16x32_f16 v[76:79], v[228:231], v[188:191], v[76:79]
v_cvt_pk_bf16_f32 v155, v158, v159
s_mov_b64 vcc, s[74:75]
v_cndmask_b32_e64 v140, v120, v152, s[74:75]
s_waitcnt lgkmcnt(2)
v_mfma_f32_16x16x32_f16 v[80:83], v[0:3], v[184:187], v[80:83]
ds_read_b128 v[228:231], v250 offset:2304
v_cndmask_b32_dpp v120, v136, v120, vcc quad_perm:[1,0,3,2] row_mask:0xf bank_mask:0xf
v_mfma_f32_16x16x32_f16 v[168:171], v[0:3], v[188:191], v[168:171]
v_cndmask_b32_e64 v141, v121, v153, s[74:75]
s_waitcnt lgkmcnt(2)
v_mfma_f32_16x16x32_f16 v[84:87], v[4:7], v[184:187], v[84:87]
ds_read_b128 v[0:3], v248 offset:16384
v_cndmask_b32_dpp v121, v137, v121, vcc quad_perm:[1,0,3,2] row_mask:0xf bank_mask:0xf
v_cndmask_b32_e64 v142, v122, v154, s[74:75]
v_mfma_f32_16x16x32_f16 v[172:175], v[4:7], v[188:191], v[172:175]
v_cndmask_b32_dpp v122, v138, v122, vcc quad_perm:[1,0,3,2] row_mask:0xf bank_mask:0xf
s_waitcnt vmcnt(3)
v_mfma_f32_16x16x32_bf16 v[144:147], v[26:29], v[8:11], v[144:147]
ds_read_b128 v[4:7], v250 offset:3072
v_cndmask_b32_e64 v143, v123, v155, s[74:75]
v_mfma_f32_16x16x32_bf16 v[148:151], v[24:27], v[8:11], v[148:151]
v_cndmask_b32_dpp v123, v139, v123, vcc quad_perm:[1,0,3,2] row_mask:0xf bank_mask:0xf
s_not_b64 vcc, s[74:75]
v_cndmask_b32_dpp v152, v136, v152, vcc quad_perm:[1,0,3,2] row_mask:0xf bank_mask:0xf
s_waitcnt vmcnt(2)
v_mfma_f32_16x16x32_bf16 v[160:163], v[26:29], v[12:15], v[160:163]
v_cndmask_b32_dpp v153, v137, v153, vcc quad_perm:[1,0,3,2] row_mask:0xf bank_mask:0xf
v_mfma_f32_16x16x32_bf16 v[164:167], v[24:27], v[12:15], v[164:167]
v_cndmask_b32_dpp v154, v138, v154, vcc quad_perm:[1,0,3,2] row_mask:0xf bank_mask:0xf
v_cndmask_b32_dpp v155, v139, v155, vcc quad_perm:[1,0,3,2] row_mask:0xf bank_mask:0xf
s_waitcnt lgkmcnt(2)
v_mfma_f32_16x16x32_f16 v[48:51], v[224:227], v[192:195], v[48:51]
buffer_load_dwordx4 v[8:11], v252, s[4:7], s70 offen offset:128
buffer_store_dwordx4 v[120:123], v255, s[8:11], s71 offen sc1
v_mfma_f32_16x16x32_f16 v[56:59], v[224:227], v[196:199], v[56:59]
v_mfma_f32_16x16x32_f16 v[52:55], v[228:231], v[192:195], v[52:55]
ds_read_b128 v[224:227], v250 offset:3328
v_permlane16_swap_b32 v240, v244
v_mfma_f32_16x16x32_f16 v[60:63], v[228:231], v[196:199], v[60:63]
s_waitcnt lgkmcnt(2)
v_mfma_f32_16x16x32_bf16 v[176:179], v[0:3], v[96:99], 0
ds_read_b128 v[228:231], v250 offset:4096
v_permlane16_swap_b32 v241, v245
v_mfma_f32_16x16x32_bf16 v[184:187], v[0:3], v[100:103], 0
s_waitcnt lgkmcnt(2)
v_mfma_f32_16x16x32_f16 v[64:67], v[4:7], v[192:195], v[64:67]
ds_read_b128 v[0:3], v250 offset:4352
v_mfma_f32_16x16x32_f16 v[72:75], v[4:7], v[196:199], v[72:75]
v_permlane16_swap_b32 v242, v246
s_waitcnt lgkmcnt(2)
v_mfma_f32_16x16x32_f16 v[68:71], v[224:227], v[192:195], v[68:71]
ds_read_b128 v[4:7], v248 offset:16640
v_mfma_f32_16x16x32_f16 v[76:79], v[224:227], v[196:199], v[76:79]
v_permlane16_swap_b32 v243, v247
s_waitcnt lgkmcnt(2)
v_mfma_f32_16x16x32_f16 v[80:83], v[228:231], v[192:195], v[80:83]
s_add_u32 s46, s70, 98304
buffer_load_dwordx4 v[12:15], v252, s[4:7], s46 offen
ds_read_b128 v[224:227], v250 offset:8192
v_mfma_f32_16x16x32_f16 v[168:171], v[228:231], v[196:199], v[168:171]
s_waitcnt lgkmcnt(2)
v_mfma_f32_16x16x32_f16 v[84:87], v[0:3], v[192:195], v[84:87]
ds_read_b128 v[228:231], v250 offset:8448
v_permlane16_swap_b32 v232, v236
v_mfma_f32_16x16x32_f16 v[172:175], v[0:3], v[196:199], v[172:175]
s_waitcnt lgkmcnt(2)
v_mfma_f32_16x16x32_bf16 v[180:183], v[4:7], v[96:99], 0
ds_read_b128 v[0:3], v250 offset:9216
v_permlane16_swap_b32 v233, v237
v_mfma_f32_16x16x32_bf16 v[188:191], v[4:7], v[100:103], 0
s_waitcnt lgkmcnt(2)
v_mfma_f32_16x16x32_f16 v[48:51], v[224:227], v[200:203], v[48:51]
ds_read_b128 v[4:7], v250 offset:9472
v_mfma_f32_16x16x32_f16 v[56:59], v[224:227], v[204:207], v[56:59]
v_permlane16_swap_b32 v234, v238
s_waitcnt lgkmcnt(2)
v_mfma_f32_16x16x32_f16 v[52:55], v[228:231], v[200:203], v[52:55]
ds_read_b128 v[224:227], v248 offset:17408
v_mfma_f32_16x16x32_f16 v[60:63], v[228:231], v[204:207], v[60:63]
v_permlane16_swap_b32 v235, v239
s_waitcnt lgkmcnt(2)
v_mfma_f32_16x16x32_f16 v[64:67], v[0:3], v[200:203], v[64:67]
buffer_store_dwordx4 v[140:143], v255, s[8:11], s71 offen offset:128 sc1
ds_read_b128 v[228:231], v250 offset:10240
v_mfma_f32_16x16x32_f16 v[72:75], v[0:3], v[204:207], v[72:75]
s_waitcnt lgkmcnt(2)
v_mfma_f32_16x16x32_f16 v[68:71], v[4:7], v[200:203], v[68:71]
ds_read_b128 v[0:3], v250 offset:10496
v_permlane16_swap_b32 v216, v220
v_mfma_f32_16x16x32_f16 v[76:79], v[4:7], v[204:207], v[76:79]
s_waitcnt lgkmcnt(2)
v_mfma_f32_16x16x32_bf16 v[176:179], v[224:227], v[104:107], v[176:179]
ds_read_b128 v[4:7], v250 offset:14336
v_permlane16_swap_b32 v217, v221
v_mfma_f32_16x16x32_bf16 v[184:187], v[224:227], v[108:111], v[184:187]
s_waitcnt lgkmcnt(2)
v_mfma_f32_16x16x32_f16 v[80:83], v[228:231], v[200:203], v[80:83]
ds_read_b128 v[224:227], v250 offset:14592
v_mfma_f32_16x16x32_f16 v[168:171], v[228:231], v[204:207], v[168:171]
v_permlane16_swap_b32 v218, v222
s_waitcnt lgkmcnt(2)
v_mfma_f32_16x16x32_f16 v[84:87], v[0:3], v[200:203], v[84:87]
ds_read_b128 v[228:231], v248 offset:17664
v_mfma_f32_16x16x32_f16 v[172:175], v[0:3], v[204:207], v[172:175]
v_permlane16_swap_b32 v219, v223
s_waitcnt lgkmcnt(2)
v_mfma_f32_16x16x32_f16 v[48:51], v[4:7], v[240:243], v[48:51]
buffer_store_dwordx4 v[152:155], v255, s[8:11], s71 offen offset:256 sc1
ds_read_b128 v[0:3], v250 offset:15360
v_mfma_f32_16x16x32_f16 v[56:59], v[4:7], v[244:247], v[56:59]
s_waitcnt lgkmcnt(2)
v_mfma_f32_16x16x32_f16 v[52:55], v[224:227], v[240:243], v[52:55]
ds_read_b128 v[4:7], v250 offset:15616
v_mfma_f32_16x16x32_f16 v[60:63], v[224:227], v[244:247], v[60:63]
s_waitcnt lgkmcnt(2)
v_mfma_f32_16x16x32_bf16 v[180:183], v[228:231], v[104:107], v[180:183]
ds_read_b128 v[224:227], v250 offset:16384
v_mfma_f32_16x16x32_bf16 v[188:191], v[228:231], v[108:111], v[188:191]
s_waitcnt lgkmcnt(2)
v_mfma_f32_16x16x32_f16 v[64:67], v[0:3], v[240:243], v[64:67]
ds_read_b128 v[228:231], v250 offset:16640
v_mfma_f32_16x16x32_f16 v[72:75], v[0:3], v[244:247], v[72:75]
s_waitcnt lgkmcnt(2)
v_mfma_f32_16x16x32_f16 v[68:71], v[4:7], v[240:243], v[68:71]
ds_read_b128 v[0:3], v248 offset:18432
v_mfma_f32_16x16x32_f16 v[76:79], v[4:7], v[244:247], v[76:79]
s_waitcnt lgkmcnt(2)
v_mfma_f32_16x16x32_f16 v[80:83], v[224:227], v[240:243], v[80:83]
ds_read_b128 v[4:7], v250 offset:20480
v_permlane16_swap_b32 v208, v212
v_mfma_f32_16x16x32_f16 v[168:171], v[224:227], v[244:247], v[168:171]
s_waitcnt lgkmcnt(2)
v_mfma_f32_16x16x32_f16 v[84:87], v[228:231], v[240:243], v[84:87]
ds_read_b128 v[224:227], v250 offset:20736
v_mfma_f32_16x16x32_f16 v[172:175], v[228:231], v[244:247], v[172:175]
s_waitcnt lgkmcnt(2)
v_mfma_f32_16x16x32_bf16 v[176:179], v[0:3], v[112:115], v[176:179]
ds_read_b128 v[228:231], v250 offset:21504
v_mfma_f32_16x16x32_bf16 v[184:187], v[0:3], v[116:119], v[184:187]
s_waitcnt lgkmcnt(2)
v_mfma_f32_16x16x32_f16 v[48:51], v[4:7], v[232:235], v[48:51]
ds_read_b128 v[0:3], v250 offset:21760
v_mfma_f32_16x16x32_f16 v[56:59], v[4:7], v[236:239], v[56:59]
s_waitcnt lgkmcnt(2)
v_mfma_f32_16x16x32_f16 v[52:55], v[224:227], v[232:235], v[52:55]
ds_read_b128 v[4:7], v248 offset:18688
v_mfma_f32_16x16x32_f16 v[60:63], v[224:227], v[236:239], v[60:63]
s_waitcnt lgkmcnt(2)
v_mfma_f32_16x16x32_f16 v[64:67], v[228:231], v[232:235], v[64:67]
ds_read_b128 v[224:227], v250 offset:22528
v_mfma_f32_16x16x32_f16 v[72:75], v[228:231], v[236:239], v[72:75]
v_permlane16_swap_b32 v209, v213
s_waitcnt lgkmcnt(2)
v_mfma_f32_16x16x32_f16 v[68:71], v[0:3], v[232:235], v[68:71]
ds_read_b128 v[228:231], v250 offset:22784
v_mfma_f32_16x16x32_f16 v[76:79], v[0:3], v[236:239], v[76:79]
s_waitcnt lgkmcnt(2)
v_mfma_f32_16x16x32_bf16 v[180:183], v[4:7], v[112:115], v[180:183]
ds_read_b128 v[0:3], v250 offset:26624
v_mfma_f32_16x16x32_bf16 v[188:191], v[4:7], v[116:119], v[188:191]
s_waitcnt lgkmcnt(2)
v_mfma_f32_16x16x32_f16 v[80:83], v[224:227], v[232:235], v[80:83]
ds_read_b128 v[4:7], v250 offset:26880
v_mfma_f32_16x16x32_f16 v[168:171], v[224:227], v[236:239], v[168:171]
s_waitcnt lgkmcnt(2)
v_mfma_f32_16x16x32_f16 v[84:87], v[228:231], v[232:235], v[84:87]
ds_read_b128 v[224:227], v250 offset:27648
v_mfma_f32_16x16x32_f16 v[172:175], v[228:231], v[236:239], v[172:175]
s_waitcnt lgkmcnt(2)
v_mfma_f32_16x16x32_f16 v[48:51], v[0:3], v[216:219], v[48:51]
ds_read_b128 v[228:231], v250 offset:27904
v_mfma_f32_16x16x32_f16 v[56:59], v[0:3], v[220:223], v[56:59]
v_permlane16_swap_b32 v210, v214
s_waitcnt lgkmcnt(2)
v_mfma_f32_16x16x32_f16 v[52:55], v[4:7], v[216:219], v[52:55]
ds_read_b128 v[0:3], v250 offset:28672
v_mfma_f32_16x16x32_f16 v[60:63], v[4:7], v[220:223], v[60:63]
s_waitcnt lgkmcnt(2)
v_mfma_f32_16x16x32_f16 v[64:67], v[224:227], v[216:219], v[64:67]
ds_read_b128 v[4:7], v250 offset:28928
v_mfma_f32_16x16x32_f16 v[72:75], v[224:227], v[220:223], v[72:75]
s_waitcnt lgkmcnt(2)
v_mfma_f32_16x16x32_f16 v[68:71], v[228:231], v[216:219], v[68:71]
ds_read_b128 v[224:227], v248 offset:22528
v_mfma_f32_16x16x32_f16 v[76:79], v[228:231], v[220:223], v[76:79]
s_waitcnt lgkmcnt(2)
v_mfma_f32_16x16x32_f16 v[80:83], v[0:3], v[216:219], v[80:83]
ds_read_b128 v[228:231], v248 offset:22784
v_mfma_f32_16x16x32_f16 v[168:171], v[0:3], v[220:223], v[168:171]
s_waitcnt lgkmcnt(2)
v_mfma_f32_16x16x32_f16 v[84:87], v[4:7], v[216:219], v[84:87]
ds_read_b128 v[0:3], v248 offset:23552
v_mfma_f32_16x16x32_f16 v[172:175], v[4:7], v[220:223], v[172:175]
v_permlane16_swap_b32 v211, v215
s_setprio 3
v_cvt_pkrtz_f16_f32 v193, v176, v177
v_cvt_pkrtz_f16_f32 v195, v178, v179
v_cvt_pkrtz_f16_f32 v197, v180, v181
v_cvt_pkrtz_f16_f32 v199, v182, v183
v_cvt_pkrtz_f16_f32 v201, v184, v185
v_cvt_pkrtz_f16_f32 v203, v186, v187
v_cvt_pk_f16_f32 v243, v188, v189
v_cvt_pk_f16_f32 v240, v190, v191
s_waitcnt lgkmcnt(2)
v_mfma_f32_16x16x32_bf16 v[176:179], v[224:227], v[96:99], 0
s_add_u32 s46, s70, 98304
buffer_load_dwordx4 v[216:219], v252, s[4:7], s46 offen offset:64
ds_read_b128 v[4:7], v248 offset:23808
v_mfma_f32_16x16x32_bf16 v[184:187], v[224:227], v[100:103], 0
v_pk_fma_f16 v242, v243, v243, s48
v_cvt_pk_bf16_f32 v144, v144, v145
v_and_b32 v193, s49, v193
v_cvt_pk_bf16_f32 v145, v146, v147
s_waitcnt lgkmcnt(2)
v_mfma_f32_16x16x32_bf16 v[180:183], v[228:231], v[96:99], 0
ds_read_b128 v[224:227], v248 offset:24576
v_and_b32 v195, s49, v195
v_cvt_pk_bf16_f32 v146, v148, v149
v_pk_fma_f16 v207, v240, v240, s48
v_lshrrev_b16 v192, 2, v193
v_cvt_pk_bf16_f32 v147, v150, v151
v_pk_mul_f16 v242, v243, v242
v_mfma_f32_16x16x32_bf16 v[188:191], v[228:231], v[100:103], 0
v_cvt_pk_bf16_f32 v128, v128, v129
v_lshrrev_b16 v194, 2, v195
v_pk_mul_f16 v207, v240, v207
v_cvt_pk_bf16_f32 v129, v130, v131
v_lshrrev_b32 v193, 18, v193
v_cvt_pk_bf16_f32 v130, v132, v133
s_waitcnt lgkmcnt(2)
v_mfma_f32_16x16x32_bf16 v[176:179], v[0:3], v[104:107], v[176:179]
ds_read_b128 v[228:231], v248 offset:24832
ds_read_u16_d16 v192, v192
ds_read_u16_d16 v194, v194
ds_read_u16_d16_hi v193, v193
v_exp_f16 v241, v242
v_cvt_pk_bf16_f32 v131, v134, v135
v_lshrrev_b32 v195, 18, v195
v_cvt_pk_bf16_f32 v160, v160, v161
v_and_b32 v197, s49, v197
v_mfma_f32_16x16x32_bf16 v[184:187], v[0:3], v[108:111], v[184:187]
v_cvt_pk_bf16_f32 v161, v162, v163
v_exp_f16 v206, v207
v_cvt_pk_bf16_f32 v162, v164, v165
v_and_b32 v199, s49, v199
v_cvt_pk_bf16_f32 v163, v166, v167
s_mov_b64 vcc, s[74:75]
s_waitcnt lgkmcnt(4)
v_mfma_f32_16x16x32_bf16 v[180:183], v[4:7], v[104:107], v[180:183]
s_add_u32 s46, s70, 98304
buffer_load_dwordx4 v[244:247], v252, s[4:7], s46 offen offset:128
ds_read_u16_d16_hi v195, v195
v_lshrrev_b16 v196, 2, v197
v_exp_f16_sdwa v241, v242 dst_sel:WORD_1 dst_unused:UNUSED_PRESERVE src0_sel:WORD_1
v_cndmask_b32_e64 v148, v128, v160, s[74:75]
v_cndmask_b32_dpp v128, v144, v128, vcc quad_perm:[1,0,3,2] row_mask:0xf bank_mask:0xf
v_lshrrev_b16 v198, 2, v199
v_mfma_f32_16x16x32_bf16 v[188:191], v[4:7], v[108:111], v[188:191]
v_cndmask_b32_e64 v149, v129, v161, s[74:75]
v_lshrrev_b32 v197, 18, v197
v_lshrrev_b32 v199, 18, v199
v_cndmask_b32_dpp v129, v145, v129, vcc quad_perm:[1,0,3,2] row_mask:0xf bank_mask:0xf
v_exp_f16_sdwa v206, v207 dst_sel:WORD_1 dst_unused:UNUSED_PRESERVE src0_sel:WORD_1
v_mfma_f32_16x16x32_bf16 v[176:179], v[224:227], v[112:115], v[176:179]
ds_read_u16_d16 v196, v196
ds_read_u16_d16 v198, v198
ds_read_u16_d16_hi v197, v197
ds_read_u16_d16_hi v199, v199
v_cndmask_b32_e64 v150, v130, v162, s[74:75]
v_and_b32 v201, s49, v201
v_cndmask_b32_dpp v130, v146, v130, vcc quad_perm:[1,0,3,2] row_mask:0xf bank_mask:0xf
v_and_b32 v203, s49, v203
v_cndmask_b32_e64 v151, v131, v163, s[74:75]
v_pk_add_f16 v241, v241, 1.0 op_sel_hi:[1,0]
v_mfma_f32_16x16x32_bf16 v[184:187], v[224:227], v[116:119], v[184:187]
v_cndmask_b32_dpp v131, v147, v131, vcc quad_perm:[1,0,3,2] row_mask:0xf bank_mask:0xf
s_not_b64 vcc, s[74:75]
v_lshrrev_b16 v200, 2, v201
v_pk_add_f16 v206, v206, 1.0 op_sel_hi:[1,0]
v_cndmask_b32_dpp v160, v144, v160, vcc quad_perm:[1,0,3,2] row_mask:0xf bank_mask:0xf
v_lshrrev_b16 v202, 2, v203
v_cndmask_b32_dpp v161, v145, v161, vcc quad_perm:[1,0,3,2] row_mask:0xf bank_mask:0xf
s_waitcnt lgkmcnt(4)
v_mfma_f32_16x16x32_bf16 v[180:183], v[228:231], v[112:115], v[180:183]
ds_read_b128 v[224:227], v249 offset:24576
ds_read_u16_d16 v200, v200
ds_read_u16_d16 v202, v202
v_rcp_f16 v242, v241
v_cndmask_b32_dpp v162, v146, v162, vcc quad_perm:[1,0,3,2] row_mask:0xf bank_mask:0xf
v_lshrrev_b32 v201, 18, v201
v_cndmask_b32_dpp v163, v147, v163, vcc quad_perm:[1,0,3,2] row_mask:0xf bank_mask:0xf
v_lshrrev_b32 v203, 18, v203
v_mfma_f32_16x16x32_bf16 v[188:191], v[228:231], v[116:119], v[188:191]
v_rcp_f16 v207, v206
v_rcp_f16_sdwa v242, v241 dst_sel:WORD_1 dst_unused:UNUSED_PRESERVE src0_sel:WORD_1
v_or_b32 v232, v192, v193
v_or_b32 v233, v194, v195
s_waitcnt lgkmcnt(3)
v_or_b32 v234, v196, v197
v_rcp_f16_sdwa v207, v206 dst_sel:WORD_1 dst_unused:UNUSED_PRESERVE src0_sel:WORD_1
v_or_b32 v235, v198, v199
ds_read_u16_d16_hi v201, v201
s_add_u32 s46, s71, 98304
buffer_store_dwordx4 v[128:131], v255, s[8:11], s46 offen sc1
ds_read_u16_d16_hi v203, v203
s_waitcnt lgkmcnt(1)
v_or_b32 v236, v200, v201
s_waitcnt lgkmcnt(0)
v_or_b32 v237, v202, v203
v_pk_mul_f16 v238, v243, v242
v_pk_mul_f16 v239, v240, v207
v_mfma_f32_16x16x32_f16 v[48:51], v[224:227], v[232:235], v[48:51]
s_add_u32 s46, s71, 98304
buffer_store_dwordx4 v[148:151], v255, s[8:11], s46 offen offset:128 sc1
ds_read_b128 v[228:231], v249 offset:24832
ds_read_b128 v[0:3], v248 offset:28672
ds_read_b128 v[4:7], v249 offset:25600
ds_read_b128 v[40:43], v248 offset:28928
ds_read_b128 v[44:47], v249 offset:25856
v_cvt_pkrtz_f16_f32 v193, v176, v177
v_cvt_pkrtz_f16_f32 v195, v178, v179
v_mfma_f32_16x16x32_f16 v[56:59], v[224:227], v[236:239], v[56:59]
v_cvt_pkrtz_f16_f32 v197, v180, v181
v_cvt_pkrtz_f16_f32 v199, v182, v183
s_waitcnt lgkmcnt(4)
v_mfma_f32_16x16x32_f16 v[52:55], v[228:231], v[232:235], v[52:55]
ds_read_b128 v[224:227], v248 offset:29696
v_cvt_pkrtz_f16_f32 v201, v184, v185
v_cvt_pk_f16_f32 v243, v186, v187
v_cvt_pk_f16_f32 v240, v188, v189
v_mfma_f32_16x16x32_f16 v[60:63], v[228:231], v[236:239], v[60:63]
v_cvt_pk_f16_f32 v205, v190, v191
v_pk_fma_f16 v242, v243, v243, s48
s_waitcnt lgkmcnt(4)
v_mfma_f32_16x16x32_bf16 v[176:179], v[0:3], v[96:99], 0
ds_read_b128 v[228:231], v249 offset:26624
v_and_b32 v193, s49, v193
v_pk_fma_f16 v207, v240, v240, s48
v_mfma_f32_16x16x32_bf16 v[184:187], v[0:3], v[100:103], 0
v_and_b32 v195, s49, v195
v_pk_fma_f16 v204, v205, v205, s48
s_setprio 2
v_lshrrev_b16 v192, 2, v193
s_waitcnt lgkmcnt(2)
v_mfma_f32_16x16x32_f16 v[64:67], v[4:7], v[232:235], v[64:67]
ds_read_b128 v[0:3], v249 offset:26880
ds_read_u16_d16 v192, v192
v_pk_mul_f16 v242, v243, v242
v_lshrrev_b16 v194, 2, v195
v_mfma_f32_16x16x32_f16 v[72:75], v[4:7], v[236:239], v[72:75]
v_pk_mul_f16 v207, v240, v207
v_lshrrev_b32 v193, 18, v193
v_mfma_f32_16x16x32_bf16 v[180:183], v[40:43], v[96:99], 0
ds_read_b128 v[4:7], v248 offset:29952
ds_read_u16_d16 v194, v194
ds_read_u16_d16_hi v193, v193
v_pk_mul_f16 v204, v205, v204
v_lshrrev_b32 v195, 18, v195
v_mfma_f32_16x16x32_bf16 v[188:191], v[40:43], v[100:103], 0
v_exp_f16 v241, v242
v_and_b32 v197, s49, v197
v_mfma_f32_16x16x32_f16 v[68:71], v[44:47], v[232:235], v[68:71]
ds_read_b128 v[40:43], v248 offset:30720
ds_read_u16_d16_hi v195, v195
v_and_b32 v199, s49, v199
v_mfma_f32_16x16x32_f16 v[76:79], v[44:47], v[236:239], v[76:79]
v_exp_f16 v206, v207
v_lshrrev_b16 v196, 2, v197
v_lshrrev_b16 v198, 2, v199
s_waitcnt lgkmcnt(7)
v_mfma_f32_16x16x32_bf16 v[176:179], v[224:227], v[104:107], v[176:179]
ds_read_b128 v[44:47], v248 offset:30976
ds_read_u16_d16 v196, v196
ds_read_u16_d16 v198, v198
v_exp_f16 v203, v204
v_mfma_f32_16x16x32_bf16 v[184:187], v[224:227], v[108:111], v[184:187]
v_lshrrev_b32 v197, 18, v197
v_lshrrev_b32 v199, 18, v199
v_mfma_f32_16x16x32_f16 v[80:83], v[228:231], v[232:235], v[80:83]
ds_read_b128 v[224:227], v249 offset:30720
ds_read_u16_d16_hi v197, v197
ds_read_u16_d16_hi v199, v199
v_exp_f16_sdwa v241, v242 dst_sel:WORD_1 dst_unused:UNUSED_PRESERVE src0_sel:WORD_1
v_and_b32 v201, s49, v201
v_mfma_f32_16x16x32_f16 v[168:171], v[228:231], v[236:239], v[168:171]
v_lshrrev_b16 v200, 2, v201
s_waitcnt lgkmcnt(8)
v_mfma_f32_16x16x32_f16 v[84:87], v[0:3], v[232:235], v[84:87]
ds_read_b128 v[228:231], v249 offset:30976
ds_read_u16_d16 v200, v200
v_exp_f16_sdwa v206, v207 dst_sel:WORD_1 dst_unused:UNUSED_PRESERVE src0_sel:WORD_1
v_lshrrev_b32 v201, 18, v201
v_mfma_f32_16x16x32_f16 v[172:175], v[0:3], v[236:239], v[172:175]
v_exp_f16_sdwa v203, v204 dst_sel:WORD_1 dst_unused:UNUSED_PRESERVE src0_sel:WORD_1
v_pk_add_f16 v241, v241, 1.0 op_sel_hi:[1,0]
v_mfma_f32_16x16x32_bf16 v[180:183], v[4:7], v[104:107], v[180:183]
ds_read_b128 v[0:3], v248 offset:34816
ds_read_u16_d16_hi v201, v201
v_pk_add_f16 v206, v206, 1.0 op_sel_hi:[1,0]
v_pk_add_f16 v203, v203, 1.0 op_sel_hi:[1,0]
v_mfma_f32_16x16x32_bf16 v[188:191], v[4:7], v[108:111], v[188:191]
v_rcp_f16 v242, v241
s_waitcnt lgkmcnt(7)
v_mfma_f32_16x16x32_bf16 v[176:179], v[40:43], v[112:115], v[176:179]
ds_read_b128 v[4:7], v249 offset:31744
v_rcp_f16 v207, v206
v_mfma_f32_16x16x32_bf16 v[184:187], v[40:43], v[116:119], v[184:187]
v_rcp_f16 v204, v203
v_mfma_f32_16x16x32_bf16 v[180:183], v[44:47], v[112:115], v[180:183]
ds_read_b128 v[40:43], v248 offset:35072
v_rcp_f16_sdwa v242, v241 dst_sel:WORD_1 dst_unused:UNUSED_PRESERVE src0_sel:WORD_1
v_mfma_f32_16x16x32_bf16 v[188:191], v[44:47], v[116:119], v[188:191]
v_rcp_f16_sdwa v207, v206 dst_sel:WORD_1 dst_unused:UNUSED_PRESERVE src0_sel:WORD_1
v_or_b32 v232, v192, v193
v_or_b32 v233, v194, v195
s_waitcnt lgkmcnt(4)
v_or_b32 v234, v196, v197
v_rcp_f16_sdwa v204, v203 dst_sel:WORD_1 dst_unused:UNUSED_PRESERVE src0_sel:WORD_1
v_or_b32 v235, v198, v199
s_waitcnt lgkmcnt(2)
v_or_b32 v236, v200, v201
v_pk_mul_f16 v237, v243, v242
v_pk_mul_f16 v238, v240, v207
v_pk_mul_f16 v239, v205, v204
v_mfma_f32_16x16x32_f16 v[48:51], v[224:227], v[232:235], v[48:51]
s_add_u32 s46, s71, 98304
buffer_store_dwordx4 v[160:163], v255, s[8:11], s46 offen offset:256 sc1
ds_read_b128 v[44:47], v249 offset:32000
v_cvt_pkrtz_f16_f32 v193, v176, v177
v_cvt_pkrtz_f16_f32 v195, v178, v179
v_mfma_f32_16x16x32_f16 v[56:59], v[224:227], v[236:239], v[56:59]
v_cvt_pkrtz_f16_f32 v197, v180, v181
v_cvt_pkrtz_f16_f32 v199, v182, v183
v_mfma_f32_16x16x32_f16 v[52:55], v[228:231], v[232:235], v[52:55]
ds_read_b128 v[224:227], v248 offset:35840
v_cvt_pkrtz_f16_f32 v201, v184, v185
v_cvt_pk_f16_f32 v243, v186, v187
v_mfma_f32_16x16x32_f16 v[60:63], v[228:231], v[236:239], v[60:63]
v_cvt_pk_f16_f32 v240, v188, v189
v_cvt_pk_f16_f32 v205, v190, v191
s_setprio 1
v_mfma_f32_16x16x32_bf16 v[176:179], v[0:3], v[96:99], 0
ds_read_b128 v[228:231], v249 offset:32768
v_pk_fma_f16 v242, v243, v243, s48
v_and_b32 v193, s49, v193
v_mfma_f32_16x16x32_bf16 v[184:187], v[0:3], v[100:103], 0
v_pk_fma_f16 v207, v240, v240, s48
v_and_b32 v195, s49, v195
s_waitcnt lgkmcnt(3)
v_mfma_f32_16x16x32_f16 v[64:67], v[4:7], v[232:235], v[64:67]
ds_read_b128 v[0:3], v249 offset:33024
v_pk_fma_f16 v204, v205, v205, s48
v_lshrrev_b16 v192, 2, v193
v_pk_mul_f16 v242, v243, v242
v_mfma_f32_16x16x32_f16 v[72:75], v[4:7], v[236:239], v[72:75]
v_lshrrev_b16 v194, 2, v195
v_pk_mul_f16 v207, v240, v207
s_waitcnt vmcnt(11)
v_mfma_f32_16x16x32_bf16 v[48:51], v[26:29], v[20:23], v[48:51]
ds_read_b128 v[4:7], v248 offset:36096
ds_read_u16_d16 v192, v192
ds_read_u16_d16 v194, v194
v_lshrrev_b32 v193, 18, v193
v_pk_mul_f16 v204, v205, v204
v_mfma_f32_16x16x32_bf16 v[52:55], v[24:27], v[20:23], v[52:55]
v_lshrrev_b32 v195, 18, v195
v_mfma_f32_16x16x32_bf16 v[180:183], v[40:43], v[96:99], 0
ds_read_u16_d16_hi v193, v193
ds_read_u16_d16_hi v195, v195
v_exp_f16 v241, v242
v_and_b32 v197, s49, v197
v_mfma_f32_16x16x32_bf16 v[188:191], v[40:43], v[100:103], 0
v_and_b32 v199, s49, v199
s_waitcnt lgkmcnt(6)
v_mfma_f32_16x16x32_f16 v[68:71], v[44:47], v[232:235], v[68:71]
ds_read_b128 v[40:43], v248 offset:36864
v_exp_f16 v206, v207
v_lshrrev_b16 v196, 2, v197
v_mfma_f32_16x16x32_f16 v[76:79], v[44:47], v[236:239], v[76:79]
v_lshrrev_b16 v198, 2, v199
v_exp_f16 v203, v204
v_mfma_f32_16x16x32_bf16 v[176:179], v[224:227], v[104:107], v[176:179]
ds_read_b128 v[44:47], v248 offset:37120
ds_read_u16_d16 v196, v196
ds_read_u16_d16 v198, v198
v_lshrrev_b32 v197, 18, v197
v_lshrrev_b32 v199, 18, v199
v_mfma_f32_16x16x32_bf16 v[184:187], v[224:227], v[108:111], v[184:187]
v_exp_f16_sdwa v241, v242 dst_sel:WORD_1 dst_unused:UNUSED_PRESERVE src0_sel:WORD_1
v_mfma_f32_16x16x32_f16 v[80:83], v[228:231], v[232:235], v[80:83]
ds_read_b128 v[224:227], v249 offset:36864
ds_read_u16_d16_hi v197, v197
ds_read_u16_d16_hi v199, v199
v_and_b32 v201, s49, v201
v_lshrrev_b16 v200, 2, v201
v_mfma_f32_16x16x32_f16 v[168:171], v[228:231], v[236:239], v[168:171]
v_exp_f16_sdwa v206, v207 dst_sel:WORD_1 dst_unused:UNUSED_PRESERVE src0_sel:WORD_1
s_waitcnt lgkmcnt(7)
v_mfma_f32_16x16x32_f16 v[84:87], v[0:3], v[232:235], v[84:87]
ds_read_b128 v[228:231], v249 offset:37120
ds_read_u16_d16 v200, v200
v_lshrrev_b32 v201, 18, v201
v_mfma_f32_16x16x32_f16 v[172:175], v[0:3], v[236:239], v[172:175]
v_exp_f16_sdwa v203, v204 dst_sel:WORD_1 dst_unused:UNUSED_PRESERVE src0_sel:WORD_1
v_pk_add_f16 v241, v241, 1.0 op_sel_hi:[1,0]
v_pk_add_f16 v206, v206, 1.0 op_sel_hi:[1,0]
v_mfma_f32_16x16x32_bf16 v[180:183], v[4:7], v[104:107], v[180:183]
ds_read_b128 v[0:3], v248 offset:40960
ds_read_u16_d16_hi v201, v201
v_pk_add_f16 v203, v203, 1.0 op_sel_hi:[1,0]
v_mfma_f32_16x16x32_bf16 v[188:191], v[4:7], v[108:111], v[188:191]
v_rcp_f16 v242, v241
s_setprio 0
s_waitcnt lgkmcnt(7)
v_mfma_f32_16x16x32_bf16 v[176:179], v[40:43], v[112:115], v[176:179]
ds_read_b128 v[4:7], v249 offset:37888
v_rcp_f16 v207, v206
v_mfma_f32_16x16x32_bf16 v[184:187], v[40:43], v[116:119], v[184:187]
v_rcp_f16 v204, v203
v_mfma_f32_16x16x32_bf16 v[180:183], v[44:47], v[112:115], v[180:183]
ds_read_b128 v[40:43], v248 offset:41216
v_rcp_f16_sdwa v242, v241 dst_sel:WORD_1 dst_unused:UNUSED_PRESERVE src0_sel:WORD_1
v_mfma_f32_16x16x32_bf16 v[188:191], v[44:47], v[116:119], v[188:191]
v_rcp_f16_sdwa v207, v206 dst_sel:WORD_1 dst_unused:UNUSED_PRESERVE src0_sel:WORD_1
v_or_b32 v232, v192, v193
v_or_b32 v233, v194, v195
s_waitcnt lgkmcnt(4)
v_or_b32 v234, v196, v197
v_rcp_f16_sdwa v204, v203 dst_sel:WORD_1 dst_unused:UNUSED_PRESERVE src0_sel:WORD_1
v_or_b32 v235, v198, v199
s_waitcnt lgkmcnt(2)
v_or_b32 v236, v200, v201
v_pk_mul_f16 v237, v243, v242
v_pk_mul_f16 v238, v240, v207
v_pk_mul_f16 v239, v205, v204
s_setprio 3
v_mfma_f32_16x16x32_f16 v[48:51], v[224:227], v[232:235], v[48:51]
ds_read_b128 v[44:47], v249 offset:38144
v_cvt_pkrtz_f16_f32 v193, v176, v177
v_cvt_pkrtz_f16_f32 v195, v178, v179
v_mfma_f32_16x16x32_f16 v[56:59], v[224:227], v[236:239], v[56:59]
v_cvt_pkrtz_f16_f32 v197, v180, v181
v_cvt_pkrtz_f16_f32 v199, v182, v183
v_mfma_f32_16x16x32_f16 v[52:55], v[228:231], v[232:235], v[52:55]
ds_read_b128 v[224:227], v248 offset:41984
v_cvt_pkrtz_f16_f32 v201, v184, v185
v_cvt_pk_f16_f32 v243, v186, v187
v_mfma_f32_16x16x32_f16 v[60:63], v[228:231], v[236:239], v[60:63]
v_cvt_pk_f16_f32 v240, v188, v189
v_cvt_pk_f16_f32 v205, v190, v191
v_mfma_f32_16x16x32_bf16 v[176:179], v[0:3], v[96:99], 0
ds_read_b128 v[228:231], v249 offset:38912
v_pk_fma_f16 v242, v243, v243, s48
v_and_b32 v193, s49, v193
v_mfma_f32_16x16x32_bf16 v[184:187], v[0:3], v[100:103], 0
v_pk_fma_f16 v207, v240, v240, s48
v_and_b32 v195, s49, v195
s_waitcnt lgkmcnt(3)
v_mfma_f32_16x16x32_f16 v[64:67], v[4:7], v[232:235], v[64:67]
ds_read_b128 v[0:3], v249 offset:39168
v_pk_fma_f16 v204, v205, v205, s48
v_lshrrev_b16 v192, 2, v193
v_pk_mul_f16 v242, v243, v242
v_mfma_f32_16x16x32_f16 v[72:75], v[4:7], v[236:239], v[72:75]
v_lshrrev_b16 v194, 2, v195
v_pk_mul_f16 v207, v240, v207
s_waitcnt vmcnt(10)
v_mfma_f32_16x16x32_bf16 v[64:67], v[26:29], v[16:19], v[64:67]
ds_read_b128 v[4:7], v248 offset:42240
ds_read_u16_d16 v192, v192
ds_read_u16_d16 v194, v194
v_lshrrev_b32 v193, 18, v193
v_pk_mul_f16 v204, v205, v204
v_mfma_f32_16x16x32_bf16 v[68:71], v[24:27], v[16:19], v[68:71]
v_lshrrev_b32 v195, 18, v195
v_mfma_f32_16x16x32_bf16 v[180:183], v[40:43], v[96:99], 0
ds_read_u16_d16_hi v193, v193
ds_read_u16_d16_hi v195, v195
v_exp_f16 v241, v242
v_and_b32 v197, s49, v197
v_mfma_f32_16x16x32_bf16 v[188:191], v[40:43], v[100:103], 0
v_and_b32 v199, s49, v199
s_waitcnt lgkmcnt(6)
v_mfma_f32_16x16x32_f16 v[68:71], v[44:47], v[232:235], v[68:71]
ds_read_b128 v[40:43], v248 offset:43008
v_exp_f16 v206, v207
v_lshrrev_b16 v196, 2, v197
v_mfma_f32_16x16x32_f16 v[76:79], v[44:47], v[236:239], v[76:79]
v_lshrrev_b16 v198, 2, v199
v_exp_f16 v203, v204
v_mfma_f32_16x16x32_bf16 v[176:179], v[224:227], v[104:107], v[176:179]
ds_read_b128 v[44:47], v248 offset:43264
ds_read_u16_d16 v196, v196
ds_read_u16_d16 v198, v198
v_lshrrev_b32 v197, 18, v197
v_lshrrev_b32 v199, 18, v199
v_mfma_f32_16x16x32_bf16 v[184:187], v[224:227], v[108:111], v[184:187]
v_exp_f16_sdwa v241, v242 dst_sel:WORD_1 dst_unused:UNUSED_PRESERVE src0_sel:WORD_1
v_mfma_f32_16x16x32_f16 v[80:83], v[228:231], v[232:235], v[80:83]
ds_read_b128 v[224:227], v249 offset:43008
ds_read_u16_d16_hi v197, v197
ds_read_u16_d16_hi v199, v199
v_and_b32 v201, s49, v201
v_lshrrev_b16 v200, 2, v201
v_mfma_f32_16x16x32_f16 v[168:171], v[228:231], v[236:239], v[168:171]
v_exp_f16_sdwa v206, v207 dst_sel:WORD_1 dst_unused:UNUSED_PRESERVE src0_sel:WORD_1
s_waitcnt lgkmcnt(7)
v_mfma_f32_16x16x32_f16 v[84:87], v[0:3], v[232:235], v[84:87]
ds_read_b128 v[228:231], v249 offset:43264
ds_read_u16_d16 v200, v200
v_lshrrev_b32 v201, 18, v201
v_mfma_f32_16x16x32_f16 v[172:175], v[0:3], v[236:239], v[172:175]
v_exp_f16_sdwa v203, v204 dst_sel:WORD_1 dst_unused:UNUSED_PRESERVE src0_sel:WORD_1
v_pk_add_f16 v241, v241, 1.0 op_sel_hi:[1,0]
v_pk_add_f16 v206, v206, 1.0 op_sel_hi:[1,0]
v_mfma_f32_16x16x32_bf16 v[180:183], v[4:7], v[104:107], v[180:183]
ds_read_b128 v[0:3], v248 offset:16384
ds_read_u16_d16_hi v201, v201
v_pk_add_f16 v203, v203, 1.0 op_sel_hi:[1,0]
v_mfma_f32_16x16x32_bf16 v[188:191], v[4:7], v[108:111], v[188:191]
v_rcp_f16 v242, v241
s_waitcnt lgkmcnt(7)
v_mfma_f32_16x16x32_bf16 v[176:179], v[40:43], v[112:115], v[176:179]
ds_read_b128 v[4:7], v249 offset:44032
v_rcp_f16 v207, v206
v_mfma_f32_16x16x32_bf16 v[184:187], v[40:43], v[116:119], v[184:187]
v_rcp_f16 v204, v203
v_mfma_f32_16x16x32_bf16 v[180:183], v[44:47], v[112:115], v[180:183]
ds_read_b128 v[40:43], v248 offset:16640
v_rcp_f16_sdwa v242, v241 dst_sel:WORD_1 dst_unused:UNUSED_PRESERVE src0_sel:WORD_1
v_mfma_f32_16x16x32_bf16 v[188:191], v[44:47], v[116:119], v[188:191]
v_rcp_f16_sdwa v207, v206 dst_sel:WORD_1 dst_unused:UNUSED_PRESERVE src0_sel:WORD_1
v_or_b32 v232, v192, v193
v_or_b32 v233, v194, v195
s_waitcnt lgkmcnt(4)
v_or_b32 v234, v196, v197
v_rcp_f16_sdwa v204, v203 dst_sel:WORD_1 dst_unused:UNUSED_PRESERVE src0_sel:WORD_1
v_or_b32 v235, v198, v199
s_waitcnt lgkmcnt(2)
v_or_b32 v236, v200, v201
v_pk_mul_f16 v237, v243, v242
v_pk_mul_f16 v238, v240, v207
v_pk_mul_f16 v239, v205, v204
v_mfma_f32_16x16x32_f16 v[48:51], v[224:227], v[232:235], v[48:51]
s_add_u32 s46, s80, 12582912
buffer_load_dwordx4 v[96:99], v253, s[32:35], s46 offen nt
ds_read_b128 v[44:47], v249 offset:44288
v_cvt_pkrtz_f16_f32 v193, v176, v177
v_cvt_pkrtz_f16_f32 v195, v178, v179
v_mfma_f32_16x16x32_f16 v[56:59], v[224:227], v[236:239], v[56:59]
v_cvt_pkrtz_f16_f32 v197, v180, v181
v_cvt_pkrtz_f16_f32 v199, v182, v183
v_mfma_f32_16x16x32_f16 v[52:55], v[228:231], v[232:235], v[52:55]
ds_read_b128 v[224:227], v248 offset:17408
v_cvt_pkrtz_f16_f32 v201, v184, v185
v_cvt_pk_f16_f32 v243, v186, v187
v_mfma_f32_16x16x32_f16 v[60:63], v[228:231], v[236:239], v[60:63]
v_cvt_pk_f16_f32 v240, v188, v189
v_cvt_pk_f16_f32 v205, v190, v191
v_mfma_f32_16x16x32_bf16 v[176:179], v[0:3], v[88:91], 0
ds_read_b128 v[228:231], v249 offset:45056
v_pk_fma_f16 v242, v243, v243, s48
v_and_b32 v193, s49, v193
v_mfma_f32_16x16x32_bf16 v[184:187], v[0:3], v[92:95], 0
v_pk_fma_f16 v207, v240, v240, s48
v_and_b32 v195, s49, v195
s_waitcnt lgkmcnt(3)
v_mfma_f32_16x16x32_f16 v[64:67], v[4:7], v[232:235], v[64:67]
ds_read_b128 v[0:3], v249 offset:45312
v_pk_fma_f16 v204, v205, v205, s48
s_setprio 2
v_lshrrev_b16 v192, 2, v193
v_pk_mul_f16 v242, v243, v242
v_mfma_f32_16x16x32_f16 v[72:75], v[4:7], v[236:239], v[72:75]
v_lshrrev_b16 v194, 2, v195
v_pk_mul_f16 v207, v240, v207
s_waitcnt vmcnt(10)
v_mfma_f32_16x16x32_bf16 v[80:83], v[26:29], v[8:11], v[80:83]
ds_read_b128 v[4:7], v248 offset:17664
ds_read_u16_d16 v192, v192
ds_read_u16_d16 v194, v194
v_lshrrev_b32 v193, 18, v193
v_pk_mul_f16 v204, v205, v204
v_mfma_f32_16x16x32_bf16 v[84:87], v[24:27], v[8:11], v[84:87]
v_lshrrev_b32 v195, 18, v195
v_mfma_f32_16x16x32_bf16 v[180:183], v[40:43], v[88:91], 0
ds_read_u16_d16_hi v193, v193
ds_read_u16_d16_hi v195, v195
v_exp_f16 v241, v242
v_and_b32 v197, s49, v197
v_mfma_f32_16x16x32_bf16 v[188:191], v[40:43], v[92:95], 0
v_and_b32 v199, s49, v199
s_waitcnt lgkmcnt(6)
v_mfma_f32_16x16x32_f16 v[68:71], v[44:47], v[232:235], v[68:71]
ds_read_b128 v[40:43], v248 offset:18432
v_exp_f16 v206, v207
v_lshrrev_b16 v196, 2, v197
v_mfma_f32_16x16x32_f16 v[76:79], v[44:47], v[236:239], v[76:79]
v_lshrrev_b16 v198, 2, v199
v_exp_f16 v203, v204
v_mfma_f32_16x16x32_bf16 v[176:179], v[224:227], v[208:211], v[176:179]
ds_read_b128 v[44:47], v248 offset:18688
ds_read_u16_d16 v196, v196
ds_read_u16_d16 v198, v198
v_lshrrev_b32 v197, 18, v197
v_lshrrev_b32 v199, 18, v199
v_mfma_f32_16x16x32_bf16 v[184:187], v[224:227], v[212:215], v[184:187]
v_exp_f16_sdwa v241, v242 dst_sel:WORD_1 dst_unused:UNUSED_PRESERVE src0_sel:WORD_1
v_mfma_f32_16x16x32_f16 v[80:83], v[228:231], v[232:235], v[80:83]
ds_read_b128 v[224:227], v249 offset:49152
ds_read_u16_d16_hi v197, v197
ds_read_u16_d16_hi v199, v199
v_and_b32 v201, s49, v201
v_lshrrev_b16 v200, 2, v201
v_mfma_f32_16x16x32_f16 v[168:171], v[228:231], v[236:239], v[168:171]
v_exp_f16_sdwa v206, v207 dst_sel:WORD_1 dst_unused:UNUSED_PRESERVE src0_sel:WORD_1
s_waitcnt lgkmcnt(7)
v_mfma_f32_16x16x32_f16 v[84:87], v[0:3], v[232:235], v[84:87]
ds_read_b128 v[228:231], v249 offset:49408
ds_read_u16_d16 v200, v200
v_lshrrev_b32 v201, 18, v201
v_mfma_f32_16x16x32_f16 v[172:175], v[0:3], v[236:239], v[172:175]
v_exp_f16_sdwa v203, v204 dst_sel:WORD_1 dst_unused:UNUSED_PRESERVE src0_sel:WORD_1
v_pk_add_f16 v241, v241, 1.0 op_sel_hi:[1,0]
v_pk_add_f16 v206, v206, 1.0 op_sel_hi:[1,0]
v_mfma_f32_16x16x32_bf16 v[180:183], v[4:7], v[208:211], v[180:183]
ds_read_b128 v[0:3], v248 offset:22528
ds_read_u16_d16_hi v201, v201
v_pk_add_f16 v203, v203, 1.0 op_sel_hi:[1,0]
v_mfma_f32_16x16x32_bf16 v[188:191], v[4:7], v[212:215], v[188:191]
v_rcp_f16 v242, v241
s_waitcnt lgkmcnt(7)
v_mfma_f32_16x16x32_bf16 v[176:179], v[40:43], v[32:35], v[176:179]
ds_read_b128 v[4:7], v249 offset:50176
v_rcp_f16 v207, v206
v_mfma_f32_16x16x32_bf16 v[184:187], v[40:43], v[36:39], v[184:187]
v_rcp_f16 v204, v203
v_mfma_f32_16x16x32_bf16 v[180:183], v[44:47], v[32:35], v[180:183]
ds_read_b128 v[40:43], v248 offset:22784
v_rcp_f16_sdwa v242, v241 dst_sel:WORD_1 dst_unused:UNUSED_PRESERVE src0_sel:WORD_1
v_mfma_f32_16x16x32_bf16 v[188:191], v[44:47], v[36:39], v[188:191]
v_rcp_f16_sdwa v207, v206 dst_sel:WORD_1 dst_unused:UNUSED_PRESERVE src0_sel:WORD_1
v_or_b32 v232, v192, v193
v_or_b32 v233, v194, v195
s_waitcnt lgkmcnt(4)
v_or_b32 v234, v196, v197
v_rcp_f16_sdwa v204, v203 dst_sel:WORD_1 dst_unused:UNUSED_PRESERVE src0_sel:WORD_1
v_or_b32 v235, v198, v199
s_waitcnt lgkmcnt(2)
v_or_b32 v236, v200, v201
v_pk_mul_f16 v237, v243, v242
v_pk_mul_f16 v238, v240, v207
v_pk_mul_f16 v239, v205, v204
v_mfma_f32_16x16x32_f16 v[48:51], v[224:227], v[232:235], v[48:51]
s_add_u32 s46, s80, 12582912
buffer_load_dwordx4 v[100:103], v253, s[32:35], s46 offen offset:256 nt
ds_read_b128 v[44:47], v249 offset:50432
v_cvt_pkrtz_f16_f32 v193, v176, v177
v_cvt_pkrtz_f16_f32 v195, v178, v179
v_mfma_f32_16x16x32_f16 v[56:59], v[224:227], v[236:239], v[56:59]
v_cvt_pkrtz_f16_f32 v197, v180, v181
v_cvt_pkrtz_f16_f32 v199, v182, v183
v_mfma_f32_16x16x32_f16 v[52:55], v[228:231], v[232:235], v[52:55]
ds_read_b128 v[224:227], v248 offset:23552
v_cvt_pkrtz_f16_f32 v201, v184, v185
v_cvt_pk_f16_f32 v243, v186, v187
v_mfma_f32_16x16x32_f16 v[60:63], v[228:231], v[236:239], v[60:63]
v_cvt_pk_f16_f32 v240, v188, v189
v_cvt_pk_f16_f32 v205, v190, v191
s_setprio 1
v_mfma_f32_16x16x32_bf16 v[176:179], v[0:3], v[88:91], 0
ds_read_b128 v[228:231], v249 offset:51200
v_pk_fma_f16 v242, v243, v243, s48
v_and_b32 v193, s49, v193
v_mfma_f32_16x16x32_bf16 v[184:187], v[0:3], v[92:95], 0
v_pk_fma_f16 v207, v240, v240, s48
v_and_b32 v195, s49, v195
s_waitcnt lgkmcnt(3)
v_mfma_f32_16x16x32_f16 v[64:67], v[4:7], v[232:235], v[64:67]
ds_read_b128 v[0:3], v249 offset:51456
v_pk_fma_f16 v204, v205, v205, s48
v_lshrrev_b16 v192, 2, v193
v_pk_mul_f16 v242, v243, v242
v_mfma_f32_16x16x32_f16 v[72:75], v[4:7], v[236:239], v[72:75]
v_lshrrev_b16 v194, 2, v195
v_pk_mul_f16 v207, v240, v207
s_waitcnt vmcnt(9)
v_mfma_f32_16x16x32_bf16 v[56:59], v[26:29], v[12:15], v[56:59]
ds_read_b128 v[4:7], v248 offset:23808
ds_read_u16_d16 v192, v192
ds_read_u16_d16 v194, v194
v_lshrrev_b32 v193, 18, v193
v_pk_mul_f16 v204, v205, v204
v_mfma_f32_16x16x32_bf16 v[60:63], v[24:27], v[12:15], v[60:63]
v_lshrrev_b32 v195, 18, v195
v_mfma_f32_16x16x32_bf16 v[180:183], v[40:43], v[88:91], 0
ds_read_u16_d16_hi v193, v193
ds_read_u16_d16_hi v195, v195
v_exp_f16 v241, v242
v_and_b32 v197, s49, v197
v_mfma_f32_16x16x32_bf16 v[188:191], v[40:43], v[92:95], 0
v_and_b32 v199, s49, v199
s_waitcnt lgkmcnt(6)
v_mfma_f32_16x16x32_f16 v[68:71], v[44:47], v[232:235], v[68:71]
ds_read_b128 v[40:43], v248 offset:24576
v_exp_f16 v206, v207
v_lshrrev_b16 v196, 2, v197
v_mfma_f32_16x16x32_f16 v[76:79], v[44:47], v[236:239], v[76:79]
v_lshrrev_b16 v198, 2, v199
v_exp_f16 v203, v204
v_mfma_f32_16x16x32_bf16 v[176:179], v[224:227], v[208:211], v[176:179]
ds_read_b128 v[44:47], v248 offset:24832
ds_read_u16_d16 v196, v196
ds_read_u16_d16 v198, v198
v_lshrrev_b32 v197, 18, v197
v_lshrrev_b32 v199, 18, v199
v_mfma_f32_16x16x32_bf16 v[184:187], v[224:227], v[212:215], v[184:187]
v_exp_f16_sdwa v241, v242 dst_sel:WORD_1 dst_unused:UNUSED_PRESERVE src0_sel:WORD_1
v_mfma_f32_16x16x32_f16 v[80:83], v[228:231], v[232:235], v[80:83]
ds_read_b128 v[224:227], v249 offset:24576
ds_read_u16_d16_hi v197, v197
ds_read_u16_d16_hi v199, v199
v_and_b32 v201, s49, v201
v_lshrrev_b16 v200, 2, v201
v_mfma_f32_16x16x32_f16 v[168:171], v[228:231], v[236:239], v[168:171]
v_exp_f16_sdwa v206, v207 dst_sel:WORD_1 dst_unused:UNUSED_PRESERVE src0_sel:WORD_1
s_waitcnt lgkmcnt(7)
v_mfma_f32_16x16x32_f16 v[84:87], v[0:3], v[232:235], v[84:87]
ds_read_b128 v[228:231], v254 offset:7936
ds_read_u16_d16 v200, v200
v_lshrrev_b32 v201, 18, v201
v_mfma_f32_16x16x32_f16 v[172:175], v[0:3], v[236:239], v[172:175]
v_exp_f16_sdwa v203, v204 dst_sel:WORD_1 dst_unused:UNUSED_PRESERVE src0_sel:WORD_1
v_pk_add_f16 v241, v241, 1.0 op_sel_hi:[1,0]
v_pk_add_f16 v206, v206, 1.0 op_sel_hi:[1,0]
v_mfma_f32_16x16x32_bf16 v[180:183], v[4:7], v[208:211], v[180:183]
ds_read_b128 v[0:3], v249 offset:24832
ds_read_u16_d16_hi v201, v201
v_pk_add_f16 v203, v203, 1.0 op_sel_hi:[1,0]
v_mfma_f32_16x16x32_bf16 v[188:191], v[4:7], v[212:215], v[188:191]
v_rcp_f16 v242, v241
s_setprio 0
s_waitcnt lgkmcnt(7)
v_mfma_f32_16x16x32_bf16 v[176:179], v[40:43], v[32:35], v[176:179]
ds_read_b128 v[4:7], v254 offset:7952
v_rcp_f16 v207, v206
v_mfma_f32_16x16x32_bf16 v[184:187], v[40:43], v[36:39], v[184:187]
v_rcp_f16 v204, v203
v_mfma_f32_16x16x32_bf16 v[180:183], v[44:47], v[32:35], v[180:183]
ds_read_b128 v[40:43], v248 offset:28672
v_rcp_f16_sdwa v242, v241 dst_sel:WORD_1 dst_unused:UNUSED_PRESERVE src0_sel:WORD_1
v_mfma_f32_16x16x32_bf16 v[188:191], v[44:47], v[36:39], v[188:191]
v_rcp_f16_sdwa v207, v206 dst_sel:WORD_1 dst_unused:UNUSED_PRESERVE src0_sel:WORD_1
v_or_b32 v232, v192, v193
v_or_b32 v233, v194, v195
s_waitcnt lgkmcnt(4)
v_or_b32 v234, v196, v197
v_rcp_f16_sdwa v204, v203 dst_sel:WORD_1 dst_unused:UNUSED_PRESERVE src0_sel:WORD_1
v_or_b32 v235, v198, v199
s_waitcnt lgkmcnt(2)
v_or_b32 v236, v200, v201
v_pk_mul_f16 v237, v243, v242
v_pk_mul_f16 v238, v240, v207
v_pk_mul_f16 v239, v205, v204
s_setprio 3
v_mfma_f32_16x16x32_f16 v[120:123], v[224:227], v[232:235], v[228:231]
s_add_u32 s46, s80, 16777216
buffer_load_dwordx4 v[104:107], v253, s[32:35], s46 offen nt
ds_read_b128 v[44:47], v249 offset:25600
v_cvt_pkrtz_f16_f32 v193, v176, v177
v_cvt_pkrtz_f16_f32 v195, v178, v179
v_mfma_f32_16x16x32_f16 v[128:131], v[224:227], v[236:239], v[228:231]
v_cvt_pkrtz_f16_f32 v197, v180, v181
v_cvt_pkrtz_f16_f32 v199, v182, v183
s_waitcnt lgkmcnt(1)
v_mfma_f32_16x16x32_f16 v[124:127], v[0:3], v[232:235], v[4:7]
ds_read_b128 v[224:227], v254 offset:8064
ds_read_b128 v[228:231], v248 offset:28928
v_cvt_pkrtz_f16_f32 v201, v184, v185
v_cvt_pk_f16_f32 v243, v186, v187
v_mfma_f32_16x16x32_f16 v[132:135], v[0:3], v[236:239], v[4:7]
v_cvt_pk_f16_f32 v240, v188, v189
v_cvt_pk_f16_f32 v205, v190, v191
v_mfma_f32_16x16x32_bf16 v[176:179], v[40:43], v[88:91], 0
ds_read_b128 v[0:3], v249 offset:25856
ds_read_b128 v[4:7], v254 offset:8080
v_pk_fma_f16 v242, v243, v243, s48
v_and_b32 v193, s49, v193
v_mfma_f32_16x16x32_bf16 v[184:187], v[40:43], v[92:95], 0
v_pk_fma_f16 v207, v240, v240, s48
v_and_b32 v195, s49, v195
s_waitcnt lgkmcnt(3)
v_mfma_f32_16x16x32_f16 v[136:139], v[44:47], v[232:235], v[224:227]
ds_read_b128 v[40:43], v248 offset:29696
v_pk_fma_f16 v204, v205, v205, s48
v_lshrrev_b16 v192, 2, v193
v_pk_mul_f16 v242, v243, v242
v_mfma_f32_16x16x32_f16 v[144:147], v[44:47], v[236:239], v[224:227]
v_lshrrev_b16 v194, 2, v195
v_pk_mul_f16 v207, v240, v207
s_waitcnt vmcnt(7)
v_mfma_f32_16x16x32_bf16 v[72:75], v[26:29], v[216:219], v[72:75]
ds_read_b128 v[44:47], v249 offset:26624
ds_read_b128 v[224:227], v254 offset:16128
ds_read_u16_d16 v192, v192
ds_read_u16_d16 v194, v194
v_lshrrev_b32 v193, 18, v193
v_pk_mul_f16 v204, v205, v204
v_mfma_f32_16x16x32_bf16 v[76:79], v[24:27], v[216:219], v[76:79]
v_lshrrev_b32 v195, 18, v195
s_waitcnt lgkmcnt(5)
v_mfma_f32_16x16x32_bf16 v[180:183], v[228:231], v[88:91], 0
ds_read_u16_d16_hi v193, v193
ds_read_u16_d16_hi v195, v195
v_exp_f16 v241, v242
v_and_b32 v197, s49, v197
v_mfma_f32_16x16x32_bf16 v[188:191], v[228:231], v[92:95], 0
v_and_b32 v199, s49, v199
v_mfma_f32_16x16x32_f16 v[140:143], v[0:3], v[232:235], v[4:7]
ds_read_b128 v[228:231], v249 offset:26880
v_exp_f16 v206, v207
v_lshrrev_b16 v196, 2, v197
v_mfma_f32_16x16x32_f16 v[148:151], v[0:3], v[236:239], v[4:7]
v_lshrrev_b16 v198, 2, v199
v_exp_f16 v203, v204
s_waitcnt lgkmcnt(7)
v_mfma_f32_16x16x32_bf16 v[176:179], v[40:43], v[208:211], v[176:179]
ds_read_b128 v[0:3], v254 offset:16144
ds_read_b128 v[4:7], v248 offset:29952
ds_read_u16_d16 v196, v196
ds_read_u16_d16 v198, v198
v_lshrrev_b32 v197, 18, v197
v_lshrrev_b32 v199, 18, v199
v_mfma_f32_16x16x32_bf16 v[184:187], v[40:43], v[212:215], v[184:187]
v_exp_f16_sdwa v241, v242 dst_sel:WORD_1 dst_unused:UNUSED_PRESERVE src0_sel:WORD_1
s_waitcnt lgkmcnt(7)
v_mfma_f32_16x16x32_f16 v[152:155], v[44:47], v[232:235], v[224:227]
ds_read_b128 v[40:43], v248 offset:30720
ds_read_u16_d16_hi v197, v197
ds_read_u16_d16_hi v199, v199
v_and_b32 v201, s49, v201
v_lshrrev_b16 v200, 2, v201
v_mfma_f32_16x16x32_f16 v[160:163], v[44:47], v[236:239], v[224:227]
v_exp_f16_sdwa v206, v207 dst_sel:WORD_1 dst_unused:UNUSED_PRESERVE src0_sel:WORD_1
s_waitcnt lgkmcnt(6)
v_mfma_f32_16x16x32_f16 v[156:159], v[228:231], v[232:235], v[0:3]
ds_read_b128 v[44:47], v248 offset:30976
ds_read_b128 v[224:227], v249 offset:30720
ds_read_u16_d16 v200, v200
v_lshrrev_b32 v201, 18, v201
v_mfma_f32_16x16x32_f16 v[164:167], v[228:231], v[236:239], v[0:3]
v_exp_f16_sdwa v203, v204 dst_sel:WORD_1 dst_unused:UNUSED_PRESERVE src0_sel:WORD_1
v_pk_add_f16 v241, v241, 1.0 op_sel_hi:[1,0]
v_pk_add_f16 v206, v206, 1.0 op_sel_hi:[1,0]
s_waitcnt lgkmcnt(7)
v_mfma_f32_16x16x32_bf16 v[180:183], v[4:7], v[208:211], v[180:183]
ds_read_b128 v[228:231], v249 offset:30976
ds_read_b128 v[0:3], v248 offset:40960
ds_read_u16_d16_hi v201, v201
v_pk_add_f16 v203, v203, 1.0 op_sel_hi:[1,0]
v_mfma_f32_16x16x32_bf16 v[188:191], v[4:7], v[212:215], v[188:191]
v_rcp_f16 v242, v241
s_waitcnt lgkmcnt(8)
v_mfma_f32_16x16x32_bf16 v[176:179], v[40:43], v[32:35], v[176:179]
ds_read_b128 v[4:7], v249 offset:31744
v_rcp_f16 v207, v206
v_mfma_f32_16x16x32_bf16 v[184:187], v[40:43], v[36:39], v[184:187]
v_rcp_f16 v204, v203
s_waitcnt lgkmcnt(6)
v_mfma_f32_16x16x32_bf16 v[180:183], v[44:47], v[32:35], v[180:183]
ds_read_b128 v[40:43], v248 offset:41216
v_rcp_f16_sdwa v242, v241 dst_sel:WORD_1 dst_unused:UNUSED_PRESERVE src0_sel:WORD_1
v_mfma_f32_16x16x32_bf16 v[188:191], v[44:47], v[36:39], v[188:191]
v_rcp_f16_sdwa v207, v206 dst_sel:WORD_1 dst_unused:UNUSED_PRESERVE src0_sel:WORD_1
v_or_b32 v232, v192, v193
v_or_b32 v233, v194, v195
v_or_b32 v234, v196, v197
v_rcp_f16_sdwa v204, v203 dst_sel:WORD_1 dst_unused:UNUSED_PRESERVE src0_sel:WORD_1
v_or_b32 v235, v198, v199
s_waitcnt lgkmcnt(2)
v_or_b32 v236, v200, v201
v_pk_mul_f16 v237, v243, v242
v_pk_mul_f16 v238, v240, v207
v_pk_mul_f16 v239, v205, v204
v_mfma_f32_16x16x32_f16 v[120:123], v[224:227], v[232:235], v[120:123]
s_add_u32 s46, s80, 16777216
buffer_load_dwordx4 v[108:111], v253, s[32:35], s46 offen offset:256 nt
ds_read_b128 v[44:47], v249 offset:32000
v_cvt_pkrtz_f16_f32 v193, v176, v177
v_cvt_pkrtz_f16_f32 v195, v178, v179
v_mfma_f32_16x16x32_f16 v[128:131], v[224:227], v[236:239], v[128:131]
v_cvt_pkrtz_f16_f32 v197, v180, v181
v_cvt_pkrtz_f16_f32 v199, v182, v183
v_mfma_f32_16x16x32_f16 v[124:127], v[228:231], v[232:235], v[124:127]
ds_read_b128 v[224:227], v248 offset:41984
v_cvt_pkrtz_f16_f32 v201, v184, v185
v_cvt_pk_f16_f32 v243, v186, v187
v_mfma_f32_16x16x32_f16 v[132:135], v[228:231], v[236:239], v[132:135]
v_cvt_pk_f16_f32 v240, v188, v189
v_cvt_pk_f16_f32 v205, v190, v191
v_mfma_f32_16x16x32_bf16 v[176:179], v[0:3], v[88:91], 0
ds_read_b128 v[228:231], v249 offset:32768
v_pk_fma_f16 v242, v243, v243, s48
v_and_b32 v193, s49, v193
v_mfma_f32_16x16x32_bf16 v[184:187], v[0:3], v[92:95], 0
v_pk_fma_f16 v207, v240, v240, s48
v_and_b32 v195, s49, v195
s_waitcnt lgkmcnt(3)
v_mfma_f32_16x16x32_f16 v[136:139], v[4:7], v[232:235], v[136:139]
ds_read_b128 v[0:3], v249 offset:33024
v_pk_fma_f16 v204, v205, v205, s48
s_setprio 2
v_lshrrev_b16 v192, 2, v193
v_pk_mul_f16 v242, v243, v242
v_mfma_f32_16x16x32_f16 v[144:147], v[4:7], v[236:239], v[144:147]
v_lshrrev_b16 v194, 2, v195
v_pk_mul_f16 v207, v240, v207
s_waitcnt vmcnt(7)
v_mfma_f32_16x16x32_bf16 v[168:171], v[26:29], v[244:247], v[168:171]
ds_read_b128 v[4:7], v248 offset:42240
ds_read_u16_d16 v192, v192
ds_read_u16_d16 v194, v194
v_lshrrev_b32 v193, 18, v193
v_pk_mul_f16 v204, v205, v204
v_mfma_f32_16x16x32_bf16 v[172:175], v[24:27], v[244:247], v[172:175]
v_lshrrev_b32 v195, 18, v195
v_mfma_f32_16x16x32_bf16 v[180:183], v[40:43], v[88:91], 0
ds_read_u16_d16_hi v193, v193
ds_read_u16_d16_hi v195, v195
v_exp_f16 v241, v242
v_and_b32 v197, s49, v197
v_mfma_f32_16x16x32_bf16 v[188:191], v[40:43], v[92:95], 0
v_and_b32 v199, s49, v199
s_waitcnt lgkmcnt(6)
v_mfma_f32_16x16x32_f16 v[140:143], v[44:47], v[232:235], v[140:143]
ds_read_b128 v[40:43], v248 offset:43008
v_exp_f16 v206, v207
v_lshrrev_b16 v196, 2, v197
v_mfma_f32_16x16x32_f16 v[148:151], v[44:47], v[236:239], v[148:151]
v_lshrrev_b16 v198, 2, v199
v_exp_f16 v203, v204
v_mfma_f32_16x16x32_bf16 v[176:179], v[224:227], v[208:211], v[176:179]
ds_read_b128 v[44:47], v248 offset:43264
ds_read_u16_d16 v196, v196
ds_read_u16_d16 v198, v198
v_lshrrev_b32 v197, 18, v197
v_lshrrev_b32 v199, 18, v199
v_mfma_f32_16x16x32_bf16 v[184:187], v[224:227], v[212:215], v[184:187]
v_exp_f16_sdwa v241, v242 dst_sel:WORD_1 dst_unused:UNUSED_PRESERVE src0_sel:WORD_1
v_mfma_f32_16x16x32_f16 v[152:155], v[228:231], v[232:235], v[152:155]
ds_read_b128 v[224:227], v249 offset:36864
ds_read_u16_d16_hi v197, v197
ds_read_u16_d16_hi v199, v199
v_and_b32 v201, s49, v201
v_lshrrev_b16 v200, 2, v201
v_mfma_f32_16x16x32_f16 v[160:163], v[228:231], v[236:239], v[160:163]
v_exp_f16_sdwa v206, v207 dst_sel:WORD_1 dst_unused:UNUSED_PRESERVE src0_sel:WORD_1
s_waitcnt lgkmcnt(7)
v_mfma_f32_16x16x32_f16 v[156:159], v[0:3], v[232:235], v[156:159]
ds_read_b128 v[228:231], v249 offset:37120
ds_read_u16_d16 v200, v200
v_lshrrev_b32 v201, 18, v201
v_mfma_f32_16x16x32_f16 v[164:167], v[0:3], v[236:239], v[164:167]
v_exp_f16_sdwa v203, v204 dst_sel:WORD_1 dst_unused:UNUSED_PRESERVE src0_sel:WORD_1
v_pk_add_f16 v241, v241, 1.0 op_sel_hi:[1,0]
v_pk_add_f16 v206, v206, 1.0 op_sel_hi:[1,0]
v_mfma_f32_16x16x32_bf16 v[180:183], v[4:7], v[208:211], v[180:183]
ds_read_b128 v[0:3], v248 offset:34816
ds_read_u16_d16_hi v201, v201
v_pk_add_f16 v203, v203, 1.0 op_sel_hi:[1,0]
v_mfma_f32_16x16x32_bf16 v[188:191], v[4:7], v[212:215], v[188:191]
v_rcp_f16 v242, v241
s_waitcnt lgkmcnt(7)
v_mfma_f32_16x16x32_bf16 v[176:179], v[40:43], v[32:35], v[176:179]
ds_read_b128 v[4:7], v249 offset:37888
v_rcp_f16 v207, v206
v_mfma_f32_16x16x32_bf16 v[184:187], v[40:43], v[36:39], v[184:187]
v_rcp_f16 v204, v203
v_mfma_f32_16x16x32_bf16 v[180:183], v[44:47], v[32:35], v[180:183]
ds_read_b128 v[40:43], v248 offset:35072
v_rcp_f16_sdwa v242, v241 dst_sel:WORD_1 dst_unused:UNUSED_PRESERVE src0_sel:WORD_1
v_mfma_f32_16x16x32_bf16 v[188:191], v[44:47], v[36:39], v[188:191]
v_rcp_f16_sdwa v207, v206 dst_sel:WORD_1 dst_unused:UNUSED_PRESERVE src0_sel:WORD_1
v_or_b32 v232, v192, v193
v_or_b32 v233, v194, v195
s_waitcnt lgkmcnt(4)
v_or_b32 v234, v196, v197
v_rcp_f16_sdwa v204, v203 dst_sel:WORD_1 dst_unused:UNUSED_PRESERVE src0_sel:WORD_1
v_or_b32 v235, v198, v199
s_waitcnt lgkmcnt(2)
v_or_b32 v236, v200, v201
v_pk_mul_f16 v237, v243, v242
v_pk_mul_f16 v238, v240, v207
v_pk_mul_f16 v239, v205, v204
v_mfma_f32_16x16x32_f16 v[120:123], v[224:227], v[232:235], v[120:123]
s_add_u32 s46, s80, 20971520
buffer_load_dwordx4 v[112:115], v253, s[32:35], s46 offen nt
ds_read_b128 v[44:47], v249 offset:38144
v_cvt_pkrtz_f16_f32 v193, v176, v177
v_cvt_pkrtz_f16_f32 v195, v178, v179
v_cvt_pkrtz_f16_f32 v197, v180, v181
v_mfma_f32_16x16x32_f16 v[128:131], v[224:227], v[236:239], v[128:131]
v_cvt_pkrtz_f16_f32 v199, v182, v183
v_cvt_pkrtz_f16_f32 v201, v184, v185
v_cvt_pkrtz_f16_f32 v203, v186, v187
v_mfma_f32_16x16x32_f16 v[124:127], v[228:231], v[232:235], v[124:127]
ds_read_b128 v[224:227], v248 offset:35840
v_cvt_pk_f16_f32 v243, v188, v189
v_cvt_pk_f16_f32 v240, v190, v191
s_setprio 1
v_pk_fma_f16 v242, v243, v243, s48
v_mfma_f32_16x16x32_f16 v[132:135], v[228:231], v[236:239], v[132:135]
v_cvt_pk_bf16_f32 v64, v64, v65
v_and_b32 v193, s49, v193
v_cvt_pk_bf16_f32 v65, v66, v67
v_mfma_f32_16x16x32_bf16 v[176:179], v[0:3], v[88:91], 0
ds_read_b128 v[228:231], v249 offset:38912
v_and_b32 v195, s49, v195
v_cvt_pk_bf16_f32 v66, v68, v69
v_pk_fma_f16 v207, v240, v240, s48
v_mfma_f32_16x16x32_bf16 v[184:187], v[0:3], v[92:95], 0
v_lshrrev_b16 v192, 2, v193
v_cvt_pk_bf16_f32 v67, v70, v71
v_pk_mul_f16 v242, v243, v242
s_waitcnt lgkmcnt(2)
v_mfma_f32_16x16x32_f16 v[136:139], v[4:7], v[232:235], v[136:139]
ds_read_b128 v[0:3], v249 offset:39168
ds_read_u16_d16 v192, v192
v_cvt_pk_bf16_f32 v48, v48, v49
v_lshrrev_b16 v194, 2, v195
v_cvt_pk_bf16_f32 v49, v50, v51
v_mfma_f32_16x16x32_f16 v[144:147], v[4:7], v[236:239], v[144:147]
v_pk_mul_f16 v207, v240, v207
v_lshrrev_b32 v193, 18, v193
v_cvt_pk_bf16_f32 v50, v52, v53
v_mfma_f32_16x16x32_bf16 v[180:183], v[40:43], v[88:91], 0
ds_read_b128 v[4:7], v248 offset:36096
ds_read_u16_d16 v194, v194
ds_read_u16_d16_hi v193, v193
v_exp_f16 v241, v242
v_cvt_pk_bf16_f32 v51, v54, v55
v_mfma_f32_16x16x32_bf16 v[188:191], v[40:43], v[92:95], 0
v_lshrrev_b32 v195, 18, v195
v_cvt_pk_bf16_f32 v80, v80, v81
v_and_b32 v197, s49, v197
v_mfma_f32_16x16x32_f16 v[140:143], v[44:47], v[232:235], v[140:143]
ds_read_b128 v[40:43], v248 offset:36864
ds_read_u16_d16_hi v195, v195
v_cvt_pk_bf16_f32 v81, v82, v83
v_exp_f16 v206, v207
v_mfma_f32_16x16x32_f16 v[148:151], v[44:47], v[236:239], v[148:151]
v_cvt_pk_bf16_f32 v82, v84, v85
v_and_b32 v199, s49, v199
v_cvt_pk_bf16_f32 v83, v86, v87
s_mov_b64 vcc, s[74:75]
s_waitcnt lgkmcnt(5)
v_mfma_f32_16x16x32_bf16 v[176:179], v[224:227], v[208:211], v[176:179]
ds_read_b128 v[44:47], v248 offset:37120
v_lshrrev_b16 v196, 2, v197
v_cndmask_b32_e64 v68, v48, v80, s[74:75]
v_mfma_f32_16x16x32_bf16 v[184:187], v[224:227], v[212:215], v[184:187]
v_exp_f16_sdwa v241, v242 dst_sel:WORD_1 dst_unused:UNUSED_PRESERVE src0_sel:WORD_1
v_cndmask_b32_dpp v48, v64, v48, vcc quad_perm:[1,0,3,2] row_mask:0xf bank_mask:0xf
v_lshrrev_b16 v198, 2, v199
v_mfma_f32_16x16x32_f16 v[152:155], v[228:231], v[232:235], v[152:155]
ds_read_b128 v[224:227], v249 offset:49152
ds_read_u16_d16 v196, v196
ds_read_u16_d16 v198, v198
v_cndmask_b32_e64 v69, v49, v81, s[74:75]
v_lshrrev_b32 v197, 18, v197
v_cndmask_b32_dpp v49, v65, v49, vcc quad_perm:[1,0,3,2] row_mask:0xf bank_mask:0xf
v_mfma_f32_16x16x32_f16 v[160:163], v[228:231], v[236:239], v[160:163]
v_lshrrev_b32 v199, 18, v199
v_exp_f16_sdwa v206, v207 dst_sel:WORD_1 dst_unused:UNUSED_PRESERVE src0_sel:WORD_1
v_mfma_f32_16x16x32_f16 v[156:159], v[0:3], v[232:235], v[156:159]
ds_read_b128 v[228:231], v249 offset:49408
ds_read_u16_d16_hi v197, v197
ds_read_u16_d16_hi v199, v199
v_cndmask_b32_e64 v70, v50, v82, s[74:75]
v_cndmask_b32_dpp v50, v66, v50, vcc quad_perm:[1,0,3,2] row_mask:0xf bank_mask:0xf
v_and_b32 v201, s49, v201
v_mfma_f32_16x16x32_f16 v[164:167], v[0:3], v[236:239], v[164:167]
v_cndmask_b32_e64 v71, v51, v83, s[74:75]
v_and_b32 v203, s49, v203
v_pk_add_f16 v241, v241, 1.0 op_sel_hi:[1,0]
s_waitcnt lgkmcnt(6)
v_mfma_f32_16x16x32_bf16 v[180:183], v[4:7], v[208:211], v[180:183]
ds_read_b128 v[0:3], v248 offset:47104
v_cndmask_b32_dpp v51, v67, v51, vcc quad_perm:[1,0,3,2] row_mask:0xf bank_mask:0xf
s_not_b64 vcc, s[74:75]
v_lshrrev_b16 v200, 2, v201
s_setprio 0
v_cndmask_b32_dpp v80, v64, v80, vcc quad_perm:[1,0,3,2] row_mask:0xf bank_mask:0xf
v_mfma_f32_16x16x32_bf16 v[188:191], v[4:7], v[212:215], v[188:191]
v_pk_add_f16 v206, v206, 1.0 op_sel_hi:[1,0]
v_cndmask_b32_dpp v81, v65, v81, vcc quad_perm:[1,0,3,2] row_mask:0xf bank_mask:0xf
v_lshrrev_b16 v202, 2, v203
v_mfma_f32_16x16x32_bf16 v[176:179], v[40:43], v[32:35], v[176:179]
ds_read_b128 v[4:7], v249 offset:50176
ds_read_u16_d16 v200, v200
ds_read_u16_d16 v202, v202
v_rcp_f16 v242, v241
v_cndmask_b32_dpp v82, v66, v82, vcc quad_perm:[1,0,3,2] row_mask:0xf bank_mask:0xf
v_mfma_f32_16x16x32_bf16 v[184:187], v[40:43], v[36:39], v[184:187]
v_cndmask_b32_dpp v83, v67, v83, vcc quad_perm:[1,0,3,2] row_mask:0xf bank_mask:0xf
v_lshrrev_b32 v201, 18, v201
v_lshrrev_b32 v203, 18, v203
v_mfma_f32_16x16x32_bf16 v[180:183], v[44:47], v[32:35], v[180:183]
ds_read_b128 v[40:43], v248 offset:47360
buffer_store_dwordx4 v[48:51], v255, s[8:11], s70 offen sc1
ds_read_u16_d16_hi v201, v201
ds_read_u16_d16_hi v203, v203
v_rcp_f16 v207, v206
v_mfma_f32_16x16x32_bf16 v[188:191], v[44:47], v[36:39], v[188:191]
v_rcp_f16_sdwa v242, v241 dst_sel:WORD_1 dst_unused:UNUSED_PRESERVE src0_sel:WORD_1
v_or_b32 v232, v192, v193
v_or_b32 v233, v194, v195
s_waitcnt lgkmcnt(6)
v_or_b32 v234, v196, v197
v_rcp_f16_sdwa v207, v206 dst_sel:WORD_1 dst_unused:UNUSED_PRESERVE src0_sel:WORD_1
v_or_b32 v235, v198, v199
s_waitcnt lgkmcnt(1)
v_or_b32 v236, v200, v201
s_waitcnt lgkmcnt(0)
v_or_b32 v237, v202, v203
v_pk_mul_f16 v238, v243, v242
v_pk_mul_f16 v239, v240, v207
s_setprio 3
v_mfma_f32_16x16x32_f16 v[120:123], v[224:227], v[232:235], v[120:123]
buffer_store_dwordx4 v[68:71], v255, s[8:11], s70 offen offset:128 sc1
ds_read_b128 v[44:47], v249 offset:50432
v_cvt_pkrtz_f16_f32 v193, v176, v177
v_cvt_pkrtz_f16_f32 v195, v178, v179
v_mfma_f32_16x16x32_f16 v[128:131], v[224:227], v[236:239], v[128:131]
v_cvt_pkrtz_f16_f32 v197, v180, v181
v_cvt_pkrtz_f16_f32 v199, v182, v183
v_mfma_f32_16x16x32_f16 v[124:127], v[228:231], v[232:235], v[124:127]
ds_read_b128 v[224:227], v248 offset:48128
v_cvt_pkrtz_f16_f32 v201, v184, v185
v_cvt_pk_f16_f32 v243, v186, v187
v_cvt_pk_f16_f32 v240, v188, v189
v_mfma_f32_16x16x32_f16 v[132:135], v[228:231], v[236:239], v[132:135]
v_cvt_pk_f16_f32 v205, v190, v191
v_pk_fma_f16 v242, v243, v243, s48
v_mfma_f32_16x16x32_bf16 v[176:179], v[0:3], v[88:91], 0
ds_read_b128 v[228:231], v249 offset:51200
v_and_b32 v193, s49, v193
v_pk_fma_f16 v207, v240, v240, s48
v_mfma_f32_16x16x32_bf16 v[184:187], v[0:3], v[92:95], 0
v_and_b32 v195, s49, v195
v_pk_fma_f16 v204, v205, v205, s48
v_lshrrev_b16 v192, 2, v193
v_mfma_f32_16x16x32_f16 v[136:139], v[4:7], v[232:235], v[136:139]
ds_read_b128 v[0:3], v249 offset:51456
ds_read_u16_d16 v192, v192
v_pk_mul_f16 v242, v243, v242
v_lshrrev_b16 v194, 2, v195
v_mfma_f32_16x16x32_f16 v[144:147], v[4:7], v[236:239], v[144:147]
v_pk_mul_f16 v207, v240, v207
v_lshrrev_b32 v193, 18, v193
v_mfma_f32_16x16x32_bf16 v[180:183], v[40:43], v[88:91], 0
ds_read_b128 v[4:7], v248 offset:48384
ds_read_u16_d16 v194, v194
ds_read_u16_d16_hi v193, v193
v_pk_mul_f16 v204, v205, v204
v_lshrrev_b32 v195, 18, v195
v_mfma_f32_16x16x32_bf16 v[188:191], v[40:43], v[92:95], 0
v_exp_f16 v241, v242
v_and_b32 v197, s49, v197
s_waitcnt lgkmcnt(6)
v_mfma_f32_16x16x32_f16 v[140:143], v[44:47], v[232:235], v[140:143]
ds_read_b128 v[40:43], v248 offset:49152
ds_read_u16_d16_hi v195, v195
v_and_b32 v199, s49, v199
v_mfma_f32_16x16x32_f16 v[148:151], v[44:47], v[236:239], v[148:151]
v_exp_f16 v206, v207
v_lshrrev_b16 v196, 2, v197
v_lshrrev_b16 v198, 2, v199
v_mfma_f32_16x16x32_bf16 v[176:179], v[224:227], v[208:211], v[176:179]
s_add_u32 s46, s80, 20971520
buffer_load_dwordx4 v[116:119], v253, s[32:35], s46 offen offset:256 nt
ds_read_b128 v[44:47], v248 offset:49408
ds_read_u16_d16 v196, v196
ds_read_u16_d16 v198, v198
v_exp_f16 v203, v204
v_mfma_f32_16x16x32_bf16 v[184:187], v[224:227], v[212:215], v[184:187]
v_lshrrev_b32 v197, 18, v197
v_lshrrev_b32 v199, 18, v199
s_waitcnt lgkmcnt(5)
v_mfma_f32_16x16x32_f16 v[152:155], v[228:231], v[232:235], v[152:155]
ds_read_b128 v[224:227], v249 offset:43008
ds_read_u16_d16_hi v197, v197
ds_read_u16_d16_hi v199, v199
v_exp_f16_sdwa v241, v242 dst_sel:WORD_1 dst_unused:UNUSED_PRESERVE src0_sel:WORD_1
v_and_b32 v201, s49, v201
v_mfma_f32_16x16x32_f16 v[160:163], v[228:231], v[236:239], v[160:163]
v_lshrrev_b16 v200, 2, v201
v_mfma_f32_16x16x32_f16 v[156:159], v[0:3], v[232:235], v[156:159]
ds_read_b128 v[228:231], v249 offset:43264
ds_read_u16_d16 v200, v200
v_exp_f16_sdwa v206, v207 dst_sel:WORD_1 dst_unused:UNUSED_PRESERVE src0_sel:WORD_1
v_lshrrev_b32 v201, 18, v201
v_mfma_f32_16x16x32_f16 v[164:167], v[0:3], v[236:239], v[164:167]
v_exp_f16_sdwa v203, v204 dst_sel:WORD_1 dst_unused:UNUSED_PRESERVE src0_sel:WORD_1
v_pk_add_f16 v241, v241, 1.0 op_sel_hi:[1,0]
v_mfma_f32_16x16x32_bf16 v[180:183], v[4:7], v[208:211], v[180:183]
ds_read_b128 v[0:3], v248 offset:53248
ds_read_u16_d16_hi v201, v201
v_pk_add_f16 v206, v206, 1.0 op_sel_hi:[1,0]
v_pk_add_f16 v203, v203, 1.0 op_sel_hi:[1,0]
v_mfma_f32_16x16x32_bf16 v[188:191], v[4:7], v[212:215], v[188:191]
v_rcp_f16 v242, v241
s_waitcnt lgkmcnt(7)
v_mfma_f32_16x16x32_bf16 v[176:179], v[40:43], v[32:35], v[176:179]
ds_read_b128 v[4:7], v249 offset:44032
v_rcp_f16 v207, v206
v_mfma_f32_16x16x32_bf16 v[184:187], v[40:43], v[36:39], v[184:187]
v_rcp_f16 v204, v203
v_mfma_f32_16x16x32_bf16 v[180:183], v[44:47], v[32:35], v[180:183]
ds_read_b128 v[40:43], v248 offset:53504
v_rcp_f16_sdwa v242, v241 dst_sel:WORD_1 dst_unused:UNUSED_PRESERVE src0_sel:WORD_1
v_mfma_f32_16x16x32_bf16 v[188:191], v[44:47], v[36:39], v[188:191]
v_rcp_f16_sdwa v207, v206 dst_sel:WORD_1 dst_unused:UNUSED_PRESERVE src0_sel:WORD_1
v_or_b32 v232, v192, v193
v_or_b32 v233, v194, v195
s_waitcnt lgkmcnt(4)
v_or_b32 v234, v196, v197
v_rcp_f16_sdwa v204, v203 dst_sel:WORD_1 dst_unused:UNUSED_PRESERVE src0_sel:WORD_1
v_or_b32 v235, v198, v199
s_waitcnt lgkmcnt(2)
v_or_b32 v236, v200, v201
v_pk_mul_f16 v237, v243, v242
v_pk_mul_f16 v238, v240, v207
v_pk_mul_f16 v239, v205, v204
v_mfma_f32_16x16x32_f16 v[120:123], v[224:227], v[232:235], v[120:123]
ds_read_b128 v[44:47], v249 offset:44288
v_cvt_pkrtz_f16_f32 v193, v176, v177
v_cvt_pkrtz_f16_f32 v195, v178, v179
v_mfma_f32_16x16x32_f16 v[128:131], v[224:227], v[236:239], v[128:131]
v_cvt_pkrtz_f16_f32 v197, v180, v181
v_cvt_pkrtz_f16_f32 v199, v182, v183
v_mfma_f32_16x16x32_f16 v[124:127], v[228:231], v[232:235], v[124:127]
ds_read_b128 v[224:227], v248 offset:54272
v_cvt_pkrtz_f16_f32 v201, v184, v185
v_cvt_pk_f16_f32 v243, v186, v187
v_cvt_pk_f16_f32 v240, v188, v189
v_mfma_f32_16x16x32_f16 v[132:135], v[228:231], v[236:239], v[132:135]
v_cvt_pk_f16_f32 v205, v190, v191
v_pk_fma_f16 v242, v243, v243, s48
v_mfma_f32_16x16x32_bf16 v[176:179], v[0:3], v[88:91], 0
ds_read_b128 v[228:231], v249 offset:45056
v_and_b32 v193, s49, v193
v_pk_fma_f16 v207, v240, v240, s48
v_mfma_f32_16x16x32_bf16 v[184:187], v[0:3], v[92:95], 0
v_and_b32 v195, s49, v195
v_pk_fma_f16 v204, v205, v205, s48
s_setprio 2
v_lshrrev_b16 v192, 2, v193
s_waitcnt lgkmcnt(3)
v_mfma_f32_16x16x32_f16 v[136:139], v[4:7], v[232:235], v[136:139]
ds_read_b128 v[0:3], v249 offset:45312
ds_read_u16_d16 v192, v192
v_pk_mul_f16 v242, v243, v242
v_lshrrev_b16 v194, 2, v195
v_mfma_f32_16x16x32_f16 v[144:147], v[4:7], v[236:239], v[144:147]
v_pk_mul_f16 v207, v240, v207
v_lshrrev_b32 v193, 18, v193
v_mfma_f32_16x16x32_bf16 v[180:183], v[40:43], v[88:91], 0
ds_read_b128 v[4:7], v248 offset:54528
ds_read_u16_d16 v194, v194
ds_read_u16_d16_hi v193, v193
v_pk_mul_f16 v204, v205, v204
v_lshrrev_b32 v195, 18, v195
v_mfma_f32_16x16x32_bf16 v[188:191], v[40:43], v[92:95], 0
v_exp_f16 v241, v242
v_and_b32 v197, s49, v197
s_waitcnt lgkmcnt(5)
v_mfma_f32_16x16x32_f16 v[140:143], v[44:47], v[232:235], v[140:143]
ds_read_b128 v[40:43], v248 offset:55296
ds_read_u16_d16_hi v195, v195
v_and_b32 v199, s49, v199
v_mfma_f32_16x16x32_f16 v[148:151], v[44:47], v[236:239], v[148:151]
v_exp_f16 v206, v207
v_lshrrev_b16 v196, 2, v197
v_lshrrev_b16 v198, 2, v199
v_mfma_f32_16x16x32_bf16 v[176:179], v[224:227], v[208:211], v[176:179]
ds_read_b128 v[44:47], v248 offset:55552
ds_read_u16_d16 v196, v196
ds_read_u16_d16 v198, v198
v_exp_f16 v203, v204
v_mfma_f32_16x16x32_bf16 v[184:187], v[224:227], v[212:215], v[184:187]
v_lshrrev_b32 v197, 18, v197
v_lshrrev_b32 v199, 18, v199
v_mfma_f32_16x16x32_f16 v[152:155], v[228:231], v[232:235], v[152:155]
ds_read_b128 v[224:227], v249 offset:55296
ds_read_u16_d16_hi v197, v197
ds_read_u16_d16_hi v199, v199
v_exp_f16_sdwa v241, v242 dst_sel:WORD_1 dst_unused:UNUSED_PRESERVE src0_sel:WORD_1
v_and_b32 v201, s49, v201
v_mfma_f32_16x16x32_f16 v[160:163], v[228:231], v[236:239], v[160:163]
v_lshrrev_b16 v200, 2, v201
s_waitcnt lgkmcnt(8)
v_mfma_f32_16x16x32_f16 v[156:159], v[0:3], v[232:235], v[156:159]
ds_read_b128 v[228:231], v249 offset:55552
ds_read_u16_d16 v200, v200
v_exp_f16_sdwa v206, v207 dst_sel:WORD_1 dst_unused:UNUSED_PRESERVE src0_sel:WORD_1
v_lshrrev_b32 v201, 18, v201
v_mfma_f32_16x16x32_f16 v[164:167], v[0:3], v[236:239], v[164:167]
v_exp_f16_sdwa v203, v204 dst_sel:WORD_1 dst_unused:UNUSED_PRESERVE src0_sel:WORD_1
v_pk_add_f16 v241, v241, 1.0 op_sel_hi:[1,0]
v_mfma_f32_16x16x32_bf16 v[180:183], v[4:7], v[208:211], v[180:183]
ds_read_b128 v[0:3], v248 offset:59392
ds_read_u16_d16_hi v201, v201
v_pk_add_f16 v206, v206, 1.0 op_sel_hi:[1,0]
v_pk_add_f16 v203, v203, 1.0 op_sel_hi:[1,0]
v_mfma_f32_16x16x32_bf16 v[188:191], v[4:7], v[212:215], v[188:191]
v_rcp_f16 v242, v241
s_waitcnt lgkmcnt(7)
v_mfma_f32_16x16x32_bf16 v[176:179], v[40:43], v[32:35], v[176:179]
ds_read_b128 v[4:7], v249 offset:56320
v_rcp_f16 v207, v206
v_mfma_f32_16x16x32_bf16 v[184:187], v[40:43], v[36:39], v[184:187]
v_rcp_f16 v204, v203
v_mfma_f32_16x16x32_bf16 v[180:183], v[44:47], v[32:35], v[180:183]
ds_read_b128 v[40:43], v248 offset:59648
v_rcp_f16_sdwa v242, v241 dst_sel:WORD_1 dst_unused:UNUSED_PRESERVE src0_sel:WORD_1
v_mfma_f32_16x16x32_bf16 v[188:191], v[44:47], v[36:39], v[188:191]
v_rcp_f16_sdwa v207, v206 dst_sel:WORD_1 dst_unused:UNUSED_PRESERVE src0_sel:WORD_1
v_or_b32 v232, v192, v193
v_or_b32 v233, v194, v195
s_waitcnt lgkmcnt(4)
v_or_b32 v234, v196, v197
v_rcp_f16_sdwa v204, v203 dst_sel:WORD_1 dst_unused:UNUSED_PRESERVE src0_sel:WORD_1
v_or_b32 v235, v198, v199
s_waitcnt lgkmcnt(2)
v_or_b32 v236, v200, v201
v_pk_mul_f16 v237, v243, v242
v_pk_mul_f16 v238, v240, v207
v_pk_mul_f16 v239, v205, v204
v_mfma_f32_16x16x32_f16 v[120:123], v[224:227], v[232:235], v[120:123]
buffer_load_dwordx4 v[244:247], v252, s[4:7], s68 offen
ds_read_b128 v[44:47], v249 offset:56576
v_cvt_pkrtz_f16_f32 v193, v176, v177
v_cvt_pkrtz_f16_f32 v195, v178, v179
v_mfma_f32_16x16x32_f16 v[128:131], v[224:227], v[236:239], v[128:131]
v_cvt_pkrtz_f16_f32 v197, v180, v181
v_cvt_pkrtz_f16_f32 v199, v182, v183
v_mfma_f32_16x16x32_f16 v[124:127], v[228:231], v[232:235], v[124:127]
ds_read_b128 v[224:227], v248 offset:60416
v_cvt_pkrtz_f16_f32 v201, v184, v185
v_cvt_pk_f16_f32 v243, v186, v187
v_cvt_pk_f16_f32 v240, v188, v189
v_mfma_f32_16x16x32_f16 v[132:135], v[228:231], v[236:239], v[132:135]
v_cvt_pk_f16_f32 v205, v190, v191
s_setprio 1
v_pk_fma_f16 v242, v243, v243, s48
v_mfma_f32_16x16x32_bf16 v[176:179], v[0:3], v[88:91], 0
ds_read_b128 v[228:231], v249 offset:57344
v_and_b32 v193, s49, v193
v_pk_fma_f16 v207, v240, v240, s48
v_mfma_f32_16x16x32_bf16 v[184:187], v[0:3], v[92:95], 0
v_and_b32 v195, s49, v195
v_pk_fma_f16 v204, v205, v205, s48
v_lshrrev_b16 v192, 2, v193
s_waitcnt lgkmcnt(3)
v_mfma_f32_16x16x32_f16 v[136:139], v[4:7], v[232:235], v[136:139]
ds_read_b128 v[0:3], v249 offset:57600
ds_read_u16_d16 v192, v192
v_pk_mul_f16 v242, v243, v242
v_lshrrev_b16 v194, 2, v195
v_mfma_f32_16x16x32_f16 v[144:147], v[4:7], v[236:239], v[144:147]
v_pk_mul_f16 v207, v240, v207
v_lshrrev_b32 v193, 18, v193
v_mfma_f32_16x16x32_bf16 v[180:183], v[40:43], v[88:91], 0
ds_read_b128 v[4:7], v248 offset:60672
ds_read_u16_d16 v194, v194
ds_read_u16_d16_hi v193, v193
v_pk_mul_f16 v204, v205, v204
v_lshrrev_b32 v195, 18, v195
v_mfma_f32_16x16x32_bf16 v[188:191], v[40:43], v[92:95], 0
v_exp_f16 v241, v242
v_and_b32 v197, s49, v197
s_waitcnt lgkmcnt(5)
v_mfma_f32_16x16x32_f16 v[140:143], v[44:47], v[232:235], v[140:143]
ds_read_b128 v[40:43], v248 offset:61440
ds_read_u16_d16_hi v195, v195
v_and_b32 v199, s49, v199
v_mfma_f32_16x16x32_f16 v[148:151], v[44:47], v[236:239], v[148:151]
v_exp_f16 v206, v207
v_lshrrev_b16 v196, 2, v197
v_lshrrev_b16 v198, 2, v199
v_mfma_f32_16x16x32_bf16 v[176:179], v[224:227], v[208:211], v[176:179]
buffer_store_dwordx4 v[80:83], v255, s[8:11], s70 offen offset:256 sc1
ds_read_b128 v[44:47], v248 offset:61696
ds_read_u16_d16 v196, v196
ds_read_u16_d16 v198, v198
v_exp_f16 v203, v204
v_mfma_f32_16x16x32_bf16 v[184:187], v[224:227], v[212:215], v[184:187]
v_lshrrev_b32 v197, 18, v197
v_lshrrev_b32 v199, 18, v199
v_mfma_f32_16x16x32_f16 v[152:155], v[228:231], v[232:235], v[152:155]
ds_read_b128 v[224:227], v249 offset:61440
ds_read_u16_d16_hi v197, v197
ds_read_u16_d16_hi v199, v199
v_exp_f16_sdwa v241, v242 dst_sel:WORD_1 dst_unused:UNUSED_PRESERVE src0_sel:WORD_1
v_and_b32 v201, s49, v201
v_mfma_f32_16x16x32_f16 v[160:163], v[228:231], v[236:239], v[160:163]
v_lshrrev_b16 v200, 2, v201
s_waitcnt lgkmcnt(8)
v_mfma_f32_16x16x32_f16 v[156:159], v[0:3], v[232:235], v[156:159]
ds_read_b128 v[228:231], v249 offset:61696
ds_read_u16_d16 v200, v200
v_exp_f16_sdwa v206, v207 dst_sel:WORD_1 dst_unused:UNUSED_PRESERVE src0_sel:WORD_1
v_lshrrev_b32 v201, 18, v201
v_mfma_f32_16x16x32_f16 v[164:167], v[0:3], v[236:239], v[164:167]
v_exp_f16_sdwa v203, v204 dst_sel:WORD_1 dst_unused:UNUSED_PRESERVE src0_sel:WORD_1
v_pk_add_f16 v241, v241, 1.0 op_sel_hi:[1,0]
v_mfma_f32_16x16x32_bf16 v[180:183], v[4:7], v[208:211], v[180:183]
ds_read_b128 v[0:3], v249
ds_read_u16_d16_hi v201, v201
v_pk_add_f16 v206, v206, 1.0 op_sel_hi:[1,0]
v_pk_add_f16 v203, v203, 1.0 op_sel_hi:[1,0]
v_mfma_f32_16x16x32_bf16 v[188:191], v[4:7], v[212:215], v[188:191]
v_rcp_f16 v242, v241
s_setprio 0
s_waitcnt lgkmcnt(7)
v_mfma_f32_16x16x32_bf16 v[176:179], v[40:43], v[32:35], v[176:179]
ds_read_b128 v[4:7], v249 offset:62464
v_rcp_f16 v207, v206
v_mfma_f32_16x16x32_bf16 v[184:187], v[40:43], v[36:39], v[184:187]
v_rcp_f16 v204, v203
v_mfma_f32_16x16x32_bf16 v[180:183], v[44:47], v[32:35], v[180:183]
ds_read_b128 v[40:43], v249 offset:256
v_rcp_f16_sdwa v242, v241 dst_sel:WORD_1 dst_unused:UNUSED_PRESERVE src0_sel:WORD_1
v_mfma_f32_16x16x32_bf16 v[188:191], v[44:47], v[36:39], v[188:191]
v_rcp_f16_sdwa v207, v206 dst_sel:WORD_1 dst_unused:UNUSED_PRESERVE src0_sel:WORD_1
v_or_b32 v232, v192, v193
v_or_b32 v233, v194, v195
s_waitcnt lgkmcnt(4)
v_or_b32 v234, v196, v197
v_rcp_f16_sdwa v204, v203 dst_sel:WORD_1 dst_unused:UNUSED_PRESERVE src0_sel:WORD_1
v_or_b32 v235, v198, v199
s_waitcnt lgkmcnt(2)
v_or_b32 v236, v200, v201
v_pk_mul_f16 v237, v243, v242
v_pk_mul_f16 v238, v240, v207
v_pk_mul_f16 v239, v205, v204
s_setprio 3
v_mfma_f32_16x16x32_f16 v[120:123], v[224:227], v[232:235], v[120:123]
buffer_load_dwordx4 v[216:219], v252, s[4:7], s68 offen offset:64
ds_read_b128 v[44:47], v249 offset:62720
v_cvt_pkrtz_f16_f32 v193, v176, v177
v_cvt_pkrtz_f16_f32 v195, v178, v179
v_mfma_f32_16x16x32_f16 v[128:131], v[224:227], v[236:239], v[128:131]
v_cvt_pkrtz_f16_f32 v197, v180, v181
v_cvt_pkrtz_f16_f32 v199, v182, v183
v_mfma_f32_16x16x32_f16 v[124:127], v[228:231], v[232:235], v[124:127]
ds_read_b128 v[224:227], v249 offset:1024
v_cvt_pkrtz_f16_f32 v201, v184, v185
v_cvt_pk_f16_f32 v243, v186, v187
v_cvt_pk_f16_f32 v240, v188, v189
v_mfma_f32_16x16x32_f16 v[132:135], v[228:231], v[236:239], v[132:135]
v_cvt_pk_f16_f32 v205, v190, v191
v_pk_fma_f16 v242, v243, v243, s48
v_mfma_f32_16x16x32_bf16 v[176:179], v[0:3], v[88:91], 0
ds_read_b128 v[228:231], v249 offset:63488
v_and_b32 v193, s49, v193
v_pk_fma_f16 v207, v240, v240, s48
v_mfma_f32_16x16x32_bf16 v[184:187], v[0:3], v[92:95], 0
v_and_b32 v195, s49, v195
v_pk_fma_f16 v204, v205, v205, s48
v_lshrrev_b16 v192, 2, v193
s_waitcnt lgkmcnt(3)
v_mfma_f32_16x16x32_f16 v[136:139], v[4:7], v[232:235], v[136:139]
ds_read_b128 v[0:3], v249 offset:63744
ds_read_u16_d16 v192, v192
v_pk_mul_f16 v242, v243, v242
v_lshrrev_b16 v194, 2, v195
v_mfma_f32_16x16x32_f16 v[144:147], v[4:7], v[236:239], v[144:147]
v_pk_mul_f16 v207, v240, v207
v_lshrrev_b32 v193, 18, v193
v_mfma_f32_16x16x32_bf16 v[180:183], v[40:43], v[88:91], 0
ds_read_b128 v[4:7], v249 offset:1280
ds_read_u16_d16 v194, v194
ds_read_u16_d16_hi v193, v193
v_pk_mul_f16 v204, v205, v204
v_lshrrev_b32 v195, 18, v195
v_mfma_f32_16x16x32_bf16 v[188:191], v[40:43], v[92:95], 0
v_exp_f16 v241, v242
v_and_b32 v197, s49, v197
s_waitcnt lgkmcnt(5)
v_mfma_f32_16x16x32_f16 v[140:143], v[44:47], v[232:235], v[140:143]
ds_read_b128 v[40:43], v249 offset:2048
ds_read_u16_d16_hi v195, v195
v_and_b32 v199, s49, v199
v_mfma_f32_16x16x32_f16 v[148:151], v[44:47], v[236:239], v[148:151]
v_exp_f16 v206, v207
v_lshrrev_b16 v196, 2, v197
v_lshrrev_b16 v198, 2, v199
v_mfma_f32_16x16x32_bf16 v[176:179], v[224:227], v[208:211], v[176:179]
ds_read_b128 v[44:47], v249 offset:2304
ds_read_u16_d16 v196, v196
ds_read_u16_d16 v198, v198
v_exp_f16 v203, v204
v_mfma_f32_16x16x32_bf16 v[184:187], v[224:227], v[212:215], v[184:187]
v_lshrrev_b32 v197, 18, v197
v_lshrrev_b32 v199, 18, v199
v_mfma_f32_16x16x32_f16 v[152:155], v[228:231], v[232:235], v[152:155]
ds_read_b128 v[224:227], v250 offset:2048
ds_read_u16_d16_hi v197, v197
ds_read_u16_d16_hi v199, v199
v_exp_f16_sdwa v241, v242 dst_sel:WORD_1 dst_unused:UNUSED_PRESERVE src0_sel:WORD_1
v_and_b32 v201, s49, v201
v_mfma_f32_16x16x32_f16 v[160:163], v[228:231], v[236:239], v[160:163]
v_lshrrev_b16 v200, 2, v201
s_waitcnt lgkmcnt(8)
v_mfma_f32_16x16x32_f16 v[156:159], v[0:3], v[232:235], v[156:159]
ds_read_b128 v[228:231], v250 offset:2304
ds_read_u16_d16 v200, v200
v_exp_f16_sdwa v206, v207 dst_sel:WORD_1 dst_unused:UNUSED_PRESERVE src0_sel:WORD_1
v_lshrrev_b32 v201, 18, v201
v_mfma_f32_16x16x32_f16 v[164:167], v[0:3], v[236:239], v[164:167]
v_exp_f16_sdwa v203, v204 dst_sel:WORD_1 dst_unused:UNUSED_PRESERVE src0_sel:WORD_1
v_pk_add_f16 v241, v241, 1.0 op_sel_hi:[1,0]
v_mfma_f32_16x16x32_bf16 v[180:183], v[4:7], v[208:211], v[180:183]
ds_read_b128 v[0:3], v249 offset:6144
ds_read_u16_d16_hi v201, v201
v_pk_add_f16 v206, v206, 1.0 op_sel_hi:[1,0]
v_pk_add_f16 v203, v203, 1.0 op_sel_hi:[1,0]
v_mfma_f32_16x16x32_bf16 v[188:191], v[4:7], v[212:215], v[188:191]
v_rcp_f16 v242, v241
s_waitcnt lgkmcnt(7)
v_mfma_f32_16x16x32_bf16 v[176:179], v[40:43], v[32:35], v[176:179]
ds_read_b128 v[4:7], v250 offset:3072
v_rcp_f16 v207, v206
v_mfma_f32_16x16x32_bf16 v[184:187], v[40:43], v[36:39], v[184:187]
v_rcp_f16 v204, v203
v_mfma_f32_16x16x32_bf16 v[180:183], v[44:47], v[32:35], v[180:183]
ds_read_b128 v[40:43], v249 offset:6400
v_rcp_f16_sdwa v242, v241 dst_sel:WORD_1 dst_unused:UNUSED_PRESERVE src0_sel:WORD_1
v_mfma_f32_16x16x32_bf16 v[188:191], v[44:47], v[36:39], v[188:191]
v_rcp_f16_sdwa v207, v206 dst_sel:WORD_1 dst_unused:UNUSED_PRESERVE src0_sel:WORD_1
v_or_b32 v232, v192, v193
v_or_b32 v233, v194, v195
s_waitcnt lgkmcnt(4)
v_or_b32 v234, v196, v197
v_rcp_f16_sdwa v204, v203 dst_sel:WORD_1 dst_unused:UNUSED_PRESERVE src0_sel:WORD_1
v_or_b32 v235, v198, v199
s_waitcnt lgkmcnt(2)
v_or_b32 v236, v200, v201
v_pk_mul_f16 v237, v243, v242
v_pk_mul_f16 v238, v240, v207
v_pk_mul_f16 v239, v205, v204
v_mfma_f32_16x16x32_f16 v[120:123], v[224:227], v[232:235], v[120:123]
ds_read_b128 v[44:47], v250 offset:3328
v_cvt_pkrtz_f16_f32 v193, v176, v177
v_cvt_pkrtz_f16_f32 v195, v178, v179
v_cvt_pkrtz_f16_f32 v197, v180, v181
v_mfma_f32_16x16x32_f16 v[128:131], v[224:227], v[236:239], v[128:131]
v_cvt_pkrtz_f16_f32 v199, v182, v183
v_cvt_pkrtz_f16_f32 v201, v184, v185
v_cvt_pkrtz_f16_f32 v203, v186, v187
v_mfma_f32_16x16x32_f16 v[124:127], v[228:231], v[232:235], v[124:127]
ds_read_b128 v[224:227], v249 offset:7168
v_cvt_pk_f16_f32 v243, v188, v189
v_cvt_pk_f16_f32 v240, v190, v191
v_pk_fma_f16 v242, v243, v243, s48
v_mfma_f32_16x16x32_f16 v[132:135], v[228:231], v[236:239], v[132:135]
v_cvt_pk_bf16_f32 v72, v72, v73
v_and_b32 v193, s49, v193
v_cvt_pk_bf16_f32 v73, v74, v75
v_mfma_f32_16x16x32_bf16 v[176:179], v[0:3], v[88:91], 0
ds_read_b128 v[228:231], v250 offset:4096
v_and_b32 v195, s49, v195
v_cvt_pk_bf16_f32 v74, v76, v77
v_pk_fma_f16 v207, v240, v240, s48
v_mfma_f32_16x16x32_bf16 v[184:187], v[0:3], v[92:95], 0
v_lshrrev_b16 v192, 2, v193
s_setprio 2
v_cvt_pk_bf16_f32 v75, v78, v79
v_pk_mul_f16 v242, v243, v242
s_waitcnt lgkmcnt(2)
v_mfma_f32_16x16x32_f16 v[136:139], v[4:7], v[232:235], v[136:139]
ds_read_b128 v[0:3], v250 offset:4352
ds_read_u16_d16 v192, v192
v_cvt_pk_bf16_f32 v56, v56, v57
v_lshrrev_b16 v194, 2, v195
v_cvt_pk_bf16_f32 v57, v58, v59
v_mfma_f32_16x16x32_f16 v[144:147], v[4:7], v[236:239], v[144:147]
v_pk_mul_f16 v207, v240, v207
v_lshrrev_b32 v193, 18, v193
v_cvt_pk_bf16_f32 v58, v60, v61
v_mfma_f32_16x16x32_bf16 v[180:183], v[40:43], v[88:91], 0
ds_read_b128 v[4:7], v249 offset:7424
ds_read_u16_d16 v194, v194
ds_read_u16_d16_hi v193, v193
v_exp_f16 v241, v242
v_cvt_pk_bf16_f32 v59, v62, v63
v_mfma_f32_16x16x32_bf16 v[188:191], v[40:43], v[92:95], 0
v_lshrrev_b32 v195, 18, v195
v_cvt_pk_bf16_f32 v168, v168, v169
v_and_b32 v197, s49, v197
v_mfma_f32_16x16x32_f16 v[140:143], v[44:47], v[232:235], v[140:143]
ds_read_b128 v[40:43], v249 offset:8192
ds_read_u16_d16_hi v195, v195
v_cvt_pk_bf16_f32 v169, v170, v171
v_exp_f16 v206, v207
v_mfma_f32_16x16x32_f16 v[148:151], v[44:47], v[236:239], v[148:151]
v_cvt_pk_bf16_f32 v170, v172, v173
v_and_b32 v199, s49, v199
v_cvt_pk_bf16_f32 v171, v174, v175
s_mov_b64 vcc, s[74:75]
s_waitcnt lgkmcnt(5)
v_mfma_f32_16x16x32_bf16 v[176:179], v[224:227], v[208:211], v[176:179]
ds_read_b128 v[44:47], v249 offset:8448
v_lshrrev_b16 v196, 2, v197
v_cndmask_b32_e64 v76, v56, v168, s[74:75]
v_mfma_f32_16x16x32_bf16 v[184:187], v[224:227], v[212:215], v[184:187]
v_exp_f16_sdwa v241, v242 dst_sel:WORD_1 dst_unused:UNUSED_PRESERVE src0_sel:WORD_1
v_cndmask_b32_dpp v56, v72, v56, vcc quad_perm:[1,0,3,2] row_mask:0xf bank_mask:0xf
v_lshrrev_b16 v198, 2, v199
v_mfma_f32_16x16x32_f16 v[152:155], v[228:231], v[232:235], v[152:155]
ds_read_b128 v[224:227], v250 offset:8192
ds_read_u16_d16 v196, v196
ds_read_u16_d16 v198, v198
v_cndmask_b32_e64 v77, v57, v169, s[74:75]
v_lshrrev_b32 v197, 18, v197
v_cndmask_b32_dpp v57, v73, v57, vcc quad_perm:[1,0,3,2] row_mask:0xf bank_mask:0xf
v_mfma_f32_16x16x32_f16 v[160:163], v[228:231], v[236:239], v[160:163]
v_lshrrev_b32 v199, 18, v199
v_exp_f16_sdwa v206, v207 dst_sel:WORD_1 dst_unused:UNUSED_PRESERVE src0_sel:WORD_1
v_mfma_f32_16x16x32_f16 v[156:159], v[0:3], v[232:235], v[156:159]
ds_read_b128 v[228:231], v250 offset:8448
ds_read_u16_d16_hi v197, v197
ds_read_u16_d16_hi v199, v199
v_cndmask_b32_e64 v78, v58, v170, s[74:75]
v_cndmask_b32_dpp v58, v74, v58, vcc quad_perm:[1,0,3,2] row_mask:0xf bank_mask:0xf
v_and_b32 v201, s49, v201
v_mfma_f32_16x16x32_f16 v[164:167], v[0:3], v[236:239], v[164:167]
v_cndmask_b32_e64 v79, v59, v171, s[74:75]
v_and_b32 v203, s49, v203
v_pk_add_f16 v241, v241, 1.0 op_sel_hi:[1,0]
s_waitcnt lgkmcnt(6)
v_mfma_f32_16x16x32_bf16 v[180:183], v[4:7], v[208:211], v[180:183]
ds_read_b128 v[0:3], v249 offset:12288
v_cndmask_b32_dpp v59, v75, v59, vcc quad_perm:[1,0,3,2] row_mask:0xf bank_mask:0xf
s_not_b64 vcc, s[74:75]
v_lshrrev_b16 v200, 2, v201
v_cndmask_b32_dpp v168, v72, v168, vcc quad_perm:[1,0,3,2] row_mask:0xf bank_mask:0xf
v_mfma_f32_16x16x32_bf16 v[188:191], v[4:7], v[212:215], v[188:191]
v_pk_add_f16 v206, v206, 1.0 op_sel_hi:[1,0]
v_cndmask_b32_dpp v169, v73, v169, vcc quad_perm:[1,0,3,2] row_mask:0xf bank_mask:0xf
v_lshrrev_b16 v202, 2, v203
v_mfma_f32_16x16x32_bf16 v[176:179], v[40:43], v[32:35], v[176:179]
ds_read_b128 v[4:7], v250 offset:9216
ds_read_u16_d16 v200, v200
ds_read_u16_d16 v202, v202
v_rcp_f16 v242, v241
v_cndmask_b32_dpp v170, v74, v170, vcc quad_perm:[1,0,3,2] row_mask:0xf bank_mask:0xf
v_mfma_f32_16x16x32_bf16 v[184:187], v[40:43], v[36:39], v[184:187]
v_cndmask_b32_dpp v171, v75, v171, vcc quad_perm:[1,0,3,2] row_mask:0xf bank_mask:0xf
v_lshrrev_b32 v201, 18, v201
v_lshrrev_b32 v203, 18, v203
v_mfma_f32_16x16x32_bf16 v[180:183], v[44:47], v[32:35], v[180:183]
ds_read_b128 v[40:43], v249 offset:12544
s_add_u32 s46, s70, 98304
buffer_store_dwordx4 v[56:59], v255, s[8:11], s46 offen sc1
ds_read_u16_d16_hi v201, v201
ds_read_u16_d16_hi v203, v203
v_rcp_f16 v207, v206
v_mfma_f32_16x16x32_bf16 v[188:191], v[44:47], v[36:39], v[188:191]
v_rcp_f16_sdwa v242, v241 dst_sel:WORD_1 dst_unused:UNUSED_PRESERVE src0_sel:WORD_1
v_or_b32 v232, v192, v193
v_or_b32 v233, v194, v195
s_waitcnt lgkmcnt(6)
v_or_b32 v234, v196, v197
v_rcp_f16_sdwa v207, v206 dst_sel:WORD_1 dst_unused:UNUSED_PRESERVE src0_sel:WORD_1
v_or_b32 v235, v198, v199
s_waitcnt lgkmcnt(1)
v_or_b32 v236, v200, v201
s_waitcnt lgkmcnt(0)
v_or_b32 v237, v202, v203
v_pk_mul_f16 v238, v243, v242
v_pk_mul_f16 v239, v240, v207
v_mfma_f32_16x16x32_f16 v[120:123], v[224:227], v[232:235], v[120:123]
buffer_load_dwordx4 v[12:15], v252, s[4:7], s68 offen offset:128
ds_read_b128 v[44:47], v250 offset:9472
v_cvt_pkrtz_f16_f32 v193, v176, v177
v_cvt_pkrtz_f16_f32 v195, v178, v179
v_mfma_f32_16x16x32_f16 v[128:131], v[224:227], v[236:239], v[128:131]
v_cvt_pkrtz_f16_f32 v197, v180, v181
v_cvt_pkrtz_f16_f32 v199, v182, v183
v_mfma_f32_16x16x32_f16 v[124:127], v[228:231], v[232:235], v[124:127]
ds_read_b128 v[224:227], v249 offset:13312
v_cvt_pkrtz_f16_f32 v201, v184, v185
v_cvt_pk_f16_f32 v243, v186, v187
v_cvt_pk_f16_f32 v240, v188, v189
v_mfma_f32_16x16x32_f16 v[132:135], v[228:231], v[236:239], v[132:135]
v_cvt_pk_f16_f32 v205, v190, v191
s_setprio 1
v_pk_fma_f16 v242, v243, v243, s48
v_mfma_f32_16x16x32_bf16 v[176:179], v[0:3], v[88:91], 0
ds_read_b128 v[228:231], v250 offset:10240
v_and_b32 v193, s49, v193
v_pk_fma_f16 v207, v240, v240, s48
v_mfma_f32_16x16x32_bf16 v[184:187], v[0:3], v[92:95], 0
v_and_b32 v195, s49, v195
v_pk_fma_f16 v204, v205, v205, s48
v_lshrrev_b16 v192, 2, v193
v_mfma_f32_16x16x32_f16 v[136:139], v[4:7], v[232:235], v[136:139]
ds_read_b128 v[0:3], v250 offset:10496
ds_read_u16_d16 v192, v192
v_pk_mul_f16 v242, v243, v242
v_lshrrev_b16 v194, 2, v195
v_mfma_f32_16x16x32_f16 v[144:147], v[4:7], v[236:239], v[144:147]
v_pk_mul_f16 v207, v240, v207
v_lshrrev_b32 v193, 18, v193
v_mfma_f32_16x16x32_bf16 v[180:183], v[40:43], v[88:91], 0
ds_read_b128 v[4:7], v249 offset:13568
ds_read_u16_d16 v194, v194
ds_read_u16_d16_hi v193, v193
v_pk_mul_f16 v204, v205, v204
v_lshrrev_b32 v195, 18, v195
v_mfma_f32_16x16x32_bf16 v[188:191], v[40:43], v[92:95], 0
v_exp_f16 v241, v242
v_and_b32 v197, s49, v197
s_waitcnt lgkmcnt(6)
v_mfma_f32_16x16x32_f16 v[140:143], v[44:47], v[232:235], v[140:143]
ds_read_b128 v[40:43], v249 offset:14336
ds_read_u16_d16_hi v195, v195
v_and_b32 v199, s49, v199
v_mfma_f32_16x16x32_f16 v[148:151], v[44:47], v[236:239], v[148:151]
v_exp_f16 v206, v207
v_lshrrev_b16 v196, 2, v197
v_lshrrev_b16 v198, 2, v199
v_mfma_f32_16x16x32_bf16 v[176:179], v[224:227], v[208:211], v[176:179]
ds_read_b128 v[44:47], v249 offset:14592
ds_read_u16_d16 v196, v196
ds_read_u16_d16 v198, v198
v_exp_f16 v203, v204
v_mfma_f32_16x16x32_bf16 v[184:187], v[224:227], v[212:215], v[184:187]
v_lshrrev_b32 v197, 18, v197
v_lshrrev_b32 v199, 18, v199
s_waitcnt lgkmcnt(7)
v_mfma_f32_16x16x32_f16 v[152:155], v[228:231], v[232:235], v[152:155]
ds_read_b128 v[224:227], v250 offset:14336
ds_read_u16_d16_hi v197, v197
ds_read_u16_d16_hi v199, v199
v_exp_f16_sdwa v241, v242 dst_sel:WORD_1 dst_unused:UNUSED_PRESERVE src0_sel:WORD_1
v_and_b32 v201, s49, v201
v_mfma_f32_16x16x32_f16 v[160:163], v[228:231], v[236:239], v[160:163]
v_lshrrev_b16 v200, 2, v201
v_mfma_f32_16x16x32_f16 v[156:159], v[0:3], v[232:235], v[156:159]
ds_read_b128 v[228:231], v250 offset:14592
ds_read_u16_d16 v200, v200
v_exp_f16_sdwa v206, v207 dst_sel:WORD_1 dst_unused:UNUSED_PRESERVE src0_sel:WORD_1
v_lshrrev_b32 v201, 18, v201
v_mfma_f32_16x16x32_f16 v[164:167], v[0:3], v[236:239], v[164:167]
v_exp_f16_sdwa v203, v204 dst_sel:WORD_1 dst_unused:UNUSED_PRESERVE src0_sel:WORD_1
v_pk_add_f16 v241, v241, 1.0 op_sel_hi:[1,0]
v_mfma_f32_16x16x32_bf16 v[180:183], v[4:7], v[208:211], v[180:183]
ds_read_b128 v[0:3], v249 offset:18432
ds_read_u16_d16_hi v201, v201
v_pk_add_f16 v206, v206, 1.0 op_sel_hi:[1,0]
v_pk_add_f16 v203, v203, 1.0 op_sel_hi:[1,0]
v_mfma_f32_16x16x32_bf16 v[188:191], v[4:7], v[212:215], v[188:191]
v_rcp_f16 v242, v241
s_setprio 0
s_waitcnt lgkmcnt(7)
v_mfma_f32_16x16x32_bf16 v[176:179], v[40:43], v[32:35], v[176:179]
ds_read_b128 v[4:7], v250 offset:15360
v_rcp_f16 v207, v206
v_mfma_f32_16x16x32_bf16 v[184:187], v[40:43], v[36:39], v[184:187]
v_rcp_f16 v204, v203
v_mfma_f32_16x16x32_bf16 v[180:183], v[44:47], v[32:35], v[180:183]
ds_read_b128 v[40:43], v249 offset:18688
v_rcp_f16_sdwa v242, v241 dst_sel:WORD_1 dst_unused:UNUSED_PRESERVE src0_sel:WORD_1
v_mfma_f32_16x16x32_bf16 v[188:191], v[44:47], v[36:39], v[188:191]
v_rcp_f16_sdwa v207, v206 dst_sel:WORD_1 dst_unused:UNUSED_PRESERVE src0_sel:WORD_1
v_or_b32 v232, v192, v193
v_or_b32 v233, v194, v195
s_waitcnt lgkmcnt(4)
v_or_b32 v234, v196, v197
v_rcp_f16_sdwa v204, v203 dst_sel:WORD_1 dst_unused:UNUSED_PRESERVE src0_sel:WORD_1
v_or_b32 v235, v198, v199
s_waitcnt lgkmcnt(2)
v_or_b32 v236, v200, v201
v_pk_mul_f16 v237, v243, v242
v_pk_mul_f16 v238, v240, v207
v_pk_mul_f16 v239, v205, v204
s_setprio 3
v_mfma_f32_16x16x32_f16 v[120:123], v[224:227], v[232:235], v[120:123]
s_add_u32 s46, s68, 98304
buffer_load_dwordx4 v[8:11], v252, s[4:7], s46 offen
ds_read_b128 v[44:47], v250 offset:15616
v_cvt_pkrtz_f16_f32 v193, v176, v177
v_cvt_pkrtz_f16_f32 v195, v178, v179
v_mfma_f32_16x16x32_f16 v[128:131], v[224:227], v[236:239], v[128:131]
v_cvt_pkrtz_f16_f32 v197, v180, v181
v_cvt_pkrtz_f16_f32 v199, v182, v183
v_mfma_f32_16x16x32_f16 v[124:127], v[228:231], v[232:235], v[124:127]
ds_read_b128 v[224:227], v249 offset:19456
v_cvt_pkrtz_f16_f32 v201, v184, v185
v_cvt_pk_f16_f32 v243, v186, v187
v_cvt_pk_f16_f32 v240, v188, v189
v_mfma_f32_16x16x32_f16 v[132:135], v[228:231], v[236:239], v[132:135]
v_cvt_pk_f16_f32 v205, v190, v191
v_pk_fma_f16 v242, v243, v243, s48
v_mfma_f32_16x16x32_bf16 v[176:179], v[0:3], v[88:91], 0
ds_read_b128 v[228:231], v250 offset:16384
v_and_b32 v193, s49, v193
v_pk_fma_f16 v207, v240, v240, s48
v_mfma_f32_16x16x32_bf16 v[184:187], v[0:3], v[92:95], 0
v_and_b32 v195, s49, v195
v_pk_fma_f16 v204, v205, v205, s48
v_lshrrev_b16 v192, 2, v193
s_waitcnt lgkmcnt(3)
v_mfma_f32_16x16x32_f16 v[136:139], v[4:7], v[232:235], v[136:139]
ds_read_b128 v[0:3], v250 offset:16640
ds_read_u16_d16 v192, v192
v_pk_mul_f16 v242, v243, v242
v_lshrrev_b16 v194, 2, v195
v_mfma_f32_16x16x32_f16 v[144:147], v[4:7], v[236:239], v[144:147]
v_pk_mul_f16 v207, v240, v207
v_lshrrev_b32 v193, 18, v193
v_mfma_f32_16x16x32_bf16 v[180:183], v[40:43], v[88:91], 0
ds_read_b128 v[4:7], v249 offset:19712
ds_read_u16_d16 v194, v194
ds_read_u16_d16_hi v193, v193
v_pk_mul_f16 v204, v205, v204
v_lshrrev_b32 v195, 18, v195
v_mfma_f32_16x16x32_bf16 v[188:191], v[40:43], v[92:95], 0
v_exp_f16 v241, v242
v_and_b32 v197, s49, v197
s_waitcnt lgkmcnt(5)
v_mfma_f32_16x16x32_f16 v[140:143], v[44:47], v[232:235], v[140:143]
ds_read_b128 v[40:43], v249 offset:20480
ds_read_u16_d16_hi v195, v195
v_and_b32 v199, s49, v199
v_mfma_f32_16x16x32_f16 v[148:151], v[44:47], v[236:239], v[148:151]
v_exp_f16 v206, v207
v_lshrrev_b16 v196, 2, v197
v_lshrrev_b16 v198, 2, v199
v_mfma_f32_16x16x32_bf16 v[176:179], v[224:227], v[208:211], v[176:179]
s_add_u32 s46, s70, 98304
buffer_store_dwordx4 v[76:79], v255, s[8:11], s46 offen offset:128 sc1
ds_read_b128 v[44:47], v249 offset:20736
ds_read_u16_d16 v196, v196
ds_read_u16_d16 v198, v198
v_exp_f16 v203, v204
v_mfma_f32_16x16x32_bf16 v[184:187], v[224:227], v[212:215], v[184:187]
v_lshrrev_b32 v197, 18, v197
v_lshrrev_b32 v199, 18, v199
v_mfma_f32_16x16x32_f16 v[152:155], v[228:231], v[232:235], v[152:155]
ds_read_b128 v[224:227], v250 offset:20480
ds_read_u16_d16_hi v197, v197
ds_read_u16_d16_hi v199, v199
v_exp_f16_sdwa v241, v242 dst_sel:WORD_1 dst_unused:UNUSED_PRESERVE src0_sel:WORD_1
v_and_b32 v201, s49, v201
v_mfma_f32_16x16x32_f16 v[160:163], v[228:231], v[236:239], v[160:163]
v_lshrrev_b16 v200, 2, v201
s_waitcnt lgkmcnt(7)
v_mfma_f32_16x16x32_f16 v[156:159], v[0:3], v[232:235], v[156:159]
ds_read_b128 v[228:231], v250 offset:20736
ds_read_u16_d16 v200, v200
v_exp_f16_sdwa v206, v207 dst_sel:WORD_1 dst_unused:UNUSED_PRESERVE src0_sel:WORD_1
v_lshrrev_b32 v201, 18, v201
v_mfma_f32_16x16x32_f16 v[164:167], v[0:3], v[236:239], v[164:167]
v_exp_f16_sdwa v203, v204 dst_sel:WORD_1 dst_unused:UNUSED_PRESERVE src0_sel:WORD_1
v_pk_add_f16 v241, v241, 1.0 op_sel_hi:[1,0]
v_mfma_f32_16x16x32_bf16 v[180:183], v[4:7], v[208:211], v[180:183]
ds_read_b128 v[0:3], v248 offset:16384
ds_read_u16_d16_hi v201, v201
v_pk_add_f16 v206, v206, 1.0 op_sel_hi:[1,0]
v_pk_add_f16 v203, v203, 1.0 op_sel_hi:[1,0]
v_mfma_f32_16x16x32_bf16 v[188:191], v[4:7], v[212:215], v[188:191]
v_rcp_f16 v242, v241
v_mfma_f32_16x16x32_bf16 v[176:179], v[40:43], v[32:35], v[176:179]
ds_read_b128 v[4:7], v250 offset:21504
v_rcp_f16 v207, v206
v_mfma_f32_16x16x32_bf16 v[184:187], v[40:43], v[36:39], v[184:187]
v_rcp_f16 v204, v203
s_waitcnt lgkmcnt(5)
v_mfma_f32_16x16x32_bf16 v[180:183], v[44:47], v[32:35], v[180:183]
ds_read_b128 v[40:43], v248 offset:16640
v_rcp_f16_sdwa v242, v241 dst_sel:WORD_1 dst_unused:UNUSED_PRESERVE src0_sel:WORD_1
v_mfma_f32_16x16x32_bf16 v[188:191], v[44:47], v[36:39], v[188:191]
v_rcp_f16_sdwa v207, v206 dst_sel:WORD_1 dst_unused:UNUSED_PRESERVE src0_sel:WORD_1
v_or_b32 v232, v192, v193
v_or_b32 v233, v194, v195
v_or_b32 v234, v196, v197
v_rcp_f16_sdwa v204, v203 dst_sel:WORD_1 dst_unused:UNUSED_PRESERVE src0_sel:WORD_1
v_or_b32 v235, v198, v199
s_waitcnt lgkmcnt(2)
v_or_b32 v236, v200, v201
v_pk_mul_f16 v237, v243, v242
v_pk_mul_f16 v238, v240, v207
v_pk_mul_f16 v239, v205, v204
v_mfma_f32_16x16x32_f16 v[120:123], v[224:227], v[232:235], v[120:123]
ds_read_b128 v[44:47], v250 offset:21760
v_cvt_pkrtz_f16_f32 v193, v176, v177
v_cvt_pkrtz_f16_f32 v195, v178, v179
v_mfma_f32_16x16x32_f16 v[128:131], v[224:227], v[236:239], v[128:131]
v_cvt_pkrtz_f16_f32 v197, v180, v181
v_cvt_pkrtz_f16_f32 v199, v182, v183
v_mfma_f32_16x16x32_f16 v[124:127], v[228:231], v[232:235], v[124:127]
ds_read_b128 v[224:227], v248 offset:17408
v_cvt_pkrtz_f16_f32 v201, v184, v185
v_cvt_pk_f16_f32 v243, v186, v187
v_cvt_pk_f16_f32 v240, v188, v189
v_mfma_f32_16x16x32_f16 v[132:135], v[228:231], v[236:239], v[132:135]
v_cvt_pk_f16_f32 v205, v190, v191
v_pk_fma_f16 v242, v243, v243, s48
s_waitcnt vmcnt(14)
v_mfma_f32_16x16x32_bf16 v[176:179], v[0:3], v[96:99], 0
ds_read_b128 v[228:231], v250 offset:22528
v_and_b32 v193, s49, v193
v_pk_fma_f16 v207, v240, v240, s48
s_waitcnt vmcnt(13)
v_mfma_f32_16x16x32_bf16 v[184:187], v[0:3], v[100:103], 0
v_and_b32 v195, s49, v195
v_pk_fma_f16 v204, v205, v205, s48
s_setprio 2
v_lshrrev_b16 v192, 2, v193
s_waitcnt lgkmcnt(2)
v_mfma_f32_16x16x32_f16 v[136:139], v[4:7], v[232:235], v[136:139]
ds_read_b128 v[0:3], v250 offset:22784
ds_read_u16_d16 v192, v192
v_pk_mul_f16 v242, v243, v242
v_lshrrev_b16 v194, 2, v195
v_mfma_f32_16x16x32_f16 v[144:147], v[4:7], v[236:239], v[144:147]
v_pk_mul_f16 v207, v240, v207
v_lshrrev_b32 v193, 18, v193
v_mfma_f32_16x16x32_bf16 v[180:183], v[40:43], v[96:99], 0
ds_read_b128 v[4:7], v248 offset:17664
ds_read_u16_d16 v194, v194
ds_read_u16_d16_hi v193, v193
v_pk_mul_f16 v204, v205, v204
v_lshrrev_b32 v195, 18, v195
v_mfma_f32_16x16x32_bf16 v[188:191], v[40:43], v[100:103], 0
v_exp_f16 v241, v242
v_and_b32 v197, s49, v197
v_mfma_f32_16x16x32_f16 v[140:143], v[44:47], v[232:235], v[140:143]
ds_read_b128 v[40:43], v248 offset:18432
ds_read_u16_d16_hi v195, v195
v_and_b32 v199, s49, v199
v_mfma_f32_16x16x32_f16 v[148:151], v[44:47], v[236:239], v[148:151]
v_exp_f16 v206, v207
v_lshrrev_b16 v196, 2, v197
v_lshrrev_b16 v198, 2, v199
s_waitcnt vmcnt(12) lgkmcnt(7)
v_mfma_f32_16x16x32_bf16 v[176:179], v[224:227], v[104:107], v[176:179]
ds_read_b128 v[44:47], v248 offset:18688
ds_read_u16_d16 v196, v196
ds_read_u16_d16 v198, v198
v_exp_f16 v203, v204
s_waitcnt vmcnt(11)
v_mfma_f32_16x16x32_bf16 v[184:187], v[224:227], v[108:111], v[184:187]
v_lshrrev_b32 v197, 18, v197
v_lshrrev_b32 v199, 18, v199
v_mfma_f32_16x16x32_f16 v[152:155], v[228:231], v[232:235], v[152:155]
ds_read_b128 v[224:227], v250 offset:26624
ds_read_u16_d16_hi v197, v197
ds_read_u16_d16_hi v199, v199
v_exp_f16_sdwa v241, v242 dst_sel:WORD_1 dst_unused:UNUSED_PRESERVE src0_sel:WORD_1
v_and_b32 v201, s49, v201
v_mfma_f32_16x16x32_f16 v[160:163], v[228:231], v[236:239], v[160:163]
v_lshrrev_b16 v200, 2, v201
s_waitcnt lgkmcnt(7)
v_mfma_f32_16x16x32_f16 v[156:159], v[0:3], v[232:235], v[156:159]
ds_read_b128 v[228:231], v250 offset:26880
ds_read_u16_d16 v200, v200
v_exp_f16_sdwa v206, v207 dst_sel:WORD_1 dst_unused:UNUSED_PRESERVE src0_sel:WORD_1
v_lshrrev_b32 v201, 18, v201
v_mfma_f32_16x16x32_f16 v[164:167], v[0:3], v[236:239], v[164:167]
v_exp_f16_sdwa v203, v204 dst_sel:WORD_1 dst_unused:UNUSED_PRESERVE src0_sel:WORD_1
v_pk_add_f16 v241, v241, 1.0 op_sel_hi:[1,0]
v_mfma_f32_16x16x32_bf16 v[180:183], v[4:7], v[104:107], v[180:183]
ds_read_b128 v[0:3], v248 offset:22528
ds_read_u16_d16_hi v201, v201
v_pk_add_f16 v206, v206, 1.0 op_sel_hi:[1,0]
v_pk_add_f16 v203, v203, 1.0 op_sel_hi:[1,0]
v_mfma_f32_16x16x32_bf16 v[188:191], v[4:7], v[108:111], v[188:191]
v_rcp_f16 v242, v241
s_waitcnt vmcnt(10)
v_mfma_f32_16x16x32_bf16 v[176:179], v[40:43], v[112:115], v[176:179]
ds_read_b128 v[4:7], v250 offset:27648
v_rcp_f16 v207, v206
s_waitcnt vmcnt(7)
v_mfma_f32_16x16x32_bf16 v[184:187], v[40:43], v[116:119], v[184:187]
v_rcp_f16 v204, v203
s_waitcnt lgkmcnt(5)
v_mfma_f32_16x16x32_bf16 v[180:183], v[44:47], v[112:115], v[180:183]
ds_read_b128 v[40:43], v248 offset:22784
v_rcp_f16_sdwa v242, v241 dst_sel:WORD_1 dst_unused:UNUSED_PRESERVE src0_sel:WORD_1
v_mfma_f32_16x16x32_bf16 v[188:191], v[44:47], v[116:119], v[188:191]
v_rcp_f16_sdwa v207, v206 dst_sel:WORD_1 dst_unused:UNUSED_PRESERVE src0_sel:WORD_1
v_or_b32 v232, v192, v193
v_or_b32 v233, v194, v195
v_or_b32 v234, v196, v197
v_rcp_f16_sdwa v204, v203 dst_sel:WORD_1 dst_unused:UNUSED_PRESERVE src0_sel:WORD_1
v_or_b32 v235, v198, v199
s_waitcnt lgkmcnt(2)
v_or_b32 v236, v200, v201
v_pk_mul_f16 v237, v243, v242
v_pk_mul_f16 v238, v240, v207
v_pk_mul_f16 v239, v205, v204
v_mfma_f32_16x16x32_f16 v[120:123], v[224:227], v[232:235], v[120:123]
s_add_u32 s46, s68, 98304
buffer_load_dwordx4 v[36:39], v252, s[4:7], s46 offen offset:64
ds_read_b128 v[44:47], v250 offset:27904
v_cvt_pkrtz_f16_f32 v193, v176, v177
v_cvt_pkrtz_f16_f32 v195, v178, v179
v_mfma_f32_16x16x32_f16 v[128:131], v[224:227], v[236:239], v[128:131]
v_cvt_pkrtz_f16_f32 v197, v180, v181
v_cvt_pkrtz_f16_f32 v199, v182, v183
v_mfma_f32_16x16x32_f16 v[124:127], v[228:231], v[232:235], v[124:127]
ds_read_b128 v[224:227], v248 offset:23552
v_cvt_pkrtz_f16_f32 v201, v184, v185
v_cvt_pk_f16_f32 v243, v186, v187
v_mfma_f32_16x16x32_f16 v[132:135], v[228:231], v[236:239], v[132:135]
v_cvt_pk_f16_f32 v240, v188, v189
v_cvt_pk_f16_f32 v205, v190, v191
s_setprio 1
v_mfma_f32_16x16x32_bf16 v[176:179], v[0:3], v[96:99], 0
ds_read_b128 v[228:231], v250 offset:28672
v_pk_fma_f16 v242, v243, v243, s48
v_and_b32 v193, s49, v193
v_mfma_f32_16x16x32_bf16 v[184:187], v[0:3], v[100:103], 0
v_pk_fma_f16 v207, v240, v240, s48
v_and_b32 v195, s49, v195
s_waitcnt lgkmcnt(3)
v_mfma_f32_16x16x32_f16 v[136:139], v[4:7], v[232:235], v[136:139]
ds_read_b128 v[0:3], v250 offset:28928
v_pk_fma_f16 v204, v205, v205, s48
v_lshrrev_b16 v192, 2, v193
v_pk_mul_f16 v242, v243, v242
v_mfma_f32_16x16x32_f16 v[144:147], v[4:7], v[236:239], v[144:147]
v_lshrrev_b16 v194, 2, v195
v_pk_mul_f16 v207, v240, v207
s_waitcnt vmcnt(7)
v_mfma_f32_16x16x32_bf16 v[120:123], v[26:29], v[244:247], v[120:123]
ds_read_b128 v[4:7], v248 offset:23808
ds_read_u16_d16 v192, v192
ds_read_u16_d16 v194, v194
v_lshrrev_b32 v193, 18, v193
v_pk_mul_f16 v204, v205, v204
v_mfma_f32_16x16x32_bf16 v[124:127], v[24:27], v[244:247], v[124:127]
v_lshrrev_b32 v195, 18, v195
v_mfma_f32_16x16x32_bf16 v[180:183], v[40:43], v[96:99], 0
ds_read_u16_d16_hi v193, v193
ds_read_u16_d16_hi v195, v195
v_exp_f16 v241, v242
v_and_b32 v197, s49, v197
v_mfma_f32_16x16x32_bf16 v[188:191], v[40:43], v[100:103], 0
v_and_b32 v199, s49, v199
s_waitcnt lgkmcnt(6)
v_mfma_f32_16x16x32_f16 v[140:143], v[44:47], v[232:235], v[140:143]
ds_read_b128 v[40:43], v248 offset:24576
v_exp_f16 v206, v207
v_lshrrev_b16 v196, 2, v197
v_mfma_f32_16x16x32_f16 v[148:151], v[44:47], v[236:239], v[148:151]
v_lshrrev_b16 v198, 2, v199
v_exp_f16 v203, v204
v_mfma_f32_16x16x32_bf16 v[176:179], v[224:227], v[104:107], v[176:179]
s_add_u32 s46, s70, 98304
buffer_store_dwordx4 v[168:171], v255, s[8:11], s46 offen offset:256 sc1
ds_read_b128 v[44:47], v248 offset:24832
ds_read_u16_d16 v196, v196
ds_read_u16_d16 v198, v198
v_lshrrev_b32 v197, 18, v197
v_lshrrev_b32 v199, 18, v199
v_mfma_f32_16x16x32_bf16 v[184:187], v[224:227], v[108:111], v[184:187]
v_exp_f16_sdwa v241, v242 dst_sel:WORD_1 dst_unused:UNUSED_PRESERVE src0_sel:WORD_1
v_mfma_f32_16x16x32_f16 v[152:155], v[228:231], v[232:235], v[152:155]
ds_read_b128 v[224:227], v249 offset:24576
ds_read_u16_d16_hi v197, v197
ds_read_u16_d16_hi v199, v199
v_and_b32 v201, s49, v201
v_lshrrev_b16 v200, 2, v201
v_mfma_f32_16x16x32_f16 v[160:163], v[228:231], v[236:239], v[160:163]
v_exp_f16_sdwa v206, v207 dst_sel:WORD_1 dst_unused:UNUSED_PRESERVE src0_sel:WORD_1
s_waitcnt lgkmcnt(7)
v_mfma_f32_16x16x32_f16 v[156:159], v[0:3], v[232:235], v[156:159]
ds_read_b128 v[228:231], v254 offset:7936
ds_read_u16_d16 v200, v200
v_lshrrev_b32 v201, 18, v201
v_mfma_f32_16x16x32_f16 v[164:167], v[0:3], v[236:239], v[164:167]
v_exp_f16_sdwa v203, v204 dst_sel:WORD_1 dst_unused:UNUSED_PRESERVE src0_sel:WORD_1
v_pk_add_f16 v241, v241, 1.0 op_sel_hi:[1,0]
v_pk_add_f16 v206, v206, 1.0 op_sel_hi:[1,0]
v_mfma_f32_16x16x32_bf16 v[180:183], v[4:7], v[104:107], v[180:183]
ds_read_b128 v[0:3], v249 offset:24832
ds_read_u16_d16_hi v201, v201
v_pk_add_f16 v203, v203, 1.0 op_sel_hi:[1,0]
v_mfma_f32_16x16x32_bf16 v[188:191], v[4:7], v[108:111], v[188:191]
v_rcp_f16 v242, v241
s_setprio 0
s_waitcnt lgkmcnt(7)
v_mfma_f32_16x16x32_bf16 v[176:179], v[40:43], v[112:115], v[176:179]
ds_read_b128 v[4:7], v254 offset:7952
v_rcp_f16 v207, v206
v_mfma_f32_16x16x32_bf16 v[184:187], v[40:43], v[116:119], v[184:187]
v_rcp_f16 v204, v203
v_mfma_f32_16x16x32_bf16 v[180:183], v[44:47], v[112:115], v[180:183]
ds_read_b128 v[40:43], v248 offset:28672
v_rcp_f16_sdwa v242, v241 dst_sel:WORD_1 dst_unused:UNUSED_PRESERVE src0_sel:WORD_1
v_mfma_f32_16x16x32_bf16 v[188:191], v[44:47], v[116:119], v[188:191]
v_rcp_f16_sdwa v207, v206 dst_sel:WORD_1 dst_unused:UNUSED_PRESERVE src0_sel:WORD_1
v_or_b32 v232, v192, v193
v_or_b32 v233, v194, v195
s_waitcnt lgkmcnt(4)
v_or_b32 v234, v196, v197
v_rcp_f16_sdwa v204, v203 dst_sel:WORD_1 dst_unused:UNUSED_PRESERVE src0_sel:WORD_1
v_or_b32 v235, v198, v199
s_waitcnt lgkmcnt(2)
v_or_b32 v236, v200, v201
v_pk_mul_f16 v237, v243, v242
v_pk_mul_f16 v238, v240, v207
v_pk_mul_f16 v239, v205, v204
s_setprio 3
v_mfma_f32_16x16x32_f16 v[48:51], v[224:227], v[232:235], v[228:231]
ds_read_b128 v[44:47], v249 offset:25600
v_cvt_pkrtz_f16_f32 v193, v176, v177
v_cvt_pkrtz_f16_f32 v195, v178, v179
v_mfma_f32_16x16x32_f16 v[56:59], v[224:227], v[236:239], v[228:231]
v_cvt_pkrtz_f16_f32 v197, v180, v181
v_cvt_pkrtz_f16_f32 v199, v182, v183
s_waitcnt lgkmcnt(2)
v_mfma_f32_16x16x32_f16 v[52:55], v[0:3], v[232:235], v[4:7]
ds_read_b128 v[224:227], v254 offset:8064
ds_read_b128 v[228:231], v248 offset:28928
v_cvt_pkrtz_f16_f32 v201, v184, v185
v_cvt_pk_f16_f32 v243, v186, v187
v_mfma_f32_16x16x32_f16 v[60:63], v[0:3], v[236:239], v[4:7]
v_cvt_pk_f16_f32 v240, v188, v189
v_cvt_pk_f16_f32 v205, v190, v191
s_waitcnt lgkmcnt(3)
v_mfma_f32_16x16x32_bf16 v[176:179], v[40:43], v[96:99], 0
ds_read_b128 v[0:3], v249 offset:25856
ds_read_b128 v[4:7], v254 offset:8080
v_pk_fma_f16 v242, v243, v243, s48
v_and_b32 v193, s49, v193
v_mfma_f32_16x16x32_bf16 v[184:187], v[40:43], v[100:103], 0
v_pk_fma_f16 v207, v240, v240, s48
v_and_b32 v195, s49, v195
s_waitcnt lgkmcnt(3)
v_mfma_f32_16x16x32_f16 v[64:67], v[44:47], v[232:235], v[224:227]
ds_read_b128 v[40:43], v248 offset:29696
v_pk_fma_f16 v204, v205, v205, s48
v_lshrrev_b16 v192, 2, v193
v_pk_mul_f16 v242, v243, v242
v_mfma_f32_16x16x32_f16 v[72:75], v[44:47], v[236:239], v[224:227]
v_lshrrev_b16 v194, 2, v195
v_pk_mul_f16 v207, v240, v207
s_waitcnt vmcnt(6)
v_mfma_f32_16x16x32_bf16 v[136:139], v[26:29], v[216:219], v[136:139]
ds_read_b128 v[44:47], v249 offset:26624
ds_read_b128 v[224:227], v254 offset:16128
ds_read_u16_d16 v192, v192
ds_read_u16_d16 v194, v194
v_lshrrev_b32 v193, 18, v193
v_pk_mul_f16 v204, v205, v204
v_mfma_f32_16x16x32_bf16 v[140:143], v[24:27], v[216:219], v[140:143]
v_lshrrev_b32 v195, 18, v195
s_waitcnt lgkmcnt(5)
v_mfma_f32_16x16x32_bf16 v[180:183], v[228:231], v[96:99], 0
ds_read_u16_d16_hi v193, v193
ds_read_u16_d16_hi v195, v195
v_exp_f16 v241, v242
v_and_b32 v197, s49, v197
v_mfma_f32_16x16x32_bf16 v[188:191], v[228:231], v[100:103], 0
v_and_b32 v199, s49, v199
v_mfma_f32_16x16x32_f16 v[68:71], v[0:3], v[232:235], v[4:7]
ds_read_b128 v[228:231], v249 offset:26880
v_exp_f16 v206, v207
v_lshrrev_b16 v196, 2, v197
v_mfma_f32_16x16x32_f16 v[76:79], v[0:3], v[236:239], v[4:7]
v_lshrrev_b16 v198, 2, v199
v_exp_f16 v203, v204
s_waitcnt lgkmcnt(7)
v_mfma_f32_16x16x32_bf16 v[176:179], v[40:43], v[104:107], v[176:179]
ds_read_b128 v[0:3], v254 offset:16144
ds_read_b128 v[4:7], v248 offset:29952
ds_read_u16_d16 v196, v196
ds_read_u16_d16 v198, v198
v_lshrrev_b32 v197, 18, v197
v_lshrrev_b32 v199, 18, v199
v_mfma_f32_16x16x32_bf16 v[184:187], v[40:43], v[108:111], v[184:187]
v_exp_f16_sdwa v241, v242 dst_sel:WORD_1 dst_unused:UNUSED_PRESERVE src0_sel:WORD_1
s_waitcnt lgkmcnt(7)
v_mfma_f32_16x16x32_f16 v[80:83], v[44:47], v[232:235], v[224:227]
ds_read_b128 v[40:43], v248 offset:30720
ds_read_u16_d16_hi v197, v197
ds_read_u16_d16_hi v199, v199
v_and_b32 v201, s49, v201
v_lshrrev_b16 v200, 2, v201
v_mfma_f32_16x16x32_f16 v[168:171], v[44:47], v[236:239], v[224:227]
v_exp_f16_sdwa v206, v207 dst_sel:WORD_1 dst_unused:UNUSED_PRESERVE src0_sel:WORD_1
s_waitcnt lgkmcnt(6)
v_mfma_f32_16x16x32_f16 v[84:87], v[228:231], v[232:235], v[0:3]
ds_read_b128 v[44:47], v248 offset:30976
ds_read_b128 v[224:227], v249 offset:30720
ds_read_u16_d16 v200, v200
v_lshrrev_b32 v201, 18, v201
v_mfma_f32_16x16x32_f16 v[172:175], v[228:231], v[236:239], v[0:3]
v_exp_f16_sdwa v203, v204 dst_sel:WORD_1 dst_unused:UNUSED_PRESERVE src0_sel:WORD_1
v_pk_add_f16 v241, v241, 1.0 op_sel_hi:[1,0]
v_pk_add_f16 v206, v206, 1.0 op_sel_hi:[1,0]
s_waitcnt lgkmcnt(7)
v_mfma_f32_16x16x32_bf16 v[180:183], v[4:7], v[104:107], v[180:183]
ds_read_b128 v[228:231], v249 offset:30976
ds_read_b128 v[0:3], v248 offset:34816
ds_read_u16_d16_hi v201, v201
v_pk_add_f16 v203, v203, 1.0 op_sel_hi:[1,0]
v_mfma_f32_16x16x32_bf16 v[188:191], v[4:7], v[108:111], v[188:191]
v_rcp_f16 v242, v241
s_waitcnt lgkmcnt(8)
v_mfma_f32_16x16x32_bf16 v[176:179], v[40:43], v[112:115], v[176:179]
ds_read_b128 v[4:7], v249 offset:31744
v_rcp_f16 v207, v206
v_mfma_f32_16x16x32_bf16 v[184:187], v[40:43], v[116:119], v[184:187]
v_rcp_f16 v204, v203
s_waitcnt lgkmcnt(6)
v_mfma_f32_16x16x32_bf16 v[180:183], v[44:47], v[112:115], v[180:183]
ds_read_b128 v[40:43], v248 offset:35072
v_rcp_f16_sdwa v242, v241 dst_sel:WORD_1 dst_unused:UNUSED_PRESERVE src0_sel:WORD_1
v_mfma_f32_16x16x32_bf16 v[188:191], v[44:47], v[116:119], v[188:191]
v_rcp_f16_sdwa v207, v206 dst_sel:WORD_1 dst_unused:UNUSED_PRESERVE src0_sel:WORD_1
v_or_b32 v232, v192, v193
v_or_b32 v233, v194, v195
v_or_b32 v234, v196, v197
v_rcp_f16_sdwa v204, v203 dst_sel:WORD_1 dst_unused:UNUSED_PRESERVE src0_sel:WORD_1
v_or_b32 v235, v198, v199
s_waitcnt lgkmcnt(2)
v_or_b32 v236, v200, v201
v_pk_mul_f16 v237, v243, v242
v_pk_mul_f16 v238, v240, v207
v_pk_mul_f16 v239, v205, v204
v_mfma_f32_16x16x32_f16 v[48:51], v[224:227], v[232:235], v[48:51]
s_add_u32 s46, s68, 98304
buffer_load_dwordx4 v[216:219], v252, s[4:7], s46 offen offset:128
ds_read_b128 v[44:47], v249 offset:32000
v_cvt_pkrtz_f16_f32 v193, v176, v177
v_cvt_pkrtz_f16_f32 v195, v178, v179
v_mfma_f32_16x16x32_f16 v[56:59], v[224:227], v[236:239], v[56:59]
v_cvt_pkrtz_f16_f32 v197, v180, v181
v_cvt_pkrtz_f16_f32 v199, v182, v183
v_mfma_f32_16x16x32_f16 v[52:55], v[228:231], v[232:235], v[52:55]
ds_read_b128 v[224:227], v248 offset:35840
v_cvt_pkrtz_f16_f32 v201, v184, v185
v_cvt_pk_f16_f32 v243, v186, v187
v_mfma_f32_16x16x32_f16 v[60:63], v[228:231], v[236:239], v[60:63]
v_cvt_pk_f16_f32 v240, v188, v189
v_cvt_pk_f16_f32 v205, v190, v191
v_mfma_f32_16x16x32_bf16 v[176:179], v[0:3], v[96:99], 0
ds_read_b128 v[228:231], v249 offset:32768
v_pk_fma_f16 v242, v243, v243, s48
v_and_b32 v193, s49, v193
v_mfma_f32_16x16x32_bf16 v[184:187], v[0:3], v[100:103], 0
v_pk_fma_f16 v207, v240, v240, s48
v_and_b32 v195, s49, v195
s_waitcnt lgkmcnt(3)
v_mfma_f32_16x16x32_f16 v[64:67], v[4:7], v[232:235], v[64:67]
ds_read_b128 v[0:3], v249 offset:33024
v_pk_fma_f16 v204, v205, v205, s48
s_setprio 2
v_lshrrev_b16 v192, 2, v193
v_pk_mul_f16 v242, v243, v242
v_mfma_f32_16x16x32_f16 v[72:75], v[4:7], v[236:239], v[72:75]
v_lshrrev_b16 v194, 2, v195
v_pk_mul_f16 v207, v240, v207
s_waitcnt vmcnt(5)
v_mfma_f32_16x16x32_bf16 v[152:155], v[26:29], v[12:15], v[152:155]
ds_read_b128 v[4:7], v248 offset:36096
ds_read_u16_d16 v192, v192
ds_read_u16_d16 v194, v194
v_lshrrev_b32 v193, 18, v193
v_pk_mul_f16 v204, v205, v204
v_mfma_f32_16x16x32_bf16 v[156:159], v[24:27], v[12:15], v[156:159]
v_lshrrev_b32 v195, 18, v195
v_mfma_f32_16x16x32_bf16 v[180:183], v[40:43], v[96:99], 0
ds_read_u16_d16_hi v193, v193
ds_read_u16_d16_hi v195, v195
v_exp_f16 v241, v242
v_and_b32 v197, s49, v197
v_mfma_f32_16x16x32_bf16 v[188:191], v[40:43], v[100:103], 0
v_and_b32 v199, s49, v199
s_waitcnt lgkmcnt(6)
v_mfma_f32_16x16x32_f16 v[68:71], v[44:47], v[232:235], v[68:71]
ds_read_b128 v[40:43], v248 offset:36864
v_exp_f16 v206, v207
v_lshrrev_b16 v196, 2, v197
v_mfma_f32_16x16x32_f16 v[76:79], v[44:47], v[236:239], v[76:79]
v_lshrrev_b16 v198, 2, v199
v_exp_f16 v203, v204
v_mfma_f32_16x16x32_bf16 v[176:179], v[224:227], v[104:107], v[176:179]
ds_read_b128 v[44:47], v248 offset:37120
ds_read_u16_d16 v196, v196
ds_read_u16_d16 v198, v198
v_lshrrev_b32 v197, 18, v197
v_lshrrev_b32 v199, 18, v199
v_mfma_f32_16x16x32_bf16 v[184:187], v[224:227], v[108:111], v[184:187]
v_exp_f16_sdwa v241, v242 dst_sel:WORD_1 dst_unused:UNUSED_PRESERVE src0_sel:WORD_1
v_mfma_f32_16x16x32_f16 v[80:83], v[228:231], v[232:235], v[80:83]
ds_read_b128 v[224:227], v249 offset:36864
ds_read_u16_d16_hi v197, v197
ds_read_u16_d16_hi v199, v199
v_and_b32 v201, s49, v201
v_lshrrev_b16 v200, 2, v201
v_mfma_f32_16x16x32_f16 v[168:171], v[228:231], v[236:239], v[168:171]
v_exp_f16_sdwa v206, v207 dst_sel:WORD_1 dst_unused:UNUSED_PRESERVE src0_sel:WORD_1
s_waitcnt lgkmcnt(7)
v_mfma_f32_16x16x32_f16 v[84:87], v[0:3], v[232:235], v[84:87]
ds_read_b128 v[228:231], v249 offset:37120
ds_read_u16_d16 v200, v200
v_lshrrev_b32 v201, 18, v201
v_mfma_f32_16x16x32_f16 v[172:175], v[0:3], v[236:239], v[172:175]
v_exp_f16_sdwa v203, v204 dst_sel:WORD_1 dst_unused:UNUSED_PRESERVE src0_sel:WORD_1
v_pk_add_f16 v241, v241, 1.0 op_sel_hi:[1,0]
v_pk_add_f16 v206, v206, 1.0 op_sel_hi:[1,0]
v_mfma_f32_16x16x32_bf16 v[180:183], v[4:7], v[104:107], v[180:183]
ds_read_b128 v[0:3], v248 offset:40960
ds_read_u16_d16_hi v201, v201
v_pk_add_f16 v203, v203, 1.0 op_sel_hi:[1,0]
v_mfma_f32_16x16x32_bf16 v[188:191], v[4:7], v[108:111], v[188:191]
v_rcp_f16 v242, v241
s_waitcnt lgkmcnt(7)
v_mfma_f32_16x16x32_bf16 v[176:179], v[40:43], v[112:115], v[176:179]
ds_read_b128 v[4:7], v249 offset:37888
v_rcp_f16 v207, v206
v_mfma_f32_16x16x32_bf16 v[184:187], v[40:43], v[116:119], v[184:187]
v_rcp_f16 v204, v203
v_mfma_f32_16x16x32_bf16 v[180:183], v[44:47], v[112:115], v[180:183]
ds_read_b128 v[40:43], v248 offset:41216
v_rcp_f16_sdwa v242, v241 dst_sel:WORD_1 dst_unused:UNUSED_PRESERVE src0_sel:WORD_1
v_mfma_f32_16x16x32_bf16 v[188:191], v[44:47], v[116:119], v[188:191]
v_rcp_f16_sdwa v207, v206 dst_sel:WORD_1 dst_unused:UNUSED_PRESERVE src0_sel:WORD_1
v_or_b32 v232, v192, v193
v_or_b32 v233, v194, v195
s_waitcnt lgkmcnt(4)
v_or_b32 v234, v196, v197
v_rcp_f16_sdwa v204, v203 dst_sel:WORD_1 dst_unused:UNUSED_PRESERVE src0_sel:WORD_1
v_or_b32 v235, v198, v199
s_waitcnt lgkmcnt(2)
v_or_b32 v236, v200, v201
v_pk_mul_f16 v237, v243, v242
v_pk_mul_f16 v238, v240, v207
v_pk_mul_f16 v239, v205, v204
v_mfma_f32_16x16x32_f16 v[48:51], v[224:227], v[232:235], v[48:51]
buffer_load_dwordx4 v[12:15], v252, s[4:7], s69 offen
ds_read_b128 v[44:47], v249 offset:38144
v_cvt_pkrtz_f16_f32 v193, v176, v177
v_cvt_pkrtz_f16_f32 v195, v178, v179
v_cvt_pkrtz_f16_f32 v197, v180, v181
v_mfma_f32_16x16x32_f16 v[56:59], v[224:227], v[236:239], v[56:59]
v_cvt_pkrtz_f16_f32 v199, v182, v183
v_cvt_pkrtz_f16_f32 v201, v184, v185
v_cvt_pkrtz_f16_f32 v203, v186, v187
v_mfma_f32_16x16x32_f16 v[52:55], v[228:231], v[232:235], v[52:55]
ds_read_b128 v[224:227], v248 offset:41984
v_cvt_pk_f16_f32 v243, v188, v189
v_cvt_pk_f16_f32 v240, v190, v191
v_pk_fma_f16 v242, v243, v243, s48
s_setprio 1
v_mfma_f32_16x16x32_f16 v[60:63], v[228:231], v[236:239], v[60:63]
v_cvt_pk_bf16_f32 v136, v136, v137
v_and_b32 v193, s49, v193
v_cvt_pk_bf16_f32 v137, v138, v139
v_mfma_f32_16x16x32_bf16 v[176:179], v[0:3], v[96:99], 0
ds_read_b128 v[228:231], v249 offset:38912
v_and_b32 v195, s49, v195
v_cvt_pk_bf16_f32 v138, v140, v141
v_pk_fma_f16 v207, v240, v240, s48
v_mfma_f32_16x16x32_bf16 v[184:187], v[0:3], v[100:103], 0
v_lshrrev_b16 v192, 2, v193
v_cvt_pk_bf16_f32 v139, v142, v143
v_pk_mul_f16 v242, v243, v242
s_waitcnt lgkmcnt(2)
v_mfma_f32_16x16x32_f16 v[64:67], v[4:7], v[232:235], v[64:67]
ds_read_b128 v[0:3], v249 offset:39168
ds_read_u16_d16 v192, v192
v_cvt_pk_bf16_f32 v120, v120, v121
v_lshrrev_b16 v194, 2, v195
v_cvt_pk_bf16_f32 v121, v122, v123
v_mfma_f32_16x16x32_f16 v[72:75], v[4:7], v[236:239], v[72:75]
v_pk_mul_f16 v207, v240, v207
v_lshrrev_b32 v193, 18, v193
v_cvt_pk_bf16_f32 v122, v124, v125
v_mfma_f32_16x16x32_bf16 v[180:183], v[40:43], v[96:99], 0
ds_read_b128 v[4:7], v248 offset:42240
ds_read_u16_d16 v194, v194
ds_read_u16_d16_hi v193, v193
v_exp_f16 v241, v242
v_cvt_pk_bf16_f32 v123, v126, v127
v_mfma_f32_16x16x32_bf16 v[188:191], v[40:43], v[100:103], 0
v_lshrrev_b32 v195, 18, v195
v_cvt_pk_bf16_f32 v152, v152, v153
v_and_b32 v197, s49, v197
v_mfma_f32_16x16x32_f16 v[68:71], v[44:47], v[232:235], v[68:71]
ds_read_b128 v[40:43], v248 offset:43008
ds_read_u16_d16_hi v195, v195
v_cvt_pk_bf16_f32 v153, v154, v155
v_exp_f16 v206, v207
v_mfma_f32_16x16x32_f16 v[76:79], v[44:47], v[236:239], v[76:79]
v_cvt_pk_bf16_f32 v154, v156, v157
v_and_b32 v199, s49, v199
v_cvt_pk_bf16_f32 v155, v158, v159
s_mov_b64 vcc, s[74:75]
s_waitcnt lgkmcnt(5)
v_mfma_f32_16x16x32_bf16 v[176:179], v[224:227], v[104:107], v[176:179]
ds_read_b128 v[44:47], v248 offset:43264
v_lshrrev_b16 v196, 2, v197
v_cndmask_b32_e64 v140, v120, v152, s[74:75]
v_mfma_f32_16x16x32_bf16 v[184:187], v[224:227], v[108:111], v[184:187]
v_exp_f16_sdwa v241, v242 dst_sel:WORD_1 dst_unused:UNUSED_PRESERVE src0_sel:WORD_1
v_cndmask_b32_dpp v120, v136, v120, vcc quad_perm:[1,0,3,2] row_mask:0xf bank_mask:0xf
v_lshrrev_b16 v198, 2, v199
v_mfma_f32_16x16x32_f16 v[80:83], v[228:231], v[232:235], v[80:83]
ds_read_b128 v[224:227], v249 offset:43008
ds_read_u16_d16 v196, v196
ds_read_u16_d16 v198, v198
v_cndmask_b32_e64 v141, v121, v153, s[74:75]
v_lshrrev_b32 v197, 18, v197
v_cndmask_b32_dpp v121, v137, v121, vcc quad_perm:[1,0,3,2] row_mask:0xf bank_mask:0xf
v_mfma_f32_16x16x32_f16 v[168:171], v[228:231], v[236:239], v[168:171]
v_lshrrev_b32 v199, 18, v199
v_exp_f16_sdwa v206, v207 dst_sel:WORD_1 dst_unused:UNUSED_PRESERVE src0_sel:WORD_1
v_mfma_f32_16x16x32_f16 v[84:87], v[0:3], v[232:235], v[84:87]
ds_read_b128 v[228:231], v249 offset:43264
ds_read_u16_d16_hi v197, v197
ds_read_u16_d16_hi v199, v199
v_cndmask_b32_e64 v142, v122, v154, s[74:75]
v_cndmask_b32_dpp v122, v138, v122, vcc quad_perm:[1,0,3,2] row_mask:0xf bank_mask:0xf
v_and_b32 v201, s49, v201
v_mfma_f32_16x16x32_f16 v[172:175], v[0:3], v[236:239], v[172:175]
v_cndmask_b32_e64 v143, v123, v155, s[74:75]
v_and_b32 v203, s49, v203
v_pk_add_f16 v241, v241, 1.0 op_sel_hi:[1,0]
s_waitcnt lgkmcnt(6)
v_mfma_f32_16x16x32_bf16 v[180:183], v[4:7], v[104:107], v[180:183]
ds_read_b128 v[0:3], v248 offset:47104
v_cndmask_b32_dpp v123, v139, v123, vcc quad_perm:[1,0,3,2] row_mask:0xf bank_mask:0xf
s_not_b64 vcc, s[74:75]
v_lshrrev_b16 v200, 2, v201
s_setprio 0
v_cndmask_b32_dpp v152, v136, v152, vcc quad_perm:[1,0,3,2] row_mask:0xf bank_mask:0xf
v_mfma_f32_16x16x32_bf16 v[188:191], v[4:7], v[108:111], v[188:191]
v_pk_add_f16 v206, v206, 1.0 op_sel_hi:[1,0]
v_cndmask_b32_dpp v153, v137, v153, vcc quad_perm:[1,0,3,2] row_mask:0xf bank_mask:0xf
v_lshrrev_b16 v202, 2, v203
v_mfma_f32_16x16x32_bf16 v[176:179], v[40:43], v[112:115], v[176:179]
ds_read_b128 v[4:7], v249 offset:44032
ds_read_u16_d16 v200, v200
ds_read_u16_d16 v202, v202
v_rcp_f16 v242, v241
v_cndmask_b32_dpp v154, v138, v154, vcc quad_perm:[1,0,3,2] row_mask:0xf bank_mask:0xf
v_mfma_f32_16x16x32_bf16 v[184:187], v[40:43], v[116:119], v[184:187]
v_cndmask_b32_dpp v155, v139, v155, vcc quad_perm:[1,0,3,2] row_mask:0xf bank_mask:0xf
v_lshrrev_b32 v201, 18, v201
v_lshrrev_b32 v203, 18, v203
v_mfma_f32_16x16x32_bf16 v[180:183], v[44:47], v[112:115], v[180:183]
ds_read_b128 v[40:43], v248 offset:47360
buffer_store_dwordx4 v[120:123], v255, s[8:11], s68 offen sc1
ds_read_u16_d16_hi v201, v201
ds_read_u16_d16_hi v203, v203
v_rcp_f16 v207, v206
v_mfma_f32_16x16x32_bf16 v[188:191], v[44:47], v[116:119], v[188:191]
v_rcp_f16_sdwa v242, v241 dst_sel:WORD_1 dst_unused:UNUSED_PRESERVE src0_sel:WORD_1
v_or_b32 v232, v192, v193
v_or_b32 v233, v194, v195
s_waitcnt lgkmcnt(6)
v_or_b32 v234, v196, v197
v_rcp_f16_sdwa v207, v206 dst_sel:WORD_1 dst_unused:UNUSED_PRESERVE src0_sel:WORD_1
v_or_b32 v235, v198, v199
s_waitcnt lgkmcnt(1)
v_or_b32 v236, v200, v201
s_waitcnt lgkmcnt(0)
v_or_b32 v237, v202, v203
v_pk_mul_f16 v238, v243, v242
v_pk_mul_f16 v239, v240, v207
s_setprio 3
v_mfma_f32_16x16x32_f16 v[48:51], v[224:227], v[232:235], v[48:51]
buffer_load_dwordx4 v[244:247], v252, s[4:7], s69 offen offset:64
ds_read_b128 v[44:47], v249 offset:44288
v_cvt_pkrtz_f16_f32 v193, v176, v177
v_cvt_pkrtz_f16_f32 v195, v178, v179
v_mfma_f32_16x16x32_f16 v[56:59], v[224:227], v[236:239], v[56:59]
v_cvt_pkrtz_f16_f32 v197, v180, v181
v_cvt_pkrtz_f16_f32 v199, v182, v183
v_mfma_f32_16x16x32_f16 v[52:55], v[228:231], v[232:235], v[52:55]
ds_read_b128 v[224:227], v248 offset:48128
v_cvt_pkrtz_f16_f32 v201, v184, v185
v_cvt_pk_f16_f32 v243, v186, v187
v_mfma_f32_16x16x32_f16 v[60:63], v[228:231], v[236:239], v[60:63]
v_cvt_pk_f16_f32 v240, v188, v189
v_cvt_pk_f16_f32 v205, v190, v191
v_mfma_f32_16x16x32_bf16 v[176:179], v[0:3], v[96:99], 0
ds_read_b128 v[228:231], v249 offset:45056
v_pk_fma_f16 v242, v243, v243, s48
v_and_b32 v193, s49, v193
v_mfma_f32_16x16x32_bf16 v[184:187], v[0:3], v[100:103], 0
v_pk_fma_f16 v207, v240, v240, s48
v_and_b32 v195, s49, v195
v_mfma_f32_16x16x32_f16 v[64:67], v[4:7], v[232:235], v[64:67]
ds_read_b128 v[0:3], v249 offset:45312
v_pk_fma_f16 v204, v205, v205, s48
v_lshrrev_b16 v192, 2, v193
v_pk_mul_f16 v242, v243, v242
v_mfma_f32_16x16x32_f16 v[72:75], v[4:7], v[236:239], v[72:75]
v_lshrrev_b16 v194, 2, v195
v_pk_mul_f16 v207, v240, v207
s_waitcnt vmcnt(7)
v_mfma_f32_16x16x32_bf16 v[128:131], v[26:29], v[8:11], v[128:131]
ds_read_b128 v[4:7], v248 offset:48384
ds_read_u16_d16 v192, v192
ds_read_u16_d16 v194, v194
v_lshrrev_b32 v193, 18, v193
v_pk_mul_f16 v204, v205, v204
v_mfma_f32_16x16x32_bf16 v[132:135], v[24:27], v[8:11], v[132:135]
v_lshrrev_b32 v195, 18, v195
v_mfma_f32_16x16x32_bf16 v[180:183], v[40:43], v[96:99], 0
ds_read_u16_d16_hi v193, v193
ds_read_u16_d16_hi v195, v195
v_exp_f16 v241, v242
v_and_b32 v197, s49, v197
v_mfma_f32_16x16x32_bf16 v[188:191], v[40:43], v[100:103], 0
v_and_b32 v199, s49, v199
s_waitcnt lgkmcnt(6)
v_mfma_f32_16x16x32_f16 v[68:71], v[44:47], v[232:235], v[68:71]
ds_read_b128 v[40:43], v248 offset:49152
v_exp_f16 v206, v207
v_lshrrev_b16 v196, 2, v197
v_mfma_f32_16x16x32_f16 v[76:79], v[44:47], v[236:239], v[76:79]
v_lshrrev_b16 v198, 2, v199
v_exp_f16 v203, v204
v_mfma_f32_16x16x32_bf16 v[176:179], v[224:227], v[104:107], v[176:179]
buffer_store_dwordx4 v[140:143], v255, s[8:11], s68 offen offset:128 sc1
ds_read_b128 v[44:47], v248 offset:49408
ds_read_u16_d16 v196, v196
ds_read_u16_d16 v198, v198
v_lshrrev_b32 v197, 18, v197
v_lshrrev_b32 v199, 18, v199
v_mfma_f32_16x16x32_bf16 v[184:187], v[224:227], v[108:111], v[184:187]
v_exp_f16_sdwa v241, v242 dst_sel:WORD_1 dst_unused:UNUSED_PRESERVE src0_sel:WORD_1
v_mfma_f32_16x16x32_f16 v[80:83], v[228:231], v[232:235], v[80:83]
ds_read_b128 v[224:227], v249 offset:49152
ds_read_u16_d16_hi v197, v197
ds_read_u16_d16_hi v199, v199
v_and_b32 v201, s49, v201
v_lshrrev_b16 v200, 2, v201
v_mfma_f32_16x16x32_f16 v[168:171], v[228:231], v[236:239], v[168:171]
v_exp_f16_sdwa v206, v207 dst_sel:WORD_1 dst_unused:UNUSED_PRESERVE src0_sel:WORD_1
s_waitcnt lgkmcnt(7)
v_mfma_f32_16x16x32_f16 v[84:87], v[0:3], v[232:235], v[84:87]
ds_read_b128 v[228:231], v249 offset:49408
ds_read_u16_d16 v200, v200
v_lshrrev_b32 v201, 18, v201
v_mfma_f32_16x16x32_f16 v[172:175], v[0:3], v[236:239], v[172:175]
v_exp_f16_sdwa v203, v204 dst_sel:WORD_1 dst_unused:UNUSED_PRESERVE src0_sel:WORD_1
v_pk_add_f16 v241, v241, 1.0 op_sel_hi:[1,0]
v_pk_add_f16 v206, v206, 1.0 op_sel_hi:[1,0]
v_mfma_f32_16x16x32_bf16 v[180:183], v[4:7], v[104:107], v[180:183]
ds_read_b128 v[0:3], v248 offset:53248
ds_read_u16_d16_hi v201, v201
v_pk_add_f16 v203, v203, 1.0 op_sel_hi:[1,0]
v_mfma_f32_16x16x32_bf16 v[188:191], v[4:7], v[108:111], v[188:191]
v_rcp_f16 v242, v241
s_waitcnt lgkmcnt(7)
v_mfma_f32_16x16x32_bf16 v[176:179], v[40:43], v[112:115], v[176:179]
ds_read_b128 v[4:7], v249 offset:50176
v_rcp_f16 v207, v206
v_mfma_f32_16x16x32_bf16 v[184:187], v[40:43], v[116:119], v[184:187]
v_rcp_f16 v204, v203
v_mfma_f32_16x16x32_bf16 v[180:183], v[44:47], v[112:115], v[180:183]
ds_read_b128 v[40:43], v248 offset:53504
v_rcp_f16_sdwa v242, v241 dst_sel:WORD_1 dst_unused:UNUSED_PRESERVE src0_sel:WORD_1
v_mfma_f32_16x16x32_bf16 v[188:191], v[44:47], v[116:119], v[188:191]
v_rcp_f16_sdwa v207, v206 dst_sel:WORD_1 dst_unused:UNUSED_PRESERVE src0_sel:WORD_1
v_or_b32 v232, v192, v193
v_or_b32 v233, v194, v195
s_waitcnt lgkmcnt(4)
v_or_b32 v234, v196, v197
v_rcp_f16_sdwa v204, v203 dst_sel:WORD_1 dst_unused:UNUSED_PRESERVE src0_sel:WORD_1
v_or_b32 v235, v198, v199
s_waitcnt lgkmcnt(2)
v_or_b32 v236, v200, v201
v_pk_mul_f16 v237, v243, v242
v_pk_mul_f16 v238, v240, v207
v_pk_mul_f16 v239, v205, v204
v_mfma_f32_16x16x32_f16 v[48:51], v[224:227], v[232:235], v[48:51]
buffer_load_dwordx4 v[8:11], v252, s[4:7], s69 offen offset:128
ds_read_b128 v[44:47], v249 offset:50432
v_cvt_pkrtz_f16_f32 v193, v176, v177
v_cvt_pkrtz_f16_f32 v195, v178, v179
v_mfma_f32_16x16x32_f16 v[56:59], v[224:227], v[236:239], v[56:59]
v_cvt_pkrtz_f16_f32 v197, v180, v181
v_cvt_pkrtz_f16_f32 v199, v182, v183
v_mfma_f32_16x16x32_f16 v[52:55], v[228:231], v[232:235], v[52:55]
ds_read_b128 v[224:227], v248 offset:54272
v_cvt_pkrtz_f16_f32 v201, v184, v185
v_cvt_pk_f16_f32 v243, v186, v187
v_mfma_f32_16x16x32_f16 v[60:63], v[228:231], v[236:239], v[60:63]
v_cvt_pk_f16_f32 v240, v188, v189
v_cvt_pk_f16_f32 v205, v190, v191
v_mfma_f32_16x16x32_bf16 v[176:179], v[0:3], v[96:99], 0
ds_read_b128 v[228:231], v249 offset:51200
v_pk_fma_f16 v242, v243, v243, s48
v_and_b32 v193, s49, v193
v_mfma_f32_16x16x32_bf16 v[184:187], v[0:3], v[100:103], 0
v_pk_fma_f16 v207, v240, v240, s48
v_and_b32 v195, s49, v195
s_waitcnt lgkmcnt(3)
v_mfma_f32_16x16x32_f16 v[64:67], v[4:7], v[232:235], v[64:67]
ds_read_b128 v[0:3], v249 offset:51456
v_pk_fma_f16 v204, v205, v205, s48
s_setprio 2
v_lshrrev_b16 v192, 2, v193
v_pk_mul_f16 v242, v243, v242
v_mfma_f32_16x16x32_f16 v[72:75], v[4:7], v[236:239], v[72:75]
v_lshrrev_b16 v194, 2, v195
v_pk_mul_f16 v207, v240, v207
s_waitcnt vmcnt(7)
v_mfma_f32_16x16x32_bf16 v[144:147], v[26:29], v[36:39], v[144:147]
ds_read_b128 v[4:7], v248 offset:54528
ds_read_u16_d16 v192, v192
ds_read_u16_d16 v194, v194
v_lshrrev_b32 v193, 18, v193
v_pk_mul_f16 v204, v205, v204
v_mfma_f32_16x16x32_bf16 v[148:151], v[24:27], v[36:39], v[148:151]
v_lshrrev_b32 v195, 18, v195
v_mfma_f32_16x16x32_bf16 v[180:183], v[40:43], v[96:99], 0
ds_read_u16_d16_hi v193, v193
ds_read_u16_d16_hi v195, v195
v_exp_f16 v241, v242
v_and_b32 v197, s49, v197
v_mfma_f32_16x16x32_bf16 v[188:191], v[40:43], v[100:103], 0
v_and_b32 v199, s49, v199
s_waitcnt lgkmcnt(6)
v_mfma_f32_16x16x32_f16 v[68:71], v[44:47], v[232:235], v[68:71]
ds_read_b128 v[40:43], v248 offset:55296
v_exp_f16 v206, v207
v_lshrrev_b16 v196, 2, v197
v_mfma_f32_16x16x32_f16 v[76:79], v[44:47], v[236:239], v[76:79]
v_lshrrev_b16 v198, 2, v199
v_exp_f16 v203, v204
v_mfma_f32_16x16x32_bf16 v[176:179], v[224:227], v[104:107], v[176:179]
ds_read_b128 v[44:47], v248 offset:55552
ds_read_u16_d16 v196, v196
ds_read_u16_d16 v198, v198
v_lshrrev_b32 v197, 18, v197
v_lshrrev_b32 v199, 18, v199
v_mfma_f32_16x16x32_bf16 v[184:187], v[224:227], v[108:111], v[184:187]
v_exp_f16_sdwa v241, v242 dst_sel:WORD_1 dst_unused:UNUSED_PRESERVE src0_sel:WORD_1
v_mfma_f32_16x16x32_f16 v[80:83], v[228:231], v[232:235], v[80:83]
ds_read_b128 v[224:227], v249 offset:55296
ds_read_u16_d16_hi v197, v197
ds_read_u16_d16_hi v199, v199
v_and_b32 v201, s49, v201
v_lshrrev_b16 v200, 2, v201
v_mfma_f32_16x16x32_f16 v[168:171], v[228:231], v[236:239], v[168:171]
v_exp_f16_sdwa v206, v207 dst_sel:WORD_1 dst_unused:UNUSED_PRESERVE src0_sel:WORD_1
s_waitcnt lgkmcnt(7)
v_mfma_f32_16x16x32_f16 v[84:87], v[0:3], v[232:235], v[84:87]
ds_read_b128 v[228:231], v249 offset:55552
ds_read_u16_d16 v200, v200
v_lshrrev_b32 v201, 18, v201
v_mfma_f32_16x16x32_f16 v[172:175], v[0:3], v[236:239], v[172:175]
v_exp_f16_sdwa v203, v204 dst_sel:WORD_1 dst_unused:UNUSED_PRESERVE src0_sel:WORD_1
v_pk_add_f16 v241, v241, 1.0 op_sel_hi:[1,0]
v_pk_add_f16 v206, v206, 1.0 op_sel_hi:[1,0]
v_mfma_f32_16x16x32_bf16 v[180:183], v[4:7], v[104:107], v[180:183]
ds_read_b128 v[0:3], v248 offset:59392
ds_read_u16_d16_hi v201, v201
v_pk_add_f16 v203, v203, 1.0 op_sel_hi:[1,0]
v_mfma_f32_16x16x32_bf16 v[188:191], v[4:7], v[108:111], v[188:191]
v_rcp_f16 v242, v241
s_waitcnt lgkmcnt(7)
v_mfma_f32_16x16x32_bf16 v[176:179], v[40:43], v[112:115], v[176:179]
ds_read_b128 v[4:7], v249 offset:56320
v_rcp_f16 v207, v206
v_mfma_f32_16x16x32_bf16 v[184:187], v[40:43], v[116:119], v[184:187]
v_rcp_f16 v204, v203
v_mfma_f32_16x16x32_bf16 v[180:183], v[44:47], v[112:115], v[180:183]
ds_read_b128 v[40:43], v248 offset:59648
v_rcp_f16_sdwa v242, v241 dst_sel:WORD_1 dst_unused:UNUSED_PRESERVE src0_sel:WORD_1
v_mfma_f32_16x16x32_bf16 v[188:191], v[44:47], v[116:119], v[188:191]
v_rcp_f16_sdwa v207, v206 dst_sel:WORD_1 dst_unused:UNUSED_PRESERVE src0_sel:WORD_1
v_or_b32 v232, v192, v193
v_or_b32 v233, v194, v195
s_waitcnt lgkmcnt(4)
v_or_b32 v234, v196, v197
v_rcp_f16_sdwa v204, v203 dst_sel:WORD_1 dst_unused:UNUSED_PRESERVE src0_sel:WORD_1
v_or_b32 v235, v198, v199
s_waitcnt lgkmcnt(2)
v_or_b32 v236, v200, v201
v_pk_mul_f16 v237, v243, v242
v_pk_mul_f16 v238, v240, v207
v_pk_mul_f16 v239, v205, v204
v_mfma_f32_16x16x32_f16 v[48:51], v[224:227], v[232:235], v[48:51]
s_add_u32 s46, s69, 98304
buffer_load_dwordx4 v[36:39], v252, s[4:7], s46 offen
ds_read_b128 v[44:47], v249 offset:56576
v_cvt_pkrtz_f16_f32 v193, v176, v177
v_cvt_pkrtz_f16_f32 v195, v178, v179
v_mfma_f32_16x16x32_f16 v[56:59], v[224:227], v[236:239], v[56:59]
v_cvt_pkrtz_f16_f32 v197, v180, v181
v_cvt_pkrtz_f16_f32 v199, v182, v183
v_mfma_f32_16x16x32_f16 v[52:55], v[228:231], v[232:235], v[52:55]
ds_read_b128 v[224:227], v248 offset:60416
v_cvt_pkrtz_f16_f32 v201, v184, v185
v_cvt_pk_f16_f32 v243, v186, v187
v_cvt_pk_f16_f32 v240, v188, v189
v_mfma_f32_16x16x32_f16 v[60:63], v[228:231], v[236:239], v[60:63]
v_cvt_pk_f16_f32 v205, v190, v191
s_setprio 1
v_pk_fma_f16 v242, v243, v243, s48
v_mfma_f32_16x16x32_bf16 v[176:179], v[0:3], v[96:99], 0
ds_read_b128 v[228:231], v249 offset:57344
v_and_b32 v193, s49, v193
v_pk_fma_f16 v207, v240, v240, s48
v_mfma_f32_16x16x32_bf16 v[184:187], v[0:3], v[100:103], 0
v_and_b32 v195, s49, v195
v_pk_fma_f16 v204, v205, v205, s48
v_lshrrev_b16 v192, 2, v193
s_waitcnt lgkmcnt(3)
v_mfma_f32_16x16x32_f16 v[64:67], v[4:7], v[232:235], v[64:67]
ds_read_b128 v[0:3], v249 offset:57600
ds_read_u16_d16 v192, v192
v_pk_mul_f16 v242, v243, v242
v_lshrrev_b16 v194, 2, v195
v_mfma_f32_16x16x32_f16 v[72:75], v[4:7], v[236:239], v[72:75]
v_pk_mul_f16 v207, v240, v207
v_lshrrev_b32 v193, 18, v193
v_mfma_f32_16x16x32_bf16 v[180:183], v[40:43], v[96:99], 0
ds_read_b128 v[4:7], v248 offset:60672
ds_read_u16_d16 v194, v194
ds_read_u16_d16_hi v193, v193
v_pk_mul_f16 v204, v205, v204
v_lshrrev_b32 v195, 18, v195
v_mfma_f32_16x16x32_bf16 v[188:191], v[40:43], v[100:103], 0
v_exp_f16 v241, v242
v_and_b32 v197, s49, v197
s_waitcnt lgkmcnt(5)
v_mfma_f32_16x16x32_f16 v[68:71], v[44:47], v[232:235], v[68:71]
ds_read_b128 v[40:43], v248 offset:61440
ds_read_u16_d16_hi v195, v195
v_and_b32 v199, s49, v199
v_mfma_f32_16x16x32_f16 v[76:79], v[44:47], v[236:239], v[76:79]
v_exp_f16 v206, v207
v_lshrrev_b16 v196, 2, v197
v_lshrrev_b16 v198, 2, v199
v_mfma_f32_16x16x32_bf16 v[176:179], v[224:227], v[104:107], v[176:179]
buffer_store_dwordx4 v[152:155], v255, s[8:11], s68 offen offset:256 sc1
ds_read_b128 v[44:47], v248 offset:61696
ds_read_u16_d16 v196, v196
ds_read_u16_d16 v198, v198
v_exp_f16 v203, v204
v_mfma_f32_16x16x32_bf16 v[184:187], v[224:227], v[108:111], v[184:187]
v_lshrrev_b32 v197, 18, v197
v_lshrrev_b32 v199, 18, v199
v_mfma_f32_16x16x32_f16 v[80:83], v[228:231], v[232:235], v[80:83]
ds_read_b128 v[224:227], v249 offset:61440
ds_read_u16_d16_hi v197, v197
ds_read_u16_d16_hi v199, v199
v_exp_f16_sdwa v241, v242 dst_sel:WORD_1 dst_unused:UNUSED_PRESERVE src0_sel:WORD_1
v_and_b32 v201, s49, v201
v_mfma_f32_16x16x32_f16 v[168:171], v[228:231], v[236:239], v[168:171]
v_lshrrev_b16 v200, 2, v201
s_waitcnt lgkmcnt(8)
v_mfma_f32_16x16x32_f16 v[84:87], v[0:3], v[232:235], v[84:87]
ds_read_b128 v[228:231], v249 offset:61696
ds_read_u16_d16 v200, v200
v_exp_f16_sdwa v206, v207 dst_sel:WORD_1 dst_unused:UNUSED_PRESERVE src0_sel:WORD_1
v_lshrrev_b32 v201, 18, v201
v_mfma_f32_16x16x32_f16 v[172:175], v[0:3], v[236:239], v[172:175]
v_exp_f16_sdwa v203, v204 dst_sel:WORD_1 dst_unused:UNUSED_PRESERVE src0_sel:WORD_1
v_pk_add_f16 v241, v241, 1.0 op_sel_hi:[1,0]
v_mfma_f32_16x16x32_bf16 v[180:183], v[4:7], v[104:107], v[180:183]
ds_read_b128 v[0:3], v249
ds_read_u16_d16_hi v201, v201
v_pk_add_f16 v206, v206, 1.0 op_sel_hi:[1,0]
v_pk_add_f16 v203, v203, 1.0 op_sel_hi:[1,0]
v_mfma_f32_16x16x32_bf16 v[188:191], v[4:7], v[108:111], v[188:191]
v_rcp_f16 v242, v241
s_setprio 0
s_waitcnt lgkmcnt(7)
v_mfma_f32_16x16x32_bf16 v[176:179], v[40:43], v[112:115], v[176:179]
ds_read_b128 v[4:7], v249 offset:62464
v_rcp_f16 v207, v206
v_mfma_f32_16x16x32_bf16 v[184:187], v[40:43], v[116:119], v[184:187]
v_rcp_f16 v204, v203
v_mfma_f32_16x16x32_bf16 v[180:183], v[44:47], v[112:115], v[180:183]
ds_read_b128 v[40:43], v249 offset:256
v_rcp_f16_sdwa v242, v241 dst_sel:WORD_1 dst_unused:UNUSED_PRESERVE src0_sel:WORD_1
v_mfma_f32_16x16x32_bf16 v[188:191], v[44:47], v[116:119], v[188:191]
v_rcp_f16_sdwa v207, v206 dst_sel:WORD_1 dst_unused:UNUSED_PRESERVE src0_sel:WORD_1
v_or_b32 v232, v192, v193
v_or_b32 v233, v194, v195
s_waitcnt lgkmcnt(4)
v_or_b32 v234, v196, v197
v_rcp_f16_sdwa v204, v203 dst_sel:WORD_1 dst_unused:UNUSED_PRESERVE src0_sel:WORD_1
v_or_b32 v235, v198, v199
s_waitcnt lgkmcnt(2)
v_or_b32 v236, v200, v201
v_pk_mul_f16 v237, v243, v242
v_pk_mul_f16 v238, v240, v207
v_pk_mul_f16 v239, v205, v204
v_mfma_f32_16x16x32_f16 v[48:51], v[224:227], v[232:235], v[48:51]
s_add_u32 s46, s69, 98304
buffer_load_dwordx4 v[32:35], v252, s[4:7], s46 offen offset:64
ds_read_b128 v[44:47], v249 offset:62720
v_cvt_pkrtz_f16_f32 v193, v176, v177
v_cvt_pkrtz_f16_f32 v195, v178, v179
v_mfma_f32_16x16x32_f16 v[56:59], v[224:227], v[236:239], v[56:59]
v_cvt_pkrtz_f16_f32 v197, v180, v181
v_cvt_pkrtz_f16_f32 v199, v182, v183
v_mfma_f32_16x16x32_f16 v[52:55], v[228:231], v[232:235], v[52:55]
ds_read_b128 v[224:227], v249 offset:1024
v_cvt_pkrtz_f16_f32 v201, v184, v185
v_cvt_pk_f16_f32 v243, v186, v187
v_mfma_f32_16x16x32_f16 v[60:63], v[228:231], v[236:239], v[60:63]
v_cvt_pk_f16_f32 v240, v188, v189
v_cvt_pk_f16_f32 v205, v190, v191
v_mfma_f32_16x16x32_bf16 v[176:179], v[0:3], v[96:99], 0
ds_read_b128 v[228:231], v249 offset:63488
v_pk_fma_f16 v242, v243, v243, s48
v_and_b32 v193, s49, v193
v_mfma_f32_16x16x32_bf16 v[184:187], v[0:3], v[100:103], 0
v_pk_fma_f16 v207, v240, v240, s48
v_and_b32 v195, s49, v195
s_waitcnt lgkmcnt(3)
v_mfma_f32_16x16x32_f16 v[64:67], v[4:7], v[232:235], v[64:67]
ds_read_b128 v[0:3], v249 offset:63744
v_pk_fma_f16 v204, v205, v205, s48
v_lshrrev_b16 v192, 2, v193
v_mfma_f32_16x16x32_f16 v[72:75], v[4:7], v[236:239], v[72:75]
v_pk_mul_f16 v242, v243, v242
v_lshrrev_b16 v194, 2, v195
s_waitcnt vmcnt(8)
v_mfma_f32_16x16x32_bf16 v[160:163], v[26:29], v[216:219], v[160:163]
ds_read_b128 v[4:7], v249 offset:1280
ds_read_u16_d16 v192, v192
ds_read_u16_d16 v194, v194
v_pk_mul_f16 v207, v240, v207
v_lshrrev_b32 v193, 18, v193
v_mfma_f32_16x16x32_bf16 v[164:167], v[24:27], v[216:219], v[164:167]
v_pk_mul_f16 v204, v205, v204
v_lshrrev_b32 v195, 18, v195
v_mfma_f32_16x16x32_bf16 v[180:183], v[40:43], v[96:99], 0
ds_read_u16_d16_hi v193, v193
ds_read_u16_d16_hi v195, v195
v_exp_f16 v241, v242
v_mfma_f32_16x16x32_bf16 v[188:191], v[40:43], v[100:103], 0
v_and_b32 v197, s49, v197
v_and_b32 v199, s49, v199
s_waitcnt lgkmcnt(6)
v_mfma_f32_16x16x32_f16 v[68:71], v[44:47], v[232:235], v[68:71]
ds_read_b128 v[40:43], v249 offset:2048
v_exp_f16 v206, v207
v_mfma_f32_16x16x32_f16 v[76:79], v[44:47], v[236:239], v[76:79]
v_lshrrev_b16 v196, 2, v197
v_lshrrev_b16 v198, 2, v199
v_mfma_f32_16x16x32_bf16 v[176:179], v[224:227], v[104:107], v[176:179]
ds_read_b128 v[44:47], v249 offset:2304
ds_read_u16_d16 v196, v196
ds_read_u16_d16 v198, v198
v_exp_f16 v203, v204
v_mfma_f32_16x16x32_bf16 v[184:187], v[224:227], v[108:111], v[184:187]
v_lshrrev_b32 v197, 18, v197
v_lshrrev_b32 v199, 18, v199
v_mfma_f32_16x16x32_f16 v[80:83], v[228:231], v[232:235], v[80:83]
ds_read_b128 v[224:227], v250 offset:2048
ds_read_u16_d16_hi v197, v197
ds_read_u16_d16_hi v199, v199
v_exp_f16_sdwa v241, v242 dst_sel:WORD_1 dst_unused:UNUSED_PRESERVE src0_sel:WORD_1
v_mfma_f32_16x16x32_f16 v[168:171], v[228:231], v[236:239], v[168:171]
v_and_b32 v201, s49, v201
v_lshrrev_b16 v200, 2, v201
s_waitcnt lgkmcnt(7)
v_mfma_f32_16x16x32_f16 v[84:87], v[0:3], v[232:235], v[84:87]
ds_read_b128 v[228:231], v250 offset:2304
ds_read_u16_d16 v200, v200
v_exp_f16_sdwa v206, v207 dst_sel:WORD_1 dst_unused:UNUSED_PRESERVE src0_sel:WORD_1
v_mfma_f32_16x16x32_f16 v[172:175], v[0:3], v[236:239], v[172:175]
v_lshrrev_b32 v201, 18, v201
s_waitcnt vmcnt(7)
v_mfma_f32_16x16x32_bf16 v[48:51], v[26:29], v[12:15], v[48:51]
ds_read_b128 v[0:3], v249 offset:6144
ds_read_u16_d16_hi v201, v201
v_exp_f16_sdwa v203, v204 dst_sel:WORD_1 dst_unused:UNUSED_PRESERVE src0_sel:WORD_1
v_pk_add_f16 v241, v241, 1.0 op_sel_hi:[1,0]
v_mfma_f32_16x16x32_bf16 v[52:55], v[24:27], v[12:15], v[52:55]
v_pk_add_f16 v206, v206, 1.0 op_sel_hi:[1,0]
v_pk_add_f16 v203, v203, 1.0 op_sel_hi:[1,0]
v_mfma_f32_16x16x32_bf16 v[180:183], v[4:7], v[104:107], v[180:183]
v_rcp_f16 v242, v241
v_mfma_f32_16x16x32_bf16 v[188:191], v[4:7], v[108:111], v[188:191]
v_rcp_f16 v207, v206
s_waitcnt lgkmcnt(4)
v_mfma_f32_16x16x32_bf16 v[176:179], v[40:43], v[112:115], v[176:179]
ds_read_b128 v[4:7], v250 offset:3072
v_rcp_f16 v204, v203
v_mfma_f32_16x16x32_bf16 v[184:187], v[40:43], v[116:119], v[184:187]
v_rcp_f16_sdwa v242, v241 dst_sel:WORD_1 dst_unused:UNUSED_PRESERVE src0_sel:WORD_1
v_mfma_f32_16x16x32_bf16 v[180:183], v[44:47], v[112:115], v[180:183]
ds_read_b128 v[40:43], v249 offset:6400
v_rcp_f16_sdwa v207, v206 dst_sel:WORD_1 dst_unused:UNUSED_PRESERVE src0_sel:WORD_1
v_mfma_f32_16x16x32_bf16 v[188:191], v[44:47], v[116:119], v[188:191]
v_or_b32 v232, v192, v193
v_or_b32 v233, v194, v195
v_or_b32 v234, v196, v197
v_rcp_f16_sdwa v204, v203 dst_sel:WORD_1 dst_unused:UNUSED_PRESERVE src0_sel:WORD_1
v_or_b32 v235, v198, v199
s_waitcnt lgkmcnt(2)
v_or_b32 v236, v200, v201
v_pk_mul_f16 v237, v243, v242
v_pk_mul_f16 v238, v240, v207
v_pk_mul_f16 v239, v205, v204
v_mfma_f32_16x16x32_f16 v[48:51], v[224:227], v[232:235], v[48:51]
s_add_u32 s46, s69, 98304
buffer_load_dwordx4 v[216:219], v252, s[4:7], s46 offen offset:128
ds_read_b128 v[44:47], v250 offset:3328
v_cvt_pkrtz_f16_f32 v193, v176, v177
v_cvt_pkrtz_f16_f32 v195, v178, v179
v_mfma_f32_16x16x32_f16 v[56:59], v[224:227], v[236:239], v[56:59]
v_cvt_pkrtz_f16_f32 v197, v180, v181
v_cvt_pkrtz_f16_f32 v199, v182, v183
v_cvt_pkrtz_f16_f32 v201, v184, v185
v_mfma_f32_16x16x32_f16 v[52:55], v[228:231], v[232:235], v[52:55]
ds_read_b128 v[224:227], v249 offset:7168
v_cvt_pkrtz_f16_f32 v203, v186, v187
v_cvt_pk_f16_f32 v243, v188, v189
v_cvt_pk_f16_f32 v240, v190, v191
v_mfma_f32_16x16x32_f16 v[60:63], v[228:231], v[236:239], v[60:63]
v_pk_fma_f16 v242, v243, v243, s48
v_cvt_pk_bf16_f32 v144, v144, v145
v_and_b32 v193, s49, v193
v_mfma_f32_16x16x32_bf16 v[176:179], v[0:3], v[96:99], 0
ds_read_b128 v[228:231], v250 offset:4096
v_cvt_pk_bf16_f32 v145, v146, v147
v_and_b32 v195, s49, v195
v_mfma_f32_16x16x32_bf16 v[184:187], v[0:3], v[100:103], 0
v_cvt_pk_bf16_f32 v146, v148, v149
v_pk_fma_f16 v207, v240, v240, s48
v_lshrrev_b16 v192, 2, v193
s_waitcnt lgkmcnt(3)
v_mfma_f32_16x16x32_f16 v[64:67], v[4:7], v[232:235], v[64:67]
ds_read_b128 v[0:3], v250 offset:4352
ds_read_u16_d16 v192, v192
v_cvt_pk_bf16_f32 v147, v150, v151
v_pk_mul_f16 v242, v243, v242
v_cvt_pk_bf16_f32 v128, v128, v129
v_mfma_f32_16x16x32_f16 v[72:75], v[4:7], v[236:239], v[72:75]
v_lshrrev_b16 v194, 2, v195
v_cvt_pk_bf16_f32 v129, v130, v131
v_pk_mul_f16 v207, v240, v207
s_waitcnt vmcnt(6)
v_mfma_f32_16x16x32_bf16 v[64:67], v[26:29], v[244:247], v[64:67]
ds_read_b128 v[4:7], v249 offset:7424
ds_read_u16_d16 v194, v194
v_lshrrev_b32 v193, 18, v193
v_cvt_pk_bf16_f32 v130, v132, v133
v_mfma_f32_16x16x32_bf16 v[68:71], v[24:27], v[244:247], v[68:71]
v_exp_f16 v241, v242
v_cvt_pk_bf16_f32 v131, v134, v135
v_mfma_f32_16x16x32_bf16 v[180:183], v[40:43], v[96:99], 0
ds_read_u16_d16_hi v193, v193
v_lshrrev_b32 v195, 18, v195
v_cvt_pk_bf16_f32 v160, v160, v161
v_and_b32 v197, s49, v197
v_mfma_f32_16x16x32_bf16 v[188:191], v[40:43], v[100:103], 0
v_cvt_pk_bf16_f32 v161, v162, v163
v_exp_f16 v206, v207
s_waitcnt lgkmcnt(3)
v_mfma_f32_16x16x32_f16 v[68:71], v[44:47], v[232:235], v[68:71]
ds_read_b128 v[40:43], v249 offset:8192
ds_read_u16_d16_hi v195, v195
v_cvt_pk_bf16_f32 v162, v164, v165
v_and_b32 v199, s49, v199
v_mfma_f32_16x16x32_f16 v[76:79], v[44:47], v[236:239], v[76:79]
v_cvt_pk_bf16_f32 v163, v166, v167
s_mov_b64 vcc, s[74:75]
v_lshrrev_b16 v196, 2, v197
v_cndmask_b32_e64 v148, v128, v160, s[74:75]
v_mfma_f32_16x16x32_bf16 v[176:179], v[224:227], v[104:107], v[176:179]
ds_read_b128 v[44:47], v249 offset:8448
ds_read_u16_d16 v196, v196
v_exp_f16_sdwa v241, v242 dst_sel:WORD_1 dst_unused:UNUSED_PRESERVE src0_sel:WORD_1
v_cndmask_b32_dpp v128, v144, v128, vcc quad_perm:[1,0,3,2] row_mask:0xf bank_mask:0xf
v_mfma_f32_16x16x32_bf16 v[184:187], v[224:227], v[108:111], v[184:187]
v_lshrrev_b16 v198, 2, v199
v_cndmask_b32_e64 v149, v129, v161, s[74:75]
v_lshrrev_b32 v197, 18, v197
v_mfma_f32_16x16x32_f16 v[80:83], v[228:231], v[232:235], v[80:83]
ds_read_b128 v[224:227], v250 offset:8192
ds_read_u16_d16 v198, v198
ds_read_u16_d16_hi v197, v197
v_cndmask_b32_dpp v129, v145, v129, vcc quad_perm:[1,0,3,2] row_mask:0xf bank_mask:0xf
v_lshrrev_b32 v199, 18, v199
v_mfma_f32_16x16x32_f16 v[168:171], v[228:231], v[236:239], v[168:171]
v_exp_f16_sdwa v206, v207 dst_sel:WORD_1 dst_unused:UNUSED_PRESERVE src0_sel:WORD_1
v_cndmask_b32_e64 v150, v130, v162, s[74:75]
v_mfma_f32_16x16x32_f16 v[84:87], v[0:3], v[232:235], v[84:87]
ds_read_b128 v[228:231], v250 offset:8448
ds_read_u16_d16_hi v199, v199
v_cndmask_b32_dpp v130, v146, v130, vcc quad_perm:[1,0,3,2] row_mask:0xf bank_mask:0xf
v_and_b32 v201, s49, v201
v_cndmask_b32_e64 v151, v131, v163, s[74:75]
v_mfma_f32_16x16x32_f16 v[172:175], v[0:3], v[236:239], v[172:175]
v_and_b32 v203, s49, v203
v_pk_add_f16 v241, v241, 1.0 op_sel_hi:[1,0]
v_cndmask_b32_dpp v131, v147, v131, vcc quad_perm:[1,0,3,2] row_mask:0xf bank_mask:0xf
s_not_b64 vcc, s[74:75]
s_waitcnt lgkmcnt(5)
v_mfma_f32_16x16x32_bf16 v[180:183], v[4:7], v[104:107], v[180:183]
ds_read_b128 v[0:3], v249 offset:12288
v_lshrrev_b16 v200, 2, v201
v_cndmask_b32_dpp v160, v144, v160, vcc quad_perm:[1,0,3,2] row_mask:0xf bank_mask:0xf
v_pk_add_f16 v206, v206, 1.0 op_sel_hi:[1,0]
v_mfma_f32_16x16x32_bf16 v[188:191], v[4:7], v[108:111], v[188:191]
v_cndmask_b32_dpp v161, v145, v161, vcc quad_perm:[1,0,3,2] row_mask:0xf bank_mask:0xf
v_lshrrev_b16 v202, 2, v203
v_mfma_f32_16x16x32_bf16 v[176:179], v[40:43], v[112:115], v[176:179]
ds_read_b128 v[4:7], v250 offset:9216
ds_read_u16_d16 v200, v200
ds_read_u16_d16 v202, v202
v_rcp_f16 v242, v241
v_cndmask_b32_dpp v162, v146, v162, vcc quad_perm:[1,0,3,2] row_mask:0xf bank_mask:0xf
v_mfma_f32_16x16x32_bf16 v[184:187], v[40:43], v[116:119], v[184:187]
v_cndmask_b32_dpp v163, v147, v163, vcc quad_perm:[1,0,3,2] row_mask:0xf bank_mask:0xf
v_lshrrev_b32 v201, 18, v201
v_lshrrev_b32 v203, 18, v203
v_mfma_f32_16x16x32_bf16 v[180:183], v[44:47], v[112:115], v[180:183]
ds_read_b128 v[40:43], v249 offset:12544
s_add_u32 s46, s68, 98304
buffer_store_dwordx4 v[128:131], v255, s[8:11], s46 offen sc1
ds_read_u16_d16_hi v201, v201
ds_read_u16_d16_hi v203, v203
v_rcp_f16 v207, v206
v_mfma_f32_16x16x32_bf16 v[188:191], v[44:47], v[116:119], v[188:191]
v_rcp_f16_sdwa v242, v241 dst_sel:WORD_1 dst_unused:UNUSED_PRESERVE src0_sel:WORD_1
v_or_b32 v232, v192, v193
v_or_b32 v233, v194, v195
s_waitcnt lgkmcnt(6)
v_or_b32 v234, v196, v197
v_rcp_f16_sdwa v207, v206 dst_sel:WORD_1 dst_unused:UNUSED_PRESERVE src0_sel:WORD_1
v_or_b32 v235, v198, v199
s_waitcnt lgkmcnt(1)
v_or_b32 v236, v200, v201
s_waitcnt lgkmcnt(0)
v_or_b32 v237, v202, v203
v_pk_mul_f16 v238, v243, v242
v_pk_mul_f16 v239, v240, v207
v_mfma_f32_16x16x32_f16 v[48:51], v[224:227], v[232:235], v[48:51]
s_add_u32 s46, s68, 98304
buffer_store_dwordx4 v[148:151], v255, s[8:11], s46 offen offset:128 sc1
ds_read_b128 v[44:47], v250 offset:9472
v_cvt_pkrtz_f16_f32 v193, v176, v177
v_cvt_pkrtz_f16_f32 v195, v178, v179
v_mfma_f32_16x16x32_f16 v[56:59], v[224:227], v[236:239], v[56:59]
v_cvt_pkrtz_f16_f32 v197, v180, v181
v_cvt_pkrtz_f16_f32 v199, v182, v183
v_mfma_f32_16x16x32_f16 v[52:55], v[228:231], v[232:235], v[52:55]
ds_read_b128 v[224:227], v249 offset:13312
v_cvt_pkrtz_f16_f32 v201, v184, v185
v_cvt_pk_f16_f32 v243, v186, v187
v_mfma_f32_16x16x32_f16 v[60:63], v[228:231], v[236:239], v[60:63]
v_cvt_pk_f16_f32 v240, v188, v189
v_cvt_pk_f16_f32 v205, v190, v191
v_mfma_f32_16x16x32_bf16 v[176:179], v[0:3], v[96:99], 0
ds_read_b128 v[228:231], v250 offset:10240
v_pk_fma_f16 v242, v243, v243, s48
v_and_b32 v193, s49, v193
v_mfma_f32_16x16x32_bf16 v[184:187], v[0:3], v[100:103], 0
v_pk_fma_f16 v207, v240, v240, s48
v_and_b32 v195, s49, v195
v_mfma_f32_16x16x32_f16 v[64:67], v[4:7], v[232:235], v[64:67]
ds_read_b128 v[0:3], v250 offset:10496
v_pk_fma_f16 v204, v205, v205, s48
v_lshrrev_b16 v192, 2, v193
v_pk_mul_f16 v242, v243, v242
v_mfma_f32_16x16x32_f16 v[72:75], v[4:7], v[236:239], v[72:75]
v_lshrrev_b16 v194, 2, v195
v_pk_mul_f16 v207, v240, v207
s_waitcnt vmcnt(6)
v_mfma_f32_16x16x32_bf16 v[80:83], v[26:29], v[8:11], v[80:83]
ds_read_b128 v[4:7], v249 offset:13568
ds_read_u16_d16 v192, v192
ds_read_u16_d16 v194, v194
v_lshrrev_b32 v193, 18, v193
v_pk_mul_f16 v204, v205, v204
v_mfma_f32_16x16x32_bf16 v[84:87], v[24:27], v[8:11], v[84:87]
v_lshrrev_b32 v195, 18, v195
v_mfma_f32_16x16x32_bf16 v[180:183], v[40:43], v[96:99], 0
ds_read_u16_d16_hi v193, v193
ds_read_u16_d16_hi v195, v195
v_exp_f16 v241, v242
v_and_b32 v197, s49, v197
v_mfma_f32_16x16x32_bf16 v[188:191], v[40:43], v[100:103], 0
v_and_b32 v199, s49, v199
s_waitcnt lgkmcnt(6)
v_mfma_f32_16x16x32_f16 v[68:71], v[44:47], v[232:235], v[68:71]
ds_read_b128 v[40:43], v249 offset:14336
v_exp_f16 v206, v207
v_lshrrev_b16 v196, 2, v197
v_mfma_f32_16x16x32_f16 v[76:79], v[44:47], v[236:239], v[76:79]
v_lshrrev_b16 v198, 2, v199
v_exp_f16 v203, v204
v_mfma_f32_16x16x32_bf16 v[176:179], v[224:227], v[104:107], v[176:179]
ds_read_b128 v[44:47], v249 offset:14592
ds_read_u16_d16 v196, v196
ds_read_u16_d16 v198, v198
v_lshrrev_b32 v197, 18, v197
v_lshrrev_b32 v199, 18, v199
v_mfma_f32_16x16x32_bf16 v[184:187], v[224:227], v[108:111], v[184:187]
v_exp_f16_sdwa v241, v242 dst_sel:WORD_1 dst_unused:UNUSED_PRESERVE src0_sel:WORD_1
v_mfma_f32_16x16x32_f16 v[80:83], v[228:231], v[232:235], v[80:83]
ds_read_b128 v[224:227], v250 offset:14336
ds_read_u16_d16_hi v197, v197
ds_read_u16_d16_hi v199, v199
v_and_b32 v201, s49, v201
v_lshrrev_b16 v200, 2, v201
v_mfma_f32_16x16x32_f16 v[168:171], v[228:231], v[236:239], v[168:171]
v_exp_f16_sdwa v206, v207 dst_sel:WORD_1 dst_unused:UNUSED_PRESERVE src0_sel:WORD_1
s_waitcnt lgkmcnt(7)
v_mfma_f32_16x16x32_f16 v[84:87], v[0:3], v[232:235], v[84:87]
ds_read_b128 v[228:231], v250 offset:14592
ds_read_u16_d16 v200, v200
v_lshrrev_b32 v201, 18, v201
v_mfma_f32_16x16x32_f16 v[172:175], v[0:3], v[236:239], v[172:175]
v_exp_f16_sdwa v203, v204 dst_sel:WORD_1 dst_unused:UNUSED_PRESERVE src0_sel:WORD_1
v_pk_add_f16 v241, v241, 1.0 op_sel_hi:[1,0]
v_pk_add_f16 v206, v206, 1.0 op_sel_hi:[1,0]
v_mfma_f32_16x16x32_bf16 v[180:183], v[4:7], v[104:107], v[180:183]
ds_read_b128 v[0:3], v249 offset:18432
ds_read_u16_d16_hi v201, v201
v_pk_add_f16 v203, v203, 1.0 op_sel_hi:[1,0]
v_mfma_f32_16x16x32_bf16 v[188:191], v[4:7], v[108:111], v[188:191]
v_rcp_f16 v242, v241
s_waitcnt lgkmcnt(7)
v_mfma_f32_16x16x32_bf16 v[176:179], v[40:43], v[112:115], v[176:179]
ds_read_b128 v[4:7], v250 offset:15360
v_rcp_f16 v207, v206
v_mfma_f32_16x16x32_bf16 v[184:187], v[40:43], v[116:119], v[184:187]
v_rcp_f16 v204, v203
v_mfma_f32_16x16x32_bf16 v[180:183], v[44:47], v[112:115], v[180:183]
ds_read_b128 v[40:43], v249 offset:18688
v_rcp_f16_sdwa v242, v241 dst_sel:WORD_1 dst_unused:UNUSED_PRESERVE src0_sel:WORD_1
v_mfma_f32_16x16x32_bf16 v[188:191], v[44:47], v[116:119], v[188:191]
v_rcp_f16_sdwa v207, v206 dst_sel:WORD_1 dst_unused:UNUSED_PRESERVE src0_sel:WORD_1
v_or_b32 v232, v192, v193
v_or_b32 v233, v194, v195
s_waitcnt lgkmcnt(4)
v_or_b32 v234, v196, v197
v_rcp_f16_sdwa v204, v203 dst_sel:WORD_1 dst_unused:UNUSED_PRESERVE src0_sel:WORD_1
v_or_b32 v235, v198, v199
s_waitcnt lgkmcnt(2)
v_or_b32 v236, v200, v201
v_pk_mul_f16 v237, v243, v242
v_pk_mul_f16 v238, v240, v207
v_pk_mul_f16 v239, v205, v204
v_mfma_f32_16x16x32_f16 v[48:51], v[224:227], v[232:235], v[48:51]
ds_read_b128 v[44:47], v250 offset:15616
v_cvt_pkrtz_f16_f32 v193, v176, v177
v_cvt_pkrtz_f16_f32 v195, v178, v179
v_mfma_f32_16x16x32_f16 v[56:59], v[224:227], v[236:239], v[56:59]
v_cvt_pkrtz_f16_f32 v197, v180, v181
v_cvt_pkrtz_f16_f32 v199, v182, v183
v_mfma_f32_16x16x32_f16 v[52:55], v[228:231], v[232:235], v[52:55]
ds_read_b128 v[224:227], v249 offset:19456
v_cvt_pkrtz_f16_f32 v201, v184, v185
v_cvt_pk_f16_f32 v243, v186, v187
v_mfma_f32_16x16x32_f16 v[60:63], v[228:231], v[236:239], v[60:63]
v_cvt_pk_f16_f32 v240, v188, v189
v_cvt_pk_f16_f32 v205, v190, v191
v_mfma_f32_16x16x32_bf16 v[176:179], v[0:3], v[96:99], 0
ds_read_b128 v[228:231], v250 offset:16384
v_pk_fma_f16 v242, v243, v243, s48
v_and_b32 v193, s49, v193
v_mfma_f32_16x16x32_bf16 v[184:187], v[0:3], v[100:103], 0
v_pk_fma_f16 v207, v240, v240, s48
v_and_b32 v195, s49, v195
s_waitcnt lgkmcnt(3)
v_mfma_f32_16x16x32_f16 v[64:67], v[4:7], v[232:235], v[64:67]
ds_read_b128 v[0:3], v250 offset:16640
v_pk_fma_f16 v204, v205, v205, s48
v_lshrrev_b16 v192, 2, v193
v_pk_mul_f16 v242, v243, v242
v_mfma_f32_16x16x32_f16 v[72:75], v[4:7], v[236:239], v[72:75]
v_lshrrev_b16 v194, 2, v195
v_pk_mul_f16 v207, v240, v207
s_waitcnt vmcnt(5)
v_mfma_f32_16x16x32_bf16 v[56:59], v[26:29], v[36:39], v[56:59]
ds_read_b128 v[4:7], v249 offset:19712
ds_read_u16_d16 v192, v192
ds_read_u16_d16 v194, v194
v_lshrrev_b32 v193, 18, v193
v_pk_mul_f16 v204, v205, v204
v_mfma_f32_16x16x32_bf16 v[60:63], v[24:27], v[36:39], v[60:63]
v_lshrrev_b32 v195, 18, v195
v_mfma_f32_16x16x32_bf16 v[180:183], v[40:43], v[96:99], 0
ds_read_u16_d16_hi v193, v193
ds_read_u16_d16_hi v195, v195
v_exp_f16 v241, v242
v_and_b32 v197, s49, v197
v_mfma_f32_16x16x32_bf16 v[188:191], v[40:43], v[100:103], 0
v_and_b32 v199, s49, v199
s_waitcnt lgkmcnt(6)
v_mfma_f32_16x16x32_f16 v[68:71], v[44:47], v[232:235], v[68:71]
ds_read_b128 v[40:43], v249 offset:20480
v_exp_f16 v206, v207
v_lshrrev_b16 v196, 2, v197
v_mfma_f32_16x16x32_f16 v[76:79], v[44:47], v[236:239], v[76:79]
v_lshrrev_b16 v198, 2, v199
v_exp_f16 v203, v204
v_mfma_f32_16x16x32_bf16 v[176:179], v[224:227], v[104:107], v[176:179]
ds_read_b128 v[44:47], v249 offset:20736
ds_read_u16_d16 v196, v196
ds_read_u16_d16 v198, v198
v_lshrrev_b32 v197, 18, v197
v_lshrrev_b32 v199, 18, v199
v_mfma_f32_16x16x32_bf16 v[184:187], v[224:227], v[108:111], v[184:187]
v_exp_f16_sdwa v241, v242 dst_sel:WORD_1 dst_unused:UNUSED_PRESERVE src0_sel:WORD_1
v_mfma_f32_16x16x32_f16 v[80:83], v[228:231], v[232:235], v[80:83]
ds_read_b128 v[224:227], v250 offset:20480
ds_read_u16_d16_hi v197, v197
ds_read_u16_d16_hi v199, v199
v_and_b32 v201, s49, v201
v_lshrrev_b16 v200, 2, v201
v_mfma_f32_16x16x32_f16 v[168:171], v[228:231], v[236:239], v[168:171]
v_exp_f16_sdwa v206, v207 dst_sel:WORD_1 dst_unused:UNUSED_PRESERVE src0_sel:WORD_1
s_waitcnt lgkmcnt(7)
v_mfma_f32_16x16x32_f16 v[84:87], v[0:3], v[232:235], v[84:87]
ds_read_b128 v[228:231], v250 offset:20736
ds_read_u16_d16 v200, v200
v_lshrrev_b32 v201, 18, v201
v_mfma_f32_16x16x32_f16 v[172:175], v[0:3], v[236:239], v[172:175]
v_exp_f16_sdwa v203, v204 dst_sel:WORD_1 dst_unused:UNUSED_PRESERVE src0_sel:WORD_1
v_pk_add_f16 v241, v241, 1.0 op_sel_hi:[1,0]
v_pk_add_f16 v206, v206, 1.0 op_sel_hi:[1,0]
v_mfma_f32_16x16x32_bf16 v[180:183], v[4:7], v[104:107], v[180:183]
ds_read_b128 v[0:3], v250 offset:21504
ds_read_u16_d16_hi v201, v201
v_pk_add_f16 v203, v203, 1.0 op_sel_hi:[1,0]
v_mfma_f32_16x16x32_bf16 v[188:191], v[4:7], v[108:111], v[188:191]
v_rcp_f16 v242, v241
s_waitcnt lgkmcnt(7)
v_mfma_f32_16x16x32_bf16 v[176:179], v[40:43], v[112:115], v[176:179]
ds_read_b128 v[4:7], v250 offset:21760
v_rcp_f16 v207, v206
v_mfma_f32_16x16x32_bf16 v[184:187], v[40:43], v[116:119], v[184:187]
v_rcp_f16 v204, v203
v_mfma_f32_16x16x32_bf16 v[180:183], v[44:47], v[112:115], v[180:183]
ds_read_b128 v[40:43], v250 offset:22528
v_rcp_f16_sdwa v242, v241 dst_sel:WORD_1 dst_unused:UNUSED_PRESERVE src0_sel:WORD_1
v_mfma_f32_16x16x32_bf16 v[188:191], v[44:47], v[116:119], v[188:191]
v_rcp_f16_sdwa v207, v206 dst_sel:WORD_1 dst_unused:UNUSED_PRESERVE src0_sel:WORD_1
v_or_b32 v232, v192, v193
v_or_b32 v233, v194, v195
s_waitcnt lgkmcnt(4)
v_or_b32 v234, v196, v197
v_rcp_f16_sdwa v204, v203 dst_sel:WORD_1 dst_unused:UNUSED_PRESERVE src0_sel:WORD_1
v_or_b32 v235, v198, v199
s_waitcnt lgkmcnt(2)
v_or_b32 v236, v200, v201
v_pk_mul_f16 v237, v243, v242
v_pk_mul_f16 v238, v240, v207
v_pk_mul_f16 v239, v205, v204
v_mfma_f32_16x16x32_f16 v[48:51], v[224:227], v[232:235], v[48:51]
s_add_u32 s46, s68, 98304
buffer_store_dwordx4 v[160:163], v255, s[8:11], s46 offen offset:256 sc1
ds_read_b128 v[44:47], v250 offset:22784
v_cvt_pkrtz_f16_f32 v193, v176, v177
v_cvt_pkrtz_f16_f32 v195, v178, v179
v_cvt_pkrtz_f16_f32 v197, v180, v181
v_cvt_pkrtz_f16_f32 v199, v182, v183
v_mfma_f32_16x16x32_f16 v[56:59], v[224:227], v[236:239], v[56:59]
v_cvt_pkrtz_f16_f32 v201, v184, v185
v_cvt_pk_f16_f32 v243, v186, v187
v_cvt_pk_f16_f32 v240, v188, v189
v_cvt_pk_f16_f32 v205, v190, v191
v_mfma_f32_16x16x32_f16 v[52:55], v[228:231], v[232:235], v[52:55]
ds_read_b128 v[224:227], v250 offset:26624
v_pk_fma_f16 v242, v243, v243, s48
v_and_b32 v193, s49, v193
v_pk_fma_f16 v207, v240, v240, s48
v_and_b32 v195, s49, v195
v_mfma_f32_16x16x32_f16 v[60:63], v[228:231], v[236:239], v[60:63]
v_pk_fma_f16 v204, v205, v205, s48
v_lshrrev_b16 v192, 2, v193
v_pk_mul_f16 v242, v243, v242
v_lshrrev_b16 v194, 2, v195
v_mfma_f32_16x16x32_f16 v[64:67], v[0:3], v[232:235], v[64:67]
ds_read_b128 v[228:231], v250 offset:26880
ds_read_u16_d16 v192, v192
ds_read_u16_d16 v194, v194
v_pk_mul_f16 v207, v240, v207
v_lshrrev_b32 v193, 18, v193
v_pk_mul_f16 v204, v205, v204
v_lshrrev_b32 v195, 18, v195
v_mfma_f32_16x16x32_f16 v[72:75], v[0:3], v[236:239], v[72:75]
v_exp_f16 v241, v242
v_and_b32 v197, s49, v197
v_and_b32 v199, s49, v199
s_waitcnt vmcnt(4)
v_mfma_f32_16x16x32_bf16 v[72:75], v[26:29], v[32:35], v[72:75]
ds_read_b128 v[0:3], v250 offset:27648
ds_read_u16_d16_hi v193, v193
ds_read_u16_d16_hi v195, v195
v_exp_f16 v206, v207
v_lshrrev_b16 v196, 2, v197
v_lshrrev_b16 v198, 2, v199
v_mfma_f32_16x16x32_bf16 v[76:79], v[24:27], v[32:35], v[76:79]
v_exp_f16 v203, v204
v_lshrrev_b32 v197, 18, v197
v_lshrrev_b32 v199, 18, v199
s_waitcnt lgkmcnt(6)
v_mfma_f32_16x16x32_f16 v[68:71], v[4:7], v[232:235], v[68:71]
ds_read_u16_d16 v196, v196
ds_read_u16_d16 v198, v198
ds_read_u16_d16_hi v197, v197
ds_read_u16_d16_hi v199, v199
v_exp_f16_sdwa v241, v242 dst_sel:WORD_1 dst_unused:UNUSED_PRESERVE src0_sel:WORD_1
v_and_b32 v201, s49, v201
v_lshrrev_b16 v200, 2, v201
v_mfma_f32_16x16x32_f16 v[76:79], v[4:7], v[236:239], v[76:79]
v_exp_f16_sdwa v206, v207 dst_sel:WORD_1 dst_unused:UNUSED_PRESERVE src0_sel:WORD_1
v_lshrrev_b32 v201, 18, v201
v_mfma_f32_16x16x32_f16 v[80:83], v[40:43], v[232:235], v[80:83]
ds_read_b128 v[4:7], v250 offset:27904
ds_read_u16_d16 v200, v200
ds_read_u16_d16_hi v201, v201
v_exp_f16_sdwa v203, v204 dst_sel:WORD_1 dst_unused:UNUSED_PRESERVE src0_sel:WORD_1
v_pk_add_f16 v241, v241, 1.0 op_sel_hi:[1,0]
v_pk_add_f16 v206, v206, 1.0 op_sel_hi:[1,0]
v_pk_add_f16 v203, v203, 1.0 op_sel_hi:[1,0]
v_mfma_f32_16x16x32_f16 v[168:171], v[40:43], v[236:239], v[168:171]
v_rcp_f16 v242, v241
v_rcp_f16 v207, v206
v_mfma_f32_16x16x32_f16 v[84:87], v[44:47], v[232:235], v[84:87]
ds_read_b128 v[40:43], v250 offset:28672
v_rcp_f16 v204, v203
v_rcp_f16_sdwa v242, v241 dst_sel:WORD_1 dst_unused:UNUSED_PRESERVE src0_sel:WORD_1
v_mfma_f32_16x16x32_f16 v[172:175], v[44:47], v[236:239], v[172:175]
v_rcp_f16_sdwa v207, v206 dst_sel:WORD_1 dst_unused:UNUSED_PRESERVE src0_sel:WORD_1
s_waitcnt lgkmcnt(5)
v_or_b32 v232, v192, v193
v_or_b32 v233, v194, v195
v_or_b32 v234, v196, v197
v_rcp_f16_sdwa v204, v203 dst_sel:WORD_1 dst_unused:UNUSED_PRESERVE src0_sel:WORD_1
s_waitcnt lgkmcnt(4)
v_or_b32 v235, v198, v199
s_waitcnt lgkmcnt(1)
v_or_b32 v236, v200, v201
v_pk_mul_f16 v237, v243, v242
v_pk_mul_f16 v238, v240, v207
v_pk_mul_f16 v239, v205, v204
s_waitcnt vmcnt(3)
v_mfma_f32_16x16x32_bf16 v[168:171], v[26:29], v[216:219], v[168:171]
ds_read_b128 v[44:47], v250 offset:28928
v_mfma_f32_16x16x32_bf16 v[172:175], v[24:27], v[216:219], v[172:175]
v_mfma_f32_16x16x32_f16 v[48:51], v[224:227], v[232:235], v[48:51]
s_waitcnt lgkmcnt(0)
v_mfma_f32_16x16x32_f16 v[52:55], v[228:231], v[232:235], v[52:55]
v_mfma_f32_16x16x32_f16 v[64:67], v[0:3], v[232:235], v[64:67]
v_mfma_f32_16x16x32_f16 v[68:71], v[4:7], v[232:235], v[68:71]
v_mfma_f32_16x16x32_f16 v[80:83], v[40:43], v[232:235], v[80:83]
v_mfma_f32_16x16x32_f16 v[84:87], v[44:47], v[232:235], v[84:87]
s_nop 4
v_cvt_pk_bf16_f32 v64, v64, v65
v_cvt_pk_bf16_f32 v65, v66, v67
v_cvt_pk_bf16_f32 v66, v68, v69
v_cvt_pk_bf16_f32 v67, v70, v71
v_cvt_pk_bf16_f32 v48, v48, v49
v_cvt_pk_bf16_f32 v49, v50, v51
v_cvt_pk_bf16_f32 v50, v52, v53
v_cvt_pk_bf16_f32 v51, v54, v55
v_cvt_pk_bf16_f32 v80, v80, v81
v_cvt_pk_bf16_f32 v81, v82, v83
v_cvt_pk_bf16_f32 v82, v84, v85
v_cvt_pk_bf16_f32 v83, v86, v87
s_mov_b64 vcc, s[74:75]
v_cndmask_b32_e64 v68, v48, v80, s[74:75]
v_mfma_f32_16x16x32_f16 v[56:59], v[224:227], v[236:239], v[56:59]
v_cndmask_b32_dpp v48, v64, v48, vcc quad_perm:[1,0,3,2] row_mask:0xf bank_mask:0xf
v_cndmask_b32_e64 v69, v49, v81, s[74:75]
v_mfma_f32_16x16x32_f16 v[60:63], v[228:231], v[236:239], v[60:63]
v_cndmask_b32_dpp v49, v65, v49, vcc quad_perm:[1,0,3,2] row_mask:0xf bank_mask:0xf
v_cndmask_b32_e64 v70, v50, v82, s[74:75]
v_mfma_f32_16x16x32_f16 v[72:75], v[0:3], v[236:239], v[72:75]
v_cndmask_b32_dpp v50, v66, v50, vcc quad_perm:[1,0,3,2] row_mask:0xf bank_mask:0xf
v_mfma_f32_16x16x32_f16 v[76:79], v[4:7], v[236:239], v[76:79]
v_cndmask_b32_e64 v71, v51, v83, s[74:75]
v_cndmask_b32_dpp v51, v67, v51, vcc quad_perm:[1,0,3,2] row_mask:0xf bank_mask:0xf
s_not_b64 vcc, s[74:75]
v_mfma_f32_16x16x32_f16 v[168:171], v[40:43], v[236:239], v[168:171]
v_cndmask_b32_dpp v80, v64, v80, vcc quad_perm:[1,0,3,2] row_mask:0xf bank_mask:0xf
v_cndmask_b32_dpp v81, v65, v81, vcc quad_perm:[1,0,3,2] row_mask:0xf bank_mask:0xf
v_mfma_f32_16x16x32_f16 v[172:175], v[44:47], v[236:239], v[172:175]
v_cndmask_b32_dpp v82, v66, v82, vcc quad_perm:[1,0,3,2] row_mask:0xf bank_mask:0xf
v_cndmask_b32_dpp v83, v67, v83, vcc quad_perm:[1,0,3,2] row_mask:0xf bank_mask:0xf
buffer_store_dwordx4 v[48:51], v255, s[8:11], s69 offen sc1
buffer_store_dwordx4 v[68:71], v255, s[8:11], s69 offen offset:128 sc1
buffer_store_dwordx4 v[80:83], v255, s[8:11], s69 offen offset:256 sc1
v_cvt_pk_bf16_f32 v72, v72, v73
v_cvt_pk_bf16_f32 v73, v74, v75
v_cvt_pk_bf16_f32 v74, v76, v77
v_cvt_pk_bf16_f32 v75, v78, v79
v_cvt_pk_bf16_f32 v56, v56, v57
v_cvt_pk_bf16_f32 v57, v58, v59
v_cvt_pk_bf16_f32 v58, v60, v61
v_cvt_pk_bf16_f32 v59, v62, v63
v_cvt_pk_bf16_f32 v168, v168, v169
v_cvt_pk_bf16_f32 v169, v170, v171
v_cvt_pk_bf16_f32 v170, v172, v173
v_cvt_pk_bf16_f32 v171, v174, v175
s_mov_b64 vcc, s[74:75]
v_cndmask_b32_e64 v76, v56, v168, s[74:75]
v_cndmask_b32_dpp v56, v72, v56, vcc quad_perm:[1,0,3,2] row_mask:0xf bank_mask:0xf
v_cndmask_b32_e64 v77, v57, v169, s[74:75]
v_cndmask_b32_dpp v57, v73, v57, vcc quad_perm:[1,0,3,2] row_mask:0xf bank_mask:0xf
v_cndmask_b32_e64 v78, v58, v170, s[74:75]
v_cndmask_b32_dpp v58, v74, v58, vcc quad_perm:[1,0,3,2] row_mask:0xf bank_mask:0xf
v_cndmask_b32_e64 v79, v59, v171, s[74:75]
v_cndmask_b32_dpp v59, v75, v59, vcc quad_perm:[1,0,3,2] row_mask:0xf bank_mask:0xf
s_not_b64 vcc, s[74:75]
v_cndmask_b32_dpp v168, v72, v168, vcc quad_perm:[1,0,3,2] row_mask:0xf bank_mask:0xf
v_cndmask_b32_dpp v169, v73, v169, vcc quad_perm:[1,0,3,2] row_mask:0xf bank_mask:0xf
v_cndmask_b32_dpp v170, v74, v170, vcc quad_perm:[1,0,3,2] row_mask:0xf bank_mask:0xf
v_cndmask_b32_dpp v171, v75, v171, vcc quad_perm:[1,0,3,2] row_mask:0xf bank_mask:0xf
s_add_u32 s46, s69, 98304
buffer_store_dwordx4 v[56:59], v255, s[8:11], s46 offen sc1
s_add_u32 s46, s69, 98304
buffer_store_dwordx4 v[76:79], v255, s[8:11], s46 offen offset:128 sc1
s_add_u32 s46, s69, 98304
buffer_store_dwordx4 v[168:171], v255, s[8:11], s46 offen offset:256 sc1
s_endpgm
Lpoll:
s_waitcnt vmcnt(0)
Lpoll1:
s_cmp_eq_u32 s77, 2
s_cbranch_scc1 LpollC
v_max_u32 v250, v156, v157
v_max3_u32 v250, v250, v158, v159
v_max3_u32 v250, v250, v160, v161
v_max3_u32 v250, v250, v162, v163
v_max3_u32 v250, v250, v164, v165
v_max3_u32 v250, v250, v166, v167
v_max3_u32 v250, v250, v252, v253
v_max3_u32 v250, v250, v254, v255
v_cmp_eq_u32 vcc, -1, v250
s_nop 4
s_cbranch_vccz LpollR
v_lshlrev_b32 v250, 4, v251
s_lshl_b32 s44, s3, 12
buffer_load_dwordx4 v[156:159], v250, s[32:35], s44 offen sc1
buffer_load_dwordx4 v[160:163], v250, s[32:35], s44 offen offset:1024 sc1
buffer_load_dwordx4 v[164:167], v250, s[32:35], s44 offen offset:2048 sc1
buffer_load_dwordx4 v[252:255], v250, s[32:35], s44 offen offset:3072 sc1
s_setpc_b64 s[78:79]
LpollR:
s_setprio 3
v_add_f32 v156, v156, v160
v_add_f32 v252, v164, v252
v_add_f32 v252, v156, v252
v_add_f32 v157, v157, v161
v_add_f32 v253, v165, v253
v_add_f32 v253, v157, v253
v_add_f32 v158, v158, v162
v_add_f32 v254, v166, v254
v_add_f32 v254, v158, v254
v_add_f32 v159, v159, v163
v_add_f32 v255, v167, v255
v_add_f32 v255, v159, v255
v_add_f32_dpp v252, v252, v252 row_ror:8 row_mask:0xf bank_mask:0xf
v_add_f32_dpp v253, v253, v253 row_ror:8 row_mask:0xf bank_mask:0xf
v_add_f32_dpp v254, v254, v254 row_ror:8 row_mask:0xf bank_mask:0xf
v_add_f32_dpp v255, v255, v255 row_ror:8 row_mask:0xf bank_mask:0xf
v_add_f32_dpp v252, v252, v252 row_ror:4 row_mask:0xf bank_mask:0xf
v_add_f32_dpp v253, v253, v253 row_ror:4 row_mask:0xf bank_mask:0xf
v_add_f32_dpp v254, v254, v254 row_ror:4 row_mask:0xf bank_mask:0xf
v_add_f32_dpp v255, v255, v255 row_ror:4 row_mask:0xf bank_mask:0xf
v_add_f32_dpp v252, v252, v252 row_ror:2 row_mask:0xf bank_mask:0xf
v_add_f32_dpp v253, v253, v253 row_ror:2 row_mask:0xf bank_mask:0xf
v_add_f32_dpp v254, v254, v254 row_ror:2 row_mask:0xf bank_mask:0xf
v_add_f32_dpp v255, v255, v255 row_ror:2 row_mask:0xf bank_mask:0xf
v_add_f32_dpp v252, v252, v252 row_ror:1 row_mask:0xf bank_mask:0xf
v_add_f32_dpp v253, v253, v253 row_ror:1 row_mask:0xf bank_mask:0xf
v_add_f32_dpp v254, v254, v254 row_ror:1 row_mask:0xf bank_mask:0xf
v_add_f32_dpp v255, v255, v255 row_ror:1 row_mask:0xf bank_mask:0xf
v_mov_b32 v156, v252
v_mov_b32 v157, v253
v_mov_b32 v158, v254
v_mov_b32 v159, v255
v_permlane16_swap_b32 v252, v156
v_permlane16_swap_b32 v253, v157
v_permlane16_swap_b32 v254, v158
v_permlane16_swap_b32 v255, v159
v_add_f32 v252, v252, v156
v_add_f32 v253, v253, v157
v_add_f32 v254, v254, v158
v_add_f32 v255, v255, v159
v_mov_b32 v156, v252
v_mov_b32 v157, v253
v_mov_b32 v158, v254
v_mov_b32 v159, v255
v_permlane32_swap_b32 v252, v156
v_permlane32_swap_b32 v253, v157
v_permlane32_swap_b32 v254, v158
v_permlane32_swap_b32 v255, v159
v_add_f32 v252, v252, v156
v_add_f32 v253, v253, v157
v_add_f32 v254, v254, v158
v_add_f32 v255, v255, v159
v_min_u32 v252, -2, v252
v_min_u32 v253, -2, v253
v_min_u32 v254, -2, v254
v_min_u32 v255, -2, v255
s_lshl_b32 s44, s3, 4
s_add_u32 s44, s44, 393216
v_lshlrev_b32 v250, 11, v251
s_mov_b64 exec, 0xff
buffer_store_dwordx4 v[252:255], v250, s[32:35], s44 offen sc1
s_mov_b64 exec, -1
s_cmp_eq_u32 s40, 0
s_cselect_b32 s77, 2, 0
s_cbranch_scc0 LpollRx
LpollG:
s_nop 1
v_lshlrev_b32 v250, 2, v251
buffer_load_dword v162, v250, s[24:27], 0 offen
buffer_load_dword v163, v250, s[24:27], 0 offen offset:256
buffer_load_dword v164, v250, s[24:27], 0 offen offset:512
v_lshlrev_b32 v250, 3, v251
s_and_b32 s44, s2, 7
s_lshl_b32 s44, s44, 11
s_add_u32 s44, s44, 393216
buffer_load_dwordx2 v[156:157], v250, s[32:35], s44 offen sc1
buffer_load_dwordx2 v[158:159], v250, s[32:35], s44 offen offset:512 sc1
buffer_load_dwordx2 v[160:161], v250, s[32:35], s44 offen offset:1024 sc1
LpollRx:
s_setpc_b64 s[78:79]
LpollC:
v_max3_u32 v250, v156, v157, v158
v_max3_u32 v250, v250, v159, v160
v_max_u32 v250, v250, v161
v_cmp_eq_u32 vcc, -1, v250
s_nop 4
s_cbranch_vccz LpollS
v_lshlrev_b32 v250, 3, v251
s_and_b32 s44, s2, 7
s_lshl_b32 s44, s44, 11
s_add_u32 s44, s44, 393216
buffer_load_dwordx2 v[156:157], v250, s[32:35], s44 offen sc1
buffer_load_dwordx2 v[158:159], v250, s[32:35], s44 offen offset:512 sc1
buffer_load_dwordx2 v[160:161], v250, s[32:35], s44 offen offset:1024 sc1
s_setpc_b64 s[78:79]
LpollS:
s_setprio 3
s_mov_b32 s43, 1083296634
v_mov_b32 v165, 897988541
v_fma_f32 v156, v156, s43, v165
v_fma_f32 v157, v157, s43, v165
v_fma_f32 v158, v158, s43, v165
v_fma_f32 v159, v159, s43, v165
v_fma_f32 v160, v160, s43, v165
v_fma_f32 v161, v161, s43, v165
v_sqrt_f32 v156, v156
v_sqrt_f32 v157, v157
v_sqrt_f32 v158, v158
v_sqrt_f32 v159, v159
v_sqrt_f32 v160, v160
v_sqrt_f32 v161, v161
v_add_f32 v166, v156, v157
v_add_f32 v166, v166, v158
v_add_f32 v166, v166, v159
v_add_f32 v166, v166, v160
v_add_f32 v166, v166, v161
s_nop 1
v_add_f32_dpp v166, v166, v166 row_ror:8 row_mask:0xf bank_mask:0xf
s_nop 1
v_add_f32_dpp v166, v166, v166 row_ror:4 row_mask:0xf bank_mask:0xf
s_nop 1
v_add_f32_dpp v166, v166, v166 row_ror:2 row_mask:0xf bank_mask:0xf
s_nop 1
v_add_f32_dpp v166, v166, v166 row_ror:1 row_mask:0xf bank_mask:0xf
v_mov_b32 v250, v166
s_nop 1
v_permlane16_swap_b32 v166, v250
v_add_f32 v166, v166, v250
v_mov_b32 v250, v166
s_nop 1
v_permlane32_swap_b32 v166, v250
v_add_f32 v166, v166, v250
s_mov_b32 s43, 992651947
v_fma_f32 v166, v166, s43, v165
v_rcp_f32 v166, v166
v_mov_b32 v165, 3221789604
v_mul_f32 v166, v166, v165
v_lshlrev_b32 v167, 16, v162
v_and_b32 v252, 4294901760, v162
v_mul_f32 v156, v156, v166
v_mul_f32 v157, v157, v166
v_fma_f32 v167, v167, v156, v165
v_fma_f32 v252, v252, v157, v165
v_cvt_pk_f16_f32 v162, v167, v252
v_lshlrev_b32 v167, 16, v163
v_and_b32 v252, 4294901760, v163
v_mul_f32 v158, v158, v166
v_mul_f32 v159, v159, v166
v_fma_f32 v167, v167, v158, v165
v_fma_f32 v252, v252, v159, v165
v_cvt_pk_f16_f32 v163, v167, v252
v_lshlrev_b32 v167, 16, v164
v_and_b32 v252, 4294901760, v164
v_mul_f32 v160, v160, v166
v_mul_f32 v161, v161, v166
v_fma_f32 v167, v167, v160, v165
v_fma_f32 v252, v252, v161, v165
v_cvt_pk_f16_f32 v164, v167, v252
s_mov_b32 s77, 0
s_setpc_b64 s[78:79]
Lend:
s_endpgm

.section .rodata,"a"
.p2align 6
.amdhsa_kernel standalone__modern_conv_block_convnext_v2__vision_kernel
  .amdhsa_next_free_vgpr 256
  .amdhsa_next_free_sgpr 102
  .amdhsa_accum_offset 256
  .amdhsa_group_segment_fixed_size 0
  .amdhsa_kernarg_size 72
  .amdhsa_user_sgpr_count 2
  .amdhsa_user_sgpr_kernarg_segment_ptr 1
  .amdhsa_system_sgpr_workgroup_id_x 1
.end_amdhsa_kernel
```
